```python
import torch

def _softmax(x, axis=-1):
    return torch.softmax(x, dim=axis)
def _gelu(x):
    return torch.nn.functional.gelu(x, approximate="tanh")
def _silu(x):
    return torch.nn.functional.silu(x)
def _sigmoid(x):
    return torch.sigmoid(x)
def _layernorm(x, axis=-1, eps=1e-5):
    m = x.mean(dim=axis, keepdim=True)
    v = x.var(dim=axis, keepdim=True, unbiased=False)
    return (x - m) / torch.sqrt(v + eps)
def _scatter_add(tgt, idx, src, axis=0):
    return tgt.clone().index_add_(axis, idx, src)
def _segment_sum(src, seg, n):
    out = torch.zeros((n,) + src.shape[1:], dtype=src.dtype)
    return out.index_add_(0, seg, src)
def _pad(x, pw):
    flat = tuple(v for pair in reversed(pw) for v in pair)
    return torch.nn.functional.pad(x, flat)

kernel_name = 'recurrent_scan__compressed_kv_cla__moe_arch_mod__prompt'

def setup_inputs():

    _w = (lambda a: (lambda t: t.to(torch.bfloat16) if t.is_floating_point() else t)(torch.as_tensor(a)))
    def _A_setup():
        B, H, Sq, Sk, D, M = 1, 32, 2048, 2048, 128, 1024
        Dc = 4 * D
        return {
            "x": _w((lambda *s: torch.randn(*s, dtype=torch.bfloat16) * 0.05)(B, Sq, M)),
            "c_kv": _w((lambda *s: torch.randn(*s, dtype=torch.bfloat16) * 0.2)(B, Sk, Dc)),
            "w_q": _w((lambda *s: torch.randn(*s, dtype=torch.bfloat16) * 3.2)(M, H, D) * (M ** -0.5)),
            "w_uk": _w((lambda *s: torch.randn(*s, dtype=torch.bfloat16) * 3.2)(Dc, H, D) * (Dc ** -0.5)),
            "w_uv": _w((lambda *s: torch.randn(*s, dtype=torch.bfloat16) * 0.2)(Dc, H, D) * (Dc ** -0.5)),
            "w_o": _w((lambda *s: torch.randn(*s, dtype=torch.bfloat16) * 0.2)(H, D, M) * ((H * D) ** -0.5)),
        }
    _A_in = _A_setup()

    def _B_setup():
        B, S, D, F, C = 1, 2048, 1024, 3584, 2
        return {
            "x": _w((lambda *s: torch.randn(*s, dtype=torch.bfloat16) * 0.05)(B, S, D)),
            "w_r": _w((lambda *s: torch.randn(*s, dtype=torch.bfloat16) * 0.2)(D)),
            "w_gate": _w((lambda *s: torch.randn(*s, dtype=torch.bfloat16) * 0.1)(D, F)),
            "w_up": _w((lambda *s: torch.randn(*s, dtype=torch.bfloat16) * 0.1)(D, F)),
            "w_down": _w((lambda *s: torch.randn(*s, dtype=torch.bfloat16) * 0.1)(F, D)),
        }
    _B_in = _B_setup()

    return {
        "A_x": _A_in["x"],
        "A_c_kv": _A_in["c_kv"],
        "A_w_q": _A_in["w_q"],
        "A_w_uk": _A_in["w_uk"],
        "A_w_uv": _A_in["w_uv"],
        "A_w_o": _A_in["w_o"],
        "B_x": _B_in["x"],
        "B_w_r": _B_in["w_r"],
        "B_w_gate": _B_in["w_gate"],
        "B_w_up": _B_in["w_up"],
        "B_w_down": _B_in["w_down"],
    }

def reference(A_x, A_c_kv, A_w_q, A_w_uk, A_w_uv, A_w_o, B_x, B_w_r, B_w_gate, B_w_up, B_w_down):
    def _A_ref(x, c_kv, w_q, w_uk, w_uv, w_o):
        B, Sq, M = x.shape[0], x.shape[1], x.shape[2]
        Sk = c_kv.shape[1]
        H, D = w_q.shape[1], w_q.shape[2]
        q = torch.einsum("bqm,mhd->bhqd", x, w_q)
        k = torch.einsum("bkc,chd->bhkd", c_kv, w_uk)
        v = torch.einsum("bkc,chd->bhkd", c_kv, w_uv)
        scores = torch.einsum("bhqd,bhkd->bhqk", q, k) * (D ** -0.5)
        off = Sk - Sq
        qi = torch.arange(Sq)[:, None]
        kj = torch.arange(Sk)[None, :]
        cmask = kj <= (qi + off)
        scores = torch.where(cmask[None, None], scores, -1e9)
        p = _softmax(scores, axis=-1)
        ctx = torch.einsum("bhqk,bhkd->bhqd", p, v)
        return torch.einsum("bhqd,hdm->bqm", ctx, w_o)

    def _B_ref(x, w_r, w_gate, w_up, w_down):
        B, S, D = x.shape
        C = 2
        r = x @ w_r
        idx = torch.argsort(-r, axis=-1)[:, :C]
        idx_e = (lambda x, n, axis: torch.repeat_interleave(x, n, dim=axis))(idx.reshape(B, C, 1), D, axis=2)
        x_sel = (lambda x, i, axis: torch.take_along_dim(x, i, dim=axis))(x, idx_e, axis=1)
        g = _silu(x_sel @ w_gate)
        u = x_sel @ w_up
        y = (g * u) @ w_down
        r_sel = _sigmoid((lambda x, i, axis: torch.take_along_dim(x, i, dim=axis))(r, idx, axis=1))
        y = y * r_sel.reshape(B, C, 1)
        b_off = (torch.arange(B) * S).reshape(B, 1)
        flat_idx = (idx + b_off).reshape(B * C)
        zero = (x * 0.0).reshape(B * S, D)
        upd = _scatter_add(zero, flat_idx, y.reshape(B * C, D), axis=0)
        return x + upd.reshape(B, S, D)

    x = A_x
    xn = _layernorm(x, axis=-1)
    s = _A_ref(xn, A_c_kv, A_w_q, A_w_uk, A_w_uv, A_w_o)
    g = _silu(_B_ref(xn, B_w_r, B_w_gate, B_w_up, B_w_down))
    return x + s * g
```

```asm
; @launch kernel=kv_kernel grid=(256,1,1) block=(256,1,1) lds=148480
; @launch kernel=attn_kernel grid=(256,1,1) block=(256,1,1) lds=139264
; @launch kernel=oproj_kernel grid=(256,1,1) block=(256,1,1) lds=135168
.amdgcn_target "amdgcn-amd-amdhsa--gfx950"
.text
.globl kv_kernel
.p2align 8
.type kv_kernel,@function
kv_kernel:
  s_cmp_ge_u32 s2, 256
  s_cbranch_scc1 L_k1_end
  s_load_dwordx4 s[4:7], s[0:1], 0
  s_load_dwordx4 s[40:43], s[0:1], 24
  s_load_dwordx2 s[44:45], s[0:1], 56
  s_load_dwordx2 s[46:47], s[0:1], 104
  v_lshrrev_b32 v1, 6, v0
  v_and_b32 v0, 63, v0
  v_readfirstlane_b32 s32, v1
  s_lshr_b32 s3, s2, 3
  s_and_b32 s33, s3, 7
  s_lshr_b32 s3, s3, 3
  s_lshr_b32 s35, s3, 1
  s_and_b32 s3, s3, 1
  s_and_b32 s34, s2, 7
  s_lshl_b32 s34, s34, 1
  s_add_u32 s34, s34, s3
  s_mov_b32 s48, 0
  s_mov_b32 s52, 0
  s_mov_b32 s49, 7168
  s_mov_b32 s53, 15360
  s_mov_b32 s50, 14336
  s_mov_b32 s54, 30720
  s_mov_b32 s51, 21504
  s_mov_b32 s55, 46080
  s_lshl_b32 s56, s32, 13
  s_add_u32 s57, s56, 32768
  v_lshrrev_b32 v30, 3, v0
  s_lshl_b32 s3, s32, 6
  v_add_u32 v30, s3, v30
  v_lshlrev_b32 v30, 10, v30
  v_and_b32 v31, 7, v0
  v_lshrrev_b32 v32, 4, v0
  v_xor_b32 v31, v31, v32
  v_lshl_add_u32 v2, v31, 4, v30
  v_xor_b32 v31, 4, v31
  v_lshl_add_u32 v3, v31, 4, v30
  v_add_u32 v4, 32768, v2
  v_add_u32 v5, 32768, v3
  v_lshrrev_b32 v33, 5, v0
  s_lshl_b32 s3, s32, 4
  v_add_u32 v30, s3, v33
  v_lshlrev_b32 v30, 13, v30
  v_and_b32 v31, 31, v0
  v_lshlrev_b32 v34, 1, v33
  v_xor_b32 v31, v31, v34
  v_xor_b32 v34, 0, v31
  v_lshl_add_u32 v6, v34, 4, v30
  v_xor_b32 v34, 4, v31
  v_lshl_add_u32 v7, v34, 4, v30
  v_xor_b32 v34, 8, v31
  v_lshl_add_u32 v8, v34, 4, v30
  v_add_u32 v8, 65536, v8
  v_xor_b32 v34, 12, v31
  v_lshl_add_u32 v9, v34, 4, v30
  v_add_u32 v9, 65536, v9
  v_lshlrev_b32 v35, 11, v33
  v_and_b32 v31, 31, v0
  v_lshl_add_u32 v35, v31, 4, v35
  v_lshrrev_b32 v36, 3, v0
  v_lshlrev_b32 v36, 4, v36
  s_waitcnt lgkmcnt(0)
  s_mov_b32 s16, s4
  s_and_b32 s17, s5, 0xffff
  s_mov_b32 s18, 4194304
  s_mov_b32 s19, 0x20000
  s_mov_b32 s28, s44
  s_and_b32 s29, s45, 0xffff
  s_mov_b32 s30, 2048
  s_mov_b32 s31, 0x20000
  s_lshl_b32 s36, s2, 14
  s_lshl_b32 s37, s32, 9
  s_add_u32 s36, s36, s37
  s_lshl_b32 s38, s32, 12
  s_add_u32 s38, s38, 131072
  s_mov_b32 m0, s38
  s_add_u32 s3, s36, 0
  buffer_load_dwordx4 v35, s[16:19], s3 offen offset:0 nt lds
  s_add_u32 s3, s36, 3072
  buffer_load_dwordx4 v35, s[16:19], s3 offen offset:1024 nt lds
  s_add_u32 s3, s36, 6144
  buffer_load_dwordx4 v35, s[16:19], s3 offen offset:2048 nt lds
  s_add_u32 s3, s36, 9216
  buffer_load_dwordx4 v35, s[16:19], s3 offen offset:3072 nt lds
  buffer_load_dwordx4 v[224:227], v36, s[28:31], s37 offen offset:0
  buffer_load_dwordx4 v[228:231], v36, s[28:31], s37 offen offset:128
  buffer_load_dwordx4 v[232:235], v36, s[28:31], s37 offen offset:256
  buffer_load_dwordx4 v[236:239], v36, s[28:31], s37 offen offset:384
  s_lshl_b32 s3, s33, 18
  s_add_u32 s8, s6, s3
  s_addc_u32 s9, s7, 0
  s_and_b32 s9, s9, 0xffff
  s_mov_b32 s10, 262144
  s_mov_b32 s11, 0x20000
  s_cmp_eq_u32 s35, 0
  s_cselect_b32 s40, s40, s42
  s_cselect_b32 s41, s41, s43
  s_lshl_b32 s3, s34, 9
  s_add_u32 s12, s40, s3
  s_addc_u32 s13, s41, 0
  s_and_b32 s13, s13, 0xffff
  s_mov_b32 s14, 0
  s_mov_b32 s15, 0x20000
  s_sub_u32 s14, 4194304, s3
  s_mov_b32 s20, s46
  s_and_b32 s21, s47, 0xffff
  s_mov_b32 s22, 8388608
  s_mov_b32 s23, 0x20000
  s_add_u32 s24, s46, 8388608
  s_addc_u32 s25, s47, 0
  s_and_b32 s25, s25, 0xffff
  s_mov_b32 s26, 33554432
  s_mov_b32 s27, 0x20000
  s_add_u32 m0, s57, 0
  s_nop 0
  buffer_load_dwordx4 v6, s[12:15], s52 offen offset:0 nt lds
  buffer_load_dwordx4 v7, s[12:15], s53 offen offset:1024 nt lds
  buffer_load_dwordx4 v6, s[12:15], s54 offen offset:2048 nt lds
  buffer_load_dwordx4 v7, s[12:15], s55 offen offset:3072 nt lds
  s_add_u32 m0, s57, 4096
  s_nop 0
  buffer_load_dwordx4 v8, s[12:15], s52 offen offset:0 nt lds
  buffer_load_dwordx4 v9, s[12:15], s53 offen offset:1024 nt lds
  buffer_load_dwordx4 v8, s[12:15], s54 offen offset:2048 nt lds
  buffer_load_dwordx4 v9, s[12:15], s55 offen offset:3072 nt lds
  s_add_u32 m0, s56, 0
  s_nop 0
  buffer_load_dwordx4 v2, s[8:11], s48 offen offset:0 lds
  buffer_load_dwordx4 v3, s[8:11], s49 offen offset:1024 lds
  buffer_load_dwordx4 v2, s[8:11], s50 offen offset:2048 lds
  buffer_load_dwordx4 v3, s[8:11], s51 offen offset:3072 lds
  s_add_u32 m0, s56, 4096
  s_nop 0
  buffer_load_dwordx4 v4, s[8:11], s48 offen offset:0 lds
  buffer_load_dwordx4 v5, s[8:11], s49 offen offset:1024 lds
  buffer_load_dwordx4 v4, s[8:11], s50 offen offset:2048 lds
  buffer_load_dwordx4 v5, s[8:11], s51 offen offset:3072 lds
  v_add_u32 v6, 524288, v6
  v_add_u32 v7, 524288, v7
  v_add_u32 v8, 524288, v8
  v_add_u32 v9, 524288, v9
  v_add_u32 v2, 128, v2
  v_add_u32 v3, 128, v3
  v_add_u32 v4, 128, v4
  v_add_u32 v5, 128, v5
  s_add_u32 m0, s57, 65536
  s_nop 0
  buffer_load_dwordx4 v6, s[12:15], s52 offen offset:0 nt lds
  buffer_load_dwordx4 v7, s[12:15], s53 offen offset:1024 nt lds
  buffer_load_dwordx4 v6, s[12:15], s54 offen offset:2048 nt lds
  buffer_load_dwordx4 v7, s[12:15], s55 offen offset:3072 nt lds
  s_add_u32 m0, s57, 69632
  s_nop 0
  buffer_load_dwordx4 v8, s[12:15], s52 offen offset:0 nt lds
  buffer_load_dwordx4 v9, s[12:15], s53 offen offset:1024 nt lds
  buffer_load_dwordx4 v8, s[12:15], s54 offen offset:2048 nt lds
  buffer_load_dwordx4 v9, s[12:15], s55 offen offset:3072 nt lds
  s_add_u32 m0, s56, 65536
  s_nop 0
  buffer_load_dwordx4 v2, s[8:11], s48 offen offset:0 lds
  buffer_load_dwordx4 v3, s[8:11], s49 offen offset:1024 lds
  buffer_load_dwordx4 v2, s[8:11], s50 offen offset:2048 lds
  buffer_load_dwordx4 v3, s[8:11], s51 offen offset:3072 lds
  s_add_u32 m0, s56, 69632
  s_nop 0
  buffer_load_dwordx4 v4, s[8:11], s48 offen offset:0 lds
  buffer_load_dwordx4 v5, s[8:11], s49 offen offset:1024 lds
  buffer_load_dwordx4 v4, s[8:11], s50 offen offset:2048 lds
  buffer_load_dwordx4 v5, s[8:11], s51 offen offset:3072 lds
  v_add_u32 v6, 524288, v6
  v_add_u32 v7, 524288, v7
  v_add_u32 v8, 524288, v8
  v_add_u32 v9, 524288, v9
  v_add_u32 v2, 128, v2
  v_add_u32 v3, 128, v3
  v_add_u32 v4, 128, v4
  v_add_u32 v5, 128, v5
  s_cmp_lt_u32 s32, 2
  s_cselect_b32 s60, s8, s12
  s_cselect_b32 s61, s9, s13
  s_cselect_b32 s62, s10, s14
  s_mov_b32 s63, 0x20000
  s_mov_b32 s59, 524288
  s_cselect_b32 s59, 128, s59
  s_lshr_b32 s3, s2, 6
  s_lshl_b32 s3, s3, 1
  s_add_u32 s3, s3, s32
  s_lshl_b32 s3, s3, 15
  s_add_u32 s3, s3, 256
  v_lshlrev_b32 v37, 10, v0
  v_add_u32 v37, s3, v37
  v_lshrrev_b32 v38, 2, v0
  v_lshlrev_b32 v38, 13, v38
  v_and_b32 v39, 3, v0
  v_lshl_add_u32 v38, v39, 7, v38
  s_lshl_b32 s39, s33, 1
  s_add_u32 s39, s39, s32
  s_lshl_b32 s39, s39, 15
  s_add_u32 s39, s39, 983040
  v_add_u32 v38, s39, v38
  s_cmp_lt_u32 s32, 2
  s_cselect_b64 vcc, -1, 0
  s_cselect_b32 s3, 32, 16
  v_cndmask_b32 v47, v38, v37, vcc
  v_cmp_gt_u32 vcc, s3, v0
  v_mov_b32 v37, 0x7ff00000
  s_nop 0
  v_cndmask_b32 v47, v37, v47, vcc
  buffer_load_dword v1, v47, s[60:63], 0 offen
  v_add_u32 v47, s59, v47
  buffer_load_dword v1, v47, s[60:63], 0 offen
  v_add_u32 v47, s59, v47
  v_and_b32 v30, 15, v0
  s_lshr_b32 s3, s32, 1
  s_lshl_b32 s3, s3, 14
  v_lshlrev_b32 v31, 7, v30
  v_add_u32 v31, s3, v31
  v_lshrrev_b32 v33, 1, v30
  v_xor_b32 v33, v33, v32
  v_lshl_add_u32 v10, v33, 4, v31
  v_xor_b32 v33, 4, v33
  v_lshl_add_u32 v11, v33, 4, v31
  v_lshrrev_b32 v30, 2, v30
  v_lshl_add_u32 v31, v32, 3, v30
  v_lshlrev_b32 v31, 9, v31
  v_and_b32 v33, 3, v0
  v_lshl_add_u32 v31, v33, 3, v31
  s_and_b32 s3, s32, 1
  s_lshl_b32 s3, s3, 8
  s_add_u32 s3, s3, 32768
  v_add_u32 v31, s3, v31
  v_and_b32 v33, 1, v32
  v_lshl_add_u32 v30, v33, 2, v30
  v_xor_b32 v33, 0, v30
  v_lshl_add_u32 v12, v33, 5, v31
  v_xor_b32 v33, 1, v30
  v_lshl_add_u32 v13, v33, 5, v31
  v_xor_b32 v33, 2, v30
  v_lshl_add_u32 v14, v33, 5, v31
  v_xor_b32 v33, 3, v30
  v_lshl_add_u32 v15, v33, 5, v31
  v_xor_b32 v33, 4, v30
  v_lshl_add_u32 v16, v33, 5, v31
  v_xor_b32 v33, 5, v30
  v_lshl_add_u32 v17, v33, 5, v31
  v_xor_b32 v33, 6, v30
  v_lshl_add_u32 v18, v33, 5, v31
  v_xor_b32 v33, 7, v30
  v_lshl_add_u32 v19, v33, 5, v31
  v_add_u32 v20, 65536, v10
  v_add_u32 v21, 65536, v11
  v_add_u32 v22, 65536, v12
  v_add_u32 v23, 65536, v13
  v_add_u32 v24, 65536, v14
  v_add_u32 v25, 65536, v15
  v_add_u32 v26, 65536, v16
  v_add_u32 v27, 65536, v17
  v_add_u32 v28, 65536, v18
  v_add_u32 v29, 65536, v19
  v_mov_b32 v48, 0
  v_mov_b32 v49, 0
  v_mov_b32 v50, 0
  v_mov_b32 v51, 0
  v_mov_b32 v52, 0
  v_mov_b32 v53, 0
  v_mov_b32 v54, 0
  v_mov_b32 v55, 0
  v_mov_b32 v56, 0
  v_mov_b32 v57, 0
  v_mov_b32 v58, 0
  v_mov_b32 v59, 0
  v_mov_b32 v60, 0
  v_mov_b32 v61, 0
  v_mov_b32 v62, 0
  v_mov_b32 v63, 0
  v_mov_b32 v64, 0
  v_mov_b32 v65, 0
  v_mov_b32 v66, 0
  v_mov_b32 v67, 0
  v_mov_b32 v68, 0
  v_mov_b32 v69, 0
  v_mov_b32 v70, 0
  v_mov_b32 v71, 0
  v_mov_b32 v72, 0
  v_mov_b32 v73, 0
  v_mov_b32 v74, 0
  v_mov_b32 v75, 0
  v_mov_b32 v76, 0
  v_mov_b32 v77, 0
  v_mov_b32 v78, 0
  v_mov_b32 v79, 0
  v_mov_b32 v80, 0
  v_mov_b32 v81, 0
  v_mov_b32 v82, 0
  v_mov_b32 v83, 0
  v_mov_b32 v84, 0
  v_mov_b32 v85, 0
  v_mov_b32 v86, 0
  v_mov_b32 v87, 0
  v_mov_b32 v88, 0
  v_mov_b32 v89, 0
  v_mov_b32 v90, 0
  v_mov_b32 v91, 0
  v_mov_b32 v92, 0
  v_mov_b32 v93, 0
  v_mov_b32 v94, 0
  v_mov_b32 v95, 0
  v_mov_b32 v96, 0
  v_mov_b32 v97, 0
  v_mov_b32 v98, 0
  v_mov_b32 v99, 0
  v_mov_b32 v100, 0
  v_mov_b32 v101, 0
  v_mov_b32 v102, 0
  v_mov_b32 v103, 0
  v_mov_b32 v104, 0
  v_mov_b32 v105, 0
  v_mov_b32 v106, 0
  v_mov_b32 v107, 0
  v_mov_b32 v108, 0
  v_mov_b32 v109, 0
  v_mov_b32 v110, 0
  v_mov_b32 v111, 0
  v_mov_b32 v112, 0
  v_mov_b32 v113, 0
  v_mov_b32 v114, 0
  v_mov_b32 v115, 0
  v_mov_b32 v116, 0
  v_mov_b32 v117, 0
  v_mov_b32 v118, 0
  v_mov_b32 v119, 0
  v_mov_b32 v120, 0
  v_mov_b32 v121, 0
  v_mov_b32 v122, 0
  v_mov_b32 v123, 0
  v_mov_b32 v124, 0
  v_mov_b32 v125, 0
  v_mov_b32 v126, 0
  v_mov_b32 v127, 0
  v_mov_b32 v128, 0
  v_mov_b32 v129, 0
  v_mov_b32 v130, 0
  v_mov_b32 v131, 0
  v_mov_b32 v132, 0
  v_mov_b32 v133, 0
  v_mov_b32 v134, 0
  v_mov_b32 v135, 0
  v_mov_b32 v136, 0
  v_mov_b32 v137, 0
  v_mov_b32 v138, 0
  v_mov_b32 v139, 0
  v_mov_b32 v140, 0
  v_mov_b32 v141, 0
  v_mov_b32 v142, 0
  v_mov_b32 v143, 0
  v_mov_b32 v144, 0
  v_mov_b32 v145, 0
  v_mov_b32 v146, 0
  v_mov_b32 v147, 0
  v_mov_b32 v148, 0
  v_mov_b32 v149, 0
  v_mov_b32 v150, 0
  v_mov_b32 v151, 0
  v_mov_b32 v152, 0
  v_mov_b32 v153, 0
  v_mov_b32 v154, 0
  v_mov_b32 v155, 0
  v_mov_b32 v156, 0
  v_mov_b32 v157, 0
  v_mov_b32 v158, 0
  v_mov_b32 v159, 0
  v_accvgpr_write_b32 a128, 0
  v_accvgpr_write_b32 a129, 0
  v_accvgpr_write_b32 a130, 0
  v_accvgpr_write_b32 a131, 0
  v_accvgpr_write_b32 a132, 0
  v_accvgpr_write_b32 a133, 0
  v_accvgpr_write_b32 a134, 0
  v_accvgpr_write_b32 a135, 0
  v_accvgpr_write_b32 a136, 0
  v_accvgpr_write_b32 a137, 0
  v_accvgpr_write_b32 a138, 0
  v_accvgpr_write_b32 a139, 0
  v_accvgpr_write_b32 a140, 0
  v_accvgpr_write_b32 a141, 0
  v_accvgpr_write_b32 a142, 0
  v_accvgpr_write_b32 a143, 0
  v_accvgpr_write_b32 a144, 0
  v_accvgpr_write_b32 a145, 0
  v_accvgpr_write_b32 a146, 0
  v_accvgpr_write_b32 a147, 0
  v_accvgpr_write_b32 a148, 0
  v_accvgpr_write_b32 a149, 0
  v_accvgpr_write_b32 a150, 0
  v_accvgpr_write_b32 a151, 0
  v_accvgpr_write_b32 a152, 0
  v_accvgpr_write_b32 a153, 0
  v_accvgpr_write_b32 a154, 0
  v_accvgpr_write_b32 a155, 0
  v_accvgpr_write_b32 a156, 0
  v_accvgpr_write_b32 a157, 0
  v_accvgpr_write_b32 a158, 0
  v_accvgpr_write_b32 a159, 0
  v_accvgpr_write_b32 a160, 0
  v_accvgpr_write_b32 a161, 0
  v_accvgpr_write_b32 a162, 0
  v_accvgpr_write_b32 a163, 0
  v_accvgpr_write_b32 a164, 0
  v_accvgpr_write_b32 a165, 0
  v_accvgpr_write_b32 a166, 0
  v_accvgpr_write_b32 a167, 0
  v_accvgpr_write_b32 a168, 0
  v_accvgpr_write_b32 a169, 0
  v_accvgpr_write_b32 a170, 0
  v_accvgpr_write_b32 a171, 0
  v_accvgpr_write_b32 a172, 0
  v_accvgpr_write_b32 a173, 0
  v_accvgpr_write_b32 a174, 0
  v_accvgpr_write_b32 a175, 0
  v_and_b32 v30, 7, v0
  v_lshrrev_b32 v31, 3, v0
  v_lshlrev_b32 v33, 9, v30
  v_lshl_add_u32 v33, v31, 4, v33
  v_add_u32 v33, s38, v33
  v_lshlrev_b32 v34, 4, v30
  v_add_u32 v34, 147456, v34
  s_lshl_b32 s3, s32, 2
  v_add_u32 v35, s3, v34
  s_waitcnt vmcnt(34)
  ds_read_b128 v[240:243], v33 offset:0
  ds_read_b128 v[244:247], v33 offset:128
  ds_read_b128 v[248:251], v33 offset:256
  ds_read_b128 v[252:255], v33 offset:384
  v_lshlrev_b32 v192, 16, v224
  v_and_b32 v193, 0xffff0000, v224
  v_lshlrev_b32 v194, 16, v225
  v_and_b32 v195, 0xffff0000, v225
  v_lshlrev_b32 v196, 16, v226
  v_and_b32 v197, 0xffff0000, v226
  v_lshlrev_b32 v198, 16, v227
  v_and_b32 v199, 0xffff0000, v227
  v_lshlrev_b32 v200, 16, v228
  v_and_b32 v201, 0xffff0000, v228
  v_lshlrev_b32 v202, 16, v229
  v_and_b32 v203, 0xffff0000, v229
  v_lshlrev_b32 v204, 16, v230
  v_and_b32 v205, 0xffff0000, v230
  v_lshlrev_b32 v206, 16, v231
  v_and_b32 v207, 0xffff0000, v231
  v_lshlrev_b32 v208, 16, v232
  v_and_b32 v209, 0xffff0000, v232
  v_lshlrev_b32 v210, 16, v233
  v_and_b32 v211, 0xffff0000, v233
  v_lshlrev_b32 v212, 16, v234
  v_and_b32 v213, 0xffff0000, v234
  v_lshlrev_b32 v214, 16, v235
  v_and_b32 v215, 0xffff0000, v235
  v_lshlrev_b32 v216, 16, v236
  v_and_b32 v217, 0xffff0000, v236
  v_lshlrev_b32 v218, 16, v237
  v_and_b32 v219, 0xffff0000, v237
  v_lshlrev_b32 v220, 16, v238
  v_and_b32 v221, 0xffff0000, v238
  v_lshlrev_b32 v222, 16, v239
  v_and_b32 v223, 0xffff0000, v239
  s_waitcnt lgkmcnt(0)
  v_lshlrev_b32 v160, 16, v240
  v_and_b32 v161, 0xffff0000, v240
  v_lshlrev_b32 v162, 16, v241
  v_and_b32 v163, 0xffff0000, v241
  v_lshlrev_b32 v164, 16, v242
  v_and_b32 v165, 0xffff0000, v242
  v_lshlrev_b32 v166, 16, v243
  v_and_b32 v167, 0xffff0000, v243
  v_lshlrev_b32 v168, 16, v244
  v_and_b32 v169, 0xffff0000, v244
  v_lshlrev_b32 v170, 16, v245
  v_and_b32 v171, 0xffff0000, v245
  v_lshlrev_b32 v172, 16, v246
  v_and_b32 v173, 0xffff0000, v246
  v_lshlrev_b32 v174, 16, v247
  v_and_b32 v175, 0xffff0000, v247
  v_lshlrev_b32 v176, 16, v248
  v_and_b32 v177, 0xffff0000, v248
  v_lshlrev_b32 v178, 16, v249
  v_and_b32 v179, 0xffff0000, v249
  v_lshlrev_b32 v180, 16, v250
  v_and_b32 v181, 0xffff0000, v250
  v_lshlrev_b32 v182, 16, v251
  v_and_b32 v183, 0xffff0000, v251
  v_lshlrev_b32 v184, 16, v252
  v_and_b32 v185, 0xffff0000, v252
  v_lshlrev_b32 v186, 16, v253
  v_and_b32 v187, 0xffff0000, v253
  v_lshlrev_b32 v188, 16, v254
  v_and_b32 v189, 0xffff0000, v254
  v_lshlrev_b32 v190, 16, v255
  v_and_b32 v191, 0xffff0000, v255
  v_add_f32 v38, v160, v161
  v_add_f32 v39, v162, v163
  v_add_f32 v38, v38, v164
  v_add_f32 v39, v39, v165
  v_add_f32 v38, v38, v166
  v_add_f32 v39, v39, v167
  v_add_f32 v38, v38, v168
  v_add_f32 v39, v39, v169
  v_add_f32 v38, v38, v170
  v_add_f32 v39, v39, v171
  v_add_f32 v38, v38, v172
  v_add_f32 v39, v39, v173
  v_add_f32 v38, v38, v174
  v_add_f32 v39, v39, v175
  v_add_f32 v38, v38, v176
  v_add_f32 v39, v39, v177
  v_add_f32 v38, v38, v178
  v_add_f32 v39, v39, v179
  v_add_f32 v38, v38, v180
  v_add_f32 v39, v39, v181
  v_add_f32 v38, v38, v182
  v_add_f32 v39, v39, v183
  v_add_f32 v38, v38, v184
  v_add_f32 v39, v39, v185
  v_add_f32 v38, v38, v186
  v_add_f32 v39, v39, v187
  v_add_f32 v38, v38, v188
  v_add_f32 v39, v39, v189
  v_add_f32 v38, v38, v190
  v_add_f32 v39, v39, v191
  v_add_f32 v38, v38, v39
  s_nop 1
  v_add_f32_dpp v38, v38, v38 row_ror:8 row_mask:0xf bank_mask:0xf
  v_mov_b32 v37, v38
  s_nop 1
  v_permlane16_swap_b32 v37, v38
  v_add_f32 v38, v38, v37
  v_mov_b32 v37, v38
  s_nop 1
  v_permlane32_swap_b32 v37, v38
  v_add_f32 v38, v38, v37
  ds_write_b32 v35, v38 offset:0
  s_waitcnt lgkmcnt(0)
  s_barrier
  ds_read_b128 v[40:43], v34 offset:0
  s_waitcnt lgkmcnt(0)
  v_add_f32 v40, v40, v41
  v_add_f32 v42, v42, v43
  v_add_f32 v38, v40, v42
  v_mul_f32 v38, 0x3a800000, v38
  v_sub_f32 v44, v160, v38
  v_sub_f32 v45, v161, v38
  v_mul_f32 v39, v44, v44
  v_mul_f32 v46, v45, v45
  v_sub_f32 v44, v162, v38
  v_sub_f32 v45, v163, v38
  v_fmac_f32 v39, v44, v44
  v_fmac_f32 v46, v45, v45
  v_sub_f32 v44, v164, v38
  v_sub_f32 v45, v165, v38
  v_fmac_f32 v39, v44, v44
  v_fmac_f32 v46, v45, v45
  v_sub_f32 v44, v166, v38
  v_sub_f32 v45, v167, v38
  v_fmac_f32 v39, v44, v44
  v_fmac_f32 v46, v45, v45
  v_sub_f32 v44, v168, v38
  v_sub_f32 v45, v169, v38
  v_fmac_f32 v39, v44, v44
  v_fmac_f32 v46, v45, v45
  v_sub_f32 v44, v170, v38
  v_sub_f32 v45, v171, v38
  v_fmac_f32 v39, v44, v44
  v_fmac_f32 v46, v45, v45
  v_sub_f32 v44, v172, v38
  v_sub_f32 v45, v173, v38
  v_fmac_f32 v39, v44, v44
  v_fmac_f32 v46, v45, v45
  v_sub_f32 v44, v174, v38
  v_sub_f32 v45, v175, v38
  v_fmac_f32 v39, v44, v44
  v_fmac_f32 v46, v45, v45
  v_sub_f32 v44, v176, v38
  v_sub_f32 v45, v177, v38
  v_fmac_f32 v39, v44, v44
  v_fmac_f32 v46, v45, v45
  v_sub_f32 v44, v178, v38
  v_sub_f32 v45, v179, v38
  v_fmac_f32 v39, v44, v44
  v_fmac_f32 v46, v45, v45
  v_sub_f32 v44, v180, v38
  v_sub_f32 v45, v181, v38
  v_fmac_f32 v39, v44, v44
  v_fmac_f32 v46, v45, v45
  v_sub_f32 v44, v182, v38
  v_sub_f32 v45, v183, v38
  v_fmac_f32 v39, v44, v44
  v_fmac_f32 v46, v45, v45
  v_sub_f32 v44, v184, v38
  v_sub_f32 v45, v185, v38
  v_fmac_f32 v39, v44, v44
  v_fmac_f32 v46, v45, v45
  v_sub_f32 v44, v186, v38
  v_sub_f32 v45, v187, v38
  v_fmac_f32 v39, v44, v44
  v_fmac_f32 v46, v45, v45
  v_sub_f32 v44, v188, v38
  v_sub_f32 v45, v189, v38
  v_fmac_f32 v39, v44, v44
  v_fmac_f32 v46, v45, v45
  v_sub_f32 v44, v190, v38
  v_sub_f32 v45, v191, v38
  v_fmac_f32 v39, v44, v44
  v_fmac_f32 v46, v45, v45
  v_add_f32 v39, v39, v46
  s_nop 1
  v_add_f32_dpp v39, v39, v39 row_ror:8 row_mask:0xf bank_mask:0xf
  v_mov_b32 v37, v39
  s_nop 1
  v_permlane16_swap_b32 v37, v39
  v_add_f32 v39, v39, v37
  v_mov_b32 v37, v39
  s_nop 1
  v_permlane32_swap_b32 v37, v39
  v_add_f32 v39, v39, v37
  ds_write_b32 v35, v39 offset:128
  s_waitcnt lgkmcnt(0)
  s_barrier
  ds_read_b128 v[40:43], v34 offset:128
  s_waitcnt lgkmcnt(0)
  v_add_f32 v40, v40, v41
  v_add_f32 v42, v42, v43
  v_add_f32 v39, v40, v42
  v_mul_f32 v39, 0x3a800000, v39
  v_cvt_pk_bf16_f32 v44, v38, v39
  v_lshlrev_b32 v38, 16, v44
  v_and_b32 v39, 0xffff0000, v44
  v_add_f32 v39, 0x3727c5ac, v39
  v_cvt_pk_bf16_f32 v44, v39, v39
  v_lshlrev_b32 v39, 16, v44
  v_sqrt_f32 v39, v39
  s_nop 0
  v_cvt_pk_bf16_f32 v44, v39, v39
  v_lshlrev_b32 v44, 16, v44
  v_rcp_f32 v39, v44
  s_nop 0
  v_fma_f32 v45, -v44, v39, 1.0
  v_fma_f32 v39, v45, v39, v39
  v_sub_f32 v160, v160, v38
  v_sub_f32 v161, v161, v38
  v_cvt_pk_bf16_f32 v44, v160, v161
  v_lshlrev_b32 v160, 16, v44
  v_and_b32 v161, 0xffff0000, v44
  v_mul_f32 v160, v160, v39
  v_mul_f32 v161, v161, v39
  v_cvt_pk_bf16_f32 v240, v160, v161
  v_lshlrev_b32 v160, 16, v240
  v_and_b32 v161, 0xffff0000, v240
  v_sub_f32 v162, v162, v38
  v_sub_f32 v163, v163, v38
  v_cvt_pk_bf16_f32 v44, v162, v163
  v_lshlrev_b32 v162, 16, v44
  v_and_b32 v163, 0xffff0000, v44
  v_mul_f32 v162, v162, v39
  v_mul_f32 v163, v163, v39
  v_cvt_pk_bf16_f32 v241, v162, v163
  v_lshlrev_b32 v162, 16, v241
  v_and_b32 v163, 0xffff0000, v241
  v_sub_f32 v164, v164, v38
  v_sub_f32 v165, v165, v38
  v_cvt_pk_bf16_f32 v44, v164, v165
  v_lshlrev_b32 v164, 16, v44
  v_and_b32 v165, 0xffff0000, v44
  v_mul_f32 v164, v164, v39
  v_mul_f32 v165, v165, v39
  v_cvt_pk_bf16_f32 v242, v164, v165
  v_lshlrev_b32 v164, 16, v242
  v_and_b32 v165, 0xffff0000, v242
  v_sub_f32 v166, v166, v38
  v_sub_f32 v167, v167, v38
  v_cvt_pk_bf16_f32 v44, v166, v167
  v_lshlrev_b32 v166, 16, v44
  v_and_b32 v167, 0xffff0000, v44
  v_mul_f32 v166, v166, v39
  v_mul_f32 v167, v167, v39
  v_cvt_pk_bf16_f32 v243, v166, v167
  v_lshlrev_b32 v166, 16, v243
  v_and_b32 v167, 0xffff0000, v243
  v_sub_f32 v168, v168, v38
  v_sub_f32 v169, v169, v38
  v_cvt_pk_bf16_f32 v44, v168, v169
  v_lshlrev_b32 v168, 16, v44
  v_and_b32 v169, 0xffff0000, v44
  v_mul_f32 v168, v168, v39
  v_mul_f32 v169, v169, v39
  v_cvt_pk_bf16_f32 v244, v168, v169
  v_lshlrev_b32 v168, 16, v244
  v_and_b32 v169, 0xffff0000, v244
  v_sub_f32 v170, v170, v38
  v_sub_f32 v171, v171, v38
  v_cvt_pk_bf16_f32 v44, v170, v171
  v_lshlrev_b32 v170, 16, v44
  v_and_b32 v171, 0xffff0000, v44
  v_mul_f32 v170, v170, v39
  v_mul_f32 v171, v171, v39
  v_cvt_pk_bf16_f32 v245, v170, v171
  v_lshlrev_b32 v170, 16, v245
  v_and_b32 v171, 0xffff0000, v245
  v_sub_f32 v172, v172, v38
  v_sub_f32 v173, v173, v38
  v_cvt_pk_bf16_f32 v44, v172, v173
  v_lshlrev_b32 v172, 16, v44
  v_and_b32 v173, 0xffff0000, v44
  v_mul_f32 v172, v172, v39
  v_mul_f32 v173, v173, v39
  v_cvt_pk_bf16_f32 v246, v172, v173
  v_lshlrev_b32 v172, 16, v246
  v_and_b32 v173, 0xffff0000, v246
  v_sub_f32 v174, v174, v38
  v_sub_f32 v175, v175, v38
  v_cvt_pk_bf16_f32 v44, v174, v175
  v_lshlrev_b32 v174, 16, v44
  v_and_b32 v175, 0xffff0000, v44
  v_mul_f32 v174, v174, v39
  v_mul_f32 v175, v175, v39
  v_cvt_pk_bf16_f32 v247, v174, v175
  v_lshlrev_b32 v174, 16, v247
  v_and_b32 v175, 0xffff0000, v247
  v_sub_f32 v176, v176, v38
  v_sub_f32 v177, v177, v38
  v_cvt_pk_bf16_f32 v44, v176, v177
  v_lshlrev_b32 v176, 16, v44
  v_and_b32 v177, 0xffff0000, v44
  v_mul_f32 v176, v176, v39
  v_mul_f32 v177, v177, v39
  v_cvt_pk_bf16_f32 v248, v176, v177
  v_lshlrev_b32 v176, 16, v248
  v_and_b32 v177, 0xffff0000, v248
  v_sub_f32 v178, v178, v38
  v_sub_f32 v179, v179, v38
  v_cvt_pk_bf16_f32 v44, v178, v179
  v_lshlrev_b32 v178, 16, v44
  v_and_b32 v179, 0xffff0000, v44
  v_mul_f32 v178, v178, v39
  v_mul_f32 v179, v179, v39
  v_cvt_pk_bf16_f32 v249, v178, v179
  v_lshlrev_b32 v178, 16, v249
  v_and_b32 v179, 0xffff0000, v249
  v_sub_f32 v180, v180, v38
  v_sub_f32 v181, v181, v38
  v_cvt_pk_bf16_f32 v44, v180, v181
  v_lshlrev_b32 v180, 16, v44
  v_and_b32 v181, 0xffff0000, v44
  v_mul_f32 v180, v180, v39
  v_mul_f32 v181, v181, v39
  v_cvt_pk_bf16_f32 v250, v180, v181
  v_lshlrev_b32 v180, 16, v250
  v_and_b32 v181, 0xffff0000, v250
  v_sub_f32 v182, v182, v38
  v_sub_f32 v183, v183, v38
  v_cvt_pk_bf16_f32 v44, v182, v183
  v_lshlrev_b32 v182, 16, v44
  v_and_b32 v183, 0xffff0000, v44
  v_mul_f32 v182, v182, v39
  v_mul_f32 v183, v183, v39
  v_cvt_pk_bf16_f32 v251, v182, v183
  v_lshlrev_b32 v182, 16, v251
  v_and_b32 v183, 0xffff0000, v251
  v_sub_f32 v184, v184, v38
  v_sub_f32 v185, v185, v38
  v_cvt_pk_bf16_f32 v44, v184, v185
  v_lshlrev_b32 v184, 16, v44
  v_and_b32 v185, 0xffff0000, v44
  v_mul_f32 v184, v184, v39
  v_mul_f32 v185, v185, v39
  v_cvt_pk_bf16_f32 v252, v184, v185
  v_lshlrev_b32 v184, 16, v252
  v_and_b32 v185, 0xffff0000, v252
  v_sub_f32 v186, v186, v38
  v_sub_f32 v187, v187, v38
  v_cvt_pk_bf16_f32 v44, v186, v187
  v_lshlrev_b32 v186, 16, v44
  v_and_b32 v187, 0xffff0000, v44
  v_mul_f32 v186, v186, v39
  v_mul_f32 v187, v187, v39
  v_cvt_pk_bf16_f32 v253, v186, v187
  v_lshlrev_b32 v186, 16, v253
  v_and_b32 v187, 0xffff0000, v253
  v_sub_f32 v188, v188, v38
  v_sub_f32 v189, v189, v38
  v_cvt_pk_bf16_f32 v44, v188, v189
  v_lshlrev_b32 v188, 16, v44
  v_and_b32 v189, 0xffff0000, v44
  v_mul_f32 v188, v188, v39
  v_mul_f32 v189, v189, v39
  v_cvt_pk_bf16_f32 v254, v188, v189
  v_lshlrev_b32 v188, 16, v254
  v_and_b32 v189, 0xffff0000, v254
  v_sub_f32 v190, v190, v38
  v_sub_f32 v191, v191, v38
  v_cvt_pk_bf16_f32 v44, v190, v191
  v_lshlrev_b32 v190, 16, v44
  v_and_b32 v191, 0xffff0000, v44
  v_mul_f32 v190, v190, v39
  v_mul_f32 v191, v191, v39
  v_cvt_pk_bf16_f32 v255, v190, v191
  v_lshlrev_b32 v190, 16, v255
  v_and_b32 v191, 0xffff0000, v255
  v_lshlrev_b32 v44, 8, v31
  v_lshl_add_u32 v44, v30, 4, v44
  s_lshr_b32 s3, s2, 1
  s_lshl_b32 s3, s3, 15
  s_add_u32 s3, s3, s56
  s_and_b32 s39, s2, 1
  s_lshl_b32 s39, s39, 7
  s_add_u32 s3, s3, s39
  s_add_u32 s39, s3, 4096
  buffer_store_dwordx4 v[240:243], v44, s[20:23], s3 offen offset:0
  buffer_store_dwordx4 v[244:247], v44, s[20:23], s3 offen offset:2048
  buffer_store_dwordx4 v[248:251], v44, s[20:23], s39 offen offset:0
  buffer_store_dwordx4 v[252:255], v44, s[20:23], s39 offen offset:2048
  v_mul_f32 v45, v160, v192
  v_mul_f32 v46, v161, v193
  v_fmac_f32 v45, v162, v194
  v_fmac_f32 v46, v163, v195
  v_fmac_f32 v45, v164, v196
  v_fmac_f32 v46, v165, v197
  v_fmac_f32 v45, v166, v198
  v_fmac_f32 v46, v167, v199
  v_fmac_f32 v45, v168, v200
  v_fmac_f32 v46, v169, v201
  v_fmac_f32 v45, v170, v202
  v_fmac_f32 v46, v171, v203
  v_fmac_f32 v45, v172, v204
  v_fmac_f32 v46, v173, v205
  v_fmac_f32 v45, v174, v206
  v_fmac_f32 v46, v175, v207
  v_fmac_f32 v45, v176, v208
  v_fmac_f32 v46, v177, v209
  v_fmac_f32 v45, v178, v210
  v_fmac_f32 v46, v179, v211
  v_fmac_f32 v45, v180, v212
  v_fmac_f32 v46, v181, v213
  v_fmac_f32 v45, v182, v214
  v_fmac_f32 v46, v183, v215
  v_fmac_f32 v45, v184, v216
  v_fmac_f32 v46, v185, v217
  v_fmac_f32 v45, v186, v218
  v_fmac_f32 v46, v187, v219
  v_fmac_f32 v45, v188, v220
  v_fmac_f32 v46, v189, v221
  v_fmac_f32 v45, v190, v222
  v_fmac_f32 v46, v191, v223
  v_add_f32 v45, v45, v46
  s_nop 1
  v_add_f32_dpp v45, v45, v45 row_ror:8 row_mask:0xf bank_mask:0xf
  v_mov_b32 v37, v45
  s_nop 1
  v_permlane16_swap_b32 v37, v45
  v_add_f32 v45, v45, v37
  v_mov_b32 v37, v45
  s_nop 1
  v_permlane32_swap_b32 v37, v45
  v_add_f32 v45, v45, v37
  ds_write_b32 v35, v45 offset:256
  s_waitcnt lgkmcnt(0)
  s_barrier
  ds_read_b128 v[40:43], v34 offset:256
  s_waitcnt lgkmcnt(0)
  v_add_f32 v40, v40, v41
  v_add_f32 v42, v42, v43
  v_add_f32 v45, v40, v42
  v_cvt_pk_bf16_f32 v45, v45, v45
  v_ashrrev_i32 v46, 31, v45
  v_or_b32 v46, 0x80000000, v46
  v_xor_b32 v45, v45, v46
  v_and_b32 v45, 0xffff0000, v45
  s_lshl_b32 s3, s2, 3
  v_add_u32 v46, s3, v30
  v_sub_u32 v44, 0xffff, v46
  v_or_b32 v45, v45, v44
  v_lshlrev_b32 v44, 2, v46
  v_lshlrev_b32 v46, 3, v46
  s_mov_b32 s3, 4194304
  s_mov_b32 s39, 4210688
  s_cmp_lg_u32 s32, 0
  s_cbranch_scc1 L_k1_nokey
  s_mov_b64 exec, 0xff
  buffer_store_dword v45, v44, s[20:23], s3 offen
  buffer_store_dwordx2 v[38:39], v46, s[20:23], s39 offen
  s_mov_b64 exec, -1
L_k1_nokey:
  v_mov_b32 v160, 0
  v_mov_b32 v161, 0
  v_mov_b32 v162, 0
  v_mov_b32 v163, 0
  v_mov_b32 v164, 0
  v_mov_b32 v165, 0
  v_mov_b32 v166, 0
  v_mov_b32 v167, 0
  v_mov_b32 v168, 0
  v_mov_b32 v169, 0
  v_mov_b32 v170, 0
  v_mov_b32 v171, 0
  v_mov_b32 v172, 0
  v_mov_b32 v173, 0
  v_mov_b32 v174, 0
  v_mov_b32 v175, 0
  v_mov_b32 v176, 0
  v_mov_b32 v177, 0
  v_mov_b32 v178, 0
  v_mov_b32 v179, 0
  v_mov_b32 v180, 0
  v_mov_b32 v181, 0
  v_mov_b32 v182, 0
  v_mov_b32 v183, 0
  v_mov_b32 v184, 0
  v_mov_b32 v185, 0
  v_mov_b32 v186, 0
  v_mov_b32 v187, 0
  v_mov_b32 v188, 0
  v_mov_b32 v189, 0
  v_mov_b32 v190, 0
  v_mov_b32 v191, 0
  v_mov_b32 v192, 0
  v_mov_b32 v193, 0
  v_mov_b32 v194, 0
  v_mov_b32 v195, 0
  v_mov_b32 v196, 0
  v_mov_b32 v197, 0
  v_mov_b32 v198, 0
  v_mov_b32 v199, 0
  v_mov_b32 v200, 0
  v_mov_b32 v201, 0
  v_mov_b32 v202, 0
  v_mov_b32 v203, 0
  v_mov_b32 v204, 0
  v_mov_b32 v205, 0
  v_mov_b32 v206, 0
  v_mov_b32 v207, 0
  v_mov_b32 v208, 0
  v_mov_b32 v209, 0
  v_mov_b32 v210, 0
  v_mov_b32 v211, 0
  v_mov_b32 v212, 0
  v_mov_b32 v213, 0
  v_mov_b32 v214, 0
  v_mov_b32 v215, 0
  v_mov_b32 v216, 0
  v_mov_b32 v217, 0
  v_mov_b32 v218, 0
  v_mov_b32 v219, 0
  v_mov_b32 v220, 0
  v_mov_b32 v221, 0
  v_mov_b32 v222, 0
  v_mov_b32 v223, 0
  v_mov_b32 v224, 0
  v_mov_b32 v225, 0
  v_mov_b32 v226, 0
  v_mov_b32 v227, 0
  v_mov_b32 v228, 0
  v_mov_b32 v229, 0
  v_mov_b32 v230, 0
  v_mov_b32 v231, 0
  v_mov_b32 v232, 0
  v_mov_b32 v233, 0
  v_mov_b32 v234, 0
  v_mov_b32 v235, 0
  v_mov_b32 v236, 0
  v_mov_b32 v237, 0
  v_mov_b32 v238, 0
  v_mov_b32 v239, 0
  v_mov_b32 v240, 0
  v_mov_b32 v241, 0
  v_mov_b32 v242, 0
  v_mov_b32 v243, 0
  v_mov_b32 v244, 0
  v_mov_b32 v245, 0
  v_mov_b32 v246, 0
  v_mov_b32 v247, 0
  v_mov_b32 v248, 0
  v_mov_b32 v249, 0
  v_mov_b32 v250, 0
  v_mov_b32 v251, 0
  v_mov_b32 v252, 0
  v_mov_b32 v253, 0
  v_mov_b32 v254, 0
  v_mov_b32 v255, 0
  s_waitcnt vmcnt(22)
  s_barrier
  ds_read_b64_tr_b16 a[32:33], v12 offset:0
  ds_read_b64_tr_b16 a[34:35], v12 offset:2048
  ds_read_b128 a[0:3], v10 offset:0
  ds_read_b64_tr_b16 a[36:37], v13 offset:0
  ds_read_b64_tr_b16 a[38:39], v13 offset:2048
  ds_read_b128 a[4:7], v10 offset:2048
  ds_read_b64_tr_b16 a[40:41], v14 offset:0
  ds_read_b64_tr_b16 a[42:43], v14 offset:2048
  ds_read_b128 a[8:11], v10 offset:4096
  ds_read_b64_tr_b16 a[44:45], v15 offset:0
  ds_read_b64_tr_b16 a[46:47], v15 offset:2048
  ds_read_b128 a[12:15], v10 offset:6144
  s_waitcnt lgkmcnt(2)
  ds_read_b64_tr_b16 a[48:49], v16 offset:0
  ds_read_b64_tr_b16 a[50:51], v16 offset:2048
  ds_read_b128 a[16:19], v10 offset:8192
  ds_read_b64_tr_b16 a[52:53], v17 offset:0
  ds_read_b64_tr_b16 a[54:55], v17 offset:2048
  ds_read_b128 a[20:23], v10 offset:10240
  ds_read_b64_tr_b16 a[56:57], v18 offset:0
  ds_read_b64_tr_b16 a[58:59], v18 offset:2048
  ds_read_b128 a[24:27], v10 offset:12288
  ds_read_b64_tr_b16 a[60:61], v19 offset:0
  ds_read_b64_tr_b16 a[62:63], v19 offset:2048
  ds_read_b128 a[28:31], v10 offset:14336
  s_cmp_lg_u32 s35, 0
  s_cbranch_scc1 L_k1_vpath
  s_mov_b32 s58, 3
L_kv_kernel_loop1:
  s_waitcnt lgkmcnt(0)
  v_mfma_f32_16x16x32_bf16 v[48:51], a[32:35], a[0:3], v[48:51]
  v_mfma_f32_16x16x32_bf16 v[52:55], a[36:39], a[0:3], v[52:55]
  ds_read_b64_tr_b16 a[96:97], v12 offset:16384
  ds_read_b64_tr_b16 a[98:99], v12 offset:18432
  v_mfma_f32_16x16x32_bf16 v[56:59], a[40:43], a[0:3], v[56:59]
  v_mfma_f32_16x16x32_bf16 v[60:63], a[44:47], a[0:3], v[60:63]
  ds_read_b128 a[64:67], v11 offset:0
  v_mfma_f32_16x16x32_bf16 v[64:67], a[48:51], a[0:3], v[64:67]
  v_mfma_f32_16x16x32_bf16 v[68:71], a[52:55], a[0:3], v[68:71]
  ds_read_b64_tr_b16 a[100:101], v13 offset:16384
  ds_read_b64_tr_b16 a[102:103], v13 offset:18432
  v_mfma_f32_16x16x32_bf16 v[72:75], a[56:59], a[0:3], v[72:75]
  v_mfma_f32_16x16x32_bf16 v[76:79], a[60:63], a[0:3], v[76:79]
  s_waitcnt lgkmcnt(6)
  ds_read_b128 a[68:71], v11 offset:2048
  v_mfma_f32_16x16x32_bf16 v[80:83], a[32:35], a[4:7], v[80:83]
  v_mfma_f32_16x16x32_bf16 v[84:87], a[36:39], a[4:7], v[84:87]
  ds_read_b64_tr_b16 a[104:105], v14 offset:16384
  ds_read_b64_tr_b16 a[106:107], v14 offset:18432
  v_mfma_f32_16x16x32_bf16 v[88:91], a[40:43], a[4:7], v[88:91]
  v_mfma_f32_16x16x32_bf16 v[92:95], a[44:47], a[4:7], v[92:95]
  ds_read_b128 a[72:75], v11 offset:4096
  v_mfma_f32_16x16x32_bf16 v[96:99], a[48:51], a[4:7], v[96:99]
  v_mfma_f32_16x16x32_bf16 v[100:103], a[52:55], a[4:7], v[100:103]
  ds_read_b64_tr_b16 a[108:109], v15 offset:16384
  ds_read_b64_tr_b16 a[110:111], v15 offset:18432
  v_mfma_f32_16x16x32_bf16 v[104:107], a[56:59], a[4:7], v[104:107]
  v_mfma_f32_16x16x32_bf16 v[108:111], a[60:63], a[4:7], v[108:111]
  s_waitcnt lgkmcnt(6)
  ds_read_b128 a[76:79], v11 offset:6144
  v_mfma_f32_16x16x32_bf16 v[112:115], a[32:35], a[8:11], v[112:115]
  v_mfma_f32_16x16x32_bf16 v[116:119], a[36:39], a[8:11], v[116:119]
  ds_read_b64_tr_b16 a[112:113], v16 offset:16384
  ds_read_b64_tr_b16 a[114:115], v16 offset:18432
  v_mfma_f32_16x16x32_bf16 v[120:123], a[40:43], a[8:11], v[120:123]
  v_mfma_f32_16x16x32_bf16 v[124:127], a[44:47], a[8:11], v[124:127]
  ds_read_b128 a[80:83], v11 offset:8192
  v_mfma_f32_16x16x32_bf16 v[128:131], a[48:51], a[8:11], v[128:131]
  v_mfma_f32_16x16x32_bf16 v[132:135], a[52:55], a[8:11], v[132:135]
  ds_read_b64_tr_b16 a[116:117], v17 offset:16384
  ds_read_b64_tr_b16 a[118:119], v17 offset:18432
  v_mfma_f32_16x16x32_bf16 v[136:139], a[56:59], a[8:11], v[136:139]
  v_mfma_f32_16x16x32_bf16 v[140:143], a[60:63], a[8:11], v[140:143]
  s_waitcnt lgkmcnt(6)
  ds_read_b128 a[84:87], v11 offset:10240
  v_mfma_f32_16x16x32_bf16 v[144:147], a[32:35], a[12:15], v[144:147]
  v_mfma_f32_16x16x32_bf16 v[148:151], a[36:39], a[12:15], v[148:151]
  ds_read_b64_tr_b16 a[120:121], v18 offset:16384
  ds_read_b64_tr_b16 a[122:123], v18 offset:18432
  v_mfma_f32_16x16x32_bf16 v[152:155], a[40:43], a[12:15], v[152:155]
  v_mfma_f32_16x16x32_bf16 v[156:159], a[44:47], a[12:15], v[156:159]
  ds_read_b128 a[88:91], v11 offset:12288
  v_mfma_f32_16x16x32_bf16 v[160:163], a[48:51], a[12:15], v[160:163]
  v_mfma_f32_16x16x32_bf16 v[164:167], a[52:55], a[12:15], v[164:167]
  ds_read_b64_tr_b16 a[124:125], v19 offset:16384
  ds_read_b64_tr_b16 a[126:127], v19 offset:18432
  v_mfma_f32_16x16x32_bf16 v[168:171], a[56:59], a[12:15], v[168:171]
  v_mfma_f32_16x16x32_bf16 v[172:175], a[60:63], a[12:15], v[172:175]
  s_waitcnt lgkmcnt(6)
  ds_read_b128 a[92:95], v11 offset:14336
  v_mfma_f32_16x16x32_bf16 v[176:179], a[32:35], a[16:19], v[176:179]
  v_mfma_f32_16x16x32_bf16 v[180:183], a[36:39], a[16:19], v[180:183]
  v_mfma_f32_16x16x32_bf16 v[184:187], a[40:43], a[16:19], v[184:187]
  v_mfma_f32_16x16x32_bf16 v[188:191], a[44:47], a[16:19], v[188:191]
  v_mfma_f32_16x16x32_bf16 v[192:195], a[48:51], a[16:19], v[192:195]
  v_mfma_f32_16x16x32_bf16 v[196:199], a[52:55], a[16:19], v[196:199]
  v_mfma_f32_16x16x32_bf16 v[200:203], a[56:59], a[16:19], v[200:203]
  v_mfma_f32_16x16x32_bf16 v[204:207], a[60:63], a[16:19], v[204:207]
  v_mfma_f32_16x16x32_bf16 v[208:211], a[32:35], a[20:23], v[208:211]
  v_mfma_f32_16x16x32_bf16 v[212:215], a[36:39], a[20:23], v[212:215]
  v_mfma_f32_16x16x32_bf16 v[216:219], a[40:43], a[20:23], v[216:219]
  v_mfma_f32_16x16x32_bf16 v[220:223], a[44:47], a[20:23], v[220:223]
  v_mfma_f32_16x16x32_bf16 v[224:227], a[48:51], a[20:23], v[224:227]
  v_mfma_f32_16x16x32_bf16 v[228:231], a[52:55], a[20:23], v[228:231]
  v_mfma_f32_16x16x32_bf16 v[232:235], a[56:59], a[20:23], v[232:235]
  v_mfma_f32_16x16x32_bf16 v[236:239], a[60:63], a[20:23], v[236:239]
  v_mfma_f32_16x16x32_bf16 v[240:243], a[32:35], a[24:27], v[240:243]
  v_mfma_f32_16x16x32_bf16 v[244:247], a[36:39], a[24:27], v[244:247]
  v_mfma_f32_16x16x32_bf16 v[248:251], a[40:43], a[24:27], v[248:251]
  v_mfma_f32_16x16x32_bf16 v[252:255], a[44:47], a[24:27], v[252:255]
  v_mfma_f32_16x16x32_bf16 a[128:131], a[48:51], a[24:27], a[128:131]
  v_mfma_f32_16x16x32_bf16 a[132:135], a[52:55], a[24:27], a[132:135]
  v_mfma_f32_16x16x32_bf16 a[136:139], a[56:59], a[24:27], a[136:139]
  v_mfma_f32_16x16x32_bf16 a[140:143], a[60:63], a[24:27], a[140:143]
  v_mfma_f32_16x16x32_bf16 a[144:147], a[32:35], a[28:31], a[144:147]
  v_mfma_f32_16x16x32_bf16 a[148:151], a[36:39], a[28:31], a[148:151]
  v_mfma_f32_16x16x32_bf16 a[152:155], a[40:43], a[28:31], a[152:155]
  v_mfma_f32_16x16x32_bf16 a[156:159], a[44:47], a[28:31], a[156:159]
  v_mfma_f32_16x16x32_bf16 a[160:163], a[48:51], a[28:31], a[160:163]
  v_mfma_f32_16x16x32_bf16 a[164:167], a[52:55], a[28:31], a[164:167]
  v_mfma_f32_16x16x32_bf16 a[168:171], a[56:59], a[28:31], a[168:171]
  v_mfma_f32_16x16x32_bf16 a[172:175], a[60:63], a[28:31], a[172:175]
  s_waitcnt vmcnt(1) lgkmcnt(0)
  s_add_u32 m0, s57, 0
  s_barrier
  v_mfma_f32_16x16x32_bf16 v[48:51], a[96:99], a[64:67], v[48:51]
  buffer_load_dwordx4 v6, s[12:15], s52 offen offset:0 nt lds
  v_mfma_f32_16x16x32_bf16 v[52:55], a[100:103], a[64:67], v[52:55]
  ds_read_b64_tr_b16 a[32:33], v22 offset:0
  ds_read_b64_tr_b16 a[34:35], v22 offset:2048
  v_mfma_f32_16x16x32_bf16 v[56:59], a[104:107], a[64:67], v[56:59]
  v_mfma_f32_16x16x32_bf16 v[60:63], a[108:111], a[64:67], v[60:63]
  ds_read_b128 a[0:3], v20 offset:0
  v_mfma_f32_16x16x32_bf16 v[64:67], a[112:115], a[64:67], v[64:67]
  buffer_load_dwordx4 v7, s[12:15], s53 offen offset:1024 nt lds
  v_mfma_f32_16x16x32_bf16 v[68:71], a[116:119], a[64:67], v[68:71]
  s_waitcnt lgkmcnt(6)
  ds_read_b64_tr_b16 a[36:37], v23 offset:0
  ds_read_b64_tr_b16 a[38:39], v23 offset:2048
  v_mfma_f32_16x16x32_bf16 v[72:75], a[120:123], a[64:67], v[72:75]
  v_mfma_f32_16x16x32_bf16 v[76:79], a[124:127], a[64:67], v[76:79]
  ds_read_b128 a[4:7], v20 offset:2048
  v_mfma_f32_16x16x32_bf16 v[80:83], a[96:99], a[68:71], v[80:83]
  buffer_load_dwordx4 v6, s[12:15], s54 offen offset:2048 nt lds
  v_mfma_f32_16x16x32_bf16 v[84:87], a[100:103], a[68:71], v[84:87]
  ds_read_b64_tr_b16 a[40:41], v24 offset:0
  ds_read_b64_tr_b16 a[42:43], v24 offset:2048
  v_mfma_f32_16x16x32_bf16 v[88:91], a[104:107], a[68:71], v[88:91]
  v_mfma_f32_16x16x32_bf16 v[92:95], a[108:111], a[68:71], v[92:95]
  ds_read_b128 a[8:11], v20 offset:4096
  v_mfma_f32_16x16x32_bf16 v[96:99], a[112:115], a[68:71], v[96:99]
  buffer_load_dwordx4 v7, s[12:15], s55 offen offset:3072 nt lds
  v_mfma_f32_16x16x32_bf16 v[100:103], a[116:119], a[68:71], v[100:103]
  s_waitcnt lgkmcnt(6)
  ds_read_b64_tr_b16 a[44:45], v25 offset:0
  ds_read_b64_tr_b16 a[46:47], v25 offset:2048
  v_mfma_f32_16x16x32_bf16 v[104:107], a[120:123], a[68:71], v[104:107]
  v_mfma_f32_16x16x32_bf16 v[108:111], a[124:127], a[68:71], v[108:111]
  s_add_u32 m0, s57, 4096
  ds_read_b128 a[12:15], v20 offset:6144
  v_mfma_f32_16x16x32_bf16 v[112:115], a[96:99], a[72:75], v[112:115]
  buffer_load_dwordx4 v8, s[12:15], s52 offen offset:0 nt lds
  v_mfma_f32_16x16x32_bf16 v[116:119], a[100:103], a[72:75], v[116:119]
  ds_read_b64_tr_b16 a[48:49], v26 offset:0
  ds_read_b64_tr_b16 a[50:51], v26 offset:2048
  v_mfma_f32_16x16x32_bf16 v[120:123], a[104:107], a[72:75], v[120:123]
  v_mfma_f32_16x16x32_bf16 v[124:127], a[108:111], a[72:75], v[124:127]
  ds_read_b128 a[16:19], v20 offset:8192
  v_mfma_f32_16x16x32_bf16 v[128:131], a[112:115], a[72:75], v[128:131]
  buffer_load_dwordx4 v9, s[12:15], s53 offen offset:1024 nt lds
  v_mfma_f32_16x16x32_bf16 v[132:135], a[116:119], a[72:75], v[132:135]
  s_waitcnt lgkmcnt(6)
  ds_read_b64_tr_b16 a[52:53], v27 offset:0
  ds_read_b64_tr_b16 a[54:55], v27 offset:2048
  v_mfma_f32_16x16x32_bf16 v[136:139], a[120:123], a[72:75], v[136:139]
  v_mfma_f32_16x16x32_bf16 v[140:143], a[124:127], a[72:75], v[140:143]
  ds_read_b128 a[20:23], v20 offset:10240
  v_mfma_f32_16x16x32_bf16 v[144:147], a[96:99], a[76:79], v[144:147]
  buffer_load_dwordx4 v8, s[12:15], s54 offen offset:2048 nt lds
  v_mfma_f32_16x16x32_bf16 v[148:151], a[100:103], a[76:79], v[148:151]
  ds_read_b64_tr_b16 a[56:57], v28 offset:0
  ds_read_b64_tr_b16 a[58:59], v28 offset:2048
  v_mfma_f32_16x16x32_bf16 v[152:155], a[104:107], a[76:79], v[152:155]
  v_mfma_f32_16x16x32_bf16 v[156:159], a[108:111], a[76:79], v[156:159]
  ds_read_b128 a[24:27], v20 offset:12288
  v_mfma_f32_16x16x32_bf16 v[160:163], a[112:115], a[76:79], v[160:163]
  buffer_load_dwordx4 v9, s[12:15], s55 offen offset:3072 nt lds
  v_mfma_f32_16x16x32_bf16 v[164:167], a[116:119], a[76:79], v[164:167]
  s_waitcnt lgkmcnt(6)
  ds_read_b64_tr_b16 a[60:61], v29 offset:0
  ds_read_b64_tr_b16 a[62:63], v29 offset:2048
  v_mfma_f32_16x16x32_bf16 v[168:171], a[120:123], a[76:79], v[168:171]
  v_add_u32 v6, 524288, v6
  v_add_u32 v7, 524288, v7
  v_mfma_f32_16x16x32_bf16 v[172:175], a[124:127], a[76:79], v[172:175]
  s_add_u32 m0, s56, 0
  ds_read_b128 a[28:31], v20 offset:14336
  v_mfma_f32_16x16x32_bf16 v[176:179], a[96:99], a[80:83], v[176:179]
  buffer_load_dwordx4 v2, s[8:11], s48 offen offset:0 lds
  v_mfma_f32_16x16x32_bf16 v[180:183], a[100:103], a[80:83], v[180:183]
  v_add_u32 v8, 524288, v8
  v_add_u32 v9, 524288, v9
  v_mfma_f32_16x16x32_bf16 v[184:187], a[104:107], a[80:83], v[184:187]
  v_mfma_f32_16x16x32_bf16 v[188:191], a[108:111], a[80:83], v[188:191]
  v_mfma_f32_16x16x32_bf16 v[192:195], a[112:115], a[80:83], v[192:195]
  buffer_load_dwordx4 v3, s[8:11], s49 offen offset:1024 lds
  v_mfma_f32_16x16x32_bf16 v[196:199], a[116:119], a[80:83], v[196:199]
  v_mfma_f32_16x16x32_bf16 v[200:203], a[120:123], a[80:83], v[200:203]
  v_mfma_f32_16x16x32_bf16 v[204:207], a[124:127], a[80:83], v[204:207]
  v_mfma_f32_16x16x32_bf16 v[208:211], a[96:99], a[84:87], v[208:211]
  buffer_load_dwordx4 v2, s[8:11], s50 offen offset:2048 lds
  v_mfma_f32_16x16x32_bf16 v[212:215], a[100:103], a[84:87], v[212:215]
  v_mfma_f32_16x16x32_bf16 v[216:219], a[104:107], a[84:87], v[216:219]
  v_mfma_f32_16x16x32_bf16 v[220:223], a[108:111], a[84:87], v[220:223]
  v_mfma_f32_16x16x32_bf16 v[224:227], a[112:115], a[84:87], v[224:227]
  buffer_load_dwordx4 v3, s[8:11], s51 offen offset:3072 lds
  v_mfma_f32_16x16x32_bf16 v[228:231], a[116:119], a[84:87], v[228:231]
  v_mfma_f32_16x16x32_bf16 v[232:235], a[120:123], a[84:87], v[232:235]
  v_mfma_f32_16x16x32_bf16 v[236:239], a[124:127], a[84:87], v[236:239]
  s_add_u32 m0, s56, 4096
  v_mfma_f32_16x16x32_bf16 v[240:243], a[96:99], a[88:91], v[240:243]
  buffer_load_dwordx4 v4, s[8:11], s48 offen offset:0 lds
  v_mfma_f32_16x16x32_bf16 v[244:247], a[100:103], a[88:91], v[244:247]
  v_mfma_f32_16x16x32_bf16 v[248:251], a[104:107], a[88:91], v[248:251]
  v_mfma_f32_16x16x32_bf16 v[252:255], a[108:111], a[88:91], v[252:255]
  v_mfma_f32_16x16x32_bf16 a[128:131], a[112:115], a[88:91], a[128:131]
  buffer_load_dwordx4 v5, s[8:11], s49 offen offset:1024 lds
  v_mfma_f32_16x16x32_bf16 a[132:135], a[116:119], a[88:91], a[132:135]
  v_mfma_f32_16x16x32_bf16 a[136:139], a[120:123], a[88:91], a[136:139]
  v_mfma_f32_16x16x32_bf16 a[140:143], a[124:127], a[88:91], a[140:143]
  v_mfma_f32_16x16x32_bf16 a[144:147], a[96:99], a[92:95], a[144:147]
  buffer_load_dwordx4 v4, s[8:11], s50 offen offset:2048 lds
  v_mfma_f32_16x16x32_bf16 a[148:151], a[100:103], a[92:95], a[148:151]
  v_mfma_f32_16x16x32_bf16 a[152:155], a[104:107], a[92:95], a[152:155]
  v_mfma_f32_16x16x32_bf16 a[156:159], a[108:111], a[92:95], a[156:159]
  v_mfma_f32_16x16x32_bf16 a[160:163], a[112:115], a[92:95], a[160:163]
  buffer_load_dwordx4 v5, s[8:11], s51 offen offset:3072 lds
  v_mfma_f32_16x16x32_bf16 a[164:167], a[116:119], a[92:95], a[164:167]
  v_mfma_f32_16x16x32_bf16 a[168:171], a[120:123], a[92:95], a[168:171]
  buffer_load_dword v1, v47, s[60:63], 0 offen
  v_mfma_f32_16x16x32_bf16 a[172:175], a[124:127], a[92:95], a[172:175]
  v_add_u32 v2, 128, v2
  v_add_u32 v3, 128, v3
  v_add_u32 v4, 128, v4
  v_add_u32 v5, 128, v5
  v_add_u32 v47, s59, v47
  s_waitcnt lgkmcnt(0)
  v_mfma_f32_16x16x32_bf16 v[48:51], a[32:35], a[0:3], v[48:51]
  v_mfma_f32_16x16x32_bf16 v[52:55], a[36:39], a[0:3], v[52:55]
  ds_read_b64_tr_b16 a[96:97], v22 offset:16384
  ds_read_b64_tr_b16 a[98:99], v22 offset:18432
  v_mfma_f32_16x16x32_bf16 v[56:59], a[40:43], a[0:3], v[56:59]
  v_mfma_f32_16x16x32_bf16 v[60:63], a[44:47], a[0:3], v[60:63]
  ds_read_b128 a[64:67], v21 offset:0
  v_mfma_f32_16x16x32_bf16 v[64:67], a[48:51], a[0:3], v[64:67]
  v_mfma_f32_16x16x32_bf16 v[68:71], a[52:55], a[0:3], v[68:71]
  ds_read_b64_tr_b16 a[100:101], v23 offset:16384
  ds_read_b64_tr_b16 a[102:103], v23 offset:18432
  v_mfma_f32_16x16x32_bf16 v[72:75], a[56:59], a[0:3], v[72:75]
  v_mfma_f32_16x16x32_bf16 v[76:79], a[60:63], a[0:3], v[76:79]
  s_waitcnt lgkmcnt(6)
  ds_read_b128 a[68:71], v21 offset:2048
  v_mfma_f32_16x16x32_bf16 v[80:83], a[32:35], a[4:7], v[80:83]
  v_mfma_f32_16x16x32_bf16 v[84:87], a[36:39], a[4:7], v[84:87]
  ds_read_b64_tr_b16 a[104:105], v24 offset:16384
  ds_read_b64_tr_b16 a[106:107], v24 offset:18432
  v_mfma_f32_16x16x32_bf16 v[88:91], a[40:43], a[4:7], v[88:91]
  v_mfma_f32_16x16x32_bf16 v[92:95], a[44:47], a[4:7], v[92:95]
  ds_read_b128 a[72:75], v21 offset:4096
  v_mfma_f32_16x16x32_bf16 v[96:99], a[48:51], a[4:7], v[96:99]
  v_mfma_f32_16x16x32_bf16 v[100:103], a[52:55], a[4:7], v[100:103]
  ds_read_b64_tr_b16 a[108:109], v25 offset:16384
  ds_read_b64_tr_b16 a[110:111], v25 offset:18432
  v_mfma_f32_16x16x32_bf16 v[104:107], a[56:59], a[4:7], v[104:107]
  v_mfma_f32_16x16x32_bf16 v[108:111], a[60:63], a[4:7], v[108:111]
  s_waitcnt lgkmcnt(6)
  ds_read_b128 a[76:79], v21 offset:6144
  v_mfma_f32_16x16x32_bf16 v[112:115], a[32:35], a[8:11], v[112:115]
  v_mfma_f32_16x16x32_bf16 v[116:119], a[36:39], a[8:11], v[116:119]
  ds_read_b64_tr_b16 a[112:113], v26 offset:16384
  ds_read_b64_tr_b16 a[114:115], v26 offset:18432
  v_mfma_f32_16x16x32_bf16 v[120:123], a[40:43], a[8:11], v[120:123]
  v_mfma_f32_16x16x32_bf16 v[124:127], a[44:47], a[8:11], v[124:127]
  ds_read_b128 a[80:83], v21 offset:8192
  v_mfma_f32_16x16x32_bf16 v[128:131], a[48:51], a[8:11], v[128:131]
  v_mfma_f32_16x16x32_bf16 v[132:135], a[52:55], a[8:11], v[132:135]
  ds_read_b64_tr_b16 a[116:117], v27 offset:16384
  ds_read_b64_tr_b16 a[118:119], v27 offset:18432
  v_mfma_f32_16x16x32_bf16 v[136:139], a[56:59], a[8:11], v[136:139]
  v_mfma_f32_16x16x32_bf16 v[140:143], a[60:63], a[8:11], v[140:143]
  s_waitcnt lgkmcnt(6)
  ds_read_b128 a[84:87], v21 offset:10240
  v_mfma_f32_16x16x32_bf16 v[144:147], a[32:35], a[12:15], v[144:147]
  v_mfma_f32_16x16x32_bf16 v[148:151], a[36:39], a[12:15], v[148:151]
  ds_read_b64_tr_b16 a[120:121], v28 offset:16384
  ds_read_b64_tr_b16 a[122:123], v28 offset:18432
  v_mfma_f32_16x16x32_bf16 v[152:155], a[40:43], a[12:15], v[152:155]
  v_mfma_f32_16x16x32_bf16 v[156:159], a[44:47], a[12:15], v[156:159]
  ds_read_b128 a[88:91], v21 offset:12288
  v_mfma_f32_16x16x32_bf16 v[160:163], a[48:51], a[12:15], v[160:163]
  v_mfma_f32_16x16x32_bf16 v[164:167], a[52:55], a[12:15], v[164:167]
  ds_read_b64_tr_b16 a[124:125], v29 offset:16384
  ds_read_b64_tr_b16 a[126:127], v29 offset:18432
  v_mfma_f32_16x16x32_bf16 v[168:171], a[56:59], a[12:15], v[168:171]
  v_mfma_f32_16x16x32_bf16 v[172:175], a[60:63], a[12:15], v[172:175]
  s_waitcnt lgkmcnt(6)
  ds_read_b128 a[92:95], v21 offset:14336
  v_mfma_f32_16x16x32_bf16 v[176:179], a[32:35], a[16:19], v[176:179]
  v_mfma_f32_16x16x32_bf16 v[180:183], a[36:39], a[16:19], v[180:183]
  v_mfma_f32_16x16x32_bf16 v[184:187], a[40:43], a[16:19], v[184:187]
  v_mfma_f32_16x16x32_bf16 v[188:191], a[44:47], a[16:19], v[188:191]
  v_mfma_f32_16x16x32_bf16 v[192:195], a[48:51], a[16:19], v[192:195]
  v_mfma_f32_16x16x32_bf16 v[196:199], a[52:55], a[16:19], v[196:199]
  v_mfma_f32_16x16x32_bf16 v[200:203], a[56:59], a[16:19], v[200:203]
  v_mfma_f32_16x16x32_bf16 v[204:207], a[60:63], a[16:19], v[204:207]
  v_mfma_f32_16x16x32_bf16 v[208:211], a[32:35], a[20:23], v[208:211]
  v_mfma_f32_16x16x32_bf16 v[212:215], a[36:39], a[20:23], v[212:215]
  v_mfma_f32_16x16x32_bf16 v[216:219], a[40:43], a[20:23], v[216:219]
  v_mfma_f32_16x16x32_bf16 v[220:223], a[44:47], a[20:23], v[220:223]
  v_mfma_f32_16x16x32_bf16 v[224:227], a[48:51], a[20:23], v[224:227]
  v_mfma_f32_16x16x32_bf16 v[228:231], a[52:55], a[20:23], v[228:231]
  v_mfma_f32_16x16x32_bf16 v[232:235], a[56:59], a[20:23], v[232:235]
  v_mfma_f32_16x16x32_bf16 v[236:239], a[60:63], a[20:23], v[236:239]
  v_mfma_f32_16x16x32_bf16 v[240:243], a[32:35], a[24:27], v[240:243]
  v_mfma_f32_16x16x32_bf16 v[244:247], a[36:39], a[24:27], v[244:247]
  v_mfma_f32_16x16x32_bf16 v[248:251], a[40:43], a[24:27], v[248:251]
  v_mfma_f32_16x16x32_bf16 v[252:255], a[44:47], a[24:27], v[252:255]
  v_mfma_f32_16x16x32_bf16 a[128:131], a[48:51], a[24:27], a[128:131]
  v_mfma_f32_16x16x32_bf16 a[132:135], a[52:55], a[24:27], a[132:135]
  v_mfma_f32_16x16x32_bf16 a[136:139], a[56:59], a[24:27], a[136:139]
  v_mfma_f32_16x16x32_bf16 a[140:143], a[60:63], a[24:27], a[140:143]
  v_mfma_f32_16x16x32_bf16 a[144:147], a[32:35], a[28:31], a[144:147]
  v_mfma_f32_16x16x32_bf16 a[148:151], a[36:39], a[28:31], a[148:151]
  v_mfma_f32_16x16x32_bf16 a[152:155], a[40:43], a[28:31], a[152:155]
  v_mfma_f32_16x16x32_bf16 a[156:159], a[44:47], a[28:31], a[156:159]
  v_mfma_f32_16x16x32_bf16 a[160:163], a[48:51], a[28:31], a[160:163]
  v_mfma_f32_16x16x32_bf16 a[164:167], a[52:55], a[28:31], a[164:167]
  v_mfma_f32_16x16x32_bf16 a[168:171], a[56:59], a[28:31], a[168:171]
  v_mfma_f32_16x16x32_bf16 a[172:175], a[60:63], a[28:31], a[172:175]
  s_waitcnt vmcnt(1) lgkmcnt(0)
  s_add_u32 m0, s57, 65536
  s_barrier
  v_mfma_f32_16x16x32_bf16 v[48:51], a[96:99], a[64:67], v[48:51]
  buffer_load_dwordx4 v6, s[12:15], s52 offen offset:0 nt lds
  v_mfma_f32_16x16x32_bf16 v[52:55], a[100:103], a[64:67], v[52:55]
  ds_read_b64_tr_b16 a[32:33], v12 offset:0
  ds_read_b64_tr_b16 a[34:35], v12 offset:2048
  v_mfma_f32_16x16x32_bf16 v[56:59], a[104:107], a[64:67], v[56:59]
  v_mfma_f32_16x16x32_bf16 v[60:63], a[108:111], a[64:67], v[60:63]
  ds_read_b128 a[0:3], v10 offset:0
  v_mfma_f32_16x16x32_bf16 v[64:67], a[112:115], a[64:67], v[64:67]
  buffer_load_dwordx4 v7, s[12:15], s53 offen offset:1024 nt lds
  v_mfma_f32_16x16x32_bf16 v[68:71], a[116:119], a[64:67], v[68:71]
  s_waitcnt lgkmcnt(6)
  ds_read_b64_tr_b16 a[36:37], v13 offset:0
  ds_read_b64_tr_b16 a[38:39], v13 offset:2048
  v_mfma_f32_16x16x32_bf16 v[72:75], a[120:123], a[64:67], v[72:75]
  v_mfma_f32_16x16x32_bf16 v[76:79], a[124:127], a[64:67], v[76:79]
  ds_read_b128 a[4:7], v10 offset:2048
  v_mfma_f32_16x16x32_bf16 v[80:83], a[96:99], a[68:71], v[80:83]
  buffer_load_dwordx4 v6, s[12:15], s54 offen offset:2048 nt lds
  v_mfma_f32_16x16x32_bf16 v[84:87], a[100:103], a[68:71], v[84:87]
  ds_read_b64_tr_b16 a[40:41], v14 offset:0
  ds_read_b64_tr_b16 a[42:43], v14 offset:2048
  v_mfma_f32_16x16x32_bf16 v[88:91], a[104:107], a[68:71], v[88:91]
  v_mfma_f32_16x16x32_bf16 v[92:95], a[108:111], a[68:71], v[92:95]
  ds_read_b128 a[8:11], v10 offset:4096
  v_mfma_f32_16x16x32_bf16 v[96:99], a[112:115], a[68:71], v[96:99]
  buffer_load_dwordx4 v7, s[12:15], s55 offen offset:3072 nt lds
  v_mfma_f32_16x16x32_bf16 v[100:103], a[116:119], a[68:71], v[100:103]
  s_waitcnt lgkmcnt(6)
  ds_read_b64_tr_b16 a[44:45], v15 offset:0
  ds_read_b64_tr_b16 a[46:47], v15 offset:2048
  v_mfma_f32_16x16x32_bf16 v[104:107], a[120:123], a[68:71], v[104:107]
  v_mfma_f32_16x16x32_bf16 v[108:111], a[124:127], a[68:71], v[108:111]
  s_add_u32 m0, s57, 69632
  ds_read_b128 a[12:15], v10 offset:6144
  v_mfma_f32_16x16x32_bf16 v[112:115], a[96:99], a[72:75], v[112:115]
  buffer_load_dwordx4 v8, s[12:15], s52 offen offset:0 nt lds
  v_mfma_f32_16x16x32_bf16 v[116:119], a[100:103], a[72:75], v[116:119]
  ds_read_b64_tr_b16 a[48:49], v16 offset:0
  ds_read_b64_tr_b16 a[50:51], v16 offset:2048
  v_mfma_f32_16x16x32_bf16 v[120:123], a[104:107], a[72:75], v[120:123]
  v_mfma_f32_16x16x32_bf16 v[124:127], a[108:111], a[72:75], v[124:127]
  ds_read_b128 a[16:19], v10 offset:8192
  v_mfma_f32_16x16x32_bf16 v[128:131], a[112:115], a[72:75], v[128:131]
  buffer_load_dwordx4 v9, s[12:15], s53 offen offset:1024 nt lds
  v_mfma_f32_16x16x32_bf16 v[132:135], a[116:119], a[72:75], v[132:135]
  s_waitcnt lgkmcnt(6)
  ds_read_b64_tr_b16 a[52:53], v17 offset:0
  ds_read_b64_tr_b16 a[54:55], v17 offset:2048
  v_mfma_f32_16x16x32_bf16 v[136:139], a[120:123], a[72:75], v[136:139]
  v_mfma_f32_16x16x32_bf16 v[140:143], a[124:127], a[72:75], v[140:143]
  ds_read_b128 a[20:23], v10 offset:10240
  v_mfma_f32_16x16x32_bf16 v[144:147], a[96:99], a[76:79], v[144:147]
  buffer_load_dwordx4 v8, s[12:15], s54 offen offset:2048 nt lds
  v_mfma_f32_16x16x32_bf16 v[148:151], a[100:103], a[76:79], v[148:151]
  ds_read_b64_tr_b16 a[56:57], v18 offset:0
  ds_read_b64_tr_b16 a[58:59], v18 offset:2048
  v_mfma_f32_16x16x32_bf16 v[152:155], a[104:107], a[76:79], v[152:155]
  v_mfma_f32_16x16x32_bf16 v[156:159], a[108:111], a[76:79], v[156:159]
  ds_read_b128 a[24:27], v10 offset:12288
  v_mfma_f32_16x16x32_bf16 v[160:163], a[112:115], a[76:79], v[160:163]
  buffer_load_dwordx4 v9, s[12:15], s55 offen offset:3072 nt lds
  v_mfma_f32_16x16x32_bf16 v[164:167], a[116:119], a[76:79], v[164:167]
  s_waitcnt lgkmcnt(6)
  ds_read_b64_tr_b16 a[60:61], v19 offset:0
  ds_read_b64_tr_b16 a[62:63], v19 offset:2048
  v_mfma_f32_16x16x32_bf16 v[168:171], a[120:123], a[76:79], v[168:171]
  v_add_u32 v6, 524288, v6
  v_add_u32 v7, 524288, v7
  v_mfma_f32_16x16x32_bf16 v[172:175], a[124:127], a[76:79], v[172:175]
  s_add_u32 m0, s56, 65536
  ds_read_b128 a[28:31], v10 offset:14336
  v_mfma_f32_16x16x32_bf16 v[176:179], a[96:99], a[80:83], v[176:179]
  buffer_load_dwordx4 v2, s[8:11], s48 offen offset:0 lds
  v_mfma_f32_16x16x32_bf16 v[180:183], a[100:103], a[80:83], v[180:183]
  v_add_u32 v8, 524288, v8
  v_add_u32 v9, 524288, v9
  v_mfma_f32_16x16x32_bf16 v[184:187], a[104:107], a[80:83], v[184:187]
  v_mfma_f32_16x16x32_bf16 v[188:191], a[108:111], a[80:83], v[188:191]
  v_mfma_f32_16x16x32_bf16 v[192:195], a[112:115], a[80:83], v[192:195]
  buffer_load_dwordx4 v3, s[8:11], s49 offen offset:1024 lds
  v_mfma_f32_16x16x32_bf16 v[196:199], a[116:119], a[80:83], v[196:199]
  v_mfma_f32_16x16x32_bf16 v[200:203], a[120:123], a[80:83], v[200:203]
  v_mfma_f32_16x16x32_bf16 v[204:207], a[124:127], a[80:83], v[204:207]
  v_mfma_f32_16x16x32_bf16 v[208:211], a[96:99], a[84:87], v[208:211]
  buffer_load_dwordx4 v2, s[8:11], s50 offen offset:2048 lds
  v_mfma_f32_16x16x32_bf16 v[212:215], a[100:103], a[84:87], v[212:215]
  v_mfma_f32_16x16x32_bf16 v[216:219], a[104:107], a[84:87], v[216:219]
  v_mfma_f32_16x16x32_bf16 v[220:223], a[108:111], a[84:87], v[220:223]
  v_mfma_f32_16x16x32_bf16 v[224:227], a[112:115], a[84:87], v[224:227]
  buffer_load_dwordx4 v3, s[8:11], s51 offen offset:3072 lds
  v_mfma_f32_16x16x32_bf16 v[228:231], a[116:119], a[84:87], v[228:231]
  v_mfma_f32_16x16x32_bf16 v[232:235], a[120:123], a[84:87], v[232:235]
  v_mfma_f32_16x16x32_bf16 v[236:239], a[124:127], a[84:87], v[236:239]
  s_add_u32 m0, s56, 69632
  v_mfma_f32_16x16x32_bf16 v[240:243], a[96:99], a[88:91], v[240:243]
  buffer_load_dwordx4 v4, s[8:11], s48 offen offset:0 lds
  v_mfma_f32_16x16x32_bf16 v[244:247], a[100:103], a[88:91], v[244:247]
  v_mfma_f32_16x16x32_bf16 v[248:251], a[104:107], a[88:91], v[248:251]
  v_mfma_f32_16x16x32_bf16 v[252:255], a[108:111], a[88:91], v[252:255]
  v_mfma_f32_16x16x32_bf16 a[128:131], a[112:115], a[88:91], a[128:131]
  buffer_load_dwordx4 v5, s[8:11], s49 offen offset:1024 lds
  v_mfma_f32_16x16x32_bf16 a[132:135], a[116:119], a[88:91], a[132:135]
  v_mfma_f32_16x16x32_bf16 a[136:139], a[120:123], a[88:91], a[136:139]
  v_mfma_f32_16x16x32_bf16 a[140:143], a[124:127], a[88:91], a[140:143]
  v_mfma_f32_16x16x32_bf16 a[144:147], a[96:99], a[92:95], a[144:147]
  buffer_load_dwordx4 v4, s[8:11], s50 offen offset:2048 lds
  v_mfma_f32_16x16x32_bf16 a[148:151], a[100:103], a[92:95], a[148:151]
  v_mfma_f32_16x16x32_bf16 a[152:155], a[104:107], a[92:95], a[152:155]
  v_mfma_f32_16x16x32_bf16 a[156:159], a[108:111], a[92:95], a[156:159]
  v_mfma_f32_16x16x32_bf16 a[160:163], a[112:115], a[92:95], a[160:163]
  buffer_load_dwordx4 v5, s[8:11], s51 offen offset:3072 lds
  v_mfma_f32_16x16x32_bf16 a[164:167], a[116:119], a[92:95], a[164:167]
  v_mfma_f32_16x16x32_bf16 a[168:171], a[120:123], a[92:95], a[168:171]
  buffer_load_dword v1, v47, s[60:63], 0 offen
  v_mfma_f32_16x16x32_bf16 a[172:175], a[124:127], a[92:95], a[172:175]
  v_add_u32 v2, 128, v2
  v_add_u32 v3, 128, v3
  v_add_u32 v4, 128, v4
  v_add_u32 v5, 128, v5
  v_add_u32 v47, s59, v47
  s_sub_u32 s58, s58, 1
  s_cmp_lg_u32 s58, 0
  s_cbranch_scc1 L_kv_kernel_loop1
  s_waitcnt lgkmcnt(0)
  v_mfma_f32_16x16x32_bf16 v[48:51], a[32:35], a[0:3], v[48:51]
  v_mfma_f32_16x16x32_bf16 v[52:55], a[36:39], a[0:3], v[52:55]
  ds_read_b64_tr_b16 a[96:97], v12 offset:16384
  ds_read_b64_tr_b16 a[98:99], v12 offset:18432
  v_mfma_f32_16x16x32_bf16 v[56:59], a[40:43], a[0:3], v[56:59]
  v_mfma_f32_16x16x32_bf16 v[60:63], a[44:47], a[0:3], v[60:63]
  ds_read_b128 a[64:67], v11 offset:0
  v_mfma_f32_16x16x32_bf16 v[64:67], a[48:51], a[0:3], v[64:67]
  v_mfma_f32_16x16x32_bf16 v[68:71], a[52:55], a[0:3], v[68:71]
  ds_read_b64_tr_b16 a[100:101], v13 offset:16384
  ds_read_b64_tr_b16 a[102:103], v13 offset:18432
  v_mfma_f32_16x16x32_bf16 v[72:75], a[56:59], a[0:3], v[72:75]
  v_mfma_f32_16x16x32_bf16 v[76:79], a[60:63], a[0:3], v[76:79]
  s_waitcnt lgkmcnt(6)
  ds_read_b128 a[68:71], v11 offset:2048
  v_mfma_f32_16x16x32_bf16 v[80:83], a[32:35], a[4:7], v[80:83]
  v_mfma_f32_16x16x32_bf16 v[84:87], a[36:39], a[4:7], v[84:87]
  ds_read_b64_tr_b16 a[104:105], v14 offset:16384
  ds_read_b64_tr_b16 a[106:107], v14 offset:18432
  v_mfma_f32_16x16x32_bf16 v[88:91], a[40:43], a[4:7], v[88:91]
  v_mfma_f32_16x16x32_bf16 v[92:95], a[44:47], a[4:7], v[92:95]
  ds_read_b128 a[72:75], v11 offset:4096
  v_mfma_f32_16x16x32_bf16 v[96:99], a[48:51], a[4:7], v[96:99]
  v_mfma_f32_16x16x32_bf16 v[100:103], a[52:55], a[4:7], v[100:103]
  ds_read_b64_tr_b16 a[108:109], v15 offset:16384
  ds_read_b64_tr_b16 a[110:111], v15 offset:18432
  v_mfma_f32_16x16x32_bf16 v[104:107], a[56:59], a[4:7], v[104:107]
  v_mfma_f32_16x16x32_bf16 v[108:111], a[60:63], a[4:7], v[108:111]
  s_waitcnt lgkmcnt(6)
  ds_read_b128 a[76:79], v11 offset:6144
  v_mfma_f32_16x16x32_bf16 v[112:115], a[32:35], a[8:11], v[112:115]
  v_mfma_f32_16x16x32_bf16 v[116:119], a[36:39], a[8:11], v[116:119]
  ds_read_b64_tr_b16 a[112:113], v16 offset:16384
  ds_read_b64_tr_b16 a[114:115], v16 offset:18432
  v_mfma_f32_16x16x32_bf16 v[120:123], a[40:43], a[8:11], v[120:123]
  v_mfma_f32_16x16x32_bf16 v[124:127], a[44:47], a[8:11], v[124:127]
  ds_read_b128 a[80:83], v11 offset:8192
  v_mfma_f32_16x16x32_bf16 v[128:131], a[48:51], a[8:11], v[128:131]
  v_mfma_f32_16x16x32_bf16 v[132:135], a[52:55], a[8:11], v[132:135]
  ds_read_b64_tr_b16 a[116:117], v17 offset:16384
  ds_read_b64_tr_b16 a[118:119], v17 offset:18432
  v_mfma_f32_16x16x32_bf16 v[136:139], a[56:59], a[8:11], v[136:139]
  v_mfma_f32_16x16x32_bf16 v[140:143], a[60:63], a[8:11], v[140:143]
  s_waitcnt lgkmcnt(6)
  ds_read_b128 a[84:87], v11 offset:10240
  v_mfma_f32_16x16x32_bf16 v[144:147], a[32:35], a[12:15], v[144:147]
  v_mfma_f32_16x16x32_bf16 v[148:151], a[36:39], a[12:15], v[148:151]
  ds_read_b64_tr_b16 a[120:121], v18 offset:16384
  ds_read_b64_tr_b16 a[122:123], v18 offset:18432
  v_mfma_f32_16x16x32_bf16 v[152:155], a[40:43], a[12:15], v[152:155]
  v_mfma_f32_16x16x32_bf16 v[156:159], a[44:47], a[12:15], v[156:159]
  ds_read_b128 a[88:91], v11 offset:12288
  v_mfma_f32_16x16x32_bf16 v[160:163], a[48:51], a[12:15], v[160:163]
  v_mfma_f32_16x16x32_bf16 v[164:167], a[52:55], a[12:15], v[164:167]
  ds_read_b64_tr_b16 a[124:125], v19 offset:16384
  ds_read_b64_tr_b16 a[126:127], v19 offset:18432
  v_mfma_f32_16x16x32_bf16 v[168:171], a[56:59], a[12:15], v[168:171]
  v_mfma_f32_16x16x32_bf16 v[172:175], a[60:63], a[12:15], v[172:175]
  s_waitcnt lgkmcnt(6)
  ds_read_b128 a[92:95], v11 offset:14336
  v_mfma_f32_16x16x32_bf16 v[176:179], a[32:35], a[16:19], v[176:179]
  v_mfma_f32_16x16x32_bf16 v[180:183], a[36:39], a[16:19], v[180:183]
  v_mfma_f32_16x16x32_bf16 v[184:187], a[40:43], a[16:19], v[184:187]
  v_mfma_f32_16x16x32_bf16 v[188:191], a[44:47], a[16:19], v[188:191]
  v_mfma_f32_16x16x32_bf16 v[192:195], a[48:51], a[16:19], v[192:195]
  v_mfma_f32_16x16x32_bf16 v[196:199], a[52:55], a[16:19], v[196:199]
  v_mfma_f32_16x16x32_bf16 v[200:203], a[56:59], a[16:19], v[200:203]
  v_mfma_f32_16x16x32_bf16 v[204:207], a[60:63], a[16:19], v[204:207]
  v_mfma_f32_16x16x32_bf16 v[208:211], a[32:35], a[20:23], v[208:211]
  v_mfma_f32_16x16x32_bf16 v[212:215], a[36:39], a[20:23], v[212:215]
  v_mfma_f32_16x16x32_bf16 v[216:219], a[40:43], a[20:23], v[216:219]
  v_mfma_f32_16x16x32_bf16 v[220:223], a[44:47], a[20:23], v[220:223]
  v_mfma_f32_16x16x32_bf16 v[224:227], a[48:51], a[20:23], v[224:227]
  v_mfma_f32_16x16x32_bf16 v[228:231], a[52:55], a[20:23], v[228:231]
  v_mfma_f32_16x16x32_bf16 v[232:235], a[56:59], a[20:23], v[232:235]
  v_mfma_f32_16x16x32_bf16 v[236:239], a[60:63], a[20:23], v[236:239]
  v_mfma_f32_16x16x32_bf16 v[240:243], a[32:35], a[24:27], v[240:243]
  v_mfma_f32_16x16x32_bf16 v[244:247], a[36:39], a[24:27], v[244:247]
  v_mfma_f32_16x16x32_bf16 v[248:251], a[40:43], a[24:27], v[248:251]
  v_mfma_f32_16x16x32_bf16 v[252:255], a[44:47], a[24:27], v[252:255]
  v_mfma_f32_16x16x32_bf16 a[128:131], a[48:51], a[24:27], a[128:131]
  v_mfma_f32_16x16x32_bf16 a[132:135], a[52:55], a[24:27], a[132:135]
  v_mfma_f32_16x16x32_bf16 a[136:139], a[56:59], a[24:27], a[136:139]
  v_mfma_f32_16x16x32_bf16 a[140:143], a[60:63], a[24:27], a[140:143]
  v_mfma_f32_16x16x32_bf16 a[144:147], a[32:35], a[28:31], a[144:147]
  v_mfma_f32_16x16x32_bf16 a[148:151], a[36:39], a[28:31], a[148:151]
  v_mfma_f32_16x16x32_bf16 a[152:155], a[40:43], a[28:31], a[152:155]
  v_mfma_f32_16x16x32_bf16 a[156:159], a[44:47], a[28:31], a[156:159]
  v_mfma_f32_16x16x32_bf16 a[160:163], a[48:51], a[28:31], a[160:163]
  v_mfma_f32_16x16x32_bf16 a[164:167], a[52:55], a[28:31], a[164:167]
  v_mfma_f32_16x16x32_bf16 a[168:171], a[56:59], a[28:31], a[168:171]
  v_mfma_f32_16x16x32_bf16 a[172:175], a[60:63], a[28:31], a[172:175]
  s_waitcnt vmcnt(1) lgkmcnt(0)
  s_barrier
  v_mfma_f32_16x16x32_bf16 v[48:51], a[96:99], a[64:67], v[48:51]
  v_mfma_f32_16x16x32_bf16 v[52:55], a[100:103], a[64:67], v[52:55]
  ds_read_b64_tr_b16 a[32:33], v22 offset:0
  ds_read_b64_tr_b16 a[34:35], v22 offset:2048
  v_mfma_f32_16x16x32_bf16 v[56:59], a[104:107], a[64:67], v[56:59]
  v_mfma_f32_16x16x32_bf16 v[60:63], a[108:111], a[64:67], v[60:63]
  ds_read_b128 a[0:3], v20 offset:0
  v_mfma_f32_16x16x32_bf16 v[64:67], a[112:115], a[64:67], v[64:67]
  v_mfma_f32_16x16x32_bf16 v[68:71], a[116:119], a[64:67], v[68:71]
  ds_read_b64_tr_b16 a[36:37], v23 offset:0
  ds_read_b64_tr_b16 a[38:39], v23 offset:2048
  v_mfma_f32_16x16x32_bf16 v[72:75], a[120:123], a[64:67], v[72:75]
  v_mfma_f32_16x16x32_bf16 v[76:79], a[124:127], a[64:67], v[76:79]
  s_waitcnt lgkmcnt(6)
  ds_read_b128 a[4:7], v20 offset:2048
  v_mfma_f32_16x16x32_bf16 v[80:83], a[96:99], a[68:71], v[80:83]
  v_mfma_f32_16x16x32_bf16 v[84:87], a[100:103], a[68:71], v[84:87]
  ds_read_b64_tr_b16 a[40:41], v24 offset:0
  ds_read_b64_tr_b16 a[42:43], v24 offset:2048
  v_mfma_f32_16x16x32_bf16 v[88:91], a[104:107], a[68:71], v[88:91]
  v_mfma_f32_16x16x32_bf16 v[92:95], a[108:111], a[68:71], v[92:95]
  ds_read_b128 a[8:11], v20 offset:4096
  v_mfma_f32_16x16x32_bf16 v[96:99], a[112:115], a[68:71], v[96:99]
  v_mfma_f32_16x16x32_bf16 v[100:103], a[116:119], a[68:71], v[100:103]
  ds_read_b64_tr_b16 a[44:45], v25 offset:0
  ds_read_b64_tr_b16 a[46:47], v25 offset:2048
  v_mfma_f32_16x16x32_bf16 v[104:107], a[120:123], a[68:71], v[104:107]
  v_mfma_f32_16x16x32_bf16 v[108:111], a[124:127], a[68:71], v[108:111]
  s_waitcnt lgkmcnt(6)
  ds_read_b128 a[12:15], v20 offset:6144
  v_mfma_f32_16x16x32_bf16 v[112:115], a[96:99], a[72:75], v[112:115]
  v_mfma_f32_16x16x32_bf16 v[116:119], a[100:103], a[72:75], v[116:119]
  ds_read_b64_tr_b16 a[48:49], v26 offset:0
  ds_read_b64_tr_b16 a[50:51], v26 offset:2048
  v_mfma_f32_16x16x32_bf16 v[120:123], a[104:107], a[72:75], v[120:123]
  v_mfma_f32_16x16x32_bf16 v[124:127], a[108:111], a[72:75], v[124:127]
  ds_read_b128 a[16:19], v20 offset:8192
  v_mfma_f32_16x16x32_bf16 v[128:131], a[112:115], a[72:75], v[128:131]
  v_mfma_f32_16x16x32_bf16 v[132:135], a[116:119], a[72:75], v[132:135]
  ds_read_b64_tr_b16 a[52:53], v27 offset:0
  ds_read_b64_tr_b16 a[54:55], v27 offset:2048
  v_mfma_f32_16x16x32_bf16 v[136:139], a[120:123], a[72:75], v[136:139]
  v_mfma_f32_16x16x32_bf16 v[140:143], a[124:127], a[72:75], v[140:143]
  s_waitcnt lgkmcnt(6)
  ds_read_b128 a[20:23], v20 offset:10240
  v_mfma_f32_16x16x32_bf16 v[144:147], a[96:99], a[76:79], v[144:147]
  v_mfma_f32_16x16x32_bf16 v[148:151], a[100:103], a[76:79], v[148:151]
  ds_read_b64_tr_b16 a[56:57], v28 offset:0
  ds_read_b64_tr_b16 a[58:59], v28 offset:2048
  v_mfma_f32_16x16x32_bf16 v[152:155], a[104:107], a[76:79], v[152:155]
  v_mfma_f32_16x16x32_bf16 v[156:159], a[108:111], a[76:79], v[156:159]
  ds_read_b128 a[24:27], v20 offset:12288
  v_mfma_f32_16x16x32_bf16 v[160:163], a[112:115], a[76:79], v[160:163]
  v_mfma_f32_16x16x32_bf16 v[164:167], a[116:119], a[76:79], v[164:167]
  ds_read_b64_tr_b16 a[60:61], v29 offset:0
  ds_read_b64_tr_b16 a[62:63], v29 offset:2048
  v_mfma_f32_16x16x32_bf16 v[168:171], a[120:123], a[76:79], v[168:171]
  v_mfma_f32_16x16x32_bf16 v[172:175], a[124:127], a[76:79], v[172:175]
  s_waitcnt lgkmcnt(6)
  ds_read_b128 a[28:31], v20 offset:14336
  v_mfma_f32_16x16x32_bf16 v[176:179], a[96:99], a[80:83], v[176:179]
  v_mfma_f32_16x16x32_bf16 v[180:183], a[100:103], a[80:83], v[180:183]
  v_mfma_f32_16x16x32_bf16 v[184:187], a[104:107], a[80:83], v[184:187]
  v_mfma_f32_16x16x32_bf16 v[188:191], a[108:111], a[80:83], v[188:191]
  v_mfma_f32_16x16x32_bf16 v[192:195], a[112:115], a[80:83], v[192:195]
  v_mfma_f32_16x16x32_bf16 v[196:199], a[116:119], a[80:83], v[196:199]
  v_mfma_f32_16x16x32_bf16 v[200:203], a[120:123], a[80:83], v[200:203]
  v_mfma_f32_16x16x32_bf16 v[204:207], a[124:127], a[80:83], v[204:207]
  v_mfma_f32_16x16x32_bf16 v[208:211], a[96:99], a[84:87], v[208:211]
  v_mfma_f32_16x16x32_bf16 v[212:215], a[100:103], a[84:87], v[212:215]
  v_mfma_f32_16x16x32_bf16 v[216:219], a[104:107], a[84:87], v[216:219]
  v_mfma_f32_16x16x32_bf16 v[220:223], a[108:111], a[84:87], v[220:223]
  v_mfma_f32_16x16x32_bf16 v[224:227], a[112:115], a[84:87], v[224:227]
  v_mfma_f32_16x16x32_bf16 v[228:231], a[116:119], a[84:87], v[228:231]
  v_mfma_f32_16x16x32_bf16 v[232:235], a[120:123], a[84:87], v[232:235]
  v_mfma_f32_16x16x32_bf16 v[236:239], a[124:127], a[84:87], v[236:239]
  v_mfma_f32_16x16x32_bf16 v[240:243], a[96:99], a[88:91], v[240:243]
  v_mfma_f32_16x16x32_bf16 v[244:247], a[100:103], a[88:91], v[244:247]
  v_mfma_f32_16x16x32_bf16 v[248:251], a[104:107], a[88:91], v[248:251]
  v_mfma_f32_16x16x32_bf16 v[252:255], a[108:111], a[88:91], v[252:255]
  v_mfma_f32_16x16x32_bf16 a[128:131], a[112:115], a[88:91], a[128:131]
  v_mfma_f32_16x16x32_bf16 a[132:135], a[116:119], a[88:91], a[132:135]
  v_mfma_f32_16x16x32_bf16 a[136:139], a[120:123], a[88:91], a[136:139]
  v_mfma_f32_16x16x32_bf16 a[140:143], a[124:127], a[88:91], a[140:143]
  v_mfma_f32_16x16x32_bf16 a[144:147], a[96:99], a[92:95], a[144:147]
  v_mfma_f32_16x16x32_bf16 a[148:151], a[100:103], a[92:95], a[148:151]
  v_mfma_f32_16x16x32_bf16 a[152:155], a[104:107], a[92:95], a[152:155]
  v_mfma_f32_16x16x32_bf16 a[156:159], a[108:111], a[92:95], a[156:159]
  v_mfma_f32_16x16x32_bf16 a[160:163], a[112:115], a[92:95], a[160:163]
  v_mfma_f32_16x16x32_bf16 a[164:167], a[116:119], a[92:95], a[164:167]
  v_mfma_f32_16x16x32_bf16 a[168:171], a[120:123], a[92:95], a[168:171]
  v_mfma_f32_16x16x32_bf16 a[172:175], a[124:127], a[92:95], a[172:175]
  s_waitcnt lgkmcnt(0)
  v_mfma_f32_16x16x32_bf16 v[48:51], a[32:35], a[0:3], v[48:51]
  v_mfma_f32_16x16x32_bf16 v[52:55], a[36:39], a[0:3], v[52:55]
  ds_read_b64_tr_b16 a[96:97], v22 offset:16384
  ds_read_b64_tr_b16 a[98:99], v22 offset:18432
  v_mfma_f32_16x16x32_bf16 v[56:59], a[40:43], a[0:3], v[56:59]
  v_mfma_f32_16x16x32_bf16 v[60:63], a[44:47], a[0:3], v[60:63]
  ds_read_b128 a[64:67], v21 offset:0
  v_mfma_f32_16x16x32_bf16 v[64:67], a[48:51], a[0:3], v[64:67]
  v_mfma_f32_16x16x32_bf16 v[68:71], a[52:55], a[0:3], v[68:71]
  ds_read_b64_tr_b16 a[100:101], v23 offset:16384
  ds_read_b64_tr_b16 a[102:103], v23 offset:18432
  v_mfma_f32_16x16x32_bf16 v[72:75], a[56:59], a[0:3], v[72:75]
  v_mfma_f32_16x16x32_bf16 v[76:79], a[60:63], a[0:3], v[76:79]
  s_waitcnt lgkmcnt(6)
  ds_read_b128 a[68:71], v21 offset:2048
  v_mfma_f32_16x16x32_bf16 v[80:83], a[32:35], a[4:7], v[80:83]
  v_mfma_f32_16x16x32_bf16 v[84:87], a[36:39], a[4:7], v[84:87]
  ds_read_b64_tr_b16 a[104:105], v24 offset:16384
  ds_read_b64_tr_b16 a[106:107], v24 offset:18432
  v_mfma_f32_16x16x32_bf16 v[88:91], a[40:43], a[4:7], v[88:91]
  v_mfma_f32_16x16x32_bf16 v[92:95], a[44:47], a[4:7], v[92:95]
  ds_read_b128 a[72:75], v21 offset:4096
  v_mfma_f32_16x16x32_bf16 v[96:99], a[48:51], a[4:7], v[96:99]
  v_mfma_f32_16x16x32_bf16 v[100:103], a[52:55], a[4:7], v[100:103]
  ds_read_b64_tr_b16 a[108:109], v25 offset:16384
  ds_read_b64_tr_b16 a[110:111], v25 offset:18432
  v_mfma_f32_16x16x32_bf16 v[104:107], a[56:59], a[4:7], v[104:107]
  v_mfma_f32_16x16x32_bf16 v[108:111], a[60:63], a[4:7], v[108:111]
  s_waitcnt lgkmcnt(6)
  ds_read_b128 a[76:79], v21 offset:6144
  v_mfma_f32_16x16x32_bf16 v[112:115], a[32:35], a[8:11], v[112:115]
  v_mfma_f32_16x16x32_bf16 v[116:119], a[36:39], a[8:11], v[116:119]
  ds_read_b64_tr_b16 a[112:113], v26 offset:16384
  ds_read_b64_tr_b16 a[114:115], v26 offset:18432
  v_mfma_f32_16x16x32_bf16 v[120:123], a[40:43], a[8:11], v[120:123]
  v_mfma_f32_16x16x32_bf16 v[124:127], a[44:47], a[8:11], v[124:127]
  ds_read_b128 a[80:83], v21 offset:8192
  v_mfma_f32_16x16x32_bf16 v[128:131], a[48:51], a[8:11], v[128:131]
  v_mfma_f32_16x16x32_bf16 v[132:135], a[52:55], a[8:11], v[132:135]
  ds_read_b64_tr_b16 a[116:117], v27 offset:16384
  ds_read_b64_tr_b16 a[118:119], v27 offset:18432
  v_mfma_f32_16x16x32_bf16 v[136:139], a[56:59], a[8:11], v[136:139]
  v_mfma_f32_16x16x32_bf16 v[140:143], a[60:63], a[8:11], v[140:143]
  s_waitcnt lgkmcnt(6)
  ds_read_b128 a[84:87], v21 offset:10240
  v_mfma_f32_16x16x32_bf16 v[144:147], a[32:35], a[12:15], v[144:147]
  v_mfma_f32_16x16x32_bf16 v[148:151], a[36:39], a[12:15], v[148:151]
  ds_read_b64_tr_b16 a[120:121], v28 offset:16384
  ds_read_b64_tr_b16 a[122:123], v28 offset:18432
  v_mfma_f32_16x16x32_bf16 v[152:155], a[40:43], a[12:15], v[152:155]
  v_mfma_f32_16x16x32_bf16 v[156:159], a[44:47], a[12:15], v[156:159]
  ds_read_b128 a[88:91], v21 offset:12288
  v_mfma_f32_16x16x32_bf16 v[160:163], a[48:51], a[12:15], v[160:163]
  v_mfma_f32_16x16x32_bf16 v[164:167], a[52:55], a[12:15], v[164:167]
  ds_read_b64_tr_b16 a[124:125], v29 offset:16384
  ds_read_b64_tr_b16 a[126:127], v29 offset:18432
  v_mfma_f32_16x16x32_bf16 v[168:171], a[56:59], a[12:15], v[168:171]
  v_mfma_f32_16x16x32_bf16 v[172:175], a[60:63], a[12:15], v[172:175]
  s_waitcnt lgkmcnt(6)
  ds_read_b128 a[92:95], v21 offset:14336
  v_mfma_f32_16x16x32_bf16 v[176:179], a[32:35], a[16:19], v[176:179]
  v_mfma_f32_16x16x32_bf16 v[180:183], a[36:39], a[16:19], v[180:183]
  v_mfma_f32_16x16x32_bf16 v[184:187], a[40:43], a[16:19], v[184:187]
  v_mfma_f32_16x16x32_bf16 v[188:191], a[44:47], a[16:19], v[188:191]
  v_mfma_f32_16x16x32_bf16 v[192:195], a[48:51], a[16:19], v[192:195]
  v_mfma_f32_16x16x32_bf16 v[196:199], a[52:55], a[16:19], v[196:199]
  v_mfma_f32_16x16x32_bf16 v[200:203], a[56:59], a[16:19], v[200:203]
  v_mfma_f32_16x16x32_bf16 v[204:207], a[60:63], a[16:19], v[204:207]
  v_mfma_f32_16x16x32_bf16 v[208:211], a[32:35], a[20:23], v[208:211]
  v_mfma_f32_16x16x32_bf16 v[212:215], a[36:39], a[20:23], v[212:215]
  v_mfma_f32_16x16x32_bf16 v[216:219], a[40:43], a[20:23], v[216:219]
  v_mfma_f32_16x16x32_bf16 v[220:223], a[44:47], a[20:23], v[220:223]
  v_mfma_f32_16x16x32_bf16 v[224:227], a[48:51], a[20:23], v[224:227]
  v_mfma_f32_16x16x32_bf16 v[228:231], a[52:55], a[20:23], v[228:231]
  v_mfma_f32_16x16x32_bf16 v[232:235], a[56:59], a[20:23], v[232:235]
  v_mfma_f32_16x16x32_bf16 v[236:239], a[60:63], a[20:23], v[236:239]
  v_mfma_f32_16x16x32_bf16 v[240:243], a[32:35], a[24:27], v[240:243]
  v_mfma_f32_16x16x32_bf16 v[244:247], a[36:39], a[24:27], v[244:247]
  v_mfma_f32_16x16x32_bf16 v[248:251], a[40:43], a[24:27], v[248:251]
  v_mfma_f32_16x16x32_bf16 v[252:255], a[44:47], a[24:27], v[252:255]
  v_mfma_f32_16x16x32_bf16 a[128:131], a[48:51], a[24:27], a[128:131]
  v_mfma_f32_16x16x32_bf16 a[132:135], a[52:55], a[24:27], a[132:135]
  v_mfma_f32_16x16x32_bf16 a[136:139], a[56:59], a[24:27], a[136:139]
  v_mfma_f32_16x16x32_bf16 a[140:143], a[60:63], a[24:27], a[140:143]
  v_mfma_f32_16x16x32_bf16 a[144:147], a[32:35], a[28:31], a[144:147]
  v_mfma_f32_16x16x32_bf16 a[148:151], a[36:39], a[28:31], a[148:151]
  v_mfma_f32_16x16x32_bf16 a[152:155], a[40:43], a[28:31], a[152:155]
  v_mfma_f32_16x16x32_bf16 a[156:159], a[44:47], a[28:31], a[156:159]
  v_mfma_f32_16x16x32_bf16 a[160:163], a[48:51], a[28:31], a[160:163]
  v_mfma_f32_16x16x32_bf16 a[164:167], a[52:55], a[28:31], a[164:167]
  v_mfma_f32_16x16x32_bf16 a[168:171], a[56:59], a[28:31], a[168:171]
  v_mfma_f32_16x16x32_bf16 a[172:175], a[60:63], a[28:31], a[172:175]
  s_waitcnt lgkmcnt(0)
  v_mfma_f32_16x16x32_bf16 v[48:51], a[96:99], a[64:67], v[48:51]
  v_mfma_f32_16x16x32_bf16 v[52:55], a[100:103], a[64:67], v[52:55]
  v_mfma_f32_16x16x32_bf16 v[56:59], a[104:107], a[64:67], v[56:59]
  v_mfma_f32_16x16x32_bf16 v[60:63], a[108:111], a[64:67], v[60:63]
  v_mfma_f32_16x16x32_bf16 v[64:67], a[112:115], a[64:67], v[64:67]
  v_mfma_f32_16x16x32_bf16 v[68:71], a[116:119], a[64:67], v[68:71]
  v_mfma_f32_16x16x32_bf16 v[72:75], a[120:123], a[64:67], v[72:75]
  v_mfma_f32_16x16x32_bf16 v[76:79], a[124:127], a[64:67], v[76:79]
  v_mfma_f32_16x16x32_bf16 v[80:83], a[96:99], a[68:71], v[80:83]
  v_mfma_f32_16x16x32_bf16 v[84:87], a[100:103], a[68:71], v[84:87]
  v_mfma_f32_16x16x32_bf16 v[88:91], a[104:107], a[68:71], v[88:91]
  v_mfma_f32_16x16x32_bf16 v[92:95], a[108:111], a[68:71], v[92:95]
  v_mfma_f32_16x16x32_bf16 v[96:99], a[112:115], a[68:71], v[96:99]
  v_mfma_f32_16x16x32_bf16 v[100:103], a[116:119], a[68:71], v[100:103]
  v_mfma_f32_16x16x32_bf16 v[104:107], a[120:123], a[68:71], v[104:107]
  v_mfma_f32_16x16x32_bf16 v[108:111], a[124:127], a[68:71], v[108:111]
  v_mfma_f32_16x16x32_bf16 v[112:115], a[96:99], a[72:75], v[112:115]
  v_mfma_f32_16x16x32_bf16 v[116:119], a[100:103], a[72:75], v[116:119]
  v_mfma_f32_16x16x32_bf16 v[120:123], a[104:107], a[72:75], v[120:123]
  v_mfma_f32_16x16x32_bf16 v[124:127], a[108:111], a[72:75], v[124:127]
  v_mfma_f32_16x16x32_bf16 v[128:131], a[112:115], a[72:75], v[128:131]
  v_mfma_f32_16x16x32_bf16 v[132:135], a[116:119], a[72:75], v[132:135]
  v_mfma_f32_16x16x32_bf16 v[136:139], a[120:123], a[72:75], v[136:139]
  v_mfma_f32_16x16x32_bf16 v[140:143], a[124:127], a[72:75], v[140:143]
  v_mfma_f32_16x16x32_bf16 v[144:147], a[96:99], a[76:79], v[144:147]
  v_mfma_f32_16x16x32_bf16 v[148:151], a[100:103], a[76:79], v[148:151]
  v_mfma_f32_16x16x32_bf16 v[152:155], a[104:107], a[76:79], v[152:155]
  v_mfma_f32_16x16x32_bf16 v[156:159], a[108:111], a[76:79], v[156:159]
  v_mfma_f32_16x16x32_bf16 v[160:163], a[112:115], a[76:79], v[160:163]
  v_mfma_f32_16x16x32_bf16 v[164:167], a[116:119], a[76:79], v[164:167]
  v_mfma_f32_16x16x32_bf16 v[168:171], a[120:123], a[76:79], v[168:171]
  v_mfma_f32_16x16x32_bf16 v[172:175], a[124:127], a[76:79], v[172:175]
  v_mfma_f32_16x16x32_bf16 v[176:179], a[96:99], a[80:83], v[176:179]
  v_mfma_f32_16x16x32_bf16 v[180:183], a[100:103], a[80:83], v[180:183]
  v_mfma_f32_16x16x32_bf16 v[184:187], a[104:107], a[80:83], v[184:187]
  v_mfma_f32_16x16x32_bf16 v[188:191], a[108:111], a[80:83], v[188:191]
  v_mfma_f32_16x16x32_bf16 v[192:195], a[112:115], a[80:83], v[192:195]
  v_mfma_f32_16x16x32_bf16 v[196:199], a[116:119], a[80:83], v[196:199]
  v_mfma_f32_16x16x32_bf16 v[200:203], a[120:123], a[80:83], v[200:203]
  v_mfma_f32_16x16x32_bf16 v[204:207], a[124:127], a[80:83], v[204:207]
  v_mfma_f32_16x16x32_bf16 v[208:211], a[96:99], a[84:87], v[208:211]
  v_mfma_f32_16x16x32_bf16 v[212:215], a[100:103], a[84:87], v[212:215]
  v_mfma_f32_16x16x32_bf16 v[216:219], a[104:107], a[84:87], v[216:219]
  v_mfma_f32_16x16x32_bf16 v[220:223], a[108:111], a[84:87], v[220:223]
  v_mfma_f32_16x16x32_bf16 v[224:227], a[112:115], a[84:87], v[224:227]
  v_mfma_f32_16x16x32_bf16 v[228:231], a[116:119], a[84:87], v[228:231]
  v_mfma_f32_16x16x32_bf16 v[232:235], a[120:123], a[84:87], v[232:235]
  v_mfma_f32_16x16x32_bf16 v[236:239], a[124:127], a[84:87], v[236:239]
  v_mfma_f32_16x16x32_bf16 v[240:243], a[96:99], a[88:91], v[240:243]
  v_mfma_f32_16x16x32_bf16 v[244:247], a[100:103], a[88:91], v[244:247]
  v_mfma_f32_16x16x32_bf16 v[248:251], a[104:107], a[88:91], v[248:251]
  v_mfma_f32_16x16x32_bf16 v[252:255], a[108:111], a[88:91], v[252:255]
  v_mfma_f32_16x16x32_bf16 a[128:131], a[112:115], a[88:91], a[128:131]
  v_mfma_f32_16x16x32_bf16 a[132:135], a[116:119], a[88:91], a[132:135]
  v_mfma_f32_16x16x32_bf16 a[136:139], a[120:123], a[88:91], a[136:139]
  v_mfma_f32_16x16x32_bf16 a[140:143], a[124:127], a[88:91], a[140:143]
  v_mfma_f32_16x16x32_bf16 a[144:147], a[96:99], a[92:95], a[144:147]
  v_mfma_f32_16x16x32_bf16 a[148:151], a[100:103], a[92:95], a[148:151]
  v_mfma_f32_16x16x32_bf16 a[152:155], a[104:107], a[92:95], a[152:155]
  v_mfma_f32_16x16x32_bf16 a[156:159], a[108:111], a[92:95], a[156:159]
  v_mfma_f32_16x16x32_bf16 a[160:163], a[112:115], a[92:95], a[160:163]
  v_mfma_f32_16x16x32_bf16 a[164:167], a[116:119], a[92:95], a[164:167]
  v_mfma_f32_16x16x32_bf16 a[168:171], a[120:123], a[92:95], a[168:171]
  v_mfma_f32_16x16x32_bf16 a[172:175], a[124:127], a[92:95], a[172:175]
  s_waitcnt vmcnt(0)
  v_lshlrev_b32 v1, 4, v0
  s_lshl_b32 s3, s34, 1
  s_and_b32 s36, s32, 1
  s_add_u32 s3, s3, s36
  s_lshl_b32 s3, s3, 20
  s_lshl_b32 s36, s33, 17
  s_add_u32 s3, s3, s36
  s_lshr_b32 s36, s32, 1
  s_lshl_b32 s36, s36, 16
  s_add_u32 s3, s3, s36
  v_cvt_pk_bf16_f32 v2, v48, v49
  v_cvt_pk_bf16_f32 v3, v50, v51
  v_cvt_pk_bf16_f32 v4, v52, v53
  v_cvt_pk_bf16_f32 v5, v54, v55
  s_add_u32 s36, s3, 0
  buffer_store_dwordx4 v[2:5], v1, s[24:27], s36 offen offset:0 sc1
  v_cvt_pk_bf16_f32 v6, v56, v57
  v_cvt_pk_bf16_f32 v7, v58, v59
  v_cvt_pk_bf16_f32 v8, v60, v61
  v_cvt_pk_bf16_f32 v9, v62, v63
  buffer_store_dwordx4 v[6:9], v1, s[24:27], s36 offen offset:1024 sc1
  v_cvt_pk_bf16_f32 v10, v64, v65
  v_cvt_pk_bf16_f32 v11, v66, v67
  v_cvt_pk_bf16_f32 v12, v68, v69
  v_cvt_pk_bf16_f32 v13, v70, v71
  buffer_store_dwordx4 v[10:13], v1, s[24:27], s36 offen offset:2048 sc1
  v_cvt_pk_bf16_f32 v14, v72, v73
  v_cvt_pk_bf16_f32 v15, v74, v75
  v_cvt_pk_bf16_f32 v16, v76, v77
  v_cvt_pk_bf16_f32 v17, v78, v79
  buffer_store_dwordx4 v[14:17], v1, s[24:27], s36 offen offset:3072 sc1
  v_cvt_pk_bf16_f32 v2, v80, v81
  v_cvt_pk_bf16_f32 v3, v82, v83
  v_cvt_pk_bf16_f32 v4, v84, v85
  v_cvt_pk_bf16_f32 v5, v86, v87
  s_add_u32 s36, s3, 4096
  buffer_store_dwordx4 v[2:5], v1, s[24:27], s36 offen offset:0 sc1
  v_cvt_pk_bf16_f32 v6, v88, v89
  v_cvt_pk_bf16_f32 v7, v90, v91
  v_cvt_pk_bf16_f32 v8, v92, v93
  v_cvt_pk_bf16_f32 v9, v94, v95
  buffer_store_dwordx4 v[6:9], v1, s[24:27], s36 offen offset:1024 sc1
  v_cvt_pk_bf16_f32 v10, v96, v97
  v_cvt_pk_bf16_f32 v11, v98, v99
  v_cvt_pk_bf16_f32 v12, v100, v101
  v_cvt_pk_bf16_f32 v13, v102, v103
  buffer_store_dwordx4 v[10:13], v1, s[24:27], s36 offen offset:2048 sc1
  v_cvt_pk_bf16_f32 v14, v104, v105
  v_cvt_pk_bf16_f32 v15, v106, v107
  v_cvt_pk_bf16_f32 v16, v108, v109
  v_cvt_pk_bf16_f32 v17, v110, v111
  buffer_store_dwordx4 v[14:17], v1, s[24:27], s36 offen offset:3072 sc1
  v_cvt_pk_bf16_f32 v2, v112, v113
  v_cvt_pk_bf16_f32 v3, v114, v115
  v_cvt_pk_bf16_f32 v4, v116, v117
  v_cvt_pk_bf16_f32 v5, v118, v119
  s_add_u32 s36, s3, 8192
  buffer_store_dwordx4 v[2:5], v1, s[24:27], s36 offen offset:0 sc1
  v_cvt_pk_bf16_f32 v6, v120, v121
  v_cvt_pk_bf16_f32 v7, v122, v123
  v_cvt_pk_bf16_f32 v8, v124, v125
  v_cvt_pk_bf16_f32 v9, v126, v127
  buffer_store_dwordx4 v[6:9], v1, s[24:27], s36 offen offset:1024 sc1
  v_cvt_pk_bf16_f32 v10, v128, v129
  v_cvt_pk_bf16_f32 v11, v130, v131
  v_cvt_pk_bf16_f32 v12, v132, v133
  v_cvt_pk_bf16_f32 v13, v134, v135
  buffer_store_dwordx4 v[10:13], v1, s[24:27], s36 offen offset:2048 sc1
  v_cvt_pk_bf16_f32 v14, v136, v137
  v_cvt_pk_bf16_f32 v15, v138, v139
  v_cvt_pk_bf16_f32 v16, v140, v141
  v_cvt_pk_bf16_f32 v17, v142, v143
  buffer_store_dwordx4 v[14:17], v1, s[24:27], s36 offen offset:3072 sc1
  v_cvt_pk_bf16_f32 v2, v144, v145
  v_cvt_pk_bf16_f32 v3, v146, v147
  v_cvt_pk_bf16_f32 v4, v148, v149
  v_cvt_pk_bf16_f32 v5, v150, v151
  s_add_u32 s36, s3, 12288
  buffer_store_dwordx4 v[2:5], v1, s[24:27], s36 offen offset:0 sc1
  v_cvt_pk_bf16_f32 v6, v152, v153
  v_cvt_pk_bf16_f32 v7, v154, v155
  v_cvt_pk_bf16_f32 v8, v156, v157
  v_cvt_pk_bf16_f32 v9, v158, v159
  buffer_store_dwordx4 v[6:9], v1, s[24:27], s36 offen offset:1024 sc1
  v_cvt_pk_bf16_f32 v10, v160, v161
  v_cvt_pk_bf16_f32 v11, v162, v163
  v_cvt_pk_bf16_f32 v12, v164, v165
  v_cvt_pk_bf16_f32 v13, v166, v167
  buffer_store_dwordx4 v[10:13], v1, s[24:27], s36 offen offset:2048 sc1
  v_cvt_pk_bf16_f32 v14, v168, v169
  v_cvt_pk_bf16_f32 v15, v170, v171
  v_cvt_pk_bf16_f32 v16, v172, v173
  v_cvt_pk_bf16_f32 v17, v174, v175
  buffer_store_dwordx4 v[14:17], v1, s[24:27], s36 offen offset:3072 sc1
  v_cvt_pk_bf16_f32 v2, v176, v177
  v_cvt_pk_bf16_f32 v3, v178, v179
  v_cvt_pk_bf16_f32 v4, v180, v181
  v_cvt_pk_bf16_f32 v5, v182, v183
  s_add_u32 s36, s3, 32768
  buffer_store_dwordx4 v[2:5], v1, s[24:27], s36 offen offset:0 sc1
  v_cvt_pk_bf16_f32 v6, v184, v185
  v_cvt_pk_bf16_f32 v7, v186, v187
  v_cvt_pk_bf16_f32 v8, v188, v189
  v_cvt_pk_bf16_f32 v9, v190, v191
  buffer_store_dwordx4 v[6:9], v1, s[24:27], s36 offen offset:1024 sc1
  v_cvt_pk_bf16_f32 v10, v192, v193
  v_cvt_pk_bf16_f32 v11, v194, v195
  v_cvt_pk_bf16_f32 v12, v196, v197
  v_cvt_pk_bf16_f32 v13, v198, v199
  buffer_store_dwordx4 v[10:13], v1, s[24:27], s36 offen offset:2048 sc1
  v_cvt_pk_bf16_f32 v14, v200, v201
  v_cvt_pk_bf16_f32 v15, v202, v203
  v_cvt_pk_bf16_f32 v16, v204, v205
  v_cvt_pk_bf16_f32 v17, v206, v207
  buffer_store_dwordx4 v[14:17], v1, s[24:27], s36 offen offset:3072 sc1
  v_cvt_pk_bf16_f32 v2, v208, v209
  v_cvt_pk_bf16_f32 v3, v210, v211
  v_cvt_pk_bf16_f32 v4, v212, v213
  v_cvt_pk_bf16_f32 v5, v214, v215
  s_add_u32 s36, s3, 36864
  buffer_store_dwordx4 v[2:5], v1, s[24:27], s36 offen offset:0 sc1
  v_cvt_pk_bf16_f32 v6, v216, v217
  v_cvt_pk_bf16_f32 v7, v218, v219
  v_cvt_pk_bf16_f32 v8, v220, v221
  v_cvt_pk_bf16_f32 v9, v222, v223
  buffer_store_dwordx4 v[6:9], v1, s[24:27], s36 offen offset:1024 sc1
  v_cvt_pk_bf16_f32 v10, v224, v225
  v_cvt_pk_bf16_f32 v11, v226, v227
  v_cvt_pk_bf16_f32 v12, v228, v229
  v_cvt_pk_bf16_f32 v13, v230, v231
  buffer_store_dwordx4 v[10:13], v1, s[24:27], s36 offen offset:2048 sc1
  v_cvt_pk_bf16_f32 v14, v232, v233
  v_cvt_pk_bf16_f32 v15, v234, v235
  v_cvt_pk_bf16_f32 v16, v236, v237
  v_cvt_pk_bf16_f32 v17, v238, v239
  buffer_store_dwordx4 v[14:17], v1, s[24:27], s36 offen offset:3072 sc1
  v_cvt_pk_bf16_f32 v2, v240, v241
  v_cvt_pk_bf16_f32 v3, v242, v243
  v_cvt_pk_bf16_f32 v4, v244, v245
  v_cvt_pk_bf16_f32 v5, v246, v247
  s_add_u32 s36, s3, 40960
  buffer_store_dwordx4 v[2:5], v1, s[24:27], s36 offen offset:0 sc1
  v_cvt_pk_bf16_f32 v6, v248, v249
  v_cvt_pk_bf16_f32 v7, v250, v251
  v_cvt_pk_bf16_f32 v8, v252, v253
  v_cvt_pk_bf16_f32 v9, v254, v255
  buffer_store_dwordx4 v[6:9], v1, s[24:27], s36 offen offset:1024 sc1
  v_accvgpr_read_b32 v20, a128
  v_accvgpr_read_b32 v21, a129
  v_accvgpr_read_b32 v22, a130
  v_accvgpr_read_b32 v23, a131
  v_cvt_pk_bf16_f32 v10, v20, v21
  v_cvt_pk_bf16_f32 v11, v22, v23
  v_accvgpr_read_b32 v20, a132
  v_accvgpr_read_b32 v21, a133
  v_accvgpr_read_b32 v22, a134
  v_accvgpr_read_b32 v23, a135
  v_cvt_pk_bf16_f32 v12, v20, v21
  v_cvt_pk_bf16_f32 v13, v22, v23
  buffer_store_dwordx4 v[10:13], v1, s[24:27], s36 offen offset:2048 sc1
  v_accvgpr_read_b32 v20, a136
  v_accvgpr_read_b32 v21, a137
  v_accvgpr_read_b32 v22, a138
  v_accvgpr_read_b32 v23, a139
  v_cvt_pk_bf16_f32 v14, v20, v21
  v_cvt_pk_bf16_f32 v15, v22, v23
  v_accvgpr_read_b32 v20, a140
  v_accvgpr_read_b32 v21, a141
  v_accvgpr_read_b32 v22, a142
  v_accvgpr_read_b32 v23, a143
  v_cvt_pk_bf16_f32 v16, v20, v21
  v_cvt_pk_bf16_f32 v17, v22, v23
  buffer_store_dwordx4 v[14:17], v1, s[24:27], s36 offen offset:3072 sc1
  v_accvgpr_read_b32 v20, a144
  v_accvgpr_read_b32 v21, a145
  v_accvgpr_read_b32 v22, a146
  v_accvgpr_read_b32 v23, a147
  v_cvt_pk_bf16_f32 v2, v20, v21
  v_cvt_pk_bf16_f32 v3, v22, v23
  v_accvgpr_read_b32 v20, a148
  v_accvgpr_read_b32 v21, a149
  v_accvgpr_read_b32 v22, a150
  v_accvgpr_read_b32 v23, a151
  v_cvt_pk_bf16_f32 v4, v20, v21
  v_cvt_pk_bf16_f32 v5, v22, v23
  s_add_u32 s36, s3, 45056
  buffer_store_dwordx4 v[2:5], v1, s[24:27], s36 offen offset:0 sc1
  v_accvgpr_read_b32 v20, a152
  v_accvgpr_read_b32 v21, a153
  v_accvgpr_read_b32 v22, a154
  v_accvgpr_read_b32 v23, a155
  v_cvt_pk_bf16_f32 v6, v20, v21
  v_cvt_pk_bf16_f32 v7, v22, v23
  v_accvgpr_read_b32 v20, a156
  v_accvgpr_read_b32 v21, a157
  v_accvgpr_read_b32 v22, a158
  v_accvgpr_read_b32 v23, a159
  v_cvt_pk_bf16_f32 v8, v20, v21
  v_cvt_pk_bf16_f32 v9, v22, v23
  buffer_store_dwordx4 v[6:9], v1, s[24:27], s36 offen offset:1024 sc1
  v_accvgpr_read_b32 v20, a160
  v_accvgpr_read_b32 v21, a161
  v_accvgpr_read_b32 v22, a162
  v_accvgpr_read_b32 v23, a163
  v_cvt_pk_bf16_f32 v10, v20, v21
  v_cvt_pk_bf16_f32 v11, v22, v23
  v_accvgpr_read_b32 v20, a164
  v_accvgpr_read_b32 v21, a165
  v_accvgpr_read_b32 v22, a166
  v_accvgpr_read_b32 v23, a167
  v_cvt_pk_bf16_f32 v12, v20, v21
  v_cvt_pk_bf16_f32 v13, v22, v23
  buffer_store_dwordx4 v[10:13], v1, s[24:27], s36 offen offset:2048 sc1
  v_accvgpr_read_b32 v20, a168
  v_accvgpr_read_b32 v21, a169
  v_accvgpr_read_b32 v22, a170
  v_accvgpr_read_b32 v23, a171
  v_cvt_pk_bf16_f32 v14, v20, v21
  v_cvt_pk_bf16_f32 v15, v22, v23
  v_accvgpr_read_b32 v20, a172
  v_accvgpr_read_b32 v21, a173
  v_accvgpr_read_b32 v22, a174
  v_accvgpr_read_b32 v23, a175
  v_cvt_pk_bf16_f32 v16, v20, v21
  v_cvt_pk_bf16_f32 v17, v22, v23
  buffer_store_dwordx4 v[14:17], v1, s[24:27], s36 offen offset:3072 sc1
  s_endpgm
L_k1_vpath:
  s_mov_b32 s58, 3
L_kv_kernel_loop2:
  s_waitcnt lgkmcnt(0)
  v_mfma_f32_16x16x32_bf16 v[48:51], a[0:3], a[32:35], v[48:51]
  v_mfma_f32_16x16x32_bf16 v[52:55], a[0:3], a[36:39], v[52:55]
  ds_read_b64_tr_b16 a[96:97], v12 offset:16384
  ds_read_b64_tr_b16 a[98:99], v12 offset:18432
  v_mfma_f32_16x16x32_bf16 v[56:59], a[0:3], a[40:43], v[56:59]
  v_mfma_f32_16x16x32_bf16 v[60:63], a[0:3], a[44:47], v[60:63]
  ds_read_b128 a[64:67], v11 offset:0
  v_mfma_f32_16x16x32_bf16 v[64:67], a[0:3], a[48:51], v[64:67]
  v_mfma_f32_16x16x32_bf16 v[68:71], a[0:3], a[52:55], v[68:71]
  ds_read_b64_tr_b16 a[100:101], v13 offset:16384
  ds_read_b64_tr_b16 a[102:103], v13 offset:18432
  v_mfma_f32_16x16x32_bf16 v[72:75], a[0:3], a[56:59], v[72:75]
  v_mfma_f32_16x16x32_bf16 v[76:79], a[0:3], a[60:63], v[76:79]
  s_waitcnt lgkmcnt(6)
  ds_read_b128 a[68:71], v11 offset:2048
  v_mfma_f32_16x16x32_bf16 v[80:83], a[4:7], a[32:35], v[80:83]
  v_mfma_f32_16x16x32_bf16 v[84:87], a[4:7], a[36:39], v[84:87]
  ds_read_b64_tr_b16 a[104:105], v14 offset:16384
  ds_read_b64_tr_b16 a[106:107], v14 offset:18432
  v_mfma_f32_16x16x32_bf16 v[88:91], a[4:7], a[40:43], v[88:91]
  v_mfma_f32_16x16x32_bf16 v[92:95], a[4:7], a[44:47], v[92:95]
  ds_read_b128 a[72:75], v11 offset:4096
  v_mfma_f32_16x16x32_bf16 v[96:99], a[4:7], a[48:51], v[96:99]
  v_mfma_f32_16x16x32_bf16 v[100:103], a[4:7], a[52:55], v[100:103]
  ds_read_b64_tr_b16 a[108:109], v15 offset:16384
  ds_read_b64_tr_b16 a[110:111], v15 offset:18432
  v_mfma_f32_16x16x32_bf16 v[104:107], a[4:7], a[56:59], v[104:107]
  v_mfma_f32_16x16x32_bf16 v[108:111], a[4:7], a[60:63], v[108:111]
  s_waitcnt lgkmcnt(6)
  ds_read_b128 a[76:79], v11 offset:6144
  v_mfma_f32_16x16x32_bf16 v[112:115], a[8:11], a[32:35], v[112:115]
  v_mfma_f32_16x16x32_bf16 v[116:119], a[8:11], a[36:39], v[116:119]
  ds_read_b64_tr_b16 a[112:113], v16 offset:16384
  ds_read_b64_tr_b16 a[114:115], v16 offset:18432
  v_mfma_f32_16x16x32_bf16 v[120:123], a[8:11], a[40:43], v[120:123]
  v_mfma_f32_16x16x32_bf16 v[124:127], a[8:11], a[44:47], v[124:127]
  ds_read_b128 a[80:83], v11 offset:8192
  v_mfma_f32_16x16x32_bf16 v[128:131], a[8:11], a[48:51], v[128:131]
  v_mfma_f32_16x16x32_bf16 v[132:135], a[8:11], a[52:55], v[132:135]
  ds_read_b64_tr_b16 a[116:117], v17 offset:16384
  ds_read_b64_tr_b16 a[118:119], v17 offset:18432
  v_mfma_f32_16x16x32_bf16 v[136:139], a[8:11], a[56:59], v[136:139]
  v_mfma_f32_16x16x32_bf16 v[140:143], a[8:11], a[60:63], v[140:143]
  s_waitcnt lgkmcnt(6)
  ds_read_b128 a[84:87], v11 offset:10240
  v_mfma_f32_16x16x32_bf16 v[144:147], a[12:15], a[32:35], v[144:147]
  v_mfma_f32_16x16x32_bf16 v[148:151], a[12:15], a[36:39], v[148:151]
  ds_read_b64_tr_b16 a[120:121], v18 offset:16384
  ds_read_b64_tr_b16 a[122:123], v18 offset:18432
  v_mfma_f32_16x16x32_bf16 v[152:155], a[12:15], a[40:43], v[152:155]
  v_mfma_f32_16x16x32_bf16 v[156:159], a[12:15], a[44:47], v[156:159]
  ds_read_b128 a[88:91], v11 offset:12288
  v_mfma_f32_16x16x32_bf16 v[160:163], a[12:15], a[48:51], v[160:163]
  v_mfma_f32_16x16x32_bf16 v[164:167], a[12:15], a[52:55], v[164:167]
  ds_read_b64_tr_b16 a[124:125], v19 offset:16384
  ds_read_b64_tr_b16 a[126:127], v19 offset:18432
  v_mfma_f32_16x16x32_bf16 v[168:171], a[12:15], a[56:59], v[168:171]
  v_mfma_f32_16x16x32_bf16 v[172:175], a[12:15], a[60:63], v[172:175]
  s_waitcnt lgkmcnt(6)
  ds_read_b128 a[92:95], v11 offset:14336
  v_mfma_f32_16x16x32_bf16 v[176:179], a[16:19], a[32:35], v[176:179]
  v_mfma_f32_16x16x32_bf16 v[180:183], a[16:19], a[36:39], v[180:183]
  v_mfma_f32_16x16x32_bf16 v[184:187], a[16:19], a[40:43], v[184:187]
  v_mfma_f32_16x16x32_bf16 v[188:191], a[16:19], a[44:47], v[188:191]
  v_mfma_f32_16x16x32_bf16 v[192:195], a[16:19], a[48:51], v[192:195]
  v_mfma_f32_16x16x32_bf16 v[196:199], a[16:19], a[52:55], v[196:199]
  v_mfma_f32_16x16x32_bf16 v[200:203], a[16:19], a[56:59], v[200:203]
  v_mfma_f32_16x16x32_bf16 v[204:207], a[16:19], a[60:63], v[204:207]
  v_mfma_f32_16x16x32_bf16 v[208:211], a[20:23], a[32:35], v[208:211]
  v_mfma_f32_16x16x32_bf16 v[212:215], a[20:23], a[36:39], v[212:215]
  v_mfma_f32_16x16x32_bf16 v[216:219], a[20:23], a[40:43], v[216:219]
  v_mfma_f32_16x16x32_bf16 v[220:223], a[20:23], a[44:47], v[220:223]
  v_mfma_f32_16x16x32_bf16 v[224:227], a[20:23], a[48:51], v[224:227]
  v_mfma_f32_16x16x32_bf16 v[228:231], a[20:23], a[52:55], v[228:231]
  v_mfma_f32_16x16x32_bf16 v[232:235], a[20:23], a[56:59], v[232:235]
  v_mfma_f32_16x16x32_bf16 v[236:239], a[20:23], a[60:63], v[236:239]
  v_mfma_f32_16x16x32_bf16 v[240:243], a[24:27], a[32:35], v[240:243]
  v_mfma_f32_16x16x32_bf16 v[244:247], a[24:27], a[36:39], v[244:247]
  v_mfma_f32_16x16x32_bf16 v[248:251], a[24:27], a[40:43], v[248:251]
  v_mfma_f32_16x16x32_bf16 v[252:255], a[24:27], a[44:47], v[252:255]
  v_mfma_f32_16x16x32_bf16 a[128:131], a[24:27], a[48:51], a[128:131]
  v_mfma_f32_16x16x32_bf16 a[132:135], a[24:27], a[52:55], a[132:135]
  v_mfma_f32_16x16x32_bf16 a[136:139], a[24:27], a[56:59], a[136:139]
  v_mfma_f32_16x16x32_bf16 a[140:143], a[24:27], a[60:63], a[140:143]
  v_mfma_f32_16x16x32_bf16 a[144:147], a[28:31], a[32:35], a[144:147]
  v_mfma_f32_16x16x32_bf16 a[148:151], a[28:31], a[36:39], a[148:151]
  v_mfma_f32_16x16x32_bf16 a[152:155], a[28:31], a[40:43], a[152:155]
  v_mfma_f32_16x16x32_bf16 a[156:159], a[28:31], a[44:47], a[156:159]
  v_mfma_f32_16x16x32_bf16 a[160:163], a[28:31], a[48:51], a[160:163]
  v_mfma_f32_16x16x32_bf16 a[164:167], a[28:31], a[52:55], a[164:167]
  v_mfma_f32_16x16x32_bf16 a[168:171], a[28:31], a[56:59], a[168:171]
  v_mfma_f32_16x16x32_bf16 a[172:175], a[28:31], a[60:63], a[172:175]
  s_waitcnt vmcnt(1) lgkmcnt(0)
  s_add_u32 m0, s57, 0
  s_barrier
  v_mfma_f32_16x16x32_bf16 v[48:51], a[64:67], a[96:99], v[48:51]
  buffer_load_dwordx4 v6, s[12:15], s52 offen offset:0 nt lds
  v_mfma_f32_16x16x32_bf16 v[52:55], a[64:67], a[100:103], v[52:55]
  ds_read_b64_tr_b16 a[32:33], v22 offset:0
  ds_read_b64_tr_b16 a[34:35], v22 offset:2048
  v_mfma_f32_16x16x32_bf16 v[56:59], a[64:67], a[104:107], v[56:59]
  v_mfma_f32_16x16x32_bf16 v[60:63], a[64:67], a[108:111], v[60:63]
  ds_read_b128 a[0:3], v20 offset:0
  v_mfma_f32_16x16x32_bf16 v[64:67], a[64:67], a[112:115], v[64:67]
  buffer_load_dwordx4 v7, s[12:15], s53 offen offset:1024 nt lds
  v_mfma_f32_16x16x32_bf16 v[68:71], a[64:67], a[116:119], v[68:71]
  s_waitcnt lgkmcnt(6)
  ds_read_b64_tr_b16 a[36:37], v23 offset:0
  ds_read_b64_tr_b16 a[38:39], v23 offset:2048
  v_mfma_f32_16x16x32_bf16 v[72:75], a[64:67], a[120:123], v[72:75]
  v_mfma_f32_16x16x32_bf16 v[76:79], a[64:67], a[124:127], v[76:79]
  ds_read_b128 a[4:7], v20 offset:2048
  v_mfma_f32_16x16x32_bf16 v[80:83], a[68:71], a[96:99], v[80:83]
  buffer_load_dwordx4 v6, s[12:15], s54 offen offset:2048 nt lds
  v_mfma_f32_16x16x32_bf16 v[84:87], a[68:71], a[100:103], v[84:87]
  ds_read_b64_tr_b16 a[40:41], v24 offset:0
  ds_read_b64_tr_b16 a[42:43], v24 offset:2048
  v_mfma_f32_16x16x32_bf16 v[88:91], a[68:71], a[104:107], v[88:91]
  v_mfma_f32_16x16x32_bf16 v[92:95], a[68:71], a[108:111], v[92:95]
  ds_read_b128 a[8:11], v20 offset:4096
  v_mfma_f32_16x16x32_bf16 v[96:99], a[68:71], a[112:115], v[96:99]
  buffer_load_dwordx4 v7, s[12:15], s55 offen offset:3072 nt lds
  v_mfma_f32_16x16x32_bf16 v[100:103], a[68:71], a[116:119], v[100:103]
  s_waitcnt lgkmcnt(6)
  ds_read_b64_tr_b16 a[44:45], v25 offset:0
  ds_read_b64_tr_b16 a[46:47], v25 offset:2048
  v_mfma_f32_16x16x32_bf16 v[104:107], a[68:71], a[120:123], v[104:107]
  v_mfma_f32_16x16x32_bf16 v[108:111], a[68:71], a[124:127], v[108:111]
  s_add_u32 m0, s57, 4096
  ds_read_b128 a[12:15], v20 offset:6144
  v_mfma_f32_16x16x32_bf16 v[112:115], a[72:75], a[96:99], v[112:115]
  buffer_load_dwordx4 v8, s[12:15], s52 offen offset:0 nt lds
  v_mfma_f32_16x16x32_bf16 v[116:119], a[72:75], a[100:103], v[116:119]
  ds_read_b64_tr_b16 a[48:49], v26 offset:0
  ds_read_b64_tr_b16 a[50:51], v26 offset:2048
  v_mfma_f32_16x16x32_bf16 v[120:123], a[72:75], a[104:107], v[120:123]
  v_mfma_f32_16x16x32_bf16 v[124:127], a[72:75], a[108:111], v[124:127]
  ds_read_b128 a[16:19], v20 offset:8192
  v_mfma_f32_16x16x32_bf16 v[128:131], a[72:75], a[112:115], v[128:131]
  buffer_load_dwordx4 v9, s[12:15], s53 offen offset:1024 nt lds
  v_mfma_f32_16x16x32_bf16 v[132:135], a[72:75], a[116:119], v[132:135]
  s_waitcnt lgkmcnt(6)
  ds_read_b64_tr_b16 a[52:53], v27 offset:0
  ds_read_b64_tr_b16 a[54:55], v27 offset:2048
  v_mfma_f32_16x16x32_bf16 v[136:139], a[72:75], a[120:123], v[136:139]
  v_mfma_f32_16x16x32_bf16 v[140:143], a[72:75], a[124:127], v[140:143]
  ds_read_b128 a[20:23], v20 offset:10240
  v_mfma_f32_16x16x32_bf16 v[144:147], a[76:79], a[96:99], v[144:147]
  buffer_load_dwordx4 v8, s[12:15], s54 offen offset:2048 nt lds
  v_mfma_f32_16x16x32_bf16 v[148:151], a[76:79], a[100:103], v[148:151]
  ds_read_b64_tr_b16 a[56:57], v28 offset:0
  ds_read_b64_tr_b16 a[58:59], v28 offset:2048
  v_mfma_f32_16x16x32_bf16 v[152:155], a[76:79], a[104:107], v[152:155]
  v_mfma_f32_16x16x32_bf16 v[156:159], a[76:79], a[108:111], v[156:159]
  ds_read_b128 a[24:27], v20 offset:12288
  v_mfma_f32_16x16x32_bf16 v[160:163], a[76:79], a[112:115], v[160:163]
  buffer_load_dwordx4 v9, s[12:15], s55 offen offset:3072 nt lds
  v_mfma_f32_16x16x32_bf16 v[164:167], a[76:79], a[116:119], v[164:167]
  s_waitcnt lgkmcnt(6)
  ds_read_b64_tr_b16 a[60:61], v29 offset:0
  ds_read_b64_tr_b16 a[62:63], v29 offset:2048
  v_mfma_f32_16x16x32_bf16 v[168:171], a[76:79], a[120:123], v[168:171]
  v_add_u32 v6, 524288, v6
  v_add_u32 v7, 524288, v7
  v_mfma_f32_16x16x32_bf16 v[172:175], a[76:79], a[124:127], v[172:175]
  s_add_u32 m0, s56, 0
  ds_read_b128 a[28:31], v20 offset:14336
  v_mfma_f32_16x16x32_bf16 v[176:179], a[80:83], a[96:99], v[176:179]
  buffer_load_dwordx4 v2, s[8:11], s48 offen offset:0 lds
  v_mfma_f32_16x16x32_bf16 v[180:183], a[80:83], a[100:103], v[180:183]
  v_add_u32 v8, 524288, v8
  v_add_u32 v9, 524288, v9
  v_mfma_f32_16x16x32_bf16 v[184:187], a[80:83], a[104:107], v[184:187]
  v_mfma_f32_16x16x32_bf16 v[188:191], a[80:83], a[108:111], v[188:191]
  v_mfma_f32_16x16x32_bf16 v[192:195], a[80:83], a[112:115], v[192:195]
  buffer_load_dwordx4 v3, s[8:11], s49 offen offset:1024 lds
  v_mfma_f32_16x16x32_bf16 v[196:199], a[80:83], a[116:119], v[196:199]
  v_mfma_f32_16x16x32_bf16 v[200:203], a[80:83], a[120:123], v[200:203]
  v_mfma_f32_16x16x32_bf16 v[204:207], a[80:83], a[124:127], v[204:207]
  v_mfma_f32_16x16x32_bf16 v[208:211], a[84:87], a[96:99], v[208:211]
  buffer_load_dwordx4 v2, s[8:11], s50 offen offset:2048 lds
  v_mfma_f32_16x16x32_bf16 v[212:215], a[84:87], a[100:103], v[212:215]
  v_mfma_f32_16x16x32_bf16 v[216:219], a[84:87], a[104:107], v[216:219]
  v_mfma_f32_16x16x32_bf16 v[220:223], a[84:87], a[108:111], v[220:223]
  v_mfma_f32_16x16x32_bf16 v[224:227], a[84:87], a[112:115], v[224:227]
  buffer_load_dwordx4 v3, s[8:11], s51 offen offset:3072 lds
  v_mfma_f32_16x16x32_bf16 v[228:231], a[84:87], a[116:119], v[228:231]
  v_mfma_f32_16x16x32_bf16 v[232:235], a[84:87], a[120:123], v[232:235]
  v_mfma_f32_16x16x32_bf16 v[236:239], a[84:87], a[124:127], v[236:239]
  s_add_u32 m0, s56, 4096
  v_mfma_f32_16x16x32_bf16 v[240:243], a[88:91], a[96:99], v[240:243]
  buffer_load_dwordx4 v4, s[8:11], s48 offen offset:0 lds
  v_mfma_f32_16x16x32_bf16 v[244:247], a[88:91], a[100:103], v[244:247]
  v_mfma_f32_16x16x32_bf16 v[248:251], a[88:91], a[104:107], v[248:251]
  v_mfma_f32_16x16x32_bf16 v[252:255], a[88:91], a[108:111], v[252:255]
  v_mfma_f32_16x16x32_bf16 a[128:131], a[88:91], a[112:115], a[128:131]
  buffer_load_dwordx4 v5, s[8:11], s49 offen offset:1024 lds
  v_mfma_f32_16x16x32_bf16 a[132:135], a[88:91], a[116:119], a[132:135]
  v_mfma_f32_16x16x32_bf16 a[136:139], a[88:91], a[120:123], a[136:139]
  v_mfma_f32_16x16x32_bf16 a[140:143], a[88:91], a[124:127], a[140:143]
  v_mfma_f32_16x16x32_bf16 a[144:147], a[92:95], a[96:99], a[144:147]
  buffer_load_dwordx4 v4, s[8:11], s50 offen offset:2048 lds
  v_mfma_f32_16x16x32_bf16 a[148:151], a[92:95], a[100:103], a[148:151]
  v_mfma_f32_16x16x32_bf16 a[152:155], a[92:95], a[104:107], a[152:155]
  v_mfma_f32_16x16x32_bf16 a[156:159], a[92:95], a[108:111], a[156:159]
  v_mfma_f32_16x16x32_bf16 a[160:163], a[92:95], a[112:115], a[160:163]
  buffer_load_dwordx4 v5, s[8:11], s51 offen offset:3072 lds
  v_mfma_f32_16x16x32_bf16 a[164:167], a[92:95], a[116:119], a[164:167]
  v_mfma_f32_16x16x32_bf16 a[168:171], a[92:95], a[120:123], a[168:171]
  buffer_load_dword v1, v47, s[60:63], 0 offen
  v_mfma_f32_16x16x32_bf16 a[172:175], a[92:95], a[124:127], a[172:175]
  v_add_u32 v2, 128, v2
  v_add_u32 v3, 128, v3
  v_add_u32 v4, 128, v4
  v_add_u32 v5, 128, v5
  v_add_u32 v47, s59, v47
  s_waitcnt lgkmcnt(0)
  v_mfma_f32_16x16x32_bf16 v[48:51], a[0:3], a[32:35], v[48:51]
  v_mfma_f32_16x16x32_bf16 v[52:55], a[0:3], a[36:39], v[52:55]
  ds_read_b64_tr_b16 a[96:97], v22 offset:16384
  ds_read_b64_tr_b16 a[98:99], v22 offset:18432
  v_mfma_f32_16x16x32_bf16 v[56:59], a[0:3], a[40:43], v[56:59]
  v_mfma_f32_16x16x32_bf16 v[60:63], a[0:3], a[44:47], v[60:63]
  ds_read_b128 a[64:67], v21 offset:0
  v_mfma_f32_16x16x32_bf16 v[64:67], a[0:3], a[48:51], v[64:67]
  v_mfma_f32_16x16x32_bf16 v[68:71], a[0:3], a[52:55], v[68:71]
  ds_read_b64_tr_b16 a[100:101], v23 offset:16384
  ds_read_b64_tr_b16 a[102:103], v23 offset:18432
  v_mfma_f32_16x16x32_bf16 v[72:75], a[0:3], a[56:59], v[72:75]
  v_mfma_f32_16x16x32_bf16 v[76:79], a[0:3], a[60:63], v[76:79]
  s_waitcnt lgkmcnt(6)
  ds_read_b128 a[68:71], v21 offset:2048
  v_mfma_f32_16x16x32_bf16 v[80:83], a[4:7], a[32:35], v[80:83]
  v_mfma_f32_16x16x32_bf16 v[84:87], a[4:7], a[36:39], v[84:87]
  ds_read_b64_tr_b16 a[104:105], v24 offset:16384
  ds_read_b64_tr_b16 a[106:107], v24 offset:18432
  v_mfma_f32_16x16x32_bf16 v[88:91], a[4:7], a[40:43], v[88:91]
  v_mfma_f32_16x16x32_bf16 v[92:95], a[4:7], a[44:47], v[92:95]
  ds_read_b128 a[72:75], v21 offset:4096
  v_mfma_f32_16x16x32_bf16 v[96:99], a[4:7], a[48:51], v[96:99]
  v_mfma_f32_16x16x32_bf16 v[100:103], a[4:7], a[52:55], v[100:103]
  ds_read_b64_tr_b16 a[108:109], v25 offset:16384
  ds_read_b64_tr_b16 a[110:111], v25 offset:18432
  v_mfma_f32_16x16x32_bf16 v[104:107], a[4:7], a[56:59], v[104:107]
  v_mfma_f32_16x16x32_bf16 v[108:111], a[4:7], a[60:63], v[108:111]
  s_waitcnt lgkmcnt(6)
  ds_read_b128 a[76:79], v21 offset:6144
  v_mfma_f32_16x16x32_bf16 v[112:115], a[8:11], a[32:35], v[112:115]
  v_mfma_f32_16x16x32_bf16 v[116:119], a[8:11], a[36:39], v[116:119]
  ds_read_b64_tr_b16 a[112:113], v26 offset:16384
  ds_read_b64_tr_b16 a[114:115], v26 offset:18432
  v_mfma_f32_16x16x32_bf16 v[120:123], a[8:11], a[40:43], v[120:123]
  v_mfma_f32_16x16x32_bf16 v[124:127], a[8:11], a[44:47], v[124:127]
  ds_read_b128 a[80:83], v21 offset:8192
  v_mfma_f32_16x16x32_bf16 v[128:131], a[8:11], a[48:51], v[128:131]
  v_mfma_f32_16x16x32_bf16 v[132:135], a[8:11], a[52:55], v[132:135]
  ds_read_b64_tr_b16 a[116:117], v27 offset:16384
  ds_read_b64_tr_b16 a[118:119], v27 offset:18432
  v_mfma_f32_16x16x32_bf16 v[136:139], a[8:11], a[56:59], v[136:139]
  v_mfma_f32_16x16x32_bf16 v[140:143], a[8:11], a[60:63], v[140:143]
  s_waitcnt lgkmcnt(6)
  ds_read_b128 a[84:87], v21 offset:10240
  v_mfma_f32_16x16x32_bf16 v[144:147], a[12:15], a[32:35], v[144:147]
  v_mfma_f32_16x16x32_bf16 v[148:151], a[12:15], a[36:39], v[148:151]
  ds_read_b64_tr_b16 a[120:121], v28 offset:16384
  ds_read_b64_tr_b16 a[122:123], v28 offset:18432
  v_mfma_f32_16x16x32_bf16 v[152:155], a[12:15], a[40:43], v[152:155]
  v_mfma_f32_16x16x32_bf16 v[156:159], a[12:15], a[44:47], v[156:159]
  ds_read_b128 a[88:91], v21 offset:12288
  v_mfma_f32_16x16x32_bf16 v[160:163], a[12:15], a[48:51], v[160:163]
  v_mfma_f32_16x16x32_bf16 v[164:167], a[12:15], a[52:55], v[164:167]
  ds_read_b64_tr_b16 a[124:125], v29 offset:16384
  ds_read_b64_tr_b16 a[126:127], v29 offset:18432
  v_mfma_f32_16x16x32_bf16 v[168:171], a[12:15], a[56:59], v[168:171]
  v_mfma_f32_16x16x32_bf16 v[172:175], a[12:15], a[60:63], v[172:175]
  s_waitcnt lgkmcnt(6)
  ds_read_b128 a[92:95], v21 offset:14336
  v_mfma_f32_16x16x32_bf16 v[176:179], a[16:19], a[32:35], v[176:179]
  v_mfma_f32_16x16x32_bf16 v[180:183], a[16:19], a[36:39], v[180:183]
  v_mfma_f32_16x16x32_bf16 v[184:187], a[16:19], a[40:43], v[184:187]
  v_mfma_f32_16x16x32_bf16 v[188:191], a[16:19], a[44:47], v[188:191]
  v_mfma_f32_16x16x32_bf16 v[192:195], a[16:19], a[48:51], v[192:195]
  v_mfma_f32_16x16x32_bf16 v[196:199], a[16:19], a[52:55], v[196:199]
  v_mfma_f32_16x16x32_bf16 v[200:203], a[16:19], a[56:59], v[200:203]
  v_mfma_f32_16x16x32_bf16 v[204:207], a[16:19], a[60:63], v[204:207]
  v_mfma_f32_16x16x32_bf16 v[208:211], a[20:23], a[32:35], v[208:211]
  v_mfma_f32_16x16x32_bf16 v[212:215], a[20:23], a[36:39], v[212:215]
  v_mfma_f32_16x16x32_bf16 v[216:219], a[20:23], a[40:43], v[216:219]
  v_mfma_f32_16x16x32_bf16 v[220:223], a[20:23], a[44:47], v[220:223]
  v_mfma_f32_16x16x32_bf16 v[224:227], a[20:23], a[48:51], v[224:227]
  v_mfma_f32_16x16x32_bf16 v[228:231], a[20:23], a[52:55], v[228:231]
  v_mfma_f32_16x16x32_bf16 v[232:235], a[20:23], a[56:59], v[232:235]
  v_mfma_f32_16x16x32_bf16 v[236:239], a[20:23], a[60:63], v[236:239]
  v_mfma_f32_16x16x32_bf16 v[240:243], a[24:27], a[32:35], v[240:243]
  v_mfma_f32_16x16x32_bf16 v[244:247], a[24:27], a[36:39], v[244:247]
  v_mfma_f32_16x16x32_bf16 v[248:251], a[24:27], a[40:43], v[248:251]
  v_mfma_f32_16x16x32_bf16 v[252:255], a[24:27], a[44:47], v[252:255]
  v_mfma_f32_16x16x32_bf16 a[128:131], a[24:27], a[48:51], a[128:131]
  v_mfma_f32_16x16x32_bf16 a[132:135], a[24:27], a[52:55], a[132:135]
  v_mfma_f32_16x16x32_bf16 a[136:139], a[24:27], a[56:59], a[136:139]
  v_mfma_f32_16x16x32_bf16 a[140:143], a[24:27], a[60:63], a[140:143]
  v_mfma_f32_16x16x32_bf16 a[144:147], a[28:31], a[32:35], a[144:147]
  v_mfma_f32_16x16x32_bf16 a[148:151], a[28:31], a[36:39], a[148:151]
  v_mfma_f32_16x16x32_bf16 a[152:155], a[28:31], a[40:43], a[152:155]
  v_mfma_f32_16x16x32_bf16 a[156:159], a[28:31], a[44:47], a[156:159]
  v_mfma_f32_16x16x32_bf16 a[160:163], a[28:31], a[48:51], a[160:163]
  v_mfma_f32_16x16x32_bf16 a[164:167], a[28:31], a[52:55], a[164:167]
  v_mfma_f32_16x16x32_bf16 a[168:171], a[28:31], a[56:59], a[168:171]
  v_mfma_f32_16x16x32_bf16 a[172:175], a[28:31], a[60:63], a[172:175]
  s_waitcnt vmcnt(1) lgkmcnt(0)
  s_add_u32 m0, s57, 65536
  s_barrier
  v_mfma_f32_16x16x32_bf16 v[48:51], a[64:67], a[96:99], v[48:51]
  buffer_load_dwordx4 v6, s[12:15], s52 offen offset:0 nt lds
  v_mfma_f32_16x16x32_bf16 v[52:55], a[64:67], a[100:103], v[52:55]
  ds_read_b64_tr_b16 a[32:33], v12 offset:0
  ds_read_b64_tr_b16 a[34:35], v12 offset:2048
  v_mfma_f32_16x16x32_bf16 v[56:59], a[64:67], a[104:107], v[56:59]
  v_mfma_f32_16x16x32_bf16 v[60:63], a[64:67], a[108:111], v[60:63]
  ds_read_b128 a[0:3], v10 offset:0
  v_mfma_f32_16x16x32_bf16 v[64:67], a[64:67], a[112:115], v[64:67]
  buffer_load_dwordx4 v7, s[12:15], s53 offen offset:1024 nt lds
  v_mfma_f32_16x16x32_bf16 v[68:71], a[64:67], a[116:119], v[68:71]
  s_waitcnt lgkmcnt(6)
  ds_read_b64_tr_b16 a[36:37], v13 offset:0
  ds_read_b64_tr_b16 a[38:39], v13 offset:2048
  v_mfma_f32_16x16x32_bf16 v[72:75], a[64:67], a[120:123], v[72:75]
  v_mfma_f32_16x16x32_bf16 v[76:79], a[64:67], a[124:127], v[76:79]
  ds_read_b128 a[4:7], v10 offset:2048
  v_mfma_f32_16x16x32_bf16 v[80:83], a[68:71], a[96:99], v[80:83]
  buffer_load_dwordx4 v6, s[12:15], s54 offen offset:2048 nt lds
  v_mfma_f32_16x16x32_bf16 v[84:87], a[68:71], a[100:103], v[84:87]
  ds_read_b64_tr_b16 a[40:41], v14 offset:0
  ds_read_b64_tr_b16 a[42:43], v14 offset:2048
  v_mfma_f32_16x16x32_bf16 v[88:91], a[68:71], a[104:107], v[88:91]
  v_mfma_f32_16x16x32_bf16 v[92:95], a[68:71], a[108:111], v[92:95]
  ds_read_b128 a[8:11], v10 offset:4096
  v_mfma_f32_16x16x32_bf16 v[96:99], a[68:71], a[112:115], v[96:99]
  buffer_load_dwordx4 v7, s[12:15], s55 offen offset:3072 nt lds
  v_mfma_f32_16x16x32_bf16 v[100:103], a[68:71], a[116:119], v[100:103]
  s_waitcnt lgkmcnt(6)
  ds_read_b64_tr_b16 a[44:45], v15 offset:0
  ds_read_b64_tr_b16 a[46:47], v15 offset:2048
  v_mfma_f32_16x16x32_bf16 v[104:107], a[68:71], a[120:123], v[104:107]
  v_mfma_f32_16x16x32_bf16 v[108:111], a[68:71], a[124:127], v[108:111]
  s_add_u32 m0, s57, 69632
  ds_read_b128 a[12:15], v10 offset:6144
  v_mfma_f32_16x16x32_bf16 v[112:115], a[72:75], a[96:99], v[112:115]
  buffer_load_dwordx4 v8, s[12:15], s52 offen offset:0 nt lds
  v_mfma_f32_16x16x32_bf16 v[116:119], a[72:75], a[100:103], v[116:119]
  ds_read_b64_tr_b16 a[48:49], v16 offset:0
  ds_read_b64_tr_b16 a[50:51], v16 offset:2048
  v_mfma_f32_16x16x32_bf16 v[120:123], a[72:75], a[104:107], v[120:123]
  v_mfma_f32_16x16x32_bf16 v[124:127], a[72:75], a[108:111], v[124:127]
  ds_read_b128 a[16:19], v10 offset:8192
  v_mfma_f32_16x16x32_bf16 v[128:131], a[72:75], a[112:115], v[128:131]
  buffer_load_dwordx4 v9, s[12:15], s53 offen offset:1024 nt lds
  v_mfma_f32_16x16x32_bf16 v[132:135], a[72:75], a[116:119], v[132:135]
  s_waitcnt lgkmcnt(6)
  ds_read_b64_tr_b16 a[52:53], v17 offset:0
  ds_read_b64_tr_b16 a[54:55], v17 offset:2048
  v_mfma_f32_16x16x32_bf16 v[136:139], a[72:75], a[120:123], v[136:139]
  v_mfma_f32_16x16x32_bf16 v[140:143], a[72:75], a[124:127], v[140:143]
  ds_read_b128 a[20:23], v10 offset:10240
  v_mfma_f32_16x16x32_bf16 v[144:147], a[76:79], a[96:99], v[144:147]
  buffer_load_dwordx4 v8, s[12:15], s54 offen offset:2048 nt lds
  v_mfma_f32_16x16x32_bf16 v[148:151], a[76:79], a[100:103], v[148:151]
  ds_read_b64_tr_b16 a[56:57], v18 offset:0
  ds_read_b64_tr_b16 a[58:59], v18 offset:2048
  v_mfma_f32_16x16x32_bf16 v[152:155], a[76:79], a[104:107], v[152:155]
  v_mfma_f32_16x16x32_bf16 v[156:159], a[76:79], a[108:111], v[156:159]
  ds_read_b128 a[24:27], v10 offset:12288
  v_mfma_f32_16x16x32_bf16 v[160:163], a[76:79], a[112:115], v[160:163]
  buffer_load_dwordx4 v9, s[12:15], s55 offen offset:3072 nt lds
  v_mfma_f32_16x16x32_bf16 v[164:167], a[76:79], a[116:119], v[164:167]
  s_waitcnt lgkmcnt(6)
  ds_read_b64_tr_b16 a[60:61], v19 offset:0
  ds_read_b64_tr_b16 a[62:63], v19 offset:2048
  v_mfma_f32_16x16x32_bf16 v[168:171], a[76:79], a[120:123], v[168:171]
  v_add_u32 v6, 524288, v6
  v_add_u32 v7, 524288, v7
  v_mfma_f32_16x16x32_bf16 v[172:175], a[76:79], a[124:127], v[172:175]
  s_add_u32 m0, s56, 65536
  ds_read_b128 a[28:31], v10 offset:14336
  v_mfma_f32_16x16x32_bf16 v[176:179], a[80:83], a[96:99], v[176:179]
  buffer_load_dwordx4 v2, s[8:11], s48 offen offset:0 lds
  v_mfma_f32_16x16x32_bf16 v[180:183], a[80:83], a[100:103], v[180:183]
  v_add_u32 v8, 524288, v8
  v_add_u32 v9, 524288, v9
  v_mfma_f32_16x16x32_bf16 v[184:187], a[80:83], a[104:107], v[184:187]
  v_mfma_f32_16x16x32_bf16 v[188:191], a[80:83], a[108:111], v[188:191]
  v_mfma_f32_16x16x32_bf16 v[192:195], a[80:83], a[112:115], v[192:195]
  buffer_load_dwordx4 v3, s[8:11], s49 offen offset:1024 lds
  v_mfma_f32_16x16x32_bf16 v[196:199], a[80:83], a[116:119], v[196:199]
  v_mfma_f32_16x16x32_bf16 v[200:203], a[80:83], a[120:123], v[200:203]
  v_mfma_f32_16x16x32_bf16 v[204:207], a[80:83], a[124:127], v[204:207]
  v_mfma_f32_16x16x32_bf16 v[208:211], a[84:87], a[96:99], v[208:211]
  buffer_load_dwordx4 v2, s[8:11], s50 offen offset:2048 lds
  v_mfma_f32_16x16x32_bf16 v[212:215], a[84:87], a[100:103], v[212:215]
  v_mfma_f32_16x16x32_bf16 v[216:219], a[84:87], a[104:107], v[216:219]
  v_mfma_f32_16x16x32_bf16 v[220:223], a[84:87], a[108:111], v[220:223]
  v_mfma_f32_16x16x32_bf16 v[224:227], a[84:87], a[112:115], v[224:227]
  buffer_load_dwordx4 v3, s[8:11], s51 offen offset:3072 lds
  v_mfma_f32_16x16x32_bf16 v[228:231], a[84:87], a[116:119], v[228:231]
  v_mfma_f32_16x16x32_bf16 v[232:235], a[84:87], a[120:123], v[232:235]
  v_mfma_f32_16x16x32_bf16 v[236:239], a[84:87], a[124:127], v[236:239]
  s_add_u32 m0, s56, 69632
  v_mfma_f32_16x16x32_bf16 v[240:243], a[88:91], a[96:99], v[240:243]
  buffer_load_dwordx4 v4, s[8:11], s48 offen offset:0 lds
  v_mfma_f32_16x16x32_bf16 v[244:247], a[88:91], a[100:103], v[244:247]
  v_mfma_f32_16x16x32_bf16 v[248:251], a[88:91], a[104:107], v[248:251]
  v_mfma_f32_16x16x32_bf16 v[252:255], a[88:91], a[108:111], v[252:255]
  v_mfma_f32_16x16x32_bf16 a[128:131], a[88:91], a[112:115], a[128:131]
  buffer_load_dwordx4 v5, s[8:11], s49 offen offset:1024 lds
  v_mfma_f32_16x16x32_bf16 a[132:135], a[88:91], a[116:119], a[132:135]
  v_mfma_f32_16x16x32_bf16 a[136:139], a[88:91], a[120:123], a[136:139]
  v_mfma_f32_16x16x32_bf16 a[140:143], a[88:91], a[124:127], a[140:143]
  v_mfma_f32_16x16x32_bf16 a[144:147], a[92:95], a[96:99], a[144:147]
  buffer_load_dwordx4 v4, s[8:11], s50 offen offset:2048 lds
  v_mfma_f32_16x16x32_bf16 a[148:151], a[92:95], a[100:103], a[148:151]
  v_mfma_f32_16x16x32_bf16 a[152:155], a[92:95], a[104:107], a[152:155]
  v_mfma_f32_16x16x32_bf16 a[156:159], a[92:95], a[108:111], a[156:159]
  v_mfma_f32_16x16x32_bf16 a[160:163], a[92:95], a[112:115], a[160:163]
  buffer_load_dwordx4 v5, s[8:11], s51 offen offset:3072 lds
  v_mfma_f32_16x16x32_bf16 a[164:167], a[92:95], a[116:119], a[164:167]
  v_mfma_f32_16x16x32_bf16 a[168:171], a[92:95], a[120:123], a[168:171]
  buffer_load_dword v1, v47, s[60:63], 0 offen
  v_mfma_f32_16x16x32_bf16 a[172:175], a[92:95], a[124:127], a[172:175]
  v_add_u32 v2, 128, v2
  v_add_u32 v3, 128, v3
  v_add_u32 v4, 128, v4
  v_add_u32 v5, 128, v5
  v_add_u32 v47, s59, v47
  s_sub_u32 s58, s58, 1
  s_cmp_lg_u32 s58, 0
  s_cbranch_scc1 L_kv_kernel_loop2
  s_waitcnt lgkmcnt(0)
  v_mfma_f32_16x16x32_bf16 v[48:51], a[0:3], a[32:35], v[48:51]
  v_mfma_f32_16x16x32_bf16 v[52:55], a[0:3], a[36:39], v[52:55]
  ds_read_b64_tr_b16 a[96:97], v12 offset:16384
  ds_read_b64_tr_b16 a[98:99], v12 offset:18432
  v_mfma_f32_16x16x32_bf16 v[56:59], a[0:3], a[40:43], v[56:59]
  v_mfma_f32_16x16x32_bf16 v[60:63], a[0:3], a[44:47], v[60:63]
  ds_read_b128 a[64:67], v11 offset:0
  v_mfma_f32_16x16x32_bf16 v[64:67], a[0:3], a[48:51], v[64:67]
  v_mfma_f32_16x16x32_bf16 v[68:71], a[0:3], a[52:55], v[68:71]
  ds_read_b64_tr_b16 a[100:101], v13 offset:16384
  ds_read_b64_tr_b16 a[102:103], v13 offset:18432
  v_mfma_f32_16x16x32_bf16 v[72:75], a[0:3], a[56:59], v[72:75]
  v_mfma_f32_16x16x32_bf16 v[76:79], a[0:3], a[60:63], v[76:79]
  s_waitcnt lgkmcnt(6)
  ds_read_b128 a[68:71], v11 offset:2048
  v_mfma_f32_16x16x32_bf16 v[80:83], a[4:7], a[32:35], v[80:83]
  v_mfma_f32_16x16x32_bf16 v[84:87], a[4:7], a[36:39], v[84:87]
  ds_read_b64_tr_b16 a[104:105], v14 offset:16384
  ds_read_b64_tr_b16 a[106:107], v14 offset:18432
  v_mfma_f32_16x16x32_bf16 v[88:91], a[4:7], a[40:43], v[88:91]
  v_mfma_f32_16x16x32_bf16 v[92:95], a[4:7], a[44:47], v[92:95]
  ds_read_b128 a[72:75], v11 offset:4096
  v_mfma_f32_16x16x32_bf16 v[96:99], a[4:7], a[48:51], v[96:99]
  v_mfma_f32_16x16x32_bf16 v[100:103], a[4:7], a[52:55], v[100:103]
  ds_read_b64_tr_b16 a[108:109], v15 offset:16384
  ds_read_b64_tr_b16 a[110:111], v15 offset:18432
  v_mfma_f32_16x16x32_bf16 v[104:107], a[4:7], a[56:59], v[104:107]
  v_mfma_f32_16x16x32_bf16 v[108:111], a[4:7], a[60:63], v[108:111]
  s_waitcnt lgkmcnt(6)
  ds_read_b128 a[76:79], v11 offset:6144
  v_mfma_f32_16x16x32_bf16 v[112:115], a[8:11], a[32:35], v[112:115]
  v_mfma_f32_16x16x32_bf16 v[116:119], a[8:11], a[36:39], v[116:119]
  ds_read_b64_tr_b16 a[112:113], v16 offset:16384
  ds_read_b64_tr_b16 a[114:115], v16 offset:18432
  v_mfma_f32_16x16x32_bf16 v[120:123], a[8:11], a[40:43], v[120:123]
  v_mfma_f32_16x16x32_bf16 v[124:127], a[8:11], a[44:47], v[124:127]
  ds_read_b128 a[80:83], v11 offset:8192
  v_mfma_f32_16x16x32_bf16 v[128:131], a[8:11], a[48:51], v[128:131]
  v_mfma_f32_16x16x32_bf16 v[132:135], a[8:11], a[52:55], v[132:135]
  ds_read_b64_tr_b16 a[116:117], v17 offset:16384
  ds_read_b64_tr_b16 a[118:119], v17 offset:18432
  v_mfma_f32_16x16x32_bf16 v[136:139], a[8:11], a[56:59], v[136:139]
  v_mfma_f32_16x16x32_bf16 v[140:143], a[8:11], a[60:63], v[140:143]
  s_waitcnt lgkmcnt(6)
  ds_read_b128 a[84:87], v11 offset:10240
  v_mfma_f32_16x16x32_bf16 v[144:147], a[12:15], a[32:35], v[144:147]
  v_mfma_f32_16x16x32_bf16 v[148:151], a[12:15], a[36:39], v[148:151]
  ds_read_b64_tr_b16 a[120:121], v18 offset:16384
  ds_read_b64_tr_b16 a[122:123], v18 offset:18432
  v_mfma_f32_16x16x32_bf16 v[152:155], a[12:15], a[40:43], v[152:155]
  v_mfma_f32_16x16x32_bf16 v[156:159], a[12:15], a[44:47], v[156:159]
  ds_read_b128 a[88:91], v11 offset:12288
  v_mfma_f32_16x16x32_bf16 v[160:163], a[12:15], a[48:51], v[160:163]
  v_mfma_f32_16x16x32_bf16 v[164:167], a[12:15], a[52:55], v[164:167]
  ds_read_b64_tr_b16 a[124:125], v19 offset:16384
  ds_read_b64_tr_b16 a[126:127], v19 offset:18432
  v_mfma_f32_16x16x32_bf16 v[168:171], a[12:15], a[56:59], v[168:171]
  v_mfma_f32_16x16x32_bf16 v[172:175], a[12:15], a[60:63], v[172:175]
  s_waitcnt lgkmcnt(6)
  ds_read_b128 a[92:95], v11 offset:14336
  v_mfma_f32_16x16x32_bf16 v[176:179], a[16:19], a[32:35], v[176:179]
  v_mfma_f32_16x16x32_bf16 v[180:183], a[16:19], a[36:39], v[180:183]
  v_mfma_f32_16x16x32_bf16 v[184:187], a[16:19], a[40:43], v[184:187]
  v_mfma_f32_16x16x32_bf16 v[188:191], a[16:19], a[44:47], v[188:191]
  v_mfma_f32_16x16x32_bf16 v[192:195], a[16:19], a[48:51], v[192:195]
  v_mfma_f32_16x16x32_bf16 v[196:199], a[16:19], a[52:55], v[196:199]
  v_mfma_f32_16x16x32_bf16 v[200:203], a[16:19], a[56:59], v[200:203]
  v_mfma_f32_16x16x32_bf16 v[204:207], a[16:19], a[60:63], v[204:207]
  v_mfma_f32_16x16x32_bf16 v[208:211], a[20:23], a[32:35], v[208:211]
  v_mfma_f32_16x16x32_bf16 v[212:215], a[20:23], a[36:39], v[212:215]
  v_mfma_f32_16x16x32_bf16 v[216:219], a[20:23], a[40:43], v[216:219]
  v_mfma_f32_16x16x32_bf16 v[220:223], a[20:23], a[44:47], v[220:223]
  v_mfma_f32_16x16x32_bf16 v[224:227], a[20:23], a[48:51], v[224:227]
  v_mfma_f32_16x16x32_bf16 v[228:231], a[20:23], a[52:55], v[228:231]
  v_mfma_f32_16x16x32_bf16 v[232:235], a[20:23], a[56:59], v[232:235]
  v_mfma_f32_16x16x32_bf16 v[236:239], a[20:23], a[60:63], v[236:239]
  v_mfma_f32_16x16x32_bf16 v[240:243], a[24:27], a[32:35], v[240:243]
  v_mfma_f32_16x16x32_bf16 v[244:247], a[24:27], a[36:39], v[244:247]
  v_mfma_f32_16x16x32_bf16 v[248:251], a[24:27], a[40:43], v[248:251]
  v_mfma_f32_16x16x32_bf16 v[252:255], a[24:27], a[44:47], v[252:255]
  v_mfma_f32_16x16x32_bf16 a[128:131], a[24:27], a[48:51], a[128:131]
  v_mfma_f32_16x16x32_bf16 a[132:135], a[24:27], a[52:55], a[132:135]
  v_mfma_f32_16x16x32_bf16 a[136:139], a[24:27], a[56:59], a[136:139]
  v_mfma_f32_16x16x32_bf16 a[140:143], a[24:27], a[60:63], a[140:143]
  v_mfma_f32_16x16x32_bf16 a[144:147], a[28:31], a[32:35], a[144:147]
  v_mfma_f32_16x16x32_bf16 a[148:151], a[28:31], a[36:39], a[148:151]
  v_mfma_f32_16x16x32_bf16 a[152:155], a[28:31], a[40:43], a[152:155]
  v_mfma_f32_16x16x32_bf16 a[156:159], a[28:31], a[44:47], a[156:159]
  v_mfma_f32_16x16x32_bf16 a[160:163], a[28:31], a[48:51], a[160:163]
  v_mfma_f32_16x16x32_bf16 a[164:167], a[28:31], a[52:55], a[164:167]
  v_mfma_f32_16x16x32_bf16 a[168:171], a[28:31], a[56:59], a[168:171]
  v_mfma_f32_16x16x32_bf16 a[172:175], a[28:31], a[60:63], a[172:175]
  s_waitcnt vmcnt(1) lgkmcnt(0)
  s_barrier
  v_mfma_f32_16x16x32_bf16 v[48:51], a[64:67], a[96:99], v[48:51]
  v_mfma_f32_16x16x32_bf16 v[52:55], a[64:67], a[100:103], v[52:55]
  ds_read_b64_tr_b16 a[32:33], v22 offset:0
  ds_read_b64_tr_b16 a[34:35], v22 offset:2048
  v_mfma_f32_16x16x32_bf16 v[56:59], a[64:67], a[104:107], v[56:59]
  v_mfma_f32_16x16x32_bf16 v[60:63], a[64:67], a[108:111], v[60:63]
  ds_read_b128 a[0:3], v20 offset:0
  v_mfma_f32_16x16x32_bf16 v[64:67], a[64:67], a[112:115], v[64:67]
  v_mfma_f32_16x16x32_bf16 v[68:71], a[64:67], a[116:119], v[68:71]
  ds_read_b64_tr_b16 a[36:37], v23 offset:0
  ds_read_b64_tr_b16 a[38:39], v23 offset:2048
  v_mfma_f32_16x16x32_bf16 v[72:75], a[64:67], a[120:123], v[72:75]
  v_mfma_f32_16x16x32_bf16 v[76:79], a[64:67], a[124:127], v[76:79]
  s_waitcnt lgkmcnt(6)
  ds_read_b128 a[4:7], v20 offset:2048
  v_mfma_f32_16x16x32_bf16 v[80:83], a[68:71], a[96:99], v[80:83]
  v_mfma_f32_16x16x32_bf16 v[84:87], a[68:71], a[100:103], v[84:87]
  ds_read_b64_tr_b16 a[40:41], v24 offset:0
  ds_read_b64_tr_b16 a[42:43], v24 offset:2048
  v_mfma_f32_16x16x32_bf16 v[88:91], a[68:71], a[104:107], v[88:91]
  v_mfma_f32_16x16x32_bf16 v[92:95], a[68:71], a[108:111], v[92:95]
  ds_read_b128 a[8:11], v20 offset:4096
  v_mfma_f32_16x16x32_bf16 v[96:99], a[68:71], a[112:115], v[96:99]
  v_mfma_f32_16x16x32_bf16 v[100:103], a[68:71], a[116:119], v[100:103]
  ds_read_b64_tr_b16 a[44:45], v25 offset:0
  ds_read_b64_tr_b16 a[46:47], v25 offset:2048
  v_mfma_f32_16x16x32_bf16 v[104:107], a[68:71], a[120:123], v[104:107]
  v_mfma_f32_16x16x32_bf16 v[108:111], a[68:71], a[124:127], v[108:111]
  s_waitcnt lgkmcnt(6)
  ds_read_b128 a[12:15], v20 offset:6144
  v_mfma_f32_16x16x32_bf16 v[112:115], a[72:75], a[96:99], v[112:115]
  v_mfma_f32_16x16x32_bf16 v[116:119], a[72:75], a[100:103], v[116:119]
  ds_read_b64_tr_b16 a[48:49], v26 offset:0
  ds_read_b64_tr_b16 a[50:51], v26 offset:2048
  v_mfma_f32_16x16x32_bf16 v[120:123], a[72:75], a[104:107], v[120:123]
  v_mfma_f32_16x16x32_bf16 v[124:127], a[72:75], a[108:111], v[124:127]
  ds_read_b128 a[16:19], v20 offset:8192
  v_mfma_f32_16x16x32_bf16 v[128:131], a[72:75], a[112:115], v[128:131]
  v_mfma_f32_16x16x32_bf16 v[132:135], a[72:75], a[116:119], v[132:135]
  ds_read_b64_tr_b16 a[52:53], v27 offset:0
  ds_read_b64_tr_b16 a[54:55], v27 offset:2048
  v_mfma_f32_16x16x32_bf16 v[136:139], a[72:75], a[120:123], v[136:139]
  v_mfma_f32_16x16x32_bf16 v[140:143], a[72:75], a[124:127], v[140:143]
  s_waitcnt lgkmcnt(6)
  ds_read_b128 a[20:23], v20 offset:10240
  v_mfma_f32_16x16x32_bf16 v[144:147], a[76:79], a[96:99], v[144:147]
  v_mfma_f32_16x16x32_bf16 v[148:151], a[76:79], a[100:103], v[148:151]
  ds_read_b64_tr_b16 a[56:57], v28 offset:0
  ds_read_b64_tr_b16 a[58:59], v28 offset:2048
  v_mfma_f32_16x16x32_bf16 v[152:155], a[76:79], a[104:107], v[152:155]
  v_mfma_f32_16x16x32_bf16 v[156:159], a[76:79], a[108:111], v[156:159]
  ds_read_b128 a[24:27], v20 offset:12288
  v_mfma_f32_16x16x32_bf16 v[160:163], a[76:79], a[112:115], v[160:163]
  v_mfma_f32_16x16x32_bf16 v[164:167], a[76:79], a[116:119], v[164:167]
  ds_read_b64_tr_b16 a[60:61], v29 offset:0
  ds_read_b64_tr_b16 a[62:63], v29 offset:2048
  v_mfma_f32_16x16x32_bf16 v[168:171], a[76:79], a[120:123], v[168:171]
  v_mfma_f32_16x16x32_bf16 v[172:175], a[76:79], a[124:127], v[172:175]
  s_waitcnt lgkmcnt(6)
  ds_read_b128 a[28:31], v20 offset:14336
  v_mfma_f32_16x16x32_bf16 v[176:179], a[80:83], a[96:99], v[176:179]
  v_mfma_f32_16x16x32_bf16 v[180:183], a[80:83], a[100:103], v[180:183]
  v_mfma_f32_16x16x32_bf16 v[184:187], a[80:83], a[104:107], v[184:187]
  v_mfma_f32_16x16x32_bf16 v[188:191], a[80:83], a[108:111], v[188:191]
  v_mfma_f32_16x16x32_bf16 v[192:195], a[80:83], a[112:115], v[192:195]
  v_mfma_f32_16x16x32_bf16 v[196:199], a[80:83], a[116:119], v[196:199]
  v_mfma_f32_16x16x32_bf16 v[200:203], a[80:83], a[120:123], v[200:203]
  v_mfma_f32_16x16x32_bf16 v[204:207], a[80:83], a[124:127], v[204:207]
  v_mfma_f32_16x16x32_bf16 v[208:211], a[84:87], a[96:99], v[208:211]
  v_mfma_f32_16x16x32_bf16 v[212:215], a[84:87], a[100:103], v[212:215]
  v_mfma_f32_16x16x32_bf16 v[216:219], a[84:87], a[104:107], v[216:219]
  v_mfma_f32_16x16x32_bf16 v[220:223], a[84:87], a[108:111], v[220:223]
  v_mfma_f32_16x16x32_bf16 v[224:227], a[84:87], a[112:115], v[224:227]
  v_mfma_f32_16x16x32_bf16 v[228:231], a[84:87], a[116:119], v[228:231]
  v_mfma_f32_16x16x32_bf16 v[232:235], a[84:87], a[120:123], v[232:235]
  v_mfma_f32_16x16x32_bf16 v[236:239], a[84:87], a[124:127], v[236:239]
  v_mfma_f32_16x16x32_bf16 v[240:243], a[88:91], a[96:99], v[240:243]
  v_mfma_f32_16x16x32_bf16 v[244:247], a[88:91], a[100:103], v[244:247]
  v_mfma_f32_16x16x32_bf16 v[248:251], a[88:91], a[104:107], v[248:251]
  v_mfma_f32_16x16x32_bf16 v[252:255], a[88:91], a[108:111], v[252:255]
  v_mfma_f32_16x16x32_bf16 a[128:131], a[88:91], a[112:115], a[128:131]
  v_mfma_f32_16x16x32_bf16 a[132:135], a[88:91], a[116:119], a[132:135]
  v_mfma_f32_16x16x32_bf16 a[136:139], a[88:91], a[120:123], a[136:139]
  v_mfma_f32_16x16x32_bf16 a[140:143], a[88:91], a[124:127], a[140:143]
  v_mfma_f32_16x16x32_bf16 a[144:147], a[92:95], a[96:99], a[144:147]
  v_mfma_f32_16x16x32_bf16 a[148:151], a[92:95], a[100:103], a[148:151]
  v_mfma_f32_16x16x32_bf16 a[152:155], a[92:95], a[104:107], a[152:155]
  v_mfma_f32_16x16x32_bf16 a[156:159], a[92:95], a[108:111], a[156:159]
  v_mfma_f32_16x16x32_bf16 a[160:163], a[92:95], a[112:115], a[160:163]
  v_mfma_f32_16x16x32_bf16 a[164:167], a[92:95], a[116:119], a[164:167]
  v_mfma_f32_16x16x32_bf16 a[168:171], a[92:95], a[120:123], a[168:171]
  v_mfma_f32_16x16x32_bf16 a[172:175], a[92:95], a[124:127], a[172:175]
  s_waitcnt lgkmcnt(0)
  v_mfma_f32_16x16x32_bf16 v[48:51], a[0:3], a[32:35], v[48:51]
  v_mfma_f32_16x16x32_bf16 v[52:55], a[0:3], a[36:39], v[52:55]
  ds_read_b64_tr_b16 a[96:97], v22 offset:16384
  ds_read_b64_tr_b16 a[98:99], v22 offset:18432
  v_mfma_f32_16x16x32_bf16 v[56:59], a[0:3], a[40:43], v[56:59]
  v_mfma_f32_16x16x32_bf16 v[60:63], a[0:3], a[44:47], v[60:63]
  ds_read_b128 a[64:67], v21 offset:0
  v_mfma_f32_16x16x32_bf16 v[64:67], a[0:3], a[48:51], v[64:67]
  v_mfma_f32_16x16x32_bf16 v[68:71], a[0:3], a[52:55], v[68:71]
  ds_read_b64_tr_b16 a[100:101], v23 offset:16384
  ds_read_b64_tr_b16 a[102:103], v23 offset:18432
  v_mfma_f32_16x16x32_bf16 v[72:75], a[0:3], a[56:59], v[72:75]
  v_mfma_f32_16x16x32_bf16 v[76:79], a[0:3], a[60:63], v[76:79]
  s_waitcnt lgkmcnt(6)
  ds_read_b128 a[68:71], v21 offset:2048
  v_mfma_f32_16x16x32_bf16 v[80:83], a[4:7], a[32:35], v[80:83]
  v_mfma_f32_16x16x32_bf16 v[84:87], a[4:7], a[36:39], v[84:87]
  ds_read_b64_tr_b16 a[104:105], v24 offset:16384
  ds_read_b64_tr_b16 a[106:107], v24 offset:18432
  v_mfma_f32_16x16x32_bf16 v[88:91], a[4:7], a[40:43], v[88:91]
  v_mfma_f32_16x16x32_bf16 v[92:95], a[4:7], a[44:47], v[92:95]
  ds_read_b128 a[72:75], v21 offset:4096
  v_mfma_f32_16x16x32_bf16 v[96:99], a[4:7], a[48:51], v[96:99]
  v_mfma_f32_16x16x32_bf16 v[100:103], a[4:7], a[52:55], v[100:103]
  ds_read_b64_tr_b16 a[108:109], v25 offset:16384
  ds_read_b64_tr_b16 a[110:111], v25 offset:18432
  v_mfma_f32_16x16x32_bf16 v[104:107], a[4:7], a[56:59], v[104:107]
  v_mfma_f32_16x16x32_bf16 v[108:111], a[4:7], a[60:63], v[108:111]
  s_waitcnt lgkmcnt(6)
  ds_read_b128 a[76:79], v21 offset:6144
  v_mfma_f32_16x16x32_bf16 v[112:115], a[8:11], a[32:35], v[112:115]
  v_mfma_f32_16x16x32_bf16 v[116:119], a[8:11], a[36:39], v[116:119]
  ds_read_b64_tr_b16 a[112:113], v26 offset:16384
  ds_read_b64_tr_b16 a[114:115], v26 offset:18432
  v_mfma_f32_16x16x32_bf16 v[120:123], a[8:11], a[40:43], v[120:123]
  v_mfma_f32_16x16x32_bf16 v[124:127], a[8:11], a[44:47], v[124:127]
  ds_read_b128 a[80:83], v21 offset:8192
  v_mfma_f32_16x16x32_bf16 v[128:131], a[8:11], a[48:51], v[128:131]
  v_mfma_f32_16x16x32_bf16 v[132:135], a[8:11], a[52:55], v[132:135]
  ds_read_b64_tr_b16 a[116:117], v27 offset:16384
  ds_read_b64_tr_b16 a[118:119], v27 offset:18432
  v_mfma_f32_16x16x32_bf16 v[136:139], a[8:11], a[56:59], v[136:139]
  v_mfma_f32_16x16x32_bf16 v[140:143], a[8:11], a[60:63], v[140:143]
  s_waitcnt lgkmcnt(6)
  ds_read_b128 a[84:87], v21 offset:10240
  v_mfma_f32_16x16x32_bf16 v[144:147], a[12:15], a[32:35], v[144:147]
  v_mfma_f32_16x16x32_bf16 v[148:151], a[12:15], a[36:39], v[148:151]
  ds_read_b64_tr_b16 a[120:121], v28 offset:16384
  ds_read_b64_tr_b16 a[122:123], v28 offset:18432
  v_mfma_f32_16x16x32_bf16 v[152:155], a[12:15], a[40:43], v[152:155]
  v_mfma_f32_16x16x32_bf16 v[156:159], a[12:15], a[44:47], v[156:159]
  ds_read_b128 a[88:91], v21 offset:12288
  v_mfma_f32_16x16x32_bf16 v[160:163], a[12:15], a[48:51], v[160:163]
  v_mfma_f32_16x16x32_bf16 v[164:167], a[12:15], a[52:55], v[164:167]
  ds_read_b64_tr_b16 a[124:125], v29 offset:16384
  ds_read_b64_tr_b16 a[126:127], v29 offset:18432
  v_mfma_f32_16x16x32_bf16 v[168:171], a[12:15], a[56:59], v[168:171]
  v_mfma_f32_16x16x32_bf16 v[172:175], a[12:15], a[60:63], v[172:175]
  s_waitcnt lgkmcnt(6)
  ds_read_b128 a[92:95], v21 offset:14336
  v_mfma_f32_16x16x32_bf16 v[176:179], a[16:19], a[32:35], v[176:179]
  v_mfma_f32_16x16x32_bf16 v[180:183], a[16:19], a[36:39], v[180:183]
  v_mfma_f32_16x16x32_bf16 v[184:187], a[16:19], a[40:43], v[184:187]
  v_mfma_f32_16x16x32_bf16 v[188:191], a[16:19], a[44:47], v[188:191]
  v_mfma_f32_16x16x32_bf16 v[192:195], a[16:19], a[48:51], v[192:195]
  v_mfma_f32_16x16x32_bf16 v[196:199], a[16:19], a[52:55], v[196:199]
  v_mfma_f32_16x16x32_bf16 v[200:203], a[16:19], a[56:59], v[200:203]
  v_mfma_f32_16x16x32_bf16 v[204:207], a[16:19], a[60:63], v[204:207]
  v_mfma_f32_16x16x32_bf16 v[208:211], a[20:23], a[32:35], v[208:211]
  v_mfma_f32_16x16x32_bf16 v[212:215], a[20:23], a[36:39], v[212:215]
  v_mfma_f32_16x16x32_bf16 v[216:219], a[20:23], a[40:43], v[216:219]
  v_mfma_f32_16x16x32_bf16 v[220:223], a[20:23], a[44:47], v[220:223]
  v_mfma_f32_16x16x32_bf16 v[224:227], a[20:23], a[48:51], v[224:227]
  v_mfma_f32_16x16x32_bf16 v[228:231], a[20:23], a[52:55], v[228:231]
  v_mfma_f32_16x16x32_bf16 v[232:235], a[20:23], a[56:59], v[232:235]
  v_mfma_f32_16x16x32_bf16 v[236:239], a[20:23], a[60:63], v[236:239]
  v_mfma_f32_16x16x32_bf16 v[240:243], a[24:27], a[32:35], v[240:243]
  v_mfma_f32_16x16x32_bf16 v[244:247], a[24:27], a[36:39], v[244:247]
  v_mfma_f32_16x16x32_bf16 v[248:251], a[24:27], a[40:43], v[248:251]
  v_mfma_f32_16x16x32_bf16 v[252:255], a[24:27], a[44:47], v[252:255]
  v_mfma_f32_16x16x32_bf16 a[128:131], a[24:27], a[48:51], a[128:131]
  v_mfma_f32_16x16x32_bf16 a[132:135], a[24:27], a[52:55], a[132:135]
  v_mfma_f32_16x16x32_bf16 a[136:139], a[24:27], a[56:59], a[136:139]
  v_mfma_f32_16x16x32_bf16 a[140:143], a[24:27], a[60:63], a[140:143]
  v_mfma_f32_16x16x32_bf16 a[144:147], a[28:31], a[32:35], a[144:147]
  v_mfma_f32_16x16x32_bf16 a[148:151], a[28:31], a[36:39], a[148:151]
  v_mfma_f32_16x16x32_bf16 a[152:155], a[28:31], a[40:43], a[152:155]
  v_mfma_f32_16x16x32_bf16 a[156:159], a[28:31], a[44:47], a[156:159]
  v_mfma_f32_16x16x32_bf16 a[160:163], a[28:31], a[48:51], a[160:163]
  v_mfma_f32_16x16x32_bf16 a[164:167], a[28:31], a[52:55], a[164:167]
  v_mfma_f32_16x16x32_bf16 a[168:171], a[28:31], a[56:59], a[168:171]
  v_mfma_f32_16x16x32_bf16 a[172:175], a[28:31], a[60:63], a[172:175]
  s_waitcnt lgkmcnt(0)
  v_mfma_f32_16x16x32_bf16 v[48:51], a[64:67], a[96:99], v[48:51]
  v_mfma_f32_16x16x32_bf16 v[52:55], a[64:67], a[100:103], v[52:55]
  v_mfma_f32_16x16x32_bf16 v[56:59], a[64:67], a[104:107], v[56:59]
  v_mfma_f32_16x16x32_bf16 v[60:63], a[64:67], a[108:111], v[60:63]
  v_mfma_f32_16x16x32_bf16 v[64:67], a[64:67], a[112:115], v[64:67]
  v_mfma_f32_16x16x32_bf16 v[68:71], a[64:67], a[116:119], v[68:71]
  v_mfma_f32_16x16x32_bf16 v[72:75], a[64:67], a[120:123], v[72:75]
  v_mfma_f32_16x16x32_bf16 v[76:79], a[64:67], a[124:127], v[76:79]
  v_mfma_f32_16x16x32_bf16 v[80:83], a[68:71], a[96:99], v[80:83]
  v_mfma_f32_16x16x32_bf16 v[84:87], a[68:71], a[100:103], v[84:87]
  v_mfma_f32_16x16x32_bf16 v[88:91], a[68:71], a[104:107], v[88:91]
  v_mfma_f32_16x16x32_bf16 v[92:95], a[68:71], a[108:111], v[92:95]
  v_mfma_f32_16x16x32_bf16 v[96:99], a[68:71], a[112:115], v[96:99]
  v_mfma_f32_16x16x32_bf16 v[100:103], a[68:71], a[116:119], v[100:103]
  v_mfma_f32_16x16x32_bf16 v[104:107], a[68:71], a[120:123], v[104:107]
  v_mfma_f32_16x16x32_bf16 v[108:111], a[68:71], a[124:127], v[108:111]
  v_mfma_f32_16x16x32_bf16 v[112:115], a[72:75], a[96:99], v[112:115]
  v_mfma_f32_16x16x32_bf16 v[116:119], a[72:75], a[100:103], v[116:119]
  v_mfma_f32_16x16x32_bf16 v[120:123], a[72:75], a[104:107], v[120:123]
  v_mfma_f32_16x16x32_bf16 v[124:127], a[72:75], a[108:111], v[124:127]
  v_mfma_f32_16x16x32_bf16 v[128:131], a[72:75], a[112:115], v[128:131]
  v_mfma_f32_16x16x32_bf16 v[132:135], a[72:75], a[116:119], v[132:135]
  v_mfma_f32_16x16x32_bf16 v[136:139], a[72:75], a[120:123], v[136:139]
  v_mfma_f32_16x16x32_bf16 v[140:143], a[72:75], a[124:127], v[140:143]
  v_mfma_f32_16x16x32_bf16 v[144:147], a[76:79], a[96:99], v[144:147]
  v_mfma_f32_16x16x32_bf16 v[148:151], a[76:79], a[100:103], v[148:151]
  v_mfma_f32_16x16x32_bf16 v[152:155], a[76:79], a[104:107], v[152:155]
  v_mfma_f32_16x16x32_bf16 v[156:159], a[76:79], a[108:111], v[156:159]
  v_mfma_f32_16x16x32_bf16 v[160:163], a[76:79], a[112:115], v[160:163]
  v_mfma_f32_16x16x32_bf16 v[164:167], a[76:79], a[116:119], v[164:167]
  v_mfma_f32_16x16x32_bf16 v[168:171], a[76:79], a[120:123], v[168:171]
  v_mfma_f32_16x16x32_bf16 v[172:175], a[76:79], a[124:127], v[172:175]
  v_mfma_f32_16x16x32_bf16 v[176:179], a[80:83], a[96:99], v[176:179]
  v_mfma_f32_16x16x32_bf16 v[180:183], a[80:83], a[100:103], v[180:183]
  v_mfma_f32_16x16x32_bf16 v[184:187], a[80:83], a[104:107], v[184:187]
  v_mfma_f32_16x16x32_bf16 v[188:191], a[80:83], a[108:111], v[188:191]
  v_mfma_f32_16x16x32_bf16 v[192:195], a[80:83], a[112:115], v[192:195]
  v_mfma_f32_16x16x32_bf16 v[196:199], a[80:83], a[116:119], v[196:199]
  v_mfma_f32_16x16x32_bf16 v[200:203], a[80:83], a[120:123], v[200:203]
  v_mfma_f32_16x16x32_bf16 v[204:207], a[80:83], a[124:127], v[204:207]
  v_mfma_f32_16x16x32_bf16 v[208:211], a[84:87], a[96:99], v[208:211]
  v_mfma_f32_16x16x32_bf16 v[212:215], a[84:87], a[100:103], v[212:215]
  v_mfma_f32_16x16x32_bf16 v[216:219], a[84:87], a[104:107], v[216:219]
  v_mfma_f32_16x16x32_bf16 v[220:223], a[84:87], a[108:111], v[220:223]
  v_mfma_f32_16x16x32_bf16 v[224:227], a[84:87], a[112:115], v[224:227]
  v_mfma_f32_16x16x32_bf16 v[228:231], a[84:87], a[116:119], v[228:231]
  v_mfma_f32_16x16x32_bf16 v[232:235], a[84:87], a[120:123], v[232:235]
  v_mfma_f32_16x16x32_bf16 v[236:239], a[84:87], a[124:127], v[236:239]
  v_mfma_f32_16x16x32_bf16 v[240:243], a[88:91], a[96:99], v[240:243]
  v_mfma_f32_16x16x32_bf16 v[244:247], a[88:91], a[100:103], v[244:247]
  v_mfma_f32_16x16x32_bf16 v[248:251], a[88:91], a[104:107], v[248:251]
  v_mfma_f32_16x16x32_bf16 v[252:255], a[88:91], a[108:111], v[252:255]
  v_mfma_f32_16x16x32_bf16 a[128:131], a[88:91], a[112:115], a[128:131]
  v_mfma_f32_16x16x32_bf16 a[132:135], a[88:91], a[116:119], a[132:135]
  v_mfma_f32_16x16x32_bf16 a[136:139], a[88:91], a[120:123], a[136:139]
  v_mfma_f32_16x16x32_bf16 a[140:143], a[88:91], a[124:127], a[140:143]
  v_mfma_f32_16x16x32_bf16 a[144:147], a[92:95], a[96:99], a[144:147]
  v_mfma_f32_16x16x32_bf16 a[148:151], a[92:95], a[100:103], a[148:151]
  v_mfma_f32_16x16x32_bf16 a[152:155], a[92:95], a[104:107], a[152:155]
  v_mfma_f32_16x16x32_bf16 a[156:159], a[92:95], a[108:111], a[156:159]
  v_mfma_f32_16x16x32_bf16 a[160:163], a[92:95], a[112:115], a[160:163]
  v_mfma_f32_16x16x32_bf16 a[164:167], a[92:95], a[116:119], a[164:167]
  v_mfma_f32_16x16x32_bf16 a[168:171], a[92:95], a[120:123], a[168:171]
  v_mfma_f32_16x16x32_bf16 a[172:175], a[92:95], a[124:127], a[172:175]
  s_waitcnt vmcnt(0)
  v_lshlrev_b32 v1, 4, v0
  s_lshl_b32 s3, s34, 1
  s_and_b32 s36, s32, 1
  s_add_u32 s3, s3, s36
  s_lshl_b32 s3, s3, 20
  s_lshl_b32 s36, s33, 17
  s_add_u32 s3, s3, s36
  s_lshr_b32 s36, s32, 1
  s_lshl_b32 s36, s36, 16
  s_add_u32 s3, s3, s36
  v_cvt_pk_bf16_f32 v2, v48, v49
  v_cvt_pk_bf16_f32 v3, v50, v51
  v_cvt_pk_bf16_f32 v4, v80, v81
  v_cvt_pk_bf16_f32 v5, v82, v83
  s_add_u32 s36, s3, 16384
  buffer_store_dwordx4 v[2:5], v1, s[24:27], s36 offen offset:0 sc1
  v_cvt_pk_bf16_f32 v6, v112, v113
  v_cvt_pk_bf16_f32 v7, v114, v115
  v_cvt_pk_bf16_f32 v8, v144, v145
  v_cvt_pk_bf16_f32 v9, v146, v147
  buffer_store_dwordx4 v[6:9], v1, s[24:27], s36 offen offset:1024 sc1
  v_cvt_pk_bf16_f32 v10, v52, v53
  v_cvt_pk_bf16_f32 v11, v54, v55
  v_cvt_pk_bf16_f32 v12, v84, v85
  v_cvt_pk_bf16_f32 v13, v86, v87
  buffer_store_dwordx4 v[10:13], v1, s[24:27], s36 offen offset:2048 sc1
  v_cvt_pk_bf16_f32 v14, v116, v117
  v_cvt_pk_bf16_f32 v15, v118, v119
  v_cvt_pk_bf16_f32 v16, v148, v149
  v_cvt_pk_bf16_f32 v17, v150, v151
  buffer_store_dwordx4 v[14:17], v1, s[24:27], s36 offen offset:3072 sc1
  v_cvt_pk_bf16_f32 v2, v56, v57
  v_cvt_pk_bf16_f32 v3, v58, v59
  v_cvt_pk_bf16_f32 v4, v88, v89
  v_cvt_pk_bf16_f32 v5, v90, v91
  s_add_u32 s36, s3, 20480
  buffer_store_dwordx4 v[2:5], v1, s[24:27], s36 offen offset:0 sc1
  v_cvt_pk_bf16_f32 v6, v120, v121
  v_cvt_pk_bf16_f32 v7, v122, v123
  v_cvt_pk_bf16_f32 v8, v152, v153
  v_cvt_pk_bf16_f32 v9, v154, v155
  buffer_store_dwordx4 v[6:9], v1, s[24:27], s36 offen offset:1024 sc1
  v_cvt_pk_bf16_f32 v10, v60, v61
  v_cvt_pk_bf16_f32 v11, v62, v63
  v_cvt_pk_bf16_f32 v12, v92, v93
  v_cvt_pk_bf16_f32 v13, v94, v95
  buffer_store_dwordx4 v[10:13], v1, s[24:27], s36 offen offset:2048 sc1
  v_cvt_pk_bf16_f32 v14, v124, v125
  v_cvt_pk_bf16_f32 v15, v126, v127
  v_cvt_pk_bf16_f32 v16, v156, v157
  v_cvt_pk_bf16_f32 v17, v158, v159
  buffer_store_dwordx4 v[14:17], v1, s[24:27], s36 offen offset:3072 sc1
  v_cvt_pk_bf16_f32 v2, v64, v65
  v_cvt_pk_bf16_f32 v3, v66, v67
  v_cvt_pk_bf16_f32 v4, v96, v97
  v_cvt_pk_bf16_f32 v5, v98, v99
  s_add_u32 s36, s3, 24576
  buffer_store_dwordx4 v[2:5], v1, s[24:27], s36 offen offset:0 sc1
  v_cvt_pk_bf16_f32 v6, v128, v129
  v_cvt_pk_bf16_f32 v7, v130, v131
  v_cvt_pk_bf16_f32 v8, v160, v161
  v_cvt_pk_bf16_f32 v9, v162, v163
  buffer_store_dwordx4 v[6:9], v1, s[24:27], s36 offen offset:1024 sc1
  v_cvt_pk_bf16_f32 v10, v68, v69
  v_cvt_pk_bf16_f32 v11, v70, v71
  v_cvt_pk_bf16_f32 v12, v100, v101
  v_cvt_pk_bf16_f32 v13, v102, v103
  buffer_store_dwordx4 v[10:13], v1, s[24:27], s36 offen offset:2048 sc1
  v_cvt_pk_bf16_f32 v14, v132, v133
  v_cvt_pk_bf16_f32 v15, v134, v135
  v_cvt_pk_bf16_f32 v16, v164, v165
  v_cvt_pk_bf16_f32 v17, v166, v167
  buffer_store_dwordx4 v[14:17], v1, s[24:27], s36 offen offset:3072 sc1
  v_cvt_pk_bf16_f32 v2, v72, v73
  v_cvt_pk_bf16_f32 v3, v74, v75
  v_cvt_pk_bf16_f32 v4, v104, v105
  v_cvt_pk_bf16_f32 v5, v106, v107
  s_add_u32 s36, s3, 28672
  buffer_store_dwordx4 v[2:5], v1, s[24:27], s36 offen offset:0 sc1
  v_cvt_pk_bf16_f32 v6, v136, v137
  v_cvt_pk_bf16_f32 v7, v138, v139
  v_cvt_pk_bf16_f32 v8, v168, v169
  v_cvt_pk_bf16_f32 v9, v170, v171
  buffer_store_dwordx4 v[6:9], v1, s[24:27], s36 offen offset:1024 sc1
  v_cvt_pk_bf16_f32 v10, v76, v77
  v_cvt_pk_bf16_f32 v11, v78, v79
  v_cvt_pk_bf16_f32 v12, v108, v109
  v_cvt_pk_bf16_f32 v13, v110, v111
  buffer_store_dwordx4 v[10:13], v1, s[24:27], s36 offen offset:2048 sc1
  v_cvt_pk_bf16_f32 v14, v140, v141
  v_cvt_pk_bf16_f32 v15, v142, v143
  v_cvt_pk_bf16_f32 v16, v172, v173
  v_cvt_pk_bf16_f32 v17, v174, v175
  buffer_store_dwordx4 v[14:17], v1, s[24:27], s36 offen offset:3072 sc1
  v_cvt_pk_bf16_f32 v2, v176, v177
  v_cvt_pk_bf16_f32 v3, v178, v179
  v_cvt_pk_bf16_f32 v4, v208, v209
  v_cvt_pk_bf16_f32 v5, v210, v211
  s_add_u32 s36, s3, 49152
  buffer_store_dwordx4 v[2:5], v1, s[24:27], s36 offen offset:0 sc1
  v_cvt_pk_bf16_f32 v6, v240, v241
  v_cvt_pk_bf16_f32 v7, v242, v243
  v_accvgpr_read_b32 v20, a144
  v_accvgpr_read_b32 v21, a145
  v_accvgpr_read_b32 v22, a146
  v_accvgpr_read_b32 v23, a147
  v_cvt_pk_bf16_f32 v8, v20, v21
  v_cvt_pk_bf16_f32 v9, v22, v23
  buffer_store_dwordx4 v[6:9], v1, s[24:27], s36 offen offset:1024 sc1
  v_cvt_pk_bf16_f32 v10, v180, v181
  v_cvt_pk_bf16_f32 v11, v182, v183
  v_cvt_pk_bf16_f32 v12, v212, v213
  v_cvt_pk_bf16_f32 v13, v214, v215
  buffer_store_dwordx4 v[10:13], v1, s[24:27], s36 offen offset:2048 sc1
  v_cvt_pk_bf16_f32 v14, v244, v245
  v_cvt_pk_bf16_f32 v15, v246, v247
  v_accvgpr_read_b32 v20, a148
  v_accvgpr_read_b32 v21, a149
  v_accvgpr_read_b32 v22, a150
  v_accvgpr_read_b32 v23, a151
  v_cvt_pk_bf16_f32 v16, v20, v21
  v_cvt_pk_bf16_f32 v17, v22, v23
  buffer_store_dwordx4 v[14:17], v1, s[24:27], s36 offen offset:3072 sc1
  v_cvt_pk_bf16_f32 v2, v184, v185
  v_cvt_pk_bf16_f32 v3, v186, v187
  v_cvt_pk_bf16_f32 v4, v216, v217
  v_cvt_pk_bf16_f32 v5, v218, v219
  s_add_u32 s36, s3, 53248
  buffer_store_dwordx4 v[2:5], v1, s[24:27], s36 offen offset:0 sc1
  v_cvt_pk_bf16_f32 v6, v248, v249
  v_cvt_pk_bf16_f32 v7, v250, v251
  v_accvgpr_read_b32 v20, a152
  v_accvgpr_read_b32 v21, a153
  v_accvgpr_read_b32 v22, a154
  v_accvgpr_read_b32 v23, a155
  v_cvt_pk_bf16_f32 v8, v20, v21
  v_cvt_pk_bf16_f32 v9, v22, v23
  buffer_store_dwordx4 v[6:9], v1, s[24:27], s36 offen offset:1024 sc1
  v_cvt_pk_bf16_f32 v10, v188, v189
  v_cvt_pk_bf16_f32 v11, v190, v191
  v_cvt_pk_bf16_f32 v12, v220, v221
  v_cvt_pk_bf16_f32 v13, v222, v223
  buffer_store_dwordx4 v[10:13], v1, s[24:27], s36 offen offset:2048 sc1
  v_cvt_pk_bf16_f32 v14, v252, v253
  v_cvt_pk_bf16_f32 v15, v254, v255
  v_accvgpr_read_b32 v20, a156
  v_accvgpr_read_b32 v21, a157
  v_accvgpr_read_b32 v22, a158
  v_accvgpr_read_b32 v23, a159
  v_cvt_pk_bf16_f32 v16, v20, v21
  v_cvt_pk_bf16_f32 v17, v22, v23
  buffer_store_dwordx4 v[14:17], v1, s[24:27], s36 offen offset:3072 sc1
  v_cvt_pk_bf16_f32 v2, v192, v193
  v_cvt_pk_bf16_f32 v3, v194, v195
  v_cvt_pk_bf16_f32 v4, v224, v225
  v_cvt_pk_bf16_f32 v5, v226, v227
  s_add_u32 s36, s3, 57344
  buffer_store_dwordx4 v[2:5], v1, s[24:27], s36 offen offset:0 sc1
  v_accvgpr_read_b32 v20, a128
  v_accvgpr_read_b32 v21, a129
  v_accvgpr_read_b32 v22, a130
  v_accvgpr_read_b32 v23, a131
  v_cvt_pk_bf16_f32 v6, v20, v21
  v_cvt_pk_bf16_f32 v7, v22, v23
  v_accvgpr_read_b32 v20, a160
  v_accvgpr_read_b32 v21, a161
  v_accvgpr_read_b32 v22, a162
  v_accvgpr_read_b32 v23, a163
  v_cvt_pk_bf16_f32 v8, v20, v21
  v_cvt_pk_bf16_f32 v9, v22, v23
  buffer_store_dwordx4 v[6:9], v1, s[24:27], s36 offen offset:1024 sc1
  v_cvt_pk_bf16_f32 v10, v196, v197
  v_cvt_pk_bf16_f32 v11, v198, v199
  v_cvt_pk_bf16_f32 v12, v228, v229
  v_cvt_pk_bf16_f32 v13, v230, v231
  buffer_store_dwordx4 v[10:13], v1, s[24:27], s36 offen offset:2048 sc1
  v_accvgpr_read_b32 v20, a132
  v_accvgpr_read_b32 v21, a133
  v_accvgpr_read_b32 v22, a134
  v_accvgpr_read_b32 v23, a135
  v_cvt_pk_bf16_f32 v14, v20, v21
  v_cvt_pk_bf16_f32 v15, v22, v23
  v_accvgpr_read_b32 v20, a164
  v_accvgpr_read_b32 v21, a165
  v_accvgpr_read_b32 v22, a166
  v_accvgpr_read_b32 v23, a167
  v_cvt_pk_bf16_f32 v16, v20, v21
  v_cvt_pk_bf16_f32 v17, v22, v23
  buffer_store_dwordx4 v[14:17], v1, s[24:27], s36 offen offset:3072 sc1
  v_cvt_pk_bf16_f32 v2, v200, v201
  v_cvt_pk_bf16_f32 v3, v202, v203
  v_cvt_pk_bf16_f32 v4, v232, v233
  v_cvt_pk_bf16_f32 v5, v234, v235
  s_add_u32 s36, s3, 61440
  buffer_store_dwordx4 v[2:5], v1, s[24:27], s36 offen offset:0 sc1
  v_accvgpr_read_b32 v20, a136
  v_accvgpr_read_b32 v21, a137
  v_accvgpr_read_b32 v22, a138
  v_accvgpr_read_b32 v23, a139
  v_cvt_pk_bf16_f32 v6, v20, v21
  v_cvt_pk_bf16_f32 v7, v22, v23
  v_accvgpr_read_b32 v20, a168
  v_accvgpr_read_b32 v21, a169
  v_accvgpr_read_b32 v22, a170
  v_accvgpr_read_b32 v23, a171
  v_cvt_pk_bf16_f32 v8, v20, v21
  v_cvt_pk_bf16_f32 v9, v22, v23
  buffer_store_dwordx4 v[6:9], v1, s[24:27], s36 offen offset:1024 sc1
  v_cvt_pk_bf16_f32 v10, v204, v205
  v_cvt_pk_bf16_f32 v11, v206, v207
  v_cvt_pk_bf16_f32 v12, v236, v237
  v_cvt_pk_bf16_f32 v13, v238, v239
  buffer_store_dwordx4 v[10:13], v1, s[24:27], s36 offen offset:2048 sc1
  v_accvgpr_read_b32 v20, a140
  v_accvgpr_read_b32 v21, a141
  v_accvgpr_read_b32 v22, a142
  v_accvgpr_read_b32 v23, a143
  v_cvt_pk_bf16_f32 v14, v20, v21
  v_cvt_pk_bf16_f32 v15, v22, v23
  v_accvgpr_read_b32 v20, a172
  v_accvgpr_read_b32 v21, a173
  v_accvgpr_read_b32 v22, a174
  v_accvgpr_read_b32 v23, a175
  v_cvt_pk_bf16_f32 v16, v20, v21
  v_cvt_pk_bf16_f32 v17, v22, v23
  buffer_store_dwordx4 v[14:17], v1, s[24:27], s36 offen offset:3072 sc1
  s_endpgm
L_k1_end:
  s_endpgm
.globl attn_kernel
.p2align 8
.type attn_kernel,@function
attn_kernel:
  s_cmp_ge_u32 s2, 256
  s_cbranch_scc1 L_k2_end
  s_load_dwordx2 s[4:5], s[0:1], 16
  s_load_dwordx2 s[6:7], s[0:1], 104
  s_load_dwordx4 s[40:43], s[0:1], 64
  v_lshrrev_b32 v1, 6, v0
  v_and_b32 v0, 63, v0
  v_readfirstlane_b32 s32, v1
  s_and_b32 s33, s2, 7
  s_lshl_b32 s33, s33, 2
  s_bfe_u32 s3, s2, 0x20003
  s_add_u32 s33, s33, s3
  s_lshr_b32 s34, s2, 5
  s_lshl_b32 s35, s34, 1
  s_sub_u32 s36, 32, s35
  s_add_u32 s35, s35, 2
  s_lshl_b32 s44, s32, 12
  s_mov_b32 s48, 0
  s_mov_b32 s49, 31744
  s_mov_b32 s50, 63488
  s_mov_b32 s51, 95232
  s_mov_b32 s52, 32768
  v_lshrrev_b32 v24, 4, v0
  v_and_b32 v25, 15, v0
  s_lshl_b32 s3, s32, 4
  v_add_u32 v26, s3, v24
  v_lshlrev_b32 v26, 13, v26
  v_lshlrev_b32 v27, 1, v24
  v_xor_b32 v27, v27, v25
  v_lshl_add_u32 v8, v27, 4, v26
  v_xor_b32 v27, 8, v27
  v_lshl_add_u32 v9, v27, 4, v26
  v_lshlrev_b32 v2, 4, v0
  v_add_u32 v3, 65536, v2
  v_add_u32 v4, s44, v2
  s_sub_u32 s3, 15, s34
  s_lshl_b32 s45, s3, 2
  s_add_u32 s45, s45, s32
  s_lshl_b32 s46, s34, 2
  s_add_u32 s46, s46, s32
  s_lshl_b32 s3, s45, 16
  v_add_u32 v10, s3, v2
  s_lshl_b32 s3, s46, 16
  v_add_u32 v11, s3, v2
  v_lshlrev_b32 v26, 2, v24
  v_sub_u32 v26, v25, v26
  s_lshl_b32 s3, s45, 5
  v_add_u32 v5, s3, v26
  s_lshl_b32 s3, s46, 5
  v_add_u32 v6, s3, v26
  v_lshrrev_b32 v26, 2, v25
  v_lshl_add_u32 v27, v24, 3, v26
  v_lshlrev_b32 v27, 8, v27
  v_and_b32 v28, 3, v0
  v_lshl_add_u32 v27, v28, 3, v27
  v_and_b32 v28, 1, v24
  v_lshl_add_u32 v26, v28, 2, v26
  v_xor_b32 v28, 0, v26
  v_lshl_add_u32 v16, v28, 5, v27
  v_xor_b32 v28, 1, v26
  v_lshl_add_u32 v17, v28, 5, v27
  v_xor_b32 v28, 2, v26
  v_lshl_add_u32 v18, v28, 5, v27
  v_xor_b32 v28, 3, v26
  v_lshl_add_u32 v19, v28, 5, v27
  v_xor_b32 v28, 4, v26
  v_lshl_add_u32 v20, v28, 5, v27
  v_xor_b32 v28, 5, v26
  v_lshl_add_u32 v21, v28, 5, v27
  v_xor_b32 v28, 6, v26
  v_lshl_add_u32 v22, v28, 5, v27
  v_xor_b32 v28, 7, v26
  v_lshl_add_u32 v23, v28, 5, v27
  s_waitcnt lgkmcnt(0)
  s_lshl_b32 s3, s33, 8
  s_add_u32 s8, s4, s3
  s_addc_u32 s9, s5, 0
  s_and_b32 s9, s9, 0xffff
  s_mov_b32 s10, 0
  s_mov_b32 s11, 0x20000
  s_sub_u32 s10, 8388608, s3
  s_mov_b32 s16, s6
  s_and_b32 s17, s7, 0xffff
  s_mov_b32 s18, 8388608
  s_mov_b32 s19, 0x20000
  s_lshl_b32 s3, s33, 20
  s_add_u32 s3, s3, 8388608
  s_add_u32 s12, s6, s3
  s_addc_u32 s13, s7, 0
  s_and_b32 s13, s13, 0xffff
  s_mov_b32 s14, 0
  s_mov_b32 s15, 0x20000
  s_lshl_b32 s14, s36, 15
  s_add_u32 s20, s6, 41943040
  s_addc_u32 s21, s7, 0
  s_and_b32 s21, s21, 0xffff
  s_mov_b32 s22, 16777216
  s_mov_b32 s23, 0x20000
  s_mov_b32 s24, s40
  s_and_b32 s25, s41, 0xffff
  s_mov_b32 s26, 7340032
  s_mov_b32 s27, 0x20000
  s_mov_b32 s28, s42
  s_and_b32 s29, s43, 0xffff
  s_mov_b32 s30, 7340032
  s_mov_b32 s31, 0x20000
  s_add_u32 m0, s44, 0
  s_nop 0
  buffer_load_dwordx4 v8, s[8:11], s48 offen offset:0 lds
  buffer_load_dwordx4 v8, s[8:11], s49 offen offset:1024 lds
  buffer_load_dwordx4 v9, s[8:11], s50 offen offset:2048 lds
  buffer_load_dwordx4 v9, s[8:11], s51 offen offset:3072 lds
  v_add_u32 v8, 524288, v8
  v_add_u32 v9, 524288, v9
  buffer_load_dwordx4 a[0:3], v10, s[16:19], 0 offen offset:0
  buffer_load_dwordx4 a[4:7], v10, s[16:19], s52 offen offset:0
  buffer_load_dwordx4 a[8:11], v11, s[16:19], 0 offen offset:0
  buffer_load_dwordx4 a[12:15], v11, s[16:19], s52 offen offset:0
  buffer_load_dwordx4 a[16:19], v10, s[16:19], 0 offen offset:1024
  buffer_load_dwordx4 a[20:23], v10, s[16:19], s52 offen offset:1024
  buffer_load_dwordx4 a[24:27], v11, s[16:19], 0 offen offset:1024
  buffer_load_dwordx4 a[28:31], v11, s[16:19], s52 offen offset:1024
  s_add_u32 m0, s44, 16384
  s_nop 0
  buffer_load_dwordx4 v8, s[8:11], s48 offen offset:0 lds
  buffer_load_dwordx4 v8, s[8:11], s49 offen offset:1024 lds
  buffer_load_dwordx4 v9, s[8:11], s50 offen offset:2048 lds
  buffer_load_dwordx4 v9, s[8:11], s51 offen offset:3072 lds
  v_add_u32 v8, 524288, v8
  v_add_u32 v9, 524288, v9
  buffer_load_dwordx4 a[32:35], v10, s[16:19], 0 offen offset:2048
  buffer_load_dwordx4 a[36:39], v10, s[16:19], s52 offen offset:2048
  buffer_load_dwordx4 a[40:43], v11, s[16:19], 0 offen offset:2048
  buffer_load_dwordx4 a[44:47], v11, s[16:19], s52 offen offset:2048
  buffer_load_dwordx4 a[48:51], v10, s[16:19], 0 offen offset:3072
  buffer_load_dwordx4 a[52:55], v10, s[16:19], s52 offen offset:3072
  buffer_load_dwordx4 a[56:59], v11, s[16:19], 0 offen offset:3072
  buffer_load_dwordx4 a[60:63], v11, s[16:19], s52 offen offset:3072
  v_add_u32 v10, 4096, v10
  v_add_u32 v11, 4096, v11
  s_add_u32 m0, s44, 32768
  s_nop 0
  buffer_load_dwordx4 v8, s[8:11], s48 offen offset:0 lds
  buffer_load_dwordx4 v8, s[8:11], s49 offen offset:1024 lds
  buffer_load_dwordx4 v9, s[8:11], s50 offen offset:2048 lds
  buffer_load_dwordx4 v9, s[8:11], s51 offen offset:3072 lds
  v_add_u32 v8, 524288, v8
  v_add_u32 v9, 524288, v9
  buffer_load_dwordx4 a[64:67], v10, s[16:19], 0 offen offset:0
  buffer_load_dwordx4 a[68:71], v10, s[16:19], s52 offen offset:0
  buffer_load_dwordx4 a[72:75], v11, s[16:19], 0 offen offset:0
  buffer_load_dwordx4 a[76:79], v11, s[16:19], s52 offen offset:0
  buffer_load_dwordx4 a[80:83], v10, s[16:19], 0 offen offset:1024
  buffer_load_dwordx4 a[84:87], v10, s[16:19], s52 offen offset:1024
  buffer_load_dwordx4 a[88:91], v11, s[16:19], 0 offen offset:1024
  buffer_load_dwordx4 a[92:95], v11, s[16:19], s52 offen offset:1024
  s_add_u32 m0, s44, 49152
  s_nop 0
  buffer_load_dwordx4 v8, s[8:11], s48 offen offset:0 lds
  buffer_load_dwordx4 v8, s[8:11], s49 offen offset:1024 lds
  buffer_load_dwordx4 v9, s[8:11], s50 offen offset:2048 lds
  buffer_load_dwordx4 v9, s[8:11], s51 offen offset:3072 lds
  v_add_u32 v8, 524288, v8
  v_add_u32 v9, 524288, v9
  buffer_load_dwordx4 a[96:99], v10, s[16:19], 0 offen offset:2048
  buffer_load_dwordx4 a[100:103], v10, s[16:19], s52 offen offset:2048
  buffer_load_dwordx4 a[104:107], v11, s[16:19], 0 offen offset:2048
  buffer_load_dwordx4 a[108:111], v11, s[16:19], s52 offen offset:2048
  s_add_u32 m0, s44, 65536
  s_nop 0
  buffer_load_dwordx4 v8, s[8:11], s48 offen offset:0 lds
  buffer_load_dwordx4 v8, s[8:11], s49 offen offset:1024 lds
  buffer_load_dwordx4 v9, s[8:11], s50 offen offset:2048 lds
  buffer_load_dwordx4 v9, s[8:11], s51 offen offset:3072 lds
  v_add_u32 v8, 524288, v8
  v_add_u32 v9, 524288, v9
  s_add_u32 m0, s44, 81920
  s_nop 0
  buffer_load_dwordx4 v8, s[8:11], s48 offen offset:0 lds
  buffer_load_dwordx4 v8, s[8:11], s49 offen offset:1024 lds
  buffer_load_dwordx4 v9, s[8:11], s50 offen offset:2048 lds
  buffer_load_dwordx4 v9, s[8:11], s51 offen offset:3072 lds
  v_add_u32 v8, 524288, v8
  v_add_u32 v9, 524288, v9
  s_add_u32 m0, s44, 98304
  s_nop 0
  buffer_load_dwordx4 v8, s[8:11], s48 offen offset:0 lds
  buffer_load_dwordx4 v8, s[8:11], s49 offen offset:1024 lds
  buffer_load_dwordx4 v9, s[8:11], s50 offen offset:2048 lds
  buffer_load_dwordx4 v9, s[8:11], s51 offen offset:3072 lds
  v_add_u32 v8, 524288, v8
  v_add_u32 v9, 524288, v9
  v_mov_b32 v128, 0
  v_mov_b32 v129, 0
  v_mov_b32 v130, 0
  v_mov_b32 v131, 0
  v_mov_b32 v132, 0
  v_mov_b32 v133, 0
  v_mov_b32 v134, 0
  v_mov_b32 v135, 0
  v_mov_b32 v136, 0
  v_mov_b32 v137, 0
  v_mov_b32 v138, 0
  v_mov_b32 v139, 0
  v_mov_b32 v140, 0
  v_mov_b32 v141, 0
  v_mov_b32 v142, 0
  v_mov_b32 v143, 0
  v_mov_b32 v144, 0
  v_mov_b32 v145, 0
  v_mov_b32 v146, 0
  v_mov_b32 v147, 0
  v_mov_b32 v148, 0
  v_mov_b32 v149, 0
  v_mov_b32 v150, 0
  v_mov_b32 v151, 0
  v_mov_b32 v152, 0
  v_mov_b32 v153, 0
  v_mov_b32 v154, 0
  v_mov_b32 v155, 0
  v_mov_b32 v156, 0
  v_mov_b32 v157, 0
  v_mov_b32 v158, 0
  v_mov_b32 v159, 0
  v_mov_b32 v160, 0
  v_mov_b32 v161, 0
  v_mov_b32 v162, 0
  v_mov_b32 v163, 0
  v_mov_b32 v164, 0
  v_mov_b32 v165, 0
  v_mov_b32 v166, 0
  v_mov_b32 v167, 0
  v_mov_b32 v168, 0
  v_mov_b32 v169, 0
  v_mov_b32 v170, 0
  v_mov_b32 v171, 0
  v_mov_b32 v172, 0
  v_mov_b32 v173, 0
  v_mov_b32 v174, 0
  v_mov_b32 v175, 0
  v_mov_b32 v176, 0
  v_mov_b32 v177, 0
  v_mov_b32 v178, 0
  v_mov_b32 v179, 0
  v_mov_b32 v180, 0
  v_mov_b32 v181, 0
  v_mov_b32 v182, 0
  v_mov_b32 v183, 0
  v_mov_b32 v184, 0
  v_mov_b32 v185, 0
  v_mov_b32 v186, 0
  v_mov_b32 v187, 0
  v_mov_b32 v188, 0
  v_mov_b32 v189, 0
  v_mov_b32 v190, 0
  v_mov_b32 v191, 0
  v_mov_b32 v192, 0
  v_mov_b32 v193, 0
  v_mov_b32 v194, 0
  v_mov_b32 v195, 0
  v_mov_b32 v196, 0
  v_mov_b32 v197, 0
  v_mov_b32 v198, 0
  v_mov_b32 v199, 0
  v_mov_b32 v200, 0
  v_mov_b32 v201, 0
  v_mov_b32 v202, 0
  v_mov_b32 v203, 0
  v_mov_b32 v204, 0
  v_mov_b32 v205, 0
  v_mov_b32 v206, 0
  v_mov_b32 v207, 0
  v_mov_b32 v208, 0
  v_mov_b32 v209, 0
  v_mov_b32 v210, 0
  v_mov_b32 v211, 0
  v_mov_b32 v212, 0
  v_mov_b32 v213, 0
  v_mov_b32 v214, 0
  v_mov_b32 v215, 0
  v_mov_b32 v216, 0
  v_mov_b32 v217, 0
  v_mov_b32 v218, 0
  v_mov_b32 v219, 0
  v_mov_b32 v220, 0
  v_mov_b32 v221, 0
  v_mov_b32 v222, 0
  v_mov_b32 v223, 0
  v_mov_b32 v224, 0
  v_mov_b32 v225, 0
  v_mov_b32 v226, 0
  v_mov_b32 v227, 0
  v_mov_b32 v228, 0
  v_mov_b32 v229, 0
  v_mov_b32 v230, 0
  v_mov_b32 v231, 0
  v_mov_b32 v232, 0
  v_mov_b32 v233, 0
  v_mov_b32 v234, 0
  v_mov_b32 v235, 0
  v_mov_b32 v236, 0
  v_mov_b32 v237, 0
  v_mov_b32 v238, 0
  v_mov_b32 v239, 0
  v_mov_b32 v240, 0
  v_mov_b32 v241, 0
  v_mov_b32 v242, 0
  v_mov_b32 v243, 0
  v_mov_b32 v244, 0
  v_mov_b32 v245, 0
  v_mov_b32 v246, 0
  v_mov_b32 v247, 0
  v_mov_b32 v248, 0
  v_mov_b32 v249, 0
  v_mov_b32 v250, 0
  v_mov_b32 v251, 0
  v_mov_b32 v252, 0
  v_mov_b32 v253, 0
  v_mov_b32 v254, 0
  v_mov_b32 v255, 0
  s_waitcnt vmcnt(36)
  s_mov_b32 s3, 4194304
  s_mov_b32 s47, 4198400
  buffer_load_dwordx4 v[32:35], v2, s[16:19], s3 offen offset:0
  buffer_load_dwordx4 v[36:39], v2, s[16:19], s3 offen offset:1024
  buffer_load_dwordx4 v[40:43], v2, s[16:19], s3 offen offset:2048
  buffer_load_dwordx4 v[44:47], v2, s[16:19], s3 offen offset:3072
  buffer_load_dwordx4 v[48:51], v2, s[16:19], s47 offen offset:0
  buffer_load_dwordx4 v[52:55], v2, s[16:19], s47 offen offset:1024
  buffer_load_dwordx4 v[56:59], v2, s[16:19], s47 offen offset:2048
  buffer_load_dwordx4 v[60:63], v2, s[16:19], s47 offen offset:3072
  s_mul_i32 s53, s2, 2341
  s_lshr_b32 s53, s53, 16
  s_mul_i32 s3, s53, 28
  s_sub_u32 s54, s2, s3
  s_lshl_b32 s55, s53, 2
  s_add_u32 s55, s55, s32
  s_mul_i32 s3, s55, 229376
  s_lshl_b32 s47, s54, 8
  s_add_u32 s3, s3, s47
  v_mul_u32_u24 v26, 57344, v24
  v_lshl_add_u32 v26, v25, 4, v26
  buffer_load_dwordx4 v[64:67], v26, s[24:27], s3 offen
  buffer_load_dwordx4 v[68:71], v26, s[28:31], s3 offen
  s_add_u32 s3, s3, 7168
  buffer_load_dwordx4 v[72:75], v26, s[24:27], s3 offen
  buffer_load_dwordx4 v[76:79], v26, s[28:31], s3 offen
  s_add_u32 s3, s3, 7168
  buffer_load_dwordx4 v[80:83], v26, s[24:27], s3 offen
  buffer_load_dwordx4 v[84:87], v26, s[28:31], s3 offen
  s_add_u32 s3, s3, 7168
  buffer_load_dwordx4 v[88:91], v26, s[24:27], s3 offen
  buffer_load_dwordx4 v[92:95], v26, s[28:31], s3 offen
  s_add_u32 s3, s3, 7168
  buffer_load_dwordx4 v[96:99], v26, s[24:27], s3 offen
  buffer_load_dwordx4 v[100:103], v26, s[28:31], s3 offen
  s_add_u32 s3, s3, 7168
  buffer_load_dwordx4 v[104:107], v26, s[24:27], s3 offen
  buffer_load_dwordx4 v[108:111], v26, s[28:31], s3 offen
  s_add_u32 s3, s3, 7168
  buffer_load_dwordx4 v[112:115], v26, s[24:27], s3 offen
  buffer_load_dwordx4 v[116:119], v26, s[28:31], s3 offen
  s_add_u32 s3, s3, 7168
  buffer_load_dwordx4 v[120:123], v26, s[24:27], s3 offen
  buffer_load_dwordx4 v[124:127], v26, s[28:31], s3 offen
  s_waitcnt vmcnt(16)
  v_max_u32 v28, v32, v33
  v_min_u32 v29, v32, v33
  v_med3_u32 v29, v28, v29, v34
  v_max_u32 v28, v28, v34
  v_med3_u32 v29, v28, v29, v35
  v_max_u32 v28, v28, v35
  v_med3_u32 v29, v28, v29, v36
  v_max_u32 v28, v28, v36
  v_med3_u32 v29, v28, v29, v37
  v_max_u32 v28, v28, v37
  v_med3_u32 v29, v28, v29, v38
  v_max_u32 v28, v28, v38
  v_med3_u32 v29, v28, v29, v39
  v_max_u32 v28, v28, v39
  v_med3_u32 v29, v28, v29, v40
  v_max_u32 v28, v28, v40
  v_med3_u32 v29, v28, v29, v41
  v_max_u32 v28, v28, v41
  v_med3_u32 v29, v28, v29, v42
  v_max_u32 v28, v28, v42
  v_med3_u32 v29, v28, v29, v43
  v_max_u32 v28, v28, v43
  v_med3_u32 v29, v28, v29, v44
  v_max_u32 v28, v28, v44
  v_med3_u32 v29, v28, v29, v45
  v_max_u32 v28, v28, v45
  v_med3_u32 v29, v28, v29, v46
  v_max_u32 v28, v28, v46
  v_med3_u32 v29, v28, v29, v47
  v_max_u32 v28, v28, v47
  v_med3_u32 v29, v28, v29, v48
  v_max_u32 v28, v28, v48
  v_med3_u32 v29, v28, v29, v49
  v_max_u32 v28, v28, v49
  v_med3_u32 v29, v28, v29, v50
  v_max_u32 v28, v28, v50
  v_med3_u32 v29, v28, v29, v51
  v_max_u32 v28, v28, v51
  v_med3_u32 v29, v28, v29, v52
  v_max_u32 v28, v28, v52
  v_med3_u32 v29, v28, v29, v53
  v_max_u32 v28, v28, v53
  v_med3_u32 v29, v28, v29, v54
  v_max_u32 v28, v28, v54
  v_med3_u32 v29, v28, v29, v55
  v_max_u32 v28, v28, v55
  v_med3_u32 v29, v28, v29, v56
  v_max_u32 v28, v28, v56
  v_med3_u32 v29, v28, v29, v57
  v_max_u32 v28, v28, v57
  v_med3_u32 v29, v28, v29, v58
  v_max_u32 v28, v28, v58
  v_med3_u32 v29, v28, v29, v59
  v_max_u32 v28, v28, v59
  v_med3_u32 v29, v28, v29, v60
  v_max_u32 v28, v28, v60
  v_med3_u32 v29, v28, v29, v61
  v_max_u32 v28, v28, v61
  v_med3_u32 v29, v28, v29, v62
  v_max_u32 v28, v28, v62
  v_med3_u32 v29, v28, v29, v63
  v_max_u32 v28, v28, v63
  v_mov_b32 v30, v28
  s_nop 1
  v_max_u32_dpp v30, v30, v30 quad_perm:[1,0,3,2] row_mask:0xf bank_mask:0xf
  s_nop 1
  v_max_u32_dpp v30, v30, v30 quad_perm:[2,3,0,1] row_mask:0xf bank_mask:0xf
  s_nop 1
  v_max_u32_dpp v30, v30, v30 row_half_mirror row_mask:0xf bank_mask:0xf
  s_nop 1
  v_max_u32_dpp v30, v30, v30 row_mirror row_mask:0xf bank_mask:0xf
  s_nop 0
  v_readlane_b32 s58, v30, 0
  v_readlane_b32 s59, v30, 16
  v_readlane_b32 s60, v30, 32
  v_readlane_b32 s61, v30, 48
  s_max_u32 s58, s58, s59
  s_max_u32 s60, s60, s61
  s_max_u32 s56, s58, s60
  v_cmp_eq_u32 vcc, s56, v28
  s_nop 1
  v_cndmask_b32 v30, v28, v29, vcc
  s_nop 1
  v_max_u32_dpp v30, v30, v30 quad_perm:[1,0,3,2] row_mask:0xf bank_mask:0xf
  s_nop 1
  v_max_u32_dpp v30, v30, v30 quad_perm:[2,3,0,1] row_mask:0xf bank_mask:0xf
  s_nop 1
  v_max_u32_dpp v30, v30, v30 row_half_mirror row_mask:0xf bank_mask:0xf
  s_nop 1
  v_max_u32_dpp v30, v30, v30 row_mirror row_mask:0xf bank_mask:0xf
  s_nop 0
  v_readlane_b32 s58, v30, 0
  v_readlane_b32 s59, v30, 16
  v_readlane_b32 s60, v30, 32
  v_readlane_b32 s61, v30, 48
  s_max_u32 s58, s58, s59
  s_max_u32 s60, s60, s61
  s_max_u32 s57, s58, s60
  s_and_b32 s3, s56, 0xffff
  s_sub_u32 s58, 0xffff, s3
  s_lshr_b32 s3, s58, 4
  s_lshl_b32 s3, s3, 15
  s_and_b32 s47, s58, 15
  s_lshl_b32 s47, s47, 4
  s_add_u32 s3, s3, s47
  s_lshl_b32 s47, s55, 10
  s_add_u32 s3, s3, s47
  v_lshlrev_b32 v27, 8, v24
  buffer_load_dwordx4 v[12:15], v27, s[16:19], s3 offen
  s_and_b32 s3, s57, 0xffff
  s_sub_u32 s59, 0xffff, s3
  s_lshr_b32 s3, s59, 4
  s_lshl_b32 s3, s3, 15
  s_and_b32 s47, s59, 15
  s_lshl_b32 s47, s47, 4
  s_add_u32 s3, s3, s47
  s_lshl_b32 s47, s55, 10
  s_add_u32 s3, s3, s47
  v_lshlrev_b32 v27, 8, v24
  buffer_load_dwordx4 v[28:31], v27, s[16:19], s3 offen
  s_or_b32 s3, s2, s32
  s_cmp_lg_u32 s3, 0
  s_cbranch_scc1 L_k2_nosel
  v_mov_b32 v32, s58
  v_mov_b32 v36, s56
  v_not_b32 v37, v36
  v_ashrrev_i32 v37, 31, v37
  v_or_b32 v37, 0x80000000, v37
  v_xor_b32 v36, v36, v37
  v_and_b32 v36, 0xffff0000, v36
  v_mul_f32 v36, 0xbfb8aa3b, v36
  v_exp_f32 v36, v36
  s_nop 0
  v_add_f32 v36, 1.0, v36
  v_rcp_f32 v36, v36
  s_nop 0
  v_cvt_pk_bf16_f32 v36, v36, v36
  v_and_b32 v34, 0xffff0000, v36
  v_mov_b32 v33, s59
  v_mov_b32 v36, s57
  v_not_b32 v37, v36
  v_ashrrev_i32 v37, 31, v37
  v_or_b32 v37, 0x80000000, v37
  v_xor_b32 v36, v36, v37
  v_and_b32 v36, 0xffff0000, v36
  v_mul_f32 v36, 0xbfb8aa3b, v36
  v_exp_f32 v36, v36
  s_nop 0
  v_add_f32 v36, 1.0, v36
  v_rcp_f32 v36, v36
  s_nop 0
  v_cvt_pk_bf16_f32 v36, v36, v36
  v_and_b32 v35, 0xffff0000, v36
  v_mov_b32 v36, 0
  s_mov_b32 s3, 4243456
  s_mov_b64 exec, 1
  buffer_store_dwordx4 v[32:35], v36, s[16:19], s3 offen
  s_mov_b64 exec, -1
L_k2_nosel:
  s_waitcnt vmcnt(0)
  s_cmp_ge_u32 s2, 224
  s_cbranch_scc1 L_k2_noffn
  v_lshlrev_b32 v1, 16, v12
  v_lshlrev_b32 v7, 16, v28
  v_lshlrev_b32 v26, 16, v64
  v_and_b32 v27, 0xffff0000, v64
  v_mul_f32 v32, v26, v1
  v_mul_f32 v33, v27, v1
  v_mul_f32 v40, v26, v7
  v_mul_f32 v41, v27, v7
  v_lshlrev_b32 v26, 16, v65
  v_and_b32 v27, 0xffff0000, v65
  v_mul_f32 v34, v26, v1
  v_mul_f32 v35, v27, v1
  v_mul_f32 v42, v26, v7
  v_mul_f32 v43, v27, v7
  v_lshlrev_b32 v26, 16, v66
  v_and_b32 v27, 0xffff0000, v66
  v_mul_f32 v36, v26, v1
  v_mul_f32 v37, v27, v1
  v_mul_f32 v44, v26, v7
  v_mul_f32 v45, v27, v7
  v_lshlrev_b32 v26, 16, v67
  v_and_b32 v27, 0xffff0000, v67
  v_mul_f32 v38, v26, v1
  v_mul_f32 v39, v27, v1
  v_mul_f32 v46, v26, v7
  v_mul_f32 v47, v27, v7
  v_lshlrev_b32 v26, 16, v68
  v_and_b32 v27, 0xffff0000, v68
  v_mul_f32 v48, v26, v1
  v_mul_f32 v49, v27, v1
  v_mul_f32 v56, v26, v7
  v_mul_f32 v57, v27, v7
  v_lshlrev_b32 v26, 16, v69
  v_and_b32 v27, 0xffff0000, v69
  v_mul_f32 v50, v26, v1
  v_mul_f32 v51, v27, v1
  v_mul_f32 v58, v26, v7
  v_mul_f32 v59, v27, v7
  v_lshlrev_b32 v26, 16, v70
  v_and_b32 v27, 0xffff0000, v70
  v_mul_f32 v52, v26, v1
  v_mul_f32 v53, v27, v1
  v_mul_f32 v60, v26, v7
  v_mul_f32 v61, v27, v7
  v_lshlrev_b32 v26, 16, v71
  v_and_b32 v27, 0xffff0000, v71
  v_mul_f32 v54, v26, v1
  v_mul_f32 v55, v27, v1
  v_mul_f32 v62, v26, v7
  v_mul_f32 v63, v27, v7
  v_and_b32 v1, 0xffff0000, v12
  v_and_b32 v7, 0xffff0000, v28
  v_lshlrev_b32 v26, 16, v72
  v_and_b32 v27, 0xffff0000, v72
  v_fmac_f32 v32, v26, v1
  v_fmac_f32 v33, v27, v1
  v_fmac_f32 v40, v26, v7
  v_fmac_f32 v41, v27, v7
  v_lshlrev_b32 v26, 16, v73
  v_and_b32 v27, 0xffff0000, v73
  v_fmac_f32 v34, v26, v1
  v_fmac_f32 v35, v27, v1
  v_fmac_f32 v42, v26, v7
  v_fmac_f32 v43, v27, v7
  v_lshlrev_b32 v26, 16, v74
  v_and_b32 v27, 0xffff0000, v74
  v_fmac_f32 v36, v26, v1
  v_fmac_f32 v37, v27, v1
  v_fmac_f32 v44, v26, v7
  v_fmac_f32 v45, v27, v7
  v_lshlrev_b32 v26, 16, v75
  v_and_b32 v27, 0xffff0000, v75
  v_fmac_f32 v38, v26, v1
  v_fmac_f32 v39, v27, v1
  v_fmac_f32 v46, v26, v7
  v_fmac_f32 v47, v27, v7
  v_lshlrev_b32 v26, 16, v76
  v_and_b32 v27, 0xffff0000, v76
  v_fmac_f32 v48, v26, v1
  v_fmac_f32 v49, v27, v1
  v_fmac_f32 v56, v26, v7
  v_fmac_f32 v57, v27, v7
  v_lshlrev_b32 v26, 16, v77
  v_and_b32 v27, 0xffff0000, v77
  v_fmac_f32 v50, v26, v1
  v_fmac_f32 v51, v27, v1
  v_fmac_f32 v58, v26, v7
  v_fmac_f32 v59, v27, v7
  v_lshlrev_b32 v26, 16, v78
  v_and_b32 v27, 0xffff0000, v78
  v_fmac_f32 v52, v26, v1
  v_fmac_f32 v53, v27, v1
  v_fmac_f32 v60, v26, v7
  v_fmac_f32 v61, v27, v7
  v_lshlrev_b32 v26, 16, v79
  v_and_b32 v27, 0xffff0000, v79
  v_fmac_f32 v54, v26, v1
  v_fmac_f32 v55, v27, v1
  v_fmac_f32 v62, v26, v7
  v_fmac_f32 v63, v27, v7
  v_lshlrev_b32 v1, 16, v13
  v_lshlrev_b32 v7, 16, v29
  v_lshlrev_b32 v26, 16, v80
  v_and_b32 v27, 0xffff0000, v80
  v_fmac_f32 v32, v26, v1
  v_fmac_f32 v33, v27, v1
  v_fmac_f32 v40, v26, v7
  v_fmac_f32 v41, v27, v7
  v_lshlrev_b32 v26, 16, v81
  v_and_b32 v27, 0xffff0000, v81
  v_fmac_f32 v34, v26, v1
  v_fmac_f32 v35, v27, v1
  v_fmac_f32 v42, v26, v7
  v_fmac_f32 v43, v27, v7
  v_lshlrev_b32 v26, 16, v82
  v_and_b32 v27, 0xffff0000, v82
  v_fmac_f32 v36, v26, v1
  v_fmac_f32 v37, v27, v1
  v_fmac_f32 v44, v26, v7
  v_fmac_f32 v45, v27, v7
  v_lshlrev_b32 v26, 16, v83
  v_and_b32 v27, 0xffff0000, v83
  v_fmac_f32 v38, v26, v1
  v_fmac_f32 v39, v27, v1
  v_fmac_f32 v46, v26, v7
  v_fmac_f32 v47, v27, v7
  v_lshlrev_b32 v26, 16, v84
  v_and_b32 v27, 0xffff0000, v84
  v_fmac_f32 v48, v26, v1
  v_fmac_f32 v49, v27, v1
  v_fmac_f32 v56, v26, v7
  v_fmac_f32 v57, v27, v7
  v_lshlrev_b32 v26, 16, v85
  v_and_b32 v27, 0xffff0000, v85
  v_fmac_f32 v50, v26, v1
  v_fmac_f32 v51, v27, v1
  v_fmac_f32 v58, v26, v7
  v_fmac_f32 v59, v27, v7
  v_lshlrev_b32 v26, 16, v86
  v_and_b32 v27, 0xffff0000, v86
  v_fmac_f32 v52, v26, v1
  v_fmac_f32 v53, v27, v1
  v_fmac_f32 v60, v26, v7
  v_fmac_f32 v61, v27, v7
  v_lshlrev_b32 v26, 16, v87
  v_and_b32 v27, 0xffff0000, v87
  v_fmac_f32 v54, v26, v1
  v_fmac_f32 v55, v27, v1
  v_fmac_f32 v62, v26, v7
  v_fmac_f32 v63, v27, v7
  v_and_b32 v1, 0xffff0000, v13
  v_and_b32 v7, 0xffff0000, v29
  v_lshlrev_b32 v26, 16, v88
  v_and_b32 v27, 0xffff0000, v88
  v_fmac_f32 v32, v26, v1
  v_fmac_f32 v33, v27, v1
  v_fmac_f32 v40, v26, v7
  v_fmac_f32 v41, v27, v7
  v_lshlrev_b32 v26, 16, v89
  v_and_b32 v27, 0xffff0000, v89
  v_fmac_f32 v34, v26, v1
  v_fmac_f32 v35, v27, v1
  v_fmac_f32 v42, v26, v7
  v_fmac_f32 v43, v27, v7
  v_lshlrev_b32 v26, 16, v90
  v_and_b32 v27, 0xffff0000, v90
  v_fmac_f32 v36, v26, v1
  v_fmac_f32 v37, v27, v1
  v_fmac_f32 v44, v26, v7
  v_fmac_f32 v45, v27, v7
  v_lshlrev_b32 v26, 16, v91
  v_and_b32 v27, 0xffff0000, v91
  v_fmac_f32 v38, v26, v1
  v_fmac_f32 v39, v27, v1
  v_fmac_f32 v46, v26, v7
  v_fmac_f32 v47, v27, v7
  v_lshlrev_b32 v26, 16, v92
  v_and_b32 v27, 0xffff0000, v92
  v_fmac_f32 v48, v26, v1
  v_fmac_f32 v49, v27, v1
  v_fmac_f32 v56, v26, v7
  v_fmac_f32 v57, v27, v7
  v_lshlrev_b32 v26, 16, v93
  v_and_b32 v27, 0xffff0000, v93
  v_fmac_f32 v50, v26, v1
  v_fmac_f32 v51, v27, v1
  v_fmac_f32 v58, v26, v7
  v_fmac_f32 v59, v27, v7
  v_lshlrev_b32 v26, 16, v94
  v_and_b32 v27, 0xffff0000, v94
  v_fmac_f32 v52, v26, v1
  v_fmac_f32 v53, v27, v1
  v_fmac_f32 v60, v26, v7
  v_fmac_f32 v61, v27, v7
  v_lshlrev_b32 v26, 16, v95
  v_and_b32 v27, 0xffff0000, v95
  v_fmac_f32 v54, v26, v1
  v_fmac_f32 v55, v27, v1
  v_fmac_f32 v62, v26, v7
  v_fmac_f32 v63, v27, v7
  v_lshlrev_b32 v1, 16, v14
  v_lshlrev_b32 v7, 16, v30
  v_lshlrev_b32 v26, 16, v96
  v_and_b32 v27, 0xffff0000, v96
  v_fmac_f32 v32, v26, v1
  v_fmac_f32 v33, v27, v1
  v_fmac_f32 v40, v26, v7
  v_fmac_f32 v41, v27, v7
  v_lshlrev_b32 v26, 16, v97
  v_and_b32 v27, 0xffff0000, v97
  v_fmac_f32 v34, v26, v1
  v_fmac_f32 v35, v27, v1
  v_fmac_f32 v42, v26, v7
  v_fmac_f32 v43, v27, v7
  v_lshlrev_b32 v26, 16, v98
  v_and_b32 v27, 0xffff0000, v98
  v_fmac_f32 v36, v26, v1
  v_fmac_f32 v37, v27, v1
  v_fmac_f32 v44, v26, v7
  v_fmac_f32 v45, v27, v7
  v_lshlrev_b32 v26, 16, v99
  v_and_b32 v27, 0xffff0000, v99
  v_fmac_f32 v38, v26, v1
  v_fmac_f32 v39, v27, v1
  v_fmac_f32 v46, v26, v7
  v_fmac_f32 v47, v27, v7
  v_lshlrev_b32 v26, 16, v100
  v_and_b32 v27, 0xffff0000, v100
  v_fmac_f32 v48, v26, v1
  v_fmac_f32 v49, v27, v1
  v_fmac_f32 v56, v26, v7
  v_fmac_f32 v57, v27, v7
  v_lshlrev_b32 v26, 16, v101
  v_and_b32 v27, 0xffff0000, v101
  v_fmac_f32 v50, v26, v1
  v_fmac_f32 v51, v27, v1
  v_fmac_f32 v58, v26, v7
  v_fmac_f32 v59, v27, v7
  v_lshlrev_b32 v26, 16, v102
  v_and_b32 v27, 0xffff0000, v102
  v_fmac_f32 v52, v26, v1
  v_fmac_f32 v53, v27, v1
  v_fmac_f32 v60, v26, v7
  v_fmac_f32 v61, v27, v7
  v_lshlrev_b32 v26, 16, v103
  v_and_b32 v27, 0xffff0000, v103
  v_fmac_f32 v54, v26, v1
  v_fmac_f32 v55, v27, v1
  v_fmac_f32 v62, v26, v7
  v_fmac_f32 v63, v27, v7
  v_and_b32 v1, 0xffff0000, v14
  v_and_b32 v7, 0xffff0000, v30
  v_lshlrev_b32 v26, 16, v104
  v_and_b32 v27, 0xffff0000, v104
  v_fmac_f32 v32, v26, v1
  v_fmac_f32 v33, v27, v1
  v_fmac_f32 v40, v26, v7
  v_fmac_f32 v41, v27, v7
  v_lshlrev_b32 v26, 16, v105
  v_and_b32 v27, 0xffff0000, v105
  v_fmac_f32 v34, v26, v1
  v_fmac_f32 v35, v27, v1
  v_fmac_f32 v42, v26, v7
  v_fmac_f32 v43, v27, v7
  v_lshlrev_b32 v26, 16, v106
  v_and_b32 v27, 0xffff0000, v106
  v_fmac_f32 v36, v26, v1
  v_fmac_f32 v37, v27, v1
  v_fmac_f32 v44, v26, v7
  v_fmac_f32 v45, v27, v7
  v_lshlrev_b32 v26, 16, v107
  v_and_b32 v27, 0xffff0000, v107
  v_fmac_f32 v38, v26, v1
  v_fmac_f32 v39, v27, v1
  v_fmac_f32 v46, v26, v7
  v_fmac_f32 v47, v27, v7
  v_lshlrev_b32 v26, 16, v108
  v_and_b32 v27, 0xffff0000, v108
  v_fmac_f32 v48, v26, v1
  v_fmac_f32 v49, v27, v1
  v_fmac_f32 v56, v26, v7
  v_fmac_f32 v57, v27, v7
  v_lshlrev_b32 v26, 16, v109
  v_and_b32 v27, 0xffff0000, v109
  v_fmac_f32 v50, v26, v1
  v_fmac_f32 v51, v27, v1
  v_fmac_f32 v58, v26, v7
  v_fmac_f32 v59, v27, v7
  v_lshlrev_b32 v26, 16, v110
  v_and_b32 v27, 0xffff0000, v110
  v_fmac_f32 v52, v26, v1
  v_fmac_f32 v53, v27, v1
  v_fmac_f32 v60, v26, v7
  v_fmac_f32 v61, v27, v7
  v_lshlrev_b32 v26, 16, v111
  v_and_b32 v27, 0xffff0000, v111
  v_fmac_f32 v54, v26, v1
  v_fmac_f32 v55, v27, v1
  v_fmac_f32 v62, v26, v7
  v_fmac_f32 v63, v27, v7
  v_lshlrev_b32 v1, 16, v15
  v_lshlrev_b32 v7, 16, v31
  v_lshlrev_b32 v26, 16, v112
  v_and_b32 v27, 0xffff0000, v112
  v_fmac_f32 v32, v26, v1
  v_fmac_f32 v33, v27, v1
  v_fmac_f32 v40, v26, v7
  v_fmac_f32 v41, v27, v7
  v_lshlrev_b32 v26, 16, v113
  v_and_b32 v27, 0xffff0000, v113
  v_fmac_f32 v34, v26, v1
  v_fmac_f32 v35, v27, v1
  v_fmac_f32 v42, v26, v7
  v_fmac_f32 v43, v27, v7
  v_lshlrev_b32 v26, 16, v114
  v_and_b32 v27, 0xffff0000, v114
  v_fmac_f32 v36, v26, v1
  v_fmac_f32 v37, v27, v1
  v_fmac_f32 v44, v26, v7
  v_fmac_f32 v45, v27, v7
  v_lshlrev_b32 v26, 16, v115
  v_and_b32 v27, 0xffff0000, v115
  v_fmac_f32 v38, v26, v1
  v_fmac_f32 v39, v27, v1
  v_fmac_f32 v46, v26, v7
  v_fmac_f32 v47, v27, v7
  v_lshlrev_b32 v26, 16, v116
  v_and_b32 v27, 0xffff0000, v116
  v_fmac_f32 v48, v26, v1
  v_fmac_f32 v49, v27, v1
  v_fmac_f32 v56, v26, v7
  v_fmac_f32 v57, v27, v7
  v_lshlrev_b32 v26, 16, v117
  v_and_b32 v27, 0xffff0000, v117
  v_fmac_f32 v50, v26, v1
  v_fmac_f32 v51, v27, v1
  v_fmac_f32 v58, v26, v7
  v_fmac_f32 v59, v27, v7
  v_lshlrev_b32 v26, 16, v118
  v_and_b32 v27, 0xffff0000, v118
  v_fmac_f32 v52, v26, v1
  v_fmac_f32 v53, v27, v1
  v_fmac_f32 v60, v26, v7
  v_fmac_f32 v61, v27, v7
  v_lshlrev_b32 v26, 16, v119
  v_and_b32 v27, 0xffff0000, v119
  v_fmac_f32 v54, v26, v1
  v_fmac_f32 v55, v27, v1
  v_fmac_f32 v62, v26, v7
  v_fmac_f32 v63, v27, v7
  v_and_b32 v1, 0xffff0000, v15
  v_and_b32 v7, 0xffff0000, v31
  v_lshlrev_b32 v26, 16, v120
  v_and_b32 v27, 0xffff0000, v120
  v_fmac_f32 v32, v26, v1
  v_fmac_f32 v33, v27, v1
  v_fmac_f32 v40, v26, v7
  v_fmac_f32 v41, v27, v7
  v_lshlrev_b32 v26, 16, v121
  v_and_b32 v27, 0xffff0000, v121
  v_fmac_f32 v34, v26, v1
  v_fmac_f32 v35, v27, v1
  v_fmac_f32 v42, v26, v7
  v_fmac_f32 v43, v27, v7
  v_lshlrev_b32 v26, 16, v122
  v_and_b32 v27, 0xffff0000, v122
  v_fmac_f32 v36, v26, v1
  v_fmac_f32 v37, v27, v1
  v_fmac_f32 v44, v26, v7
  v_fmac_f32 v45, v27, v7
  v_lshlrev_b32 v26, 16, v123
  v_and_b32 v27, 0xffff0000, v123
  v_fmac_f32 v38, v26, v1
  v_fmac_f32 v39, v27, v1
  v_fmac_f32 v46, v26, v7
  v_fmac_f32 v47, v27, v7
  v_lshlrev_b32 v26, 16, v124
  v_and_b32 v27, 0xffff0000, v124
  v_fmac_f32 v48, v26, v1
  v_fmac_f32 v49, v27, v1
  v_fmac_f32 v56, v26, v7
  v_fmac_f32 v57, v27, v7
  v_lshlrev_b32 v26, 16, v125
  v_and_b32 v27, 0xffff0000, v125
  v_fmac_f32 v50, v26, v1
  v_fmac_f32 v51, v27, v1
  v_fmac_f32 v58, v26, v7
  v_fmac_f32 v59, v27, v7
  v_lshlrev_b32 v26, 16, v126
  v_and_b32 v27, 0xffff0000, v126
  v_fmac_f32 v52, v26, v1
  v_fmac_f32 v53, v27, v1
  v_fmac_f32 v60, v26, v7
  v_fmac_f32 v61, v27, v7
  v_lshlrev_b32 v26, 16, v127
  v_and_b32 v27, 0xffff0000, v127
  v_fmac_f32 v54, v26, v1
  v_fmac_f32 v55, v27, v1
  v_fmac_f32 v62, v26, v7
  v_fmac_f32 v63, v27, v7
  v_permlane32_swap_b32 v32, v48
  v_permlane32_swap_b32 v33, v49
  v_permlane32_swap_b32 v34, v50
  v_permlane32_swap_b32 v35, v51
  v_permlane32_swap_b32 v36, v52
  v_permlane32_swap_b32 v37, v53
  v_permlane32_swap_b32 v38, v54
  v_permlane32_swap_b32 v39, v55
  v_permlane32_swap_b32 v40, v56
  v_permlane32_swap_b32 v41, v57
  v_permlane32_swap_b32 v42, v58
  v_permlane32_swap_b32 v43, v59
  v_permlane32_swap_b32 v44, v60
  v_permlane32_swap_b32 v45, v61
  v_permlane32_swap_b32 v46, v62
  v_permlane32_swap_b32 v47, v63
  v_add_f32 v32, v32, v48
  v_add_f32 v33, v33, v49
  v_add_f32 v34, v34, v50
  v_add_f32 v35, v35, v51
  v_add_f32 v36, v36, v52
  v_add_f32 v37, v37, v53
  v_add_f32 v38, v38, v54
  v_add_f32 v39, v39, v55
  v_add_f32 v40, v40, v56
  v_add_f32 v41, v41, v57
  v_add_f32 v42, v42, v58
  v_add_f32 v43, v43, v59
  v_add_f32 v44, v44, v60
  v_add_f32 v45, v45, v61
  v_add_f32 v46, v46, v62
  v_add_f32 v47, v47, v63
  v_permlane16_swap_b32 v32, v40
  v_permlane16_swap_b32 v33, v41
  v_permlane16_swap_b32 v34, v42
  v_permlane16_swap_b32 v35, v43
  v_permlane16_swap_b32 v36, v44
  v_permlane16_swap_b32 v37, v45
  v_permlane16_swap_b32 v38, v46
  v_permlane16_swap_b32 v39, v47
  v_add_f32 v32, v32, v40
  v_add_f32 v33, v33, v41
  v_add_f32 v34, v34, v42
  v_add_f32 v35, v35, v43
  v_add_f32 v36, v36, v44
  v_add_f32 v37, v37, v45
  v_add_f32 v38, v38, v46
  v_add_f32 v39, v39, v47
  s_lshl_b32 s3, s32, 11
  s_add_u32 s3, s3, 131072
  v_add_u32 v26, s3, v2
  ds_write_b128 v26, v[32:35]
  ds_write_b128 v26, v[36:39] offset:1024
  s_waitcnt lgkmcnt(0)
  s_barrier
  s_cmp_ge_u32 s32, 2
  s_cbranch_scc1 L_k2_noffn
  s_lshl_b32 s3, s32, 10
  s_add_u32 s3, s3, 131072
  v_add_u32 v26, s3, v2
  ds_read_b128 v[32:35], v26 offset:0
  ds_read_b128 v[36:39], v26 offset:2048
  ds_read_b128 v[40:43], v26 offset:4096
  ds_read_b128 v[44:47], v26 offset:6144
  v_mul_u32_u24 v27, 14336, v24
  v_lshl_add_u32 v27, v25, 5, v27
  s_mul_i32 s3, s53, 57344
  s_lshl_b32 s47, s54, 9
  s_add_u32 s3, s3, s47
  s_lshl_b32 s47, s32, 4
  s_add_u32 s3, s3, s47
  s_add_u32 s3, s3, 5242880
  s_waitcnt lgkmcnt(0)
  v_add_f32 v32, v32, v36
  v_add_f32 v40, v40, v44
  v_add_f32 v32, v32, v40
  v_add_f32 v33, v33, v37
  v_add_f32 v41, v41, v45
  v_add_f32 v33, v33, v41
  v_add_f32 v34, v34, v38
  v_add_f32 v42, v42, v46
  v_add_f32 v34, v34, v42
  v_add_f32 v35, v35, v39
  v_add_f32 v43, v43, v47
  v_add_f32 v35, v35, v43
  buffer_store_dwordx4 v[32:35], v27, s[16:19], s3 offen
L_k2_noffn:
  s_barrier
  ds_read_b64_tr_b16 a[192:193], v16 offset:0
  ds_read_b64_tr_b16 a[194:195], v16 offset:1024
  ds_read_b64_tr_b16 a[196:197], v17 offset:0
  ds_read_b64_tr_b16 a[198:199], v17 offset:1024
  ds_read_b64_tr_b16 a[200:201], v18 offset:0
  ds_read_b64_tr_b16 a[202:203], v18 offset:1024
  ds_read_b64_tr_b16 a[204:205], v19 offset:0
  ds_read_b64_tr_b16 a[206:207], v19 offset:1024
  ds_read_b64_tr_b16 a[208:209], v20 offset:0
  ds_read_b64_tr_b16 a[210:211], v20 offset:1024
  ds_read_b64_tr_b16 a[212:213], v21 offset:0
  ds_read_b64_tr_b16 a[214:215], v21 offset:1024
  s_waitcnt lgkmcnt(4)
  ds_read_b64_tr_b16 a[216:217], v22 offset:0
  ds_read_b64_tr_b16 a[218:219], v22 offset:1024
  ds_read_b64_tr_b16 a[220:221], v23 offset:0
  ds_read_b64_tr_b16 a[222:223], v23 offset:1024
  s_waitcnt lgkmcnt(0)
  v_mfma_f32_16x16x32_bf16 v[128:131], a[192:195], a[0:3], v[128:131]
  s_add_u32 m0, s44, 114688
  v_mfma_f32_16x16x32_bf16 v[132:135], a[192:195], a[4:7], v[132:135]
  ds_read_b64_tr_b16 a[224:225], v16 offset:8192
  ds_read_b64_tr_b16 a[226:227], v16 offset:9216
  v_mfma_f32_16x16x32_bf16 v[136:139], a[192:195], a[8:11], v[136:139]
  buffer_load_dwordx4 v8, s[8:11], s48 offen offset:0 lds
  v_mfma_f32_16x16x32_bf16 v[140:143], a[192:195], a[12:15], v[140:143]
  v_mfma_f32_16x16x32_bf16 v[144:147], a[196:199], a[0:3], v[144:147]
  ds_read_b64_tr_b16 a[228:229], v17 offset:8192
  ds_read_b64_tr_b16 a[230:231], v17 offset:9216
  v_mfma_f32_16x16x32_bf16 v[148:151], a[196:199], a[4:7], v[148:151]
  v_mfma_f32_16x16x32_bf16 v[152:155], a[196:199], a[8:11], v[152:155]
  buffer_load_dwordx4 v8, s[8:11], s49 offen offset:1024 lds
  v_mfma_f32_16x16x32_bf16 v[156:159], a[196:199], a[12:15], v[156:159]
  ds_read_b64_tr_b16 a[232:233], v18 offset:8192
  ds_read_b64_tr_b16 a[234:235], v18 offset:9216
  v_mfma_f32_16x16x32_bf16 v[160:163], a[200:203], a[0:3], v[160:163]
  v_mfma_f32_16x16x32_bf16 v[164:167], a[200:203], a[4:7], v[164:167]
  v_mfma_f32_16x16x32_bf16 v[168:171], a[200:203], a[8:11], v[168:171]
  ds_read_b64_tr_b16 a[236:237], v19 offset:8192
  ds_read_b64_tr_b16 a[238:239], v19 offset:9216
  v_mfma_f32_16x16x32_bf16 v[172:175], a[200:203], a[12:15], v[172:175]
  buffer_load_dwordx4 a[112:115], v10, s[16:19], 0 offen offset:3072
  v_mfma_f32_16x16x32_bf16 v[176:179], a[204:207], a[0:3], v[176:179]
  v_mfma_f32_16x16x32_bf16 v[180:183], a[204:207], a[4:7], v[180:183]
  ds_read_b64_tr_b16 a[240:241], v20 offset:8192
  ds_read_b64_tr_b16 a[242:243], v20 offset:9216
  v_mfma_f32_16x16x32_bf16 v[184:187], a[204:207], a[8:11], v[184:187]
  v_mfma_f32_16x16x32_bf16 v[188:191], a[204:207], a[12:15], v[188:191]
  buffer_load_dwordx4 a[116:119], v10, s[16:19], s52 offen offset:3072
  v_mfma_f32_16x16x32_bf16 v[192:195], a[208:211], a[0:3], v[192:195]
  s_waitcnt lgkmcnt(6)
  ds_read_b64_tr_b16 a[244:245], v21 offset:8192
  ds_read_b64_tr_b16 a[246:247], v21 offset:9216
  v_mfma_f32_16x16x32_bf16 v[196:199], a[208:211], a[4:7], v[196:199]
  v_mfma_f32_16x16x32_bf16 v[200:203], a[208:211], a[8:11], v[200:203]
  v_mfma_f32_16x16x32_bf16 v[204:207], a[208:211], a[12:15], v[204:207]
  ds_read_b64_tr_b16 a[248:249], v22 offset:8192
  ds_read_b64_tr_b16 a[250:251], v22 offset:9216
  v_mfma_f32_16x16x32_bf16 v[208:211], a[212:215], a[0:3], v[208:211]
  buffer_load_dwordx4 a[120:123], v11, s[16:19], 0 offen offset:3072
  v_mfma_f32_16x16x32_bf16 v[212:215], a[212:215], a[4:7], v[212:215]
  v_mfma_f32_16x16x32_bf16 v[216:219], a[212:215], a[8:11], v[216:219]
  ds_read_b64_tr_b16 a[252:253], v23 offset:8192
  ds_read_b64_tr_b16 a[254:255], v23 offset:9216
  v_mfma_f32_16x16x32_bf16 v[220:223], a[212:215], a[12:15], v[220:223]
  v_mfma_f32_16x16x32_bf16 v[224:227], a[216:219], a[0:3], v[224:227]
  buffer_load_dwordx4 a[124:127], v11, s[16:19], s52 offen offset:3072
  v_mfma_f32_16x16x32_bf16 v[228:231], a[216:219], a[4:7], v[228:231]
  v_add_u32 v10, 4096, v10
  v_add_u32 v11, 4096, v11
  v_mfma_f32_16x16x32_bf16 v[232:235], a[216:219], a[8:11], v[232:235]
  v_mfma_f32_16x16x32_bf16 v[236:239], a[216:219], a[12:15], v[236:239]
  v_mfma_f32_16x16x32_bf16 v[240:243], a[220:223], a[0:3], v[240:243]
  v_mfma_f32_16x16x32_bf16 v[244:247], a[220:223], a[4:7], v[244:247]
  v_mfma_f32_16x16x32_bf16 v[248:251], a[220:223], a[8:11], v[248:251]
  v_mfma_f32_16x16x32_bf16 v[252:255], a[220:223], a[12:15], v[252:255]
  s_waitcnt lgkmcnt(0)
  s_barrier
  v_mfma_f32_16x16x32_bf16 v[128:131], a[224:227], a[16:19], v[128:131]
  v_mfma_f32_16x16x32_bf16 v[132:135], a[224:227], a[20:23], v[132:135]
  ds_read_b64_tr_b16 a[192:193], v16 offset:16384
  ds_read_b64_tr_b16 a[194:195], v16 offset:17408
  v_mfma_f32_16x16x32_bf16 v[136:139], a[224:227], a[24:27], v[136:139]
  buffer_load_dwordx4 v9, s[8:11], s50 offen offset:2048 lds
  v_mfma_f32_16x16x32_bf16 v[140:143], a[224:227], a[28:31], v[140:143]
  v_mfma_f32_16x16x32_bf16 v[144:147], a[228:231], a[16:19], v[144:147]
  ds_read_b64_tr_b16 a[196:197], v17 offset:16384
  ds_read_b64_tr_b16 a[198:199], v17 offset:17408
  v_mfma_f32_16x16x32_bf16 v[148:151], a[228:231], a[20:23], v[148:151]
  v_mfma_f32_16x16x32_bf16 v[152:155], a[228:231], a[24:27], v[152:155]
  buffer_load_dwordx4 v9, s[8:11], s51 offen offset:3072 lds
  v_mfma_f32_16x16x32_bf16 v[156:159], a[228:231], a[28:31], v[156:159]
  ds_read_b64_tr_b16 a[200:201], v18 offset:16384
  ds_read_b64_tr_b16 a[202:203], v18 offset:17408
  v_mfma_f32_16x16x32_bf16 v[160:163], a[232:235], a[16:19], v[160:163]
  v_add_u32 v8, 524288, v8
  v_add_u32 v9, 524288, v9
  v_mfma_f32_16x16x32_bf16 v[164:167], a[232:235], a[20:23], v[164:167]
  v_mfma_f32_16x16x32_bf16 v[168:171], a[232:235], a[24:27], v[168:171]
  ds_read_b64_tr_b16 a[204:205], v19 offset:16384
  ds_read_b64_tr_b16 a[206:207], v19 offset:17408
  v_mfma_f32_16x16x32_bf16 v[172:175], a[232:235], a[28:31], v[172:175]
  buffer_load_dwordx4 a[0:3], v10, s[16:19], 0 offen offset:0
  v_mfma_f32_16x16x32_bf16 v[176:179], a[236:239], a[16:19], v[176:179]
  v_mfma_f32_16x16x32_bf16 v[180:183], a[236:239], a[20:23], v[180:183]
  ds_read_b64_tr_b16 a[208:209], v20 offset:16384
  ds_read_b64_tr_b16 a[210:211], v20 offset:17408
  v_mfma_f32_16x16x32_bf16 v[184:187], a[236:239], a[24:27], v[184:187]
  v_mfma_f32_16x16x32_bf16 v[188:191], a[236:239], a[28:31], v[188:191]
  buffer_load_dwordx4 a[4:7], v10, s[16:19], s52 offen offset:0
  v_mfma_f32_16x16x32_bf16 v[192:195], a[240:243], a[16:19], v[192:195]
  s_waitcnt lgkmcnt(6)
  ds_read_b64_tr_b16 a[212:213], v21 offset:16384
  ds_read_b64_tr_b16 a[214:215], v21 offset:17408
  v_mfma_f32_16x16x32_bf16 v[196:199], a[240:243], a[20:23], v[196:199]
  v_mfma_f32_16x16x32_bf16 v[200:203], a[240:243], a[24:27], v[200:203]
  v_mfma_f32_16x16x32_bf16 v[204:207], a[240:243], a[28:31], v[204:207]
  ds_read_b64_tr_b16 a[216:217], v22 offset:16384
  ds_read_b64_tr_b16 a[218:219], v22 offset:17408
  v_mfma_f32_16x16x32_bf16 v[208:211], a[244:247], a[16:19], v[208:211]
  buffer_load_dwordx4 a[8:11], v11, s[16:19], 0 offen offset:0
  v_mfma_f32_16x16x32_bf16 v[212:215], a[244:247], a[20:23], v[212:215]
  v_mfma_f32_16x16x32_bf16 v[216:219], a[244:247], a[24:27], v[216:219]
  ds_read_b64_tr_b16 a[220:221], v23 offset:16384
  ds_read_b64_tr_b16 a[222:223], v23 offset:17408
  v_mfma_f32_16x16x32_bf16 v[220:223], a[244:247], a[28:31], v[220:223]
  v_mfma_f32_16x16x32_bf16 v[224:227], a[248:251], a[16:19], v[224:227]
  buffer_load_dwordx4 a[12:15], v11, s[16:19], s52 offen offset:0
  v_mfma_f32_16x16x32_bf16 v[228:231], a[248:251], a[20:23], v[228:231]
  v_mfma_f32_16x16x32_bf16 v[232:235], a[248:251], a[24:27], v[232:235]
  v_mfma_f32_16x16x32_bf16 v[236:239], a[248:251], a[28:31], v[236:239]
  v_mfma_f32_16x16x32_bf16 v[240:243], a[252:255], a[16:19], v[240:243]
  v_mfma_f32_16x16x32_bf16 v[244:247], a[252:255], a[20:23], v[244:247]
  v_mfma_f32_16x16x32_bf16 v[248:251], a[252:255], a[24:27], v[248:251]
  v_mfma_f32_16x16x32_bf16 v[252:255], a[252:255], a[28:31], v[252:255]
  s_waitcnt lgkmcnt(0)
  v_mfma_f32_16x16x32_bf16 v[128:131], a[192:195], a[32:35], v[128:131]
  s_add_u32 m0, s44, 0
  v_mfma_f32_16x16x32_bf16 v[132:135], a[192:195], a[36:39], v[132:135]
  ds_read_b64_tr_b16 a[224:225], v16 offset:24576
  ds_read_b64_tr_b16 a[226:227], v16 offset:25600
  v_mfma_f32_16x16x32_bf16 v[136:139], a[192:195], a[40:43], v[136:139]
  buffer_load_dwordx4 v8, s[8:11], s48 offen offset:0 lds
  v_mfma_f32_16x16x32_bf16 v[140:143], a[192:195], a[44:47], v[140:143]
  v_mfma_f32_16x16x32_bf16 v[144:147], a[196:199], a[32:35], v[144:147]
  ds_read_b64_tr_b16 a[228:229], v17 offset:24576
  ds_read_b64_tr_b16 a[230:231], v17 offset:25600
  v_mfma_f32_16x16x32_bf16 v[148:151], a[196:199], a[36:39], v[148:151]
  v_mfma_f32_16x16x32_bf16 v[152:155], a[196:199], a[40:43], v[152:155]
  buffer_load_dwordx4 v8, s[8:11], s49 offen offset:1024 lds
  v_mfma_f32_16x16x32_bf16 v[156:159], a[196:199], a[44:47], v[156:159]
  ds_read_b64_tr_b16 a[232:233], v18 offset:24576
  ds_read_b64_tr_b16 a[234:235], v18 offset:25600
  v_mfma_f32_16x16x32_bf16 v[160:163], a[200:203], a[32:35], v[160:163]
  v_mfma_f32_16x16x32_bf16 v[164:167], a[200:203], a[36:39], v[164:167]
  v_mfma_f32_16x16x32_bf16 v[168:171], a[200:203], a[40:43], v[168:171]
  ds_read_b64_tr_b16 a[236:237], v19 offset:24576
  ds_read_b64_tr_b16 a[238:239], v19 offset:25600
  v_mfma_f32_16x16x32_bf16 v[172:175], a[200:203], a[44:47], v[172:175]
  buffer_load_dwordx4 a[16:19], v10, s[16:19], 0 offen offset:1024
  v_mfma_f32_16x16x32_bf16 v[176:179], a[204:207], a[32:35], v[176:179]
  v_mfma_f32_16x16x32_bf16 v[180:183], a[204:207], a[36:39], v[180:183]
  ds_read_b64_tr_b16 a[240:241], v20 offset:24576
  ds_read_b64_tr_b16 a[242:243], v20 offset:25600
  v_mfma_f32_16x16x32_bf16 v[184:187], a[204:207], a[40:43], v[184:187]
  v_mfma_f32_16x16x32_bf16 v[188:191], a[204:207], a[44:47], v[188:191]
  buffer_load_dwordx4 a[20:23], v10, s[16:19], s52 offen offset:1024
  v_mfma_f32_16x16x32_bf16 v[192:195], a[208:211], a[32:35], v[192:195]
  s_waitcnt lgkmcnt(6)
  ds_read_b64_tr_b16 a[244:245], v21 offset:24576
  ds_read_b64_tr_b16 a[246:247], v21 offset:25600
  v_mfma_f32_16x16x32_bf16 v[196:199], a[208:211], a[36:39], v[196:199]
  v_mfma_f32_16x16x32_bf16 v[200:203], a[208:211], a[40:43], v[200:203]
  v_mfma_f32_16x16x32_bf16 v[204:207], a[208:211], a[44:47], v[204:207]
  ds_read_b64_tr_b16 a[248:249], v22 offset:24576
  ds_read_b64_tr_b16 a[250:251], v22 offset:25600
  v_mfma_f32_16x16x32_bf16 v[208:211], a[212:215], a[32:35], v[208:211]
  buffer_load_dwordx4 a[24:27], v11, s[16:19], 0 offen offset:1024
  v_mfma_f32_16x16x32_bf16 v[212:215], a[212:215], a[36:39], v[212:215]
  v_mfma_f32_16x16x32_bf16 v[216:219], a[212:215], a[40:43], v[216:219]
  ds_read_b64_tr_b16 a[252:253], v23 offset:24576
  ds_read_b64_tr_b16 a[254:255], v23 offset:25600
  v_mfma_f32_16x16x32_bf16 v[220:223], a[212:215], a[44:47], v[220:223]
  v_mfma_f32_16x16x32_bf16 v[224:227], a[216:219], a[32:35], v[224:227]
  buffer_load_dwordx4 a[28:31], v11, s[16:19], s52 offen offset:1024
  v_mfma_f32_16x16x32_bf16 v[228:231], a[216:219], a[36:39], v[228:231]
  v_mfma_f32_16x16x32_bf16 v[232:235], a[216:219], a[40:43], v[232:235]
  v_mfma_f32_16x16x32_bf16 v[236:239], a[216:219], a[44:47], v[236:239]
  v_mfma_f32_16x16x32_bf16 v[240:243], a[220:223], a[32:35], v[240:243]
  v_mfma_f32_16x16x32_bf16 v[244:247], a[220:223], a[36:39], v[244:247]
  v_mfma_f32_16x16x32_bf16 v[248:251], a[220:223], a[40:43], v[248:251]
  v_mfma_f32_16x16x32_bf16 v[252:255], a[220:223], a[44:47], v[252:255]
  s_waitcnt lgkmcnt(0)
  s_barrier
  v_mfma_f32_16x16x32_bf16 v[128:131], a[224:227], a[48:51], v[128:131]
  v_mfma_f32_16x16x32_bf16 v[132:135], a[224:227], a[52:55], v[132:135]
  ds_read_b64_tr_b16 a[192:193], v16 offset:32768
  ds_read_b64_tr_b16 a[194:195], v16 offset:33792
  v_mfma_f32_16x16x32_bf16 v[136:139], a[224:227], a[56:59], v[136:139]
  buffer_load_dwordx4 v9, s[8:11], s50 offen offset:2048 lds
  v_mfma_f32_16x16x32_bf16 v[140:143], a[224:227], a[60:63], v[140:143]
  v_mfma_f32_16x16x32_bf16 v[144:147], a[228:231], a[48:51], v[144:147]
  ds_read_b64_tr_b16 a[196:197], v17 offset:32768
  ds_read_b64_tr_b16 a[198:199], v17 offset:33792
  v_mfma_f32_16x16x32_bf16 v[148:151], a[228:231], a[52:55], v[148:151]
  v_mfma_f32_16x16x32_bf16 v[152:155], a[228:231], a[56:59], v[152:155]
  buffer_load_dwordx4 v9, s[8:11], s51 offen offset:3072 lds
  v_mfma_f32_16x16x32_bf16 v[156:159], a[228:231], a[60:63], v[156:159]
  ds_read_b64_tr_b16 a[200:201], v18 offset:32768
  ds_read_b64_tr_b16 a[202:203], v18 offset:33792
  v_mfma_f32_16x16x32_bf16 v[160:163], a[232:235], a[48:51], v[160:163]
  v_add_u32 v8, 524288, v8
  v_add_u32 v9, 524288, v9
  v_mfma_f32_16x16x32_bf16 v[164:167], a[232:235], a[52:55], v[164:167]
  v_mfma_f32_16x16x32_bf16 v[168:171], a[232:235], a[56:59], v[168:171]
  ds_read_b64_tr_b16 a[204:205], v19 offset:32768
  ds_read_b64_tr_b16 a[206:207], v19 offset:33792
  v_mfma_f32_16x16x32_bf16 v[172:175], a[232:235], a[60:63], v[172:175]
  buffer_load_dwordx4 a[32:35], v10, s[16:19], 0 offen offset:2048
  v_mfma_f32_16x16x32_bf16 v[176:179], a[236:239], a[48:51], v[176:179]
  v_mfma_f32_16x16x32_bf16 v[180:183], a[236:239], a[52:55], v[180:183]
  ds_read_b64_tr_b16 a[208:209], v20 offset:32768
  ds_read_b64_tr_b16 a[210:211], v20 offset:33792
  v_mfma_f32_16x16x32_bf16 v[184:187], a[236:239], a[56:59], v[184:187]
  v_mfma_f32_16x16x32_bf16 v[188:191], a[236:239], a[60:63], v[188:191]
  buffer_load_dwordx4 a[36:39], v10, s[16:19], s52 offen offset:2048
  v_mfma_f32_16x16x32_bf16 v[192:195], a[240:243], a[48:51], v[192:195]
  s_waitcnt lgkmcnt(6)
  ds_read_b64_tr_b16 a[212:213], v21 offset:32768
  ds_read_b64_tr_b16 a[214:215], v21 offset:33792
  v_mfma_f32_16x16x32_bf16 v[196:199], a[240:243], a[52:55], v[196:199]
  v_mfma_f32_16x16x32_bf16 v[200:203], a[240:243], a[56:59], v[200:203]
  v_mfma_f32_16x16x32_bf16 v[204:207], a[240:243], a[60:63], v[204:207]
  ds_read_b64_tr_b16 a[216:217], v22 offset:32768
  ds_read_b64_tr_b16 a[218:219], v22 offset:33792
  v_mfma_f32_16x16x32_bf16 v[208:211], a[244:247], a[48:51], v[208:211]
  buffer_load_dwordx4 a[40:43], v11, s[16:19], 0 offen offset:2048
  v_mfma_f32_16x16x32_bf16 v[212:215], a[244:247], a[52:55], v[212:215]
  v_mfma_f32_16x16x32_bf16 v[216:219], a[244:247], a[56:59], v[216:219]
  ds_read_b64_tr_b16 a[220:221], v23 offset:32768
  ds_read_b64_tr_b16 a[222:223], v23 offset:33792
  v_mfma_f32_16x16x32_bf16 v[220:223], a[244:247], a[60:63], v[220:223]
  v_mfma_f32_16x16x32_bf16 v[224:227], a[248:251], a[48:51], v[224:227]
  buffer_load_dwordx4 a[44:47], v11, s[16:19], s52 offen offset:2048
  v_mfma_f32_16x16x32_bf16 v[228:231], a[248:251], a[52:55], v[228:231]
  v_mfma_f32_16x16x32_bf16 v[232:235], a[248:251], a[56:59], v[232:235]
  v_mfma_f32_16x16x32_bf16 v[236:239], a[248:251], a[60:63], v[236:239]
  v_mfma_f32_16x16x32_bf16 v[240:243], a[252:255], a[48:51], v[240:243]
  v_mfma_f32_16x16x32_bf16 v[244:247], a[252:255], a[52:55], v[244:247]
  v_mfma_f32_16x16x32_bf16 v[248:251], a[252:255], a[56:59], v[248:251]
  v_mfma_f32_16x16x32_bf16 v[252:255], a[252:255], a[60:63], v[252:255]
  s_waitcnt lgkmcnt(0)
  v_mfma_f32_16x16x32_bf16 v[128:131], a[192:195], a[64:67], v[128:131]
  s_add_u32 m0, s44, 16384
  v_mfma_f32_16x16x32_bf16 v[132:135], a[192:195], a[68:71], v[132:135]
  ds_read_b64_tr_b16 a[224:225], v16 offset:40960
  ds_read_b64_tr_b16 a[226:227], v16 offset:41984
  v_mfma_f32_16x16x32_bf16 v[136:139], a[192:195], a[72:75], v[136:139]
  buffer_load_dwordx4 v8, s[8:11], s48 offen offset:0 lds
  v_mfma_f32_16x16x32_bf16 v[140:143], a[192:195], a[76:79], v[140:143]
  v_mfma_f32_16x16x32_bf16 v[144:147], a[196:199], a[64:67], v[144:147]
  ds_read_b64_tr_b16 a[228:229], v17 offset:40960
  ds_read_b64_tr_b16 a[230:231], v17 offset:41984
  v_mfma_f32_16x16x32_bf16 v[148:151], a[196:199], a[68:71], v[148:151]
  v_mfma_f32_16x16x32_bf16 v[152:155], a[196:199], a[72:75], v[152:155]
  buffer_load_dwordx4 v8, s[8:11], s49 offen offset:1024 lds
  v_mfma_f32_16x16x32_bf16 v[156:159], a[196:199], a[76:79], v[156:159]
  ds_read_b64_tr_b16 a[232:233], v18 offset:40960
  ds_read_b64_tr_b16 a[234:235], v18 offset:41984
  v_mfma_f32_16x16x32_bf16 v[160:163], a[200:203], a[64:67], v[160:163]
  v_mfma_f32_16x16x32_bf16 v[164:167], a[200:203], a[68:71], v[164:167]
  v_mfma_f32_16x16x32_bf16 v[168:171], a[200:203], a[72:75], v[168:171]
  ds_read_b64_tr_b16 a[236:237], v19 offset:40960
  ds_read_b64_tr_b16 a[238:239], v19 offset:41984
  v_mfma_f32_16x16x32_bf16 v[172:175], a[200:203], a[76:79], v[172:175]
  buffer_load_dwordx4 a[48:51], v10, s[16:19], 0 offen offset:3072
  v_mfma_f32_16x16x32_bf16 v[176:179], a[204:207], a[64:67], v[176:179]
  v_mfma_f32_16x16x32_bf16 v[180:183], a[204:207], a[68:71], v[180:183]
  ds_read_b64_tr_b16 a[240:241], v20 offset:40960
  ds_read_b64_tr_b16 a[242:243], v20 offset:41984
  v_mfma_f32_16x16x32_bf16 v[184:187], a[204:207], a[72:75], v[184:187]
  v_mfma_f32_16x16x32_bf16 v[188:191], a[204:207], a[76:79], v[188:191]
  buffer_load_dwordx4 a[52:55], v10, s[16:19], s52 offen offset:3072
  v_mfma_f32_16x16x32_bf16 v[192:195], a[208:211], a[64:67], v[192:195]
  s_waitcnt lgkmcnt(6)
  ds_read_b64_tr_b16 a[244:245], v21 offset:40960
  ds_read_b64_tr_b16 a[246:247], v21 offset:41984
  v_mfma_f32_16x16x32_bf16 v[196:199], a[208:211], a[68:71], v[196:199]
  v_mfma_f32_16x16x32_bf16 v[200:203], a[208:211], a[72:75], v[200:203]
  v_mfma_f32_16x16x32_bf16 v[204:207], a[208:211], a[76:79], v[204:207]
  ds_read_b64_tr_b16 a[248:249], v22 offset:40960
  ds_read_b64_tr_b16 a[250:251], v22 offset:41984
  v_mfma_f32_16x16x32_bf16 v[208:211], a[212:215], a[64:67], v[208:211]
  buffer_load_dwordx4 a[56:59], v11, s[16:19], 0 offen offset:3072
  v_mfma_f32_16x16x32_bf16 v[212:215], a[212:215], a[68:71], v[212:215]
  v_mfma_f32_16x16x32_bf16 v[216:219], a[212:215], a[72:75], v[216:219]
  ds_read_b64_tr_b16 a[252:253], v23 offset:40960
  ds_read_b64_tr_b16 a[254:255], v23 offset:41984
  v_mfma_f32_16x16x32_bf16 v[220:223], a[212:215], a[76:79], v[220:223]
  v_mfma_f32_16x16x32_bf16 v[224:227], a[216:219], a[64:67], v[224:227]
  buffer_load_dwordx4 a[60:63], v11, s[16:19], s52 offen offset:3072
  v_mfma_f32_16x16x32_bf16 v[228:231], a[216:219], a[68:71], v[228:231]
  v_add_u32 v10, 4096, v10
  v_add_u32 v11, 4096, v11
  v_mfma_f32_16x16x32_bf16 v[232:235], a[216:219], a[72:75], v[232:235]
  v_mfma_f32_16x16x32_bf16 v[236:239], a[216:219], a[76:79], v[236:239]
  v_mfma_f32_16x16x32_bf16 v[240:243], a[220:223], a[64:67], v[240:243]
  v_mfma_f32_16x16x32_bf16 v[244:247], a[220:223], a[68:71], v[244:247]
  v_mfma_f32_16x16x32_bf16 v[248:251], a[220:223], a[72:75], v[248:251]
  v_mfma_f32_16x16x32_bf16 v[252:255], a[220:223], a[76:79], v[252:255]
  s_waitcnt lgkmcnt(0)
  s_barrier
  v_mfma_f32_16x16x32_bf16 v[128:131], a[224:227], a[80:83], v[128:131]
  v_mfma_f32_16x16x32_bf16 v[132:135], a[224:227], a[84:87], v[132:135]
  ds_read_b64_tr_b16 a[192:193], v16 offset:49152
  ds_read_b64_tr_b16 a[194:195], v16 offset:50176
  v_mfma_f32_16x16x32_bf16 v[136:139], a[224:227], a[88:91], v[136:139]
  buffer_load_dwordx4 v9, s[8:11], s50 offen offset:2048 lds
  v_mfma_f32_16x16x32_bf16 v[140:143], a[224:227], a[92:95], v[140:143]
  v_mfma_f32_16x16x32_bf16 v[144:147], a[228:231], a[80:83], v[144:147]
  ds_read_b64_tr_b16 a[196:197], v17 offset:49152
  ds_read_b64_tr_b16 a[198:199], v17 offset:50176
  v_mfma_f32_16x16x32_bf16 v[148:151], a[228:231], a[84:87], v[148:151]
  v_mfma_f32_16x16x32_bf16 v[152:155], a[228:231], a[88:91], v[152:155]
  buffer_load_dwordx4 v9, s[8:11], s51 offen offset:3072 lds
  v_mfma_f32_16x16x32_bf16 v[156:159], a[228:231], a[92:95], v[156:159]
  ds_read_b64_tr_b16 a[200:201], v18 offset:49152
  ds_read_b64_tr_b16 a[202:203], v18 offset:50176
  v_mfma_f32_16x16x32_bf16 v[160:163], a[232:235], a[80:83], v[160:163]
  v_add_u32 v8, 524288, v8
  v_add_u32 v9, 524288, v9
  v_mfma_f32_16x16x32_bf16 v[164:167], a[232:235], a[84:87], v[164:167]
  v_mfma_f32_16x16x32_bf16 v[168:171], a[232:235], a[88:91], v[168:171]
  ds_read_b64_tr_b16 a[204:205], v19 offset:49152
  ds_read_b64_tr_b16 a[206:207], v19 offset:50176
  v_mfma_f32_16x16x32_bf16 v[172:175], a[232:235], a[92:95], v[172:175]
  buffer_load_dwordx4 a[64:67], v10, s[16:19], 0 offen offset:0
  v_mfma_f32_16x16x32_bf16 v[176:179], a[236:239], a[80:83], v[176:179]
  v_mfma_f32_16x16x32_bf16 v[180:183], a[236:239], a[84:87], v[180:183]
  ds_read_b64_tr_b16 a[208:209], v20 offset:49152
  ds_read_b64_tr_b16 a[210:211], v20 offset:50176
  v_mfma_f32_16x16x32_bf16 v[184:187], a[236:239], a[88:91], v[184:187]
  v_mfma_f32_16x16x32_bf16 v[188:191], a[236:239], a[92:95], v[188:191]
  buffer_load_dwordx4 a[68:71], v10, s[16:19], s52 offen offset:0
  v_mfma_f32_16x16x32_bf16 v[192:195], a[240:243], a[80:83], v[192:195]
  s_waitcnt lgkmcnt(6)
  ds_read_b64_tr_b16 a[212:213], v21 offset:49152
  ds_read_b64_tr_b16 a[214:215], v21 offset:50176
  v_mfma_f32_16x16x32_bf16 v[196:199], a[240:243], a[84:87], v[196:199]
  v_mfma_f32_16x16x32_bf16 v[200:203], a[240:243], a[88:91], v[200:203]
  v_mfma_f32_16x16x32_bf16 v[204:207], a[240:243], a[92:95], v[204:207]
  ds_read_b64_tr_b16 a[216:217], v22 offset:49152
  ds_read_b64_tr_b16 a[218:219], v22 offset:50176
  v_mfma_f32_16x16x32_bf16 v[208:211], a[244:247], a[80:83], v[208:211]
  buffer_load_dwordx4 a[72:75], v11, s[16:19], 0 offen offset:0
  v_mfma_f32_16x16x32_bf16 v[212:215], a[244:247], a[84:87], v[212:215]
  v_mfma_f32_16x16x32_bf16 v[216:219], a[244:247], a[88:91], v[216:219]
  ds_read_b64_tr_b16 a[220:221], v23 offset:49152
  ds_read_b64_tr_b16 a[222:223], v23 offset:50176
  v_mfma_f32_16x16x32_bf16 v[220:223], a[244:247], a[92:95], v[220:223]
  v_mfma_f32_16x16x32_bf16 v[224:227], a[248:251], a[80:83], v[224:227]
  buffer_load_dwordx4 a[76:79], v11, s[16:19], s52 offen offset:0
  v_mfma_f32_16x16x32_bf16 v[228:231], a[248:251], a[84:87], v[228:231]
  v_mfma_f32_16x16x32_bf16 v[232:235], a[248:251], a[88:91], v[232:235]
  v_mfma_f32_16x16x32_bf16 v[236:239], a[248:251], a[92:95], v[236:239]
  v_mfma_f32_16x16x32_bf16 v[240:243], a[252:255], a[80:83], v[240:243]
  v_mfma_f32_16x16x32_bf16 v[244:247], a[252:255], a[84:87], v[244:247]
  v_mfma_f32_16x16x32_bf16 v[248:251], a[252:255], a[88:91], v[248:251]
  v_mfma_f32_16x16x32_bf16 v[252:255], a[252:255], a[92:95], v[252:255]
  s_waitcnt lgkmcnt(0)
  v_mfma_f32_16x16x32_bf16 v[128:131], a[192:195], a[96:99], v[128:131]
  s_add_u32 m0, s44, 32768
  v_mfma_f32_16x16x32_bf16 v[132:135], a[192:195], a[100:103], v[132:135]
  ds_read_b64_tr_b16 a[224:225], v16 offset:57344
  ds_read_b64_tr_b16 a[226:227], v16 offset:58368
  v_mfma_f32_16x16x32_bf16 v[136:139], a[192:195], a[104:107], v[136:139]
  buffer_load_dwordx4 v8, s[8:11], s48 offen offset:0 lds
  v_mfma_f32_16x16x32_bf16 v[140:143], a[192:195], a[108:111], v[140:143]
  v_mfma_f32_16x16x32_bf16 v[144:147], a[196:199], a[96:99], v[144:147]
  ds_read_b64_tr_b16 a[228:229], v17 offset:57344
  ds_read_b64_tr_b16 a[230:231], v17 offset:58368
  v_mfma_f32_16x16x32_bf16 v[148:151], a[196:199], a[100:103], v[148:151]
  v_mfma_f32_16x16x32_bf16 v[152:155], a[196:199], a[104:107], v[152:155]
  buffer_load_dwordx4 v8, s[8:11], s49 offen offset:1024 lds
  v_mfma_f32_16x16x32_bf16 v[156:159], a[196:199], a[108:111], v[156:159]
  ds_read_b64_tr_b16 a[232:233], v18 offset:57344
  ds_read_b64_tr_b16 a[234:235], v18 offset:58368
  v_mfma_f32_16x16x32_bf16 v[160:163], a[200:203], a[96:99], v[160:163]
  v_mfma_f32_16x16x32_bf16 v[164:167], a[200:203], a[100:103], v[164:167]
  v_mfma_f32_16x16x32_bf16 v[168:171], a[200:203], a[104:107], v[168:171]
  ds_read_b64_tr_b16 a[236:237], v19 offset:57344
  ds_read_b64_tr_b16 a[238:239], v19 offset:58368
  v_mfma_f32_16x16x32_bf16 v[172:175], a[200:203], a[108:111], v[172:175]
  buffer_load_dwordx4 a[80:83], v10, s[16:19], 0 offen offset:1024
  v_mfma_f32_16x16x32_bf16 v[176:179], a[204:207], a[96:99], v[176:179]
  v_mfma_f32_16x16x32_bf16 v[180:183], a[204:207], a[100:103], v[180:183]
  ds_read_b64_tr_b16 a[240:241], v20 offset:57344
  ds_read_b64_tr_b16 a[242:243], v20 offset:58368
  v_mfma_f32_16x16x32_bf16 v[184:187], a[204:207], a[104:107], v[184:187]
  v_mfma_f32_16x16x32_bf16 v[188:191], a[204:207], a[108:111], v[188:191]
  buffer_load_dwordx4 a[84:87], v10, s[16:19], s52 offen offset:1024
  v_mfma_f32_16x16x32_bf16 v[192:195], a[208:211], a[96:99], v[192:195]
  s_waitcnt lgkmcnt(6)
  ds_read_b64_tr_b16 a[244:245], v21 offset:57344
  ds_read_b64_tr_b16 a[246:247], v21 offset:58368
  v_mfma_f32_16x16x32_bf16 v[196:199], a[208:211], a[100:103], v[196:199]
  v_mfma_f32_16x16x32_bf16 v[200:203], a[208:211], a[104:107], v[200:203]
  v_mfma_f32_16x16x32_bf16 v[204:207], a[208:211], a[108:111], v[204:207]
  ds_read_b64_tr_b16 a[248:249], v22 offset:57344
  ds_read_b64_tr_b16 a[250:251], v22 offset:58368
  v_mfma_f32_16x16x32_bf16 v[208:211], a[212:215], a[96:99], v[208:211]
  buffer_load_dwordx4 a[88:91], v11, s[16:19], 0 offen offset:1024
  v_mfma_f32_16x16x32_bf16 v[212:215], a[212:215], a[100:103], v[212:215]
  v_mfma_f32_16x16x32_bf16 v[216:219], a[212:215], a[104:107], v[216:219]
  ds_read_b64_tr_b16 a[252:253], v23 offset:57344
  ds_read_b64_tr_b16 a[254:255], v23 offset:58368
  v_mfma_f32_16x16x32_bf16 v[220:223], a[212:215], a[108:111], v[220:223]
  v_mfma_f32_16x16x32_bf16 v[224:227], a[216:219], a[96:99], v[224:227]
  buffer_load_dwordx4 a[92:95], v11, s[16:19], s52 offen offset:1024
  v_mfma_f32_16x16x32_bf16 v[228:231], a[216:219], a[100:103], v[228:231]
  v_mfma_f32_16x16x32_bf16 v[232:235], a[216:219], a[104:107], v[232:235]
  v_mfma_f32_16x16x32_bf16 v[236:239], a[216:219], a[108:111], v[236:239]
  v_mfma_f32_16x16x32_bf16 v[240:243], a[220:223], a[96:99], v[240:243]
  v_mfma_f32_16x16x32_bf16 v[244:247], a[220:223], a[100:103], v[244:247]
  v_mfma_f32_16x16x32_bf16 v[248:251], a[220:223], a[104:107], v[248:251]
  v_mfma_f32_16x16x32_bf16 v[252:255], a[220:223], a[108:111], v[252:255]
  s_waitcnt vmcnt(36) lgkmcnt(0)
  s_barrier
  v_mfma_f32_16x16x32_bf16 v[128:131], a[224:227], a[112:115], v[128:131]
  v_xor_b32 v16, 65536, v16
  v_xor_b32 v17, 65536, v17
  v_mfma_f32_16x16x32_bf16 v[132:135], a[224:227], a[116:119], v[132:135]
  v_xor_b32 v18, 65536, v18
  v_xor_b32 v19, 65536, v19
  v_mfma_f32_16x16x32_bf16 v[136:139], a[224:227], a[120:123], v[136:139]
  v_xor_b32 v20, 65536, v20
  v_xor_b32 v21, 65536, v21
  v_mfma_f32_16x16x32_bf16 v[140:143], a[224:227], a[124:127], v[140:143]
  v_xor_b32 v22, 65536, v22
  v_xor_b32 v23, 65536, v23
  v_mfma_f32_16x16x32_bf16 v[144:147], a[228:231], a[112:115], v[144:147]
  v_mfma_f32_16x16x32_bf16 v[148:151], a[228:231], a[116:119], v[148:151]
  ds_read_b64_tr_b16 a[192:193], v16 offset:0
  ds_read_b64_tr_b16 a[194:195], v16 offset:1024
  v_mfma_f32_16x16x32_bf16 v[152:155], a[228:231], a[120:123], v[152:155]
  buffer_load_dwordx4 v9, s[8:11], s50 offen offset:2048 lds
  v_mfma_f32_16x16x32_bf16 v[156:159], a[228:231], a[124:127], v[156:159]
  v_mfma_f32_16x16x32_bf16 v[160:163], a[232:235], a[112:115], v[160:163]
  ds_read_b64_tr_b16 a[196:197], v17 offset:0
  ds_read_b64_tr_b16 a[198:199], v17 offset:1024
  v_mfma_f32_16x16x32_bf16 v[164:167], a[232:235], a[116:119], v[164:167]
  v_mfma_f32_16x16x32_bf16 v[168:171], a[232:235], a[120:123], v[168:171]
  buffer_load_dwordx4 v9, s[8:11], s51 offen offset:3072 lds
  v_mfma_f32_16x16x32_bf16 v[172:175], a[232:235], a[124:127], v[172:175]
  ds_read_b64_tr_b16 a[200:201], v18 offset:0
  ds_read_b64_tr_b16 a[202:203], v18 offset:1024
  v_mfma_f32_16x16x32_bf16 v[176:179], a[236:239], a[112:115], v[176:179]
  v_add_u32 v8, 524288, v8
  v_add_u32 v9, 524288, v9
  v_mfma_f32_16x16x32_bf16 v[180:183], a[236:239], a[116:119], v[180:183]
  v_mfma_f32_16x16x32_bf16 v[184:187], a[236:239], a[120:123], v[184:187]
  ds_read_b64_tr_b16 a[204:205], v19 offset:0
  ds_read_b64_tr_b16 a[206:207], v19 offset:1024
  v_mfma_f32_16x16x32_bf16 v[188:191], a[236:239], a[124:127], v[188:191]
  buffer_load_dwordx4 a[96:99], v10, s[16:19], 0 offen offset:2048
  v_mfma_f32_16x16x32_bf16 v[192:195], a[240:243], a[112:115], v[192:195]
  v_mfma_f32_16x16x32_bf16 v[196:199], a[240:243], a[116:119], v[196:199]
  ds_read_b64_tr_b16 a[208:209], v20 offset:0
  ds_read_b64_tr_b16 a[210:211], v20 offset:1024
  v_mfma_f32_16x16x32_bf16 v[200:203], a[240:243], a[120:123], v[200:203]
  v_mfma_f32_16x16x32_bf16 v[204:207], a[240:243], a[124:127], v[204:207]
  buffer_load_dwordx4 a[100:103], v10, s[16:19], s52 offen offset:2048
  v_mfma_f32_16x16x32_bf16 v[208:211], a[244:247], a[112:115], v[208:211]
  s_waitcnt lgkmcnt(6)
  ds_read_b64_tr_b16 a[212:213], v21 offset:0
  ds_read_b64_tr_b16 a[214:215], v21 offset:1024
  v_mfma_f32_16x16x32_bf16 v[212:215], a[244:247], a[116:119], v[212:215]
  v_mfma_f32_16x16x32_bf16 v[216:219], a[244:247], a[120:123], v[216:219]
  v_mfma_f32_16x16x32_bf16 v[220:223], a[244:247], a[124:127], v[220:223]
  ds_read_b64_tr_b16 a[216:217], v22 offset:0
  ds_read_b64_tr_b16 a[218:219], v22 offset:1024
  v_mfma_f32_16x16x32_bf16 v[224:227], a[248:251], a[112:115], v[224:227]
  buffer_load_dwordx4 a[104:107], v11, s[16:19], 0 offen offset:2048
  v_mfma_f32_16x16x32_bf16 v[228:231], a[248:251], a[116:119], v[228:231]
  v_mfma_f32_16x16x32_bf16 v[232:235], a[248:251], a[120:123], v[232:235]
  ds_read_b64_tr_b16 a[220:221], v23 offset:0
  ds_read_b64_tr_b16 a[222:223], v23 offset:1024
  v_mfma_f32_16x16x32_bf16 v[236:239], a[248:251], a[124:127], v[236:239]
  v_mfma_f32_16x16x32_bf16 v[240:243], a[252:255], a[112:115], v[240:243]
  buffer_load_dwordx4 a[108:111], v11, s[16:19], s52 offen offset:2048
  v_mfma_f32_16x16x32_bf16 v[244:247], a[252:255], a[116:119], v[244:247]
  v_mfma_f32_16x16x32_bf16 v[248:251], a[252:255], a[120:123], v[248:251]
  v_mfma_f32_16x16x32_bf16 v[252:255], a[252:255], a[124:127], v[252:255]
  s_waitcnt vmcnt(36) lgkmcnt(0)
  v_mfma_f32_16x16x32_bf16 v[128:131], a[192:195], a[0:3], v[128:131]
  s_add_u32 m0, s44, 49152
  v_mfma_f32_16x16x32_bf16 v[132:135], a[192:195], a[4:7], v[132:135]
  ds_read_b64_tr_b16 a[224:225], v16 offset:8192
  ds_read_b64_tr_b16 a[226:227], v16 offset:9216
  v_mfma_f32_16x16x32_bf16 v[136:139], a[192:195], a[8:11], v[136:139]
  buffer_load_dwordx4 v8, s[8:11], s48 offen offset:0 lds
  v_mfma_f32_16x16x32_bf16 v[140:143], a[192:195], a[12:15], v[140:143]
  v_mfma_f32_16x16x32_bf16 v[144:147], a[196:199], a[0:3], v[144:147]
  ds_read_b64_tr_b16 a[228:229], v17 offset:8192
  ds_read_b64_tr_b16 a[230:231], v17 offset:9216
  v_mfma_f32_16x16x32_bf16 v[148:151], a[196:199], a[4:7], v[148:151]
  v_mfma_f32_16x16x32_bf16 v[152:155], a[196:199], a[8:11], v[152:155]
  buffer_load_dwordx4 v8, s[8:11], s49 offen offset:1024 lds
  v_mfma_f32_16x16x32_bf16 v[156:159], a[196:199], a[12:15], v[156:159]
  ds_read_b64_tr_b16 a[232:233], v18 offset:8192
  ds_read_b64_tr_b16 a[234:235], v18 offset:9216
  v_mfma_f32_16x16x32_bf16 v[160:163], a[200:203], a[0:3], v[160:163]
  v_mfma_f32_16x16x32_bf16 v[164:167], a[200:203], a[4:7], v[164:167]
  v_mfma_f32_16x16x32_bf16 v[168:171], a[200:203], a[8:11], v[168:171]
  ds_read_b64_tr_b16 a[236:237], v19 offset:8192
  ds_read_b64_tr_b16 a[238:239], v19 offset:9216
  v_mfma_f32_16x16x32_bf16 v[172:175], a[200:203], a[12:15], v[172:175]
  buffer_load_dwordx4 a[112:115], v10, s[16:19], 0 offen offset:3072
  v_mfma_f32_16x16x32_bf16 v[176:179], a[204:207], a[0:3], v[176:179]
  v_mfma_f32_16x16x32_bf16 v[180:183], a[204:207], a[4:7], v[180:183]
  ds_read_b64_tr_b16 a[240:241], v20 offset:8192
  ds_read_b64_tr_b16 a[242:243], v20 offset:9216
  v_mfma_f32_16x16x32_bf16 v[184:187], a[204:207], a[8:11], v[184:187]
  v_mfma_f32_16x16x32_bf16 v[188:191], a[204:207], a[12:15], v[188:191]
  buffer_load_dwordx4 a[116:119], v10, s[16:19], s52 offen offset:3072
  v_mfma_f32_16x16x32_bf16 v[192:195], a[208:211], a[0:3], v[192:195]
  s_waitcnt lgkmcnt(6)
  ds_read_b64_tr_b16 a[244:245], v21 offset:8192
  ds_read_b64_tr_b16 a[246:247], v21 offset:9216
  v_mfma_f32_16x16x32_bf16 v[196:199], a[208:211], a[4:7], v[196:199]
  v_mfma_f32_16x16x32_bf16 v[200:203], a[208:211], a[8:11], v[200:203]
  v_mfma_f32_16x16x32_bf16 v[204:207], a[208:211], a[12:15], v[204:207]
  ds_read_b64_tr_b16 a[248:249], v22 offset:8192
  ds_read_b64_tr_b16 a[250:251], v22 offset:9216
  v_mfma_f32_16x16x32_bf16 v[208:211], a[212:215], a[0:3], v[208:211]
  buffer_load_dwordx4 a[120:123], v11, s[16:19], 0 offen offset:3072
  v_mfma_f32_16x16x32_bf16 v[212:215], a[212:215], a[4:7], v[212:215]
  v_mfma_f32_16x16x32_bf16 v[216:219], a[212:215], a[8:11], v[216:219]
  ds_read_b64_tr_b16 a[252:253], v23 offset:8192
  ds_read_b64_tr_b16 a[254:255], v23 offset:9216
  v_mfma_f32_16x16x32_bf16 v[220:223], a[212:215], a[12:15], v[220:223]
  v_mfma_f32_16x16x32_bf16 v[224:227], a[216:219], a[0:3], v[224:227]
  buffer_load_dwordx4 a[124:127], v11, s[16:19], s52 offen offset:3072
  v_mfma_f32_16x16x32_bf16 v[228:231], a[216:219], a[4:7], v[228:231]
  v_add_u32 v10, 4096, v10
  v_add_u32 v11, 4096, v11
  v_mfma_f32_16x16x32_bf16 v[232:235], a[216:219], a[8:11], v[232:235]
  v_mfma_f32_16x16x32_bf16 v[236:239], a[216:219], a[12:15], v[236:239]
  v_mfma_f32_16x16x32_bf16 v[240:243], a[220:223], a[0:3], v[240:243]
  v_mfma_f32_16x16x32_bf16 v[244:247], a[220:223], a[4:7], v[244:247]
  v_mfma_f32_16x16x32_bf16 v[248:251], a[220:223], a[8:11], v[248:251]
  v_mfma_f32_16x16x32_bf16 v[252:255], a[220:223], a[12:15], v[252:255]
  s_waitcnt vmcnt(36) lgkmcnt(0)
  s_barrier
  v_mfma_f32_16x16x32_bf16 v[128:131], a[224:227], a[16:19], v[128:131]
  v_mfma_f32_16x16x32_bf16 v[132:135], a[224:227], a[20:23], v[132:135]
  ds_read_b64_tr_b16 a[192:193], v16 offset:16384
  ds_read_b64_tr_b16 a[194:195], v16 offset:17408
  v_mfma_f32_16x16x32_bf16 v[136:139], a[224:227], a[24:27], v[136:139]
  buffer_load_dwordx4 v9, s[8:11], s50 offen offset:2048 lds
  v_mfma_f32_16x16x32_bf16 v[140:143], a[224:227], a[28:31], v[140:143]
  v_mfma_f32_16x16x32_bf16 v[144:147], a[228:231], a[16:19], v[144:147]
  ds_read_b64_tr_b16 a[196:197], v17 offset:16384
  ds_read_b64_tr_b16 a[198:199], v17 offset:17408
  v_mfma_f32_16x16x32_bf16 v[148:151], a[228:231], a[20:23], v[148:151]
  v_mfma_f32_16x16x32_bf16 v[152:155], a[228:231], a[24:27], v[152:155]
  buffer_load_dwordx4 v9, s[8:11], s51 offen offset:3072 lds
  v_mfma_f32_16x16x32_bf16 v[156:159], a[228:231], a[28:31], v[156:159]
  ds_read_b64_tr_b16 a[200:201], v18 offset:16384
  ds_read_b64_tr_b16 a[202:203], v18 offset:17408
  v_mfma_f32_16x16x32_bf16 v[160:163], a[232:235], a[16:19], v[160:163]
  v_add_u32 v8, 524288, v8
  v_add_u32 v9, 524288, v9
  v_mfma_f32_16x16x32_bf16 v[164:167], a[232:235], a[20:23], v[164:167]
  v_mfma_f32_16x16x32_bf16 v[168:171], a[232:235], a[24:27], v[168:171]
  ds_read_b64_tr_b16 a[204:205], v19 offset:16384
  ds_read_b64_tr_b16 a[206:207], v19 offset:17408
  v_mfma_f32_16x16x32_bf16 v[172:175], a[232:235], a[28:31], v[172:175]
  buffer_load_dwordx4 a[0:3], v10, s[16:19], 0 offen offset:0
  v_mfma_f32_16x16x32_bf16 v[176:179], a[236:239], a[16:19], v[176:179]
  v_mfma_f32_16x16x32_bf16 v[180:183], a[236:239], a[20:23], v[180:183]
  ds_read_b64_tr_b16 a[208:209], v20 offset:16384
  ds_read_b64_tr_b16 a[210:211], v20 offset:17408
  v_mfma_f32_16x16x32_bf16 v[184:187], a[236:239], a[24:27], v[184:187]
  v_mfma_f32_16x16x32_bf16 v[188:191], a[236:239], a[28:31], v[188:191]
  buffer_load_dwordx4 a[4:7], v10, s[16:19], s52 offen offset:0
  v_mfma_f32_16x16x32_bf16 v[192:195], a[240:243], a[16:19], v[192:195]
  s_waitcnt lgkmcnt(6)
  ds_read_b64_tr_b16 a[212:213], v21 offset:16384
  ds_read_b64_tr_b16 a[214:215], v21 offset:17408
  v_mfma_f32_16x16x32_bf16 v[196:199], a[240:243], a[20:23], v[196:199]
  v_mfma_f32_16x16x32_bf16 v[200:203], a[240:243], a[24:27], v[200:203]
  v_mfma_f32_16x16x32_bf16 v[204:207], a[240:243], a[28:31], v[204:207]
  ds_read_b64_tr_b16 a[216:217], v22 offset:16384
  ds_read_b64_tr_b16 a[218:219], v22 offset:17408
  v_mfma_f32_16x16x32_bf16 v[208:211], a[244:247], a[16:19], v[208:211]
  buffer_load_dwordx4 a[8:11], v11, s[16:19], 0 offen offset:0
  v_mfma_f32_16x16x32_bf16 v[212:215], a[244:247], a[20:23], v[212:215]
  v_mfma_f32_16x16x32_bf16 v[216:219], a[244:247], a[24:27], v[216:219]
  ds_read_b64_tr_b16 a[220:221], v23 offset:16384
  ds_read_b64_tr_b16 a[222:223], v23 offset:17408
  v_mfma_f32_16x16x32_bf16 v[220:223], a[244:247], a[28:31], v[220:223]
  v_mfma_f32_16x16x32_bf16 v[224:227], a[248:251], a[16:19], v[224:227]
  buffer_load_dwordx4 a[12:15], v11, s[16:19], s52 offen offset:0
  v_mfma_f32_16x16x32_bf16 v[228:231], a[248:251], a[20:23], v[228:231]
  v_mfma_f32_16x16x32_bf16 v[232:235], a[248:251], a[24:27], v[232:235]
  v_mfma_f32_16x16x32_bf16 v[236:239], a[248:251], a[28:31], v[236:239]
  v_mfma_f32_16x16x32_bf16 v[240:243], a[252:255], a[16:19], v[240:243]
  v_mfma_f32_16x16x32_bf16 v[244:247], a[252:255], a[20:23], v[244:247]
  v_mfma_f32_16x16x32_bf16 v[248:251], a[252:255], a[24:27], v[248:251]
  v_mfma_f32_16x16x32_bf16 v[252:255], a[252:255], a[28:31], v[252:255]
  s_waitcnt vmcnt(36) lgkmcnt(0)
  v_mfma_f32_16x16x32_bf16 v[128:131], a[192:195], a[32:35], v[128:131]
  s_add_u32 m0, s44, 65536
  v_mfma_f32_16x16x32_bf16 v[132:135], a[192:195], a[36:39], v[132:135]
  ds_read_b64_tr_b16 a[224:225], v16 offset:24576
  ds_read_b64_tr_b16 a[226:227], v16 offset:25600
  v_mfma_f32_16x16x32_bf16 v[136:139], a[192:195], a[40:43], v[136:139]
  buffer_load_dwordx4 v8, s[8:11], s48 offen offset:0 lds
  v_mfma_f32_16x16x32_bf16 v[140:143], a[192:195], a[44:47], v[140:143]
  v_mfma_f32_16x16x32_bf16 v[144:147], a[196:199], a[32:35], v[144:147]
  ds_read_b64_tr_b16 a[228:229], v17 offset:24576
  ds_read_b64_tr_b16 a[230:231], v17 offset:25600
  v_mfma_f32_16x16x32_bf16 v[148:151], a[196:199], a[36:39], v[148:151]
  v_mfma_f32_16x16x32_bf16 v[152:155], a[196:199], a[40:43], v[152:155]
  buffer_load_dwordx4 v8, s[8:11], s49 offen offset:1024 lds
  v_mfma_f32_16x16x32_bf16 v[156:159], a[196:199], a[44:47], v[156:159]
  ds_read_b64_tr_b16 a[232:233], v18 offset:24576
  ds_read_b64_tr_b16 a[234:235], v18 offset:25600
  v_mfma_f32_16x16x32_bf16 v[160:163], a[200:203], a[32:35], v[160:163]
  v_mfma_f32_16x16x32_bf16 v[164:167], a[200:203], a[36:39], v[164:167]
  v_mfma_f32_16x16x32_bf16 v[168:171], a[200:203], a[40:43], v[168:171]
  ds_read_b64_tr_b16 a[236:237], v19 offset:24576
  ds_read_b64_tr_b16 a[238:239], v19 offset:25600
  v_mfma_f32_16x16x32_bf16 v[172:175], a[200:203], a[44:47], v[172:175]
  buffer_load_dwordx4 a[16:19], v10, s[16:19], 0 offen offset:1024
  v_mfma_f32_16x16x32_bf16 v[176:179], a[204:207], a[32:35], v[176:179]
  v_mfma_f32_16x16x32_bf16 v[180:183], a[204:207], a[36:39], v[180:183]
  ds_read_b64_tr_b16 a[240:241], v20 offset:24576
  ds_read_b64_tr_b16 a[242:243], v20 offset:25600
  v_mfma_f32_16x16x32_bf16 v[184:187], a[204:207], a[40:43], v[184:187]
  v_mfma_f32_16x16x32_bf16 v[188:191], a[204:207], a[44:47], v[188:191]
  buffer_load_dwordx4 a[20:23], v10, s[16:19], s52 offen offset:1024
  v_mfma_f32_16x16x32_bf16 v[192:195], a[208:211], a[32:35], v[192:195]
  s_waitcnt lgkmcnt(6)
  ds_read_b64_tr_b16 a[244:245], v21 offset:24576
  ds_read_b64_tr_b16 a[246:247], v21 offset:25600
  v_mfma_f32_16x16x32_bf16 v[196:199], a[208:211], a[36:39], v[196:199]
  v_mfma_f32_16x16x32_bf16 v[200:203], a[208:211], a[40:43], v[200:203]
  v_mfma_f32_16x16x32_bf16 v[204:207], a[208:211], a[44:47], v[204:207]
  ds_read_b64_tr_b16 a[248:249], v22 offset:24576
  ds_read_b64_tr_b16 a[250:251], v22 offset:25600
  v_mfma_f32_16x16x32_bf16 v[208:211], a[212:215], a[32:35], v[208:211]
  buffer_load_dwordx4 a[24:27], v11, s[16:19], 0 offen offset:1024
  v_mfma_f32_16x16x32_bf16 v[212:215], a[212:215], a[36:39], v[212:215]
  v_mfma_f32_16x16x32_bf16 v[216:219], a[212:215], a[40:43], v[216:219]
  ds_read_b64_tr_b16 a[252:253], v23 offset:24576
  ds_read_b64_tr_b16 a[254:255], v23 offset:25600
  v_mfma_f32_16x16x32_bf16 v[220:223], a[212:215], a[44:47], v[220:223]
  v_mfma_f32_16x16x32_bf16 v[224:227], a[216:219], a[32:35], v[224:227]
  buffer_load_dwordx4 a[28:31], v11, s[16:19], s52 offen offset:1024
  v_mfma_f32_16x16x32_bf16 v[228:231], a[216:219], a[36:39], v[228:231]
  v_mfma_f32_16x16x32_bf16 v[232:235], a[216:219], a[40:43], v[232:235]
  v_mfma_f32_16x16x32_bf16 v[236:239], a[216:219], a[44:47], v[236:239]
  v_mfma_f32_16x16x32_bf16 v[240:243], a[220:223], a[32:35], v[240:243]
  v_mfma_f32_16x16x32_bf16 v[244:247], a[220:223], a[36:39], v[244:247]
  v_mfma_f32_16x16x32_bf16 v[248:251], a[220:223], a[40:43], v[248:251]
  v_mfma_f32_16x16x32_bf16 v[252:255], a[220:223], a[44:47], v[252:255]
  s_waitcnt vmcnt(36) lgkmcnt(0)
  s_barrier
  v_mfma_f32_16x16x32_bf16 v[128:131], a[224:227], a[48:51], v[128:131]
  v_mfma_f32_16x16x32_bf16 v[132:135], a[224:227], a[52:55], v[132:135]
  ds_read_b64_tr_b16 a[192:193], v16 offset:32768
  ds_read_b64_tr_b16 a[194:195], v16 offset:33792
  v_mfma_f32_16x16x32_bf16 v[136:139], a[224:227], a[56:59], v[136:139]
  buffer_load_dwordx4 v9, s[8:11], s50 offen offset:2048 lds
  v_mfma_f32_16x16x32_bf16 v[140:143], a[224:227], a[60:63], v[140:143]
  v_mfma_f32_16x16x32_bf16 v[144:147], a[228:231], a[48:51], v[144:147]
  ds_read_b64_tr_b16 a[196:197], v17 offset:32768
  ds_read_b64_tr_b16 a[198:199], v17 offset:33792
  v_mfma_f32_16x16x32_bf16 v[148:151], a[228:231], a[52:55], v[148:151]
  v_mfma_f32_16x16x32_bf16 v[152:155], a[228:231], a[56:59], v[152:155]
  buffer_load_dwordx4 v9, s[8:11], s51 offen offset:3072 lds
  v_mfma_f32_16x16x32_bf16 v[156:159], a[228:231], a[60:63], v[156:159]
  ds_read_b64_tr_b16 a[200:201], v18 offset:32768
  ds_read_b64_tr_b16 a[202:203], v18 offset:33792
  v_mfma_f32_16x16x32_bf16 v[160:163], a[232:235], a[48:51], v[160:163]
  v_add_u32 v8, 524288, v8
  v_add_u32 v9, 524288, v9
  v_mfma_f32_16x16x32_bf16 v[164:167], a[232:235], a[52:55], v[164:167]
  v_mfma_f32_16x16x32_bf16 v[168:171], a[232:235], a[56:59], v[168:171]
  ds_read_b64_tr_b16 a[204:205], v19 offset:32768
  ds_read_b64_tr_b16 a[206:207], v19 offset:33792
  v_mfma_f32_16x16x32_bf16 v[172:175], a[232:235], a[60:63], v[172:175]
  buffer_load_dwordx4 a[32:35], v10, s[16:19], 0 offen offset:2048
  v_mfma_f32_16x16x32_bf16 v[176:179], a[236:239], a[48:51], v[176:179]
  v_mfma_f32_16x16x32_bf16 v[180:183], a[236:239], a[52:55], v[180:183]
  ds_read_b64_tr_b16 a[208:209], v20 offset:32768
  ds_read_b64_tr_b16 a[210:211], v20 offset:33792
  v_mfma_f32_16x16x32_bf16 v[184:187], a[236:239], a[56:59], v[184:187]
  v_mfma_f32_16x16x32_bf16 v[188:191], a[236:239], a[60:63], v[188:191]
  buffer_load_dwordx4 a[36:39], v10, s[16:19], s52 offen offset:2048
  v_mfma_f32_16x16x32_bf16 v[192:195], a[240:243], a[48:51], v[192:195]
  s_waitcnt lgkmcnt(6)
  ds_read_b64_tr_b16 a[212:213], v21 offset:32768
  ds_read_b64_tr_b16 a[214:215], v21 offset:33792
  v_mfma_f32_16x16x32_bf16 v[196:199], a[240:243], a[52:55], v[196:199]
  v_mfma_f32_16x16x32_bf16 v[200:203], a[240:243], a[56:59], v[200:203]
  v_mfma_f32_16x16x32_bf16 v[204:207], a[240:243], a[60:63], v[204:207]
  ds_read_b64_tr_b16 a[216:217], v22 offset:32768
  ds_read_b64_tr_b16 a[218:219], v22 offset:33792
  v_mfma_f32_16x16x32_bf16 v[208:211], a[244:247], a[48:51], v[208:211]
  buffer_load_dwordx4 a[40:43], v11, s[16:19], 0 offen offset:2048
  v_mfma_f32_16x16x32_bf16 v[212:215], a[244:247], a[52:55], v[212:215]
  v_mfma_f32_16x16x32_bf16 v[216:219], a[244:247], a[56:59], v[216:219]
  ds_read_b64_tr_b16 a[220:221], v23 offset:32768
  ds_read_b64_tr_b16 a[222:223], v23 offset:33792
  v_mfma_f32_16x16x32_bf16 v[220:223], a[244:247], a[60:63], v[220:223]
  v_mfma_f32_16x16x32_bf16 v[224:227], a[248:251], a[48:51], v[224:227]
  buffer_load_dwordx4 a[44:47], v11, s[16:19], s52 offen offset:2048
  v_mfma_f32_16x16x32_bf16 v[228:231], a[248:251], a[52:55], v[228:231]
  v_mfma_f32_16x16x32_bf16 v[232:235], a[248:251], a[56:59], v[232:235]
  v_mfma_f32_16x16x32_bf16 v[236:239], a[248:251], a[60:63], v[236:239]
  v_mfma_f32_16x16x32_bf16 v[240:243], a[252:255], a[48:51], v[240:243]
  v_mfma_f32_16x16x32_bf16 v[244:247], a[252:255], a[52:55], v[244:247]
  v_mfma_f32_16x16x32_bf16 v[248:251], a[252:255], a[56:59], v[248:251]
  v_mfma_f32_16x16x32_bf16 v[252:255], a[252:255], a[60:63], v[252:255]
  s_waitcnt vmcnt(36) lgkmcnt(0)
  v_mfma_f32_16x16x32_bf16 v[128:131], a[192:195], a[64:67], v[128:131]
  s_add_u32 m0, s44, 81920
  v_mfma_f32_16x16x32_bf16 v[132:135], a[192:195], a[68:71], v[132:135]
  ds_read_b64_tr_b16 a[224:225], v16 offset:40960
  ds_read_b64_tr_b16 a[226:227], v16 offset:41984
  v_mfma_f32_16x16x32_bf16 v[136:139], a[192:195], a[72:75], v[136:139]
  buffer_load_dwordx4 v8, s[8:11], s48 offen offset:0 lds
  v_mfma_f32_16x16x32_bf16 v[140:143], a[192:195], a[76:79], v[140:143]
  v_mfma_f32_16x16x32_bf16 v[144:147], a[196:199], a[64:67], v[144:147]
  ds_read_b64_tr_b16 a[228:229], v17 offset:40960
  ds_read_b64_tr_b16 a[230:231], v17 offset:41984
  v_mfma_f32_16x16x32_bf16 v[148:151], a[196:199], a[68:71], v[148:151]
  v_mfma_f32_16x16x32_bf16 v[152:155], a[196:199], a[72:75], v[152:155]
  buffer_load_dwordx4 v8, s[8:11], s49 offen offset:1024 lds
  v_mfma_f32_16x16x32_bf16 v[156:159], a[196:199], a[76:79], v[156:159]
  ds_read_b64_tr_b16 a[232:233], v18 offset:40960
  ds_read_b64_tr_b16 a[234:235], v18 offset:41984
  v_mfma_f32_16x16x32_bf16 v[160:163], a[200:203], a[64:67], v[160:163]
  v_mfma_f32_16x16x32_bf16 v[164:167], a[200:203], a[68:71], v[164:167]
  v_mfma_f32_16x16x32_bf16 v[168:171], a[200:203], a[72:75], v[168:171]
  ds_read_b64_tr_b16 a[236:237], v19 offset:40960
  ds_read_b64_tr_b16 a[238:239], v19 offset:41984
  v_mfma_f32_16x16x32_bf16 v[172:175], a[200:203], a[76:79], v[172:175]
  buffer_load_dwordx4 a[48:51], v10, s[16:19], 0 offen offset:3072
  v_mfma_f32_16x16x32_bf16 v[176:179], a[204:207], a[64:67], v[176:179]
  v_mfma_f32_16x16x32_bf16 v[180:183], a[204:207], a[68:71], v[180:183]
  ds_read_b64_tr_b16 a[240:241], v20 offset:40960
  ds_read_b64_tr_b16 a[242:243], v20 offset:41984
  v_mfma_f32_16x16x32_bf16 v[184:187], a[204:207], a[72:75], v[184:187]
  v_mfma_f32_16x16x32_bf16 v[188:191], a[204:207], a[76:79], v[188:191]
  buffer_load_dwordx4 a[52:55], v10, s[16:19], s52 offen offset:3072
  v_mfma_f32_16x16x32_bf16 v[192:195], a[208:211], a[64:67], v[192:195]
  s_waitcnt lgkmcnt(6)
  ds_read_b64_tr_b16 a[244:245], v21 offset:40960
  ds_read_b64_tr_b16 a[246:247], v21 offset:41984
  v_mfma_f32_16x16x32_bf16 v[196:199], a[208:211], a[68:71], v[196:199]
  v_mfma_f32_16x16x32_bf16 v[200:203], a[208:211], a[72:75], v[200:203]
  v_mfma_f32_16x16x32_bf16 v[204:207], a[208:211], a[76:79], v[204:207]
  ds_read_b64_tr_b16 a[248:249], v22 offset:40960
  ds_read_b64_tr_b16 a[250:251], v22 offset:41984
  v_mfma_f32_16x16x32_bf16 v[208:211], a[212:215], a[64:67], v[208:211]
  buffer_load_dwordx4 a[56:59], v11, s[16:19], 0 offen offset:3072
  v_mfma_f32_16x16x32_bf16 v[212:215], a[212:215], a[68:71], v[212:215]
  v_mfma_f32_16x16x32_bf16 v[216:219], a[212:215], a[72:75], v[216:219]
  ds_read_b64_tr_b16 a[252:253], v23 offset:40960
  ds_read_b64_tr_b16 a[254:255], v23 offset:41984
  v_mfma_f32_16x16x32_bf16 v[220:223], a[212:215], a[76:79], v[220:223]
  v_mfma_f32_16x16x32_bf16 v[224:227], a[216:219], a[64:67], v[224:227]
  buffer_load_dwordx4 a[60:63], v11, s[16:19], s52 offen offset:3072
  v_mfma_f32_16x16x32_bf16 v[228:231], a[216:219], a[68:71], v[228:231]
  v_add_u32 v10, 4096, v10
  v_add_u32 v11, 4096, v11
  v_mfma_f32_16x16x32_bf16 v[232:235], a[216:219], a[72:75], v[232:235]
  v_mfma_f32_16x16x32_bf16 v[236:239], a[216:219], a[76:79], v[236:239]
  v_mfma_f32_16x16x32_bf16 v[240:243], a[220:223], a[64:67], v[240:243]
  v_mfma_f32_16x16x32_bf16 v[244:247], a[220:223], a[68:71], v[244:247]
  v_mfma_f32_16x16x32_bf16 v[248:251], a[220:223], a[72:75], v[248:251]
  v_mfma_f32_16x16x32_bf16 v[252:255], a[220:223], a[76:79], v[252:255]
  s_waitcnt vmcnt(36) lgkmcnt(0)
  s_barrier
  v_mfma_f32_16x16x32_bf16 v[128:131], a[224:227], a[80:83], v[128:131]
  v_mfma_f32_16x16x32_bf16 v[132:135], a[224:227], a[84:87], v[132:135]
  ds_read_b64_tr_b16 a[192:193], v16 offset:49152
  ds_read_b64_tr_b16 a[194:195], v16 offset:50176
  v_mfma_f32_16x16x32_bf16 v[136:139], a[224:227], a[88:91], v[136:139]
  buffer_load_dwordx4 v9, s[8:11], s50 offen offset:2048 lds
  v_mfma_f32_16x16x32_bf16 v[140:143], a[224:227], a[92:95], v[140:143]
  v_mfma_f32_16x16x32_bf16 v[144:147], a[228:231], a[80:83], v[144:147]
  ds_read_b64_tr_b16 a[196:197], v17 offset:49152
  ds_read_b64_tr_b16 a[198:199], v17 offset:50176
  v_mfma_f32_16x16x32_bf16 v[148:151], a[228:231], a[84:87], v[148:151]
  v_mfma_f32_16x16x32_bf16 v[152:155], a[228:231], a[88:91], v[152:155]
  buffer_load_dwordx4 v9, s[8:11], s51 offen offset:3072 lds
  v_mfma_f32_16x16x32_bf16 v[156:159], a[228:231], a[92:95], v[156:159]
  ds_read_b64_tr_b16 a[200:201], v18 offset:49152
  ds_read_b64_tr_b16 a[202:203], v18 offset:50176
  v_mfma_f32_16x16x32_bf16 v[160:163], a[232:235], a[80:83], v[160:163]
  v_add_u32 v8, 524288, v8
  v_add_u32 v9, 524288, v9
  v_mfma_f32_16x16x32_bf16 v[164:167], a[232:235], a[84:87], v[164:167]
  v_mfma_f32_16x16x32_bf16 v[168:171], a[232:235], a[88:91], v[168:171]
  ds_read_b64_tr_b16 a[204:205], v19 offset:49152
  ds_read_b64_tr_b16 a[206:207], v19 offset:50176
  v_mfma_f32_16x16x32_bf16 v[172:175], a[232:235], a[92:95], v[172:175]
  buffer_load_dwordx4 a[64:67], v10, s[16:19], 0 offen offset:0
  v_mfma_f32_16x16x32_bf16 v[176:179], a[236:239], a[80:83], v[176:179]
  v_mfma_f32_16x16x32_bf16 v[180:183], a[236:239], a[84:87], v[180:183]
  ds_read_b64_tr_b16 a[208:209], v20 offset:49152
  ds_read_b64_tr_b16 a[210:211], v20 offset:50176
  v_mfma_f32_16x16x32_bf16 v[184:187], a[236:239], a[88:91], v[184:187]
  v_mfma_f32_16x16x32_bf16 v[188:191], a[236:239], a[92:95], v[188:191]
  buffer_load_dwordx4 a[68:71], v10, s[16:19], s52 offen offset:0
  v_mfma_f32_16x16x32_bf16 v[192:195], a[240:243], a[80:83], v[192:195]
  s_waitcnt lgkmcnt(6)
  ds_read_b64_tr_b16 a[212:213], v21 offset:49152
  ds_read_b64_tr_b16 a[214:215], v21 offset:50176
  v_mfma_f32_16x16x32_bf16 v[196:199], a[240:243], a[84:87], v[196:199]
  v_mfma_f32_16x16x32_bf16 v[200:203], a[240:243], a[88:91], v[200:203]
  v_mfma_f32_16x16x32_bf16 v[204:207], a[240:243], a[92:95], v[204:207]
  ds_read_b64_tr_b16 a[216:217], v22 offset:49152
  ds_read_b64_tr_b16 a[218:219], v22 offset:50176
  v_mfma_f32_16x16x32_bf16 v[208:211], a[244:247], a[80:83], v[208:211]
  buffer_load_dwordx4 a[72:75], v11, s[16:19], 0 offen offset:0
  v_mfma_f32_16x16x32_bf16 v[212:215], a[244:247], a[84:87], v[212:215]
  v_mfma_f32_16x16x32_bf16 v[216:219], a[244:247], a[88:91], v[216:219]
  ds_read_b64_tr_b16 a[220:221], v23 offset:49152
  ds_read_b64_tr_b16 a[222:223], v23 offset:50176
  v_mfma_f32_16x16x32_bf16 v[220:223], a[244:247], a[92:95], v[220:223]
  v_mfma_f32_16x16x32_bf16 v[224:227], a[248:251], a[80:83], v[224:227]
  buffer_load_dwordx4 a[76:79], v11, s[16:19], s52 offen offset:0
  v_mfma_f32_16x16x32_bf16 v[228:231], a[248:251], a[84:87], v[228:231]
  v_mfma_f32_16x16x32_bf16 v[232:235], a[248:251], a[88:91], v[232:235]
  v_mfma_f32_16x16x32_bf16 v[236:239], a[248:251], a[92:95], v[236:239]
  v_mfma_f32_16x16x32_bf16 v[240:243], a[252:255], a[80:83], v[240:243]
  v_mfma_f32_16x16x32_bf16 v[244:247], a[252:255], a[84:87], v[244:247]
  v_mfma_f32_16x16x32_bf16 v[248:251], a[252:255], a[88:91], v[248:251]
  v_mfma_f32_16x16x32_bf16 v[252:255], a[252:255], a[92:95], v[252:255]
  s_waitcnt vmcnt(36) lgkmcnt(0)
  v_mfma_f32_16x16x32_bf16 v[128:131], a[192:195], a[96:99], v[128:131]
  s_add_u32 m0, s44, 98304
  v_mfma_f32_16x16x32_bf16 v[132:135], a[192:195], a[100:103], v[132:135]
  ds_read_b64_tr_b16 a[224:225], v16 offset:57344
  ds_read_b64_tr_b16 a[226:227], v16 offset:58368
  v_mfma_f32_16x16x32_bf16 v[136:139], a[192:195], a[104:107], v[136:139]
  buffer_load_dwordx4 v8, s[8:11], s48 offen offset:0 lds
  v_mfma_f32_16x16x32_bf16 v[140:143], a[192:195], a[108:111], v[140:143]
  v_mfma_f32_16x16x32_bf16 v[144:147], a[196:199], a[96:99], v[144:147]
  ds_read_b64_tr_b16 a[228:229], v17 offset:57344
  ds_read_b64_tr_b16 a[230:231], v17 offset:58368
  v_mfma_f32_16x16x32_bf16 v[148:151], a[196:199], a[100:103], v[148:151]
  v_mfma_f32_16x16x32_bf16 v[152:155], a[196:199], a[104:107], v[152:155]
  buffer_load_dwordx4 v8, s[8:11], s49 offen offset:1024 lds
  v_mfma_f32_16x16x32_bf16 v[156:159], a[196:199], a[108:111], v[156:159]
  ds_read_b64_tr_b16 a[232:233], v18 offset:57344
  ds_read_b64_tr_b16 a[234:235], v18 offset:58368
  v_mfma_f32_16x16x32_bf16 v[160:163], a[200:203], a[96:99], v[160:163]
  v_mfma_f32_16x16x32_bf16 v[164:167], a[200:203], a[100:103], v[164:167]
  v_mfma_f32_16x16x32_bf16 v[168:171], a[200:203], a[104:107], v[168:171]
  ds_read_b64_tr_b16 a[236:237], v19 offset:57344
  ds_read_b64_tr_b16 a[238:239], v19 offset:58368
  v_mfma_f32_16x16x32_bf16 v[172:175], a[200:203], a[108:111], v[172:175]
  buffer_load_dwordx4 a[80:83], v10, s[16:19], 0 offen offset:1024
  v_mfma_f32_16x16x32_bf16 v[176:179], a[204:207], a[96:99], v[176:179]
  v_mfma_f32_16x16x32_bf16 v[180:183], a[204:207], a[100:103], v[180:183]
  ds_read_b64_tr_b16 a[240:241], v20 offset:57344
  ds_read_b64_tr_b16 a[242:243], v20 offset:58368
  v_mfma_f32_16x16x32_bf16 v[184:187], a[204:207], a[104:107], v[184:187]
  v_mfma_f32_16x16x32_bf16 v[188:191], a[204:207], a[108:111], v[188:191]
  buffer_load_dwordx4 a[84:87], v10, s[16:19], s52 offen offset:1024
  v_mfma_f32_16x16x32_bf16 v[192:195], a[208:211], a[96:99], v[192:195]
  s_waitcnt lgkmcnt(6)
  ds_read_b64_tr_b16 a[244:245], v21 offset:57344
  ds_read_b64_tr_b16 a[246:247], v21 offset:58368
  v_mfma_f32_16x16x32_bf16 v[196:199], a[208:211], a[100:103], v[196:199]
  v_mfma_f32_16x16x32_bf16 v[200:203], a[208:211], a[104:107], v[200:203]
  v_mfma_f32_16x16x32_bf16 v[204:207], a[208:211], a[108:111], v[204:207]
  ds_read_b64_tr_b16 a[248:249], v22 offset:57344
  ds_read_b64_tr_b16 a[250:251], v22 offset:58368
  v_mfma_f32_16x16x32_bf16 v[208:211], a[212:215], a[96:99], v[208:211]
  buffer_load_dwordx4 a[88:91], v11, s[16:19], 0 offen offset:1024
  v_mfma_f32_16x16x32_bf16 v[212:215], a[212:215], a[100:103], v[212:215]
  v_mfma_f32_16x16x32_bf16 v[216:219], a[212:215], a[104:107], v[216:219]
  ds_read_b64_tr_b16 a[252:253], v23 offset:57344
  ds_read_b64_tr_b16 a[254:255], v23 offset:58368
  v_mfma_f32_16x16x32_bf16 v[220:223], a[212:215], a[108:111], v[220:223]
  v_mfma_f32_16x16x32_bf16 v[224:227], a[216:219], a[96:99], v[224:227]
  buffer_load_dwordx4 a[92:95], v11, s[16:19], s52 offen offset:1024
  v_mfma_f32_16x16x32_bf16 v[228:231], a[216:219], a[100:103], v[228:231]
  v_mfma_f32_16x16x32_bf16 v[232:235], a[216:219], a[104:107], v[232:235]
  v_mfma_f32_16x16x32_bf16 v[236:239], a[216:219], a[108:111], v[236:239]
  v_mfma_f32_16x16x32_bf16 v[240:243], a[220:223], a[96:99], v[240:243]
  v_mfma_f32_16x16x32_bf16 v[244:247], a[220:223], a[100:103], v[244:247]
  v_mfma_f32_16x16x32_bf16 v[248:251], a[220:223], a[104:107], v[248:251]
  v_mfma_f32_16x16x32_bf16 v[252:255], a[220:223], a[108:111], v[252:255]
  s_waitcnt vmcnt(36) lgkmcnt(0)
  s_barrier
  v_mfma_f32_16x16x32_bf16 v[128:131], a[224:227], a[112:115], v[128:131]
  v_xor_b32 v16, 65536, v16
  v_xor_b32 v17, 65536, v17
  v_mfma_f32_16x16x32_bf16 v[132:135], a[224:227], a[116:119], v[132:135]
  v_xor_b32 v18, 65536, v18
  v_xor_b32 v19, 65536, v19
  v_mfma_f32_16x16x32_bf16 v[136:139], a[224:227], a[120:123], v[136:139]
  v_xor_b32 v20, 65536, v20
  v_xor_b32 v21, 65536, v21
  v_mfma_f32_16x16x32_bf16 v[140:143], a[224:227], a[124:127], v[140:143]
  v_xor_b32 v22, 65536, v22
  v_xor_b32 v23, 65536, v23
  v_mfma_f32_16x16x32_bf16 v[144:147], a[228:231], a[112:115], v[144:147]
  v_mfma_f32_16x16x32_bf16 v[148:151], a[228:231], a[116:119], v[148:151]
  ds_read_b64_tr_b16 a[192:193], v16 offset:0
  ds_read_b64_tr_b16 a[194:195], v16 offset:1024
  v_mfma_f32_16x16x32_bf16 v[152:155], a[228:231], a[120:123], v[152:155]
  buffer_load_dwordx4 v9, s[8:11], s50 offen offset:2048 lds
  v_mfma_f32_16x16x32_bf16 v[156:159], a[228:231], a[124:127], v[156:159]
  v_mfma_f32_16x16x32_bf16 v[160:163], a[232:235], a[112:115], v[160:163]
  ds_read_b64_tr_b16 a[196:197], v17 offset:0
  ds_read_b64_tr_b16 a[198:199], v17 offset:1024
  v_mfma_f32_16x16x32_bf16 v[164:167], a[232:235], a[116:119], v[164:167]
  v_mfma_f32_16x16x32_bf16 v[168:171], a[232:235], a[120:123], v[168:171]
  buffer_load_dwordx4 v9, s[8:11], s51 offen offset:3072 lds
  v_mfma_f32_16x16x32_bf16 v[172:175], a[232:235], a[124:127], v[172:175]
  ds_read_b64_tr_b16 a[200:201], v18 offset:0
  ds_read_b64_tr_b16 a[202:203], v18 offset:1024
  v_mfma_f32_16x16x32_bf16 v[176:179], a[236:239], a[112:115], v[176:179]
  v_add_u32 v8, 524288, v8
  v_add_u32 v9, 524288, v9
  v_mfma_f32_16x16x32_bf16 v[180:183], a[236:239], a[116:119], v[180:183]
  v_mfma_f32_16x16x32_bf16 v[184:187], a[236:239], a[120:123], v[184:187]
  ds_read_b64_tr_b16 a[204:205], v19 offset:0
  ds_read_b64_tr_b16 a[206:207], v19 offset:1024
  v_mfma_f32_16x16x32_bf16 v[188:191], a[236:239], a[124:127], v[188:191]
  buffer_load_dwordx4 a[96:99], v10, s[16:19], 0 offen offset:2048
  v_mfma_f32_16x16x32_bf16 v[192:195], a[240:243], a[112:115], v[192:195]
  v_mfma_f32_16x16x32_bf16 v[196:199], a[240:243], a[116:119], v[196:199]
  ds_read_b64_tr_b16 a[208:209], v20 offset:0
  ds_read_b64_tr_b16 a[210:211], v20 offset:1024
  v_mfma_f32_16x16x32_bf16 v[200:203], a[240:243], a[120:123], v[200:203]
  v_mfma_f32_16x16x32_bf16 v[204:207], a[240:243], a[124:127], v[204:207]
  buffer_load_dwordx4 a[100:103], v10, s[16:19], s52 offen offset:2048
  v_mfma_f32_16x16x32_bf16 v[208:211], a[244:247], a[112:115], v[208:211]
  s_waitcnt lgkmcnt(6)
  ds_read_b64_tr_b16 a[212:213], v21 offset:0
  ds_read_b64_tr_b16 a[214:215], v21 offset:1024
  v_mfma_f32_16x16x32_bf16 v[212:215], a[244:247], a[116:119], v[212:215]
  v_mfma_f32_16x16x32_bf16 v[216:219], a[244:247], a[120:123], v[216:219]
  v_mfma_f32_16x16x32_bf16 v[220:223], a[244:247], a[124:127], v[220:223]
  ds_read_b64_tr_b16 a[216:217], v22 offset:0
  ds_read_b64_tr_b16 a[218:219], v22 offset:1024
  v_mfma_f32_16x16x32_bf16 v[224:227], a[248:251], a[112:115], v[224:227]
  buffer_load_dwordx4 a[104:107], v11, s[16:19], 0 offen offset:2048
  v_mfma_f32_16x16x32_bf16 v[228:231], a[248:251], a[116:119], v[228:231]
  v_mfma_f32_16x16x32_bf16 v[232:235], a[248:251], a[120:123], v[232:235]
  ds_read_b64_tr_b16 a[220:221], v23 offset:0
  ds_read_b64_tr_b16 a[222:223], v23 offset:1024
  v_mfma_f32_16x16x32_bf16 v[236:239], a[248:251], a[124:127], v[236:239]
  v_mfma_f32_16x16x32_bf16 v[240:243], a[252:255], a[112:115], v[240:243]
  buffer_load_dwordx4 a[108:111], v11, s[16:19], s52 offen offset:2048
  v_mfma_f32_16x16x32_bf16 v[244:247], a[252:255], a[116:119], v[244:247]
  v_mfma_f32_16x16x32_bf16 v[248:251], a[252:255], a[120:123], v[248:251]
  v_mfma_f32_16x16x32_bf16 v[252:255], a[252:255], a[124:127], v[252:255]
  s_waitcnt vmcnt(36) lgkmcnt(0)
  v_mfma_f32_16x16x32_bf16 v[128:131], a[192:195], a[0:3], v[128:131]
  s_add_u32 m0, s44, 114688
  v_mfma_f32_16x16x32_bf16 v[132:135], a[192:195], a[4:7], v[132:135]
  ds_read_b64_tr_b16 a[224:225], v16 offset:8192
  ds_read_b64_tr_b16 a[226:227], v16 offset:9216
  v_mfma_f32_16x16x32_bf16 v[136:139], a[192:195], a[8:11], v[136:139]
  buffer_load_dwordx4 v8, s[8:11], s48 offen offset:0 lds
  v_mfma_f32_16x16x32_bf16 v[140:143], a[192:195], a[12:15], v[140:143]
  v_mfma_f32_16x16x32_bf16 v[144:147], a[196:199], a[0:3], v[144:147]
  ds_read_b64_tr_b16 a[228:229], v17 offset:8192
  ds_read_b64_tr_b16 a[230:231], v17 offset:9216
  v_mfma_f32_16x16x32_bf16 v[148:151], a[196:199], a[4:7], v[148:151]
  v_mfma_f32_16x16x32_bf16 v[152:155], a[196:199], a[8:11], v[152:155]
  buffer_load_dwordx4 v8, s[8:11], s49 offen offset:1024 lds
  v_mfma_f32_16x16x32_bf16 v[156:159], a[196:199], a[12:15], v[156:159]
  ds_read_b64_tr_b16 a[232:233], v18 offset:8192
  ds_read_b64_tr_b16 a[234:235], v18 offset:9216
  v_mfma_f32_16x16x32_bf16 v[160:163], a[200:203], a[0:3], v[160:163]
  v_mfma_f32_16x16x32_bf16 v[164:167], a[200:203], a[4:7], v[164:167]
  v_mfma_f32_16x16x32_bf16 v[168:171], a[200:203], a[8:11], v[168:171]
  ds_read_b64_tr_b16 a[236:237], v19 offset:8192
  ds_read_b64_tr_b16 a[238:239], v19 offset:9216
  v_mfma_f32_16x16x32_bf16 v[172:175], a[200:203], a[12:15], v[172:175]
  buffer_load_dwordx4 a[112:115], v10, s[16:19], 0 offen offset:3072
  v_mfma_f32_16x16x32_bf16 v[176:179], a[204:207], a[0:3], v[176:179]
  v_mfma_f32_16x16x32_bf16 v[180:183], a[204:207], a[4:7], v[180:183]
  ds_read_b64_tr_b16 a[240:241], v20 offset:8192
  ds_read_b64_tr_b16 a[242:243], v20 offset:9216
  v_mfma_f32_16x16x32_bf16 v[184:187], a[204:207], a[8:11], v[184:187]
  v_mfma_f32_16x16x32_bf16 v[188:191], a[204:207], a[12:15], v[188:191]
  buffer_load_dwordx4 a[116:119], v10, s[16:19], s52 offen offset:3072
  v_mfma_f32_16x16x32_bf16 v[192:195], a[208:211], a[0:3], v[192:195]
  s_waitcnt lgkmcnt(6)
  ds_read_b64_tr_b16 a[244:245], v21 offset:8192
  ds_read_b64_tr_b16 a[246:247], v21 offset:9216
  v_mfma_f32_16x16x32_bf16 v[196:199], a[208:211], a[4:7], v[196:199]
  v_mfma_f32_16x16x32_bf16 v[200:203], a[208:211], a[8:11], v[200:203]
  v_mfma_f32_16x16x32_bf16 v[204:207], a[208:211], a[12:15], v[204:207]
  ds_read_b64_tr_b16 a[248:249], v22 offset:8192
  ds_read_b64_tr_b16 a[250:251], v22 offset:9216
  v_mfma_f32_16x16x32_bf16 v[208:211], a[212:215], a[0:3], v[208:211]
  buffer_load_dwordx4 a[120:123], v11, s[16:19], 0 offen offset:3072
  v_mfma_f32_16x16x32_bf16 v[212:215], a[212:215], a[4:7], v[212:215]
  v_mfma_f32_16x16x32_bf16 v[216:219], a[212:215], a[8:11], v[216:219]
  ds_read_b64_tr_b16 a[252:253], v23 offset:8192
  ds_read_b64_tr_b16 a[254:255], v23 offset:9216
  v_mfma_f32_16x16x32_bf16 v[220:223], a[212:215], a[12:15], v[220:223]
  v_mfma_f32_16x16x32_bf16 v[224:227], a[216:219], a[0:3], v[224:227]
  buffer_load_dwordx4 a[124:127], v11, s[16:19], s52 offen offset:3072
  v_mfma_f32_16x16x32_bf16 v[228:231], a[216:219], a[4:7], v[228:231]
  v_add_u32 v10, 4096, v10
  v_add_u32 v11, 4096, v11
  v_mfma_f32_16x16x32_bf16 v[232:235], a[216:219], a[8:11], v[232:235]
  v_mfma_f32_16x16x32_bf16 v[236:239], a[216:219], a[12:15], v[236:239]
  v_mfma_f32_16x16x32_bf16 v[240:243], a[220:223], a[0:3], v[240:243]
  v_mfma_f32_16x16x32_bf16 v[244:247], a[220:223], a[4:7], v[244:247]
  v_mfma_f32_16x16x32_bf16 v[248:251], a[220:223], a[8:11], v[248:251]
  v_mfma_f32_16x16x32_bf16 v[252:255], a[220:223], a[12:15], v[252:255]
  s_waitcnt vmcnt(36) lgkmcnt(0)
  s_barrier
  v_mfma_f32_16x16x32_bf16 v[128:131], a[224:227], a[16:19], v[128:131]
  v_mfma_f32_16x16x32_bf16 v[132:135], a[224:227], a[20:23], v[132:135]
  ds_read_b64_tr_b16 a[192:193], v16 offset:16384
  ds_read_b64_tr_b16 a[194:195], v16 offset:17408
  v_mfma_f32_16x16x32_bf16 v[136:139], a[224:227], a[24:27], v[136:139]
  buffer_load_dwordx4 v9, s[8:11], s50 offen offset:2048 lds
  v_mfma_f32_16x16x32_bf16 v[140:143], a[224:227], a[28:31], v[140:143]
  v_mfma_f32_16x16x32_bf16 v[144:147], a[228:231], a[16:19], v[144:147]
  ds_read_b64_tr_b16 a[196:197], v17 offset:16384
  ds_read_b64_tr_b16 a[198:199], v17 offset:17408
  v_mfma_f32_16x16x32_bf16 v[148:151], a[228:231], a[20:23], v[148:151]
  v_mfma_f32_16x16x32_bf16 v[152:155], a[228:231], a[24:27], v[152:155]
  buffer_load_dwordx4 v9, s[8:11], s51 offen offset:3072 lds
  v_mfma_f32_16x16x32_bf16 v[156:159], a[228:231], a[28:31], v[156:159]
  ds_read_b64_tr_b16 a[200:201], v18 offset:16384
  ds_read_b64_tr_b16 a[202:203], v18 offset:17408
  v_mfma_f32_16x16x32_bf16 v[160:163], a[232:235], a[16:19], v[160:163]
  v_add_u32 v8, 524288, v8
  v_add_u32 v9, 524288, v9
  v_mfma_f32_16x16x32_bf16 v[164:167], a[232:235], a[20:23], v[164:167]
  v_mfma_f32_16x16x32_bf16 v[168:171], a[232:235], a[24:27], v[168:171]
  ds_read_b64_tr_b16 a[204:205], v19 offset:16384
  ds_read_b64_tr_b16 a[206:207], v19 offset:17408
  v_mfma_f32_16x16x32_bf16 v[172:175], a[232:235], a[28:31], v[172:175]
  buffer_load_dwordx4 a[0:3], v10, s[16:19], 0 offen offset:0
  v_mfma_f32_16x16x32_bf16 v[176:179], a[236:239], a[16:19], v[176:179]
  v_mfma_f32_16x16x32_bf16 v[180:183], a[236:239], a[20:23], v[180:183]
  ds_read_b64_tr_b16 a[208:209], v20 offset:16384
  ds_read_b64_tr_b16 a[210:211], v20 offset:17408
  v_mfma_f32_16x16x32_bf16 v[184:187], a[236:239], a[24:27], v[184:187]
  v_mfma_f32_16x16x32_bf16 v[188:191], a[236:239], a[28:31], v[188:191]
  buffer_load_dwordx4 a[4:7], v10, s[16:19], s52 offen offset:0
  v_mfma_f32_16x16x32_bf16 v[192:195], a[240:243], a[16:19], v[192:195]
  s_waitcnt lgkmcnt(6)
  ds_read_b64_tr_b16 a[212:213], v21 offset:16384
  ds_read_b64_tr_b16 a[214:215], v21 offset:17408
  v_mfma_f32_16x16x32_bf16 v[196:199], a[240:243], a[20:23], v[196:199]
  v_mfma_f32_16x16x32_bf16 v[200:203], a[240:243], a[24:27], v[200:203]
  v_mfma_f32_16x16x32_bf16 v[204:207], a[240:243], a[28:31], v[204:207]
  ds_read_b64_tr_b16 a[216:217], v22 offset:16384
  ds_read_b64_tr_b16 a[218:219], v22 offset:17408
  v_mfma_f32_16x16x32_bf16 v[208:211], a[244:247], a[16:19], v[208:211]
  buffer_load_dwordx4 a[8:11], v11, s[16:19], 0 offen offset:0
  v_mfma_f32_16x16x32_bf16 v[212:215], a[244:247], a[20:23], v[212:215]
  v_mfma_f32_16x16x32_bf16 v[216:219], a[244:247], a[24:27], v[216:219]
  ds_read_b64_tr_b16 a[220:221], v23 offset:16384
  ds_read_b64_tr_b16 a[222:223], v23 offset:17408
  v_mfma_f32_16x16x32_bf16 v[220:223], a[244:247], a[28:31], v[220:223]
  v_mfma_f32_16x16x32_bf16 v[224:227], a[248:251], a[16:19], v[224:227]
  buffer_load_dwordx4 a[12:15], v11, s[16:19], s52 offen offset:0
  v_mfma_f32_16x16x32_bf16 v[228:231], a[248:251], a[20:23], v[228:231]
  v_mfma_f32_16x16x32_bf16 v[232:235], a[248:251], a[24:27], v[232:235]
  v_mfma_f32_16x16x32_bf16 v[236:239], a[248:251], a[28:31], v[236:239]
  v_mfma_f32_16x16x32_bf16 v[240:243], a[252:255], a[16:19], v[240:243]
  v_mfma_f32_16x16x32_bf16 v[244:247], a[252:255], a[20:23], v[244:247]
  v_mfma_f32_16x16x32_bf16 v[248:251], a[252:255], a[24:27], v[248:251]
  v_mfma_f32_16x16x32_bf16 v[252:255], a[252:255], a[28:31], v[252:255]
  s_waitcnt vmcnt(36) lgkmcnt(0)
  v_mfma_f32_16x16x32_bf16 v[128:131], a[192:195], a[32:35], v[128:131]
  s_add_u32 m0, s44, 0
  s_mov_b32 s47, 0
  v_mfma_f32_16x16x32_bf16 v[132:135], a[192:195], a[36:39], v[132:135]
  ds_read_b64_tr_b16 a[224:225], v16 offset:24576
  ds_read_b64_tr_b16 a[226:227], v16 offset:25600
  v_mfma_f32_16x16x32_bf16 v[136:139], a[192:195], a[40:43], v[136:139]
  buffer_load_dwordx4 v4, s[12:15], s47 offen offset:0 lds
  v_mfma_f32_16x16x32_bf16 v[140:143], a[192:195], a[44:47], v[140:143]
  v_mfma_f32_16x16x32_bf16 v[144:147], a[196:199], a[32:35], v[144:147]
  ds_read_b64_tr_b16 a[228:229], v17 offset:24576
  ds_read_b64_tr_b16 a[230:231], v17 offset:25600
  v_mfma_f32_16x16x32_bf16 v[148:151], a[196:199], a[36:39], v[148:151]
  v_mfma_f32_16x16x32_bf16 v[152:155], a[196:199], a[40:43], v[152:155]
  buffer_load_dwordx4 v4, s[12:15], s47 offen offset:1024 lds
  v_mfma_f32_16x16x32_bf16 v[156:159], a[196:199], a[44:47], v[156:159]
  ds_read_b64_tr_b16 a[232:233], v18 offset:24576
  ds_read_b64_tr_b16 a[234:235], v18 offset:25600
  v_mfma_f32_16x16x32_bf16 v[160:163], a[200:203], a[32:35], v[160:163]
  v_mfma_f32_16x16x32_bf16 v[164:167], a[200:203], a[36:39], v[164:167]
  v_mfma_f32_16x16x32_bf16 v[168:171], a[200:203], a[40:43], v[168:171]
  ds_read_b64_tr_b16 a[236:237], v19 offset:24576
  ds_read_b64_tr_b16 a[238:239], v19 offset:25600
  v_mfma_f32_16x16x32_bf16 v[172:175], a[200:203], a[44:47], v[172:175]
  buffer_load_dwordx4 a[16:19], v10, s[16:19], 0 offen offset:1024
  v_mfma_f32_16x16x32_bf16 v[176:179], a[204:207], a[32:35], v[176:179]
  v_mfma_f32_16x16x32_bf16 v[180:183], a[204:207], a[36:39], v[180:183]
  ds_read_b64_tr_b16 a[240:241], v20 offset:24576
  ds_read_b64_tr_b16 a[242:243], v20 offset:25600
  v_mfma_f32_16x16x32_bf16 v[184:187], a[204:207], a[40:43], v[184:187]
  v_mfma_f32_16x16x32_bf16 v[188:191], a[204:207], a[44:47], v[188:191]
  buffer_load_dwordx4 a[20:23], v10, s[16:19], s52 offen offset:1024
  v_mfma_f32_16x16x32_bf16 v[192:195], a[208:211], a[32:35], v[192:195]
  s_waitcnt lgkmcnt(6)
  ds_read_b64_tr_b16 a[244:245], v21 offset:24576
  ds_read_b64_tr_b16 a[246:247], v21 offset:25600
  v_mfma_f32_16x16x32_bf16 v[196:199], a[208:211], a[36:39], v[196:199]
  v_mfma_f32_16x16x32_bf16 v[200:203], a[208:211], a[40:43], v[200:203]
  v_mfma_f32_16x16x32_bf16 v[204:207], a[208:211], a[44:47], v[204:207]
  ds_read_b64_tr_b16 a[248:249], v22 offset:24576
  ds_read_b64_tr_b16 a[250:251], v22 offset:25600
  v_mfma_f32_16x16x32_bf16 v[208:211], a[212:215], a[32:35], v[208:211]
  buffer_load_dwordx4 a[24:27], v11, s[16:19], 0 offen offset:1024
  v_mfma_f32_16x16x32_bf16 v[212:215], a[212:215], a[36:39], v[212:215]
  v_mfma_f32_16x16x32_bf16 v[216:219], a[212:215], a[40:43], v[216:219]
  ds_read_b64_tr_b16 a[252:253], v23 offset:24576
  ds_read_b64_tr_b16 a[254:255], v23 offset:25600
  v_mfma_f32_16x16x32_bf16 v[220:223], a[212:215], a[44:47], v[220:223]
  v_mfma_f32_16x16x32_bf16 v[224:227], a[216:219], a[32:35], v[224:227]
  buffer_load_dwordx4 a[28:31], v11, s[16:19], s52 offen offset:1024
  v_mfma_f32_16x16x32_bf16 v[228:231], a[216:219], a[36:39], v[228:231]
  v_mfma_f32_16x16x32_bf16 v[232:235], a[216:219], a[40:43], v[232:235]
  v_mfma_f32_16x16x32_bf16 v[236:239], a[216:219], a[44:47], v[236:239]
  v_mfma_f32_16x16x32_bf16 v[240:243], a[220:223], a[32:35], v[240:243]
  v_mfma_f32_16x16x32_bf16 v[244:247], a[220:223], a[36:39], v[244:247]
  v_mfma_f32_16x16x32_bf16 v[248:251], a[220:223], a[40:43], v[248:251]
  v_mfma_f32_16x16x32_bf16 v[252:255], a[220:223], a[44:47], v[252:255]
  s_waitcnt vmcnt(36) lgkmcnt(0)
  s_barrier
  v_mfma_f32_16x16x32_bf16 v[128:131], a[224:227], a[48:51], v[128:131]
  v_mfma_f32_16x16x32_bf16 v[132:135], a[224:227], a[52:55], v[132:135]
  ds_read_b64_tr_b16 a[192:193], v16 offset:32768
  ds_read_b64_tr_b16 a[194:195], v16 offset:33792
  v_mfma_f32_16x16x32_bf16 v[136:139], a[224:227], a[56:59], v[136:139]
  buffer_load_dwordx4 v4, s[12:15], s47 offen offset:2048 lds
  v_mfma_f32_16x16x32_bf16 v[140:143], a[224:227], a[60:63], v[140:143]
  v_mfma_f32_16x16x32_bf16 v[144:147], a[228:231], a[48:51], v[144:147]
  ds_read_b64_tr_b16 a[196:197], v17 offset:32768
  ds_read_b64_tr_b16 a[198:199], v17 offset:33792
  v_mfma_f32_16x16x32_bf16 v[148:151], a[228:231], a[52:55], v[148:151]
  v_mfma_f32_16x16x32_bf16 v[152:155], a[228:231], a[56:59], v[152:155]
  buffer_load_dwordx4 v4, s[12:15], s47 offen offset:3072 lds
  v_mfma_f32_16x16x32_bf16 v[156:159], a[228:231], a[60:63], v[156:159]
  ds_read_b64_tr_b16 a[200:201], v18 offset:32768
  ds_read_b64_tr_b16 a[202:203], v18 offset:33792
  v_mfma_f32_16x16x32_bf16 v[160:163], a[232:235], a[48:51], v[160:163]
  v_mfma_f32_16x16x32_bf16 v[164:167], a[232:235], a[52:55], v[164:167]
  v_mfma_f32_16x16x32_bf16 v[168:171], a[232:235], a[56:59], v[168:171]
  ds_read_b64_tr_b16 a[204:205], v19 offset:32768
  ds_read_b64_tr_b16 a[206:207], v19 offset:33792
  v_mfma_f32_16x16x32_bf16 v[172:175], a[232:235], a[60:63], v[172:175]
  buffer_load_dwordx4 a[32:35], v10, s[16:19], 0 offen offset:2048
  v_mfma_f32_16x16x32_bf16 v[176:179], a[236:239], a[48:51], v[176:179]
  v_mfma_f32_16x16x32_bf16 v[180:183], a[236:239], a[52:55], v[180:183]
  ds_read_b64_tr_b16 a[208:209], v20 offset:32768
  ds_read_b64_tr_b16 a[210:211], v20 offset:33792
  v_mfma_f32_16x16x32_bf16 v[184:187], a[236:239], a[56:59], v[184:187]
  v_mfma_f32_16x16x32_bf16 v[188:191], a[236:239], a[60:63], v[188:191]
  buffer_load_dwordx4 a[36:39], v10, s[16:19], s52 offen offset:2048
  v_mfma_f32_16x16x32_bf16 v[192:195], a[240:243], a[48:51], v[192:195]
  s_waitcnt lgkmcnt(6)
  ds_read_b64_tr_b16 a[212:213], v21 offset:32768
  ds_read_b64_tr_b16 a[214:215], v21 offset:33792
  v_mfma_f32_16x16x32_bf16 v[196:199], a[240:243], a[52:55], v[196:199]
  v_mfma_f32_16x16x32_bf16 v[200:203], a[240:243], a[56:59], v[200:203]
  v_mfma_f32_16x16x32_bf16 v[204:207], a[240:243], a[60:63], v[204:207]
  ds_read_b64_tr_b16 a[216:217], v22 offset:32768
  ds_read_b64_tr_b16 a[218:219], v22 offset:33792
  v_mfma_f32_16x16x32_bf16 v[208:211], a[244:247], a[48:51], v[208:211]
  buffer_load_dwordx4 a[40:43], v11, s[16:19], 0 offen offset:2048
  v_mfma_f32_16x16x32_bf16 v[212:215], a[244:247], a[52:55], v[212:215]
  v_mfma_f32_16x16x32_bf16 v[216:219], a[244:247], a[56:59], v[216:219]
  ds_read_b64_tr_b16 a[220:221], v23 offset:32768
  ds_read_b64_tr_b16 a[222:223], v23 offset:33792
  v_mfma_f32_16x16x32_bf16 v[220:223], a[244:247], a[60:63], v[220:223]
  v_mfma_f32_16x16x32_bf16 v[224:227], a[248:251], a[48:51], v[224:227]
  buffer_load_dwordx4 a[44:47], v11, s[16:19], s52 offen offset:2048
  v_mfma_f32_16x16x32_bf16 v[228:231], a[248:251], a[52:55], v[228:231]
  v_mfma_f32_16x16x32_bf16 v[232:235], a[248:251], a[56:59], v[232:235]
  v_mfma_f32_16x16x32_bf16 v[236:239], a[248:251], a[60:63], v[236:239]
  v_mfma_f32_16x16x32_bf16 v[240:243], a[252:255], a[48:51], v[240:243]
  v_mfma_f32_16x16x32_bf16 v[244:247], a[252:255], a[52:55], v[244:247]
  v_mfma_f32_16x16x32_bf16 v[248:251], a[252:255], a[56:59], v[248:251]
  v_mfma_f32_16x16x32_bf16 v[252:255], a[252:255], a[60:63], v[252:255]
  s_waitcnt vmcnt(36) lgkmcnt(0)
  v_mfma_f32_16x16x32_bf16 v[128:131], a[192:195], a[64:67], v[128:131]
  s_add_u32 m0, s44, 16384
  s_mov_b32 s47, 16384
  v_mfma_f32_16x16x32_bf16 v[132:135], a[192:195], a[68:71], v[132:135]
  ds_read_b64_tr_b16 a[224:225], v16 offset:40960
  ds_read_b64_tr_b16 a[226:227], v16 offset:41984
  v_mfma_f32_16x16x32_bf16 v[136:139], a[192:195], a[72:75], v[136:139]
  buffer_load_dwordx4 v4, s[12:15], s47 offen offset:0 lds
  v_mfma_f32_16x16x32_bf16 v[140:143], a[192:195], a[76:79], v[140:143]
  v_mfma_f32_16x16x32_bf16 v[144:147], a[196:199], a[64:67], v[144:147]
  ds_read_b64_tr_b16 a[228:229], v17 offset:40960
  ds_read_b64_tr_b16 a[230:231], v17 offset:41984
  v_mfma_f32_16x16x32_bf16 v[148:151], a[196:199], a[68:71], v[148:151]
  v_mfma_f32_16x16x32_bf16 v[152:155], a[196:199], a[72:75], v[152:155]
  buffer_load_dwordx4 v4, s[12:15], s47 offen offset:1024 lds
  v_mfma_f32_16x16x32_bf16 v[156:159], a[196:199], a[76:79], v[156:159]
  ds_read_b64_tr_b16 a[232:233], v18 offset:40960
  ds_read_b64_tr_b16 a[234:235], v18 offset:41984
  v_mfma_f32_16x16x32_bf16 v[160:163], a[200:203], a[64:67], v[160:163]
  v_mfma_f32_16x16x32_bf16 v[164:167], a[200:203], a[68:71], v[164:167]
  v_mfma_f32_16x16x32_bf16 v[168:171], a[200:203], a[72:75], v[168:171]
  ds_read_b64_tr_b16 a[236:237], v19 offset:40960
  ds_read_b64_tr_b16 a[238:239], v19 offset:41984
  v_mfma_f32_16x16x32_bf16 v[172:175], a[200:203], a[76:79], v[172:175]
  buffer_load_dwordx4 a[48:51], v10, s[16:19], 0 offen offset:3072
  v_mfma_f32_16x16x32_bf16 v[176:179], a[204:207], a[64:67], v[176:179]
  v_mfma_f32_16x16x32_bf16 v[180:183], a[204:207], a[68:71], v[180:183]
  ds_read_b64_tr_b16 a[240:241], v20 offset:40960
  ds_read_b64_tr_b16 a[242:243], v20 offset:41984
  v_mfma_f32_16x16x32_bf16 v[184:187], a[204:207], a[72:75], v[184:187]
  v_mfma_f32_16x16x32_bf16 v[188:191], a[204:207], a[76:79], v[188:191]
  buffer_load_dwordx4 a[52:55], v10, s[16:19], s52 offen offset:3072
  v_mfma_f32_16x16x32_bf16 v[192:195], a[208:211], a[64:67], v[192:195]
  s_waitcnt lgkmcnt(6)
  ds_read_b64_tr_b16 a[244:245], v21 offset:40960
  ds_read_b64_tr_b16 a[246:247], v21 offset:41984
  v_mfma_f32_16x16x32_bf16 v[196:199], a[208:211], a[68:71], v[196:199]
  v_mfma_f32_16x16x32_bf16 v[200:203], a[208:211], a[72:75], v[200:203]
  v_mfma_f32_16x16x32_bf16 v[204:207], a[208:211], a[76:79], v[204:207]
  ds_read_b64_tr_b16 a[248:249], v22 offset:40960
  ds_read_b64_tr_b16 a[250:251], v22 offset:41984
  v_mfma_f32_16x16x32_bf16 v[208:211], a[212:215], a[64:67], v[208:211]
  buffer_load_dwordx4 a[56:59], v11, s[16:19], 0 offen offset:3072
  v_mfma_f32_16x16x32_bf16 v[212:215], a[212:215], a[68:71], v[212:215]
  v_mfma_f32_16x16x32_bf16 v[216:219], a[212:215], a[72:75], v[216:219]
  ds_read_b64_tr_b16 a[252:253], v23 offset:40960
  ds_read_b64_tr_b16 a[254:255], v23 offset:41984
  v_mfma_f32_16x16x32_bf16 v[220:223], a[212:215], a[76:79], v[220:223]
  v_mfma_f32_16x16x32_bf16 v[224:227], a[216:219], a[64:67], v[224:227]
  buffer_load_dwordx4 a[60:63], v11, s[16:19], s52 offen offset:3072
  v_mfma_f32_16x16x32_bf16 v[228:231], a[216:219], a[68:71], v[228:231]
  v_add_u32 v10, 4096, v10
  v_add_u32 v11, 4096, v11
  v_mfma_f32_16x16x32_bf16 v[232:235], a[216:219], a[72:75], v[232:235]
  v_mfma_f32_16x16x32_bf16 v[236:239], a[216:219], a[76:79], v[236:239]
  v_mfma_f32_16x16x32_bf16 v[240:243], a[220:223], a[64:67], v[240:243]
  v_mfma_f32_16x16x32_bf16 v[244:247], a[220:223], a[68:71], v[244:247]
  v_mfma_f32_16x16x32_bf16 v[248:251], a[220:223], a[72:75], v[248:251]
  v_mfma_f32_16x16x32_bf16 v[252:255], a[220:223], a[76:79], v[252:255]
  s_waitcnt vmcnt(36) lgkmcnt(0)
  s_barrier
  v_mfma_f32_16x16x32_bf16 v[128:131], a[224:227], a[80:83], v[128:131]
  v_mfma_f32_16x16x32_bf16 v[132:135], a[224:227], a[84:87], v[132:135]
  ds_read_b64_tr_b16 a[192:193], v16 offset:49152
  ds_read_b64_tr_b16 a[194:195], v16 offset:50176
  v_mfma_f32_16x16x32_bf16 v[136:139], a[224:227], a[88:91], v[136:139]
  buffer_load_dwordx4 v4, s[12:15], s47 offen offset:2048 lds
  v_mfma_f32_16x16x32_bf16 v[140:143], a[224:227], a[92:95], v[140:143]
  v_mfma_f32_16x16x32_bf16 v[144:147], a[228:231], a[80:83], v[144:147]
  ds_read_b64_tr_b16 a[196:197], v17 offset:49152
  ds_read_b64_tr_b16 a[198:199], v17 offset:50176
  v_mfma_f32_16x16x32_bf16 v[148:151], a[228:231], a[84:87], v[148:151]
  v_mfma_f32_16x16x32_bf16 v[152:155], a[228:231], a[88:91], v[152:155]
  buffer_load_dwordx4 v4, s[12:15], s47 offen offset:3072 lds
  v_mfma_f32_16x16x32_bf16 v[156:159], a[228:231], a[92:95], v[156:159]
  ds_read_b64_tr_b16 a[200:201], v18 offset:49152
  ds_read_b64_tr_b16 a[202:203], v18 offset:50176
  v_mfma_f32_16x16x32_bf16 v[160:163], a[232:235], a[80:83], v[160:163]
  v_mfma_f32_16x16x32_bf16 v[164:167], a[232:235], a[84:87], v[164:167]
  v_mfma_f32_16x16x32_bf16 v[168:171], a[232:235], a[88:91], v[168:171]
  ds_read_b64_tr_b16 a[204:205], v19 offset:49152
  ds_read_b64_tr_b16 a[206:207], v19 offset:50176
  v_mfma_f32_16x16x32_bf16 v[172:175], a[232:235], a[92:95], v[172:175]
  buffer_load_dwordx4 a[64:67], v10, s[16:19], 0 offen offset:0
  v_mfma_f32_16x16x32_bf16 v[176:179], a[236:239], a[80:83], v[176:179]
  v_mfma_f32_16x16x32_bf16 v[180:183], a[236:239], a[84:87], v[180:183]
  ds_read_b64_tr_b16 a[208:209], v20 offset:49152
  ds_read_b64_tr_b16 a[210:211], v20 offset:50176
  v_mfma_f32_16x16x32_bf16 v[184:187], a[236:239], a[88:91], v[184:187]
  v_mfma_f32_16x16x32_bf16 v[188:191], a[236:239], a[92:95], v[188:191]
  buffer_load_dwordx4 a[68:71], v10, s[16:19], s52 offen offset:0
  v_mfma_f32_16x16x32_bf16 v[192:195], a[240:243], a[80:83], v[192:195]
  s_waitcnt lgkmcnt(6)
  ds_read_b64_tr_b16 a[212:213], v21 offset:49152
  ds_read_b64_tr_b16 a[214:215], v21 offset:50176
  v_mfma_f32_16x16x32_bf16 v[196:199], a[240:243], a[84:87], v[196:199]
  v_mfma_f32_16x16x32_bf16 v[200:203], a[240:243], a[88:91], v[200:203]
  v_mfma_f32_16x16x32_bf16 v[204:207], a[240:243], a[92:95], v[204:207]
  ds_read_b64_tr_b16 a[216:217], v22 offset:49152
  ds_read_b64_tr_b16 a[218:219], v22 offset:50176
  v_mfma_f32_16x16x32_bf16 v[208:211], a[244:247], a[80:83], v[208:211]
  buffer_load_dwordx4 a[72:75], v11, s[16:19], 0 offen offset:0
  v_mfma_f32_16x16x32_bf16 v[212:215], a[244:247], a[84:87], v[212:215]
  v_mfma_f32_16x16x32_bf16 v[216:219], a[244:247], a[88:91], v[216:219]
  ds_read_b64_tr_b16 a[220:221], v23 offset:49152
  ds_read_b64_tr_b16 a[222:223], v23 offset:50176
  v_mfma_f32_16x16x32_bf16 v[220:223], a[244:247], a[92:95], v[220:223]
  v_mfma_f32_16x16x32_bf16 v[224:227], a[248:251], a[80:83], v[224:227]
  buffer_load_dwordx4 a[76:79], v11, s[16:19], s52 offen offset:0
  v_mfma_f32_16x16x32_bf16 v[228:231], a[248:251], a[84:87], v[228:231]
  v_mfma_f32_16x16x32_bf16 v[232:235], a[248:251], a[88:91], v[232:235]
  v_mfma_f32_16x16x32_bf16 v[236:239], a[248:251], a[92:95], v[236:239]
  v_mfma_f32_16x16x32_bf16 v[240:243], a[252:255], a[80:83], v[240:243]
  v_mfma_f32_16x16x32_bf16 v[244:247], a[252:255], a[84:87], v[244:247]
  v_mfma_f32_16x16x32_bf16 v[248:251], a[252:255], a[88:91], v[248:251]
  v_mfma_f32_16x16x32_bf16 v[252:255], a[252:255], a[92:95], v[252:255]
  s_waitcnt vmcnt(36) lgkmcnt(0)
  v_mfma_f32_16x16x32_bf16 v[128:131], a[192:195], a[96:99], v[128:131]
  s_add_u32 m0, s44, 32768
  s_mov_b32 s47, 32768
  v_mfma_f32_16x16x32_bf16 v[132:135], a[192:195], a[100:103], v[132:135]
  ds_read_b64_tr_b16 a[224:225], v16 offset:57344
  ds_read_b64_tr_b16 a[226:227], v16 offset:58368
  v_mfma_f32_16x16x32_bf16 v[136:139], a[192:195], a[104:107], v[136:139]
  buffer_load_dwordx4 v4, s[12:15], s47 offen offset:0 lds
  v_mfma_f32_16x16x32_bf16 v[140:143], a[192:195], a[108:111], v[140:143]
  v_mfma_f32_16x16x32_bf16 v[144:147], a[196:199], a[96:99], v[144:147]
  ds_read_b64_tr_b16 a[228:229], v17 offset:57344
  ds_read_b64_tr_b16 a[230:231], v17 offset:58368
  v_mfma_f32_16x16x32_bf16 v[148:151], a[196:199], a[100:103], v[148:151]
  v_mfma_f32_16x16x32_bf16 v[152:155], a[196:199], a[104:107], v[152:155]
  buffer_load_dwordx4 v4, s[12:15], s47 offen offset:1024 lds
  v_mfma_f32_16x16x32_bf16 v[156:159], a[196:199], a[108:111], v[156:159]
  ds_read_b64_tr_b16 a[232:233], v18 offset:57344
  ds_read_b64_tr_b16 a[234:235], v18 offset:58368
  v_mfma_f32_16x16x32_bf16 v[160:163], a[200:203], a[96:99], v[160:163]
  v_mfma_f32_16x16x32_bf16 v[164:167], a[200:203], a[100:103], v[164:167]
  v_mfma_f32_16x16x32_bf16 v[168:171], a[200:203], a[104:107], v[168:171]
  ds_read_b64_tr_b16 a[236:237], v19 offset:57344
  ds_read_b64_tr_b16 a[238:239], v19 offset:58368
  v_mfma_f32_16x16x32_bf16 v[172:175], a[200:203], a[108:111], v[172:175]
  buffer_load_dwordx4 a[80:83], v10, s[16:19], 0 offen offset:1024
  v_mfma_f32_16x16x32_bf16 v[176:179], a[204:207], a[96:99], v[176:179]
  v_mfma_f32_16x16x32_bf16 v[180:183], a[204:207], a[100:103], v[180:183]
  ds_read_b64_tr_b16 a[240:241], v20 offset:57344
  ds_read_b64_tr_b16 a[242:243], v20 offset:58368
  v_mfma_f32_16x16x32_bf16 v[184:187], a[204:207], a[104:107], v[184:187]
  v_mfma_f32_16x16x32_bf16 v[188:191], a[204:207], a[108:111], v[188:191]
  buffer_load_dwordx4 a[84:87], v10, s[16:19], s52 offen offset:1024
  v_mfma_f32_16x16x32_bf16 v[192:195], a[208:211], a[96:99], v[192:195]
  s_waitcnt lgkmcnt(6)
  ds_read_b64_tr_b16 a[244:245], v21 offset:57344
  ds_read_b64_tr_b16 a[246:247], v21 offset:58368
  v_mfma_f32_16x16x32_bf16 v[196:199], a[208:211], a[100:103], v[196:199]
  v_mfma_f32_16x16x32_bf16 v[200:203], a[208:211], a[104:107], v[200:203]
  v_mfma_f32_16x16x32_bf16 v[204:207], a[208:211], a[108:111], v[204:207]
  ds_read_b64_tr_b16 a[248:249], v22 offset:57344
  ds_read_b64_tr_b16 a[250:251], v22 offset:58368
  v_mfma_f32_16x16x32_bf16 v[208:211], a[212:215], a[96:99], v[208:211]
  buffer_load_dwordx4 a[88:91], v11, s[16:19], 0 offen offset:1024
  v_mfma_f32_16x16x32_bf16 v[212:215], a[212:215], a[100:103], v[212:215]
  v_mfma_f32_16x16x32_bf16 v[216:219], a[212:215], a[104:107], v[216:219]
  ds_read_b64_tr_b16 a[252:253], v23 offset:57344
  ds_read_b64_tr_b16 a[254:255], v23 offset:58368
  v_mfma_f32_16x16x32_bf16 v[220:223], a[212:215], a[108:111], v[220:223]
  v_mfma_f32_16x16x32_bf16 v[224:227], a[216:219], a[96:99], v[224:227]
  buffer_load_dwordx4 a[92:95], v11, s[16:19], s52 offen offset:1024
  v_mfma_f32_16x16x32_bf16 v[228:231], a[216:219], a[100:103], v[228:231]
  v_mfma_f32_16x16x32_bf16 v[232:235], a[216:219], a[104:107], v[232:235]
  v_mfma_f32_16x16x32_bf16 v[236:239], a[216:219], a[108:111], v[236:239]
  v_mfma_f32_16x16x32_bf16 v[240:243], a[220:223], a[96:99], v[240:243]
  v_mfma_f32_16x16x32_bf16 v[244:247], a[220:223], a[100:103], v[244:247]
  v_mfma_f32_16x16x32_bf16 v[248:251], a[220:223], a[104:107], v[248:251]
  v_mfma_f32_16x16x32_bf16 v[252:255], a[220:223], a[108:111], v[252:255]
  s_waitcnt vmcnt(36) lgkmcnt(0)
  s_barrier
  v_mfma_f32_16x16x32_bf16 v[128:131], a[224:227], a[112:115], v[128:131]
  v_xor_b32 v16, 65536, v16
  v_xor_b32 v17, 65536, v17
  v_mfma_f32_16x16x32_bf16 v[132:135], a[224:227], a[116:119], v[132:135]
  v_xor_b32 v18, 65536, v18
  v_xor_b32 v19, 65536, v19
  v_mfma_f32_16x16x32_bf16 v[136:139], a[224:227], a[120:123], v[136:139]
  v_xor_b32 v20, 65536, v20
  v_xor_b32 v21, 65536, v21
  v_mfma_f32_16x16x32_bf16 v[140:143], a[224:227], a[124:127], v[140:143]
  v_xor_b32 v22, 65536, v22
  v_xor_b32 v23, 65536, v23
  v_mfma_f32_16x16x32_bf16 v[144:147], a[228:231], a[112:115], v[144:147]
  v_mfma_f32_16x16x32_bf16 v[148:151], a[228:231], a[116:119], v[148:151]
  ds_read_b64_tr_b16 a[192:193], v16 offset:0
  ds_read_b64_tr_b16 a[194:195], v16 offset:1024
  v_mfma_f32_16x16x32_bf16 v[152:155], a[228:231], a[120:123], v[152:155]
  buffer_load_dwordx4 v4, s[12:15], s47 offen offset:2048 lds
  v_mfma_f32_16x16x32_bf16 v[156:159], a[228:231], a[124:127], v[156:159]
  v_mfma_f32_16x16x32_bf16 v[160:163], a[232:235], a[112:115], v[160:163]
  ds_read_b64_tr_b16 a[196:197], v17 offset:0
  ds_read_b64_tr_b16 a[198:199], v17 offset:1024
  v_mfma_f32_16x16x32_bf16 v[164:167], a[232:235], a[116:119], v[164:167]
  v_mfma_f32_16x16x32_bf16 v[168:171], a[232:235], a[120:123], v[168:171]
  buffer_load_dwordx4 v4, s[12:15], s47 offen offset:3072 lds
  v_mfma_f32_16x16x32_bf16 v[172:175], a[232:235], a[124:127], v[172:175]
  ds_read_b64_tr_b16 a[200:201], v18 offset:0
  ds_read_b64_tr_b16 a[202:203], v18 offset:1024
  v_mfma_f32_16x16x32_bf16 v[176:179], a[236:239], a[112:115], v[176:179]
  v_mfma_f32_16x16x32_bf16 v[180:183], a[236:239], a[116:119], v[180:183]
  v_mfma_f32_16x16x32_bf16 v[184:187], a[236:239], a[120:123], v[184:187]
  ds_read_b64_tr_b16 a[204:205], v19 offset:0
  ds_read_b64_tr_b16 a[206:207], v19 offset:1024
  v_mfma_f32_16x16x32_bf16 v[188:191], a[236:239], a[124:127], v[188:191]
  buffer_load_dwordx4 a[96:99], v10, s[16:19], 0 offen offset:2048
  v_mfma_f32_16x16x32_bf16 v[192:195], a[240:243], a[112:115], v[192:195]
  v_mfma_f32_16x16x32_bf16 v[196:199], a[240:243], a[116:119], v[196:199]
  ds_read_b64_tr_b16 a[208:209], v20 offset:0
  ds_read_b64_tr_b16 a[210:211], v20 offset:1024
  v_mfma_f32_16x16x32_bf16 v[200:203], a[240:243], a[120:123], v[200:203]
  v_mfma_f32_16x16x32_bf16 v[204:207], a[240:243], a[124:127], v[204:207]
  buffer_load_dwordx4 a[100:103], v10, s[16:19], s52 offen offset:2048
  v_mfma_f32_16x16x32_bf16 v[208:211], a[244:247], a[112:115], v[208:211]
  s_waitcnt lgkmcnt(6)
  ds_read_b64_tr_b16 a[212:213], v21 offset:0
  ds_read_b64_tr_b16 a[214:215], v21 offset:1024
  v_mfma_f32_16x16x32_bf16 v[212:215], a[244:247], a[116:119], v[212:215]
  v_mfma_f32_16x16x32_bf16 v[216:219], a[244:247], a[120:123], v[216:219]
  v_mfma_f32_16x16x32_bf16 v[220:223], a[244:247], a[124:127], v[220:223]
  ds_read_b64_tr_b16 a[216:217], v22 offset:0
  ds_read_b64_tr_b16 a[218:219], v22 offset:1024
  v_mfma_f32_16x16x32_bf16 v[224:227], a[248:251], a[112:115], v[224:227]
  buffer_load_dwordx4 a[104:107], v11, s[16:19], 0 offen offset:2048
  v_mfma_f32_16x16x32_bf16 v[228:231], a[248:251], a[116:119], v[228:231]
  v_mfma_f32_16x16x32_bf16 v[232:235], a[248:251], a[120:123], v[232:235]
  ds_read_b64_tr_b16 a[220:221], v23 offset:0
  ds_read_b64_tr_b16 a[222:223], v23 offset:1024
  v_mfma_f32_16x16x32_bf16 v[236:239], a[248:251], a[124:127], v[236:239]
  v_mfma_f32_16x16x32_bf16 v[240:243], a[252:255], a[112:115], v[240:243]
  buffer_load_dwordx4 a[108:111], v11, s[16:19], s52 offen offset:2048
  v_mfma_f32_16x16x32_bf16 v[244:247], a[252:255], a[116:119], v[244:247]
  v_mfma_f32_16x16x32_bf16 v[248:251], a[252:255], a[120:123], v[248:251]
  v_mfma_f32_16x16x32_bf16 v[252:255], a[252:255], a[124:127], v[252:255]
  s_waitcnt vmcnt(36) lgkmcnt(0)
  v_mfma_f32_16x16x32_bf16 v[128:131], a[192:195], a[0:3], v[128:131]
  s_add_u32 m0, s44, 49152
  s_mov_b32 s47, 49152
  v_mfma_f32_16x16x32_bf16 v[132:135], a[192:195], a[4:7], v[132:135]
  ds_read_b64_tr_b16 a[224:225], v16 offset:8192
  ds_read_b64_tr_b16 a[226:227], v16 offset:9216
  v_mfma_f32_16x16x32_bf16 v[136:139], a[192:195], a[8:11], v[136:139]
  buffer_load_dwordx4 v4, s[12:15], s47 offen offset:0 lds
  v_mfma_f32_16x16x32_bf16 v[140:143], a[192:195], a[12:15], v[140:143]
  v_mfma_f32_16x16x32_bf16 v[144:147], a[196:199], a[0:3], v[144:147]
  ds_read_b64_tr_b16 a[228:229], v17 offset:8192
  ds_read_b64_tr_b16 a[230:231], v17 offset:9216
  v_mfma_f32_16x16x32_bf16 v[148:151], a[196:199], a[4:7], v[148:151]
  v_mfma_f32_16x16x32_bf16 v[152:155], a[196:199], a[8:11], v[152:155]
  buffer_load_dwordx4 v4, s[12:15], s47 offen offset:1024 lds
  v_mfma_f32_16x16x32_bf16 v[156:159], a[196:199], a[12:15], v[156:159]
  ds_read_b64_tr_b16 a[232:233], v18 offset:8192
  ds_read_b64_tr_b16 a[234:235], v18 offset:9216
  v_mfma_f32_16x16x32_bf16 v[160:163], a[200:203], a[0:3], v[160:163]
  v_mfma_f32_16x16x32_bf16 v[164:167], a[200:203], a[4:7], v[164:167]
  v_mfma_f32_16x16x32_bf16 v[168:171], a[200:203], a[8:11], v[168:171]
  ds_read_b64_tr_b16 a[236:237], v19 offset:8192
  ds_read_b64_tr_b16 a[238:239], v19 offset:9216
  v_mfma_f32_16x16x32_bf16 v[172:175], a[200:203], a[12:15], v[172:175]
  buffer_load_dwordx4 a[112:115], v10, s[16:19], 0 offen offset:3072
  v_mfma_f32_16x16x32_bf16 v[176:179], a[204:207], a[0:3], v[176:179]
  v_mfma_f32_16x16x32_bf16 v[180:183], a[204:207], a[4:7], v[180:183]
  ds_read_b64_tr_b16 a[240:241], v20 offset:8192
  ds_read_b64_tr_b16 a[242:243], v20 offset:9216
  v_mfma_f32_16x16x32_bf16 v[184:187], a[204:207], a[8:11], v[184:187]
  v_mfma_f32_16x16x32_bf16 v[188:191], a[204:207], a[12:15], v[188:191]
  buffer_load_dwordx4 a[116:119], v10, s[16:19], s52 offen offset:3072
  v_mfma_f32_16x16x32_bf16 v[192:195], a[208:211], a[0:3], v[192:195]
  s_waitcnt lgkmcnt(6)
  ds_read_b64_tr_b16 a[244:245], v21 offset:8192
  ds_read_b64_tr_b16 a[246:247], v21 offset:9216
  v_mfma_f32_16x16x32_bf16 v[196:199], a[208:211], a[4:7], v[196:199]
  v_mfma_f32_16x16x32_bf16 v[200:203], a[208:211], a[8:11], v[200:203]
  v_mfma_f32_16x16x32_bf16 v[204:207], a[208:211], a[12:15], v[204:207]
  ds_read_b64_tr_b16 a[248:249], v22 offset:8192
  ds_read_b64_tr_b16 a[250:251], v22 offset:9216
  v_mfma_f32_16x16x32_bf16 v[208:211], a[212:215], a[0:3], v[208:211]
  buffer_load_dwordx4 a[120:123], v11, s[16:19], 0 offen offset:3072
  v_mfma_f32_16x16x32_bf16 v[212:215], a[212:215], a[4:7], v[212:215]
  v_mfma_f32_16x16x32_bf16 v[216:219], a[212:215], a[8:11], v[216:219]
  ds_read_b64_tr_b16 a[252:253], v23 offset:8192
  ds_read_b64_tr_b16 a[254:255], v23 offset:9216
  v_mfma_f32_16x16x32_bf16 v[220:223], a[212:215], a[12:15], v[220:223]
  v_mfma_f32_16x16x32_bf16 v[224:227], a[216:219], a[0:3], v[224:227]
  buffer_load_dwordx4 a[124:127], v11, s[16:19], s52 offen offset:3072
  v_mfma_f32_16x16x32_bf16 v[228:231], a[216:219], a[4:7], v[228:231]
  v_add_u32 v10, 4096, v10
  v_add_u32 v11, 4096, v11
  v_mfma_f32_16x16x32_bf16 v[232:235], a[216:219], a[8:11], v[232:235]
  v_mfma_f32_16x16x32_bf16 v[236:239], a[216:219], a[12:15], v[236:239]
  v_mfma_f32_16x16x32_bf16 v[240:243], a[220:223], a[0:3], v[240:243]
  v_mfma_f32_16x16x32_bf16 v[244:247], a[220:223], a[4:7], v[244:247]
  v_mfma_f32_16x16x32_bf16 v[248:251], a[220:223], a[8:11], v[248:251]
  v_mfma_f32_16x16x32_bf16 v[252:255], a[220:223], a[12:15], v[252:255]
  s_waitcnt vmcnt(36) lgkmcnt(0)
  s_barrier
  v_mfma_f32_16x16x32_bf16 v[128:131], a[224:227], a[16:19], v[128:131]
  v_mfma_f32_16x16x32_bf16 v[132:135], a[224:227], a[20:23], v[132:135]
  ds_read_b64_tr_b16 a[192:193], v16 offset:16384
  ds_read_b64_tr_b16 a[194:195], v16 offset:17408
  v_mfma_f32_16x16x32_bf16 v[136:139], a[224:227], a[24:27], v[136:139]
  buffer_load_dwordx4 v4, s[12:15], s47 offen offset:2048 lds
  v_mfma_f32_16x16x32_bf16 v[140:143], a[224:227], a[28:31], v[140:143]
  v_mfma_f32_16x16x32_bf16 v[144:147], a[228:231], a[16:19], v[144:147]
  ds_read_b64_tr_b16 a[196:197], v17 offset:16384
  ds_read_b64_tr_b16 a[198:199], v17 offset:17408
  v_mfma_f32_16x16x32_bf16 v[148:151], a[228:231], a[20:23], v[148:151]
  v_mfma_f32_16x16x32_bf16 v[152:155], a[228:231], a[24:27], v[152:155]
  buffer_load_dwordx4 v4, s[12:15], s47 offen offset:3072 lds
  v_mfma_f32_16x16x32_bf16 v[156:159], a[228:231], a[28:31], v[156:159]
  ds_read_b64_tr_b16 a[200:201], v18 offset:16384
  ds_read_b64_tr_b16 a[202:203], v18 offset:17408
  v_mfma_f32_16x16x32_bf16 v[160:163], a[232:235], a[16:19], v[160:163]
  v_mfma_f32_16x16x32_bf16 v[164:167], a[232:235], a[20:23], v[164:167]
  v_mfma_f32_16x16x32_bf16 v[168:171], a[232:235], a[24:27], v[168:171]
  ds_read_b64_tr_b16 a[204:205], v19 offset:16384
  ds_read_b64_tr_b16 a[206:207], v19 offset:17408
  v_mfma_f32_16x16x32_bf16 v[172:175], a[232:235], a[28:31], v[172:175]
  v_mfma_f32_16x16x32_bf16 v[176:179], a[236:239], a[16:19], v[176:179]
  v_mfma_f32_16x16x32_bf16 v[180:183], a[236:239], a[20:23], v[180:183]
  ds_read_b64_tr_b16 a[208:209], v20 offset:16384
  ds_read_b64_tr_b16 a[210:211], v20 offset:17408
  v_mfma_f32_16x16x32_bf16 v[184:187], a[236:239], a[24:27], v[184:187]
  v_mfma_f32_16x16x32_bf16 v[188:191], a[236:239], a[28:31], v[188:191]
  v_mfma_f32_16x16x32_bf16 v[192:195], a[240:243], a[16:19], v[192:195]
  s_waitcnt lgkmcnt(6)
  ds_read_b64_tr_b16 a[212:213], v21 offset:16384
  ds_read_b64_tr_b16 a[214:215], v21 offset:17408
  v_mfma_f32_16x16x32_bf16 v[196:199], a[240:243], a[20:23], v[196:199]
  v_mfma_f32_16x16x32_bf16 v[200:203], a[240:243], a[24:27], v[200:203]
  v_mfma_f32_16x16x32_bf16 v[204:207], a[240:243], a[28:31], v[204:207]
  ds_read_b64_tr_b16 a[216:217], v22 offset:16384
  ds_read_b64_tr_b16 a[218:219], v22 offset:17408
  v_mfma_f32_16x16x32_bf16 v[208:211], a[244:247], a[16:19], v[208:211]
  v_mfma_f32_16x16x32_bf16 v[212:215], a[244:247], a[20:23], v[212:215]
  v_mfma_f32_16x16x32_bf16 v[216:219], a[244:247], a[24:27], v[216:219]
  ds_read_b64_tr_b16 a[220:221], v23 offset:16384
  ds_read_b64_tr_b16 a[222:223], v23 offset:17408
  v_mfma_f32_16x16x32_bf16 v[220:223], a[244:247], a[28:31], v[220:223]
  v_mfma_f32_16x16x32_bf16 v[224:227], a[248:251], a[16:19], v[224:227]
  v_mfma_f32_16x16x32_bf16 v[228:231], a[248:251], a[20:23], v[228:231]
  v_mfma_f32_16x16x32_bf16 v[232:235], a[248:251], a[24:27], v[232:235]
  v_mfma_f32_16x16x32_bf16 v[236:239], a[248:251], a[28:31], v[236:239]
  v_mfma_f32_16x16x32_bf16 v[240:243], a[252:255], a[16:19], v[240:243]
  v_mfma_f32_16x16x32_bf16 v[244:247], a[252:255], a[20:23], v[244:247]
  v_mfma_f32_16x16x32_bf16 v[248:251], a[252:255], a[24:27], v[248:251]
  v_mfma_f32_16x16x32_bf16 v[252:255], a[252:255], a[28:31], v[252:255]
  s_waitcnt vmcnt(32) lgkmcnt(0)
  v_mfma_f32_16x16x32_bf16 v[128:131], a[192:195], a[32:35], v[128:131]
  s_add_u32 m0, s44, 65536
  s_mov_b32 s47, 65536
  v_mfma_f32_16x16x32_bf16 v[132:135], a[192:195], a[36:39], v[132:135]
  ds_read_b64_tr_b16 a[224:225], v16 offset:24576
  ds_read_b64_tr_b16 a[226:227], v16 offset:25600
  v_mfma_f32_16x16x32_bf16 v[136:139], a[192:195], a[40:43], v[136:139]
  buffer_load_dwordx4 v4, s[12:15], s47 offen offset:0 lds
  v_mfma_f32_16x16x32_bf16 v[140:143], a[192:195], a[44:47], v[140:143]
  v_mfma_f32_16x16x32_bf16 v[144:147], a[196:199], a[32:35], v[144:147]
  ds_read_b64_tr_b16 a[228:229], v17 offset:24576
  ds_read_b64_tr_b16 a[230:231], v17 offset:25600
  v_mfma_f32_16x16x32_bf16 v[148:151], a[196:199], a[36:39], v[148:151]
  v_mfma_f32_16x16x32_bf16 v[152:155], a[196:199], a[40:43], v[152:155]
  buffer_load_dwordx4 v4, s[12:15], s47 offen offset:1024 lds
  v_mfma_f32_16x16x32_bf16 v[156:159], a[196:199], a[44:47], v[156:159]
  ds_read_b64_tr_b16 a[232:233], v18 offset:24576
  ds_read_b64_tr_b16 a[234:235], v18 offset:25600
  v_mfma_f32_16x16x32_bf16 v[160:163], a[200:203], a[32:35], v[160:163]
  v_mfma_f32_16x16x32_bf16 v[164:167], a[200:203], a[36:39], v[164:167]
  v_mfma_f32_16x16x32_bf16 v[168:171], a[200:203], a[40:43], v[168:171]
  ds_read_b64_tr_b16 a[236:237], v19 offset:24576
  ds_read_b64_tr_b16 a[238:239], v19 offset:25600
  v_mfma_f32_16x16x32_bf16 v[172:175], a[200:203], a[44:47], v[172:175]
  v_mfma_f32_16x16x32_bf16 v[176:179], a[204:207], a[32:35], v[176:179]
  v_mfma_f32_16x16x32_bf16 v[180:183], a[204:207], a[36:39], v[180:183]
  ds_read_b64_tr_b16 a[240:241], v20 offset:24576
  ds_read_b64_tr_b16 a[242:243], v20 offset:25600
  v_mfma_f32_16x16x32_bf16 v[184:187], a[204:207], a[40:43], v[184:187]
  v_mfma_f32_16x16x32_bf16 v[188:191], a[204:207], a[44:47], v[188:191]
  v_mfma_f32_16x16x32_bf16 v[192:195], a[208:211], a[32:35], v[192:195]
  s_waitcnt lgkmcnt(6)
  ds_read_b64_tr_b16 a[244:245], v21 offset:24576
  ds_read_b64_tr_b16 a[246:247], v21 offset:25600
  v_mfma_f32_16x16x32_bf16 v[196:199], a[208:211], a[36:39], v[196:199]
  v_mfma_f32_16x16x32_bf16 v[200:203], a[208:211], a[40:43], v[200:203]
  v_mfma_f32_16x16x32_bf16 v[204:207], a[208:211], a[44:47], v[204:207]
  ds_read_b64_tr_b16 a[248:249], v22 offset:24576
  ds_read_b64_tr_b16 a[250:251], v22 offset:25600
  v_mfma_f32_16x16x32_bf16 v[208:211], a[212:215], a[32:35], v[208:211]
  v_mfma_f32_16x16x32_bf16 v[212:215], a[212:215], a[36:39], v[212:215]
  v_mfma_f32_16x16x32_bf16 v[216:219], a[212:215], a[40:43], v[216:219]
  ds_read_b64_tr_b16 a[252:253], v23 offset:24576
  ds_read_b64_tr_b16 a[254:255], v23 offset:25600
  v_mfma_f32_16x16x32_bf16 v[220:223], a[212:215], a[44:47], v[220:223]
  v_mfma_f32_16x16x32_bf16 v[224:227], a[216:219], a[32:35], v[224:227]
  v_mfma_f32_16x16x32_bf16 v[228:231], a[216:219], a[36:39], v[228:231]
  v_mfma_f32_16x16x32_bf16 v[232:235], a[216:219], a[40:43], v[232:235]
  v_mfma_f32_16x16x32_bf16 v[236:239], a[216:219], a[44:47], v[236:239]
  v_mfma_f32_16x16x32_bf16 v[240:243], a[220:223], a[32:35], v[240:243]
  v_mfma_f32_16x16x32_bf16 v[244:247], a[220:223], a[36:39], v[244:247]
  v_mfma_f32_16x16x32_bf16 v[248:251], a[220:223], a[40:43], v[248:251]
  v_mfma_f32_16x16x32_bf16 v[252:255], a[220:223], a[44:47], v[252:255]
  s_waitcnt vmcnt(28) lgkmcnt(0)
  s_barrier
  v_mfma_f32_16x16x32_bf16 v[128:131], a[224:227], a[48:51], v[128:131]
  v_mfma_f32_16x16x32_bf16 v[132:135], a[224:227], a[52:55], v[132:135]
  ds_read_b64_tr_b16 a[192:193], v16 offset:32768
  ds_read_b64_tr_b16 a[194:195], v16 offset:33792
  v_mfma_f32_16x16x32_bf16 v[136:139], a[224:227], a[56:59], v[136:139]
  buffer_load_dwordx4 v4, s[12:15], s47 offen offset:2048 lds
  v_mfma_f32_16x16x32_bf16 v[140:143], a[224:227], a[60:63], v[140:143]
  v_mfma_f32_16x16x32_bf16 v[144:147], a[228:231], a[48:51], v[144:147]
  ds_read_b64_tr_b16 a[196:197], v17 offset:32768
  ds_read_b64_tr_b16 a[198:199], v17 offset:33792
  v_mfma_f32_16x16x32_bf16 v[148:151], a[228:231], a[52:55], v[148:151]
  v_mfma_f32_16x16x32_bf16 v[152:155], a[228:231], a[56:59], v[152:155]
  buffer_load_dwordx4 v4, s[12:15], s47 offen offset:3072 lds
  v_mfma_f32_16x16x32_bf16 v[156:159], a[228:231], a[60:63], v[156:159]
  ds_read_b64_tr_b16 a[200:201], v18 offset:32768
  ds_read_b64_tr_b16 a[202:203], v18 offset:33792
  v_mfma_f32_16x16x32_bf16 v[160:163], a[232:235], a[48:51], v[160:163]
  v_mfma_f32_16x16x32_bf16 v[164:167], a[232:235], a[52:55], v[164:167]
  v_mfma_f32_16x16x32_bf16 v[168:171], a[232:235], a[56:59], v[168:171]
  ds_read_b64_tr_b16 a[204:205], v19 offset:32768
  ds_read_b64_tr_b16 a[206:207], v19 offset:33792
  v_mfma_f32_16x16x32_bf16 v[172:175], a[232:235], a[60:63], v[172:175]
  v_mfma_f32_16x16x32_bf16 v[176:179], a[236:239], a[48:51], v[176:179]
  v_mfma_f32_16x16x32_bf16 v[180:183], a[236:239], a[52:55], v[180:183]
  ds_read_b64_tr_b16 a[208:209], v20 offset:32768
  ds_read_b64_tr_b16 a[210:211], v20 offset:33792
  v_mfma_f32_16x16x32_bf16 v[184:187], a[236:239], a[56:59], v[184:187]
  v_mfma_f32_16x16x32_bf16 v[188:191], a[236:239], a[60:63], v[188:191]
  v_mfma_f32_16x16x32_bf16 v[192:195], a[240:243], a[48:51], v[192:195]
  s_waitcnt lgkmcnt(6)
  ds_read_b64_tr_b16 a[212:213], v21 offset:32768
  ds_read_b64_tr_b16 a[214:215], v21 offset:33792
  v_mfma_f32_16x16x32_bf16 v[196:199], a[240:243], a[52:55], v[196:199]
  v_mfma_f32_16x16x32_bf16 v[200:203], a[240:243], a[56:59], v[200:203]
  v_mfma_f32_16x16x32_bf16 v[204:207], a[240:243], a[60:63], v[204:207]
  ds_read_b64_tr_b16 a[216:217], v22 offset:32768
  ds_read_b64_tr_b16 a[218:219], v22 offset:33792
  v_mfma_f32_16x16x32_bf16 v[208:211], a[244:247], a[48:51], v[208:211]
  v_mfma_f32_16x16x32_bf16 v[212:215], a[244:247], a[52:55], v[212:215]
  v_mfma_f32_16x16x32_bf16 v[216:219], a[244:247], a[56:59], v[216:219]
  ds_read_b64_tr_b16 a[220:221], v23 offset:32768
  ds_read_b64_tr_b16 a[222:223], v23 offset:33792
  v_mfma_f32_16x16x32_bf16 v[220:223], a[244:247], a[60:63], v[220:223]
  v_mfma_f32_16x16x32_bf16 v[224:227], a[248:251], a[48:51], v[224:227]
  v_mfma_f32_16x16x32_bf16 v[228:231], a[248:251], a[52:55], v[228:231]
  v_mfma_f32_16x16x32_bf16 v[232:235], a[248:251], a[56:59], v[232:235]
  v_mfma_f32_16x16x32_bf16 v[236:239], a[248:251], a[60:63], v[236:239]
  v_mfma_f32_16x16x32_bf16 v[240:243], a[252:255], a[48:51], v[240:243]
  v_mfma_f32_16x16x32_bf16 v[244:247], a[252:255], a[52:55], v[244:247]
  v_mfma_f32_16x16x32_bf16 v[248:251], a[252:255], a[56:59], v[248:251]
  v_mfma_f32_16x16x32_bf16 v[252:255], a[252:255], a[60:63], v[252:255]
  s_waitcnt vmcnt(24) lgkmcnt(0)
  v_mfma_f32_16x16x32_bf16 v[128:131], a[192:195], a[64:67], v[128:131]
  s_add_u32 m0, s44, 81920
  s_mov_b32 s47, 81920
  v_mfma_f32_16x16x32_bf16 v[132:135], a[192:195], a[68:71], v[132:135]
  ds_read_b64_tr_b16 a[224:225], v16 offset:40960
  ds_read_b64_tr_b16 a[226:227], v16 offset:41984
  v_mfma_f32_16x16x32_bf16 v[136:139], a[192:195], a[72:75], v[136:139]
  buffer_load_dwordx4 v4, s[12:15], s47 offen offset:0 lds
  v_mfma_f32_16x16x32_bf16 v[140:143], a[192:195], a[76:79], v[140:143]
  v_mfma_f32_16x16x32_bf16 v[144:147], a[196:199], a[64:67], v[144:147]
  ds_read_b64_tr_b16 a[228:229], v17 offset:40960
  ds_read_b64_tr_b16 a[230:231], v17 offset:41984
  v_mfma_f32_16x16x32_bf16 v[148:151], a[196:199], a[68:71], v[148:151]
  v_mfma_f32_16x16x32_bf16 v[152:155], a[196:199], a[72:75], v[152:155]
  buffer_load_dwordx4 v4, s[12:15], s47 offen offset:1024 lds
  v_mfma_f32_16x16x32_bf16 v[156:159], a[196:199], a[76:79], v[156:159]
  ds_read_b64_tr_b16 a[232:233], v18 offset:40960
  ds_read_b64_tr_b16 a[234:235], v18 offset:41984
  v_mfma_f32_16x16x32_bf16 v[160:163], a[200:203], a[64:67], v[160:163]
  v_mfma_f32_16x16x32_bf16 v[164:167], a[200:203], a[68:71], v[164:167]
  v_mfma_f32_16x16x32_bf16 v[168:171], a[200:203], a[72:75], v[168:171]
  ds_read_b64_tr_b16 a[236:237], v19 offset:40960
  ds_read_b64_tr_b16 a[238:239], v19 offset:41984
  v_mfma_f32_16x16x32_bf16 v[172:175], a[200:203], a[76:79], v[172:175]
  v_mfma_f32_16x16x32_bf16 v[176:179], a[204:207], a[64:67], v[176:179]
  v_mfma_f32_16x16x32_bf16 v[180:183], a[204:207], a[68:71], v[180:183]
  ds_read_b64_tr_b16 a[240:241], v20 offset:40960
  ds_read_b64_tr_b16 a[242:243], v20 offset:41984
  v_mfma_f32_16x16x32_bf16 v[184:187], a[204:207], a[72:75], v[184:187]
  v_mfma_f32_16x16x32_bf16 v[188:191], a[204:207], a[76:79], v[188:191]
  v_mfma_f32_16x16x32_bf16 v[192:195], a[208:211], a[64:67], v[192:195]
  s_waitcnt lgkmcnt(6)
  ds_read_b64_tr_b16 a[244:245], v21 offset:40960
  ds_read_b64_tr_b16 a[246:247], v21 offset:41984
  v_mfma_f32_16x16x32_bf16 v[196:199], a[208:211], a[68:71], v[196:199]
  v_mfma_f32_16x16x32_bf16 v[200:203], a[208:211], a[72:75], v[200:203]
  v_mfma_f32_16x16x32_bf16 v[204:207], a[208:211], a[76:79], v[204:207]
  ds_read_b64_tr_b16 a[248:249], v22 offset:40960
  ds_read_b64_tr_b16 a[250:251], v22 offset:41984
  v_mfma_f32_16x16x32_bf16 v[208:211], a[212:215], a[64:67], v[208:211]
  v_mfma_f32_16x16x32_bf16 v[212:215], a[212:215], a[68:71], v[212:215]
  v_mfma_f32_16x16x32_bf16 v[216:219], a[212:215], a[72:75], v[216:219]
  ds_read_b64_tr_b16 a[252:253], v23 offset:40960
  ds_read_b64_tr_b16 a[254:255], v23 offset:41984
  v_mfma_f32_16x16x32_bf16 v[220:223], a[212:215], a[76:79], v[220:223]
  v_mfma_f32_16x16x32_bf16 v[224:227], a[216:219], a[64:67], v[224:227]
  v_mfma_f32_16x16x32_bf16 v[228:231], a[216:219], a[68:71], v[228:231]
  v_mfma_f32_16x16x32_bf16 v[232:235], a[216:219], a[72:75], v[232:235]
  v_mfma_f32_16x16x32_bf16 v[236:239], a[216:219], a[76:79], v[236:239]
  v_mfma_f32_16x16x32_bf16 v[240:243], a[220:223], a[64:67], v[240:243]
  v_mfma_f32_16x16x32_bf16 v[244:247], a[220:223], a[68:71], v[244:247]
  v_mfma_f32_16x16x32_bf16 v[248:251], a[220:223], a[72:75], v[248:251]
  v_mfma_f32_16x16x32_bf16 v[252:255], a[220:223], a[76:79], v[252:255]
  s_waitcnt vmcnt(20) lgkmcnt(0)
  s_barrier
  v_mfma_f32_16x16x32_bf16 v[128:131], a[224:227], a[80:83], v[128:131]
  v_mfma_f32_16x16x32_bf16 v[132:135], a[224:227], a[84:87], v[132:135]
  ds_read_b64_tr_b16 a[192:193], v16 offset:49152
  ds_read_b64_tr_b16 a[194:195], v16 offset:50176
  v_mfma_f32_16x16x32_bf16 v[136:139], a[224:227], a[88:91], v[136:139]
  buffer_load_dwordx4 v4, s[12:15], s47 offen offset:2048 lds
  v_mfma_f32_16x16x32_bf16 v[140:143], a[224:227], a[92:95], v[140:143]
  v_mfma_f32_16x16x32_bf16 v[144:147], a[228:231], a[80:83], v[144:147]
  ds_read_b64_tr_b16 a[196:197], v17 offset:49152
  ds_read_b64_tr_b16 a[198:199], v17 offset:50176
  v_mfma_f32_16x16x32_bf16 v[148:151], a[228:231], a[84:87], v[148:151]
  v_mfma_f32_16x16x32_bf16 v[152:155], a[228:231], a[88:91], v[152:155]
  buffer_load_dwordx4 v4, s[12:15], s47 offen offset:3072 lds
  v_mfma_f32_16x16x32_bf16 v[156:159], a[228:231], a[92:95], v[156:159]
  ds_read_b64_tr_b16 a[200:201], v18 offset:49152
  ds_read_b64_tr_b16 a[202:203], v18 offset:50176
  v_mfma_f32_16x16x32_bf16 v[160:163], a[232:235], a[80:83], v[160:163]
  v_mfma_f32_16x16x32_bf16 v[164:167], a[232:235], a[84:87], v[164:167]
  v_mfma_f32_16x16x32_bf16 v[168:171], a[232:235], a[88:91], v[168:171]
  ds_read_b64_tr_b16 a[204:205], v19 offset:49152
  ds_read_b64_tr_b16 a[206:207], v19 offset:50176
  v_mfma_f32_16x16x32_bf16 v[172:175], a[232:235], a[92:95], v[172:175]
  v_mfma_f32_16x16x32_bf16 v[176:179], a[236:239], a[80:83], v[176:179]
  v_mfma_f32_16x16x32_bf16 v[180:183], a[236:239], a[84:87], v[180:183]
  ds_read_b64_tr_b16 a[208:209], v20 offset:49152
  ds_read_b64_tr_b16 a[210:211], v20 offset:50176
  v_mfma_f32_16x16x32_bf16 v[184:187], a[236:239], a[88:91], v[184:187]
  v_mfma_f32_16x16x32_bf16 v[188:191], a[236:239], a[92:95], v[188:191]
  v_mfma_f32_16x16x32_bf16 v[192:195], a[240:243], a[80:83], v[192:195]
  s_waitcnt lgkmcnt(6)
  ds_read_b64_tr_b16 a[212:213], v21 offset:49152
  ds_read_b64_tr_b16 a[214:215], v21 offset:50176
  v_mfma_f32_16x16x32_bf16 v[196:199], a[240:243], a[84:87], v[196:199]
  v_mfma_f32_16x16x32_bf16 v[200:203], a[240:243], a[88:91], v[200:203]
  v_mfma_f32_16x16x32_bf16 v[204:207], a[240:243], a[92:95], v[204:207]
  ds_read_b64_tr_b16 a[216:217], v22 offset:49152
  ds_read_b64_tr_b16 a[218:219], v22 offset:50176
  v_mfma_f32_16x16x32_bf16 v[208:211], a[244:247], a[80:83], v[208:211]
  v_mfma_f32_16x16x32_bf16 v[212:215], a[244:247], a[84:87], v[212:215]
  v_mfma_f32_16x16x32_bf16 v[216:219], a[244:247], a[88:91], v[216:219]
  ds_read_b64_tr_b16 a[220:221], v23 offset:49152
  ds_read_b64_tr_b16 a[222:223], v23 offset:50176
  v_mfma_f32_16x16x32_bf16 v[220:223], a[244:247], a[92:95], v[220:223]
  v_mfma_f32_16x16x32_bf16 v[224:227], a[248:251], a[80:83], v[224:227]
  v_mfma_f32_16x16x32_bf16 v[228:231], a[248:251], a[84:87], v[228:231]
  v_mfma_f32_16x16x32_bf16 v[232:235], a[248:251], a[88:91], v[232:235]
  v_mfma_f32_16x16x32_bf16 v[236:239], a[248:251], a[92:95], v[236:239]
  v_mfma_f32_16x16x32_bf16 v[240:243], a[252:255], a[80:83], v[240:243]
  v_mfma_f32_16x16x32_bf16 v[244:247], a[252:255], a[84:87], v[244:247]
  v_mfma_f32_16x16x32_bf16 v[248:251], a[252:255], a[88:91], v[248:251]
  v_mfma_f32_16x16x32_bf16 v[252:255], a[252:255], a[92:95], v[252:255]
  s_waitcnt vmcnt(16) lgkmcnt(0)
  v_mfma_f32_16x16x32_bf16 v[128:131], a[192:195], a[96:99], v[128:131]
  s_add_u32 m0, s44, 98304
  s_mov_b32 s47, 98304
  v_mfma_f32_16x16x32_bf16 v[132:135], a[192:195], a[100:103], v[132:135]
  ds_read_b64_tr_b16 a[224:225], v16 offset:57344
  ds_read_b64_tr_b16 a[226:227], v16 offset:58368
  v_mfma_f32_16x16x32_bf16 v[136:139], a[192:195], a[104:107], v[136:139]
  buffer_load_dwordx4 v4, s[12:15], s47 offen offset:0 lds
  v_mfma_f32_16x16x32_bf16 v[140:143], a[192:195], a[108:111], v[140:143]
  v_mfma_f32_16x16x32_bf16 v[144:147], a[196:199], a[96:99], v[144:147]
  ds_read_b64_tr_b16 a[228:229], v17 offset:57344
  ds_read_b64_tr_b16 a[230:231], v17 offset:58368
  v_mfma_f32_16x16x32_bf16 v[148:151], a[196:199], a[100:103], v[148:151]
  v_mfma_f32_16x16x32_bf16 v[152:155], a[196:199], a[104:107], v[152:155]
  buffer_load_dwordx4 v4, s[12:15], s47 offen offset:1024 lds
  v_mfma_f32_16x16x32_bf16 v[156:159], a[196:199], a[108:111], v[156:159]
  ds_read_b64_tr_b16 a[232:233], v18 offset:57344
  ds_read_b64_tr_b16 a[234:235], v18 offset:58368
  v_mfma_f32_16x16x32_bf16 v[160:163], a[200:203], a[96:99], v[160:163]
  v_mfma_f32_16x16x32_bf16 v[164:167], a[200:203], a[100:103], v[164:167]
  v_mfma_f32_16x16x32_bf16 v[168:171], a[200:203], a[104:107], v[168:171]
  ds_read_b64_tr_b16 a[236:237], v19 offset:57344
  ds_read_b64_tr_b16 a[238:239], v19 offset:58368
  v_mfma_f32_16x16x32_bf16 v[172:175], a[200:203], a[108:111], v[172:175]
  v_mfma_f32_16x16x32_bf16 v[176:179], a[204:207], a[96:99], v[176:179]
  v_mfma_f32_16x16x32_bf16 v[180:183], a[204:207], a[100:103], v[180:183]
  ds_read_b64_tr_b16 a[240:241], v20 offset:57344
  ds_read_b64_tr_b16 a[242:243], v20 offset:58368
  v_mfma_f32_16x16x32_bf16 v[184:187], a[204:207], a[104:107], v[184:187]
  v_mfma_f32_16x16x32_bf16 v[188:191], a[204:207], a[108:111], v[188:191]
  v_mfma_f32_16x16x32_bf16 v[192:195], a[208:211], a[96:99], v[192:195]
  s_waitcnt lgkmcnt(6)
  ds_read_b64_tr_b16 a[244:245], v21 offset:57344
  ds_read_b64_tr_b16 a[246:247], v21 offset:58368
  v_mfma_f32_16x16x32_bf16 v[196:199], a[208:211], a[100:103], v[196:199]
  v_mfma_f32_16x16x32_bf16 v[200:203], a[208:211], a[104:107], v[200:203]
  v_mfma_f32_16x16x32_bf16 v[204:207], a[208:211], a[108:111], v[204:207]
  ds_read_b64_tr_b16 a[248:249], v22 offset:57344
  ds_read_b64_tr_b16 a[250:251], v22 offset:58368
  v_mfma_f32_16x16x32_bf16 v[208:211], a[212:215], a[96:99], v[208:211]
  v_mfma_f32_16x16x32_bf16 v[212:215], a[212:215], a[100:103], v[212:215]
  v_mfma_f32_16x16x32_bf16 v[216:219], a[212:215], a[104:107], v[216:219]
  ds_read_b64_tr_b16 a[252:253], v23 offset:57344
  ds_read_b64_tr_b16 a[254:255], v23 offset:58368
  v_mfma_f32_16x16x32_bf16 v[220:223], a[212:215], a[108:111], v[220:223]
  v_mfma_f32_16x16x32_bf16 v[224:227], a[216:219], a[96:99], v[224:227]
  v_mfma_f32_16x16x32_bf16 v[228:231], a[216:219], a[100:103], v[228:231]
  v_mfma_f32_16x16x32_bf16 v[232:235], a[216:219], a[104:107], v[232:235]
  v_mfma_f32_16x16x32_bf16 v[236:239], a[216:219], a[108:111], v[236:239]
  v_mfma_f32_16x16x32_bf16 v[240:243], a[220:223], a[96:99], v[240:243]
  v_mfma_f32_16x16x32_bf16 v[244:247], a[220:223], a[100:103], v[244:247]
  v_mfma_f32_16x16x32_bf16 v[248:251], a[220:223], a[104:107], v[248:251]
  v_mfma_f32_16x16x32_bf16 v[252:255], a[220:223], a[108:111], v[252:255]
  s_waitcnt vmcnt(12) lgkmcnt(0)
  v_mfma_f32_16x16x32_bf16 v[128:131], a[224:227], a[112:115], v[128:131]
  v_mfma_f32_16x16x32_bf16 v[132:135], a[224:227], a[116:119], v[132:135]
  v_mfma_f32_16x16x32_bf16 v[136:139], a[224:227], a[120:123], v[136:139]
  v_mfma_f32_16x16x32_bf16 v[140:143], a[224:227], a[124:127], v[140:143]
  v_mfma_f32_16x16x32_bf16 v[144:147], a[228:231], a[112:115], v[144:147]
  v_mfma_f32_16x16x32_bf16 v[148:151], a[228:231], a[116:119], v[148:151]
  v_mfma_f32_16x16x32_bf16 v[152:155], a[228:231], a[120:123], v[152:155]
  buffer_load_dwordx4 v4, s[12:15], s47 offen offset:2048 lds
  v_mfma_f32_16x16x32_bf16 v[156:159], a[228:231], a[124:127], v[156:159]
  v_mfma_f32_16x16x32_bf16 v[160:163], a[232:235], a[112:115], v[160:163]
  v_mfma_f32_16x16x32_bf16 v[164:167], a[232:235], a[116:119], v[164:167]
  v_mfma_f32_16x16x32_bf16 v[168:171], a[232:235], a[120:123], v[168:171]
  buffer_load_dwordx4 v4, s[12:15], s47 offen offset:3072 lds
  v_mfma_f32_16x16x32_bf16 v[172:175], a[232:235], a[124:127], v[172:175]
  v_mfma_f32_16x16x32_bf16 v[176:179], a[236:239], a[112:115], v[176:179]
  v_mfma_f32_16x16x32_bf16 v[180:183], a[236:239], a[116:119], v[180:183]
  v_mfma_f32_16x16x32_bf16 v[184:187], a[236:239], a[120:123], v[184:187]
  v_mfma_f32_16x16x32_bf16 v[188:191], a[236:239], a[124:127], v[188:191]
  v_mfma_f32_16x16x32_bf16 v[192:195], a[240:243], a[112:115], v[192:195]
  v_mfma_f32_16x16x32_bf16 v[196:199], a[240:243], a[116:119], v[196:199]
  v_mfma_f32_16x16x32_bf16 v[200:203], a[240:243], a[120:123], v[200:203]
  v_mfma_f32_16x16x32_bf16 v[204:207], a[240:243], a[124:127], v[204:207]
  v_mfma_f32_16x16x32_bf16 v[208:211], a[244:247], a[112:115], v[208:211]
  v_mfma_f32_16x16x32_bf16 v[212:215], a[244:247], a[116:119], v[212:215]
  v_mfma_f32_16x16x32_bf16 v[216:219], a[244:247], a[120:123], v[216:219]
  v_mfma_f32_16x16x32_bf16 v[220:223], a[244:247], a[124:127], v[220:223]
  v_mfma_f32_16x16x32_bf16 v[224:227], a[248:251], a[112:115], v[224:227]
  v_mfma_f32_16x16x32_bf16 v[228:231], a[248:251], a[116:119], v[228:231]
  v_mfma_f32_16x16x32_bf16 v[232:235], a[248:251], a[120:123], v[232:235]
  v_mfma_f32_16x16x32_bf16 v[236:239], a[248:251], a[124:127], v[236:239]
  v_mfma_f32_16x16x32_bf16 v[240:243], a[252:255], a[112:115], v[240:243]
  v_mfma_f32_16x16x32_bf16 v[244:247], a[252:255], a[116:119], v[244:247]
  v_mfma_f32_16x16x32_bf16 v[248:251], a[252:255], a[120:123], v[248:251]
  v_mfma_f32_16x16x32_bf16 v[252:255], a[252:255], a[124:127], v[252:255]
  s_mov_b32 s3, 1040356334
  v_mul_f32 v128, s3, v128
  v_mul_f32 v129, s3, v129
  v_mul_f32 v130, s3, v130
  v_mul_f32 v131, s3, v131
  v_cvt_pk_bf16_f32 v128, v128, v129
  v_cvt_pk_bf16_f32 v129, v130, v131
  v_accvgpr_write_b32 a128, v128
  v_accvgpr_write_b32 a129, v129
  v_mul_f32 v144, s3, v144
  v_mul_f32 v145, s3, v145
  v_mul_f32 v146, s3, v146
  v_mul_f32 v147, s3, v147
  v_cvt_pk_bf16_f32 v144, v144, v145
  v_cvt_pk_bf16_f32 v145, v146, v147
  v_accvgpr_write_b32 a130, v144
  v_accvgpr_write_b32 a131, v145
  v_mul_f32 v160, s3, v160
  v_mul_f32 v161, s3, v161
  v_mul_f32 v162, s3, v162
  v_mul_f32 v163, s3, v163
  v_cvt_pk_bf16_f32 v160, v160, v161
  v_cvt_pk_bf16_f32 v161, v162, v163
  v_accvgpr_write_b32 a132, v160
  v_accvgpr_write_b32 a133, v161
  v_mul_f32 v176, s3, v176
  v_mul_f32 v177, s3, v177
  v_mul_f32 v178, s3, v178
  v_mul_f32 v179, s3, v179
  v_cvt_pk_bf16_f32 v176, v176, v177
  v_cvt_pk_bf16_f32 v177, v178, v179
  v_accvgpr_write_b32 a134, v176
  v_accvgpr_write_b32 a135, v177
  v_mul_f32 v192, s3, v192
  v_mul_f32 v193, s3, v193
  v_mul_f32 v194, s3, v194
  v_mul_f32 v195, s3, v195
  v_cvt_pk_bf16_f32 v192, v192, v193
  v_cvt_pk_bf16_f32 v193, v194, v195
  v_accvgpr_write_b32 a136, v192
  v_accvgpr_write_b32 a137, v193
  v_mul_f32 v208, s3, v208
  v_mul_f32 v209, s3, v209
  v_mul_f32 v210, s3, v210
  v_mul_f32 v211, s3, v211
  v_cvt_pk_bf16_f32 v208, v208, v209
  v_cvt_pk_bf16_f32 v209, v210, v211
  v_accvgpr_write_b32 a138, v208
  v_accvgpr_write_b32 a139, v209
  v_mul_f32 v224, s3, v224
  v_mul_f32 v225, s3, v225
  v_mul_f32 v226, s3, v226
  v_mul_f32 v227, s3, v227
  v_cvt_pk_bf16_f32 v224, v224, v225
  v_cvt_pk_bf16_f32 v225, v226, v227
  v_accvgpr_write_b32 a140, v224
  v_accvgpr_write_b32 a141, v225
  v_mul_f32 v240, s3, v240
  v_mul_f32 v241, s3, v241
  v_mul_f32 v242, s3, v242
  v_mul_f32 v243, s3, v243
  v_cvt_pk_bf16_f32 v240, v240, v241
  v_cvt_pk_bf16_f32 v241, v242, v243
  v_accvgpr_write_b32 a142, v240
  v_accvgpr_write_b32 a143, v241
  v_mul_f32 v132, s3, v132
  v_mul_f32 v133, s3, v133
  v_mul_f32 v134, s3, v134
  v_mul_f32 v135, s3, v135
  v_cvt_pk_bf16_f32 v132, v132, v133
  v_cvt_pk_bf16_f32 v133, v134, v135
  v_accvgpr_write_b32 a144, v132
  v_accvgpr_write_b32 a145, v133
  v_mul_f32 v148, s3, v148
  v_mul_f32 v149, s3, v149
  v_mul_f32 v150, s3, v150
  v_mul_f32 v151, s3, v151
  v_cvt_pk_bf16_f32 v148, v148, v149
  v_cvt_pk_bf16_f32 v149, v150, v151
  v_accvgpr_write_b32 a146, v148
  v_accvgpr_write_b32 a147, v149
  v_mul_f32 v164, s3, v164
  v_mul_f32 v165, s3, v165
  v_mul_f32 v166, s3, v166
  v_mul_f32 v167, s3, v167
  v_cvt_pk_bf16_f32 v164, v164, v165
  v_cvt_pk_bf16_f32 v165, v166, v167
  v_accvgpr_write_b32 a148, v164
  v_accvgpr_write_b32 a149, v165
  v_mul_f32 v180, s3, v180
  v_mul_f32 v181, s3, v181
  v_mul_f32 v182, s3, v182
  v_mul_f32 v183, s3, v183
  v_cvt_pk_bf16_f32 v180, v180, v181
  v_cvt_pk_bf16_f32 v181, v182, v183
  v_accvgpr_write_b32 a150, v180
  v_accvgpr_write_b32 a151, v181
  v_mul_f32 v196, s3, v196
  v_mul_f32 v197, s3, v197
  v_mul_f32 v198, s3, v198
  v_mul_f32 v199, s3, v199
  v_cvt_pk_bf16_f32 v196, v196, v197
  v_cvt_pk_bf16_f32 v197, v198, v199
  v_accvgpr_write_b32 a152, v196
  v_accvgpr_write_b32 a153, v197
  v_mul_f32 v212, s3, v212
  v_mul_f32 v213, s3, v213
  v_mul_f32 v214, s3, v214
  v_mul_f32 v215, s3, v215
  v_cvt_pk_bf16_f32 v212, v212, v213
  v_cvt_pk_bf16_f32 v213, v214, v215
  v_accvgpr_write_b32 a154, v212
  v_accvgpr_write_b32 a155, v213
  v_mul_f32 v228, s3, v228
  v_mul_f32 v229, s3, v229
  v_mul_f32 v230, s3, v230
  v_mul_f32 v231, s3, v231
  v_cvt_pk_bf16_f32 v228, v228, v229
  v_cvt_pk_bf16_f32 v229, v230, v231
  v_accvgpr_write_b32 a156, v228
  v_accvgpr_write_b32 a157, v229
  v_mul_f32 v244, s3, v244
  v_mul_f32 v245, s3, v245
  v_mul_f32 v246, s3, v246
  v_mul_f32 v247, s3, v247
  v_cvt_pk_bf16_f32 v244, v244, v245
  v_cvt_pk_bf16_f32 v245, v246, v247
  v_accvgpr_write_b32 a158, v244
  v_accvgpr_write_b32 a159, v245
  v_mul_f32 v136, s3, v136
  v_mul_f32 v137, s3, v137
  v_mul_f32 v138, s3, v138
  v_mul_f32 v139, s3, v139
  v_cvt_pk_bf16_f32 v136, v136, v137
  v_cvt_pk_bf16_f32 v137, v138, v139
  v_accvgpr_write_b32 a160, v136
  v_accvgpr_write_b32 a161, v137
  v_mul_f32 v152, s3, v152
  v_mul_f32 v153, s3, v153
  v_mul_f32 v154, s3, v154
  v_mul_f32 v155, s3, v155
  v_cvt_pk_bf16_f32 v152, v152, v153
  v_cvt_pk_bf16_f32 v153, v154, v155
  v_accvgpr_write_b32 a162, v152
  v_accvgpr_write_b32 a163, v153
  v_mul_f32 v168, s3, v168
  v_mul_f32 v169, s3, v169
  v_mul_f32 v170, s3, v170
  v_mul_f32 v171, s3, v171
  v_cvt_pk_bf16_f32 v168, v168, v169
  v_cvt_pk_bf16_f32 v169, v170, v171
  v_accvgpr_write_b32 a164, v168
  v_accvgpr_write_b32 a165, v169
  v_mul_f32 v184, s3, v184
  v_mul_f32 v185, s3, v185
  v_mul_f32 v186, s3, v186
  v_mul_f32 v187, s3, v187
  v_cvt_pk_bf16_f32 v184, v184, v185
  v_cvt_pk_bf16_f32 v185, v186, v187
  v_accvgpr_write_b32 a166, v184
  v_accvgpr_write_b32 a167, v185
  v_mul_f32 v200, s3, v200
  v_mul_f32 v201, s3, v201
  v_mul_f32 v202, s3, v202
  v_mul_f32 v203, s3, v203
  v_cvt_pk_bf16_f32 v200, v200, v201
  v_cvt_pk_bf16_f32 v201, v202, v203
  v_accvgpr_write_b32 a168, v200
  v_accvgpr_write_b32 a169, v201
  v_mul_f32 v216, s3, v216
  v_mul_f32 v217, s3, v217
  v_mul_f32 v218, s3, v218
  v_mul_f32 v219, s3, v219
  v_cvt_pk_bf16_f32 v216, v216, v217
  v_cvt_pk_bf16_f32 v217, v218, v219
  v_accvgpr_write_b32 a170, v216
  v_accvgpr_write_b32 a171, v217
  v_mul_f32 v232, s3, v232
  v_mul_f32 v233, s3, v233
  v_mul_f32 v234, s3, v234
  v_mul_f32 v235, s3, v235
  v_cvt_pk_bf16_f32 v232, v232, v233
  v_cvt_pk_bf16_f32 v233, v234, v235
  v_accvgpr_write_b32 a172, v232
  v_accvgpr_write_b32 a173, v233
  v_mul_f32 v248, s3, v248
  v_mul_f32 v249, s3, v249
  v_mul_f32 v250, s3, v250
  v_mul_f32 v251, s3, v251
  v_cvt_pk_bf16_f32 v248, v248, v249
  v_cvt_pk_bf16_f32 v249, v250, v251
  v_accvgpr_write_b32 a174, v248
  v_accvgpr_write_b32 a175, v249
  v_mul_f32 v140, s3, v140
  v_mul_f32 v141, s3, v141
  v_mul_f32 v142, s3, v142
  v_mul_f32 v143, s3, v143
  v_cvt_pk_bf16_f32 v140, v140, v141
  v_cvt_pk_bf16_f32 v141, v142, v143
  v_accvgpr_write_b32 a176, v140
  v_accvgpr_write_b32 a177, v141
  v_mul_f32 v156, s3, v156
  v_mul_f32 v157, s3, v157
  v_mul_f32 v158, s3, v158
  v_mul_f32 v159, s3, v159
  v_cvt_pk_bf16_f32 v156, v156, v157
  v_cvt_pk_bf16_f32 v157, v158, v159
  v_accvgpr_write_b32 a178, v156
  v_accvgpr_write_b32 a179, v157
  v_mul_f32 v172, s3, v172
  v_mul_f32 v173, s3, v173
  v_mul_f32 v174, s3, v174
  v_mul_f32 v175, s3, v175
  v_cvt_pk_bf16_f32 v172, v172, v173
  v_cvt_pk_bf16_f32 v173, v174, v175
  v_accvgpr_write_b32 a180, v172
  v_accvgpr_write_b32 a181, v173
  v_mul_f32 v188, s3, v188
  v_mul_f32 v189, s3, v189
  v_mul_f32 v190, s3, v190
  v_mul_f32 v191, s3, v191
  v_cvt_pk_bf16_f32 v188, v188, v189
  v_cvt_pk_bf16_f32 v189, v190, v191
  v_accvgpr_write_b32 a182, v188
  v_accvgpr_write_b32 a183, v189
  v_mul_f32 v204, s3, v204
  v_mul_f32 v205, s3, v205
  v_mul_f32 v206, s3, v206
  v_mul_f32 v207, s3, v207
  v_cvt_pk_bf16_f32 v204, v204, v205
  v_cvt_pk_bf16_f32 v205, v206, v207
  v_accvgpr_write_b32 a184, v204
  v_accvgpr_write_b32 a185, v205
  v_mul_f32 v220, s3, v220
  v_mul_f32 v221, s3, v221
  v_mul_f32 v222, s3, v222
  v_mul_f32 v223, s3, v223
  v_cvt_pk_bf16_f32 v220, v220, v221
  v_cvt_pk_bf16_f32 v221, v222, v223
  v_accvgpr_write_b32 a186, v220
  v_accvgpr_write_b32 a187, v221
  v_mul_f32 v236, s3, v236
  v_mul_f32 v237, s3, v237
  v_mul_f32 v238, s3, v238
  v_mul_f32 v239, s3, v239
  v_cvt_pk_bf16_f32 v236, v236, v237
  v_cvt_pk_bf16_f32 v237, v238, v239
  v_accvgpr_write_b32 a188, v236
  v_accvgpr_write_b32 a189, v237
  v_mul_f32 v252, s3, v252
  v_mul_f32 v253, s3, v253
  v_mul_f32 v254, s3, v254
  v_mul_f32 v255, s3, v255
  v_cvt_pk_bf16_f32 v252, v252, v253
  v_cvt_pk_bf16_f32 v253, v254, v255
  v_accvgpr_write_b32 a190, v252
  v_accvgpr_write_b32 a191, v253
  v_accvgpr_write_b32 a0, 0
  v_accvgpr_write_b32 a1, 0
  v_accvgpr_write_b32 a2, 0
  v_accvgpr_write_b32 a3, 0
  v_accvgpr_write_b32 a4, 0
  v_accvgpr_write_b32 a5, 0
  v_accvgpr_write_b32 a6, 0
  v_accvgpr_write_b32 a7, 0
  v_accvgpr_write_b32 a8, 0
  v_accvgpr_write_b32 a9, 0
  v_accvgpr_write_b32 a10, 0
  v_accvgpr_write_b32 a11, 0
  v_accvgpr_write_b32 a12, 0
  v_accvgpr_write_b32 a13, 0
  v_accvgpr_write_b32 a14, 0
  v_accvgpr_write_b32 a15, 0
  v_accvgpr_write_b32 a16, 0
  v_accvgpr_write_b32 a17, 0
  v_accvgpr_write_b32 a18, 0
  v_accvgpr_write_b32 a19, 0
  v_accvgpr_write_b32 a20, 0
  v_accvgpr_write_b32 a21, 0
  v_accvgpr_write_b32 a22, 0
  v_accvgpr_write_b32 a23, 0
  v_accvgpr_write_b32 a24, 0
  v_accvgpr_write_b32 a25, 0
  v_accvgpr_write_b32 a26, 0
  v_accvgpr_write_b32 a27, 0
  v_accvgpr_write_b32 a28, 0
  v_accvgpr_write_b32 a29, 0
  v_accvgpr_write_b32 a30, 0
  v_accvgpr_write_b32 a31, 0
  v_accvgpr_write_b32 a32, 0
  v_accvgpr_write_b32 a33, 0
  v_accvgpr_write_b32 a34, 0
  v_accvgpr_write_b32 a35, 0
  v_accvgpr_write_b32 a36, 0
  v_accvgpr_write_b32 a37, 0
  v_accvgpr_write_b32 a38, 0
  v_accvgpr_write_b32 a39, 0
  v_accvgpr_write_b32 a40, 0
  v_accvgpr_write_b32 a41, 0
  v_accvgpr_write_b32 a42, 0
  v_accvgpr_write_b32 a43, 0
  v_accvgpr_write_b32 a44, 0
  v_accvgpr_write_b32 a45, 0
  v_accvgpr_write_b32 a46, 0
  v_accvgpr_write_b32 a47, 0
  v_accvgpr_write_b32 a48, 0
  v_accvgpr_write_b32 a49, 0
  v_accvgpr_write_b32 a50, 0
  v_accvgpr_write_b32 a51, 0
  v_accvgpr_write_b32 a52, 0
  v_accvgpr_write_b32 a53, 0
  v_accvgpr_write_b32 a54, 0
  v_accvgpr_write_b32 a55, 0
  v_accvgpr_write_b32 a56, 0
  v_accvgpr_write_b32 a57, 0
  v_accvgpr_write_b32 a58, 0
  v_accvgpr_write_b32 a59, 0
  v_accvgpr_write_b32 a60, 0
  v_accvgpr_write_b32 a61, 0
  v_accvgpr_write_b32 a62, 0
  v_accvgpr_write_b32 a63, 0
  v_accvgpr_write_b32 a64, 0
  v_accvgpr_write_b32 a65, 0
  v_accvgpr_write_b32 a66, 0
  v_accvgpr_write_b32 a67, 0
  v_accvgpr_write_b32 a68, 0
  v_accvgpr_write_b32 a69, 0
  v_accvgpr_write_b32 a70, 0
  v_accvgpr_write_b32 a71, 0
  v_accvgpr_write_b32 a72, 0
  v_accvgpr_write_b32 a73, 0
  v_accvgpr_write_b32 a74, 0
  v_accvgpr_write_b32 a75, 0
  v_accvgpr_write_b32 a76, 0
  v_accvgpr_write_b32 a77, 0
  v_accvgpr_write_b32 a78, 0
  v_accvgpr_write_b32 a79, 0
  v_accvgpr_write_b32 a80, 0
  v_accvgpr_write_b32 a81, 0
  v_accvgpr_write_b32 a82, 0
  v_accvgpr_write_b32 a83, 0
  v_accvgpr_write_b32 a84, 0
  v_accvgpr_write_b32 a85, 0
  v_accvgpr_write_b32 a86, 0
  v_accvgpr_write_b32 a87, 0
  v_accvgpr_write_b32 a88, 0
  v_accvgpr_write_b32 a89, 0
  v_accvgpr_write_b32 a90, 0
  v_accvgpr_write_b32 a91, 0
  v_accvgpr_write_b32 a92, 0
  v_accvgpr_write_b32 a93, 0
  v_accvgpr_write_b32 a94, 0
  v_accvgpr_write_b32 a95, 0
  v_accvgpr_write_b32 a96, 0
  v_accvgpr_write_b32 a97, 0
  v_accvgpr_write_b32 a98, 0
  v_accvgpr_write_b32 a99, 0
  v_accvgpr_write_b32 a100, 0
  v_accvgpr_write_b32 a101, 0
  v_accvgpr_write_b32 a102, 0
  v_accvgpr_write_b32 a103, 0
  v_accvgpr_write_b32 a104, 0
  v_accvgpr_write_b32 a105, 0
  v_accvgpr_write_b32 a106, 0
  v_accvgpr_write_b32 a107, 0
  v_accvgpr_write_b32 a108, 0
  v_accvgpr_write_b32 a109, 0
  v_accvgpr_write_b32 a110, 0
  v_accvgpr_write_b32 a111, 0
  v_accvgpr_write_b32 a112, 0
  v_accvgpr_write_b32 a113, 0
  v_accvgpr_write_b32 a114, 0
  v_accvgpr_write_b32 a115, 0
  v_accvgpr_write_b32 a116, 0
  v_accvgpr_write_b32 a117, 0
  v_accvgpr_write_b32 a118, 0
  v_accvgpr_write_b32 a119, 0
  v_accvgpr_write_b32 a120, 0
  v_accvgpr_write_b32 a121, 0
  v_accvgpr_write_b32 a122, 0
  v_accvgpr_write_b32 a123, 0
  v_accvgpr_write_b32 a124, 0
  v_accvgpr_write_b32 a125, 0
  v_accvgpr_write_b32 a126, 0
  v_accvgpr_write_b32 a127, 0
  v_mov_b32 v48, 0
  v_mov_b32 v49, 0
  v_mov_b32 v50, 0
  v_mov_b32 v51, 0
  v_mov_b32 v52, 0
  v_mov_b32 v53, 0
  v_mov_b32 v54, 0
  v_mov_b32 v55, 0
  v_mov_b32 v56, 0
  v_mov_b32 v57, 0
  v_mov_b32 v58, 0
  v_mov_b32 v59, 0
  v_mov_b32 v60, 0
  v_mov_b32 v61, 0
  v_mov_b32 v62, 0
  v_mov_b32 v63, 0
  v_mov_b32 v16, 0x3f803f80
  v_mov_b32 v17, 0x3f803f80
  v_mov_b32 v18, 0x3f803f80
  v_mov_b32 v19, 0x3f803f80
  v_mov_b32 v20, 0xff800000
  s_sub_u32 s55, 15, s34
  s_sub_u32 s45, s36, 3
  s_sub_u32 s46, s35, 3
  s_max_i32 s46, s46, 0
  s_mov_b32 s53, s44
  s_add_u32 s54, s44, 65536
  s_barrier
  ds_read_b128 a[192:195], v2 offset:0
  ds_read_b128 a[196:199], v2 offset:1024
  ds_read_b128 a[200:203], v2 offset:2048
  ds_read_b128 a[204:207], v2 offset:3072
  ds_read_b128 a[208:211], v2 offset:4096
  ds_read_b128 a[212:215], v2 offset:5120
  ds_read_b128 a[216:219], v2 offset:6144
  ds_read_b128 a[220:223], v2 offset:7168
  s_waitcnt lgkmcnt(4)
  v_mfma_f32_16x16x32_bf16 v[128:131], a[192:195], a[128:131], 0
  ds_read_b128 a[224:227], v2 offset:8192
  ds_read_b128 a[228:231], v2 offset:9216
  v_mfma_f32_16x16x32_bf16 v[128:131], a[196:199], a[132:135], v[128:131]
  ds_read_b128 a[232:235], v2 offset:10240
  ds_read_b128 a[236:239], v2 offset:11264
  v_mfma_f32_16x16x32_bf16 v[128:131], a[200:203], a[136:139], v[128:131]
  v_mfma_f32_16x16x32_bf16 v[128:131], a[204:207], a[140:143], v[128:131]
  v_mfma_f32_16x16x32_bf16 v[144:147], a[192:195], a[144:147], 0
  v_mfma_f32_16x16x32_bf16 v[144:147], a[196:199], a[148:151], v[144:147]
  v_mfma_f32_16x16x32_bf16 v[144:147], a[200:203], a[152:155], v[144:147]
  v_mfma_f32_16x16x32_bf16 v[144:147], a[204:207], a[156:159], v[144:147]
  v_mfma_f32_16x16x32_bf16 v[160:163], a[192:195], a[160:163], 0
  v_mfma_f32_16x16x32_bf16 v[160:163], a[196:199], a[164:167], v[160:163]
  v_mfma_f32_16x16x32_bf16 v[160:163], a[200:203], a[168:171], v[160:163]
  v_mfma_f32_16x16x32_bf16 v[160:163], a[204:207], a[172:175], v[160:163]
  v_mfma_f32_16x16x32_bf16 v[176:179], a[192:195], a[176:179], 0
  v_mfma_f32_16x16x32_bf16 v[176:179], a[196:199], a[180:183], v[176:179]
  v_mfma_f32_16x16x32_bf16 v[176:179], a[200:203], a[184:187], v[176:179]
  v_mfma_f32_16x16x32_bf16 v[176:179], a[204:207], a[188:191], v[176:179]
  s_waitcnt lgkmcnt(4)
  v_mfma_f32_16x16x32_bf16 v[132:135], a[208:211], a[128:131], 0
  ds_read_b128 a[240:243], v2 offset:12288
  ds_read_b128 a[244:247], v2 offset:13312
  v_mfma_f32_16x16x32_bf16 v[132:135], a[212:215], a[132:135], v[132:135]
  ds_read_b128 a[248:251], v2 offset:14336
  ds_read_b128 a[252:255], v2 offset:15360
  v_mfma_f32_16x16x32_bf16 v[132:135], a[216:219], a[136:139], v[132:135]
  v_mfma_f32_16x16x32_bf16 v[132:135], a[220:223], a[140:143], v[132:135]
  v_mfma_f32_16x16x32_bf16 v[148:151], a[208:211], a[144:147], 0
  v_mfma_f32_16x16x32_bf16 v[148:151], a[212:215], a[148:151], v[148:151]
  v_mfma_f32_16x16x32_bf16 v[148:151], a[216:219], a[152:155], v[148:151]
  v_mfma_f32_16x16x32_bf16 v[148:151], a[220:223], a[156:159], v[148:151]
  v_mfma_f32_16x16x32_bf16 v[164:167], a[208:211], a[160:163], 0
  v_mfma_f32_16x16x32_bf16 v[164:167], a[212:215], a[164:167], v[164:167]
  v_mfma_f32_16x16x32_bf16 v[164:167], a[216:219], a[168:171], v[164:167]
  v_mfma_f32_16x16x32_bf16 v[164:167], a[220:223], a[172:175], v[164:167]
  v_mfma_f32_16x16x32_bf16 v[180:183], a[208:211], a[176:179], 0
  v_mfma_f32_16x16x32_bf16 v[180:183], a[212:215], a[180:183], v[180:183]
  v_mfma_f32_16x16x32_bf16 v[180:183], a[216:219], a[184:187], v[180:183]
  v_mfma_f32_16x16x32_bf16 v[180:183], a[220:223], a[188:191], v[180:183]
  s_waitcnt lgkmcnt(4)
  v_mfma_f32_16x16x32_bf16 v[136:139], a[224:227], a[128:131], 0
  ds_read_b128 a[192:195], v2 offset:32768
  ds_read_b128 a[196:199], v2 offset:33792
  v_mfma_f32_16x16x32_bf16 v[136:139], a[228:231], a[132:135], v[136:139]
  ds_read_b128 a[200:203], v2 offset:34816
  ds_read_b128 a[204:207], v2 offset:35840
  v_mfma_f32_16x16x32_bf16 v[136:139], a[232:235], a[136:139], v[136:139]
  v_mfma_f32_16x16x32_bf16 v[136:139], a[236:239], a[140:143], v[136:139]
  v_mfma_f32_16x16x32_bf16 v[152:155], a[224:227], a[144:147], 0
  v_mfma_f32_16x16x32_bf16 v[152:155], a[228:231], a[148:151], v[152:155]
  v_mfma_f32_16x16x32_bf16 v[152:155], a[232:235], a[152:155], v[152:155]
  v_mfma_f32_16x16x32_bf16 v[152:155], a[236:239], a[156:159], v[152:155]
  v_mfma_f32_16x16x32_bf16 v[168:171], a[224:227], a[160:163], 0
  v_mfma_f32_16x16x32_bf16 v[168:171], a[228:231], a[164:167], v[168:171]
  v_mfma_f32_16x16x32_bf16 v[168:171], a[232:235], a[168:171], v[168:171]
  v_mfma_f32_16x16x32_bf16 v[168:171], a[236:239], a[172:175], v[168:171]
  v_mfma_f32_16x16x32_bf16 v[184:187], a[224:227], a[176:179], 0
  v_mfma_f32_16x16x32_bf16 v[184:187], a[228:231], a[180:183], v[184:187]
  v_mfma_f32_16x16x32_bf16 v[184:187], a[232:235], a[184:187], v[184:187]
  v_mfma_f32_16x16x32_bf16 v[184:187], a[236:239], a[188:191], v[184:187]
  s_waitcnt lgkmcnt(4)
  v_mfma_f32_16x16x32_bf16 v[140:143], a[240:243], a[128:131], 0
  ds_read_b128 a[208:211], v2 offset:36864
  ds_read_b128 a[212:215], v2 offset:37888
  v_mfma_f32_16x16x32_bf16 v[140:143], a[244:247], a[132:135], v[140:143]
  ds_read_b128 a[216:219], v2 offset:38912
  ds_read_b128 a[220:223], v2 offset:39936
  v_mfma_f32_16x16x32_bf16 v[140:143], a[248:251], a[136:139], v[140:143]
  v_mfma_f32_16x16x32_bf16 v[140:143], a[252:255], a[140:143], v[140:143]
  v_mfma_f32_16x16x32_bf16 v[156:159], a[240:243], a[144:147], 0
  v_mfma_f32_16x16x32_bf16 v[156:159], a[244:247], a[148:151], v[156:159]
  v_mfma_f32_16x16x32_bf16 v[156:159], a[248:251], a[152:155], v[156:159]
  v_mfma_f32_16x16x32_bf16 v[156:159], a[252:255], a[156:159], v[156:159]
  v_mfma_f32_16x16x32_bf16 v[172:175], a[240:243], a[160:163], 0
  v_mfma_f32_16x16x32_bf16 v[172:175], a[244:247], a[164:167], v[172:175]
  v_mfma_f32_16x16x32_bf16 v[172:175], a[248:251], a[168:171], v[172:175]
  v_mfma_f32_16x16x32_bf16 v[172:175], a[252:255], a[172:175], v[172:175]
  v_mfma_f32_16x16x32_bf16 v[188:191], a[240:243], a[176:179], 0
  v_mfma_f32_16x16x32_bf16 v[188:191], a[244:247], a[180:183], v[188:191]
  v_mfma_f32_16x16x32_bf16 v[188:191], a[248:251], a[184:187], v[188:191]
  v_mfma_f32_16x16x32_bf16 v[188:191], a[252:255], a[188:191], v[188:191]
  s_barrier
  s_mov_b32 m0, s53
  s_mov_b32 s38, 131072
  buffer_load_dwordx4 v4, s[12:15], s38 offen offset:0 lds
  buffer_load_dwordx4 v4, s[12:15], s38 offen offset:1024 lds
  buffer_load_dwordx4 v4, s[12:15], s38 offen offset:2048 lds
  buffer_load_dwordx4 v4, s[12:15], s38 offen offset:3072 lds
  s_mov_b32 s38, 163840
  s_mov_b32 s39, 114688
  s_mov_b32 s37, -1
  s_cmp_lg_u32 s34, 0
  s_cbranch_scc1 L_k2_nomask0
  s_nop 7
  s_add_u32 s3, s37, 1
  s_lshl_b32 s3, s3, 6
  v_subrev_u32 v1, s3, v6
  v_cmp_gt_i32 s[56:57], -16, v1
  v_cmp_gt_i32 s[58:59], -15, v1
  v_cmp_gt_i32 s[60:61], -14, v1
  v_cmp_gt_i32 s[62:63], -13, v1
  v_cndmask_b32 v176, v176, v20, s[56:57]
  v_cndmask_b32 v177, v177, v20, s[58:59]
  v_cndmask_b32 v178, v178, v20, s[60:61]
  v_cndmask_b32 v179, v179, v20, s[62:63]
  v_cmp_gt_i32 s[56:57], 0, v1
  v_cmp_gt_i32 s[58:59], 1, v1
  v_cmp_gt_i32 s[60:61], 2, v1
  v_cmp_gt_i32 s[62:63], 3, v1
  v_cndmask_b32 v160, v160, v20, s[56:57]
  v_cndmask_b32 v161, v161, v20, s[58:59]
  v_cndmask_b32 v162, v162, v20, s[60:61]
  v_cndmask_b32 v163, v163, v20, s[62:63]
  v_cndmask_b32 v180, v180, v20, s[56:57]
  v_cndmask_b32 v181, v181, v20, s[58:59]
  v_cndmask_b32 v182, v182, v20, s[60:61]
  v_cndmask_b32 v183, v183, v20, s[62:63]
  v_cmp_gt_i32 s[56:57], 16, v1
  v_cmp_gt_i32 s[58:59], 17, v1
  v_cmp_gt_i32 s[60:61], 18, v1
  v_cmp_gt_i32 s[62:63], 19, v1
  v_cndmask_b32 v164, v164, v20, s[56:57]
  v_cndmask_b32 v165, v165, v20, s[58:59]
  v_cndmask_b32 v166, v166, v20, s[60:61]
  v_cndmask_b32 v167, v167, v20, s[62:63]
  v_cndmask_b32 v184, v184, v20, s[56:57]
  v_cndmask_b32 v185, v185, v20, s[58:59]
  v_cndmask_b32 v186, v186, v20, s[60:61]
  v_cndmask_b32 v187, v187, v20, s[62:63]
  v_cmp_gt_i32 s[56:57], 32, v1
  v_cmp_gt_i32 s[58:59], 33, v1
  v_cmp_gt_i32 s[60:61], 34, v1
  v_cmp_gt_i32 s[62:63], 35, v1
  v_cndmask_b32 v168, v168, v20, s[56:57]
  v_cndmask_b32 v169, v169, v20, s[58:59]
  v_cndmask_b32 v170, v170, v20, s[60:61]
  v_cndmask_b32 v171, v171, v20, s[62:63]
  v_cndmask_b32 v188, v188, v20, s[56:57]
  v_cndmask_b32 v189, v189, v20, s[58:59]
  v_cndmask_b32 v190, v190, v20, s[60:61]
  v_cndmask_b32 v191, v191, v20, s[62:63]
  v_cmp_gt_i32 s[56:57], 48, v1
  v_cmp_gt_i32 s[58:59], 49, v1
  v_cmp_gt_i32 s[60:61], 50, v1
  v_cmp_gt_i32 s[62:63], 51, v1
  v_cndmask_b32 v172, v172, v20, s[56:57]
  v_cndmask_b32 v173, v173, v20, s[58:59]
  v_cndmask_b32 v174, v174, v20, s[60:61]
  v_cndmask_b32 v175, v175, v20, s[62:63]
  s_nop 1
L_k2_nomask0:
  s_mov_b32 s37, 0
  s_nop 7
  v_max3_f32 v21, v128, v129, v130
  v_max3_f32 v21, v21, v131, v132
  v_max3_f32 v21, v21, v133, v134
  v_max3_f32 v21, v21, v135, v136
  v_max3_f32 v21, v21, v137, v138
  v_max3_f32 v21, v21, v139, v140
  v_max3_f32 v21, v21, v141, v142
  v_max_f32 v21, v21, v143
  v_mov_b32 v1, v21
  s_nop 1
  v_permlane16_swap_b32 v1, v21
  v_max_f32 v21, v21, v1
  v_mov_b32 v1, v21
  s_nop 1
  v_permlane32_swap_b32 v1, v21
  v_max_f32 v21, v21, v1
  v_add_f32 v21, 0x40e00000, v21
  v_sub_f32 v128, v128, v21
  v_sub_f32 v129, v129, v21
  v_sub_f32 v130, v130, v21
  v_sub_f32 v131, v131, v21
  v_sub_f32 v132, v132, v21
  v_sub_f32 v133, v133, v21
  v_sub_f32 v134, v134, v21
  v_sub_f32 v135, v135, v21
  v_sub_f32 v136, v136, v21
  v_sub_f32 v137, v137, v21
  v_sub_f32 v138, v138, v21
  v_sub_f32 v139, v139, v21
  v_sub_f32 v140, v140, v21
  v_sub_f32 v141, v141, v21
  v_sub_f32 v142, v142, v21
  v_sub_f32 v143, v143, v21
  v_sub_f32 v32, 0, v21
  v_sub_f32 v33, 0, v21
  v_sub_f32 v34, 0, v21
  v_sub_f32 v35, 0, v21
  v_max3_f32 v21, v144, v145, v146
  v_max3_f32 v21, v21, v147, v148
  v_max3_f32 v21, v21, v149, v150
  v_max3_f32 v21, v21, v151, v152
  v_max3_f32 v21, v21, v153, v154
  v_max3_f32 v21, v21, v155, v156
  v_max3_f32 v21, v21, v157, v158
  v_max_f32 v21, v21, v159
  v_mov_b32 v1, v21
  s_nop 1
  v_permlane16_swap_b32 v1, v21
  v_max_f32 v21, v21, v1
  v_mov_b32 v1, v21
  s_nop 1
  v_permlane32_swap_b32 v1, v21
  v_max_f32 v21, v21, v1
  v_add_f32 v21, 0x40e00000, v21
  v_sub_f32 v144, v144, v21
  v_sub_f32 v145, v145, v21
  v_sub_f32 v146, v146, v21
  v_sub_f32 v147, v147, v21
  v_sub_f32 v148, v148, v21
  v_sub_f32 v149, v149, v21
  v_sub_f32 v150, v150, v21
  v_sub_f32 v151, v151, v21
  v_sub_f32 v152, v152, v21
  v_sub_f32 v153, v153, v21
  v_sub_f32 v154, v154, v21
  v_sub_f32 v155, v155, v21
  v_sub_f32 v156, v156, v21
  v_sub_f32 v157, v157, v21
  v_sub_f32 v158, v158, v21
  v_sub_f32 v159, v159, v21
  v_sub_f32 v36, 0, v21
  v_sub_f32 v37, 0, v21
  v_sub_f32 v38, 0, v21
  v_sub_f32 v39, 0, v21
  v_max3_f32 v21, v160, v161, v162
  v_max3_f32 v21, v21, v163, v164
  v_max3_f32 v21, v21, v165, v166
  v_max3_f32 v21, v21, v167, v168
  v_max3_f32 v21, v21, v169, v170
  v_max3_f32 v21, v21, v171, v172
  v_max3_f32 v21, v21, v173, v174
  v_max_f32 v21, v21, v175
  v_mov_b32 v1, v21
  s_nop 1
  v_permlane16_swap_b32 v1, v21
  v_max_f32 v21, v21, v1
  v_mov_b32 v1, v21
  s_nop 1
  v_permlane32_swap_b32 v1, v21
  v_max_f32 v21, v21, v1
  v_add_f32 v21, 0x40e00000, v21
  v_sub_f32 v160, v160, v21
  v_sub_f32 v161, v161, v21
  v_sub_f32 v162, v162, v21
  v_sub_f32 v163, v163, v21
  v_sub_f32 v164, v164, v21
  v_sub_f32 v165, v165, v21
  v_sub_f32 v166, v166, v21
  v_sub_f32 v167, v167, v21
  v_sub_f32 v168, v168, v21
  v_sub_f32 v169, v169, v21
  v_sub_f32 v170, v170, v21
  v_sub_f32 v171, v171, v21
  v_sub_f32 v172, v172, v21
  v_sub_f32 v173, v173, v21
  v_sub_f32 v174, v174, v21
  v_sub_f32 v175, v175, v21
  v_sub_f32 v40, 0, v21
  v_sub_f32 v41, 0, v21
  v_sub_f32 v42, 0, v21
  v_sub_f32 v43, 0, v21
  v_max3_f32 v21, v176, v177, v178
  v_max3_f32 v21, v21, v179, v180
  v_max3_f32 v21, v21, v181, v182
  v_max3_f32 v21, v21, v183, v184
  v_max3_f32 v21, v21, v185, v186
  v_max3_f32 v21, v21, v187, v188
  v_max3_f32 v21, v21, v189, v190
  v_max_f32 v21, v21, v191
  v_mov_b32 v1, v21
  s_nop 1
  v_permlane16_swap_b32 v1, v21
  v_max_f32 v21, v21, v1
  v_mov_b32 v1, v21
  s_nop 1
  v_permlane32_swap_b32 v1, v21
  v_max_f32 v21, v21, v1
  v_add_f32 v21, 0x40e00000, v21
  v_sub_f32 v176, v176, v21
  v_sub_f32 v177, v177, v21
  v_sub_f32 v178, v178, v21
  v_sub_f32 v179, v179, v21
  v_sub_f32 v180, v180, v21
  v_sub_f32 v181, v181, v21
  v_sub_f32 v182, v182, v21
  v_sub_f32 v183, v183, v21
  v_sub_f32 v184, v184, v21
  v_sub_f32 v185, v185, v21
  v_sub_f32 v186, v186, v21
  v_sub_f32 v187, v187, v21
  v_sub_f32 v188, v188, v21
  v_sub_f32 v189, v189, v21
  v_sub_f32 v190, v190, v21
  v_sub_f32 v191, v191, v21
  v_sub_f32 v44, 0, v21
  v_sub_f32 v45, 0, v21
  v_sub_f32 v46, 0, v21
  v_sub_f32 v47, 0, v21
  v_exp_f32 v8, v128
  v_exp_f32 v9, v129
  v_exp_f32 v10, v130
  v_exp_f32 v11, v131
  v_cvt_pk_bf16_f32 v64, v8, v9
  v_exp_f32 v12, v144
  v_exp_f32 v13, v145
  v_cvt_pk_bf16_f32 v65, v10, v11
  v_exp_f32 v14, v146
  v_exp_f32 v15, v147
  v_cvt_pk_bf16_f32 v72, v12, v13
  v_exp_f32 v8, v160
  v_exp_f32 v9, v161
  v_cvt_pk_bf16_f32 v73, v14, v15
  v_exp_f32 v10, v162
  v_exp_f32 v11, v163
  v_cvt_pk_bf16_f32 v80, v8, v9
  v_exp_f32 v12, v176
  v_exp_f32 v13, v177
  v_cvt_pk_bf16_f32 v81, v10, v11
  v_exp_f32 v14, v178
  v_exp_f32 v15, v179
  v_cvt_pk_bf16_f32 v88, v12, v13
  v_exp_f32 v8, v132
  v_exp_f32 v9, v133
  v_cvt_pk_bf16_f32 v89, v14, v15
  v_exp_f32 v10, v134
  v_exp_f32 v11, v135
  v_cvt_pk_bf16_f32 v66, v8, v9
  v_exp_f32 v12, v148
  v_exp_f32 v13, v149
  v_cvt_pk_bf16_f32 v67, v10, v11
  v_exp_f32 v14, v150
  v_exp_f32 v15, v151
  v_cvt_pk_bf16_f32 v74, v12, v13
  v_exp_f32 v8, v164
  v_exp_f32 v9, v165
  v_cvt_pk_bf16_f32 v75, v14, v15
  v_exp_f32 v10, v166
  v_exp_f32 v11, v167
  v_cvt_pk_bf16_f32 v82, v8, v9
  v_exp_f32 v12, v180
  v_exp_f32 v13, v181
  v_cvt_pk_bf16_f32 v83, v10, v11
  v_exp_f32 v14, v182
  v_exp_f32 v15, v183
  v_cvt_pk_bf16_f32 v90, v12, v13
  v_cvt_pk_bf16_f32 v91, v14, v15
  v_or_b32 v7, v64, v65
  v_or3_b32 v7, v7, v72, v73
  v_or3_b32 v7, v7, v80, v81
  v_or3_b32 v7, v7, v88, v89
  v_or3_b32 v7, v7, v66, v67
  v_or3_b32 v7, v7, v74, v75
  v_or3_b32 v7, v7, v82, v83
  v_or3_b32 v7, v7, v90, v91
  s_sub_u32 s35, s35, 1
  s_sub_u32 s36, s36, 1
L_k2_wloop:
  s_waitcnt lgkmcnt(4)
  v_mfma_f32_16x16x32_bf16 v[192:195], a[192:195], a[128:131], v[32:35]
  v_exp_f32 v8, v136
  v_mfma_f32_16x16x32_bf16 v[192:195], a[196:199], a[132:135], v[192:195]
  v_exp_f32 v9, v137
  v_mfma_f32_16x16x32_bf16 v[192:195], a[200:203], a[136:139], v[192:195]
  ds_read_b128 a[224:227], v2 offset:40960
  v_cvt_pk_bf16_f32 v68, v8, v9
  v_mfma_f32_16x16x32_bf16 v[192:195], a[204:207], a[140:143], v[192:195]
  v_exp_f32 v10, v138
  v_mfma_f32_16x16x32_bf16 v[208:211], a[192:195], a[144:147], v[36:39]
  v_exp_f32 v11, v139
  v_mfma_f32_16x16x32_bf16 v[208:211], a[196:199], a[148:151], v[208:211]
  ds_read_b128 a[228:231], v2 offset:41984
  v_cvt_pk_bf16_f32 v69, v10, v11
  v_mfma_f32_16x16x32_bf16 v[208:211], a[200:203], a[152:155], v[208:211]
  ds_read_b128 a[232:235], v2 offset:43008
  v_or3_b32 v7, v7, v68, v69
  v_mfma_f32_16x16x32_bf16 v[208:211], a[204:207], a[156:159], v[208:211]
  v_exp_f32 v12, v152
  v_mfma_f32_16x16x32_bf16 v[224:227], a[192:195], a[160:163], v[40:43]
  v_exp_f32 v13, v153
  v_mfma_f32_16x16x32_bf16 v[224:227], a[196:199], a[164:167], v[224:227]
  ds_read_b128 a[236:239], v2 offset:44032
  v_cvt_pk_bf16_f32 v76, v12, v13
  v_mfma_f32_16x16x32_bf16 v[224:227], a[200:203], a[168:171], v[224:227]
  v_exp_f32 v14, v154
  v_mfma_f32_16x16x32_bf16 v[224:227], a[204:207], a[172:175], v[224:227]
  v_exp_f32 v15, v155
  v_mfma_f32_16x16x32_bf16 v[240:243], a[192:195], a[176:179], v[44:47]
  v_exp_f32 v8, v168
  v_mfma_f32_16x16x32_bf16 v[240:243], a[196:199], a[180:183], v[240:243]
  v_exp_f32 v9, v169
  v_mfma_f32_16x16x32_bf16 v[240:243], a[200:203], a[184:187], v[240:243]
  v_exp_f32 v10, v170
  v_mfma_f32_16x16x32_bf16 v[240:243], a[204:207], a[188:191], v[240:243]
  s_waitcnt lgkmcnt(4)
  v_exp_f32 v11, v171
  v_mfma_f32_16x16x32_bf16 v[196:199], a[208:211], a[128:131], v[32:35]
  ds_read_b128 a[240:243], v2 offset:45056
  v_cvt_pk_bf16_f32 v77, v14, v15
  v_mfma_f32_16x16x32_bf16 v[196:199], a[212:215], a[132:135], v[196:199]
  ds_read_b128 a[244:247], v2 offset:46080
  v_cvt_pk_bf16_f32 v84, v8, v9
  v_mfma_f32_16x16x32_bf16 v[196:199], a[216:219], a[136:139], v[196:199]
  ds_read_b128 a[248:251], v2 offset:47104
  v_cvt_pk_bf16_f32 v85, v10, v11
  v_mfma_f32_16x16x32_bf16 v[196:199], a[220:223], a[140:143], v[196:199]
  ds_read_b128 a[252:255], v2 offset:48128
  v_or3_b32 v7, v7, v76, v77
  v_mfma_f32_16x16x32_bf16 v[212:215], a[208:211], a[144:147], v[36:39]
  v_exp_f32 v12, v184
  v_mfma_f32_16x16x32_bf16 v[212:215], a[212:215], a[148:151], v[212:215]
  v_exp_f32 v13, v185
  v_mfma_f32_16x16x32_bf16 v[212:215], a[216:219], a[152:155], v[212:215]
  v_exp_f32 v14, v186
  v_mfma_f32_16x16x32_bf16 v[212:215], a[220:223], a[156:159], v[212:215]
  v_exp_f32 v15, v187
  v_mfma_f32_16x16x32_bf16 v[228:231], a[208:211], a[160:163], v[40:43]
  v_cvt_pk_bf16_f32 v92, v12, v13
  v_cvt_pk_bf16_f32 v93, v14, v15
  v_mfma_f32_16x16x32_bf16 v[228:231], a[212:215], a[164:167], v[228:231]
  v_exp_f32 v8, v140
  v_mfma_f32_16x16x32_bf16 v[228:231], a[216:219], a[168:171], v[228:231]
  v_exp_f32 v9, v141
  v_mfma_f32_16x16x32_bf16 v[228:231], a[220:223], a[172:175], v[228:231]
  v_cvt_pk_bf16_f32 v70, v8, v9
  v_or3_b32 v7, v7, v84, v85
  v_mfma_f32_16x16x32_bf16 v[244:247], a[208:211], a[176:179], v[44:47]
  v_exp_f32 v10, v142
  v_mfma_f32_16x16x32_bf16 v[244:247], a[212:215], a[180:183], v[244:247]
  v_exp_f32 v11, v143
  v_mfma_f32_16x16x32_bf16 v[244:247], a[216:219], a[184:187], v[244:247]
  v_exp_f32 v12, v156
  v_mfma_f32_16x16x32_bf16 v[244:247], a[220:223], a[188:191], v[244:247]
  s_waitcnt lgkmcnt(4)
  v_exp_f32 v13, v157
  v_mfma_f32_16x16x32_bf16 v[200:203], a[224:227], a[128:131], v[32:35]
  ds_read_b128 a[192:195], v2 offset:16384
  v_cvt_pk_bf16_f32 v71, v10, v11
  v_mfma_f32_16x16x32_bf16 v[200:203], a[228:231], a[132:135], v[200:203]
  ds_read_b128 a[196:199], v2 offset:17408
  v_cvt_pk_bf16_f32 v78, v12, v13
  v_mfma_f32_16x16x32_bf16 v[200:203], a[232:235], a[136:139], v[200:203]
  ds_read_b128 a[200:203], v2 offset:18432
  v_or3_b32 v7, v7, v92, v93
  v_mfma_f32_16x16x32_bf16 v[200:203], a[236:239], a[140:143], v[200:203]
  ds_read_b128 a[204:207], v2 offset:19456
  v_or3_b32 v7, v7, v70, v71
  v_mfma_f32_16x16x32_bf16 v[216:219], a[224:227], a[144:147], v[36:39]
  v_exp_f32 v14, v158
  v_mfma_f32_16x16x32_bf16 v[216:219], a[228:231], a[148:151], v[216:219]
  v_exp_f32 v15, v159
  v_mfma_f32_16x16x32_bf16 v[216:219], a[232:235], a[152:155], v[216:219]
  v_exp_f32 v8, v172
  v_mfma_f32_16x16x32_bf16 v[216:219], a[236:239], a[156:159], v[216:219]
  v_exp_f32 v9, v173
  v_mfma_f32_16x16x32_bf16 v[232:235], a[224:227], a[160:163], v[40:43]
  v_exp_f32 v10, v174
  v_mfma_f32_16x16x32_bf16 v[232:235], a[228:231], a[164:167], v[232:235]
  v_exp_f32 v11, v175
  v_mfma_f32_16x16x32_bf16 v[232:235], a[232:235], a[168:171], v[232:235]
  v_cvt_pk_bf16_f32 v79, v14, v15
  v_cvt_pk_bf16_f32 v86, v8, v9
  v_mfma_f32_16x16x32_bf16 v[232:235], a[236:239], a[172:175], v[232:235]
  v_exp_f32 v12, v188
  v_mfma_f32_16x16x32_bf16 v[248:251], a[224:227], a[176:179], v[44:47]
  v_exp_f32 v13, v189
  v_mfma_f32_16x16x32_bf16 v[248:251], a[228:231], a[180:183], v[248:251]
  v_cvt_pk_bf16_f32 v87, v10, v11
  v_cvt_pk_bf16_f32 v94, v12, v13
  v_mfma_f32_16x16x32_bf16 v[248:251], a[232:235], a[184:187], v[248:251]
  v_exp_f32 v14, v190
  v_mfma_f32_16x16x32_bf16 v[248:251], a[236:239], a[188:191], v[248:251]
  s_waitcnt lgkmcnt(4)
  v_exp_f32 v15, v191
  v_mfma_f32_16x16x32_bf16 v[204:207], a[240:243], a[128:131], v[32:35]
  ds_read_b128 a[208:211], v2 offset:20480
  v_cvt_pk_bf16_f32 v95, v14, v15
  v_mfma_f32_16x16x32_bf16 v[204:207], a[244:247], a[132:135], v[204:207]
  ds_read_b128 a[212:215], v2 offset:21504
  v_or3_b32 v7, v7, v78, v79
  v_mfma_f32_16x16x32_bf16 v[204:207], a[248:251], a[136:139], v[204:207]
  ds_read_b128 a[216:219], v2 offset:22528
  v_or3_b32 v7, v7, v86, v87
  v_mfma_f32_16x16x32_bf16 v[204:207], a[252:255], a[140:143], v[204:207]
  ds_read_b128 a[220:223], v2 offset:23552
  v_or3_b32 v7, v7, v94, v95
  v_mfma_f32_16x16x32_bf16 v[220:223], a[240:243], a[144:147], v[36:39]
  v_and_b32 v1, 0x40004000, v7
  v_cmp_ne_u32 vcc, 0, v1
  v_mfma_f32_16x16x32_bf16 v[220:223], a[244:247], a[148:151], v[220:223]
  v_mfma_f32_16x16x32_bf16 v[220:223], a[248:251], a[152:155], v[220:223]
  v_mfma_f32_16x16x32_bf16 v[220:223], a[252:255], a[156:159], v[220:223]
  v_mfma_f32_16x16x32_bf16 v[236:239], a[240:243], a[160:163], v[40:43]
  v_mfma_f32_16x16x32_bf16 v[236:239], a[244:247], a[164:167], v[236:239]
  v_mfma_f32_16x16x32_bf16 v[236:239], a[248:251], a[168:171], v[236:239]
  v_mfma_f32_16x16x32_bf16 v[236:239], a[252:255], a[172:175], v[236:239]
  v_mfma_f32_16x16x32_bf16 v[252:255], a[240:243], a[176:179], v[44:47]
  v_mfma_f32_16x16x32_bf16 v[252:255], a[244:247], a[180:183], v[252:255]
  v_mfma_f32_16x16x32_bf16 v[252:255], a[248:251], a[184:187], v[252:255]
  v_mfma_f32_16x16x32_bf16 v[252:255], a[252:255], a[188:191], v[252:255]
  s_cbranch_vccnz L_k2_fb_we
L_k2_fbr_we:
  s_cmp_ge_u32 s37, s46
  s_cbranch_scc1 L_k2_mk_we
L_k2_mkr_we:
  s_waitcnt vmcnt(12)
  s_barrier
  s_waitcnt lgkmcnt(4)
  v_mfma_f32_16x16x32_bf16 a[0:3], a[192:195], v[64:67], a[0:3]
  s_add_u32 m0, s54, 49152
  v_exp_f32 v8, v192
  v_mfma_f32_16x16x32_bf16 a[0:3], a[196:199], v[68:71], a[0:3]
  buffer_load_dwordx4 v4, s[12:15], s39 offen offset:0 lds
  v_mfma_f32_16x16x32_bf16 a[32:35], a[192:195], v[72:75], a[32:35]
  v_exp_f32 v9, v193
  v_mfma_f32_16x16x32_bf16 a[32:35], a[196:199], v[76:79], a[32:35]
  ds_read_b128 a[224:227], v2 offset:24576
  v_cvt_pk_bf16_f32 v96, v8, v9
  v_mfma_f32_16x16x32_bf16 a[64:67], a[192:195], v[80:83], a[64:67]
  v_exp_f32 v10, v194
  v_mfma_f32_16x16x32_bf16 a[64:67], a[196:199], v[84:87], a[64:67]
  v_exp_f32 v11, v195
  v_mfma_f32_16x16x32_bf16 a[96:99], a[192:195], v[88:91], a[96:99]
  ds_read_b128 a[228:231], v2 offset:25600
  v_cvt_pk_bf16_f32 v97, v10, v11
  v_mfma_f32_16x16x32_bf16 a[96:99], a[196:199], v[92:95], a[96:99]
  ds_read_b128 a[232:235], v2 offset:26624
  v_or_b32 v7, v96, v97
  v_mfma_f32_16x16x32_bf16 a[4:7], a[200:203], v[64:67], a[4:7]
  v_exp_f32 v12, v208
  v_mfma_f32_16x16x32_bf16 a[4:7], a[204:207], v[68:71], a[4:7]
  buffer_load_dwordx4 v4, s[12:15], s39 offen offset:1024 lds
  v_mfma_f32_16x16x32_bf16 a[36:39], a[200:203], v[72:75], a[36:39]
  v_exp_f32 v13, v209
  v_mfma_f32_16x16x32_bf16 a[36:39], a[204:207], v[76:79], a[36:39]
  ds_read_b128 a[236:239], v2 offset:27648
  v_cvt_pk_bf16_f32 v104, v12, v13
  v_mfma_f32_16x16x32_bf16 a[68:71], a[200:203], v[80:83], a[68:71]
  v_exp_f32 v14, v210
  v_mfma_f32_16x16x32_bf16 a[68:71], a[204:207], v[84:87], a[68:71]
  v_exp_f32 v15, v211
  v_mfma_f32_16x16x32_bf16 a[100:103], a[200:203], v[88:91], a[100:103]
  v_exp_f32 v8, v224
  v_mfma_f32_16x16x32_bf16 a[100:103], a[204:207], v[92:95], a[100:103]
  v_exp_f32 v9, v225
  v_mfma_f32_16x16x32_bf16 v[48:51], v[16:19], v[64:67], v[48:51]
  v_exp_f32 v10, v226
  v_mfma_f32_16x16x32_bf16 v[48:51], v[16:19], v[68:71], v[48:51]
  buffer_load_dwordx4 v4, s[12:15], s39 offen offset:2048 lds
  s_waitcnt lgkmcnt(4)
  v_mfma_f32_16x16x32_bf16 a[8:11], a[208:211], v[64:67], a[8:11]
  ds_read_b128 a[240:243], v2 offset:28672
  v_cvt_pk_bf16_f32 v105, v14, v15
  v_mfma_f32_16x16x32_bf16 a[8:11], a[212:215], v[68:71], a[8:11]
  ds_read_b128 a[244:247], v2 offset:29696
  v_cvt_pk_bf16_f32 v112, v8, v9
  v_mfma_f32_16x16x32_bf16 a[40:43], a[208:211], v[72:75], a[40:43]
  ds_read_b128 a[248:251], v2 offset:30720
  v_or3_b32 v7, v7, v104, v105
  v_mfma_f32_16x16x32_bf16 a[40:43], a[212:215], v[76:79], a[40:43]
  v_exp_f32 v11, v227
  v_mfma_f32_16x16x32_bf16 a[72:75], a[208:211], v[80:83], a[72:75]
  ds_read_b128 a[252:255], v2 offset:31744
  v_cvt_pk_bf16_f32 v113, v10, v11
  v_mfma_f32_16x16x32_bf16 a[72:75], a[212:215], v[84:87], a[72:75]
  v_exp_f32 v12, v240
  v_mfma_f32_16x16x32_bf16 a[104:107], a[208:211], v[88:91], a[104:107]
  v_exp_f32 v13, v241
  v_mfma_f32_16x16x32_bf16 a[104:107], a[212:215], v[92:95], a[104:107]
  buffer_load_dwordx4 v4, s[12:15], s39 offen offset:3072 lds
  v_mfma_f32_16x16x32_bf16 a[12:15], a[216:219], v[64:67], a[12:15]
  v_exp_f32 v14, v242
  v_mfma_f32_16x16x32_bf16 a[12:15], a[220:223], v[68:71], a[12:15]
  v_exp_f32 v15, v243
  v_mfma_f32_16x16x32_bf16 a[44:47], a[216:219], v[72:75], a[44:47]
  v_cvt_pk_bf16_f32 v120, v12, v13
  v_cvt_pk_bf16_f32 v121, v14, v15
  v_mfma_f32_16x16x32_bf16 a[44:47], a[220:223], v[76:79], a[44:47]
  v_exp_f32 v8, v196
  v_mfma_f32_16x16x32_bf16 a[76:79], a[216:219], v[80:83], a[76:79]
  v_exp_f32 v9, v197
  v_mfma_f32_16x16x32_bf16 a[76:79], a[220:223], v[84:87], a[76:79]
  v_cvt_pk_bf16_f32 v98, v8, v9
  v_or3_b32 v7, v7, v112, v113
  v_mfma_f32_16x16x32_bf16 a[108:111], a[216:219], v[88:91], a[108:111]
  s_add_u32 m0, s53, 32768
  v_exp_f32 v10, v198
  v_mfma_f32_16x16x32_bf16 a[108:111], a[220:223], v[92:95], a[108:111]
  buffer_load_dwordx4 v4, s[12:15], s38 offen offset:0 lds
  v_mfma_f32_16x16x32_bf16 v[52:55], v[16:19], v[72:75], v[52:55]
  v_exp_f32 v11, v199
  v_mfma_f32_16x16x32_bf16 v[52:55], v[16:19], v[76:79], v[52:55]
  s_waitcnt lgkmcnt(4)
  v_exp_f32 v12, v212
  v_mfma_f32_16x16x32_bf16 a[16:19], a[224:227], v[64:67], a[16:19]
  ds_read_b128 a[192:195], v3 offset:0
  v_cvt_pk_bf16_f32 v99, v10, v11
  v_mfma_f32_16x16x32_bf16 a[16:19], a[228:231], v[68:71], a[16:19]
  ds_read_b128 a[196:199], v3 offset:1024
  v_or3_b32 v7, v7, v120, v121
  v_mfma_f32_16x16x32_bf16 a[48:51], a[224:227], v[72:75], a[48:51]
  ds_read_b128 a[200:203], v3 offset:2048
  v_or3_b32 v7, v7, v98, v99
  v_mfma_f32_16x16x32_bf16 a[48:51], a[228:231], v[76:79], a[48:51]
  v_exp_f32 v13, v213
  v_mfma_f32_16x16x32_bf16 a[80:83], a[224:227], v[80:83], a[80:83]
  s_add_u32 s39, s39, 32768
  ds_read_b128 a[204:207], v3 offset:3072
  v_cvt_pk_bf16_f32 v106, v12, v13
  v_mfma_f32_16x16x32_bf16 a[80:83], a[228:231], v[84:87], a[80:83]
  buffer_load_dwordx4 v4, s[12:15], s38 offen offset:1024 lds
  v_mfma_f32_16x16x32_bf16 a[112:115], a[224:227], v[88:91], a[112:115]
  v_exp_f32 v14, v214
  v_mfma_f32_16x16x32_bf16 a[112:115], a[228:231], v[92:95], a[112:115]
  v_exp_f32 v15, v215
  v_mfma_f32_16x16x32_bf16 a[20:23], a[232:235], v[64:67], a[20:23]
  v_exp_f32 v8, v228
  v_mfma_f32_16x16x32_bf16 a[20:23], a[236:239], v[68:71], a[20:23]
  v_exp_f32 v9, v229
  v_mfma_f32_16x16x32_bf16 a[52:55], a[232:235], v[72:75], a[52:55]
  v_exp_f32 v10, v230
  v_mfma_f32_16x16x32_bf16 a[52:55], a[236:239], v[76:79], a[52:55]
  v_exp_f32 v11, v231
  v_mfma_f32_16x16x32_bf16 a[84:87], a[232:235], v[80:83], a[84:87]
  v_cvt_pk_bf16_f32 v107, v14, v15
  v_cvt_pk_bf16_f32 v114, v8, v9
  v_mfma_f32_16x16x32_bf16 a[84:87], a[236:239], v[84:87], a[84:87]
  buffer_load_dwordx4 v4, s[12:15], s38 offen offset:2048 lds
  v_mfma_f32_16x16x32_bf16 a[116:119], a[232:235], v[88:91], a[116:119]
  v_exp_f32 v12, v244
  v_mfma_f32_16x16x32_bf16 a[116:119], a[236:239], v[92:95], a[116:119]
  v_exp_f32 v13, v245
  v_mfma_f32_16x16x32_bf16 v[56:59], v[16:19], v[80:83], v[56:59]
  v_cvt_pk_bf16_f32 v115, v10, v11
  v_cvt_pk_bf16_f32 v122, v12, v13
  v_mfma_f32_16x16x32_bf16 v[56:59], v[16:19], v[84:87], v[56:59]
  s_waitcnt lgkmcnt(4)
  v_exp_f32 v14, v246
  v_mfma_f32_16x16x32_bf16 a[24:27], a[240:243], v[64:67], a[24:27]
  ds_read_b128 a[208:211], v3 offset:4096
  v_or3_b32 v7, v7, v106, v107
  v_mfma_f32_16x16x32_bf16 a[24:27], a[244:247], v[68:71], a[24:27]
  ds_read_b128 a[212:215], v3 offset:5120
  v_or3_b32 v7, v7, v114, v115
  v_mfma_f32_16x16x32_bf16 a[56:59], a[240:243], v[72:75], a[56:59]
  v_exp_f32 v15, v247
  v_mfma_f32_16x16x32_bf16 a[56:59], a[244:247], v[76:79], a[56:59]
  buffer_load_dwordx4 v4, s[12:15], s38 offen offset:3072 lds
  v_mfma_f32_16x16x32_bf16 a[88:91], a[240:243], v[80:83], a[88:91]
  ds_read_b128 a[216:219], v3 offset:6144
  v_cvt_pk_bf16_f32 v123, v14, v15
  v_mfma_f32_16x16x32_bf16 a[88:91], a[244:247], v[84:87], a[88:91]
  ds_read_b128 a[220:223], v3 offset:7168
  v_or3_b32 v7, v7, v122, v123
  v_mfma_f32_16x16x32_bf16 a[120:123], a[240:243], v[88:91], a[120:123]
  v_mfma_f32_16x16x32_bf16 a[120:123], a[244:247], v[92:95], a[120:123]
  v_mfma_f32_16x16x32_bf16 a[28:31], a[248:251], v[64:67], a[28:31]
  v_mfma_f32_16x16x32_bf16 a[28:31], a[252:255], v[68:71], a[28:31]
  v_mfma_f32_16x16x32_bf16 a[60:63], a[248:251], v[72:75], a[60:63]
  v_mfma_f32_16x16x32_bf16 a[60:63], a[252:255], v[76:79], a[60:63]
  v_mfma_f32_16x16x32_bf16 a[92:95], a[248:251], v[80:83], a[92:95]
  v_mfma_f32_16x16x32_bf16 a[92:95], a[252:255], v[84:87], a[92:95]
  v_mfma_f32_16x16x32_bf16 a[124:127], a[248:251], v[88:91], a[124:127]
  v_mfma_f32_16x16x32_bf16 a[124:127], a[252:255], v[92:95], a[124:127]
  v_mfma_f32_16x16x32_bf16 v[60:63], v[16:19], v[88:91], v[60:63]
  v_mfma_f32_16x16x32_bf16 v[60:63], v[16:19], v[92:95], v[60:63]
  s_add_u32 s38, s38, 32768
  s_add_u32 s37, s37, 1
  s_cmp_eq_u32 s37, s35
  s_cbranch_scc1 L_k2_trans
  s_waitcnt lgkmcnt(4)
  v_mfma_f32_16x16x32_bf16 v[128:131], a[192:195], a[128:131], v[32:35]
  v_exp_f32 v8, v200
  v_mfma_f32_16x16x32_bf16 v[128:131], a[196:199], a[132:135], v[128:131]
  v_exp_f32 v9, v201
  v_mfma_f32_16x16x32_bf16 v[128:131], a[200:203], a[136:139], v[128:131]
  ds_read_b128 a[224:227], v3 offset:8192
  v_cvt_pk_bf16_f32 v100, v8, v9
  v_mfma_f32_16x16x32_bf16 v[128:131], a[204:207], a[140:143], v[128:131]
  v_exp_f32 v10, v202
  v_mfma_f32_16x16x32_bf16 v[144:147], a[192:195], a[144:147], v[36:39]
  v_exp_f32 v11, v203
  v_mfma_f32_16x16x32_bf16 v[144:147], a[196:199], a[148:151], v[144:147]
  ds_read_b128 a[228:231], v3 offset:9216
  v_cvt_pk_bf16_f32 v101, v10, v11
  v_mfma_f32_16x16x32_bf16 v[144:147], a[200:203], a[152:155], v[144:147]
  ds_read_b128 a[232:235], v3 offset:10240
  v_or3_b32 v7, v7, v100, v101
  v_mfma_f32_16x16x32_bf16 v[144:147], a[204:207], a[156:159], v[144:147]
  v_exp_f32 v12, v216
  v_mfma_f32_16x16x32_bf16 v[160:163], a[192:195], a[160:163], v[40:43]
  v_exp_f32 v13, v217
  v_mfma_f32_16x16x32_bf16 v[160:163], a[196:199], a[164:167], v[160:163]
  ds_read_b128 a[236:239], v3 offset:11264
  v_cvt_pk_bf16_f32 v108, v12, v13
  v_mfma_f32_16x16x32_bf16 v[160:163], a[200:203], a[168:171], v[160:163]
  v_exp_f32 v14, v218
  v_mfma_f32_16x16x32_bf16 v[160:163], a[204:207], a[172:175], v[160:163]
  v_exp_f32 v15, v219
  v_mfma_f32_16x16x32_bf16 v[176:179], a[192:195], a[176:179], v[44:47]
  v_exp_f32 v8, v232
  v_mfma_f32_16x16x32_bf16 v[176:179], a[196:199], a[180:183], v[176:179]
  v_exp_f32 v9, v233
  v_mfma_f32_16x16x32_bf16 v[176:179], a[200:203], a[184:187], v[176:179]
  v_exp_f32 v10, v234
  v_mfma_f32_16x16x32_bf16 v[176:179], a[204:207], a[188:191], v[176:179]
  s_waitcnt lgkmcnt(4)
  v_exp_f32 v11, v235
  v_mfma_f32_16x16x32_bf16 v[132:135], a[208:211], a[128:131], v[32:35]
  ds_read_b128 a[240:243], v3 offset:12288
  v_cvt_pk_bf16_f32 v109, v14, v15
  v_mfma_f32_16x16x32_bf16 v[132:135], a[212:215], a[132:135], v[132:135]
  ds_read_b128 a[244:247], v3 offset:13312
  v_cvt_pk_bf16_f32 v116, v8, v9
  v_mfma_f32_16x16x32_bf16 v[132:135], a[216:219], a[136:139], v[132:135]
  ds_read_b128 a[248:251], v3 offset:14336
  v_cvt_pk_bf16_f32 v117, v10, v11
  v_mfma_f32_16x16x32_bf16 v[132:135], a[220:223], a[140:143], v[132:135]
  ds_read_b128 a[252:255], v3 offset:15360
  v_or3_b32 v7, v7, v108, v109
  v_mfma_f32_16x16x32_bf16 v[148:151], a[208:211], a[144:147], v[36:39]
  v_exp_f32 v12, v248
  v_mfma_f32_16x16x32_bf16 v[148:151], a[212:215], a[148:151], v[148:151]
  v_exp_f32 v13, v249
  v_mfma_f32_16x16x32_bf16 v[148:151], a[216:219], a[152:155], v[148:151]
  v_exp_f32 v14, v250
  v_mfma_f32_16x16x32_bf16 v[148:151], a[220:223], a[156:159], v[148:151]
  v_exp_f32 v15, v251
  v_mfma_f32_16x16x32_bf16 v[164:167], a[208:211], a[160:163], v[40:43]
  v_cvt_pk_bf16_f32 v124, v12, v13
  v_cvt_pk_bf16_f32 v125, v14, v15
  v_mfma_f32_16x16x32_bf16 v[164:167], a[212:215], a[164:167], v[164:167]
  v_exp_f32 v8, v204
  v_mfma_f32_16x16x32_bf16 v[164:167], a[216:219], a[168:171], v[164:167]
  v_exp_f32 v9, v205
  v_mfma_f32_16x16x32_bf16 v[164:167], a[220:223], a[172:175], v[164:167]
  v_cvt_pk_bf16_f32 v102, v8, v9
  v_or3_b32 v7, v7, v116, v117
  v_mfma_f32_16x16x32_bf16 v[180:183], a[208:211], a[176:179], v[44:47]
  v_exp_f32 v10, v206
  v_mfma_f32_16x16x32_bf16 v[180:183], a[212:215], a[180:183], v[180:183]
  v_exp_f32 v11, v207
  v_mfma_f32_16x16x32_bf16 v[180:183], a[216:219], a[184:187], v[180:183]
  v_exp_f32 v12, v220
  v_mfma_f32_16x16x32_bf16 v[180:183], a[220:223], a[188:191], v[180:183]
  s_waitcnt lgkmcnt(4)
  v_exp_f32 v13, v221
  v_mfma_f32_16x16x32_bf16 v[136:139], a[224:227], a[128:131], v[32:35]
  ds_read_b128 a[192:195], v2 offset:49152
  v_cvt_pk_bf16_f32 v103, v10, v11
  v_mfma_f32_16x16x32_bf16 v[136:139], a[228:231], a[132:135], v[136:139]
  ds_read_b128 a[196:199], v2 offset:50176
  v_cvt_pk_bf16_f32 v110, v12, v13
  v_mfma_f32_16x16x32_bf16 v[136:139], a[232:235], a[136:139], v[136:139]
  ds_read_b128 a[200:203], v2 offset:51200
  v_or3_b32 v7, v7, v124, v125
  v_mfma_f32_16x16x32_bf16 v[136:139], a[236:239], a[140:143], v[136:139]
  ds_read_b128 a[204:207], v2 offset:52224
  v_or3_b32 v7, v7, v102, v103
  v_mfma_f32_16x16x32_bf16 v[152:155], a[224:227], a[144:147], v[36:39]
  v_exp_f32 v14, v222
  v_mfma_f32_16x16x32_bf16 v[152:155], a[228:231], a[148:151], v[152:155]
  v_exp_f32 v15, v223
  v_mfma_f32_16x16x32_bf16 v[152:155], a[232:235], a[152:155], v[152:155]
  v_exp_f32 v8, v236
  v_mfma_f32_16x16x32_bf16 v[152:155], a[236:239], a[156:159], v[152:155]
  v_exp_f32 v9, v237
  v_mfma_f32_16x16x32_bf16 v[168:171], a[224:227], a[160:163], v[40:43]
  v_exp_f32 v10, v238
  v_mfma_f32_16x16x32_bf16 v[168:171], a[228:231], a[164:167], v[168:171]
  v_exp_f32 v11, v239
  v_mfma_f32_16x16x32_bf16 v[168:171], a[232:235], a[168:171], v[168:171]
  v_cvt_pk_bf16_f32 v111, v14, v15
  v_cvt_pk_bf16_f32 v118, v8, v9
  v_mfma_f32_16x16x32_bf16 v[168:171], a[236:239], a[172:175], v[168:171]
  v_exp_f32 v12, v252
  v_mfma_f32_16x16x32_bf16 v[184:187], a[224:227], a[176:179], v[44:47]
  v_exp_f32 v13, v253
  v_mfma_f32_16x16x32_bf16 v[184:187], a[228:231], a[180:183], v[184:187]
  v_cvt_pk_bf16_f32 v119, v10, v11
  v_cvt_pk_bf16_f32 v126, v12, v13
  v_mfma_f32_16x16x32_bf16 v[184:187], a[232:235], a[184:187], v[184:187]
  v_exp_f32 v14, v254
  v_mfma_f32_16x16x32_bf16 v[184:187], a[236:239], a[188:191], v[184:187]
  s_waitcnt lgkmcnt(4)
  v_exp_f32 v15, v255
  v_mfma_f32_16x16x32_bf16 v[140:143], a[240:243], a[128:131], v[32:35]
  ds_read_b128 a[208:211], v2 offset:53248
  v_cvt_pk_bf16_f32 v127, v14, v15
  v_mfma_f32_16x16x32_bf16 v[140:143], a[244:247], a[132:135], v[140:143]
  ds_read_b128 a[212:215], v2 offset:54272
  v_or3_b32 v7, v7, v110, v111
  v_mfma_f32_16x16x32_bf16 v[140:143], a[248:251], a[136:139], v[140:143]
  ds_read_b128 a[216:219], v2 offset:55296
  v_or3_b32 v7, v7, v118, v119
  v_mfma_f32_16x16x32_bf16 v[140:143], a[252:255], a[140:143], v[140:143]
  ds_read_b128 a[220:223], v2 offset:56320
  v_or3_b32 v7, v7, v126, v127
  v_mfma_f32_16x16x32_bf16 v[156:159], a[240:243], a[144:147], v[36:39]
  v_and_b32 v1, 0x40004000, v7
  v_cmp_ne_u32 vcc, 0, v1
  v_mfma_f32_16x16x32_bf16 v[156:159], a[244:247], a[148:151], v[156:159]
  v_mfma_f32_16x16x32_bf16 v[156:159], a[248:251], a[152:155], v[156:159]
  v_mfma_f32_16x16x32_bf16 v[156:159], a[252:255], a[156:159], v[156:159]
  v_mfma_f32_16x16x32_bf16 v[172:175], a[240:243], a[160:163], v[40:43]
  v_mfma_f32_16x16x32_bf16 v[172:175], a[244:247], a[164:167], v[172:175]
  v_mfma_f32_16x16x32_bf16 v[172:175], a[248:251], a[168:171], v[172:175]
  v_mfma_f32_16x16x32_bf16 v[172:175], a[252:255], a[172:175], v[172:175]
  v_mfma_f32_16x16x32_bf16 v[188:191], a[240:243], a[176:179], v[44:47]
  v_mfma_f32_16x16x32_bf16 v[188:191], a[244:247], a[180:183], v[188:191]
  v_mfma_f32_16x16x32_bf16 v[188:191], a[248:251], a[184:187], v[188:191]
  v_mfma_f32_16x16x32_bf16 v[188:191], a[252:255], a[188:191], v[188:191]
  s_cbranch_vccnz L_k2_fb_wo
L_k2_fbr_wo:
  s_cmp_ge_u32 s37, s46
  s_cbranch_scc1 L_k2_mk_wo
L_k2_mkr_wo:
  s_waitcnt vmcnt(12)
  s_barrier
  s_waitcnt lgkmcnt(4)
  v_mfma_f32_16x16x32_bf16 a[0:3], a[192:195], v[96:99], a[0:3]
  s_add_u32 m0, s53, 16384
  v_exp_f32 v8, v128
  v_mfma_f32_16x16x32_bf16 a[0:3], a[196:199], v[100:103], a[0:3]
  buffer_load_dwordx4 v4, s[12:15], s39 offen offset:0 lds
  v_mfma_f32_16x16x32_bf16 a[32:35], a[192:195], v[104:107], a[32:35]
  v_exp_f32 v9, v129
  v_mfma_f32_16x16x32_bf16 a[32:35], a[196:199], v[108:111], a[32:35]
  ds_read_b128 a[224:227], v2 offset:57344
  v_cvt_pk_bf16_f32 v64, v8, v9
  v_mfma_f32_16x16x32_bf16 a[64:67], a[192:195], v[112:115], a[64:67]
  v_exp_f32 v10, v130
  v_mfma_f32_16x16x32_bf16 a[64:67], a[196:199], v[116:119], a[64:67]
  v_exp_f32 v11, v131
  v_mfma_f32_16x16x32_bf16 a[96:99], a[192:195], v[120:123], a[96:99]
  ds_read_b128 a[228:231], v2 offset:58368
  v_cvt_pk_bf16_f32 v65, v10, v11
  v_mfma_f32_16x16x32_bf16 a[96:99], a[196:199], v[124:127], a[96:99]
  ds_read_b128 a[232:235], v2 offset:59392
  v_or_b32 v7, v64, v65
  v_mfma_f32_16x16x32_bf16 a[4:7], a[200:203], v[96:99], a[4:7]
  v_exp_f32 v12, v144
  v_mfma_f32_16x16x32_bf16 a[4:7], a[204:207], v[100:103], a[4:7]
  buffer_load_dwordx4 v4, s[12:15], s39 offen offset:1024 lds
  v_mfma_f32_16x16x32_bf16 a[36:39], a[200:203], v[104:107], a[36:39]
  v_exp_f32 v13, v145
  v_mfma_f32_16x16x32_bf16 a[36:39], a[204:207], v[108:111], a[36:39]
  ds_read_b128 a[236:239], v2 offset:60416
  v_cvt_pk_bf16_f32 v72, v12, v13
  v_mfma_f32_16x16x32_bf16 a[68:71], a[200:203], v[112:115], a[68:71]
  v_exp_f32 v14, v146
  v_mfma_f32_16x16x32_bf16 a[68:71], a[204:207], v[116:119], a[68:71]
  v_exp_f32 v15, v147
  v_mfma_f32_16x16x32_bf16 a[100:103], a[200:203], v[120:123], a[100:103]
  v_exp_f32 v8, v160
  v_mfma_f32_16x16x32_bf16 a[100:103], a[204:207], v[124:127], a[100:103]
  v_exp_f32 v9, v161
  v_mfma_f32_16x16x32_bf16 v[48:51], v[16:19], v[96:99], v[48:51]
  v_exp_f32 v10, v162
  v_mfma_f32_16x16x32_bf16 v[48:51], v[16:19], v[100:103], v[48:51]
  buffer_load_dwordx4 v4, s[12:15], s39 offen offset:2048 lds
  s_waitcnt lgkmcnt(4)
  v_mfma_f32_16x16x32_bf16 a[8:11], a[208:211], v[96:99], a[8:11]
  ds_read_b128 a[240:243], v2 offset:61440
  v_cvt_pk_bf16_f32 v73, v14, v15
  v_mfma_f32_16x16x32_bf16 a[8:11], a[212:215], v[100:103], a[8:11]
  ds_read_b128 a[244:247], v2 offset:62464
  v_cvt_pk_bf16_f32 v80, v8, v9
  v_mfma_f32_16x16x32_bf16 a[40:43], a[208:211], v[104:107], a[40:43]
  ds_read_b128 a[248:251], v2 offset:63488
  v_or3_b32 v7, v7, v72, v73
  v_mfma_f32_16x16x32_bf16 a[40:43], a[212:215], v[108:111], a[40:43]
  v_exp_f32 v11, v163
  v_mfma_f32_16x16x32_bf16 a[72:75], a[208:211], v[112:115], a[72:75]
  ds_read_b128 a[252:255], v2 offset:64512
  v_cvt_pk_bf16_f32 v81, v10, v11
  v_mfma_f32_16x16x32_bf16 a[72:75], a[212:215], v[116:119], a[72:75]
  v_exp_f32 v12, v176
  v_mfma_f32_16x16x32_bf16 a[104:107], a[208:211], v[120:123], a[104:107]
  v_exp_f32 v13, v177
  v_mfma_f32_16x16x32_bf16 a[104:107], a[212:215], v[124:127], a[104:107]
  buffer_load_dwordx4 v4, s[12:15], s39 offen offset:3072 lds
  v_mfma_f32_16x16x32_bf16 a[12:15], a[216:219], v[96:99], a[12:15]
  v_exp_f32 v14, v178
  v_mfma_f32_16x16x32_bf16 a[12:15], a[220:223], v[100:103], a[12:15]
  v_exp_f32 v15, v179
  v_mfma_f32_16x16x32_bf16 a[44:47], a[216:219], v[104:107], a[44:47]
  v_cvt_pk_bf16_f32 v88, v12, v13
  v_cvt_pk_bf16_f32 v89, v14, v15
  v_mfma_f32_16x16x32_bf16 a[44:47], a[220:223], v[108:111], a[44:47]
  v_exp_f32 v8, v132
  v_mfma_f32_16x16x32_bf16 a[76:79], a[216:219], v[112:115], a[76:79]
  v_exp_f32 v9, v133
  v_mfma_f32_16x16x32_bf16 a[76:79], a[220:223], v[116:119], a[76:79]
  v_cvt_pk_bf16_f32 v66, v8, v9
  v_or3_b32 v7, v7, v80, v81
  v_mfma_f32_16x16x32_bf16 a[108:111], a[216:219], v[120:123], a[108:111]
  s_mov_b32 m0, s54
  v_exp_f32 v10, v134
  v_mfma_f32_16x16x32_bf16 a[108:111], a[220:223], v[124:127], a[108:111]
  buffer_load_dwordx4 v4, s[12:15], s38 offen offset:0 lds
  v_mfma_f32_16x16x32_bf16 v[52:55], v[16:19], v[104:107], v[52:55]
  v_exp_f32 v11, v135
  v_mfma_f32_16x16x32_bf16 v[52:55], v[16:19], v[108:111], v[52:55]
  s_waitcnt lgkmcnt(4)
  v_exp_f32 v12, v148
  v_mfma_f32_16x16x32_bf16 a[16:19], a[224:227], v[96:99], a[16:19]
  ds_read_b128 a[192:195], v3 offset:32768
  v_cvt_pk_bf16_f32 v67, v10, v11
  v_mfma_f32_16x16x32_bf16 a[16:19], a[228:231], v[100:103], a[16:19]
  ds_read_b128 a[196:199], v3 offset:33792
  v_or3_b32 v7, v7, v88, v89
  v_mfma_f32_16x16x32_bf16 a[48:51], a[224:227], v[104:107], a[48:51]
  ds_read_b128 a[200:203], v3 offset:34816
  v_or3_b32 v7, v7, v66, v67
  v_mfma_f32_16x16x32_bf16 a[48:51], a[228:231], v[108:111], a[48:51]
  v_exp_f32 v13, v149
  v_mfma_f32_16x16x32_bf16 a[80:83], a[224:227], v[112:115], a[80:83]
  s_add_u32 s39, s39, 32768
  ds_read_b128 a[204:207], v3 offset:35840
  v_cvt_pk_bf16_f32 v74, v12, v13
  v_mfma_f32_16x16x32_bf16 a[80:83], a[228:231], v[116:119], a[80:83]
  buffer_load_dwordx4 v4, s[12:15], s38 offen offset:1024 lds
  v_mfma_f32_16x16x32_bf16 a[112:115], a[224:227], v[120:123], a[112:115]
  v_exp_f32 v14, v150
  v_mfma_f32_16x16x32_bf16 a[112:115], a[228:231], v[124:127], a[112:115]
  v_exp_f32 v15, v151
  v_mfma_f32_16x16x32_bf16 a[20:23], a[232:235], v[96:99], a[20:23]
  v_exp_f32 v8, v164
  v_mfma_f32_16x16x32_bf16 a[20:23], a[236:239], v[100:103], a[20:23]
  v_exp_f32 v9, v165
  v_mfma_f32_16x16x32_bf16 a[52:55], a[232:235], v[104:107], a[52:55]
  v_exp_f32 v10, v166
  v_mfma_f32_16x16x32_bf16 a[52:55], a[236:239], v[108:111], a[52:55]
  v_exp_f32 v11, v167
  v_mfma_f32_16x16x32_bf16 a[84:87], a[232:235], v[112:115], a[84:87]
  v_cvt_pk_bf16_f32 v75, v14, v15
  v_cvt_pk_bf16_f32 v82, v8, v9
  v_mfma_f32_16x16x32_bf16 a[84:87], a[236:239], v[116:119], a[84:87]
  buffer_load_dwordx4 v4, s[12:15], s38 offen offset:2048 lds
  v_mfma_f32_16x16x32_bf16 a[116:119], a[232:235], v[120:123], a[116:119]
  v_exp_f32 v12, v180
  v_mfma_f32_16x16x32_bf16 a[116:119], a[236:239], v[124:127], a[116:119]
  v_exp_f32 v13, v181
  v_mfma_f32_16x16x32_bf16 v[56:59], v[16:19], v[112:115], v[56:59]
  v_cvt_pk_bf16_f32 v83, v10, v11
  v_cvt_pk_bf16_f32 v90, v12, v13
  v_mfma_f32_16x16x32_bf16 v[56:59], v[16:19], v[116:119], v[56:59]
  s_waitcnt lgkmcnt(4)
  v_exp_f32 v14, v182
  v_mfma_f32_16x16x32_bf16 a[24:27], a[240:243], v[96:99], a[24:27]
  ds_read_b128 a[208:211], v3 offset:36864
  v_or3_b32 v7, v7, v74, v75
  v_mfma_f32_16x16x32_bf16 a[24:27], a[244:247], v[100:103], a[24:27]
  ds_read_b128 a[212:215], v3 offset:37888
  v_or3_b32 v7, v7, v82, v83
  v_mfma_f32_16x16x32_bf16 a[56:59], a[240:243], v[104:107], a[56:59]
  v_exp_f32 v15, v183
  v_mfma_f32_16x16x32_bf16 a[56:59], a[244:247], v[108:111], a[56:59]
  buffer_load_dwordx4 v4, s[12:15], s38 offen offset:3072 lds
  v_mfma_f32_16x16x32_bf16 a[88:91], a[240:243], v[112:115], a[88:91]
  ds_read_b128 a[216:219], v3 offset:38912
  v_cvt_pk_bf16_f32 v91, v14, v15
  v_mfma_f32_16x16x32_bf16 a[88:91], a[244:247], v[116:119], a[88:91]
  ds_read_b128 a[220:223], v3 offset:39936
  v_or3_b32 v7, v7, v90, v91
  v_mfma_f32_16x16x32_bf16 a[120:123], a[240:243], v[120:123], a[120:123]
  v_mfma_f32_16x16x32_bf16 a[120:123], a[244:247], v[124:127], a[120:123]
  v_mfma_f32_16x16x32_bf16 a[28:31], a[248:251], v[96:99], a[28:31]
  v_mfma_f32_16x16x32_bf16 a[28:31], a[252:255], v[100:103], a[28:31]
  v_mfma_f32_16x16x32_bf16 a[60:63], a[248:251], v[104:107], a[60:63]
  v_mfma_f32_16x16x32_bf16 a[60:63], a[252:255], v[108:111], a[60:63]
  v_mfma_f32_16x16x32_bf16 a[92:95], a[248:251], v[112:115], a[92:95]
  v_mfma_f32_16x16x32_bf16 a[92:95], a[252:255], v[116:119], a[92:95]
  v_mfma_f32_16x16x32_bf16 a[124:127], a[248:251], v[120:123], a[124:127]
  v_mfma_f32_16x16x32_bf16 a[124:127], a[252:255], v[124:127], a[124:127]
  v_mfma_f32_16x16x32_bf16 v[60:63], v[16:19], v[120:123], v[60:63]
  v_mfma_f32_16x16x32_bf16 v[60:63], v[16:19], v[124:127], v[60:63]
  s_add_u32 s38, s38, 32768
  s_add_u32 s37, s37, 1
  v_swap_b32 v2, v3
  s_xor_b32 s53, s53, 65536
  s_xor_b32 s54, s54, 65536
  s_branch L_k2_wloop
L_k2_trans:
  s_waitcnt lgkmcnt(4)
  v_mfma_f32_16x16x32_bf16 v[128:131], a[192:195], a[128:131], v[32:35]
  v_exp_f32 v8, v200
  v_mfma_f32_16x16x32_bf16 v[128:131], a[196:199], a[132:135], v[128:131]
  v_exp_f32 v9, v201
  v_mfma_f32_16x16x32_bf16 v[128:131], a[200:203], a[136:139], v[128:131]
  ds_read_b128 a[224:227], v3 offset:8192
  v_cvt_pk_bf16_f32 v100, v8, v9
  v_mfma_f32_16x16x32_bf16 v[128:131], a[204:207], a[140:143], v[128:131]
  v_exp_f32 v10, v202
  v_mfma_f32_16x16x32_bf16 v[144:147], a[192:195], a[144:147], v[36:39]
  ds_read_b128 a[228:231], v3 offset:9216
  ds_read_b128 a[232:235], v3 offset:10240
  v_mfma_f32_16x16x32_bf16 v[144:147], a[196:199], a[148:151], v[144:147]
  v_exp_f32 v11, v203
  v_mfma_f32_16x16x32_bf16 v[144:147], a[200:203], a[152:155], v[144:147]
  ds_read_b128 a[236:239], v3 offset:11264
  v_cvt_pk_bf16_f32 v101, v10, v11
  v_mfma_f32_16x16x32_bf16 v[144:147], a[204:207], a[156:159], v[144:147]
  s_waitcnt lgkmcnt(4)
  v_exp_f32 v12, v216
  v_mfma_f32_16x16x32_bf16 v[132:135], a[208:211], a[128:131], v[32:35]
  ds_read_b128 a[240:243], v3 offset:12288
  v_or3_b32 v7, v7, v100, v101
  v_mfma_f32_16x16x32_bf16 v[132:135], a[212:215], a[132:135], v[132:135]
  v_exp_f32 v13, v217
  v_mfma_f32_16x16x32_bf16 v[132:135], a[216:219], a[136:139], v[132:135]
  ds_read_b128 a[244:247], v3 offset:13312
  v_cvt_pk_bf16_f32 v108, v12, v13
  v_mfma_f32_16x16x32_bf16 v[132:135], a[220:223], a[140:143], v[132:135]
  v_exp_f32 v14, v218
  v_mfma_f32_16x16x32_bf16 v[148:151], a[208:211], a[144:147], v[36:39]
  v_exp_f32 v15, v219
  v_mfma_f32_16x16x32_bf16 v[148:151], a[212:215], a[148:151], v[148:151]
  ds_read_b128 a[248:251], v3 offset:14336
  v_cvt_pk_bf16_f32 v109, v14, v15
  v_mfma_f32_16x16x32_bf16 v[148:151], a[216:219], a[152:155], v[148:151]
  ds_read_b128 a[252:255], v3 offset:15360
  v_or3_b32 v7, v7, v108, v109
  v_mfma_f32_16x16x32_bf16 v[148:151], a[220:223], a[156:159], v[148:151]
  s_waitcnt lgkmcnt(4)
  v_exp_f32 v8, v232
  v_mfma_f32_16x16x32_bf16 v[136:139], a[224:227], a[128:131], v[32:35]
  v_exp_f32 v9, v233
  v_mfma_f32_16x16x32_bf16 v[136:139], a[228:231], a[132:135], v[136:139]
  ds_read_b128 a[192:195], v2 offset:49152
  v_cvt_pk_bf16_f32 v116, v8, v9
  v_mfma_f32_16x16x32_bf16 v[136:139], a[232:235], a[136:139], v[136:139]
  v_exp_f32 v10, v234
  v_mfma_f32_16x16x32_bf16 v[136:139], a[236:239], a[140:143], v[136:139]
  v_exp_f32 v11, v235
  v_mfma_f32_16x16x32_bf16 v[152:155], a[224:227], a[144:147], v[36:39]
  ds_read_b128 a[196:199], v2 offset:50176
  v_cvt_pk_bf16_f32 v117, v10, v11
  v_mfma_f32_16x16x32_bf16 v[152:155], a[228:231], a[148:151], v[152:155]
  ds_read_b128 a[200:203], v2 offset:51200
  v_or3_b32 v7, v7, v116, v117
  v_mfma_f32_16x16x32_bf16 v[152:155], a[232:235], a[152:155], v[152:155]
  ds_read_b128 a[204:207], v2 offset:52224
  v_mfma_f32_16x16x32_bf16 v[152:155], a[236:239], a[156:159], v[152:155]
  s_waitcnt lgkmcnt(4)
  v_exp_f32 v12, v248
  v_mfma_f32_16x16x32_bf16 v[140:143], a[240:243], a[128:131], v[32:35]
  v_exp_f32 v13, v249
  v_mfma_f32_16x16x32_bf16 v[140:143], a[244:247], a[132:135], v[140:143]
  ds_read_b128 a[208:211], v2 offset:53248
  v_cvt_pk_bf16_f32 v124, v12, v13
  v_mfma_f32_16x16x32_bf16 v[140:143], a[248:251], a[136:139], v[140:143]
  v_exp_f32 v14, v250
  v_mfma_f32_16x16x32_bf16 v[140:143], a[252:255], a[140:143], v[140:143]
  v_exp_f32 v15, v251
  v_mfma_f32_16x16x32_bf16 v[156:159], a[240:243], a[144:147], v[36:39]
  ds_read_b128 a[212:215], v2 offset:54272
  v_cvt_pk_bf16_f32 v125, v14, v15
  v_mfma_f32_16x16x32_bf16 v[156:159], a[244:247], a[148:151], v[156:159]
  ds_read_b128 a[216:219], v2 offset:55296
  v_or3_b32 v7, v7, v124, v125
  v_mfma_f32_16x16x32_bf16 v[156:159], a[248:251], a[152:155], v[156:159]
  ds_read_b128 a[220:223], v2 offset:56320
  v_mfma_f32_16x16x32_bf16 v[156:159], a[252:255], a[156:159], v[156:159]
  v_exp_f32 v8, v204
  v_exp_f32 v9, v205
  v_exp_f32 v10, v206
  v_exp_f32 v11, v207
  v_exp_f32 v12, v220
  v_cvt_pk_bf16_f32 v102, v8, v9
  v_exp_f32 v13, v221
  v_exp_f32 v14, v222
  v_cvt_pk_bf16_f32 v103, v10, v11
  v_exp_f32 v15, v223
  v_exp_f32 v8, v236
  v_cvt_pk_bf16_f32 v110, v12, v13
  v_exp_f32 v9, v237
  v_exp_f32 v10, v238
  v_cvt_pk_bf16_f32 v111, v14, v15
  v_exp_f32 v11, v239
  v_exp_f32 v12, v252
  v_cvt_pk_bf16_f32 v118, v8, v9
  v_exp_f32 v13, v253
  v_exp_f32 v14, v254
  v_cvt_pk_bf16_f32 v119, v10, v11
  v_exp_f32 v15, v255
  v_cvt_pk_bf16_f32 v126, v12, v13
  v_cvt_pk_bf16_f32 v127, v14, v15
  v_or3_b32 v7, v7, v102, v103
  v_or3_b32 v7, v7, v110, v111
  v_or3_b32 v7, v7, v118, v119
  v_or3_b32 v7, v7, v126, v127
  v_and_b32 v1, 0x40004000, v7
  v_cmp_ne_u32 vcc, 0, v1
  s_cbranch_vccnz L_k2_fb_tr
L_k2_fbr_tr:
  s_cmp_ge_u32 s37, s45
  s_cbranch_scc1 L_k2_mk_tr
L_k2_mkr_tr:
  s_waitcnt vmcnt(12)
  s_barrier
  s_waitcnt lgkmcnt(4)
  v_mfma_f32_16x16x32_bf16 a[0:3], a[192:195], v[96:99], a[0:3]
  s_add_u32 m0, s53, 16384
  v_exp_f32 v8, v128
  v_mfma_f32_16x16x32_bf16 a[0:3], a[196:199], v[100:103], a[0:3]
  buffer_load_dwordx4 v4, s[12:15], s39 offen offset:0 lds
  v_mfma_f32_16x16x32_bf16 a[32:35], a[192:195], v[104:107], a[32:35]
  v_exp_f32 v9, v129
  v_mfma_f32_16x16x32_bf16 a[32:35], a[196:199], v[108:111], a[32:35]
  ds_read_b128 a[224:227], v2 offset:57344
  v_cvt_pk_bf16_f32 v64, v8, v9
  v_mfma_f32_16x16x32_bf16 a[64:67], a[192:195], v[112:115], a[64:67]
  v_exp_f32 v10, v130
  v_mfma_f32_16x16x32_bf16 a[64:67], a[196:199], v[116:119], a[64:67]
  v_exp_f32 v11, v131
  v_mfma_f32_16x16x32_bf16 a[96:99], a[192:195], v[120:123], a[96:99]
  ds_read_b128 a[228:231], v2 offset:58368
  v_cvt_pk_bf16_f32 v65, v10, v11
  v_mfma_f32_16x16x32_bf16 a[96:99], a[196:199], v[124:127], a[96:99]
  ds_read_b128 a[232:235], v2 offset:59392
  v_or_b32 v7, v64, v65
  v_mfma_f32_16x16x32_bf16 a[4:7], a[200:203], v[96:99], a[4:7]
  v_exp_f32 v12, v144
  v_mfma_f32_16x16x32_bf16 a[4:7], a[204:207], v[100:103], a[4:7]
  buffer_load_dwordx4 v4, s[12:15], s39 offen offset:1024 lds
  v_mfma_f32_16x16x32_bf16 a[36:39], a[200:203], v[104:107], a[36:39]
  v_exp_f32 v13, v145
  v_mfma_f32_16x16x32_bf16 a[36:39], a[204:207], v[108:111], a[36:39]
  ds_read_b128 a[236:239], v2 offset:60416
  v_cvt_pk_bf16_f32 v72, v12, v13
  v_mfma_f32_16x16x32_bf16 a[68:71], a[200:203], v[112:115], a[68:71]
  v_exp_f32 v14, v146
  v_mfma_f32_16x16x32_bf16 a[68:71], a[204:207], v[116:119], a[68:71]
  v_exp_f32 v15, v147
  v_mfma_f32_16x16x32_bf16 a[100:103], a[200:203], v[120:123], a[100:103]
  v_exp_f32 v8, v132
  v_mfma_f32_16x16x32_bf16 a[100:103], a[204:207], v[124:127], a[100:103]
  v_exp_f32 v9, v133
  v_mfma_f32_16x16x32_bf16 v[48:51], v[16:19], v[96:99], v[48:51]
  v_exp_f32 v10, v134
  v_mfma_f32_16x16x32_bf16 v[48:51], v[16:19], v[100:103], v[48:51]
  buffer_load_dwordx4 v4, s[12:15], s39 offen offset:2048 lds
  s_waitcnt lgkmcnt(4)
  v_mfma_f32_16x16x32_bf16 a[8:11], a[208:211], v[96:99], a[8:11]
  ds_read_b128 a[240:243], v2 offset:61440
  v_cvt_pk_bf16_f32 v73, v14, v15
  v_mfma_f32_16x16x32_bf16 a[8:11], a[212:215], v[100:103], a[8:11]
  ds_read_b128 a[244:247], v2 offset:62464
  v_cvt_pk_bf16_f32 v66, v8, v9
  v_mfma_f32_16x16x32_bf16 a[40:43], a[208:211], v[104:107], a[40:43]
  ds_read_b128 a[248:251], v2 offset:63488
  v_or3_b32 v7, v7, v72, v73
  v_mfma_f32_16x16x32_bf16 a[40:43], a[212:215], v[108:111], a[40:43]
  v_exp_f32 v11, v135
  v_mfma_f32_16x16x32_bf16 a[72:75], a[208:211], v[112:115], a[72:75]
  ds_read_b128 a[252:255], v2 offset:64512
  v_cvt_pk_bf16_f32 v67, v10, v11
  v_mfma_f32_16x16x32_bf16 a[72:75], a[212:215], v[116:119], a[72:75]
  v_exp_f32 v12, v148
  v_mfma_f32_16x16x32_bf16 a[104:107], a[208:211], v[120:123], a[104:107]
  v_exp_f32 v13, v149
  v_mfma_f32_16x16x32_bf16 a[104:107], a[212:215], v[124:127], a[104:107]
  buffer_load_dwordx4 v4, s[12:15], s39 offen offset:3072 lds
  v_mfma_f32_16x16x32_bf16 a[12:15], a[216:219], v[96:99], a[12:15]
  v_exp_f32 v14, v150
  v_mfma_f32_16x16x32_bf16 a[12:15], a[220:223], v[100:103], a[12:15]
  v_exp_f32 v15, v151
  v_mfma_f32_16x16x32_bf16 a[44:47], a[216:219], v[104:107], a[44:47]
  v_cvt_pk_bf16_f32 v74, v12, v13
  v_cvt_pk_bf16_f32 v75, v14, v15
  v_mfma_f32_16x16x32_bf16 a[44:47], a[220:223], v[108:111], a[44:47]
  v_or3_b32 v7, v7, v66, v67
  v_or3_b32 v7, v7, v74, v75
  v_mfma_f32_16x16x32_bf16 a[76:79], a[216:219], v[112:115], a[76:79]
  v_mfma_f32_16x16x32_bf16 a[76:79], a[220:223], v[116:119], a[76:79]
  v_mfma_f32_16x16x32_bf16 a[108:111], a[216:219], v[120:123], a[108:111]
  s_mov_b32 m0, s54
  v_mfma_f32_16x16x32_bf16 a[108:111], a[220:223], v[124:127], a[108:111]
  buffer_load_dwordx4 v4, s[12:15], s38 offen offset:0 lds
  v_mfma_f32_16x16x32_bf16 v[52:55], v[16:19], v[104:107], v[52:55]
  v_mfma_f32_16x16x32_bf16 v[52:55], v[16:19], v[108:111], v[52:55]
  s_waitcnt lgkmcnt(4)
  v_mfma_f32_16x16x32_bf16 a[16:19], a[224:227], v[96:99], a[16:19]
  ds_read_b128 a[192:195], v3 offset:32768
  ds_read_b128 a[196:199], v3 offset:33792
  v_mfma_f32_16x16x32_bf16 a[16:19], a[228:231], v[100:103], a[16:19]
  ds_read_b128 a[200:203], v3 offset:34816
  ds_read_b128 a[204:207], v3 offset:35840
  v_mfma_f32_16x16x32_bf16 a[48:51], a[224:227], v[104:107], a[48:51]
  v_mfma_f32_16x16x32_bf16 a[48:51], a[228:231], v[108:111], a[48:51]
  v_mfma_f32_16x16x32_bf16 a[80:83], a[224:227], v[112:115], a[80:83]
  s_add_u32 s39, s39, 32768
  v_mfma_f32_16x16x32_bf16 a[80:83], a[228:231], v[116:119], a[80:83]
  buffer_load_dwordx4 v4, s[12:15], s38 offen offset:1024 lds
  v_mfma_f32_16x16x32_bf16 a[112:115], a[224:227], v[120:123], a[112:115]
  v_mfma_f32_16x16x32_bf16 a[112:115], a[228:231], v[124:127], a[112:115]
  v_mfma_f32_16x16x32_bf16 a[20:23], a[232:235], v[96:99], a[20:23]
  v_mfma_f32_16x16x32_bf16 a[20:23], a[236:239], v[100:103], a[20:23]
  v_mfma_f32_16x16x32_bf16 a[52:55], a[232:235], v[104:107], a[52:55]
  v_mfma_f32_16x16x32_bf16 a[52:55], a[236:239], v[108:111], a[52:55]
  v_mfma_f32_16x16x32_bf16 a[84:87], a[232:235], v[112:115], a[84:87]
  v_mfma_f32_16x16x32_bf16 a[84:87], a[236:239], v[116:119], a[84:87]
  buffer_load_dwordx4 v4, s[12:15], s38 offen offset:2048 lds
  v_mfma_f32_16x16x32_bf16 a[116:119], a[232:235], v[120:123], a[116:119]
  v_mfma_f32_16x16x32_bf16 a[116:119], a[236:239], v[124:127], a[116:119]
  v_mfma_f32_16x16x32_bf16 v[56:59], v[16:19], v[112:115], v[56:59]
  v_mfma_f32_16x16x32_bf16 v[56:59], v[16:19], v[116:119], v[56:59]
  s_waitcnt lgkmcnt(4)
  v_mfma_f32_16x16x32_bf16 a[24:27], a[240:243], v[96:99], a[24:27]
  ds_read_b128 a[208:211], v3 offset:36864
  ds_read_b128 a[212:215], v3 offset:37888
  v_mfma_f32_16x16x32_bf16 a[24:27], a[244:247], v[100:103], a[24:27]
  ds_read_b128 a[216:219], v3 offset:38912
  ds_read_b128 a[220:223], v3 offset:39936
  v_mfma_f32_16x16x32_bf16 a[56:59], a[240:243], v[104:107], a[56:59]
  v_mfma_f32_16x16x32_bf16 a[56:59], a[244:247], v[108:111], a[56:59]
  buffer_load_dwordx4 v4, s[12:15], s38 offen offset:3072 lds
  v_mfma_f32_16x16x32_bf16 a[88:91], a[240:243], v[112:115], a[88:91]
  v_mfma_f32_16x16x32_bf16 a[88:91], a[244:247], v[116:119], a[88:91]
  v_mfma_f32_16x16x32_bf16 a[120:123], a[240:243], v[120:123], a[120:123]
  v_mfma_f32_16x16x32_bf16 a[120:123], a[244:247], v[124:127], a[120:123]
  v_mfma_f32_16x16x32_bf16 a[28:31], a[248:251], v[96:99], a[28:31]
  v_mfma_f32_16x16x32_bf16 a[28:31], a[252:255], v[100:103], a[28:31]
  v_mfma_f32_16x16x32_bf16 a[60:63], a[248:251], v[104:107], a[60:63]
  v_mfma_f32_16x16x32_bf16 a[60:63], a[252:255], v[108:111], a[60:63]
  v_mfma_f32_16x16x32_bf16 a[92:95], a[248:251], v[112:115], a[92:95]
  v_mfma_f32_16x16x32_bf16 a[92:95], a[252:255], v[116:119], a[92:95]
  v_mfma_f32_16x16x32_bf16 a[124:127], a[248:251], v[120:123], a[124:127]
  v_mfma_f32_16x16x32_bf16 a[124:127], a[252:255], v[124:127], a[124:127]
  v_mfma_f32_16x16x32_bf16 v[60:63], v[16:19], v[120:123], v[60:63]
  v_mfma_f32_16x16x32_bf16 v[60:63], v[16:19], v[124:127], v[60:63]
  s_add_u32 s38, s38, 32768
  s_add_u32 s37, s37, 1
  v_swap_b32 v2, v3
  s_xor_b32 s53, s53, 65536
  s_xor_b32 s54, s54, 65536
  s_nop 7
  s_lshl_b32 s3, s34, 20
  s_lshl_b32 s47, s33, 15
  s_add_u32 s3, s3, s47
  s_lshl_b32 s47, s32, 11
  s_add_u32 s3, s3, s47
  v_lshlrev_b32 v23, 4, v0
  v_rcp_f32 v21, v56
  v_rcp_f32 v22, v60
  v_accvgpr_read_b32 v8, a64
  v_accvgpr_read_b32 v9, a65
  v_accvgpr_read_b32 v10, a66
  v_accvgpr_read_b32 v11, a67
  v_accvgpr_read_b32 v12, a68
  v_accvgpr_read_b32 v13, a69
  v_accvgpr_read_b32 v14, a70
  v_accvgpr_read_b32 v15, a71
  v_mul_f32 v8, v8, v21
  v_mul_f32 v9, v9, v21
  v_mul_f32 v10, v10, v21
  v_mul_f32 v11, v11, v21
  v_mul_f32 v12, v12, v21
  v_mul_f32 v13, v13, v21
  v_mul_f32 v14, v14, v21
  v_mul_f32 v15, v15, v21
  v_cvt_pk_bf16_f32 v24, v8, v9
  v_cvt_pk_bf16_f32 v25, v10, v11
  v_cvt_pk_bf16_f32 v26, v12, v13
  v_cvt_pk_bf16_f32 v27, v14, v15
  buffer_store_dwordx4 v[24:27], v23, s[20:23], s3 offen offset:0
  v_accvgpr_read_b32 v8, a96
  v_accvgpr_read_b32 v9, a97
  v_accvgpr_read_b32 v10, a98
  v_accvgpr_read_b32 v11, a99
  v_accvgpr_read_b32 v12, a100
  v_accvgpr_read_b32 v13, a101
  v_accvgpr_read_b32 v14, a102
  v_accvgpr_read_b32 v15, a103
  v_mul_f32 v8, v8, v22
  v_mul_f32 v9, v9, v22
  v_mul_f32 v10, v10, v22
  v_mul_f32 v11, v11, v22
  v_mul_f32 v12, v12, v22
  v_mul_f32 v13, v13, v22
  v_mul_f32 v14, v14, v22
  v_mul_f32 v15, v15, v22
  v_cvt_pk_bf16_f32 v28, v8, v9
  v_cvt_pk_bf16_f32 v29, v10, v11
  v_cvt_pk_bf16_f32 v30, v12, v13
  v_cvt_pk_bf16_f32 v31, v14, v15
  buffer_store_dwordx4 v[28:31], v23, s[20:23], s3 offen offset:1024
  s_add_u32 s3, s3, 8192
  v_accvgpr_read_b32 v8, a72
  v_accvgpr_read_b32 v9, a73
  v_accvgpr_read_b32 v10, a74
  v_accvgpr_read_b32 v11, a75
  v_accvgpr_read_b32 v12, a76
  v_accvgpr_read_b32 v13, a77
  v_accvgpr_read_b32 v14, a78
  v_accvgpr_read_b32 v15, a79
  v_mul_f32 v8, v8, v21
  v_mul_f32 v9, v9, v21
  v_mul_f32 v10, v10, v21
  v_mul_f32 v11, v11, v21
  v_mul_f32 v12, v12, v21
  v_mul_f32 v13, v13, v21
  v_mul_f32 v14, v14, v21
  v_mul_f32 v15, v15, v21
  v_cvt_pk_bf16_f32 v24, v8, v9
  v_cvt_pk_bf16_f32 v25, v10, v11
  v_cvt_pk_bf16_f32 v26, v12, v13
  v_cvt_pk_bf16_f32 v27, v14, v15
  buffer_store_dwordx4 v[24:27], v23, s[20:23], s3 offen offset:0
  v_accvgpr_read_b32 v8, a104
  v_accvgpr_read_b32 v9, a105
  v_accvgpr_read_b32 v10, a106
  v_accvgpr_read_b32 v11, a107
  v_accvgpr_read_b32 v12, a108
  v_accvgpr_read_b32 v13, a109
  v_accvgpr_read_b32 v14, a110
  v_accvgpr_read_b32 v15, a111
  v_mul_f32 v8, v8, v22
  v_mul_f32 v9, v9, v22
  v_mul_f32 v10, v10, v22
  v_mul_f32 v11, v11, v22
  v_mul_f32 v12, v12, v22
  v_mul_f32 v13, v13, v22
  v_mul_f32 v14, v14, v22
  v_mul_f32 v15, v15, v22
  v_cvt_pk_bf16_f32 v28, v8, v9
  v_cvt_pk_bf16_f32 v29, v10, v11
  v_cvt_pk_bf16_f32 v30, v12, v13
  v_cvt_pk_bf16_f32 v31, v14, v15
  buffer_store_dwordx4 v[28:31], v23, s[20:23], s3 offen offset:1024
  s_add_u32 s3, s3, 8192
  v_accvgpr_read_b32 v8, a80
  v_accvgpr_read_b32 v9, a81
  v_accvgpr_read_b32 v10, a82
  v_accvgpr_read_b32 v11, a83
  v_accvgpr_read_b32 v12, a84
  v_accvgpr_read_b32 v13, a85
  v_accvgpr_read_b32 v14, a86
  v_accvgpr_read_b32 v15, a87
  v_mul_f32 v8, v8, v21
  v_mul_f32 v9, v9, v21
  v_mul_f32 v10, v10, v21
  v_mul_f32 v11, v11, v21
  v_mul_f32 v12, v12, v21
  v_mul_f32 v13, v13, v21
  v_mul_f32 v14, v14, v21
  v_mul_f32 v15, v15, v21
  v_cvt_pk_bf16_f32 v24, v8, v9
  v_cvt_pk_bf16_f32 v25, v10, v11
  v_cvt_pk_bf16_f32 v26, v12, v13
  v_cvt_pk_bf16_f32 v27, v14, v15
  buffer_store_dwordx4 v[24:27], v23, s[20:23], s3 offen offset:0
  v_accvgpr_read_b32 v8, a112
  v_accvgpr_read_b32 v9, a113
  v_accvgpr_read_b32 v10, a114
  v_accvgpr_read_b32 v11, a115
  v_accvgpr_read_b32 v12, a116
  v_accvgpr_read_b32 v13, a117
  v_accvgpr_read_b32 v14, a118
  v_accvgpr_read_b32 v15, a119
  v_mul_f32 v8, v8, v22
  v_mul_f32 v9, v9, v22
  v_mul_f32 v10, v10, v22
  v_mul_f32 v11, v11, v22
  v_mul_f32 v12, v12, v22
  v_mul_f32 v13, v13, v22
  v_mul_f32 v14, v14, v22
  v_mul_f32 v15, v15, v22
  v_cvt_pk_bf16_f32 v28, v8, v9
  v_cvt_pk_bf16_f32 v29, v10, v11
  v_cvt_pk_bf16_f32 v30, v12, v13
  v_cvt_pk_bf16_f32 v31, v14, v15
  buffer_store_dwordx4 v[28:31], v23, s[20:23], s3 offen offset:1024
  s_add_u32 s3, s3, 8192
  v_accvgpr_read_b32 v8, a88
  v_accvgpr_read_b32 v9, a89
  v_accvgpr_read_b32 v10, a90
  v_accvgpr_read_b32 v11, a91
  v_accvgpr_read_b32 v12, a92
  v_accvgpr_read_b32 v13, a93
  v_accvgpr_read_b32 v14, a94
  v_accvgpr_read_b32 v15, a95
  v_mul_f32 v8, v8, v21
  v_mul_f32 v9, v9, v21
  v_mul_f32 v10, v10, v21
  v_mul_f32 v11, v11, v21
  v_mul_f32 v12, v12, v21
  v_mul_f32 v13, v13, v21
  v_mul_f32 v14, v14, v21
  v_mul_f32 v15, v15, v21
  v_cvt_pk_bf16_f32 v24, v8, v9
  v_cvt_pk_bf16_f32 v25, v10, v11
  v_cvt_pk_bf16_f32 v26, v12, v13
  v_cvt_pk_bf16_f32 v27, v14, v15
  buffer_store_dwordx4 v[24:27], v23, s[20:23], s3 offen offset:0
  v_accvgpr_read_b32 v8, a120
  v_accvgpr_read_b32 v9, a121
  v_accvgpr_read_b32 v10, a122
  v_accvgpr_read_b32 v11, a123
  v_accvgpr_read_b32 v12, a124
  v_accvgpr_read_b32 v13, a125
  v_accvgpr_read_b32 v14, a126
  v_accvgpr_read_b32 v15, a127
  v_mul_f32 v8, v8, v22
  v_mul_f32 v9, v9, v22
  v_mul_f32 v10, v10, v22
  v_mul_f32 v11, v11, v22
  v_mul_f32 v12, v12, v22
  v_mul_f32 v13, v13, v22
  v_mul_f32 v14, v14, v22
  v_mul_f32 v15, v15, v22
  v_cvt_pk_bf16_f32 v28, v8, v9
  v_cvt_pk_bf16_f32 v29, v10, v11
  v_cvt_pk_bf16_f32 v30, v12, v13
  v_cvt_pk_bf16_f32 v31, v14, v15
  buffer_store_dwordx4 v[28:31], v23, s[20:23], s3 offen offset:1024
L_k2_nloop:
  s_waitcnt lgkmcnt(4)
  v_mfma_f32_16x16x32_bf16 v[192:195], a[192:195], a[128:131], v[32:35]
  v_exp_f32 v8, v136
  v_mfma_f32_16x16x32_bf16 v[192:195], a[196:199], a[132:135], v[192:195]
  v_exp_f32 v9, v137
  v_mfma_f32_16x16x32_bf16 v[192:195], a[200:203], a[136:139], v[192:195]
  ds_read_b128 a[224:227], v2 offset:40960
  v_cvt_pk_bf16_f32 v68, v8, v9
  v_mfma_f32_16x16x32_bf16 v[192:195], a[204:207], a[140:143], v[192:195]
  v_exp_f32 v10, v138
  v_mfma_f32_16x16x32_bf16 v[208:211], a[192:195], a[144:147], v[36:39]
  ds_read_b128 a[228:231], v2 offset:41984
  ds_read_b128 a[232:235], v2 offset:43008
  v_mfma_f32_16x16x32_bf16 v[208:211], a[196:199], a[148:151], v[208:211]
  v_exp_f32 v11, v139
  v_mfma_f32_16x16x32_bf16 v[208:211], a[200:203], a[152:155], v[208:211]
  ds_read_b128 a[236:239], v2 offset:44032
  v_cvt_pk_bf16_f32 v69, v10, v11
  v_mfma_f32_16x16x32_bf16 v[208:211], a[204:207], a[156:159], v[208:211]
  s_waitcnt lgkmcnt(4)
  v_exp_f32 v12, v152
  v_mfma_f32_16x16x32_bf16 v[196:199], a[208:211], a[128:131], v[32:35]
  ds_read_b128 a[240:243], v2 offset:45056
  v_or3_b32 v7, v7, v68, v69
  v_mfma_f32_16x16x32_bf16 v[196:199], a[212:215], a[132:135], v[196:199]
  v_exp_f32 v13, v153
  v_mfma_f32_16x16x32_bf16 v[196:199], a[216:219], a[136:139], v[196:199]
  ds_read_b128 a[244:247], v2 offset:46080
  v_cvt_pk_bf16_f32 v76, v12, v13
  v_mfma_f32_16x16x32_bf16 v[196:199], a[220:223], a[140:143], v[196:199]
  v_exp_f32 v14, v154
  v_mfma_f32_16x16x32_bf16 v[212:215], a[208:211], a[144:147], v[36:39]
  v_exp_f32 v15, v155
  v_mfma_f32_16x16x32_bf16 v[212:215], a[212:215], a[148:151], v[212:215]
  ds_read_b128 a[248:251], v2 offset:47104
  v_cvt_pk_bf16_f32 v77, v14, v15
  v_mfma_f32_16x16x32_bf16 v[212:215], a[216:219], a[152:155], v[212:215]
  ds_read_b128 a[252:255], v2 offset:48128
  v_or3_b32 v7, v7, v76, v77
  v_mfma_f32_16x16x32_bf16 v[212:215], a[220:223], a[156:159], v[212:215]
  s_waitcnt lgkmcnt(4)
  v_exp_f32 v8, v140
  v_mfma_f32_16x16x32_bf16 v[200:203], a[224:227], a[128:131], v[32:35]
  v_exp_f32 v9, v141
  v_mfma_f32_16x16x32_bf16 v[200:203], a[228:231], a[132:135], v[200:203]
  ds_read_b128 a[192:195], v2 offset:16384
  v_cvt_pk_bf16_f32 v70, v8, v9
  v_mfma_f32_16x16x32_bf16 v[200:203], a[232:235], a[136:139], v[200:203]
  v_exp_f32 v10, v142
  v_mfma_f32_16x16x32_bf16 v[200:203], a[236:239], a[140:143], v[200:203]
  v_exp_f32 v11, v143
  v_mfma_f32_16x16x32_bf16 v[216:219], a[224:227], a[144:147], v[36:39]
  ds_read_b128 a[196:199], v2 offset:17408
  v_cvt_pk_bf16_f32 v71, v10, v11
  v_mfma_f32_16x16x32_bf16 v[216:219], a[228:231], a[148:151], v[216:219]
  ds_read_b128 a[200:203], v2 offset:18432
  v_or3_b32 v7, v7, v70, v71
  v_mfma_f32_16x16x32_bf16 v[216:219], a[232:235], a[152:155], v[216:219]
  ds_read_b128 a[204:207], v2 offset:19456
  v_mfma_f32_16x16x32_bf16 v[216:219], a[236:239], a[156:159], v[216:219]
  s_waitcnt lgkmcnt(4)
  v_exp_f32 v12, v156
  v_mfma_f32_16x16x32_bf16 v[204:207], a[240:243], a[128:131], v[32:35]
  v_exp_f32 v13, v157
  v_mfma_f32_16x16x32_bf16 v[204:207], a[244:247], a[132:135], v[204:207]
  ds_read_b128 a[208:211], v2 offset:20480
  v_cvt_pk_bf16_f32 v78, v12, v13
  v_mfma_f32_16x16x32_bf16 v[204:207], a[248:251], a[136:139], v[204:207]
  v_exp_f32 v14, v158
  v_mfma_f32_16x16x32_bf16 v[204:207], a[252:255], a[140:143], v[204:207]
  v_exp_f32 v15, v159
  v_mfma_f32_16x16x32_bf16 v[220:223], a[240:243], a[144:147], v[36:39]
  ds_read_b128 a[212:215], v2 offset:21504
  v_cvt_pk_bf16_f32 v79, v14, v15
  v_mfma_f32_16x16x32_bf16 v[220:223], a[244:247], a[148:151], v[220:223]
  ds_read_b128 a[216:219], v2 offset:22528
  v_or3_b32 v7, v7, v78, v79
  v_mfma_f32_16x16x32_bf16 v[220:223], a[248:251], a[152:155], v[220:223]
  ds_read_b128 a[220:223], v2 offset:23552
  v_and_b32 v1, 0x40004000, v7
  v_mfma_f32_16x16x32_bf16 v[220:223], a[252:255], a[156:159], v[220:223]
  v_cmp_ne_u32 vcc, 0, v1
  s_cbranch_vccnz L_k2_fb_ne
L_k2_fbr_ne:
  s_cmp_ge_u32 s37, s45
  s_cbranch_scc1 L_k2_mk_ne
L_k2_mkr_ne:
  s_waitcnt vmcnt(12)
  s_barrier
  s_waitcnt lgkmcnt(4)
  v_mfma_f32_16x16x32_bf16 a[0:3], a[192:195], v[64:67], a[0:3]
  s_add_u32 m0, s54, 49152
  v_exp_f32 v8, v192
  v_mfma_f32_16x16x32_bf16 a[0:3], a[196:199], v[68:71], a[0:3]
  buffer_load_dwordx4 v4, s[12:15], s39 offen offset:0 lds
  v_mfma_f32_16x16x32_bf16 a[32:35], a[192:195], v[72:75], a[32:35]
  v_exp_f32 v9, v193
  v_mfma_f32_16x16x32_bf16 a[32:35], a[196:199], v[76:79], a[32:35]
  ds_read_b128 a[224:227], v2 offset:24576
  v_cvt_pk_bf16_f32 v96, v8, v9
  v_mfma_f32_16x16x32_bf16 a[4:7], a[200:203], v[64:67], a[4:7]
  ds_read_b128 a[228:231], v2 offset:25600
  ds_read_b128 a[232:235], v2 offset:26624
  v_mfma_f32_16x16x32_bf16 a[4:7], a[204:207], v[68:71], a[4:7]
  buffer_load_dwordx4 v4, s[12:15], s39 offen offset:1024 lds
  v_mfma_f32_16x16x32_bf16 a[36:39], a[200:203], v[72:75], a[36:39]
  v_exp_f32 v10, v194
  v_mfma_f32_16x16x32_bf16 a[36:39], a[204:207], v[76:79], a[36:39]
  ds_read_b128 a[236:239], v2 offset:27648
  v_mfma_f32_16x16x32_bf16 v[48:51], v[16:19], v[64:67], v[48:51]
  v_exp_f32 v11, v195
  v_mfma_f32_16x16x32_bf16 v[48:51], v[16:19], v[68:71], v[48:51]
  buffer_load_dwordx4 v4, s[12:15], s39 offen offset:2048 lds
  s_waitcnt lgkmcnt(4)
  v_mfma_f32_16x16x32_bf16 a[8:11], a[208:211], v[64:67], a[8:11]
  ds_read_b128 a[240:243], v2 offset:28672
  v_cvt_pk_bf16_f32 v97, v10, v11
  v_mfma_f32_16x16x32_bf16 a[8:11], a[212:215], v[68:71], a[8:11]
  ds_read_b128 a[244:247], v2 offset:29696
  v_or_b32 v7, v96, v97
  v_mfma_f32_16x16x32_bf16 a[40:43], a[208:211], v[72:75], a[40:43]
  v_exp_f32 v12, v208
  v_mfma_f32_16x16x32_bf16 a[40:43], a[212:215], v[76:79], a[40:43]
  buffer_load_dwordx4 v4, s[12:15], s39 offen offset:3072 lds
  v_mfma_f32_16x16x32_bf16 a[12:15], a[216:219], v[64:67], a[12:15]
  v_exp_f32 v13, v209
  v_mfma_f32_16x16x32_bf16 a[12:15], a[220:223], v[68:71], a[12:15]
  ds_read_b128 a[248:251], v2 offset:30720
  v_cvt_pk_bf16_f32 v104, v12, v13
  v_mfma_f32_16x16x32_bf16 a[44:47], a[216:219], v[72:75], a[44:47]
  s_add_u32 m0, s53, 32768
  v_exp_f32 v14, v210
  v_mfma_f32_16x16x32_bf16 a[44:47], a[220:223], v[76:79], a[44:47]
  buffer_load_dwordx4 v4, s[12:15], s38 offen offset:0 lds
  v_mfma_f32_16x16x32_bf16 v[52:55], v[16:19], v[72:75], v[52:55]
  ds_read_b128 a[252:255], v2 offset:31744
  v_mfma_f32_16x16x32_bf16 v[52:55], v[16:19], v[76:79], v[52:55]
  s_waitcnt lgkmcnt(4)
  v_exp_f32 v15, v211
  v_mfma_f32_16x16x32_bf16 a[16:19], a[224:227], v[64:67], a[16:19]
  s_add_u32 s39, s39, 32768
  ds_read_b128 a[192:195], v3 offset:0
  v_cvt_pk_bf16_f32 v105, v14, v15
  v_mfma_f32_16x16x32_bf16 a[16:19], a[228:231], v[68:71], a[16:19]
  buffer_load_dwordx4 v4, s[12:15], s38 offen offset:1024 lds
  v_mfma_f32_16x16x32_bf16 a[48:51], a[224:227], v[72:75], a[48:51]
  ds_read_b128 a[196:199], v3 offset:1024
  v_or3_b32 v7, v7, v104, v105
  v_mfma_f32_16x16x32_bf16 a[48:51], a[228:231], v[76:79], a[48:51]
  v_exp_f32 v8, v196
  v_mfma_f32_16x16x32_bf16 a[20:23], a[232:235], v[64:67], a[20:23]
  ds_read_b128 a[200:203], v3 offset:2048
  ds_read_b128 a[204:207], v3 offset:3072
  v_mfma_f32_16x16x32_bf16 a[20:23], a[236:239], v[68:71], a[20:23]
  buffer_load_dwordx4 v4, s[12:15], s38 offen offset:2048 lds
  v_mfma_f32_16x16x32_bf16 a[52:55], a[232:235], v[72:75], a[52:55]
  v_exp_f32 v9, v197
  v_mfma_f32_16x16x32_bf16 a[52:55], a[236:239], v[76:79], a[52:55]
  s_waitcnt lgkmcnt(4)
  v_exp_f32 v10, v198
  v_mfma_f32_16x16x32_bf16 a[24:27], a[240:243], v[64:67], a[24:27]
  ds_read_b128 a[208:211], v3 offset:4096
  v_cvt_pk_bf16_f32 v98, v8, v9
  v_mfma_f32_16x16x32_bf16 a[24:27], a[244:247], v[68:71], a[24:27]
  buffer_load_dwordx4 v4, s[12:15], s38 offen offset:3072 lds
  v_mfma_f32_16x16x32_bf16 a[56:59], a[240:243], v[72:75], a[56:59]
  v_exp_f32 v11, v199
  v_mfma_f32_16x16x32_bf16 a[56:59], a[244:247], v[76:79], a[56:59]
  ds_read_b128 a[212:215], v3 offset:5120
  v_cvt_pk_bf16_f32 v99, v10, v11
  v_mfma_f32_16x16x32_bf16 a[28:31], a[248:251], v[64:67], a[28:31]
  ds_read_b128 a[216:219], v3 offset:6144
  v_or3_b32 v7, v7, v98, v99
  v_mfma_f32_16x16x32_bf16 a[28:31], a[252:255], v[68:71], a[28:31]
  v_exp_f32 v12, v212
  v_mfma_f32_16x16x32_bf16 a[60:63], a[248:251], v[72:75], a[60:63]
  ds_read_b128 a[220:223], v3 offset:7168
  v_mfma_f32_16x16x32_bf16 a[60:63], a[252:255], v[76:79], a[60:63]
  v_exp_f32 v13, v213
  v_exp_f32 v14, v214
  v_exp_f32 v15, v215
  v_cvt_pk_bf16_f32 v106, v12, v13
  v_cvt_pk_bf16_f32 v107, v14, v15
  v_or3_b32 v7, v7, v106, v107
  s_add_u32 s38, s38, 32768
  s_add_u32 s37, s37, 1
  s_cmp_eq_u32 s37, s36
  s_cbranch_scc1 L_k2_fin
  s_waitcnt lgkmcnt(4)
  v_mfma_f32_16x16x32_bf16 v[128:131], a[192:195], a[128:131], v[32:35]
  v_exp_f32 v8, v200
  v_mfma_f32_16x16x32_bf16 v[128:131], a[196:199], a[132:135], v[128:131]
  v_exp_f32 v9, v201
  v_mfma_f32_16x16x32_bf16 v[128:131], a[200:203], a[136:139], v[128:131]
  ds_read_b128 a[224:227], v3 offset:8192
  v_cvt_pk_bf16_f32 v100, v8, v9
  v_mfma_f32_16x16x32_bf16 v[128:131], a[204:207], a[140:143], v[128:131]
  v_exp_f32 v10, v202
  v_mfma_f32_16x16x32_bf16 v[144:147], a[192:195], a[144:147], v[36:39]
  ds_read_b128 a[228:231], v3 offset:9216
  ds_read_b128 a[232:235], v3 offset:10240
  v_mfma_f32_16x16x32_bf16 v[144:147], a[196:199], a[148:151], v[144:147]
  v_exp_f32 v11, v203
  v_mfma_f32_16x16x32_bf16 v[144:147], a[200:203], a[152:155], v[144:147]
  ds_read_b128 a[236:239], v3 offset:11264
  v_cvt_pk_bf16_f32 v101, v10, v11
  v_mfma_f32_16x16x32_bf16 v[144:147], a[204:207], a[156:159], v[144:147]
  s_waitcnt lgkmcnt(4)
  v_exp_f32 v12, v216
  v_mfma_f32_16x16x32_bf16 v[132:135], a[208:211], a[128:131], v[32:35]
  ds_read_b128 a[240:243], v3 offset:12288
  v_or3_b32 v7, v7, v100, v101
  v_mfma_f32_16x16x32_bf16 v[132:135], a[212:215], a[132:135], v[132:135]
  v_exp_f32 v13, v217
  v_mfma_f32_16x16x32_bf16 v[132:135], a[216:219], a[136:139], v[132:135]
  ds_read_b128 a[244:247], v3 offset:13312
  v_cvt_pk_bf16_f32 v108, v12, v13
  v_mfma_f32_16x16x32_bf16 v[132:135], a[220:223], a[140:143], v[132:135]
  v_exp_f32 v14, v218
  v_mfma_f32_16x16x32_bf16 v[148:151], a[208:211], a[144:147], v[36:39]
  v_exp_f32 v15, v219
  v_mfma_f32_16x16x32_bf16 v[148:151], a[212:215], a[148:151], v[148:151]
  ds_read_b128 a[248:251], v3 offset:14336
  v_cvt_pk_bf16_f32 v109, v14, v15
  v_mfma_f32_16x16x32_bf16 v[148:151], a[216:219], a[152:155], v[148:151]
  ds_read_b128 a[252:255], v3 offset:15360
  v_or3_b32 v7, v7, v108, v109
  v_mfma_f32_16x16x32_bf16 v[148:151], a[220:223], a[156:159], v[148:151]
  s_waitcnt lgkmcnt(4)
  v_exp_f32 v8, v204
  v_mfma_f32_16x16x32_bf16 v[136:139], a[224:227], a[128:131], v[32:35]
  v_exp_f32 v9, v205
  v_mfma_f32_16x16x32_bf16 v[136:139], a[228:231], a[132:135], v[136:139]
  ds_read_b128 a[192:195], v2 offset:49152
  v_cvt_pk_bf16_f32 v102, v8, v9
  v_mfma_f32_16x16x32_bf16 v[136:139], a[232:235], a[136:139], v[136:139]
  v_exp_f32 v10, v206
  v_mfma_f32_16x16x32_bf16 v[136:139], a[236:239], a[140:143], v[136:139]
  v_exp_f32 v11, v207
  v_mfma_f32_16x16x32_bf16 v[152:155], a[224:227], a[144:147], v[36:39]
  ds_read_b128 a[196:199], v2 offset:50176
  v_cvt_pk_bf16_f32 v103, v10, v11
  v_mfma_f32_16x16x32_bf16 v[152:155], a[228:231], a[148:151], v[152:155]
  ds_read_b128 a[200:203], v2 offset:51200
  v_or3_b32 v7, v7, v102, v103
  v_mfma_f32_16x16x32_bf16 v[152:155], a[232:235], a[152:155], v[152:155]
  ds_read_b128 a[204:207], v2 offset:52224
  v_mfma_f32_16x16x32_bf16 v[152:155], a[236:239], a[156:159], v[152:155]
  s_waitcnt lgkmcnt(4)
  v_exp_f32 v12, v220
  v_mfma_f32_16x16x32_bf16 v[140:143], a[240:243], a[128:131], v[32:35]
  v_exp_f32 v13, v221
  v_mfma_f32_16x16x32_bf16 v[140:143], a[244:247], a[132:135], v[140:143]
  ds_read_b128 a[208:211], v2 offset:53248
  v_cvt_pk_bf16_f32 v110, v12, v13
  v_mfma_f32_16x16x32_bf16 v[140:143], a[248:251], a[136:139], v[140:143]
  v_exp_f32 v14, v222
  v_mfma_f32_16x16x32_bf16 v[140:143], a[252:255], a[140:143], v[140:143]
  v_exp_f32 v15, v223
  v_mfma_f32_16x16x32_bf16 v[156:159], a[240:243], a[144:147], v[36:39]
  ds_read_b128 a[212:215], v2 offset:54272
  v_cvt_pk_bf16_f32 v111, v14, v15
  v_mfma_f32_16x16x32_bf16 v[156:159], a[244:247], a[148:151], v[156:159]
  ds_read_b128 a[216:219], v2 offset:55296
  v_or3_b32 v7, v7, v110, v111
  v_mfma_f32_16x16x32_bf16 v[156:159], a[248:251], a[152:155], v[156:159]
  ds_read_b128 a[220:223], v2 offset:56320
  v_and_b32 v1, 0x40004000, v7
  v_mfma_f32_16x16x32_bf16 v[156:159], a[252:255], a[156:159], v[156:159]
  v_cmp_ne_u32 vcc, 0, v1
  s_cbranch_vccnz L_k2_fb_no
L_k2_fbr_no:
  s_cmp_ge_u32 s37, s45
  s_cbranch_scc1 L_k2_mk_no
L_k2_mkr_no:
  s_waitcnt vmcnt(12)
  s_barrier
  s_waitcnt lgkmcnt(4)
  v_mfma_f32_16x16x32_bf16 a[0:3], a[192:195], v[96:99], a[0:3]
  s_add_u32 m0, s53, 16384
  v_exp_f32 v8, v128
  v_mfma_f32_16x16x32_bf16 a[0:3], a[196:199], v[100:103], a[0:3]
  buffer_load_dwordx4 v4, s[12:15], s39 offen offset:0 lds
  v_mfma_f32_16x16x32_bf16 a[32:35], a[192:195], v[104:107], a[32:35]
  v_exp_f32 v9, v129
  v_mfma_f32_16x16x32_bf16 a[32:35], a[196:199], v[108:111], a[32:35]
  ds_read_b128 a[224:227], v2 offset:57344
  v_cvt_pk_bf16_f32 v64, v8, v9
  v_mfma_f32_16x16x32_bf16 a[4:7], a[200:203], v[96:99], a[4:7]
  ds_read_b128 a[228:231], v2 offset:58368
  ds_read_b128 a[232:235], v2 offset:59392
  v_mfma_f32_16x16x32_bf16 a[4:7], a[204:207], v[100:103], a[4:7]
  buffer_load_dwordx4 v4, s[12:15], s39 offen offset:1024 lds
  v_mfma_f32_16x16x32_bf16 a[36:39], a[200:203], v[104:107], a[36:39]
  v_exp_f32 v10, v130
  v_mfma_f32_16x16x32_bf16 a[36:39], a[204:207], v[108:111], a[36:39]
  ds_read_b128 a[236:239], v2 offset:60416
  v_mfma_f32_16x16x32_bf16 v[48:51], v[16:19], v[96:99], v[48:51]
  v_exp_f32 v11, v131
  v_mfma_f32_16x16x32_bf16 v[48:51], v[16:19], v[100:103], v[48:51]
  buffer_load_dwordx4 v4, s[12:15], s39 offen offset:2048 lds
  s_waitcnt lgkmcnt(4)
  v_mfma_f32_16x16x32_bf16 a[8:11], a[208:211], v[96:99], a[8:11]
  ds_read_b128 a[240:243], v2 offset:61440
  v_cvt_pk_bf16_f32 v65, v10, v11
  v_mfma_f32_16x16x32_bf16 a[8:11], a[212:215], v[100:103], a[8:11]
  ds_read_b128 a[244:247], v2 offset:62464
  v_or_b32 v7, v64, v65
  v_mfma_f32_16x16x32_bf16 a[40:43], a[208:211], v[104:107], a[40:43]
  v_exp_f32 v12, v144
  v_mfma_f32_16x16x32_bf16 a[40:43], a[212:215], v[108:111], a[40:43]
  buffer_load_dwordx4 v4, s[12:15], s39 offen offset:3072 lds
  v_mfma_f32_16x16x32_bf16 a[12:15], a[216:219], v[96:99], a[12:15]
  v_exp_f32 v13, v145
  v_mfma_f32_16x16x32_bf16 a[12:15], a[220:223], v[100:103], a[12:15]
  ds_read_b128 a[248:251], v2 offset:63488
  v_cvt_pk_bf16_f32 v72, v12, v13
  v_mfma_f32_16x16x32_bf16 a[44:47], a[216:219], v[104:107], a[44:47]
  s_mov_b32 m0, s54
  v_exp_f32 v14, v146
  v_mfma_f32_16x16x32_bf16 a[44:47], a[220:223], v[108:111], a[44:47]
  buffer_load_dwordx4 v4, s[12:15], s38 offen offset:0 lds
  v_mfma_f32_16x16x32_bf16 v[52:55], v[16:19], v[104:107], v[52:55]
  ds_read_b128 a[252:255], v2 offset:64512
  v_mfma_f32_16x16x32_bf16 v[52:55], v[16:19], v[108:111], v[52:55]
  s_waitcnt lgkmcnt(4)
  v_exp_f32 v15, v147
  v_mfma_f32_16x16x32_bf16 a[16:19], a[224:227], v[96:99], a[16:19]
  s_add_u32 s39, s39, 32768
  ds_read_b128 a[192:195], v3 offset:32768
  v_cvt_pk_bf16_f32 v73, v14, v15
  v_mfma_f32_16x16x32_bf16 a[16:19], a[228:231], v[100:103], a[16:19]
  buffer_load_dwordx4 v4, s[12:15], s38 offen offset:1024 lds
  v_mfma_f32_16x16x32_bf16 a[48:51], a[224:227], v[104:107], a[48:51]
  ds_read_b128 a[196:199], v3 offset:33792
  v_or3_b32 v7, v7, v72, v73
  v_mfma_f32_16x16x32_bf16 a[48:51], a[228:231], v[108:111], a[48:51]
  v_exp_f32 v8, v132
  v_mfma_f32_16x16x32_bf16 a[20:23], a[232:235], v[96:99], a[20:23]
  ds_read_b128 a[200:203], v3 offset:34816
  ds_read_b128 a[204:207], v3 offset:35840
  v_mfma_f32_16x16x32_bf16 a[20:23], a[236:239], v[100:103], a[20:23]
  buffer_load_dwordx4 v4, s[12:15], s38 offen offset:2048 lds
  v_mfma_f32_16x16x32_bf16 a[52:55], a[232:235], v[104:107], a[52:55]
  v_exp_f32 v9, v133
  v_mfma_f32_16x16x32_bf16 a[52:55], a[236:239], v[108:111], a[52:55]
  s_waitcnt lgkmcnt(4)
  v_exp_f32 v10, v134
  v_mfma_f32_16x16x32_bf16 a[24:27], a[240:243], v[96:99], a[24:27]
  ds_read_b128 a[208:211], v3 offset:36864
  v_cvt_pk_bf16_f32 v66, v8, v9
  v_mfma_f32_16x16x32_bf16 a[24:27], a[244:247], v[100:103], a[24:27]
  buffer_load_dwordx4 v4, s[12:15], s38 offen offset:3072 lds
  v_mfma_f32_16x16x32_bf16 a[56:59], a[240:243], v[104:107], a[56:59]
  v_exp_f32 v11, v135
  v_mfma_f32_16x16x32_bf16 a[56:59], a[244:247], v[108:111], a[56:59]
  ds_read_b128 a[212:215], v3 offset:37888
  v_cvt_pk_bf16_f32 v67, v10, v11
  v_mfma_f32_16x16x32_bf16 a[28:31], a[248:251], v[96:99], a[28:31]
  ds_read_b128 a[216:219], v3 offset:38912
  v_or3_b32 v7, v7, v66, v67
  v_mfma_f32_16x16x32_bf16 a[28:31], a[252:255], v[100:103], a[28:31]
  v_exp_f32 v12, v148
  v_mfma_f32_16x16x32_bf16 a[60:63], a[248:251], v[104:107], a[60:63]
  ds_read_b128 a[220:223], v3 offset:39936
  v_mfma_f32_16x16x32_bf16 a[60:63], a[252:255], v[108:111], a[60:63]
  v_exp_f32 v13, v149
  v_exp_f32 v14, v150
  v_exp_f32 v15, v151
  v_cvt_pk_bf16_f32 v74, v12, v13
  v_cvt_pk_bf16_f32 v75, v14, v15
  v_or3_b32 v7, v7, v74, v75
  s_add_u32 s38, s38, 32768
  s_add_u32 s37, s37, 1
  v_swap_b32 v2, v3
  s_xor_b32 s53, s53, 65536
  s_xor_b32 s54, s54, 65536
  s_branch L_k2_nloop
L_k2_fin:
  s_waitcnt lgkmcnt(0)
  ds_read_b128 a[192:195], v2 offset:49152
  ds_read_b128 a[196:199], v2 offset:50176
  ds_read_b128 a[200:203], v2 offset:51200
  ds_read_b128 a[204:207], v2 offset:52224
  ds_read_b128 a[208:211], v2 offset:53248
  ds_read_b128 a[212:215], v2 offset:54272
  ds_read_b128 a[216:219], v2 offset:55296
  ds_read_b128 a[220:223], v2 offset:56320
  v_exp_f32 v8, v200
  v_exp_f32 v9, v201
  v_exp_f32 v10, v202
  v_exp_f32 v11, v203
  v_cvt_pk_bf16_f32 v100, v8, v9
  v_exp_f32 v12, v216
  v_exp_f32 v13, v217
  v_cvt_pk_bf16_f32 v101, v10, v11
  v_exp_f32 v14, v218
  v_exp_f32 v15, v219
  v_cvt_pk_bf16_f32 v108, v12, v13
  v_exp_f32 v8, v204
  v_exp_f32 v9, v205
  v_cvt_pk_bf16_f32 v109, v14, v15
  v_exp_f32 v10, v206
  v_exp_f32 v11, v207
  v_cvt_pk_bf16_f32 v102, v8, v9
  v_exp_f32 v12, v220
  v_exp_f32 v13, v221
  v_cvt_pk_bf16_f32 v103, v10, v11
  v_exp_f32 v14, v222
  v_exp_f32 v15, v223
  v_cvt_pk_bf16_f32 v110, v12, v13
  v_cvt_pk_bf16_f32 v111, v14, v15
  v_or3_b32 v7, v7, v100, v101
  v_or3_b32 v7, v7, v108, v109
  v_or3_b32 v7, v7, v102, v103
  v_or3_b32 v7, v7, v110, v111
  v_and_b32 v1, 0x40004000, v7
  v_cmp_ne_u32 vcc, 0, v1
  s_cbranch_vccnz L_k2_fb_fi
L_k2_fbr_fi:
  s_waitcnt lgkmcnt(4)
  v_mfma_f32_16x16x32_bf16 a[0:3], a[192:195], v[96:99], a[0:3]
  ds_read_b128 a[224:227], v2 offset:57344
  ds_read_b128 a[228:231], v2 offset:58368
  v_mfma_f32_16x16x32_bf16 a[0:3], a[196:199], v[100:103], a[0:3]
  ds_read_b128 a[232:235], v2 offset:59392
  ds_read_b128 a[236:239], v2 offset:60416
  v_mfma_f32_16x16x32_bf16 a[32:35], a[192:195], v[104:107], a[32:35]
  v_mfma_f32_16x16x32_bf16 a[32:35], a[196:199], v[108:111], a[32:35]
  v_mfma_f32_16x16x32_bf16 a[4:7], a[200:203], v[96:99], a[4:7]
  v_mfma_f32_16x16x32_bf16 a[4:7], a[204:207], v[100:103], a[4:7]
  v_mfma_f32_16x16x32_bf16 a[36:39], a[200:203], v[104:107], a[36:39]
  v_mfma_f32_16x16x32_bf16 a[36:39], a[204:207], v[108:111], a[36:39]
  v_mfma_f32_16x16x32_bf16 v[48:51], v[16:19], v[96:99], v[48:51]
  v_mfma_f32_16x16x32_bf16 v[48:51], v[16:19], v[100:103], v[48:51]
  s_waitcnt lgkmcnt(4)
  v_mfma_f32_16x16x32_bf16 a[8:11], a[208:211], v[96:99], a[8:11]
  ds_read_b128 a[240:243], v2 offset:61440
  ds_read_b128 a[244:247], v2 offset:62464
  v_mfma_f32_16x16x32_bf16 a[8:11], a[212:215], v[100:103], a[8:11]
  ds_read_b128 a[248:251], v2 offset:63488
  ds_read_b128 a[252:255], v2 offset:64512
  v_mfma_f32_16x16x32_bf16 a[40:43], a[208:211], v[104:107], a[40:43]
  v_mfma_f32_16x16x32_bf16 a[40:43], a[212:215], v[108:111], a[40:43]
  v_mfma_f32_16x16x32_bf16 a[12:15], a[216:219], v[96:99], a[12:15]
  v_mfma_f32_16x16x32_bf16 a[12:15], a[220:223], v[100:103], a[12:15]
  v_mfma_f32_16x16x32_bf16 a[44:47], a[216:219], v[104:107], a[44:47]
  v_mfma_f32_16x16x32_bf16 a[44:47], a[220:223], v[108:111], a[44:47]
  v_mfma_f32_16x16x32_bf16 v[52:55], v[16:19], v[104:107], v[52:55]
  v_mfma_f32_16x16x32_bf16 v[52:55], v[16:19], v[108:111], v[52:55]
  s_waitcnt lgkmcnt(4)
  v_mfma_f32_16x16x32_bf16 a[16:19], a[224:227], v[96:99], a[16:19]
  v_mfma_f32_16x16x32_bf16 a[16:19], a[228:231], v[100:103], a[16:19]
  v_mfma_f32_16x16x32_bf16 a[48:51], a[224:227], v[104:107], a[48:51]
  v_mfma_f32_16x16x32_bf16 a[48:51], a[228:231], v[108:111], a[48:51]
  v_mfma_f32_16x16x32_bf16 a[20:23], a[232:235], v[96:99], a[20:23]
  v_mfma_f32_16x16x32_bf16 a[20:23], a[236:239], v[100:103], a[20:23]
  v_mfma_f32_16x16x32_bf16 a[52:55], a[232:235], v[104:107], a[52:55]
  v_mfma_f32_16x16x32_bf16 a[52:55], a[236:239], v[108:111], a[52:55]
  s_waitcnt lgkmcnt(0)
  v_mfma_f32_16x16x32_bf16 a[24:27], a[240:243], v[96:99], a[24:27]
  v_mfma_f32_16x16x32_bf16 a[24:27], a[244:247], v[100:103], a[24:27]
  v_mfma_f32_16x16x32_bf16 a[56:59], a[240:243], v[104:107], a[56:59]
  v_mfma_f32_16x16x32_bf16 a[56:59], a[244:247], v[108:111], a[56:59]
  v_mfma_f32_16x16x32_bf16 a[28:31], a[248:251], v[96:99], a[28:31]
  v_mfma_f32_16x16x32_bf16 a[28:31], a[252:255], v[100:103], a[28:31]
  v_mfma_f32_16x16x32_bf16 a[60:63], a[248:251], v[104:107], a[60:63]
  v_mfma_f32_16x16x32_bf16 a[60:63], a[252:255], v[108:111], a[60:63]
  s_nop 7
  s_lshl_b32 s3, s55, 20
  s_lshl_b32 s47, s33, 15
  s_add_u32 s3, s3, s47
  s_lshl_b32 s47, s32, 11
  s_add_u32 s3, s3, s47
  v_lshlrev_b32 v23, 4, v0
  v_rcp_f32 v21, v48
  v_rcp_f32 v22, v52
  v_accvgpr_read_b32 v8, a0
  v_accvgpr_read_b32 v9, a1
  v_accvgpr_read_b32 v10, a2
  v_accvgpr_read_b32 v11, a3
  v_accvgpr_read_b32 v12, a4
  v_accvgpr_read_b32 v13, a5
  v_accvgpr_read_b32 v14, a6
  v_accvgpr_read_b32 v15, a7
  v_mul_f32 v8, v8, v21
  v_mul_f32 v9, v9, v21
  v_mul_f32 v10, v10, v21
  v_mul_f32 v11, v11, v21
  v_mul_f32 v12, v12, v21
  v_mul_f32 v13, v13, v21
  v_mul_f32 v14, v14, v21
  v_mul_f32 v15, v15, v21
  v_cvt_pk_bf16_f32 v24, v8, v9
  v_cvt_pk_bf16_f32 v25, v10, v11
  v_cvt_pk_bf16_f32 v26, v12, v13
  v_cvt_pk_bf16_f32 v27, v14, v15
  buffer_store_dwordx4 v[24:27], v23, s[20:23], s3 offen offset:0
  v_accvgpr_read_b32 v8, a32
  v_accvgpr_read_b32 v9, a33
  v_accvgpr_read_b32 v10, a34
  v_accvgpr_read_b32 v11, a35
  v_accvgpr_read_b32 v12, a36
  v_accvgpr_read_b32 v13, a37
  v_accvgpr_read_b32 v14, a38
  v_accvgpr_read_b32 v15, a39
  v_mul_f32 v8, v8, v22
  v_mul_f32 v9, v9, v22
  v_mul_f32 v10, v10, v22
  v_mul_f32 v11, v11, v22
  v_mul_f32 v12, v12, v22
  v_mul_f32 v13, v13, v22
  v_mul_f32 v14, v14, v22
  v_mul_f32 v15, v15, v22
  v_cvt_pk_bf16_f32 v28, v8, v9
  v_cvt_pk_bf16_f32 v29, v10, v11
  v_cvt_pk_bf16_f32 v30, v12, v13
  v_cvt_pk_bf16_f32 v31, v14, v15
  buffer_store_dwordx4 v[28:31], v23, s[20:23], s3 offen offset:1024
  s_add_u32 s3, s3, 8192
  v_accvgpr_read_b32 v8, a8
  v_accvgpr_read_b32 v9, a9
  v_accvgpr_read_b32 v10, a10
  v_accvgpr_read_b32 v11, a11
  v_accvgpr_read_b32 v12, a12
  v_accvgpr_read_b32 v13, a13
  v_accvgpr_read_b32 v14, a14
  v_accvgpr_read_b32 v15, a15
  v_mul_f32 v8, v8, v21
  v_mul_f32 v9, v9, v21
  v_mul_f32 v10, v10, v21
  v_mul_f32 v11, v11, v21
  v_mul_f32 v12, v12, v21
  v_mul_f32 v13, v13, v21
  v_mul_f32 v14, v14, v21
  v_mul_f32 v15, v15, v21
  v_cvt_pk_bf16_f32 v24, v8, v9
  v_cvt_pk_bf16_f32 v25, v10, v11
  v_cvt_pk_bf16_f32 v26, v12, v13
  v_cvt_pk_bf16_f32 v27, v14, v15
  buffer_store_dwordx4 v[24:27], v23, s[20:23], s3 offen offset:0
  v_accvgpr_read_b32 v8, a40
  v_accvgpr_read_b32 v9, a41
  v_accvgpr_read_b32 v10, a42
  v_accvgpr_read_b32 v11, a43
  v_accvgpr_read_b32 v12, a44
  v_accvgpr_read_b32 v13, a45
  v_accvgpr_read_b32 v14, a46
  v_accvgpr_read_b32 v15, a47
  v_mul_f32 v8, v8, v22
  v_mul_f32 v9, v9, v22
  v_mul_f32 v10, v10, v22
  v_mul_f32 v11, v11, v22
  v_mul_f32 v12, v12, v22
  v_mul_f32 v13, v13, v22
  v_mul_f32 v14, v14, v22
  v_mul_f32 v15, v15, v22
  v_cvt_pk_bf16_f32 v28, v8, v9
  v_cvt_pk_bf16_f32 v29, v10, v11
  v_cvt_pk_bf16_f32 v30, v12, v13
  v_cvt_pk_bf16_f32 v31, v14, v15
  buffer_store_dwordx4 v[28:31], v23, s[20:23], s3 offen offset:1024
  s_add_u32 s3, s3, 8192
  v_accvgpr_read_b32 v8, a16
  v_accvgpr_read_b32 v9, a17
  v_accvgpr_read_b32 v10, a18
  v_accvgpr_read_b32 v11, a19
  v_accvgpr_read_b32 v12, a20
  v_accvgpr_read_b32 v13, a21
  v_accvgpr_read_b32 v14, a22
  v_accvgpr_read_b32 v15, a23
  v_mul_f32 v8, v8, v21
  v_mul_f32 v9, v9, v21
  v_mul_f32 v10, v10, v21
  v_mul_f32 v11, v11, v21
  v_mul_f32 v12, v12, v21
  v_mul_f32 v13, v13, v21
  v_mul_f32 v14, v14, v21
  v_mul_f32 v15, v15, v21
  v_cvt_pk_bf16_f32 v24, v8, v9
  v_cvt_pk_bf16_f32 v25, v10, v11
  v_cvt_pk_bf16_f32 v26, v12, v13
  v_cvt_pk_bf16_f32 v27, v14, v15
  buffer_store_dwordx4 v[24:27], v23, s[20:23], s3 offen offset:0
  v_accvgpr_read_b32 v8, a48
  v_accvgpr_read_b32 v9, a49
  v_accvgpr_read_b32 v10, a50
  v_accvgpr_read_b32 v11, a51
  v_accvgpr_read_b32 v12, a52
  v_accvgpr_read_b32 v13, a53
  v_accvgpr_read_b32 v14, a54
  v_accvgpr_read_b32 v15, a55
  v_mul_f32 v8, v8, v22
  v_mul_f32 v9, v9, v22
  v_mul_f32 v10, v10, v22
  v_mul_f32 v11, v11, v22
  v_mul_f32 v12, v12, v22
  v_mul_f32 v13, v13, v22
  v_mul_f32 v14, v14, v22
  v_mul_f32 v15, v15, v22
  v_cvt_pk_bf16_f32 v28, v8, v9
  v_cvt_pk_bf16_f32 v29, v10, v11
  v_cvt_pk_bf16_f32 v30, v12, v13
  v_cvt_pk_bf16_f32 v31, v14, v15
  buffer_store_dwordx4 v[28:31], v23, s[20:23], s3 offen offset:1024
  s_add_u32 s3, s3, 8192
  v_accvgpr_read_b32 v8, a24
  v_accvgpr_read_b32 v9, a25
  v_accvgpr_read_b32 v10, a26
  v_accvgpr_read_b32 v11, a27
  v_accvgpr_read_b32 v12, a28
  v_accvgpr_read_b32 v13, a29
  v_accvgpr_read_b32 v14, a30
  v_accvgpr_read_b32 v15, a31
  v_mul_f32 v8, v8, v21
  v_mul_f32 v9, v9, v21
  v_mul_f32 v10, v10, v21
  v_mul_f32 v11, v11, v21
  v_mul_f32 v12, v12, v21
  v_mul_f32 v13, v13, v21
  v_mul_f32 v14, v14, v21
  v_mul_f32 v15, v15, v21
  v_cvt_pk_bf16_f32 v24, v8, v9
  v_cvt_pk_bf16_f32 v25, v10, v11
  v_cvt_pk_bf16_f32 v26, v12, v13
  v_cvt_pk_bf16_f32 v27, v14, v15
  buffer_store_dwordx4 v[24:27], v23, s[20:23], s3 offen offset:0
  v_accvgpr_read_b32 v8, a56
  v_accvgpr_read_b32 v9, a57
  v_accvgpr_read_b32 v10, a58
  v_accvgpr_read_b32 v11, a59
  v_accvgpr_read_b32 v12, a60
  v_accvgpr_read_b32 v13, a61
  v_accvgpr_read_b32 v14, a62
  v_accvgpr_read_b32 v15, a63
  v_mul_f32 v8, v8, v22
  v_mul_f32 v9, v9, v22
  v_mul_f32 v10, v10, v22
  v_mul_f32 v11, v11, v22
  v_mul_f32 v12, v12, v22
  v_mul_f32 v13, v13, v22
  v_mul_f32 v14, v14, v22
  v_mul_f32 v15, v15, v22
  v_cvt_pk_bf16_f32 v28, v8, v9
  v_cvt_pk_bf16_f32 v29, v10, v11
  v_cvt_pk_bf16_f32 v30, v12, v13
  v_cvt_pk_bf16_f32 v31, v14, v15
  buffer_store_dwordx4 v[28:31], v23, s[20:23], s3 offen offset:1024
L_k2_end:
  s_endpgm
L_k2_fb_we:
  s_nop 7
  v_max3_f32 v21, v128, v129, v130
  v_max3_f32 v21, v21, v131, v132
  v_max3_f32 v21, v21, v133, v134
  v_max3_f32 v21, v21, v135, v136
  v_max3_f32 v21, v21, v137, v138
  v_max3_f32 v21, v21, v139, v140
  v_max3_f32 v21, v21, v141, v142
  v_max_f32 v21, v21, v143
  v_mov_b32 v1, v21
  s_nop 1
  v_permlane16_swap_b32 v1, v21
  v_max_f32 v21, v21, v1
  v_mov_b32 v1, v21
  s_nop 1
  v_permlane32_swap_b32 v1, v21
  v_max_f32 v21, v21, v1
  v_add_f32 v21, 0x40e00000, v21
  v_max_f32 v21, 0, v21
  v_sub_f32 v128, v128, v21
  v_sub_f32 v129, v129, v21
  v_sub_f32 v130, v130, v21
  v_sub_f32 v131, v131, v21
  v_sub_f32 v132, v132, v21
  v_sub_f32 v133, v133, v21
  v_sub_f32 v134, v134, v21
  v_sub_f32 v135, v135, v21
  v_sub_f32 v136, v136, v21
  v_sub_f32 v137, v137, v21
  v_sub_f32 v138, v138, v21
  v_sub_f32 v139, v139, v21
  v_sub_f32 v140, v140, v21
  v_sub_f32 v141, v141, v21
  v_sub_f32 v142, v142, v21
  v_sub_f32 v143, v143, v21
  v_sub_f32 v192, v192, v21
  v_sub_f32 v193, v193, v21
  v_sub_f32 v194, v194, v21
  v_sub_f32 v195, v195, v21
  v_sub_f32 v196, v196, v21
  v_sub_f32 v197, v197, v21
  v_sub_f32 v198, v198, v21
  v_sub_f32 v199, v199, v21
  v_sub_f32 v200, v200, v21
  v_sub_f32 v201, v201, v21
  v_sub_f32 v202, v202, v21
  v_sub_f32 v203, v203, v21
  v_sub_f32 v204, v204, v21
  v_sub_f32 v205, v205, v21
  v_sub_f32 v206, v206, v21
  v_sub_f32 v207, v207, v21
  v_sub_f32 v32, v32, v21
  v_sub_f32 v33, v33, v21
  v_sub_f32 v34, v34, v21
  v_sub_f32 v35, v35, v21
  v_exp_f32 v22, -v21
  s_nop 0
  v_mul_f32 v48, v48, v22
  v_mul_f32 v49, v49, v22
  v_mul_f32 v50, v50, v22
  v_mul_f32 v51, v51, v22
  v_accvgpr_read_b32 v8, a0
  v_accvgpr_read_b32 v9, a1
  v_accvgpr_read_b32 v10, a2
  v_accvgpr_read_b32 v11, a3
  v_accvgpr_read_b32 v12, a4
  v_accvgpr_read_b32 v13, a5
  v_accvgpr_read_b32 v14, a6
  v_accvgpr_read_b32 v15, a7
  v_mul_f32 v8, v8, v22
  v_mul_f32 v9, v9, v22
  v_mul_f32 v10, v10, v22
  v_mul_f32 v11, v11, v22
  v_mul_f32 v12, v12, v22
  v_mul_f32 v13, v13, v22
  v_mul_f32 v14, v14, v22
  v_mul_f32 v15, v15, v22
  v_accvgpr_write_b32 a0, v8
  v_accvgpr_write_b32 a1, v9
  v_accvgpr_write_b32 a2, v10
  v_accvgpr_write_b32 a3, v11
  v_accvgpr_write_b32 a4, v12
  v_accvgpr_write_b32 a5, v13
  v_accvgpr_write_b32 a6, v14
  v_accvgpr_write_b32 a7, v15
  v_accvgpr_read_b32 v8, a8
  v_accvgpr_read_b32 v9, a9
  v_accvgpr_read_b32 v10, a10
  v_accvgpr_read_b32 v11, a11
  v_accvgpr_read_b32 v12, a12
  v_accvgpr_read_b32 v13, a13
  v_accvgpr_read_b32 v14, a14
  v_accvgpr_read_b32 v15, a15
  v_mul_f32 v8, v8, v22
  v_mul_f32 v9, v9, v22
  v_mul_f32 v10, v10, v22
  v_mul_f32 v11, v11, v22
  v_mul_f32 v12, v12, v22
  v_mul_f32 v13, v13, v22
  v_mul_f32 v14, v14, v22
  v_mul_f32 v15, v15, v22
  v_accvgpr_write_b32 a8, v8
  v_accvgpr_write_b32 a9, v9
  v_accvgpr_write_b32 a10, v10
  v_accvgpr_write_b32 a11, v11
  v_accvgpr_write_b32 a12, v12
  v_accvgpr_write_b32 a13, v13
  v_accvgpr_write_b32 a14, v14
  v_accvgpr_write_b32 a15, v15
  v_accvgpr_read_b32 v8, a16
  v_accvgpr_read_b32 v9, a17
  v_accvgpr_read_b32 v10, a18
  v_accvgpr_read_b32 v11, a19
  v_accvgpr_read_b32 v12, a20
  v_accvgpr_read_b32 v13, a21
  v_accvgpr_read_b32 v14, a22
  v_accvgpr_read_b32 v15, a23
  v_mul_f32 v8, v8, v22
  v_mul_f32 v9, v9, v22
  v_mul_f32 v10, v10, v22
  v_mul_f32 v11, v11, v22
  v_mul_f32 v12, v12, v22
  v_mul_f32 v13, v13, v22
  v_mul_f32 v14, v14, v22
  v_mul_f32 v15, v15, v22
  v_accvgpr_write_b32 a16, v8
  v_accvgpr_write_b32 a17, v9
  v_accvgpr_write_b32 a18, v10
  v_accvgpr_write_b32 a19, v11
  v_accvgpr_write_b32 a20, v12
  v_accvgpr_write_b32 a21, v13
  v_accvgpr_write_b32 a22, v14
  v_accvgpr_write_b32 a23, v15
  v_accvgpr_read_b32 v8, a24
  v_accvgpr_read_b32 v9, a25
  v_accvgpr_read_b32 v10, a26
  v_accvgpr_read_b32 v11, a27
  v_accvgpr_read_b32 v12, a28
  v_accvgpr_read_b32 v13, a29
  v_accvgpr_read_b32 v14, a30
  v_accvgpr_read_b32 v15, a31
  v_mul_f32 v8, v8, v22
  v_mul_f32 v9, v9, v22
  v_mul_f32 v10, v10, v22
  v_mul_f32 v11, v11, v22
  v_mul_f32 v12, v12, v22
  v_mul_f32 v13, v13, v22
  v_mul_f32 v14, v14, v22
  v_mul_f32 v15, v15, v22
  v_accvgpr_write_b32 a24, v8
  v_accvgpr_write_b32 a25, v9
  v_accvgpr_write_b32 a26, v10
  v_accvgpr_write_b32 a27, v11
  v_accvgpr_write_b32 a28, v12
  v_accvgpr_write_b32 a29, v13
  v_accvgpr_write_b32 a30, v14
  v_accvgpr_write_b32 a31, v15
  v_max3_f32 v21, v144, v145, v146
  v_max3_f32 v21, v21, v147, v148
  v_max3_f32 v21, v21, v149, v150
  v_max3_f32 v21, v21, v151, v152
  v_max3_f32 v21, v21, v153, v154
  v_max3_f32 v21, v21, v155, v156
  v_max3_f32 v21, v21, v157, v158
  v_max_f32 v21, v21, v159
  v_mov_b32 v1, v21
  s_nop 1
  v_permlane16_swap_b32 v1, v21
  v_max_f32 v21, v21, v1
  v_mov_b32 v1, v21
  s_nop 1
  v_permlane32_swap_b32 v1, v21
  v_max_f32 v21, v21, v1
  v_add_f32 v21, 0x40e00000, v21
  v_max_f32 v21, 0, v21
  v_sub_f32 v144, v144, v21
  v_sub_f32 v145, v145, v21
  v_sub_f32 v146, v146, v21
  v_sub_f32 v147, v147, v21
  v_sub_f32 v148, v148, v21
  v_sub_f32 v149, v149, v21
  v_sub_f32 v150, v150, v21
  v_sub_f32 v151, v151, v21
  v_sub_f32 v152, v152, v21
  v_sub_f32 v153, v153, v21
  v_sub_f32 v154, v154, v21
  v_sub_f32 v155, v155, v21
  v_sub_f32 v156, v156, v21
  v_sub_f32 v157, v157, v21
  v_sub_f32 v158, v158, v21
  v_sub_f32 v159, v159, v21
  v_sub_f32 v208, v208, v21
  v_sub_f32 v209, v209, v21
  v_sub_f32 v210, v210, v21
  v_sub_f32 v211, v211, v21
  v_sub_f32 v212, v212, v21
  v_sub_f32 v213, v213, v21
  v_sub_f32 v214, v214, v21
  v_sub_f32 v215, v215, v21
  v_sub_f32 v216, v216, v21
  v_sub_f32 v217, v217, v21
  v_sub_f32 v218, v218, v21
  v_sub_f32 v219, v219, v21
  v_sub_f32 v220, v220, v21
  v_sub_f32 v221, v221, v21
  v_sub_f32 v222, v222, v21
  v_sub_f32 v223, v223, v21
  v_sub_f32 v36, v36, v21
  v_sub_f32 v37, v37, v21
  v_sub_f32 v38, v38, v21
  v_sub_f32 v39, v39, v21
  v_exp_f32 v22, -v21
  s_nop 0
  v_mul_f32 v52, v52, v22
  v_mul_f32 v53, v53, v22
  v_mul_f32 v54, v54, v22
  v_mul_f32 v55, v55, v22
  v_accvgpr_read_b32 v8, a32
  v_accvgpr_read_b32 v9, a33
  v_accvgpr_read_b32 v10, a34
  v_accvgpr_read_b32 v11, a35
  v_accvgpr_read_b32 v12, a36
  v_accvgpr_read_b32 v13, a37
  v_accvgpr_read_b32 v14, a38
  v_accvgpr_read_b32 v15, a39
  v_mul_f32 v8, v8, v22
  v_mul_f32 v9, v9, v22
  v_mul_f32 v10, v10, v22
  v_mul_f32 v11, v11, v22
  v_mul_f32 v12, v12, v22
  v_mul_f32 v13, v13, v22
  v_mul_f32 v14, v14, v22
  v_mul_f32 v15, v15, v22
  v_accvgpr_write_b32 a32, v8
  v_accvgpr_write_b32 a33, v9
  v_accvgpr_write_b32 a34, v10
  v_accvgpr_write_b32 a35, v11
  v_accvgpr_write_b32 a36, v12
  v_accvgpr_write_b32 a37, v13
  v_accvgpr_write_b32 a38, v14
  v_accvgpr_write_b32 a39, v15
  v_accvgpr_read_b32 v8, a40
  v_accvgpr_read_b32 v9, a41
  v_accvgpr_read_b32 v10, a42
  v_accvgpr_read_b32 v11, a43
  v_accvgpr_read_b32 v12, a44
  v_accvgpr_read_b32 v13, a45
  v_accvgpr_read_b32 v14, a46
  v_accvgpr_read_b32 v15, a47
  v_mul_f32 v8, v8, v22
  v_mul_f32 v9, v9, v22
  v_mul_f32 v10, v10, v22
  v_mul_f32 v11, v11, v22
  v_mul_f32 v12, v12, v22
  v_mul_f32 v13, v13, v22
  v_mul_f32 v14, v14, v22
  v_mul_f32 v15, v15, v22
  v_accvgpr_write_b32 a40, v8
  v_accvgpr_write_b32 a41, v9
  v_accvgpr_write_b32 a42, v10
  v_accvgpr_write_b32 a43, v11
  v_accvgpr_write_b32 a44, v12
  v_accvgpr_write_b32 a45, v13
  v_accvgpr_write_b32 a46, v14
  v_accvgpr_write_b32 a47, v15
  v_accvgpr_read_b32 v8, a48
  v_accvgpr_read_b32 v9, a49
  v_accvgpr_read_b32 v10, a50
  v_accvgpr_read_b32 v11, a51
  v_accvgpr_read_b32 v12, a52
  v_accvgpr_read_b32 v13, a53
  v_accvgpr_read_b32 v14, a54
  v_accvgpr_read_b32 v15, a55
  v_mul_f32 v8, v8, v22
  v_mul_f32 v9, v9, v22
  v_mul_f32 v10, v10, v22
  v_mul_f32 v11, v11, v22
  v_mul_f32 v12, v12, v22
  v_mul_f32 v13, v13, v22
  v_mul_f32 v14, v14, v22
  v_mul_f32 v15, v15, v22
  v_accvgpr_write_b32 a48, v8
  v_accvgpr_write_b32 a49, v9
  v_accvgpr_write_b32 a50, v10
  v_accvgpr_write_b32 a51, v11
  v_accvgpr_write_b32 a52, v12
  v_accvgpr_write_b32 a53, v13
  v_accvgpr_write_b32 a54, v14
  v_accvgpr_write_b32 a55, v15
  v_accvgpr_read_b32 v8, a56
  v_accvgpr_read_b32 v9, a57
  v_accvgpr_read_b32 v10, a58
  v_accvgpr_read_b32 v11, a59
  v_accvgpr_read_b32 v12, a60
  v_accvgpr_read_b32 v13, a61
  v_accvgpr_read_b32 v14, a62
  v_accvgpr_read_b32 v15, a63
  v_mul_f32 v8, v8, v22
  v_mul_f32 v9, v9, v22
  v_mul_f32 v10, v10, v22
  v_mul_f32 v11, v11, v22
  v_mul_f32 v12, v12, v22
  v_mul_f32 v13, v13, v22
  v_mul_f32 v14, v14, v22
  v_mul_f32 v15, v15, v22
  v_accvgpr_write_b32 a56, v8
  v_accvgpr_write_b32 a57, v9
  v_accvgpr_write_b32 a58, v10
  v_accvgpr_write_b32 a59, v11
  v_accvgpr_write_b32 a60, v12
  v_accvgpr_write_b32 a61, v13
  v_accvgpr_write_b32 a62, v14
  v_accvgpr_write_b32 a63, v15
  v_max3_f32 v21, v160, v161, v162
  v_max3_f32 v21, v21, v163, v164
  v_max3_f32 v21, v21, v165, v166
  v_max3_f32 v21, v21, v167, v168
  v_max3_f32 v21, v21, v169, v170
  v_max3_f32 v21, v21, v171, v172
  v_max3_f32 v21, v21, v173, v174
  v_max_f32 v21, v21, v175
  v_mov_b32 v1, v21
  s_nop 1
  v_permlane16_swap_b32 v1, v21
  v_max_f32 v21, v21, v1
  v_mov_b32 v1, v21
  s_nop 1
  v_permlane32_swap_b32 v1, v21
  v_max_f32 v21, v21, v1
  v_add_f32 v21, 0x40e00000, v21
  v_max_f32 v21, 0, v21
  v_sub_f32 v160, v160, v21
  v_sub_f32 v161, v161, v21
  v_sub_f32 v162, v162, v21
  v_sub_f32 v163, v163, v21
  v_sub_f32 v164, v164, v21
  v_sub_f32 v165, v165, v21
  v_sub_f32 v166, v166, v21
  v_sub_f32 v167, v167, v21
  v_sub_f32 v168, v168, v21
  v_sub_f32 v169, v169, v21
  v_sub_f32 v170, v170, v21
  v_sub_f32 v171, v171, v21
  v_sub_f32 v172, v172, v21
  v_sub_f32 v173, v173, v21
  v_sub_f32 v174, v174, v21
  v_sub_f32 v175, v175, v21
  v_sub_f32 v224, v224, v21
  v_sub_f32 v225, v225, v21
  v_sub_f32 v226, v226, v21
  v_sub_f32 v227, v227, v21
  v_sub_f32 v228, v228, v21
  v_sub_f32 v229, v229, v21
  v_sub_f32 v230, v230, v21
  v_sub_f32 v231, v231, v21
  v_sub_f32 v232, v232, v21
  v_sub_f32 v233, v233, v21
  v_sub_f32 v234, v234, v21
  v_sub_f32 v235, v235, v21
  v_sub_f32 v236, v236, v21
  v_sub_f32 v237, v237, v21
  v_sub_f32 v238, v238, v21
  v_sub_f32 v239, v239, v21
  v_sub_f32 v40, v40, v21
  v_sub_f32 v41, v41, v21
  v_sub_f32 v42, v42, v21
  v_sub_f32 v43, v43, v21
  v_exp_f32 v22, -v21
  s_nop 0
  v_mul_f32 v56, v56, v22
  v_mul_f32 v57, v57, v22
  v_mul_f32 v58, v58, v22
  v_mul_f32 v59, v59, v22
  v_accvgpr_read_b32 v8, a64
  v_accvgpr_read_b32 v9, a65
  v_accvgpr_read_b32 v10, a66
  v_accvgpr_read_b32 v11, a67
  v_accvgpr_read_b32 v12, a68
  v_accvgpr_read_b32 v13, a69
  v_accvgpr_read_b32 v14, a70
  v_accvgpr_read_b32 v15, a71
  v_mul_f32 v8, v8, v22
  v_mul_f32 v9, v9, v22
  v_mul_f32 v10, v10, v22
  v_mul_f32 v11, v11, v22
  v_mul_f32 v12, v12, v22
  v_mul_f32 v13, v13, v22
  v_mul_f32 v14, v14, v22
  v_mul_f32 v15, v15, v22
  v_accvgpr_write_b32 a64, v8
  v_accvgpr_write_b32 a65, v9
  v_accvgpr_write_b32 a66, v10
  v_accvgpr_write_b32 a67, v11
  v_accvgpr_write_b32 a68, v12
  v_accvgpr_write_b32 a69, v13
  v_accvgpr_write_b32 a70, v14
  v_accvgpr_write_b32 a71, v15
  v_accvgpr_read_b32 v8, a72
  v_accvgpr_read_b32 v9, a73
  v_accvgpr_read_b32 v10, a74
  v_accvgpr_read_b32 v11, a75
  v_accvgpr_read_b32 v12, a76
  v_accvgpr_read_b32 v13, a77
  v_accvgpr_read_b32 v14, a78
  v_accvgpr_read_b32 v15, a79
  v_mul_f32 v8, v8, v22
  v_mul_f32 v9, v9, v22
  v_mul_f32 v10, v10, v22
  v_mul_f32 v11, v11, v22
  v_mul_f32 v12, v12, v22
  v_mul_f32 v13, v13, v22
  v_mul_f32 v14, v14, v22
  v_mul_f32 v15, v15, v22
  v_accvgpr_write_b32 a72, v8
  v_accvgpr_write_b32 a73, v9
  v_accvgpr_write_b32 a74, v10
  v_accvgpr_write_b32 a75, v11
  v_accvgpr_write_b32 a76, v12
  v_accvgpr_write_b32 a77, v13
  v_accvgpr_write_b32 a78, v14
  v_accvgpr_write_b32 a79, v15
  v_accvgpr_read_b32 v8, a80
  v_accvgpr_read_b32 v9, a81
  v_accvgpr_read_b32 v10, a82
  v_accvgpr_read_b32 v11, a83
  v_accvgpr_read_b32 v12, a84
  v_accvgpr_read_b32 v13, a85
  v_accvgpr_read_b32 v14, a86
  v_accvgpr_read_b32 v15, a87
  v_mul_f32 v8, v8, v22
  v_mul_f32 v9, v9, v22
  v_mul_f32 v10, v10, v22
  v_mul_f32 v11, v11, v22
  v_mul_f32 v12, v12, v22
  v_mul_f32 v13, v13, v22
  v_mul_f32 v14, v14, v22
  v_mul_f32 v15, v15, v22
  v_accvgpr_write_b32 a80, v8
  v_accvgpr_write_b32 a81, v9
  v_accvgpr_write_b32 a82, v10
  v_accvgpr_write_b32 a83, v11
  v_accvgpr_write_b32 a84, v12
  v_accvgpr_write_b32 a85, v13
  v_accvgpr_write_b32 a86, v14
  v_accvgpr_write_b32 a87, v15
  v_accvgpr_read_b32 v8, a88
  v_accvgpr_read_b32 v9, a89
  v_accvgpr_read_b32 v10, a90
  v_accvgpr_read_b32 v11, a91
  v_accvgpr_read_b32 v12, a92
  v_accvgpr_read_b32 v13, a93
  v_accvgpr_read_b32 v14, a94
  v_accvgpr_read_b32 v15, a95
  v_mul_f32 v8, v8, v22
  v_mul_f32 v9, v9, v22
  v_mul_f32 v10, v10, v22
  v_mul_f32 v11, v11, v22
  v_mul_f32 v12, v12, v22
  v_mul_f32 v13, v13, v22
  v_mul_f32 v14, v14, v22
  v_mul_f32 v15, v15, v22
  v_accvgpr_write_b32 a88, v8
  v_accvgpr_write_b32 a89, v9
  v_accvgpr_write_b32 a90, v10
  v_accvgpr_write_b32 a91, v11
  v_accvgpr_write_b32 a92, v12
  v_accvgpr_write_b32 a93, v13
  v_accvgpr_write_b32 a94, v14
  v_accvgpr_write_b32 a95, v15
  v_max3_f32 v21, v176, v177, v178
  v_max3_f32 v21, v21, v179, v180
  v_max3_f32 v21, v21, v181, v182
  v_max3_f32 v21, v21, v183, v184
  v_max3_f32 v21, v21, v185, v186
  v_max3_f32 v21, v21, v187, v188
  v_max3_f32 v21, v21, v189, v190
  v_max_f32 v21, v21, v191
  v_mov_b32 v1, v21
  s_nop 1
  v_permlane16_swap_b32 v1, v21
  v_max_f32 v21, v21, v1
  v_mov_b32 v1, v21
  s_nop 1
  v_permlane32_swap_b32 v1, v21
  v_max_f32 v21, v21, v1
  v_add_f32 v21, 0x40e00000, v21
  v_max_f32 v21, 0, v21
  v_sub_f32 v176, v176, v21
  v_sub_f32 v177, v177, v21
  v_sub_f32 v178, v178, v21
  v_sub_f32 v179, v179, v21
  v_sub_f32 v180, v180, v21
  v_sub_f32 v181, v181, v21
  v_sub_f32 v182, v182, v21
  v_sub_f32 v183, v183, v21
  v_sub_f32 v184, v184, v21
  v_sub_f32 v185, v185, v21
  v_sub_f32 v186, v186, v21
  v_sub_f32 v187, v187, v21
  v_sub_f32 v188, v188, v21
  v_sub_f32 v189, v189, v21
  v_sub_f32 v190, v190, v21
  v_sub_f32 v191, v191, v21
  v_sub_f32 v240, v240, v21
  v_sub_f32 v241, v241, v21
  v_sub_f32 v242, v242, v21
  v_sub_f32 v243, v243, v21
  v_sub_f32 v244, v244, v21
  v_sub_f32 v245, v245, v21
  v_sub_f32 v246, v246, v21
  v_sub_f32 v247, v247, v21
  v_sub_f32 v248, v248, v21
  v_sub_f32 v249, v249, v21
  v_sub_f32 v250, v250, v21
  v_sub_f32 v251, v251, v21
  v_sub_f32 v252, v252, v21
  v_sub_f32 v253, v253, v21
  v_sub_f32 v254, v254, v21
  v_sub_f32 v255, v255, v21
  v_sub_f32 v44, v44, v21
  v_sub_f32 v45, v45, v21
  v_sub_f32 v46, v46, v21
  v_sub_f32 v47, v47, v21
  v_exp_f32 v22, -v21
  s_nop 0
  v_mul_f32 v60, v60, v22
  v_mul_f32 v61, v61, v22
  v_mul_f32 v62, v62, v22
  v_mul_f32 v63, v63, v22
  v_accvgpr_read_b32 v8, a96
  v_accvgpr_read_b32 v9, a97
  v_accvgpr_read_b32 v10, a98
  v_accvgpr_read_b32 v11, a99
  v_accvgpr_read_b32 v12, a100
  v_accvgpr_read_b32 v13, a101
  v_accvgpr_read_b32 v14, a102
  v_accvgpr_read_b32 v15, a103
  v_mul_f32 v8, v8, v22
  v_mul_f32 v9, v9, v22
  v_mul_f32 v10, v10, v22
  v_mul_f32 v11, v11, v22
  v_mul_f32 v12, v12, v22
  v_mul_f32 v13, v13, v22
  v_mul_f32 v14, v14, v22
  v_mul_f32 v15, v15, v22
  v_accvgpr_write_b32 a96, v8
  v_accvgpr_write_b32 a97, v9
  v_accvgpr_write_b32 a98, v10
  v_accvgpr_write_b32 a99, v11
  v_accvgpr_write_b32 a100, v12
  v_accvgpr_write_b32 a101, v13
  v_accvgpr_write_b32 a102, v14
  v_accvgpr_write_b32 a103, v15
  v_accvgpr_read_b32 v8, a104
  v_accvgpr_read_b32 v9, a105
  v_accvgpr_read_b32 v10, a106
  v_accvgpr_read_b32 v11, a107
  v_accvgpr_read_b32 v12, a108
  v_accvgpr_read_b32 v13, a109
  v_accvgpr_read_b32 v14, a110
  v_accvgpr_read_b32 v15, a111
  v_mul_f32 v8, v8, v22
  v_mul_f32 v9, v9, v22
  v_mul_f32 v10, v10, v22
  v_mul_f32 v11, v11, v22
  v_mul_f32 v12, v12, v22
  v_mul_f32 v13, v13, v22
  v_mul_f32 v14, v14, v22
  v_mul_f32 v15, v15, v22
  v_accvgpr_write_b32 a104, v8
  v_accvgpr_write_b32 a105, v9
  v_accvgpr_write_b32 a106, v10
  v_accvgpr_write_b32 a107, v11
  v_accvgpr_write_b32 a108, v12
  v_accvgpr_write_b32 a109, v13
  v_accvgpr_write_b32 a110, v14
  v_accvgpr_write_b32 a111, v15
  v_accvgpr_read_b32 v8, a112
  v_accvgpr_read_b32 v9, a113
  v_accvgpr_read_b32 v10, a114
  v_accvgpr_read_b32 v11, a115
  v_accvgpr_read_b32 v12, a116
  v_accvgpr_read_b32 v13, a117
  v_accvgpr_read_b32 v14, a118
  v_accvgpr_read_b32 v15, a119
  v_mul_f32 v8, v8, v22
  v_mul_f32 v9, v9, v22
  v_mul_f32 v10, v10, v22
  v_mul_f32 v11, v11, v22
  v_mul_f32 v12, v12, v22
  v_mul_f32 v13, v13, v22
  v_mul_f32 v14, v14, v22
  v_mul_f32 v15, v15, v22
  v_accvgpr_write_b32 a112, v8
  v_accvgpr_write_b32 a113, v9
  v_accvgpr_write_b32 a114, v10
  v_accvgpr_write_b32 a115, v11
  v_accvgpr_write_b32 a116, v12
  v_accvgpr_write_b32 a117, v13
  v_accvgpr_write_b32 a118, v14
  v_accvgpr_write_b32 a119, v15
  v_accvgpr_read_b32 v8, a120
  v_accvgpr_read_b32 v9, a121
  v_accvgpr_read_b32 v10, a122
  v_accvgpr_read_b32 v11, a123
  v_accvgpr_read_b32 v12, a124
  v_accvgpr_read_b32 v13, a125
  v_accvgpr_read_b32 v14, a126
  v_accvgpr_read_b32 v15, a127
  v_mul_f32 v8, v8, v22
  v_mul_f32 v9, v9, v22
  v_mul_f32 v10, v10, v22
  v_mul_f32 v11, v11, v22
  v_mul_f32 v12, v12, v22
  v_mul_f32 v13, v13, v22
  v_mul_f32 v14, v14, v22
  v_mul_f32 v15, v15, v22
  v_accvgpr_write_b32 a120, v8
  v_accvgpr_write_b32 a121, v9
  v_accvgpr_write_b32 a122, v10
  v_accvgpr_write_b32 a123, v11
  v_accvgpr_write_b32 a124, v12
  v_accvgpr_write_b32 a125, v13
  v_accvgpr_write_b32 a126, v14
  v_accvgpr_write_b32 a127, v15
  v_exp_f32 v8, v128
  v_exp_f32 v9, v129
  s_nop 0
  v_cvt_pk_bf16_f32 v64, v8, v9
  v_exp_f32 v8, v130
  v_exp_f32 v9, v131
  s_nop 0
  v_cvt_pk_bf16_f32 v65, v8, v9
  v_exp_f32 v8, v144
  v_exp_f32 v9, v145
  s_nop 0
  v_cvt_pk_bf16_f32 v72, v8, v9
  v_exp_f32 v8, v146
  v_exp_f32 v9, v147
  s_nop 0
  v_cvt_pk_bf16_f32 v73, v8, v9
  v_exp_f32 v8, v160
  v_exp_f32 v9, v161
  s_nop 0
  v_cvt_pk_bf16_f32 v80, v8, v9
  v_exp_f32 v8, v162
  v_exp_f32 v9, v163
  s_nop 0
  v_cvt_pk_bf16_f32 v81, v8, v9
  v_exp_f32 v8, v176
  v_exp_f32 v9, v177
  s_nop 0
  v_cvt_pk_bf16_f32 v88, v8, v9
  v_exp_f32 v8, v178
  v_exp_f32 v9, v179
  s_nop 0
  v_cvt_pk_bf16_f32 v89, v8, v9
  v_exp_f32 v8, v132
  v_exp_f32 v9, v133
  s_nop 0
  v_cvt_pk_bf16_f32 v66, v8, v9
  v_exp_f32 v8, v134
  v_exp_f32 v9, v135
  s_nop 0
  v_cvt_pk_bf16_f32 v67, v8, v9
  v_exp_f32 v8, v148
  v_exp_f32 v9, v149
  s_nop 0
  v_cvt_pk_bf16_f32 v74, v8, v9
  v_exp_f32 v8, v150
  v_exp_f32 v9, v151
  s_nop 0
  v_cvt_pk_bf16_f32 v75, v8, v9
  v_exp_f32 v8, v164
  v_exp_f32 v9, v165
  s_nop 0
  v_cvt_pk_bf16_f32 v82, v8, v9
  v_exp_f32 v8, v166
  v_exp_f32 v9, v167
  s_nop 0
  v_cvt_pk_bf16_f32 v83, v8, v9
  v_exp_f32 v8, v180
  v_exp_f32 v9, v181
  s_nop 0
  v_cvt_pk_bf16_f32 v90, v8, v9
  v_exp_f32 v8, v182
  v_exp_f32 v9, v183
  s_nop 0
  v_cvt_pk_bf16_f32 v91, v8, v9
  v_exp_f32 v8, v136
  v_exp_f32 v9, v137
  s_nop 0
  v_cvt_pk_bf16_f32 v68, v8, v9
  v_exp_f32 v8, v138
  v_exp_f32 v9, v139
  s_nop 0
  v_cvt_pk_bf16_f32 v69, v8, v9
  v_exp_f32 v8, v152
  v_exp_f32 v9, v153
  s_nop 0
  v_cvt_pk_bf16_f32 v76, v8, v9
  v_exp_f32 v8, v154
  v_exp_f32 v9, v155
  s_nop 0
  v_cvt_pk_bf16_f32 v77, v8, v9
  v_exp_f32 v8, v168
  v_exp_f32 v9, v169
  s_nop 0
  v_cvt_pk_bf16_f32 v84, v8, v9
  v_exp_f32 v8, v170
  v_exp_f32 v9, v171
  s_nop 0
  v_cvt_pk_bf16_f32 v85, v8, v9
  v_exp_f32 v8, v184
  v_exp_f32 v9, v185
  s_nop 0
  v_cvt_pk_bf16_f32 v92, v8, v9
  v_exp_f32 v8, v186
  v_exp_f32 v9, v187
  s_nop 0
  v_cvt_pk_bf16_f32 v93, v8, v9
  v_exp_f32 v8, v140
  v_exp_f32 v9, v141
  s_nop 0
  v_cvt_pk_bf16_f32 v70, v8, v9
  v_exp_f32 v8, v142
  v_exp_f32 v9, v143
  s_nop 0
  v_cvt_pk_bf16_f32 v71, v8, v9
  v_exp_f32 v8, v156
  v_exp_f32 v9, v157
  s_nop 0
  v_cvt_pk_bf16_f32 v78, v8, v9
  v_exp_f32 v8, v158
  v_exp_f32 v9, v159
  s_nop 0
  v_cvt_pk_bf16_f32 v79, v8, v9
  v_exp_f32 v8, v172
  v_exp_f32 v9, v173
  s_nop 0
  v_cvt_pk_bf16_f32 v86, v8, v9
  v_exp_f32 v8, v174
  v_exp_f32 v9, v175
  s_nop 0
  v_cvt_pk_bf16_f32 v87, v8, v9
  v_exp_f32 v8, v188
  v_exp_f32 v9, v189
  s_nop 0
  v_cvt_pk_bf16_f32 v94, v8, v9
  v_exp_f32 v8, v190
  v_exp_f32 v9, v191
  s_nop 0
  v_cvt_pk_bf16_f32 v95, v8, v9
  s_nop 1
  s_branch L_k2_fbr_we
L_k2_mk_we:
  s_nop 7
  s_add_u32 s3, s37, 1
  s_lshl_b32 s3, s3, 6
  v_subrev_u32 v1, s3, v6
  v_cmp_gt_i32 s[56:57], -16, v1
  v_cmp_gt_i32 s[58:59], -15, v1
  v_cmp_gt_i32 s[60:61], -14, v1
  v_cmp_gt_i32 s[62:63], -13, v1
  v_cndmask_b32 v240, v240, v20, s[56:57]
  v_cndmask_b32 v241, v241, v20, s[58:59]
  v_cndmask_b32 v242, v242, v20, s[60:61]
  v_cndmask_b32 v243, v243, v20, s[62:63]
  v_cmp_gt_i32 s[56:57], 0, v1
  v_cmp_gt_i32 s[58:59], 1, v1
  v_cmp_gt_i32 s[60:61], 2, v1
  v_cmp_gt_i32 s[62:63], 3, v1
  v_cndmask_b32 v224, v224, v20, s[56:57]
  v_cndmask_b32 v225, v225, v20, s[58:59]
  v_cndmask_b32 v226, v226, v20, s[60:61]
  v_cndmask_b32 v227, v227, v20, s[62:63]
  v_cndmask_b32 v244, v244, v20, s[56:57]
  v_cndmask_b32 v245, v245, v20, s[58:59]
  v_cndmask_b32 v246, v246, v20, s[60:61]
  v_cndmask_b32 v247, v247, v20, s[62:63]
  v_cmp_gt_i32 s[56:57], 16, v1
  v_cmp_gt_i32 s[58:59], 17, v1
  v_cmp_gt_i32 s[60:61], 18, v1
  v_cmp_gt_i32 s[62:63], 19, v1
  v_cndmask_b32 v228, v228, v20, s[56:57]
  v_cndmask_b32 v229, v229, v20, s[58:59]
  v_cndmask_b32 v230, v230, v20, s[60:61]
  v_cndmask_b32 v231, v231, v20, s[62:63]
  v_cndmask_b32 v248, v248, v20, s[56:57]
  v_cndmask_b32 v249, v249, v20, s[58:59]
  v_cndmask_b32 v250, v250, v20, s[60:61]
  v_cndmask_b32 v251, v251, v20, s[62:63]
  v_cmp_gt_i32 s[56:57], 32, v1
  v_cmp_gt_i32 s[58:59], 33, v1
  v_cmp_gt_i32 s[60:61], 34, v1
  v_cmp_gt_i32 s[62:63], 35, v1
  v_cndmask_b32 v232, v232, v20, s[56:57]
  v_cndmask_b32 v233, v233, v20, s[58:59]
  v_cndmask_b32 v234, v234, v20, s[60:61]
  v_cndmask_b32 v235, v235, v20, s[62:63]
  v_cndmask_b32 v252, v252, v20, s[56:57]
  v_cndmask_b32 v253, v253, v20, s[58:59]
  v_cndmask_b32 v254, v254, v20, s[60:61]
  v_cndmask_b32 v255, v255, v20, s[62:63]
  v_cmp_gt_i32 s[56:57], 48, v1
  v_cmp_gt_i32 s[58:59], 49, v1
  v_cmp_gt_i32 s[60:61], 50, v1
  v_cmp_gt_i32 s[62:63], 51, v1
  v_cndmask_b32 v236, v236, v20, s[56:57]
  v_cndmask_b32 v237, v237, v20, s[58:59]
  v_cndmask_b32 v238, v238, v20, s[60:61]
  v_cndmask_b32 v239, v239, v20, s[62:63]
  s_nop 1
  s_branch L_k2_mkr_we
L_k2_fb_wo:
  s_nop 7
  v_max3_f32 v21, v192, v193, v194
  v_max3_f32 v21, v21, v195, v196
  v_max3_f32 v21, v21, v197, v198
  v_max3_f32 v21, v21, v199, v200
  v_max3_f32 v21, v21, v201, v202
  v_max3_f32 v21, v21, v203, v204
  v_max3_f32 v21, v21, v205, v206
  v_max_f32 v21, v21, v207
  v_mov_b32 v1, v21
  s_nop 1
  v_permlane16_swap_b32 v1, v21
  v_max_f32 v21, v21, v1
  v_mov_b32 v1, v21
  s_nop 1
  v_permlane32_swap_b32 v1, v21
  v_max_f32 v21, v21, v1
  v_add_f32 v21, 0x40e00000, v21
  v_max_f32 v21, 0, v21
  v_sub_f32 v192, v192, v21
  v_sub_f32 v193, v193, v21
  v_sub_f32 v194, v194, v21
  v_sub_f32 v195, v195, v21
  v_sub_f32 v196, v196, v21
  v_sub_f32 v197, v197, v21
  v_sub_f32 v198, v198, v21
  v_sub_f32 v199, v199, v21
  v_sub_f32 v200, v200, v21
  v_sub_f32 v201, v201, v21
  v_sub_f32 v202, v202, v21
  v_sub_f32 v203, v203, v21
  v_sub_f32 v204, v204, v21
  v_sub_f32 v205, v205, v21
  v_sub_f32 v206, v206, v21
  v_sub_f32 v207, v207, v21
  v_sub_f32 v128, v128, v21
  v_sub_f32 v129, v129, v21
  v_sub_f32 v130, v130, v21
  v_sub_f32 v131, v131, v21
  v_sub_f32 v132, v132, v21
  v_sub_f32 v133, v133, v21
  v_sub_f32 v134, v134, v21
  v_sub_f32 v135, v135, v21
  v_sub_f32 v136, v136, v21
  v_sub_f32 v137, v137, v21
  v_sub_f32 v138, v138, v21
  v_sub_f32 v139, v139, v21
  v_sub_f32 v140, v140, v21
  v_sub_f32 v141, v141, v21
  v_sub_f32 v142, v142, v21
  v_sub_f32 v143, v143, v21
  v_sub_f32 v32, v32, v21
  v_sub_f32 v33, v33, v21
  v_sub_f32 v34, v34, v21
  v_sub_f32 v35, v35, v21
  v_exp_f32 v22, -v21
  s_nop 0
  v_mul_f32 v48, v48, v22
  v_mul_f32 v49, v49, v22
  v_mul_f32 v50, v50, v22
  v_mul_f32 v51, v51, v22
  v_accvgpr_read_b32 v8, a0
  v_accvgpr_read_b32 v9, a1
  v_accvgpr_read_b32 v10, a2
  v_accvgpr_read_b32 v11, a3
  v_accvgpr_read_b32 v12, a4
  v_accvgpr_read_b32 v13, a5
  v_accvgpr_read_b32 v14, a6
  v_accvgpr_read_b32 v15, a7
  v_mul_f32 v8, v8, v22
  v_mul_f32 v9, v9, v22
  v_mul_f32 v10, v10, v22
  v_mul_f32 v11, v11, v22
  v_mul_f32 v12, v12, v22
  v_mul_f32 v13, v13, v22
  v_mul_f32 v14, v14, v22
  v_mul_f32 v15, v15, v22
  v_accvgpr_write_b32 a0, v8
  v_accvgpr_write_b32 a1, v9
  v_accvgpr_write_b32 a2, v10
  v_accvgpr_write_b32 a3, v11
  v_accvgpr_write_b32 a4, v12
  v_accvgpr_write_b32 a5, v13
  v_accvgpr_write_b32 a6, v14
  v_accvgpr_write_b32 a7, v15
  v_accvgpr_read_b32 v8, a8
  v_accvgpr_read_b32 v9, a9
  v_accvgpr_read_b32 v10, a10
  v_accvgpr_read_b32 v11, a11
  v_accvgpr_read_b32 v12, a12
  v_accvgpr_read_b32 v13, a13
  v_accvgpr_read_b32 v14, a14
  v_accvgpr_read_b32 v15, a15
  v_mul_f32 v8, v8, v22
  v_mul_f32 v9, v9, v22
  v_mul_f32 v10, v10, v22
  v_mul_f32 v11, v11, v22
  v_mul_f32 v12, v12, v22
  v_mul_f32 v13, v13, v22
  v_mul_f32 v14, v14, v22
  v_mul_f32 v15, v15, v22
  v_accvgpr_write_b32 a8, v8
  v_accvgpr_write_b32 a9, v9
  v_accvgpr_write_b32 a10, v10
  v_accvgpr_write_b32 a11, v11
  v_accvgpr_write_b32 a12, v12
  v_accvgpr_write_b32 a13, v13
  v_accvgpr_write_b32 a14, v14
  v_accvgpr_write_b32 a15, v15
  v_accvgpr_read_b32 v8, a16
  v_accvgpr_read_b32 v9, a17
  v_accvgpr_read_b32 v10, a18
  v_accvgpr_read_b32 v11, a19
  v_accvgpr_read_b32 v12, a20
  v_accvgpr_read_b32 v13, a21
  v_accvgpr_read_b32 v14, a22
  v_accvgpr_read_b32 v15, a23
  v_mul_f32 v8, v8, v22
  v_mul_f32 v9, v9, v22
  v_mul_f32 v10, v10, v22
  v_mul_f32 v11, v11, v22
  v_mul_f32 v12, v12, v22
  v_mul_f32 v13, v13, v22
  v_mul_f32 v14, v14, v22
  v_mul_f32 v15, v15, v22
  v_accvgpr_write_b32 a16, v8
  v_accvgpr_write_b32 a17, v9
  v_accvgpr_write_b32 a18, v10
  v_accvgpr_write_b32 a19, v11
  v_accvgpr_write_b32 a20, v12
  v_accvgpr_write_b32 a21, v13
  v_accvgpr_write_b32 a22, v14
  v_accvgpr_write_b32 a23, v15
  v_accvgpr_read_b32 v8, a24
  v_accvgpr_read_b32 v9, a25
  v_accvgpr_read_b32 v10, a26
  v_accvgpr_read_b32 v11, a27
  v_accvgpr_read_b32 v12, a28
  v_accvgpr_read_b32 v13, a29
  v_accvgpr_read_b32 v14, a30
  v_accvgpr_read_b32 v15, a31
  v_mul_f32 v8, v8, v22
  v_mul_f32 v9, v9, v22
  v_mul_f32 v10, v10, v22
  v_mul_f32 v11, v11, v22
  v_mul_f32 v12, v12, v22
  v_mul_f32 v13, v13, v22
  v_mul_f32 v14, v14, v22
  v_mul_f32 v15, v15, v22
  v_accvgpr_write_b32 a24, v8
  v_accvgpr_write_b32 a25, v9
  v_accvgpr_write_b32 a26, v10
  v_accvgpr_write_b32 a27, v11
  v_accvgpr_write_b32 a28, v12
  v_accvgpr_write_b32 a29, v13
  v_accvgpr_write_b32 a30, v14
  v_accvgpr_write_b32 a31, v15
  v_max3_f32 v21, v208, v209, v210
  v_max3_f32 v21, v21, v211, v212
  v_max3_f32 v21, v21, v213, v214
  v_max3_f32 v21, v21, v215, v216
  v_max3_f32 v21, v21, v217, v218
  v_max3_f32 v21, v21, v219, v220
  v_max3_f32 v21, v21, v221, v222
  v_max_f32 v21, v21, v223
  v_mov_b32 v1, v21
  s_nop 1
  v_permlane16_swap_b32 v1, v21
  v_max_f32 v21, v21, v1
  v_mov_b32 v1, v21
  s_nop 1
  v_permlane32_swap_b32 v1, v21
  v_max_f32 v21, v21, v1
  v_add_f32 v21, 0x40e00000, v21
  v_max_f32 v21, 0, v21
  v_sub_f32 v208, v208, v21
  v_sub_f32 v209, v209, v21
  v_sub_f32 v210, v210, v21
  v_sub_f32 v211, v211, v21
  v_sub_f32 v212, v212, v21
  v_sub_f32 v213, v213, v21
  v_sub_f32 v214, v214, v21
  v_sub_f32 v215, v215, v21
  v_sub_f32 v216, v216, v21
  v_sub_f32 v217, v217, v21
  v_sub_f32 v218, v218, v21
  v_sub_f32 v219, v219, v21
  v_sub_f32 v220, v220, v21
  v_sub_f32 v221, v221, v21
  v_sub_f32 v222, v222, v21
  v_sub_f32 v223, v223, v21
  v_sub_f32 v144, v144, v21
  v_sub_f32 v145, v145, v21
  v_sub_f32 v146, v146, v21
  v_sub_f32 v147, v147, v21
  v_sub_f32 v148, v148, v21
  v_sub_f32 v149, v149, v21
  v_sub_f32 v150, v150, v21
  v_sub_f32 v151, v151, v21
  v_sub_f32 v152, v152, v21
  v_sub_f32 v153, v153, v21
  v_sub_f32 v154, v154, v21
  v_sub_f32 v155, v155, v21
  v_sub_f32 v156, v156, v21
  v_sub_f32 v157, v157, v21
  v_sub_f32 v158, v158, v21
  v_sub_f32 v159, v159, v21
  v_sub_f32 v36, v36, v21
  v_sub_f32 v37, v37, v21
  v_sub_f32 v38, v38, v21
  v_sub_f32 v39, v39, v21
  v_exp_f32 v22, -v21
  s_nop 0
  v_mul_f32 v52, v52, v22
  v_mul_f32 v53, v53, v22
  v_mul_f32 v54, v54, v22
  v_mul_f32 v55, v55, v22
  v_accvgpr_read_b32 v8, a32
  v_accvgpr_read_b32 v9, a33
  v_accvgpr_read_b32 v10, a34
  v_accvgpr_read_b32 v11, a35
  v_accvgpr_read_b32 v12, a36
  v_accvgpr_read_b32 v13, a37
  v_accvgpr_read_b32 v14, a38
  v_accvgpr_read_b32 v15, a39
  v_mul_f32 v8, v8, v22
  v_mul_f32 v9, v9, v22
  v_mul_f32 v10, v10, v22
  v_mul_f32 v11, v11, v22
  v_mul_f32 v12, v12, v22
  v_mul_f32 v13, v13, v22
  v_mul_f32 v14, v14, v22
  v_mul_f32 v15, v15, v22
  v_accvgpr_write_b32 a32, v8
  v_accvgpr_write_b32 a33, v9
  v_accvgpr_write_b32 a34, v10
  v_accvgpr_write_b32 a35, v11
  v_accvgpr_write_b32 a36, v12
  v_accvgpr_write_b32 a37, v13
  v_accvgpr_write_b32 a38, v14
  v_accvgpr_write_b32 a39, v15
  v_accvgpr_read_b32 v8, a40
  v_accvgpr_read_b32 v9, a41
  v_accvgpr_read_b32 v10, a42
  v_accvgpr_read_b32 v11, a43
  v_accvgpr_read_b32 v12, a44
  v_accvgpr_read_b32 v13, a45
  v_accvgpr_read_b32 v14, a46
  v_accvgpr_read_b32 v15, a47
  v_mul_f32 v8, v8, v22
  v_mul_f32 v9, v9, v22
  v_mul_f32 v10, v10, v22
  v_mul_f32 v11, v11, v22
  v_mul_f32 v12, v12, v22
  v_mul_f32 v13, v13, v22
  v_mul_f32 v14, v14, v22
  v_mul_f32 v15, v15, v22
  v_accvgpr_write_b32 a40, v8
  v_accvgpr_write_b32 a41, v9
  v_accvgpr_write_b32 a42, v10
  v_accvgpr_write_b32 a43, v11
  v_accvgpr_write_b32 a44, v12
  v_accvgpr_write_b32 a45, v13
  v_accvgpr_write_b32 a46, v14
  v_accvgpr_write_b32 a47, v15
  v_accvgpr_read_b32 v8, a48
  v_accvgpr_read_b32 v9, a49
  v_accvgpr_read_b32 v10, a50
  v_accvgpr_read_b32 v11, a51
  v_accvgpr_read_b32 v12, a52
  v_accvgpr_read_b32 v13, a53
  v_accvgpr_read_b32 v14, a54
  v_accvgpr_read_b32 v15, a55
  v_mul_f32 v8, v8, v22
  v_mul_f32 v9, v9, v22
  v_mul_f32 v10, v10, v22
  v_mul_f32 v11, v11, v22
  v_mul_f32 v12, v12, v22
  v_mul_f32 v13, v13, v22
  v_mul_f32 v14, v14, v22
  v_mul_f32 v15, v15, v22
  v_accvgpr_write_b32 a48, v8
  v_accvgpr_write_b32 a49, v9
  v_accvgpr_write_b32 a50, v10
  v_accvgpr_write_b32 a51, v11
  v_accvgpr_write_b32 a52, v12
  v_accvgpr_write_b32 a53, v13
  v_accvgpr_write_b32 a54, v14
  v_accvgpr_write_b32 a55, v15
  v_accvgpr_read_b32 v8, a56
  v_accvgpr_read_b32 v9, a57
  v_accvgpr_read_b32 v10, a58
  v_accvgpr_read_b32 v11, a59
  v_accvgpr_read_b32 v12, a60
  v_accvgpr_read_b32 v13, a61
  v_accvgpr_read_b32 v14, a62
  v_accvgpr_read_b32 v15, a63
  v_mul_f32 v8, v8, v22
  v_mul_f32 v9, v9, v22
  v_mul_f32 v10, v10, v22
  v_mul_f32 v11, v11, v22
  v_mul_f32 v12, v12, v22
  v_mul_f32 v13, v13, v22
  v_mul_f32 v14, v14, v22
  v_mul_f32 v15, v15, v22
  v_accvgpr_write_b32 a56, v8
  v_accvgpr_write_b32 a57, v9
  v_accvgpr_write_b32 a58, v10
  v_accvgpr_write_b32 a59, v11
  v_accvgpr_write_b32 a60, v12
  v_accvgpr_write_b32 a61, v13
  v_accvgpr_write_b32 a62, v14
  v_accvgpr_write_b32 a63, v15
  v_max3_f32 v21, v224, v225, v226
  v_max3_f32 v21, v21, v227, v228
  v_max3_f32 v21, v21, v229, v230
  v_max3_f32 v21, v21, v231, v232
  v_max3_f32 v21, v21, v233, v234
  v_max3_f32 v21, v21, v235, v236
  v_max3_f32 v21, v21, v237, v238
  v_max_f32 v21, v21, v239
  v_mov_b32 v1, v21
  s_nop 1
  v_permlane16_swap_b32 v1, v21
  v_max_f32 v21, v21, v1
  v_mov_b32 v1, v21
  s_nop 1
  v_permlane32_swap_b32 v1, v21
  v_max_f32 v21, v21, v1
  v_add_f32 v21, 0x40e00000, v21
  v_max_f32 v21, 0, v21
  v_sub_f32 v224, v224, v21
  v_sub_f32 v225, v225, v21
  v_sub_f32 v226, v226, v21
  v_sub_f32 v227, v227, v21
  v_sub_f32 v228, v228, v21
  v_sub_f32 v229, v229, v21
  v_sub_f32 v230, v230, v21
  v_sub_f32 v231, v231, v21
  v_sub_f32 v232, v232, v21
  v_sub_f32 v233, v233, v21
  v_sub_f32 v234, v234, v21
  v_sub_f32 v235, v235, v21
  v_sub_f32 v236, v236, v21
  v_sub_f32 v237, v237, v21
  v_sub_f32 v238, v238, v21
  v_sub_f32 v239, v239, v21
  v_sub_f32 v160, v160, v21
  v_sub_f32 v161, v161, v21
  v_sub_f32 v162, v162, v21
  v_sub_f32 v163, v163, v21
  v_sub_f32 v164, v164, v21
  v_sub_f32 v165, v165, v21
  v_sub_f32 v166, v166, v21
  v_sub_f32 v167, v167, v21
  v_sub_f32 v168, v168, v21
  v_sub_f32 v169, v169, v21
  v_sub_f32 v170, v170, v21
  v_sub_f32 v171, v171, v21
  v_sub_f32 v172, v172, v21
  v_sub_f32 v173, v173, v21
  v_sub_f32 v174, v174, v21
  v_sub_f32 v175, v175, v21
  v_sub_f32 v40, v40, v21
  v_sub_f32 v41, v41, v21
  v_sub_f32 v42, v42, v21
  v_sub_f32 v43, v43, v21
  v_exp_f32 v22, -v21
  s_nop 0
  v_mul_f32 v56, v56, v22
  v_mul_f32 v57, v57, v22
  v_mul_f32 v58, v58, v22
  v_mul_f32 v59, v59, v22
  v_accvgpr_read_b32 v8, a64
  v_accvgpr_read_b32 v9, a65
  v_accvgpr_read_b32 v10, a66
  v_accvgpr_read_b32 v11, a67
  v_accvgpr_read_b32 v12, a68
  v_accvgpr_read_b32 v13, a69
  v_accvgpr_read_b32 v14, a70
  v_accvgpr_read_b32 v15, a71
  v_mul_f32 v8, v8, v22
  v_mul_f32 v9, v9, v22
  v_mul_f32 v10, v10, v22
  v_mul_f32 v11, v11, v22
  v_mul_f32 v12, v12, v22
  v_mul_f32 v13, v13, v22
  v_mul_f32 v14, v14, v22
  v_mul_f32 v15, v15, v22
  v_accvgpr_write_b32 a64, v8
  v_accvgpr_write_b32 a65, v9
  v_accvgpr_write_b32 a66, v10
  v_accvgpr_write_b32 a67, v11
  v_accvgpr_write_b32 a68, v12
  v_accvgpr_write_b32 a69, v13
  v_accvgpr_write_b32 a70, v14
  v_accvgpr_write_b32 a71, v15
  v_accvgpr_read_b32 v8, a72
  v_accvgpr_read_b32 v9, a73
  v_accvgpr_read_b32 v10, a74
  v_accvgpr_read_b32 v11, a75
  v_accvgpr_read_b32 v12, a76
  v_accvgpr_read_b32 v13, a77
  v_accvgpr_read_b32 v14, a78
  v_accvgpr_read_b32 v15, a79
  v_mul_f32 v8, v8, v22
  v_mul_f32 v9, v9, v22
  v_mul_f32 v10, v10, v22
  v_mul_f32 v11, v11, v22
  v_mul_f32 v12, v12, v22
  v_mul_f32 v13, v13, v22
  v_mul_f32 v14, v14, v22
  v_mul_f32 v15, v15, v22
  v_accvgpr_write_b32 a72, v8
  v_accvgpr_write_b32 a73, v9
  v_accvgpr_write_b32 a74, v10
  v_accvgpr_write_b32 a75, v11
  v_accvgpr_write_b32 a76, v12
  v_accvgpr_write_b32 a77, v13
  v_accvgpr_write_b32 a78, v14
  v_accvgpr_write_b32 a79, v15
  v_accvgpr_read_b32 v8, a80
  v_accvgpr_read_b32 v9, a81
  v_accvgpr_read_b32 v10, a82
  v_accvgpr_read_b32 v11, a83
  v_accvgpr_read_b32 v12, a84
  v_accvgpr_read_b32 v13, a85
  v_accvgpr_read_b32 v14, a86
  v_accvgpr_read_b32 v15, a87
  v_mul_f32 v8, v8, v22
  v_mul_f32 v9, v9, v22
  v_mul_f32 v10, v10, v22
  v_mul_f32 v11, v11, v22
  v_mul_f32 v12, v12, v22
  v_mul_f32 v13, v13, v22
  v_mul_f32 v14, v14, v22
  v_mul_f32 v15, v15, v22
  v_accvgpr_write_b32 a80, v8
  v_accvgpr_write_b32 a81, v9
  v_accvgpr_write_b32 a82, v10
  v_accvgpr_write_b32 a83, v11
  v_accvgpr_write_b32 a84, v12
  v_accvgpr_write_b32 a85, v13
  v_accvgpr_write_b32 a86, v14
  v_accvgpr_write_b32 a87, v15
  v_accvgpr_read_b32 v8, a88
  v_accvgpr_read_b32 v9, a89
  v_accvgpr_read_b32 v10, a90
  v_accvgpr_read_b32 v11, a91
  v_accvgpr_read_b32 v12, a92
  v_accvgpr_read_b32 v13, a93
  v_accvgpr_read_b32 v14, a94
  v_accvgpr_read_b32 v15, a95
  v_mul_f32 v8, v8, v22
  v_mul_f32 v9, v9, v22
  v_mul_f32 v10, v10, v22
  v_mul_f32 v11, v11, v22
  v_mul_f32 v12, v12, v22
  v_mul_f32 v13, v13, v22
  v_mul_f32 v14, v14, v22
  v_mul_f32 v15, v15, v22
  v_accvgpr_write_b32 a88, v8
  v_accvgpr_write_b32 a89, v9
  v_accvgpr_write_b32 a90, v10
  v_accvgpr_write_b32 a91, v11
  v_accvgpr_write_b32 a92, v12
  v_accvgpr_write_b32 a93, v13
  v_accvgpr_write_b32 a94, v14
  v_accvgpr_write_b32 a95, v15
  v_max3_f32 v21, v240, v241, v242
  v_max3_f32 v21, v21, v243, v244
  v_max3_f32 v21, v21, v245, v246
  v_max3_f32 v21, v21, v247, v248
  v_max3_f32 v21, v21, v249, v250
  v_max3_f32 v21, v21, v251, v252
  v_max3_f32 v21, v21, v253, v254
  v_max_f32 v21, v21, v255
  v_mov_b32 v1, v21
  s_nop 1
  v_permlane16_swap_b32 v1, v21
  v_max_f32 v21, v21, v1
  v_mov_b32 v1, v21
  s_nop 1
  v_permlane32_swap_b32 v1, v21
  v_max_f32 v21, v21, v1
  v_add_f32 v21, 0x40e00000, v21
  v_max_f32 v21, 0, v21
  v_sub_f32 v240, v240, v21
  v_sub_f32 v241, v241, v21
  v_sub_f32 v242, v242, v21
  v_sub_f32 v243, v243, v21
  v_sub_f32 v244, v244, v21
  v_sub_f32 v245, v245, v21
  v_sub_f32 v246, v246, v21
  v_sub_f32 v247, v247, v21
  v_sub_f32 v248, v248, v21
  v_sub_f32 v249, v249, v21
  v_sub_f32 v250, v250, v21
  v_sub_f32 v251, v251, v21
  v_sub_f32 v252, v252, v21
  v_sub_f32 v253, v253, v21
  v_sub_f32 v254, v254, v21
  v_sub_f32 v255, v255, v21
  v_sub_f32 v176, v176, v21
  v_sub_f32 v177, v177, v21
  v_sub_f32 v178, v178, v21
  v_sub_f32 v179, v179, v21
  v_sub_f32 v180, v180, v21
  v_sub_f32 v181, v181, v21
  v_sub_f32 v182, v182, v21
  v_sub_f32 v183, v183, v21
  v_sub_f32 v184, v184, v21
  v_sub_f32 v185, v185, v21
  v_sub_f32 v186, v186, v21
  v_sub_f32 v187, v187, v21
  v_sub_f32 v188, v188, v21
  v_sub_f32 v189, v189, v21
  v_sub_f32 v190, v190, v21
  v_sub_f32 v191, v191, v21
  v_sub_f32 v44, v44, v21
  v_sub_f32 v45, v45, v21
  v_sub_f32 v46, v46, v21
  v_sub_f32 v47, v47, v21
  v_exp_f32 v22, -v21
  s_nop 0
  v_mul_f32 v60, v60, v22
  v_mul_f32 v61, v61, v22
  v_mul_f32 v62, v62, v22
  v_mul_f32 v63, v63, v22
  v_accvgpr_read_b32 v8, a96
  v_accvgpr_read_b32 v9, a97
  v_accvgpr_read_b32 v10, a98
  v_accvgpr_read_b32 v11, a99
  v_accvgpr_read_b32 v12, a100
  v_accvgpr_read_b32 v13, a101
  v_accvgpr_read_b32 v14, a102
  v_accvgpr_read_b32 v15, a103
  v_mul_f32 v8, v8, v22
  v_mul_f32 v9, v9, v22
  v_mul_f32 v10, v10, v22
  v_mul_f32 v11, v11, v22
  v_mul_f32 v12, v12, v22
  v_mul_f32 v13, v13, v22
  v_mul_f32 v14, v14, v22
  v_mul_f32 v15, v15, v22
  v_accvgpr_write_b32 a96, v8
  v_accvgpr_write_b32 a97, v9
  v_accvgpr_write_b32 a98, v10
  v_accvgpr_write_b32 a99, v11
  v_accvgpr_write_b32 a100, v12
  v_accvgpr_write_b32 a101, v13
  v_accvgpr_write_b32 a102, v14
  v_accvgpr_write_b32 a103, v15
  v_accvgpr_read_b32 v8, a104
  v_accvgpr_read_b32 v9, a105
  v_accvgpr_read_b32 v10, a106
  v_accvgpr_read_b32 v11, a107
  v_accvgpr_read_b32 v12, a108
  v_accvgpr_read_b32 v13, a109
  v_accvgpr_read_b32 v14, a110
  v_accvgpr_read_b32 v15, a111
  v_mul_f32 v8, v8, v22
  v_mul_f32 v9, v9, v22
  v_mul_f32 v10, v10, v22
  v_mul_f32 v11, v11, v22
  v_mul_f32 v12, v12, v22
  v_mul_f32 v13, v13, v22
  v_mul_f32 v14, v14, v22
  v_mul_f32 v15, v15, v22
  v_accvgpr_write_b32 a104, v8
  v_accvgpr_write_b32 a105, v9
  v_accvgpr_write_b32 a106, v10
  v_accvgpr_write_b32 a107, v11
  v_accvgpr_write_b32 a108, v12
  v_accvgpr_write_b32 a109, v13
  v_accvgpr_write_b32 a110, v14
  v_accvgpr_write_b32 a111, v15
  v_accvgpr_read_b32 v8, a112
  v_accvgpr_read_b32 v9, a113
  v_accvgpr_read_b32 v10, a114
  v_accvgpr_read_b32 v11, a115
  v_accvgpr_read_b32 v12, a116
  v_accvgpr_read_b32 v13, a117
  v_accvgpr_read_b32 v14, a118
  v_accvgpr_read_b32 v15, a119
  v_mul_f32 v8, v8, v22
  v_mul_f32 v9, v9, v22
  v_mul_f32 v10, v10, v22
  v_mul_f32 v11, v11, v22
  v_mul_f32 v12, v12, v22
  v_mul_f32 v13, v13, v22
  v_mul_f32 v14, v14, v22
  v_mul_f32 v15, v15, v22
  v_accvgpr_write_b32 a112, v8
  v_accvgpr_write_b32 a113, v9
  v_accvgpr_write_b32 a114, v10
  v_accvgpr_write_b32 a115, v11
  v_accvgpr_write_b32 a116, v12
  v_accvgpr_write_b32 a117, v13
  v_accvgpr_write_b32 a118, v14
  v_accvgpr_write_b32 a119, v15
  v_accvgpr_read_b32 v8, a120
  v_accvgpr_read_b32 v9, a121
  v_accvgpr_read_b32 v10, a122
  v_accvgpr_read_b32 v11, a123
  v_accvgpr_read_b32 v12, a124
  v_accvgpr_read_b32 v13, a125
  v_accvgpr_read_b32 v14, a126
  v_accvgpr_read_b32 v15, a127
  v_mul_f32 v8, v8, v22
  v_mul_f32 v9, v9, v22
  v_mul_f32 v10, v10, v22
  v_mul_f32 v11, v11, v22
  v_mul_f32 v12, v12, v22
  v_mul_f32 v13, v13, v22
  v_mul_f32 v14, v14, v22
  v_mul_f32 v15, v15, v22
  v_accvgpr_write_b32 a120, v8
  v_accvgpr_write_b32 a121, v9
  v_accvgpr_write_b32 a122, v10
  v_accvgpr_write_b32 a123, v11
  v_accvgpr_write_b32 a124, v12
  v_accvgpr_write_b32 a125, v13
  v_accvgpr_write_b32 a126, v14
  v_accvgpr_write_b32 a127, v15
  v_exp_f32 v8, v192
  v_exp_f32 v9, v193
  s_nop 0
  v_cvt_pk_bf16_f32 v96, v8, v9
  v_exp_f32 v8, v194
  v_exp_f32 v9, v195
  s_nop 0
  v_cvt_pk_bf16_f32 v97, v8, v9
  v_exp_f32 v8, v208
  v_exp_f32 v9, v209
  s_nop 0
  v_cvt_pk_bf16_f32 v104, v8, v9
  v_exp_f32 v8, v210
  v_exp_f32 v9, v211
  s_nop 0
  v_cvt_pk_bf16_f32 v105, v8, v9
  v_exp_f32 v8, v224
  v_exp_f32 v9, v225
  s_nop 0
  v_cvt_pk_bf16_f32 v112, v8, v9
  v_exp_f32 v8, v226
  v_exp_f32 v9, v227
  s_nop 0
  v_cvt_pk_bf16_f32 v113, v8, v9
  v_exp_f32 v8, v240
  v_exp_f32 v9, v241
  s_nop 0
  v_cvt_pk_bf16_f32 v120, v8, v9
  v_exp_f32 v8, v242
  v_exp_f32 v9, v243
  s_nop 0
  v_cvt_pk_bf16_f32 v121, v8, v9
  v_exp_f32 v8, v196
  v_exp_f32 v9, v197
  s_nop 0
  v_cvt_pk_bf16_f32 v98, v8, v9
  v_exp_f32 v8, v198
  v_exp_f32 v9, v199
  s_nop 0
  v_cvt_pk_bf16_f32 v99, v8, v9
  v_exp_f32 v8, v212
  v_exp_f32 v9, v213
  s_nop 0
  v_cvt_pk_bf16_f32 v106, v8, v9
  v_exp_f32 v8, v214
  v_exp_f32 v9, v215
  s_nop 0
  v_cvt_pk_bf16_f32 v107, v8, v9
  v_exp_f32 v8, v228
  v_exp_f32 v9, v229
  s_nop 0
  v_cvt_pk_bf16_f32 v114, v8, v9
  v_exp_f32 v8, v230
  v_exp_f32 v9, v231
  s_nop 0
  v_cvt_pk_bf16_f32 v115, v8, v9
  v_exp_f32 v8, v244
  v_exp_f32 v9, v245
  s_nop 0
  v_cvt_pk_bf16_f32 v122, v8, v9
  v_exp_f32 v8, v246
  v_exp_f32 v9, v247
  s_nop 0
  v_cvt_pk_bf16_f32 v123, v8, v9
  v_exp_f32 v8, v200
  v_exp_f32 v9, v201
  s_nop 0
  v_cvt_pk_bf16_f32 v100, v8, v9
  v_exp_f32 v8, v202
  v_exp_f32 v9, v203
  s_nop 0
  v_cvt_pk_bf16_f32 v101, v8, v9
  v_exp_f32 v8, v216
  v_exp_f32 v9, v217
  s_nop 0
  v_cvt_pk_bf16_f32 v108, v8, v9
  v_exp_f32 v8, v218
  v_exp_f32 v9, v219
  s_nop 0
  v_cvt_pk_bf16_f32 v109, v8, v9
  v_exp_f32 v8, v232
  v_exp_f32 v9, v233
  s_nop 0
  v_cvt_pk_bf16_f32 v116, v8, v9
  v_exp_f32 v8, v234
  v_exp_f32 v9, v235
  s_nop 0
  v_cvt_pk_bf16_f32 v117, v8, v9
  v_exp_f32 v8, v248
  v_exp_f32 v9, v249
  s_nop 0
  v_cvt_pk_bf16_f32 v124, v8, v9
  v_exp_f32 v8, v250
  v_exp_f32 v9, v251
  s_nop 0
  v_cvt_pk_bf16_f32 v125, v8, v9
  v_exp_f32 v8, v204
  v_exp_f32 v9, v205
  s_nop 0
  v_cvt_pk_bf16_f32 v102, v8, v9
  v_exp_f32 v8, v206
  v_exp_f32 v9, v207
  s_nop 0
  v_cvt_pk_bf16_f32 v103, v8, v9
  v_exp_f32 v8, v220
  v_exp_f32 v9, v221
  s_nop 0
  v_cvt_pk_bf16_f32 v110, v8, v9
  v_exp_f32 v8, v222
  v_exp_f32 v9, v223
  s_nop 0
  v_cvt_pk_bf16_f32 v111, v8, v9
  v_exp_f32 v8, v236
  v_exp_f32 v9, v237
  s_nop 0
  v_cvt_pk_bf16_f32 v118, v8, v9
  v_exp_f32 v8, v238
  v_exp_f32 v9, v239
  s_nop 0
  v_cvt_pk_bf16_f32 v119, v8, v9
  v_exp_f32 v8, v252
  v_exp_f32 v9, v253
  s_nop 0
  v_cvt_pk_bf16_f32 v126, v8, v9
  v_exp_f32 v8, v254
  v_exp_f32 v9, v255
  s_nop 0
  v_cvt_pk_bf16_f32 v127, v8, v9
  s_nop 1
  s_branch L_k2_fbr_wo
L_k2_mk_wo:
  s_nop 7
  s_add_u32 s3, s37, 1
  s_lshl_b32 s3, s3, 6
  v_subrev_u32 v1, s3, v6
  v_cmp_gt_i32 s[56:57], -16, v1
  v_cmp_gt_i32 s[58:59], -15, v1
  v_cmp_gt_i32 s[60:61], -14, v1
  v_cmp_gt_i32 s[62:63], -13, v1
  v_cndmask_b32 v176, v176, v20, s[56:57]
  v_cndmask_b32 v177, v177, v20, s[58:59]
  v_cndmask_b32 v178, v178, v20, s[60:61]
  v_cndmask_b32 v179, v179, v20, s[62:63]
  v_cmp_gt_i32 s[56:57], 0, v1
  v_cmp_gt_i32 s[58:59], 1, v1
  v_cmp_gt_i32 s[60:61], 2, v1
  v_cmp_gt_i32 s[62:63], 3, v1
  v_cndmask_b32 v160, v160, v20, s[56:57]
  v_cndmask_b32 v161, v161, v20, s[58:59]
  v_cndmask_b32 v162, v162, v20, s[60:61]
  v_cndmask_b32 v163, v163, v20, s[62:63]
  v_cndmask_b32 v180, v180, v20, s[56:57]
  v_cndmask_b32 v181, v181, v20, s[58:59]
  v_cndmask_b32 v182, v182, v20, s[60:61]
  v_cndmask_b32 v183, v183, v20, s[62:63]
  v_cmp_gt_i32 s[56:57], 16, v1
  v_cmp_gt_i32 s[58:59], 17, v1
  v_cmp_gt_i32 s[60:61], 18, v1
  v_cmp_gt_i32 s[62:63], 19, v1
  v_cndmask_b32 v164, v164, v20, s[56:57]
  v_cndmask_b32 v165, v165, v20, s[58:59]
  v_cndmask_b32 v166, v166, v20, s[60:61]
  v_cndmask_b32 v167, v167, v20, s[62:63]
  v_cndmask_b32 v184, v184, v20, s[56:57]
  v_cndmask_b32 v185, v185, v20, s[58:59]
  v_cndmask_b32 v186, v186, v20, s[60:61]
  v_cndmask_b32 v187, v187, v20, s[62:63]
  v_cmp_gt_i32 s[56:57], 32, v1
  v_cmp_gt_i32 s[58:59], 33, v1
  v_cmp_gt_i32 s[60:61], 34, v1
  v_cmp_gt_i32 s[62:63], 35, v1
  v_cndmask_b32 v168, v168, v20, s[56:57]
  v_cndmask_b32 v169, v169, v20, s[58:59]
  v_cndmask_b32 v170, v170, v20, s[60:61]
  v_cndmask_b32 v171, v171, v20, s[62:63]
  v_cndmask_b32 v188, v188, v20, s[56:57]
  v_cndmask_b32 v189, v189, v20, s[58:59]
  v_cndmask_b32 v190, v190, v20, s[60:61]
  v_cndmask_b32 v191, v191, v20, s[62:63]
  v_cmp_gt_i32 s[56:57], 48, v1
  v_cmp_gt_i32 s[58:59], 49, v1
  v_cmp_gt_i32 s[60:61], 50, v1
  v_cmp_gt_i32 s[62:63], 51, v1
  v_cndmask_b32 v172, v172, v20, s[56:57]
  v_cndmask_b32 v173, v173, v20, s[58:59]
  v_cndmask_b32 v174, v174, v20, s[60:61]
  v_cndmask_b32 v175, v175, v20, s[62:63]
  s_nop 1
  s_branch L_k2_mkr_wo
L_k2_fb_tr:
  s_nop 7
  v_max3_f32 v21, v192, v193, v194
  v_max3_f32 v21, v21, v195, v196
  v_max3_f32 v21, v21, v197, v198
  v_max3_f32 v21, v21, v199, v200
  v_max3_f32 v21, v21, v201, v202
  v_max3_f32 v21, v21, v203, v204
  v_max3_f32 v21, v21, v205, v206
  v_max_f32 v21, v21, v207
  v_mov_b32 v1, v21
  s_nop 1
  v_permlane16_swap_b32 v1, v21
  v_max_f32 v21, v21, v1
  v_mov_b32 v1, v21
  s_nop 1
  v_permlane32_swap_b32 v1, v21
  v_max_f32 v21, v21, v1
  v_add_f32 v21, 0x40e00000, v21
  v_max_f32 v21, 0, v21
  v_sub_f32 v192, v192, v21
  v_sub_f32 v193, v193, v21
  v_sub_f32 v194, v194, v21
  v_sub_f32 v195, v195, v21
  v_sub_f32 v196, v196, v21
  v_sub_f32 v197, v197, v21
  v_sub_f32 v198, v198, v21
  v_sub_f32 v199, v199, v21
  v_sub_f32 v200, v200, v21
  v_sub_f32 v201, v201, v21
  v_sub_f32 v202, v202, v21
  v_sub_f32 v203, v203, v21
  v_sub_f32 v204, v204, v21
  v_sub_f32 v205, v205, v21
  v_sub_f32 v206, v206, v21
  v_sub_f32 v207, v207, v21
  v_sub_f32 v128, v128, v21
  v_sub_f32 v129, v129, v21
  v_sub_f32 v130, v130, v21
  v_sub_f32 v131, v131, v21
  v_sub_f32 v132, v132, v21
  v_sub_f32 v133, v133, v21
  v_sub_f32 v134, v134, v21
  v_sub_f32 v135, v135, v21
  v_sub_f32 v136, v136, v21
  v_sub_f32 v137, v137, v21
  v_sub_f32 v138, v138, v21
  v_sub_f32 v139, v139, v21
  v_sub_f32 v140, v140, v21
  v_sub_f32 v141, v141, v21
  v_sub_f32 v142, v142, v21
  v_sub_f32 v143, v143, v21
  v_sub_f32 v32, v32, v21
  v_sub_f32 v33, v33, v21
  v_sub_f32 v34, v34, v21
  v_sub_f32 v35, v35, v21
  v_exp_f32 v22, -v21
  s_nop 0
  v_mul_f32 v48, v48, v22
  v_mul_f32 v49, v49, v22
  v_mul_f32 v50, v50, v22
  v_mul_f32 v51, v51, v22
  v_accvgpr_read_b32 v8, a0
  v_accvgpr_read_b32 v9, a1
  v_accvgpr_read_b32 v10, a2
  v_accvgpr_read_b32 v11, a3
  v_accvgpr_read_b32 v12, a4
  v_accvgpr_read_b32 v13, a5
  v_accvgpr_read_b32 v14, a6
  v_accvgpr_read_b32 v15, a7
  v_mul_f32 v8, v8, v22
  v_mul_f32 v9, v9, v22
  v_mul_f32 v10, v10, v22
  v_mul_f32 v11, v11, v22
  v_mul_f32 v12, v12, v22
  v_mul_f32 v13, v13, v22
  v_mul_f32 v14, v14, v22
  v_mul_f32 v15, v15, v22
  v_accvgpr_write_b32 a0, v8
  v_accvgpr_write_b32 a1, v9
  v_accvgpr_write_b32 a2, v10
  v_accvgpr_write_b32 a3, v11
  v_accvgpr_write_b32 a4, v12
  v_accvgpr_write_b32 a5, v13
  v_accvgpr_write_b32 a6, v14
  v_accvgpr_write_b32 a7, v15
  v_accvgpr_read_b32 v8, a8
  v_accvgpr_read_b32 v9, a9
  v_accvgpr_read_b32 v10, a10
  v_accvgpr_read_b32 v11, a11
  v_accvgpr_read_b32 v12, a12
  v_accvgpr_read_b32 v13, a13
  v_accvgpr_read_b32 v14, a14
  v_accvgpr_read_b32 v15, a15
  v_mul_f32 v8, v8, v22
  v_mul_f32 v9, v9, v22
  v_mul_f32 v10, v10, v22
  v_mul_f32 v11, v11, v22
  v_mul_f32 v12, v12, v22
  v_mul_f32 v13, v13, v22
  v_mul_f32 v14, v14, v22
  v_mul_f32 v15, v15, v22
  v_accvgpr_write_b32 a8, v8
  v_accvgpr_write_b32 a9, v9
  v_accvgpr_write_b32 a10, v10
  v_accvgpr_write_b32 a11, v11
  v_accvgpr_write_b32 a12, v12
  v_accvgpr_write_b32 a13, v13
  v_accvgpr_write_b32 a14, v14
  v_accvgpr_write_b32 a15, v15
  v_accvgpr_read_b32 v8, a16
  v_accvgpr_read_b32 v9, a17
  v_accvgpr_read_b32 v10, a18
  v_accvgpr_read_b32 v11, a19
  v_accvgpr_read_b32 v12, a20
  v_accvgpr_read_b32 v13, a21
  v_accvgpr_read_b32 v14, a22
  v_accvgpr_read_b32 v15, a23
  v_mul_f32 v8, v8, v22
  v_mul_f32 v9, v9, v22
  v_mul_f32 v10, v10, v22
  v_mul_f32 v11, v11, v22
  v_mul_f32 v12, v12, v22
  v_mul_f32 v13, v13, v22
  v_mul_f32 v14, v14, v22
  v_mul_f32 v15, v15, v22
  v_accvgpr_write_b32 a16, v8
  v_accvgpr_write_b32 a17, v9
  v_accvgpr_write_b32 a18, v10
  v_accvgpr_write_b32 a19, v11
  v_accvgpr_write_b32 a20, v12
  v_accvgpr_write_b32 a21, v13
  v_accvgpr_write_b32 a22, v14
  v_accvgpr_write_b32 a23, v15
  v_accvgpr_read_b32 v8, a24
  v_accvgpr_read_b32 v9, a25
  v_accvgpr_read_b32 v10, a26
  v_accvgpr_read_b32 v11, a27
  v_accvgpr_read_b32 v12, a28
  v_accvgpr_read_b32 v13, a29
  v_accvgpr_read_b32 v14, a30
  v_accvgpr_read_b32 v15, a31
  v_mul_f32 v8, v8, v22
  v_mul_f32 v9, v9, v22
  v_mul_f32 v10, v10, v22
  v_mul_f32 v11, v11, v22
  v_mul_f32 v12, v12, v22
  v_mul_f32 v13, v13, v22
  v_mul_f32 v14, v14, v22
  v_mul_f32 v15, v15, v22
  v_accvgpr_write_b32 a24, v8
  v_accvgpr_write_b32 a25, v9
  v_accvgpr_write_b32 a26, v10
  v_accvgpr_write_b32 a27, v11
  v_accvgpr_write_b32 a28, v12
  v_accvgpr_write_b32 a29, v13
  v_accvgpr_write_b32 a30, v14
  v_accvgpr_write_b32 a31, v15
  v_max3_f32 v21, v208, v209, v210
  v_max3_f32 v21, v21, v211, v212
  v_max3_f32 v21, v21, v213, v214
  v_max3_f32 v21, v21, v215, v216
  v_max3_f32 v21, v21, v217, v218
  v_max3_f32 v21, v21, v219, v220
  v_max3_f32 v21, v21, v221, v222
  v_max_f32 v21, v21, v223
  v_mov_b32 v1, v21
  s_nop 1
  v_permlane16_swap_b32 v1, v21
  v_max_f32 v21, v21, v1
  v_mov_b32 v1, v21
  s_nop 1
  v_permlane32_swap_b32 v1, v21
  v_max_f32 v21, v21, v1
  v_add_f32 v21, 0x40e00000, v21
  v_max_f32 v21, 0, v21
  v_sub_f32 v208, v208, v21
  v_sub_f32 v209, v209, v21
  v_sub_f32 v210, v210, v21
  v_sub_f32 v211, v211, v21
  v_sub_f32 v212, v212, v21
  v_sub_f32 v213, v213, v21
  v_sub_f32 v214, v214, v21
  v_sub_f32 v215, v215, v21
  v_sub_f32 v216, v216, v21
  v_sub_f32 v217, v217, v21
  v_sub_f32 v218, v218, v21
  v_sub_f32 v219, v219, v21
  v_sub_f32 v220, v220, v21
  v_sub_f32 v221, v221, v21
  v_sub_f32 v222, v222, v21
  v_sub_f32 v223, v223, v21
  v_sub_f32 v144, v144, v21
  v_sub_f32 v145, v145, v21
  v_sub_f32 v146, v146, v21
  v_sub_f32 v147, v147, v21
  v_sub_f32 v148, v148, v21
  v_sub_f32 v149, v149, v21
  v_sub_f32 v150, v150, v21
  v_sub_f32 v151, v151, v21
  v_sub_f32 v152, v152, v21
  v_sub_f32 v153, v153, v21
  v_sub_f32 v154, v154, v21
  v_sub_f32 v155, v155, v21
  v_sub_f32 v156, v156, v21
  v_sub_f32 v157, v157, v21
  v_sub_f32 v158, v158, v21
  v_sub_f32 v159, v159, v21
  v_sub_f32 v36, v36, v21
  v_sub_f32 v37, v37, v21
  v_sub_f32 v38, v38, v21
  v_sub_f32 v39, v39, v21
  v_exp_f32 v22, -v21
  s_nop 0
  v_mul_f32 v52, v52, v22
  v_mul_f32 v53, v53, v22
  v_mul_f32 v54, v54, v22
  v_mul_f32 v55, v55, v22
  v_accvgpr_read_b32 v8, a32
  v_accvgpr_read_b32 v9, a33
  v_accvgpr_read_b32 v10, a34
  v_accvgpr_read_b32 v11, a35
  v_accvgpr_read_b32 v12, a36
  v_accvgpr_read_b32 v13, a37
  v_accvgpr_read_b32 v14, a38
  v_accvgpr_read_b32 v15, a39
  v_mul_f32 v8, v8, v22
  v_mul_f32 v9, v9, v22
  v_mul_f32 v10, v10, v22
  v_mul_f32 v11, v11, v22
  v_mul_f32 v12, v12, v22
  v_mul_f32 v13, v13, v22
  v_mul_f32 v14, v14, v22
  v_mul_f32 v15, v15, v22
  v_accvgpr_write_b32 a32, v8
  v_accvgpr_write_b32 a33, v9
  v_accvgpr_write_b32 a34, v10
  v_accvgpr_write_b32 a35, v11
  v_accvgpr_write_b32 a36, v12
  v_accvgpr_write_b32 a37, v13
  v_accvgpr_write_b32 a38, v14
  v_accvgpr_write_b32 a39, v15
  v_accvgpr_read_b32 v8, a40
  v_accvgpr_read_b32 v9, a41
  v_accvgpr_read_b32 v10, a42
  v_accvgpr_read_b32 v11, a43
  v_accvgpr_read_b32 v12, a44
  v_accvgpr_read_b32 v13, a45
  v_accvgpr_read_b32 v14, a46
  v_accvgpr_read_b32 v15, a47
  v_mul_f32 v8, v8, v22
  v_mul_f32 v9, v9, v22
  v_mul_f32 v10, v10, v22
  v_mul_f32 v11, v11, v22
  v_mul_f32 v12, v12, v22
  v_mul_f32 v13, v13, v22
  v_mul_f32 v14, v14, v22
  v_mul_f32 v15, v15, v22
  v_accvgpr_write_b32 a40, v8
  v_accvgpr_write_b32 a41, v9
  v_accvgpr_write_b32 a42, v10
  v_accvgpr_write_b32 a43, v11
  v_accvgpr_write_b32 a44, v12
  v_accvgpr_write_b32 a45, v13
  v_accvgpr_write_b32 a46, v14
  v_accvgpr_write_b32 a47, v15
  v_accvgpr_read_b32 v8, a48
  v_accvgpr_read_b32 v9, a49
  v_accvgpr_read_b32 v10, a50
  v_accvgpr_read_b32 v11, a51
  v_accvgpr_read_b32 v12, a52
  v_accvgpr_read_b32 v13, a53
  v_accvgpr_read_b32 v14, a54
  v_accvgpr_read_b32 v15, a55
  v_mul_f32 v8, v8, v22
  v_mul_f32 v9, v9, v22
  v_mul_f32 v10, v10, v22
  v_mul_f32 v11, v11, v22
  v_mul_f32 v12, v12, v22
  v_mul_f32 v13, v13, v22
  v_mul_f32 v14, v14, v22
  v_mul_f32 v15, v15, v22
  v_accvgpr_write_b32 a48, v8
  v_accvgpr_write_b32 a49, v9
  v_accvgpr_write_b32 a50, v10
  v_accvgpr_write_b32 a51, v11
  v_accvgpr_write_b32 a52, v12
  v_accvgpr_write_b32 a53, v13
  v_accvgpr_write_b32 a54, v14
  v_accvgpr_write_b32 a55, v15
  v_accvgpr_read_b32 v8, a56
  v_accvgpr_read_b32 v9, a57
  v_accvgpr_read_b32 v10, a58
  v_accvgpr_read_b32 v11, a59
  v_accvgpr_read_b32 v12, a60
  v_accvgpr_read_b32 v13, a61
  v_accvgpr_read_b32 v14, a62
  v_accvgpr_read_b32 v15, a63
  v_mul_f32 v8, v8, v22
  v_mul_f32 v9, v9, v22
  v_mul_f32 v10, v10, v22
  v_mul_f32 v11, v11, v22
  v_mul_f32 v12, v12, v22
  v_mul_f32 v13, v13, v22
  v_mul_f32 v14, v14, v22
  v_mul_f32 v15, v15, v22
  v_accvgpr_write_b32 a56, v8
  v_accvgpr_write_b32 a57, v9
  v_accvgpr_write_b32 a58, v10
  v_accvgpr_write_b32 a59, v11
  v_accvgpr_write_b32 a60, v12
  v_accvgpr_write_b32 a61, v13
  v_accvgpr_write_b32 a62, v14
  v_accvgpr_write_b32 a63, v15
  v_max3_f32 v21, v224, v225, v226
  v_max3_f32 v21, v21, v227, v228
  v_max3_f32 v21, v21, v229, v230
  v_max3_f32 v21, v21, v231, v232
  v_max3_f32 v21, v21, v233, v234
  v_max3_f32 v21, v21, v235, v236
  v_max3_f32 v21, v21, v237, v238
  v_max_f32 v21, v21, v239
  v_mov_b32 v1, v21
  s_nop 1
  v_permlane16_swap_b32 v1, v21
  v_max_f32 v21, v21, v1
  v_mov_b32 v1, v21
  s_nop 1
  v_permlane32_swap_b32 v1, v21
  v_max_f32 v21, v21, v1
  v_add_f32 v21, 0x40e00000, v21
  v_max_f32 v21, 0, v21
  v_sub_f32 v224, v224, v21
  v_sub_f32 v225, v225, v21
  v_sub_f32 v226, v226, v21
  v_sub_f32 v227, v227, v21
  v_sub_f32 v228, v228, v21
  v_sub_f32 v229, v229, v21
  v_sub_f32 v230, v230, v21
  v_sub_f32 v231, v231, v21
  v_sub_f32 v232, v232, v21
  v_sub_f32 v233, v233, v21
  v_sub_f32 v234, v234, v21
  v_sub_f32 v235, v235, v21
  v_sub_f32 v236, v236, v21
  v_sub_f32 v237, v237, v21
  v_sub_f32 v238, v238, v21
  v_sub_f32 v239, v239, v21
  v_sub_f32 v40, v40, v21
  v_sub_f32 v41, v41, v21
  v_sub_f32 v42, v42, v21
  v_sub_f32 v43, v43, v21
  v_exp_f32 v22, -v21
  s_nop 0
  v_mul_f32 v56, v56, v22
  v_mul_f32 v57, v57, v22
  v_mul_f32 v58, v58, v22
  v_mul_f32 v59, v59, v22
  v_accvgpr_read_b32 v8, a64
  v_accvgpr_read_b32 v9, a65
  v_accvgpr_read_b32 v10, a66
  v_accvgpr_read_b32 v11, a67
  v_accvgpr_read_b32 v12, a68
  v_accvgpr_read_b32 v13, a69
  v_accvgpr_read_b32 v14, a70
  v_accvgpr_read_b32 v15, a71
  v_mul_f32 v8, v8, v22
  v_mul_f32 v9, v9, v22
  v_mul_f32 v10, v10, v22
  v_mul_f32 v11, v11, v22
  v_mul_f32 v12, v12, v22
  v_mul_f32 v13, v13, v22
  v_mul_f32 v14, v14, v22
  v_mul_f32 v15, v15, v22
  v_accvgpr_write_b32 a64, v8
  v_accvgpr_write_b32 a65, v9
  v_accvgpr_write_b32 a66, v10
  v_accvgpr_write_b32 a67, v11
  v_accvgpr_write_b32 a68, v12
  v_accvgpr_write_b32 a69, v13
  v_accvgpr_write_b32 a70, v14
  v_accvgpr_write_b32 a71, v15
  v_accvgpr_read_b32 v8, a72
  v_accvgpr_read_b32 v9, a73
  v_accvgpr_read_b32 v10, a74
  v_accvgpr_read_b32 v11, a75
  v_accvgpr_read_b32 v12, a76
  v_accvgpr_read_b32 v13, a77
  v_accvgpr_read_b32 v14, a78
  v_accvgpr_read_b32 v15, a79
  v_mul_f32 v8, v8, v22
  v_mul_f32 v9, v9, v22
  v_mul_f32 v10, v10, v22
  v_mul_f32 v11, v11, v22
  v_mul_f32 v12, v12, v22
  v_mul_f32 v13, v13, v22
  v_mul_f32 v14, v14, v22
  v_mul_f32 v15, v15, v22
  v_accvgpr_write_b32 a72, v8
  v_accvgpr_write_b32 a73, v9
  v_accvgpr_write_b32 a74, v10
  v_accvgpr_write_b32 a75, v11
  v_accvgpr_write_b32 a76, v12
  v_accvgpr_write_b32 a77, v13
  v_accvgpr_write_b32 a78, v14
  v_accvgpr_write_b32 a79, v15
  v_accvgpr_read_b32 v8, a80
  v_accvgpr_read_b32 v9, a81
  v_accvgpr_read_b32 v10, a82
  v_accvgpr_read_b32 v11, a83
  v_accvgpr_read_b32 v12, a84
  v_accvgpr_read_b32 v13, a85
  v_accvgpr_read_b32 v14, a86
  v_accvgpr_read_b32 v15, a87
  v_mul_f32 v8, v8, v22
  v_mul_f32 v9, v9, v22
  v_mul_f32 v10, v10, v22
  v_mul_f32 v11, v11, v22
  v_mul_f32 v12, v12, v22
  v_mul_f32 v13, v13, v22
  v_mul_f32 v14, v14, v22
  v_mul_f32 v15, v15, v22
  v_accvgpr_write_b32 a80, v8
  v_accvgpr_write_b32 a81, v9
  v_accvgpr_write_b32 a82, v10
  v_accvgpr_write_b32 a83, v11
  v_accvgpr_write_b32 a84, v12
  v_accvgpr_write_b32 a85, v13
  v_accvgpr_write_b32 a86, v14
  v_accvgpr_write_b32 a87, v15
  v_accvgpr_read_b32 v8, a88
  v_accvgpr_read_b32 v9, a89
  v_accvgpr_read_b32 v10, a90
  v_accvgpr_read_b32 v11, a91
  v_accvgpr_read_b32 v12, a92
  v_accvgpr_read_b32 v13, a93
  v_accvgpr_read_b32 v14, a94
  v_accvgpr_read_b32 v15, a95
  v_mul_f32 v8, v8, v22
  v_mul_f32 v9, v9, v22
  v_mul_f32 v10, v10, v22
  v_mul_f32 v11, v11, v22
  v_mul_f32 v12, v12, v22
  v_mul_f32 v13, v13, v22
  v_mul_f32 v14, v14, v22
  v_mul_f32 v15, v15, v22
  v_accvgpr_write_b32 a88, v8
  v_accvgpr_write_b32 a89, v9
  v_accvgpr_write_b32 a90, v10
  v_accvgpr_write_b32 a91, v11
  v_accvgpr_write_b32 a92, v12
  v_accvgpr_write_b32 a93, v13
  v_accvgpr_write_b32 a94, v14
  v_accvgpr_write_b32 a95, v15
  v_max3_f32 v21, v240, v241, v242
  v_max3_f32 v21, v21, v243, v244
  v_max3_f32 v21, v21, v245, v246
  v_max3_f32 v21, v21, v247, v248
  v_max3_f32 v21, v21, v249, v250
  v_max3_f32 v21, v21, v251, v252
  v_max3_f32 v21, v21, v253, v254
  v_max_f32 v21, v21, v255
  v_mov_b32 v1, v21
  s_nop 1
  v_permlane16_swap_b32 v1, v21
  v_max_f32 v21, v21, v1
  v_mov_b32 v1, v21
  s_nop 1
  v_permlane32_swap_b32 v1, v21
  v_max_f32 v21, v21, v1
  v_add_f32 v21, 0x40e00000, v21
  v_max_f32 v21, 0, v21
  v_sub_f32 v240, v240, v21
  v_sub_f32 v241, v241, v21
  v_sub_f32 v242, v242, v21
  v_sub_f32 v243, v243, v21
  v_sub_f32 v244, v244, v21
  v_sub_f32 v245, v245, v21
  v_sub_f32 v246, v246, v21
  v_sub_f32 v247, v247, v21
  v_sub_f32 v248, v248, v21
  v_sub_f32 v249, v249, v21
  v_sub_f32 v250, v250, v21
  v_sub_f32 v251, v251, v21
  v_sub_f32 v252, v252, v21
  v_sub_f32 v253, v253, v21
  v_sub_f32 v254, v254, v21
  v_sub_f32 v255, v255, v21
  v_sub_f32 v44, v44, v21
  v_sub_f32 v45, v45, v21
  v_sub_f32 v46, v46, v21
  v_sub_f32 v47, v47, v21
  v_exp_f32 v22, -v21
  s_nop 0
  v_mul_f32 v60, v60, v22
  v_mul_f32 v61, v61, v22
  v_mul_f32 v62, v62, v22
  v_mul_f32 v63, v63, v22
  v_accvgpr_read_b32 v8, a96
  v_accvgpr_read_b32 v9, a97
  v_accvgpr_read_b32 v10, a98
  v_accvgpr_read_b32 v11, a99
  v_accvgpr_read_b32 v12, a100
  v_accvgpr_read_b32 v13, a101
  v_accvgpr_read_b32 v14, a102
  v_accvgpr_read_b32 v15, a103
  v_mul_f32 v8, v8, v22
  v_mul_f32 v9, v9, v22
  v_mul_f32 v10, v10, v22
  v_mul_f32 v11, v11, v22
  v_mul_f32 v12, v12, v22
  v_mul_f32 v13, v13, v22
  v_mul_f32 v14, v14, v22
  v_mul_f32 v15, v15, v22
  v_accvgpr_write_b32 a96, v8
  v_accvgpr_write_b32 a97, v9
  v_accvgpr_write_b32 a98, v10
  v_accvgpr_write_b32 a99, v11
  v_accvgpr_write_b32 a100, v12
  v_accvgpr_write_b32 a101, v13
  v_accvgpr_write_b32 a102, v14
  v_accvgpr_write_b32 a103, v15
  v_accvgpr_read_b32 v8, a104
  v_accvgpr_read_b32 v9, a105
  v_accvgpr_read_b32 v10, a106
  v_accvgpr_read_b32 v11, a107
  v_accvgpr_read_b32 v12, a108
  v_accvgpr_read_b32 v13, a109
  v_accvgpr_read_b32 v14, a110
  v_accvgpr_read_b32 v15, a111
  v_mul_f32 v8, v8, v22
  v_mul_f32 v9, v9, v22
  v_mul_f32 v10, v10, v22
  v_mul_f32 v11, v11, v22
  v_mul_f32 v12, v12, v22
  v_mul_f32 v13, v13, v22
  v_mul_f32 v14, v14, v22
  v_mul_f32 v15, v15, v22
  v_accvgpr_write_b32 a104, v8
  v_accvgpr_write_b32 a105, v9
  v_accvgpr_write_b32 a106, v10
  v_accvgpr_write_b32 a107, v11
  v_accvgpr_write_b32 a108, v12
  v_accvgpr_write_b32 a109, v13
  v_accvgpr_write_b32 a110, v14
  v_accvgpr_write_b32 a111, v15
  v_accvgpr_read_b32 v8, a112
  v_accvgpr_read_b32 v9, a113
  v_accvgpr_read_b32 v10, a114
  v_accvgpr_read_b32 v11, a115
  v_accvgpr_read_b32 v12, a116
  v_accvgpr_read_b32 v13, a117
  v_accvgpr_read_b32 v14, a118
  v_accvgpr_read_b32 v15, a119
  v_mul_f32 v8, v8, v22
  v_mul_f32 v9, v9, v22
  v_mul_f32 v10, v10, v22
  v_mul_f32 v11, v11, v22
  v_mul_f32 v12, v12, v22
  v_mul_f32 v13, v13, v22
  v_mul_f32 v14, v14, v22
  v_mul_f32 v15, v15, v22
  v_accvgpr_write_b32 a112, v8
  v_accvgpr_write_b32 a113, v9
  v_accvgpr_write_b32 a114, v10
  v_accvgpr_write_b32 a115, v11
  v_accvgpr_write_b32 a116, v12
  v_accvgpr_write_b32 a117, v13
  v_accvgpr_write_b32 a118, v14
  v_accvgpr_write_b32 a119, v15
  v_accvgpr_read_b32 v8, a120
  v_accvgpr_read_b32 v9, a121
  v_accvgpr_read_b32 v10, a122
  v_accvgpr_read_b32 v11, a123
  v_accvgpr_read_b32 v12, a124
  v_accvgpr_read_b32 v13, a125
  v_accvgpr_read_b32 v14, a126
  v_accvgpr_read_b32 v15, a127
  v_mul_f32 v8, v8, v22
  v_mul_f32 v9, v9, v22
  v_mul_f32 v10, v10, v22
  v_mul_f32 v11, v11, v22
  v_mul_f32 v12, v12, v22
  v_mul_f32 v13, v13, v22
  v_mul_f32 v14, v14, v22
  v_mul_f32 v15, v15, v22
  v_accvgpr_write_b32 a120, v8
  v_accvgpr_write_b32 a121, v9
  v_accvgpr_write_b32 a122, v10
  v_accvgpr_write_b32 a123, v11
  v_accvgpr_write_b32 a124, v12
  v_accvgpr_write_b32 a125, v13
  v_accvgpr_write_b32 a126, v14
  v_accvgpr_write_b32 a127, v15
  v_exp_f32 v8, v192
  v_exp_f32 v9, v193
  s_nop 0
  v_cvt_pk_bf16_f32 v96, v8, v9
  v_exp_f32 v8, v194
  v_exp_f32 v9, v195
  s_nop 0
  v_cvt_pk_bf16_f32 v97, v8, v9
  v_exp_f32 v8, v208
  v_exp_f32 v9, v209
  s_nop 0
  v_cvt_pk_bf16_f32 v104, v8, v9
  v_exp_f32 v8, v210
  v_exp_f32 v9, v211
  s_nop 0
  v_cvt_pk_bf16_f32 v105, v8, v9
  v_exp_f32 v8, v224
  v_exp_f32 v9, v225
  s_nop 0
  v_cvt_pk_bf16_f32 v112, v8, v9
  v_exp_f32 v8, v226
  v_exp_f32 v9, v227
  s_nop 0
  v_cvt_pk_bf16_f32 v113, v8, v9
  v_exp_f32 v8, v240
  v_exp_f32 v9, v241
  s_nop 0
  v_cvt_pk_bf16_f32 v120, v8, v9
  v_exp_f32 v8, v242
  v_exp_f32 v9, v243
  s_nop 0
  v_cvt_pk_bf16_f32 v121, v8, v9
  v_exp_f32 v8, v196
  v_exp_f32 v9, v197
  s_nop 0
  v_cvt_pk_bf16_f32 v98, v8, v9
  v_exp_f32 v8, v198
  v_exp_f32 v9, v199
  s_nop 0
  v_cvt_pk_bf16_f32 v99, v8, v9
  v_exp_f32 v8, v212
  v_exp_f32 v9, v213
  s_nop 0
  v_cvt_pk_bf16_f32 v106, v8, v9
  v_exp_f32 v8, v214
  v_exp_f32 v9, v215
  s_nop 0
  v_cvt_pk_bf16_f32 v107, v8, v9
  v_exp_f32 v8, v228
  v_exp_f32 v9, v229
  s_nop 0
  v_cvt_pk_bf16_f32 v114, v8, v9
  v_exp_f32 v8, v230
  v_exp_f32 v9, v231
  s_nop 0
  v_cvt_pk_bf16_f32 v115, v8, v9
  v_exp_f32 v8, v244
  v_exp_f32 v9, v245
  s_nop 0
  v_cvt_pk_bf16_f32 v122, v8, v9
  v_exp_f32 v8, v246
  v_exp_f32 v9, v247
  s_nop 0
  v_cvt_pk_bf16_f32 v123, v8, v9
  v_exp_f32 v8, v200
  v_exp_f32 v9, v201
  s_nop 0
  v_cvt_pk_bf16_f32 v100, v8, v9
  v_exp_f32 v8, v202
  v_exp_f32 v9, v203
  s_nop 0
  v_cvt_pk_bf16_f32 v101, v8, v9
  v_exp_f32 v8, v216
  v_exp_f32 v9, v217
  s_nop 0
  v_cvt_pk_bf16_f32 v108, v8, v9
  v_exp_f32 v8, v218
  v_exp_f32 v9, v219
  s_nop 0
  v_cvt_pk_bf16_f32 v109, v8, v9
  v_exp_f32 v8, v232
  v_exp_f32 v9, v233
  s_nop 0
  v_cvt_pk_bf16_f32 v116, v8, v9
  v_exp_f32 v8, v234
  v_exp_f32 v9, v235
  s_nop 0
  v_cvt_pk_bf16_f32 v117, v8, v9
  v_exp_f32 v8, v248
  v_exp_f32 v9, v249
  s_nop 0
  v_cvt_pk_bf16_f32 v124, v8, v9
  v_exp_f32 v8, v250
  v_exp_f32 v9, v251
  s_nop 0
  v_cvt_pk_bf16_f32 v125, v8, v9
  v_exp_f32 v8, v204
  v_exp_f32 v9, v205
  s_nop 0
  v_cvt_pk_bf16_f32 v102, v8, v9
  v_exp_f32 v8, v206
  v_exp_f32 v9, v207
  s_nop 0
  v_cvt_pk_bf16_f32 v103, v8, v9
  v_exp_f32 v8, v220
  v_exp_f32 v9, v221
  s_nop 0
  v_cvt_pk_bf16_f32 v110, v8, v9
  v_exp_f32 v8, v222
  v_exp_f32 v9, v223
  s_nop 0
  v_cvt_pk_bf16_f32 v111, v8, v9
  v_exp_f32 v8, v236
  v_exp_f32 v9, v237
  s_nop 0
  v_cvt_pk_bf16_f32 v118, v8, v9
  v_exp_f32 v8, v238
  v_exp_f32 v9, v239
  s_nop 0
  v_cvt_pk_bf16_f32 v119, v8, v9
  v_exp_f32 v8, v252
  v_exp_f32 v9, v253
  s_nop 0
  v_cvt_pk_bf16_f32 v126, v8, v9
  v_exp_f32 v8, v254
  v_exp_f32 v9, v255
  s_nop 0
  v_cvt_pk_bf16_f32 v127, v8, v9
  s_nop 1
  s_branch L_k2_fbr_tr
L_k2_mk_tr:
  s_nop 7
  s_add_u32 s3, s37, 1
  s_lshl_b32 s3, s3, 6
  v_subrev_u32 v1, s3, v5
  v_cmp_gt_i32 s[56:57], -16, v1
  v_cmp_gt_i32 s[58:59], -15, v1
  v_cmp_gt_i32 s[60:61], -14, v1
  v_cmp_gt_i32 s[62:63], -13, v1
  v_cndmask_b32 v144, v144, v20, s[56:57]
  v_cndmask_b32 v145, v145, v20, s[58:59]
  v_cndmask_b32 v146, v146, v20, s[60:61]
  v_cndmask_b32 v147, v147, v20, s[62:63]
  v_cmp_gt_i32 s[56:57], 0, v1
  v_cmp_gt_i32 s[58:59], 1, v1
  v_cmp_gt_i32 s[60:61], 2, v1
  v_cmp_gt_i32 s[62:63], 3, v1
  v_cndmask_b32 v128, v128, v20, s[56:57]
  v_cndmask_b32 v129, v129, v20, s[58:59]
  v_cndmask_b32 v130, v130, v20, s[60:61]
  v_cndmask_b32 v131, v131, v20, s[62:63]
  v_cndmask_b32 v148, v148, v20, s[56:57]
  v_cndmask_b32 v149, v149, v20, s[58:59]
  v_cndmask_b32 v150, v150, v20, s[60:61]
  v_cndmask_b32 v151, v151, v20, s[62:63]
  v_cmp_gt_i32 s[56:57], 16, v1
  v_cmp_gt_i32 s[58:59], 17, v1
  v_cmp_gt_i32 s[60:61], 18, v1
  v_cmp_gt_i32 s[62:63], 19, v1
  v_cndmask_b32 v132, v132, v20, s[56:57]
  v_cndmask_b32 v133, v133, v20, s[58:59]
  v_cndmask_b32 v134, v134, v20, s[60:61]
  v_cndmask_b32 v135, v135, v20, s[62:63]
  v_cndmask_b32 v152, v152, v20, s[56:57]
  v_cndmask_b32 v153, v153, v20, s[58:59]
  v_cndmask_b32 v154, v154, v20, s[60:61]
  v_cndmask_b32 v155, v155, v20, s[62:63]
  v_cmp_gt_i32 s[56:57], 32, v1
  v_cmp_gt_i32 s[58:59], 33, v1
  v_cmp_gt_i32 s[60:61], 34, v1
  v_cmp_gt_i32 s[62:63], 35, v1
  v_cndmask_b32 v136, v136, v20, s[56:57]
  v_cndmask_b32 v137, v137, v20, s[58:59]
  v_cndmask_b32 v138, v138, v20, s[60:61]
  v_cndmask_b32 v139, v139, v20, s[62:63]
  v_cndmask_b32 v156, v156, v20, s[56:57]
  v_cndmask_b32 v157, v157, v20, s[58:59]
  v_cndmask_b32 v158, v158, v20, s[60:61]
  v_cndmask_b32 v159, v159, v20, s[62:63]
  v_cmp_gt_i32 s[56:57], 48, v1
  v_cmp_gt_i32 s[58:59], 49, v1
  v_cmp_gt_i32 s[60:61], 50, v1
  v_cmp_gt_i32 s[62:63], 51, v1
  v_cndmask_b32 v140, v140, v20, s[56:57]
  v_cndmask_b32 v141, v141, v20, s[58:59]
  v_cndmask_b32 v142, v142, v20, s[60:61]
  v_cndmask_b32 v143, v143, v20, s[62:63]
  s_nop 1
  s_branch L_k2_mkr_tr
L_k2_fb_ne:
  s_nop 7
  v_max3_f32 v21, v128, v129, v130
  v_max3_f32 v21, v21, v131, v132
  v_max3_f32 v21, v21, v133, v134
  v_max3_f32 v21, v21, v135, v136
  v_max3_f32 v21, v21, v137, v138
  v_max3_f32 v21, v21, v139, v140
  v_max3_f32 v21, v21, v141, v142
  v_max_f32 v21, v21, v143
  v_mov_b32 v1, v21
  s_nop 1
  v_permlane16_swap_b32 v1, v21
  v_max_f32 v21, v21, v1
  v_mov_b32 v1, v21
  s_nop 1
  v_permlane32_swap_b32 v1, v21
  v_max_f32 v21, v21, v1
  v_add_f32 v21, 0x40e00000, v21
  v_max_f32 v21, 0, v21
  v_sub_f32 v128, v128, v21
  v_sub_f32 v129, v129, v21
  v_sub_f32 v130, v130, v21
  v_sub_f32 v131, v131, v21
  v_sub_f32 v132, v132, v21
  v_sub_f32 v133, v133, v21
  v_sub_f32 v134, v134, v21
  v_sub_f32 v135, v135, v21
  v_sub_f32 v136, v136, v21
  v_sub_f32 v137, v137, v21
  v_sub_f32 v138, v138, v21
  v_sub_f32 v139, v139, v21
  v_sub_f32 v140, v140, v21
  v_sub_f32 v141, v141, v21
  v_sub_f32 v142, v142, v21
  v_sub_f32 v143, v143, v21
  v_sub_f32 v192, v192, v21
  v_sub_f32 v193, v193, v21
  v_sub_f32 v194, v194, v21
  v_sub_f32 v195, v195, v21
  v_sub_f32 v196, v196, v21
  v_sub_f32 v197, v197, v21
  v_sub_f32 v198, v198, v21
  v_sub_f32 v199, v199, v21
  v_sub_f32 v200, v200, v21
  v_sub_f32 v201, v201, v21
  v_sub_f32 v202, v202, v21
  v_sub_f32 v203, v203, v21
  v_sub_f32 v204, v204, v21
  v_sub_f32 v205, v205, v21
  v_sub_f32 v206, v206, v21
  v_sub_f32 v207, v207, v21
  v_sub_f32 v32, v32, v21
  v_sub_f32 v33, v33, v21
  v_sub_f32 v34, v34, v21
  v_sub_f32 v35, v35, v21
  v_exp_f32 v22, -v21
  s_nop 0
  v_mul_f32 v48, v48, v22
  v_mul_f32 v49, v49, v22
  v_mul_f32 v50, v50, v22
  v_mul_f32 v51, v51, v22
  v_accvgpr_read_b32 v8, a0
  v_accvgpr_read_b32 v9, a1
  v_accvgpr_read_b32 v10, a2
  v_accvgpr_read_b32 v11, a3
  v_accvgpr_read_b32 v12, a4
  v_accvgpr_read_b32 v13, a5
  v_accvgpr_read_b32 v14, a6
  v_accvgpr_read_b32 v15, a7
  v_mul_f32 v8, v8, v22
  v_mul_f32 v9, v9, v22
  v_mul_f32 v10, v10, v22
  v_mul_f32 v11, v11, v22
  v_mul_f32 v12, v12, v22
  v_mul_f32 v13, v13, v22
  v_mul_f32 v14, v14, v22
  v_mul_f32 v15, v15, v22
  v_accvgpr_write_b32 a0, v8
  v_accvgpr_write_b32 a1, v9
  v_accvgpr_write_b32 a2, v10
  v_accvgpr_write_b32 a3, v11
  v_accvgpr_write_b32 a4, v12
  v_accvgpr_write_b32 a5, v13
  v_accvgpr_write_b32 a6, v14
  v_accvgpr_write_b32 a7, v15
  v_accvgpr_read_b32 v8, a8
  v_accvgpr_read_b32 v9, a9
  v_accvgpr_read_b32 v10, a10
  v_accvgpr_read_b32 v11, a11
  v_accvgpr_read_b32 v12, a12
  v_accvgpr_read_b32 v13, a13
  v_accvgpr_read_b32 v14, a14
  v_accvgpr_read_b32 v15, a15
  v_mul_f32 v8, v8, v22
  v_mul_f32 v9, v9, v22
  v_mul_f32 v10, v10, v22
  v_mul_f32 v11, v11, v22
  v_mul_f32 v12, v12, v22
  v_mul_f32 v13, v13, v22
  v_mul_f32 v14, v14, v22
  v_mul_f32 v15, v15, v22
  v_accvgpr_write_b32 a8, v8
  v_accvgpr_write_b32 a9, v9
  v_accvgpr_write_b32 a10, v10
  v_accvgpr_write_b32 a11, v11
  v_accvgpr_write_b32 a12, v12
  v_accvgpr_write_b32 a13, v13
  v_accvgpr_write_b32 a14, v14
  v_accvgpr_write_b32 a15, v15
  v_accvgpr_read_b32 v8, a16
  v_accvgpr_read_b32 v9, a17
  v_accvgpr_read_b32 v10, a18
  v_accvgpr_read_b32 v11, a19
  v_accvgpr_read_b32 v12, a20
  v_accvgpr_read_b32 v13, a21
  v_accvgpr_read_b32 v14, a22
  v_accvgpr_read_b32 v15, a23
  v_mul_f32 v8, v8, v22
  v_mul_f32 v9, v9, v22
  v_mul_f32 v10, v10, v22
  v_mul_f32 v11, v11, v22
  v_mul_f32 v12, v12, v22
  v_mul_f32 v13, v13, v22
  v_mul_f32 v14, v14, v22
  v_mul_f32 v15, v15, v22
  v_accvgpr_write_b32 a16, v8
  v_accvgpr_write_b32 a17, v9
  v_accvgpr_write_b32 a18, v10
  v_accvgpr_write_b32 a19, v11
  v_accvgpr_write_b32 a20, v12
  v_accvgpr_write_b32 a21, v13
  v_accvgpr_write_b32 a22, v14
  v_accvgpr_write_b32 a23, v15
  v_accvgpr_read_b32 v8, a24
  v_accvgpr_read_b32 v9, a25
  v_accvgpr_read_b32 v10, a26
  v_accvgpr_read_b32 v11, a27
  v_accvgpr_read_b32 v12, a28
  v_accvgpr_read_b32 v13, a29
  v_accvgpr_read_b32 v14, a30
  v_accvgpr_read_b32 v15, a31
  v_mul_f32 v8, v8, v22
  v_mul_f32 v9, v9, v22
  v_mul_f32 v10, v10, v22
  v_mul_f32 v11, v11, v22
  v_mul_f32 v12, v12, v22
  v_mul_f32 v13, v13, v22
  v_mul_f32 v14, v14, v22
  v_mul_f32 v15, v15, v22
  v_accvgpr_write_b32 a24, v8
  v_accvgpr_write_b32 a25, v9
  v_accvgpr_write_b32 a26, v10
  v_accvgpr_write_b32 a27, v11
  v_accvgpr_write_b32 a28, v12
  v_accvgpr_write_b32 a29, v13
  v_accvgpr_write_b32 a30, v14
  v_accvgpr_write_b32 a31, v15
  v_max3_f32 v21, v144, v145, v146
  v_max3_f32 v21, v21, v147, v148
  v_max3_f32 v21, v21, v149, v150
  v_max3_f32 v21, v21, v151, v152
  v_max3_f32 v21, v21, v153, v154
  v_max3_f32 v21, v21, v155, v156
  v_max3_f32 v21, v21, v157, v158
  v_max_f32 v21, v21, v159
  v_mov_b32 v1, v21
  s_nop 1
  v_permlane16_swap_b32 v1, v21
  v_max_f32 v21, v21, v1
  v_mov_b32 v1, v21
  s_nop 1
  v_permlane32_swap_b32 v1, v21
  v_max_f32 v21, v21, v1
  v_add_f32 v21, 0x40e00000, v21
  v_max_f32 v21, 0, v21
  v_sub_f32 v144, v144, v21
  v_sub_f32 v145, v145, v21
  v_sub_f32 v146, v146, v21
  v_sub_f32 v147, v147, v21
  v_sub_f32 v148, v148, v21
  v_sub_f32 v149, v149, v21
  v_sub_f32 v150, v150, v21
  v_sub_f32 v151, v151, v21
  v_sub_f32 v152, v152, v21
  v_sub_f32 v153, v153, v21
  v_sub_f32 v154, v154, v21
  v_sub_f32 v155, v155, v21
  v_sub_f32 v156, v156, v21
  v_sub_f32 v157, v157, v21
  v_sub_f32 v158, v158, v21
  v_sub_f32 v159, v159, v21
  v_sub_f32 v208, v208, v21
  v_sub_f32 v209, v209, v21
  v_sub_f32 v210, v210, v21
  v_sub_f32 v211, v211, v21
  v_sub_f32 v212, v212, v21
  v_sub_f32 v213, v213, v21
  v_sub_f32 v214, v214, v21
  v_sub_f32 v215, v215, v21
  v_sub_f32 v216, v216, v21
  v_sub_f32 v217, v217, v21
  v_sub_f32 v218, v218, v21
  v_sub_f32 v219, v219, v21
  v_sub_f32 v220, v220, v21
  v_sub_f32 v221, v221, v21
  v_sub_f32 v222, v222, v21
  v_sub_f32 v223, v223, v21
  v_sub_f32 v36, v36, v21
  v_sub_f32 v37, v37, v21
  v_sub_f32 v38, v38, v21
  v_sub_f32 v39, v39, v21
  v_exp_f32 v22, -v21
  s_nop 0
  v_mul_f32 v52, v52, v22
  v_mul_f32 v53, v53, v22
  v_mul_f32 v54, v54, v22
  v_mul_f32 v55, v55, v22
  v_accvgpr_read_b32 v8, a32
  v_accvgpr_read_b32 v9, a33
  v_accvgpr_read_b32 v10, a34
  v_accvgpr_read_b32 v11, a35
  v_accvgpr_read_b32 v12, a36
  v_accvgpr_read_b32 v13, a37
  v_accvgpr_read_b32 v14, a38
  v_accvgpr_read_b32 v15, a39
  v_mul_f32 v8, v8, v22
  v_mul_f32 v9, v9, v22
  v_mul_f32 v10, v10, v22
  v_mul_f32 v11, v11, v22
  v_mul_f32 v12, v12, v22
  v_mul_f32 v13, v13, v22
  v_mul_f32 v14, v14, v22
  v_mul_f32 v15, v15, v22
  v_accvgpr_write_b32 a32, v8
  v_accvgpr_write_b32 a33, v9
  v_accvgpr_write_b32 a34, v10
  v_accvgpr_write_b32 a35, v11
  v_accvgpr_write_b32 a36, v12
  v_accvgpr_write_b32 a37, v13
  v_accvgpr_write_b32 a38, v14
  v_accvgpr_write_b32 a39, v15
  v_accvgpr_read_b32 v8, a40
  v_accvgpr_read_b32 v9, a41
  v_accvgpr_read_b32 v10, a42
  v_accvgpr_read_b32 v11, a43
  v_accvgpr_read_b32 v12, a44
  v_accvgpr_read_b32 v13, a45
  v_accvgpr_read_b32 v14, a46
  v_accvgpr_read_b32 v15, a47
  v_mul_f32 v8, v8, v22
  v_mul_f32 v9, v9, v22
  v_mul_f32 v10, v10, v22
  v_mul_f32 v11, v11, v22
  v_mul_f32 v12, v12, v22
  v_mul_f32 v13, v13, v22
  v_mul_f32 v14, v14, v22
  v_mul_f32 v15, v15, v22
  v_accvgpr_write_b32 a40, v8
  v_accvgpr_write_b32 a41, v9
  v_accvgpr_write_b32 a42, v10
  v_accvgpr_write_b32 a43, v11
  v_accvgpr_write_b32 a44, v12
  v_accvgpr_write_b32 a45, v13
  v_accvgpr_write_b32 a46, v14
  v_accvgpr_write_b32 a47, v15
  v_accvgpr_read_b32 v8, a48
  v_accvgpr_read_b32 v9, a49
  v_accvgpr_read_b32 v10, a50
  v_accvgpr_read_b32 v11, a51
  v_accvgpr_read_b32 v12, a52
  v_accvgpr_read_b32 v13, a53
  v_accvgpr_read_b32 v14, a54
  v_accvgpr_read_b32 v15, a55
  v_mul_f32 v8, v8, v22
  v_mul_f32 v9, v9, v22
  v_mul_f32 v10, v10, v22
  v_mul_f32 v11, v11, v22
  v_mul_f32 v12, v12, v22
  v_mul_f32 v13, v13, v22
  v_mul_f32 v14, v14, v22
  v_mul_f32 v15, v15, v22
  v_accvgpr_write_b32 a48, v8
  v_accvgpr_write_b32 a49, v9
  v_accvgpr_write_b32 a50, v10
  v_accvgpr_write_b32 a51, v11
  v_accvgpr_write_b32 a52, v12
  v_accvgpr_write_b32 a53, v13
  v_accvgpr_write_b32 a54, v14
  v_accvgpr_write_b32 a55, v15
  v_accvgpr_read_b32 v8, a56
  v_accvgpr_read_b32 v9, a57
  v_accvgpr_read_b32 v10, a58
  v_accvgpr_read_b32 v11, a59
  v_accvgpr_read_b32 v12, a60
  v_accvgpr_read_b32 v13, a61
  v_accvgpr_read_b32 v14, a62
  v_accvgpr_read_b32 v15, a63
  v_mul_f32 v8, v8, v22
  v_mul_f32 v9, v9, v22
  v_mul_f32 v10, v10, v22
  v_mul_f32 v11, v11, v22
  v_mul_f32 v12, v12, v22
  v_mul_f32 v13, v13, v22
  v_mul_f32 v14, v14, v22
  v_mul_f32 v15, v15, v22
  v_accvgpr_write_b32 a56, v8
  v_accvgpr_write_b32 a57, v9
  v_accvgpr_write_b32 a58, v10
  v_accvgpr_write_b32 a59, v11
  v_accvgpr_write_b32 a60, v12
  v_accvgpr_write_b32 a61, v13
  v_accvgpr_write_b32 a62, v14
  v_accvgpr_write_b32 a63, v15
  v_exp_f32 v8, v128
  v_exp_f32 v9, v129
  s_nop 0
  v_cvt_pk_bf16_f32 v64, v8, v9
  v_exp_f32 v8, v130
  v_exp_f32 v9, v131
  s_nop 0
  v_cvt_pk_bf16_f32 v65, v8, v9
  v_exp_f32 v8, v144
  v_exp_f32 v9, v145
  s_nop 0
  v_cvt_pk_bf16_f32 v72, v8, v9
  v_exp_f32 v8, v146
  v_exp_f32 v9, v147
  s_nop 0
  v_cvt_pk_bf16_f32 v73, v8, v9
  v_exp_f32 v8, v132
  v_exp_f32 v9, v133
  s_nop 0
  v_cvt_pk_bf16_f32 v66, v8, v9
  v_exp_f32 v8, v134
  v_exp_f32 v9, v135
  s_nop 0
  v_cvt_pk_bf16_f32 v67, v8, v9
  v_exp_f32 v8, v148
  v_exp_f32 v9, v149
  s_nop 0
  v_cvt_pk_bf16_f32 v74, v8, v9
  v_exp_f32 v8, v150
  v_exp_f32 v9, v151
  s_nop 0
  v_cvt_pk_bf16_f32 v75, v8, v9
  v_exp_f32 v8, v136
  v_exp_f32 v9, v137
  s_nop 0
  v_cvt_pk_bf16_f32 v68, v8, v9
  v_exp_f32 v8, v138
  v_exp_f32 v9, v139
  s_nop 0
  v_cvt_pk_bf16_f32 v69, v8, v9
  v_exp_f32 v8, v152
  v_exp_f32 v9, v153
  s_nop 0
  v_cvt_pk_bf16_f32 v76, v8, v9
  v_exp_f32 v8, v154
  v_exp_f32 v9, v155
  s_nop 0
  v_cvt_pk_bf16_f32 v77, v8, v9
  v_exp_f32 v8, v140
  v_exp_f32 v9, v141
  s_nop 0
  v_cvt_pk_bf16_f32 v70, v8, v9
  v_exp_f32 v8, v142
  v_exp_f32 v9, v143
  s_nop 0
  v_cvt_pk_bf16_f32 v71, v8, v9
  v_exp_f32 v8, v156
  v_exp_f32 v9, v157
  s_nop 0
  v_cvt_pk_bf16_f32 v78, v8, v9
  v_exp_f32 v8, v158
  v_exp_f32 v9, v159
  s_nop 0
  v_cvt_pk_bf16_f32 v79, v8, v9
  s_nop 1
  s_branch L_k2_fbr_ne
L_k2_mk_ne:
  s_nop 7
  s_add_u32 s3, s37, 1
  s_lshl_b32 s3, s3, 6
  v_subrev_u32 v1, s3, v5
  v_cmp_gt_i32 s[56:57], -16, v1
  v_cmp_gt_i32 s[58:59], -15, v1
  v_cmp_gt_i32 s[60:61], -14, v1
  v_cmp_gt_i32 s[62:63], -13, v1
  v_cndmask_b32 v208, v208, v20, s[56:57]
  v_cndmask_b32 v209, v209, v20, s[58:59]
  v_cndmask_b32 v210, v210, v20, s[60:61]
  v_cndmask_b32 v211, v211, v20, s[62:63]
  v_cmp_gt_i32 s[56:57], 0, v1
  v_cmp_gt_i32 s[58:59], 1, v1
  v_cmp_gt_i32 s[60:61], 2, v1
  v_cmp_gt_i32 s[62:63], 3, v1
  v_cndmask_b32 v192, v192, v20, s[56:57]
  v_cndmask_b32 v193, v193, v20, s[58:59]
  v_cndmask_b32 v194, v194, v20, s[60:61]
  v_cndmask_b32 v195, v195, v20, s[62:63]
  v_cndmask_b32 v212, v212, v20, s[56:57]
  v_cndmask_b32 v213, v213, v20, s[58:59]
  v_cndmask_b32 v214, v214, v20, s[60:61]
  v_cndmask_b32 v215, v215, v20, s[62:63]
  v_cmp_gt_i32 s[56:57], 16, v1
  v_cmp_gt_i32 s[58:59], 17, v1
  v_cmp_gt_i32 s[60:61], 18, v1
  v_cmp_gt_i32 s[62:63], 19, v1
  v_cndmask_b32 v196, v196, v20, s[56:57]
  v_cndmask_b32 v197, v197, v20, s[58:59]
  v_cndmask_b32 v198, v198, v20, s[60:61]
  v_cndmask_b32 v199, v199, v20, s[62:63]
  v_cndmask_b32 v216, v216, v20, s[56:57]
  v_cndmask_b32 v217, v217, v20, s[58:59]
  v_cndmask_b32 v218, v218, v20, s[60:61]
  v_cndmask_b32 v219, v219, v20, s[62:63]
  v_cmp_gt_i32 s[56:57], 32, v1
  v_cmp_gt_i32 s[58:59], 33, v1
  v_cmp_gt_i32 s[60:61], 34, v1
  v_cmp_gt_i32 s[62:63], 35, v1
  v_cndmask_b32 v200, v200, v20, s[56:57]
  v_cndmask_b32 v201, v201, v20, s[58:59]
  v_cndmask_b32 v202, v202, v20, s[60:61]
  v_cndmask_b32 v203, v203, v20, s[62:63]
  v_cndmask_b32 v220, v220, v20, s[56:57]
  v_cndmask_b32 v221, v221, v20, s[58:59]
  v_cndmask_b32 v222, v222, v20, s[60:61]
  v_cndmask_b32 v223, v223, v20, s[62:63]
  v_cmp_gt_i32 s[56:57], 48, v1
  v_cmp_gt_i32 s[58:59], 49, v1
  v_cmp_gt_i32 s[60:61], 50, v1
  v_cmp_gt_i32 s[62:63], 51, v1
  v_cndmask_b32 v204, v204, v20, s[56:57]
  v_cndmask_b32 v205, v205, v20, s[58:59]
  v_cndmask_b32 v206, v206, v20, s[60:61]
  v_cndmask_b32 v207, v207, v20, s[62:63]
  s_nop 1
  s_branch L_k2_mkr_ne
L_k2_fb_no:
  s_nop 7
  v_max3_f32 v21, v192, v193, v194
  v_max3_f32 v21, v21, v195, v196
  v_max3_f32 v21, v21, v197, v198
  v_max3_f32 v21, v21, v199, v200
  v_max3_f32 v21, v21, v201, v202
  v_max3_f32 v21, v21, v203, v204
  v_max3_f32 v21, v21, v205, v206
  v_max_f32 v21, v21, v207
  v_mov_b32 v1, v21
  s_nop 1
  v_permlane16_swap_b32 v1, v21
  v_max_f32 v21, v21, v1
  v_mov_b32 v1, v21
  s_nop 1
  v_permlane32_swap_b32 v1, v21
  v_max_f32 v21, v21, v1
  v_add_f32 v21, 0x40e00000, v21
  v_max_f32 v21, 0, v21
  v_sub_f32 v192, v192, v21
  v_sub_f32 v193, v193, v21
  v_sub_f32 v194, v194, v21
  v_sub_f32 v195, v195, v21
  v_sub_f32 v196, v196, v21
  v_sub_f32 v197, v197, v21
  v_sub_f32 v198, v198, v21
  v_sub_f32 v199, v199, v21
  v_sub_f32 v200, v200, v21
  v_sub_f32 v201, v201, v21
  v_sub_f32 v202, v202, v21
  v_sub_f32 v203, v203, v21
  v_sub_f32 v204, v204, v21
  v_sub_f32 v205, v205, v21
  v_sub_f32 v206, v206, v21
  v_sub_f32 v207, v207, v21
  v_sub_f32 v128, v128, v21
  v_sub_f32 v129, v129, v21
  v_sub_f32 v130, v130, v21
  v_sub_f32 v131, v131, v21
  v_sub_f32 v132, v132, v21
  v_sub_f32 v133, v133, v21
  v_sub_f32 v134, v134, v21
  v_sub_f32 v135, v135, v21
  v_sub_f32 v136, v136, v21
  v_sub_f32 v137, v137, v21
  v_sub_f32 v138, v138, v21
  v_sub_f32 v139, v139, v21
  v_sub_f32 v140, v140, v21
  v_sub_f32 v141, v141, v21
  v_sub_f32 v142, v142, v21
  v_sub_f32 v143, v143, v21
  v_sub_f32 v32, v32, v21
  v_sub_f32 v33, v33, v21
  v_sub_f32 v34, v34, v21
  v_sub_f32 v35, v35, v21
  v_exp_f32 v22, -v21
  s_nop 0
  v_mul_f32 v48, v48, v22
  v_mul_f32 v49, v49, v22
  v_mul_f32 v50, v50, v22
  v_mul_f32 v51, v51, v22
  v_accvgpr_read_b32 v8, a0
  v_accvgpr_read_b32 v9, a1
  v_accvgpr_read_b32 v10, a2
  v_accvgpr_read_b32 v11, a3
  v_accvgpr_read_b32 v12, a4
  v_accvgpr_read_b32 v13, a5
  v_accvgpr_read_b32 v14, a6
  v_accvgpr_read_b32 v15, a7
  v_mul_f32 v8, v8, v22
  v_mul_f32 v9, v9, v22
  v_mul_f32 v10, v10, v22
  v_mul_f32 v11, v11, v22
  v_mul_f32 v12, v12, v22
  v_mul_f32 v13, v13, v22
  v_mul_f32 v14, v14, v22
  v_mul_f32 v15, v15, v22
  v_accvgpr_write_b32 a0, v8
  v_accvgpr_write_b32 a1, v9
  v_accvgpr_write_b32 a2, v10
  v_accvgpr_write_b32 a3, v11
  v_accvgpr_write_b32 a4, v12
  v_accvgpr_write_b32 a5, v13
  v_accvgpr_write_b32 a6, v14
  v_accvgpr_write_b32 a7, v15
  v_accvgpr_read_b32 v8, a8
  v_accvgpr_read_b32 v9, a9
  v_accvgpr_read_b32 v10, a10
  v_accvgpr_read_b32 v11, a11
  v_accvgpr_read_b32 v12, a12
  v_accvgpr_read_b32 v13, a13
  v_accvgpr_read_b32 v14, a14
  v_accvgpr_read_b32 v15, a15
  v_mul_f32 v8, v8, v22
  v_mul_f32 v9, v9, v22
  v_mul_f32 v10, v10, v22
  v_mul_f32 v11, v11, v22
  v_mul_f32 v12, v12, v22
  v_mul_f32 v13, v13, v22
  v_mul_f32 v14, v14, v22
  v_mul_f32 v15, v15, v22
  v_accvgpr_write_b32 a8, v8
  v_accvgpr_write_b32 a9, v9
  v_accvgpr_write_b32 a10, v10
  v_accvgpr_write_b32 a11, v11
  v_accvgpr_write_b32 a12, v12
  v_accvgpr_write_b32 a13, v13
  v_accvgpr_write_b32 a14, v14
  v_accvgpr_write_b32 a15, v15
  v_accvgpr_read_b32 v8, a16
  v_accvgpr_read_b32 v9, a17
  v_accvgpr_read_b32 v10, a18
  v_accvgpr_read_b32 v11, a19
  v_accvgpr_read_b32 v12, a20
  v_accvgpr_read_b32 v13, a21
  v_accvgpr_read_b32 v14, a22
  v_accvgpr_read_b32 v15, a23
  v_mul_f32 v8, v8, v22
  v_mul_f32 v9, v9, v22
  v_mul_f32 v10, v10, v22
  v_mul_f32 v11, v11, v22
  v_mul_f32 v12, v12, v22
  v_mul_f32 v13, v13, v22
  v_mul_f32 v14, v14, v22
  v_mul_f32 v15, v15, v22
  v_accvgpr_write_b32 a16, v8
  v_accvgpr_write_b32 a17, v9
  v_accvgpr_write_b32 a18, v10
  v_accvgpr_write_b32 a19, v11
  v_accvgpr_write_b32 a20, v12
  v_accvgpr_write_b32 a21, v13
  v_accvgpr_write_b32 a22, v14
  v_accvgpr_write_b32 a23, v15
  v_accvgpr_read_b32 v8, a24
  v_accvgpr_read_b32 v9, a25
  v_accvgpr_read_b32 v10, a26
  v_accvgpr_read_b32 v11, a27
  v_accvgpr_read_b32 v12, a28
  v_accvgpr_read_b32 v13, a29
  v_accvgpr_read_b32 v14, a30
  v_accvgpr_read_b32 v15, a31
  v_mul_f32 v8, v8, v22
  v_mul_f32 v9, v9, v22
  v_mul_f32 v10, v10, v22
  v_mul_f32 v11, v11, v22
  v_mul_f32 v12, v12, v22
  v_mul_f32 v13, v13, v22
  v_mul_f32 v14, v14, v22
  v_mul_f32 v15, v15, v22
  v_accvgpr_write_b32 a24, v8
  v_accvgpr_write_b32 a25, v9
  v_accvgpr_write_b32 a26, v10
  v_accvgpr_write_b32 a27, v11
  v_accvgpr_write_b32 a28, v12
  v_accvgpr_write_b32 a29, v13
  v_accvgpr_write_b32 a30, v14
  v_accvgpr_write_b32 a31, v15
  v_max3_f32 v21, v208, v209, v210
  v_max3_f32 v21, v21, v211, v212
  v_max3_f32 v21, v21, v213, v214
  v_max3_f32 v21, v21, v215, v216
  v_max3_f32 v21, v21, v217, v218
  v_max3_f32 v21, v21, v219, v220
  v_max3_f32 v21, v21, v221, v222
  v_max_f32 v21, v21, v223
  v_mov_b32 v1, v21
  s_nop 1
  v_permlane16_swap_b32 v1, v21
  v_max_f32 v21, v21, v1
  v_mov_b32 v1, v21
  s_nop 1
  v_permlane32_swap_b32 v1, v21
  v_max_f32 v21, v21, v1
  v_add_f32 v21, 0x40e00000, v21
  v_max_f32 v21, 0, v21
  v_sub_f32 v208, v208, v21
  v_sub_f32 v209, v209, v21
  v_sub_f32 v210, v210, v21
  v_sub_f32 v211, v211, v21
  v_sub_f32 v212, v212, v21
  v_sub_f32 v213, v213, v21
  v_sub_f32 v214, v214, v21
  v_sub_f32 v215, v215, v21
  v_sub_f32 v216, v216, v21
  v_sub_f32 v217, v217, v21
  v_sub_f32 v218, v218, v21
  v_sub_f32 v219, v219, v21
  v_sub_f32 v220, v220, v21
  v_sub_f32 v221, v221, v21
  v_sub_f32 v222, v222, v21
  v_sub_f32 v223, v223, v21
  v_sub_f32 v144, v144, v21
  v_sub_f32 v145, v145, v21
  v_sub_f32 v146, v146, v21
  v_sub_f32 v147, v147, v21
  v_sub_f32 v148, v148, v21
  v_sub_f32 v149, v149, v21
  v_sub_f32 v150, v150, v21
  v_sub_f32 v151, v151, v21
  v_sub_f32 v152, v152, v21
  v_sub_f32 v153, v153, v21
  v_sub_f32 v154, v154, v21
  v_sub_f32 v155, v155, v21
  v_sub_f32 v156, v156, v21
  v_sub_f32 v157, v157, v21
  v_sub_f32 v158, v158, v21
  v_sub_f32 v159, v159, v21
  v_sub_f32 v36, v36, v21
  v_sub_f32 v37, v37, v21
  v_sub_f32 v38, v38, v21
  v_sub_f32 v39, v39, v21
  v_exp_f32 v22, -v21
  s_nop 0
  v_mul_f32 v52, v52, v22
  v_mul_f32 v53, v53, v22
  v_mul_f32 v54, v54, v22
  v_mul_f32 v55, v55, v22
  v_accvgpr_read_b32 v8, a32
  v_accvgpr_read_b32 v9, a33
  v_accvgpr_read_b32 v10, a34
  v_accvgpr_read_b32 v11, a35
  v_accvgpr_read_b32 v12, a36
  v_accvgpr_read_b32 v13, a37
  v_accvgpr_read_b32 v14, a38
  v_accvgpr_read_b32 v15, a39
  v_mul_f32 v8, v8, v22
  v_mul_f32 v9, v9, v22
  v_mul_f32 v10, v10, v22
  v_mul_f32 v11, v11, v22
  v_mul_f32 v12, v12, v22
  v_mul_f32 v13, v13, v22
  v_mul_f32 v14, v14, v22
  v_mul_f32 v15, v15, v22
  v_accvgpr_write_b32 a32, v8
  v_accvgpr_write_b32 a33, v9
  v_accvgpr_write_b32 a34, v10
  v_accvgpr_write_b32 a35, v11
  v_accvgpr_write_b32 a36, v12
  v_accvgpr_write_b32 a37, v13
  v_accvgpr_write_b32 a38, v14
  v_accvgpr_write_b32 a39, v15
  v_accvgpr_read_b32 v8, a40
  v_accvgpr_read_b32 v9, a41
  v_accvgpr_read_b32 v10, a42
  v_accvgpr_read_b32 v11, a43
  v_accvgpr_read_b32 v12, a44
  v_accvgpr_read_b32 v13, a45
  v_accvgpr_read_b32 v14, a46
  v_accvgpr_read_b32 v15, a47
  v_mul_f32 v8, v8, v22
  v_mul_f32 v9, v9, v22
  v_mul_f32 v10, v10, v22
  v_mul_f32 v11, v11, v22
  v_mul_f32 v12, v12, v22
  v_mul_f32 v13, v13, v22
  v_mul_f32 v14, v14, v22
  v_mul_f32 v15, v15, v22
  v_accvgpr_write_b32 a40, v8
  v_accvgpr_write_b32 a41, v9
  v_accvgpr_write_b32 a42, v10
  v_accvgpr_write_b32 a43, v11
  v_accvgpr_write_b32 a44, v12
  v_accvgpr_write_b32 a45, v13
  v_accvgpr_write_b32 a46, v14
  v_accvgpr_write_b32 a47, v15
  v_accvgpr_read_b32 v8, a48
  v_accvgpr_read_b32 v9, a49
  v_accvgpr_read_b32 v10, a50
  v_accvgpr_read_b32 v11, a51
  v_accvgpr_read_b32 v12, a52
  v_accvgpr_read_b32 v13, a53
  v_accvgpr_read_b32 v14, a54
  v_accvgpr_read_b32 v15, a55
  v_mul_f32 v8, v8, v22
  v_mul_f32 v9, v9, v22
  v_mul_f32 v10, v10, v22
  v_mul_f32 v11, v11, v22
  v_mul_f32 v12, v12, v22
  v_mul_f32 v13, v13, v22
  v_mul_f32 v14, v14, v22
  v_mul_f32 v15, v15, v22
  v_accvgpr_write_b32 a48, v8
  v_accvgpr_write_b32 a49, v9
  v_accvgpr_write_b32 a50, v10
  v_accvgpr_write_b32 a51, v11
  v_accvgpr_write_b32 a52, v12
  v_accvgpr_write_b32 a53, v13
  v_accvgpr_write_b32 a54, v14
  v_accvgpr_write_b32 a55, v15
  v_accvgpr_read_b32 v8, a56
  v_accvgpr_read_b32 v9, a57
  v_accvgpr_read_b32 v10, a58
  v_accvgpr_read_b32 v11, a59
  v_accvgpr_read_b32 v12, a60
  v_accvgpr_read_b32 v13, a61
  v_accvgpr_read_b32 v14, a62
  v_accvgpr_read_b32 v15, a63
  v_mul_f32 v8, v8, v22
  v_mul_f32 v9, v9, v22
  v_mul_f32 v10, v10, v22
  v_mul_f32 v11, v11, v22
  v_mul_f32 v12, v12, v22
  v_mul_f32 v13, v13, v22
  v_mul_f32 v14, v14, v22
  v_mul_f32 v15, v15, v22
  v_accvgpr_write_b32 a56, v8
  v_accvgpr_write_b32 a57, v9
  v_accvgpr_write_b32 a58, v10
  v_accvgpr_write_b32 a59, v11
  v_accvgpr_write_b32 a60, v12
  v_accvgpr_write_b32 a61, v13
  v_accvgpr_write_b32 a62, v14
  v_accvgpr_write_b32 a63, v15
  v_exp_f32 v8, v192
  v_exp_f32 v9, v193
  s_nop 0
  v_cvt_pk_bf16_f32 v96, v8, v9
  v_exp_f32 v8, v194
  v_exp_f32 v9, v195
  s_nop 0
  v_cvt_pk_bf16_f32 v97, v8, v9
  v_exp_f32 v8, v208
  v_exp_f32 v9, v209
  s_nop 0
  v_cvt_pk_bf16_f32 v104, v8, v9
  v_exp_f32 v8, v210
  v_exp_f32 v9, v211
  s_nop 0
  v_cvt_pk_bf16_f32 v105, v8, v9
  v_exp_f32 v8, v196
  v_exp_f32 v9, v197
  s_nop 0
  v_cvt_pk_bf16_f32 v98, v8, v9
  v_exp_f32 v8, v198
  v_exp_f32 v9, v199
  s_nop 0
  v_cvt_pk_bf16_f32 v99, v8, v9
  v_exp_f32 v8, v212
  v_exp_f32 v9, v213
  s_nop 0
  v_cvt_pk_bf16_f32 v106, v8, v9
  v_exp_f32 v8, v214
  v_exp_f32 v9, v215
  s_nop 0
  v_cvt_pk_bf16_f32 v107, v8, v9
  v_exp_f32 v8, v200
  v_exp_f32 v9, v201
  s_nop 0
  v_cvt_pk_bf16_f32 v100, v8, v9
  v_exp_f32 v8, v202
  v_exp_f32 v9, v203
  s_nop 0
  v_cvt_pk_bf16_f32 v101, v8, v9
  v_exp_f32 v8, v216
  v_exp_f32 v9, v217
  s_nop 0
  v_cvt_pk_bf16_f32 v108, v8, v9
  v_exp_f32 v8, v218
  v_exp_f32 v9, v219
  s_nop 0
  v_cvt_pk_bf16_f32 v109, v8, v9
  v_exp_f32 v8, v204
  v_exp_f32 v9, v205
  s_nop 0
  v_cvt_pk_bf16_f32 v102, v8, v9
  v_exp_f32 v8, v206
  v_exp_f32 v9, v207
  s_nop 0
  v_cvt_pk_bf16_f32 v103, v8, v9
  v_exp_f32 v8, v220
  v_exp_f32 v9, v221
  s_nop 0
  v_cvt_pk_bf16_f32 v110, v8, v9
  v_exp_f32 v8, v222
  v_exp_f32 v9, v223
  s_nop 0
  v_cvt_pk_bf16_f32 v111, v8, v9
  s_nop 1
  s_branch L_k2_fbr_no
L_k2_mk_no:
  s_nop 7
  s_add_u32 s3, s37, 1
  s_lshl_b32 s3, s3, 6
  v_subrev_u32 v1, s3, v5
  v_cmp_gt_i32 s[56:57], -16, v1
  v_cmp_gt_i32 s[58:59], -15, v1
  v_cmp_gt_i32 s[60:61], -14, v1
  v_cmp_gt_i32 s[62:63], -13, v1
  v_cndmask_b32 v144, v144, v20, s[56:57]
  v_cndmask_b32 v145, v145, v20, s[58:59]
  v_cndmask_b32 v146, v146, v20, s[60:61]
  v_cndmask_b32 v147, v147, v20, s[62:63]
  v_cmp_gt_i32 s[56:57], 0, v1
  v_cmp_gt_i32 s[58:59], 1, v1
  v_cmp_gt_i32 s[60:61], 2, v1
  v_cmp_gt_i32 s[62:63], 3, v1
  v_cndmask_b32 v128, v128, v20, s[56:57]
  v_cndmask_b32 v129, v129, v20, s[58:59]
  v_cndmask_b32 v130, v130, v20, s[60:61]
  v_cndmask_b32 v131, v131, v20, s[62:63]
  v_cndmask_b32 v148, v148, v20, s[56:57]
  v_cndmask_b32 v149, v149, v20, s[58:59]
  v_cndmask_b32 v150, v150, v20, s[60:61]
  v_cndmask_b32 v151, v151, v20, s[62:63]
  v_cmp_gt_i32 s[56:57], 16, v1
  v_cmp_gt_i32 s[58:59], 17, v1
  v_cmp_gt_i32 s[60:61], 18, v1
  v_cmp_gt_i32 s[62:63], 19, v1
  v_cndmask_b32 v132, v132, v20, s[56:57]
  v_cndmask_b32 v133, v133, v20, s[58:59]
  v_cndmask_b32 v134, v134, v20, s[60:61]
  v_cndmask_b32 v135, v135, v20, s[62:63]
  v_cndmask_b32 v152, v152, v20, s[56:57]
  v_cndmask_b32 v153, v153, v20, s[58:59]
  v_cndmask_b32 v154, v154, v20, s[60:61]
  v_cndmask_b32 v155, v155, v20, s[62:63]
  v_cmp_gt_i32 s[56:57], 32, v1
  v_cmp_gt_i32 s[58:59], 33, v1
  v_cmp_gt_i32 s[60:61], 34, v1
  v_cmp_gt_i32 s[62:63], 35, v1
  v_cndmask_b32 v136, v136, v20, s[56:57]
  v_cndmask_b32 v137, v137, v20, s[58:59]
  v_cndmask_b32 v138, v138, v20, s[60:61]
  v_cndmask_b32 v139, v139, v20, s[62:63]
  v_cndmask_b32 v156, v156, v20, s[56:57]
  v_cndmask_b32 v157, v157, v20, s[58:59]
  v_cndmask_b32 v158, v158, v20, s[60:61]
  v_cndmask_b32 v159, v159, v20, s[62:63]
  v_cmp_gt_i32 s[56:57], 48, v1
  v_cmp_gt_i32 s[58:59], 49, v1
  v_cmp_gt_i32 s[60:61], 50, v1
  v_cmp_gt_i32 s[62:63], 51, v1
  v_cndmask_b32 v140, v140, v20, s[56:57]
  v_cndmask_b32 v141, v141, v20, s[58:59]
  v_cndmask_b32 v142, v142, v20, s[60:61]
  v_cndmask_b32 v143, v143, v20, s[62:63]
  s_nop 1
  s_branch L_k2_mkr_no
L_k2_fb_fi:
  s_nop 7
  v_max3_f32 v21, v192, v193, v194
  v_max3_f32 v21, v21, v195, v196
  v_max3_f32 v21, v21, v197, v198
  v_max3_f32 v21, v21, v199, v200
  v_max3_f32 v21, v21, v201, v202
  v_max3_f32 v21, v21, v203, v204
  v_max3_f32 v21, v21, v205, v206
  v_max_f32 v21, v21, v207
  v_mov_b32 v1, v21
  s_nop 1
  v_permlane16_swap_b32 v1, v21
  v_max_f32 v21, v21, v1
  v_mov_b32 v1, v21
  s_nop 1
  v_permlane32_swap_b32 v1, v21
  v_max_f32 v21, v21, v1
  v_add_f32 v21, 0x40e00000, v21
  v_max_f32 v21, 0, v21
  v_sub_f32 v192, v192, v21
  v_sub_f32 v193, v193, v21
  v_sub_f32 v194, v194, v21
  v_sub_f32 v195, v195, v21
  v_sub_f32 v196, v196, v21
  v_sub_f32 v197, v197, v21
  v_sub_f32 v198, v198, v21
  v_sub_f32 v199, v199, v21
  v_sub_f32 v200, v200, v21
  v_sub_f32 v201, v201, v21
  v_sub_f32 v202, v202, v21
  v_sub_f32 v203, v203, v21
  v_sub_f32 v204, v204, v21
  v_sub_f32 v205, v205, v21
  v_sub_f32 v206, v206, v21
  v_sub_f32 v207, v207, v21
  v_sub_f32 v32, v32, v21
  v_sub_f32 v33, v33, v21
  v_sub_f32 v34, v34, v21
  v_sub_f32 v35, v35, v21
  v_exp_f32 v22, -v21
  s_nop 0
  v_mul_f32 v48, v48, v22
  v_mul_f32 v49, v49, v22
  v_mul_f32 v50, v50, v22
  v_mul_f32 v51, v51, v22
  v_accvgpr_read_b32 v8, a0
  v_accvgpr_read_b32 v9, a1
  v_accvgpr_read_b32 v10, a2
  v_accvgpr_read_b32 v11, a3
  v_accvgpr_read_b32 v12, a4
  v_accvgpr_read_b32 v13, a5
  v_accvgpr_read_b32 v14, a6
  v_accvgpr_read_b32 v15, a7
  v_mul_f32 v8, v8, v22
  v_mul_f32 v9, v9, v22
  v_mul_f32 v10, v10, v22
  v_mul_f32 v11, v11, v22
  v_mul_f32 v12, v12, v22
  v_mul_f32 v13, v13, v22
  v_mul_f32 v14, v14, v22
  v_mul_f32 v15, v15, v22
  v_accvgpr_write_b32 a0, v8
  v_accvgpr_write_b32 a1, v9
  v_accvgpr_write_b32 a2, v10
  v_accvgpr_write_b32 a3, v11
  v_accvgpr_write_b32 a4, v12
  v_accvgpr_write_b32 a5, v13
  v_accvgpr_write_b32 a6, v14
  v_accvgpr_write_b32 a7, v15
  v_accvgpr_read_b32 v8, a8
  v_accvgpr_read_b32 v9, a9
  v_accvgpr_read_b32 v10, a10
  v_accvgpr_read_b32 v11, a11
  v_accvgpr_read_b32 v12, a12
  v_accvgpr_read_b32 v13, a13
  v_accvgpr_read_b32 v14, a14
  v_accvgpr_read_b32 v15, a15
  v_mul_f32 v8, v8, v22
  v_mul_f32 v9, v9, v22
  v_mul_f32 v10, v10, v22
  v_mul_f32 v11, v11, v22
  v_mul_f32 v12, v12, v22
  v_mul_f32 v13, v13, v22
  v_mul_f32 v14, v14, v22
  v_mul_f32 v15, v15, v22
  v_accvgpr_write_b32 a8, v8
  v_accvgpr_write_b32 a9, v9
  v_accvgpr_write_b32 a10, v10
  v_accvgpr_write_b32 a11, v11
  v_accvgpr_write_b32 a12, v12
  v_accvgpr_write_b32 a13, v13
  v_accvgpr_write_b32 a14, v14
  v_accvgpr_write_b32 a15, v15
  v_accvgpr_read_b32 v8, a16
  v_accvgpr_read_b32 v9, a17
  v_accvgpr_read_b32 v10, a18
  v_accvgpr_read_b32 v11, a19
  v_accvgpr_read_b32 v12, a20
  v_accvgpr_read_b32 v13, a21
  v_accvgpr_read_b32 v14, a22
  v_accvgpr_read_b32 v15, a23
  v_mul_f32 v8, v8, v22
  v_mul_f32 v9, v9, v22
  v_mul_f32 v10, v10, v22
  v_mul_f32 v11, v11, v22
  v_mul_f32 v12, v12, v22
  v_mul_f32 v13, v13, v22
  v_mul_f32 v14, v14, v22
  v_mul_f32 v15, v15, v22
  v_accvgpr_write_b32 a16, v8
  v_accvgpr_write_b32 a17, v9
  v_accvgpr_write_b32 a18, v10
  v_accvgpr_write_b32 a19, v11
  v_accvgpr_write_b32 a20, v12
  v_accvgpr_write_b32 a21, v13
  v_accvgpr_write_b32 a22, v14
  v_accvgpr_write_b32 a23, v15
  v_accvgpr_read_b32 v8, a24
  v_accvgpr_read_b32 v9, a25
  v_accvgpr_read_b32 v10, a26
  v_accvgpr_read_b32 v11, a27
  v_accvgpr_read_b32 v12, a28
  v_accvgpr_read_b32 v13, a29
  v_accvgpr_read_b32 v14, a30
  v_accvgpr_read_b32 v15, a31
  v_mul_f32 v8, v8, v22
  v_mul_f32 v9, v9, v22
  v_mul_f32 v10, v10, v22
  v_mul_f32 v11, v11, v22
  v_mul_f32 v12, v12, v22
  v_mul_f32 v13, v13, v22
  v_mul_f32 v14, v14, v22
  v_mul_f32 v15, v15, v22
  v_accvgpr_write_b32 a24, v8
  v_accvgpr_write_b32 a25, v9
  v_accvgpr_write_b32 a26, v10
  v_accvgpr_write_b32 a27, v11
  v_accvgpr_write_b32 a28, v12
  v_accvgpr_write_b32 a29, v13
  v_accvgpr_write_b32 a30, v14
  v_accvgpr_write_b32 a31, v15
  v_max3_f32 v21, v208, v209, v210
  v_max3_f32 v21, v21, v211, v212
  v_max3_f32 v21, v21, v213, v214
  v_max3_f32 v21, v21, v215, v216
  v_max3_f32 v21, v21, v217, v218
  v_max3_f32 v21, v21, v219, v220
  v_max3_f32 v21, v21, v221, v222
  v_max_f32 v21, v21, v223
  v_mov_b32 v1, v21
  s_nop 1
  v_permlane16_swap_b32 v1, v21
  v_max_f32 v21, v21, v1
  v_mov_b32 v1, v21
  s_nop 1
  v_permlane32_swap_b32 v1, v21
  v_max_f32 v21, v21, v1
  v_add_f32 v21, 0x40e00000, v21
  v_max_f32 v21, 0, v21
  v_sub_f32 v208, v208, v21
  v_sub_f32 v209, v209, v21
  v_sub_f32 v210, v210, v21
  v_sub_f32 v211, v211, v21
  v_sub_f32 v212, v212, v21
  v_sub_f32 v213, v213, v21
  v_sub_f32 v214, v214, v21
  v_sub_f32 v215, v215, v21
  v_sub_f32 v216, v216, v21
  v_sub_f32 v217, v217, v21
  v_sub_f32 v218, v218, v21
  v_sub_f32 v219, v219, v21
  v_sub_f32 v220, v220, v21
  v_sub_f32 v221, v221, v21
  v_sub_f32 v222, v222, v21
  v_sub_f32 v223, v223, v21
  v_sub_f32 v36, v36, v21
  v_sub_f32 v37, v37, v21
  v_sub_f32 v38, v38, v21
  v_sub_f32 v39, v39, v21
  v_exp_f32 v22, -v21
  s_nop 0
  v_mul_f32 v52, v52, v22
  v_mul_f32 v53, v53, v22
  v_mul_f32 v54, v54, v22
  v_mul_f32 v55, v55, v22
  v_accvgpr_read_b32 v8, a32
  v_accvgpr_read_b32 v9, a33
  v_accvgpr_read_b32 v10, a34
  v_accvgpr_read_b32 v11, a35
  v_accvgpr_read_b32 v12, a36
  v_accvgpr_read_b32 v13, a37
  v_accvgpr_read_b32 v14, a38
  v_accvgpr_read_b32 v15, a39
  v_mul_f32 v8, v8, v22
  v_mul_f32 v9, v9, v22
  v_mul_f32 v10, v10, v22
  v_mul_f32 v11, v11, v22
  v_mul_f32 v12, v12, v22
  v_mul_f32 v13, v13, v22
  v_mul_f32 v14, v14, v22
  v_mul_f32 v15, v15, v22
  v_accvgpr_write_b32 a32, v8
  v_accvgpr_write_b32 a33, v9
  v_accvgpr_write_b32 a34, v10
  v_accvgpr_write_b32 a35, v11
  v_accvgpr_write_b32 a36, v12
  v_accvgpr_write_b32 a37, v13
  v_accvgpr_write_b32 a38, v14
  v_accvgpr_write_b32 a39, v15
  v_accvgpr_read_b32 v8, a40
  v_accvgpr_read_b32 v9, a41
  v_accvgpr_read_b32 v10, a42
  v_accvgpr_read_b32 v11, a43
  v_accvgpr_read_b32 v12, a44
  v_accvgpr_read_b32 v13, a45
  v_accvgpr_read_b32 v14, a46
  v_accvgpr_read_b32 v15, a47
  v_mul_f32 v8, v8, v22
  v_mul_f32 v9, v9, v22
  v_mul_f32 v10, v10, v22
  v_mul_f32 v11, v11, v22
  v_mul_f32 v12, v12, v22
  v_mul_f32 v13, v13, v22
  v_mul_f32 v14, v14, v22
  v_mul_f32 v15, v15, v22
  v_accvgpr_write_b32 a40, v8
  v_accvgpr_write_b32 a41, v9
  v_accvgpr_write_b32 a42, v10
  v_accvgpr_write_b32 a43, v11
  v_accvgpr_write_b32 a44, v12
  v_accvgpr_write_b32 a45, v13
  v_accvgpr_write_b32 a46, v14
  v_accvgpr_write_b32 a47, v15
  v_accvgpr_read_b32 v8, a48
  v_accvgpr_read_b32 v9, a49
  v_accvgpr_read_b32 v10, a50
  v_accvgpr_read_b32 v11, a51
  v_accvgpr_read_b32 v12, a52
  v_accvgpr_read_b32 v13, a53
  v_accvgpr_read_b32 v14, a54
  v_accvgpr_read_b32 v15, a55
  v_mul_f32 v8, v8, v22
  v_mul_f32 v9, v9, v22
  v_mul_f32 v10, v10, v22
  v_mul_f32 v11, v11, v22
  v_mul_f32 v12, v12, v22
  v_mul_f32 v13, v13, v22
  v_mul_f32 v14, v14, v22
  v_mul_f32 v15, v15, v22
  v_accvgpr_write_b32 a48, v8
  v_accvgpr_write_b32 a49, v9
  v_accvgpr_write_b32 a50, v10
  v_accvgpr_write_b32 a51, v11
  v_accvgpr_write_b32 a52, v12
  v_accvgpr_write_b32 a53, v13
  v_accvgpr_write_b32 a54, v14
  v_accvgpr_write_b32 a55, v15
  v_accvgpr_read_b32 v8, a56
  v_accvgpr_read_b32 v9, a57
  v_accvgpr_read_b32 v10, a58
  v_accvgpr_read_b32 v11, a59
  v_accvgpr_read_b32 v12, a60
  v_accvgpr_read_b32 v13, a61
  v_accvgpr_read_b32 v14, a62
  v_accvgpr_read_b32 v15, a63
  v_mul_f32 v8, v8, v22
  v_mul_f32 v9, v9, v22
  v_mul_f32 v10, v10, v22
  v_mul_f32 v11, v11, v22
  v_mul_f32 v12, v12, v22
  v_mul_f32 v13, v13, v22
  v_mul_f32 v14, v14, v22
  v_mul_f32 v15, v15, v22
  v_accvgpr_write_b32 a56, v8
  v_accvgpr_write_b32 a57, v9
  v_accvgpr_write_b32 a58, v10
  v_accvgpr_write_b32 a59, v11
  v_accvgpr_write_b32 a60, v12
  v_accvgpr_write_b32 a61, v13
  v_accvgpr_write_b32 a62, v14
  v_accvgpr_write_b32 a63, v15
  v_exp_f32 v8, v192
  v_exp_f32 v9, v193
  s_nop 0
  v_cvt_pk_bf16_f32 v96, v8, v9
  v_exp_f32 v8, v194
  v_exp_f32 v9, v195
  s_nop 0
  v_cvt_pk_bf16_f32 v97, v8, v9
  v_exp_f32 v8, v208
  v_exp_f32 v9, v209
  s_nop 0
  v_cvt_pk_bf16_f32 v104, v8, v9
  v_exp_f32 v8, v210
  v_exp_f32 v9, v211
  s_nop 0
  v_cvt_pk_bf16_f32 v105, v8, v9
  v_exp_f32 v8, v196
  v_exp_f32 v9, v197
  s_nop 0
  v_cvt_pk_bf16_f32 v98, v8, v9
  v_exp_f32 v8, v198
  v_exp_f32 v9, v199
  s_nop 0
  v_cvt_pk_bf16_f32 v99, v8, v9
  v_exp_f32 v8, v212
  v_exp_f32 v9, v213
  s_nop 0
  v_cvt_pk_bf16_f32 v106, v8, v9
  v_exp_f32 v8, v214
  v_exp_f32 v9, v215
  s_nop 0
  v_cvt_pk_bf16_f32 v107, v8, v9
  v_exp_f32 v8, v200
  v_exp_f32 v9, v201
  s_nop 0
  v_cvt_pk_bf16_f32 v100, v8, v9
  v_exp_f32 v8, v202
  v_exp_f32 v9, v203
  s_nop 0
  v_cvt_pk_bf16_f32 v101, v8, v9
  v_exp_f32 v8, v216
  v_exp_f32 v9, v217
  s_nop 0
  v_cvt_pk_bf16_f32 v108, v8, v9
  v_exp_f32 v8, v218
  v_exp_f32 v9, v219
  s_nop 0
  v_cvt_pk_bf16_f32 v109, v8, v9
  v_exp_f32 v8, v204
  v_exp_f32 v9, v205
  s_nop 0
  v_cvt_pk_bf16_f32 v102, v8, v9
  v_exp_f32 v8, v206
  v_exp_f32 v9, v207
  s_nop 0
  v_cvt_pk_bf16_f32 v103, v8, v9
  v_exp_f32 v8, v220
  v_exp_f32 v9, v221
  s_nop 0
  v_cvt_pk_bf16_f32 v110, v8, v9
  v_exp_f32 v8, v222
  v_exp_f32 v9, v223
  s_nop 0
  v_cvt_pk_bf16_f32 v111, v8, v9
  s_nop 1
  s_branch L_k2_fbr_fi
.globl oproj_kernel
.p2align 8
.type oproj_kernel,@function
oproj_kernel:
  s_cmp_ge_u32 s2, 256
  s_cbranch_scc1 L_k3_end
  s_load_dwordx2 s[4:5], s[0:1], 40
  s_load_dwordx2 s[40:41], s[0:1], 0
  s_load_dwordx4 s[44:47], s[0:1], 80
  s_load_dwordx4 s[56:59], s[0:1], 96
  v_lshrrev_b32 v1, 6, v0
  v_lshrrev_b32 v10, 3, v0
  v_and_b32 v0, 63, v0
  v_readfirstlane_b32 s32, v1
  s_bfe_u32 s33, s2, 0x20001
  s_lshl_b32 s33, s33, 2
  s_bfe_u32 s3, s2, 0x20003
  s_add_u32 s33, s33, s3
  s_and_b32 s34, s2, 1
  s_lshl_b32 s34, s34, 3
  s_lshr_b32 s3, s2, 5
  s_add_u32 s34, s34, s3
  s_mov_b32 s48, 0
  s_mov_b32 s49, 15360
  s_mov_b32 s50, 30720
  s_mov_b32 s51, 46080
  s_lshl_b32 s35, s32, 15
  v_lshlrev_b32 v2, 4, v0
  v_add_u32 v3, 4096, v2
  v_lshrrev_b32 v12, 4, v0
  v_and_b32 v13, 7, v0
  v_lshrrev_b32 v14, 3, v0
  v_lshlrev_b32 v1, 1, v12
  v_xor_b32 v1, v1, v13
  v_lshlrev_b32 v1, 4, v1
  v_lshl_add_u32 v4, v14, 11, v1
  v_lshrrev_b32 v1, 2, v0
  v_bfe_u32 v11, v0, 3, 2
  v_lshlrev_b32 v1, 7, v1
  v_and_b32 v15, 3, v0
  v_lshl_add_u32 v1, v15, 3, v1
  v_add_u32 v1, s35, v1
  v_xor_b32 v15, 0, v11
  v_lshl_add_u32 v5, v15, 5, v1
  v_xor_b32 v15, 1, v11
  v_lshl_add_u32 v6, v15, 5, v1
  v_xor_b32 v15, 2, v11
  v_lshl_add_u32 v7, v15, 5, v1
  v_xor_b32 v15, 3, v11
  v_lshl_add_u32 v8, v15, 5, v1
  v_lshlrev_b32 v9, 11, v10
  v_lshl_add_u32 v9, v13, 4, v9
  s_waitcnt lgkmcnt(0)
  s_add_u32 s60, s58, 4243456
  s_addc_u32 s61, s59, 0
  s_load_dwordx4 s[52:55], s[60:61], 0
  s_mov_b32 s16, s58
  s_and_b32 s17, s59, 0xffff
  s_mov_b32 s18, 8388608
  s_mov_b32 s19, 0x20000
  s_mov_b32 s24, s44
  s_and_b32 s25, s45, 0xffff
  s_mov_b32 s26, 7340032
  s_mov_b32 s27, 0x20000
  s_lshl_b32 s36, s33, 18
  s_lshl_b32 s3, s34, 7
  s_add_u32 s36, s36, s3
  s_mov_b32 s20, s40
  s_and_b32 s21, s41, 0xffff
  s_mov_b32 s22, 4194304
  s_mov_b32 s23, 0x20000
  s_mov_b32 s28, s46
  s_and_b32 s29, s47, 0xffff
  s_mov_b32 s30, 4194304
  s_mov_b32 s31, 0x20000
  s_lshr_b32 s37, s2, 4
  s_lshl_b32 s3, s37, 2
  s_add_u32 s3, s3, s32
  s_mul_i32 s38, s3, 56
  s_lshl_b32 s3, s38, 2
  s_add_u32 s3, s3, 5242880
  v_mul_u32_u24 v1, 14336, v12
  v_and_b32 v15, 15, v0
  v_lshl_add_u32 v1, v15, 4, v1
  buffer_load_dwordx4 v[128:131], v1, s[16:19], s3 offen
  s_add_u32 s3, s3, 57344
  buffer_load_dwordx4 v[132:135], v1, s[16:19], s3 offen
  s_add_u32 s3, s3, 57344
  buffer_load_dwordx4 v[136:139], v1, s[16:19], s3 offen
  s_add_u32 s3, s3, 57344
  buffer_load_dwordx4 v[140:143], v1, s[16:19], s3 offen
  s_add_u32 s3, s3, 57344
  buffer_load_dwordx4 v[144:147], v1, s[16:19], s3 offen
  s_add_u32 s3, s3, 57344
  buffer_load_dwordx4 v[148:151], v1, s[16:19], s3 offen
  s_add_u32 s3, s3, 57344
  buffer_load_dwordx4 v[152:155], v1, s[16:19], s3 offen
  s_add_u32 s3, s3, 57344
  buffer_load_dwordx4 v[156:159], v1, s[16:19], s3 offen
  s_lshl_b32 s3, s38, 11
  s_and_b32 s39, s2, 15
  s_lshl_b32 s62, s39, 7
  s_add_u32 s3, s3, s62
  v_mul_u32_u24 v1, 14336, v14
  v_lshl_add_u32 v1, v13, 4, v1
  buffer_load_dwordx4 v[160:163], v1, s[24:27], s3 offen offset:0
  buffer_load_dwordx4 v[164:167], v1, s[24:27], s3 offen offset:2048
  s_add_u32 s3, s3, 4096
  buffer_load_dwordx4 v[168:171], v1, s[24:27], s3 offen offset:0
  buffer_load_dwordx4 v[172:175], v1, s[24:27], s3 offen offset:2048
  s_add_u32 s3, s3, 4096
  buffer_load_dwordx4 v[176:179], v1, s[24:27], s3 offen offset:0
  buffer_load_dwordx4 v[180:183], v1, s[24:27], s3 offen offset:2048
  s_add_u32 s3, s3, 4096
  buffer_load_dwordx4 v[184:187], v1, s[24:27], s3 offen offset:0
  s_mov_b32 s3, s36
  buffer_load_dwordx4 v[16:19], v9, s[20:23], s3 offen
  s_add_u32 s3, s3, 65536
  buffer_load_dwordx4 v[20:23], v9, s[20:23], s3 offen
  s_add_u32 s3, s3, 65536
  buffer_load_dwordx4 v[24:27], v9, s[20:23], s3 offen
  s_add_u32 s3, s3, 65536
  buffer_load_dwordx4 v[28:31], v9, s[20:23], s3 offen
  s_lshl_b32 s3, s33, 10
  s_add_u32 s3, s3, 4210688
  v_lshlrev_b32 v1, 3, v10
  buffer_load_dwordx2 v[32:33], v1, s[16:19], s3 offen offset:0
  buffer_load_dwordx2 v[34:35], v1, s[16:19], s3 offen offset:256
  buffer_load_dwordx2 v[36:37], v1, s[16:19], s3 offen offset:512
  buffer_load_dwordx2 v[38:39], v1, s[16:19], s3 offen offset:768
  s_lshl_b32 s3, s33, 20
  s_lshl_b32 s62, s32, 18
  s_add_u32 s3, s3, s62
  s_add_u32 s3, s3, 41943040
  s_add_u32 s8, s58, s3
  s_addc_u32 s9, s59, 0
  s_and_b32 s9, s9, 0xffff
  s_mov_b32 s10, 262144
  s_mov_b32 s11, 0x20000
  s_lshl_b32 s62, s34, 7
  s_lshl_b32 s3, s32, 21
  s_add_u32 s3, s3, s62
  s_add_u32 s12, s4, s3
  s_addc_u32 s13, s5, 0
  s_and_b32 s13, s13, 0xffff
  s_mov_b32 s14, 0
  s_mov_b32 s15, 0x20000
  s_sub_u32 s14, 2097152, s62
  s_mov_b32 s63, 0
  s_add_u32 m0, s35, 0
  s_nop 0
  buffer_load_dwordx4 v4, s[12:15], s48 offen offset:0 lds
  buffer_load_dwordx4 v4, s[12:15], s49 offen offset:1024 lds
  buffer_load_dwordx4 v4, s[12:15], s50 offen offset:2048 lds
  buffer_load_dwordx4 v4, s[12:15], s51 offen offset:3072 lds
  v_add_u32 v4, 65536, v4
  s_add_u32 m0, s35, 4096
  s_nop 0
  buffer_load_dwordx4 v4, s[12:15], s48 offen offset:0 lds
  buffer_load_dwordx4 v4, s[12:15], s49 offen offset:1024 lds
  buffer_load_dwordx4 v4, s[12:15], s50 offen offset:2048 lds
  buffer_load_dwordx4 v4, s[12:15], s51 offen offset:3072 lds
  v_add_u32 v4, 65536, v4
  buffer_load_dwordx4 a[0:3], v2, s[8:11], s63 offen offset:0
  buffer_load_dwordx4 a[4:7], v2, s[8:11], s63 offen offset:1024
  buffer_load_dwordx4 a[8:11], v2, s[8:11], s63 offen offset:2048
  buffer_load_dwordx4 a[12:15], v2, s[8:11], s63 offen offset:3072
  buffer_load_dwordx4 a[16:19], v3, s[8:11], s63 offen offset:0
  buffer_load_dwordx4 a[20:23], v3, s[8:11], s63 offen offset:1024
  buffer_load_dwordx4 a[24:27], v3, s[8:11], s63 offen offset:2048
  buffer_load_dwordx4 a[28:31], v3, s[8:11], s63 offen offset:3072
  s_add_u32 s63, s63, 8192
  s_add_u32 m0, s35, 8192
  s_nop 0
  buffer_load_dwordx4 v4, s[12:15], s48 offen offset:0 lds
  buffer_load_dwordx4 v4, s[12:15], s49 offen offset:1024 lds
  buffer_load_dwordx4 v4, s[12:15], s50 offen offset:2048 lds
  buffer_load_dwordx4 v4, s[12:15], s51 offen offset:3072 lds
  v_add_u32 v4, 65536, v4
  buffer_load_dwordx4 a[32:35], v2, s[8:11], s63 offen offset:0
  buffer_load_dwordx4 a[36:39], v2, s[8:11], s63 offen offset:1024
  buffer_load_dwordx4 a[40:43], v2, s[8:11], s63 offen offset:2048
  buffer_load_dwordx4 a[44:47], v2, s[8:11], s63 offen offset:3072
  buffer_load_dwordx4 a[48:51], v3, s[8:11], s63 offen offset:0
  buffer_load_dwordx4 a[52:55], v3, s[8:11], s63 offen offset:1024
  buffer_load_dwordx4 a[56:59], v3, s[8:11], s63 offen offset:2048
  buffer_load_dwordx4 a[60:63], v3, s[8:11], s63 offen offset:3072
  s_add_u32 s63, s63, 8192
  s_add_u32 m0, s35, 12288
  s_nop 0
  buffer_load_dwordx4 v4, s[12:15], s48 offen offset:0 lds
  buffer_load_dwordx4 v4, s[12:15], s49 offen offset:1024 lds
  buffer_load_dwordx4 v4, s[12:15], s50 offen offset:2048 lds
  buffer_load_dwordx4 v4, s[12:15], s51 offen offset:3072 lds
  v_add_u32 v4, 65536, v4
  buffer_load_dwordx4 a[64:67], v2, s[8:11], s63 offen offset:0
  buffer_load_dwordx4 a[68:71], v2, s[8:11], s63 offen offset:1024
  buffer_load_dwordx4 a[72:75], v2, s[8:11], s63 offen offset:2048
  buffer_load_dwordx4 a[76:79], v2, s[8:11], s63 offen offset:3072
  buffer_load_dwordx4 a[80:83], v3, s[8:11], s63 offen offset:0
  buffer_load_dwordx4 a[84:87], v3, s[8:11], s63 offen offset:1024
  buffer_load_dwordx4 a[88:91], v3, s[8:11], s63 offen offset:2048
  buffer_load_dwordx4 a[92:95], v3, s[8:11], s63 offen offset:3072
  s_add_u32 s63, s63, 8192
  s_waitcnt vmcnt(55)
  v_add_f32 v128, v128, v132
  v_add_f32 v129, v129, v133
  v_add_f32 v130, v130, v134
  v_add_f32 v131, v131, v135
  v_add_f32 v128, v128, v136
  v_add_f32 v129, v129, v137
  v_add_f32 v130, v130, v138
  v_add_f32 v131, v131, v139
  v_add_f32 v128, v128, v140
  v_add_f32 v129, v129, v141
  v_add_f32 v130, v130, v142
  v_add_f32 v131, v131, v143
  v_add_f32 v128, v128, v144
  v_add_f32 v129, v129, v145
  v_add_f32 v130, v130, v146
  v_add_f32 v131, v131, v147
  v_add_f32 v128, v128, v148
  v_add_f32 v129, v129, v149
  v_add_f32 v130, v130, v150
  v_add_f32 v131, v131, v151
  v_add_f32 v128, v128, v152
  v_add_f32 v129, v129, v153
  v_add_f32 v130, v130, v154
  v_add_f32 v131, v131, v155
  v_add_f32 v128, v128, v156
  v_add_f32 v129, v129, v157
  v_add_f32 v130, v130, v158
  v_add_f32 v131, v131, v159
  v_cvt_pk_bf16_f32 v1, v128, v129
  v_lshlrev_b32 v128, 16, v1
  v_and_b32 v129, 0xffff0000, v1
  v_cvt_pk_bf16_f32 v1, v130, v131
  v_lshlrev_b32 v130, 16, v1
  v_and_b32 v131, 0xffff0000, v1
  v_mov_b32 v132, v128
  v_mov_b32 v133, v129
  v_mov_b32 v134, v130
  v_mov_b32 v135, v131
  v_permlane32_swap_b32 v132, v128
  v_permlane32_swap_b32 v133, v129
  v_permlane32_swap_b32 v134, v130
  v_permlane32_swap_b32 v135, v131
  v_mul_f32 v136, 0xbfb8aa3b, v132
  v_mul_f32 v137, 0xbfb8aa3b, v133
  v_mul_f32 v138, 0xbfb8aa3b, v134
  v_mul_f32 v139, 0xbfb8aa3b, v135
  v_exp_f32 v136, v136
  v_exp_f32 v137, v137
  v_exp_f32 v138, v138
  v_exp_f32 v139, v139
  v_add_f32 v136, 1.0, v136
  v_add_f32 v137, 1.0, v137
  v_add_f32 v138, 1.0, v138
  v_add_f32 v139, 1.0, v139
  v_rcp_f32 v136, v136
  v_rcp_f32 v137, v137
  v_rcp_f32 v138, v138
  v_rcp_f32 v139, v139
  v_mul_f32 v132, v132, v136
  v_mul_f32 v133, v133, v137
  v_mul_f32 v134, v134, v138
  v_mul_f32 v135, v135, v139
  v_cvt_pk_bf16_f32 v1, v132, v133
  v_lshlrev_b32 v132, 16, v1
  v_and_b32 v133, 0xffff0000, v1
  v_cvt_pk_bf16_f32 v1, v134, v135
  v_lshlrev_b32 v134, 16, v1
  v_and_b32 v135, 0xffff0000, v1
  v_mul_f32 v128, v128, v132
  v_mul_f32 v129, v129, v133
  v_mul_f32 v130, v130, v134
  v_mul_f32 v131, v131, v135
  v_cvt_pk_bf16_f32 v1, v128, v129
  v_lshlrev_b32 v128, 16, v1
  v_and_b32 v129, 0xffff0000, v1
  v_cvt_pk_bf16_f32 v1, v130, v131
  v_lshlrev_b32 v130, 16, v1
  v_and_b32 v131, 0xffff0000, v1
  s_lshl_b32 s3, s32, 9
  s_add_u32 s3, s3, 131072
  v_and_b32 v1, 31, v0
  v_lshl_add_u32 v1, v1, 4, s3
  ds_write_b128 v1, v[128:131]
  v_mul_u32_u24 v1, 28, v14
  v_add_u32 v1, s3, v1
  s_waitcnt lgkmcnt(0)
  ds_read_b32 v132, v1 offset:0
  ds_read_b32 v133, v1 offset:4
  ds_read_b32 v134, v1 offset:8
  ds_read_b32 v135, v1 offset:12
  ds_read_b32 v136, v1 offset:16
  ds_read_b32 v137, v1 offset:20
  ds_read_b32 v138, v1 offset:24
  ds_read_b32 v139, v1 offset:256
  ds_read_b32 v140, v1 offset:260
  ds_read_b32 v141, v1 offset:264
  ds_read_b32 v142, v1 offset:268
  ds_read_b32 v143, v1 offset:272
  ds_read_b32 v144, v1 offset:276
  ds_read_b32 v145, v1 offset:280
  s_waitcnt vmcnt(48)
  s_waitcnt lgkmcnt(0)
  v_lshlrev_b32 v146, 16, v160
  v_and_b32 v147, 0xffff0000, v160
  v_mul_f32 v192, v146, v132
  v_mul_f32 v193, v147, v132
  v_mul_f32 v200, v146, v139
  v_mul_f32 v201, v147, v139
  v_lshlrev_b32 v146, 16, v161
  v_and_b32 v147, 0xffff0000, v161
  v_mul_f32 v194, v146, v132
  v_mul_f32 v195, v147, v132
  v_mul_f32 v202, v146, v139
  v_mul_f32 v203, v147, v139
  v_lshlrev_b32 v146, 16, v162
  v_and_b32 v147, 0xffff0000, v162
  v_mul_f32 v196, v146, v132
  v_mul_f32 v197, v147, v132
  v_mul_f32 v204, v146, v139
  v_mul_f32 v205, v147, v139
  v_lshlrev_b32 v146, 16, v163
  v_and_b32 v147, 0xffff0000, v163
  v_mul_f32 v198, v146, v132
  v_mul_f32 v199, v147, v132
  v_mul_f32 v206, v146, v139
  v_mul_f32 v207, v147, v139
  v_lshlrev_b32 v146, 16, v164
  v_and_b32 v147, 0xffff0000, v164
  v_fmac_f32 v192, v146, v133
  v_fmac_f32 v193, v147, v133
  v_fmac_f32 v200, v146, v140
  v_fmac_f32 v201, v147, v140
  v_lshlrev_b32 v146, 16, v165
  v_and_b32 v147, 0xffff0000, v165
  v_fmac_f32 v194, v146, v133
  v_fmac_f32 v195, v147, v133
  v_fmac_f32 v202, v146, v140
  v_fmac_f32 v203, v147, v140
  v_lshlrev_b32 v146, 16, v166
  v_and_b32 v147, 0xffff0000, v166
  v_fmac_f32 v196, v146, v133
  v_fmac_f32 v197, v147, v133
  v_fmac_f32 v204, v146, v140
  v_fmac_f32 v205, v147, v140
  v_lshlrev_b32 v146, 16, v167
  v_and_b32 v147, 0xffff0000, v167
  v_fmac_f32 v198, v146, v133
  v_fmac_f32 v199, v147, v133
  v_fmac_f32 v206, v146, v140
  v_fmac_f32 v207, v147, v140
  v_lshlrev_b32 v146, 16, v168
  v_and_b32 v147, 0xffff0000, v168
  v_fmac_f32 v192, v146, v134
  v_fmac_f32 v193, v147, v134
  v_fmac_f32 v200, v146, v141
  v_fmac_f32 v201, v147, v141
  v_lshlrev_b32 v146, 16, v169
  v_and_b32 v147, 0xffff0000, v169
  v_fmac_f32 v194, v146, v134
  v_fmac_f32 v195, v147, v134
  v_fmac_f32 v202, v146, v141
  v_fmac_f32 v203, v147, v141
  v_lshlrev_b32 v146, 16, v170
  v_and_b32 v147, 0xffff0000, v170
  v_fmac_f32 v196, v146, v134
  v_fmac_f32 v197, v147, v134
  v_fmac_f32 v204, v146, v141
  v_fmac_f32 v205, v147, v141
  v_lshlrev_b32 v146, 16, v171
  v_and_b32 v147, 0xffff0000, v171
  v_fmac_f32 v198, v146, v134
  v_fmac_f32 v199, v147, v134
  v_fmac_f32 v206, v146, v141
  v_fmac_f32 v207, v147, v141
  v_lshlrev_b32 v146, 16, v172
  v_and_b32 v147, 0xffff0000, v172
  v_fmac_f32 v192, v146, v135
  v_fmac_f32 v193, v147, v135
  v_fmac_f32 v200, v146, v142
  v_fmac_f32 v201, v147, v142
  v_lshlrev_b32 v146, 16, v173
  v_and_b32 v147, 0xffff0000, v173
  v_fmac_f32 v194, v146, v135
  v_fmac_f32 v195, v147, v135
  v_fmac_f32 v202, v146, v142
  v_fmac_f32 v203, v147, v142
  v_lshlrev_b32 v146, 16, v174
  v_and_b32 v147, 0xffff0000, v174
  v_fmac_f32 v196, v146, v135
  v_fmac_f32 v197, v147, v135
  v_fmac_f32 v204, v146, v142
  v_fmac_f32 v205, v147, v142
  v_lshlrev_b32 v146, 16, v175
  v_and_b32 v147, 0xffff0000, v175
  v_fmac_f32 v198, v146, v135
  v_fmac_f32 v199, v147, v135
  v_fmac_f32 v206, v146, v142
  v_fmac_f32 v207, v147, v142
  v_lshlrev_b32 v146, 16, v176
  v_and_b32 v147, 0xffff0000, v176
  v_fmac_f32 v192, v146, v136
  v_fmac_f32 v193, v147, v136
  v_fmac_f32 v200, v146, v143
  v_fmac_f32 v201, v147, v143
  v_lshlrev_b32 v146, 16, v177
  v_and_b32 v147, 0xffff0000, v177
  v_fmac_f32 v194, v146, v136
  v_fmac_f32 v195, v147, v136
  v_fmac_f32 v202, v146, v143
  v_fmac_f32 v203, v147, v143
  v_lshlrev_b32 v146, 16, v178
  v_and_b32 v147, 0xffff0000, v178
  v_fmac_f32 v196, v146, v136
  v_fmac_f32 v197, v147, v136
  v_fmac_f32 v204, v146, v143
  v_fmac_f32 v205, v147, v143
  v_lshlrev_b32 v146, 16, v179
  v_and_b32 v147, 0xffff0000, v179
  v_fmac_f32 v198, v146, v136
  v_fmac_f32 v199, v147, v136
  v_fmac_f32 v206, v146, v143
  v_fmac_f32 v207, v147, v143
  v_lshlrev_b32 v146, 16, v180
  v_and_b32 v147, 0xffff0000, v180
  v_fmac_f32 v192, v146, v137
  v_fmac_f32 v193, v147, v137
  v_fmac_f32 v200, v146, v144
  v_fmac_f32 v201, v147, v144
  v_lshlrev_b32 v146, 16, v181
  v_and_b32 v147, 0xffff0000, v181
  v_fmac_f32 v194, v146, v137
  v_fmac_f32 v195, v147, v137
  v_fmac_f32 v202, v146, v144
  v_fmac_f32 v203, v147, v144
  v_lshlrev_b32 v146, 16, v182
  v_and_b32 v147, 0xffff0000, v182
  v_fmac_f32 v196, v146, v137
  v_fmac_f32 v197, v147, v137
  v_fmac_f32 v204, v146, v144
  v_fmac_f32 v205, v147, v144
  v_lshlrev_b32 v146, 16, v183
  v_and_b32 v147, 0xffff0000, v183
  v_fmac_f32 v198, v146, v137
  v_fmac_f32 v199, v147, v137
  v_fmac_f32 v206, v146, v144
  v_fmac_f32 v207, v147, v144
  v_lshlrev_b32 v146, 16, v184
  v_and_b32 v147, 0xffff0000, v184
  v_fmac_f32 v192, v146, v138
  v_fmac_f32 v193, v147, v138
  v_fmac_f32 v200, v146, v145
  v_fmac_f32 v201, v147, v145
  v_lshlrev_b32 v146, 16, v185
  v_and_b32 v147, 0xffff0000, v185
  v_fmac_f32 v194, v146, v138
  v_fmac_f32 v195, v147, v138
  v_fmac_f32 v202, v146, v145
  v_fmac_f32 v203, v147, v145
  v_lshlrev_b32 v146, 16, v186
  v_and_b32 v147, 0xffff0000, v186
  v_fmac_f32 v196, v146, v138
  v_fmac_f32 v197, v147, v138
  v_fmac_f32 v204, v146, v145
  v_fmac_f32 v205, v147, v145
  v_lshlrev_b32 v146, 16, v187
  v_and_b32 v147, 0xffff0000, v187
  v_fmac_f32 v198, v146, v138
  v_fmac_f32 v199, v147, v138
  v_fmac_f32 v206, v146, v145
  v_fmac_f32 v207, v147, v145
  v_permlane32_swap_b32 v192, v200
  v_permlane32_swap_b32 v193, v201
  v_permlane32_swap_b32 v194, v202
  v_permlane32_swap_b32 v195, v203
  v_permlane32_swap_b32 v196, v204
  v_permlane32_swap_b32 v197, v205
  v_permlane32_swap_b32 v198, v206
  v_permlane32_swap_b32 v199, v207
  v_add_f32 v192, v192, v200
  v_add_f32 v193, v193, v201
  v_add_f32 v194, v194, v202
  v_add_f32 v195, v195, v203
  v_add_f32 v196, v196, v204
  v_add_f32 v197, v197, v205
  v_add_f32 v198, v198, v206
  v_add_f32 v199, v199, v207
  v_permlane16_swap_b32 v192, v196
  v_permlane16_swap_b32 v193, v197
  v_permlane16_swap_b32 v194, v198
  v_permlane16_swap_b32 v195, v199
  v_add_f32 v192, v192, v196
  v_add_f32 v193, v193, v197
  v_add_f32 v194, v194, v198
  v_add_f32 v195, v195, v199
  v_add_f32_dpp v192, v192, v192 row_ror:8 row_mask:0xf bank_mask:0xf
  v_add_f32_dpp v193, v193, v193 row_ror:8 row_mask:0xf bank_mask:0xf
  v_add_f32_dpp v194, v194, v194 row_ror:8 row_mask:0xf bank_mask:0xf
  v_add_f32_dpp v195, v195, v195 row_ror:8 row_mask:0xf bank_mask:0xf
  v_lshrrev_b32 v1, 5, v0
  v_lshlrev_b32 v1, 8, v1
  v_lshl_add_u32 v1, v13, 5, v1
  v_and_b32 v15, 1, v12
  v_lshl_add_u32 v1, v15, 4, v1
  v_add_u32 v1, s3, v1
  ds_write_b128 v1, v[192:195] offset:2048
  s_waitcnt lgkmcnt(0)
  s_barrier
  s_cmp_lg_u32 s32, 0
  s_cbranch_scc1 L_k3_nopub
  v_lshlrev_b32 v1, 3, v0
  v_add_u32 v15, 133120, v1
  ds_read_b64 v[192:193], v15 offset:0
  ds_read_b64 v[194:195], v15 offset:512
  ds_read_b64 v[196:197], v15 offset:1024
  ds_read_b64 v[198:199], v15 offset:1536
  s_lshl_b32 s3, s39, 4
  s_add_u32 s3, s3, s37
  s_lshl_b32 s3, s3, 9
  s_add_u32 s3, s3, 4259840
  s_waitcnt lgkmcnt(0)
  v_add_f32 v192, v192, v194
  v_add_f32 v196, v196, v198
  v_add_f32 v192, v192, v196
  v_add_f32 v193, v193, v195
  v_add_f32 v197, v197, v199
  v_add_f32 v193, v193, v197
  buffer_store_dwordx2 v[192:193], v1, s[16:19], s3 offen sc1
L_k3_nopub:
  s_waitcnt vmcnt(40)
  v_lshlrev_b32 v40, 16, v16
  v_and_b32 v41, 0xffff0000, v16
  v_lshlrev_b32 v42, 16, v17
  v_and_b32 v43, 0xffff0000, v17
  v_lshlrev_b32 v44, 16, v18
  v_and_b32 v45, 0xffff0000, v18
  v_lshlrev_b32 v46, 16, v19
  v_and_b32 v47, 0xffff0000, v19
  v_sub_f32 v40, v40, v32
  v_sub_f32 v41, v41, v32
  v_sub_f32 v42, v42, v32
  v_sub_f32 v43, v43, v32
  v_sub_f32 v44, v44, v32
  v_sub_f32 v45, v45, v32
  v_sub_f32 v46, v46, v32
  v_sub_f32 v47, v47, v32
  v_cvt_pk_bf16_f32 v72, v40, v41
  v_lshlrev_b32 v40, 16, v72
  v_and_b32 v41, 0xffff0000, v72
  v_cvt_pk_bf16_f32 v73, v42, v43
  v_lshlrev_b32 v42, 16, v73
  v_and_b32 v43, 0xffff0000, v73
  v_cvt_pk_bf16_f32 v74, v44, v45
  v_lshlrev_b32 v44, 16, v74
  v_and_b32 v45, 0xffff0000, v74
  v_cvt_pk_bf16_f32 v75, v46, v47
  v_lshlrev_b32 v46, 16, v75
  v_and_b32 v47, 0xffff0000, v75
  v_mul_f32 v40, v40, v33
  v_mul_f32 v41, v41, v33
  v_mul_f32 v42, v42, v33
  v_mul_f32 v43, v43, v33
  v_mul_f32 v44, v44, v33
  v_mul_f32 v45, v45, v33
  v_mul_f32 v46, v46, v33
  v_mul_f32 v47, v47, v33
  v_cvt_pk_bf16_f32 v72, v40, v41
  v_lshlrev_b32 v40, 16, v72
  v_and_b32 v41, 0xffff0000, v72
  v_cvt_pk_bf16_f32 v73, v42, v43
  v_lshlrev_b32 v42, 16, v73
  v_and_b32 v43, 0xffff0000, v73
  v_cvt_pk_bf16_f32 v74, v44, v45
  v_lshlrev_b32 v44, 16, v74
  v_and_b32 v45, 0xffff0000, v74
  v_cvt_pk_bf16_f32 v75, v46, v47
  v_lshlrev_b32 v46, 16, v75
  v_and_b32 v47, 0xffff0000, v75
  v_mul_f32 v72, 0xbfb8aa3b, v40
  v_mul_f32 v73, 0xbfb8aa3b, v41
  v_mul_f32 v74, 0xbfb8aa3b, v42
  v_mul_f32 v75, 0xbfb8aa3b, v43
  v_mul_f32 v76, 0xbfb8aa3b, v44
  v_mul_f32 v77, 0xbfb8aa3b, v45
  v_mul_f32 v78, 0xbfb8aa3b, v46
  v_mul_f32 v79, 0xbfb8aa3b, v47
  v_exp_f32 v72, v72
  v_exp_f32 v73, v73
  v_exp_f32 v74, v74
  v_exp_f32 v75, v75
  v_exp_f32 v76, v76
  v_exp_f32 v77, v77
  v_exp_f32 v78, v78
  v_exp_f32 v79, v79
  v_add_f32 v72, 1.0, v72
  v_add_f32 v73, 1.0, v73
  v_add_f32 v74, 1.0, v74
  v_add_f32 v75, 1.0, v75
  v_add_f32 v76, 1.0, v76
  v_add_f32 v77, 1.0, v77
  v_add_f32 v78, 1.0, v78
  v_add_f32 v79, 1.0, v79
  v_rcp_f32 v72, v72
  v_rcp_f32 v73, v73
  v_rcp_f32 v74, v74
  v_rcp_f32 v75, v75
  v_rcp_f32 v76, v76
  v_rcp_f32 v77, v77
  v_rcp_f32 v78, v78
  v_rcp_f32 v79, v79
  v_mul_f32 v40, v40, v72
  v_mul_f32 v41, v41, v73
  v_mul_f32 v42, v42, v74
  v_mul_f32 v43, v43, v75
  v_mul_f32 v44, v44, v76
  v_mul_f32 v45, v45, v77
  v_mul_f32 v46, v46, v78
  v_mul_f32 v47, v47, v79
  v_cvt_pk_bf16_f32 v72, v40, v41
  v_lshlrev_b32 v40, 16, v72
  v_and_b32 v41, 0xffff0000, v72
  v_cvt_pk_bf16_f32 v73, v42, v43
  v_lshlrev_b32 v42, 16, v73
  v_and_b32 v43, 0xffff0000, v73
  v_cvt_pk_bf16_f32 v74, v44, v45
  v_lshlrev_b32 v44, 16, v74
  v_and_b32 v45, 0xffff0000, v74
  v_cvt_pk_bf16_f32 v75, v46, v47
  v_lshlrev_b32 v46, 16, v75
  v_and_b32 v47, 0xffff0000, v75
  v_lshlrev_b32 v48, 16, v20
  v_and_b32 v49, 0xffff0000, v20
  v_lshlrev_b32 v50, 16, v21
  v_and_b32 v51, 0xffff0000, v21
  v_lshlrev_b32 v52, 16, v22
  v_and_b32 v53, 0xffff0000, v22
  v_lshlrev_b32 v54, 16, v23
  v_and_b32 v55, 0xffff0000, v23
  v_sub_f32 v48, v48, v34
  v_sub_f32 v49, v49, v34
  v_sub_f32 v50, v50, v34
  v_sub_f32 v51, v51, v34
  v_sub_f32 v52, v52, v34
  v_sub_f32 v53, v53, v34
  v_sub_f32 v54, v54, v34
  v_sub_f32 v55, v55, v34
  v_cvt_pk_bf16_f32 v72, v48, v49
  v_lshlrev_b32 v48, 16, v72
  v_and_b32 v49, 0xffff0000, v72
  v_cvt_pk_bf16_f32 v73, v50, v51
  v_lshlrev_b32 v50, 16, v73
  v_and_b32 v51, 0xffff0000, v73
  v_cvt_pk_bf16_f32 v74, v52, v53
  v_lshlrev_b32 v52, 16, v74
  v_and_b32 v53, 0xffff0000, v74
  v_cvt_pk_bf16_f32 v75, v54, v55
  v_lshlrev_b32 v54, 16, v75
  v_and_b32 v55, 0xffff0000, v75
  v_mul_f32 v48, v48, v35
  v_mul_f32 v49, v49, v35
  v_mul_f32 v50, v50, v35
  v_mul_f32 v51, v51, v35
  v_mul_f32 v52, v52, v35
  v_mul_f32 v53, v53, v35
  v_mul_f32 v54, v54, v35
  v_mul_f32 v55, v55, v35
  v_cvt_pk_bf16_f32 v72, v48, v49
  v_lshlrev_b32 v48, 16, v72
  v_and_b32 v49, 0xffff0000, v72
  v_cvt_pk_bf16_f32 v73, v50, v51
  v_lshlrev_b32 v50, 16, v73
  v_and_b32 v51, 0xffff0000, v73
  v_cvt_pk_bf16_f32 v74, v52, v53
  v_lshlrev_b32 v52, 16, v74
  v_and_b32 v53, 0xffff0000, v74
  v_cvt_pk_bf16_f32 v75, v54, v55
  v_lshlrev_b32 v54, 16, v75
  v_and_b32 v55, 0xffff0000, v75
  v_mul_f32 v72, 0xbfb8aa3b, v48
  v_mul_f32 v73, 0xbfb8aa3b, v49
  v_mul_f32 v74, 0xbfb8aa3b, v50
  v_mul_f32 v75, 0xbfb8aa3b, v51
  v_mul_f32 v76, 0xbfb8aa3b, v52
  v_mul_f32 v77, 0xbfb8aa3b, v53
  v_mul_f32 v78, 0xbfb8aa3b, v54
  v_mul_f32 v79, 0xbfb8aa3b, v55
  v_exp_f32 v72, v72
  v_exp_f32 v73, v73
  v_exp_f32 v74, v74
  v_exp_f32 v75, v75
  v_exp_f32 v76, v76
  v_exp_f32 v77, v77
  v_exp_f32 v78, v78
  v_exp_f32 v79, v79
  v_add_f32 v72, 1.0, v72
  v_add_f32 v73, 1.0, v73
  v_add_f32 v74, 1.0, v74
  v_add_f32 v75, 1.0, v75
  v_add_f32 v76, 1.0, v76
  v_add_f32 v77, 1.0, v77
  v_add_f32 v78, 1.0, v78
  v_add_f32 v79, 1.0, v79
  v_rcp_f32 v72, v72
  v_rcp_f32 v73, v73
  v_rcp_f32 v74, v74
  v_rcp_f32 v75, v75
  v_rcp_f32 v76, v76
  v_rcp_f32 v77, v77
  v_rcp_f32 v78, v78
  v_rcp_f32 v79, v79
  v_mul_f32 v48, v48, v72
  v_mul_f32 v49, v49, v73
  v_mul_f32 v50, v50, v74
  v_mul_f32 v51, v51, v75
  v_mul_f32 v52, v52, v76
  v_mul_f32 v53, v53, v77
  v_mul_f32 v54, v54, v78
  v_mul_f32 v55, v55, v79
  v_cvt_pk_bf16_f32 v72, v48, v49
  v_lshlrev_b32 v48, 16, v72
  v_and_b32 v49, 0xffff0000, v72
  v_cvt_pk_bf16_f32 v73, v50, v51
  v_lshlrev_b32 v50, 16, v73
  v_and_b32 v51, 0xffff0000, v73
  v_cvt_pk_bf16_f32 v74, v52, v53
  v_lshlrev_b32 v52, 16, v74
  v_and_b32 v53, 0xffff0000, v74
  v_cvt_pk_bf16_f32 v75, v54, v55
  v_lshlrev_b32 v54, 16, v75
  v_and_b32 v55, 0xffff0000, v75
  v_lshlrev_b32 v56, 16, v24
  v_and_b32 v57, 0xffff0000, v24
  v_lshlrev_b32 v58, 16, v25
  v_and_b32 v59, 0xffff0000, v25
  v_lshlrev_b32 v60, 16, v26
  v_and_b32 v61, 0xffff0000, v26
  v_lshlrev_b32 v62, 16, v27
  v_and_b32 v63, 0xffff0000, v27
  v_sub_f32 v56, v56, v36
  v_sub_f32 v57, v57, v36
  v_sub_f32 v58, v58, v36
  v_sub_f32 v59, v59, v36
  v_sub_f32 v60, v60, v36
  v_sub_f32 v61, v61, v36
  v_sub_f32 v62, v62, v36
  v_sub_f32 v63, v63, v36
  v_cvt_pk_bf16_f32 v72, v56, v57
  v_lshlrev_b32 v56, 16, v72
  v_and_b32 v57, 0xffff0000, v72
  v_cvt_pk_bf16_f32 v73, v58, v59
  v_lshlrev_b32 v58, 16, v73
  v_and_b32 v59, 0xffff0000, v73
  v_cvt_pk_bf16_f32 v74, v60, v61
  v_lshlrev_b32 v60, 16, v74
  v_and_b32 v61, 0xffff0000, v74
  v_cvt_pk_bf16_f32 v75, v62, v63
  v_lshlrev_b32 v62, 16, v75
  v_and_b32 v63, 0xffff0000, v75
  v_mul_f32 v56, v56, v37
  v_mul_f32 v57, v57, v37
  v_mul_f32 v58, v58, v37
  v_mul_f32 v59, v59, v37
  v_mul_f32 v60, v60, v37
  v_mul_f32 v61, v61, v37
  v_mul_f32 v62, v62, v37
  v_mul_f32 v63, v63, v37
  v_cvt_pk_bf16_f32 v72, v56, v57
  v_lshlrev_b32 v56, 16, v72
  v_and_b32 v57, 0xffff0000, v72
  v_cvt_pk_bf16_f32 v73, v58, v59
  v_lshlrev_b32 v58, 16, v73
  v_and_b32 v59, 0xffff0000, v73
  v_cvt_pk_bf16_f32 v74, v60, v61
  v_lshlrev_b32 v60, 16, v74
  v_and_b32 v61, 0xffff0000, v74
  v_cvt_pk_bf16_f32 v75, v62, v63
  v_lshlrev_b32 v62, 16, v75
  v_and_b32 v63, 0xffff0000, v75
  v_mul_f32 v72, 0xbfb8aa3b, v56
  v_mul_f32 v73, 0xbfb8aa3b, v57
  v_mul_f32 v74, 0xbfb8aa3b, v58
  v_mul_f32 v75, 0xbfb8aa3b, v59
  v_mul_f32 v76, 0xbfb8aa3b, v60
  v_mul_f32 v77, 0xbfb8aa3b, v61
  v_mul_f32 v78, 0xbfb8aa3b, v62
  v_mul_f32 v79, 0xbfb8aa3b, v63
  v_exp_f32 v72, v72
  v_exp_f32 v73, v73
  v_exp_f32 v74, v74
  v_exp_f32 v75, v75
  v_exp_f32 v76, v76
  v_exp_f32 v77, v77
  v_exp_f32 v78, v78
  v_exp_f32 v79, v79
  v_add_f32 v72, 1.0, v72
  v_add_f32 v73, 1.0, v73
  v_add_f32 v74, 1.0, v74
  v_add_f32 v75, 1.0, v75
  v_add_f32 v76, 1.0, v76
  v_add_f32 v77, 1.0, v77
  v_add_f32 v78, 1.0, v78
  v_add_f32 v79, 1.0, v79
  v_rcp_f32 v72, v72
  v_rcp_f32 v73, v73
  v_rcp_f32 v74, v74
  v_rcp_f32 v75, v75
  v_rcp_f32 v76, v76
  v_rcp_f32 v77, v77
  v_rcp_f32 v78, v78
  v_rcp_f32 v79, v79
  v_mul_f32 v56, v56, v72
  v_mul_f32 v57, v57, v73
  v_mul_f32 v58, v58, v74
  v_mul_f32 v59, v59, v75
  v_mul_f32 v60, v60, v76
  v_mul_f32 v61, v61, v77
  v_mul_f32 v62, v62, v78
  v_mul_f32 v63, v63, v79
  v_cvt_pk_bf16_f32 v72, v56, v57
  v_lshlrev_b32 v56, 16, v72
  v_and_b32 v57, 0xffff0000, v72
  v_cvt_pk_bf16_f32 v73, v58, v59
  v_lshlrev_b32 v58, 16, v73
  v_and_b32 v59, 0xffff0000, v73
  v_cvt_pk_bf16_f32 v74, v60, v61
  v_lshlrev_b32 v60, 16, v74
  v_and_b32 v61, 0xffff0000, v74
  v_cvt_pk_bf16_f32 v75, v62, v63
  v_lshlrev_b32 v62, 16, v75
  v_and_b32 v63, 0xffff0000, v75
  v_lshlrev_b32 v64, 16, v28
  v_and_b32 v65, 0xffff0000, v28
  v_lshlrev_b32 v66, 16, v29
  v_and_b32 v67, 0xffff0000, v29
  v_lshlrev_b32 v68, 16, v30
  v_and_b32 v69, 0xffff0000, v30
  v_lshlrev_b32 v70, 16, v31
  v_and_b32 v71, 0xffff0000, v31
  v_sub_f32 v64, v64, v38
  v_sub_f32 v65, v65, v38
  v_sub_f32 v66, v66, v38
  v_sub_f32 v67, v67, v38
  v_sub_f32 v68, v68, v38
  v_sub_f32 v69, v69, v38
  v_sub_f32 v70, v70, v38
  v_sub_f32 v71, v71, v38
  v_cvt_pk_bf16_f32 v72, v64, v65
  v_lshlrev_b32 v64, 16, v72
  v_and_b32 v65, 0xffff0000, v72
  v_cvt_pk_bf16_f32 v73, v66, v67
  v_lshlrev_b32 v66, 16, v73
  v_and_b32 v67, 0xffff0000, v73
  v_cvt_pk_bf16_f32 v74, v68, v69
  v_lshlrev_b32 v68, 16, v74
  v_and_b32 v69, 0xffff0000, v74
  v_cvt_pk_bf16_f32 v75, v70, v71
  v_lshlrev_b32 v70, 16, v75
  v_and_b32 v71, 0xffff0000, v75
  v_mul_f32 v64, v64, v39
  v_mul_f32 v65, v65, v39
  v_mul_f32 v66, v66, v39
  v_mul_f32 v67, v67, v39
  v_mul_f32 v68, v68, v39
  v_mul_f32 v69, v69, v39
  v_mul_f32 v70, v70, v39
  v_mul_f32 v71, v71, v39
  v_cvt_pk_bf16_f32 v72, v64, v65
  v_lshlrev_b32 v64, 16, v72
  v_and_b32 v65, 0xffff0000, v72
  v_cvt_pk_bf16_f32 v73, v66, v67
  v_lshlrev_b32 v66, 16, v73
  v_and_b32 v67, 0xffff0000, v73
  v_cvt_pk_bf16_f32 v74, v68, v69
  v_lshlrev_b32 v68, 16, v74
  v_and_b32 v69, 0xffff0000, v74
  v_cvt_pk_bf16_f32 v75, v70, v71
  v_lshlrev_b32 v70, 16, v75
  v_and_b32 v71, 0xffff0000, v75
  v_mul_f32 v72, 0xbfb8aa3b, v64
  v_mul_f32 v73, 0xbfb8aa3b, v65
  v_mul_f32 v74, 0xbfb8aa3b, v66
  v_mul_f32 v75, 0xbfb8aa3b, v67
  v_mul_f32 v76, 0xbfb8aa3b, v68
  v_mul_f32 v77, 0xbfb8aa3b, v69
  v_mul_f32 v78, 0xbfb8aa3b, v70
  v_mul_f32 v79, 0xbfb8aa3b, v71
  v_exp_f32 v72, v72
  v_exp_f32 v73, v73
  v_exp_f32 v74, v74
  v_exp_f32 v75, v75
  v_exp_f32 v76, v76
  v_exp_f32 v77, v77
  v_exp_f32 v78, v78
  v_exp_f32 v79, v79
  v_add_f32 v72, 1.0, v72
  v_add_f32 v73, 1.0, v73
  v_add_f32 v74, 1.0, v74
  v_add_f32 v75, 1.0, v75
  v_add_f32 v76, 1.0, v76
  v_add_f32 v77, 1.0, v77
  v_add_f32 v78, 1.0, v78
  v_add_f32 v79, 1.0, v79
  v_rcp_f32 v72, v72
  v_rcp_f32 v73, v73
  v_rcp_f32 v74, v74
  v_rcp_f32 v75, v75
  v_rcp_f32 v76, v76
  v_rcp_f32 v77, v77
  v_rcp_f32 v78, v78
  v_rcp_f32 v79, v79
  v_mul_f32 v64, v64, v72
  v_mul_f32 v65, v65, v73
  v_mul_f32 v66, v66, v74
  v_mul_f32 v67, v67, v75
  v_mul_f32 v68, v68, v76
  v_mul_f32 v69, v69, v77
  v_mul_f32 v70, v70, v78
  v_mul_f32 v71, v71, v79
  v_cvt_pk_bf16_f32 v72, v64, v65
  v_lshlrev_b32 v64, 16, v72
  v_and_b32 v65, 0xffff0000, v72
  v_cvt_pk_bf16_f32 v73, v66, v67
  v_lshlrev_b32 v66, 16, v73
  v_and_b32 v67, 0xffff0000, v73
  v_cvt_pk_bf16_f32 v74, v68, v69
  v_lshlrev_b32 v68, 16, v74
  v_and_b32 v69, 0xffff0000, v74
  v_cvt_pk_bf16_f32 v75, v70, v71
  v_lshlrev_b32 v70, 16, v75
  v_and_b32 v71, 0xffff0000, v75
  v_mov_b32 v128, 0
  v_mov_b32 v129, 0
  v_mov_b32 v130, 0
  v_mov_b32 v131, 0
  v_mov_b32 v132, 0
  v_mov_b32 v133, 0
  v_mov_b32 v134, 0
  v_mov_b32 v135, 0
  v_mov_b32 v136, 0
  v_mov_b32 v137, 0
  v_mov_b32 v138, 0
  v_mov_b32 v139, 0
  v_mov_b32 v140, 0
  v_mov_b32 v141, 0
  v_mov_b32 v142, 0
  v_mov_b32 v143, 0
  v_mov_b32 v144, 0
  v_mov_b32 v145, 0
  v_mov_b32 v146, 0
  v_mov_b32 v147, 0
  v_mov_b32 v148, 0
  v_mov_b32 v149, 0
  v_mov_b32 v150, 0
  v_mov_b32 v151, 0
  v_mov_b32 v152, 0
  v_mov_b32 v153, 0
  v_mov_b32 v154, 0
  v_mov_b32 v155, 0
  v_mov_b32 v156, 0
  v_mov_b32 v157, 0
  v_mov_b32 v158, 0
  v_mov_b32 v159, 0
  v_mov_b32 v160, 0
  v_mov_b32 v161, 0
  v_mov_b32 v162, 0
  v_mov_b32 v163, 0
  v_mov_b32 v164, 0
  v_mov_b32 v165, 0
  v_mov_b32 v166, 0
  v_mov_b32 v167, 0
  v_mov_b32 v168, 0
  v_mov_b32 v169, 0
  v_mov_b32 v170, 0
  v_mov_b32 v171, 0
  v_mov_b32 v172, 0
  v_mov_b32 v173, 0
  v_mov_b32 v174, 0
  v_mov_b32 v175, 0
  v_mov_b32 v176, 0
  v_mov_b32 v177, 0
  v_mov_b32 v178, 0
  v_mov_b32 v179, 0
  v_mov_b32 v180, 0
  v_mov_b32 v181, 0
  v_mov_b32 v182, 0
  v_mov_b32 v183, 0
  v_mov_b32 v184, 0
  v_mov_b32 v185, 0
  v_mov_b32 v186, 0
  v_mov_b32 v187, 0
  v_mov_b32 v188, 0
  v_mov_b32 v189, 0
  v_mov_b32 v190, 0
  v_mov_b32 v191, 0
  v_mov_b32 v192, 0
  v_mov_b32 v193, 0
  v_mov_b32 v194, 0
  v_mov_b32 v195, 0
  v_mov_b32 v196, 0
  v_mov_b32 v197, 0
  v_mov_b32 v198, 0
  v_mov_b32 v199, 0
  v_mov_b32 v200, 0
  v_mov_b32 v201, 0
  v_mov_b32 v202, 0
  v_mov_b32 v203, 0
  v_mov_b32 v204, 0
  v_mov_b32 v205, 0
  v_mov_b32 v206, 0
  v_mov_b32 v207, 0
  v_mov_b32 v208, 0
  v_mov_b32 v209, 0
  v_mov_b32 v210, 0
  v_mov_b32 v211, 0
  v_mov_b32 v212, 0
  v_mov_b32 v213, 0
  v_mov_b32 v214, 0
  v_mov_b32 v215, 0
  v_mov_b32 v216, 0
  v_mov_b32 v217, 0
  v_mov_b32 v218, 0
  v_mov_b32 v219, 0
  v_mov_b32 v220, 0
  v_mov_b32 v221, 0
  v_mov_b32 v222, 0
  v_mov_b32 v223, 0
  v_mov_b32 v224, 0
  v_mov_b32 v225, 0
  v_mov_b32 v226, 0
  v_mov_b32 v227, 0
  v_mov_b32 v228, 0
  v_mov_b32 v229, 0
  v_mov_b32 v230, 0
  v_mov_b32 v231, 0
  v_mov_b32 v232, 0
  v_mov_b32 v233, 0
  v_mov_b32 v234, 0
  v_mov_b32 v235, 0
  v_mov_b32 v236, 0
  v_mov_b32 v237, 0
  v_mov_b32 v238, 0
  v_mov_b32 v239, 0
  v_mov_b32 v240, 0
  v_mov_b32 v241, 0
  v_mov_b32 v242, 0
  v_mov_b32 v243, 0
  v_mov_b32 v244, 0
  v_mov_b32 v245, 0
  v_mov_b32 v246, 0
  v_mov_b32 v247, 0
  v_mov_b32 v248, 0
  v_mov_b32 v249, 0
  v_mov_b32 v250, 0
  v_mov_b32 v251, 0
  v_mov_b32 v252, 0
  v_mov_b32 v253, 0
  v_mov_b32 v254, 0
  v_mov_b32 v255, 0
  s_mov_b32 s40, s56
  s_and_b32 s41, s57, 0xffff
  s_mov_b32 s42, 256
  s_mov_b32 s43, 0x20000
  s_cmp_lg_u32 s32, 0
  s_cbranch_scc1 L_k3_noflag
  s_waitcnt vmcnt(0)
  v_mov_b32 v1, 1
  v_mov_b32 v15, 0
  s_lshl_b32 s3, s39, 2
  s_mov_b64 exec, 1
  buffer_atomic_add v1, v15, s[40:43], s3 offen sc1
  s_mov_b64 exec, -1
L_k3_noflag:
  s_waitcnt vmcnt(36)
  ds_read_b64_tr_b16 a[128:129], v5 offset:0
  ds_read_b64_tr_b16 a[130:131], v5 offset:2048
  ds_read_b64_tr_b16 a[132:133], v6 offset:0
  ds_read_b64_tr_b16 a[134:135], v6 offset:2048
  ds_read_b64_tr_b16 a[136:137], v7 offset:0
  ds_read_b64_tr_b16 a[138:139], v7 offset:2048
  ds_read_b64_tr_b16 a[140:141], v8 offset:0
  ds_read_b64_tr_b16 a[142:143], v8 offset:2048
  s_mov_b32 s62, 8
L_k3_loop:
  s_waitcnt vmcnt(24) lgkmcnt(0)
  v_mfma_f32_16x16x32_bf16 v[128:131], a[128:131], a[0:3], v[128:131]
  s_add_u32 m0, s35, 0
  v_mfma_f32_16x16x32_bf16 v[132:135], a[132:135], a[0:3], v[132:135]
  buffer_load_dwordx4 v4, s[12:15], s48 offen offset:0 lds
  v_mfma_f32_16x16x32_bf16 v[136:139], a[136:139], a[0:3], v[136:139]
  ds_read_b64_tr_b16 a[144:145], v5 offset:4096
  ds_read_b64_tr_b16 a[146:147], v5 offset:6144
  v_mfma_f32_16x16x32_bf16 v[140:143], a[140:143], a[0:3], v[140:143]
  buffer_load_dwordx4 v4, s[12:15], s49 offen offset:1024 lds
  v_mfma_f32_16x16x32_bf16 v[144:147], a[128:131], a[4:7], v[144:147]
  v_mfma_f32_16x16x32_bf16 v[148:151], a[132:135], a[4:7], v[148:151]
  v_mfma_f32_16x16x32_bf16 v[152:155], a[136:139], a[4:7], v[152:155]
  buffer_load_dwordx4 v4, s[12:15], s50 offen offset:2048 lds
  v_mfma_f32_16x16x32_bf16 v[156:159], a[140:143], a[4:7], v[156:159]
  ds_read_b64_tr_b16 a[148:149], v6 offset:4096
  ds_read_b64_tr_b16 a[150:151], v6 offset:6144
  v_mfma_f32_16x16x32_bf16 v[160:163], a[128:131], a[8:11], v[160:163]
  buffer_load_dwordx4 v4, s[12:15], s51 offen offset:3072 lds
  v_mfma_f32_16x16x32_bf16 v[164:167], a[132:135], a[8:11], v[164:167]
  v_add_u32 v4, 65536, v4
  v_mfma_f32_16x16x32_bf16 v[168:171], a[136:139], a[8:11], v[168:171]
  v_mfma_f32_16x16x32_bf16 v[172:175], a[140:143], a[8:11], v[172:175]
  buffer_load_dwordx4 a[96:99], v2, s[8:11], s63 offen offset:0
  v_mfma_f32_16x16x32_bf16 v[176:179], a[128:131], a[12:15], v[176:179]
  ds_read_b64_tr_b16 a[152:153], v7 offset:4096
  ds_read_b64_tr_b16 a[154:155], v7 offset:6144
  v_mfma_f32_16x16x32_bf16 v[180:183], a[132:135], a[12:15], v[180:183]
  buffer_load_dwordx4 a[100:103], v2, s[8:11], s63 offen offset:1024
  v_mfma_f32_16x16x32_bf16 v[184:187], a[136:139], a[12:15], v[184:187]
  v_mfma_f32_16x16x32_bf16 v[188:191], a[140:143], a[12:15], v[188:191]
  v_mfma_f32_16x16x32_bf16 v[192:195], a[128:131], a[16:19], v[192:195]
  buffer_load_dwordx4 a[104:107], v2, s[8:11], s63 offen offset:2048
  v_mfma_f32_16x16x32_bf16 v[196:199], a[132:135], a[16:19], v[196:199]
  ds_read_b64_tr_b16 a[156:157], v8 offset:4096
  ds_read_b64_tr_b16 a[158:159], v8 offset:6144
  v_mfma_f32_16x16x32_bf16 v[200:203], a[136:139], a[16:19], v[200:203]
  buffer_load_dwordx4 a[108:111], v2, s[8:11], s63 offen offset:3072
  v_mfma_f32_16x16x32_bf16 v[204:207], a[140:143], a[16:19], v[204:207]
  v_mfma_f32_16x16x32_bf16 v[208:211], a[128:131], a[20:23], v[208:211]
  v_mfma_f32_16x16x32_bf16 v[212:215], a[132:135], a[20:23], v[212:215]
  buffer_load_dwordx4 a[112:115], v3, s[8:11], s63 offen offset:0
  v_mfma_f32_16x16x32_bf16 v[216:219], a[136:139], a[20:23], v[216:219]
  v_mfma_f32_16x16x32_bf16 v[220:223], a[140:143], a[20:23], v[220:223]
  buffer_load_dwordx4 a[116:119], v3, s[8:11], s63 offen offset:1024
  v_mfma_f32_16x16x32_bf16 v[224:227], a[128:131], a[24:27], v[224:227]
  v_mfma_f32_16x16x32_bf16 v[228:231], a[132:135], a[24:27], v[228:231]
  v_mfma_f32_16x16x32_bf16 v[232:235], a[136:139], a[24:27], v[232:235]
  buffer_load_dwordx4 a[120:123], v3, s[8:11], s63 offen offset:2048
  v_mfma_f32_16x16x32_bf16 v[236:239], a[140:143], a[24:27], v[236:239]
  v_mfma_f32_16x16x32_bf16 v[240:243], a[128:131], a[28:31], v[240:243]
  buffer_load_dwordx4 a[124:127], v3, s[8:11], s63 offen offset:3072
  v_mfma_f32_16x16x32_bf16 v[244:247], a[132:135], a[28:31], v[244:247]
  s_add_u32 s63, s63, 8192
  v_mfma_f32_16x16x32_bf16 v[248:251], a[136:139], a[28:31], v[248:251]
  v_mfma_f32_16x16x32_bf16 v[252:255], a[140:143], a[28:31], v[252:255]
  s_waitcnt vmcnt(24) lgkmcnt(0)
  v_mfma_f32_16x16x32_bf16 v[128:131], a[144:147], a[32:35], v[128:131]
  s_add_u32 m0, s35, 4096
  v_mfma_f32_16x16x32_bf16 v[132:135], a[148:151], a[32:35], v[132:135]
  buffer_load_dwordx4 v4, s[12:15], s48 offen offset:0 lds
  v_mfma_f32_16x16x32_bf16 v[136:139], a[152:155], a[32:35], v[136:139]
  ds_read_b64_tr_b16 a[128:129], v5 offset:8192
  ds_read_b64_tr_b16 a[130:131], v5 offset:10240
  v_mfma_f32_16x16x32_bf16 v[140:143], a[156:159], a[32:35], v[140:143]
  buffer_load_dwordx4 v4, s[12:15], s49 offen offset:1024 lds
  v_mfma_f32_16x16x32_bf16 v[144:147], a[144:147], a[36:39], v[144:147]
  v_mfma_f32_16x16x32_bf16 v[148:151], a[148:151], a[36:39], v[148:151]
  v_mfma_f32_16x16x32_bf16 v[152:155], a[152:155], a[36:39], v[152:155]
  buffer_load_dwordx4 v4, s[12:15], s50 offen offset:2048 lds
  v_mfma_f32_16x16x32_bf16 v[156:159], a[156:159], a[36:39], v[156:159]
  ds_read_b64_tr_b16 a[132:133], v6 offset:8192
  ds_read_b64_tr_b16 a[134:135], v6 offset:10240
  v_mfma_f32_16x16x32_bf16 v[160:163], a[144:147], a[40:43], v[160:163]
  buffer_load_dwordx4 v4, s[12:15], s51 offen offset:3072 lds
  v_mfma_f32_16x16x32_bf16 v[164:167], a[148:151], a[40:43], v[164:167]
  v_add_u32 v4, 65536, v4
  v_mfma_f32_16x16x32_bf16 v[168:171], a[152:155], a[40:43], v[168:171]
  v_mfma_f32_16x16x32_bf16 v[172:175], a[156:159], a[40:43], v[172:175]
  buffer_load_dwordx4 a[0:3], v2, s[8:11], s63 offen offset:0
  v_mfma_f32_16x16x32_bf16 v[176:179], a[144:147], a[44:47], v[176:179]
  ds_read_b64_tr_b16 a[136:137], v7 offset:8192
  ds_read_b64_tr_b16 a[138:139], v7 offset:10240
  v_mfma_f32_16x16x32_bf16 v[180:183], a[148:151], a[44:47], v[180:183]
  buffer_load_dwordx4 a[4:7], v2, s[8:11], s63 offen offset:1024
  v_mfma_f32_16x16x32_bf16 v[184:187], a[152:155], a[44:47], v[184:187]
  v_mfma_f32_16x16x32_bf16 v[188:191], a[156:159], a[44:47], v[188:191]
  v_mfma_f32_16x16x32_bf16 v[192:195], a[144:147], a[48:51], v[192:195]
  buffer_load_dwordx4 a[8:11], v2, s[8:11], s63 offen offset:2048
  v_mfma_f32_16x16x32_bf16 v[196:199], a[148:151], a[48:51], v[196:199]
  ds_read_b64_tr_b16 a[140:141], v8 offset:8192
  ds_read_b64_tr_b16 a[142:143], v8 offset:10240
  v_mfma_f32_16x16x32_bf16 v[200:203], a[152:155], a[48:51], v[200:203]
  buffer_load_dwordx4 a[12:15], v2, s[8:11], s63 offen offset:3072
  v_mfma_f32_16x16x32_bf16 v[204:207], a[156:159], a[48:51], v[204:207]
  v_mfma_f32_16x16x32_bf16 v[208:211], a[144:147], a[52:55], v[208:211]
  v_mfma_f32_16x16x32_bf16 v[212:215], a[148:151], a[52:55], v[212:215]
  buffer_load_dwordx4 a[16:19], v3, s[8:11], s63 offen offset:0
  v_mfma_f32_16x16x32_bf16 v[216:219], a[152:155], a[52:55], v[216:219]
  v_mfma_f32_16x16x32_bf16 v[220:223], a[156:159], a[52:55], v[220:223]
  buffer_load_dwordx4 a[20:23], v3, s[8:11], s63 offen offset:1024
  v_mfma_f32_16x16x32_bf16 v[224:227], a[144:147], a[56:59], v[224:227]
  v_mfma_f32_16x16x32_bf16 v[228:231], a[148:151], a[56:59], v[228:231]
  v_mfma_f32_16x16x32_bf16 v[232:235], a[152:155], a[56:59], v[232:235]
  buffer_load_dwordx4 a[24:27], v3, s[8:11], s63 offen offset:2048
  v_mfma_f32_16x16x32_bf16 v[236:239], a[156:159], a[56:59], v[236:239]
  v_mfma_f32_16x16x32_bf16 v[240:243], a[144:147], a[60:63], v[240:243]
  buffer_load_dwordx4 a[28:31], v3, s[8:11], s63 offen offset:3072
  v_mfma_f32_16x16x32_bf16 v[244:247], a[148:151], a[60:63], v[244:247]
  s_add_u32 s63, s63, 8192
  v_mfma_f32_16x16x32_bf16 v[248:251], a[152:155], a[60:63], v[248:251]
  v_mfma_f32_16x16x32_bf16 v[252:255], a[156:159], a[60:63], v[252:255]
  s_waitcnt vmcnt(24) lgkmcnt(0)
  v_mfma_f32_16x16x32_bf16 v[128:131], a[128:131], a[64:67], v[128:131]
  s_add_u32 m0, s35, 8192
  v_mfma_f32_16x16x32_bf16 v[132:135], a[132:135], a[64:67], v[132:135]
  buffer_load_dwordx4 v4, s[12:15], s48 offen offset:0 lds
  v_mfma_f32_16x16x32_bf16 v[136:139], a[136:139], a[64:67], v[136:139]
  ds_read_b64_tr_b16 a[144:145], v5 offset:12288
  ds_read_b64_tr_b16 a[146:147], v5 offset:14336
  v_mfma_f32_16x16x32_bf16 v[140:143], a[140:143], a[64:67], v[140:143]
  buffer_load_dwordx4 v4, s[12:15], s49 offen offset:1024 lds
  v_mfma_f32_16x16x32_bf16 v[144:147], a[128:131], a[68:71], v[144:147]
  v_mfma_f32_16x16x32_bf16 v[148:151], a[132:135], a[68:71], v[148:151]
  v_mfma_f32_16x16x32_bf16 v[152:155], a[136:139], a[68:71], v[152:155]
  buffer_load_dwordx4 v4, s[12:15], s50 offen offset:2048 lds
  v_mfma_f32_16x16x32_bf16 v[156:159], a[140:143], a[68:71], v[156:159]
  ds_read_b64_tr_b16 a[148:149], v6 offset:12288
  ds_read_b64_tr_b16 a[150:151], v6 offset:14336
  v_mfma_f32_16x16x32_bf16 v[160:163], a[128:131], a[72:75], v[160:163]
  buffer_load_dwordx4 v4, s[12:15], s51 offen offset:3072 lds
  v_mfma_f32_16x16x32_bf16 v[164:167], a[132:135], a[72:75], v[164:167]
  v_add_u32 v4, 65536, v4
  v_mfma_f32_16x16x32_bf16 v[168:171], a[136:139], a[72:75], v[168:171]
  v_mfma_f32_16x16x32_bf16 v[172:175], a[140:143], a[72:75], v[172:175]
  buffer_load_dwordx4 a[32:35], v2, s[8:11], s63 offen offset:0
  v_mfma_f32_16x16x32_bf16 v[176:179], a[128:131], a[76:79], v[176:179]
  ds_read_b64_tr_b16 a[152:153], v7 offset:12288
  ds_read_b64_tr_b16 a[154:155], v7 offset:14336
  v_mfma_f32_16x16x32_bf16 v[180:183], a[132:135], a[76:79], v[180:183]
  buffer_load_dwordx4 a[36:39], v2, s[8:11], s63 offen offset:1024
  v_mfma_f32_16x16x32_bf16 v[184:187], a[136:139], a[76:79], v[184:187]
  v_mfma_f32_16x16x32_bf16 v[188:191], a[140:143], a[76:79], v[188:191]
  v_mfma_f32_16x16x32_bf16 v[192:195], a[128:131], a[80:83], v[192:195]
  buffer_load_dwordx4 a[40:43], v2, s[8:11], s63 offen offset:2048
  v_mfma_f32_16x16x32_bf16 v[196:199], a[132:135], a[80:83], v[196:199]
  ds_read_b64_tr_b16 a[156:157], v8 offset:12288
  ds_read_b64_tr_b16 a[158:159], v8 offset:14336
  v_mfma_f32_16x16x32_bf16 v[200:203], a[136:139], a[80:83], v[200:203]
  buffer_load_dwordx4 a[44:47], v2, s[8:11], s63 offen offset:3072
  v_mfma_f32_16x16x32_bf16 v[204:207], a[140:143], a[80:83], v[204:207]
  v_mfma_f32_16x16x32_bf16 v[208:211], a[128:131], a[84:87], v[208:211]
  v_mfma_f32_16x16x32_bf16 v[212:215], a[132:135], a[84:87], v[212:215]
  buffer_load_dwordx4 a[48:51], v3, s[8:11], s63 offen offset:0
  v_mfma_f32_16x16x32_bf16 v[216:219], a[136:139], a[84:87], v[216:219]
  v_mfma_f32_16x16x32_bf16 v[220:223], a[140:143], a[84:87], v[220:223]
  buffer_load_dwordx4 a[52:55], v3, s[8:11], s63 offen offset:1024
  v_mfma_f32_16x16x32_bf16 v[224:227], a[128:131], a[88:91], v[224:227]
  v_mfma_f32_16x16x32_bf16 v[228:231], a[132:135], a[88:91], v[228:231]
  v_mfma_f32_16x16x32_bf16 v[232:235], a[136:139], a[88:91], v[232:235]
  buffer_load_dwordx4 a[56:59], v3, s[8:11], s63 offen offset:2048
  v_mfma_f32_16x16x32_bf16 v[236:239], a[140:143], a[88:91], v[236:239]
  v_mfma_f32_16x16x32_bf16 v[240:243], a[128:131], a[92:95], v[240:243]
  buffer_load_dwordx4 a[60:63], v3, s[8:11], s63 offen offset:3072
  v_mfma_f32_16x16x32_bf16 v[244:247], a[132:135], a[92:95], v[244:247]
  s_add_u32 s63, s63, 8192
  v_mfma_f32_16x16x32_bf16 v[248:251], a[136:139], a[92:95], v[248:251]
  v_mfma_f32_16x16x32_bf16 v[252:255], a[140:143], a[92:95], v[252:255]
  s_waitcnt vmcnt(24) lgkmcnt(0)
  v_mfma_f32_16x16x32_bf16 v[128:131], a[144:147], a[96:99], v[128:131]
  s_add_u32 m0, s35, 12288
  v_mfma_f32_16x16x32_bf16 v[132:135], a[148:151], a[96:99], v[132:135]
  buffer_load_dwordx4 v4, s[12:15], s48 offen offset:0 lds
  v_mfma_f32_16x16x32_bf16 v[136:139], a[152:155], a[96:99], v[136:139]
  ds_read_b64_tr_b16 a[128:129], v5 offset:0
  ds_read_b64_tr_b16 a[130:131], v5 offset:2048
  v_mfma_f32_16x16x32_bf16 v[140:143], a[156:159], a[96:99], v[140:143]
  buffer_load_dwordx4 v4, s[12:15], s49 offen offset:1024 lds
  v_mfma_f32_16x16x32_bf16 v[144:147], a[144:147], a[100:103], v[144:147]
  v_mfma_f32_16x16x32_bf16 v[148:151], a[148:151], a[100:103], v[148:151]
  v_mfma_f32_16x16x32_bf16 v[152:155], a[152:155], a[100:103], v[152:155]
  buffer_load_dwordx4 v4, s[12:15], s50 offen offset:2048 lds
  v_mfma_f32_16x16x32_bf16 v[156:159], a[156:159], a[100:103], v[156:159]
  ds_read_b64_tr_b16 a[132:133], v6 offset:0
  ds_read_b64_tr_b16 a[134:135], v6 offset:2048
  v_mfma_f32_16x16x32_bf16 v[160:163], a[144:147], a[104:107], v[160:163]
  buffer_load_dwordx4 v4, s[12:15], s51 offen offset:3072 lds
  v_mfma_f32_16x16x32_bf16 v[164:167], a[148:151], a[104:107], v[164:167]
  v_add_u32 v4, 65536, v4
  v_mfma_f32_16x16x32_bf16 v[168:171], a[152:155], a[104:107], v[168:171]
  v_mfma_f32_16x16x32_bf16 v[172:175], a[156:159], a[104:107], v[172:175]
  buffer_load_dwordx4 a[64:67], v2, s[8:11], s63 offen offset:0
  v_mfma_f32_16x16x32_bf16 v[176:179], a[144:147], a[108:111], v[176:179]
  ds_read_b64_tr_b16 a[136:137], v7 offset:0
  ds_read_b64_tr_b16 a[138:139], v7 offset:2048
  v_mfma_f32_16x16x32_bf16 v[180:183], a[148:151], a[108:111], v[180:183]
  buffer_load_dwordx4 a[68:71], v2, s[8:11], s63 offen offset:1024
  v_mfma_f32_16x16x32_bf16 v[184:187], a[152:155], a[108:111], v[184:187]
  v_mfma_f32_16x16x32_bf16 v[188:191], a[156:159], a[108:111], v[188:191]
  v_mfma_f32_16x16x32_bf16 v[192:195], a[144:147], a[112:115], v[192:195]
  buffer_load_dwordx4 a[72:75], v2, s[8:11], s63 offen offset:2048
  v_mfma_f32_16x16x32_bf16 v[196:199], a[148:151], a[112:115], v[196:199]
  ds_read_b64_tr_b16 a[140:141], v8 offset:0
  ds_read_b64_tr_b16 a[142:143], v8 offset:2048
  v_mfma_f32_16x16x32_bf16 v[200:203], a[152:155], a[112:115], v[200:203]
  buffer_load_dwordx4 a[76:79], v2, s[8:11], s63 offen offset:3072
  v_mfma_f32_16x16x32_bf16 v[204:207], a[156:159], a[112:115], v[204:207]
  v_mfma_f32_16x16x32_bf16 v[208:211], a[144:147], a[116:119], v[208:211]
  v_mfma_f32_16x16x32_bf16 v[212:215], a[148:151], a[116:119], v[212:215]
  buffer_load_dwordx4 a[80:83], v3, s[8:11], s63 offen offset:0
  v_mfma_f32_16x16x32_bf16 v[216:219], a[152:155], a[116:119], v[216:219]
  v_mfma_f32_16x16x32_bf16 v[220:223], a[156:159], a[116:119], v[220:223]
  buffer_load_dwordx4 a[84:87], v3, s[8:11], s63 offen offset:1024
  v_mfma_f32_16x16x32_bf16 v[224:227], a[144:147], a[120:123], v[224:227]
  v_mfma_f32_16x16x32_bf16 v[228:231], a[148:151], a[120:123], v[228:231]
  v_mfma_f32_16x16x32_bf16 v[232:235], a[152:155], a[120:123], v[232:235]
  buffer_load_dwordx4 a[88:91], v3, s[8:11], s63 offen offset:2048
  v_mfma_f32_16x16x32_bf16 v[236:239], a[156:159], a[120:123], v[236:239]
  v_mfma_f32_16x16x32_bf16 v[240:243], a[144:147], a[124:127], v[240:243]
  buffer_load_dwordx4 a[92:95], v3, s[8:11], s63 offen offset:3072
  v_mfma_f32_16x16x32_bf16 v[244:247], a[148:151], a[124:127], v[244:247]
  s_add_u32 s63, s63, 8192
  v_mfma_f32_16x16x32_bf16 v[248:251], a[152:155], a[124:127], v[248:251]
  s_sub_u32 s62, s62, 1
  v_mfma_f32_16x16x32_bf16 v[252:255], a[156:159], a[124:127], v[252:255]
  s_cmp_lg_u32 s62, 0
  s_cbranch_scc1 L_k3_loop
  s_waitcnt vmcnt(0) lgkmcnt(0)
  v_and_b32 v1, 15, v0
  v_lshlrev_b32 v11, 8, v1
  v_add_u32 v11, s35, v11
  v_xor_b32 v1, v1, v12
  v_xor_b32 v15, 0, v1
  v_lshl_add_u32 v5, v15, 4, v11
  v_xor_b32 v15, 4, v1
  v_lshl_add_u32 v6, v15, 4, v11
  v_xor_b32 v15, 8, v1
  v_lshl_add_u32 v7, v15, 4, v11
  v_xor_b32 v15, 12, v1
  v_lshl_add_u32 v8, v15, 4, v11
  ds_write_b128 v5, v[128:131] offset:0
  ds_write_b128 v6, v[132:135] offset:0
  ds_write_b128 v7, v[136:139] offset:0
  ds_write_b128 v8, v[140:143] offset:0
  ds_write_b128 v5, v[144:147] offset:4096
  ds_write_b128 v6, v[148:151] offset:4096
  ds_write_b128 v7, v[152:155] offset:4096
  ds_write_b128 v8, v[156:159] offset:4096
  s_waitcnt lgkmcnt(4)
  ds_write_b128 v5, v[160:163] offset:8192
  ds_write_b128 v6, v[164:167] offset:8192
  ds_write_b128 v7, v[168:171] offset:8192
  ds_write_b128 v8, v[172:175] offset:8192
  ds_write_b128 v5, v[176:179] offset:12288
  ds_write_b128 v6, v[180:183] offset:12288
  ds_write_b128 v7, v[184:187] offset:12288
  ds_write_b128 v8, v[188:191] offset:12288
  s_waitcnt lgkmcnt(4)
  ds_write_b128 v5, v[192:195] offset:16384
  ds_write_b128 v6, v[196:199] offset:16384
  ds_write_b128 v7, v[200:203] offset:16384
  ds_write_b128 v8, v[204:207] offset:16384
  ds_write_b128 v5, v[208:211] offset:20480
  ds_write_b128 v6, v[212:215] offset:20480
  ds_write_b128 v7, v[216:219] offset:20480
  ds_write_b128 v8, v[220:223] offset:20480
  s_waitcnt lgkmcnt(4)
  ds_write_b128 v5, v[224:227] offset:24576
  ds_write_b128 v6, v[228:231] offset:24576
  ds_write_b128 v7, v[232:235] offset:24576
  ds_write_b128 v8, v[236:239] offset:24576
  ds_write_b128 v5, v[240:243] offset:28672
  ds_write_b128 v6, v[244:247] offset:28672
  ds_write_b128 v7, v[248:251] offset:28672
  ds_write_b128 v8, v[252:255] offset:28672
  s_waitcnt lgkmcnt(4)
  s_lshr_b32 s3, s52, 7
  s_lshr_b32 s62, s53, 7
  s_cmp_eq_u32 s3, s33
  s_cbranch_scc1 L_k3_sel
  s_cmp_eq_u32 s62, s33
  s_cbranch_scc1 L_k3_sel
L_k3_selr:
  v_and_b32 v1, 15, v10
  v_lshlrev_b32 v15, 1, v13
  v_xor_b32 v1, v1, v15
  v_lshlrev_b32 v11, 8, v10
  v_lshl_add_u32 v2, v1, 4, v11
  v_xor_b32 v3, 16, v2
  v_add_u32 v4, 65536, v2
  v_add_u32 v5, 65536, v3
  s_waitcnt lgkmcnt(0)
  s_barrier
  ds_read_b128 v[128:131], v2 offset:0
  ds_read_b128 v[132:135], v3 offset:0
  ds_read_b128 v[136:139], v2 offset:32768
  ds_read_b128 v[140:143], v3 offset:32768
  ds_read_b128 v[144:147], v4 offset:0
  ds_read_b128 v[148:151], v5 offset:0
  ds_read_b128 v[152:155], v4 offset:32768
  ds_read_b128 v[156:159], v5 offset:32768
  s_waitcnt lgkmcnt(0)
  ds_read_b128 v[160:163], v2 offset:8192
  ds_read_b128 v[164:167], v3 offset:8192
  ds_read_b128 v[168:171], v2 offset:40960
  ds_read_b128 v[172:175], v3 offset:40960
  ds_read_b128 v[176:179], v4 offset:8192
  ds_read_b128 v[180:183], v5 offset:8192
  ds_read_b128 v[184:187], v4 offset:40960
  ds_read_b128 v[188:191], v5 offset:40960
  v_add_f32 v128, v128, v136
  v_add_f32 v144, v144, v152
  v_add_f32 v129, v129, v137
  v_add_f32 v145, v145, v153
  v_add_f32 v130, v130, v138
  v_add_f32 v146, v146, v154
  v_add_f32 v131, v131, v139
  v_add_f32 v147, v147, v155
  v_add_f32 v132, v132, v140
  v_add_f32 v148, v148, v156
  v_add_f32 v133, v133, v141
  v_add_f32 v149, v149, v157
  v_add_f32 v134, v134, v142
  v_add_f32 v150, v150, v158
  v_add_f32 v135, v135, v143
  v_add_f32 v151, v151, v159
  v_add_f32 v128, v128, v144
  v_add_f32 v129, v129, v145
  v_add_f32 v130, v130, v146
  v_add_f32 v131, v131, v147
  v_add_f32 v132, v132, v148
  v_add_f32 v133, v133, v149
  v_add_f32 v134, v134, v150
  v_add_f32 v135, v135, v151
  v_cvt_pk_bf16_f32 v136, v128, v129
  v_lshlrev_b32 v128, 16, v136
  v_and_b32 v129, 0xffff0000, v136
  v_cvt_pk_bf16_f32 v137, v130, v131
  v_lshlrev_b32 v130, 16, v137
  v_and_b32 v131, 0xffff0000, v137
  v_cvt_pk_bf16_f32 v138, v132, v133
  v_lshlrev_b32 v132, 16, v138
  v_and_b32 v133, 0xffff0000, v138
  v_cvt_pk_bf16_f32 v139, v134, v135
  v_lshlrev_b32 v134, 16, v139
  v_and_b32 v135, 0xffff0000, v139
  v_mul_f32 v128, v128, v40
  v_mul_f32 v129, v129, v41
  v_mul_f32 v130, v130, v42
  v_mul_f32 v131, v131, v43
  v_mul_f32 v132, v132, v44
  v_mul_f32 v133, v133, v45
  v_mul_f32 v134, v134, v46
  v_mul_f32 v135, v135, v47
  v_cvt_pk_bf16_f32 v136, v128, v129
  v_lshlrev_b32 v128, 16, v136
  v_and_b32 v129, 0xffff0000, v136
  v_cvt_pk_bf16_f32 v137, v130, v131
  v_lshlrev_b32 v130, 16, v137
  v_and_b32 v131, 0xffff0000, v137
  v_cvt_pk_bf16_f32 v138, v132, v133
  v_lshlrev_b32 v132, 16, v138
  v_and_b32 v133, 0xffff0000, v138
  v_cvt_pk_bf16_f32 v139, v134, v135
  v_lshlrev_b32 v134, 16, v139
  v_and_b32 v135, 0xffff0000, v139
  v_lshlrev_b32 v144, 16, v16
  v_and_b32 v145, 0xffff0000, v16
  v_lshlrev_b32 v146, 16, v17
  v_and_b32 v147, 0xffff0000, v17
  v_lshlrev_b32 v148, 16, v18
  v_and_b32 v149, 0xffff0000, v18
  v_lshlrev_b32 v150, 16, v19
  v_and_b32 v151, 0xffff0000, v19
  v_add_f32 v128, v128, v144
  v_add_f32 v129, v129, v145
  v_add_f32 v130, v130, v146
  v_add_f32 v131, v131, v147
  v_add_f32 v132, v132, v148
  v_add_f32 v133, v133, v149
  v_add_f32 v134, v134, v150
  v_add_f32 v135, v135, v151
  v_cvt_pk_bf16_f32 v136, v128, v129
  v_cvt_pk_bf16_f32 v137, v130, v131
  v_cvt_pk_bf16_f32 v138, v132, v133
  v_cvt_pk_bf16_f32 v139, v134, v135
  buffer_store_dwordx4 v[136:139], v9, s[28:31], s36 offen
  s_add_u32 s36, s36, 65536
  s_waitcnt lgkmcnt(0)
  ds_read_b128 v[192:195], v2 offset:16384
  ds_read_b128 v[196:199], v3 offset:16384
  ds_read_b128 v[200:203], v2 offset:49152
  ds_read_b128 v[204:207], v3 offset:49152
  ds_read_b128 v[208:211], v4 offset:16384
  ds_read_b128 v[212:215], v5 offset:16384
  ds_read_b128 v[216:219], v4 offset:49152
  ds_read_b128 v[220:223], v5 offset:49152
  v_add_f32 v160, v160, v168
  v_add_f32 v176, v176, v184
  v_add_f32 v161, v161, v169
  v_add_f32 v177, v177, v185
  v_add_f32 v162, v162, v170
  v_add_f32 v178, v178, v186
  v_add_f32 v163, v163, v171
  v_add_f32 v179, v179, v187
  v_add_f32 v164, v164, v172
  v_add_f32 v180, v180, v188
  v_add_f32 v165, v165, v173
  v_add_f32 v181, v181, v189
  v_add_f32 v166, v166, v174
  v_add_f32 v182, v182, v190
  v_add_f32 v167, v167, v175
  v_add_f32 v183, v183, v191
  v_add_f32 v160, v160, v176
  v_add_f32 v161, v161, v177
  v_add_f32 v162, v162, v178
  v_add_f32 v163, v163, v179
  v_add_f32 v164, v164, v180
  v_add_f32 v165, v165, v181
  v_add_f32 v166, v166, v182
  v_add_f32 v167, v167, v183
  v_cvt_pk_bf16_f32 v168, v160, v161
  v_lshlrev_b32 v160, 16, v168
  v_and_b32 v161, 0xffff0000, v168
  v_cvt_pk_bf16_f32 v169, v162, v163
  v_lshlrev_b32 v162, 16, v169
  v_and_b32 v163, 0xffff0000, v169
  v_cvt_pk_bf16_f32 v170, v164, v165
  v_lshlrev_b32 v164, 16, v170
  v_and_b32 v165, 0xffff0000, v170
  v_cvt_pk_bf16_f32 v171, v166, v167
  v_lshlrev_b32 v166, 16, v171
  v_and_b32 v167, 0xffff0000, v171
  v_mul_f32 v160, v160, v48
  v_mul_f32 v161, v161, v49
  v_mul_f32 v162, v162, v50
  v_mul_f32 v163, v163, v51
  v_mul_f32 v164, v164, v52
  v_mul_f32 v165, v165, v53
  v_mul_f32 v166, v166, v54
  v_mul_f32 v167, v167, v55
  v_cvt_pk_bf16_f32 v168, v160, v161
  v_lshlrev_b32 v160, 16, v168
  v_and_b32 v161, 0xffff0000, v168
  v_cvt_pk_bf16_f32 v169, v162, v163
  v_lshlrev_b32 v162, 16, v169
  v_and_b32 v163, 0xffff0000, v169
  v_cvt_pk_bf16_f32 v170, v164, v165
  v_lshlrev_b32 v164, 16, v170
  v_and_b32 v165, 0xffff0000, v170
  v_cvt_pk_bf16_f32 v171, v166, v167
  v_lshlrev_b32 v166, 16, v171
  v_and_b32 v167, 0xffff0000, v171
  v_lshlrev_b32 v176, 16, v20
  v_and_b32 v177, 0xffff0000, v20
  v_lshlrev_b32 v178, 16, v21
  v_and_b32 v179, 0xffff0000, v21
  v_lshlrev_b32 v180, 16, v22
  v_and_b32 v181, 0xffff0000, v22
  v_lshlrev_b32 v182, 16, v23
  v_and_b32 v183, 0xffff0000, v23
  v_add_f32 v160, v160, v176
  v_add_f32 v161, v161, v177
  v_add_f32 v162, v162, v178
  v_add_f32 v163, v163, v179
  v_add_f32 v164, v164, v180
  v_add_f32 v165, v165, v181
  v_add_f32 v166, v166, v182
  v_add_f32 v167, v167, v183
  v_cvt_pk_bf16_f32 v168, v160, v161
  v_cvt_pk_bf16_f32 v169, v162, v163
  v_cvt_pk_bf16_f32 v170, v164, v165
  v_cvt_pk_bf16_f32 v171, v166, v167
  buffer_store_dwordx4 v[168:171], v9, s[28:31], s36 offen
  s_add_u32 s36, s36, 65536
  s_waitcnt lgkmcnt(0)
  ds_read_b128 v[224:227], v2 offset:24576
  ds_read_b128 v[228:231], v3 offset:24576
  ds_read_b128 v[232:235], v2 offset:57344
  ds_read_b128 v[236:239], v3 offset:57344
  ds_read_b128 v[240:243], v4 offset:24576
  ds_read_b128 v[244:247], v5 offset:24576
  ds_read_b128 v[248:251], v4 offset:57344
  ds_read_b128 v[252:255], v5 offset:57344
  v_add_f32 v192, v192, v200
  v_add_f32 v208, v208, v216
  v_add_f32 v193, v193, v201
  v_add_f32 v209, v209, v217
  v_add_f32 v194, v194, v202
  v_add_f32 v210, v210, v218
  v_add_f32 v195, v195, v203
  v_add_f32 v211, v211, v219
  v_add_f32 v196, v196, v204
  v_add_f32 v212, v212, v220
  v_add_f32 v197, v197, v205
  v_add_f32 v213, v213, v221
  v_add_f32 v198, v198, v206
  v_add_f32 v214, v214, v222
  v_add_f32 v199, v199, v207
  v_add_f32 v215, v215, v223
  v_add_f32 v192, v192, v208
  v_add_f32 v193, v193, v209
  v_add_f32 v194, v194, v210
  v_add_f32 v195, v195, v211
  v_add_f32 v196, v196, v212
  v_add_f32 v197, v197, v213
  v_add_f32 v198, v198, v214
  v_add_f32 v199, v199, v215
  v_cvt_pk_bf16_f32 v200, v192, v193
  v_lshlrev_b32 v192, 16, v200
  v_and_b32 v193, 0xffff0000, v200
  v_cvt_pk_bf16_f32 v201, v194, v195
  v_lshlrev_b32 v194, 16, v201
  v_and_b32 v195, 0xffff0000, v201
  v_cvt_pk_bf16_f32 v202, v196, v197
  v_lshlrev_b32 v196, 16, v202
  v_and_b32 v197, 0xffff0000, v202
  v_cvt_pk_bf16_f32 v203, v198, v199
  v_lshlrev_b32 v198, 16, v203
  v_and_b32 v199, 0xffff0000, v203
  v_mul_f32 v192, v192, v56
  v_mul_f32 v193, v193, v57
  v_mul_f32 v194, v194, v58
  v_mul_f32 v195, v195, v59
  v_mul_f32 v196, v196, v60
  v_mul_f32 v197, v197, v61
  v_mul_f32 v198, v198, v62
  v_mul_f32 v199, v199, v63
  v_cvt_pk_bf16_f32 v200, v192, v193
  v_lshlrev_b32 v192, 16, v200
  v_and_b32 v193, 0xffff0000, v200
  v_cvt_pk_bf16_f32 v201, v194, v195
  v_lshlrev_b32 v194, 16, v201
  v_and_b32 v195, 0xffff0000, v201
  v_cvt_pk_bf16_f32 v202, v196, v197
  v_lshlrev_b32 v196, 16, v202
  v_and_b32 v197, 0xffff0000, v202
  v_cvt_pk_bf16_f32 v203, v198, v199
  v_lshlrev_b32 v198, 16, v203
  v_and_b32 v199, 0xffff0000, v203
  v_lshlrev_b32 v208, 16, v24
  v_and_b32 v209, 0xffff0000, v24
  v_lshlrev_b32 v210, 16, v25
  v_and_b32 v211, 0xffff0000, v25
  v_lshlrev_b32 v212, 16, v26
  v_and_b32 v213, 0xffff0000, v26
  v_lshlrev_b32 v214, 16, v27
  v_and_b32 v215, 0xffff0000, v27
  v_add_f32 v192, v192, v208
  v_add_f32 v193, v193, v209
  v_add_f32 v194, v194, v210
  v_add_f32 v195, v195, v211
  v_add_f32 v196, v196, v212
  v_add_f32 v197, v197, v213
  v_add_f32 v198, v198, v214
  v_add_f32 v199, v199, v215
  v_cvt_pk_bf16_f32 v200, v192, v193
  v_cvt_pk_bf16_f32 v201, v194, v195
  v_cvt_pk_bf16_f32 v202, v196, v197
  v_cvt_pk_bf16_f32 v203, v198, v199
  buffer_store_dwordx4 v[200:203], v9, s[28:31], s36 offen
  s_add_u32 s36, s36, 65536
  s_waitcnt lgkmcnt(0)
  v_add_f32 v224, v224, v232
  v_add_f32 v240, v240, v248
  v_add_f32 v225, v225, v233
  v_add_f32 v241, v241, v249
  v_add_f32 v226, v226, v234
  v_add_f32 v242, v242, v250
  v_add_f32 v227, v227, v235
  v_add_f32 v243, v243, v251
  v_add_f32 v228, v228, v236
  v_add_f32 v244, v244, v252
  v_add_f32 v229, v229, v237
  v_add_f32 v245, v245, v253
  v_add_f32 v230, v230, v238
  v_add_f32 v246, v246, v254
  v_add_f32 v231, v231, v239
  v_add_f32 v247, v247, v255
  v_add_f32 v224, v224, v240
  v_add_f32 v225, v225, v241
  v_add_f32 v226, v226, v242
  v_add_f32 v227, v227, v243
  v_add_f32 v228, v228, v244
  v_add_f32 v229, v229, v245
  v_add_f32 v230, v230, v246
  v_add_f32 v231, v231, v247
  v_cvt_pk_bf16_f32 v232, v224, v225
  v_lshlrev_b32 v224, 16, v232
  v_and_b32 v225, 0xffff0000, v232
  v_cvt_pk_bf16_f32 v233, v226, v227
  v_lshlrev_b32 v226, 16, v233
  v_and_b32 v227, 0xffff0000, v233
  v_cvt_pk_bf16_f32 v234, v228, v229
  v_lshlrev_b32 v228, 16, v234
  v_and_b32 v229, 0xffff0000, v234
  v_cvt_pk_bf16_f32 v235, v230, v231
  v_lshlrev_b32 v230, 16, v235
  v_and_b32 v231, 0xffff0000, v235
  v_mul_f32 v224, v224, v64
  v_mul_f32 v225, v225, v65
  v_mul_f32 v226, v226, v66
  v_mul_f32 v227, v227, v67
  v_mul_f32 v228, v228, v68
  v_mul_f32 v229, v229, v69
  v_mul_f32 v230, v230, v70
  v_mul_f32 v231, v231, v71
  v_cvt_pk_bf16_f32 v232, v224, v225
  v_lshlrev_b32 v224, 16, v232
  v_and_b32 v225, 0xffff0000, v232
  v_cvt_pk_bf16_f32 v233, v226, v227
  v_lshlrev_b32 v226, 16, v233
  v_and_b32 v227, 0xffff0000, v233
  v_cvt_pk_bf16_f32 v234, v228, v229
  v_lshlrev_b32 v228, 16, v234
  v_and_b32 v229, 0xffff0000, v234
  v_cvt_pk_bf16_f32 v235, v230, v231
  v_lshlrev_b32 v230, 16, v235
  v_and_b32 v231, 0xffff0000, v235
  v_lshlrev_b32 v240, 16, v28
  v_and_b32 v241, 0xffff0000, v28
  v_lshlrev_b32 v242, 16, v29
  v_and_b32 v243, 0xffff0000, v29
  v_lshlrev_b32 v244, 16, v30
  v_and_b32 v245, 0xffff0000, v30
  v_lshlrev_b32 v246, 16, v31
  v_and_b32 v247, 0xffff0000, v31
  v_add_f32 v224, v224, v240
  v_add_f32 v225, v225, v241
  v_add_f32 v226, v226, v242
  v_add_f32 v227, v227, v243
  v_add_f32 v228, v228, v244
  v_add_f32 v229, v229, v245
  v_add_f32 v230, v230, v246
  v_add_f32 v231, v231, v247
  v_cvt_pk_bf16_f32 v232, v224, v225
  v_cvt_pk_bf16_f32 v233, v226, v227
  v_cvt_pk_bf16_f32 v234, v228, v229
  v_cvt_pk_bf16_f32 v235, v230, v231
  buffer_store_dwordx4 v[232:235], v9, s[28:31], s36 offen
L_k3_end:
  s_endpgm
L_k3_sel:
  s_lshl_b32 s3, s34, 2
  v_mov_b32 v15, 0
  s_mov_b32 s62, 0x400000
L_k3_poll:
  buffer_load_dword v1, v15, s[40:43], s3 offen sc1
  s_waitcnt vmcnt(0)
  v_readfirstlane_b32 s63, v1
  s_sub_u32 s62, s62, 1
  s_cmp_eq_u32 s62, 0
  s_cbranch_scc1 L_k3_polled
  s_cmp_lt_u32 s63, 16
  s_cbranch_scc1 L_k3_poll
L_k3_polled:
  s_lshl_b32 s3, s34, 13
  s_add_u32 s3, s3, 4259840
  v_lshlrev_b32 v1, 10, v14
  v_lshl_add_u32 v1, v13, 5, v1
  buffer_load_dwordx4 v[80:83], v1, s[16:19], s3 offen offset:0 sc1
  buffer_load_dwordx4 v[84:87], v1, s[16:19], s3 offen offset:16 sc1
  buffer_load_dwordx4 v[88:91], v1, s[16:19], s3 offen offset:256 sc1
  buffer_load_dwordx4 v[92:95], v1, s[16:19], s3 offen offset:272 sc1
  buffer_load_dwordx4 v[96:99], v1, s[16:19], s3 offen offset:512 sc1
  buffer_load_dwordx4 v[100:103], v1, s[16:19], s3 offen offset:528 sc1
  buffer_load_dwordx4 v[104:107], v1, s[16:19], s3 offen offset:768 sc1
  buffer_load_dwordx4 v[108:111], v1, s[16:19], s3 offen offset:784 sc1
  s_waitcnt vmcnt(0)
  v_add_f32 v80, v80, v96
  v_add_f32 v81, v81, v97
  v_add_f32 v82, v82, v98
  v_add_f32 v83, v83, v99
  v_add_f32 v84, v84, v100
  v_add_f32 v85, v85, v101
  v_add_f32 v86, v86, v102
  v_add_f32 v87, v87, v103
  v_add_f32 v88, v88, v104
  v_add_f32 v89, v89, v105
  v_add_f32 v90, v90, v106
  v_add_f32 v91, v91, v107
  v_add_f32 v92, v92, v108
  v_add_f32 v93, v93, v109
  v_add_f32 v94, v94, v110
  v_add_f32 v95, v95, v111
  v_add_f32_dpp v80, v80, v80 row_ror:8 row_mask:0xf bank_mask:0xf
  v_add_f32_dpp v81, v81, v81 row_ror:8 row_mask:0xf bank_mask:0xf
  v_add_f32_dpp v82, v82, v82 row_ror:8 row_mask:0xf bank_mask:0xf
  v_add_f32_dpp v83, v83, v83 row_ror:8 row_mask:0xf bank_mask:0xf
  v_add_f32_dpp v84, v84, v84 row_ror:8 row_mask:0xf bank_mask:0xf
  v_add_f32_dpp v85, v85, v85 row_ror:8 row_mask:0xf bank_mask:0xf
  v_add_f32_dpp v86, v86, v86 row_ror:8 row_mask:0xf bank_mask:0xf
  v_add_f32_dpp v87, v87, v87 row_ror:8 row_mask:0xf bank_mask:0xf
  v_add_f32_dpp v88, v88, v88 row_ror:8 row_mask:0xf bank_mask:0xf
  v_add_f32_dpp v89, v89, v89 row_ror:8 row_mask:0xf bank_mask:0xf
  v_add_f32_dpp v90, v90, v90 row_ror:8 row_mask:0xf bank_mask:0xf
  v_add_f32_dpp v91, v91, v91 row_ror:8 row_mask:0xf bank_mask:0xf
  v_add_f32_dpp v92, v92, v92 row_ror:8 row_mask:0xf bank_mask:0xf
  v_add_f32_dpp v93, v93, v93 row_ror:8 row_mask:0xf bank_mask:0xf
  v_add_f32_dpp v94, v94, v94 row_ror:8 row_mask:0xf bank_mask:0xf
  v_add_f32_dpp v95, v95, v95 row_ror:8 row_mask:0xf bank_mask:0xf
  v_mov_b32 v96, v80
  v_mov_b32 v97, v81
  v_mov_b32 v98, v82
  v_mov_b32 v99, v83
  v_mov_b32 v100, v84
  v_mov_b32 v101, v85
  v_mov_b32 v102, v86
  v_mov_b32 v103, v87
  v_mov_b32 v104, v88
  v_mov_b32 v105, v89
  v_mov_b32 v106, v90
  v_mov_b32 v107, v91
  v_mov_b32 v108, v92
  v_mov_b32 v109, v93
  v_mov_b32 v110, v94
  v_mov_b32 v111, v95
  v_permlane16_swap_b32 v96, v80
  v_permlane16_swap_b32 v97, v81
  v_permlane16_swap_b32 v98, v82
  v_permlane16_swap_b32 v99, v83
  v_permlane16_swap_b32 v100, v84
  v_permlane16_swap_b32 v101, v85
  v_permlane16_swap_b32 v102, v86
  v_permlane16_swap_b32 v103, v87
  v_permlane16_swap_b32 v104, v88
  v_permlane16_swap_b32 v105, v89
  v_permlane16_swap_b32 v106, v90
  v_permlane16_swap_b32 v107, v91
  v_permlane16_swap_b32 v108, v92
  v_permlane16_swap_b32 v109, v93
  v_permlane16_swap_b32 v110, v94
  v_permlane16_swap_b32 v111, v95
  v_add_f32 v80, v80, v96
  v_add_f32 v81, v81, v97
  v_add_f32 v82, v82, v98
  v_add_f32 v83, v83, v99
  v_add_f32 v84, v84, v100
  v_add_f32 v85, v85, v101
  v_add_f32 v86, v86, v102
  v_add_f32 v87, v87, v103
  v_add_f32 v88, v88, v104
  v_add_f32 v89, v89, v105
  v_add_f32 v90, v90, v106
  v_add_f32 v91, v91, v107
  v_add_f32 v92, v92, v108
  v_add_f32 v93, v93, v109
  v_add_f32 v94, v94, v110
  v_add_f32 v95, v95, v111
  v_mov_b32 v96, v80
  v_mov_b32 v97, v81
  v_mov_b32 v98, v82
  v_mov_b32 v99, v83
  v_mov_b32 v100, v84
  v_mov_b32 v101, v85
  v_mov_b32 v102, v86
  v_mov_b32 v103, v87
  v_mov_b32 v104, v88
  v_mov_b32 v105, v89
  v_mov_b32 v106, v90
  v_mov_b32 v107, v91
  v_mov_b32 v108, v92
  v_mov_b32 v109, v93
  v_mov_b32 v110, v94
  v_mov_b32 v111, v95
  v_permlane32_swap_b32 v96, v80
  v_permlane32_swap_b32 v97, v81
  v_permlane32_swap_b32 v98, v82
  v_permlane32_swap_b32 v99, v83
  v_permlane32_swap_b32 v100, v84
  v_permlane32_swap_b32 v101, v85
  v_permlane32_swap_b32 v102, v86
  v_permlane32_swap_b32 v103, v87
  v_permlane32_swap_b32 v104, v88
  v_permlane32_swap_b32 v105, v89
  v_permlane32_swap_b32 v106, v90
  v_permlane32_swap_b32 v107, v91
  v_permlane32_swap_b32 v108, v92
  v_permlane32_swap_b32 v109, v93
  v_permlane32_swap_b32 v110, v94
  v_permlane32_swap_b32 v111, v95
  v_add_f32 v80, v80, v96
  v_add_f32 v81, v81, v97
  v_add_f32 v82, v82, v98
  v_add_f32 v83, v83, v99
  v_add_f32 v84, v84, v100
  v_add_f32 v85, v85, v101
  v_add_f32 v86, v86, v102
  v_add_f32 v87, v87, v103
  v_add_f32 v88, v88, v104
  v_add_f32 v89, v89, v105
  v_add_f32 v90, v90, v106
  v_add_f32 v91, v91, v107
  v_add_f32 v92, v92, v108
  v_add_f32 v93, v93, v109
  v_add_f32 v94, v94, v110
  v_add_f32 v95, v95, v111
  v_cvt_pk_bf16_f32 v1, v80, v81
  v_lshlrev_b32 v80, 16, v1
  v_and_b32 v81, 0xffff0000, v1
  v_cvt_pk_bf16_f32 v1, v82, v83
  v_lshlrev_b32 v82, 16, v1
  v_and_b32 v83, 0xffff0000, v1
  v_cvt_pk_bf16_f32 v1, v84, v85
  v_lshlrev_b32 v84, 16, v1
  v_and_b32 v85, 0xffff0000, v1
  v_cvt_pk_bf16_f32 v1, v86, v87
  v_lshlrev_b32 v86, 16, v1
  v_and_b32 v87, 0xffff0000, v1
  v_cvt_pk_bf16_f32 v1, v88, v89
  v_lshlrev_b32 v88, 16, v1
  v_and_b32 v89, 0xffff0000, v1
  v_cvt_pk_bf16_f32 v1, v90, v91
  v_lshlrev_b32 v90, 16, v1
  v_and_b32 v91, 0xffff0000, v1
  v_cvt_pk_bf16_f32 v1, v92, v93
  v_lshlrev_b32 v92, 16, v1
  v_and_b32 v93, 0xffff0000, v1
  v_cvt_pk_bf16_f32 v1, v94, v95
  v_lshlrev_b32 v94, 16, v1
  v_and_b32 v95, 0xffff0000, v1
  v_mul_f32 v80, s54, v80
  v_mul_f32 v81, s54, v81
  v_mul_f32 v82, s54, v82
  v_mul_f32 v83, s54, v83
  v_mul_f32 v84, s54, v84
  v_mul_f32 v85, s54, v85
  v_mul_f32 v86, s54, v86
  v_mul_f32 v87, s54, v87
  v_mul_f32 v88, s55, v88
  v_mul_f32 v89, s55, v89
  v_mul_f32 v90, s55, v90
  v_mul_f32 v91, s55, v91
  v_mul_f32 v92, s55, v92
  v_mul_f32 v93, s55, v93
  v_mul_f32 v94, s55, v94
  v_mul_f32 v95, s55, v95
  v_cvt_pk_bf16_f32 v1, v80, v81
  v_lshlrev_b32 v80, 16, v1
  v_and_b32 v81, 0xffff0000, v1
  v_cvt_pk_bf16_f32 v1, v82, v83
  v_lshlrev_b32 v82, 16, v1
  v_and_b32 v83, 0xffff0000, v1
  v_cvt_pk_bf16_f32 v1, v84, v85
  v_lshlrev_b32 v84, 16, v1
  v_and_b32 v85, 0xffff0000, v1
  v_cvt_pk_bf16_f32 v1, v86, v87
  v_lshlrev_b32 v86, 16, v1
  v_and_b32 v87, 0xffff0000, v1
  v_cvt_pk_bf16_f32 v1, v88, v89
  v_lshlrev_b32 v88, 16, v1
  v_and_b32 v89, 0xffff0000, v1
  v_cvt_pk_bf16_f32 v1, v90, v91
  v_lshlrev_b32 v90, 16, v1
  v_and_b32 v91, 0xffff0000, v1
  v_cvt_pk_bf16_f32 v1, v92, v93
  v_lshlrev_b32 v92, 16, v1
  v_and_b32 v93, 0xffff0000, v1
  v_cvt_pk_bf16_f32 v1, v94, v95
  v_lshlrev_b32 v94, 16, v1
  v_and_b32 v95, 0xffff0000, v1
  s_lshl_b32 s3, s33, 7
  s_sub_u32 s52, s52, s3
  s_sub_u32 s53, s53, s3
  v_add_u32 v1, 0, v10
  v_cmp_eq_u32 vcc, s52, v1
  v_cmp_eq_u32 s[62:63], s53, v1
  s_nop 0
  v_cndmask_b32 v96, 0, v80, vcc
  v_cndmask_b32 v96, v96, v88, s[62:63]
  v_cndmask_b32 v97, 0, v81, vcc
  v_cndmask_b32 v97, v97, v89, s[62:63]
  v_cndmask_b32 v98, 0, v82, vcc
  v_cndmask_b32 v98, v98, v90, s[62:63]
  v_cndmask_b32 v99, 0, v83, vcc
  v_cndmask_b32 v99, v99, v91, s[62:63]
  v_cndmask_b32 v100, 0, v84, vcc
  v_cndmask_b32 v100, v100, v92, s[62:63]
  v_cndmask_b32 v101, 0, v85, vcc
  v_cndmask_b32 v101, v101, v93, s[62:63]
  v_cndmask_b32 v102, 0, v86, vcc
  v_cndmask_b32 v102, v102, v94, s[62:63]
  v_cndmask_b32 v103, 0, v87, vcc
  v_cndmask_b32 v103, v103, v95, s[62:63]
  v_lshlrev_b32 v40, 16, v16
  v_and_b32 v41, 0xffff0000, v16
  v_lshlrev_b32 v42, 16, v17
  v_and_b32 v43, 0xffff0000, v17
  v_lshlrev_b32 v44, 16, v18
  v_and_b32 v45, 0xffff0000, v18
  v_lshlrev_b32 v46, 16, v19
  v_and_b32 v47, 0xffff0000, v19
  v_sub_f32 v40, v40, v32
  v_sub_f32 v41, v41, v32
  v_sub_f32 v42, v42, v32
  v_sub_f32 v43, v43, v32
  v_sub_f32 v44, v44, v32
  v_sub_f32 v45, v45, v32
  v_sub_f32 v46, v46, v32
  v_sub_f32 v47, v47, v32
  v_cvt_pk_bf16_f32 v72, v40, v41
  v_lshlrev_b32 v40, 16, v72
  v_and_b32 v41, 0xffff0000, v72
  v_cvt_pk_bf16_f32 v73, v42, v43
  v_lshlrev_b32 v42, 16, v73
  v_and_b32 v43, 0xffff0000, v73
  v_cvt_pk_bf16_f32 v74, v44, v45
  v_lshlrev_b32 v44, 16, v74
  v_and_b32 v45, 0xffff0000, v74
  v_cvt_pk_bf16_f32 v75, v46, v47
  v_lshlrev_b32 v46, 16, v75
  v_and_b32 v47, 0xffff0000, v75
  v_mul_f32 v40, v40, v33
  v_mul_f32 v41, v41, v33
  v_mul_f32 v42, v42, v33
  v_mul_f32 v43, v43, v33
  v_mul_f32 v44, v44, v33
  v_mul_f32 v45, v45, v33
  v_mul_f32 v46, v46, v33
  v_mul_f32 v47, v47, v33
  v_cvt_pk_bf16_f32 v72, v40, v41
  v_lshlrev_b32 v40, 16, v72
  v_and_b32 v41, 0xffff0000, v72
  v_cvt_pk_bf16_f32 v73, v42, v43
  v_lshlrev_b32 v42, 16, v73
  v_and_b32 v43, 0xffff0000, v73
  v_cvt_pk_bf16_f32 v74, v44, v45
  v_lshlrev_b32 v44, 16, v74
  v_and_b32 v45, 0xffff0000, v74
  v_cvt_pk_bf16_f32 v75, v46, v47
  v_lshlrev_b32 v46, 16, v75
  v_and_b32 v47, 0xffff0000, v75
  v_add_f32 v40, v40, v96
  v_add_f32 v41, v41, v97
  v_add_f32 v42, v42, v98
  v_add_f32 v43, v43, v99
  v_add_f32 v44, v44, v100
  v_add_f32 v45, v45, v101
  v_add_f32 v46, v46, v102
  v_add_f32 v47, v47, v103
  v_cvt_pk_bf16_f32 v72, v40, v41
  v_lshlrev_b32 v40, 16, v72
  v_and_b32 v41, 0xffff0000, v72
  v_cvt_pk_bf16_f32 v73, v42, v43
  v_lshlrev_b32 v42, 16, v73
  v_and_b32 v43, 0xffff0000, v73
  v_cvt_pk_bf16_f32 v74, v44, v45
  v_lshlrev_b32 v44, 16, v74
  v_and_b32 v45, 0xffff0000, v74
  v_cvt_pk_bf16_f32 v75, v46, v47
  v_lshlrev_b32 v46, 16, v75
  v_and_b32 v47, 0xffff0000, v75
  v_mul_f32 v72, 0xbfb8aa3b, v40
  v_mul_f32 v73, 0xbfb8aa3b, v41
  v_mul_f32 v74, 0xbfb8aa3b, v42
  v_mul_f32 v75, 0xbfb8aa3b, v43
  v_mul_f32 v76, 0xbfb8aa3b, v44
  v_mul_f32 v77, 0xbfb8aa3b, v45
  v_mul_f32 v78, 0xbfb8aa3b, v46
  v_mul_f32 v79, 0xbfb8aa3b, v47
  v_exp_f32 v72, v72
  v_exp_f32 v73, v73
  v_exp_f32 v74, v74
  v_exp_f32 v75, v75
  v_exp_f32 v76, v76
  v_exp_f32 v77, v77
  v_exp_f32 v78, v78
  v_exp_f32 v79, v79
  v_add_f32 v72, 1.0, v72
  v_add_f32 v73, 1.0, v73
  v_add_f32 v74, 1.0, v74
  v_add_f32 v75, 1.0, v75
  v_add_f32 v76, 1.0, v76
  v_add_f32 v77, 1.0, v77
  v_add_f32 v78, 1.0, v78
  v_add_f32 v79, 1.0, v79
  v_rcp_f32 v72, v72
  v_rcp_f32 v73, v73
  v_rcp_f32 v74, v74
  v_rcp_f32 v75, v75
  v_rcp_f32 v76, v76
  v_rcp_f32 v77, v77
  v_rcp_f32 v78, v78
  v_rcp_f32 v79, v79
  v_mul_f32 v40, v40, v72
  v_mul_f32 v41, v41, v73
  v_mul_f32 v42, v42, v74
  v_mul_f32 v43, v43, v75
  v_mul_f32 v44, v44, v76
  v_mul_f32 v45, v45, v77
  v_mul_f32 v46, v46, v78
  v_mul_f32 v47, v47, v79
  v_cvt_pk_bf16_f32 v72, v40, v41
  v_lshlrev_b32 v40, 16, v72
  v_and_b32 v41, 0xffff0000, v72
  v_cvt_pk_bf16_f32 v73, v42, v43
  v_lshlrev_b32 v42, 16, v73
  v_and_b32 v43, 0xffff0000, v73
  v_cvt_pk_bf16_f32 v74, v44, v45
  v_lshlrev_b32 v44, 16, v74
  v_and_b32 v45, 0xffff0000, v74
  v_cvt_pk_bf16_f32 v75, v46, v47
  v_lshlrev_b32 v46, 16, v75
  v_and_b32 v47, 0xffff0000, v75
  v_add_u32 v1, 32, v10
  v_cmp_eq_u32 vcc, s52, v1
  v_cmp_eq_u32 s[62:63], s53, v1
  s_nop 0
  v_cndmask_b32 v96, 0, v80, vcc
  v_cndmask_b32 v96, v96, v88, s[62:63]
  v_cndmask_b32 v97, 0, v81, vcc
  v_cndmask_b32 v97, v97, v89, s[62:63]
  v_cndmask_b32 v98, 0, v82, vcc
  v_cndmask_b32 v98, v98, v90, s[62:63]
  v_cndmask_b32 v99, 0, v83, vcc
  v_cndmask_b32 v99, v99, v91, s[62:63]
  v_cndmask_b32 v100, 0, v84, vcc
  v_cndmask_b32 v100, v100, v92, s[62:63]
  v_cndmask_b32 v101, 0, v85, vcc
  v_cndmask_b32 v101, v101, v93, s[62:63]
  v_cndmask_b32 v102, 0, v86, vcc
  v_cndmask_b32 v102, v102, v94, s[62:63]
  v_cndmask_b32 v103, 0, v87, vcc
  v_cndmask_b32 v103, v103, v95, s[62:63]
  v_lshlrev_b32 v48, 16, v20
  v_and_b32 v49, 0xffff0000, v20
  v_lshlrev_b32 v50, 16, v21
  v_and_b32 v51, 0xffff0000, v21
  v_lshlrev_b32 v52, 16, v22
  v_and_b32 v53, 0xffff0000, v22
  v_lshlrev_b32 v54, 16, v23
  v_and_b32 v55, 0xffff0000, v23
  v_sub_f32 v48, v48, v34
  v_sub_f32 v49, v49, v34
  v_sub_f32 v50, v50, v34
  v_sub_f32 v51, v51, v34
  v_sub_f32 v52, v52, v34
  v_sub_f32 v53, v53, v34
  v_sub_f32 v54, v54, v34
  v_sub_f32 v55, v55, v34
  v_cvt_pk_bf16_f32 v72, v48, v49
  v_lshlrev_b32 v48, 16, v72
  v_and_b32 v49, 0xffff0000, v72
  v_cvt_pk_bf16_f32 v73, v50, v51
  v_lshlrev_b32 v50, 16, v73
  v_and_b32 v51, 0xffff0000, v73
  v_cvt_pk_bf16_f32 v74, v52, v53
  v_lshlrev_b32 v52, 16, v74
  v_and_b32 v53, 0xffff0000, v74
  v_cvt_pk_bf16_f32 v75, v54, v55
  v_lshlrev_b32 v54, 16, v75
  v_and_b32 v55, 0xffff0000, v75
  v_mul_f32 v48, v48, v35
  v_mul_f32 v49, v49, v35
  v_mul_f32 v50, v50, v35
  v_mul_f32 v51, v51, v35
  v_mul_f32 v52, v52, v35
  v_mul_f32 v53, v53, v35
  v_mul_f32 v54, v54, v35
  v_mul_f32 v55, v55, v35
  v_cvt_pk_bf16_f32 v72, v48, v49
  v_lshlrev_b32 v48, 16, v72
  v_and_b32 v49, 0xffff0000, v72
  v_cvt_pk_bf16_f32 v73, v50, v51
  v_lshlrev_b32 v50, 16, v73
  v_and_b32 v51, 0xffff0000, v73
  v_cvt_pk_bf16_f32 v74, v52, v53
  v_lshlrev_b32 v52, 16, v74
  v_and_b32 v53, 0xffff0000, v74
  v_cvt_pk_bf16_f32 v75, v54, v55
  v_lshlrev_b32 v54, 16, v75
  v_and_b32 v55, 0xffff0000, v75
  v_add_f32 v48, v48, v96
  v_add_f32 v49, v49, v97
  v_add_f32 v50, v50, v98
  v_add_f32 v51, v51, v99
  v_add_f32 v52, v52, v100
  v_add_f32 v53, v53, v101
  v_add_f32 v54, v54, v102
  v_add_f32 v55, v55, v103
  v_cvt_pk_bf16_f32 v72, v48, v49
  v_lshlrev_b32 v48, 16, v72
  v_and_b32 v49, 0xffff0000, v72
  v_cvt_pk_bf16_f32 v73, v50, v51
  v_lshlrev_b32 v50, 16, v73
  v_and_b32 v51, 0xffff0000, v73
  v_cvt_pk_bf16_f32 v74, v52, v53
  v_lshlrev_b32 v52, 16, v74
  v_and_b32 v53, 0xffff0000, v74
  v_cvt_pk_bf16_f32 v75, v54, v55
  v_lshlrev_b32 v54, 16, v75
  v_and_b32 v55, 0xffff0000, v75
  v_mul_f32 v72, 0xbfb8aa3b, v48
  v_mul_f32 v73, 0xbfb8aa3b, v49
  v_mul_f32 v74, 0xbfb8aa3b, v50
  v_mul_f32 v75, 0xbfb8aa3b, v51
  v_mul_f32 v76, 0xbfb8aa3b, v52
  v_mul_f32 v77, 0xbfb8aa3b, v53
  v_mul_f32 v78, 0xbfb8aa3b, v54
  v_mul_f32 v79, 0xbfb8aa3b, v55
  v_exp_f32 v72, v72
  v_exp_f32 v73, v73
  v_exp_f32 v74, v74
  v_exp_f32 v75, v75
  v_exp_f32 v76, v76
  v_exp_f32 v77, v77
  v_exp_f32 v78, v78
  v_exp_f32 v79, v79
  v_add_f32 v72, 1.0, v72
  v_add_f32 v73, 1.0, v73
  v_add_f32 v74, 1.0, v74
  v_add_f32 v75, 1.0, v75
  v_add_f32 v76, 1.0, v76
  v_add_f32 v77, 1.0, v77
  v_add_f32 v78, 1.0, v78
  v_add_f32 v79, 1.0, v79
  v_rcp_f32 v72, v72
  v_rcp_f32 v73, v73
  v_rcp_f32 v74, v74
  v_rcp_f32 v75, v75
  v_rcp_f32 v76, v76
  v_rcp_f32 v77, v77
  v_rcp_f32 v78, v78
  v_rcp_f32 v79, v79
  v_mul_f32 v48, v48, v72
  v_mul_f32 v49, v49, v73
  v_mul_f32 v50, v50, v74
  v_mul_f32 v51, v51, v75
  v_mul_f32 v52, v52, v76
  v_mul_f32 v53, v53, v77
  v_mul_f32 v54, v54, v78
  v_mul_f32 v55, v55, v79
  v_cvt_pk_bf16_f32 v72, v48, v49
  v_lshlrev_b32 v48, 16, v72
  v_and_b32 v49, 0xffff0000, v72
  v_cvt_pk_bf16_f32 v73, v50, v51
  v_lshlrev_b32 v50, 16, v73
  v_and_b32 v51, 0xffff0000, v73
  v_cvt_pk_bf16_f32 v74, v52, v53
  v_lshlrev_b32 v52, 16, v74
  v_and_b32 v53, 0xffff0000, v74
  v_cvt_pk_bf16_f32 v75, v54, v55
  v_lshlrev_b32 v54, 16, v75
  v_and_b32 v55, 0xffff0000, v75
  v_add_u32 v1, 64, v10
  v_cmp_eq_u32 vcc, s52, v1
  v_cmp_eq_u32 s[62:63], s53, v1
  s_nop 0
  v_cndmask_b32 v96, 0, v80, vcc
  v_cndmask_b32 v96, v96, v88, s[62:63]
  v_cndmask_b32 v97, 0, v81, vcc
  v_cndmask_b32 v97, v97, v89, s[62:63]
  v_cndmask_b32 v98, 0, v82, vcc
  v_cndmask_b32 v98, v98, v90, s[62:63]
  v_cndmask_b32 v99, 0, v83, vcc
  v_cndmask_b32 v99, v99, v91, s[62:63]
  v_cndmask_b32 v100, 0, v84, vcc
  v_cndmask_b32 v100, v100, v92, s[62:63]
  v_cndmask_b32 v101, 0, v85, vcc
  v_cndmask_b32 v101, v101, v93, s[62:63]
  v_cndmask_b32 v102, 0, v86, vcc
  v_cndmask_b32 v102, v102, v94, s[62:63]
  v_cndmask_b32 v103, 0, v87, vcc
  v_cndmask_b32 v103, v103, v95, s[62:63]
  v_lshlrev_b32 v56, 16, v24
  v_and_b32 v57, 0xffff0000, v24
  v_lshlrev_b32 v58, 16, v25
  v_and_b32 v59, 0xffff0000, v25
  v_lshlrev_b32 v60, 16, v26
  v_and_b32 v61, 0xffff0000, v26
  v_lshlrev_b32 v62, 16, v27
  v_and_b32 v63, 0xffff0000, v27
  v_sub_f32 v56, v56, v36
  v_sub_f32 v57, v57, v36
  v_sub_f32 v58, v58, v36
  v_sub_f32 v59, v59, v36
  v_sub_f32 v60, v60, v36
  v_sub_f32 v61, v61, v36
  v_sub_f32 v62, v62, v36
  v_sub_f32 v63, v63, v36
  v_cvt_pk_bf16_f32 v72, v56, v57
  v_lshlrev_b32 v56, 16, v72
  v_and_b32 v57, 0xffff0000, v72
  v_cvt_pk_bf16_f32 v73, v58, v59
  v_lshlrev_b32 v58, 16, v73
  v_and_b32 v59, 0xffff0000, v73
  v_cvt_pk_bf16_f32 v74, v60, v61
  v_lshlrev_b32 v60, 16, v74
  v_and_b32 v61, 0xffff0000, v74
  v_cvt_pk_bf16_f32 v75, v62, v63
  v_lshlrev_b32 v62, 16, v75
  v_and_b32 v63, 0xffff0000, v75
  v_mul_f32 v56, v56, v37
  v_mul_f32 v57, v57, v37
  v_mul_f32 v58, v58, v37
  v_mul_f32 v59, v59, v37
  v_mul_f32 v60, v60, v37
  v_mul_f32 v61, v61, v37
  v_mul_f32 v62, v62, v37
  v_mul_f32 v63, v63, v37
  v_cvt_pk_bf16_f32 v72, v56, v57
  v_lshlrev_b32 v56, 16, v72
  v_and_b32 v57, 0xffff0000, v72
  v_cvt_pk_bf16_f32 v73, v58, v59
  v_lshlrev_b32 v58, 16, v73
  v_and_b32 v59, 0xffff0000, v73
  v_cvt_pk_bf16_f32 v74, v60, v61
  v_lshlrev_b32 v60, 16, v74
  v_and_b32 v61, 0xffff0000, v74
  v_cvt_pk_bf16_f32 v75, v62, v63
  v_lshlrev_b32 v62, 16, v75
  v_and_b32 v63, 0xffff0000, v75
  v_add_f32 v56, v56, v96
  v_add_f32 v57, v57, v97
  v_add_f32 v58, v58, v98
  v_add_f32 v59, v59, v99
  v_add_f32 v60, v60, v100
  v_add_f32 v61, v61, v101
  v_add_f32 v62, v62, v102
  v_add_f32 v63, v63, v103
  v_cvt_pk_bf16_f32 v72, v56, v57
  v_lshlrev_b32 v56, 16, v72
  v_and_b32 v57, 0xffff0000, v72
  v_cvt_pk_bf16_f32 v73, v58, v59
  v_lshlrev_b32 v58, 16, v73
  v_and_b32 v59, 0xffff0000, v73
  v_cvt_pk_bf16_f32 v74, v60, v61
  v_lshlrev_b32 v60, 16, v74
  v_and_b32 v61, 0xffff0000, v74
  v_cvt_pk_bf16_f32 v75, v62, v63
  v_lshlrev_b32 v62, 16, v75
  v_and_b32 v63, 0xffff0000, v75
  v_mul_f32 v72, 0xbfb8aa3b, v56
  v_mul_f32 v73, 0xbfb8aa3b, v57
  v_mul_f32 v74, 0xbfb8aa3b, v58
  v_mul_f32 v75, 0xbfb8aa3b, v59
  v_mul_f32 v76, 0xbfb8aa3b, v60
  v_mul_f32 v77, 0xbfb8aa3b, v61
  v_mul_f32 v78, 0xbfb8aa3b, v62
  v_mul_f32 v79, 0xbfb8aa3b, v63
  v_exp_f32 v72, v72
  v_exp_f32 v73, v73
  v_exp_f32 v74, v74
  v_exp_f32 v75, v75
  v_exp_f32 v76, v76
  v_exp_f32 v77, v77
  v_exp_f32 v78, v78
  v_exp_f32 v79, v79
  v_add_f32 v72, 1.0, v72
  v_add_f32 v73, 1.0, v73
  v_add_f32 v74, 1.0, v74
  v_add_f32 v75, 1.0, v75
  v_add_f32 v76, 1.0, v76
  v_add_f32 v77, 1.0, v77
  v_add_f32 v78, 1.0, v78
  v_add_f32 v79, 1.0, v79
  v_rcp_f32 v72, v72
  v_rcp_f32 v73, v73
  v_rcp_f32 v74, v74
  v_rcp_f32 v75, v75
  v_rcp_f32 v76, v76
  v_rcp_f32 v77, v77
  v_rcp_f32 v78, v78
  v_rcp_f32 v79, v79
  v_mul_f32 v56, v56, v72
  v_mul_f32 v57, v57, v73
  v_mul_f32 v58, v58, v74
  v_mul_f32 v59, v59, v75
  v_mul_f32 v60, v60, v76
  v_mul_f32 v61, v61, v77
  v_mul_f32 v62, v62, v78
  v_mul_f32 v63, v63, v79
  v_cvt_pk_bf16_f32 v72, v56, v57
  v_lshlrev_b32 v56, 16, v72
  v_and_b32 v57, 0xffff0000, v72
  v_cvt_pk_bf16_f32 v73, v58, v59
  v_lshlrev_b32 v58, 16, v73
  v_and_b32 v59, 0xffff0000, v73
  v_cvt_pk_bf16_f32 v74, v60, v61
  v_lshlrev_b32 v60, 16, v74
  v_and_b32 v61, 0xffff0000, v74
  v_cvt_pk_bf16_f32 v75, v62, v63
  v_lshlrev_b32 v62, 16, v75
  v_and_b32 v63, 0xffff0000, v75
  v_add_u32 v1, 96, v10
  v_cmp_eq_u32 vcc, s52, v1
  v_cmp_eq_u32 s[62:63], s53, v1
  s_nop 0
  v_cndmask_b32 v96, 0, v80, vcc
  v_cndmask_b32 v96, v96, v88, s[62:63]
  v_cndmask_b32 v97, 0, v81, vcc
  v_cndmask_b32 v97, v97, v89, s[62:63]
  v_cndmask_b32 v98, 0, v82, vcc
  v_cndmask_b32 v98, v98, v90, s[62:63]
  v_cndmask_b32 v99, 0, v83, vcc
  v_cndmask_b32 v99, v99, v91, s[62:63]
  v_cndmask_b32 v100, 0, v84, vcc
  v_cndmask_b32 v100, v100, v92, s[62:63]
  v_cndmask_b32 v101, 0, v85, vcc
  v_cndmask_b32 v101, v101, v93, s[62:63]
  v_cndmask_b32 v102, 0, v86, vcc
  v_cndmask_b32 v102, v102, v94, s[62:63]
  v_cndmask_b32 v103, 0, v87, vcc
  v_cndmask_b32 v103, v103, v95, s[62:63]
  v_lshlrev_b32 v64, 16, v28
  v_and_b32 v65, 0xffff0000, v28
  v_lshlrev_b32 v66, 16, v29
  v_and_b32 v67, 0xffff0000, v29
  v_lshlrev_b32 v68, 16, v30
  v_and_b32 v69, 0xffff0000, v30
  v_lshlrev_b32 v70, 16, v31
  v_and_b32 v71, 0xffff0000, v31
  v_sub_f32 v64, v64, v38
  v_sub_f32 v65, v65, v38
  v_sub_f32 v66, v66, v38
  v_sub_f32 v67, v67, v38
  v_sub_f32 v68, v68, v38
  v_sub_f32 v69, v69, v38
  v_sub_f32 v70, v70, v38
  v_sub_f32 v71, v71, v38
  v_cvt_pk_bf16_f32 v72, v64, v65
  v_lshlrev_b32 v64, 16, v72
  v_and_b32 v65, 0xffff0000, v72
  v_cvt_pk_bf16_f32 v73, v66, v67
  v_lshlrev_b32 v66, 16, v73
  v_and_b32 v67, 0xffff0000, v73
  v_cvt_pk_bf16_f32 v74, v68, v69
  v_lshlrev_b32 v68, 16, v74
  v_and_b32 v69, 0xffff0000, v74
  v_cvt_pk_bf16_f32 v75, v70, v71
  v_lshlrev_b32 v70, 16, v75
  v_and_b32 v71, 0xffff0000, v75
  v_mul_f32 v64, v64, v39
  v_mul_f32 v65, v65, v39
  v_mul_f32 v66, v66, v39
  v_mul_f32 v67, v67, v39
  v_mul_f32 v68, v68, v39
  v_mul_f32 v69, v69, v39
  v_mul_f32 v70, v70, v39
  v_mul_f32 v71, v71, v39
  v_cvt_pk_bf16_f32 v72, v64, v65
  v_lshlrev_b32 v64, 16, v72
  v_and_b32 v65, 0xffff0000, v72
  v_cvt_pk_bf16_f32 v73, v66, v67
  v_lshlrev_b32 v66, 16, v73
  v_and_b32 v67, 0xffff0000, v73
  v_cvt_pk_bf16_f32 v74, v68, v69
  v_lshlrev_b32 v68, 16, v74
  v_and_b32 v69, 0xffff0000, v74
  v_cvt_pk_bf16_f32 v75, v70, v71
  v_lshlrev_b32 v70, 16, v75
  v_and_b32 v71, 0xffff0000, v75
  v_add_f32 v64, v64, v96
  v_add_f32 v65, v65, v97
  v_add_f32 v66, v66, v98
  v_add_f32 v67, v67, v99
  v_add_f32 v68, v68, v100
  v_add_f32 v69, v69, v101
  v_add_f32 v70, v70, v102
  v_add_f32 v71, v71, v103
  v_cvt_pk_bf16_f32 v72, v64, v65
  v_lshlrev_b32 v64, 16, v72
  v_and_b32 v65, 0xffff0000, v72
  v_cvt_pk_bf16_f32 v73, v66, v67
  v_lshlrev_b32 v66, 16, v73
  v_and_b32 v67, 0xffff0000, v73
  v_cvt_pk_bf16_f32 v74, v68, v69
  v_lshlrev_b32 v68, 16, v74
  v_and_b32 v69, 0xffff0000, v74
  v_cvt_pk_bf16_f32 v75, v70, v71
  v_lshlrev_b32 v70, 16, v75
  v_and_b32 v71, 0xffff0000, v75
  v_mul_f32 v72, 0xbfb8aa3b, v64
  v_mul_f32 v73, 0xbfb8aa3b, v65
  v_mul_f32 v74, 0xbfb8aa3b, v66
  v_mul_f32 v75, 0xbfb8aa3b, v67
  v_mul_f32 v76, 0xbfb8aa3b, v68
  v_mul_f32 v77, 0xbfb8aa3b, v69
  v_mul_f32 v78, 0xbfb8aa3b, v70
  v_mul_f32 v79, 0xbfb8aa3b, v71
  v_exp_f32 v72, v72
  v_exp_f32 v73, v73
  v_exp_f32 v74, v74
  v_exp_f32 v75, v75
  v_exp_f32 v76, v76
  v_exp_f32 v77, v77
  v_exp_f32 v78, v78
  v_exp_f32 v79, v79
  v_add_f32 v72, 1.0, v72
  v_add_f32 v73, 1.0, v73
  v_add_f32 v74, 1.0, v74
  v_add_f32 v75, 1.0, v75
  v_add_f32 v76, 1.0, v76
  v_add_f32 v77, 1.0, v77
  v_add_f32 v78, 1.0, v78
  v_add_f32 v79, 1.0, v79
  v_rcp_f32 v72, v72
  v_rcp_f32 v73, v73
  v_rcp_f32 v74, v74
  v_rcp_f32 v75, v75
  v_rcp_f32 v76, v76
  v_rcp_f32 v77, v77
  v_rcp_f32 v78, v78
  v_rcp_f32 v79, v79
  v_mul_f32 v64, v64, v72
  v_mul_f32 v65, v65, v73
  v_mul_f32 v66, v66, v74
  v_mul_f32 v67, v67, v75
  v_mul_f32 v68, v68, v76
  v_mul_f32 v69, v69, v77
  v_mul_f32 v70, v70, v78
  v_mul_f32 v71, v71, v79
  v_cvt_pk_bf16_f32 v72, v64, v65
  v_lshlrev_b32 v64, 16, v72
  v_and_b32 v65, 0xffff0000, v72
  v_cvt_pk_bf16_f32 v73, v66, v67
  v_lshlrev_b32 v66, 16, v73
  v_and_b32 v67, 0xffff0000, v73
  v_cvt_pk_bf16_f32 v74, v68, v69
  v_lshlrev_b32 v68, 16, v74
  v_and_b32 v69, 0xffff0000, v74
  v_cvt_pk_bf16_f32 v75, v70, v71
  v_lshlrev_b32 v70, 16, v75
  v_and_b32 v71, 0xffff0000, v75
  s_branch L_k3_selr
.section .rodata,"a"
.p2align 6
.amdhsa_kernel kv_kernel
  .amdhsa_next_free_vgpr 432
  .amdhsa_next_free_sgpr 102
  .amdhsa_accum_offset 256
  .amdhsa_group_segment_fixed_size 0
  .amdhsa_kernarg_size 112
  .amdhsa_user_sgpr_count 2
  .amdhsa_user_sgpr_kernarg_segment_ptr 1
  .amdhsa_system_sgpr_workgroup_id_x 1
.end_amdhsa_kernel
.p2align 6
.amdhsa_kernel attn_kernel
  .amdhsa_next_free_vgpr 512
  .amdhsa_next_free_sgpr 102
  .amdhsa_accum_offset 256
  .amdhsa_group_segment_fixed_size 0
  .amdhsa_kernarg_size 112
  .amdhsa_user_sgpr_count 2
  .amdhsa_user_sgpr_kernarg_segment_ptr 1
  .amdhsa_system_sgpr_workgroup_id_x 1
.end_amdhsa_kernel
.p2align 6
.amdhsa_kernel oproj_kernel
  .amdhsa_next_free_vgpr 416
  .amdhsa_next_free_sgpr 102
  .amdhsa_accum_offset 256
  .amdhsa_group_segment_fixed_size 0
  .amdhsa_kernarg_size 112
  .amdhsa_user_sgpr_count 2
  .amdhsa_user_sgpr_kernarg_segment_ptr 1
  .amdhsa_system_sgpr_workgroup_id_x 1
.end_amdhsa_kernel
```

```asm
; @launch kernel=front_kernel grid=(256,1,1) block=(256,1,1) lds=163840
; @launch kernel=oproj_kernel grid=(256,1,1) block=(256,1,1) lds=135168
.amdgcn_target "amdgcn-amd-amdhsa--gfx950"
.macro Va d,x,y
v_add_f32 v\d, v\x, v\y
.endm
.macro Vc d,x,y
v_cvt_pk_bf16_f32 v\d, v\x, v\y
.endm
.macro Ta d,x,o
ds_read_b64_tr_b16 a[\d:\d+1], v\x offset:\o
.endm
.macro Ra d,x,o
ds_read_b128 a[\d:\d+3], v\x offset:\o
.endm
.macro Zvaa d,x,y
v_mfma_f32_16x16x32_bf16 v[\d:\d+3], a[\x:\x+3], a[\y:\y+3], 0
.endm
.macro Rv d,x,o
ds_read_b128 v[\d:\d+3], v\x offset:\o
.endm
.macro Zaaa d,x,y
v_mfma_f32_16x16x32_bf16 a[\d:\d+3], a[\x:\x+3], a[\y:\y+3], 0
.endm
.macro Mvaa d,x,y
v_mfma_f32_16x16x32_bf16 v[\d:\d+3], a[\x:\x+3], a[\y:\y+3], v[\d:\d+3]
.endm
.macro Maaa d,x,y
v_mfma_f32_16x16x32_bf16 a[\d:\d+3], a[\x:\x+3], a[\y:\y+3], a[\d:\d+3]
.endm
.macro Ar d,x
v_accvgpr_read_b32 v\d, a\x
.endm
.macro Ve d,x
v_exp_f32 v\d, v\x
.endm
.macro Aw d,x
v_accvgpr_write_b32 a\d, v\x
.endm
.macro Vs d,x,y
v_sub_f32 v\d, v\x, v\y
.endm
.macro Cvaa d,x,y,c
v_mfma_f32_16x16x32_bf16 v[\d:\d+3], a[\x:\x+3], a[\y:\y+3], v[\c:\c+3]
.endm
.macro Maav d,x,y
v_mfma_f32_16x16x32_bf16 a[\d:\d+3], a[\x:\x+3], v[\y:\y+3], a[\d:\d+3]
.endm
.macro Mvvv d,x,y
v_mfma_f32_16x16x32_bf16 v[\d:\d+3], v[\x:\x+3], v[\y:\y+3], v[\d:\d+3]
.endm
.macro Vm d,x,y
v_mul_f32 v\d, v\x, v\y
.endm
.macro Zvva d,x,y
v_mfma_f32_16x16x32_bf16 v[\d:\d+3], v[\x:\x+3], a[\y:\y+3], 0
.endm
.macro Mvva d,x,y
v_mfma_f32_16x16x32_bf16 v[\d:\d+3], v[\x:\x+3], a[\y:\y+3], v[\d:\d+3]
.endm
.macro Vf d,x,y
v_fmac_f32 v\d, v\x, v\y
.endm
.text
.globl front_kernel
.p2align 8
.type front_kernel,@function
front_kernel:
s_cmp_ge_u32 s2, 256
s_cbranch_scc1 L_k2_end
s_load_dwordx4 s[4:7], s[0:1], 0
s_load_dwordx2 s[44:45], s[0:1], 56
s_load_dwordx4 s[40:43], s[0:1], 24
s_load_dwordx4 s[64:67], s[0:1], 96
v_lshrrev_b32 v1, 6, v0
v_and_b32 v0, 63, v0
v_readfirstlane_b32 s32, v1
v_lshrrev_b32 v33, 5, v0
v_and_b32 v31, 31, v0
v_lshlrev_b32 v36, 4, v31
v_lshl_add_u32 v35, v33, 11, v36
s_lshl_b32 s36, s2, 14
s_lshl_b32 s37, s32, 12
s_add_u32 s36, s36, s37
s_lshr_b32 s3, s2, 3
s_and_b32 s33, s3, 7
s_lshr_b32 s3, s3, 3
s_lshr_b32 s35, s3, 1
s_and_b32 s3, s3, 1
s_and_b32 s34, s2, 7
s_lshl_b32 s34, s34, 1
s_add_u32 s34, s34, s3
s_mov_b32 s48, 0
s_mov_b32 s52, 0
s_mov_b32 s49, 7168
s_mov_b32 s53, 15360
s_mov_b32 s50, 14336
s_mov_b32 s54, 30720
s_mov_b32 s51, 21504
s_mov_b32 s55, 46080
s_lshl_b32 s56, s32, 13
s_add_u32 s57, s56, 32768
s_lshl_b32 s3, s32, 4
v_add_u32 v30, s3, v33
v_lshlrev_b32 v30, 13, v30
v_lshlrev_b32 v34, 1, v33
v_xor_b32 v31, v31, v34
v_xor_b32 v34, 0, v31
v_lshl_add_u32 v6, v34, 4, v30
v_xor_b32 v34, 4, v31
v_lshl_add_u32 v7, v34, 4, v30
v_xor_b32 v34, 8, v31
v_lshl_add_u32 v8, v34, 4, v30
v_add_u32 v8, 65536, v8
v_xor_b32 v34, 12, v31
v_lshl_add_u32 v9, v34, 4, v30
v_add_u32 v9, 65536, v9
v_lshrrev_b32 v30, 3, v0
s_lshl_b32 s3, s32, 6
v_add_u32 v30, s3, v30
v_lshlrev_b32 v30, 10, v30
v_and_b32 v31, 7, v0
v_lshrrev_b32 v32, 4, v0
v_xor_b32 v31, v31, v32
v_lshl_add_u32 v2, v31, 4, v30
v_xor_b32 v31, 4, v31
v_lshl_add_u32 v3, v31, 4, v30
v_add_u32 v4, 32768, v2
v_add_u32 v5, 32768, v3
s_waitcnt lgkmcnt(0)
s_mov_b32 s16, s4
s_and_b32 s17, s5, 0xffff
s_mov_b32 s18, 4194304
s_mov_b32 s19, 0x20000
buffer_load_dwordx4 v[48:51], v35, s[16:19], s36 offen offset:0 nt
buffer_load_dwordx4 v[52:55], v35, s[16:19], s36 offen offset:512 nt
buffer_load_dwordx4 v[56:59], v35, s[16:19], s36 offen offset:1024 nt
buffer_load_dwordx4 v[60:63], v35, s[16:19], s36 offen offset:1536 nt
s_getpc_b64 s[68:69]
L_cpf1:
s_add_u32 s68, s68, (front_kernel-L_cpf1)&0xffffffff
s_addc_u32 s69, s69, ((front_kernel-L_cpf1)>>32)&0xffffffff
s_lshr_b32 s70, s2, 3
s_lshl_b32 s70, s70, 2
s_add_u32 s70, s70, s32
s_lshl_b32 s70, s70, 10
v_and_b32 v122, 7, v0
v_lshlrev_b32 v122, 7, v122
v_add_u32 v122, s70, v122
v_min_u32 v122, L_k2_end-front_kernel-4, v122
v_mov_b32 v121, s69
v_add_co_u32 v120, vcc, s68, v122
s_nop 1
v_addc_co_u32 v121, vcc, 0, v121, vcc
global_load_dword v124, v[120:121], off
s_cmp_eq_u32 s35, 0
s_cselect_b32 s40, s40, s42
s_cselect_b32 s41, s41, s43
s_lshl_b32 s3, s34, 9
s_add_u32 s12, s40, s3
s_addc_u32 s13, s41, 0
s_and_b32 s13, s13, 0xffff
s_mov_b32 s14, 0
s_mov_b32 s15, 0x20000
s_sub_u32 s14, 4194304, s3
s_lshl_b32 s3, s33, 18
s_add_u32 s8, s6, s3
s_addc_u32 s9, s7, 0
s_and_b32 s9, s9, 0xffff
s_mov_b32 s10, 262144
s_mov_b32 s11, 0x20000
s_add_u32 m0, s57, 0
s_nop 0
buffer_load_dwordx4 v6, s[12:15], s52 offen offset:0 nt lds
buffer_load_dwordx4 v7, s[12:15], s53 offen offset:1024 nt lds
buffer_load_dwordx4 v6, s[12:15], s54 offen offset:2048 nt lds
buffer_load_dwordx4 v7, s[12:15], s55 offen offset:3072 nt lds
s_add_u32 m0, s57, 4096
s_nop 0
buffer_load_dwordx4 v8, s[12:15], s52 offen offset:0 nt lds
buffer_load_dwordx4 v9, s[12:15], s53 offen offset:1024 nt lds
buffer_load_dwordx4 v8, s[12:15], s54 offen offset:2048 nt lds
buffer_load_dwordx4 v9, s[12:15], s55 offen offset:3072 nt lds
s_mov_b32 s28, s44
s_and_b32 s29, s45, 0xffff
s_mov_b32 s30, 2048
s_mov_b32 s31, 0x20000
s_mov_b32 s20, s66
s_and_b32 s21, s67, 0xffff
s_mov_b32 s22, 8388608
s_mov_b32 s23, 0x20000
s_add_u32 s24, s66, 8388608
s_addc_u32 s25, s67, 0
s_and_b32 s25, s25, 0xffff
s_mov_b32 s26, 35717120
s_mov_b32 s27, 0x20000
v_and_b32 v30, 15, v0
s_lshr_b32 s3, s32, 1
s_lshl_b32 s3, s3, 14
v_lshlrev_b32 v31, 7, v30
v_add_u32 v31, s3, v31
v_lshrrev_b32 v34, 1, v30
v_xor_b32 v34, v34, v32
v_lshl_add_u32 v10, v34, 4, v31
v_xor_b32 v34, 4, v34
v_lshl_add_u32 v11, v34, 4, v31
v_lshrrev_b32 v30, 2, v30
v_lshl_add_u32 v31, v32, 3, v30
v_lshlrev_b32 v31, 9, v31
v_and_b32 v34, 3, v0
v_lshl_add_u32 v31, v34, 3, v31
s_and_b32 s3, s32, 1
s_lshl_b32 s3, s3, 8
s_add_u32 s3, s3, 32768
v_add_u32 v31, s3, v31
v_and_b32 v34, 1, v32
v_lshl_add_u32 v30, v34, 2, v30
v_xor_b32 v34, 0, v30
v_lshl_add_u32 v12, v34, 5, v31
v_xor_b32 v34, 1, v30
v_lshl_add_u32 v13, v34, 5, v31
v_xor_b32 v34, 2, v30
v_lshl_add_u32 v14, v34, 5, v31
v_xor_b32 v34, 3, v30
v_lshl_add_u32 v15, v34, 5, v31
v_xor_b32 v34, 4, v30
v_lshl_add_u32 v16, v34, 5, v31
v_xor_b32 v34, 5, v30
v_lshl_add_u32 v17, v34, 5, v31
v_xor_b32 v34, 6, v30
v_lshl_add_u32 v18, v34, 5, v31
v_xor_b32 v34, 7, v30
v_lshl_add_u32 v19, v34, 5, v31
v_add_u32 v20, 65536, v10
v_add_u32 v21, 65536, v11
v_add_u32 v22, 65536, v12
v_add_u32 v23, 65536, v13
v_add_u32 v24, 65536, v14
v_add_u32 v25, 65536, v15
v_add_u32 v26, 65536, v16
v_add_u32 v27, 65536, v17
v_add_u32 v28, 65536, v18
v_add_u32 v29, 65536, v19
s_cmp_lt_u32 s32, 2
s_cselect_b32 s60, s8, s12
s_cselect_b32 s61, s9, s13
s_cselect_b32 s62, s10, s14
s_mov_b32 s63, 0x20000
s_mov_b32 s59, 524288
s_cselect_b32 s59, 128, s59
s_lshr_b32 s3, s2, 6
s_lshl_b32 s3, s3, 1
s_add_u32 s3, s3, s32
s_lshl_b32 s3, s3, 15
s_add_u32 s3, s3, 256
v_lshlrev_b32 v37, 10, v0
v_add_u32 v37, s3, v37
v_lshrrev_b32 v38, 2, v0
v_lshlrev_b32 v38, 13, v38
v_and_b32 v39, 3, v0
v_lshl_add_u32 v38, v39, 7, v38
s_lshl_b32 s39, s33, 1
s_add_u32 s39, s39, s32
s_lshl_b32 s39, s39, 15
s_add_u32 s39, s39, 983040
v_add_u32 v38, s39, v38
s_cmp_lt_u32 s32, 2
s_cselect_b64 vcc, -1, 0
s_cselect_b32 s3, 32, 16
v_cndmask_b32 v47, v38, v37, vcc
v_cmp_gt_u32 vcc, s3, v0
v_mov_b32 v37, 2146435072
s_nop 0
v_cndmask_b32 v47, v37, v47, vcc
s_add_u32 m0, s56, 0
s_nop 0
buffer_load_dwordx4 v2, s[8:11], s48 offen offset:0 lds
buffer_load_dwordx4 v3, s[8:11], s49 offen offset:1024 lds
buffer_load_dwordx4 v2, s[8:11], s50 offen offset:2048 lds
buffer_load_dwordx4 v3, s[8:11], s51 offen offset:3072 lds
s_add_u32 m0, s56, 4096
s_nop 0
buffer_load_dwordx4 v4, s[8:11], s48 offen offset:0 lds
buffer_load_dwordx4 v5, s[8:11], s49 offen offset:1024 lds
buffer_load_dwordx4 v4, s[8:11], s50 offen offset:2048 lds
buffer_load_dwordx4 v5, s[8:11], s51 offen offset:3072 lds
buffer_load_dwordx4 v[64:67], v36, s[28:31], 0 offen offset:0
buffer_load_dwordx4 v[68:71], v36, s[28:31], 0 offen offset:512
buffer_load_dwordx4 v[72:75], v36, s[28:31], 0 offen offset:1024
buffer_load_dwordx4 v[76:79], v36, s[28:31], 0 offen offset:1536
v_add_u32 v6, 524288, v6
v_add_u32 v7, 524288, v7
v_add_u32 v8, 524288, v8
v_add_u32 v9, 524288, v9
v_add_u32 v2, 128, v2
v_add_u32 v3, 128, v3
v_add_u32 v4, 128, v4
v_add_u32 v5, 128, v5
s_waitcnt vmcnt(21)
v_lshlrev_b32 v80, 16, v48
v_and_b32 v81, 0xffff0000, v48
v_lshlrev_b32 v82, 16, v49
v_and_b32 v83, 0xffff0000, v49
v_lshlrev_b32 v84, 16, v50
v_and_b32 v85, 0xffff0000, v50
v_lshlrev_b32 v86, 16, v51
v_and_b32 v87, 0xffff0000, v51
v_lshlrev_b32 v88, 16, v52
v_and_b32 v89, 0xffff0000, v52
v_lshlrev_b32 v90, 16, v53
v_and_b32 v91, 0xffff0000, v53
v_lshlrev_b32 v92, 16, v54
v_and_b32 v93, 0xffff0000, v54
v_lshlrev_b32 v94, 16, v55
v_and_b32 v95, 0xffff0000, v55
v_lshlrev_b32 v96, 16, v56
v_and_b32 v97, 0xffff0000, v56
v_lshlrev_b32 v98, 16, v57
v_and_b32 v99, 0xffff0000, v57
v_lshlrev_b32 v100, 16, v58
v_and_b32 v101, 0xffff0000, v58
v_lshlrev_b32 v102, 16, v59
v_and_b32 v103, 0xffff0000, v59
v_lshlrev_b32 v104, 16, v60
v_and_b32 v105, 0xffff0000, v60
v_lshlrev_b32 v106, 16, v61
v_and_b32 v107, 0xffff0000, v61
v_lshlrev_b32 v108, 16, v62
v_and_b32 v109, 0xffff0000, v62
v_lshlrev_b32 v110, 16, v63
v_and_b32 v111, 0xffff0000, v63
v_pk_add_f32 v[40:41], v[80:81], v[82:83]
v_pk_add_f32 v[42:43], v[84:85], v[86:87]
v_pk_add_f32 v[40:41], v[40:41], v[88:89]
v_pk_add_f32 v[42:43], v[42:43], v[90:91]
v_pk_add_f32 v[40:41], v[40:41], v[92:93]
v_pk_add_f32 v[42:43], v[42:43], v[94:95]
v_pk_add_f32 v[40:41], v[40:41], v[96:97]
v_pk_add_f32 v[42:43], v[42:43], v[98:99]
v_pk_add_f32 v[40:41], v[40:41], v[100:101]
v_pk_add_f32 v[42:43], v[42:43], v[102:103]
v_pk_add_f32 v[40:41], v[40:41], v[104:105]
v_pk_add_f32 v[42:43], v[42:43], v[106:107]
v_pk_add_f32 v[40:41], v[40:41], v[108:109]
v_pk_add_f32 v[42:43], v[42:43], v[110:111]
v_pk_add_f32 v[40:41], v[40:41], v[42:43]
Va 38,40,41
s_nop 1
v_add_f32_dpp v38, v38, v38 quad_perm:[1,0,3,2] row_mask:0xf bank_mask:0xf
s_nop 1
v_add_f32_dpp v38, v38, v38 quad_perm:[2,3,0,1] row_mask:0xf bank_mask:0xf
s_nop 1
v_add_f32_dpp v38, v38, v38 row_half_mirror row_mask:0xf bank_mask:0xf
s_nop 1
v_add_f32_dpp v38, v38, v38 row_mirror row_mask:0xf bank_mask:0xf
v_mov_b32 v37, v38
s_nop 1
v_permlane16_swap_b32 v37, v38
Va 38,38,37
s_add_u32 m0, s57, 65536
s_nop 0
buffer_load_dwordx4 v6, s[12:15], s52 offen offset:0 nt lds
buffer_load_dwordx4 v7, s[12:15], s53 offen offset:1024 nt lds
buffer_load_dwordx4 v6, s[12:15], s54 offen offset:2048 nt lds
buffer_load_dwordx4 v7, s[12:15], s55 offen offset:3072 nt lds
s_add_u32 m0, s57, 69632
s_nop 0
buffer_load_dwordx4 v8, s[12:15], s52 offen offset:0 nt lds
buffer_load_dwordx4 v9, s[12:15], s53 offen offset:1024 nt lds
buffer_load_dwordx4 v8, s[12:15], s54 offen offset:2048 nt lds
buffer_load_dwordx4 v9, s[12:15], s55 offen offset:3072 nt lds
v_mul_f32 v38, 0xba800000, v38
v_mov_b32 v39, v38
v_pk_add_f32 v[112:113], v[80:81], v[38:39]
v_pk_mul_f32 v[40:41], v[112:113], v[112:113]
v_pk_add_f32 v[114:115], v[82:83], v[38:39]
v_pk_mul_f32 v[42:43], v[114:115], v[114:115]
v_pk_add_f32 v[116:117], v[84:85], v[38:39]
v_pk_fma_f32 v[40:41], v[116:117], v[116:117], v[40:41]
v_pk_add_f32 v[118:119], v[86:87], v[38:39]
v_pk_fma_f32 v[42:43], v[118:119], v[118:119], v[42:43]
v_pk_add_f32 v[112:113], v[88:89], v[38:39]
v_pk_fma_f32 v[40:41], v[112:113], v[112:113], v[40:41]
v_pk_add_f32 v[114:115], v[90:91], v[38:39]
v_pk_fma_f32 v[42:43], v[114:115], v[114:115], v[42:43]
v_pk_add_f32 v[116:117], v[92:93], v[38:39]
v_pk_fma_f32 v[40:41], v[116:117], v[116:117], v[40:41]
v_pk_add_f32 v[118:119], v[94:95], v[38:39]
v_pk_fma_f32 v[42:43], v[118:119], v[118:119], v[42:43]
v_pk_add_f32 v[112:113], v[96:97], v[38:39]
v_pk_fma_f32 v[40:41], v[112:113], v[112:113], v[40:41]
v_pk_add_f32 v[114:115], v[98:99], v[38:39]
v_pk_fma_f32 v[42:43], v[114:115], v[114:115], v[42:43]
v_pk_add_f32 v[116:117], v[100:101], v[38:39]
v_pk_fma_f32 v[40:41], v[116:117], v[116:117], v[40:41]
v_pk_add_f32 v[118:119], v[102:103], v[38:39]
v_pk_fma_f32 v[42:43], v[118:119], v[118:119], v[42:43]
v_pk_add_f32 v[112:113], v[104:105], v[38:39]
v_pk_fma_f32 v[40:41], v[112:113], v[112:113], v[40:41]
v_pk_add_f32 v[114:115], v[106:107], v[38:39]
v_pk_fma_f32 v[42:43], v[114:115], v[114:115], v[42:43]
v_pk_add_f32 v[116:117], v[108:109], v[38:39]
v_pk_fma_f32 v[40:41], v[116:117], v[116:117], v[40:41]
v_pk_add_f32 v[118:119], v[110:111], v[38:39]
v_pk_fma_f32 v[42:43], v[118:119], v[118:119], v[42:43]
v_pk_add_f32 v[40:41], v[40:41], v[42:43]
Va 40,40,41
s_nop 1
v_add_f32_dpp v40, v40, v40 quad_perm:[1,0,3,2] row_mask:0xf bank_mask:0xf
s_nop 1
v_add_f32_dpp v40, v40, v40 quad_perm:[2,3,0,1] row_mask:0xf bank_mask:0xf
s_nop 1
v_add_f32_dpp v40, v40, v40 row_half_mirror row_mask:0xf bank_mask:0xf
s_nop 1
v_add_f32_dpp v40, v40, v40 row_mirror row_mask:0xf bank_mask:0xf
v_mov_b32 v37, v40
s_nop 1
v_permlane16_swap_b32 v37, v40
Va 40,40,37
s_add_u32 m0, s56, 65536
s_nop 0
buffer_load_dwordx4 v2, s[8:11], s48 offen offset:0 lds
buffer_load_dwordx4 v3, s[8:11], s49 offen offset:1024 lds
buffer_load_dwordx4 v2, s[8:11], s50 offen offset:2048 lds
buffer_load_dwordx4 v3, s[8:11], s51 offen offset:3072 lds
s_add_u32 m0, s56, 69632
s_nop 0
buffer_load_dwordx4 v4, s[8:11], s48 offen offset:0 lds
buffer_load_dwordx4 v5, s[8:11], s49 offen offset:1024 lds
buffer_load_dwordx4 v4, s[8:11], s50 offen offset:2048 lds
buffer_load_dwordx4 v5, s[8:11], s51 offen offset:3072 lds
v_mul_f32 v40, 0x3a800000, v40
Vc 44,38,40
v_lshlrev_b32 v38, 16, v44
v_and_b32 v40, 0xffff0000, v44
v_add_f32 v40, 0x3727c5ac, v40
Vc 44,40,40
v_lshlrev_b32 v40, 16, v44
v_sqrt_f32 v40, v40
v_mov_b32 v39, v38
Vc 44,40,40
v_lshlrev_b32 v44, 16, v44
v_rcp_f32 v40, v44
v_pk_add_f32 v[80:81], v[80:81], v[38:39]
v_pk_add_f32 v[82:83], v[82:83], v[38:39]
v_pk_add_f32 v[84:85], v[84:85], v[38:39]
v_pk_add_f32 v[86:87], v[86:87], v[38:39]
v_pk_add_f32 v[88:89], v[88:89], v[38:39]
v_pk_add_f32 v[90:91], v[90:91], v[38:39]
v_pk_add_f32 v[92:93], v[92:93], v[38:39]
v_pk_add_f32 v[94:95], v[94:95], v[38:39]
v_pk_add_f32 v[96:97], v[96:97], v[38:39]
v_pk_add_f32 v[98:99], v[98:99], v[38:39]
v_pk_add_f32 v[100:101], v[100:101], v[38:39]
v_pk_add_f32 v[102:103], v[102:103], v[38:39]
v_pk_add_f32 v[104:105], v[104:105], v[38:39]
v_pk_add_f32 v[106:107], v[106:107], v[38:39]
v_pk_add_f32 v[108:109], v[108:109], v[38:39]
v_pk_add_f32 v[110:111], v[110:111], v[38:39]
v_fma_f32 v45, -v44, v40, 1.0
v_fma_f32 v40, v45, v40, v40
v_mov_b32 v41, v40
Vc 48,80,81
Vc 49,82,83
Vc 50,84,85
Vc 51,86,87
Vc 52,88,89
Vc 53,90,91
Vc 54,92,93
Vc 55,94,95
Vc 56,96,97
Vc 57,98,99
Vc 58,100,101
Vc 59,102,103
Vc 60,104,105
Vc 61,106,107
Vc 62,108,109
Vc 63,110,111
v_lshlrev_b32 v80, 16, v48
v_and_b32 v81, 0xffff0000, v48
v_lshlrev_b32 v82, 16, v49
v_and_b32 v83, 0xffff0000, v49
v_lshlrev_b32 v84, 16, v50
v_and_b32 v85, 0xffff0000, v50
v_lshlrev_b32 v86, 16, v51
v_and_b32 v87, 0xffff0000, v51
v_lshlrev_b32 v88, 16, v52
v_and_b32 v89, 0xffff0000, v52
v_lshlrev_b32 v90, 16, v53
v_and_b32 v91, 0xffff0000, v53
v_lshlrev_b32 v92, 16, v54
v_and_b32 v93, 0xffff0000, v54
v_lshlrev_b32 v94, 16, v55
v_and_b32 v95, 0xffff0000, v55
v_lshlrev_b32 v96, 16, v56
v_and_b32 v97, 0xffff0000, v56
v_lshlrev_b32 v98, 16, v57
v_and_b32 v99, 0xffff0000, v57
v_lshlrev_b32 v100, 16, v58
v_and_b32 v101, 0xffff0000, v58
v_lshlrev_b32 v102, 16, v59
v_and_b32 v103, 0xffff0000, v59
v_lshlrev_b32 v104, 16, v60
v_and_b32 v105, 0xffff0000, v60
v_lshlrev_b32 v106, 16, v61
v_and_b32 v107, 0xffff0000, v61
v_lshlrev_b32 v108, 16, v62
v_and_b32 v109, 0xffff0000, v62
v_lshlrev_b32 v110, 16, v63
v_and_b32 v111, 0xffff0000, v63
v_pk_mul_f32 v[80:81], v[80:81], v[40:41]
v_pk_mul_f32 v[82:83], v[82:83], v[40:41]
v_pk_mul_f32 v[84:85], v[84:85], v[40:41]
v_pk_mul_f32 v[86:87], v[86:87], v[40:41]
v_pk_mul_f32 v[88:89], v[88:89], v[40:41]
v_pk_mul_f32 v[90:91], v[90:91], v[40:41]
v_pk_mul_f32 v[92:93], v[92:93], v[40:41]
v_pk_mul_f32 v[94:95], v[94:95], v[40:41]
v_pk_mul_f32 v[96:97], v[96:97], v[40:41]
v_pk_mul_f32 v[98:99], v[98:99], v[40:41]
v_pk_mul_f32 v[100:101], v[100:101], v[40:41]
v_pk_mul_f32 v[102:103], v[102:103], v[40:41]
v_pk_mul_f32 v[104:105], v[104:105], v[40:41]
v_pk_mul_f32 v[106:107], v[106:107], v[40:41]
v_pk_mul_f32 v[108:109], v[108:109], v[40:41]
v_pk_mul_f32 v[110:111], v[110:111], v[40:41]
Vc 48,80,81
Vc 49,82,83
Vc 50,84,85
Vc 51,86,87
Vc 52,88,89
Vc 53,90,91
Vc 54,92,93
Vc 55,94,95
Vc 56,96,97
Vc 57,98,99
Vc 58,100,101
Vc 59,102,103
Vc 60,104,105
Vc 61,106,107
Vc 62,108,109
Vc 63,110,111
s_mul_i32 s3, s32, 4128
s_add_u32 s3, s3, 131072
v_mul_u32_u24 v42, 2064, v33
v_add3_u32 v42, v42, v36, s3
ds_write_b128 v42, v[48:51] offset:0
ds_write_b128 v42, v[52:55] offset:512
ds_write_b128 v42, v[56:59] offset:1024
ds_write_b128 v42, v[60:63] offset:1536
v_add_u32 v6, 524288, v6
v_add_u32 v7, 524288, v7
v_add_u32 v8, 524288, v8
v_add_u32 v9, 524288, v9
v_add_u32 v2, 128, v2
v_add_u32 v3, 128, v3
v_add_u32 v4, 128, v4
v_add_u32 v5, 128, v5
buffer_load_dword v1, v47, s[60:63], 0 offen
v_add_u32 v47, s59, v47
buffer_load_dword v1, v47, s[60:63], 0 offen
v_add_u32 v47, s59, v47
s_waitcnt vmcnt(18)
v_lshlrev_b32 v80, 16, v48
v_and_b32 v81, 0xffff0000, v48
v_lshlrev_b32 v112, 16, v64
v_and_b32 v113, 0xffff0000, v64
v_pk_mul_f32 v[42:43], v[80:81], v[112:113]
v_lshlrev_b32 v82, 16, v49
v_and_b32 v83, 0xffff0000, v49
v_lshlrev_b32 v114, 16, v65
v_and_b32 v115, 0xffff0000, v65
v_pk_mul_f32 v[44:45], v[82:83], v[114:115]
v_lshlrev_b32 v84, 16, v50
v_and_b32 v85, 0xffff0000, v50
v_lshlrev_b32 v116, 16, v66
v_and_b32 v117, 0xffff0000, v66
v_pk_fma_f32 v[42:43], v[84:85], v[116:117], v[42:43]
v_lshlrev_b32 v86, 16, v51
v_and_b32 v87, 0xffff0000, v51
v_lshlrev_b32 v118, 16, v67
v_and_b32 v119, 0xffff0000, v67
v_pk_fma_f32 v[44:45], v[86:87], v[118:119], v[44:45]
v_lshlrev_b32 v88, 16, v52
v_and_b32 v89, 0xffff0000, v52
v_lshlrev_b32 v112, 16, v68
v_and_b32 v113, 0xffff0000, v68
v_pk_fma_f32 v[42:43], v[88:89], v[112:113], v[42:43]
v_lshlrev_b32 v90, 16, v53
v_and_b32 v91, 0xffff0000, v53
v_lshlrev_b32 v114, 16, v69
v_and_b32 v115, 0xffff0000, v69
v_pk_fma_f32 v[44:45], v[90:91], v[114:115], v[44:45]
v_lshlrev_b32 v92, 16, v54
v_and_b32 v93, 0xffff0000, v54
v_lshlrev_b32 v116, 16, v70
v_and_b32 v117, 0xffff0000, v70
v_pk_fma_f32 v[42:43], v[92:93], v[116:117], v[42:43]
v_lshlrev_b32 v94, 16, v55
v_and_b32 v95, 0xffff0000, v55
v_lshlrev_b32 v118, 16, v71
v_and_b32 v119, 0xffff0000, v71
v_pk_fma_f32 v[44:45], v[94:95], v[118:119], v[44:45]
v_lshlrev_b32 v96, 16, v56
v_and_b32 v97, 0xffff0000, v56
v_lshlrev_b32 v112, 16, v72
v_and_b32 v113, 0xffff0000, v72
v_pk_fma_f32 v[42:43], v[96:97], v[112:113], v[42:43]
v_lshlrev_b32 v98, 16, v57
v_and_b32 v99, 0xffff0000, v57
v_lshlrev_b32 v114, 16, v73
v_and_b32 v115, 0xffff0000, v73
v_pk_fma_f32 v[44:45], v[98:99], v[114:115], v[44:45]
v_lshlrev_b32 v100, 16, v58
v_and_b32 v101, 0xffff0000, v58
v_lshlrev_b32 v116, 16, v74
v_and_b32 v117, 0xffff0000, v74
v_pk_fma_f32 v[42:43], v[100:101], v[116:117], v[42:43]
v_lshlrev_b32 v102, 16, v59
v_and_b32 v103, 0xffff0000, v59
v_lshlrev_b32 v118, 16, v75
v_and_b32 v119, 0xffff0000, v75
v_pk_fma_f32 v[44:45], v[102:103], v[118:119], v[44:45]
v_lshlrev_b32 v104, 16, v60
v_and_b32 v105, 0xffff0000, v60
v_lshlrev_b32 v112, 16, v76
v_and_b32 v113, 0xffff0000, v76
v_pk_fma_f32 v[42:43], v[104:105], v[112:113], v[42:43]
v_lshlrev_b32 v106, 16, v61
v_and_b32 v107, 0xffff0000, v61
v_lshlrev_b32 v114, 16, v77
v_and_b32 v115, 0xffff0000, v77
v_pk_fma_f32 v[44:45], v[106:107], v[114:115], v[44:45]
v_lshlrev_b32 v108, 16, v62
v_and_b32 v109, 0xffff0000, v62
v_lshlrev_b32 v116, 16, v78
v_and_b32 v117, 0xffff0000, v78
v_pk_fma_f32 v[42:43], v[108:109], v[116:117], v[42:43]
v_lshlrev_b32 v110, 16, v63
v_and_b32 v111, 0xffff0000, v63
v_lshlrev_b32 v118, 16, v79
v_and_b32 v119, 0xffff0000, v79
v_pk_fma_f32 v[44:45], v[110:111], v[118:119], v[44:45]
v_pk_add_f32 v[42:43], v[42:43], v[44:45]
Va 45,42,43
s_nop 1
v_add_f32_dpp v45, v45, v45 quad_perm:[1,0,3,2] row_mask:0xf bank_mask:0xf
s_nop 1
v_add_f32_dpp v45, v45, v45 quad_perm:[2,3,0,1] row_mask:0xf bank_mask:0xf
s_nop 1
v_add_f32_dpp v45, v45, v45 row_half_mirror row_mask:0xf bank_mask:0xf
s_nop 1
v_add_f32_dpp v45, v45, v45 row_mirror row_mask:0xf bank_mask:0xf
v_mov_b32 v37, v45
s_nop 1
v_permlane16_swap_b32 v37, v45
Va 45,45,37
Vc 45,45,45
v_ashrrev_i32 v46, 31, v45
v_or_b32 v46, 0x80000000, v46
v_xor_b32 v45, v45, v46
v_and_b32 v45, 0xffff0000, v45
s_lshr_b32 s3, s36, 11
v_add_u32 v46, s3, v33
v_sub_u32 v44, 0xffff, v46
v_or_b32 v45, v45, v44
v_lshlrev_b32 v44, 2, v46
v_lshlrev_b32 v46, 3, v46
v_xor_b32 v38, 0x80000000, v38
v_mov_b32 v39, v40
s_mov_b32 s3, 5242880
s_mov_b32 s39, 5259264
s_mov_b32 exec_lo, 1
s_mov_b32 exec_hi, 1
buffer_store_dword v45, v44, s[20:23], s3 offen sc1
buffer_store_dwordx2 v[38:39], v46, s[20:23], s39 offen
s_mov_b64 exec, -1
s_load_dwordx2 s[4:5], s[0:1], 16
s_load_dwordx4 s[40:43], s[0:1], 64
s_mov_b32 s28, s64
s_and_b32 s29, s65, 0xffff
s_mov_b32 s30, 256
s_mov_b32 s31, 0x20000
s_waitcnt lgkmcnt(0)
s_barrier
Ta 32,12,0
Ta 34,12,2048
Ra 0,10,0
Ta 36,13,0
Ta 38,13,2048
Ra 4,10,2048
Ta 40,14,0
Ta 42,14,2048
Ra 8,10,4096
Ta 44,15,0
Ta 46,15,2048
Ra 12,10,6144
s_waitcnt lgkmcnt(2)
Ta 48,16,0
Ta 50,16,2048
Ra 16,10,8192
Ta 52,17,0
Ta 54,17,2048
Ra 20,10,10240
Ta 56,18,0
Ta 58,18,2048
Ra 24,10,12288
Ta 60,19,0
Ta 62,19,2048
Ra 28,10,14336
s_cmp_lg_u32 s35, 0
s_cbranch_scc1 L_k1_vpath
s_waitcnt lgkmcnt(0)
Zvaa 48,32,0
v_and_b32 v46, 7, v0
v_mul_u32_u24 v30, 2064, v46
Zvaa 52,36,0
Ta 96,12,16384
Ta 98,12,18432
Zvaa 56,40,0
v_lshrrev_b32 v31, 3, v0
Zvaa 60,44,0
Ra 64,11,0
Zvaa 64,48,0
s_lshl_b32 s3, s32, 9
s_add_u32 s3, s3, 131072
v_lshl_add_u32 v30, v31, 4, v30
Zvaa 68,52,0
Ta 100,13,16384
Ta 102,13,18432
Zvaa 72,56,0
v_add_u32 v30, s3, v30
v_lshlrev_b32 v31, 8, v31
Zvaa 76,60,0
s_waitcnt lgkmcnt(6)
Ra 68,11,2048
Zvaa 80,32,4
v_lshl_add_u32 v46, v46, 4, v31
Zvaa 84,36,4
Ta 104,14,16384
Ta 106,14,18432
Zvaa 88,40,4
Rv 34,30,128
Rv 38,30,256
Zvaa 92,44,4
Ra 72,11,4096
Zvaa 96,48,4
Rv 42,30,384
Rv 30,30,0
Zvaa 100,52,4
Ta 108,15,16384
Ta 110,15,18432
Zvaa 104,56,4
s_lshr_b32 s3, s2, 1
s_mul_i32 s3, s3, 33792
s_add_u32 s3, s3, s56
Zvaa 108,60,4
s_waitcnt lgkmcnt(6)
Ra 76,11,6144
Zvaa 112,32,8
s_and_b32 s39, s2, 1
s_lshl_b32 s39, s39, 7
s_add_u32 s3, s3, s39
Zvaa 116,36,8
Ta 112,16,16384
Ta 114,16,18432
Zvaa 120,40,8
s_add_u32 s39, s3, 4096
Zvaa 124,44,8
Ra 80,11,8192
Zvaa 128,48,8
Zvaa 132,52,8
Ta 116,17,16384
Ta 118,17,18432
Zvaa 136,56,8
Zvaa 140,60,8
s_waitcnt lgkmcnt(6)
Ra 84,11,10240
Zvaa 144,32,12
Zvaa 148,36,12
Ta 120,18,16384
Ta 122,18,18432
Zvaa 152,40,12
Zvaa 156,44,12
Ra 88,11,12288
Zvaa 160,48,12
Zvaa 164,52,12
Ta 124,19,16384
Ta 126,19,18432
Zvaa 168,56,12
Zvaa 172,60,12
s_waitcnt lgkmcnt(6)
Ra 92,11,14336
Zvaa 176,32,16
Zvaa 180,36,16
Zvaa 184,40,16
Zvaa 188,44,16
Zvaa 192,48,16
Zvaa 196,52,16
Zvaa 200,56,16
Zvaa 204,60,16
Zvaa 208,32,20
Zvaa 212,36,20
Zvaa 216,40,20
Zvaa 220,44,20
Zvaa 224,48,20
Zvaa 228,52,20
Zvaa 232,56,20
Zvaa 236,60,20
Zvaa 240,32,24
Zvaa 244,36,24
Zvaa 248,40,24
Zvaa 252,44,24
Zaaa 128,48,24
Zaaa 132,52,24
Zaaa 136,56,24
Zaaa 140,60,24
Zaaa 144,32,28
Zaaa 148,36,28
Zaaa 152,40,28
Zaaa 156,44,28
Zaaa 160,48,28
Zaaa 164,52,28
Zaaa 168,56,28
Zaaa 172,60,28
s_waitcnt vmcnt(4) lgkmcnt(0)
s_add_u32 m0, s57, 0
s_barrier
Mvaa 48,96,64
buffer_load_dwordx4 v6, s[12:15], s52 offen offset:0 nt lds
Mvaa 52,100,64
Ta 32,22,0
Ta 34,22,2048
Mvaa 56,104,64
Mvaa 60,108,64
Ra 0,20,0
Mvaa 64,112,64
buffer_load_dwordx4 v7, s[12:15], s53 offen offset:1024 nt lds
Mvaa 68,116,64
s_waitcnt lgkmcnt(6)
Ta 36,23,0
Ta 38,23,2048
Mvaa 72,120,64
Mvaa 76,124,64
Ra 4,20,2048
Mvaa 80,96,68
buffer_load_dwordx4 v6, s[12:15], s54 offen offset:2048 nt lds
Mvaa 84,100,68
Ta 40,24,0
Ta 42,24,2048
Mvaa 88,104,68
Mvaa 92,108,68
Ra 8,20,4096
Mvaa 96,112,68
buffer_load_dwordx4 v7, s[12:15], s55 offen offset:3072 nt lds
Mvaa 100,116,68
s_waitcnt lgkmcnt(6)
Ta 44,25,0
Ta 46,25,2048
Mvaa 104,120,68
Mvaa 108,124,68
s_add_u32 m0, s57, 4096
Ra 12,20,6144
Mvaa 112,96,72
buffer_load_dwordx4 v8, s[12:15], s52 offen offset:0 nt lds
Mvaa 116,100,72
Ta 48,26,0
Ta 50,26,2048
Mvaa 120,104,72
Mvaa 124,108,72
Ra 16,20,8192
Mvaa 128,112,72
buffer_load_dwordx4 v9, s[12:15], s53 offen offset:1024 nt lds
Mvaa 132,116,72
s_waitcnt lgkmcnt(6)
Ta 52,27,0
Ta 54,27,2048
Mvaa 136,120,72
Mvaa 140,124,72
Ra 20,20,10240
Mvaa 144,96,76
buffer_load_dwordx4 v8, s[12:15], s54 offen offset:2048 nt lds
Mvaa 148,100,76
Ta 56,28,0
Ta 58,28,2048
Mvaa 152,104,76
Mvaa 156,108,76
Ra 24,20,12288
Mvaa 160,112,76
buffer_load_dwordx4 v9, s[12:15], s55 offen offset:3072 nt lds
Mvaa 164,116,76
s_waitcnt lgkmcnt(6)
Ta 60,29,0
Ta 62,29,2048
Mvaa 168,120,76
v_add_u32 v6, 524288, v6
v_add_u32 v7, 524288, v7
Mvaa 172,124,76
s_add_u32 m0, s56, 0
Ra 28,20,14336
v_add_u32 v8, 524288, v8
Mvaa 176,96,80
buffer_load_dwordx4 v2, s[8:11], s48 offen offset:0 lds
Mvaa 180,100,80
v_add_u32 v9, 524288, v9
Mvaa 184,104,80
Mvaa 188,108,80
Mvaa 192,112,80
buffer_load_dwordx4 v3, s[8:11], s49 offen offset:1024 lds
Mvaa 196,116,80
Mvaa 200,120,80
Mvaa 204,124,80
Mvaa 208,96,84
buffer_load_dwordx4 v2, s[8:11], s50 offen offset:2048 lds
Mvaa 212,100,84
Mvaa 216,104,84
Mvaa 220,108,84
Mvaa 224,112,84
buffer_load_dwordx4 v3, s[8:11], s51 offen offset:3072 lds
Mvaa 228,116,84
Mvaa 232,120,84
Mvaa 236,124,84
s_add_u32 m0, s56, 4096
Mvaa 240,96,88
buffer_load_dwordx4 v4, s[8:11], s48 offen offset:0 lds
Mvaa 244,100,88
Mvaa 248,104,88
Mvaa 252,108,88
Maaa 128,112,88
buffer_load_dwordx4 v5, s[8:11], s49 offen offset:1024 lds
Maaa 132,116,88
Maaa 136,120,88
Maaa 140,124,88
Maaa 144,96,92
buffer_load_dwordx4 v4, s[8:11], s50 offen offset:2048 lds
Maaa 148,100,92
Maaa 152,104,92
Maaa 156,108,92
Maaa 160,112,92
buffer_load_dwordx4 v5, s[8:11], s51 offen offset:3072 lds
Maaa 164,116,92
v_add_u32 v2, 128, v2
v_add_u32 v3, 128, v3
Maaa 168,120,92
buffer_load_dword v1, v47, s[60:63], 0 offen
v_add_u32 v4, 128, v4
v_add_u32 v5, 128, v5
Maaa 172,124,92
v_add_u32 v47, s59, v47
s_waitcnt lgkmcnt(0)
Mvaa 48,32,0
buffer_store_dwordx4 v[30:33], v46, s[20:23], s3 offen offset:0 sc1
Mvaa 52,36,0
Ta 96,22,16384
Ta 98,22,18432
Mvaa 56,40,0
buffer_store_dwordx4 v[34:37], v46, s[20:23], s3 offen offset:2048 sc1
Mvaa 60,44,0
Ra 64,21,0
Mvaa 64,48,0
buffer_store_dwordx4 v[38:41], v46, s[20:23], s39 offen offset:0 sc1
Mvaa 68,52,0
Ta 100,23,16384
Ta 102,23,18432
Mvaa 72,56,0
buffer_store_dwordx4 v[42:45], v46, s[20:23], s39 offen offset:2048 sc1
Mvaa 76,60,0
s_waitcnt lgkmcnt(6)
Ra 68,21,2048
Mvaa 80,32,4
s_lshl_b32 s3, s34, 1
s_and_b32 s36, s32, 1
s_add_u32 s3, s3, s36
Mvaa 84,36,4
Ta 104,24,16384
Ta 106,24,18432
Mvaa 88,40,4
s_mul_i32 s3, s3, 1116160
s_mul_i32 s36, s33, 139264
s_add_u32 s3, s3, s36
Mvaa 92,44,4
Ra 72,21,4096
Mvaa 96,48,4
s_lshr_b32 s36, s32, 1
s_mul_i32 s36, s36, 69632
s_add_u32 s3, s3, s36
Mvaa 100,52,4
Ta 108,25,16384
Ta 110,25,18432
Mvaa 104,56,4
s_add_u32 s38, s3, 0
s_lshl_b32 s39, s34, 7
s_lshl_b32 s36, s33, 2
Mvaa 108,60,4
s_waitcnt lgkmcnt(6)
Ra 76,21,6144
Mvaa 112,32,8
s_add_u32 s39, s39, s36
s_add_u32 s39, s39, 5296128
v_mov_b32 v30, 1
Mvaa 116,36,8
Ta 112,26,16384
Ta 114,26,18432
Mvaa 120,40,8
v_mov_b32 v31, 0
Mvaa 124,44,8
Ra 80,21,8192
Mvaa 128,48,8
s_cmp_eq_u32 s32, 0
s_cselect_b32 s39, s39, 2146435072
Mvaa 132,52,8
Ta 116,27,16384
Ta 118,27,18432
Mvaa 136,56,8
s_mov_b64 exec, 1
buffer_store_dword v31, v31, s[20:23], s39 offen sc1
s_mov_b64 exec, -1
Mvaa 140,60,8
s_waitcnt lgkmcnt(6)
Ra 84,21,10240
Mvaa 144,32,12
s_and_b32 s33, s2, 7
s_lshl_b32 s33, s33, 2
s_bfe_u32 s3, s2, 0x20003
Mvaa 148,36,12
Ta 120,28,16384
Ta 122,28,18432
Mvaa 152,40,12
s_add_u32 s33, s33, s3
s_lshr_b32 s34, s2, 5
s_lshl_b32 s35, s34, 1
Mvaa 156,44,12
Ra 88,21,12288
Mvaa 160,48,12
s_sub_u32 s36, 32, s35
s_add_u32 s35, s35, 2
s_lshl_b32 s44, s32, 12
Mvaa 164,52,12
Ta 124,29,16384
Ta 126,29,18432
Mvaa 168,56,12
s_mov_b32 s58, 33792
s_sub_u32 s3, 15, s34
s_lshl_b32 s45, s3, 2
Mvaa 172,60,12
s_waitcnt lgkmcnt(6)
Ra 92,21,14336
Mvaa 176,32,16
s_add_u32 s45, s45, s32
s_lshl_b32 s46, s34, 2
s_add_u32 s46, s46, s32
Mvaa 180,36,16
s_add_u32 s16, s66, 46137344
s_addc_u32 s17, s67, 0
s_and_b32 s17, s17, 0xffff
Mvaa 184,40,16
s_mov_b32 s18, 16777216
s_mov_b32 s19, 0x20000
s_mov_b32 s68, s42
Mvaa 188,44,16
s_and_b32 s69, s43, 0xffff
s_mov_b32 s70, 7340032
s_mov_b32 s71, 0x20000
Mvaa 192,48,16
s_cmp_eq_u32 s32, 0
s_cselect_b32 s37, 0, 2146435072
Mvaa 196,52,16
Mvaa 200,56,16
Mvaa 204,60,16
Mvaa 208,32,20
Mvaa 212,36,20
Mvaa 216,40,20
Mvaa 220,44,20
Mvaa 224,48,20
Mvaa 228,52,20
Mvaa 232,56,20
Mvaa 236,60,20
Mvaa 240,32,24
Mvaa 244,36,24
Mvaa 248,40,24
Mvaa 252,44,24
Maaa 128,48,24
Maaa 132,52,24
Maaa 136,56,24
Maaa 140,60,24
Maaa 144,32,28
Maaa 148,36,28
Maaa 152,40,28
Maaa 156,44,28
Maaa 160,48,28
Maaa 164,52,28
Maaa 168,56,28
Maaa 172,60,28
s_waitcnt vmcnt(6) lgkmcnt(0)
s_add_u32 m0, s57, 65536
s_barrier
Mvaa 48,96,64
buffer_load_dwordx4 v6, s[12:15], s52 offen offset:0 nt lds
Mvaa 52,100,64
Ta 32,12,0
Ta 34,12,2048
Mvaa 56,104,64
Mvaa 60,108,64
Ra 0,10,0
Mvaa 64,112,64
buffer_load_dwordx4 v7, s[12:15], s53 offen offset:1024 nt lds
Mvaa 68,116,64
s_waitcnt lgkmcnt(6)
Ta 36,13,0
Ta 38,13,2048
Mvaa 72,120,64
Mvaa 76,124,64
Ra 4,10,2048
Mvaa 80,96,68
buffer_load_dwordx4 v6, s[12:15], s54 offen offset:2048 nt lds
Mvaa 84,100,68
Ta 40,14,0
Ta 42,14,2048
Mvaa 88,104,68
Mvaa 92,108,68
Ra 8,10,4096
Mvaa 96,112,68
buffer_load_dwordx4 v7, s[12:15], s55 offen offset:3072 nt lds
Mvaa 100,116,68
s_waitcnt lgkmcnt(6)
Ta 44,15,0
Ta 46,15,2048
Mvaa 104,120,68
Mvaa 108,124,68
s_add_u32 m0, s57, 69632
Ra 12,10,6144
Mvaa 112,96,72
buffer_load_dwordx4 v8, s[12:15], s52 offen offset:0 nt lds
Mvaa 116,100,72
Ta 48,16,0
Ta 50,16,2048
Mvaa 120,104,72
Mvaa 124,108,72
Ra 16,10,8192
Mvaa 128,112,72
buffer_load_dwordx4 v9, s[12:15], s53 offen offset:1024 nt lds
Mvaa 132,116,72
s_waitcnt lgkmcnt(6)
Ta 52,17,0
Ta 54,17,2048
Mvaa 136,120,72
Mvaa 140,124,72
Ra 20,10,10240
Mvaa 144,96,76
buffer_load_dwordx4 v8, s[12:15], s54 offen offset:2048 nt lds
Mvaa 148,100,76
Ta 56,18,0
Ta 58,18,2048
Mvaa 152,104,76
Mvaa 156,108,76
Ra 24,10,12288
Mvaa 160,112,76
buffer_load_dwordx4 v9, s[12:15], s55 offen offset:3072 nt lds
Mvaa 164,116,76
s_waitcnt lgkmcnt(6)
Ta 60,19,0
Ta 62,19,2048
Mvaa 168,120,76
v_add_u32 v6, 524288, v6
v_add_u32 v7, 524288, v7
Mvaa 172,124,76
s_add_u32 m0, s56, 65536
Ra 28,10,14336
v_add_u32 v8, 524288, v8
Mvaa 176,96,80
buffer_load_dwordx4 v2, s[8:11], s48 offen offset:0 lds
Mvaa 180,100,80
v_add_u32 v9, 524288, v9
Mvaa 184,104,80
Mvaa 188,108,80
Mvaa 192,112,80
buffer_load_dwordx4 v3, s[8:11], s49 offen offset:1024 lds
Mvaa 196,116,80
Mvaa 200,120,80
Mvaa 204,124,80
Mvaa 208,96,84
buffer_load_dwordx4 v2, s[8:11], s50 offen offset:2048 lds
Mvaa 212,100,84
Mvaa 216,104,84
Mvaa 220,108,84
Mvaa 224,112,84
buffer_load_dwordx4 v3, s[8:11], s51 offen offset:3072 lds
Mvaa 228,116,84
Mvaa 232,120,84
Mvaa 236,124,84
s_add_u32 m0, s56, 69632
Mvaa 240,96,88
buffer_load_dwordx4 v4, s[8:11], s48 offen offset:0 lds
Mvaa 244,100,88
Mvaa 248,104,88
Mvaa 252,108,88
Maaa 128,112,88
buffer_load_dwordx4 v5, s[8:11], s49 offen offset:1024 lds
Maaa 132,116,88
Maaa 136,120,88
Maaa 140,124,88
Maaa 144,96,92
buffer_load_dwordx4 v4, s[8:11], s50 offen offset:2048 lds
Maaa 148,100,92
Maaa 152,104,92
Maaa 156,108,92
Maaa 160,112,92
buffer_load_dwordx4 v5, s[8:11], s51 offen offset:3072 lds
Maaa 164,116,92
v_add_u32 v2, 128, v2
v_add_u32 v3, 128, v3
Maaa 168,120,92
buffer_load_dword v1, v47, s[60:63], 0 offen
v_add_u32 v4, 128, v4
v_add_u32 v5, 128, v5
Maaa 172,124,92
v_add_u32 v47, s59, v47
s_waitcnt lgkmcnt(0)
Mvaa 48,32,0
Mvaa 52,36,0
Ta 96,12,16384
Ta 98,12,18432
Mvaa 56,40,0
Mvaa 60,44,0
Ra 64,11,0
Mvaa 64,48,0
Mvaa 68,52,0
Ta 100,13,16384
Ta 102,13,18432
Mvaa 72,56,0
Mvaa 76,60,0
s_waitcnt lgkmcnt(6)
Ra 68,11,2048
Mvaa 80,32,4
Mvaa 84,36,4
Ta 104,14,16384
Ta 106,14,18432
Mvaa 88,40,4
Mvaa 92,44,4
Ra 72,11,4096
Mvaa 96,48,4
Mvaa 100,52,4
Ta 108,15,16384
Ta 110,15,18432
Mvaa 104,56,4
Mvaa 108,60,4
s_waitcnt lgkmcnt(6)
Ra 76,11,6144
Mvaa 112,32,8
Mvaa 116,36,8
Ta 112,16,16384
Ta 114,16,18432
Mvaa 120,40,8
Mvaa 124,44,8
Ra 80,11,8192
Mvaa 128,48,8
Mvaa 132,52,8
Ta 116,17,16384
Ta 118,17,18432
Mvaa 136,56,8
Mvaa 140,60,8
s_waitcnt lgkmcnt(6)
Ra 84,11,10240
Mvaa 144,32,12
Mvaa 148,36,12
Ta 120,18,16384
Ta 122,18,18432
Mvaa 152,40,12
Mvaa 156,44,12
Ra 88,11,12288
Mvaa 160,48,12
Mvaa 164,52,12
Ta 124,19,16384
Ta 126,19,18432
Mvaa 168,56,12
Mvaa 172,60,12
s_waitcnt lgkmcnt(6)
Ra 92,11,14336
Mvaa 176,32,16
Mvaa 180,36,16
Mvaa 184,40,16
Mvaa 188,44,16
Mvaa 192,48,16
Mvaa 196,52,16
Mvaa 200,56,16
Mvaa 204,60,16
Mvaa 208,32,20
Mvaa 212,36,20
Mvaa 216,40,20
Mvaa 220,44,20
Mvaa 224,48,20
Mvaa 228,52,20
Mvaa 232,56,20
Mvaa 236,60,20
Mvaa 240,32,24
Mvaa 244,36,24
Mvaa 248,40,24
Mvaa 252,44,24
Maaa 128,48,24
Maaa 132,52,24
Maaa 136,56,24
Maaa 140,60,24
Maaa 144,32,28
Maaa 148,36,28
Maaa 152,40,28
Maaa 156,44,28
Maaa 160,48,28
Maaa 164,52,28
Maaa 168,56,28
Maaa 172,60,28
s_waitcnt vmcnt(1) lgkmcnt(0)
s_add_u32 m0, s57, 0
s_barrier
Mvaa 48,96,64
buffer_load_dwordx4 v6, s[12:15], s52 offen offset:0 nt lds
Mvaa 52,100,64
Ta 32,22,0
Ta 34,22,2048
Mvaa 56,104,64
Mvaa 60,108,64
Ra 0,20,0
Mvaa 64,112,64
buffer_load_dwordx4 v7, s[12:15], s53 offen offset:1024 nt lds
Mvaa 68,116,64
s_waitcnt lgkmcnt(6)
Ta 36,23,0
Ta 38,23,2048
Mvaa 72,120,64
Mvaa 76,124,64
Ra 4,20,2048
Mvaa 80,96,68
buffer_load_dwordx4 v6, s[12:15], s54 offen offset:2048 nt lds
Mvaa 84,100,68
Ta 40,24,0
Ta 42,24,2048
Mvaa 88,104,68
Mvaa 92,108,68
Ra 8,20,4096
Mvaa 96,112,68
buffer_load_dwordx4 v7, s[12:15], s55 offen offset:3072 nt lds
Mvaa 100,116,68
s_waitcnt lgkmcnt(6)
Ta 44,25,0
Ta 46,25,2048
Mvaa 104,120,68
Mvaa 108,124,68
s_add_u32 m0, s57, 4096
Ra 12,20,6144
Mvaa 112,96,72
buffer_load_dwordx4 v8, s[12:15], s52 offen offset:0 nt lds
Mvaa 116,100,72
Ta 48,26,0
Ta 50,26,2048
Mvaa 120,104,72
Mvaa 124,108,72
Ra 16,20,8192
Mvaa 128,112,72
buffer_load_dwordx4 v9, s[12:15], s53 offen offset:1024 nt lds
Mvaa 132,116,72
s_waitcnt lgkmcnt(6)
Ta 52,27,0
Ta 54,27,2048
Mvaa 136,120,72
Mvaa 140,124,72
Ra 20,20,10240
Mvaa 144,96,76
buffer_load_dwordx4 v8, s[12:15], s54 offen offset:2048 nt lds
Mvaa 148,100,76
Ta 56,28,0
Ta 58,28,2048
Mvaa 152,104,76
Mvaa 156,108,76
Ra 24,20,12288
Mvaa 160,112,76
buffer_load_dwordx4 v9, s[12:15], s55 offen offset:3072 nt lds
Mvaa 164,116,76
s_waitcnt lgkmcnt(6)
Ta 60,29,0
Ta 62,29,2048
Mvaa 168,120,76
v_add_u32 v6, 524288, v6
v_add_u32 v7, 524288, v7
Mvaa 172,124,76
s_add_u32 m0, s56, 0
Ra 28,20,14336
v_add_u32 v8, 524288, v8
Mvaa 176,96,80
buffer_load_dwordx4 v2, s[8:11], s48 offen offset:0 lds
Mvaa 180,100,80
v_add_u32 v9, 524288, v9
Mvaa 184,104,80
Mvaa 188,108,80
Mvaa 192,112,80
buffer_load_dwordx4 v3, s[8:11], s49 offen offset:1024 lds
Mvaa 196,116,80
Mvaa 200,120,80
Mvaa 204,124,80
Mvaa 208,96,84
buffer_load_dwordx4 v2, s[8:11], s50 offen offset:2048 lds
Mvaa 212,100,84
Mvaa 216,104,84
Mvaa 220,108,84
Mvaa 224,112,84
buffer_load_dwordx4 v3, s[8:11], s51 offen offset:3072 lds
Mvaa 228,116,84
Mvaa 232,120,84
Mvaa 236,124,84
s_add_u32 m0, s56, 4096
Mvaa 240,96,88
buffer_load_dwordx4 v4, s[8:11], s48 offen offset:0 lds
Mvaa 244,100,88
Mvaa 248,104,88
Mvaa 252,108,88
Maaa 128,112,88
buffer_load_dwordx4 v5, s[8:11], s49 offen offset:1024 lds
Maaa 132,116,88
Maaa 136,120,88
Maaa 140,124,88
Maaa 144,96,92
buffer_load_dwordx4 v4, s[8:11], s50 offen offset:2048 lds
Maaa 148,100,92
Maaa 152,104,92
Maaa 156,108,92
Maaa 160,112,92
buffer_load_dwordx4 v5, s[8:11], s51 offen offset:3072 lds
Maaa 164,116,92
v_add_u32 v2, 128, v2
v_add_u32 v3, 128, v3
Maaa 168,120,92
buffer_load_dword v1, v47, s[60:63], 0 offen
v_add_u32 v4, 128, v4
v_add_u32 v5, 128, v5
Maaa 172,124,92
v_add_u32 v47, s59, v47
s_waitcnt lgkmcnt(0)
Mvaa 48,32,0
s_mov_b64 exec, 1
buffer_atomic_add v30, v31, s[28:31], s37 offen sc1
s_mov_b64 exec, -1
Mvaa 52,36,0
Ta 96,22,16384
Ta 98,22,18432
Mvaa 56,40,0
Mvaa 60,44,0
Ra 64,21,0
Mvaa 64,48,0
Mvaa 68,52,0
Ta 100,23,16384
Ta 102,23,18432
Mvaa 72,56,0
Mvaa 76,60,0
s_waitcnt lgkmcnt(6)
Ra 68,21,2048
Mvaa 80,32,4
Mvaa 84,36,4
Ta 104,24,16384
Ta 106,24,18432
Mvaa 88,40,4
Mvaa 92,44,4
Ra 72,21,4096
Mvaa 96,48,4
Mvaa 100,52,4
Ta 108,25,16384
Ta 110,25,18432
Mvaa 104,56,4
Mvaa 108,60,4
s_waitcnt lgkmcnt(6)
Ra 76,21,6144
Mvaa 112,32,8
Mvaa 116,36,8
Ta 112,26,16384
Ta 114,26,18432
Mvaa 120,40,8
Mvaa 124,44,8
Ra 80,21,8192
Mvaa 128,48,8
Mvaa 132,52,8
Ta 116,27,16384
Ta 118,27,18432
Mvaa 136,56,8
Mvaa 140,60,8
s_waitcnt lgkmcnt(6)
Ra 84,21,10240
Mvaa 144,32,12
Mvaa 148,36,12
Ta 120,28,16384
Ta 122,28,18432
Mvaa 152,40,12
Mvaa 156,44,12
Ra 88,21,12288
Mvaa 160,48,12
Mvaa 164,52,12
Ta 124,29,16384
Ta 126,29,18432
Mvaa 168,56,12
Mvaa 172,60,12
s_waitcnt lgkmcnt(6)
Ra 92,21,14336
Mvaa 176,32,16
Mvaa 180,36,16
Mvaa 184,40,16
Mvaa 188,44,16
Mvaa 192,48,16
Mvaa 196,52,16
Mvaa 200,56,16
Mvaa 204,60,16
Mvaa 208,32,20
Mvaa 212,36,20
Mvaa 216,40,20
Mvaa 220,44,20
Mvaa 224,48,20
Mvaa 228,52,20
Mvaa 232,56,20
Mvaa 236,60,20
Mvaa 240,32,24
Mvaa 244,36,24
Mvaa 248,40,24
Mvaa 252,44,24
Maaa 128,48,24
Maaa 132,52,24
Maaa 136,56,24
Maaa 140,60,24
Maaa 144,32,28
Maaa 148,36,28
Maaa 152,40,28
Maaa 156,44,28
Maaa 160,48,28
Maaa 164,52,28
Maaa 168,56,28
Maaa 172,60,28
s_waitcnt vmcnt(2) lgkmcnt(0)
s_add_u32 m0, s57, 65536
s_barrier
Mvaa 48,96,64
buffer_load_dwordx4 v6, s[12:15], s52 offen offset:0 nt lds
Mvaa 52,100,64
Ta 32,12,0
Ta 34,12,2048
Mvaa 56,104,64
Mvaa 60,108,64
Ra 0,10,0
Mvaa 64,112,64
buffer_load_dwordx4 v7, s[12:15], s53 offen offset:1024 nt lds
Mvaa 68,116,64
s_waitcnt lgkmcnt(6)
Ta 36,13,0
Ta 38,13,2048
Mvaa 72,120,64
Mvaa 76,124,64
Ra 4,10,2048
Mvaa 80,96,68
buffer_load_dwordx4 v6, s[12:15], s54 offen offset:2048 nt lds
Mvaa 84,100,68
Ta 40,14,0
Ta 42,14,2048
Mvaa 88,104,68
Mvaa 92,108,68
Ra 8,10,4096
Mvaa 96,112,68
buffer_load_dwordx4 v7, s[12:15], s55 offen offset:3072 nt lds
Mvaa 100,116,68
s_waitcnt lgkmcnt(6)
Ta 44,15,0
Ta 46,15,2048
Mvaa 104,120,68
Mvaa 108,124,68
s_add_u32 m0, s57, 69632
Ra 12,10,6144
Mvaa 112,96,72
buffer_load_dwordx4 v8, s[12:15], s52 offen offset:0 nt lds
Mvaa 116,100,72
Ta 48,16,0
Ta 50,16,2048
Mvaa 120,104,72
Mvaa 124,108,72
Ra 16,10,8192
Mvaa 128,112,72
buffer_load_dwordx4 v9, s[12:15], s53 offen offset:1024 nt lds
Mvaa 132,116,72
s_waitcnt lgkmcnt(6)
Ta 52,17,0
Ta 54,17,2048
Mvaa 136,120,72
Mvaa 140,124,72
Ra 20,10,10240
Mvaa 144,96,76
buffer_load_dwordx4 v8, s[12:15], s54 offen offset:2048 nt lds
Mvaa 148,100,76
Ta 56,18,0
Ta 58,18,2048
Mvaa 152,104,76
Mvaa 156,108,76
Ra 24,10,12288
Mvaa 160,112,76
buffer_load_dwordx4 v9, s[12:15], s55 offen offset:3072 nt lds
Mvaa 164,116,76
s_waitcnt lgkmcnt(6)
Ta 60,19,0
Ta 62,19,2048
Mvaa 168,120,76
v_add_u32 v6, 524288, v6
v_add_u32 v7, 524288, v7
Mvaa 172,124,76
s_add_u32 m0, s56, 65536
Ra 28,10,14336
v_add_u32 v8, 524288, v8
Mvaa 176,96,80
buffer_load_dwordx4 v2, s[8:11], s48 offen offset:0 lds
Mvaa 180,100,80
v_add_u32 v9, 524288, v9
Mvaa 184,104,80
Mvaa 188,108,80
Mvaa 192,112,80
buffer_load_dwordx4 v3, s[8:11], s49 offen offset:1024 lds
Mvaa 196,116,80
Mvaa 200,120,80
Mvaa 204,124,80
Mvaa 208,96,84
buffer_load_dwordx4 v2, s[8:11], s50 offen offset:2048 lds
Mvaa 212,100,84
Mvaa 216,104,84
Mvaa 220,108,84
Mvaa 224,112,84
buffer_load_dwordx4 v3, s[8:11], s51 offen offset:3072 lds
Mvaa 228,116,84
Mvaa 232,120,84
Mvaa 236,124,84
s_add_u32 m0, s56, 69632
Mvaa 240,96,88
buffer_load_dwordx4 v4, s[8:11], s48 offen offset:0 lds
Mvaa 244,100,88
Mvaa 248,104,88
Mvaa 252,108,88
Maaa 128,112,88
buffer_load_dwordx4 v5, s[8:11], s49 offen offset:1024 lds
Maaa 132,116,88
Maaa 136,120,88
Maaa 140,124,88
Maaa 144,96,92
buffer_load_dwordx4 v4, s[8:11], s50 offen offset:2048 lds
Maaa 148,100,92
Maaa 152,104,92
Maaa 156,108,92
Maaa 160,112,92
buffer_load_dwordx4 v5, s[8:11], s51 offen offset:3072 lds
Maaa 164,116,92
v_add_u32 v2, 128, v2
v_add_u32 v3, 128, v3
Maaa 168,120,92
buffer_load_dword v1, v47, s[60:63], 0 offen
v_add_u32 v4, 128, v4
v_add_u32 v5, 128, v5
Maaa 172,124,92
v_add_u32 v47, s59, v47
s_waitcnt lgkmcnt(0)
Mvaa 48,32,0
s_lshl_b32 s3, s33, 8
s_add_u32 s60, s4, s3
s_addc_u32 s61, s5, 0
s_and_b32 s61, s61, 0xffff
Mvaa 52,36,0
Ta 96,12,16384
Ta 98,12,18432
Mvaa 56,40,0
s_mov_b32 s62, 0
s_mov_b32 s63, 0x20000
s_sub_u32 s62, 8388608, s3
Mvaa 60,44,0
Ra 64,11,0
Mvaa 64,48,0
v_lshrrev_b32 v32, 1, v0
v_and_b32 v33, 1, v0
Mvaa 68,52,0
Ta 100,13,16384
Ta 102,13,18432
Mvaa 72,56,0
v_lshlrev_b32 v32, 13, v32
v_lshl_add_u32 v32, v33, 7, v32
Mvaa 76,60,0
s_waitcnt lgkmcnt(6)
Ra 68,11,2048
Mvaa 80,32,4
s_lshl_b32 s3, s32, 3
s_add_u32 s3, s3, s34
s_lshl_b32 s3, s3, 18
Mvaa 84,36,4
Ta 104,14,16384
Ta 106,14,18432
Mvaa 88,40,4
s_mov_b32 s59, 8388608
v_add_u32 v47, s3, v32
v_lshrrev_b32 v32, 4, v0
Mvaa 92,44,4
Ra 72,11,4096
Mvaa 96,48,4
v_and_b32 v33, 15, v0
Mvaa 100,52,4
Ta 108,15,16384
Ta 110,15,18432
Mvaa 104,56,4
s_lshl_b32 s3, s32, 4
v_add_u32 v34, s3, v32
v_lshlrev_b32 v36, 1, v32
Mvaa 108,60,4
s_waitcnt lgkmcnt(6)
Ra 76,11,6144
Mvaa 112,32,8
v_xor_b32 v36, v36, v33
v_xor_b32 v37, 8, v36
Mvaa 116,36,8
Ta 112,16,16384
Ta 114,16,18432
Mvaa 120,40,8
Mvaa 124,44,8
Ra 80,11,8192
Mvaa 128,48,8
Mvaa 132,52,8
Ta 116,17,16384
Ta 118,17,18432
Mvaa 136,56,8
Mvaa 140,60,8
s_waitcnt lgkmcnt(6)
Ra 84,11,10240
Mvaa 144,32,12
Mvaa 148,36,12
Ta 120,18,16384
Ta 122,18,18432
Mvaa 152,40,12
Mvaa 156,44,12
Ra 88,11,12288
Mvaa 160,48,12
Mvaa 164,52,12
Ta 124,19,16384
Ta 126,19,18432
Mvaa 168,56,12
Mvaa 172,60,12
s_waitcnt lgkmcnt(6)
Ra 92,11,14336
Mvaa 176,32,16
Mvaa 180,36,16
Mvaa 184,40,16
Mvaa 188,44,16
Mvaa 192,48,16
Mvaa 196,52,16
Mvaa 200,56,16
Mvaa 204,60,16
Mvaa 208,32,20
Mvaa 212,36,20
Mvaa 216,40,20
Mvaa 220,44,20
Mvaa 224,48,20
Mvaa 228,52,20
Mvaa 232,56,20
Mvaa 236,60,20
Mvaa 240,32,24
Mvaa 244,36,24
Mvaa 248,40,24
Mvaa 252,44,24
Maaa 128,48,24
Maaa 132,52,24
Maaa 136,56,24
Maaa 140,60,24
Maaa 144,32,28
Maaa 148,36,28
Maaa 152,40,28
Maaa 156,44,28
Maaa 160,48,28
Maaa 164,52,28
Maaa 168,56,28
Maaa 172,60,28
s_waitcnt vmcnt(1) lgkmcnt(0)
s_add_u32 m0, s57, 0
s_barrier
Mvaa 48,96,64
buffer_load_dwordx4 v6, s[12:15], s52 offen offset:0 nt lds
Mvaa 52,100,64
Ta 32,22,0
Ta 34,22,2048
Mvaa 56,104,64
Mvaa 60,108,64
Ra 0,20,0
Mvaa 64,112,64
buffer_load_dwordx4 v7, s[12:15], s53 offen offset:1024 nt lds
Mvaa 68,116,64
s_waitcnt lgkmcnt(6)
Ta 36,23,0
Ta 38,23,2048
Mvaa 72,120,64
Mvaa 76,124,64
Ra 4,20,2048
Mvaa 80,96,68
buffer_load_dwordx4 v6, s[12:15], s54 offen offset:2048 nt lds
Mvaa 84,100,68
Ta 40,24,0
Ta 42,24,2048
Mvaa 88,104,68
Mvaa 92,108,68
Ra 8,20,4096
Mvaa 96,112,68
buffer_load_dwordx4 v7, s[12:15], s55 offen offset:3072 nt lds
Mvaa 100,116,68
s_waitcnt lgkmcnt(6)
Ta 44,25,0
Ta 46,25,2048
Mvaa 104,120,68
Mvaa 108,124,68
s_add_u32 m0, s57, 4096
Ra 12,20,6144
Mvaa 112,96,72
buffer_load_dwordx4 v8, s[12:15], s52 offen offset:0 nt lds
Mvaa 116,100,72
Ta 48,26,0
Ta 50,26,2048
Mvaa 120,104,72
Mvaa 124,108,72
Ra 16,20,8192
Mvaa 128,112,72
buffer_load_dwordx4 v9, s[12:15], s53 offen offset:1024 nt lds
Mvaa 132,116,72
s_waitcnt lgkmcnt(6)
Ta 52,27,0
Ta 54,27,2048
Mvaa 136,120,72
Mvaa 140,124,72
Ra 20,20,10240
Mvaa 144,96,76
buffer_load_dwordx4 v8, s[12:15], s54 offen offset:2048 nt lds
Mvaa 148,100,76
Ta 56,28,0
Ta 58,28,2048
Mvaa 152,104,76
Mvaa 156,108,76
Ra 24,20,12288
Mvaa 160,112,76
buffer_load_dwordx4 v9, s[12:15], s55 offen offset:3072 nt lds
Mvaa 164,116,76
s_waitcnt lgkmcnt(6)
Ta 60,29,0
Ta 62,29,2048
Mvaa 168,120,76
v_add_u32 v6, 524288, v6
v_add_u32 v7, 524288, v7
Mvaa 172,124,76
s_add_u32 m0, s56, 0
Ra 28,20,14336
v_add_u32 v8, 524288, v8
Mvaa 176,96,80
buffer_load_dwordx4 v2, s[8:11], s48 offen offset:0 lds
Mvaa 180,100,80
v_add_u32 v9, 524288, v9
Mvaa 184,104,80
Mvaa 188,108,80
Mvaa 192,112,80
buffer_load_dwordx4 v3, s[8:11], s49 offen offset:1024 lds
Mvaa 196,116,80
Mvaa 200,120,80
Mvaa 204,124,80
Mvaa 208,96,84
buffer_load_dwordx4 v2, s[8:11], s50 offen offset:2048 lds
Mvaa 212,100,84
Mvaa 216,104,84
Mvaa 220,108,84
Mvaa 224,112,84
buffer_load_dwordx4 v3, s[8:11], s51 offen offset:3072 lds
Mvaa 228,116,84
Mvaa 232,120,84
Mvaa 236,124,84
s_add_u32 m0, s56, 4096
Mvaa 240,96,88
buffer_load_dwordx4 v4, s[8:11], s48 offen offset:0 lds
Mvaa 244,100,88
Mvaa 248,104,88
Mvaa 252,108,88
Maaa 128,112,88
buffer_load_dwordx4 v5, s[8:11], s49 offen offset:1024 lds
Maaa 132,116,88
Maaa 136,120,88
Maaa 140,124,88
Maaa 144,96,92
buffer_load_dwordx4 v4, s[8:11], s50 offen offset:2048 lds
Maaa 148,100,92
Maaa 152,104,92
Maaa 156,108,92
Maaa 160,112,92
buffer_load_dwordx4 v5, s[8:11], s51 offen offset:3072 lds
Maaa 164,116,92
v_add_u32 v2, 128, v2
v_add_u32 v3, 128, v3
Maaa 168,120,92
buffer_load_dword v1, v47, s[60:63], 0 offen
v_add_u32 v4, 128, v4
v_add_u32 v5, 128, v5
Maaa 172,124,92
v_add_u32 v47, s59, v47
s_waitcnt lgkmcnt(0)
Mvaa 48,32,0
s_getpc_b64 s[6:7]
L_cpf2:
s_add_u32 s6, s6, (L_phase2-L_cpf2)&0xffffffff
s_addc_u32 s7, s7, ((L_phase2-L_cpf2)>>32)&0xffffffff
Mvaa 52,36,0
Ta 96,22,16384
Ta 98,22,18432
Mvaa 56,40,0
s_lshr_b32 s3, s2, 3
s_lshl_b32 s3, s3, 2
s_add_u32 s3, s3, s32
Mvaa 60,44,0
Ra 64,21,0
Mvaa 64,48,0
s_lshl_b32 s3, s3, 10
v_and_b32 v42, 7, v0
v_lshlrev_b32 v42, 7, v42
Mvaa 68,52,0
Ta 100,23,16384
Ta 102,23,18432
Mvaa 72,56,0
v_add_u32 v42, s3, v42
v_min_u32 v42, L_k2_end-L_phase2-4, v42
Mvaa 76,60,0
s_waitcnt lgkmcnt(6)
Ra 68,21,2048
Mvaa 80,32,4
v_mov_b32 v41, s7
Mvaa 84,36,4
Ta 104,24,16384
Ta 106,24,18432
Mvaa 88,40,4
v_add_co_u32 v40, vcc, s6, v42
s_nop 1
v_addc_co_u32 v41, vcc, 0, v41, vcc
Mvaa 92,44,4
Ra 72,21,4096
Mvaa 96,48,4
global_load_dword v44, v[40:41], off
Mvaa 100,52,4
Ta 108,25,16384
Ta 110,25,18432
Mvaa 104,56,4
Mvaa 108,60,4
s_waitcnt lgkmcnt(6)
Ra 76,21,6144
Mvaa 112,32,8
Mvaa 116,36,8
Ta 112,26,16384
Ta 114,26,18432
Mvaa 120,40,8
Mvaa 124,44,8
Ra 80,21,8192
Mvaa 128,48,8
Mvaa 132,52,8
Ta 116,27,16384
Ta 118,27,18432
Mvaa 136,56,8
Mvaa 140,60,8
s_waitcnt lgkmcnt(6)
Ra 84,21,10240
Mvaa 144,32,12
Mvaa 148,36,12
Ta 120,28,16384
Ta 122,28,18432
Mvaa 152,40,12
Mvaa 156,44,12
Ra 88,21,12288
Mvaa 160,48,12
Mvaa 164,52,12
Ta 124,29,16384
Ta 126,29,18432
Mvaa 168,56,12
Mvaa 172,60,12
s_waitcnt lgkmcnt(6)
Ra 92,21,14336
Mvaa 176,32,16
Mvaa 180,36,16
Mvaa 184,40,16
Mvaa 188,44,16
Mvaa 192,48,16
Mvaa 196,52,16
Mvaa 200,56,16
Mvaa 204,60,16
Mvaa 208,32,20
Mvaa 212,36,20
Mvaa 216,40,20
Mvaa 220,44,20
Mvaa 224,48,20
Mvaa 228,52,20
Mvaa 232,56,20
Mvaa 236,60,20
Mvaa 240,32,24
Mvaa 244,36,24
Mvaa 248,40,24
Mvaa 252,44,24
Maaa 128,48,24
Maaa 132,52,24
Maaa 136,56,24
Maaa 140,60,24
Maaa 144,32,28
Maaa 148,36,28
Maaa 152,40,28
Maaa 156,44,28
Maaa 160,48,28
Maaa 164,52,28
Maaa 168,56,28
Maaa 172,60,28
s_waitcnt vmcnt(2) lgkmcnt(0)
s_add_u32 m0, s57, 65536
s_barrier
Mvaa 48,96,64
buffer_load_dwordx4 v6, s[12:15], s52 offen offset:0 nt lds
Mvaa 52,100,64
Ta 32,12,0
Ta 34,12,2048
Mvaa 56,104,64
Mvaa 60,108,64
Ra 0,10,0
Mvaa 64,112,64
buffer_load_dwordx4 v7, s[12:15], s53 offen offset:1024 nt lds
Mvaa 68,116,64
s_waitcnt lgkmcnt(6)
Ta 36,13,0
Ta 38,13,2048
Mvaa 72,120,64
Mvaa 76,124,64
Ra 4,10,2048
Mvaa 80,96,68
buffer_load_dwordx4 v6, s[12:15], s54 offen offset:2048 nt lds
Mvaa 84,100,68
Ta 40,14,0
Ta 42,14,2048
Mvaa 88,104,68
Mvaa 92,108,68
Ra 8,10,4096
Mvaa 96,112,68
buffer_load_dwordx4 v7, s[12:15], s55 offen offset:3072 nt lds
Mvaa 100,116,68
s_waitcnt lgkmcnt(6)
Ta 44,15,0
Ta 46,15,2048
Mvaa 104,120,68
Mvaa 108,124,68
s_add_u32 m0, s57, 69632
Ra 12,10,6144
Mvaa 112,96,72
buffer_load_dwordx4 v8, s[12:15], s52 offen offset:0 nt lds
Mvaa 116,100,72
Ta 48,16,0
Ta 50,16,2048
Mvaa 120,104,72
Mvaa 124,108,72
Ra 16,10,8192
Mvaa 128,112,72
buffer_load_dwordx4 v9, s[12:15], s53 offen offset:1024 nt lds
Mvaa 132,116,72
s_waitcnt lgkmcnt(6)
Ta 52,17,0
Ta 54,17,2048
Mvaa 136,120,72
Mvaa 140,124,72
Ra 20,10,10240
Mvaa 144,96,76
buffer_load_dwordx4 v8, s[12:15], s54 offen offset:2048 nt lds
Mvaa 148,100,76
Ta 56,18,0
Ta 58,18,2048
Mvaa 152,104,76
Mvaa 156,108,76
Ra 24,10,12288
Mvaa 160,112,76
buffer_load_dwordx4 v9, s[12:15], s55 offen offset:3072 nt lds
Mvaa 164,116,76
s_waitcnt lgkmcnt(6)
Ta 60,19,0
Ta 62,19,2048
Mvaa 168,120,76
v_add_u32 v6, 524288, v6
v_add_u32 v7, 524288, v7
Mvaa 172,124,76
s_add_u32 m0, s56, 65536
Ra 28,10,14336
v_add_u32 v8, 524288, v8
Mvaa 176,96,80
buffer_load_dwordx4 v2, s[8:11], s48 offen offset:0 lds
Mvaa 180,100,80
v_add_u32 v9, 524288, v9
Mvaa 184,104,80
Mvaa 188,108,80
Mvaa 192,112,80
buffer_load_dwordx4 v3, s[8:11], s49 offen offset:1024 lds
Mvaa 196,116,80
Mvaa 200,120,80
Mvaa 204,124,80
Mvaa 208,96,84
buffer_load_dwordx4 v2, s[8:11], s50 offen offset:2048 lds
Mvaa 212,100,84
Mvaa 216,104,84
Mvaa 220,108,84
Mvaa 224,112,84
buffer_load_dwordx4 v3, s[8:11], s51 offen offset:3072 lds
Mvaa 228,116,84
Mvaa 232,120,84
Mvaa 236,124,84
s_add_u32 m0, s56, 69632
Mvaa 240,96,88
buffer_load_dwordx4 v4, s[8:11], s48 offen offset:0 lds
Mvaa 244,100,88
Mvaa 248,104,88
Mvaa 252,108,88
Maaa 128,112,88
buffer_load_dwordx4 v5, s[8:11], s49 offen offset:1024 lds
Maaa 132,116,88
Maaa 136,120,88
Maaa 140,124,88
Maaa 144,96,92
buffer_load_dwordx4 v4, s[8:11], s50 offen offset:2048 lds
Maaa 148,100,92
Maaa 152,104,92
Maaa 156,108,92
Maaa 160,112,92
buffer_load_dwordx4 v5, s[8:11], s51 offen offset:3072 lds
Maaa 164,116,92
v_add_u32 v2, 128, v2
v_add_u32 v3, 128, v3
Maaa 168,120,92
v_add_u32 v4, 128, v4
v_add_u32 v5, 128, v5
Maaa 172,124,92
s_waitcnt lgkmcnt(0)
Mvaa 48,32,0
buffer_load_dword v30, v31, s[28:31], s37 offen sc1
Mvaa 52,36,0
Ta 96,12,16384
Ta 98,12,18432
Mvaa 56,40,0
s_mov_b32 s8, s60
s_mov_b32 s9, s61
s_mov_b32 s10, s62
Mvaa 60,44,0
Ra 64,11,0
Mvaa 64,48,0
s_mov_b32 s48, 0
s_mov_b32 s49, 31744
s_mov_b32 s50, 63488
Mvaa 68,52,0
Ta 100,13,16384
Ta 102,13,18432
Mvaa 72,56,0
s_mov_b32 s51, 95232
v_lshlrev_b32 v35, 13, v34
v_lshl_add_u32 v8, v36, 4, v35
Mvaa 76,60,0
s_waitcnt lgkmcnt(6)
Ra 68,11,2048
Mvaa 80,32,4
v_lshl_add_u32 v9, v37, 4, v35
v_lshlrev_b32 v2, 4, v0
Mvaa 84,36,4
Ta 104,14,16384
Ta 106,14,18432
Mvaa 88,40,4
v_add_u32 v3, 65536, v2
v_add_u32 v4, s44, v2
Mvaa 92,44,4
Ra 72,11,4096
Mvaa 96,48,4
v_mov_b32 v7, 0
v_lshlrev_b32 v35, 2, v32
Mvaa 100,52,4
Ta 108,15,16384
Ta 110,15,18432
Mvaa 104,56,4
v_sub_u32 v35, v33, v35
Mvaa 108,60,4
s_waitcnt lgkmcnt(6)
Ra 76,11,6144
Mvaa 112,32,8
s_lshl_b32 s3, s45, 5
v_add_u32 v5, s3, v35
Mvaa 116,36,8
Ta 112,16,16384
Ta 114,16,18432
Mvaa 120,40,8
s_lshl_b32 s3, s46, 5
v_add_u32 v6, s3, v35
Mvaa 124,44,8
Ra 80,11,8192
Mvaa 128,48,8
s_mul_i32 s3, s33, 1116160
s_add_u32 s3, s3, 8388608
s_add_u32 s12, s66, s3
s_addc_u32 s13, s67, 0
s_and_b32 s13, s13, 0xffff
Mvaa 132,52,8
Ta 116,17,16384
Ta 118,17,18432
Mvaa 136,56,8
s_mov_b32 s14, 0
s_mov_b32 s15, 0x20000
s_mul_i32 s14, s36, 34816
Mvaa 140,60,8
s_waitcnt lgkmcnt(6)
Ra 84,11,10240
Mvaa 144,32,12
Mvaa 148,36,12
Ta 120,18,16384
Ta 122,18,18432
Mvaa 152,40,12
Mvaa 156,44,12
Ra 88,11,12288
Mvaa 160,48,12
Mvaa 164,52,12
Ta 124,19,16384
Ta 126,19,18432
Mvaa 168,56,12
Mvaa 172,60,12
s_waitcnt lgkmcnt(6)
Ra 92,11,14336
Mvaa 176,32,16
Mvaa 180,36,16
Mvaa 184,40,16
Mvaa 188,44,16
Mvaa 192,48,16
Mvaa 196,52,16
Mvaa 200,56,16
Mvaa 204,60,16
Mvaa 208,32,20
Mvaa 212,36,20
Mvaa 216,40,20
Mvaa 220,44,20
Mvaa 224,48,20
Mvaa 228,52,20
Mvaa 232,56,20
Mvaa 236,60,20
Mvaa 240,32,24
Mvaa 244,36,24
Mvaa 248,40,24
Mvaa 252,44,24
Maaa 128,48,24
Maaa 132,52,24
Maaa 136,56,24
Maaa 140,60,24
Maaa 144,32,28
Maaa 148,36,28
Maaa 152,40,28
Maaa 156,44,28
Maaa 160,48,28
Maaa 164,52,28
Maaa 168,56,28
Maaa 172,60,28
s_waitcnt vmcnt(1) lgkmcnt(0)
s_add_u32 m0, s44, 0
s_barrier
Mvaa 48,96,64
buffer_load_dwordx4 v8, s[8:11], s48 offen offset:0 lds
Mvaa 52,100,64
Ta 32,22,0
Ta 34,22,2048
Mvaa 56,104,64
s_mul_i32 s3, s45, 67584
v_add_u32 v10, s3, v2
Mvaa 60,108,64
Ra 0,20,0
Mvaa 64,112,64
buffer_load_dwordx4 v8, s[8:11], s49 offen offset:1024 lds
Mvaa 68,116,64
s_waitcnt lgkmcnt(6)
Ta 36,23,0
Ta 38,23,2048
Mvaa 72,120,64
s_mul_i32 s3, s46, 67584
v_add_u32 v11, s3, v2
Mvaa 76,124,64
Ra 4,20,2048
Mvaa 80,96,68
buffer_load_dwordx4 v9, s[8:11], s50 offen offset:2048 lds
Mvaa 84,100,68
Ta 40,24,0
Ta 42,24,2048
Mvaa 88,104,68
Mvaa 92,108,68
Ra 8,20,4096
Mvaa 96,112,68
buffer_load_dwordx4 v9, s[8:11], s51 offen offset:3072 lds
Mvaa 100,116,68
s_waitcnt lgkmcnt(6)
Ta 44,25,0
Ta 46,25,2048
Mvaa 104,120,68
v_add_u32 v8, 524288, v8
v_add_u32 v9, 524288, v9
Mvaa 108,124,68
s_add_u32 m0, s44, 16384
Ra 12,20,6144
Mvaa 112,96,72
buffer_load_dwordx4 v8, s[8:11], s48 offen offset:0 lds
Mvaa 116,100,72
Ta 48,26,0
Ta 50,26,2048
Mvaa 120,104,72
Mvaa 124,108,72
Ra 16,20,8192
Mvaa 128,112,72
buffer_load_dwordx4 v8, s[8:11], s49 offen offset:1024 lds
Mvaa 132,116,72
s_waitcnt lgkmcnt(6)
Ta 52,27,0
Ta 54,27,2048
Mvaa 136,120,72
Mvaa 140,124,72
Ra 20,20,10240
Mvaa 144,96,76
buffer_load_dwordx4 v9, s[8:11], s50 offen offset:2048 lds
Mvaa 148,100,76
Ta 56,28,0
Ta 58,28,2048
Mvaa 152,104,76
Mvaa 156,108,76
Ra 24,20,12288
Mvaa 160,112,76
buffer_load_dwordx4 v9, s[8:11], s51 offen offset:3072 lds
Mvaa 164,116,76
s_waitcnt lgkmcnt(6)
Ta 60,29,0
Ta 62,29,2048
Mvaa 168,120,76
v_add_u32 v8, 524288, v8
v_add_u32 v9, 524288, v9
Mvaa 172,124,76
s_add_u32 m0, s44, 32768
Ra 28,20,14336
Mvaa 176,96,80
buffer_load_dwordx4 v8, s[8:11], s48 offen offset:0 lds
Mvaa 180,100,80
Mvaa 184,104,80
Mvaa 188,108,80
Mvaa 192,112,80
buffer_load_dwordx4 v8, s[8:11], s49 offen offset:1024 lds
Mvaa 196,116,80
Mvaa 200,120,80
Mvaa 204,124,80
Mvaa 208,96,84
buffer_load_dwordx4 v9, s[8:11], s50 offen offset:2048 lds
Mvaa 212,100,84
Mvaa 216,104,84
Mvaa 220,108,84
Mvaa 224,112,84
buffer_load_dwordx4 v9, s[8:11], s51 offen offset:3072 lds
Mvaa 228,116,84
v_add_u32 v8, 524288, v8
v_add_u32 v9, 524288, v9
Mvaa 232,120,84
Mvaa 236,124,84
s_add_u32 m0, s44, 49152
Mvaa 240,96,88
buffer_load_dwordx4 v8, s[8:11], s48 offen offset:0 lds
Mvaa 244,100,88
Mvaa 248,104,88
Mvaa 252,108,88
Maaa 128,112,88
buffer_load_dwordx4 v8, s[8:11], s49 offen offset:1024 lds
Maaa 132,116,88
Maaa 136,120,88
Maaa 140,124,88
Maaa 144,96,92
buffer_load_dwordx4 v9, s[8:11], s50 offen offset:2048 lds
Maaa 148,100,92
Maaa 152,104,92
Maaa 156,108,92
Maaa 160,112,92
buffer_load_dwordx4 v9, s[8:11], s51 offen offset:3072 lds
Maaa 164,116,92
v_add_u32 v8, 524288, v8
v_add_u32 v9, 524288, v9
Maaa 168,120,92
Maaa 172,124,92
s_waitcnt lgkmcnt(0)
Mvaa 48,32,0
Mvaa 52,36,0
Ta 96,22,16384
Ta 98,22,18432
Mvaa 56,40,0
Mvaa 60,44,0
Ra 64,21,0
Mvaa 64,48,0
Mvaa 68,52,0
Ta 100,23,16384
Ta 102,23,18432
Mvaa 72,56,0
Mvaa 76,60,0
s_waitcnt lgkmcnt(6)
Ra 68,21,2048
Mvaa 80,32,4
Mvaa 84,36,4
Ta 104,24,16384
Ta 106,24,18432
Mvaa 88,40,4
Mvaa 92,44,4
Ra 72,21,4096
Mvaa 96,48,4
Mvaa 100,52,4
Ta 108,25,16384
Ta 110,25,18432
Mvaa 104,56,4
Mvaa 108,60,4
s_waitcnt lgkmcnt(6)
Ra 76,21,6144
Mvaa 112,32,8
Mvaa 116,36,8
Ta 112,26,16384
Ta 114,26,18432
Mvaa 120,40,8
Mvaa 124,44,8
Ra 80,21,8192
Mvaa 128,48,8
Mvaa 132,52,8
Ta 116,27,16384
Ta 118,27,18432
Mvaa 136,56,8
Mvaa 140,60,8
s_waitcnt lgkmcnt(6)
Ra 84,21,10240
Mvaa 144,32,12
Mvaa 148,36,12
Ta 120,28,16384
Ta 122,28,18432
Mvaa 152,40,12
Mvaa 156,44,12
Ra 88,21,12288
Mvaa 160,48,12
Mvaa 164,52,12
Ta 124,29,16384
Ta 126,29,18432
Mvaa 168,56,12
Mvaa 172,60,12
s_waitcnt lgkmcnt(6)
Ra 92,21,14336
Mvaa 176,32,16
Mvaa 180,36,16
Mvaa 184,40,16
Mvaa 188,44,16
Mvaa 192,48,16
Mvaa 196,52,16
Mvaa 200,56,16
Mvaa 204,60,16
Mvaa 208,32,20
Mvaa 212,36,20
Mvaa 216,40,20
Mvaa 220,44,20
Mvaa 224,48,20
Mvaa 228,52,20
Mvaa 232,56,20
Mvaa 236,60,20
Mvaa 240,32,24
Mvaa 244,36,24
Mvaa 248,40,24
Mvaa 252,44,24
Maaa 128,48,24
Maaa 132,52,24
Maaa 136,56,24
Maaa 140,60,24
Maaa 144,32,28
Maaa 148,36,28
Maaa 152,40,28
Maaa 156,44,28
Maaa 160,48,28
Maaa 164,52,28
Maaa 168,56,28
Maaa 172,60,28
s_waitcnt vmcnt(12) lgkmcnt(0)
v_readfirstlane_b32 s3, v30
s_nop 0
s_or_b32 s3, s3, s37
s_cmp_lt_u32 s3, 256
s_cbranch_scc1 L_spinAk
L_spinArk:
s_barrier
Mvaa 48,96,64
buffer_load_dwordx4 a[0:3], v10, s[20:23], 0 offen offset:0 sc1
Mvaa 52,100,64
v_lshrrev_b32 v42, 2, v33
v_lshl_add_u32 v43, v32, 3, v42
Mvaa 56,104,64
v_lshlrev_b32 v43, 8, v43
v_and_b32 v44, 3, v0
Mvaa 60,108,64
v_lshl_add_u32 v43, v44, 3, v43
v_and_b32 v44, 1, v32
Mvaa 64,112,64
buffer_load_dwordx4 a[4:7], v10, s[20:23], s58 offen offset:0 sc1
Mvaa 68,116,64
v_lshl_add_u32 v42, v44, 2, v42
v_xor_b32 v44, 0, v42
Mvaa 72,120,64
v_lshl_add_u32 v16, v44, 5, v43
v_xor_b32 v44, 1, v42
Mvaa 76,124,64
v_lshl_add_u32 v17, v44, 5, v43
v_xor_b32 v44, 2, v42
Mvaa 80,96,68
buffer_load_dwordx4 a[8:11], v11, s[20:23], 0 offen offset:0 sc1
Mvaa 84,100,68
v_lshl_add_u32 v18, v44, 5, v43
v_xor_b32 v44, 3, v42
Mvaa 88,104,68
v_lshl_add_u32 v19, v44, 5, v43
v_xor_b32 v44, 4, v42
Mvaa 92,108,68
v_lshl_add_u32 v20, v44, 5, v43
v_xor_b32 v44, 5, v42
Mvaa 96,112,68
buffer_load_dwordx4 a[12:15], v11, s[20:23], s58 offen offset:0 sc1
Mvaa 100,116,68
v_lshl_add_u32 v21, v44, 5, v43
v_xor_b32 v44, 6, v42
Mvaa 104,120,68
v_lshl_add_u32 v22, v44, 5, v43
v_xor_b32 v44, 7, v42
Mvaa 108,124,68
v_lshl_add_u32 v23, v44, 5, v43
Mvaa 112,96,72
buffer_load_dwordx4 a[16:19], v10, s[20:23], 0 offen offset:1024 sc1
Mvaa 116,100,72
Mvaa 120,104,72
Mvaa 124,108,72
Mvaa 128,112,72
buffer_load_dwordx4 a[20:23], v10, s[20:23], s58 offen offset:1024 sc1
Mvaa 132,116,72
Ta 192,16,0
Ta 194,16,1024
Mvaa 136,120,72
Ta 196,17,0
Ta 198,17,1024
Mvaa 140,124,72
Ta 200,18,0
Ta 202,18,1024
Mvaa 144,96,76
buffer_load_dwordx4 a[24:27], v11, s[20:23], 0 offen offset:1024 sc1
Mvaa 148,100,76
Ta 204,19,0
Ta 206,19,1024
Mvaa 152,104,76
Ta 208,20,0
Ta 210,20,1024
Mvaa 156,108,76
Ta 212,21,0
Ta 214,21,1024
Mvaa 160,112,76
buffer_load_dwordx4 a[28:31], v11, s[20:23], s58 offen offset:1024 sc1
Mvaa 164,116,76
Ta 216,22,0
Ta 218,22,1024
Mvaa 168,120,76
Ta 220,23,0
s_waitcnt lgkmcnt(9)
Ta 222,23,1024
Mvaa 172,124,76
s_waitcnt lgkmcnt(8)
Vc 24,48,49
Vc 25,50,51
Mvaa 176,96,80
buffer_load_dwordx4 a[32:35], v10, s[20:23], 0 offen offset:2048 sc1
Mvaa 180,100,80
Vc 26,52,53
Vc 27,54,55
Mvaa 184,104,80
Vc 28,56,57
Vc 29,58,59
Mvaa 188,108,80
Vc 30,60,61
Vc 31,62,63
Mvaa 192,112,80
buffer_load_dwordx4 a[36:39], v10, s[20:23], s58 offen offset:2048 sc1
Mvaa 196,116,80
Vc 32,64,65
Vc 33,66,67
Mvaa 200,120,80
Vc 34,68,69
Vc 35,70,71
Mvaa 204,124,80
Vc 36,72,73
Vc 37,74,75
Mvaa 208,96,84
buffer_load_dwordx4 a[40:43], v11, s[20:23], 0 offen offset:2048 sc1
Mvaa 212,100,84
Vc 38,76,77
Vc 39,78,79
Mvaa 216,104,84
Vc 40,80,81
Vc 41,82,83
Mvaa 220,108,84
Vc 42,84,85
Vc 43,86,87
Mvaa 224,112,84
buffer_load_dwordx4 a[44:47], v11, s[20:23], s58 offen offset:2048 sc1
Mvaa 228,116,84
Vc 44,88,89
Vc 45,90,91
Mvaa 232,120,84
Vc 46,92,93
Vc 47,94,95
Mvaa 236,124,84
Vc 48,96,97
Vc 49,98,99
Mvaa 240,96,88
buffer_load_dwordx4 a[48:51], v10, s[20:23], 0 offen offset:3072 sc1
Mvaa 244,100,88
Vc 50,100,101
Vc 51,102,103
Mvaa 248,104,88
Vc 52,104,105
Vc 53,106,107
Mvaa 252,108,88
Vc 54,108,109
Vc 55,110,111
Maaa 128,112,88
buffer_load_dwordx4 a[52:55], v10, s[20:23], s58 offen offset:3072 sc1
Maaa 132,116,88
Vc 56,112,113
Vc 57,114,115
Maaa 136,120,88
Vc 58,116,117
Vc 59,118,119
Maaa 140,124,88
Vc 60,120,121
Vc 61,122,123
Maaa 144,96,92
buffer_load_dwordx4 a[56:59], v11, s[20:23], 0 offen offset:3072 sc1
Maaa 148,100,92
Vc 62,124,125
Vc 63,126,127
Maaa 152,104,92
Vc 64,128,129
Vc 65,130,131
Maaa 156,108,92
Vc 66,132,133
Vc 67,134,135
Maaa 160,112,92
buffer_load_dwordx4 a[60:63], v11, s[20:23], s58 offen offset:3072 sc1
Maaa 164,116,92
v_add_u32 v10, 4096, v10
v_add_u32 v11, 4096, v11
Maaa 168,120,92
Vc 68,136,137
Vc 69,138,139
Maaa 172,124,92
Vc 70,140,141
Vc 71,142,143
Vc 72,144,145
Vc 73,146,147
Vc 74,148,149
Vc 75,150,151
Vc 76,152,153
Vc 77,154,155
Vc 78,156,157
Vc 79,158,159
Vc 80,160,161
Vc 81,162,163
Vc 82,164,165
Vc 83,166,167
Vc 84,168,169
Vc 85,170,171
Vc 86,172,173
Vc 87,174,175
Vc 88,176,177
Vc 89,178,179
Vc 90,180,181
Vc 91,182,183
Vc 92,184,185
Vc 93,186,187
Vc 94,188,189
Vc 95,190,191
Vc 96,192,193
Vc 97,194,195
Vc 98,196,197
Vc 99,198,199
Vc 100,200,201
Vc 101,202,203
Vc 102,204,205
Vc 103,206,207
Vc 104,208,209
Vc 105,210,211
Vc 106,212,213
Vc 107,214,215
Vc 108,216,217
Vc 109,218,219
Vc 110,220,221
Vc 111,222,223
Vc 112,224,225
Vc 113,226,227
Vc 114,228,229
Vc 115,230,231
Vc 116,232,233
Vc 117,234,235
Vc 118,236,237
Vc 119,238,239
Vc 120,240,241
Vc 121,242,243
Vc 122,244,245
Vc 123,246,247
Vc 124,248,249
Vc 125,250,251
Vc 126,252,253
Vc 127,254,255
s_branch L_phase2
L_k1_vpath:
s_waitcnt lgkmcnt(0)
Zvaa 48,0,32
v_and_b32 v46, 7, v0
v_mul_u32_u24 v30, 2064, v46
Zvaa 64,0,36
Ta 96,12,16384
Ta 98,12,18432
Zvaa 80,0,40
v_lshrrev_b32 v31, 3, v0
Zvaa 96,0,44
Ra 64,11,0
Zvaa 112,0,48
s_lshl_b32 s3, s32, 9
s_add_u32 s3, s3, 131072
v_lshl_add_u32 v30, v31, 4, v30
Zvaa 128,0,52
Ta 100,13,16384
Ta 102,13,18432
Zvaa 144,0,56
v_add_u32 v30, s3, v30
v_lshlrev_b32 v31, 8, v31
Zvaa 160,0,60
s_waitcnt lgkmcnt(6)
Ra 68,11,2048
Zvaa 52,4,32
v_lshl_add_u32 v46, v46, 4, v31
Zvaa 68,4,36
Ta 104,14,16384
Ta 106,14,18432
Zvaa 84,4,40
Rv 34,30,128
Rv 38,30,256
Zvaa 100,4,44
Ra 72,11,4096
Zvaa 116,4,48
Rv 42,30,384
Rv 30,30,0
Zvaa 132,4,52
Ta 108,15,16384
Ta 110,15,18432
Zvaa 148,4,56
s_lshr_b32 s3, s2, 1
s_mul_i32 s3, s3, 33792
s_add_u32 s3, s3, s56
Zvaa 164,4,60
s_waitcnt lgkmcnt(6)
Ra 76,11,6144
Zvaa 56,8,32
s_and_b32 s39, s2, 1
s_lshl_b32 s39, s39, 7
s_add_u32 s3, s3, s39
Zvaa 72,8,36
Ta 112,16,16384
Ta 114,16,18432
Zvaa 88,8,40
s_add_u32 s39, s3, 4096
Zvaa 104,8,44
Ra 80,11,8192
Zvaa 120,8,48
Zvaa 136,8,52
Ta 116,17,16384
Ta 118,17,18432
Zvaa 152,8,56
Zvaa 168,8,60
s_waitcnt lgkmcnt(6)
Ra 84,11,10240
Zvaa 60,12,32
Zvaa 76,12,36
Ta 120,18,16384
Ta 122,18,18432
Zvaa 92,12,40
Zvaa 108,12,44
Ra 88,11,12288
Zvaa 124,12,48
Zvaa 140,12,52
Ta 124,19,16384
Ta 126,19,18432
Zvaa 156,12,56
Zvaa 172,12,60
s_waitcnt lgkmcnt(6)
Ra 92,11,14336
Zvaa 176,16,32
Zvaa 192,16,36
Zvaa 208,16,40
Zvaa 224,16,44
Zvaa 240,16,48
Zaaa 128,16,52
Zaaa 144,16,56
Zaaa 160,16,60
Zvaa 180,20,32
Zvaa 196,20,36
Zvaa 212,20,40
Zvaa 228,20,44
Zvaa 244,20,48
Zaaa 132,20,52
Zaaa 148,20,56
Zaaa 164,20,60
Zvaa 184,24,32
Zvaa 200,24,36
Zvaa 216,24,40
Zvaa 232,24,44
Zvaa 248,24,48
Zaaa 136,24,52
Zaaa 152,24,56
Zaaa 168,24,60
Zvaa 188,28,32
Zvaa 204,28,36
Zvaa 220,28,40
Zvaa 236,28,44
Zvaa 252,28,48
Zaaa 140,28,52
Zaaa 156,28,56
Zaaa 172,28,60
s_waitcnt vmcnt(4) lgkmcnt(0)
s_add_u32 m0, s57, 0
s_barrier
Mvaa 48,64,96
buffer_load_dwordx4 v6, s[12:15], s52 offen offset:0 nt lds
Mvaa 64,64,100
Ta 32,22,0
Ta 34,22,2048
Mvaa 80,64,104
Mvaa 96,64,108
Ra 0,20,0
Mvaa 112,64,112
buffer_load_dwordx4 v7, s[12:15], s53 offen offset:1024 nt lds
Mvaa 128,64,116
s_waitcnt lgkmcnt(6)
Ta 36,23,0
Ta 38,23,2048
Mvaa 144,64,120
Mvaa 160,64,124
Ra 4,20,2048
Mvaa 52,68,96
buffer_load_dwordx4 v6, s[12:15], s54 offen offset:2048 nt lds
Mvaa 68,68,100
Ta 40,24,0
Ta 42,24,2048
Mvaa 84,68,104
Mvaa 100,68,108
Ra 8,20,4096
Mvaa 116,68,112
buffer_load_dwordx4 v7, s[12:15], s55 offen offset:3072 nt lds
Mvaa 132,68,116
s_waitcnt lgkmcnt(6)
Ta 44,25,0
Ta 46,25,2048
Mvaa 148,68,120
Mvaa 164,68,124
s_add_u32 m0, s57, 4096
Ra 12,20,6144
Mvaa 56,72,96
buffer_load_dwordx4 v8, s[12:15], s52 offen offset:0 nt lds
Mvaa 72,72,100
Ta 48,26,0
Ta 50,26,2048
Mvaa 88,72,104
Mvaa 104,72,108
Ra 16,20,8192
Mvaa 120,72,112
buffer_load_dwordx4 v9, s[12:15], s53 offen offset:1024 nt lds
Mvaa 136,72,116
s_waitcnt lgkmcnt(6)
Ta 52,27,0
Ta 54,27,2048
Mvaa 152,72,120
Mvaa 168,72,124
Ra 20,20,10240
Mvaa 60,76,96
buffer_load_dwordx4 v8, s[12:15], s54 offen offset:2048 nt lds
Mvaa 76,76,100
Ta 56,28,0
Ta 58,28,2048
Mvaa 92,76,104
Mvaa 108,76,108
Ra 24,20,12288
Mvaa 124,76,112
buffer_load_dwordx4 v9, s[12:15], s55 offen offset:3072 nt lds
Mvaa 140,76,116
s_waitcnt lgkmcnt(6)
Ta 60,29,0
Ta 62,29,2048
Mvaa 156,76,120
v_add_u32 v6, 524288, v6
v_add_u32 v7, 524288, v7
Mvaa 172,76,124
s_add_u32 m0, s56, 0
Ra 28,20,14336
v_add_u32 v8, 524288, v8
Mvaa 176,80,96
buffer_load_dwordx4 v2, s[8:11], s48 offen offset:0 lds
Mvaa 192,80,100
v_add_u32 v9, 524288, v9
Mvaa 208,80,104
Mvaa 224,80,108
Mvaa 240,80,112
buffer_load_dwordx4 v3, s[8:11], s49 offen offset:1024 lds
Maaa 128,80,116
Maaa 144,80,120
Maaa 160,80,124
Mvaa 180,84,96
buffer_load_dwordx4 v2, s[8:11], s50 offen offset:2048 lds
Mvaa 196,84,100
Mvaa 212,84,104
Mvaa 228,84,108
Mvaa 244,84,112
buffer_load_dwordx4 v3, s[8:11], s51 offen offset:3072 lds
Maaa 132,84,116
Maaa 148,84,120
Maaa 164,84,124
s_add_u32 m0, s56, 4096
Mvaa 184,88,96
buffer_load_dwordx4 v4, s[8:11], s48 offen offset:0 lds
Mvaa 200,88,100
Mvaa 216,88,104
Mvaa 232,88,108
Mvaa 248,88,112
buffer_load_dwordx4 v5, s[8:11], s49 offen offset:1024 lds
Maaa 136,88,116
Maaa 152,88,120
Maaa 168,88,124
Mvaa 188,92,96
buffer_load_dwordx4 v4, s[8:11], s50 offen offset:2048 lds
Mvaa 204,92,100
Mvaa 220,92,104
Mvaa 236,92,108
Mvaa 252,92,112
buffer_load_dwordx4 v5, s[8:11], s51 offen offset:3072 lds
Maaa 140,92,116
v_add_u32 v2, 128, v2
v_add_u32 v3, 128, v3
Maaa 156,92,120
buffer_load_dword v1, v47, s[60:63], 0 offen
v_add_u32 v4, 128, v4
v_add_u32 v5, 128, v5
Maaa 172,92,124
v_add_u32 v47, s59, v47
s_waitcnt lgkmcnt(0)
Mvaa 48,0,32
buffer_store_dwordx4 v[30:33], v46, s[20:23], s3 offen offset:0 sc1
Mvaa 64,0,36
Ta 96,22,16384
Ta 98,22,18432
Mvaa 80,0,40
buffer_store_dwordx4 v[34:37], v46, s[20:23], s3 offen offset:2048 sc1
Mvaa 96,0,44
Ra 64,21,0
Mvaa 112,0,48
buffer_store_dwordx4 v[38:41], v46, s[20:23], s39 offen offset:0 sc1
Mvaa 128,0,52
Ta 100,23,16384
Ta 102,23,18432
Mvaa 144,0,56
buffer_store_dwordx4 v[42:45], v46, s[20:23], s39 offen offset:2048 sc1
Mvaa 160,0,60
s_waitcnt lgkmcnt(6)
Ra 68,21,2048
Mvaa 52,4,32
s_lshl_b32 s3, s34, 1
s_and_b32 s36, s32, 1
s_add_u32 s3, s3, s36
Mvaa 68,4,36
Ta 104,24,16384
Ta 106,24,18432
Mvaa 84,4,40
s_mul_i32 s3, s3, 1116160
s_mul_i32 s36, s33, 139264
s_add_u32 s3, s3, s36
Mvaa 100,4,44
Ra 72,21,4096
Mvaa 116,4,48
s_lshr_b32 s36, s32, 1
s_mul_i32 s36, s36, 69632
s_add_u32 s3, s3, s36
Mvaa 132,4,52
Ta 108,25,16384
Ta 110,25,18432
Mvaa 148,4,56
s_add_u32 s38, s3, 17408
s_lshl_b32 s39, s34, 7
s_lshl_b32 s36, s33, 2
Mvaa 164,4,60
s_waitcnt lgkmcnt(6)
Ra 76,21,6144
Mvaa 56,8,32
s_add_u32 s39, s39, s36
s_add_u32 s39, s39, 5296160
v_mov_b32 v30, 1
Mvaa 72,8,36
Ta 112,26,16384
Ta 114,26,18432
Mvaa 88,8,40
v_mov_b32 v31, 0
Mvaa 104,8,44
Ra 80,21,8192
Mvaa 120,8,48
s_cmp_eq_u32 s32, 0
s_cselect_b32 s39, s39, 2146435072
Mvaa 136,8,52
Ta 116,27,16384
Ta 118,27,18432
Mvaa 152,8,56
s_mov_b64 exec, 1
buffer_store_dword v31, v31, s[20:23], s39 offen sc1
s_mov_b64 exec, -1
Mvaa 168,8,60
s_waitcnt lgkmcnt(6)
Ra 84,21,10240
Mvaa 60,12,32
s_and_b32 s33, s2, 7
s_lshl_b32 s33, s33, 2
s_bfe_u32 s3, s2, 0x20003
Mvaa 76,12,36
Ta 120,28,16384
Ta 122,28,18432
Mvaa 92,12,40
s_add_u32 s33, s33, s3
s_lshr_b32 s34, s2, 5
s_lshl_b32 s35, s34, 1
Mvaa 108,12,44
Ra 88,21,12288
Mvaa 124,12,48
s_sub_u32 s36, 32, s35
s_add_u32 s35, s35, 2
s_lshl_b32 s44, s32, 12
Mvaa 140,12,52
Ta 124,29,16384
Ta 126,29,18432
Mvaa 156,12,56
s_mov_b32 s58, 33792
s_sub_u32 s3, 15, s34
s_lshl_b32 s45, s3, 2
Mvaa 172,12,60
s_waitcnt lgkmcnt(6)
Ra 92,21,14336
Mvaa 176,16,32
s_add_u32 s45, s45, s32
s_lshl_b32 s46, s34, 2
s_add_u32 s46, s46, s32
Mvaa 192,16,36
s_add_u32 s16, s66, 46137344
s_addc_u32 s17, s67, 0
s_and_b32 s17, s17, 0xffff
Mvaa 208,16,40
s_mov_b32 s18, 16777216
s_mov_b32 s19, 0x20000
s_mov_b32 s68, s42
Mvaa 224,16,44
s_and_b32 s69, s43, 0xffff
s_mov_b32 s70, 7340032
s_mov_b32 s71, 0x20000
Mvaa 240,16,48
s_cmp_eq_u32 s32, 0
s_cselect_b32 s37, 0, 2146435072
Maaa 128,16,52
Maaa 144,16,56
Maaa 160,16,60
Mvaa 180,20,32
Mvaa 196,20,36
Mvaa 212,20,40
Mvaa 228,20,44
Mvaa 244,20,48
Maaa 132,20,52
Maaa 148,20,56
Maaa 164,20,60
Mvaa 184,24,32
Mvaa 200,24,36
Mvaa 216,24,40
Mvaa 232,24,44
Mvaa 248,24,48
Maaa 136,24,52
Maaa 152,24,56
Maaa 168,24,60
Mvaa 188,28,32
Mvaa 204,28,36
Mvaa 220,28,40
Mvaa 236,28,44
Mvaa 252,28,48
Maaa 140,28,52
Maaa 156,28,56
Maaa 172,28,60
s_waitcnt vmcnt(6) lgkmcnt(0)
s_add_u32 m0, s57, 65536
s_barrier
Mvaa 48,64,96
buffer_load_dwordx4 v6, s[12:15], s52 offen offset:0 nt lds
Mvaa 64,64,100
Ta 32,12,0
Ta 34,12,2048
Mvaa 80,64,104
Mvaa 96,64,108
Ra 0,10,0
Mvaa 112,64,112
buffer_load_dwordx4 v7, s[12:15], s53 offen offset:1024 nt lds
Mvaa 128,64,116
s_waitcnt lgkmcnt(6)
Ta 36,13,0
Ta 38,13,2048
Mvaa 144,64,120
Mvaa 160,64,124
Ra 4,10,2048
Mvaa 52,68,96
buffer_load_dwordx4 v6, s[12:15], s54 offen offset:2048 nt lds
Mvaa 68,68,100
Ta 40,14,0
Ta 42,14,2048
Mvaa 84,68,104
Mvaa 100,68,108
Ra 8,10,4096
Mvaa 116,68,112
buffer_load_dwordx4 v7, s[12:15], s55 offen offset:3072 nt lds
Mvaa 132,68,116
s_waitcnt lgkmcnt(6)
Ta 44,15,0
Ta 46,15,2048
Mvaa 148,68,120
Mvaa 164,68,124
s_add_u32 m0, s57, 69632
Ra 12,10,6144
Mvaa 56,72,96
buffer_load_dwordx4 v8, s[12:15], s52 offen offset:0 nt lds
Mvaa 72,72,100
Ta 48,16,0
Ta 50,16,2048
Mvaa 88,72,104
Mvaa 104,72,108
Ra 16,10,8192
Mvaa 120,72,112
buffer_load_dwordx4 v9, s[12:15], s53 offen offset:1024 nt lds
Mvaa 136,72,116
s_waitcnt lgkmcnt(6)
Ta 52,17,0
Ta 54,17,2048
Mvaa 152,72,120
Mvaa 168,72,124
Ra 20,10,10240
Mvaa 60,76,96
buffer_load_dwordx4 v8, s[12:15], s54 offen offset:2048 nt lds
Mvaa 76,76,100
Ta 56,18,0
Ta 58,18,2048
Mvaa 92,76,104
Mvaa 108,76,108
Ra 24,10,12288
Mvaa 124,76,112
buffer_load_dwordx4 v9, s[12:15], s55 offen offset:3072 nt lds
Mvaa 140,76,116
s_waitcnt lgkmcnt(6)
Ta 60,19,0
Ta 62,19,2048
Mvaa 156,76,120
v_add_u32 v6, 524288, v6
v_add_u32 v7, 524288, v7
Mvaa 172,76,124
s_add_u32 m0, s56, 65536
Ra 28,10,14336
v_add_u32 v8, 524288, v8
Mvaa 176,80,96
buffer_load_dwordx4 v2, s[8:11], s48 offen offset:0 lds
Mvaa 192,80,100
v_add_u32 v9, 524288, v9
Mvaa 208,80,104
Mvaa 224,80,108
Mvaa 240,80,112
buffer_load_dwordx4 v3, s[8:11], s49 offen offset:1024 lds
Maaa 128,80,116
Maaa 144,80,120
Maaa 160,80,124
Mvaa 180,84,96
buffer_load_dwordx4 v2, s[8:11], s50 offen offset:2048 lds
Mvaa 196,84,100
Mvaa 212,84,104
Mvaa 228,84,108
Mvaa 244,84,112
buffer_load_dwordx4 v3, s[8:11], s51 offen offset:3072 lds
Maaa 132,84,116
Maaa 148,84,120
Maaa 164,84,124
s_add_u32 m0, s56, 69632
Mvaa 184,88,96
buffer_load_dwordx4 v4, s[8:11], s48 offen offset:0 lds
Mvaa 200,88,100
Mvaa 216,88,104
Mvaa 232,88,108
Mvaa 248,88,112
buffer_load_dwordx4 v5, s[8:11], s49 offen offset:1024 lds
Maaa 136,88,116
Maaa 152,88,120
Maaa 168,88,124
Mvaa 188,92,96
buffer_load_dwordx4 v4, s[8:11], s50 offen offset:2048 lds
Mvaa 204,92,100
Mvaa 220,92,104
Mvaa 236,92,108
Mvaa 252,92,112
buffer_load_dwordx4 v5, s[8:11], s51 offen offset:3072 lds
Maaa 140,92,116
v_add_u32 v2, 128, v2
v_add_u32 v3, 128, v3
Maaa 156,92,120
buffer_load_dword v1, v47, s[60:63], 0 offen
v_add_u32 v4, 128, v4
v_add_u32 v5, 128, v5
Maaa 172,92,124
v_add_u32 v47, s59, v47
s_waitcnt lgkmcnt(0)
Mvaa 48,0,32
Mvaa 64,0,36
Ta 96,12,16384
Ta 98,12,18432
Mvaa 80,0,40
Mvaa 96,0,44
Ra 64,11,0
Mvaa 112,0,48
Mvaa 128,0,52
Ta 100,13,16384
Ta 102,13,18432
Mvaa 144,0,56
Mvaa 160,0,60
s_waitcnt lgkmcnt(6)
Ra 68,11,2048
Mvaa 52,4,32
Mvaa 68,4,36
Ta 104,14,16384
Ta 106,14,18432
Mvaa 84,4,40
Mvaa 100,4,44
Ra 72,11,4096
Mvaa 116,4,48
Mvaa 132,4,52
Ta 108,15,16384
Ta 110,15,18432
Mvaa 148,4,56
Mvaa 164,4,60
s_waitcnt lgkmcnt(6)
Ra 76,11,6144
Mvaa 56,8,32
Mvaa 72,8,36
Ta 112,16,16384
Ta 114,16,18432
Mvaa 88,8,40
Mvaa 104,8,44
Ra 80,11,8192
Mvaa 120,8,48
Mvaa 136,8,52
Ta 116,17,16384
Ta 118,17,18432
Mvaa 152,8,56
Mvaa 168,8,60
s_waitcnt lgkmcnt(6)
Ra 84,11,10240
Mvaa 60,12,32
Mvaa 76,12,36
Ta 120,18,16384
Ta 122,18,18432
Mvaa 92,12,40
Mvaa 108,12,44
Ra 88,11,12288
Mvaa 124,12,48
Mvaa 140,12,52
Ta 124,19,16384
Ta 126,19,18432
Mvaa 156,12,56
Mvaa 172,12,60
s_waitcnt lgkmcnt(6)
Ra 92,11,14336
Mvaa 176,16,32
Mvaa 192,16,36
Mvaa 208,16,40
Mvaa 224,16,44
Mvaa 240,16,48
Maaa 128,16,52
Maaa 144,16,56
Maaa 160,16,60
Mvaa 180,20,32
Mvaa 196,20,36
Mvaa 212,20,40
Mvaa 228,20,44
Mvaa 244,20,48
Maaa 132,20,52
Maaa 148,20,56
Maaa 164,20,60
Mvaa 184,24,32
Mvaa 200,24,36
Mvaa 216,24,40
Mvaa 232,24,44
Mvaa 248,24,48
Maaa 136,24,52
Maaa 152,24,56
Maaa 168,24,60
Mvaa 188,28,32
Mvaa 204,28,36
Mvaa 220,28,40
Mvaa 236,28,44
Mvaa 252,28,48
Maaa 140,28,52
Maaa 156,28,56
Maaa 172,28,60
s_waitcnt vmcnt(1) lgkmcnt(0)
s_add_u32 m0, s57, 0
s_barrier
Mvaa 48,64,96
buffer_load_dwordx4 v6, s[12:15], s52 offen offset:0 nt lds
Mvaa 64,64,100
Ta 32,22,0
Ta 34,22,2048
Mvaa 80,64,104
Mvaa 96,64,108
Ra 0,20,0
Mvaa 112,64,112
buffer_load_dwordx4 v7, s[12:15], s53 offen offset:1024 nt lds
Mvaa 128,64,116
s_waitcnt lgkmcnt(6)
Ta 36,23,0
Ta 38,23,2048
Mvaa 144,64,120
Mvaa 160,64,124
Ra 4,20,2048
Mvaa 52,68,96
buffer_load_dwordx4 v6, s[12:15], s54 offen offset:2048 nt lds
Mvaa 68,68,100
Ta 40,24,0
Ta 42,24,2048
Mvaa 84,68,104
Mvaa 100,68,108
Ra 8,20,4096
Mvaa 116,68,112
buffer_load_dwordx4 v7, s[12:15], s55 offen offset:3072 nt lds
Mvaa 132,68,116
s_waitcnt lgkmcnt(6)
Ta 44,25,0
Ta 46,25,2048
Mvaa 148,68,120
Mvaa 164,68,124
s_add_u32 m0, s57, 4096
Ra 12,20,6144
Mvaa 56,72,96
buffer_load_dwordx4 v8, s[12:15], s52 offen offset:0 nt lds
Mvaa 72,72,100
Ta 48,26,0
Ta 50,26,2048
Mvaa 88,72,104
Mvaa 104,72,108
Ra 16,20,8192
Mvaa 120,72,112
buffer_load_dwordx4 v9, s[12:15], s53 offen offset:1024 nt lds
Mvaa 136,72,116
s_waitcnt lgkmcnt(6)
Ta 52,27,0
Ta 54,27,2048
Mvaa 152,72,120
Mvaa 168,72,124
Ra 20,20,10240
Mvaa 60,76,96
buffer_load_dwordx4 v8, s[12:15], s54 offen offset:2048 nt lds
Mvaa 76,76,100
Ta 56,28,0
Ta 58,28,2048
Mvaa 92,76,104
Mvaa 108,76,108
Ra 24,20,12288
Mvaa 124,76,112
buffer_load_dwordx4 v9, s[12:15], s55 offen offset:3072 nt lds
Mvaa 140,76,116
s_waitcnt lgkmcnt(6)
Ta 60,29,0
Ta 62,29,2048
Mvaa 156,76,120
v_add_u32 v6, 524288, v6
v_add_u32 v7, 524288, v7
Mvaa 172,76,124
s_add_u32 m0, s56, 0
Ra 28,20,14336
v_add_u32 v8, 524288, v8
Mvaa 176,80,96
buffer_load_dwordx4 v2, s[8:11], s48 offen offset:0 lds
Mvaa 192,80,100
v_add_u32 v9, 524288, v9
Mvaa 208,80,104
Mvaa 224,80,108
Mvaa 240,80,112
buffer_load_dwordx4 v3, s[8:11], s49 offen offset:1024 lds
Maaa 128,80,116
Maaa 144,80,120
Maaa 160,80,124
Mvaa 180,84,96
buffer_load_dwordx4 v2, s[8:11], s50 offen offset:2048 lds
Mvaa 196,84,100
Mvaa 212,84,104
Mvaa 228,84,108
Mvaa 244,84,112
buffer_load_dwordx4 v3, s[8:11], s51 offen offset:3072 lds
Maaa 132,84,116
Maaa 148,84,120
Maaa 164,84,124
s_add_u32 m0, s56, 4096
Mvaa 184,88,96
buffer_load_dwordx4 v4, s[8:11], s48 offen offset:0 lds
Mvaa 200,88,100
Mvaa 216,88,104
Mvaa 232,88,108
Mvaa 248,88,112
buffer_load_dwordx4 v5, s[8:11], s49 offen offset:1024 lds
Maaa 136,88,116
Maaa 152,88,120
Maaa 168,88,124
Mvaa 188,92,96
buffer_load_dwordx4 v4, s[8:11], s50 offen offset:2048 lds
Mvaa 204,92,100
Mvaa 220,92,104
Mvaa 236,92,108
Mvaa 252,92,112
buffer_load_dwordx4 v5, s[8:11], s51 offen offset:3072 lds
Maaa 140,92,116
v_add_u32 v2, 128, v2
v_add_u32 v3, 128, v3
Maaa 156,92,120
buffer_load_dword v1, v47, s[60:63], 0 offen
v_add_u32 v4, 128, v4
v_add_u32 v5, 128, v5
Maaa 172,92,124
v_add_u32 v47, s59, v47
s_waitcnt lgkmcnt(0)
Mvaa 48,0,32
s_mov_b64 exec, 1
buffer_atomic_add v30, v31, s[28:31], s37 offen sc1
s_mov_b64 exec, -1
Mvaa 64,0,36
Ta 96,22,16384
Ta 98,22,18432
Mvaa 80,0,40
Mvaa 96,0,44
Ra 64,21,0
Mvaa 112,0,48
Mvaa 128,0,52
Ta 100,23,16384
Ta 102,23,18432
Mvaa 144,0,56
Mvaa 160,0,60
s_waitcnt lgkmcnt(6)
Ra 68,21,2048
Mvaa 52,4,32
Mvaa 68,4,36
Ta 104,24,16384
Ta 106,24,18432
Mvaa 84,4,40
Mvaa 100,4,44
Ra 72,21,4096
Mvaa 116,4,48
Mvaa 132,4,52
Ta 108,25,16384
Ta 110,25,18432
Mvaa 148,4,56
Mvaa 164,4,60
s_waitcnt lgkmcnt(6)
Ra 76,21,6144
Mvaa 56,8,32
Mvaa 72,8,36
Ta 112,26,16384
Ta 114,26,18432
Mvaa 88,8,40
Mvaa 104,8,44
Ra 80,21,8192
Mvaa 120,8,48
Mvaa 136,8,52
Ta 116,27,16384
Ta 118,27,18432
Mvaa 152,8,56
Mvaa 168,8,60
s_waitcnt lgkmcnt(6)
Ra 84,21,10240
Mvaa 60,12,32
Mvaa 76,12,36
Ta 120,28,16384
Ta 122,28,18432
Mvaa 92,12,40
Mvaa 108,12,44
Ra 88,21,12288
Mvaa 124,12,48
Mvaa 140,12,52
Ta 124,29,16384
Ta 126,29,18432
Mvaa 156,12,56
Mvaa 172,12,60
s_waitcnt lgkmcnt(6)
Ra 92,21,14336
Mvaa 176,16,32
Mvaa 192,16,36
Mvaa 208,16,40
Mvaa 224,16,44
Mvaa 240,16,48
Maaa 128,16,52
Maaa 144,16,56
Maaa 160,16,60
Mvaa 180,20,32
Mvaa 196,20,36
Mvaa 212,20,40
Mvaa 228,20,44
Mvaa 244,20,48
Maaa 132,20,52
Maaa 148,20,56
Maaa 164,20,60
Mvaa 184,24,32
Mvaa 200,24,36
Mvaa 216,24,40
Mvaa 232,24,44
Mvaa 248,24,48
Maaa 136,24,52
Maaa 152,24,56
Maaa 168,24,60
Mvaa 188,28,32
Mvaa 204,28,36
Mvaa 220,28,40
Mvaa 236,28,44
Mvaa 252,28,48
Maaa 140,28,52
Maaa 156,28,56
Maaa 172,28,60
s_waitcnt vmcnt(2) lgkmcnt(0)
s_add_u32 m0, s57, 65536
s_barrier
Mvaa 48,64,96
buffer_load_dwordx4 v6, s[12:15], s52 offen offset:0 nt lds
Mvaa 64,64,100
Ta 32,12,0
Ta 34,12,2048
Mvaa 80,64,104
Mvaa 96,64,108
Ra 0,10,0
Mvaa 112,64,112
buffer_load_dwordx4 v7, s[12:15], s53 offen offset:1024 nt lds
Mvaa 128,64,116
s_waitcnt lgkmcnt(6)
Ta 36,13,0
Ta 38,13,2048
Mvaa 144,64,120
Mvaa 160,64,124
Ra 4,10,2048
Mvaa 52,68,96
buffer_load_dwordx4 v6, s[12:15], s54 offen offset:2048 nt lds
Mvaa 68,68,100
Ta 40,14,0
Ta 42,14,2048
Mvaa 84,68,104
Mvaa 100,68,108
Ra 8,10,4096
Mvaa 116,68,112
buffer_load_dwordx4 v7, s[12:15], s55 offen offset:3072 nt lds
Mvaa 132,68,116
s_waitcnt lgkmcnt(6)
Ta 44,15,0
Ta 46,15,2048
Mvaa 148,68,120
Mvaa 164,68,124
s_add_u32 m0, s57, 69632
Ra 12,10,6144
Mvaa 56,72,96
buffer_load_dwordx4 v8, s[12:15], s52 offen offset:0 nt lds
Mvaa 72,72,100
Ta 48,16,0
Ta 50,16,2048
Mvaa 88,72,104
Mvaa 104,72,108
Ra 16,10,8192
Mvaa 120,72,112
buffer_load_dwordx4 v9, s[12:15], s53 offen offset:1024 nt lds
Mvaa 136,72,116
s_waitcnt lgkmcnt(6)
Ta 52,17,0
Ta 54,17,2048
Mvaa 152,72,120
Mvaa 168,72,124
Ra 20,10,10240
Mvaa 60,76,96
buffer_load_dwordx4 v8, s[12:15], s54 offen offset:2048 nt lds
Mvaa 76,76,100
Ta 56,18,0
Ta 58,18,2048
Mvaa 92,76,104
Mvaa 108,76,108
Ra 24,10,12288
Mvaa 124,76,112
buffer_load_dwordx4 v9, s[12:15], s55 offen offset:3072 nt lds
Mvaa 140,76,116
s_waitcnt lgkmcnt(6)
Ta 60,19,0
Ta 62,19,2048
Mvaa 156,76,120
v_add_u32 v6, 524288, v6
v_add_u32 v7, 524288, v7
Mvaa 172,76,124
s_add_u32 m0, s56, 65536
Ra 28,10,14336
v_add_u32 v8, 524288, v8
Mvaa 176,80,96
buffer_load_dwordx4 v2, s[8:11], s48 offen offset:0 lds
Mvaa 192,80,100
v_add_u32 v9, 524288, v9
Mvaa 208,80,104
Mvaa 224,80,108
Mvaa 240,80,112
buffer_load_dwordx4 v3, s[8:11], s49 offen offset:1024 lds
Maaa 128,80,116
Maaa 144,80,120
Maaa 160,80,124
Mvaa 180,84,96
buffer_load_dwordx4 v2, s[8:11], s50 offen offset:2048 lds
Mvaa 196,84,100
Mvaa 212,84,104
Mvaa 228,84,108
Mvaa 244,84,112
buffer_load_dwordx4 v3, s[8:11], s51 offen offset:3072 lds
Maaa 132,84,116
Maaa 148,84,120
Maaa 164,84,124
s_add_u32 m0, s56, 69632
Mvaa 184,88,96
buffer_load_dwordx4 v4, s[8:11], s48 offen offset:0 lds
Mvaa 200,88,100
Mvaa 216,88,104
Mvaa 232,88,108
Mvaa 248,88,112
buffer_load_dwordx4 v5, s[8:11], s49 offen offset:1024 lds
Maaa 136,88,116
Maaa 152,88,120
Maaa 168,88,124
Mvaa 188,92,96
buffer_load_dwordx4 v4, s[8:11], s50 offen offset:2048 lds
Mvaa 204,92,100
Mvaa 220,92,104
Mvaa 236,92,108
Mvaa 252,92,112
buffer_load_dwordx4 v5, s[8:11], s51 offen offset:3072 lds
Maaa 140,92,116
v_add_u32 v2, 128, v2
v_add_u32 v3, 128, v3
Maaa 156,92,120
buffer_load_dword v1, v47, s[60:63], 0 offen
v_add_u32 v4, 128, v4
v_add_u32 v5, 128, v5
Maaa 172,92,124
v_add_u32 v47, s59, v47
s_waitcnt lgkmcnt(0)
Mvaa 48,0,32
s_lshl_b32 s3, s33, 8
s_add_u32 s60, s4, s3
s_addc_u32 s61, s5, 0
s_and_b32 s61, s61, 0xffff
Mvaa 64,0,36
Ta 96,12,16384
Ta 98,12,18432
Mvaa 80,0,40
s_mov_b32 s62, 0
s_mov_b32 s63, 0x20000
s_sub_u32 s62, 8388608, s3
Mvaa 96,0,44
Ra 64,11,0
Mvaa 112,0,48
v_lshrrev_b32 v32, 1, v0
v_and_b32 v33, 1, v0
Mvaa 128,0,52
Ta 100,13,16384
Ta 102,13,18432
Mvaa 144,0,56
v_lshlrev_b32 v32, 13, v32
v_lshl_add_u32 v32, v33, 7, v32
Mvaa 160,0,60
s_waitcnt lgkmcnt(6)
Ra 68,11,2048
Mvaa 52,4,32
s_lshl_b32 s3, s32, 3
s_add_u32 s3, s3, s34
s_lshl_b32 s3, s3, 18
Mvaa 68,4,36
Ta 104,14,16384
Ta 106,14,18432
Mvaa 84,4,40
s_mov_b32 s59, 8388608
v_add_u32 v47, s3, v32
v_lshrrev_b32 v32, 4, v0
Mvaa 100,4,44
Ra 72,11,4096
Mvaa 116,4,48
v_and_b32 v33, 15, v0
Mvaa 132,4,52
Ta 108,15,16384
Ta 110,15,18432
Mvaa 148,4,56
s_lshl_b32 s3, s32, 4
v_add_u32 v34, s3, v32
v_lshlrev_b32 v36, 1, v32
Mvaa 164,4,60
s_waitcnt lgkmcnt(6)
Ra 76,11,6144
Mvaa 56,8,32
v_xor_b32 v36, v36, v33
v_xor_b32 v37, 8, v36
Mvaa 72,8,36
Ta 112,16,16384
Ta 114,16,18432
Mvaa 88,8,40
Mvaa 104,8,44
Ra 80,11,8192
Mvaa 120,8,48
Mvaa 136,8,52
Ta 116,17,16384
Ta 118,17,18432
Mvaa 152,8,56
Mvaa 168,8,60
s_waitcnt lgkmcnt(6)
Ra 84,11,10240
Mvaa 60,12,32
Mvaa 76,12,36
Ta 120,18,16384
Ta 122,18,18432
Mvaa 92,12,40
Mvaa 108,12,44
Ra 88,11,12288
Mvaa 124,12,48
Mvaa 140,12,52
Ta 124,19,16384
Ta 126,19,18432
Mvaa 156,12,56
Mvaa 172,12,60
s_waitcnt lgkmcnt(6)
Ra 92,11,14336
Mvaa 176,16,32
Mvaa 192,16,36
Mvaa 208,16,40
Mvaa 224,16,44
Mvaa 240,16,48
Maaa 128,16,52
Maaa 144,16,56
Maaa 160,16,60
Mvaa 180,20,32
Mvaa 196,20,36
Mvaa 212,20,40
Mvaa 228,20,44
Mvaa 244,20,48
Maaa 132,20,52
Maaa 148,20,56
Maaa 164,20,60
Mvaa 184,24,32
Mvaa 200,24,36
Mvaa 216,24,40
Mvaa 232,24,44
Mvaa 248,24,48
Maaa 136,24,52
Maaa 152,24,56
Maaa 168,24,60
Mvaa 188,28,32
Mvaa 204,28,36
Mvaa 220,28,40
Mvaa 236,28,44
Mvaa 252,28,48
Maaa 140,28,52
Maaa 156,28,56
Maaa 172,28,60
s_waitcnt vmcnt(1) lgkmcnt(0)
s_add_u32 m0, s57, 0
s_barrier
Mvaa 48,64,96
buffer_load_dwordx4 v6, s[12:15], s52 offen offset:0 nt lds
Mvaa 64,64,100
Ta 32,22,0
Ta 34,22,2048
Mvaa 80,64,104
Mvaa 96,64,108
Ra 0,20,0
Mvaa 112,64,112
buffer_load_dwordx4 v7, s[12:15], s53 offen offset:1024 nt lds
Mvaa 128,64,116
s_waitcnt lgkmcnt(6)
Ta 36,23,0
Ta 38,23,2048
Mvaa 144,64,120
Mvaa 160,64,124
Ra 4,20,2048
Mvaa 52,68,96
buffer_load_dwordx4 v6, s[12:15], s54 offen offset:2048 nt lds
Mvaa 68,68,100
Ta 40,24,0
Ta 42,24,2048
Mvaa 84,68,104
Mvaa 100,68,108
Ra 8,20,4096
Mvaa 116,68,112
buffer_load_dwordx4 v7, s[12:15], s55 offen offset:3072 nt lds
Mvaa 132,68,116
s_waitcnt lgkmcnt(6)
Ta 44,25,0
Ta 46,25,2048
Mvaa 148,68,120
Mvaa 164,68,124
s_add_u32 m0, s57, 4096
Ra 12,20,6144
Mvaa 56,72,96
buffer_load_dwordx4 v8, s[12:15], s52 offen offset:0 nt lds
Mvaa 72,72,100
Ta 48,26,0
Ta 50,26,2048
Mvaa 88,72,104
Mvaa 104,72,108
Ra 16,20,8192
Mvaa 120,72,112
buffer_load_dwordx4 v9, s[12:15], s53 offen offset:1024 nt lds
Mvaa 136,72,116
s_waitcnt lgkmcnt(6)
Ta 52,27,0
Ta 54,27,2048
Mvaa 152,72,120
Mvaa 168,72,124
Ra 20,20,10240
Mvaa 60,76,96
buffer_load_dwordx4 v8, s[12:15], s54 offen offset:2048 nt lds
Mvaa 76,76,100
Ta 56,28,0
Ta 58,28,2048
Mvaa 92,76,104
Mvaa 108,76,108
Ra 24,20,12288
Mvaa 124,76,112
buffer_load_dwordx4 v9, s[12:15], s55 offen offset:3072 nt lds
Mvaa 140,76,116
s_waitcnt lgkmcnt(6)
Ta 60,29,0
Ta 62,29,2048
Mvaa 156,76,120
v_add_u32 v6, 524288, v6
v_add_u32 v7, 524288, v7
Mvaa 172,76,124
s_add_u32 m0, s56, 0
Ra 28,20,14336
v_add_u32 v8, 524288, v8
Mvaa 176,80,96
buffer_load_dwordx4 v2, s[8:11], s48 offen offset:0 lds
Mvaa 192,80,100
v_add_u32 v9, 524288, v9
Mvaa 208,80,104
Mvaa 224,80,108
Mvaa 240,80,112
buffer_load_dwordx4 v3, s[8:11], s49 offen offset:1024 lds
Maaa 128,80,116
Maaa 144,80,120
Maaa 160,80,124
Mvaa 180,84,96
buffer_load_dwordx4 v2, s[8:11], s50 offen offset:2048 lds
Mvaa 196,84,100
Mvaa 212,84,104
Mvaa 228,84,108
Mvaa 244,84,112
buffer_load_dwordx4 v3, s[8:11], s51 offen offset:3072 lds
Maaa 132,84,116
Maaa 148,84,120
Maaa 164,84,124
s_add_u32 m0, s56, 4096
Mvaa 184,88,96
buffer_load_dwordx4 v4, s[8:11], s48 offen offset:0 lds
Mvaa 200,88,100
Mvaa 216,88,104
Mvaa 232,88,108
Mvaa 248,88,112
buffer_load_dwordx4 v5, s[8:11], s49 offen offset:1024 lds
Maaa 136,88,116
Maaa 152,88,120
Maaa 168,88,124
Mvaa 188,92,96
buffer_load_dwordx4 v4, s[8:11], s50 offen offset:2048 lds
Mvaa 204,92,100
Mvaa 220,92,104
Mvaa 236,92,108
Mvaa 252,92,112
buffer_load_dwordx4 v5, s[8:11], s51 offen offset:3072 lds
Maaa 140,92,116
v_add_u32 v2, 128, v2
v_add_u32 v3, 128, v3
Maaa 156,92,120
buffer_load_dword v1, v47, s[60:63], 0 offen
v_add_u32 v4, 128, v4
v_add_u32 v5, 128, v5
Maaa 172,92,124
v_add_u32 v47, s59, v47
s_waitcnt lgkmcnt(0)
Mvaa 48,0,32
s_getpc_b64 s[6:7]
L_cpf3:
s_add_u32 s6, s6, (L_phase2-L_cpf3)&0xffffffff
s_addc_u32 s7, s7, ((L_phase2-L_cpf3)>>32)&0xffffffff
Mvaa 64,0,36
Ta 96,22,16384
Ta 98,22,18432
Mvaa 80,0,40
s_lshr_b32 s3, s2, 3
s_lshl_b32 s3, s3, 2
s_add_u32 s3, s3, s32
Mvaa 96,0,44
Ra 64,21,0
Mvaa 112,0,48
s_lshl_b32 s3, s3, 10
v_and_b32 v42, 7, v0
v_lshlrev_b32 v42, 7, v42
Mvaa 128,0,52
Ta 100,23,16384
Ta 102,23,18432
Mvaa 144,0,56
v_add_u32 v42, s3, v42
v_min_u32 v42, L_k2_end-L_phase2-4, v42
Mvaa 160,0,60
s_waitcnt lgkmcnt(6)
Ra 68,21,2048
Mvaa 52,4,32
v_mov_b32 v41, s7
Mvaa 68,4,36
Ta 104,24,16384
Ta 106,24,18432
Mvaa 84,4,40
v_add_co_u32 v40, vcc, s6, v42
s_nop 1
v_addc_co_u32 v41, vcc, 0, v41, vcc
Mvaa 100,4,44
Ra 72,21,4096
Mvaa 116,4,48
global_load_dword v44, v[40:41], off
Mvaa 132,4,52
Ta 108,25,16384
Ta 110,25,18432
Mvaa 148,4,56
Mvaa 164,4,60
s_waitcnt lgkmcnt(6)
Ra 76,21,6144
Mvaa 56,8,32
Mvaa 72,8,36
Ta 112,26,16384
Ta 114,26,18432
Mvaa 88,8,40
Mvaa 104,8,44
Ra 80,21,8192
Mvaa 120,8,48
Mvaa 136,8,52
Ta 116,27,16384
Ta 118,27,18432
Mvaa 152,8,56
Mvaa 168,8,60
s_waitcnt lgkmcnt(6)
Ra 84,21,10240
Mvaa 60,12,32
Mvaa 76,12,36
Ta 120,28,16384
Ta 122,28,18432
Mvaa 92,12,40
Mvaa 108,12,44
Ra 88,21,12288
Mvaa 124,12,48
Mvaa 140,12,52
Ta 124,29,16384
Ta 126,29,18432
Mvaa 156,12,56
Mvaa 172,12,60
s_waitcnt lgkmcnt(6)
Ra 92,21,14336
Mvaa 176,16,32
Mvaa 192,16,36
Mvaa 208,16,40
Mvaa 224,16,44
Mvaa 240,16,48
Maaa 128,16,52
Maaa 144,16,56
Maaa 160,16,60
Mvaa 180,20,32
Mvaa 196,20,36
Mvaa 212,20,40
Mvaa 228,20,44
Mvaa 244,20,48
Maaa 132,20,52
Maaa 148,20,56
Maaa 164,20,60
Mvaa 184,24,32
Mvaa 200,24,36
Mvaa 216,24,40
Mvaa 232,24,44
Mvaa 248,24,48
Maaa 136,24,52
Maaa 152,24,56
Maaa 168,24,60
Mvaa 188,28,32
Mvaa 204,28,36
Mvaa 220,28,40
Mvaa 236,28,44
Mvaa 252,28,48
Maaa 140,28,52
Maaa 156,28,56
Maaa 172,28,60
s_waitcnt vmcnt(2) lgkmcnt(0)
s_add_u32 m0, s57, 65536
s_barrier
Mvaa 48,64,96
buffer_load_dwordx4 v6, s[12:15], s52 offen offset:0 nt lds
Mvaa 64,64,100
Ta 32,12,0
Ta 34,12,2048
Mvaa 80,64,104
Mvaa 96,64,108
Ra 0,10,0
Mvaa 112,64,112
buffer_load_dwordx4 v7, s[12:15], s53 offen offset:1024 nt lds
Mvaa 128,64,116
s_waitcnt lgkmcnt(6)
Ta 36,13,0
Ta 38,13,2048
Mvaa 144,64,120
Mvaa 160,64,124
Ra 4,10,2048
Mvaa 52,68,96
buffer_load_dwordx4 v6, s[12:15], s54 offen offset:2048 nt lds
Mvaa 68,68,100
Ta 40,14,0
Ta 42,14,2048
Mvaa 84,68,104
Mvaa 100,68,108
Ra 8,10,4096
Mvaa 116,68,112
buffer_load_dwordx4 v7, s[12:15], s55 offen offset:3072 nt lds
Mvaa 132,68,116
s_waitcnt lgkmcnt(6)
Ta 44,15,0
Ta 46,15,2048
Mvaa 148,68,120
Mvaa 164,68,124
s_add_u32 m0, s57, 69632
Ra 12,10,6144
Mvaa 56,72,96
buffer_load_dwordx4 v8, s[12:15], s52 offen offset:0 nt lds
Mvaa 72,72,100
Ta 48,16,0
Ta 50,16,2048
Mvaa 88,72,104
Mvaa 104,72,108
Ra 16,10,8192
Mvaa 120,72,112
buffer_load_dwordx4 v9, s[12:15], s53 offen offset:1024 nt lds
Mvaa 136,72,116
s_waitcnt lgkmcnt(6)
Ta 52,17,0
Ta 54,17,2048
Mvaa 152,72,120
Mvaa 168,72,124
Ra 20,10,10240
Mvaa 60,76,96
buffer_load_dwordx4 v8, s[12:15], s54 offen offset:2048 nt lds
Mvaa 76,76,100
Ta 56,18,0
Ta 58,18,2048
Mvaa 92,76,104
Mvaa 108,76,108
Ra 24,10,12288
Mvaa 124,76,112
buffer_load_dwordx4 v9, s[12:15], s55 offen offset:3072 nt lds
Mvaa 140,76,116
s_waitcnt lgkmcnt(6)
Ta 60,19,0
Ta 62,19,2048
Mvaa 156,76,120
v_add_u32 v6, 524288, v6
v_add_u32 v7, 524288, v7
Mvaa 172,76,124
s_add_u32 m0, s56, 65536
Ra 28,10,14336
v_add_u32 v8, 524288, v8
Mvaa 176,80,96
buffer_load_dwordx4 v2, s[8:11], s48 offen offset:0 lds
Mvaa 192,80,100
v_add_u32 v9, 524288, v9
Mvaa 208,80,104
Mvaa 224,80,108
Mvaa 240,80,112
buffer_load_dwordx4 v3, s[8:11], s49 offen offset:1024 lds
Maaa 128,80,116
Maaa 144,80,120
Maaa 160,80,124
Mvaa 180,84,96
buffer_load_dwordx4 v2, s[8:11], s50 offen offset:2048 lds
Mvaa 196,84,100
Mvaa 212,84,104
Mvaa 228,84,108
Mvaa 244,84,112
buffer_load_dwordx4 v3, s[8:11], s51 offen offset:3072 lds
Maaa 132,84,116
Maaa 148,84,120
Maaa 164,84,124
s_add_u32 m0, s56, 69632
Mvaa 184,88,96
buffer_load_dwordx4 v4, s[8:11], s48 offen offset:0 lds
Mvaa 200,88,100
Mvaa 216,88,104
Mvaa 232,88,108
Mvaa 248,88,112
buffer_load_dwordx4 v5, s[8:11], s49 offen offset:1024 lds
Maaa 136,88,116
Maaa 152,88,120
Maaa 168,88,124
Mvaa 188,92,96
buffer_load_dwordx4 v4, s[8:11], s50 offen offset:2048 lds
Mvaa 204,92,100
Mvaa 220,92,104
Mvaa 236,92,108
Mvaa 252,92,112
buffer_load_dwordx4 v5, s[8:11], s51 offen offset:3072 lds
Maaa 140,92,116
v_add_u32 v2, 128, v2
v_add_u32 v3, 128, v3
Maaa 156,92,120
v_add_u32 v4, 128, v4
v_add_u32 v5, 128, v5
Maaa 172,92,124
s_waitcnt lgkmcnt(0)
Mvaa 48,0,32
buffer_load_dword v30, v31, s[28:31], s37 offen sc1
Mvaa 64,0,36
Ta 96,12,16384
Ta 98,12,18432
Mvaa 80,0,40
s_mov_b32 s8, s60
s_mov_b32 s9, s61
s_mov_b32 s10, s62
Mvaa 96,0,44
Ra 64,11,0
Mvaa 112,0,48
s_mov_b32 s48, 0
s_mov_b32 s49, 31744
s_mov_b32 s50, 63488
Mvaa 128,0,52
Ta 100,13,16384
Ta 102,13,18432
Mvaa 144,0,56
s_mov_b32 s51, 95232
v_lshlrev_b32 v35, 13, v34
v_lshl_add_u32 v8, v36, 4, v35
Mvaa 160,0,60
s_waitcnt lgkmcnt(6)
Ra 68,11,2048
Mvaa 52,4,32
v_lshl_add_u32 v9, v37, 4, v35
v_lshlrev_b32 v2, 4, v0
Mvaa 68,4,36
Ta 104,14,16384
Ta 106,14,18432
Mvaa 84,4,40
v_add_u32 v3, 65536, v2
v_add_u32 v4, s44, v2
Mvaa 100,4,44
Ra 72,11,4096
Mvaa 116,4,48
v_mov_b32 v7, 0
v_lshlrev_b32 v35, 2, v32
Mvaa 132,4,52
Ta 108,15,16384
Ta 110,15,18432
Mvaa 148,4,56
v_sub_u32 v35, v33, v35
Mvaa 164,4,60
s_waitcnt lgkmcnt(6)
Ra 76,11,6144
Mvaa 56,8,32
s_lshl_b32 s3, s45, 5
v_add_u32 v5, s3, v35
Mvaa 72,8,36
Ta 112,16,16384
Ta 114,16,18432
Mvaa 88,8,40
s_lshl_b32 s3, s46, 5
v_add_u32 v6, s3, v35
Mvaa 104,8,44
Ra 80,11,8192
Mvaa 120,8,48
s_mul_i32 s3, s33, 1116160
s_add_u32 s3, s3, 8388608
s_add_u32 s12, s66, s3
s_addc_u32 s13, s67, 0
s_and_b32 s13, s13, 0xffff
Mvaa 136,8,52
Ta 116,17,16384
Ta 118,17,18432
Mvaa 152,8,56
s_mov_b32 s14, 0
s_mov_b32 s15, 0x20000
s_mul_i32 s14, s36, 34816
Mvaa 168,8,60
s_waitcnt lgkmcnt(6)
Ra 84,11,10240
Mvaa 60,12,32
Mvaa 76,12,36
Ta 120,18,16384
Ta 122,18,18432
Mvaa 92,12,40
Mvaa 108,12,44
Ra 88,11,12288
Mvaa 124,12,48
Mvaa 140,12,52
Ta 124,19,16384
Ta 126,19,18432
Mvaa 156,12,56
Mvaa 172,12,60
s_waitcnt lgkmcnt(6)
Ra 92,11,14336
Mvaa 176,16,32
Mvaa 192,16,36
Mvaa 208,16,40
Mvaa 224,16,44
Mvaa 240,16,48
Maaa 128,16,52
Maaa 144,16,56
Maaa 160,16,60
Mvaa 180,20,32
Mvaa 196,20,36
Mvaa 212,20,40
Mvaa 228,20,44
Mvaa 244,20,48
Maaa 132,20,52
Maaa 148,20,56
Maaa 164,20,60
Mvaa 184,24,32
Mvaa 200,24,36
Mvaa 216,24,40
Mvaa 232,24,44
Mvaa 248,24,48
Maaa 136,24,52
Maaa 152,24,56
Maaa 168,24,60
Mvaa 188,28,32
Mvaa 204,28,36
Mvaa 220,28,40
Mvaa 236,28,44
Mvaa 252,28,48
Maaa 140,28,52
Maaa 156,28,56
Maaa 172,28,60
s_waitcnt vmcnt(1) lgkmcnt(0)
s_add_u32 m0, s44, 0
s_barrier
Mvaa 48,64,96
buffer_load_dwordx4 v8, s[8:11], s48 offen offset:0 lds
Mvaa 64,64,100
Ta 32,22,0
Ta 34,22,2048
Mvaa 80,64,104
s_mul_i32 s3, s45, 67584
v_add_u32 v10, s3, v2
Mvaa 96,64,108
Ra 0,20,0
Mvaa 112,64,112
buffer_load_dwordx4 v8, s[8:11], s49 offen offset:1024 lds
Mvaa 128,64,116
s_waitcnt lgkmcnt(6)
Ta 36,23,0
Ta 38,23,2048
Mvaa 144,64,120
s_mul_i32 s3, s46, 67584
v_add_u32 v11, s3, v2
Mvaa 160,64,124
Ra 4,20,2048
Mvaa 52,68,96
buffer_load_dwordx4 v9, s[8:11], s50 offen offset:2048 lds
Mvaa 68,68,100
Ta 40,24,0
Ta 42,24,2048
Mvaa 84,68,104
Mvaa 100,68,108
Ra 8,20,4096
Mvaa 116,68,112
buffer_load_dwordx4 v9, s[8:11], s51 offen offset:3072 lds
Mvaa 132,68,116
s_waitcnt lgkmcnt(6)
Ta 44,25,0
Ta 46,25,2048
Mvaa 148,68,120
v_add_u32 v8, 524288, v8
v_add_u32 v9, 524288, v9
Mvaa 164,68,124
s_add_u32 m0, s44, 16384
Ra 12,20,6144
Mvaa 56,72,96
buffer_load_dwordx4 v8, s[8:11], s48 offen offset:0 lds
Mvaa 72,72,100
Ta 48,26,0
Ta 50,26,2048
Mvaa 88,72,104
Mvaa 104,72,108
Ra 16,20,8192
Mvaa 120,72,112
buffer_load_dwordx4 v8, s[8:11], s49 offen offset:1024 lds
Mvaa 136,72,116
s_waitcnt lgkmcnt(6)
Ta 52,27,0
Ta 54,27,2048
Mvaa 152,72,120
Mvaa 168,72,124
Ra 20,20,10240
Mvaa 60,76,96
buffer_load_dwordx4 v9, s[8:11], s50 offen offset:2048 lds
Mvaa 76,76,100
Ta 56,28,0
Ta 58,28,2048
Mvaa 92,76,104
Mvaa 108,76,108
Ra 24,20,12288
Mvaa 124,76,112
buffer_load_dwordx4 v9, s[8:11], s51 offen offset:3072 lds
Mvaa 140,76,116
s_waitcnt lgkmcnt(6)
Ta 60,29,0
Ta 62,29,2048
Mvaa 156,76,120
v_add_u32 v8, 524288, v8
v_add_u32 v9, 524288, v9
Mvaa 172,76,124
s_add_u32 m0, s44, 32768
Ra 28,20,14336
Mvaa 176,80,96
buffer_load_dwordx4 v8, s[8:11], s48 offen offset:0 lds
Mvaa 192,80,100
Mvaa 208,80,104
Mvaa 224,80,108
Mvaa 240,80,112
buffer_load_dwordx4 v8, s[8:11], s49 offen offset:1024 lds
Maaa 128,80,116
Maaa 144,80,120
Maaa 160,80,124
Mvaa 180,84,96
buffer_load_dwordx4 v9, s[8:11], s50 offen offset:2048 lds
Mvaa 196,84,100
Mvaa 212,84,104
Mvaa 228,84,108
Mvaa 244,84,112
buffer_load_dwordx4 v9, s[8:11], s51 offen offset:3072 lds
Maaa 132,84,116
v_add_u32 v8, 524288, v8
v_add_u32 v9, 524288, v9
Maaa 148,84,120
Maaa 164,84,124
s_add_u32 m0, s44, 49152
Mvaa 184,88,96
buffer_load_dwordx4 v8, s[8:11], s48 offen offset:0 lds
Mvaa 200,88,100
Mvaa 216,88,104
Mvaa 232,88,108
Mvaa 248,88,112
buffer_load_dwordx4 v8, s[8:11], s49 offen offset:1024 lds
Maaa 136,88,116
Maaa 152,88,120
Maaa 168,88,124
Mvaa 188,92,96
buffer_load_dwordx4 v9, s[8:11], s50 offen offset:2048 lds
Mvaa 204,92,100
Mvaa 220,92,104
Mvaa 236,92,108
Mvaa 252,92,112
buffer_load_dwordx4 v9, s[8:11], s51 offen offset:3072 lds
Maaa 140,92,116
v_add_u32 v8, 524288, v8
v_add_u32 v9, 524288, v9
Maaa 156,92,120
Maaa 172,92,124
s_waitcnt lgkmcnt(0)
Mvaa 48,0,32
Mvaa 64,0,36
Ta 96,22,16384
Ta 98,22,18432
Mvaa 80,0,40
Mvaa 96,0,44
Ra 64,21,0
Mvaa 112,0,48
Mvaa 128,0,52
Ta 100,23,16384
Ta 102,23,18432
Mvaa 144,0,56
Mvaa 160,0,60
s_waitcnt lgkmcnt(6)
Ra 68,21,2048
Mvaa 52,4,32
Mvaa 68,4,36
Ta 104,24,16384
Ta 106,24,18432
Mvaa 84,4,40
Mvaa 100,4,44
Ra 72,21,4096
Mvaa 116,4,48
Mvaa 132,4,52
Ta 108,25,16384
Ta 110,25,18432
Mvaa 148,4,56
Mvaa 164,4,60
s_waitcnt lgkmcnt(6)
Ra 76,21,6144
Mvaa 56,8,32
Mvaa 72,8,36
Ta 112,26,16384
Ta 114,26,18432
Mvaa 88,8,40
Mvaa 104,8,44
Ra 80,21,8192
Mvaa 120,8,48
Mvaa 136,8,52
Ta 116,27,16384
Ta 118,27,18432
Mvaa 152,8,56
Mvaa 168,8,60
s_waitcnt lgkmcnt(6)
Ra 84,21,10240
Mvaa 60,12,32
Mvaa 76,12,36
Ta 120,28,16384
Ta 122,28,18432
Mvaa 92,12,40
Mvaa 108,12,44
Ra 88,21,12288
Mvaa 124,12,48
Mvaa 140,12,52
Ta 124,29,16384
Ta 126,29,18432
Mvaa 156,12,56
Mvaa 172,12,60
s_waitcnt lgkmcnt(6)
Ra 92,21,14336
Mvaa 176,16,32
Mvaa 192,16,36
Mvaa 208,16,40
Mvaa 224,16,44
Mvaa 240,16,48
Maaa 128,16,52
Maaa 144,16,56
Maaa 160,16,60
Mvaa 180,20,32
Mvaa 196,20,36
Mvaa 212,20,40
Mvaa 228,20,44
Mvaa 244,20,48
Maaa 132,20,52
Maaa 148,20,56
Maaa 164,20,60
Mvaa 184,24,32
Mvaa 200,24,36
Mvaa 216,24,40
Mvaa 232,24,44
Mvaa 248,24,48
Maaa 136,24,52
Maaa 152,24,56
Maaa 168,24,60
Mvaa 188,28,32
Mvaa 204,28,36
Mvaa 220,28,40
Mvaa 236,28,44
Mvaa 252,28,48
Maaa 140,28,52
Maaa 156,28,56
Maaa 172,28,60
s_waitcnt vmcnt(12) lgkmcnt(0)
v_readfirstlane_b32 s3, v30
s_nop 0
s_or_b32 s3, s3, s37
s_cmp_lt_u32 s3, 256
s_cbranch_scc1 L_spinAv
L_spinArv:
s_barrier
Mvaa 48,64,96
buffer_load_dwordx4 a[0:3], v10, s[20:23], 0 offen offset:0 sc1
Mvaa 52,68,96
v_lshrrev_b32 v42, 2, v33
v_lshl_add_u32 v43, v32, 3, v42
Mvaa 56,72,96
v_lshlrev_b32 v43, 8, v43
v_and_b32 v44, 3, v0
Mvaa 60,76,96
v_lshl_add_u32 v43, v44, 3, v43
v_and_b32 v44, 1, v32
Mvaa 64,64,100
buffer_load_dwordx4 a[4:7], v10, s[20:23], s58 offen offset:0 sc1
Mvaa 68,68,100
v_lshl_add_u32 v42, v44, 2, v42
v_xor_b32 v44, 0, v42
Mvaa 72,72,100
v_lshl_add_u32 v16, v44, 5, v43
v_xor_b32 v44, 1, v42
Mvaa 76,76,100
v_lshl_add_u32 v17, v44, 5, v43
v_xor_b32 v44, 2, v42
Mvaa 80,64,104
buffer_load_dwordx4 a[8:11], v11, s[20:23], 0 offen offset:0 sc1
Mvaa 84,68,104
v_lshl_add_u32 v18, v44, 5, v43
v_xor_b32 v44, 3, v42
Mvaa 88,72,104
v_lshl_add_u32 v19, v44, 5, v43
v_xor_b32 v44, 4, v42
Mvaa 92,76,104
v_lshl_add_u32 v20, v44, 5, v43
v_xor_b32 v44, 5, v42
Mvaa 96,64,108
buffer_load_dwordx4 a[12:15], v11, s[20:23], s58 offen offset:0 sc1
Mvaa 100,68,108
v_lshl_add_u32 v21, v44, 5, v43
v_xor_b32 v44, 6, v42
Mvaa 104,72,108
v_lshl_add_u32 v22, v44, 5, v43
v_xor_b32 v44, 7, v42
Mvaa 108,76,108
v_lshl_add_u32 v23, v44, 5, v43
Mvaa 112,64,112
buffer_load_dwordx4 a[16:19], v10, s[20:23], 0 offen offset:1024 sc1
Mvaa 116,68,112
Mvaa 120,72,112
Mvaa 124,76,112
Mvaa 128,64,116
buffer_load_dwordx4 a[20:23], v10, s[20:23], s58 offen offset:1024 sc1
Mvaa 132,68,116
Ta 192,16,0
Ta 194,16,1024
Mvaa 136,72,116
Ta 196,17,0
Ta 198,17,1024
Mvaa 140,76,116
Ta 200,18,0
Ta 202,18,1024
Mvaa 144,64,120
buffer_load_dwordx4 a[24:27], v11, s[20:23], 0 offen offset:1024 sc1
Mvaa 148,68,120
Ta 204,19,0
Ta 206,19,1024
Mvaa 152,72,120
Ta 208,20,0
Ta 210,20,1024
Mvaa 156,76,120
Ta 212,21,0
Ta 214,21,1024
Mvaa 160,64,124
buffer_load_dwordx4 a[28:31], v11, s[20:23], s58 offen offset:1024 sc1
Mvaa 164,68,124
Ta 216,22,0
Ta 218,22,1024
Mvaa 168,72,124
Ta 220,23,0
s_waitcnt lgkmcnt(9)
Ta 222,23,1024
Mvaa 172,76,124
s_waitcnt lgkmcnt(8)
Vc 24,48,49
Vc 25,50,51
Mvaa 176,80,96
buffer_load_dwordx4 a[32:35], v10, s[20:23], 0 offen offset:2048 sc1
Mvaa 180,84,96
Vc 26,52,53
Vc 27,54,55
Mvaa 184,88,96
Vc 28,56,57
Vc 29,58,59
Mvaa 188,92,96
Vc 30,60,61
Vc 31,62,63
Mvaa 192,80,100
buffer_load_dwordx4 a[36:39], v10, s[20:23], s58 offen offset:2048 sc1
Mvaa 196,84,100
Vc 32,64,65
Vc 33,66,67
Mvaa 200,88,100
Vc 34,68,69
Vc 35,70,71
Mvaa 204,92,100
Vc 36,72,73
Vc 37,74,75
Mvaa 208,80,104
buffer_load_dwordx4 a[40:43], v11, s[20:23], 0 offen offset:2048 sc1
Mvaa 212,84,104
Vc 38,76,77
Vc 39,78,79
Mvaa 216,88,104
Vc 40,80,81
Vc 41,82,83
Mvaa 220,92,104
Vc 42,84,85
Vc 43,86,87
Mvaa 224,80,108
buffer_load_dwordx4 a[44:47], v11, s[20:23], s58 offen offset:2048 sc1
Mvaa 228,84,108
Vc 44,88,89
Vc 45,90,91
Mvaa 232,88,108
Vc 46,92,93
Vc 47,94,95
Mvaa 236,92,108
Vc 48,96,97
Vc 49,98,99
Mvaa 240,80,112
buffer_load_dwordx4 a[48:51], v10, s[20:23], 0 offen offset:3072 sc1
Mvaa 244,84,112
Vc 50,100,101
Vc 51,102,103
Mvaa 248,88,112
Vc 52,104,105
Vc 53,106,107
Mvaa 252,92,112
Vc 54,108,109
Vc 55,110,111
Maaa 128,80,116
buffer_load_dwordx4 a[52:55], v10, s[20:23], s58 offen offset:3072 sc1
Maaa 132,84,116
Vc 56,112,113
Vc 57,114,115
Maaa 136,88,116
Vc 58,116,117
Vc 59,118,119
Maaa 140,92,116
Vc 60,120,121
Vc 61,122,123
Maaa 144,80,120
buffer_load_dwordx4 a[56:59], v11, s[20:23], 0 offen offset:3072 sc1
Maaa 148,84,120
Vc 62,124,125
Vc 63,126,127
Maaa 152,88,120
Vc 64,128,129
Vc 65,130,131
Maaa 156,92,120
Vc 66,132,133
Vc 67,134,135
Maaa 160,80,124
buffer_load_dwordx4 a[60:63], v11, s[20:23], s58 offen offset:3072 sc1
Maaa 164,84,124
v_add_u32 v10, 4096, v10
v_add_u32 v11, 4096, v11
Maaa 168,88,124
Vc 68,136,137
Vc 69,138,139
Maaa 172,92,124
Vc 70,140,141
Vc 71,142,143
Vc 72,144,145
Vc 73,146,147
Vc 74,148,149
Vc 75,150,151
Vc 76,152,153
Vc 77,154,155
Vc 78,156,157
Vc 79,158,159
Vc 80,160,161
Vc 81,162,163
Vc 82,164,165
Vc 83,166,167
Vc 84,168,169
Vc 85,170,171
Vc 86,172,173
Vc 87,174,175
Vc 88,176,177
Vc 89,178,179
Vc 90,180,181
Vc 91,182,183
Vc 92,184,185
Vc 93,186,187
Vc 94,188,189
Vc 95,190,191
Vc 96,192,193
Vc 97,194,195
Vc 98,196,197
Vc 99,198,199
Vc 100,200,201
Vc 101,202,203
Vc 102,204,205
Vc 103,206,207
Vc 104,208,209
Vc 105,210,211
Vc 106,212,213
Vc 107,214,215
Vc 108,216,217
Vc 109,218,219
Vc 110,220,221
Vc 111,222,223
Vc 112,224,225
Vc 113,226,227
Vc 114,228,229
Vc 115,230,231
Vc 116,232,233
Vc 117,234,235
Vc 118,236,237
Vc 119,238,239
Vc 120,240,241
Vc 121,242,243
Vc 122,244,245
Vc 123,246,247
Vc 124,248,249
Vc 125,250,251
Vc 126,252,253
Vc 127,254,255
L_phase2:
s_nop 7
s_waitcnt vmcnt(12) lgkmcnt(0)
Zvaa 128,192,0
s_add_u32 s37, s38, 0
Zvaa 132,192,4
Ta 224,16,8192
Ta 226,16,9216
Zvaa 136,192,8
buffer_load_dwordx4 a[64:67], v10, s[20:23], 0 offen offset:0 sc1
Zvaa 140,192,12
buffer_store_dwordx4 v[24:27], v2, s[24:27], s37 offen offset:0 sc1
Zvaa 144,196,0
Ta 228,17,8192
Ta 230,17,9216
Zvaa 148,196,4
buffer_load_dwordx4 a[68:71], v10, s[20:23], s58 offen offset:0 sc1
Zvaa 152,196,8
s_mov_b32 s60, s40
s_and_b32 s61, s41, 0xffff
s_mov_b32 s62, 7340032
Zvaa 156,196,12
Ta 232,18,8192
Ta 234,18,9216
Zvaa 160,200,0
s_mov_b32 s63, 0x20000
Zvaa 164,200,4
buffer_load_dwordx4 a[72:75], v11, s[20:23], 0 offen offset:0 sc1
Zvaa 168,200,8
Ta 236,19,8192
Ta 238,19,9216
Zvaa 172,200,12
Zvaa 176,204,0
Zvaa 180,204,4
Ta 240,20,8192
Ta 242,20,9216
Zvaa 184,204,8
buffer_load_dwordx4 a[76:79], v11, s[20:23], s58 offen offset:0 sc1
Zvaa 188,204,12
Zvaa 192,208,0
s_waitcnt lgkmcnt(6)
Ta 244,21,8192
Ta 246,21,9216
Zvaa 196,208,4
buffer_store_dwordx4 v[28:31], v2, s[24:27], s37 offen offset:1024 sc1
Zvaa 200,208,8
buffer_load_dwordx4 a[80:83], v10, s[20:23], 0 offen offset:1024 sc1
Zvaa 204,208,12
Ta 248,22,8192
Ta 250,22,9216
Zvaa 208,212,0
Zvaa 212,212,4
Zvaa 216,212,8
Ta 252,23,8192
Ta 254,23,9216
Zvaa 220,212,12
buffer_load_dwordx4 a[84:87], v10, s[20:23], s58 offen offset:1024 sc1
Zvaa 224,216,0
Zvaa 228,216,4
Zvaa 232,216,8
buffer_load_dwordx4 a[88:91], v11, s[20:23], 0 offen offset:1024 sc1
Zvaa 236,216,12
Zvaa 240,220,0
Zvaa 244,220,4
buffer_load_dwordx4 a[92:95], v11, s[20:23], s58 offen offset:1024 sc1
Zvaa 248,220,8
Zvaa 252,220,12
s_waitcnt vmcnt(18) lgkmcnt(0)
s_barrier
Mvaa 128,224,16
buffer_store_dwordx4 v[32:35], v2, s[24:27], s37 offen offset:2048 sc1
Mvaa 132,224,20
s_add_u32 m0, s44, 0
Ta 192,16,16384
Ta 194,16,17408
Mvaa 136,224,24
buffer_load_dwordx4 v8, s[8:11], s48 offen offset:0 lds
Mvaa 140,224,28
buffer_load_dwordx4 v8, s[8:11], s49 offen offset:1024 lds
Mvaa 144,228,16
Ta 196,17,16384
Ta 198,17,17408
Mvaa 148,228,20
Mvaa 152,228,24
buffer_load_dwordx4 v9, s[8:11], s50 offen offset:2048 lds
Mvaa 156,228,28
Ta 200,18,16384
Ta 202,18,17408
Mvaa 160,232,16
Mvaa 164,232,20
buffer_load_dwordx4 v9, s[8:11], s51 offen offset:3072 lds
v_add_u32 v8, 524288, v8
v_add_u32 v9, 524288, v9
Mvaa 168,232,24
Ta 204,19,16384
Ta 206,19,17408
Mvaa 172,232,28
Mvaa 176,236,16
buffer_load_dwordx4 a[96:99], v10, s[20:23], 0 offen offset:2048 sc1
Mvaa 180,236,20
Ta 208,20,16384
Ta 210,20,17408
Mvaa 184,236,24
Mvaa 188,236,28
buffer_load_dwordx4 a[100:103], v10, s[20:23], s58 offen offset:2048 sc1
Mvaa 192,240,16
s_waitcnt lgkmcnt(6)
Ta 212,21,16384
Ta 214,21,17408
Mvaa 196,240,20
buffer_store_dwordx4 v[36:39], v2, s[24:27], s37 offen offset:3072 sc1
Mvaa 200,240,24
buffer_load_dwordx4 a[104:107], v11, s[20:23], 0 offen offset:2048 sc1
Mvaa 204,240,28
Ta 216,22,16384
Ta 218,22,17408
Mvaa 208,244,16
Mvaa 212,244,20
buffer_load_dwordx4 a[108:111], v11, s[20:23], s58 offen offset:2048 sc1
Mvaa 216,244,24
Ta 220,23,16384
Ta 222,23,17408
Mvaa 220,244,28
Mvaa 224,248,16
buffer_load_dwordx4 a[112:115], v10, s[20:23], 0 offen offset:3072 sc1
Mvaa 228,248,20
Mvaa 232,248,24
buffer_load_dwordx4 a[116:119], v10, s[20:23], s58 offen offset:3072 sc1
Mvaa 236,248,28
Mvaa 240,252,16
buffer_load_dwordx4 a[120:123], v11, s[20:23], 0 offen offset:3072 sc1
Mvaa 244,252,20
Mvaa 248,252,24
buffer_load_dwordx4 a[124:127], v11, s[20:23], s58 offen offset:3072 sc1
v_add_u32 v10, 4096, v10
v_add_u32 v11, 4096, v11
Mvaa 252,252,28
s_waitcnt vmcnt(28) lgkmcnt(0)
Mvaa 128,192,32
s_add_u32 s37, s38, 4096
Mvaa 132,192,36
Ta 224,16,24576
Ta 226,16,25600
Mvaa 136,192,40
buffer_load_dwordx4 a[0:3], v10, s[20:23], 0 offen offset:0 sc1
Mvaa 140,192,44
buffer_store_dwordx4 v[40:43], v2, s[24:27], s37 offen offset:0 sc1
Mvaa 144,196,32
Ta 228,17,24576
Ta 230,17,25600
Mvaa 148,196,36
buffer_load_dwordx4 a[4:7], v10, s[20:23], s58 offen offset:0 sc1
Mvaa 152,196,40
Mvaa 156,196,44
Ta 232,18,24576
Ta 234,18,25600
Mvaa 160,200,32
Mvaa 164,200,36
buffer_load_dwordx4 a[8:11], v11, s[20:23], 0 offen offset:0 sc1
Mvaa 168,200,40
Ta 236,19,24576
Ta 238,19,25600
Mvaa 172,200,44
Mvaa 176,204,32
Mvaa 180,204,36
Ta 240,20,24576
Ta 242,20,25600
Mvaa 184,204,40
buffer_load_dwordx4 a[12:15], v11, s[20:23], s58 offen offset:0 sc1
Mvaa 188,204,44
Mvaa 192,208,32
s_waitcnt lgkmcnt(6)
Ta 244,21,24576
Ta 246,21,25600
Mvaa 196,208,36
buffer_store_dwordx4 v[44:47], v2, s[24:27], s37 offen offset:1024 sc1
Mvaa 200,208,40
buffer_load_dwordx4 a[16:19], v10, s[20:23], 0 offen offset:1024 sc1
Mvaa 204,208,44
Ta 248,22,24576
Ta 250,22,25600
Mvaa 208,212,32
Mvaa 212,212,36
Mvaa 216,212,40
Ta 252,23,24576
Ta 254,23,25600
Mvaa 220,212,44
buffer_load_dwordx4 a[20:23], v10, s[20:23], s58 offen offset:1024 sc1
Mvaa 224,216,32
Mvaa 228,216,36
Mvaa 232,216,40
buffer_load_dwordx4 a[24:27], v11, s[20:23], 0 offen offset:1024 sc1
Mvaa 236,216,44
Mvaa 240,220,32
Mvaa 244,220,36
buffer_load_dwordx4 a[28:31], v11, s[20:23], s58 offen offset:1024 sc1
Mvaa 248,220,40
Mvaa 252,220,44
s_waitcnt vmcnt(34) lgkmcnt(0)
s_barrier
Mvaa 128,224,48
buffer_store_dwordx4 v[48:51], v2, s[24:27], s37 offen offset:2048 sc1
Mvaa 132,224,52
s_add_u32 m0, s44, 16384
Ta 192,16,32768
Ta 194,16,33792
Mvaa 136,224,56
buffer_load_dwordx4 v8, s[8:11], s48 offen offset:0 lds
Mvaa 140,224,60
Mvaa 144,228,48
Ta 196,17,32768
Ta 198,17,33792
Mvaa 148,228,52
buffer_load_dwordx4 v8, s[8:11], s49 offen offset:1024 lds
Mvaa 152,228,56
Mvaa 156,228,60
Ta 200,18,32768
Ta 202,18,33792
Mvaa 160,232,48
Mvaa 164,232,52
buffer_load_dwordx4 v9, s[8:11], s50 offen offset:2048 lds
Mvaa 168,232,56
Ta 204,19,32768
Ta 206,19,33792
Mvaa 172,232,60
Mvaa 176,236,48
Mvaa 180,236,52
Ta 208,20,32768
Ta 210,20,33792
Mvaa 184,236,56
buffer_load_dwordx4 v9, s[8:11], s51 offen offset:3072 lds
v_add_u32 v8, 524288, v8
v_add_u32 v9, 524288, v9
Mvaa 188,236,60
Mvaa 192,240,48
s_waitcnt lgkmcnt(6)
Ta 212,21,32768
Ta 214,21,33792
Mvaa 196,240,52
buffer_store_dwordx4 v[52:55], v2, s[24:27], s37 offen offset:3072 sc1
Mvaa 200,240,56
buffer_load_dwordx4 a[32:35], v10, s[20:23], 0 offen offset:2048 sc1
Mvaa 204,240,60
Ta 216,22,32768
Ta 218,22,33792
Mvaa 208,244,48
Mvaa 212,244,52
Mvaa 216,244,56
Ta 220,23,32768
Ta 222,23,33792
Mvaa 220,244,60
buffer_load_dwordx4 a[36:39], v10, s[20:23], s58 offen offset:2048 sc1
Mvaa 224,248,48
Mvaa 228,248,52
Mvaa 232,248,56
buffer_load_dwordx4 a[40:43], v11, s[20:23], 0 offen offset:2048 sc1
Mvaa 236,248,60
Mvaa 240,252,48
Mvaa 244,252,52
buffer_load_dwordx4 a[44:47], v11, s[20:23], s58 offen offset:2048 sc1
Mvaa 248,252,56
Mvaa 252,252,60
s_waitcnt vmcnt(39) lgkmcnt(0)
Mvaa 128,192,64
s_add_u32 s37, s38, 8192
Mvaa 132,192,68
Ta 224,16,40960
Ta 226,16,41984
Mvaa 136,192,72
buffer_load_dwordx4 a[48:51], v10, s[20:23], 0 offen offset:3072 sc1
Mvaa 140,192,76
buffer_store_dwordx4 v[56:59], v2, s[24:27], s37 offen offset:0 sc1
Mvaa 144,196,64
Ta 228,17,40960
Ta 230,17,41984
Mvaa 148,196,68
Ar 48,128
Ar 49,129
Mvaa 152,196,72
Ar 50,130
Ar 51,131
Mvaa 156,196,76
Ta 232,18,40960
Ta 234,18,41984
Mvaa 160,200,64
Ar 52,132
Ar 53,133
Mvaa 164,200,68
buffer_load_dwordx4 a[52:55], v10, s[20:23], s58 offen offset:3072 sc1
Mvaa 168,200,72
Ta 236,19,40960
Ta 238,19,41984
Mvaa 172,200,76
Ar 54,134
Ar 55,135
Mvaa 176,204,64
Vc 24,48,49
Vc 25,50,51
Mvaa 180,204,68
Ta 240,20,40960
Ta 242,20,41984
Mvaa 184,204,72
Vc 26,52,53
Vc 27,54,55
Mvaa 188,204,76
Mvaa 192,208,64
s_waitcnt lgkmcnt(6)
Ta 244,21,40960
Ta 246,21,41984
Mvaa 196,208,68
buffer_store_dwordx4 v[60:63], v2, s[24:27], s37 offen offset:1024 sc1
Mvaa 200,208,72
buffer_load_dwordx4 a[56:59], v11, s[20:23], 0 offen offset:3072 sc1
Mvaa 204,208,76
Ta 248,22,40960
Ta 250,22,41984
Mvaa 208,212,64
Ar 48,136
Ar 49,137
Mvaa 212,212,68
Ar 50,138
Ar 51,139
Mvaa 216,212,72
Ta 252,23,40960
Ta 254,23,41984
Mvaa 220,212,76
Ar 52,140
Ar 53,141
Mvaa 224,216,64
Ar 54,142
Ar 55,143
Mvaa 228,216,68
Vc 28,48,49
Vc 29,50,51
Mvaa 232,216,72
buffer_load_dwordx4 a[60:63], v11, s[20:23], s58 offen offset:3072 sc1
v_add_u32 v10, 4096, v10
v_add_u32 v11, 4096, v11
Mvaa 236,216,76
Vc 30,52,53
Vc 31,54,55
Mvaa 240,220,64
Mvaa 244,220,68
Mvaa 248,220,72
Mvaa 252,220,76
s_waitcnt vmcnt(40) lgkmcnt(0)
s_barrier
Mvaa 128,224,80
buffer_store_dwordx4 v[64:67], v2, s[24:27], s37 offen offset:2048 sc1
Mvaa 132,224,84
s_add_u32 m0, s44, 32768
Ta 192,16,49152
Ta 194,16,50176
Mvaa 136,224,88
buffer_load_dwordx4 v8, s[8:11], s48 offen offset:0 lds
Mvaa 140,224,92
Ar 48,144
Ar 49,145
Mvaa 144,228,80
Ta 196,17,49152
Ta 198,17,50176
Mvaa 148,228,84
buffer_load_dwordx4 v8, s[8:11], s49 offen offset:1024 lds
Mvaa 152,228,88
Ar 50,146
Ar 51,147
Mvaa 156,228,92
Ta 200,18,49152
Ta 202,18,50176
Mvaa 160,232,80
Ar 52,148
Ar 53,149
Mvaa 164,232,84
buffer_load_dwordx4 v9, s[8:11], s50 offen offset:2048 lds
Mvaa 168,232,88
Ta 204,19,49152
Ta 206,19,50176
Mvaa 172,232,92
Ar 54,150
Ar 55,151
Mvaa 176,236,80
Vc 32,48,49
Vc 33,50,51
Mvaa 180,236,84
Ta 208,20,49152
Ta 210,20,50176
Mvaa 184,236,88
buffer_load_dwordx4 v9, s[8:11], s51 offen offset:3072 lds
v_add_u32 v8, 524288, v8
v_add_u32 v9, 524288, v9
Mvaa 188,236,92
Vc 34,52,53
Vc 35,54,55
Mvaa 192,240,80
s_waitcnt lgkmcnt(6)
Ta 212,21,49152
Ta 214,21,50176
Mvaa 196,240,84
buffer_store_dwordx4 v[68:71], v2, s[24:27], s37 offen offset:3072 sc1
Mvaa 200,240,88
buffer_load_dwordx4 a[64:67], v10, s[20:23], 0 offen offset:0 sc1
Mvaa 204,240,92
Ta 216,22,49152
Ta 218,22,50176
Mvaa 208,244,80
Ar 48,152
Ar 49,153
Mvaa 212,244,84
Ar 50,154
Ar 51,155
Mvaa 216,244,88
Ta 220,23,49152
Ta 222,23,50176
Mvaa 220,244,92
buffer_load_dwordx4 a[68:71], v10, s[20:23], s58 offen offset:0 sc1
Mvaa 224,248,80
Ar 52,156
Ar 53,157
Mvaa 228,248,84
Ar 54,158
Ar 55,159
Mvaa 232,248,88
buffer_load_dwordx4 a[72:75], v11, s[20:23], 0 offen offset:0 sc1
Mvaa 236,248,92
Vc 36,48,49
Vc 37,50,51
Mvaa 240,252,80
Vc 38,52,53
Vc 39,54,55
Mvaa 244,252,84
buffer_load_dwordx4 a[76:79], v11, s[20:23], s58 offen offset:0 sc1
Mvaa 248,252,88
Mvaa 252,252,92
s_waitcnt vmcnt(40) lgkmcnt(0)
Mvaa 128,192,96
s_add_u32 s37, s38, 12288
Mvaa 132,192,100
Ta 224,16,57344
Ta 226,16,58368
Mvaa 136,192,104
buffer_load_dwordx4 a[80:83], v10, s[20:23], 0 offen offset:1024 sc1
Mvaa 140,192,108
buffer_store_dwordx4 v[72:75], v2, s[24:27], s37 offen offset:0 sc1
Mvaa 144,196,96
Ta 228,17,57344
Ta 230,17,58368
Mvaa 148,196,100
Ar 48,160
Ar 49,161
Mvaa 152,196,104
Ar 50,162
Ar 51,163
Mvaa 156,196,108
Ta 232,18,57344
Ta 234,18,58368
Mvaa 160,200,96
Ar 52,164
Ar 53,165
Mvaa 164,200,100
buffer_load_dwordx4 a[84:87], v10, s[20:23], s58 offen offset:1024 sc1
Mvaa 168,200,104
Ta 236,19,57344
Ta 238,19,58368
Mvaa 172,200,108
Ar 54,166
Ar 55,167
Mvaa 176,204,96
Vc 40,48,49
Vc 41,50,51
Mvaa 180,204,100
Ta 240,20,57344
Ta 242,20,58368
Mvaa 184,204,104
Vc 42,52,53
Vc 43,54,55
Mvaa 188,204,108
Mvaa 192,208,96
s_waitcnt lgkmcnt(6)
Ta 244,21,57344
Ta 246,21,58368
Mvaa 196,208,100
buffer_store_dwordx4 v[76:79], v2, s[24:27], s37 offen offset:1024 sc1
Mvaa 200,208,104
buffer_load_dwordx4 a[88:91], v11, s[20:23], 0 offen offset:1024 sc1
Mvaa 204,208,108
Ta 248,22,57344
Ta 250,22,58368
Mvaa 208,212,96
Ar 48,168
Ar 49,169
Mvaa 212,212,100
Ar 50,170
Ar 51,171
Mvaa 216,212,104
Ta 252,23,57344
Ta 254,23,58368
Mvaa 220,212,108
Ar 52,172
Ar 53,173
Mvaa 224,216,96
Ar 54,174
Ar 55,175
Mvaa 228,216,100
Vc 44,48,49
Vc 45,50,51
Mvaa 232,216,104
buffer_load_dwordx4 a[92:95], v11, s[20:23], s58 offen offset:1024 sc1
Mvaa 236,216,108
Vc 46,52,53
Vc 47,54,55
Mvaa 240,220,96
Mvaa 244,220,100
Mvaa 248,220,104
Mvaa 252,220,108
s_waitcnt vmcnt(42) lgkmcnt(0)
s_barrier
Mvaa 128,224,112
buffer_store_dwordx4 v[80:83], v2, s[24:27], s37 offen offset:2048 sc1
Mvaa 132,224,116
s_add_u32 m0, s44, 49152
Ta 192,16,0
Ta 194,16,1024
Mvaa 136,224,120
buffer_load_dwordx4 v8, s[8:11], s48 offen offset:0 lds
Mvaa 140,224,124
Mvaa 144,228,112
Ta 196,17,0
Ta 198,17,1024
Mvaa 148,228,116
buffer_load_dwordx4 v8, s[8:11], s49 offen offset:1024 lds
Mvaa 152,228,120
Mvaa 156,228,124
Ta 200,18,0
Ta 202,18,1024
Mvaa 160,232,112
Mvaa 164,232,116
buffer_load_dwordx4 v9, s[8:11], s50 offen offset:2048 lds
Mvaa 168,232,120
Ta 204,19,0
Ta 206,19,1024
Mvaa 172,232,124
Mvaa 176,236,112
Mvaa 180,236,116
Ta 208,20,0
Ta 210,20,1024
Mvaa 184,236,120
buffer_load_dwordx4 v9, s[8:11], s51 offen offset:3072 lds
v_add_u32 v8, 524288, v8
v_add_u32 v9, 524288, v9
Mvaa 188,236,124
Mvaa 192,240,112
s_waitcnt lgkmcnt(6)
Ta 212,21,0
Ta 214,21,1024
Mvaa 196,240,116
buffer_store_dwordx4 v[84:87], v2, s[24:27], s37 offen offset:3072 sc1
Mvaa 200,240,120
buffer_load_dwordx4 a[96:99], v10, s[20:23], 0 offen offset:2048 sc1
Mvaa 204,240,124
Ta 216,22,0
Ta 218,22,1024
Mvaa 208,244,112
Mvaa 212,244,116
Mvaa 216,244,120
Ta 220,23,0
Ta 222,23,1024
Mvaa 220,244,124
buffer_load_dwordx4 a[100:103], v10, s[20:23], s58 offen offset:2048 sc1
Mvaa 224,248,112
Mvaa 228,248,116
Mvaa 232,248,120
buffer_load_dwordx4 a[104:107], v11, s[20:23], 0 offen offset:2048 sc1
Mvaa 236,248,124
Mvaa 240,252,112
Mvaa 244,252,116
buffer_load_dwordx4 a[108:111], v11, s[20:23], s58 offen offset:2048 sc1
Mvaa 248,252,120
Mvaa 252,252,124
s_waitcnt vmcnt(47) lgkmcnt(0)
Mvaa 128,192,0
s_add_u32 s37, s38, 34816
Mvaa 132,192,4
Ta 224,16,8192
Ta 226,16,9216
Mvaa 136,192,8
buffer_load_dwordx4 a[112:115], v10, s[20:23], 0 offen offset:3072 sc1
Mvaa 140,192,12
buffer_store_dwordx4 v[88:91], v2, s[24:27], s37 offen offset:0 sc1
Mvaa 144,196,0
Ta 228,17,8192
Ta 230,17,9216
Mvaa 148,196,4
Mvaa 152,196,8
Mvaa 156,196,12
Ta 232,18,8192
Ta 234,18,9216
Mvaa 160,200,0
Mvaa 164,200,4
buffer_load_dwordx4 a[116:119], v10, s[20:23], s58 offen offset:3072 sc1
Mvaa 168,200,8
Ta 236,19,8192
Ta 238,19,9216
Mvaa 172,200,12
Mvaa 176,204,0
Mvaa 180,204,4
Ta 240,20,8192
Ta 242,20,9216
Mvaa 184,204,8
Mvaa 188,204,12
Mvaa 192,208,0
s_waitcnt lgkmcnt(6)
Ta 244,21,8192
Ta 246,21,9216
Mvaa 196,208,4
buffer_store_dwordx4 v[92:95], v2, s[24:27], s37 offen offset:1024 sc1
Mvaa 200,208,8
buffer_load_dwordx4 a[120:123], v11, s[20:23], 0 offen offset:3072 sc1
Mvaa 204,208,12
Ta 248,22,8192
Ta 250,22,9216
Mvaa 208,212,0
s_mov_b32 s3, 5242880
s_mov_b32 s47, 5246976
Mvaa 212,212,4
buffer_load_dwordx4 v[56:59], v2, s[20:23], s3 offen offset:0 sc1
Mvaa 216,212,8
Ta 252,23,8192
Ta 254,23,9216
Mvaa 220,212,12
buffer_load_dwordx4 v[60:63], v2, s[20:23], s3 offen offset:1024 sc1
Mvaa 224,216,0
buffer_load_dwordx4 v[64:67], v2, s[20:23], s3 offen offset:2048 sc1
Mvaa 228,216,4
buffer_load_dwordx4 v[68:71], v2, s[20:23], s3 offen offset:3072 sc1
Mvaa 232,216,8
buffer_load_dwordx4 a[124:127], v11, s[20:23], s58 offen offset:3072 sc1
v_add_u32 v10, 4096, v10
v_add_u32 v11, 4096, v11
Mvaa 236,216,12
buffer_load_dwordx4 v[72:75], v2, s[20:23], s47 offen offset:0 sc1
Mvaa 240,220,0
buffer_load_dwordx4 v[76:79], v2, s[20:23], s47 offen offset:1024 sc1
Mvaa 244,220,4
buffer_load_dwordx4 v[80:83], v2, s[20:23], s47 offen offset:2048 sc1
Mvaa 248,220,8
buffer_load_dwordx4 v[84:87], v2, s[20:23], s47 offen offset:3072 sc1
Mvaa 252,220,12
s_waitcnt vmcnt(51) lgkmcnt(0)
s_barrier
Mvaa 128,224,16
buffer_store_dwordx4 v[96:99], v2, s[24:27], s37 offen offset:2048 sc1
Mvaa 132,224,20
s_add_u32 m0, s44, 0
Ta 192,16,16384
Ta 194,16,17408
Mvaa 136,224,24
buffer_load_dwordx4 v8, s[8:11], s48 offen offset:0 lds
Mvaa 140,224,28
Mvaa 144,228,16
Ta 196,17,16384
Ta 198,17,17408
Mvaa 148,228,20
buffer_load_dwordx4 v8, s[8:11], s49 offen offset:1024 lds
Mvaa 152,228,24
Mvaa 156,228,28
Ta 200,18,16384
Ta 202,18,17408
Mvaa 160,232,16
Mvaa 164,232,20
buffer_load_dwordx4 v9, s[8:11], s50 offen offset:2048 lds
Mvaa 168,232,24
Ta 204,19,16384
Ta 206,19,17408
Mvaa 172,232,28
Mvaa 176,236,16
Mvaa 180,236,20
Ta 208,20,16384
Ta 210,20,17408
Mvaa 184,236,24
buffer_load_dwordx4 v9, s[8:11], s51 offen offset:3072 lds
v_add_u32 v8, 524288, v8
v_add_u32 v9, 524288, v9
Mvaa 188,236,28
Mvaa 192,240,16
s_waitcnt lgkmcnt(6)
Ta 212,21,16384
Ta 214,21,17408
Mvaa 196,240,20
buffer_store_dwordx4 v[100:103], v2, s[24:27], s37 offen offset:3072 sc1
Mvaa 200,240,24
buffer_load_dwordx4 a[0:3], v10, s[20:23], 0 offen offset:0 sc1
Mvaa 204,240,28
Ta 216,22,16384
Ta 218,22,17408
Mvaa 208,244,16
Mvaa 212,244,20
Mvaa 216,244,24
Ta 220,23,16384
Ta 222,23,17408
Mvaa 220,244,28
buffer_load_dwordx4 a[4:7], v10, s[20:23], s58 offen offset:0 sc1
Mvaa 224,248,16
Mvaa 228,248,20
Mvaa 232,248,24
buffer_load_dwordx4 a[8:11], v11, s[20:23], 0 offen offset:0 sc1
Mvaa 236,248,28
Mvaa 240,252,16
Mvaa 244,252,20
buffer_load_dwordx4 a[12:15], v11, s[20:23], s58 offen offset:0 sc1
Mvaa 248,252,24
Mvaa 252,252,28
s_waitcnt vmcnt(56) lgkmcnt(0)
Mvaa 128,192,32
s_add_u32 s37, s38, 38912
Mvaa 132,192,36
Ta 224,16,24576
Ta 226,16,25600
Mvaa 136,192,40
buffer_load_dwordx4 a[16:19], v10, s[20:23], 0 offen offset:1024 sc1
Mvaa 140,192,44
buffer_store_dwordx4 v[104:107], v2, s[24:27], s37 offen offset:0 sc1
Mvaa 144,196,32
Ta 228,17,24576
Ta 230,17,25600
Mvaa 148,196,36
Mvaa 152,196,40
Mvaa 156,196,44
Ta 232,18,24576
Ta 234,18,25600
Mvaa 160,200,32
Mvaa 164,200,36
buffer_load_dwordx4 a[20:23], v10, s[20:23], s58 offen offset:1024 sc1
Mvaa 168,200,40
Ta 236,19,24576
Ta 238,19,25600
Mvaa 172,200,44
Mvaa 176,204,32
Mvaa 180,204,36
Ta 240,20,24576
Ta 242,20,25600
Mvaa 184,204,40
Mvaa 188,204,44
Mvaa 192,208,32
s_waitcnt lgkmcnt(6)
Ta 244,21,24576
Ta 246,21,25600
Mvaa 196,208,36
buffer_store_dwordx4 v[108:111], v2, s[24:27], s37 offen offset:1024 sc1
Mvaa 200,208,40
buffer_load_dwordx4 a[24:27], v11, s[20:23], 0 offen offset:1024 sc1
Mvaa 204,208,44
Ta 248,22,24576
Ta 250,22,25600
Mvaa 208,212,32
Mvaa 212,212,36
Mvaa 216,212,40
Ta 252,23,24576
Ta 254,23,25600
Mvaa 220,212,44
Mvaa 224,216,32
Mvaa 228,216,36
Mvaa 232,216,40
buffer_load_dwordx4 a[28:31], v11, s[20:23], s58 offen offset:1024 sc1
Mvaa 236,216,44
Mvaa 240,220,32
Mvaa 244,220,36
Mvaa 248,220,40
Mvaa 252,220,44
s_waitcnt vmcnt(51) lgkmcnt(0)
s_barrier
Mvaa 128,224,48
buffer_store_dwordx4 v[112:115], v2, s[24:27], s37 offen offset:2048 sc1
Mvaa 132,224,52
s_add_u32 m0, s44, 16384
Ta 192,16,32768
Ta 194,16,33792
Mvaa 136,224,56
buffer_load_dwordx4 v8, s[8:11], s48 offen offset:0 lds
Mvaa 140,224,60
Mvaa 144,228,48
Ta 196,17,32768
Ta 198,17,33792
Mvaa 148,228,52
buffer_load_dwordx4 v8, s[8:11], s49 offen offset:1024 lds
Mvaa 152,228,56
Mvaa 156,228,60
Ta 200,18,32768
Ta 202,18,33792
Mvaa 160,232,48
Mvaa 164,232,52
buffer_load_dwordx4 v9, s[8:11], s50 offen offset:2048 lds
Mvaa 168,232,56
Ta 204,19,32768
Ta 206,19,33792
Mvaa 172,232,60
Mvaa 176,236,48
Mvaa 180,236,52
Ta 208,20,32768
Ta 210,20,33792
Mvaa 184,236,56
buffer_load_dwordx4 v9, s[8:11], s51 offen offset:3072 lds
v_add_u32 v8, 524288, v8
v_add_u32 v9, 524288, v9
Mvaa 188,236,60
Mvaa 192,240,48
s_waitcnt lgkmcnt(6)
Ta 212,21,32768
Ta 214,21,33792
Mvaa 196,240,52
buffer_store_dwordx4 v[116:119], v2, s[24:27], s37 offen offset:3072 sc1
Mvaa 200,240,56
buffer_load_dwordx4 a[32:35], v10, s[20:23], 0 offen offset:2048 sc1
Mvaa 204,240,60
Ta 216,22,32768
Ta 218,22,33792
Mvaa 208,244,48
Mvaa 212,244,52
Mvaa 216,244,56
Ta 220,23,32768
Ta 222,23,33792
Mvaa 220,244,60
buffer_load_dwordx4 a[36:39], v10, s[20:23], s58 offen offset:2048 sc1
Mvaa 224,248,48
Mvaa 228,248,52
Mvaa 232,248,56
buffer_load_dwordx4 a[40:43], v11, s[20:23], 0 offen offset:2048 sc1
Mvaa 236,248,60
Mvaa 240,252,48
Mvaa 244,252,52
buffer_load_dwordx4 a[44:47], v11, s[20:23], s58 offen offset:2048 sc1
Mvaa 248,252,56
Mvaa 252,252,60
s_waitcnt vmcnt(56) lgkmcnt(0)
Mvaa 128,192,64
s_add_u32 s37, s38, 43008
Mvaa 132,192,68
Ta 224,16,40960
Ta 226,16,41984
Mvaa 136,192,72
buffer_load_dwordx4 a[48:51], v10, s[20:23], 0 offen offset:3072 sc1
Mvaa 140,192,76
buffer_store_dwordx4 v[120:123], v2, s[24:27], s37 offen offset:0 sc1
Mvaa 144,196,64
Ta 228,17,40960
Ta 230,17,41984
Mvaa 148,196,68
Mvaa 152,196,72
Mvaa 156,196,76
Ta 232,18,40960
Ta 234,18,41984
Mvaa 160,200,64
Mvaa 164,200,68
buffer_load_dwordx4 a[52:55], v10, s[20:23], s58 offen offset:3072 sc1
Mvaa 168,200,72
Ta 236,19,40960
Ta 238,19,41984
Mvaa 172,200,76
Mvaa 176,204,64
Mvaa 180,204,68
Ta 240,20,40960
Ta 242,20,41984
Mvaa 184,204,72
Mvaa 188,204,76
Mvaa 192,208,64
s_waitcnt lgkmcnt(6)
Ta 244,21,40960
Ta 246,21,41984
Mvaa 196,208,68
buffer_store_dwordx4 v[124:127], v2, s[24:27], s37 offen offset:1024 sc1
Mvaa 200,208,72
buffer_load_dwordx4 a[56:59], v11, s[20:23], 0 offen offset:3072 sc1
Mvaa 204,208,76
Ta 248,22,40960
Ta 250,22,41984
Mvaa 208,212,64
Mvaa 212,212,68
Mvaa 216,212,72
Ta 252,23,40960
Ta 254,23,41984
Mvaa 220,212,76
Mvaa 224,216,64
Mvaa 228,216,68
Mvaa 232,216,72
buffer_load_dwordx4 a[60:63], v11, s[20:23], s58 offen offset:3072 sc1
v_add_u32 v10, 4096, v10
v_add_u32 v11, 4096, v11
Mvaa 236,216,76
Mvaa 240,220,64
Mvaa 244,220,68
Mvaa 248,220,72
Mvaa 252,220,76
s_waitcnt vmcnt(51) lgkmcnt(0)
s_barrier
Mvaa 128,224,80
buffer_store_dwordx4 v[24:27], v2, s[24:27], s37 offen offset:2048 sc1
Mvaa 132,224,84
s_add_u32 m0, s44, 32768
Ta 192,16,49152
Ta 194,16,50176
Mvaa 136,224,88
buffer_load_dwordx4 v8, s[8:11], s48 offen offset:0 lds
Mvaa 140,224,92
Mvaa 144,228,80
Ta 196,17,49152
Ta 198,17,50176
Mvaa 148,228,84
buffer_load_dwordx4 v8, s[8:11], s49 offen offset:1024 lds
Mvaa 152,228,88
Mvaa 156,228,92
Ta 200,18,49152
Ta 202,18,50176
Mvaa 160,232,80
Mvaa 164,232,84
buffer_load_dwordx4 v9, s[8:11], s50 offen offset:2048 lds
Mvaa 168,232,88
Ta 204,19,49152
Ta 206,19,50176
Mvaa 172,232,92
Mvaa 176,236,80
Mvaa 180,236,84
Ta 208,20,49152
Ta 210,20,50176
Mvaa 184,236,88
buffer_load_dwordx4 v9, s[8:11], s51 offen offset:3072 lds
v_add_u32 v8, 524288, v8
v_add_u32 v9, 524288, v9
Mvaa 188,236,92
Mvaa 192,240,80
s_waitcnt lgkmcnt(6)
Ta 212,21,49152
Ta 214,21,50176
Mvaa 196,240,84
buffer_store_dwordx4 v[28:31], v2, s[24:27], s37 offen offset:3072 sc1
Mvaa 200,240,88
buffer_load_dwordx4 a[64:67], v10, s[20:23], 0 offen offset:0 sc1
Mvaa 204,240,92
Ta 216,22,49152
Ta 218,22,50176
Mvaa 208,244,80
Mvaa 212,244,84
Mvaa 216,244,88
Ta 220,23,49152
Ta 222,23,50176
Mvaa 220,244,92
buffer_load_dwordx4 a[68:71], v10, s[20:23], s58 offen offset:0 sc1
Mvaa 224,248,80
Mvaa 228,248,84
Mvaa 232,248,88
buffer_load_dwordx4 a[72:75], v11, s[20:23], 0 offen offset:0 sc1
Mvaa 236,248,92
Mvaa 240,252,80
Mvaa 244,252,84
buffer_load_dwordx4 a[76:79], v11, s[20:23], s58 offen offset:0 sc1
Mvaa 248,252,88
Mvaa 252,252,92
s_waitcnt vmcnt(56) lgkmcnt(0)
Mvaa 128,192,96
s_add_u32 s37, s38, 47104
Mvaa 132,192,100
Ta 224,16,57344
Ta 226,16,58368
Mvaa 136,192,104
buffer_load_dwordx4 a[80:83], v10, s[20:23], 0 offen offset:1024 sc1
Mvaa 140,192,108
buffer_store_dwordx4 v[32:35], v2, s[24:27], s37 offen offset:0 sc1
Mvaa 144,196,96
Ta 228,17,57344
Ta 230,17,58368
Mvaa 148,196,100
Mvaa 152,196,104
Mvaa 156,196,108
Ta 232,18,57344
Ta 234,18,58368
Mvaa 160,200,96
Mvaa 164,200,100
buffer_load_dwordx4 a[84:87], v10, s[20:23], s58 offen offset:1024 sc1
Mvaa 168,200,104
Ta 236,19,57344
Ta 238,19,58368
Mvaa 172,200,108
Mvaa 176,204,96
Mvaa 180,204,100
Ta 240,20,57344
Ta 242,20,58368
Mvaa 184,204,104
Mvaa 188,204,108
Mvaa 192,208,96
s_waitcnt lgkmcnt(6)
Ta 244,21,57344
Ta 246,21,58368
Mvaa 196,208,100
buffer_store_dwordx4 v[36:39], v2, s[24:27], s37 offen offset:1024 sc1
Mvaa 200,208,104
buffer_load_dwordx4 a[88:91], v11, s[20:23], 0 offen offset:1024 sc1
Mvaa 204,208,108
Ta 248,22,57344
Ta 250,22,58368
Mvaa 208,212,96
Mvaa 212,212,100
Mvaa 216,212,104
Ta 252,23,57344
Ta 254,23,58368
Mvaa 220,212,108
Mvaa 224,216,96
Mvaa 228,216,100
Mvaa 232,216,104
buffer_load_dwordx4 a[92:95], v11, s[20:23], s58 offen offset:1024 sc1
Mvaa 236,216,108
Mvaa 240,220,96
Mvaa 244,220,100
Mvaa 248,220,104
Mvaa 252,220,108
s_waitcnt vmcnt(43) lgkmcnt(0)
s_barrier
Mvaa 128,224,112
buffer_store_dwordx4 v[40:43], v2, s[24:27], s37 offen offset:2048 sc1
Mvaa 132,224,116
s_add_u32 m0, s44, 49152
Ta 192,16,0
Ta 194,16,1024
Mvaa 136,224,120
buffer_load_dwordx4 v8, s[8:11], s48 offen offset:0 lds
Mvaa 140,224,124
Mvaa 144,228,112
Ta 196,17,0
Ta 198,17,1024
Mvaa 148,228,116
buffer_load_dwordx4 v8, s[8:11], s49 offen offset:1024 lds
Mvaa 152,228,120
Mvaa 156,228,124
Ta 200,18,0
Ta 202,18,1024
Mvaa 160,232,112
Mvaa 164,232,116
buffer_load_dwordx4 v9, s[8:11], s50 offen offset:2048 lds
Mvaa 168,232,120
Ta 204,19,0
Ta 206,19,1024
Mvaa 172,232,124
Mvaa 176,236,112
Mvaa 180,236,116
Ta 208,20,0
Ta 210,20,1024
Mvaa 184,236,120
buffer_load_dwordx4 v9, s[8:11], s51 offen offset:3072 lds
v_add_u32 v8, 524288, v8
v_add_u32 v9, 524288, v9
Mvaa 188,236,124
Mvaa 192,240,112
s_waitcnt lgkmcnt(6)
Ta 212,21,0
Ta 214,21,1024
Mvaa 196,240,116
buffer_store_dwordx4 v[44:47], v2, s[24:27], s37 offen offset:3072 sc1
Mvaa 200,240,120
buffer_load_dwordx4 a[96:99], v10, s[20:23], 0 offen offset:2048 sc1
Mvaa 204,240,124
Ta 216,22,0
Ta 218,22,1024
Mvaa 208,244,112
v_mov_b32 v12, 1
v_and_b32 v1, 15, v0
Mvaa 212,244,116
v_lshlrev_b32 v1, 2, v1
Mvaa 216,244,120
Ta 220,23,0
Ta 222,23,1024
Mvaa 220,244,124
buffer_load_dwordx4 a[100:103], v10, s[20:23], s58 offen offset:2048 sc1
Mvaa 224,248,112
s_lshr_b32 s6, s33, 1
s_lshl_b32 s6, s6, 7
s_add_u32 s6, s6, 5296128
Mvaa 228,248,116
s_cmp_eq_u32 s32, 0
s_cselect_b32 s6, s6, 2146435072
Mvaa 232,248,120
buffer_load_dwordx4 a[104:107], v11, s[20:23], 0 offen offset:2048 sc1
Mvaa 236,248,124
Mvaa 240,252,112
Mvaa 244,252,116
buffer_load_dwordx4 a[108:111], v11, s[20:23], s58 offen offset:2048 sc1
Mvaa 248,252,120
Mvaa 252,252,124
s_waitcnt vmcnt(48) lgkmcnt(0)
Mvaa 128,192,0
Mvaa 132,192,4
Ta 224,16,8192
Ta 226,16,9216
Mvaa 136,192,8
buffer_load_dwordx4 a[112:115], v10, s[20:23], 0 offen offset:3072 sc1
Mvaa 140,192,12
Mvaa 144,196,0
Ta 228,17,8192
Ta 230,17,9216
Mvaa 148,196,4
Mvaa 152,196,8
Mvaa 156,196,12
Ta 232,18,8192
Ta 234,18,9216
Mvaa 160,200,0
Mvaa 164,200,4
buffer_load_dwordx4 a[116:119], v10, s[20:23], s58 offen offset:3072 sc1
Mvaa 168,200,8
Ta 236,19,8192
Ta 238,19,9216
Mvaa 172,200,12
Mvaa 176,204,0
Mvaa 180,204,4
Ta 240,20,8192
Ta 242,20,9216
Mvaa 184,204,8
Mvaa 188,204,12
Mvaa 192,208,0
s_waitcnt lgkmcnt(6)
Ta 244,21,8192
Ta 246,21,9216
Mvaa 196,208,4
v_max_u32 v14, v56, v57
v_min_u32 v15, v56, v57
Mvaa 200,208,8
buffer_load_dwordx4 a[120:123], v11, s[20:23], 0 offen offset:3072 sc1
Mvaa 204,208,12
Ta 248,22,8192
Ta 250,22,9216
Mvaa 208,212,0
v_med3_u32 v15, v14, v15, v58
v_max_u32 v14, v14, v58
Mvaa 212,212,4
v_med3_u32 v15, v14, v15, v59
v_max_u32 v14, v14, v59
Mvaa 216,212,8
Ta 252,23,8192
Ta 254,23,9216
Mvaa 220,212,12
v_med3_u32 v15, v14, v15, v60
v_max_u32 v14, v14, v60
Mvaa 224,216,0
v_med3_u32 v15, v14, v15, v61
v_max_u32 v14, v14, v61
Mvaa 228,216,4
v_med3_u32 v15, v14, v15, v62
v_max_u32 v14, v14, v62
Mvaa 232,216,8
buffer_load_dwordx4 a[124:127], v11, s[20:23], s58 offen offset:3072 sc1
v_add_u32 v10, 4096, v10
v_add_u32 v11, 4096, v11
Mvaa 236,216,12
v_med3_u32 v15, v14, v15, v63
v_max_u32 v14, v14, v63
Mvaa 240,220,0
v_med3_u32 v15, v14, v15, v64
v_max_u32 v14, v14, v64
Mvaa 244,220,4
v_med3_u32 v15, v14, v15, v65
v_max_u32 v14, v14, v65
Mvaa 248,220,8
v_med3_u32 v15, v14, v15, v66
v_max_u32 v14, v14, v66
Mvaa 252,220,12
v_med3_u32 v15, v14, v15, v67
v_max_u32 v14, v14, v67
s_waitcnt vmcnt(41) lgkmcnt(0)
s_barrier
Mvaa 128,224,16
v_med3_u32 v15, v14, v15, v68
v_max_u32 v14, v14, v68
Mvaa 132,224,20
s_add_u32 m0, s44, 0
Ta 192,16,16384
Ta 194,16,17408
Mvaa 136,224,24
buffer_load_dwordx4 v8, s[8:11], s48 offen offset:0 lds
Mvaa 140,224,28
v_med3_u32 v15, v14, v15, v69
v_max_u32 v14, v14, v69
Mvaa 144,228,16
Ta 196,17,16384
Ta 198,17,17408
Mvaa 148,228,20
buffer_load_dwordx4 v8, s[8:11], s49 offen offset:1024 lds
Mvaa 152,228,24
v_med3_u32 v15, v14, v15, v70
v_max_u32 v14, v14, v70
Mvaa 156,228,28
Ta 200,18,16384
Ta 202,18,17408
Mvaa 160,232,16
v_med3_u32 v15, v14, v15, v71
v_max_u32 v14, v14, v71
Mvaa 164,232,20
buffer_load_dwordx4 v9, s[8:11], s50 offen offset:2048 lds
Mvaa 168,232,24
Ta 204,19,16384
Ta 206,19,17408
Mvaa 172,232,28
v_med3_u32 v15, v14, v15, v72
v_max_u32 v14, v14, v72
Mvaa 176,236,16
v_med3_u32 v15, v14, v15, v73
v_max_u32 v14, v14, v73
Mvaa 180,236,20
Ta 208,20,16384
Ta 210,20,17408
Mvaa 184,236,24
buffer_load_dwordx4 v9, s[8:11], s51 offen offset:3072 lds
v_add_u32 v8, 524288, v8
v_add_u32 v9, 524288, v9
Mvaa 188,236,28
v_med3_u32 v15, v14, v15, v74
v_max_u32 v14, v14, v74
Mvaa 192,240,16
s_waitcnt lgkmcnt(6)
Ta 212,21,16384
Ta 214,21,17408
Mvaa 196,240,20
v_med3_u32 v15, v14, v15, v75
v_max_u32 v14, v14, v75
Mvaa 200,240,24
buffer_load_dwordx4 a[0:3], v10, s[20:23], 0 offen offset:0 sc1
Mvaa 204,240,28
Ta 216,22,16384
Ta 218,22,17408
Mvaa 208,244,16
v_med3_u32 v15, v14, v15, v76
v_max_u32 v14, v14, v76
Mvaa 212,244,20
v_med3_u32 v15, v14, v15, v77
v_max_u32 v14, v14, v77
Mvaa 216,244,24
Ta 220,23,16384
Ta 222,23,17408
Mvaa 220,244,28
buffer_load_dwordx4 a[4:7], v10, s[20:23], s58 offen offset:0 sc1
Mvaa 224,248,16
v_med3_u32 v15, v14, v15, v78
v_max_u32 v14, v14, v78
Mvaa 228,248,20
v_med3_u32 v15, v14, v15, v79
v_max_u32 v14, v14, v79
Mvaa 232,248,24
buffer_load_dwordx4 a[8:11], v11, s[20:23], 0 offen offset:0 sc1
Mvaa 236,248,28
v_med3_u32 v15, v14, v15, v80
v_max_u32 v14, v14, v80
Mvaa 240,252,16
v_med3_u32 v15, v14, v15, v81
v_max_u32 v14, v14, v81
Mvaa 244,252,20
buffer_load_dwordx4 a[12:15], v11, s[20:23], s58 offen offset:0 sc1
Mvaa 248,252,24
v_med3_u32 v15, v14, v15, v82
v_max_u32 v14, v14, v82
Mvaa 252,252,28
v_med3_u32 v15, v14, v15, v83
v_max_u32 v14, v14, v83
s_waitcnt vmcnt(44) lgkmcnt(0)
Mvaa 128,192,32
v_med3_u32 v15, v14, v15, v84
v_max_u32 v14, v14, v84
Mvaa 132,192,36
Ta 224,16,24576
Ta 226,16,25600
Mvaa 136,192,40
buffer_load_dwordx4 a[16:19], v10, s[20:23], 0 offen offset:1024 sc1
Mvaa 140,192,44
v_med3_u32 v15, v14, v15, v85
v_max_u32 v14, v14, v85
Mvaa 144,196,32
Ta 228,17,24576
Ta 230,17,25600
Mvaa 148,196,36
v_med3_u32 v15, v14, v15, v86
v_max_u32 v14, v14, v86
Mvaa 152,196,40
v_med3_u32 v15, v14, v15, v87
v_max_u32 v14, v14, v87
Mvaa 156,196,44
Ta 232,18,24576
Ta 234,18,25600
Mvaa 160,200,32
v_mov_b32 v13, v14
Mvaa 164,200,36
buffer_load_dwordx4 a[20:23], v10, s[20:23], s58 offen offset:1024 sc1
Mvaa 168,200,40
Ta 236,19,24576
Ta 238,19,25600
Mvaa 172,200,44
v_max_u32_dpp v13, v13, v13 quad_perm:[1,0,3,2] row_mask:0xf bank_mask:0xf
Mvaa 176,204,32
s_nop 0
v_max_u32_dpp v13, v13, v13 quad_perm:[2,3,0,1] row_mask:0xf bank_mask:0xf
Mvaa 180,204,36
Ta 240,20,24576
Ta 242,20,25600
Mvaa 184,204,40
v_max_u32_dpp v13, v13, v13 row_half_mirror row_mask:0xf bank_mask:0xf
Mvaa 188,204,44
s_nop 0
v_max_u32_dpp v13, v13, v13 row_mirror row_mask:0xf bank_mask:0xf
Mvaa 192,208,32
s_waitcnt lgkmcnt(6)
Ta 244,21,24576
Ta 246,21,25600
Mvaa 196,208,36
v_readlane_b32 s3, v13, 0
v_readlane_b32 s47, v13, 16
Mvaa 200,208,40
buffer_load_dwordx4 a[24:27], v11, s[20:23], 0 offen offset:1024 sc1
Mvaa 204,208,44
Ta 248,22,24576
Ta 250,22,25600
Mvaa 208,212,32
v_readlane_b32 s4, v13, 32
v_readlane_b32 s5, v13, 48
Mvaa 212,212,36
s_max_u32 s3, s3, s47
s_max_u32 s4, s4, s5
s_max_u32 s40, s3, s4
Mvaa 216,212,40
Ta 252,23,24576
Ta 254,23,25600
Mvaa 220,212,44
v_cmp_eq_u32 vcc, s40, v14
Mvaa 224,216,32
s_nop 0
v_cndmask_b32 v13, v14, v15, vcc
Mvaa 228,216,36
s_nop 0
v_max_u32_dpp v13, v13, v13 quad_perm:[1,0,3,2] row_mask:0xf bank_mask:0xf
Mvaa 232,216,40
buffer_load_dwordx4 a[28:31], v11, s[20:23], s58 offen offset:1024 sc1
Mvaa 236,216,44
v_max_u32_dpp v13, v13, v13 quad_perm:[2,3,0,1] row_mask:0xf bank_mask:0xf
Mvaa 240,220,32
s_nop 0
v_max_u32_dpp v13, v13, v13 row_half_mirror row_mask:0xf bank_mask:0xf
Mvaa 244,220,36
s_nop 0
v_max_u32_dpp v13, v13, v13 row_mirror row_mask:0xf bank_mask:0xf
Mvaa 248,220,40
v_readlane_b32 s3, v13, 0
v_readlane_b32 s47, v13, 16
Mvaa 252,220,44
v_readlane_b32 s4, v13, 32
v_readlane_b32 s5, v13, 48
s_waitcnt vmcnt(37) lgkmcnt(0)
s_barrier
Mvaa 128,224,48
s_max_u32 s3, s3, s47
s_max_u32 s4, s4, s5
s_max_u32 s41, s3, s4
Mvaa 132,224,52
s_add_u32 m0, s44, 16384
Ta 192,16,32768
Ta 194,16,33792
Mvaa 136,224,56
buffer_load_dwordx4 v8, s[8:11], s48 offen offset:0 lds
Mvaa 140,224,60
s_and_b32 s3, s40, 0xffff
s_sub_u32 s42, 0xffff, s3
s_and_b32 s3, s41, 0xffff
Mvaa 144,228,48
Ta 196,17,32768
Ta 198,17,33792
Mvaa 148,228,52
buffer_load_dwordx4 v8, s[8:11], s49 offen offset:1024 lds
Mvaa 152,228,56
s_sub_u32 s43, 0xffff, s3
v_mov_b32 v56, s42
v_mov_b32 v60, s40
Mvaa 156,228,60
Ta 200,18,32768
Ta 202,18,33792
Mvaa 160,232,48
v_not_b32 v61, v60
v_ashrrev_i32 v61, 31, v61
Mvaa 164,232,52
buffer_load_dwordx4 v9, s[8:11], s50 offen offset:2048 lds
Mvaa 168,232,56
Ta 204,19,32768
Ta 206,19,33792
Mvaa 172,232,60
v_or_b32 v61, 0x80000000, v61
v_xor_b32 v60, v60, v61
Mvaa 176,236,48
v_and_b32 v60, 0xffff0000, v60
v_mul_f32 v60, 0xbfb8aa3b, v60
Mvaa 180,236,52
Ta 208,20,32768
Ta 210,20,33792
Mvaa 184,236,56
buffer_load_dwordx4 v9, s[8:11], s51 offen offset:3072 lds
v_add_u32 v8, 524288, v8
v_add_u32 v9, 524288, v9
Mvaa 188,236,60
Ve 60,60
Mvaa 192,240,48
s_waitcnt lgkmcnt(6)
Ta 212,21,32768
Ta 214,21,33792
Mvaa 196,240,52
v_add_f32 v60, 1.0, v60
Mvaa 200,240,56
buffer_load_dwordx4 a[32:35], v10, s[20:23], 0 offen offset:2048 sc1
Mvaa 204,240,60
Ta 216,22,32768
Ta 218,22,33792
Mvaa 208,244,48
v_rcp_f32 v60, v60
Mvaa 212,244,52
Vc 60,60,60
v_and_b32 v58, 0xffff0000, v60
Mvaa 216,244,56
Ta 220,23,32768
Ta 222,23,33792
Mvaa 220,244,60
buffer_load_dwordx4 a[36:39], v10, s[20:23], s58 offen offset:2048 sc1
Mvaa 224,248,48
v_mov_b32 v57, s43
v_mov_b32 v60, s41
Mvaa 228,248,52
v_not_b32 v61, v60
v_ashrrev_i32 v61, 31, v61
Mvaa 232,248,56
buffer_load_dwordx4 a[40:43], v11, s[20:23], 0 offen offset:2048 sc1
Mvaa 236,248,60
v_or_b32 v61, 0x80000000, v61
v_xor_b32 v60, v60, v61
Mvaa 240,252,48
v_and_b32 v60, 0xffff0000, v60
v_mul_f32 v60, 0xbfb8aa3b, v60
Mvaa 244,252,52
buffer_load_dwordx4 a[44:47], v11, s[20:23], s58 offen offset:2048 sc1
Mvaa 248,252,56
Ve 60,60
Mvaa 252,252,60
v_add_f32 v60, 1.0, v60
s_waitcnt vmcnt(40) lgkmcnt(0)
Mvaa 128,192,64
v_rcp_f32 v60, v60
Mvaa 132,192,68
Ta 224,16,40960
Ta 226,16,41984
Mvaa 136,192,72
buffer_load_dwordx4 a[48:51], v10, s[20:23], 0 offen offset:3072 sc1
Mvaa 140,192,76
Vc 60,60,60
v_and_b32 v59, 0xffff0000, v60
Mvaa 144,196,64
Ta 228,17,40960
Ta 230,17,41984
Mvaa 148,196,68
s_mov_b32 s47, 5292032
s_or_b32 s3, s2, s32
s_cmp_eq_u32 s3, 0
s_cselect_b32 s3, s47, 2146435072
Mvaa 152,196,72
s_mov_b64 exec, 1
buffer_store_dwordx4 v[56:59], v7, s[20:23], s3 offen
s_mov_b64 exec, -1
Mvaa 156,196,76
Ta 232,18,40960
Ta 234,18,41984
Mvaa 160,200,64
v_mov_b32 v48, 0
v_mov_b32 v49, 0
Mvaa 164,200,68
buffer_load_dwordx4 a[52:55], v10, s[20:23], s58 offen offset:3072 sc1
Mvaa 168,200,72
Ta 236,19,40960
Ta 238,19,41984
Mvaa 172,200,76
v_mov_b32 v50, 0
v_mov_b32 v51, 0
Mvaa 176,204,64
v_mov_b32 v52, 0
v_mov_b32 v53, 0
Mvaa 180,204,68
Ta 240,20,40960
Ta 242,20,41984
Mvaa 184,204,72
v_mov_b32 v54, 0
v_mov_b32 v55, 0
Mvaa 188,204,76
v_mov_b32 v56, 0
v_mov_b32 v57, 0
Mvaa 192,208,64
s_waitcnt lgkmcnt(6)
Ta 244,21,40960
Ta 246,21,41984
Mvaa 196,208,68
v_mov_b32 v58, 0
v_mov_b32 v59, 0
Mvaa 200,208,72
buffer_load_dwordx4 a[56:59], v11, s[20:23], 0 offen offset:3072 sc1
Mvaa 204,208,76
Ta 248,22,40960
Ta 250,22,41984
Mvaa 208,212,64
v_mov_b32 v60, 0
v_mov_b32 v61, 0
Mvaa 212,212,68
v_mov_b32 v62, 0
v_mov_b32 v63, 0
Mvaa 216,212,72
Ta 252,23,40960
Ta 254,23,41984
Mvaa 220,212,76
Mvaa 224,216,64
Mvaa 228,216,68
Mvaa 232,216,72
buffer_load_dwordx4 a[60:63], v11, s[20:23], s58 offen offset:3072 sc1
v_add_u32 v10, 4096, v10
v_add_u32 v11, 4096, v11
Mvaa 236,216,76
Mvaa 240,220,64
Mvaa 244,220,68
Mvaa 248,220,72
Mvaa 252,220,76
s_waitcnt vmcnt(33) lgkmcnt(0)
s_barrier
Mvaa 128,224,80
s_mov_b64 exec, 1
buffer_store_dword v12, v7, s[20:23], s39 offen sc1
s_mov_b64 exec, -1
Mvaa 132,224,84
s_add_u32 m0, s44, 32768
Ta 192,16,49152
Ta 194,16,50176
Mvaa 136,224,88
buffer_load_dwordx4 v8, s[8:11], s48 offen offset:0 lds
Mvaa 140,224,92
Mvaa 144,228,80
Ta 196,17,49152
Ta 198,17,50176
Mvaa 148,228,84
buffer_load_dwordx4 v8, s[8:11], s49 offen offset:1024 lds
Mvaa 152,228,88
Mvaa 156,228,92
Ta 200,18,49152
Ta 202,18,50176
Mvaa 160,232,80
Mvaa 164,232,84
buffer_load_dwordx4 v9, s[8:11], s50 offen offset:2048 lds
Mvaa 168,232,88
Ta 204,19,49152
Ta 206,19,50176
Mvaa 172,232,92
Mvaa 176,236,80
Mvaa 180,236,84
Ta 208,20,49152
Ta 210,20,50176
Mvaa 184,236,88
buffer_load_dwordx4 v9, s[8:11], s51 offen offset:3072 lds
v_add_u32 v8, 524288, v8
v_add_u32 v9, 524288, v9
Mvaa 188,236,92
Mvaa 192,240,80
s_waitcnt lgkmcnt(6)
Ta 212,21,49152
Ta 214,21,50176
Mvaa 196,240,84
Mvaa 200,240,88
buffer_load_dwordx4 a[64:67], v10, s[20:23], 0 offen offset:0 sc1
Mvaa 204,240,92
Ta 216,22,49152
Ta 218,22,50176
Mvaa 208,244,80
Mvaa 212,244,84
Mvaa 216,244,88
Ta 220,23,49152
Ta 222,23,50176
Mvaa 220,244,92
buffer_load_dwordx4 a[68:71], v10, s[20:23], s58 offen offset:0 sc1
Mvaa 224,248,80
Mvaa 228,248,84
Mvaa 232,248,88
buffer_load_dwordx4 a[72:75], v11, s[20:23], 0 offen offset:0 sc1
Mvaa 236,248,92
Mvaa 240,252,80
Mvaa 244,252,84
buffer_load_dwordx4 a[76:79], v11, s[20:23], s58 offen offset:0 sc1
Mvaa 248,252,88
Mvaa 252,252,92
s_waitcnt vmcnt(38) lgkmcnt(0)
Mvaa 128,192,96
Mvaa 132,192,100
Ta 224,16,57344
Ta 226,16,58368
Mvaa 136,192,104
buffer_load_dwordx4 a[80:83], v10, s[20:23], 0 offen offset:1024 sc1
Mvaa 140,192,108
Mvaa 144,196,96
Ta 228,17,57344
Ta 230,17,58368
Mvaa 148,196,100
Mvaa 152,196,104
Mvaa 156,196,108
Ta 232,18,57344
Ta 234,18,58368
Mvaa 160,200,96
Mvaa 164,200,100
buffer_load_dwordx4 a[84:87], v10, s[20:23], s58 offen offset:1024 sc1
Mvaa 168,200,104
Ta 236,19,57344
Ta 238,19,58368
Mvaa 172,200,108
Mvaa 176,204,96
Mvaa 180,204,100
Ta 240,20,57344
Ta 242,20,58368
Mvaa 184,204,104
Mvaa 188,204,108
Mvaa 192,208,96
s_waitcnt lgkmcnt(6)
Ta 244,21,57344
Ta 246,21,58368
Mvaa 196,208,100
Mvaa 200,208,104
buffer_load_dwordx4 a[88:91], v11, s[20:23], 0 offen offset:1024 sc1
Mvaa 204,208,108
Ta 248,22,57344
Ta 250,22,58368
Mvaa 208,212,96
Mvaa 212,212,100
Mvaa 216,212,104
Ta 252,23,57344
Ta 254,23,58368
Mvaa 220,212,108
Mvaa 224,216,96
Mvaa 228,216,100
Mvaa 232,216,104
buffer_load_dwordx4 a[92:95], v11, s[20:23], s58 offen offset:1024 sc1
Mvaa 236,216,108
Mvaa 240,220,96
Mvaa 244,220,100
Mvaa 248,220,104
Mvaa 252,220,108
s_waitcnt vmcnt(34) lgkmcnt(0)
s_barrier
Mvaa 128,224,112
Mvaa 132,224,116
s_add_u32 m0, s44, 49152
Ta 192,16,0
Ta 194,16,1024
Mvaa 136,224,120
buffer_load_dwordx4 v8, s[8:11], s48 offen offset:0 lds
Mvaa 140,224,124
Mvaa 144,228,112
Ta 196,17,0
Ta 198,17,1024
Mvaa 148,228,116
buffer_load_dwordx4 v8, s[8:11], s49 offen offset:1024 lds
Mvaa 152,228,120
Mvaa 156,228,124
Ta 200,18,0
Ta 202,18,1024
Mvaa 160,232,112
Mvaa 164,232,116
buffer_load_dwordx4 v9, s[8:11], s50 offen offset:2048 lds
Mvaa 168,232,120
Ta 204,19,0
Ta 206,19,1024
Mvaa 172,232,124
Mvaa 176,236,112
Mvaa 180,236,116
Ta 208,20,0
Ta 210,20,1024
Mvaa 184,236,120
buffer_load_dwordx4 v9, s[8:11], s51 offen offset:3072 lds
v_add_u32 v8, 524288, v8
v_add_u32 v9, 524288, v9
Mvaa 188,236,124
Mvaa 192,240,112
s_waitcnt lgkmcnt(6)
Ta 212,21,0
Ta 214,21,1024
Mvaa 196,240,116
Mvaa 200,240,120
buffer_load_dwordx4 a[96:99], v10, s[20:23], 0 offen offset:2048 sc1
Mvaa 204,240,124
Ta 216,22,0
Ta 218,22,1024
Mvaa 208,244,112
Mvaa 212,244,116
Mvaa 216,244,120
Ta 220,23,0
Ta 222,23,1024
Mvaa 220,244,124
buffer_load_dwordx4 a[100:103], v10, s[20:23], s58 offen offset:2048 sc1
Mvaa 224,248,112
Mvaa 228,248,116
Mvaa 232,248,120
buffer_load_dwordx4 a[104:107], v11, s[20:23], 0 offen offset:2048 sc1
Mvaa 236,248,124
Mvaa 240,252,112
Mvaa 244,252,116
buffer_load_dwordx4 a[108:111], v11, s[20:23], s58 offen offset:2048 sc1
Mvaa 248,252,120
Mvaa 252,252,124
s_waitcnt vmcnt(38) lgkmcnt(0)
Mvaa 128,192,0
Mvaa 132,192,4
Ta 224,16,8192
Ta 226,16,9216
Mvaa 136,192,8
buffer_load_dwordx4 a[112:115], v10, s[20:23], 0 offen offset:3072 sc1
Mvaa 140,192,12
Mvaa 144,196,0
Ta 228,17,8192
Ta 230,17,9216
Mvaa 148,196,4
Mvaa 152,196,8
Mvaa 156,196,12
Ta 232,18,8192
Ta 234,18,9216
Mvaa 160,200,0
Mvaa 164,200,4
buffer_load_dwordx4 a[116:119], v10, s[20:23], s58 offen offset:3072 sc1
Mvaa 168,200,8
Ta 236,19,8192
Ta 238,19,9216
Mvaa 172,200,12
Mvaa 176,204,0
Mvaa 180,204,4
Ta 240,20,8192
Ta 242,20,9216
Mvaa 184,204,8
Mvaa 188,204,12
Mvaa 192,208,0
s_waitcnt lgkmcnt(6)
Ta 244,21,8192
Ta 246,21,9216
Mvaa 196,208,4
Mvaa 200,208,8
buffer_load_dwordx4 a[120:123], v11, s[20:23], 0 offen offset:3072 sc1
Mvaa 204,208,12
Ta 248,22,8192
Ta 250,22,9216
Mvaa 208,212,0
Mvaa 212,212,4
Mvaa 216,212,8
Ta 252,23,8192
Ta 254,23,9216
Mvaa 220,212,12
Mvaa 224,216,0
Mvaa 228,216,4
Mvaa 232,216,8
buffer_load_dwordx4 a[124:127], v11, s[20:23], s58 offen offset:3072 sc1
v_add_u32 v10, 4096, v10
v_add_u32 v11, 4096, v11
Mvaa 236,216,12
Mvaa 240,220,0
Mvaa 244,220,4
Mvaa 248,220,8
Mvaa 252,220,12
s_waitcnt vmcnt(34) lgkmcnt(0)
s_barrier
Mvaa 128,224,16
Mvaa 132,224,20
Ta 192,16,16384
Ta 194,16,17408
Mvaa 136,224,24
Mvaa 140,224,28
Mvaa 144,228,16
Ta 196,17,16384
Ta 198,17,17408
Mvaa 148,228,20
Mvaa 152,228,24
Mvaa 156,228,28
Ta 200,18,16384
Ta 202,18,17408
Mvaa 160,232,16
Mvaa 164,232,20
Mvaa 168,232,24
Ta 204,19,16384
Ta 206,19,17408
Mvaa 172,232,28
Mvaa 176,236,16
Mvaa 180,236,20
Ta 208,20,16384
Ta 210,20,17408
Mvaa 184,236,24
Mvaa 188,236,28
Mvaa 192,240,16
s_waitcnt lgkmcnt(6)
Ta 212,21,16384
Ta 214,21,17408
Mvaa 196,240,20
Mvaa 200,240,24
Mvaa 204,240,28
Ta 216,22,16384
Ta 218,22,17408
Mvaa 208,244,16
Mvaa 212,244,20
Mvaa 216,244,24
Ta 220,23,16384
Ta 222,23,17408
Mvaa 220,244,28
Mvaa 224,248,16
Mvaa 228,248,20
Mvaa 232,248,24
Mvaa 236,248,28
Mvaa 240,252,16
Mvaa 244,252,20
Mvaa 248,252,24
Mvaa 252,252,28
s_waitcnt vmcnt(30) lgkmcnt(0)
Mvaa 128,192,32
Mvaa 132,192,36
Ta 224,16,24576
Ta 226,16,25600
Mvaa 136,192,40
Mvaa 140,192,44
Mvaa 144,196,32
Ta 228,17,24576
Ta 230,17,25600
Mvaa 148,196,36
Mvaa 152,196,40
Mvaa 156,196,44
Ta 232,18,24576
Ta 234,18,25600
Mvaa 160,200,32
Mvaa 164,200,36
Mvaa 168,200,40
Ta 236,19,24576
Ta 238,19,25600
Mvaa 172,200,44
Mvaa 176,204,32
Mvaa 180,204,36
Ta 240,20,24576
Ta 242,20,25600
Mvaa 184,204,40
Mvaa 188,204,44
Mvaa 192,208,32
s_waitcnt lgkmcnt(6)
Ta 244,21,24576
Ta 246,21,25600
Mvaa 196,208,36
Mvaa 200,208,40
Mvaa 204,208,44
Ta 248,22,24576
Ta 250,22,25600
Mvaa 208,212,32
Mvaa 212,212,36
Mvaa 216,212,40
Ta 252,23,24576
Ta 254,23,25600
Mvaa 220,212,44
Mvaa 224,216,32
Mvaa 228,216,36
Mvaa 232,216,40
Mvaa 236,216,44
Mvaa 240,220,32
Mvaa 244,220,36
Mvaa 248,220,40
Mvaa 252,220,44
s_waitcnt vmcnt(20) lgkmcnt(0)
s_barrier
Mvaa 128,224,48
Mvaa 132,224,52
Ta 192,16,32768
Ta 194,16,33792
Mvaa 136,224,56
Mvaa 140,224,60
Mvaa 144,228,48
Ta 196,17,32768
Ta 198,17,33792
Mvaa 148,228,52
Mvaa 152,228,56
Mvaa 156,228,60
Ta 200,18,32768
Ta 202,18,33792
Mvaa 160,232,48
Mvaa 164,232,52
Mvaa 168,232,56
Ta 204,19,32768
Ta 206,19,33792
Mvaa 172,232,60
Mvaa 176,236,48
Mvaa 180,236,52
Ta 208,20,32768
Ta 210,20,33792
Mvaa 184,236,56
Mvaa 188,236,60
Mvaa 192,240,48
s_waitcnt lgkmcnt(6)
Ta 212,21,32768
Ta 214,21,33792
Mvaa 196,240,52
Mvaa 200,240,56
Mvaa 204,240,60
Ta 216,22,32768
Ta 218,22,33792
Mvaa 208,244,48
Mvaa 212,244,52
Mvaa 216,244,56
Ta 220,23,32768
Ta 222,23,33792
Mvaa 220,244,60
Mvaa 224,248,48
Mvaa 228,248,52
Mvaa 232,248,56
Mvaa 236,248,60
Mvaa 240,252,48
Mvaa 244,252,52
Mvaa 248,252,56
Mvaa 252,252,60
s_waitcnt vmcnt(16) lgkmcnt(0)
Mvaa 128,192,64
buffer_load_dword v12, v1, s[20:23], s6 offen sc1
Mvaa 132,192,68
Ta 224,16,40960
Ta 226,16,41984
Mvaa 136,192,72
Mvaa 140,192,76
Mvaa 144,196,64
Ta 228,17,40960
Ta 230,17,41984
Mvaa 148,196,68
Mvaa 152,196,72
Mvaa 156,196,76
Ta 232,18,40960
Ta 234,18,41984
Mvaa 160,200,64
Mvaa 164,200,68
Mvaa 168,200,72
Ta 236,19,40960
Ta 238,19,41984
Mvaa 172,200,76
Mvaa 176,204,64
Mvaa 180,204,68
Ta 240,20,40960
Ta 242,20,41984
Mvaa 184,204,72
Mvaa 188,204,76
Mvaa 192,208,64
s_waitcnt lgkmcnt(6)
Ta 244,21,40960
Ta 246,21,41984
Mvaa 196,208,68
Mvaa 200,208,72
Mvaa 204,208,76
Ta 248,22,40960
Ta 250,22,41984
Mvaa 208,212,64
Mvaa 212,212,68
Mvaa 216,212,72
Ta 252,23,40960
Ta 254,23,41984
Mvaa 220,212,76
Mvaa 224,216,64
Mvaa 228,216,68
Mvaa 232,216,72
Mvaa 236,216,76
Mvaa 240,220,64
Mvaa 244,220,68
Mvaa 248,220,72
Mvaa 252,220,76
s_waitcnt vmcnt(9) lgkmcnt(0)
s_barrier
Mvaa 128,224,80
Mvaa 132,224,84
Ta 192,16,49152
Ta 194,16,50176
Mvaa 136,224,88
Mvaa 140,224,92
Mvaa 144,228,80
Ta 196,17,49152
Ta 198,17,50176
Mvaa 148,228,84
Mvaa 152,228,88
Mvaa 156,228,92
Ta 200,18,49152
Ta 202,18,50176
Mvaa 160,232,80
Mvaa 164,232,84
Mvaa 168,232,88
Ta 204,19,49152
Ta 206,19,50176
Mvaa 172,232,92
Mvaa 176,236,80
Mvaa 180,236,84
Ta 208,20,49152
Ta 210,20,50176
Mvaa 184,236,88
Mvaa 188,236,92
Mvaa 192,240,80
s_waitcnt lgkmcnt(6)
Ta 212,21,49152
Ta 214,21,50176
Mvaa 196,240,84
Mvaa 200,240,88
Mvaa 204,240,92
Ta 216,22,49152
Ta 218,22,50176
Mvaa 208,244,80
Mvaa 212,244,84
Mvaa 216,244,88
Ta 220,23,49152
Ta 222,23,50176
Mvaa 220,244,92
Mvaa 224,248,80
Mvaa 228,248,84
Mvaa 232,248,88
Mvaa 236,248,92
Mvaa 240,252,80
Mvaa 244,252,84
Mvaa 248,252,88
Mvaa 252,252,92
s_waitcnt vmcnt(5) lgkmcnt(0)
Mvaa 128,192,96
Mvaa 132,192,100
Ta 224,16,57344
Ta 226,16,58368
Mvaa 136,192,104
Mvaa 140,192,108
Mvaa 144,196,96
Ta 228,17,57344
Ta 230,17,58368
Mvaa 148,196,100
Mvaa 152,196,104
Mvaa 156,196,108
Ta 232,18,57344
Ta 234,18,58368
Mvaa 160,200,96
Mvaa 164,200,100
Mvaa 168,200,104
Ta 236,19,57344
Ta 238,19,58368
Mvaa 172,200,108
Mvaa 176,204,96
Mvaa 180,204,100
Ta 240,20,57344
Ta 242,20,58368
Mvaa 184,204,104
Mvaa 188,204,108
Mvaa 192,208,96
s_waitcnt lgkmcnt(6)
Ta 244,21,57344
Ta 246,21,58368
Mvaa 196,208,100
Mvaa 200,208,104
Mvaa 204,208,108
Ta 248,22,57344
Ta 250,22,58368
Mvaa 208,212,96
Mvaa 212,212,100
Mvaa 216,212,104
Ta 252,23,57344
Ta 254,23,58368
Mvaa 220,212,108
Mvaa 224,216,96
Mvaa 228,216,100
Mvaa 232,216,104
Mvaa 236,216,108
Mvaa 240,220,96
Mvaa 244,220,100
Mvaa 248,220,104
Mvaa 252,220,108
s_waitcnt vmcnt(0) lgkmcnt(0)
s_cmp_lg_u32 s32, 0
s_cbranch_scc1 L_spinBr
v_cmp_ne_u32 vcc, 1, v12
s_cbranch_vccnz L_spinB
L_spinBr:
s_barrier
Mvaa 128,224,112
s_add_u32 m0, s44, 0
s_mov_b32 s7, 0
Mvaa 132,224,116
buffer_load_dwordx4 v4, s[12:15], s7 offen offset:0 sc1 lds
Mvaa 136,224,120
buffer_load_dwordx4 v4, s[12:15], s7 offen offset:1024 sc1 lds
Mvaa 140,224,124
buffer_load_dwordx4 v4, s[12:15], s7 offen offset:2048 sc1 lds
Mvaa 144,228,112
buffer_load_dwordx4 v4, s[12:15], s7 offen offset:3072 sc1 lds
Mvaa 148,228,116
s_add_u32 m0, s44, 16384
s_mov_b32 s7, 17408
Mvaa 152,228,120
buffer_load_dwordx4 v4, s[12:15], s7 offen offset:0 sc1 lds
Mvaa 156,228,124
buffer_load_dwordx4 v4, s[12:15], s7 offen offset:1024 sc1 lds
Mvaa 160,232,112
buffer_load_dwordx4 v4, s[12:15], s7 offen offset:2048 sc1 lds
Mvaa 164,232,116
buffer_load_dwordx4 v4, s[12:15], s7 offen offset:3072 sc1 lds
Mvaa 168,232,120
s_add_u32 m0, s44, 32768
s_mov_b32 s7, 34816
Mvaa 172,232,124
buffer_load_dwordx4 v4, s[12:15], s7 offen offset:0 sc1 lds
Mvaa 176,236,112
buffer_load_dwordx4 v4, s[12:15], s7 offen offset:1024 sc1 lds
Mvaa 180,236,116
buffer_load_dwordx4 v4, s[12:15], s7 offen offset:2048 sc1 lds
Mvaa 184,236,120
buffer_load_dwordx4 v4, s[12:15], s7 offen offset:3072 sc1 lds
Mvaa 188,236,124
s_add_u32 m0, s44, 49152
s_mov_b32 s7, 52224
Mvaa 192,240,112
buffer_load_dwordx4 v4, s[12:15], s7 offen offset:0 sc1 lds
Mvaa 196,240,116
buffer_load_dwordx4 v4, s[12:15], s7 offen offset:1024 sc1 lds
Mvaa 200,240,120
buffer_load_dwordx4 v4, s[12:15], s7 offen offset:2048 sc1 lds
Mvaa 204,240,124
buffer_load_dwordx4 v4, s[12:15], s7 offen offset:3072 sc1 lds
Mvaa 208,244,112
s_add_u32 m0, s44, 65536
s_mov_b32 s7, 69632
Mvaa 212,244,116
buffer_load_dwordx4 v4, s[12:15], s7 offen offset:0 sc1 lds
Mvaa 216,244,120
buffer_load_dwordx4 v4, s[12:15], s7 offen offset:1024 sc1 lds
Mvaa 220,244,124
buffer_load_dwordx4 v4, s[12:15], s7 offen offset:2048 sc1 lds
Mvaa 224,248,112
buffer_load_dwordx4 v4, s[12:15], s7 offen offset:3072 sc1 lds
Mvaa 228,248,116
s_add_u32 m0, s44, 81920
s_mov_b32 s7, 87040
Mvaa 232,248,120
buffer_load_dwordx4 v4, s[12:15], s7 offen offset:0 sc1 lds
Mvaa 236,248,124
buffer_load_dwordx4 v4, s[12:15], s7 offen offset:1024 sc1 lds
Mvaa 240,252,112
buffer_load_dwordx4 v4, s[12:15], s7 offen offset:2048 sc1 lds
Mvaa 244,252,116
buffer_load_dwordx4 v4, s[12:15], s7 offen offset:3072 sc1 lds
Mvaa 248,252,120
s_add_u32 m0, s44, 98304
s_mov_b32 s7, 104448
Mvaa 252,252,124
buffer_load_dwordx4 v4, s[12:15], s7 offen offset:0 sc1 lds
s_mov_b32 s4, 1040356334
s_mov_b32 s5, s4
v_pk_mul_f32 v[128:129], v[128:129], s[4:5]
v_pk_mul_f32 v[130:131], v[130:131], s[4:5]
Vc 128,128,129
Vc 129,130,131
Aw 128,128
Aw 129,129
v_pk_mul_f32 v[144:145], v[144:145], s[4:5]
v_pk_mul_f32 v[146:147], v[146:147], s[4:5]
Vc 144,144,145
Vc 145,146,147
Aw 130,144
Aw 131,145
v_pk_mul_f32 v[160:161], v[160:161], s[4:5]
v_pk_mul_f32 v[162:163], v[162:163], s[4:5]
Vc 160,160,161
Vc 161,162,163
Aw 132,160
Aw 133,161
v_pk_mul_f32 v[176:177], v[176:177], s[4:5]
v_pk_mul_f32 v[178:179], v[178:179], s[4:5]
Vc 176,176,177
Vc 177,178,179
Aw 134,176
Aw 135,177
v_pk_mul_f32 v[192:193], v[192:193], s[4:5]
v_pk_mul_f32 v[194:195], v[194:195], s[4:5]
Vc 192,192,193
Vc 193,194,195
Aw 136,192
Aw 137,193
v_pk_mul_f32 v[208:209], v[208:209], s[4:5]
v_pk_mul_f32 v[210:211], v[210:211], s[4:5]
Vc 208,208,209
Vc 209,210,211
Aw 138,208
Aw 139,209
v_pk_mul_f32 v[224:225], v[224:225], s[4:5]
v_pk_mul_f32 v[226:227], v[226:227], s[4:5]
Vc 224,224,225
Vc 225,226,227
Aw 140,224
Aw 141,225
v_pk_mul_f32 v[240:241], v[240:241], s[4:5]
v_pk_mul_f32 v[242:243], v[242:243], s[4:5]
Vc 240,240,241
Vc 241,242,243
Aw 142,240
Aw 143,241
buffer_load_dwordx4 v4, s[12:15], s7 offen offset:1024 sc1 lds
buffer_load_dwordx4 v4, s[12:15], s7 offen offset:2048 sc1 lds
buffer_load_dwordx4 v4, s[12:15], s7 offen offset:3072 sc1 lds
v_pk_mul_f32 v[132:133], v[132:133], s[4:5]
v_pk_mul_f32 v[134:135], v[134:135], s[4:5]
Vc 132,132,133
Vc 133,134,135
Aw 144,132
Aw 145,133
v_pk_mul_f32 v[148:149], v[148:149], s[4:5]
v_pk_mul_f32 v[150:151], v[150:151], s[4:5]
Vc 148,148,149
Vc 149,150,151
Aw 146,148
Aw 147,149
v_pk_mul_f32 v[164:165], v[164:165], s[4:5]
v_pk_mul_f32 v[166:167], v[166:167], s[4:5]
Vc 164,164,165
Vc 165,166,167
Aw 148,164
Aw 149,165
v_pk_mul_f32 v[180:181], v[180:181], s[4:5]
v_pk_mul_f32 v[182:183], v[182:183], s[4:5]
Vc 180,180,181
Vc 181,182,183
Aw 150,180
Aw 151,181
v_pk_mul_f32 v[196:197], v[196:197], s[4:5]
v_pk_mul_f32 v[198:199], v[198:199], s[4:5]
Vc 196,196,197
Vc 197,198,199
Aw 152,196
Aw 153,197
v_pk_mul_f32 v[212:213], v[212:213], s[4:5]
v_pk_mul_f32 v[214:215], v[214:215], s[4:5]
Vc 212,212,213
Vc 213,214,215
Aw 154,212
Aw 155,213
v_pk_mul_f32 v[228:229], v[228:229], s[4:5]
v_pk_mul_f32 v[230:231], v[230:231], s[4:5]
Vc 228,228,229
Vc 229,230,231
Aw 156,228
Aw 157,229
v_pk_mul_f32 v[244:245], v[244:245], s[4:5]
v_pk_mul_f32 v[246:247], v[246:247], s[4:5]
Vc 244,244,245
Vc 245,246,247
Aw 158,244
Aw 159,245
v_pk_mul_f32 v[136:137], v[136:137], s[4:5]
v_pk_mul_f32 v[138:139], v[138:139], s[4:5]
Vc 136,136,137
Vc 137,138,139
Aw 160,136
Aw 161,137
v_pk_mul_f32 v[152:153], v[152:153], s[4:5]
v_pk_mul_f32 v[154:155], v[154:155], s[4:5]
Vc 152,152,153
Vc 153,154,155
Aw 162,152
Aw 163,153
v_pk_mul_f32 v[168:169], v[168:169], s[4:5]
v_pk_mul_f32 v[170:171], v[170:171], s[4:5]
Vc 168,168,169
Vc 169,170,171
Aw 164,168
Aw 165,169
v_pk_mul_f32 v[184:185], v[184:185], s[4:5]
v_pk_mul_f32 v[186:187], v[186:187], s[4:5]
Vc 184,184,185
Vc 185,186,187
Aw 166,184
Aw 167,185
v_pk_mul_f32 v[200:201], v[200:201], s[4:5]
v_pk_mul_f32 v[202:203], v[202:203], s[4:5]
Vc 200,200,201
Vc 201,202,203
Aw 168,200
Aw 169,201
v_pk_mul_f32 v[216:217], v[216:217], s[4:5]
v_pk_mul_f32 v[218:219], v[218:219], s[4:5]
Vc 216,216,217
Vc 217,218,219
Aw 170,216
Aw 171,217
v_pk_mul_f32 v[232:233], v[232:233], s[4:5]
v_pk_mul_f32 v[234:235], v[234:235], s[4:5]
Vc 232,232,233
Vc 233,234,235
Aw 172,232
Aw 173,233
v_pk_mul_f32 v[248:249], v[248:249], s[4:5]
v_pk_mul_f32 v[250:251], v[250:251], s[4:5]
Vc 248,248,249
Vc 249,250,251
Aw 174,248
Aw 175,249
v_pk_mul_f32 v[140:141], v[140:141], s[4:5]
v_pk_mul_f32 v[142:143], v[142:143], s[4:5]
Vc 140,140,141
Vc 141,142,143
Aw 176,140
Aw 177,141
v_pk_mul_f32 v[156:157], v[156:157], s[4:5]
v_pk_mul_f32 v[158:159], v[158:159], s[4:5]
Vc 156,156,157
Vc 157,158,159
Aw 178,156
Aw 179,157
v_pk_mul_f32 v[172:173], v[172:173], s[4:5]
v_pk_mul_f32 v[174:175], v[174:175], s[4:5]
Vc 172,172,173
Vc 173,174,175
Aw 180,172
Aw 181,173
v_pk_mul_f32 v[188:189], v[188:189], s[4:5]
v_pk_mul_f32 v[190:191], v[190:191], s[4:5]
Vc 188,188,189
Vc 189,190,191
Aw 182,188
Aw 183,189
v_pk_mul_f32 v[204:205], v[204:205], s[4:5]
v_pk_mul_f32 v[206:207], v[206:207], s[4:5]
Vc 204,204,205
Vc 205,206,207
Aw 184,204
Aw 185,205
v_pk_mul_f32 v[220:221], v[220:221], s[4:5]
v_pk_mul_f32 v[222:223], v[222:223], s[4:5]
Vc 220,220,221
Vc 221,222,223
Aw 186,220
Aw 187,221
v_pk_mul_f32 v[236:237], v[236:237], s[4:5]
v_pk_mul_f32 v[238:239], v[238:239], s[4:5]
Vc 236,236,237
Vc 237,238,239
Aw 188,236
Aw 189,237
v_pk_mul_f32 v[252:253], v[252:253], s[4:5]
v_pk_mul_f32 v[254:255], v[254:255], s[4:5]
Vc 252,252,253
Vc 253,254,255
Aw 190,252
Aw 191,253
v_mov_b32 v16, 0x3f803f80
v_mov_b32 v17, 0x3f803f80
v_mov_b32 v18, 0x3f803f80
v_mov_b32 v19, 0x3f803f80
v_mov_b32 v20, 0xff800000
s_mov_b32 s24, s60
s_mov_b32 s25, s61
s_mov_b32 s26, s62
s_lshl_b32 s3, s34, 5
s_add_u32 s3, s3, s33
s_mul_i32 s6, s3, 2341
s_lshr_b32 s6, s6, 16
s_mul_i32 s47, s6, 28
s_sub_u32 s4, s3, s47
s_mul_i32 s5, s6, 917504
s_lshl_b32 s47, s4, 8
s_add_u32 s5, s5, s47
s_sub_u32 s55, 15, s34
s_sub_u32 s45, s36, 3
s_sub_u32 s46, s35, 3
s_max_i32 s46, s46, 0
s_mov_b32 s53, s44
s_add_u32 s54, s44, 65536
s_waitcnt vmcnt(16)
s_barrier
Ra 192,2,0
Ra 196,2,1024
Ra 200,2,2048
Ra 204,2,3072
Ra 208,2,4096
Ra 212,2,5120
Ra 216,2,6144
Ra 220,2,7168
s_waitcnt lgkmcnt(4)
Zvaa 128,192,128
Ra 224,2,8192
v_accvgpr_write_b32 a0, 0
Mvaa 128,196,132
Ra 228,2,9216
v_accvgpr_write_b32 a1, 0
Mvaa 128,200,136
Ra 232,2,10240
v_accvgpr_write_b32 a2, 0
Mvaa 128,204,140
Ra 236,2,11264
v_accvgpr_write_b32 a3, 0
Zvaa 144,192,144
v_accvgpr_write_b32 a4, 0
v_accvgpr_write_b32 a5, 0
Mvaa 144,196,148
v_accvgpr_write_b32 a6, 0
v_accvgpr_write_b32 a7, 0
Mvaa 144,200,152
v_accvgpr_write_b32 a8, 0
v_accvgpr_write_b32 a9, 0
Mvaa 144,204,156
v_accvgpr_write_b32 a10, 0
v_accvgpr_write_b32 a11, 0
Zvaa 160,192,160
v_accvgpr_write_b32 a12, 0
v_accvgpr_write_b32 a13, 0
Mvaa 160,196,164
v_accvgpr_write_b32 a14, 0
v_accvgpr_write_b32 a15, 0
Mvaa 160,200,168
v_accvgpr_write_b32 a16, 0
v_accvgpr_write_b32 a17, 0
Mvaa 160,204,172
v_accvgpr_write_b32 a18, 0
v_accvgpr_write_b32 a19, 0
Zvaa 176,192,176
v_accvgpr_write_b32 a20, 0
v_accvgpr_write_b32 a21, 0
Mvaa 176,196,180
v_accvgpr_write_b32 a22, 0
v_accvgpr_write_b32 a23, 0
Mvaa 176,200,184
v_accvgpr_write_b32 a24, 0
v_accvgpr_write_b32 a25, 0
Mvaa 176,204,188
s_waitcnt lgkmcnt(4)
v_accvgpr_write_b32 a26, 0
v_accvgpr_write_b32 a27, 0
Zvaa 132,208,128
Ra 240,2,12288
v_accvgpr_write_b32 a28, 0
Mvaa 132,212,132
Ra 244,2,13312
v_accvgpr_write_b32 a29, 0
Mvaa 132,216,136
Ra 248,2,14336
v_accvgpr_write_b32 a30, 0
Mvaa 132,220,140
Ra 252,2,15360
v_accvgpr_write_b32 a31, 0
Zvaa 148,208,144
v_accvgpr_write_b32 a32, 0
v_accvgpr_write_b32 a33, 0
Mvaa 148,212,148
v_accvgpr_write_b32 a34, 0
v_accvgpr_write_b32 a35, 0
Mvaa 148,216,152
v_accvgpr_write_b32 a36, 0
v_accvgpr_write_b32 a37, 0
Mvaa 148,220,156
v_accvgpr_write_b32 a38, 0
v_accvgpr_write_b32 a39, 0
Zvaa 164,208,160
v_accvgpr_write_b32 a40, 0
v_accvgpr_write_b32 a41, 0
Mvaa 164,212,164
v_accvgpr_write_b32 a42, 0
v_accvgpr_write_b32 a43, 0
Mvaa 164,216,168
v_accvgpr_write_b32 a44, 0
v_accvgpr_write_b32 a45, 0
Mvaa 164,220,172
v_accvgpr_write_b32 a46, 0
v_accvgpr_write_b32 a47, 0
Zvaa 180,208,176
v_accvgpr_write_b32 a48, 0
v_accvgpr_write_b32 a49, 0
Mvaa 180,212,180
v_accvgpr_write_b32 a50, 0
v_accvgpr_write_b32 a51, 0
Mvaa 180,216,184
v_accvgpr_write_b32 a52, 0
v_accvgpr_write_b32 a53, 0
Mvaa 180,220,188
s_waitcnt lgkmcnt(4)
v_accvgpr_write_b32 a54, 0
v_accvgpr_write_b32 a55, 0
Zvaa 136,224,128
Ra 192,2,32768
v_accvgpr_write_b32 a56, 0
Mvaa 136,228,132
Ra 196,2,33792
v_accvgpr_write_b32 a57, 0
Mvaa 136,232,136
Ra 200,2,34816
v_accvgpr_write_b32 a58, 0
Mvaa 136,236,140
Ra 204,2,35840
v_accvgpr_write_b32 a59, 0
Zvaa 152,224,144
v_accvgpr_write_b32 a60, 0
v_accvgpr_write_b32 a61, 0
Mvaa 152,228,148
v_accvgpr_write_b32 a62, 0
v_accvgpr_write_b32 a63, 0
Mvaa 152,232,152
v_accvgpr_write_b32 a64, 0
v_accvgpr_write_b32 a65, 0
Mvaa 152,236,156
v_accvgpr_write_b32 a66, 0
v_accvgpr_write_b32 a67, 0
Zvaa 168,224,160
v_accvgpr_write_b32 a68, 0
v_accvgpr_write_b32 a69, 0
Mvaa 168,228,164
v_accvgpr_write_b32 a70, 0
v_accvgpr_write_b32 a71, 0
Mvaa 168,232,168
v_accvgpr_write_b32 a72, 0
v_accvgpr_write_b32 a73, 0
Mvaa 168,236,172
v_accvgpr_write_b32 a74, 0
v_accvgpr_write_b32 a75, 0
Zvaa 184,224,176
v_accvgpr_write_b32 a76, 0
v_accvgpr_write_b32 a77, 0
Mvaa 184,228,180
v_accvgpr_write_b32 a78, 0
v_accvgpr_write_b32 a79, 0
Mvaa 184,232,184
v_accvgpr_write_b32 a80, 0
v_accvgpr_write_b32 a81, 0
Mvaa 184,236,188
s_waitcnt lgkmcnt(4)
v_accvgpr_write_b32 a82, 0
v_accvgpr_write_b32 a83, 0
Zvaa 140,240,128
Ra 208,2,36864
v_accvgpr_write_b32 a84, 0
Mvaa 140,244,132
Ra 212,2,37888
v_accvgpr_write_b32 a85, 0
Mvaa 140,248,136
Ra 216,2,38912
v_accvgpr_write_b32 a86, 0
Mvaa 140,252,140
Ra 220,2,39936
v_accvgpr_write_b32 a87, 0
Zvaa 156,240,144
v_accvgpr_write_b32 a88, 0
v_accvgpr_write_b32 a89, 0
Mvaa 156,244,148
v_accvgpr_write_b32 a90, 0
v_accvgpr_write_b32 a91, 0
Mvaa 156,248,152
v_accvgpr_write_b32 a92, 0
v_accvgpr_write_b32 a93, 0
Mvaa 156,252,156
v_accvgpr_write_b32 a94, 0
v_accvgpr_write_b32 a95, 0
Zvaa 172,240,160
v_accvgpr_write_b32 a96, 0
v_accvgpr_write_b32 a97, 0
Mvaa 172,244,164
v_accvgpr_write_b32 a98, 0
v_accvgpr_write_b32 a99, 0
Mvaa 172,248,168
v_accvgpr_write_b32 a100, 0
v_accvgpr_write_b32 a101, 0
Mvaa 172,252,172
v_accvgpr_write_b32 a102, 0
v_accvgpr_write_b32 a103, 0
Zvaa 188,240,176
v_accvgpr_write_b32 a104, 0
v_accvgpr_write_b32 a105, 0
Mvaa 188,244,180
v_accvgpr_write_b32 a106, 0
v_accvgpr_write_b32 a107, 0
Mvaa 188,248,184
v_accvgpr_write_b32 a108, 0
v_accvgpr_write_b32 a109, 0
Mvaa 188,252,188
v_accvgpr_write_b32 a110, 0
v_accvgpr_write_b32 a111, 0
v_accvgpr_write_b32 a112, 0
v_accvgpr_write_b32 a113, 0
v_accvgpr_write_b32 a114, 0
v_accvgpr_write_b32 a115, 0
v_accvgpr_write_b32 a116, 0
v_accvgpr_write_b32 a117, 0
v_accvgpr_write_b32 a118, 0
v_accvgpr_write_b32 a119, 0
v_accvgpr_write_b32 a120, 0
v_accvgpr_write_b32 a121, 0
v_accvgpr_write_b32 a122, 0
v_accvgpr_write_b32 a123, 0
v_accvgpr_write_b32 a124, 0
v_accvgpr_write_b32 a125, 0
v_accvgpr_write_b32 a126, 0
v_accvgpr_write_b32 a127, 0
s_barrier
s_mov_b32 m0, s53
s_mov_b32 s38, 139264
buffer_load_dwordx4 v4, s[12:15], s38 offen offset:0 sc1 lds
buffer_load_dwordx4 v4, s[12:15], s38 offen offset:1024 sc1 lds
buffer_load_dwordx4 v4, s[12:15], s38 offen offset:2048 sc1 lds
buffer_load_dwordx4 v4, s[12:15], s38 offen offset:3072 sc1 lds
v_lshrrev_b32 v24, 4, v0
v_and_b32 v25, 15, v0
s_lshl_b32 s3, s32, 4
v_add_u32 v26, s3, v24
v_mul_u32_u24 v26, 7168, v26
v_lshlrev_b32 v24, 1, v24
v_xor_b32 v24, v24, v25
v_xor_b32 v25, 8, v24
v_lshl_add_u32 v24, v24, 4, v26
v_lshl_add_u32 v25, v25, 4, v26
s_add_u32 m0, s44, 131072
s_add_u32 s3, s5, 0
buffer_load_dwordx4 v24, s[24:27], s3 offen offset:0 nt lds
s_add_u32 s3, s5, 27648
buffer_load_dwordx4 v24, s[24:27], s3 offen offset:1024 nt lds
s_add_u32 s3, s5, 55296
buffer_load_dwordx4 v25, s[24:27], s3 offen offset:2048 nt lds
s_add_u32 s3, s5, 82944
buffer_load_dwordx4 v25, s[24:27], s3 offen offset:3072 nt lds
s_add_u32 m0, s44, 147456
s_add_u32 s3, s5, 458752
buffer_load_dwordx4 v24, s[24:27], s3 offen offset:0 nt lds
s_add_u32 s3, s5, 486400
buffer_load_dwordx4 v24, s[24:27], s3 offen offset:1024 nt lds
s_add_u32 s3, s5, 514048
buffer_load_dwordx4 v25, s[24:27], s3 offen offset:2048 nt lds
s_add_u32 s3, s5, 541696
buffer_load_dwordx4 v25, s[24:27], s3 offen offset:3072 nt lds
v_lshrrev_b32 v24, 1, v0
v_mul_u32_u24 v24, 7168, v24
v_and_b32 v25, 1, v0
v_lshl_add_u32 v24, v25, 7, v24
s_mul_i32 s3, s32, 229376
s_add_u32 s3, s3, s5
buffer_load_dword v31, v24, s[68:71], s3 offen nt
s_mov_b32 s38, 174080
s_mov_b32 s39, 121856
s_mov_b32 s37, -1
s_cmp_lg_u32 s34, 0
s_cbranch_scc1 L_k2_nomask0
s_nop 7
s_add_u32 s3, s37, 1
s_lshl_b32 s3, s3, 6
v_subrev_u32 v1, s3, v6
v_cmp_gt_i32 s[56:57], -16, v1
v_cmp_gt_i32 s[58:59], -15, v1
v_cmp_gt_i32 s[60:61], -14, v1
v_cmp_gt_i32 s[62:63], -13, v1
v_cndmask_b32 v176, v176, v20, s[56:57]
v_cndmask_b32 v177, v177, v20, s[58:59]
v_cndmask_b32 v178, v178, v20, s[60:61]
v_cndmask_b32 v179, v179, v20, s[62:63]
v_cmp_gt_i32 s[56:57], 0, v1
v_cmp_gt_i32 s[58:59], 1, v1
v_cmp_gt_i32 s[60:61], 2, v1
v_cmp_gt_i32 s[62:63], 3, v1
v_cndmask_b32 v160, v160, v20, s[56:57]
v_cndmask_b32 v161, v161, v20, s[58:59]
v_cndmask_b32 v162, v162, v20, s[60:61]
v_cndmask_b32 v163, v163, v20, s[62:63]
v_cndmask_b32 v180, v180, v20, s[56:57]
v_cndmask_b32 v181, v181, v20, s[58:59]
v_cndmask_b32 v182, v182, v20, s[60:61]
v_cndmask_b32 v183, v183, v20, s[62:63]
v_cmp_gt_i32 s[56:57], 16, v1
v_cmp_gt_i32 s[58:59], 17, v1
v_cmp_gt_i32 s[60:61], 18, v1
v_cmp_gt_i32 s[62:63], 19, v1
v_cndmask_b32 v164, v164, v20, s[56:57]
v_cndmask_b32 v165, v165, v20, s[58:59]
v_cndmask_b32 v166, v166, v20, s[60:61]
v_cndmask_b32 v167, v167, v20, s[62:63]
v_cndmask_b32 v184, v184, v20, s[56:57]
v_cndmask_b32 v185, v185, v20, s[58:59]
v_cndmask_b32 v186, v186, v20, s[60:61]
v_cndmask_b32 v187, v187, v20, s[62:63]
v_cmp_gt_i32 s[56:57], 32, v1
v_cmp_gt_i32 s[58:59], 33, v1
v_cmp_gt_i32 s[60:61], 34, v1
v_cmp_gt_i32 s[62:63], 35, v1
v_cndmask_b32 v168, v168, v20, s[56:57]
v_cndmask_b32 v169, v169, v20, s[58:59]
v_cndmask_b32 v170, v170, v20, s[60:61]
v_cndmask_b32 v171, v171, v20, s[62:63]
v_cndmask_b32 v188, v188, v20, s[56:57]
v_cndmask_b32 v189, v189, v20, s[58:59]
v_cndmask_b32 v190, v190, v20, s[60:61]
v_cndmask_b32 v191, v191, v20, s[62:63]
v_cmp_gt_i32 s[56:57], 48, v1
v_cmp_gt_i32 s[58:59], 49, v1
v_cmp_gt_i32 s[60:61], 50, v1
v_cmp_gt_i32 s[62:63], 51, v1
v_cndmask_b32 v172, v172, v20, s[56:57]
v_cndmask_b32 v173, v173, v20, s[58:59]
v_cndmask_b32 v174, v174, v20, s[60:61]
v_cndmask_b32 v175, v175, v20, s[62:63]
s_nop 1
L_k2_nomask0:
s_mov_b32 s37, 0
s_nop 7
v_max3_f32 v21, v128, v129, v130
v_max3_f32 v21, v21, v131, v132
v_max3_f32 v21, v21, v133, v134
v_max3_f32 v21, v21, v135, v136
v_max3_f32 v21, v21, v137, v138
v_max3_f32 v21, v21, v139, v140
v_max3_f32 v21, v21, v141, v142
v_max_f32 v21, v21, v143
v_mov_b32 v1, v21
s_nop 1
v_permlane16_swap_b32 v1, v21
v_max_f32 v21, v21, v1
v_mov_b32 v1, v21
s_nop 1
v_permlane32_swap_b32 v1, v21
v_max_f32 v21, v21, v1
v_add_f32 v21, 0x40e00000, v21
Vs 128,128,21
Vs 129,129,21
Vs 130,130,21
Vs 131,131,21
Vs 132,132,21
Vs 133,133,21
Vs 134,134,21
Vs 135,135,21
Vs 136,136,21
Vs 137,137,21
Vs 138,138,21
Vs 139,139,21
Vs 140,140,21
Vs 141,141,21
Vs 142,142,21
Vs 143,143,21
v_sub_f32 v32, 0, v21
v_sub_f32 v33, 0, v21
v_sub_f32 v34, 0, v21
v_sub_f32 v35, 0, v21
v_max3_f32 v21, v144, v145, v146
v_max3_f32 v21, v21, v147, v148
v_max3_f32 v21, v21, v149, v150
v_max3_f32 v21, v21, v151, v152
v_max3_f32 v21, v21, v153, v154
v_max3_f32 v21, v21, v155, v156
v_max3_f32 v21, v21, v157, v158
v_max_f32 v21, v21, v159
v_mov_b32 v1, v21
s_nop 1
v_permlane16_swap_b32 v1, v21
v_max_f32 v21, v21, v1
v_mov_b32 v1, v21
s_nop 1
v_permlane32_swap_b32 v1, v21
v_max_f32 v21, v21, v1
v_add_f32 v21, 0x40e00000, v21
Vs 144,144,21
Vs 145,145,21
Vs 146,146,21
Vs 147,147,21
Vs 148,148,21
Vs 149,149,21
Vs 150,150,21
Vs 151,151,21
Vs 152,152,21
Vs 153,153,21
Vs 154,154,21
Vs 155,155,21
Vs 156,156,21
Vs 157,157,21
Vs 158,158,21
Vs 159,159,21
v_sub_f32 v36, 0, v21
v_sub_f32 v37, 0, v21
v_sub_f32 v38, 0, v21
v_sub_f32 v39, 0, v21
v_max3_f32 v21, v160, v161, v162
v_max3_f32 v21, v21, v163, v164
v_max3_f32 v21, v21, v165, v166
v_max3_f32 v21, v21, v167, v168
v_max3_f32 v21, v21, v169, v170
v_max3_f32 v21, v21, v171, v172
v_max3_f32 v21, v21, v173, v174
v_max_f32 v21, v21, v175
v_mov_b32 v1, v21
s_nop 1
v_permlane16_swap_b32 v1, v21
v_max_f32 v21, v21, v1
v_mov_b32 v1, v21
s_nop 1
v_permlane32_swap_b32 v1, v21
v_max_f32 v21, v21, v1
v_add_f32 v21, 0x40e00000, v21
Vs 160,160,21
Vs 161,161,21
Vs 162,162,21
Vs 163,163,21
Vs 164,164,21
Vs 165,165,21
Vs 166,166,21
Vs 167,167,21
Vs 168,168,21
Vs 169,169,21
Vs 170,170,21
Vs 171,171,21
Vs 172,172,21
Vs 173,173,21
Vs 174,174,21
Vs 175,175,21
v_sub_f32 v40, 0, v21
v_sub_f32 v41, 0, v21
v_sub_f32 v42, 0, v21
v_sub_f32 v43, 0, v21
v_max3_f32 v21, v176, v177, v178
v_max3_f32 v21, v21, v179, v180
v_max3_f32 v21, v21, v181, v182
v_max3_f32 v21, v21, v183, v184
v_max3_f32 v21, v21, v185, v186
v_max3_f32 v21, v21, v187, v188
v_max3_f32 v21, v21, v189, v190
v_max_f32 v21, v21, v191
v_mov_b32 v1, v21
s_nop 1
v_permlane16_swap_b32 v1, v21
v_max_f32 v21, v21, v1
v_mov_b32 v1, v21
s_nop 1
v_permlane32_swap_b32 v1, v21
v_max_f32 v21, v21, v1
v_add_f32 v21, 0x40e00000, v21
Vs 176,176,21
Vs 177,177,21
Vs 178,178,21
Vs 179,179,21
Vs 180,180,21
Vs 181,181,21
Vs 182,182,21
Vs 183,183,21
Vs 184,184,21
Vs 185,185,21
Vs 186,186,21
Vs 187,187,21
Vs 188,188,21
Vs 189,189,21
Vs 190,190,21
Vs 191,191,21
v_sub_f32 v44, 0, v21
v_sub_f32 v45, 0, v21
v_sub_f32 v46, 0, v21
v_sub_f32 v47, 0, v21
Ve 8,128
Ve 9,129
Ve 10,130
Ve 11,131
Vc 64,8,9
Ve 12,144
Ve 13,145
Vc 65,10,11
Ve 14,146
Ve 15,147
Vc 72,12,13
Ve 8,160
Ve 9,161
Vc 73,14,15
Ve 10,162
Ve 11,163
Vc 80,8,9
Ve 12,176
Ve 13,177
Vc 81,10,11
Ve 14,178
Ve 15,179
Vc 88,12,13
Ve 8,132
Ve 9,133
Vc 89,14,15
Ve 10,134
Ve 11,135
Vc 66,8,9
Ve 12,148
Ve 13,149
Vc 67,10,11
Ve 14,150
Ve 15,151
Vc 74,12,13
Ve 8,164
Ve 9,165
Vc 75,14,15
Ve 10,166
Ve 11,167
Vc 82,8,9
Ve 12,180
Ve 13,181
Vc 83,10,11
Ve 14,182
Ve 15,183
Vc 90,12,13
Vc 91,14,15
v_or_b32 v7, v64, v65
v_or3_b32 v7, v7, v72, v73
v_or3_b32 v7, v7, v80, v81
v_or3_b32 v7, v7, v88, v89
v_or3_b32 v7, v7, v66, v67
v_or3_b32 v7, v7, v74, v75
v_or3_b32 v7, v7, v82, v83
v_or3_b32 v7, v7, v90, v91
s_sub_u32 s35, s35, 1
s_sub_u32 s36, s36, 1
L_k2_wloop:
s_waitcnt lgkmcnt(4)
Cvaa 192,192,128,32
Ve 8,136
Mvaa 192,196,132
Ve 9,137
Mvaa 192,200,136
Ra 224,2,40960
Vc 68,8,9
Mvaa 192,204,140
Ve 10,138
Cvaa 208,192,144,36
Ve 11,139
Mvaa 208,196,148
Ra 228,2,41984
Vc 69,10,11
Mvaa 208,200,152
Ra 232,2,43008
v_or3_b32 v7, v7, v68, v69
Mvaa 208,204,156
Ve 12,152
Cvaa 224,192,160,40
Ve 13,153
Mvaa 224,196,164
Ra 236,2,44032
Vc 76,12,13
Mvaa 224,200,168
Ve 14,154
Mvaa 224,204,172
Ve 15,155
Cvaa 240,192,176,44
Ve 8,168
Mvaa 240,196,180
Ve 9,169
Mvaa 240,200,184
Ve 10,170
Mvaa 240,204,188
s_waitcnt lgkmcnt(4)
Ve 11,171
Cvaa 196,208,128,32
Ra 240,2,45056
Vc 77,14,15
Mvaa 196,212,132
Ra 244,2,46080
Vc 84,8,9
Mvaa 196,216,136
Ra 248,2,47104
Vc 85,10,11
Mvaa 196,220,140
Ra 252,2,48128
v_or3_b32 v7, v7, v76, v77
Cvaa 212,208,144,36
Ve 12,184
Mvaa 212,212,148
Ve 13,185
Mvaa 212,216,152
Ve 14,186
Mvaa 212,220,156
Ve 15,187
Cvaa 228,208,160,40
Vc 92,12,13
Vc 93,14,15
Mvaa 228,212,164
Ve 8,140
Mvaa 228,216,168
Ve 9,141
Mvaa 228,220,172
Vc 70,8,9
v_or3_b32 v7, v7, v84, v85
Cvaa 244,208,176,44
Ve 10,142
Mvaa 244,212,180
Ve 11,143
Mvaa 244,216,184
Ve 12,156
Mvaa 244,220,188
s_waitcnt lgkmcnt(4)
Ve 13,157
Cvaa 200,224,128,32
Ra 192,2,16384
Vc 71,10,11
Mvaa 200,228,132
Ra 196,2,17408
Vc 78,12,13
Mvaa 200,232,136
Ra 200,2,18432
v_or3_b32 v7, v7, v92, v93
Mvaa 200,236,140
Ra 204,2,19456
v_or3_b32 v7, v7, v70, v71
Cvaa 216,224,144,36
Ve 14,158
Mvaa 216,228,148
Ve 15,159
Mvaa 216,232,152
Ve 8,172
Mvaa 216,236,156
Ve 9,173
Cvaa 232,224,160,40
Ve 10,174
Mvaa 232,228,164
Ve 11,175
Mvaa 232,232,168
Vc 79,14,15
Vc 86,8,9
Mvaa 232,236,172
Ve 12,188
Cvaa 248,224,176,44
Ve 13,189
Mvaa 248,228,180
Vc 87,10,11
Vc 94,12,13
Mvaa 248,232,184
Ve 14,190
Mvaa 248,236,188
s_waitcnt lgkmcnt(4)
Ve 15,191
Cvaa 204,240,128,32
Ra 208,2,20480
Vc 95,14,15
Mvaa 204,244,132
Ra 212,2,21504
v_or3_b32 v7, v7, v78, v79
Mvaa 204,248,136
Ra 216,2,22528
v_or3_b32 v7, v7, v86, v87
Mvaa 204,252,140
Ra 220,2,23552
v_or3_b32 v7, v7, v94, v95
Cvaa 220,240,144,36
v_and_b32 v1, 0x40004000, v7
v_cmp_ne_u32 vcc, 0, v1
Mvaa 220,244,148
Mvaa 220,248,152
Mvaa 220,252,156
Cvaa 236,240,160,40
Mvaa 236,244,164
Mvaa 236,248,168
Mvaa 236,252,172
Cvaa 252,240,176,44
Mvaa 252,244,180
Mvaa 252,248,184
Mvaa 252,252,188
s_cbranch_vccnz L_k2_fb_we
L_k2_fbr_we:
s_cmp_ge_u32 s37, s46
s_cbranch_scc1 L_k2_mk_we
L_k2_mkr_we:
s_waitcnt vmcnt(12)
s_barrier
s_waitcnt lgkmcnt(4)
Maav 0,192,64
s_add_u32 m0, s54, 49152
Ve 8,192
Maav 0,196,68
buffer_load_dwordx4 v4, s[12:15], s39 offen offset:0 sc1 lds
Maav 32,192,72
Ve 9,193
Maav 32,196,76
Ra 224,2,24576
Vc 96,8,9
Maav 64,192,80
Ve 10,194
Maav 64,196,84
Ve 11,195
Maav 96,192,88
Ra 228,2,25600
Vc 97,10,11
Maav 96,196,92
Ra 232,2,26624
v_or_b32 v7, v96, v97
Maav 4,200,64
Ve 12,208
Maav 4,204,68
buffer_load_dwordx4 v4, s[12:15], s39 offen offset:1024 sc1 lds
Maav 36,200,72
Ve 13,209
Maav 36,204,76
Ra 236,2,27648
Vc 104,12,13
Maav 68,200,80
Ve 14,210
Maav 68,204,84
Ve 15,211
Maav 100,200,88
Ve 8,224
Maav 100,204,92
Ve 9,225
Mvvv 48,16,64
Ve 10,226
Mvvv 48,16,68
buffer_load_dwordx4 v4, s[12:15], s39 offen offset:2048 sc1 lds
s_waitcnt lgkmcnt(4)
Maav 8,208,64
Ra 240,2,28672
Vc 105,14,15
Maav 8,212,68
Ra 244,2,29696
Vc 112,8,9
Maav 40,208,72
Ra 248,2,30720
v_or3_b32 v7, v7, v104, v105
Maav 40,212,76
Ve 11,227
Maav 72,208,80
Ra 252,2,31744
Vc 113,10,11
Maav 72,212,84
Ve 12,240
Maav 104,208,88
Ve 13,241
Maav 104,212,92
buffer_load_dwordx4 v4, s[12:15], s39 offen offset:3072 sc1 lds
Maav 12,216,64
Ve 14,242
Maav 12,220,68
Ve 15,243
Maav 44,216,72
Vc 120,12,13
Vc 121,14,15
Maav 44,220,76
Ve 8,196
Maav 76,216,80
Ve 9,197
Maav 76,220,84
Vc 98,8,9
v_or3_b32 v7, v7, v112, v113
Maav 108,216,88
s_add_u32 m0, s53, 32768
Ve 10,198
Maav 108,220,92
buffer_load_dwordx4 v4, s[12:15], s38 offen offset:0 sc1 lds
Mvvv 52,16,72
Ve 11,199
Mvvv 52,16,76
s_waitcnt lgkmcnt(4)
Ve 12,212
Maav 16,224,64
Ra 192,3,0
Vc 99,10,11
Maav 16,228,68
Ra 196,3,1024
v_or3_b32 v7, v7, v120, v121
Maav 48,224,72
Ra 200,3,2048
v_or3_b32 v7, v7, v98, v99
Maav 48,228,76
Ve 13,213
Maav 80,224,80
s_add_u32 s39, s39, 34816
Ra 204,3,3072
Vc 106,12,13
Maav 80,228,84
buffer_load_dwordx4 v4, s[12:15], s38 offen offset:1024 sc1 lds
Maav 112,224,88
Ve 14,214
Maav 112,228,92
Ve 15,215
Maav 20,232,64
Ve 8,228
Maav 20,236,68
Ve 9,229
Maav 52,232,72
Ve 10,230
Maav 52,236,76
Ve 11,231
Maav 84,232,80
Vc 107,14,15
Vc 114,8,9
Maav 84,236,84
buffer_load_dwordx4 v4, s[12:15], s38 offen offset:2048 sc1 lds
Maav 116,232,88
Ve 12,244
Maav 116,236,92
Ve 13,245
Mvvv 56,16,80
Vc 115,10,11
Vc 122,12,13
Mvvv 56,16,84
s_waitcnt lgkmcnt(4)
Ve 14,246
Maav 24,240,64
Ra 208,3,4096
v_or3_b32 v7, v7, v106, v107
Maav 24,244,68
Ra 212,3,5120
v_or3_b32 v7, v7, v114, v115
Maav 56,240,72
Ve 15,247
Maav 56,244,76
buffer_load_dwordx4 v4, s[12:15], s38 offen offset:3072 sc1 lds
Maav 88,240,80
Ra 216,3,6144
Vc 123,14,15
Maav 88,244,84
Ra 220,3,7168
v_or3_b32 v7, v7, v122, v123
Maav 120,240,88
Maav 120,244,92
Maav 28,248,64
Maav 28,252,68
Maav 60,248,72
Maav 60,252,76
Maav 92,248,80
Maav 92,252,84
Maav 124,248,88
Maav 124,252,92
Mvvv 60,16,88
Mvvv 60,16,92
s_add_u32 s38, s38, 34816
s_add_u32 s37, s37, 1
s_cmp_eq_u32 s37, s35
s_cbranch_scc1 L_k2_trans
s_waitcnt lgkmcnt(4)
Cvaa 128,192,128,32
Ve 8,200
Mvaa 128,196,132
Ve 9,201
Mvaa 128,200,136
Ra 224,3,8192
Vc 100,8,9
Mvaa 128,204,140
Ve 10,202
Cvaa 144,192,144,36
Ve 11,203
Mvaa 144,196,148
Ra 228,3,9216
Vc 101,10,11
Mvaa 144,200,152
Ra 232,3,10240
v_or3_b32 v7, v7, v100, v101
Mvaa 144,204,156
Ve 12,216
Cvaa 160,192,160,40
Ve 13,217
Mvaa 160,196,164
Ra 236,3,11264
Vc 108,12,13
Mvaa 160,200,168
Ve 14,218
Mvaa 160,204,172
Ve 15,219
Cvaa 176,192,176,44
Ve 8,232
Mvaa 176,196,180
Ve 9,233
Mvaa 176,200,184
Ve 10,234
Mvaa 176,204,188
s_waitcnt lgkmcnt(4)
Ve 11,235
Cvaa 132,208,128,32
Ra 240,3,12288
Vc 109,14,15
Mvaa 132,212,132
Ra 244,3,13312
Vc 116,8,9
Mvaa 132,216,136
Ra 248,3,14336
Vc 117,10,11
Mvaa 132,220,140
Ra 252,3,15360
v_or3_b32 v7, v7, v108, v109
Cvaa 148,208,144,36
Ve 12,248
Mvaa 148,212,148
Ve 13,249
Mvaa 148,216,152
Ve 14,250
Mvaa 148,220,156
Ve 15,251
Cvaa 164,208,160,40
Vc 124,12,13
Vc 125,14,15
Mvaa 164,212,164
Ve 8,204
Mvaa 164,216,168
Ve 9,205
Mvaa 164,220,172
Vc 102,8,9
v_or3_b32 v7, v7, v116, v117
Cvaa 180,208,176,44
Ve 10,206
Mvaa 180,212,180
Ve 11,207
Mvaa 180,216,184
Ve 12,220
Mvaa 180,220,188
s_waitcnt lgkmcnt(4)
Ve 13,221
Cvaa 136,224,128,32
Ra 192,2,49152
Vc 103,10,11
Mvaa 136,228,132
Ra 196,2,50176
Vc 110,12,13
Mvaa 136,232,136
Ra 200,2,51200
v_or3_b32 v7, v7, v124, v125
Mvaa 136,236,140
Ra 204,2,52224
v_or3_b32 v7, v7, v102, v103
Cvaa 152,224,144,36
Ve 14,222
Mvaa 152,228,148
Ve 15,223
Mvaa 152,232,152
Ve 8,236
Mvaa 152,236,156
Ve 9,237
Cvaa 168,224,160,40
Ve 10,238
Mvaa 168,228,164
Ve 11,239
Mvaa 168,232,168
Vc 111,14,15
Vc 118,8,9
Mvaa 168,236,172
Ve 12,252
Cvaa 184,224,176,44
Ve 13,253
Mvaa 184,228,180
Vc 119,10,11
Vc 126,12,13
Mvaa 184,232,184
Ve 14,254
Mvaa 184,236,188
s_waitcnt lgkmcnt(4)
Ve 15,255
Cvaa 140,240,128,32
Ra 208,2,53248
Vc 127,14,15
Mvaa 140,244,132
Ra 212,2,54272
v_or3_b32 v7, v7, v110, v111
Mvaa 140,248,136
Ra 216,2,55296
v_or3_b32 v7, v7, v118, v119
Mvaa 140,252,140
Ra 220,2,56320
v_or3_b32 v7, v7, v126, v127
Cvaa 156,240,144,36
v_and_b32 v1, 0x40004000, v7
v_cmp_ne_u32 vcc, 0, v1
Mvaa 156,244,148
Mvaa 156,248,152
Mvaa 156,252,156
Cvaa 172,240,160,40
Mvaa 172,244,164
Mvaa 172,248,168
Mvaa 172,252,172
Cvaa 188,240,176,44
Mvaa 188,244,180
Mvaa 188,248,184
Mvaa 188,252,188
s_cbranch_vccnz L_k2_fb_wo
L_k2_fbr_wo:
s_cmp_ge_u32 s37, s46
s_cbranch_scc1 L_k2_mk_wo
L_k2_mkr_wo:
s_waitcnt vmcnt(12)
s_barrier
s_waitcnt lgkmcnt(4)
Maav 0,192,96
s_add_u32 m0, s53, 16384
Ve 8,128
Maav 0,196,100
buffer_load_dwordx4 v4, s[12:15], s39 offen offset:0 sc1 lds
Maav 32,192,104
Ve 9,129
Maav 32,196,108
Ra 224,2,57344
Vc 64,8,9
Maav 64,192,112
Ve 10,130
Maav 64,196,116
Ve 11,131
Maav 96,192,120
Ra 228,2,58368
Vc 65,10,11
Maav 96,196,124
Ra 232,2,59392
v_or_b32 v7, v64, v65
Maav 4,200,96
Ve 12,144
Maav 4,204,100
buffer_load_dwordx4 v4, s[12:15], s39 offen offset:1024 sc1 lds
Maav 36,200,104
Ve 13,145
Maav 36,204,108
Ra 236,2,60416
Vc 72,12,13
Maav 68,200,112
Ve 14,146
Maav 68,204,116
Ve 15,147
Maav 100,200,120
Ve 8,160
Maav 100,204,124
Ve 9,161
Mvvv 48,16,96
Ve 10,162
Mvvv 48,16,100
buffer_load_dwordx4 v4, s[12:15], s39 offen offset:2048 sc1 lds
s_waitcnt lgkmcnt(4)
Maav 8,208,96
Ra 240,2,61440
Vc 73,14,15
Maav 8,212,100
Ra 244,2,62464
Vc 80,8,9
Maav 40,208,104
Ra 248,2,63488
v_or3_b32 v7, v7, v72, v73
Maav 40,212,108
Ve 11,163
Maav 72,208,112
Ra 252,2,64512
Vc 81,10,11
Maav 72,212,116
Ve 12,176
Maav 104,208,120
Ve 13,177
Maav 104,212,124
buffer_load_dwordx4 v4, s[12:15], s39 offen offset:3072 sc1 lds
Maav 12,216,96
Ve 14,178
Maav 12,220,100
Ve 15,179
Maav 44,216,104
Vc 88,12,13
Vc 89,14,15
Maav 44,220,108
Ve 8,132
Maav 76,216,112
Ve 9,133
Maav 76,220,116
Vc 66,8,9
v_or3_b32 v7, v7, v80, v81
Maav 108,216,120
s_mov_b32 m0, s54
Ve 10,134
Maav 108,220,124
buffer_load_dwordx4 v4, s[12:15], s38 offen offset:0 sc1 lds
Mvvv 52,16,104
Ve 11,135
Mvvv 52,16,108
s_waitcnt lgkmcnt(4)
Ve 12,148
Maav 16,224,96
Ra 192,3,32768
Vc 67,10,11
Maav 16,228,100
Ra 196,3,33792
v_or3_b32 v7, v7, v88, v89
Maav 48,224,104
Ra 200,3,34816
v_or3_b32 v7, v7, v66, v67
Maav 48,228,108
Ve 13,149
Maav 80,224,112
s_add_u32 s39, s39, 34816
Ra 204,3,35840
Vc 74,12,13
Maav 80,228,116
buffer_load_dwordx4 v4, s[12:15], s38 offen offset:1024 sc1 lds
Maav 112,224,120
Ve 14,150
Maav 112,228,124
Ve 15,151
Maav 20,232,96
Ve 8,164
Maav 20,236,100
Ve 9,165
Maav 52,232,104
Ve 10,166
Maav 52,236,108
Ve 11,167
Maav 84,232,112
Vc 75,14,15
Vc 82,8,9
Maav 84,236,116
buffer_load_dwordx4 v4, s[12:15], s38 offen offset:2048 sc1 lds
Maav 116,232,120
Ve 12,180
Maav 116,236,124
Ve 13,181
Mvvv 56,16,112
Vc 83,10,11
Vc 90,12,13
Mvvv 56,16,116
s_waitcnt lgkmcnt(4)
Ve 14,182
Maav 24,240,96
Ra 208,3,36864
v_or3_b32 v7, v7, v74, v75
Maav 24,244,100
Ra 212,3,37888
v_or3_b32 v7, v7, v82, v83
Maav 56,240,104
Ve 15,183
Maav 56,244,108
buffer_load_dwordx4 v4, s[12:15], s38 offen offset:3072 sc1 lds
Maav 88,240,112
Ra 216,3,38912
Vc 91,14,15
Maav 88,244,116
Ra 220,3,39936
v_or3_b32 v7, v7, v90, v91
Maav 120,240,120
Maav 120,244,124
Maav 28,248,96
Maav 28,252,100
Maav 60,248,104
Maav 60,252,108
Maav 92,248,112
Maav 92,252,116
Maav 124,248,120
Maav 124,252,124
Mvvv 60,16,120
Mvvv 60,16,124
s_add_u32 s38, s38, 34816
s_add_u32 s37, s37, 1
v_swap_b32 v2, v3
s_xor_b32 s53, s53, 65536
s_xor_b32 s54, s54, 65536
s_branch L_k2_wloop
L_k2_trans:
s_waitcnt lgkmcnt(4)
Cvaa 128,192,128,32
Ve 8,200
Mvaa 128,196,132
Ve 9,201
Mvaa 128,200,136
Ra 224,3,8192
Vc 100,8,9
Mvaa 128,204,140
Ve 10,202
Cvaa 144,192,144,36
Ra 228,3,9216
Ra 232,3,10240
Mvaa 144,196,148
Ve 11,203
Mvaa 144,200,152
Ra 236,3,11264
Vc 101,10,11
Mvaa 144,204,156
s_waitcnt lgkmcnt(4)
Ve 12,216
Cvaa 132,208,128,32
Ra 240,3,12288
v_or3_b32 v7, v7, v100, v101
Mvaa 132,212,132
Ve 13,217
Mvaa 132,216,136
Ra 244,3,13312
Vc 108,12,13
Mvaa 132,220,140
Ve 14,218
Cvaa 148,208,144,36
Ve 15,219
Mvaa 148,212,148
Ra 248,3,14336
Vc 109,14,15
Mvaa 148,216,152
Ra 252,3,15360
v_or3_b32 v7, v7, v108, v109
Mvaa 148,220,156
s_waitcnt lgkmcnt(4)
Ve 8,232
Cvaa 136,224,128,32
Ve 9,233
Mvaa 136,228,132
Ra 192,2,49152
Vc 116,8,9
Mvaa 136,232,136
Ve 10,234
Mvaa 136,236,140
Ve 11,235
Cvaa 152,224,144,36
Ra 196,2,50176
Vc 117,10,11
Mvaa 152,228,148
Ra 200,2,51200
v_or3_b32 v7, v7, v116, v117
Mvaa 152,232,152
Ra 204,2,52224
Mvaa 152,236,156
s_waitcnt lgkmcnt(4)
Ve 12,248
Cvaa 140,240,128,32
Ve 13,249
Mvaa 140,244,132
Ra 208,2,53248
Vc 124,12,13
Mvaa 140,248,136
Ve 14,250
Mvaa 140,252,140
Ve 15,251
Cvaa 156,240,144,36
Ra 212,2,54272
Vc 125,14,15
Mvaa 156,244,148
Ra 216,2,55296
v_or3_b32 v7, v7, v124, v125
Mvaa 156,248,152
Ra 220,2,56320
Mvaa 156,252,156
Ve 8,204
Ve 9,205
Ve 10,206
Ve 11,207
Ve 12,220
Vc 102,8,9
Ve 13,221
Ve 14,222
Vc 103,10,11
Ve 15,223
Ve 8,236
Vc 110,12,13
Ve 9,237
Ve 10,238
Vc 111,14,15
Ve 11,239
Ve 12,252
Vc 118,8,9
Ve 13,253
Ve 14,254
Vc 119,10,11
Ve 15,255
Vc 126,12,13
Vc 127,14,15
v_or3_b32 v7, v7, v102, v103
v_or3_b32 v7, v7, v110, v111
v_or3_b32 v7, v7, v118, v119
v_or3_b32 v7, v7, v126, v127
v_and_b32 v1, 0x40004000, v7
v_cmp_ne_u32 vcc, 0, v1
s_cbranch_vccnz L_k2_fb_tr
L_k2_fbr_tr:
s_cmp_ge_u32 s37, s45
s_cbranch_scc1 L_k2_mk_tr
L_k2_mkr_tr:
s_waitcnt vmcnt(12)
s_barrier
s_waitcnt lgkmcnt(4)
Maav 0,192,96
s_add_u32 m0, s53, 16384
Ve 8,128
Maav 0,196,100
buffer_load_dwordx4 v4, s[12:15], s39 offen offset:0 sc1 lds
Maav 32,192,104
Ve 9,129
Maav 32,196,108
Ra 224,2,57344
Vc 64,8,9
Maav 64,192,112
Ve 10,130
Maav 64,196,116
Ve 11,131
Maav 96,192,120
Ra 228,2,58368
Vc 65,10,11
Maav 96,196,124
Ra 232,2,59392
v_or_b32 v7, v64, v65
Maav 4,200,96
Ve 12,144
Maav 4,204,100
buffer_load_dwordx4 v4, s[12:15], s39 offen offset:1024 sc1 lds
Maav 36,200,104
Ve 13,145
Maav 36,204,108
Ra 236,2,60416
Vc 72,12,13
Maav 68,200,112
Ve 14,146
Maav 68,204,116
Ve 15,147
Maav 100,200,120
Ve 8,132
Maav 100,204,124
Ve 9,133
Mvvv 48,16,96
Ve 10,134
Mvvv 48,16,100
buffer_load_dwordx4 v4, s[12:15], s39 offen offset:2048 sc1 lds
s_waitcnt lgkmcnt(4)
Maav 8,208,96
Ra 240,2,61440
Vc 73,14,15
Maav 8,212,100
Ra 244,2,62464
Vc 66,8,9
Maav 40,208,104
Ra 248,2,63488
v_or3_b32 v7, v7, v72, v73
Maav 40,212,108
Ve 11,135
Maav 72,208,112
Ra 252,2,64512
Vc 67,10,11
Maav 72,212,116
Ve 12,148
Maav 104,208,120
Ve 13,149
Maav 104,212,124
buffer_load_dwordx4 v4, s[12:15], s39 offen offset:3072 sc1 lds
Maav 12,216,96
Ve 14,150
Maav 12,220,100
Ve 15,151
Maav 44,216,104
Vc 74,12,13
Vc 75,14,15
Maav 44,220,108
v_or3_b32 v7, v7, v66, v67
v_or3_b32 v7, v7, v74, v75
Maav 76,216,112
Maav 76,220,116
Maav 108,216,120
s_mov_b32 m0, s54
Maav 108,220,124
buffer_load_dwordx4 v4, s[12:15], s38 offen offset:0 sc1 lds
Mvvv 52,16,104
Mvvv 52,16,108
s_waitcnt lgkmcnt(4)
Maav 16,224,96
Ra 192,3,32768
Ra 196,3,33792
Maav 16,228,100
Ra 200,3,34816
Ra 204,3,35840
Maav 48,224,104
Maav 48,228,108
Maav 80,224,112
s_add_u32 s39, s39, 34816
Maav 80,228,116
buffer_load_dwordx4 v4, s[12:15], s38 offen offset:1024 sc1 lds
Maav 112,224,120
Maav 112,228,124
Maav 20,232,96
Maav 20,236,100
Maav 52,232,104
Maav 52,236,108
Maav 84,232,112
Maav 84,236,116
buffer_load_dwordx4 v4, s[12:15], s38 offen offset:2048 sc1 lds
Maav 116,232,120
Maav 116,236,124
Mvvv 56,16,112
Mvvv 56,16,116
s_waitcnt lgkmcnt(4)
Maav 24,240,96
Ra 208,3,36864
Ra 212,3,37888
Maav 24,244,100
Ra 216,3,38912
Ra 220,3,39936
Maav 56,240,104
Maav 56,244,108
buffer_load_dwordx4 v4, s[12:15], s38 offen offset:3072 sc1 lds
Maav 88,240,112
Maav 88,244,116
Maav 120,240,120
Maav 120,244,124
Maav 28,248,96
Maav 28,252,100
Maav 60,248,104
Maav 60,252,108
Maav 92,248,112
Maav 92,252,116
Maav 124,248,120
Maav 124,252,124
Mvvv 60,16,120
Mvvv 60,16,124
s_add_u32 s38, s38, 34816
s_add_u32 s37, s37, 1
v_swap_b32 v2, v3
s_xor_b32 s53, s53, 65536
s_xor_b32 s54, s54, 65536
s_lshr_b32 s3, s42, 4
s_mul_i32 s3, s3, 33792
s_and_b32 s47, s42, 15
s_lshl_b32 s47, s47, 4
s_add_u32 s3, s3, s47
v_mov_b32 v24, s3
s_lshr_b32 s3, s43, 4
s_mul_i32 s3, s3, 33792
s_and_b32 s47, s43, 15
s_lshl_b32 s47, s47, 4
s_add_u32 s3, s3, s47
v_mov_b32 v25, s3
v_and_b32 v26, 15, v0
v_cmp_eq_u32 vcc, 1, v26
v_lshrrev_b32 v26, 4, v0
s_lshl_b32 s3, s6, 12
v_cndmask_b32 v24, v24, v25, vcc
v_lshl_add_u32 v24, v26, 8, v24
buffer_load_dwordx4 a[160:163], v24, s[20:23], s3 offen offset:0 sc1
buffer_load_dwordx4 a[164:167], v24, s[20:23], s3 offen offset:1024 sc1
buffer_load_dwordx4 a[168:171], v24, s[20:23], s3 offen offset:2048 sc1
buffer_load_dwordx4 a[172:175], v24, s[20:23], s3 offen offset:3072 sc1
s_waitcnt vmcnt(20)
s_lshl_b32 s3, s34, 20
s_lshl_b32 s47, s33, 15
s_add_u32 s3, s3, s47
s_lshl_b32 s47, s32, 11
s_add_u32 s3, s3, s47
v_lshlrev_b32 v23, 4, v0
v_rcp_f32 v21, v56
v_rcp_f32 v22, v60
Ar 8,64
Ar 9,65
Ar 10,66
Ar 11,67
Ar 12,68
Ar 13,69
Ar 14,70
Ar 15,71
Vm 8,8,21
Vm 9,9,21
Vm 10,10,21
Vm 11,11,21
Vm 12,12,21
Vm 13,13,21
Vm 14,14,21
Vm 15,15,21
Vc 24,8,9
Vc 25,10,11
Vc 26,12,13
Vc 27,14,15
buffer_store_dwordx4 v[24:27], v23, s[16:19], s3 offen offset:0
Ar 8,96
Ar 9,97
Ar 10,98
Ar 11,99
Ar 12,100
Ar 13,101
Ar 14,102
Ar 15,103
Vm 8,8,22
Vm 9,9,22
Vm 10,10,22
Vm 11,11,22
Vm 12,12,22
Vm 13,13,22
Vm 14,14,22
Vm 15,15,22
Vc 28,8,9
Vc 29,10,11
Vc 30,12,13
Vc 31,14,15
buffer_store_dwordx4 v[28:31], v23, s[16:19], s3 offen offset:1024
s_add_u32 s3, s3, 8192
Ar 8,72
Ar 9,73
Ar 10,74
Ar 11,75
Ar 12,76
Ar 13,77
Ar 14,78
Ar 15,79
Vm 8,8,21
Vm 9,9,21
Vm 10,10,21
Vm 11,11,21
Vm 12,12,21
Vm 13,13,21
Vm 14,14,21
Vm 15,15,21
Vc 24,8,9
Vc 25,10,11
Vc 26,12,13
Vc 27,14,15
buffer_store_dwordx4 v[24:27], v23, s[16:19], s3 offen offset:0
Ar 8,104
Ar 9,105
Ar 10,106
Ar 11,107
Ar 12,108
Ar 13,109
Ar 14,110
Ar 15,111
Vm 8,8,22
Vm 9,9,22
Vm 10,10,22
Vm 11,11,22
Vm 12,12,22
Vm 13,13,22
Vm 14,14,22
Vm 15,15,22
Vc 28,8,9
Vc 29,10,11
Vc 30,12,13
Vc 31,14,15
buffer_store_dwordx4 v[28:31], v23, s[16:19], s3 offen offset:1024
s_add_u32 s3, s3, 8192
Ar 8,80
Ar 9,81
Ar 10,82
Ar 11,83
Ar 12,84
Ar 13,85
Ar 14,86
Ar 15,87
Vm 8,8,21
Vm 9,9,21
Vm 10,10,21
Vm 11,11,21
Vm 12,12,21
Vm 13,13,21
Vm 14,14,21
Vm 15,15,21
Vc 24,8,9
Vc 25,10,11
Vc 26,12,13
Vc 27,14,15
buffer_store_dwordx4 v[24:27], v23, s[16:19], s3 offen offset:0
Ar 8,112
Ar 9,113
Ar 10,114
Ar 11,115
Ar 12,116
Ar 13,117
Ar 14,118
Ar 15,119
Vm 8,8,22
Vm 9,9,22
Vm 10,10,22
Vm 11,11,22
Vm 12,12,22
Vm 13,13,22
Vm 14,14,22
Vm 15,15,22
Vc 28,8,9
Vc 29,10,11
Vc 30,12,13
Vc 31,14,15
buffer_store_dwordx4 v[28:31], v23, s[16:19], s3 offen offset:1024
s_add_u32 s3, s3, 8192
Ar 8,88
Ar 9,89
Ar 10,90
Ar 11,91
Ar 12,92
Ar 13,93
Ar 14,94
Ar 15,95
Vm 8,8,21
Vm 9,9,21
Vm 10,10,21
Vm 11,11,21
Vm 12,12,21
Vm 13,13,21
Vm 14,14,21
Vm 15,15,21
Vc 24,8,9
Vc 25,10,11
Vc 26,12,13
Vc 27,14,15
buffer_store_dwordx4 v[24:27], v23, s[16:19], s3 offen offset:0
Ar 8,120
Ar 9,121
Ar 10,122
Ar 11,123
Ar 12,124
Ar 13,125
Ar 14,126
Ar 15,127
Vm 8,8,22
Vm 9,9,22
Vm 10,10,22
Vm 11,11,22
Vm 12,12,22
Vm 13,13,22
Vm 14,14,22
Vm 15,15,22
Vc 28,8,9
Vc 29,10,11
Vc 30,12,13
Vc 31,14,15
buffer_store_dwordx4 v[28:31], v23, s[16:19], s3 offen offset:1024
s_cmp_eq_u32 s34, 7
s_cbranch_scc1 L_noffn0
v_lshrrev_b32 v24, 4, v0
v_bfe_u32 v25, v0, 2, 2
v_lshl_add_u32 v26, v24, 3, v25
v_lshlrev_b32 v26, 8, v26
v_and_b32 v27, 3, v0
v_lshl_add_u32 v26, v27, 3, v26
v_and_b32 v27, 1, v24
v_lshl_add_u32 v25, v27, 2, v25
s_lshl_b32 s3, s32, 1
v_xor_b32 v25, s3, v25
v_lshl_add_u32 v26, v25, 5, v26
v_add_u32 v26, 131072, v26
v_xor_b32 v27, 32, v26
s_waitcnt vmcnt(8) lgkmcnt(0)
s_barrier
ds_read_b64_tr_b16 v[160:161], v26 offset:0
ds_read_b64_tr_b16 v[162:163], v26 offset:1024
ds_read_b64_tr_b16 v[164:165], v27 offset:0
ds_read_b64_tr_b16 v[166:167], v27 offset:1024
ds_read_b64_tr_b16 v[168:169], v26 offset:8192
ds_read_b64_tr_b16 v[170:171], v26 offset:9216
ds_read_b64_tr_b16 v[172:173], v27 offset:8192
ds_read_b64_tr_b16 v[174:175], v27 offset:9216
ds_read_b64_tr_b16 v[176:177], v26 offset:16384
ds_read_b64_tr_b16 v[178:179], v26 offset:17408
ds_read_b64_tr_b16 v[180:181], v27 offset:16384
ds_read_b64_tr_b16 v[182:183], v27 offset:17408
ds_read_b64_tr_b16 v[184:185], v26 offset:24576
ds_read_b64_tr_b16 v[186:187], v26 offset:25600
ds_read_b64_tr_b16 v[188:189], v27 offset:24576
s_waitcnt lgkmcnt(9)
ds_read_b64_tr_b16 v[190:191], v27 offset:25600
v_and_b32 v25, 15, v0
v_mul_u32_u24 v28, 14336, v25
v_lshl_add_u32 v28, v24, 4, v28
v_mov_b32 v29, 2146435072
v_cmp_gt_u32 vcc, 2, v25
s_mul_i32 s3, s6, 57344
s_lshl_b32 s47, s4, 9
s_add_u32 s3, s3, s47
v_cndmask_b32 v28, v29, v28, vcc
s_lshl_b32 s47, s32, 7
s_add_u32 s3, s3, s47
s_add_u32 s7, s3, 6291456
s_waitcnt lgkmcnt(0)
Zvva 224,160,160
Zvva 228,164,160
Mvva 224,168,164
Mvva 228,172,164
Mvva 224,176,168
Mvva 228,180,168
Mvva 224,184,172
Mvva 228,188,172
s_barrier
v_lshrrev_b32 v24, 4, v0
v_and_b32 v25, 15, v0
s_lshl_b32 s3, s32, 4
v_add_u32 v26, s3, v24
v_mul_u32_u24 v26, 7168, v26
v_lshlrev_b32 v24, 1, v24
v_xor_b32 v24, v24, v25
v_xor_b32 v25, 8, v24
v_lshl_add_u32 v24, v24, 4, v26
v_lshl_add_u32 v25, v25, 4, v26
s_add_u32 m0, s44, 131072
s_add_u32 s3, s5, 0
buffer_load_dwordx4 v24, s[68:71], s3 offen offset:0 nt lds
s_add_u32 s3, s5, 27648
buffer_load_dwordx4 v24, s[68:71], s3 offen offset:1024 nt lds
s_add_u32 s3, s5, 55296
buffer_load_dwordx4 v25, s[68:71], s3 offen offset:2048 nt lds
s_add_u32 s3, s5, 82944
buffer_load_dwordx4 v25, s[68:71], s3 offen offset:3072 nt lds
s_add_u32 m0, s44, 147456
s_add_u32 s3, s5, 458752
buffer_load_dwordx4 v24, s[68:71], s3 offen offset:0 nt lds
s_add_u32 s3, s5, 486400
buffer_load_dwordx4 v24, s[68:71], s3 offen offset:1024 nt lds
s_add_u32 s3, s5, 514048
buffer_load_dwordx4 v25, s[68:71], s3 offen offset:2048 nt lds
s_add_u32 s3, s5, 541696
buffer_load_dwordx4 v25, s[68:71], s3 offen offset:3072 nt lds
buffer_store_dwordx4 v[224:227], v28, s[20:23], s7 offen offset:0
buffer_store_dwordx4 v[228:231], v28, s[20:23], s7 offen offset:64
L_noffn0:
L_k2_nloop:
s_waitcnt lgkmcnt(4)
Cvaa 192,192,128,32
Ve 8,136
Mvaa 192,196,132
Ve 9,137
Mvaa 192,200,136
Ra 224,2,40960
Vc 68,8,9
Mvaa 192,204,140
Ve 10,138
Cvaa 208,192,144,36
Ra 228,2,41984
Ra 232,2,43008
Mvaa 208,196,148
Ve 11,139
Mvaa 208,200,152
Ra 236,2,44032
Vc 69,10,11
Mvaa 208,204,156
s_waitcnt lgkmcnt(4)
Ve 12,152
Cvaa 196,208,128,32
Ra 240,2,45056
v_or3_b32 v7, v7, v68, v69
Mvaa 196,212,132
Ve 13,153
Mvaa 196,216,136
Ra 244,2,46080
Vc 76,12,13
Mvaa 196,220,140
Ve 14,154
Cvaa 212,208,144,36
Ve 15,155
Mvaa 212,212,148
Ra 248,2,47104
Vc 77,14,15
Mvaa 212,216,152
Ra 252,2,48128
v_or3_b32 v7, v7, v76, v77
Mvaa 212,220,156
s_waitcnt lgkmcnt(4)
Ve 8,140
Cvaa 200,224,128,32
Ve 9,141
Mvaa 200,228,132
Ra 192,2,16384
Vc 70,8,9
Mvaa 200,232,136
Ve 10,142
Mvaa 200,236,140
Ve 11,143
Cvaa 216,224,144,36
Ra 196,2,17408
Vc 71,10,11
Mvaa 216,228,148
Ra 200,2,18432
v_or3_b32 v7, v7, v70, v71
Mvaa 216,232,152
Ra 204,2,19456
Mvaa 216,236,156
s_waitcnt lgkmcnt(4)
Ve 12,156
Cvaa 204,240,128,32
Ve 13,157
Mvaa 204,244,132
Ra 208,2,20480
Vc 78,12,13
Mvaa 204,248,136
Ve 14,158
Mvaa 204,252,140
Ve 15,159
Cvaa 220,240,144,36
Ra 212,2,21504
Vc 79,14,15
Mvaa 220,244,148
Ra 216,2,22528
v_or3_b32 v7, v7, v78, v79
Mvaa 220,248,152
Ra 220,2,23552
v_and_b32 v1, 0x40004000, v7
Mvaa 220,252,156
v_cmp_ne_u32 vcc, 0, v1
s_cbranch_vccnz L_k2_fb_ne
L_k2_fbr_ne:
s_cmp_ge_u32 s37, s45
s_cbranch_scc1 L_k2_mk_ne
L_k2_mkr_ne:
s_waitcnt vmcnt(12)
s_barrier
s_waitcnt lgkmcnt(4)
Maav 0,192,64
s_add_u32 m0, s54, 49152
Ve 8,192
Maav 0,196,68
buffer_load_dwordx4 v4, s[12:15], s39 offen offset:0 sc1 lds
Maav 32,192,72
Ve 9,193
Maav 32,196,76
Ra 224,2,24576
Vc 96,8,9
Maav 4,200,64
Ra 228,2,25600
Ra 232,2,26624
Maav 4,204,68
buffer_load_dwordx4 v4, s[12:15], s39 offen offset:1024 sc1 lds
Maav 36,200,72
Ve 10,194
Maav 36,204,76
Ra 236,2,27648
Mvvv 48,16,64
Ve 11,195
Mvvv 48,16,68
buffer_load_dwordx4 v4, s[12:15], s39 offen offset:2048 sc1 lds
s_waitcnt lgkmcnt(4)
Maav 8,208,64
Ra 240,2,28672
Vc 97,10,11
Maav 8,212,68
Ra 244,2,29696
v_or_b32 v7, v96, v97
Maav 40,208,72
Ve 12,208
Maav 40,212,76
buffer_load_dwordx4 v4, s[12:15], s39 offen offset:3072 sc1 lds
Maav 12,216,64
Ve 13,209
Maav 12,220,68
Ra 248,2,30720
Vc 104,12,13
Maav 44,216,72
s_add_u32 m0, s53, 32768
Ve 14,210
Maav 44,220,76
buffer_load_dwordx4 v4, s[12:15], s38 offen offset:0 sc1 lds
Mvvv 52,16,72
Ra 252,2,31744
Mvvv 52,16,76
s_waitcnt lgkmcnt(4)
Ve 15,211
Maav 16,224,64
s_add_u32 s39, s39, 34816
Ra 192,3,0
Vc 105,14,15
Maav 16,228,68
buffer_load_dwordx4 v4, s[12:15], s38 offen offset:1024 sc1 lds
Maav 48,224,72
Ra 196,3,1024
v_or3_b32 v7, v7, v104, v105
Maav 48,228,76
Ve 8,196
Maav 20,232,64
Ra 200,3,2048
Ra 204,3,3072
Maav 20,236,68
buffer_load_dwordx4 v4, s[12:15], s38 offen offset:2048 sc1 lds
Maav 52,232,72
Ve 9,197
Maav 52,236,76
s_waitcnt lgkmcnt(4)
Ve 10,198
Maav 24,240,64
Ra 208,3,4096
Vc 98,8,9
Maav 24,244,68
buffer_load_dwordx4 v4, s[12:15], s38 offen offset:3072 sc1 lds
Maav 56,240,72
Ve 11,199
Maav 56,244,76
Ra 212,3,5120
Vc 99,10,11
Maav 28,248,64
Ra 216,3,6144
v_or3_b32 v7, v7, v98, v99
Maav 28,252,68
Ve 12,212
Maav 60,248,72
Ra 220,3,7168
Maav 60,252,76
Ve 13,213
Ve 14,214
Ve 15,215
Vc 106,12,13
Vc 107,14,15
v_or3_b32 v7, v7, v106, v107
s_add_u32 s38, s38, 34816
s_add_u32 s37, s37, 1
s_cmp_eq_u32 s37, s36
s_cbranch_scc1 L_k2_fin
s_waitcnt lgkmcnt(4)
Cvaa 128,192,128,32
Ve 8,200
Mvaa 128,196,132
Ve 9,201
Mvaa 128,200,136
Ra 224,3,8192
Vc 100,8,9
Mvaa 128,204,140
Ve 10,202
Cvaa 144,192,144,36
Ra 228,3,9216
Ra 232,3,10240
Mvaa 144,196,148
Ve 11,203
Mvaa 144,200,152
Ra 236,3,11264
Vc 101,10,11
Mvaa 144,204,156
s_waitcnt lgkmcnt(4)
Ve 12,216
Cvaa 132,208,128,32
Ra 240,3,12288
v_or3_b32 v7, v7, v100, v101
Mvaa 132,212,132
Ve 13,217
Mvaa 132,216,136
Ra 244,3,13312
Vc 108,12,13
Mvaa 132,220,140
Ve 14,218
Cvaa 148,208,144,36
Ve 15,219
Mvaa 148,212,148
Ra 248,3,14336
Vc 109,14,15
Mvaa 148,216,152
Ra 252,3,15360
v_or3_b32 v7, v7, v108, v109
Mvaa 148,220,156
s_waitcnt lgkmcnt(4)
Ve 8,204
Cvaa 136,224,128,32
Ve 9,205
Mvaa 136,228,132
Ra 192,2,49152
Vc 102,8,9
Mvaa 136,232,136
Ve 10,206
Mvaa 136,236,140
Ve 11,207
Cvaa 152,224,144,36
Ra 196,2,50176
Vc 103,10,11
Mvaa 152,228,148
Ra 200,2,51200
v_or3_b32 v7, v7, v102, v103
Mvaa 152,232,152
Ra 204,2,52224
Mvaa 152,236,156
s_waitcnt lgkmcnt(4)
Ve 12,220
Cvaa 140,240,128,32
Ve 13,221
Mvaa 140,244,132
Ra 208,2,53248
Vc 110,12,13
Mvaa 140,248,136
Ve 14,222
Mvaa 140,252,140
Ve 15,223
Cvaa 156,240,144,36
Ra 212,2,54272
Vc 111,14,15
Mvaa 156,244,148
Ra 216,2,55296
v_or3_b32 v7, v7, v110, v111
Mvaa 156,248,152
Ra 220,2,56320
v_and_b32 v1, 0x40004000, v7
Mvaa 156,252,156
v_cmp_ne_u32 vcc, 0, v1
s_cbranch_vccnz L_k2_fb_no
L_k2_fbr_no:
s_cmp_ge_u32 s37, s45
s_cbranch_scc1 L_k2_mk_no
L_k2_mkr_no:
s_waitcnt vmcnt(12)
s_barrier
s_waitcnt lgkmcnt(4)
Maav 0,192,96
s_add_u32 m0, s53, 16384
Ve 8,128
Maav 0,196,100
buffer_load_dwordx4 v4, s[12:15], s39 offen offset:0 sc1 lds
Maav 32,192,104
Ve 9,129
Maav 32,196,108
Ra 224,2,57344
Vc 64,8,9
Maav 4,200,96
Ra 228,2,58368
Ra 232,2,59392
Maav 4,204,100
buffer_load_dwordx4 v4, s[12:15], s39 offen offset:1024 sc1 lds
Maav 36,200,104
Ve 10,130
Maav 36,204,108
Ra 236,2,60416
Mvvv 48,16,96
Ve 11,131
Mvvv 48,16,100
buffer_load_dwordx4 v4, s[12:15], s39 offen offset:2048 sc1 lds
s_waitcnt lgkmcnt(4)
Maav 8,208,96
Ra 240,2,61440
Vc 65,10,11
Maav 8,212,100
Ra 244,2,62464
v_or_b32 v7, v64, v65
Maav 40,208,104
Ve 12,144
Maav 40,212,108
buffer_load_dwordx4 v4, s[12:15], s39 offen offset:3072 sc1 lds
Maav 12,216,96
Ve 13,145
Maav 12,220,100
Ra 248,2,63488
Vc 72,12,13
Maav 44,216,104
s_mov_b32 m0, s54
Ve 14,146
Maav 44,220,108
buffer_load_dwordx4 v4, s[12:15], s38 offen offset:0 sc1 lds
Mvvv 52,16,104
Ra 252,2,64512
Mvvv 52,16,108
s_waitcnt lgkmcnt(4)
Ve 15,147
Maav 16,224,96
s_add_u32 s39, s39, 34816
Ra 192,3,32768
Vc 73,14,15
Maav 16,228,100
buffer_load_dwordx4 v4, s[12:15], s38 offen offset:1024 sc1 lds
Maav 48,224,104
Ra 196,3,33792
v_or3_b32 v7, v7, v72, v73
Maav 48,228,108
Ve 8,132
Maav 20,232,96
Ra 200,3,34816
Ra 204,3,35840
Maav 20,236,100
buffer_load_dwordx4 v4, s[12:15], s38 offen offset:2048 sc1 lds
Maav 52,232,104
Ve 9,133
Maav 52,236,108
s_waitcnt lgkmcnt(4)
Ve 10,134
Maav 24,240,96
Ra 208,3,36864
Vc 66,8,9
Maav 24,244,100
buffer_load_dwordx4 v4, s[12:15], s38 offen offset:3072 sc1 lds
Maav 56,240,104
Ve 11,135
Maav 56,244,108
Ra 212,3,37888
Vc 67,10,11
Maav 28,248,96
Ra 216,3,38912
v_or3_b32 v7, v7, v66, v67
Maav 28,252,100
Ve 12,148
Maav 60,248,104
Ra 220,3,39936
Maav 60,252,108
Ve 13,149
Ve 14,150
Ve 15,151
Vc 74,12,13
Vc 75,14,15
v_or3_b32 v7, v7, v74, v75
s_add_u32 s38, s38, 34816
s_add_u32 s37, s37, 1
v_swap_b32 v2, v3
s_xor_b32 s53, s53, 65536
s_xor_b32 s54, s54, 65536
s_branch L_k2_nloop
L_k2_fin:
s_waitcnt lgkmcnt(0)
Ra 192,2,49152
Ra 196,2,50176
Ra 200,2,51200
Ra 204,2,52224
Ra 208,2,53248
Ra 212,2,54272
Ra 216,2,55296
Ra 220,2,56320
Ve 8,200
Ve 9,201
Ve 10,202
Ve 11,203
Vc 100,8,9
Ve 12,216
Ve 13,217
Vc 101,10,11
Ve 14,218
Ve 15,219
Vc 108,12,13
Ve 8,204
Ve 9,205
Vc 109,14,15
Ve 10,206
Ve 11,207
Vc 102,8,9
Ve 12,220
Ve 13,221
Vc 103,10,11
Ve 14,222
Ve 15,223
Vc 110,12,13
Vc 111,14,15
v_or3_b32 v7, v7, v100, v101
v_or3_b32 v7, v7, v108, v109
v_or3_b32 v7, v7, v102, v103
v_or3_b32 v7, v7, v110, v111
v_and_b32 v1, 0x40004000, v7
v_cmp_ne_u32 vcc, 0, v1
s_cbranch_vccnz L_k2_fb_fi
L_k2_fbr_fi:
s_waitcnt lgkmcnt(4)
Maav 0,192,96
Ra 224,2,57344
Ra 228,2,58368
Maav 0,196,100
Ra 232,2,59392
Ra 236,2,60416
Maav 32,192,104
Maav 32,196,108
Maav 4,200,96
Maav 4,204,100
Maav 36,200,104
Maav 36,204,108
Mvvv 48,16,96
Mvvv 48,16,100
s_waitcnt lgkmcnt(4)
Maav 8,208,96
Ra 240,2,61440
Ra 244,2,62464
Maav 8,212,100
Ra 248,2,63488
Ra 252,2,64512
Maav 40,208,104
Maav 40,212,108
Maav 12,216,96
Maav 12,220,100
Maav 44,216,104
Maav 44,220,108
Mvvv 52,16,104
Mvvv 52,16,108
s_waitcnt lgkmcnt(4)
Maav 16,224,96
Maav 16,228,100
Maav 48,224,104
Maav 48,228,108
Maav 20,232,96
Maav 20,236,100
Maav 52,232,104
Maav 52,236,108
s_waitcnt lgkmcnt(0)
Maav 24,240,96
Maav 24,244,100
Maav 56,240,104
Maav 56,244,108
Maav 28,248,96
Maav 28,252,100
Maav 60,248,104
Maav 60,252,108
s_nop 7
s_lshl_b32 s3, s55, 20
s_lshl_b32 s47, s33, 15
s_add_u32 s3, s3, s47
s_lshl_b32 s47, s32, 11
s_add_u32 s3, s3, s47
v_lshlrev_b32 v23, 4, v0
v_rcp_f32 v21, v48
v_rcp_f32 v22, v52
Ar 8,0
Ar 9,1
Ar 10,2
Ar 11,3
Ar 12,4
Ar 13,5
Ar 14,6
Ar 15,7
Vm 8,8,21
Vm 9,9,21
Vm 10,10,21
Vm 11,11,21
Vm 12,12,21
Vm 13,13,21
Vm 14,14,21
Vm 15,15,21
Vc 24,8,9
Vc 25,10,11
Vc 26,12,13
Vc 27,14,15
buffer_store_dwordx4 v[24:27], v23, s[16:19], s3 offen offset:0
Ar 8,32
Ar 9,33
Ar 10,34
Ar 11,35
Ar 12,36
Ar 13,37
Ar 14,38
Ar 15,39
Vm 8,8,22
Vm 9,9,22
Vm 10,10,22
Vm 11,11,22
Vm 12,12,22
Vm 13,13,22
Vm 14,14,22
Vm 15,15,22
Vc 28,8,9
Vc 29,10,11
Vc 30,12,13
Vc 31,14,15
buffer_store_dwordx4 v[28:31], v23, s[16:19], s3 offen offset:1024
s_add_u32 s3, s3, 8192
Ar 8,8
Ar 9,9
Ar 10,10
Ar 11,11
Ar 12,12
Ar 13,13
Ar 14,14
Ar 15,15
Vm 8,8,21
Vm 9,9,21
Vm 10,10,21
Vm 11,11,21
Vm 12,12,21
Vm 13,13,21
Vm 14,14,21
Vm 15,15,21
Vc 24,8,9
Vc 25,10,11
Vc 26,12,13
Vc 27,14,15
buffer_store_dwordx4 v[24:27], v23, s[16:19], s3 offen offset:0
Ar 8,40
Ar 9,41
Ar 10,42
Ar 11,43
Ar 12,44
Ar 13,45
Ar 14,46
Ar 15,47
Vm 8,8,22
Vm 9,9,22
Vm 10,10,22
Vm 11,11,22
Vm 12,12,22
Vm 13,13,22
Vm 14,14,22
Vm 15,15,22
Vc 28,8,9
Vc 29,10,11
Vc 30,12,13
Vc 31,14,15
buffer_store_dwordx4 v[28:31], v23, s[16:19], s3 offen offset:1024
s_add_u32 s3, s3, 8192
Ar 8,16
Ar 9,17
Ar 10,18
Ar 11,19
Ar 12,20
Ar 13,21
Ar 14,22
Ar 15,23
Vm 8,8,21
Vm 9,9,21
Vm 10,10,21
Vm 11,11,21
Vm 12,12,21
Vm 13,13,21
Vm 14,14,21
Vm 15,15,21
Vc 24,8,9
Vc 25,10,11
Vc 26,12,13
Vc 27,14,15
buffer_store_dwordx4 v[24:27], v23, s[16:19], s3 offen offset:0
Ar 8,48
Ar 9,49
Ar 10,50
Ar 11,51
Ar 12,52
Ar 13,53
Ar 14,54
Ar 15,55
Vm 8,8,22
Vm 9,9,22
Vm 10,10,22
Vm 11,11,22
Vm 12,12,22
Vm 13,13,22
Vm 14,14,22
Vm 15,15,22
Vc 28,8,9
Vc 29,10,11
Vc 30,12,13
Vc 31,14,15
buffer_store_dwordx4 v[28:31], v23, s[16:19], s3 offen offset:1024
s_add_u32 s3, s3, 8192
Ar 8,24
Ar 9,25
Ar 10,26
Ar 11,27
Ar 12,28
Ar 13,29
Ar 14,30
Ar 15,31
Vm 8,8,21
Vm 9,9,21
Vm 10,10,21
Vm 11,11,21
Vm 12,12,21
Vm 13,13,21
Vm 14,14,21
Vm 15,15,21
Vc 24,8,9
Vc 25,10,11
Vc 26,12,13
Vc 27,14,15
buffer_store_dwordx4 v[24:27], v23, s[16:19], s3 offen offset:0
Ar 8,56
Ar 9,57
Ar 10,58
Ar 11,59
Ar 12,60
Ar 13,61
Ar 14,62
Ar 15,63
Vm 8,8,22
Vm 9,9,22
Vm 10,10,22
Vm 11,11,22
Vm 12,12,22
Vm 13,13,22
Vm 14,14,22
Vm 15,15,22
Vc 28,8,9
Vc 29,10,11
Vc 30,12,13
Vc 31,14,15
buffer_store_dwordx4 v[28:31], v23, s[16:19], s3 offen offset:1024
s_cmp_eq_u32 s34, 7
s_cbranch_scc1 L_noffn1
v_lshrrev_b32 v24, 4, v0
v_bfe_u32 v25, v0, 2, 2
v_lshl_add_u32 v26, v24, 3, v25
v_lshlrev_b32 v26, 8, v26
v_and_b32 v27, 3, v0
v_lshl_add_u32 v26, v27, 3, v26
v_and_b32 v27, 1, v24
v_lshl_add_u32 v25, v27, 2, v25
s_lshl_b32 s3, s32, 1
v_xor_b32 v25, s3, v25
v_lshl_add_u32 v26, v25, 5, v26
v_add_u32 v26, 131072, v26
v_xor_b32 v27, 32, v26
s_waitcnt vmcnt(8) lgkmcnt(0)
s_barrier
ds_read_b64_tr_b16 v[160:161], v26 offset:0
ds_read_b64_tr_b16 v[162:163], v26 offset:1024
ds_read_b64_tr_b16 v[164:165], v27 offset:0
ds_read_b64_tr_b16 v[166:167], v27 offset:1024
ds_read_b64_tr_b16 v[168:169], v26 offset:8192
ds_read_b64_tr_b16 v[170:171], v26 offset:9216
ds_read_b64_tr_b16 v[172:173], v27 offset:8192
ds_read_b64_tr_b16 v[174:175], v27 offset:9216
ds_read_b64_tr_b16 v[176:177], v26 offset:16384
ds_read_b64_tr_b16 v[178:179], v26 offset:17408
ds_read_b64_tr_b16 v[180:181], v27 offset:16384
ds_read_b64_tr_b16 v[182:183], v27 offset:17408
ds_read_b64_tr_b16 v[184:185], v26 offset:24576
ds_read_b64_tr_b16 v[186:187], v26 offset:25600
ds_read_b64_tr_b16 v[188:189], v27 offset:24576
s_waitcnt lgkmcnt(9)
ds_read_b64_tr_b16 v[190:191], v27 offset:25600
v_and_b32 v25, 15, v0
v_mul_u32_u24 v28, 14336, v25
v_lshl_add_u32 v28, v24, 4, v28
v_mov_b32 v29, 2146435072
v_cmp_gt_u32 vcc, 2, v25
s_mul_i32 s3, s6, 57344
s_lshl_b32 s47, s4, 9
s_add_u32 s3, s3, s47
v_cndmask_b32 v28, v29, v28, vcc
s_lshl_b32 s47, s32, 7
s_add_u32 s3, s3, s47
s_add_u32 s7, s3, 6320128
s_waitcnt lgkmcnt(0)
Zvva 224,160,160
Zvva 228,164,160
Mvva 224,168,164
Mvva 228,172,164
Mvva 224,176,168
Mvva 228,180,168
Mvva 224,184,172
Mvva 228,188,172
s_nop 6
buffer_store_dwordx4 v[224:227], v28, s[20:23], s7 offen offset:0
buffer_store_dwordx4 v[228:231], v28, s[20:23], s7 offen offset:64
L_noffn1:
L_k2_end:
s_endpgm
L_spinAk:
s_mov_b32 s47, 0x400000
L_spinAk_l:
s_sleep 8
buffer_load_dword v30, v31, s[28:31], 0 offen sc1
s_waitcnt vmcnt(0)
v_readfirstlane_b32 s3, v30
s_sub_u32 s47, s47, 1
s_cmp_eq_u32 s47, 0
s_cbranch_scc1 L_spinArk
s_cmp_lt_u32 s3, 256
s_cbranch_scc1 L_spinAk_l
s_branch L_spinArk
L_spinAv:
s_mov_b32 s47, 0x400000
L_spinAv_l:
s_sleep 8
buffer_load_dword v30, v31, s[28:31], 0 offen sc1
s_waitcnt vmcnt(0)
v_readfirstlane_b32 s3, v30
s_sub_u32 s47, s47, 1
s_cmp_eq_u32 s47, 0
s_cbranch_scc1 L_spinArv
s_cmp_lt_u32 s3, 256
s_cbranch_scc1 L_spinAv_l
s_branch L_spinArv
L_spinB:
s_mov_b32 s59, 0x400000
L_spinB_l:
s_sleep 4
buffer_load_dword v12, v1, s[20:23], s6 offen sc1
s_sub_u32 s59, s59, 1
s_cmp_eq_u32 s59, 0
s_cbranch_scc1 L_spinBx
s_waitcnt vmcnt(0)
v_cmp_ne_u32 vcc, 1, v12
s_cbranch_vccnz L_spinB_l
L_spinBx:
s_waitcnt vmcnt(0)
s_branch L_spinBr
L_k2_fb_we:
s_nop 7
v_max3_f32 v21, v128, v129, v130
v_max3_f32 v21, v21, v131, v132
v_max3_f32 v21, v21, v133, v134
v_max3_f32 v21, v21, v135, v136
v_max3_f32 v21, v21, v137, v138
v_max3_f32 v21, v21, v139, v140
v_max3_f32 v21, v21, v141, v142
v_max_f32 v21, v21, v143
v_mov_b32 v1, v21
s_nop 1
v_permlane16_swap_b32 v1, v21
v_max_f32 v21, v21, v1
v_mov_b32 v1, v21
s_nop 1
v_permlane32_swap_b32 v1, v21
v_max_f32 v21, v21, v1
v_add_f32 v21, 0x40e00000, v21
v_max_f32 v21, 0, v21
Vs 128,128,21
Vs 129,129,21
Vs 130,130,21
Vs 131,131,21
Vs 132,132,21
Vs 133,133,21
Vs 134,134,21
Vs 135,135,21
Vs 136,136,21
Vs 137,137,21
Vs 138,138,21
Vs 139,139,21
Vs 140,140,21
Vs 141,141,21
Vs 142,142,21
Vs 143,143,21
Vs 192,192,21
Vs 193,193,21
Vs 194,194,21
Vs 195,195,21
Vs 196,196,21
Vs 197,197,21
Vs 198,198,21
Vs 199,199,21
Vs 200,200,21
Vs 201,201,21
Vs 202,202,21
Vs 203,203,21
Vs 204,204,21
Vs 205,205,21
Vs 206,206,21
Vs 207,207,21
Vs 32,32,21
Vs 33,33,21
Vs 34,34,21
Vs 35,35,21
v_exp_f32 v22, -v21
s_nop 0
Vm 48,48,22
Vm 49,49,22
Vm 50,50,22
Vm 51,51,22
Ar 8,0
Ar 9,1
Ar 10,2
Ar 11,3
Ar 12,4
Ar 13,5
Ar 14,6
Ar 15,7
Vm 8,8,22
Vm 9,9,22
Vm 10,10,22
Vm 11,11,22
Vm 12,12,22
Vm 13,13,22
Vm 14,14,22
Vm 15,15,22
Aw 0,8
Aw 1,9
Aw 2,10
Aw 3,11
Aw 4,12
Aw 5,13
Aw 6,14
Aw 7,15
Ar 8,8
Ar 9,9
Ar 10,10
Ar 11,11
Ar 12,12
Ar 13,13
Ar 14,14
Ar 15,15
Vm 8,8,22
Vm 9,9,22
Vm 10,10,22
Vm 11,11,22
Vm 12,12,22
Vm 13,13,22
Vm 14,14,22
Vm 15,15,22
Aw 8,8
Aw 9,9
Aw 10,10
Aw 11,11
Aw 12,12
Aw 13,13
Aw 14,14
Aw 15,15
Ar 8,16
Ar 9,17
Ar 10,18
Ar 11,19
Ar 12,20
Ar 13,21
Ar 14,22
Ar 15,23
Vm 8,8,22
Vm 9,9,22
Vm 10,10,22
Vm 11,11,22
Vm 12,12,22
Vm 13,13,22
Vm 14,14,22
Vm 15,15,22
Aw 16,8
Aw 17,9
Aw 18,10
Aw 19,11
Aw 20,12
Aw 21,13
Aw 22,14
Aw 23,15
Ar 8,24
Ar 9,25
Ar 10,26
Ar 11,27
Ar 12,28
Ar 13,29
Ar 14,30
Ar 15,31
Vm 8,8,22
Vm 9,9,22
Vm 10,10,22
Vm 11,11,22
Vm 12,12,22
Vm 13,13,22
Vm 14,14,22
Vm 15,15,22
Aw 24,8
Aw 25,9
Aw 26,10
Aw 27,11
Aw 28,12
Aw 29,13
Aw 30,14
Aw 31,15
v_max3_f32 v21, v144, v145, v146
v_max3_f32 v21, v21, v147, v148
v_max3_f32 v21, v21, v149, v150
v_max3_f32 v21, v21, v151, v152
v_max3_f32 v21, v21, v153, v154
v_max3_f32 v21, v21, v155, v156
v_max3_f32 v21, v21, v157, v158
v_max_f32 v21, v21, v159
v_mov_b32 v1, v21
s_nop 1
v_permlane16_swap_b32 v1, v21
v_max_f32 v21, v21, v1
v_mov_b32 v1, v21
s_nop 1
v_permlane32_swap_b32 v1, v21
v_max_f32 v21, v21, v1
v_add_f32 v21, 0x40e00000, v21
v_max_f32 v21, 0, v21
Vs 144,144,21
Vs 145,145,21
Vs 146,146,21
Vs 147,147,21
Vs 148,148,21
Vs 149,149,21
Vs 150,150,21
Vs 151,151,21
Vs 152,152,21
Vs 153,153,21
Vs 154,154,21
Vs 155,155,21
Vs 156,156,21
Vs 157,157,21
Vs 158,158,21
Vs 159,159,21
Vs 208,208,21
Vs 209,209,21
Vs 210,210,21
Vs 211,211,21
Vs 212,212,21
Vs 213,213,21
Vs 214,214,21
Vs 215,215,21
Vs 216,216,21
Vs 217,217,21
Vs 218,218,21
Vs 219,219,21
Vs 220,220,21
Vs 221,221,21
Vs 222,222,21
Vs 223,223,21
Vs 36,36,21
Vs 37,37,21
Vs 38,38,21
Vs 39,39,21
v_exp_f32 v22, -v21
s_nop 0
Vm 52,52,22
Vm 53,53,22
Vm 54,54,22
Vm 55,55,22
Ar 8,32
Ar 9,33
Ar 10,34
Ar 11,35
Ar 12,36
Ar 13,37
Ar 14,38
Ar 15,39
Vm 8,8,22
Vm 9,9,22
Vm 10,10,22
Vm 11,11,22
Vm 12,12,22
Vm 13,13,22
Vm 14,14,22
Vm 15,15,22
Aw 32,8
Aw 33,9
Aw 34,10
Aw 35,11
Aw 36,12
Aw 37,13
Aw 38,14
Aw 39,15
Ar 8,40
Ar 9,41
Ar 10,42
Ar 11,43
Ar 12,44
Ar 13,45
Ar 14,46
Ar 15,47
Vm 8,8,22
Vm 9,9,22
Vm 10,10,22
Vm 11,11,22
Vm 12,12,22
Vm 13,13,22
Vm 14,14,22
Vm 15,15,22
Aw 40,8
Aw 41,9
Aw 42,10
Aw 43,11
Aw 44,12
Aw 45,13
Aw 46,14
Aw 47,15
Ar 8,48
Ar 9,49
Ar 10,50
Ar 11,51
Ar 12,52
Ar 13,53
Ar 14,54
Ar 15,55
Vm 8,8,22
Vm 9,9,22
Vm 10,10,22
Vm 11,11,22
Vm 12,12,22
Vm 13,13,22
Vm 14,14,22
Vm 15,15,22
Aw 48,8
Aw 49,9
Aw 50,10
Aw 51,11
Aw 52,12
Aw 53,13
Aw 54,14
Aw 55,15
Ar 8,56
Ar 9,57
Ar 10,58
Ar 11,59
Ar 12,60
Ar 13,61
Ar 14,62
Ar 15,63
Vm 8,8,22
Vm 9,9,22
Vm 10,10,22
Vm 11,11,22
Vm 12,12,22
Vm 13,13,22
Vm 14,14,22
Vm 15,15,22
Aw 56,8
Aw 57,9
Aw 58,10
Aw 59,11
Aw 60,12
Aw 61,13
Aw 62,14
Aw 63,15
v_max3_f32 v21, v160, v161, v162
v_max3_f32 v21, v21, v163, v164
v_max3_f32 v21, v21, v165, v166
v_max3_f32 v21, v21, v167, v168
v_max3_f32 v21, v21, v169, v170
v_max3_f32 v21, v21, v171, v172
v_max3_f32 v21, v21, v173, v174
v_max_f32 v21, v21, v175
v_mov_b32 v1, v21
s_nop 1
v_permlane16_swap_b32 v1, v21
v_max_f32 v21, v21, v1
v_mov_b32 v1, v21
s_nop 1
v_permlane32_swap_b32 v1, v21
v_max_f32 v21, v21, v1
v_add_f32 v21, 0x40e00000, v21
v_max_f32 v21, 0, v21
Vs 160,160,21
Vs 161,161,21
Vs 162,162,21
Vs 163,163,21
Vs 164,164,21
Vs 165,165,21
Vs 166,166,21
Vs 167,167,21
Vs 168,168,21
Vs 169,169,21
Vs 170,170,21
Vs 171,171,21
Vs 172,172,21
Vs 173,173,21
Vs 174,174,21
Vs 175,175,21
Vs 224,224,21
Vs 225,225,21
Vs 226,226,21
Vs 227,227,21
Vs 228,228,21
Vs 229,229,21
Vs 230,230,21
Vs 231,231,21
Vs 232,232,21
Vs 233,233,21
Vs 234,234,21
Vs 235,235,21
Vs 236,236,21
Vs 237,237,21
Vs 238,238,21
Vs 239,239,21
Vs 40,40,21
Vs 41,41,21
Vs 42,42,21
Vs 43,43,21
v_exp_f32 v22, -v21
s_nop 0
Vm 56,56,22
Vm 57,57,22
Vm 58,58,22
Vm 59,59,22
Ar 8,64
Ar 9,65
Ar 10,66
Ar 11,67
Ar 12,68
Ar 13,69
Ar 14,70
Ar 15,71
Vm 8,8,22
Vm 9,9,22
Vm 10,10,22
Vm 11,11,22
Vm 12,12,22
Vm 13,13,22
Vm 14,14,22
Vm 15,15,22
Aw 64,8
Aw 65,9
Aw 66,10
Aw 67,11
Aw 68,12
Aw 69,13
Aw 70,14
Aw 71,15
Ar 8,72
Ar 9,73
Ar 10,74
Ar 11,75
Ar 12,76
Ar 13,77
Ar 14,78
Ar 15,79
Vm 8,8,22
Vm 9,9,22
Vm 10,10,22
Vm 11,11,22
Vm 12,12,22
Vm 13,13,22
Vm 14,14,22
Vm 15,15,22
Aw 72,8
Aw 73,9
Aw 74,10
Aw 75,11
Aw 76,12
Aw 77,13
Aw 78,14
Aw 79,15
Ar 8,80
Ar 9,81
Ar 10,82
Ar 11,83
Ar 12,84
Ar 13,85
Ar 14,86
Ar 15,87
Vm 8,8,22
Vm 9,9,22
Vm 10,10,22
Vm 11,11,22
Vm 12,12,22
Vm 13,13,22
Vm 14,14,22
Vm 15,15,22
Aw 80,8
Aw 81,9
Aw 82,10
Aw 83,11
Aw 84,12
Aw 85,13
Aw 86,14
Aw 87,15
Ar 8,88
Ar 9,89
Ar 10,90
Ar 11,91
Ar 12,92
Ar 13,93
Ar 14,94
Ar 15,95
Vm 8,8,22
Vm 9,9,22
Vm 10,10,22
Vm 11,11,22
Vm 12,12,22
Vm 13,13,22
Vm 14,14,22
Vm 15,15,22
Aw 88,8
Aw 89,9
Aw 90,10
Aw 91,11
Aw 92,12
Aw 93,13
Aw 94,14
Aw 95,15
v_max3_f32 v21, v176, v177, v178
v_max3_f32 v21, v21, v179, v180
v_max3_f32 v21, v21, v181, v182
v_max3_f32 v21, v21, v183, v184
v_max3_f32 v21, v21, v185, v186
v_max3_f32 v21, v21, v187, v188
v_max3_f32 v21, v21, v189, v190
v_max_f32 v21, v21, v191
v_mov_b32 v1, v21
s_nop 1
v_permlane16_swap_b32 v1, v21
v_max_f32 v21, v21, v1
v_mov_b32 v1, v21
s_nop 1
v_permlane32_swap_b32 v1, v21
v_max_f32 v21, v21, v1
v_add_f32 v21, 0x40e00000, v21
v_max_f32 v21, 0, v21
Vs 176,176,21
Vs 177,177,21
Vs 178,178,21
Vs 179,179,21
Vs 180,180,21
Vs 181,181,21
Vs 182,182,21
Vs 183,183,21
Vs 184,184,21
Vs 185,185,21
Vs 186,186,21
Vs 187,187,21
Vs 188,188,21
Vs 189,189,21
Vs 190,190,21
Vs 191,191,21
Vs 240,240,21
Vs 241,241,21
Vs 242,242,21
Vs 243,243,21
Vs 244,244,21
Vs 245,245,21
Vs 246,246,21
Vs 247,247,21
Vs 248,248,21
Vs 249,249,21
Vs 250,250,21
Vs 251,251,21
Vs 252,252,21
Vs 253,253,21
Vs 254,254,21
Vs 255,255,21
Vs 44,44,21
Vs 45,45,21
Vs 46,46,21
Vs 47,47,21
v_exp_f32 v22, -v21
s_nop 0
Vm 60,60,22
Vm 61,61,22
Vm 62,62,22
Vm 63,63,22
Ar 8,96
Ar 9,97
Ar 10,98
Ar 11,99
Ar 12,100
Ar 13,101
Ar 14,102
Ar 15,103
Vm 8,8,22
Vm 9,9,22
Vm 10,10,22
Vm 11,11,22
Vm 12,12,22
Vm 13,13,22
Vm 14,14,22
Vm 15,15,22
Aw 96,8
Aw 97,9
Aw 98,10
Aw 99,11
Aw 100,12
Aw 101,13
Aw 102,14
Aw 103,15
Ar 8,104
Ar 9,105
Ar 10,106
Ar 11,107
Ar 12,108
Ar 13,109
Ar 14,110
Ar 15,111
Vm 8,8,22
Vm 9,9,22
Vm 10,10,22
Vm 11,11,22
Vm 12,12,22
Vm 13,13,22
Vm 14,14,22
Vm 15,15,22
Aw 104,8
Aw 105,9
Aw 106,10
Aw 107,11
Aw 108,12
Aw 109,13
Aw 110,14
Aw 111,15
Ar 8,112
Ar 9,113
Ar 10,114
Ar 11,115
Ar 12,116
Ar 13,117
Ar 14,118
Ar 15,119
Vm 8,8,22
Vm 9,9,22
Vm 10,10,22
Vm 11,11,22
Vm 12,12,22
Vm 13,13,22
Vm 14,14,22
Vm 15,15,22
Aw 112,8
Aw 113,9
Aw 114,10
Aw 115,11
Aw 116,12
Aw 117,13
Aw 118,14
Aw 119,15
Ar 8,120
Ar 9,121
Ar 10,122
Ar 11,123
Ar 12,124
Ar 13,125
Ar 14,126
Ar 15,127
Vm 8,8,22
Vm 9,9,22
Vm 10,10,22
Vm 11,11,22
Vm 12,12,22
Vm 13,13,22
Vm 14,14,22
Vm 15,15,22
Aw 120,8
Aw 121,9
Aw 122,10
Aw 123,11
Aw 124,12
Aw 125,13
Aw 126,14
Aw 127,15
Ve 8,128
Ve 9,129
s_nop 0
Vc 64,8,9
Ve 8,130
Ve 9,131
s_nop 0
Vc 65,8,9
Ve 8,144
Ve 9,145
s_nop 0
Vc 72,8,9
Ve 8,146
Ve 9,147
s_nop 0
Vc 73,8,9
Ve 8,160
Ve 9,161
s_nop 0
Vc 80,8,9
Ve 8,162
Ve 9,163
s_nop 0
Vc 81,8,9
Ve 8,176
Ve 9,177
s_nop 0
Vc 88,8,9
Ve 8,178
Ve 9,179
s_nop 0
Vc 89,8,9
Ve 8,132
Ve 9,133
s_nop 0
Vc 66,8,9
Ve 8,134
Ve 9,135
s_nop 0
Vc 67,8,9
Ve 8,148
Ve 9,149
s_nop 0
Vc 74,8,9
Ve 8,150
Ve 9,151
s_nop 0
Vc 75,8,9
Ve 8,164
Ve 9,165
s_nop 0
Vc 82,8,9
Ve 8,166
Ve 9,167
s_nop 0
Vc 83,8,9
Ve 8,180
Ve 9,181
s_nop 0
Vc 90,8,9
Ve 8,182
Ve 9,183
s_nop 0
Vc 91,8,9
Ve 8,136
Ve 9,137
s_nop 0
Vc 68,8,9
Ve 8,138
Ve 9,139
s_nop 0
Vc 69,8,9
Ve 8,152
Ve 9,153
s_nop 0
Vc 76,8,9
Ve 8,154
Ve 9,155
s_nop 0
Vc 77,8,9
Ve 8,168
Ve 9,169
s_nop 0
Vc 84,8,9
Ve 8,170
Ve 9,171
s_nop 0
Vc 85,8,9
Ve 8,184
Ve 9,185
s_nop 0
Vc 92,8,9
Ve 8,186
Ve 9,187
s_nop 0
Vc 93,8,9
Ve 8,140
Ve 9,141
s_nop 0
Vc 70,8,9
Ve 8,142
Ve 9,143
s_nop 0
Vc 71,8,9
Ve 8,156
Ve 9,157
s_nop 0
Vc 78,8,9
Ve 8,158
Ve 9,159
s_nop 0
Vc 79,8,9
Ve 8,172
Ve 9,173
s_nop 0
Vc 86,8,9
Ve 8,174
Ve 9,175
s_nop 0
Vc 87,8,9
Ve 8,188
Ve 9,189
s_nop 0
Vc 94,8,9
Ve 8,190
Ve 9,191
s_nop 0
Vc 95,8,9
s_nop 1
s_branch L_k2_fbr_we
L_k2_mk_we:
s_nop 7
s_add_u32 s3, s37, 1
s_lshl_b32 s3, s3, 6
v_subrev_u32 v1, s3, v6
v_cmp_gt_i32 s[56:57], -16, v1
v_cmp_gt_i32 s[58:59], -15, v1
v_cmp_gt_i32 s[60:61], -14, v1
v_cmp_gt_i32 s[62:63], -13, v1
v_cndmask_b32 v240, v240, v20, s[56:57]
v_cndmask_b32 v241, v241, v20, s[58:59]
v_cndmask_b32 v242, v242, v20, s[60:61]
v_cndmask_b32 v243, v243, v20, s[62:63]
v_cmp_gt_i32 s[56:57], 0, v1
v_cmp_gt_i32 s[58:59], 1, v1
v_cmp_gt_i32 s[60:61], 2, v1
v_cmp_gt_i32 s[62:63], 3, v1
v_cndmask_b32 v224, v224, v20, s[56:57]
v_cndmask_b32 v225, v225, v20, s[58:59]
v_cndmask_b32 v226, v226, v20, s[60:61]
v_cndmask_b32 v227, v227, v20, s[62:63]
v_cndmask_b32 v244, v244, v20, s[56:57]
v_cndmask_b32 v245, v245, v20, s[58:59]
v_cndmask_b32 v246, v246, v20, s[60:61]
v_cndmask_b32 v247, v247, v20, s[62:63]
v_cmp_gt_i32 s[56:57], 16, v1
v_cmp_gt_i32 s[58:59], 17, v1
v_cmp_gt_i32 s[60:61], 18, v1
v_cmp_gt_i32 s[62:63], 19, v1
v_cndmask_b32 v228, v228, v20, s[56:57]
v_cndmask_b32 v229, v229, v20, s[58:59]
v_cndmask_b32 v230, v230, v20, s[60:61]
v_cndmask_b32 v231, v231, v20, s[62:63]
v_cndmask_b32 v248, v248, v20, s[56:57]
v_cndmask_b32 v249, v249, v20, s[58:59]
v_cndmask_b32 v250, v250, v20, s[60:61]
v_cndmask_b32 v251, v251, v20, s[62:63]
v_cmp_gt_i32 s[56:57], 32, v1
v_cmp_gt_i32 s[58:59], 33, v1
v_cmp_gt_i32 s[60:61], 34, v1
v_cmp_gt_i32 s[62:63], 35, v1
v_cndmask_b32 v232, v232, v20, s[56:57]
v_cndmask_b32 v233, v233, v20, s[58:59]
v_cndmask_b32 v234, v234, v20, s[60:61]
v_cndmask_b32 v235, v235, v20, s[62:63]
v_cndmask_b32 v252, v252, v20, s[56:57]
v_cndmask_b32 v253, v253, v20, s[58:59]
v_cndmask_b32 v254, v254, v20, s[60:61]
v_cndmask_b32 v255, v255, v20, s[62:63]
v_cmp_gt_i32 s[56:57], 48, v1
v_cmp_gt_i32 s[58:59], 49, v1
v_cmp_gt_i32 s[60:61], 50, v1
v_cmp_gt_i32 s[62:63], 51, v1
v_cndmask_b32 v236, v236, v20, s[56:57]
v_cndmask_b32 v237, v237, v20, s[58:59]
v_cndmask_b32 v238, v238, v20, s[60:61]
v_cndmask_b32 v239, v239, v20, s[62:63]
s_nop 1
s_branch L_k2_mkr_we
L_k2_fb_wo:
s_nop 7
v_max3_f32 v21, v192, v193, v194
v_max3_f32 v21, v21, v195, v196
v_max3_f32 v21, v21, v197, v198
v_max3_f32 v21, v21, v199, v200
v_max3_f32 v21, v21, v201, v202
v_max3_f32 v21, v21, v203, v204
v_max3_f32 v21, v21, v205, v206
v_max_f32 v21, v21, v207
v_mov_b32 v1, v21
s_nop 1
v_permlane16_swap_b32 v1, v21
v_max_f32 v21, v21, v1
v_mov_b32 v1, v21
s_nop 1
v_permlane32_swap_b32 v1, v21
v_max_f32 v21, v21, v1
v_add_f32 v21, 0x40e00000, v21
v_max_f32 v21, 0, v21
Vs 192,192,21
Vs 193,193,21
Vs 194,194,21
Vs 195,195,21
Vs 196,196,21
Vs 197,197,21
Vs 198,198,21
Vs 199,199,21
Vs 200,200,21
Vs 201,201,21
Vs 202,202,21
Vs 203,203,21
Vs 204,204,21
Vs 205,205,21
Vs 206,206,21
Vs 207,207,21
Vs 128,128,21
Vs 129,129,21
Vs 130,130,21
Vs 131,131,21
Vs 132,132,21
Vs 133,133,21
Vs 134,134,21
Vs 135,135,21
Vs 136,136,21
Vs 137,137,21
Vs 138,138,21
Vs 139,139,21
Vs 140,140,21
Vs 141,141,21
Vs 142,142,21
Vs 143,143,21
Vs 32,32,21
Vs 33,33,21
Vs 34,34,21
Vs 35,35,21
v_exp_f32 v22, -v21
s_nop 0
Vm 48,48,22
Vm 49,49,22
Vm 50,50,22
Vm 51,51,22
Ar 8,0
Ar 9,1
Ar 10,2
Ar 11,3
Ar 12,4
Ar 13,5
Ar 14,6
Ar 15,7
Vm 8,8,22
Vm 9,9,22
Vm 10,10,22
Vm 11,11,22
Vm 12,12,22
Vm 13,13,22
Vm 14,14,22
Vm 15,15,22
Aw 0,8
Aw 1,9
Aw 2,10
Aw 3,11
Aw 4,12
Aw 5,13
Aw 6,14
Aw 7,15
Ar 8,8
Ar 9,9
Ar 10,10
Ar 11,11
Ar 12,12
Ar 13,13
Ar 14,14
Ar 15,15
Vm 8,8,22
Vm 9,9,22
Vm 10,10,22
Vm 11,11,22
Vm 12,12,22
Vm 13,13,22
Vm 14,14,22
Vm 15,15,22
Aw 8,8
Aw 9,9
Aw 10,10
Aw 11,11
Aw 12,12
Aw 13,13
Aw 14,14
Aw 15,15
Ar 8,16
Ar 9,17
Ar 10,18
Ar 11,19
Ar 12,20
Ar 13,21
Ar 14,22
Ar 15,23
Vm 8,8,22
Vm 9,9,22
Vm 10,10,22
Vm 11,11,22
Vm 12,12,22
Vm 13,13,22
Vm 14,14,22
Vm 15,15,22
Aw 16,8
Aw 17,9
Aw 18,10
Aw 19,11
Aw 20,12
Aw 21,13
Aw 22,14
Aw 23,15
Ar 8,24
Ar 9,25
Ar 10,26
Ar 11,27
Ar 12,28
Ar 13,29
Ar 14,30
Ar 15,31
Vm 8,8,22
Vm 9,9,22
Vm 10,10,22
Vm 11,11,22
Vm 12,12,22
Vm 13,13,22
Vm 14,14,22
Vm 15,15,22
Aw 24,8
Aw 25,9
Aw 26,10
Aw 27,11
Aw 28,12
Aw 29,13
Aw 30,14
Aw 31,15
v_max3_f32 v21, v208, v209, v210
v_max3_f32 v21, v21, v211, v212
v_max3_f32 v21, v21, v213, v214
v_max3_f32 v21, v21, v215, v216
v_max3_f32 v21, v21, v217, v218
v_max3_f32 v21, v21, v219, v220
v_max3_f32 v21, v21, v221, v222
v_max_f32 v21, v21, v223
v_mov_b32 v1, v21
s_nop 1
v_permlane16_swap_b32 v1, v21
v_max_f32 v21, v21, v1
v_mov_b32 v1, v21
s_nop 1
v_permlane32_swap_b32 v1, v21
v_max_f32 v21, v21, v1
v_add_f32 v21, 0x40e00000, v21
v_max_f32 v21, 0, v21
Vs 208,208,21
Vs 209,209,21
Vs 210,210,21
Vs 211,211,21
Vs 212,212,21
Vs 213,213,21
Vs 214,214,21
Vs 215,215,21
Vs 216,216,21
Vs 217,217,21
Vs 218,218,21
Vs 219,219,21
Vs 220,220,21
Vs 221,221,21
Vs 222,222,21
Vs 223,223,21
Vs 144,144,21
Vs 145,145,21
Vs 146,146,21
Vs 147,147,21
Vs 148,148,21
Vs 149,149,21
Vs 150,150,21
Vs 151,151,21
Vs 152,152,21
Vs 153,153,21
Vs 154,154,21
Vs 155,155,21
Vs 156,156,21
Vs 157,157,21
Vs 158,158,21
Vs 159,159,21
Vs 36,36,21
Vs 37,37,21
Vs 38,38,21
Vs 39,39,21
v_exp_f32 v22, -v21
s_nop 0
Vm 52,52,22
Vm 53,53,22
Vm 54,54,22
Vm 55,55,22
Ar 8,32
Ar 9,33
Ar 10,34
Ar 11,35
Ar 12,36
Ar 13,37
Ar 14,38
Ar 15,39
Vm 8,8,22
Vm 9,9,22
Vm 10,10,22
Vm 11,11,22
Vm 12,12,22
Vm 13,13,22
Vm 14,14,22
Vm 15,15,22
Aw 32,8
Aw 33,9
Aw 34,10
Aw 35,11
Aw 36,12
Aw 37,13
Aw 38,14
Aw 39,15
Ar 8,40
Ar 9,41
Ar 10,42
Ar 11,43
Ar 12,44
Ar 13,45
Ar 14,46
Ar 15,47
Vm 8,8,22
Vm 9,9,22
Vm 10,10,22
Vm 11,11,22
Vm 12,12,22
Vm 13,13,22
Vm 14,14,22
Vm 15,15,22
Aw 40,8
Aw 41,9
Aw 42,10
Aw 43,11
Aw 44,12
Aw 45,13
Aw 46,14
Aw 47,15
Ar 8,48
Ar 9,49
Ar 10,50
Ar 11,51
Ar 12,52
Ar 13,53
Ar 14,54
Ar 15,55
Vm 8,8,22
Vm 9,9,22
Vm 10,10,22
Vm 11,11,22
Vm 12,12,22
Vm 13,13,22
Vm 14,14,22
Vm 15,15,22
Aw 48,8
Aw 49,9
Aw 50,10
Aw 51,11
Aw 52,12
Aw 53,13
Aw 54,14
Aw 55,15
Ar 8,56
Ar 9,57
Ar 10,58
Ar 11,59
Ar 12,60
Ar 13,61
Ar 14,62
Ar 15,63
Vm 8,8,22
Vm 9,9,22
Vm 10,10,22
Vm 11,11,22
Vm 12,12,22
Vm 13,13,22
Vm 14,14,22
Vm 15,15,22
Aw 56,8
Aw 57,9
Aw 58,10
Aw 59,11
Aw 60,12
Aw 61,13
Aw 62,14
Aw 63,15
v_max3_f32 v21, v224, v225, v226
v_max3_f32 v21, v21, v227, v228
v_max3_f32 v21, v21, v229, v230
v_max3_f32 v21, v21, v231, v232
v_max3_f32 v21, v21, v233, v234
v_max3_f32 v21, v21, v235, v236
v_max3_f32 v21, v21, v237, v238
v_max_f32 v21, v21, v239
v_mov_b32 v1, v21
s_nop 1
v_permlane16_swap_b32 v1, v21
v_max_f32 v21, v21, v1
v_mov_b32 v1, v21
s_nop 1
v_permlane32_swap_b32 v1, v21
v_max_f32 v21, v21, v1
v_add_f32 v21, 0x40e00000, v21
v_max_f32 v21, 0, v21
Vs 224,224,21
Vs 225,225,21
Vs 226,226,21
Vs 227,227,21
Vs 228,228,21
Vs 229,229,21
Vs 230,230,21
Vs 231,231,21
Vs 232,232,21
Vs 233,233,21
Vs 234,234,21
Vs 235,235,21
Vs 236,236,21
Vs 237,237,21
Vs 238,238,21
Vs 239,239,21
Vs 160,160,21
Vs 161,161,21
Vs 162,162,21
Vs 163,163,21
Vs 164,164,21
Vs 165,165,21
Vs 166,166,21
Vs 167,167,21
Vs 168,168,21
Vs 169,169,21
Vs 170,170,21
Vs 171,171,21
Vs 172,172,21
Vs 173,173,21
Vs 174,174,21
Vs 175,175,21
Vs 40,40,21
Vs 41,41,21
Vs 42,42,21
Vs 43,43,21
v_exp_f32 v22, -v21
s_nop 0
Vm 56,56,22
Vm 57,57,22
Vm 58,58,22
Vm 59,59,22
Ar 8,64
Ar 9,65
Ar 10,66
Ar 11,67
Ar 12,68
Ar 13,69
Ar 14,70
Ar 15,71
Vm 8,8,22
Vm 9,9,22
Vm 10,10,22
Vm 11,11,22
Vm 12,12,22
Vm 13,13,22
Vm 14,14,22
Vm 15,15,22
Aw 64,8
Aw 65,9
Aw 66,10
Aw 67,11
Aw 68,12
Aw 69,13
Aw 70,14
Aw 71,15
Ar 8,72
Ar 9,73
Ar 10,74
Ar 11,75
Ar 12,76
Ar 13,77
Ar 14,78
Ar 15,79
Vm 8,8,22
Vm 9,9,22
Vm 10,10,22
Vm 11,11,22
Vm 12,12,22
Vm 13,13,22
Vm 14,14,22
Vm 15,15,22
Aw 72,8
Aw 73,9
Aw 74,10
Aw 75,11
Aw 76,12
Aw 77,13
Aw 78,14
Aw 79,15
Ar 8,80
Ar 9,81
Ar 10,82
Ar 11,83
Ar 12,84
Ar 13,85
Ar 14,86
Ar 15,87
Vm 8,8,22
Vm 9,9,22
Vm 10,10,22
Vm 11,11,22
Vm 12,12,22
Vm 13,13,22
Vm 14,14,22
Vm 15,15,22
Aw 80,8
Aw 81,9
Aw 82,10
Aw 83,11
Aw 84,12
Aw 85,13
Aw 86,14
Aw 87,15
Ar 8,88
Ar 9,89
Ar 10,90
Ar 11,91
Ar 12,92
Ar 13,93
Ar 14,94
Ar 15,95
Vm 8,8,22
Vm 9,9,22
Vm 10,10,22
Vm 11,11,22
Vm 12,12,22
Vm 13,13,22
Vm 14,14,22
Vm 15,15,22
Aw 88,8
Aw 89,9
Aw 90,10
Aw 91,11
Aw 92,12
Aw 93,13
Aw 94,14
Aw 95,15
v_max3_f32 v21, v240, v241, v242
v_max3_f32 v21, v21, v243, v244
v_max3_f32 v21, v21, v245, v246
v_max3_f32 v21, v21, v247, v248
v_max3_f32 v21, v21, v249, v250
v_max3_f32 v21, v21, v251, v252
v_max3_f32 v21, v21, v253, v254
v_max_f32 v21, v21, v255
v_mov_b32 v1, v21
s_nop 1
v_permlane16_swap_b32 v1, v21
v_max_f32 v21, v21, v1
v_mov_b32 v1, v21
s_nop 1
v_permlane32_swap_b32 v1, v21
v_max_f32 v21, v21, v1
v_add_f32 v21, 0x40e00000, v21
v_max_f32 v21, 0, v21
Vs 240,240,21
Vs 241,241,21
Vs 242,242,21
Vs 243,243,21
Vs 244,244,21
Vs 245,245,21
Vs 246,246,21
Vs 247,247,21
Vs 248,248,21
Vs 249,249,21
Vs 250,250,21
Vs 251,251,21
Vs 252,252,21
Vs 253,253,21
Vs 254,254,21
Vs 255,255,21
Vs 176,176,21
Vs 177,177,21
Vs 178,178,21
Vs 179,179,21
Vs 180,180,21
Vs 181,181,21
Vs 182,182,21
Vs 183,183,21
Vs 184,184,21
Vs 185,185,21
Vs 186,186,21
Vs 187,187,21
Vs 188,188,21
Vs 189,189,21
Vs 190,190,21
Vs 191,191,21
Vs 44,44,21
Vs 45,45,21
Vs 46,46,21
Vs 47,47,21
v_exp_f32 v22, -v21
s_nop 0
Vm 60,60,22
Vm 61,61,22
Vm 62,62,22
Vm 63,63,22
Ar 8,96
Ar 9,97
Ar 10,98
Ar 11,99
Ar 12,100
Ar 13,101
Ar 14,102
Ar 15,103
Vm 8,8,22
Vm 9,9,22
Vm 10,10,22
Vm 11,11,22
Vm 12,12,22
Vm 13,13,22
Vm 14,14,22
Vm 15,15,22
Aw 96,8
Aw 97,9
Aw 98,10
Aw 99,11
Aw 100,12
Aw 101,13
Aw 102,14
Aw 103,15
Ar 8,104
Ar 9,105
Ar 10,106
Ar 11,107
Ar 12,108
Ar 13,109
Ar 14,110
Ar 15,111
Vm 8,8,22
Vm 9,9,22
Vm 10,10,22
Vm 11,11,22
Vm 12,12,22
Vm 13,13,22
Vm 14,14,22
Vm 15,15,22
Aw 104,8
Aw 105,9
Aw 106,10
Aw 107,11
Aw 108,12
Aw 109,13
Aw 110,14
Aw 111,15
Ar 8,112
Ar 9,113
Ar 10,114
Ar 11,115
Ar 12,116
Ar 13,117
Ar 14,118
Ar 15,119
Vm 8,8,22
Vm 9,9,22
Vm 10,10,22
Vm 11,11,22
Vm 12,12,22
Vm 13,13,22
Vm 14,14,22
Vm 15,15,22
Aw 112,8
Aw 113,9
Aw 114,10
Aw 115,11
Aw 116,12
Aw 117,13
Aw 118,14
Aw 119,15
Ar 8,120
Ar 9,121
Ar 10,122
Ar 11,123
Ar 12,124
Ar 13,125
Ar 14,126
Ar 15,127
Vm 8,8,22
Vm 9,9,22
Vm 10,10,22
Vm 11,11,22
Vm 12,12,22
Vm 13,13,22
Vm 14,14,22
Vm 15,15,22
Aw 120,8
Aw 121,9
Aw 122,10
Aw 123,11
Aw 124,12
Aw 125,13
Aw 126,14
Aw 127,15
Ve 8,192
Ve 9,193
s_nop 0
Vc 96,8,9
Ve 8,194
Ve 9,195
s_nop 0
Vc 97,8,9
Ve 8,208
Ve 9,209
s_nop 0
Vc 104,8,9
Ve 8,210
Ve 9,211
s_nop 0
Vc 105,8,9
Ve 8,224
Ve 9,225
s_nop 0
Vc 112,8,9
Ve 8,226
Ve 9,227
s_nop 0
Vc 113,8,9
Ve 8,240
Ve 9,241
s_nop 0
Vc 120,8,9
Ve 8,242
Ve 9,243
s_nop 0
Vc 121,8,9
Ve 8,196
Ve 9,197
s_nop 0
Vc 98,8,9
Ve 8,198
Ve 9,199
s_nop 0
Vc 99,8,9
Ve 8,212
Ve 9,213
s_nop 0
Vc 106,8,9
Ve 8,214
Ve 9,215
s_nop 0
Vc 107,8,9
Ve 8,228
Ve 9,229
s_nop 0
Vc 114,8,9
Ve 8,230
Ve 9,231
s_nop 0
Vc 115,8,9
Ve 8,244
Ve 9,245
s_nop 0
Vc 122,8,9
Ve 8,246
Ve 9,247
s_nop 0
Vc 123,8,9
Ve 8,200
Ve 9,201
s_nop 0
Vc 100,8,9
Ve 8,202
Ve 9,203
s_nop 0
Vc 101,8,9
Ve 8,216
Ve 9,217
s_nop 0
Vc 108,8,9
Ve 8,218
Ve 9,219
s_nop 0
Vc 109,8,9
Ve 8,232
Ve 9,233
s_nop 0
Vc 116,8,9
Ve 8,234
Ve 9,235
s_nop 0
Vc 117,8,9
Ve 8,248
Ve 9,249
s_nop 0
Vc 124,8,9
Ve 8,250
Ve 9,251
s_nop 0
Vc 125,8,9
Ve 8,204
Ve 9,205
s_nop 0
Vc 102,8,9
Ve 8,206
Ve 9,207
s_nop 0
Vc 103,8,9
Ve 8,220
Ve 9,221
s_nop 0
Vc 110,8,9
Ve 8,222
Ve 9,223
s_nop 0
Vc 111,8,9
Ve 8,236
Ve 9,237
s_nop 0
Vc 118,8,9
Ve 8,238
Ve 9,239
s_nop 0
Vc 119,8,9
Ve 8,252
Ve 9,253
s_nop 0
Vc 126,8,9
Ve 8,254
Ve 9,255
s_nop 0
Vc 127,8,9
s_nop 1
s_branch L_k2_fbr_wo
L_k2_mk_wo:
s_nop 7
s_add_u32 s3, s37, 1
s_lshl_b32 s3, s3, 6
v_subrev_u32 v1, s3, v6
v_cmp_gt_i32 s[56:57], -16, v1
v_cmp_gt_i32 s[58:59], -15, v1
v_cmp_gt_i32 s[60:61], -14, v1
v_cmp_gt_i32 s[62:63], -13, v1
v_cndmask_b32 v176, v176, v20, s[56:57]
v_cndmask_b32 v177, v177, v20, s[58:59]
v_cndmask_b32 v178, v178, v20, s[60:61]
v_cndmask_b32 v179, v179, v20, s[62:63]
v_cmp_gt_i32 s[56:57], 0, v1
v_cmp_gt_i32 s[58:59], 1, v1
v_cmp_gt_i32 s[60:61], 2, v1
v_cmp_gt_i32 s[62:63], 3, v1
v_cndmask_b32 v160, v160, v20, s[56:57]
v_cndmask_b32 v161, v161, v20, s[58:59]
v_cndmask_b32 v162, v162, v20, s[60:61]
v_cndmask_b32 v163, v163, v20, s[62:63]
v_cndmask_b32 v180, v180, v20, s[56:57]
v_cndmask_b32 v181, v181, v20, s[58:59]
v_cndmask_b32 v182, v182, v20, s[60:61]
v_cndmask_b32 v183, v183, v20, s[62:63]
v_cmp_gt_i32 s[56:57], 16, v1
v_cmp_gt_i32 s[58:59], 17, v1
v_cmp_gt_i32 s[60:61], 18, v1
v_cmp_gt_i32 s[62:63], 19, v1
v_cndmask_b32 v164, v164, v20, s[56:57]
v_cndmask_b32 v165, v165, v20, s[58:59]
v_cndmask_b32 v166, v166, v20, s[60:61]
v_cndmask_b32 v167, v167, v20, s[62:63]
v_cndmask_b32 v184, v184, v20, s[56:57]
v_cndmask_b32 v185, v185, v20, s[58:59]
v_cndmask_b32 v186, v186, v20, s[60:61]
v_cndmask_b32 v187, v187, v20, s[62:63]
v_cmp_gt_i32 s[56:57], 32, v1
v_cmp_gt_i32 s[58:59], 33, v1
v_cmp_gt_i32 s[60:61], 34, v1
v_cmp_gt_i32 s[62:63], 35, v1
v_cndmask_b32 v168, v168, v20, s[56:57]
v_cndmask_b32 v169, v169, v20, s[58:59]
v_cndmask_b32 v170, v170, v20, s[60:61]
v_cndmask_b32 v171, v171, v20, s[62:63]
v_cndmask_b32 v188, v188, v20, s[56:57]
v_cndmask_b32 v189, v189, v20, s[58:59]
v_cndmask_b32 v190, v190, v20, s[60:61]
v_cndmask_b32 v191, v191, v20, s[62:63]
v_cmp_gt_i32 s[56:57], 48, v1
v_cmp_gt_i32 s[58:59], 49, v1
v_cmp_gt_i32 s[60:61], 50, v1
v_cmp_gt_i32 s[62:63], 51, v1
v_cndmask_b32 v172, v172, v20, s[56:57]
v_cndmask_b32 v173, v173, v20, s[58:59]
v_cndmask_b32 v174, v174, v20, s[60:61]
v_cndmask_b32 v175, v175, v20, s[62:63]
s_nop 1
s_branch L_k2_mkr_wo
L_k2_fb_tr:
s_nop 7
v_max3_f32 v21, v192, v193, v194
v_max3_f32 v21, v21, v195, v196
v_max3_f32 v21, v21, v197, v198
v_max3_f32 v21, v21, v199, v200
v_max3_f32 v21, v21, v201, v202
v_max3_f32 v21, v21, v203, v204
v_max3_f32 v21, v21, v205, v206
v_max_f32 v21, v21, v207
v_mov_b32 v1, v21
s_nop 1
v_permlane16_swap_b32 v1, v21
v_max_f32 v21, v21, v1
v_mov_b32 v1, v21
s_nop 1
v_permlane32_swap_b32 v1, v21
v_max_f32 v21, v21, v1
v_add_f32 v21, 0x40e00000, v21
v_max_f32 v21, 0, v21
Vs 192,192,21
Vs 193,193,21
Vs 194,194,21
Vs 195,195,21
Vs 196,196,21
Vs 197,197,21
Vs 198,198,21
Vs 199,199,21
Vs 200,200,21
Vs 201,201,21
Vs 202,202,21
Vs 203,203,21
Vs 204,204,21
Vs 205,205,21
Vs 206,206,21
Vs 207,207,21
Vs 128,128,21
Vs 129,129,21
Vs 130,130,21
Vs 131,131,21
Vs 132,132,21
Vs 133,133,21
Vs 134,134,21
Vs 135,135,21
Vs 136,136,21
Vs 137,137,21
Vs 138,138,21
Vs 139,139,21
Vs 140,140,21
Vs 141,141,21
Vs 142,142,21
Vs 143,143,21
Vs 32,32,21
Vs 33,33,21
Vs 34,34,21
Vs 35,35,21
v_exp_f32 v22, -v21
s_nop 0
Vm 48,48,22
Vm 49,49,22
Vm 50,50,22
Vm 51,51,22
Ar 8,0
Ar 9,1
Ar 10,2
Ar 11,3
Ar 12,4
Ar 13,5
Ar 14,6
Ar 15,7
Vm 8,8,22
Vm 9,9,22
Vm 10,10,22
Vm 11,11,22
Vm 12,12,22
Vm 13,13,22
Vm 14,14,22
Vm 15,15,22
Aw 0,8
Aw 1,9
Aw 2,10
Aw 3,11
Aw 4,12
Aw 5,13
Aw 6,14
Aw 7,15
Ar 8,8
Ar 9,9
Ar 10,10
Ar 11,11
Ar 12,12
Ar 13,13
Ar 14,14
Ar 15,15
Vm 8,8,22
Vm 9,9,22
Vm 10,10,22
Vm 11,11,22
Vm 12,12,22
Vm 13,13,22
Vm 14,14,22
Vm 15,15,22
Aw 8,8
Aw 9,9
Aw 10,10
Aw 11,11
Aw 12,12
Aw 13,13
Aw 14,14
Aw 15,15
Ar 8,16
Ar 9,17
Ar 10,18
Ar 11,19
Ar 12,20
Ar 13,21
Ar 14,22
Ar 15,23
Vm 8,8,22
Vm 9,9,22
Vm 10,10,22
Vm 11,11,22
Vm 12,12,22
Vm 13,13,22
Vm 14,14,22
Vm 15,15,22
Aw 16,8
Aw 17,9
Aw 18,10
Aw 19,11
Aw 20,12
Aw 21,13
Aw 22,14
Aw 23,15
Ar 8,24
Ar 9,25
Ar 10,26
Ar 11,27
Ar 12,28
Ar 13,29
Ar 14,30
Ar 15,31
Vm 8,8,22
Vm 9,9,22
Vm 10,10,22
Vm 11,11,22
Vm 12,12,22
Vm 13,13,22
Vm 14,14,22
Vm 15,15,22
Aw 24,8
Aw 25,9
Aw 26,10
Aw 27,11
Aw 28,12
Aw 29,13
Aw 30,14
Aw 31,15
v_max3_f32 v21, v208, v209, v210
v_max3_f32 v21, v21, v211, v212
v_max3_f32 v21, v21, v213, v214
v_max3_f32 v21, v21, v215, v216
v_max3_f32 v21, v21, v217, v218
v_max3_f32 v21, v21, v219, v220
v_max3_f32 v21, v21, v221, v222
v_max_f32 v21, v21, v223
v_mov_b32 v1, v21
s_nop 1
v_permlane16_swap_b32 v1, v21
v_max_f32 v21, v21, v1
v_mov_b32 v1, v21
s_nop 1
v_permlane32_swap_b32 v1, v21
v_max_f32 v21, v21, v1
v_add_f32 v21, 0x40e00000, v21
v_max_f32 v21, 0, v21
Vs 208,208,21
Vs 209,209,21
Vs 210,210,21
Vs 211,211,21
Vs 212,212,21
Vs 213,213,21
Vs 214,214,21
Vs 215,215,21
Vs 216,216,21
Vs 217,217,21
Vs 218,218,21
Vs 219,219,21
Vs 220,220,21
Vs 221,221,21
Vs 222,222,21
Vs 223,223,21
Vs 144,144,21
Vs 145,145,21
Vs 146,146,21
Vs 147,147,21
Vs 148,148,21
Vs 149,149,21
Vs 150,150,21
Vs 151,151,21
Vs 152,152,21
Vs 153,153,21
Vs 154,154,21
Vs 155,155,21
Vs 156,156,21
Vs 157,157,21
Vs 158,158,21
Vs 159,159,21
Vs 36,36,21
Vs 37,37,21
Vs 38,38,21
Vs 39,39,21
v_exp_f32 v22, -v21
s_nop 0
Vm 52,52,22
Vm 53,53,22
Vm 54,54,22
Vm 55,55,22
Ar 8,32
Ar 9,33
Ar 10,34
Ar 11,35
Ar 12,36
Ar 13,37
Ar 14,38
Ar 15,39
Vm 8,8,22
Vm 9,9,22
Vm 10,10,22
Vm 11,11,22
Vm 12,12,22
Vm 13,13,22
Vm 14,14,22
Vm 15,15,22
Aw 32,8
Aw 33,9
Aw 34,10
Aw 35,11
Aw 36,12
Aw 37,13
Aw 38,14
Aw 39,15
Ar 8,40
Ar 9,41
Ar 10,42
Ar 11,43
Ar 12,44
Ar 13,45
Ar 14,46
Ar 15,47
Vm 8,8,22
Vm 9,9,22
Vm 10,10,22
Vm 11,11,22
Vm 12,12,22
Vm 13,13,22
Vm 14,14,22
Vm 15,15,22
Aw 40,8
Aw 41,9
Aw 42,10
Aw 43,11
Aw 44,12
Aw 45,13
Aw 46,14
Aw 47,15
Ar 8,48
Ar 9,49
Ar 10,50
Ar 11,51
Ar 12,52
Ar 13,53
Ar 14,54
Ar 15,55
Vm 8,8,22
Vm 9,9,22
Vm 10,10,22
Vm 11,11,22
Vm 12,12,22
Vm 13,13,22
Vm 14,14,22
Vm 15,15,22
Aw 48,8
Aw 49,9
Aw 50,10
Aw 51,11
Aw 52,12
Aw 53,13
Aw 54,14
Aw 55,15
Ar 8,56
Ar 9,57
Ar 10,58
Ar 11,59
Ar 12,60
Ar 13,61
Ar 14,62
Ar 15,63
Vm 8,8,22
Vm 9,9,22
Vm 10,10,22
Vm 11,11,22
Vm 12,12,22
Vm 13,13,22
Vm 14,14,22
Vm 15,15,22
Aw 56,8
Aw 57,9
Aw 58,10
Aw 59,11
Aw 60,12
Aw 61,13
Aw 62,14
Aw 63,15
v_max3_f32 v21, v224, v225, v226
v_max3_f32 v21, v21, v227, v228
v_max3_f32 v21, v21, v229, v230
v_max3_f32 v21, v21, v231, v232
v_max3_f32 v21, v21, v233, v234
v_max3_f32 v21, v21, v235, v236
v_max3_f32 v21, v21, v237, v238
v_max_f32 v21, v21, v239
v_mov_b32 v1, v21
s_nop 1
v_permlane16_swap_b32 v1, v21
v_max_f32 v21, v21, v1
v_mov_b32 v1, v21
s_nop 1
v_permlane32_swap_b32 v1, v21
v_max_f32 v21, v21, v1
v_add_f32 v21, 0x40e00000, v21
v_max_f32 v21, 0, v21
Vs 224,224,21
Vs 225,225,21
Vs 226,226,21
Vs 227,227,21
Vs 228,228,21
Vs 229,229,21
Vs 230,230,21
Vs 231,231,21
Vs 232,232,21
Vs 233,233,21
Vs 234,234,21
Vs 235,235,21
Vs 236,236,21
Vs 237,237,21
Vs 238,238,21
Vs 239,239,21
Vs 40,40,21
Vs 41,41,21
Vs 42,42,21
Vs 43,43,21
v_exp_f32 v22, -v21
s_nop 0
Vm 56,56,22
Vm 57,57,22
Vm 58,58,22
Vm 59,59,22
Ar 8,64
Ar 9,65
Ar 10,66
Ar 11,67
Ar 12,68
Ar 13,69
Ar 14,70
Ar 15,71
Vm 8,8,22
Vm 9,9,22
Vm 10,10,22
Vm 11,11,22
Vm 12,12,22
Vm 13,13,22
Vm 14,14,22
Vm 15,15,22
Aw 64,8
Aw 65,9
Aw 66,10
Aw 67,11
Aw 68,12
Aw 69,13
Aw 70,14
Aw 71,15
Ar 8,72
Ar 9,73
Ar 10,74
Ar 11,75
Ar 12,76
Ar 13,77
Ar 14,78
Ar 15,79
Vm 8,8,22
Vm 9,9,22
Vm 10,10,22
Vm 11,11,22
Vm 12,12,22
Vm 13,13,22
Vm 14,14,22
Vm 15,15,22
Aw 72,8
Aw 73,9
Aw 74,10
Aw 75,11
Aw 76,12
Aw 77,13
Aw 78,14
Aw 79,15
Ar 8,80
Ar 9,81
Ar 10,82
Ar 11,83
Ar 12,84
Ar 13,85
Ar 14,86
Ar 15,87
Vm 8,8,22
Vm 9,9,22
Vm 10,10,22
Vm 11,11,22
Vm 12,12,22
Vm 13,13,22
Vm 14,14,22
Vm 15,15,22
Aw 80,8
Aw 81,9
Aw 82,10
Aw 83,11
Aw 84,12
Aw 85,13
Aw 86,14
Aw 87,15
Ar 8,88
Ar 9,89
Ar 10,90
Ar 11,91
Ar 12,92
Ar 13,93
Ar 14,94
Ar 15,95
Vm 8,8,22
Vm 9,9,22
Vm 10,10,22
Vm 11,11,22
Vm 12,12,22
Vm 13,13,22
Vm 14,14,22
Vm 15,15,22
Aw 88,8
Aw 89,9
Aw 90,10
Aw 91,11
Aw 92,12
Aw 93,13
Aw 94,14
Aw 95,15
v_max3_f32 v21, v240, v241, v242
v_max3_f32 v21, v21, v243, v244
v_max3_f32 v21, v21, v245, v246
v_max3_f32 v21, v21, v247, v248
v_max3_f32 v21, v21, v249, v250
v_max3_f32 v21, v21, v251, v252
v_max3_f32 v21, v21, v253, v254
v_max_f32 v21, v21, v255
v_mov_b32 v1, v21
s_nop 1
v_permlane16_swap_b32 v1, v21
v_max_f32 v21, v21, v1
v_mov_b32 v1, v21
s_nop 1
v_permlane32_swap_b32 v1, v21
v_max_f32 v21, v21, v1
v_add_f32 v21, 0x40e00000, v21
v_max_f32 v21, 0, v21
Vs 240,240,21
Vs 241,241,21
Vs 242,242,21
Vs 243,243,21
Vs 244,244,21
Vs 245,245,21
Vs 246,246,21
Vs 247,247,21
Vs 248,248,21
Vs 249,249,21
Vs 250,250,21
Vs 251,251,21
Vs 252,252,21
Vs 253,253,21
Vs 254,254,21
Vs 255,255,21
Vs 44,44,21
Vs 45,45,21
Vs 46,46,21
Vs 47,47,21
v_exp_f32 v22, -v21
s_nop 0
Vm 60,60,22
Vm 61,61,22
Vm 62,62,22
Vm 63,63,22
Ar 8,96
Ar 9,97
Ar 10,98
Ar 11,99
Ar 12,100
Ar 13,101
Ar 14,102
Ar 15,103
Vm 8,8,22
Vm 9,9,22
Vm 10,10,22
Vm 11,11,22
Vm 12,12,22
Vm 13,13,22
Vm 14,14,22
Vm 15,15,22
Aw 96,8
Aw 97,9
Aw 98,10
Aw 99,11
Aw 100,12
Aw 101,13
Aw 102,14
Aw 103,15
Ar 8,104
Ar 9,105
Ar 10,106
Ar 11,107
Ar 12,108
Ar 13,109
Ar 14,110
Ar 15,111
Vm 8,8,22
Vm 9,9,22
Vm 10,10,22
Vm 11,11,22
Vm 12,12,22
Vm 13,13,22
Vm 14,14,22
Vm 15,15,22
Aw 104,8
Aw 105,9
Aw 106,10
Aw 107,11
Aw 108,12
Aw 109,13
Aw 110,14
Aw 111,15
Ar 8,112
Ar 9,113
Ar 10,114
Ar 11,115
Ar 12,116
Ar 13,117
Ar 14,118
Ar 15,119
Vm 8,8,22
Vm 9,9,22
Vm 10,10,22
Vm 11,11,22
Vm 12,12,22
Vm 13,13,22
Vm 14,14,22
Vm 15,15,22
Aw 112,8
Aw 113,9
Aw 114,10
Aw 115,11
Aw 116,12
Aw 117,13
Aw 118,14
Aw 119,15
Ar 8,120
Ar 9,121
Ar 10,122
Ar 11,123
Ar 12,124
Ar 13,125
Ar 14,126
Ar 15,127
Vm 8,8,22
Vm 9,9,22
Vm 10,10,22
Vm 11,11,22
Vm 12,12,22
Vm 13,13,22
Vm 14,14,22
Vm 15,15,22
Aw 120,8
Aw 121,9
Aw 122,10
Aw 123,11
Aw 124,12
Aw 125,13
Aw 126,14
Aw 127,15
Ve 8,192
Ve 9,193
s_nop 0
Vc 96,8,9
Ve 8,194
Ve 9,195
s_nop 0
Vc 97,8,9
Ve 8,208
Ve 9,209
s_nop 0
Vc 104,8,9
Ve 8,210
Ve 9,211
s_nop 0
Vc 105,8,9
Ve 8,224
Ve 9,225
s_nop 0
Vc 112,8,9
Ve 8,226
Ve 9,227
s_nop 0
Vc 113,8,9
Ve 8,240
Ve 9,241
s_nop 0
Vc 120,8,9
Ve 8,242
Ve 9,243
s_nop 0
Vc 121,8,9
Ve 8,196
Ve 9,197
s_nop 0
Vc 98,8,9
Ve 8,198
Ve 9,199
s_nop 0
Vc 99,8,9
Ve 8,212
Ve 9,213
s_nop 0
Vc 106,8,9
Ve 8,214
Ve 9,215
s_nop 0
Vc 107,8,9
Ve 8,228
Ve 9,229
s_nop 0
Vc 114,8,9
Ve 8,230
Ve 9,231
s_nop 0
Vc 115,8,9
Ve 8,244
Ve 9,245
s_nop 0
Vc 122,8,9
Ve 8,246
Ve 9,247
s_nop 0
Vc 123,8,9
Ve 8,200
Ve 9,201
s_nop 0
Vc 100,8,9
Ve 8,202
Ve 9,203
s_nop 0
Vc 101,8,9
Ve 8,216
Ve 9,217
s_nop 0
Vc 108,8,9
Ve 8,218
Ve 9,219
s_nop 0
Vc 109,8,9
Ve 8,232
Ve 9,233
s_nop 0
Vc 116,8,9
Ve 8,234
Ve 9,235
s_nop 0
Vc 117,8,9
Ve 8,248
Ve 9,249
s_nop 0
Vc 124,8,9
Ve 8,250
Ve 9,251
s_nop 0
Vc 125,8,9
Ve 8,204
Ve 9,205
s_nop 0
Vc 102,8,9
Ve 8,206
Ve 9,207
s_nop 0
Vc 103,8,9
Ve 8,220
Ve 9,221
s_nop 0
Vc 110,8,9
Ve 8,222
Ve 9,223
s_nop 0
Vc 111,8,9
Ve 8,236
Ve 9,237
s_nop 0
Vc 118,8,9
Ve 8,238
Ve 9,239
s_nop 0
Vc 119,8,9
Ve 8,252
Ve 9,253
s_nop 0
Vc 126,8,9
Ve 8,254
Ve 9,255
s_nop 0
Vc 127,8,9
s_nop 1
s_branch L_k2_fbr_tr
L_k2_mk_tr:
s_nop 7
s_add_u32 s3, s37, 1
s_lshl_b32 s3, s3, 6
v_subrev_u32 v1, s3, v5
v_cmp_gt_i32 s[56:57], -16, v1
v_cmp_gt_i32 s[58:59], -15, v1
v_cmp_gt_i32 s[60:61], -14, v1
v_cmp_gt_i32 s[62:63], -13, v1
v_cndmask_b32 v144, v144, v20, s[56:57]
v_cndmask_b32 v145, v145, v20, s[58:59]
v_cndmask_b32 v146, v146, v20, s[60:61]
v_cndmask_b32 v147, v147, v20, s[62:63]
v_cmp_gt_i32 s[56:57], 0, v1
v_cmp_gt_i32 s[58:59], 1, v1
v_cmp_gt_i32 s[60:61], 2, v1
v_cmp_gt_i32 s[62:63], 3, v1
v_cndmask_b32 v128, v128, v20, s[56:57]
v_cndmask_b32 v129, v129, v20, s[58:59]
v_cndmask_b32 v130, v130, v20, s[60:61]
v_cndmask_b32 v131, v131, v20, s[62:63]
v_cndmask_b32 v148, v148, v20, s[56:57]
v_cndmask_b32 v149, v149, v20, s[58:59]
v_cndmask_b32 v150, v150, v20, s[60:61]
v_cndmask_b32 v151, v151, v20, s[62:63]
v_cmp_gt_i32 s[56:57], 16, v1
v_cmp_gt_i32 s[58:59], 17, v1
v_cmp_gt_i32 s[60:61], 18, v1
v_cmp_gt_i32 s[62:63], 19, v1
v_cndmask_b32 v132, v132, v20, s[56:57]
v_cndmask_b32 v133, v133, v20, s[58:59]
v_cndmask_b32 v134, v134, v20, s[60:61]
v_cndmask_b32 v135, v135, v20, s[62:63]
v_cndmask_b32 v152, v152, v20, s[56:57]
v_cndmask_b32 v153, v153, v20, s[58:59]
v_cndmask_b32 v154, v154, v20, s[60:61]
v_cndmask_b32 v155, v155, v20, s[62:63]
v_cmp_gt_i32 s[56:57], 32, v1
v_cmp_gt_i32 s[58:59], 33, v1
v_cmp_gt_i32 s[60:61], 34, v1
v_cmp_gt_i32 s[62:63], 35, v1
v_cndmask_b32 v136, v136, v20, s[56:57]
v_cndmask_b32 v137, v137, v20, s[58:59]
v_cndmask_b32 v138, v138, v20, s[60:61]
v_cndmask_b32 v139, v139, v20, s[62:63]
v_cndmask_b32 v156, v156, v20, s[56:57]
v_cndmask_b32 v157, v157, v20, s[58:59]
v_cndmask_b32 v158, v158, v20, s[60:61]
v_cndmask_b32 v159, v159, v20, s[62:63]
v_cmp_gt_i32 s[56:57], 48, v1
v_cmp_gt_i32 s[58:59], 49, v1
v_cmp_gt_i32 s[60:61], 50, v1
v_cmp_gt_i32 s[62:63], 51, v1
v_cndmask_b32 v140, v140, v20, s[56:57]
v_cndmask_b32 v141, v141, v20, s[58:59]
v_cndmask_b32 v142, v142, v20, s[60:61]
v_cndmask_b32 v143, v143, v20, s[62:63]
s_nop 1
s_branch L_k2_mkr_tr
L_k2_fb_ne:
s_nop 7
v_max3_f32 v21, v128, v129, v130
v_max3_f32 v21, v21, v131, v132
v_max3_f32 v21, v21, v133, v134
v_max3_f32 v21, v21, v135, v136
v_max3_f32 v21, v21, v137, v138
v_max3_f32 v21, v21, v139, v140
v_max3_f32 v21, v21, v141, v142
v_max_f32 v21, v21, v143
v_mov_b32 v1, v21
s_nop 1
v_permlane16_swap_b32 v1, v21
v_max_f32 v21, v21, v1
v_mov_b32 v1, v21
s_nop 1
v_permlane32_swap_b32 v1, v21
v_max_f32 v21, v21, v1
v_add_f32 v21, 0x40e00000, v21
v_max_f32 v21, 0, v21
Vs 128,128,21
Vs 129,129,21
Vs 130,130,21
Vs 131,131,21
Vs 132,132,21
Vs 133,133,21
Vs 134,134,21
Vs 135,135,21
Vs 136,136,21
Vs 137,137,21
Vs 138,138,21
Vs 139,139,21
Vs 140,140,21
Vs 141,141,21
Vs 142,142,21
Vs 143,143,21
Vs 192,192,21
Vs 193,193,21
Vs 194,194,21
Vs 195,195,21
Vs 196,196,21
Vs 197,197,21
Vs 198,198,21
Vs 199,199,21
Vs 200,200,21
Vs 201,201,21
Vs 202,202,21
Vs 203,203,21
Vs 204,204,21
Vs 205,205,21
Vs 206,206,21
Vs 207,207,21
Vs 32,32,21
Vs 33,33,21
Vs 34,34,21
Vs 35,35,21
v_exp_f32 v22, -v21
s_nop 0
Vm 48,48,22
Vm 49,49,22
Vm 50,50,22
Vm 51,51,22
Ar 8,0
Ar 9,1
Ar 10,2
Ar 11,3
Ar 12,4
Ar 13,5
Ar 14,6
Ar 15,7
Vm 8,8,22
Vm 9,9,22
Vm 10,10,22
Vm 11,11,22
Vm 12,12,22
Vm 13,13,22
Vm 14,14,22
Vm 15,15,22
Aw 0,8
Aw 1,9
Aw 2,10
Aw 3,11
Aw 4,12
Aw 5,13
Aw 6,14
Aw 7,15
Ar 8,8
Ar 9,9
Ar 10,10
Ar 11,11
Ar 12,12
Ar 13,13
Ar 14,14
Ar 15,15
Vm 8,8,22
Vm 9,9,22
Vm 10,10,22
Vm 11,11,22
Vm 12,12,22
Vm 13,13,22
Vm 14,14,22
Vm 15,15,22
Aw 8,8
Aw 9,9
Aw 10,10
Aw 11,11
Aw 12,12
Aw 13,13
Aw 14,14
Aw 15,15
Ar 8,16
Ar 9,17
Ar 10,18
Ar 11,19
Ar 12,20
Ar 13,21
Ar 14,22
Ar 15,23
Vm 8,8,22
Vm 9,9,22
Vm 10,10,22
Vm 11,11,22
Vm 12,12,22
Vm 13,13,22
Vm 14,14,22
Vm 15,15,22
Aw 16,8
Aw 17,9
Aw 18,10
Aw 19,11
Aw 20,12
Aw 21,13
Aw 22,14
Aw 23,15
Ar 8,24
Ar 9,25
Ar 10,26
Ar 11,27
Ar 12,28
Ar 13,29
Ar 14,30
Ar 15,31
Vm 8,8,22
Vm 9,9,22
Vm 10,10,22
Vm 11,11,22
Vm 12,12,22
Vm 13,13,22
Vm 14,14,22
Vm 15,15,22
Aw 24,8
Aw 25,9
Aw 26,10
Aw 27,11
Aw 28,12
Aw 29,13
Aw 30,14
Aw 31,15
v_max3_f32 v21, v144, v145, v146
v_max3_f32 v21, v21, v147, v148
v_max3_f32 v21, v21, v149, v150
v_max3_f32 v21, v21, v151, v152
v_max3_f32 v21, v21, v153, v154
v_max3_f32 v21, v21, v155, v156
v_max3_f32 v21, v21, v157, v158
v_max_f32 v21, v21, v159
v_mov_b32 v1, v21
s_nop 1
v_permlane16_swap_b32 v1, v21
v_max_f32 v21, v21, v1
v_mov_b32 v1, v21
s_nop 1
v_permlane32_swap_b32 v1, v21
v_max_f32 v21, v21, v1
v_add_f32 v21, 0x40e00000, v21
v_max_f32 v21, 0, v21
Vs 144,144,21
Vs 145,145,21
Vs 146,146,21
Vs 147,147,21
Vs 148,148,21
Vs 149,149,21
Vs 150,150,21
Vs 151,151,21
Vs 152,152,21
Vs 153,153,21
Vs 154,154,21
Vs 155,155,21
Vs 156,156,21
Vs 157,157,21
Vs 158,158,21
Vs 159,159,21
Vs 208,208,21
Vs 209,209,21
Vs 210,210,21
Vs 211,211,21
Vs 212,212,21
Vs 213,213,21
Vs 214,214,21
Vs 215,215,21
Vs 216,216,21
Vs 217,217,21
Vs 218,218,21
Vs 219,219,21
Vs 220,220,21
Vs 221,221,21
Vs 222,222,21
Vs 223,223,21
Vs 36,36,21
Vs 37,37,21
Vs 38,38,21
Vs 39,39,21
v_exp_f32 v22, -v21
s_nop 0
Vm 52,52,22
Vm 53,53,22
Vm 54,54,22
Vm 55,55,22
Ar 8,32
Ar 9,33
Ar 10,34
Ar 11,35
Ar 12,36
Ar 13,37
Ar 14,38
Ar 15,39
Vm 8,8,22
Vm 9,9,22
Vm 10,10,22
Vm 11,11,22
Vm 12,12,22
Vm 13,13,22
Vm 14,14,22
Vm 15,15,22
Aw 32,8
Aw 33,9
Aw 34,10
Aw 35,11
Aw 36,12
Aw 37,13
Aw 38,14
Aw 39,15
Ar 8,40
Ar 9,41
Ar 10,42
Ar 11,43
Ar 12,44
Ar 13,45
Ar 14,46
Ar 15,47
Vm 8,8,22
Vm 9,9,22
Vm 10,10,22
Vm 11,11,22
Vm 12,12,22
Vm 13,13,22
Vm 14,14,22
Vm 15,15,22
Aw 40,8
Aw 41,9
Aw 42,10
Aw 43,11
Aw 44,12
Aw 45,13
Aw 46,14
Aw 47,15
Ar 8,48
Ar 9,49
Ar 10,50
Ar 11,51
Ar 12,52
Ar 13,53
Ar 14,54
Ar 15,55
Vm 8,8,22
Vm 9,9,22
Vm 10,10,22
Vm 11,11,22
Vm 12,12,22
Vm 13,13,22
Vm 14,14,22
Vm 15,15,22
Aw 48,8
Aw 49,9
Aw 50,10
Aw 51,11
Aw 52,12
Aw 53,13
Aw 54,14
Aw 55,15
Ar 8,56
Ar 9,57
Ar 10,58
Ar 11,59
Ar 12,60
Ar 13,61
Ar 14,62
Ar 15,63
Vm 8,8,22
Vm 9,9,22
Vm 10,10,22
Vm 11,11,22
Vm 12,12,22
Vm 13,13,22
Vm 14,14,22
Vm 15,15,22
Aw 56,8
Aw 57,9
Aw 58,10
Aw 59,11
Aw 60,12
Aw 61,13
Aw 62,14
Aw 63,15
Ve 8,128
Ve 9,129
s_nop 0
Vc 64,8,9
Ve 8,130
Ve 9,131
s_nop 0
Vc 65,8,9
Ve 8,144
Ve 9,145
s_nop 0
Vc 72,8,9
Ve 8,146
Ve 9,147
s_nop 0
Vc 73,8,9
Ve 8,132
Ve 9,133
s_nop 0
Vc 66,8,9
Ve 8,134
Ve 9,135
s_nop 0
Vc 67,8,9
Ve 8,148
Ve 9,149
s_nop 0
Vc 74,8,9
Ve 8,150
Ve 9,151
s_nop 0
Vc 75,8,9
Ve 8,136
Ve 9,137
s_nop 0
Vc 68,8,9
Ve 8,138
Ve 9,139
s_nop 0
Vc 69,8,9
Ve 8,152
Ve 9,153
s_nop 0
Vc 76,8,9
Ve 8,154
Ve 9,155
s_nop 0
Vc 77,8,9
Ve 8,140
Ve 9,141
s_nop 0
Vc 70,8,9
Ve 8,142
Ve 9,143
s_nop 0
Vc 71,8,9
Ve 8,156
Ve 9,157
s_nop 0
Vc 78,8,9
Ve 8,158
Ve 9,159
s_nop 0
Vc 79,8,9
s_nop 1
s_branch L_k2_fbr_ne
L_k2_mk_ne:
s_nop 7
s_add_u32 s3, s37, 1
s_lshl_b32 s3, s3, 6
v_subrev_u32 v1, s3, v5
v_cmp_gt_i32 s[56:57], -16, v1
v_cmp_gt_i32 s[58:59], -15, v1
v_cmp_gt_i32 s[60:61], -14, v1
v_cmp_gt_i32 s[62:63], -13, v1
v_cndmask_b32 v208, v208, v20, s[56:57]
v_cndmask_b32 v209, v209, v20, s[58:59]
v_cndmask_b32 v210, v210, v20, s[60:61]
v_cndmask_b32 v211, v211, v20, s[62:63]
v_cmp_gt_i32 s[56:57], 0, v1
v_cmp_gt_i32 s[58:59], 1, v1
v_cmp_gt_i32 s[60:61], 2, v1
v_cmp_gt_i32 s[62:63], 3, v1
v_cndmask_b32 v192, v192, v20, s[56:57]
v_cndmask_b32 v193, v193, v20, s[58:59]
v_cndmask_b32 v194, v194, v20, s[60:61]
v_cndmask_b32 v195, v195, v20, s[62:63]
v_cndmask_b32 v212, v212, v20, s[56:57]
v_cndmask_b32 v213, v213, v20, s[58:59]
v_cndmask_b32 v214, v214, v20, s[60:61]
v_cndmask_b32 v215, v215, v20, s[62:63]
v_cmp_gt_i32 s[56:57], 16, v1
v_cmp_gt_i32 s[58:59], 17, v1
v_cmp_gt_i32 s[60:61], 18, v1
v_cmp_gt_i32 s[62:63], 19, v1
v_cndmask_b32 v196, v196, v20, s[56:57]
v_cndmask_b32 v197, v197, v20, s[58:59]
v_cndmask_b32 v198, v198, v20, s[60:61]
v_cndmask_b32 v199, v199, v20, s[62:63]
v_cndmask_b32 v216, v216, v20, s[56:57]
v_cndmask_b32 v217, v217, v20, s[58:59]
v_cndmask_b32 v218, v218, v20, s[60:61]
v_cndmask_b32 v219, v219, v20, s[62:63]
v_cmp_gt_i32 s[56:57], 32, v1
v_cmp_gt_i32 s[58:59], 33, v1
v_cmp_gt_i32 s[60:61], 34, v1
v_cmp_gt_i32 s[62:63], 35, v1
v_cndmask_b32 v200, v200, v20, s[56:57]
v_cndmask_b32 v201, v201, v20, s[58:59]
v_cndmask_b32 v202, v202, v20, s[60:61]
v_cndmask_b32 v203, v203, v20, s[62:63]
v_cndmask_b32 v220, v220, v20, s[56:57]
v_cndmask_b32 v221, v221, v20, s[58:59]
v_cndmask_b32 v222, v222, v20, s[60:61]
v_cndmask_b32 v223, v223, v20, s[62:63]
v_cmp_gt_i32 s[56:57], 48, v1
v_cmp_gt_i32 s[58:59], 49, v1
v_cmp_gt_i32 s[60:61], 50, v1
v_cmp_gt_i32 s[62:63], 51, v1
v_cndmask_b32 v204, v204, v20, s[56:57]
v_cndmask_b32 v205, v205, v20, s[58:59]
v_cndmask_b32 v206, v206, v20, s[60:61]
v_cndmask_b32 v207, v207, v20, s[62:63]
s_nop 1
s_branch L_k2_mkr_ne
L_k2_fb_no:
s_nop 7
v_max3_f32 v21, v192, v193, v194
v_max3_f32 v21, v21, v195, v196
v_max3_f32 v21, v21, v197, v198
v_max3_f32 v21, v21, v199, v200
v_max3_f32 v21, v21, v201, v202
v_max3_f32 v21, v21, v203, v204
v_max3_f32 v21, v21, v205, v206
v_max_f32 v21, v21, v207
v_mov_b32 v1, v21
s_nop 1
v_permlane16_swap_b32 v1, v21
v_max_f32 v21, v21, v1
v_mov_b32 v1, v21
s_nop 1
v_permlane32_swap_b32 v1, v21
v_max_f32 v21, v21, v1
v_add_f32 v21, 0x40e00000, v21
v_max_f32 v21, 0, v21
Vs 192,192,21
Vs 193,193,21
Vs 194,194,21
Vs 195,195,21
Vs 196,196,21
Vs 197,197,21
Vs 198,198,21
Vs 199,199,21
Vs 200,200,21
Vs 201,201,21
Vs 202,202,21
Vs 203,203,21
Vs 204,204,21
Vs 205,205,21
Vs 206,206,21
Vs 207,207,21
Vs 128,128,21
Vs 129,129,21
Vs 130,130,21
Vs 131,131,21
Vs 132,132,21
Vs 133,133,21
Vs 134,134,21
Vs 135,135,21
Vs 136,136,21
Vs 137,137,21
Vs 138,138,21
Vs 139,139,21
Vs 140,140,21
Vs 141,141,21
Vs 142,142,21
Vs 143,143,21
Vs 32,32,21
Vs 33,33,21
Vs 34,34,21
Vs 35,35,21
v_exp_f32 v22, -v21
s_nop 0
Vm 48,48,22
Vm 49,49,22
Vm 50,50,22
Vm 51,51,22
Ar 8,0
Ar 9,1
Ar 10,2
Ar 11,3
Ar 12,4
Ar 13,5
Ar 14,6
Ar 15,7
Vm 8,8,22
Vm 9,9,22
Vm 10,10,22
Vm 11,11,22
Vm 12,12,22
Vm 13,13,22
Vm 14,14,22
Vm 15,15,22
Aw 0,8
Aw 1,9
Aw 2,10
Aw 3,11
Aw 4,12
Aw 5,13
Aw 6,14
Aw 7,15
Ar 8,8
Ar 9,9
Ar 10,10
Ar 11,11
Ar 12,12
Ar 13,13
Ar 14,14
Ar 15,15
Vm 8,8,22
Vm 9,9,22
Vm 10,10,22
Vm 11,11,22
Vm 12,12,22
Vm 13,13,22
Vm 14,14,22
Vm 15,15,22
Aw 8,8
Aw 9,9
Aw 10,10
Aw 11,11
Aw 12,12
Aw 13,13
Aw 14,14
Aw 15,15
Ar 8,16
Ar 9,17
Ar 10,18
Ar 11,19
Ar 12,20
Ar 13,21
Ar 14,22
Ar 15,23
Vm 8,8,22
Vm 9,9,22
Vm 10,10,22
Vm 11,11,22
Vm 12,12,22
Vm 13,13,22
Vm 14,14,22
Vm 15,15,22
Aw 16,8
Aw 17,9
Aw 18,10
Aw 19,11
Aw 20,12
Aw 21,13
Aw 22,14
Aw 23,15
Ar 8,24
Ar 9,25
Ar 10,26
Ar 11,27
Ar 12,28
Ar 13,29
Ar 14,30
Ar 15,31
Vm 8,8,22
Vm 9,9,22
Vm 10,10,22
Vm 11,11,22
Vm 12,12,22
Vm 13,13,22
Vm 14,14,22
Vm 15,15,22
Aw 24,8
Aw 25,9
Aw 26,10
Aw 27,11
Aw 28,12
Aw 29,13
Aw 30,14
Aw 31,15
v_max3_f32 v21, v208, v209, v210
v_max3_f32 v21, v21, v211, v212
v_max3_f32 v21, v21, v213, v214
v_max3_f32 v21, v21, v215, v216
v_max3_f32 v21, v21, v217, v218
v_max3_f32 v21, v21, v219, v220
v_max3_f32 v21, v21, v221, v222
v_max_f32 v21, v21, v223
v_mov_b32 v1, v21
s_nop 1
v_permlane16_swap_b32 v1, v21
v_max_f32 v21, v21, v1
v_mov_b32 v1, v21
s_nop 1
v_permlane32_swap_b32 v1, v21
v_max_f32 v21, v21, v1
v_add_f32 v21, 0x40e00000, v21
v_max_f32 v21, 0, v21
Vs 208,208,21
Vs 209,209,21
Vs 210,210,21
Vs 211,211,21
Vs 212,212,21
Vs 213,213,21
Vs 214,214,21
Vs 215,215,21
Vs 216,216,21
Vs 217,217,21
Vs 218,218,21
Vs 219,219,21
Vs 220,220,21
Vs 221,221,21
Vs 222,222,21
Vs 223,223,21
Vs 144,144,21
Vs 145,145,21
Vs 146,146,21
Vs 147,147,21
Vs 148,148,21
Vs 149,149,21
Vs 150,150,21
Vs 151,151,21
Vs 152,152,21
Vs 153,153,21
Vs 154,154,21
Vs 155,155,21
Vs 156,156,21
Vs 157,157,21
Vs 158,158,21
Vs 159,159,21
Vs 36,36,21
Vs 37,37,21
Vs 38,38,21
Vs 39,39,21
v_exp_f32 v22, -v21
s_nop 0
Vm 52,52,22
Vm 53,53,22
Vm 54,54,22
Vm 55,55,22
Ar 8,32
Ar 9,33
Ar 10,34
Ar 11,35
Ar 12,36
Ar 13,37
Ar 14,38
Ar 15,39
Vm 8,8,22
Vm 9,9,22
Vm 10,10,22
Vm 11,11,22
Vm 12,12,22
Vm 13,13,22
Vm 14,14,22
Vm 15,15,22
Aw 32,8
Aw 33,9
Aw 34,10
Aw 35,11
Aw 36,12
Aw 37,13
Aw 38,14
Aw 39,15
Ar 8,40
Ar 9,41
Ar 10,42
Ar 11,43
Ar 12,44
Ar 13,45
Ar 14,46
Ar 15,47
Vm 8,8,22
Vm 9,9,22
Vm 10,10,22
Vm 11,11,22
Vm 12,12,22
Vm 13,13,22
Vm 14,14,22
Vm 15,15,22
Aw 40,8
Aw 41,9
Aw 42,10
Aw 43,11
Aw 44,12
Aw 45,13
Aw 46,14
Aw 47,15
Ar 8,48
Ar 9,49
Ar 10,50
Ar 11,51
Ar 12,52
Ar 13,53
Ar 14,54
Ar 15,55
Vm 8,8,22
Vm 9,9,22
Vm 10,10,22
Vm 11,11,22
Vm 12,12,22
Vm 13,13,22
Vm 14,14,22
Vm 15,15,22
Aw 48,8
Aw 49,9
Aw 50,10
Aw 51,11
Aw 52,12
Aw 53,13
Aw 54,14
Aw 55,15
Ar 8,56
Ar 9,57
Ar 10,58
Ar 11,59
Ar 12,60
Ar 13,61
Ar 14,62
Ar 15,63
Vm 8,8,22
Vm 9,9,22
Vm 10,10,22
Vm 11,11,22
Vm 12,12,22
Vm 13,13,22
Vm 14,14,22
Vm 15,15,22
Aw 56,8
Aw 57,9
Aw 58,10
Aw 59,11
Aw 60,12
Aw 61,13
Aw 62,14
Aw 63,15
Ve 8,192
Ve 9,193
s_nop 0
Vc 96,8,9
Ve 8,194
Ve 9,195
s_nop 0
Vc 97,8,9
Ve 8,208
Ve 9,209
s_nop 0
Vc 104,8,9
Ve 8,210
Ve 9,211
s_nop 0
Vc 105,8,9
Ve 8,196
Ve 9,197
s_nop 0
Vc 98,8,9
Ve 8,198
Ve 9,199
s_nop 0
Vc 99,8,9
Ve 8,212
Ve 9,213
s_nop 0
Vc 106,8,9
Ve 8,214
Ve 9,215
s_nop 0
Vc 107,8,9
Ve 8,200
Ve 9,201
s_nop 0
Vc 100,8,9
Ve 8,202
Ve 9,203
s_nop 0
Vc 101,8,9
Ve 8,216
Ve 9,217
s_nop 0
Vc 108,8,9
Ve 8,218
Ve 9,219
s_nop 0
Vc 109,8,9
Ve 8,204
Ve 9,205
s_nop 0
Vc 102,8,9
Ve 8,206
Ve 9,207
s_nop 0
Vc 103,8,9
Ve 8,220
Ve 9,221
s_nop 0
Vc 110,8,9
Ve 8,222
Ve 9,223
s_nop 0
Vc 111,8,9
s_nop 1
s_branch L_k2_fbr_no
L_k2_mk_no:
s_nop 7
s_add_u32 s3, s37, 1
s_lshl_b32 s3, s3, 6
v_subrev_u32 v1, s3, v5
v_cmp_gt_i32 s[56:57], -16, v1
v_cmp_gt_i32 s[58:59], -15, v1
v_cmp_gt_i32 s[60:61], -14, v1
v_cmp_gt_i32 s[62:63], -13, v1
v_cndmask_b32 v144, v144, v20, s[56:57]
v_cndmask_b32 v145, v145, v20, s[58:59]
v_cndmask_b32 v146, v146, v20, s[60:61]
v_cndmask_b32 v147, v147, v20, s[62:63]
v_cmp_gt_i32 s[56:57], 0, v1
v_cmp_gt_i32 s[58:59], 1, v1
v_cmp_gt_i32 s[60:61], 2, v1
v_cmp_gt_i32 s[62:63], 3, v1
v_cndmask_b32 v128, v128, v20, s[56:57]
v_cndmask_b32 v129, v129, v20, s[58:59]
v_cndmask_b32 v130, v130, v20, s[60:61]
v_cndmask_b32 v131, v131, v20, s[62:63]
v_cndmask_b32 v148, v148, v20, s[56:57]
v_cndmask_b32 v149, v149, v20, s[58:59]
v_cndmask_b32 v150, v150, v20, s[60:61]
v_cndmask_b32 v151, v151, v20, s[62:63]
v_cmp_gt_i32 s[56:57], 16, v1
v_cmp_gt_i32 s[58:59], 17, v1
v_cmp_gt_i32 s[60:61], 18, v1
v_cmp_gt_i32 s[62:63], 19, v1
v_cndmask_b32 v132, v132, v20, s[56:57]
v_cndmask_b32 v133, v133, v20, s[58:59]
v_cndmask_b32 v134, v134, v20, s[60:61]
v_cndmask_b32 v135, v135, v20, s[62:63]
v_cndmask_b32 v152, v152, v20, s[56:57]
v_cndmask_b32 v153, v153, v20, s[58:59]
v_cndmask_b32 v154, v154, v20, s[60:61]
v_cndmask_b32 v155, v155, v20, s[62:63]
v_cmp_gt_i32 s[56:57], 32, v1
v_cmp_gt_i32 s[58:59], 33, v1
v_cmp_gt_i32 s[60:61], 34, v1
v_cmp_gt_i32 s[62:63], 35, v1
v_cndmask_b32 v136, v136, v20, s[56:57]
v_cndmask_b32 v137, v137, v20, s[58:59]
v_cndmask_b32 v138, v138, v20, s[60:61]
v_cndmask_b32 v139, v139, v20, s[62:63]
v_cndmask_b32 v156, v156, v20, s[56:57]
v_cndmask_b32 v157, v157, v20, s[58:59]
v_cndmask_b32 v158, v158, v20, s[60:61]
v_cndmask_b32 v159, v159, v20, s[62:63]
v_cmp_gt_i32 s[56:57], 48, v1
v_cmp_gt_i32 s[58:59], 49, v1
v_cmp_gt_i32 s[60:61], 50, v1
v_cmp_gt_i32 s[62:63], 51, v1
v_cndmask_b32 v140, v140, v20, s[56:57]
v_cndmask_b32 v141, v141, v20, s[58:59]
v_cndmask_b32 v142, v142, v20, s[60:61]
v_cndmask_b32 v143, v143, v20, s[62:63]
s_nop 1
s_branch L_k2_mkr_no
L_k2_fb_fi:
s_nop 7
v_max3_f32 v21, v192, v193, v194
v_max3_f32 v21, v21, v195, v196
v_max3_f32 v21, v21, v197, v198
v_max3_f32 v21, v21, v199, v200
v_max3_f32 v21, v21, v201, v202
v_max3_f32 v21, v21, v203, v204
v_max3_f32 v21, v21, v205, v206
v_max_f32 v21, v21, v207
v_mov_b32 v1, v21
s_nop 1
v_permlane16_swap_b32 v1, v21
v_max_f32 v21, v21, v1
v_mov_b32 v1, v21
s_nop 1
v_permlane32_swap_b32 v1, v21
v_max_f32 v21, v21, v1
v_add_f32 v21, 0x40e00000, v21
v_max_f32 v21, 0, v21
Vs 192,192,21
Vs 193,193,21
Vs 194,194,21
Vs 195,195,21
Vs 196,196,21
Vs 197,197,21
Vs 198,198,21
Vs 199,199,21
Vs 200,200,21
Vs 201,201,21
Vs 202,202,21
Vs 203,203,21
Vs 204,204,21
Vs 205,205,21
Vs 206,206,21
Vs 207,207,21
Vs 32,32,21
Vs 33,33,21
Vs 34,34,21
Vs 35,35,21
v_exp_f32 v22, -v21
s_nop 0
Vm 48,48,22
Vm 49,49,22
Vm 50,50,22
Vm 51,51,22
Ar 8,0
Ar 9,1
Ar 10,2
Ar 11,3
Ar 12,4
Ar 13,5
Ar 14,6
Ar 15,7
Vm 8,8,22
Vm 9,9,22
Vm 10,10,22
Vm 11,11,22
Vm 12,12,22
Vm 13,13,22
Vm 14,14,22
Vm 15,15,22
Aw 0,8
Aw 1,9
Aw 2,10
Aw 3,11
Aw 4,12
Aw 5,13
Aw 6,14
Aw 7,15
Ar 8,8
Ar 9,9
Ar 10,10
Ar 11,11
Ar 12,12
Ar 13,13
Ar 14,14
Ar 15,15
Vm 8,8,22
Vm 9,9,22
Vm 10,10,22
Vm 11,11,22
Vm 12,12,22
Vm 13,13,22
Vm 14,14,22
Vm 15,15,22
Aw 8,8
Aw 9,9
Aw 10,10
Aw 11,11
Aw 12,12
Aw 13,13
Aw 14,14
Aw 15,15
Ar 8,16
Ar 9,17
Ar 10,18
Ar 11,19
Ar 12,20
Ar 13,21
Ar 14,22
Ar 15,23
Vm 8,8,22
Vm 9,9,22
Vm 10,10,22
Vm 11,11,22
Vm 12,12,22
Vm 13,13,22
Vm 14,14,22
Vm 15,15,22
Aw 16,8
Aw 17,9
Aw 18,10
Aw 19,11
Aw 20,12
Aw 21,13
Aw 22,14
Aw 23,15
Ar 8,24
Ar 9,25
Ar 10,26
Ar 11,27
Ar 12,28
Ar 13,29
Ar 14,30
Ar 15,31
Vm 8,8,22
Vm 9,9,22
Vm 10,10,22
Vm 11,11,22
Vm 12,12,22
Vm 13,13,22
Vm 14,14,22
Vm 15,15,22
Aw 24,8
Aw 25,9
Aw 26,10
Aw 27,11
Aw 28,12
Aw 29,13
Aw 30,14
Aw 31,15
v_max3_f32 v21, v208, v209, v210
v_max3_f32 v21, v21, v211, v212
v_max3_f32 v21, v21, v213, v214
v_max3_f32 v21, v21, v215, v216
v_max3_f32 v21, v21, v217, v218
v_max3_f32 v21, v21, v219, v220
v_max3_f32 v21, v21, v221, v222
v_max_f32 v21, v21, v223
v_mov_b32 v1, v21
s_nop 1
v_permlane16_swap_b32 v1, v21
v_max_f32 v21, v21, v1
v_mov_b32 v1, v21
s_nop 1
v_permlane32_swap_b32 v1, v21
v_max_f32 v21, v21, v1
v_add_f32 v21, 0x40e00000, v21
v_max_f32 v21, 0, v21
Vs 208,208,21
Vs 209,209,21
Vs 210,210,21
Vs 211,211,21
Vs 212,212,21
Vs 213,213,21
Vs 214,214,21
Vs 215,215,21
Vs 216,216,21
Vs 217,217,21
Vs 218,218,21
Vs 219,219,21
Vs 220,220,21
Vs 221,221,21
Vs 222,222,21
Vs 223,223,21
Vs 36,36,21
Vs 37,37,21
Vs 38,38,21
Vs 39,39,21
v_exp_f32 v22, -v21
s_nop 0
Vm 52,52,22
Vm 53,53,22
Vm 54,54,22
Vm 55,55,22
Ar 8,32
Ar 9,33
Ar 10,34
Ar 11,35
Ar 12,36
Ar 13,37
Ar 14,38
Ar 15,39
Vm 8,8,22
Vm 9,9,22
Vm 10,10,22
Vm 11,11,22
Vm 12,12,22
Vm 13,13,22
Vm 14,14,22
Vm 15,15,22
Aw 32,8
Aw 33,9
Aw 34,10
Aw 35,11
Aw 36,12
Aw 37,13
Aw 38,14
Aw 39,15
Ar 8,40
Ar 9,41
Ar 10,42
Ar 11,43
Ar 12,44
Ar 13,45
Ar 14,46
Ar 15,47
Vm 8,8,22
Vm 9,9,22
Vm 10,10,22
Vm 11,11,22
Vm 12,12,22
Vm 13,13,22
Vm 14,14,22
Vm 15,15,22
Aw 40,8
Aw 41,9
Aw 42,10
Aw 43,11
Aw 44,12
Aw 45,13
Aw 46,14
Aw 47,15
Ar 8,48
Ar 9,49
Ar 10,50
Ar 11,51
Ar 12,52
Ar 13,53
Ar 14,54
Ar 15,55
Vm 8,8,22
Vm 9,9,22
Vm 10,10,22
Vm 11,11,22
Vm 12,12,22
Vm 13,13,22
Vm 14,14,22
Vm 15,15,22
Aw 48,8
Aw 49,9
Aw 50,10
Aw 51,11
Aw 52,12
Aw 53,13
Aw 54,14
Aw 55,15
Ar 8,56
Ar 9,57
Ar 10,58
Ar 11,59
Ar 12,60
Ar 13,61
Ar 14,62
Ar 15,63
Vm 8,8,22
Vm 9,9,22
Vm 10,10,22
Vm 11,11,22
Vm 12,12,22
Vm 13,13,22
Vm 14,14,22
Vm 15,15,22
Aw 56,8
Aw 57,9
Aw 58,10
Aw 59,11
Aw 60,12
Aw 61,13
Aw 62,14
Aw 63,15
Ve 8,192
Ve 9,193
s_nop 0
Vc 96,8,9
Ve 8,194
Ve 9,195
s_nop 0
Vc 97,8,9
Ve 8,208
Ve 9,209
s_nop 0
Vc 104,8,9
Ve 8,210
Ve 9,211
s_nop 0
Vc 105,8,9
Ve 8,196
Ve 9,197
s_nop 0
Vc 98,8,9
Ve 8,198
Ve 9,199
s_nop 0
Vc 99,8,9
Ve 8,212
Ve 9,213
s_nop 0
Vc 106,8,9
Ve 8,214
Ve 9,215
s_nop 0
Vc 107,8,9
Ve 8,200
Ve 9,201
s_nop 0
Vc 100,8,9
Ve 8,202
Ve 9,203
s_nop 0
Vc 101,8,9
Ve 8,216
Ve 9,217
s_nop 0
Vc 108,8,9
Ve 8,218
Ve 9,219
s_nop 0
Vc 109,8,9
Ve 8,204
Ve 9,205
s_nop 0
Vc 102,8,9
Ve 8,206
Ve 9,207
s_nop 0
Vc 103,8,9
Ve 8,220
Ve 9,221
s_nop 0
Vc 110,8,9
Ve 8,222
Ve 9,223
s_nop 0
Vc 111,8,9
s_nop 1
s_branch L_k2_fbr_fi
.globl oproj_kernel
.p2align 8
.type oproj_kernel,@function
oproj_kernel:
s_cmp_ge_u32 s2, 256
s_cbranch_scc1 L_k3_end
s_load_dwordx2 s[4:5], s[0:1], 40
s_load_dwordx2 s[40:41], s[0:1], 0
s_load_dwordx4 s[44:47], s[0:1], 80
s_load_dwordx4 s[56:59], s[0:1], 96
v_lshrrev_b32 v1, 6, v0
v_lshrrev_b32 v10, 3, v0
v_and_b32 v0, 63, v0
v_readfirstlane_b32 s32, v1
s_bfe_u32 s33, s2, 0x20001
s_lshl_b32 s33, s33, 2
s_bfe_u32 s3, s2, 0x20003
s_add_u32 s33, s33, s3
s_and_b32 s34, s2, 1
s_lshl_b32 s34, s34, 3
s_lshr_b32 s3, s2, 5
s_add_u32 s34, s34, s3
s_mov_b32 s48, 0
s_mov_b32 s49, 15360
s_mov_b32 s50, 30720
s_mov_b32 s51, 46080
s_lshl_b32 s35, s32, 15
v_lshlrev_b32 v2, 4, v0
v_add_u32 v3, 4096, v2
v_lshrrev_b32 v12, 4, v0
v_and_b32 v13, 7, v0
v_lshrrev_b32 v14, 3, v0
v_lshlrev_b32 v1, 1, v12
v_xor_b32 v1, v1, v13
v_lshlrev_b32 v1, 4, v1
v_lshl_add_u32 v4, v14, 11, v1
v_lshrrev_b32 v1, 2, v0
v_bfe_u32 v11, v0, 3, 2
v_lshlrev_b32 v1, 7, v1
v_and_b32 v15, 3, v0
v_lshl_add_u32 v1, v15, 3, v1
v_add_u32 v1, s35, v1
v_xor_b32 v15, 0, v11
v_lshl_add_u32 v5, v15, 5, v1
v_xor_b32 v15, 1, v11
v_lshl_add_u32 v6, v15, 5, v1
v_xor_b32 v15, 2, v11
v_lshl_add_u32 v7, v15, 5, v1
v_xor_b32 v15, 3, v11
v_lshl_add_u32 v8, v15, 5, v1
v_lshlrev_b32 v9, 11, v10
v_lshl_add_u32 v9, v13, 4, v9
s_lshr_b32 s3, s2, 5
s_mul_i32 s3, s3, 4096
v_lshlrev_b32 v120, 7, v0
v_add_u32 v120, s3, v120
s_bfe_u32 s3, s2, 0x20003
s_mul_i32 s3, s3, 65536
v_lshlrev_b32 v121, 11, v0
v_add_u32 v121, s3, v121
v_cmp_gt_u32 vcc, 32, v0
v_mov_b32 v1, 0x7ff00000
s_nop 0
v_cndmask_b32 v120, v1, v120, vcc
v_cndmask_b32 v121, v1, v121, vcc
s_waitcnt lgkmcnt(0)
s_lshl_b32 s3, s33, 20
s_lshl_b32 s62, s32, 18
s_add_u32 s3, s3, s62
s_add_u32 s3, s3, 46137344
s_add_u32 s8, s58, s3
s_addc_u32 s9, s59, 0
s_and_b32 s9, s9, 0xffff
s_mov_b32 s10, 262144
s_mov_b32 s11, 0x20000
s_lshl_b32 s62, s34, 7
s_lshl_b32 s3, s32, 21
s_add_u32 s3, s3, s62
s_add_u32 s12, s4, s3
s_addc_u32 s13, s5, 0
s_and_b32 s13, s13, 0xffff
s_mov_b32 s14, 0
s_mov_b32 s15, 0x20000
s_sub_u32 s14, 2097152, s62
s_bfe_u32 s3, s2, 0x20003
s_mul_i32 s3, s3, 2
s_lshr_b32 s62, s2, 5
s_mul_i32 s62, s62, 1
s_add_u32 s5, s3, s62
v_mov_b32 v123, v4
s_add_u32 s4, s5, 0
s_and_b32 s4, s4, 7
s_or_b32 s4, s4, 0
s_lshl_b32 s4, s4, 16
s_add_u32 s63, s5, 0
s_and_b32 s63, s63, 7
s_or_b32 s63, s63, 0
s_lshl_b32 s63, s63, 13
v_add_u32 v4, s4, v123
s_add_u32 m0, s35, 0
s_nop 0
buffer_load_dwordx4 v4, s[12:15], s48 offen offset:0 lds
buffer_load_dwordx4 v4, s[12:15], s49 offen offset:1024 lds
buffer_load_dwordx4 v4, s[12:15], s50 offen offset:2048 lds
buffer_load_dwordx4 v4, s[12:15], s51 offen offset:3072 lds
s_add_u32 s4, s5, 1
s_and_b32 s4, s4, 7
s_or_b32 s4, s4, 0
s_lshl_b32 s4, s4, 16
v_add_u32 v4, s4, v123
s_add_u32 m0, s35, 4096
s_nop 0
buffer_load_dwordx4 v4, s[12:15], s48 offen offset:0 lds
buffer_load_dwordx4 v4, s[12:15], s49 offen offset:1024 lds
buffer_load_dwordx4 v4, s[12:15], s50 offen offset:2048 lds
buffer_load_dwordx4 v4, s[12:15], s51 offen offset:3072 lds
s_add_u32 s4, s5, 2
s_and_b32 s4, s4, 7
s_or_b32 s4, s4, 0
s_lshl_b32 s4, s4, 16
v_add_u32 v4, s4, v123
buffer_load_dwordx4 a[0:3], v2, s[8:11], s63 offen offset:0
buffer_load_dwordx4 a[4:7], v2, s[8:11], s63 offen offset:1024
buffer_load_dwordx4 a[8:11], v2, s[8:11], s63 offen offset:2048
buffer_load_dwordx4 a[12:15], v2, s[8:11], s63 offen offset:3072
buffer_load_dwordx4 a[16:19], v3, s[8:11], s63 offen offset:0
buffer_load_dwordx4 a[20:23], v3, s[8:11], s63 offen offset:1024
buffer_load_dwordx4 a[24:27], v3, s[8:11], s63 offen offset:2048
buffer_load_dwordx4 a[28:31], v3, s[8:11], s63 offen offset:3072
s_add_u32 s63, s5, 1
s_and_b32 s63, s63, 7
s_or_b32 s63, s63, 0
s_lshl_b32 s63, s63, 13
s_add_u32 m0, s35, 8192
s_nop 0
buffer_load_dwordx4 v4, s[12:15], s48 offen offset:0 lds
buffer_load_dwordx4 v4, s[12:15], s49 offen offset:1024 lds
buffer_load_dwordx4 v4, s[12:15], s50 offen offset:2048 lds
buffer_load_dwordx4 v4, s[12:15], s51 offen offset:3072 lds
s_add_u32 s4, s5, 3
s_and_b32 s4, s4, 7
s_or_b32 s4, s4, 0
s_lshl_b32 s4, s4, 16
v_add_u32 v4, s4, v123
buffer_load_dwordx4 a[32:35], v2, s[8:11], s63 offen offset:0
buffer_load_dwordx4 a[36:39], v2, s[8:11], s63 offen offset:1024
buffer_load_dwordx4 a[40:43], v2, s[8:11], s63 offen offset:2048
buffer_load_dwordx4 a[44:47], v2, s[8:11], s63 offen offset:3072
buffer_load_dwordx4 a[48:51], v3, s[8:11], s63 offen offset:0
buffer_load_dwordx4 a[52:55], v3, s[8:11], s63 offen offset:1024
buffer_load_dwordx4 a[56:59], v3, s[8:11], s63 offen offset:2048
buffer_load_dwordx4 a[60:63], v3, s[8:11], s63 offen offset:3072
s_add_u32 s63, s5, 2
s_and_b32 s63, s63, 7
s_or_b32 s63, s63, 0
s_lshl_b32 s63, s63, 13
s_add_u32 m0, s35, 12288
s_nop 0
buffer_load_dwordx4 v4, s[12:15], s48 offen offset:0 lds
buffer_load_dwordx4 v4, s[12:15], s49 offen offset:1024 lds
buffer_load_dwordx4 v4, s[12:15], s50 offen offset:2048 lds
buffer_load_dwordx4 v4, s[12:15], s51 offen offset:3072 lds
s_add_u32 s4, s5, 4
s_and_b32 s4, s4, 7
s_or_b32 s4, s4, 0
s_lshl_b32 s4, s4, 16
v_add_u32 v4, s4, v123
buffer_load_dwordx4 a[64:67], v2, s[8:11], s63 offen offset:0
buffer_load_dwordx4 a[68:71], v2, s[8:11], s63 offen offset:1024
buffer_load_dwordx4 a[72:75], v2, s[8:11], s63 offen offset:2048
buffer_load_dwordx4 a[76:79], v2, s[8:11], s63 offen offset:3072
buffer_load_dwordx4 a[80:83], v3, s[8:11], s63 offen offset:0
buffer_load_dwordx4 a[84:87], v3, s[8:11], s63 offen offset:1024
buffer_load_dwordx4 a[88:91], v3, s[8:11], s63 offen offset:2048
buffer_load_dwordx4 a[92:95], v3, s[8:11], s63 offen offset:3072
s_add_u32 s63, s5, 3
s_and_b32 s63, s63, 7
s_or_b32 s63, s63, 0
s_lshl_b32 s63, s63, 13
s_add_u32 s60, s58, 5292032
s_addc_u32 s61, s59, 0
s_load_dwordx4 s[52:55], s[60:61], 0
s_mov_b32 s16, s58
s_and_b32 s17, s59, 0xffff
s_mov_b32 s18, 8388608
s_mov_b32 s19, 0x20000
s_mov_b32 s24, s44
s_and_b32 s25, s45, 0xffff
s_mov_b32 s26, 7340032
s_mov_b32 s27, 0x20000
s_lshl_b32 s36, s33, 18
s_lshl_b32 s3, s34, 7
s_add_u32 s36, s36, s3
s_mov_b32 s20, s40
s_and_b32 s21, s41, 0xffff
s_mov_b32 s22, 4194304
s_mov_b32 s23, 0x20000
s_mov_b32 s28, s46
s_and_b32 s29, s47, 0xffff
s_mov_b32 s30, 4194304
s_mov_b32 s31, 0x20000
s_mov_b32 s40, s56
s_and_b32 s41, s57, 0xffff
s_mov_b32 s42, 256
s_mov_b32 s43, 0x20000
s_lshr_b32 s37, s2, 4
s_lshl_b32 s3, s37, 2
s_add_u32 s3, s3, s32
s_mul_i32 s38, s3, 56
s_and_b32 s39, s2, 15
s_waitcnt vmcnt(36)
Ta 128,5,0
Ta 130,5,2048
Ta 132,6,0
Ta 134,6,2048
Ta 136,7,0
Ta 138,7,2048
Ta 140,8,0
Ta 142,8,2048
s_waitcnt vmcnt(24) lgkmcnt(0)
Zvaa 128,128,0
s_add_u32 m0, s35, 0
Zvaa 132,132,0
buffer_load_dwordx4 v4, s[12:15], s48 offen offset:0 lds
Zvaa 136,136,0
Ta 144,5,4096
Ta 146,5,6144
Zvaa 140,140,0
buffer_load_dwordx4 v4, s[12:15], s49 offen offset:1024 lds
Zvaa 144,128,4
s_lshl_b32 s3, s38, 2
s_add_u32 s3, s3, 6291456
v_mul_u32_u24 v1, 14336, v12
v_and_b32 v15, 15, v0
Zvaa 148,132,4
v_lshl_add_u32 v1, v15, 4, v1
Zvaa 152,136,4
buffer_load_dwordx4 v4, s[12:15], s50 offen offset:2048 lds
Zvaa 156,140,4
Ta 148,6,4096
Ta 150,6,6144
Zvaa 160,128,8
buffer_load_dwordx4 v4, s[12:15], s51 offen offset:3072 lds
Zvaa 164,132,8
s_add_u32 s4, s5, 5
s_and_b32 s4, s4, 7
s_or_b32 s4, s4, 0
s_lshl_b32 s4, s4, 16
v_add_u32 v4, s4, v123
Zvaa 168,136,8
buffer_load_dwordx4 v[40:43], v1, s[16:19], s3 offen
Zvaa 172,140,8
buffer_load_dwordx4 a[96:99], v2, s[8:11], s63 offen offset:0
Zvaa 176,128,12
Ta 152,7,4096
Ta 154,7,6144
Zvaa 180,132,12
buffer_load_dwordx4 a[100:103], v2, s[8:11], s63 offen offset:1024
Zvaa 184,136,12
s_add_u32 s3, s3, 57344
Zvaa 188,140,12
buffer_load_dwordx4 v[44:47], v1, s[16:19], s3 offen
Zvaa 192,128,16
buffer_load_dwordx4 a[104:107], v2, s[8:11], s63 offen offset:2048
Zvaa 196,132,16
Ta 156,8,4096
Ta 158,8,6144
Zvaa 200,136,16
buffer_load_dwordx4 a[108:111], v2, s[8:11], s63 offen offset:3072
Zvaa 204,140,16
s_add_u32 s3, s3, 57344
Zvaa 208,128,20
buffer_load_dwordx4 v[48:51], v1, s[16:19], s3 offen
Zvaa 212,132,20
buffer_load_dwordx4 a[112:115], v3, s[8:11], s63 offen offset:0
Zvaa 216,136,20
s_add_u32 s3, s3, 57344
Zvaa 220,140,20
buffer_load_dwordx4 a[116:119], v3, s[8:11], s63 offen offset:1024
Zvaa 224,128,24
buffer_load_dwordx4 v[52:55], v1, s[16:19], s3 offen
Zvaa 228,132,24
s_add_u32 s3, s3, 57344
Zvaa 232,136,24
buffer_load_dwordx4 a[120:123], v3, s[8:11], s63 offen offset:2048
Zvaa 236,140,24
buffer_load_dwordx4 v[56:59], v1, s[16:19], s3 offen
Zvaa 240,128,28
buffer_load_dwordx4 a[124:127], v3, s[8:11], s63 offen offset:3072
Zvaa 244,132,28
s_add_u32 s63, s5, 4
s_and_b32 s63, s63, 7
s_or_b32 s63, s63, 0
s_lshl_b32 s63, s63, 13
Zvaa 248,136,28
s_add_u32 s3, s3, 57344
Zvaa 252,140,28
buffer_load_dwordx4 v[60:63], v1, s[16:19], s3 offen
s_waitcnt vmcnt(30) lgkmcnt(0)
Mvaa 128,144,32
s_add_u32 m0, s35, 4096
Mvaa 132,148,32
buffer_load_dwordx4 v4, s[12:15], s48 offen offset:0 lds
Mvaa 136,152,32
Ta 128,5,8192
Ta 130,5,10240
Mvaa 140,156,32
buffer_load_dwordx4 v4, s[12:15], s49 offen offset:1024 lds
Mvaa 144,144,36
s_add_u32 s3, s3, 57344
Mvaa 148,148,36
buffer_load_dwordx4 v[64:67], v1, s[16:19], s3 offen
Mvaa 152,152,36
buffer_load_dwordx4 v4, s[12:15], s50 offen offset:2048 lds
Mvaa 156,156,36
Ta 132,6,8192
Ta 134,6,10240
Mvaa 160,144,40
buffer_load_dwordx4 v4, s[12:15], s51 offen offset:3072 lds
Mvaa 164,148,40
s_add_u32 s4, s5, 6
s_and_b32 s4, s4, 7
s_or_b32 s4, s4, 0
s_lshl_b32 s4, s4, 16
v_add_u32 v4, s4, v123
Mvaa 168,152,40
s_add_u32 s3, s3, 57344
Mvaa 172,156,40
buffer_load_dwordx4 a[0:3], v2, s[8:11], s63 offen offset:0
Mvaa 176,144,44
Ta 136,7,8192
Ta 138,7,10240
Mvaa 180,148,44
buffer_load_dwordx4 a[4:7], v2, s[8:11], s63 offen offset:1024
Mvaa 184,152,44
buffer_load_dwordx4 v[68:71], v1, s[16:19], s3 offen
Mvaa 188,156,44
s_lshl_b32 s3, s38, 11
s_lshl_b32 s62, s39, 7
s_add_u32 s3, s3, s62
v_mul_u32_u24 v1, 14336, v14
Mvaa 192,144,48
buffer_load_dwordx4 a[8:11], v2, s[8:11], s63 offen offset:2048
Mvaa 196,148,48
Ta 140,8,8192
Ta 142,8,10240
Mvaa 200,152,48
buffer_load_dwordx4 a[12:15], v2, s[8:11], s63 offen offset:3072
Mvaa 204,156,48
v_lshl_add_u32 v1, v13, 4, v1
Mvaa 208,144,52
buffer_load_dwordx4 v[72:75], v1, s[24:27], s3 offen offset:0
Mvaa 212,148,52
buffer_load_dwordx4 a[16:19], v3, s[8:11], s63 offen offset:0
Mvaa 216,152,52
buffer_load_dwordx4 v[76:79], v1, s[24:27], s3 offen offset:2048
Mvaa 220,156,52
buffer_load_dwordx4 a[20:23], v3, s[8:11], s63 offen offset:1024
Mvaa 224,144,56
s_add_u32 s3, s3, 4096
Mvaa 228,148,56
buffer_load_dwordx4 v[80:83], v1, s[24:27], s3 offen offset:0
Mvaa 232,152,56
buffer_load_dwordx4 a[24:27], v3, s[8:11], s63 offen offset:2048
Mvaa 236,156,56
buffer_load_dwordx4 v[84:87], v1, s[24:27], s3 offen offset:2048
Mvaa 240,144,60
buffer_load_dwordx4 a[28:31], v3, s[8:11], s63 offen offset:3072
Mvaa 244,148,60
s_add_u32 s63, s5, 5
s_and_b32 s63, s63, 7
s_or_b32 s63, s63, 0
s_lshl_b32 s63, s63, 13
Mvaa 248,152,60
s_add_u32 s3, s3, 4096
Mvaa 252,156,60
buffer_load_dwordx4 v[88:91], v1, s[24:27], s3 offen offset:0
s_waitcnt vmcnt(37) lgkmcnt(0)
Mvaa 128,128,64
s_add_u32 m0, s35, 8192
Mvaa 132,132,64
buffer_load_dwordx4 v4, s[12:15], s48 offen offset:0 lds
Mvaa 136,136,64
Ta 144,5,12288
Ta 146,5,14336
Mvaa 140,140,64
buffer_load_dwordx4 v4, s[12:15], s49 offen offset:1024 lds
Mvaa 144,128,68
buffer_load_dwordx4 v[92:95], v1, s[24:27], s3 offen offset:2048
Mvaa 148,132,68
s_add_u32 s3, s3, 4096
Mvaa 152,136,68
buffer_load_dwordx4 v4, s[12:15], s50 offen offset:2048 lds
Mvaa 156,140,68
Ta 148,6,12288
Ta 150,6,14336
Mvaa 160,128,72
buffer_load_dwordx4 v4, s[12:15], s51 offen offset:3072 lds
Mvaa 164,132,72
s_add_u32 s4, s5, 7
s_and_b32 s4, s4, 7
s_or_b32 s4, s4, 0
s_lshl_b32 s4, s4, 16
v_add_u32 v4, s4, v123
Mvaa 168,136,72
buffer_load_dwordx4 v[96:99], v1, s[24:27], s3 offen offset:0
Mvaa 172,140,72
buffer_load_dwordx4 a[32:35], v2, s[8:11], s63 offen offset:0
Mvaa 176,128,76
Ta 152,7,12288
Ta 154,7,14336
Mvaa 180,132,76
buffer_load_dwordx4 a[36:39], v2, s[8:11], s63 offen offset:1024
Mvaa 184,136,76
Mvaa 188,140,76
Mvaa 192,128,80
buffer_load_dwordx4 a[40:43], v2, s[8:11], s63 offen offset:2048
Mvaa 196,132,80
Ta 156,8,12288
Ta 158,8,14336
Mvaa 200,136,80
buffer_load_dwordx4 a[44:47], v2, s[8:11], s63 offen offset:3072
Mvaa 204,140,80
Mvaa 208,128,84
Mvaa 212,132,84
buffer_load_dwordx4 a[48:51], v3, s[8:11], s63 offen offset:0
Mvaa 216,136,84
Mvaa 220,140,84
buffer_load_dwordx4 a[52:55], v3, s[8:11], s63 offen offset:1024
Mvaa 224,128,88
Mvaa 228,132,88
Mvaa 232,136,88
buffer_load_dwordx4 a[56:59], v3, s[8:11], s63 offen offset:2048
Mvaa 236,140,88
Mvaa 240,128,92
buffer_load_dwordx4 a[60:63], v3, s[8:11], s63 offen offset:3072
Mvaa 244,132,92
s_add_u32 s63, s5, 6
s_and_b32 s63, s63, 7
s_or_b32 s63, s63, 0
s_lshl_b32 s63, s63, 13
Mvaa 248,136,92
Mvaa 252,140,92
s_waitcnt vmcnt(34) lgkmcnt(0)
Mvaa 128,144,96
s_add_u32 m0, s35, 12288
Mvaa 132,148,96
buffer_load_dwordx4 v4, s[12:15], s48 offen offset:0 lds
Mvaa 136,152,96
Ta 128,5,0
Ta 130,5,2048
Mvaa 140,156,96
buffer_load_dwordx4 v4, s[12:15], s49 offen offset:1024 lds
Mvaa 144,144,100
s_mov_b32 s3, s36
Mvaa 148,148,100
buffer_load_dwordx4 v[16:19], v9, s[20:23], s3 offen
Mvaa 152,152,100
buffer_load_dwordx4 v4, s[12:15], s50 offen offset:2048 lds
Mvaa 156,156,100
Ta 132,6,0
Ta 134,6,2048
Mvaa 160,144,104
buffer_load_dwordx4 v4, s[12:15], s51 offen offset:3072 lds
Mvaa 164,148,104
s_add_u32 s4, s5, 8
s_and_b32 s4, s4, 7
s_or_b32 s4, s4, 8
s_lshl_b32 s4, s4, 16
v_add_u32 v4, s4, v123
Mvaa 168,152,104
s_add_u32 s3, s3, 65536
Mvaa 172,156,104
buffer_load_dwordx4 a[64:67], v2, s[8:11], s63 offen offset:0
Mvaa 176,144,108
Ta 136,7,0
Ta 138,7,2048
Mvaa 180,148,108
buffer_load_dwordx4 a[68:71], v2, s[8:11], s63 offen offset:1024
Mvaa 184,152,108
buffer_load_dwordx4 v[20:23], v9, s[20:23], s3 offen
Mvaa 188,156,108
s_add_u32 s3, s3, 65536
Mvaa 192,144,112
buffer_load_dwordx4 a[72:75], v2, s[8:11], s63 offen offset:2048
Mvaa 196,148,112
Ta 140,8,0
Ta 142,8,2048
Mvaa 200,152,112
buffer_load_dwordx4 a[76:79], v2, s[8:11], s63 offen offset:3072
Mvaa 204,156,112
buffer_load_dwordx4 v[24:27], v9, s[20:23], s3 offen
Mvaa 208,144,116
s_add_u32 s3, s3, 65536
Mvaa 212,148,116
buffer_load_dwordx4 a[80:83], v3, s[8:11], s63 offen offset:0
Mvaa 216,152,116
buffer_load_dwordx4 v[28:31], v9, s[20:23], s3 offen
Mvaa 220,156,116
buffer_load_dwordx4 a[84:87], v3, s[8:11], s63 offen offset:1024
Mvaa 224,144,120
s_lshl_b32 s3, s33, 10
s_add_u32 s3, s3, 5259264
v_lshlrev_b32 v1, 3, v10
Mvaa 228,148,120
buffer_load_dwordx2 v[32:33], v1, s[16:19], s3 offen offset:0
Mvaa 232,152,120
buffer_load_dwordx4 a[88:91], v3, s[8:11], s63 offen offset:2048
Mvaa 236,156,120
buffer_load_dwordx2 v[34:35], v1, s[16:19], s3 offen offset:256
Mvaa 240,144,124
buffer_load_dwordx4 a[92:95], v3, s[8:11], s63 offen offset:3072
Mvaa 244,148,124
s_add_u32 s63, s5, 7
s_and_b32 s63, s63, 7
s_or_b32 s63, s63, 0
s_lshl_b32 s63, s63, 13
Mvaa 248,152,124
buffer_load_dwordx2 v[36:37], v1, s[16:19], s3 offen offset:512
Mvaa 252,156,124
buffer_load_dwordx2 v[38:39], v1, s[16:19], s3 offen offset:768
s_waitcnt vmcnt(35) lgkmcnt(0)
Mvaa 128,128,0
s_add_u32 m0, s35, 0
Mvaa 132,132,0
buffer_load_dwordx4 v4, s[12:15], s48 offen offset:0 lds
Mvaa 136,136,0
Ta 144,5,4096
Ta 146,5,6144
Mvaa 140,140,0
buffer_load_dwordx4 v4, s[12:15], s49 offen offset:1024 lds
Mvaa 144,128,4
Va 40,40,44
Va 41,41,45
Va 42,42,46
Mvaa 148,132,4
Va 43,43,47
Va 40,40,48
Va 41,41,49
Mvaa 152,136,4
buffer_load_dwordx4 v4, s[12:15], s50 offen offset:2048 lds
Mvaa 156,140,4
Ta 148,6,4096
Ta 150,6,6144
Mvaa 160,128,8
buffer_load_dwordx4 v4, s[12:15], s51 offen offset:3072 lds
Mvaa 164,132,8
s_add_u32 s4, s5, 9
s_and_b32 s4, s4, 7
s_or_b32 s4, s4, 8
s_lshl_b32 s4, s4, 16
v_add_u32 v4, s4, v123
Mvaa 168,136,8
Va 42,42,50
Va 43,43,51
Va 40,40,52
Mvaa 172,140,8
buffer_load_dwordx4 a[96:99], v2, s[8:11], s63 offen offset:0
Mvaa 176,128,12
Ta 152,7,4096
Ta 154,7,6144
Mvaa 180,132,12
buffer_load_dwordx4 a[100:103], v2, s[8:11], s63 offen offset:1024
Mvaa 184,136,12
Va 41,41,53
Va 42,42,54
Va 43,43,55
Mvaa 188,140,12
Va 40,40,56
Va 41,41,57
Va 42,42,58
Mvaa 192,128,16
buffer_load_dwordx4 a[104:107], v2, s[8:11], s63 offen offset:2048
Mvaa 196,132,16
Ta 156,8,4096
Ta 158,8,6144
Mvaa 200,136,16
buffer_load_dwordx4 a[108:111], v2, s[8:11], s63 offen offset:3072
Mvaa 204,140,16
Va 43,43,59
Va 40,40,60
Va 41,41,61
Mvaa 208,128,20
Va 42,42,62
Va 43,43,63
Va 40,40,64
Mvaa 212,132,20
buffer_load_dwordx4 a[112:115], v3, s[8:11], s63 offen offset:0
Mvaa 216,136,20
Va 41,41,65
Va 42,42,66
Va 43,43,67
Mvaa 220,140,20
buffer_load_dwordx4 a[116:119], v3, s[8:11], s63 offen offset:1024
Mvaa 224,128,24
Va 40,40,68
Va 41,41,69
Va 42,42,70
Mvaa 228,132,24
Va 43,43,71
Vc 1,40,41
v_lshlrev_b32 v40, 16, v1
Mvaa 232,136,24
buffer_load_dwordx4 a[120:123], v3, s[8:11], s63 offen offset:2048
Mvaa 236,140,24
v_and_b32 v41, 0xffff0000, v1
Vc 15,42,43
v_lshlrev_b32 v42, 16, v15
Mvaa 240,128,28
buffer_load_dwordx4 a[124:127], v3, s[8:11], s63 offen offset:3072
Mvaa 244,132,28
s_add_u32 s63, s5, 8
s_and_b32 s63, s63, 7
s_or_b32 s63, s63, 8
s_lshl_b32 s63, s63, 13
Mvaa 248,136,28
v_and_b32 v43, 0xffff0000, v15
v_mov_b32 v44, v40
v_mov_b32 v45, v41
Mvaa 252,140,28
v_mov_b32 v46, v42
v_mov_b32 v47, v43
v_permlane32_swap_b32 v44, v40
s_waitcnt vmcnt(32) lgkmcnt(0)
Mvaa 128,144,32
s_add_u32 m0, s35, 4096
Mvaa 132,148,32
buffer_load_dwordx4 v4, s[12:15], s48 offen offset:0 lds
Mvaa 136,152,32
Ta 128,5,8192
Ta 130,5,10240
Mvaa 140,156,32
buffer_load_dwordx4 v4, s[12:15], s49 offen offset:1024 lds
Mvaa 144,144,36
v_permlane32_swap_b32 v45, v41
v_permlane32_swap_b32 v46, v42
v_permlane32_swap_b32 v47, v43
Mvaa 148,148,36
v_mul_f32 v48, 0xbfb8aa3b, v44
v_mul_f32 v49, 0xbfb8aa3b, v45
v_mul_f32 v50, 0xbfb8aa3b, v46
Mvaa 152,152,36
buffer_load_dwordx4 v4, s[12:15], s50 offen offset:2048 lds
Mvaa 156,156,36
Ta 132,6,8192
Ta 134,6,10240
Mvaa 160,144,40
buffer_load_dwordx4 v4, s[12:15], s51 offen offset:3072 lds
Mvaa 164,148,40
s_add_u32 s4, s5, 10
s_and_b32 s4, s4, 7
s_or_b32 s4, s4, 8
s_lshl_b32 s4, s4, 16
v_add_u32 v4, s4, v123
Mvaa 168,152,40
v_mul_f32 v51, 0xbfb8aa3b, v47
Ve 48,48
Mvaa 172,156,40
buffer_load_dwordx4 a[0:3], v2, s[8:11], s63 offen offset:0
Mvaa 176,144,44
Ta 136,7,8192
Ta 138,7,10240
Mvaa 180,148,44
buffer_load_dwordx4 a[4:7], v2, s[8:11], s63 offen offset:1024
Mvaa 184,152,44
Ve 49,49
Mvaa 188,156,44
Ve 50,50
Mvaa 192,144,48
buffer_load_dwordx4 a[8:11], v2, s[8:11], s63 offen offset:2048
Mvaa 196,148,48
Ta 140,8,8192
Ta 142,8,10240
Mvaa 200,152,48
buffer_load_dwordx4 a[12:15], v2, s[8:11], s63 offen offset:3072
Mvaa 204,156,48
Ve 51,51
v_add_f32 v48, 1.0, v48
Mvaa 208,144,52
v_add_f32 v49, 1.0, v49
v_add_f32 v50, 1.0, v50
v_add_f32 v51, 1.0, v51
Mvaa 212,148,52
buffer_load_dwordx4 a[16:19], v3, s[8:11], s63 offen offset:0
Mvaa 216,152,52
v_rcp_f32 v48, v48
Mvaa 220,156,52
buffer_load_dwordx4 a[20:23], v3, s[8:11], s63 offen offset:1024
Mvaa 224,144,56
v_rcp_f32 v49, v49
Mvaa 228,148,56
v_rcp_f32 v50, v50
Mvaa 232,152,56
buffer_load_dwordx4 a[24:27], v3, s[8:11], s63 offen offset:2048
Mvaa 236,156,56
v_rcp_f32 v51, v51
Vm 44,44,48
Mvaa 240,144,60
buffer_load_dwordx4 a[28:31], v3, s[8:11], s63 offen offset:3072
Mvaa 244,148,60
s_add_u32 s63, s5, 9
s_and_b32 s63, s63, 7
s_or_b32 s63, s63, 8
s_lshl_b32 s63, s63, 13
Mvaa 248,152,60
Vm 45,45,49
Vm 46,46,50
Vm 47,47,51
Mvaa 252,156,60
Vc 1,44,45
v_lshlrev_b32 v44, 16, v1
v_and_b32 v45, 0xffff0000, v1
s_waitcnt vmcnt(26) lgkmcnt(0)
Mvaa 128,128,64
s_add_u32 m0, s35, 8192
Mvaa 132,132,64
buffer_load_dwordx4 v4, s[12:15], s48 offen offset:0 lds
Mvaa 136,136,64
Ta 144,5,12288
Ta 146,5,14336
Mvaa 140,140,64
buffer_load_dwordx4 v4, s[12:15], s49 offen offset:1024 lds
Mvaa 144,128,68
Vc 15,46,47
v_lshlrev_b32 v46, 16, v15
v_and_b32 v47, 0xffff0000, v15
Mvaa 148,132,68
Vm 40,40,44
Vm 41,41,45
Vm 42,42,46
Mvaa 152,136,68
buffer_load_dwordx4 v4, s[12:15], s50 offen offset:2048 lds
Mvaa 156,140,68
Ta 148,6,12288
Ta 150,6,14336
Mvaa 160,128,72
buffer_load_dwordx4 v4, s[12:15], s51 offen offset:3072 lds
Mvaa 164,132,72
s_add_u32 s4, s5, 11
s_and_b32 s4, s4, 7
s_or_b32 s4, s4, 8
s_lshl_b32 s4, s4, 16
v_add_u32 v4, s4, v123
Mvaa 168,136,72
Vm 43,43,47
Vc 1,40,41
v_lshlrev_b32 v40, 16, v1
Mvaa 172,140,72
buffer_load_dwordx4 a[32:35], v2, s[8:11], s63 offen offset:0
Mvaa 176,128,76
Ta 152,7,12288
Ta 154,7,14336
Mvaa 180,132,76
buffer_load_dwordx4 a[36:39], v2, s[8:11], s63 offen offset:1024
Mvaa 184,136,76
v_and_b32 v41, 0xffff0000, v1
Vc 15,42,43
v_lshlrev_b32 v42, 16, v15
Mvaa 188,140,76
v_and_b32 v43, 0xffff0000, v15
Mvaa 192,128,80
buffer_load_dwordx4 a[40:43], v2, s[8:11], s63 offen offset:2048
Mvaa 196,132,80
Ta 156,8,12288
Ta 158,8,14336
Mvaa 200,136,80
buffer_load_dwordx4 a[44:47], v2, s[8:11], s63 offen offset:3072
Mvaa 204,140,80
s_lshl_b32 s3, s32, 9
s_add_u32 s3, s3, 131072
v_and_b32 v1, 31, v0
v_lshl_add_u32 v1, v1, 4, s3
Mvaa 208,128,84
v_mul_u32_u24 v15, 28, v14
v_add_u32 v15, s3, v15
Mvaa 212,132,84
buffer_load_dwordx4 a[48:51], v3, s[8:11], s63 offen offset:0
Mvaa 216,136,84
ds_write_b128 v1, v[40:43]
ds_read_b32 v52, v15 offset:0
ds_read_b32 v53, v15 offset:4
Mvaa 220,140,84
buffer_load_dwordx4 a[52:55], v3, s[8:11], s63 offen offset:1024
Mvaa 224,128,88
ds_read_b32 v54, v15 offset:8
ds_read_b32 v55, v15 offset:12
ds_read_b32 v56, v15 offset:16
Mvaa 228,132,88
ds_read_b32 v57, v15 offset:20
Mvaa 232,136,88
buffer_load_dwordx4 a[56:59], v3, s[8:11], s63 offen offset:2048
Mvaa 236,140,88
s_waitcnt lgkmcnt(4)
ds_read_b32 v58, v15 offset:24
ds_read_b32 v59, v15 offset:256
ds_read_b32 v60, v15 offset:260
Mvaa 240,128,92
buffer_load_dwordx4 a[60:63], v3, s[8:11], s63 offen offset:3072
Mvaa 244,132,92
s_add_u32 s63, s5, 10
s_and_b32 s63, s63, 7
s_or_b32 s63, s63, 8
s_lshl_b32 s63, s63, 13
Mvaa 248,136,92
ds_read_b32 v61, v15 offset:264
ds_read_b32 v62, v15 offset:268
ds_read_b32 v63, v15 offset:272
Mvaa 252,140,92
ds_read_b32 v64, v15 offset:276
s_waitcnt vmcnt(24) lgkmcnt(0)
Mvaa 128,144,96
s_add_u32 m0, s35, 12288
Mvaa 132,148,96
buffer_load_dwordx4 v4, s[12:15], s48 offen offset:0 lds
Mvaa 136,152,96
Ta 128,5,0
Ta 130,5,2048
Mvaa 140,156,96
buffer_load_dwordx4 v4, s[12:15], s49 offen offset:1024 lds
Mvaa 144,144,100
s_waitcnt lgkmcnt(4)
ds_read_b32 v65, v15 offset:280
v_lshrrev_b32 v1, 5, v0
v_lshlrev_b32 v1, 8, v1
Mvaa 148,148,100
v_lshl_add_u32 v1, v13, 5, v1
v_and_b32 v15, 1, v12
v_lshl_add_u32 v1, v15, 4, v1
Mvaa 152,152,100
buffer_load_dwordx4 v4, s[12:15], s50 offen offset:2048 lds
Mvaa 156,156,100
Ta 132,6,0
Ta 134,6,2048
Mvaa 160,144,104
buffer_load_dwordx4 v4, s[12:15], s51 offen offset:3072 lds
Mvaa 164,148,104
s_add_u32 s4, s5, 12
s_and_b32 s4, s4, 7
s_or_b32 s4, s4, 8
s_lshl_b32 s4, s4, 16
v_add_u32 v4, s4, v123
Mvaa 168,152,104
v_add_u32 v1, s3, v1
s_waitcnt lgkmcnt(2)
v_lshlrev_b32 v100, 16, v72
v_and_b32 v101, 0xffff0000, v72
Mvaa 172,156,104
buffer_load_dwordx4 a[64:67], v2, s[8:11], s63 offen offset:0
Mvaa 176,144,108
Ta 136,7,0
Ta 138,7,2048
Mvaa 180,148,108
buffer_load_dwordx4 a[68:71], v2, s[8:11], s63 offen offset:1024
Mvaa 184,152,108
Vm 104,100,52
Vm 105,101,52
Vm 112,100,59
Mvaa 188,156,108
Vm 113,101,59
v_lshlrev_b32 v100, 16, v73
v_and_b32 v101, 0xffff0000, v73
Mvaa 192,144,112
buffer_load_dwordx4 a[72:75], v2, s[8:11], s63 offen offset:2048
Mvaa 196,148,112
Ta 140,8,0
Ta 142,8,2048
Mvaa 200,152,112
buffer_load_dwordx4 a[76:79], v2, s[8:11], s63 offen offset:3072
Mvaa 204,156,112
Vm 106,100,52
Vm 107,101,52
Vm 114,100,59
Mvaa 208,144,116
Vm 115,101,59
v_lshlrev_b32 v100, 16, v74
v_and_b32 v101, 0xffff0000, v74
Mvaa 212,148,116
buffer_load_dwordx4 a[80:83], v3, s[8:11], s63 offen offset:0
Mvaa 216,152,116
Vm 108,100,52
Vm 109,101,52
Vm 116,100,59
Mvaa 220,156,116
buffer_load_dwordx4 a[84:87], v3, s[8:11], s63 offen offset:1024
Mvaa 224,144,120
Vm 117,101,59
v_lshlrev_b32 v100, 16, v75
v_and_b32 v101, 0xffff0000, v75
Mvaa 228,148,120
Vm 110,100,52
Vm 111,101,52
Vm 118,100,59
Mvaa 232,152,120
buffer_load_dwordx4 a[88:91], v3, s[8:11], s63 offen offset:2048
Mvaa 236,156,120
Vm 119,101,59
v_lshlrev_b32 v100, 16, v76
v_and_b32 v101, 0xffff0000, v76
Mvaa 240,144,124
buffer_load_dwordx4 a[92:95], v3, s[8:11], s63 offen offset:3072
Mvaa 244,148,124
s_add_u32 s63, s5, 11
s_and_b32 s63, s63, 7
s_or_b32 s63, s63, 8
s_lshl_b32 s63, s63, 13
Mvaa 248,152,124
Vf 104,100,53
Vf 105,101,53
Vf 112,100,60
Mvaa 252,156,124
Vf 113,101,60
v_lshlrev_b32 v100, 16, v77
v_and_b32 v101, 0xffff0000, v77
s_waitcnt vmcnt(24) lgkmcnt(0)
Mvaa 128,128,0
s_add_u32 m0, s35, 0
Mvaa 132,132,0
buffer_load_dwordx4 v4, s[12:15], s48 offen offset:0 lds
Mvaa 136,136,0
Ta 144,5,4096
Ta 146,5,6144
Mvaa 140,140,0
buffer_load_dwordx4 v4, s[12:15], s49 offen offset:1024 lds
Mvaa 144,128,4
Vf 106,100,53
Vf 107,101,53
Vf 114,100,60
Mvaa 148,132,4
Vf 115,101,60
v_lshlrev_b32 v100, 16, v78
v_and_b32 v101, 0xffff0000, v78
Mvaa 152,136,4
buffer_load_dwordx4 v4, s[12:15], s50 offen offset:2048 lds
Mvaa 156,140,4
Ta 148,6,4096
Ta 150,6,6144
Mvaa 160,128,8
buffer_load_dwordx4 v4, s[12:15], s51 offen offset:3072 lds
Mvaa 164,132,8
s_add_u32 s4, s5, 13
s_and_b32 s4, s4, 7
s_or_b32 s4, s4, 8
s_lshl_b32 s4, s4, 16
v_add_u32 v4, s4, v123
Mvaa 168,136,8
Vf 108,100,53
Vf 109,101,53
Vf 116,100,60
Mvaa 172,140,8
buffer_load_dwordx4 a[96:99], v2, s[8:11], s63 offen offset:0
Mvaa 176,128,12
Ta 152,7,4096
Ta 154,7,6144
Mvaa 180,132,12
buffer_load_dwordx4 a[100:103], v2, s[8:11], s63 offen offset:1024
Mvaa 184,136,12
Vf 117,101,60
v_lshlrev_b32 v100, 16, v79
v_and_b32 v101, 0xffff0000, v79
Mvaa 188,140,12
Vf 110,100,53
Vf 111,101,53
Vf 118,100,60
Mvaa 192,128,16
buffer_load_dwordx4 a[104:107], v2, s[8:11], s63 offen offset:2048
Mvaa 196,132,16
Ta 156,8,4096
Ta 158,8,6144
Mvaa 200,136,16
buffer_load_dwordx4 a[108:111], v2, s[8:11], s63 offen offset:3072
Mvaa 204,140,16
Vf 119,101,60
v_lshlrev_b32 v100, 16, v80
v_and_b32 v101, 0xffff0000, v80
Mvaa 208,128,20
Vf 104,100,54
Vf 105,101,54
Vf 112,100,61
Mvaa 212,132,20
buffer_load_dwordx4 a[112:115], v3, s[8:11], s63 offen offset:0
Mvaa 216,136,20
Vf 113,101,61
v_lshlrev_b32 v100, 16, v81
v_and_b32 v101, 0xffff0000, v81
Mvaa 220,140,20
buffer_load_dwordx4 a[116:119], v3, s[8:11], s63 offen offset:1024
Mvaa 224,128,24
Vf 106,100,54
Vf 107,101,54
Vf 114,100,61
Mvaa 228,132,24
Vf 115,101,61
v_lshlrev_b32 v100, 16, v82
v_and_b32 v101, 0xffff0000, v82
Mvaa 232,136,24
buffer_load_dwordx4 a[120:123], v3, s[8:11], s63 offen offset:2048
Mvaa 236,140,24
Vf 108,100,54
Vf 109,101,54
Vf 116,100,61
Mvaa 240,128,28
buffer_load_dwordx4 a[124:127], v3, s[8:11], s63 offen offset:3072
Mvaa 244,132,28
s_add_u32 s63, s5, 12
s_and_b32 s63, s63, 7
s_or_b32 s63, s63, 8
s_lshl_b32 s63, s63, 13
Mvaa 248,136,28
Vf 117,101,61
v_lshlrev_b32 v100, 16, v83
v_and_b32 v101, 0xffff0000, v83
Mvaa 252,140,28
Vf 110,100,54
Vf 111,101,54
Vf 118,100,61
s_waitcnt vmcnt(24) lgkmcnt(0)
Mvaa 128,144,32
s_add_u32 m0, s35, 4096
Mvaa 132,148,32
buffer_load_dwordx4 v4, s[12:15], s48 offen offset:0 lds
Mvaa 136,152,32
Ta 128,5,8192
Ta 130,5,10240
Mvaa 140,156,32
buffer_load_dwordx4 v4, s[12:15], s49 offen offset:1024 lds
Mvaa 144,144,36
Vf 119,101,61
v_lshlrev_b32 v100, 16, v84
v_and_b32 v101, 0xffff0000, v84
Mvaa 148,148,36
Vf 104,100,55
Vf 105,101,55
Vf 112,100,62
Mvaa 152,152,36
buffer_load_dwordx4 v4, s[12:15], s50 offen offset:2048 lds
Mvaa 156,156,36
Ta 132,6,8192
Ta 134,6,10240
Mvaa 160,144,40
buffer_load_dwordx4 v4, s[12:15], s51 offen offset:3072 lds
Mvaa 164,148,40
s_add_u32 s4, s5, 14
s_and_b32 s4, s4, 7
s_or_b32 s4, s4, 8
s_lshl_b32 s4, s4, 16
v_add_u32 v4, s4, v123
Mvaa 168,152,40
Vf 113,101,62
v_lshlrev_b32 v100, 16, v85
v_and_b32 v101, 0xffff0000, v85
Mvaa 172,156,40
buffer_load_dwordx4 a[0:3], v2, s[8:11], s63 offen offset:0
Mvaa 176,144,44
Ta 136,7,8192
Ta 138,7,10240
Mvaa 180,148,44
buffer_load_dwordx4 a[4:7], v2, s[8:11], s63 offen offset:1024
Mvaa 184,152,44
Vf 106,100,55
Vf 107,101,55
Vf 114,100,62
Mvaa 188,156,44
Vf 115,101,62
v_lshlrev_b32 v100, 16, v86
v_and_b32 v101, 0xffff0000, v86
Mvaa 192,144,48
buffer_load_dwordx4 a[8:11], v2, s[8:11], s63 offen offset:2048
Mvaa 196,148,48
Ta 140,8,8192
Ta 142,8,10240
Mvaa 200,152,48
buffer_load_dwordx4 a[12:15], v2, s[8:11], s63 offen offset:3072
Mvaa 204,156,48
Vf 108,100,55
Vf 109,101,55
Vf 116,100,62
Mvaa 208,144,52
Vf 117,101,62
v_lshlrev_b32 v100, 16, v87
v_and_b32 v101, 0xffff0000, v87
Mvaa 212,148,52
buffer_load_dwordx4 a[16:19], v3, s[8:11], s63 offen offset:0
Mvaa 216,152,52
Vf 110,100,55
Vf 111,101,55
Vf 118,100,62
Mvaa 220,156,52
buffer_load_dwordx4 a[20:23], v3, s[8:11], s63 offen offset:1024
Mvaa 224,144,56
Vf 119,101,62
v_lshlrev_b32 v100, 16, v88
v_and_b32 v101, 0xffff0000, v88
Mvaa 228,148,56
Vf 104,100,56
Vf 105,101,56
Vf 112,100,63
Mvaa 232,152,56
buffer_load_dwordx4 a[24:27], v3, s[8:11], s63 offen offset:2048
Mvaa 236,156,56
Vf 113,101,63
v_lshlrev_b32 v100, 16, v89
v_and_b32 v101, 0xffff0000, v89
Mvaa 240,144,60
buffer_load_dwordx4 a[28:31], v3, s[8:11], s63 offen offset:3072
Mvaa 244,148,60
s_add_u32 s63, s5, 13
s_and_b32 s63, s63, 7
s_or_b32 s63, s63, 8
s_lshl_b32 s63, s63, 13
Mvaa 248,152,60
Vf 106,100,56
Vf 107,101,56
Vf 114,100,63
Mvaa 252,156,60
Vf 115,101,63
v_lshlrev_b32 v100, 16, v90
v_and_b32 v101, 0xffff0000, v90
s_waitcnt vmcnt(24) lgkmcnt(0)
Mvaa 128,128,64
s_add_u32 m0, s35, 8192
Mvaa 132,132,64
buffer_load_dwordx4 v4, s[12:15], s48 offen offset:0 lds
Mvaa 136,136,64
Ta 144,5,12288
Ta 146,5,14336
Mvaa 140,140,64
buffer_load_dwordx4 v4, s[12:15], s49 offen offset:1024 lds
Mvaa 144,128,68
Vf 108,100,56
Vf 109,101,56
Vf 116,100,63
Mvaa 148,132,68
Vf 117,101,63
v_lshlrev_b32 v100, 16, v91
v_and_b32 v101, 0xffff0000, v91
Mvaa 152,136,68
buffer_load_dwordx4 v4, s[12:15], s50 offen offset:2048 lds
Mvaa 156,140,68
Ta 148,6,12288
Ta 150,6,14336
Mvaa 160,128,72
buffer_load_dwordx4 v4, s[12:15], s51 offen offset:3072 lds
Mvaa 164,132,72
s_add_u32 s4, s5, 15
s_and_b32 s4, s4, 7
s_or_b32 s4, s4, 8
s_lshl_b32 s4, s4, 16
v_add_u32 v4, s4, v123
Mvaa 168,136,72
Vf 110,100,56
Vf 111,101,56
Vf 118,100,63
Mvaa 172,140,72
buffer_load_dwordx4 a[32:35], v2, s[8:11], s63 offen offset:0
Mvaa 176,128,76
Ta 152,7,12288
Ta 154,7,14336
Mvaa 180,132,76
buffer_load_dwordx4 a[36:39], v2, s[8:11], s63 offen offset:1024
Mvaa 184,136,76
Vf 119,101,63
v_lshlrev_b32 v100, 16, v92
v_and_b32 v101, 0xffff0000, v92
Mvaa 188,140,76
Vf 104,100,57
Vf 105,101,57
Vf 112,100,64
Mvaa 192,128,80
buffer_load_dwordx4 a[40:43], v2, s[8:11], s63 offen offset:2048
Mvaa 196,132,80
Ta 156,8,12288
Ta 158,8,14336
Mvaa 200,136,80
buffer_load_dwordx4 a[44:47], v2, s[8:11], s63 offen offset:3072
Mvaa 204,140,80
Vf 113,101,64
v_lshlrev_b32 v100, 16, v93
v_and_b32 v101, 0xffff0000, v93
Mvaa 208,128,84
Vf 106,100,57
Vf 107,101,57
Vf 114,100,64
Mvaa 212,132,84
buffer_load_dwordx4 a[48:51], v3, s[8:11], s63 offen offset:0
Mvaa 216,136,84
Vf 115,101,64
v_lshlrev_b32 v100, 16, v94
v_and_b32 v101, 0xffff0000, v94
Mvaa 220,140,84
buffer_load_dwordx4 a[52:55], v3, s[8:11], s63 offen offset:1024
Mvaa 224,128,88
Vf 108,100,57
Vf 109,101,57
Vf 116,100,64
Mvaa 228,132,88
Vf 117,101,64
v_lshlrev_b32 v100, 16, v95
v_and_b32 v101, 0xffff0000, v95
Mvaa 232,136,88
buffer_load_dwordx4 a[56:59], v3, s[8:11], s63 offen offset:2048
Mvaa 236,140,88
Vf 110,100,57
Vf 111,101,57
Vf 118,100,64
Mvaa 240,128,92
buffer_load_dwordx4 a[60:63], v3, s[8:11], s63 offen offset:3072
Mvaa 244,132,92
s_add_u32 s63, s5, 14
s_and_b32 s63, s63, 7
s_or_b32 s63, s63, 8
s_lshl_b32 s63, s63, 13
Mvaa 248,136,92
Vf 119,101,64
v_lshlrev_b32 v100, 16, v96
v_and_b32 v101, 0xffff0000, v96
Mvaa 252,140,92
Vf 104,100,58
Vf 105,101,58
Vf 112,100,65
s_waitcnt vmcnt(24) lgkmcnt(0)
Mvaa 128,144,96
s_add_u32 m0, s35, 12288
Mvaa 132,148,96
buffer_load_dwordx4 v4, s[12:15], s48 offen offset:0 lds
Mvaa 136,152,96
Ta 128,5,0
Ta 130,5,2048
Mvaa 140,156,96
buffer_load_dwordx4 v4, s[12:15], s49 offen offset:1024 lds
Mvaa 144,144,100
Vf 113,101,65
v_lshlrev_b32 v100, 16, v97
v_and_b32 v101, 0xffff0000, v97
Mvaa 148,148,100
Vf 106,100,58
Vf 107,101,58
Vf 114,100,65
Mvaa 152,152,100
buffer_load_dwordx4 v4, s[12:15], s50 offen offset:2048 lds
Mvaa 156,156,100
Ta 132,6,0
Ta 134,6,2048
Mvaa 160,144,104
buffer_load_dwordx4 v4, s[12:15], s51 offen offset:3072 lds
Mvaa 164,148,104
s_add_u32 s4, s5, 16
s_and_b32 s4, s4, 7
s_or_b32 s4, s4, 16
s_lshl_b32 s4, s4, 16
v_add_u32 v4, s4, v123
Mvaa 168,152,104
Vf 115,101,65
v_lshlrev_b32 v100, 16, v98
v_and_b32 v101, 0xffff0000, v98
Mvaa 172,156,104
buffer_load_dwordx4 a[64:67], v2, s[8:11], s63 offen offset:0
Mvaa 176,144,108
Ta 136,7,0
Ta 138,7,2048
Mvaa 180,148,108
buffer_load_dwordx4 a[68:71], v2, s[8:11], s63 offen offset:1024
Mvaa 184,152,108
Vf 108,100,58
Vf 109,101,58
Vf 116,100,65
Mvaa 188,156,108
Vf 117,101,65
v_lshlrev_b32 v100, 16, v99
v_and_b32 v101, 0xffff0000, v99
Mvaa 192,144,112
buffer_load_dwordx4 a[72:75], v2, s[8:11], s63 offen offset:2048
Mvaa 196,148,112
Ta 140,8,0
Ta 142,8,2048
Mvaa 200,152,112
buffer_load_dwordx4 a[76:79], v2, s[8:11], s63 offen offset:3072
Mvaa 204,156,112
Vf 110,100,58
Vf 111,101,58
Vf 118,100,65
Mvaa 208,144,116
Vf 119,101,65
v_permlane32_swap_b32 v104, v112
v_permlane32_swap_b32 v105, v113
Mvaa 212,148,116
buffer_load_dwordx4 a[80:83], v3, s[8:11], s63 offen offset:0
Mvaa 216,152,116
v_permlane32_swap_b32 v106, v114
v_permlane32_swap_b32 v107, v115
v_permlane32_swap_b32 v108, v116
Mvaa 220,156,116
buffer_load_dwordx4 a[84:87], v3, s[8:11], s63 offen offset:1024
Mvaa 224,144,120
v_permlane32_swap_b32 v109, v117
v_permlane32_swap_b32 v110, v118
v_permlane32_swap_b32 v111, v119
Mvaa 228,148,120
Va 104,104,112
Va 105,105,113
Va 106,106,114
Mvaa 232,152,120
buffer_load_dwordx4 a[88:91], v3, s[8:11], s63 offen offset:2048
Mvaa 236,156,120
Va 107,107,115
Va 108,108,116
Va 109,109,117
Mvaa 240,144,124
buffer_load_dwordx4 a[92:95], v3, s[8:11], s63 offen offset:3072
Mvaa 244,148,124
s_add_u32 s63, s5, 15
s_and_b32 s63, s63, 7
s_or_b32 s63, s63, 8
s_lshl_b32 s63, s63, 13
Mvaa 248,152,124
Va 110,110,118
Va 111,111,119
v_permlane16_swap_b32 v104, v108
Mvaa 252,156,124
v_permlane16_swap_b32 v105, v109
v_permlane16_swap_b32 v106, v110
v_permlane16_swap_b32 v107, v111
s_waitcnt vmcnt(24) lgkmcnt(0)
Mvaa 128,128,0
s_add_u32 m0, s35, 0
Mvaa 132,132,0
buffer_load_dwordx4 v4, s[12:15], s48 offen offset:0 lds
Mvaa 136,136,0
Ta 144,5,4096
Ta 146,5,6144
Mvaa 140,140,0
buffer_load_dwordx4 v4, s[12:15], s49 offen offset:1024 lds
Mvaa 144,128,4
Va 104,104,108
Va 105,105,109
Va 106,106,110
Mvaa 148,132,4
Va 107,107,111
v_add_f32_dpp v104, v104, v104 row_ror:8 row_mask:0xf bank_mask:0xf
v_add_f32_dpp v105, v105, v105 row_ror:8 row_mask:0xf bank_mask:0xf
Mvaa 152,136,4
buffer_load_dwordx4 v4, s[12:15], s50 offen offset:2048 lds
Mvaa 156,140,4
Ta 148,6,4096
Ta 150,6,6144
Mvaa 160,128,8
buffer_load_dwordx4 v4, s[12:15], s51 offen offset:3072 lds
Mvaa 164,132,8
s_add_u32 s4, s5, 17
s_and_b32 s4, s4, 7
s_or_b32 s4, s4, 16
s_lshl_b32 s4, s4, 16
v_add_u32 v4, s4, v123
Mvaa 168,136,8
v_add_f32_dpp v106, v106, v106 row_ror:8 row_mask:0xf bank_mask:0xf
v_add_f32_dpp v107, v107, v107 row_ror:8 row_mask:0xf bank_mask:0xf
Mvaa 172,140,8
buffer_load_dwordx4 a[96:99], v2, s[8:11], s63 offen offset:0
Mvaa 176,128,12
Ta 152,7,4096
Ta 154,7,6144
Mvaa 180,132,12
buffer_load_dwordx4 a[100:103], v2, s[8:11], s63 offen offset:1024
Mvaa 184,136,12
ds_write_b128 v1, v[104:107] offset:2048
v_lshlrev_b32 v1, 3, v0
v_add_u32 v15, 133120, v1
Mvaa 188,140,12
s_lshl_b32 s3, s39, 4
s_add_u32 s3, s3, s37
s_lshl_b32 s3, s3, 9
Mvaa 192,128,16
buffer_load_dwordx4 a[104:107], v2, s[8:11], s63 offen offset:2048
Mvaa 196,132,16
Ta 156,8,4096
Ta 158,8,6144
Mvaa 200,136,16
buffer_load_dwordx4 a[108:111], v2, s[8:11], s63 offen offset:3072
Mvaa 204,140,16
s_add_u32 s3, s3, 5308416
s_cmp_eq_u32 s32, 0
s_cselect_b32 s3, s3, 0x7ff00000
s_lshl_b32 s38, s39, 4
s_cmp_eq_u32 s32, 0
s_cselect_b32 s38, s38, 0x7ff00000
Mvaa 208,128,20
s_waitcnt lgkmcnt(2)
s_barrier
ds_read_b64 v[104:105], v15 offset:0
ds_read_b64 v[106:107], v15 offset:512
ds_read_b64 v[108:109], v15 offset:1024
Mvaa 212,132,20
buffer_load_dwordx4 a[112:115], v3, s[8:11], s63 offen offset:0
Mvaa 216,136,20
ds_read_b64 v[110:111], v15 offset:1536
v_mov_b32 v102, 1
v_mov_b32 v103, 0
Mvaa 220,140,20
buffer_load_dwordx4 a[116:119], v3, s[8:11], s63 offen offset:1024
Mvaa 224,128,24
s_waitcnt lgkmcnt(0)
Va 104,104,106
Va 108,108,110
Va 105,105,107
Mvaa 228,132,24
Va 109,109,111
Va 104,104,108
Va 105,105,109
Mvaa 232,136,24
buffer_load_dwordx4 a[120:123], v3, s[8:11], s63 offen offset:2048
Mvaa 236,140,24
buffer_store_dwordx2 v[104:105], v1, s[16:19], s3 offen sc1
v_lshlrev_b32 v40, 16, v16
Mvaa 240,128,28
buffer_load_dwordx4 a[124:127], v3, s[8:11], s63 offen offset:3072
Mvaa 244,132,28
s_add_u32 s63, s5, 16
s_and_b32 s63, s63, 7
s_or_b32 s63, s63, 16
s_lshl_b32 s63, s63, 13
Mvaa 248,136,28
v_and_b32 v41, 0xffff0000, v16
v_lshlrev_b32 v42, 16, v17
v_and_b32 v43, 0xffff0000, v17
Mvaa 252,140,28
v_lshlrev_b32 v44, 16, v18
v_and_b32 v45, 0xffff0000, v18
v_lshlrev_b32 v46, 16, v19
s_waitcnt vmcnt(25) lgkmcnt(0)
Mvaa 128,144,32
s_add_u32 m0, s35, 4096
Mvaa 132,148,32
buffer_load_dwordx4 v4, s[12:15], s48 offen offset:0 lds
Mvaa 136,152,32
Ta 128,5,8192
Ta 130,5,10240
Mvaa 140,156,32
buffer_load_dwordx4 v4, s[12:15], s49 offen offset:1024 lds
Mvaa 144,144,36
v_and_b32 v47, 0xffff0000, v19
Vs 40,40,32
Vs 41,41,32
Mvaa 148,148,36
Vs 42,42,32
Vs 43,43,32
Vs 44,44,32
Mvaa 152,152,36
buffer_load_dwordx4 v4, s[12:15], s50 offen offset:2048 lds
Mvaa 156,156,36
Ta 132,6,8192
Ta 134,6,10240
Mvaa 160,144,40
buffer_load_dwordx4 v4, s[12:15], s51 offen offset:3072 lds
Mvaa 164,148,40
s_add_u32 s4, s5, 18
s_and_b32 s4, s4, 7
s_or_b32 s4, s4, 16
s_lshl_b32 s4, s4, 16
v_add_u32 v4, s4, v123
Mvaa 168,152,40
Vs 45,45,32
Vs 46,46,32
Vs 47,47,32
Mvaa 172,156,40
buffer_load_dwordx4 a[0:3], v2, s[8:11], s63 offen offset:0
Mvaa 176,144,44
Ta 136,7,8192
Ta 138,7,10240
Mvaa 180,148,44
buffer_load_dwordx4 a[4:7], v2, s[8:11], s63 offen offset:1024
Mvaa 184,152,44
Vc 72,40,41
v_lshlrev_b32 v40, 16, v72
v_and_b32 v41, 0xffff0000, v72
Mvaa 188,156,44
Vc 73,42,43
v_lshlrev_b32 v42, 16, v73
v_and_b32 v43, 0xffff0000, v73
Mvaa 192,144,48
buffer_load_dwordx4 a[8:11], v2, s[8:11], s63 offen offset:2048
Mvaa 196,148,48
Ta 140,8,8192
Ta 142,8,10240
Mvaa 200,152,48
buffer_load_dwordx4 a[12:15], v2, s[8:11], s63 offen offset:3072
Mvaa 204,156,48
Vc 74,44,45
v_lshlrev_b32 v44, 16, v74
v_and_b32 v45, 0xffff0000, v74
Mvaa 208,144,52
Vc 75,46,47
v_lshlrev_b32 v46, 16, v75
v_and_b32 v47, 0xffff0000, v75
Mvaa 212,148,52
buffer_load_dwordx4 a[16:19], v3, s[8:11], s63 offen offset:0
Mvaa 216,152,52
Vm 40,40,33
Vm 41,41,33
Vm 42,42,33
Mvaa 220,156,52
buffer_load_dwordx4 a[20:23], v3, s[8:11], s63 offen offset:1024
Mvaa 224,144,56
Vm 43,43,33
Vm 44,44,33
Vm 45,45,33
Mvaa 228,148,56
Vm 46,46,33
Vm 47,47,33
Vc 72,40,41
Mvaa 232,152,56
buffer_load_dwordx4 a[24:27], v3, s[8:11], s63 offen offset:2048
Mvaa 236,156,56
v_lshlrev_b32 v40, 16, v72
v_and_b32 v41, 0xffff0000, v72
Vc 73,42,43
Mvaa 240,144,60
buffer_load_dwordx4 a[28:31], v3, s[8:11], s63 offen offset:3072
Mvaa 244,148,60
s_add_u32 s63, s5, 17
s_and_b32 s63, s63, 7
s_or_b32 s63, s63, 16
s_lshl_b32 s63, s63, 13
Mvaa 248,152,60
v_lshlrev_b32 v42, 16, v73
v_and_b32 v43, 0xffff0000, v73
Vc 74,44,45
Mvaa 252,156,60
v_lshlrev_b32 v44, 16, v74
v_and_b32 v45, 0xffff0000, v74
Vc 75,46,47
s_waitcnt vmcnt(25) lgkmcnt(0)
Mvaa 128,128,64
s_add_u32 m0, s35, 8192
Mvaa 132,132,64
buffer_load_dwordx4 v4, s[12:15], s48 offen offset:0 lds
Mvaa 136,136,64
Ta 144,5,12288
Ta 146,5,14336
Mvaa 140,140,64
buffer_load_dwordx4 v4, s[12:15], s49 offen offset:1024 lds
Mvaa 144,128,68
v_lshlrev_b32 v46, 16, v75
v_and_b32 v47, 0xffff0000, v75
v_mul_f32 v72, 0xbfb8aa3b, v40
Mvaa 148,132,68
v_mul_f32 v73, 0xbfb8aa3b, v41
v_mul_f32 v74, 0xbfb8aa3b, v42
v_mul_f32 v75, 0xbfb8aa3b, v43
Mvaa 152,136,68
buffer_load_dwordx4 v4, s[12:15], s50 offen offset:2048 lds
Mvaa 156,140,68
Ta 148,6,12288
Ta 150,6,14336
Mvaa 160,128,72
buffer_load_dwordx4 v4, s[12:15], s51 offen offset:3072 lds
Mvaa 164,132,72
s_add_u32 s4, s5, 19
s_and_b32 s4, s4, 7
s_or_b32 s4, s4, 16
s_lshl_b32 s4, s4, 16
v_add_u32 v4, s4, v123
Mvaa 168,136,72
v_mul_f32 v76, 0xbfb8aa3b, v44
v_mul_f32 v77, 0xbfb8aa3b, v45
v_mul_f32 v78, 0xbfb8aa3b, v46
Mvaa 172,140,72
buffer_load_dwordx4 a[32:35], v2, s[8:11], s63 offen offset:0
Mvaa 176,128,76
Ta 152,7,12288
Ta 154,7,14336
Mvaa 180,132,76
buffer_load_dwordx4 a[36:39], v2, s[8:11], s63 offen offset:1024
Mvaa 184,136,76
v_mul_f32 v79, 0xbfb8aa3b, v47
Ve 72,72
Mvaa 188,140,76
Ve 73,73
Mvaa 192,128,80
buffer_load_dwordx4 a[40:43], v2, s[8:11], s63 offen offset:2048
Mvaa 196,132,80
Ta 156,8,12288
Ta 158,8,14336
Mvaa 200,136,80
buffer_load_dwordx4 a[44:47], v2, s[8:11], s63 offen offset:3072
Mvaa 204,140,80
Ve 74,74
Mvaa 208,128,84
Ve 75,75
Mvaa 212,132,84
buffer_load_dwordx4 a[48:51], v3, s[8:11], s63 offen offset:0
Mvaa 216,136,84
Ve 76,76
Mvaa 220,140,84
buffer_load_dwordx4 a[52:55], v3, s[8:11], s63 offen offset:1024
Mvaa 224,128,88
Ve 77,77
Mvaa 228,132,88
Ve 78,78
Mvaa 232,136,88
buffer_load_dwordx4 a[56:59], v3, s[8:11], s63 offen offset:2048
Mvaa 236,140,88
Ve 79,79
v_add_f32 v72, 1.0, v72
Mvaa 240,128,92
buffer_load_dwordx4 a[60:63], v3, s[8:11], s63 offen offset:3072
Mvaa 244,132,92
s_add_u32 s63, s5, 18
s_and_b32 s63, s63, 7
s_or_b32 s63, s63, 16
s_lshl_b32 s63, s63, 13
Mvaa 248,136,92
v_add_f32 v73, 1.0, v73
v_add_f32 v74, 1.0, v74
v_add_f32 v75, 1.0, v75
Mvaa 252,140,92
v_add_f32 v76, 1.0, v76
v_add_f32 v77, 1.0, v77
v_add_f32 v78, 1.0, v78
s_waitcnt vmcnt(24) lgkmcnt(0)
Mvaa 128,144,96
s_add_u32 m0, s35, 12288
Mvaa 132,148,96
buffer_load_dwordx4 v4, s[12:15], s48 offen offset:0 lds
Mvaa 136,152,96
Ta 128,5,0
Ta 130,5,2048
Mvaa 140,156,96
buffer_load_dwordx4 v4, s[12:15], s49 offen offset:1024 lds
Mvaa 144,144,100
v_add_f32 v79, 1.0, v79
v_rcp_f32 v72, v72
Mvaa 148,148,100
v_rcp_f32 v73, v73
Mvaa 152,152,100
buffer_load_dwordx4 v4, s[12:15], s50 offen offset:2048 lds
Mvaa 156,156,100
Ta 132,6,0
Ta 134,6,2048
Mvaa 160,144,104
buffer_load_dwordx4 v4, s[12:15], s51 offen offset:3072 lds
Mvaa 164,148,104
s_add_u32 s4, s5, 20
s_and_b32 s4, s4, 7
s_or_b32 s4, s4, 16
s_lshl_b32 s4, s4, 16
v_add_u32 v4, s4, v123
Mvaa 168,152,104
v_rcp_f32 v74, v74
Mvaa 172,156,104
buffer_load_dwordx4 a[64:67], v2, s[8:11], s63 offen offset:0
Mvaa 176,144,108
Ta 136,7,0
Ta 138,7,2048
Mvaa 180,148,108
buffer_load_dwordx4 a[68:71], v2, s[8:11], s63 offen offset:1024
Mvaa 184,152,108
v_rcp_f32 v75, v75
Mvaa 188,156,108
v_rcp_f32 v76, v76
Mvaa 192,144,112
buffer_load_dwordx4 a[72:75], v2, s[8:11], s63 offen offset:2048
Mvaa 196,148,112
Ta 140,8,0
Ta 142,8,2048
Mvaa 200,152,112
buffer_load_dwordx4 a[76:79], v2, s[8:11], s63 offen offset:3072
Mvaa 204,156,112
v_rcp_f32 v77, v77
Mvaa 208,144,116
v_rcp_f32 v78, v78
Mvaa 212,148,116
buffer_load_dwordx4 a[80:83], v3, s[8:11], s63 offen offset:0
Mvaa 216,152,116
v_rcp_f32 v79, v79
Vm 40,40,72
Mvaa 220,156,116
buffer_load_dwordx4 a[84:87], v3, s[8:11], s63 offen offset:1024
Mvaa 224,144,120
Vm 41,41,73
Vm 42,42,74
Vm 43,43,75
Mvaa 228,148,120
Vm 44,44,76
Vm 45,45,77
Vm 46,46,78
Mvaa 232,152,120
buffer_load_dwordx4 a[88:91], v3, s[8:11], s63 offen offset:2048
Mvaa 236,156,120
Vm 47,47,79
Vc 72,40,41
v_lshlrev_b32 v40, 16, v72
Mvaa 240,144,124
buffer_load_dwordx4 a[92:95], v3, s[8:11], s63 offen offset:3072
Mvaa 244,148,124
s_add_u32 s63, s5, 19
s_and_b32 s63, s63, 7
s_or_b32 s63, s63, 16
s_lshl_b32 s63, s63, 13
Mvaa 248,152,124
v_and_b32 v41, 0xffff0000, v72
Vc 73,42,43
v_lshlrev_b32 v42, 16, v73
Mvaa 252,156,124
v_and_b32 v43, 0xffff0000, v73
Vc 74,44,45
v_lshlrev_b32 v44, 16, v74
s_waitcnt vmcnt(24) lgkmcnt(0)
Mvaa 128,128,0
s_add_u32 m0, s35, 0
Mvaa 132,132,0
buffer_load_dwordx4 v4, s[12:15], s48 offen offset:0 lds
Mvaa 136,136,0
Ta 144,5,4096
Ta 146,5,6144
Mvaa 140,140,0
buffer_load_dwordx4 v4, s[12:15], s49 offen offset:1024 lds
Mvaa 144,128,4
v_and_b32 v45, 0xffff0000, v74
Vc 75,46,47
v_lshlrev_b32 v46, 16, v75
Mvaa 148,132,4
v_and_b32 v47, 0xffff0000, v75
v_lshlrev_b32 v48, 16, v20
v_and_b32 v49, 0xffff0000, v20
Mvaa 152,136,4
buffer_load_dwordx4 v4, s[12:15], s50 offen offset:2048 lds
Mvaa 156,140,4
Ta 148,6,4096
Ta 150,6,6144
Mvaa 160,128,8
buffer_load_dwordx4 v4, s[12:15], s51 offen offset:3072 lds
Mvaa 164,132,8
s_add_u32 s4, s5, 21
s_and_b32 s4, s4, 7
s_or_b32 s4, s4, 16
s_lshl_b32 s4, s4, 16
v_add_u32 v4, s4, v123
Mvaa 168,136,8
v_lshlrev_b32 v50, 16, v21
v_and_b32 v51, 0xffff0000, v21
v_lshlrev_b32 v52, 16, v22
Mvaa 172,140,8
buffer_load_dwordx4 a[96:99], v2, s[8:11], s63 offen offset:0
Mvaa 176,128,12
Ta 152,7,4096
Ta 154,7,6144
Mvaa 180,132,12
buffer_load_dwordx4 a[100:103], v2, s[8:11], s63 offen offset:1024
Mvaa 184,136,12
v_and_b32 v53, 0xffff0000, v22
v_lshlrev_b32 v54, 16, v23
v_and_b32 v55, 0xffff0000, v23
Mvaa 188,140,12
Vs 48,48,34
Vs 49,49,34
Vs 50,50,34
Mvaa 192,128,16
buffer_load_dwordx4 a[104:107], v2, s[8:11], s63 offen offset:2048
Mvaa 196,132,16
Ta 156,8,4096
Ta 158,8,6144
Mvaa 200,136,16
buffer_load_dwordx4 a[108:111], v2, s[8:11], s63 offen offset:3072
Mvaa 204,140,16
Vs 51,51,34
Vs 52,52,34
Vs 53,53,34
Mvaa 208,128,20
Vs 54,54,34
Vs 55,55,34
Vc 72,48,49
Mvaa 212,132,20
buffer_load_dwordx4 a[112:115], v3, s[8:11], s63 offen offset:0
Mvaa 216,136,20
v_lshlrev_b32 v48, 16, v72
v_and_b32 v49, 0xffff0000, v72
Vc 73,50,51
Mvaa 220,140,20
buffer_load_dwordx4 a[116:119], v3, s[8:11], s63 offen offset:1024
Mvaa 224,128,24
v_lshlrev_b32 v50, 16, v73
v_and_b32 v51, 0xffff0000, v73
Vc 74,52,53
Mvaa 228,132,24
v_lshlrev_b32 v52, 16, v74
v_and_b32 v53, 0xffff0000, v74
Vc 75,54,55
Mvaa 232,136,24
buffer_load_dwordx4 a[120:123], v3, s[8:11], s63 offen offset:2048
Mvaa 236,140,24
v_lshlrev_b32 v54, 16, v75
v_and_b32 v55, 0xffff0000, v75
Vm 48,48,35
Mvaa 240,128,28
buffer_load_dwordx4 a[124:127], v3, s[8:11], s63 offen offset:3072
Mvaa 244,132,28
s_add_u32 s63, s5, 20
s_and_b32 s63, s63, 7
s_or_b32 s63, s63, 16
s_lshl_b32 s63, s63, 13
Mvaa 248,136,28
Vm 49,49,35
Vm 50,50,35
Vm 51,51,35
Mvaa 252,140,28
Vm 52,52,35
Vm 53,53,35
Vm 54,54,35
s_waitcnt vmcnt(24) lgkmcnt(0)
Mvaa 128,144,32
s_add_u32 m0, s35, 4096
Mvaa 132,148,32
buffer_load_dwordx4 v4, s[12:15], s48 offen offset:0 lds
Mvaa 136,152,32
Ta 128,5,8192
Ta 130,5,10240
Mvaa 140,156,32
buffer_load_dwordx4 v4, s[12:15], s49 offen offset:1024 lds
Mvaa 144,144,36
Vm 55,55,35
Vc 72,48,49
v_lshlrev_b32 v48, 16, v72
Mvaa 148,148,36
v_and_b32 v49, 0xffff0000, v72
Vc 73,50,51
v_lshlrev_b32 v50, 16, v73
Mvaa 152,152,36
buffer_load_dwordx4 v4, s[12:15], s50 offen offset:2048 lds
Mvaa 156,156,36
Ta 132,6,8192
Ta 134,6,10240
Mvaa 160,144,40
buffer_load_dwordx4 v4, s[12:15], s51 offen offset:3072 lds
Mvaa 164,148,40
s_add_u32 s4, s5, 22
s_and_b32 s4, s4, 7
s_or_b32 s4, s4, 16
s_lshl_b32 s4, s4, 16
v_add_u32 v4, s4, v123
Mvaa 168,152,40
v_and_b32 v51, 0xffff0000, v73
Vc 74,52,53
v_lshlrev_b32 v52, 16, v74
Mvaa 172,156,40
buffer_load_dwordx4 a[0:3], v2, s[8:11], s63 offen offset:0
Mvaa 176,144,44
Ta 136,7,8192
Ta 138,7,10240
Mvaa 180,148,44
buffer_load_dwordx4 a[4:7], v2, s[8:11], s63 offen offset:1024
Mvaa 184,152,44
v_and_b32 v53, 0xffff0000, v74
Vc 75,54,55
v_lshlrev_b32 v54, 16, v75
Mvaa 188,156,44
v_and_b32 v55, 0xffff0000, v75
v_mul_f32 v72, 0xbfb8aa3b, v48
v_mul_f32 v73, 0xbfb8aa3b, v49
Mvaa 192,144,48
buffer_load_dwordx4 a[8:11], v2, s[8:11], s63 offen offset:2048
Mvaa 196,148,48
Ta 140,8,8192
Ta 142,8,10240
Mvaa 200,152,48
buffer_load_dwordx4 a[12:15], v2, s[8:11], s63 offen offset:3072
Mvaa 204,156,48
v_mul_f32 v74, 0xbfb8aa3b, v50
v_mul_f32 v75, 0xbfb8aa3b, v51
v_mul_f32 v76, 0xbfb8aa3b, v52
Mvaa 208,144,52
v_mul_f32 v77, 0xbfb8aa3b, v53
v_mul_f32 v78, 0xbfb8aa3b, v54
v_mul_f32 v79, 0xbfb8aa3b, v55
Mvaa 212,148,52
buffer_load_dwordx4 a[16:19], v3, s[8:11], s63 offen offset:0
Mvaa 216,152,52
Ve 72,72
Mvaa 220,156,52
buffer_load_dwordx4 a[20:23], v3, s[8:11], s63 offen offset:1024
Mvaa 224,144,56
Ve 73,73
Mvaa 228,148,56
Ve 74,74
Mvaa 232,152,56
buffer_load_dwordx4 a[24:27], v3, s[8:11], s63 offen offset:2048
Mvaa 236,156,56
Ve 75,75
Mvaa 240,144,60
buffer_load_dwordx4 a[28:31], v3, s[8:11], s63 offen offset:3072
Mvaa 244,148,60
s_add_u32 s63, s5, 21
s_and_b32 s63, s63, 7
s_or_b32 s63, s63, 16
s_lshl_b32 s63, s63, 13
Mvaa 248,152,60
Ve 76,76
Mvaa 252,156,60
Ve 77,77
s_waitcnt vmcnt(24) lgkmcnt(0)
Mvaa 128,128,64
s_add_u32 m0, s35, 8192
Mvaa 132,132,64
buffer_load_dwordx4 v4, s[12:15], s48 offen offset:0 lds
Mvaa 136,136,64
Ta 144,5,12288
Ta 146,5,14336
Mvaa 140,140,64
buffer_load_dwordx4 v4, s[12:15], s49 offen offset:1024 lds
Mvaa 144,128,68
Ve 78,78
Mvaa 148,132,68
Ve 79,79
v_add_f32 v72, 1.0, v72
Mvaa 152,136,68
buffer_load_dwordx4 v4, s[12:15], s50 offen offset:2048 lds
Mvaa 156,140,68
Ta 148,6,12288
Ta 150,6,14336
Mvaa 160,128,72
buffer_load_dwordx4 v4, s[12:15], s51 offen offset:3072 lds
Mvaa 164,132,72
s_add_u32 s4, s5, 23
s_and_b32 s4, s4, 7
s_or_b32 s4, s4, 16
s_lshl_b32 s4, s4, 16
v_add_u32 v4, s4, v123
Mvaa 168,136,72
v_add_f32 v73, 1.0, v73
v_add_f32 v74, 1.0, v74
v_add_f32 v75, 1.0, v75
Mvaa 172,140,72
buffer_load_dwordx4 a[32:35], v2, s[8:11], s63 offen offset:0
Mvaa 176,128,76
Ta 152,7,12288
Ta 154,7,14336
Mvaa 180,132,76
buffer_load_dwordx4 a[36:39], v2, s[8:11], s63 offen offset:1024
Mvaa 184,136,76
v_add_f32 v76, 1.0, v76
v_add_f32 v77, 1.0, v77
v_add_f32 v78, 1.0, v78
Mvaa 188,140,76
v_add_f32 v79, 1.0, v79
v_rcp_f32 v72, v72
Mvaa 192,128,80
buffer_load_dwordx4 a[40:43], v2, s[8:11], s63 offen offset:2048
Mvaa 196,132,80
Ta 156,8,12288
Ta 158,8,14336
Mvaa 200,136,80
buffer_load_dwordx4 a[44:47], v2, s[8:11], s63 offen offset:3072
Mvaa 204,140,80
v_rcp_f32 v73, v73
Mvaa 208,128,84
v_rcp_f32 v74, v74
Mvaa 212,132,84
buffer_load_dwordx4 a[48:51], v3, s[8:11], s63 offen offset:0
Mvaa 216,136,84
v_rcp_f32 v75, v75
Mvaa 220,140,84
buffer_load_dwordx4 a[52:55], v3, s[8:11], s63 offen offset:1024
Mvaa 224,128,88
v_rcp_f32 v76, v76
Mvaa 228,132,88
v_rcp_f32 v77, v77
Mvaa 232,136,88
buffer_load_dwordx4 a[56:59], v3, s[8:11], s63 offen offset:2048
Mvaa 236,140,88
v_rcp_f32 v78, v78
Mvaa 240,128,92
buffer_load_dwordx4 a[60:63], v3, s[8:11], s63 offen offset:3072
Mvaa 244,132,92
s_add_u32 s63, s5, 22
s_and_b32 s63, s63, 7
s_or_b32 s63, s63, 16
s_lshl_b32 s63, s63, 13
Mvaa 248,136,92
v_rcp_f32 v79, v79
Vm 48,48,72
Mvaa 252,140,92
Vm 49,49,73
Vm 50,50,74
Vm 51,51,75
s_waitcnt vmcnt(24) lgkmcnt(0)
Mvaa 128,144,96
s_add_u32 m0, s35, 12288
Mvaa 132,148,96
buffer_load_dwordx4 v4, s[12:15], s48 offen offset:0 lds
Mvaa 136,152,96
Ta 128,5,0
Ta 130,5,2048
Mvaa 140,156,96
buffer_load_dwordx4 v4, s[12:15], s49 offen offset:1024 lds
Mvaa 144,144,100
Vm 52,52,76
Vm 53,53,77
Vm 54,54,78
Mvaa 148,148,100
Vm 55,55,79
Vc 72,48,49
v_lshlrev_b32 v48, 16, v72
Mvaa 152,152,100
buffer_load_dwordx4 v4, s[12:15], s50 offen offset:2048 lds
Mvaa 156,156,100
Ta 132,6,0
Ta 134,6,2048
Mvaa 160,144,104
buffer_load_dwordx4 v4, s[12:15], s51 offen offset:3072 lds
Mvaa 164,148,104
s_add_u32 s4, s5, 24
s_and_b32 s4, s4, 7
s_or_b32 s4, s4, 24
s_lshl_b32 s4, s4, 16
v_add_u32 v4, s4, v123
Mvaa 168,152,104
v_and_b32 v49, 0xffff0000, v72
Vc 73,50,51
v_lshlrev_b32 v50, 16, v73
Mvaa 172,156,104
buffer_load_dwordx4 a[64:67], v2, s[8:11], s63 offen offset:0
Mvaa 176,144,108
Ta 136,7,0
Ta 138,7,2048
Mvaa 180,148,108
buffer_load_dwordx4 a[68:71], v2, s[8:11], s63 offen offset:1024
Mvaa 184,152,108
v_and_b32 v51, 0xffff0000, v73
Vc 74,52,53
v_lshlrev_b32 v52, 16, v74
Mvaa 188,156,108
v_and_b32 v53, 0xffff0000, v74
Vc 75,54,55
v_lshlrev_b32 v54, 16, v75
Mvaa 192,144,112
buffer_load_dwordx4 a[72:75], v2, s[8:11], s63 offen offset:2048
Mvaa 196,148,112
Ta 140,8,0
Ta 142,8,2048
Mvaa 200,152,112
buffer_load_dwordx4 a[76:79], v2, s[8:11], s63 offen offset:3072
Mvaa 204,156,112
v_and_b32 v55, 0xffff0000, v75
Mvaa 208,144,116
s_mov_b64 exec, 1
buffer_atomic_add v102, v103, s[40:43], s38 offen sc1
s_mov_b64 exec, -1
Mvaa 212,148,116
buffer_load_dwordx4 a[80:83], v3, s[8:11], s63 offen offset:0
Mvaa 216,152,116
v_lshlrev_b32 v56, 16, v24
v_and_b32 v57, 0xffff0000, v24
v_lshlrev_b32 v58, 16, v25
Mvaa 220,156,116
buffer_load_dwordx4 a[84:87], v3, s[8:11], s63 offen offset:1024
Mvaa 224,144,120
v_and_b32 v59, 0xffff0000, v25
v_lshlrev_b32 v60, 16, v26
v_and_b32 v61, 0xffff0000, v26
Mvaa 228,148,120
v_lshlrev_b32 v62, 16, v27
v_and_b32 v63, 0xffff0000, v27
Vs 56,56,36
Mvaa 232,152,120
buffer_load_dwordx4 a[88:91], v3, s[8:11], s63 offen offset:2048
Mvaa 236,156,120
Vs 57,57,36
Vs 58,58,36
Vs 59,59,36
Mvaa 240,144,124
buffer_load_dwordx4 a[92:95], v3, s[8:11], s63 offen offset:3072
Mvaa 244,148,124
s_add_u32 s63, s5, 23
s_and_b32 s63, s63, 7
s_or_b32 s63, s63, 16
s_lshl_b32 s63, s63, 13
Mvaa 248,152,124
Vs 60,60,36
Vs 61,61,36
Vs 62,62,36
Mvaa 252,156,124
Vs 63,63,36
Vc 72,56,57
v_lshlrev_b32 v56, 16, v72
s_waitcnt vmcnt(25) lgkmcnt(0)
Mvaa 128,128,0
s_add_u32 m0, s35, 0
Mvaa 132,132,0
buffer_load_dwordx4 v4, s[12:15], s48 offen offset:0 lds
Mvaa 136,136,0
Ta 144,5,4096
Ta 146,5,6144
Mvaa 140,140,0
buffer_load_dwordx4 v4, s[12:15], s49 offen offset:1024 lds
Mvaa 144,128,4
v_and_b32 v57, 0xffff0000, v72
Vc 73,58,59
v_lshlrev_b32 v58, 16, v73
Mvaa 148,132,4
v_and_b32 v59, 0xffff0000, v73
Vc 74,60,61
v_lshlrev_b32 v60, 16, v74
Mvaa 152,136,4
buffer_load_dwordx4 v4, s[12:15], s50 offen offset:2048 lds
Mvaa 156,140,4
Ta 148,6,4096
Ta 150,6,6144
Mvaa 160,128,8
buffer_load_dwordx4 v4, s[12:15], s51 offen offset:3072 lds
Mvaa 164,132,8
s_add_u32 s4, s5, 25
s_and_b32 s4, s4, 7
s_or_b32 s4, s4, 24
s_lshl_b32 s4, s4, 16
v_add_u32 v4, s4, v123
Mvaa 168,136,8
v_and_b32 v61, 0xffff0000, v74
Vc 75,62,63
v_lshlrev_b32 v62, 16, v75
Mvaa 172,140,8
buffer_load_dwordx4 a[96:99], v2, s[8:11], s63 offen offset:0
Mvaa 176,128,12
Ta 152,7,4096
Ta 154,7,6144
Mvaa 180,132,12
buffer_load_dwordx4 a[100:103], v2, s[8:11], s63 offen offset:1024
Mvaa 184,136,12
v_and_b32 v63, 0xffff0000, v75
Vm 56,56,37
Vm 57,57,37
Mvaa 188,140,12
Vm 58,58,37
Vm 59,59,37
Vm 60,60,37
Mvaa 192,128,16
buffer_load_dwordx4 a[104:107], v2, s[8:11], s63 offen offset:2048
Mvaa 196,132,16
Ta 156,8,4096
Ta 158,8,6144
Mvaa 200,136,16
buffer_load_dwordx4 a[108:111], v2, s[8:11], s63 offen offset:3072
Mvaa 204,140,16
Vm 61,61,37
Vm 62,62,37
Vm 63,63,37
Mvaa 208,128,20
Vc 72,56,57
v_lshlrev_b32 v56, 16, v72
v_and_b32 v57, 0xffff0000, v72
Mvaa 212,132,20
buffer_load_dwordx4 a[112:115], v3, s[8:11], s63 offen offset:0
Mvaa 216,136,20
Vc 73,58,59
v_lshlrev_b32 v58, 16, v73
v_and_b32 v59, 0xffff0000, v73
Mvaa 220,140,20
buffer_load_dwordx4 a[116:119], v3, s[8:11], s63 offen offset:1024
Mvaa 224,128,24
Vc 74,60,61
v_lshlrev_b32 v60, 16, v74
v_and_b32 v61, 0xffff0000, v74
Mvaa 228,132,24
Vc 75,62,63
v_lshlrev_b32 v62, 16, v75
v_and_b32 v63, 0xffff0000, v75
Mvaa 232,136,24
buffer_load_dwordx4 a[120:123], v3, s[8:11], s63 offen offset:2048
Mvaa 236,140,24
v_mul_f32 v72, 0xbfb8aa3b, v56
v_mul_f32 v73, 0xbfb8aa3b, v57
v_mul_f32 v74, 0xbfb8aa3b, v58
Mvaa 240,128,28
buffer_load_dwordx4 a[124:127], v3, s[8:11], s63 offen offset:3072
Mvaa 244,132,28
s_add_u32 s63, s5, 24
s_and_b32 s63, s63, 7
s_or_b32 s63, s63, 24
s_lshl_b32 s63, s63, 13
Mvaa 248,136,28
v_mul_f32 v75, 0xbfb8aa3b, v59
v_mul_f32 v76, 0xbfb8aa3b, v60
v_mul_f32 v77, 0xbfb8aa3b, v61
Mvaa 252,140,28
v_mul_f32 v78, 0xbfb8aa3b, v62
v_mul_f32 v79, 0xbfb8aa3b, v63
s_waitcnt vmcnt(25) lgkmcnt(0)
Mvaa 128,144,32
s_add_u32 m0, s35, 4096
Mvaa 132,148,32
buffer_load_dwordx4 v4, s[12:15], s48 offen offset:0 lds
Mvaa 136,152,32
Ta 128,5,8192
Ta 130,5,10240
Mvaa 140,156,32
buffer_load_dwordx4 v4, s[12:15], s49 offen offset:1024 lds
Mvaa 144,144,36
Ve 72,72
Mvaa 148,148,36
Ve 73,73
Mvaa 152,152,36
buffer_load_dwordx4 v4, s[12:15], s50 offen offset:2048 lds
Mvaa 156,156,36
Ta 132,6,8192
Ta 134,6,10240
Mvaa 160,144,40
buffer_load_dwordx4 v4, s[12:15], s51 offen offset:3072 lds
Mvaa 164,148,40
s_add_u32 s4, s5, 26
s_and_b32 s4, s4, 7
s_or_b32 s4, s4, 24
s_lshl_b32 s4, s4, 16
v_add_u32 v4, s4, v123
Mvaa 168,152,40
Ve 74,74
Mvaa 172,156,40
buffer_load_dwordx4 a[0:3], v2, s[8:11], s63 offen offset:0
Mvaa 176,144,44
Ta 136,7,8192
Ta 138,7,10240
Mvaa 180,148,44
buffer_load_dwordx4 a[4:7], v2, s[8:11], s63 offen offset:1024
Mvaa 184,152,44
Ve 75,75
Mvaa 188,156,44
Ve 76,76
Mvaa 192,144,48
buffer_load_dwordx4 a[8:11], v2, s[8:11], s63 offen offset:2048
Mvaa 196,148,48
Ta 140,8,8192
Ta 142,8,10240
Mvaa 200,152,48
buffer_load_dwordx4 a[12:15], v2, s[8:11], s63 offen offset:3072
Mvaa 204,156,48
Ve 77,77
Mvaa 208,144,52
Ve 78,78
Mvaa 212,148,52
buffer_load_dwordx4 a[16:19], v3, s[8:11], s63 offen offset:0
Mvaa 216,152,52
Ve 79,79
v_add_f32 v72, 1.0, v72
Mvaa 220,156,52
buffer_load_dwordx4 a[20:23], v3, s[8:11], s63 offen offset:1024
Mvaa 224,144,56
v_add_f32 v73, 1.0, v73
v_add_f32 v74, 1.0, v74
v_add_f32 v75, 1.0, v75
Mvaa 228,148,56
v_add_f32 v76, 1.0, v76
v_add_f32 v77, 1.0, v77
v_add_f32 v78, 1.0, v78
Mvaa 232,152,56
buffer_load_dwordx4 a[24:27], v3, s[8:11], s63 offen offset:2048
Mvaa 236,156,56
v_add_f32 v79, 1.0, v79
v_rcp_f32 v72, v72
Mvaa 240,144,60
buffer_load_dwordx4 a[28:31], v3, s[8:11], s63 offen offset:3072
Mvaa 244,148,60
s_add_u32 s63, s5, 25
s_and_b32 s63, s63, 7
s_or_b32 s63, s63, 24
s_lshl_b32 s63, s63, 13
Mvaa 248,152,60
v_rcp_f32 v73, v73
Mvaa 252,156,60
v_rcp_f32 v74, v74
s_waitcnt vmcnt(24) lgkmcnt(0)
Mvaa 128,128,64
s_add_u32 m0, s35, 8192
Mvaa 132,132,64
buffer_load_dwordx4 v4, s[12:15], s48 offen offset:0 lds
Mvaa 136,136,64
Ta 144,5,12288
Ta 146,5,14336
Mvaa 140,140,64
buffer_load_dwordx4 v4, s[12:15], s49 offen offset:1024 lds
Mvaa 144,128,68
v_rcp_f32 v75, v75
Mvaa 148,132,68
v_rcp_f32 v76, v76
Mvaa 152,136,68
buffer_load_dwordx4 v4, s[12:15], s50 offen offset:2048 lds
Mvaa 156,140,68
Ta 148,6,12288
Ta 150,6,14336
Mvaa 160,128,72
buffer_load_dwordx4 v4, s[12:15], s51 offen offset:3072 lds
Mvaa 164,132,72
s_add_u32 s4, s5, 27
s_and_b32 s4, s4, 7
s_or_b32 s4, s4, 24
s_lshl_b32 s4, s4, 16
v_add_u32 v4, s4, v123
Mvaa 168,136,72
v_rcp_f32 v77, v77
Mvaa 172,140,72
buffer_load_dwordx4 a[32:35], v2, s[8:11], s63 offen offset:0
Mvaa 176,128,76
Ta 152,7,12288
Ta 154,7,14336
Mvaa 180,132,76
buffer_load_dwordx4 a[36:39], v2, s[8:11], s63 offen offset:1024
Mvaa 184,136,76
v_rcp_f32 v78, v78
Mvaa 188,140,76
v_rcp_f32 v79, v79
Vm 56,56,72
Mvaa 192,128,80
buffer_load_dwordx4 a[40:43], v2, s[8:11], s63 offen offset:2048
Mvaa 196,132,80
Ta 156,8,12288
Ta 158,8,14336
Mvaa 200,136,80
buffer_load_dwordx4 a[44:47], v2, s[8:11], s63 offen offset:3072
Mvaa 204,140,80
Vm 57,57,73
Vm 58,58,74
Vm 59,59,75
Mvaa 208,128,84
Vm 60,60,76
Vm 61,61,77
Vm 62,62,78
Mvaa 212,132,84
buffer_load_dwordx4 a[48:51], v3, s[8:11], s63 offen offset:0
Mvaa 216,136,84
Vm 63,63,79
Vc 72,56,57
v_lshlrev_b32 v56, 16, v72
Mvaa 220,140,84
buffer_load_dwordx4 a[52:55], v3, s[8:11], s63 offen offset:1024
Mvaa 224,128,88
v_and_b32 v57, 0xffff0000, v72
Vc 73,58,59
v_lshlrev_b32 v58, 16, v73
Mvaa 228,132,88
v_and_b32 v59, 0xffff0000, v73
Vc 74,60,61
v_lshlrev_b32 v60, 16, v74
Mvaa 232,136,88
buffer_load_dwordx4 a[56:59], v3, s[8:11], s63 offen offset:2048
Mvaa 236,140,88
v_and_b32 v61, 0xffff0000, v74
Vc 75,62,63
v_lshlrev_b32 v62, 16, v75
Mvaa 240,128,92
buffer_load_dwordx4 a[60:63], v3, s[8:11], s63 offen offset:3072
Mvaa 244,132,92
s_add_u32 s63, s5, 26
s_and_b32 s63, s63, 7
s_or_b32 s63, s63, 24
s_lshl_b32 s63, s63, 13
Mvaa 248,136,92
v_and_b32 v63, 0xffff0000, v75
v_lshlrev_b32 v64, 16, v28
v_and_b32 v65, 0xffff0000, v28
Mvaa 252,140,92
v_lshlrev_b32 v66, 16, v29
v_and_b32 v67, 0xffff0000, v29
v_lshlrev_b32 v68, 16, v30
s_waitcnt vmcnt(24) lgkmcnt(0)
Mvaa 128,144,96
s_add_u32 m0, s35, 12288
Mvaa 132,148,96
buffer_load_dwordx4 v4, s[12:15], s48 offen offset:0 lds
Mvaa 136,152,96
Ta 128,5,0
Ta 130,5,2048
Mvaa 140,156,96
buffer_load_dwordx4 v4, s[12:15], s49 offen offset:1024 lds
Mvaa 144,144,100
v_and_b32 v69, 0xffff0000, v30
v_lshlrev_b32 v70, 16, v31
v_and_b32 v71, 0xffff0000, v31
Mvaa 148,148,100
Vs 64,64,38
Vs 65,65,38
Vs 66,66,38
Mvaa 152,152,100
buffer_load_dwordx4 v4, s[12:15], s50 offen offset:2048 lds
Mvaa 156,156,100
Ta 132,6,0
Ta 134,6,2048
Mvaa 160,144,104
buffer_load_dwordx4 v4, s[12:15], s51 offen offset:3072 lds
Mvaa 164,148,104
s_add_u32 s4, s5, 28
s_and_b32 s4, s4, 7
s_or_b32 s4, s4, 24
s_lshl_b32 s4, s4, 16
v_add_u32 v4, s4, v123
Mvaa 168,152,104
Vs 67,67,38
Vs 68,68,38
Vs 69,69,38
Mvaa 172,156,104
buffer_load_dwordx4 a[64:67], v2, s[8:11], s63 offen offset:0
Mvaa 176,144,108
Ta 136,7,0
Ta 138,7,2048
Mvaa 180,148,108
buffer_load_dwordx4 a[68:71], v2, s[8:11], s63 offen offset:1024
Mvaa 184,152,108
Vs 70,70,38
Vs 71,71,38
Vc 72,64,65
Mvaa 188,156,108
v_lshlrev_b32 v64, 16, v72
v_and_b32 v65, 0xffff0000, v72
Vc 73,66,67
Mvaa 192,144,112
buffer_load_dwordx4 a[72:75], v2, s[8:11], s63 offen offset:2048
Mvaa 196,148,112
Ta 140,8,0
Ta 142,8,2048
Mvaa 200,152,112
buffer_load_dwordx4 a[76:79], v2, s[8:11], s63 offen offset:3072
Mvaa 204,156,112
v_lshlrev_b32 v66, 16, v73
v_and_b32 v67, 0xffff0000, v73
Vc 74,68,69
Mvaa 208,144,116
v_lshlrev_b32 v68, 16, v74
v_and_b32 v69, 0xffff0000, v74
Vc 75,70,71
Mvaa 212,148,116
buffer_load_dwordx4 a[80:83], v3, s[8:11], s63 offen offset:0
Mvaa 216,152,116
v_lshlrev_b32 v70, 16, v75
v_and_b32 v71, 0xffff0000, v75
Vm 64,64,39
Mvaa 220,156,116
buffer_load_dwordx4 a[84:87], v3, s[8:11], s63 offen offset:1024
Mvaa 224,144,120
Vm 65,65,39
Vm 66,66,39
Vm 67,67,39
Mvaa 228,148,120
Vm 68,68,39
Vm 69,69,39
Vm 70,70,39
Mvaa 232,152,120
buffer_load_dwordx4 a[88:91], v3, s[8:11], s63 offen offset:2048
Mvaa 236,156,120
Vm 71,71,39
Vc 72,64,65
v_lshlrev_b32 v64, 16, v72
Mvaa 240,144,124
buffer_load_dwordx4 a[92:95], v3, s[8:11], s63 offen offset:3072
Mvaa 244,148,124
s_add_u32 s63, s5, 27
s_and_b32 s63, s63, 7
s_or_b32 s63, s63, 24
s_lshl_b32 s63, s63, 13
Mvaa 248,152,124
v_and_b32 v65, 0xffff0000, v72
Vc 73,66,67
v_lshlrev_b32 v66, 16, v73
Mvaa 252,156,124
v_and_b32 v67, 0xffff0000, v73
Vc 74,68,69
v_lshlrev_b32 v68, 16, v74
s_waitcnt vmcnt(24) lgkmcnt(0)
Mvaa 128,128,0
s_add_u32 m0, s35, 0
Mvaa 132,132,0
buffer_load_dwordx4 v4, s[12:15], s48 offen offset:0 lds
Mvaa 136,136,0
Ta 144,5,4096
Ta 146,5,6144
Mvaa 140,140,0
buffer_load_dwordx4 v4, s[12:15], s49 offen offset:1024 lds
Mvaa 144,128,4
v_and_b32 v69, 0xffff0000, v74
Vc 75,70,71
v_lshlrev_b32 v70, 16, v75
Mvaa 148,132,4
v_and_b32 v71, 0xffff0000, v75
v_mul_f32 v72, 0xbfb8aa3b, v64
v_mul_f32 v73, 0xbfb8aa3b, v65
Mvaa 152,136,4
buffer_load_dwordx4 v4, s[12:15], s50 offen offset:2048 lds
Mvaa 156,140,4
Ta 148,6,4096
Ta 150,6,6144
Mvaa 160,128,8
buffer_load_dwordx4 v4, s[12:15], s51 offen offset:3072 lds
Mvaa 164,132,8
s_add_u32 s4, s5, 29
s_and_b32 s4, s4, 7
s_or_b32 s4, s4, 24
s_lshl_b32 s4, s4, 16
v_add_u32 v4, s4, v123
Mvaa 168,136,8
v_mul_f32 v74, 0xbfb8aa3b, v66
v_mul_f32 v75, 0xbfb8aa3b, v67
v_mul_f32 v76, 0xbfb8aa3b, v68
Mvaa 172,140,8
buffer_load_dwordx4 a[96:99], v2, s[8:11], s63 offen offset:0
Mvaa 176,128,12
Ta 152,7,4096
Ta 154,7,6144
Mvaa 180,132,12
buffer_load_dwordx4 a[100:103], v2, s[8:11], s63 offen offset:1024
Mvaa 184,136,12
v_mul_f32 v77, 0xbfb8aa3b, v69
v_mul_f32 v78, 0xbfb8aa3b, v70
v_mul_f32 v79, 0xbfb8aa3b, v71
Mvaa 188,140,12
Ve 72,72
Mvaa 192,128,16
buffer_load_dwordx4 a[104:107], v2, s[8:11], s63 offen offset:2048
Mvaa 196,132,16
Ta 156,8,4096
Ta 158,8,6144
Mvaa 200,136,16
buffer_load_dwordx4 a[108:111], v2, s[8:11], s63 offen offset:3072
Mvaa 204,140,16
Ve 73,73
Mvaa 208,128,20
Ve 74,74
Mvaa 212,132,20
buffer_load_dwordx4 a[112:115], v3, s[8:11], s63 offen offset:0
Mvaa 216,136,20
Ve 75,75
Mvaa 220,140,20
buffer_load_dwordx4 a[116:119], v3, s[8:11], s63 offen offset:1024
Mvaa 224,128,24
Ve 76,76
Mvaa 228,132,24
Ve 77,77
Mvaa 232,136,24
buffer_load_dwordx4 a[120:123], v3, s[8:11], s63 offen offset:2048
Mvaa 236,140,24
Ve 78,78
Mvaa 240,128,28
buffer_load_dwordx4 a[124:127], v3, s[8:11], s63 offen offset:3072
Mvaa 244,132,28
s_add_u32 s63, s5, 28
s_and_b32 s63, s63, 7
s_or_b32 s63, s63, 24
s_lshl_b32 s63, s63, 13
Mvaa 248,136,28
Ve 79,79
v_add_f32 v72, 1.0, v72
Mvaa 252,140,28
v_add_f32 v73, 1.0, v73
v_add_f32 v74, 1.0, v74
v_add_f32 v75, 1.0, v75
s_waitcnt vmcnt(24) lgkmcnt(0)
Mvaa 128,144,32
s_add_u32 m0, s35, 4096
Mvaa 132,148,32
buffer_load_dwordx4 v4, s[12:15], s48 offen offset:0 lds
Mvaa 136,152,32
Ta 128,5,8192
Ta 130,5,10240
Mvaa 140,156,32
buffer_load_dwordx4 v4, s[12:15], s49 offen offset:1024 lds
Mvaa 144,144,36
v_add_f32 v76, 1.0, v76
v_add_f32 v77, 1.0, v77
v_add_f32 v78, 1.0, v78
Mvaa 148,148,36
v_add_f32 v79, 1.0, v79
v_rcp_f32 v72, v72
Mvaa 152,152,36
buffer_load_dwordx4 v4, s[12:15], s50 offen offset:2048 lds
Mvaa 156,156,36
Ta 132,6,8192
Ta 134,6,10240
Mvaa 160,144,40
buffer_load_dwordx4 v4, s[12:15], s51 offen offset:3072 lds
Mvaa 164,148,40
s_add_u32 s4, s5, 30
s_and_b32 s4, s4, 7
s_or_b32 s4, s4, 24
s_lshl_b32 s4, s4, 16
v_add_u32 v4, s4, v123
Mvaa 168,152,40
v_rcp_f32 v73, v73
Mvaa 172,156,40
buffer_load_dwordx4 a[0:3], v2, s[8:11], s63 offen offset:0
Mvaa 176,144,44
Ta 136,7,8192
Ta 138,7,10240
Mvaa 180,148,44
buffer_load_dwordx4 a[4:7], v2, s[8:11], s63 offen offset:1024
Mvaa 184,152,44
v_rcp_f32 v74, v74
Mvaa 188,156,44
v_rcp_f32 v75, v75
Mvaa 192,144,48
buffer_load_dwordx4 a[8:11], v2, s[8:11], s63 offen offset:2048
Mvaa 196,148,48
Ta 140,8,8192
Ta 142,8,10240
Mvaa 200,152,48
buffer_load_dwordx4 a[12:15], v2, s[8:11], s63 offen offset:3072
Mvaa 204,156,48
v_rcp_f32 v76, v76
Mvaa 208,144,52
v_rcp_f32 v77, v77
Mvaa 212,148,52
buffer_load_dwordx4 a[16:19], v3, s[8:11], s63 offen offset:0
Mvaa 216,152,52
v_rcp_f32 v78, v78
Mvaa 220,156,52
buffer_load_dwordx4 a[20:23], v3, s[8:11], s63 offen offset:1024
Mvaa 224,144,56
v_rcp_f32 v79, v79
Vm 64,64,72
Mvaa 228,148,56
Vm 65,65,73
Vm 66,66,74
Vm 67,67,75
Mvaa 232,152,56
buffer_load_dwordx4 a[24:27], v3, s[8:11], s63 offen offset:2048
Mvaa 236,156,56
Vm 68,68,76
Vm 69,69,77
Vm 70,70,78
Mvaa 240,144,60
buffer_load_dwordx4 a[28:31], v3, s[8:11], s63 offen offset:3072
Mvaa 244,148,60
s_add_u32 s63, s5, 29
s_and_b32 s63, s63, 7
s_or_b32 s63, s63, 24
s_lshl_b32 s63, s63, 13
Mvaa 248,152,60
Vm 71,71,79
Vc 72,64,65
v_lshlrev_b32 v64, 16, v72
Mvaa 252,156,60
v_and_b32 v65, 0xffff0000, v72
Vc 73,66,67
v_lshlrev_b32 v66, 16, v73
s_waitcnt vmcnt(24) lgkmcnt(0)
Mvaa 128,128,64
s_add_u32 m0, s35, 8192
Mvaa 132,132,64
buffer_load_dwordx4 v4, s[12:15], s48 offen offset:0 lds
Mvaa 136,136,64
Ta 144,5,12288
Ta 146,5,14336
Mvaa 140,140,64
buffer_load_dwordx4 v4, s[12:15], s49 offen offset:1024 lds
Mvaa 144,128,68
v_and_b32 v67, 0xffff0000, v73
Vc 74,68,69
v_lshlrev_b32 v68, 16, v74
Mvaa 148,132,68
v_and_b32 v69, 0xffff0000, v74
Vc 75,70,71
v_lshlrev_b32 v70, 16, v75
Mvaa 152,136,68
buffer_load_dwordx4 v4, s[12:15], s50 offen offset:2048 lds
Mvaa 156,140,68
Ta 148,6,12288
Ta 150,6,14336
Mvaa 160,128,72
buffer_load_dwordx4 v4, s[12:15], s51 offen offset:3072 lds
Mvaa 164,132,72
s_add_u32 s4, s5, 31
s_and_b32 s4, s4, 7
s_or_b32 s4, s4, 24
s_lshl_b32 s4, s4, 16
v_add_u32 v4, s4, v123
Mvaa 168,136,72
v_and_b32 v71, 0xffff0000, v75
Mvaa 172,140,72
buffer_load_dwordx4 a[32:35], v2, s[8:11], s63 offen offset:0
Mvaa 176,128,76
Ta 152,7,12288
Ta 154,7,14336
Mvaa 180,132,76
buffer_load_dwordx4 a[36:39], v2, s[8:11], s63 offen offset:1024
Mvaa 184,136,76
s_lshr_b32 s3, s52, 7
s_lshr_b32 s62, s53, 7
s_cmp_eq_u32 s3, s33
s_cselect_b32 s44, 1, 0
s_cmp_eq_u32 s62, s33
s_cselect_b32 s44, 1, s44
s_lshl_b32 s45, s34, 4
Mvaa 188,140,76
v_lshlrev_b32 v15, 10, v14
v_lshl_add_u32 v15, v13, 5, v15
Mvaa 192,128,80
buffer_load_dwordx4 a[40:43], v2, s[8:11], s63 offen offset:2048
Mvaa 196,132,80
Ta 156,8,12288
Ta 158,8,14336
Mvaa 200,136,80
buffer_load_dwordx4 a[44:47], v2, s[8:11], s63 offen offset:3072
Mvaa 204,140,80
buffer_load_dword v102, v103, s[40:43], s45 offen sc1
s_waitcnt vmcnt(0)
Mvaa 208,128,84
v_readfirstlane_b32 s46, v102
s_lshl_b32 s47, s34, 13
s_add_u32 s47, s47, 5308416
s_cmp_ge_u32 s46, 16
s_cselect_b32 s46, s44, 0
s_cmp_lg_u32 s46, 0
s_cselect_b32 s3, s47, 0x7ff00000
Mvaa 212,132,84
buffer_load_dwordx4 a[48:51], v3, s[8:11], s63 offen offset:0
Mvaa 216,136,84
buffer_load_dwordx4 v[80:83], v15, s[16:19], s3 offen offset:0 sc1
Mvaa 220,140,84
buffer_load_dwordx4 a[52:55], v3, s[8:11], s63 offen offset:1024
Mvaa 224,128,88
buffer_load_dwordx4 v[84:87], v15, s[16:19], s3 offen offset:16 sc1
Mvaa 228,132,88
buffer_load_dwordx4 v[88:91], v15, s[16:19], s3 offen offset:256 sc1
Mvaa 232,136,88
buffer_load_dwordx4 a[56:59], v3, s[8:11], s63 offen offset:2048
Mvaa 236,140,88
buffer_load_dwordx4 v[92:95], v15, s[16:19], s3 offen offset:272 sc1
Mvaa 240,128,92
buffer_load_dwordx4 a[60:63], v3, s[8:11], s63 offen offset:3072
Mvaa 244,132,92
s_add_u32 s63, s5, 30
s_and_b32 s63, s63, 7
s_or_b32 s63, s63, 24
s_lshl_b32 s63, s63, 13
Mvaa 248,136,92
buffer_load_dwordx4 v[96:99], v15, s[16:19], s3 offen offset:512 sc1
Mvaa 252,140,92
buffer_load_dwordx4 v[100:103], v15, s[16:19], s3 offen offset:528 sc1
s_waitcnt lgkmcnt(0)
Mvaa 128,144,96
s_add_u32 m0, s35, 12288
Mvaa 132,148,96
buffer_load_dwordx4 v4, s[12:15], s48 offen offset:0 lds
Mvaa 136,152,96
Ta 128,5,0
Ta 130,5,2048
Mvaa 140,156,96
buffer_load_dwordx4 v4, s[12:15], s49 offen offset:1024 lds
Mvaa 144,144,100
buffer_load_dwordx4 v[104:107], v15, s[16:19], s3 offen offset:768 sc1
Mvaa 148,148,100
buffer_load_dwordx4 v[108:111], v15, s[16:19], s3 offen offset:784 sc1
Mvaa 152,152,100
buffer_load_dwordx4 v4, s[12:15], s50 offen offset:2048 lds
Mvaa 156,156,100
Ta 132,6,0
Ta 134,6,2048
Mvaa 160,144,104
buffer_load_dwordx4 v4, s[12:15], s51 offen offset:3072 lds
Mvaa 164,148,104
s_add_u32 s4, s5, 32
s_and_b32 s4, s4, 7
s_or_b32 s4, s4, 32
s_lshl_b32 s4, s4, 16
v_add_u32 v4, s4, v123
Mvaa 168,152,104
Mvaa 172,156,104
buffer_load_dwordx4 a[64:67], v2, s[8:11], s63 offen offset:0
Mvaa 176,144,108
Ta 136,7,0
Ta 138,7,2048
Mvaa 180,148,108
buffer_load_dwordx4 a[68:71], v2, s[8:11], s63 offen offset:1024
Mvaa 184,152,108
Mvaa 188,156,108
Mvaa 192,144,112
buffer_load_dwordx4 a[72:75], v2, s[8:11], s63 offen offset:2048
Mvaa 196,148,112
Ta 140,8,0
Ta 142,8,2048
Mvaa 200,152,112
buffer_load_dwordx4 a[76:79], v2, s[8:11], s63 offen offset:3072
Mvaa 204,156,112
Mvaa 208,144,116
Mvaa 212,148,116
buffer_load_dwordx4 a[80:83], v3, s[8:11], s63 offen offset:0
Mvaa 216,152,116
Mvaa 220,156,116
buffer_load_dwordx4 a[84:87], v3, s[8:11], s63 offen offset:1024
Mvaa 224,144,120
Mvaa 228,148,120
Mvaa 232,152,120
buffer_load_dwordx4 a[88:91], v3, s[8:11], s63 offen offset:2048
Mvaa 236,156,120
Mvaa 240,144,124
buffer_load_dwordx4 a[92:95], v3, s[8:11], s63 offen offset:3072
Mvaa 244,148,124
s_add_u32 s63, s5, 31
s_and_b32 s63, s63, 7
s_or_b32 s63, s63, 24
s_lshl_b32 s63, s63, 13
Mvaa 248,152,124
Mvaa 252,156,124
s_waitcnt lgkmcnt(0)
Mvaa 128,128,0
s_waitcnt vmcnt(10)
s_cmp_lg_u32 s46, 0
s_cbranch_scc1 L_k3_selA
L_k3_selAr:
Mvaa 132,132,0
buffer_load_dwordx4 a[96:99], v2, s[8:11], s63 offen offset:0
Mvaa 136,136,0
Ta 144,5,4096
Ta 146,5,6144
Mvaa 140,140,0
buffer_load_dwordx4 a[100:103], v2, s[8:11], s63 offen offset:1024
Mvaa 144,128,4
Mvaa 148,132,4
Mvaa 152,136,4
buffer_load_dwordx4 a[104:107], v2, s[8:11], s63 offen offset:2048
Mvaa 156,140,4
Ta 148,6,4096
Ta 150,6,6144
Mvaa 160,128,8
buffer_load_dwordx4 a[108:111], v2, s[8:11], s63 offen offset:3072
Mvaa 164,132,8
Mvaa 168,136,8
Mvaa 172,140,8
buffer_load_dwordx4 a[112:115], v3, s[8:11], s63 offen offset:0
Mvaa 176,128,12
Ta 152,7,4096
Ta 154,7,6144
Mvaa 180,132,12
buffer_load_dwordx4 a[116:119], v3, s[8:11], s63 offen offset:1024
Mvaa 184,136,12
Mvaa 188,140,12
Mvaa 192,128,16
buffer_load_dwordx4 a[120:123], v3, s[8:11], s63 offen offset:2048
Mvaa 196,132,16
Ta 156,8,4096
Ta 158,8,6144
Mvaa 200,136,16
buffer_load_dwordx4 a[124:127], v3, s[8:11], s63 offen offset:3072
Mvaa 204,140,16
s_add_u32 s63, s5, 32
s_and_b32 s63, s63, 7
s_or_b32 s63, s63, 32
s_lshl_b32 s63, s63, 13
Mvaa 208,128,20
Mvaa 212,132,20
Mvaa 216,136,20
Mvaa 220,140,20
Mvaa 224,128,24
Mvaa 228,132,24
Mvaa 232,136,24
Mvaa 236,140,24
Mvaa 240,128,28
Mvaa 244,132,28
Mvaa 248,136,28
Mvaa 252,140,28
s_waitcnt lgkmcnt(0)
Mvaa 128,144,32
Mvaa 132,148,32
Mvaa 136,152,32
Ta 128,5,8192
Ta 130,5,10240
Mvaa 140,156,32
Mvaa 144,144,36
Mvaa 148,148,36
Mvaa 152,152,36
Mvaa 156,156,36
Ta 132,6,8192
Ta 134,6,10240
Mvaa 160,144,40
Mvaa 164,148,40
Mvaa 168,152,40
Mvaa 172,156,40
Mvaa 176,144,44
Ta 136,7,8192
Ta 138,7,10240
Mvaa 180,148,44
Mvaa 184,152,44
Mvaa 188,156,44
Mvaa 192,144,48
Mvaa 196,148,48
Ta 140,8,8192
Ta 142,8,10240
Mvaa 200,152,48
Mvaa 204,156,48
Mvaa 208,144,52
Mvaa 212,148,52
Mvaa 216,152,52
Mvaa 220,156,52
Mvaa 224,144,56
Mvaa 228,148,56
Mvaa 232,152,56
Mvaa 236,156,56
Mvaa 240,144,60
Mvaa 244,148,60
Mvaa 248,152,60
Mvaa 252,156,60
s_waitcnt vmcnt(8) lgkmcnt(0)
Mvaa 128,128,64
Mvaa 132,132,64
Mvaa 136,136,64
Ta 144,5,12288
Ta 146,5,14336
Mvaa 140,140,64
Mvaa 144,128,68
Mvaa 148,132,68
Mvaa 152,136,68
Mvaa 156,140,68
Ta 148,6,12288
Ta 150,6,14336
Mvaa 160,128,72
Mvaa 164,132,72
Mvaa 168,136,72
Mvaa 172,140,72
Mvaa 176,128,76
Ta 152,7,12288
Ta 154,7,14336
Mvaa 180,132,76
Mvaa 184,136,76
Mvaa 188,140,76
Mvaa 192,128,80
Mvaa 196,132,80
Ta 156,8,12288
Ta 158,8,14336
Mvaa 200,136,80
Mvaa 204,140,80
Mvaa 208,128,84
Mvaa 212,132,84
Mvaa 216,136,84
Mvaa 220,140,84
Mvaa 224,128,88
Mvaa 228,132,88
Mvaa 232,136,88
Mvaa 236,140,88
Mvaa 240,128,92
Mvaa 244,132,92
Mvaa 248,136,92
Mvaa 252,140,92
s_waitcnt vmcnt(0) lgkmcnt(0)
Mvaa 128,144,96
Mvaa 132,148,96
Mvaa 136,152,96
Mvaa 140,156,96
Mvaa 144,144,100
Mvaa 148,148,100
Mvaa 152,152,100
Mvaa 156,156,100
Mvaa 160,144,104
Mvaa 164,148,104
Mvaa 168,152,104
Mvaa 172,156,104
Mvaa 176,144,108
Mvaa 180,148,108
Mvaa 184,152,108
Mvaa 188,156,108
Mvaa 192,144,112
Mvaa 196,148,112
Mvaa 200,152,112
Mvaa 204,156,112
Mvaa 208,144,116
Mvaa 212,148,116
Mvaa 216,152,116
Mvaa 220,156,116
Mvaa 224,144,120
Mvaa 228,148,120
Mvaa 232,152,120
Mvaa 236,156,120
Mvaa 240,144,124
Mvaa 244,148,124
Mvaa 248,152,124
Mvaa 252,156,124
s_waitcnt vmcnt(0) lgkmcnt(0)
v_and_b32 v1, 15, v0
v_lshlrev_b32 v11, 8, v1
v_add_u32 v11, s35, v11
v_xor_b32 v1, v1, v12
v_xor_b32 v15, 0, v1
v_lshl_add_u32 v5, v15, 4, v11
v_xor_b32 v15, 4, v1
v_lshl_add_u32 v6, v15, 4, v11
v_xor_b32 v15, 8, v1
v_lshl_add_u32 v7, v15, 4, v11
v_xor_b32 v15, 12, v1
v_lshl_add_u32 v8, v15, 4, v11
ds_write_b128 v5, v[128:131] offset:0
ds_write_b128 v6, v[132:135] offset:0
ds_write_b128 v7, v[136:139] offset:0
ds_write_b128 v8, v[140:143] offset:0
ds_write_b128 v5, v[144:147] offset:4096
ds_write_b128 v6, v[148:151] offset:4096
ds_write_b128 v7, v[152:155] offset:4096
ds_write_b128 v8, v[156:159] offset:4096
s_waitcnt lgkmcnt(4)
ds_write_b128 v5, v[160:163] offset:8192
ds_write_b128 v6, v[164:167] offset:8192
ds_write_b128 v7, v[168:171] offset:8192
ds_write_b128 v8, v[172:175] offset:8192
ds_write_b128 v5, v[176:179] offset:12288
ds_write_b128 v6, v[180:183] offset:12288
ds_write_b128 v7, v[184:187] offset:12288
ds_write_b128 v8, v[188:191] offset:12288
s_waitcnt lgkmcnt(4)
ds_write_b128 v5, v[192:195] offset:16384
ds_write_b128 v6, v[196:199] offset:16384
ds_write_b128 v7, v[200:203] offset:16384
ds_write_b128 v8, v[204:207] offset:16384
ds_write_b128 v5, v[208:211] offset:20480
ds_write_b128 v6, v[212:215] offset:20480
ds_write_b128 v7, v[216:219] offset:20480
ds_write_b128 v8, v[220:223] offset:20480
s_waitcnt lgkmcnt(4)
ds_write_b128 v5, v[224:227] offset:24576
ds_write_b128 v6, v[228:231] offset:24576
ds_write_b128 v7, v[232:235] offset:24576
ds_write_b128 v8, v[236:239] offset:24576
ds_write_b128 v5, v[240:243] offset:28672
ds_write_b128 v6, v[244:247] offset:28672
ds_write_b128 v7, v[248:251] offset:28672
ds_write_b128 v8, v[252:255] offset:28672
s_waitcnt lgkmcnt(4)
s_cmp_lg_u32 s44, s46
s_cbranch_scc1 L_k3_sel
L_k3_selr:
v_and_b32 v1, 15, v10
v_lshlrev_b32 v15, 1, v13
v_xor_b32 v1, v1, v15
v_lshlrev_b32 v11, 8, v10
v_lshl_add_u32 v2, v1, 4, v11
v_xor_b32 v3, 16, v2
v_add_u32 v4, 65536, v2
v_add_u32 v5, 65536, v3
s_waitcnt lgkmcnt(0)
s_barrier
Rv 128,2,0
Rv 132,3,0
Rv 136,2,32768
Rv 140,3,32768
Rv 144,4,0
Rv 148,5,0
Rv 152,4,32768
Rv 156,5,32768
s_waitcnt lgkmcnt(0)
Rv 160,2,8192
Rv 164,3,8192
Rv 168,2,40960
Rv 172,3,40960
Rv 176,4,8192
Rv 180,5,8192
Rv 184,4,40960
Rv 188,5,40960
Va 128,128,136
Va 144,144,152
Va 129,129,137
Va 145,145,153
Va 130,130,138
Va 146,146,154
Va 131,131,139
Va 147,147,155
Va 132,132,140
Va 148,148,156
Va 133,133,141
Va 149,149,157
Va 134,134,142
Va 150,150,158
Va 135,135,143
Va 151,151,159
Va 128,128,144
Va 129,129,145
Va 130,130,146
Va 131,131,147
Va 132,132,148
Va 133,133,149
Va 134,134,150
Va 135,135,151
Vc 136,128,129
v_lshlrev_b32 v128, 16, v136
v_and_b32 v129, 0xffff0000, v136
Vc 137,130,131
v_lshlrev_b32 v130, 16, v137
v_and_b32 v131, 0xffff0000, v137
Vc 138,132,133
v_lshlrev_b32 v132, 16, v138
v_and_b32 v133, 0xffff0000, v138
Vc 139,134,135
v_lshlrev_b32 v134, 16, v139
v_and_b32 v135, 0xffff0000, v139
Vm 128,128,40
Vm 129,129,41
Vm 130,130,42
Vm 131,131,43
Vm 132,132,44
Vm 133,133,45
Vm 134,134,46
Vm 135,135,47
Vc 136,128,129
v_lshlrev_b32 v128, 16, v136
v_and_b32 v129, 0xffff0000, v136
Vc 137,130,131
v_lshlrev_b32 v130, 16, v137
v_and_b32 v131, 0xffff0000, v137
Vc 138,132,133
v_lshlrev_b32 v132, 16, v138
v_and_b32 v133, 0xffff0000, v138
Vc 139,134,135
v_lshlrev_b32 v134, 16, v139
v_and_b32 v135, 0xffff0000, v139
v_lshlrev_b32 v144, 16, v16
v_and_b32 v145, 0xffff0000, v16
v_lshlrev_b32 v146, 16, v17
v_and_b32 v147, 0xffff0000, v17
v_lshlrev_b32 v148, 16, v18
v_and_b32 v149, 0xffff0000, v18
v_lshlrev_b32 v150, 16, v19
v_and_b32 v151, 0xffff0000, v19
Va 128,128,144
Va 129,129,145
Va 130,130,146
Va 131,131,147
Va 132,132,148
Va 133,133,149
Va 134,134,150
Va 135,135,151
Vc 136,128,129
Vc 137,130,131
Vc 138,132,133
Vc 139,134,135
buffer_store_dwordx4 v[136:139], v9, s[28:31], s36 offen
s_add_u32 s36, s36, 65536
s_waitcnt lgkmcnt(0)
Rv 192,2,16384
Rv 196,3,16384
Rv 200,2,49152
Rv 204,3,49152
Rv 208,4,16384
Rv 212,5,16384
Rv 216,4,49152
Rv 220,5,49152
Va 160,160,168
Va 176,176,184
Va 161,161,169
Va 177,177,185
Va 162,162,170
Va 178,178,186
Va 163,163,171
Va 179,179,187
Va 164,164,172
Va 180,180,188
Va 165,165,173
Va 181,181,189
Va 166,166,174
Va 182,182,190
Va 167,167,175
Va 183,183,191
Va 160,160,176
Va 161,161,177
Va 162,162,178
Va 163,163,179
Va 164,164,180
Va 165,165,181
Va 166,166,182
Va 167,167,183
Vc 168,160,161
v_lshlrev_b32 v160, 16, v168
v_and_b32 v161, 0xffff0000, v168
Vc 169,162,163
v_lshlrev_b32 v162, 16, v169
v_and_b32 v163, 0xffff0000, v169
Vc 170,164,165
v_lshlrev_b32 v164, 16, v170
v_and_b32 v165, 0xffff0000, v170
Vc 171,166,167
v_lshlrev_b32 v166, 16, v171
v_and_b32 v167, 0xffff0000, v171
Vm 160,160,48
Vm 161,161,49
Vm 162,162,50
Vm 163,163,51
Vm 164,164,52
Vm 165,165,53
Vm 166,166,54
Vm 167,167,55
Vc 168,160,161
v_lshlrev_b32 v160, 16, v168
v_and_b32 v161, 0xffff0000, v168
Vc 169,162,163
v_lshlrev_b32 v162, 16, v169
v_and_b32 v163, 0xffff0000, v169
Vc 170,164,165
v_lshlrev_b32 v164, 16, v170
v_and_b32 v165, 0xffff0000, v170
Vc 171,166,167
v_lshlrev_b32 v166, 16, v171
v_and_b32 v167, 0xffff0000, v171
v_lshlrev_b32 v176, 16, v20
v_and_b32 v177, 0xffff0000, v20
v_lshlrev_b32 v178, 16, v21
v_and_b32 v179, 0xffff0000, v21
v_lshlrev_b32 v180, 16, v22
v_and_b32 v181, 0xffff0000, v22
v_lshlrev_b32 v182, 16, v23
v_and_b32 v183, 0xffff0000, v23
Va 160,160,176
Va 161,161,177
Va 162,162,178
Va 163,163,179
Va 164,164,180
Va 165,165,181
Va 166,166,182
Va 167,167,183
Vc 168,160,161
Vc 169,162,163
Vc 170,164,165
Vc 171,166,167
buffer_store_dwordx4 v[168:171], v9, s[28:31], s36 offen
s_add_u32 s36, s36, 65536
s_waitcnt lgkmcnt(0)
Rv 224,2,24576
Rv 228,3,24576
Rv 232,2,57344
Rv 236,3,57344
Rv 240,4,24576
Rv 244,5,24576
Rv 248,4,57344
Rv 252,5,57344
Va 192,192,200
Va 208,208,216
Va 193,193,201
Va 209,209,217
Va 194,194,202
Va 210,210,218
Va 195,195,203
Va 211,211,219
Va 196,196,204
Va 212,212,220
Va 197,197,205
Va 213,213,221
Va 198,198,206
Va 214,214,222
Va 199,199,207
Va 215,215,223
Va 192,192,208
Va 193,193,209
Va 194,194,210
Va 195,195,211
Va 196,196,212
Va 197,197,213
Va 198,198,214
Va 199,199,215
Vc 200,192,193
v_lshlrev_b32 v192, 16, v200
v_and_b32 v193, 0xffff0000, v200
Vc 201,194,195
v_lshlrev_b32 v194, 16, v201
v_and_b32 v195, 0xffff0000, v201
Vc 202,196,197
v_lshlrev_b32 v196, 16, v202
v_and_b32 v197, 0xffff0000, v202
Vc 203,198,199
v_lshlrev_b32 v198, 16, v203
v_and_b32 v199, 0xffff0000, v203
Vm 192,192,56
Vm 193,193,57
Vm 194,194,58
Vm 195,195,59
Vm 196,196,60
Vm 197,197,61
Vm 198,198,62
Vm 199,199,63
Vc 200,192,193
v_lshlrev_b32 v192, 16, v200
v_and_b32 v193, 0xffff0000, v200
Vc 201,194,195
v_lshlrev_b32 v194, 16, v201
v_and_b32 v195, 0xffff0000, v201
Vc 202,196,197
v_lshlrev_b32 v196, 16, v202
v_and_b32 v197, 0xffff0000, v202
Vc 203,198,199
v_lshlrev_b32 v198, 16, v203
v_and_b32 v199, 0xffff0000, v203
v_lshlrev_b32 v208, 16, v24
v_and_b32 v209, 0xffff0000, v24
v_lshlrev_b32 v210, 16, v25
v_and_b32 v211, 0xffff0000, v25
v_lshlrev_b32 v212, 16, v26
v_and_b32 v213, 0xffff0000, v26
v_lshlrev_b32 v214, 16, v27
v_and_b32 v215, 0xffff0000, v27
Va 192,192,208
Va 193,193,209
Va 194,194,210
Va 195,195,211
Va 196,196,212
Va 197,197,213
Va 198,198,214
Va 199,199,215
Vc 200,192,193
Vc 201,194,195
Vc 202,196,197
Vc 203,198,199
buffer_store_dwordx4 v[200:203], v9, s[28:31], s36 offen
s_add_u32 s36, s36, 65536
s_waitcnt lgkmcnt(0)
Va 224,224,232
Va 240,240,248
Va 225,225,233
Va 241,241,249
Va 226,226,234
Va 242,242,250
Va 227,227,235
Va 243,243,251
Va 228,228,236
Va 244,244,252
Va 229,229,237
Va 245,245,253
Va 230,230,238
Va 246,246,254
Va 231,231,239
Va 247,247,255
Va 224,224,240
Va 225,225,241
Va 226,226,242
Va 227,227,243
Va 228,228,244
Va 229,229,245
Va 230,230,246
Va 231,231,247
Vc 232,224,225
v_lshlrev_b32 v224, 16, v232
v_and_b32 v225, 0xffff0000, v232
Vc 233,226,227
v_lshlrev_b32 v226, 16, v233
v_and_b32 v227, 0xffff0000, v233
Vc 234,228,229
v_lshlrev_b32 v228, 16, v234
v_and_b32 v229, 0xffff0000, v234
Vc 235,230,231
v_lshlrev_b32 v230, 16, v235
v_and_b32 v231, 0xffff0000, v235
Vm 224,224,64
Vm 225,225,65
Vm 226,226,66
Vm 227,227,67
Vm 228,228,68
Vm 229,229,69
Vm 230,230,70
Vm 231,231,71
Vc 232,224,225
v_lshlrev_b32 v224, 16, v232
v_and_b32 v225, 0xffff0000, v232
Vc 233,226,227
v_lshlrev_b32 v226, 16, v233
v_and_b32 v227, 0xffff0000, v233
Vc 234,228,229
v_lshlrev_b32 v228, 16, v234
v_and_b32 v229, 0xffff0000, v234
Vc 235,230,231
v_lshlrev_b32 v230, 16, v235
v_and_b32 v231, 0xffff0000, v235
v_lshlrev_b32 v240, 16, v28
v_and_b32 v241, 0xffff0000, v28
v_lshlrev_b32 v242, 16, v29
v_and_b32 v243, 0xffff0000, v29
v_lshlrev_b32 v244, 16, v30
v_and_b32 v245, 0xffff0000, v30
v_lshlrev_b32 v246, 16, v31
v_and_b32 v247, 0xffff0000, v31
Va 224,224,240
Va 225,225,241
Va 226,226,242
Va 227,227,243
Va 228,228,244
Va 229,229,245
Va 230,230,246
Va 231,231,247
Vc 232,224,225
Vc 233,226,227
Vc 234,228,229
Vc 235,230,231
buffer_store_dwordx4 v[232:235], v9, s[28:31], s36 offen
L_k3_end:
s_endpgm
L_k3_selA:
Va 80,80,96
Va 81,81,97
Va 82,82,98
Va 83,83,99
Va 84,84,100
Va 85,85,101
Va 86,86,102
Va 87,87,103
Va 88,88,104
Va 89,89,105
Va 90,90,106
Va 91,91,107
Va 92,92,108
Va 93,93,109
Va 94,94,110
Va 95,95,111
v_add_f32_dpp v80, v80, v80 row_ror:8 row_mask:0xf bank_mask:0xf
v_add_f32_dpp v81, v81, v81 row_ror:8 row_mask:0xf bank_mask:0xf
v_add_f32_dpp v82, v82, v82 row_ror:8 row_mask:0xf bank_mask:0xf
v_add_f32_dpp v83, v83, v83 row_ror:8 row_mask:0xf bank_mask:0xf
v_add_f32_dpp v84, v84, v84 row_ror:8 row_mask:0xf bank_mask:0xf
v_add_f32_dpp v85, v85, v85 row_ror:8 row_mask:0xf bank_mask:0xf
v_add_f32_dpp v86, v86, v86 row_ror:8 row_mask:0xf bank_mask:0xf
v_add_f32_dpp v87, v87, v87 row_ror:8 row_mask:0xf bank_mask:0xf
v_add_f32_dpp v88, v88, v88 row_ror:8 row_mask:0xf bank_mask:0xf
v_add_f32_dpp v89, v89, v89 row_ror:8 row_mask:0xf bank_mask:0xf
v_add_f32_dpp v90, v90, v90 row_ror:8 row_mask:0xf bank_mask:0xf
v_add_f32_dpp v91, v91, v91 row_ror:8 row_mask:0xf bank_mask:0xf
v_add_f32_dpp v92, v92, v92 row_ror:8 row_mask:0xf bank_mask:0xf
v_add_f32_dpp v93, v93, v93 row_ror:8 row_mask:0xf bank_mask:0xf
v_add_f32_dpp v94, v94, v94 row_ror:8 row_mask:0xf bank_mask:0xf
v_add_f32_dpp v95, v95, v95 row_ror:8 row_mask:0xf bank_mask:0xf
v_mov_b32 v96, v80
v_mov_b32 v97, v81
v_mov_b32 v98, v82
v_mov_b32 v99, v83
v_mov_b32 v100, v84
v_mov_b32 v101, v85
v_mov_b32 v102, v86
v_mov_b32 v103, v87
v_mov_b32 v104, v88
v_mov_b32 v105, v89
v_mov_b32 v106, v90
v_mov_b32 v107, v91
v_mov_b32 v108, v92
v_mov_b32 v109, v93
v_mov_b32 v110, v94
v_mov_b32 v111, v95
v_permlane16_swap_b32 v96, v80
v_permlane16_swap_b32 v97, v81
v_permlane16_swap_b32 v98, v82
v_permlane16_swap_b32 v99, v83
v_permlane16_swap_b32 v100, v84
v_permlane16_swap_b32 v101, v85
v_permlane16_swap_b32 v102, v86
v_permlane16_swap_b32 v103, v87
v_permlane16_swap_b32 v104, v88
v_permlane16_swap_b32 v105, v89
v_permlane16_swap_b32 v106, v90
v_permlane16_swap_b32 v107, v91
v_permlane16_swap_b32 v108, v92
v_permlane16_swap_b32 v109, v93
v_permlane16_swap_b32 v110, v94
v_permlane16_swap_b32 v111, v95
Va 80,80,96
Va 81,81,97
Va 82,82,98
Va 83,83,99
Va 84,84,100
Va 85,85,101
Va 86,86,102
Va 87,87,103
Va 88,88,104
Va 89,89,105
Va 90,90,106
Va 91,91,107
Va 92,92,108
Va 93,93,109
Va 94,94,110
Va 95,95,111
v_mov_b32 v96, v80
v_mov_b32 v97, v81
v_mov_b32 v98, v82
v_mov_b32 v99, v83
v_mov_b32 v100, v84
v_mov_b32 v101, v85
v_mov_b32 v102, v86
v_mov_b32 v103, v87
v_mov_b32 v104, v88
v_mov_b32 v105, v89
v_mov_b32 v106, v90
v_mov_b32 v107, v91
v_mov_b32 v108, v92
v_mov_b32 v109, v93
v_mov_b32 v110, v94
v_mov_b32 v111, v95
v_permlane32_swap_b32 v96, v80
v_permlane32_swap_b32 v97, v81
v_permlane32_swap_b32 v98, v82
v_permlane32_swap_b32 v99, v83
v_permlane32_swap_b32 v100, v84
v_permlane32_swap_b32 v101, v85
v_permlane32_swap_b32 v102, v86
v_permlane32_swap_b32 v103, v87
v_permlane32_swap_b32 v104, v88
v_permlane32_swap_b32 v105, v89
v_permlane32_swap_b32 v106, v90
v_permlane32_swap_b32 v107, v91
v_permlane32_swap_b32 v108, v92
v_permlane32_swap_b32 v109, v93
v_permlane32_swap_b32 v110, v94
v_permlane32_swap_b32 v111, v95
Va 80,80,96
Va 81,81,97
Va 82,82,98
Va 83,83,99
Va 84,84,100
Va 85,85,101
Va 86,86,102
Va 87,87,103
Va 88,88,104
Va 89,89,105
Va 90,90,106
Va 91,91,107
Va 92,92,108
Va 93,93,109
Va 94,94,110
Va 95,95,111
Vc 1,80,81
v_lshlrev_b32 v80, 16, v1
v_and_b32 v81, 0xffff0000, v1
Vc 1,82,83
v_lshlrev_b32 v82, 16, v1
v_and_b32 v83, 0xffff0000, v1
Vc 1,84,85
v_lshlrev_b32 v84, 16, v1
v_and_b32 v85, 0xffff0000, v1
Vc 1,86,87
v_lshlrev_b32 v86, 16, v1
v_and_b32 v87, 0xffff0000, v1
Vc 1,88,89
v_lshlrev_b32 v88, 16, v1
v_and_b32 v89, 0xffff0000, v1
Vc 1,90,91
v_lshlrev_b32 v90, 16, v1
v_and_b32 v91, 0xffff0000, v1
Vc 1,92,93
v_lshlrev_b32 v92, 16, v1
v_and_b32 v93, 0xffff0000, v1
Vc 1,94,95
v_lshlrev_b32 v94, 16, v1
v_and_b32 v95, 0xffff0000, v1
v_mul_f32 v80, s54, v80
v_mul_f32 v81, s54, v81
v_mul_f32 v82, s54, v82
v_mul_f32 v83, s54, v83
v_mul_f32 v84, s54, v84
v_mul_f32 v85, s54, v85
v_mul_f32 v86, s54, v86
v_mul_f32 v87, s54, v87
v_mul_f32 v88, s55, v88
v_mul_f32 v89, s55, v89
v_mul_f32 v90, s55, v90
v_mul_f32 v91, s55, v91
v_mul_f32 v92, s55, v92
v_mul_f32 v93, s55, v93
v_mul_f32 v94, s55, v94
v_mul_f32 v95, s55, v95
Vc 1,80,81
v_lshlrev_b32 v80, 16, v1
v_and_b32 v81, 0xffff0000, v1
Vc 1,82,83
v_lshlrev_b32 v82, 16, v1
v_and_b32 v83, 0xffff0000, v1
Vc 1,84,85
v_lshlrev_b32 v84, 16, v1
v_and_b32 v85, 0xffff0000, v1
Vc 1,86,87
v_lshlrev_b32 v86, 16, v1
v_and_b32 v87, 0xffff0000, v1
Vc 1,88,89
v_lshlrev_b32 v88, 16, v1
v_and_b32 v89, 0xffff0000, v1
Vc 1,90,91
v_lshlrev_b32 v90, 16, v1
v_and_b32 v91, 0xffff0000, v1
Vc 1,92,93
v_lshlrev_b32 v92, 16, v1
v_and_b32 v93, 0xffff0000, v1
Vc 1,94,95
v_lshlrev_b32 v94, 16, v1
v_and_b32 v95, 0xffff0000, v1
s_lshl_b32 s3, s33, 7
s_sub_u32 s52, s52, s3
s_sub_u32 s53, s53, s3
v_add_u32 v1, 0, v10
v_cmp_eq_u32 vcc, s52, v1
v_cmp_eq_u32 s[60:61], s53, v1
s_nop 3
s_or_b64 s[56:57], vcc, s[60:61]
s_cbranch_scc0 L_oproj_kernel_selskip1
v_cndmask_b32 v96, 0, v80, vcc
v_cndmask_b32 v96, v96, v88, s[60:61]
v_cndmask_b32 v97, 0, v81, vcc
v_cndmask_b32 v97, v97, v89, s[60:61]
v_cndmask_b32 v98, 0, v82, vcc
v_cndmask_b32 v98, v98, v90, s[60:61]
v_cndmask_b32 v99, 0, v83, vcc
v_cndmask_b32 v99, v99, v91, s[60:61]
v_cndmask_b32 v100, 0, v84, vcc
v_cndmask_b32 v100, v100, v92, s[60:61]
v_cndmask_b32 v101, 0, v85, vcc
v_cndmask_b32 v101, v101, v93, s[60:61]
v_cndmask_b32 v102, 0, v86, vcc
v_cndmask_b32 v102, v102, v94, s[60:61]
v_cndmask_b32 v103, 0, v87, vcc
v_cndmask_b32 v103, v103, v95, s[60:61]
v_lshlrev_b32 v40, 16, v16
v_and_b32 v41, 0xffff0000, v16
v_lshlrev_b32 v42, 16, v17
v_and_b32 v43, 0xffff0000, v17
v_lshlrev_b32 v44, 16, v18
v_and_b32 v45, 0xffff0000, v18
v_lshlrev_b32 v46, 16, v19
v_and_b32 v47, 0xffff0000, v19
Vs 40,40,32
Vs 41,41,32
Vs 42,42,32
Vs 43,43,32
Vs 44,44,32
Vs 45,45,32
Vs 46,46,32
Vs 47,47,32
Vc 72,40,41
v_lshlrev_b32 v40, 16, v72
v_and_b32 v41, 0xffff0000, v72
Vc 73,42,43
v_lshlrev_b32 v42, 16, v73
v_and_b32 v43, 0xffff0000, v73
Vc 74,44,45
v_lshlrev_b32 v44, 16, v74
v_and_b32 v45, 0xffff0000, v74
Vc 75,46,47
v_lshlrev_b32 v46, 16, v75
v_and_b32 v47, 0xffff0000, v75
Vm 40,40,33
Vm 41,41,33
Vm 42,42,33
Vm 43,43,33
Vm 44,44,33
Vm 45,45,33
Vm 46,46,33
Vm 47,47,33
Vc 72,40,41
v_lshlrev_b32 v40, 16, v72
v_and_b32 v41, 0xffff0000, v72
Vc 73,42,43
v_lshlrev_b32 v42, 16, v73
v_and_b32 v43, 0xffff0000, v73
Vc 74,44,45
v_lshlrev_b32 v44, 16, v74
v_and_b32 v45, 0xffff0000, v74
Vc 75,46,47
v_lshlrev_b32 v46, 16, v75
v_and_b32 v47, 0xffff0000, v75
Va 40,40,96
Va 41,41,97
Va 42,42,98
Va 43,43,99
Va 44,44,100
Va 45,45,101
Va 46,46,102
Va 47,47,103
Vc 72,40,41
v_lshlrev_b32 v40, 16, v72
v_and_b32 v41, 0xffff0000, v72
Vc 73,42,43
v_lshlrev_b32 v42, 16, v73
v_and_b32 v43, 0xffff0000, v73
Vc 74,44,45
v_lshlrev_b32 v44, 16, v74
v_and_b32 v45, 0xffff0000, v74
Vc 75,46,47
v_lshlrev_b32 v46, 16, v75
v_and_b32 v47, 0xffff0000, v75
v_mul_f32 v72, 0xbfb8aa3b, v40
v_mul_f32 v73, 0xbfb8aa3b, v41
v_mul_f32 v74, 0xbfb8aa3b, v42
v_mul_f32 v75, 0xbfb8aa3b, v43
v_mul_f32 v76, 0xbfb8aa3b, v44
v_mul_f32 v77, 0xbfb8aa3b, v45
v_mul_f32 v78, 0xbfb8aa3b, v46
v_mul_f32 v79, 0xbfb8aa3b, v47
Ve 72,72
Ve 73,73
Ve 74,74
Ve 75,75
Ve 76,76
Ve 77,77
Ve 78,78
Ve 79,79
v_add_f32 v72, 1.0, v72
v_add_f32 v73, 1.0, v73
v_add_f32 v74, 1.0, v74
v_add_f32 v75, 1.0, v75
v_add_f32 v76, 1.0, v76
v_add_f32 v77, 1.0, v77
v_add_f32 v78, 1.0, v78
v_add_f32 v79, 1.0, v79
v_rcp_f32 v72, v72
v_rcp_f32 v73, v73
v_rcp_f32 v74, v74
v_rcp_f32 v75, v75
v_rcp_f32 v76, v76
v_rcp_f32 v77, v77
v_rcp_f32 v78, v78
v_rcp_f32 v79, v79
Vm 40,40,72
Vm 41,41,73
Vm 42,42,74
Vm 43,43,75
Vm 44,44,76
Vm 45,45,77
Vm 46,46,78
Vm 47,47,79
Vc 72,40,41
v_lshlrev_b32 v40, 16, v72
v_and_b32 v41, 0xffff0000, v72
Vc 73,42,43
v_lshlrev_b32 v42, 16, v73
v_and_b32 v43, 0xffff0000, v73
Vc 74,44,45
v_lshlrev_b32 v44, 16, v74
v_and_b32 v45, 0xffff0000, v74
Vc 75,46,47
v_lshlrev_b32 v46, 16, v75
v_and_b32 v47, 0xffff0000, v75
L_oproj_kernel_selskip1:
v_add_u32 v1, 32, v10
v_cmp_eq_u32 vcc, s52, v1
v_cmp_eq_u32 s[60:61], s53, v1
s_nop 3
s_or_b64 s[56:57], vcc, s[60:61]
s_cbranch_scc0 L_oproj_kernel_selskip2
v_cndmask_b32 v96, 0, v80, vcc
v_cndmask_b32 v96, v96, v88, s[60:61]
v_cndmask_b32 v97, 0, v81, vcc
v_cndmask_b32 v97, v97, v89, s[60:61]
v_cndmask_b32 v98, 0, v82, vcc
v_cndmask_b32 v98, v98, v90, s[60:61]
v_cndmask_b32 v99, 0, v83, vcc
v_cndmask_b32 v99, v99, v91, s[60:61]
v_cndmask_b32 v100, 0, v84, vcc
v_cndmask_b32 v100, v100, v92, s[60:61]
v_cndmask_b32 v101, 0, v85, vcc
v_cndmask_b32 v101, v101, v93, s[60:61]
v_cndmask_b32 v102, 0, v86, vcc
v_cndmask_b32 v102, v102, v94, s[60:61]
v_cndmask_b32 v103, 0, v87, vcc
v_cndmask_b32 v103, v103, v95, s[60:61]
v_lshlrev_b32 v48, 16, v20
v_and_b32 v49, 0xffff0000, v20
v_lshlrev_b32 v50, 16, v21
v_and_b32 v51, 0xffff0000, v21
v_lshlrev_b32 v52, 16, v22
v_and_b32 v53, 0xffff0000, v22
v_lshlrev_b32 v54, 16, v23
v_and_b32 v55, 0xffff0000, v23
Vs 48,48,34
Vs 49,49,34
Vs 50,50,34
Vs 51,51,34
Vs 52,52,34
Vs 53,53,34
Vs 54,54,34
Vs 55,55,34
Vc 72,48,49
v_lshlrev_b32 v48, 16, v72
v_and_b32 v49, 0xffff0000, v72
Vc 73,50,51
v_lshlrev_b32 v50, 16, v73
v_and_b32 v51, 0xffff0000, v73
Vc 74,52,53
v_lshlrev_b32 v52, 16, v74
v_and_b32 v53, 0xffff0000, v74
Vc 75,54,55
v_lshlrev_b32 v54, 16, v75
v_and_b32 v55, 0xffff0000, v75
Vm 48,48,35
Vm 49,49,35
Vm 50,50,35
Vm 51,51,35
Vm 52,52,35
Vm 53,53,35
Vm 54,54,35
Vm 55,55,35
Vc 72,48,49
v_lshlrev_b32 v48, 16, v72
v_and_b32 v49, 0xffff0000, v72
Vc 73,50,51
v_lshlrev_b32 v50, 16, v73
v_and_b32 v51, 0xffff0000, v73
Vc 74,52,53
v_lshlrev_b32 v52, 16, v74
v_and_b32 v53, 0xffff0000, v74
Vc 75,54,55
v_lshlrev_b32 v54, 16, v75
v_and_b32 v55, 0xffff0000, v75
Va 48,48,96
Va 49,49,97
Va 50,50,98
Va 51,51,99
Va 52,52,100
Va 53,53,101
Va 54,54,102
Va 55,55,103
Vc 72,48,49
v_lshlrev_b32 v48, 16, v72
v_and_b32 v49, 0xffff0000, v72
Vc 73,50,51
v_lshlrev_b32 v50, 16, v73
v_and_b32 v51, 0xffff0000, v73
Vc 74,52,53
v_lshlrev_b32 v52, 16, v74
v_and_b32 v53, 0xffff0000, v74
Vc 75,54,55
v_lshlrev_b32 v54, 16, v75
v_and_b32 v55, 0xffff0000, v75
v_mul_f32 v72, 0xbfb8aa3b, v48
v_mul_f32 v73, 0xbfb8aa3b, v49
v_mul_f32 v74, 0xbfb8aa3b, v50
v_mul_f32 v75, 0xbfb8aa3b, v51
v_mul_f32 v76, 0xbfb8aa3b, v52
v_mul_f32 v77, 0xbfb8aa3b, v53
v_mul_f32 v78, 0xbfb8aa3b, v54
v_mul_f32 v79, 0xbfb8aa3b, v55
Ve 72,72
Ve 73,73
Ve 74,74
Ve 75,75
Ve 76,76
Ve 77,77
Ve 78,78
Ve 79,79
v_add_f32 v72, 1.0, v72
v_add_f32 v73, 1.0, v73
v_add_f32 v74, 1.0, v74
v_add_f32 v75, 1.0, v75
v_add_f32 v76, 1.0, v76
v_add_f32 v77, 1.0, v77
v_add_f32 v78, 1.0, v78
v_add_f32 v79, 1.0, v79
v_rcp_f32 v72, v72
v_rcp_f32 v73, v73
v_rcp_f32 v74, v74
v_rcp_f32 v75, v75
v_rcp_f32 v76, v76
v_rcp_f32 v77, v77
v_rcp_f32 v78, v78
v_rcp_f32 v79, v79
Vm 48,48,72
Vm 49,49,73
Vm 50,50,74
Vm 51,51,75
Vm 52,52,76
Vm 53,53,77
Vm 54,54,78
Vm 55,55,79
Vc 72,48,49
v_lshlrev_b32 v48, 16, v72
v_and_b32 v49, 0xffff0000, v72
Vc 73,50,51
v_lshlrev_b32 v50, 16, v73
v_and_b32 v51, 0xffff0000, v73
Vc 74,52,53
v_lshlrev_b32 v52, 16, v74
v_and_b32 v53, 0xffff0000, v74
Vc 75,54,55
v_lshlrev_b32 v54, 16, v75
v_and_b32 v55, 0xffff0000, v75
L_oproj_kernel_selskip2:
v_add_u32 v1, 64, v10
v_cmp_eq_u32 vcc, s52, v1
v_cmp_eq_u32 s[60:61], s53, v1
s_nop 3
s_or_b64 s[56:57], vcc, s[60:61]
s_cbranch_scc0 L_oproj_kernel_selskip3
v_cndmask_b32 v96, 0, v80, vcc
v_cndmask_b32 v96, v96, v88, s[60:61]
v_cndmask_b32 v97, 0, v81, vcc
v_cndmask_b32 v97, v97, v89, s[60:61]
v_cndmask_b32 v98, 0, v82, vcc
v_cndmask_b32 v98, v98, v90, s[60:61]
v_cndmask_b32 v99, 0, v83, vcc
v_cndmask_b32 v99, v99, v91, s[60:61]
v_cndmask_b32 v100, 0, v84, vcc
v_cndmask_b32 v100, v100, v92, s[60:61]
v_cndmask_b32 v101, 0, v85, vcc
v_cndmask_b32 v101, v101, v93, s[60:61]
v_cndmask_b32 v102, 0, v86, vcc
v_cndmask_b32 v102, v102, v94, s[60:61]
v_cndmask_b32 v103, 0, v87, vcc
v_cndmask_b32 v103, v103, v95, s[60:61]
v_lshlrev_b32 v56, 16, v24
v_and_b32 v57, 0xffff0000, v24
v_lshlrev_b32 v58, 16, v25
v_and_b32 v59, 0xffff0000, v25
v_lshlrev_b32 v60, 16, v26
v_and_b32 v61, 0xffff0000, v26
v_lshlrev_b32 v62, 16, v27
v_and_b32 v63, 0xffff0000, v27
Vs 56,56,36
Vs 57,57,36
Vs 58,58,36
Vs 59,59,36
Vs 60,60,36
Vs 61,61,36
Vs 62,62,36
Vs 63,63,36
Vc 72,56,57
v_lshlrev_b32 v56, 16, v72
v_and_b32 v57, 0xffff0000, v72
Vc 73,58,59
v_lshlrev_b32 v58, 16, v73
v_and_b32 v59, 0xffff0000, v73
Vc 74,60,61
v_lshlrev_b32 v60, 16, v74
v_and_b32 v61, 0xffff0000, v74
Vc 75,62,63
v_lshlrev_b32 v62, 16, v75
v_and_b32 v63, 0xffff0000, v75
Vm 56,56,37
Vm 57,57,37
Vm 58,58,37
Vm 59,59,37
Vm 60,60,37
Vm 61,61,37
Vm 62,62,37
Vm 63,63,37
Vc 72,56,57
v_lshlrev_b32 v56, 16, v72
v_and_b32 v57, 0xffff0000, v72
Vc 73,58,59
v_lshlrev_b32 v58, 16, v73
v_and_b32 v59, 0xffff0000, v73
Vc 74,60,61
v_lshlrev_b32 v60, 16, v74
v_and_b32 v61, 0xffff0000, v74
Vc 75,62,63
v_lshlrev_b32 v62, 16, v75
v_and_b32 v63, 0xffff0000, v75
Va 56,56,96
Va 57,57,97
Va 58,58,98
Va 59,59,99
Va 60,60,100
Va 61,61,101
Va 62,62,102
Va 63,63,103
Vc 72,56,57
v_lshlrev_b32 v56, 16, v72
v_and_b32 v57, 0xffff0000, v72
Vc 73,58,59
v_lshlrev_b32 v58, 16, v73
v_and_b32 v59, 0xffff0000, v73
Vc 74,60,61
v_lshlrev_b32 v60, 16, v74
v_and_b32 v61, 0xffff0000, v74
Vc 75,62,63
v_lshlrev_b32 v62, 16, v75
v_and_b32 v63, 0xffff0000, v75
v_mul_f32 v72, 0xbfb8aa3b, v56
v_mul_f32 v73, 0xbfb8aa3b, v57
v_mul_f32 v74, 0xbfb8aa3b, v58
v_mul_f32 v75, 0xbfb8aa3b, v59
v_mul_f32 v76, 0xbfb8aa3b, v60
v_mul_f32 v77, 0xbfb8aa3b, v61
v_mul_f32 v78, 0xbfb8aa3b, v62
v_mul_f32 v79, 0xbfb8aa3b, v63
Ve 72,72
Ve 73,73
Ve 74,74
Ve 75,75
Ve 76,76
Ve 77,77
Ve 78,78
Ve 79,79
v_add_f32 v72, 1.0, v72
v_add_f32 v73, 1.0, v73
v_add_f32 v74, 1.0, v74
v_add_f32 v75, 1.0, v75
v_add_f32 v76, 1.0, v76
v_add_f32 v77, 1.0, v77
v_add_f32 v78, 1.0, v78
v_add_f32 v79, 1.0, v79
v_rcp_f32 v72, v72
v_rcp_f32 v73, v73
v_rcp_f32 v74, v74
v_rcp_f32 v75, v75
v_rcp_f32 v76, v76
v_rcp_f32 v77, v77
v_rcp_f32 v78, v78
v_rcp_f32 v79, v79
Vm 56,56,72
Vm 57,57,73
Vm 58,58,74
Vm 59,59,75
Vm 60,60,76
Vm 61,61,77
Vm 62,62,78
Vm 63,63,79
Vc 72,56,57
v_lshlrev_b32 v56, 16, v72
v_and_b32 v57, 0xffff0000, v72
Vc 73,58,59
v_lshlrev_b32 v58, 16, v73
v_and_b32 v59, 0xffff0000, v73
Vc 74,60,61
v_lshlrev_b32 v60, 16, v74
v_and_b32 v61, 0xffff0000, v74
Vc 75,62,63
v_lshlrev_b32 v62, 16, v75
v_and_b32 v63, 0xffff0000, v75
L_oproj_kernel_selskip3:
v_add_u32 v1, 96, v10
v_cmp_eq_u32 vcc, s52, v1
v_cmp_eq_u32 s[60:61], s53, v1
s_nop 3
s_or_b64 s[56:57], vcc, s[60:61]
s_cbranch_scc0 L_oproj_kernel_selskip4
v_cndmask_b32 v96, 0, v80, vcc
v_cndmask_b32 v96, v96, v88, s[60:61]
v_cndmask_b32 v97, 0, v81, vcc
v_cndmask_b32 v97, v97, v89, s[60:61]
v_cndmask_b32 v98, 0, v82, vcc
v_cndmask_b32 v98, v98, v90, s[60:61]
v_cndmask_b32 v99, 0, v83, vcc
v_cndmask_b32 v99, v99, v91, s[60:61]
v_cndmask_b32 v100, 0, v84, vcc
v_cndmask_b32 v100, v100, v92, s[60:61]
v_cndmask_b32 v101, 0, v85, vcc
v_cndmask_b32 v101, v101, v93, s[60:61]
v_cndmask_b32 v102, 0, v86, vcc
v_cndmask_b32 v102, v102, v94, s[60:61]
v_cndmask_b32 v103, 0, v87, vcc
v_cndmask_b32 v103, v103, v95, s[60:61]
v_lshlrev_b32 v64, 16, v28
v_and_b32 v65, 0xffff0000, v28
v_lshlrev_b32 v66, 16, v29
v_and_b32 v67, 0xffff0000, v29
v_lshlrev_b32 v68, 16, v30
v_and_b32 v69, 0xffff0000, v30
v_lshlrev_b32 v70, 16, v31
v_and_b32 v71, 0xffff0000, v31
Vs 64,64,38
Vs 65,65,38
Vs 66,66,38
Vs 67,67,38
Vs 68,68,38
Vs 69,69,38
Vs 70,70,38
Vs 71,71,38
Vc 72,64,65
v_lshlrev_b32 v64, 16, v72
v_and_b32 v65, 0xffff0000, v72
Vc 73,66,67
v_lshlrev_b32 v66, 16, v73
v_and_b32 v67, 0xffff0000, v73
Vc 74,68,69
v_lshlrev_b32 v68, 16, v74
v_and_b32 v69, 0xffff0000, v74
Vc 75,70,71
v_lshlrev_b32 v70, 16, v75
v_and_b32 v71, 0xffff0000, v75
Vm 64,64,39
Vm 65,65,39
Vm 66,66,39
Vm 67,67,39
Vm 68,68,39
Vm 69,69,39
Vm 70,70,39
Vm 71,71,39
Vc 72,64,65
v_lshlrev_b32 v64, 16, v72
v_and_b32 v65, 0xffff0000, v72
Vc 73,66,67
v_lshlrev_b32 v66, 16, v73
v_and_b32 v67, 0xffff0000, v73
Vc 74,68,69
v_lshlrev_b32 v68, 16, v74
v_and_b32 v69, 0xffff0000, v74
Vc 75,70,71
v_lshlrev_b32 v70, 16, v75
v_and_b32 v71, 0xffff0000, v75
Va 64,64,96
Va 65,65,97
Va 66,66,98
Va 67,67,99
Va 68,68,100
Va 69,69,101
Va 70,70,102
Va 71,71,103
Vc 72,64,65
v_lshlrev_b32 v64, 16, v72
v_and_b32 v65, 0xffff0000, v72
Vc 73,66,67
v_lshlrev_b32 v66, 16, v73
v_and_b32 v67, 0xffff0000, v73
Vc 74,68,69
v_lshlrev_b32 v68, 16, v74
v_and_b32 v69, 0xffff0000, v74
Vc 75,70,71
v_lshlrev_b32 v70, 16, v75
v_and_b32 v71, 0xffff0000, v75
v_mul_f32 v72, 0xbfb8aa3b, v64
v_mul_f32 v73, 0xbfb8aa3b, v65
v_mul_f32 v74, 0xbfb8aa3b, v66
v_mul_f32 v75, 0xbfb8aa3b, v67
v_mul_f32 v76, 0xbfb8aa3b, v68
v_mul_f32 v77, 0xbfb8aa3b, v69
v_mul_f32 v78, 0xbfb8aa3b, v70
v_mul_f32 v79, 0xbfb8aa3b, v71
Ve 72,72
Ve 73,73
Ve 74,74
Ve 75,75
Ve 76,76
Ve 77,77
Ve 78,78
Ve 79,79
v_add_f32 v72, 1.0, v72
v_add_f32 v73, 1.0, v73
v_add_f32 v74, 1.0, v74
v_add_f32 v75, 1.0, v75
v_add_f32 v76, 1.0, v76
v_add_f32 v77, 1.0, v77
v_add_f32 v78, 1.0, v78
v_add_f32 v79, 1.0, v79
v_rcp_f32 v72, v72
v_rcp_f32 v73, v73
v_rcp_f32 v74, v74
v_rcp_f32 v75, v75
v_rcp_f32 v76, v76
v_rcp_f32 v77, v77
v_rcp_f32 v78, v78
v_rcp_f32 v79, v79
Vm 64,64,72
Vm 65,65,73
Vm 66,66,74
Vm 67,67,75
Vm 68,68,76
Vm 69,69,77
Vm 70,70,78
Vm 71,71,79
Vc 72,64,65
v_lshlrev_b32 v64, 16, v72
v_and_b32 v65, 0xffff0000, v72
Vc 73,66,67
v_lshlrev_b32 v66, 16, v73
v_and_b32 v67, 0xffff0000, v73
Vc 74,68,69
v_lshlrev_b32 v68, 16, v74
v_and_b32 v69, 0xffff0000, v74
Vc 75,70,71
v_lshlrev_b32 v70, 16, v75
v_and_b32 v71, 0xffff0000, v75
L_oproj_kernel_selskip4:
s_branch L_k3_selAr
L_k3_sel:
v_mov_b32 v103, 0
s_mov_b32 s62, 0x400000
L_k3_poll:
buffer_load_dword v102, v103, s[40:43], s45 offen sc1
s_waitcnt vmcnt(0)
v_readfirstlane_b32 s63, v102
s_sub_u32 s62, s62, 1
s_cmp_eq_u32 s62, 0
s_cbranch_scc1 L_k3_polled
s_cmp_lt_u32 s63, 16
s_cbranch_scc1 L_k3_poll
L_k3_polled:
v_lshlrev_b32 v15, 10, v14
v_lshl_add_u32 v15, v13, 5, v15
buffer_load_dwordx4 v[80:83], v15, s[16:19], s47 offen offset:0 sc1
buffer_load_dwordx4 v[84:87], v15, s[16:19], s47 offen offset:16 sc1
buffer_load_dwordx4 v[88:91], v15, s[16:19], s47 offen offset:256 sc1
buffer_load_dwordx4 v[92:95], v15, s[16:19], s47 offen offset:272 sc1
buffer_load_dwordx4 v[96:99], v15, s[16:19], s47 offen offset:512 sc1
buffer_load_dwordx4 v[100:103], v15, s[16:19], s47 offen offset:528 sc1
buffer_load_dwordx4 v[104:107], v15, s[16:19], s47 offen offset:768 sc1
buffer_load_dwordx4 v[108:111], v15, s[16:19], s47 offen offset:784 sc1
s_waitcnt vmcnt(0)
Va 80,80,96
Va 81,81,97
Va 82,82,98
Va 83,83,99
Va 84,84,100
Va 85,85,101
Va 86,86,102
Va 87,87,103
Va 88,88,104
Va 89,89,105
Va 90,90,106
Va 91,91,107
Va 92,92,108
Va 93,93,109
Va 94,94,110
Va 95,95,111
v_add_f32_dpp v80, v80, v80 row_ror:8 row_mask:0xf bank_mask:0xf
v_add_f32_dpp v81, v81, v81 row_ror:8 row_mask:0xf bank_mask:0xf
v_add_f32_dpp v82, v82, v82 row_ror:8 row_mask:0xf bank_mask:0xf
v_add_f32_dpp v83, v83, v83 row_ror:8 row_mask:0xf bank_mask:0xf
v_add_f32_dpp v84, v84, v84 row_ror:8 row_mask:0xf bank_mask:0xf
v_add_f32_dpp v85, v85, v85 row_ror:8 row_mask:0xf bank_mask:0xf
v_add_f32_dpp v86, v86, v86 row_ror:8 row_mask:0xf bank_mask:0xf
v_add_f32_dpp v87, v87, v87 row_ror:8 row_mask:0xf bank_mask:0xf
v_add_f32_dpp v88, v88, v88 row_ror:8 row_mask:0xf bank_mask:0xf
v_add_f32_dpp v89, v89, v89 row_ror:8 row_mask:0xf bank_mask:0xf
v_add_f32_dpp v90, v90, v90 row_ror:8 row_mask:0xf bank_mask:0xf
v_add_f32_dpp v91, v91, v91 row_ror:8 row_mask:0xf bank_mask:0xf
v_add_f32_dpp v92, v92, v92 row_ror:8 row_mask:0xf bank_mask:0xf
v_add_f32_dpp v93, v93, v93 row_ror:8 row_mask:0xf bank_mask:0xf
v_add_f32_dpp v94, v94, v94 row_ror:8 row_mask:0xf bank_mask:0xf
v_add_f32_dpp v95, v95, v95 row_ror:8 row_mask:0xf bank_mask:0xf
v_mov_b32 v96, v80
v_mov_b32 v97, v81
v_mov_b32 v98, v82
v_mov_b32 v99, v83
v_mov_b32 v100, v84
v_mov_b32 v101, v85
v_mov_b32 v102, v86
v_mov_b32 v103, v87
v_mov_b32 v104, v88
v_mov_b32 v105, v89
v_mov_b32 v106, v90
v_mov_b32 v107, v91
v_mov_b32 v108, v92
v_mov_b32 v109, v93
v_mov_b32 v110, v94
v_mov_b32 v111, v95
v_permlane16_swap_b32 v96, v80
v_permlane16_swap_b32 v97, v81
v_permlane16_swap_b32 v98, v82
v_permlane16_swap_b32 v99, v83
v_permlane16_swap_b32 v100, v84
v_permlane16_swap_b32 v101, v85
v_permlane16_swap_b32 v102, v86
v_permlane16_swap_b32 v103, v87
v_permlane16_swap_b32 v104, v88
v_permlane16_swap_b32 v105, v89
v_permlane16_swap_b32 v106, v90
v_permlane16_swap_b32 v107, v91
v_permlane16_swap_b32 v108, v92
v_permlane16_swap_b32 v109, v93
v_permlane16_swap_b32 v110, v94
v_permlane16_swap_b32 v111, v95
Va 80,80,96
Va 81,81,97
Va 82,82,98
Va 83,83,99
Va 84,84,100
Va 85,85,101
Va 86,86,102
Va 87,87,103
Va 88,88,104
Va 89,89,105
Va 90,90,106
Va 91,91,107
Va 92,92,108
Va 93,93,109
Va 94,94,110
Va 95,95,111
v_mov_b32 v96, v80
v_mov_b32 v97, v81
v_mov_b32 v98, v82
v_mov_b32 v99, v83
v_mov_b32 v100, v84
v_mov_b32 v101, v85
v_mov_b32 v102, v86
v_mov_b32 v103, v87
v_mov_b32 v104, v88
v_mov_b32 v105, v89
v_mov_b32 v106, v90
v_mov_b32 v107, v91
v_mov_b32 v108, v92
v_mov_b32 v109, v93
v_mov_b32 v110, v94
v_mov_b32 v111, v95
v_permlane32_swap_b32 v96, v80
v_permlane32_swap_b32 v97, v81
v_permlane32_swap_b32 v98, v82
v_permlane32_swap_b32 v99, v83
v_permlane32_swap_b32 v100, v84
v_permlane32_swap_b32 v101, v85
v_permlane32_swap_b32 v102, v86
v_permlane32_swap_b32 v103, v87
v_permlane32_swap_b32 v104, v88
v_permlane32_swap_b32 v105, v89
v_permlane32_swap_b32 v106, v90
v_permlane32_swap_b32 v107, v91
v_permlane32_swap_b32 v108, v92
v_permlane32_swap_b32 v109, v93
v_permlane32_swap_b32 v110, v94
v_permlane32_swap_b32 v111, v95
Va 80,80,96
Va 81,81,97
Va 82,82,98
Va 83,83,99
Va 84,84,100
Va 85,85,101
Va 86,86,102
Va 87,87,103
Va 88,88,104
Va 89,89,105
Va 90,90,106
Va 91,91,107
Va 92,92,108
Va 93,93,109
Va 94,94,110
Va 95,95,111
Vc 1,80,81
v_lshlrev_b32 v80, 16, v1
v_and_b32 v81, 0xffff0000, v1
Vc 1,82,83
v_lshlrev_b32 v82, 16, v1
v_and_b32 v83, 0xffff0000, v1
Vc 1,84,85
v_lshlrev_b32 v84, 16, v1
v_and_b32 v85, 0xffff0000, v1
Vc 1,86,87
v_lshlrev_b32 v86, 16, v1
v_and_b32 v87, 0xffff0000, v1
Vc 1,88,89
v_lshlrev_b32 v88, 16, v1
v_and_b32 v89, 0xffff0000, v1
Vc 1,90,91
v_lshlrev_b32 v90, 16, v1
v_and_b32 v91, 0xffff0000, v1
Vc 1,92,93
v_lshlrev_b32 v92, 16, v1
v_and_b32 v93, 0xffff0000, v1
Vc 1,94,95
v_lshlrev_b32 v94, 16, v1
v_and_b32 v95, 0xffff0000, v1
v_mul_f32 v80, s54, v80
v_mul_f32 v81, s54, v81
v_mul_f32 v82, s54, v82
v_mul_f32 v83, s54, v83
v_mul_f32 v84, s54, v84
v_mul_f32 v85, s54, v85
v_mul_f32 v86, s54, v86
v_mul_f32 v87, s54, v87
v_mul_f32 v88, s55, v88
v_mul_f32 v89, s55, v89
v_mul_f32 v90, s55, v90
v_mul_f32 v91, s55, v91
v_mul_f32 v92, s55, v92
v_mul_f32 v93, s55, v93
v_mul_f32 v94, s55, v94
v_mul_f32 v95, s55, v95
Vc 1,80,81
v_lshlrev_b32 v80, 16, v1
v_and_b32 v81, 0xffff0000, v1
Vc 1,82,83
v_lshlrev_b32 v82, 16, v1
v_and_b32 v83, 0xffff0000, v1
Vc 1,84,85
v_lshlrev_b32 v84, 16, v1
v_and_b32 v85, 0xffff0000, v1
Vc 1,86,87
v_lshlrev_b32 v86, 16, v1
v_and_b32 v87, 0xffff0000, v1
Vc 1,88,89
v_lshlrev_b32 v88, 16, v1
v_and_b32 v89, 0xffff0000, v1
Vc 1,90,91
v_lshlrev_b32 v90, 16, v1
v_and_b32 v91, 0xffff0000, v1
Vc 1,92,93
v_lshlrev_b32 v92, 16, v1
v_and_b32 v93, 0xffff0000, v1
Vc 1,94,95
v_lshlrev_b32 v94, 16, v1
v_and_b32 v95, 0xffff0000, v1
s_lshl_b32 s3, s33, 7
s_sub_u32 s52, s52, s3
s_sub_u32 s53, s53, s3
v_add_u32 v1, 0, v10
v_cmp_eq_u32 vcc, s52, v1
v_cmp_eq_u32 s[60:61], s53, v1
s_nop 3
s_or_b64 s[56:57], vcc, s[60:61]
s_cbranch_scc0 L_oproj_kernel_selskip5
v_cndmask_b32 v96, 0, v80, vcc
v_cndmask_b32 v96, v96, v88, s[60:61]
v_cndmask_b32 v97, 0, v81, vcc
v_cndmask_b32 v97, v97, v89, s[60:61]
v_cndmask_b32 v98, 0, v82, vcc
v_cndmask_b32 v98, v98, v90, s[60:61]
v_cndmask_b32 v99, 0, v83, vcc
v_cndmask_b32 v99, v99, v91, s[60:61]
v_cndmask_b32 v100, 0, v84, vcc
v_cndmask_b32 v100, v100, v92, s[60:61]
v_cndmask_b32 v101, 0, v85, vcc
v_cndmask_b32 v101, v101, v93, s[60:61]
v_cndmask_b32 v102, 0, v86, vcc
v_cndmask_b32 v102, v102, v94, s[60:61]
v_cndmask_b32 v103, 0, v87, vcc
v_cndmask_b32 v103, v103, v95, s[60:61]
v_lshlrev_b32 v40, 16, v16
v_and_b32 v41, 0xffff0000, v16
v_lshlrev_b32 v42, 16, v17
v_and_b32 v43, 0xffff0000, v17
v_lshlrev_b32 v44, 16, v18
v_and_b32 v45, 0xffff0000, v18
v_lshlrev_b32 v46, 16, v19
v_and_b32 v47, 0xffff0000, v19
Vs 40,40,32
Vs 41,41,32
Vs 42,42,32
Vs 43,43,32
Vs 44,44,32
Vs 45,45,32
Vs 46,46,32
Vs 47,47,32
Vc 72,40,41
v_lshlrev_b32 v40, 16, v72
v_and_b32 v41, 0xffff0000, v72
Vc 73,42,43
v_lshlrev_b32 v42, 16, v73
v_and_b32 v43, 0xffff0000, v73
Vc 74,44,45
v_lshlrev_b32 v44, 16, v74
v_and_b32 v45, 0xffff0000, v74
Vc 75,46,47
v_lshlrev_b32 v46, 16, v75
v_and_b32 v47, 0xffff0000, v75
Vm 40,40,33
Vm 41,41,33
Vm 42,42,33
Vm 43,43,33
Vm 44,44,33
Vm 45,45,33
Vm 46,46,33
Vm 47,47,33
Vc 72,40,41
v_lshlrev_b32 v40, 16, v72
v_and_b32 v41, 0xffff0000, v72
Vc 73,42,43
v_lshlrev_b32 v42, 16, v73
v_and_b32 v43, 0xffff0000, v73
Vc 74,44,45
v_lshlrev_b32 v44, 16, v74
v_and_b32 v45, 0xffff0000, v74
Vc 75,46,47
v_lshlrev_b32 v46, 16, v75
v_and_b32 v47, 0xffff0000, v75
Va 40,40,96
Va 41,41,97
Va 42,42,98
Va 43,43,99
Va 44,44,100
Va 45,45,101
Va 46,46,102
Va 47,47,103
Vc 72,40,41
v_lshlrev_b32 v40, 16, v72
v_and_b32 v41, 0xffff0000, v72
Vc 73,42,43
v_lshlrev_b32 v42, 16, v73
v_and_b32 v43, 0xffff0000, v73
Vc 74,44,45
v_lshlrev_b32 v44, 16, v74
v_and_b32 v45, 0xffff0000, v74
Vc 75,46,47
v_lshlrev_b32 v46, 16, v75
v_and_b32 v47, 0xffff0000, v75
v_mul_f32 v72, 0xbfb8aa3b, v40
v_mul_f32 v73, 0xbfb8aa3b, v41
v_mul_f32 v74, 0xbfb8aa3b, v42
v_mul_f32 v75, 0xbfb8aa3b, v43
v_mul_f32 v76, 0xbfb8aa3b, v44
v_mul_f32 v77, 0xbfb8aa3b, v45
v_mul_f32 v78, 0xbfb8aa3b, v46
v_mul_f32 v79, 0xbfb8aa3b, v47
Ve 72,72
Ve 73,73
Ve 74,74
Ve 75,75
Ve 76,76
Ve 77,77
Ve 78,78
Ve 79,79
v_add_f32 v72, 1.0, v72
v_add_f32 v73, 1.0, v73
v_add_f32 v74, 1.0, v74
v_add_f32 v75, 1.0, v75
v_add_f32 v76, 1.0, v76
v_add_f32 v77, 1.0, v77
v_add_f32 v78, 1.0, v78
v_add_f32 v79, 1.0, v79
v_rcp_f32 v72, v72
v_rcp_f32 v73, v73
v_rcp_f32 v74, v74
v_rcp_f32 v75, v75
v_rcp_f32 v76, v76
v_rcp_f32 v77, v77
v_rcp_f32 v78, v78
v_rcp_f32 v79, v79
Vm 40,40,72
Vm 41,41,73
Vm 42,42,74
Vm 43,43,75
Vm 44,44,76
Vm 45,45,77
Vm 46,46,78
Vm 47,47,79
Vc 72,40,41
v_lshlrev_b32 v40, 16, v72
v_and_b32 v41, 0xffff0000, v72
Vc 73,42,43
v_lshlrev_b32 v42, 16, v73
v_and_b32 v43, 0xffff0000, v73
Vc 74,44,45
v_lshlrev_b32 v44, 16, v74
v_and_b32 v45, 0xffff0000, v74
Vc 75,46,47
v_lshlrev_b32 v46, 16, v75
v_and_b32 v47, 0xffff0000, v75
L_oproj_kernel_selskip5:
v_add_u32 v1, 32, v10
v_cmp_eq_u32 vcc, s52, v1
v_cmp_eq_u32 s[60:61], s53, v1
s_nop 3
s_or_b64 s[56:57], vcc, s[60:61]
s_cbranch_scc0 L_oproj_kernel_selskip6
v_cndmask_b32 v96, 0, v80, vcc
v_cndmask_b32 v96, v96, v88, s[60:61]
v_cndmask_b32 v97, 0, v81, vcc
v_cndmask_b32 v97, v97, v89, s[60:61]
v_cndmask_b32 v98, 0, v82, vcc
v_cndmask_b32 v98, v98, v90, s[60:61]
v_cndmask_b32 v99, 0, v83, vcc
v_cndmask_b32 v99, v99, v91, s[60:61]
v_cndmask_b32 v100, 0, v84, vcc
v_cndmask_b32 v100, v100, v92, s[60:61]
v_cndmask_b32 v101, 0, v85, vcc
v_cndmask_b32 v101, v101, v93, s[60:61]
v_cndmask_b32 v102, 0, v86, vcc
v_cndmask_b32 v102, v102, v94, s[60:61]
v_cndmask_b32 v103, 0, v87, vcc
v_cndmask_b32 v103, v103, v95, s[60:61]
v_lshlrev_b32 v48, 16, v20
v_and_b32 v49, 0xffff0000, v20
v_lshlrev_b32 v50, 16, v21
v_and_b32 v51, 0xffff0000, v21
v_lshlrev_b32 v52, 16, v22
v_and_b32 v53, 0xffff0000, v22
v_lshlrev_b32 v54, 16, v23
v_and_b32 v55, 0xffff0000, v23
Vs 48,48,34
Vs 49,49,34
Vs 50,50,34
Vs 51,51,34
Vs 52,52,34
Vs 53,53,34
Vs 54,54,34
Vs 55,55,34
Vc 72,48,49
v_lshlrev_b32 v48, 16, v72
v_and_b32 v49, 0xffff0000, v72
Vc 73,50,51
v_lshlrev_b32 v50, 16, v73
v_and_b32 v51, 0xffff0000, v73
Vc 74,52,53
v_lshlrev_b32 v52, 16, v74
v_and_b32 v53, 0xffff0000, v74
Vc 75,54,55
v_lshlrev_b32 v54, 16, v75
v_and_b32 v55, 0xffff0000, v75
Vm 48,48,35
Vm 49,49,35
Vm 50,50,35
Vm 51,51,35
Vm 52,52,35
Vm 53,53,35
Vm 54,54,35
Vm 55,55,35
Vc 72,48,49
v_lshlrev_b32 v48, 16, v72
v_and_b32 v49, 0xffff0000, v72
Vc 73,50,51
v_lshlrev_b32 v50, 16, v73
v_and_b32 v51, 0xffff0000, v73
Vc 74,52,53
v_lshlrev_b32 v52, 16, v74
v_and_b32 v53, 0xffff0000, v74
Vc 75,54,55
v_lshlrev_b32 v54, 16, v75
v_and_b32 v55, 0xffff0000, v75
Va 48,48,96
Va 49,49,97
Va 50,50,98
Va 51,51,99
Va 52,52,100
Va 53,53,101
Va 54,54,102
Va 55,55,103
Vc 72,48,49
v_lshlrev_b32 v48, 16, v72
v_and_b32 v49, 0xffff0000, v72
Vc 73,50,51
v_lshlrev_b32 v50, 16, v73
v_and_b32 v51, 0xffff0000, v73
Vc 74,52,53
v_lshlrev_b32 v52, 16, v74
v_and_b32 v53, 0xffff0000, v74
Vc 75,54,55
v_lshlrev_b32 v54, 16, v75
v_and_b32 v55, 0xffff0000, v75
v_mul_f32 v72, 0xbfb8aa3b, v48
v_mul_f32 v73, 0xbfb8aa3b, v49
v_mul_f32 v74, 0xbfb8aa3b, v50
v_mul_f32 v75, 0xbfb8aa3b, v51
v_mul_f32 v76, 0xbfb8aa3b, v52
v_mul_f32 v77, 0xbfb8aa3b, v53
v_mul_f32 v78, 0xbfb8aa3b, v54
v_mul_f32 v79, 0xbfb8aa3b, v55
Ve 72,72
Ve 73,73
Ve 74,74
Ve 75,75
Ve 76,76
Ve 77,77
Ve 78,78
Ve 79,79
v_add_f32 v72, 1.0, v72
v_add_f32 v73, 1.0, v73
v_add_f32 v74, 1.0, v74
v_add_f32 v75, 1.0, v75
v_add_f32 v76, 1.0, v76
v_add_f32 v77, 1.0, v77
v_add_f32 v78, 1.0, v78
v_add_f32 v79, 1.0, v79
v_rcp_f32 v72, v72
v_rcp_f32 v73, v73
v_rcp_f32 v74, v74
v_rcp_f32 v75, v75
v_rcp_f32 v76, v76
v_rcp_f32 v77, v77
v_rcp_f32 v78, v78
v_rcp_f32 v79, v79
Vm 48,48,72
Vm 49,49,73
Vm 50,50,74
Vm 51,51,75
Vm 52,52,76
Vm 53,53,77
Vm 54,54,78
Vm 55,55,79
Vc 72,48,49
v_lshlrev_b32 v48, 16, v72
v_and_b32 v49, 0xffff0000, v72
Vc 73,50,51
v_lshlrev_b32 v50, 16, v73
v_and_b32 v51, 0xffff0000, v73
Vc 74,52,53
v_lshlrev_b32 v52, 16, v74
v_and_b32 v53, 0xffff0000, v74
Vc 75,54,55
v_lshlrev_b32 v54, 16, v75
v_and_b32 v55, 0xffff0000, v75
L_oproj_kernel_selskip6:
v_add_u32 v1, 64, v10
v_cmp_eq_u32 vcc, s52, v1
v_cmp_eq_u32 s[60:61], s53, v1
s_nop 3
s_or_b64 s[56:57], vcc, s[60:61]
s_cbranch_scc0 L_oproj_kernel_selskip7
v_cndmask_b32 v96, 0, v80, vcc
v_cndmask_b32 v96, v96, v88, s[60:61]
v_cndmask_b32 v97, 0, v81, vcc
v_cndmask_b32 v97, v97, v89, s[60:61]
v_cndmask_b32 v98, 0, v82, vcc
v_cndmask_b32 v98, v98, v90, s[60:61]
v_cndmask_b32 v99, 0, v83, vcc
v_cndmask_b32 v99, v99, v91, s[60:61]
v_cndmask_b32 v100, 0, v84, vcc
v_cndmask_b32 v100, v100, v92, s[60:61]
v_cndmask_b32 v101, 0, v85, vcc
v_cndmask_b32 v101, v101, v93, s[60:61]
v_cndmask_b32 v102, 0, v86, vcc
v_cndmask_b32 v102, v102, v94, s[60:61]
v_cndmask_b32 v103, 0, v87, vcc
v_cndmask_b32 v103, v103, v95, s[60:61]
v_lshlrev_b32 v56, 16, v24
v_and_b32 v57, 0xffff0000, v24
v_lshlrev_b32 v58, 16, v25
v_and_b32 v59, 0xffff0000, v25
v_lshlrev_b32 v60, 16, v26
v_and_b32 v61, 0xffff0000, v26
v_lshlrev_b32 v62, 16, v27
v_and_b32 v63, 0xffff0000, v27
Vs 56,56,36
Vs 57,57,36
Vs 58,58,36
Vs 59,59,36
Vs 60,60,36
Vs 61,61,36
Vs 62,62,36
Vs 63,63,36
Vc 72,56,57
v_lshlrev_b32 v56, 16, v72
v_and_b32 v57, 0xffff0000, v72
Vc 73,58,59
v_lshlrev_b32 v58, 16, v73
v_and_b32 v59, 0xffff0000, v73
Vc 74,60,61
v_lshlrev_b32 v60, 16, v74
v_and_b32 v61, 0xffff0000, v74
Vc 75,62,63
v_lshlrev_b32 v62, 16, v75
v_and_b32 v63, 0xffff0000, v75
Vm 56,56,37
Vm 57,57,37
Vm 58,58,37
Vm 59,59,37
Vm 60,60,37
Vm 61,61,37
Vm 62,62,37
Vm 63,63,37
Vc 72,56,57
v_lshlrev_b32 v56, 16, v72
v_and_b32 v57, 0xffff0000, v72
Vc 73,58,59
v_lshlrev_b32 v58, 16, v73
v_and_b32 v59, 0xffff0000, v73
Vc 74,60,61
v_lshlrev_b32 v60, 16, v74
v_and_b32 v61, 0xffff0000, v74
Vc 75,62,63
v_lshlrev_b32 v62, 16, v75
v_and_b32 v63, 0xffff0000, v75
Va 56,56,96
Va 57,57,97
Va 58,58,98
Va 59,59,99
Va 60,60,100
Va 61,61,101
Va 62,62,102
Va 63,63,103
Vc 72,56,57
v_lshlrev_b32 v56, 16, v72
v_and_b32 v57, 0xffff0000, v72
Vc 73,58,59
v_lshlrev_b32 v58, 16, v73
v_and_b32 v59, 0xffff0000, v73
Vc 74,60,61
v_lshlrev_b32 v60, 16, v74
v_and_b32 v61, 0xffff0000, v74
Vc 75,62,63
v_lshlrev_b32 v62, 16, v75
v_and_b32 v63, 0xffff0000, v75
v_mul_f32 v72, 0xbfb8aa3b, v56
v_mul_f32 v73, 0xbfb8aa3b, v57
v_mul_f32 v74, 0xbfb8aa3b, v58
v_mul_f32 v75, 0xbfb8aa3b, v59
v_mul_f32 v76, 0xbfb8aa3b, v60
v_mul_f32 v77, 0xbfb8aa3b, v61
v_mul_f32 v78, 0xbfb8aa3b, v62
v_mul_f32 v79, 0xbfb8aa3b, v63
Ve 72,72
Ve 73,73
Ve 74,74
Ve 75,75
Ve 76,76
Ve 77,77
Ve 78,78
Ve 79,79
v_add_f32 v72, 1.0, v72
v_add_f32 v73, 1.0, v73
v_add_f32 v74, 1.0, v74
v_add_f32 v75, 1.0, v75
v_add_f32 v76, 1.0, v76
v_add_f32 v77, 1.0, v77
v_add_f32 v78, 1.0, v78
v_add_f32 v79, 1.0, v79
v_rcp_f32 v72, v72
v_rcp_f32 v73, v73
v_rcp_f32 v74, v74
v_rcp_f32 v75, v75
v_rcp_f32 v76, v76
v_rcp_f32 v77, v77
v_rcp_f32 v78, v78
v_rcp_f32 v79, v79
Vm 56,56,72
Vm 57,57,73
Vm 58,58,74
Vm 59,59,75
Vm 60,60,76
Vm 61,61,77
Vm 62,62,78
Vm 63,63,79
Vc 72,56,57
v_lshlrev_b32 v56, 16, v72
v_and_b32 v57, 0xffff0000, v72
Vc 73,58,59
v_lshlrev_b32 v58, 16, v73
v_and_b32 v59, 0xffff0000, v73
Vc 74,60,61
v_lshlrev_b32 v60, 16, v74
v_and_b32 v61, 0xffff0000, v74
Vc 75,62,63
v_lshlrev_b32 v62, 16, v75
v_and_b32 v63, 0xffff0000, v75
L_oproj_kernel_selskip7:
v_add_u32 v1, 96, v10
v_cmp_eq_u32 vcc, s52, v1
v_cmp_eq_u32 s[60:61], s53, v1
s_nop 3
s_or_b64 s[56:57], vcc, s[60:61]
s_cbranch_scc0 L_oproj_kernel_selskip8
v_cndmask_b32 v96, 0, v80, vcc
v_cndmask_b32 v96, v96, v88, s[60:61]
v_cndmask_b32 v97, 0, v81, vcc
v_cndmask_b32 v97, v97, v89, s[60:61]
v_cndmask_b32 v98, 0, v82, vcc
v_cndmask_b32 v98, v98, v90, s[60:61]
v_cndmask_b32 v99, 0, v83, vcc
v_cndmask_b32 v99, v99, v91, s[60:61]
v_cndmask_b32 v100, 0, v84, vcc
v_cndmask_b32 v100, v100, v92, s[60:61]
v_cndmask_b32 v101, 0, v85, vcc
v_cndmask_b32 v101, v101, v93, s[60:61]
v_cndmask_b32 v102, 0, v86, vcc
v_cndmask_b32 v102, v102, v94, s[60:61]
v_cndmask_b32 v103, 0, v87, vcc
v_cndmask_b32 v103, v103, v95, s[60:61]
v_lshlrev_b32 v64, 16, v28
v_and_b32 v65, 0xffff0000, v28
v_lshlrev_b32 v66, 16, v29
v_and_b32 v67, 0xffff0000, v29
v_lshlrev_b32 v68, 16, v30
v_and_b32 v69, 0xffff0000, v30
v_lshlrev_b32 v70, 16, v31
v_and_b32 v71, 0xffff0000, v31
Vs 64,64,38
Vs 65,65,38
Vs 66,66,38
Vs 67,67,38
Vs 68,68,38
Vs 69,69,38
Vs 70,70,38
Vs 71,71,38
Vc 72,64,65
v_lshlrev_b32 v64, 16, v72
v_and_b32 v65, 0xffff0000, v72
Vc 73,66,67
v_lshlrev_b32 v66, 16, v73
v_and_b32 v67, 0xffff0000, v73
Vc 74,68,69
v_lshlrev_b32 v68, 16, v74
v_and_b32 v69, 0xffff0000, v74
Vc 75,70,71
v_lshlrev_b32 v70, 16, v75
v_and_b32 v71, 0xffff0000, v75
Vm 64,64,39
Vm 65,65,39
Vm 66,66,39
Vm 67,67,39
Vm 68,68,39
Vm 69,69,39
Vm 70,70,39
Vm 71,71,39
Vc 72,64,65
v_lshlrev_b32 v64, 16, v72
v_and_b32 v65, 0xffff0000, v72
Vc 73,66,67
v_lshlrev_b32 v66, 16, v73
v_and_b32 v67, 0xffff0000, v73
Vc 74,68,69
v_lshlrev_b32 v68, 16, v74
v_and_b32 v69, 0xffff0000, v74
Vc 75,70,71
v_lshlrev_b32 v70, 16, v75
v_and_b32 v71, 0xffff0000, v75
Va 64,64,96
Va 65,65,97
Va 66,66,98
Va 67,67,99
Va 68,68,100
Va 69,69,101
Va 70,70,102
Va 71,71,103
Vc 72,64,65
v_lshlrev_b32 v64, 16, v72
v_and_b32 v65, 0xffff0000, v72
Vc 73,66,67
v_lshlrev_b32 v66, 16, v73
v_and_b32 v67, 0xffff0000, v73
Vc 74,68,69
v_lshlrev_b32 v68, 16, v74
v_and_b32 v69, 0xffff0000, v74
Vc 75,70,71
v_lshlrev_b32 v70, 16, v75
v_and_b32 v71, 0xffff0000, v75
v_mul_f32 v72, 0xbfb8aa3b, v64
v_mul_f32 v73, 0xbfb8aa3b, v65
v_mul_f32 v74, 0xbfb8aa3b, v66
v_mul_f32 v75, 0xbfb8aa3b, v67
v_mul_f32 v76, 0xbfb8aa3b, v68
v_mul_f32 v77, 0xbfb8aa3b, v69
v_mul_f32 v78, 0xbfb8aa3b, v70
v_mul_f32 v79, 0xbfb8aa3b, v71
Ve 72,72
Ve 73,73
Ve 74,74
Ve 75,75
Ve 76,76
Ve 77,77
Ve 78,78
Ve 79,79
v_add_f32 v72, 1.0, v72
v_add_f32 v73, 1.0, v73
v_add_f32 v74, 1.0, v74
v_add_f32 v75, 1.0, v75
v_add_f32 v76, 1.0, v76
v_add_f32 v77, 1.0, v77
v_add_f32 v78, 1.0, v78
v_add_f32 v79, 1.0, v79
v_rcp_f32 v72, v72
v_rcp_f32 v73, v73
v_rcp_f32 v74, v74
v_rcp_f32 v75, v75
v_rcp_f32 v76, v76
v_rcp_f32 v77, v77
v_rcp_f32 v78, v78
v_rcp_f32 v79, v79
Vm 64,64,72
Vm 65,65,73
Vm 66,66,74
Vm 67,67,75
Vm 68,68,76
Vm 69,69,77
Vm 70,70,78
Vm 71,71,79
Vc 72,64,65
v_lshlrev_b32 v64, 16, v72
v_and_b32 v65, 0xffff0000, v72
Vc 73,66,67
v_lshlrev_b32 v66, 16, v73
v_and_b32 v67, 0xffff0000, v73
Vc 74,68,69
v_lshlrev_b32 v68, 16, v74
v_and_b32 v69, 0xffff0000, v74
Vc 75,70,71
v_lshlrev_b32 v70, 16, v75
v_and_b32 v71, 0xffff0000, v75
L_oproj_kernel_selskip8:
s_branch L_k3_selr
.section .rodata,"a"
.p2align 6
.amdhsa_kernel front_kernel
  .amdhsa_next_free_vgpr 512
  .amdhsa_next_free_sgpr 102
  .amdhsa_accum_offset 256
  .amdhsa_group_segment_fixed_size 0
  .amdhsa_kernarg_size 112
  .amdhsa_user_sgpr_count 2
  .amdhsa_user_sgpr_kernarg_segment_ptr 1
  .amdhsa_system_sgpr_workgroup_id_x 1
.end_amdhsa_kernel
.p2align 6
.amdhsa_kernel oproj_kernel
  .amdhsa_next_free_vgpr 416
  .amdhsa_next_free_sgpr 102
  .amdhsa_accum_offset 256
  .amdhsa_group_segment_fixed_size 0
  .amdhsa_kernarg_size 112
  .amdhsa_user_sgpr_count 2
  .amdhsa_user_sgpr_kernarg_segment_ptr 1
  .amdhsa_system_sgpr_workgroup_id_x 1
.end_amdhsa_kernel
```

```asm
; @launch kernel=front_kernel grid=(256,1,1) block=(256,1,1) lds=148480
; @launch kernel=oproj_kernel grid=(256,1,1) block=(256,1,1) lds=135168
.amdgcn_target "amdgcn-amd-amdhsa--gfx950"
.macro Va d,x,y
v_add_f32 v\d, v\x, v\y
.endm
.macro Vc d,x,y
v_cvt_pk_bf16_f32 v\d, v\x, v\y
.endm
.macro Ta d,x,o
ds_read_b64_tr_b16 a[\d:\d+1], v\x offset:\o
.endm
.macro Ra d,x,o
ds_read_b128 a[\d:\d+3], v\x offset:\o
.endm
.macro Zvaa d,x,y
v_mfma_f32_16x16x32_bf16 v[\d:\d+3], a[\x:\x+3], a[\y:\y+3], 0
.endm
.macro Rv d,x,o
ds_read_b128 v[\d:\d+3], v\x offset:\o
.endm
.macro Zaaa d,x,y
v_mfma_f32_16x16x32_bf16 a[\d:\d+3], a[\x:\x+3], a[\y:\y+3], 0
.endm
.macro Mvaa d,x,y
v_mfma_f32_16x16x32_bf16 v[\d:\d+3], a[\x:\x+3], a[\y:\y+3], v[\d:\d+3]
.endm
.macro Maaa d,x,y
v_mfma_f32_16x16x32_bf16 a[\d:\d+3], a[\x:\x+3], a[\y:\y+3], a[\d:\d+3]
.endm
.macro Ar d,x
v_accvgpr_read_b32 v\d, a\x
.endm
.macro Ve d,x
v_exp_f32 v\d, v\x
.endm
.macro Aw d,x
v_accvgpr_write_b32 a\d, v\x
.endm
.macro Vs d,x,y
v_sub_f32 v\d, v\x, v\y
.endm
.macro Cvaa d,x,y,c
v_mfma_f32_16x16x32_bf16 v[\d:\d+3], a[\x:\x+3], a[\y:\y+3], v[\c:\c+3]
.endm
.macro Maav d,x,y
v_mfma_f32_16x16x32_bf16 a[\d:\d+3], a[\x:\x+3], v[\y:\y+3], a[\d:\d+3]
.endm
.macro Mvvv d,x,y
v_mfma_f32_16x16x32_bf16 v[\d:\d+3], v[\x:\x+3], v[\y:\y+3], v[\d:\d+3]
.endm
.macro Vm d,x,y
v_mul_f32 v\d, v\x, v\y
.endm
.macro Zvva d,x,y
v_mfma_f32_16x16x32_bf16 v[\d:\d+3], v[\x:\x+3], a[\y:\y+3], 0
.endm
.macro Mvva d,x,y
v_mfma_f32_16x16x32_bf16 v[\d:\d+3], v[\x:\x+3], a[\y:\y+3], v[\d:\d+3]
.endm
.macro Vf d,x,y
v_fmac_f32 v\d, v\x, v\y
.endm
.text
.globl front_kernel
.p2align 8
.type front_kernel,@function
front_kernel:
s_cmp_ge_u32 s2, 256
s_cbranch_scc1 L_k2_end
s_load_dwordx4 s[4:7], s[0:1], 0
s_load_dwordx2 s[44:45], s[0:1], 56
s_load_dwordx4 s[40:43], s[0:1], 24
s_load_dwordx4 s[64:67], s[0:1], 96
v_lshrrev_b32 v1, 6, v0
v_and_b32 v0, 63, v0
v_readfirstlane_b32 s32, v1
v_lshrrev_b32 v33, 5, v0
v_and_b32 v31, 31, v0
v_lshlrev_b32 v36, 4, v31
v_lshl_add_u32 v35, v33, 11, v36
s_lshl_b32 s36, s2, 14
s_lshl_b32 s37, s32, 12
s_add_u32 s36, s36, s37
s_lshr_b32 s3, s2, 3
s_and_b32 s33, s3, 7
s_lshr_b32 s3, s3, 3
s_lshr_b32 s35, s3, 1
s_and_b32 s3, s3, 1
s_and_b32 s34, s2, 7
s_lshl_b32 s34, s34, 1
s_add_u32 s34, s34, s3
s_mov_b32 s48, 0
s_mov_b32 s52, 0
s_mov_b32 s49, 7168
s_mov_b32 s53, 15360
s_mov_b32 s50, 14336
s_mov_b32 s54, 30720
s_mov_b32 s51, 21504
s_mov_b32 s55, 46080
s_lshl_b32 s56, s32, 13
s_add_u32 s57, s56, 32768
s_lshl_b32 s3, s32, 4
v_add_u32 v30, s3, v33
v_lshlrev_b32 v30, 13, v30
v_lshlrev_b32 v34, 1, v33
v_xor_b32 v31, v31, v34
v_xor_b32 v34, 0, v31
v_lshl_add_u32 v6, v34, 4, v30
v_xor_b32 v34, 4, v31
v_lshl_add_u32 v7, v34, 4, v30
v_xor_b32 v34, 8, v31
v_lshl_add_u32 v8, v34, 4, v30
v_add_u32 v8, 65536, v8
v_xor_b32 v34, 12, v31
v_lshl_add_u32 v9, v34, 4, v30
v_add_u32 v9, 65536, v9
v_lshrrev_b32 v30, 3, v0
s_lshl_b32 s3, s32, 6
v_add_u32 v30, s3, v30
v_lshlrev_b32 v30, 10, v30
v_and_b32 v31, 7, v0
v_lshrrev_b32 v32, 4, v0
v_xor_b32 v31, v31, v32
v_lshl_add_u32 v2, v31, 4, v30
v_xor_b32 v31, 4, v31
v_lshl_add_u32 v3, v31, 4, v30
v_add_u32 v4, 32768, v2
v_add_u32 v5, 32768, v3
s_waitcnt lgkmcnt(0)
s_mov_b32 s16, s4
s_and_b32 s17, s5, 0xffff
s_mov_b32 s18, 4194304
s_mov_b32 s19, 0x20000
buffer_load_dwordx4 v[48:51], v35, s[16:19], s36 offen offset:0 nt
buffer_load_dwordx4 v[52:55], v35, s[16:19], s36 offen offset:512 nt
buffer_load_dwordx4 v[56:59], v35, s[16:19], s36 offen offset:1024 nt
buffer_load_dwordx4 v[60:63], v35, s[16:19], s36 offen offset:1536 nt
s_getpc_b64 s[68:69]
L_cpf1:
s_add_u32 s68, s68, (front_kernel-L_cpf1)&0xffffffff
s_addc_u32 s69, s69, ((front_kernel-L_cpf1)>>32)&0xffffffff
s_lshr_b32 s70, s2, 3
s_lshl_b32 s70, s70, 2
s_add_u32 s70, s70, s32
s_lshl_b32 s70, s70, 10
v_and_b32 v122, 7, v0
v_lshlrev_b32 v122, 7, v122
v_add_u32 v122, s70, v122
v_min_u32 v122, L_k2_end-front_kernel-4, v122
v_mov_b32 v121, s69
v_add_co_u32 v120, vcc, s68, v122
s_nop 1
v_addc_co_u32 v121, vcc, 0, v121, vcc
global_load_dword v124, v[120:121], off
s_cmp_eq_u32 s35, 0
s_cselect_b32 s40, s40, s42
s_cselect_b32 s41, s41, s43
s_lshl_b32 s3, s34, 9
s_add_u32 s12, s40, s3
s_addc_u32 s13, s41, 0
s_and_b32 s13, s13, 0xffff
s_mov_b32 s14, 0
s_mov_b32 s15, 0x20000
s_sub_u32 s14, 4194304, s3
s_lshl_b32 s3, s33, 18
s_add_u32 s8, s6, s3
s_addc_u32 s9, s7, 0
s_and_b32 s9, s9, 0xffff
s_mov_b32 s10, 262144
s_mov_b32 s11, 0x20000
s_add_u32 m0, s57, 0
s_nop 0
buffer_load_dwordx4 v6, s[12:15], s52 offen offset:0 nt lds
buffer_load_dwordx4 v7, s[12:15], s53 offen offset:1024 nt lds
buffer_load_dwordx4 v6, s[12:15], s54 offen offset:2048 nt lds
buffer_load_dwordx4 v7, s[12:15], s55 offen offset:3072 nt lds
s_add_u32 m0, s57, 4096
s_nop 0
buffer_load_dwordx4 v8, s[12:15], s52 offen offset:0 nt lds
buffer_load_dwordx4 v9, s[12:15], s53 offen offset:1024 nt lds
buffer_load_dwordx4 v8, s[12:15], s54 offen offset:2048 nt lds
buffer_load_dwordx4 v9, s[12:15], s55 offen offset:3072 nt lds
s_mov_b32 s28, s44
s_and_b32 s29, s45, 0xffff
s_mov_b32 s30, 2048
s_mov_b32 s31, 0x20000
s_mov_b32 s20, s66
s_and_b32 s21, s67, 0xffff
s_mov_b32 s22, 8388608
s_mov_b32 s23, 0x20000
s_add_u32 s24, s66, 8388608
s_addc_u32 s25, s67, 0
s_and_b32 s25, s25, 0xffff
s_mov_b32 s26, 35717120
s_mov_b32 s27, 0x20000
v_and_b32 v30, 15, v0
s_lshr_b32 s3, s32, 1
s_lshl_b32 s3, s3, 14
v_lshlrev_b32 v31, 7, v30
v_add_u32 v31, s3, v31
v_lshrrev_b32 v34, 1, v30
v_xor_b32 v34, v34, v32
v_lshl_add_u32 v10, v34, 4, v31
v_xor_b32 v34, 4, v34
v_lshl_add_u32 v11, v34, 4, v31
v_lshrrev_b32 v30, 2, v30
v_lshl_add_u32 v31, v32, 3, v30
v_lshlrev_b32 v31, 9, v31
v_and_b32 v34, 3, v0
v_lshl_add_u32 v31, v34, 3, v31
s_and_b32 s3, s32, 1
s_lshl_b32 s3, s3, 8
s_add_u32 s3, s3, 32768
v_add_u32 v31, s3, v31
v_and_b32 v34, 1, v32
v_lshl_add_u32 v30, v34, 2, v30
v_xor_b32 v34, 0, v30
v_lshl_add_u32 v12, v34, 5, v31
v_xor_b32 v34, 1, v30
v_lshl_add_u32 v13, v34, 5, v31
v_xor_b32 v34, 2, v30
v_lshl_add_u32 v14, v34, 5, v31
v_xor_b32 v34, 3, v30
v_lshl_add_u32 v15, v34, 5, v31
v_xor_b32 v34, 4, v30
v_lshl_add_u32 v16, v34, 5, v31
v_xor_b32 v34, 5, v30
v_lshl_add_u32 v17, v34, 5, v31
v_xor_b32 v34, 6, v30
v_lshl_add_u32 v18, v34, 5, v31
v_xor_b32 v34, 7, v30
v_lshl_add_u32 v19, v34, 5, v31
v_add_u32 v20, 65536, v10
v_add_u32 v21, 65536, v11
v_add_u32 v22, 65536, v12
v_add_u32 v23, 65536, v13
v_add_u32 v24, 65536, v14
v_add_u32 v25, 65536, v15
v_add_u32 v26, 65536, v16
v_add_u32 v27, 65536, v17
v_add_u32 v28, 65536, v18
v_add_u32 v29, 65536, v19
s_cmp_lt_u32 s32, 2
s_cselect_b32 s60, s8, s12
s_cselect_b32 s61, s9, s13
s_cselect_b32 s62, s10, s14
s_mov_b32 s63, 0x20000
s_mov_b32 s59, 524288
s_cselect_b32 s59, 128, s59
s_lshr_b32 s3, s2, 6
s_lshl_b32 s3, s3, 1
s_add_u32 s3, s3, s32
s_lshl_b32 s3, s3, 15
s_add_u32 s3, s3, 256
v_lshlrev_b32 v37, 10, v0
v_add_u32 v37, s3, v37
v_lshrrev_b32 v38, 2, v0
v_lshlrev_b32 v38, 13, v38
v_and_b32 v39, 3, v0
v_lshl_add_u32 v38, v39, 7, v38
s_lshl_b32 s39, s33, 1
s_add_u32 s39, s39, s32
s_lshl_b32 s39, s39, 15
s_add_u32 s39, s39, 983040
v_add_u32 v38, s39, v38
s_cmp_lt_u32 s32, 2
s_cselect_b64 vcc, -1, 0
s_cselect_b32 s3, 32, 16
v_cndmask_b32 v47, v38, v37, vcc
v_cmp_gt_u32 vcc, s3, v0
v_mov_b32 v37, 2146435072
s_nop 0
v_cndmask_b32 v47, v37, v47, vcc
s_add_u32 m0, s56, 0
s_nop 0
buffer_load_dwordx4 v2, s[8:11], s48 offen offset:0 lds
buffer_load_dwordx4 v3, s[8:11], s49 offen offset:1024 lds
buffer_load_dwordx4 v2, s[8:11], s50 offen offset:2048 lds
buffer_load_dwordx4 v3, s[8:11], s51 offen offset:3072 lds
s_add_u32 m0, s56, 4096
s_nop 0
buffer_load_dwordx4 v4, s[8:11], s48 offen offset:0 lds
buffer_load_dwordx4 v5, s[8:11], s49 offen offset:1024 lds
buffer_load_dwordx4 v4, s[8:11], s50 offen offset:2048 lds
buffer_load_dwordx4 v5, s[8:11], s51 offen offset:3072 lds
buffer_load_dwordx4 v[64:67], v36, s[28:31], 0 offen offset:0
buffer_load_dwordx4 v[68:71], v36, s[28:31], 0 offen offset:512
buffer_load_dwordx4 v[72:75], v36, s[28:31], 0 offen offset:1024
buffer_load_dwordx4 v[76:79], v36, s[28:31], 0 offen offset:1536
v_add_u32 v6, 524288, v6
v_add_u32 v7, 524288, v7
v_add_u32 v8, 524288, v8
v_add_u32 v9, 524288, v9
v_add_u32 v2, 128, v2
v_add_u32 v3, 128, v3
v_add_u32 v4, 128, v4
v_add_u32 v5, 128, v5
s_waitcnt vmcnt(21)
v_lshlrev_b32 v80, 16, v48
v_and_b32 v81, 0xffff0000, v48
v_lshlrev_b32 v82, 16, v49
v_and_b32 v83, 0xffff0000, v49
v_lshlrev_b32 v84, 16, v50
v_and_b32 v85, 0xffff0000, v50
v_lshlrev_b32 v86, 16, v51
v_and_b32 v87, 0xffff0000, v51
v_lshlrev_b32 v88, 16, v52
v_and_b32 v89, 0xffff0000, v52
v_lshlrev_b32 v90, 16, v53
v_and_b32 v91, 0xffff0000, v53
v_lshlrev_b32 v92, 16, v54
v_and_b32 v93, 0xffff0000, v54
v_lshlrev_b32 v94, 16, v55
v_and_b32 v95, 0xffff0000, v55
v_lshlrev_b32 v96, 16, v56
v_and_b32 v97, 0xffff0000, v56
v_lshlrev_b32 v98, 16, v57
v_and_b32 v99, 0xffff0000, v57
v_lshlrev_b32 v100, 16, v58
v_and_b32 v101, 0xffff0000, v58
v_lshlrev_b32 v102, 16, v59
v_and_b32 v103, 0xffff0000, v59
v_lshlrev_b32 v104, 16, v60
v_and_b32 v105, 0xffff0000, v60
v_lshlrev_b32 v106, 16, v61
v_and_b32 v107, 0xffff0000, v61
v_lshlrev_b32 v108, 16, v62
v_and_b32 v109, 0xffff0000, v62
v_lshlrev_b32 v110, 16, v63
v_and_b32 v111, 0xffff0000, v63
v_pk_add_f32 v[40:41], v[80:81], v[82:83]
v_pk_add_f32 v[42:43], v[84:85], v[86:87]
v_pk_add_f32 v[40:41], v[40:41], v[88:89]
v_pk_add_f32 v[42:43], v[42:43], v[90:91]
v_pk_add_f32 v[40:41], v[40:41], v[92:93]
v_pk_add_f32 v[42:43], v[42:43], v[94:95]
v_pk_add_f32 v[40:41], v[40:41], v[96:97]
v_pk_add_f32 v[42:43], v[42:43], v[98:99]
v_pk_add_f32 v[40:41], v[40:41], v[100:101]
v_pk_add_f32 v[42:43], v[42:43], v[102:103]
v_pk_add_f32 v[40:41], v[40:41], v[104:105]
v_pk_add_f32 v[42:43], v[42:43], v[106:107]
v_pk_add_f32 v[40:41], v[40:41], v[108:109]
v_pk_add_f32 v[42:43], v[42:43], v[110:111]
v_pk_add_f32 v[40:41], v[40:41], v[42:43]
Va 38,40,41
s_nop 1
v_add_f32_dpp v38, v38, v38 quad_perm:[1,0,3,2] row_mask:0xf bank_mask:0xf
s_nop 1
v_add_f32_dpp v38, v38, v38 quad_perm:[2,3,0,1] row_mask:0xf bank_mask:0xf
s_nop 1
v_add_f32_dpp v38, v38, v38 row_half_mirror row_mask:0xf bank_mask:0xf
s_nop 1
v_add_f32_dpp v38, v38, v38 row_mirror row_mask:0xf bank_mask:0xf
v_mov_b32 v37, v38
s_nop 1
v_permlane16_swap_b32 v37, v38
Va 38,38,37
s_add_u32 m0, s57, 65536
s_nop 0
buffer_load_dwordx4 v6, s[12:15], s52 offen offset:0 nt lds
buffer_load_dwordx4 v7, s[12:15], s53 offen offset:1024 nt lds
buffer_load_dwordx4 v6, s[12:15], s54 offen offset:2048 nt lds
buffer_load_dwordx4 v7, s[12:15], s55 offen offset:3072 nt lds
s_add_u32 m0, s57, 69632
s_nop 0
buffer_load_dwordx4 v8, s[12:15], s52 offen offset:0 nt lds
buffer_load_dwordx4 v9, s[12:15], s53 offen offset:1024 nt lds
buffer_load_dwordx4 v8, s[12:15], s54 offen offset:2048 nt lds
buffer_load_dwordx4 v9, s[12:15], s55 offen offset:3072 nt lds
v_mul_f32 v38, 0xba800000, v38
v_mov_b32 v39, v38
v_pk_add_f32 v[112:113], v[80:81], v[38:39]
v_pk_mul_f32 v[40:41], v[112:113], v[112:113]
v_pk_add_f32 v[114:115], v[82:83], v[38:39]
v_pk_mul_f32 v[42:43], v[114:115], v[114:115]
v_pk_add_f32 v[116:117], v[84:85], v[38:39]
v_pk_fma_f32 v[40:41], v[116:117], v[116:117], v[40:41]
v_pk_add_f32 v[118:119], v[86:87], v[38:39]
v_pk_fma_f32 v[42:43], v[118:119], v[118:119], v[42:43]
v_pk_add_f32 v[112:113], v[88:89], v[38:39]
v_pk_fma_f32 v[40:41], v[112:113], v[112:113], v[40:41]
v_pk_add_f32 v[114:115], v[90:91], v[38:39]
v_pk_fma_f32 v[42:43], v[114:115], v[114:115], v[42:43]
v_pk_add_f32 v[116:117], v[92:93], v[38:39]
v_pk_fma_f32 v[40:41], v[116:117], v[116:117], v[40:41]
v_pk_add_f32 v[118:119], v[94:95], v[38:39]
v_pk_fma_f32 v[42:43], v[118:119], v[118:119], v[42:43]
v_pk_add_f32 v[112:113], v[96:97], v[38:39]
v_pk_fma_f32 v[40:41], v[112:113], v[112:113], v[40:41]
v_pk_add_f32 v[114:115], v[98:99], v[38:39]
v_pk_fma_f32 v[42:43], v[114:115], v[114:115], v[42:43]
v_pk_add_f32 v[116:117], v[100:101], v[38:39]
v_pk_fma_f32 v[40:41], v[116:117], v[116:117], v[40:41]
v_pk_add_f32 v[118:119], v[102:103], v[38:39]
v_pk_fma_f32 v[42:43], v[118:119], v[118:119], v[42:43]
v_pk_add_f32 v[112:113], v[104:105], v[38:39]
v_pk_fma_f32 v[40:41], v[112:113], v[112:113], v[40:41]
v_pk_add_f32 v[114:115], v[106:107], v[38:39]
v_pk_fma_f32 v[42:43], v[114:115], v[114:115], v[42:43]
v_pk_add_f32 v[116:117], v[108:109], v[38:39]
v_pk_fma_f32 v[40:41], v[116:117], v[116:117], v[40:41]
v_pk_add_f32 v[118:119], v[110:111], v[38:39]
v_pk_fma_f32 v[42:43], v[118:119], v[118:119], v[42:43]
v_pk_add_f32 v[40:41], v[40:41], v[42:43]
Va 40,40,41
s_nop 1
v_add_f32_dpp v40, v40, v40 quad_perm:[1,0,3,2] row_mask:0xf bank_mask:0xf
s_nop 1
v_add_f32_dpp v40, v40, v40 quad_perm:[2,3,0,1] row_mask:0xf bank_mask:0xf
s_nop 1
v_add_f32_dpp v40, v40, v40 row_half_mirror row_mask:0xf bank_mask:0xf
s_nop 1
v_add_f32_dpp v40, v40, v40 row_mirror row_mask:0xf bank_mask:0xf
v_mov_b32 v37, v40
s_nop 1
v_permlane16_swap_b32 v37, v40
Va 40,40,37
s_add_u32 m0, s56, 65536
s_nop 0
buffer_load_dwordx4 v2, s[8:11], s48 offen offset:0 lds
buffer_load_dwordx4 v3, s[8:11], s49 offen offset:1024 lds
buffer_load_dwordx4 v2, s[8:11], s50 offen offset:2048 lds
buffer_load_dwordx4 v3, s[8:11], s51 offen offset:3072 lds
s_add_u32 m0, s56, 69632
s_nop 0
buffer_load_dwordx4 v4, s[8:11], s48 offen offset:0 lds
buffer_load_dwordx4 v5, s[8:11], s49 offen offset:1024 lds
buffer_load_dwordx4 v4, s[8:11], s50 offen offset:2048 lds
buffer_load_dwordx4 v5, s[8:11], s51 offen offset:3072 lds
v_mul_f32 v40, 0x3a800000, v40
Vc 44,38,40
v_lshlrev_b32 v38, 16, v44
v_and_b32 v40, 0xffff0000, v44
v_add_f32 v40, 0x3727c5ac, v40
Vc 44,40,40
v_lshlrev_b32 v40, 16, v44
v_sqrt_f32 v40, v40
v_mov_b32 v39, v38
Vc 44,40,40
v_lshlrev_b32 v44, 16, v44
v_rcp_f32 v40, v44
v_pk_add_f32 v[80:81], v[80:81], v[38:39]
v_pk_add_f32 v[82:83], v[82:83], v[38:39]
v_pk_add_f32 v[84:85], v[84:85], v[38:39]
v_pk_add_f32 v[86:87], v[86:87], v[38:39]
v_pk_add_f32 v[88:89], v[88:89], v[38:39]
v_pk_add_f32 v[90:91], v[90:91], v[38:39]
v_pk_add_f32 v[92:93], v[92:93], v[38:39]
v_pk_add_f32 v[94:95], v[94:95], v[38:39]
v_pk_add_f32 v[96:97], v[96:97], v[38:39]
v_pk_add_f32 v[98:99], v[98:99], v[38:39]
v_pk_add_f32 v[100:101], v[100:101], v[38:39]
v_pk_add_f32 v[102:103], v[102:103], v[38:39]
v_pk_add_f32 v[104:105], v[104:105], v[38:39]
v_pk_add_f32 v[106:107], v[106:107], v[38:39]
v_pk_add_f32 v[108:109], v[108:109], v[38:39]
v_pk_add_f32 v[110:111], v[110:111], v[38:39]
v_fma_f32 v45, -v44, v40, 1.0
v_fma_f32 v40, v45, v40, v40
v_mov_b32 v41, v40
Vc 48,80,81
Vc 49,82,83
Vc 50,84,85
Vc 51,86,87
Vc 52,88,89
Vc 53,90,91
Vc 54,92,93
Vc 55,94,95
Vc 56,96,97
Vc 57,98,99
Vc 58,100,101
Vc 59,102,103
Vc 60,104,105
Vc 61,106,107
Vc 62,108,109
Vc 63,110,111
v_lshlrev_b32 v80, 16, v48
v_and_b32 v81, 0xffff0000, v48
v_lshlrev_b32 v82, 16, v49
v_and_b32 v83, 0xffff0000, v49
v_lshlrev_b32 v84, 16, v50
v_and_b32 v85, 0xffff0000, v50
v_lshlrev_b32 v86, 16, v51
v_and_b32 v87, 0xffff0000, v51
v_lshlrev_b32 v88, 16, v52
v_and_b32 v89, 0xffff0000, v52
v_lshlrev_b32 v90, 16, v53
v_and_b32 v91, 0xffff0000, v53
v_lshlrev_b32 v92, 16, v54
v_and_b32 v93, 0xffff0000, v54
v_lshlrev_b32 v94, 16, v55
v_and_b32 v95, 0xffff0000, v55
v_lshlrev_b32 v96, 16, v56
v_and_b32 v97, 0xffff0000, v56
v_lshlrev_b32 v98, 16, v57
v_and_b32 v99, 0xffff0000, v57
v_lshlrev_b32 v100, 16, v58
v_and_b32 v101, 0xffff0000, v58
v_lshlrev_b32 v102, 16, v59
v_and_b32 v103, 0xffff0000, v59
v_lshlrev_b32 v104, 16, v60
v_and_b32 v105, 0xffff0000, v60
v_lshlrev_b32 v106, 16, v61
v_and_b32 v107, 0xffff0000, v61
v_lshlrev_b32 v108, 16, v62
v_and_b32 v109, 0xffff0000, v62
v_lshlrev_b32 v110, 16, v63
v_and_b32 v111, 0xffff0000, v63
v_pk_mul_f32 v[80:81], v[80:81], v[40:41]
v_pk_mul_f32 v[82:83], v[82:83], v[40:41]
v_pk_mul_f32 v[84:85], v[84:85], v[40:41]
v_pk_mul_f32 v[86:87], v[86:87], v[40:41]
v_pk_mul_f32 v[88:89], v[88:89], v[40:41]
v_pk_mul_f32 v[90:91], v[90:91], v[40:41]
v_pk_mul_f32 v[92:93], v[92:93], v[40:41]
v_pk_mul_f32 v[94:95], v[94:95], v[40:41]
v_pk_mul_f32 v[96:97], v[96:97], v[40:41]
v_pk_mul_f32 v[98:99], v[98:99], v[40:41]
v_pk_mul_f32 v[100:101], v[100:101], v[40:41]
v_pk_mul_f32 v[102:103], v[102:103], v[40:41]
v_pk_mul_f32 v[104:105], v[104:105], v[40:41]
v_pk_mul_f32 v[106:107], v[106:107], v[40:41]
v_pk_mul_f32 v[108:109], v[108:109], v[40:41]
v_pk_mul_f32 v[110:111], v[110:111], v[40:41]
Vc 48,80,81
Vc 49,82,83
Vc 50,84,85
Vc 51,86,87
Vc 52,88,89
Vc 53,90,91
Vc 54,92,93
Vc 55,94,95
Vc 56,96,97
Vc 57,98,99
Vc 58,100,101
Vc 59,102,103
Vc 60,104,105
Vc 61,106,107
Vc 62,108,109
Vc 63,110,111
s_mul_i32 s3, s32, 4128
s_add_u32 s3, s3, 131072
v_mul_u32_u24 v42, 2064, v33
v_add3_u32 v42, v42, v36, s3
ds_write_b128 v42, v[48:51] offset:0
ds_write_b128 v42, v[52:55] offset:512
ds_write_b128 v42, v[56:59] offset:1024
ds_write_b128 v42, v[60:63] offset:1536
v_add_u32 v6, 524288, v6
v_add_u32 v7, 524288, v7
v_add_u32 v8, 524288, v8
v_add_u32 v9, 524288, v9
v_add_u32 v2, 128, v2
v_add_u32 v3, 128, v3
v_add_u32 v4, 128, v4
v_add_u32 v5, 128, v5
buffer_load_dword v1, v47, s[60:63], 0 offen
v_add_u32 v47, s59, v47
buffer_load_dword v1, v47, s[60:63], 0 offen
v_add_u32 v47, s59, v47
s_waitcnt vmcnt(18)
v_lshlrev_b32 v80, 16, v48
v_and_b32 v81, 0xffff0000, v48
v_lshlrev_b32 v112, 16, v64
v_and_b32 v113, 0xffff0000, v64
v_pk_mul_f32 v[42:43], v[80:81], v[112:113]
v_lshlrev_b32 v82, 16, v49
v_and_b32 v83, 0xffff0000, v49
v_lshlrev_b32 v114, 16, v65
v_and_b32 v115, 0xffff0000, v65
v_pk_mul_f32 v[44:45], v[82:83], v[114:115]
v_lshlrev_b32 v84, 16, v50
v_and_b32 v85, 0xffff0000, v50
v_lshlrev_b32 v116, 16, v66
v_and_b32 v117, 0xffff0000, v66
v_pk_fma_f32 v[42:43], v[84:85], v[116:117], v[42:43]
v_lshlrev_b32 v86, 16, v51
v_and_b32 v87, 0xffff0000, v51
v_lshlrev_b32 v118, 16, v67
v_and_b32 v119, 0xffff0000, v67
v_pk_fma_f32 v[44:45], v[86:87], v[118:119], v[44:45]
v_lshlrev_b32 v88, 16, v52
v_and_b32 v89, 0xffff0000, v52
v_lshlrev_b32 v112, 16, v68
v_and_b32 v113, 0xffff0000, v68
v_pk_fma_f32 v[42:43], v[88:89], v[112:113], v[42:43]
v_lshlrev_b32 v90, 16, v53
v_and_b32 v91, 0xffff0000, v53
v_lshlrev_b32 v114, 16, v69
v_and_b32 v115, 0xffff0000, v69
v_pk_fma_f32 v[44:45], v[90:91], v[114:115], v[44:45]
v_lshlrev_b32 v92, 16, v54
v_and_b32 v93, 0xffff0000, v54
v_lshlrev_b32 v116, 16, v70
v_and_b32 v117, 0xffff0000, v70
v_pk_fma_f32 v[42:43], v[92:93], v[116:117], v[42:43]
v_lshlrev_b32 v94, 16, v55
v_and_b32 v95, 0xffff0000, v55
v_lshlrev_b32 v118, 16, v71
v_and_b32 v119, 0xffff0000, v71
v_pk_fma_f32 v[44:45], v[94:95], v[118:119], v[44:45]
v_lshlrev_b32 v96, 16, v56
v_and_b32 v97, 0xffff0000, v56
v_lshlrev_b32 v112, 16, v72
v_and_b32 v113, 0xffff0000, v72
v_pk_fma_f32 v[42:43], v[96:97], v[112:113], v[42:43]
v_lshlrev_b32 v98, 16, v57
v_and_b32 v99, 0xffff0000, v57
v_lshlrev_b32 v114, 16, v73
v_and_b32 v115, 0xffff0000, v73
v_pk_fma_f32 v[44:45], v[98:99], v[114:115], v[44:45]
v_lshlrev_b32 v100, 16, v58
v_and_b32 v101, 0xffff0000, v58
v_lshlrev_b32 v116, 16, v74
v_and_b32 v117, 0xffff0000, v74
v_pk_fma_f32 v[42:43], v[100:101], v[116:117], v[42:43]
v_lshlrev_b32 v102, 16, v59
v_and_b32 v103, 0xffff0000, v59
v_lshlrev_b32 v118, 16, v75
v_and_b32 v119, 0xffff0000, v75
v_pk_fma_f32 v[44:45], v[102:103], v[118:119], v[44:45]
v_lshlrev_b32 v104, 16, v60
v_and_b32 v105, 0xffff0000, v60
v_lshlrev_b32 v112, 16, v76
v_and_b32 v113, 0xffff0000, v76
v_pk_fma_f32 v[42:43], v[104:105], v[112:113], v[42:43]
v_lshlrev_b32 v106, 16, v61
v_and_b32 v107, 0xffff0000, v61
v_lshlrev_b32 v114, 16, v77
v_and_b32 v115, 0xffff0000, v77
v_pk_fma_f32 v[44:45], v[106:107], v[114:115], v[44:45]
v_lshlrev_b32 v108, 16, v62
v_and_b32 v109, 0xffff0000, v62
v_lshlrev_b32 v116, 16, v78
v_and_b32 v117, 0xffff0000, v78
v_pk_fma_f32 v[42:43], v[108:109], v[116:117], v[42:43]
v_lshlrev_b32 v110, 16, v63
v_and_b32 v111, 0xffff0000, v63
v_lshlrev_b32 v118, 16, v79
v_and_b32 v119, 0xffff0000, v79
v_pk_fma_f32 v[44:45], v[110:111], v[118:119], v[44:45]
v_pk_add_f32 v[42:43], v[42:43], v[44:45]
Va 45,42,43
s_nop 1
v_add_f32_dpp v45, v45, v45 quad_perm:[1,0,3,2] row_mask:0xf bank_mask:0xf
s_nop 1
v_add_f32_dpp v45, v45, v45 quad_perm:[2,3,0,1] row_mask:0xf bank_mask:0xf
s_nop 1
v_add_f32_dpp v45, v45, v45 row_half_mirror row_mask:0xf bank_mask:0xf
s_nop 1
v_add_f32_dpp v45, v45, v45 row_mirror row_mask:0xf bank_mask:0xf
v_mov_b32 v37, v45
s_nop 1
v_permlane16_swap_b32 v37, v45
Va 45,45,37
Vc 45,45,45
v_ashrrev_i32 v46, 31, v45
v_or_b32 v46, 0x80000000, v46
v_xor_b32 v45, v45, v46
v_and_b32 v45, 0xffff0000, v45
s_lshr_b32 s3, s36, 11
v_add_u32 v46, s3, v33
v_sub_u32 v44, 0xffff, v46
v_or_b32 v45, v45, v44
v_lshlrev_b32 v44, 2, v46
v_lshlrev_b32 v46, 3, v46
v_xor_b32 v38, 0x80000000, v38
v_mov_b32 v39, v40
s_mov_b32 s3, 5242880
s_mov_b32 s39, 5259264
s_mov_b32 exec_lo, 1
s_mov_b32 exec_hi, 1
buffer_store_dword v45, v44, s[20:23], s3 offen sc1
buffer_store_dwordx2 v[38:39], v46, s[20:23], s39 offen
s_mov_b64 exec, -1
s_load_dwordx2 s[4:5], s[0:1], 16
s_load_dwordx4 s[40:43], s[0:1], 64
s_load_dwordx2 s[92:93], s[0:1], 40
s_load_dwordx2 s[94:95], s[0:1], 80
s_load_dwordx2 s[100:101], s[0:1], 0
s_mov_b32 s28, s64
s_and_b32 s29, s65, 0xffff
s_mov_b32 s30, 256
s_mov_b32 s31, 0x20000
s_waitcnt lgkmcnt(0)
s_barrier
Ta 32,12,0
Ta 34,12,2048
Ra 0,10,0
Ta 36,13,0
Ta 38,13,2048
Ra 4,10,2048
Ta 40,14,0
Ta 42,14,2048
Ra 8,10,4096
Ta 44,15,0
Ta 46,15,2048
Ra 12,10,6144
s_waitcnt lgkmcnt(2)
Ta 48,16,0
Ta 50,16,2048
Ra 16,10,8192
Ta 52,17,0
Ta 54,17,2048
Ra 20,10,10240
Ta 56,18,0
Ta 58,18,2048
Ra 24,10,12288
Ta 60,19,0
Ta 62,19,2048
Ra 28,10,14336
s_cmp_lg_u32 s35, 0
s_cbranch_scc1 L_k1_vpath
s_waitcnt lgkmcnt(0)
Zvaa 48,32,0
v_and_b32 v46, 7, v0
v_mul_u32_u24 v30, 2064, v46
Zvaa 52,36,0
Ta 96,12,16384
Ta 98,12,18432
Zvaa 56,40,0
v_lshrrev_b32 v31, 3, v0
Zvaa 60,44,0
Ra 64,11,0
Zvaa 64,48,0
s_lshl_b32 s3, s32, 9
s_add_u32 s3, s3, 131072
v_lshl_add_u32 v30, v31, 4, v30
Zvaa 68,52,0
Ta 100,13,16384
Ta 102,13,18432
Zvaa 72,56,0
v_add_u32 v30, s3, v30
v_lshlrev_b32 v31, 8, v31
Zvaa 76,60,0
s_waitcnt lgkmcnt(6)
Ra 68,11,2048
Zvaa 80,32,4
v_lshl_add_u32 v46, v46, 4, v31
Zvaa 84,36,4
Ta 104,14,16384
Ta 106,14,18432
Zvaa 88,40,4
Rv 34,30,128
Rv 38,30,256
Zvaa 92,44,4
Ra 72,11,4096
Zvaa 96,48,4
Rv 42,30,384
Rv 30,30,0
Zvaa 100,52,4
Ta 108,15,16384
Ta 110,15,18432
Zvaa 104,56,4
s_lshr_b32 s3, s2, 1
s_mul_i32 s3, s3, 33792
s_add_u32 s3, s3, s56
Zvaa 108,60,4
s_waitcnt lgkmcnt(6)
Ra 76,11,6144
Zvaa 112,32,8
s_and_b32 s39, s2, 1
s_lshl_b32 s39, s39, 7
s_add_u32 s3, s3, s39
Zvaa 116,36,8
Ta 112,16,16384
Ta 114,16,18432
Zvaa 120,40,8
s_add_u32 s39, s3, 4096
Zvaa 124,44,8
Ra 80,11,8192
Zvaa 128,48,8
Zvaa 132,52,8
Ta 116,17,16384
Ta 118,17,18432
Zvaa 136,56,8
Zvaa 140,60,8
s_waitcnt lgkmcnt(6)
Ra 84,11,10240
Zvaa 144,32,12
Zvaa 148,36,12
Ta 120,18,16384
Ta 122,18,18432
Zvaa 152,40,12
Zvaa 156,44,12
Ra 88,11,12288
Zvaa 160,48,12
Zvaa 164,52,12
Ta 124,19,16384
Ta 126,19,18432
Zvaa 168,56,12
Zvaa 172,60,12
s_waitcnt lgkmcnt(6)
Ra 92,11,14336
Zvaa 176,32,16
Zvaa 180,36,16
Zvaa 184,40,16
Zvaa 188,44,16
Zvaa 192,48,16
Zvaa 196,52,16
Zvaa 200,56,16
Zvaa 204,60,16
Zvaa 208,32,20
Zvaa 212,36,20
Zvaa 216,40,20
Zvaa 220,44,20
Zvaa 224,48,20
Zvaa 228,52,20
Zvaa 232,56,20
Zvaa 236,60,20
Zvaa 240,32,24
Zvaa 244,36,24
Zvaa 248,40,24
Zvaa 252,44,24
Zaaa 128,48,24
Zaaa 132,52,24
Zaaa 136,56,24
Zaaa 140,60,24
Zaaa 144,32,28
Zaaa 148,36,28
Zaaa 152,40,28
Zaaa 156,44,28
Zaaa 160,48,28
Zaaa 164,52,28
Zaaa 168,56,28
Zaaa 172,60,28
s_waitcnt vmcnt(4) lgkmcnt(0)
s_add_u32 m0, s57, 0
s_barrier
Mvaa 48,96,64
buffer_load_dwordx4 v6, s[12:15], s52 offen offset:0 nt lds
Mvaa 52,100,64
Ta 32,22,0
Ta 34,22,2048
Mvaa 56,104,64
Mvaa 60,108,64
Ra 0,20,0
Mvaa 64,112,64
buffer_load_dwordx4 v7, s[12:15], s53 offen offset:1024 nt lds
Mvaa 68,116,64
s_waitcnt lgkmcnt(6)
Ta 36,23,0
Ta 38,23,2048
Mvaa 72,120,64
Mvaa 76,124,64
Ra 4,20,2048
Mvaa 80,96,68
buffer_load_dwordx4 v6, s[12:15], s54 offen offset:2048 nt lds
Mvaa 84,100,68
Ta 40,24,0
Ta 42,24,2048
Mvaa 88,104,68
Mvaa 92,108,68
Ra 8,20,4096
Mvaa 96,112,68
buffer_load_dwordx4 v7, s[12:15], s55 offen offset:3072 nt lds
Mvaa 100,116,68
s_waitcnt lgkmcnt(6)
Ta 44,25,0
Ta 46,25,2048
Mvaa 104,120,68
Mvaa 108,124,68
s_add_u32 m0, s57, 4096
Ra 12,20,6144
Mvaa 112,96,72
buffer_load_dwordx4 v8, s[12:15], s52 offen offset:0 nt lds
Mvaa 116,100,72
Ta 48,26,0
Ta 50,26,2048
Mvaa 120,104,72
Mvaa 124,108,72
Ra 16,20,8192
Mvaa 128,112,72
buffer_load_dwordx4 v9, s[12:15], s53 offen offset:1024 nt lds
Mvaa 132,116,72
s_waitcnt lgkmcnt(6)
Ta 52,27,0
Ta 54,27,2048
Mvaa 136,120,72
Mvaa 140,124,72
Ra 20,20,10240
Mvaa 144,96,76
buffer_load_dwordx4 v8, s[12:15], s54 offen offset:2048 nt lds
Mvaa 148,100,76
Ta 56,28,0
Ta 58,28,2048
Mvaa 152,104,76
Mvaa 156,108,76
Ra 24,20,12288
Mvaa 160,112,76
buffer_load_dwordx4 v9, s[12:15], s55 offen offset:3072 nt lds
Mvaa 164,116,76
s_waitcnt lgkmcnt(6)
Ta 60,29,0
Ta 62,29,2048
Mvaa 168,120,76
v_add_u32 v6, 524288, v6
v_add_u32 v7, 524288, v7
Mvaa 172,124,76
s_add_u32 m0, s56, 0
Ra 28,20,14336
v_add_u32 v8, 524288, v8
Mvaa 176,96,80
buffer_load_dwordx4 v2, s[8:11], s48 offen offset:0 lds
Mvaa 180,100,80
v_add_u32 v9, 524288, v9
Mvaa 184,104,80
Mvaa 188,108,80
Mvaa 192,112,80
buffer_load_dwordx4 v3, s[8:11], s49 offen offset:1024 lds
Mvaa 196,116,80
Mvaa 200,120,80
Mvaa 204,124,80
Mvaa 208,96,84
buffer_load_dwordx4 v2, s[8:11], s50 offen offset:2048 lds
Mvaa 212,100,84
Mvaa 216,104,84
Mvaa 220,108,84
Mvaa 224,112,84
buffer_load_dwordx4 v3, s[8:11], s51 offen offset:3072 lds
Mvaa 228,116,84
Mvaa 232,120,84
Mvaa 236,124,84
s_add_u32 m0, s56, 4096
Mvaa 240,96,88
buffer_load_dwordx4 v4, s[8:11], s48 offen offset:0 lds
Mvaa 244,100,88
Mvaa 248,104,88
Mvaa 252,108,88
Maaa 128,112,88
buffer_load_dwordx4 v5, s[8:11], s49 offen offset:1024 lds
Maaa 132,116,88
Maaa 136,120,88
Maaa 140,124,88
Maaa 144,96,92
buffer_load_dwordx4 v4, s[8:11], s50 offen offset:2048 lds
Maaa 148,100,92
Maaa 152,104,92
Maaa 156,108,92
Maaa 160,112,92
buffer_load_dwordx4 v5, s[8:11], s51 offen offset:3072 lds
Maaa 164,116,92
v_add_u32 v2, 128, v2
v_add_u32 v3, 128, v3
Maaa 168,120,92
buffer_load_dword v1, v47, s[60:63], 0 offen
v_add_u32 v4, 128, v4
v_add_u32 v5, 128, v5
Maaa 172,124,92
v_add_u32 v47, s59, v47
s_waitcnt lgkmcnt(0)
Mvaa 48,32,0
buffer_store_dwordx4 v[30:33], v46, s[20:23], s3 offen offset:0 sc1
Mvaa 52,36,0
Ta 96,22,16384
Ta 98,22,18432
Mvaa 56,40,0
buffer_store_dwordx4 v[34:37], v46, s[20:23], s3 offen offset:2048 sc1
Mvaa 60,44,0
Ra 64,21,0
Mvaa 64,48,0
buffer_store_dwordx4 v[38:41], v46, s[20:23], s39 offen offset:0 sc1
Mvaa 68,52,0
Ta 100,23,16384
Ta 102,23,18432
Mvaa 72,56,0
buffer_store_dwordx4 v[42:45], v46, s[20:23], s39 offen offset:2048 sc1
Mvaa 76,60,0
s_waitcnt lgkmcnt(6)
Ra 68,21,2048
Mvaa 80,32,4
s_lshl_b32 s3, s34, 1
s_and_b32 s36, s32, 1
s_add_u32 s3, s3, s36
Mvaa 84,36,4
Ta 104,24,16384
Ta 106,24,18432
Mvaa 88,40,4
s_mul_i32 s3, s3, 1116160
s_mul_i32 s36, s33, 139264
s_add_u32 s3, s3, s36
Mvaa 92,44,4
Ra 72,21,4096
Mvaa 96,48,4
s_lshr_b32 s36, s32, 1
s_mul_i32 s36, s36, 69632
s_add_u32 s3, s3, s36
Mvaa 100,52,4
Ta 108,25,16384
Ta 110,25,18432
Mvaa 104,56,4
s_add_u32 s38, s3, 0
s_lshl_b32 s39, s34, 7
s_lshl_b32 s36, s33, 2
Mvaa 108,60,4
s_waitcnt lgkmcnt(6)
Ra 76,21,6144
Mvaa 112,32,8
s_add_u32 s39, s39, s36
s_add_u32 s39, s39, 5296128
v_mov_b32 v30, 1
Mvaa 116,36,8
Ta 112,26,16384
Ta 114,26,18432
Mvaa 120,40,8
v_mov_b32 v31, 0
Mvaa 124,44,8
Ra 80,21,8192
Mvaa 128,48,8
s_cmp_eq_u32 s32, 0
s_cselect_b32 s39, s39, 2146435072
Mvaa 132,52,8
Ta 116,27,16384
Ta 118,27,18432
Mvaa 136,56,8
s_mov_b64 exec, 1
buffer_store_dword v31, v31, s[20:23], s39 offen sc1
s_mov_b64 exec, -1
Mvaa 140,60,8
s_waitcnt lgkmcnt(6)
Ra 84,21,10240
Mvaa 144,32,12
s_and_b32 s33, s2, 7
s_lshl_b32 s33, s33, 2
s_bfe_u32 s3, s2, 0x20003
Mvaa 148,36,12
Ta 120,28,16384
Ta 122,28,18432
Mvaa 152,40,12
s_add_u32 s33, s33, s3
s_lshr_b32 s34, s2, 5
s_lshl_b32 s35, s34, 1
Mvaa 156,44,12
Ra 88,21,12288
Mvaa 160,48,12
s_sub_u32 s36, 32, s35
s_add_u32 s35, s35, 2
s_lshl_b32 s44, s32, 12
Mvaa 164,52,12
Ta 124,29,16384
Ta 126,29,18432
Mvaa 168,56,12
s_mov_b32 s58, 33792
s_sub_u32 s3, 15, s34
s_lshl_b32 s45, s3, 2
Mvaa 172,60,12
s_waitcnt lgkmcnt(6)
Ra 92,21,14336
Mvaa 176,32,16
s_add_u32 s45, s45, s32
s_lshl_b32 s46, s34, 2
s_add_u32 s46, s46, s32
Mvaa 180,36,16
s_add_u32 s16, s66, 46137344
s_addc_u32 s17, s67, 0
s_and_b32 s17, s17, 0xffff
Mvaa 184,40,16
s_mov_b32 s18, 16777216
s_mov_b32 s19, 0x20000
s_mov_b32 s68, s42
Mvaa 188,44,16
s_and_b32 s69, s43, 0xffff
s_mov_b32 s70, 7340032
s_mov_b32 s71, 0x20000
Mvaa 192,48,16
s_cmp_eq_u32 s32, 0
s_cselect_b32 s37, 0, 2146435072
Mvaa 196,52,16
Mvaa 200,56,16
Mvaa 204,60,16
Mvaa 208,32,20
Mvaa 212,36,20
Mvaa 216,40,20
Mvaa 220,44,20
Mvaa 224,48,20
Mvaa 228,52,20
Mvaa 232,56,20
Mvaa 236,60,20
Mvaa 240,32,24
Mvaa 244,36,24
Mvaa 248,40,24
Mvaa 252,44,24
Maaa 128,48,24
Maaa 132,52,24
Maaa 136,56,24
Maaa 140,60,24
Maaa 144,32,28
Maaa 148,36,28
Maaa 152,40,28
Maaa 156,44,28
Maaa 160,48,28
Maaa 164,52,28
Maaa 168,56,28
Maaa 172,60,28
s_waitcnt vmcnt(6) lgkmcnt(0)
s_add_u32 m0, s57, 65536
s_barrier
Mvaa 48,96,64
buffer_load_dwordx4 v6, s[12:15], s52 offen offset:0 nt lds
Mvaa 52,100,64
Ta 32,12,0
Ta 34,12,2048
Mvaa 56,104,64
Mvaa 60,108,64
Ra 0,10,0
Mvaa 64,112,64
buffer_load_dwordx4 v7, s[12:15], s53 offen offset:1024 nt lds
Mvaa 68,116,64
s_waitcnt lgkmcnt(6)
Ta 36,13,0
Ta 38,13,2048
Mvaa 72,120,64
Mvaa 76,124,64
Ra 4,10,2048
Mvaa 80,96,68
buffer_load_dwordx4 v6, s[12:15], s54 offen offset:2048 nt lds
Mvaa 84,100,68
Ta 40,14,0
Ta 42,14,2048
Mvaa 88,104,68
Mvaa 92,108,68
Ra 8,10,4096
Mvaa 96,112,68
buffer_load_dwordx4 v7, s[12:15], s55 offen offset:3072 nt lds
Mvaa 100,116,68
s_waitcnt lgkmcnt(6)
Ta 44,15,0
Ta 46,15,2048
Mvaa 104,120,68
Mvaa 108,124,68
s_add_u32 m0, s57, 69632
Ra 12,10,6144
Mvaa 112,96,72
buffer_load_dwordx4 v8, s[12:15], s52 offen offset:0 nt lds
Mvaa 116,100,72
Ta 48,16,0
Ta 50,16,2048
Mvaa 120,104,72
Mvaa 124,108,72
Ra 16,10,8192
Mvaa 128,112,72
buffer_load_dwordx4 v9, s[12:15], s53 offen offset:1024 nt lds
Mvaa 132,116,72
s_waitcnt lgkmcnt(6)
Ta 52,17,0
Ta 54,17,2048
Mvaa 136,120,72
Mvaa 140,124,72
Ra 20,10,10240
Mvaa 144,96,76
buffer_load_dwordx4 v8, s[12:15], s54 offen offset:2048 nt lds
Mvaa 148,100,76
Ta 56,18,0
Ta 58,18,2048
Mvaa 152,104,76
Mvaa 156,108,76
Ra 24,10,12288
Mvaa 160,112,76
buffer_load_dwordx4 v9, s[12:15], s55 offen offset:3072 nt lds
Mvaa 164,116,76
s_waitcnt lgkmcnt(6)
Ta 60,19,0
Ta 62,19,2048
Mvaa 168,120,76
v_add_u32 v6, 524288, v6
v_add_u32 v7, 524288, v7
Mvaa 172,124,76
s_add_u32 m0, s56, 65536
Ra 28,10,14336
v_add_u32 v8, 524288, v8
Mvaa 176,96,80
buffer_load_dwordx4 v2, s[8:11], s48 offen offset:0 lds
Mvaa 180,100,80
v_add_u32 v9, 524288, v9
Mvaa 184,104,80
Mvaa 188,108,80
Mvaa 192,112,80
buffer_load_dwordx4 v3, s[8:11], s49 offen offset:1024 lds
Mvaa 196,116,80
Mvaa 200,120,80
Mvaa 204,124,80
Mvaa 208,96,84
buffer_load_dwordx4 v2, s[8:11], s50 offen offset:2048 lds
Mvaa 212,100,84
Mvaa 216,104,84
Mvaa 220,108,84
Mvaa 224,112,84
buffer_load_dwordx4 v3, s[8:11], s51 offen offset:3072 lds
Mvaa 228,116,84
Mvaa 232,120,84
Mvaa 236,124,84
s_add_u32 m0, s56, 69632
Mvaa 240,96,88
buffer_load_dwordx4 v4, s[8:11], s48 offen offset:0 lds
Mvaa 244,100,88
Mvaa 248,104,88
Mvaa 252,108,88
Maaa 128,112,88
buffer_load_dwordx4 v5, s[8:11], s49 offen offset:1024 lds
Maaa 132,116,88
Maaa 136,120,88
Maaa 140,124,88
Maaa 144,96,92
buffer_load_dwordx4 v4, s[8:11], s50 offen offset:2048 lds
Maaa 148,100,92
Maaa 152,104,92
Maaa 156,108,92
Maaa 160,112,92
buffer_load_dwordx4 v5, s[8:11], s51 offen offset:3072 lds
Maaa 164,116,92
v_add_u32 v2, 128, v2
v_add_u32 v3, 128, v3
Maaa 168,120,92
buffer_load_dword v1, v47, s[60:63], 0 offen
v_add_u32 v4, 128, v4
v_add_u32 v5, 128, v5
Maaa 172,124,92
v_add_u32 v47, s59, v47
s_waitcnt lgkmcnt(0)
Mvaa 48,32,0
Mvaa 52,36,0
Ta 96,12,16384
Ta 98,12,18432
Mvaa 56,40,0
Mvaa 60,44,0
Ra 64,11,0
Mvaa 64,48,0
Mvaa 68,52,0
Ta 100,13,16384
Ta 102,13,18432
Mvaa 72,56,0
Mvaa 76,60,0
s_waitcnt lgkmcnt(6)
Ra 68,11,2048
Mvaa 80,32,4
Mvaa 84,36,4
Ta 104,14,16384
Ta 106,14,18432
Mvaa 88,40,4
Mvaa 92,44,4
Ra 72,11,4096
Mvaa 96,48,4
Mvaa 100,52,4
Ta 108,15,16384
Ta 110,15,18432
Mvaa 104,56,4
Mvaa 108,60,4
s_waitcnt lgkmcnt(6)
Ra 76,11,6144
Mvaa 112,32,8
Mvaa 116,36,8
Ta 112,16,16384
Ta 114,16,18432
Mvaa 120,40,8
Mvaa 124,44,8
Ra 80,11,8192
Mvaa 128,48,8
Mvaa 132,52,8
Ta 116,17,16384
Ta 118,17,18432
Mvaa 136,56,8
Mvaa 140,60,8
s_waitcnt lgkmcnt(6)
Ra 84,11,10240
Mvaa 144,32,12
Mvaa 148,36,12
Ta 120,18,16384
Ta 122,18,18432
Mvaa 152,40,12
Mvaa 156,44,12
Ra 88,11,12288
Mvaa 160,48,12
Mvaa 164,52,12
Ta 124,19,16384
Ta 126,19,18432
Mvaa 168,56,12
Mvaa 172,60,12
s_waitcnt lgkmcnt(6)
Ra 92,11,14336
Mvaa 176,32,16
Mvaa 180,36,16
Mvaa 184,40,16
Mvaa 188,44,16
Mvaa 192,48,16
Mvaa 196,52,16
Mvaa 200,56,16
Mvaa 204,60,16
Mvaa 208,32,20
Mvaa 212,36,20
Mvaa 216,40,20
Mvaa 220,44,20
Mvaa 224,48,20
Mvaa 228,52,20
Mvaa 232,56,20
Mvaa 236,60,20
Mvaa 240,32,24
Mvaa 244,36,24
Mvaa 248,40,24
Mvaa 252,44,24
Maaa 128,48,24
Maaa 132,52,24
Maaa 136,56,24
Maaa 140,60,24
Maaa 144,32,28
Maaa 148,36,28
Maaa 152,40,28
Maaa 156,44,28
Maaa 160,48,28
Maaa 164,52,28
Maaa 168,56,28
Maaa 172,60,28
s_waitcnt vmcnt(1) lgkmcnt(0)
s_add_u32 m0, s57, 0
s_barrier
Mvaa 48,96,64
buffer_load_dwordx4 v6, s[12:15], s52 offen offset:0 nt lds
Mvaa 52,100,64
Ta 32,22,0
Ta 34,22,2048
Mvaa 56,104,64
Mvaa 60,108,64
Ra 0,20,0
Mvaa 64,112,64
buffer_load_dwordx4 v7, s[12:15], s53 offen offset:1024 nt lds
Mvaa 68,116,64
s_waitcnt lgkmcnt(6)
Ta 36,23,0
Ta 38,23,2048
Mvaa 72,120,64
Mvaa 76,124,64
Ra 4,20,2048
Mvaa 80,96,68
buffer_load_dwordx4 v6, s[12:15], s54 offen offset:2048 nt lds
Mvaa 84,100,68
Ta 40,24,0
Ta 42,24,2048
Mvaa 88,104,68
Mvaa 92,108,68
Ra 8,20,4096
Mvaa 96,112,68
buffer_load_dwordx4 v7, s[12:15], s55 offen offset:3072 nt lds
Mvaa 100,116,68
s_waitcnt lgkmcnt(6)
Ta 44,25,0
Ta 46,25,2048
Mvaa 104,120,68
Mvaa 108,124,68
s_add_u32 m0, s57, 4096
Ra 12,20,6144
Mvaa 112,96,72
buffer_load_dwordx4 v8, s[12:15], s52 offen offset:0 nt lds
Mvaa 116,100,72
Ta 48,26,0
Ta 50,26,2048
Mvaa 120,104,72
Mvaa 124,108,72
Ra 16,20,8192
Mvaa 128,112,72
buffer_load_dwordx4 v9, s[12:15], s53 offen offset:1024 nt lds
Mvaa 132,116,72
s_waitcnt lgkmcnt(6)
Ta 52,27,0
Ta 54,27,2048
Mvaa 136,120,72
Mvaa 140,124,72
Ra 20,20,10240
Mvaa 144,96,76
buffer_load_dwordx4 v8, s[12:15], s54 offen offset:2048 nt lds
Mvaa 148,100,76
Ta 56,28,0
Ta 58,28,2048
Mvaa 152,104,76
Mvaa 156,108,76
Ra 24,20,12288
Mvaa 160,112,76
buffer_load_dwordx4 v9, s[12:15], s55 offen offset:3072 nt lds
Mvaa 164,116,76
s_waitcnt lgkmcnt(6)
Ta 60,29,0
Ta 62,29,2048
Mvaa 168,120,76
v_add_u32 v6, 524288, v6
v_add_u32 v7, 524288, v7
Mvaa 172,124,76
s_add_u32 m0, s56, 0
Ra 28,20,14336
v_add_u32 v8, 524288, v8
Mvaa 176,96,80
buffer_load_dwordx4 v2, s[8:11], s48 offen offset:0 lds
Mvaa 180,100,80
v_add_u32 v9, 524288, v9
Mvaa 184,104,80
Mvaa 188,108,80
Mvaa 192,112,80
buffer_load_dwordx4 v3, s[8:11], s49 offen offset:1024 lds
Mvaa 196,116,80
Mvaa 200,120,80
Mvaa 204,124,80
Mvaa 208,96,84
buffer_load_dwordx4 v2, s[8:11], s50 offen offset:2048 lds
Mvaa 212,100,84
Mvaa 216,104,84
Mvaa 220,108,84
Mvaa 224,112,84
buffer_load_dwordx4 v3, s[8:11], s51 offen offset:3072 lds
Mvaa 228,116,84
Mvaa 232,120,84
Mvaa 236,124,84
s_add_u32 m0, s56, 4096
Mvaa 240,96,88
buffer_load_dwordx4 v4, s[8:11], s48 offen offset:0 lds
Mvaa 244,100,88
Mvaa 248,104,88
Mvaa 252,108,88
Maaa 128,112,88
buffer_load_dwordx4 v5, s[8:11], s49 offen offset:1024 lds
Maaa 132,116,88
Maaa 136,120,88
Maaa 140,124,88
Maaa 144,96,92
buffer_load_dwordx4 v4, s[8:11], s50 offen offset:2048 lds
Maaa 148,100,92
Maaa 152,104,92
Maaa 156,108,92
Maaa 160,112,92
buffer_load_dwordx4 v5, s[8:11], s51 offen offset:3072 lds
Maaa 164,116,92
v_add_u32 v2, 128, v2
v_add_u32 v3, 128, v3
Maaa 168,120,92
buffer_load_dword v1, v47, s[60:63], 0 offen
v_add_u32 v4, 128, v4
v_add_u32 v5, 128, v5
Maaa 172,124,92
v_add_u32 v47, s59, v47
s_waitcnt lgkmcnt(0)
Mvaa 48,32,0
s_mov_b64 exec, 1
buffer_atomic_add v30, v31, s[28:31], s37 offen sc1
s_mov_b64 exec, -1
Mvaa 52,36,0
Ta 96,22,16384
Ta 98,22,18432
Mvaa 56,40,0
Mvaa 60,44,0
Ra 64,21,0
Mvaa 64,48,0
Mvaa 68,52,0
Ta 100,23,16384
Ta 102,23,18432
Mvaa 72,56,0
Mvaa 76,60,0
s_waitcnt lgkmcnt(6)
Ra 68,21,2048
Mvaa 80,32,4
Mvaa 84,36,4
Ta 104,24,16384
Ta 106,24,18432
Mvaa 88,40,4
Mvaa 92,44,4
Ra 72,21,4096
Mvaa 96,48,4
Mvaa 100,52,4
Ta 108,25,16384
Ta 110,25,18432
Mvaa 104,56,4
Mvaa 108,60,4
s_waitcnt lgkmcnt(6)
Ra 76,21,6144
Mvaa 112,32,8
Mvaa 116,36,8
Ta 112,26,16384
Ta 114,26,18432
Mvaa 120,40,8
Mvaa 124,44,8
Ra 80,21,8192
Mvaa 128,48,8
Mvaa 132,52,8
Ta 116,27,16384
Ta 118,27,18432
Mvaa 136,56,8
Mvaa 140,60,8
s_waitcnt lgkmcnt(6)
Ra 84,21,10240
Mvaa 144,32,12
Mvaa 148,36,12
Ta 120,28,16384
Ta 122,28,18432
Mvaa 152,40,12
Mvaa 156,44,12
Ra 88,21,12288
Mvaa 160,48,12
Mvaa 164,52,12
Ta 124,29,16384
Ta 126,29,18432
Mvaa 168,56,12
Mvaa 172,60,12
s_waitcnt lgkmcnt(6)
Ra 92,21,14336
Mvaa 176,32,16
Mvaa 180,36,16
Mvaa 184,40,16
Mvaa 188,44,16
Mvaa 192,48,16
Mvaa 196,52,16
Mvaa 200,56,16
Mvaa 204,60,16
Mvaa 208,32,20
Mvaa 212,36,20
Mvaa 216,40,20
Mvaa 220,44,20
Mvaa 224,48,20
Mvaa 228,52,20
Mvaa 232,56,20
Mvaa 236,60,20
Mvaa 240,32,24
Mvaa 244,36,24
Mvaa 248,40,24
Mvaa 252,44,24
Maaa 128,48,24
Maaa 132,52,24
Maaa 136,56,24
Maaa 140,60,24
Maaa 144,32,28
Maaa 148,36,28
Maaa 152,40,28
Maaa 156,44,28
Maaa 160,48,28
Maaa 164,52,28
Maaa 168,56,28
Maaa 172,60,28
s_waitcnt vmcnt(2) lgkmcnt(0)
s_add_u32 m0, s57, 65536
s_barrier
Mvaa 48,96,64
buffer_load_dwordx4 v6, s[12:15], s52 offen offset:0 nt lds
Mvaa 52,100,64
Ta 32,12,0
Ta 34,12,2048
Mvaa 56,104,64
Mvaa 60,108,64
Ra 0,10,0
Mvaa 64,112,64
buffer_load_dwordx4 v7, s[12:15], s53 offen offset:1024 nt lds
Mvaa 68,116,64
s_waitcnt lgkmcnt(6)
Ta 36,13,0
Ta 38,13,2048
Mvaa 72,120,64
Mvaa 76,124,64
Ra 4,10,2048
Mvaa 80,96,68
buffer_load_dwordx4 v6, s[12:15], s54 offen offset:2048 nt lds
Mvaa 84,100,68
Ta 40,14,0
Ta 42,14,2048
Mvaa 88,104,68
Mvaa 92,108,68
Ra 8,10,4096
Mvaa 96,112,68
buffer_load_dwordx4 v7, s[12:15], s55 offen offset:3072 nt lds
Mvaa 100,116,68
s_waitcnt lgkmcnt(6)
Ta 44,15,0
Ta 46,15,2048
Mvaa 104,120,68
Mvaa 108,124,68
s_add_u32 m0, s57, 69632
Ra 12,10,6144
Mvaa 112,96,72
buffer_load_dwordx4 v8, s[12:15], s52 offen offset:0 nt lds
Mvaa 116,100,72
Ta 48,16,0
Ta 50,16,2048
Mvaa 120,104,72
Mvaa 124,108,72
Ra 16,10,8192
Mvaa 128,112,72
buffer_load_dwordx4 v9, s[12:15], s53 offen offset:1024 nt lds
Mvaa 132,116,72
s_waitcnt lgkmcnt(6)
Ta 52,17,0
Ta 54,17,2048
Mvaa 136,120,72
Mvaa 140,124,72
Ra 20,10,10240
Mvaa 144,96,76
buffer_load_dwordx4 v8, s[12:15], s54 offen offset:2048 nt lds
Mvaa 148,100,76
Ta 56,18,0
Ta 58,18,2048
Mvaa 152,104,76
Mvaa 156,108,76
Ra 24,10,12288
Mvaa 160,112,76
buffer_load_dwordx4 v9, s[12:15], s55 offen offset:3072 nt lds
Mvaa 164,116,76
s_waitcnt lgkmcnt(6)
Ta 60,19,0
Ta 62,19,2048
Mvaa 168,120,76
v_add_u32 v6, 524288, v6
v_add_u32 v7, 524288, v7
Mvaa 172,124,76
s_add_u32 m0, s56, 65536
Ra 28,10,14336
v_add_u32 v8, 524288, v8
Mvaa 176,96,80
buffer_load_dwordx4 v2, s[8:11], s48 offen offset:0 lds
Mvaa 180,100,80
v_add_u32 v9, 524288, v9
Mvaa 184,104,80
Mvaa 188,108,80
Mvaa 192,112,80
buffer_load_dwordx4 v3, s[8:11], s49 offen offset:1024 lds
Mvaa 196,116,80
Mvaa 200,120,80
Mvaa 204,124,80
Mvaa 208,96,84
buffer_load_dwordx4 v2, s[8:11], s50 offen offset:2048 lds
Mvaa 212,100,84
Mvaa 216,104,84
Mvaa 220,108,84
Mvaa 224,112,84
buffer_load_dwordx4 v3, s[8:11], s51 offen offset:3072 lds
Mvaa 228,116,84
Mvaa 232,120,84
Mvaa 236,124,84
s_add_u32 m0, s56, 69632
Mvaa 240,96,88
buffer_load_dwordx4 v4, s[8:11], s48 offen offset:0 lds
Mvaa 244,100,88
Mvaa 248,104,88
Mvaa 252,108,88
Maaa 128,112,88
buffer_load_dwordx4 v5, s[8:11], s49 offen offset:1024 lds
Maaa 132,116,88
Maaa 136,120,88
Maaa 140,124,88
Maaa 144,96,92
buffer_load_dwordx4 v4, s[8:11], s50 offen offset:2048 lds
Maaa 148,100,92
Maaa 152,104,92
Maaa 156,108,92
Maaa 160,112,92
buffer_load_dwordx4 v5, s[8:11], s51 offen offset:3072 lds
Maaa 164,116,92
v_add_u32 v2, 128, v2
v_add_u32 v3, 128, v3
Maaa 168,120,92
buffer_load_dword v1, v47, s[60:63], 0 offen
v_add_u32 v4, 128, v4
v_add_u32 v5, 128, v5
Maaa 172,124,92
v_add_u32 v47, s59, v47
s_waitcnt lgkmcnt(0)
Mvaa 48,32,0
s_lshl_b32 s3, s33, 8
s_add_u32 s60, s4, s3
s_addc_u32 s61, s5, 0
s_and_b32 s61, s61, 0xffff
Mvaa 52,36,0
Ta 96,12,16384
Ta 98,12,18432
Mvaa 56,40,0
s_mov_b32 s62, 0
s_mov_b32 s63, 0x20000
s_sub_u32 s62, 8388608, s3
Mvaa 60,44,0
Ra 64,11,0
Mvaa 64,48,0
v_lshrrev_b32 v32, 1, v0
v_and_b32 v33, 1, v0
Mvaa 68,52,0
Ta 100,13,16384
Ta 102,13,18432
Mvaa 72,56,0
v_lshlrev_b32 v32, 13, v32
v_lshl_add_u32 v32, v33, 7, v32
Mvaa 76,60,0
s_waitcnt lgkmcnt(6)
Ra 68,11,2048
Mvaa 80,32,4
s_lshl_b32 s3, s32, 3
s_add_u32 s3, s3, s34
s_lshl_b32 s3, s3, 18
Mvaa 84,36,4
Ta 104,14,16384
Ta 106,14,18432
Mvaa 88,40,4
s_mov_b32 s59, 8388608
v_add_u32 v47, s3, v32
v_lshrrev_b32 v32, 4, v0
Mvaa 92,44,4
Ra 72,11,4096
Mvaa 96,48,4
v_and_b32 v33, 15, v0
Mvaa 100,52,4
Ta 108,15,16384
Ta 110,15,18432
Mvaa 104,56,4
s_lshl_b32 s3, s32, 4
v_add_u32 v34, s3, v32
v_lshlrev_b32 v36, 1, v32
Mvaa 108,60,4
s_waitcnt lgkmcnt(6)
Ra 76,11,6144
Mvaa 112,32,8
v_xor_b32 v36, v36, v33
v_xor_b32 v37, 8, v36
Mvaa 116,36,8
Ta 112,16,16384
Ta 114,16,18432
Mvaa 120,40,8
Mvaa 124,44,8
Ra 80,11,8192
Mvaa 128,48,8
Mvaa 132,52,8
Ta 116,17,16384
Ta 118,17,18432
Mvaa 136,56,8
Mvaa 140,60,8
s_waitcnt lgkmcnt(6)
Ra 84,11,10240
Mvaa 144,32,12
Mvaa 148,36,12
Ta 120,18,16384
Ta 122,18,18432
Mvaa 152,40,12
Mvaa 156,44,12
Ra 88,11,12288
Mvaa 160,48,12
Mvaa 164,52,12
Ta 124,19,16384
Ta 126,19,18432
Mvaa 168,56,12
Mvaa 172,60,12
s_waitcnt lgkmcnt(6)
Ra 92,11,14336
Mvaa 176,32,16
Mvaa 180,36,16
Mvaa 184,40,16
Mvaa 188,44,16
Mvaa 192,48,16
Mvaa 196,52,16
Mvaa 200,56,16
Mvaa 204,60,16
Mvaa 208,32,20
Mvaa 212,36,20
Mvaa 216,40,20
Mvaa 220,44,20
Mvaa 224,48,20
Mvaa 228,52,20
Mvaa 232,56,20
Mvaa 236,60,20
Mvaa 240,32,24
Mvaa 244,36,24
Mvaa 248,40,24
Mvaa 252,44,24
Maaa 128,48,24
Maaa 132,52,24
Maaa 136,56,24
Maaa 140,60,24
Maaa 144,32,28
Maaa 148,36,28
Maaa 152,40,28
Maaa 156,44,28
Maaa 160,48,28
Maaa 164,52,28
Maaa 168,56,28
Maaa 172,60,28
s_waitcnt vmcnt(1) lgkmcnt(0)
s_add_u32 m0, s57, 0
s_barrier
Mvaa 48,96,64
buffer_load_dwordx4 v6, s[12:15], s52 offen offset:0 nt lds
Mvaa 52,100,64
Ta 32,22,0
Ta 34,22,2048
Mvaa 56,104,64
Mvaa 60,108,64
Ra 0,20,0
Mvaa 64,112,64
buffer_load_dwordx4 v7, s[12:15], s53 offen offset:1024 nt lds
Mvaa 68,116,64
s_waitcnt lgkmcnt(6)
Ta 36,23,0
Ta 38,23,2048
Mvaa 72,120,64
Mvaa 76,124,64
Ra 4,20,2048
Mvaa 80,96,68
buffer_load_dwordx4 v6, s[12:15], s54 offen offset:2048 nt lds
Mvaa 84,100,68
Ta 40,24,0
Ta 42,24,2048
Mvaa 88,104,68
Mvaa 92,108,68
Ra 8,20,4096
Mvaa 96,112,68
buffer_load_dwordx4 v7, s[12:15], s55 offen offset:3072 nt lds
Mvaa 100,116,68
s_waitcnt lgkmcnt(6)
Ta 44,25,0
Ta 46,25,2048
Mvaa 104,120,68
Mvaa 108,124,68
s_add_u32 m0, s57, 4096
Ra 12,20,6144
Mvaa 112,96,72
buffer_load_dwordx4 v8, s[12:15], s52 offen offset:0 nt lds
Mvaa 116,100,72
Ta 48,26,0
Ta 50,26,2048
Mvaa 120,104,72
Mvaa 124,108,72
Ra 16,20,8192
Mvaa 128,112,72
buffer_load_dwordx4 v9, s[12:15], s53 offen offset:1024 nt lds
Mvaa 132,116,72
s_waitcnt lgkmcnt(6)
Ta 52,27,0
Ta 54,27,2048
Mvaa 136,120,72
Mvaa 140,124,72
Ra 20,20,10240
Mvaa 144,96,76
buffer_load_dwordx4 v8, s[12:15], s54 offen offset:2048 nt lds
Mvaa 148,100,76
Ta 56,28,0
Ta 58,28,2048
Mvaa 152,104,76
Mvaa 156,108,76
Ra 24,20,12288
Mvaa 160,112,76
buffer_load_dwordx4 v9, s[12:15], s55 offen offset:3072 nt lds
Mvaa 164,116,76
s_waitcnt lgkmcnt(6)
Ta 60,29,0
Ta 62,29,2048
Mvaa 168,120,76
v_add_u32 v6, 524288, v6
v_add_u32 v7, 524288, v7
Mvaa 172,124,76
s_add_u32 m0, s56, 0
Ra 28,20,14336
v_add_u32 v8, 524288, v8
Mvaa 176,96,80
buffer_load_dwordx4 v2, s[8:11], s48 offen offset:0 lds
Mvaa 180,100,80
v_add_u32 v9, 524288, v9
Mvaa 184,104,80
Mvaa 188,108,80
Mvaa 192,112,80
buffer_load_dwordx4 v3, s[8:11], s49 offen offset:1024 lds
Mvaa 196,116,80
Mvaa 200,120,80
Mvaa 204,124,80
Mvaa 208,96,84
buffer_load_dwordx4 v2, s[8:11], s50 offen offset:2048 lds
Mvaa 212,100,84
Mvaa 216,104,84
Mvaa 220,108,84
Mvaa 224,112,84
buffer_load_dwordx4 v3, s[8:11], s51 offen offset:3072 lds
Mvaa 228,116,84
Mvaa 232,120,84
Mvaa 236,124,84
s_add_u32 m0, s56, 4096
Mvaa 240,96,88
buffer_load_dwordx4 v4, s[8:11], s48 offen offset:0 lds
Mvaa 244,100,88
Mvaa 248,104,88
Mvaa 252,108,88
Maaa 128,112,88
buffer_load_dwordx4 v5, s[8:11], s49 offen offset:1024 lds
Maaa 132,116,88
Maaa 136,120,88
Maaa 140,124,88
Maaa 144,96,92
buffer_load_dwordx4 v4, s[8:11], s50 offen offset:2048 lds
Maaa 148,100,92
Maaa 152,104,92
Maaa 156,108,92
Maaa 160,112,92
buffer_load_dwordx4 v5, s[8:11], s51 offen offset:3072 lds
Maaa 164,116,92
v_add_u32 v2, 128, v2
v_add_u32 v3, 128, v3
Maaa 168,120,92
buffer_load_dword v1, v47, s[60:63], 0 offen
v_add_u32 v4, 128, v4
v_add_u32 v5, 128, v5
Maaa 172,124,92
v_add_u32 v47, s59, v47
s_waitcnt lgkmcnt(0)
Mvaa 48,32,0
s_getpc_b64 s[6:7]
L_cpf2:
s_add_u32 s6, s6, (L_phase2-L_cpf2)&0xffffffff
s_addc_u32 s7, s7, ((L_phase2-L_cpf2)>>32)&0xffffffff
Mvaa 52,36,0
Ta 96,22,16384
Ta 98,22,18432
Mvaa 56,40,0
s_lshr_b32 s3, s2, 3
s_lshl_b32 s3, s3, 2
s_add_u32 s3, s3, s32
Mvaa 60,44,0
Ra 64,21,0
Mvaa 64,48,0
s_lshl_b32 s3, s3, 10
v_and_b32 v42, 7, v0
v_lshlrev_b32 v42, 7, v42
Mvaa 68,52,0
Ta 100,23,16384
Ta 102,23,18432
Mvaa 72,56,0
v_add_u32 v42, s3, v42
v_min_u32 v42, L_k2_end-L_phase2-4, v42
Mvaa 76,60,0
s_waitcnt lgkmcnt(6)
Ra 68,21,2048
Mvaa 80,32,4
v_mov_b32 v41, s7
Mvaa 84,36,4
Ta 104,24,16384
Ta 106,24,18432
Mvaa 88,40,4
v_add_co_u32 v40, vcc, s6, v42
s_nop 1
v_addc_co_u32 v41, vcc, 0, v41, vcc
Mvaa 92,44,4
Ra 72,21,4096
Mvaa 96,48,4
global_load_dword v44, v[40:41], off
Mvaa 100,52,4
Ta 108,25,16384
Ta 110,25,18432
Mvaa 104,56,4
Mvaa 108,60,4
s_waitcnt lgkmcnt(6)
Ra 76,21,6144
Mvaa 112,32,8
Mvaa 116,36,8
Ta 112,26,16384
Ta 114,26,18432
Mvaa 120,40,8
Mvaa 124,44,8
Ra 80,21,8192
Mvaa 128,48,8
Mvaa 132,52,8
Ta 116,27,16384
Ta 118,27,18432
Mvaa 136,56,8
Mvaa 140,60,8
s_waitcnt lgkmcnt(6)
Ra 84,21,10240
Mvaa 144,32,12
Mvaa 148,36,12
Ta 120,28,16384
Ta 122,28,18432
Mvaa 152,40,12
Mvaa 156,44,12
Ra 88,21,12288
Mvaa 160,48,12
Mvaa 164,52,12
Ta 124,29,16384
Ta 126,29,18432
Mvaa 168,56,12
Mvaa 172,60,12
s_waitcnt lgkmcnt(6)
Ra 92,21,14336
Mvaa 176,32,16
Mvaa 180,36,16
Mvaa 184,40,16
Mvaa 188,44,16
Mvaa 192,48,16
Mvaa 196,52,16
Mvaa 200,56,16
Mvaa 204,60,16
Mvaa 208,32,20
Mvaa 212,36,20
Mvaa 216,40,20
Mvaa 220,44,20
Mvaa 224,48,20
Mvaa 228,52,20
Mvaa 232,56,20
Mvaa 236,60,20
Mvaa 240,32,24
Mvaa 244,36,24
Mvaa 248,40,24
Mvaa 252,44,24
Maaa 128,48,24
Maaa 132,52,24
Maaa 136,56,24
Maaa 140,60,24
Maaa 144,32,28
Maaa 148,36,28
Maaa 152,40,28
Maaa 156,44,28
Maaa 160,48,28
Maaa 164,52,28
Maaa 168,56,28
Maaa 172,60,28
s_waitcnt vmcnt(2) lgkmcnt(0)
s_add_u32 m0, s57, 65536
s_barrier
Mvaa 48,96,64
buffer_load_dwordx4 v6, s[12:15], s52 offen offset:0 nt lds
Mvaa 52,100,64
Ta 32,12,0
Ta 34,12,2048
Mvaa 56,104,64
Mvaa 60,108,64
Ra 0,10,0
Mvaa 64,112,64
buffer_load_dwordx4 v7, s[12:15], s53 offen offset:1024 nt lds
Mvaa 68,116,64
s_waitcnt lgkmcnt(6)
Ta 36,13,0
Ta 38,13,2048
Mvaa 72,120,64
Mvaa 76,124,64
Ra 4,10,2048
Mvaa 80,96,68
buffer_load_dwordx4 v6, s[12:15], s54 offen offset:2048 nt lds
Mvaa 84,100,68
Ta 40,14,0
Ta 42,14,2048
Mvaa 88,104,68
Mvaa 92,108,68
Ra 8,10,4096
Mvaa 96,112,68
buffer_load_dwordx4 v7, s[12:15], s55 offen offset:3072 nt lds
Mvaa 100,116,68
s_waitcnt lgkmcnt(6)
Ta 44,15,0
Ta 46,15,2048
Mvaa 104,120,68
Mvaa 108,124,68
s_add_u32 m0, s57, 69632
Ra 12,10,6144
Mvaa 112,96,72
buffer_load_dwordx4 v8, s[12:15], s52 offen offset:0 nt lds
Mvaa 116,100,72
Ta 48,16,0
Ta 50,16,2048
Mvaa 120,104,72
Mvaa 124,108,72
Ra 16,10,8192
Mvaa 128,112,72
buffer_load_dwordx4 v9, s[12:15], s53 offen offset:1024 nt lds
Mvaa 132,116,72
s_waitcnt lgkmcnt(6)
Ta 52,17,0
Ta 54,17,2048
Mvaa 136,120,72
Mvaa 140,124,72
Ra 20,10,10240
Mvaa 144,96,76
buffer_load_dwordx4 v8, s[12:15], s54 offen offset:2048 nt lds
Mvaa 148,100,76
Ta 56,18,0
Ta 58,18,2048
Mvaa 152,104,76
Mvaa 156,108,76
Ra 24,10,12288
Mvaa 160,112,76
buffer_load_dwordx4 v9, s[12:15], s55 offen offset:3072 nt lds
Mvaa 164,116,76
s_waitcnt lgkmcnt(6)
Ta 60,19,0
Ta 62,19,2048
Mvaa 168,120,76
v_add_u32 v6, 524288, v6
v_add_u32 v7, 524288, v7
Mvaa 172,124,76
s_add_u32 m0, s56, 65536
Ra 28,10,14336
v_add_u32 v8, 524288, v8
Mvaa 176,96,80
buffer_load_dwordx4 v2, s[8:11], s48 offen offset:0 lds
Mvaa 180,100,80
v_add_u32 v9, 524288, v9
Mvaa 184,104,80
Mvaa 188,108,80
Mvaa 192,112,80
buffer_load_dwordx4 v3, s[8:11], s49 offen offset:1024 lds
Mvaa 196,116,80
Mvaa 200,120,80
Mvaa 204,124,80
Mvaa 208,96,84
buffer_load_dwordx4 v2, s[8:11], s50 offen offset:2048 lds
Mvaa 212,100,84
Mvaa 216,104,84
Mvaa 220,108,84
Mvaa 224,112,84
buffer_load_dwordx4 v3, s[8:11], s51 offen offset:3072 lds
Mvaa 228,116,84
Mvaa 232,120,84
Mvaa 236,124,84
s_add_u32 m0, s56, 69632
Mvaa 240,96,88
buffer_load_dwordx4 v4, s[8:11], s48 offen offset:0 lds
Mvaa 244,100,88
Mvaa 248,104,88
Mvaa 252,108,88
Maaa 128,112,88
buffer_load_dwordx4 v5, s[8:11], s49 offen offset:1024 lds
Maaa 132,116,88
Maaa 136,120,88
Maaa 140,124,88
Maaa 144,96,92
buffer_load_dwordx4 v4, s[8:11], s50 offen offset:2048 lds
Maaa 148,100,92
Maaa 152,104,92
Maaa 156,108,92
Maaa 160,112,92
buffer_load_dwordx4 v5, s[8:11], s51 offen offset:3072 lds
Maaa 164,116,92
v_add_u32 v2, 128, v2
v_add_u32 v3, 128, v3
Maaa 168,120,92
v_add_u32 v4, 128, v4
v_add_u32 v5, 128, v5
Maaa 172,124,92
s_waitcnt lgkmcnt(0)
Mvaa 48,32,0
buffer_load_dword v30, v31, s[28:31], s37 offen sc1
Mvaa 52,36,0
Ta 96,12,16384
Ta 98,12,18432
Mvaa 56,40,0
s_mov_b32 s8, s60
s_mov_b32 s9, s61
s_mov_b32 s10, s62
Mvaa 60,44,0
Ra 64,11,0
Mvaa 64,48,0
s_mov_b32 s48, 0
s_mov_b32 s49, 31744
s_mov_b32 s50, 63488
Mvaa 68,52,0
Ta 100,13,16384
Ta 102,13,18432
Mvaa 72,56,0
s_mov_b32 s51, 95232
v_lshlrev_b32 v35, 13, v34
v_lshl_add_u32 v8, v36, 4, v35
Mvaa 76,60,0
s_waitcnt lgkmcnt(6)
Ra 68,11,2048
Mvaa 80,32,4
v_lshl_add_u32 v9, v37, 4, v35
v_lshlrev_b32 v2, 4, v0
Mvaa 84,36,4
Ta 104,14,16384
Ta 106,14,18432
Mvaa 88,40,4
v_add_u32 v3, 65536, v2
v_add_u32 v4, s44, v2
Mvaa 92,44,4
Ra 72,11,4096
Mvaa 96,48,4
v_mov_b32 v7, 0
v_lshlrev_b32 v35, 2, v32
Mvaa 100,52,4
Ta 108,15,16384
Ta 110,15,18432
Mvaa 104,56,4
v_sub_u32 v35, v33, v35
Mvaa 108,60,4
s_waitcnt lgkmcnt(6)
Ra 76,11,6144
Mvaa 112,32,8
s_lshl_b32 s3, s45, 5
v_add_u32 v5, s3, v35
Mvaa 116,36,8
Ta 112,16,16384
Ta 114,16,18432
Mvaa 120,40,8
s_lshl_b32 s3, s46, 5
v_add_u32 v6, s3, v35
Mvaa 124,44,8
Ra 80,11,8192
Mvaa 128,48,8
s_mul_i32 s3, s33, 1116160
s_add_u32 s3, s3, 8388608
s_add_u32 s12, s66, s3
s_addc_u32 s13, s67, 0
s_and_b32 s13, s13, 0xffff
Mvaa 132,52,8
Ta 116,17,16384
Ta 118,17,18432
Mvaa 136,56,8
s_mov_b32 s14, 0
s_mov_b32 s15, 0x20000
s_mul_i32 s14, s36, 34816
Mvaa 140,60,8
s_waitcnt lgkmcnt(6)
Ra 84,11,10240
Mvaa 144,32,12
Mvaa 148,36,12
Ta 120,18,16384
Ta 122,18,18432
Mvaa 152,40,12
Mvaa 156,44,12
Ra 88,11,12288
Mvaa 160,48,12
Mvaa 164,52,12
Ta 124,19,16384
Ta 126,19,18432
Mvaa 168,56,12
Mvaa 172,60,12
s_waitcnt lgkmcnt(6)
Ra 92,11,14336
Mvaa 176,32,16
Mvaa 180,36,16
Mvaa 184,40,16
Mvaa 188,44,16
Mvaa 192,48,16
Mvaa 196,52,16
Mvaa 200,56,16
Mvaa 204,60,16
Mvaa 208,32,20
Mvaa 212,36,20
Mvaa 216,40,20
Mvaa 220,44,20
Mvaa 224,48,20
Mvaa 228,52,20
Mvaa 232,56,20
Mvaa 236,60,20
Mvaa 240,32,24
Mvaa 244,36,24
Mvaa 248,40,24
Mvaa 252,44,24
Maaa 128,48,24
Maaa 132,52,24
Maaa 136,56,24
Maaa 140,60,24
Maaa 144,32,28
Maaa 148,36,28
Maaa 152,40,28
Maaa 156,44,28
Maaa 160,48,28
Maaa 164,52,28
Maaa 168,56,28
Maaa 172,60,28
s_waitcnt vmcnt(1) lgkmcnt(0)
s_add_u32 m0, s44, 0
s_barrier
Mvaa 48,96,64
buffer_load_dwordx4 v8, s[8:11], s48 offen offset:0 lds
Mvaa 52,100,64
Ta 32,22,0
Ta 34,22,2048
Mvaa 56,104,64
s_mul_i32 s3, s45, 67584
v_add_u32 v10, s3, v2
Mvaa 60,108,64
Ra 0,20,0
Mvaa 64,112,64
buffer_load_dwordx4 v8, s[8:11], s49 offen offset:1024 lds
Mvaa 68,116,64
s_waitcnt lgkmcnt(6)
Ta 36,23,0
Ta 38,23,2048
Mvaa 72,120,64
s_mul_i32 s3, s46, 67584
v_add_u32 v11, s3, v2
Mvaa 76,124,64
Ra 4,20,2048
Mvaa 80,96,68
buffer_load_dwordx4 v9, s[8:11], s50 offen offset:2048 lds
Mvaa 84,100,68
Ta 40,24,0
Ta 42,24,2048
Mvaa 88,104,68
Mvaa 92,108,68
Ra 8,20,4096
Mvaa 96,112,68
buffer_load_dwordx4 v9, s[8:11], s51 offen offset:3072 lds
Mvaa 100,116,68
s_waitcnt lgkmcnt(6)
Ta 44,25,0
Ta 46,25,2048
Mvaa 104,120,68
v_add_u32 v8, 524288, v8
v_add_u32 v9, 524288, v9
Mvaa 108,124,68
s_add_u32 m0, s44, 16384
Ra 12,20,6144
Mvaa 112,96,72
buffer_load_dwordx4 v8, s[8:11], s48 offen offset:0 lds
Mvaa 116,100,72
Ta 48,26,0
Ta 50,26,2048
Mvaa 120,104,72
Mvaa 124,108,72
Ra 16,20,8192
Mvaa 128,112,72
buffer_load_dwordx4 v8, s[8:11], s49 offen offset:1024 lds
Mvaa 132,116,72
s_waitcnt lgkmcnt(6)
Ta 52,27,0
Ta 54,27,2048
Mvaa 136,120,72
Mvaa 140,124,72
Ra 20,20,10240
Mvaa 144,96,76
buffer_load_dwordx4 v9, s[8:11], s50 offen offset:2048 lds
Mvaa 148,100,76
Ta 56,28,0
Ta 58,28,2048
Mvaa 152,104,76
Mvaa 156,108,76
Ra 24,20,12288
Mvaa 160,112,76
buffer_load_dwordx4 v9, s[8:11], s51 offen offset:3072 lds
Mvaa 164,116,76
s_waitcnt lgkmcnt(6)
Ta 60,29,0
Ta 62,29,2048
Mvaa 168,120,76
v_add_u32 v8, 524288, v8
v_add_u32 v9, 524288, v9
Mvaa 172,124,76
s_add_u32 m0, s44, 32768
Ra 28,20,14336
Mvaa 176,96,80
buffer_load_dwordx4 v8, s[8:11], s48 offen offset:0 lds
Mvaa 180,100,80
Mvaa 184,104,80
Mvaa 188,108,80
Mvaa 192,112,80
buffer_load_dwordx4 v8, s[8:11], s49 offen offset:1024 lds
Mvaa 196,116,80
Mvaa 200,120,80
Mvaa 204,124,80
Mvaa 208,96,84
buffer_load_dwordx4 v9, s[8:11], s50 offen offset:2048 lds
Mvaa 212,100,84
Mvaa 216,104,84
Mvaa 220,108,84
Mvaa 224,112,84
buffer_load_dwordx4 v9, s[8:11], s51 offen offset:3072 lds
Mvaa 228,116,84
v_add_u32 v8, 524288, v8
v_add_u32 v9, 524288, v9
Mvaa 232,120,84
Mvaa 236,124,84
s_add_u32 m0, s44, 49152
Mvaa 240,96,88
buffer_load_dwordx4 v8, s[8:11], s48 offen offset:0 lds
Mvaa 244,100,88
Mvaa 248,104,88
Mvaa 252,108,88
Maaa 128,112,88
buffer_load_dwordx4 v8, s[8:11], s49 offen offset:1024 lds
Maaa 132,116,88
Maaa 136,120,88
Maaa 140,124,88
Maaa 144,96,92
buffer_load_dwordx4 v9, s[8:11], s50 offen offset:2048 lds
Maaa 148,100,92
Maaa 152,104,92
Maaa 156,108,92
Maaa 160,112,92
buffer_load_dwordx4 v9, s[8:11], s51 offen offset:3072 lds
Maaa 164,116,92
v_add_u32 v8, 524288, v8
v_add_u32 v9, 524288, v9
Maaa 168,120,92
Maaa 172,124,92
s_waitcnt lgkmcnt(0)
Mvaa 48,32,0
Mvaa 52,36,0
Ta 96,22,16384
Ta 98,22,18432
Mvaa 56,40,0
Mvaa 60,44,0
Ra 64,21,0
Mvaa 64,48,0
Mvaa 68,52,0
Ta 100,23,16384
Ta 102,23,18432
Mvaa 72,56,0
Mvaa 76,60,0
s_waitcnt lgkmcnt(6)
Ra 68,21,2048
Mvaa 80,32,4
Mvaa 84,36,4
Ta 104,24,16384
Ta 106,24,18432
Mvaa 88,40,4
Mvaa 92,44,4
Ra 72,21,4096
Mvaa 96,48,4
Mvaa 100,52,4
Ta 108,25,16384
Ta 110,25,18432
Mvaa 104,56,4
Mvaa 108,60,4
s_waitcnt lgkmcnt(6)
Ra 76,21,6144
Mvaa 112,32,8
Mvaa 116,36,8
Ta 112,26,16384
Ta 114,26,18432
Mvaa 120,40,8
Mvaa 124,44,8
Ra 80,21,8192
Mvaa 128,48,8
Mvaa 132,52,8
Ta 116,27,16384
Ta 118,27,18432
Mvaa 136,56,8
Mvaa 140,60,8
s_waitcnt lgkmcnt(6)
Ra 84,21,10240
Mvaa 144,32,12
Mvaa 148,36,12
Ta 120,28,16384
Ta 122,28,18432
Mvaa 152,40,12
Mvaa 156,44,12
Ra 88,21,12288
Mvaa 160,48,12
Mvaa 164,52,12
Ta 124,29,16384
Ta 126,29,18432
Mvaa 168,56,12
Mvaa 172,60,12
s_waitcnt lgkmcnt(6)
Ra 92,21,14336
Mvaa 176,32,16
Mvaa 180,36,16
Mvaa 184,40,16
Mvaa 188,44,16
Mvaa 192,48,16
Mvaa 196,52,16
Mvaa 200,56,16
Mvaa 204,60,16
Mvaa 208,32,20
Mvaa 212,36,20
Mvaa 216,40,20
Mvaa 220,44,20
Mvaa 224,48,20
Mvaa 228,52,20
Mvaa 232,56,20
Mvaa 236,60,20
Mvaa 240,32,24
Mvaa 244,36,24
Mvaa 248,40,24
Mvaa 252,44,24
Maaa 128,48,24
Maaa 132,52,24
Maaa 136,56,24
Maaa 140,60,24
Maaa 144,32,28
Maaa 148,36,28
Maaa 152,40,28
Maaa 156,44,28
Maaa 160,48,28
Maaa 164,52,28
Maaa 168,56,28
Maaa 172,60,28
s_waitcnt vmcnt(12) lgkmcnt(0)
v_readfirstlane_b32 s3, v30
s_nop 0
s_or_b32 s3, s3, s37
s_cmp_lt_u32 s3, 256
s_cbranch_scc1 L_spinAk
L_spinArk:
s_barrier
Mvaa 48,96,64
buffer_load_dwordx4 a[0:3], v10, s[20:23], 0 offen offset:0 sc1
Mvaa 52,100,64
v_lshrrev_b32 v42, 2, v33
v_lshl_add_u32 v43, v32, 3, v42
Mvaa 56,104,64
v_lshlrev_b32 v43, 8, v43
v_and_b32 v44, 3, v0
Mvaa 60,108,64
v_lshl_add_u32 v43, v44, 3, v43
v_and_b32 v44, 1, v32
Mvaa 64,112,64
buffer_load_dwordx4 a[4:7], v10, s[20:23], s58 offen offset:0 sc1
Mvaa 68,116,64
v_lshl_add_u32 v42, v44, 2, v42
v_xor_b32 v44, 0, v42
Mvaa 72,120,64
v_lshl_add_u32 v16, v44, 5, v43
v_xor_b32 v44, 1, v42
Mvaa 76,124,64
v_lshl_add_u32 v17, v44, 5, v43
v_xor_b32 v44, 2, v42
Mvaa 80,96,68
buffer_load_dwordx4 a[8:11], v11, s[20:23], 0 offen offset:0 sc1
Mvaa 84,100,68
v_lshl_add_u32 v18, v44, 5, v43
v_xor_b32 v44, 3, v42
Mvaa 88,104,68
v_lshl_add_u32 v19, v44, 5, v43
v_xor_b32 v44, 4, v42
Mvaa 92,108,68
v_lshl_add_u32 v20, v44, 5, v43
v_xor_b32 v44, 5, v42
Mvaa 96,112,68
buffer_load_dwordx4 a[12:15], v11, s[20:23], s58 offen offset:0 sc1
Mvaa 100,116,68
v_lshl_add_u32 v21, v44, 5, v43
v_xor_b32 v44, 6, v42
Mvaa 104,120,68
v_lshl_add_u32 v22, v44, 5, v43
v_xor_b32 v44, 7, v42
Mvaa 108,124,68
v_lshl_add_u32 v23, v44, 5, v43
Mvaa 112,96,72
buffer_load_dwordx4 a[16:19], v10, s[20:23], 0 offen offset:1024 sc1
Mvaa 116,100,72
Mvaa 120,104,72
Mvaa 124,108,72
Mvaa 128,112,72
buffer_load_dwordx4 a[20:23], v10, s[20:23], s58 offen offset:1024 sc1
Mvaa 132,116,72
Ta 192,16,0
Ta 194,16,1024
Mvaa 136,120,72
Ta 196,17,0
Ta 198,17,1024
Mvaa 140,124,72
Ta 200,18,0
Ta 202,18,1024
Mvaa 144,96,76
buffer_load_dwordx4 a[24:27], v11, s[20:23], 0 offen offset:1024 sc1
Mvaa 148,100,76
Ta 204,19,0
Ta 206,19,1024
Mvaa 152,104,76
Ta 208,20,0
Ta 210,20,1024
Mvaa 156,108,76
Ta 212,21,0
Ta 214,21,1024
Mvaa 160,112,76
buffer_load_dwordx4 a[28:31], v11, s[20:23], s58 offen offset:1024 sc1
Mvaa 164,116,76
Ta 216,22,0
Ta 218,22,1024
Mvaa 168,120,76
Ta 220,23,0
s_waitcnt lgkmcnt(9)
Ta 222,23,1024
Mvaa 172,124,76
s_waitcnt lgkmcnt(8)
Vc 24,48,49
Vc 25,50,51
Mvaa 176,96,80
buffer_load_dwordx4 a[32:35], v10, s[20:23], 0 offen offset:2048 sc1
Mvaa 180,100,80
Vc 26,52,53
Vc 27,54,55
Mvaa 184,104,80
Vc 28,56,57
Vc 29,58,59
Mvaa 188,108,80
Vc 30,60,61
Vc 31,62,63
Mvaa 192,112,80
buffer_load_dwordx4 a[36:39], v10, s[20:23], s58 offen offset:2048 sc1
Mvaa 196,116,80
Vc 32,64,65
Vc 33,66,67
Mvaa 200,120,80
Vc 34,68,69
Vc 35,70,71
Mvaa 204,124,80
Vc 36,72,73
Vc 37,74,75
Mvaa 208,96,84
buffer_load_dwordx4 a[40:43], v11, s[20:23], 0 offen offset:2048 sc1
Mvaa 212,100,84
Vc 38,76,77
Vc 39,78,79
Mvaa 216,104,84
Vc 40,80,81
Vc 41,82,83
Mvaa 220,108,84
Vc 42,84,85
Vc 43,86,87
Mvaa 224,112,84
buffer_load_dwordx4 a[44:47], v11, s[20:23], s58 offen offset:2048 sc1
Mvaa 228,116,84
Vc 44,88,89
Vc 45,90,91
Mvaa 232,120,84
Vc 46,92,93
Vc 47,94,95
Mvaa 236,124,84
Vc 48,96,97
Vc 49,98,99
Mvaa 240,96,88
buffer_load_dwordx4 a[48:51], v10, s[20:23], 0 offen offset:3072 sc1
Mvaa 244,100,88
Vc 50,100,101
Vc 51,102,103
Mvaa 248,104,88
Vc 52,104,105
Vc 53,106,107
Mvaa 252,108,88
Vc 54,108,109
Vc 55,110,111
Maaa 128,112,88
buffer_load_dwordx4 a[52:55], v10, s[20:23], s58 offen offset:3072 sc1
Maaa 132,116,88
Vc 56,112,113
Vc 57,114,115
Maaa 136,120,88
Vc 58,116,117
Vc 59,118,119
Maaa 140,124,88
Vc 60,120,121
Vc 61,122,123
Maaa 144,96,92
buffer_load_dwordx4 a[56:59], v11, s[20:23], 0 offen offset:3072 sc1
Maaa 148,100,92
Vc 62,124,125
Vc 63,126,127
Maaa 152,104,92
Vc 64,128,129
Vc 65,130,131
Maaa 156,108,92
Vc 66,132,133
Vc 67,134,135
Maaa 160,112,92
buffer_load_dwordx4 a[60:63], v11, s[20:23], s58 offen offset:3072 sc1
Maaa 164,116,92
v_add_u32 v10, 4096, v10
v_add_u32 v11, 4096, v11
Maaa 168,120,92
Vc 68,136,137
Vc 69,138,139
Maaa 172,124,92
Vc 70,140,141
Vc 71,142,143
Vc 72,144,145
Vc 73,146,147
Vc 74,148,149
Vc 75,150,151
Vc 76,152,153
Vc 77,154,155
Vc 78,156,157
Vc 79,158,159
Vc 80,160,161
Vc 81,162,163
Vc 82,164,165
Vc 83,166,167
Vc 84,168,169
Vc 85,170,171
Vc 86,172,173
Vc 87,174,175
Vc 88,176,177
Vc 89,178,179
Vc 90,180,181
Vc 91,182,183
Vc 92,184,185
Vc 93,186,187
Vc 94,188,189
Vc 95,190,191
Vc 96,192,193
Vc 97,194,195
Vc 98,196,197
Vc 99,198,199
Vc 100,200,201
Vc 101,202,203
Vc 102,204,205
Vc 103,206,207
Vc 104,208,209
Vc 105,210,211
Vc 106,212,213
Vc 107,214,215
Vc 108,216,217
Vc 109,218,219
Vc 110,220,221
Vc 111,222,223
Vc 112,224,225
Vc 113,226,227
Vc 114,228,229
Vc 115,230,231
Vc 116,232,233
Vc 117,234,235
Vc 118,236,237
Vc 119,238,239
Vc 120,240,241
Vc 121,242,243
Vc 122,244,245
Vc 123,246,247
Vc 124,248,249
Vc 125,250,251
Vc 126,252,253
Vc 127,254,255
s_branch L_phase2
L_k1_vpath:
s_waitcnt lgkmcnt(0)
Zvaa 48,0,32
v_and_b32 v46, 7, v0
v_mul_u32_u24 v30, 2064, v46
Zvaa 64,0,36
Ta 96,12,16384
Ta 98,12,18432
Zvaa 80,0,40
v_lshrrev_b32 v31, 3, v0
Zvaa 96,0,44
Ra 64,11,0
Zvaa 112,0,48
s_lshl_b32 s3, s32, 9
s_add_u32 s3, s3, 131072
v_lshl_add_u32 v30, v31, 4, v30
Zvaa 128,0,52
Ta 100,13,16384
Ta 102,13,18432
Zvaa 144,0,56
v_add_u32 v30, s3, v30
v_lshlrev_b32 v31, 8, v31
Zvaa 160,0,60
s_waitcnt lgkmcnt(6)
Ra 68,11,2048
Zvaa 52,4,32
v_lshl_add_u32 v46, v46, 4, v31
Zvaa 68,4,36
Ta 104,14,16384
Ta 106,14,18432
Zvaa 84,4,40
Rv 34,30,128
Rv 38,30,256
Zvaa 100,4,44
Ra 72,11,4096
Zvaa 116,4,48
Rv 42,30,384
Rv 30,30,0
Zvaa 132,4,52
Ta 108,15,16384
Ta 110,15,18432
Zvaa 148,4,56
s_lshr_b32 s3, s2, 1
s_mul_i32 s3, s3, 33792
s_add_u32 s3, s3, s56
Zvaa 164,4,60
s_waitcnt lgkmcnt(6)
Ra 76,11,6144
Zvaa 56,8,32
s_and_b32 s39, s2, 1
s_lshl_b32 s39, s39, 7
s_add_u32 s3, s3, s39
Zvaa 72,8,36
Ta 112,16,16384
Ta 114,16,18432
Zvaa 88,8,40
s_add_u32 s39, s3, 4096
Zvaa 104,8,44
Ra 80,11,8192
Zvaa 120,8,48
Zvaa 136,8,52
Ta 116,17,16384
Ta 118,17,18432
Zvaa 152,8,56
Zvaa 168,8,60
s_waitcnt lgkmcnt(6)
Ra 84,11,10240
Zvaa 60,12,32
Zvaa 76,12,36
Ta 120,18,16384
Ta 122,18,18432
Zvaa 92,12,40
Zvaa 108,12,44
Ra 88,11,12288
Zvaa 124,12,48
Zvaa 140,12,52
Ta 124,19,16384
Ta 126,19,18432
Zvaa 156,12,56
Zvaa 172,12,60
s_waitcnt lgkmcnt(6)
Ra 92,11,14336
Zvaa 176,16,32
Zvaa 192,16,36
Zvaa 208,16,40
Zvaa 224,16,44
Zvaa 240,16,48
Zaaa 128,16,52
Zaaa 144,16,56
Zaaa 160,16,60
Zvaa 180,20,32
Zvaa 196,20,36
Zvaa 212,20,40
Zvaa 228,20,44
Zvaa 244,20,48
Zaaa 132,20,52
Zaaa 148,20,56
Zaaa 164,20,60
Zvaa 184,24,32
Zvaa 200,24,36
Zvaa 216,24,40
Zvaa 232,24,44
Zvaa 248,24,48
Zaaa 136,24,52
Zaaa 152,24,56
Zaaa 168,24,60
Zvaa 188,28,32
Zvaa 204,28,36
Zvaa 220,28,40
Zvaa 236,28,44
Zvaa 252,28,48
Zaaa 140,28,52
Zaaa 156,28,56
Zaaa 172,28,60
s_waitcnt vmcnt(4) lgkmcnt(0)
s_add_u32 m0, s57, 0
s_barrier
Mvaa 48,64,96
buffer_load_dwordx4 v6, s[12:15], s52 offen offset:0 nt lds
Mvaa 64,64,100
Ta 32,22,0
Ta 34,22,2048
Mvaa 80,64,104
Mvaa 96,64,108
Ra 0,20,0
Mvaa 112,64,112
buffer_load_dwordx4 v7, s[12:15], s53 offen offset:1024 nt lds
Mvaa 128,64,116
s_waitcnt lgkmcnt(6)
Ta 36,23,0
Ta 38,23,2048
Mvaa 144,64,120
Mvaa 160,64,124
Ra 4,20,2048
Mvaa 52,68,96
buffer_load_dwordx4 v6, s[12:15], s54 offen offset:2048 nt lds
Mvaa 68,68,100
Ta 40,24,0
Ta 42,24,2048
Mvaa 84,68,104
Mvaa 100,68,108
Ra 8,20,4096
Mvaa 116,68,112
buffer_load_dwordx4 v7, s[12:15], s55 offen offset:3072 nt lds
Mvaa 132,68,116
s_waitcnt lgkmcnt(6)
Ta 44,25,0
Ta 46,25,2048
Mvaa 148,68,120
Mvaa 164,68,124
s_add_u32 m0, s57, 4096
Ra 12,20,6144
Mvaa 56,72,96
buffer_load_dwordx4 v8, s[12:15], s52 offen offset:0 nt lds
Mvaa 72,72,100
Ta 48,26,0
Ta 50,26,2048
Mvaa 88,72,104
Mvaa 104,72,108
Ra 16,20,8192
Mvaa 120,72,112
buffer_load_dwordx4 v9, s[12:15], s53 offen offset:1024 nt lds
Mvaa 136,72,116
s_waitcnt lgkmcnt(6)
Ta 52,27,0
Ta 54,27,2048
Mvaa 152,72,120
Mvaa 168,72,124
Ra 20,20,10240
Mvaa 60,76,96
buffer_load_dwordx4 v8, s[12:15], s54 offen offset:2048 nt lds
Mvaa 76,76,100
Ta 56,28,0
Ta 58,28,2048
Mvaa 92,76,104
Mvaa 108,76,108
Ra 24,20,12288
Mvaa 124,76,112
buffer_load_dwordx4 v9, s[12:15], s55 offen offset:3072 nt lds
Mvaa 140,76,116
s_waitcnt lgkmcnt(6)
Ta 60,29,0
Ta 62,29,2048
Mvaa 156,76,120
v_add_u32 v6, 524288, v6
v_add_u32 v7, 524288, v7
Mvaa 172,76,124
s_add_u32 m0, s56, 0
Ra 28,20,14336
v_add_u32 v8, 524288, v8
Mvaa 176,80,96
buffer_load_dwordx4 v2, s[8:11], s48 offen offset:0 lds
Mvaa 192,80,100
v_add_u32 v9, 524288, v9
Mvaa 208,80,104
Mvaa 224,80,108
Mvaa 240,80,112
buffer_load_dwordx4 v3, s[8:11], s49 offen offset:1024 lds
Maaa 128,80,116
Maaa 144,80,120
Maaa 160,80,124
Mvaa 180,84,96
buffer_load_dwordx4 v2, s[8:11], s50 offen offset:2048 lds
Mvaa 196,84,100
Mvaa 212,84,104
Mvaa 228,84,108
Mvaa 244,84,112
buffer_load_dwordx4 v3, s[8:11], s51 offen offset:3072 lds
Maaa 132,84,116
Maaa 148,84,120
Maaa 164,84,124
s_add_u32 m0, s56, 4096
Mvaa 184,88,96
buffer_load_dwordx4 v4, s[8:11], s48 offen offset:0 lds
Mvaa 200,88,100
Mvaa 216,88,104
Mvaa 232,88,108
Mvaa 248,88,112
buffer_load_dwordx4 v5, s[8:11], s49 offen offset:1024 lds
Maaa 136,88,116
Maaa 152,88,120
Maaa 168,88,124
Mvaa 188,92,96
buffer_load_dwordx4 v4, s[8:11], s50 offen offset:2048 lds
Mvaa 204,92,100
Mvaa 220,92,104
Mvaa 236,92,108
Mvaa 252,92,112
buffer_load_dwordx4 v5, s[8:11], s51 offen offset:3072 lds
Maaa 140,92,116
v_add_u32 v2, 128, v2
v_add_u32 v3, 128, v3
Maaa 156,92,120
buffer_load_dword v1, v47, s[60:63], 0 offen
v_add_u32 v4, 128, v4
v_add_u32 v5, 128, v5
Maaa 172,92,124
v_add_u32 v47, s59, v47
s_waitcnt lgkmcnt(0)
Mvaa 48,0,32
buffer_store_dwordx4 v[30:33], v46, s[20:23], s3 offen offset:0 sc1
Mvaa 64,0,36
Ta 96,22,16384
Ta 98,22,18432
Mvaa 80,0,40
buffer_store_dwordx4 v[34:37], v46, s[20:23], s3 offen offset:2048 sc1
Mvaa 96,0,44
Ra 64,21,0
Mvaa 112,0,48
buffer_store_dwordx4 v[38:41], v46, s[20:23], s39 offen offset:0 sc1
Mvaa 128,0,52
Ta 100,23,16384
Ta 102,23,18432
Mvaa 144,0,56
buffer_store_dwordx4 v[42:45], v46, s[20:23], s39 offen offset:2048 sc1
Mvaa 160,0,60
s_waitcnt lgkmcnt(6)
Ra 68,21,2048
Mvaa 52,4,32
s_lshl_b32 s3, s34, 1
s_and_b32 s36, s32, 1
s_add_u32 s3, s3, s36
Mvaa 68,4,36
Ta 104,24,16384
Ta 106,24,18432
Mvaa 84,4,40
s_mul_i32 s3, s3, 1116160
s_mul_i32 s36, s33, 139264
s_add_u32 s3, s3, s36
Mvaa 100,4,44
Ra 72,21,4096
Mvaa 116,4,48
s_lshr_b32 s36, s32, 1
s_mul_i32 s36, s36, 69632
s_add_u32 s3, s3, s36
Mvaa 132,4,52
Ta 108,25,16384
Ta 110,25,18432
Mvaa 148,4,56
s_add_u32 s38, s3, 17408
s_lshl_b32 s39, s34, 7
s_lshl_b32 s36, s33, 2
Mvaa 164,4,60
s_waitcnt lgkmcnt(6)
Ra 76,21,6144
Mvaa 56,8,32
s_add_u32 s39, s39, s36
s_add_u32 s39, s39, 5296160
v_mov_b32 v30, 1
Mvaa 72,8,36
Ta 112,26,16384
Ta 114,26,18432
Mvaa 88,8,40
v_mov_b32 v31, 0
Mvaa 104,8,44
Ra 80,21,8192
Mvaa 120,8,48
s_cmp_eq_u32 s32, 0
s_cselect_b32 s39, s39, 2146435072
Mvaa 136,8,52
Ta 116,27,16384
Ta 118,27,18432
Mvaa 152,8,56
s_mov_b64 exec, 1
buffer_store_dword v31, v31, s[20:23], s39 offen sc1
s_mov_b64 exec, -1
Mvaa 168,8,60
s_waitcnt lgkmcnt(6)
Ra 84,21,10240
Mvaa 60,12,32
s_and_b32 s33, s2, 7
s_lshl_b32 s33, s33, 2
s_bfe_u32 s3, s2, 0x20003
Mvaa 76,12,36
Ta 120,28,16384
Ta 122,28,18432
Mvaa 92,12,40
s_add_u32 s33, s33, s3
s_lshr_b32 s34, s2, 5
s_lshl_b32 s35, s34, 1
Mvaa 108,12,44
Ra 88,21,12288
Mvaa 124,12,48
s_sub_u32 s36, 32, s35
s_add_u32 s35, s35, 2
s_lshl_b32 s44, s32, 12
Mvaa 140,12,52
Ta 124,29,16384
Ta 126,29,18432
Mvaa 156,12,56
s_mov_b32 s58, 33792
s_sub_u32 s3, 15, s34
s_lshl_b32 s45, s3, 2
Mvaa 172,12,60
s_waitcnt lgkmcnt(6)
Ra 92,21,14336
Mvaa 176,16,32
s_add_u32 s45, s45, s32
s_lshl_b32 s46, s34, 2
s_add_u32 s46, s46, s32
Mvaa 192,16,36
s_add_u32 s16, s66, 46137344
s_addc_u32 s17, s67, 0
s_and_b32 s17, s17, 0xffff
Mvaa 208,16,40
s_mov_b32 s18, 16777216
s_mov_b32 s19, 0x20000
s_mov_b32 s68, s42
Mvaa 224,16,44
s_and_b32 s69, s43, 0xffff
s_mov_b32 s70, 7340032
s_mov_b32 s71, 0x20000
Mvaa 240,16,48
s_cmp_eq_u32 s32, 0
s_cselect_b32 s37, 0, 2146435072
Maaa 128,16,52
Maaa 144,16,56
Maaa 160,16,60
Mvaa 180,20,32
Mvaa 196,20,36
Mvaa 212,20,40
Mvaa 228,20,44
Mvaa 244,20,48
Maaa 132,20,52
Maaa 148,20,56
Maaa 164,20,60
Mvaa 184,24,32
Mvaa 200,24,36
Mvaa 216,24,40
Mvaa 232,24,44
Mvaa 248,24,48
Maaa 136,24,52
Maaa 152,24,56
Maaa 168,24,60
Mvaa 188,28,32
Mvaa 204,28,36
Mvaa 220,28,40
Mvaa 236,28,44
Mvaa 252,28,48
Maaa 140,28,52
Maaa 156,28,56
Maaa 172,28,60
s_waitcnt vmcnt(6) lgkmcnt(0)
s_add_u32 m0, s57, 65536
s_barrier
Mvaa 48,64,96
buffer_load_dwordx4 v6, s[12:15], s52 offen offset:0 nt lds
Mvaa 64,64,100
Ta 32,12,0
Ta 34,12,2048
Mvaa 80,64,104
Mvaa 96,64,108
Ra 0,10,0
Mvaa 112,64,112
buffer_load_dwordx4 v7, s[12:15], s53 offen offset:1024 nt lds
Mvaa 128,64,116
s_waitcnt lgkmcnt(6)
Ta 36,13,0
Ta 38,13,2048
Mvaa 144,64,120
Mvaa 160,64,124
Ra 4,10,2048
Mvaa 52,68,96
buffer_load_dwordx4 v6, s[12:15], s54 offen offset:2048 nt lds
Mvaa 68,68,100
Ta 40,14,0
Ta 42,14,2048
Mvaa 84,68,104
Mvaa 100,68,108
Ra 8,10,4096
Mvaa 116,68,112
buffer_load_dwordx4 v7, s[12:15], s55 offen offset:3072 nt lds
Mvaa 132,68,116
s_waitcnt lgkmcnt(6)
Ta 44,15,0
Ta 46,15,2048
Mvaa 148,68,120
Mvaa 164,68,124
s_add_u32 m0, s57, 69632
Ra 12,10,6144
Mvaa 56,72,96
buffer_load_dwordx4 v8, s[12:15], s52 offen offset:0 nt lds
Mvaa 72,72,100
Ta 48,16,0
Ta 50,16,2048
Mvaa 88,72,104
Mvaa 104,72,108
Ra 16,10,8192
Mvaa 120,72,112
buffer_load_dwordx4 v9, s[12:15], s53 offen offset:1024 nt lds
Mvaa 136,72,116
s_waitcnt lgkmcnt(6)
Ta 52,17,0
Ta 54,17,2048
Mvaa 152,72,120
Mvaa 168,72,124
Ra 20,10,10240
Mvaa 60,76,96
buffer_load_dwordx4 v8, s[12:15], s54 offen offset:2048 nt lds
Mvaa 76,76,100
Ta 56,18,0
Ta 58,18,2048
Mvaa 92,76,104
Mvaa 108,76,108
Ra 24,10,12288
Mvaa 124,76,112
buffer_load_dwordx4 v9, s[12:15], s55 offen offset:3072 nt lds
Mvaa 140,76,116
s_waitcnt lgkmcnt(6)
Ta 60,19,0
Ta 62,19,2048
Mvaa 156,76,120
v_add_u32 v6, 524288, v6
v_add_u32 v7, 524288, v7
Mvaa 172,76,124
s_add_u32 m0, s56, 65536
Ra 28,10,14336
v_add_u32 v8, 524288, v8
Mvaa 176,80,96
buffer_load_dwordx4 v2, s[8:11], s48 offen offset:0 lds
Mvaa 192,80,100
v_add_u32 v9, 524288, v9
Mvaa 208,80,104
Mvaa 224,80,108
Mvaa 240,80,112
buffer_load_dwordx4 v3, s[8:11], s49 offen offset:1024 lds
Maaa 128,80,116
Maaa 144,80,120
Maaa 160,80,124
Mvaa 180,84,96
buffer_load_dwordx4 v2, s[8:11], s50 offen offset:2048 lds
Mvaa 196,84,100
Mvaa 212,84,104
Mvaa 228,84,108
Mvaa 244,84,112
buffer_load_dwordx4 v3, s[8:11], s51 offen offset:3072 lds
Maaa 132,84,116
Maaa 148,84,120
Maaa 164,84,124
s_add_u32 m0, s56, 69632
Mvaa 184,88,96
buffer_load_dwordx4 v4, s[8:11], s48 offen offset:0 lds
Mvaa 200,88,100
Mvaa 216,88,104
Mvaa 232,88,108
Mvaa 248,88,112
buffer_load_dwordx4 v5, s[8:11], s49 offen offset:1024 lds
Maaa 136,88,116
Maaa 152,88,120
Maaa 168,88,124
Mvaa 188,92,96
buffer_load_dwordx4 v4, s[8:11], s50 offen offset:2048 lds
Mvaa 204,92,100
Mvaa 220,92,104
Mvaa 236,92,108
Mvaa 252,92,112
buffer_load_dwordx4 v5, s[8:11], s51 offen offset:3072 lds
Maaa 140,92,116
v_add_u32 v2, 128, v2
v_add_u32 v3, 128, v3
Maaa 156,92,120
buffer_load_dword v1, v47, s[60:63], 0 offen
v_add_u32 v4, 128, v4
v_add_u32 v5, 128, v5
Maaa 172,92,124
v_add_u32 v47, s59, v47
s_waitcnt lgkmcnt(0)
Mvaa 48,0,32
Mvaa 64,0,36
Ta 96,12,16384
Ta 98,12,18432
Mvaa 80,0,40
Mvaa 96,0,44
Ra 64,11,0
Mvaa 112,0,48
Mvaa 128,0,52
Ta 100,13,16384
Ta 102,13,18432
Mvaa 144,0,56
Mvaa 160,0,60
s_waitcnt lgkmcnt(6)
Ra 68,11,2048
Mvaa 52,4,32
Mvaa 68,4,36
Ta 104,14,16384
Ta 106,14,18432
Mvaa 84,4,40
Mvaa 100,4,44
Ra 72,11,4096
Mvaa 116,4,48
Mvaa 132,4,52
Ta 108,15,16384
Ta 110,15,18432
Mvaa 148,4,56
Mvaa 164,4,60
s_waitcnt lgkmcnt(6)
Ra 76,11,6144
Mvaa 56,8,32
Mvaa 72,8,36
Ta 112,16,16384
Ta 114,16,18432
Mvaa 88,8,40
Mvaa 104,8,44
Ra 80,11,8192
Mvaa 120,8,48
Mvaa 136,8,52
Ta 116,17,16384
Ta 118,17,18432
Mvaa 152,8,56
Mvaa 168,8,60
s_waitcnt lgkmcnt(6)
Ra 84,11,10240
Mvaa 60,12,32
Mvaa 76,12,36
Ta 120,18,16384
Ta 122,18,18432
Mvaa 92,12,40
Mvaa 108,12,44
Ra 88,11,12288
Mvaa 124,12,48
Mvaa 140,12,52
Ta 124,19,16384
Ta 126,19,18432
Mvaa 156,12,56
Mvaa 172,12,60
s_waitcnt lgkmcnt(6)
Ra 92,11,14336
Mvaa 176,16,32
Mvaa 192,16,36
Mvaa 208,16,40
Mvaa 224,16,44
Mvaa 240,16,48
Maaa 128,16,52
Maaa 144,16,56
Maaa 160,16,60
Mvaa 180,20,32
Mvaa 196,20,36
Mvaa 212,20,40
Mvaa 228,20,44
Mvaa 244,20,48
Maaa 132,20,52
Maaa 148,20,56
Maaa 164,20,60
Mvaa 184,24,32
Mvaa 200,24,36
Mvaa 216,24,40
Mvaa 232,24,44
Mvaa 248,24,48
Maaa 136,24,52
Maaa 152,24,56
Maaa 168,24,60
Mvaa 188,28,32
Mvaa 204,28,36
Mvaa 220,28,40
Mvaa 236,28,44
Mvaa 252,28,48
Maaa 140,28,52
Maaa 156,28,56
Maaa 172,28,60
s_waitcnt vmcnt(1) lgkmcnt(0)
s_add_u32 m0, s57, 0
s_barrier
Mvaa 48,64,96
buffer_load_dwordx4 v6, s[12:15], s52 offen offset:0 nt lds
Mvaa 64,64,100
Ta 32,22,0
Ta 34,22,2048
Mvaa 80,64,104
Mvaa 96,64,108
Ra 0,20,0
Mvaa 112,64,112
buffer_load_dwordx4 v7, s[12:15], s53 offen offset:1024 nt lds
Mvaa 128,64,116
s_waitcnt lgkmcnt(6)
Ta 36,23,0
Ta 38,23,2048
Mvaa 144,64,120
Mvaa 160,64,124
Ra 4,20,2048
Mvaa 52,68,96
buffer_load_dwordx4 v6, s[12:15], s54 offen offset:2048 nt lds
Mvaa 68,68,100
Ta 40,24,0
Ta 42,24,2048
Mvaa 84,68,104
Mvaa 100,68,108
Ra 8,20,4096
Mvaa 116,68,112
buffer_load_dwordx4 v7, s[12:15], s55 offen offset:3072 nt lds
Mvaa 132,68,116
s_waitcnt lgkmcnt(6)
Ta 44,25,0
Ta 46,25,2048
Mvaa 148,68,120
Mvaa 164,68,124
s_add_u32 m0, s57, 4096
Ra 12,20,6144
Mvaa 56,72,96
buffer_load_dwordx4 v8, s[12:15], s52 offen offset:0 nt lds
Mvaa 72,72,100
Ta 48,26,0
Ta 50,26,2048
Mvaa 88,72,104
Mvaa 104,72,108
Ra 16,20,8192
Mvaa 120,72,112
buffer_load_dwordx4 v9, s[12:15], s53 offen offset:1024 nt lds
Mvaa 136,72,116
s_waitcnt lgkmcnt(6)
Ta 52,27,0
Ta 54,27,2048
Mvaa 152,72,120
Mvaa 168,72,124
Ra 20,20,10240
Mvaa 60,76,96
buffer_load_dwordx4 v8, s[12:15], s54 offen offset:2048 nt lds
Mvaa 76,76,100
Ta 56,28,0
Ta 58,28,2048
Mvaa 92,76,104
Mvaa 108,76,108
Ra 24,20,12288
Mvaa 124,76,112
buffer_load_dwordx4 v9, s[12:15], s55 offen offset:3072 nt lds
Mvaa 140,76,116
s_waitcnt lgkmcnt(6)
Ta 60,29,0
Ta 62,29,2048
Mvaa 156,76,120
v_add_u32 v6, 524288, v6
v_add_u32 v7, 524288, v7
Mvaa 172,76,124
s_add_u32 m0, s56, 0
Ra 28,20,14336
v_add_u32 v8, 524288, v8
Mvaa 176,80,96
buffer_load_dwordx4 v2, s[8:11], s48 offen offset:0 lds
Mvaa 192,80,100
v_add_u32 v9, 524288, v9
Mvaa 208,80,104
Mvaa 224,80,108
Mvaa 240,80,112
buffer_load_dwordx4 v3, s[8:11], s49 offen offset:1024 lds
Maaa 128,80,116
Maaa 144,80,120
Maaa 160,80,124
Mvaa 180,84,96
buffer_load_dwordx4 v2, s[8:11], s50 offen offset:2048 lds
Mvaa 196,84,100
Mvaa 212,84,104
Mvaa 228,84,108
Mvaa 244,84,112
buffer_load_dwordx4 v3, s[8:11], s51 offen offset:3072 lds
Maaa 132,84,116
Maaa 148,84,120
Maaa 164,84,124
s_add_u32 m0, s56, 4096
Mvaa 184,88,96
buffer_load_dwordx4 v4, s[8:11], s48 offen offset:0 lds
Mvaa 200,88,100
Mvaa 216,88,104
Mvaa 232,88,108
Mvaa 248,88,112
buffer_load_dwordx4 v5, s[8:11], s49 offen offset:1024 lds
Maaa 136,88,116
Maaa 152,88,120
Maaa 168,88,124
Mvaa 188,92,96
buffer_load_dwordx4 v4, s[8:11], s50 offen offset:2048 lds
Mvaa 204,92,100
Mvaa 220,92,104
Mvaa 236,92,108
Mvaa 252,92,112
buffer_load_dwordx4 v5, s[8:11], s51 offen offset:3072 lds
Maaa 140,92,116
v_add_u32 v2, 128, v2
v_add_u32 v3, 128, v3
Maaa 156,92,120
buffer_load_dword v1, v47, s[60:63], 0 offen
v_add_u32 v4, 128, v4
v_add_u32 v5, 128, v5
Maaa 172,92,124
v_add_u32 v47, s59, v47
s_waitcnt lgkmcnt(0)
Mvaa 48,0,32
s_mov_b64 exec, 1
buffer_atomic_add v30, v31, s[28:31], s37 offen sc1
s_mov_b64 exec, -1
Mvaa 64,0,36
Ta 96,22,16384
Ta 98,22,18432
Mvaa 80,0,40
Mvaa 96,0,44
Ra 64,21,0
Mvaa 112,0,48
Mvaa 128,0,52
Ta 100,23,16384
Ta 102,23,18432
Mvaa 144,0,56
Mvaa 160,0,60
s_waitcnt lgkmcnt(6)
Ra 68,21,2048
Mvaa 52,4,32
Mvaa 68,4,36
Ta 104,24,16384
Ta 106,24,18432
Mvaa 84,4,40
Mvaa 100,4,44
Ra 72,21,4096
Mvaa 116,4,48
Mvaa 132,4,52
Ta 108,25,16384
Ta 110,25,18432
Mvaa 148,4,56
Mvaa 164,4,60
s_waitcnt lgkmcnt(6)
Ra 76,21,6144
Mvaa 56,8,32
Mvaa 72,8,36
Ta 112,26,16384
Ta 114,26,18432
Mvaa 88,8,40
Mvaa 104,8,44
Ra 80,21,8192
Mvaa 120,8,48
Mvaa 136,8,52
Ta 116,27,16384
Ta 118,27,18432
Mvaa 152,8,56
Mvaa 168,8,60
s_waitcnt lgkmcnt(6)
Ra 84,21,10240
Mvaa 60,12,32
Mvaa 76,12,36
Ta 120,28,16384
Ta 122,28,18432
Mvaa 92,12,40
Mvaa 108,12,44
Ra 88,21,12288
Mvaa 124,12,48
Mvaa 140,12,52
Ta 124,29,16384
Ta 126,29,18432
Mvaa 156,12,56
Mvaa 172,12,60
s_waitcnt lgkmcnt(6)
Ra 92,21,14336
Mvaa 176,16,32
Mvaa 192,16,36
Mvaa 208,16,40
Mvaa 224,16,44
Mvaa 240,16,48
Maaa 128,16,52
Maaa 144,16,56
Maaa 160,16,60
Mvaa 180,20,32
Mvaa 196,20,36
Mvaa 212,20,40
Mvaa 228,20,44
Mvaa 244,20,48
Maaa 132,20,52
Maaa 148,20,56
Maaa 164,20,60
Mvaa 184,24,32
Mvaa 200,24,36
Mvaa 216,24,40
Mvaa 232,24,44
Mvaa 248,24,48
Maaa 136,24,52
Maaa 152,24,56
Maaa 168,24,60
Mvaa 188,28,32
Mvaa 204,28,36
Mvaa 220,28,40
Mvaa 236,28,44
Mvaa 252,28,48
Maaa 140,28,52
Maaa 156,28,56
Maaa 172,28,60
s_waitcnt vmcnt(2) lgkmcnt(0)
s_add_u32 m0, s57, 65536
s_barrier
Mvaa 48,64,96
buffer_load_dwordx4 v6, s[12:15], s52 offen offset:0 nt lds
Mvaa 64,64,100
Ta 32,12,0
Ta 34,12,2048
Mvaa 80,64,104
Mvaa 96,64,108
Ra 0,10,0
Mvaa 112,64,112
buffer_load_dwordx4 v7, s[12:15], s53 offen offset:1024 nt lds
Mvaa 128,64,116
s_waitcnt lgkmcnt(6)
Ta 36,13,0
Ta 38,13,2048
Mvaa 144,64,120
Mvaa 160,64,124
Ra 4,10,2048
Mvaa 52,68,96
buffer_load_dwordx4 v6, s[12:15], s54 offen offset:2048 nt lds
Mvaa 68,68,100
Ta 40,14,0
Ta 42,14,2048
Mvaa 84,68,104
Mvaa 100,68,108
Ra 8,10,4096
Mvaa 116,68,112
buffer_load_dwordx4 v7, s[12:15], s55 offen offset:3072 nt lds
Mvaa 132,68,116
s_waitcnt lgkmcnt(6)
Ta 44,15,0
Ta 46,15,2048
Mvaa 148,68,120
Mvaa 164,68,124
s_add_u32 m0, s57, 69632
Ra 12,10,6144
Mvaa 56,72,96
buffer_load_dwordx4 v8, s[12:15], s52 offen offset:0 nt lds
Mvaa 72,72,100
Ta 48,16,0
Ta 50,16,2048
Mvaa 88,72,104
Mvaa 104,72,108
Ra 16,10,8192
Mvaa 120,72,112
buffer_load_dwordx4 v9, s[12:15], s53 offen offset:1024 nt lds
Mvaa 136,72,116
s_waitcnt lgkmcnt(6)
Ta 52,17,0
Ta 54,17,2048
Mvaa 152,72,120
Mvaa 168,72,124
Ra 20,10,10240
Mvaa 60,76,96
buffer_load_dwordx4 v8, s[12:15], s54 offen offset:2048 nt lds
Mvaa 76,76,100
Ta 56,18,0
Ta 58,18,2048
Mvaa 92,76,104
Mvaa 108,76,108
Ra 24,10,12288
Mvaa 124,76,112
buffer_load_dwordx4 v9, s[12:15], s55 offen offset:3072 nt lds
Mvaa 140,76,116
s_waitcnt lgkmcnt(6)
Ta 60,19,0
Ta 62,19,2048
Mvaa 156,76,120
v_add_u32 v6, 524288, v6
v_add_u32 v7, 524288, v7
Mvaa 172,76,124
s_add_u32 m0, s56, 65536
Ra 28,10,14336
v_add_u32 v8, 524288, v8
Mvaa 176,80,96
buffer_load_dwordx4 v2, s[8:11], s48 offen offset:0 lds
Mvaa 192,80,100
v_add_u32 v9, 524288, v9
Mvaa 208,80,104
Mvaa 224,80,108
Mvaa 240,80,112
buffer_load_dwordx4 v3, s[8:11], s49 offen offset:1024 lds
Maaa 128,80,116
Maaa 144,80,120
Maaa 160,80,124
Mvaa 180,84,96
buffer_load_dwordx4 v2, s[8:11], s50 offen offset:2048 lds
Mvaa 196,84,100
Mvaa 212,84,104
Mvaa 228,84,108
Mvaa 244,84,112
buffer_load_dwordx4 v3, s[8:11], s51 offen offset:3072 lds
Maaa 132,84,116
Maaa 148,84,120
Maaa 164,84,124
s_add_u32 m0, s56, 69632
Mvaa 184,88,96
buffer_load_dwordx4 v4, s[8:11], s48 offen offset:0 lds
Mvaa 200,88,100
Mvaa 216,88,104
Mvaa 232,88,108
Mvaa 248,88,112
buffer_load_dwordx4 v5, s[8:11], s49 offen offset:1024 lds
Maaa 136,88,116
Maaa 152,88,120
Maaa 168,88,124
Mvaa 188,92,96
buffer_load_dwordx4 v4, s[8:11], s50 offen offset:2048 lds
Mvaa 204,92,100
Mvaa 220,92,104
Mvaa 236,92,108
Mvaa 252,92,112
buffer_load_dwordx4 v5, s[8:11], s51 offen offset:3072 lds
Maaa 140,92,116
v_add_u32 v2, 128, v2
v_add_u32 v3, 128, v3
Maaa 156,92,120
buffer_load_dword v1, v47, s[60:63], 0 offen
v_add_u32 v4, 128, v4
v_add_u32 v5, 128, v5
Maaa 172,92,124
v_add_u32 v47, s59, v47
s_waitcnt lgkmcnt(0)
Mvaa 48,0,32
s_lshl_b32 s3, s33, 8
s_add_u32 s60, s4, s3
s_addc_u32 s61, s5, 0
s_and_b32 s61, s61, 0xffff
Mvaa 64,0,36
Ta 96,12,16384
Ta 98,12,18432
Mvaa 80,0,40
s_mov_b32 s62, 0
s_mov_b32 s63, 0x20000
s_sub_u32 s62, 8388608, s3
Mvaa 96,0,44
Ra 64,11,0
Mvaa 112,0,48
v_lshrrev_b32 v32, 1, v0
v_and_b32 v33, 1, v0
Mvaa 128,0,52
Ta 100,13,16384
Ta 102,13,18432
Mvaa 144,0,56
v_lshlrev_b32 v32, 13, v32
v_lshl_add_u32 v32, v33, 7, v32
Mvaa 160,0,60
s_waitcnt lgkmcnt(6)
Ra 68,11,2048
Mvaa 52,4,32
s_lshl_b32 s3, s32, 3
s_add_u32 s3, s3, s34
s_lshl_b32 s3, s3, 18
Mvaa 68,4,36
Ta 104,14,16384
Ta 106,14,18432
Mvaa 84,4,40
s_mov_b32 s59, 8388608
v_add_u32 v47, s3, v32
v_lshrrev_b32 v32, 4, v0
Mvaa 100,4,44
Ra 72,11,4096
Mvaa 116,4,48
v_and_b32 v33, 15, v0
Mvaa 132,4,52
Ta 108,15,16384
Ta 110,15,18432
Mvaa 148,4,56
s_lshl_b32 s3, s32, 4
v_add_u32 v34, s3, v32
v_lshlrev_b32 v36, 1, v32
Mvaa 164,4,60
s_waitcnt lgkmcnt(6)
Ra 76,11,6144
Mvaa 56,8,32
v_xor_b32 v36, v36, v33
v_xor_b32 v37, 8, v36
Mvaa 72,8,36
Ta 112,16,16384
Ta 114,16,18432
Mvaa 88,8,40
Mvaa 104,8,44
Ra 80,11,8192
Mvaa 120,8,48
Mvaa 136,8,52
Ta 116,17,16384
Ta 118,17,18432
Mvaa 152,8,56
Mvaa 168,8,60
s_waitcnt lgkmcnt(6)
Ra 84,11,10240
Mvaa 60,12,32
Mvaa 76,12,36
Ta 120,18,16384
Ta 122,18,18432
Mvaa 92,12,40
Mvaa 108,12,44
Ra 88,11,12288
Mvaa 124,12,48
Mvaa 140,12,52
Ta 124,19,16384
Ta 126,19,18432
Mvaa 156,12,56
Mvaa 172,12,60
s_waitcnt lgkmcnt(6)
Ra 92,11,14336
Mvaa 176,16,32
Mvaa 192,16,36
Mvaa 208,16,40
Mvaa 224,16,44
Mvaa 240,16,48
Maaa 128,16,52
Maaa 144,16,56
Maaa 160,16,60
Mvaa 180,20,32
Mvaa 196,20,36
Mvaa 212,20,40
Mvaa 228,20,44
Mvaa 244,20,48
Maaa 132,20,52
Maaa 148,20,56
Maaa 164,20,60
Mvaa 184,24,32
Mvaa 200,24,36
Mvaa 216,24,40
Mvaa 232,24,44
Mvaa 248,24,48
Maaa 136,24,52
Maaa 152,24,56
Maaa 168,24,60
Mvaa 188,28,32
Mvaa 204,28,36
Mvaa 220,28,40
Mvaa 236,28,44
Mvaa 252,28,48
Maaa 140,28,52
Maaa 156,28,56
Maaa 172,28,60
s_waitcnt vmcnt(1) lgkmcnt(0)
s_add_u32 m0, s57, 0
s_barrier
Mvaa 48,64,96
buffer_load_dwordx4 v6, s[12:15], s52 offen offset:0 nt lds
Mvaa 64,64,100
Ta 32,22,0
Ta 34,22,2048
Mvaa 80,64,104
Mvaa 96,64,108
Ra 0,20,0
Mvaa 112,64,112
buffer_load_dwordx4 v7, s[12:15], s53 offen offset:1024 nt lds
Mvaa 128,64,116
s_waitcnt lgkmcnt(6)
Ta 36,23,0
Ta 38,23,2048
Mvaa 144,64,120
Mvaa 160,64,124
Ra 4,20,2048
Mvaa 52,68,96
buffer_load_dwordx4 v6, s[12:15], s54 offen offset:2048 nt lds
Mvaa 68,68,100
Ta 40,24,0
Ta 42,24,2048
Mvaa 84,68,104
Mvaa 100,68,108
Ra 8,20,4096
Mvaa 116,68,112
buffer_load_dwordx4 v7, s[12:15], s55 offen offset:3072 nt lds
Mvaa 132,68,116
s_waitcnt lgkmcnt(6)
Ta 44,25,0
Ta 46,25,2048
Mvaa 148,68,120
Mvaa 164,68,124
s_add_u32 m0, s57, 4096
Ra 12,20,6144
Mvaa 56,72,96
buffer_load_dwordx4 v8, s[12:15], s52 offen offset:0 nt lds
Mvaa 72,72,100
Ta 48,26,0
Ta 50,26,2048
Mvaa 88,72,104
Mvaa 104,72,108
Ra 16,20,8192
Mvaa 120,72,112
buffer_load_dwordx4 v9, s[12:15], s53 offen offset:1024 nt lds
Mvaa 136,72,116
s_waitcnt lgkmcnt(6)
Ta 52,27,0
Ta 54,27,2048
Mvaa 152,72,120
Mvaa 168,72,124
Ra 20,20,10240
Mvaa 60,76,96
buffer_load_dwordx4 v8, s[12:15], s54 offen offset:2048 nt lds
Mvaa 76,76,100
Ta 56,28,0
Ta 58,28,2048
Mvaa 92,76,104
Mvaa 108,76,108
Ra 24,20,12288
Mvaa 124,76,112
buffer_load_dwordx4 v9, s[12:15], s55 offen offset:3072 nt lds
Mvaa 140,76,116
s_waitcnt lgkmcnt(6)
Ta 60,29,0
Ta 62,29,2048
Mvaa 156,76,120
v_add_u32 v6, 524288, v6
v_add_u32 v7, 524288, v7
Mvaa 172,76,124
s_add_u32 m0, s56, 0
Ra 28,20,14336
v_add_u32 v8, 524288, v8
Mvaa 176,80,96
buffer_load_dwordx4 v2, s[8:11], s48 offen offset:0 lds
Mvaa 192,80,100
v_add_u32 v9, 524288, v9
Mvaa 208,80,104
Mvaa 224,80,108
Mvaa 240,80,112
buffer_load_dwordx4 v3, s[8:11], s49 offen offset:1024 lds
Maaa 128,80,116
Maaa 144,80,120
Maaa 160,80,124
Mvaa 180,84,96
buffer_load_dwordx4 v2, s[8:11], s50 offen offset:2048 lds
Mvaa 196,84,100
Mvaa 212,84,104
Mvaa 228,84,108
Mvaa 244,84,112
buffer_load_dwordx4 v3, s[8:11], s51 offen offset:3072 lds
Maaa 132,84,116
Maaa 148,84,120
Maaa 164,84,124
s_add_u32 m0, s56, 4096
Mvaa 184,88,96
buffer_load_dwordx4 v4, s[8:11], s48 offen offset:0 lds
Mvaa 200,88,100
Mvaa 216,88,104
Mvaa 232,88,108
Mvaa 248,88,112
buffer_load_dwordx4 v5, s[8:11], s49 offen offset:1024 lds
Maaa 136,88,116
Maaa 152,88,120
Maaa 168,88,124
Mvaa 188,92,96
buffer_load_dwordx4 v4, s[8:11], s50 offen offset:2048 lds
Mvaa 204,92,100
Mvaa 220,92,104
Mvaa 236,92,108
Mvaa 252,92,112
buffer_load_dwordx4 v5, s[8:11], s51 offen offset:3072 lds
Maaa 140,92,116
v_add_u32 v2, 128, v2
v_add_u32 v3, 128, v3
Maaa 156,92,120
buffer_load_dword v1, v47, s[60:63], 0 offen
v_add_u32 v4, 128, v4
v_add_u32 v5, 128, v5
Maaa 172,92,124
v_add_u32 v47, s59, v47
s_waitcnt lgkmcnt(0)
Mvaa 48,0,32
s_getpc_b64 s[6:7]
L_cpf3:
s_add_u32 s6, s6, (L_phase2-L_cpf3)&0xffffffff
s_addc_u32 s7, s7, ((L_phase2-L_cpf3)>>32)&0xffffffff
Mvaa 64,0,36
Ta 96,22,16384
Ta 98,22,18432
Mvaa 80,0,40
s_lshr_b32 s3, s2, 3
s_lshl_b32 s3, s3, 2
s_add_u32 s3, s3, s32
Mvaa 96,0,44
Ra 64,21,0
Mvaa 112,0,48
s_lshl_b32 s3, s3, 10
v_and_b32 v42, 7, v0
v_lshlrev_b32 v42, 7, v42
Mvaa 128,0,52
Ta 100,23,16384
Ta 102,23,18432
Mvaa 144,0,56
v_add_u32 v42, s3, v42
v_min_u32 v42, L_k2_end-L_phase2-4, v42
Mvaa 160,0,60
s_waitcnt lgkmcnt(6)
Ra 68,21,2048
Mvaa 52,4,32
v_mov_b32 v41, s7
Mvaa 68,4,36
Ta 104,24,16384
Ta 106,24,18432
Mvaa 84,4,40
v_add_co_u32 v40, vcc, s6, v42
s_nop 1
v_addc_co_u32 v41, vcc, 0, v41, vcc
Mvaa 100,4,44
Ra 72,21,4096
Mvaa 116,4,48
global_load_dword v44, v[40:41], off
Mvaa 132,4,52
Ta 108,25,16384
Ta 110,25,18432
Mvaa 148,4,56
Mvaa 164,4,60
s_waitcnt lgkmcnt(6)
Ra 76,21,6144
Mvaa 56,8,32
Mvaa 72,8,36
Ta 112,26,16384
Ta 114,26,18432
Mvaa 88,8,40
Mvaa 104,8,44
Ra 80,21,8192
Mvaa 120,8,48
Mvaa 136,8,52
Ta 116,27,16384
Ta 118,27,18432
Mvaa 152,8,56
Mvaa 168,8,60
s_waitcnt lgkmcnt(6)
Ra 84,21,10240
Mvaa 60,12,32
Mvaa 76,12,36
Ta 120,28,16384
Ta 122,28,18432
Mvaa 92,12,40
Mvaa 108,12,44
Ra 88,21,12288
Mvaa 124,12,48
Mvaa 140,12,52
Ta 124,29,16384
Ta 126,29,18432
Mvaa 156,12,56
Mvaa 172,12,60
s_waitcnt lgkmcnt(6)
Ra 92,21,14336
Mvaa 176,16,32
Mvaa 192,16,36
Mvaa 208,16,40
Mvaa 224,16,44
Mvaa 240,16,48
Maaa 128,16,52
Maaa 144,16,56
Maaa 160,16,60
Mvaa 180,20,32
Mvaa 196,20,36
Mvaa 212,20,40
Mvaa 228,20,44
Mvaa 244,20,48
Maaa 132,20,52
Maaa 148,20,56
Maaa 164,20,60
Mvaa 184,24,32
Mvaa 200,24,36
Mvaa 216,24,40
Mvaa 232,24,44
Mvaa 248,24,48
Maaa 136,24,52
Maaa 152,24,56
Maaa 168,24,60
Mvaa 188,28,32
Mvaa 204,28,36
Mvaa 220,28,40
Mvaa 236,28,44
Mvaa 252,28,48
Maaa 140,28,52
Maaa 156,28,56
Maaa 172,28,60
s_waitcnt vmcnt(2) lgkmcnt(0)
s_add_u32 m0, s57, 65536
s_barrier
Mvaa 48,64,96
buffer_load_dwordx4 v6, s[12:15], s52 offen offset:0 nt lds
Mvaa 64,64,100
Ta 32,12,0
Ta 34,12,2048
Mvaa 80,64,104
Mvaa 96,64,108
Ra 0,10,0
Mvaa 112,64,112
buffer_load_dwordx4 v7, s[12:15], s53 offen offset:1024 nt lds
Mvaa 128,64,116
s_waitcnt lgkmcnt(6)
Ta 36,13,0
Ta 38,13,2048
Mvaa 144,64,120
Mvaa 160,64,124
Ra 4,10,2048
Mvaa 52,68,96
buffer_load_dwordx4 v6, s[12:15], s54 offen offset:2048 nt lds
Mvaa 68,68,100
Ta 40,14,0
Ta 42,14,2048
Mvaa 84,68,104
Mvaa 100,68,108
Ra 8,10,4096
Mvaa 116,68,112
buffer_load_dwordx4 v7, s[12:15], s55 offen offset:3072 nt lds
Mvaa 132,68,116
s_waitcnt lgkmcnt(6)
Ta 44,15,0
Ta 46,15,2048
Mvaa 148,68,120
Mvaa 164,68,124
s_add_u32 m0, s57, 69632
Ra 12,10,6144
Mvaa 56,72,96
buffer_load_dwordx4 v8, s[12:15], s52 offen offset:0 nt lds
Mvaa 72,72,100
Ta 48,16,0
Ta 50,16,2048
Mvaa 88,72,104
Mvaa 104,72,108
Ra 16,10,8192
Mvaa 120,72,112
buffer_load_dwordx4 v9, s[12:15], s53 offen offset:1024 nt lds
Mvaa 136,72,116
s_waitcnt lgkmcnt(6)
Ta 52,17,0
Ta 54,17,2048
Mvaa 152,72,120
Mvaa 168,72,124
Ra 20,10,10240
Mvaa 60,76,96
buffer_load_dwordx4 v8, s[12:15], s54 offen offset:2048 nt lds
Mvaa 76,76,100
Ta 56,18,0
Ta 58,18,2048
Mvaa 92,76,104
Mvaa 108,76,108
Ra 24,10,12288
Mvaa 124,76,112
buffer_load_dwordx4 v9, s[12:15], s55 offen offset:3072 nt lds
Mvaa 140,76,116
s_waitcnt lgkmcnt(6)
Ta 60,19,0
Ta 62,19,2048
Mvaa 156,76,120
v_add_u32 v6, 524288, v6
v_add_u32 v7, 524288, v7
Mvaa 172,76,124
s_add_u32 m0, s56, 65536
Ra 28,10,14336
v_add_u32 v8, 524288, v8
Mvaa 176,80,96
buffer_load_dwordx4 v2, s[8:11], s48 offen offset:0 lds
Mvaa 192,80,100
v_add_u32 v9, 524288, v9
Mvaa 208,80,104
Mvaa 224,80,108
Mvaa 240,80,112
buffer_load_dwordx4 v3, s[8:11], s49 offen offset:1024 lds
Maaa 128,80,116
Maaa 144,80,120
Maaa 160,80,124
Mvaa 180,84,96
buffer_load_dwordx4 v2, s[8:11], s50 offen offset:2048 lds
Mvaa 196,84,100
Mvaa 212,84,104
Mvaa 228,84,108
Mvaa 244,84,112
buffer_load_dwordx4 v3, s[8:11], s51 offen offset:3072 lds
Maaa 132,84,116
Maaa 148,84,120
Maaa 164,84,124
s_add_u32 m0, s56, 69632
Mvaa 184,88,96
buffer_load_dwordx4 v4, s[8:11], s48 offen offset:0 lds
Mvaa 200,88,100
Mvaa 216,88,104
Mvaa 232,88,108
Mvaa 248,88,112
buffer_load_dwordx4 v5, s[8:11], s49 offen offset:1024 lds
Maaa 136,88,116
Maaa 152,88,120
Maaa 168,88,124
Mvaa 188,92,96
buffer_load_dwordx4 v4, s[8:11], s50 offen offset:2048 lds
Mvaa 204,92,100
Mvaa 220,92,104
Mvaa 236,92,108
Mvaa 252,92,112
buffer_load_dwordx4 v5, s[8:11], s51 offen offset:3072 lds
Maaa 140,92,116
v_add_u32 v2, 128, v2
v_add_u32 v3, 128, v3
Maaa 156,92,120
v_add_u32 v4, 128, v4
v_add_u32 v5, 128, v5
Maaa 172,92,124
s_waitcnt lgkmcnt(0)
Mvaa 48,0,32
buffer_load_dword v30, v31, s[28:31], s37 offen sc1
Mvaa 64,0,36
Ta 96,12,16384
Ta 98,12,18432
Mvaa 80,0,40
s_mov_b32 s8, s60
s_mov_b32 s9, s61
s_mov_b32 s10, s62
Mvaa 96,0,44
Ra 64,11,0
Mvaa 112,0,48
s_mov_b32 s48, 0
s_mov_b32 s49, 31744
s_mov_b32 s50, 63488
Mvaa 128,0,52
Ta 100,13,16384
Ta 102,13,18432
Mvaa 144,0,56
s_mov_b32 s51, 95232
v_lshlrev_b32 v35, 13, v34
v_lshl_add_u32 v8, v36, 4, v35
Mvaa 160,0,60
s_waitcnt lgkmcnt(6)
Ra 68,11,2048
Mvaa 52,4,32
v_lshl_add_u32 v9, v37, 4, v35
v_lshlrev_b32 v2, 4, v0
Mvaa 68,4,36
Ta 104,14,16384
Ta 106,14,18432
Mvaa 84,4,40
v_add_u32 v3, 65536, v2
v_add_u32 v4, s44, v2
Mvaa 100,4,44
Ra 72,11,4096
Mvaa 116,4,48
v_mov_b32 v7, 0
v_lshlrev_b32 v35, 2, v32
Mvaa 132,4,52
Ta 108,15,16384
Ta 110,15,18432
Mvaa 148,4,56
v_sub_u32 v35, v33, v35
Mvaa 164,4,60
s_waitcnt lgkmcnt(6)
Ra 76,11,6144
Mvaa 56,8,32
s_lshl_b32 s3, s45, 5
v_add_u32 v5, s3, v35
Mvaa 72,8,36
Ta 112,16,16384
Ta 114,16,18432
Mvaa 88,8,40
s_lshl_b32 s3, s46, 5
v_add_u32 v6, s3, v35
Mvaa 104,8,44
Ra 80,11,8192
Mvaa 120,8,48
s_mul_i32 s3, s33, 1116160
s_add_u32 s3, s3, 8388608
s_add_u32 s12, s66, s3
s_addc_u32 s13, s67, 0
s_and_b32 s13, s13, 0xffff
Mvaa 136,8,52
Ta 116,17,16384
Ta 118,17,18432
Mvaa 152,8,56
s_mov_b32 s14, 0
s_mov_b32 s15, 0x20000
s_mul_i32 s14, s36, 34816
Mvaa 168,8,60
s_waitcnt lgkmcnt(6)
Ra 84,11,10240
Mvaa 60,12,32
Mvaa 76,12,36
Ta 120,18,16384
Ta 122,18,18432
Mvaa 92,12,40
Mvaa 108,12,44
Ra 88,11,12288
Mvaa 124,12,48
Mvaa 140,12,52
Ta 124,19,16384
Ta 126,19,18432
Mvaa 156,12,56
Mvaa 172,12,60
s_waitcnt lgkmcnt(6)
Ra 92,11,14336
Mvaa 176,16,32
Mvaa 192,16,36
Mvaa 208,16,40
Mvaa 224,16,44
Mvaa 240,16,48
Maaa 128,16,52
Maaa 144,16,56
Maaa 160,16,60
Mvaa 180,20,32
Mvaa 196,20,36
Mvaa 212,20,40
Mvaa 228,20,44
Mvaa 244,20,48
Maaa 132,20,52
Maaa 148,20,56
Maaa 164,20,60
Mvaa 184,24,32
Mvaa 200,24,36
Mvaa 216,24,40
Mvaa 232,24,44
Mvaa 248,24,48
Maaa 136,24,52
Maaa 152,24,56
Maaa 168,24,60
Mvaa 188,28,32
Mvaa 204,28,36
Mvaa 220,28,40
Mvaa 236,28,44
Mvaa 252,28,48
Maaa 140,28,52
Maaa 156,28,56
Maaa 172,28,60
s_waitcnt vmcnt(1) lgkmcnt(0)
s_add_u32 m0, s44, 0
s_barrier
Mvaa 48,64,96
buffer_load_dwordx4 v8, s[8:11], s48 offen offset:0 lds
Mvaa 64,64,100
Ta 32,22,0
Ta 34,22,2048
Mvaa 80,64,104
s_mul_i32 s3, s45, 67584
v_add_u32 v10, s3, v2
Mvaa 96,64,108
Ra 0,20,0
Mvaa 112,64,112
buffer_load_dwordx4 v8, s[8:11], s49 offen offset:1024 lds
Mvaa 128,64,116
s_waitcnt lgkmcnt(6)
Ta 36,23,0
Ta 38,23,2048
Mvaa 144,64,120
s_mul_i32 s3, s46, 67584
v_add_u32 v11, s3, v2
Mvaa 160,64,124
Ra 4,20,2048
Mvaa 52,68,96
buffer_load_dwordx4 v9, s[8:11], s50 offen offset:2048 lds
Mvaa 68,68,100
Ta 40,24,0
Ta 42,24,2048
Mvaa 84,68,104
Mvaa 100,68,108
Ra 8,20,4096
Mvaa 116,68,112
buffer_load_dwordx4 v9, s[8:11], s51 offen offset:3072 lds
Mvaa 132,68,116
s_waitcnt lgkmcnt(6)
Ta 44,25,0
Ta 46,25,2048
Mvaa 148,68,120
v_add_u32 v8, 524288, v8
v_add_u32 v9, 524288, v9
Mvaa 164,68,124
s_add_u32 m0, s44, 16384
Ra 12,20,6144
Mvaa 56,72,96
buffer_load_dwordx4 v8, s[8:11], s48 offen offset:0 lds
Mvaa 72,72,100
Ta 48,26,0
Ta 50,26,2048
Mvaa 88,72,104
Mvaa 104,72,108
Ra 16,20,8192
Mvaa 120,72,112
buffer_load_dwordx4 v8, s[8:11], s49 offen offset:1024 lds
Mvaa 136,72,116
s_waitcnt lgkmcnt(6)
Ta 52,27,0
Ta 54,27,2048
Mvaa 152,72,120
Mvaa 168,72,124
Ra 20,20,10240
Mvaa 60,76,96
buffer_load_dwordx4 v9, s[8:11], s50 offen offset:2048 lds
Mvaa 76,76,100
Ta 56,28,0
Ta 58,28,2048
Mvaa 92,76,104
Mvaa 108,76,108
Ra 24,20,12288
Mvaa 124,76,112
buffer_load_dwordx4 v9, s[8:11], s51 offen offset:3072 lds
Mvaa 140,76,116
s_waitcnt lgkmcnt(6)
Ta 60,29,0
Ta 62,29,2048
Mvaa 156,76,120
v_add_u32 v8, 524288, v8
v_add_u32 v9, 524288, v9
Mvaa 172,76,124
s_add_u32 m0, s44, 32768
Ra 28,20,14336
Mvaa 176,80,96
buffer_load_dwordx4 v8, s[8:11], s48 offen offset:0 lds
Mvaa 192,80,100
Mvaa 208,80,104
Mvaa 224,80,108
Mvaa 240,80,112
buffer_load_dwordx4 v8, s[8:11], s49 offen offset:1024 lds
Maaa 128,80,116
Maaa 144,80,120
Maaa 160,80,124
Mvaa 180,84,96
buffer_load_dwordx4 v9, s[8:11], s50 offen offset:2048 lds
Mvaa 196,84,100
Mvaa 212,84,104
Mvaa 228,84,108
Mvaa 244,84,112
buffer_load_dwordx4 v9, s[8:11], s51 offen offset:3072 lds
Maaa 132,84,116
v_add_u32 v8, 524288, v8
v_add_u32 v9, 524288, v9
Maaa 148,84,120
Maaa 164,84,124
s_add_u32 m0, s44, 49152
Mvaa 184,88,96
buffer_load_dwordx4 v8, s[8:11], s48 offen offset:0 lds
Mvaa 200,88,100
Mvaa 216,88,104
Mvaa 232,88,108
Mvaa 248,88,112
buffer_load_dwordx4 v8, s[8:11], s49 offen offset:1024 lds
Maaa 136,88,116
Maaa 152,88,120
Maaa 168,88,124
Mvaa 188,92,96
buffer_load_dwordx4 v9, s[8:11], s50 offen offset:2048 lds
Mvaa 204,92,100
Mvaa 220,92,104
Mvaa 236,92,108
Mvaa 252,92,112
buffer_load_dwordx4 v9, s[8:11], s51 offen offset:3072 lds
Maaa 140,92,116
v_add_u32 v8, 524288, v8
v_add_u32 v9, 524288, v9
Maaa 156,92,120
Maaa 172,92,124
s_waitcnt lgkmcnt(0)
Mvaa 48,0,32
Mvaa 64,0,36
Ta 96,22,16384
Ta 98,22,18432
Mvaa 80,0,40
Mvaa 96,0,44
Ra 64,21,0
Mvaa 112,0,48
Mvaa 128,0,52
Ta 100,23,16384
Ta 102,23,18432
Mvaa 144,0,56
Mvaa 160,0,60
s_waitcnt lgkmcnt(6)
Ra 68,21,2048
Mvaa 52,4,32
Mvaa 68,4,36
Ta 104,24,16384
Ta 106,24,18432
Mvaa 84,4,40
Mvaa 100,4,44
Ra 72,21,4096
Mvaa 116,4,48
Mvaa 132,4,52
Ta 108,25,16384
Ta 110,25,18432
Mvaa 148,4,56
Mvaa 164,4,60
s_waitcnt lgkmcnt(6)
Ra 76,21,6144
Mvaa 56,8,32
Mvaa 72,8,36
Ta 112,26,16384
Ta 114,26,18432
Mvaa 88,8,40
Mvaa 104,8,44
Ra 80,21,8192
Mvaa 120,8,48
Mvaa 136,8,52
Ta 116,27,16384
Ta 118,27,18432
Mvaa 152,8,56
Mvaa 168,8,60
s_waitcnt lgkmcnt(6)
Ra 84,21,10240
Mvaa 60,12,32
Mvaa 76,12,36
Ta 120,28,16384
Ta 122,28,18432
Mvaa 92,12,40
Mvaa 108,12,44
Ra 88,21,12288
Mvaa 124,12,48
Mvaa 140,12,52
Ta 124,29,16384
Ta 126,29,18432
Mvaa 156,12,56
Mvaa 172,12,60
s_waitcnt lgkmcnt(6)
Ra 92,21,14336
Mvaa 176,16,32
Mvaa 192,16,36
Mvaa 208,16,40
Mvaa 224,16,44
Mvaa 240,16,48
Maaa 128,16,52
Maaa 144,16,56
Maaa 160,16,60
Mvaa 180,20,32
Mvaa 196,20,36
Mvaa 212,20,40
Mvaa 228,20,44
Mvaa 244,20,48
Maaa 132,20,52
Maaa 148,20,56
Maaa 164,20,60
Mvaa 184,24,32
Mvaa 200,24,36
Mvaa 216,24,40
Mvaa 232,24,44
Mvaa 248,24,48
Maaa 136,24,52
Maaa 152,24,56
Maaa 168,24,60
Mvaa 188,28,32
Mvaa 204,28,36
Mvaa 220,28,40
Mvaa 236,28,44
Mvaa 252,28,48
Maaa 140,28,52
Maaa 156,28,56
Maaa 172,28,60
s_waitcnt vmcnt(12) lgkmcnt(0)
v_readfirstlane_b32 s3, v30
s_nop 0
s_or_b32 s3, s3, s37
s_cmp_lt_u32 s3, 256
s_cbranch_scc1 L_spinAv
L_spinArv:
s_barrier
Mvaa 48,64,96
buffer_load_dwordx4 a[0:3], v10, s[20:23], 0 offen offset:0 sc1
Mvaa 52,68,96
v_lshrrev_b32 v42, 2, v33
v_lshl_add_u32 v43, v32, 3, v42
Mvaa 56,72,96
v_lshlrev_b32 v43, 8, v43
v_and_b32 v44, 3, v0
Mvaa 60,76,96
v_lshl_add_u32 v43, v44, 3, v43
v_and_b32 v44, 1, v32
Mvaa 64,64,100
buffer_load_dwordx4 a[4:7], v10, s[20:23], s58 offen offset:0 sc1
Mvaa 68,68,100
v_lshl_add_u32 v42, v44, 2, v42
v_xor_b32 v44, 0, v42
Mvaa 72,72,100
v_lshl_add_u32 v16, v44, 5, v43
v_xor_b32 v44, 1, v42
Mvaa 76,76,100
v_lshl_add_u32 v17, v44, 5, v43
v_xor_b32 v44, 2, v42
Mvaa 80,64,104
buffer_load_dwordx4 a[8:11], v11, s[20:23], 0 offen offset:0 sc1
Mvaa 84,68,104
v_lshl_add_u32 v18, v44, 5, v43
v_xor_b32 v44, 3, v42
Mvaa 88,72,104
v_lshl_add_u32 v19, v44, 5, v43
v_xor_b32 v44, 4, v42
Mvaa 92,76,104
v_lshl_add_u32 v20, v44, 5, v43
v_xor_b32 v44, 5, v42
Mvaa 96,64,108
buffer_load_dwordx4 a[12:15], v11, s[20:23], s58 offen offset:0 sc1
Mvaa 100,68,108
v_lshl_add_u32 v21, v44, 5, v43
v_xor_b32 v44, 6, v42
Mvaa 104,72,108
v_lshl_add_u32 v22, v44, 5, v43
v_xor_b32 v44, 7, v42
Mvaa 108,76,108
v_lshl_add_u32 v23, v44, 5, v43
Mvaa 112,64,112
buffer_load_dwordx4 a[16:19], v10, s[20:23], 0 offen offset:1024 sc1
Mvaa 116,68,112
Mvaa 120,72,112
Mvaa 124,76,112
Mvaa 128,64,116
buffer_load_dwordx4 a[20:23], v10, s[20:23], s58 offen offset:1024 sc1
Mvaa 132,68,116
Ta 192,16,0
Ta 194,16,1024
Mvaa 136,72,116
Ta 196,17,0
Ta 198,17,1024
Mvaa 140,76,116
Ta 200,18,0
Ta 202,18,1024
Mvaa 144,64,120
buffer_load_dwordx4 a[24:27], v11, s[20:23], 0 offen offset:1024 sc1
Mvaa 148,68,120
Ta 204,19,0
Ta 206,19,1024
Mvaa 152,72,120
Ta 208,20,0
Ta 210,20,1024
Mvaa 156,76,120
Ta 212,21,0
Ta 214,21,1024
Mvaa 160,64,124
buffer_load_dwordx4 a[28:31], v11, s[20:23], s58 offen offset:1024 sc1
Mvaa 164,68,124
Ta 216,22,0
Ta 218,22,1024
Mvaa 168,72,124
Ta 220,23,0
s_waitcnt lgkmcnt(9)
Ta 222,23,1024
Mvaa 172,76,124
s_waitcnt lgkmcnt(8)
Vc 24,48,49
Vc 25,50,51
Mvaa 176,80,96
buffer_load_dwordx4 a[32:35], v10, s[20:23], 0 offen offset:2048 sc1
Mvaa 180,84,96
Vc 26,52,53
Vc 27,54,55
Mvaa 184,88,96
Vc 28,56,57
Vc 29,58,59
Mvaa 188,92,96
Vc 30,60,61
Vc 31,62,63
Mvaa 192,80,100
buffer_load_dwordx4 a[36:39], v10, s[20:23], s58 offen offset:2048 sc1
Mvaa 196,84,100
Vc 32,64,65
Vc 33,66,67
Mvaa 200,88,100
Vc 34,68,69
Vc 35,70,71
Mvaa 204,92,100
Vc 36,72,73
Vc 37,74,75
Mvaa 208,80,104
buffer_load_dwordx4 a[40:43], v11, s[20:23], 0 offen offset:2048 sc1
Mvaa 212,84,104
Vc 38,76,77
Vc 39,78,79
Mvaa 216,88,104
Vc 40,80,81
Vc 41,82,83
Mvaa 220,92,104
Vc 42,84,85
Vc 43,86,87
Mvaa 224,80,108
buffer_load_dwordx4 a[44:47], v11, s[20:23], s58 offen offset:2048 sc1
Mvaa 228,84,108
Vc 44,88,89
Vc 45,90,91
Mvaa 232,88,108
Vc 46,92,93
Vc 47,94,95
Mvaa 236,92,108
Vc 48,96,97
Vc 49,98,99
Mvaa 240,80,112
buffer_load_dwordx4 a[48:51], v10, s[20:23], 0 offen offset:3072 sc1
Mvaa 244,84,112
Vc 50,100,101
Vc 51,102,103
Mvaa 248,88,112
Vc 52,104,105
Vc 53,106,107
Mvaa 252,92,112
Vc 54,108,109
Vc 55,110,111
Maaa 128,80,116
buffer_load_dwordx4 a[52:55], v10, s[20:23], s58 offen offset:3072 sc1
Maaa 132,84,116
Vc 56,112,113
Vc 57,114,115
Maaa 136,88,116
Vc 58,116,117
Vc 59,118,119
Maaa 140,92,116
Vc 60,120,121
Vc 61,122,123
Maaa 144,80,120
buffer_load_dwordx4 a[56:59], v11, s[20:23], 0 offen offset:3072 sc1
Maaa 148,84,120
Vc 62,124,125
Vc 63,126,127
Maaa 152,88,120
Vc 64,128,129
Vc 65,130,131
Maaa 156,92,120
Vc 66,132,133
Vc 67,134,135
Maaa 160,80,124
buffer_load_dwordx4 a[60:63], v11, s[20:23], s58 offen offset:3072 sc1
Maaa 164,84,124
v_add_u32 v10, 4096, v10
v_add_u32 v11, 4096, v11
Maaa 168,88,124
Vc 68,136,137
Vc 69,138,139
Maaa 172,92,124
Vc 70,140,141
Vc 71,142,143
Vc 72,144,145
Vc 73,146,147
Vc 74,148,149
Vc 75,150,151
Vc 76,152,153
Vc 77,154,155
Vc 78,156,157
Vc 79,158,159
Vc 80,160,161
Vc 81,162,163
Vc 82,164,165
Vc 83,166,167
Vc 84,168,169
Vc 85,170,171
Vc 86,172,173
Vc 87,174,175
Vc 88,176,177
Vc 89,178,179
Vc 90,180,181
Vc 91,182,183
Vc 92,184,185
Vc 93,186,187
Vc 94,188,189
Vc 95,190,191
Vc 96,192,193
Vc 97,194,195
Vc 98,196,197
Vc 99,198,199
Vc 100,200,201
Vc 101,202,203
Vc 102,204,205
Vc 103,206,207
Vc 104,208,209
Vc 105,210,211
Vc 106,212,213
Vc 107,214,215
Vc 108,216,217
Vc 109,218,219
Vc 110,220,221
Vc 111,222,223
Vc 112,224,225
Vc 113,226,227
Vc 114,228,229
Vc 115,230,231
Vc 116,232,233
Vc 117,234,235
Vc 118,236,237
Vc 119,238,239
Vc 120,240,241
Vc 121,242,243
Vc 122,244,245
Vc 123,246,247
Vc 124,248,249
Vc 125,250,251
Vc 126,252,253
Vc 127,254,255
L_phase2:
s_nop 7
s_waitcnt vmcnt(12) lgkmcnt(0)
Zvaa 128,192,0
s_add_u32 s37, s38, 0
Zvaa 132,192,4
Ta 224,16,8192
Ta 226,16,9216
Zvaa 136,192,8
buffer_load_dwordx4 a[64:67], v10, s[20:23], 0 offen offset:0 sc1
Zvaa 140,192,12
buffer_store_dwordx4 v[24:27], v2, s[24:27], s37 offen offset:0 sc1
Zvaa 144,196,0
Ta 228,17,8192
Ta 230,17,9216
Zvaa 148,196,4
buffer_load_dwordx4 a[68:71], v10, s[20:23], s58 offen offset:0 sc1
Zvaa 152,196,8
s_mov_b32 s60, s40
s_and_b32 s61, s41, 0xffff
s_mov_b32 s62, 7340032
Zvaa 156,196,12
Ta 232,18,8192
Ta 234,18,9216
Zvaa 160,200,0
s_mov_b32 s63, 0x20000
Zvaa 164,200,4
buffer_load_dwordx4 a[72:75], v11, s[20:23], 0 offen offset:0 sc1
Zvaa 168,200,8
Ta 236,19,8192
Ta 238,19,9216
Zvaa 172,200,12
Zvaa 176,204,0
Zvaa 180,204,4
Ta 240,20,8192
Ta 242,20,9216
Zvaa 184,204,8
buffer_load_dwordx4 a[76:79], v11, s[20:23], s58 offen offset:0 sc1
Zvaa 188,204,12
Zvaa 192,208,0
s_waitcnt lgkmcnt(6)
Ta 244,21,8192
Ta 246,21,9216
Zvaa 196,208,4
buffer_store_dwordx4 v[28:31], v2, s[24:27], s37 offen offset:1024 sc1
Zvaa 200,208,8
buffer_load_dwordx4 a[80:83], v10, s[20:23], 0 offen offset:1024 sc1
Zvaa 204,208,12
Ta 248,22,8192
Ta 250,22,9216
Zvaa 208,212,0
Zvaa 212,212,4
Zvaa 216,212,8
Ta 252,23,8192
Ta 254,23,9216
Zvaa 220,212,12
buffer_load_dwordx4 a[84:87], v10, s[20:23], s58 offen offset:1024 sc1
Zvaa 224,216,0
Zvaa 228,216,4
Zvaa 232,216,8
buffer_load_dwordx4 a[88:91], v11, s[20:23], 0 offen offset:1024 sc1
Zvaa 236,216,12
Zvaa 240,220,0
Zvaa 244,220,4
buffer_load_dwordx4 a[92:95], v11, s[20:23], s58 offen offset:1024 sc1
Zvaa 248,220,8
Zvaa 252,220,12
s_waitcnt vmcnt(18) lgkmcnt(0)
s_barrier
Mvaa 128,224,16
buffer_store_dwordx4 v[32:35], v2, s[24:27], s37 offen offset:2048 sc1
Mvaa 132,224,20
s_add_u32 m0, s44, 0
Ta 192,16,16384
Ta 194,16,17408
Mvaa 136,224,24
buffer_load_dwordx4 v8, s[8:11], s48 offen offset:0 lds
Mvaa 140,224,28
buffer_load_dwordx4 v8, s[8:11], s49 offen offset:1024 lds
Mvaa 144,228,16
Ta 196,17,16384
Ta 198,17,17408
Mvaa 148,228,20
Mvaa 152,228,24
buffer_load_dwordx4 v9, s[8:11], s50 offen offset:2048 lds
Mvaa 156,228,28
Ta 200,18,16384
Ta 202,18,17408
Mvaa 160,232,16
Mvaa 164,232,20
buffer_load_dwordx4 v9, s[8:11], s51 offen offset:3072 lds
v_add_u32 v8, 524288, v8
v_add_u32 v9, 524288, v9
Mvaa 168,232,24
Ta 204,19,16384
Ta 206,19,17408
Mvaa 172,232,28
Mvaa 176,236,16
buffer_load_dwordx4 a[96:99], v10, s[20:23], 0 offen offset:2048 sc1
Mvaa 180,236,20
Ta 208,20,16384
Ta 210,20,17408
Mvaa 184,236,24
Mvaa 188,236,28
buffer_load_dwordx4 a[100:103], v10, s[20:23], s58 offen offset:2048 sc1
Mvaa 192,240,16
s_waitcnt lgkmcnt(6)
Ta 212,21,16384
Ta 214,21,17408
Mvaa 196,240,20
buffer_store_dwordx4 v[36:39], v2, s[24:27], s37 offen offset:3072 sc1
Mvaa 200,240,24
buffer_load_dwordx4 a[104:107], v11, s[20:23], 0 offen offset:2048 sc1
Mvaa 204,240,28
Ta 216,22,16384
Ta 218,22,17408
Mvaa 208,244,16
Mvaa 212,244,20
buffer_load_dwordx4 a[108:111], v11, s[20:23], s58 offen offset:2048 sc1
Mvaa 216,244,24
Ta 220,23,16384
Ta 222,23,17408
Mvaa 220,244,28
Mvaa 224,248,16
buffer_load_dwordx4 a[112:115], v10, s[20:23], 0 offen offset:3072 sc1
Mvaa 228,248,20
Mvaa 232,248,24
buffer_load_dwordx4 a[116:119], v10, s[20:23], s58 offen offset:3072 sc1
Mvaa 236,248,28
Mvaa 240,252,16
buffer_load_dwordx4 a[120:123], v11, s[20:23], 0 offen offset:3072 sc1
Mvaa 244,252,20
Mvaa 248,252,24
buffer_load_dwordx4 a[124:127], v11, s[20:23], s58 offen offset:3072 sc1
v_add_u32 v10, 4096, v10
v_add_u32 v11, 4096, v11
Mvaa 252,252,28
s_waitcnt vmcnt(28) lgkmcnt(0)
Mvaa 128,192,32
s_add_u32 s37, s38, 4096
Mvaa 132,192,36
Ta 224,16,24576
Ta 226,16,25600
Mvaa 136,192,40
buffer_load_dwordx4 a[0:3], v10, s[20:23], 0 offen offset:0 sc1
Mvaa 140,192,44
buffer_store_dwordx4 v[40:43], v2, s[24:27], s37 offen offset:0 sc1
Mvaa 144,196,32
Ta 228,17,24576
Ta 230,17,25600
Mvaa 148,196,36
buffer_load_dwordx4 a[4:7], v10, s[20:23], s58 offen offset:0 sc1
Mvaa 152,196,40
Mvaa 156,196,44
Ta 232,18,24576
Ta 234,18,25600
Mvaa 160,200,32
Mvaa 164,200,36
buffer_load_dwordx4 a[8:11], v11, s[20:23], 0 offen offset:0 sc1
Mvaa 168,200,40
Ta 236,19,24576
Ta 238,19,25600
Mvaa 172,200,44
Mvaa 176,204,32
Mvaa 180,204,36
Ta 240,20,24576
Ta 242,20,25600
Mvaa 184,204,40
buffer_load_dwordx4 a[12:15], v11, s[20:23], s58 offen offset:0 sc1
Mvaa 188,204,44
Mvaa 192,208,32
s_waitcnt lgkmcnt(6)
Ta 244,21,24576
Ta 246,21,25600
Mvaa 196,208,36
buffer_store_dwordx4 v[44:47], v2, s[24:27], s37 offen offset:1024 sc1
Mvaa 200,208,40
buffer_load_dwordx4 a[16:19], v10, s[20:23], 0 offen offset:1024 sc1
Mvaa 204,208,44
Ta 248,22,24576
Ta 250,22,25600
Mvaa 208,212,32
Mvaa 212,212,36
Mvaa 216,212,40
Ta 252,23,24576
Ta 254,23,25600
Mvaa 220,212,44
buffer_load_dwordx4 a[20:23], v10, s[20:23], s58 offen offset:1024 sc1
Mvaa 224,216,32
Mvaa 228,216,36
Mvaa 232,216,40
buffer_load_dwordx4 a[24:27], v11, s[20:23], 0 offen offset:1024 sc1
Mvaa 236,216,44
Mvaa 240,220,32
Mvaa 244,220,36
buffer_load_dwordx4 a[28:31], v11, s[20:23], s58 offen offset:1024 sc1
Mvaa 248,220,40
Mvaa 252,220,44
s_waitcnt vmcnt(34) lgkmcnt(0)
s_barrier
Mvaa 128,224,48
buffer_store_dwordx4 v[48:51], v2, s[24:27], s37 offen offset:2048 sc1
Mvaa 132,224,52
s_add_u32 m0, s44, 16384
Ta 192,16,32768
Ta 194,16,33792
Mvaa 136,224,56
buffer_load_dwordx4 v8, s[8:11], s48 offen offset:0 lds
Mvaa 140,224,60
Mvaa 144,228,48
Ta 196,17,32768
Ta 198,17,33792
Mvaa 148,228,52
buffer_load_dwordx4 v8, s[8:11], s49 offen offset:1024 lds
Mvaa 152,228,56
Mvaa 156,228,60
Ta 200,18,32768
Ta 202,18,33792
Mvaa 160,232,48
Mvaa 164,232,52
buffer_load_dwordx4 v9, s[8:11], s50 offen offset:2048 lds
Mvaa 168,232,56
Ta 204,19,32768
Ta 206,19,33792
Mvaa 172,232,60
Mvaa 176,236,48
Mvaa 180,236,52
Ta 208,20,32768
Ta 210,20,33792
Mvaa 184,236,56
buffer_load_dwordx4 v9, s[8:11], s51 offen offset:3072 lds
v_add_u32 v8, 524288, v8
v_add_u32 v9, 524288, v9
Mvaa 188,236,60
Mvaa 192,240,48
s_waitcnt lgkmcnt(6)
Ta 212,21,32768
Ta 214,21,33792
Mvaa 196,240,52
buffer_store_dwordx4 v[52:55], v2, s[24:27], s37 offen offset:3072 sc1
Mvaa 200,240,56
buffer_load_dwordx4 a[32:35], v10, s[20:23], 0 offen offset:2048 sc1
Mvaa 204,240,60
Ta 216,22,32768
Ta 218,22,33792
Mvaa 208,244,48
Mvaa 212,244,52
Mvaa 216,244,56
Ta 220,23,32768
Ta 222,23,33792
Mvaa 220,244,60
buffer_load_dwordx4 a[36:39], v10, s[20:23], s58 offen offset:2048 sc1
Mvaa 224,248,48
Mvaa 228,248,52
Mvaa 232,248,56
buffer_load_dwordx4 a[40:43], v11, s[20:23], 0 offen offset:2048 sc1
Mvaa 236,248,60
Mvaa 240,252,48
Mvaa 244,252,52
buffer_load_dwordx4 a[44:47], v11, s[20:23], s58 offen offset:2048 sc1
Mvaa 248,252,56
Mvaa 252,252,60
s_waitcnt vmcnt(39) lgkmcnt(0)
Mvaa 128,192,64
s_add_u32 s37, s38, 8192
Mvaa 132,192,68
Ta 224,16,40960
Ta 226,16,41984
Mvaa 136,192,72
buffer_load_dwordx4 a[48:51], v10, s[20:23], 0 offen offset:3072 sc1
Mvaa 140,192,76
buffer_store_dwordx4 v[56:59], v2, s[24:27], s37 offen offset:0 sc1
Mvaa 144,196,64
Ta 228,17,40960
Ta 230,17,41984
Mvaa 148,196,68
Ar 48,128
Ar 49,129
Mvaa 152,196,72
Ar 50,130
Ar 51,131
Mvaa 156,196,76
Ta 232,18,40960
Ta 234,18,41984
Mvaa 160,200,64
Ar 52,132
Ar 53,133
Mvaa 164,200,68
buffer_load_dwordx4 a[52:55], v10, s[20:23], s58 offen offset:3072 sc1
Mvaa 168,200,72
Ta 236,19,40960
Ta 238,19,41984
Mvaa 172,200,76
Ar 54,134
Ar 55,135
Mvaa 176,204,64
Vc 24,48,49
Vc 25,50,51
Mvaa 180,204,68
Ta 240,20,40960
Ta 242,20,41984
Mvaa 184,204,72
Vc 26,52,53
Vc 27,54,55
Mvaa 188,204,76
Mvaa 192,208,64
s_waitcnt lgkmcnt(6)
Ta 244,21,40960
Ta 246,21,41984
Mvaa 196,208,68
buffer_store_dwordx4 v[60:63], v2, s[24:27], s37 offen offset:1024 sc1
Mvaa 200,208,72
buffer_load_dwordx4 a[56:59], v11, s[20:23], 0 offen offset:3072 sc1
Mvaa 204,208,76
Ta 248,22,40960
Ta 250,22,41984
Mvaa 208,212,64
Ar 48,136
Ar 49,137
Mvaa 212,212,68
Ar 50,138
Ar 51,139
Mvaa 216,212,72
Ta 252,23,40960
Ta 254,23,41984
Mvaa 220,212,76
Ar 52,140
Ar 53,141
Mvaa 224,216,64
Ar 54,142
Ar 55,143
Mvaa 228,216,68
Vc 28,48,49
Vc 29,50,51
Mvaa 232,216,72
buffer_load_dwordx4 a[60:63], v11, s[20:23], s58 offen offset:3072 sc1
v_add_u32 v10, 4096, v10
v_add_u32 v11, 4096, v11
Mvaa 236,216,76
Vc 30,52,53
Vc 31,54,55
Mvaa 240,220,64
Mvaa 244,220,68
Mvaa 248,220,72
Mvaa 252,220,76
s_waitcnt vmcnt(40) lgkmcnt(0)
s_barrier
Mvaa 128,224,80
buffer_store_dwordx4 v[64:67], v2, s[24:27], s37 offen offset:2048 sc1
Mvaa 132,224,84
s_add_u32 m0, s44, 32768
Ta 192,16,49152
Ta 194,16,50176
Mvaa 136,224,88
buffer_load_dwordx4 v8, s[8:11], s48 offen offset:0 lds
Mvaa 140,224,92
Ar 48,144
Ar 49,145
Mvaa 144,228,80
Ta 196,17,49152
Ta 198,17,50176
Mvaa 148,228,84
buffer_load_dwordx4 v8, s[8:11], s49 offen offset:1024 lds
Mvaa 152,228,88
Ar 50,146
Ar 51,147
Mvaa 156,228,92
Ta 200,18,49152
Ta 202,18,50176
Mvaa 160,232,80
Ar 52,148
Ar 53,149
Mvaa 164,232,84
buffer_load_dwordx4 v9, s[8:11], s50 offen offset:2048 lds
Mvaa 168,232,88
Ta 204,19,49152
Ta 206,19,50176
Mvaa 172,232,92
Ar 54,150
Ar 55,151
Mvaa 176,236,80
Vc 32,48,49
Vc 33,50,51
Mvaa 180,236,84
Ta 208,20,49152
Ta 210,20,50176
Mvaa 184,236,88
buffer_load_dwordx4 v9, s[8:11], s51 offen offset:3072 lds
v_add_u32 v8, 524288, v8
v_add_u32 v9, 524288, v9
Mvaa 188,236,92
Vc 34,52,53
Vc 35,54,55
Mvaa 192,240,80
s_waitcnt lgkmcnt(6)
Ta 212,21,49152
Ta 214,21,50176
Mvaa 196,240,84
buffer_store_dwordx4 v[68:71], v2, s[24:27], s37 offen offset:3072 sc1
Mvaa 200,240,88
buffer_load_dwordx4 a[64:67], v10, s[20:23], 0 offen offset:0 sc1
Mvaa 204,240,92
Ta 216,22,49152
Ta 218,22,50176
Mvaa 208,244,80
Ar 48,152
Ar 49,153
Mvaa 212,244,84
Ar 50,154
Ar 51,155
Mvaa 216,244,88
Ta 220,23,49152
Ta 222,23,50176
Mvaa 220,244,92
buffer_load_dwordx4 a[68:71], v10, s[20:23], s58 offen offset:0 sc1
Mvaa 224,248,80
Ar 52,156
Ar 53,157
Mvaa 228,248,84
Ar 54,158
Ar 55,159
Mvaa 232,248,88
buffer_load_dwordx4 a[72:75], v11, s[20:23], 0 offen offset:0 sc1
Mvaa 236,248,92
Vc 36,48,49
Vc 37,50,51
Mvaa 240,252,80
Vc 38,52,53
Vc 39,54,55
Mvaa 244,252,84
buffer_load_dwordx4 a[76:79], v11, s[20:23], s58 offen offset:0 sc1
Mvaa 248,252,88
Mvaa 252,252,92
s_waitcnt vmcnt(40) lgkmcnt(0)
Mvaa 128,192,96
s_add_u32 s37, s38, 12288
Mvaa 132,192,100
Ta 224,16,57344
Ta 226,16,58368
Mvaa 136,192,104
buffer_load_dwordx4 a[80:83], v10, s[20:23], 0 offen offset:1024 sc1
Mvaa 140,192,108
buffer_store_dwordx4 v[72:75], v2, s[24:27], s37 offen offset:0 sc1
Mvaa 144,196,96
Ta 228,17,57344
Ta 230,17,58368
Mvaa 148,196,100
Ar 48,160
Ar 49,161
Mvaa 152,196,104
Ar 50,162
Ar 51,163
Mvaa 156,196,108
Ta 232,18,57344
Ta 234,18,58368
Mvaa 160,200,96
Ar 52,164
Ar 53,165
Mvaa 164,200,100
buffer_load_dwordx4 a[84:87], v10, s[20:23], s58 offen offset:1024 sc1
Mvaa 168,200,104
Ta 236,19,57344
Ta 238,19,58368
Mvaa 172,200,108
Ar 54,166
Ar 55,167
Mvaa 176,204,96
Vc 40,48,49
Vc 41,50,51
Mvaa 180,204,100
Ta 240,20,57344
Ta 242,20,58368
Mvaa 184,204,104
Vc 42,52,53
Vc 43,54,55
Mvaa 188,204,108
Mvaa 192,208,96
s_waitcnt lgkmcnt(6)
Ta 244,21,57344
Ta 246,21,58368
Mvaa 196,208,100
buffer_store_dwordx4 v[76:79], v2, s[24:27], s37 offen offset:1024 sc1
Mvaa 200,208,104
buffer_load_dwordx4 a[88:91], v11, s[20:23], 0 offen offset:1024 sc1
Mvaa 204,208,108
Ta 248,22,57344
Ta 250,22,58368
Mvaa 208,212,96
Ar 48,168
Ar 49,169
Mvaa 212,212,100
Ar 50,170
Ar 51,171
Mvaa 216,212,104
Ta 252,23,57344
Ta 254,23,58368
Mvaa 220,212,108
Ar 52,172
Ar 53,173
Mvaa 224,216,96
Ar 54,174
Ar 55,175
Mvaa 228,216,100
Vc 44,48,49
Vc 45,50,51
Mvaa 232,216,104
buffer_load_dwordx4 a[92:95], v11, s[20:23], s58 offen offset:1024 sc1
Mvaa 236,216,108
Vc 46,52,53
Vc 47,54,55
Mvaa 240,220,96
Mvaa 244,220,100
Mvaa 248,220,104
Mvaa 252,220,108
s_waitcnt vmcnt(42) lgkmcnt(0)
s_barrier
Mvaa 128,224,112
buffer_store_dwordx4 v[80:83], v2, s[24:27], s37 offen offset:2048 sc1
Mvaa 132,224,116
s_add_u32 m0, s44, 49152
Ta 192,16,0
Ta 194,16,1024
Mvaa 136,224,120
buffer_load_dwordx4 v8, s[8:11], s48 offen offset:0 lds
Mvaa 140,224,124
Mvaa 144,228,112
Ta 196,17,0
Ta 198,17,1024
Mvaa 148,228,116
buffer_load_dwordx4 v8, s[8:11], s49 offen offset:1024 lds
Mvaa 152,228,120
Mvaa 156,228,124
Ta 200,18,0
Ta 202,18,1024
Mvaa 160,232,112
Mvaa 164,232,116
buffer_load_dwordx4 v9, s[8:11], s50 offen offset:2048 lds
Mvaa 168,232,120
Ta 204,19,0
Ta 206,19,1024
Mvaa 172,232,124
Mvaa 176,236,112
Mvaa 180,236,116
Ta 208,20,0
Ta 210,20,1024
Mvaa 184,236,120
buffer_load_dwordx4 v9, s[8:11], s51 offen offset:3072 lds
v_add_u32 v8, 524288, v8
v_add_u32 v9, 524288, v9
Mvaa 188,236,124
Mvaa 192,240,112
s_waitcnt lgkmcnt(6)
Ta 212,21,0
Ta 214,21,1024
Mvaa 196,240,116
buffer_store_dwordx4 v[84:87], v2, s[24:27], s37 offen offset:3072 sc1
Mvaa 200,240,120
buffer_load_dwordx4 a[96:99], v10, s[20:23], 0 offen offset:2048 sc1
Mvaa 204,240,124
Ta 216,22,0
Ta 218,22,1024
Mvaa 208,244,112
Mvaa 212,244,116
Mvaa 216,244,120
Ta 220,23,0
Ta 222,23,1024
Mvaa 220,244,124
buffer_load_dwordx4 a[100:103], v10, s[20:23], s58 offen offset:2048 sc1
Mvaa 224,248,112
Mvaa 228,248,116
Mvaa 232,248,120
buffer_load_dwordx4 a[104:107], v11, s[20:23], 0 offen offset:2048 sc1
Mvaa 236,248,124
Mvaa 240,252,112
Mvaa 244,252,116
buffer_load_dwordx4 a[108:111], v11, s[20:23], s58 offen offset:2048 sc1
Mvaa 248,252,120
Mvaa 252,252,124
s_waitcnt vmcnt(47) lgkmcnt(0)
Mvaa 128,192,0
s_add_u32 s37, s38, 34816
Mvaa 132,192,4
Ta 224,16,8192
Ta 226,16,9216
Mvaa 136,192,8
buffer_load_dwordx4 a[112:115], v10, s[20:23], 0 offen offset:3072 sc1
Mvaa 140,192,12
buffer_store_dwordx4 v[88:91], v2, s[24:27], s37 offen offset:0 sc1
Mvaa 144,196,0
Ta 228,17,8192
Ta 230,17,9216
Mvaa 148,196,4
Mvaa 152,196,8
Mvaa 156,196,12
Ta 232,18,8192
Ta 234,18,9216
Mvaa 160,200,0
Mvaa 164,200,4
buffer_load_dwordx4 a[116:119], v10, s[20:23], s58 offen offset:3072 sc1
Mvaa 168,200,8
Ta 236,19,8192
Ta 238,19,9216
Mvaa 172,200,12
Mvaa 176,204,0
Mvaa 180,204,4
Ta 240,20,8192
Ta 242,20,9216
Mvaa 184,204,8
Mvaa 188,204,12
Mvaa 192,208,0
s_waitcnt lgkmcnt(6)
Ta 244,21,8192
Ta 246,21,9216
Mvaa 196,208,4
buffer_store_dwordx4 v[92:95], v2, s[24:27], s37 offen offset:1024 sc1
Mvaa 200,208,8
buffer_load_dwordx4 a[120:123], v11, s[20:23], 0 offen offset:3072 sc1
Mvaa 204,208,12
Ta 248,22,8192
Ta 250,22,9216
Mvaa 208,212,0
s_mov_b32 s3, 5242880
s_mov_b32 s47, 5246976
Mvaa 212,212,4
buffer_load_dwordx4 v[56:59], v2, s[20:23], s3 offen offset:0 sc1
Mvaa 216,212,8
Ta 252,23,8192
Ta 254,23,9216
Mvaa 220,212,12
buffer_load_dwordx4 v[60:63], v2, s[20:23], s3 offen offset:1024 sc1
Mvaa 224,216,0
buffer_load_dwordx4 v[64:67], v2, s[20:23], s3 offen offset:2048 sc1
Mvaa 228,216,4
buffer_load_dwordx4 v[68:71], v2, s[20:23], s3 offen offset:3072 sc1
Mvaa 232,216,8
buffer_load_dwordx4 a[124:127], v11, s[20:23], s58 offen offset:3072 sc1
v_add_u32 v10, 4096, v10
v_add_u32 v11, 4096, v11
Mvaa 236,216,12
buffer_load_dwordx4 v[72:75], v2, s[20:23], s47 offen offset:0 sc1
Mvaa 240,220,0
buffer_load_dwordx4 v[76:79], v2, s[20:23], s47 offen offset:1024 sc1
Mvaa 244,220,4
buffer_load_dwordx4 v[80:83], v2, s[20:23], s47 offen offset:2048 sc1
Mvaa 248,220,8
buffer_load_dwordx4 v[84:87], v2, s[20:23], s47 offen offset:3072 sc1
Mvaa 252,220,12
s_waitcnt vmcnt(51) lgkmcnt(0)
s_barrier
Mvaa 128,224,16
buffer_store_dwordx4 v[96:99], v2, s[24:27], s37 offen offset:2048 sc1
Mvaa 132,224,20
s_add_u32 m0, s44, 0
Ta 192,16,16384
Ta 194,16,17408
Mvaa 136,224,24
buffer_load_dwordx4 v8, s[8:11], s48 offen offset:0 lds
Mvaa 140,224,28
Mvaa 144,228,16
Ta 196,17,16384
Ta 198,17,17408
Mvaa 148,228,20
buffer_load_dwordx4 v8, s[8:11], s49 offen offset:1024 lds
Mvaa 152,228,24
Mvaa 156,228,28
Ta 200,18,16384
Ta 202,18,17408
Mvaa 160,232,16
Mvaa 164,232,20
buffer_load_dwordx4 v9, s[8:11], s50 offen offset:2048 lds
Mvaa 168,232,24
Ta 204,19,16384
Ta 206,19,17408
Mvaa 172,232,28
Mvaa 176,236,16
Mvaa 180,236,20
Ta 208,20,16384
Ta 210,20,17408
Mvaa 184,236,24
buffer_load_dwordx4 v9, s[8:11], s51 offen offset:3072 lds
v_add_u32 v8, 524288, v8
v_add_u32 v9, 524288, v9
Mvaa 188,236,28
Mvaa 192,240,16
s_waitcnt lgkmcnt(6)
Ta 212,21,16384
Ta 214,21,17408
Mvaa 196,240,20
buffer_store_dwordx4 v[100:103], v2, s[24:27], s37 offen offset:3072 sc1
Mvaa 200,240,24
buffer_load_dwordx4 a[0:3], v10, s[20:23], 0 offen offset:0 sc1
Mvaa 204,240,28
Ta 216,22,16384
Ta 218,22,17408
Mvaa 208,244,16
Mvaa 212,244,20
Mvaa 216,244,24
Ta 220,23,16384
Ta 222,23,17408
Mvaa 220,244,28
buffer_load_dwordx4 a[4:7], v10, s[20:23], s58 offen offset:0 sc1
Mvaa 224,248,16
Mvaa 228,248,20
Mvaa 232,248,24
buffer_load_dwordx4 a[8:11], v11, s[20:23], 0 offen offset:0 sc1
Mvaa 236,248,28
Mvaa 240,252,16
Mvaa 244,252,20
buffer_load_dwordx4 a[12:15], v11, s[20:23], s58 offen offset:0 sc1
Mvaa 248,252,24
Mvaa 252,252,28
s_waitcnt vmcnt(56) lgkmcnt(0)
Mvaa 128,192,32
s_add_u32 s37, s38, 38912
Mvaa 132,192,36
Ta 224,16,24576
Ta 226,16,25600
Mvaa 136,192,40
buffer_load_dwordx4 a[16:19], v10, s[20:23], 0 offen offset:1024 sc1
Mvaa 140,192,44
buffer_store_dwordx4 v[104:107], v2, s[24:27], s37 offen offset:0 sc1
Mvaa 144,196,32
Ta 228,17,24576
Ta 230,17,25600
Mvaa 148,196,36
Mvaa 152,196,40
Mvaa 156,196,44
Ta 232,18,24576
Ta 234,18,25600
Mvaa 160,200,32
Mvaa 164,200,36
buffer_load_dwordx4 a[20:23], v10, s[20:23], s58 offen offset:1024 sc1
Mvaa 168,200,40
Ta 236,19,24576
Ta 238,19,25600
Mvaa 172,200,44
Mvaa 176,204,32
Mvaa 180,204,36
Ta 240,20,24576
Ta 242,20,25600
Mvaa 184,204,40
Mvaa 188,204,44
Mvaa 192,208,32
s_waitcnt lgkmcnt(6)
Ta 244,21,24576
Ta 246,21,25600
Mvaa 196,208,36
buffer_store_dwordx4 v[108:111], v2, s[24:27], s37 offen offset:1024 sc1
Mvaa 200,208,40
buffer_load_dwordx4 a[24:27], v11, s[20:23], 0 offen offset:1024 sc1
Mvaa 204,208,44
Ta 248,22,24576
Ta 250,22,25600
Mvaa 208,212,32
Mvaa 212,212,36
Mvaa 216,212,40
Ta 252,23,24576
Ta 254,23,25600
Mvaa 220,212,44
Mvaa 224,216,32
Mvaa 228,216,36
Mvaa 232,216,40
buffer_load_dwordx4 a[28:31], v11, s[20:23], s58 offen offset:1024 sc1
Mvaa 236,216,44
Mvaa 240,220,32
Mvaa 244,220,36
Mvaa 248,220,40
Mvaa 252,220,44
s_waitcnt vmcnt(51) lgkmcnt(0)
s_barrier
Mvaa 128,224,48
buffer_store_dwordx4 v[112:115], v2, s[24:27], s37 offen offset:2048 sc1
Mvaa 132,224,52
s_add_u32 m0, s44, 16384
Ta 192,16,32768
Ta 194,16,33792
Mvaa 136,224,56
buffer_load_dwordx4 v8, s[8:11], s48 offen offset:0 lds
Mvaa 140,224,60
Mvaa 144,228,48
Ta 196,17,32768
Ta 198,17,33792
Mvaa 148,228,52
buffer_load_dwordx4 v8, s[8:11], s49 offen offset:1024 lds
Mvaa 152,228,56
Mvaa 156,228,60
Ta 200,18,32768
Ta 202,18,33792
Mvaa 160,232,48
Mvaa 164,232,52
buffer_load_dwordx4 v9, s[8:11], s50 offen offset:2048 lds
Mvaa 168,232,56
Ta 204,19,32768
Ta 206,19,33792
Mvaa 172,232,60
Mvaa 176,236,48
Mvaa 180,236,52
Ta 208,20,32768
Ta 210,20,33792
Mvaa 184,236,56
buffer_load_dwordx4 v9, s[8:11], s51 offen offset:3072 lds
v_add_u32 v8, 524288, v8
v_add_u32 v9, 524288, v9
Mvaa 188,236,60
Mvaa 192,240,48
s_waitcnt lgkmcnt(6)
Ta 212,21,32768
Ta 214,21,33792
Mvaa 196,240,52
buffer_store_dwordx4 v[116:119], v2, s[24:27], s37 offen offset:3072 sc1
Mvaa 200,240,56
buffer_load_dwordx4 a[32:35], v10, s[20:23], 0 offen offset:2048 sc1
Mvaa 204,240,60
Ta 216,22,32768
Ta 218,22,33792
Mvaa 208,244,48
Mvaa 212,244,52
Mvaa 216,244,56
Ta 220,23,32768
Ta 222,23,33792
Mvaa 220,244,60
buffer_load_dwordx4 a[36:39], v10, s[20:23], s58 offen offset:2048 sc1
Mvaa 224,248,48
Mvaa 228,248,52
Mvaa 232,248,56
buffer_load_dwordx4 a[40:43], v11, s[20:23], 0 offen offset:2048 sc1
Mvaa 236,248,60
Mvaa 240,252,48
Mvaa 244,252,52
buffer_load_dwordx4 a[44:47], v11, s[20:23], s58 offen offset:2048 sc1
Mvaa 248,252,56
Mvaa 252,252,60
s_waitcnt vmcnt(56) lgkmcnt(0)
Mvaa 128,192,64
s_add_u32 s37, s38, 43008
Mvaa 132,192,68
Ta 224,16,40960
Ta 226,16,41984
Mvaa 136,192,72
buffer_load_dwordx4 a[48:51], v10, s[20:23], 0 offen offset:3072 sc1
Mvaa 140,192,76
buffer_store_dwordx4 v[120:123], v2, s[24:27], s37 offen offset:0 sc1
Mvaa 144,196,64
Ta 228,17,40960
Ta 230,17,41984
Mvaa 148,196,68
Mvaa 152,196,72
Mvaa 156,196,76
Ta 232,18,40960
Ta 234,18,41984
Mvaa 160,200,64
Mvaa 164,200,68
buffer_load_dwordx4 a[52:55], v10, s[20:23], s58 offen offset:3072 sc1
Mvaa 168,200,72
Ta 236,19,40960
Ta 238,19,41984
Mvaa 172,200,76
Mvaa 176,204,64
Mvaa 180,204,68
Ta 240,20,40960
Ta 242,20,41984
Mvaa 184,204,72
Mvaa 188,204,76
Mvaa 192,208,64
s_waitcnt lgkmcnt(6)
Ta 244,21,40960
Ta 246,21,41984
Mvaa 196,208,68
buffer_store_dwordx4 v[124:127], v2, s[24:27], s37 offen offset:1024 sc1
Mvaa 200,208,72
buffer_load_dwordx4 a[56:59], v11, s[20:23], 0 offen offset:3072 sc1
Mvaa 204,208,76
Ta 248,22,40960
Ta 250,22,41984
Mvaa 208,212,64
Mvaa 212,212,68
Mvaa 216,212,72
Ta 252,23,40960
Ta 254,23,41984
Mvaa 220,212,76
Mvaa 224,216,64
Mvaa 228,216,68
Mvaa 232,216,72
buffer_load_dwordx4 a[60:63], v11, s[20:23], s58 offen offset:3072 sc1
v_add_u32 v10, 4096, v10
v_add_u32 v11, 4096, v11
Mvaa 236,216,76
Mvaa 240,220,64
Mvaa 244,220,68
Mvaa 248,220,72
Mvaa 252,220,76
s_waitcnt vmcnt(51) lgkmcnt(0)
s_barrier
Mvaa 128,224,80
buffer_store_dwordx4 v[24:27], v2, s[24:27], s37 offen offset:2048 sc1
Mvaa 132,224,84
s_add_u32 m0, s44, 32768
Ta 192,16,49152
Ta 194,16,50176
Mvaa 136,224,88
buffer_load_dwordx4 v8, s[8:11], s48 offen offset:0 lds
Mvaa 140,224,92
Mvaa 144,228,80
Ta 196,17,49152
Ta 198,17,50176
Mvaa 148,228,84
buffer_load_dwordx4 v8, s[8:11], s49 offen offset:1024 lds
Mvaa 152,228,88
Mvaa 156,228,92
Ta 200,18,49152
Ta 202,18,50176
Mvaa 160,232,80
Mvaa 164,232,84
buffer_load_dwordx4 v9, s[8:11], s50 offen offset:2048 lds
Mvaa 168,232,88
Ta 204,19,49152
Ta 206,19,50176
Mvaa 172,232,92
Mvaa 176,236,80
Mvaa 180,236,84
Ta 208,20,49152
Ta 210,20,50176
Mvaa 184,236,88
buffer_load_dwordx4 v9, s[8:11], s51 offen offset:3072 lds
v_add_u32 v8, 524288, v8
v_add_u32 v9, 524288, v9
Mvaa 188,236,92
Mvaa 192,240,80
s_waitcnt lgkmcnt(6)
Ta 212,21,49152
Ta 214,21,50176
Mvaa 196,240,84
buffer_store_dwordx4 v[28:31], v2, s[24:27], s37 offen offset:3072 sc1
Mvaa 200,240,88
buffer_load_dwordx4 a[64:67], v10, s[20:23], 0 offen offset:0 sc1
Mvaa 204,240,92
Ta 216,22,49152
Ta 218,22,50176
Mvaa 208,244,80
Mvaa 212,244,84
Mvaa 216,244,88
Ta 220,23,49152
Ta 222,23,50176
Mvaa 220,244,92
buffer_load_dwordx4 a[68:71], v10, s[20:23], s58 offen offset:0 sc1
Mvaa 224,248,80
Mvaa 228,248,84
Mvaa 232,248,88
buffer_load_dwordx4 a[72:75], v11, s[20:23], 0 offen offset:0 sc1
Mvaa 236,248,92
Mvaa 240,252,80
Mvaa 244,252,84
buffer_load_dwordx4 a[76:79], v11, s[20:23], s58 offen offset:0 sc1
Mvaa 248,252,88
Mvaa 252,252,92
s_waitcnt vmcnt(56) lgkmcnt(0)
Mvaa 128,192,96
s_add_u32 s37, s38, 47104
Mvaa 132,192,100
Ta 224,16,57344
Ta 226,16,58368
Mvaa 136,192,104
buffer_load_dwordx4 a[80:83], v10, s[20:23], 0 offen offset:1024 sc1
Mvaa 140,192,108
buffer_store_dwordx4 v[32:35], v2, s[24:27], s37 offen offset:0 sc1
Mvaa 144,196,96
Ta 228,17,57344
Ta 230,17,58368
Mvaa 148,196,100
Mvaa 152,196,104
Mvaa 156,196,108
Ta 232,18,57344
Ta 234,18,58368
Mvaa 160,200,96
Mvaa 164,200,100
buffer_load_dwordx4 a[84:87], v10, s[20:23], s58 offen offset:1024 sc1
Mvaa 168,200,104
Ta 236,19,57344
Ta 238,19,58368
Mvaa 172,200,108
Mvaa 176,204,96
Mvaa 180,204,100
Ta 240,20,57344
Ta 242,20,58368
Mvaa 184,204,104
Mvaa 188,204,108
Mvaa 192,208,96
s_waitcnt lgkmcnt(6)
Ta 244,21,57344
Ta 246,21,58368
Mvaa 196,208,100
buffer_store_dwordx4 v[36:39], v2, s[24:27], s37 offen offset:1024 sc1
Mvaa 200,208,104
buffer_load_dwordx4 a[88:91], v11, s[20:23], 0 offen offset:1024 sc1
Mvaa 204,208,108
Ta 248,22,57344
Ta 250,22,58368
Mvaa 208,212,96
Mvaa 212,212,100
Mvaa 216,212,104
Ta 252,23,57344
Ta 254,23,58368
Mvaa 220,212,108
Mvaa 224,216,96
Mvaa 228,216,100
Mvaa 232,216,104
buffer_load_dwordx4 a[92:95], v11, s[20:23], s58 offen offset:1024 sc1
Mvaa 236,216,108
Mvaa 240,220,96
Mvaa 244,220,100
Mvaa 248,220,104
Mvaa 252,220,108
s_waitcnt vmcnt(43) lgkmcnt(0)
s_barrier
Mvaa 128,224,112
buffer_store_dwordx4 v[40:43], v2, s[24:27], s37 offen offset:2048 sc1
Mvaa 132,224,116
s_add_u32 m0, s44, 49152
Ta 192,16,0
Ta 194,16,1024
Mvaa 136,224,120
buffer_load_dwordx4 v8, s[8:11], s48 offen offset:0 lds
Mvaa 140,224,124
Mvaa 144,228,112
Ta 196,17,0
Ta 198,17,1024
Mvaa 148,228,116
buffer_load_dwordx4 v8, s[8:11], s49 offen offset:1024 lds
Mvaa 152,228,120
Mvaa 156,228,124
Ta 200,18,0
Ta 202,18,1024
Mvaa 160,232,112
Mvaa 164,232,116
buffer_load_dwordx4 v9, s[8:11], s50 offen offset:2048 lds
Mvaa 168,232,120
Ta 204,19,0
Ta 206,19,1024
Mvaa 172,232,124
Mvaa 176,236,112
Mvaa 180,236,116
Ta 208,20,0
Ta 210,20,1024
Mvaa 184,236,120
buffer_load_dwordx4 v9, s[8:11], s51 offen offset:3072 lds
v_add_u32 v8, 524288, v8
v_add_u32 v9, 524288, v9
Mvaa 188,236,124
Mvaa 192,240,112
s_waitcnt lgkmcnt(6)
Ta 212,21,0
Ta 214,21,1024
Mvaa 196,240,116
buffer_store_dwordx4 v[44:47], v2, s[24:27], s37 offen offset:3072 sc1
Mvaa 200,240,120
buffer_load_dwordx4 a[96:99], v10, s[20:23], 0 offen offset:2048 sc1
Mvaa 204,240,124
Ta 216,22,0
Ta 218,22,1024
Mvaa 208,244,112
v_mov_b32 v12, 1
v_and_b32 v1, 15, v0
Mvaa 212,244,116
v_lshlrev_b32 v1, 2, v1
Mvaa 216,244,120
Ta 220,23,0
Ta 222,23,1024
Mvaa 220,244,124
buffer_load_dwordx4 a[100:103], v10, s[20:23], s58 offen offset:2048 sc1
Mvaa 224,248,112
s_lshr_b32 s6, s33, 1
s_lshl_b32 s6, s6, 7
s_add_u32 s6, s6, 5296128
Mvaa 228,248,116
s_cmp_eq_u32 s32, 0
s_cselect_b32 s6, s6, 2146435072
Mvaa 232,248,120
buffer_load_dwordx4 a[104:107], v11, s[20:23], 0 offen offset:2048 sc1
Mvaa 236,248,124
Mvaa 240,252,112
Mvaa 244,252,116
buffer_load_dwordx4 a[108:111], v11, s[20:23], s58 offen offset:2048 sc1
Mvaa 248,252,120
Mvaa 252,252,124
s_waitcnt vmcnt(48) lgkmcnt(0)
Mvaa 128,192,0
Mvaa 132,192,4
Ta 224,16,8192
Ta 226,16,9216
Mvaa 136,192,8
buffer_load_dwordx4 a[112:115], v10, s[20:23], 0 offen offset:3072 sc1
Mvaa 140,192,12
Mvaa 144,196,0
Ta 228,17,8192
Ta 230,17,9216
Mvaa 148,196,4
Mvaa 152,196,8
Mvaa 156,196,12
Ta 232,18,8192
Ta 234,18,9216
Mvaa 160,200,0
Mvaa 164,200,4
buffer_load_dwordx4 a[116:119], v10, s[20:23], s58 offen offset:3072 sc1
Mvaa 168,200,8
Ta 236,19,8192
Ta 238,19,9216
Mvaa 172,200,12
Mvaa 176,204,0
Mvaa 180,204,4
Ta 240,20,8192
Ta 242,20,9216
Mvaa 184,204,8
Mvaa 188,204,12
Mvaa 192,208,0
s_waitcnt lgkmcnt(6)
Ta 244,21,8192
Ta 246,21,9216
Mvaa 196,208,4
v_max_u32 v14, v56, v57
v_min_u32 v15, v56, v57
Mvaa 200,208,8
buffer_load_dwordx4 a[120:123], v11, s[20:23], 0 offen offset:3072 sc1
Mvaa 204,208,12
Ta 248,22,8192
Ta 250,22,9216
Mvaa 208,212,0
v_med3_u32 v15, v14, v15, v58
v_max_u32 v14, v14, v58
Mvaa 212,212,4
v_med3_u32 v15, v14, v15, v59
v_max_u32 v14, v14, v59
Mvaa 216,212,8
Ta 252,23,8192
Ta 254,23,9216
Mvaa 220,212,12
v_med3_u32 v15, v14, v15, v60
v_max_u32 v14, v14, v60
Mvaa 224,216,0
v_med3_u32 v15, v14, v15, v61
v_max_u32 v14, v14, v61
Mvaa 228,216,4
v_med3_u32 v15, v14, v15, v62
v_max_u32 v14, v14, v62
Mvaa 232,216,8
buffer_load_dwordx4 a[124:127], v11, s[20:23], s58 offen offset:3072 sc1
v_add_u32 v10, 4096, v10
v_add_u32 v11, 4096, v11
Mvaa 236,216,12
v_med3_u32 v15, v14, v15, v63
v_max_u32 v14, v14, v63
Mvaa 240,220,0
v_med3_u32 v15, v14, v15, v64
v_max_u32 v14, v14, v64
Mvaa 244,220,4
v_med3_u32 v15, v14, v15, v65
v_max_u32 v14, v14, v65
Mvaa 248,220,8
v_med3_u32 v15, v14, v15, v66
v_max_u32 v14, v14, v66
Mvaa 252,220,12
v_med3_u32 v15, v14, v15, v67
v_max_u32 v14, v14, v67
s_waitcnt vmcnt(41) lgkmcnt(0)
s_barrier
Mvaa 128,224,16
v_med3_u32 v15, v14, v15, v68
v_max_u32 v14, v14, v68
Mvaa 132,224,20
s_add_u32 m0, s44, 0
Ta 192,16,16384
Ta 194,16,17408
Mvaa 136,224,24
buffer_load_dwordx4 v8, s[8:11], s48 offen offset:0 lds
Mvaa 140,224,28
v_med3_u32 v15, v14, v15, v69
v_max_u32 v14, v14, v69
Mvaa 144,228,16
Ta 196,17,16384
Ta 198,17,17408
Mvaa 148,228,20
buffer_load_dwordx4 v8, s[8:11], s49 offen offset:1024 lds
Mvaa 152,228,24
v_med3_u32 v15, v14, v15, v70
v_max_u32 v14, v14, v70
Mvaa 156,228,28
Ta 200,18,16384
Ta 202,18,17408
Mvaa 160,232,16
v_med3_u32 v15, v14, v15, v71
v_max_u32 v14, v14, v71
Mvaa 164,232,20
buffer_load_dwordx4 v9, s[8:11], s50 offen offset:2048 lds
Mvaa 168,232,24
Ta 204,19,16384
Ta 206,19,17408
Mvaa 172,232,28
v_med3_u32 v15, v14, v15, v72
v_max_u32 v14, v14, v72
Mvaa 176,236,16
v_med3_u32 v15, v14, v15, v73
v_max_u32 v14, v14, v73
Mvaa 180,236,20
Ta 208,20,16384
Ta 210,20,17408
Mvaa 184,236,24
buffer_load_dwordx4 v9, s[8:11], s51 offen offset:3072 lds
v_add_u32 v8, 524288, v8
v_add_u32 v9, 524288, v9
Mvaa 188,236,28
v_med3_u32 v15, v14, v15, v74
v_max_u32 v14, v14, v74
Mvaa 192,240,16
s_waitcnt lgkmcnt(6)
Ta 212,21,16384
Ta 214,21,17408
Mvaa 196,240,20
v_med3_u32 v15, v14, v15, v75
v_max_u32 v14, v14, v75
Mvaa 200,240,24
buffer_load_dwordx4 a[0:3], v10, s[20:23], 0 offen offset:0 sc1
Mvaa 204,240,28
Ta 216,22,16384
Ta 218,22,17408
Mvaa 208,244,16
v_med3_u32 v15, v14, v15, v76
v_max_u32 v14, v14, v76
Mvaa 212,244,20
v_med3_u32 v15, v14, v15, v77
v_max_u32 v14, v14, v77
Mvaa 216,244,24
Ta 220,23,16384
Ta 222,23,17408
Mvaa 220,244,28
buffer_load_dwordx4 a[4:7], v10, s[20:23], s58 offen offset:0 sc1
Mvaa 224,248,16
v_med3_u32 v15, v14, v15, v78
v_max_u32 v14, v14, v78
Mvaa 228,248,20
v_med3_u32 v15, v14, v15, v79
v_max_u32 v14, v14, v79
Mvaa 232,248,24
buffer_load_dwordx4 a[8:11], v11, s[20:23], 0 offen offset:0 sc1
Mvaa 236,248,28
v_med3_u32 v15, v14, v15, v80
v_max_u32 v14, v14, v80
Mvaa 240,252,16
v_med3_u32 v15, v14, v15, v81
v_max_u32 v14, v14, v81
Mvaa 244,252,20
buffer_load_dwordx4 a[12:15], v11, s[20:23], s58 offen offset:0 sc1
Mvaa 248,252,24
v_med3_u32 v15, v14, v15, v82
v_max_u32 v14, v14, v82
Mvaa 252,252,28
v_med3_u32 v15, v14, v15, v83
v_max_u32 v14, v14, v83
s_waitcnt vmcnt(44) lgkmcnt(0)
Mvaa 128,192,32
v_med3_u32 v15, v14, v15, v84
v_max_u32 v14, v14, v84
Mvaa 132,192,36
Ta 224,16,24576
Ta 226,16,25600
Mvaa 136,192,40
buffer_load_dwordx4 a[16:19], v10, s[20:23], 0 offen offset:1024 sc1
Mvaa 140,192,44
v_med3_u32 v15, v14, v15, v85
v_max_u32 v14, v14, v85
Mvaa 144,196,32
Ta 228,17,24576
Ta 230,17,25600
Mvaa 148,196,36
v_med3_u32 v15, v14, v15, v86
v_max_u32 v14, v14, v86
Mvaa 152,196,40
v_med3_u32 v15, v14, v15, v87
v_max_u32 v14, v14, v87
Mvaa 156,196,44
Ta 232,18,24576
Ta 234,18,25600
Mvaa 160,200,32
v_mov_b32 v13, v14
Mvaa 164,200,36
buffer_load_dwordx4 a[20:23], v10, s[20:23], s58 offen offset:1024 sc1
Mvaa 168,200,40
Ta 236,19,24576
Ta 238,19,25600
Mvaa 172,200,44
v_max_u32_dpp v13, v13, v13 quad_perm:[1,0,3,2] row_mask:0xf bank_mask:0xf
Mvaa 176,204,32
s_nop 0
v_max_u32_dpp v13, v13, v13 quad_perm:[2,3,0,1] row_mask:0xf bank_mask:0xf
Mvaa 180,204,36
Ta 240,20,24576
Ta 242,20,25600
Mvaa 184,204,40
v_max_u32_dpp v13, v13, v13 row_half_mirror row_mask:0xf bank_mask:0xf
Mvaa 188,204,44
s_nop 0
v_max_u32_dpp v13, v13, v13 row_mirror row_mask:0xf bank_mask:0xf
Mvaa 192,208,32
s_waitcnt lgkmcnt(6)
Ta 244,21,24576
Ta 246,21,25600
Mvaa 196,208,36
v_readlane_b32 s3, v13, 0
v_readlane_b32 s47, v13, 16
Mvaa 200,208,40
buffer_load_dwordx4 a[24:27], v11, s[20:23], 0 offen offset:1024 sc1
Mvaa 204,208,44
Ta 248,22,24576
Ta 250,22,25600
Mvaa 208,212,32
v_readlane_b32 s4, v13, 32
v_readlane_b32 s5, v13, 48
Mvaa 212,212,36
s_max_u32 s3, s3, s47
s_max_u32 s4, s4, s5
s_max_u32 s40, s3, s4
Mvaa 216,212,40
Ta 252,23,24576
Ta 254,23,25600
Mvaa 220,212,44
v_cmp_eq_u32 vcc, s40, v14
Mvaa 224,216,32
s_nop 0
v_cndmask_b32 v13, v14, v15, vcc
Mvaa 228,216,36
s_nop 0
v_max_u32_dpp v13, v13, v13 quad_perm:[1,0,3,2] row_mask:0xf bank_mask:0xf
Mvaa 232,216,40
buffer_load_dwordx4 a[28:31], v11, s[20:23], s58 offen offset:1024 sc1
Mvaa 236,216,44
v_max_u32_dpp v13, v13, v13 quad_perm:[2,3,0,1] row_mask:0xf bank_mask:0xf
Mvaa 240,220,32
s_nop 0
v_max_u32_dpp v13, v13, v13 row_half_mirror row_mask:0xf bank_mask:0xf
Mvaa 244,220,36
s_nop 0
v_max_u32_dpp v13, v13, v13 row_mirror row_mask:0xf bank_mask:0xf
Mvaa 248,220,40
v_readlane_b32 s3, v13, 0
v_readlane_b32 s47, v13, 16
Mvaa 252,220,44
v_readlane_b32 s4, v13, 32
v_readlane_b32 s5, v13, 48
s_waitcnt vmcnt(37) lgkmcnt(0)
s_barrier
Mvaa 128,224,48
s_max_u32 s3, s3, s47
s_max_u32 s4, s4, s5
s_max_u32 s41, s3, s4
Mvaa 132,224,52
s_add_u32 m0, s44, 16384
Ta 192,16,32768
Ta 194,16,33792
Mvaa 136,224,56
buffer_load_dwordx4 v8, s[8:11], s48 offen offset:0 lds
Mvaa 140,224,60
s_and_b32 s3, s40, 0xffff
s_sub_u32 s42, 0xffff, s3
s_and_b32 s3, s41, 0xffff
Mvaa 144,228,48
Ta 196,17,32768
Ta 198,17,33792
Mvaa 148,228,52
buffer_load_dwordx4 v8, s[8:11], s49 offen offset:1024 lds
Mvaa 152,228,56
s_sub_u32 s43, 0xffff, s3
v_mov_b32 v56, s42
v_mov_b32 v60, s40
Mvaa 156,228,60
Ta 200,18,32768
Ta 202,18,33792
Mvaa 160,232,48
v_not_b32 v61, v60
v_ashrrev_i32 v61, 31, v61
Mvaa 164,232,52
buffer_load_dwordx4 v9, s[8:11], s50 offen offset:2048 lds
Mvaa 168,232,56
Ta 204,19,32768
Ta 206,19,33792
Mvaa 172,232,60
v_or_b32 v61, 0x80000000, v61
v_xor_b32 v60, v60, v61
Mvaa 176,236,48
v_and_b32 v60, 0xffff0000, v60
v_mul_f32 v60, 0xbfb8aa3b, v60
Mvaa 180,236,52
Ta 208,20,32768
Ta 210,20,33792
Mvaa 184,236,56
buffer_load_dwordx4 v9, s[8:11], s51 offen offset:3072 lds
v_add_u32 v8, 524288, v8
v_add_u32 v9, 524288, v9
Mvaa 188,236,60
Ve 60,60
Mvaa 192,240,48
s_waitcnt lgkmcnt(6)
Ta 212,21,32768
Ta 214,21,33792
Mvaa 196,240,52
v_add_f32 v60, 1.0, v60
Mvaa 200,240,56
buffer_load_dwordx4 a[32:35], v10, s[20:23], 0 offen offset:2048 sc1
Mvaa 204,240,60
Ta 216,22,32768
Ta 218,22,33792
Mvaa 208,244,48
v_rcp_f32 v60, v60
Mvaa 212,244,52
Vc 60,60,60
v_and_b32 v58, 0xffff0000, v60
Mvaa 216,244,56
Ta 220,23,32768
Ta 222,23,33792
Mvaa 220,244,60
buffer_load_dwordx4 a[36:39], v10, s[20:23], s58 offen offset:2048 sc1
Mvaa 224,248,48
v_mov_b32 v57, s43
v_mov_b32 v60, s41
Mvaa 228,248,52
v_not_b32 v61, v60
v_ashrrev_i32 v61, 31, v61
Mvaa 232,248,56
buffer_load_dwordx4 a[40:43], v11, s[20:23], 0 offen offset:2048 sc1
Mvaa 236,248,60
v_or_b32 v61, 0x80000000, v61
v_xor_b32 v60, v60, v61
Mvaa 240,252,48
v_and_b32 v60, 0xffff0000, v60
v_mul_f32 v60, 0xbfb8aa3b, v60
Mvaa 244,252,52
buffer_load_dwordx4 a[44:47], v11, s[20:23], s58 offen offset:2048 sc1
Mvaa 248,252,56
Ve 60,60
Mvaa 252,252,60
v_add_f32 v60, 1.0, v60
s_waitcnt vmcnt(40) lgkmcnt(0)
Mvaa 128,192,64
v_rcp_f32 v60, v60
Mvaa 132,192,68
Ta 224,16,40960
Ta 226,16,41984
Mvaa 136,192,72
buffer_load_dwordx4 a[48:51], v10, s[20:23], 0 offen offset:3072 sc1
Mvaa 140,192,76
Vc 60,60,60
v_and_b32 v59, 0xffff0000, v60
Mvaa 144,196,64
Ta 228,17,40960
Ta 230,17,41984
Mvaa 148,196,68
s_mov_b32 s47, 5292032
s_or_b32 s3, s2, s32
s_cmp_eq_u32 s3, 0
s_cselect_b32 s3, s47, 2146435072
Mvaa 152,196,72
s_mov_b64 exec, 1
buffer_store_dwordx4 v[56:59], v7, s[20:23], s3 offen
s_mov_b64 exec, -1
Mvaa 156,196,76
Ta 232,18,40960
Ta 234,18,41984
Mvaa 160,200,64
v_mov_b32 v48, 0
v_mov_b32 v49, 0
Mvaa 164,200,68
buffer_load_dwordx4 a[52:55], v10, s[20:23], s58 offen offset:3072 sc1
Mvaa 168,200,72
Ta 236,19,40960
Ta 238,19,41984
Mvaa 172,200,76
v_mov_b32 v50, 0
v_mov_b32 v51, 0
Mvaa 176,204,64
v_mov_b32 v52, 0
v_mov_b32 v53, 0
Mvaa 180,204,68
Ta 240,20,40960
Ta 242,20,41984
Mvaa 184,204,72
v_mov_b32 v54, 0
v_mov_b32 v55, 0
Mvaa 188,204,76
v_mov_b32 v56, 0
v_mov_b32 v57, 0
Mvaa 192,208,64
s_waitcnt lgkmcnt(6)
Ta 244,21,40960
Ta 246,21,41984
Mvaa 196,208,68
v_mov_b32 v58, 0
v_mov_b32 v59, 0
Mvaa 200,208,72
buffer_load_dwordx4 a[56:59], v11, s[20:23], 0 offen offset:3072 sc1
Mvaa 204,208,76
Ta 248,22,40960
Ta 250,22,41984
Mvaa 208,212,64
v_mov_b32 v60, 0
v_mov_b32 v61, 0
Mvaa 212,212,68
v_mov_b32 v62, 0
v_mov_b32 v63, 0
Mvaa 216,212,72
Ta 252,23,40960
Ta 254,23,41984
Mvaa 220,212,76
s_mul_i32 s3, s34, s34
s_lshl_b32 s47, s33, 6
s_add_u32 s3, s3, s47
Mvaa 224,216,64
s_lshl_b32 s3, s3, 2
s_add_u32 s3, s3, s32
s_lshl_b32 s3, s3, 7
Mvaa 228,216,68
s_sub_u32 s3, s3, 512
v_min_u32 v13, 32, v0
v_mov_b32 v28, s92
Mvaa 232,216,72
buffer_load_dwordx4 a[60:63], v11, s[20:23], s58 offen offset:3072 sc1
v_add_u32 v10, 4096, v10
v_add_u32 v11, 4096, v11
Mvaa 236,216,76
v_mov_b32 v29, s93
v_mov_b32 v30, v13
Mvaa 240,220,64
v_mov_b32 v14, s94
v_mov_b32 v15, s95
Mvaa 244,220,68
v_cmp_le_u32 vcc, 8, v13
v_subrev_u32 v31, 8, v13
Mvaa 248,220,72
v_cndmask_b32 v28, v28, v14, vcc
v_cndmask_b32 v29, v29, v15, vcc
Mvaa 252,220,76
v_cndmask_b32 v30, v30, v31, vcc
s_waitcnt vmcnt(33) lgkmcnt(0)
s_barrier
Mvaa 128,224,80
s_mov_b64 exec, 1
buffer_store_dword v12, v7, s[20:23], s39 offen sc1
s_mov_b64 exec, -1
Mvaa 132,224,84
s_add_u32 m0, s44, 32768
Ta 192,16,49152
Ta 194,16,50176
Mvaa 136,224,88
buffer_load_dwordx4 v8, s[8:11], s48 offen offset:0 lds
Mvaa 140,224,92
v_mov_b32 v14, s100
v_mov_b32 v15, s101
Mvaa 144,228,80
Ta 196,17,49152
Ta 198,17,50176
Mvaa 148,228,84
buffer_load_dwordx4 v8, s[8:11], s49 offen offset:1024 lds
Mvaa 152,228,88
v_cmp_le_u32 vcc, 15, v13
v_subrev_u32 v31, 15, v13
Mvaa 156,228,92
Ta 200,18,49152
Ta 202,18,50176
Mvaa 160,232,80
v_cndmask_b32 v28, v28, v14, vcc
v_cndmask_b32 v29, v29, v15, vcc
Mvaa 164,232,84
buffer_load_dwordx4 v9, s[8:11], s50 offen offset:2048 lds
Mvaa 168,232,88
Ta 204,19,49152
Ta 206,19,50176
Mvaa 172,232,92
v_cndmask_b32 v30, v30, v31, vcc
Mvaa 176,236,80
v_mov_b32 v14, s60
v_mov_b32 v15, s61
Mvaa 180,236,84
Ta 208,20,49152
Ta 210,20,50176
Mvaa 184,236,88
buffer_load_dwordx4 v9, s[8:11], s51 offen offset:3072 lds
v_add_u32 v8, 524288, v8
v_add_u32 v9, 524288, v9
Mvaa 188,236,92
v_cmp_le_u32 vcc, 19, v13
v_subrev_u32 v31, 19, v13
Mvaa 192,240,80
s_waitcnt lgkmcnt(6)
Ta 212,21,49152
Ta 214,21,50176
Mvaa 196,240,84
v_cndmask_b32 v28, v28, v14, vcc
v_cndmask_b32 v29, v29, v15, vcc
Mvaa 200,240,88
buffer_load_dwordx4 a[64:67], v10, s[20:23], 0 offen offset:0 sc1
Mvaa 204,240,92
Ta 216,22,49152
Ta 218,22,50176
Mvaa 208,244,80
v_cndmask_b32 v30, v30, v31, vcc
Mvaa 212,244,84
v_mov_b32 v14, s68
v_mov_b32 v15, s69
Mvaa 216,244,88
Ta 220,23,49152
Ta 222,23,50176
Mvaa 220,244,92
buffer_load_dwordx4 a[68:71], v10, s[20:23], s58 offen offset:0 sc1
Mvaa 224,248,80
v_cmp_le_u32 vcc, 26, v13
v_subrev_u32 v31, 26, v13
Mvaa 228,248,84
v_cndmask_b32 v28, v28, v14, vcc
v_cndmask_b32 v29, v29, v15, vcc
Mvaa 232,248,88
buffer_load_dwordx4 a[72:75], v11, s[20:23], 0 offen offset:0 sc1
Mvaa 236,248,92
v_cndmask_b32 v30, v30, v31, vcc
Mvaa 240,252,80
v_lshlrev_b32 v30, 20, v30
v_add_u32 v30, s3, v30
Mvaa 244,252,84
buffer_load_dwordx4 a[76:79], v11, s[20:23], s58 offen offset:0 sc1
Mvaa 248,252,88
v_ashrrev_i32 v31, 31, v30
v_lshl_add_u64 v[28:29], v[30:31], 0, v[28:29]
Mvaa 252,252,92
s_mov_b32 s40, 512
s_mov_b32 s41, 0
s_waitcnt vmcnt(38) lgkmcnt(0)
Mvaa 128,192,96
Mvaa 132,192,100
Ta 224,16,57344
Ta 226,16,58368
Mvaa 136,192,104
buffer_load_dwordx4 a[80:83], v10, s[20:23], 0 offen offset:1024 sc1
Mvaa 140,192,108
Mvaa 144,196,96
Ta 228,17,57344
Ta 230,17,58368
Mvaa 148,196,100
Mvaa 152,196,104
Mvaa 156,196,108
Ta 232,18,57344
Ta 234,18,58368
Mvaa 160,200,96
Mvaa 164,200,100
buffer_load_dwordx4 a[84:87], v10, s[20:23], s58 offen offset:1024 sc1
Mvaa 168,200,104
Ta 236,19,57344
Ta 238,19,58368
Mvaa 172,200,108
Mvaa 176,204,96
Mvaa 180,204,100
Ta 240,20,57344
Ta 242,20,58368
Mvaa 184,204,104
Mvaa 188,204,108
Mvaa 192,208,96
s_waitcnt lgkmcnt(6)
Ta 244,21,57344
Ta 246,21,58368
Mvaa 196,208,100
Mvaa 200,208,104
buffer_load_dwordx4 a[88:91], v11, s[20:23], 0 offen offset:1024 sc1
Mvaa 204,208,108
Ta 248,22,57344
Ta 250,22,58368
Mvaa 208,212,96
Mvaa 212,212,100
Mvaa 216,212,104
Ta 252,23,57344
Ta 254,23,58368
Mvaa 220,212,108
Mvaa 224,216,96
Mvaa 228,216,100
Mvaa 232,216,104
buffer_load_dwordx4 a[92:95], v11, s[20:23], s58 offen offset:1024 sc1
Mvaa 236,216,108
Mvaa 240,220,96
Mvaa 244,220,100
Mvaa 248,220,104
Mvaa 252,220,108
s_waitcnt vmcnt(34) lgkmcnt(0)
s_barrier
Mvaa 128,224,112
Mvaa 132,224,116
s_add_u32 m0, s44, 49152
Ta 192,16,0
Ta 194,16,1024
Mvaa 136,224,120
buffer_load_dwordx4 v8, s[8:11], s48 offen offset:0 lds
Mvaa 140,224,124
Mvaa 144,228,112
Ta 196,17,0
Ta 198,17,1024
Mvaa 148,228,116
buffer_load_dwordx4 v8, s[8:11], s49 offen offset:1024 lds
Mvaa 152,228,120
Mvaa 156,228,124
Ta 200,18,0
Ta 202,18,1024
Mvaa 160,232,112
Mvaa 164,232,116
buffer_load_dwordx4 v9, s[8:11], s50 offen offset:2048 lds
Mvaa 168,232,120
Ta 204,19,0
Ta 206,19,1024
Mvaa 172,232,124
Mvaa 176,236,112
Mvaa 180,236,116
Ta 208,20,0
Ta 210,20,1024
Mvaa 184,236,120
buffer_load_dwordx4 v9, s[8:11], s51 offen offset:3072 lds
v_add_u32 v8, 524288, v8
v_add_u32 v9, 524288, v9
Mvaa 188,236,124
Mvaa 192,240,112
s_waitcnt lgkmcnt(6)
Ta 212,21,0
Ta 214,21,1024
Mvaa 196,240,116
Mvaa 200,240,120
buffer_load_dwordx4 a[96:99], v10, s[20:23], 0 offen offset:2048 sc1
Mvaa 204,240,124
Ta 216,22,0
Ta 218,22,1024
Mvaa 208,244,112
Mvaa 212,244,116
Mvaa 216,244,120
Ta 220,23,0
Ta 222,23,1024
Mvaa 220,244,124
buffer_load_dwordx4 a[100:103], v10, s[20:23], s58 offen offset:2048 sc1
Mvaa 224,248,112
Mvaa 228,248,116
Mvaa 232,248,120
buffer_load_dwordx4 a[104:107], v11, s[20:23], 0 offen offset:2048 sc1
Mvaa 236,248,124
Mvaa 240,252,112
Mvaa 244,252,116
buffer_load_dwordx4 a[108:111], v11, s[20:23], s58 offen offset:2048 sc1
Mvaa 248,252,120
Mvaa 252,252,124
s_waitcnt vmcnt(38) lgkmcnt(0)
Mvaa 128,192,0
Mvaa 132,192,4
Ta 224,16,8192
Ta 226,16,9216
Mvaa 136,192,8
buffer_load_dwordx4 a[112:115], v10, s[20:23], 0 offen offset:3072 sc1
Mvaa 140,192,12
Mvaa 144,196,0
Ta 228,17,8192
Ta 230,17,9216
Mvaa 148,196,4
Mvaa 152,196,8
Mvaa 156,196,12
Ta 232,18,8192
Ta 234,18,9216
Mvaa 160,200,0
Mvaa 164,200,4
buffer_load_dwordx4 a[116:119], v10, s[20:23], s58 offen offset:3072 sc1
Mvaa 168,200,8
Ta 236,19,8192
Ta 238,19,9216
Mvaa 172,200,12
Mvaa 176,204,0
Mvaa 180,204,4
Ta 240,20,8192
Ta 242,20,9216
Mvaa 184,204,8
Mvaa 188,204,12
Mvaa 192,208,0
s_waitcnt lgkmcnt(6)
Ta 244,21,8192
Ta 246,21,9216
Mvaa 196,208,4
Mvaa 200,208,8
buffer_load_dwordx4 a[120:123], v11, s[20:23], 0 offen offset:3072 sc1
Mvaa 204,208,12
Ta 248,22,8192
Ta 250,22,9216
Mvaa 208,212,0
Mvaa 212,212,4
Mvaa 216,212,8
Ta 252,23,8192
Ta 254,23,9216
Mvaa 220,212,12
Mvaa 224,216,0
Mvaa 228,216,4
Mvaa 232,216,8
buffer_load_dwordx4 a[124:127], v11, s[20:23], s58 offen offset:3072 sc1
v_add_u32 v10, 4096, v10
v_add_u32 v11, 4096, v11
Mvaa 236,216,12
Mvaa 240,220,0
Mvaa 244,220,4
Mvaa 248,220,8
Mvaa 252,220,12
s_waitcnt vmcnt(34) lgkmcnt(0)
s_barrier
Mvaa 128,224,16
Mvaa 132,224,20
Ta 192,16,16384
Ta 194,16,17408
Mvaa 136,224,24
Mvaa 140,224,28
Mvaa 144,228,16
Ta 196,17,16384
Ta 198,17,17408
Mvaa 148,228,20
Mvaa 152,228,24
Mvaa 156,228,28
Ta 200,18,16384
Ta 202,18,17408
Mvaa 160,232,16
Mvaa 164,232,20
Mvaa 168,232,24
Ta 204,19,16384
Ta 206,19,17408
Mvaa 172,232,28
Mvaa 176,236,16
Mvaa 180,236,20
Ta 208,20,16384
Ta 210,20,17408
Mvaa 184,236,24
Mvaa 188,236,28
Mvaa 192,240,16
s_waitcnt lgkmcnt(6)
Ta 212,21,16384
Ta 214,21,17408
Mvaa 196,240,20
Mvaa 200,240,24
Mvaa 204,240,28
Ta 216,22,16384
Ta 218,22,17408
Mvaa 208,244,16
Mvaa 212,244,20
Mvaa 216,244,24
Ta 220,23,16384
Ta 222,23,17408
Mvaa 220,244,28
Mvaa 224,248,16
Mvaa 228,248,20
Mvaa 232,248,24
Mvaa 236,248,28
Mvaa 240,252,16
Mvaa 244,252,20
Mvaa 248,252,24
Mvaa 252,252,28
s_waitcnt vmcnt(30) lgkmcnt(0)
Mvaa 128,192,32
Mvaa 132,192,36
Ta 224,16,24576
Ta 226,16,25600
Mvaa 136,192,40
Mvaa 140,192,44
Mvaa 144,196,32
Ta 228,17,24576
Ta 230,17,25600
Mvaa 148,196,36
Mvaa 152,196,40
Mvaa 156,196,44
Ta 232,18,24576
Ta 234,18,25600
Mvaa 160,200,32
Mvaa 164,200,36
Mvaa 168,200,40
Ta 236,19,24576
Ta 238,19,25600
Mvaa 172,200,44
Mvaa 176,204,32
Mvaa 180,204,36
Ta 240,20,24576
Ta 242,20,25600
Mvaa 184,204,40
Mvaa 188,204,44
Mvaa 192,208,32
s_waitcnt lgkmcnt(6)
Ta 244,21,24576
Ta 246,21,25600
Mvaa 196,208,36
Mvaa 200,208,40
Mvaa 204,208,44
Ta 248,22,24576
Ta 250,22,25600
Mvaa 208,212,32
Mvaa 212,212,36
Mvaa 216,212,40
Ta 252,23,24576
Ta 254,23,25600
Mvaa 220,212,44
Mvaa 224,216,32
Mvaa 228,216,36
Mvaa 232,216,40
Mvaa 236,216,44
Mvaa 240,220,32
Mvaa 244,220,36
Mvaa 248,220,40
Mvaa 252,220,44
s_waitcnt vmcnt(20) lgkmcnt(0)
s_barrier
Mvaa 128,224,48
Mvaa 132,224,52
Ta 192,16,32768
Ta 194,16,33792
Mvaa 136,224,56
Mvaa 140,224,60
Mvaa 144,228,48
Ta 196,17,32768
Ta 198,17,33792
Mvaa 148,228,52
Mvaa 152,228,56
Mvaa 156,228,60
Ta 200,18,32768
Ta 202,18,33792
Mvaa 160,232,48
Mvaa 164,232,52
Mvaa 168,232,56
Ta 204,19,32768
Ta 206,19,33792
Mvaa 172,232,60
Mvaa 176,236,48
Mvaa 180,236,52
Ta 208,20,32768
Ta 210,20,33792
Mvaa 184,236,56
Mvaa 188,236,60
Mvaa 192,240,48
s_waitcnt lgkmcnt(6)
Ta 212,21,32768
Ta 214,21,33792
Mvaa 196,240,52
Mvaa 200,240,56
Mvaa 204,240,60
Ta 216,22,32768
Ta 218,22,33792
Mvaa 208,244,48
Mvaa 212,244,52
Mvaa 216,244,56
Ta 220,23,32768
Ta 222,23,33792
Mvaa 220,244,60
Mvaa 224,248,48
Mvaa 228,248,52
Mvaa 232,248,56
Mvaa 236,248,60
Mvaa 240,252,48
Mvaa 244,252,52
Mvaa 248,252,56
Mvaa 252,252,60
s_waitcnt vmcnt(16) lgkmcnt(0)
Mvaa 128,192,64
buffer_load_dword v12, v1, s[20:23], s6 offen sc1
Mvaa 132,192,68
Ta 224,16,40960
Ta 226,16,41984
Mvaa 136,192,72
Mvaa 140,192,76
Mvaa 144,196,64
Ta 228,17,40960
Ta 230,17,41984
Mvaa 148,196,68
Mvaa 152,196,72
Mvaa 156,196,76
Ta 232,18,40960
Ta 234,18,41984
Mvaa 160,200,64
Mvaa 164,200,68
Mvaa 168,200,72
Ta 236,19,40960
Ta 238,19,41984
Mvaa 172,200,76
Mvaa 176,204,64
Mvaa 180,204,68
Ta 240,20,40960
Ta 242,20,41984
Mvaa 184,204,72
Mvaa 188,204,76
Mvaa 192,208,64
s_waitcnt lgkmcnt(6)
Ta 244,21,40960
Ta 246,21,41984
Mvaa 196,208,68
Mvaa 200,208,72
Mvaa 204,208,76
Ta 248,22,40960
Ta 250,22,41984
Mvaa 208,212,64
Mvaa 212,212,68
Mvaa 216,212,72
Ta 252,23,40960
Ta 254,23,41984
Mvaa 220,212,76
Mvaa 224,216,64
Mvaa 228,216,68
Mvaa 232,216,72
Mvaa 236,216,76
Mvaa 240,220,64
Mvaa 244,220,68
Mvaa 248,220,72
Mvaa 252,220,76
s_waitcnt vmcnt(9) lgkmcnt(0)
s_barrier
Mvaa 128,224,80
Mvaa 132,224,84
Ta 192,16,49152
Ta 194,16,50176
Mvaa 136,224,88
Mvaa 140,224,92
Mvaa 144,228,80
Ta 196,17,49152
Ta 198,17,50176
Mvaa 148,228,84
Mvaa 152,228,88
Mvaa 156,228,92
Ta 200,18,49152
Ta 202,18,50176
Mvaa 160,232,80
Mvaa 164,232,84
Mvaa 168,232,88
Ta 204,19,49152
Ta 206,19,50176
Mvaa 172,232,92
Mvaa 176,236,80
Mvaa 180,236,84
Ta 208,20,49152
Ta 210,20,50176
Mvaa 184,236,88
Mvaa 188,236,92
Mvaa 192,240,80
s_waitcnt lgkmcnt(6)
Ta 212,21,49152
Ta 214,21,50176
Mvaa 196,240,84
Mvaa 200,240,88
Mvaa 204,240,92
Ta 216,22,49152
Ta 218,22,50176
Mvaa 208,244,80
Mvaa 212,244,84
Mvaa 216,244,88
Ta 220,23,49152
Ta 222,23,50176
Mvaa 220,244,92
Mvaa 224,248,80
Mvaa 228,248,84
Mvaa 232,248,88
Mvaa 236,248,92
Mvaa 240,252,80
Mvaa 244,252,84
Mvaa 248,252,88
Mvaa 252,252,92
s_waitcnt vmcnt(5) lgkmcnt(0)
Mvaa 128,192,96
Mvaa 132,192,100
Ta 224,16,57344
Ta 226,16,58368
Mvaa 136,192,104
Mvaa 140,192,108
Mvaa 144,196,96
Ta 228,17,57344
Ta 230,17,58368
Mvaa 148,196,100
Mvaa 152,196,104
Mvaa 156,196,108
Ta 232,18,57344
Ta 234,18,58368
Mvaa 160,200,96
Mvaa 164,200,100
Mvaa 168,200,104
Ta 236,19,57344
Ta 238,19,58368
Mvaa 172,200,108
Mvaa 176,204,96
Mvaa 180,204,100
Ta 240,20,57344
Ta 242,20,58368
Mvaa 184,204,104
Mvaa 188,204,108
Mvaa 192,208,96
s_waitcnt lgkmcnt(6)
Ta 244,21,57344
Ta 246,21,58368
Mvaa 196,208,100
Mvaa 200,208,104
Mvaa 204,208,108
Ta 248,22,57344
Ta 250,22,58368
Mvaa 208,212,96
Mvaa 212,212,100
Mvaa 216,212,104
Ta 252,23,57344
Ta 254,23,58368
Mvaa 220,212,108
Mvaa 224,216,96
Mvaa 228,216,100
Mvaa 232,216,104
Mvaa 236,216,108
Mvaa 240,220,96
Mvaa 244,220,100
Mvaa 248,220,104
Mvaa 252,220,108
s_waitcnt vmcnt(0) lgkmcnt(0)
s_cmp_lg_u32 s32, 0
s_cbranch_scc1 L_spinBr
v_cmp_ne_u32 vcc, 1, v12
s_cbranch_vccnz L_spinB
L_spinBr:
s_barrier
Mvaa 128,224,112
s_add_u32 m0, s44, 0
s_mov_b32 s7, 0
Mvaa 132,224,116
buffer_load_dwordx4 v4, s[12:15], s7 offen offset:0 sc1 lds
Mvaa 136,224,120
buffer_load_dwordx4 v4, s[12:15], s7 offen offset:1024 sc1 lds
Mvaa 140,224,124
buffer_load_dwordx4 v4, s[12:15], s7 offen offset:2048 sc1 lds
Mvaa 144,228,112
buffer_load_dwordx4 v4, s[12:15], s7 offen offset:3072 sc1 lds
Mvaa 148,228,116
s_add_u32 m0, s44, 16384
s_mov_b32 s7, 17408
Mvaa 152,228,120
buffer_load_dwordx4 v4, s[12:15], s7 offen offset:0 sc1 lds
Mvaa 156,228,124
buffer_load_dwordx4 v4, s[12:15], s7 offen offset:1024 sc1 lds
Mvaa 160,232,112
buffer_load_dwordx4 v4, s[12:15], s7 offen offset:2048 sc1 lds
Mvaa 164,232,116
buffer_load_dwordx4 v4, s[12:15], s7 offen offset:3072 sc1 lds
Mvaa 168,232,120
s_add_u32 m0, s44, 32768
s_mov_b32 s7, 34816
Mvaa 172,232,124
buffer_load_dwordx4 v4, s[12:15], s7 offen offset:0 sc1 lds
Mvaa 176,236,112
buffer_load_dwordx4 v4, s[12:15], s7 offen offset:1024 sc1 lds
Mvaa 180,236,116
buffer_load_dwordx4 v4, s[12:15], s7 offen offset:2048 sc1 lds
Mvaa 184,236,120
buffer_load_dwordx4 v4, s[12:15], s7 offen offset:3072 sc1 lds
Mvaa 188,236,124
s_add_u32 m0, s44, 49152
s_mov_b32 s7, 52224
Mvaa 192,240,112
buffer_load_dwordx4 v4, s[12:15], s7 offen offset:0 sc1 lds
Mvaa 196,240,116
buffer_load_dwordx4 v4, s[12:15], s7 offen offset:1024 sc1 lds
Mvaa 200,240,120
buffer_load_dwordx4 v4, s[12:15], s7 offen offset:2048 sc1 lds
Mvaa 204,240,124
buffer_load_dwordx4 v4, s[12:15], s7 offen offset:3072 sc1 lds
Mvaa 208,244,112
s_add_u32 m0, s44, 65536
s_mov_b32 s7, 69632
Mvaa 212,244,116
buffer_load_dwordx4 v4, s[12:15], s7 offen offset:0 sc1 lds
Mvaa 216,244,120
buffer_load_dwordx4 v4, s[12:15], s7 offen offset:1024 sc1 lds
Mvaa 220,244,124
buffer_load_dwordx4 v4, s[12:15], s7 offen offset:2048 sc1 lds
Mvaa 224,248,112
buffer_load_dwordx4 v4, s[12:15], s7 offen offset:3072 sc1 lds
Mvaa 228,248,116
s_add_u32 m0, s44, 81920
s_mov_b32 s7, 87040
Mvaa 232,248,120
buffer_load_dwordx4 v4, s[12:15], s7 offen offset:0 sc1 lds
Mvaa 236,248,124
buffer_load_dwordx4 v4, s[12:15], s7 offen offset:1024 sc1 lds
Mvaa 240,252,112
buffer_load_dwordx4 v4, s[12:15], s7 offen offset:2048 sc1 lds
Mvaa 244,252,116
buffer_load_dwordx4 v4, s[12:15], s7 offen offset:3072 sc1 lds
Mvaa 248,252,120
s_add_u32 m0, s44, 98304
s_mov_b32 s7, 104448
Mvaa 252,252,124
buffer_load_dwordx4 v4, s[12:15], s7 offen offset:0 sc1 lds
s_mov_b32 s4, 1040356334
s_mov_b32 s5, s4
v_pk_mul_f32 v[128:129], v[128:129], s[4:5]
v_pk_mul_f32 v[130:131], v[130:131], s[4:5]
Vc 128,128,129
Vc 129,130,131
Aw 128,128
Aw 129,129
v_pk_mul_f32 v[144:145], v[144:145], s[4:5]
v_pk_mul_f32 v[146:147], v[146:147], s[4:5]
Vc 144,144,145
Vc 145,146,147
Aw 130,144
Aw 131,145
v_pk_mul_f32 v[160:161], v[160:161], s[4:5]
v_pk_mul_f32 v[162:163], v[162:163], s[4:5]
Vc 160,160,161
Vc 161,162,163
Aw 132,160
Aw 133,161
v_pk_mul_f32 v[176:177], v[176:177], s[4:5]
v_pk_mul_f32 v[178:179], v[178:179], s[4:5]
Vc 176,176,177
Vc 177,178,179
Aw 134,176
Aw 135,177
v_pk_mul_f32 v[192:193], v[192:193], s[4:5]
v_pk_mul_f32 v[194:195], v[194:195], s[4:5]
Vc 192,192,193
Vc 193,194,195
Aw 136,192
Aw 137,193
v_pk_mul_f32 v[208:209], v[208:209], s[4:5]
v_pk_mul_f32 v[210:211], v[210:211], s[4:5]
Vc 208,208,209
Vc 209,210,211
Aw 138,208
Aw 139,209
v_pk_mul_f32 v[224:225], v[224:225], s[4:5]
v_pk_mul_f32 v[226:227], v[226:227], s[4:5]
Vc 224,224,225
Vc 225,226,227
Aw 140,224
Aw 141,225
v_pk_mul_f32 v[240:241], v[240:241], s[4:5]
v_pk_mul_f32 v[242:243], v[242:243], s[4:5]
Vc 240,240,241
Vc 241,242,243
Aw 142,240
Aw 143,241
buffer_load_dwordx4 v4, s[12:15], s7 offen offset:1024 sc1 lds
buffer_load_dwordx4 v4, s[12:15], s7 offen offset:2048 sc1 lds
buffer_load_dwordx4 v4, s[12:15], s7 offen offset:3072 sc1 lds
v_pk_mul_f32 v[132:133], v[132:133], s[4:5]
v_pk_mul_f32 v[134:135], v[134:135], s[4:5]
Vc 132,132,133
Vc 133,134,135
Aw 144,132
Aw 145,133
v_pk_mul_f32 v[148:149], v[148:149], s[4:5]
v_pk_mul_f32 v[150:151], v[150:151], s[4:5]
Vc 148,148,149
Vc 149,150,151
Aw 146,148
Aw 147,149
v_pk_mul_f32 v[164:165], v[164:165], s[4:5]
v_pk_mul_f32 v[166:167], v[166:167], s[4:5]
Vc 164,164,165
Vc 165,166,167
Aw 148,164
Aw 149,165
v_pk_mul_f32 v[180:181], v[180:181], s[4:5]
v_pk_mul_f32 v[182:183], v[182:183], s[4:5]
Vc 180,180,181
Vc 181,182,183
Aw 150,180
Aw 151,181
v_pk_mul_f32 v[196:197], v[196:197], s[4:5]
v_pk_mul_f32 v[198:199], v[198:199], s[4:5]
Vc 196,196,197
Vc 197,198,199
Aw 152,196
Aw 153,197
v_pk_mul_f32 v[212:213], v[212:213], s[4:5]
v_pk_mul_f32 v[214:215], v[214:215], s[4:5]
Vc 212,212,213
Vc 213,214,215
Aw 154,212
Aw 155,213
v_pk_mul_f32 v[228:229], v[228:229], s[4:5]
v_pk_mul_f32 v[230:231], v[230:231], s[4:5]
Vc 228,228,229
Vc 229,230,231
Aw 156,228
Aw 157,229
v_pk_mul_f32 v[244:245], v[244:245], s[4:5]
v_pk_mul_f32 v[246:247], v[246:247], s[4:5]
Vc 244,244,245
Vc 245,246,247
Aw 158,244
Aw 159,245
v_pk_mul_f32 v[136:137], v[136:137], s[4:5]
v_pk_mul_f32 v[138:139], v[138:139], s[4:5]
Vc 136,136,137
Vc 137,138,139
Aw 160,136
Aw 161,137
v_pk_mul_f32 v[152:153], v[152:153], s[4:5]
v_pk_mul_f32 v[154:155], v[154:155], s[4:5]
Vc 152,152,153
Vc 153,154,155
Aw 162,152
Aw 163,153
v_pk_mul_f32 v[168:169], v[168:169], s[4:5]
v_pk_mul_f32 v[170:171], v[170:171], s[4:5]
Vc 168,168,169
Vc 169,170,171
Aw 164,168
Aw 165,169
v_pk_mul_f32 v[184:185], v[184:185], s[4:5]
v_pk_mul_f32 v[186:187], v[186:187], s[4:5]
Vc 184,184,185
Vc 185,186,187
Aw 166,184
Aw 167,185
v_pk_mul_f32 v[200:201], v[200:201], s[4:5]
v_pk_mul_f32 v[202:203], v[202:203], s[4:5]
Vc 200,200,201
Vc 201,202,203
Aw 168,200
Aw 169,201
v_pk_mul_f32 v[216:217], v[216:217], s[4:5]
v_pk_mul_f32 v[218:219], v[218:219], s[4:5]
Vc 216,216,217
Vc 217,218,219
Aw 170,216
Aw 171,217
v_pk_mul_f32 v[232:233], v[232:233], s[4:5]
v_pk_mul_f32 v[234:235], v[234:235], s[4:5]
Vc 232,232,233
Vc 233,234,235
Aw 172,232
Aw 173,233
v_pk_mul_f32 v[248:249], v[248:249], s[4:5]
v_pk_mul_f32 v[250:251], v[250:251], s[4:5]
Vc 248,248,249
Vc 249,250,251
Aw 174,248
Aw 175,249
v_pk_mul_f32 v[140:141], v[140:141], s[4:5]
v_pk_mul_f32 v[142:143], v[142:143], s[4:5]
Vc 140,140,141
Vc 141,142,143
Aw 176,140
Aw 177,141
v_pk_mul_f32 v[156:157], v[156:157], s[4:5]
v_pk_mul_f32 v[158:159], v[158:159], s[4:5]
Vc 156,156,157
Vc 157,158,159
Aw 178,156
Aw 179,157
v_pk_mul_f32 v[172:173], v[172:173], s[4:5]
v_pk_mul_f32 v[174:175], v[174:175], s[4:5]
Vc 172,172,173
Vc 173,174,175
Aw 180,172
Aw 181,173
v_pk_mul_f32 v[188:189], v[188:189], s[4:5]
v_pk_mul_f32 v[190:191], v[190:191], s[4:5]
Vc 188,188,189
Vc 189,190,191
Aw 182,188
Aw 183,189
v_pk_mul_f32 v[204:205], v[204:205], s[4:5]
v_pk_mul_f32 v[206:207], v[206:207], s[4:5]
Vc 204,204,205
Vc 205,206,207
Aw 184,204
Aw 185,205
v_pk_mul_f32 v[220:221], v[220:221], s[4:5]
v_pk_mul_f32 v[222:223], v[222:223], s[4:5]
Vc 220,220,221
Vc 221,222,223
Aw 186,220
Aw 187,221
v_pk_mul_f32 v[236:237], v[236:237], s[4:5]
v_pk_mul_f32 v[238:239], v[238:239], s[4:5]
Vc 236,236,237
Vc 237,238,239
Aw 188,236
Aw 189,237
v_pk_mul_f32 v[252:253], v[252:253], s[4:5]
v_pk_mul_f32 v[254:255], v[254:255], s[4:5]
Vc 252,252,253
Vc 253,254,255
Aw 190,252
Aw 191,253
v_mov_b32 v16, 0x3f803f80
v_mov_b32 v17, 0x3f803f80
v_mov_b32 v18, 0x3f803f80
v_mov_b32 v19, 0x3f803f80
v_mov_b32 v20, 0xff800000
s_mov_b32 s24, s60
s_mov_b32 s25, s61
s_mov_b32 s26, s62
s_lshl_b32 s3, s34, 5
s_add_u32 s3, s3, s33
s_mul_i32 s6, s3, 2341
s_lshr_b32 s6, s6, 16
s_mul_i32 s47, s6, 28
s_sub_u32 s4, s3, s47
s_mul_i32 s5, s6, 917504
s_lshl_b32 s47, s4, 8
s_add_u32 s5, s5, s47
s_sub_u32 s55, 15, s34
s_sub_u32 s45, s36, 3
s_sub_u32 s46, s35, 3
s_max_i32 s46, s46, 0
s_mov_b32 s53, s44
s_add_u32 s54, s44, 65536
s_waitcnt vmcnt(16)
s_barrier
Ra 192,2,0
Ra 196,2,1024
Ra 200,2,2048
Ra 204,2,3072
Ra 208,2,4096
Ra 212,2,5120
Ra 216,2,6144
Ra 220,2,7168
s_waitcnt lgkmcnt(4)
Zvaa 128,192,128
Ra 224,2,8192
v_accvgpr_write_b32 a0, 0
Mvaa 128,196,132
Ra 228,2,9216
v_accvgpr_write_b32 a1, 0
Mvaa 128,200,136
Ra 232,2,10240
v_accvgpr_write_b32 a2, 0
Mvaa 128,204,140
Ra 236,2,11264
v_accvgpr_write_b32 a3, 0
Zvaa 144,192,144
v_accvgpr_write_b32 a4, 0
v_accvgpr_write_b32 a5, 0
Mvaa 144,196,148
v_accvgpr_write_b32 a6, 0
v_accvgpr_write_b32 a7, 0
Mvaa 144,200,152
v_accvgpr_write_b32 a8, 0
v_accvgpr_write_b32 a9, 0
Mvaa 144,204,156
v_accvgpr_write_b32 a10, 0
v_accvgpr_write_b32 a11, 0
Zvaa 160,192,160
v_accvgpr_write_b32 a12, 0
v_accvgpr_write_b32 a13, 0
Mvaa 160,196,164
v_accvgpr_write_b32 a14, 0
v_accvgpr_write_b32 a15, 0
Mvaa 160,200,168
v_accvgpr_write_b32 a16, 0
v_accvgpr_write_b32 a17, 0
Mvaa 160,204,172
v_accvgpr_write_b32 a18, 0
v_accvgpr_write_b32 a19, 0
Zvaa 176,192,176
v_accvgpr_write_b32 a20, 0
v_accvgpr_write_b32 a21, 0
Mvaa 176,196,180
v_accvgpr_write_b32 a22, 0
v_accvgpr_write_b32 a23, 0
Mvaa 176,200,184
v_accvgpr_write_b32 a24, 0
v_accvgpr_write_b32 a25, 0
Mvaa 176,204,188
s_waitcnt lgkmcnt(4)
v_accvgpr_write_b32 a26, 0
v_accvgpr_write_b32 a27, 0
Zvaa 132,208,128
Ra 240,2,12288
v_accvgpr_write_b32 a28, 0
Mvaa 132,212,132
Ra 244,2,13312
v_accvgpr_write_b32 a29, 0
Mvaa 132,216,136
Ra 248,2,14336
v_accvgpr_write_b32 a30, 0
Mvaa 132,220,140
Ra 252,2,15360
v_accvgpr_write_b32 a31, 0
Zvaa 148,208,144
v_accvgpr_write_b32 a32, 0
v_accvgpr_write_b32 a33, 0
Mvaa 148,212,148
v_accvgpr_write_b32 a34, 0
v_accvgpr_write_b32 a35, 0
Mvaa 148,216,152
v_accvgpr_write_b32 a36, 0
v_accvgpr_write_b32 a37, 0
Mvaa 148,220,156
v_accvgpr_write_b32 a38, 0
v_accvgpr_write_b32 a39, 0
Zvaa 164,208,160
v_accvgpr_write_b32 a40, 0
v_accvgpr_write_b32 a41, 0
Mvaa 164,212,164
v_accvgpr_write_b32 a42, 0
v_accvgpr_write_b32 a43, 0
Mvaa 164,216,168
v_accvgpr_write_b32 a44, 0
v_accvgpr_write_b32 a45, 0
Mvaa 164,220,172
v_accvgpr_write_b32 a46, 0
v_accvgpr_write_b32 a47, 0
Zvaa 180,208,176
v_accvgpr_write_b32 a48, 0
v_accvgpr_write_b32 a49, 0
Mvaa 180,212,180
v_accvgpr_write_b32 a50, 0
v_accvgpr_write_b32 a51, 0
Mvaa 180,216,184
v_accvgpr_write_b32 a52, 0
v_accvgpr_write_b32 a53, 0
Mvaa 180,220,188
s_waitcnt lgkmcnt(4)
v_accvgpr_write_b32 a54, 0
v_accvgpr_write_b32 a55, 0
Zvaa 136,224,128
Ra 192,2,32768
v_accvgpr_write_b32 a56, 0
Mvaa 136,228,132
Ra 196,2,33792
v_accvgpr_write_b32 a57, 0
Mvaa 136,232,136
Ra 200,2,34816
v_accvgpr_write_b32 a58, 0
Mvaa 136,236,140
Ra 204,2,35840
v_accvgpr_write_b32 a59, 0
Zvaa 152,224,144
v_accvgpr_write_b32 a60, 0
v_accvgpr_write_b32 a61, 0
Mvaa 152,228,148
v_accvgpr_write_b32 a62, 0
v_accvgpr_write_b32 a63, 0
Mvaa 152,232,152
v_accvgpr_write_b32 a64, 0
v_accvgpr_write_b32 a65, 0
Mvaa 152,236,156
v_accvgpr_write_b32 a66, 0
v_accvgpr_write_b32 a67, 0
Zvaa 168,224,160
v_accvgpr_write_b32 a68, 0
v_accvgpr_write_b32 a69, 0
Mvaa 168,228,164
v_accvgpr_write_b32 a70, 0
v_accvgpr_write_b32 a71, 0
Mvaa 168,232,168
v_accvgpr_write_b32 a72, 0
v_accvgpr_write_b32 a73, 0
Mvaa 168,236,172
v_accvgpr_write_b32 a74, 0
v_accvgpr_write_b32 a75, 0
Zvaa 184,224,176
v_accvgpr_write_b32 a76, 0
v_accvgpr_write_b32 a77, 0
Mvaa 184,228,180
v_accvgpr_write_b32 a78, 0
v_accvgpr_write_b32 a79, 0
Mvaa 184,232,184
v_accvgpr_write_b32 a80, 0
v_accvgpr_write_b32 a81, 0
Mvaa 184,236,188
s_waitcnt lgkmcnt(4)
v_accvgpr_write_b32 a82, 0
v_accvgpr_write_b32 a83, 0
Zvaa 140,240,128
Ra 208,2,36864
v_accvgpr_write_b32 a84, 0
Mvaa 140,244,132
Ra 212,2,37888
v_accvgpr_write_b32 a85, 0
Mvaa 140,248,136
Ra 216,2,38912
v_accvgpr_write_b32 a86, 0
Mvaa 140,252,140
Ra 220,2,39936
v_accvgpr_write_b32 a87, 0
Zvaa 156,240,144
v_accvgpr_write_b32 a88, 0
v_accvgpr_write_b32 a89, 0
Mvaa 156,244,148
v_accvgpr_write_b32 a90, 0
v_accvgpr_write_b32 a91, 0
Mvaa 156,248,152
v_accvgpr_write_b32 a92, 0
v_accvgpr_write_b32 a93, 0
Mvaa 156,252,156
v_accvgpr_write_b32 a94, 0
v_accvgpr_write_b32 a95, 0
Zvaa 172,240,160
v_accvgpr_write_b32 a96, 0
v_accvgpr_write_b32 a97, 0
Mvaa 172,244,164
v_accvgpr_write_b32 a98, 0
v_accvgpr_write_b32 a99, 0
Mvaa 172,248,168
v_accvgpr_write_b32 a100, 0
v_accvgpr_write_b32 a101, 0
Mvaa 172,252,172
v_accvgpr_write_b32 a102, 0
v_accvgpr_write_b32 a103, 0
Zvaa 188,240,176
v_accvgpr_write_b32 a104, 0
v_accvgpr_write_b32 a105, 0
Mvaa 188,244,180
v_accvgpr_write_b32 a106, 0
v_accvgpr_write_b32 a107, 0
Mvaa 188,248,184
v_accvgpr_write_b32 a108, 0
v_accvgpr_write_b32 a109, 0
Mvaa 188,252,188
v_accvgpr_write_b32 a110, 0
v_accvgpr_write_b32 a111, 0
v_accvgpr_write_b32 a112, 0
v_accvgpr_write_b32 a113, 0
v_accvgpr_write_b32 a114, 0
v_accvgpr_write_b32 a115, 0
v_accvgpr_write_b32 a116, 0
v_accvgpr_write_b32 a117, 0
v_accvgpr_write_b32 a118, 0
v_accvgpr_write_b32 a119, 0
v_accvgpr_write_b32 a120, 0
v_accvgpr_write_b32 a121, 0
v_accvgpr_write_b32 a122, 0
v_accvgpr_write_b32 a123, 0
v_accvgpr_write_b32 a124, 0
v_accvgpr_write_b32 a125, 0
v_accvgpr_write_b32 a126, 0
v_accvgpr_write_b32 a127, 0
s_barrier
s_mov_b32 s38, 139264
s_mov_b32 s39, 121856
s_mov_b32 s37, -1
s_cmp_lg_u32 s34, 0
s_cbranch_scc1 L_k2_nomask0
s_nop 7
s_add_u32 s3, s37, 1
s_lshl_b32 s3, s3, 6
v_subrev_u32 v1, s3, v6
v_cmp_gt_i32 s[56:57], -16, v1
v_cmp_gt_i32 s[58:59], -15, v1
v_cmp_gt_i32 s[60:61], -14, v1
v_cmp_gt_i32 s[62:63], -13, v1
v_cndmask_b32 v176, v176, v20, s[56:57]
v_cndmask_b32 v177, v177, v20, s[58:59]
v_cndmask_b32 v178, v178, v20, s[60:61]
v_cndmask_b32 v179, v179, v20, s[62:63]
v_cmp_gt_i32 s[56:57], 0, v1
v_cmp_gt_i32 s[58:59], 1, v1
v_cmp_gt_i32 s[60:61], 2, v1
v_cmp_gt_i32 s[62:63], 3, v1
v_cndmask_b32 v160, v160, v20, s[56:57]
v_cndmask_b32 v161, v161, v20, s[58:59]
v_cndmask_b32 v162, v162, v20, s[60:61]
v_cndmask_b32 v163, v163, v20, s[62:63]
v_cndmask_b32 v180, v180, v20, s[56:57]
v_cndmask_b32 v181, v181, v20, s[58:59]
v_cndmask_b32 v182, v182, v20, s[60:61]
v_cndmask_b32 v183, v183, v20, s[62:63]
v_cmp_gt_i32 s[56:57], 16, v1
v_cmp_gt_i32 s[58:59], 17, v1
v_cmp_gt_i32 s[60:61], 18, v1
v_cmp_gt_i32 s[62:63], 19, v1
v_cndmask_b32 v164, v164, v20, s[56:57]
v_cndmask_b32 v165, v165, v20, s[58:59]
v_cndmask_b32 v166, v166, v20, s[60:61]
v_cndmask_b32 v167, v167, v20, s[62:63]
v_cndmask_b32 v184, v184, v20, s[56:57]
v_cndmask_b32 v185, v185, v20, s[58:59]
v_cndmask_b32 v186, v186, v20, s[60:61]
v_cndmask_b32 v187, v187, v20, s[62:63]
v_cmp_gt_i32 s[56:57], 32, v1
v_cmp_gt_i32 s[58:59], 33, v1
v_cmp_gt_i32 s[60:61], 34, v1
v_cmp_gt_i32 s[62:63], 35, v1
v_cndmask_b32 v168, v168, v20, s[56:57]
v_cndmask_b32 v169, v169, v20, s[58:59]
v_cndmask_b32 v170, v170, v20, s[60:61]
v_cndmask_b32 v171, v171, v20, s[62:63]
v_cndmask_b32 v188, v188, v20, s[56:57]
v_cndmask_b32 v189, v189, v20, s[58:59]
v_cndmask_b32 v190, v190, v20, s[60:61]
v_cndmask_b32 v191, v191, v20, s[62:63]
v_cmp_gt_i32 s[56:57], 48, v1
v_cmp_gt_i32 s[58:59], 49, v1
v_cmp_gt_i32 s[60:61], 50, v1
v_cmp_gt_i32 s[62:63], 51, v1
v_cndmask_b32 v172, v172, v20, s[56:57]
v_cndmask_b32 v173, v173, v20, s[58:59]
v_cndmask_b32 v174, v174, v20, s[60:61]
v_cndmask_b32 v175, v175, v20, s[62:63]
s_nop 1
L_k2_nomask0:
s_mov_b32 s37, 0
s_nop 7
v_max3_f32 v21, v128, v129, v130
v_max3_f32 v21, v21, v131, v132
v_max3_f32 v21, v21, v133, v134
v_max3_f32 v21, v21, v135, v136
v_max3_f32 v21, v21, v137, v138
v_max3_f32 v21, v21, v139, v140
v_max3_f32 v21, v21, v141, v142
v_max_f32 v21, v21, v143
v_mov_b32 v1, v21
s_nop 1
v_permlane16_swap_b32 v1, v21
v_max_f32 v21, v21, v1
v_mov_b32 v1, v21
s_nop 1
v_permlane32_swap_b32 v1, v21
v_max_f32 v21, v21, v1
v_add_f32 v21, 0x41f80000, v21
Vs 128,128,21
Vs 129,129,21
Vs 130,130,21
Vs 131,131,21
Vs 132,132,21
Vs 133,133,21
Vs 134,134,21
Vs 135,135,21
Vs 136,136,21
Vs 137,137,21
Vs 138,138,21
Vs 139,139,21
Vs 140,140,21
Vs 141,141,21
Vs 142,142,21
Vs 143,143,21
v_sub_f32 v32, 0, v21
v_sub_f32 v33, 0, v21
v_sub_f32 v34, 0, v21
v_sub_f32 v35, 0, v21
v_max3_f32 v21, v144, v145, v146
v_max3_f32 v21, v21, v147, v148
v_max3_f32 v21, v21, v149, v150
v_max3_f32 v21, v21, v151, v152
v_max3_f32 v21, v21, v153, v154
v_max3_f32 v21, v21, v155, v156
v_max3_f32 v21, v21, v157, v158
v_max_f32 v21, v21, v159
v_mov_b32 v1, v21
s_nop 1
v_permlane16_swap_b32 v1, v21
v_max_f32 v21, v21, v1
v_mov_b32 v1, v21
s_nop 1
v_permlane32_swap_b32 v1, v21
v_max_f32 v21, v21, v1
v_add_f32 v21, 0x41f80000, v21
Vs 144,144,21
Vs 145,145,21
Vs 146,146,21
Vs 147,147,21
Vs 148,148,21
Vs 149,149,21
Vs 150,150,21
Vs 151,151,21
Vs 152,152,21
Vs 153,153,21
Vs 154,154,21
Vs 155,155,21
Vs 156,156,21
Vs 157,157,21
Vs 158,158,21
Vs 159,159,21
v_sub_f32 v36, 0, v21
v_sub_f32 v37, 0, v21
v_sub_f32 v38, 0, v21
v_sub_f32 v39, 0, v21
v_max3_f32 v21, v160, v161, v162
v_max3_f32 v21, v21, v163, v164
v_max3_f32 v21, v21, v165, v166
v_max3_f32 v21, v21, v167, v168
v_max3_f32 v21, v21, v169, v170
v_max3_f32 v21, v21, v171, v172
v_max3_f32 v21, v21, v173, v174
v_max_f32 v21, v21, v175
v_mov_b32 v1, v21
s_nop 1
v_permlane16_swap_b32 v1, v21
v_max_f32 v21, v21, v1
v_mov_b32 v1, v21
s_nop 1
v_permlane32_swap_b32 v1, v21
v_max_f32 v21, v21, v1
v_add_f32 v21, 0x41f80000, v21
Vs 160,160,21
Vs 161,161,21
Vs 162,162,21
Vs 163,163,21
Vs 164,164,21
Vs 165,165,21
Vs 166,166,21
Vs 167,167,21
Vs 168,168,21
Vs 169,169,21
Vs 170,170,21
Vs 171,171,21
Vs 172,172,21
Vs 173,173,21
Vs 174,174,21
Vs 175,175,21
v_sub_f32 v40, 0, v21
v_sub_f32 v41, 0, v21
v_sub_f32 v42, 0, v21
v_sub_f32 v43, 0, v21
v_max3_f32 v21, v176, v177, v178
v_max3_f32 v21, v21, v179, v180
v_max3_f32 v21, v21, v181, v182
v_max3_f32 v21, v21, v183, v184
v_max3_f32 v21, v21, v185, v186
v_max3_f32 v21, v21, v187, v188
v_max3_f32 v21, v21, v189, v190
v_max_f32 v21, v21, v191
v_mov_b32 v1, v21
s_nop 1
v_permlane16_swap_b32 v1, v21
v_max_f32 v21, v21, v1
v_mov_b32 v1, v21
s_nop 1
v_permlane32_swap_b32 v1, v21
v_max_f32 v21, v21, v1
v_add_f32 v21, 0x41f80000, v21
Vs 176,176,21
Vs 177,177,21
Vs 178,178,21
Vs 179,179,21
Vs 180,180,21
Vs 181,181,21
Vs 182,182,21
Vs 183,183,21
Vs 184,184,21
Vs 185,185,21
Vs 186,186,21
Vs 187,187,21
Vs 188,188,21
Vs 189,189,21
Vs 190,190,21
Vs 191,191,21
v_sub_f32 v44, 0, v21
v_sub_f32 v45, 0, v21
v_sub_f32 v46, 0, v21
v_sub_f32 v47, 0, v21
Ve 8,128
Ve 9,129
Ve 10,130
Ve 11,131
Vc 64,8,9
Ve 12,144
Ve 13,145
Vc 65,10,11
Ve 14,146
Ve 15,147
Vc 72,12,13
Ve 8,160
Ve 9,161
Vc 73,14,15
Ve 10,162
Ve 11,163
Vc 80,8,9
Ve 12,176
Ve 13,177
Vc 81,10,11
Ve 14,178
Ve 15,179
Vc 88,12,13
Ve 8,132
Ve 9,133
Vc 89,14,15
Ve 10,134
Ve 11,135
Vc 66,8,9
Ve 12,148
Ve 13,149
Vc 67,10,11
Ve 14,150
Ve 15,151
Vc 74,12,13
Ve 8,164
Ve 9,165
Vc 75,14,15
Ve 10,166
Ve 11,167
Vc 82,8,9
Ve 12,180
Ve 13,181
Vc 83,10,11
Ve 14,182
Ve 15,183
Vc 90,12,13
Vc 91,14,15
v_or_b32 v7, v64, v65
v_or3_b32 v7, v7, v72, v73
v_or3_b32 v7, v7, v80, v81
v_or3_b32 v7, v7, v88, v89
v_or3_b32 v7, v7, v66, v67
v_or3_b32 v7, v7, v74, v75
v_or3_b32 v7, v7, v82, v83
v_or3_b32 v7, v7, v90, v91
v_swap_b32 v2, v3
s_waitcnt lgkmcnt(4)
s_sub_u32 s35, s35, 1
s_sub_u32 s36, s36, 1
L_k2_wloop:
v_xor_b32 v2, 65536, v2
v_xor_b32 v3, 65536, v3
Cvaa 192,192,128,32
s_mov_b32 m0, s53
Ra 224,2,40960
v_lshl_add_u64 v[28:29], s[40:41], 0, v[28:29]
Mvaa 192,196,132
buffer_load_dwordx4 v4, s[12:15], s38 offen offset:0 sc1 lds
Mvaa 192,200,136
Ve 8,136
Mvaa 192,204,140
Ve 9,137
Cvaa 208,192,144,36
Ra 228,2,41984
Vc 68,8,9
Mvaa 208,196,148
Ve 10,138
Mvaa 208,200,152
Ve 11,139
Mvaa 208,204,156
Ra 232,2,43008
Vc 69,10,11
Cvaa 224,192,160,40
Ra 236,2,44032
v_or3_b32 v7, v7, v68, v69
Mvaa 224,196,164
Ve 12,152
Mvaa 224,200,168
Ve 13,153
Mvaa 224,204,172
Ra 240,2,45056
Vc 76,12,13
Cvaa 240,192,176,44
Ve 14,154
Mvaa 240,196,180
Ve 15,155
Mvaa 240,200,184
Ra 244,2,46080
Vc 77,14,15
Mvaa 240,204,188
s_waitcnt lgkmcnt(6)
Ra 248,2,47104
v_or3_b32 v7, v7, v76, v77
Cvaa 196,208,128,32
buffer_load_dwordx4 v4, s[12:15], s38 offen offset:1024 sc1 lds
Mvaa 196,212,132
Ve 8,168
Mvaa 196,216,136
Ve 9,169
Mvaa 196,220,140
Ra 252,2,48128
Vc 84,8,9
Cvaa 212,208,144,36
Ve 10,170
Mvaa 212,212,148
Ve 11,171
Mvaa 212,216,152
Ra 192,2,16384
Vc 85,10,11
Mvaa 212,220,156
Ra 196,2,17408
v_or3_b32 v7, v7, v84, v85
Cvaa 228,208,160,40
Ve 12,184
Mvaa 228,212,164
Ve 13,185
Mvaa 228,216,168
Ra 200,2,18432
Vc 92,12,13
Mvaa 228,220,172
Ve 14,186
Cvaa 244,208,176,44
Ve 15,187
Mvaa 244,212,180
buffer_load_dwordx4 v4, s[12:15], s38 offen offset:2048 sc1 lds
Mvaa 244,216,184
Ra 204,2,19456
Vc 93,14,15
Mvaa 244,220,188
s_waitcnt lgkmcnt(8)
Ve 8,140
Cvaa 200,224,128,32
Ra 208,2,20480
v_or3_b32 v7, v7, v92, v93
Mvaa 200,228,132
Ve 9,141
Mvaa 200,232,136
Ra 212,2,21504
Vc 70,8,9
Mvaa 200,236,140
Ve 10,142
Cvaa 216,224,144,36
Ve 11,143
Mvaa 216,228,148
Ra 216,2,22528
Vc 71,10,11
Mvaa 216,232,152
Ra 220,2,23552
v_or3_b32 v7, v7, v70, v71
Mvaa 216,236,156
Ve 12,156
Cvaa 232,224,160,40
Ve 13,157
Mvaa 232,228,164
Ve 14,158
Mvaa 232,232,168
Ve 15,159
Mvaa 232,236,172
buffer_load_dwordx4 v4, s[12:15], s38 offen offset:3072 sc1 lds
Cvaa 248,224,176,44
Ve 8,172
Mvaa 248,228,180
Ve 9,173
Mvaa 248,232,184
Vc 78,12,13
Vc 79,14,15
Mvaa 248,236,188
s_waitcnt lgkmcnt(8)
Ve 10,174
Cvaa 204,240,128,32
Ve 11,175
Mvaa 204,244,132
Vc 86,8,9
Vc 87,10,11
Mvaa 204,248,136
Ve 12,188
Mvaa 204,252,140
Ve 13,189
Cvaa 220,240,144,36
Vc 94,12,13
v_or3_b32 v7, v7, v78, v79
Mvaa 220,244,148
Ve 14,190
Mvaa 220,248,152
Ve 15,191
Mvaa 220,252,156
Vc 95,14,15
v_or3_b32 v7, v7, v86, v87
Cvaa 236,240,160,40
v_or3_b32 v7, v7, v94, v95
v_and_b32 v1, 0x40004000, v7
Mvaa 236,244,164
v_cmp_ne_u32 vcc, 0, v1
Mvaa 236,248,168
Mvaa 236,252,172
s_cmp_ge_u32 s37, s46
Cvaa 252,240,176,44
s_waitcnt vmcnt(12)
Mvaa 252,244,180
s_barrier
Mvaa 252,248,184
s_waitcnt lgkmcnt(4)
Mvaa 252,252,188
s_cbranch_vccnz L_k2_fb_we
L_k2_fbr_we:
Maav 0,192,64
s_cbranch_scc1 L_k2_mk_we
L_k2_mkr_we:
Ve 8,192
Maav 0,196,68
s_add_u32 m0, s54, 49152
Ve 9,193
Maav 32,192,72
buffer_load_dwordx4 v4, s[12:15], s39 offen offset:0 sc1 lds
Maav 32,196,76
s_add_u32 s37, s37, 1
Ra 224,2,24576
Vc 96,8,9
Maav 64,192,80
s_add_u32 s38, s38, 34816
Ve 10,194
Maav 64,196,84
Ve 11,195
Maav 96,192,88
Ra 228,2,25600
Vc 97,10,11
Maav 96,196,92
Ra 232,2,26624
v_or_b32 v7, v96, v97
Maav 4,200,64
Ve 12,208
Maav 4,204,68
Ve 13,209
Maav 36,200,72
Ra 236,2,27648
Vc 104,12,13
Maav 36,204,76
Ve 14,210
Maav 68,200,80
Ve 15,211
Maav 68,204,84
Ra 240,2,28672
Vc 105,14,15
Maav 100,200,88
Ra 244,2,29696
v_or3_b32 v7, v7, v104, v105
Maav 100,204,92
buffer_load_dwordx4 v4, s[12:15], s39 offen offset:1024 sc1 lds
Mvvv 48,16,64
Ve 8,224
Mvvv 48,16,68
s_waitcnt lgkmcnt(6)
Ve 9,225
Maav 8,208,64
Ra 248,2,30720
Vc 112,8,9
Maav 8,212,68
Ve 10,226
Maav 40,208,72
Ve 11,227
Maav 40,212,76
Ra 252,2,31744
Vc 113,10,11
Maav 72,208,80
Ra 192,3,0
v_or3_b32 v7, v7, v112, v113
Maav 72,212,84
Ve 12,240
Maav 104,208,88
Ve 13,241
Maav 104,212,92
Ra 196,3,1024
Vc 120,12,13
Maav 12,216,64
Ve 14,242
Maav 12,220,68
Ve 15,243
Maav 44,216,72
Ra 200,3,2048
Vc 121,14,15
Maav 44,220,76
buffer_load_dwordx4 v4, s[12:15], s39 offen offset:2048 sc1 lds
Maav 76,216,80
Ra 204,3,3072
v_or3_b32 v7, v7, v120, v121
Maav 76,220,84
Ve 8,196
Maav 108,216,88
Ve 9,197
Maav 108,220,92
Ve 10,198
Mvvv 52,16,72
Ve 11,199
Mvvv 52,16,76
s_waitcnt lgkmcnt(8)
Ve 12,212
Maav 16,224,64
Ra 208,3,4096
Vc 98,8,9
Maav 16,228,68
Ra 212,3,5120
Vc 99,10,11
Maav 48,224,72
Ra 216,3,6144
v_or3_b32 v7, v7, v98, v99
Maav 48,228,76
Ve 13,213
Maav 80,224,80
Ra 220,3,7168
Vc 106,12,13
Maav 80,228,84
Ve 14,214
Maav 112,224,88
buffer_load_dwordx4 v4, s[12:15], s39 offen offset:3072 sc1 lds
Maav 112,228,92
s_add_u32 s39, s39, 34816
Ve 15,215
Maav 20,232,64
Ve 8,228
Maav 20,236,68
Ve 9,229
Maav 52,232,72
Ve 10,230
Maav 52,236,76
Ve 11,231
Maav 84,232,80
Vc 107,14,15
Vc 114,8,9
Maav 84,236,84
Ve 12,244
Maav 116,232,88
Ve 13,245
Maav 116,236,92
Vc 115,10,11
Vc 122,12,13
Mvvv 56,16,80
Ve 14,246
Mvvv 56,16,84
s_waitcnt lgkmcnt(8)
Ve 15,247
Maav 24,240,64
Vc 123,14,15
v_or3_b32 v7, v7, v106, v107
Maav 24,244,68
v_or3_b32 v7, v7, v114, v115
v_or3_b32 v7, v7, v122, v123
Maav 56,240,72
global_load_dword v30, v[28:29], off
Maav 56,244,76
Maav 88,240,80
Maav 88,244,84
Maav 120,240,88
Maav 120,244,92
Maav 28,248,64
Maav 28,252,68
Maav 60,248,72
Maav 60,252,76
Maav 92,248,80
Maav 92,252,84
Maav 124,248,88
Maav 124,252,92
s_cmp_eq_u32 s37, s35
Mvvv 60,16,88
s_waitcnt lgkmcnt(4)
Mvvv 60,16,92
s_cbranch_scc1 L_k2_trans
Ve 8,200
Cvaa 128,192,128,32
s_add_u32 m0, s53, 32768
Ra 224,3,8192
v_lshl_add_u64 v[28:29], s[40:41], 0, v[28:29]
Mvaa 128,196,132
buffer_load_dwordx4 v4, s[12:15], s38 offen offset:0 sc1 lds
Mvaa 128,200,136
Ve 9,201
Mvaa 128,204,140
Ra 228,3,9216
Vc 100,8,9
Cvaa 144,192,144,36
Ve 10,202
Mvaa 144,196,148
Ve 11,203
Mvaa 144,200,152
Ra 232,3,10240
Vc 101,10,11
Mvaa 144,204,156
Ra 236,3,11264
v_or3_b32 v7, v7, v100, v101
Cvaa 160,192,160,40
Ve 12,216
Mvaa 160,196,164
Ve 13,217
Mvaa 160,200,168
Ra 240,3,12288
Vc 108,12,13
Mvaa 160,204,172
Ve 14,218
Cvaa 176,192,176,44
Ve 15,219
Mvaa 176,196,180
Ra 244,3,13312
Vc 109,14,15
Mvaa 176,200,184
Ra 248,3,14336
v_or3_b32 v7, v7, v108, v109
Mvaa 176,204,188
s_waitcnt lgkmcnt(7)
Ve 8,232
Cvaa 132,208,128,32
buffer_load_dwordx4 v4, s[12:15], s38 offen offset:1024 sc1 lds
Mvaa 132,212,132
Ve 9,233
Mvaa 132,216,136
Ra 252,3,15360
Vc 116,8,9
Mvaa 132,220,140
Ve 10,234
Cvaa 148,208,144,36
Ve 11,235
Mvaa 148,212,148
Ra 192,2,49152
Vc 117,10,11
Mvaa 148,216,152
Ra 196,2,50176
v_or3_b32 v7, v7, v116, v117
Mvaa 148,220,156
Ve 12,248
Cvaa 164,208,160,40
Ve 13,249
Mvaa 164,212,164
Ra 200,2,51200
Vc 124,12,13
Mvaa 164,216,168
Ve 14,250
Mvaa 164,220,172
Ve 15,251
Cvaa 180,208,176,44
Ra 204,2,52224
Vc 125,14,15
Mvaa 180,212,180
buffer_load_dwordx4 v4, s[12:15], s38 offen offset:2048 sc1 lds
Mvaa 180,216,184
Ve 8,204
Mvaa 180,220,188
s_waitcnt lgkmcnt(8)
Ve 9,205
Cvaa 136,224,128,32
Ra 208,2,53248
Vc 102,8,9
Mvaa 136,228,132
Ra 212,2,54272
v_or3_b32 v7, v7, v124, v125
Mvaa 136,232,136
Ve 10,206
Mvaa 136,236,140
Ve 11,207
Cvaa 152,224,144,36
Ra 216,2,55296
Vc 103,10,11
Mvaa 152,228,148
Ra 220,2,56320
v_or3_b32 v7, v7, v102, v103
Mvaa 152,232,152
Ve 12,220
Mvaa 152,236,156
Ve 13,221
Cvaa 168,224,160,40
Ve 14,222
Mvaa 168,228,164
Ve 15,223
Mvaa 168,232,168
Ve 8,236
Mvaa 168,236,172
buffer_load_dwordx4 v4, s[12:15], s38 offen offset:3072 sc1 lds
Cvaa 184,224,176,44
Ve 9,237
Mvaa 184,228,180
Vc 110,12,13
Vc 111,14,15
Mvaa 184,232,184
Ve 10,238
Mvaa 184,236,188
s_waitcnt lgkmcnt(8)
Ve 11,239
Cvaa 140,240,128,32
Vc 118,8,9
Vc 119,10,11
Mvaa 140,244,132
Ve 12,252
Mvaa 140,248,136
Ve 13,253
Mvaa 140,252,140
Vc 126,12,13
v_or3_b32 v7, v7, v110, v111
Cvaa 156,240,144,36
Ve 14,254
Mvaa 156,244,148
Ve 15,255
Mvaa 156,248,152
Vc 127,14,15
v_or3_b32 v7, v7, v118, v119
Mvaa 156,252,156
v_or3_b32 v7, v7, v126, v127
v_and_b32 v1, 0x40004000, v7
Cvaa 172,240,160,40
v_cmp_ne_u32 vcc, 0, v1
Mvaa 172,244,164
Mvaa 172,248,168
Mvaa 172,252,172
s_cmp_ge_u32 s37, s46
Cvaa 188,240,176,44
s_waitcnt vmcnt(12)
Mvaa 188,244,180
s_barrier
Mvaa 188,248,184
s_waitcnt lgkmcnt(4)
Mvaa 188,252,188
s_cbranch_vccnz L_k2_fb_wo
L_k2_fbr_wo:
Maav 0,192,96
s_cbranch_scc1 L_k2_mk_wo
L_k2_mkr_wo:
Ve 8,128
Maav 0,196,100
s_add_u32 m0, s53, 16384
Ve 9,129
Maav 32,192,104
buffer_load_dwordx4 v4, s[12:15], s39 offen offset:0 sc1 lds
Maav 32,196,108
s_add_u32 s37, s37, 1
Ra 224,2,57344
Vc 64,8,9
Maav 64,192,112
s_add_u32 s38, s38, 34816
Ve 10,130
Maav 64,196,116
s_xor_b32 s53, s53, 65536
Ve 11,131
Maav 96,192,120
s_xor_b32 s54, s54, 65536
Ra 228,2,58368
Vc 65,10,11
Maav 96,196,124
Ra 232,2,59392
v_or_b32 v7, v64, v65
Maav 4,200,96
Ve 12,144
Maav 4,204,100
Ve 13,145
Maav 36,200,104
Ra 236,2,60416
Vc 72,12,13
Maav 36,204,108
Ve 14,146
Maav 68,200,112
Ve 15,147
Maav 68,204,116
Ra 240,2,61440
Vc 73,14,15
Maav 100,200,120
Ra 244,2,62464
v_or3_b32 v7, v7, v72, v73
Maav 100,204,124
buffer_load_dwordx4 v4, s[12:15], s39 offen offset:1024 sc1 lds
Mvvv 48,16,96
Ve 8,160
Mvvv 48,16,100
s_waitcnt lgkmcnt(6)
Ve 9,161
Maav 8,208,96
Ra 248,2,63488
Vc 80,8,9
Maav 8,212,100
Ve 10,162
Maav 40,208,104
Ve 11,163
Maav 40,212,108
Ra 252,2,64512
Vc 81,10,11
Maav 72,208,112
Ra 192,3,32768
v_or3_b32 v7, v7, v80, v81
Maav 72,212,116
Ve 12,176
Maav 104,208,120
Ve 13,177
Maav 104,212,124
Ra 196,3,33792
Vc 88,12,13
Maav 12,216,96
Ve 14,178
Maav 12,220,100
Ve 15,179
Maav 44,216,104
Ra 200,3,34816
Vc 89,14,15
Maav 44,220,108
buffer_load_dwordx4 v4, s[12:15], s39 offen offset:2048 sc1 lds
Maav 76,216,112
Ra 204,3,35840
v_or3_b32 v7, v7, v88, v89
Maav 76,220,116
Ve 8,132
Maav 108,216,120
Ve 9,133
Maav 108,220,124
Ve 10,134
Mvvv 52,16,104
Ve 11,135
Mvvv 52,16,108
s_waitcnt lgkmcnt(8)
Ve 12,148
Maav 16,224,96
Ra 208,3,36864
Vc 66,8,9
Maav 16,228,100
Ra 212,3,37888
Vc 67,10,11
Maav 48,224,104
Ra 216,3,38912
v_or3_b32 v7, v7, v66, v67
Maav 48,228,108
Ve 13,149
Maav 80,224,112
Ra 220,3,39936
Vc 74,12,13
Maav 80,228,116
Ve 14,150
Maav 112,224,120
buffer_load_dwordx4 v4, s[12:15], s39 offen offset:3072 sc1 lds
Maav 112,228,124
s_add_u32 s39, s39, 34816
Ve 15,151
Maav 20,232,96
Ve 8,164
Maav 20,236,100
Ve 9,165
Maav 52,232,104
Ve 10,166
Maav 52,236,108
Ve 11,167
Maav 84,232,112
Vc 75,14,15
Vc 82,8,9
Maav 84,236,116
Ve 12,180
Maav 116,232,120
Ve 13,181
Maav 116,236,124
Vc 83,10,11
Vc 90,12,13
Mvvv 56,16,112
Ve 14,182
Mvvv 56,16,116
s_waitcnt lgkmcnt(8)
Ve 15,183
Maav 24,240,96
Vc 91,14,15
v_or3_b32 v7, v7, v74, v75
Maav 24,244,100
v_or3_b32 v7, v7, v82, v83
v_or3_b32 v7, v7, v90, v91
Maav 56,240,104
global_load_dword v30, v[28:29], off
Maav 56,244,108
Maav 88,240,112
Maav 88,244,116
Maav 120,240,120
Maav 120,244,124
Maav 28,248,96
Maav 28,252,100
Maav 60,248,104
Maav 60,252,108
Maav 92,248,112
Maav 92,252,116
Maav 124,248,120
Maav 124,252,124
Mvvv 60,16,120
s_waitcnt lgkmcnt(4)
Mvvv 60,16,124
s_branch L_k2_wloop
L_k2_trans:
Ve 8,200
Cvaa 128,192,128,32
s_add_u32 m0, s53, 32768
Ve 9,201
Mvaa 128,196,132
buffer_load_dwordx4 v4, s[12:15], s38 offen offset:0 sc1 lds
Mvaa 128,200,136
Ra 224,3,8192
Vc 100,8,9
Mvaa 128,204,140
Ve 10,202
Cvaa 144,192,144,36
Ve 11,203
Mvaa 144,196,148
Ra 228,3,9216
Vc 101,10,11
Mvaa 144,200,152
Ra 232,3,10240
v_or3_b32 v7, v7, v100, v101
Mvaa 144,204,156
s_waitcnt lgkmcnt(3)
Ra 236,3,11264
Ra 240,3,12288
Cvaa 132,208,128,32
buffer_load_dwordx4 v4, s[12:15], s38 offen offset:1024 sc1 lds
Mvaa 132,212,132
Ve 12,216
Mvaa 132,216,136
Ve 13,217
Mvaa 132,220,140
Ra 244,3,13312
Vc 108,12,13
Cvaa 148,208,144,36
Ve 14,218
Mvaa 148,212,148
buffer_load_dwordx4 v4, s[12:15], s38 offen offset:2048 sc1 lds
Mvaa 148,216,152
Ve 15,219
Mvaa 148,220,156
s_waitcnt lgkmcnt(2)
Ra 248,3,14336
Ra 252,3,15360
Cvaa 136,224,128,32
Ra 192,2,49152
Vc 109,14,15
Mvaa 136,228,132
Ra 196,2,50176
v_or3_b32 v7, v7, v108, v109
Mvaa 136,232,136
Ve 8,232
Mvaa 136,236,140
buffer_load_dwordx4 v4, s[12:15], s38 offen offset:3072 sc1 lds
Cvaa 152,224,144,36
Ve 9,233
Mvaa 152,228,148
Ra 200,2,51200
Vc 116,8,9
Mvaa 152,232,152
Ve 10,234
Mvaa 152,236,156
s_waitcnt lgkmcnt(3)
Ra 204,2,52224
Ra 208,2,53248
Cvaa 140,240,128,32
Ve 11,235
Mvaa 140,244,132
Ra 212,2,54272
Vc 117,10,11
Mvaa 140,248,136
Ra 216,2,55296
v_or3_b32 v7, v7, v116, v117
Mvaa 140,252,140
s_cmp_ge_u32 s37, s45
Ve 12,248
Cvaa 156,240,144,36
s_waitcnt vmcnt(12)
Ve 13,249
Mvaa 156,244,148
s_barrier
Ra 220,2,56320
Vc 124,12,13
Mvaa 156,248,152
s_waitcnt lgkmcnt(4)
Ve 14,250
Ve 15,251
Ve 8,204
Ve 9,205
Ve 10,206
Ve 11,207
Ve 12,220
Ve 13,221
Vc 125,14,15
Ve 14,222
Ve 15,223
Vc 102,8,9
Ve 8,236
Ve 9,237
Vc 103,10,11
Ve 10,238
Ve 11,239
Vc 110,12,13
Ve 12,252
Ve 13,253
Vc 111,14,15
Ve 14,254
Ve 15,255
Vc 118,8,9
Vc 119,10,11
Vc 126,12,13
Vc 127,14,15
v_or3_b32 v7, v7, v124, v125
v_or3_b32 v7, v7, v102, v103
v_or3_b32 v7, v7, v110, v111
v_or3_b32 v7, v7, v118, v119
v_or3_b32 v7, v7, v126, v127
v_and_b32 v1, 0x40004000, v7
v_cmp_ne_u32 vcc, 0, v1
Mvaa 156,252,156
s_cbranch_vccnz L_k2_fb_tr
L_k2_fbr_tr:
Maav 0,192,96
s_cbranch_scc1 L_k2_mk_tr
L_k2_mkr_tr:
Ve 8,128
Maav 0,196,100
s_add_u32 m0, s53, 16384
Ve 9,129
Maav 32,192,104
buffer_load_dwordx4 v4, s[12:15], s39 offen offset:0 sc1 lds
Maav 32,196,108
s_add_u32 s37, s37, 1
Ra 224,2,57344
Vc 64,8,9
Maav 64,192,112
s_add_u32 s38, s38, 34816
Ve 10,130
Maav 64,196,116
s_xor_b32 s53, s53, 65536
Ve 11,131
Maav 96,192,120
s_xor_b32 s54, s54, 65536
Ra 228,2,58368
Vc 65,10,11
Maav 96,196,124
Ra 232,2,59392
v_or_b32 v7, v64, v65
Maav 4,200,96
Ve 12,144
Maav 4,204,100
Ve 13,145
Maav 36,200,104
Ra 236,2,60416
Vc 72,12,13
Maav 36,204,108
Ve 14,146
Maav 68,200,112
Ve 15,147
Maav 68,204,116
Ra 240,2,61440
Vc 73,14,15
Maav 100,200,120
Ra 244,2,62464
v_or3_b32 v7, v7, v72, v73
Maav 100,204,124
Ve 8,132
Mvvv 48,16,96
Ve 9,133
Mvvv 48,16,100
s_waitcnt lgkmcnt(6)
Ra 248,2,63488
Vc 66,8,9
Maav 8,208,96
Ve 10,134
Maav 8,212,100
buffer_load_dwordx4 v4, s[12:15], s39 offen offset:1024 sc1 lds
Maav 40,208,104
Ve 11,135
Maav 40,212,108
Ra 252,2,64512
Vc 67,10,11
Maav 72,208,112
Ra 192,3,32768
v_or3_b32 v7, v7, v66, v67
Maav 72,212,116
Ve 12,148
Maav 104,208,120
Ve 13,149
Maav 104,212,124
Ra 196,3,33792
Vc 74,12,13
Maav 12,216,96
Ve 14,150
Maav 12,220,100
Ve 15,151
Maav 44,216,104
Ra 200,3,34816
Vc 75,14,15
Maav 44,220,108
Ra 204,3,35840
v_or3_b32 v7, v7, v74, v75
Maav 76,216,112
Ve 8,136
Maav 76,220,116
Maav 108,216,120
Maav 108,220,124
Mvvv 52,16,104
Mvvv 52,16,108
s_waitcnt lgkmcnt(8)
Maav 16,224,96
buffer_load_dwordx4 v4, s[12:15], s39 offen offset:2048 sc1 lds
Maav 16,228,100
Ra 208,3,36864
Ra 212,3,37888
Maav 48,224,104
Ra 216,3,38912
Ra 220,3,39936
Maav 48,228,108
Maav 80,224,112
Maav 80,228,116
Maav 112,224,120
Maav 112,228,124
Maav 20,232,96
Maav 20,236,100
Maav 52,232,104
Maav 52,236,108
Maav 84,232,112
Maav 84,236,116
Maav 116,232,120
Maav 116,236,124
Mvvv 56,16,112
Mvvv 56,16,116
s_waitcnt lgkmcnt(8)
Maav 24,240,96
buffer_load_dwordx4 v4, s[12:15], s39 offen offset:3072 sc1 lds
Maav 24,244,100
s_add_u32 s39, s39, 34816
Maav 56,240,104
Maav 56,244,108
Maav 88,240,112
Maav 88,244,116
Maav 120,240,120
Maav 120,244,124
Maav 28,248,96
Maav 28,252,100
Maav 60,248,104
Maav 60,252,108
Maav 92,248,112
Maav 92,252,116
Maav 124,248,120
Maav 124,252,124
Mvvv 60,16,120
s_waitcnt lgkmcnt(4)
Mvvv 60,16,124
s_waitcnt vmcnt(8)
s_lshl_b32 s3, s34, 20
s_lshl_b32 s47, s33, 15
s_add_u32 s3, s3, s47
s_lshl_b32 s47, s32, 11
s_add_u32 s3, s3, s47
v_lshlrev_b32 v23, 4, v0
v_rcp_f32 v21, v56
v_rcp_f32 v22, v60
Ar 240,64
Ar 241,65
Ar 242,66
Ar 243,67
Ar 244,68
Ar 245,69
Ar 246,70
Ar 247,71
Vm 240,240,21
Vm 241,241,21
Vm 242,242,21
Vm 243,243,21
Vm 244,244,21
Vm 245,245,21
Vm 246,246,21
Vm 247,247,21
Vc 24,240,241
Vc 25,242,243
Vc 26,244,245
Vc 27,246,247
buffer_store_dwordx4 v[24:27], v23, s[16:19], s3 offen offset:0 sc1
Ar 240,96
Ar 241,97
Ar 242,98
Ar 243,99
Ar 244,100
Ar 245,101
Ar 246,102
Ar 247,103
Vm 240,240,22
Vm 241,241,22
Vm 242,242,22
Vm 243,243,22
Vm 244,244,22
Vm 245,245,22
Vm 246,246,22
Vm 247,247,22
Vc 28,240,241
Vc 29,242,243
Vc 30,244,245
Vc 31,246,247
buffer_store_dwordx4 v[28:31], v23, s[16:19], s3 offen offset:1024 sc1
s_add_u32 s3, s3, 8192
Ar 240,72
Ar 241,73
Ar 242,74
Ar 243,75
Ar 244,76
Ar 245,77
Ar 246,78
Ar 247,79
Vm 240,240,21
Vm 241,241,21
Vm 242,242,21
Vm 243,243,21
Vm 244,244,21
Vm 245,245,21
Vm 246,246,21
Vm 247,247,21
Vc 24,240,241
Vc 25,242,243
Vc 26,244,245
Vc 27,246,247
buffer_store_dwordx4 v[24:27], v23, s[16:19], s3 offen offset:0 sc1
Ar 240,104
Ar 241,105
Ar 242,106
Ar 243,107
Ar 244,108
Ar 245,109
Ar 246,110
Ar 247,111
Vm 240,240,22
Vm 241,241,22
Vm 242,242,22
Vm 243,243,22
Vm 244,244,22
Vm 245,245,22
Vm 246,246,22
Vm 247,247,22
Vc 28,240,241
Vc 29,242,243
Vc 30,244,245
Vc 31,246,247
buffer_store_dwordx4 v[28:31], v23, s[16:19], s3 offen offset:1024 sc1
s_add_u32 s3, s3, 8192
Ar 240,80
Ar 241,81
Ar 242,82
Ar 243,83
Ar 244,84
Ar 245,85
Ar 246,86
Ar 247,87
Vm 240,240,21
Vm 241,241,21
Vm 242,242,21
Vm 243,243,21
Vm 244,244,21
Vm 245,245,21
Vm 246,246,21
Vm 247,247,21
Vc 24,240,241
Vc 25,242,243
Vc 26,244,245
Vc 27,246,247
buffer_store_dwordx4 v[24:27], v23, s[16:19], s3 offen offset:0 sc1
Ar 240,112
Ar 241,113
Ar 242,114
Ar 243,115
Ar 244,116
Ar 245,117
Ar 246,118
Ar 247,119
Vm 240,240,22
Vm 241,241,22
Vm 242,242,22
Vm 243,243,22
Vm 244,244,22
Vm 245,245,22
Vm 246,246,22
Vm 247,247,22
Vc 28,240,241
Vc 29,242,243
Vc 30,244,245
Vc 31,246,247
buffer_store_dwordx4 v[28:31], v23, s[16:19], s3 offen offset:1024 sc1
s_add_u32 s3, s3, 8192
Ar 240,88
Ar 241,89
Ar 242,90
Ar 243,91
Ar 244,92
Ar 245,93
Ar 246,94
Ar 247,95
Vm 240,240,21
Vm 241,241,21
Vm 242,242,21
Vm 243,243,21
Vm 244,244,21
Vm 245,245,21
Vm 246,246,21
Vm 247,247,21
Vc 24,240,241
Vc 25,242,243
Vc 26,244,245
Vc 27,246,247
buffer_store_dwordx4 v[24:27], v23, s[16:19], s3 offen offset:0 sc1
Ar 240,120
Ar 241,121
Ar 242,122
Ar 243,123
Ar 244,124
Ar 245,125
Ar 246,126
Ar 247,127
Vm 240,240,22
Vm 241,241,22
Vm 242,242,22
Vm 243,243,22
Vm 244,244,22
Vm 245,245,22
Vm 246,246,22
Vm 247,247,22
Vc 28,240,241
Vc 29,242,243
Vc 30,244,245
Vc 31,246,247
buffer_store_dwordx4 v[28:31], v23, s[16:19], s3 offen offset:1024 sc1
s_add_u32 s52, s37, 2
s_waitcnt vmcnt(8)
L_k2_nloop:
v_xor_b32 v2, 65536, v2
v_xor_b32 v3, 65536, v3
Cvaa 192,192,128,32
s_mov_b32 m0, s53
Ve 9,137
Mvaa 192,196,132
buffer_load_dwordx4 v4, s[12:15], s38 offen offset:0 sc1 lds
Mvaa 192,200,136
Ra 224,2,40960
Vc 68,8,9
Mvaa 192,204,140
Ve 10,138
Cvaa 208,192,144,36
Ve 11,139
Mvaa 208,196,148
Ra 228,2,41984
Vc 69,10,11
Mvaa 208,200,152
Ra 232,2,43008
v_or3_b32 v7, v7, v68, v69
Mvaa 208,204,156
s_waitcnt lgkmcnt(3)
Ra 236,2,44032
Ra 240,2,45056
Cvaa 196,208,128,32
buffer_load_dwordx4 v4, s[12:15], s38 offen offset:1024 sc1 lds
Mvaa 196,212,132
Ve 12,152
Mvaa 196,216,136
Ve 13,153
Mvaa 196,220,140
Ra 244,2,46080
Vc 76,12,13
Cvaa 212,208,144,36
Ve 14,154
Mvaa 212,212,148
buffer_load_dwordx4 v4, s[12:15], s38 offen offset:2048 sc1 lds
Mvaa 212,216,152
Ve 15,155
Mvaa 212,220,156
s_waitcnt lgkmcnt(2)
Ra 248,2,47104
Ra 252,2,48128
Cvaa 200,224,128,32
Ra 192,2,16384
Vc 77,14,15
Mvaa 200,228,132
Ra 196,2,17408
v_or3_b32 v7, v7, v76, v77
Mvaa 200,232,136
Ve 8,140
Mvaa 200,236,140
buffer_load_dwordx4 v4, s[12:15], s38 offen offset:3072 sc1 lds
Cvaa 216,224,144,36
Ve 9,141
Mvaa 216,228,148
Ra 200,2,18432
Vc 70,8,9
Mvaa 216,232,152
Ve 10,142
Mvaa 216,236,156
s_waitcnt lgkmcnt(3)
Ra 204,2,19456
Ra 208,2,20480
Cvaa 204,240,128,32
Ve 11,143
Mvaa 204,244,132
s_cmp_lt_u32 s37, s52
Ra 212,2,21504
Vc 71,10,11
Mvaa 204,248,136
s_cbranch_scc1 L_nw_ne
s_waitcnt vmcnt(12)
L_nw_ne:
Ra 216,2,22528
v_or3_b32 v7, v7, v70, v71
Mvaa 204,252,140
s_cmp_ge_u32 s37, s45
Ve 12,156
Cvaa 220,240,144,36
Ve 13,157
Mvaa 220,244,148
s_barrier
Ra 220,2,23552
Vc 78,12,13
Mvaa 220,248,152
s_waitcnt lgkmcnt(4)
Ve 14,158
Ve 15,159
s_nop 0
Vc 79,14,15
v_or3_b32 v7, v7, v78, v79
v_and_b32 v1, 0x40004000, v7
v_cmp_ne_u32 vcc, 0, v1
Mvaa 220,252,156
s_cbranch_vccnz L_k2_fb_ne
L_k2_fbr_ne:
Maav 0,192,64
s_cbranch_scc1 L_k2_mk_ne
L_k2_mkr_ne:
Ve 8,192
Maav 0,196,68
s_add_u32 m0, s54, 49152
Ve 9,193
Maav 32,192,72
buffer_load_dwordx4 v4, s[12:15], s39 offen offset:0 sc1 lds
Maav 32,196,76
s_add_u32 s37, s37, 1
Ra 224,2,24576
Vc 96,8,9
Maav 4,200,64
s_add_u32 s38, s38, 34816
Ve 10,194
Maav 4,204,68
Ve 11,195
Maav 36,200,72
Ra 228,2,25600
Vc 97,10,11
Maav 36,204,76
Ra 232,2,26624
v_or_b32 v7, v96, v97
Mvvv 48,16,64
Ve 12,208
Mvvv 48,16,68
s_waitcnt lgkmcnt(3)
Ra 236,2,27648
Ra 240,2,28672
Maav 8,208,64
buffer_load_dwordx4 v4, s[12:15], s39 offen offset:1024 sc1 lds
Maav 8,212,68
Ve 13,209
Maav 40,208,72
Ra 244,2,29696
Vc 104,12,13
Maav 40,212,76
Ve 14,210
Maav 12,216,64
Ve 15,211
Maav 12,220,68
Ra 248,2,30720
Vc 105,14,15
Maav 44,216,72
Ra 252,2,31744
v_or3_b32 v7, v7, v104, v105
Maav 44,220,76
Ve 8,196
Mvvv 52,16,72
buffer_load_dwordx4 v4, s[12:15], s39 offen offset:2048 sc1 lds
Mvvv 52,16,76
s_waitcnt lgkmcnt(4)
Ve 9,197
Maav 16,224,64
Ra 192,3,0
Vc 98,8,9
Maav 16,228,68
Ve 10,198
Maav 48,224,72
Ve 11,199
Maav 48,228,76
Ra 196,3,1024
Vc 99,10,11
Maav 20,232,64
Ra 200,3,2048
v_or3_b32 v7, v7, v98, v99
Maav 20,236,68
Ra 204,3,3072
Ra 208,3,4096
Maav 52,232,72
buffer_load_dwordx4 v4, s[12:15], s39 offen offset:3072 sc1 lds
Maav 52,236,76
s_waitcnt lgkmcnt(5)
Ve 12,212
Maav 24,240,64
s_add_u32 s39, s39, 34816
Ve 13,213
Maav 24,244,68
Ra 212,3,5120
Vc 106,12,13
Maav 56,240,72
Ve 14,214
Maav 56,244,76
Ve 15,215
Maav 28,248,64
Ra 216,3,6144
Vc 107,14,15
Maav 28,252,68
s_cmp_eq_u32 s37, s36
Ra 220,3,7168
v_or3_b32 v7, v7, v106, v107
Maav 60,248,72
s_waitcnt lgkmcnt(4)
Ve 8,200
Maav 60,252,76
s_cbranch_scc1 L_k2_fin
Ve 9,201
Cvaa 128,192,128,32
s_add_u32 m0, s53, 32768
Ra 224,3,8192
Vc 100,8,9
Mvaa 128,196,132
buffer_load_dwordx4 v4, s[12:15], s38 offen offset:0 sc1 lds
Mvaa 128,200,136
Ve 10,202
Mvaa 128,204,140
Ve 11,203
Cvaa 144,192,144,36
Ra 228,3,9216
Vc 101,10,11
Mvaa 144,196,148
Ra 232,3,10240
v_or3_b32 v7, v7, v100, v101
Mvaa 144,200,152
Ve 12,216
Mvaa 144,204,156
s_waitcnt lgkmcnt(3)
Ra 236,3,11264
Ra 240,3,12288
Cvaa 132,208,128,32
buffer_load_dwordx4 v4, s[12:15], s38 offen offset:1024 sc1 lds
Mvaa 132,212,132
Ve 13,217
Mvaa 132,216,136
Ra 244,3,13312
Vc 108,12,13
Mvaa 132,220,140
Ve 14,218
Cvaa 148,208,144,36
Ve 15,219
Mvaa 148,212,148
buffer_load_dwordx4 v4, s[12:15], s38 offen offset:2048 sc1 lds
Mvaa 148,216,152
Ra 248,3,14336
Vc 109,14,15
Mvaa 148,220,156
s_waitcnt lgkmcnt(3)
Ra 252,3,15360
v_or3_b32 v7, v7, v108, v109
Cvaa 136,224,128,32
Ve 8,204
Mvaa 136,228,132
Ve 9,205
Mvaa 136,232,136
Ra 192,2,49152
Vc 102,8,9
Mvaa 136,236,140
buffer_load_dwordx4 v4, s[12:15], s38 offen offset:3072 sc1 lds
Cvaa 152,224,144,36
Ve 10,206
Mvaa 152,228,148
Ve 11,207
Mvaa 152,232,152
Ra 196,2,50176
Vc 103,10,11
Mvaa 152,236,156
s_waitcnt lgkmcnt(2)
Ra 200,2,51200
Ra 204,2,52224
Cvaa 140,240,128,32
Ra 208,2,53248
v_or3_b32 v7, v7, v102, v103
Mvaa 140,244,132
s_cmp_lt_u32 s37, s52
Ve 12,220
Mvaa 140,248,136
s_cbranch_scc1 L_nw_no
s_waitcnt vmcnt(12)
L_nw_no:
Ve 13,221
Mvaa 140,252,140
s_cmp_ge_u32 s37, s45
Ra 212,2,54272
Vc 110,12,13
Cvaa 156,240,144,36
Ve 14,222
Mvaa 156,244,148
s_barrier
Ve 15,223
Mvaa 156,248,152
s_waitcnt lgkmcnt(2)
Ra 216,2,55296
Vc 111,14,15
v_or3_b32 v7, v7, v110, v111
v_and_b32 v1, 0x40004000, v7
v_cmp_ne_u32 vcc, 0, v1
Mvaa 156,252,156
s_cbranch_vccnz L_k2_fb_no
L_k2_fbr_no:
Ra 220,2,56320
Maav 0,192,96
s_cbranch_scc1 L_k2_mk_no
L_k2_mkr_no:
Ve 8,128
Maav 0,196,100
s_add_u32 m0, s53, 16384
Ve 9,129
Maav 32,192,104
buffer_load_dwordx4 v4, s[12:15], s39 offen offset:0 sc1 lds
Maav 32,196,108
s_add_u32 s37, s37, 1
Ra 224,2,57344
Vc 64,8,9
Maav 4,200,96
s_add_u32 s38, s38, 34816
Ve 10,130
Maav 4,204,100
s_xor_b32 s53, s53, 65536
Ve 11,131
Maav 36,200,104
s_xor_b32 s54, s54, 65536
Ra 228,2,58368
Vc 65,10,11
Maav 36,204,108
Ra 232,2,59392
v_or_b32 v7, v64, v65
Mvvv 48,16,96
Ve 12,144
Mvvv 48,16,100
s_waitcnt lgkmcnt(3)
Ra 236,2,60416
Ra 240,2,61440
Maav 8,208,96
buffer_load_dwordx4 v4, s[12:15], s39 offen offset:1024 sc1 lds
Maav 8,212,100
Ve 13,145
Maav 40,208,104
Ra 244,2,62464
Vc 72,12,13
Maav 40,212,108
Ve 14,146
Maav 12,216,96
Ve 15,147
Maav 12,220,100
Ra 248,2,63488
Vc 73,14,15
Maav 44,216,104
Ra 252,2,64512
v_or3_b32 v7, v7, v72, v73
Maav 44,220,108
Ve 8,132
Mvvv 52,16,104
buffer_load_dwordx4 v4, s[12:15], s39 offen offset:2048 sc1 lds
Mvvv 52,16,108
s_waitcnt lgkmcnt(4)
Ve 9,133
Maav 16,224,96
Ra 192,3,32768
Vc 66,8,9
Maav 16,228,100
Ve 10,134
Maav 48,224,104
Ve 11,135
Maav 48,228,108
Ra 196,3,33792
Vc 67,10,11
Maav 20,232,96
Ra 200,3,34816
v_or3_b32 v7, v7, v66, v67
Maav 20,236,100
Ra 204,3,35840
Ra 208,3,36864
Maav 52,232,104
buffer_load_dwordx4 v4, s[12:15], s39 offen offset:3072 sc1 lds
Maav 52,236,108
s_waitcnt lgkmcnt(5)
Ve 12,148
Maav 24,240,96
s_add_u32 s39, s39, 34816
Ve 13,149
Maav 24,244,100
Ra 212,3,37888
Vc 74,12,13
Maav 56,240,104
Ve 14,150
Maav 56,244,108
Ve 15,151
Maav 28,248,96
Ra 216,3,38912
Vc 75,14,15
Maav 28,252,100
Ra 220,3,39936
v_or3_b32 v7, v7, v74, v75
Maav 60,248,104
s_waitcnt lgkmcnt(4)
Ve 8,136
Maav 60,252,108
s_branch L_k2_nloop
L_k2_fin:
s_getpc_b64 s[56:57]
L_cpf4:
s_add_u32 s56, s56, (oproj_kernel-L_cpf4)&0xffffffff
s_addc_u32 s57, s57, ((oproj_kernel-L_cpf4)>>32)&0xffffffff
s_lshr_b32 s58, s2, 3
s_lshl_b32 s58, s58, 2
s_add_u32 s58, s58, s32
s_lshl_b32 s58, s58, 10
v_and_b32 v162, 7, v0
v_lshlrev_b32 v162, 7, v162
v_add_u32 v162, s58, v162
v_min_u32 v162, L_k3_end-oproj_kernel-4, v162
v_mov_b32 v161, s57
v_add_co_u32 v160, vcc, s56, v162
s_nop 1
v_addc_co_u32 v161, vcc, 0, v161, vcc
global_load_dword v164, v[160:161], off
s_waitcnt lgkmcnt(0)
Ra 192,2,49152
Ra 196,2,50176
Ra 200,2,51200
Ra 204,2,52224
Ra 208,2,53248
Ra 212,2,54272
Ra 216,2,55296
Ra 220,2,56320
s_lshr_b32 s3, s42, 4
s_mul_i32 s3, s3, 33792
s_and_b32 s47, s42, 15
s_lshl_b32 s47, s47, 4
s_add_u32 s3, s3, s47
v_mov_b32 v28, s3
s_lshr_b32 s3, s43, 4
s_mul_i32 s3, s3, 33792
s_and_b32 s47, s43, 15
s_lshl_b32 s47, s47, 4
s_add_u32 s3, s3, s47
v_mov_b32 v29, s3
v_lshrrev_b32 v24, 4, v0
v_and_b32 v25, 15, v0
v_cmp_eq_u32 vcc, 1, v25
s_lshl_b32 s3, s32, 4
v_add_u32 v26, s3, v24
v_cndmask_b32 v28, v28, v29, vcc
v_lshl_add_u32 v28, v24, 8, v28
v_mul_u32_u24 v26, 7168, v26
v_lshlrev_b32 v24, 1, v24
v_xor_b32 v24, v24, v25
v_xor_b32 v25, 8, v24
v_lshl_add_u32 v24, v24, 4, v26
v_lshl_add_u32 v25, v25, 4, v26
s_lshl_b32 s3, s6, 12
buffer_load_dwordx4 a[160:163], v28, s[20:23], s3 offen offset:0 sc1
buffer_load_dwordx4 a[164:167], v28, s[20:23], s3 offen offset:1024 sc1
buffer_load_dwordx4 a[168:171], v28, s[20:23], s3 offen offset:2048 sc1
buffer_load_dwordx4 a[172:175], v28, s[20:23], s3 offen offset:3072 sc1
s_add_u32 m0, s54, 0
s_add_u32 s3, s5, 0
buffer_load_dwordx4 v24, s[24:27], s3 offen offset:0 lds
Ve 9,201
Ve 10,202
s_add_u32 s3, s5, 27648
buffer_load_dwordx4 v24, s[24:27], s3 offen offset:1024 lds
Ve 11,203
Ve 12,216
s_add_u32 s3, s5, 55296
buffer_load_dwordx4 v25, s[24:27], s3 offen offset:2048 lds
Ve 13,217
Ve 14,218
s_add_u32 s3, s5, 82944
buffer_load_dwordx4 v25, s[24:27], s3 offen offset:3072 lds
Ve 15,219
Vc 100,8,9
s_add_u32 m0, s54, 16384
s_add_u32 s3, s5, 458752
buffer_load_dwordx4 v24, s[24:27], s3 offen offset:0 lds
Ve 8,204
Ve 9,205
s_add_u32 s3, s5, 486400
buffer_load_dwordx4 v24, s[24:27], s3 offen offset:1024 lds
Vc 101,10,11
Ve 10,206
s_add_u32 s3, s5, 514048
buffer_load_dwordx4 v25, s[24:27], s3 offen offset:2048 lds
Ve 11,207
Vc 108,12,13
s_add_u32 s3, s5, 541696
buffer_load_dwordx4 v25, s[24:27], s3 offen offset:3072 lds
Ve 12,220
Ve 13,221
s_add_u32 m0, s54, 32768
s_add_u32 s3, s5, 0
buffer_load_dwordx4 v24, s[68:71], s3 offen offset:0 lds
Vc 109,14,15
Ve 14,222
s_add_u32 s3, s5, 27648
buffer_load_dwordx4 v24, s[68:71], s3 offen offset:1024 lds
Ve 15,223
Vc 102,8,9
s_add_u32 s3, s5, 55296
buffer_load_dwordx4 v25, s[68:71], s3 offen offset:2048 lds
Vc 103,10,11
Vc 110,12,13
s_add_u32 s3, s5, 82944
buffer_load_dwordx4 v25, s[68:71], s3 offen offset:3072 lds
Vc 111,14,15
v_or3_b32 v7, v7, v100, v101
s_add_u32 m0, s54, 49152
s_add_u32 s3, s5, 458752
buffer_load_dwordx4 v24, s[68:71], s3 offen offset:0 lds
v_or3_b32 v7, v7, v108, v109
v_or3_b32 v7, v7, v102, v103
s_add_u32 s3, s5, 486400
buffer_load_dwordx4 v24, s[68:71], s3 offen offset:1024 lds
v_or3_b32 v7, v7, v110, v111
v_and_b32 v1, 0x40004000, v7
s_add_u32 s3, s5, 514048
buffer_load_dwordx4 v25, s[68:71], s3 offen offset:2048 lds
v_cmp_ne_u32 vcc, 0, v1
s_add_u32 s3, s5, 541696
buffer_load_dwordx4 v25, s[68:71], s3 offen offset:3072 lds
s_waitcnt lgkmcnt(4)
s_cbranch_vccnz L_k2_fb_fi
L_k2_fbr_fi:
Maav 0,192,96
Ra 224,2,57344
Ra 228,2,58368
Maav 0,196,100
Ra 232,2,59392
Ra 236,2,60416
Maav 32,192,104
Ra 240,2,61440
Ra 244,2,62464
Maav 32,196,108
Ra 248,2,63488
Ra 252,2,64512
Maav 4,200,96
Maav 4,204,100
Maav 36,200,104
Maav 36,204,108
Mvvv 48,16,96
Mvvv 48,16,100
s_waitcnt lgkmcnt(8)
Maav 8,208,96
Maav 8,212,100
Maav 40,208,104
Maav 40,212,108
Maav 12,216,96
Maav 12,220,100
Maav 44,216,104
Maav 44,220,108
Mvvv 52,16,104
Mvvv 52,16,108
s_waitcnt lgkmcnt(4)
Maav 16,224,96
Maav 16,228,100
Maav 48,224,104
Maav 48,228,108
Maav 20,232,96
Maav 20,236,100
Maav 52,232,104
Maav 52,236,108
s_waitcnt lgkmcnt(0)
Maav 24,240,96
Maav 24,244,100
Maav 56,240,104
Maav 56,244,108
Maav 28,248,96
Maav 28,252,100
Maav 60,248,104
Maav 60,252,108
s_nop 7
s_lshl_b32 s3, s55, 20
s_lshl_b32 s47, s33, 15
s_add_u32 s3, s3, s47
s_lshl_b32 s47, s32, 11
s_add_u32 s3, s3, s47
v_lshlrev_b32 v23, 4, v0
v_rcp_f32 v21, v48
v_rcp_f32 v22, v52
Ar 240,0
Ar 241,1
Ar 242,2
Ar 243,3
Ar 244,4
Ar 245,5
Ar 246,6
Ar 247,7
Vm 240,240,21
Vm 241,241,21
Vm 242,242,21
Vm 243,243,21
Vm 244,244,21
Vm 245,245,21
Vm 246,246,21
Vm 247,247,21
Vc 24,240,241
Vc 25,242,243
Vc 26,244,245
Vc 27,246,247
buffer_store_dwordx4 v[24:27], v23, s[16:19], s3 offen offset:0 sc1
Ar 240,32
Ar 241,33
Ar 242,34
Ar 243,35
Ar 244,36
Ar 245,37
Ar 246,38
Ar 247,39
Vm 240,240,22
Vm 241,241,22
Vm 242,242,22
Vm 243,243,22
Vm 244,244,22
Vm 245,245,22
Vm 246,246,22
Vm 247,247,22
Vc 28,240,241
Vc 29,242,243
Vc 30,244,245
Vc 31,246,247
buffer_store_dwordx4 v[28:31], v23, s[16:19], s3 offen offset:1024 sc1
s_add_u32 s3, s3, 8192
Ar 240,8
Ar 241,9
Ar 242,10
Ar 243,11
Ar 244,12
Ar 245,13
Ar 246,14
Ar 247,15
Vm 240,240,21
Vm 241,241,21
Vm 242,242,21
Vm 243,243,21
Vm 244,244,21
Vm 245,245,21
Vm 246,246,21
Vm 247,247,21
Vc 24,240,241
Vc 25,242,243
Vc 26,244,245
Vc 27,246,247
buffer_store_dwordx4 v[24:27], v23, s[16:19], s3 offen offset:0 sc1
Ar 240,40
Ar 241,41
Ar 242,42
Ar 243,43
Ar 244,44
Ar 245,45
Ar 246,46
Ar 247,47
Vm 240,240,22
Vm 241,241,22
Vm 242,242,22
Vm 243,243,22
Vm 244,244,22
Vm 245,245,22
Vm 246,246,22
Vm 247,247,22
Vc 28,240,241
Vc 29,242,243
Vc 30,244,245
Vc 31,246,247
buffer_store_dwordx4 v[28:31], v23, s[16:19], s3 offen offset:1024 sc1
s_add_u32 s3, s3, 8192
Ar 240,16
Ar 241,17
Ar 242,18
Ar 243,19
Ar 244,20
Ar 245,21
Ar 246,22
Ar 247,23
Vm 240,240,21
Vm 241,241,21
Vm 242,242,21
Vm 243,243,21
Vm 244,244,21
Vm 245,245,21
Vm 246,246,21
Vm 247,247,21
Vc 24,240,241
Vc 25,242,243
Vc 26,244,245
Vc 27,246,247
buffer_store_dwordx4 v[24:27], v23, s[16:19], s3 offen offset:0 sc1
Ar 240,48
Ar 241,49
Ar 242,50
Ar 243,51
Ar 244,52
Ar 245,53
Ar 246,54
Ar 247,55
Vm 240,240,22
Vm 241,241,22
Vm 242,242,22
Vm 243,243,22
Vm 244,244,22
Vm 245,245,22
Vm 246,246,22
Vm 247,247,22
Vc 28,240,241
Vc 29,242,243
Vc 30,244,245
Vc 31,246,247
buffer_store_dwordx4 v[28:31], v23, s[16:19], s3 offen offset:1024 sc1
s_add_u32 s3, s3, 8192
Ar 240,24
Ar 241,25
Ar 242,26
Ar 243,27
Ar 244,28
Ar 245,29
Ar 246,30
Ar 247,31
Vm 240,240,21
Vm 241,241,21
Vm 242,242,21
Vm 243,243,21
Vm 244,244,21
Vm 245,245,21
Vm 246,246,21
Vm 247,247,21
Vc 24,240,241
Vc 25,242,243
Vc 26,244,245
Vc 27,246,247
buffer_store_dwordx4 v[24:27], v23, s[16:19], s3 offen offset:0 sc1
Ar 240,56
Ar 241,57
Ar 242,58
Ar 243,59
Ar 244,60
Ar 245,61
Ar 246,62
Ar 247,63
Vm 240,240,22
Vm 241,241,22
Vm 242,242,22
Vm 243,243,22
Vm 244,244,22
Vm 245,245,22
Vm 246,246,22
Vm 247,247,22
Vc 28,240,241
Vc 29,242,243
Vc 30,244,245
Vc 31,246,247
buffer_store_dwordx4 v[28:31], v23, s[16:19], s3 offen offset:1024 sc1
s_cmp_eq_u32 s34, 7
s_cbranch_scc1 L_noffn1
v_lshrrev_b32 v24, 4, v0
v_bfe_u32 v25, v0, 2, 2
v_lshl_add_u32 v26, v24, 3, v25
v_lshlrev_b32 v26, 8, v26
v_and_b32 v27, 3, v0
v_lshl_add_u32 v26, v27, 3, v26
v_and_b32 v27, 1, v24
v_lshl_add_u32 v25, v27, 2, v25
s_lshl_b32 s3, s32, 1
v_xor_b32 v25, s3, v25
v_lshl_add_u32 v26, v25, 5, v26
s_sub_u32 s3, s54, s44
v_add_u32 v26, s3, v26
v_xor_b32 v27, 32, v26
s_waitcnt vmcnt(8) lgkmcnt(0)
s_barrier
ds_read_b64_tr_b16 v[128:129], v26 offset:0
ds_read_b64_tr_b16 v[130:131], v26 offset:1024
ds_read_b64_tr_b16 v[132:133], v27 offset:0
ds_read_b64_tr_b16 v[134:135], v27 offset:1024
ds_read_b64_tr_b16 v[136:137], v26 offset:8192
ds_read_b64_tr_b16 v[138:139], v26 offset:9216
ds_read_b64_tr_b16 v[140:141], v27 offset:8192
ds_read_b64_tr_b16 v[142:143], v27 offset:9216
ds_read_b64_tr_b16 v[144:145], v26 offset:16384
ds_read_b64_tr_b16 v[146:147], v26 offset:17408
ds_read_b64_tr_b16 v[148:149], v27 offset:16384
ds_read_b64_tr_b16 v[150:151], v27 offset:17408
ds_read_b64_tr_b16 v[152:153], v26 offset:24576
ds_read_b64_tr_b16 v[154:155], v26 offset:25600
ds_read_b64_tr_b16 v[156:157], v27 offset:24576
s_waitcnt lgkmcnt(9)
ds_read_b64_tr_b16 v[158:159], v27 offset:25600
ds_read_b64_tr_b16 v[160:161], v26 offset:32768
ds_read_b64_tr_b16 v[162:163], v26 offset:33792
ds_read_b64_tr_b16 v[164:165], v27 offset:32768
ds_read_b64_tr_b16 v[166:167], v27 offset:33792
ds_read_b64_tr_b16 v[168:169], v26 offset:40960
s_waitcnt lgkmcnt(9)
ds_read_b64_tr_b16 v[170:171], v26 offset:41984
ds_read_b64_tr_b16 v[172:173], v27 offset:40960
ds_read_b64_tr_b16 v[174:175], v27 offset:41984
ds_read_b64_tr_b16 v[176:177], v26 offset:49152
ds_read_b64_tr_b16 v[178:179], v26 offset:50176
ds_read_b64_tr_b16 v[180:181], v27 offset:49152
s_waitcnt lgkmcnt(9)
ds_read_b64_tr_b16 v[182:183], v27 offset:50176
ds_read_b64_tr_b16 v[184:185], v26 offset:57344
ds_read_b64_tr_b16 v[186:187], v26 offset:58368
ds_read_b64_tr_b16 v[188:189], v27 offset:57344
ds_read_b64_tr_b16 v[190:191], v27 offset:58368
v_and_b32 v25, 15, v0
v_mul_u32_u24 v28, 14336, v25
v_lshl_add_u32 v28, v24, 4, v28
v_mov_b32 v29, 2146435072
v_cmp_gt_u32 vcc, 2, v25
s_mul_i32 s3, s6, 57344
s_lshl_b32 s47, s4, 9
s_add_u32 s3, s3, s47
v_cndmask_b32 v28, v29, v28, vcc
s_lshl_b32 s47, s32, 7
s_add_u32 s3, s3, s47
s_add_u32 s3, s3, 6291456
s_add_u32 s7, s3, 28672
Zvva 224,128,160
Zvva 228,132,160
Mvva 224,136,164
Mvva 228,140,164
Mvva 224,144,168
Mvva 228,148,168
Mvva 224,152,172
Mvva 228,156,172
s_waitcnt lgkmcnt(0)
Zvva 232,160,160
Zvva 236,164,160
Mvva 232,168,164
Mvva 236,172,164
Mvva 232,176,168
Mvva 236,180,168
Mvva 232,184,172
Mvva 236,188,172
buffer_store_dwordx4 v[224:227], v28, s[20:23], s3 offen offset:0 sc1
buffer_store_dwordx4 v[228:231], v28, s[20:23], s3 offen offset:64 sc1
s_nop 4
buffer_store_dwordx4 v[232:235], v28, s[20:23], s7 offen offset:0 sc1
buffer_store_dwordx4 v[236:239], v28, s[20:23], s7 offen offset:64 sc1
L_noffn1:
L_k2_end:
s_endpgm
L_spinAk:
s_mov_b32 s47, 0x400000
L_spinAk_l:
s_sleep 8
buffer_load_dword v30, v31, s[28:31], 0 offen sc1
s_waitcnt vmcnt(0)
v_readfirstlane_b32 s3, v30
s_sub_u32 s47, s47, 1
s_cmp_eq_u32 s47, 0
s_cbranch_scc1 L_spinArk
s_cmp_lt_u32 s3, 256
s_cbranch_scc1 L_spinAk_l
s_branch L_spinArk
L_spinAv:
s_mov_b32 s47, 0x400000
L_spinAv_l:
s_sleep 8
buffer_load_dword v30, v31, s[28:31], 0 offen sc1
s_waitcnt vmcnt(0)
v_readfirstlane_b32 s3, v30
s_sub_u32 s47, s47, 1
s_cmp_eq_u32 s47, 0
s_cbranch_scc1 L_spinArv
s_cmp_lt_u32 s3, 256
s_cbranch_scc1 L_spinAv_l
s_branch L_spinArv
L_spinB:
s_mov_b32 s59, 0x400000
L_spinB_l:
s_sleep 4
buffer_load_dword v12, v1, s[20:23], s6 offen sc1
s_sub_u32 s59, s59, 1
s_cmp_eq_u32 s59, 0
s_cbranch_scc1 L_spinBx
s_waitcnt vmcnt(0)
v_cmp_ne_u32 vcc, 1, v12
s_cbranch_vccnz L_spinB_l
L_spinBx:
s_waitcnt vmcnt(0)
s_branch L_spinBr
L_k2_fb_we:
s_nop 7
v_max3_f32 v21, v128, v129, v130
v_max3_f32 v21, v21, v131, v132
v_max3_f32 v21, v21, v133, v134
v_max3_f32 v21, v21, v135, v136
v_max3_f32 v21, v21, v137, v138
v_max3_f32 v21, v21, v139, v140
v_max3_f32 v21, v21, v141, v142
v_max_f32 v21, v21, v143
v_mov_b32 v1, v21
s_nop 1
v_permlane16_swap_b32 v1, v21
v_max_f32 v21, v21, v1
v_mov_b32 v1, v21
s_nop 1
v_permlane32_swap_b32 v1, v21
v_max_f32 v21, v21, v1
v_add_f32 v21, 0x41f80000, v21
v_max_f32 v21, 0, v21
Vs 128,128,21
Vs 129,129,21
Vs 130,130,21
Vs 131,131,21
Vs 132,132,21
Vs 133,133,21
Vs 134,134,21
Vs 135,135,21
Vs 136,136,21
Vs 137,137,21
Vs 138,138,21
Vs 139,139,21
Vs 140,140,21
Vs 141,141,21
Vs 142,142,21
Vs 143,143,21
Vs 192,192,21
Vs 193,193,21
Vs 194,194,21
Vs 195,195,21
Vs 196,196,21
Vs 197,197,21
Vs 198,198,21
Vs 199,199,21
Vs 200,200,21
Vs 201,201,21
Vs 202,202,21
Vs 203,203,21
Vs 204,204,21
Vs 205,205,21
Vs 206,206,21
Vs 207,207,21
Vs 32,32,21
Vs 33,33,21
Vs 34,34,21
Vs 35,35,21
v_exp_f32 v22, -v21
s_nop 0
Vm 48,48,22
Vm 49,49,22
Vm 50,50,22
Vm 51,51,22
Ar 8,0
Ar 9,1
Ar 10,2
Ar 11,3
Ar 12,4
Ar 13,5
Ar 14,6
Ar 15,7
Vm 8,8,22
Vm 9,9,22
Vm 10,10,22
Vm 11,11,22
Vm 12,12,22
Vm 13,13,22
Vm 14,14,22
Vm 15,15,22
Aw 0,8
Aw 1,9
Aw 2,10
Aw 3,11
Aw 4,12
Aw 5,13
Aw 6,14
Aw 7,15
Ar 8,8
Ar 9,9
Ar 10,10
Ar 11,11
Ar 12,12
Ar 13,13
Ar 14,14
Ar 15,15
Vm 8,8,22
Vm 9,9,22
Vm 10,10,22
Vm 11,11,22
Vm 12,12,22
Vm 13,13,22
Vm 14,14,22
Vm 15,15,22
Aw 8,8
Aw 9,9
Aw 10,10
Aw 11,11
Aw 12,12
Aw 13,13
Aw 14,14
Aw 15,15
Ar 8,16
Ar 9,17
Ar 10,18
Ar 11,19
Ar 12,20
Ar 13,21
Ar 14,22
Ar 15,23
Vm 8,8,22
Vm 9,9,22
Vm 10,10,22
Vm 11,11,22
Vm 12,12,22
Vm 13,13,22
Vm 14,14,22
Vm 15,15,22
Aw 16,8
Aw 17,9
Aw 18,10
Aw 19,11
Aw 20,12
Aw 21,13
Aw 22,14
Aw 23,15
Ar 8,24
Ar 9,25
Ar 10,26
Ar 11,27
Ar 12,28
Ar 13,29
Ar 14,30
Ar 15,31
Vm 8,8,22
Vm 9,9,22
Vm 10,10,22
Vm 11,11,22
Vm 12,12,22
Vm 13,13,22
Vm 14,14,22
Vm 15,15,22
Aw 24,8
Aw 25,9
Aw 26,10
Aw 27,11
Aw 28,12
Aw 29,13
Aw 30,14
Aw 31,15
v_max3_f32 v21, v144, v145, v146
v_max3_f32 v21, v21, v147, v148
v_max3_f32 v21, v21, v149, v150
v_max3_f32 v21, v21, v151, v152
v_max3_f32 v21, v21, v153, v154
v_max3_f32 v21, v21, v155, v156
v_max3_f32 v21, v21, v157, v158
v_max_f32 v21, v21, v159
v_mov_b32 v1, v21
s_nop 1
v_permlane16_swap_b32 v1, v21
v_max_f32 v21, v21, v1
v_mov_b32 v1, v21
s_nop 1
v_permlane32_swap_b32 v1, v21
v_max_f32 v21, v21, v1
v_add_f32 v21, 0x41f80000, v21
v_max_f32 v21, 0, v21
Vs 144,144,21
Vs 145,145,21
Vs 146,146,21
Vs 147,147,21
Vs 148,148,21
Vs 149,149,21
Vs 150,150,21
Vs 151,151,21
Vs 152,152,21
Vs 153,153,21
Vs 154,154,21
Vs 155,155,21
Vs 156,156,21
Vs 157,157,21
Vs 158,158,21
Vs 159,159,21
Vs 208,208,21
Vs 209,209,21
Vs 210,210,21
Vs 211,211,21
Vs 212,212,21
Vs 213,213,21
Vs 214,214,21
Vs 215,215,21
Vs 216,216,21
Vs 217,217,21
Vs 218,218,21
Vs 219,219,21
Vs 220,220,21
Vs 221,221,21
Vs 222,222,21
Vs 223,223,21
Vs 36,36,21
Vs 37,37,21
Vs 38,38,21
Vs 39,39,21
v_exp_f32 v22, -v21
s_nop 0
Vm 52,52,22
Vm 53,53,22
Vm 54,54,22
Vm 55,55,22
Ar 8,32
Ar 9,33
Ar 10,34
Ar 11,35
Ar 12,36
Ar 13,37
Ar 14,38
Ar 15,39
Vm 8,8,22
Vm 9,9,22
Vm 10,10,22
Vm 11,11,22
Vm 12,12,22
Vm 13,13,22
Vm 14,14,22
Vm 15,15,22
Aw 32,8
Aw 33,9
Aw 34,10
Aw 35,11
Aw 36,12
Aw 37,13
Aw 38,14
Aw 39,15
Ar 8,40
Ar 9,41
Ar 10,42
Ar 11,43
Ar 12,44
Ar 13,45
Ar 14,46
Ar 15,47
Vm 8,8,22
Vm 9,9,22
Vm 10,10,22
Vm 11,11,22
Vm 12,12,22
Vm 13,13,22
Vm 14,14,22
Vm 15,15,22
Aw 40,8
Aw 41,9
Aw 42,10
Aw 43,11
Aw 44,12
Aw 45,13
Aw 46,14
Aw 47,15
Ar 8,48
Ar 9,49
Ar 10,50
Ar 11,51
Ar 12,52
Ar 13,53
Ar 14,54
Ar 15,55
Vm 8,8,22
Vm 9,9,22
Vm 10,10,22
Vm 11,11,22
Vm 12,12,22
Vm 13,13,22
Vm 14,14,22
Vm 15,15,22
Aw 48,8
Aw 49,9
Aw 50,10
Aw 51,11
Aw 52,12
Aw 53,13
Aw 54,14
Aw 55,15
Ar 8,56
Ar 9,57
Ar 10,58
Ar 11,59
Ar 12,60
Ar 13,61
Ar 14,62
Ar 15,63
Vm 8,8,22
Vm 9,9,22
Vm 10,10,22
Vm 11,11,22
Vm 12,12,22
Vm 13,13,22
Vm 14,14,22
Vm 15,15,22
Aw 56,8
Aw 57,9
Aw 58,10
Aw 59,11
Aw 60,12
Aw 61,13
Aw 62,14
Aw 63,15
v_max3_f32 v21, v160, v161, v162
v_max3_f32 v21, v21, v163, v164
v_max3_f32 v21, v21, v165, v166
v_max3_f32 v21, v21, v167, v168
v_max3_f32 v21, v21, v169, v170
v_max3_f32 v21, v21, v171, v172
v_max3_f32 v21, v21, v173, v174
v_max_f32 v21, v21, v175
v_mov_b32 v1, v21
s_nop 1
v_permlane16_swap_b32 v1, v21
v_max_f32 v21, v21, v1
v_mov_b32 v1, v21
s_nop 1
v_permlane32_swap_b32 v1, v21
v_max_f32 v21, v21, v1
v_add_f32 v21, 0x41f80000, v21
v_max_f32 v21, 0, v21
Vs 160,160,21
Vs 161,161,21
Vs 162,162,21
Vs 163,163,21
Vs 164,164,21
Vs 165,165,21
Vs 166,166,21
Vs 167,167,21
Vs 168,168,21
Vs 169,169,21
Vs 170,170,21
Vs 171,171,21
Vs 172,172,21
Vs 173,173,21
Vs 174,174,21
Vs 175,175,21
Vs 224,224,21
Vs 225,225,21
Vs 226,226,21
Vs 227,227,21
Vs 228,228,21
Vs 229,229,21
Vs 230,230,21
Vs 231,231,21
Vs 232,232,21
Vs 233,233,21
Vs 234,234,21
Vs 235,235,21
Vs 236,236,21
Vs 237,237,21
Vs 238,238,21
Vs 239,239,21
Vs 40,40,21
Vs 41,41,21
Vs 42,42,21
Vs 43,43,21
v_exp_f32 v22, -v21
s_nop 0
Vm 56,56,22
Vm 57,57,22
Vm 58,58,22
Vm 59,59,22
Ar 8,64
Ar 9,65
Ar 10,66
Ar 11,67
Ar 12,68
Ar 13,69
Ar 14,70
Ar 15,71
Vm 8,8,22
Vm 9,9,22
Vm 10,10,22
Vm 11,11,22
Vm 12,12,22
Vm 13,13,22
Vm 14,14,22
Vm 15,15,22
Aw 64,8
Aw 65,9
Aw 66,10
Aw 67,11
Aw 68,12
Aw 69,13
Aw 70,14
Aw 71,15
Ar 8,72
Ar 9,73
Ar 10,74
Ar 11,75
Ar 12,76
Ar 13,77
Ar 14,78
Ar 15,79
Vm 8,8,22
Vm 9,9,22
Vm 10,10,22
Vm 11,11,22
Vm 12,12,22
Vm 13,13,22
Vm 14,14,22
Vm 15,15,22
Aw 72,8
Aw 73,9
Aw 74,10
Aw 75,11
Aw 76,12
Aw 77,13
Aw 78,14
Aw 79,15
Ar 8,80
Ar 9,81
Ar 10,82
Ar 11,83
Ar 12,84
Ar 13,85
Ar 14,86
Ar 15,87
Vm 8,8,22
Vm 9,9,22
Vm 10,10,22
Vm 11,11,22
Vm 12,12,22
Vm 13,13,22
Vm 14,14,22
Vm 15,15,22
Aw 80,8
Aw 81,9
Aw 82,10
Aw 83,11
Aw 84,12
Aw 85,13
Aw 86,14
Aw 87,15
Ar 8,88
Ar 9,89
Ar 10,90
Ar 11,91
Ar 12,92
Ar 13,93
Ar 14,94
Ar 15,95
Vm 8,8,22
Vm 9,9,22
Vm 10,10,22
Vm 11,11,22
Vm 12,12,22
Vm 13,13,22
Vm 14,14,22
Vm 15,15,22
Aw 88,8
Aw 89,9
Aw 90,10
Aw 91,11
Aw 92,12
Aw 93,13
Aw 94,14
Aw 95,15
v_max3_f32 v21, v176, v177, v178
v_max3_f32 v21, v21, v179, v180
v_max3_f32 v21, v21, v181, v182
v_max3_f32 v21, v21, v183, v184
v_max3_f32 v21, v21, v185, v186
v_max3_f32 v21, v21, v187, v188
v_max3_f32 v21, v21, v189, v190
v_max_f32 v21, v21, v191
v_mov_b32 v1, v21
s_nop 1
v_permlane16_swap_b32 v1, v21
v_max_f32 v21, v21, v1
v_mov_b32 v1, v21
s_nop 1
v_permlane32_swap_b32 v1, v21
v_max_f32 v21, v21, v1
v_add_f32 v21, 0x41f80000, v21
v_max_f32 v21, 0, v21
Vs 176,176,21
Vs 177,177,21
Vs 178,178,21
Vs 179,179,21
Vs 180,180,21
Vs 181,181,21
Vs 182,182,21
Vs 183,183,21
Vs 184,184,21
Vs 185,185,21
Vs 186,186,21
Vs 187,187,21
Vs 188,188,21
Vs 189,189,21
Vs 190,190,21
Vs 191,191,21
Vs 240,240,21
Vs 241,241,21
Vs 242,242,21
Vs 243,243,21
Vs 244,244,21
Vs 245,245,21
Vs 246,246,21
Vs 247,247,21
Vs 248,248,21
Vs 249,249,21
Vs 250,250,21
Vs 251,251,21
Vs 252,252,21
Vs 253,253,21
Vs 254,254,21
Vs 255,255,21
Vs 44,44,21
Vs 45,45,21
Vs 46,46,21
Vs 47,47,21
v_exp_f32 v22, -v21
s_nop 0
Vm 60,60,22
Vm 61,61,22
Vm 62,62,22
Vm 63,63,22
Ar 8,96
Ar 9,97
Ar 10,98
Ar 11,99
Ar 12,100
Ar 13,101
Ar 14,102
Ar 15,103
Vm 8,8,22
Vm 9,9,22
Vm 10,10,22
Vm 11,11,22
Vm 12,12,22
Vm 13,13,22
Vm 14,14,22
Vm 15,15,22
Aw 96,8
Aw 97,9
Aw 98,10
Aw 99,11
Aw 100,12
Aw 101,13
Aw 102,14
Aw 103,15
Ar 8,104
Ar 9,105
Ar 10,106
Ar 11,107
Ar 12,108
Ar 13,109
Ar 14,110
Ar 15,111
Vm 8,8,22
Vm 9,9,22
Vm 10,10,22
Vm 11,11,22
Vm 12,12,22
Vm 13,13,22
Vm 14,14,22
Vm 15,15,22
Aw 104,8
Aw 105,9
Aw 106,10
Aw 107,11
Aw 108,12
Aw 109,13
Aw 110,14
Aw 111,15
Ar 8,112
Ar 9,113
Ar 10,114
Ar 11,115
Ar 12,116
Ar 13,117
Ar 14,118
Ar 15,119
Vm 8,8,22
Vm 9,9,22
Vm 10,10,22
Vm 11,11,22
Vm 12,12,22
Vm 13,13,22
Vm 14,14,22
Vm 15,15,22
Aw 112,8
Aw 113,9
Aw 114,10
Aw 115,11
Aw 116,12
Aw 117,13
Aw 118,14
Aw 119,15
Ar 8,120
Ar 9,121
Ar 10,122
Ar 11,123
Ar 12,124
Ar 13,125
Ar 14,126
Ar 15,127
Vm 8,8,22
Vm 9,9,22
Vm 10,10,22
Vm 11,11,22
Vm 12,12,22
Vm 13,13,22
Vm 14,14,22
Vm 15,15,22
Aw 120,8
Aw 121,9
Aw 122,10
Aw 123,11
Aw 124,12
Aw 125,13
Aw 126,14
Aw 127,15
Ve 8,128
Ve 9,129
s_nop 0
Vc 64,8,9
Ve 8,130
Ve 9,131
s_nop 0
Vc 65,8,9
Ve 8,144
Ve 9,145
s_nop 0
Vc 72,8,9
Ve 8,146
Ve 9,147
s_nop 0
Vc 73,8,9
Ve 8,160
Ve 9,161
s_nop 0
Vc 80,8,9
Ve 8,162
Ve 9,163
s_nop 0
Vc 81,8,9
Ve 8,176
Ve 9,177
s_nop 0
Vc 88,8,9
Ve 8,178
Ve 9,179
s_nop 0
Vc 89,8,9
Ve 8,132
Ve 9,133
s_nop 0
Vc 66,8,9
Ve 8,134
Ve 9,135
s_nop 0
Vc 67,8,9
Ve 8,148
Ve 9,149
s_nop 0
Vc 74,8,9
Ve 8,150
Ve 9,151
s_nop 0
Vc 75,8,9
Ve 8,164
Ve 9,165
s_nop 0
Vc 82,8,9
Ve 8,166
Ve 9,167
s_nop 0
Vc 83,8,9
Ve 8,180
Ve 9,181
s_nop 0
Vc 90,8,9
Ve 8,182
Ve 9,183
s_nop 0
Vc 91,8,9
Ve 8,136
Ve 9,137
s_nop 0
Vc 68,8,9
Ve 8,138
Ve 9,139
s_nop 0
Vc 69,8,9
Ve 8,152
Ve 9,153
s_nop 0
Vc 76,8,9
Ve 8,154
Ve 9,155
s_nop 0
Vc 77,8,9
Ve 8,168
Ve 9,169
s_nop 0
Vc 84,8,9
Ve 8,170
Ve 9,171
s_nop 0
Vc 85,8,9
Ve 8,184
Ve 9,185
s_nop 0
Vc 92,8,9
Ve 8,186
Ve 9,187
s_nop 0
Vc 93,8,9
Ve 8,140
Ve 9,141
s_nop 0
Vc 70,8,9
Ve 8,142
Ve 9,143
s_nop 0
Vc 71,8,9
Ve 8,156
Ve 9,157
s_nop 0
Vc 78,8,9
Ve 8,158
Ve 9,159
s_nop 0
Vc 79,8,9
Ve 8,172
Ve 9,173
s_nop 0
Vc 86,8,9
Ve 8,174
Ve 9,175
s_nop 0
Vc 87,8,9
Ve 8,188
Ve 9,189
s_nop 0
Vc 94,8,9
Ve 8,190
Ve 9,191
s_nop 0
Vc 95,8,9
s_nop 1
s_branch L_k2_fbr_we
L_k2_mk_we:
s_nop 7
s_add_u32 s3, s37, 1
s_lshl_b32 s3, s3, 6
v_subrev_u32 v1, s3, v6
v_cmp_gt_i32 s[56:57], -16, v1
v_cmp_gt_i32 s[58:59], -15, v1
v_cmp_gt_i32 s[60:61], -14, v1
v_cmp_gt_i32 s[62:63], -13, v1
v_cndmask_b32 v240, v240, v20, s[56:57]
v_cndmask_b32 v241, v241, v20, s[58:59]
v_cndmask_b32 v242, v242, v20, s[60:61]
v_cndmask_b32 v243, v243, v20, s[62:63]
v_cmp_gt_i32 s[56:57], 0, v1
v_cmp_gt_i32 s[58:59], 1, v1
v_cmp_gt_i32 s[60:61], 2, v1
v_cmp_gt_i32 s[62:63], 3, v1
v_cndmask_b32 v224, v224, v20, s[56:57]
v_cndmask_b32 v225, v225, v20, s[58:59]
v_cndmask_b32 v226, v226, v20, s[60:61]
v_cndmask_b32 v227, v227, v20, s[62:63]
v_cndmask_b32 v244, v244, v20, s[56:57]
v_cndmask_b32 v245, v245, v20, s[58:59]
v_cndmask_b32 v246, v246, v20, s[60:61]
v_cndmask_b32 v247, v247, v20, s[62:63]
v_cmp_gt_i32 s[56:57], 16, v1
v_cmp_gt_i32 s[58:59], 17, v1
v_cmp_gt_i32 s[60:61], 18, v1
v_cmp_gt_i32 s[62:63], 19, v1
v_cndmask_b32 v228, v228, v20, s[56:57]
v_cndmask_b32 v229, v229, v20, s[58:59]
v_cndmask_b32 v230, v230, v20, s[60:61]
v_cndmask_b32 v231, v231, v20, s[62:63]
v_cndmask_b32 v248, v248, v20, s[56:57]
v_cndmask_b32 v249, v249, v20, s[58:59]
v_cndmask_b32 v250, v250, v20, s[60:61]
v_cndmask_b32 v251, v251, v20, s[62:63]
v_cmp_gt_i32 s[56:57], 32, v1
v_cmp_gt_i32 s[58:59], 33, v1
v_cmp_gt_i32 s[60:61], 34, v1
v_cmp_gt_i32 s[62:63], 35, v1
v_cndmask_b32 v232, v232, v20, s[56:57]
v_cndmask_b32 v233, v233, v20, s[58:59]
v_cndmask_b32 v234, v234, v20, s[60:61]
v_cndmask_b32 v235, v235, v20, s[62:63]
v_cndmask_b32 v252, v252, v20, s[56:57]
v_cndmask_b32 v253, v253, v20, s[58:59]
v_cndmask_b32 v254, v254, v20, s[60:61]
v_cndmask_b32 v255, v255, v20, s[62:63]
v_cmp_gt_i32 s[56:57], 48, v1
v_cmp_gt_i32 s[58:59], 49, v1
v_cmp_gt_i32 s[60:61], 50, v1
v_cmp_gt_i32 s[62:63], 51, v1
v_cndmask_b32 v236, v236, v20, s[56:57]
v_cndmask_b32 v237, v237, v20, s[58:59]
v_cndmask_b32 v238, v238, v20, s[60:61]
v_cndmask_b32 v239, v239, v20, s[62:63]
s_nop 1
s_branch L_k2_mkr_we
L_k2_fb_wo:
s_nop 7
v_max3_f32 v21, v192, v193, v194
v_max3_f32 v21, v21, v195, v196
v_max3_f32 v21, v21, v197, v198
v_max3_f32 v21, v21, v199, v200
v_max3_f32 v21, v21, v201, v202
v_max3_f32 v21, v21, v203, v204
v_max3_f32 v21, v21, v205, v206
v_max_f32 v21, v21, v207
v_mov_b32 v1, v21
s_nop 1
v_permlane16_swap_b32 v1, v21
v_max_f32 v21, v21, v1
v_mov_b32 v1, v21
s_nop 1
v_permlane32_swap_b32 v1, v21
v_max_f32 v21, v21, v1
v_add_f32 v21, 0x41f80000, v21
v_max_f32 v21, 0, v21
Vs 192,192,21
Vs 193,193,21
Vs 194,194,21
Vs 195,195,21
Vs 196,196,21
Vs 197,197,21
Vs 198,198,21
Vs 199,199,21
Vs 200,200,21
Vs 201,201,21
Vs 202,202,21
Vs 203,203,21
Vs 204,204,21
Vs 205,205,21
Vs 206,206,21
Vs 207,207,21
Vs 128,128,21
Vs 129,129,21
Vs 130,130,21
Vs 131,131,21
Vs 132,132,21
Vs 133,133,21
Vs 134,134,21
Vs 135,135,21
Vs 136,136,21
Vs 137,137,21
Vs 138,138,21
Vs 139,139,21
Vs 140,140,21
Vs 141,141,21
Vs 142,142,21
Vs 143,143,21
Vs 32,32,21
Vs 33,33,21
Vs 34,34,21
Vs 35,35,21
v_exp_f32 v22, -v21
s_nop 0
Vm 48,48,22
Vm 49,49,22
Vm 50,50,22
Vm 51,51,22
Ar 8,0
Ar 9,1
Ar 10,2
Ar 11,3
Ar 12,4
Ar 13,5
Ar 14,6
Ar 15,7
Vm 8,8,22
Vm 9,9,22
Vm 10,10,22
Vm 11,11,22
Vm 12,12,22
Vm 13,13,22
Vm 14,14,22
Vm 15,15,22
Aw 0,8
Aw 1,9
Aw 2,10
Aw 3,11
Aw 4,12
Aw 5,13
Aw 6,14
Aw 7,15
Ar 8,8
Ar 9,9
Ar 10,10
Ar 11,11
Ar 12,12
Ar 13,13
Ar 14,14
Ar 15,15
Vm 8,8,22
Vm 9,9,22
Vm 10,10,22
Vm 11,11,22
Vm 12,12,22
Vm 13,13,22
Vm 14,14,22
Vm 15,15,22
Aw 8,8
Aw 9,9
Aw 10,10
Aw 11,11
Aw 12,12
Aw 13,13
Aw 14,14
Aw 15,15
Ar 8,16
Ar 9,17
Ar 10,18
Ar 11,19
Ar 12,20
Ar 13,21
Ar 14,22
Ar 15,23
Vm 8,8,22
Vm 9,9,22
Vm 10,10,22
Vm 11,11,22
Vm 12,12,22
Vm 13,13,22
Vm 14,14,22
Vm 15,15,22
Aw 16,8
Aw 17,9
Aw 18,10
Aw 19,11
Aw 20,12
Aw 21,13
Aw 22,14
Aw 23,15
Ar 8,24
Ar 9,25
Ar 10,26
Ar 11,27
Ar 12,28
Ar 13,29
Ar 14,30
Ar 15,31
Vm 8,8,22
Vm 9,9,22
Vm 10,10,22
Vm 11,11,22
Vm 12,12,22
Vm 13,13,22
Vm 14,14,22
Vm 15,15,22
Aw 24,8
Aw 25,9
Aw 26,10
Aw 27,11
Aw 28,12
Aw 29,13
Aw 30,14
Aw 31,15
v_max3_f32 v21, v208, v209, v210
v_max3_f32 v21, v21, v211, v212
v_max3_f32 v21, v21, v213, v214
v_max3_f32 v21, v21, v215, v216
v_max3_f32 v21, v21, v217, v218
v_max3_f32 v21, v21, v219, v220
v_max3_f32 v21, v21, v221, v222
v_max_f32 v21, v21, v223
v_mov_b32 v1, v21
s_nop 1
v_permlane16_swap_b32 v1, v21
v_max_f32 v21, v21, v1
v_mov_b32 v1, v21
s_nop 1
v_permlane32_swap_b32 v1, v21
v_max_f32 v21, v21, v1
v_add_f32 v21, 0x41f80000, v21
v_max_f32 v21, 0, v21
Vs 208,208,21
Vs 209,209,21
Vs 210,210,21
Vs 211,211,21
Vs 212,212,21
Vs 213,213,21
Vs 214,214,21
Vs 215,215,21
Vs 216,216,21
Vs 217,217,21
Vs 218,218,21
Vs 219,219,21
Vs 220,220,21
Vs 221,221,21
Vs 222,222,21
Vs 223,223,21
Vs 144,144,21
Vs 145,145,21
Vs 146,146,21
Vs 147,147,21
Vs 148,148,21
Vs 149,149,21
Vs 150,150,21
Vs 151,151,21
Vs 152,152,21
Vs 153,153,21
Vs 154,154,21
Vs 155,155,21
Vs 156,156,21
Vs 157,157,21
Vs 158,158,21
Vs 159,159,21
Vs 36,36,21
Vs 37,37,21
Vs 38,38,21
Vs 39,39,21
v_exp_f32 v22, -v21
s_nop 0
Vm 52,52,22
Vm 53,53,22
Vm 54,54,22
Vm 55,55,22
Ar 8,32
Ar 9,33
Ar 10,34
Ar 11,35
Ar 12,36
Ar 13,37
Ar 14,38
Ar 15,39
Vm 8,8,22
Vm 9,9,22
Vm 10,10,22
Vm 11,11,22
Vm 12,12,22
Vm 13,13,22
Vm 14,14,22
Vm 15,15,22
Aw 32,8
Aw 33,9
Aw 34,10
Aw 35,11
Aw 36,12
Aw 37,13
Aw 38,14
Aw 39,15
Ar 8,40
Ar 9,41
Ar 10,42
Ar 11,43
Ar 12,44
Ar 13,45
Ar 14,46
Ar 15,47
Vm 8,8,22
Vm 9,9,22
Vm 10,10,22
Vm 11,11,22
Vm 12,12,22
Vm 13,13,22
Vm 14,14,22
Vm 15,15,22
Aw 40,8
Aw 41,9
Aw 42,10
Aw 43,11
Aw 44,12
Aw 45,13
Aw 46,14
Aw 47,15
Ar 8,48
Ar 9,49
Ar 10,50
Ar 11,51
Ar 12,52
Ar 13,53
Ar 14,54
Ar 15,55
Vm 8,8,22
Vm 9,9,22
Vm 10,10,22
Vm 11,11,22
Vm 12,12,22
Vm 13,13,22
Vm 14,14,22
Vm 15,15,22
Aw 48,8
Aw 49,9
Aw 50,10
Aw 51,11
Aw 52,12
Aw 53,13
Aw 54,14
Aw 55,15
Ar 8,56
Ar 9,57
Ar 10,58
Ar 11,59
Ar 12,60
Ar 13,61
Ar 14,62
Ar 15,63
Vm 8,8,22
Vm 9,9,22
Vm 10,10,22
Vm 11,11,22
Vm 12,12,22
Vm 13,13,22
Vm 14,14,22
Vm 15,15,22
Aw 56,8
Aw 57,9
Aw 58,10
Aw 59,11
Aw 60,12
Aw 61,13
Aw 62,14
Aw 63,15
v_max3_f32 v21, v224, v225, v226
v_max3_f32 v21, v21, v227, v228
v_max3_f32 v21, v21, v229, v230
v_max3_f32 v21, v21, v231, v232
v_max3_f32 v21, v21, v233, v234
v_max3_f32 v21, v21, v235, v236
v_max3_f32 v21, v21, v237, v238
v_max_f32 v21, v21, v239
v_mov_b32 v1, v21
s_nop 1
v_permlane16_swap_b32 v1, v21
v_max_f32 v21, v21, v1
v_mov_b32 v1, v21
s_nop 1
v_permlane32_swap_b32 v1, v21
v_max_f32 v21, v21, v1
v_add_f32 v21, 0x41f80000, v21
v_max_f32 v21, 0, v21
Vs 224,224,21
Vs 225,225,21
Vs 226,226,21
Vs 227,227,21
Vs 228,228,21
Vs 229,229,21
Vs 230,230,21
Vs 231,231,21
Vs 232,232,21
Vs 233,233,21
Vs 234,234,21
Vs 235,235,21
Vs 236,236,21
Vs 237,237,21
Vs 238,238,21
Vs 239,239,21
Vs 160,160,21
Vs 161,161,21
Vs 162,162,21
Vs 163,163,21
Vs 164,164,21
Vs 165,165,21
Vs 166,166,21
Vs 167,167,21
Vs 168,168,21
Vs 169,169,21
Vs 170,170,21
Vs 171,171,21
Vs 172,172,21
Vs 173,173,21
Vs 174,174,21
Vs 175,175,21
Vs 40,40,21
Vs 41,41,21
Vs 42,42,21
Vs 43,43,21
v_exp_f32 v22, -v21
s_nop 0
Vm 56,56,22
Vm 57,57,22
Vm 58,58,22
Vm 59,59,22
Ar 8,64
Ar 9,65
Ar 10,66
Ar 11,67
Ar 12,68
Ar 13,69
Ar 14,70
Ar 15,71
Vm 8,8,22
Vm 9,9,22
Vm 10,10,22
Vm 11,11,22
Vm 12,12,22
Vm 13,13,22
Vm 14,14,22
Vm 15,15,22
Aw 64,8
Aw 65,9
Aw 66,10
Aw 67,11
Aw 68,12
Aw 69,13
Aw 70,14
Aw 71,15
Ar 8,72
Ar 9,73
Ar 10,74
Ar 11,75
Ar 12,76
Ar 13,77
Ar 14,78
Ar 15,79
Vm 8,8,22
Vm 9,9,22
Vm 10,10,22
Vm 11,11,22
Vm 12,12,22
Vm 13,13,22
Vm 14,14,22
Vm 15,15,22
Aw 72,8
Aw 73,9
Aw 74,10
Aw 75,11
Aw 76,12
Aw 77,13
Aw 78,14
Aw 79,15
Ar 8,80
Ar 9,81
Ar 10,82
Ar 11,83
Ar 12,84
Ar 13,85
Ar 14,86
Ar 15,87
Vm 8,8,22
Vm 9,9,22
Vm 10,10,22
Vm 11,11,22
Vm 12,12,22
Vm 13,13,22
Vm 14,14,22
Vm 15,15,22
Aw 80,8
Aw 81,9
Aw 82,10
Aw 83,11
Aw 84,12
Aw 85,13
Aw 86,14
Aw 87,15
Ar 8,88
Ar 9,89
Ar 10,90
Ar 11,91
Ar 12,92
Ar 13,93
Ar 14,94
Ar 15,95
Vm 8,8,22
Vm 9,9,22
Vm 10,10,22
Vm 11,11,22
Vm 12,12,22
Vm 13,13,22
Vm 14,14,22
Vm 15,15,22
Aw 88,8
Aw 89,9
Aw 90,10
Aw 91,11
Aw 92,12
Aw 93,13
Aw 94,14
Aw 95,15
v_max3_f32 v21, v240, v241, v242
v_max3_f32 v21, v21, v243, v244
v_max3_f32 v21, v21, v245, v246
v_max3_f32 v21, v21, v247, v248
v_max3_f32 v21, v21, v249, v250
v_max3_f32 v21, v21, v251, v252
v_max3_f32 v21, v21, v253, v254
v_max_f32 v21, v21, v255
v_mov_b32 v1, v21
s_nop 1
v_permlane16_swap_b32 v1, v21
v_max_f32 v21, v21, v1
v_mov_b32 v1, v21
s_nop 1
v_permlane32_swap_b32 v1, v21
v_max_f32 v21, v21, v1
v_add_f32 v21, 0x41f80000, v21
v_max_f32 v21, 0, v21
Vs 240,240,21
Vs 241,241,21
Vs 242,242,21
Vs 243,243,21
Vs 244,244,21
Vs 245,245,21
Vs 246,246,21
Vs 247,247,21
Vs 248,248,21
Vs 249,249,21
Vs 250,250,21
Vs 251,251,21
Vs 252,252,21
Vs 253,253,21
Vs 254,254,21
Vs 255,255,21
Vs 176,176,21
Vs 177,177,21
Vs 178,178,21
Vs 179,179,21
Vs 180,180,21
Vs 181,181,21
Vs 182,182,21
Vs 183,183,21
Vs 184,184,21
Vs 185,185,21
Vs 186,186,21
Vs 187,187,21
Vs 188,188,21
Vs 189,189,21
Vs 190,190,21
Vs 191,191,21
Vs 44,44,21
Vs 45,45,21
Vs 46,46,21
Vs 47,47,21
v_exp_f32 v22, -v21
s_nop 0
Vm 60,60,22
Vm 61,61,22
Vm 62,62,22
Vm 63,63,22
Ar 8,96
Ar 9,97
Ar 10,98
Ar 11,99
Ar 12,100
Ar 13,101
Ar 14,102
Ar 15,103
Vm 8,8,22
Vm 9,9,22
Vm 10,10,22
Vm 11,11,22
Vm 12,12,22
Vm 13,13,22
Vm 14,14,22
Vm 15,15,22
Aw 96,8
Aw 97,9
Aw 98,10
Aw 99,11
Aw 100,12
Aw 101,13
Aw 102,14
Aw 103,15
Ar 8,104
Ar 9,105
Ar 10,106
Ar 11,107
Ar 12,108
Ar 13,109
Ar 14,110
Ar 15,111
Vm 8,8,22
Vm 9,9,22
Vm 10,10,22
Vm 11,11,22
Vm 12,12,22
Vm 13,13,22
Vm 14,14,22
Vm 15,15,22
Aw 104,8
Aw 105,9
Aw 106,10
Aw 107,11
Aw 108,12
Aw 109,13
Aw 110,14
Aw 111,15
Ar 8,112
Ar 9,113
Ar 10,114
Ar 11,115
Ar 12,116
Ar 13,117
Ar 14,118
Ar 15,119
Vm 8,8,22
Vm 9,9,22
Vm 10,10,22
Vm 11,11,22
Vm 12,12,22
Vm 13,13,22
Vm 14,14,22
Vm 15,15,22
Aw 112,8
Aw 113,9
Aw 114,10
Aw 115,11
Aw 116,12
Aw 117,13
Aw 118,14
Aw 119,15
Ar 8,120
Ar 9,121
Ar 10,122
Ar 11,123
Ar 12,124
Ar 13,125
Ar 14,126
Ar 15,127
Vm 8,8,22
Vm 9,9,22
Vm 10,10,22
Vm 11,11,22
Vm 12,12,22
Vm 13,13,22
Vm 14,14,22
Vm 15,15,22
Aw 120,8
Aw 121,9
Aw 122,10
Aw 123,11
Aw 124,12
Aw 125,13
Aw 126,14
Aw 127,15
Ve 8,192
Ve 9,193
s_nop 0
Vc 96,8,9
Ve 8,194
Ve 9,195
s_nop 0
Vc 97,8,9
Ve 8,208
Ve 9,209
s_nop 0
Vc 104,8,9
Ve 8,210
Ve 9,211
s_nop 0
Vc 105,8,9
Ve 8,224
Ve 9,225
s_nop 0
Vc 112,8,9
Ve 8,226
Ve 9,227
s_nop 0
Vc 113,8,9
Ve 8,240
Ve 9,241
s_nop 0
Vc 120,8,9
Ve 8,242
Ve 9,243
s_nop 0
Vc 121,8,9
Ve 8,196
Ve 9,197
s_nop 0
Vc 98,8,9
Ve 8,198
Ve 9,199
s_nop 0
Vc 99,8,9
Ve 8,212
Ve 9,213
s_nop 0
Vc 106,8,9
Ve 8,214
Ve 9,215
s_nop 0
Vc 107,8,9
Ve 8,228
Ve 9,229
s_nop 0
Vc 114,8,9
Ve 8,230
Ve 9,231
s_nop 0
Vc 115,8,9
Ve 8,244
Ve 9,245
s_nop 0
Vc 122,8,9
Ve 8,246
Ve 9,247
s_nop 0
Vc 123,8,9
Ve 8,200
Ve 9,201
s_nop 0
Vc 100,8,9
Ve 8,202
Ve 9,203
s_nop 0
Vc 101,8,9
Ve 8,216
Ve 9,217
s_nop 0
Vc 108,8,9
Ve 8,218
Ve 9,219
s_nop 0
Vc 109,8,9
Ve 8,232
Ve 9,233
s_nop 0
Vc 116,8,9
Ve 8,234
Ve 9,235
s_nop 0
Vc 117,8,9
Ve 8,248
Ve 9,249
s_nop 0
Vc 124,8,9
Ve 8,250
Ve 9,251
s_nop 0
Vc 125,8,9
Ve 8,204
Ve 9,205
s_nop 0
Vc 102,8,9
Ve 8,206
Ve 9,207
s_nop 0
Vc 103,8,9
Ve 8,220
Ve 9,221
s_nop 0
Vc 110,8,9
Ve 8,222
Ve 9,223
s_nop 0
Vc 111,8,9
Ve 8,236
Ve 9,237
s_nop 0
Vc 118,8,9
Ve 8,238
Ve 9,239
s_nop 0
Vc 119,8,9
Ve 8,252
Ve 9,253
s_nop 0
Vc 126,8,9
Ve 8,254
Ve 9,255
s_nop 0
Vc 127,8,9
s_nop 1
s_branch L_k2_fbr_wo
L_k2_mk_wo:
s_nop 7
s_add_u32 s3, s37, 1
s_lshl_b32 s3, s3, 6
v_subrev_u32 v1, s3, v6
v_cmp_gt_i32 s[56:57], -16, v1
v_cmp_gt_i32 s[58:59], -15, v1
v_cmp_gt_i32 s[60:61], -14, v1
v_cmp_gt_i32 s[62:63], -13, v1
v_cndmask_b32 v176, v176, v20, s[56:57]
v_cndmask_b32 v177, v177, v20, s[58:59]
v_cndmask_b32 v178, v178, v20, s[60:61]
v_cndmask_b32 v179, v179, v20, s[62:63]
v_cmp_gt_i32 s[56:57], 0, v1
v_cmp_gt_i32 s[58:59], 1, v1
v_cmp_gt_i32 s[60:61], 2, v1
v_cmp_gt_i32 s[62:63], 3, v1
v_cndmask_b32 v160, v160, v20, s[56:57]
v_cndmask_b32 v161, v161, v20, s[58:59]
v_cndmask_b32 v162, v162, v20, s[60:61]
v_cndmask_b32 v163, v163, v20, s[62:63]
v_cndmask_b32 v180, v180, v20, s[56:57]
v_cndmask_b32 v181, v181, v20, s[58:59]
v_cndmask_b32 v182, v182, v20, s[60:61]
v_cndmask_b32 v183, v183, v20, s[62:63]
v_cmp_gt_i32 s[56:57], 16, v1
v_cmp_gt_i32 s[58:59], 17, v1
v_cmp_gt_i32 s[60:61], 18, v1
v_cmp_gt_i32 s[62:63], 19, v1
v_cndmask_b32 v164, v164, v20, s[56:57]
v_cndmask_b32 v165, v165, v20, s[58:59]
v_cndmask_b32 v166, v166, v20, s[60:61]
v_cndmask_b32 v167, v167, v20, s[62:63]
v_cndmask_b32 v184, v184, v20, s[56:57]
v_cndmask_b32 v185, v185, v20, s[58:59]
v_cndmask_b32 v186, v186, v20, s[60:61]
v_cndmask_b32 v187, v187, v20, s[62:63]
v_cmp_gt_i32 s[56:57], 32, v1
v_cmp_gt_i32 s[58:59], 33, v1
v_cmp_gt_i32 s[60:61], 34, v1
v_cmp_gt_i32 s[62:63], 35, v1
v_cndmask_b32 v168, v168, v20, s[56:57]
v_cndmask_b32 v169, v169, v20, s[58:59]
v_cndmask_b32 v170, v170, v20, s[60:61]
v_cndmask_b32 v171, v171, v20, s[62:63]
v_cndmask_b32 v188, v188, v20, s[56:57]
v_cndmask_b32 v189, v189, v20, s[58:59]
v_cndmask_b32 v190, v190, v20, s[60:61]
v_cndmask_b32 v191, v191, v20, s[62:63]
v_cmp_gt_i32 s[56:57], 48, v1
v_cmp_gt_i32 s[58:59], 49, v1
v_cmp_gt_i32 s[60:61], 50, v1
v_cmp_gt_i32 s[62:63], 51, v1
v_cndmask_b32 v172, v172, v20, s[56:57]
v_cndmask_b32 v173, v173, v20, s[58:59]
v_cndmask_b32 v174, v174, v20, s[60:61]
v_cndmask_b32 v175, v175, v20, s[62:63]
s_nop 1
s_branch L_k2_mkr_wo
L_k2_fb_tr:
s_nop 7
v_max3_f32 v21, v192, v193, v194
v_max3_f32 v21, v21, v195, v196
v_max3_f32 v21, v21, v197, v198
v_max3_f32 v21, v21, v199, v200
v_max3_f32 v21, v21, v201, v202
v_max3_f32 v21, v21, v203, v204
v_max3_f32 v21, v21, v205, v206
v_max_f32 v21, v21, v207
v_mov_b32 v1, v21
s_nop 1
v_permlane16_swap_b32 v1, v21
v_max_f32 v21, v21, v1
v_mov_b32 v1, v21
s_nop 1
v_permlane32_swap_b32 v1, v21
v_max_f32 v21, v21, v1
v_add_f32 v21, 0x41f80000, v21
v_max_f32 v21, 0, v21
Vs 192,192,21
Vs 193,193,21
Vs 194,194,21
Vs 195,195,21
Vs 196,196,21
Vs 197,197,21
Vs 198,198,21
Vs 199,199,21
Vs 200,200,21
Vs 201,201,21
Vs 202,202,21
Vs 203,203,21
Vs 204,204,21
Vs 205,205,21
Vs 206,206,21
Vs 207,207,21
Vs 128,128,21
Vs 129,129,21
Vs 130,130,21
Vs 131,131,21
Vs 132,132,21
Vs 133,133,21
Vs 134,134,21
Vs 135,135,21
Vs 136,136,21
Vs 137,137,21
Vs 138,138,21
Vs 139,139,21
Vs 140,140,21
Vs 141,141,21
Vs 142,142,21
Vs 143,143,21
Vs 32,32,21
Vs 33,33,21
Vs 34,34,21
Vs 35,35,21
v_exp_f32 v22, -v21
s_nop 0
Vm 48,48,22
Vm 49,49,22
Vm 50,50,22
Vm 51,51,22
Ar 8,0
Ar 9,1
Ar 10,2
Ar 11,3
Ar 12,4
Ar 13,5
Ar 14,6
Ar 15,7
Vm 8,8,22
Vm 9,9,22
Vm 10,10,22
Vm 11,11,22
Vm 12,12,22
Vm 13,13,22
Vm 14,14,22
Vm 15,15,22
Aw 0,8
Aw 1,9
Aw 2,10
Aw 3,11
Aw 4,12
Aw 5,13
Aw 6,14
Aw 7,15
Ar 8,8
Ar 9,9
Ar 10,10
Ar 11,11
Ar 12,12
Ar 13,13
Ar 14,14
Ar 15,15
Vm 8,8,22
Vm 9,9,22
Vm 10,10,22
Vm 11,11,22
Vm 12,12,22
Vm 13,13,22
Vm 14,14,22
Vm 15,15,22
Aw 8,8
Aw 9,9
Aw 10,10
Aw 11,11
Aw 12,12
Aw 13,13
Aw 14,14
Aw 15,15
Ar 8,16
Ar 9,17
Ar 10,18
Ar 11,19
Ar 12,20
Ar 13,21
Ar 14,22
Ar 15,23
Vm 8,8,22
Vm 9,9,22
Vm 10,10,22
Vm 11,11,22
Vm 12,12,22
Vm 13,13,22
Vm 14,14,22
Vm 15,15,22
Aw 16,8
Aw 17,9
Aw 18,10
Aw 19,11
Aw 20,12
Aw 21,13
Aw 22,14
Aw 23,15
Ar 8,24
Ar 9,25
Ar 10,26
Ar 11,27
Ar 12,28
Ar 13,29
Ar 14,30
Ar 15,31
Vm 8,8,22
Vm 9,9,22
Vm 10,10,22
Vm 11,11,22
Vm 12,12,22
Vm 13,13,22
Vm 14,14,22
Vm 15,15,22
Aw 24,8
Aw 25,9
Aw 26,10
Aw 27,11
Aw 28,12
Aw 29,13
Aw 30,14
Aw 31,15
v_max3_f32 v21, v208, v209, v210
v_max3_f32 v21, v21, v211, v212
v_max3_f32 v21, v21, v213, v214
v_max3_f32 v21, v21, v215, v216
v_max3_f32 v21, v21, v217, v218
v_max3_f32 v21, v21, v219, v220
v_max3_f32 v21, v21, v221, v222
v_max_f32 v21, v21, v223
v_mov_b32 v1, v21
s_nop 1
v_permlane16_swap_b32 v1, v21
v_max_f32 v21, v21, v1
v_mov_b32 v1, v21
s_nop 1
v_permlane32_swap_b32 v1, v21
v_max_f32 v21, v21, v1
v_add_f32 v21, 0x41f80000, v21
v_max_f32 v21, 0, v21
Vs 208,208,21
Vs 209,209,21
Vs 210,210,21
Vs 211,211,21
Vs 212,212,21
Vs 213,213,21
Vs 214,214,21
Vs 215,215,21
Vs 216,216,21
Vs 217,217,21
Vs 218,218,21
Vs 219,219,21
Vs 220,220,21
Vs 221,221,21
Vs 222,222,21
Vs 223,223,21
Vs 144,144,21
Vs 145,145,21
Vs 146,146,21
Vs 147,147,21
Vs 148,148,21
Vs 149,149,21
Vs 150,150,21
Vs 151,151,21
Vs 152,152,21
Vs 153,153,21
Vs 154,154,21
Vs 155,155,21
Vs 156,156,21
Vs 157,157,21
Vs 158,158,21
Vs 159,159,21
Vs 36,36,21
Vs 37,37,21
Vs 38,38,21
Vs 39,39,21
v_exp_f32 v22, -v21
s_nop 0
Vm 52,52,22
Vm 53,53,22
Vm 54,54,22
Vm 55,55,22
Ar 8,32
Ar 9,33
Ar 10,34
Ar 11,35
Ar 12,36
Ar 13,37
Ar 14,38
Ar 15,39
Vm 8,8,22
Vm 9,9,22
Vm 10,10,22
Vm 11,11,22
Vm 12,12,22
Vm 13,13,22
Vm 14,14,22
Vm 15,15,22
Aw 32,8
Aw 33,9
Aw 34,10
Aw 35,11
Aw 36,12
Aw 37,13
Aw 38,14
Aw 39,15
Ar 8,40
Ar 9,41
Ar 10,42
Ar 11,43
Ar 12,44
Ar 13,45
Ar 14,46
Ar 15,47
Vm 8,8,22
Vm 9,9,22
Vm 10,10,22
Vm 11,11,22
Vm 12,12,22
Vm 13,13,22
Vm 14,14,22
Vm 15,15,22
Aw 40,8
Aw 41,9
Aw 42,10
Aw 43,11
Aw 44,12
Aw 45,13
Aw 46,14
Aw 47,15
Ar 8,48
Ar 9,49
Ar 10,50
Ar 11,51
Ar 12,52
Ar 13,53
Ar 14,54
Ar 15,55
Vm 8,8,22
Vm 9,9,22
Vm 10,10,22
Vm 11,11,22
Vm 12,12,22
Vm 13,13,22
Vm 14,14,22
Vm 15,15,22
Aw 48,8
Aw 49,9
Aw 50,10
Aw 51,11
Aw 52,12
Aw 53,13
Aw 54,14
Aw 55,15
Ar 8,56
Ar 9,57
Ar 10,58
Ar 11,59
Ar 12,60
Ar 13,61
Ar 14,62
Ar 15,63
Vm 8,8,22
Vm 9,9,22
Vm 10,10,22
Vm 11,11,22
Vm 12,12,22
Vm 13,13,22
Vm 14,14,22
Vm 15,15,22
Aw 56,8
Aw 57,9
Aw 58,10
Aw 59,11
Aw 60,12
Aw 61,13
Aw 62,14
Aw 63,15
v_max3_f32 v21, v224, v225, v226
v_max3_f32 v21, v21, v227, v228
v_max3_f32 v21, v21, v229, v230
v_max3_f32 v21, v21, v231, v232
v_max3_f32 v21, v21, v233, v234
v_max3_f32 v21, v21, v235, v236
v_max3_f32 v21, v21, v237, v238
v_max_f32 v21, v21, v239
v_mov_b32 v1, v21
s_nop 1
v_permlane16_swap_b32 v1, v21
v_max_f32 v21, v21, v1
v_mov_b32 v1, v21
s_nop 1
v_permlane32_swap_b32 v1, v21
v_max_f32 v21, v21, v1
v_add_f32 v21, 0x41f80000, v21
v_max_f32 v21, 0, v21
Vs 224,224,21
Vs 225,225,21
Vs 226,226,21
Vs 227,227,21
Vs 228,228,21
Vs 229,229,21
Vs 230,230,21
Vs 231,231,21
Vs 232,232,21
Vs 233,233,21
Vs 234,234,21
Vs 235,235,21
Vs 236,236,21
Vs 237,237,21
Vs 238,238,21
Vs 239,239,21
Vs 40,40,21
Vs 41,41,21
Vs 42,42,21
Vs 43,43,21
v_exp_f32 v22, -v21
s_nop 0
Vm 56,56,22
Vm 57,57,22
Vm 58,58,22
Vm 59,59,22
Ar 8,64
Ar 9,65
Ar 10,66
Ar 11,67
Ar 12,68
Ar 13,69
Ar 14,70
Ar 15,71
Vm 8,8,22
Vm 9,9,22
Vm 10,10,22
Vm 11,11,22
Vm 12,12,22
Vm 13,13,22
Vm 14,14,22
Vm 15,15,22
Aw 64,8
Aw 65,9
Aw 66,10
Aw 67,11
Aw 68,12
Aw 69,13
Aw 70,14
Aw 71,15
Ar 8,72
Ar 9,73
Ar 10,74
Ar 11,75
Ar 12,76
Ar 13,77
Ar 14,78
Ar 15,79
Vm 8,8,22
Vm 9,9,22
Vm 10,10,22
Vm 11,11,22
Vm 12,12,22
Vm 13,13,22
Vm 14,14,22
Vm 15,15,22
Aw 72,8
Aw 73,9
Aw 74,10
Aw 75,11
Aw 76,12
Aw 77,13
Aw 78,14
Aw 79,15
Ar 8,80
Ar 9,81
Ar 10,82
Ar 11,83
Ar 12,84
Ar 13,85
Ar 14,86
Ar 15,87
Vm 8,8,22
Vm 9,9,22
Vm 10,10,22
Vm 11,11,22
Vm 12,12,22
Vm 13,13,22
Vm 14,14,22
Vm 15,15,22
Aw 80,8
Aw 81,9
Aw 82,10
Aw 83,11
Aw 84,12
Aw 85,13
Aw 86,14
Aw 87,15
Ar 8,88
Ar 9,89
Ar 10,90
Ar 11,91
Ar 12,92
Ar 13,93
Ar 14,94
Ar 15,95
Vm 8,8,22
Vm 9,9,22
Vm 10,10,22
Vm 11,11,22
Vm 12,12,22
Vm 13,13,22
Vm 14,14,22
Vm 15,15,22
Aw 88,8
Aw 89,9
Aw 90,10
Aw 91,11
Aw 92,12
Aw 93,13
Aw 94,14
Aw 95,15
v_max3_f32 v21, v240, v241, v242
v_max3_f32 v21, v21, v243, v244
v_max3_f32 v21, v21, v245, v246
v_max3_f32 v21, v21, v247, v248
v_max3_f32 v21, v21, v249, v250
v_max3_f32 v21, v21, v251, v252
v_max3_f32 v21, v21, v253, v254
v_max_f32 v21, v21, v255
v_mov_b32 v1, v21
s_nop 1
v_permlane16_swap_b32 v1, v21
v_max_f32 v21, v21, v1
v_mov_b32 v1, v21
s_nop 1
v_permlane32_swap_b32 v1, v21
v_max_f32 v21, v21, v1
v_add_f32 v21, 0x41f80000, v21
v_max_f32 v21, 0, v21
Vs 240,240,21
Vs 241,241,21
Vs 242,242,21
Vs 243,243,21
Vs 244,244,21
Vs 245,245,21
Vs 246,246,21
Vs 247,247,21
Vs 248,248,21
Vs 249,249,21
Vs 250,250,21
Vs 251,251,21
Vs 252,252,21
Vs 253,253,21
Vs 254,254,21
Vs 255,255,21
Vs 44,44,21
Vs 45,45,21
Vs 46,46,21
Vs 47,47,21
v_exp_f32 v22, -v21
s_nop 0
Vm 60,60,22
Vm 61,61,22
Vm 62,62,22
Vm 63,63,22
Ar 8,96
Ar 9,97
Ar 10,98
Ar 11,99
Ar 12,100
Ar 13,101
Ar 14,102
Ar 15,103
Vm 8,8,22
Vm 9,9,22
Vm 10,10,22
Vm 11,11,22
Vm 12,12,22
Vm 13,13,22
Vm 14,14,22
Vm 15,15,22
Aw 96,8
Aw 97,9
Aw 98,10
Aw 99,11
Aw 100,12
Aw 101,13
Aw 102,14
Aw 103,15
Ar 8,104
Ar 9,105
Ar 10,106
Ar 11,107
Ar 12,108
Ar 13,109
Ar 14,110
Ar 15,111
Vm 8,8,22
Vm 9,9,22
Vm 10,10,22
Vm 11,11,22
Vm 12,12,22
Vm 13,13,22
Vm 14,14,22
Vm 15,15,22
Aw 104,8
Aw 105,9
Aw 106,10
Aw 107,11
Aw 108,12
Aw 109,13
Aw 110,14
Aw 111,15
Ar 8,112
Ar 9,113
Ar 10,114
Ar 11,115
Ar 12,116
Ar 13,117
Ar 14,118
Ar 15,119
Vm 8,8,22
Vm 9,9,22
Vm 10,10,22
Vm 11,11,22
Vm 12,12,22
Vm 13,13,22
Vm 14,14,22
Vm 15,15,22
Aw 112,8
Aw 113,9
Aw 114,10
Aw 115,11
Aw 116,12
Aw 117,13
Aw 118,14
Aw 119,15
Ar 8,120
Ar 9,121
Ar 10,122
Ar 11,123
Ar 12,124
Ar 13,125
Ar 14,126
Ar 15,127
Vm 8,8,22
Vm 9,9,22
Vm 10,10,22
Vm 11,11,22
Vm 12,12,22
Vm 13,13,22
Vm 14,14,22
Vm 15,15,22
Aw 120,8
Aw 121,9
Aw 122,10
Aw 123,11
Aw 124,12
Aw 125,13
Aw 126,14
Aw 127,15
Ve 8,192
Ve 9,193
s_nop 0
Vc 96,8,9
Ve 8,194
Ve 9,195
s_nop 0
Vc 97,8,9
Ve 8,208
Ve 9,209
s_nop 0
Vc 104,8,9
Ve 8,210
Ve 9,211
s_nop 0
Vc 105,8,9
Ve 8,224
Ve 9,225
s_nop 0
Vc 112,8,9
Ve 8,226
Ve 9,227
s_nop 0
Vc 113,8,9
Ve 8,240
Ve 9,241
s_nop 0
Vc 120,8,9
Ve 8,242
Ve 9,243
s_nop 0
Vc 121,8,9
Ve 8,196
Ve 9,197
s_nop 0
Vc 98,8,9
Ve 8,198
Ve 9,199
s_nop 0
Vc 99,8,9
Ve 8,212
Ve 9,213
s_nop 0
Vc 106,8,9
Ve 8,214
Ve 9,215
s_nop 0
Vc 107,8,9
Ve 8,228
Ve 9,229
s_nop 0
Vc 114,8,9
Ve 8,230
Ve 9,231
s_nop 0
Vc 115,8,9
Ve 8,244
Ve 9,245
s_nop 0
Vc 122,8,9
Ve 8,246
Ve 9,247
s_nop 0
Vc 123,8,9
Ve 8,200
Ve 9,201
s_nop 0
Vc 100,8,9
Ve 8,202
Ve 9,203
s_nop 0
Vc 101,8,9
Ve 8,216
Ve 9,217
s_nop 0
Vc 108,8,9
Ve 8,218
Ve 9,219
s_nop 0
Vc 109,8,9
Ve 8,232
Ve 9,233
s_nop 0
Vc 116,8,9
Ve 8,234
Ve 9,235
s_nop 0
Vc 117,8,9
Ve 8,248
Ve 9,249
s_nop 0
Vc 124,8,9
Ve 8,250
Ve 9,251
s_nop 0
Vc 125,8,9
Ve 8,204
Ve 9,205
s_nop 0
Vc 102,8,9
Ve 8,206
Ve 9,207
s_nop 0
Vc 103,8,9
Ve 8,220
Ve 9,221
s_nop 0
Vc 110,8,9
Ve 8,222
Ve 9,223
s_nop 0
Vc 111,8,9
Ve 8,236
Ve 9,237
s_nop 0
Vc 118,8,9
Ve 8,238
Ve 9,239
s_nop 0
Vc 119,8,9
Ve 8,252
Ve 9,253
s_nop 0
Vc 126,8,9
Ve 8,254
Ve 9,255
s_nop 0
Vc 127,8,9
s_nop 1
s_branch L_k2_fbr_tr
L_k2_mk_tr:
s_nop 7
s_add_u32 s3, s37, 1
s_lshl_b32 s3, s3, 6
v_subrev_u32 v1, s3, v5
v_cmp_gt_i32 s[56:57], -16, v1
v_cmp_gt_i32 s[58:59], -15, v1
v_cmp_gt_i32 s[60:61], -14, v1
v_cmp_gt_i32 s[62:63], -13, v1
v_cndmask_b32 v144, v144, v20, s[56:57]
v_cndmask_b32 v145, v145, v20, s[58:59]
v_cndmask_b32 v146, v146, v20, s[60:61]
v_cndmask_b32 v147, v147, v20, s[62:63]
v_cmp_gt_i32 s[56:57], 0, v1
v_cmp_gt_i32 s[58:59], 1, v1
v_cmp_gt_i32 s[60:61], 2, v1
v_cmp_gt_i32 s[62:63], 3, v1
v_cndmask_b32 v128, v128, v20, s[56:57]
v_cndmask_b32 v129, v129, v20, s[58:59]
v_cndmask_b32 v130, v130, v20, s[60:61]
v_cndmask_b32 v131, v131, v20, s[62:63]
v_cndmask_b32 v148, v148, v20, s[56:57]
v_cndmask_b32 v149, v149, v20, s[58:59]
v_cndmask_b32 v150, v150, v20, s[60:61]
v_cndmask_b32 v151, v151, v20, s[62:63]
v_cmp_gt_i32 s[56:57], 16, v1
v_cmp_gt_i32 s[58:59], 17, v1
v_cmp_gt_i32 s[60:61], 18, v1
v_cmp_gt_i32 s[62:63], 19, v1
v_cndmask_b32 v132, v132, v20, s[56:57]
v_cndmask_b32 v133, v133, v20, s[58:59]
v_cndmask_b32 v134, v134, v20, s[60:61]
v_cndmask_b32 v135, v135, v20, s[62:63]
v_cndmask_b32 v152, v152, v20, s[56:57]
v_cndmask_b32 v153, v153, v20, s[58:59]
v_cndmask_b32 v154, v154, v20, s[60:61]
v_cndmask_b32 v155, v155, v20, s[62:63]
v_cmp_gt_i32 s[56:57], 32, v1
v_cmp_gt_i32 s[58:59], 33, v1
v_cmp_gt_i32 s[60:61], 34, v1
v_cmp_gt_i32 s[62:63], 35, v1
v_cndmask_b32 v136, v136, v20, s[56:57]
v_cndmask_b32 v137, v137, v20, s[58:59]
v_cndmask_b32 v138, v138, v20, s[60:61]
v_cndmask_b32 v139, v139, v20, s[62:63]
v_cndmask_b32 v156, v156, v20, s[56:57]
v_cndmask_b32 v157, v157, v20, s[58:59]
v_cndmask_b32 v158, v158, v20, s[60:61]
v_cndmask_b32 v159, v159, v20, s[62:63]
v_cmp_gt_i32 s[56:57], 48, v1
v_cmp_gt_i32 s[58:59], 49, v1
v_cmp_gt_i32 s[60:61], 50, v1
v_cmp_gt_i32 s[62:63], 51, v1
v_cndmask_b32 v140, v140, v20, s[56:57]
v_cndmask_b32 v141, v141, v20, s[58:59]
v_cndmask_b32 v142, v142, v20, s[60:61]
v_cndmask_b32 v143, v143, v20, s[62:63]
s_nop 1
s_branch L_k2_mkr_tr
L_k2_fb_ne:
s_nop 7
v_max3_f32 v21, v128, v129, v130
v_max3_f32 v21, v21, v131, v132
v_max3_f32 v21, v21, v133, v134
v_max3_f32 v21, v21, v135, v136
v_max3_f32 v21, v21, v137, v138
v_max3_f32 v21, v21, v139, v140
v_max3_f32 v21, v21, v141, v142
v_max_f32 v21, v21, v143
v_mov_b32 v1, v21
s_nop 1
v_permlane16_swap_b32 v1, v21
v_max_f32 v21, v21, v1
v_mov_b32 v1, v21
s_nop 1
v_permlane32_swap_b32 v1, v21
v_max_f32 v21, v21, v1
v_add_f32 v21, 0x41f80000, v21
v_max_f32 v21, 0, v21
Vs 128,128,21
Vs 129,129,21
Vs 130,130,21
Vs 131,131,21
Vs 132,132,21
Vs 133,133,21
Vs 134,134,21
Vs 135,135,21
Vs 136,136,21
Vs 137,137,21
Vs 138,138,21
Vs 139,139,21
Vs 140,140,21
Vs 141,141,21
Vs 142,142,21
Vs 143,143,21
Vs 192,192,21
Vs 193,193,21
Vs 194,194,21
Vs 195,195,21
Vs 196,196,21
Vs 197,197,21
Vs 198,198,21
Vs 199,199,21
Vs 200,200,21
Vs 201,201,21
Vs 202,202,21
Vs 203,203,21
Vs 204,204,21
Vs 205,205,21
Vs 206,206,21
Vs 207,207,21
Vs 32,32,21
Vs 33,33,21
Vs 34,34,21
Vs 35,35,21
v_exp_f32 v22, -v21
s_nop 0
Vm 48,48,22
Vm 49,49,22
Vm 50,50,22
Vm 51,51,22
Ar 8,0
Ar 9,1
Ar 10,2
Ar 11,3
Ar 12,4
Ar 13,5
Ar 14,6
Ar 15,7
Vm 8,8,22
Vm 9,9,22
Vm 10,10,22
Vm 11,11,22
Vm 12,12,22
Vm 13,13,22
Vm 14,14,22
Vm 15,15,22
Aw 0,8
Aw 1,9
Aw 2,10
Aw 3,11
Aw 4,12
Aw 5,13
Aw 6,14
Aw 7,15
Ar 8,8
Ar 9,9
Ar 10,10
Ar 11,11
Ar 12,12
Ar 13,13
Ar 14,14
Ar 15,15
Vm 8,8,22
Vm 9,9,22
Vm 10,10,22
Vm 11,11,22
Vm 12,12,22
Vm 13,13,22
Vm 14,14,22
Vm 15,15,22
Aw 8,8
Aw 9,9
Aw 10,10
Aw 11,11
Aw 12,12
Aw 13,13
Aw 14,14
Aw 15,15
Ar 8,16
Ar 9,17
Ar 10,18
Ar 11,19
Ar 12,20
Ar 13,21
Ar 14,22
Ar 15,23
Vm 8,8,22
Vm 9,9,22
Vm 10,10,22
Vm 11,11,22
Vm 12,12,22
Vm 13,13,22
Vm 14,14,22
Vm 15,15,22
Aw 16,8
Aw 17,9
Aw 18,10
Aw 19,11
Aw 20,12
Aw 21,13
Aw 22,14
Aw 23,15
Ar 8,24
Ar 9,25
Ar 10,26
Ar 11,27
Ar 12,28
Ar 13,29
Ar 14,30
Ar 15,31
Vm 8,8,22
Vm 9,9,22
Vm 10,10,22
Vm 11,11,22
Vm 12,12,22
Vm 13,13,22
Vm 14,14,22
Vm 15,15,22
Aw 24,8
Aw 25,9
Aw 26,10
Aw 27,11
Aw 28,12
Aw 29,13
Aw 30,14
Aw 31,15
v_max3_f32 v21, v144, v145, v146
v_max3_f32 v21, v21, v147, v148
v_max3_f32 v21, v21, v149, v150
v_max3_f32 v21, v21, v151, v152
v_max3_f32 v21, v21, v153, v154
v_max3_f32 v21, v21, v155, v156
v_max3_f32 v21, v21, v157, v158
v_max_f32 v21, v21, v159
v_mov_b32 v1, v21
s_nop 1
v_permlane16_swap_b32 v1, v21
v_max_f32 v21, v21, v1
v_mov_b32 v1, v21
s_nop 1
v_permlane32_swap_b32 v1, v21
v_max_f32 v21, v21, v1
v_add_f32 v21, 0x41f80000, v21
v_max_f32 v21, 0, v21
Vs 144,144,21
Vs 145,145,21
Vs 146,146,21
Vs 147,147,21
Vs 148,148,21
Vs 149,149,21
Vs 150,150,21
Vs 151,151,21
Vs 152,152,21
Vs 153,153,21
Vs 154,154,21
Vs 155,155,21
Vs 156,156,21
Vs 157,157,21
Vs 158,158,21
Vs 159,159,21
Vs 208,208,21
Vs 209,209,21
Vs 210,210,21
Vs 211,211,21
Vs 212,212,21
Vs 213,213,21
Vs 214,214,21
Vs 215,215,21
Vs 216,216,21
Vs 217,217,21
Vs 218,218,21
Vs 219,219,21
Vs 220,220,21
Vs 221,221,21
Vs 222,222,21
Vs 223,223,21
Vs 36,36,21
Vs 37,37,21
Vs 38,38,21
Vs 39,39,21
v_exp_f32 v22, -v21
s_nop 0
Vm 52,52,22
Vm 53,53,22
Vm 54,54,22
Vm 55,55,22
Ar 8,32
Ar 9,33
Ar 10,34
Ar 11,35
Ar 12,36
Ar 13,37
Ar 14,38
Ar 15,39
Vm 8,8,22
Vm 9,9,22
Vm 10,10,22
Vm 11,11,22
Vm 12,12,22
Vm 13,13,22
Vm 14,14,22
Vm 15,15,22
Aw 32,8
Aw 33,9
Aw 34,10
Aw 35,11
Aw 36,12
Aw 37,13
Aw 38,14
Aw 39,15
Ar 8,40
Ar 9,41
Ar 10,42
Ar 11,43
Ar 12,44
Ar 13,45
Ar 14,46
Ar 15,47
Vm 8,8,22
Vm 9,9,22
Vm 10,10,22
Vm 11,11,22
Vm 12,12,22
Vm 13,13,22
Vm 14,14,22
Vm 15,15,22
Aw 40,8
Aw 41,9
Aw 42,10
Aw 43,11
Aw 44,12
Aw 45,13
Aw 46,14
Aw 47,15
Ar 8,48
Ar 9,49
Ar 10,50
Ar 11,51
Ar 12,52
Ar 13,53
Ar 14,54
Ar 15,55
Vm 8,8,22
Vm 9,9,22
Vm 10,10,22
Vm 11,11,22
Vm 12,12,22
Vm 13,13,22
Vm 14,14,22
Vm 15,15,22
Aw 48,8
Aw 49,9
Aw 50,10
Aw 51,11
Aw 52,12
Aw 53,13
Aw 54,14
Aw 55,15
Ar 8,56
Ar 9,57
Ar 10,58
Ar 11,59
Ar 12,60
Ar 13,61
Ar 14,62
Ar 15,63
Vm 8,8,22
Vm 9,9,22
Vm 10,10,22
Vm 11,11,22
Vm 12,12,22
Vm 13,13,22
Vm 14,14,22
Vm 15,15,22
Aw 56,8
Aw 57,9
Aw 58,10
Aw 59,11
Aw 60,12
Aw 61,13
Aw 62,14
Aw 63,15
Ve 8,128
Ve 9,129
s_nop 0
Vc 64,8,9
Ve 8,130
Ve 9,131
s_nop 0
Vc 65,8,9
Ve 8,144
Ve 9,145
s_nop 0
Vc 72,8,9
Ve 8,146
Ve 9,147
s_nop 0
Vc 73,8,9
Ve 8,132
Ve 9,133
s_nop 0
Vc 66,8,9
Ve 8,134
Ve 9,135
s_nop 0
Vc 67,8,9
Ve 8,148
Ve 9,149
s_nop 0
Vc 74,8,9
Ve 8,150
Ve 9,151
s_nop 0
Vc 75,8,9
Ve 8,136
Ve 9,137
s_nop 0
Vc 68,8,9
Ve 8,138
Ve 9,139
s_nop 0
Vc 69,8,9
Ve 8,152
Ve 9,153
s_nop 0
Vc 76,8,9
Ve 8,154
Ve 9,155
s_nop 0
Vc 77,8,9
Ve 8,140
Ve 9,141
s_nop 0
Vc 70,8,9
Ve 8,142
Ve 9,143
s_nop 0
Vc 71,8,9
Ve 8,156
Ve 9,157
s_nop 0
Vc 78,8,9
Ve 8,158
Ve 9,159
s_nop 0
Vc 79,8,9
s_nop 1
s_branch L_k2_fbr_ne
L_k2_mk_ne:
s_nop 7
s_add_u32 s3, s37, 1
s_lshl_b32 s3, s3, 6
v_subrev_u32 v1, s3, v5
v_cmp_gt_i32 s[56:57], -16, v1
v_cmp_gt_i32 s[58:59], -15, v1
v_cmp_gt_i32 s[60:61], -14, v1
v_cmp_gt_i32 s[62:63], -13, v1
v_cndmask_b32 v208, v208, v20, s[56:57]
v_cndmask_b32 v209, v209, v20, s[58:59]
v_cndmask_b32 v210, v210, v20, s[60:61]
v_cndmask_b32 v211, v211, v20, s[62:63]
v_cmp_gt_i32 s[56:57], 0, v1
v_cmp_gt_i32 s[58:59], 1, v1
v_cmp_gt_i32 s[60:61], 2, v1
v_cmp_gt_i32 s[62:63], 3, v1
v_cndmask_b32 v192, v192, v20, s[56:57]
v_cndmask_b32 v193, v193, v20, s[58:59]
v_cndmask_b32 v194, v194, v20, s[60:61]
v_cndmask_b32 v195, v195, v20, s[62:63]
v_cndmask_b32 v212, v212, v20, s[56:57]
v_cndmask_b32 v213, v213, v20, s[58:59]
v_cndmask_b32 v214, v214, v20, s[60:61]
v_cndmask_b32 v215, v215, v20, s[62:63]
v_cmp_gt_i32 s[56:57], 16, v1
v_cmp_gt_i32 s[58:59], 17, v1
v_cmp_gt_i32 s[60:61], 18, v1
v_cmp_gt_i32 s[62:63], 19, v1
v_cndmask_b32 v196, v196, v20, s[56:57]
v_cndmask_b32 v197, v197, v20, s[58:59]
v_cndmask_b32 v198, v198, v20, s[60:61]
v_cndmask_b32 v199, v199, v20, s[62:63]
v_cndmask_b32 v216, v216, v20, s[56:57]
v_cndmask_b32 v217, v217, v20, s[58:59]
v_cndmask_b32 v218, v218, v20, s[60:61]
v_cndmask_b32 v219, v219, v20, s[62:63]
v_cmp_gt_i32 s[56:57], 32, v1
v_cmp_gt_i32 s[58:59], 33, v1
v_cmp_gt_i32 s[60:61], 34, v1
v_cmp_gt_i32 s[62:63], 35, v1
v_cndmask_b32 v200, v200, v20, s[56:57]
v_cndmask_b32 v201, v201, v20, s[58:59]
v_cndmask_b32 v202, v202, v20, s[60:61]
v_cndmask_b32 v203, v203, v20, s[62:63]
v_cndmask_b32 v220, v220, v20, s[56:57]
v_cndmask_b32 v221, v221, v20, s[58:59]
v_cndmask_b32 v222, v222, v20, s[60:61]
v_cndmask_b32 v223, v223, v20, s[62:63]
v_cmp_gt_i32 s[56:57], 48, v1
v_cmp_gt_i32 s[58:59], 49, v1
v_cmp_gt_i32 s[60:61], 50, v1
v_cmp_gt_i32 s[62:63], 51, v1
v_cndmask_b32 v204, v204, v20, s[56:57]
v_cndmask_b32 v205, v205, v20, s[58:59]
v_cndmask_b32 v206, v206, v20, s[60:61]
v_cndmask_b32 v207, v207, v20, s[62:63]
s_nop 1
s_branch L_k2_mkr_ne
L_k2_fb_no:
s_nop 7
v_max3_f32 v21, v192, v193, v194
v_max3_f32 v21, v21, v195, v196
v_max3_f32 v21, v21, v197, v198
v_max3_f32 v21, v21, v199, v200
v_max3_f32 v21, v21, v201, v202
v_max3_f32 v21, v21, v203, v204
v_max3_f32 v21, v21, v205, v206
v_max_f32 v21, v21, v207
v_mov_b32 v1, v21
s_nop 1
v_permlane16_swap_b32 v1, v21
v_max_f32 v21, v21, v1
v_mov_b32 v1, v21
s_nop 1
v_permlane32_swap_b32 v1, v21
v_max_f32 v21, v21, v1
v_add_f32 v21, 0x41f80000, v21
v_max_f32 v21, 0, v21
Vs 192,192,21
Vs 193,193,21
Vs 194,194,21
Vs 195,195,21
Vs 196,196,21
Vs 197,197,21
Vs 198,198,21
Vs 199,199,21
Vs 200,200,21
Vs 201,201,21
Vs 202,202,21
Vs 203,203,21
Vs 204,204,21
Vs 205,205,21
Vs 206,206,21
Vs 207,207,21
Vs 128,128,21
Vs 129,129,21
Vs 130,130,21
Vs 131,131,21
Vs 132,132,21
Vs 133,133,21
Vs 134,134,21
Vs 135,135,21
Vs 136,136,21
Vs 137,137,21
Vs 138,138,21
Vs 139,139,21
Vs 140,140,21
Vs 141,141,21
Vs 142,142,21
Vs 143,143,21
Vs 32,32,21
Vs 33,33,21
Vs 34,34,21
Vs 35,35,21
v_exp_f32 v22, -v21
s_nop 0
Vm 48,48,22
Vm 49,49,22
Vm 50,50,22
Vm 51,51,22
Ar 8,0
Ar 9,1
Ar 10,2
Ar 11,3
Ar 12,4
Ar 13,5
Ar 14,6
Ar 15,7
Vm 8,8,22
Vm 9,9,22
Vm 10,10,22
Vm 11,11,22
Vm 12,12,22
Vm 13,13,22
Vm 14,14,22
Vm 15,15,22
Aw 0,8
Aw 1,9
Aw 2,10
Aw 3,11
Aw 4,12
Aw 5,13
Aw 6,14
Aw 7,15
Ar 8,8
Ar 9,9
Ar 10,10
Ar 11,11
Ar 12,12
Ar 13,13
Ar 14,14
Ar 15,15
Vm 8,8,22
Vm 9,9,22
Vm 10,10,22
Vm 11,11,22
Vm 12,12,22
Vm 13,13,22
Vm 14,14,22
Vm 15,15,22
Aw 8,8
Aw 9,9
Aw 10,10
Aw 11,11
Aw 12,12
Aw 13,13
Aw 14,14
Aw 15,15
Ar 8,16
Ar 9,17
Ar 10,18
Ar 11,19
Ar 12,20
Ar 13,21
Ar 14,22
Ar 15,23
Vm 8,8,22
Vm 9,9,22
Vm 10,10,22
Vm 11,11,22
Vm 12,12,22
Vm 13,13,22
Vm 14,14,22
Vm 15,15,22
Aw 16,8
Aw 17,9
Aw 18,10
Aw 19,11
Aw 20,12
Aw 21,13
Aw 22,14
Aw 23,15
Ar 8,24
Ar 9,25
Ar 10,26
Ar 11,27
Ar 12,28
Ar 13,29
Ar 14,30
Ar 15,31
Vm 8,8,22
Vm 9,9,22
Vm 10,10,22
Vm 11,11,22
Vm 12,12,22
Vm 13,13,22
Vm 14,14,22
Vm 15,15,22
Aw 24,8
Aw 25,9
Aw 26,10
Aw 27,11
Aw 28,12
Aw 29,13
Aw 30,14
Aw 31,15
v_max3_f32 v21, v208, v209, v210
v_max3_f32 v21, v21, v211, v212
v_max3_f32 v21, v21, v213, v214
v_max3_f32 v21, v21, v215, v216
v_max3_f32 v21, v21, v217, v218
v_max3_f32 v21, v21, v219, v220
v_max3_f32 v21, v21, v221, v222
v_max_f32 v21, v21, v223
v_mov_b32 v1, v21
s_nop 1
v_permlane16_swap_b32 v1, v21
v_max_f32 v21, v21, v1
v_mov_b32 v1, v21
s_nop 1
v_permlane32_swap_b32 v1, v21
v_max_f32 v21, v21, v1
v_add_f32 v21, 0x41f80000, v21
v_max_f32 v21, 0, v21
Vs 208,208,21
Vs 209,209,21
Vs 210,210,21
Vs 211,211,21
Vs 212,212,21
Vs 213,213,21
Vs 214,214,21
Vs 215,215,21
Vs 216,216,21
Vs 217,217,21
Vs 218,218,21
Vs 219,219,21
Vs 220,220,21
Vs 221,221,21
Vs 222,222,21
Vs 223,223,21
Vs 144,144,21
Vs 145,145,21
Vs 146,146,21
Vs 147,147,21
Vs 148,148,21
Vs 149,149,21
Vs 150,150,21
Vs 151,151,21
Vs 152,152,21
Vs 153,153,21
Vs 154,154,21
Vs 155,155,21
Vs 156,156,21
Vs 157,157,21
Vs 158,158,21
Vs 159,159,21
Vs 36,36,21
Vs 37,37,21
Vs 38,38,21
Vs 39,39,21
v_exp_f32 v22, -v21
s_nop 0
Vm 52,52,22
Vm 53,53,22
Vm 54,54,22
Vm 55,55,22
Ar 8,32
Ar 9,33
Ar 10,34
Ar 11,35
Ar 12,36
Ar 13,37
Ar 14,38
Ar 15,39
Vm 8,8,22
Vm 9,9,22
Vm 10,10,22
Vm 11,11,22
Vm 12,12,22
Vm 13,13,22
Vm 14,14,22
Vm 15,15,22
Aw 32,8
Aw 33,9
Aw 34,10
Aw 35,11
Aw 36,12
Aw 37,13
Aw 38,14
Aw 39,15
Ar 8,40
Ar 9,41
Ar 10,42
Ar 11,43
Ar 12,44
Ar 13,45
Ar 14,46
Ar 15,47
Vm 8,8,22
Vm 9,9,22
Vm 10,10,22
Vm 11,11,22
Vm 12,12,22
Vm 13,13,22
Vm 14,14,22
Vm 15,15,22
Aw 40,8
Aw 41,9
Aw 42,10
Aw 43,11
Aw 44,12
Aw 45,13
Aw 46,14
Aw 47,15
Ar 8,48
Ar 9,49
Ar 10,50
Ar 11,51
Ar 12,52
Ar 13,53
Ar 14,54
Ar 15,55
Vm 8,8,22
Vm 9,9,22
Vm 10,10,22
Vm 11,11,22
Vm 12,12,22
Vm 13,13,22
Vm 14,14,22
Vm 15,15,22
Aw 48,8
Aw 49,9
Aw 50,10
Aw 51,11
Aw 52,12
Aw 53,13
Aw 54,14
Aw 55,15
Ar 8,56
Ar 9,57
Ar 10,58
Ar 11,59
Ar 12,60
Ar 13,61
Ar 14,62
Ar 15,63
Vm 8,8,22
Vm 9,9,22
Vm 10,10,22
Vm 11,11,22
Vm 12,12,22
Vm 13,13,22
Vm 14,14,22
Vm 15,15,22
Aw 56,8
Aw 57,9
Aw 58,10
Aw 59,11
Aw 60,12
Aw 61,13
Aw 62,14
Aw 63,15
Ve 8,192
Ve 9,193
s_nop 0
Vc 96,8,9
Ve 8,194
Ve 9,195
s_nop 0
Vc 97,8,9
Ve 8,208
Ve 9,209
s_nop 0
Vc 104,8,9
Ve 8,210
Ve 9,211
s_nop 0
Vc 105,8,9
Ve 8,196
Ve 9,197
s_nop 0
Vc 98,8,9
Ve 8,198
Ve 9,199
s_nop 0
Vc 99,8,9
Ve 8,212
Ve 9,213
s_nop 0
Vc 106,8,9
Ve 8,214
Ve 9,215
s_nop 0
Vc 107,8,9
Ve 8,200
Ve 9,201
s_nop 0
Vc 100,8,9
Ve 8,202
Ve 9,203
s_nop 0
Vc 101,8,9
Ve 8,216
Ve 9,217
s_nop 0
Vc 108,8,9
Ve 8,218
Ve 9,219
s_nop 0
Vc 109,8,9
Ve 8,204
Ve 9,205
s_nop 0
Vc 102,8,9
Ve 8,206
Ve 9,207
s_nop 0
Vc 103,8,9
Ve 8,220
Ve 9,221
s_nop 0
Vc 110,8,9
Ve 8,222
Ve 9,223
s_nop 0
Vc 111,8,9
s_nop 1
s_branch L_k2_fbr_no
L_k2_mk_no:
s_nop 7
s_add_u32 s3, s37, 1
s_lshl_b32 s3, s3, 6
v_subrev_u32 v1, s3, v5
v_cmp_gt_i32 s[56:57], -16, v1
v_cmp_gt_i32 s[58:59], -15, v1
v_cmp_gt_i32 s[60:61], -14, v1
v_cmp_gt_i32 s[62:63], -13, v1
v_cndmask_b32 v144, v144, v20, s[56:57]
v_cndmask_b32 v145, v145, v20, s[58:59]
v_cndmask_b32 v146, v146, v20, s[60:61]
v_cndmask_b32 v147, v147, v20, s[62:63]
v_cmp_gt_i32 s[56:57], 0, v1
v_cmp_gt_i32 s[58:59], 1, v1
v_cmp_gt_i32 s[60:61], 2, v1
v_cmp_gt_i32 s[62:63], 3, v1
v_cndmask_b32 v128, v128, v20, s[56:57]
v_cndmask_b32 v129, v129, v20, s[58:59]
v_cndmask_b32 v130, v130, v20, s[60:61]
v_cndmask_b32 v131, v131, v20, s[62:63]
v_cndmask_b32 v148, v148, v20, s[56:57]
v_cndmask_b32 v149, v149, v20, s[58:59]
v_cndmask_b32 v150, v150, v20, s[60:61]
v_cndmask_b32 v151, v151, v20, s[62:63]
v_cmp_gt_i32 s[56:57], 16, v1
v_cmp_gt_i32 s[58:59], 17, v1
v_cmp_gt_i32 s[60:61], 18, v1
v_cmp_gt_i32 s[62:63], 19, v1
v_cndmask_b32 v132, v132, v20, s[56:57]
v_cndmask_b32 v133, v133, v20, s[58:59]
v_cndmask_b32 v134, v134, v20, s[60:61]
v_cndmask_b32 v135, v135, v20, s[62:63]
v_cndmask_b32 v152, v152, v20, s[56:57]
v_cndmask_b32 v153, v153, v20, s[58:59]
v_cndmask_b32 v154, v154, v20, s[60:61]
v_cndmask_b32 v155, v155, v20, s[62:63]
v_cmp_gt_i32 s[56:57], 32, v1
v_cmp_gt_i32 s[58:59], 33, v1
v_cmp_gt_i32 s[60:61], 34, v1
v_cmp_gt_i32 s[62:63], 35, v1
v_cndmask_b32 v136, v136, v20, s[56:57]
v_cndmask_b32 v137, v137, v20, s[58:59]
v_cndmask_b32 v138, v138, v20, s[60:61]
v_cndmask_b32 v139, v139, v20, s[62:63]
v_cndmask_b32 v156, v156, v20, s[56:57]
v_cndmask_b32 v157, v157, v20, s[58:59]
v_cndmask_b32 v158, v158, v20, s[60:61]
v_cndmask_b32 v159, v159, v20, s[62:63]
v_cmp_gt_i32 s[56:57], 48, v1
v_cmp_gt_i32 s[58:59], 49, v1
v_cmp_gt_i32 s[60:61], 50, v1
v_cmp_gt_i32 s[62:63], 51, v1
v_cndmask_b32 v140, v140, v20, s[56:57]
v_cndmask_b32 v141, v141, v20, s[58:59]
v_cndmask_b32 v142, v142, v20, s[60:61]
v_cndmask_b32 v143, v143, v20, s[62:63]
s_nop 1
s_branch L_k2_mkr_no
L_k2_fb_fi:
s_nop 7
v_max3_f32 v21, v192, v193, v194
v_max3_f32 v21, v21, v195, v196
v_max3_f32 v21, v21, v197, v198
v_max3_f32 v21, v21, v199, v200
v_max3_f32 v21, v21, v201, v202
v_max3_f32 v21, v21, v203, v204
v_max3_f32 v21, v21, v205, v206
v_max_f32 v21, v21, v207
v_mov_b32 v1, v21
s_nop 1
v_permlane16_swap_b32 v1, v21
v_max_f32 v21, v21, v1
v_mov_b32 v1, v21
s_nop 1
v_permlane32_swap_b32 v1, v21
v_max_f32 v21, v21, v1
v_add_f32 v21, 0x41f80000, v21
v_max_f32 v21, 0, v21
Vs 192,192,21
Vs 193,193,21
Vs 194,194,21
Vs 195,195,21
Vs 196,196,21
Vs 197,197,21
Vs 198,198,21
Vs 199,199,21
Vs 200,200,21
Vs 201,201,21
Vs 202,202,21
Vs 203,203,21
Vs 204,204,21
Vs 205,205,21
Vs 206,206,21
Vs 207,207,21
Vs 32,32,21
Vs 33,33,21
Vs 34,34,21
Vs 35,35,21
v_exp_f32 v22, -v21
s_nop 0
Vm 48,48,22
Vm 49,49,22
Vm 50,50,22
Vm 51,51,22
Ar 8,0
Ar 9,1
Ar 10,2
Ar 11,3
Ar 12,4
Ar 13,5
Ar 14,6
Ar 15,7
Vm 8,8,22
Vm 9,9,22
Vm 10,10,22
Vm 11,11,22
Vm 12,12,22
Vm 13,13,22
Vm 14,14,22
Vm 15,15,22
Aw 0,8
Aw 1,9
Aw 2,10
Aw 3,11
Aw 4,12
Aw 5,13
Aw 6,14
Aw 7,15
Ar 8,8
Ar 9,9
Ar 10,10
Ar 11,11
Ar 12,12
Ar 13,13
Ar 14,14
Ar 15,15
Vm 8,8,22
Vm 9,9,22
Vm 10,10,22
Vm 11,11,22
Vm 12,12,22
Vm 13,13,22
Vm 14,14,22
Vm 15,15,22
Aw 8,8
Aw 9,9
Aw 10,10
Aw 11,11
Aw 12,12
Aw 13,13
Aw 14,14
Aw 15,15
Ar 8,16
Ar 9,17
Ar 10,18
Ar 11,19
Ar 12,20
Ar 13,21
Ar 14,22
Ar 15,23
Vm 8,8,22
Vm 9,9,22
Vm 10,10,22
Vm 11,11,22
Vm 12,12,22
Vm 13,13,22
Vm 14,14,22
Vm 15,15,22
Aw 16,8
Aw 17,9
Aw 18,10
Aw 19,11
Aw 20,12
Aw 21,13
Aw 22,14
Aw 23,15
Ar 8,24
Ar 9,25
Ar 10,26
Ar 11,27
Ar 12,28
Ar 13,29
Ar 14,30
Ar 15,31
Vm 8,8,22
Vm 9,9,22
Vm 10,10,22
Vm 11,11,22
Vm 12,12,22
Vm 13,13,22
Vm 14,14,22
Vm 15,15,22
Aw 24,8
Aw 25,9
Aw 26,10
Aw 27,11
Aw 28,12
Aw 29,13
Aw 30,14
Aw 31,15
v_max3_f32 v21, v208, v209, v210
v_max3_f32 v21, v21, v211, v212
v_max3_f32 v21, v21, v213, v214
v_max3_f32 v21, v21, v215, v216
v_max3_f32 v21, v21, v217, v218
v_max3_f32 v21, v21, v219, v220
v_max3_f32 v21, v21, v221, v222
v_max_f32 v21, v21, v223
v_mov_b32 v1, v21
s_nop 1
v_permlane16_swap_b32 v1, v21
v_max_f32 v21, v21, v1
v_mov_b32 v1, v21
s_nop 1
v_permlane32_swap_b32 v1, v21
v_max_f32 v21, v21, v1
v_add_f32 v21, 0x41f80000, v21
v_max_f32 v21, 0, v21
Vs 208,208,21
Vs 209,209,21
Vs 210,210,21
Vs 211,211,21
Vs 212,212,21
Vs 213,213,21
Vs 214,214,21
Vs 215,215,21
Vs 216,216,21
Vs 217,217,21
Vs 218,218,21
Vs 219,219,21
Vs 220,220,21
Vs 221,221,21
Vs 222,222,21
Vs 223,223,21
Vs 36,36,21
Vs 37,37,21
Vs 38,38,21
Vs 39,39,21
v_exp_f32 v22, -v21
s_nop 0
Vm 52,52,22
Vm 53,53,22
Vm 54,54,22
Vm 55,55,22
Ar 8,32
Ar 9,33
Ar 10,34
Ar 11,35
Ar 12,36
Ar 13,37
Ar 14,38
Ar 15,39
Vm 8,8,22
Vm 9,9,22
Vm 10,10,22
Vm 11,11,22
Vm 12,12,22
Vm 13,13,22
Vm 14,14,22
Vm 15,15,22
Aw 32,8
Aw 33,9
Aw 34,10
Aw 35,11
Aw 36,12
Aw 37,13
Aw 38,14
Aw 39,15
Ar 8,40
Ar 9,41
Ar 10,42
Ar 11,43
Ar 12,44
Ar 13,45
Ar 14,46
Ar 15,47
Vm 8,8,22
Vm 9,9,22
Vm 10,10,22
Vm 11,11,22
Vm 12,12,22
Vm 13,13,22
Vm 14,14,22
Vm 15,15,22
Aw 40,8
Aw 41,9
Aw 42,10
Aw 43,11
Aw 44,12
Aw 45,13
Aw 46,14
Aw 47,15
Ar 8,48
Ar 9,49
Ar 10,50
Ar 11,51
Ar 12,52
Ar 13,53
Ar 14,54
Ar 15,55
Vm 8,8,22
Vm 9,9,22
Vm 10,10,22
Vm 11,11,22
Vm 12,12,22
Vm 13,13,22
Vm 14,14,22
Vm 15,15,22
Aw 48,8
Aw 49,9
Aw 50,10
Aw 51,11
Aw 52,12
Aw 53,13
Aw 54,14
Aw 55,15
Ar 8,56
Ar 9,57
Ar 10,58
Ar 11,59
Ar 12,60
Ar 13,61
Ar 14,62
Ar 15,63
Vm 8,8,22
Vm 9,9,22
Vm 10,10,22
Vm 11,11,22
Vm 12,12,22
Vm 13,13,22
Vm 14,14,22
Vm 15,15,22
Aw 56,8
Aw 57,9
Aw 58,10
Aw 59,11
Aw 60,12
Aw 61,13
Aw 62,14
Aw 63,15
Ve 8,192
Ve 9,193
s_nop 0
Vc 96,8,9
Ve 8,194
Ve 9,195
s_nop 0
Vc 97,8,9
Ve 8,208
Ve 9,209
s_nop 0
Vc 104,8,9
Ve 8,210
Ve 9,211
s_nop 0
Vc 105,8,9
Ve 8,196
Ve 9,197
s_nop 0
Vc 98,8,9
Ve 8,198
Ve 9,199
s_nop 0
Vc 99,8,9
Ve 8,212
Ve 9,213
s_nop 0
Vc 106,8,9
Ve 8,214
Ve 9,215
s_nop 0
Vc 107,8,9
Ve 8,200
Ve 9,201
s_nop 0
Vc 100,8,9
Ve 8,202
Ve 9,203
s_nop 0
Vc 101,8,9
Ve 8,216
Ve 9,217
s_nop 0
Vc 108,8,9
Ve 8,218
Ve 9,219
s_nop 0
Vc 109,8,9
Ve 8,204
Ve 9,205
s_nop 0
Vc 102,8,9
Ve 8,206
Ve 9,207
s_nop 0
Vc 103,8,9
Ve 8,220
Ve 9,221
s_nop 0
Vc 110,8,9
Ve 8,222
Ve 9,223
s_nop 0
Vc 111,8,9
s_nop 1
s_branch L_k2_fbr_fi
.globl oproj_kernel
.p2align 8
.type oproj_kernel,@function
oproj_kernel:
s_cmp_ge_u32 s2, 256
s_cbranch_scc1 L_k3_end
s_load_dwordx2 s[4:5], s[0:1], 40
s_load_dwordx2 s[40:41], s[0:1], 0
s_load_dwordx4 s[44:47], s[0:1], 80
s_load_dwordx4 s[56:59], s[0:1], 96
v_lshrrev_b32 v1, 6, v0
v_lshrrev_b32 v10, 3, v0
v_and_b32 v0, 63, v0
v_readfirstlane_b32 s32, v1
s_bfe_u32 s33, s2, 0x20001
s_lshl_b32 s33, s33, 2
s_bfe_u32 s3, s2, 0x20003
s_add_u32 s33, s33, s3
s_and_b32 s34, s2, 1
s_lshl_b32 s34, s34, 3
s_lshr_b32 s3, s2, 5
s_add_u32 s34, s34, s3
s_mov_b32 s48, 0
s_mov_b32 s49, 15360
s_mov_b32 s50, 30720
s_mov_b32 s51, 46080
s_lshl_b32 s35, s32, 15
v_lshlrev_b32 v2, 4, v0
v_add_u32 v3, 4096, v2
v_lshrrev_b32 v12, 4, v0
v_and_b32 v13, 7, v0
v_lshrrev_b32 v14, 3, v0
v_lshlrev_b32 v1, 1, v12
v_xor_b32 v1, v1, v13
v_lshlrev_b32 v1, 4, v1
v_lshl_add_u32 v4, v14, 11, v1
v_lshrrev_b32 v1, 2, v0
v_bfe_u32 v11, v0, 3, 2
v_lshlrev_b32 v1, 7, v1
v_and_b32 v15, 3, v0
v_lshl_add_u32 v1, v15, 3, v1
v_add_u32 v1, s35, v1
v_xor_b32 v15, 0, v11
v_lshl_add_u32 v5, v15, 5, v1
v_xor_b32 v15, 1, v11
v_lshl_add_u32 v6, v15, 5, v1
v_xor_b32 v15, 2, v11
v_lshl_add_u32 v7, v15, 5, v1
v_xor_b32 v15, 3, v11
v_lshl_add_u32 v8, v15, 5, v1
v_lshlrev_b32 v9, 11, v10
v_lshl_add_u32 v9, v13, 4, v9
s_getpc_b64 s[64:65]
L_cpf5:
s_add_u32 s64, s64, (oproj_kernel-L_cpf5)&0xffffffff
s_addc_u32 s65, s65, ((oproj_kernel-L_cpf5)>>32)&0xffffffff
s_lshr_b32 s66, s2, 3
s_lshl_b32 s66, s66, 2
s_add_u32 s66, s66, s32
s_lshl_b32 s66, s66, 10
v_and_b32 v126, 7, v0
v_lshlrev_b32 v126, 7, v126
v_add_u32 v126, s66, v126
v_min_u32 v126, L_k3_end-oproj_kernel-4, v126
v_mov_b32 v125, s65
v_add_co_u32 v124, vcc, s64, v126
s_nop 1
v_addc_co_u32 v125, vcc, 0, v125, vcc
global_load_dword v127, v[124:125], off
s_lshr_b32 s3, s2, 5
s_mul_i32 s3, s3, 4096
v_lshlrev_b32 v120, 7, v0
v_add_u32 v120, s3, v120
s_bfe_u32 s3, s2, 0x20003
s_mul_i32 s3, s3, 65536
v_lshlrev_b32 v121, 11, v0
v_add_u32 v121, s3, v121
v_cmp_gt_u32 vcc, 32, v0
v_mov_b32 v1, 0x7ff00000
s_nop 0
v_cndmask_b32 v120, v1, v120, vcc
v_cndmask_b32 v121, v1, v121, vcc
s_waitcnt lgkmcnt(0)
s_lshl_b32 s3, s33, 20
s_lshl_b32 s62, s32, 18
s_add_u32 s3, s3, s62
s_add_u32 s3, s3, 46137344
s_add_u32 s8, s58, s3
s_addc_u32 s9, s59, 0
s_and_b32 s9, s9, 0xffff
s_mov_b32 s10, 262144
s_mov_b32 s11, 0x20000
s_lshl_b32 s62, s34, 7
s_lshl_b32 s3, s32, 21
s_add_u32 s3, s3, s62
s_add_u32 s12, s4, s3
s_addc_u32 s13, s5, 0
s_and_b32 s13, s13, 0xffff
s_mov_b32 s14, 0
s_mov_b32 s15, 0x20000
s_sub_u32 s14, 2097152, s62
s_bfe_u32 s3, s2, 0x20003
s_mul_i32 s3, s3, 1
s_lshr_b32 s62, s2, 5
s_mul_i32 s62, s62, 1
s_add_u32 s5, s3, s62
v_mov_b32 v123, v4
s_mul_i32 s6, s32, 0
s_sub_u32 s6, 32, s6
s_add_u32 s4, s5, 0
s_and_b32 s4, s4, 3
s_or_b32 s4, s4, 0
s_lshl_b32 s4, s4, 16
s_add_u32 s63, s5, 0
s_and_b32 s63, s63, 3
s_or_b32 s63, s63, 0
s_lshl_b32 s63, s63, 13
v_add_u32 v4, s4, v123
s_add_u32 m0, s35, 0
s_nop 0
buffer_load_dwordx4 v4, s[12:15], s48 offen offset:0 lds
buffer_load_dwordx4 v4, s[12:15], s49 offen offset:1024 lds
buffer_load_dwordx4 v4, s[12:15], s50 offen offset:2048 lds
buffer_load_dwordx4 v4, s[12:15], s51 offen offset:3072 lds
s_add_u32 s4, s5, 1
s_and_b32 s4, s4, 3
s_or_b32 s4, s4, 0
s_lshl_b32 s4, s4, 16
v_add_u32 v4, s4, v123
s_add_u32 m0, s35, 4096
s_nop 0
buffer_load_dwordx4 v4, s[12:15], s48 offen offset:0 lds
buffer_load_dwordx4 v4, s[12:15], s49 offen offset:1024 lds
buffer_load_dwordx4 v4, s[12:15], s50 offen offset:2048 lds
buffer_load_dwordx4 v4, s[12:15], s51 offen offset:3072 lds
s_add_u32 s4, s5, 2
s_and_b32 s4, s4, 3
s_or_b32 s4, s4, 0
s_lshl_b32 s4, s4, 16
v_add_u32 v4, s4, v123
buffer_load_dwordx4 a[0:3], v2, s[8:11], s63 offen offset:0
buffer_load_dwordx4 a[4:7], v2, s[8:11], s63 offen offset:1024
buffer_load_dwordx4 a[8:11], v2, s[8:11], s63 offen offset:2048
buffer_load_dwordx4 a[12:15], v2, s[8:11], s63 offen offset:3072
buffer_load_dwordx4 a[16:19], v3, s[8:11], s63 offen offset:0
buffer_load_dwordx4 a[20:23], v3, s[8:11], s63 offen offset:1024
buffer_load_dwordx4 a[24:27], v3, s[8:11], s63 offen offset:2048
buffer_load_dwordx4 a[28:31], v3, s[8:11], s63 offen offset:3072
s_add_u32 s63, s5, 1
s_and_b32 s63, s63, 3
s_or_b32 s63, s63, 0
s_lshl_b32 s63, s63, 13
s_add_u32 m0, s35, 8192
s_nop 0
buffer_load_dwordx4 v4, s[12:15], s48 offen offset:0 lds
buffer_load_dwordx4 v4, s[12:15], s49 offen offset:1024 lds
buffer_load_dwordx4 v4, s[12:15], s50 offen offset:2048 lds
buffer_load_dwordx4 v4, s[12:15], s51 offen offset:3072 lds
s_add_u32 s4, s5, 3
s_and_b32 s4, s4, 3
s_or_b32 s4, s4, 0
s_lshl_b32 s4, s4, 16
v_add_u32 v4, s4, v123
buffer_load_dwordx4 a[32:35], v2, s[8:11], s63 offen offset:0
buffer_load_dwordx4 a[36:39], v2, s[8:11], s63 offen offset:1024
buffer_load_dwordx4 a[40:43], v2, s[8:11], s63 offen offset:2048
buffer_load_dwordx4 a[44:47], v2, s[8:11], s63 offen offset:3072
buffer_load_dwordx4 a[48:51], v3, s[8:11], s63 offen offset:0
buffer_load_dwordx4 a[52:55], v3, s[8:11], s63 offen offset:1024
buffer_load_dwordx4 a[56:59], v3, s[8:11], s63 offen offset:2048
buffer_load_dwordx4 a[60:63], v3, s[8:11], s63 offen offset:3072
s_add_u32 s63, s5, 2
s_and_b32 s63, s63, 3
s_or_b32 s63, s63, 0
s_lshl_b32 s63, s63, 13
s_add_u32 m0, s35, 12288
s_nop 0
buffer_load_dwordx4 v4, s[12:15], s48 offen offset:0 lds
buffer_load_dwordx4 v4, s[12:15], s49 offen offset:1024 lds
buffer_load_dwordx4 v4, s[12:15], s50 offen offset:2048 lds
buffer_load_dwordx4 v4, s[12:15], s51 offen offset:3072 lds
s_add_u32 s4, s5, 4
s_and_b32 s4, s4, 3
s_or_b32 s4, s4, 4
s_lshl_b32 s4, s4, 16
v_add_u32 v4, s4, v123
buffer_load_dwordx4 a[64:67], v2, s[8:11], s63 offen offset:0
buffer_load_dwordx4 a[68:71], v2, s[8:11], s63 offen offset:1024
buffer_load_dwordx4 a[72:75], v2, s[8:11], s63 offen offset:2048
buffer_load_dwordx4 a[76:79], v2, s[8:11], s63 offen offset:3072
buffer_load_dwordx4 a[80:83], v3, s[8:11], s63 offen offset:0
buffer_load_dwordx4 a[84:87], v3, s[8:11], s63 offen offset:1024
buffer_load_dwordx4 a[88:91], v3, s[8:11], s63 offen offset:2048
buffer_load_dwordx4 a[92:95], v3, s[8:11], s63 offen offset:3072
s_add_u32 s63, s5, 3
s_and_b32 s63, s63, 3
s_or_b32 s63, s63, 0
s_lshl_b32 s63, s63, 13
s_add_u32 s60, s58, 5292032
s_addc_u32 s61, s59, 0
s_load_dwordx4 s[52:55], s[60:61], 0
s_mov_b32 s16, s58
s_and_b32 s17, s59, 0xffff
s_mov_b32 s18, 8388608
s_mov_b32 s19, 0x20000
s_mov_b32 s24, s44
s_and_b32 s25, s45, 0xffff
s_mov_b32 s26, 7340032
s_mov_b32 s27, 0x20000
s_lshl_b32 s36, s33, 18
s_lshl_b32 s3, s34, 7
s_add_u32 s36, s36, s3
s_mov_b32 s20, s40
s_and_b32 s21, s41, 0xffff
s_mov_b32 s22, 4194304
s_mov_b32 s23, 0x20000
s_mov_b32 s28, s46
s_and_b32 s29, s47, 0xffff
s_mov_b32 s30, 4194304
s_mov_b32 s31, 0x20000
s_mov_b32 s40, s56
s_and_b32 s41, s57, 0xffff
s_mov_b32 s42, 256
s_mov_b32 s43, 0x20000
s_lshr_b32 s37, s2, 4
s_lshl_b32 s3, s37, 2
s_add_u32 s3, s3, s32
s_mul_i32 s38, s3, 56
s_and_b32 s39, s2, 15
s_waitcnt vmcnt(36)
Ta 128,5,0
Ta 130,5,2048
Ta 132,6,0
Ta 134,6,2048
Ta 136,7,0
Ta 138,7,2048
Ta 140,8,0
Ta 142,8,2048
s_waitcnt vmcnt(24) lgkmcnt(0)
Zvaa 128,128,0
s_add_u32 m0, s35, 0
Zvaa 132,132,0
buffer_load_dwordx4 v4, s[12:15], s48 offen offset:0 lds
Zvaa 136,136,0
Ta 144,5,4096
Ta 146,5,6144
Zvaa 140,140,0
buffer_load_dwordx4 v4, s[12:15], s49 offen offset:1024 lds
Zvaa 144,128,4
s_lshl_b32 s3, s38, 2
s_add_u32 s3, s3, 6291456
v_mul_u32_u24 v1, 14336, v12
v_and_b32 v15, 15, v0
Zvaa 148,132,4
v_lshl_add_u32 v1, v15, 4, v1
Zvaa 152,136,4
buffer_load_dwordx4 v4, s[12:15], s50 offen offset:2048 lds
Zvaa 156,140,4
Ta 148,6,4096
Ta 150,6,6144
Zvaa 160,128,8
buffer_load_dwordx4 v4, s[12:15], s51 offen offset:3072 lds
Zvaa 164,132,8
s_add_u32 s4, s5, 5
s_and_b32 s4, s4, 3
s_or_b32 s4, s4, 4
s_lshl_b32 s4, s4, 16
v_add_u32 v4, s4, v123
Zvaa 168,136,8
buffer_load_dwordx4 v[40:43], v1, s[16:19], s3 offen
Zvaa 172,140,8
buffer_load_dwordx4 a[96:99], v2, s[8:11], s63 offen offset:0
Zvaa 176,128,12
Ta 152,7,4096
Ta 154,7,6144
Zvaa 180,132,12
buffer_load_dwordx4 a[100:103], v2, s[8:11], s63 offen offset:1024
Zvaa 184,136,12
s_add_u32 s3, s3, 57344
Zvaa 188,140,12
buffer_load_dwordx4 v[44:47], v1, s[16:19], s3 offen
Zvaa 192,128,16
buffer_load_dwordx4 a[104:107], v2, s[8:11], s63 offen offset:2048
Zvaa 196,132,16
Ta 156,8,4096
Ta 158,8,6144
Zvaa 200,136,16
buffer_load_dwordx4 a[108:111], v2, s[8:11], s63 offen offset:3072
Zvaa 204,140,16
s_add_u32 s3, s3, 57344
Zvaa 208,128,20
buffer_load_dwordx4 v[48:51], v1, s[16:19], s3 offen
Zvaa 212,132,20
buffer_load_dwordx4 a[112:115], v3, s[8:11], s63 offen offset:0
Zvaa 216,136,20
s_add_u32 s3, s3, 57344
Zvaa 220,140,20
buffer_load_dwordx4 a[116:119], v3, s[8:11], s63 offen offset:1024
Zvaa 224,128,24
buffer_load_dwordx4 v[52:55], v1, s[16:19], s3 offen
Zvaa 228,132,24
s_add_u32 s3, s3, 57344
Zvaa 232,136,24
buffer_load_dwordx4 a[120:123], v3, s[8:11], s63 offen offset:2048
Zvaa 236,140,24
buffer_load_dwordx4 v[56:59], v1, s[16:19], s3 offen
Zvaa 240,128,28
buffer_load_dwordx4 a[124:127], v3, s[8:11], s63 offen offset:3072
Zvaa 244,132,28
s_add_u32 s63, s5, 4
s_and_b32 s63, s63, 3
s_or_b32 s63, s63, 4
s_lshl_b32 s63, s63, 13
Zvaa 248,136,28
s_add_u32 s3, s3, 57344
Zvaa 252,140,28
buffer_load_dwordx4 v[60:63], v1, s[16:19], s3 offen
s_waitcnt vmcnt(30) lgkmcnt(0)
Mvaa 128,144,32
s_add_u32 m0, s35, 4096
Mvaa 132,148,32
buffer_load_dwordx4 v4, s[12:15], s48 offen offset:0 lds
Mvaa 136,152,32
Ta 128,5,8192
Ta 130,5,10240
Mvaa 140,156,32
buffer_load_dwordx4 v4, s[12:15], s49 offen offset:1024 lds
Mvaa 144,144,36
s_add_u32 s3, s3, 57344
Mvaa 148,148,36
buffer_load_dwordx4 v[64:67], v1, s[16:19], s3 offen
Mvaa 152,152,36
buffer_load_dwordx4 v4, s[12:15], s50 offen offset:2048 lds
Mvaa 156,156,36
Ta 132,6,8192
Ta 134,6,10240
Mvaa 160,144,40
buffer_load_dwordx4 v4, s[12:15], s51 offen offset:3072 lds
Mvaa 164,148,40
s_add_u32 s4, s5, 6
s_and_b32 s4, s4, 3
s_or_b32 s4, s4, 4
s_lshl_b32 s4, s4, 16
v_add_u32 v4, s4, v123
Mvaa 168,152,40
s_add_u32 s3, s3, 57344
Mvaa 172,156,40
buffer_load_dwordx4 a[0:3], v2, s[8:11], s63 offen offset:0
Mvaa 176,144,44
Ta 136,7,8192
Ta 138,7,10240
Mvaa 180,148,44
buffer_load_dwordx4 a[4:7], v2, s[8:11], s63 offen offset:1024
Mvaa 184,152,44
buffer_load_dwordx4 v[68:71], v1, s[16:19], s3 offen
Mvaa 188,156,44
s_lshl_b32 s3, s38, 11
s_lshl_b32 s62, s39, 7
s_add_u32 s3, s3, s62
v_mul_u32_u24 v1, 14336, v14
Mvaa 192,144,48
buffer_load_dwordx4 a[8:11], v2, s[8:11], s63 offen offset:2048
Mvaa 196,148,48
Ta 140,8,8192
Ta 142,8,10240
Mvaa 200,152,48
buffer_load_dwordx4 a[12:15], v2, s[8:11], s63 offen offset:3072
Mvaa 204,156,48
v_lshl_add_u32 v1, v13, 4, v1
Mvaa 208,144,52
buffer_load_dwordx4 v[72:75], v1, s[24:27], s3 offen offset:0
Mvaa 212,148,52
buffer_load_dwordx4 a[16:19], v3, s[8:11], s63 offen offset:0
Mvaa 216,152,52
buffer_load_dwordx4 v[76:79], v1, s[24:27], s3 offen offset:2048
Mvaa 220,156,52
buffer_load_dwordx4 a[20:23], v3, s[8:11], s63 offen offset:1024
Mvaa 224,144,56
s_add_u32 s3, s3, 4096
Mvaa 228,148,56
buffer_load_dwordx4 v[80:83], v1, s[24:27], s3 offen offset:0
Mvaa 232,152,56
buffer_load_dwordx4 a[24:27], v3, s[8:11], s63 offen offset:2048
Mvaa 236,156,56
buffer_load_dwordx4 v[84:87], v1, s[24:27], s3 offen offset:2048
Mvaa 240,144,60
buffer_load_dwordx4 a[28:31], v3, s[8:11], s63 offen offset:3072
Mvaa 244,148,60
s_add_u32 s63, s5, 5
s_and_b32 s63, s63, 3
s_or_b32 s63, s63, 4
s_lshl_b32 s63, s63, 13
Mvaa 248,152,60
s_add_u32 s3, s3, 4096
Mvaa 252,156,60
buffer_load_dwordx4 v[88:91], v1, s[24:27], s3 offen offset:0
s_waitcnt vmcnt(37) lgkmcnt(0)
Mvaa 128,128,64
s_add_u32 m0, s35, 8192
Mvaa 132,132,64
buffer_load_dwordx4 v4, s[12:15], s48 offen offset:0 lds
Mvaa 136,136,64
Ta 144,5,12288
Ta 146,5,14336
Mvaa 140,140,64
buffer_load_dwordx4 v4, s[12:15], s49 offen offset:1024 lds
Mvaa 144,128,68
buffer_load_dwordx4 v[92:95], v1, s[24:27], s3 offen offset:2048
Mvaa 148,132,68
s_add_u32 s3, s3, 4096
Mvaa 152,136,68
buffer_load_dwordx4 v4, s[12:15], s50 offen offset:2048 lds
Mvaa 156,140,68
Ta 148,6,12288
Ta 150,6,14336
Mvaa 160,128,72
buffer_load_dwordx4 v4, s[12:15], s51 offen offset:3072 lds
Mvaa 164,132,72
s_add_u32 s4, s5, 7
s_and_b32 s4, s4, 3
s_or_b32 s4, s4, 4
s_lshl_b32 s4, s4, 16
v_add_u32 v4, s4, v123
Mvaa 168,136,72
buffer_load_dwordx4 v[96:99], v1, s[24:27], s3 offen offset:0
Mvaa 172,140,72
buffer_load_dwordx4 a[32:35], v2, s[8:11], s63 offen offset:0
Mvaa 176,128,76
Ta 152,7,12288
Ta 154,7,14336
Mvaa 180,132,76
buffer_load_dwordx4 a[36:39], v2, s[8:11], s63 offen offset:1024
Mvaa 184,136,76
Mvaa 188,140,76
Mvaa 192,128,80
buffer_load_dwordx4 a[40:43], v2, s[8:11], s63 offen offset:2048
Mvaa 196,132,80
Ta 156,8,12288
Ta 158,8,14336
Mvaa 200,136,80
buffer_load_dwordx4 a[44:47], v2, s[8:11], s63 offen offset:3072
Mvaa 204,140,80
Mvaa 208,128,84
Mvaa 212,132,84
buffer_load_dwordx4 a[48:51], v3, s[8:11], s63 offen offset:0
Mvaa 216,136,84
Mvaa 220,140,84
buffer_load_dwordx4 a[52:55], v3, s[8:11], s63 offen offset:1024
Mvaa 224,128,88
Mvaa 228,132,88
Mvaa 232,136,88
buffer_load_dwordx4 a[56:59], v3, s[8:11], s63 offen offset:2048
Mvaa 236,140,88
Mvaa 240,128,92
buffer_load_dwordx4 a[60:63], v3, s[8:11], s63 offen offset:3072
Mvaa 244,132,92
s_add_u32 s63, s5, 6
s_and_b32 s63, s63, 3
s_or_b32 s63, s63, 4
s_lshl_b32 s63, s63, 13
Mvaa 248,136,92
Mvaa 252,140,92
s_waitcnt vmcnt(34) lgkmcnt(0)
Mvaa 128,144,96
s_add_u32 m0, s35, 12288
Mvaa 132,148,96
buffer_load_dwordx4 v4, s[12:15], s48 offen offset:0 lds
Mvaa 136,152,96
Ta 128,5,0
Ta 130,5,2048
Mvaa 140,156,96
buffer_load_dwordx4 v4, s[12:15], s49 offen offset:1024 lds
Mvaa 144,144,100
s_mov_b32 s3, s36
Mvaa 148,148,100
buffer_load_dwordx4 v[16:19], v9, s[20:23], s3 offen
Mvaa 152,152,100
buffer_load_dwordx4 v4, s[12:15], s50 offen offset:2048 lds
Mvaa 156,156,100
Ta 132,6,0
Ta 134,6,2048
Mvaa 160,144,104
buffer_load_dwordx4 v4, s[12:15], s51 offen offset:3072 lds
Mvaa 164,148,104
s_add_u32 s4, s5, 8
s_and_b32 s4, s4, 3
s_or_b32 s4, s4, 8
s_lshl_b32 s4, s4, 16
v_add_u32 v4, s4, v123
Mvaa 168,152,104
s_add_u32 s3, s3, 65536
Mvaa 172,156,104
buffer_load_dwordx4 a[64:67], v2, s[8:11], s63 offen offset:0
Mvaa 176,144,108
Ta 136,7,0
Ta 138,7,2048
Mvaa 180,148,108
buffer_load_dwordx4 a[68:71], v2, s[8:11], s63 offen offset:1024
Mvaa 184,152,108
buffer_load_dwordx4 v[20:23], v9, s[20:23], s3 offen
Mvaa 188,156,108
s_add_u32 s3, s3, 65536
Mvaa 192,144,112
buffer_load_dwordx4 a[72:75], v2, s[8:11], s63 offen offset:2048
Mvaa 196,148,112
Ta 140,8,0
Ta 142,8,2048
Mvaa 200,152,112
buffer_load_dwordx4 a[76:79], v2, s[8:11], s63 offen offset:3072
Mvaa 204,156,112
buffer_load_dwordx4 v[24:27], v9, s[20:23], s3 offen
Mvaa 208,144,116
s_add_u32 s3, s3, 65536
Mvaa 212,148,116
buffer_load_dwordx4 a[80:83], v3, s[8:11], s63 offen offset:0
Mvaa 216,152,116
buffer_load_dwordx4 v[28:31], v9, s[20:23], s3 offen
Mvaa 220,156,116
buffer_load_dwordx4 a[84:87], v3, s[8:11], s63 offen offset:1024
Mvaa 224,144,120
s_lshl_b32 s3, s33, 10
s_add_u32 s3, s3, 5259264
v_lshlrev_b32 v1, 3, v10
Mvaa 228,148,120
buffer_load_dwordx2 v[32:33], v1, s[16:19], s3 offen offset:0
Mvaa 232,152,120
buffer_load_dwordx4 a[88:91], v3, s[8:11], s63 offen offset:2048
Mvaa 236,156,120
buffer_load_dwordx2 v[34:35], v1, s[16:19], s3 offen offset:256
Mvaa 240,144,124
buffer_load_dwordx4 a[92:95], v3, s[8:11], s63 offen offset:3072
Mvaa 244,148,124
s_add_u32 s63, s5, 7
s_and_b32 s63, s63, 3
s_or_b32 s63, s63, 4
s_lshl_b32 s63, s63, 13
Mvaa 248,152,124
buffer_load_dwordx2 v[36:37], v1, s[16:19], s3 offen offset:512
Mvaa 252,156,124
buffer_load_dwordx2 v[38:39], v1, s[16:19], s3 offen offset:768
s_waitcnt vmcnt(35) lgkmcnt(0)
Mvaa 128,128,0
s_add_u32 m0, s35, 0
Mvaa 132,132,0
buffer_load_dwordx4 v4, s[12:15], s48 offen offset:0 lds
Mvaa 136,136,0
Ta 144,5,4096
Ta 146,5,6144
Mvaa 140,140,0
buffer_load_dwordx4 v4, s[12:15], s49 offen offset:1024 lds
Mvaa 144,128,4
Va 40,40,44
Va 41,41,45
Va 42,42,46
Mvaa 148,132,4
Va 43,43,47
Va 40,40,48
Va 41,41,49
Mvaa 152,136,4
buffer_load_dwordx4 v4, s[12:15], s50 offen offset:2048 lds
Mvaa 156,140,4
Ta 148,6,4096
Ta 150,6,6144
Mvaa 160,128,8
buffer_load_dwordx4 v4, s[12:15], s51 offen offset:3072 lds
Mvaa 164,132,8
s_add_u32 s4, s5, 9
s_and_b32 s4, s4, 3
s_or_b32 s4, s4, 8
s_lshl_b32 s4, s4, 16
v_add_u32 v4, s4, v123
Mvaa 168,136,8
Va 42,42,50
Va 43,43,51
Va 40,40,52
Mvaa 172,140,8
buffer_load_dwordx4 a[96:99], v2, s[8:11], s63 offen offset:0
Mvaa 176,128,12
Ta 152,7,4096
Ta 154,7,6144
Mvaa 180,132,12
buffer_load_dwordx4 a[100:103], v2, s[8:11], s63 offen offset:1024
Mvaa 184,136,12
Va 41,41,53
Va 42,42,54
Va 43,43,55
Mvaa 188,140,12
Va 40,40,56
Va 41,41,57
Va 42,42,58
Mvaa 192,128,16
buffer_load_dwordx4 a[104:107], v2, s[8:11], s63 offen offset:2048
Mvaa 196,132,16
Ta 156,8,4096
Ta 158,8,6144
Mvaa 200,136,16
buffer_load_dwordx4 a[108:111], v2, s[8:11], s63 offen offset:3072
Mvaa 204,140,16
Va 43,43,59
Va 40,40,60
Va 41,41,61
Mvaa 208,128,20
Va 42,42,62
Va 43,43,63
Va 40,40,64
Mvaa 212,132,20
buffer_load_dwordx4 a[112:115], v3, s[8:11], s63 offen offset:0
Mvaa 216,136,20
Va 41,41,65
Va 42,42,66
Va 43,43,67
Mvaa 220,140,20
buffer_load_dwordx4 a[116:119], v3, s[8:11], s63 offen offset:1024
Mvaa 224,128,24
Va 40,40,68
Va 41,41,69
Va 42,42,70
Mvaa 228,132,24
Va 43,43,71
Vc 1,40,41
v_lshlrev_b32 v40, 16, v1
Mvaa 232,136,24
buffer_load_dwordx4 a[120:123], v3, s[8:11], s63 offen offset:2048
Mvaa 236,140,24
v_and_b32 v41, 0xffff0000, v1
Vc 15,42,43
v_lshlrev_b32 v42, 16, v15
Mvaa 240,128,28
buffer_load_dwordx4 a[124:127], v3, s[8:11], s63 offen offset:3072
Mvaa 244,132,28
s_add_u32 s63, s5, 8
s_and_b32 s63, s63, 3
s_or_b32 s63, s63, 8
s_lshl_b32 s63, s63, 13
Mvaa 248,136,28
v_and_b32 v43, 0xffff0000, v15
v_mov_b32 v44, v40
v_mov_b32 v45, v41
Mvaa 252,140,28
v_mov_b32 v46, v42
v_mov_b32 v47, v43
v_permlane32_swap_b32 v44, v40
s_waitcnt vmcnt(32) lgkmcnt(0)
Mvaa 128,144,32
s_add_u32 m0, s35, 4096
Mvaa 132,148,32
buffer_load_dwordx4 v4, s[12:15], s48 offen offset:0 lds
Mvaa 136,152,32
Ta 128,5,8192
Ta 130,5,10240
Mvaa 140,156,32
buffer_load_dwordx4 v4, s[12:15], s49 offen offset:1024 lds
Mvaa 144,144,36
v_permlane32_swap_b32 v45, v41
v_permlane32_swap_b32 v46, v42
v_permlane32_swap_b32 v47, v43
Mvaa 148,148,36
v_mul_f32 v48, 0xbfb8aa3b, v44
v_mul_f32 v49, 0xbfb8aa3b, v45
v_mul_f32 v50, 0xbfb8aa3b, v46
Mvaa 152,152,36
buffer_load_dwordx4 v4, s[12:15], s50 offen offset:2048 lds
Mvaa 156,156,36
Ta 132,6,8192
Ta 134,6,10240
Mvaa 160,144,40
buffer_load_dwordx4 v4, s[12:15], s51 offen offset:3072 lds
Mvaa 164,148,40
s_add_u32 s4, s5, 10
s_and_b32 s4, s4, 3
s_or_b32 s4, s4, 8
s_lshl_b32 s4, s4, 16
v_add_u32 v4, s4, v123
Mvaa 168,152,40
v_mul_f32 v51, 0xbfb8aa3b, v47
Ve 48,48
Mvaa 172,156,40
buffer_load_dwordx4 a[0:3], v2, s[8:11], s63 offen offset:0
Mvaa 176,144,44
Ta 136,7,8192
Ta 138,7,10240
Mvaa 180,148,44
buffer_load_dwordx4 a[4:7], v2, s[8:11], s63 offen offset:1024
Mvaa 184,152,44
Ve 49,49
Mvaa 188,156,44
Ve 50,50
Mvaa 192,144,48
buffer_load_dwordx4 a[8:11], v2, s[8:11], s63 offen offset:2048
Mvaa 196,148,48
Ta 140,8,8192
Ta 142,8,10240
Mvaa 200,152,48
buffer_load_dwordx4 a[12:15], v2, s[8:11], s63 offen offset:3072
Mvaa 204,156,48
Ve 51,51
v_add_f32 v48, 1.0, v48
Mvaa 208,144,52
v_add_f32 v49, 1.0, v49
v_add_f32 v50, 1.0, v50
v_add_f32 v51, 1.0, v51
Mvaa 212,148,52
buffer_load_dwordx4 a[16:19], v3, s[8:11], s63 offen offset:0
Mvaa 216,152,52
v_rcp_f32 v48, v48
Mvaa 220,156,52
buffer_load_dwordx4 a[20:23], v3, s[8:11], s63 offen offset:1024
Mvaa 224,144,56
v_rcp_f32 v49, v49
Mvaa 228,148,56
v_rcp_f32 v50, v50
Mvaa 232,152,56
buffer_load_dwordx4 a[24:27], v3, s[8:11], s63 offen offset:2048
Mvaa 236,156,56
v_rcp_f32 v51, v51
Vm 44,44,48
Mvaa 240,144,60
buffer_load_dwordx4 a[28:31], v3, s[8:11], s63 offen offset:3072
Mvaa 244,148,60
s_add_u32 s63, s5, 9
s_and_b32 s63, s63, 3
s_or_b32 s63, s63, 8
s_lshl_b32 s63, s63, 13
Mvaa 248,152,60
Vm 45,45,49
Vm 46,46,50
Vm 47,47,51
Mvaa 252,156,60
Vc 1,44,45
v_lshlrev_b32 v44, 16, v1
v_and_b32 v45, 0xffff0000, v1
s_waitcnt vmcnt(26) lgkmcnt(0)
Mvaa 128,128,64
s_add_u32 m0, s35, 8192
Mvaa 132,132,64
buffer_load_dwordx4 v4, s[12:15], s48 offen offset:0 lds
Mvaa 136,136,64
Ta 144,5,12288
Ta 146,5,14336
Mvaa 140,140,64
buffer_load_dwordx4 v4, s[12:15], s49 offen offset:1024 lds
Mvaa 144,128,68
Vc 15,46,47
v_lshlrev_b32 v46, 16, v15
v_and_b32 v47, 0xffff0000, v15
Mvaa 148,132,68
Vm 40,40,44
Vm 41,41,45
Vm 42,42,46
Mvaa 152,136,68
buffer_load_dwordx4 v4, s[12:15], s50 offen offset:2048 lds
Mvaa 156,140,68
Ta 148,6,12288
Ta 150,6,14336
Mvaa 160,128,72
buffer_load_dwordx4 v4, s[12:15], s51 offen offset:3072 lds
Mvaa 164,132,72
s_add_u32 s4, s5, 11
s_and_b32 s4, s4, 3
s_or_b32 s4, s4, 8
s_lshl_b32 s4, s4, 16
v_add_u32 v4, s4, v123
Mvaa 168,136,72
Vm 43,43,47
Vc 1,40,41
v_lshlrev_b32 v40, 16, v1
Mvaa 172,140,72
buffer_load_dwordx4 a[32:35], v2, s[8:11], s63 offen offset:0
Mvaa 176,128,76
Ta 152,7,12288
Ta 154,7,14336
Mvaa 180,132,76
buffer_load_dwordx4 a[36:39], v2, s[8:11], s63 offen offset:1024
Mvaa 184,136,76
v_and_b32 v41, 0xffff0000, v1
Vc 15,42,43
v_lshlrev_b32 v42, 16, v15
Mvaa 188,140,76
v_and_b32 v43, 0xffff0000, v15
Mvaa 192,128,80
buffer_load_dwordx4 a[40:43], v2, s[8:11], s63 offen offset:2048
Mvaa 196,132,80
Ta 156,8,12288
Ta 158,8,14336
Mvaa 200,136,80
buffer_load_dwordx4 a[44:47], v2, s[8:11], s63 offen offset:3072
Mvaa 204,140,80
s_lshl_b32 s3, s32, 9
s_add_u32 s3, s3, 131072
v_and_b32 v1, 31, v0
v_lshl_add_u32 v1, v1, 4, s3
Mvaa 208,128,84
v_mul_u32_u24 v15, 28, v14
v_add_u32 v15, s3, v15
Mvaa 212,132,84
buffer_load_dwordx4 a[48:51], v3, s[8:11], s63 offen offset:0
Mvaa 216,136,84
ds_write_b128 v1, v[40:43]
ds_read_b32 v52, v15 offset:0
ds_read_b32 v53, v15 offset:4
Mvaa 220,140,84
buffer_load_dwordx4 a[52:55], v3, s[8:11], s63 offen offset:1024
Mvaa 224,128,88
ds_read_b32 v54, v15 offset:8
ds_read_b32 v55, v15 offset:12
ds_read_b32 v56, v15 offset:16
Mvaa 228,132,88
ds_read_b32 v57, v15 offset:20
Mvaa 232,136,88
buffer_load_dwordx4 a[56:59], v3, s[8:11], s63 offen offset:2048
Mvaa 236,140,88
s_waitcnt lgkmcnt(4)
ds_read_b32 v58, v15 offset:24
ds_read_b32 v59, v15 offset:256
ds_read_b32 v60, v15 offset:260
Mvaa 240,128,92
buffer_load_dwordx4 a[60:63], v3, s[8:11], s63 offen offset:3072
Mvaa 244,132,92
s_add_u32 s63, s5, 10
s_and_b32 s63, s63, 3
s_or_b32 s63, s63, 8
s_lshl_b32 s63, s63, 13
Mvaa 248,136,92
ds_read_b32 v61, v15 offset:264
ds_read_b32 v62, v15 offset:268
ds_read_b32 v63, v15 offset:272
Mvaa 252,140,92
ds_read_b32 v64, v15 offset:276
s_waitcnt vmcnt(24) lgkmcnt(0)
Mvaa 128,144,96
s_add_u32 m0, s35, 12288
Mvaa 132,148,96
buffer_load_dwordx4 v4, s[12:15], s48 offen offset:0 lds
Mvaa 136,152,96
Ta 128,5,0
Ta 130,5,2048
Mvaa 140,156,96
buffer_load_dwordx4 v4, s[12:15], s49 offen offset:1024 lds
Mvaa 144,144,100
s_waitcnt lgkmcnt(4)
ds_read_b32 v65, v15 offset:280
v_lshrrev_b32 v1, 5, v0
v_lshlrev_b32 v1, 8, v1
Mvaa 148,148,100
v_lshl_add_u32 v1, v13, 5, v1
v_and_b32 v15, 1, v12
v_lshl_add_u32 v1, v15, 4, v1
Mvaa 152,152,100
buffer_load_dwordx4 v4, s[12:15], s50 offen offset:2048 lds
Mvaa 156,156,100
Ta 132,6,0
Ta 134,6,2048
Mvaa 160,144,104
buffer_load_dwordx4 v4, s[12:15], s51 offen offset:3072 lds
Mvaa 164,148,104
s_add_u32 s4, s5, 12
s_and_b32 s4, s4, 3
s_or_b32 s4, s4, 12
s_lshl_b32 s4, s4, 16
v_add_u32 v4, s4, v123
Mvaa 168,152,104
v_add_u32 v1, s3, v1
s_waitcnt lgkmcnt(2)
v_lshlrev_b32 v100, 16, v72
v_and_b32 v101, 0xffff0000, v72
Mvaa 172,156,104
buffer_load_dwordx4 a[64:67], v2, s[8:11], s63 offen offset:0
Mvaa 176,144,108
Ta 136,7,0
Ta 138,7,2048
Mvaa 180,148,108
buffer_load_dwordx4 a[68:71], v2, s[8:11], s63 offen offset:1024
Mvaa 184,152,108
Vm 104,100,52
Vm 105,101,52
Vm 112,100,59
Mvaa 188,156,108
Vm 113,101,59
v_lshlrev_b32 v100, 16, v73
v_and_b32 v101, 0xffff0000, v73
Mvaa 192,144,112
buffer_load_dwordx4 a[72:75], v2, s[8:11], s63 offen offset:2048
Mvaa 196,148,112
Ta 140,8,0
Ta 142,8,2048
Mvaa 200,152,112
buffer_load_dwordx4 a[76:79], v2, s[8:11], s63 offen offset:3072
Mvaa 204,156,112
Vm 106,100,52
Vm 107,101,52
Vm 114,100,59
Mvaa 208,144,116
Vm 115,101,59
v_lshlrev_b32 v100, 16, v74
v_and_b32 v101, 0xffff0000, v74
Mvaa 212,148,116
buffer_load_dwordx4 a[80:83], v3, s[8:11], s63 offen offset:0
Mvaa 216,152,116
Vm 108,100,52
Vm 109,101,52
Vm 116,100,59
Mvaa 220,156,116
buffer_load_dwordx4 a[84:87], v3, s[8:11], s63 offen offset:1024
Mvaa 224,144,120
Vm 117,101,59
v_lshlrev_b32 v100, 16, v75
v_and_b32 v101, 0xffff0000, v75
Mvaa 228,148,120
Vm 110,100,52
Vm 111,101,52
Vm 118,100,59
Mvaa 232,152,120
buffer_load_dwordx4 a[88:91], v3, s[8:11], s63 offen offset:2048
Mvaa 236,156,120
Vm 119,101,59
v_lshlrev_b32 v100, 16, v76
v_and_b32 v101, 0xffff0000, v76
Mvaa 240,144,124
buffer_load_dwordx4 a[92:95], v3, s[8:11], s63 offen offset:3072
Mvaa 244,148,124
s_add_u32 s63, s5, 11
s_and_b32 s63, s63, 3
s_or_b32 s63, s63, 8
s_lshl_b32 s63, s63, 13
Mvaa 248,152,124
Vf 104,100,53
Vf 105,101,53
Vf 112,100,60
Mvaa 252,156,124
Vf 113,101,60
v_lshlrev_b32 v100, 16, v77
v_and_b32 v101, 0xffff0000, v77
s_waitcnt vmcnt(24) lgkmcnt(0)
Mvaa 128,128,0
s_add_u32 m0, s35, 0
Mvaa 132,132,0
buffer_load_dwordx4 v4, s[12:15], s48 offen offset:0 lds
Mvaa 136,136,0
Ta 144,5,4096
Ta 146,5,6144
Mvaa 140,140,0
buffer_load_dwordx4 v4, s[12:15], s49 offen offset:1024 lds
Mvaa 144,128,4
Vf 106,100,53
Vf 107,101,53
Vf 114,100,60
Mvaa 148,132,4
Vf 115,101,60
v_lshlrev_b32 v100, 16, v78
v_and_b32 v101, 0xffff0000, v78
Mvaa 152,136,4
buffer_load_dwordx4 v4, s[12:15], s50 offen offset:2048 lds
Mvaa 156,140,4
Ta 148,6,4096
Ta 150,6,6144
Mvaa 160,128,8
buffer_load_dwordx4 v4, s[12:15], s51 offen offset:3072 lds
Mvaa 164,132,8
s_add_u32 s4, s5, 13
s_and_b32 s4, s4, 3
s_or_b32 s4, s4, 12
s_lshl_b32 s4, s4, 16
v_add_u32 v4, s4, v123
Mvaa 168,136,8
Vf 108,100,53
Vf 109,101,53
Vf 116,100,60
Mvaa 172,140,8
buffer_load_dwordx4 a[96:99], v2, s[8:11], s63 offen offset:0
Mvaa 176,128,12
Ta 152,7,4096
Ta 154,7,6144
Mvaa 180,132,12
buffer_load_dwordx4 a[100:103], v2, s[8:11], s63 offen offset:1024
Mvaa 184,136,12
Vf 117,101,60
v_lshlrev_b32 v100, 16, v79
v_and_b32 v101, 0xffff0000, v79
Mvaa 188,140,12
Vf 110,100,53
Vf 111,101,53
Vf 118,100,60
Mvaa 192,128,16
buffer_load_dwordx4 a[104:107], v2, s[8:11], s63 offen offset:2048
Mvaa 196,132,16
Ta 156,8,4096
Ta 158,8,6144
Mvaa 200,136,16
buffer_load_dwordx4 a[108:111], v2, s[8:11], s63 offen offset:3072
Mvaa 204,140,16
Vf 119,101,60
v_lshlrev_b32 v100, 16, v80
v_and_b32 v101, 0xffff0000, v80
Mvaa 208,128,20
Vf 104,100,54
Vf 105,101,54
Vf 112,100,61
Mvaa 212,132,20
buffer_load_dwordx4 a[112:115], v3, s[8:11], s63 offen offset:0
Mvaa 216,136,20
Vf 113,101,61
v_lshlrev_b32 v100, 16, v81
v_and_b32 v101, 0xffff0000, v81
Mvaa 220,140,20
buffer_load_dwordx4 a[116:119], v3, s[8:11], s63 offen offset:1024
Mvaa 224,128,24
Vf 106,100,54
Vf 107,101,54
Vf 114,100,61
Mvaa 228,132,24
Vf 115,101,61
v_lshlrev_b32 v100, 16, v82
v_and_b32 v101, 0xffff0000, v82
Mvaa 232,136,24
buffer_load_dwordx4 a[120:123], v3, s[8:11], s63 offen offset:2048
Mvaa 236,140,24
Vf 108,100,54
Vf 109,101,54
Vf 116,100,61
Mvaa 240,128,28
buffer_load_dwordx4 a[124:127], v3, s[8:11], s63 offen offset:3072
Mvaa 244,132,28
s_add_u32 s63, s5, 12
s_and_b32 s63, s63, 3
s_or_b32 s63, s63, 12
s_lshl_b32 s63, s63, 13
Mvaa 248,136,28
Vf 117,101,61
v_lshlrev_b32 v100, 16, v83
v_and_b32 v101, 0xffff0000, v83
Mvaa 252,140,28
Vf 110,100,54
Vf 111,101,54
Vf 118,100,61
s_waitcnt vmcnt(24) lgkmcnt(0)
Mvaa 128,144,32
s_add_u32 m0, s35, 4096
Mvaa 132,148,32
buffer_load_dwordx4 v4, s[12:15], s48 offen offset:0 lds
Mvaa 136,152,32
Ta 128,5,8192
Ta 130,5,10240
Mvaa 140,156,32
buffer_load_dwordx4 v4, s[12:15], s49 offen offset:1024 lds
Mvaa 144,144,36
Vf 119,101,61
v_lshlrev_b32 v100, 16, v84
v_and_b32 v101, 0xffff0000, v84
Mvaa 148,148,36
Vf 104,100,55
Vf 105,101,55
Vf 112,100,62
Mvaa 152,152,36
buffer_load_dwordx4 v4, s[12:15], s50 offen offset:2048 lds
Mvaa 156,156,36
Ta 132,6,8192
Ta 134,6,10240
Mvaa 160,144,40
buffer_load_dwordx4 v4, s[12:15], s51 offen offset:3072 lds
Mvaa 164,148,40
s_add_u32 s4, s5, 14
s_and_b32 s4, s4, 3
s_or_b32 s4, s4, 12
s_lshl_b32 s4, s4, 16
v_add_u32 v4, s4, v123
Mvaa 168,152,40
Vf 113,101,62
v_lshlrev_b32 v100, 16, v85
v_and_b32 v101, 0xffff0000, v85
Mvaa 172,156,40
buffer_load_dwordx4 a[0:3], v2, s[8:11], s63 offen offset:0
Mvaa 176,144,44
Ta 136,7,8192
Ta 138,7,10240
Mvaa 180,148,44
buffer_load_dwordx4 a[4:7], v2, s[8:11], s63 offen offset:1024
Mvaa 184,152,44
Vf 106,100,55
Vf 107,101,55
Vf 114,100,62
Mvaa 188,156,44
Vf 115,101,62
v_lshlrev_b32 v100, 16, v86
v_and_b32 v101, 0xffff0000, v86
Mvaa 192,144,48
buffer_load_dwordx4 a[8:11], v2, s[8:11], s63 offen offset:2048
Mvaa 196,148,48
Ta 140,8,8192
Ta 142,8,10240
Mvaa 200,152,48
buffer_load_dwordx4 a[12:15], v2, s[8:11], s63 offen offset:3072
Mvaa 204,156,48
Vf 108,100,55
Vf 109,101,55
Vf 116,100,62
Mvaa 208,144,52
Vf 117,101,62
v_lshlrev_b32 v100, 16, v87
v_and_b32 v101, 0xffff0000, v87
Mvaa 212,148,52
buffer_load_dwordx4 a[16:19], v3, s[8:11], s63 offen offset:0
Mvaa 216,152,52
Vf 110,100,55
Vf 111,101,55
Vf 118,100,62
Mvaa 220,156,52
buffer_load_dwordx4 a[20:23], v3, s[8:11], s63 offen offset:1024
Mvaa 224,144,56
Vf 119,101,62
v_lshlrev_b32 v100, 16, v88
v_and_b32 v101, 0xffff0000, v88
Mvaa 228,148,56
Vf 104,100,56
Vf 105,101,56
Vf 112,100,63
Mvaa 232,152,56
buffer_load_dwordx4 a[24:27], v3, s[8:11], s63 offen offset:2048
Mvaa 236,156,56
Vf 113,101,63
v_lshlrev_b32 v100, 16, v89
v_and_b32 v101, 0xffff0000, v89
Mvaa 240,144,60
buffer_load_dwordx4 a[28:31], v3, s[8:11], s63 offen offset:3072
Mvaa 244,148,60
s_add_u32 s63, s5, 13
s_and_b32 s63, s63, 3
s_or_b32 s63, s63, 12
s_lshl_b32 s63, s63, 13
Mvaa 248,152,60
Vf 106,100,56
Vf 107,101,56
Vf 114,100,63
Mvaa 252,156,60
Vf 115,101,63
v_lshlrev_b32 v100, 16, v90
v_and_b32 v101, 0xffff0000, v90
s_waitcnt vmcnt(24) lgkmcnt(0)
Mvaa 128,128,64
s_add_u32 m0, s35, 8192
Mvaa 132,132,64
buffer_load_dwordx4 v4, s[12:15], s48 offen offset:0 lds
Mvaa 136,136,64
Ta 144,5,12288
Ta 146,5,14336
Mvaa 140,140,64
buffer_load_dwordx4 v4, s[12:15], s49 offen offset:1024 lds
Mvaa 144,128,68
Vf 108,100,56
Vf 109,101,56
Vf 116,100,63
Mvaa 148,132,68
Vf 117,101,63
v_lshlrev_b32 v100, 16, v91
v_and_b32 v101, 0xffff0000, v91
Mvaa 152,136,68
buffer_load_dwordx4 v4, s[12:15], s50 offen offset:2048 lds
Mvaa 156,140,68
Ta 148,6,12288
Ta 150,6,14336
Mvaa 160,128,72
buffer_load_dwordx4 v4, s[12:15], s51 offen offset:3072 lds
Mvaa 164,132,72
s_add_u32 s4, s5, 15
s_and_b32 s4, s4, 3
s_or_b32 s4, s4, 12
s_lshl_b32 s4, s4, 16
v_add_u32 v4, s4, v123
Mvaa 168,136,72
Vf 110,100,56
Vf 111,101,56
Vf 118,100,63
Mvaa 172,140,72
buffer_load_dwordx4 a[32:35], v2, s[8:11], s63 offen offset:0
Mvaa 176,128,76
Ta 152,7,12288
Ta 154,7,14336
Mvaa 180,132,76
buffer_load_dwordx4 a[36:39], v2, s[8:11], s63 offen offset:1024
Mvaa 184,136,76
Vf 119,101,63
v_lshlrev_b32 v100, 16, v92
v_and_b32 v101, 0xffff0000, v92
Mvaa 188,140,76
Vf 104,100,57
Vf 105,101,57
Vf 112,100,64
Mvaa 192,128,80
buffer_load_dwordx4 a[40:43], v2, s[8:11], s63 offen offset:2048
Mvaa 196,132,80
Ta 156,8,12288
Ta 158,8,14336
Mvaa 200,136,80
buffer_load_dwordx4 a[44:47], v2, s[8:11], s63 offen offset:3072
Mvaa 204,140,80
Vf 113,101,64
v_lshlrev_b32 v100, 16, v93
v_and_b32 v101, 0xffff0000, v93
Mvaa 208,128,84
Vf 106,100,57
Vf 107,101,57
Vf 114,100,64
Mvaa 212,132,84
buffer_load_dwordx4 a[48:51], v3, s[8:11], s63 offen offset:0
Mvaa 216,136,84
Vf 115,101,64
v_lshlrev_b32 v100, 16, v94
v_and_b32 v101, 0xffff0000, v94
Mvaa 220,140,84
buffer_load_dwordx4 a[52:55], v3, s[8:11], s63 offen offset:1024
Mvaa 224,128,88
Vf 108,100,57
Vf 109,101,57
Vf 116,100,64
Mvaa 228,132,88
Vf 117,101,64
v_lshlrev_b32 v100, 16, v95
v_and_b32 v101, 0xffff0000, v95
Mvaa 232,136,88
buffer_load_dwordx4 a[56:59], v3, s[8:11], s63 offen offset:2048
Mvaa 236,140,88
Vf 110,100,57
Vf 111,101,57
Vf 118,100,64
Mvaa 240,128,92
buffer_load_dwordx4 a[60:63], v3, s[8:11], s63 offen offset:3072
Mvaa 244,132,92
s_add_u32 s63, s5, 14
s_and_b32 s63, s63, 3
s_or_b32 s63, s63, 12
s_lshl_b32 s63, s63, 13
Mvaa 248,136,92
Vf 119,101,64
v_lshlrev_b32 v100, 16, v96
v_and_b32 v101, 0xffff0000, v96
Mvaa 252,140,92
Vf 104,100,58
Vf 105,101,58
Vf 112,100,65
s_waitcnt vmcnt(24) lgkmcnt(0)
Mvaa 128,144,96
s_add_u32 m0, s35, 12288
Mvaa 132,148,96
buffer_load_dwordx4 v4, s[12:15], s48 offen offset:0 lds
Mvaa 136,152,96
Ta 128,5,0
Ta 130,5,2048
Mvaa 140,156,96
buffer_load_dwordx4 v4, s[12:15], s49 offen offset:1024 lds
Mvaa 144,144,100
Vf 113,101,65
v_lshlrev_b32 v100, 16, v97
v_and_b32 v101, 0xffff0000, v97
Mvaa 148,148,100
Vf 106,100,58
Vf 107,101,58
Vf 114,100,65
Mvaa 152,152,100
buffer_load_dwordx4 v4, s[12:15], s50 offen offset:2048 lds
Mvaa 156,156,100
Ta 132,6,0
Ta 134,6,2048
Mvaa 160,144,104
buffer_load_dwordx4 v4, s[12:15], s51 offen offset:3072 lds
Mvaa 164,148,104
s_add_u32 s4, s5, 16
s_and_b32 s4, s4, 3
s_or_b32 s4, s4, 16
s_lshl_b32 s4, s4, 16
v_add_u32 v4, s4, v123
Mvaa 168,152,104
Vf 115,101,65
v_lshlrev_b32 v100, 16, v98
v_and_b32 v101, 0xffff0000, v98
Mvaa 172,156,104
buffer_load_dwordx4 a[64:67], v2, s[8:11], s63 offen offset:0
Mvaa 176,144,108
Ta 136,7,0
Ta 138,7,2048
Mvaa 180,148,108
buffer_load_dwordx4 a[68:71], v2, s[8:11], s63 offen offset:1024
Mvaa 184,152,108
Vf 108,100,58
Vf 109,101,58
Vf 116,100,65
Mvaa 188,156,108
Vf 117,101,65
v_lshlrev_b32 v100, 16, v99
v_and_b32 v101, 0xffff0000, v99
Mvaa 192,144,112
buffer_load_dwordx4 a[72:75], v2, s[8:11], s63 offen offset:2048
Mvaa 196,148,112
Ta 140,8,0
Ta 142,8,2048
Mvaa 200,152,112
buffer_load_dwordx4 a[76:79], v2, s[8:11], s63 offen offset:3072
Mvaa 204,156,112
Vf 110,100,58
Vf 111,101,58
Vf 118,100,65
Mvaa 208,144,116
Vf 119,101,65
v_permlane32_swap_b32 v104, v112
v_permlane32_swap_b32 v105, v113
Mvaa 212,148,116
buffer_load_dwordx4 a[80:83], v3, s[8:11], s63 offen offset:0
Mvaa 216,152,116
v_permlane32_swap_b32 v106, v114
v_permlane32_swap_b32 v107, v115
v_permlane32_swap_b32 v108, v116
Mvaa 220,156,116
buffer_load_dwordx4 a[84:87], v3, s[8:11], s63 offen offset:1024
Mvaa 224,144,120
v_permlane32_swap_b32 v109, v117
v_permlane32_swap_b32 v110, v118
v_permlane32_swap_b32 v111, v119
Mvaa 228,148,120
Va 104,104,112
Va 105,105,113
Va 106,106,114
Mvaa 232,152,120
buffer_load_dwordx4 a[88:91], v3, s[8:11], s63 offen offset:2048
Mvaa 236,156,120
Va 107,107,115
Va 108,108,116
Va 109,109,117
Mvaa 240,144,124
buffer_load_dwordx4 a[92:95], v3, s[8:11], s63 offen offset:3072
Mvaa 244,148,124
s_add_u32 s63, s5, 15
s_and_b32 s63, s63, 3
s_or_b32 s63, s63, 12
s_lshl_b32 s63, s63, 13
Mvaa 248,152,124
Va 110,110,118
Va 111,111,119
v_permlane16_swap_b32 v104, v108
Mvaa 252,156,124
v_permlane16_swap_b32 v105, v109
v_permlane16_swap_b32 v106, v110
v_permlane16_swap_b32 v107, v111
s_waitcnt vmcnt(24) lgkmcnt(0)
Mvaa 128,128,0
s_add_u32 m0, s35, 0
Mvaa 132,132,0
buffer_load_dwordx4 v4, s[12:15], s48 offen offset:0 lds
Mvaa 136,136,0
Ta 144,5,4096
Ta 146,5,6144
Mvaa 140,140,0
buffer_load_dwordx4 v4, s[12:15], s49 offen offset:1024 lds
Mvaa 144,128,4
Va 104,104,108
Va 105,105,109
Va 106,106,110
Mvaa 148,132,4
Va 107,107,111
v_add_f32_dpp v104, v104, v104 row_ror:8 row_mask:0xf bank_mask:0xf
v_add_f32_dpp v105, v105, v105 row_ror:8 row_mask:0xf bank_mask:0xf
Mvaa 152,136,4
buffer_load_dwordx4 v4, s[12:15], s50 offen offset:2048 lds
Mvaa 156,140,4
Ta 148,6,4096
Ta 150,6,6144
Mvaa 160,128,8
buffer_load_dwordx4 v4, s[12:15], s51 offen offset:3072 lds
Mvaa 164,132,8
s_add_u32 s4, s5, 17
s_and_b32 s4, s4, 3
s_or_b32 s4, s4, 16
s_lshl_b32 s4, s4, 16
v_add_u32 v4, s4, v123
Mvaa 168,136,8
v_add_f32_dpp v106, v106, v106 row_ror:8 row_mask:0xf bank_mask:0xf
v_add_f32_dpp v107, v107, v107 row_ror:8 row_mask:0xf bank_mask:0xf
Mvaa 172,140,8
buffer_load_dwordx4 a[96:99], v2, s[8:11], s63 offen offset:0
Mvaa 176,128,12
Ta 152,7,4096
Ta 154,7,6144
Mvaa 180,132,12
buffer_load_dwordx4 a[100:103], v2, s[8:11], s63 offen offset:1024
Mvaa 184,136,12
ds_write_b128 v1, v[104:107] offset:2048
v_lshlrev_b32 v1, 3, v0
v_add_u32 v15, 133120, v1
Mvaa 188,140,12
s_lshl_b32 s3, s39, 4
s_add_u32 s3, s3, s37
s_lshl_b32 s3, s3, 9
Mvaa 192,128,16
buffer_load_dwordx4 a[104:107], v2, s[8:11], s63 offen offset:2048
Mvaa 196,132,16
Ta 156,8,4096
Ta 158,8,6144
Mvaa 200,136,16
buffer_load_dwordx4 a[108:111], v2, s[8:11], s63 offen offset:3072
Mvaa 204,140,16
s_add_u32 s3, s3, 5308416
s_cmp_eq_u32 s32, 0
s_cselect_b32 s3, s3, 0x7ff00000
s_lshl_b32 s38, s39, 4
s_cmp_eq_u32 s32, 0
s_cselect_b32 s38, s38, 0x7ff00000
Mvaa 208,128,20
s_waitcnt lgkmcnt(2)
s_barrier
ds_read_b64 v[104:105], v15 offset:0
ds_read_b64 v[106:107], v15 offset:512
ds_read_b64 v[108:109], v15 offset:1024
Mvaa 212,132,20
buffer_load_dwordx4 a[112:115], v3, s[8:11], s63 offen offset:0
Mvaa 216,136,20
ds_read_b64 v[110:111], v15 offset:1536
v_mov_b32 v102, 1
v_mov_b32 v103, 0
Mvaa 220,140,20
buffer_load_dwordx4 a[116:119], v3, s[8:11], s63 offen offset:1024
Mvaa 224,128,24
s_waitcnt lgkmcnt(0)
Va 104,104,106
Va 108,108,110
Va 105,105,107
Mvaa 228,132,24
Va 109,109,111
Va 104,104,108
Va 105,105,109
Mvaa 232,136,24
buffer_load_dwordx4 a[120:123], v3, s[8:11], s63 offen offset:2048
Mvaa 236,140,24
buffer_store_dwordx2 v[104:105], v1, s[16:19], s3 offen sc1
v_lshlrev_b32 v40, 16, v16
Mvaa 240,128,28
buffer_load_dwordx4 a[124:127], v3, s[8:11], s63 offen offset:3072
Mvaa 244,132,28
s_add_u32 s63, s5, 16
s_and_b32 s63, s63, 3
s_or_b32 s63, s63, 16
s_lshl_b32 s63, s63, 13
Mvaa 248,136,28
v_and_b32 v41, 0xffff0000, v16
v_lshlrev_b32 v42, 16, v17
v_and_b32 v43, 0xffff0000, v17
Mvaa 252,140,28
v_lshlrev_b32 v44, 16, v18
v_and_b32 v45, 0xffff0000, v18
v_lshlrev_b32 v46, 16, v19
s_waitcnt vmcnt(25) lgkmcnt(0)
Mvaa 128,144,32
s_add_u32 m0, s35, 4096
Mvaa 132,148,32
buffer_load_dwordx4 v4, s[12:15], s48 offen offset:0 lds
Mvaa 136,152,32
Ta 128,5,8192
Ta 130,5,10240
Mvaa 140,156,32
buffer_load_dwordx4 v4, s[12:15], s49 offen offset:1024 lds
Mvaa 144,144,36
v_and_b32 v47, 0xffff0000, v19
Vs 40,40,32
Vs 41,41,32
Mvaa 148,148,36
Vs 42,42,32
Vs 43,43,32
Vs 44,44,32
Mvaa 152,152,36
buffer_load_dwordx4 v4, s[12:15], s50 offen offset:2048 lds
Mvaa 156,156,36
Ta 132,6,8192
Ta 134,6,10240
Mvaa 160,144,40
buffer_load_dwordx4 v4, s[12:15], s51 offen offset:3072 lds
Mvaa 164,148,40
s_add_u32 s4, s5, 18
s_and_b32 s4, s4, 3
s_or_b32 s4, s4, 16
s_lshl_b32 s4, s4, 16
v_add_u32 v4, s4, v123
Mvaa 168,152,40
Vs 45,45,32
Vs 46,46,32
Vs 47,47,32
Mvaa 172,156,40
buffer_load_dwordx4 a[0:3], v2, s[8:11], s63 offen offset:0
Mvaa 176,144,44
Ta 136,7,8192
Ta 138,7,10240
Mvaa 180,148,44
buffer_load_dwordx4 a[4:7], v2, s[8:11], s63 offen offset:1024
Mvaa 184,152,44
Vc 72,40,41
v_lshlrev_b32 v40, 16, v72
v_and_b32 v41, 0xffff0000, v72
Mvaa 188,156,44
Vc 73,42,43
v_lshlrev_b32 v42, 16, v73
v_and_b32 v43, 0xffff0000, v73
Mvaa 192,144,48
buffer_load_dwordx4 a[8:11], v2, s[8:11], s63 offen offset:2048
Mvaa 196,148,48
Ta 140,8,8192
Ta 142,8,10240
Mvaa 200,152,48
buffer_load_dwordx4 a[12:15], v2, s[8:11], s63 offen offset:3072
Mvaa 204,156,48
Vc 74,44,45
v_lshlrev_b32 v44, 16, v74
v_and_b32 v45, 0xffff0000, v74
Mvaa 208,144,52
Vc 75,46,47
v_lshlrev_b32 v46, 16, v75
v_and_b32 v47, 0xffff0000, v75
Mvaa 212,148,52
buffer_load_dwordx4 a[16:19], v3, s[8:11], s63 offen offset:0
Mvaa 216,152,52
Vm 40,40,33
Vm 41,41,33
Vm 42,42,33
Mvaa 220,156,52
buffer_load_dwordx4 a[20:23], v3, s[8:11], s63 offen offset:1024
Mvaa 224,144,56
Vm 43,43,33
Vm 44,44,33
Vm 45,45,33
Mvaa 228,148,56
Vm 46,46,33
Vm 47,47,33
Vc 72,40,41
Mvaa 232,152,56
buffer_load_dwordx4 a[24:27], v3, s[8:11], s63 offen offset:2048
Mvaa 236,156,56
v_lshlrev_b32 v40, 16, v72
v_and_b32 v41, 0xffff0000, v72
Vc 73,42,43
Mvaa 240,144,60
buffer_load_dwordx4 a[28:31], v3, s[8:11], s63 offen offset:3072
Mvaa 244,148,60
s_add_u32 s63, s5, 17
s_and_b32 s63, s63, 3
s_or_b32 s63, s63, 16
s_lshl_b32 s63, s63, 13
Mvaa 248,152,60
v_lshlrev_b32 v42, 16, v73
v_and_b32 v43, 0xffff0000, v73
Vc 74,44,45
Mvaa 252,156,60
v_lshlrev_b32 v44, 16, v74
v_and_b32 v45, 0xffff0000, v74
Vc 75,46,47
s_waitcnt vmcnt(25) lgkmcnt(0)
Mvaa 128,128,64
s_add_u32 m0, s35, 8192
Mvaa 132,132,64
buffer_load_dwordx4 v4, s[12:15], s48 offen offset:0 lds
Mvaa 136,136,64
Ta 144,5,12288
Ta 146,5,14336
Mvaa 140,140,64
buffer_load_dwordx4 v4, s[12:15], s49 offen offset:1024 lds
Mvaa 144,128,68
v_lshlrev_b32 v46, 16, v75
v_and_b32 v47, 0xffff0000, v75
v_mul_f32 v72, 0xbfb8aa3b, v40
Mvaa 148,132,68
v_mul_f32 v73, 0xbfb8aa3b, v41
v_mul_f32 v74, 0xbfb8aa3b, v42
v_mul_f32 v75, 0xbfb8aa3b, v43
Mvaa 152,136,68
buffer_load_dwordx4 v4, s[12:15], s50 offen offset:2048 lds
Mvaa 156,140,68
Ta 148,6,12288
Ta 150,6,14336
Mvaa 160,128,72
buffer_load_dwordx4 v4, s[12:15], s51 offen offset:3072 lds
Mvaa 164,132,72
s_add_u32 s4, s5, 19
s_and_b32 s4, s4, 3
s_or_b32 s4, s4, 16
s_lshl_b32 s4, s4, 16
v_add_u32 v4, s4, v123
Mvaa 168,136,72
v_mul_f32 v76, 0xbfb8aa3b, v44
v_mul_f32 v77, 0xbfb8aa3b, v45
v_mul_f32 v78, 0xbfb8aa3b, v46
Mvaa 172,140,72
buffer_load_dwordx4 a[32:35], v2, s[8:11], s63 offen offset:0
Mvaa 176,128,76
Ta 152,7,12288
Ta 154,7,14336
Mvaa 180,132,76
buffer_load_dwordx4 a[36:39], v2, s[8:11], s63 offen offset:1024
Mvaa 184,136,76
v_mul_f32 v79, 0xbfb8aa3b, v47
Ve 72,72
Mvaa 188,140,76
Ve 73,73
Mvaa 192,128,80
buffer_load_dwordx4 a[40:43], v2, s[8:11], s63 offen offset:2048
Mvaa 196,132,80
Ta 156,8,12288
Ta 158,8,14336
Mvaa 200,136,80
buffer_load_dwordx4 a[44:47], v2, s[8:11], s63 offen offset:3072
Mvaa 204,140,80
Ve 74,74
Mvaa 208,128,84
Ve 75,75
Mvaa 212,132,84
buffer_load_dwordx4 a[48:51], v3, s[8:11], s63 offen offset:0
Mvaa 216,136,84
Ve 76,76
Mvaa 220,140,84
buffer_load_dwordx4 a[52:55], v3, s[8:11], s63 offen offset:1024
Mvaa 224,128,88
Ve 77,77
Mvaa 228,132,88
Ve 78,78
Mvaa 232,136,88
buffer_load_dwordx4 a[56:59], v3, s[8:11], s63 offen offset:2048
Mvaa 236,140,88
Ve 79,79
v_add_f32 v72, 1.0, v72
Mvaa 240,128,92
buffer_load_dwordx4 a[60:63], v3, s[8:11], s63 offen offset:3072
Mvaa 244,132,92
s_add_u32 s63, s5, 18
s_and_b32 s63, s63, 3
s_or_b32 s63, s63, 16
s_lshl_b32 s63, s63, 13
Mvaa 248,136,92
v_add_f32 v73, 1.0, v73
v_add_f32 v74, 1.0, v74
v_add_f32 v75, 1.0, v75
Mvaa 252,140,92
v_add_f32 v76, 1.0, v76
v_add_f32 v77, 1.0, v77
v_add_f32 v78, 1.0, v78
s_waitcnt vmcnt(24) lgkmcnt(0)
Mvaa 128,144,96
s_add_u32 m0, s35, 12288
Mvaa 132,148,96
buffer_load_dwordx4 v4, s[12:15], s48 offen offset:0 lds
Mvaa 136,152,96
Ta 128,5,0
Ta 130,5,2048
Mvaa 140,156,96
buffer_load_dwordx4 v4, s[12:15], s49 offen offset:1024 lds
Mvaa 144,144,100
v_add_f32 v79, 1.0, v79
v_rcp_f32 v72, v72
Mvaa 148,148,100
v_rcp_f32 v73, v73
Mvaa 152,152,100
buffer_load_dwordx4 v4, s[12:15], s50 offen offset:2048 lds
Mvaa 156,156,100
Ta 132,6,0
Ta 134,6,2048
Mvaa 160,144,104
buffer_load_dwordx4 v4, s[12:15], s51 offen offset:3072 lds
Mvaa 164,148,104
s_add_u32 s4, s5, 20
s_and_b32 s4, s4, 3
s_or_b32 s4, s4, 20
s_lshl_b32 s4, s4, 16
v_add_u32 v4, s4, v123
Mvaa 168,152,104
v_rcp_f32 v74, v74
Mvaa 172,156,104
buffer_load_dwordx4 a[64:67], v2, s[8:11], s63 offen offset:0
Mvaa 176,144,108
Ta 136,7,0
Ta 138,7,2048
Mvaa 180,148,108
buffer_load_dwordx4 a[68:71], v2, s[8:11], s63 offen offset:1024
Mvaa 184,152,108
v_rcp_f32 v75, v75
Mvaa 188,156,108
v_rcp_f32 v76, v76
Mvaa 192,144,112
buffer_load_dwordx4 a[72:75], v2, s[8:11], s63 offen offset:2048
Mvaa 196,148,112
Ta 140,8,0
Ta 142,8,2048
Mvaa 200,152,112
buffer_load_dwordx4 a[76:79], v2, s[8:11], s63 offen offset:3072
Mvaa 204,156,112
v_rcp_f32 v77, v77
Mvaa 208,144,116
v_rcp_f32 v78, v78
Mvaa 212,148,116
buffer_load_dwordx4 a[80:83], v3, s[8:11], s63 offen offset:0
Mvaa 216,152,116
v_rcp_f32 v79, v79
Vm 40,40,72
Mvaa 220,156,116
buffer_load_dwordx4 a[84:87], v3, s[8:11], s63 offen offset:1024
Mvaa 224,144,120
Vm 41,41,73
Vm 42,42,74
Vm 43,43,75
Mvaa 228,148,120
Vm 44,44,76
Vm 45,45,77
Vm 46,46,78
Mvaa 232,152,120
buffer_load_dwordx4 a[88:91], v3, s[8:11], s63 offen offset:2048
Mvaa 236,156,120
Vm 47,47,79
Vc 72,40,41
v_lshlrev_b32 v40, 16, v72
Mvaa 240,144,124
buffer_load_dwordx4 a[92:95], v3, s[8:11], s63 offen offset:3072
Mvaa 244,148,124
s_add_u32 s63, s5, 19
s_and_b32 s63, s63, 3
s_or_b32 s63, s63, 16
s_lshl_b32 s63, s63, 13
Mvaa 248,152,124
v_and_b32 v41, 0xffff0000, v72
Vc 73,42,43
v_lshlrev_b32 v42, 16, v73
Mvaa 252,156,124
v_and_b32 v43, 0xffff0000, v73
Vc 74,44,45
v_lshlrev_b32 v44, 16, v74
s_waitcnt vmcnt(24) lgkmcnt(0)
Mvaa 128,128,0
s_add_u32 m0, s35, 0
Mvaa 132,132,0
buffer_load_dwordx4 v4, s[12:15], s48 offen offset:0 lds
Mvaa 136,136,0
Ta 144,5,4096
Ta 146,5,6144
Mvaa 140,140,0
buffer_load_dwordx4 v4, s[12:15], s49 offen offset:1024 lds
Mvaa 144,128,4
v_and_b32 v45, 0xffff0000, v74
Vc 75,46,47
v_lshlrev_b32 v46, 16, v75
Mvaa 148,132,4
v_and_b32 v47, 0xffff0000, v75
v_lshlrev_b32 v48, 16, v20
v_and_b32 v49, 0xffff0000, v20
Mvaa 152,136,4
buffer_load_dwordx4 v4, s[12:15], s50 offen offset:2048 lds
Mvaa 156,140,4
Ta 148,6,4096
Ta 150,6,6144
Mvaa 160,128,8
buffer_load_dwordx4 v4, s[12:15], s51 offen offset:3072 lds
Mvaa 164,132,8
s_add_u32 s4, s5, 21
s_and_b32 s4, s4, 3
s_or_b32 s4, s4, 20
s_lshl_b32 s4, s4, 16
v_add_u32 v4, s4, v123
Mvaa 168,136,8
v_lshlrev_b32 v50, 16, v21
v_and_b32 v51, 0xffff0000, v21
v_lshlrev_b32 v52, 16, v22
Mvaa 172,140,8
buffer_load_dwordx4 a[96:99], v2, s[8:11], s63 offen offset:0
Mvaa 176,128,12
Ta 152,7,4096
Ta 154,7,6144
Mvaa 180,132,12
buffer_load_dwordx4 a[100:103], v2, s[8:11], s63 offen offset:1024
Mvaa 184,136,12
v_and_b32 v53, 0xffff0000, v22
v_lshlrev_b32 v54, 16, v23
v_and_b32 v55, 0xffff0000, v23
Mvaa 188,140,12
Vs 48,48,34
Vs 49,49,34
Vs 50,50,34
Mvaa 192,128,16
buffer_load_dwordx4 a[104:107], v2, s[8:11], s63 offen offset:2048
Mvaa 196,132,16
Ta 156,8,4096
Ta 158,8,6144
Mvaa 200,136,16
buffer_load_dwordx4 a[108:111], v2, s[8:11], s63 offen offset:3072
Mvaa 204,140,16
Vs 51,51,34
Vs 52,52,34
Vs 53,53,34
Mvaa 208,128,20
Vs 54,54,34
Vs 55,55,34
Vc 72,48,49
Mvaa 212,132,20
buffer_load_dwordx4 a[112:115], v3, s[8:11], s63 offen offset:0
Mvaa 216,136,20
v_lshlrev_b32 v48, 16, v72
v_and_b32 v49, 0xffff0000, v72
Vc 73,50,51
Mvaa 220,140,20
buffer_load_dwordx4 a[116:119], v3, s[8:11], s63 offen offset:1024
Mvaa 224,128,24
v_lshlrev_b32 v50, 16, v73
v_and_b32 v51, 0xffff0000, v73
Vc 74,52,53
Mvaa 228,132,24
v_lshlrev_b32 v52, 16, v74
v_and_b32 v53, 0xffff0000, v74
Vc 75,54,55
Mvaa 232,136,24
buffer_load_dwordx4 a[120:123], v3, s[8:11], s63 offen offset:2048
Mvaa 236,140,24
v_lshlrev_b32 v54, 16, v75
v_and_b32 v55, 0xffff0000, v75
Vm 48,48,35
Mvaa 240,128,28
buffer_load_dwordx4 a[124:127], v3, s[8:11], s63 offen offset:3072
Mvaa 244,132,28
s_add_u32 s63, s5, 20
s_and_b32 s63, s63, 3
s_or_b32 s63, s63, 20
s_lshl_b32 s63, s63, 13
Mvaa 248,136,28
Vm 49,49,35
Vm 50,50,35
Vm 51,51,35
Mvaa 252,140,28
Vm 52,52,35
Vm 53,53,35
Vm 54,54,35
s_waitcnt vmcnt(24) lgkmcnt(0)
Mvaa 128,144,32
s_add_u32 m0, s35, 4096
Mvaa 132,148,32
buffer_load_dwordx4 v4, s[12:15], s48 offen offset:0 lds
Mvaa 136,152,32
Ta 128,5,8192
Ta 130,5,10240
Mvaa 140,156,32
buffer_load_dwordx4 v4, s[12:15], s49 offen offset:1024 lds
Mvaa 144,144,36
Vm 55,55,35
Vc 72,48,49
v_lshlrev_b32 v48, 16, v72
Mvaa 148,148,36
v_and_b32 v49, 0xffff0000, v72
Vc 73,50,51
v_lshlrev_b32 v50, 16, v73
Mvaa 152,152,36
buffer_load_dwordx4 v4, s[12:15], s50 offen offset:2048 lds
Mvaa 156,156,36
Ta 132,6,8192
Ta 134,6,10240
Mvaa 160,144,40
buffer_load_dwordx4 v4, s[12:15], s51 offen offset:3072 lds
Mvaa 164,148,40
s_add_u32 s4, s5, 22
s_and_b32 s4, s4, 3
s_or_b32 s4, s4, 20
s_lshl_b32 s4, s4, 16
v_add_u32 v4, s4, v123
Mvaa 168,152,40
v_and_b32 v51, 0xffff0000, v73
Vc 74,52,53
v_lshlrev_b32 v52, 16, v74
Mvaa 172,156,40
buffer_load_dwordx4 a[0:3], v2, s[8:11], s63 offen offset:0
Mvaa 176,144,44
Ta 136,7,8192
Ta 138,7,10240
Mvaa 180,148,44
buffer_load_dwordx4 a[4:7], v2, s[8:11], s63 offen offset:1024
Mvaa 184,152,44
v_and_b32 v53, 0xffff0000, v74
Vc 75,54,55
v_lshlrev_b32 v54, 16, v75
Mvaa 188,156,44
v_and_b32 v55, 0xffff0000, v75
v_mul_f32 v72, 0xbfb8aa3b, v48
v_mul_f32 v73, 0xbfb8aa3b, v49
Mvaa 192,144,48
buffer_load_dwordx4 a[8:11], v2, s[8:11], s63 offen offset:2048
Mvaa 196,148,48
Ta 140,8,8192
Ta 142,8,10240
Mvaa 200,152,48
buffer_load_dwordx4 a[12:15], v2, s[8:11], s63 offen offset:3072
Mvaa 204,156,48
v_mul_f32 v74, 0xbfb8aa3b, v50
v_mul_f32 v75, 0xbfb8aa3b, v51
v_mul_f32 v76, 0xbfb8aa3b, v52
Mvaa 208,144,52
v_mul_f32 v77, 0xbfb8aa3b, v53
v_mul_f32 v78, 0xbfb8aa3b, v54
v_mul_f32 v79, 0xbfb8aa3b, v55
Mvaa 212,148,52
buffer_load_dwordx4 a[16:19], v3, s[8:11], s63 offen offset:0
Mvaa 216,152,52
Ve 72,72
Mvaa 220,156,52
buffer_load_dwordx4 a[20:23], v3, s[8:11], s63 offen offset:1024
Mvaa 224,144,56
Ve 73,73
Mvaa 228,148,56
Ve 74,74
Mvaa 232,152,56
buffer_load_dwordx4 a[24:27], v3, s[8:11], s63 offen offset:2048
Mvaa 236,156,56
Ve 75,75
Mvaa 240,144,60
buffer_load_dwordx4 a[28:31], v3, s[8:11], s63 offen offset:3072
Mvaa 244,148,60
s_add_u32 s63, s5, 21
s_and_b32 s63, s63, 3
s_or_b32 s63, s63, 20
s_lshl_b32 s63, s63, 13
Mvaa 248,152,60
Ve 76,76
Mvaa 252,156,60
Ve 77,77
s_waitcnt vmcnt(24) lgkmcnt(0)
Mvaa 128,128,64
s_add_u32 m0, s35, 8192
Mvaa 132,132,64
buffer_load_dwordx4 v4, s[12:15], s48 offen offset:0 lds
Mvaa 136,136,64
Ta 144,5,12288
Ta 146,5,14336
Mvaa 140,140,64
buffer_load_dwordx4 v4, s[12:15], s49 offen offset:1024 lds
Mvaa 144,128,68
Ve 78,78
Mvaa 148,132,68
Ve 79,79
v_add_f32 v72, 1.0, v72
Mvaa 152,136,68
buffer_load_dwordx4 v4, s[12:15], s50 offen offset:2048 lds
Mvaa 156,140,68
Ta 148,6,12288
Ta 150,6,14336
Mvaa 160,128,72
buffer_load_dwordx4 v4, s[12:15], s51 offen offset:3072 lds
Mvaa 164,132,72
s_add_u32 s4, s5, 23
s_and_b32 s4, s4, 3
s_or_b32 s4, s4, 20
s_lshl_b32 s4, s4, 16
v_add_u32 v4, s4, v123
Mvaa 168,136,72
v_add_f32 v73, 1.0, v73
v_add_f32 v74, 1.0, v74
v_add_f32 v75, 1.0, v75
Mvaa 172,140,72
buffer_load_dwordx4 a[32:35], v2, s[8:11], s63 offen offset:0
Mvaa 176,128,76
Ta 152,7,12288
Ta 154,7,14336
Mvaa 180,132,76
buffer_load_dwordx4 a[36:39], v2, s[8:11], s63 offen offset:1024
Mvaa 184,136,76
v_add_f32 v76, 1.0, v76
v_add_f32 v77, 1.0, v77
v_add_f32 v78, 1.0, v78
Mvaa 188,140,76
v_add_f32 v79, 1.0, v79
v_rcp_f32 v72, v72
Mvaa 192,128,80
buffer_load_dwordx4 a[40:43], v2, s[8:11], s63 offen offset:2048
Mvaa 196,132,80
Ta 156,8,12288
Ta 158,8,14336
Mvaa 200,136,80
buffer_load_dwordx4 a[44:47], v2, s[8:11], s63 offen offset:3072
Mvaa 204,140,80
v_rcp_f32 v73, v73
Mvaa 208,128,84
v_rcp_f32 v74, v74
Mvaa 212,132,84
buffer_load_dwordx4 a[48:51], v3, s[8:11], s63 offen offset:0
Mvaa 216,136,84
v_rcp_f32 v75, v75
Mvaa 220,140,84
buffer_load_dwordx4 a[52:55], v3, s[8:11], s63 offen offset:1024
Mvaa 224,128,88
v_rcp_f32 v76, v76
Mvaa 228,132,88
v_rcp_f32 v77, v77
Mvaa 232,136,88
buffer_load_dwordx4 a[56:59], v3, s[8:11], s63 offen offset:2048
Mvaa 236,140,88
v_rcp_f32 v78, v78
Mvaa 240,128,92
buffer_load_dwordx4 a[60:63], v3, s[8:11], s63 offen offset:3072
Mvaa 244,132,92
s_add_u32 s63, s5, 22
s_and_b32 s63, s63, 3
s_or_b32 s63, s63, 20
s_lshl_b32 s63, s63, 13
Mvaa 248,136,92
v_rcp_f32 v79, v79
Vm 48,48,72
Mvaa 252,140,92
Vm 49,49,73
Vm 50,50,74
Vm 51,51,75
s_waitcnt vmcnt(24) lgkmcnt(0)
Mvaa 128,144,96
s_add_u32 m0, s35, 12288
Mvaa 132,148,96
buffer_load_dwordx4 v4, s[12:15], s48 offen offset:0 lds
Mvaa 136,152,96
Ta 128,5,0
Ta 130,5,2048
Mvaa 140,156,96
buffer_load_dwordx4 v4, s[12:15], s49 offen offset:1024 lds
Mvaa 144,144,100
Vm 52,52,76
Vm 53,53,77
Vm 54,54,78
Mvaa 148,148,100
Vm 55,55,79
Vc 72,48,49
v_lshlrev_b32 v48, 16, v72
Mvaa 152,152,100
buffer_load_dwordx4 v4, s[12:15], s50 offen offset:2048 lds
Mvaa 156,156,100
Ta 132,6,0
Ta 134,6,2048
Mvaa 160,144,104
buffer_load_dwordx4 v4, s[12:15], s51 offen offset:3072 lds
Mvaa 164,148,104
s_add_u32 s4, s5, 24
s_and_b32 s4, s4, 3
s_or_b32 s4, s4, 24
s_lshl_b32 s4, s4, 16
v_add_u32 v4, s4, v123
Mvaa 168,152,104
v_and_b32 v49, 0xffff0000, v72
Vc 73,50,51
v_lshlrev_b32 v50, 16, v73
Mvaa 172,156,104
buffer_load_dwordx4 a[64:67], v2, s[8:11], s63 offen offset:0
Mvaa 176,144,108
Ta 136,7,0
Ta 138,7,2048
Mvaa 180,148,108
buffer_load_dwordx4 a[68:71], v2, s[8:11], s63 offen offset:1024
Mvaa 184,152,108
v_and_b32 v51, 0xffff0000, v73
Vc 74,52,53
v_lshlrev_b32 v52, 16, v74
Mvaa 188,156,108
v_and_b32 v53, 0xffff0000, v74
Vc 75,54,55
v_lshlrev_b32 v54, 16, v75
Mvaa 192,144,112
buffer_load_dwordx4 a[72:75], v2, s[8:11], s63 offen offset:2048
Mvaa 196,148,112
Ta 140,8,0
Ta 142,8,2048
Mvaa 200,152,112
buffer_load_dwordx4 a[76:79], v2, s[8:11], s63 offen offset:3072
Mvaa 204,156,112
v_and_b32 v55, 0xffff0000, v75
Mvaa 208,144,116
s_mov_b64 exec, 1
buffer_atomic_add v102, v103, s[40:43], s38 offen sc1
s_mov_b64 exec, -1
Mvaa 212,148,116
buffer_load_dwordx4 a[80:83], v3, s[8:11], s63 offen offset:0
Mvaa 216,152,116
v_lshlrev_b32 v56, 16, v24
v_and_b32 v57, 0xffff0000, v24
v_lshlrev_b32 v58, 16, v25
Mvaa 220,156,116
buffer_load_dwordx4 a[84:87], v3, s[8:11], s63 offen offset:1024
Mvaa 224,144,120
v_and_b32 v59, 0xffff0000, v25
v_lshlrev_b32 v60, 16, v26
v_and_b32 v61, 0xffff0000, v26
Mvaa 228,148,120
v_lshlrev_b32 v62, 16, v27
v_and_b32 v63, 0xffff0000, v27
Vs 56,56,36
Mvaa 232,152,120
buffer_load_dwordx4 a[88:91], v3, s[8:11], s63 offen offset:2048
Mvaa 236,156,120
Vs 57,57,36
Vs 58,58,36
Vs 59,59,36
Mvaa 240,144,124
buffer_load_dwordx4 a[92:95], v3, s[8:11], s63 offen offset:3072
Mvaa 244,148,124
s_add_u32 s63, s5, 23
s_and_b32 s63, s63, 3
s_or_b32 s63, s63, 20
s_lshl_b32 s63, s63, 13
Mvaa 248,152,124
Vs 60,60,36
Vs 61,61,36
Vs 62,62,36
Mvaa 252,156,124
Vs 63,63,36
Vc 72,56,57
v_lshlrev_b32 v56, 16, v72
s_waitcnt vmcnt(25) lgkmcnt(0)
Mvaa 128,128,0
s_add_u32 m0, s35, 0
Mvaa 132,132,0
buffer_load_dwordx4 v4, s[12:15], s48 offen offset:0 lds
Mvaa 136,136,0
Ta 144,5,4096
Ta 146,5,6144
Mvaa 140,140,0
buffer_load_dwordx4 v4, s[12:15], s49 offen offset:1024 lds
Mvaa 144,128,4
v_and_b32 v57, 0xffff0000, v72
Vc 73,58,59
v_lshlrev_b32 v58, 16, v73
Mvaa 148,132,4
v_and_b32 v59, 0xffff0000, v73
Vc 74,60,61
v_lshlrev_b32 v60, 16, v74
Mvaa 152,136,4
buffer_load_dwordx4 v4, s[12:15], s50 offen offset:2048 lds
Mvaa 156,140,4
Ta 148,6,4096
Ta 150,6,6144
Mvaa 160,128,8
buffer_load_dwordx4 v4, s[12:15], s51 offen offset:3072 lds
Mvaa 164,132,8
s_add_u32 s4, s5, 25
s_and_b32 s4, s4, 3
s_or_b32 s4, s4, 24
s_lshl_b32 s4, s4, 16
v_add_u32 v4, s4, v123
Mvaa 168,136,8
v_and_b32 v61, 0xffff0000, v74
Vc 75,62,63
v_lshlrev_b32 v62, 16, v75
Mvaa 172,140,8
buffer_load_dwordx4 a[96:99], v2, s[8:11], s63 offen offset:0
Mvaa 176,128,12
Ta 152,7,4096
Ta 154,7,6144
Mvaa 180,132,12
buffer_load_dwordx4 a[100:103], v2, s[8:11], s63 offen offset:1024
Mvaa 184,136,12
v_and_b32 v63, 0xffff0000, v75
Vm 56,56,37
Vm 57,57,37
Mvaa 188,140,12
Vm 58,58,37
Vm 59,59,37
Vm 60,60,37
Mvaa 192,128,16
buffer_load_dwordx4 a[104:107], v2, s[8:11], s63 offen offset:2048
Mvaa 196,132,16
Ta 156,8,4096
Ta 158,8,6144
Mvaa 200,136,16
buffer_load_dwordx4 a[108:111], v2, s[8:11], s63 offen offset:3072
Mvaa 204,140,16
Vm 61,61,37
Vm 62,62,37
Vm 63,63,37
Mvaa 208,128,20
Vc 72,56,57
v_lshlrev_b32 v56, 16, v72
v_and_b32 v57, 0xffff0000, v72
Mvaa 212,132,20
buffer_load_dwordx4 a[112:115], v3, s[8:11], s63 offen offset:0
Mvaa 216,136,20
Vc 73,58,59
v_lshlrev_b32 v58, 16, v73
v_and_b32 v59, 0xffff0000, v73
Mvaa 220,140,20
buffer_load_dwordx4 a[116:119], v3, s[8:11], s63 offen offset:1024
Mvaa 224,128,24
Vc 74,60,61
v_lshlrev_b32 v60, 16, v74
v_and_b32 v61, 0xffff0000, v74
Mvaa 228,132,24
Vc 75,62,63
v_lshlrev_b32 v62, 16, v75
v_and_b32 v63, 0xffff0000, v75
Mvaa 232,136,24
buffer_load_dwordx4 a[120:123], v3, s[8:11], s63 offen offset:2048
Mvaa 236,140,24
v_mul_f32 v72, 0xbfb8aa3b, v56
v_mul_f32 v73, 0xbfb8aa3b, v57
v_mul_f32 v74, 0xbfb8aa3b, v58
Mvaa 240,128,28
buffer_load_dwordx4 a[124:127], v3, s[8:11], s63 offen offset:3072
Mvaa 244,132,28
s_add_u32 s63, s5, 24
s_and_b32 s63, s63, 3
s_or_b32 s63, s63, 24
s_lshl_b32 s63, s63, 13
Mvaa 248,136,28
v_mul_f32 v75, 0xbfb8aa3b, v59
v_mul_f32 v76, 0xbfb8aa3b, v60
v_mul_f32 v77, 0xbfb8aa3b, v61
Mvaa 252,140,28
v_mul_f32 v78, 0xbfb8aa3b, v62
v_mul_f32 v79, 0xbfb8aa3b, v63
s_waitcnt vmcnt(25) lgkmcnt(0)
Mvaa 128,144,32
s_add_u32 m0, s35, 4096
Mvaa 132,148,32
buffer_load_dwordx4 v4, s[12:15], s48 offen offset:0 lds
Mvaa 136,152,32
Ta 128,5,8192
Ta 130,5,10240
Mvaa 140,156,32
buffer_load_dwordx4 v4, s[12:15], s49 offen offset:1024 lds
Mvaa 144,144,36
Ve 72,72
Mvaa 148,148,36
Ve 73,73
Mvaa 152,152,36
buffer_load_dwordx4 v4, s[12:15], s50 offen offset:2048 lds
Mvaa 156,156,36
Ta 132,6,8192
Ta 134,6,10240
Mvaa 160,144,40
buffer_load_dwordx4 v4, s[12:15], s51 offen offset:3072 lds
Mvaa 164,148,40
s_add_u32 s4, s5, 26
s_and_b32 s4, s4, 3
s_or_b32 s4, s4, 24
s_lshl_b32 s4, s4, 16
v_add_u32 v4, s4, v123
Mvaa 168,152,40
Ve 74,74
Mvaa 172,156,40
buffer_load_dwordx4 a[0:3], v2, s[8:11], s63 offen offset:0
Mvaa 176,144,44
Ta 136,7,8192
Ta 138,7,10240
Mvaa 180,148,44
buffer_load_dwordx4 a[4:7], v2, s[8:11], s63 offen offset:1024
Mvaa 184,152,44
Ve 75,75
Mvaa 188,156,44
Ve 76,76
Mvaa 192,144,48
buffer_load_dwordx4 a[8:11], v2, s[8:11], s63 offen offset:2048
Mvaa 196,148,48
Ta 140,8,8192
Ta 142,8,10240
Mvaa 200,152,48
buffer_load_dwordx4 a[12:15], v2, s[8:11], s63 offen offset:3072
Mvaa 204,156,48
Ve 77,77
Mvaa 208,144,52
Ve 78,78
Mvaa 212,148,52
buffer_load_dwordx4 a[16:19], v3, s[8:11], s63 offen offset:0
Mvaa 216,152,52
Ve 79,79
v_add_f32 v72, 1.0, v72
Mvaa 220,156,52
buffer_load_dwordx4 a[20:23], v3, s[8:11], s63 offen offset:1024
Mvaa 224,144,56
v_add_f32 v73, 1.0, v73
v_add_f32 v74, 1.0, v74
v_add_f32 v75, 1.0, v75
Mvaa 228,148,56
v_add_f32 v76, 1.0, v76
v_add_f32 v77, 1.0, v77
v_add_f32 v78, 1.0, v78
Mvaa 232,152,56
buffer_load_dwordx4 a[24:27], v3, s[8:11], s63 offen offset:2048
Mvaa 236,156,56
v_add_f32 v79, 1.0, v79
v_rcp_f32 v72, v72
Mvaa 240,144,60
buffer_load_dwordx4 a[28:31], v3, s[8:11], s63 offen offset:3072
Mvaa 244,148,60
s_add_u32 s63, s5, 25
s_and_b32 s63, s63, 3
s_or_b32 s63, s63, 24
s_lshl_b32 s63, s63, 13
Mvaa 248,152,60
v_rcp_f32 v73, v73
Mvaa 252,156,60
v_rcp_f32 v74, v74
s_waitcnt vmcnt(24) lgkmcnt(0)
Mvaa 128,128,64
s_add_u32 m0, s35, 8192
Mvaa 132,132,64
buffer_load_dwordx4 v4, s[12:15], s48 offen offset:0 lds
Mvaa 136,136,64
Ta 144,5,12288
Ta 146,5,14336
Mvaa 140,140,64
buffer_load_dwordx4 v4, s[12:15], s49 offen offset:1024 lds
Mvaa 144,128,68
v_rcp_f32 v75, v75
Mvaa 148,132,68
v_rcp_f32 v76, v76
Mvaa 152,136,68
buffer_load_dwordx4 v4, s[12:15], s50 offen offset:2048 lds
Mvaa 156,140,68
Ta 148,6,12288
Ta 150,6,14336
Mvaa 160,128,72
buffer_load_dwordx4 v4, s[12:15], s51 offen offset:3072 lds
Mvaa 164,132,72
s_add_u32 s4, s5, 27
s_and_b32 s4, s4, 3
s_or_b32 s4, s4, 24
s_lshl_b32 s4, s4, 16
v_add_u32 v4, s4, v123
Mvaa 168,136,72
v_rcp_f32 v77, v77
Mvaa 172,140,72
buffer_load_dwordx4 a[32:35], v2, s[8:11], s63 offen offset:0
Mvaa 176,128,76
Ta 152,7,12288
Ta 154,7,14336
Mvaa 180,132,76
buffer_load_dwordx4 a[36:39], v2, s[8:11], s63 offen offset:1024
Mvaa 184,136,76
v_rcp_f32 v78, v78
Mvaa 188,140,76
v_rcp_f32 v79, v79
Vm 56,56,72
Mvaa 192,128,80
buffer_load_dwordx4 a[40:43], v2, s[8:11], s63 offen offset:2048
Mvaa 196,132,80
Ta 156,8,12288
Ta 158,8,14336
Mvaa 200,136,80
buffer_load_dwordx4 a[44:47], v2, s[8:11], s63 offen offset:3072
Mvaa 204,140,80
Vm 57,57,73
Vm 58,58,74
Vm 59,59,75
Mvaa 208,128,84
Vm 60,60,76
Vm 61,61,77
Vm 62,62,78
Mvaa 212,132,84
buffer_load_dwordx4 a[48:51], v3, s[8:11], s63 offen offset:0
Mvaa 216,136,84
Vm 63,63,79
Vc 72,56,57
v_lshlrev_b32 v56, 16, v72
Mvaa 220,140,84
buffer_load_dwordx4 a[52:55], v3, s[8:11], s63 offen offset:1024
Mvaa 224,128,88
v_and_b32 v57, 0xffff0000, v72
Vc 73,58,59
v_lshlrev_b32 v58, 16, v73
Mvaa 228,132,88
v_and_b32 v59, 0xffff0000, v73
Vc 74,60,61
v_lshlrev_b32 v60, 16, v74
Mvaa 232,136,88
buffer_load_dwordx4 a[56:59], v3, s[8:11], s63 offen offset:2048
Mvaa 236,140,88
v_and_b32 v61, 0xffff0000, v74
Vc 75,62,63
v_lshlrev_b32 v62, 16, v75
Mvaa 240,128,92
buffer_load_dwordx4 a[60:63], v3, s[8:11], s63 offen offset:3072
Mvaa 244,132,92
s_add_u32 s63, s5, 26
s_and_b32 s63, s63, 3
s_or_b32 s63, s63, 24
s_lshl_b32 s63, s63, 13
Mvaa 248,136,92
v_and_b32 v63, 0xffff0000, v75
v_lshlrev_b32 v64, 16, v28
v_and_b32 v65, 0xffff0000, v28
Mvaa 252,140,92
v_lshlrev_b32 v66, 16, v29
v_and_b32 v67, 0xffff0000, v29
v_lshlrev_b32 v68, 16, v30
s_waitcnt vmcnt(24) lgkmcnt(0)
Mvaa 128,144,96
s_add_u32 m0, s35, 12288
Mvaa 132,148,96
buffer_load_dwordx4 v4, s[12:15], s48 offen offset:0 lds
Mvaa 136,152,96
Ta 128,5,0
Ta 130,5,2048
Mvaa 140,156,96
buffer_load_dwordx4 v4, s[12:15], s49 offen offset:1024 lds
Mvaa 144,144,100
v_and_b32 v69, 0xffff0000, v30
v_lshlrev_b32 v70, 16, v31
v_and_b32 v71, 0xffff0000, v31
Mvaa 148,148,100
Vs 64,64,38
Vs 65,65,38
Vs 66,66,38
Mvaa 152,152,100
buffer_load_dwordx4 v4, s[12:15], s50 offen offset:2048 lds
Mvaa 156,156,100
Ta 132,6,0
Ta 134,6,2048
Mvaa 160,144,104
buffer_load_dwordx4 v4, s[12:15], s51 offen offset:3072 lds
Mvaa 164,148,104
s_add_u32 s4, s5, 28
s_and_b32 s4, s4, 3
s_or_b32 s4, s4, 28
s_lshl_b32 s4, s4, 16
v_add_u32 v4, s4, v123
Mvaa 168,152,104
Vs 67,67,38
Vs 68,68,38
Vs 69,69,38
Mvaa 172,156,104
buffer_load_dwordx4 a[64:67], v2, s[8:11], s63 offen offset:0
Mvaa 176,144,108
Ta 136,7,0
Ta 138,7,2048
Mvaa 180,148,108
buffer_load_dwordx4 a[68:71], v2, s[8:11], s63 offen offset:1024
Mvaa 184,152,108
Vs 70,70,38
Vs 71,71,38
Vc 72,64,65
Mvaa 188,156,108
v_lshlrev_b32 v64, 16, v72
v_and_b32 v65, 0xffff0000, v72
Vc 73,66,67
Mvaa 192,144,112
buffer_load_dwordx4 a[72:75], v2, s[8:11], s63 offen offset:2048
Mvaa 196,148,112
Ta 140,8,0
Ta 142,8,2048
Mvaa 200,152,112
buffer_load_dwordx4 a[76:79], v2, s[8:11], s63 offen offset:3072
Mvaa 204,156,112
v_lshlrev_b32 v66, 16, v73
v_and_b32 v67, 0xffff0000, v73
Vc 74,68,69
Mvaa 208,144,116
v_lshlrev_b32 v68, 16, v74
v_and_b32 v69, 0xffff0000, v74
Vc 75,70,71
Mvaa 212,148,116
buffer_load_dwordx4 a[80:83], v3, s[8:11], s63 offen offset:0
Mvaa 216,152,116
v_lshlrev_b32 v70, 16, v75
v_and_b32 v71, 0xffff0000, v75
Vm 64,64,39
Mvaa 220,156,116
buffer_load_dwordx4 a[84:87], v3, s[8:11], s63 offen offset:1024
Mvaa 224,144,120
Vm 65,65,39
Vm 66,66,39
Vm 67,67,39
Mvaa 228,148,120
Vm 68,68,39
Vm 69,69,39
Vm 70,70,39
Mvaa 232,152,120
buffer_load_dwordx4 a[88:91], v3, s[8:11], s63 offen offset:2048
Mvaa 236,156,120
Vm 71,71,39
Vc 72,64,65
v_lshlrev_b32 v64, 16, v72
Mvaa 240,144,124
buffer_load_dwordx4 a[92:95], v3, s[8:11], s63 offen offset:3072
Mvaa 244,148,124
s_add_u32 s63, s5, 27
s_and_b32 s63, s63, 3
s_or_b32 s63, s63, 24
s_lshl_b32 s63, s63, 13
Mvaa 248,152,124
v_and_b32 v65, 0xffff0000, v72
Vc 73,66,67
v_lshlrev_b32 v66, 16, v73
Mvaa 252,156,124
v_and_b32 v67, 0xffff0000, v73
Vc 74,68,69
v_lshlrev_b32 v68, 16, v74
s_waitcnt vmcnt(24) lgkmcnt(0)
Mvaa 128,128,0
s_add_u32 m0, s35, 0
Mvaa 132,132,0
buffer_load_dwordx4 v4, s[12:15], s48 offen offset:0 lds
Mvaa 136,136,0
Ta 144,5,4096
Ta 146,5,6144
Mvaa 140,140,0
buffer_load_dwordx4 v4, s[12:15], s49 offen offset:1024 lds
Mvaa 144,128,4
v_and_b32 v69, 0xffff0000, v74
Vc 75,70,71
v_lshlrev_b32 v70, 16, v75
Mvaa 148,132,4
v_and_b32 v71, 0xffff0000, v75
v_mul_f32 v72, 0xbfb8aa3b, v64
v_mul_f32 v73, 0xbfb8aa3b, v65
Mvaa 152,136,4
buffer_load_dwordx4 v4, s[12:15], s50 offen offset:2048 lds
Mvaa 156,140,4
Ta 148,6,4096
Ta 150,6,6144
Mvaa 160,128,8
buffer_load_dwordx4 v4, s[12:15], s51 offen offset:3072 lds
Mvaa 164,132,8
s_add_u32 s4, s5, 29
s_and_b32 s4, s4, 3
s_or_b32 s4, s4, 28
s_lshl_b32 s4, s4, 16
v_add_u32 v4, s4, v123
Mvaa 168,136,8
v_mul_f32 v74, 0xbfb8aa3b, v66
v_mul_f32 v75, 0xbfb8aa3b, v67
v_mul_f32 v76, 0xbfb8aa3b, v68
Mvaa 172,140,8
buffer_load_dwordx4 a[96:99], v2, s[8:11], s63 offen offset:0
Mvaa 176,128,12
Ta 152,7,4096
Ta 154,7,6144
Mvaa 180,132,12
buffer_load_dwordx4 a[100:103], v2, s[8:11], s63 offen offset:1024
Mvaa 184,136,12
v_mul_f32 v77, 0xbfb8aa3b, v69
v_mul_f32 v78, 0xbfb8aa3b, v70
v_mul_f32 v79, 0xbfb8aa3b, v71
Mvaa 188,140,12
Ve 72,72
Mvaa 192,128,16
buffer_load_dwordx4 a[104:107], v2, s[8:11], s63 offen offset:2048
Mvaa 196,132,16
Ta 156,8,4096
Ta 158,8,6144
Mvaa 200,136,16
buffer_load_dwordx4 a[108:111], v2, s[8:11], s63 offen offset:3072
Mvaa 204,140,16
Ve 73,73
Mvaa 208,128,20
Ve 74,74
Mvaa 212,132,20
buffer_load_dwordx4 a[112:115], v3, s[8:11], s63 offen offset:0
Mvaa 216,136,20
Ve 75,75
Mvaa 220,140,20
buffer_load_dwordx4 a[116:119], v3, s[8:11], s63 offen offset:1024
Mvaa 224,128,24
Ve 76,76
Mvaa 228,132,24
Ve 77,77
Mvaa 232,136,24
buffer_load_dwordx4 a[120:123], v3, s[8:11], s63 offen offset:2048
Mvaa 236,140,24
Ve 78,78
Mvaa 240,128,28
buffer_load_dwordx4 a[124:127], v3, s[8:11], s63 offen offset:3072
Mvaa 244,132,28
s_add_u32 s63, s5, 28
s_and_b32 s63, s63, 3
s_or_b32 s63, s63, 28
s_lshl_b32 s63, s63, 13
Mvaa 248,136,28
Ve 79,79
v_add_f32 v72, 1.0, v72
Mvaa 252,140,28
v_add_f32 v73, 1.0, v73
v_add_f32 v74, 1.0, v74
v_add_f32 v75, 1.0, v75
s_waitcnt vmcnt(24) lgkmcnt(0)
Mvaa 128,144,32
s_add_u32 m0, s35, 4096
Mvaa 132,148,32
buffer_load_dwordx4 v4, s[12:15], s48 offen offset:0 lds
Mvaa 136,152,32
Ta 128,5,8192
Ta 130,5,10240
Mvaa 140,156,32
buffer_load_dwordx4 v4, s[12:15], s49 offen offset:1024 lds
Mvaa 144,144,36
v_add_f32 v76, 1.0, v76
v_add_f32 v77, 1.0, v77
v_add_f32 v78, 1.0, v78
Mvaa 148,148,36
v_add_f32 v79, 1.0, v79
v_rcp_f32 v72, v72
Mvaa 152,152,36
buffer_load_dwordx4 v4, s[12:15], s50 offen offset:2048 lds
Mvaa 156,156,36
Ta 132,6,8192
Ta 134,6,10240
Mvaa 160,144,40
buffer_load_dwordx4 v4, s[12:15], s51 offen offset:3072 lds
Mvaa 164,148,40
s_add_u32 s4, s5, 30
s_and_b32 s4, s4, 3
s_or_b32 s4, s4, 28
s_lshl_b32 s4, s4, 16
v_add_u32 v4, s4, v123
Mvaa 168,152,40
v_rcp_f32 v73, v73
Mvaa 172,156,40
buffer_load_dwordx4 a[0:3], v2, s[8:11], s63 offen offset:0
Mvaa 176,144,44
Ta 136,7,8192
Ta 138,7,10240
Mvaa 180,148,44
buffer_load_dwordx4 a[4:7], v2, s[8:11], s63 offen offset:1024
Mvaa 184,152,44
v_rcp_f32 v74, v74
Mvaa 188,156,44
v_rcp_f32 v75, v75
Mvaa 192,144,48
buffer_load_dwordx4 a[8:11], v2, s[8:11], s63 offen offset:2048
Mvaa 196,148,48
Ta 140,8,8192
Ta 142,8,10240
Mvaa 200,152,48
buffer_load_dwordx4 a[12:15], v2, s[8:11], s63 offen offset:3072
Mvaa 204,156,48
v_rcp_f32 v76, v76
Mvaa 208,144,52
v_rcp_f32 v77, v77
Mvaa 212,148,52
buffer_load_dwordx4 a[16:19], v3, s[8:11], s63 offen offset:0
Mvaa 216,152,52
v_rcp_f32 v78, v78
Mvaa 220,156,52
buffer_load_dwordx4 a[20:23], v3, s[8:11], s63 offen offset:1024
Mvaa 224,144,56
v_rcp_f32 v79, v79
Vm 64,64,72
Mvaa 228,148,56
Vm 65,65,73
Vm 66,66,74
Vm 67,67,75
Mvaa 232,152,56
buffer_load_dwordx4 a[24:27], v3, s[8:11], s63 offen offset:2048
Mvaa 236,156,56
Vm 68,68,76
Vm 69,69,77
Vm 70,70,78
Mvaa 240,144,60
buffer_load_dwordx4 a[28:31], v3, s[8:11], s63 offen offset:3072
Mvaa 244,148,60
s_add_u32 s63, s5, 29
s_and_b32 s63, s63, 3
s_or_b32 s63, s63, 28
s_lshl_b32 s63, s63, 13
Mvaa 248,152,60
Vm 71,71,79
Vc 72,64,65
v_lshlrev_b32 v64, 16, v72
Mvaa 252,156,60
v_and_b32 v65, 0xffff0000, v72
Vc 73,66,67
v_lshlrev_b32 v66, 16, v73
s_waitcnt vmcnt(24) lgkmcnt(0)
Mvaa 128,128,64
s_add_u32 m0, s35, 8192
Mvaa 132,132,64
buffer_load_dwordx4 v4, s[12:15], s48 offen offset:0 lds
Mvaa 136,136,64
Ta 144,5,12288
Ta 146,5,14336
Mvaa 140,140,64
buffer_load_dwordx4 v4, s[12:15], s49 offen offset:1024 lds
Mvaa 144,128,68
v_and_b32 v67, 0xffff0000, v73
Vc 74,68,69
v_lshlrev_b32 v68, 16, v74
Mvaa 148,132,68
v_and_b32 v69, 0xffff0000, v74
Vc 75,70,71
v_lshlrev_b32 v70, 16, v75
Mvaa 152,136,68
buffer_load_dwordx4 v4, s[12:15], s50 offen offset:2048 lds
Mvaa 156,140,68
Ta 148,6,12288
Ta 150,6,14336
Mvaa 160,128,72
buffer_load_dwordx4 v4, s[12:15], s51 offen offset:3072 lds
Mvaa 164,132,72
s_add_u32 s4, s5, 31
s_and_b32 s4, s4, 3
s_or_b32 s4, s4, 28
s_lshl_b32 s4, s4, 16
v_add_u32 v4, s4, v123
Mvaa 168,136,72
v_and_b32 v71, 0xffff0000, v75
Mvaa 172,140,72
buffer_load_dwordx4 a[32:35], v2, s[8:11], s63 offen offset:0
Mvaa 176,128,76
Ta 152,7,12288
Ta 154,7,14336
Mvaa 180,132,76
buffer_load_dwordx4 a[36:39], v2, s[8:11], s63 offen offset:1024
Mvaa 184,136,76
s_lshr_b32 s3, s52, 7
s_lshr_b32 s62, s53, 7
s_cmp_eq_u32 s3, s33
s_cselect_b32 s44, 1, 0
s_cmp_eq_u32 s62, s33
s_cselect_b32 s44, 1, s44
s_lshl_b32 s45, s34, 4
Mvaa 188,140,76
v_lshlrev_b32 v15, 10, v14
v_lshl_add_u32 v15, v13, 5, v15
Mvaa 192,128,80
buffer_load_dwordx4 a[40:43], v2, s[8:11], s63 offen offset:2048
Mvaa 196,132,80
Ta 156,8,12288
Ta 158,8,14336
Mvaa 200,136,80
buffer_load_dwordx4 a[44:47], v2, s[8:11], s63 offen offset:3072
Mvaa 204,140,80
buffer_load_dword v102, v103, s[40:43], s45 offen sc1
s_waitcnt vmcnt(0)
Mvaa 208,128,84
v_readfirstlane_b32 s46, v102
s_lshl_b32 s47, s34, 13
s_add_u32 s47, s47, 5308416
s_cmp_ge_u32 s46, 16
s_cselect_b32 s46, s44, 0
s_cmp_lg_u32 s46, 0
s_cselect_b32 s3, s47, 0x7ff00000
Mvaa 212,132,84
buffer_load_dwordx4 a[48:51], v3, s[8:11], s63 offen offset:0
Mvaa 216,136,84
buffer_load_dwordx4 v[80:83], v15, s[16:19], s3 offen offset:0 sc1
Mvaa 220,140,84
buffer_load_dwordx4 a[52:55], v3, s[8:11], s63 offen offset:1024
Mvaa 224,128,88
buffer_load_dwordx4 v[84:87], v15, s[16:19], s3 offen offset:16 sc1
Mvaa 228,132,88
buffer_load_dwordx4 v[88:91], v15, s[16:19], s3 offen offset:256 sc1
Mvaa 232,136,88
buffer_load_dwordx4 a[56:59], v3, s[8:11], s63 offen offset:2048
Mvaa 236,140,88
buffer_load_dwordx4 v[92:95], v15, s[16:19], s3 offen offset:272 sc1
Mvaa 240,128,92
buffer_load_dwordx4 a[60:63], v3, s[8:11], s63 offen offset:3072
Mvaa 244,132,92
s_add_u32 s63, s5, 30
s_and_b32 s63, s63, 3
s_or_b32 s63, s63, 28
s_lshl_b32 s63, s63, 13
Mvaa 248,136,92
buffer_load_dwordx4 v[96:99], v15, s[16:19], s3 offen offset:512 sc1
Mvaa 252,140,92
buffer_load_dwordx4 v[100:103], v15, s[16:19], s3 offen offset:528 sc1
s_waitcnt lgkmcnt(0)
Mvaa 128,144,96
s_add_u32 m0, s35, 12288
Mvaa 132,148,96
buffer_load_dwordx4 v4, s[12:15], s48 offen offset:0 lds
Mvaa 136,152,96
Ta 128,5,0
Ta 130,5,2048
Mvaa 140,156,96
buffer_load_dwordx4 v4, s[12:15], s49 offen offset:1024 lds
Mvaa 144,144,100
buffer_load_dwordx4 v[104:107], v15, s[16:19], s3 offen offset:768 sc1
Mvaa 148,148,100
buffer_load_dwordx4 v[108:111], v15, s[16:19], s3 offen offset:784 sc1
Mvaa 152,152,100
buffer_load_dwordx4 v4, s[12:15], s50 offen offset:2048 lds
Mvaa 156,156,100
Ta 132,6,0
Ta 134,6,2048
Mvaa 160,144,104
buffer_load_dwordx4 v4, s[12:15], s51 offen offset:3072 lds
Mvaa 164,148,104
s_add_u32 s4, s5, 32
s_and_b32 s4, s4, 3
s_or_b32 s4, s4, 32
s_lshl_b32 s4, s4, 16
v_add_u32 v4, s4, v123
Mvaa 168,152,104
Mvaa 172,156,104
buffer_load_dwordx4 a[64:67], v2, s[8:11], s63 offen offset:0
Mvaa 176,144,108
Ta 136,7,0
Ta 138,7,2048
Mvaa 180,148,108
buffer_load_dwordx4 a[68:71], v2, s[8:11], s63 offen offset:1024
Mvaa 184,152,108
Mvaa 188,156,108
Mvaa 192,144,112
buffer_load_dwordx4 a[72:75], v2, s[8:11], s63 offen offset:2048
Mvaa 196,148,112
Ta 140,8,0
Ta 142,8,2048
Mvaa 200,152,112
buffer_load_dwordx4 a[76:79], v2, s[8:11], s63 offen offset:3072
Mvaa 204,156,112
Mvaa 208,144,116
Mvaa 212,148,116
buffer_load_dwordx4 a[80:83], v3, s[8:11], s63 offen offset:0
Mvaa 216,152,116
Mvaa 220,156,116
buffer_load_dwordx4 a[84:87], v3, s[8:11], s63 offen offset:1024
Mvaa 224,144,120
Mvaa 228,148,120
Mvaa 232,152,120
buffer_load_dwordx4 a[88:91], v3, s[8:11], s63 offen offset:2048
Mvaa 236,156,120
Mvaa 240,144,124
buffer_load_dwordx4 a[92:95], v3, s[8:11], s63 offen offset:3072
Mvaa 244,148,124
s_add_u32 s63, s5, 31
s_and_b32 s63, s63, 3
s_or_b32 s63, s63, 28
s_lshl_b32 s63, s63, 13
Mvaa 248,152,124
Mvaa 252,156,124
s_waitcnt lgkmcnt(0)
Mvaa 128,128,0
s_waitcnt vmcnt(10)
s_cmp_lg_u32 s46, 0
s_cbranch_scc1 L_k3_selA
L_k3_selAr:
Mvaa 132,132,0
buffer_load_dwordx4 a[96:99], v2, s[8:11], s63 offen offset:0
Mvaa 136,136,0
Ta 144,5,4096
Ta 146,5,6144
Mvaa 140,140,0
buffer_load_dwordx4 a[100:103], v2, s[8:11], s63 offen offset:1024
Mvaa 144,128,4
Mvaa 148,132,4
Mvaa 152,136,4
buffer_load_dwordx4 a[104:107], v2, s[8:11], s63 offen offset:2048
Mvaa 156,140,4
Ta 148,6,4096
Ta 150,6,6144
Mvaa 160,128,8
buffer_load_dwordx4 a[108:111], v2, s[8:11], s63 offen offset:3072
Mvaa 164,132,8
Mvaa 168,136,8
Mvaa 172,140,8
buffer_load_dwordx4 a[112:115], v3, s[8:11], s63 offen offset:0
Mvaa 176,128,12
Ta 152,7,4096
Ta 154,7,6144
Mvaa 180,132,12
buffer_load_dwordx4 a[116:119], v3, s[8:11], s63 offen offset:1024
Mvaa 184,136,12
Mvaa 188,140,12
Mvaa 192,128,16
buffer_load_dwordx4 a[120:123], v3, s[8:11], s63 offen offset:2048
Mvaa 196,132,16
Ta 156,8,4096
Ta 158,8,6144
Mvaa 200,136,16
buffer_load_dwordx4 a[124:127], v3, s[8:11], s63 offen offset:3072
Mvaa 204,140,16
s_add_u32 s63, s5, 32
s_and_b32 s63, s63, 3
s_or_b32 s63, s63, 32
s_lshl_b32 s63, s63, 13
Mvaa 208,128,20
Mvaa 212,132,20
Mvaa 216,136,20
Mvaa 220,140,20
Mvaa 224,128,24
Mvaa 228,132,24
Mvaa 232,136,24
Mvaa 236,140,24
Mvaa 240,128,28
Mvaa 244,132,28
Mvaa 248,136,28
Mvaa 252,140,28
s_waitcnt lgkmcnt(0)
Mvaa 128,144,32
Mvaa 132,148,32
Mvaa 136,152,32
Ta 128,5,8192
Ta 130,5,10240
Mvaa 140,156,32
Mvaa 144,144,36
Mvaa 148,148,36
Mvaa 152,152,36
Mvaa 156,156,36
Ta 132,6,8192
Ta 134,6,10240
Mvaa 160,144,40
Mvaa 164,148,40
Mvaa 168,152,40
Mvaa 172,156,40
Mvaa 176,144,44
Ta 136,7,8192
Ta 138,7,10240
Mvaa 180,148,44
Mvaa 184,152,44
Mvaa 188,156,44
Mvaa 192,144,48
Mvaa 196,148,48
Ta 140,8,8192
Ta 142,8,10240
Mvaa 200,152,48
Mvaa 204,156,48
Mvaa 208,144,52
Mvaa 212,148,52
Mvaa 216,152,52
Mvaa 220,156,52
Mvaa 224,144,56
Mvaa 228,148,56
Mvaa 232,152,56
Mvaa 236,156,56
Mvaa 240,144,60
Mvaa 244,148,60
Mvaa 248,152,60
Mvaa 252,156,60
s_waitcnt vmcnt(8) lgkmcnt(0)
Mvaa 128,128,64
Mvaa 132,132,64
Mvaa 136,136,64
Ta 144,5,12288
Ta 146,5,14336
Mvaa 140,140,64
Mvaa 144,128,68
Mvaa 148,132,68
Mvaa 152,136,68
Mvaa 156,140,68
Ta 148,6,12288
Ta 150,6,14336
Mvaa 160,128,72
Mvaa 164,132,72
Mvaa 168,136,72
Mvaa 172,140,72
Mvaa 176,128,76
Ta 152,7,12288
Ta 154,7,14336
Mvaa 180,132,76
Mvaa 184,136,76
Mvaa 188,140,76
Mvaa 192,128,80
Mvaa 196,132,80
Ta 156,8,12288
Ta 158,8,14336
Mvaa 200,136,80
Mvaa 204,140,80
Mvaa 208,128,84
Mvaa 212,132,84
Mvaa 216,136,84
Mvaa 220,140,84
Mvaa 224,128,88
Mvaa 228,132,88
Mvaa 232,136,88
Mvaa 236,140,88
Mvaa 240,128,92
Mvaa 244,132,92
Mvaa 248,136,92
Mvaa 252,140,92
s_waitcnt vmcnt(0) lgkmcnt(0)
Mvaa 128,144,96
Mvaa 132,148,96
Mvaa 136,152,96
Mvaa 140,156,96
Mvaa 144,144,100
Mvaa 148,148,100
Mvaa 152,152,100
Mvaa 156,156,100
Mvaa 160,144,104
Mvaa 164,148,104
Mvaa 168,152,104
Mvaa 172,156,104
Mvaa 176,144,108
Mvaa 180,148,108
Mvaa 184,152,108
Mvaa 188,156,108
Mvaa 192,144,112
Mvaa 196,148,112
Mvaa 200,152,112
Mvaa 204,156,112
Mvaa 208,144,116
Mvaa 212,148,116
Mvaa 216,152,116
Mvaa 220,156,116
Mvaa 224,144,120
Mvaa 228,148,120
Mvaa 232,152,120
Mvaa 236,156,120
Mvaa 240,144,124
Mvaa 244,148,124
Mvaa 248,152,124
Mvaa 252,156,124
s_waitcnt vmcnt(0) lgkmcnt(0)
v_and_b32 v1, 15, v0
v_lshlrev_b32 v11, 8, v1
v_add_u32 v11, s35, v11
v_xor_b32 v1, v1, v12
v_xor_b32 v15, 0, v1
v_lshl_add_u32 v5, v15, 4, v11
v_xor_b32 v15, 4, v1
v_lshl_add_u32 v6, v15, 4, v11
v_xor_b32 v15, 8, v1
v_lshl_add_u32 v7, v15, 4, v11
v_xor_b32 v15, 12, v1
v_lshl_add_u32 v8, v15, 4, v11
ds_write_b128 v5, v[128:131] offset:0
ds_write_b128 v6, v[132:135] offset:0
ds_write_b128 v7, v[136:139] offset:0
ds_write_b128 v8, v[140:143] offset:0
ds_write_b128 v5, v[144:147] offset:4096
ds_write_b128 v6, v[148:151] offset:4096
ds_write_b128 v7, v[152:155] offset:4096
ds_write_b128 v8, v[156:159] offset:4096
s_waitcnt lgkmcnt(4)
ds_write_b128 v5, v[160:163] offset:8192
ds_write_b128 v6, v[164:167] offset:8192
ds_write_b128 v7, v[168:171] offset:8192
ds_write_b128 v8, v[172:175] offset:8192
ds_write_b128 v5, v[176:179] offset:12288
ds_write_b128 v6, v[180:183] offset:12288
ds_write_b128 v7, v[184:187] offset:12288
ds_write_b128 v8, v[188:191] offset:12288
s_waitcnt lgkmcnt(4)
ds_write_b128 v5, v[192:195] offset:16384
ds_write_b128 v6, v[196:199] offset:16384
ds_write_b128 v7, v[200:203] offset:16384
ds_write_b128 v8, v[204:207] offset:16384
ds_write_b128 v5, v[208:211] offset:20480
ds_write_b128 v6, v[212:215] offset:20480
ds_write_b128 v7, v[216:219] offset:20480
ds_write_b128 v8, v[220:223] offset:20480
s_waitcnt lgkmcnt(4)
ds_write_b128 v5, v[224:227] offset:24576
ds_write_b128 v6, v[228:231] offset:24576
ds_write_b128 v7, v[232:235] offset:24576
ds_write_b128 v8, v[236:239] offset:24576
ds_write_b128 v5, v[240:243] offset:28672
ds_write_b128 v6, v[244:247] offset:28672
ds_write_b128 v7, v[248:251] offset:28672
ds_write_b128 v8, v[252:255] offset:28672
s_waitcnt lgkmcnt(4)
s_cmp_lg_u32 s44, s46
s_cbranch_scc1 L_k3_sel
L_k3_selr:
v_and_b32 v1, 15, v10
v_lshlrev_b32 v15, 1, v13
v_xor_b32 v1, v1, v15
v_lshlrev_b32 v11, 8, v10
v_lshl_add_u32 v2, v1, 4, v11
v_xor_b32 v3, 16, v2
v_add_u32 v4, 65536, v2
v_add_u32 v5, 65536, v3
s_waitcnt lgkmcnt(0)
s_barrier
Rv 128,2,0
Rv 132,3,0
Rv 136,2,32768
Rv 140,3,32768
Rv 144,4,0
Rv 148,5,0
Rv 152,4,32768
Rv 156,5,32768
s_waitcnt lgkmcnt(0)
Rv 160,2,8192
Rv 164,3,8192
Rv 168,2,40960
Rv 172,3,40960
Rv 176,4,8192
Rv 180,5,8192
Rv 184,4,40960
Rv 188,5,40960
Va 128,128,136
Va 144,144,152
Va 129,129,137
Va 145,145,153
Va 130,130,138
Va 146,146,154
Va 131,131,139
Va 147,147,155
Va 132,132,140
Va 148,148,156
Va 133,133,141
Va 149,149,157
Va 134,134,142
Va 150,150,158
Va 135,135,143
Va 151,151,159
Va 128,128,144
Va 129,129,145
Va 130,130,146
Va 131,131,147
Va 132,132,148
Va 133,133,149
Va 134,134,150
Va 135,135,151
Vc 136,128,129
v_lshlrev_b32 v128, 16, v136
v_and_b32 v129, 0xffff0000, v136
Vc 137,130,131
v_lshlrev_b32 v130, 16, v137
v_and_b32 v131, 0xffff0000, v137
Vc 138,132,133
v_lshlrev_b32 v132, 16, v138
v_and_b32 v133, 0xffff0000, v138
Vc 139,134,135
v_lshlrev_b32 v134, 16, v139
v_and_b32 v135, 0xffff0000, v139
Vm 128,128,40
Vm 129,129,41
Vm 130,130,42
Vm 131,131,43
Vm 132,132,44
Vm 133,133,45
Vm 134,134,46
Vm 135,135,47
Vc 136,128,129
v_lshlrev_b32 v128, 16, v136
v_and_b32 v129, 0xffff0000, v136
Vc 137,130,131
v_lshlrev_b32 v130, 16, v137
v_and_b32 v131, 0xffff0000, v137
Vc 138,132,133
v_lshlrev_b32 v132, 16, v138
v_and_b32 v133, 0xffff0000, v138
Vc 139,134,135
v_lshlrev_b32 v134, 16, v139
v_and_b32 v135, 0xffff0000, v139
v_lshlrev_b32 v144, 16, v16
v_and_b32 v145, 0xffff0000, v16
v_lshlrev_b32 v146, 16, v17
v_and_b32 v147, 0xffff0000, v17
v_lshlrev_b32 v148, 16, v18
v_and_b32 v149, 0xffff0000, v18
v_lshlrev_b32 v150, 16, v19
v_and_b32 v151, 0xffff0000, v19
Va 128,128,144
Va 129,129,145
Va 130,130,146
Va 131,131,147
Va 132,132,148
Va 133,133,149
Va 134,134,150
Va 135,135,151
Vc 136,128,129
Vc 137,130,131
Vc 138,132,133
Vc 139,134,135
buffer_store_dwordx4 v[136:139], v9, s[28:31], s36 offen
s_add_u32 s36, s36, 65536
s_waitcnt lgkmcnt(0)
Rv 192,2,16384
Rv 196,3,16384
Rv 200,2,49152
Rv 204,3,49152
Rv 208,4,16384
Rv 212,5,16384
Rv 216,4,49152
Rv 220,5,49152
Va 160,160,168
Va 176,176,184
Va 161,161,169
Va 177,177,185
Va 162,162,170
Va 178,178,186
Va 163,163,171
Va 179,179,187
Va 164,164,172
Va 180,180,188
Va 165,165,173
Va 181,181,189
Va 166,166,174
Va 182,182,190
Va 167,167,175
Va 183,183,191
Va 160,160,176
Va 161,161,177
Va 162,162,178
Va 163,163,179
Va 164,164,180
Va 165,165,181
Va 166,166,182
Va 167,167,183
Vc 168,160,161
v_lshlrev_b32 v160, 16, v168
v_and_b32 v161, 0xffff0000, v168
Vc 169,162,163
v_lshlrev_b32 v162, 16, v169
v_and_b32 v163, 0xffff0000, v169
Vc 170,164,165
v_lshlrev_b32 v164, 16, v170
v_and_b32 v165, 0xffff0000, v170
Vc 171,166,167
v_lshlrev_b32 v166, 16, v171
v_and_b32 v167, 0xffff0000, v171
Vm 160,160,48
Vm 161,161,49
Vm 162,162,50
Vm 163,163,51
Vm 164,164,52
Vm 165,165,53
Vm 166,166,54
Vm 167,167,55
Vc 168,160,161
v_lshlrev_b32 v160, 16, v168
v_and_b32 v161, 0xffff0000, v168
Vc 169,162,163
v_lshlrev_b32 v162, 16, v169
v_and_b32 v163, 0xffff0000, v169
Vc 170,164,165
v_lshlrev_b32 v164, 16, v170
v_and_b32 v165, 0xffff0000, v170
Vc 171,166,167
v_lshlrev_b32 v166, 16, v171
v_and_b32 v167, 0xffff0000, v171
v_lshlrev_b32 v176, 16, v20
v_and_b32 v177, 0xffff0000, v20
v_lshlrev_b32 v178, 16, v21
v_and_b32 v179, 0xffff0000, v21
v_lshlrev_b32 v180, 16, v22
v_and_b32 v181, 0xffff0000, v22
v_lshlrev_b32 v182, 16, v23
v_and_b32 v183, 0xffff0000, v23
Va 160,160,176
Va 161,161,177
Va 162,162,178
Va 163,163,179
Va 164,164,180
Va 165,165,181
Va 166,166,182
Va 167,167,183
Vc 168,160,161
Vc 169,162,163
Vc 170,164,165
Vc 171,166,167
buffer_store_dwordx4 v[168:171], v9, s[28:31], s36 offen
s_add_u32 s36, s36, 65536
s_waitcnt lgkmcnt(0)
Rv 224,2,24576
Rv 228,3,24576
Rv 232,2,57344
Rv 236,3,57344
Rv 240,4,24576
Rv 244,5,24576
Rv 248,4,57344
Rv 252,5,57344
Va 192,192,200
Va 208,208,216
Va 193,193,201
Va 209,209,217
Va 194,194,202
Va 210,210,218
Va 195,195,203
Va 211,211,219
Va 196,196,204
Va 212,212,220
Va 197,197,205
Va 213,213,221
Va 198,198,206
Va 214,214,222
Va 199,199,207
Va 215,215,223
Va 192,192,208
Va 193,193,209
Va 194,194,210
Va 195,195,211
Va 196,196,212
Va 197,197,213
Va 198,198,214
Va 199,199,215
Vc 200,192,193
v_lshlrev_b32 v192, 16, v200
v_and_b32 v193, 0xffff0000, v200
Vc 201,194,195
v_lshlrev_b32 v194, 16, v201
v_and_b32 v195, 0xffff0000, v201
Vc 202,196,197
v_lshlrev_b32 v196, 16, v202
v_and_b32 v197, 0xffff0000, v202
Vc 203,198,199
v_lshlrev_b32 v198, 16, v203
v_and_b32 v199, 0xffff0000, v203
Vm 192,192,56
Vm 193,193,57
Vm 194,194,58
Vm 195,195,59
Vm 196,196,60
Vm 197,197,61
Vm 198,198,62
Vm 199,199,63
Vc 200,192,193
v_lshlrev_b32 v192, 16, v200
v_and_b32 v193, 0xffff0000, v200
Vc 201,194,195
v_lshlrev_b32 v194, 16, v201
v_and_b32 v195, 0xffff0000, v201
Vc 202,196,197
v_lshlrev_b32 v196, 16, v202
v_and_b32 v197, 0xffff0000, v202
Vc 203,198,199
v_lshlrev_b32 v198, 16, v203
v_and_b32 v199, 0xffff0000, v203
v_lshlrev_b32 v208, 16, v24
v_and_b32 v209, 0xffff0000, v24
v_lshlrev_b32 v210, 16, v25
v_and_b32 v211, 0xffff0000, v25
v_lshlrev_b32 v212, 16, v26
v_and_b32 v213, 0xffff0000, v26
v_lshlrev_b32 v214, 16, v27
v_and_b32 v215, 0xffff0000, v27
Va 192,192,208
Va 193,193,209
Va 194,194,210
Va 195,195,211
Va 196,196,212
Va 197,197,213
Va 198,198,214
Va 199,199,215
Vc 200,192,193
Vc 201,194,195
Vc 202,196,197
Vc 203,198,199
buffer_store_dwordx4 v[200:203], v9, s[28:31], s36 offen
s_add_u32 s36, s36, 65536
s_waitcnt lgkmcnt(0)
Va 224,224,232
Va 240,240,248
Va 225,225,233
Va 241,241,249
Va 226,226,234
Va 242,242,250
Va 227,227,235
Va 243,243,251
Va 228,228,236
Va 244,244,252
Va 229,229,237
Va 245,245,253
Va 230,230,238
Va 246,246,254
Va 231,231,239
Va 247,247,255
Va 224,224,240
Va 225,225,241
Va 226,226,242
Va 227,227,243
Va 228,228,244
Va 229,229,245
Va 230,230,246
Va 231,231,247
Vc 232,224,225
v_lshlrev_b32 v224, 16, v232
v_and_b32 v225, 0xffff0000, v232
Vc 233,226,227
v_lshlrev_b32 v226, 16, v233
v_and_b32 v227, 0xffff0000, v233
Vc 234,228,229
v_lshlrev_b32 v228, 16, v234
v_and_b32 v229, 0xffff0000, v234
Vc 235,230,231
v_lshlrev_b32 v230, 16, v235
v_and_b32 v231, 0xffff0000, v235
Vm 224,224,64
Vm 225,225,65
Vm 226,226,66
Vm 227,227,67
Vm 228,228,68
Vm 229,229,69
Vm 230,230,70
Vm 231,231,71
Vc 232,224,225
v_lshlrev_b32 v224, 16, v232
v_and_b32 v225, 0xffff0000, v232
Vc 233,226,227
v_lshlrev_b32 v226, 16, v233
v_and_b32 v227, 0xffff0000, v233
Vc 234,228,229
v_lshlrev_b32 v228, 16, v234
v_and_b32 v229, 0xffff0000, v234
Vc 235,230,231
v_lshlrev_b32 v230, 16, v235
v_and_b32 v231, 0xffff0000, v235
v_lshlrev_b32 v240, 16, v28
v_and_b32 v241, 0xffff0000, v28
v_lshlrev_b32 v242, 16, v29
v_and_b32 v243, 0xffff0000, v29
v_lshlrev_b32 v244, 16, v30
v_and_b32 v245, 0xffff0000, v30
v_lshlrev_b32 v246, 16, v31
v_and_b32 v247, 0xffff0000, v31
Va 224,224,240
Va 225,225,241
Va 226,226,242
Va 227,227,243
Va 228,228,244
Va 229,229,245
Va 230,230,246
Va 231,231,247
Vc 232,224,225
Vc 233,226,227
Vc 234,228,229
Vc 235,230,231
buffer_store_dwordx4 v[232:235], v9, s[28:31], s36 offen
L_k3_end:
s_endpgm
L_k3_selA:
Va 80,80,96
Va 81,81,97
Va 82,82,98
Va 83,83,99
Va 84,84,100
Va 85,85,101
Va 86,86,102
Va 87,87,103
Va 88,88,104
Va 89,89,105
Va 90,90,106
Va 91,91,107
Va 92,92,108
Va 93,93,109
Va 94,94,110
Va 95,95,111
v_add_f32_dpp v80, v80, v80 row_ror:8 row_mask:0xf bank_mask:0xf
v_add_f32_dpp v81, v81, v81 row_ror:8 row_mask:0xf bank_mask:0xf
v_add_f32_dpp v82, v82, v82 row_ror:8 row_mask:0xf bank_mask:0xf
v_add_f32_dpp v83, v83, v83 row_ror:8 row_mask:0xf bank_mask:0xf
v_add_f32_dpp v84, v84, v84 row_ror:8 row_mask:0xf bank_mask:0xf
v_add_f32_dpp v85, v85, v85 row_ror:8 row_mask:0xf bank_mask:0xf
v_add_f32_dpp v86, v86, v86 row_ror:8 row_mask:0xf bank_mask:0xf
v_add_f32_dpp v87, v87, v87 row_ror:8 row_mask:0xf bank_mask:0xf
v_add_f32_dpp v88, v88, v88 row_ror:8 row_mask:0xf bank_mask:0xf
v_add_f32_dpp v89, v89, v89 row_ror:8 row_mask:0xf bank_mask:0xf
v_add_f32_dpp v90, v90, v90 row_ror:8 row_mask:0xf bank_mask:0xf
v_add_f32_dpp v91, v91, v91 row_ror:8 row_mask:0xf bank_mask:0xf
v_add_f32_dpp v92, v92, v92 row_ror:8 row_mask:0xf bank_mask:0xf
v_add_f32_dpp v93, v93, v93 row_ror:8 row_mask:0xf bank_mask:0xf
v_add_f32_dpp v94, v94, v94 row_ror:8 row_mask:0xf bank_mask:0xf
v_add_f32_dpp v95, v95, v95 row_ror:8 row_mask:0xf bank_mask:0xf
v_mov_b32 v96, v80
v_mov_b32 v97, v81
v_mov_b32 v98, v82
v_mov_b32 v99, v83
v_mov_b32 v100, v84
v_mov_b32 v101, v85
v_mov_b32 v102, v86
v_mov_b32 v103, v87
v_mov_b32 v104, v88
v_mov_b32 v105, v89
v_mov_b32 v106, v90
v_mov_b32 v107, v91
v_mov_b32 v108, v92
v_mov_b32 v109, v93
v_mov_b32 v110, v94
v_mov_b32 v111, v95
v_permlane16_swap_b32 v96, v80
v_permlane16_swap_b32 v97, v81
v_permlane16_swap_b32 v98, v82
v_permlane16_swap_b32 v99, v83
v_permlane16_swap_b32 v100, v84
v_permlane16_swap_b32 v101, v85
v_permlane16_swap_b32 v102, v86
v_permlane16_swap_b32 v103, v87
v_permlane16_swap_b32 v104, v88
v_permlane16_swap_b32 v105, v89
v_permlane16_swap_b32 v106, v90
v_permlane16_swap_b32 v107, v91
v_permlane16_swap_b32 v108, v92
v_permlane16_swap_b32 v109, v93
v_permlane16_swap_b32 v110, v94
v_permlane16_swap_b32 v111, v95
Va 80,80,96
Va 81,81,97
Va 82,82,98
Va 83,83,99
Va 84,84,100
Va 85,85,101
Va 86,86,102
Va 87,87,103
Va 88,88,104
Va 89,89,105
Va 90,90,106
Va 91,91,107
Va 92,92,108
Va 93,93,109
Va 94,94,110
Va 95,95,111
v_mov_b32 v96, v80
v_mov_b32 v97, v81
v_mov_b32 v98, v82
v_mov_b32 v99, v83
v_mov_b32 v100, v84
v_mov_b32 v101, v85
v_mov_b32 v102, v86
v_mov_b32 v103, v87
v_mov_b32 v104, v88
v_mov_b32 v105, v89
v_mov_b32 v106, v90
v_mov_b32 v107, v91
v_mov_b32 v108, v92
v_mov_b32 v109, v93
v_mov_b32 v110, v94
v_mov_b32 v111, v95
v_permlane32_swap_b32 v96, v80
v_permlane32_swap_b32 v97, v81
v_permlane32_swap_b32 v98, v82
v_permlane32_swap_b32 v99, v83
v_permlane32_swap_b32 v100, v84
v_permlane32_swap_b32 v101, v85
v_permlane32_swap_b32 v102, v86
v_permlane32_swap_b32 v103, v87
v_permlane32_swap_b32 v104, v88
v_permlane32_swap_b32 v105, v89
v_permlane32_swap_b32 v106, v90
v_permlane32_swap_b32 v107, v91
v_permlane32_swap_b32 v108, v92
v_permlane32_swap_b32 v109, v93
v_permlane32_swap_b32 v110, v94
v_permlane32_swap_b32 v111, v95
Va 80,80,96
Va 81,81,97
Va 82,82,98
Va 83,83,99
Va 84,84,100
Va 85,85,101
Va 86,86,102
Va 87,87,103
Va 88,88,104
Va 89,89,105
Va 90,90,106
Va 91,91,107
Va 92,92,108
Va 93,93,109
Va 94,94,110
Va 95,95,111
Vc 1,80,81
v_lshlrev_b32 v80, 16, v1
v_and_b32 v81, 0xffff0000, v1
Vc 1,82,83
v_lshlrev_b32 v82, 16, v1
v_and_b32 v83, 0xffff0000, v1
Vc 1,84,85
v_lshlrev_b32 v84, 16, v1
v_and_b32 v85, 0xffff0000, v1
Vc 1,86,87
v_lshlrev_b32 v86, 16, v1
v_and_b32 v87, 0xffff0000, v1
Vc 1,88,89
v_lshlrev_b32 v88, 16, v1
v_and_b32 v89, 0xffff0000, v1
Vc 1,90,91
v_lshlrev_b32 v90, 16, v1
v_and_b32 v91, 0xffff0000, v1
Vc 1,92,93
v_lshlrev_b32 v92, 16, v1
v_and_b32 v93, 0xffff0000, v1
Vc 1,94,95
v_lshlrev_b32 v94, 16, v1
v_and_b32 v95, 0xffff0000, v1
v_mul_f32 v80, s54, v80
v_mul_f32 v81, s54, v81
v_mul_f32 v82, s54, v82
v_mul_f32 v83, s54, v83
v_mul_f32 v84, s54, v84
v_mul_f32 v85, s54, v85
v_mul_f32 v86, s54, v86
v_mul_f32 v87, s54, v87
v_mul_f32 v88, s55, v88
v_mul_f32 v89, s55, v89
v_mul_f32 v90, s55, v90
v_mul_f32 v91, s55, v91
v_mul_f32 v92, s55, v92
v_mul_f32 v93, s55, v93
v_mul_f32 v94, s55, v94
v_mul_f32 v95, s55, v95
Vc 1,80,81
v_lshlrev_b32 v80, 16, v1
v_and_b32 v81, 0xffff0000, v1
Vc 1,82,83
v_lshlrev_b32 v82, 16, v1
v_and_b32 v83, 0xffff0000, v1
Vc 1,84,85
v_lshlrev_b32 v84, 16, v1
v_and_b32 v85, 0xffff0000, v1
Vc 1,86,87
v_lshlrev_b32 v86, 16, v1
v_and_b32 v87, 0xffff0000, v1
Vc 1,88,89
v_lshlrev_b32 v88, 16, v1
v_and_b32 v89, 0xffff0000, v1
Vc 1,90,91
v_lshlrev_b32 v90, 16, v1
v_and_b32 v91, 0xffff0000, v1
Vc 1,92,93
v_lshlrev_b32 v92, 16, v1
v_and_b32 v93, 0xffff0000, v1
Vc 1,94,95
v_lshlrev_b32 v94, 16, v1
v_and_b32 v95, 0xffff0000, v1
s_lshl_b32 s3, s33, 7
s_sub_u32 s52, s52, s3
s_sub_u32 s53, s53, s3
v_add_u32 v1, 0, v10
v_cmp_eq_u32 vcc, s52, v1
v_cmp_eq_u32 s[60:61], s53, v1
s_nop 3
s_or_b64 s[56:57], vcc, s[60:61]
s_cbranch_scc0 L_oproj_kernel_selskip1
v_cndmask_b32 v96, 0, v80, vcc
v_cndmask_b32 v96, v96, v88, s[60:61]
v_cndmask_b32 v97, 0, v81, vcc
v_cndmask_b32 v97, v97, v89, s[60:61]
v_cndmask_b32 v98, 0, v82, vcc
v_cndmask_b32 v98, v98, v90, s[60:61]
v_cndmask_b32 v99, 0, v83, vcc
v_cndmask_b32 v99, v99, v91, s[60:61]
v_cndmask_b32 v100, 0, v84, vcc
v_cndmask_b32 v100, v100, v92, s[60:61]
v_cndmask_b32 v101, 0, v85, vcc
v_cndmask_b32 v101, v101, v93, s[60:61]
v_cndmask_b32 v102, 0, v86, vcc
v_cndmask_b32 v102, v102, v94, s[60:61]
v_cndmask_b32 v103, 0, v87, vcc
v_cndmask_b32 v103, v103, v95, s[60:61]
v_lshlrev_b32 v40, 16, v16
v_and_b32 v41, 0xffff0000, v16
v_lshlrev_b32 v42, 16, v17
v_and_b32 v43, 0xffff0000, v17
v_lshlrev_b32 v44, 16, v18
v_and_b32 v45, 0xffff0000, v18
v_lshlrev_b32 v46, 16, v19
v_and_b32 v47, 0xffff0000, v19
Vs 40,40,32
Vs 41,41,32
Vs 42,42,32
Vs 43,43,32
Vs 44,44,32
Vs 45,45,32
Vs 46,46,32
Vs 47,47,32
Vc 72,40,41
v_lshlrev_b32 v40, 16, v72
v_and_b32 v41, 0xffff0000, v72
Vc 73,42,43
v_lshlrev_b32 v42, 16, v73
v_and_b32 v43, 0xffff0000, v73
Vc 74,44,45
v_lshlrev_b32 v44, 16, v74
v_and_b32 v45, 0xffff0000, v74
Vc 75,46,47
v_lshlrev_b32 v46, 16, v75
v_and_b32 v47, 0xffff0000, v75
Vm 40,40,33
Vm 41,41,33
Vm 42,42,33
Vm 43,43,33
Vm 44,44,33
Vm 45,45,33
Vm 46,46,33
Vm 47,47,33
Vc 72,40,41
v_lshlrev_b32 v40, 16, v72
v_and_b32 v41, 0xffff0000, v72
Vc 73,42,43
v_lshlrev_b32 v42, 16, v73
v_and_b32 v43, 0xffff0000, v73
Vc 74,44,45
v_lshlrev_b32 v44, 16, v74
v_and_b32 v45, 0xffff0000, v74
Vc 75,46,47
v_lshlrev_b32 v46, 16, v75
v_and_b32 v47, 0xffff0000, v75
Va 40,40,96
Va 41,41,97
Va 42,42,98
Va 43,43,99
Va 44,44,100
Va 45,45,101
Va 46,46,102
Va 47,47,103
Vc 72,40,41
v_lshlrev_b32 v40, 16, v72
v_and_b32 v41, 0xffff0000, v72
Vc 73,42,43
v_lshlrev_b32 v42, 16, v73
v_and_b32 v43, 0xffff0000, v73
Vc 74,44,45
v_lshlrev_b32 v44, 16, v74
v_and_b32 v45, 0xffff0000, v74
Vc 75,46,47
v_lshlrev_b32 v46, 16, v75
v_and_b32 v47, 0xffff0000, v75
v_mul_f32 v72, 0xbfb8aa3b, v40
v_mul_f32 v73, 0xbfb8aa3b, v41
v_mul_f32 v74, 0xbfb8aa3b, v42
v_mul_f32 v75, 0xbfb8aa3b, v43
v_mul_f32 v76, 0xbfb8aa3b, v44
v_mul_f32 v77, 0xbfb8aa3b, v45
v_mul_f32 v78, 0xbfb8aa3b, v46
v_mul_f32 v79, 0xbfb8aa3b, v47
Ve 72,72
Ve 73,73
Ve 74,74
Ve 75,75
Ve 76,76
Ve 77,77
Ve 78,78
Ve 79,79
v_add_f32 v72, 1.0, v72
v_add_f32 v73, 1.0, v73
v_add_f32 v74, 1.0, v74
v_add_f32 v75, 1.0, v75
v_add_f32 v76, 1.0, v76
v_add_f32 v77, 1.0, v77
v_add_f32 v78, 1.0, v78
v_add_f32 v79, 1.0, v79
v_rcp_f32 v72, v72
v_rcp_f32 v73, v73
v_rcp_f32 v74, v74
v_rcp_f32 v75, v75
v_rcp_f32 v76, v76
v_rcp_f32 v77, v77
v_rcp_f32 v78, v78
v_rcp_f32 v79, v79
Vm 40,40,72
Vm 41,41,73
Vm 42,42,74
Vm 43,43,75
Vm 44,44,76
Vm 45,45,77
Vm 46,46,78
Vm 47,47,79
Vc 72,40,41
v_lshlrev_b32 v40, 16, v72
v_and_b32 v41, 0xffff0000, v72
Vc 73,42,43
v_lshlrev_b32 v42, 16, v73
v_and_b32 v43, 0xffff0000, v73
Vc 74,44,45
v_lshlrev_b32 v44, 16, v74
v_and_b32 v45, 0xffff0000, v74
Vc 75,46,47
v_lshlrev_b32 v46, 16, v75
v_and_b32 v47, 0xffff0000, v75
L_oproj_kernel_selskip1:
v_add_u32 v1, 32, v10
v_cmp_eq_u32 vcc, s52, v1
v_cmp_eq_u32 s[60:61], s53, v1
s_nop 3
s_or_b64 s[56:57], vcc, s[60:61]
s_cbranch_scc0 L_oproj_kernel_selskip2
v_cndmask_b32 v96, 0, v80, vcc
v_cndmask_b32 v96, v96, v88, s[60:61]
v_cndmask_b32 v97, 0, v81, vcc
v_cndmask_b32 v97, v97, v89, s[60:61]
v_cndmask_b32 v98, 0, v82, vcc
v_cndmask_b32 v98, v98, v90, s[60:61]
v_cndmask_b32 v99, 0, v83, vcc
v_cndmask_b32 v99, v99, v91, s[60:61]
v_cndmask_b32 v100, 0, v84, vcc
v_cndmask_b32 v100, v100, v92, s[60:61]
v_cndmask_b32 v101, 0, v85, vcc
v_cndmask_b32 v101, v101, v93, s[60:61]
v_cndmask_b32 v102, 0, v86, vcc
v_cndmask_b32 v102, v102, v94, s[60:61]
v_cndmask_b32 v103, 0, v87, vcc
v_cndmask_b32 v103, v103, v95, s[60:61]
v_lshlrev_b32 v48, 16, v20
v_and_b32 v49, 0xffff0000, v20
v_lshlrev_b32 v50, 16, v21
v_and_b32 v51, 0xffff0000, v21
v_lshlrev_b32 v52, 16, v22
v_and_b32 v53, 0xffff0000, v22
v_lshlrev_b32 v54, 16, v23
v_and_b32 v55, 0xffff0000, v23
Vs 48,48,34
Vs 49,49,34
Vs 50,50,34
Vs 51,51,34
Vs 52,52,34
Vs 53,53,34
Vs 54,54,34
Vs 55,55,34
Vc 72,48,49
v_lshlrev_b32 v48, 16, v72
v_and_b32 v49, 0xffff0000, v72
Vc 73,50,51
v_lshlrev_b32 v50, 16, v73
v_and_b32 v51, 0xffff0000, v73
Vc 74,52,53
v_lshlrev_b32 v52, 16, v74
v_and_b32 v53, 0xffff0000, v74
Vc 75,54,55
v_lshlrev_b32 v54, 16, v75
v_and_b32 v55, 0xffff0000, v75
Vm 48,48,35
Vm 49,49,35
Vm 50,50,35
Vm 51,51,35
Vm 52,52,35
Vm 53,53,35
Vm 54,54,35
Vm 55,55,35
Vc 72,48,49
v_lshlrev_b32 v48, 16, v72
v_and_b32 v49, 0xffff0000, v72
Vc 73,50,51
v_lshlrev_b32 v50, 16, v73
v_and_b32 v51, 0xffff0000, v73
Vc 74,52,53
v_lshlrev_b32 v52, 16, v74
v_and_b32 v53, 0xffff0000, v74
Vc 75,54,55
v_lshlrev_b32 v54, 16, v75
v_and_b32 v55, 0xffff0000, v75
Va 48,48,96
Va 49,49,97
Va 50,50,98
Va 51,51,99
Va 52,52,100
Va 53,53,101
Va 54,54,102
Va 55,55,103
Vc 72,48,49
v_lshlrev_b32 v48, 16, v72
v_and_b32 v49, 0xffff0000, v72
Vc 73,50,51
v_lshlrev_b32 v50, 16, v73
v_and_b32 v51, 0xffff0000, v73
Vc 74,52,53
v_lshlrev_b32 v52, 16, v74
v_and_b32 v53, 0xffff0000, v74
Vc 75,54,55
v_lshlrev_b32 v54, 16, v75
v_and_b32 v55, 0xffff0000, v75
v_mul_f32 v72, 0xbfb8aa3b, v48
v_mul_f32 v73, 0xbfb8aa3b, v49
v_mul_f32 v74, 0xbfb8aa3b, v50
v_mul_f32 v75, 0xbfb8aa3b, v51
v_mul_f32 v76, 0xbfb8aa3b, v52
v_mul_f32 v77, 0xbfb8aa3b, v53
v_mul_f32 v78, 0xbfb8aa3b, v54
v_mul_f32 v79, 0xbfb8aa3b, v55
Ve 72,72
Ve 73,73
Ve 74,74
Ve 75,75
Ve 76,76
Ve 77,77
Ve 78,78
Ve 79,79
v_add_f32 v72, 1.0, v72
v_add_f32 v73, 1.0, v73
v_add_f32 v74, 1.0, v74
v_add_f32 v75, 1.0, v75
v_add_f32 v76, 1.0, v76
v_add_f32 v77, 1.0, v77
v_add_f32 v78, 1.0, v78
v_add_f32 v79, 1.0, v79
v_rcp_f32 v72, v72
v_rcp_f32 v73, v73
v_rcp_f32 v74, v74
v_rcp_f32 v75, v75
v_rcp_f32 v76, v76
v_rcp_f32 v77, v77
v_rcp_f32 v78, v78
v_rcp_f32 v79, v79
Vm 48,48,72
Vm 49,49,73
Vm 50,50,74
Vm 51,51,75
Vm 52,52,76
Vm 53,53,77
Vm 54,54,78
Vm 55,55,79
Vc 72,48,49
v_lshlrev_b32 v48, 16, v72
v_and_b32 v49, 0xffff0000, v72
Vc 73,50,51
v_lshlrev_b32 v50, 16, v73
v_and_b32 v51, 0xffff0000, v73
Vc 74,52,53
v_lshlrev_b32 v52, 16, v74
v_and_b32 v53, 0xffff0000, v74
Vc 75,54,55
v_lshlrev_b32 v54, 16, v75
v_and_b32 v55, 0xffff0000, v75
L_oproj_kernel_selskip2:
v_add_u32 v1, 64, v10
v_cmp_eq_u32 vcc, s52, v1
v_cmp_eq_u32 s[60:61], s53, v1
s_nop 3
s_or_b64 s[56:57], vcc, s[60:61]
s_cbranch_scc0 L_oproj_kernel_selskip3
v_cndmask_b32 v96, 0, v80, vcc
v_cndmask_b32 v96, v96, v88, s[60:61]
v_cndmask_b32 v97, 0, v81, vcc
v_cndmask_b32 v97, v97, v89, s[60:61]
v_cndmask_b32 v98, 0, v82, vcc
v_cndmask_b32 v98, v98, v90, s[60:61]
v_cndmask_b32 v99, 0, v83, vcc
v_cndmask_b32 v99, v99, v91, s[60:61]
v_cndmask_b32 v100, 0, v84, vcc
v_cndmask_b32 v100, v100, v92, s[60:61]
v_cndmask_b32 v101, 0, v85, vcc
v_cndmask_b32 v101, v101, v93, s[60:61]
v_cndmask_b32 v102, 0, v86, vcc
v_cndmask_b32 v102, v102, v94, s[60:61]
v_cndmask_b32 v103, 0, v87, vcc
v_cndmask_b32 v103, v103, v95, s[60:61]
v_lshlrev_b32 v56, 16, v24
v_and_b32 v57, 0xffff0000, v24
v_lshlrev_b32 v58, 16, v25
v_and_b32 v59, 0xffff0000, v25
v_lshlrev_b32 v60, 16, v26
v_and_b32 v61, 0xffff0000, v26
v_lshlrev_b32 v62, 16, v27
v_and_b32 v63, 0xffff0000, v27
Vs 56,56,36
Vs 57,57,36
Vs 58,58,36
Vs 59,59,36
Vs 60,60,36
Vs 61,61,36
Vs 62,62,36
Vs 63,63,36
Vc 72,56,57
v_lshlrev_b32 v56, 16, v72
v_and_b32 v57, 0xffff0000, v72
Vc 73,58,59
v_lshlrev_b32 v58, 16, v73
v_and_b32 v59, 0xffff0000, v73
Vc 74,60,61
v_lshlrev_b32 v60, 16, v74
v_and_b32 v61, 0xffff0000, v74
Vc 75,62,63
v_lshlrev_b32 v62, 16, v75
v_and_b32 v63, 0xffff0000, v75
Vm 56,56,37
Vm 57,57,37
Vm 58,58,37
Vm 59,59,37
Vm 60,60,37
Vm 61,61,37
Vm 62,62,37
Vm 63,63,37
Vc 72,56,57
v_lshlrev_b32 v56, 16, v72
v_and_b32 v57, 0xffff0000, v72
Vc 73,58,59
v_lshlrev_b32 v58, 16, v73
v_and_b32 v59, 0xffff0000, v73
Vc 74,60,61
v_lshlrev_b32 v60, 16, v74
v_and_b32 v61, 0xffff0000, v74
Vc 75,62,63
v_lshlrev_b32 v62, 16, v75
v_and_b32 v63, 0xffff0000, v75
Va 56,56,96
Va 57,57,97
Va 58,58,98
Va 59,59,99
Va 60,60,100
Va 61,61,101
Va 62,62,102
Va 63,63,103
Vc 72,56,57
v_lshlrev_b32 v56, 16, v72
v_and_b32 v57, 0xffff0000, v72
Vc 73,58,59
v_lshlrev_b32 v58, 16, v73
v_and_b32 v59, 0xffff0000, v73
Vc 74,60,61
v_lshlrev_b32 v60, 16, v74
v_and_b32 v61, 0xffff0000, v74
Vc 75,62,63
v_lshlrev_b32 v62, 16, v75
v_and_b32 v63, 0xffff0000, v75
v_mul_f32 v72, 0xbfb8aa3b, v56
v_mul_f32 v73, 0xbfb8aa3b, v57
v_mul_f32 v74, 0xbfb8aa3b, v58
v_mul_f32 v75, 0xbfb8aa3b, v59
v_mul_f32 v76, 0xbfb8aa3b, v60
v_mul_f32 v77, 0xbfb8aa3b, v61
v_mul_f32 v78, 0xbfb8aa3b, v62
v_mul_f32 v79, 0xbfb8aa3b, v63
Ve 72,72
Ve 73,73
Ve 74,74
Ve 75,75
Ve 76,76
Ve 77,77
Ve 78,78
Ve 79,79
v_add_f32 v72, 1.0, v72
v_add_f32 v73, 1.0, v73
v_add_f32 v74, 1.0, v74
v_add_f32 v75, 1.0, v75
v_add_f32 v76, 1.0, v76
v_add_f32 v77, 1.0, v77
v_add_f32 v78, 1.0, v78
v_add_f32 v79, 1.0, v79
v_rcp_f32 v72, v72
v_rcp_f32 v73, v73
v_rcp_f32 v74, v74
v_rcp_f32 v75, v75
v_rcp_f32 v76, v76
v_rcp_f32 v77, v77
v_rcp_f32 v78, v78
v_rcp_f32 v79, v79
Vm 56,56,72
Vm 57,57,73
Vm 58,58,74
Vm 59,59,75
Vm 60,60,76
Vm 61,61,77
Vm 62,62,78
Vm 63,63,79
Vc 72,56,57
v_lshlrev_b32 v56, 16, v72
v_and_b32 v57, 0xffff0000, v72
Vc 73,58,59
v_lshlrev_b32 v58, 16, v73
v_and_b32 v59, 0xffff0000, v73
Vc 74,60,61
v_lshlrev_b32 v60, 16, v74
v_and_b32 v61, 0xffff0000, v74
Vc 75,62,63
v_lshlrev_b32 v62, 16, v75
v_and_b32 v63, 0xffff0000, v75
L_oproj_kernel_selskip3:
v_add_u32 v1, 96, v10
v_cmp_eq_u32 vcc, s52, v1
v_cmp_eq_u32 s[60:61], s53, v1
s_nop 3
s_or_b64 s[56:57], vcc, s[60:61]
s_cbranch_scc0 L_oproj_kernel_selskip4
v_cndmask_b32 v96, 0, v80, vcc
v_cndmask_b32 v96, v96, v88, s[60:61]
v_cndmask_b32 v97, 0, v81, vcc
v_cndmask_b32 v97, v97, v89, s[60:61]
v_cndmask_b32 v98, 0, v82, vcc
v_cndmask_b32 v98, v98, v90, s[60:61]
v_cndmask_b32 v99, 0, v83, vcc
v_cndmask_b32 v99, v99, v91, s[60:61]
v_cndmask_b32 v100, 0, v84, vcc
v_cndmask_b32 v100, v100, v92, s[60:61]
v_cndmask_b32 v101, 0, v85, vcc
v_cndmask_b32 v101, v101, v93, s[60:61]
v_cndmask_b32 v102, 0, v86, vcc
v_cndmask_b32 v102, v102, v94, s[60:61]
v_cndmask_b32 v103, 0, v87, vcc
v_cndmask_b32 v103, v103, v95, s[60:61]
v_lshlrev_b32 v64, 16, v28
v_and_b32 v65, 0xffff0000, v28
v_lshlrev_b32 v66, 16, v29
v_and_b32 v67, 0xffff0000, v29
v_lshlrev_b32 v68, 16, v30
v_and_b32 v69, 0xffff0000, v30
v_lshlrev_b32 v70, 16, v31
v_and_b32 v71, 0xffff0000, v31
Vs 64,64,38
Vs 65,65,38
Vs 66,66,38
Vs 67,67,38
Vs 68,68,38
Vs 69,69,38
Vs 70,70,38
Vs 71,71,38
Vc 72,64,65
v_lshlrev_b32 v64, 16, v72
v_and_b32 v65, 0xffff0000, v72
Vc 73,66,67
v_lshlrev_b32 v66, 16, v73
v_and_b32 v67, 0xffff0000, v73
Vc 74,68,69
v_lshlrev_b32 v68, 16, v74
v_and_b32 v69, 0xffff0000, v74
Vc 75,70,71
v_lshlrev_b32 v70, 16, v75
v_and_b32 v71, 0xffff0000, v75
Vm 64,64,39
Vm 65,65,39
Vm 66,66,39
Vm 67,67,39
Vm 68,68,39
Vm 69,69,39
Vm 70,70,39
Vm 71,71,39
Vc 72,64,65
v_lshlrev_b32 v64, 16, v72
v_and_b32 v65, 0xffff0000, v72
Vc 73,66,67
v_lshlrev_b32 v66, 16, v73
v_and_b32 v67, 0xffff0000, v73
Vc 74,68,69
v_lshlrev_b32 v68, 16, v74
v_and_b32 v69, 0xffff0000, v74
Vc 75,70,71
v_lshlrev_b32 v70, 16, v75
v_and_b32 v71, 0xffff0000, v75
Va 64,64,96
Va 65,65,97
Va 66,66,98
Va 67,67,99
Va 68,68,100
Va 69,69,101
Va 70,70,102
Va 71,71,103
Vc 72,64,65
v_lshlrev_b32 v64, 16, v72
v_and_b32 v65, 0xffff0000, v72
Vc 73,66,67
v_lshlrev_b32 v66, 16, v73
v_and_b32 v67, 0xffff0000, v73
Vc 74,68,69
v_lshlrev_b32 v68, 16, v74
v_and_b32 v69, 0xffff0000, v74
Vc 75,70,71
v_lshlrev_b32 v70, 16, v75
v_and_b32 v71, 0xffff0000, v75
v_mul_f32 v72, 0xbfb8aa3b, v64
v_mul_f32 v73, 0xbfb8aa3b, v65
v_mul_f32 v74, 0xbfb8aa3b, v66
v_mul_f32 v75, 0xbfb8aa3b, v67
v_mul_f32 v76, 0xbfb8aa3b, v68
v_mul_f32 v77, 0xbfb8aa3b, v69
v_mul_f32 v78, 0xbfb8aa3b, v70
v_mul_f32 v79, 0xbfb8aa3b, v71
Ve 72,72
Ve 73,73
Ve 74,74
Ve 75,75
Ve 76,76
Ve 77,77
Ve 78,78
Ve 79,79
v_add_f32 v72, 1.0, v72
v_add_f32 v73, 1.0, v73
v_add_f32 v74, 1.0, v74
v_add_f32 v75, 1.0, v75
v_add_f32 v76, 1.0, v76
v_add_f32 v77, 1.0, v77
v_add_f32 v78, 1.0, v78
v_add_f32 v79, 1.0, v79
v_rcp_f32 v72, v72
v_rcp_f32 v73, v73
v_rcp_f32 v74, v74
v_rcp_f32 v75, v75
v_rcp_f32 v76, v76
v_rcp_f32 v77, v77
v_rcp_f32 v78, v78
v_rcp_f32 v79, v79
Vm 64,64,72
Vm 65,65,73
Vm 66,66,74
Vm 67,67,75
Vm 68,68,76
Vm 69,69,77
Vm 70,70,78
Vm 71,71,79
Vc 72,64,65
v_lshlrev_b32 v64, 16, v72
v_and_b32 v65, 0xffff0000, v72
Vc 73,66,67
v_lshlrev_b32 v66, 16, v73
v_and_b32 v67, 0xffff0000, v73
Vc 74,68,69
v_lshlrev_b32 v68, 16, v74
v_and_b32 v69, 0xffff0000, v74
Vc 75,70,71
v_lshlrev_b32 v70, 16, v75
v_and_b32 v71, 0xffff0000, v75
L_oproj_kernel_selskip4:
s_branch L_k3_selAr
L_k3_sel:
v_mov_b32 v103, 0
s_mov_b32 s62, 0x400000
L_k3_poll:
buffer_load_dword v102, v103, s[40:43], s45 offen sc1
s_waitcnt vmcnt(0)
v_readfirstlane_b32 s63, v102
s_sub_u32 s62, s62, 1
s_cmp_eq_u32 s62, 0
s_cbranch_scc1 L_k3_polled
s_cmp_lt_u32 s63, 16
s_cbranch_scc1 L_k3_poll
L_k3_polled:
v_lshlrev_b32 v15, 10, v14
v_lshl_add_u32 v15, v13, 5, v15
buffer_load_dwordx4 v[80:83], v15, s[16:19], s47 offen offset:0 sc1
buffer_load_dwordx4 v[84:87], v15, s[16:19], s47 offen offset:16 sc1
buffer_load_dwordx4 v[88:91], v15, s[16:19], s47 offen offset:256 sc1
buffer_load_dwordx4 v[92:95], v15, s[16:19], s47 offen offset:272 sc1
buffer_load_dwordx4 v[96:99], v15, s[16:19], s47 offen offset:512 sc1
buffer_load_dwordx4 v[100:103], v15, s[16:19], s47 offen offset:528 sc1
buffer_load_dwordx4 v[104:107], v15, s[16:19], s47 offen offset:768 sc1
buffer_load_dwordx4 v[108:111], v15, s[16:19], s47 offen offset:784 sc1
s_waitcnt vmcnt(0)
Va 80,80,96
Va 81,81,97
Va 82,82,98
Va 83,83,99
Va 84,84,100
Va 85,85,101
Va 86,86,102
Va 87,87,103
Va 88,88,104
Va 89,89,105
Va 90,90,106
Va 91,91,107
Va 92,92,108
Va 93,93,109
Va 94,94,110
Va 95,95,111
v_add_f32_dpp v80, v80, v80 row_ror:8 row_mask:0xf bank_mask:0xf
v_add_f32_dpp v81, v81, v81 row_ror:8 row_mask:0xf bank_mask:0xf
v_add_f32_dpp v82, v82, v82 row_ror:8 row_mask:0xf bank_mask:0xf
v_add_f32_dpp v83, v83, v83 row_ror:8 row_mask:0xf bank_mask:0xf
v_add_f32_dpp v84, v84, v84 row_ror:8 row_mask:0xf bank_mask:0xf
v_add_f32_dpp v85, v85, v85 row_ror:8 row_mask:0xf bank_mask:0xf
v_add_f32_dpp v86, v86, v86 row_ror:8 row_mask:0xf bank_mask:0xf
v_add_f32_dpp v87, v87, v87 row_ror:8 row_mask:0xf bank_mask:0xf
v_add_f32_dpp v88, v88, v88 row_ror:8 row_mask:0xf bank_mask:0xf
v_add_f32_dpp v89, v89, v89 row_ror:8 row_mask:0xf bank_mask:0xf
v_add_f32_dpp v90, v90, v90 row_ror:8 row_mask:0xf bank_mask:0xf
v_add_f32_dpp v91, v91, v91 row_ror:8 row_mask:0xf bank_mask:0xf
v_add_f32_dpp v92, v92, v92 row_ror:8 row_mask:0xf bank_mask:0xf
v_add_f32_dpp v93, v93, v93 row_ror:8 row_mask:0xf bank_mask:0xf
v_add_f32_dpp v94, v94, v94 row_ror:8 row_mask:0xf bank_mask:0xf
v_add_f32_dpp v95, v95, v95 row_ror:8 row_mask:0xf bank_mask:0xf
v_mov_b32 v96, v80
v_mov_b32 v97, v81
v_mov_b32 v98, v82
v_mov_b32 v99, v83
v_mov_b32 v100, v84
v_mov_b32 v101, v85
v_mov_b32 v102, v86
v_mov_b32 v103, v87
v_mov_b32 v104, v88
v_mov_b32 v105, v89
v_mov_b32 v106, v90
v_mov_b32 v107, v91
v_mov_b32 v108, v92
v_mov_b32 v109, v93
v_mov_b32 v110, v94
v_mov_b32 v111, v95
v_permlane16_swap_b32 v96, v80
v_permlane16_swap_b32 v97, v81
v_permlane16_swap_b32 v98, v82
v_permlane16_swap_b32 v99, v83
v_permlane16_swap_b32 v100, v84
v_permlane16_swap_b32 v101, v85
v_permlane16_swap_b32 v102, v86
v_permlane16_swap_b32 v103, v87
v_permlane16_swap_b32 v104, v88
v_permlane16_swap_b32 v105, v89
v_permlane16_swap_b32 v106, v90
v_permlane16_swap_b32 v107, v91
v_permlane16_swap_b32 v108, v92
v_permlane16_swap_b32 v109, v93
v_permlane16_swap_b32 v110, v94
v_permlane16_swap_b32 v111, v95
Va 80,80,96
Va 81,81,97
Va 82,82,98
Va 83,83,99
Va 84,84,100
Va 85,85,101
Va 86,86,102
Va 87,87,103
Va 88,88,104
Va 89,89,105
Va 90,90,106
Va 91,91,107
Va 92,92,108
Va 93,93,109
Va 94,94,110
Va 95,95,111
v_mov_b32 v96, v80
v_mov_b32 v97, v81
v_mov_b32 v98, v82
v_mov_b32 v99, v83
v_mov_b32 v100, v84
v_mov_b32 v101, v85
v_mov_b32 v102, v86
v_mov_b32 v103, v87
v_mov_b32 v104, v88
v_mov_b32 v105, v89
v_mov_b32 v106, v90
v_mov_b32 v107, v91
v_mov_b32 v108, v92
v_mov_b32 v109, v93
v_mov_b32 v110, v94
v_mov_b32 v111, v95
v_permlane32_swap_b32 v96, v80
v_permlane32_swap_b32 v97, v81
v_permlane32_swap_b32 v98, v82
v_permlane32_swap_b32 v99, v83
v_permlane32_swap_b32 v100, v84
v_permlane32_swap_b32 v101, v85
v_permlane32_swap_b32 v102, v86
v_permlane32_swap_b32 v103, v87
v_permlane32_swap_b32 v104, v88
v_permlane32_swap_b32 v105, v89
v_permlane32_swap_b32 v106, v90
v_permlane32_swap_b32 v107, v91
v_permlane32_swap_b32 v108, v92
v_permlane32_swap_b32 v109, v93
v_permlane32_swap_b32 v110, v94
v_permlane32_swap_b32 v111, v95
Va 80,80,96
Va 81,81,97
Va 82,82,98
Va 83,83,99
Va 84,84,100
Va 85,85,101
Va 86,86,102
Va 87,87,103
Va 88,88,104
Va 89,89,105
Va 90,90,106
Va 91,91,107
Va 92,92,108
Va 93,93,109
Va 94,94,110
Va 95,95,111
Vc 1,80,81
v_lshlrev_b32 v80, 16, v1
v_and_b32 v81, 0xffff0000, v1
Vc 1,82,83
v_lshlrev_b32 v82, 16, v1
v_and_b32 v83, 0xffff0000, v1
Vc 1,84,85
v_lshlrev_b32 v84, 16, v1
v_and_b32 v85, 0xffff0000, v1
Vc 1,86,87
v_lshlrev_b32 v86, 16, v1
v_and_b32 v87, 0xffff0000, v1
Vc 1,88,89
v_lshlrev_b32 v88, 16, v1
v_and_b32 v89, 0xffff0000, v1
Vc 1,90,91
v_lshlrev_b32 v90, 16, v1
v_and_b32 v91, 0xffff0000, v1
Vc 1,92,93
v_lshlrev_b32 v92, 16, v1
v_and_b32 v93, 0xffff0000, v1
Vc 1,94,95
v_lshlrev_b32 v94, 16, v1
v_and_b32 v95, 0xffff0000, v1
v_mul_f32 v80, s54, v80
v_mul_f32 v81, s54, v81
v_mul_f32 v82, s54, v82
v_mul_f32 v83, s54, v83
v_mul_f32 v84, s54, v84
v_mul_f32 v85, s54, v85
v_mul_f32 v86, s54, v86
v_mul_f32 v87, s54, v87
v_mul_f32 v88, s55, v88
v_mul_f32 v89, s55, v89
v_mul_f32 v90, s55, v90
v_mul_f32 v91, s55, v91
v_mul_f32 v92, s55, v92
v_mul_f32 v93, s55, v93
v_mul_f32 v94, s55, v94
v_mul_f32 v95, s55, v95
Vc 1,80,81
v_lshlrev_b32 v80, 16, v1
v_and_b32 v81, 0xffff0000, v1
Vc 1,82,83
v_lshlrev_b32 v82, 16, v1
v_and_b32 v83, 0xffff0000, v1
Vc 1,84,85
v_lshlrev_b32 v84, 16, v1
v_and_b32 v85, 0xffff0000, v1
Vc 1,86,87
v_lshlrev_b32 v86, 16, v1
v_and_b32 v87, 0xffff0000, v1
Vc 1,88,89
v_lshlrev_b32 v88, 16, v1
v_and_b32 v89, 0xffff0000, v1
Vc 1,90,91
v_lshlrev_b32 v90, 16, v1
v_and_b32 v91, 0xffff0000, v1
Vc 1,92,93
v_lshlrev_b32 v92, 16, v1
v_and_b32 v93, 0xffff0000, v1
Vc 1,94,95
v_lshlrev_b32 v94, 16, v1
v_and_b32 v95, 0xffff0000, v1
s_lshl_b32 s3, s33, 7
s_sub_u32 s52, s52, s3
s_sub_u32 s53, s53, s3
v_add_u32 v1, 0, v10
v_cmp_eq_u32 vcc, s52, v1
v_cmp_eq_u32 s[60:61], s53, v1
s_nop 3
s_or_b64 s[56:57], vcc, s[60:61]
s_cbranch_scc0 L_oproj_kernel_selskip5
v_cndmask_b32 v96, 0, v80, vcc
v_cndmask_b32 v96, v96, v88, s[60:61]
v_cndmask_b32 v97, 0, v81, vcc
v_cndmask_b32 v97, v97, v89, s[60:61]
v_cndmask_b32 v98, 0, v82, vcc
v_cndmask_b32 v98, v98, v90, s[60:61]
v_cndmask_b32 v99, 0, v83, vcc
v_cndmask_b32 v99, v99, v91, s[60:61]
v_cndmask_b32 v100, 0, v84, vcc
v_cndmask_b32 v100, v100, v92, s[60:61]
v_cndmask_b32 v101, 0, v85, vcc
v_cndmask_b32 v101, v101, v93, s[60:61]
v_cndmask_b32 v102, 0, v86, vcc
v_cndmask_b32 v102, v102, v94, s[60:61]
v_cndmask_b32 v103, 0, v87, vcc
v_cndmask_b32 v103, v103, v95, s[60:61]
v_lshlrev_b32 v40, 16, v16
v_and_b32 v41, 0xffff0000, v16
v_lshlrev_b32 v42, 16, v17
v_and_b32 v43, 0xffff0000, v17
v_lshlrev_b32 v44, 16, v18
v_and_b32 v45, 0xffff0000, v18
v_lshlrev_b32 v46, 16, v19
v_and_b32 v47, 0xffff0000, v19
Vs 40,40,32
Vs 41,41,32
Vs 42,42,32
Vs 43,43,32
Vs 44,44,32
Vs 45,45,32
Vs 46,46,32
Vs 47,47,32
Vc 72,40,41
v_lshlrev_b32 v40, 16, v72
v_and_b32 v41, 0xffff0000, v72
Vc 73,42,43
v_lshlrev_b32 v42, 16, v73
v_and_b32 v43, 0xffff0000, v73
Vc 74,44,45
v_lshlrev_b32 v44, 16, v74
v_and_b32 v45, 0xffff0000, v74
Vc 75,46,47
v_lshlrev_b32 v46, 16, v75
v_and_b32 v47, 0xffff0000, v75
Vm 40,40,33
Vm 41,41,33
Vm 42,42,33
Vm 43,43,33
Vm 44,44,33
Vm 45,45,33
Vm 46,46,33
Vm 47,47,33
Vc 72,40,41
v_lshlrev_b32 v40, 16, v72
v_and_b32 v41, 0xffff0000, v72
Vc 73,42,43
v_lshlrev_b32 v42, 16, v73
v_and_b32 v43, 0xffff0000, v73
Vc 74,44,45
v_lshlrev_b32 v44, 16, v74
v_and_b32 v45, 0xffff0000, v74
Vc 75,46,47
v_lshlrev_b32 v46, 16, v75
v_and_b32 v47, 0xffff0000, v75
Va 40,40,96
Va 41,41,97
Va 42,42,98
Va 43,43,99
Va 44,44,100
Va 45,45,101
Va 46,46,102
Va 47,47,103
Vc 72,40,41
v_lshlrev_b32 v40, 16, v72
v_and_b32 v41, 0xffff0000, v72
Vc 73,42,43
v_lshlrev_b32 v42, 16, v73
v_and_b32 v43, 0xffff0000, v73
Vc 74,44,45
v_lshlrev_b32 v44, 16, v74
v_and_b32 v45, 0xffff0000, v74
Vc 75,46,47
v_lshlrev_b32 v46, 16, v75
v_and_b32 v47, 0xffff0000, v75
v_mul_f32 v72, 0xbfb8aa3b, v40
v_mul_f32 v73, 0xbfb8aa3b, v41
v_mul_f32 v74, 0xbfb8aa3b, v42
v_mul_f32 v75, 0xbfb8aa3b, v43
v_mul_f32 v76, 0xbfb8aa3b, v44
v_mul_f32 v77, 0xbfb8aa3b, v45
v_mul_f32 v78, 0xbfb8aa3b, v46
v_mul_f32 v79, 0xbfb8aa3b, v47
Ve 72,72
Ve 73,73
Ve 74,74
Ve 75,75
Ve 76,76
Ve 77,77
Ve 78,78
Ve 79,79
v_add_f32 v72, 1.0, v72
v_add_f32 v73, 1.0, v73
v_add_f32 v74, 1.0, v74
v_add_f32 v75, 1.0, v75
v_add_f32 v76, 1.0, v76
v_add_f32 v77, 1.0, v77
v_add_f32 v78, 1.0, v78
v_add_f32 v79, 1.0, v79
v_rcp_f32 v72, v72
v_rcp_f32 v73, v73
v_rcp_f32 v74, v74
v_rcp_f32 v75, v75
v_rcp_f32 v76, v76
v_rcp_f32 v77, v77
v_rcp_f32 v78, v78
v_rcp_f32 v79, v79
Vm 40,40,72
Vm 41,41,73
Vm 42,42,74
Vm 43,43,75
Vm 44,44,76
Vm 45,45,77
Vm 46,46,78
Vm 47,47,79
Vc 72,40,41
v_lshlrev_b32 v40, 16, v72
v_and_b32 v41, 0xffff0000, v72
Vc 73,42,43
v_lshlrev_b32 v42, 16, v73
v_and_b32 v43, 0xffff0000, v73
Vc 74,44,45
v_lshlrev_b32 v44, 16, v74
v_and_b32 v45, 0xffff0000, v74
Vc 75,46,47
v_lshlrev_b32 v46, 16, v75
v_and_b32 v47, 0xffff0000, v75
L_oproj_kernel_selskip5:
v_add_u32 v1, 32, v10
v_cmp_eq_u32 vcc, s52, v1
v_cmp_eq_u32 s[60:61], s53, v1
s_nop 3
s_or_b64 s[56:57], vcc, s[60:61]
s_cbranch_scc0 L_oproj_kernel_selskip6
v_cndmask_b32 v96, 0, v80, vcc
v_cndmask_b32 v96, v96, v88, s[60:61]
v_cndmask_b32 v97, 0, v81, vcc
v_cndmask_b32 v97, v97, v89, s[60:61]
v_cndmask_b32 v98, 0, v82, vcc
v_cndmask_b32 v98, v98, v90, s[60:61]
v_cndmask_b32 v99, 0, v83, vcc
v_cndmask_b32 v99, v99, v91, s[60:61]
v_cndmask_b32 v100, 0, v84, vcc
v_cndmask_b32 v100, v100, v92, s[60:61]
v_cndmask_b32 v101, 0, v85, vcc
v_cndmask_b32 v101, v101, v93, s[60:61]
v_cndmask_b32 v102, 0, v86, vcc
v_cndmask_b32 v102, v102, v94, s[60:61]
v_cndmask_b32 v103, 0, v87, vcc
v_cndmask_b32 v103, v103, v95, s[60:61]
v_lshlrev_b32 v48, 16, v20
v_and_b32 v49, 0xffff0000, v20
v_lshlrev_b32 v50, 16, v21
v_and_b32 v51, 0xffff0000, v21
v_lshlrev_b32 v52, 16, v22
v_and_b32 v53, 0xffff0000, v22
v_lshlrev_b32 v54, 16, v23
v_and_b32 v55, 0xffff0000, v23
Vs 48,48,34
Vs 49,49,34
Vs 50,50,34
Vs 51,51,34
Vs 52,52,34
Vs 53,53,34
Vs 54,54,34
Vs 55,55,34
Vc 72,48,49
v_lshlrev_b32 v48, 16, v72
v_and_b32 v49, 0xffff0000, v72
Vc 73,50,51
v_lshlrev_b32 v50, 16, v73
v_and_b32 v51, 0xffff0000, v73
Vc 74,52,53
v_lshlrev_b32 v52, 16, v74
v_and_b32 v53, 0xffff0000, v74
Vc 75,54,55
v_lshlrev_b32 v54, 16, v75
v_and_b32 v55, 0xffff0000, v75
Vm 48,48,35
Vm 49,49,35
Vm 50,50,35
Vm 51,51,35
Vm 52,52,35
Vm 53,53,35
Vm 54,54,35
Vm 55,55,35
Vc 72,48,49
v_lshlrev_b32 v48, 16, v72
v_and_b32 v49, 0xffff0000, v72
Vc 73,50,51
v_lshlrev_b32 v50, 16, v73
v_and_b32 v51, 0xffff0000, v73
Vc 74,52,53
v_lshlrev_b32 v52, 16, v74
v_and_b32 v53, 0xffff0000, v74
Vc 75,54,55
v_lshlrev_b32 v54, 16, v75
v_and_b32 v55, 0xffff0000, v75
Va 48,48,96
Va 49,49,97
Va 50,50,98
Va 51,51,99
Va 52,52,100
Va 53,53,101
Va 54,54,102
Va 55,55,103
Vc 72,48,49
v_lshlrev_b32 v48, 16, v72
v_and_b32 v49, 0xffff0000, v72
Vc 73,50,51
v_lshlrev_b32 v50, 16, v73
v_and_b32 v51, 0xffff0000, v73
Vc 74,52,53
v_lshlrev_b32 v52, 16, v74
v_and_b32 v53, 0xffff0000, v74
Vc 75,54,55
v_lshlrev_b32 v54, 16, v75
v_and_b32 v55, 0xffff0000, v75
v_mul_f32 v72, 0xbfb8aa3b, v48
v_mul_f32 v73, 0xbfb8aa3b, v49
v_mul_f32 v74, 0xbfb8aa3b, v50
v_mul_f32 v75, 0xbfb8aa3b, v51
v_mul_f32 v76, 0xbfb8aa3b, v52
v_mul_f32 v77, 0xbfb8aa3b, v53
v_mul_f32 v78, 0xbfb8aa3b, v54
v_mul_f32 v79, 0xbfb8aa3b, v55
Ve 72,72
Ve 73,73
Ve 74,74
Ve 75,75
Ve 76,76
Ve 77,77
Ve 78,78
Ve 79,79
v_add_f32 v72, 1.0, v72
v_add_f32 v73, 1.0, v73
v_add_f32 v74, 1.0, v74
v_add_f32 v75, 1.0, v75
v_add_f32 v76, 1.0, v76
v_add_f32 v77, 1.0, v77
v_add_f32 v78, 1.0, v78
v_add_f32 v79, 1.0, v79
v_rcp_f32 v72, v72
v_rcp_f32 v73, v73
v_rcp_f32 v74, v74
v_rcp_f32 v75, v75
v_rcp_f32 v76, v76
v_rcp_f32 v77, v77
v_rcp_f32 v78, v78
v_rcp_f32 v79, v79
Vm 48,48,72
Vm 49,49,73
Vm 50,50,74
Vm 51,51,75
Vm 52,52,76
Vm 53,53,77
Vm 54,54,78
Vm 55,55,79
Vc 72,48,49
v_lshlrev_b32 v48, 16, v72
v_and_b32 v49, 0xffff0000, v72
Vc 73,50,51
v_lshlrev_b32 v50, 16, v73
v_and_b32 v51, 0xffff0000, v73
Vc 74,52,53
v_lshlrev_b32 v52, 16, v74
v_and_b32 v53, 0xffff0000, v74
Vc 75,54,55
v_lshlrev_b32 v54, 16, v75
v_and_b32 v55, 0xffff0000, v75
L_oproj_kernel_selskip6:
v_add_u32 v1, 64, v10
v_cmp_eq_u32 vcc, s52, v1
v_cmp_eq_u32 s[60:61], s53, v1
s_nop 3
s_or_b64 s[56:57], vcc, s[60:61]
s_cbranch_scc0 L_oproj_kernel_selskip7
v_cndmask_b32 v96, 0, v80, vcc
v_cndmask_b32 v96, v96, v88, s[60:61]
v_cndmask_b32 v97, 0, v81, vcc
v_cndmask_b32 v97, v97, v89, s[60:61]
v_cndmask_b32 v98, 0, v82, vcc
v_cndmask_b32 v98, v98, v90, s[60:61]
v_cndmask_b32 v99, 0, v83, vcc
v_cndmask_b32 v99, v99, v91, s[60:61]
v_cndmask_b32 v100, 0, v84, vcc
v_cndmask_b32 v100, v100, v92, s[60:61]
v_cndmask_b32 v101, 0, v85, vcc
v_cndmask_b32 v101, v101, v93, s[60:61]
v_cndmask_b32 v102, 0, v86, vcc
v_cndmask_b32 v102, v102, v94, s[60:61]
v_cndmask_b32 v103, 0, v87, vcc
v_cndmask_b32 v103, v103, v95, s[60:61]
v_lshlrev_b32 v56, 16, v24
v_and_b32 v57, 0xffff0000, v24
v_lshlrev_b32 v58, 16, v25
v_and_b32 v59, 0xffff0000, v25
v_lshlrev_b32 v60, 16, v26
v_and_b32 v61, 0xffff0000, v26
v_lshlrev_b32 v62, 16, v27
v_and_b32 v63, 0xffff0000, v27
Vs 56,56,36
Vs 57,57,36
Vs 58,58,36
Vs 59,59,36
Vs 60,60,36
Vs 61,61,36
Vs 62,62,36
Vs 63,63,36
Vc 72,56,57
v_lshlrev_b32 v56, 16, v72
v_and_b32 v57, 0xffff0000, v72
Vc 73,58,59
v_lshlrev_b32 v58, 16, v73
v_and_b32 v59, 0xffff0000, v73
Vc 74,60,61
v_lshlrev_b32 v60, 16, v74
v_and_b32 v61, 0xffff0000, v74
Vc 75,62,63
v_lshlrev_b32 v62, 16, v75
v_and_b32 v63, 0xffff0000, v75
Vm 56,56,37
Vm 57,57,37
Vm 58,58,37
Vm 59,59,37
Vm 60,60,37
Vm 61,61,37
Vm 62,62,37
Vm 63,63,37
Vc 72,56,57
v_lshlrev_b32 v56, 16, v72
v_and_b32 v57, 0xffff0000, v72
Vc 73,58,59
v_lshlrev_b32 v58, 16, v73
v_and_b32 v59, 0xffff0000, v73
Vc 74,60,61
v_lshlrev_b32 v60, 16, v74
v_and_b32 v61, 0xffff0000, v74
Vc 75,62,63
v_lshlrev_b32 v62, 16, v75
v_and_b32 v63, 0xffff0000, v75
Va 56,56,96
Va 57,57,97
Va 58,58,98
Va 59,59,99
Va 60,60,100
Va 61,61,101
Va 62,62,102
Va 63,63,103
Vc 72,56,57
v_lshlrev_b32 v56, 16, v72
v_and_b32 v57, 0xffff0000, v72
Vc 73,58,59
v_lshlrev_b32 v58, 16, v73
v_and_b32 v59, 0xffff0000, v73
Vc 74,60,61
v_lshlrev_b32 v60, 16, v74
v_and_b32 v61, 0xffff0000, v74
Vc 75,62,63
v_lshlrev_b32 v62, 16, v75
v_and_b32 v63, 0xffff0000, v75
v_mul_f32 v72, 0xbfb8aa3b, v56
v_mul_f32 v73, 0xbfb8aa3b, v57
v_mul_f32 v74, 0xbfb8aa3b, v58
v_mul_f32 v75, 0xbfb8aa3b, v59
v_mul_f32 v76, 0xbfb8aa3b, v60
v_mul_f32 v77, 0xbfb8aa3b, v61
v_mul_f32 v78, 0xbfb8aa3b, v62
v_mul_f32 v79, 0xbfb8aa3b, v63
Ve 72,72
Ve 73,73
Ve 74,74
Ve 75,75
Ve 76,76
Ve 77,77
Ve 78,78
Ve 79,79
v_add_f32 v72, 1.0, v72
v_add_f32 v73, 1.0, v73
v_add_f32 v74, 1.0, v74
v_add_f32 v75, 1.0, v75
v_add_f32 v76, 1.0, v76
v_add_f32 v77, 1.0, v77
v_add_f32 v78, 1.0, v78
v_add_f32 v79, 1.0, v79
v_rcp_f32 v72, v72
v_rcp_f32 v73, v73
v_rcp_f32 v74, v74
v_rcp_f32 v75, v75
v_rcp_f32 v76, v76
v_rcp_f32 v77, v77
v_rcp_f32 v78, v78
v_rcp_f32 v79, v79
Vm 56,56,72
Vm 57,57,73
Vm 58,58,74
Vm 59,59,75
Vm 60,60,76
Vm 61,61,77
Vm 62,62,78
Vm 63,63,79
Vc 72,56,57
v_lshlrev_b32 v56, 16, v72
v_and_b32 v57, 0xffff0000, v72
Vc 73,58,59
v_lshlrev_b32 v58, 16, v73
v_and_b32 v59, 0xffff0000, v73
Vc 74,60,61
v_lshlrev_b32 v60, 16, v74
v_and_b32 v61, 0xffff0000, v74
Vc 75,62,63
v_lshlrev_b32 v62, 16, v75
v_and_b32 v63, 0xffff0000, v75
L_oproj_kernel_selskip7:
v_add_u32 v1, 96, v10
v_cmp_eq_u32 vcc, s52, v1
v_cmp_eq_u32 s[60:61], s53, v1
s_nop 3
s_or_b64 s[56:57], vcc, s[60:61]
s_cbranch_scc0 L_oproj_kernel_selskip8
v_cndmask_b32 v96, 0, v80, vcc
v_cndmask_b32 v96, v96, v88, s[60:61]
v_cndmask_b32 v97, 0, v81, vcc
v_cndmask_b32 v97, v97, v89, s[60:61]
v_cndmask_b32 v98, 0, v82, vcc
v_cndmask_b32 v98, v98, v90, s[60:61]
v_cndmask_b32 v99, 0, v83, vcc
v_cndmask_b32 v99, v99, v91, s[60:61]
v_cndmask_b32 v100, 0, v84, vcc
v_cndmask_b32 v100, v100, v92, s[60:61]
v_cndmask_b32 v101, 0, v85, vcc
v_cndmask_b32 v101, v101, v93, s[60:61]
v_cndmask_b32 v102, 0, v86, vcc
v_cndmask_b32 v102, v102, v94, s[60:61]
v_cndmask_b32 v103, 0, v87, vcc
v_cndmask_b32 v103, v103, v95, s[60:61]
v_lshlrev_b32 v64, 16, v28
v_and_b32 v65, 0xffff0000, v28
v_lshlrev_b32 v66, 16, v29
v_and_b32 v67, 0xffff0000, v29
v_lshlrev_b32 v68, 16, v30
v_and_b32 v69, 0xffff0000, v30
v_lshlrev_b32 v70, 16, v31
v_and_b32 v71, 0xffff0000, v31
Vs 64,64,38
Vs 65,65,38
Vs 66,66,38
Vs 67,67,38
Vs 68,68,38
Vs 69,69,38
Vs 70,70,38
Vs 71,71,38
Vc 72,64,65
v_lshlrev_b32 v64, 16, v72
v_and_b32 v65, 0xffff0000, v72
Vc 73,66,67
v_lshlrev_b32 v66, 16, v73
v_and_b32 v67, 0xffff0000, v73
Vc 74,68,69
v_lshlrev_b32 v68, 16, v74
v_and_b32 v69, 0xffff0000, v74
Vc 75,70,71
v_lshlrev_b32 v70, 16, v75
v_and_b32 v71, 0xffff0000, v75
Vm 64,64,39
Vm 65,65,39
Vm 66,66,39
Vm 67,67,39
Vm 68,68,39
Vm 69,69,39
Vm 70,70,39
Vm 71,71,39
Vc 72,64,65
v_lshlrev_b32 v64, 16, v72
v_and_b32 v65, 0xffff0000, v72
Vc 73,66,67
v_lshlrev_b32 v66, 16, v73
v_and_b32 v67, 0xffff0000, v73
Vc 74,68,69
v_lshlrev_b32 v68, 16, v74
v_and_b32 v69, 0xffff0000, v74
Vc 75,70,71
v_lshlrev_b32 v70, 16, v75
v_and_b32 v71, 0xffff0000, v75
Va 64,64,96
Va 65,65,97
Va 66,66,98
Va 67,67,99
Va 68,68,100
Va 69,69,101
Va 70,70,102
Va 71,71,103
Vc 72,64,65
v_lshlrev_b32 v64, 16, v72
v_and_b32 v65, 0xffff0000, v72
Vc 73,66,67
v_lshlrev_b32 v66, 16, v73
v_and_b32 v67, 0xffff0000, v73
Vc 74,68,69
v_lshlrev_b32 v68, 16, v74
v_and_b32 v69, 0xffff0000, v74
Vc 75,70,71
v_lshlrev_b32 v70, 16, v75
v_and_b32 v71, 0xffff0000, v75
v_mul_f32 v72, 0xbfb8aa3b, v64
v_mul_f32 v73, 0xbfb8aa3b, v65
v_mul_f32 v74, 0xbfb8aa3b, v66
v_mul_f32 v75, 0xbfb8aa3b, v67
v_mul_f32 v76, 0xbfb8aa3b, v68
v_mul_f32 v77, 0xbfb8aa3b, v69
v_mul_f32 v78, 0xbfb8aa3b, v70
v_mul_f32 v79, 0xbfb8aa3b, v71
Ve 72,72
Ve 73,73
Ve 74,74
Ve 75,75
Ve 76,76
Ve 77,77
Ve 78,78
Ve 79,79
v_add_f32 v72, 1.0, v72
v_add_f32 v73, 1.0, v73
v_add_f32 v74, 1.0, v74
v_add_f32 v75, 1.0, v75
v_add_f32 v76, 1.0, v76
v_add_f32 v77, 1.0, v77
v_add_f32 v78, 1.0, v78
v_add_f32 v79, 1.0, v79
v_rcp_f32 v72, v72
v_rcp_f32 v73, v73
v_rcp_f32 v74, v74
v_rcp_f32 v75, v75
v_rcp_f32 v76, v76
v_rcp_f32 v77, v77
v_rcp_f32 v78, v78
v_rcp_f32 v79, v79
Vm 64,64,72
Vm 65,65,73
Vm 66,66,74
Vm 67,67,75
Vm 68,68,76
Vm 69,69,77
Vm 70,70,78
Vm 71,71,79
Vc 72,64,65
v_lshlrev_b32 v64, 16, v72
v_and_b32 v65, 0xffff0000, v72
Vc 73,66,67
v_lshlrev_b32 v66, 16, v73
v_and_b32 v67, 0xffff0000, v73
Vc 74,68,69
v_lshlrev_b32 v68, 16, v74
v_and_b32 v69, 0xffff0000, v74
Vc 75,70,71
v_lshlrev_b32 v70, 16, v75
v_and_b32 v71, 0xffff0000, v75
L_oproj_kernel_selskip8:
s_branch L_k3_selr
.section .rodata,"a"
.p2align 6
.amdhsa_kernel front_kernel
  .amdhsa_next_free_vgpr 512
  .amdhsa_next_free_sgpr 102
  .amdhsa_accum_offset 256
  .amdhsa_group_segment_fixed_size 0
  .amdhsa_kernarg_size 112
  .amdhsa_user_sgpr_count 2
  .amdhsa_user_sgpr_kernarg_segment_ptr 1
  .amdhsa_system_sgpr_workgroup_id_x 1
.end_amdhsa_kernel
.p2align 6
.amdhsa_kernel oproj_kernel
  .amdhsa_next_free_vgpr 416
  .amdhsa_next_free_sgpr 102
  .amdhsa_accum_offset 256
  .amdhsa_group_segment_fixed_size 0
  .amdhsa_kernarg_size 112
  .amdhsa_user_sgpr_count 2
  .amdhsa_user_sgpr_kernarg_segment_ptr 1
  .amdhsa_system_sgpr_workgroup_id_x 1
.end_amdhsa_kernel
```

```asm
; @launch grid=(256,1,1) block=(256,1,1) lds=148480
.amdgcn_target "amdgcn-amd-amdhsa--gfx950"
.macro Va d,x,y
v_add_f32 v\d, v\x, v\y
.endm
.macro Vc d,x,y
v_cvt_pk_bf16_f32 v\d, v\x, v\y
.endm
.macro Ta d,x,o
ds_read_b64_tr_b16 a[\d:\d+1], v\x offset:\o
.endm
.macro Ra d,x,o
ds_read_b128 a[\d:\d+3], v\x offset:\o
.endm
.macro Zvaa d,x,y
v_mfma_f32_16x16x32_bf16 v[\d:\d+3], a[\x:\x+3], a[\y:\y+3], 0
.endm
.macro Rv d,x,o
ds_read_b128 v[\d:\d+3], v\x offset:\o
.endm
.macro Zaaa d,x,y
v_mfma_f32_16x16x32_bf16 a[\d:\d+3], a[\x:\x+3], a[\y:\y+3], 0
.endm
.macro Mvaa d,x,y
v_mfma_f32_16x16x32_bf16 v[\d:\d+3], a[\x:\x+3], a[\y:\y+3], v[\d:\d+3]
.endm
.macro Maaa d,x,y
v_mfma_f32_16x16x32_bf16 a[\d:\d+3], a[\x:\x+3], a[\y:\y+3], a[\d:\d+3]
.endm
.macro Ar d,x
v_accvgpr_read_b32 v\d, a\x
.endm
.macro VE d,x
v_exp_f32_e64 v\d, v\x
.endm
.macro Aw d,x
v_accvgpr_write_b32 a\d, v\x
.endm
.macro Vs d,x,y
v_sub_f32 v\d, v\x, v\y
.endm
.macro Ve d,x
v_exp_f32 v\d, v\x
.endm
.macro Cvaa d,x,y,c
v_mfma_f32_16x16x32_bf16 v[\d:\d+3], a[\x:\x+3], a[\y:\y+3], v[\c:\c+3]
.endm
.macro Maav d,x,y
v_mfma_f32_16x16x32_bf16 a[\d:\d+3], a[\x:\x+3], v[\y:\y+3], a[\d:\d+3]
.endm
.macro Mvvv d,x,y
v_mfma_f32_16x16x32_bf16 v[\d:\d+3], v[\x:\x+3], v[\y:\y+3], v[\d:\d+3]
.endm
.macro Vm d,x,y
v_mul_f32 v\d, v\x, v\y
.endm
.macro Zvva d,x,y
v_mfma_f32_16x16x32_bf16 v[\d:\d+3], v[\x:\x+3], a[\y:\y+3], 0
.endm
.macro Mvva d,x,y
v_mfma_f32_16x16x32_bf16 v[\d:\d+3], v[\x:\x+3], a[\y:\y+3], v[\d:\d+3]
.endm
.macro Zvav d,x,y
v_mfma_f32_16x16x32_bf16 v[\d:\d+3], a[\x:\x+3], v[\y:\y+3], 0
.endm
.macro Mvav d,x,y
v_mfma_f32_16x16x32_bf16 v[\d:\d+3], a[\x:\x+3], v[\y:\y+3], v[\d:\d+3]
.endm
.text
.globl recurrent_scan__compressed_kv_cla__moe_arch_mod__prompt_kernel
.p2align 8
.type recurrent_scan__compressed_kv_cla__moe_arch_mod__prompt_kernel,@function
recurrent_scan__compressed_kv_cla__moe_arch_mod__prompt_kernel:
s_cmp_ge_u32 s2, 256
s_cbranch_scc1 L_k2_end
s_load_dwordx4 s[4:7], s[0:1], 0
s_load_dwordx2 s[44:45], s[0:1], 56
s_load_dwordx4 s[40:43], s[0:1], 24
s_load_dwordx4 s[64:67], s[0:1], 96
v_lshrrev_b32 v1, 6, v0
v_and_b32 v0, 63, v0
v_readfirstlane_b32 s32, v1
v_lshrrev_b32 v33, 5, v0
v_and_b32 v31, 31, v0
v_lshlrev_b32_e64 v36, 4, v31
v_lshl_add_u32 v35, v33, 11, v36
s_lshl_b32 s36, s2, 14
s_lshl_b32 s37, s32, 12
s_add_u32 s36, s36, s37
s_lshr_b32 s3, s2, 3
s_and_b32 s33, s3, 7
s_lshr_b32 s3, s3, 3
s_lshr_b32 s35, s3, 1
s_and_b32 s3, s3, 1
s_and_b32 s34, s2, 7
s_lshl_b32 s34, s34, 1
s_add_u32 s34, s34, s3
s_mov_b32 s48, 0
s_mov_b32 s52, 0
s_nop 0
s_mov_b32 s49, 7168
s_mov_b32 s53, 15360
s_mov_b32 s50, 14336
s_mov_b32 s54, 30720
s_mov_b32 s51, 21504
s_mov_b32 s55, 46080
s_lshl_b32 s56, s32, 13
s_add_u32 s57, s56, 32768
s_lshl_b32 s3, s32, 4
v_add_u32 v30, s3, v33
v_lshlrev_b32 v30, 13, v30
v_lshlrev_b32 v34, 1, v33
v_xor_b32 v31, v31, v34
v_xor_b32_e64 v34, 0, v31
v_lshl_add_u32 v6, v34, 4, v30
v_xor_b32_e64 v34, 4, v31
v_lshl_add_u32 v7, v34, 4, v30
v_xor_b32_e64 v34, 8, v31
v_lshl_add_u32 v8, v34, 4, v30
v_add_u32 v8, 65536, v8
v_xor_b32_e64 v34, 12, v31
v_lshl_add_u32 v9, v34, 4, v30
v_add_u32 v9, 65536, v9
v_lshrrev_b32 v30, 3, v0
s_lshl_b32 s3, s32, 6
v_add_u32 v30, s3, v30
v_lshlrev_b32 v30, 10, v30
v_and_b32 v31, 7, v0
v_lshrrev_b32 v32, 4, v0
v_xor_b32_e64 v31, v31, v32
v_lshl_add_u32 v2, v31, 4, v30
v_xor_b32_e64 v31, 4, v31
v_lshl_add_u32 v3, v31, 4, v30
v_add_u32 v4, 32768, v2
v_add_u32 v5, 32768, v3
s_waitcnt lgkmcnt(0)
s_mov_b32 s16, s4
s_and_b32 s17, s5, 0xffff
s_mov_b32 s18, 4194304
s_mov_b32 s19, 0x20000
buffer_load_dwordx4 v[48:51], v35, s[16:19], s36 offen offset:0 nt
buffer_load_dwordx4 v[52:55], v35, s[16:19], s36 offen offset:512 nt
buffer_load_dwordx4 v[56:59], v35, s[16:19], s36 offen offset:1024 nt
buffer_load_dwordx4 v[60:63], v35, s[16:19], s36 offen offset:1536 nt
s_getpc_b64 s[68:69]
L_cpf1:
s_add_u32 s68, s68, (recurrent_scan__compressed_kv_cla__moe_arch_mod__prompt_kernel-L_cpf1)&0xffffffff
s_addc_u32 s69, s69, ((recurrent_scan__compressed_kv_cla__moe_arch_mod__prompt_kernel-L_cpf1)>>32)&0xffffffff
s_lshr_b32 s70, s2, 3
s_lshl_b32 s70, s70, 2
s_add_u32 s70, s70, s32
s_lshl_b32 s70, s70, 10
v_and_b32 v122, 7, v0
v_lshlrev_b32 v122, 7, v122
v_add_u32 v122, s70, v122
v_min_u32 v122, L_k2_fin-recurrent_scan__compressed_kv_cla__moe_arch_mod__prompt_kernel-4, v122
v_mov_b32 v121, s69
v_add_co_u32 v120, vcc, s68, v122
s_nop 1
v_addc_co_u32 v121, vcc, 0, v121, vcc
global_load_dword v124, v[120:121], off
s_cmp_eq_u32 s35, 0
s_cselect_b32 s40, s40, s42
s_cselect_b32 s41, s41, s43
s_lshl_b32 s3, s34, 9
s_add_u32 s12, s40, s3
s_addc_u32 s13, s41, 0
s_and_b32 s13, s13, 0xffff
s_mov_b32 s14, 0
s_mov_b32 s15, 0x20000
s_sub_u32 s14, 4194304, s3
s_lshl_b32 s3, s33, 18
s_add_u32 s8, s6, s3
s_addc_u32 s9, s7, 0
s_and_b32 s9, s9, 0xffff
s_mov_b32 s10, 262144
s_mov_b32 s11, 0x20000
s_add_u32 m0, s57, 0
s_nop 0
buffer_load_dwordx4 v6, s[12:15], s52 offen offset:0 nt lds
buffer_load_dwordx4 v7, s[12:15], s53 offen offset:1024 nt lds
buffer_load_dwordx4 v6, s[12:15], s54 offen offset:2048 nt lds
buffer_load_dwordx4 v7, s[12:15], s55 offen offset:3072 nt lds
s_add_u32 m0, s57, 4096
s_nop 0
buffer_load_dwordx4 v8, s[12:15], s52 offen offset:0 nt lds
buffer_load_dwordx4 v9, s[12:15], s53 offen offset:1024 nt lds
buffer_load_dwordx4 v8, s[12:15], s54 offen offset:2048 nt lds
buffer_load_dwordx4 v9, s[12:15], s55 offen offset:3072 nt lds
s_mov_b32 s28, s44
s_and_b32 s29, s45, 0xffff
s_mov_b32 s30, 2048
s_mov_b32 s31, 0x20000
s_mov_b32 s20, s66
s_and_b32 s21, s67, 0xffff
s_mov_b32 s22, 8388608
s_mov_b32 s23, 0x20000
s_add_u32 s24, s66, 8388608
s_addc_u32 s25, s67, 0
s_and_b32 s25, s25, 0xffff
s_mov_b32 s26, 35717120
s_mov_b32 s27, 0x20000
v_and_b32 v30, 15, v0
s_lshr_b32 s3, s32, 1
s_lshl_b32 s3, s3, 14
v_lshlrev_b32 v31, 7, v30
v_add_u32 v31, s3, v31
v_lshrrev_b32 v34, 1, v30
v_xor_b32_e64 v34, v34, v32
v_lshl_add_u32 v10, v34, 4, v31
v_xor_b32_e64 v34, 4, v34
v_lshl_add_u32 v11, v34, 4, v31
v_lshrrev_b32_e64 v30, 2, v30
v_lshl_add_u32 v31, v32, 3, v30
v_lshlrev_b32 v31, 9, v31
v_and_b32 v34, 3, v0
v_lshl_add_u32 v31, v34, 3, v31
s_and_b32 s3, s32, 1
s_lshl_b32 s3, s3, 8
s_add_u32 s3, s3, 32768
v_add_u32 v31, s3, v31
v_and_b32 v34, 1, v32
v_lshl_add_u32 v30, v34, 2, v30
v_xor_b32_e64 v34, 0, v30
v_lshl_add_u32 v12, v34, 5, v31
v_xor_b32_e64 v34, 1, v30
v_lshl_add_u32 v13, v34, 5, v31
v_xor_b32_e64 v34, 2, v30
v_lshl_add_u32 v14, v34, 5, v31
v_xor_b32_e64 v34, 3, v30
v_lshl_add_u32 v15, v34, 5, v31
v_xor_b32_e64 v34, 4, v30
v_lshl_add_u32 v16, v34, 5, v31
v_xor_b32_e64 v34, 5, v30
v_lshl_add_u32 v17, v34, 5, v31
v_xor_b32_e64 v34, 6, v30
v_lshl_add_u32 v18, v34, 5, v31
v_xor_b32_e64 v34, 7, v30
v_lshl_add_u32 v19, v34, 5, v31
v_add_u32 v20, 65536, v10
v_add_u32 v21, 65536, v11
v_add_u32 v22, 65536, v12
v_add_u32 v23, 65536, v13
v_add_u32 v24, 65536, v14
v_add_u32 v25, 65536, v15
v_add_u32 v26, 65536, v16
v_add_u32 v27, 65536, v17
v_add_u32 v28, 65536, v18
v_add_u32 v29, 65536, v19
s_cmp_lt_u32 s32, 2
s_cselect_b32 s60, s8, s12
s_cselect_b32 s61, s9, s13
s_cselect_b32 s62, s10, s14
s_mov_b32 s63, 0x20000
s_mov_b32 s59, 524288
s_cselect_b32 s59, 128, s59
s_lshr_b32 s3, s2, 6
s_lshl_b32 s3, s3, 1
s_add_u32 s3, s3, s32
s_lshl_b32 s3, s3, 15
s_add_u32 s3, s3, 256
v_lshlrev_b32 v37, 10, v0
v_add_u32 v37, s3, v37
v_lshrrev_b32 v38, 2, v0
v_lshlrev_b32 v38, 13, v38
v_and_b32_e64 v39, 3, v0
v_lshl_add_u32 v38, v39, 7, v38
s_lshl_b32 s39, s33, 1
s_add_u32 s39, s39, s32
s_lshl_b32 s39, s39, 15
s_add_u32 s39, s39, 983040
v_add_u32 v38, s39, v38
s_cmp_lt_u32 s32, 2
s_cselect_b64 vcc, -1, 0
s_cselect_b32 s3, 32, 16
v_cndmask_b32 v47, v38, v37, vcc
v_cmp_gt_u32 vcc, s3, v0
v_mov_b32 v37, 2146435072
s_nop 0
v_cndmask_b32 v47, v37, v47, vcc
s_add_u32 m0, s56, 0
s_nop 0
buffer_load_dwordx4 v2, s[8:11], s48 offen offset:0 lds
buffer_load_dwordx4 v3, s[8:11], s49 offen offset:1024 lds
buffer_load_dwordx4 v2, s[8:11], s50 offen offset:2048 lds
buffer_load_dwordx4 v3, s[8:11], s51 offen offset:3072 lds
s_add_u32 m0, s56, 4096
s_nop 0
buffer_load_dwordx4 v4, s[8:11], s48 offen offset:0 lds
buffer_load_dwordx4 v5, s[8:11], s49 offen offset:1024 lds
buffer_load_dwordx4 v4, s[8:11], s50 offen offset:2048 lds
buffer_load_dwordx4 v5, s[8:11], s51 offen offset:3072 lds
buffer_load_dwordx4 v[64:67], v36, s[28:31], 0 offen offset:0
buffer_load_dwordx4 v[68:71], v36, s[28:31], 0 offen offset:512
buffer_load_dwordx4 v[72:75], v36, s[28:31], 0 offen offset:1024
buffer_load_dwordx4 v[76:79], v36, s[28:31], 0 offen offset:1536
v_add_u32 v6, 524288, v6
v_add_u32 v7, 524288, v7
v_add_u32 v8, 524288, v8
v_add_u32 v9, 524288, v9
v_add_u32 v2, 128, v2
v_add_u32 v3, 128, v3
v_add_u32 v4, 128, v4
v_add_u32 v5, 128, v5
s_waitcnt vmcnt(21)
v_lshlrev_b32 v80, 16, v48
v_and_b32 v81, 0xffff0000, v48
v_lshlrev_b32_e64 v82, 16, v49
v_and_b32 v83, 0xffff0000, v49
v_lshlrev_b32_e64 v84, 16, v50
v_and_b32 v85, 0xffff0000, v50
v_lshlrev_b32_e64 v86, 16, v51
v_and_b32 v87, 0xffff0000, v51
v_lshlrev_b32_e64 v88, 16, v52
v_and_b32 v89, 0xffff0000, v52
v_lshlrev_b32_e64 v90, 16, v53
v_and_b32 v91, 0xffff0000, v53
v_lshlrev_b32_e64 v92, 16, v54
v_and_b32 v93, 0xffff0000, v54
v_lshlrev_b32_e64 v94, 16, v55
v_and_b32 v95, 0xffff0000, v55
v_lshlrev_b32_e64 v96, 16, v56
v_and_b32 v97, 0xffff0000, v56
v_lshlrev_b32_e64 v98, 16, v57
v_and_b32 v99, 0xffff0000, v57
v_lshlrev_b32_e64 v100, 16, v58
v_and_b32 v101, 0xffff0000, v58
v_lshlrev_b32_e64 v102, 16, v59
v_and_b32 v103, 0xffff0000, v59
v_lshlrev_b32_e64 v104, 16, v60
v_and_b32 v105, 0xffff0000, v60
v_lshlrev_b32_e64 v106, 16, v61
v_and_b32 v107, 0xffff0000, v61
v_lshlrev_b32_e64 v108, 16, v62
v_and_b32 v109, 0xffff0000, v62
v_lshlrev_b32_e64 v110, 16, v63
v_and_b32 v111, 0xffff0000, v63
v_pk_add_f32 v[40:41], v[80:81], v[82:83]
v_pk_add_f32 v[42:43], v[84:85], v[86:87]
v_pk_add_f32 v[40:41], v[40:41], v[88:89]
v_pk_add_f32 v[42:43], v[42:43], v[90:91]
v_pk_add_f32 v[40:41], v[40:41], v[92:93]
v_pk_add_f32 v[42:43], v[42:43], v[94:95]
v_pk_add_f32 v[40:41], v[40:41], v[96:97]
v_pk_add_f32 v[42:43], v[42:43], v[98:99]
v_pk_add_f32 v[40:41], v[40:41], v[100:101]
v_pk_add_f32 v[42:43], v[42:43], v[102:103]
v_pk_add_f32 v[40:41], v[40:41], v[104:105]
v_pk_add_f32 v[42:43], v[42:43], v[106:107]
v_pk_add_f32 v[40:41], v[40:41], v[108:109]
v_pk_add_f32 v[42:43], v[42:43], v[110:111]
v_pk_add_f32 v[40:41], v[40:41], v[42:43]
Va 38,40,41
s_nop 1
v_add_f32_dpp v38, v38, v38 quad_perm:[1,0,3,2] row_mask:0xf bank_mask:0xf
s_nop 1
v_add_f32_dpp v38, v38, v38 quad_perm:[2,3,0,1] row_mask:0xf bank_mask:0xf
s_nop 1
v_add_f32_dpp v38, v38, v38 row_half_mirror row_mask:0xf bank_mask:0xf
s_nop 1
v_add_f32_dpp v38, v38, v38 row_mirror row_mask:0xf bank_mask:0xf
v_mov_b32 v37, v38
s_nop 1
v_permlane16_swap_b32 v37, v38
v_add_f32_e64 v38, v38, v37
s_add_u32 m0, s57, 65536
s_nop 0
buffer_load_dwordx4 v6, s[12:15], s52 offen offset:0 nt lds
buffer_load_dwordx4 v7, s[12:15], s53 offen offset:1024 nt lds
buffer_load_dwordx4 v6, s[12:15], s54 offen offset:2048 nt lds
buffer_load_dwordx4 v7, s[12:15], s55 offen offset:3072 nt lds
s_add_u32 m0, s57, 69632
s_nop 0
buffer_load_dwordx4 v8, s[12:15], s52 offen offset:0 nt lds
buffer_load_dwordx4 v9, s[12:15], s53 offen offset:1024 nt lds
buffer_load_dwordx4 v8, s[12:15], s54 offen offset:2048 nt lds
buffer_load_dwordx4 v9, s[12:15], s55 offen offset:3072 nt lds
v_mul_f32 v38, 0xba800000, v38
v_mov_b32_e64 v39, v38
v_pk_add_f32 v[112:113], v[80:81], v[38:39]
v_pk_mul_f32 v[40:41], v[112:113], v[112:113]
v_pk_add_f32 v[114:115], v[82:83], v[38:39]
v_pk_mul_f32 v[42:43], v[114:115], v[114:115]
v_pk_add_f32 v[116:117], v[84:85], v[38:39]
v_pk_fma_f32 v[40:41], v[116:117], v[116:117], v[40:41]
v_pk_add_f32 v[118:119], v[86:87], v[38:39]
v_pk_fma_f32 v[42:43], v[118:119], v[118:119], v[42:43]
v_pk_add_f32 v[112:113], v[88:89], v[38:39]
v_pk_fma_f32 v[40:41], v[112:113], v[112:113], v[40:41]
v_pk_add_f32 v[114:115], v[90:91], v[38:39]
v_pk_fma_f32 v[42:43], v[114:115], v[114:115], v[42:43]
v_pk_add_f32 v[116:117], v[92:93], v[38:39]
v_pk_fma_f32 v[40:41], v[116:117], v[116:117], v[40:41]
v_pk_add_f32 v[118:119], v[94:95], v[38:39]
v_pk_fma_f32 v[42:43], v[118:119], v[118:119], v[42:43]
v_pk_add_f32 v[112:113], v[96:97], v[38:39]
v_pk_fma_f32 v[40:41], v[112:113], v[112:113], v[40:41]
v_pk_add_f32 v[114:115], v[98:99], v[38:39]
v_pk_fma_f32 v[42:43], v[114:115], v[114:115], v[42:43]
v_pk_add_f32 v[116:117], v[100:101], v[38:39]
v_pk_fma_f32 v[40:41], v[116:117], v[116:117], v[40:41]
v_pk_add_f32 v[118:119], v[102:103], v[38:39]
v_pk_fma_f32 v[42:43], v[118:119], v[118:119], v[42:43]
v_pk_add_f32 v[112:113], v[104:105], v[38:39]
v_pk_fma_f32 v[40:41], v[112:113], v[112:113], v[40:41]
v_pk_add_f32 v[114:115], v[106:107], v[38:39]
v_pk_fma_f32 v[42:43], v[114:115], v[114:115], v[42:43]
v_pk_add_f32 v[116:117], v[108:109], v[38:39]
v_pk_fma_f32 v[40:41], v[116:117], v[116:117], v[40:41]
v_pk_add_f32 v[118:119], v[110:111], v[38:39]
v_pk_fma_f32 v[42:43], v[118:119], v[118:119], v[42:43]
v_pk_add_f32 v[40:41], v[40:41], v[42:43]
Va 40,40,41
s_nop 1
v_add_f32_dpp v40, v40, v40 quad_perm:[1,0,3,2] row_mask:0xf bank_mask:0xf
s_nop 1
v_add_f32_dpp v40, v40, v40 quad_perm:[2,3,0,1] row_mask:0xf bank_mask:0xf
s_nop 1
v_add_f32_dpp v40, v40, v40 row_half_mirror row_mask:0xf bank_mask:0xf
s_nop 1
v_add_f32_dpp v40, v40, v40 row_mirror row_mask:0xf bank_mask:0xf
v_mov_b32 v37, v40
s_nop 1
v_permlane16_swap_b32 v37, v40
v_add_f32_e64 v40, v40, v37
s_add_u32 m0, s56, 65536
s_nop 0
buffer_load_dwordx4 v2, s[8:11], s48 offen offset:0 lds
buffer_load_dwordx4 v3, s[8:11], s49 offen offset:1024 lds
buffer_load_dwordx4 v2, s[8:11], s50 offen offset:2048 lds
buffer_load_dwordx4 v3, s[8:11], s51 offen offset:3072 lds
s_add_u32 m0, s56, 69632
s_nop 0
buffer_load_dwordx4 v4, s[8:11], s48 offen offset:0 lds
buffer_load_dwordx4 v5, s[8:11], s49 offen offset:1024 lds
buffer_load_dwordx4 v4, s[8:11], s50 offen offset:2048 lds
buffer_load_dwordx4 v5, s[8:11], s51 offen offset:3072 lds
v_mul_f32 v40, 0x3a800000, v40
Vc 44,38,40
v_lshlrev_b32_e64 v38, 16, v44
v_and_b32 v40, 0xffff0000, v44
v_add_f32 v40, 0x3727c5ac, v40
Vc 44,40,40
v_lshlrev_b32 v40, 16, v44
v_sqrt_f32 v40, v40
v_mov_b32_e64 v39, v38
Vc 44,40,40
v_lshlrev_b32 v44, 16, v44
v_rcp_f32 v40, v44
v_pk_add_f32 v[80:81], v[80:81], v[38:39]
v_pk_add_f32 v[82:83], v[82:83], v[38:39]
v_pk_add_f32 v[84:85], v[84:85], v[38:39]
v_pk_add_f32 v[86:87], v[86:87], v[38:39]
v_pk_add_f32 v[88:89], v[88:89], v[38:39]
v_pk_add_f32 v[90:91], v[90:91], v[38:39]
v_pk_add_f32 v[92:93], v[92:93], v[38:39]
v_pk_add_f32 v[94:95], v[94:95], v[38:39]
v_pk_add_f32 v[96:97], v[96:97], v[38:39]
v_pk_add_f32 v[98:99], v[98:99], v[38:39]
v_pk_add_f32 v[100:101], v[100:101], v[38:39]
v_pk_add_f32 v[102:103], v[102:103], v[38:39]
v_pk_add_f32 v[104:105], v[104:105], v[38:39]
v_pk_add_f32 v[106:107], v[106:107], v[38:39]
v_pk_add_f32 v[108:109], v[108:109], v[38:39]
v_pk_add_f32 v[110:111], v[110:111], v[38:39]
v_fma_f32 v45, -v44, v40, 1.0
v_fma_f32 v40, v45, v40, v40
v_mov_b32_e64 v41, v40
Vc 48,80,81
Vc 49,82,83
Vc 50,84,85
Vc 51,86,87
Vc 52,88,89
Vc 53,90,91
Vc 54,92,93
Vc 55,94,95
Vc 56,96,97
Vc 57,98,99
Vc 58,100,101
Vc 59,102,103
Vc 60,104,105
Vc 61,106,107
Vc 62,108,109
Vc 63,110,111
v_lshlrev_b32_e64 v80, 16, v48
v_and_b32 v81, 0xffff0000, v48
v_lshlrev_b32_e64 v82, 16, v49
v_and_b32 v83, 0xffff0000, v49
v_lshlrev_b32_e64 v84, 16, v50
v_and_b32 v85, 0xffff0000, v50
v_lshlrev_b32_e64 v86, 16, v51
v_and_b32 v87, 0xffff0000, v51
v_lshlrev_b32_e64 v88, 16, v52
v_and_b32 v89, 0xffff0000, v52
v_lshlrev_b32_e64 v90, 16, v53
v_and_b32 v91, 0xffff0000, v53
v_lshlrev_b32_e64 v92, 16, v54
v_and_b32 v93, 0xffff0000, v54
v_lshlrev_b32_e64 v94, 16, v55
v_and_b32 v95, 0xffff0000, v55
v_lshlrev_b32_e64 v96, 16, v56
v_and_b32 v97, 0xffff0000, v56
v_lshlrev_b32_e64 v98, 16, v57
v_and_b32 v99, 0xffff0000, v57
v_lshlrev_b32_e64 v100, 16, v58
v_and_b32 v101, 0xffff0000, v58
v_lshlrev_b32_e64 v102, 16, v59
v_and_b32 v103, 0xffff0000, v59
v_lshlrev_b32_e64 v104, 16, v60
v_and_b32 v105, 0xffff0000, v60
v_lshlrev_b32_e64 v106, 16, v61
v_and_b32 v107, 0xffff0000, v61
v_lshlrev_b32_e64 v108, 16, v62
v_and_b32 v109, 0xffff0000, v62
v_lshlrev_b32_e64 v110, 16, v63
v_and_b32 v111, 0xffff0000, v63
v_pk_mul_f32 v[80:81], v[80:81], v[40:41]
v_pk_mul_f32 v[82:83], v[82:83], v[40:41]
v_pk_mul_f32 v[84:85], v[84:85], v[40:41]
v_pk_mul_f32 v[86:87], v[86:87], v[40:41]
v_pk_mul_f32 v[88:89], v[88:89], v[40:41]
v_pk_mul_f32 v[90:91], v[90:91], v[40:41]
v_pk_mul_f32 v[92:93], v[92:93], v[40:41]
v_pk_mul_f32 v[94:95], v[94:95], v[40:41]
v_pk_mul_f32 v[96:97], v[96:97], v[40:41]
v_pk_mul_f32 v[98:99], v[98:99], v[40:41]
v_pk_mul_f32 v[100:101], v[100:101], v[40:41]
v_pk_mul_f32 v[102:103], v[102:103], v[40:41]
v_pk_mul_f32 v[104:105], v[104:105], v[40:41]
v_pk_mul_f32 v[106:107], v[106:107], v[40:41]
v_pk_mul_f32 v[108:109], v[108:109], v[40:41]
v_pk_mul_f32 v[110:111], v[110:111], v[40:41]
Vc 48,80,81
Vc 49,82,83
Vc 50,84,85
Vc 51,86,87
Vc 52,88,89
Vc 53,90,91
Vc 54,92,93
Vc 55,94,95
Vc 56,96,97
Vc 57,98,99
Vc 58,100,101
Vc 59,102,103
Vc 60,104,105
Vc 61,106,107
Vc 62,108,109
Vc 63,110,111
s_mul_i32 s3, s32, 4128
s_add_u32 s3, s3, 131072
v_mul_u32_u24 v42, 2064, v33
v_add3_u32 v42, v42, v36, s3
ds_write_b128 v42, v[48:51] offset:0
ds_write_b128 v42, v[52:55] offset:512
ds_write_b128 v42, v[56:59] offset:1024
ds_write_b128 v42, v[60:63] offset:1536
v_add_u32 v6, 524288, v6
v_add_u32 v7, 524288, v7
v_add_u32 v8, 524288, v8
v_add_u32 v9, 524288, v9
v_add_u32 v2, 128, v2
v_add_u32 v3, 128, v3
v_add_u32 v4, 128, v4
v_add_u32 v5, 128, v5
buffer_load_dword v1, v47, s[60:63], 0 offen
v_add_u32_e64 v47, s59, v47
buffer_load_dword v1, v47, s[60:63], 0 offen
v_add_u32_e64 v47, s59, v47
buffer_load_dword v1, v47, s[60:63], 0 offen
v_add_u32_e64 v47, s59, v47
buffer_load_dword v1, v47, s[60:63], 0 offen
v_add_u32 v47, s59, v47
s_waitcnt vmcnt(20)
v_lshlrev_b32_e64 v80, 16, v48
v_and_b32 v81, 0xffff0000, v48
v_lshlrev_b32_e64 v112, 16, v64
v_and_b32 v113, 0xffff0000, v64
v_pk_mul_f32 v[42:43], v[80:81], v[112:113]
v_lshlrev_b32_e64 v82, 16, v49
v_and_b32 v83, 0xffff0000, v49
v_lshlrev_b32_e64 v114, 16, v65
v_and_b32 v115, 0xffff0000, v65
v_pk_mul_f32 v[44:45], v[82:83], v[114:115]
v_lshlrev_b32_e64 v84, 16, v50
v_and_b32 v85, 0xffff0000, v50
v_lshlrev_b32_e64 v116, 16, v66
v_and_b32 v117, 0xffff0000, v66
v_pk_fma_f32 v[42:43], v[84:85], v[116:117], v[42:43]
v_lshlrev_b32_e64 v86, 16, v51
v_and_b32 v87, 0xffff0000, v51
v_lshlrev_b32_e64 v118, 16, v67
v_and_b32 v119, 0xffff0000, v67
v_pk_fma_f32 v[44:45], v[86:87], v[118:119], v[44:45]
v_lshlrev_b32_e64 v88, 16, v52
v_and_b32 v89, 0xffff0000, v52
v_lshlrev_b32_e64 v112, 16, v68
v_and_b32 v113, 0xffff0000, v68
v_pk_fma_f32 v[42:43], v[88:89], v[112:113], v[42:43]
v_lshlrev_b32_e64 v90, 16, v53
v_and_b32 v91, 0xffff0000, v53
v_lshlrev_b32_e64 v114, 16, v69
v_and_b32 v115, 0xffff0000, v69
v_pk_fma_f32 v[44:45], v[90:91], v[114:115], v[44:45]
v_lshlrev_b32_e64 v92, 16, v54
v_and_b32 v93, 0xffff0000, v54
v_lshlrev_b32_e64 v116, 16, v70
v_and_b32 v117, 0xffff0000, v70
v_pk_fma_f32 v[42:43], v[92:93], v[116:117], v[42:43]
v_lshlrev_b32_e64 v94, 16, v55
v_and_b32 v95, 0xffff0000, v55
v_lshlrev_b32_e64 v118, 16, v71
v_and_b32 v119, 0xffff0000, v71
v_pk_fma_f32 v[44:45], v[94:95], v[118:119], v[44:45]
v_lshlrev_b32_e64 v96, 16, v56
v_and_b32 v97, 0xffff0000, v56
v_lshlrev_b32_e64 v112, 16, v72
v_and_b32 v113, 0xffff0000, v72
v_pk_fma_f32 v[42:43], v[96:97], v[112:113], v[42:43]
v_lshlrev_b32_e64 v98, 16, v57
v_and_b32 v99, 0xffff0000, v57
v_lshlrev_b32_e64 v114, 16, v73
v_and_b32 v115, 0xffff0000, v73
v_pk_fma_f32 v[44:45], v[98:99], v[114:115], v[44:45]
v_lshlrev_b32_e64 v100, 16, v58
v_and_b32 v101, 0xffff0000, v58
v_lshlrev_b32_e64 v116, 16, v74
v_and_b32 v117, 0xffff0000, v74
v_pk_fma_f32 v[42:43], v[100:101], v[116:117], v[42:43]
v_lshlrev_b32_e64 v102, 16, v59
v_and_b32 v103, 0xffff0000, v59
v_lshlrev_b32_e64 v118, 16, v75
v_and_b32 v119, 0xffff0000, v75
v_pk_fma_f32 v[44:45], v[102:103], v[118:119], v[44:45]
v_lshlrev_b32_e64 v104, 16, v60
v_and_b32 v105, 0xffff0000, v60
v_lshlrev_b32_e64 v112, 16, v76
v_and_b32 v113, 0xffff0000, v76
v_pk_fma_f32 v[42:43], v[104:105], v[112:113], v[42:43]
v_lshlrev_b32_e64 v106, 16, v61
v_and_b32 v107, 0xffff0000, v61
v_lshlrev_b32_e64 v114, 16, v77
v_and_b32 v115, 0xffff0000, v77
v_pk_fma_f32 v[44:45], v[106:107], v[114:115], v[44:45]
v_lshlrev_b32_e64 v108, 16, v62
v_and_b32 v109, 0xffff0000, v62
v_lshlrev_b32_e64 v116, 16, v78
v_and_b32 v117, 0xffff0000, v78
v_pk_fma_f32 v[42:43], v[108:109], v[116:117], v[42:43]
v_lshlrev_b32_e64 v110, 16, v63
v_and_b32 v111, 0xffff0000, v63
v_lshlrev_b32_e64 v118, 16, v79
v_and_b32 v119, 0xffff0000, v79
v_pk_fma_f32 v[44:45], v[110:111], v[118:119], v[44:45]
v_pk_add_f32 v[42:43], v[42:43], v[44:45]
Va 45,42,43
s_nop 1
v_add_f32_dpp v45, v45, v45 quad_perm:[1,0,3,2] row_mask:0xf bank_mask:0xf
s_nop 1
v_add_f32_dpp v45, v45, v45 quad_perm:[2,3,0,1] row_mask:0xf bank_mask:0xf
s_nop 1
v_add_f32_dpp v45, v45, v45 row_half_mirror row_mask:0xf bank_mask:0xf
s_nop 1
v_add_f32_dpp v45, v45, v45 row_mirror row_mask:0xf bank_mask:0xf
v_mov_b32 v37, v45
s_nop 1
v_permlane16_swap_b32 v37, v45
v_add_f32_e64 v45, v45, v37
Vc 45,45,45
v_ashrrev_i32_e64 v46, 31, v45
v_or_b32 v46, 0x80000000, v46
v_xor_b32_e64 v45, v45, v46
v_and_b32 v45, 0xffff0000, v45
s_lshr_b32 s3, s36, 11
v_add_u32 v46, s3, v33
v_sub_u32 v44, 0xffff, v46
v_or_b32 v45, v45, v44
v_lshlrev_b32 v44, 2, v46
v_lshlrev_b32_e64 v46, 3, v46
v_xor_b32 v38, 0x80000000, v38
v_mov_b32_e64 v39, v40
s_mov_b32 s3, 5242880
s_mov_b32 s39, 5259264
s_mov_b32 exec_lo, 1
s_mov_b32 exec_hi, 1
buffer_store_dword v45, v44, s[20:23], s3 offen sc1
buffer_store_dwordx2 v[38:39], v46, s[20:23], s39 offen sc1
s_mov_b64 exec, -1
s_load_dwordx2 s[4:5], s[0:1], 16
s_load_dwordx4 s[40:43], s[0:1], 64
s_load_dwordx2 s[92:93], s[0:1], 40
s_load_dwordx2 s[94:95], s[0:1], 80
s_load_dwordx2 s[100:101], s[0:1], 0
s_mov_b32 s28, s64
s_and_b32 s29, s65, 0xffff
s_mov_b32 s30, 256
s_mov_b32 s31, 0x20000
s_waitcnt lgkmcnt(0)
s_barrier
Ta 32,12,0
Ta 34,12,2048
Ra 0,10,0
Ta 36,13,0
Ta 38,13,2048
Ra 4,10,2048
Ta 40,14,0
Ta 42,14,2048
Ra 8,10,4096
Ta 44,15,0
Ta 46,15,2048
Ra 12,10,6144
s_waitcnt lgkmcnt(2)
s_nop 0
Ta 48,16,0
Ta 50,16,2048
Ra 16,10,8192
Ta 52,17,0
Ta 54,17,2048
Ra 20,10,10240
Ta 56,18,0
Ta 58,18,2048
Ra 24,10,12288
Ta 60,19,0
Ta 62,19,2048
Ra 28,10,14336
s_cmp_lg_u32 s35, 0
s_cbranch_scc1 L_k1_vpath
s_waitcnt lgkmcnt(0)
Zvaa 48,32,0
v_and_b32 v46, 7, v0
v_mul_u32_u24 v30, 2064, v46
Zvaa 52,36,0
Ta 96,12,16384
Ta 98,12,18432
Zvaa 56,40,0
v_lshrrev_b32_e64 v31, 3, v0
Zvaa 60,44,0
Ra 64,11,0
Zvaa 64,48,0
s_lshl_b32 s3, s32, 9
s_add_u32 s3, s3, 131072
v_lshl_add_u32 v30, v31, 4, v30
Zvaa 68,52,0
Ta 100,13,16384
Ta 102,13,18432
Zvaa 72,56,0
v_add_u32 v30, s3, v30
v_lshlrev_b32_e64 v31, 8, v31
Zvaa 76,60,0
s_waitcnt lgkmcnt(6)
Ra 68,11,2048
Zvaa 80,32,4
v_lshl_add_u32 v46, v46, 4, v31
Zvaa 84,36,4
Ta 104,14,16384
Ta 106,14,18432
Zvaa 88,40,4
Rv 34,30,128
Rv 38,30,256
Zvaa 92,44,4
Ra 72,11,4096
Zvaa 96,48,4
Rv 42,30,384
Rv 30,30,0
Zvaa 100,52,4
Ta 108,15,16384
Ta 110,15,18432
Zvaa 104,56,4
s_lshr_b32 s3, s2, 1
s_mul_i32 s3, s3, 33792
s_add_u32 s3, s3, s56
Zvaa 108,60,4
s_waitcnt lgkmcnt(6)
Ra 76,11,6144
Zvaa 112,32,8
s_and_b32 s39, s2, 1
s_lshl_b32 s39, s39, 7
s_add_u32 s3, s3, s39
Zvaa 116,36,8
Ta 112,16,16384
Ta 114,16,18432
Zvaa 120,40,8
s_add_u32 s39, s3, 4096
Zvaa 124,44,8
Ra 80,11,8192
Zvaa 128,48,8
Zvaa 132,52,8
Ta 116,17,16384
Ta 118,17,18432
Zvaa 136,56,8
Zvaa 140,60,8
s_waitcnt lgkmcnt(6)
Ra 84,11,10240
Zvaa 144,32,12
Zvaa 148,36,12
Ta 120,18,16384
Ta 122,18,18432
Zvaa 152,40,12
Zvaa 156,44,12
Ra 88,11,12288
Zvaa 160,48,12
Zvaa 164,52,12
Ta 124,19,16384
Ta 126,19,18432
Zvaa 168,56,12
Zvaa 172,60,12
s_waitcnt lgkmcnt(6)
Ra 92,11,14336
Zvaa 176,32,16
Zvaa 180,36,16
Zvaa 184,40,16
Zvaa 188,44,16
Zvaa 192,48,16
Zvaa 196,52,16
Zvaa 200,56,16
Zvaa 204,60,16
Zvaa 208,32,20
Zvaa 212,36,20
Zvaa 216,40,20
Zvaa 220,44,20
Zvaa 224,48,20
Zvaa 228,52,20
Zvaa 232,56,20
Zvaa 236,60,20
Zvaa 240,32,24
Zvaa 244,36,24
Zvaa 248,40,24
Zvaa 252,44,24
Zaaa 128,48,24
Zaaa 132,52,24
Zaaa 136,56,24
Zaaa 140,60,24
Zaaa 144,32,28
Zaaa 148,36,28
Zaaa 152,40,28
Zaaa 156,44,28
Zaaa 160,48,28
Zaaa 164,52,28
Zaaa 168,56,28
Zaaa 172,60,28
s_waitcnt vmcnt(6) lgkmcnt(0)
s_add_u32 m0, s57, 0
s_barrier
Mvaa 48,96,64
buffer_load_dwordx4 v6, s[12:15], s52 offen offset:0 nt lds
Mvaa 52,100,64
Ta 32,22,0
Ta 34,22,2048
Mvaa 56,104,64
Mvaa 60,108,64
Ra 0,20,0
Mvaa 64,112,64
buffer_load_dwordx4 v7, s[12:15], s53 offen offset:1024 nt lds
Mvaa 68,116,64
s_waitcnt lgkmcnt(6)
Ta 36,23,0
Ta 38,23,2048
Mvaa 72,120,64
Mvaa 76,124,64
Ra 4,20,2048
Mvaa 80,96,68
buffer_load_dwordx4 v6, s[12:15], s54 offen offset:2048 nt lds
Mvaa 84,100,68
Ta 40,24,0
Ta 42,24,2048
Mvaa 88,104,68
Mvaa 92,108,68
Ra 8,20,4096
Mvaa 96,112,68
buffer_load_dwordx4 v7, s[12:15], s55 offen offset:3072 nt lds
Mvaa 100,116,68
s_waitcnt lgkmcnt(6)
Ta 44,25,0
Ta 46,25,2048
Mvaa 104,120,68
Mvaa 108,124,68
s_add_u32 m0, s57, 4096
Ra 12,20,6144
Mvaa 112,96,72
buffer_load_dwordx4 v8, s[12:15], s52 offen offset:0 nt lds
Mvaa 116,100,72
Ta 48,26,0
Ta 50,26,2048
Mvaa 120,104,72
Mvaa 124,108,72
Ra 16,20,8192
Mvaa 128,112,72
buffer_load_dwordx4 v9, s[12:15], s53 offen offset:1024 nt lds
Mvaa 132,116,72
s_waitcnt lgkmcnt(6)
Ta 52,27,0
Ta 54,27,2048
Mvaa 136,120,72
Mvaa 140,124,72
Ra 20,20,10240
Mvaa 144,96,76
buffer_load_dwordx4 v8, s[12:15], s54 offen offset:2048 nt lds
Mvaa 148,100,76
Ta 56,28,0
Ta 58,28,2048
Mvaa 152,104,76
Mvaa 156,108,76
Ra 24,20,12288
Mvaa 160,112,76
buffer_load_dwordx4 v9, s[12:15], s55 offen offset:3072 nt lds
Mvaa 164,116,76
s_waitcnt lgkmcnt(6)
Ta 60,29,0
Ta 62,29,2048
Mvaa 168,120,76
v_add_u32 v6, 524288, v6
v_add_u32 v7, 524288, v7
Mvaa 172,124,76
s_add_u32 m0, s56, 0
Ra 28,20,14336
v_add_u32 v8, 524288, v8
Mvaa 176,96,80
buffer_load_dwordx4 v2, s[8:11], s48 offen offset:0 lds
Mvaa 180,100,80
v_add_u32 v9, 524288, v9
Mvaa 184,104,80
Mvaa 188,108,80
Mvaa 192,112,80
buffer_load_dwordx4 v3, s[8:11], s49 offen offset:1024 lds
Mvaa 196,116,80
Mvaa 200,120,80
Mvaa 204,124,80
Mvaa 208,96,84
buffer_load_dwordx4 v2, s[8:11], s50 offen offset:2048 lds
Mvaa 212,100,84
Mvaa 216,104,84
Mvaa 220,108,84
Mvaa 224,112,84
buffer_load_dwordx4 v3, s[8:11], s51 offen offset:3072 lds
Mvaa 228,116,84
Mvaa 232,120,84
Mvaa 236,124,84
s_add_u32 m0, s56, 4096
Mvaa 240,96,88
buffer_load_dwordx4 v4, s[8:11], s48 offen offset:0 lds
Mvaa 244,100,88
Mvaa 248,104,88
Mvaa 252,108,88
Maaa 128,112,88
buffer_load_dwordx4 v5, s[8:11], s49 offen offset:1024 lds
Maaa 132,116,88
Maaa 136,120,88
Maaa 140,124,88
Maaa 144,96,92
buffer_load_dwordx4 v4, s[8:11], s50 offen offset:2048 lds
Maaa 148,100,92
Maaa 152,104,92
Maaa 156,108,92
Maaa 160,112,92
buffer_load_dwordx4 v5, s[8:11], s51 offen offset:3072 lds
Maaa 164,116,92
v_add_u32 v2, 128, v2
v_add_u32 v3, 128, v3
Maaa 168,120,92
buffer_load_dword v1, v47, s[60:63], 0 offen
v_add_u32 v4, 128, v4
v_add_u32 v5, 128, v5
Maaa 172,124,92
v_add_u32 v47, s59, v47
s_waitcnt lgkmcnt(0)
Mvaa 48,32,0
buffer_store_dwordx4 v[30:33], v46, s[20:23], s3 offen offset:0 sc1
Mvaa 52,36,0
Ta 96,22,16384
Ta 98,22,18432
Mvaa 56,40,0
buffer_store_dwordx4 v[34:37], v46, s[20:23], s3 offen offset:2048 sc1
Mvaa 60,44,0
Ra 64,21,0
Mvaa 64,48,0
buffer_store_dwordx4 v[38:41], v46, s[20:23], s39 offen offset:0 sc1
Mvaa 68,52,0
Ta 100,23,16384
Ta 102,23,18432
Mvaa 72,56,0
buffer_store_dwordx4 v[42:45], v46, s[20:23], s39 offen offset:2048 sc1
Mvaa 76,60,0
s_waitcnt lgkmcnt(6)
Ra 68,21,2048
Mvaa 80,32,4
s_lshl_b32 s3, s34, 1
s_and_b32 s36, s32, 1
s_add_u32 s3, s3, s36
Mvaa 84,36,4
Ta 104,24,16384
Ta 106,24,18432
Mvaa 88,40,4
s_mul_i32 s3, s3, 1116160
s_mul_i32 s36, s33, 139264
s_add_u32 s3, s3, s36
Mvaa 92,44,4
Ra 72,21,4096
Mvaa 96,48,4
s_lshr_b32 s36, s32, 1
s_mul_i32 s36, s36, 69632
s_add_u32 s3, s3, s36
Mvaa 100,52,4
Ta 108,25,16384
Ta 110,25,18432
Mvaa 104,56,4
s_add_u32 s38, s3, 0
s_lshl_b32 s39, s34, 7
s_lshl_b32 s36, s33, 2
Mvaa 108,60,4
s_waitcnt lgkmcnt(6)
Ra 76,21,6144
Mvaa 112,32,8
s_add_u32 s39, s39, s36
s_add_u32 s39, s39, 5296128
v_mov_b32 v30, 1
Mvaa 116,36,8
Ta 112,26,16384
Ta 114,26,18432
Mvaa 120,40,8
v_mov_b32_e64 v31, 0
Mvaa 124,44,8
Ra 80,21,8192
Mvaa 128,48,8
s_cmp_eq_u32 s32, 0
s_cselect_b32 s39, s39, 2146435072
Mvaa 132,52,8
Ta 116,27,16384
Ta 118,27,18432
Mvaa 136,56,8
s_mov_b64 exec, 1
buffer_store_dword v31, v31, s[20:23], s39 offen sc1
s_mov_b64 exec, -1
Mvaa 140,60,8
s_waitcnt lgkmcnt(6)
Ra 84,21,10240
Mvaa 144,32,12
s_and_b32 s33, s2, 7
s_lshl_b32 s33, s33, 2
s_bfe_u32 s3, s2, 0x20003
Mvaa 148,36,12
Ta 120,28,16384
Ta 122,28,18432
Mvaa 152,40,12
s_add_u32 s33, s33, s3
s_lshr_b32 s34, s2, 5
s_lshl_b32 s64, s34, 7
Mvaa 156,44,12
Ra 88,21,12288
Mvaa 160,48,12
s_lshl_b32 s3, s33, 2
s_add_u32 s64, s64, s3
s_add_u32 s64, s64, 5300224
Mvaa 164,52,12
Ta 124,29,16384
Ta 126,29,18432
Mvaa 168,56,12
s_lshl_b32 s65, s34, 8
s_sub_u32 s65, 1920, s65
v_mul_u32_u24_e64 v32, s65, v0
Mvaa 172,60,12
s_waitcnt lgkmcnt(6)
Ra 92,21,14336
Mvaa 176,32,16
s_cmp_eq_u32 s32, 0
s_cselect_b32 s64, s64, 2146435072
Mvaa 180,36,16
s_mov_b64 exec, 3
buffer_store_dword v31, v32, s[20:23], s64 offen sc1
s_mov_b64 exec, -1
Mvaa 184,40,16
s_lshl_b32 s35, s34, 1
s_sub_u32 s36, 32, s35
s_add_u32 s35, s35, 2
Mvaa 188,44,16
s_lshl_b32 s44, s32, 12
s_mov_b32 s58, 33792
s_sub_u32 s3, 15, s34
Mvaa 192,48,16
s_lshl_b32 s45, s3, 2
s_add_u32 s45, s45, s32
s_lshl_b32 s46, s34, 2
Mvaa 196,52,16
s_add_u32 s46, s46, s32
s_mov_b32 s68, s42
s_and_b32 s69, s43, 0xffff
Mvaa 200,56,16
s_mov_b32 s70, 7340032
s_mov_b32 s71, 0x20000
s_cmp_eq_u32 s32, 0
s_cselect_b32 s37, 0, 2146435072
Mvaa 204,60,16
s_lshl_b32 s3, s33, 8
s_add_u32 s16, s4, s3
s_addc_u32 s17, s5, 0
s_and_b32 s17, s17, 0xffff
Mvaa 208,32,20
s_mov_b32 s18, 0
s_mov_b32 s19, 0x20000
s_sub_u32 s18, 8388608, s3
Mvaa 212,36,20
v_and_b32 v33, 63, v0
v_lshrrev_b32_e64 v32, 1, v33
Mvaa 216,40,20
v_and_b32 v33, 1, v0
v_lshlrev_b32 v32, 13, v32
Mvaa 220,44,20
v_lshl_add_u32 v45, v33, 7, v32
Mvaa 224,48,20
s_lshl_b32 s3, s32, 3
s_add_u32 s3, s3, s34
s_mul_i32 s47, s3, 262144
Mvaa 228,52,20
Mvaa 232,56,20
Mvaa 236,60,20
Mvaa 240,32,24
Mvaa 244,36,24
Mvaa 248,40,24
Mvaa 252,44,24
Maaa 128,48,24
Maaa 132,52,24
Maaa 136,56,24
Maaa 140,60,24
Maaa 144,32,28
Maaa 148,36,28
Maaa 152,40,28
Maaa 156,44,28
Maaa 160,48,28
Maaa 164,52,28
Maaa 168,56,28
Maaa 172,60,28
s_waitcnt vmcnt(7) lgkmcnt(0)
s_add_u32 m0, s57, 65536
s_barrier
Mvaa 48,96,64
buffer_load_dwordx4 v6, s[12:15], s52 offen offset:0 nt lds
Mvaa 52,100,64
Ta 32,12,0
Ta 34,12,2048
Mvaa 56,104,64
Mvaa 60,108,64
Ra 0,10,0
Mvaa 64,112,64
buffer_load_dwordx4 v7, s[12:15], s53 offen offset:1024 nt lds
Mvaa 68,116,64
s_waitcnt lgkmcnt(6)
Ta 36,13,0
Ta 38,13,2048
Mvaa 72,120,64
Mvaa 76,124,64
Ra 4,10,2048
Mvaa 80,96,68
buffer_load_dwordx4 v6, s[12:15], s54 offen offset:2048 nt lds
Mvaa 84,100,68
Ta 40,14,0
Ta 42,14,2048
Mvaa 88,104,68
Mvaa 92,108,68
Ra 8,10,4096
Mvaa 96,112,68
buffer_load_dwordx4 v7, s[12:15], s55 offen offset:3072 nt lds
Mvaa 100,116,68
s_waitcnt lgkmcnt(6)
Ta 44,15,0
Ta 46,15,2048
Mvaa 104,120,68
Mvaa 108,124,68
s_add_u32 m0, s57, 69632
Ra 12,10,6144
Mvaa 112,96,72
buffer_load_dwordx4 v8, s[12:15], s52 offen offset:0 nt lds
Mvaa 116,100,72
Ta 48,16,0
Ta 50,16,2048
Mvaa 120,104,72
Mvaa 124,108,72
Ra 16,10,8192
Mvaa 128,112,72
buffer_load_dwordx4 v9, s[12:15], s53 offen offset:1024 nt lds
Mvaa 132,116,72
s_waitcnt lgkmcnt(6)
Ta 52,17,0
Ta 54,17,2048
Mvaa 136,120,72
Mvaa 140,124,72
Ra 20,10,10240
Mvaa 144,96,76
buffer_load_dwordx4 v8, s[12:15], s54 offen offset:2048 nt lds
Mvaa 148,100,76
Ta 56,18,0
Ta 58,18,2048
Mvaa 152,104,76
Mvaa 156,108,76
Ra 24,10,12288
Mvaa 160,112,76
buffer_load_dwordx4 v9, s[12:15], s55 offen offset:3072 nt lds
Mvaa 164,116,76
s_waitcnt lgkmcnt(6)
Ta 60,19,0
Ta 62,19,2048
Mvaa 168,120,76
v_add_u32 v6, 524288, v6
v_add_u32 v7, 524288, v7
Mvaa 172,124,76
s_add_u32 m0, s56, 65536
Ra 28,10,14336
v_add_u32 v8, 524288, v8
Mvaa 176,96,80
buffer_load_dwordx4 v2, s[8:11], s48 offen offset:0 lds
Mvaa 180,100,80
v_add_u32 v9, 524288, v9
Mvaa 184,104,80
Mvaa 188,108,80
Mvaa 192,112,80
buffer_load_dwordx4 v3, s[8:11], s49 offen offset:1024 lds
Mvaa 196,116,80
Mvaa 200,120,80
Mvaa 204,124,80
Mvaa 208,96,84
buffer_load_dwordx4 v2, s[8:11], s50 offen offset:2048 lds
Mvaa 212,100,84
Mvaa 216,104,84
Mvaa 220,108,84
Mvaa 224,112,84
buffer_load_dwordx4 v3, s[8:11], s51 offen offset:3072 lds
Mvaa 228,116,84
Mvaa 232,120,84
Mvaa 236,124,84
s_add_u32 m0, s56, 69632
Mvaa 240,96,88
buffer_load_dwordx4 v4, s[8:11], s48 offen offset:0 lds
Mvaa 244,100,88
Mvaa 248,104,88
Mvaa 252,108,88
Maaa 128,112,88
buffer_load_dwordx4 v5, s[8:11], s49 offen offset:1024 lds
Maaa 132,116,88
Maaa 136,120,88
Maaa 140,124,88
Maaa 144,96,92
buffer_load_dwordx4 v4, s[8:11], s50 offen offset:2048 lds
Maaa 148,100,92
Maaa 152,104,92
Maaa 156,108,92
Maaa 160,112,92
buffer_load_dwordx4 v5, s[8:11], s51 offen offset:3072 lds
Maaa 164,116,92
v_add_u32 v2, 128, v2
v_add_u32 v3, 128, v3
Maaa 168,120,92
buffer_load_dword v1, v47, s[60:63], 0 offen
v_add_u32 v4, 128, v4
v_add_u32 v5, 128, v5
Maaa 172,124,92
v_add_u32 v47, s59, v47
s_waitcnt lgkmcnt(0)
Mvaa 48,32,0
Mvaa 52,36,0
Ta 96,12,16384
Ta 98,12,18432
Mvaa 56,40,0
Mvaa 60,44,0
Ra 64,11,0
Mvaa 64,48,0
Mvaa 68,52,0
Ta 100,13,16384
Ta 102,13,18432
Mvaa 72,56,0
Mvaa 76,60,0
s_waitcnt lgkmcnt(6)
Ra 68,11,2048
Mvaa 80,32,4
Mvaa 84,36,4
Ta 104,14,16384
Ta 106,14,18432
Mvaa 88,40,4
Mvaa 92,44,4
Ra 72,11,4096
Mvaa 96,48,4
Mvaa 100,52,4
Ta 108,15,16384
Ta 110,15,18432
Mvaa 104,56,4
Mvaa 108,60,4
s_waitcnt lgkmcnt(6)
Ra 76,11,6144
Mvaa 112,32,8
Mvaa 116,36,8
Ta 112,16,16384
Ta 114,16,18432
Mvaa 120,40,8
Mvaa 124,44,8
Ra 80,11,8192
Mvaa 128,48,8
Mvaa 132,52,8
Ta 116,17,16384
Ta 118,17,18432
Mvaa 136,56,8
Mvaa 140,60,8
s_waitcnt lgkmcnt(6)
Ra 84,11,10240
Mvaa 144,32,12
Mvaa 148,36,12
Ta 120,18,16384
Ta 122,18,18432
Mvaa 152,40,12
Mvaa 156,44,12
Ra 88,11,12288
Mvaa 160,48,12
Mvaa 164,52,12
Ta 124,19,16384
Ta 126,19,18432
Mvaa 168,56,12
Mvaa 172,60,12
s_waitcnt lgkmcnt(6)
Ra 92,11,14336
Mvaa 176,32,16
Mvaa 180,36,16
Mvaa 184,40,16
Mvaa 188,44,16
Mvaa 192,48,16
Mvaa 196,52,16
Mvaa 200,56,16
Mvaa 204,60,16
Mvaa 208,32,20
Mvaa 212,36,20
Mvaa 216,40,20
Mvaa 220,44,20
Mvaa 224,48,20
Mvaa 228,52,20
Mvaa 232,56,20
Mvaa 236,60,20
Mvaa 240,32,24
Mvaa 244,36,24
Mvaa 248,40,24
Mvaa 252,44,24
Maaa 128,48,24
Maaa 132,52,24
Maaa 136,56,24
Maaa 140,60,24
Maaa 144,32,28
Maaa 148,36,28
Maaa 152,40,28
Maaa 156,44,28
Maaa 160,48,28
Maaa 164,52,28
Maaa 168,56,28
Maaa 172,60,28
s_waitcnt vmcnt(1) lgkmcnt(0)
s_add_u32 m0, s57, 0
s_barrier
Mvaa 48,96,64
buffer_load_dwordx4 v6, s[12:15], s52 offen offset:0 nt lds
Mvaa 52,100,64
Ta 32,22,0
Ta 34,22,2048
Mvaa 56,104,64
Mvaa 60,108,64
Ra 0,20,0
Mvaa 64,112,64
buffer_load_dwordx4 v7, s[12:15], s53 offen offset:1024 nt lds
Mvaa 68,116,64
s_waitcnt lgkmcnt(6)
Ta 36,23,0
Ta 38,23,2048
Mvaa 72,120,64
Mvaa 76,124,64
Ra 4,20,2048
Mvaa 80,96,68
buffer_load_dwordx4 v6, s[12:15], s54 offen offset:2048 nt lds
Mvaa 84,100,68
Ta 40,24,0
Ta 42,24,2048
Mvaa 88,104,68
Mvaa 92,108,68
Ra 8,20,4096
Mvaa 96,112,68
buffer_load_dwordx4 v7, s[12:15], s55 offen offset:3072 nt lds
Mvaa 100,116,68
s_waitcnt lgkmcnt(6)
Ta 44,25,0
Ta 46,25,2048
Mvaa 104,120,68
Mvaa 108,124,68
s_add_u32 m0, s57, 4096
Ra 12,20,6144
Mvaa 112,96,72
buffer_load_dwordx4 v8, s[12:15], s52 offen offset:0 nt lds
Mvaa 116,100,72
Ta 48,26,0
Ta 50,26,2048
Mvaa 120,104,72
Mvaa 124,108,72
Ra 16,20,8192
Mvaa 128,112,72
buffer_load_dwordx4 v9, s[12:15], s53 offen offset:1024 nt lds
Mvaa 132,116,72
s_waitcnt lgkmcnt(6)
Ta 52,27,0
Ta 54,27,2048
Mvaa 136,120,72
Mvaa 140,124,72
Ra 20,20,10240
Mvaa 144,96,76
buffer_load_dwordx4 v8, s[12:15], s54 offen offset:2048 nt lds
Mvaa 148,100,76
Ta 56,28,0
Ta 58,28,2048
Mvaa 152,104,76
Mvaa 156,108,76
Ra 24,20,12288
Mvaa 160,112,76
buffer_load_dwordx4 v9, s[12:15], s55 offen offset:3072 nt lds
Mvaa 164,116,76
s_waitcnt lgkmcnt(6)
Ta 60,29,0
Ta 62,29,2048
Mvaa 168,120,76
v_add_u32 v6, 524288, v6
v_add_u32 v7, 524288, v7
Mvaa 172,124,76
s_add_u32 m0, s56, 0
Ra 28,20,14336
v_add_u32 v8, 524288, v8
Mvaa 176,96,80
buffer_load_dwordx4 v2, s[8:11], s48 offen offset:0 lds
Mvaa 180,100,80
v_add_u32 v9, 524288, v9
Mvaa 184,104,80
Mvaa 188,108,80
Mvaa 192,112,80
buffer_load_dwordx4 v3, s[8:11], s49 offen offset:1024 lds
Mvaa 196,116,80
Mvaa 200,120,80
Mvaa 204,124,80
Mvaa 208,96,84
buffer_load_dwordx4 v2, s[8:11], s50 offen offset:2048 lds
Mvaa 212,100,84
Mvaa 216,104,84
Mvaa 220,108,84
Mvaa 224,112,84
buffer_load_dwordx4 v3, s[8:11], s51 offen offset:3072 lds
Mvaa 228,116,84
Mvaa 232,120,84
Mvaa 236,124,84
s_add_u32 m0, s56, 4096
Mvaa 240,96,88
buffer_load_dwordx4 v4, s[8:11], s48 offen offset:0 lds
Mvaa 244,100,88
Mvaa 248,104,88
Mvaa 252,108,88
Maaa 128,112,88
buffer_load_dwordx4 v5, s[8:11], s49 offen offset:1024 lds
Maaa 132,116,88
Maaa 136,120,88
Maaa 140,124,88
Maaa 144,96,92
buffer_load_dwordx4 v4, s[8:11], s50 offen offset:2048 lds
Maaa 148,100,92
Maaa 152,104,92
Maaa 156,108,92
Maaa 160,112,92
buffer_load_dwordx4 v5, s[8:11], s51 offen offset:3072 lds
Maaa 164,116,92
v_add_u32 v2, 128, v2
v_add_u32 v3, 128, v3
Maaa 168,120,92
v_add_u32 v4, 128, v4
v_add_u32 v5, 128, v5
Maaa 172,124,92
s_waitcnt lgkmcnt(0)
Mvaa 48,32,0
s_mov_b64 exec, 1
buffer_atomic_add v30, v31, s[28:31], s37 offen sc1
s_mov_b64 exec, -1
Mvaa 52,36,0
Ta 96,22,16384
Ta 98,22,18432
Mvaa 56,40,0
Mvaa 60,44,0
Ra 64,21,0
Mvaa 64,48,0
Mvaa 68,52,0
Ta 100,23,16384
Ta 102,23,18432
Mvaa 72,56,0
Mvaa 76,60,0
s_waitcnt lgkmcnt(6)
Ra 68,21,2048
Mvaa 80,32,4
Mvaa 84,36,4
Ta 104,24,16384
Ta 106,24,18432
Mvaa 88,40,4
Mvaa 92,44,4
Ra 72,21,4096
Mvaa 96,48,4
Mvaa 100,52,4
Ta 108,25,16384
Ta 110,25,18432
Mvaa 104,56,4
Mvaa 108,60,4
s_waitcnt lgkmcnt(6)
Ra 76,21,6144
Mvaa 112,32,8
Mvaa 116,36,8
Ta 112,26,16384
Ta 114,26,18432
Mvaa 120,40,8
Mvaa 124,44,8
Ra 80,21,8192
Mvaa 128,48,8
Mvaa 132,52,8
Ta 116,27,16384
Ta 118,27,18432
Mvaa 136,56,8
Mvaa 140,60,8
s_waitcnt lgkmcnt(6)
Ra 84,21,10240
Mvaa 144,32,12
Mvaa 148,36,12
Ta 120,28,16384
Ta 122,28,18432
Mvaa 152,40,12
Mvaa 156,44,12
Ra 88,21,12288
Mvaa 160,48,12
Mvaa 164,52,12
Ta 124,29,16384
Ta 126,29,18432
Mvaa 168,56,12
Mvaa 172,60,12
s_waitcnt lgkmcnt(6)
Ra 92,21,14336
Mvaa 176,32,16
Mvaa 180,36,16
Mvaa 184,40,16
Mvaa 188,44,16
Mvaa 192,48,16
Mvaa 196,52,16
Mvaa 200,56,16
Mvaa 204,60,16
Mvaa 208,32,20
Mvaa 212,36,20
Mvaa 216,40,20
Mvaa 220,44,20
Mvaa 224,48,20
Mvaa 228,52,20
Mvaa 232,56,20
Mvaa 236,60,20
Mvaa 240,32,24
Mvaa 244,36,24
Mvaa 248,40,24
Mvaa 252,44,24
Maaa 128,48,24
Maaa 132,52,24
Maaa 136,56,24
Maaa 140,60,24
Maaa 144,32,28
Maaa 148,36,28
Maaa 152,40,28
Maaa 156,44,28
Maaa 160,48,28
Maaa 164,52,28
Maaa 168,56,28
Maaa 172,60,28
s_waitcnt vmcnt(1) lgkmcnt(0)
s_add_u32 m0, s57, 65536
s_barrier
Mvaa 48,96,64
buffer_load_dwordx4 v6, s[12:15], s52 offen offset:0 nt lds
Mvaa 52,100,64
Ta 32,12,0
Ta 34,12,2048
Mvaa 56,104,64
Mvaa 60,108,64
Ra 0,10,0
Mvaa 64,112,64
buffer_load_dwordx4 v7, s[12:15], s53 offen offset:1024 nt lds
Mvaa 68,116,64
s_waitcnt lgkmcnt(6)
Ta 36,13,0
Ta 38,13,2048
Mvaa 72,120,64
Mvaa 76,124,64
Ra 4,10,2048
Mvaa 80,96,68
buffer_load_dwordx4 v6, s[12:15], s54 offen offset:2048 nt lds
Mvaa 84,100,68
Ta 40,14,0
Ta 42,14,2048
Mvaa 88,104,68
Mvaa 92,108,68
Ra 8,10,4096
Mvaa 96,112,68
buffer_load_dwordx4 v7, s[12:15], s55 offen offset:3072 nt lds
Mvaa 100,116,68
s_waitcnt lgkmcnt(6)
Ta 44,15,0
Ta 46,15,2048
Mvaa 104,120,68
Mvaa 108,124,68
s_add_u32 m0, s57, 69632
Ra 12,10,6144
Mvaa 112,96,72
buffer_load_dwordx4 v8, s[12:15], s52 offen offset:0 nt lds
Mvaa 116,100,72
Ta 48,16,0
Ta 50,16,2048
Mvaa 120,104,72
Mvaa 124,108,72
Ra 16,10,8192
Mvaa 128,112,72
buffer_load_dwordx4 v9, s[12:15], s53 offen offset:1024 nt lds
Mvaa 132,116,72
s_waitcnt lgkmcnt(6)
Ta 52,17,0
Ta 54,17,2048
Mvaa 136,120,72
Mvaa 140,124,72
Ra 20,10,10240
Mvaa 144,96,76
buffer_load_dwordx4 v8, s[12:15], s54 offen offset:2048 nt lds
Mvaa 148,100,76
Ta 56,18,0
Ta 58,18,2048
Mvaa 152,104,76
Mvaa 156,108,76
Ra 24,10,12288
Mvaa 160,112,76
buffer_load_dwordx4 v9, s[12:15], s55 offen offset:3072 nt lds
Mvaa 164,116,76
s_waitcnt lgkmcnt(6)
Ta 60,19,0
Ta 62,19,2048
Mvaa 168,120,76
v_add_u32 v6, 524288, v6
v_add_u32 v7, 524288, v7
Mvaa 172,124,76
s_add_u32 m0, s56, 65536
Ra 28,10,14336
v_add_u32 v8, 524288, v8
Mvaa 176,96,80
buffer_load_dwordx4 v2, s[8:11], s48 offen offset:0 lds
Mvaa 180,100,80
v_add_u32 v9, 524288, v9
Mvaa 184,104,80
Mvaa 188,108,80
Mvaa 192,112,80
buffer_load_dwordx4 v3, s[8:11], s49 offen offset:1024 lds
Mvaa 196,116,80
Mvaa 200,120,80
Mvaa 204,124,80
Mvaa 208,96,84
buffer_load_dwordx4 v2, s[8:11], s50 offen offset:2048 lds
Mvaa 212,100,84
Mvaa 216,104,84
Mvaa 220,108,84
Mvaa 224,112,84
buffer_load_dwordx4 v3, s[8:11], s51 offen offset:3072 lds
Mvaa 228,116,84
Mvaa 232,120,84
Mvaa 236,124,84
s_add_u32 m0, s56, 69632
Mvaa 240,96,88
buffer_load_dwordx4 v4, s[8:11], s48 offen offset:0 lds
Mvaa 244,100,88
Mvaa 248,104,88
Mvaa 252,108,88
Maaa 128,112,88
buffer_load_dwordx4 v5, s[8:11], s49 offen offset:1024 lds
Maaa 132,116,88
Maaa 136,120,88
Maaa 140,124,88
Maaa 144,96,92
buffer_load_dwordx4 v4, s[8:11], s50 offen offset:2048 lds
Maaa 148,100,92
Maaa 152,104,92
Maaa 156,108,92
Maaa 160,112,92
buffer_load_dwordx4 v5, s[8:11], s51 offen offset:3072 lds
Maaa 164,116,92
v_add_u32 v2, 128, v2
v_add_u32 v3, 128, v3
Maaa 168,120,92
v_add_u32 v4, 128, v4
v_add_u32 v5, 128, v5
Maaa 172,124,92
s_waitcnt lgkmcnt(0)
Mvaa 48,32,0
Mvaa 52,36,0
Ta 96,12,16384
Ta 98,12,18432
Mvaa 56,40,0
Mvaa 60,44,0
Ra 64,11,0
Mvaa 64,48,0
Mvaa 68,52,0
Ta 100,13,16384
Ta 102,13,18432
Mvaa 72,56,0
Mvaa 76,60,0
s_waitcnt lgkmcnt(6)
Ra 68,11,2048
Mvaa 80,32,4
Mvaa 84,36,4
Ta 104,14,16384
Ta 106,14,18432
Mvaa 88,40,4
Mvaa 92,44,4
Ra 72,11,4096
Mvaa 96,48,4
Mvaa 100,52,4
Ta 108,15,16384
Ta 110,15,18432
Mvaa 104,56,4
Mvaa 108,60,4
s_waitcnt lgkmcnt(6)
Ra 76,11,6144
Mvaa 112,32,8
Mvaa 116,36,8
Ta 112,16,16384
Ta 114,16,18432
Mvaa 120,40,8
Mvaa 124,44,8
Ra 80,11,8192
Mvaa 128,48,8
Mvaa 132,52,8
Ta 116,17,16384
Ta 118,17,18432
Mvaa 136,56,8
Mvaa 140,60,8
s_waitcnt lgkmcnt(6)
Ra 84,11,10240
Mvaa 144,32,12
Mvaa 148,36,12
Ta 120,18,16384
Ta 122,18,18432
Mvaa 152,40,12
Mvaa 156,44,12
Ra 88,11,12288
Mvaa 160,48,12
Mvaa 164,52,12
Ta 124,19,16384
Ta 126,19,18432
Mvaa 168,56,12
Mvaa 172,60,12
s_waitcnt lgkmcnt(6)
Ra 92,11,14336
Mvaa 176,32,16
Mvaa 180,36,16
Mvaa 184,40,16
Mvaa 188,44,16
Mvaa 192,48,16
Mvaa 196,52,16
Mvaa 200,56,16
Mvaa 204,60,16
Mvaa 208,32,20
Mvaa 212,36,20
Mvaa 216,40,20
Mvaa 220,44,20
Mvaa 224,48,20
Mvaa 228,52,20
Mvaa 232,56,20
Mvaa 236,60,20
Mvaa 240,32,24
Mvaa 244,36,24
Mvaa 248,40,24
Mvaa 252,44,24
Maaa 128,48,24
Maaa 132,52,24
Maaa 136,56,24
Maaa 140,60,24
Maaa 144,32,28
Maaa 148,36,28
Maaa 152,40,28
Maaa 156,44,28
Maaa 160,48,28
Maaa 164,52,28
Maaa 168,56,28
Maaa 172,60,28
s_waitcnt vmcnt(0) lgkmcnt(0)
s_add_u32 m0, s57, 0
s_barrier
Mvaa 48,96,64
buffer_load_dwordx4 v6, s[12:15], s52 offen offset:0 nt lds
Mvaa 52,100,64
Ta 32,22,0
Ta 34,22,2048
Mvaa 56,104,64
Mvaa 60,108,64
Ra 0,20,0
Mvaa 64,112,64
buffer_load_dwordx4 v7, s[12:15], s53 offen offset:1024 nt lds
Mvaa 68,116,64
s_waitcnt lgkmcnt(6)
Ta 36,23,0
Ta 38,23,2048
Mvaa 72,120,64
Mvaa 76,124,64
Ra 4,20,2048
Mvaa 80,96,68
buffer_load_dwordx4 v6, s[12:15], s54 offen offset:2048 nt lds
Mvaa 84,100,68
Ta 40,24,0
Ta 42,24,2048
Mvaa 88,104,68
Mvaa 92,108,68
Ra 8,20,4096
Mvaa 96,112,68
buffer_load_dwordx4 v7, s[12:15], s55 offen offset:3072 nt lds
Mvaa 100,116,68
s_waitcnt lgkmcnt(6)
Ta 44,25,0
Ta 46,25,2048
Mvaa 104,120,68
Mvaa 108,124,68
s_add_u32 m0, s57, 4096
Ra 12,20,6144
Mvaa 112,96,72
buffer_load_dwordx4 v8, s[12:15], s52 offen offset:0 nt lds
Mvaa 116,100,72
Ta 48,26,0
Ta 50,26,2048
Mvaa 120,104,72
Mvaa 124,108,72
Ra 16,20,8192
Mvaa 128,112,72
buffer_load_dwordx4 v9, s[12:15], s53 offen offset:1024 nt lds
Mvaa 132,116,72
s_waitcnt lgkmcnt(6)
Ta 52,27,0
Ta 54,27,2048
Mvaa 136,120,72
Mvaa 140,124,72
Ra 20,20,10240
Mvaa 144,96,76
buffer_load_dwordx4 v8, s[12:15], s54 offen offset:2048 nt lds
Mvaa 148,100,76
Ta 56,28,0
Ta 58,28,2048
Mvaa 152,104,76
Mvaa 156,108,76
Ra 24,20,12288
Mvaa 160,112,76
buffer_load_dwordx4 v9, s[12:15], s55 offen offset:3072 nt lds
Mvaa 164,116,76
s_waitcnt lgkmcnt(6)
Ta 60,29,0
Ta 62,29,2048
Mvaa 168,120,76
v_add_u32 v6, 524288, v6
v_add_u32 v7, 524288, v7
Mvaa 172,124,76
s_add_u32 m0, s56, 0
Ra 28,20,14336
v_add_u32 v8, 524288, v8
Mvaa 176,96,80
buffer_load_dwordx4 v2, s[8:11], s48 offen offset:0 lds
Mvaa 180,100,80
v_add_u32 v9, 524288, v9
Mvaa 184,104,80
Mvaa 188,108,80
Mvaa 192,112,80
buffer_load_dwordx4 v3, s[8:11], s49 offen offset:1024 lds
Mvaa 196,116,80
Mvaa 200,120,80
Mvaa 204,124,80
Mvaa 208,96,84
buffer_load_dwordx4 v2, s[8:11], s50 offen offset:2048 lds
Mvaa 212,100,84
Mvaa 216,104,84
Mvaa 220,108,84
Mvaa 224,112,84
buffer_load_dwordx4 v3, s[8:11], s51 offen offset:3072 lds
Mvaa 228,116,84
Mvaa 232,120,84
Mvaa 236,124,84
s_add_u32 m0, s56, 4096
Mvaa 240,96,88
buffer_load_dwordx4 v4, s[8:11], s48 offen offset:0 lds
Mvaa 244,100,88
Mvaa 248,104,88
Mvaa 252,108,88
Maaa 128,112,88
buffer_load_dwordx4 v5, s[8:11], s49 offen offset:1024 lds
Maaa 132,116,88
Maaa 136,120,88
Maaa 140,124,88
Maaa 144,96,92
buffer_load_dwordx4 v4, s[8:11], s50 offen offset:2048 lds
Maaa 148,100,92
Maaa 152,104,92
Maaa 156,108,92
Maaa 160,112,92
buffer_load_dwordx4 v5, s[8:11], s51 offen offset:3072 lds
Maaa 164,116,92
v_add_u32 v2, 128, v2
v_add_u32 v3, 128, v3
Maaa 168,120,92
v_add_u32 v4, 128, v4
v_add_u32 v5, 128, v5
Maaa 172,124,92
s_waitcnt lgkmcnt(0)
Mvaa 48,32,0
buffer_load_dword v44, v45, s[16:19], s47 offen
Mvaa 52,36,0
Ta 96,22,16384
Ta 98,22,18432
Mvaa 56,40,0
s_add_u32 s47, s47, 8388608
v_lshrrev_b32 v32, 4, v0
v_and_b32_e64 v33, 15, v0
Mvaa 60,44,0
Ra 64,21,0
Mvaa 64,48,0
s_lshl_b32 s3, s32, 4
v_add_u32 v34, s3, v32
v_lshlrev_b32_e64 v36, 1, v32
Mvaa 68,52,0
Ta 100,23,16384
Ta 102,23,18432
Mvaa 72,56,0
v_xor_b32 v36, v36, v33
v_xor_b32 v37, 8, v36
Mvaa 76,60,0
s_waitcnt lgkmcnt(6)
Ra 68,21,2048
Mvaa 80,32,4
s_getpc_b64 s[6:7]
L_cpf2:
s_add_u32 s6, s6, (L_phase2-L_cpf2)&0xffffffff
s_addc_u32 s7, s7, ((L_phase2-L_cpf2)>>32)&0xffffffff
Mvaa 84,36,4
Ta 104,24,16384
Ta 106,24,18432
Mvaa 88,40,4
s_lshr_b32 s3, s2, 3
s_lshl_b32 s3, s3, 2
s_add_u32 s3, s3, s32
Mvaa 92,44,4
Ra 72,21,4096
Mvaa 96,48,4
s_lshl_b32 s3, s3, 10
v_and_b32 v42, 7, v0
v_lshlrev_b32 v42, 7, v42
Mvaa 100,52,4
Ta 108,25,16384
Ta 110,25,18432
Mvaa 104,56,4
v_add_u32_e64 v42, s3, v42
v_min_u32 v42, L_k2_fin-L_phase2-4, v42
Mvaa 108,60,4
s_waitcnt lgkmcnt(6)
Ra 76,21,6144
Mvaa 112,32,8
v_mov_b32 v41, s7
Mvaa 116,36,8
Ta 112,26,16384
Ta 114,26,18432
Mvaa 120,40,8
v_add_co_u32 v40, vcc, s6, v42
s_nop 1
v_addc_co_u32 v41, vcc, 0, v41, vcc
Mvaa 124,44,8
Ra 80,21,8192
Mvaa 128,48,8
global_load_dword v43, v[40:41], off
Mvaa 132,52,8
Ta 116,27,16384
Ta 118,27,18432
Mvaa 136,56,8
Mvaa 140,60,8
s_waitcnt lgkmcnt(6)
Ra 84,21,10240
Mvaa 144,32,12
Mvaa 148,36,12
Ta 120,28,16384
Ta 122,28,18432
Mvaa 152,40,12
Mvaa 156,44,12
Ra 88,21,12288
Mvaa 160,48,12
Mvaa 164,52,12
Ta 124,29,16384
Ta 126,29,18432
Mvaa 168,56,12
Mvaa 172,60,12
s_waitcnt lgkmcnt(6)
Ra 92,21,14336
Mvaa 176,32,16
Mvaa 180,36,16
Mvaa 184,40,16
Mvaa 188,44,16
Mvaa 192,48,16
Mvaa 196,52,16
Mvaa 200,56,16
Mvaa 204,60,16
Mvaa 208,32,20
Mvaa 212,36,20
Mvaa 216,40,20
Mvaa 220,44,20
Mvaa 224,48,20
Mvaa 228,52,20
Mvaa 232,56,20
Mvaa 236,60,20
Mvaa 240,32,24
Mvaa 244,36,24
Mvaa 248,40,24
Mvaa 252,44,24
Maaa 128,48,24
Maaa 132,52,24
Maaa 136,56,24
Maaa 140,60,24
Maaa 144,32,28
Maaa 148,36,28
Maaa 152,40,28
Maaa 156,44,28
Maaa 160,48,28
Maaa 164,52,28
Maaa 168,56,28
Maaa 172,60,28
s_waitcnt vmcnt(2) lgkmcnt(0)
s_add_u32 m0, s57, 65536
s_barrier
Mvaa 48,96,64
buffer_load_dwordx4 v6, s[12:15], s52 offen offset:0 nt lds
Mvaa 52,100,64
Ta 32,12,0
Ta 34,12,2048
Mvaa 56,104,64
Mvaa 60,108,64
Ra 0,10,0
Mvaa 64,112,64
buffer_load_dwordx4 v7, s[12:15], s53 offen offset:1024 nt lds
Mvaa 68,116,64
s_waitcnt lgkmcnt(6)
Ta 36,13,0
Ta 38,13,2048
Mvaa 72,120,64
Mvaa 76,124,64
Ra 4,10,2048
Mvaa 80,96,68
buffer_load_dwordx4 v6, s[12:15], s54 offen offset:2048 nt lds
Mvaa 84,100,68
Ta 40,14,0
Ta 42,14,2048
Mvaa 88,104,68
Mvaa 92,108,68
Ra 8,10,4096
Mvaa 96,112,68
buffer_load_dwordx4 v7, s[12:15], s55 offen offset:3072 nt lds
Mvaa 100,116,68
s_waitcnt lgkmcnt(6)
Ta 44,15,0
Ta 46,15,2048
Mvaa 104,120,68
Mvaa 108,124,68
s_add_u32 m0, s57, 69632
Ra 12,10,6144
Mvaa 112,96,72
buffer_load_dwordx4 v8, s[12:15], s52 offen offset:0 nt lds
Mvaa 116,100,72
Ta 48,16,0
Ta 50,16,2048
Mvaa 120,104,72
Mvaa 124,108,72
Ra 16,10,8192
Mvaa 128,112,72
buffer_load_dwordx4 v9, s[12:15], s53 offen offset:1024 nt lds
Mvaa 132,116,72
s_waitcnt lgkmcnt(6)
Ta 52,17,0
Ta 54,17,2048
Mvaa 136,120,72
Mvaa 140,124,72
Ra 20,10,10240
Mvaa 144,96,76
buffer_load_dwordx4 v8, s[12:15], s54 offen offset:2048 nt lds
Mvaa 148,100,76
Ta 56,18,0
Ta 58,18,2048
Mvaa 152,104,76
Mvaa 156,108,76
Ra 24,10,12288
Mvaa 160,112,76
buffer_load_dwordx4 v9, s[12:15], s55 offen offset:3072 nt lds
Mvaa 164,116,76
s_waitcnt lgkmcnt(6)
Ta 60,19,0
Ta 62,19,2048
Mvaa 168,120,76
v_add_u32 v6, 524288, v6
v_add_u32 v7, 524288, v7
Mvaa 172,124,76
s_add_u32 m0, s56, 65536
Ra 28,10,14336
v_add_u32 v8, 524288, v8
Mvaa 176,96,80
buffer_load_dwordx4 v2, s[8:11], s48 offen offset:0 lds
Mvaa 180,100,80
v_add_u32 v9, 524288, v9
Mvaa 184,104,80
Mvaa 188,108,80
Mvaa 192,112,80
buffer_load_dwordx4 v3, s[8:11], s49 offen offset:1024 lds
Mvaa 196,116,80
Mvaa 200,120,80
Mvaa 204,124,80
Mvaa 208,96,84
buffer_load_dwordx4 v2, s[8:11], s50 offen offset:2048 lds
Mvaa 212,100,84
Mvaa 216,104,84
Mvaa 220,108,84
Mvaa 224,112,84
buffer_load_dwordx4 v3, s[8:11], s51 offen offset:3072 lds
Mvaa 228,116,84
Mvaa 232,120,84
Mvaa 236,124,84
s_add_u32 m0, s56, 69632
Mvaa 240,96,88
buffer_load_dwordx4 v4, s[8:11], s48 offen offset:0 lds
Mvaa 244,100,88
Mvaa 248,104,88
Mvaa 252,108,88
Maaa 128,112,88
buffer_load_dwordx4 v5, s[8:11], s49 offen offset:1024 lds
Maaa 132,116,88
Maaa 136,120,88
Maaa 140,124,88
Maaa 144,96,92
buffer_load_dwordx4 v4, s[8:11], s50 offen offset:2048 lds
Maaa 148,100,92
Maaa 152,104,92
Maaa 156,108,92
Maaa 160,112,92
buffer_load_dwordx4 v5, s[8:11], s51 offen offset:3072 lds
Maaa 164,116,92
v_add_u32 v2, 128, v2
v_add_u32 v3, 128, v3
Maaa 168,120,92
v_add_u32 v4, 128, v4
v_add_u32 v5, 128, v5
Maaa 172,124,92
s_waitcnt lgkmcnt(0)
Mvaa 48,32,0
buffer_load_dword v30, v31, s[28:31], s37 offen sc1
Mvaa 52,36,0
Ta 96,12,16384
Ta 98,12,18432
Mvaa 56,40,0
s_mov_b32 s8, s16
s_mov_b32 s9, s17
s_mov_b32 s10, s18
Mvaa 60,44,0
Ra 64,11,0
Mvaa 64,48,0
s_add_u32 s16, s66, 46137344
s_addc_u32 s17, s67, 0
s_and_b32 s17, s17, 0xffff
Mvaa 68,52,0
Ta 100,13,16384
Ta 102,13,18432
Mvaa 72,56,0
s_mov_b32 s18, 16777216
s_mov_b32 s19, 0x20000
s_mov_b32 s48, 0
Mvaa 76,60,0
s_waitcnt lgkmcnt(6)
Ra 68,11,2048
Mvaa 80,32,4
s_mov_b32 s49, 31744
s_mov_b32 s50, 63488
s_mov_b32 s51, 95232
Mvaa 84,36,4
Ta 104,14,16384
Ta 106,14,18432
Mvaa 88,40,4
v_lshlrev_b32_e64 v35, 13, v34
v_lshl_add_u32 v8, v36, 4, v35
Mvaa 92,44,4
Ra 72,11,4096
Mvaa 96,48,4
v_lshl_add_u32 v9, v37, 4, v35
v_lshlrev_b32_e64 v2, 4, v0
Mvaa 100,52,4
Ta 108,15,16384
Ta 110,15,18432
Mvaa 104,56,4
v_add_u32 v3, 65536, v2
v_add_u32_e64 v4, s44, v2
Mvaa 108,60,4
s_waitcnt lgkmcnt(6)
Ra 76,11,6144
Mvaa 112,32,8
v_mov_b32 v7, 0
v_lshlrev_b32_e64 v35, 2, v32
Mvaa 116,36,8
Ta 112,16,16384
Ta 114,16,18432
Mvaa 120,40,8
v_sub_u32_e64 v35, v33, v35
Mvaa 124,44,8
Ra 80,11,8192
Mvaa 128,48,8
s_lshl_b32 s3, s45, 5
v_add_u32 v5, s3, v35
Mvaa 132,52,8
Ta 116,17,16384
Ta 118,17,18432
Mvaa 136,56,8
s_lshl_b32 s3, s46, 5
v_add_u32 v6, s3, v35
Mvaa 140,60,8
s_waitcnt lgkmcnt(6)
Ra 84,11,10240
Mvaa 144,32,12
s_mul_i32 s3, s33, 1116160
s_add_u32 s3, s3, 8388608
s_add_u32 s12, s66, s3
s_addc_u32 s13, s67, 0
s_and_b32 s13, s13, 0xffff
Mvaa 148,36,12
Ta 120,18,16384
Ta 122,18,18432
Mvaa 152,40,12
s_mov_b32 s14, 0
s_mov_b32 s15, 0x20000
s_mul_i32 s14, s36, 34816
Mvaa 156,44,12
Ra 88,11,12288
Mvaa 160,48,12
Mvaa 164,52,12
Ta 124,19,16384
Ta 126,19,18432
Mvaa 168,56,12
Mvaa 172,60,12
s_waitcnt lgkmcnt(6)
Ra 92,11,14336
Mvaa 176,32,16
Mvaa 180,36,16
Mvaa 184,40,16
Mvaa 188,44,16
Mvaa 192,48,16
Mvaa 196,52,16
Mvaa 200,56,16
Mvaa 204,60,16
Mvaa 208,32,20
Mvaa 212,36,20
Mvaa 216,40,20
Mvaa 220,44,20
Mvaa 224,48,20
Mvaa 228,52,20
Mvaa 232,56,20
Mvaa 236,60,20
Mvaa 240,32,24
Mvaa 244,36,24
Mvaa 248,40,24
Mvaa 252,44,24
Maaa 128,48,24
Maaa 132,52,24
Maaa 136,56,24
Maaa 140,60,24
Maaa 144,32,28
Maaa 148,36,28
Maaa 152,40,28
Maaa 156,44,28
Maaa 160,48,28
Maaa 164,52,28
Maaa 168,56,28
Maaa 172,60,28
s_waitcnt vmcnt(1) lgkmcnt(0)
s_add_u32 m0, s44, 0
s_barrier
Mvaa 48,96,64
buffer_load_dwordx4 v8, s[8:11], s48 offen offset:0 lds
Mvaa 52,100,64
Ta 32,22,0
Ta 34,22,2048
Mvaa 56,104,64
s_mul_i32 s3, s45, 67584
v_add_u32_e64 v10, s3, v2
Mvaa 60,108,64
Ra 0,20,0
Mvaa 64,112,64
buffer_load_dwordx4 v8, s[8:11], s49 offen offset:1024 lds
Mvaa 68,116,64
s_waitcnt lgkmcnt(6)
Ta 36,23,0
Ta 38,23,2048
Mvaa 72,120,64
s_mul_i32 s3, s46, 67584
v_add_u32 v11, s3, v2
Mvaa 76,124,64
Ra 4,20,2048
Mvaa 80,96,68
buffer_load_dwordx4 v9, s[8:11], s50 offen offset:2048 lds
Mvaa 84,100,68
Ta 40,24,0
Ta 42,24,2048
Mvaa 88,104,68
Mvaa 92,108,68
Ra 8,20,4096
Mvaa 96,112,68
buffer_load_dwordx4 v9, s[8:11], s51 offen offset:3072 lds
Mvaa 100,116,68
s_waitcnt lgkmcnt(6)
Ta 44,25,0
Ta 46,25,2048
Mvaa 104,120,68
v_add_u32 v8, 524288, v8
v_add_u32 v9, 524288, v9
Mvaa 108,124,68
s_add_u32 m0, s44, 16384
Ra 12,20,6144
Mvaa 112,96,72
buffer_load_dwordx4 v8, s[8:11], s48 offen offset:0 lds
Mvaa 116,100,72
Ta 48,26,0
Ta 50,26,2048
Mvaa 120,104,72
Mvaa 124,108,72
Ra 16,20,8192
Mvaa 128,112,72
buffer_load_dwordx4 v8, s[8:11], s49 offen offset:1024 lds
Mvaa 132,116,72
s_waitcnt lgkmcnt(6)
Ta 52,27,0
Ta 54,27,2048
Mvaa 136,120,72
Mvaa 140,124,72
Ra 20,20,10240
Mvaa 144,96,76
buffer_load_dwordx4 v9, s[8:11], s50 offen offset:2048 lds
Mvaa 148,100,76
Ta 56,28,0
Ta 58,28,2048
Mvaa 152,104,76
Mvaa 156,108,76
Ra 24,20,12288
Mvaa 160,112,76
buffer_load_dwordx4 v9, s[8:11], s51 offen offset:3072 lds
Mvaa 164,116,76
s_waitcnt lgkmcnt(6)
Ta 60,29,0
Ta 62,29,2048
Mvaa 168,120,76
v_add_u32 v8, 524288, v8
v_add_u32 v9, 524288, v9
Mvaa 172,124,76
s_add_u32 m0, s44, 32768
Ra 28,20,14336
Mvaa 176,96,80
buffer_load_dwordx4 v8, s[8:11], s48 offen offset:0 lds
Mvaa 180,100,80
Mvaa 184,104,80
Mvaa 188,108,80
Mvaa 192,112,80
buffer_load_dwordx4 v8, s[8:11], s49 offen offset:1024 lds
Mvaa 196,116,80
Mvaa 200,120,80
Mvaa 204,124,80
Mvaa 208,96,84
buffer_load_dwordx4 v9, s[8:11], s50 offen offset:2048 lds
Mvaa 212,100,84
Mvaa 216,104,84
Mvaa 220,108,84
Mvaa 224,112,84
buffer_load_dwordx4 v9, s[8:11], s51 offen offset:3072 lds
Mvaa 228,116,84
v_add_u32 v8, 524288, v8
v_add_u32 v9, 524288, v9
Mvaa 232,120,84
Mvaa 236,124,84
s_add_u32 m0, s44, 49152
Mvaa 240,96,88
buffer_load_dwordx4 v8, s[8:11], s48 offen offset:0 lds
Mvaa 244,100,88
Mvaa 248,104,88
Mvaa 252,108,88
Maaa 128,112,88
buffer_load_dwordx4 v8, s[8:11], s49 offen offset:1024 lds
Maaa 132,116,88
Maaa 136,120,88
Maaa 140,124,88
Maaa 144,96,92
buffer_load_dwordx4 v9, s[8:11], s50 offen offset:2048 lds
Maaa 148,100,92
Maaa 152,104,92
Maaa 156,108,92
Maaa 160,112,92
buffer_load_dwordx4 v9, s[8:11], s51 offen offset:3072 lds
Maaa 164,116,92
v_add_u32 v8, 524288, v8
v_add_u32 v9, 524288, v9
Maaa 168,120,92
Maaa 172,124,92
s_waitcnt lgkmcnt(0)
Mvaa 48,32,0
Mvaa 52,36,0
Ta 96,22,16384
Ta 98,22,18432
Mvaa 56,40,0
Mvaa 60,44,0
Ra 64,21,0
Mvaa 64,48,0
Mvaa 68,52,0
Ta 100,23,16384
Ta 102,23,18432
Mvaa 72,56,0
Mvaa 76,60,0
s_waitcnt lgkmcnt(6)
Ra 68,21,2048
Mvaa 80,32,4
Mvaa 84,36,4
Ta 104,24,16384
Ta 106,24,18432
Mvaa 88,40,4
Mvaa 92,44,4
Ra 72,21,4096
Mvaa 96,48,4
Mvaa 100,52,4
Ta 108,25,16384
Ta 110,25,18432
Mvaa 104,56,4
Mvaa 108,60,4
s_waitcnt lgkmcnt(6)
Ra 76,21,6144
Mvaa 112,32,8
Mvaa 116,36,8
Ta 112,26,16384
Ta 114,26,18432
Mvaa 120,40,8
Mvaa 124,44,8
Ra 80,21,8192
Mvaa 128,48,8
Mvaa 132,52,8
Ta 116,27,16384
Ta 118,27,18432
Mvaa 136,56,8
Mvaa 140,60,8
s_waitcnt lgkmcnt(6)
Ra 84,21,10240
Mvaa 144,32,12
Mvaa 148,36,12
Ta 120,28,16384
Ta 122,28,18432
Mvaa 152,40,12
Mvaa 156,44,12
Ra 88,21,12288
Mvaa 160,48,12
Mvaa 164,52,12
Ta 124,29,16384
Ta 126,29,18432
Mvaa 168,56,12
Mvaa 172,60,12
s_waitcnt lgkmcnt(6)
Ra 92,21,14336
Mvaa 176,32,16
Mvaa 180,36,16
Mvaa 184,40,16
Mvaa 188,44,16
Mvaa 192,48,16
Mvaa 196,52,16
Mvaa 200,56,16
Mvaa 204,60,16
Mvaa 208,32,20
Mvaa 212,36,20
Mvaa 216,40,20
Mvaa 220,44,20
Mvaa 224,48,20
Mvaa 228,52,20
Mvaa 232,56,20
Mvaa 236,60,20
Mvaa 240,32,24
Mvaa 244,36,24
Mvaa 248,40,24
Mvaa 252,44,24
Maaa 128,48,24
Maaa 132,52,24
Maaa 136,56,24
Maaa 140,60,24
Maaa 144,32,28
Maaa 148,36,28
Maaa 152,40,28
Maaa 156,44,28
Maaa 160,48,28
Maaa 164,52,28
Maaa 168,56,28
Maaa 172,60,28
s_waitcnt vmcnt(12) lgkmcnt(0)
v_readfirstlane_b32 s3, v30
s_nop 0
s_or_b32 s3, s3, s37
s_cmp_lt_u32 s3, 256
s_cbranch_scc1 L_spinAk
L_spinArk:
s_barrier
Mvaa 48,96,64
buffer_load_dwordx4 a[0:3], v10, s[20:23], 0 offen offset:0 sc1
Mvaa 52,100,64
v_lshrrev_b32_e64 v42, 2, v33
v_lshl_add_u32 v43, v32, 3, v42
Mvaa 56,104,64
v_lshlrev_b32 v43, 8, v43
v_and_b32 v44, 3, v0
Mvaa 60,108,64
v_lshl_add_u32 v43, v44, 3, v43
v_and_b32_e64 v44, 1, v32
Mvaa 64,112,64
buffer_load_dwordx4 a[4:7], v10, s[20:23], s58 offen offset:0 sc1
Mvaa 68,116,64
v_lshl_add_u32 v42, v44, 2, v42
v_xor_b32_e64 v44, 0, v42
Mvaa 72,120,64
v_lshl_add_u32 v16, v44, 5, v43
v_xor_b32_e64 v44, 1, v42
Mvaa 76,124,64
v_lshl_add_u32 v17, v44, 5, v43
v_xor_b32_e64 v44, 2, v42
Mvaa 80,96,68
buffer_load_dwordx4 a[8:11], v11, s[20:23], 0 offen offset:0 sc1
Mvaa 84,100,68
v_lshl_add_u32 v18, v44, 5, v43
v_xor_b32_e64 v44, 3, v42
Mvaa 88,104,68
v_lshl_add_u32 v19, v44, 5, v43
v_xor_b32_e64 v44, 4, v42
Mvaa 92,108,68
v_lshl_add_u32 v20, v44, 5, v43
v_xor_b32_e64 v44, 5, v42
Mvaa 96,112,68
buffer_load_dwordx4 a[12:15], v11, s[20:23], s58 offen offset:0 sc1
Mvaa 100,116,68
v_lshl_add_u32 v21, v44, 5, v43
v_xor_b32_e64 v44, 6, v42
Mvaa 104,120,68
v_lshl_add_u32 v22, v44, 5, v43
v_xor_b32_e64 v44, 7, v42
Mvaa 108,124,68
v_lshl_add_u32 v23, v44, 5, v43
Mvaa 112,96,72
buffer_load_dwordx4 a[16:19], v10, s[20:23], 0 offen offset:1024 sc1
Mvaa 116,100,72
Mvaa 120,104,72
Mvaa 124,108,72
Mvaa 128,112,72
buffer_load_dwordx4 a[20:23], v10, s[20:23], s58 offen offset:1024 sc1
Mvaa 132,116,72
Ta 192,16,0
Ta 194,16,1024
Mvaa 136,120,72
Ta 196,17,0
Ta 198,17,1024
Mvaa 140,124,72
Ta 200,18,0
Ta 202,18,1024
Mvaa 144,96,76
buffer_load_dwordx4 a[24:27], v11, s[20:23], 0 offen offset:1024 sc1
Mvaa 148,100,76
Ta 204,19,0
Ta 206,19,1024
Mvaa 152,104,76
Ta 208,20,0
Ta 210,20,1024
Mvaa 156,108,76
Ta 212,21,0
Ta 214,21,1024
Mvaa 160,112,76
buffer_load_dwordx4 a[28:31], v11, s[20:23], s58 offen offset:1024 sc1
Mvaa 164,116,76
Ta 216,22,0
Ta 218,22,1024
Mvaa 168,120,76
Ta 220,23,0
s_waitcnt lgkmcnt(9)
Ta 222,23,1024
Mvaa 172,124,76
s_waitcnt lgkmcnt(8)
Vc 24,48,49
Vc 25,50,51
Mvaa 176,96,80
buffer_load_dwordx4 a[32:35], v10, s[20:23], 0 offen offset:2048 sc1
Mvaa 180,100,80
Vc 26,52,53
Vc 27,54,55
Mvaa 184,104,80
Vc 28,56,57
Vc 29,58,59
Mvaa 188,108,80
Vc 30,60,61
Vc 31,62,63
Mvaa 192,112,80
buffer_load_dwordx4 a[36:39], v10, s[20:23], s58 offen offset:2048 sc1
Mvaa 196,116,80
Vc 32,64,65
Vc 33,66,67
Mvaa 200,120,80
Vc 34,68,69
Vc 35,70,71
Mvaa 204,124,80
Vc 36,72,73
Vc 37,74,75
Mvaa 208,96,84
buffer_load_dwordx4 a[40:43], v11, s[20:23], 0 offen offset:2048 sc1
Mvaa 212,100,84
Vc 38,76,77
Vc 39,78,79
Mvaa 216,104,84
Vc 40,80,81
Vc 41,82,83
Mvaa 220,108,84
Vc 42,84,85
Vc 43,86,87
Mvaa 224,112,84
buffer_load_dwordx4 a[44:47], v11, s[20:23], s58 offen offset:2048 sc1
Mvaa 228,116,84
Vc 44,88,89
Vc 45,90,91
Mvaa 232,120,84
Vc 46,92,93
Vc 47,94,95
Mvaa 236,124,84
Vc 48,96,97
Vc 49,98,99
Mvaa 240,96,88
buffer_load_dwordx4 a[48:51], v10, s[20:23], 0 offen offset:3072 sc1
Mvaa 244,100,88
Vc 50,100,101
Vc 51,102,103
Mvaa 248,104,88
Vc 52,104,105
Vc 53,106,107
Mvaa 252,108,88
Vc 54,108,109
Vc 55,110,111
Maaa 128,112,88
buffer_load_dwordx4 a[52:55], v10, s[20:23], s58 offen offset:3072 sc1
Maaa 132,116,88
Vc 56,112,113
Vc 57,114,115
Maaa 136,120,88
Vc 58,116,117
Vc 59,118,119
Maaa 140,124,88
Vc 60,120,121
Vc 61,122,123
Maaa 144,96,92
buffer_load_dwordx4 a[56:59], v11, s[20:23], 0 offen offset:3072 sc1
Maaa 148,100,92
Vc 62,124,125
Vc 63,126,127
Maaa 152,104,92
Vc 64,128,129
Vc 65,130,131
Maaa 156,108,92
Vc 66,132,133
Vc 67,134,135
Maaa 160,112,92
buffer_load_dwordx4 a[60:63], v11, s[20:23], s58 offen offset:3072 sc1
Maaa 164,116,92
v_add_u32 v10, 4096, v10
v_add_u32 v11, 4096, v11
Maaa 168,120,92
Vc 68,136,137
Vc 69,138,139
Maaa 172,124,92
Vc 70,140,141
Vc 71,142,143
Vc 72,144,145
Vc 73,146,147
Vc 74,148,149
Vc 75,150,151
Vc 76,152,153
Vc 77,154,155
Vc 78,156,157
Vc 79,158,159
Vc 80,160,161
Vc 81,162,163
Vc 82,164,165
Vc 83,166,167
Vc 84,168,169
Vc 85,170,171
Vc 86,172,173
Vc 87,174,175
Vc 88,176,177
Vc 89,178,179
Vc 90,180,181
Vc 91,182,183
Vc 92,184,185
Vc 93,186,187
Vc 94,188,189
Vc 95,190,191
Vc 96,192,193
Vc 97,194,195
Vc 98,196,197
Vc 99,198,199
Vc 100,200,201
Vc 101,202,203
Vc 102,204,205
Vc 103,206,207
Vc 104,208,209
Vc 105,210,211
Vc 106,212,213
Vc 107,214,215
Vc 108,216,217
Vc 109,218,219
Vc 110,220,221
Vc 111,222,223
Vc 112,224,225
Vc 113,226,227
Vc 114,228,229
Vc 115,230,231
Vc 116,232,233
Vc 117,234,235
Vc 118,236,237
Vc 119,238,239
Vc 120,240,241
Vc 121,242,243
Vc 122,244,245
Vc 123,246,247
Vc 124,248,249
Vc 125,250,251
Vc 126,252,253
Vc 127,254,255
s_branch L_phase2
L_k1_vpath:
s_waitcnt lgkmcnt(0)
Zvaa 48,0,32
v_and_b32_e64 v46, 7, v0
v_mul_u32_u24 v30, 2064, v46
Zvaa 64,0,36
Ta 96,12,16384
Ta 98,12,18432
Zvaa 80,0,40
v_lshrrev_b32_e64 v31, 3, v0
Zvaa 96,0,44
Ra 64,11,0
Zvaa 112,0,48
s_lshl_b32 s3, s32, 9
s_add_u32 s3, s3, 131072
v_lshl_add_u32 v30, v31, 4, v30
Zvaa 128,0,52
Ta 100,13,16384
Ta 102,13,18432
Zvaa 144,0,56
v_add_u32 v30, s3, v30
v_lshlrev_b32_e64 v31, 8, v31
Zvaa 160,0,60
s_waitcnt lgkmcnt(6)
Ra 68,11,2048
Zvaa 52,4,32
v_lshl_add_u32 v46, v46, 4, v31
Zvaa 68,4,36
Ta 104,14,16384
Ta 106,14,18432
Zvaa 84,4,40
Rv 34,30,128
Rv 38,30,256
Zvaa 100,4,44
Ra 72,11,4096
Zvaa 116,4,48
Rv 42,30,384
Rv 30,30,0
Zvaa 132,4,52
Ta 108,15,16384
Ta 110,15,18432
Zvaa 148,4,56
s_lshr_b32 s3, s2, 1
s_mul_i32 s3, s3, 33792
s_add_u32 s3, s3, s56
Zvaa 164,4,60
s_waitcnt lgkmcnt(6)
Ra 76,11,6144
Zvaa 56,8,32
s_and_b32 s39, s2, 1
s_lshl_b32 s39, s39, 7
s_add_u32 s3, s3, s39
Zvaa 72,8,36
Ta 112,16,16384
Ta 114,16,18432
Zvaa 88,8,40
s_add_u32 s39, s3, 4096
Zvaa 104,8,44
Ra 80,11,8192
Zvaa 120,8,48
Zvaa 136,8,52
Ta 116,17,16384
Ta 118,17,18432
Zvaa 152,8,56
Zvaa 168,8,60
s_waitcnt lgkmcnt(6)
Ra 84,11,10240
Zvaa 60,12,32
Zvaa 76,12,36
Ta 120,18,16384
Ta 122,18,18432
Zvaa 92,12,40
Zvaa 108,12,44
Ra 88,11,12288
Zvaa 124,12,48
Zvaa 140,12,52
Ta 124,19,16384
Ta 126,19,18432
Zvaa 156,12,56
Zvaa 172,12,60
s_waitcnt lgkmcnt(6)
Ra 92,11,14336
Zvaa 176,16,32
Zvaa 192,16,36
Zvaa 208,16,40
Zvaa 224,16,44
Zvaa 240,16,48
Zaaa 128,16,52
Zaaa 144,16,56
Zaaa 160,16,60
Zvaa 180,20,32
Zvaa 196,20,36
Zvaa 212,20,40
Zvaa 228,20,44
Zvaa 244,20,48
Zaaa 132,20,52
Zaaa 148,20,56
Zaaa 164,20,60
Zvaa 184,24,32
Zvaa 200,24,36
Zvaa 216,24,40
Zvaa 232,24,44
Zvaa 248,24,48
Zaaa 136,24,52
Zaaa 152,24,56
Zaaa 168,24,60
Zvaa 188,28,32
Zvaa 204,28,36
Zvaa 220,28,40
Zvaa 236,28,44
Zvaa 252,28,48
Zaaa 140,28,52
Zaaa 156,28,56
Zaaa 172,28,60
s_waitcnt vmcnt(6) lgkmcnt(0)
s_add_u32 m0, s57, 0
s_barrier
Mvaa 48,64,96
buffer_load_dwordx4 v6, s[12:15], s52 offen offset:0 nt lds
Mvaa 64,64,100
Ta 32,22,0
Ta 34,22,2048
Mvaa 80,64,104
Mvaa 96,64,108
Ra 0,20,0
Mvaa 112,64,112
buffer_load_dwordx4 v7, s[12:15], s53 offen offset:1024 nt lds
Mvaa 128,64,116
s_waitcnt lgkmcnt(6)
Ta 36,23,0
Ta 38,23,2048
Mvaa 144,64,120
Mvaa 160,64,124
Ra 4,20,2048
Mvaa 52,68,96
buffer_load_dwordx4 v6, s[12:15], s54 offen offset:2048 nt lds
Mvaa 68,68,100
Ta 40,24,0
Ta 42,24,2048
Mvaa 84,68,104
Mvaa 100,68,108
Ra 8,20,4096
Mvaa 116,68,112
buffer_load_dwordx4 v7, s[12:15], s55 offen offset:3072 nt lds
Mvaa 132,68,116
s_waitcnt lgkmcnt(6)
Ta 44,25,0
Ta 46,25,2048
Mvaa 148,68,120
Mvaa 164,68,124
s_add_u32 m0, s57, 4096
Ra 12,20,6144
Mvaa 56,72,96
buffer_load_dwordx4 v8, s[12:15], s52 offen offset:0 nt lds
Mvaa 72,72,100
Ta 48,26,0
Ta 50,26,2048
Mvaa 88,72,104
Mvaa 104,72,108
Ra 16,20,8192
Mvaa 120,72,112
buffer_load_dwordx4 v9, s[12:15], s53 offen offset:1024 nt lds
Mvaa 136,72,116
s_waitcnt lgkmcnt(6)
Ta 52,27,0
Ta 54,27,2048
Mvaa 152,72,120
Mvaa 168,72,124
Ra 20,20,10240
Mvaa 60,76,96
buffer_load_dwordx4 v8, s[12:15], s54 offen offset:2048 nt lds
Mvaa 76,76,100
Ta 56,28,0
Ta 58,28,2048
Mvaa 92,76,104
Mvaa 108,76,108
Ra 24,20,12288
Mvaa 124,76,112
buffer_load_dwordx4 v9, s[12:15], s55 offen offset:3072 nt lds
Mvaa 140,76,116
s_waitcnt lgkmcnt(6)
Ta 60,29,0
Ta 62,29,2048
Mvaa 156,76,120
v_add_u32 v6, 524288, v6
v_add_u32 v7, 524288, v7
Mvaa 172,76,124
s_add_u32 m0, s56, 0
Ra 28,20,14336
v_add_u32 v8, 524288, v8
Mvaa 176,80,96
buffer_load_dwordx4 v2, s[8:11], s48 offen offset:0 lds
Mvaa 192,80,100
v_add_u32 v9, 524288, v9
Mvaa 208,80,104
Mvaa 224,80,108
Mvaa 240,80,112
buffer_load_dwordx4 v3, s[8:11], s49 offen offset:1024 lds
Maaa 128,80,116
Maaa 144,80,120
Maaa 160,80,124
Mvaa 180,84,96
buffer_load_dwordx4 v2, s[8:11], s50 offen offset:2048 lds
Mvaa 196,84,100
Mvaa 212,84,104
Mvaa 228,84,108
Mvaa 244,84,112
buffer_load_dwordx4 v3, s[8:11], s51 offen offset:3072 lds
Maaa 132,84,116
Maaa 148,84,120
Maaa 164,84,124
s_add_u32 m0, s56, 4096
Mvaa 184,88,96
buffer_load_dwordx4 v4, s[8:11], s48 offen offset:0 lds
Mvaa 200,88,100
Mvaa 216,88,104
Mvaa 232,88,108
Mvaa 248,88,112
buffer_load_dwordx4 v5, s[8:11], s49 offen offset:1024 lds
Maaa 136,88,116
Maaa 152,88,120
Maaa 168,88,124
Mvaa 188,92,96
buffer_load_dwordx4 v4, s[8:11], s50 offen offset:2048 lds
Mvaa 204,92,100
Mvaa 220,92,104
Mvaa 236,92,108
Mvaa 252,92,112
buffer_load_dwordx4 v5, s[8:11], s51 offen offset:3072 lds
Maaa 140,92,116
v_add_u32 v2, 128, v2
v_add_u32 v3, 128, v3
Maaa 156,92,120
buffer_load_dword v1, v47, s[60:63], 0 offen
v_add_u32 v4, 128, v4
v_add_u32 v5, 128, v5
Maaa 172,92,124
v_add_u32 v47, s59, v47
s_waitcnt lgkmcnt(0)
Mvaa 48,0,32
buffer_store_dwordx4 v[30:33], v46, s[20:23], s3 offen offset:0 sc1
Mvaa 64,0,36
Ta 96,22,16384
Ta 98,22,18432
Mvaa 80,0,40
buffer_store_dwordx4 v[34:37], v46, s[20:23], s3 offen offset:2048 sc1
Mvaa 96,0,44
Ra 64,21,0
Mvaa 112,0,48
buffer_store_dwordx4 v[38:41], v46, s[20:23], s39 offen offset:0 sc1
Mvaa 128,0,52
Ta 100,23,16384
Ta 102,23,18432
Mvaa 144,0,56
buffer_store_dwordx4 v[42:45], v46, s[20:23], s39 offen offset:2048 sc1
Mvaa 160,0,60
s_waitcnt lgkmcnt(6)
Ra 68,21,2048
Mvaa 52,4,32
s_lshl_b32 s3, s34, 1
s_and_b32 s36, s32, 1
s_add_u32 s3, s3, s36
Mvaa 68,4,36
Ta 104,24,16384
Ta 106,24,18432
Mvaa 84,4,40
s_mul_i32 s3, s3, 1116160
s_mul_i32 s36, s33, 139264
s_add_u32 s3, s3, s36
Mvaa 100,4,44
Ra 72,21,4096
Mvaa 116,4,48
s_lshr_b32 s36, s32, 1
s_mul_i32 s36, s36, 69632
s_add_u32 s3, s3, s36
Mvaa 132,4,52
Ta 108,25,16384
Ta 110,25,18432
Mvaa 148,4,56
s_add_u32 s38, s3, 17408
s_lshl_b32 s39, s34, 7
s_lshl_b32 s36, s33, 2
Mvaa 164,4,60
s_waitcnt lgkmcnt(6)
Ra 76,21,6144
Mvaa 56,8,32
s_add_u32 s39, s39, s36
s_add_u32 s39, s39, 5296160
v_mov_b32_e64 v30, 1
Mvaa 72,8,36
Ta 112,26,16384
Ta 114,26,18432
Mvaa 88,8,40
v_mov_b32_e64 v31, 0
Mvaa 104,8,44
Ra 80,21,8192
Mvaa 120,8,48
s_cmp_eq_u32 s32, 0
s_cselect_b32 s39, s39, 2146435072
Mvaa 136,8,52
Ta 116,27,16384
Ta 118,27,18432
Mvaa 152,8,56
s_mov_b64 exec, 1
buffer_store_dword v31, v31, s[20:23], s39 offen sc1
s_mov_b64 exec, -1
Mvaa 168,8,60
s_waitcnt lgkmcnt(6)
Ra 84,21,10240
Mvaa 60,12,32
s_and_b32 s33, s2, 7
s_lshl_b32 s33, s33, 2
s_bfe_u32 s3, s2, 0x20003
Mvaa 76,12,36
Ta 120,28,16384
Ta 122,28,18432
Mvaa 92,12,40
s_add_u32 s33, s33, s3
s_lshr_b32 s34, s2, 5
s_lshl_b32 s64, s34, 7
Mvaa 108,12,44
Ra 88,21,12288
Mvaa 124,12,48
s_lshl_b32 s3, s33, 2
s_add_u32 s64, s64, s3
s_add_u32 s64, s64, 5300224
Mvaa 140,12,52
Ta 124,29,16384
Ta 126,29,18432
Mvaa 156,12,56
s_lshl_b32 s65, s34, 8
s_sub_u32 s65, 1920, s65
v_mul_u32_u24_e64 v32, s65, v0
Mvaa 172,12,60
s_waitcnt lgkmcnt(6)
Ra 92,21,14336
Mvaa 176,16,32
s_cmp_eq_u32 s32, 0
s_cselect_b32 s64, s64, 2146435072
Mvaa 192,16,36
s_mov_b64 exec, 3
buffer_store_dword v31, v32, s[20:23], s64 offen sc1
s_mov_b64 exec, -1
Mvaa 208,16,40
s_lshl_b32 s35, s34, 1
s_sub_u32 s36, 32, s35
s_add_u32 s35, s35, 2
Mvaa 224,16,44
s_lshl_b32 s44, s32, 12
s_mov_b32 s58, 33792
s_sub_u32 s3, 15, s34
Mvaa 240,16,48
s_lshl_b32 s45, s3, 2
s_add_u32 s45, s45, s32
s_lshl_b32 s46, s34, 2
Maaa 128,16,52
s_add_u32 s46, s46, s32
s_mov_b32 s68, s42
s_and_b32 s69, s43, 0xffff
Maaa 144,16,56
s_mov_b32 s70, 7340032
s_mov_b32 s71, 0x20000
s_cmp_eq_u32 s32, 0
s_cselect_b32 s37, 0, 2146435072
Maaa 160,16,60
s_lshl_b32 s3, s33, 8
s_add_u32 s16, s4, s3
s_addc_u32 s17, s5, 0
s_and_b32 s17, s17, 0xffff
Mvaa 180,20,32
s_mov_b32 s18, 0
s_mov_b32 s19, 0x20000
s_sub_u32 s18, 8388608, s3
Mvaa 196,20,36
v_and_b32 v33, 63, v0
v_lshrrev_b32_e64 v32, 1, v33
Mvaa 212,20,40
v_and_b32 v33, 1, v0
v_lshlrev_b32 v32, 13, v32
Mvaa 228,20,44
v_lshl_add_u32 v45, v33, 7, v32
Mvaa 244,20,48
s_lshl_b32 s3, s32, 3
s_add_u32 s3, s3, s34
s_mul_i32 s47, s3, 262144
Maaa 132,20,52
Maaa 148,20,56
Maaa 164,20,60
Mvaa 184,24,32
Mvaa 200,24,36
Mvaa 216,24,40
Mvaa 232,24,44
Mvaa 248,24,48
Maaa 136,24,52
Maaa 152,24,56
Maaa 168,24,60
Mvaa 188,28,32
Mvaa 204,28,36
Mvaa 220,28,40
Mvaa 236,28,44
Mvaa 252,28,48
Maaa 140,28,52
Maaa 156,28,56
Maaa 172,28,60
s_waitcnt vmcnt(7) lgkmcnt(0)
s_add_u32 m0, s57, 65536
s_barrier
Mvaa 48,64,96
buffer_load_dwordx4 v6, s[12:15], s52 offen offset:0 nt lds
Mvaa 64,64,100
Ta 32,12,0
Ta 34,12,2048
Mvaa 80,64,104
Mvaa 96,64,108
Ra 0,10,0
Mvaa 112,64,112
buffer_load_dwordx4 v7, s[12:15], s53 offen offset:1024 nt lds
Mvaa 128,64,116
s_waitcnt lgkmcnt(6)
Ta 36,13,0
Ta 38,13,2048
Mvaa 144,64,120
Mvaa 160,64,124
Ra 4,10,2048
Mvaa 52,68,96
buffer_load_dwordx4 v6, s[12:15], s54 offen offset:2048 nt lds
Mvaa 68,68,100
Ta 40,14,0
Ta 42,14,2048
Mvaa 84,68,104
Mvaa 100,68,108
Ra 8,10,4096
Mvaa 116,68,112
buffer_load_dwordx4 v7, s[12:15], s55 offen offset:3072 nt lds
Mvaa 132,68,116
s_waitcnt lgkmcnt(6)
Ta 44,15,0
Ta 46,15,2048
Mvaa 148,68,120
Mvaa 164,68,124
s_add_u32 m0, s57, 69632
Ra 12,10,6144
Mvaa 56,72,96
buffer_load_dwordx4 v8, s[12:15], s52 offen offset:0 nt lds
Mvaa 72,72,100
Ta 48,16,0
Ta 50,16,2048
Mvaa 88,72,104
Mvaa 104,72,108
Ra 16,10,8192
Mvaa 120,72,112
buffer_load_dwordx4 v9, s[12:15], s53 offen offset:1024 nt lds
Mvaa 136,72,116
s_waitcnt lgkmcnt(6)
Ta 52,17,0
Ta 54,17,2048
Mvaa 152,72,120
Mvaa 168,72,124
Ra 20,10,10240
Mvaa 60,76,96
buffer_load_dwordx4 v8, s[12:15], s54 offen offset:2048 nt lds
Mvaa 76,76,100
Ta 56,18,0
Ta 58,18,2048
Mvaa 92,76,104
Mvaa 108,76,108
Ra 24,10,12288
Mvaa 124,76,112
buffer_load_dwordx4 v9, s[12:15], s55 offen offset:3072 nt lds
Mvaa 140,76,116
s_waitcnt lgkmcnt(6)
Ta 60,19,0
Ta 62,19,2048
Mvaa 156,76,120
v_add_u32 v6, 524288, v6
v_add_u32 v7, 524288, v7
Mvaa 172,76,124
s_add_u32 m0, s56, 65536
Ra 28,10,14336
v_add_u32 v8, 524288, v8
Mvaa 176,80,96
buffer_load_dwordx4 v2, s[8:11], s48 offen offset:0 lds
Mvaa 192,80,100
v_add_u32 v9, 524288, v9
Mvaa 208,80,104
Mvaa 224,80,108
Mvaa 240,80,112
buffer_load_dwordx4 v3, s[8:11], s49 offen offset:1024 lds
Maaa 128,80,116
Maaa 144,80,120
Maaa 160,80,124
Mvaa 180,84,96
buffer_load_dwordx4 v2, s[8:11], s50 offen offset:2048 lds
Mvaa 196,84,100
Mvaa 212,84,104
Mvaa 228,84,108
Mvaa 244,84,112
buffer_load_dwordx4 v3, s[8:11], s51 offen offset:3072 lds
Maaa 132,84,116
Maaa 148,84,120
Maaa 164,84,124
s_add_u32 m0, s56, 69632
Mvaa 184,88,96
buffer_load_dwordx4 v4, s[8:11], s48 offen offset:0 lds
Mvaa 200,88,100
Mvaa 216,88,104
Mvaa 232,88,108
Mvaa 248,88,112
buffer_load_dwordx4 v5, s[8:11], s49 offen offset:1024 lds
Maaa 136,88,116
Maaa 152,88,120
Maaa 168,88,124
Mvaa 188,92,96
buffer_load_dwordx4 v4, s[8:11], s50 offen offset:2048 lds
Mvaa 204,92,100
Mvaa 220,92,104
Mvaa 236,92,108
Mvaa 252,92,112
buffer_load_dwordx4 v5, s[8:11], s51 offen offset:3072 lds
Maaa 140,92,116
v_add_u32 v2, 128, v2
v_add_u32 v3, 128, v3
Maaa 156,92,120
buffer_load_dword v1, v47, s[60:63], 0 offen
v_add_u32 v4, 128, v4
v_add_u32 v5, 128, v5
Maaa 172,92,124
v_add_u32 v47, s59, v47
s_waitcnt lgkmcnt(0)
Mvaa 48,0,32
Mvaa 64,0,36
Ta 96,12,16384
Ta 98,12,18432
Mvaa 80,0,40
Mvaa 96,0,44
Ra 64,11,0
Mvaa 112,0,48
Mvaa 128,0,52
Ta 100,13,16384
Ta 102,13,18432
Mvaa 144,0,56
Mvaa 160,0,60
s_waitcnt lgkmcnt(6)
Ra 68,11,2048
Mvaa 52,4,32
Mvaa 68,4,36
Ta 104,14,16384
Ta 106,14,18432
Mvaa 84,4,40
Mvaa 100,4,44
Ra 72,11,4096
Mvaa 116,4,48
Mvaa 132,4,52
Ta 108,15,16384
Ta 110,15,18432
Mvaa 148,4,56
Mvaa 164,4,60
s_waitcnt lgkmcnt(6)
Ra 76,11,6144
Mvaa 56,8,32
Mvaa 72,8,36
Ta 112,16,16384
Ta 114,16,18432
Mvaa 88,8,40
Mvaa 104,8,44
Ra 80,11,8192
Mvaa 120,8,48
Mvaa 136,8,52
Ta 116,17,16384
Ta 118,17,18432
Mvaa 152,8,56
Mvaa 168,8,60
s_waitcnt lgkmcnt(6)
Ra 84,11,10240
Mvaa 60,12,32
Mvaa 76,12,36
Ta 120,18,16384
Ta 122,18,18432
Mvaa 92,12,40
Mvaa 108,12,44
Ra 88,11,12288
Mvaa 124,12,48
Mvaa 140,12,52
Ta 124,19,16384
Ta 126,19,18432
Mvaa 156,12,56
Mvaa 172,12,60
s_waitcnt lgkmcnt(6)
Ra 92,11,14336
Mvaa 176,16,32
Mvaa 192,16,36
Mvaa 208,16,40
Mvaa 224,16,44
Mvaa 240,16,48
Maaa 128,16,52
Maaa 144,16,56
Maaa 160,16,60
Mvaa 180,20,32
Mvaa 196,20,36
Mvaa 212,20,40
Mvaa 228,20,44
Mvaa 244,20,48
Maaa 132,20,52
Maaa 148,20,56
Maaa 164,20,60
Mvaa 184,24,32
Mvaa 200,24,36
Mvaa 216,24,40
Mvaa 232,24,44
Mvaa 248,24,48
Maaa 136,24,52
Maaa 152,24,56
Maaa 168,24,60
Mvaa 188,28,32
Mvaa 204,28,36
Mvaa 220,28,40
Mvaa 236,28,44
Mvaa 252,28,48
Maaa 140,28,52
Maaa 156,28,56
Maaa 172,28,60
s_waitcnt vmcnt(1) lgkmcnt(0)
s_add_u32 m0, s57, 0
s_barrier
Mvaa 48,64,96
buffer_load_dwordx4 v6, s[12:15], s52 offen offset:0 nt lds
Mvaa 64,64,100
Ta 32,22,0
Ta 34,22,2048
Mvaa 80,64,104
Mvaa 96,64,108
Ra 0,20,0
Mvaa 112,64,112
buffer_load_dwordx4 v7, s[12:15], s53 offen offset:1024 nt lds
Mvaa 128,64,116
s_waitcnt lgkmcnt(6)
Ta 36,23,0
Ta 38,23,2048
Mvaa 144,64,120
Mvaa 160,64,124
Ra 4,20,2048
Mvaa 52,68,96
buffer_load_dwordx4 v6, s[12:15], s54 offen offset:2048 nt lds
Mvaa 68,68,100
Ta 40,24,0
Ta 42,24,2048
Mvaa 84,68,104
Mvaa 100,68,108
Ra 8,20,4096
Mvaa 116,68,112
buffer_load_dwordx4 v7, s[12:15], s55 offen offset:3072 nt lds
Mvaa 132,68,116
s_waitcnt lgkmcnt(6)
Ta 44,25,0
Ta 46,25,2048
Mvaa 148,68,120
Mvaa 164,68,124
s_add_u32 m0, s57, 4096
Ra 12,20,6144
Mvaa 56,72,96
buffer_load_dwordx4 v8, s[12:15], s52 offen offset:0 nt lds
Mvaa 72,72,100
Ta 48,26,0
Ta 50,26,2048
Mvaa 88,72,104
Mvaa 104,72,108
Ra 16,20,8192
Mvaa 120,72,112
buffer_load_dwordx4 v9, s[12:15], s53 offen offset:1024 nt lds
Mvaa 136,72,116
s_waitcnt lgkmcnt(6)
Ta 52,27,0
Ta 54,27,2048
Mvaa 152,72,120
Mvaa 168,72,124
Ra 20,20,10240
Mvaa 60,76,96
buffer_load_dwordx4 v8, s[12:15], s54 offen offset:2048 nt lds
Mvaa 76,76,100
Ta 56,28,0
Ta 58,28,2048
Mvaa 92,76,104
Mvaa 108,76,108
Ra 24,20,12288
Mvaa 124,76,112
buffer_load_dwordx4 v9, s[12:15], s55 offen offset:3072 nt lds
Mvaa 140,76,116
s_waitcnt lgkmcnt(6)
Ta 60,29,0
Ta 62,29,2048
Mvaa 156,76,120
v_add_u32 v6, 524288, v6
v_add_u32 v7, 524288, v7
Mvaa 172,76,124
s_add_u32 m0, s56, 0
Ra 28,20,14336
v_add_u32 v8, 524288, v8
Mvaa 176,80,96
buffer_load_dwordx4 v2, s[8:11], s48 offen offset:0 lds
Mvaa 192,80,100
v_add_u32 v9, 524288, v9
Mvaa 208,80,104
Mvaa 224,80,108
Mvaa 240,80,112
buffer_load_dwordx4 v3, s[8:11], s49 offen offset:1024 lds
Maaa 128,80,116
Maaa 144,80,120
Maaa 160,80,124
Mvaa 180,84,96
buffer_load_dwordx4 v2, s[8:11], s50 offen offset:2048 lds
Mvaa 196,84,100
Mvaa 212,84,104
Mvaa 228,84,108
Mvaa 244,84,112
buffer_load_dwordx4 v3, s[8:11], s51 offen offset:3072 lds
Maaa 132,84,116
Maaa 148,84,120
Maaa 164,84,124
s_add_u32 m0, s56, 4096
Mvaa 184,88,96
buffer_load_dwordx4 v4, s[8:11], s48 offen offset:0 lds
Mvaa 200,88,100
Mvaa 216,88,104
Mvaa 232,88,108
Mvaa 248,88,112
buffer_load_dwordx4 v5, s[8:11], s49 offen offset:1024 lds
Maaa 136,88,116
Maaa 152,88,120
Maaa 168,88,124
Mvaa 188,92,96
buffer_load_dwordx4 v4, s[8:11], s50 offen offset:2048 lds
Mvaa 204,92,100
Mvaa 220,92,104
Mvaa 236,92,108
Mvaa 252,92,112
buffer_load_dwordx4 v5, s[8:11], s51 offen offset:3072 lds
Maaa 140,92,116
v_add_u32 v2, 128, v2
v_add_u32 v3, 128, v3
Maaa 156,92,120
v_add_u32 v4, 128, v4
v_add_u32 v5, 128, v5
Maaa 172,92,124
s_waitcnt lgkmcnt(0)
Mvaa 48,0,32
s_mov_b64 exec, 1
buffer_atomic_add v30, v31, s[28:31], s37 offen sc1
s_mov_b64 exec, -1
Mvaa 64,0,36
Ta 96,22,16384
Ta 98,22,18432
Mvaa 80,0,40
Mvaa 96,0,44
Ra 64,21,0
Mvaa 112,0,48
Mvaa 128,0,52
Ta 100,23,16384
Ta 102,23,18432
Mvaa 144,0,56
Mvaa 160,0,60
s_waitcnt lgkmcnt(6)
Ra 68,21,2048
Mvaa 52,4,32
Mvaa 68,4,36
Ta 104,24,16384
Ta 106,24,18432
Mvaa 84,4,40
Mvaa 100,4,44
Ra 72,21,4096
Mvaa 116,4,48
Mvaa 132,4,52
Ta 108,25,16384
Ta 110,25,18432
Mvaa 148,4,56
Mvaa 164,4,60
s_waitcnt lgkmcnt(6)
Ra 76,21,6144
Mvaa 56,8,32
Mvaa 72,8,36
Ta 112,26,16384
Ta 114,26,18432
Mvaa 88,8,40
Mvaa 104,8,44
Ra 80,21,8192
Mvaa 120,8,48
Mvaa 136,8,52
Ta 116,27,16384
Ta 118,27,18432
Mvaa 152,8,56
Mvaa 168,8,60
s_waitcnt lgkmcnt(6)
Ra 84,21,10240
Mvaa 60,12,32
Mvaa 76,12,36
Ta 120,28,16384
Ta 122,28,18432
Mvaa 92,12,40
Mvaa 108,12,44
Ra 88,21,12288
Mvaa 124,12,48
Mvaa 140,12,52
Ta 124,29,16384
Ta 126,29,18432
Mvaa 156,12,56
Mvaa 172,12,60
s_waitcnt lgkmcnt(6)
Ra 92,21,14336
Mvaa 176,16,32
Mvaa 192,16,36
Mvaa 208,16,40
Mvaa 224,16,44
Mvaa 240,16,48
Maaa 128,16,52
Maaa 144,16,56
Maaa 160,16,60
Mvaa 180,20,32
Mvaa 196,20,36
Mvaa 212,20,40
Mvaa 228,20,44
Mvaa 244,20,48
Maaa 132,20,52
Maaa 148,20,56
Maaa 164,20,60
Mvaa 184,24,32
Mvaa 200,24,36
Mvaa 216,24,40
Mvaa 232,24,44
Mvaa 248,24,48
Maaa 136,24,52
Maaa 152,24,56
Maaa 168,24,60
Mvaa 188,28,32
Mvaa 204,28,36
Mvaa 220,28,40
Mvaa 236,28,44
Mvaa 252,28,48
Maaa 140,28,52
Maaa 156,28,56
Maaa 172,28,60
s_waitcnt vmcnt(1) lgkmcnt(0)
s_add_u32 m0, s57, 65536
s_barrier
Mvaa 48,64,96
buffer_load_dwordx4 v6, s[12:15], s52 offen offset:0 nt lds
Mvaa 64,64,100
Ta 32,12,0
Ta 34,12,2048
Mvaa 80,64,104
Mvaa 96,64,108
Ra 0,10,0
Mvaa 112,64,112
buffer_load_dwordx4 v7, s[12:15], s53 offen offset:1024 nt lds
Mvaa 128,64,116
s_waitcnt lgkmcnt(6)
Ta 36,13,0
Ta 38,13,2048
Mvaa 144,64,120
Mvaa 160,64,124
Ra 4,10,2048
Mvaa 52,68,96
buffer_load_dwordx4 v6, s[12:15], s54 offen offset:2048 nt lds
Mvaa 68,68,100
Ta 40,14,0
Ta 42,14,2048
Mvaa 84,68,104
Mvaa 100,68,108
Ra 8,10,4096
Mvaa 116,68,112
buffer_load_dwordx4 v7, s[12:15], s55 offen offset:3072 nt lds
Mvaa 132,68,116
s_waitcnt lgkmcnt(6)
Ta 44,15,0
Ta 46,15,2048
Mvaa 148,68,120
Mvaa 164,68,124
s_add_u32 m0, s57, 69632
Ra 12,10,6144
Mvaa 56,72,96
buffer_load_dwordx4 v8, s[12:15], s52 offen offset:0 nt lds
Mvaa 72,72,100
Ta 48,16,0
Ta 50,16,2048
Mvaa 88,72,104
Mvaa 104,72,108
Ra 16,10,8192
Mvaa 120,72,112
buffer_load_dwordx4 v9, s[12:15], s53 offen offset:1024 nt lds
Mvaa 136,72,116
s_waitcnt lgkmcnt(6)
Ta 52,17,0
Ta 54,17,2048
Mvaa 152,72,120
Mvaa 168,72,124
Ra 20,10,10240
Mvaa 60,76,96
buffer_load_dwordx4 v8, s[12:15], s54 offen offset:2048 nt lds
Mvaa 76,76,100
Ta 56,18,0
Ta 58,18,2048
Mvaa 92,76,104
Mvaa 108,76,108
Ra 24,10,12288
Mvaa 124,76,112
buffer_load_dwordx4 v9, s[12:15], s55 offen offset:3072 nt lds
Mvaa 140,76,116
s_waitcnt lgkmcnt(6)
Ta 60,19,0
Ta 62,19,2048
Mvaa 156,76,120
v_add_u32 v6, 524288, v6
v_add_u32 v7, 524288, v7
Mvaa 172,76,124
s_add_u32 m0, s56, 65536
Ra 28,10,14336
v_add_u32 v8, 524288, v8
Mvaa 176,80,96
buffer_load_dwordx4 v2, s[8:11], s48 offen offset:0 lds
Mvaa 192,80,100
v_add_u32 v9, 524288, v9
Mvaa 208,80,104
Mvaa 224,80,108
Mvaa 240,80,112
buffer_load_dwordx4 v3, s[8:11], s49 offen offset:1024 lds
Maaa 128,80,116
Maaa 144,80,120
Maaa 160,80,124
Mvaa 180,84,96
buffer_load_dwordx4 v2, s[8:11], s50 offen offset:2048 lds
Mvaa 196,84,100
Mvaa 212,84,104
Mvaa 228,84,108
Mvaa 244,84,112
buffer_load_dwordx4 v3, s[8:11], s51 offen offset:3072 lds
Maaa 132,84,116
Maaa 148,84,120
Maaa 164,84,124
s_add_u32 m0, s56, 69632
Mvaa 184,88,96
buffer_load_dwordx4 v4, s[8:11], s48 offen offset:0 lds
Mvaa 200,88,100
Mvaa 216,88,104
Mvaa 232,88,108
Mvaa 248,88,112
buffer_load_dwordx4 v5, s[8:11], s49 offen offset:1024 lds
Maaa 136,88,116
Maaa 152,88,120
Maaa 168,88,124
Mvaa 188,92,96
buffer_load_dwordx4 v4, s[8:11], s50 offen offset:2048 lds
Mvaa 204,92,100
Mvaa 220,92,104
Mvaa 236,92,108
Mvaa 252,92,112
buffer_load_dwordx4 v5, s[8:11], s51 offen offset:3072 lds
Maaa 140,92,116
v_add_u32 v2, 128, v2
v_add_u32 v3, 128, v3
Maaa 156,92,120
v_add_u32 v4, 128, v4
v_add_u32 v5, 128, v5
Maaa 172,92,124
s_waitcnt lgkmcnt(0)
Mvaa 48,0,32
Mvaa 64,0,36
Ta 96,12,16384
Ta 98,12,18432
Mvaa 80,0,40
Mvaa 96,0,44
Ra 64,11,0
Mvaa 112,0,48
Mvaa 128,0,52
Ta 100,13,16384
Ta 102,13,18432
Mvaa 144,0,56
Mvaa 160,0,60
s_waitcnt lgkmcnt(6)
Ra 68,11,2048
Mvaa 52,4,32
Mvaa 68,4,36
Ta 104,14,16384
Ta 106,14,18432
Mvaa 84,4,40
Mvaa 100,4,44
Ra 72,11,4096
Mvaa 116,4,48
Mvaa 132,4,52
Ta 108,15,16384
Ta 110,15,18432
Mvaa 148,4,56
Mvaa 164,4,60
s_waitcnt lgkmcnt(6)
Ra 76,11,6144
Mvaa 56,8,32
Mvaa 72,8,36
Ta 112,16,16384
Ta 114,16,18432
Mvaa 88,8,40
Mvaa 104,8,44
Ra 80,11,8192
Mvaa 120,8,48
Mvaa 136,8,52
Ta 116,17,16384
Ta 118,17,18432
Mvaa 152,8,56
Mvaa 168,8,60
s_waitcnt lgkmcnt(6)
Ra 84,11,10240
Mvaa 60,12,32
Mvaa 76,12,36
Ta 120,18,16384
Ta 122,18,18432
Mvaa 92,12,40
Mvaa 108,12,44
Ra 88,11,12288
Mvaa 124,12,48
Mvaa 140,12,52
Ta 124,19,16384
Ta 126,19,18432
Mvaa 156,12,56
Mvaa 172,12,60
s_waitcnt lgkmcnt(6)
Ra 92,11,14336
Mvaa 176,16,32
Mvaa 192,16,36
Mvaa 208,16,40
Mvaa 224,16,44
Mvaa 240,16,48
Maaa 128,16,52
Maaa 144,16,56
Maaa 160,16,60
Mvaa 180,20,32
Mvaa 196,20,36
Mvaa 212,20,40
Mvaa 228,20,44
Mvaa 244,20,48
Maaa 132,20,52
Maaa 148,20,56
Maaa 164,20,60
Mvaa 184,24,32
Mvaa 200,24,36
Mvaa 216,24,40
Mvaa 232,24,44
Mvaa 248,24,48
Maaa 136,24,52
Maaa 152,24,56
Maaa 168,24,60
Mvaa 188,28,32
Mvaa 204,28,36
Mvaa 220,28,40
Mvaa 236,28,44
Mvaa 252,28,48
Maaa 140,28,52
Maaa 156,28,56
Maaa 172,28,60
s_waitcnt vmcnt(0) lgkmcnt(0)
s_add_u32 m0, s57, 0
s_barrier
Mvaa 48,64,96
buffer_load_dwordx4 v6, s[12:15], s52 offen offset:0 nt lds
Mvaa 64,64,100
Ta 32,22,0
Ta 34,22,2048
Mvaa 80,64,104
Mvaa 96,64,108
Ra 0,20,0
Mvaa 112,64,112
buffer_load_dwordx4 v7, s[12:15], s53 offen offset:1024 nt lds
Mvaa 128,64,116
s_waitcnt lgkmcnt(6)
Ta 36,23,0
Ta 38,23,2048
Mvaa 144,64,120
Mvaa 160,64,124
Ra 4,20,2048
Mvaa 52,68,96
buffer_load_dwordx4 v6, s[12:15], s54 offen offset:2048 nt lds
Mvaa 68,68,100
Ta 40,24,0
Ta 42,24,2048
Mvaa 84,68,104
Mvaa 100,68,108
Ra 8,20,4096
Mvaa 116,68,112
buffer_load_dwordx4 v7, s[12:15], s55 offen offset:3072 nt lds
Mvaa 132,68,116
s_waitcnt lgkmcnt(6)
Ta 44,25,0
Ta 46,25,2048
Mvaa 148,68,120
Mvaa 164,68,124
s_add_u32 m0, s57, 4096
Ra 12,20,6144
Mvaa 56,72,96
buffer_load_dwordx4 v8, s[12:15], s52 offen offset:0 nt lds
Mvaa 72,72,100
Ta 48,26,0
Ta 50,26,2048
Mvaa 88,72,104
Mvaa 104,72,108
Ra 16,20,8192
Mvaa 120,72,112
buffer_load_dwordx4 v9, s[12:15], s53 offen offset:1024 nt lds
Mvaa 136,72,116
s_waitcnt lgkmcnt(6)
Ta 52,27,0
Ta 54,27,2048
Mvaa 152,72,120
Mvaa 168,72,124
Ra 20,20,10240
Mvaa 60,76,96
buffer_load_dwordx4 v8, s[12:15], s54 offen offset:2048 nt lds
Mvaa 76,76,100
Ta 56,28,0
Ta 58,28,2048
Mvaa 92,76,104
Mvaa 108,76,108
Ra 24,20,12288
Mvaa 124,76,112
buffer_load_dwordx4 v9, s[12:15], s55 offen offset:3072 nt lds
Mvaa 140,76,116
s_waitcnt lgkmcnt(6)
Ta 60,29,0
Ta 62,29,2048
Mvaa 156,76,120
v_add_u32 v6, 524288, v6
v_add_u32 v7, 524288, v7
Mvaa 172,76,124
s_add_u32 m0, s56, 0
Ra 28,20,14336
v_add_u32 v8, 524288, v8
Mvaa 176,80,96
buffer_load_dwordx4 v2, s[8:11], s48 offen offset:0 lds
Mvaa 192,80,100
v_add_u32 v9, 524288, v9
Mvaa 208,80,104
Mvaa 224,80,108
Mvaa 240,80,112
buffer_load_dwordx4 v3, s[8:11], s49 offen offset:1024 lds
Maaa 128,80,116
Maaa 144,80,120
Maaa 160,80,124
Mvaa 180,84,96
buffer_load_dwordx4 v2, s[8:11], s50 offen offset:2048 lds
Mvaa 196,84,100
Mvaa 212,84,104
Mvaa 228,84,108
Mvaa 244,84,112
buffer_load_dwordx4 v3, s[8:11], s51 offen offset:3072 lds
Maaa 132,84,116
Maaa 148,84,120
Maaa 164,84,124
s_add_u32 m0, s56, 4096
Mvaa 184,88,96
buffer_load_dwordx4 v4, s[8:11], s48 offen offset:0 lds
Mvaa 200,88,100
Mvaa 216,88,104
Mvaa 232,88,108
Mvaa 248,88,112
buffer_load_dwordx4 v5, s[8:11], s49 offen offset:1024 lds
Maaa 136,88,116
Maaa 152,88,120
Maaa 168,88,124
Mvaa 188,92,96
buffer_load_dwordx4 v4, s[8:11], s50 offen offset:2048 lds
Mvaa 204,92,100
Mvaa 220,92,104
Mvaa 236,92,108
Mvaa 252,92,112
buffer_load_dwordx4 v5, s[8:11], s51 offen offset:3072 lds
Maaa 140,92,116
v_add_u32 v2, 128, v2
v_add_u32 v3, 128, v3
Maaa 156,92,120
v_add_u32 v4, 128, v4
v_add_u32 v5, 128, v5
Maaa 172,92,124
s_waitcnt lgkmcnt(0)
Mvaa 48,0,32
buffer_load_dword v44, v45, s[16:19], s47 offen
Mvaa 64,0,36
Ta 96,22,16384
Ta 98,22,18432
Mvaa 80,0,40
s_add_u32 s47, s47, 8388608
v_lshrrev_b32 v32, 4, v0
v_and_b32_e64 v33, 15, v0
Mvaa 96,0,44
Ra 64,21,0
Mvaa 112,0,48
s_lshl_b32 s3, s32, 4
v_add_u32 v34, s3, v32
v_lshlrev_b32_e64 v36, 1, v32
Mvaa 128,0,52
Ta 100,23,16384
Ta 102,23,18432
Mvaa 144,0,56
v_xor_b32 v36, v36, v33
v_xor_b32 v37, 8, v36
Mvaa 160,0,60
s_waitcnt lgkmcnt(6)
Ra 68,21,2048
Mvaa 52,4,32
s_getpc_b64 s[6:7]
L_cpf3:
s_add_u32 s6, s6, (L_phase2-L_cpf3)&0xffffffff
s_addc_u32 s7, s7, ((L_phase2-L_cpf3)>>32)&0xffffffff
Mvaa 68,4,36
Ta 104,24,16384
Ta 106,24,18432
Mvaa 84,4,40
s_lshr_b32 s3, s2, 3
s_lshl_b32 s3, s3, 2
s_add_u32 s3, s3, s32
Mvaa 100,4,44
Ra 72,21,4096
Mvaa 116,4,48
s_lshl_b32 s3, s3, 10
v_and_b32 v42, 7, v0
v_lshlrev_b32 v42, 7, v42
Mvaa 132,4,52
Ta 108,25,16384
Ta 110,25,18432
Mvaa 148,4,56
v_add_u32_e64 v42, s3, v42
v_min_u32 v42, L_k2_fin-L_phase2-4, v42
Mvaa 164,4,60
s_waitcnt lgkmcnt(6)
Ra 76,21,6144
Mvaa 56,8,32
v_mov_b32 v41, s7
Mvaa 72,8,36
Ta 112,26,16384
Ta 114,26,18432
Mvaa 88,8,40
v_add_co_u32 v40, vcc, s6, v42
s_nop 1
v_addc_co_u32 v41, vcc, 0, v41, vcc
Mvaa 104,8,44
Ra 80,21,8192
Mvaa 120,8,48
global_load_dword v43, v[40:41], off
Mvaa 136,8,52
Ta 116,27,16384
Ta 118,27,18432
Mvaa 152,8,56
Mvaa 168,8,60
s_waitcnt lgkmcnt(6)
Ra 84,21,10240
Mvaa 60,12,32
Mvaa 76,12,36
Ta 120,28,16384
Ta 122,28,18432
Mvaa 92,12,40
Mvaa 108,12,44
Ra 88,21,12288
Mvaa 124,12,48
Mvaa 140,12,52
Ta 124,29,16384
Ta 126,29,18432
Mvaa 156,12,56
Mvaa 172,12,60
s_waitcnt lgkmcnt(6)
Ra 92,21,14336
Mvaa 176,16,32
Mvaa 192,16,36
Mvaa 208,16,40
Mvaa 224,16,44
Mvaa 240,16,48
Maaa 128,16,52
Maaa 144,16,56
Maaa 160,16,60
Mvaa 180,20,32
Mvaa 196,20,36
Mvaa 212,20,40
Mvaa 228,20,44
Mvaa 244,20,48
Maaa 132,20,52
Maaa 148,20,56
Maaa 164,20,60
Mvaa 184,24,32
Mvaa 200,24,36
Mvaa 216,24,40
Mvaa 232,24,44
Mvaa 248,24,48
Maaa 136,24,52
Maaa 152,24,56
Maaa 168,24,60
Mvaa 188,28,32
Mvaa 204,28,36
Mvaa 220,28,40
Mvaa 236,28,44
Mvaa 252,28,48
Maaa 140,28,52
Maaa 156,28,56
Maaa 172,28,60
s_waitcnt vmcnt(2) lgkmcnt(0)
s_add_u32 m0, s57, 65536
s_barrier
Mvaa 48,64,96
buffer_load_dwordx4 v6, s[12:15], s52 offen offset:0 nt lds
Mvaa 64,64,100
Ta 32,12,0
Ta 34,12,2048
Mvaa 80,64,104
Mvaa 96,64,108
Ra 0,10,0
Mvaa 112,64,112
buffer_load_dwordx4 v7, s[12:15], s53 offen offset:1024 nt lds
Mvaa 128,64,116
s_waitcnt lgkmcnt(6)
Ta 36,13,0
Ta 38,13,2048
Mvaa 144,64,120
Mvaa 160,64,124
Ra 4,10,2048
Mvaa 52,68,96
buffer_load_dwordx4 v6, s[12:15], s54 offen offset:2048 nt lds
Mvaa 68,68,100
Ta 40,14,0
Ta 42,14,2048
Mvaa 84,68,104
Mvaa 100,68,108
Ra 8,10,4096
Mvaa 116,68,112
buffer_load_dwordx4 v7, s[12:15], s55 offen offset:3072 nt lds
Mvaa 132,68,116
s_waitcnt lgkmcnt(6)
Ta 44,15,0
Ta 46,15,2048
Mvaa 148,68,120
Mvaa 164,68,124
s_add_u32 m0, s57, 69632
Ra 12,10,6144
Mvaa 56,72,96
buffer_load_dwordx4 v8, s[12:15], s52 offen offset:0 nt lds
Mvaa 72,72,100
Ta 48,16,0
Ta 50,16,2048
Mvaa 88,72,104
Mvaa 104,72,108
Ra 16,10,8192
Mvaa 120,72,112
buffer_load_dwordx4 v9, s[12:15], s53 offen offset:1024 nt lds
Mvaa 136,72,116
s_waitcnt lgkmcnt(6)
Ta 52,17,0
Ta 54,17,2048
Mvaa 152,72,120
Mvaa 168,72,124
Ra 20,10,10240
Mvaa 60,76,96
buffer_load_dwordx4 v8, s[12:15], s54 offen offset:2048 nt lds
Mvaa 76,76,100
Ta 56,18,0
Ta 58,18,2048
Mvaa 92,76,104
Mvaa 108,76,108
Ra 24,10,12288
Mvaa 124,76,112
buffer_load_dwordx4 v9, s[12:15], s55 offen offset:3072 nt lds
Mvaa 140,76,116
s_waitcnt lgkmcnt(6)
Ta 60,19,0
Ta 62,19,2048
Mvaa 156,76,120
v_add_u32 v6, 524288, v6
v_add_u32 v7, 524288, v7
Mvaa 172,76,124
s_add_u32 m0, s56, 65536
Ra 28,10,14336
v_add_u32 v8, 524288, v8
Mvaa 176,80,96
buffer_load_dwordx4 v2, s[8:11], s48 offen offset:0 lds
Mvaa 192,80,100
v_add_u32 v9, 524288, v9
Mvaa 208,80,104
Mvaa 224,80,108
Mvaa 240,80,112
buffer_load_dwordx4 v3, s[8:11], s49 offen offset:1024 lds
Maaa 128,80,116
Maaa 144,80,120
Maaa 160,80,124
Mvaa 180,84,96
buffer_load_dwordx4 v2, s[8:11], s50 offen offset:2048 lds
Mvaa 196,84,100
Mvaa 212,84,104
Mvaa 228,84,108
Mvaa 244,84,112
buffer_load_dwordx4 v3, s[8:11], s51 offen offset:3072 lds
Maaa 132,84,116
Maaa 148,84,120
Maaa 164,84,124
s_add_u32 m0, s56, 69632
Mvaa 184,88,96
buffer_load_dwordx4 v4, s[8:11], s48 offen offset:0 lds
Mvaa 200,88,100
Mvaa 216,88,104
Mvaa 232,88,108
Mvaa 248,88,112
buffer_load_dwordx4 v5, s[8:11], s49 offen offset:1024 lds
Maaa 136,88,116
Maaa 152,88,120
Maaa 168,88,124
Mvaa 188,92,96
buffer_load_dwordx4 v4, s[8:11], s50 offen offset:2048 lds
Mvaa 204,92,100
Mvaa 220,92,104
Mvaa 236,92,108
Mvaa 252,92,112
buffer_load_dwordx4 v5, s[8:11], s51 offen offset:3072 lds
Maaa 140,92,116
v_add_u32 v2, 128, v2
v_add_u32 v3, 128, v3
Maaa 156,92,120
v_add_u32 v4, 128, v4
v_add_u32 v5, 128, v5
Maaa 172,92,124
s_waitcnt lgkmcnt(0)
Mvaa 48,0,32
buffer_load_dword v30, v31, s[28:31], s37 offen sc1
Mvaa 64,0,36
Ta 96,12,16384
Ta 98,12,18432
Mvaa 80,0,40
s_mov_b32 s8, s16
s_mov_b32 s9, s17
s_mov_b32 s10, s18
Mvaa 96,0,44
Ra 64,11,0
Mvaa 112,0,48
s_add_u32 s16, s66, 46137344
s_addc_u32 s17, s67, 0
s_and_b32 s17, s17, 0xffff
Mvaa 128,0,52
Ta 100,13,16384
Ta 102,13,18432
Mvaa 144,0,56
s_mov_b32 s18, 16777216
s_mov_b32 s19, 0x20000
s_mov_b32 s48, 0
Mvaa 160,0,60
s_waitcnt lgkmcnt(6)
Ra 68,11,2048
Mvaa 52,4,32
s_mov_b32 s49, 31744
s_mov_b32 s50, 63488
s_mov_b32 s51, 95232
Mvaa 68,4,36
Ta 104,14,16384
Ta 106,14,18432
Mvaa 84,4,40
v_lshlrev_b32_e64 v35, 13, v34
v_lshl_add_u32 v8, v36, 4, v35
Mvaa 100,4,44
Ra 72,11,4096
Mvaa 116,4,48
v_lshl_add_u32 v9, v37, 4, v35
v_lshlrev_b32_e64 v2, 4, v0
Mvaa 132,4,52
Ta 108,15,16384
Ta 110,15,18432
Mvaa 148,4,56
v_add_u32 v3, 65536, v2
v_add_u32_e64 v4, s44, v2
Mvaa 164,4,60
s_waitcnt lgkmcnt(6)
Ra 76,11,6144
Mvaa 56,8,32
v_mov_b32 v7, 0
v_lshlrev_b32_e64 v35, 2, v32
Mvaa 72,8,36
Ta 112,16,16384
Ta 114,16,18432
Mvaa 88,8,40
v_sub_u32_e64 v35, v33, v35
Mvaa 104,8,44
Ra 80,11,8192
Mvaa 120,8,48
s_lshl_b32 s3, s45, 5
v_add_u32 v5, s3, v35
Mvaa 136,8,52
Ta 116,17,16384
Ta 118,17,18432
Mvaa 152,8,56
s_lshl_b32 s3, s46, 5
v_add_u32 v6, s3, v35
Mvaa 168,8,60
s_waitcnt lgkmcnt(6)
Ra 84,11,10240
Mvaa 60,12,32
s_mul_i32 s3, s33, 1116160
s_add_u32 s3, s3, 8388608
s_add_u32 s12, s66, s3
s_addc_u32 s13, s67, 0
s_and_b32 s13, s13, 0xffff
Mvaa 76,12,36
Ta 120,18,16384
Ta 122,18,18432
Mvaa 92,12,40
s_mov_b32 s14, 0
s_mov_b32 s15, 0x20000
s_mul_i32 s14, s36, 34816
Mvaa 108,12,44
Ra 88,11,12288
Mvaa 124,12,48
Mvaa 140,12,52
Ta 124,19,16384
Ta 126,19,18432
Mvaa 156,12,56
Mvaa 172,12,60
s_waitcnt lgkmcnt(6)
Ra 92,11,14336
Mvaa 176,16,32
Mvaa 192,16,36
Mvaa 208,16,40
Mvaa 224,16,44
Mvaa 240,16,48
Maaa 128,16,52
Maaa 144,16,56
Maaa 160,16,60
Mvaa 180,20,32
Mvaa 196,20,36
Mvaa 212,20,40
Mvaa 228,20,44
Mvaa 244,20,48
Maaa 132,20,52
Maaa 148,20,56
Maaa 164,20,60
Mvaa 184,24,32
Mvaa 200,24,36
Mvaa 216,24,40
Mvaa 232,24,44
Mvaa 248,24,48
Maaa 136,24,52
Maaa 152,24,56
Maaa 168,24,60
Mvaa 188,28,32
Mvaa 204,28,36
Mvaa 220,28,40
Mvaa 236,28,44
Mvaa 252,28,48
Maaa 140,28,52
Maaa 156,28,56
Maaa 172,28,60
s_waitcnt vmcnt(1) lgkmcnt(0)
s_add_u32 m0, s44, 0
s_barrier
Mvaa 48,64,96
buffer_load_dwordx4 v8, s[8:11], s48 offen offset:0 lds
Mvaa 64,64,100
Ta 32,22,0
Ta 34,22,2048
Mvaa 80,64,104
s_mul_i32 s3, s45, 67584
v_add_u32_e64 v10, s3, v2
Mvaa 96,64,108
Ra 0,20,0
Mvaa 112,64,112
buffer_load_dwordx4 v8, s[8:11], s49 offen offset:1024 lds
Mvaa 128,64,116
s_waitcnt lgkmcnt(6)
Ta 36,23,0
Ta 38,23,2048
Mvaa 144,64,120
s_mul_i32 s3, s46, 67584
v_add_u32 v11, s3, v2
Mvaa 160,64,124
Ra 4,20,2048
Mvaa 52,68,96
buffer_load_dwordx4 v9, s[8:11], s50 offen offset:2048 lds
Mvaa 68,68,100
Ta 40,24,0
Ta 42,24,2048
Mvaa 84,68,104
Mvaa 100,68,108
Ra 8,20,4096
Mvaa 116,68,112
buffer_load_dwordx4 v9, s[8:11], s51 offen offset:3072 lds
Mvaa 132,68,116
s_waitcnt lgkmcnt(6)
Ta 44,25,0
Ta 46,25,2048
Mvaa 148,68,120
v_add_u32 v8, 524288, v8
v_add_u32 v9, 524288, v9
Mvaa 164,68,124
s_add_u32 m0, s44, 16384
Ra 12,20,6144
Mvaa 56,72,96
buffer_load_dwordx4 v8, s[8:11], s48 offen offset:0 lds
Mvaa 72,72,100
Ta 48,26,0
Ta 50,26,2048
Mvaa 88,72,104
Mvaa 104,72,108
Ra 16,20,8192
Mvaa 120,72,112
buffer_load_dwordx4 v8, s[8:11], s49 offen offset:1024 lds
Mvaa 136,72,116
s_waitcnt lgkmcnt(6)
Ta 52,27,0
Ta 54,27,2048
Mvaa 152,72,120
Mvaa 168,72,124
Ra 20,20,10240
Mvaa 60,76,96
buffer_load_dwordx4 v9, s[8:11], s50 offen offset:2048 lds
Mvaa 76,76,100
Ta 56,28,0
Ta 58,28,2048
Mvaa 92,76,104
Mvaa 108,76,108
Ra 24,20,12288
Mvaa 124,76,112
buffer_load_dwordx4 v9, s[8:11], s51 offen offset:3072 lds
Mvaa 140,76,116
s_waitcnt lgkmcnt(6)
Ta 60,29,0
Ta 62,29,2048
Mvaa 156,76,120
v_add_u32 v8, 524288, v8
v_add_u32 v9, 524288, v9
Mvaa 172,76,124
s_add_u32 m0, s44, 32768
Ra 28,20,14336
Mvaa 176,80,96
buffer_load_dwordx4 v8, s[8:11], s48 offen offset:0 lds
Mvaa 192,80,100
Mvaa 208,80,104
Mvaa 224,80,108
Mvaa 240,80,112
buffer_load_dwordx4 v8, s[8:11], s49 offen offset:1024 lds
Maaa 128,80,116
Maaa 144,80,120
Maaa 160,80,124
Mvaa 180,84,96
buffer_load_dwordx4 v9, s[8:11], s50 offen offset:2048 lds
Mvaa 196,84,100
Mvaa 212,84,104
Mvaa 228,84,108
Mvaa 244,84,112
buffer_load_dwordx4 v9, s[8:11], s51 offen offset:3072 lds
Maaa 132,84,116
v_add_u32 v8, 524288, v8
v_add_u32 v9, 524288, v9
Maaa 148,84,120
Maaa 164,84,124
s_add_u32 m0, s44, 49152
Mvaa 184,88,96
buffer_load_dwordx4 v8, s[8:11], s48 offen offset:0 lds
Mvaa 200,88,100
Mvaa 216,88,104
Mvaa 232,88,108
Mvaa 248,88,112
buffer_load_dwordx4 v8, s[8:11], s49 offen offset:1024 lds
Maaa 136,88,116
Maaa 152,88,120
Maaa 168,88,124
Mvaa 188,92,96
buffer_load_dwordx4 v9, s[8:11], s50 offen offset:2048 lds
Mvaa 204,92,100
Mvaa 220,92,104
Mvaa 236,92,108
Mvaa 252,92,112
buffer_load_dwordx4 v9, s[8:11], s51 offen offset:3072 lds
Maaa 140,92,116
v_add_u32 v8, 524288, v8
v_add_u32 v9, 524288, v9
Maaa 156,92,120
Maaa 172,92,124
s_waitcnt lgkmcnt(0)
Mvaa 48,0,32
Mvaa 64,0,36
Ta 96,22,16384
Ta 98,22,18432
Mvaa 80,0,40
Mvaa 96,0,44
Ra 64,21,0
Mvaa 112,0,48
Mvaa 128,0,52
Ta 100,23,16384
Ta 102,23,18432
Mvaa 144,0,56
Mvaa 160,0,60
s_waitcnt lgkmcnt(6)
Ra 68,21,2048
Mvaa 52,4,32
Mvaa 68,4,36
Ta 104,24,16384
Ta 106,24,18432
Mvaa 84,4,40
Mvaa 100,4,44
Ra 72,21,4096
Mvaa 116,4,48
Mvaa 132,4,52
Ta 108,25,16384
Ta 110,25,18432
Mvaa 148,4,56
Mvaa 164,4,60
s_waitcnt lgkmcnt(6)
Ra 76,21,6144
Mvaa 56,8,32
Mvaa 72,8,36
Ta 112,26,16384
Ta 114,26,18432
Mvaa 88,8,40
Mvaa 104,8,44
Ra 80,21,8192
Mvaa 120,8,48
Mvaa 136,8,52
Ta 116,27,16384
Ta 118,27,18432
Mvaa 152,8,56
Mvaa 168,8,60
s_waitcnt lgkmcnt(6)
Ra 84,21,10240
Mvaa 60,12,32
Mvaa 76,12,36
Ta 120,28,16384
Ta 122,28,18432
Mvaa 92,12,40
Mvaa 108,12,44
Ra 88,21,12288
Mvaa 124,12,48
Mvaa 140,12,52
Ta 124,29,16384
Ta 126,29,18432
Mvaa 156,12,56
Mvaa 172,12,60
s_waitcnt lgkmcnt(6)
Ra 92,21,14336
Mvaa 176,16,32
Mvaa 192,16,36
Mvaa 208,16,40
Mvaa 224,16,44
Mvaa 240,16,48
Maaa 128,16,52
Maaa 144,16,56
Maaa 160,16,60
Mvaa 180,20,32
Mvaa 196,20,36
Mvaa 212,20,40
Mvaa 228,20,44
Mvaa 244,20,48
Maaa 132,20,52
Maaa 148,20,56
Maaa 164,20,60
Mvaa 184,24,32
Mvaa 200,24,36
Mvaa 216,24,40
Mvaa 232,24,44
Mvaa 248,24,48
Maaa 136,24,52
Maaa 152,24,56
Maaa 168,24,60
Mvaa 188,28,32
Mvaa 204,28,36
Mvaa 220,28,40
Mvaa 236,28,44
Mvaa 252,28,48
Maaa 140,28,52
Maaa 156,28,56
Maaa 172,28,60
s_waitcnt vmcnt(12) lgkmcnt(0)
v_readfirstlane_b32 s3, v30
s_nop 0
s_or_b32 s3, s3, s37
s_cmp_lt_u32 s3, 256
s_cbranch_scc1 L_spinAv
L_spinArv:
s_barrier
Mvaa 48,64,96
buffer_load_dwordx4 a[0:3], v10, s[20:23], 0 offen offset:0 sc1
Mvaa 52,68,96
v_lshrrev_b32_e64 v42, 2, v33
v_lshl_add_u32 v43, v32, 3, v42
Mvaa 56,72,96
v_lshlrev_b32 v43, 8, v43
v_and_b32 v44, 3, v0
Mvaa 60,76,96
v_lshl_add_u32 v43, v44, 3, v43
v_and_b32_e64 v44, 1, v32
Mvaa 64,64,100
buffer_load_dwordx4 a[4:7], v10, s[20:23], s58 offen offset:0 sc1
Mvaa 68,68,100
v_lshl_add_u32 v42, v44, 2, v42
v_xor_b32_e64 v44, 0, v42
Mvaa 72,72,100
v_lshl_add_u32 v16, v44, 5, v43
v_xor_b32_e64 v44, 1, v42
Mvaa 76,76,100
v_lshl_add_u32 v17, v44, 5, v43
v_xor_b32_e64 v44, 2, v42
Mvaa 80,64,104
buffer_load_dwordx4 a[8:11], v11, s[20:23], 0 offen offset:0 sc1
Mvaa 84,68,104
v_lshl_add_u32 v18, v44, 5, v43
v_xor_b32_e64 v44, 3, v42
Mvaa 88,72,104
v_lshl_add_u32 v19, v44, 5, v43
v_xor_b32_e64 v44, 4, v42
Mvaa 92,76,104
v_lshl_add_u32 v20, v44, 5, v43
v_xor_b32_e64 v44, 5, v42
Mvaa 96,64,108
buffer_load_dwordx4 a[12:15], v11, s[20:23], s58 offen offset:0 sc1
Mvaa 100,68,108
v_lshl_add_u32 v21, v44, 5, v43
v_xor_b32_e64 v44, 6, v42
Mvaa 104,72,108
v_lshl_add_u32 v22, v44, 5, v43
v_xor_b32_e64 v44, 7, v42
Mvaa 108,76,108
v_lshl_add_u32 v23, v44, 5, v43
Mvaa 112,64,112
buffer_load_dwordx4 a[16:19], v10, s[20:23], 0 offen offset:1024 sc1
Mvaa 116,68,112
Mvaa 120,72,112
Mvaa 124,76,112
Mvaa 128,64,116
buffer_load_dwordx4 a[20:23], v10, s[20:23], s58 offen offset:1024 sc1
Mvaa 132,68,116
Ta 192,16,0
Ta 194,16,1024
Mvaa 136,72,116
Ta 196,17,0
Ta 198,17,1024
Mvaa 140,76,116
Ta 200,18,0
Ta 202,18,1024
Mvaa 144,64,120
buffer_load_dwordx4 a[24:27], v11, s[20:23], 0 offen offset:1024 sc1
Mvaa 148,68,120
Ta 204,19,0
Ta 206,19,1024
Mvaa 152,72,120
Ta 208,20,0
Ta 210,20,1024
Mvaa 156,76,120
Ta 212,21,0
Ta 214,21,1024
Mvaa 160,64,124
buffer_load_dwordx4 a[28:31], v11, s[20:23], s58 offen offset:1024 sc1
Mvaa 164,68,124
Ta 216,22,0
Ta 218,22,1024
Mvaa 168,72,124
Ta 220,23,0
s_waitcnt lgkmcnt(9)
Ta 222,23,1024
Mvaa 172,76,124
s_waitcnt lgkmcnt(8)
Vc 24,48,49
Vc 25,50,51
Mvaa 176,80,96
buffer_load_dwordx4 a[32:35], v10, s[20:23], 0 offen offset:2048 sc1
Mvaa 180,84,96
Vc 26,52,53
Vc 27,54,55
Mvaa 184,88,96
Vc 28,56,57
Vc 29,58,59
Mvaa 188,92,96
Vc 30,60,61
Vc 31,62,63
Mvaa 192,80,100
buffer_load_dwordx4 a[36:39], v10, s[20:23], s58 offen offset:2048 sc1
Mvaa 196,84,100
Vc 32,64,65
Vc 33,66,67
Mvaa 200,88,100
Vc 34,68,69
Vc 35,70,71
Mvaa 204,92,100
Vc 36,72,73
Vc 37,74,75
Mvaa 208,80,104
buffer_load_dwordx4 a[40:43], v11, s[20:23], 0 offen offset:2048 sc1
Mvaa 212,84,104
Vc 38,76,77
Vc 39,78,79
Mvaa 216,88,104
Vc 40,80,81
Vc 41,82,83
Mvaa 220,92,104
Vc 42,84,85
Vc 43,86,87
Mvaa 224,80,108
buffer_load_dwordx4 a[44:47], v11, s[20:23], s58 offen offset:2048 sc1
Mvaa 228,84,108
Vc 44,88,89
Vc 45,90,91
Mvaa 232,88,108
Vc 46,92,93
Vc 47,94,95
Mvaa 236,92,108
Vc 48,96,97
Vc 49,98,99
Mvaa 240,80,112
buffer_load_dwordx4 a[48:51], v10, s[20:23], 0 offen offset:3072 sc1
Mvaa 244,84,112
Vc 50,100,101
Vc 51,102,103
Mvaa 248,88,112
Vc 52,104,105
Vc 53,106,107
Mvaa 252,92,112
Vc 54,108,109
Vc 55,110,111
Maaa 128,80,116
buffer_load_dwordx4 a[52:55], v10, s[20:23], s58 offen offset:3072 sc1
Maaa 132,84,116
Vc 56,112,113
Vc 57,114,115
Maaa 136,88,116
Vc 58,116,117
Vc 59,118,119
Maaa 140,92,116
Vc 60,120,121
Vc 61,122,123
Maaa 144,80,120
buffer_load_dwordx4 a[56:59], v11, s[20:23], 0 offen offset:3072 sc1
Maaa 148,84,120
Vc 62,124,125
Vc 63,126,127
Maaa 152,88,120
Vc 64,128,129
Vc 65,130,131
Maaa 156,92,120
Vc 66,132,133
Vc 67,134,135
Maaa 160,80,124
buffer_load_dwordx4 a[60:63], v11, s[20:23], s58 offen offset:3072 sc1
Maaa 164,84,124
v_add_u32 v10, 4096, v10
v_add_u32 v11, 4096, v11
Maaa 168,88,124
Vc 68,136,137
Vc 69,138,139
Maaa 172,92,124
Vc 70,140,141
Vc 71,142,143
Vc 72,144,145
Vc 73,146,147
Vc 74,148,149
Vc 75,150,151
Vc 76,152,153
Vc 77,154,155
Vc 78,156,157
Vc 79,158,159
Vc 80,160,161
Vc 81,162,163
Vc 82,164,165
Vc 83,166,167
Vc 84,168,169
Vc 85,170,171
Vc 86,172,173
Vc 87,174,175
Vc 88,176,177
Vc 89,178,179
Vc 90,180,181
Vc 91,182,183
Vc 92,184,185
Vc 93,186,187
Vc 94,188,189
Vc 95,190,191
Vc 96,192,193
Vc 97,194,195
Vc 98,196,197
Vc 99,198,199
Vc 100,200,201
Vc 101,202,203
Vc 102,204,205
Vc 103,206,207
Vc 104,208,209
Vc 105,210,211
Vc 106,212,213
Vc 107,214,215
Vc 108,216,217
Vc 109,218,219
Vc 110,220,221
Vc 111,222,223
Vc 112,224,225
Vc 113,226,227
Vc 114,228,229
Vc 115,230,231
Vc 116,232,233
Vc 117,234,235
Vc 118,236,237
Vc 119,238,239
Vc 120,240,241
Vc 121,242,243
Vc 122,244,245
Vc 123,246,247
Vc 124,248,249
Vc 125,250,251
Vc 126,252,253
Vc 127,254,255
L_phase2:
s_nop 7
s_waitcnt vmcnt(12) lgkmcnt(0)
Zvaa 128,192,0
s_add_u32 s37, s38, 0
Zvaa 160,192,4
Ta 224,16,8192
Ta 226,16,9216
Zvaa 192,192,8
buffer_load_dwordx4 a[64:67], v10, s[20:23], 0 offen offset:0 sc1
Zvaa 224,192,12
buffer_store_dwordx4 v[24:27], v2, s[24:27], s37 offen offset:0 sc1
Zvaa 132,196,0
Ta 228,17,8192
Ta 230,17,9216
Zvaa 164,196,4
buffer_load_dwordx4 a[68:71], v10, s[20:23], s58 offen offset:0 sc1
Zvaa 196,196,8
s_mov_b32 s60, s40
s_and_b32 s61, s41, 0xffff
s_mov_b32 s62, 7340032
Zvaa 228,196,12
Ta 232,18,8192
Ta 234,18,9216
Zvaa 136,200,0
s_mov_b32 s63, 0x20000
Zvaa 168,200,4
buffer_load_dwordx4 a[72:75], v11, s[20:23], 0 offen offset:0 sc1
Zvaa 200,200,8
Ta 236,19,8192
Ta 238,19,9216
Zvaa 232,200,12
Zvaa 140,204,0
Zvaa 172,204,4
Ta 240,20,8192
Ta 242,20,9216
Zvaa 204,204,8
buffer_load_dwordx4 a[76:79], v11, s[20:23], s58 offen offset:0 sc1
Zvaa 236,204,12
Zvaa 144,208,0
s_waitcnt lgkmcnt(6)
Ta 244,21,8192
Ta 246,21,9216
Zvaa 176,208,4
buffer_store_dwordx4 v[28:31], v2, s[24:27], s37 offen offset:1024 sc1
Zvaa 208,208,8
buffer_load_dwordx4 a[80:83], v10, s[20:23], 0 offen offset:1024 sc1
Zvaa 240,208,12
Ta 248,22,8192
Ta 250,22,9216
Zvaa 148,212,0
Zvaa 180,212,4
Zvaa 212,212,8
Ta 252,23,8192
Ta 254,23,9216
Zvaa 244,212,12
buffer_load_dwordx4 a[84:87], v10, s[20:23], s58 offen offset:1024 sc1
Zvaa 152,216,0
Zvaa 184,216,4
Zvaa 216,216,8
buffer_load_dwordx4 a[88:91], v11, s[20:23], 0 offen offset:1024 sc1
Zvaa 248,216,12
Zvaa 156,220,0
Zvaa 188,220,4
buffer_load_dwordx4 a[92:95], v11, s[20:23], s58 offen offset:1024 sc1
Zvaa 220,220,8
Zvaa 252,220,12
s_waitcnt vmcnt(18) lgkmcnt(0)
s_barrier
Mvaa 128,224,16
buffer_store_dwordx4 v[32:35], v2, s[24:27], s37 offen offset:2048 sc1
Mvaa 160,224,20
s_add_u32 m0, s44, 0
Ta 192,16,16384
Ta 194,16,17408
Mvaa 192,224,24
buffer_load_dwordx4 v8, s[8:11], s48 offen offset:0 lds
Mvaa 224,224,28
buffer_load_dwordx4 v8, s[8:11], s49 offen offset:1024 lds
Mvaa 132,228,16
Ta 196,17,16384
Ta 198,17,17408
Mvaa 164,228,20
Mvaa 196,228,24
buffer_load_dwordx4 v9, s[8:11], s50 offen offset:2048 lds
Mvaa 228,228,28
Ta 200,18,16384
Ta 202,18,17408
Mvaa 136,232,16
Mvaa 168,232,20
buffer_load_dwordx4 v9, s[8:11], s51 offen offset:3072 lds
v_add_u32 v8, 524288, v8
v_add_u32 v9, 524288, v9
Mvaa 200,232,24
Ta 204,19,16384
Ta 206,19,17408
Mvaa 232,232,28
Mvaa 140,236,16
buffer_load_dwordx4 a[96:99], v10, s[20:23], 0 offen offset:2048 sc1
Mvaa 172,236,20
Ta 208,20,16384
Ta 210,20,17408
Mvaa 204,236,24
Mvaa 236,236,28
buffer_load_dwordx4 a[100:103], v10, s[20:23], s58 offen offset:2048 sc1
Mvaa 144,240,16
s_waitcnt lgkmcnt(6)
Ta 212,21,16384
Ta 214,21,17408
Mvaa 176,240,20
buffer_store_dwordx4 v[36:39], v2, s[24:27], s37 offen offset:3072 sc1
Mvaa 208,240,24
buffer_load_dwordx4 a[104:107], v11, s[20:23], 0 offen offset:2048 sc1
Mvaa 240,240,28
Ta 216,22,16384
Ta 218,22,17408
Mvaa 148,244,16
Mvaa 180,244,20
buffer_load_dwordx4 a[108:111], v11, s[20:23], s58 offen offset:2048 sc1
Mvaa 212,244,24
Ta 220,23,16384
Ta 222,23,17408
Mvaa 244,244,28
Mvaa 152,248,16
buffer_load_dwordx4 a[112:115], v10, s[20:23], 0 offen offset:3072 sc1
Mvaa 184,248,20
Mvaa 216,248,24
buffer_load_dwordx4 a[116:119], v10, s[20:23], s58 offen offset:3072 sc1
Mvaa 248,248,28
Mvaa 156,252,16
buffer_load_dwordx4 a[120:123], v11, s[20:23], 0 offen offset:3072 sc1
Mvaa 188,252,20
Mvaa 220,252,24
buffer_load_dwordx4 a[124:127], v11, s[20:23], s58 offen offset:3072 sc1
v_add_u32 v10, 4096, v10
v_add_u32 v11, 4096, v11
Mvaa 252,252,28
s_waitcnt vmcnt(28) lgkmcnt(0)
Mvaa 128,192,32
s_add_u32 s37, s38, 4096
Mvaa 160,192,36
Ta 224,16,24576
Ta 226,16,25600
Mvaa 192,192,40
buffer_load_dwordx4 a[0:3], v10, s[20:23], 0 offen offset:0 sc1
Mvaa 224,192,44
buffer_store_dwordx4 v[40:43], v2, s[24:27], s37 offen offset:0 sc1
Mvaa 132,196,32
Ta 228,17,24576
Ta 230,17,25600
Mvaa 164,196,36
buffer_load_dwordx4 a[4:7], v10, s[20:23], s58 offen offset:0 sc1
Mvaa 196,196,40
Mvaa 228,196,44
Ta 232,18,24576
Ta 234,18,25600
Mvaa 136,200,32
Mvaa 168,200,36
buffer_load_dwordx4 a[8:11], v11, s[20:23], 0 offen offset:0 sc1
Mvaa 200,200,40
Ta 236,19,24576
Ta 238,19,25600
Mvaa 232,200,44
Mvaa 140,204,32
Mvaa 172,204,36
Ta 240,20,24576
Ta 242,20,25600
Mvaa 204,204,40
buffer_load_dwordx4 a[12:15], v11, s[20:23], s58 offen offset:0 sc1
Mvaa 236,204,44
Mvaa 144,208,32
s_waitcnt lgkmcnt(6)
Ta 244,21,24576
Ta 246,21,25600
Mvaa 176,208,36
buffer_store_dwordx4 v[44:47], v2, s[24:27], s37 offen offset:1024 sc1
Mvaa 208,208,40
buffer_load_dwordx4 a[16:19], v10, s[20:23], 0 offen offset:1024 sc1
Mvaa 240,208,44
Ta 248,22,24576
Ta 250,22,25600
Mvaa 148,212,32
Mvaa 180,212,36
Mvaa 212,212,40
Ta 252,23,24576
Ta 254,23,25600
Mvaa 244,212,44
buffer_load_dwordx4 a[20:23], v10, s[20:23], s58 offen offset:1024 sc1
Mvaa 152,216,32
Mvaa 184,216,36
Mvaa 216,216,40
buffer_load_dwordx4 a[24:27], v11, s[20:23], 0 offen offset:1024 sc1
Mvaa 248,216,44
Mvaa 156,220,32
Mvaa 188,220,36
buffer_load_dwordx4 a[28:31], v11, s[20:23], s58 offen offset:1024 sc1
Mvaa 220,220,40
Mvaa 252,220,44
s_waitcnt vmcnt(34) lgkmcnt(0)
s_barrier
Mvaa 128,224,48
buffer_store_dwordx4 v[48:51], v2, s[24:27], s37 offen offset:2048 sc1
Mvaa 160,224,52
s_add_u32 m0, s44, 16384
Ta 192,16,32768
Ta 194,16,33792
Mvaa 192,224,56
buffer_load_dwordx4 v8, s[8:11], s48 offen offset:0 lds
Mvaa 224,224,60
Mvaa 132,228,48
Ta 196,17,32768
Ta 198,17,33792
Mvaa 164,228,52
buffer_load_dwordx4 v8, s[8:11], s49 offen offset:1024 lds
Mvaa 196,228,56
Mvaa 228,228,60
Ta 200,18,32768
Ta 202,18,33792
Mvaa 136,232,48
Mvaa 168,232,52
buffer_load_dwordx4 v9, s[8:11], s50 offen offset:2048 lds
Mvaa 200,232,56
Ta 204,19,32768
Ta 206,19,33792
Mvaa 232,232,60
Mvaa 140,236,48
Mvaa 172,236,52
Ta 208,20,32768
Ta 210,20,33792
Mvaa 204,236,56
buffer_load_dwordx4 v9, s[8:11], s51 offen offset:3072 lds
v_add_u32 v8, 524288, v8
v_add_u32 v9, 524288, v9
Mvaa 236,236,60
Mvaa 144,240,48
s_waitcnt lgkmcnt(6)
Ta 212,21,32768
Ta 214,21,33792
Mvaa 176,240,52
buffer_store_dwordx4 v[52:55], v2, s[24:27], s37 offen offset:3072 sc1
Mvaa 208,240,56
buffer_load_dwordx4 a[32:35], v10, s[20:23], 0 offen offset:2048 sc1
Mvaa 240,240,60
Ta 216,22,32768
Ta 218,22,33792
Mvaa 148,244,48
Mvaa 180,244,52
Mvaa 212,244,56
Ta 220,23,32768
Ta 222,23,33792
Mvaa 244,244,60
buffer_load_dwordx4 a[36:39], v10, s[20:23], s58 offen offset:2048 sc1
Mvaa 152,248,48
Mvaa 184,248,52
Mvaa 216,248,56
buffer_load_dwordx4 a[40:43], v11, s[20:23], 0 offen offset:2048 sc1
Mvaa 248,248,60
Mvaa 156,252,48
Mvaa 188,252,52
buffer_load_dwordx4 a[44:47], v11, s[20:23], s58 offen offset:2048 sc1
Mvaa 220,252,56
Mvaa 252,252,60
s_waitcnt vmcnt(39) lgkmcnt(0)
Mvaa 128,192,64
s_add_u32 s37, s38, 8192
Mvaa 160,192,68
Ta 224,16,40960
Ta 226,16,41984
Mvaa 192,192,72
buffer_load_dwordx4 a[48:51], v10, s[20:23], 0 offen offset:3072 sc1
Mvaa 224,192,76
buffer_store_dwordx4 v[56:59], v2, s[24:27], s37 offen offset:0 sc1
Mvaa 132,196,64
Ta 228,17,40960
Ta 230,17,41984
Mvaa 164,196,68
Ar 48,128
Ar 49,129
Mvaa 196,196,72
Ar 50,130
Ar 51,131
Mvaa 228,196,76
Ta 232,18,40960
Ta 234,18,41984
Mvaa 136,200,64
Ar 52,132
Ar 53,133
Mvaa 168,200,68
buffer_load_dwordx4 a[52:55], v10, s[20:23], s58 offen offset:3072 sc1
Mvaa 200,200,72
Ta 236,19,40960
Ta 238,19,41984
Mvaa 232,200,76
Ar 54,134
Ar 55,135
Mvaa 140,204,64
Vc 24,48,49
Vc 25,50,51
Mvaa 172,204,68
Ta 240,20,40960
Ta 242,20,41984
Mvaa 204,204,72
Vc 26,52,53
Vc 27,54,55
Mvaa 236,204,76
Mvaa 144,208,64
s_waitcnt lgkmcnt(6)
Ta 244,21,40960
Ta 246,21,41984
Mvaa 176,208,68
buffer_store_dwordx4 v[60:63], v2, s[24:27], s37 offen offset:1024 sc1
Mvaa 208,208,72
buffer_load_dwordx4 a[56:59], v11, s[20:23], 0 offen offset:3072 sc1
Mvaa 240,208,76
Ta 248,22,40960
Ta 250,22,41984
Mvaa 148,212,64
Ar 48,136
Ar 49,137
Mvaa 180,212,68
Ar 50,138
Ar 51,139
Mvaa 212,212,72
Ta 252,23,40960
Ta 254,23,41984
Mvaa 244,212,76
Ar 52,140
Ar 53,141
Mvaa 152,216,64
Ar 54,142
Ar 55,143
Mvaa 184,216,68
Vc 28,48,49
Vc 29,50,51
Mvaa 216,216,72
buffer_load_dwordx4 a[60:63], v11, s[20:23], s58 offen offset:3072 sc1
v_add_u32 v10, 4096, v10
v_add_u32 v11, 4096, v11
Mvaa 248,216,76
Vc 30,52,53
Vc 31,54,55
Mvaa 156,220,64
Mvaa 188,220,68
Mvaa 220,220,72
Mvaa 252,220,76
s_waitcnt vmcnt(40) lgkmcnt(0)
s_barrier
Mvaa 128,224,80
buffer_store_dwordx4 v[64:67], v2, s[24:27], s37 offen offset:2048 sc1
Mvaa 160,224,84
s_add_u32 m0, s44, 32768
Ta 192,16,49152
Ta 194,16,50176
Mvaa 192,224,88
buffer_load_dwordx4 v8, s[8:11], s48 offen offset:0 lds
Mvaa 224,224,92
Ar 48,144
Ar 49,145
Mvaa 132,228,80
Ta 196,17,49152
Ta 198,17,50176
Mvaa 164,228,84
buffer_load_dwordx4 v8, s[8:11], s49 offen offset:1024 lds
Mvaa 196,228,88
Ar 50,146
Ar 51,147
Mvaa 228,228,92
Ta 200,18,49152
Ta 202,18,50176
Mvaa 136,232,80
Ar 52,148
Ar 53,149
Mvaa 168,232,84
buffer_load_dwordx4 v9, s[8:11], s50 offen offset:2048 lds
Mvaa 200,232,88
Ta 204,19,49152
Ta 206,19,50176
Mvaa 232,232,92
Ar 54,150
Ar 55,151
Mvaa 140,236,80
Vc 32,48,49
Vc 33,50,51
Mvaa 172,236,84
Ta 208,20,49152
Ta 210,20,50176
Mvaa 204,236,88
buffer_load_dwordx4 v9, s[8:11], s51 offen offset:3072 lds
v_add_u32 v8, 524288, v8
v_add_u32 v9, 524288, v9
Mvaa 236,236,92
Vc 34,52,53
Vc 35,54,55
Mvaa 144,240,80
s_waitcnt lgkmcnt(6)
Ta 212,21,49152
Ta 214,21,50176
Mvaa 176,240,84
buffer_store_dwordx4 v[68:71], v2, s[24:27], s37 offen offset:3072 sc1
Mvaa 208,240,88
buffer_load_dwordx4 a[64:67], v10, s[20:23], 0 offen offset:0 sc1
Mvaa 240,240,92
Ta 216,22,49152
Ta 218,22,50176
Mvaa 148,244,80
Ar 48,152
Ar 49,153
Mvaa 180,244,84
Ar 50,154
Ar 51,155
Mvaa 212,244,88
Ta 220,23,49152
Ta 222,23,50176
Mvaa 244,244,92
buffer_load_dwordx4 a[68:71], v10, s[20:23], s58 offen offset:0 sc1
Mvaa 152,248,80
Ar 52,156
Ar 53,157
Mvaa 184,248,84
Ar 54,158
Ar 55,159
Mvaa 216,248,88
buffer_load_dwordx4 a[72:75], v11, s[20:23], 0 offen offset:0 sc1
Mvaa 248,248,92
Vc 36,48,49
Vc 37,50,51
Mvaa 156,252,80
Vc 38,52,53
Vc 39,54,55
Mvaa 188,252,84
buffer_load_dwordx4 a[76:79], v11, s[20:23], s58 offen offset:0 sc1
Mvaa 220,252,88
Mvaa 252,252,92
s_waitcnt vmcnt(40) lgkmcnt(0)
Mvaa 128,192,96
s_add_u32 s37, s38, 12288
Mvaa 160,192,100
Ta 224,16,57344
Ta 226,16,58368
Mvaa 192,192,104
buffer_load_dwordx4 a[80:83], v10, s[20:23], 0 offen offset:1024 sc1
Mvaa 224,192,108
buffer_store_dwordx4 v[72:75], v2, s[24:27], s37 offen offset:0 sc1
Mvaa 132,196,96
Ta 228,17,57344
Ta 230,17,58368
Mvaa 164,196,100
Ar 48,160
Ar 49,161
Mvaa 196,196,104
Ar 50,162
Ar 51,163
Mvaa 228,196,108
Ta 232,18,57344
Ta 234,18,58368
Mvaa 136,200,96
Ar 52,164
Ar 53,165
Mvaa 168,200,100
buffer_load_dwordx4 a[84:87], v10, s[20:23], s58 offen offset:1024 sc1
Mvaa 200,200,104
Ta 236,19,57344
Ta 238,19,58368
Mvaa 232,200,108
Ar 54,166
Ar 55,167
Mvaa 140,204,96
Vc 40,48,49
Vc 41,50,51
Mvaa 172,204,100
Ta 240,20,57344
Ta 242,20,58368
Mvaa 204,204,104
Vc 42,52,53
Vc 43,54,55
Mvaa 236,204,108
Mvaa 144,208,96
s_waitcnt lgkmcnt(6)
Ta 244,21,57344
Ta 246,21,58368
Mvaa 176,208,100
buffer_store_dwordx4 v[76:79], v2, s[24:27], s37 offen offset:1024 sc1
Mvaa 208,208,104
buffer_load_dwordx4 a[88:91], v11, s[20:23], 0 offen offset:1024 sc1
Mvaa 240,208,108
Ta 248,22,57344
Ta 250,22,58368
Mvaa 148,212,96
Ar 48,168
Ar 49,169
Mvaa 180,212,100
Ar 50,170
Ar 51,171
Mvaa 212,212,104
Ta 252,23,57344
Ta 254,23,58368
Mvaa 244,212,108
Ar 52,172
Ar 53,173
Mvaa 152,216,96
Ar 54,174
Ar 55,175
Mvaa 184,216,100
Vc 44,48,49
Vc 45,50,51
Mvaa 216,216,104
buffer_load_dwordx4 a[92:95], v11, s[20:23], s58 offen offset:1024 sc1
Mvaa 248,216,108
Vc 46,52,53
Vc 47,54,55
Mvaa 156,220,96
Mvaa 188,220,100
Mvaa 220,220,104
Mvaa 252,220,108
s_waitcnt vmcnt(42) lgkmcnt(0)
s_barrier
Mvaa 128,224,112
buffer_store_dwordx4 v[80:83], v2, s[24:27], s37 offen offset:2048 sc1
Mvaa 160,224,116
s_add_u32 m0, s44, 49152
Ta 192,16,0
Ta 194,16,1024
Mvaa 192,224,120
buffer_load_dwordx4 v8, s[8:11], s48 offen offset:0 lds
Mvaa 224,224,124
Mvaa 132,228,112
Ta 196,17,0
Ta 198,17,1024
Mvaa 164,228,116
buffer_load_dwordx4 v8, s[8:11], s49 offen offset:1024 lds
Mvaa 196,228,120
Mvaa 228,228,124
Ta 200,18,0
Ta 202,18,1024
Mvaa 136,232,112
Mvaa 168,232,116
buffer_load_dwordx4 v9, s[8:11], s50 offen offset:2048 lds
Mvaa 200,232,120
Ta 204,19,0
Ta 206,19,1024
Mvaa 232,232,124
Mvaa 140,236,112
Mvaa 172,236,116
Ta 208,20,0
Ta 210,20,1024
Mvaa 204,236,120
buffer_load_dwordx4 v9, s[8:11], s51 offen offset:3072 lds
v_add_u32 v8, 524288, v8
v_add_u32 v9, 524288, v9
Mvaa 236,236,124
Mvaa 144,240,112
s_waitcnt lgkmcnt(6)
Ta 212,21,0
Ta 214,21,1024
Mvaa 176,240,116
buffer_store_dwordx4 v[84:87], v2, s[24:27], s37 offen offset:3072 sc1
Mvaa 208,240,120
buffer_load_dwordx4 a[96:99], v10, s[20:23], 0 offen offset:2048 sc1
Mvaa 240,240,124
Ta 216,22,0
Ta 218,22,1024
Mvaa 148,244,112
Mvaa 180,244,116
Mvaa 212,244,120
Ta 220,23,0
Ta 222,23,1024
Mvaa 244,244,124
buffer_load_dwordx4 a[100:103], v10, s[20:23], s58 offen offset:2048 sc1
Mvaa 152,248,112
Mvaa 184,248,116
Mvaa 216,248,120
buffer_load_dwordx4 a[104:107], v11, s[20:23], 0 offen offset:2048 sc1
Mvaa 248,248,124
Mvaa 156,252,112
Mvaa 188,252,116
buffer_load_dwordx4 a[108:111], v11, s[20:23], s58 offen offset:2048 sc1
Mvaa 220,252,120
Mvaa 252,252,124
s_waitcnt vmcnt(47) lgkmcnt(0)
Mvaa 128,192,0
s_add_u32 s37, s38, 34816
Mvaa 160,192,4
Ta 224,16,8192
Ta 226,16,9216
Mvaa 192,192,8
buffer_load_dwordx4 a[112:115], v10, s[20:23], 0 offen offset:3072 sc1
Mvaa 224,192,12
buffer_store_dwordx4 v[88:91], v2, s[24:27], s37 offen offset:0 sc1
Mvaa 132,196,0
Ta 228,17,8192
Ta 230,17,9216
Mvaa 164,196,4
Mvaa 196,196,8
Mvaa 228,196,12
Ta 232,18,8192
Ta 234,18,9216
Mvaa 136,200,0
Mvaa 168,200,4
buffer_load_dwordx4 a[116:119], v10, s[20:23], s58 offen offset:3072 sc1
Mvaa 200,200,8
Ta 236,19,8192
Ta 238,19,9216
Mvaa 232,200,12
Mvaa 140,204,0
Mvaa 172,204,4
Ta 240,20,8192
Ta 242,20,9216
Mvaa 204,204,8
Mvaa 236,204,12
Mvaa 144,208,0
s_waitcnt lgkmcnt(6)
Ta 244,21,8192
Ta 246,21,9216
Mvaa 176,208,4
buffer_store_dwordx4 v[92:95], v2, s[24:27], s37 offen offset:1024 sc1
Mvaa 208,208,8
buffer_load_dwordx4 a[120:123], v11, s[20:23], 0 offen offset:3072 sc1
Mvaa 240,208,12
Ta 248,22,8192
Ta 250,22,9216
Mvaa 148,212,0
s_mov_b32 s3, 5242880
s_mov_b32 s47, 5246976
Mvaa 180,212,4
buffer_load_dwordx4 v[56:59], v2, s[20:23], s3 offen offset:0 sc1
Mvaa 212,212,8
Ta 252,23,8192
Ta 254,23,9216
Mvaa 244,212,12
buffer_load_dwordx4 v[60:63], v2, s[20:23], s3 offen offset:1024 sc1
Mvaa 152,216,0
buffer_load_dwordx4 v[64:67], v2, s[20:23], s3 offen offset:2048 sc1
Mvaa 184,216,4
buffer_load_dwordx4 v[68:71], v2, s[20:23], s3 offen offset:3072 sc1
Mvaa 216,216,8
buffer_load_dwordx4 a[124:127], v11, s[20:23], s58 offen offset:3072 sc1
v_add_u32 v10, 4096, v10
v_add_u32 v11, 4096, v11
Mvaa 248,216,12
buffer_load_dwordx4 v[72:75], v2, s[20:23], s47 offen offset:0 sc1
Mvaa 156,220,0
buffer_load_dwordx4 v[76:79], v2, s[20:23], s47 offen offset:1024 sc1
Mvaa 188,220,4
buffer_load_dwordx4 v[80:83], v2, s[20:23], s47 offen offset:2048 sc1
Mvaa 220,220,8
buffer_load_dwordx4 v[84:87], v2, s[20:23], s47 offen offset:3072 sc1
Mvaa 252,220,12
s_waitcnt vmcnt(51) lgkmcnt(0)
s_barrier
Mvaa 128,224,16
buffer_store_dwordx4 v[96:99], v2, s[24:27], s37 offen offset:2048 sc1
Mvaa 160,224,20
s_add_u32 m0, s44, 0
Ta 192,16,16384
Ta 194,16,17408
Mvaa 192,224,24
buffer_load_dwordx4 v8, s[8:11], s48 offen offset:0 lds
Mvaa 224,224,28
Mvaa 132,228,16
Ta 196,17,16384
Ta 198,17,17408
Mvaa 164,228,20
buffer_load_dwordx4 v8, s[8:11], s49 offen offset:1024 lds
Mvaa 196,228,24
Mvaa 228,228,28
Ta 200,18,16384
Ta 202,18,17408
Mvaa 136,232,16
Mvaa 168,232,20
buffer_load_dwordx4 v9, s[8:11], s50 offen offset:2048 lds
Mvaa 200,232,24
Ta 204,19,16384
Ta 206,19,17408
Mvaa 232,232,28
Mvaa 140,236,16
Mvaa 172,236,20
Ta 208,20,16384
Ta 210,20,17408
Mvaa 204,236,24
buffer_load_dwordx4 v9, s[8:11], s51 offen offset:3072 lds
v_add_u32 v8, 524288, v8
v_add_u32 v9, 524288, v9
Mvaa 236,236,28
Mvaa 144,240,16
s_waitcnt lgkmcnt(6)
Ta 212,21,16384
Ta 214,21,17408
Mvaa 176,240,20
buffer_store_dwordx4 v[100:103], v2, s[24:27], s37 offen offset:3072 sc1
Mvaa 208,240,24
buffer_load_dwordx4 a[0:3], v10, s[20:23], 0 offen offset:0 sc1
Mvaa 240,240,28
Ta 216,22,16384
Ta 218,22,17408
Mvaa 148,244,16
Mvaa 180,244,20
Mvaa 212,244,24
Ta 220,23,16384
Ta 222,23,17408
Mvaa 244,244,28
buffer_load_dwordx4 a[4:7], v10, s[20:23], s58 offen offset:0 sc1
Mvaa 152,248,16
Mvaa 184,248,20
Mvaa 216,248,24
buffer_load_dwordx4 a[8:11], v11, s[20:23], 0 offen offset:0 sc1
Mvaa 248,248,28
Mvaa 156,252,16
Mvaa 188,252,20
buffer_load_dwordx4 a[12:15], v11, s[20:23], s58 offen offset:0 sc1
Mvaa 220,252,24
Mvaa 252,252,28
s_waitcnt vmcnt(56) lgkmcnt(0)
Mvaa 128,192,32
s_add_u32 s37, s38, 38912
Mvaa 160,192,36
Ta 224,16,24576
Ta 226,16,25600
Mvaa 192,192,40
buffer_load_dwordx4 a[16:19], v10, s[20:23], 0 offen offset:1024 sc1
Mvaa 224,192,44
buffer_store_dwordx4 v[104:107], v2, s[24:27], s37 offen offset:0 sc1
Mvaa 132,196,32
Ta 228,17,24576
Ta 230,17,25600
Mvaa 164,196,36
Mvaa 196,196,40
Mvaa 228,196,44
Ta 232,18,24576
Ta 234,18,25600
Mvaa 136,200,32
Mvaa 168,200,36
buffer_load_dwordx4 a[20:23], v10, s[20:23], s58 offen offset:1024 sc1
Mvaa 200,200,40
Ta 236,19,24576
Ta 238,19,25600
Mvaa 232,200,44
Mvaa 140,204,32
Mvaa 172,204,36
Ta 240,20,24576
Ta 242,20,25600
Mvaa 204,204,40
Mvaa 236,204,44
Mvaa 144,208,32
s_waitcnt lgkmcnt(6)
Ta 244,21,24576
Ta 246,21,25600
Mvaa 176,208,36
buffer_store_dwordx4 v[108:111], v2, s[24:27], s37 offen offset:1024 sc1
Mvaa 208,208,40
buffer_load_dwordx4 a[24:27], v11, s[20:23], 0 offen offset:1024 sc1
Mvaa 240,208,44
Ta 248,22,24576
Ta 250,22,25600
Mvaa 148,212,32
Mvaa 180,212,36
Mvaa 212,212,40
Ta 252,23,24576
Ta 254,23,25600
Mvaa 244,212,44
Mvaa 152,216,32
Mvaa 184,216,36
Mvaa 216,216,40
buffer_load_dwordx4 a[28:31], v11, s[20:23], s58 offen offset:1024 sc1
Mvaa 248,216,44
Mvaa 156,220,32
Mvaa 188,220,36
Mvaa 220,220,40
Mvaa 252,220,44
s_waitcnt vmcnt(51) lgkmcnt(0)
s_barrier
Mvaa 128,224,48
buffer_store_dwordx4 v[112:115], v2, s[24:27], s37 offen offset:2048 sc1
Mvaa 160,224,52
s_add_u32 m0, s44, 16384
Ta 192,16,32768
Ta 194,16,33792
Mvaa 192,224,56
buffer_load_dwordx4 v8, s[8:11], s48 offen offset:0 lds
Mvaa 224,224,60
Mvaa 132,228,48
Ta 196,17,32768
Ta 198,17,33792
Mvaa 164,228,52
buffer_load_dwordx4 v8, s[8:11], s49 offen offset:1024 lds
Mvaa 196,228,56
Mvaa 228,228,60
Ta 200,18,32768
Ta 202,18,33792
Mvaa 136,232,48
Mvaa 168,232,52
buffer_load_dwordx4 v9, s[8:11], s50 offen offset:2048 lds
Mvaa 200,232,56
Ta 204,19,32768
Ta 206,19,33792
Mvaa 232,232,60
Mvaa 140,236,48
Mvaa 172,236,52
Ta 208,20,32768
Ta 210,20,33792
Mvaa 204,236,56
buffer_load_dwordx4 v9, s[8:11], s51 offen offset:3072 lds
v_add_u32 v8, 524288, v8
v_add_u32 v9, 524288, v9
Mvaa 236,236,60
Mvaa 144,240,48
s_waitcnt lgkmcnt(6)
Ta 212,21,32768
Ta 214,21,33792
Mvaa 176,240,52
buffer_store_dwordx4 v[116:119], v2, s[24:27], s37 offen offset:3072 sc1
Mvaa 208,240,56
buffer_load_dwordx4 a[32:35], v10, s[20:23], 0 offen offset:2048 sc1
Mvaa 240,240,60
Ta 216,22,32768
Ta 218,22,33792
Mvaa 148,244,48
Mvaa 180,244,52
Mvaa 212,244,56
Ta 220,23,32768
Ta 222,23,33792
Mvaa 244,244,60
buffer_load_dwordx4 a[36:39], v10, s[20:23], s58 offen offset:2048 sc1
Mvaa 152,248,48
Mvaa 184,248,52
Mvaa 216,248,56
buffer_load_dwordx4 a[40:43], v11, s[20:23], 0 offen offset:2048 sc1
Mvaa 248,248,60
Mvaa 156,252,48
Mvaa 188,252,52
buffer_load_dwordx4 a[44:47], v11, s[20:23], s58 offen offset:2048 sc1
Mvaa 220,252,56
Mvaa 252,252,60
s_waitcnt vmcnt(56) lgkmcnt(0)
Mvaa 128,192,64
s_add_u32 s37, s38, 43008
Mvaa 160,192,68
Ta 224,16,40960
Ta 226,16,41984
Mvaa 192,192,72
buffer_load_dwordx4 a[48:51], v10, s[20:23], 0 offen offset:3072 sc1
Mvaa 224,192,76
buffer_store_dwordx4 v[120:123], v2, s[24:27], s37 offen offset:0 sc1
Mvaa 132,196,64
Ta 228,17,40960
Ta 230,17,41984
Mvaa 164,196,68
Mvaa 196,196,72
Mvaa 228,196,76
Ta 232,18,40960
Ta 234,18,41984
Mvaa 136,200,64
Mvaa 168,200,68
buffer_load_dwordx4 a[52:55], v10, s[20:23], s58 offen offset:3072 sc1
Mvaa 200,200,72
Ta 236,19,40960
Ta 238,19,41984
Mvaa 232,200,76
Mvaa 140,204,64
Mvaa 172,204,68
Ta 240,20,40960
Ta 242,20,41984
Mvaa 204,204,72
Mvaa 236,204,76
Mvaa 144,208,64
s_waitcnt lgkmcnt(6)
Ta 244,21,40960
Ta 246,21,41984
Mvaa 176,208,68
buffer_store_dwordx4 v[124:127], v2, s[24:27], s37 offen offset:1024 sc1
Mvaa 208,208,72
buffer_load_dwordx4 a[56:59], v11, s[20:23], 0 offen offset:3072 sc1
Mvaa 240,208,76
Ta 248,22,40960
Ta 250,22,41984
Mvaa 148,212,64
Mvaa 180,212,68
Mvaa 212,212,72
Ta 252,23,40960
Ta 254,23,41984
Mvaa 244,212,76
Mvaa 152,216,64
Mvaa 184,216,68
Mvaa 216,216,72
buffer_load_dwordx4 a[60:63], v11, s[20:23], s58 offen offset:3072 sc1
v_add_u32 v10, 4096, v10
v_add_u32 v11, 4096, v11
Mvaa 248,216,76
Mvaa 156,220,64
Mvaa 188,220,68
Mvaa 220,220,72
Mvaa 252,220,76
s_waitcnt vmcnt(51) lgkmcnt(0)
s_barrier
Mvaa 128,224,80
buffer_store_dwordx4 v[24:27], v2, s[24:27], s37 offen offset:2048 sc1
Mvaa 160,224,84
s_add_u32 m0, s44, 32768
Ta 192,16,49152
Ta 194,16,50176
Mvaa 192,224,88
buffer_load_dwordx4 v8, s[8:11], s48 offen offset:0 lds
Mvaa 224,224,92
Mvaa 132,228,80
Ta 196,17,49152
Ta 198,17,50176
Mvaa 164,228,84
buffer_load_dwordx4 v8, s[8:11], s49 offen offset:1024 lds
Mvaa 196,228,88
Mvaa 228,228,92
Ta 200,18,49152
Ta 202,18,50176
Mvaa 136,232,80
Mvaa 168,232,84
buffer_load_dwordx4 v9, s[8:11], s50 offen offset:2048 lds
Mvaa 200,232,88
Ta 204,19,49152
Ta 206,19,50176
Mvaa 232,232,92
Mvaa 140,236,80
Mvaa 172,236,84
Ta 208,20,49152
Ta 210,20,50176
Mvaa 204,236,88
buffer_load_dwordx4 v9, s[8:11], s51 offen offset:3072 lds
v_add_u32 v8, 524288, v8
v_add_u32 v9, 524288, v9
Mvaa 236,236,92
Mvaa 144,240,80
s_waitcnt lgkmcnt(6)
Ta 212,21,49152
Ta 214,21,50176
Mvaa 176,240,84
buffer_store_dwordx4 v[28:31], v2, s[24:27], s37 offen offset:3072 sc1
Mvaa 208,240,88
buffer_load_dwordx4 a[64:67], v10, s[20:23], 0 offen offset:0 sc1
Mvaa 240,240,92
Ta 216,22,49152
Ta 218,22,50176
Mvaa 148,244,80
Mvaa 180,244,84
Mvaa 212,244,88
Ta 220,23,49152
Ta 222,23,50176
Mvaa 244,244,92
buffer_load_dwordx4 a[68:71], v10, s[20:23], s58 offen offset:0 sc1
Mvaa 152,248,80
Mvaa 184,248,84
Mvaa 216,248,88
buffer_load_dwordx4 a[72:75], v11, s[20:23], 0 offen offset:0 sc1
Mvaa 248,248,92
Mvaa 156,252,80
Mvaa 188,252,84
buffer_load_dwordx4 a[76:79], v11, s[20:23], s58 offen offset:0 sc1
Mvaa 220,252,88
Mvaa 252,252,92
s_waitcnt vmcnt(56) lgkmcnt(0)
Mvaa 128,192,96
s_add_u32 s37, s38, 47104
Mvaa 160,192,100
Ta 224,16,57344
Ta 226,16,58368
Mvaa 192,192,104
buffer_load_dwordx4 a[80:83], v10, s[20:23], 0 offen offset:1024 sc1
Mvaa 224,192,108
buffer_store_dwordx4 v[32:35], v2, s[24:27], s37 offen offset:0 sc1
Mvaa 132,196,96
Ta 228,17,57344
Ta 230,17,58368
Mvaa 164,196,100
Mvaa 196,196,104
Mvaa 228,196,108
Ta 232,18,57344
Ta 234,18,58368
Mvaa 136,200,96
Mvaa 168,200,100
buffer_load_dwordx4 a[84:87], v10, s[20:23], s58 offen offset:1024 sc1
Mvaa 200,200,104
Ta 236,19,57344
Ta 238,19,58368
Mvaa 232,200,108
Mvaa 140,204,96
Mvaa 172,204,100
Ta 240,20,57344
Ta 242,20,58368
Mvaa 204,204,104
Mvaa 236,204,108
Mvaa 144,208,96
s_waitcnt lgkmcnt(6)
Ta 244,21,57344
Ta 246,21,58368
Mvaa 176,208,100
buffer_store_dwordx4 v[36:39], v2, s[24:27], s37 offen offset:1024 sc1
Mvaa 208,208,104
buffer_load_dwordx4 a[88:91], v11, s[20:23], 0 offen offset:1024 sc1
Mvaa 240,208,108
Ta 248,22,57344
Ta 250,22,58368
Mvaa 148,212,96
Mvaa 180,212,100
Mvaa 212,212,104
Ta 252,23,57344
Ta 254,23,58368
Mvaa 244,212,108
Mvaa 152,216,96
Mvaa 184,216,100
Mvaa 216,216,104
buffer_load_dwordx4 a[92:95], v11, s[20:23], s58 offen offset:1024 sc1
Mvaa 248,216,108
Mvaa 156,220,96
Mvaa 188,220,100
Mvaa 220,220,104
Mvaa 252,220,108
s_waitcnt vmcnt(43) lgkmcnt(0)
s_barrier
Mvaa 128,224,112
buffer_store_dwordx4 v[40:43], v2, s[24:27], s37 offen offset:2048 sc1
Mvaa 160,224,116
s_add_u32 m0, s44, 49152
Ta 192,16,0
Ta 194,16,1024
Mvaa 192,224,120
buffer_load_dwordx4 v8, s[8:11], s48 offen offset:0 lds
Mvaa 224,224,124
Mvaa 132,228,112
Ta 196,17,0
Ta 198,17,1024
Mvaa 164,228,116
buffer_load_dwordx4 v8, s[8:11], s49 offen offset:1024 lds
Mvaa 196,228,120
Mvaa 228,228,124
Ta 200,18,0
Ta 202,18,1024
Mvaa 136,232,112
Mvaa 168,232,116
buffer_load_dwordx4 v9, s[8:11], s50 offen offset:2048 lds
Mvaa 200,232,120
Ta 204,19,0
Ta 206,19,1024
Mvaa 232,232,124
Mvaa 140,236,112
Mvaa 172,236,116
Ta 208,20,0
Ta 210,20,1024
Mvaa 204,236,120
buffer_load_dwordx4 v9, s[8:11], s51 offen offset:3072 lds
v_add_u32 v8, 524288, v8
v_add_u32 v9, 524288, v9
Mvaa 236,236,124
Mvaa 144,240,112
s_waitcnt lgkmcnt(6)
Ta 212,21,0
Ta 214,21,1024
Mvaa 176,240,116
buffer_store_dwordx4 v[44:47], v2, s[24:27], s37 offen offset:3072 sc1
Mvaa 208,240,120
buffer_load_dwordx4 a[96:99], v10, s[20:23], 0 offen offset:2048 sc1
Mvaa 240,240,124
Ta 216,22,0
Ta 218,22,1024
Mvaa 148,244,112
v_mov_b32 v12, 1
v_and_b32_e64 v1, 15, v0
Mvaa 180,244,116
v_lshlrev_b32_e64 v1, 2, v1
Mvaa 212,244,120
Ta 220,23,0
Ta 222,23,1024
Mvaa 244,244,124
buffer_load_dwordx4 a[100:103], v10, s[20:23], s58 offen offset:2048 sc1
Mvaa 152,248,112
s_lshr_b32 s6, s33, 1
s_lshl_b32 s6, s6, 7
s_add_u32 s6, s6, 5296128
Mvaa 184,248,116
s_cmp_eq_u32 s32, 0
s_cselect_b32 s6, s6, 2146435072
Mvaa 216,248,120
buffer_load_dwordx4 a[104:107], v11, s[20:23], 0 offen offset:2048 sc1
Mvaa 248,248,124
Mvaa 156,252,112
Mvaa 188,252,116
buffer_load_dwordx4 a[108:111], v11, s[20:23], s58 offen offset:2048 sc1
Mvaa 220,252,120
Mvaa 252,252,124
s_waitcnt vmcnt(48) lgkmcnt(0)
Mvaa 128,192,0
Mvaa 160,192,4
Ta 224,16,8192
Ta 226,16,9216
Mvaa 192,192,8
buffer_load_dwordx4 a[112:115], v10, s[20:23], 0 offen offset:3072 sc1
Mvaa 224,192,12
Mvaa 132,196,0
Ta 228,17,8192
Ta 230,17,9216
Mvaa 164,196,4
Mvaa 196,196,8
Mvaa 228,196,12
Ta 232,18,8192
Ta 234,18,9216
Mvaa 136,200,0
Mvaa 168,200,4
buffer_load_dwordx4 a[116:119], v10, s[20:23], s58 offen offset:3072 sc1
Mvaa 200,200,8
Ta 236,19,8192
Ta 238,19,9216
Mvaa 232,200,12
Mvaa 140,204,0
Mvaa 172,204,4
Ta 240,20,8192
Ta 242,20,9216
Mvaa 204,204,8
Mvaa 236,204,12
Mvaa 144,208,0
s_waitcnt lgkmcnt(6)
Ta 244,21,8192
Ta 246,21,9216
Mvaa 176,208,4
v_max_u32 v14, v56, v57
v_min_u32_e64 v15, v56, v57
Mvaa 208,208,8
buffer_load_dwordx4 a[120:123], v11, s[20:23], 0 offen offset:3072 sc1
Mvaa 240,208,12
Ta 248,22,8192
Ta 250,22,9216
Mvaa 148,212,0
v_med3_u32 v15, v14, v15, v58
v_max_u32_e64 v14, v14, v58
Mvaa 180,212,4
v_med3_u32 v15, v14, v15, v59
v_max_u32_e64 v14, v14, v59
Mvaa 212,212,8
Ta 252,23,8192
Ta 254,23,9216
Mvaa 244,212,12
v_med3_u32 v15, v14, v15, v60
v_max_u32_e64 v14, v14, v60
Mvaa 152,216,0
v_med3_u32 v15, v14, v15, v61
v_max_u32_e64 v14, v14, v61
Mvaa 184,216,4
v_med3_u32 v15, v14, v15, v62
v_max_u32_e64 v14, v14, v62
Mvaa 216,216,8
buffer_load_dwordx4 a[124:127], v11, s[20:23], s58 offen offset:3072 sc1
v_add_u32 v10, 4096, v10
v_add_u32 v11, 4096, v11
Mvaa 248,216,12
v_med3_u32 v15, v14, v15, v63
v_max_u32_e64 v14, v14, v63
Mvaa 156,220,0
v_med3_u32 v15, v14, v15, v64
v_max_u32_e64 v14, v14, v64
Mvaa 188,220,4
v_med3_u32 v15, v14, v15, v65
v_max_u32_e64 v14, v14, v65
Mvaa 220,220,8
v_med3_u32 v15, v14, v15, v66
v_max_u32_e64 v14, v14, v66
Mvaa 252,220,12
v_med3_u32 v15, v14, v15, v67
v_max_u32 v14, v14, v67
s_waitcnt vmcnt(41) lgkmcnt(0)
s_barrier
Mvaa 128,224,16
v_med3_u32 v15, v14, v15, v68
v_max_u32 v14, v14, v68
Mvaa 160,224,20
s_add_u32 m0, s44, 0
Ta 192,16,16384
Ta 194,16,17408
Mvaa 192,224,24
buffer_load_dwordx4 v8, s[8:11], s48 offen offset:0 lds
Mvaa 224,224,28
v_med3_u32 v15, v14, v15, v69
v_max_u32 v14, v14, v69
Mvaa 132,228,16
Ta 196,17,16384
Ta 198,17,17408
Mvaa 164,228,20
buffer_load_dwordx4 v8, s[8:11], s49 offen offset:1024 lds
Mvaa 196,228,24
v_med3_u32 v15, v14, v15, v70
v_max_u32_e64 v14, v14, v70
Mvaa 228,228,28
Ta 200,18,16384
Ta 202,18,17408
Mvaa 136,232,16
v_med3_u32 v15, v14, v15, v71
v_max_u32_e64 v14, v14, v71
Mvaa 168,232,20
buffer_load_dwordx4 v9, s[8:11], s50 offen offset:2048 lds
Mvaa 200,232,24
Ta 204,19,16384
Ta 206,19,17408
Mvaa 232,232,28
v_med3_u32 v15, v14, v15, v72
v_max_u32_e64 v14, v14, v72
Mvaa 140,236,16
v_med3_u32 v15, v14, v15, v73
v_max_u32_e64 v14, v14, v73
Mvaa 172,236,20
Ta 208,20,16384
Ta 210,20,17408
Mvaa 204,236,24
buffer_load_dwordx4 v9, s[8:11], s51 offen offset:3072 lds
v_add_u32 v8, 524288, v8
v_add_u32 v9, 524288, v9
Mvaa 236,236,28
v_med3_u32 v15, v14, v15, v74
v_max_u32_e64 v14, v14, v74
Mvaa 144,240,16
s_waitcnt lgkmcnt(6)
Ta 212,21,16384
Ta 214,21,17408
Mvaa 176,240,20
v_med3_u32 v15, v14, v15, v75
v_max_u32 v14, v14, v75
Mvaa 208,240,24
buffer_load_dwordx4 a[0:3], v10, s[20:23], 0 offen offset:0 sc1
Mvaa 240,240,28
Ta 216,22,16384
Ta 218,22,17408
Mvaa 148,244,16
v_med3_u32 v15, v14, v15, v76
v_max_u32_e64 v14, v14, v76
Mvaa 180,244,20
v_med3_u32 v15, v14, v15, v77
v_max_u32_e64 v14, v14, v77
Mvaa 212,244,24
Ta 220,23,16384
Ta 222,23,17408
Mvaa 244,244,28
buffer_load_dwordx4 a[4:7], v10, s[20:23], s58 offen offset:0 sc1
Mvaa 152,248,16
v_med3_u32 v15, v14, v15, v78
v_max_u32_e64 v14, v14, v78
Mvaa 184,248,20
v_med3_u32 v15, v14, v15, v79
v_max_u32_e64 v14, v14, v79
Mvaa 216,248,24
buffer_load_dwordx4 a[8:11], v11, s[20:23], 0 offen offset:0 sc1
Mvaa 248,248,28
v_med3_u32 v15, v14, v15, v80
v_max_u32_e64 v14, v14, v80
Mvaa 156,252,16
v_med3_u32 v15, v14, v15, v81
v_max_u32_e64 v14, v14, v81
Mvaa 188,252,20
buffer_load_dwordx4 a[12:15], v11, s[20:23], s58 offen offset:0 sc1
Mvaa 220,252,24
v_med3_u32 v15, v14, v15, v82
v_max_u32_e64 v14, v14, v82
Mvaa 252,252,28
v_med3_u32 v15, v14, v15, v83
v_max_u32 v14, v14, v83
s_waitcnt vmcnt(44) lgkmcnt(0)
Mvaa 128,192,32
v_med3_u32 v15, v14, v15, v84
v_max_u32_e64 v14, v14, v84
Mvaa 160,192,36
Ta 224,16,24576
Ta 226,16,25600
Mvaa 192,192,40
buffer_load_dwordx4 a[16:19], v10, s[20:23], 0 offen offset:1024 sc1
Mvaa 224,192,44
v_med3_u32 v15, v14, v15, v85
v_max_u32_e64 v14, v14, v85
Mvaa 132,196,32
Ta 228,17,24576
Ta 230,17,25600
Mvaa 164,196,36
v_med3_u32 v15, v14, v15, v86
v_max_u32_e64 v14, v14, v86
Mvaa 196,196,40
v_med3_u32 v15, v14, v15, v87
v_max_u32_e64 v14, v14, v87
Mvaa 228,196,44
Ta 232,18,24576
Ta 234,18,25600
Mvaa 136,200,32
v_mov_b32_e64 v13, v14
Mvaa 168,200,36
buffer_load_dwordx4 a[20:23], v10, s[20:23], s58 offen offset:1024 sc1
Mvaa 200,200,40
Ta 236,19,24576
Ta 238,19,25600
Mvaa 232,200,44
v_max_u32_dpp v13, v13, v13 quad_perm:[1,0,3,2] row_mask:0xf bank_mask:0xf
Mvaa 140,204,32
s_nop 0
v_max_u32_dpp v13, v13, v13 quad_perm:[2,3,0,1] row_mask:0xf bank_mask:0xf
Mvaa 172,204,36
Ta 240,20,24576
Ta 242,20,25600
Mvaa 204,204,40
v_max_u32_dpp v13, v13, v13 row_half_mirror row_mask:0xf bank_mask:0xf
Mvaa 236,204,44
s_nop 0
v_max_u32_dpp v13, v13, v13 row_mirror row_mask:0xf bank_mask:0xf
Mvaa 144,208,32
s_waitcnt lgkmcnt(6)
Ta 244,21,24576
Ta 246,21,25600
Mvaa 176,208,36
v_readlane_b32 s3, v13, 0
v_readlane_b32 s47, v13, 16
Mvaa 208,208,40
buffer_load_dwordx4 a[24:27], v11, s[20:23], 0 offen offset:1024 sc1
Mvaa 240,208,44
Ta 248,22,24576
Ta 250,22,25600
Mvaa 148,212,32
v_readlane_b32 s4, v13, 32
v_readlane_b32 s5, v13, 48
Mvaa 180,212,36
s_max_u32 s3, s3, s47
s_max_u32 s4, s4, s5
s_max_u32 s40, s3, s4
Mvaa 212,212,40
Ta 252,23,24576
Ta 254,23,25600
Mvaa 244,212,44
v_cmp_eq_u32 vcc, s40, v14
Mvaa 152,216,32
s_nop 0
v_cndmask_b32 v13, v14, v15, vcc
Mvaa 184,216,36
s_nop 0
v_max_u32_dpp v13, v13, v13 quad_perm:[1,0,3,2] row_mask:0xf bank_mask:0xf
Mvaa 216,216,40
buffer_load_dwordx4 a[28:31], v11, s[20:23], s58 offen offset:1024 sc1
Mvaa 248,216,44
v_max_u32_dpp v13, v13, v13 quad_perm:[2,3,0,1] row_mask:0xf bank_mask:0xf
Mvaa 156,220,32
s_nop 0
v_max_u32_dpp v13, v13, v13 row_half_mirror row_mask:0xf bank_mask:0xf
Mvaa 188,220,36
s_nop 0
v_max_u32_dpp v13, v13, v13 row_mirror row_mask:0xf bank_mask:0xf
Mvaa 220,220,40
v_readlane_b32 s3, v13, 0
v_readlane_b32 s47, v13, 16
Mvaa 252,220,44
v_readlane_b32 s4, v13, 32
v_readlane_b32 s5, v13, 48
s_waitcnt vmcnt(37) lgkmcnt(0)
s_barrier
Mvaa 128,224,48
s_max_u32 s3, s3, s47
s_max_u32 s4, s4, s5
s_max_u32 s41, s3, s4
Mvaa 160,224,52
s_add_u32 m0, s44, 16384
Ta 192,16,32768
Ta 194,16,33792
Mvaa 192,224,56
buffer_load_dwordx4 v8, s[8:11], s48 offen offset:0 lds
Mvaa 224,224,60
s_and_b32 s3, s40, 0xffff
s_sub_u32 s42, 0xffff, s3
s_and_b32 s3, s41, 0xffff
Mvaa 132,228,48
Ta 196,17,32768
Ta 198,17,33792
Mvaa 164,228,52
buffer_load_dwordx4 v8, s[8:11], s49 offen offset:1024 lds
Mvaa 196,228,56
s_sub_u32 s43, 0xffff, s3
v_mov_b32 v60, s40
v_not_b32_e64 v61, v60
Mvaa 228,228,60
Ta 200,18,32768
Ta 202,18,33792
Mvaa 136,232,48
v_ashrrev_i32_e64 v61, 31, v61
v_or_b32 v61, 0x80000000, v61
Mvaa 168,232,52
buffer_load_dwordx4 v9, s[8:11], s50 offen offset:2048 lds
Mvaa 200,232,56
Ta 204,19,32768
Ta 206,19,33792
Mvaa 232,232,60
v_xor_b32_e64 v60, v60, v61
v_and_b32 v60, 0xffff0000, v60
Mvaa 140,236,48
v_mul_f32 v60, 0xbfb8aa3b, v60
Mvaa 172,236,52
Ta 208,20,32768
Ta 210,20,33792
Mvaa 204,236,56
buffer_load_dwordx4 v9, s[8:11], s51 offen offset:3072 lds
v_add_u32 v8, 524288, v8
v_add_u32 v9, 524288, v9
Mvaa 236,236,60
VE 60,60
Mvaa 144,240,48
s_waitcnt lgkmcnt(6)
Ta 212,21,32768
Ta 214,21,33792
Mvaa 176,240,52
v_add_f32 v60, 1.0, v60
Mvaa 208,240,56
buffer_load_dwordx4 a[32:35], v10, s[20:23], 0 offen offset:2048 sc1
Mvaa 240,240,60
Ta 216,22,32768
Ta 218,22,33792
Mvaa 148,244,48
v_rcp_f32_e64 v60, v60
Mvaa 180,244,52
Vc 60,60,60
v_and_b32 v64, 0xffff0000, v60
Mvaa 212,244,56
Ta 220,23,32768
Ta 222,23,33792
Mvaa 244,244,60
buffer_load_dwordx4 a[36:39], v10, s[20:23], s58 offen offset:2048 sc1
Mvaa 152,248,48
v_mov_b32 v60, s41
v_not_b32 v61, v60
Mvaa 184,248,52
v_ashrrev_i32_e64 v61, 31, v61
v_or_b32 v61, 0x80000000, v61
Mvaa 216,248,56
buffer_load_dwordx4 a[40:43], v11, s[20:23], 0 offen offset:2048 sc1
Mvaa 248,248,60
v_xor_b32_e64 v60, v60, v61
v_and_b32 v60, 0xffff0000, v60
Mvaa 156,252,48
v_mul_f32 v60, 0xbfb8aa3b, v60
Mvaa 188,252,52
buffer_load_dwordx4 a[44:47], v11, s[20:23], s58 offen offset:2048 sc1
Mvaa 220,252,56
VE 60,60
Mvaa 252,252,60
v_add_f32 v60, 1.0, v60
s_waitcnt vmcnt(40) lgkmcnt(0)
Mvaa 128,192,64
v_rcp_f32_e64 v60, v60
Mvaa 160,192,68
Ta 224,16,40960
Ta 226,16,41984
Mvaa 192,192,72
buffer_load_dwordx4 a[48:51], v10, s[20:23], 0 offen offset:3072 sc1
Mvaa 224,192,76
Vc 60,60,60
v_and_b32 v65, 0xffff0000, v60
Mvaa 132,196,64
Ta 228,17,40960
Ta 230,17,41984
Mvaa 164,196,68
v_mov_b32 v48, 0
v_mov_b32 v49, 0
Mvaa 196,196,72
v_mov_b32 v50, 0
v_mov_b32 v51, 0
Mvaa 228,196,76
Ta 232,18,40960
Ta 234,18,41984
Mvaa 136,200,64
v_mov_b32 v52, 0
v_mov_b32 v53, 0
Mvaa 168,200,68
buffer_load_dwordx4 a[52:55], v10, s[20:23], s58 offen offset:3072 sc1
Mvaa 200,200,72
Ta 236,19,40960
Ta 238,19,41984
Mvaa 232,200,76
v_mov_b32 v54, 0
v_mov_b32 v55, 0
Mvaa 140,204,64
v_mov_b32 v56, 0
v_mov_b32 v57, 0
Mvaa 172,204,68
Ta 240,20,40960
Ta 242,20,41984
Mvaa 204,204,72
v_mov_b32 v58, 0
v_mov_b32 v59, 0
Mvaa 236,204,76
v_mov_b32 v60, 0
v_mov_b32 v61, 0
Mvaa 144,208,64
s_waitcnt lgkmcnt(6)
Ta 244,21,40960
Ta 246,21,41984
Mvaa 176,208,68
v_mov_b32 v62, 0
v_mov_b32_e64 v63, 0
Mvaa 208,208,72
buffer_load_dwordx4 a[56:59], v11, s[20:23], 0 offen offset:3072 sc1
Mvaa 240,208,76
Ta 248,22,40960
Ta 250,22,41984
Mvaa 148,212,64
s_mul_i32 s3, s34, s34
s_lshl_b32 s47, s33, 6
s_add_u32 s3, s3, s47
Mvaa 180,212,68
s_lshl_b32 s3, s3, 2
s_add_u32 s3, s3, s32
s_lshl_b32 s3, s3, 7
Mvaa 212,212,72
Ta 252,23,40960
Ta 254,23,41984
Mvaa 244,212,76
s_sub_u32 s3, s3, 512
v_min_u32 v13, 32, v0
v_mov_b32 v28, s92
Mvaa 152,216,64
v_mov_b32 v29, s93
v_mov_b32 v30, v13
Mvaa 184,216,68
v_mov_b32 v14, s94
v_mov_b32 v15, s95
Mvaa 216,216,72
buffer_load_dwordx4 a[60:63], v11, s[20:23], s58 offen offset:3072 sc1
v_add_u32 v10, 4096, v10
v_add_u32 v11, 4096, v11
Mvaa 248,216,76
v_cmp_le_u32 vcc, 8, v13
v_subrev_u32 v31, 8, v13
Mvaa 156,220,64
v_cndmask_b32 v28, v28, v14, vcc
v_cndmask_b32 v29, v29, v15, vcc
Mvaa 188,220,68
v_cndmask_b32 v30, v30, v31, vcc
Mvaa 220,220,72
v_mov_b32 v14, s100
v_mov_b32_e64 v15, s101
Mvaa 252,220,76
v_cmp_le_u32 vcc, 15, v13
v_subrev_u32 v31, 15, v13
s_waitcnt vmcnt(32) lgkmcnt(0)
s_barrier
Mvaa 128,224,80
s_mov_b64 exec, 1
buffer_store_dword v12, v7, s[20:23], s39 offen sc1
s_mov_b64 exec, -1
Mvaa 160,224,84
s_add_u32 m0, s44, 32768
Ta 192,16,49152
Ta 194,16,50176
Mvaa 192,224,88
buffer_load_dwordx4 v8, s[8:11], s48 offen offset:0 lds
Mvaa 224,224,92
v_cndmask_b32 v28, v28, v14, vcc
v_cndmask_b32 v29, v29, v15, vcc
Mvaa 132,228,80
Ta 196,17,49152
Ta 198,17,50176
Mvaa 164,228,84
buffer_load_dwordx4 v8, s[8:11], s49 offen offset:1024 lds
Mvaa 196,228,88
v_cndmask_b32 v30, v30, v31, vcc
Mvaa 228,228,92
Ta 200,18,49152
Ta 202,18,50176
Mvaa 136,232,80
v_mov_b32 v14, s60
v_mov_b32_e64 v15, s61
Mvaa 168,232,84
buffer_load_dwordx4 v9, s[8:11], s50 offen offset:2048 lds
Mvaa 200,232,88
Ta 204,19,49152
Ta 206,19,50176
Mvaa 232,232,92
v_cmp_le_u32 vcc, 19, v13
v_subrev_u32 v31, 19, v13
Mvaa 140,236,80
v_cndmask_b32 v28, v28, v14, vcc
v_cndmask_b32 v29, v29, v15, vcc
Mvaa 172,236,84
Ta 208,20,49152
Ta 210,20,50176
Mvaa 204,236,88
buffer_load_dwordx4 v9, s[8:11], s51 offen offset:3072 lds
v_add_u32 v8, 524288, v8
v_add_u32 v9, 524288, v9
Mvaa 236,236,92
v_cndmask_b32 v30, v30, v31, vcc
Mvaa 144,240,80
s_waitcnt lgkmcnt(6)
Ta 212,21,49152
Ta 214,21,50176
Mvaa 176,240,84
v_mov_b32 v14, s68
v_mov_b32 v15, s69
Mvaa 208,240,88
buffer_load_dwordx4 a[64:67], v10, s[20:23], 0 offen offset:0 sc1
Mvaa 240,240,92
Ta 216,22,49152
Ta 218,22,50176
Mvaa 148,244,80
v_cmp_le_u32 vcc, 26, v13
v_subrev_u32 v31, 26, v13
Mvaa 180,244,84
v_cndmask_b32 v28, v28, v14, vcc
v_cndmask_b32 v29, v29, v15, vcc
Mvaa 212,244,88
Ta 220,23,49152
Ta 222,23,50176
Mvaa 244,244,92
buffer_load_dwordx4 a[68:71], v10, s[20:23], s58 offen offset:0 sc1
Mvaa 152,248,80
v_cndmask_b32 v30, v30, v31, vcc
Mvaa 184,248,84
v_lshlrev_b32 v30, 20, v30
v_add_u32_e64 v30, s3, v30
Mvaa 216,248,88
buffer_load_dwordx4 a[72:75], v11, s[20:23], 0 offen offset:0 sc1
Mvaa 248,248,92
v_ashrrev_i32_e64 v31, 31, v30
v_lshl_add_u64 v[28:29], v[30:31], 0, v[28:29]
Mvaa 156,252,80
s_mov_b32 s40, 512
s_mov_b32 s41, 0
v_readfirstlane_b32 s100, v64
Mvaa 188,252,84
buffer_load_dwordx4 a[76:79], v11, s[20:23], s58 offen offset:0 sc1
Mvaa 220,252,88
v_readfirstlane_b32 s101, v65
Mvaa 252,252,92
s_mov_b32 s24, s60
s_mov_b32 s25, s61
s_mov_b32 s26, s62
s_waitcnt vmcnt(37) lgkmcnt(0)
Mvaa 128,192,96
s_add_u32 s3, s34, 7
s_and_b32 s3, s3, 7
s_lshl_b32 s3, s3, 5
Mvaa 160,192,100
Ta 224,16,57344
Ta 226,16,58368
Mvaa 192,192,104
buffer_load_dwordx4 a[80:83], v10, s[20:23], 0 offen offset:1024 sc1
Mvaa 224,192,108
s_add_u32 s3, s3, s33
s_mul_i32 s92, s3, 2341
s_lshr_b32 s92, s92, 16
Mvaa 132,196,96
Ta 228,17,57344
Ta 230,17,58368
Mvaa 164,196,100
s_mul_i32 s47, s92, 28
s_sub_u32 s4, s3, s47
s_mul_i32 s5, s92, 917504
Mvaa 196,196,104
s_lshl_b32 s47, s4, 8
s_add_u32 s5, s5, s47
s_mov_b32 s94, 1040356334
Mvaa 228,196,108
Ta 232,18,57344
Ta 234,18,58368
Mvaa 136,200,96
s_mov_b32 s95, 1040356334
s_sub_u32 s55, 15, s34
s_sub_u32 s45, s36, 3
Mvaa 168,200,100
buffer_load_dwordx4 a[84:87], v10, s[20:23], s58 offen offset:1024 sc1
Mvaa 200,200,104
Ta 236,19,57344
Ta 238,19,58368
Mvaa 232,200,108
s_sub_u32 s46, s35, 3
s_max_i32 s46, s46, 0
s_add_u32 s53, s44, 65536
Mvaa 140,204,96
s_mov_b32 s54, s44
s_sub_u32 s35, s35, 1
s_sub_u32 s36, s36, 1
Mvaa 172,204,100
Ta 240,20,57344
Ta 242,20,58368
Mvaa 204,204,104
Mvaa 236,204,108
Mvaa 144,208,96
s_waitcnt lgkmcnt(6)
Ta 244,21,57344
Ta 246,21,58368
Mvaa 176,208,100
Mvaa 208,208,104
buffer_load_dwordx4 a[88:91], v11, s[20:23], 0 offen offset:1024 sc1
Mvaa 240,208,108
Ta 248,22,57344
Ta 250,22,58368
Mvaa 148,212,96
Mvaa 180,212,100
Mvaa 212,212,104
Ta 252,23,57344
Ta 254,23,58368
Mvaa 244,212,108
Mvaa 152,216,96
Mvaa 184,216,100
Mvaa 216,216,104
buffer_load_dwordx4 a[92:95], v11, s[20:23], s58 offen offset:1024 sc1
Mvaa 248,216,108
Mvaa 156,220,96
Mvaa 188,220,100
Mvaa 220,220,104
Mvaa 252,220,108
s_waitcnt vmcnt(33) lgkmcnt(0)
s_barrier
Mvaa 128,224,112
Mvaa 160,224,116
s_add_u32 m0, s44, 49152
Ta 192,16,0
Ta 194,16,1024
Mvaa 192,224,120
buffer_load_dwordx4 v8, s[8:11], s48 offen offset:0 lds
Mvaa 224,224,124
Mvaa 132,228,112
Ta 196,17,0
Ta 198,17,1024
Mvaa 164,228,116
buffer_load_dwordx4 v8, s[8:11], s49 offen offset:1024 lds
Mvaa 196,228,120
Mvaa 228,228,124
Ta 200,18,0
Ta 202,18,1024
Mvaa 136,232,112
Mvaa 168,232,116
buffer_load_dwordx4 v9, s[8:11], s50 offen offset:2048 lds
Mvaa 200,232,120
Ta 204,19,0
Ta 206,19,1024
Mvaa 232,232,124
Mvaa 140,236,112
Mvaa 172,236,116
Ta 208,20,0
Ta 210,20,1024
Mvaa 204,236,120
buffer_load_dwordx4 v9, s[8:11], s51 offen offset:3072 lds
v_add_u32 v8, 524288, v8
v_add_u32 v9, 524288, v9
Mvaa 236,236,124
Mvaa 144,240,112
s_waitcnt lgkmcnt(6)
Ta 212,21,0
Ta 214,21,1024
Mvaa 176,240,116
Mvaa 208,240,120
buffer_load_dwordx4 a[96:99], v10, s[20:23], 0 offen offset:2048 sc1
Mvaa 240,240,124
Ta 216,22,0
Ta 218,22,1024
Mvaa 148,244,112
Mvaa 180,244,116
Mvaa 212,244,120
Ta 220,23,0
Ta 222,23,1024
Mvaa 244,244,124
buffer_load_dwordx4 a[100:103], v10, s[20:23], s58 offen offset:2048 sc1
Mvaa 152,248,112
Mvaa 184,248,116
Mvaa 216,248,120
buffer_load_dwordx4 a[104:107], v11, s[20:23], 0 offen offset:2048 sc1
Mvaa 248,248,124
Mvaa 156,252,112
Mvaa 188,252,116
buffer_load_dwordx4 a[108:111], v11, s[20:23], s58 offen offset:2048 sc1
Mvaa 220,252,120
Mvaa 252,252,124
s_waitcnt vmcnt(37) lgkmcnt(0)
Mvaa 128,192,0
Mvaa 160,192,4
Ta 224,16,8192
Ta 226,16,9216
Mvaa 192,192,8
buffer_load_dwordx4 a[112:115], v10, s[20:23], 0 offen offset:3072 sc1
Mvaa 224,192,12
Mvaa 132,196,0
Ta 228,17,8192
Ta 230,17,9216
Mvaa 164,196,4
Mvaa 196,196,8
Mvaa 228,196,12
Ta 232,18,8192
Ta 234,18,9216
Mvaa 136,200,0
Mvaa 168,200,4
buffer_load_dwordx4 a[116:119], v10, s[20:23], s58 offen offset:3072 sc1
Mvaa 200,200,8
Ta 236,19,8192
Ta 238,19,9216
Mvaa 232,200,12
Mvaa 140,204,0
Mvaa 172,204,4
Ta 240,20,8192
Ta 242,20,9216
Mvaa 204,204,8
Mvaa 236,204,12
Mvaa 144,208,0
s_waitcnt lgkmcnt(6)
Ta 244,21,8192
Ta 246,21,9216
Mvaa 176,208,4
Mvaa 208,208,8
buffer_load_dwordx4 a[120:123], v11, s[20:23], 0 offen offset:3072 sc1
Mvaa 240,208,12
Ta 248,22,8192
Ta 250,22,9216
Mvaa 148,212,0
Mvaa 180,212,4
Mvaa 212,212,8
Ta 252,23,8192
Ta 254,23,9216
Mvaa 244,212,12
Mvaa 152,216,0
Mvaa 184,216,4
Mvaa 216,216,8
buffer_load_dwordx4 a[124:127], v11, s[20:23], s58 offen offset:3072 sc1
v_add_u32 v10, 4096, v10
v_add_u32 v11, 4096, v11
Mvaa 248,216,12
Mvaa 156,220,0
Mvaa 188,220,4
Mvaa 220,220,8
Mvaa 252,220,12
s_waitcnt vmcnt(33) lgkmcnt(0)
s_barrier
Mvaa 128,224,16
v_accvgpr_write_b32 a0, 0
v_accvgpr_write_b32 a1, 0
Mvaa 160,224,20
Ta 192,16,16384
Ta 194,16,17408
Mvaa 192,224,24
v_accvgpr_write_b32 a2, 0
v_accvgpr_write_b32 a3, 0
Mvaa 224,224,28
v_accvgpr_write_b32 a4, 0
v_accvgpr_write_b32 a5, 0
Mvaa 132,228,16
Ta 196,17,16384
Ta 198,17,17408
Mvaa 164,228,20
v_accvgpr_write_b32 a6, 0
v_accvgpr_write_b32 a7, 0
Mvaa 196,228,24
v_accvgpr_write_b32 a8, 0
v_accvgpr_write_b32 a9, 0
Mvaa 228,228,28
Ta 200,18,16384
Ta 202,18,17408
Mvaa 136,232,16
v_accvgpr_write_b32 a10, 0
v_accvgpr_write_b32 a11, 0
Mvaa 168,232,20
v_accvgpr_write_b32 a12, 0
v_accvgpr_write_b32 a13, 0
Mvaa 200,232,24
Ta 204,19,16384
Ta 206,19,17408
Mvaa 232,232,28
v_accvgpr_write_b32 a14, 0
v_accvgpr_write_b32 a15, 0
Mvaa 140,236,16
Mvaa 172,236,20
Ta 208,20,16384
Ta 210,20,17408
Mvaa 204,236,24
Mvaa 236,236,28
Mvaa 144,240,16
s_waitcnt lgkmcnt(6)
Ta 212,21,16384
Ta 214,21,17408
Mvaa 176,240,20
Mvaa 208,240,24
Mvaa 240,240,28
Ta 216,22,16384
Ta 218,22,17408
Mvaa 148,244,16
Mvaa 180,244,20
Mvaa 212,244,24
Ta 220,23,16384
Ta 222,23,17408
Mvaa 244,244,28
Mvaa 152,248,16
Mvaa 184,248,20
Mvaa 216,248,24
Mvaa 248,248,28
Mvaa 156,252,16
Mvaa 188,252,20
Mvaa 220,252,24
Mvaa 252,252,28
s_waitcnt vmcnt(29) lgkmcnt(0)
Mvaa 128,192,32
v_accvgpr_write_b32 a16, 0
v_accvgpr_write_b32 a17, 0
Mvaa 160,192,36
Ta 224,16,24576
Ta 226,16,25600
Mvaa 192,192,40
v_accvgpr_write_b32 a18, 0
v_accvgpr_write_b32 a19, 0
Mvaa 224,192,44
v_accvgpr_write_b32 a20, 0
v_accvgpr_write_b32 a21, 0
Mvaa 132,196,32
Ta 228,17,24576
Ta 230,17,25600
Mvaa 164,196,36
v_accvgpr_write_b32 a22, 0
v_accvgpr_write_b32 a23, 0
Mvaa 196,196,40
v_accvgpr_write_b32 a24, 0
v_accvgpr_write_b32 a25, 0
Mvaa 228,196,44
Ta 232,18,24576
Ta 234,18,25600
Mvaa 136,200,32
v_accvgpr_write_b32 a26, 0
v_accvgpr_write_b32 a27, 0
Mvaa 168,200,36
v_accvgpr_write_b32 a28, 0
v_accvgpr_write_b32 a29, 0
Mvaa 200,200,40
Ta 236,19,24576
Ta 238,19,25600
Mvaa 232,200,44
v_accvgpr_write_b32 a30, 0
v_accvgpr_write_b32 a31, 0
Mvaa 140,204,32
Mvaa 172,204,36
Ta 240,20,24576
Ta 242,20,25600
Mvaa 204,204,40
Mvaa 236,204,44
Mvaa 144,208,32
s_waitcnt lgkmcnt(6)
Ta 244,21,24576
Ta 246,21,25600
Mvaa 176,208,36
buffer_load_dword v12, v1, s[20:23], s6 offen sc1
Mvaa 208,208,40
s_add_u32 m0, s44, 65536
s_mov_b32 s7, 0
Mvaa 240,208,44
Ta 248,22,24576
Ta 250,22,25600
Mvaa 148,212,32
Mvaa 180,212,36
Mvaa 212,212,40
Ta 252,23,24576
Ta 254,23,25600
Mvaa 244,212,44
Mvaa 152,216,32
Mvaa 184,216,36
Mvaa 216,216,40
Mvaa 248,216,44
Mvaa 156,220,32
Mvaa 188,220,36
Mvaa 220,220,40
Mvaa 252,220,44
s_waitcnt vmcnt(21) lgkmcnt(0)
s_barrier
Mvaa 128,224,48
v_accvgpr_write_b32 a32, 0
v_accvgpr_write_b32 a33, 0
Mvaa 160,224,52
Ta 192,16,32768
Ta 194,16,33792
Mvaa 192,224,56
v_accvgpr_write_b32 a34, 0
v_accvgpr_write_b32 a35, 0
Mvaa 224,224,60
v_accvgpr_write_b32 a36, 0
v_accvgpr_write_b32 a37, 0
Mvaa 132,228,48
Ta 196,17,32768
Ta 198,17,33792
Mvaa 164,228,52
v_accvgpr_write_b32 a38, 0
v_accvgpr_write_b32 a39, 0
Mvaa 196,228,56
v_accvgpr_write_b32 a40, 0
v_accvgpr_write_b32 a41, 0
Mvaa 228,228,60
Ta 200,18,32768
Ta 202,18,33792
Mvaa 136,232,48
v_accvgpr_write_b32 a42, 0
v_accvgpr_write_b32 a43, 0
Mvaa 168,232,52
v_accvgpr_write_b32 a44, 0
v_accvgpr_write_b32 a45, 0
Mvaa 200,232,56
Ta 204,19,32768
Ta 206,19,33792
Mvaa 232,232,60
v_accvgpr_write_b32 a46, 0
v_accvgpr_write_b32 a47, 0
Mvaa 140,236,48
Mvaa 172,236,52
Ta 208,20,32768
Ta 210,20,33792
Mvaa 204,236,56
Mvaa 236,236,60
Mvaa 144,240,48
s_waitcnt lgkmcnt(6)
Ta 212,21,32768
Ta 214,21,33792
Mvaa 176,240,52
Mvaa 208,240,56
Mvaa 240,240,60
Ta 216,22,32768
Ta 218,22,33792
Mvaa 148,244,48
Mvaa 180,244,52
Mvaa 212,244,56
Ta 220,23,32768
Ta 222,23,33792
Mvaa 244,244,60
Mvaa 152,248,48
Mvaa 184,248,52
Mvaa 216,248,56
Mvaa 248,248,60
Mvaa 156,252,48
Mvaa 188,252,52
Mvaa 220,252,56
Mvaa 252,252,60
s_waitcnt vmcnt(17) lgkmcnt(0)
Mvaa 128,192,64
v_accvgpr_write_b32 a48, 0
v_accvgpr_write_b32 a49, 0
Mvaa 160,192,68
Ta 224,16,40960
Ta 226,16,41984
Mvaa 192,192,72
v_accvgpr_write_b32 a50, 0
v_accvgpr_write_b32 a51, 0
Mvaa 224,192,76
v_accvgpr_write_b32 a52, 0
v_accvgpr_write_b32 a53, 0
Mvaa 132,196,64
Ta 228,17,40960
Ta 230,17,41984
Mvaa 164,196,68
v_accvgpr_write_b32 a54, 0
v_accvgpr_write_b32 a55, 0
Mvaa 196,196,72
v_accvgpr_write_b32 a56, 0
v_accvgpr_write_b32 a57, 0
Mvaa 228,196,76
Ta 232,18,40960
Ta 234,18,41984
Mvaa 136,200,64
v_accvgpr_write_b32 a58, 0
v_accvgpr_write_b32 a59, 0
Mvaa 168,200,68
v_accvgpr_write_b32 a60, 0
v_accvgpr_write_b32 a61, 0
Mvaa 200,200,72
Ta 236,19,40960
Ta 238,19,41984
Mvaa 232,200,76
v_accvgpr_write_b32 a62, 0
v_accvgpr_write_b32 a63, 0
Mvaa 140,204,64
Mvaa 172,204,68
Ta 240,20,40960
Ta 242,20,41984
Mvaa 204,204,72
Mvaa 236,204,76
Mvaa 144,208,64
s_waitcnt lgkmcnt(6)
Ta 244,21,40960
Ta 246,21,41984
Mvaa 176,208,68
Mvaa 208,208,72
Mvaa 240,208,76
Ta 248,22,40960
Ta 250,22,41984
Mvaa 148,212,64
Mvaa 180,212,68
Mvaa 212,212,72
Ta 252,23,40960
Ta 254,23,41984
Mvaa 244,212,76
Mvaa 152,216,64
Mvaa 184,216,68
Mvaa 216,216,72
Mvaa 248,216,76
Mvaa 156,220,64
Mvaa 188,220,68
Mvaa 220,220,72
Mvaa 252,220,76
s_waitcnt vmcnt(0) lgkmcnt(0)
s_cmp_lg_u32 s32, 0
s_cbranch_scc1 L_spinBr
v_cmp_ne_u32 vcc, 1, v12
s_cbranch_vccnz L_spinB
L_spinBr:
s_barrier
Mvaa 128,224,80
buffer_load_dwordx4 v4, s[12:15], s7 offen offset:0 sc1 lds
Mvaa 160,224,84
Ta 192,16,49152
Ta 194,16,50176
Mvaa 192,224,88
v_accvgpr_write_b32 a64, 0
v_accvgpr_write_b32 a65, 0
Mvaa 224,224,92
buffer_load_dwordx4 v4, s[12:15], s7 offen offset:1024 sc1 lds
Mvaa 132,228,80
Ta 196,17,49152
Ta 198,17,50176
Mvaa 164,228,84
v_accvgpr_write_b32 a66, 0
v_accvgpr_write_b32 a67, 0
Mvaa 196,228,88
buffer_load_dwordx4 v4, s[12:15], s7 offen offset:2048 sc1 lds
Mvaa 228,228,92
Ta 200,18,49152
Ta 202,18,50176
Mvaa 136,232,80
v_accvgpr_write_b32 a68, 0
v_accvgpr_write_b32 a69, 0
Mvaa 168,232,84
buffer_load_dwordx4 v4, s[12:15], s7 offen offset:3072 sc1 lds
Mvaa 200,232,88
Ta 204,19,49152
Ta 206,19,50176
Mvaa 232,232,92
s_add_u32 m0, s44, 98304
s_mov_b32 s7, 34816
Mvaa 140,236,80
buffer_load_dwordx4 v4, s[12:15], s7 offen offset:0 sc1 lds
Mvaa 172,236,84
Ta 208,20,49152
Ta 210,20,50176
Mvaa 204,236,88
v_accvgpr_write_b32 a70, 0
v_accvgpr_write_b32 a71, 0
Mvaa 236,236,92
buffer_load_dwordx4 v4, s[12:15], s7 offen offset:1024 sc1 lds
Mvaa 144,240,80
s_waitcnt lgkmcnt(6)
Ta 212,21,49152
Ta 214,21,50176
Mvaa 176,240,84
v_accvgpr_write_b32 a72, 0
v_accvgpr_write_b32 a73, 0
Mvaa 208,240,88
buffer_load_dwordx4 v4, s[12:15], s7 offen offset:2048 sc1 lds
Mvaa 240,240,92
Ta 216,22,49152
Ta 218,22,50176
Mvaa 148,244,80
v_accvgpr_write_b32 a74, 0
v_accvgpr_write_b32 a75, 0
Mvaa 180,244,84
buffer_load_dwordx4 v4, s[12:15], s7 offen offset:3072 sc1 lds
Mvaa 212,244,88
Ta 220,23,49152
Ta 222,23,50176
Mvaa 244,244,92
s_add_u32 m0, s44, 81920
s_mov_b32 s7, 17408
Mvaa 152,248,80
buffer_load_dwordx4 v4, s[12:15], s7 offen offset:0 sc1 lds
Mvaa 184,248,84
v_accvgpr_write_b32 a76, 0
v_accvgpr_write_b32 a77, 0
Mvaa 216,248,88
buffer_load_dwordx4 v4, s[12:15], s7 offen offset:1024 sc1 lds
Mvaa 248,248,92
v_accvgpr_write_b32 a78, 0
v_accvgpr_write_b32 a79, 0
Mvaa 156,252,80
Mvaa 188,252,84
buffer_load_dwordx4 v4, s[12:15], s7 offen offset:2048 sc1 lds
Mvaa 220,252,88
Mvaa 252,252,92
s_waitcnt lgkmcnt(0)
Mvaa 128,192,96
buffer_load_dwordx4 v4, s[12:15], s7 offen offset:3072 sc1 lds
Mvaa 160,192,100
Ta 224,16,57344
Ta 226,16,58368
Mvaa 192,192,104
s_add_u32 m0, s44, 114688
s_mov_b32 s7, 52224
Mvaa 224,192,108
buffer_load_dwordx4 v4, s[12:15], s7 offen offset:0 sc1 lds
Mvaa 132,196,96
Ta 228,17,57344
Ta 230,17,58368
Mvaa 164,196,100
v_accvgpr_write_b32 a80, 0
v_accvgpr_write_b32 a81, 0
Mvaa 196,196,104
buffer_load_dwordx4 v4, s[12:15], s7 offen offset:1024 sc1 lds
Mvaa 228,196,108
Ta 232,18,57344
Ta 234,18,58368
Mvaa 136,200,96
v_accvgpr_write_b32 a82, 0
v_accvgpr_write_b32 a83, 0
Mvaa 168,200,100
buffer_load_dwordx4 v4, s[12:15], s7 offen offset:2048 sc1 lds
Mvaa 200,200,104
Ta 236,19,57344
Ta 238,19,58368
Mvaa 232,200,108
v_accvgpr_write_b32 a84, 0
v_accvgpr_write_b32 a85, 0
Mvaa 140,204,96
buffer_load_dwordx4 v4, s[12:15], s7 offen offset:3072 sc1 lds
Mvaa 172,204,100
Ta 240,20,57344
Ta 242,20,58368
Mvaa 204,204,104
s_add_u32 m0, s44, 0
s_mov_b32 s7, 69632
Mvaa 236,204,108
buffer_load_dwordx4 v4, s[12:15], s7 offen offset:0 sc1 lds
Mvaa 144,208,96
s_waitcnt lgkmcnt(6)
Ta 244,21,57344
Ta 246,21,58368
Mvaa 176,208,100
buffer_load_dwordx4 v4, s[12:15], s7 offen offset:1024 sc1 lds
Mvaa 208,208,104
v_accvgpr_write_b32 a86, 0
v_accvgpr_write_b32 a87, 0
Mvaa 240,208,108
Ta 248,22,57344
Ta 250,22,58368
Mvaa 148,212,96
buffer_load_dwordx4 v4, s[12:15], s7 offen offset:2048 sc1 lds
Mvaa 180,212,100
v_accvgpr_write_b32 a88, 0
v_accvgpr_write_b32 a89, 0
Mvaa 212,212,104
Ta 252,23,57344
Ta 254,23,58368
Mvaa 244,212,108
buffer_load_dwordx4 v4, s[12:15], s7 offen offset:3072 sc1 lds
Mvaa 152,216,96
s_add_u32 m0, s44, 16384
s_mov_b32 s7, 87040
Mvaa 184,216,100
v_accvgpr_write_b32 a90, 0
v_accvgpr_write_b32 a91, 0
Mvaa 216,216,104
buffer_load_dwordx4 v4, s[12:15], s7 offen offset:0 sc1 lds
Mvaa 248,216,108
v_accvgpr_write_b32 a92, 0
v_accvgpr_write_b32 a93, 0
Mvaa 156,220,96
v_accvgpr_write_b32 a94, 0
v_accvgpr_write_b32 a95, 0
Mvaa 188,220,100
buffer_load_dwordx4 v4, s[12:15], s7 offen offset:1024 sc1 lds
Mvaa 220,220,104
Mvaa 252,220,108
s_waitcnt vmcnt(18) lgkmcnt(0)
s_barrier
Mvaa 128,224,112
buffer_load_dwordx4 v4, s[12:15], s7 offen offset:2048 sc1 lds
Mvaa 132,228,112
Ra 192,3,0
Ra 196,3,1024
Mvaa 136,232,112
Ra 200,3,2048
Ra 204,3,3072
Mvaa 140,236,112
buffer_load_dwordx4 v4, s[12:15], s7 offen offset:3072 sc1 lds
Mvaa 144,240,112
s_add_u32 m0, s44, 32768
s_mov_b32 s7, 104448
Mvaa 148,244,112
Ra 208,3,4096
Ra 212,3,5120
Mvaa 152,248,112
buffer_load_dwordx4 v4, s[12:15], s7 offen offset:0 sc1 lds
Mvaa 156,252,112
Ra 216,3,6144
Ra 220,3,7168
Mvaa 160,224,116
buffer_load_dwordx4 v4, s[12:15], s7 offen offset:1024 sc1 lds
Mvaa 164,228,116
Mvaa 168,232,116
Mvaa 172,236,116
buffer_load_dwordx4 v4, s[12:15], s7 offen offset:2048 sc1 lds
Mvaa 176,240,116
v_mul_f32 v128, s94, v128
v_mul_f32 v129, s94, v129
Mvaa 180,244,116
v_mul_f32 v130, s94, v130
v_mul_f32 v131, s94, v131
Mvaa 184,248,116
buffer_load_dwordx4 v4, s[12:15], s7 offen offset:3072 sc1 lds
Mvaa 188,252,116
v_mul_f32 v132, s94, v132
v_mul_f32 v133, s94, v133
Mvaa 192,224,120
v_mul_f32 v134, s94, v134
v_mul_f32 v135, s94, v135
Mvaa 196,228,120
Vc 128,128,129
Vc 129,130,131
Mvaa 200,232,120
Vc 130,132,133
Vc 131,134,135
Mvaa 204,236,120
Aw 128,128
Aw 129,129
Mvaa 208,240,120
Aw 130,130
Aw 131,131
Mvaa 212,244,120
v_mul_f32 v136, s94, v136
v_mul_f32 v137, s94, v137
Mvaa 216,248,120
v_mul_f32 v138, s94, v138
v_mul_f32 v139, s94, v139
Mvaa 220,252,120
v_mul_f32 v140, s94, v140
v_mul_f32 v141, s94, v141
Mvaa 224,224,124
v_mul_f32 v142, s94, v142
v_mul_f32 v143, s94, v143
Mvaa 228,228,124
Vc 136,136,137
Vc 137,138,139
Mvaa 232,232,124
Vc 138,140,141
Vc 139,142,143
Mvaa 236,236,124
Aw 132,136
Aw 133,137
Mvaa 240,240,124
Aw 134,138
Aw 135,139
Mvaa 244,244,124
v_mul_f32 v144, s94, v144
v_mul_f32 v145, s94, v145
Mvaa 248,248,124
v_mul_f32 v146, s94, v146
v_mul_f32 v147, s94, v147
Mvaa 252,252,124
v_mul_f32 v148, s94, v148
v_mul_f32 v149, s94, v149
Ra 224,3,8192
Ra 228,3,9216
Ra 232,3,10240
Ra 236,3,11264
Ra 240,3,12288
Ra 244,3,13312
Ra 248,3,14336
s_waitcnt lgkmcnt(9)
Ra 252,3,15360
v_mul_f32 v150, s94, v150
v_mul_f32_e64 v151, s94, v151
Vc 144,144,145
Vc 145,146,147
Vc 146,148,149
Vc 147,150,151
Aw 136,144
Aw 137,145
Aw 138,146
Aw 139,147
v_mul_f32 v152, s94, v152
v_mul_f32 v153, s94, v153
v_mul_f32 v154, s94, v154
v_mul_f32 v155, s94, v155
v_mul_f32 v156, s94, v156
v_mul_f32 v157, s94, v157
v_mul_f32 v158, s94, v158
v_mul_f32 v159, s94, v159
Vc 152,152,153
Vc 153,154,155
Vc 154,156,157
Vc 155,158,159
Aw 140,152
Aw 141,153
Aw 142,154
Aw 143,155
Zvaa 128,192,128
v_mul_f32 v160, s94, v160
v_mul_f32 v161, s94, v161
v_mul_f32 v162, s94, v162
v_mul_f32 v163, s94, v163
Mvaa 128,196,132
v_mul_f32 v164, s94, v164
v_mul_f32 v165, s94, v165
v_mul_f32 v166, s94, v166
v_mul_f32 v167, s94, v167
Mvaa 128,200,136
Vc 160,160,161
Vc 161,162,163
Vc 162,164,165
Vc 163,166,167
Mvaa 128,204,140
Aw 144,160
Aw 145,161
Aw 146,162
Aw 147,163
s_waitcnt lgkmcnt(8)
Zvaa 132,208,128
v_mul_f32 v168, s94, v168
v_mul_f32 v169, s94, v169
v_mul_f32 v170, s94, v170
v_mul_f32_e64 v171, s94, v171
Mvaa 132,212,132
v_mul_f32 v172, s94, v172
v_mul_f32 v173, s94, v173
v_mul_f32 v174, s94, v174
v_mul_f32 v175, s94, v175
Mvaa 132,216,136
Vc 168,168,169
Vc 169,170,171
Vc 170,172,173
Vc 171,174,175
Mvaa 132,220,140
Aw 148,168
Aw 149,169
Aw 150,170
Aw 151,171
s_waitcnt lgkmcnt(4)
Zvaa 136,224,128
v_mul_f32 v176, s94, v176
v_mul_f32 v177, s94, v177
v_mul_f32 v178, s94, v178
v_mul_f32_e64 v179, s94, v179
Mvaa 136,228,132
v_mul_f32 v180, s94, v180
v_mul_f32 v181, s94, v181
v_mul_f32 v182, s94, v182
v_mul_f32 v183, s94, v183
Mvaa 136,232,136
Vc 176,176,177
Vc 177,178,179
Vc 178,180,181
Vc 179,182,183
Mvaa 136,236,140
Aw 152,176
Aw 153,177
Aw 154,178
Aw 155,179
s_waitcnt lgkmcnt(0)
Zvaa 140,240,128
v_mul_f32 v184, s94, v184
v_mul_f32 v185, s94, v185
v_mul_f32 v186, s94, v186
v_mul_f32_e64 v187, s94, v187
Mvaa 140,244,132
v_mul_f32 v188, s94, v188
v_mul_f32 v189, s94, v189
v_mul_f32 v190, s94, v190
v_mul_f32 v191, s94, v191
Mvaa 140,248,136
Vc 184,184,185
Vc 185,186,187
Vc 186,188,189
Vc 187,190,191
Mvaa 140,252,140
Aw 156,184
Aw 157,185
Aw 158,186
Aw 159,187
Zvaa 144,192,144
v_mul_f32 v192, s94, v192
v_mul_f32 v193, s94, v193
v_mul_f32 v194, s94, v194
v_mul_f32 v195, s94, v195
Mvaa 144,196,148
v_mul_f32 v196, s94, v196
v_mul_f32 v197, s94, v197
v_mul_f32 v198, s94, v198
v_mul_f32 v199, s94, v199
Mvaa 144,200,152
Vc 192,192,193
Vc 193,194,195
Vc 194,196,197
Vc 195,198,199
Mvaa 144,204,156
Aw 160,192
Aw 161,193
Aw 162,194
Aw 163,195
Zvaa 148,208,144
v_mul_f32 v200, s94, v200
v_mul_f32 v201, s94, v201
v_mul_f32 v202, s94, v202
v_mul_f32 v203, s94, v203
Mvaa 148,212,148
v_mul_f32 v204, s94, v204
v_mul_f32 v205, s94, v205
v_mul_f32 v206, s94, v206
v_mul_f32 v207, s94, v207
Mvaa 148,216,152
Vc 200,200,201
Vc 201,202,203
Vc 202,204,205
Vc 203,206,207
Mvaa 148,220,156
Aw 164,200
Aw 165,201
Aw 166,202
Aw 167,203
Zvaa 152,224,144
v_mul_f32 v208, s94, v208
v_mul_f32 v209, s94, v209
v_mul_f32 v210, s94, v210
v_mul_f32 v211, s94, v211
Mvaa 152,228,148
v_mul_f32 v212, s94, v212
v_mul_f32 v213, s94, v213
v_mul_f32 v214, s94, v214
v_mul_f32 v215, s94, v215
Mvaa 152,232,152
Vc 208,208,209
Vc 209,210,211
Vc 210,212,213
Vc 211,214,215
Mvaa 152,236,156
Aw 168,208
Aw 169,209
Aw 170,210
Aw 171,211
Zvaa 156,240,144
v_mul_f32 v216, s94, v216
v_mul_f32 v217, s94, v217
v_mul_f32 v218, s94, v218
v_mul_f32 v219, s94, v219
Mvaa 156,244,148
v_mul_f32 v220, s94, v220
v_mul_f32 v221, s94, v221
v_mul_f32 v222, s94, v222
v_mul_f32 v223, s94, v223
Mvaa 156,248,152
Vc 216,216,217
Vc 217,218,219
Vc 218,220,221
Vc 219,222,223
Mvaa 156,252,156
Aw 172,216
Aw 173,217
Aw 174,218
Aw 175,219
Zvaa 160,192,160
v_mul_f32 v224, s94, v224
v_mul_f32 v225, s94, v225
v_mul_f32 v226, s94, v226
v_mul_f32 v227, s94, v227
Mvaa 160,196,164
v_mul_f32 v228, s94, v228
v_mul_f32 v229, s94, v229
v_mul_f32 v230, s94, v230
v_mul_f32 v231, s94, v231
Mvaa 160,200,168
Vc 224,224,225
Vc 225,226,227
Vc 226,228,229
Vc 227,230,231
Mvaa 160,204,172
Aw 176,224
Aw 177,225
Aw 178,226
Aw 179,227
Zvaa 164,208,160
v_mul_f32 v232, s94, v232
v_mul_f32 v233, s94, v233
v_mul_f32 v234, s94, v234
v_mul_f32 v235, s94, v235
Mvaa 164,212,164
v_mul_f32 v236, s94, v236
v_mul_f32 v237, s94, v237
v_mul_f32 v238, s94, v238
v_mul_f32 v239, s94, v239
Mvaa 164,216,168
Vc 232,232,233
Vc 233,234,235
Vc 234,236,237
Vc 235,238,239
Mvaa 164,220,172
Aw 180,232
Aw 181,233
Aw 182,234
Aw 183,235
Zvaa 168,224,160
v_mul_f32 v240, s94, v240
v_mul_f32 v241, s94, v241
v_mul_f32 v242, s94, v242
v_mul_f32 v243, s94, v243
Mvaa 168,228,164
v_mul_f32 v244, s94, v244
v_mul_f32 v245, s94, v245
v_mul_f32 v246, s94, v246
v_mul_f32 v247, s94, v247
Mvaa 168,232,168
Vc 240,240,241
Vc 241,242,243
Vc 242,244,245
Vc 243,246,247
Mvaa 168,236,172
Aw 184,240
Aw 185,241
Aw 186,242
Aw 187,243
Zvaa 172,240,160
v_mul_f32 v248, s94, v248
v_mul_f32 v249, s94, v249
v_mul_f32 v250, s94, v250
v_mul_f32 v251, s94, v251
Mvaa 172,244,164
v_mul_f32 v252, s94, v252
v_mul_f32 v253, s94, v253
v_mul_f32 v254, s94, v254
v_mul_f32 v255, s94, v255
Mvaa 172,248,168
Vc 248,248,249
Vc 249,250,251
Vc 250,252,253
Vc 251,254,255
Mvaa 172,252,172
Aw 188,248
Aw 189,249
Aw 190,250
Aw 191,251
Zvaa 176,192,176
v_accvgpr_write_b32 a96, 0
v_accvgpr_write_b32 a97, 0
v_accvgpr_write_b32 a98, 0
v_accvgpr_write_b32 a99, 0
Mvaa 176,196,180
v_accvgpr_write_b32 a100, 0
v_accvgpr_write_b32 a101, 0
v_accvgpr_write_b32 a102, 0
v_accvgpr_write_b32 a103, 0
Mvaa 176,200,184
v_accvgpr_write_b32 a104, 0
v_accvgpr_write_b32 a105, 0
v_accvgpr_write_b32 a106, 0
v_accvgpr_write_b32 a107, 0
Mvaa 176,204,188
v_accvgpr_write_b32 a108, 0
v_accvgpr_write_b32 a109, 0
v_accvgpr_write_b32 a110, 0
v_accvgpr_write_b32 a111, 0
Zvaa 180,208,176
v_accvgpr_write_b32 a112, 0
v_accvgpr_write_b32 a113, 0
v_accvgpr_write_b32 a114, 0
v_accvgpr_write_b32 a115, 0
Mvaa 180,212,180
v_accvgpr_write_b32 a116, 0
v_accvgpr_write_b32 a117, 0
v_accvgpr_write_b32 a118, 0
v_accvgpr_write_b32 a119, 0
Mvaa 180,216,184
v_accvgpr_write_b32 a120, 0
v_accvgpr_write_b32 a121, 0
v_accvgpr_write_b32 a122, 0
v_accvgpr_write_b32 a123, 0
Mvaa 180,220,188
v_accvgpr_write_b32 a124, 0
v_accvgpr_write_b32 a125, 0
v_accvgpr_write_b32 a126, 0
v_accvgpr_write_b32 a127, 0
s_waitcnt vmcnt(16)
s_barrier
Zvaa 184,224,176
Ra 192,3,32768
v_mov_b32 v16, 0x3f803f80
v_mov_b32 v17, 0x3f803f80
v_mov_b32 v18, 0x3f803f80
v_mov_b32 v19, 0x3f803f80
Mvaa 184,228,180
Ra 196,3,33792
v_mov_b32 v20, 0xff800000
v_max3_f32 v22, v128, v129, v130
v_max3_f32 v22, v22, v131, v132
v_max3_f32 v22, v22, v133, v134
Mvaa 184,232,184
Ra 200,3,34816
v_max3_f32 v22, v22, v135, v136
v_max3_f32 v22, v22, v137, v138
v_max3_f32 v22, v22, v139, v140
v_max3_f32 v22, v22, v141, v142
Mvaa 184,236,188
Ra 204,3,35840
v_max_f32 v22, v22, v143
v_mov_b32 v1, v22
s_nop 1
v_permlane16_swap_b32 v1, v22
v_max_f32_e64 v22, v22, v1
Zvaa 188,240,176
Ra 208,3,36864
v_mov_b32 v1, v22
s_nop 1
v_permlane32_swap_b32 v1, v22
v_max_f32 v22, v22, v1
v_add_f32 v22, 0x41f80000, v22
Mvaa 188,244,180
Ra 212,3,37888
Vs 128,128,22
Vs 129,129,22
Vs 130,130,22
Vs 131,131,22
Mvaa 188,248,184
Ra 216,3,38912
Vs 132,132,22
Vs 133,133,22
Vs 134,134,22
Vs 135,135,22
Mvaa 188,252,188
Ra 220,3,39936
Vs 136,136,22
Vs 137,137,22
Vs 138,138,22
Vs 139,139,22
Vs 140,140,22
Vs 141,141,22
Vs 142,142,22
Vs 143,143,22
v_sub_f32 v32, 0, v22
v_sub_f32 v33, 0, v22
v_sub_f32 v34, 0, v22
v_sub_f32 v35, 0, v22
v_max3_f32 v22, v144, v145, v146
v_max3_f32 v22, v22, v147, v148
v_max3_f32 v22, v22, v149, v150
v_max3_f32 v22, v22, v151, v152
v_max3_f32 v22, v22, v153, v154
v_max3_f32 v22, v22, v155, v156
v_max3_f32 v22, v22, v157, v158
v_max_f32 v22, v22, v159
v_mov_b32 v1, v22
s_nop 1
v_permlane16_swap_b32 v1, v22
v_max_f32 v22, v22, v1
v_mov_b32 v1, v22
s_nop 1
v_permlane32_swap_b32 v1, v22
v_max_f32_e64 v22, v22, v1
v_add_f32 v22, 0x41f80000, v22
Vs 144,144,22
Vs 145,145,22
Vs 146,146,22
Vs 147,147,22
Vs 148,148,22
Vs 149,149,22
Vs 150,150,22
Vs 151,151,22
Vs 152,152,22
Vs 153,153,22
Vs 154,154,22
Vs 155,155,22
Vs 156,156,22
Vs 157,157,22
Vs 158,158,22
Vs 159,159,22
v_sub_f32 v36, 0, v22
v_sub_f32 v37, 0, v22
v_sub_f32 v38, 0, v22
v_sub_f32 v39, 0, v22
s_mov_b32 s38, 139264
s_mov_b32 s39, 121856
s_mov_b32 s37, -1
s_cmp_lg_u32 s34, 0
s_cbranch_scc1 L_k2_nomask0
s_nop 7
s_add_u32 s3, s37, 1
s_lshl_b32 s3, s3, 6
v_subrev_u32_e64 v1, s3, v6
v_cmp_gt_i32 s[56:57], -16, v1
v_cmp_gt_i32 s[58:59], -15, v1
v_cmp_gt_i32 s[60:61], -14, v1
v_cmp_gt_i32 s[62:63], -13, v1
v_cndmask_b32 v176, v176, v20, s[56:57]
v_cndmask_b32 v177, v177, v20, s[58:59]
v_cndmask_b32 v178, v178, v20, s[60:61]
v_cndmask_b32 v179, v179, v20, s[62:63]
v_cmp_gt_i32 s[56:57], 0, v1
v_cmp_gt_i32 s[58:59], 1, v1
v_cmp_gt_i32 s[60:61], 2, v1
v_cmp_gt_i32 s[62:63], 3, v1
v_cndmask_b32 v160, v160, v20, s[56:57]
v_cndmask_b32 v161, v161, v20, s[58:59]
v_cndmask_b32 v162, v162, v20, s[60:61]
v_cndmask_b32 v163, v163, v20, s[62:63]
v_cndmask_b32 v180, v180, v20, s[56:57]
v_cndmask_b32 v181, v181, v20, s[58:59]
v_cndmask_b32 v182, v182, v20, s[60:61]
v_cndmask_b32 v183, v183, v20, s[62:63]
v_cmp_gt_i32 s[56:57], 16, v1
v_cmp_gt_i32 s[58:59], 17, v1
v_cmp_gt_i32 s[60:61], 18, v1
v_cmp_gt_i32 s[62:63], 19, v1
v_cndmask_b32 v164, v164, v20, s[56:57]
v_cndmask_b32 v165, v165, v20, s[58:59]
v_cndmask_b32 v166, v166, v20, s[60:61]
v_cndmask_b32 v167, v167, v20, s[62:63]
v_cndmask_b32 v184, v184, v20, s[56:57]
v_cndmask_b32 v185, v185, v20, s[58:59]
v_cndmask_b32 v186, v186, v20, s[60:61]
v_cndmask_b32 v187, v187, v20, s[62:63]
v_cmp_gt_i32 s[56:57], 32, v1
v_cmp_gt_i32 s[58:59], 33, v1
v_cmp_gt_i32 s[60:61], 34, v1
v_cmp_gt_i32 s[62:63], 35, v1
v_cndmask_b32 v168, v168, v20, s[56:57]
v_cndmask_b32 v169, v169, v20, s[58:59]
v_cndmask_b32 v170, v170, v20, s[60:61]
v_cndmask_b32 v171, v171, v20, s[62:63]
v_cndmask_b32 v188, v188, v20, s[56:57]
v_cndmask_b32 v189, v189, v20, s[58:59]
v_cndmask_b32 v190, v190, v20, s[60:61]
v_cndmask_b32 v191, v191, v20, s[62:63]
v_cmp_gt_i32 s[56:57], 48, v1
v_cmp_gt_i32 s[58:59], 49, v1
v_cmp_gt_i32 s[60:61], 50, v1
v_cmp_gt_i32 s[62:63], 51, v1
v_cndmask_b32 v172, v172, v20, s[56:57]
v_cndmask_b32 v173, v173, v20, s[58:59]
v_cndmask_b32 v174, v174, v20, s[60:61]
v_cndmask_b32 v175, v175, v20, s[62:63]
s_nop 1
L_k2_nomask0:
s_mov_b32 s37, 0
v_max3_f32 v22, v160, v161, v162
v_max3_f32 v22, v22, v163, v164
v_max3_f32 v22, v22, v165, v166
v_max3_f32 v22, v22, v167, v168
v_max3_f32 v22, v22, v169, v170
v_max3_f32 v22, v22, v171, v172
v_max3_f32 v22, v22, v173, v174
v_max_f32 v22, v22, v175
v_mov_b32 v1, v22
s_nop 1
v_permlane16_swap_b32 v1, v22
v_max_f32 v22, v22, v1
v_mov_b32 v1, v22
s_nop 1
v_permlane32_swap_b32 v1, v22
v_max_f32_e64 v22, v22, v1
v_add_f32 v22, 0x41f80000, v22
Vs 160,160,22
Vs 161,161,22
Vs 162,162,22
Vs 163,163,22
Vs 164,164,22
Vs 165,165,22
Vs 166,166,22
Vs 167,167,22
Vs 168,168,22
Vs 169,169,22
Vs 170,170,22
Vs 171,171,22
Vs 172,172,22
Vs 173,173,22
Vs 174,174,22
Vs 175,175,22
v_sub_f32 v40, 0, v22
v_sub_f32 v41, 0, v22
v_sub_f32 v42, 0, v22
v_sub_f32 v43, 0, v22
v_max3_f32 v22, v176, v177, v178
v_max3_f32 v22, v22, v179, v180
v_max3_f32 v22, v22, v181, v182
v_max3_f32 v22, v22, v183, v184
v_max3_f32 v22, v22, v185, v186
v_max3_f32 v22, v22, v187, v188
v_max3_f32 v22, v22, v189, v190
v_max_f32 v22, v22, v191
v_mov_b32 v1, v22
s_nop 1
v_permlane16_swap_b32 v1, v22
v_max_f32 v22, v22, v1
v_mov_b32 v1, v22
s_nop 1
v_permlane32_swap_b32 v1, v22
v_max_f32_e64 v22, v22, v1
v_add_f32 v22, 0x41f80000, v22
Vs 176,176,22
Vs 177,177,22
Vs 178,178,22
Vs 179,179,22
Vs 180,180,22
Vs 181,181,22
Vs 182,182,22
Vs 183,183,22
Vs 184,184,22
Vs 185,185,22
Vs 186,186,22
Vs 187,187,22
Vs 188,188,22
Vs 189,189,22
Vs 190,190,22
Vs 191,191,22
v_sub_f32 v44, 0, v22
v_sub_f32 v45, 0, v22
v_sub_f32 v46, 0, v22
v_sub_f32 v47, 0, v22
Ve 8,128
Ve 9,129
Ve 10,130
Ve 11,131
Vc 64,8,9
Ve 12,144
Ve 13,145
Vc 65,10,11
Ve 14,146
Ve 15,147
Vc 72,12,13
Ve 8,160
Ve 9,161
Vc 73,14,15
Ve 10,162
Ve 11,163
Vc 80,8,9
Ve 12,176
Ve 13,177
Vc 81,10,11
Ve 14,178
Ve 15,179
Vc 88,12,13
Ve 8,132
Ve 9,133
Vc 89,14,15
Ve 10,134
Ve 11,135
Vc 66,8,9
Ve 12,148
Ve 13,149
Vc 67,10,11
Ve 14,150
Ve 15,151
Vc 74,12,13
Ve 8,164
Ve 9,165
Vc 75,14,15
Ve 10,166
Ve 11,167
Vc 82,8,9
Ve 12,180
Ve 13,181
Vc 83,10,11
Ve 14,182
Ve 15,183
Vc 90,12,13
Vc 91,14,15
v_or_b32_e64 v7, v64, v65
v_or3_b32 v7, v7, v72, v73
v_or3_b32 v7, v7, v80, v81
v_or3_b32 v7, v7, v88, v89
v_or3_b32 v7, v7, v66, v67
v_or3_b32 v7, v7, v74, v75
v_or3_b32 v7, v7, v82, v83
v_or3_b32 v7, v7, v90, v91
s_waitcnt lgkmcnt(4)
L_k2_wloop:
v_xor_b32 v2, 65536, v2
v_xor_b32 v3, 65536, v3
Cvaa 192,192,128,32
s_mov_b32 m0, s53
Ra 224,2,40960
v_lshl_add_u64 v[28:29], s[40:41], 0, v[28:29]
Mvaa 192,196,132
buffer_load_dwordx4 v4, s[12:15], s38 offen offset:0 sc1 lds
Mvaa 192,200,136
VE 8,136
Mvaa 192,204,140
VE 9,137
Cvaa 208,192,144,36
Ra 228,2,41984
Vc 68,8,9
Mvaa 208,196,148
VE 10,138
Mvaa 208,200,152
VE 11,139
Mvaa 208,204,156
Ra 232,2,43008
Vc 69,10,11
Cvaa 224,192,160,40
Ra 236,2,44032
v_or3_b32 v7, v7, v68, v69
Mvaa 224,196,164
VE 12,152
Mvaa 224,200,168
VE 13,153
Mvaa 224,204,172
Ra 240,2,45056
Vc 76,12,13
Cvaa 240,192,176,44
VE 14,154
Mvaa 240,196,180
VE 15,155
Mvaa 240,200,184
Ra 244,2,46080
Vc 77,14,15
Mvaa 240,204,188
s_waitcnt lgkmcnt(6)
Ra 248,2,47104
v_or3_b32 v7, v7, v76, v77
Cvaa 196,208,128,32
buffer_load_dwordx4 v4, s[12:15], s38 offen offset:1024 sc1 lds
Mvaa 196,212,132
Ve 8,168
Mvaa 196,216,136
VE 9,169
Mvaa 196,220,140
Ra 252,2,48128
Vc 84,8,9
Cvaa 212,208,144,36
VE 10,170
Mvaa 212,212,148
VE 11,171
Mvaa 212,216,152
Ra 192,2,16384
Vc 85,10,11
Mvaa 212,220,156
Ra 196,2,17408
v_or3_b32 v7, v7, v84, v85
Cvaa 228,208,160,40
VE 12,184
Mvaa 228,212,164
VE 13,185
Mvaa 228,216,168
Ra 200,2,18432
Vc 92,12,13
Mvaa 228,220,172
VE 14,186
Cvaa 244,208,176,44
VE 15,187
Mvaa 244,212,180
buffer_load_dwordx4 v4, s[12:15], s38 offen offset:2048 sc1 lds
Mvaa 244,216,184
Ra 204,2,19456
Vc 93,14,15
Mvaa 244,220,188
s_waitcnt lgkmcnt(8)
Ve 8,140
Cvaa 200,224,128,32
Ra 208,2,20480
v_or3_b32 v7, v7, v92, v93
Mvaa 200,228,132
VE 9,141
Mvaa 200,232,136
Ra 212,2,21504
Vc 70,8,9
Mvaa 200,236,140
VE 10,142
Cvaa 216,224,144,36
VE 11,143
Mvaa 216,228,148
Ra 216,2,22528
Vc 71,10,11
Mvaa 216,232,152
Ra 220,2,23552
v_or3_b32 v7, v7, v70, v71
Mvaa 216,236,156
VE 12,156
Cvaa 232,224,160,40
VE 13,157
Mvaa 232,228,164
VE 14,158
Mvaa 232,232,168
VE 15,159
Mvaa 232,236,172
buffer_load_dwordx4 v4, s[12:15], s38 offen offset:3072 sc1 lds
Cvaa 248,224,176,44
VE 8,172
Mvaa 248,228,180
VE 9,173
Mvaa 248,232,184
Vc 78,12,13
Vc 79,14,15
Mvaa 248,236,188
s_waitcnt lgkmcnt(8)
Ve 10,174
Cvaa 204,240,128,32
VE 11,175
Mvaa 204,244,132
Vc 86,8,9
Vc 87,10,11
Mvaa 204,248,136
VE 12,188
Mvaa 204,252,140
VE 13,189
Cvaa 220,240,144,36
Vc 94,12,13
v_or3_b32 v7, v7, v78, v79
Mvaa 220,244,148
VE 14,190
Mvaa 220,248,152
VE 15,191
Mvaa 220,252,156
Vc 95,14,15
v_or3_b32 v7, v7, v86, v87
Cvaa 236,240,160,40
v_or3_b32 v7, v7, v94, v95
v_and_b32 v1, 0x40004000, v7
Mvaa 236,244,164
v_cmp_ne_u32 vcc, 0, v1
Mvaa 236,248,168
Mvaa 236,252,172
s_cmp_ge_u32 s37, s46
Cvaa 252,240,176,44
s_waitcnt vmcnt(12)
Mvaa 252,244,180
s_barrier
Mvaa 252,248,184
s_waitcnt lgkmcnt(4)
Mvaa 252,252,188
s_cbranch_vccnz L_k2_fb_we
L_k2_fbr_we:
Maav 0,192,64
s_cbranch_scc1 L_k2_mk_we
L_k2_mkr_we:
Ve 8,192
Maav 0,196,68
s_add_u32 m0, s54, 49152
VE 9,193
Maav 32,192,72
buffer_load_dwordx4 v4, s[12:15], s39 offen offset:0 sc1 lds
Maav 32,196,76
s_add_u32 s37, s37, 1
Ra 224,2,24576
Vc 96,8,9
Maav 64,192,80
s_add_u32 s38, s38, 34816
Ve 10,194
Maav 64,196,84
VE 11,195
Maav 96,192,88
Ra 228,2,25600
Vc 97,10,11
Maav 96,196,92
Ra 232,2,26624
v_or_b32_e64 v7, v96, v97
Maav 4,200,64
VE 12,208
Maav 4,204,68
VE 13,209
Maav 36,200,72
Ra 236,2,27648
Vc 104,12,13
Maav 36,204,76
VE 14,210
Maav 68,200,80
VE 15,211
Maav 68,204,84
Ra 240,2,28672
Vc 105,14,15
Maav 100,200,88
Ra 244,2,29696
v_or3_b32 v7, v7, v104, v105
Maav 100,204,92
buffer_load_dwordx4 v4, s[12:15], s39 offen offset:1024 sc1 lds
Mvvv 48,16,64
VE 8,224
Mvvv 48,16,68
s_waitcnt lgkmcnt(6)
Ve 9,225
Maav 8,208,64
Ra 248,2,30720
Vc 112,8,9
Maav 8,212,68
VE 10,226
Maav 40,208,72
VE 11,227
Maav 40,212,76
Ra 252,2,31744
Vc 113,10,11
Maav 72,208,80
Ra 192,3,0
v_or3_b32 v7, v7, v112, v113
Maav 72,212,84
VE 12,240
Maav 104,208,88
VE 13,241
Maav 104,212,92
Ra 196,3,1024
Vc 120,12,13
Maav 12,216,64
VE 14,242
Maav 12,220,68
VE 15,243
Maav 44,216,72
Ra 200,3,2048
Vc 121,14,15
Maav 44,220,76
buffer_load_dwordx4 v4, s[12:15], s39 offen offset:2048 sc1 lds
Maav 76,216,80
Ra 204,3,3072
v_or3_b32 v7, v7, v120, v121
Maav 76,220,84
VE 8,196
Maav 108,216,88
VE 9,197
Maav 108,220,92
VE 10,198
Mvvv 52,16,72
VE 11,199
Mvvv 52,16,76
s_waitcnt lgkmcnt(8)
Ve 12,212
Maav 16,224,64
Ra 208,3,4096
Vc 98,8,9
Maav 16,228,68
Ra 212,3,5120
Vc 99,10,11
Maav 48,224,72
Ra 216,3,6144
v_or3_b32 v7, v7, v98, v99
Maav 48,228,76
VE 13,213
Maav 80,224,80
Ra 220,3,7168
Vc 106,12,13
Maav 80,228,84
VE 14,214
Maav 112,224,88
buffer_load_dwordx4 v4, s[12:15], s39 offen offset:3072 sc1 lds
Maav 112,228,92
s_add_u32 s39, s39, 34816
VE 15,215
Maav 20,232,64
VE 8,228
Maav 20,236,68
VE 9,229
Maav 52,232,72
VE 10,230
Maav 52,236,76
VE 11,231
Maav 84,232,80
Vc 107,14,15
Vc 114,8,9
Maav 84,236,84
VE 12,244
Maav 116,232,88
VE 13,245
Maav 116,236,92
Vc 115,10,11
Vc 122,12,13
Mvvv 56,16,80
VE 14,246
Mvvv 56,16,84
s_waitcnt lgkmcnt(8)
Ve 15,247
Maav 24,240,64
Vc 123,14,15
v_or3_b32 v7, v7, v106, v107
Maav 24,244,68
v_or3_b32 v7, v7, v114, v115
v_or3_b32 v7, v7, v122, v123
Maav 56,240,72
global_load_dword v30, v[28:29], off
Maav 56,244,76
Maav 88,240,80
Maav 88,244,84
Maav 120,240,88
Maav 120,244,92
Maav 28,248,64
Maav 28,252,68
Maav 60,248,72
Maav 60,252,76
Maav 92,248,80
Maav 92,252,84
Maav 124,248,88
Maav 124,252,92
s_cmp_eq_u32 s37, s35
Mvvv 60,16,88
s_waitcnt lgkmcnt(4)
Mvvv 60,16,92
s_cbranch_scc1 L_k2_trans
Ve 8,200
Cvaa 128,192,128,32
s_add_u32 m0, s53, 32768
Ra 224,3,8192
v_lshl_add_u64 v[28:29], s[40:41], 0, v[28:29]
Mvaa 128,196,132
buffer_load_dwordx4 v4, s[12:15], s38 offen offset:0 sc1 lds
Mvaa 128,200,136
VE 9,201
Mvaa 128,204,140
Ra 228,3,9216
Vc 100,8,9
Cvaa 144,192,144,36
VE 10,202
Mvaa 144,196,148
VE 11,203
Mvaa 144,200,152
Ra 232,3,10240
Vc 101,10,11
Mvaa 144,204,156
Ra 236,3,11264
v_or3_b32 v7, v7, v100, v101
Cvaa 160,192,160,40
VE 12,216
Mvaa 160,196,164
VE 13,217
Mvaa 160,200,168
Ra 240,3,12288
Vc 108,12,13
Mvaa 160,204,172
VE 14,218
Cvaa 176,192,176,44
VE 15,219
Mvaa 176,196,180
Ra 244,3,13312
Vc 109,14,15
Mvaa 176,200,184
Ra 248,3,14336
v_or3_b32 v7, v7, v108, v109
Mvaa 176,204,188
s_waitcnt lgkmcnt(7)
Ve 8,232
Cvaa 132,208,128,32
buffer_load_dwordx4 v4, s[12:15], s38 offen offset:1024 sc1 lds
Mvaa 132,212,132
VE 9,233
Mvaa 132,216,136
Ra 252,3,15360
Vc 116,8,9
Mvaa 132,220,140
VE 10,234
Cvaa 148,208,144,36
VE 11,235
Mvaa 148,212,148
Ra 192,2,49152
Vc 117,10,11
Mvaa 148,216,152
Ra 196,2,50176
v_or3_b32 v7, v7, v116, v117
Mvaa 148,220,156
VE 12,248
Cvaa 164,208,160,40
VE 13,249
Mvaa 164,212,164
Ra 200,2,51200
Vc 124,12,13
Mvaa 164,216,168
VE 14,250
Mvaa 164,220,172
VE 15,251
Cvaa 180,208,176,44
Ra 204,2,52224
Vc 125,14,15
Mvaa 180,212,180
buffer_load_dwordx4 v4, s[12:15], s38 offen offset:2048 sc1 lds
Mvaa 180,216,184
VE 8,204
Mvaa 180,220,188
s_waitcnt lgkmcnt(8)
Ve 9,205
Cvaa 136,224,128,32
Ra 208,2,53248
Vc 102,8,9
Mvaa 136,228,132
Ra 212,2,54272
v_or3_b32 v7, v7, v124, v125
Mvaa 136,232,136
VE 10,206
Mvaa 136,236,140
VE 11,207
Cvaa 152,224,144,36
Ra 216,2,55296
Vc 103,10,11
Mvaa 152,228,148
Ra 220,2,56320
v_or3_b32 v7, v7, v102, v103
Mvaa 152,232,152
VE 12,220
Mvaa 152,236,156
VE 13,221
Cvaa 168,224,160,40
VE 14,222
Mvaa 168,228,164
VE 15,223
Mvaa 168,232,168
VE 8,236
Mvaa 168,236,172
buffer_load_dwordx4 v4, s[12:15], s38 offen offset:3072 sc1 lds
Cvaa 184,224,176,44
VE 9,237
Mvaa 184,228,180
Vc 110,12,13
Vc 111,14,15
Mvaa 184,232,184
VE 10,238
Mvaa 184,236,188
s_waitcnt lgkmcnt(8)
Ve 11,239
Cvaa 140,240,128,32
Vc 118,8,9
Vc 119,10,11
Mvaa 140,244,132
VE 12,252
Mvaa 140,248,136
VE 13,253
Mvaa 140,252,140
Vc 126,12,13
v_or3_b32 v7, v7, v110, v111
Cvaa 156,240,144,36
VE 14,254
Mvaa 156,244,148
VE 15,255
Mvaa 156,248,152
Vc 127,14,15
v_or3_b32 v7, v7, v118, v119
Mvaa 156,252,156
v_or3_b32 v7, v7, v126, v127
v_and_b32 v1, 0x40004000, v7
Cvaa 172,240,160,40
v_cmp_ne_u32 vcc, 0, v1
Mvaa 172,244,164
Mvaa 172,248,168
Mvaa 172,252,172
s_cmp_ge_u32 s37, s46
Cvaa 188,240,176,44
s_waitcnt vmcnt(12)
Mvaa 188,244,180
s_barrier
Mvaa 188,248,184
s_waitcnt lgkmcnt(4)
Mvaa 188,252,188
s_cbranch_vccnz L_k2_fb_wo
L_k2_fbr_wo:
Maav 0,192,96
s_cbranch_scc1 L_k2_mk_wo
L_k2_mkr_wo:
Ve 8,128
Maav 0,196,100
s_add_u32 m0, s53, 16384
VE 9,129
Maav 32,192,104
buffer_load_dwordx4 v4, s[12:15], s39 offen offset:0 sc1 lds
Maav 32,196,108
s_add_u32 s37, s37, 1
Ra 224,2,57344
Vc 64,8,9
Maav 64,192,112
s_add_u32 s38, s38, 34816
Ve 10,130
Maav 64,196,116
s_xor_b32 s53, s53, 65536
VE 11,131
Maav 96,192,120
s_xor_b32 s54, s54, 65536
Ra 228,2,58368
Vc 65,10,11
Maav 96,196,124
Ra 232,2,59392
v_or_b32_e64 v7, v64, v65
Maav 4,200,96
VE 12,144
Maav 4,204,100
VE 13,145
Maav 36,200,104
Ra 236,2,60416
Vc 72,12,13
Maav 36,204,108
VE 14,146
Maav 68,200,112
VE 15,147
Maav 68,204,116
Ra 240,2,61440
Vc 73,14,15
Maav 100,200,120
Ra 244,2,62464
v_or3_b32 v7, v7, v72, v73
Maav 100,204,124
buffer_load_dwordx4 v4, s[12:15], s39 offen offset:1024 sc1 lds
Mvvv 48,16,96
VE 8,160
Mvvv 48,16,100
s_waitcnt lgkmcnt(6)
Ve 9,161
Maav 8,208,96
Ra 248,2,63488
Vc 80,8,9
Maav 8,212,100
VE 10,162
Maav 40,208,104
VE 11,163
Maav 40,212,108
Ra 252,2,64512
Vc 81,10,11
Maav 72,208,112
Ra 192,3,32768
v_or3_b32 v7, v7, v80, v81
Maav 72,212,116
VE 12,176
Maav 104,208,120
VE 13,177
Maav 104,212,124
Ra 196,3,33792
Vc 88,12,13
Maav 12,216,96
VE 14,178
Maav 12,220,100
VE 15,179
Maav 44,216,104
Ra 200,3,34816
Vc 89,14,15
Maav 44,220,108
buffer_load_dwordx4 v4, s[12:15], s39 offen offset:2048 sc1 lds
Maav 76,216,112
Ra 204,3,35840
v_or3_b32 v7, v7, v88, v89
Maav 76,220,116
VE 8,132
Maav 108,216,120
VE 9,133
Maav 108,220,124
VE 10,134
Mvvv 52,16,104
VE 11,135
Mvvv 52,16,108
s_waitcnt lgkmcnt(8)
Ve 12,148
Maav 16,224,96
Ra 208,3,36864
Vc 66,8,9
Maav 16,228,100
Ra 212,3,37888
Vc 67,10,11
Maav 48,224,104
Ra 216,3,38912
v_or3_b32 v7, v7, v66, v67
Maav 48,228,108
VE 13,149
Maav 80,224,112
Ra 220,3,39936
Vc 74,12,13
Maav 80,228,116
VE 14,150
Maav 112,224,120
buffer_load_dwordx4 v4, s[12:15], s39 offen offset:3072 sc1 lds
Maav 112,228,124
s_add_u32 s39, s39, 34816
VE 15,151
Maav 20,232,96
VE 8,164
Maav 20,236,100
VE 9,165
Maav 52,232,104
VE 10,166
Maav 52,236,108
VE 11,167
Maav 84,232,112
Vc 75,14,15
Vc 82,8,9
Maav 84,236,116
VE 12,180
Maav 116,232,120
VE 13,181
Maav 116,236,124
Vc 83,10,11
Vc 90,12,13
Mvvv 56,16,112
VE 14,182
Mvvv 56,16,116
s_waitcnt lgkmcnt(8)
Ve 15,183
Maav 24,240,96
Vc 91,14,15
v_or3_b32 v7, v7, v74, v75
Maav 24,244,100
v_or3_b32 v7, v7, v82, v83
v_or3_b32 v7, v7, v90, v91
Maav 56,240,104
global_load_dword v30, v[28:29], off
Maav 56,244,108
Maav 88,240,112
Maav 88,244,116
Maav 120,240,120
Maav 120,244,124
Maav 28,248,96
Maav 28,252,100
Maav 60,248,104
Maav 60,252,108
Maav 92,248,112
Maav 92,252,116
Maav 124,248,120
Maav 124,252,124
Mvvv 60,16,120
s_waitcnt lgkmcnt(4)
Mvvv 60,16,124
s_branch L_k2_wloop
L_k2_trans:
VE 8,200
Cvaa 128,192,128,32
s_add_u32 m0, s53, 32768
VE 9,201
Mvaa 128,196,132
buffer_load_dwordx4 v4, s[12:15], s38 offen offset:0 sc1 lds
Mvaa 128,200,136
Ra 224,3,8192
Vc 100,8,9
Mvaa 128,204,140
VE 10,202
Cvaa 144,192,144,36
VE 11,203
Mvaa 144,196,148
Ra 228,3,9216
Vc 101,10,11
Mvaa 144,200,152
Ra 232,3,10240
v_or3_b32 v7, v7, v100, v101
Mvaa 144,204,156
s_waitcnt lgkmcnt(3)
Ra 236,3,11264
Ra 240,3,12288
Cvaa 132,208,128,32
buffer_load_dwordx4 v4, s[12:15], s38 offen offset:1024 sc1 lds
Mvaa 132,212,132
Ve 12,216
Mvaa 132,216,136
VE 13,217
Mvaa 132,220,140
Ra 244,3,13312
Vc 108,12,13
Cvaa 148,208,144,36
VE 14,218
Mvaa 148,212,148
buffer_load_dwordx4 v4, s[12:15], s38 offen offset:2048 sc1 lds
Mvaa 148,216,152
VE 15,219
Mvaa 148,220,156
s_waitcnt lgkmcnt(2)
Ra 248,3,14336
Ra 252,3,15360
Cvaa 136,224,128,32
Ra 192,2,49152
Vc 109,14,15
Mvaa 136,228,132
Ra 196,2,50176
v_or3_b32 v7, v7, v108, v109
Mvaa 136,232,136
Ve 8,232
Mvaa 136,236,140
buffer_load_dwordx4 v4, s[12:15], s38 offen offset:3072 sc1 lds
Cvaa 152,224,144,36
VE 9,233
Mvaa 152,228,148
Ra 200,2,51200
Vc 116,8,9
Mvaa 152,232,152
VE 10,234
Mvaa 152,236,156
s_waitcnt lgkmcnt(3)
Ra 204,2,52224
Ra 208,2,53248
Cvaa 140,240,128,32
Ve 11,235
Mvaa 140,244,132
Ra 212,2,54272
Vc 117,10,11
Mvaa 140,248,136
Ra 216,2,55296
v_or3_b32 v7, v7, v116, v117
Mvaa 140,252,140
s_cmp_ge_u32 s37, s45
Ve 12,248
Cvaa 156,240,144,36
s_waitcnt vmcnt(12)
Ve 13,249
Mvaa 156,244,148
s_barrier
Ra 220,2,56320
Vc 124,12,13
Mvaa 156,248,152
s_waitcnt lgkmcnt(4)
Ve 14,250
Ve 15,251
Ve 8,204
Ve 9,205
Ve 10,206
Ve 11,207
Ve 12,220
Ve 13,221
Vc 125,14,15
Ve 14,222
Ve 15,223
Vc 102,8,9
Ve 8,236
Ve 9,237
Vc 103,10,11
Ve 10,238
Ve 11,239
Vc 110,12,13
Ve 12,252
Ve 13,253
Vc 111,14,15
Ve 14,254
Ve 15,255
Vc 118,8,9
Vc 119,10,11
Vc 126,12,13
Vc 127,14,15
v_or3_b32 v7, v7, v124, v125
v_or3_b32 v7, v7, v102, v103
v_or3_b32 v7, v7, v110, v111
v_or3_b32 v7, v7, v118, v119
v_or3_b32 v7, v7, v126, v127
v_and_b32 v1, 0x40004000, v7
v_cmp_ne_u32 vcc, 0, v1
Mvaa 156,252,156
s_cbranch_vccnz L_k2_fb_tr
L_k2_fbr_tr:
Maav 0,192,96
s_cbranch_scc1 L_k2_mk_tr
L_k2_mkr_tr:
Ve 8,128
Maav 0,196,100
s_add_u32 m0, s53, 16384
VE 9,129
Maav 32,192,104
buffer_load_dwordx4 v4, s[12:15], s39 offen offset:0 sc1 lds
Maav 32,196,108
s_add_u32 s37, s37, 1
Ra 224,2,57344
Vc 64,8,9
Maav 64,192,112
s_add_u32 s38, s38, 34816
Ve 10,130
Maav 64,196,116
s_xor_b32 s53, s53, 65536
VE 11,131
Maav 96,192,120
s_xor_b32 s54, s54, 65536
Ra 228,2,58368
Vc 65,10,11
Maav 96,196,124
Ra 232,2,59392
v_or_b32_e64 v7, v64, v65
Maav 4,200,96
VE 12,144
Maav 4,204,100
VE 13,145
Maav 36,200,104
Ra 236,2,60416
Vc 72,12,13
Maav 36,204,108
VE 14,146
Maav 68,200,112
VE 15,147
Maav 68,204,116
Ra 240,2,61440
Vc 73,14,15
Maav 100,200,120
Ra 244,2,62464
v_or3_b32 v7, v7, v72, v73
Maav 100,204,124
VE 8,132
Mvvv 48,16,96
VE 9,133
Mvvv 48,16,100
s_waitcnt lgkmcnt(6)
Ra 248,2,63488
Vc 66,8,9
Maav 8,208,96
Ve 10,134
Maav 8,212,100
buffer_load_dwordx4 v4, s[12:15], s39 offen offset:1024 sc1 lds
Maav 40,208,104
VE 11,135
Maav 40,212,108
Ra 252,2,64512
Vc 67,10,11
Maav 72,208,112
Ra 192,3,32768
v_or3_b32 v7, v7, v66, v67
Maav 72,212,116
VE 12,148
Maav 104,208,120
VE 13,149
Maav 104,212,124
Ra 196,3,33792
Vc 74,12,13
Maav 12,216,96
VE 14,150
Maav 12,220,100
VE 15,151
Maav 44,216,104
Ra 200,3,34816
Vc 75,14,15
Maav 44,220,108
Ra 204,3,35840
v_or3_b32 v7, v7, v74, v75
Maav 76,216,112
VE 8,136
Maav 76,220,116
Maav 108,216,120
Maav 108,220,124
Mvvv 52,16,104
Mvvv 52,16,108
s_waitcnt lgkmcnt(8)
Maav 16,224,96
buffer_load_dwordx4 v4, s[12:15], s39 offen offset:2048 sc1 lds
Maav 16,228,100
Ra 208,3,36864
Ra 212,3,37888
Maav 48,224,104
Ra 216,3,38912
Ra 220,3,39936
Maav 48,228,108
Maav 80,224,112
Maav 80,228,116
Maav 112,224,120
Maav 112,228,124
Maav 20,232,96
Maav 20,236,100
Maav 52,232,104
Maav 52,236,108
Maav 84,232,112
Maav 84,236,116
Maav 116,232,120
Maav 116,236,124
Mvvv 56,16,112
Mvvv 56,16,116
s_waitcnt lgkmcnt(8)
Maav 24,240,96
buffer_load_dwordx4 v4, s[12:15], s39 offen offset:3072 sc1 lds
Maav 24,244,100
s_add_u32 s39, s39, 34816
Maav 56,240,104
Maav 56,244,108
Maav 88,240,112
Maav 88,244,116
Maav 120,240,120
Maav 120,244,124
Maav 28,248,96
Maav 28,252,100
Maav 60,248,104
Maav 60,252,108
Maav 92,248,112
Maav 92,252,116
Maav 124,248,120
Maav 124,252,124
Mvvv 60,16,120
s_waitcnt lgkmcnt(4)
Mvvv 60,16,124
s_getpc_b64 s[56:57]
L_cpf4:
s_add_u32 s56, s56, (L_k2_fin-L_cpf4)&0xffffffff
s_addc_u32 s57, s57, ((L_k2_fin-L_cpf4)>>32)&0xffffffff
s_lshr_b32 s58, s2, 3
s_lshl_b32 s58, s58, 2
s_add_u32 s58, s58, s32
s_lshl_b32 s58, s58, 10
v_and_b32 v162, 7, v0
v_lshlrev_b32 v162, 7, v162
v_add_u32_e64 v162, s58, v162
v_min_u32 v162, L_k2_end-L_k2_fin-4, v162
v_mov_b32 v161, s57
v_add_co_u32 v160, vcc, s56, v162
s_nop 1
v_addc_co_u32 v161, vcc, 0, v161, vcc
global_load_dword v164, v[160:161], off
s_waitcnt vmcnt(9)
s_lshl_b32 s3, s34, 20
s_lshl_b32 s47, s33, 15
s_add_u32 s3, s3, s47
s_lshl_b32 s47, s32, 11
s_add_u32 s3, s3, s47
v_lshlrev_b32 v23, 4, v0
v_rcp_f32 v21, v56
v_rcp_f32_e64 v22, v60
Ar 240,64
Ar 241,65
Ar 242,66
Ar 243,67
Ar 244,68
Ar 245,69
Ar 246,70
Ar 247,71
Vm 240,240,21
Vm 241,241,21
Vm 242,242,21
Vm 243,243,21
Vm 244,244,21
Vm 245,245,21
Vm 246,246,21
Vm 247,247,21
Vc 24,240,241
Vc 25,242,243
Vc 26,244,245
Vc 27,246,247
buffer_store_dwordx4 v[24:27], v23, s[16:19], s3 offen offset:0 sc1
Ar 240,96
Ar 241,97
Ar 242,98
Ar 243,99
Ar 244,100
Ar 245,101
Ar 246,102
Ar 247,103
Vm 240,240,22
Vm 241,241,22
Vm 242,242,22
Vm 243,243,22
Vm 244,244,22
Vm 245,245,22
Vm 246,246,22
Vm 247,247,22
Vc 28,240,241
Vc 29,242,243
Vc 30,244,245
Vc 31,246,247
buffer_store_dwordx4 v[28:31], v23, s[16:19], s3 offen offset:1024 sc1
s_add_u32 s3, s3, 8192
Ar 240,72
Ar 241,73
Ar 242,74
Ar 243,75
Ar 244,76
Ar 245,77
Ar 246,78
Ar 247,79
Vm 240,240,21
Vm 241,241,21
Vm 242,242,21
Vm 243,243,21
Vm 244,244,21
Vm 245,245,21
Vm 246,246,21
Vm 247,247,21
Vc 24,240,241
Vc 25,242,243
Vc 26,244,245
Vc 27,246,247
buffer_store_dwordx4 v[24:27], v23, s[16:19], s3 offen offset:0 sc1
Ar 240,104
Ar 241,105
Ar 242,106
Ar 243,107
Ar 244,108
Ar 245,109
Ar 246,110
Ar 247,111
Vm 240,240,22
Vm 241,241,22
Vm 242,242,22
Vm 243,243,22
Vm 244,244,22
Vm 245,245,22
Vm 246,246,22
Vm 247,247,22
Vc 28,240,241
Vc 29,242,243
Vc 30,244,245
Vc 31,246,247
buffer_store_dwordx4 v[28:31], v23, s[16:19], s3 offen offset:1024 sc1
s_add_u32 s3, s3, 8192
Ar 240,80
Ar 241,81
Ar 242,82
Ar 243,83
Ar 244,84
Ar 245,85
Ar 246,86
Ar 247,87
Vm 240,240,21
Vm 241,241,21
Vm 242,242,21
Vm 243,243,21
Vm 244,244,21
Vm 245,245,21
Vm 246,246,21
Vm 247,247,21
Vc 24,240,241
Vc 25,242,243
Vc 26,244,245
Vc 27,246,247
buffer_store_dwordx4 v[24:27], v23, s[16:19], s3 offen offset:0 sc1
Ar 240,112
Ar 241,113
Ar 242,114
Ar 243,115
Ar 244,116
Ar 245,117
Ar 246,118
Ar 247,119
Vm 240,240,22
Vm 241,241,22
Vm 242,242,22
Vm 243,243,22
Vm 244,244,22
Vm 245,245,22
Vm 246,246,22
Vm 247,247,22
Vc 28,240,241
Vc 29,242,243
Vc 30,244,245
Vc 31,246,247
buffer_store_dwordx4 v[28:31], v23, s[16:19], s3 offen offset:1024 sc1
s_add_u32 s3, s3, 8192
Ar 240,88
Ar 241,89
Ar 242,90
Ar 243,91
Ar 244,92
Ar 245,93
Ar 246,94
Ar 247,95
Vm 240,240,21
Vm 241,241,21
Vm 242,242,21
Vm 243,243,21
Vm 244,244,21
Vm 245,245,21
Vm 246,246,21
Vm 247,247,21
Vc 24,240,241
Vc 25,242,243
Vc 26,244,245
Vc 27,246,247
buffer_store_dwordx4 v[24:27], v23, s[16:19], s3 offen offset:0 sc1
Ar 240,120
Ar 241,121
Ar 242,122
Ar 243,123
Ar 244,124
Ar 245,125
Ar 246,126
Ar 247,127
Vm 240,240,22
Vm 241,241,22
Vm 242,242,22
Vm 243,243,22
Vm 244,244,22
Vm 245,245,22
Vm 246,246,22
Vm 247,247,22
Vc 28,240,241
Vc 29,242,243
Vc 30,244,245
Vc 31,246,247
buffer_store_dwordx4 v[28:31], v23, s[16:19], s3 offen offset:1024 sc1
s_add_u32 s52, s37, 2
s_waitcnt vmcnt(8)
L_k2_nloop:
v_xor_b32 v2, 65536, v2
v_xor_b32 v3, 65536, v3
Cvaa 192,192,128,32
s_mov_b32 m0, s53
Ve 9,137
Mvaa 192,196,132
buffer_load_dwordx4 v4, s[12:15], s38 offen offset:0 sc1 lds
Mvaa 192,200,136
Ra 224,2,40960
Vc 68,8,9
Mvaa 192,204,140
VE 10,138
Cvaa 208,192,144,36
VE 11,139
Mvaa 208,196,148
Ra 228,2,41984
Vc 69,10,11
Mvaa 208,200,152
Ra 232,2,43008
v_or3_b32 v7, v7, v68, v69
Mvaa 208,204,156
s_waitcnt lgkmcnt(3)
Ra 236,2,44032
Ra 240,2,45056
Cvaa 196,208,128,32
buffer_load_dwordx4 v4, s[12:15], s38 offen offset:1024 sc1 lds
Mvaa 196,212,132
Ve 12,152
Mvaa 196,216,136
VE 13,153
Mvaa 196,220,140
Ra 244,2,46080
Vc 76,12,13
Cvaa 212,208,144,36
VE 14,154
Mvaa 212,212,148
buffer_load_dwordx4 v4, s[12:15], s38 offen offset:2048 sc1 lds
Mvaa 212,216,152
VE 15,155
Mvaa 212,220,156
s_waitcnt lgkmcnt(2)
Ra 248,2,47104
Ra 252,2,48128
Cvaa 200,224,128,32
Ra 192,2,16384
Vc 77,14,15
Mvaa 200,228,132
Ra 196,2,17408
v_or3_b32 v7, v7, v76, v77
Mvaa 200,232,136
Ve 8,140
Mvaa 200,236,140
buffer_load_dwordx4 v4, s[12:15], s38 offen offset:3072 sc1 lds
Cvaa 216,224,144,36
VE 9,141
Mvaa 216,228,148
Ra 200,2,18432
Vc 70,8,9
Mvaa 216,232,152
VE 10,142
Mvaa 216,236,156
s_waitcnt lgkmcnt(3)
Ra 204,2,19456
Ra 208,2,20480
Cvaa 204,240,128,32
Ve 11,143
Mvaa 204,244,132
s_cmp_lt_u32 s37, s52
Ra 212,2,21504
Vc 71,10,11
Mvaa 204,248,136
s_cbranch_scc1 L_nw_ne
s_waitcnt vmcnt(12)
L_nw_ne:
Ra 216,2,22528
v_or3_b32 v7, v7, v70, v71
Mvaa 204,252,140
s_cmp_ge_u32 s37, s45
VE 12,156
Cvaa 220,240,144,36
VE 13,157
Mvaa 220,244,148
s_barrier
Ra 220,2,23552
Vc 78,12,13
Mvaa 220,248,152
s_waitcnt lgkmcnt(4)
Ve 14,158
Ve 15,159
s_nop 0
Vc 79,14,15
v_or3_b32 v7, v7, v78, v79
v_and_b32 v1, 0x40004000, v7
v_cmp_ne_u32 vcc, 0, v1
Mvaa 220,252,156
s_cbranch_vccnz L_k2_fb_ne
L_k2_fbr_ne:
Maav 0,192,64
s_cbranch_scc1 L_k2_mk_ne
L_k2_mkr_ne:
VE 8,192
Maav 0,196,68
s_add_u32 m0, s54, 49152
VE 9,193
Maav 32,192,72
buffer_load_dwordx4 v4, s[12:15], s39 offen offset:0 sc1 lds
Maav 32,196,76
s_cmp_eq_u32 s37, s52
Ra 224,2,24576
Vc 96,8,9
Maav 4,200,64
s_cbranch_scc1 L_pubB
L_pubBr:
VE 10,194
Maav 4,204,68
s_add_u32 s37, s37, 1
Ve 11,195
Maav 36,200,72
s_add_u32 s38, s38, 34816
Ra 228,2,25600
Vc 97,10,11
Maav 36,204,76
Ra 232,2,26624
v_or_b32_e64 v7, v96, v97
Mvvv 48,16,64
VE 12,208
Mvvv 48,16,68
s_waitcnt lgkmcnt(3)
Ra 236,2,27648
Ra 240,2,28672
Maav 8,208,64
buffer_load_dwordx4 v4, s[12:15], s39 offen offset:1024 sc1 lds
Maav 8,212,68
Ve 13,209
Maav 40,208,72
Ra 244,2,29696
Vc 104,12,13
Maav 40,212,76
VE 14,210
Maav 12,216,64
VE 15,211
Maav 12,220,68
Ra 248,2,30720
Vc 105,14,15
Maav 44,216,72
Ra 252,2,31744
v_or3_b32 v7, v7, v104, v105
Maav 44,220,76
VE 8,196
Mvvv 52,16,72
buffer_load_dwordx4 v4, s[12:15], s39 offen offset:2048 sc1 lds
Mvvv 52,16,76
s_waitcnt lgkmcnt(4)
Ve 9,197
Maav 16,224,64
Ra 192,3,0
Vc 98,8,9
Maav 16,228,68
VE 10,198
Maav 48,224,72
VE 11,199
Maav 48,228,76
Ra 196,3,1024
Vc 99,10,11
Maav 20,232,64
Ra 200,3,2048
v_or3_b32 v7, v7, v98, v99
Maav 20,236,68
Ra 204,3,3072
Ra 208,3,4096
Maav 52,232,72
buffer_load_dwordx4 v4, s[12:15], s39 offen offset:3072 sc1 lds
Maav 52,236,76
s_waitcnt lgkmcnt(5)
Ve 12,212
Maav 24,240,64
s_add_u32 s39, s39, 34816
VE 13,213
Maav 24,244,68
Ra 212,3,5120
Vc 106,12,13
Maav 56,240,72
VE 14,214
Maav 56,244,76
VE 15,215
Maav 28,248,64
Ra 216,3,6144
Vc 107,14,15
Maav 28,252,68
s_cmp_eq_u32 s37, s36
Ra 220,3,7168
v_or3_b32 v7, v7, v106, v107
Maav 60,248,72
s_waitcnt lgkmcnt(4)
VE 8,200
Maav 60,252,76
s_cbranch_scc1 L_k2_fin
Ve 9,201
Cvaa 128,192,128,32
s_add_u32 m0, s53, 32768
Ra 224,3,8192
Vc 100,8,9
Mvaa 128,196,132
buffer_load_dwordx4 v4, s[12:15], s38 offen offset:0 sc1 lds
Mvaa 128,200,136
VE 10,202
Mvaa 128,204,140
VE 11,203
Cvaa 144,192,144,36
Ra 228,3,9216
Vc 101,10,11
Mvaa 144,196,148
Ra 232,3,10240
v_or3_b32 v7, v7, v100, v101
Mvaa 144,200,152
VE 12,216
Mvaa 144,204,156
s_waitcnt lgkmcnt(3)
Ra 236,3,11264
Ra 240,3,12288
Cvaa 132,208,128,32
buffer_load_dwordx4 v4, s[12:15], s38 offen offset:1024 sc1 lds
Mvaa 132,212,132
Ve 13,217
Mvaa 132,216,136
Ra 244,3,13312
Vc 108,12,13
Mvaa 132,220,140
VE 14,218
Cvaa 148,208,144,36
VE 15,219
Mvaa 148,212,148
buffer_load_dwordx4 v4, s[12:15], s38 offen offset:2048 sc1 lds
Mvaa 148,216,152
Ra 248,3,14336
Vc 109,14,15
Mvaa 148,220,156
s_waitcnt lgkmcnt(3)
Ra 252,3,15360
v_or3_b32 v7, v7, v108, v109
Cvaa 136,224,128,32
Ve 8,204
Mvaa 136,228,132
VE 9,205
Mvaa 136,232,136
Ra 192,2,49152
Vc 102,8,9
Mvaa 136,236,140
buffer_load_dwordx4 v4, s[12:15], s38 offen offset:3072 sc1 lds
Cvaa 152,224,144,36
VE 10,206
Mvaa 152,228,148
VE 11,207
Mvaa 152,232,152
Ra 196,2,50176
Vc 103,10,11
Mvaa 152,236,156
s_waitcnt lgkmcnt(2)
Ra 200,2,51200
Ra 204,2,52224
Cvaa 140,240,128,32
Ra 208,2,53248
v_or3_b32 v7, v7, v102, v103
Mvaa 140,244,132
s_cmp_lt_u32 s37, s52
VE 12,220
Mvaa 140,248,136
s_cbranch_scc1 L_nw_no
s_waitcnt vmcnt(12)
L_nw_no:
VE 13,221
Mvaa 140,252,140
s_cmp_ge_u32 s37, s45
Ra 212,2,54272
Vc 110,12,13
Cvaa 156,240,144,36
Ve 14,222
Mvaa 156,244,148
s_barrier
Ve 15,223
Mvaa 156,248,152
s_waitcnt lgkmcnt(2)
Ra 216,2,55296
Vc 111,14,15
v_or3_b32 v7, v7, v110, v111
v_and_b32 v1, 0x40004000, v7
v_cmp_ne_u32 vcc, 0, v1
Mvaa 156,252,156
s_cbranch_vccnz L_k2_fb_no
L_k2_fbr_no:
Ra 220,2,56320
Maav 0,192,96
s_cbranch_scc1 L_k2_mk_no
L_k2_mkr_no:
VE 8,128
Maav 0,196,100
s_add_u32 m0, s53, 16384
VE 9,129
Maav 32,192,104
buffer_load_dwordx4 v4, s[12:15], s39 offen offset:0 sc1 lds
Maav 32,196,108
s_add_u32 s37, s37, 1
Ra 224,2,57344
Vc 64,8,9
Maav 4,200,96
s_add_u32 s38, s38, 34816
Ve 10,130
Maav 4,204,100
s_xor_b32 s53, s53, 65536
VE 11,131
Maav 36,200,104
s_xor_b32 s54, s54, 65536
Ra 228,2,58368
Vc 65,10,11
Maav 36,204,108
Ra 232,2,59392
v_or_b32_e64 v7, v64, v65
Mvvv 48,16,96
VE 12,144
Mvvv 48,16,100
s_waitcnt lgkmcnt(3)
Ra 236,2,60416
Ra 240,2,61440
Maav 8,208,96
buffer_load_dwordx4 v4, s[12:15], s39 offen offset:1024 sc1 lds
Maav 8,212,100
Ve 13,145
Maav 40,208,104
Ra 244,2,62464
Vc 72,12,13
Maav 40,212,108
VE 14,146
Maav 12,216,96
VE 15,147
Maav 12,220,100
Ra 248,2,63488
Vc 73,14,15
Maav 44,216,104
Ra 252,2,64512
v_or3_b32 v7, v7, v72, v73
Maav 44,220,108
VE 8,132
Mvvv 52,16,104
buffer_load_dwordx4 v4, s[12:15], s39 offen offset:2048 sc1 lds
Mvvv 52,16,108
s_waitcnt lgkmcnt(4)
Ve 9,133
Maav 16,224,96
Ra 192,3,32768
Vc 66,8,9
Maav 16,228,100
VE 10,134
Maav 48,224,104
VE 11,135
Maav 48,228,108
Ra 196,3,33792
Vc 67,10,11
Maav 20,232,96
Ra 200,3,34816
v_or3_b32 v7, v7, v66, v67
Maav 20,236,100
Ra 204,3,35840
Ra 208,3,36864
Maav 52,232,104
buffer_load_dwordx4 v4, s[12:15], s39 offen offset:3072 sc1 lds
Maav 52,236,108
s_waitcnt lgkmcnt(5)
Ve 12,148
Maav 24,240,96
s_add_u32 s39, s39, 34816
VE 13,149
Maav 24,244,100
Ra 212,3,37888
Vc 74,12,13
Maav 56,240,104
VE 14,150
Maav 56,244,108
VE 15,151
Maav 28,248,96
Ra 216,3,38912
Vc 75,14,15
Maav 28,252,100
Ra 220,3,39936
v_or3_b32 v7, v7, v74, v75
Maav 60,248,104
s_waitcnt lgkmcnt(4)
Ve 8,136
Maav 60,252,108
s_branch L_k2_nloop
L_k2_fin:
s_load_dwordx2 s[94:95], s[0:1], 40
s_load_dwordx2 s[40:41], s[0:1], 0
s_load_dwordx4 s[8:11], s[0:1], 80
s_waitcnt lgkmcnt(0)
Ra 192,2,49152
Ra 196,2,50176
Ra 200,2,51200
Ra 204,2,52224
Ra 208,2,53248
Ra 212,2,54272
Ra 216,2,55296
Ra 220,2,56320
s_lshr_b32 s3, s42, 4
s_mul_i32 s3, s3, 33792
s_and_b32 s47, s42, 15
s_lshl_b32 s47, s47, 4
s_add_u32 s3, s3, s47
v_mov_b32 v28, s3
s_lshr_b32 s3, s43, 4
s_mul_i32 s3, s3, 33792
s_and_b32 s47, s43, 15
s_lshl_b32 s47, s47, 4
s_add_u32 s3, s3, s47
v_mov_b32 v29, s3
v_lshrrev_b32 v24, 4, v0
v_and_b32 v25, 15, v0
v_cmp_eq_u32 vcc, 1, v25
s_lshl_b32 s3, s32, 4
v_add_u32 v26, s3, v24
v_cndmask_b32 v28, v28, v29, vcc
v_lshl_add_u32 v28, v24, 8, v28
v_mul_u32_u24 v26, 7168, v26
v_lshlrev_b32 v24, 1, v24
v_xor_b32 v24, v24, v25
v_xor_b32_e64 v25, 8, v24
v_lshl_add_u32 v24, v24, 4, v26
v_lshl_add_u32 v25, v25, 4, v26
s_lshl_b32 s3, s92, 12
buffer_load_dwordx4 a[160:163], v28, s[20:23], s3 offen offset:0 sc1
buffer_load_dwordx4 a[164:167], v28, s[20:23], s3 offen offset:1024 sc1
buffer_load_dwordx4 a[168:171], v28, s[20:23], s3 offen offset:2048 sc1
buffer_load_dwordx4 a[172:175], v28, s[20:23], s3 offen offset:3072 sc1
s_add_u32 m0, s54, 0
s_add_u32 s3, s5, 0
buffer_load_dwordx4 v24, s[24:27], s3 offen offset:0 lds
Ve 9,201
VE 10,202
s_add_u32 s3, s5, 27648
buffer_load_dwordx4 v24, s[24:27], s3 offen offset:1024 lds
Ve 11,203
Ve 12,216
s_add_u32 s3, s5, 55296
buffer_load_dwordx4 v25, s[24:27], s3 offen offset:2048 lds
Ve 13,217
Ve 14,218
s_add_u32 s3, s5, 82944
buffer_load_dwordx4 v25, s[24:27], s3 offen offset:3072 lds
VE 15,219
Vc 100,8,9
s_add_u32 m0, s54, 16384
s_add_u32 s3, s5, 458752
buffer_load_dwordx4 v24, s[24:27], s3 offen offset:0 lds
Ve 8,204
Ve 9,205
s_add_u32 s3, s5, 486400
buffer_load_dwordx4 v24, s[24:27], s3 offen offset:1024 lds
Vc 101,10,11
VE 10,206
s_add_u32 s3, s5, 514048
buffer_load_dwordx4 v25, s[24:27], s3 offen offset:2048 lds
VE 11,207
Vc 108,12,13
s_add_u32 s3, s5, 541696
buffer_load_dwordx4 v25, s[24:27], s3 offen offset:3072 lds
Ve 12,220
Ve 13,221
s_add_u32 m0, s54, 32768
s_add_u32 s3, s5, 0
buffer_load_dwordx4 v24, s[68:71], s3 offen offset:0 lds
Vc 109,14,15
Ve 14,222
s_add_u32 s3, s5, 27648
buffer_load_dwordx4 v24, s[68:71], s3 offen offset:1024 lds
VE 15,223
Vc 102,8,9
s_add_u32 s3, s5, 55296
buffer_load_dwordx4 v25, s[68:71], s3 offen offset:2048 lds
Vc 103,10,11
Vc 110,12,13
s_add_u32 s3, s5, 82944
buffer_load_dwordx4 v25, s[68:71], s3 offen offset:3072 lds
Vc 111,14,15
v_or3_b32 v7, v7, v100, v101
s_add_u32 m0, s54, 49152
s_add_u32 s3, s5, 458752
buffer_load_dwordx4 v24, s[68:71], s3 offen offset:0 lds
v_or3_b32 v7, v7, v108, v109
v_or3_b32 v7, v7, v102, v103
s_add_u32 s3, s5, 486400
buffer_load_dwordx4 v24, s[68:71], s3 offen offset:1024 lds
v_or3_b32 v7, v7, v110, v111
v_and_b32 v1, 0x40004000, v7
s_add_u32 s3, s5, 514048
buffer_load_dwordx4 v25, s[68:71], s3 offen offset:2048 lds
v_cmp_ne_u32 vcc, 0, v1
s_add_u32 s3, s5, 541696
buffer_load_dwordx4 v25, s[68:71], s3 offen offset:3072 lds
s_waitcnt lgkmcnt(4)
s_cbranch_vccnz L_k2_fb_fi
L_k2_fbr_fi:
Maav 0,192,96
Ra 224,2,57344
Ra 228,2,58368
Maav 0,196,100
Ra 232,2,59392
Ra 236,2,60416
Maav 32,192,104
Ra 240,2,61440
Ra 244,2,62464
Maav 32,196,108
Ra 248,2,63488
Ra 252,2,64512
Maav 4,200,96
s_mov_b32 s60, s8
s_and_b32 s61, s9, 0xffff
s_mov_b32 s62, 7340032
Maav 4,204,100
s_mov_b32 s63, 0x20000
s_mov_b32 s68, s10
s_and_b32 s69, s11, 0xffff
Maav 36,200,104
s_mov_b32 s70, 4194304
s_mov_b32 s71, 0x20000
s_mov_b32 s56, s40
Maav 36,204,108
s_and_b32 s57, s41, 0xffff
s_mov_b32 s58, 4194304
s_mov_b32 s59, 0x20000
Mvvv 48,16,96
s_bfe_u32 s6, s2, 0x20001
s_lshr_b32 s7, s34, 1
s_lshl_b32 s45, s7, 2
Mvvv 48,16,100
s_waitcnt lgkmcnt(8)
Maav 8,208,96
s_add_u32 s46, s45, s6
s_sub_u32 s46, 15, s46
s_sub_u32 s45, 12, s45
Maav 8,212,100
s_add_u32 s45, s45, s6
s_cmp_lt_u32 s7, 2
s_cselect_b32 s45, s46, s45
Maav 40,208,104
s_and_b32 s46, s2, 1
s_lshl_b32 s46, s46, 3
s_bfe_u32 s6, s2, 0x30003
Maav 40,212,108
s_add_u32 s46, s46, s6
s_mov_b32 s48, 0
s_mov_b32 s49, 15360
Maav 12,216,96
s_mov_b32 s50, 30720
s_mov_b32 s51, 46080
s_lshl_b32 s35, s32, 15
Maav 12,220,100
s_lshl_b32 s6, s45, 20
s_lshl_b32 s7, s32, 18
s_add_u32 s6, s6, s7
Maav 44,216,104
s_add_u32 s6, s6, 46137344
s_add_u32 s8, s66, s6
s_addc_u32 s9, s67, 0
s_and_b32 s9, s9, 0xffff
Maav 44,220,108
s_mov_b32 s10, 262144
s_mov_b32 s11, 0x20000
s_lshl_b32 s7, s46, 7
Mvvv 52,16,104
s_lshl_b32 s6, s32, 21
s_add_u32 s6, s6, s7
s_add_u32 s12, s94, s6
s_addc_u32 s13, s95, 0
s_and_b32 s13, s13, 0xffff
Mvvv 52,16,108
s_waitcnt lgkmcnt(4)
Maav 16,224,96
s_mov_b32 s14, 0
s_mov_b32 s15, 0x20000
s_sub_u32 s14, 2097152, s7
Maav 16,228,100
s_lshl_b32 s36, s45, 18
s_add_u32 s36, s36, s7
s_mov_b32 s52, 0
Maav 48,224,104
s_lshl_b32 s38, s45, 7
s_lshl_b32 s6, s32, 5
s_add_u32 s38, s38, s6
Maav 48,228,108
s_add_u32 s38, s38, 5300224
v_lshlrev_b32_e64 v112, 4, v0
v_add_u32 v113, 4096, v112
v_lshrrev_b32_e64 v121, 4, v0
Maav 20,232,96
v_and_b32 v122, 7, v0
v_lshrrev_b32 v123, 3, v0
v_lshlrev_b32_e64 v124, 1, v121
Maav 20,236,100
v_xor_b32 v124, v124, v122
v_lshlrev_b32 v124, 4, v124
v_lshl_add_u32 v114, v123, 11, v124
Maav 52,232,104
v_lshrrev_b32_e64 v124, 2, v0
v_bfe_u32 v126, v0, 3, 2
v_lshlrev_b32_e64 v124, 7, v124
Maav 52,236,108
s_waitcnt lgkmcnt(0)
Maav 24,240,96
v_and_b32 v125, 3, v0
v_lshl_add_u32 v124, v125, 3, v124
v_add_u32_e64 v124, s35, v124
Maav 24,244,100
v_xor_b32_e64 v125, 0, v126
v_lshl_add_u32 v115, v125, 5, v124
v_xor_b32_e64 v125, 1, v126
Maav 56,240,104
v_lshl_add_u32 v116, v125, 5, v124
v_xor_b32_e64 v125, 2, v126
v_lshl_add_u32 v117, v125, 5, v124
Maav 56,244,108
v_xor_b32_e64 v125, 3, v126
v_lshl_add_u32 v118, v125, 5, v124
Maav 28,248,96
s_lshl_b32 s6, s32, 3
v_add_u32 v120, s6, v123
v_lshlrev_b32_e64 v119, 11, v120
v_lshl_add_u32 v119, v122, 4, v119
Maav 28,252,100
v_mov_b32 v126, 0
v_lshlrev_b32 v127, 2, v122
Maav 60,248,104
Maav 60,252,108
s_nop 7
s_lshl_b32 s3, s55, 20
s_lshl_b32 s47, s33, 15
s_add_u32 s3, s3, s47
s_lshl_b32 s47, s32, 11
s_add_u32 s3, s3, s47
v_lshlrev_b32 v23, 4, v0
v_rcp_f32 v21, v48
v_rcp_f32_e64 v22, v52
Ar 240,0
Ar 241,1
Ar 242,2
Ar 243,3
Ar 244,4
Ar 245,5
Ar 246,6
Ar 247,7
Vm 240,240,21
Vm 241,241,21
Vm 242,242,21
Vm 243,243,21
Vm 244,244,21
Vm 245,245,21
Vm 246,246,21
Vm 247,247,21
Vc 24,240,241
Vc 25,242,243
Vc 26,244,245
Vc 27,246,247
buffer_store_dwordx4 v[24:27], v23, s[16:19], s3 offen offset:0 sc1
Ar 240,32
Ar 241,33
Ar 242,34
Ar 243,35
Ar 244,36
Ar 245,37
Ar 246,38
Ar 247,39
Vm 240,240,22
Vm 241,241,22
Vm 242,242,22
Vm 243,243,22
Vm 244,244,22
Vm 245,245,22
Vm 246,246,22
Vm 247,247,22
Vc 28,240,241
Vc 29,242,243
Vc 30,244,245
Vc 31,246,247
buffer_store_dwordx4 v[28:31], v23, s[16:19], s3 offen offset:1024 sc1
s_add_u32 s3, s3, 8192
Ar 240,8
Ar 241,9
Ar 242,10
Ar 243,11
Ar 244,12
Ar 245,13
Ar 246,14
Ar 247,15
Vm 240,240,21
Vm 241,241,21
Vm 242,242,21
Vm 243,243,21
Vm 244,244,21
Vm 245,245,21
Vm 246,246,21
Vm 247,247,21
Vc 24,240,241
Vc 25,242,243
Vc 26,244,245
Vc 27,246,247
buffer_store_dwordx4 v[24:27], v23, s[16:19], s3 offen offset:0 sc1
Ar 240,40
Ar 241,41
Ar 242,42
Ar 243,43
Ar 244,44
Ar 245,45
Ar 246,46
Ar 247,47
Vm 240,240,22
Vm 241,241,22
Vm 242,242,22
Vm 243,243,22
Vm 244,244,22
Vm 245,245,22
Vm 246,246,22
Vm 247,247,22
Vc 28,240,241
Vc 29,242,243
Vc 30,244,245
Vc 31,246,247
buffer_store_dwordx4 v[28:31], v23, s[16:19], s3 offen offset:1024 sc1
s_add_u32 s3, s3, 8192
Ar 240,16
Ar 241,17
Ar 242,18
Ar 243,19
Ar 244,20
Ar 245,21
Ar 246,22
Ar 247,23
Vm 240,240,21
Vm 241,241,21
Vm 242,242,21
Vm 243,243,21
Vm 244,244,21
Vm 245,245,21
Vm 246,246,21
Vm 247,247,21
Vc 24,240,241
Vc 25,242,243
Vc 26,244,245
Vc 27,246,247
buffer_store_dwordx4 v[24:27], v23, s[16:19], s3 offen offset:0 sc1
Ar 240,48
Ar 241,49
Ar 242,50
Ar 243,51
Ar 244,52
Ar 245,53
Ar 246,54
Ar 247,55
Vm 240,240,22
Vm 241,241,22
Vm 242,242,22
Vm 243,243,22
Vm 244,244,22
Vm 245,245,22
Vm 246,246,22
Vm 247,247,22
Vc 28,240,241
Vc 29,242,243
Vc 30,244,245
Vc 31,246,247
buffer_store_dwordx4 v[28:31], v23, s[16:19], s3 offen offset:1024 sc1
s_add_u32 s3, s3, 8192
Ar 240,24
Ar 241,25
Ar 242,26
Ar 243,27
Ar 244,28
Ar 245,29
Ar 246,30
Ar 247,31
Vm 240,240,21
Vm 241,241,21
Vm 242,242,21
Vm 243,243,21
Vm 244,244,21
Vm 245,245,21
Vm 246,246,21
Vm 247,247,21
Vc 24,240,241
Vc 25,242,243
Vc 26,244,245
Vc 27,246,247
buffer_store_dwordx4 v[24:27], v23, s[16:19], s3 offen offset:0 sc1
Ar 240,56
Ar 241,57
Ar 242,58
Ar 243,59
Ar 244,60
Ar 245,61
Ar 246,62
Ar 247,63
Vm 240,240,22
Vm 241,241,22
Vm 242,242,22
Vm 243,243,22
Vm 244,244,22
Vm 245,245,22
Vm 246,246,22
Vm 247,247,22
Vc 28,240,241
Vc 29,242,243
Vc 30,244,245
Vc 31,246,247
buffer_store_dwordx4 v[28:31], v23, s[16:19], s3 offen offset:1024 sc1
v_lshrrev_b32_e64 v24, 4, v0
v_bfe_u32 v25, v0, 2, 2
v_lshl_add_u32 v26, v24, 3, v25
v_lshlrev_b32 v26, 8, v26
v_and_b32 v27, 3, v0
v_lshl_add_u32 v26, v27, 3, v26
v_and_b32_e64 v27, 1, v24
v_lshl_add_u32 v25, v27, 2, v25
s_lshl_b32 s3, s32, 1
v_xor_b32 v25, s3, v25
v_lshl_add_u32 v26, v25, 5, v26
s_sub_u32 s3, s54, s44
v_add_u32 v26, s3, v26
v_xor_b32 v27, 32, v26
s_waitcnt vmcnt(8) lgkmcnt(0)
s_barrier
s_nop 0
ds_read_b64_tr_b16 v[128:129], v26 offset:0
ds_read_b64_tr_b16 v[130:131], v26 offset:1024
ds_read_b64_tr_b16 v[132:133], v27 offset:0
ds_read_b64_tr_b16 v[134:135], v27 offset:1024
ds_read_b64_tr_b16 v[136:137], v26 offset:8192
ds_read_b64_tr_b16 v[138:139], v26 offset:9216
ds_read_b64_tr_b16 v[140:141], v27 offset:8192
ds_read_b64_tr_b16 v[142:143], v27 offset:9216
ds_read_b64_tr_b16 v[144:145], v26 offset:16384
ds_read_b64_tr_b16 v[146:147], v26 offset:17408
ds_read_b64_tr_b16 v[148:149], v27 offset:16384
ds_read_b64_tr_b16 v[150:151], v27 offset:17408
ds_read_b64_tr_b16 v[152:153], v26 offset:24576
ds_read_b64_tr_b16 v[154:155], v26 offset:25600
ds_read_b64_tr_b16 v[156:157], v27 offset:24576
s_waitcnt lgkmcnt(9)
s_nop 0
ds_read_b64_tr_b16 v[158:159], v27 offset:25600
ds_read_b64_tr_b16 v[160:161], v26 offset:32768
ds_read_b64_tr_b16 v[162:163], v26 offset:33792
ds_read_b64_tr_b16 v[164:165], v27 offset:32768
ds_read_b64_tr_b16 v[166:167], v27 offset:33792
ds_read_b64_tr_b16 v[168:169], v26 offset:40960
s_waitcnt lgkmcnt(9)
s_nop 0
ds_read_b64_tr_b16 v[170:171], v26 offset:41984
ds_read_b64_tr_b16 v[172:173], v27 offset:40960
ds_read_b64_tr_b16 v[174:175], v27 offset:41984
ds_read_b64_tr_b16 v[176:177], v26 offset:49152
ds_read_b64_tr_b16 v[178:179], v26 offset:50176
ds_read_b64_tr_b16 v[180:181], v27 offset:49152
s_waitcnt lgkmcnt(9)
ds_read_b64_tr_b16 v[182:183], v27 offset:50176
ds_read_b64_tr_b16 v[184:185], v26 offset:57344
ds_read_b64_tr_b16 v[186:187], v26 offset:58368
ds_read_b64_tr_b16 v[188:189], v27 offset:57344
ds_read_b64_tr_b16 v[190:191], v27 offset:58368
v_and_b32 v25, 15, v0
v_mul_u32_u24 v28, 14336, v25
v_lshl_add_u32 v28, v24, 4, v28
v_mov_b32 v29, 2146435072
v_cmp_gt_u32 vcc, 2, v25
s_mul_i32 s3, s92, 57344
s_lshl_b32 s47, s4, 9
s_add_u32 s3, s3, s47
v_cndmask_b32 v28, v29, v28, vcc
s_lshl_b32 s47, s32, 7
s_add_u32 s3, s3, s47
s_add_u32 s3, s3, 6291456
Zvva 224,128,160
Zvva 228,132,160
Mvva 224,136,164
Mvva 228,140,164
Mvva 224,144,168
Mvva 228,148,168
Mvva 224,152,172
Mvva 228,156,172
s_waitcnt lgkmcnt(0)
Zvva 232,160,160
Zvva 236,164,160
Mvva 232,168,164
Mvva 236,172,164
Mvva 232,176,168
Mvva 236,180,168
Mvva 232,184,172
Mvva 236,188,172
v_mov_b32 v24, 1
v_mul_u32_u24 v25, s65, v0
s_waitcnt vmcnt(0)
s_barrier
s_mov_b64 exec, 3
buffer_store_dword v24, v25, s[20:23], s64 offen sc1
s_mov_b64 exec, -1
s_cmp_lg_u32 s34, 0
s_cselect_b32 s3, s3, 8388608
s_add_u32 s7, s3, 28672
buffer_store_dwordx4 v[224:227], v28, s[20:23], s3 offen offset:0 sc1
buffer_store_dwordx4 v[228:231], v28, s[20:23], s3 offen offset:64 sc1
buffer_store_dwordx4 v[232:235], v28, s[20:23], s7 offen offset:0 sc1
buffer_store_dwordx4 v[236:239], v28, s[20:23], s7 offen offset:64 sc1
buffer_load_dword v124, v127, s[20:23], s38 offen sc1
s_add_u32 m0, s35, 0
s_nop 0
buffer_load_dwordx4 v114, s[12:15], s48 offen offset:0 lds
buffer_load_dwordx4 v114, s[12:15], s49 offen offset:1024 lds
buffer_load_dwordx4 v114, s[12:15], s50 offen offset:2048 lds
buffer_load_dwordx4 v114, s[12:15], s51 offen offset:3072 lds
v_add_u32 v114, 65536, v114
s_add_u32 m0, s35, 4096
s_nop 0
s_nop 0
buffer_load_dwordx4 v114, s[12:15], s48 offen offset:0 lds
buffer_load_dwordx4 v114, s[12:15], s49 offen offset:1024 lds
buffer_load_dwordx4 v114, s[12:15], s50 offen offset:2048 lds
buffer_load_dwordx4 v114, s[12:15], s51 offen offset:3072 lds
v_add_u32 v114, 65536, v114
s_add_u32 m0, s35, 8192
s_nop 0
s_nop 0
buffer_load_dwordx4 v114, s[12:15], s48 offen offset:0 lds
buffer_load_dwordx4 v114, s[12:15], s49 offen offset:1024 lds
buffer_load_dwordx4 v114, s[12:15], s50 offen offset:2048 lds
buffer_load_dwordx4 v114, s[12:15], s51 offen offset:3072 lds
v_add_u32 v114, 65536, v114
s_add_u32 m0, s35, 12288
s_nop 0
buffer_load_dwordx4 v114, s[12:15], s48 offen offset:0 lds
buffer_load_dwordx4 v114, s[12:15], s49 offen offset:1024 lds
buffer_load_dwordx4 v114, s[12:15], s50 offen offset:2048 lds
buffer_load_dwordx4 v114, s[12:15], s51 offen offset:3072 lds
v_add_u32 v114, 65536, v114
s_waitcnt vmcnt(16)
v_cmp_ne_u32 vcc, 1, v124
s_cbranch_vccnz L_spinC
L_spinCr:
buffer_load_dwordx4 a[0:3], v112, s[8:11], s52 offen offset:0 sc1
buffer_load_dwordx4 a[4:7], v112, s[8:11], s52 offen offset:1024 sc1
buffer_load_dwordx4 a[8:11], v112, s[8:11], s52 offen offset:2048 sc1
buffer_load_dwordx4 a[12:15], v112, s[8:11], s52 offen offset:3072 sc1
buffer_load_dwordx4 a[16:19], v113, s[8:11], s52 offen offset:0 sc1
buffer_load_dwordx4 a[20:23], v113, s[8:11], s52 offen offset:1024 sc1
buffer_load_dwordx4 a[24:27], v113, s[8:11], s52 offen offset:2048 sc1
buffer_load_dwordx4 a[28:31], v113, s[8:11], s52 offen offset:3072 sc1
s_add_u32 s52, s52, 8192
buffer_load_dwordx4 a[32:35], v112, s[8:11], s52 offen offset:0 sc1
buffer_load_dwordx4 a[36:39], v112, s[8:11], s52 offen offset:1024 sc1
buffer_load_dwordx4 a[40:43], v112, s[8:11], s52 offen offset:2048 sc1
buffer_load_dwordx4 a[44:47], v112, s[8:11], s52 offen offset:3072 sc1
buffer_load_dwordx4 a[48:51], v113, s[8:11], s52 offen offset:0 sc1
buffer_load_dwordx4 a[52:55], v113, s[8:11], s52 offen offset:1024 sc1
buffer_load_dwordx4 a[56:59], v113, s[8:11], s52 offen offset:2048 sc1
buffer_load_dwordx4 a[60:63], v113, s[8:11], s52 offen offset:3072 sc1
s_add_u32 s52, s52, 8192
buffer_load_dwordx4 a[64:67], v112, s[8:11], s52 offen offset:0 sc1
buffer_load_dwordx4 a[68:71], v112, s[8:11], s52 offen offset:1024 sc1
buffer_load_dwordx4 a[72:75], v112, s[8:11], s52 offen offset:2048 sc1
buffer_load_dwordx4 a[76:79], v112, s[8:11], s52 offen offset:3072 sc1
buffer_load_dwordx4 a[80:83], v113, s[8:11], s52 offen offset:0 sc1
buffer_load_dwordx4 a[84:87], v113, s[8:11], s52 offen offset:1024 sc1
buffer_load_dwordx4 a[88:91], v113, s[8:11], s52 offen offset:2048 sc1
buffer_load_dwordx4 a[92:95], v113, s[8:11], s52 offen offset:3072 sc1
s_add_u32 s52, s52, 8192
s_waitcnt vmcnt(36)
s_nop 0
Ta 128,115,0
Ta 130,115,2048
Ta 132,116,0
Ta 134,116,2048
Ta 136,117,0
Ta 138,117,2048
Ta 140,118,0
Ta 142,118,2048
s_waitcnt vmcnt(16) lgkmcnt(0)
Zvaa 128,128,0
s_add_u32 m0, s35, 0
Zvaa 132,132,0
buffer_load_dwordx4 v114, s[12:15], s48 offen offset:0 lds
Zvaa 136,136,0
Ta 144,115,4096
Ta 146,115,6144
Zvaa 140,140,0
buffer_load_dwordx4 v114, s[12:15], s49 offen offset:1024 lds
Zvaa 144,128,4
v_mov_b32_e64 v125, 1
Zvaa 148,132,4
s_cmp_eq_u32 s32, 0
s_cselect_b32 s6, 128, s64
s_cmp_lg_u32 s34, 0
s_cselect_b32 s6, s6, 2146435072
Zvaa 152,136,4
buffer_load_dwordx4 v114, s[12:15], s50 offen offset:2048 lds
Zvaa 156,140,4
Ta 148,116,4096
Ta 150,116,6144
Zvaa 160,128,8
buffer_load_dwordx4 v114, s[12:15], s51 offen offset:3072 lds
Zvaa 164,132,8
v_add_u32 v114, 65536, v114
Zvaa 168,136,8
s_barrier
s_mov_b64 exec, 1
buffer_atomic_add v125, v126, s[28:31], s6 offen sc1
s_mov_b64 exec, -1
Zvaa 172,140,8
buffer_load_dwordx4 a[96:99], v112, s[8:11], s52 offen offset:0 sc1
Zvaa 176,128,12
Ta 152,117,4096
Ta 154,117,6144
Zvaa 180,132,12
buffer_load_dwordx4 a[100:103], v112, s[8:11], s52 offen offset:1024 sc1
Zvaa 184,136,12
Zvaa 188,140,12
Zvaa 192,128,16
buffer_load_dwordx4 a[104:107], v112, s[8:11], s52 offen offset:2048 sc1
Zvaa 196,132,16
Ta 156,118,4096
Ta 158,118,6144
Zvaa 200,136,16
buffer_load_dwordx4 a[108:111], v112, s[8:11], s52 offen offset:3072 sc1
Zvaa 204,140,16
Zvaa 208,128,20
Zvaa 212,132,20
buffer_load_dwordx4 a[112:115], v113, s[8:11], s52 offen offset:0 sc1
Zvaa 216,136,20
Zvaa 220,140,20
buffer_load_dwordx4 a[116:119], v113, s[8:11], s52 offen offset:1024 sc1
Zvaa 224,128,24
Zvaa 228,132,24
Zvaa 232,136,24
buffer_load_dwordx4 a[120:123], v113, s[8:11], s52 offen offset:2048 sc1
Zvaa 236,140,24
Zvaa 240,128,28
buffer_load_dwordx4 a[124:127], v113, s[8:11], s52 offen offset:3072 sc1
Zvaa 244,132,28
s_add_u32 s52, s52, 8192
Zvaa 248,136,28
Zvaa 252,140,28
s_waitcnt vmcnt(21) lgkmcnt(0)
Mvaa 128,144,32
s_add_u32 m0, s35, 4096
Mvaa 132,148,32
buffer_load_dwordx4 v114, s[12:15], s48 offen offset:0 lds
Mvaa 136,152,32
Ta 128,115,8192
Ta 130,115,10240
Mvaa 140,156,32
buffer_load_dwordx4 v114, s[12:15], s49 offen offset:1024 lds
Mvaa 144,144,36
s_mov_b32 s3, s36
Mvaa 148,148,36
buffer_load_dwordx4 v[18:21], v119, s[56:59], s3 offen
Mvaa 152,152,36
buffer_load_dwordx4 v114, s[12:15], s50 offen offset:2048 lds
Mvaa 156,156,36
Ta 132,116,8192
Ta 134,116,10240
Mvaa 160,144,40
buffer_load_dwordx4 v114, s[12:15], s51 offen offset:3072 lds
Mvaa 164,148,40
v_add_u32 v114, 65536, v114
Mvaa 168,152,40
s_add_u32 s3, s3, 65536
Mvaa 172,156,40
buffer_load_dwordx4 a[0:3], v112, s[8:11], s52 offen offset:0 sc1
Mvaa 176,144,44
Ta 136,117,8192
Ta 138,117,10240
Mvaa 180,148,44
buffer_load_dwordx4 a[4:7], v112, s[8:11], s52 offen offset:1024 sc1
Mvaa 184,152,44
buffer_load_dwordx4 v[22:25], v119, s[56:59], s3 offen
Mvaa 188,156,44
s_add_u32 s3, s3, 65536
Mvaa 192,144,48
buffer_load_dwordx4 a[8:11], v112, s[8:11], s52 offen offset:2048 sc1
Mvaa 196,148,48
Ta 140,118,8192
Ta 142,118,10240
Mvaa 200,152,48
buffer_load_dwordx4 a[12:15], v112, s[8:11], s52 offen offset:3072 sc1
Mvaa 204,156,48
buffer_load_dwordx4 v[26:29], v119, s[56:59], s3 offen
Mvaa 208,144,52
s_add_u32 s3, s3, 65536
Mvaa 212,148,52
buffer_load_dwordx4 a[16:19], v113, s[8:11], s52 offen offset:0 sc1
Mvaa 216,152,52
buffer_load_dwordx4 v[30:33], v119, s[56:59], s3 offen
Mvaa 220,156,52
buffer_load_dwordx4 a[20:23], v113, s[8:11], s52 offen offset:1024 sc1
Mvaa 224,144,56
s_lshl_b32 s3, s45, 10
s_add_u32 s3, s3, 5259264
v_lshlrev_b32_e64 v124, 3, v120
Mvaa 228,148,56
buffer_load_dwordx2 v[34:35], v124, s[20:23], s3 offen offset:0 sc1
Mvaa 232,152,56
buffer_load_dwordx4 a[24:27], v113, s[8:11], s52 offen offset:2048 sc1
Mvaa 236,156,56
buffer_load_dwordx2 v[36:37], v124, s[20:23], s3 offen offset:256 sc1
Mvaa 240,144,60
buffer_load_dwordx4 a[28:31], v113, s[8:11], s52 offen offset:3072 sc1
Mvaa 244,148,60
s_add_u32 s52, s52, 8192
Mvaa 248,152,60
buffer_load_dwordx2 v[38:39], v124, s[20:23], s3 offen offset:512 sc1
Mvaa 252,156,60
buffer_load_dwordx2 v[40:41], v124, s[20:23], s3 offen offset:768 sc1
s_waitcnt vmcnt(33) lgkmcnt(0)
Mvaa 128,128,64
s_add_u32 m0, s35, 8192
Mvaa 132,132,64
buffer_load_dwordx4 v114, s[12:15], s48 offen offset:0 lds
Mvaa 136,136,64
Ta 144,115,12288
Ta 146,115,14336
Mvaa 140,140,64
buffer_load_dwordx4 v114, s[12:15], s49 offen offset:1024 lds
Mvaa 144,128,68
s_lshr_b32 s3, s42, 7
s_lshr_b32 s47, s43, 7
s_cmp_eq_u32 s3, s45
s_cselect_b32 s53, 1, 0
s_cmp_eq_u32 s47, s45
s_cselect_b32 s53, 1, s53
s_mov_b32 s40, 0
Mvaa 148,132,68
s_lshl_b32 s41, s46, 2
s_add_u32 s41, s41, 4
s_lshl_b32 s44, s46, 12
Mvaa 152,136,68
buffer_load_dwordx4 v114, s[12:15], s50 offen offset:2048 lds
Mvaa 156,140,68
Ta 148,116,12288
Ta 150,116,14336
Mvaa 160,128,72
buffer_load_dwordx4 v114, s[12:15], s51 offen offset:3072 lds
Mvaa 164,132,72
v_add_u32 v114, 65536, v114
Mvaa 168,136,72
s_add_u32 s44, s44, 5308416
Mvaa 172,140,72
buffer_load_dwordx4 a[32:35], v112, s[8:11], s52 offen offset:0 sc1
Mvaa 176,128,76
Ta 152,117,12288
Ta 154,117,14336
Mvaa 180,132,76
buffer_load_dwordx4 a[36:39], v112, s[8:11], s52 offen offset:1024 sc1
Mvaa 184,136,76
Mvaa 188,140,76
Mvaa 192,128,80
buffer_load_dwordx4 a[40:43], v112, s[8:11], s52 offen offset:2048 sc1
Mvaa 196,132,80
Ta 156,118,12288
Ta 158,118,14336
Mvaa 200,136,80
buffer_load_dwordx4 a[44:47], v112, s[8:11], s52 offen offset:3072 sc1
Mvaa 204,140,80
Mvaa 208,128,84
Mvaa 212,132,84
buffer_load_dwordx4 a[48:51], v113, s[8:11], s52 offen offset:0 sc1
Mvaa 216,136,84
Mvaa 220,140,84
buffer_load_dwordx4 a[52:55], v113, s[8:11], s52 offen offset:1024 sc1
Mvaa 224,128,88
Mvaa 228,132,88
Mvaa 232,136,88
buffer_load_dwordx4 a[56:59], v113, s[8:11], s52 offen offset:2048 sc1
Mvaa 236,140,88
Mvaa 240,128,92
buffer_load_dwordx4 a[60:63], v113, s[8:11], s52 offen offset:3072 sc1
Mvaa 244,132,92
s_add_u32 s52, s52, 8192
Mvaa 248,136,92
Mvaa 252,140,92
s_waitcnt vmcnt(32) lgkmcnt(0)
Mvaa 128,144,96
s_add_u32 m0, s35, 12288
Mvaa 132,148,96
buffer_load_dwordx4 v114, s[12:15], s48 offen offset:0 lds
Mvaa 136,152,96
Ta 128,115,0
Ta 130,115,2048
Mvaa 140,156,96
buffer_load_dwordx4 v114, s[12:15], s49 offen offset:1024 lds
Mvaa 144,144,100
Mvaa 148,148,100
Mvaa 152,152,100
buffer_load_dwordx4 v114, s[12:15], s50 offen offset:2048 lds
Mvaa 156,156,100
Ta 132,116,0
Ta 134,116,2048
Mvaa 160,144,104
buffer_load_dwordx4 v114, s[12:15], s51 offen offset:3072 lds
Mvaa 164,148,104
v_add_u32 v114, 65536, v114
Mvaa 168,152,104
Mvaa 172,156,104
buffer_load_dwordx4 a[64:67], v112, s[8:11], s52 offen offset:0 sc1
Mvaa 176,144,108
Ta 136,117,0
Ta 138,117,2048
Mvaa 180,148,108
buffer_load_dwordx4 a[68:71], v112, s[8:11], s52 offen offset:1024 sc1
Mvaa 184,152,108
Mvaa 188,156,108
Mvaa 192,144,112
buffer_load_dwordx4 a[72:75], v112, s[8:11], s52 offen offset:2048 sc1
Mvaa 196,148,112
Ta 140,118,0
Ta 142,118,2048
Mvaa 200,152,112
buffer_load_dwordx4 a[76:79], v112, s[8:11], s52 offen offset:3072 sc1
Mvaa 204,156,112
Mvaa 208,144,116
Mvaa 212,148,116
buffer_load_dwordx4 a[80:83], v113, s[8:11], s52 offen offset:0 sc1
Mvaa 216,152,116
Mvaa 220,156,116
buffer_load_dwordx4 a[84:87], v113, s[8:11], s52 offen offset:1024 sc1
Mvaa 224,144,120
Mvaa 228,148,120
Mvaa 232,152,120
buffer_load_dwordx4 a[88:91], v113, s[8:11], s52 offen offset:2048 sc1
Mvaa 236,156,120
Mvaa 240,144,124
buffer_load_dwordx4 a[92:95], v113, s[8:11], s52 offen offset:3072 sc1
Mvaa 244,148,124
s_add_u32 s52, s52, 8192
Mvaa 248,152,124
Mvaa 252,156,124
s_waitcnt vmcnt(26) lgkmcnt(0)
Mvaa 128,128,0
s_add_u32 m0, s35, 0
Mvaa 132,132,0
buffer_load_dwordx4 v114, s[12:15], s48 offen offset:0 lds
Mvaa 136,136,0
Ta 144,115,4096
Ta 146,115,6144
Mvaa 140,140,0
buffer_load_dwordx4 v114, s[12:15], s49 offen offset:1024 lds
Mvaa 144,128,4
s_waitcnt vmcnt(26)
v_lshlrev_b32 v42, 16, v18
v_and_b32 v43, 0xffff0000, v18
Mvaa 148,132,4
v_lshlrev_b32_e64 v44, 16, v19
v_and_b32 v45, 0xffff0000, v19
Mvaa 152,136,4
buffer_load_dwordx4 v114, s[12:15], s50 offen offset:2048 lds
Mvaa 156,140,4
Ta 148,116,4096
Ta 150,116,6144
Mvaa 160,128,8
buffer_load_dwordx4 v114, s[12:15], s51 offen offset:3072 lds
Mvaa 164,132,8
v_add_u32 v114, 65536, v114
Mvaa 168,136,8
v_lshlrev_b32_e64 v46, 16, v20
v_and_b32 v47, 0xffff0000, v20
Mvaa 172,140,8
buffer_load_dwordx4 a[96:99], v112, s[8:11], s52 offen offset:0 sc1
Mvaa 176,128,12
Ta 152,117,4096
Ta 154,117,6144
Mvaa 180,132,12
buffer_load_dwordx4 a[100:103], v112, s[8:11], s52 offen offset:1024 sc1
Mvaa 184,136,12
v_lshlrev_b32_e64 v48, 16, v21
v_and_b32 v49, 0xffff0000, v21
Mvaa 188,140,12
Vs 42,42,34
Vs 43,43,34
Mvaa 192,128,16
buffer_load_dwordx4 a[104:107], v112, s[8:11], s52 offen offset:2048 sc1
Mvaa 196,132,16
Ta 156,118,4096
Ta 158,118,6144
Mvaa 200,136,16
buffer_load_dwordx4 a[108:111], v112, s[8:11], s52 offen offset:3072 sc1
Mvaa 204,140,16
Vs 44,44,34
Vs 45,45,34
Mvaa 208,128,20
Vs 46,46,34
Vs 47,47,34
Mvaa 212,132,20
buffer_load_dwordx4 a[112:115], v113, s[8:11], s52 offen offset:0 sc1
Mvaa 216,136,20
Vs 48,48,34
Vs 49,49,34
Mvaa 220,140,20
buffer_load_dwordx4 a[116:119], v113, s[8:11], s52 offen offset:1024 sc1
Mvaa 224,128,24
Vc 2,42,43
v_lshlrev_b32_e64 v42, 16, v2
Mvaa 228,132,24
v_and_b32 v43, 0xffff0000, v2
Vc 3,44,45
Mvaa 232,136,24
buffer_load_dwordx4 a[120:123], v113, s[8:11], s52 offen offset:2048 sc1
Mvaa 236,140,24
v_lshlrev_b32_e64 v44, 16, v3
v_and_b32 v45, 0xffff0000, v3
Mvaa 240,128,28
buffer_load_dwordx4 a[124:127], v113, s[8:11], s52 offen offset:3072 sc1
Mvaa 244,132,28
s_add_u32 s52, s52, 8192
Mvaa 248,136,28
Vc 4,46,47
v_lshlrev_b32_e64 v46, 16, v4
Mvaa 252,140,28
v_and_b32 v47, 0xffff0000, v4
Vc 5,48,49
s_waitcnt vmcnt(24) lgkmcnt(0)
Mvaa 128,144,32
s_add_u32 m0, s35, 4096
Mvaa 132,148,32
buffer_load_dwordx4 v114, s[12:15], s48 offen offset:0 lds
Mvaa 136,152,32
Ta 128,115,8192
Ta 130,115,10240
Mvaa 140,156,32
buffer_load_dwordx4 v114, s[12:15], s49 offen offset:1024 lds
Mvaa 144,144,36
v_lshlrev_b32 v48, 16, v5
v_and_b32 v49, 0xffff0000, v5
Mvaa 148,148,36
Vm 42,42,35
Vm 43,43,35
Mvaa 152,152,36
buffer_load_dwordx4 v114, s[12:15], s50 offen offset:2048 lds
Mvaa 156,156,36
Ta 132,116,8192
Ta 134,116,10240
Mvaa 160,144,40
buffer_load_dwordx4 v114, s[12:15], s51 offen offset:3072 lds
Mvaa 164,148,40
v_add_u32 v114, 65536, v114
Mvaa 168,152,40
Vm 44,44,35
Vm 45,45,35
Mvaa 172,156,40
buffer_load_dwordx4 a[0:3], v112, s[8:11], s52 offen offset:0 sc1
Mvaa 176,144,44
Ta 136,117,8192
Ta 138,117,10240
Mvaa 180,148,44
buffer_load_dwordx4 a[4:7], v112, s[8:11], s52 offen offset:1024 sc1
Mvaa 184,152,44
Vm 46,46,35
Vm 47,47,35
Mvaa 188,156,44
Vm 48,48,35
Vm 49,49,35
Mvaa 192,144,48
buffer_load_dwordx4 a[8:11], v112, s[8:11], s52 offen offset:2048 sc1
Mvaa 196,148,48
Ta 140,118,8192
Ta 142,118,10240
Mvaa 200,152,48
buffer_load_dwordx4 a[12:15], v112, s[8:11], s52 offen offset:3072 sc1
Mvaa 204,156,48
Vc 2,42,43
v_lshlrev_b32_e64 v42, 16, v2
Mvaa 208,144,52
v_and_b32 v43, 0xffff0000, v2
Vc 3,44,45
Mvaa 212,148,52
buffer_load_dwordx4 a[16:19], v113, s[8:11], s52 offen offset:0 sc1
Mvaa 216,152,52
v_lshlrev_b32_e64 v44, 16, v3
v_and_b32 v45, 0xffff0000, v3
Mvaa 220,156,52
buffer_load_dwordx4 a[20:23], v113, s[8:11], s52 offen offset:1024 sc1
Mvaa 224,144,56
Vc 4,46,47
v_lshlrev_b32_e64 v46, 16, v4
Mvaa 228,148,56
v_and_b32 v47, 0xffff0000, v4
Vc 5,48,49
Mvaa 232,152,56
buffer_load_dwordx4 a[24:27], v113, s[8:11], s52 offen offset:2048 sc1
Mvaa 236,156,56
v_lshlrev_b32_e64 v48, 16, v5
v_and_b32 v49, 0xffff0000, v5
Mvaa 240,144,60
buffer_load_dwordx4 a[28:31], v113, s[8:11], s52 offen offset:3072 sc1
Mvaa 244,148,60
s_add_u32 s52, s52, 8192
Mvaa 248,152,60
v_mul_f32 v2, 0xbfb8aa3b, v42
v_mul_f32 v3, 0xbfb8aa3b, v43
Mvaa 252,156,60
v_mul_f32 v4, 0xbfb8aa3b, v44
v_mul_f32 v5, 0xbfb8aa3b, v45
s_waitcnt vmcnt(24) lgkmcnt(0)
Mvaa 128,128,64
s_add_u32 m0, s35, 8192
Mvaa 132,132,64
buffer_load_dwordx4 v114, s[12:15], s48 offen offset:0 lds
Mvaa 136,136,64
Ta 144,115,12288
Ta 146,115,14336
Mvaa 140,140,64
buffer_load_dwordx4 v114, s[12:15], s49 offen offset:1024 lds
Mvaa 144,128,68
v_mul_f32 v6, 0xbfb8aa3b, v46
v_mul_f32 v7, 0xbfb8aa3b, v47
Mvaa 148,132,68
v_mul_f32 v8, 0xbfb8aa3b, v48
v_mul_f32 v9, 0xbfb8aa3b, v49
Mvaa 152,136,68
buffer_load_dwordx4 v114, s[12:15], s50 offen offset:2048 lds
Mvaa 156,140,68
Ta 148,116,12288
Ta 150,116,14336
Mvaa 160,128,72
buffer_load_dwordx4 v114, s[12:15], s51 offen offset:3072 lds
Mvaa 164,132,72
v_add_u32 v114, 65536, v114
Mvaa 168,136,72
Ve 2,2
Mvaa 172,140,72
buffer_load_dwordx4 a[32:35], v112, s[8:11], s52 offen offset:0 sc1
Mvaa 176,128,76
Ta 152,117,12288
Ta 154,117,14336
Mvaa 180,132,76
buffer_load_dwordx4 a[36:39], v112, s[8:11], s52 offen offset:1024 sc1
Mvaa 184,136,76
VE 3,3
Mvaa 188,140,76
VE 4,4
Mvaa 192,128,80
buffer_load_dwordx4 a[40:43], v112, s[8:11], s52 offen offset:2048 sc1
Mvaa 196,132,80
Ta 156,118,12288
Ta 158,118,14336
Mvaa 200,136,80
buffer_load_dwordx4 a[44:47], v112, s[8:11], s52 offen offset:3072 sc1
Mvaa 204,140,80
VE 5,5
Mvaa 208,128,84
VE 6,6
Mvaa 212,132,84
buffer_load_dwordx4 a[48:51], v113, s[8:11], s52 offen offset:0 sc1
Mvaa 216,136,84
VE 7,7
Mvaa 220,140,84
buffer_load_dwordx4 a[52:55], v113, s[8:11], s52 offen offset:1024 sc1
Mvaa 224,128,88
VE 8,8
Mvaa 228,132,88
VE 9,9
Mvaa 232,136,88
buffer_load_dwordx4 a[56:59], v113, s[8:11], s52 offen offset:2048 sc1
Mvaa 236,140,88
v_add_f32 v2, 1.0, v2
v_add_f32 v3, 1.0, v3
Mvaa 240,128,92
buffer_load_dwordx4 a[60:63], v113, s[8:11], s52 offen offset:3072 sc1
Mvaa 244,132,92
s_add_u32 s52, s52, 8192
Mvaa 248,136,92
v_add_f32 v4, 1.0, v4
v_add_f32 v5, 1.0, v5
Mvaa 252,140,92
v_add_f32 v6, 1.0, v6
v_add_f32 v7, 1.0, v7
s_waitcnt vmcnt(24) lgkmcnt(0)
Mvaa 128,144,96
s_add_u32 m0, s35, 12288
Mvaa 132,148,96
buffer_load_dwordx4 v114, s[12:15], s48 offen offset:0 lds
Mvaa 136,152,96
Ta 128,115,0
Ta 130,115,2048
Mvaa 140,156,96
buffer_load_dwordx4 v114, s[12:15], s49 offen offset:1024 lds
Mvaa 144,144,100
v_add_f32 v8, 1.0, v8
v_add_f32_e64 v9, 1.0, v9
Mvaa 148,148,100
v_rcp_f32_e64 v2, v2
Mvaa 152,152,100
buffer_load_dwordx4 v114, s[12:15], s50 offen offset:2048 lds
Mvaa 156,156,100
Ta 132,116,0
Ta 134,116,2048
Mvaa 160,144,104
buffer_load_dwordx4 v114, s[12:15], s51 offen offset:3072 lds
Mvaa 164,148,104
v_add_u32 v114, 65536, v114
Mvaa 168,152,104
v_rcp_f32_e64 v3, v3
Mvaa 172,156,104
buffer_load_dwordx4 a[64:67], v112, s[8:11], s52 offen offset:0 sc1
Mvaa 176,144,108
Ta 136,117,0
Ta 138,117,2048
Mvaa 180,148,108
buffer_load_dwordx4 a[68:71], v112, s[8:11], s52 offen offset:1024 sc1
Mvaa 184,152,108
s_cmp_ge_u32 s2, 144
s_cbranch_scc1 L_f2A
L_f2Ar:
Mvaa 188,156,108
v_rcp_f32 v4, v4
Mvaa 192,144,112
buffer_load_dwordx4 a[72:75], v112, s[8:11], s52 offen offset:2048 sc1
Mvaa 196,148,112
Ta 140,118,0
Ta 142,118,2048
Mvaa 200,152,112
buffer_load_dwordx4 a[76:79], v112, s[8:11], s52 offen offset:3072 sc1
Mvaa 204,156,112
v_rcp_f32_e64 v5, v5
Mvaa 208,144,116
v_rcp_f32_e64 v6, v6
Mvaa 212,148,116
buffer_load_dwordx4 a[80:83], v113, s[8:11], s52 offen offset:0 sc1
Mvaa 216,152,116
v_rcp_f32_e64 v7, v7
Mvaa 220,156,116
buffer_load_dwordx4 a[84:87], v113, s[8:11], s52 offen offset:1024 sc1
Mvaa 224,144,120
v_rcp_f32_e64 v8, v8
Mvaa 228,148,120
v_rcp_f32_e64 v9, v9
Mvaa 232,152,120
buffer_load_dwordx4 a[88:91], v113, s[8:11], s52 offen offset:2048 sc1
Mvaa 236,156,120
Vm 42,42,2
Vm 43,43,3
Mvaa 240,144,124
buffer_load_dwordx4 a[92:95], v113, s[8:11], s52 offen offset:3072 sc1
Mvaa 244,148,124
s_add_u32 s52, s52, 8192
Mvaa 248,152,124
Vm 44,44,4
Vm 45,45,5
Mvaa 252,156,124
Vm 46,46,6
Vm 47,47,7
s_waitcnt vmcnt(24) lgkmcnt(0)
Mvaa 128,128,0
s_add_u32 m0, s35, 0
Mvaa 132,132,0
buffer_load_dwordx4 v114, s[12:15], s48 offen offset:0 lds
Mvaa 136,136,0
Ta 144,115,4096
Ta 146,115,6144
Mvaa 140,140,0
buffer_load_dwordx4 v114, s[12:15], s49 offen offset:1024 lds
Mvaa 144,128,4
Vm 48,48,8
Vm 49,49,9
Mvaa 148,132,4
Vc 2,42,43
v_lshlrev_b32_e64 v42, 16, v2
Mvaa 152,136,4
buffer_load_dwordx4 v114, s[12:15], s50 offen offset:2048 lds
Mvaa 156,140,4
Ta 148,116,4096
Ta 150,116,6144
Mvaa 160,128,8
buffer_load_dwordx4 v114, s[12:15], s51 offen offset:3072 lds
Mvaa 164,132,8
v_add_u32 v114, 65536, v114
Mvaa 168,136,8
v_and_b32 v43, 0xffff0000, v2
Vc 3,44,45
Mvaa 172,140,8
buffer_load_dwordx4 a[96:99], v112, s[8:11], s52 offen offset:0 sc1
Mvaa 176,128,12
Ta 152,117,4096
Ta 154,117,6144
Mvaa 180,132,12
buffer_load_dwordx4 a[100:103], v112, s[8:11], s52 offen offset:1024 sc1
Mvaa 184,136,12
v_lshlrev_b32_e64 v44, 16, v3
v_and_b32 v45, 0xffff0000, v3
Mvaa 188,140,12
Vc 4,46,47
v_lshlrev_b32_e64 v46, 16, v4
Mvaa 192,128,16
buffer_load_dwordx4 a[104:107], v112, s[8:11], s52 offen offset:2048 sc1
Mvaa 196,132,16
Ta 156,118,4096
Ta 158,118,6144
Mvaa 200,136,16
buffer_load_dwordx4 a[108:111], v112, s[8:11], s52 offen offset:3072 sc1
Mvaa 204,140,16
v_and_b32 v47, 0xffff0000, v4
Vc 5,48,49
Mvaa 208,128,20
v_lshlrev_b32_e64 v48, 16, v5
v_and_b32 v49, 0xffff0000, v5
Mvaa 212,132,20
buffer_load_dwordx4 a[112:115], v113, s[8:11], s52 offen offset:0 sc1
Mvaa 216,136,20
v_lshlrev_b32_e64 v50, 16, v22
v_and_b32 v51, 0xffff0000, v22
Mvaa 220,140,20
buffer_load_dwordx4 a[116:119], v113, s[8:11], s52 offen offset:1024 sc1
Mvaa 224,128,24
v_lshlrev_b32_e64 v52, 16, v23
v_and_b32 v53, 0xffff0000, v23
Mvaa 228,132,24
v_lshlrev_b32_e64 v54, 16, v24
v_and_b32 v55, 0xffff0000, v24
Mvaa 232,136,24
buffer_load_dwordx4 a[120:123], v113, s[8:11], s52 offen offset:2048 sc1
Mvaa 236,140,24
v_lshlrev_b32_e64 v56, 16, v25
v_and_b32 v57, 0xffff0000, v25
Mvaa 240,128,28
buffer_load_dwordx4 a[124:127], v113, s[8:11], s52 offen offset:3072 sc1
Mvaa 244,132,28
s_add_u32 s52, s52, 8192
Mvaa 248,136,28
Vs 50,50,36
Vs 51,51,36
Mvaa 252,140,28
Vs 52,52,36
Vs 53,53,36
s_waitcnt vmcnt(24) lgkmcnt(0)
Mvaa 128,144,32
s_add_u32 m0, s35, 4096
Mvaa 132,148,32
buffer_load_dwordx4 v114, s[12:15], s48 offen offset:0 lds
Mvaa 136,152,32
Ta 128,115,8192
Ta 130,115,10240
Mvaa 140,156,32
buffer_load_dwordx4 v114, s[12:15], s49 offen offset:1024 lds
Mvaa 144,144,36
Vs 54,54,36
v_sub_f32_e64 v55, v55, v36
Mvaa 148,148,36
Vs 56,56,36
Vs 57,57,36
Mvaa 152,152,36
buffer_load_dwordx4 v114, s[12:15], s50 offen offset:2048 lds
Mvaa 156,156,36
Ta 132,116,8192
Ta 134,116,10240
Mvaa 160,144,40
buffer_load_dwordx4 v114, s[12:15], s51 offen offset:3072 lds
Mvaa 164,148,40
v_add_u32 v114, 65536, v114
Mvaa 168,152,40
Vc 2,50,51
v_lshlrev_b32_e64 v50, 16, v2
Mvaa 172,156,40
buffer_load_dwordx4 a[0:3], v112, s[8:11], s52 offen offset:0 sc1
Mvaa 176,144,44
Ta 136,117,8192
Ta 138,117,10240
Mvaa 180,148,44
buffer_load_dwordx4 a[4:7], v112, s[8:11], s52 offen offset:1024 sc1
Mvaa 184,152,44
v_and_b32 v51, 0xffff0000, v2
Vc 3,52,53
Mvaa 188,156,44
v_lshlrev_b32_e64 v52, 16, v3
v_and_b32 v53, 0xffff0000, v3
Mvaa 192,144,48
buffer_load_dwordx4 a[8:11], v112, s[8:11], s52 offen offset:2048 sc1
Mvaa 196,148,48
Ta 140,118,8192
Ta 142,118,10240
Mvaa 200,152,48
buffer_load_dwordx4 a[12:15], v112, s[8:11], s52 offen offset:3072 sc1
Mvaa 204,156,48
Vc 4,54,55
v_lshlrev_b32_e64 v54, 16, v4
Mvaa 208,144,52
v_and_b32 v55, 0xffff0000, v4
Vc 5,56,57
Mvaa 212,148,52
buffer_load_dwordx4 a[16:19], v113, s[8:11], s52 offen offset:0 sc1
Mvaa 216,152,52
v_lshlrev_b32_e64 v56, 16, v5
v_and_b32 v57, 0xffff0000, v5
Mvaa 220,156,52
buffer_load_dwordx4 a[20:23], v113, s[8:11], s52 offen offset:1024 sc1
Mvaa 224,144,56
Vm 50,50,37
Vm 51,51,37
Mvaa 228,148,56
Vm 52,52,37
Vm 53,53,37
Mvaa 232,152,56
buffer_load_dwordx4 a[24:27], v113, s[8:11], s52 offen offset:2048 sc1
Mvaa 236,156,56
Vm 54,54,37
Vm 55,55,37
Mvaa 240,144,60
buffer_load_dwordx4 a[28:31], v113, s[8:11], s52 offen offset:3072 sc1
Mvaa 244,148,60
s_add_u32 s52, s52, 8192
Mvaa 248,152,60
Vm 56,56,37
Vm 57,57,37
Mvaa 252,156,60
Vc 2,50,51
v_lshlrev_b32 v50, 16, v2
s_waitcnt vmcnt(24) lgkmcnt(0)
Mvaa 128,128,64
s_add_u32 m0, s35, 8192
Mvaa 132,132,64
buffer_load_dwordx4 v114, s[12:15], s48 offen offset:0 lds
Mvaa 136,136,64
Ta 144,115,12288
Ta 146,115,14336
Mvaa 140,140,64
buffer_load_dwordx4 v114, s[12:15], s49 offen offset:1024 lds
Mvaa 144,128,68
v_and_b32 v51, 0xffff0000, v2
Vc 3,52,53
Mvaa 148,132,68
v_lshlrev_b32_e64 v52, 16, v3
v_and_b32 v53, 0xffff0000, v3
Mvaa 152,136,68
buffer_load_dwordx4 v114, s[12:15], s50 offen offset:2048 lds
Mvaa 156,140,68
Ta 148,116,12288
Ta 150,116,14336
Mvaa 160,128,72
buffer_load_dwordx4 v114, s[12:15], s51 offen offset:3072 lds
Mvaa 164,132,72
v_add_u32 v114, 65536, v114
Mvaa 168,136,72
Vc 4,54,55
v_lshlrev_b32_e64 v54, 16, v4
Mvaa 172,140,72
buffer_load_dwordx4 a[32:35], v112, s[8:11], s52 offen offset:0 sc1
Mvaa 176,128,76
Ta 152,117,12288
Ta 154,117,14336
Mvaa 180,132,76
buffer_load_dwordx4 a[36:39], v112, s[8:11], s52 offen offset:1024 sc1
Mvaa 184,136,76
s_cmp_ge_u32 s2, 144
s_cbranch_scc1 L_f2B
L_f2Br:
Mvaa 188,140,76
v_and_b32 v55, 0xffff0000, v4
Vc 5,56,57
Mvaa 192,128,80
buffer_load_dwordx4 a[40:43], v112, s[8:11], s52 offen offset:2048 sc1
Mvaa 196,132,80
Ta 156,118,12288
Ta 158,118,14336
Mvaa 200,136,80
buffer_load_dwordx4 a[44:47], v112, s[8:11], s52 offen offset:3072 sc1
Mvaa 204,140,80
v_lshlrev_b32 v56, 16, v5
v_and_b32 v57, 0xffff0000, v5
Mvaa 208,128,84
v_mul_f32 v2, 0xbfb8aa3b, v50
v_mul_f32 v3, 0xbfb8aa3b, v51
Mvaa 212,132,84
buffer_load_dwordx4 a[48:51], v113, s[8:11], s52 offen offset:0 sc1
Mvaa 216,136,84
v_mul_f32 v4, 0xbfb8aa3b, v52
v_mul_f32 v5, 0xbfb8aa3b, v53
Mvaa 220,140,84
buffer_load_dwordx4 a[52:55], v113, s[8:11], s52 offen offset:1024 sc1
Mvaa 224,128,88
v_mul_f32 v6, 0xbfb8aa3b, v54
v_mul_f32 v7, 0xbfb8aa3b, v55
Mvaa 228,132,88
v_mul_f32 v8, 0xbfb8aa3b, v56
v_mul_f32 v9, 0xbfb8aa3b, v57
Mvaa 232,136,88
buffer_load_dwordx4 a[56:59], v113, s[8:11], s52 offen offset:2048 sc1
Mvaa 236,140,88
VE 2,2
Mvaa 240,128,92
buffer_load_dwordx4 a[60:63], v113, s[8:11], s52 offen offset:3072 sc1
Mvaa 244,132,92
s_add_u32 s52, s52, 8192
Mvaa 248,136,92
VE 3,3
Mvaa 252,140,92
Ve 4,4
s_waitcnt vmcnt(24) lgkmcnt(0)
Mvaa 128,144,96
s_add_u32 m0, s35, 12288
Mvaa 132,148,96
buffer_load_dwordx4 v114, s[12:15], s48 offen offset:0 lds
Mvaa 136,152,96
Ta 128,115,0
Ta 130,115,2048
Mvaa 140,156,96
buffer_load_dwordx4 v114, s[12:15], s49 offen offset:1024 lds
Mvaa 144,144,100
VE 5,5
Mvaa 148,148,100
VE 6,6
Mvaa 152,152,100
buffer_load_dwordx4 v114, s[12:15], s50 offen offset:2048 lds
Mvaa 156,156,100
Ta 132,116,0
Ta 134,116,2048
Mvaa 160,144,104
buffer_load_dwordx4 v114, s[12:15], s51 offen offset:3072 lds
Mvaa 164,148,104
v_add_u32 v114, 65536, v114
Mvaa 168,152,104
VE 7,7
Mvaa 172,156,104
buffer_load_dwordx4 a[64:67], v112, s[8:11], s52 offen offset:0 sc1
Mvaa 176,144,108
Ta 136,117,0
Ta 138,117,2048
Mvaa 180,148,108
buffer_load_dwordx4 a[68:71], v112, s[8:11], s52 offen offset:1024 sc1
Mvaa 184,152,108
VE 8,8
Mvaa 188,156,108
VE 9,9
Mvaa 192,144,112
buffer_load_dwordx4 a[72:75], v112, s[8:11], s52 offen offset:2048 sc1
Mvaa 196,148,112
Ta 140,118,0
Ta 142,118,2048
Mvaa 200,152,112
buffer_load_dwordx4 a[76:79], v112, s[8:11], s52 offen offset:3072 sc1
Mvaa 204,156,112
v_add_f32 v2, 1.0, v2
v_add_f32 v3, 1.0, v3
Mvaa 208,144,116
v_add_f32 v4, 1.0, v4
v_add_f32 v5, 1.0, v5
Mvaa 212,148,116
buffer_load_dwordx4 a[80:83], v113, s[8:11], s52 offen offset:0 sc1
Mvaa 216,152,116
v_add_f32 v6, 1.0, v6
v_add_f32 v7, 1.0, v7
Mvaa 220,156,116
buffer_load_dwordx4 a[84:87], v113, s[8:11], s52 offen offset:1024 sc1
Mvaa 224,144,120
v_add_f32 v8, 1.0, v8
v_add_f32 v9, 1.0, v9
Mvaa 228,148,120
v_rcp_f32_e64 v2, v2
Mvaa 232,152,120
buffer_load_dwordx4 a[88:91], v113, s[8:11], s52 offen offset:2048 sc1
Mvaa 236,156,120
v_rcp_f32_e64 v3, v3
Mvaa 240,144,124
buffer_load_dwordx4 a[92:95], v113, s[8:11], s52 offen offset:3072 sc1
Mvaa 244,148,124
s_add_u32 s52, s52, 8192
Mvaa 248,152,124
v_rcp_f32_e64 v4, v4
Mvaa 252,156,124
v_rcp_f32 v5, v5
s_waitcnt vmcnt(24) lgkmcnt(0)
Mvaa 128,128,0
s_add_u32 m0, s35, 0
Mvaa 132,132,0
buffer_load_dwordx4 v114, s[12:15], s48 offen offset:0 lds
Mvaa 136,136,0
Ta 144,115,4096
Ta 146,115,6144
Mvaa 140,140,0
buffer_load_dwordx4 v114, s[12:15], s49 offen offset:1024 lds
Mvaa 144,128,4
v_rcp_f32 v6, v6
Mvaa 148,132,4
v_rcp_f32_e64 v7, v7
Mvaa 152,136,4
buffer_load_dwordx4 v114, s[12:15], s50 offen offset:2048 lds
Mvaa 156,140,4
Ta 148,116,4096
Ta 150,116,6144
Mvaa 160,128,8
buffer_load_dwordx4 v114, s[12:15], s51 offen offset:3072 lds
Mvaa 164,132,8
v_add_u32 v114, 65536, v114
Mvaa 168,136,8
v_rcp_f32_e64 v8, v8
Mvaa 172,140,8
buffer_load_dwordx4 a[96:99], v112, s[8:11], s52 offen offset:0 sc1
Mvaa 176,128,12
Ta 152,117,4096
Ta 154,117,6144
Mvaa 180,132,12
buffer_load_dwordx4 a[100:103], v112, s[8:11], s52 offen offset:1024 sc1
Mvaa 184,136,12
v_rcp_f32_e64 v9, v9
Mvaa 188,140,12
Vm 50,50,2
Vm 51,51,3
Mvaa 192,128,16
buffer_load_dwordx4 a[104:107], v112, s[8:11], s52 offen offset:2048 sc1
Mvaa 196,132,16
Ta 156,118,4096
Ta 158,118,6144
Mvaa 200,136,16
buffer_load_dwordx4 a[108:111], v112, s[8:11], s52 offen offset:3072 sc1
Mvaa 204,140,16
Vm 52,52,4
Vm 53,53,5
Mvaa 208,128,20
Vm 54,54,6
Vm 55,55,7
Mvaa 212,132,20
buffer_load_dwordx4 a[112:115], v113, s[8:11], s52 offen offset:0 sc1
Mvaa 216,136,20
Vm 56,56,8
Vm 57,57,9
Mvaa 220,140,20
buffer_load_dwordx4 a[116:119], v113, s[8:11], s52 offen offset:1024 sc1
Mvaa 224,128,24
Vc 2,50,51
v_lshlrev_b32_e64 v50, 16, v2
Mvaa 228,132,24
v_and_b32 v51, 0xffff0000, v2
Vc 3,52,53
Mvaa 232,136,24
buffer_load_dwordx4 a[120:123], v113, s[8:11], s52 offen offset:2048 sc1
Mvaa 236,140,24
v_lshlrev_b32_e64 v52, 16, v3
v_and_b32 v53, 0xffff0000, v3
Mvaa 240,128,28
buffer_load_dwordx4 a[124:127], v113, s[8:11], s52 offen offset:3072 sc1
Mvaa 244,132,28
s_add_u32 s52, s52, 8192
Mvaa 248,136,28
Vc 4,54,55
v_lshlrev_b32_e64 v54, 16, v4
Mvaa 252,140,28
v_and_b32 v55, 0xffff0000, v4
Vc 5,56,57
s_waitcnt vmcnt(24) lgkmcnt(0)
Mvaa 128,144,32
s_add_u32 m0, s35, 4096
Mvaa 132,148,32
buffer_load_dwordx4 v114, s[12:15], s48 offen offset:0 lds
Mvaa 136,152,32
Ta 128,115,8192
Ta 130,115,10240
Mvaa 140,156,32
buffer_load_dwordx4 v114, s[12:15], s49 offen offset:1024 lds
Mvaa 144,144,36
v_lshlrev_b32 v56, 16, v5
v_and_b32 v57, 0xffff0000, v5
Mvaa 148,148,36
v_lshlrev_b32_e64 v58, 16, v26
v_and_b32 v59, 0xffff0000, v26
Mvaa 152,152,36
buffer_load_dwordx4 v114, s[12:15], s50 offen offset:2048 lds
Mvaa 156,156,36
Ta 132,116,8192
Ta 134,116,10240
Mvaa 160,144,40
buffer_load_dwordx4 v114, s[12:15], s51 offen offset:3072 lds
Mvaa 164,148,40
v_add_u32 v114, 65536, v114
Mvaa 168,152,40
v_lshlrev_b32_e64 v60, 16, v27
v_and_b32 v61, 0xffff0000, v27
Mvaa 172,156,40
buffer_load_dwordx4 a[0:3], v112, s[8:11], s52 offen offset:0 sc1
Mvaa 176,144,44
Ta 136,117,8192
Ta 138,117,10240
Mvaa 180,148,44
buffer_load_dwordx4 a[4:7], v112, s[8:11], s52 offen offset:1024 sc1
Mvaa 184,152,44
s_cmp_ge_u32 s2, 144
s_cbranch_scc1 L_f2C
L_f2Cr:
Mvaa 188,156,44
v_lshlrev_b32 v62, 16, v28
v_and_b32 v63, 0xffff0000, v28
Mvaa 192,144,48
buffer_load_dwordx4 a[8:11], v112, s[8:11], s52 offen offset:2048 sc1
Mvaa 196,148,48
Ta 140,118,8192
Ta 142,118,10240
Mvaa 200,152,48
buffer_load_dwordx4 a[12:15], v112, s[8:11], s52 offen offset:3072 sc1
Mvaa 204,156,48
v_lshlrev_b32_e64 v64, 16, v29
v_and_b32 v65, 0xffff0000, v29
Mvaa 208,144,52
Vs 58,58,38
Vs 59,59,38
Mvaa 212,148,52
buffer_load_dwordx4 a[16:19], v113, s[8:11], s52 offen offset:0 sc1
Mvaa 216,152,52
Vs 60,60,38
Vs 61,61,38
Mvaa 220,156,52
buffer_load_dwordx4 a[20:23], v113, s[8:11], s52 offen offset:1024 sc1
Mvaa 224,144,56
Vs 62,62,38
Vs 63,63,38
Mvaa 228,148,56
Vs 64,64,38
Vs 65,65,38
Mvaa 232,152,56
buffer_load_dwordx4 a[24:27], v113, s[8:11], s52 offen offset:2048 sc1
Mvaa 236,156,56
Vc 2,58,59
v_lshlrev_b32_e64 v58, 16, v2
Mvaa 240,144,60
buffer_load_dwordx4 a[28:31], v113, s[8:11], s52 offen offset:3072 sc1
Mvaa 244,148,60
s_add_u32 s52, s52, 8192
Mvaa 248,152,60
v_and_b32 v59, 0xffff0000, v2
Vc 3,60,61
Mvaa 252,156,60
v_lshlrev_b32_e64 v60, 16, v3
v_and_b32 v61, 0xffff0000, v3
s_waitcnt vmcnt(24) lgkmcnt(0)
Mvaa 128,128,64
s_add_u32 m0, s35, 8192
Mvaa 132,132,64
buffer_load_dwordx4 v114, s[12:15], s48 offen offset:0 lds
Mvaa 136,136,64
Ta 144,115,12288
Ta 146,115,14336
Mvaa 140,140,64
buffer_load_dwordx4 v114, s[12:15], s49 offen offset:1024 lds
Mvaa 144,128,68
Vc 4,62,63
v_lshlrev_b32 v62, 16, v4
Mvaa 148,132,68
v_and_b32 v63, 0xffff0000, v4
Vc 5,64,65
Mvaa 152,136,68
buffer_load_dwordx4 v114, s[12:15], s50 offen offset:2048 lds
Mvaa 156,140,68
Ta 148,116,12288
Ta 150,116,14336
Mvaa 160,128,72
buffer_load_dwordx4 v114, s[12:15], s51 offen offset:3072 lds
Mvaa 164,132,72
v_add_u32 v114, 65536, v114
Mvaa 168,136,72
v_lshlrev_b32_e64 v64, 16, v5
v_and_b32 v65, 0xffff0000, v5
Mvaa 172,140,72
buffer_load_dwordx4 a[32:35], v112, s[8:11], s52 offen offset:0 sc1
Mvaa 176,128,76
Ta 152,117,12288
Ta 154,117,14336
Mvaa 180,132,76
buffer_load_dwordx4 a[36:39], v112, s[8:11], s52 offen offset:1024 sc1
Mvaa 184,136,76
Vm 58,58,39
Vm 59,59,39
Mvaa 188,140,76
Vm 60,60,39
Vm 61,61,39
Mvaa 192,128,80
buffer_load_dwordx4 a[40:43], v112, s[8:11], s52 offen offset:2048 sc1
Mvaa 196,132,80
Ta 156,118,12288
Ta 158,118,14336
Mvaa 200,136,80
buffer_load_dwordx4 a[44:47], v112, s[8:11], s52 offen offset:3072 sc1
Mvaa 204,140,80
Vm 62,62,39
Vm 63,63,39
Mvaa 208,128,84
Vm 64,64,39
Vm 65,65,39
Mvaa 212,132,84
buffer_load_dwordx4 a[48:51], v113, s[8:11], s52 offen offset:0 sc1
Mvaa 216,136,84
Vc 2,58,59
v_lshlrev_b32_e64 v58, 16, v2
Mvaa 220,140,84
buffer_load_dwordx4 a[52:55], v113, s[8:11], s52 offen offset:1024 sc1
Mvaa 224,128,88
v_and_b32 v59, 0xffff0000, v2
Vc 3,60,61
Mvaa 228,132,88
v_lshlrev_b32_e64 v60, 16, v3
v_and_b32 v61, 0xffff0000, v3
Mvaa 232,136,88
buffer_load_dwordx4 a[56:59], v113, s[8:11], s52 offen offset:2048 sc1
Mvaa 236,140,88
Vc 4,62,63
v_lshlrev_b32_e64 v62, 16, v4
Mvaa 240,128,92
buffer_load_dwordx4 a[60:63], v113, s[8:11], s52 offen offset:3072 sc1
Mvaa 244,132,92
s_add_u32 s52, s52, 8192
Mvaa 248,136,92
v_and_b32 v63, 0xffff0000, v4
Vc 5,64,65
Mvaa 252,140,92
v_lshlrev_b32_e64 v64, 16, v5
v_and_b32 v65, 0xffff0000, v5
s_waitcnt vmcnt(24) lgkmcnt(0)
Mvaa 128,144,96
s_add_u32 m0, s35, 12288
Mvaa 132,148,96
buffer_load_dwordx4 v114, s[12:15], s48 offen offset:0 lds
Mvaa 136,152,96
Ta 128,115,0
Ta 130,115,2048
Mvaa 140,156,96
buffer_load_dwordx4 v114, s[12:15], s49 offen offset:1024 lds
Mvaa 144,144,100
v_mul_f32 v2, 0xbfb8aa3b, v58
v_mul_f32 v3, 0xbfb8aa3b, v59
Mvaa 148,148,100
v_mul_f32 v4, 0xbfb8aa3b, v60
v_mul_f32 v5, 0xbfb8aa3b, v61
Mvaa 152,152,100
buffer_load_dwordx4 v114, s[12:15], s50 offen offset:2048 lds
Mvaa 156,156,100
Ta 132,116,0
Ta 134,116,2048
Mvaa 160,144,104
buffer_load_dwordx4 v114, s[12:15], s51 offen offset:3072 lds
Mvaa 164,148,104
v_add_u32 v114, 65536, v114
Mvaa 168,152,104
v_mul_f32 v6, 0xbfb8aa3b, v62
v_mul_f32 v7, 0xbfb8aa3b, v63
Mvaa 172,156,104
buffer_load_dwordx4 a[64:67], v112, s[8:11], s52 offen offset:0 sc1
Mvaa 176,144,108
Ta 136,117,0
Ta 138,117,2048
Mvaa 180,148,108
buffer_load_dwordx4 a[68:71], v112, s[8:11], s52 offen offset:1024 sc1
Mvaa 184,152,108
v_mul_f32 v8, 0xbfb8aa3b, v64
v_mul_f32 v9, 0xbfb8aa3b, v65
Mvaa 188,156,108
Ve 2,2
Mvaa 192,144,112
buffer_load_dwordx4 a[72:75], v112, s[8:11], s52 offen offset:2048 sc1
Mvaa 196,148,112
Ta 140,118,0
Ta 142,118,2048
Mvaa 200,152,112
buffer_load_dwordx4 a[76:79], v112, s[8:11], s52 offen offset:3072 sc1
Mvaa 204,156,112
VE 3,3
Mvaa 208,144,116
VE 4,4
Mvaa 212,148,116
buffer_load_dwordx4 a[80:83], v113, s[8:11], s52 offen offset:0 sc1
Mvaa 216,152,116
VE 5,5
Mvaa 220,156,116
buffer_load_dwordx4 a[84:87], v113, s[8:11], s52 offen offset:1024 sc1
Mvaa 224,144,120
VE 6,6
Mvaa 228,148,120
VE 7,7
Mvaa 232,152,120
buffer_load_dwordx4 a[88:91], v113, s[8:11], s52 offen offset:2048 sc1
Mvaa 236,156,120
VE 8,8
Mvaa 240,144,124
buffer_load_dwordx4 a[92:95], v113, s[8:11], s52 offen offset:3072 sc1
Mvaa 244,148,124
s_add_u32 s52, s52, 8192
Mvaa 248,152,124
VE 9,9
Mvaa 252,156,124
v_add_f32 v2, 1.0, v2
v_add_f32 v3, 1.0, v3
s_waitcnt vmcnt(24) lgkmcnt(0)
Mvaa 128,128,0
s_add_u32 m0, s35, 0
Mvaa 132,132,0
buffer_load_dwordx4 v114, s[12:15], s48 offen offset:0 lds
Mvaa 136,136,0
Ta 144,115,4096
Ta 146,115,6144
Mvaa 140,140,0
buffer_load_dwordx4 v114, s[12:15], s49 offen offset:1024 lds
Mvaa 144,128,4
v_add_f32 v4, 1.0, v4
v_add_f32 v5, 1.0, v5
Mvaa 148,132,4
v_add_f32 v6, 1.0, v6
v_add_f32 v7, 1.0, v7
Mvaa 152,136,4
buffer_load_dwordx4 v114, s[12:15], s50 offen offset:2048 lds
Mvaa 156,140,4
Ta 148,116,4096
Ta 150,116,6144
Mvaa 160,128,8
buffer_load_dwordx4 v114, s[12:15], s51 offen offset:3072 lds
Mvaa 164,132,8
v_add_u32 v114, 65536, v114
Mvaa 168,136,8
v_add_f32 v8, 1.0, v8
v_add_f32 v9, 1.0, v9
Mvaa 172,140,8
buffer_load_dwordx4 a[96:99], v112, s[8:11], s52 offen offset:0 sc1
Mvaa 176,128,12
Ta 152,117,4096
Ta 154,117,6144
Mvaa 180,132,12
buffer_load_dwordx4 a[100:103], v112, s[8:11], s52 offen offset:1024 sc1
Mvaa 184,136,12
v_rcp_f32_e64 v2, v2
Mvaa 188,140,12
v_rcp_f32_e64 v3, v3
Mvaa 192,128,16
buffer_load_dwordx4 a[104:107], v112, s[8:11], s52 offen offset:2048 sc1
Mvaa 196,132,16
Ta 156,118,4096
Ta 158,118,6144
Mvaa 200,136,16
buffer_load_dwordx4 a[108:111], v112, s[8:11], s52 offen offset:3072 sc1
Mvaa 204,140,16
v_rcp_f32_e64 v4, v4
Mvaa 208,128,20
s_cmp_ge_u32 s2, 144
s_cbranch_scc1 L_f2E
L_f2Er:
Mvaa 212,132,20
buffer_load_dwordx4 a[112:115], v113, s[8:11], s52 offen offset:0 sc1
Mvaa 216,136,20
v_rcp_f32 v5, v5
Mvaa 220,140,20
buffer_load_dwordx4 a[116:119], v113, s[8:11], s52 offen offset:1024 sc1
Mvaa 224,128,24
v_rcp_f32_e64 v6, v6
Mvaa 228,132,24
v_rcp_f32_e64 v7, v7
Mvaa 232,136,24
buffer_load_dwordx4 a[120:123], v113, s[8:11], s52 offen offset:2048 sc1
Mvaa 236,140,24
v_rcp_f32_e64 v8, v8
Mvaa 240,128,28
buffer_load_dwordx4 a[124:127], v113, s[8:11], s52 offen offset:3072 sc1
Mvaa 244,132,28
s_add_u32 s52, s52, 8192
Mvaa 248,136,28
v_rcp_f32_e64 v9, v9
Mvaa 252,140,28
Vm 58,58,2
Vm 59,59,3
s_waitcnt vmcnt(24) lgkmcnt(0)
Mvaa 128,144,32
s_add_u32 m0, s35, 4096
Mvaa 132,148,32
buffer_load_dwordx4 v114, s[12:15], s48 offen offset:0 lds
Mvaa 136,152,32
Ta 128,115,8192
Ta 130,115,10240
Mvaa 140,156,32
buffer_load_dwordx4 v114, s[12:15], s49 offen offset:1024 lds
Mvaa 144,144,36
Vm 60,60,4
v_mul_f32_e64 v61, v61, v5
Mvaa 148,148,36
Vm 62,62,6
Vm 63,63,7
Mvaa 152,152,36
buffer_load_dwordx4 v114, s[12:15], s50 offen offset:2048 lds
Mvaa 156,156,36
Ta 132,116,8192
Ta 134,116,10240
Mvaa 160,144,40
buffer_load_dwordx4 v114, s[12:15], s51 offen offset:3072 lds
Mvaa 164,148,40
v_add_u32 v114, 65536, v114
Mvaa 168,152,40
Vm 64,64,8
Vm 65,65,9
Mvaa 172,156,40
buffer_load_dwordx4 a[0:3], v112, s[8:11], s52 offen offset:0 sc1
Mvaa 176,144,44
Ta 136,117,8192
Ta 138,117,10240
Mvaa 180,148,44
buffer_load_dwordx4 a[4:7], v112, s[8:11], s52 offen offset:1024 sc1
Mvaa 184,152,44
Vc 2,58,59
v_lshlrev_b32_e64 v58, 16, v2
Mvaa 188,156,44
v_and_b32 v59, 0xffff0000, v2
Vc 3,60,61
Mvaa 192,144,48
buffer_load_dwordx4 a[8:11], v112, s[8:11], s52 offen offset:2048 sc1
Mvaa 196,148,48
Ta 140,118,8192
Ta 142,118,10240
Mvaa 200,152,48
buffer_load_dwordx4 a[12:15], v112, s[8:11], s52 offen offset:3072 sc1
Mvaa 204,156,48
v_lshlrev_b32_e64 v60, 16, v3
v_and_b32 v61, 0xffff0000, v3
Mvaa 208,144,52
Vc 4,62,63
v_lshlrev_b32_e64 v62, 16, v4
Mvaa 212,148,52
buffer_load_dwordx4 a[16:19], v113, s[8:11], s52 offen offset:0 sc1
Mvaa 216,152,52
v_and_b32 v63, 0xffff0000, v4
Vc 5,64,65
Mvaa 220,156,52
buffer_load_dwordx4 a[20:23], v113, s[8:11], s52 offen offset:1024 sc1
Mvaa 224,144,56
v_lshlrev_b32_e64 v64, 16, v5
v_and_b32 v65, 0xffff0000, v5
Mvaa 228,148,56
v_lshlrev_b32_e64 v66, 16, v30
v_and_b32 v67, 0xffff0000, v30
Mvaa 232,152,56
buffer_load_dwordx4 a[24:27], v113, s[8:11], s52 offen offset:2048 sc1
Mvaa 236,156,56
v_lshlrev_b32_e64 v68, 16, v31
v_and_b32 v69, 0xffff0000, v31
Mvaa 240,144,60
buffer_load_dwordx4 a[28:31], v113, s[8:11], s52 offen offset:3072 sc1
Mvaa 244,148,60
s_add_u32 s52, s52, 8192
Mvaa 248,152,60
v_lshlrev_b32_e64 v70, 16, v32
v_and_b32 v71, 0xffff0000, v32
Mvaa 252,156,60
v_lshlrev_b32_e64 v72, 16, v33
v_and_b32 v73, 0xffff0000, v33
s_waitcnt vmcnt(24) lgkmcnt(0)
Mvaa 128,128,64
s_add_u32 m0, s35, 8192
Mvaa 132,132,64
buffer_load_dwordx4 v114, s[12:15], s48 offen offset:0 lds
Mvaa 136,136,64
Ta 144,115,12288
Ta 146,115,14336
Mvaa 140,140,64
buffer_load_dwordx4 v114, s[12:15], s49 offen offset:1024 lds
Mvaa 144,128,68
Vs 66,66,40
v_sub_f32_e64 v67, v67, v40
Mvaa 148,132,68
Vs 68,68,40
Vs 69,69,40
Mvaa 152,136,68
buffer_load_dwordx4 v114, s[12:15], s50 offen offset:2048 lds
Mvaa 156,140,68
Ta 148,116,12288
Ta 150,116,14336
Mvaa 160,128,72
buffer_load_dwordx4 v114, s[12:15], s51 offen offset:3072 lds
Mvaa 164,132,72
v_add_u32 v114, 65536, v114
Mvaa 168,136,72
Vs 70,70,40
Vs 71,71,40
Mvaa 172,140,72
buffer_load_dwordx4 a[32:35], v112, s[8:11], s52 offen offset:0 sc1
Mvaa 176,128,76
Ta 152,117,12288
Ta 154,117,14336
Mvaa 180,132,76
buffer_load_dwordx4 a[36:39], v112, s[8:11], s52 offen offset:1024 sc1
Mvaa 184,136,76
Vs 72,72,40
Vs 73,73,40
Mvaa 188,140,76
Vc 2,66,67
v_lshlrev_b32_e64 v66, 16, v2
Mvaa 192,128,80
buffer_load_dwordx4 a[40:43], v112, s[8:11], s52 offen offset:2048 sc1
Mvaa 196,132,80
Ta 156,118,12288
Ta 158,118,14336
Mvaa 200,136,80
buffer_load_dwordx4 a[44:47], v112, s[8:11], s52 offen offset:3072 sc1
Mvaa 204,140,80
v_and_b32 v67, 0xffff0000, v2
Vc 3,68,69
Mvaa 208,128,84
v_lshlrev_b32_e64 v68, 16, v3
v_and_b32 v69, 0xffff0000, v3
Mvaa 212,132,84
buffer_load_dwordx4 a[48:51], v113, s[8:11], s52 offen offset:0 sc1
Mvaa 216,136,84
Vc 4,70,71
v_lshlrev_b32_e64 v70, 16, v4
Mvaa 220,140,84
buffer_load_dwordx4 a[52:55], v113, s[8:11], s52 offen offset:1024 sc1
Mvaa 224,128,88
v_and_b32 v71, 0xffff0000, v4
Vc 5,72,73
Mvaa 228,132,88
v_lshlrev_b32_e64 v72, 16, v5
v_and_b32 v73, 0xffff0000, v5
Mvaa 232,136,88
buffer_load_dwordx4 a[56:59], v113, s[8:11], s52 offen offset:2048 sc1
Mvaa 236,140,88
Vm 66,66,41
Vm 67,67,41
Mvaa 240,128,92
buffer_load_dwordx4 a[60:63], v113, s[8:11], s52 offen offset:3072 sc1
Mvaa 244,132,92
s_add_u32 s52, s52, 8192
Mvaa 248,136,92
Vm 68,68,41
Vm 69,69,41
Mvaa 252,140,92
Vm 70,70,41
Vm 71,71,41
s_waitcnt vmcnt(24) lgkmcnt(0)
Mvaa 128,144,96
s_add_u32 m0, s35, 12288
Mvaa 132,148,96
buffer_load_dwordx4 v114, s[12:15], s48 offen offset:0 lds
Mvaa 136,152,96
Ta 128,115,0
Ta 130,115,2048
Mvaa 140,156,96
buffer_load_dwordx4 v114, s[12:15], s49 offen offset:1024 lds
Mvaa 144,144,100
Vm 72,72,41
v_mul_f32_e64 v73, v73, v41
Mvaa 148,148,100
Vc 2,66,67
v_lshlrev_b32_e64 v66, 16, v2
Mvaa 152,152,100
buffer_load_dwordx4 v114, s[12:15], s50 offen offset:2048 lds
Mvaa 156,156,100
Ta 132,116,0
Ta 134,116,2048
Mvaa 160,144,104
buffer_load_dwordx4 v114, s[12:15], s51 offen offset:3072 lds
Mvaa 164,148,104
v_add_u32 v114, 65536, v114
Mvaa 168,152,104
v_and_b32 v67, 0xffff0000, v2
Vc 3,68,69
Mvaa 172,156,104
buffer_load_dwordx4 a[64:67], v112, s[8:11], s52 offen offset:0 sc1
Mvaa 176,144,108
Ta 136,117,0
Ta 138,117,2048
Mvaa 180,148,108
buffer_load_dwordx4 a[68:71], v112, s[8:11], s52 offen offset:1024 sc1
Mvaa 184,152,108
v_lshlrev_b32_e64 v68, 16, v3
v_and_b32 v69, 0xffff0000, v3
Mvaa 188,156,108
Vc 4,70,71
v_lshlrev_b32_e64 v70, 16, v4
Mvaa 192,144,112
buffer_load_dwordx4 a[72:75], v112, s[8:11], s52 offen offset:2048 sc1
Mvaa 196,148,112
Ta 140,118,0
Ta 142,118,2048
Mvaa 200,152,112
buffer_load_dwordx4 a[76:79], v112, s[8:11], s52 offen offset:3072 sc1
Mvaa 204,156,112
v_and_b32 v71, 0xffff0000, v4
Vc 5,72,73
Mvaa 208,144,116
v_lshlrev_b32_e64 v72, 16, v5
v_and_b32 v73, 0xffff0000, v5
Mvaa 212,148,116
buffer_load_dwordx4 a[80:83], v113, s[8:11], s52 offen offset:0 sc1
Mvaa 216,152,116
v_mul_f32 v2, 0xbfb8aa3b, v66
v_mul_f32 v3, 0xbfb8aa3b, v67
Mvaa 220,156,116
buffer_load_dwordx4 a[84:87], v113, s[8:11], s52 offen offset:1024 sc1
Mvaa 224,144,120
v_mul_f32 v4, 0xbfb8aa3b, v68
v_mul_f32 v5, 0xbfb8aa3b, v69
Mvaa 228,148,120
v_mul_f32 v6, 0xbfb8aa3b, v70
v_mul_f32 v7, 0xbfb8aa3b, v71
Mvaa 232,152,120
buffer_load_dwordx4 a[88:91], v113, s[8:11], s52 offen offset:2048 sc1
Mvaa 236,156,120
v_mul_f32 v8, 0xbfb8aa3b, v72
v_mul_f32 v9, 0xbfb8aa3b, v73
Mvaa 240,144,124
buffer_load_dwordx4 a[92:95], v113, s[8:11], s52 offen offset:3072 sc1
Mvaa 244,148,124
s_add_u32 s52, s52, 8192
Mvaa 248,152,124
VE 2,2
Mvaa 252,156,124
Ve 3,3
s_waitcnt vmcnt(24) lgkmcnt(0)
Mvaa 128,128,0
s_add_u32 m0, s35, 0
Mvaa 132,132,0
buffer_load_dwordx4 v114, s[12:15], s48 offen offset:0 lds
Mvaa 136,136,0
Ta 144,115,4096
Ta 146,115,6144
Mvaa 140,140,0
buffer_load_dwordx4 v114, s[12:15], s49 offen offset:1024 lds
Mvaa 144,128,4
Ve 4,4
Mvaa 148,132,4
VE 5,5
Mvaa 152,136,4
buffer_load_dwordx4 v114, s[12:15], s50 offen offset:2048 lds
Mvaa 156,140,4
Ta 148,116,4096
Ta 150,116,6144
Mvaa 160,128,8
buffer_load_dwordx4 v114, s[12:15], s51 offen offset:3072 lds
Mvaa 164,132,8
v_add_u32 v114, 65536, v114
Mvaa 168,136,8
VE 6,6
Mvaa 172,140,8
buffer_load_dwordx4 a[96:99], v112, s[8:11], s52 offen offset:0 sc1
Mvaa 176,128,12
Ta 152,117,4096
Ta 154,117,6144
Mvaa 180,132,12
buffer_load_dwordx4 a[100:103], v112, s[8:11], s52 offen offset:1024 sc1
Mvaa 184,136,12
VE 7,7
Mvaa 188,140,12
VE 8,8
Mvaa 192,128,16
buffer_load_dwordx4 a[104:107], v112, s[8:11], s52 offen offset:2048 sc1
Mvaa 196,132,16
Ta 156,118,4096
Ta 158,118,6144
Mvaa 200,136,16
buffer_load_dwordx4 a[108:111], v112, s[8:11], s52 offen offset:3072 sc1
Mvaa 204,140,16
VE 9,9
Mvaa 208,128,20
v_add_f32 v2, 1.0, v2
v_add_f32 v3, 1.0, v3
Mvaa 212,132,20
buffer_load_dwordx4 a[112:115], v113, s[8:11], s52 offen offset:0 sc1
Mvaa 216,136,20
v_add_f32 v4, 1.0, v4
v_add_f32 v5, 1.0, v5
Mvaa 220,140,20
buffer_load_dwordx4 a[116:119], v113, s[8:11], s52 offen offset:1024 sc1
Mvaa 224,128,24
v_add_f32 v6, 1.0, v6
v_add_f32 v7, 1.0, v7
Mvaa 228,132,24
v_add_f32 v8, 1.0, v8
v_add_f32 v9, 1.0, v9
Mvaa 232,136,24
buffer_load_dwordx4 a[120:123], v113, s[8:11], s52 offen offset:2048 sc1
Mvaa 236,140,24
v_rcp_f32_e64 v2, v2
Mvaa 240,128,28
buffer_load_dwordx4 a[124:127], v113, s[8:11], s52 offen offset:3072 sc1
Mvaa 244,132,28
s_add_u32 s52, s52, 8192
Mvaa 248,136,28
v_rcp_f32_e64 v3, v3
Mvaa 252,140,28
v_rcp_f32 v4, v4
s_waitcnt vmcnt(24) lgkmcnt(0)
Mvaa 128,144,32
s_add_u32 m0, s35, 4096
Mvaa 132,148,32
buffer_load_dwordx4 v114, s[12:15], s48 offen offset:0 lds
Mvaa 136,152,32
Ta 128,115,8192
Ta 130,115,10240
Mvaa 140,156,32
buffer_load_dwordx4 v114, s[12:15], s49 offen offset:1024 lds
Mvaa 144,144,36
v_rcp_f32_e64 v5, v5
Mvaa 148,148,36
v_rcp_f32_e64 v6, v6
Mvaa 152,152,36
buffer_load_dwordx4 v114, s[12:15], s50 offen offset:2048 lds
Mvaa 156,156,36
Ta 132,116,8192
Ta 134,116,10240
Mvaa 160,144,40
buffer_load_dwordx4 v114, s[12:15], s51 offen offset:3072 lds
Mvaa 164,148,40
v_add_u32 v114, 65536, v114
Mvaa 168,152,40
v_rcp_f32_e64 v7, v7
Mvaa 172,156,40
buffer_load_dwordx4 a[0:3], v112, s[8:11], s52 offen offset:0 sc1
Mvaa 176,144,44
Ta 136,117,8192
Ta 138,117,10240
Mvaa 180,148,44
buffer_load_dwordx4 a[4:7], v112, s[8:11], s52 offen offset:1024 sc1
Mvaa 184,152,44
v_rcp_f32_e64 v8, v8
Mvaa 188,156,44
v_rcp_f32_e64 v9, v9
Mvaa 192,144,48
buffer_load_dwordx4 a[8:11], v112, s[8:11], s52 offen offset:2048 sc1
Mvaa 196,148,48
Ta 140,118,8192
Ta 142,118,10240
Mvaa 200,152,48
buffer_load_dwordx4 a[12:15], v112, s[8:11], s52 offen offset:3072 sc1
Mvaa 204,156,48
Vm 66,66,2
Vm 67,67,3
Mvaa 208,144,52
Vm 68,68,4
Vm 69,69,5
Mvaa 212,148,52
buffer_load_dwordx4 a[16:19], v113, s[8:11], s52 offen offset:0 sc1
Mvaa 216,152,52
Vm 70,70,6
Vm 71,71,7
Mvaa 220,156,52
buffer_load_dwordx4 a[20:23], v113, s[8:11], s52 offen offset:1024 sc1
Mvaa 224,144,56
Vm 72,72,8
Vm 73,73,9
Mvaa 228,148,56
Vc 2,66,67
v_lshlrev_b32_e64 v66, 16, v2
Mvaa 232,152,56
buffer_load_dwordx4 a[24:27], v113, s[8:11], s52 offen offset:2048 sc1
Mvaa 236,156,56
v_and_b32 v67, 0xffff0000, v2
Vc 3,68,69
Mvaa 240,144,60
buffer_load_dwordx4 a[28:31], v113, s[8:11], s52 offen offset:3072 sc1
Mvaa 244,148,60
s_add_u32 s52, s52, 8192
Mvaa 248,152,60
v_lshlrev_b32_e64 v68, 16, v3
v_and_b32 v69, 0xffff0000, v3
Mvaa 252,156,60
Vc 4,70,71
v_lshlrev_b32 v70, 16, v4
s_waitcnt vmcnt(24) lgkmcnt(0)
Mvaa 128,128,64
s_add_u32 m0, s35, 8192
Mvaa 132,132,64
buffer_load_dwordx4 v114, s[12:15], s48 offen offset:0 lds
Mvaa 136,136,64
Ta 144,115,12288
Ta 146,115,14336
Mvaa 140,140,64
buffer_load_dwordx4 v114, s[12:15], s49 offen offset:1024 lds
Mvaa 144,128,68
v_and_b32 v71, 0xffff0000, v4
Vc 5,72,73
Mvaa 148,132,68
v_lshlrev_b32_e64 v72, 16, v5
v_and_b32 v73, 0xffff0000, v5
Mvaa 152,136,68
buffer_load_dwordx4 v114, s[12:15], s50 offen offset:2048 lds
Mvaa 156,140,68
Ta 148,116,12288
Ta 150,116,14336
Mvaa 160,128,72
buffer_load_dwordx4 v114, s[12:15], s51 offen offset:3072 lds
Mvaa 164,132,72
v_add_u32 v114, 65536, v114
Mvaa 168,136,72
Mvaa 172,140,72
buffer_load_dwordx4 a[32:35], v112, s[8:11], s52 offen offset:0 sc1
Mvaa 176,128,76
Ta 152,117,12288
Ta 154,117,14336
Mvaa 180,132,76
buffer_load_dwordx4 a[36:39], v112, s[8:11], s52 offen offset:1024 sc1
Mvaa 184,136,76
Mvaa 188,140,76
Mvaa 192,128,80
buffer_load_dwordx4 a[40:43], v112, s[8:11], s52 offen offset:2048 sc1
Mvaa 196,132,80
Ta 156,118,12288
Ta 158,118,14336
Mvaa 200,136,80
buffer_load_dwordx4 a[44:47], v112, s[8:11], s52 offen offset:3072 sc1
Mvaa 204,140,80
Mvaa 208,128,84
Mvaa 212,132,84
buffer_load_dwordx4 a[48:51], v113, s[8:11], s52 offen offset:0 sc1
Mvaa 216,136,84
Mvaa 220,140,84
buffer_load_dwordx4 a[52:55], v113, s[8:11], s52 offen offset:1024 sc1
Mvaa 224,128,88
Mvaa 228,132,88
Mvaa 232,136,88
buffer_load_dwordx4 a[56:59], v113, s[8:11], s52 offen offset:2048 sc1
Mvaa 236,140,88
Mvaa 240,128,92
buffer_load_dwordx4 a[60:63], v113, s[8:11], s52 offen offset:3072 sc1
Mvaa 244,132,92
s_add_u32 s52, s52, 8192
Mvaa 248,136,92
Mvaa 252,140,92
s_waitcnt vmcnt(24) lgkmcnt(0)
Mvaa 128,144,96
s_add_u32 m0, s35, 12288
Mvaa 132,148,96
buffer_load_dwordx4 v114, s[12:15], s48 offen offset:0 lds
Mvaa 136,152,96
Ta 128,115,0
Ta 130,115,2048
Mvaa 140,156,96
buffer_load_dwordx4 v114, s[12:15], s49 offen offset:1024 lds
Mvaa 144,144,100
Mvaa 148,148,100
Mvaa 152,152,100
buffer_load_dwordx4 v114, s[12:15], s50 offen offset:2048 lds
Mvaa 156,156,100
Ta 132,116,0
Ta 134,116,2048
Mvaa 160,144,104
buffer_load_dwordx4 v114, s[12:15], s51 offen offset:3072 lds
Mvaa 164,148,104
v_add_u32 v114, 65536, v114
Mvaa 168,152,104
Mvaa 172,156,104
buffer_load_dwordx4 a[64:67], v112, s[8:11], s52 offen offset:0 sc1
Mvaa 176,144,108
Ta 136,117,0
Ta 138,117,2048
Mvaa 180,148,108
buffer_load_dwordx4 a[68:71], v112, s[8:11], s52 offen offset:1024 sc1
Mvaa 184,152,108
Mvaa 188,156,108
Mvaa 192,144,112
buffer_load_dwordx4 a[72:75], v112, s[8:11], s52 offen offset:2048 sc1
Mvaa 196,148,112
Ta 140,118,0
Ta 142,118,2048
Mvaa 200,152,112
buffer_load_dwordx4 a[76:79], v112, s[8:11], s52 offen offset:3072 sc1
Mvaa 204,156,112
Mvaa 208,144,116
Mvaa 212,148,116
buffer_load_dwordx4 a[80:83], v113, s[8:11], s52 offen offset:0 sc1
Mvaa 216,152,116
Mvaa 220,156,116
buffer_load_dwordx4 a[84:87], v113, s[8:11], s52 offen offset:1024 sc1
Mvaa 224,144,120
Mvaa 228,148,120
Mvaa 232,152,120
buffer_load_dwordx4 a[88:91], v113, s[8:11], s52 offen offset:2048 sc1
Mvaa 236,156,120
Mvaa 240,144,124
buffer_load_dwordx4 a[92:95], v113, s[8:11], s52 offen offset:3072 sc1
Mvaa 244,148,124
s_add_u32 s52, s52, 8192
Mvaa 248,152,124
Mvaa 252,156,124
s_waitcnt vmcnt(24) lgkmcnt(0)
Mvaa 128,128,0
s_add_u32 m0, s35, 0
Mvaa 132,132,0
buffer_load_dwordx4 v114, s[12:15], s48 offen offset:0 lds
Mvaa 136,136,0
Ta 144,115,4096
Ta 146,115,6144
Mvaa 140,140,0
buffer_load_dwordx4 v114, s[12:15], s49 offen offset:1024 lds
Mvaa 144,128,4
s_cmp_lg_u32 s53, 0
s_cbranch_scc1 L_yA
L_yAr:
Mvaa 148,132,4
Mvaa 152,136,4
buffer_load_dwordx4 v114, s[12:15], s50 offen offset:2048 lds
Mvaa 156,140,4
Ta 148,116,4096
Ta 150,116,6144
Mvaa 160,128,8
buffer_load_dwordx4 v114, s[12:15], s51 offen offset:3072 lds
Mvaa 164,132,8
v_add_u32 v114, 65536, v114
Mvaa 168,136,8
Mvaa 172,140,8
buffer_load_dwordx4 a[96:99], v112, s[8:11], s52 offen offset:0 sc1
Mvaa 176,128,12
Ta 152,117,4096
Ta 154,117,6144
Mvaa 180,132,12
buffer_load_dwordx4 a[100:103], v112, s[8:11], s52 offen offset:1024 sc1
Mvaa 184,136,12
Mvaa 188,140,12
Mvaa 192,128,16
buffer_load_dwordx4 a[104:107], v112, s[8:11], s52 offen offset:2048 sc1
Mvaa 196,132,16
Ta 156,118,4096
Ta 158,118,6144
Mvaa 200,136,16
buffer_load_dwordx4 a[108:111], v112, s[8:11], s52 offen offset:3072 sc1
Mvaa 204,140,16
Mvaa 208,128,20
Mvaa 212,132,20
buffer_load_dwordx4 a[112:115], v113, s[8:11], s52 offen offset:0 sc1
Mvaa 216,136,20
Mvaa 220,140,20
buffer_load_dwordx4 a[116:119], v113, s[8:11], s52 offen offset:1024 sc1
Mvaa 224,128,24
Mvaa 228,132,24
Mvaa 232,136,24
buffer_load_dwordx4 a[120:123], v113, s[8:11], s52 offen offset:2048 sc1
Mvaa 236,140,24
Mvaa 240,128,28
buffer_load_dwordx4 a[124:127], v113, s[8:11], s52 offen offset:3072 sc1
Mvaa 244,132,28
s_add_u32 s52, s52, 8192
Mvaa 248,136,28
Mvaa 252,140,28
s_waitcnt vmcnt(24) lgkmcnt(0)
Mvaa 128,144,32
s_add_u32 m0, s35, 4096
Mvaa 132,148,32
buffer_load_dwordx4 v114, s[12:15], s48 offen offset:0 lds
Mvaa 136,152,32
Ta 128,115,8192
Ta 130,115,10240
Mvaa 140,156,32
buffer_load_dwordx4 v114, s[12:15], s49 offen offset:1024 lds
Mvaa 144,144,36
Mvaa 148,148,36
Mvaa 152,152,36
buffer_load_dwordx4 v114, s[12:15], s50 offen offset:2048 lds
Mvaa 156,156,36
Ta 132,116,8192
Ta 134,116,10240
Mvaa 160,144,40
buffer_load_dwordx4 v114, s[12:15], s51 offen offset:3072 lds
Mvaa 164,148,40
v_add_u32 v114, 65536, v114
Mvaa 168,152,40
Mvaa 172,156,40
buffer_load_dwordx4 a[0:3], v112, s[8:11], s52 offen offset:0 sc1
Mvaa 176,144,44
Ta 136,117,8192
Ta 138,117,10240
Mvaa 180,148,44
buffer_load_dwordx4 a[4:7], v112, s[8:11], s52 offen offset:1024 sc1
Mvaa 184,152,44
Mvaa 188,156,44
Mvaa 192,144,48
buffer_load_dwordx4 a[8:11], v112, s[8:11], s52 offen offset:2048 sc1
Mvaa 196,148,48
Ta 140,118,8192
Ta 142,118,10240
Mvaa 200,152,48
buffer_load_dwordx4 a[12:15], v112, s[8:11], s52 offen offset:3072 sc1
Mvaa 204,156,48
Mvaa 208,144,52
Mvaa 212,148,52
buffer_load_dwordx4 a[16:19], v113, s[8:11], s52 offen offset:0 sc1
Mvaa 216,152,52
Mvaa 220,156,52
buffer_load_dwordx4 a[20:23], v113, s[8:11], s52 offen offset:1024 sc1
Mvaa 224,144,56
Mvaa 228,148,56
Mvaa 232,152,56
buffer_load_dwordx4 a[24:27], v113, s[8:11], s52 offen offset:2048 sc1
Mvaa 236,156,56
Mvaa 240,144,60
buffer_load_dwordx4 a[28:31], v113, s[8:11], s52 offen offset:3072 sc1
Mvaa 244,148,60
s_add_u32 s52, s52, 8192
Mvaa 248,152,60
Mvaa 252,156,60
s_waitcnt vmcnt(24) lgkmcnt(0)
Mvaa 128,128,64
s_add_u32 m0, s35, 8192
Mvaa 132,132,64
buffer_load_dwordx4 v114, s[12:15], s48 offen offset:0 lds
Mvaa 136,136,64
Ta 144,115,12288
Ta 146,115,14336
Mvaa 140,140,64
buffer_load_dwordx4 v114, s[12:15], s49 offen offset:1024 lds
Mvaa 144,128,68
Mvaa 148,132,68
Mvaa 152,136,68
buffer_load_dwordx4 v114, s[12:15], s50 offen offset:2048 lds
Mvaa 156,140,68
Ta 148,116,12288
Ta 150,116,14336
Mvaa 160,128,72
buffer_load_dwordx4 v114, s[12:15], s51 offen offset:3072 lds
Mvaa 164,132,72
v_add_u32 v114, 65536, v114
Mvaa 168,136,72
Mvaa 172,140,72
buffer_load_dwordx4 a[32:35], v112, s[8:11], s52 offen offset:0 sc1
Mvaa 176,128,76
Ta 152,117,12288
Ta 154,117,14336
Mvaa 180,132,76
buffer_load_dwordx4 a[36:39], v112, s[8:11], s52 offen offset:1024 sc1
Mvaa 184,136,76
Mvaa 188,140,76
Mvaa 192,128,80
buffer_load_dwordx4 a[40:43], v112, s[8:11], s52 offen offset:2048 sc1
Mvaa 196,132,80
Ta 156,118,12288
Ta 158,118,14336
Mvaa 200,136,80
buffer_load_dwordx4 a[44:47], v112, s[8:11], s52 offen offset:3072 sc1
Mvaa 204,140,80
Mvaa 208,128,84
Mvaa 212,132,84
buffer_load_dwordx4 a[48:51], v113, s[8:11], s52 offen offset:0 sc1
Mvaa 216,136,84
Mvaa 220,140,84
buffer_load_dwordx4 a[52:55], v113, s[8:11], s52 offen offset:1024 sc1
Mvaa 224,128,88
Mvaa 228,132,88
Mvaa 232,136,88
buffer_load_dwordx4 a[56:59], v113, s[8:11], s52 offen offset:2048 sc1
Mvaa 236,140,88
Mvaa 240,128,92
buffer_load_dwordx4 a[60:63], v113, s[8:11], s52 offen offset:3072 sc1
Mvaa 244,132,92
s_add_u32 s52, s52, 8192
Mvaa 248,136,92
Mvaa 252,140,92
s_waitcnt vmcnt(24) lgkmcnt(0)
Mvaa 128,144,96
s_add_u32 m0, s35, 12288
Mvaa 132,148,96
buffer_load_dwordx4 v114, s[12:15], s48 offen offset:0 lds
Mvaa 136,152,96
Ta 128,115,0
Ta 130,115,2048
Mvaa 140,156,96
buffer_load_dwordx4 v114, s[12:15], s49 offen offset:1024 lds
Mvaa 144,144,100
Mvaa 148,148,100
Mvaa 152,152,100
buffer_load_dwordx4 v114, s[12:15], s50 offen offset:2048 lds
Mvaa 156,156,100
Ta 132,116,0
Ta 134,116,2048
Mvaa 160,144,104
buffer_load_dwordx4 v114, s[12:15], s51 offen offset:3072 lds
Mvaa 164,148,104
v_add_u32 v114, 65536, v114
Mvaa 168,152,104
s_cmp_lg_u32 s53, 0
s_cbranch_scc1 L_yB
L_yBr:
Mvaa 172,156,104
buffer_load_dwordx4 a[64:67], v112, s[8:11], s52 offen offset:0 sc1
Mvaa 176,144,108
Ta 136,117,0
Ta 138,117,2048
Mvaa 180,148,108
buffer_load_dwordx4 a[68:71], v112, s[8:11], s52 offen offset:1024 sc1
Mvaa 184,152,108
Mvaa 188,156,108
Mvaa 192,144,112
buffer_load_dwordx4 a[72:75], v112, s[8:11], s52 offen offset:2048 sc1
Mvaa 196,148,112
Ta 140,118,0
Ta 142,118,2048
Mvaa 200,152,112
buffer_load_dwordx4 a[76:79], v112, s[8:11], s52 offen offset:3072 sc1
Mvaa 204,156,112
Mvaa 208,144,116
Mvaa 212,148,116
buffer_load_dwordx4 a[80:83], v113, s[8:11], s52 offen offset:0 sc1
Mvaa 216,152,116
Mvaa 220,156,116
buffer_load_dwordx4 a[84:87], v113, s[8:11], s52 offen offset:1024 sc1
Mvaa 224,144,120
Mvaa 228,148,120
Mvaa 232,152,120
buffer_load_dwordx4 a[88:91], v113, s[8:11], s52 offen offset:2048 sc1
Mvaa 236,156,120
Mvaa 240,144,124
buffer_load_dwordx4 a[92:95], v113, s[8:11], s52 offen offset:3072 sc1
Mvaa 244,148,124
s_add_u32 s52, s52, 8192
Mvaa 248,152,124
Mvaa 252,156,124
s_waitcnt vmcnt(24) lgkmcnt(0)
Mvaa 128,128,0
Mvaa 132,132,0
buffer_load_dwordx4 a[96:99], v112, s[8:11], s52 offen offset:0 sc1
Mvaa 136,136,0
Ta 144,115,4096
Ta 146,115,6144
Mvaa 140,140,0
buffer_load_dwordx4 a[100:103], v112, s[8:11], s52 offen offset:1024 sc1
Mvaa 144,128,4
Mvaa 148,132,4
Mvaa 152,136,4
buffer_load_dwordx4 a[104:107], v112, s[8:11], s52 offen offset:2048 sc1
Mvaa 156,140,4
Ta 148,116,4096
Ta 150,116,6144
Mvaa 160,128,8
buffer_load_dwordx4 a[108:111], v112, s[8:11], s52 offen offset:3072 sc1
Mvaa 164,132,8
Mvaa 168,136,8
Mvaa 172,140,8
buffer_load_dwordx4 a[112:115], v113, s[8:11], s52 offen offset:0 sc1
Mvaa 176,128,12
Ta 152,117,4096
Ta 154,117,6144
Mvaa 180,132,12
buffer_load_dwordx4 a[116:119], v113, s[8:11], s52 offen offset:1024 sc1
Mvaa 184,136,12
Mvaa 188,140,12
Mvaa 192,128,16
buffer_load_dwordx4 a[120:123], v113, s[8:11], s52 offen offset:2048 sc1
Mvaa 196,132,16
Ta 156,118,4096
Ta 158,118,6144
Mvaa 200,136,16
buffer_load_dwordx4 a[124:127], v113, s[8:11], s52 offen offset:3072 sc1
Mvaa 204,140,16
s_add_u32 s52, s52, 8192
Mvaa 208,128,20
Mvaa 212,132,20
Mvaa 216,136,20
Mvaa 220,140,20
Mvaa 224,128,24
Mvaa 228,132,24
Mvaa 232,136,24
Mvaa 236,140,24
Mvaa 240,128,28
Mvaa 244,132,28
Mvaa 248,136,28
Mvaa 252,140,28
s_waitcnt vmcnt(20) lgkmcnt(0)
Mvaa 128,144,32
Mvaa 132,148,32
Mvaa 136,152,32
Ta 128,115,8192
Ta 130,115,10240
Mvaa 140,156,32
Mvaa 144,144,36
Mvaa 148,148,36
Mvaa 152,152,36
Mvaa 156,156,36
Ta 132,116,8192
Ta 134,116,10240
Mvaa 160,144,40
Mvaa 164,148,40
Mvaa 168,152,40
Mvaa 172,156,40
Mvaa 176,144,44
Ta 136,117,8192
Ta 138,117,10240
Mvaa 180,148,44
Mvaa 184,152,44
Mvaa 188,156,44
Mvaa 192,144,48
Mvaa 196,148,48
Ta 140,118,8192
Ta 142,118,10240
Mvaa 200,152,48
Mvaa 204,156,48
Mvaa 208,144,52
Mvaa 212,148,52
Mvaa 216,152,52
Mvaa 220,156,52
Mvaa 224,144,56
Mvaa 228,148,56
Mvaa 232,152,56
Mvaa 236,156,56
Mvaa 240,144,60
Mvaa 244,148,60
Mvaa 248,152,60
Mvaa 252,156,60
s_waitcnt vmcnt(8) lgkmcnt(0)
Mvaa 128,128,64
Mvaa 132,132,64
Mvaa 136,136,64
Ta 144,115,12288
Ta 146,115,14336
Mvaa 140,140,64
Mvaa 144,128,68
Mvaa 148,132,68
Mvaa 152,136,68
Mvaa 156,140,68
Ta 148,116,12288
Ta 150,116,14336
Mvaa 160,128,72
Mvaa 164,132,72
Mvaa 168,136,72
Mvaa 172,140,72
Mvaa 176,128,76
Ta 152,117,12288
Ta 154,117,14336
Mvaa 180,132,76
s_cmp_lg_u32 s40, 0
s_cbranch_scc1 L_yC
L_yCr:
Mvaa 184,136,76
Mvaa 188,140,76
Mvaa 192,128,80
Mvaa 196,132,80
Ta 156,118,12288
Ta 158,118,14336
Mvaa 200,136,80
Mvaa 204,140,80
Mvaa 208,128,84
Mvaa 212,132,84
Mvaa 216,136,84
Mvaa 220,140,84
Mvaa 224,128,88
Mvaa 228,132,88
Mvaa 232,136,88
Mvaa 236,140,88
Mvaa 240,128,92
Mvaa 244,132,92
Mvaa 248,136,92
Mvaa 252,140,92
s_waitcnt vmcnt(0) lgkmcnt(0)
Mvaa 128,144,96
Mvaa 132,148,96
Mvaa 136,152,96
Mvaa 140,156,96
Mvaa 144,144,100
Mvaa 148,148,100
Mvaa 152,152,100
Mvaa 156,156,100
Mvaa 160,144,104
Mvaa 164,148,104
Mvaa 168,152,104
Mvaa 172,156,104
Mvaa 176,144,108
Mvaa 180,148,108
Mvaa 184,152,108
Mvaa 188,156,108
Mvaa 192,144,112
Mvaa 196,148,112
Mvaa 200,152,112
Mvaa 204,156,112
Mvaa 208,144,116
Mvaa 212,148,116
Mvaa 216,152,116
Mvaa 220,156,116
Mvaa 224,144,120
Mvaa 228,148,120
Mvaa 232,152,120
Mvaa 236,156,120
Mvaa 240,144,124
Mvaa 244,148,124
Mvaa 248,152,124
Mvaa 252,156,124
v_and_b32 v124, 15, v0
v_lshlrev_b32 v10, 8, v124
v_add_u32 v10, s35, v10
v_xor_b32 v124, v124, v121
v_xor_b32_e64 v125, 0, v124
v_lshl_add_u32 v115, v125, 4, v10
v_xor_b32_e64 v125, 4, v124
v_lshl_add_u32 v116, v125, 4, v10
v_xor_b32_e64 v125, 8, v124
v_lshl_add_u32 v117, v125, 4, v10
v_xor_b32_e64 v125, 12, v124
v_lshl_add_u32 v118, v125, 4, v10
ds_write_b128 v115, v[128:131] offset:0
ds_write_b128 v116, v[132:135] offset:0
ds_write_b128 v117, v[136:139] offset:0
ds_write_b128 v118, v[140:143] offset:0
ds_write_b128 v115, v[144:147] offset:4096
ds_write_b128 v116, v[148:151] offset:4096
ds_write_b128 v117, v[152:155] offset:4096
ds_write_b128 v118, v[156:159] offset:4096
ds_write_b128 v115, v[160:163] offset:8192
ds_write_b128 v116, v[164:167] offset:8192
ds_write_b128 v117, v[168:171] offset:8192
ds_write_b128 v118, v[172:175] offset:8192
ds_write_b128 v115, v[176:179] offset:12288
ds_write_b128 v116, v[180:183] offset:12288
ds_write_b128 v117, v[184:187] offset:12288
s_waitcnt lgkmcnt(9)
s_nop 0
ds_write_b128 v118, v[188:191] offset:12288
ds_write_b128 v115, v[192:195] offset:16384
ds_write_b128 v116, v[196:199] offset:16384
ds_write_b128 v117, v[200:203] offset:16384
ds_write_b128 v118, v[204:207] offset:16384
ds_write_b128 v115, v[208:211] offset:20480
s_waitcnt lgkmcnt(9)
s_nop 0
ds_write_b128 v116, v[212:215] offset:20480
ds_write_b128 v117, v[216:219] offset:20480
ds_write_b128 v118, v[220:223] offset:20480
ds_write_b128 v115, v[224:227] offset:24576
ds_write_b128 v116, v[228:231] offset:24576
ds_write_b128 v117, v[232:235] offset:24576
s_waitcnt lgkmcnt(9)
ds_write_b128 v118, v[236:239] offset:24576
ds_write_b128 v115, v[240:243] offset:28672
ds_write_b128 v116, v[244:247] offset:28672
ds_write_b128 v117, v[248:251] offset:28672
ds_write_b128 v118, v[252:255] offset:28672
s_cmp_lg_u32 s53, s40
s_cbranch_scc1 L_ysl
L_yslr:
v_and_b32 v124, 15, v120
v_lshlrev_b32 v125, 1, v122
v_xor_b32 v124, v124, v125
v_lshlrev_b32_e64 v10, 8, v120
v_lshl_add_u32 v12, v124, 4, v10
v_xor_b32_e64 v13, 16, v12
v_add_u32 v14, 65536, v12
v_add_u32 v15, 65536, v13
v_lshlrev_b32_e64 v80, 16, v18
v_and_b32 v81, 0xffff0000, v18
v_lshlrev_b32_e64 v82, 16, v19
v_and_b32 v83, 0xffff0000, v19
v_lshlrev_b32_e64 v84, 16, v20
v_and_b32 v85, 0xffff0000, v20
v_lshlrev_b32_e64 v86, 16, v21
v_and_b32 v87, 0xffff0000, v21
v_lshlrev_b32_e64 v88, 16, v22
v_and_b32 v89, 0xffff0000, v22
v_lshlrev_b32_e64 v90, 16, v23
v_and_b32 v91, 0xffff0000, v23
v_lshlrev_b32_e64 v92, 16, v24
v_and_b32 v93, 0xffff0000, v24
v_lshlrev_b32_e64 v94, 16, v25
v_and_b32 v95, 0xffff0000, v25
v_lshlrev_b32_e64 v96, 16, v26
v_and_b32 v97, 0xffff0000, v26
v_lshlrev_b32_e64 v98, 16, v27
v_and_b32 v99, 0xffff0000, v27
v_lshlrev_b32_e64 v100, 16, v28
v_and_b32 v101, 0xffff0000, v28
v_lshlrev_b32_e64 v102, 16, v29
v_and_b32 v103, 0xffff0000, v29
v_lshlrev_b32_e64 v104, 16, v30
v_and_b32 v105, 0xffff0000, v30
v_lshlrev_b32_e64 v106, 16, v31
v_and_b32 v107, 0xffff0000, v31
v_lshlrev_b32_e64 v108, 16, v32
v_and_b32 v109, 0xffff0000, v32
v_lshlrev_b32_e64 v110, 16, v33
v_and_b32 v111, 0xffff0000, v33
s_waitcnt lgkmcnt(0)
s_barrier
Rv 128,12,0
Rv 132,13,0
Rv 136,12,32768
Rv 140,13,32768
Rv 144,14,0
Rv 148,15,0
Rv 152,14,32768
Rv 156,15,32768
s_waitcnt lgkmcnt(0)
s_nop 0
Rv 160,12,8192
Rv 164,13,8192
Rv 168,12,40960
Rv 172,13,40960
Rv 176,14,8192
Rv 180,15,8192
Rv 184,14,40960
Rv 188,15,40960
v_pk_add_f32 v[128:129], v[128:129], v[136:137]
v_pk_add_f32 v[144:145], v[144:145], v[152:153]
v_pk_add_f32 v[130:131], v[130:131], v[138:139]
v_pk_add_f32 v[146:147], v[146:147], v[154:155]
v_pk_add_f32 v[132:133], v[132:133], v[140:141]
v_pk_add_f32 v[148:149], v[148:149], v[156:157]
v_pk_add_f32 v[134:135], v[134:135], v[142:143]
v_pk_add_f32 v[150:151], v[150:151], v[158:159]
v_pk_add_f32 v[128:129], v[128:129], v[144:145]
v_pk_add_f32 v[130:131], v[130:131], v[146:147]
v_pk_add_f32 v[132:133], v[132:133], v[148:149]
v_pk_add_f32 v[134:135], v[134:135], v[150:151]
Vc 136,128,129
v_lshlrev_b32_e64 v128, 16, v136
v_and_b32 v129, 0xffff0000, v136
Vc 137,130,131
v_lshlrev_b32_e64 v130, 16, v137
v_and_b32 v131, 0xffff0000, v137
Vc 138,132,133
v_lshlrev_b32_e64 v132, 16, v138
v_and_b32 v133, 0xffff0000, v138
Vc 139,134,135
v_lshlrev_b32_e64 v134, 16, v139
v_and_b32 v135, 0xffff0000, v139
v_pk_mul_f32 v[128:129], v[128:129], v[42:43]
v_pk_mul_f32 v[130:131], v[130:131], v[44:45]
v_pk_mul_f32 v[132:133], v[132:133], v[46:47]
v_pk_mul_f32 v[134:135], v[134:135], v[48:49]
Vc 136,128,129
v_lshlrev_b32_e64 v128, 16, v136
v_and_b32 v129, 0xffff0000, v136
Vc 137,130,131
v_lshlrev_b32_e64 v130, 16, v137
v_and_b32 v131, 0xffff0000, v137
Vc 138,132,133
v_lshlrev_b32_e64 v132, 16, v138
v_and_b32 v133, 0xffff0000, v138
Vc 139,134,135
v_lshlrev_b32_e64 v134, 16, v139
v_and_b32 v135, 0xffff0000, v139
v_pk_add_f32 v[128:129], v[128:129], v[80:81]
v_pk_add_f32 v[130:131], v[130:131], v[82:83]
v_pk_add_f32 v[132:133], v[132:133], v[84:85]
v_pk_add_f32 v[134:135], v[134:135], v[86:87]
Vc 136,128,129
Vc 137,130,131
Vc 138,132,133
Vc 139,134,135
buffer_store_dwordx4 v[136:139], v119, s[68:71], s36 offen sc1
s_add_u32 s36, s36, 65536
s_waitcnt lgkmcnt(0)
s_nop 0
Rv 192,12,16384
Rv 196,13,16384
Rv 200,12,49152
Rv 204,13,49152
Rv 208,14,16384
Rv 212,15,16384
Rv 216,14,49152
Rv 220,15,49152
v_pk_add_f32 v[160:161], v[160:161], v[168:169]
v_pk_add_f32 v[176:177], v[176:177], v[184:185]
v_pk_add_f32 v[162:163], v[162:163], v[170:171]
v_pk_add_f32 v[178:179], v[178:179], v[186:187]
v_pk_add_f32 v[164:165], v[164:165], v[172:173]
v_pk_add_f32 v[180:181], v[180:181], v[188:189]
v_pk_add_f32 v[166:167], v[166:167], v[174:175]
v_pk_add_f32 v[182:183], v[182:183], v[190:191]
v_pk_add_f32 v[160:161], v[160:161], v[176:177]
v_pk_add_f32 v[162:163], v[162:163], v[178:179]
v_pk_add_f32 v[164:165], v[164:165], v[180:181]
v_pk_add_f32 v[166:167], v[166:167], v[182:183]
Vc 168,160,161
v_lshlrev_b32_e64 v160, 16, v168
v_and_b32 v161, 0xffff0000, v168
Vc 169,162,163
v_lshlrev_b32_e64 v162, 16, v169
v_and_b32 v163, 0xffff0000, v169
Vc 170,164,165
v_lshlrev_b32_e64 v164, 16, v170
v_and_b32 v165, 0xffff0000, v170
Vc 171,166,167
v_lshlrev_b32_e64 v166, 16, v171
v_and_b32 v167, 0xffff0000, v171
v_pk_mul_f32 v[160:161], v[160:161], v[50:51]
v_pk_mul_f32 v[162:163], v[162:163], v[52:53]
v_pk_mul_f32 v[164:165], v[164:165], v[54:55]
v_pk_mul_f32 v[166:167], v[166:167], v[56:57]
Vc 168,160,161
v_lshlrev_b32_e64 v160, 16, v168
v_and_b32 v161, 0xffff0000, v168
Vc 169,162,163
v_lshlrev_b32_e64 v162, 16, v169
v_and_b32 v163, 0xffff0000, v169
Vc 170,164,165
v_lshlrev_b32_e64 v164, 16, v170
v_and_b32 v165, 0xffff0000, v170
Vc 171,166,167
v_lshlrev_b32_e64 v166, 16, v171
v_and_b32 v167, 0xffff0000, v171
v_pk_add_f32 v[160:161], v[160:161], v[88:89]
v_pk_add_f32 v[162:163], v[162:163], v[90:91]
v_pk_add_f32 v[164:165], v[164:165], v[92:93]
v_pk_add_f32 v[166:167], v[166:167], v[94:95]
Vc 168,160,161
Vc 169,162,163
Vc 170,164,165
Vc 171,166,167
buffer_store_dwordx4 v[168:171], v119, s[68:71], s36 offen sc1
s_add_u32 s36, s36, 65536
s_waitcnt lgkmcnt(0)
s_nop 0
Rv 224,12,24576
Rv 228,13,24576
Rv 232,12,57344
Rv 236,13,57344
Rv 240,14,24576
Rv 244,15,24576
Rv 248,14,57344
Rv 252,15,57344
v_pk_add_f32 v[192:193], v[192:193], v[200:201]
v_pk_add_f32 v[208:209], v[208:209], v[216:217]
v_pk_add_f32 v[194:195], v[194:195], v[202:203]
v_pk_add_f32 v[210:211], v[210:211], v[218:219]
v_pk_add_f32 v[196:197], v[196:197], v[204:205]
v_pk_add_f32 v[212:213], v[212:213], v[220:221]
v_pk_add_f32 v[198:199], v[198:199], v[206:207]
v_pk_add_f32 v[214:215], v[214:215], v[222:223]
v_pk_add_f32 v[192:193], v[192:193], v[208:209]
v_pk_add_f32 v[194:195], v[194:195], v[210:211]
v_pk_add_f32 v[196:197], v[196:197], v[212:213]
v_pk_add_f32 v[198:199], v[198:199], v[214:215]
Vc 200,192,193
v_lshlrev_b32_e64 v192, 16, v200
v_and_b32 v193, 0xffff0000, v200
Vc 201,194,195
v_lshlrev_b32_e64 v194, 16, v201
v_and_b32 v195, 0xffff0000, v201
Vc 202,196,197
v_lshlrev_b32_e64 v196, 16, v202
v_and_b32 v197, 0xffff0000, v202
Vc 203,198,199
v_lshlrev_b32_e64 v198, 16, v203
v_and_b32 v199, 0xffff0000, v203
v_pk_mul_f32 v[192:193], v[192:193], v[58:59]
v_pk_mul_f32 v[194:195], v[194:195], v[60:61]
v_pk_mul_f32 v[196:197], v[196:197], v[62:63]
v_pk_mul_f32 v[198:199], v[198:199], v[64:65]
Vc 200,192,193
v_lshlrev_b32_e64 v192, 16, v200
v_and_b32 v193, 0xffff0000, v200
Vc 201,194,195
v_lshlrev_b32_e64 v194, 16, v201
v_and_b32 v195, 0xffff0000, v201
Vc 202,196,197
v_lshlrev_b32_e64 v196, 16, v202
v_and_b32 v197, 0xffff0000, v202
Vc 203,198,199
v_lshlrev_b32_e64 v198, 16, v203
v_and_b32 v199, 0xffff0000, v203
v_pk_add_f32 v[192:193], v[192:193], v[96:97]
v_pk_add_f32 v[194:195], v[194:195], v[98:99]
v_pk_add_f32 v[196:197], v[196:197], v[100:101]
v_pk_add_f32 v[198:199], v[198:199], v[102:103]
Vc 200,192,193
Vc 201,194,195
Vc 202,196,197
Vc 203,198,199
buffer_store_dwordx4 v[200:203], v119, s[68:71], s36 offen sc1
s_add_u32 s36, s36, 65536
s_waitcnt lgkmcnt(0)
s_nop 0
v_pk_add_f32 v[224:225], v[224:225], v[232:233]
v_pk_add_f32 v[240:241], v[240:241], v[248:249]
v_pk_add_f32 v[226:227], v[226:227], v[234:235]
v_pk_add_f32 v[242:243], v[242:243], v[250:251]
v_pk_add_f32 v[228:229], v[228:229], v[236:237]
v_pk_add_f32 v[244:245], v[244:245], v[252:253]
v_pk_add_f32 v[230:231], v[230:231], v[238:239]
v_pk_add_f32 v[246:247], v[246:247], v[254:255]
v_pk_add_f32 v[224:225], v[224:225], v[240:241]
v_pk_add_f32 v[226:227], v[226:227], v[242:243]
v_pk_add_f32 v[228:229], v[228:229], v[244:245]
v_pk_add_f32 v[230:231], v[230:231], v[246:247]
Vc 232,224,225
v_lshlrev_b32_e64 v224, 16, v232
v_and_b32 v225, 0xffff0000, v232
Vc 233,226,227
v_lshlrev_b32_e64 v226, 16, v233
v_and_b32 v227, 0xffff0000, v233
Vc 234,228,229
v_lshlrev_b32_e64 v228, 16, v234
v_and_b32 v229, 0xffff0000, v234
Vc 235,230,231
v_lshlrev_b32_e64 v230, 16, v235
v_and_b32 v231, 0xffff0000, v235
v_pk_mul_f32 v[224:225], v[224:225], v[66:67]
v_pk_mul_f32 v[226:227], v[226:227], v[68:69]
v_pk_mul_f32 v[228:229], v[228:229], v[70:71]
v_pk_mul_f32 v[230:231], v[230:231], v[72:73]
Vc 232,224,225
v_lshlrev_b32_e64 v224, 16, v232
v_and_b32 v225, 0xffff0000, v232
Vc 233,226,227
v_lshlrev_b32_e64 v226, 16, v233
v_and_b32 v227, 0xffff0000, v233
Vc 234,228,229
v_lshlrev_b32_e64 v228, 16, v234
v_and_b32 v229, 0xffff0000, v234
Vc 235,230,231
v_lshlrev_b32_e64 v230, 16, v235
v_and_b32 v231, 0xffff0000, v235
v_pk_add_f32 v[224:225], v[224:225], v[104:105]
v_pk_add_f32 v[226:227], v[226:227], v[106:107]
v_pk_add_f32 v[228:229], v[228:229], v[108:109]
v_pk_add_f32 v[230:231], v[230:231], v[110:111]
Vc 232,224,225
Vc 233,226,227
Vc 234,228,229
Vc 235,230,231
buffer_store_dwordx4 v[232:235], v119, s[68:71], s36 offen sc1
L_k2_end:
s_endpgm
L_spinAk:
s_mov_b32 s47, 0x400000
L_spinAk_l:
s_sleep 8
buffer_load_dword v30, v31, s[28:31], 0 offen sc1
s_waitcnt vmcnt(0)
v_readfirstlane_b32 s3, v30
s_sub_u32 s47, s47, 1
s_cmp_eq_u32 s47, 0
s_cbranch_scc1 L_spinArk
s_cmp_lt_u32 s3, 256
s_cbranch_scc1 L_spinAk_l
s_branch L_spinArk
L_spinAv:
s_mov_b32 s47, 0x400000
L_spinAv_l:
s_sleep 8
buffer_load_dword v30, v31, s[28:31], 0 offen sc1
s_waitcnt vmcnt(0)
v_readfirstlane_b32 s3, v30
s_sub_u32 s47, s47, 1
s_cmp_eq_u32 s47, 0
s_cbranch_scc1 L_spinArv
s_cmp_lt_u32 s3, 256
s_cbranch_scc1 L_spinAv_l
s_branch L_spinArv
L_spinB:
s_mov_b32 s59, 0x400000
L_spinB_l:
s_sleep 4
buffer_load_dword v12, v1, s[20:23], s6 offen sc1
s_sub_u32 s59, s59, 1
s_cmp_eq_u32 s59, 0
s_cbranch_scc1 L_spinBx
s_waitcnt vmcnt(0)
v_cmp_ne_u32 vcc, 1, v12
s_cbranch_vccnz L_spinB_l
L_spinBx:
s_waitcnt vmcnt(0)
s_branch L_spinBr
L_k2_fb_we:
s_nop 7
s_nop 0
v_max3_f32 v21, v128, v129, v130
v_max3_f32 v21, v21, v131, v132
v_max3_f32 v21, v21, v133, v134
v_max3_f32 v21, v21, v135, v136
v_max3_f32 v21, v21, v137, v138
v_max3_f32 v21, v21, v139, v140
v_max3_f32 v21, v21, v141, v142
v_max_f32 v21, v21, v143
v_mov_b32 v1, v21
s_nop 1
v_permlane16_swap_b32 v1, v21
v_max_f32 v21, v21, v1
v_mov_b32 v1, v21
s_nop 1
v_permlane32_swap_b32 v1, v21
v_max_f32_e64 v21, v21, v1
v_add_f32 v21, 0x41f80000, v21
v_max_f32 v21, 0, v21
Vs 128,128,21
Vs 129,129,21
Vs 130,130,21
Vs 131,131,21
Vs 132,132,21
Vs 133,133,21
Vs 134,134,21
Vs 135,135,21
Vs 136,136,21
Vs 137,137,21
Vs 138,138,21
Vs 139,139,21
Vs 140,140,21
Vs 141,141,21
Vs 142,142,21
Vs 143,143,21
Vs 192,192,21
Vs 193,193,21
Vs 194,194,21
Vs 195,195,21
Vs 196,196,21
Vs 197,197,21
Vs 198,198,21
Vs 199,199,21
Vs 200,200,21
Vs 201,201,21
Vs 202,202,21
Vs 203,203,21
Vs 204,204,21
Vs 205,205,21
Vs 206,206,21
Vs 207,207,21
Vs 32,32,21
Vs 33,33,21
Vs 34,34,21
v_sub_f32_e64 v35, v35, v21
v_exp_f32 v22, -v21
s_nop 0
Vm 48,48,22
Vm 49,49,22
Vm 50,50,22
v_mul_f32_e64 v51, v51, v22
Ar 8,0
Ar 9,1
Ar 10,2
Ar 11,3
Ar 12,4
Ar 13,5
Ar 14,6
Ar 15,7
Vm 8,8,22
Vm 9,9,22
Vm 10,10,22
Vm 11,11,22
Vm 12,12,22
Vm 13,13,22
Vm 14,14,22
Vm 15,15,22
Aw 0,8
Aw 1,9
Aw 2,10
Aw 3,11
Aw 4,12
Aw 5,13
Aw 6,14
Aw 7,15
Ar 8,8
Ar 9,9
Ar 10,10
Ar 11,11
Ar 12,12
Ar 13,13
Ar 14,14
Ar 15,15
Vm 8,8,22
Vm 9,9,22
Vm 10,10,22
Vm 11,11,22
Vm 12,12,22
Vm 13,13,22
Vm 14,14,22
Vm 15,15,22
Aw 8,8
Aw 9,9
Aw 10,10
Aw 11,11
Aw 12,12
Aw 13,13
Aw 14,14
Aw 15,15
Ar 8,16
Ar 9,17
Ar 10,18
Ar 11,19
Ar 12,20
Ar 13,21
Ar 14,22
Ar 15,23
Vm 8,8,22
Vm 9,9,22
Vm 10,10,22
Vm 11,11,22
Vm 12,12,22
Vm 13,13,22
Vm 14,14,22
Vm 15,15,22
Aw 16,8
Aw 17,9
Aw 18,10
Aw 19,11
Aw 20,12
Aw 21,13
Aw 22,14
Aw 23,15
Ar 8,24
Ar 9,25
Ar 10,26
Ar 11,27
Ar 12,28
Ar 13,29
Ar 14,30
Ar 15,31
Vm 8,8,22
Vm 9,9,22
Vm 10,10,22
Vm 11,11,22
Vm 12,12,22
Vm 13,13,22
Vm 14,14,22
Vm 15,15,22
Aw 24,8
Aw 25,9
Aw 26,10
Aw 27,11
Aw 28,12
Aw 29,13
Aw 30,14
Aw 31,15
v_max3_f32 v21, v144, v145, v146
v_max3_f32 v21, v21, v147, v148
v_max3_f32 v21, v21, v149, v150
v_max3_f32 v21, v21, v151, v152
v_max3_f32 v21, v21, v153, v154
v_max3_f32 v21, v21, v155, v156
v_max3_f32 v21, v21, v157, v158
v_max_f32 v21, v21, v159
v_mov_b32 v1, v21
s_nop 1
v_permlane16_swap_b32 v1, v21
v_max_f32 v21, v21, v1
v_mov_b32 v1, v21
s_nop 1
v_permlane32_swap_b32 v1, v21
v_max_f32_e64 v21, v21, v1
v_add_f32 v21, 0x41f80000, v21
v_max_f32 v21, 0, v21
Vs 144,144,21
Vs 145,145,21
Vs 146,146,21
Vs 147,147,21
Vs 148,148,21
Vs 149,149,21
Vs 150,150,21
Vs 151,151,21
Vs 152,152,21
Vs 153,153,21
Vs 154,154,21
Vs 155,155,21
Vs 156,156,21
Vs 157,157,21
Vs 158,158,21
Vs 159,159,21
Vs 208,208,21
Vs 209,209,21
Vs 210,210,21
Vs 211,211,21
Vs 212,212,21
Vs 213,213,21
Vs 214,214,21
Vs 215,215,21
Vs 216,216,21
Vs 217,217,21
Vs 218,218,21
Vs 219,219,21
Vs 220,220,21
Vs 221,221,21
Vs 222,222,21
Vs 223,223,21
Vs 36,36,21
Vs 37,37,21
Vs 38,38,21
v_sub_f32_e64 v39, v39, v21
v_exp_f32 v22, -v21
s_nop 0
Vm 52,52,22
Vm 53,53,22
Vm 54,54,22
v_mul_f32_e64 v55, v55, v22
Ar 8,32
Ar 9,33
Ar 10,34
Ar 11,35
Ar 12,36
Ar 13,37
Ar 14,38
Ar 15,39
Vm 8,8,22
Vm 9,9,22
Vm 10,10,22
Vm 11,11,22
Vm 12,12,22
Vm 13,13,22
Vm 14,14,22
Vm 15,15,22
Aw 32,8
Aw 33,9
Aw 34,10
Aw 35,11
Aw 36,12
Aw 37,13
Aw 38,14
Aw 39,15
Ar 8,40
Ar 9,41
Ar 10,42
Ar 11,43
Ar 12,44
Ar 13,45
Ar 14,46
Ar 15,47
Vm 8,8,22
Vm 9,9,22
Vm 10,10,22
Vm 11,11,22
Vm 12,12,22
Vm 13,13,22
Vm 14,14,22
Vm 15,15,22
Aw 40,8
Aw 41,9
Aw 42,10
Aw 43,11
Aw 44,12
Aw 45,13
Aw 46,14
Aw 47,15
Ar 8,48
Ar 9,49
Ar 10,50
Ar 11,51
Ar 12,52
Ar 13,53
Ar 14,54
Ar 15,55
Vm 8,8,22
Vm 9,9,22
Vm 10,10,22
Vm 11,11,22
Vm 12,12,22
Vm 13,13,22
Vm 14,14,22
Vm 15,15,22
Aw 48,8
Aw 49,9
Aw 50,10
Aw 51,11
Aw 52,12
Aw 53,13
Aw 54,14
Aw 55,15
Ar 8,56
Ar 9,57
Ar 10,58
Ar 11,59
Ar 12,60
Ar 13,61
Ar 14,62
Ar 15,63
Vm 8,8,22
Vm 9,9,22
Vm 10,10,22
Vm 11,11,22
Vm 12,12,22
Vm 13,13,22
Vm 14,14,22
Vm 15,15,22
Aw 56,8
Aw 57,9
Aw 58,10
Aw 59,11
Aw 60,12
Aw 61,13
Aw 62,14
Aw 63,15
v_max3_f32 v21, v160, v161, v162
v_max3_f32 v21, v21, v163, v164
v_max3_f32 v21, v21, v165, v166
v_max3_f32 v21, v21, v167, v168
v_max3_f32 v21, v21, v169, v170
v_max3_f32 v21, v21, v171, v172
v_max3_f32 v21, v21, v173, v174
v_max_f32 v21, v21, v175
v_mov_b32 v1, v21
s_nop 1
v_permlane16_swap_b32 v1, v21
v_max_f32 v21, v21, v1
v_mov_b32 v1, v21
s_nop 1
v_permlane32_swap_b32 v1, v21
v_max_f32_e64 v21, v21, v1
v_add_f32 v21, 0x41f80000, v21
v_max_f32 v21, 0, v21
Vs 160,160,21
Vs 161,161,21
Vs 162,162,21
Vs 163,163,21
Vs 164,164,21
Vs 165,165,21
Vs 166,166,21
Vs 167,167,21
Vs 168,168,21
Vs 169,169,21
Vs 170,170,21
Vs 171,171,21
Vs 172,172,21
Vs 173,173,21
Vs 174,174,21
Vs 175,175,21
Vs 224,224,21
Vs 225,225,21
Vs 226,226,21
Vs 227,227,21
Vs 228,228,21
Vs 229,229,21
Vs 230,230,21
Vs 231,231,21
Vs 232,232,21
Vs 233,233,21
Vs 234,234,21
Vs 235,235,21
Vs 236,236,21
Vs 237,237,21
Vs 238,238,21
Vs 239,239,21
Vs 40,40,21
Vs 41,41,21
Vs 42,42,21
v_sub_f32_e64 v43, v43, v21
v_exp_f32 v22, -v21
s_nop 0
Vm 56,56,22
Vm 57,57,22
Vm 58,58,22
v_mul_f32_e64 v59, v59, v22
Ar 8,64
Ar 9,65
Ar 10,66
Ar 11,67
Ar 12,68
Ar 13,69
Ar 14,70
Ar 15,71
Vm 8,8,22
Vm 9,9,22
Vm 10,10,22
Vm 11,11,22
Vm 12,12,22
Vm 13,13,22
Vm 14,14,22
Vm 15,15,22
Aw 64,8
Aw 65,9
Aw 66,10
Aw 67,11
Aw 68,12
Aw 69,13
Aw 70,14
Aw 71,15
Ar 8,72
Ar 9,73
Ar 10,74
Ar 11,75
Ar 12,76
Ar 13,77
Ar 14,78
Ar 15,79
Vm 8,8,22
Vm 9,9,22
Vm 10,10,22
Vm 11,11,22
Vm 12,12,22
Vm 13,13,22
Vm 14,14,22
Vm 15,15,22
Aw 72,8
Aw 73,9
Aw 74,10
Aw 75,11
Aw 76,12
Aw 77,13
Aw 78,14
Aw 79,15
Ar 8,80
Ar 9,81
Ar 10,82
Ar 11,83
Ar 12,84
Ar 13,85
Ar 14,86
Ar 15,87
Vm 8,8,22
Vm 9,9,22
Vm 10,10,22
Vm 11,11,22
Vm 12,12,22
Vm 13,13,22
Vm 14,14,22
Vm 15,15,22
Aw 80,8
Aw 81,9
Aw 82,10
Aw 83,11
Aw 84,12
Aw 85,13
Aw 86,14
Aw 87,15
Ar 8,88
Ar 9,89
Ar 10,90
Ar 11,91
Ar 12,92
Ar 13,93
Ar 14,94
Ar 15,95
Vm 8,8,22
Vm 9,9,22
Vm 10,10,22
Vm 11,11,22
Vm 12,12,22
Vm 13,13,22
Vm 14,14,22
Vm 15,15,22
Aw 88,8
Aw 89,9
Aw 90,10
Aw 91,11
Aw 92,12
Aw 93,13
Aw 94,14
Aw 95,15
v_max3_f32 v21, v176, v177, v178
v_max3_f32 v21, v21, v179, v180
v_max3_f32 v21, v21, v181, v182
v_max3_f32 v21, v21, v183, v184
v_max3_f32 v21, v21, v185, v186
v_max3_f32 v21, v21, v187, v188
v_max3_f32 v21, v21, v189, v190
v_max_f32 v21, v21, v191
v_mov_b32 v1, v21
s_nop 1
v_permlane16_swap_b32 v1, v21
v_max_f32 v21, v21, v1
v_mov_b32 v1, v21
s_nop 1
v_permlane32_swap_b32 v1, v21
v_max_f32_e64 v21, v21, v1
v_add_f32 v21, 0x41f80000, v21
v_max_f32 v21, 0, v21
Vs 176,176,21
Vs 177,177,21
Vs 178,178,21
Vs 179,179,21
Vs 180,180,21
Vs 181,181,21
Vs 182,182,21
Vs 183,183,21
Vs 184,184,21
Vs 185,185,21
Vs 186,186,21
Vs 187,187,21
Vs 188,188,21
Vs 189,189,21
Vs 190,190,21
Vs 191,191,21
Vs 240,240,21
Vs 241,241,21
Vs 242,242,21
Vs 243,243,21
Vs 244,244,21
Vs 245,245,21
Vs 246,246,21
Vs 247,247,21
Vs 248,248,21
Vs 249,249,21
Vs 250,250,21
Vs 251,251,21
Vs 252,252,21
Vs 253,253,21
Vs 254,254,21
Vs 255,255,21
Vs 44,44,21
Vs 45,45,21
Vs 46,46,21
v_sub_f32_e64 v47, v47, v21
v_exp_f32 v22, -v21
s_nop 0
Vm 60,60,22
Vm 61,61,22
Vm 62,62,22
v_mul_f32_e64 v63, v63, v22
Ar 8,96
Ar 9,97
Ar 10,98
Ar 11,99
Ar 12,100
Ar 13,101
Ar 14,102
Ar 15,103
Vm 8,8,22
Vm 9,9,22
Vm 10,10,22
Vm 11,11,22
Vm 12,12,22
Vm 13,13,22
Vm 14,14,22
Vm 15,15,22
Aw 96,8
Aw 97,9
Aw 98,10
Aw 99,11
Aw 100,12
Aw 101,13
Aw 102,14
Aw 103,15
Ar 8,104
Ar 9,105
Ar 10,106
Ar 11,107
Ar 12,108
Ar 13,109
Ar 14,110
Ar 15,111
Vm 8,8,22
Vm 9,9,22
Vm 10,10,22
Vm 11,11,22
Vm 12,12,22
Vm 13,13,22
Vm 14,14,22
Vm 15,15,22
Aw 104,8
Aw 105,9
Aw 106,10
Aw 107,11
Aw 108,12
Aw 109,13
Aw 110,14
Aw 111,15
Ar 8,112
Ar 9,113
Ar 10,114
Ar 11,115
Ar 12,116
Ar 13,117
Ar 14,118
Ar 15,119
Vm 8,8,22
Vm 9,9,22
Vm 10,10,22
Vm 11,11,22
Vm 12,12,22
Vm 13,13,22
Vm 14,14,22
Vm 15,15,22
Aw 112,8
Aw 113,9
Aw 114,10
Aw 115,11
Aw 116,12
Aw 117,13
Aw 118,14
Aw 119,15
Ar 8,120
Ar 9,121
Ar 10,122
Ar 11,123
Ar 12,124
Ar 13,125
Ar 14,126
Ar 15,127
Vm 8,8,22
Vm 9,9,22
Vm 10,10,22
Vm 11,11,22
Vm 12,12,22
Vm 13,13,22
Vm 14,14,22
Vm 15,15,22
Aw 120,8
Aw 121,9
Aw 122,10
Aw 123,11
Aw 124,12
Aw 125,13
Aw 126,14
Aw 127,15
Ve 8,128
Ve 9,129
s_nop 0
Vc 64,8,9
Ve 8,130
Ve 9,131
s_nop 0
Vc 65,8,9
Ve 8,144
Ve 9,145
s_nop 0
Vc 72,8,9
Ve 8,146
Ve 9,147
s_nop 0
Vc 73,8,9
Ve 8,160
Ve 9,161
s_nop 0
Vc 80,8,9
Ve 8,162
Ve 9,163
s_nop 0
Vc 81,8,9
Ve 8,176
Ve 9,177
s_nop 0
Vc 88,8,9
Ve 8,178
Ve 9,179
s_nop 0
Vc 89,8,9
Ve 8,132
Ve 9,133
s_nop 0
Vc 66,8,9
Ve 8,134
Ve 9,135
s_nop 0
Vc 67,8,9
Ve 8,148
Ve 9,149
s_nop 0
Vc 74,8,9
Ve 8,150
Ve 9,151
s_nop 0
Vc 75,8,9
Ve 8,164
Ve 9,165
s_nop 0
Vc 82,8,9
Ve 8,166
Ve 9,167
s_nop 0
Vc 83,8,9
Ve 8,180
Ve 9,181
s_nop 0
Vc 90,8,9
Ve 8,182
Ve 9,183
s_nop 0
Vc 91,8,9
Ve 8,136
Ve 9,137
s_nop 0
Vc 68,8,9
Ve 8,138
Ve 9,139
s_nop 0
Vc 69,8,9
Ve 8,152
Ve 9,153
s_nop 0
Vc 76,8,9
Ve 8,154
Ve 9,155
s_nop 0
Vc 77,8,9
Ve 8,168
Ve 9,169
s_nop 0
Vc 84,8,9
Ve 8,170
Ve 9,171
s_nop 0
Vc 85,8,9
Ve 8,184
Ve 9,185
s_nop 0
Vc 92,8,9
Ve 8,186
Ve 9,187
s_nop 0
Vc 93,8,9
Ve 8,140
Ve 9,141
s_nop 0
Vc 70,8,9
Ve 8,142
Ve 9,143
s_nop 0
Vc 71,8,9
Ve 8,156
Ve 9,157
s_nop 0
Vc 78,8,9
Ve 8,158
Ve 9,159
s_nop 0
Vc 79,8,9
Ve 8,172
Ve 9,173
s_nop 0
Vc 86,8,9
Ve 8,174
Ve 9,175
s_nop 0
Vc 87,8,9
Ve 8,188
Ve 9,189
s_nop 0
Vc 94,8,9
Ve 8,190
Ve 9,191
s_nop 0
Vc 95,8,9
s_nop 1
s_branch L_k2_fbr_we
L_k2_mk_we:
s_nop 7
s_add_u32 s3, s37, 1
s_lshl_b32 s3, s3, 6
v_subrev_u32 v1, s3, v6
v_cmp_gt_i32 s[56:57], -16, v1
v_cmp_gt_i32 s[58:59], -15, v1
v_cmp_gt_i32 s[60:61], -14, v1
v_cmp_gt_i32 s[62:63], -13, v1
v_cndmask_b32 v240, v240, v20, s[56:57]
v_cndmask_b32 v241, v241, v20, s[58:59]
v_cndmask_b32 v242, v242, v20, s[60:61]
v_cndmask_b32 v243, v243, v20, s[62:63]
v_cmp_gt_i32 s[56:57], 0, v1
v_cmp_gt_i32 s[58:59], 1, v1
v_cmp_gt_i32 s[60:61], 2, v1
v_cmp_gt_i32 s[62:63], 3, v1
v_cndmask_b32 v224, v224, v20, s[56:57]
v_cndmask_b32 v225, v225, v20, s[58:59]
v_cndmask_b32 v226, v226, v20, s[60:61]
v_cndmask_b32 v227, v227, v20, s[62:63]
v_cndmask_b32 v244, v244, v20, s[56:57]
v_cndmask_b32 v245, v245, v20, s[58:59]
v_cndmask_b32 v246, v246, v20, s[60:61]
v_cndmask_b32 v247, v247, v20, s[62:63]
v_cmp_gt_i32 s[56:57], 16, v1
v_cmp_gt_i32 s[58:59], 17, v1
v_cmp_gt_i32 s[60:61], 18, v1
v_cmp_gt_i32 s[62:63], 19, v1
v_cndmask_b32 v228, v228, v20, s[56:57]
v_cndmask_b32 v229, v229, v20, s[58:59]
v_cndmask_b32 v230, v230, v20, s[60:61]
v_cndmask_b32 v231, v231, v20, s[62:63]
v_cndmask_b32 v248, v248, v20, s[56:57]
v_cndmask_b32 v249, v249, v20, s[58:59]
v_cndmask_b32 v250, v250, v20, s[60:61]
v_cndmask_b32 v251, v251, v20, s[62:63]
v_cmp_gt_i32 s[56:57], 32, v1
v_cmp_gt_i32 s[58:59], 33, v1
v_cmp_gt_i32 s[60:61], 34, v1
v_cmp_gt_i32 s[62:63], 35, v1
v_cndmask_b32 v232, v232, v20, s[56:57]
v_cndmask_b32 v233, v233, v20, s[58:59]
v_cndmask_b32 v234, v234, v20, s[60:61]
v_cndmask_b32 v235, v235, v20, s[62:63]
v_cndmask_b32 v252, v252, v20, s[56:57]
v_cndmask_b32 v253, v253, v20, s[58:59]
v_cndmask_b32 v254, v254, v20, s[60:61]
v_cndmask_b32 v255, v255, v20, s[62:63]
v_cmp_gt_i32 s[56:57], 48, v1
v_cmp_gt_i32 s[58:59], 49, v1
v_cmp_gt_i32 s[60:61], 50, v1
v_cmp_gt_i32 s[62:63], 51, v1
v_cndmask_b32 v236, v236, v20, s[56:57]
v_cndmask_b32 v237, v237, v20, s[58:59]
v_cndmask_b32 v238, v238, v20, s[60:61]
v_cndmask_b32 v239, v239, v20, s[62:63]
s_nop 1
s_branch L_k2_mkr_we
L_k2_fb_wo:
s_nop 7
s_nop 0
v_max3_f32 v21, v192, v193, v194
v_max3_f32 v21, v21, v195, v196
v_max3_f32 v21, v21, v197, v198
v_max3_f32 v21, v21, v199, v200
v_max3_f32 v21, v21, v201, v202
v_max3_f32 v21, v21, v203, v204
v_max3_f32 v21, v21, v205, v206
v_max_f32 v21, v21, v207
v_mov_b32 v1, v21
s_nop 1
v_permlane16_swap_b32 v1, v21
v_max_f32 v21, v21, v1
v_mov_b32 v1, v21
s_nop 1
v_permlane32_swap_b32 v1, v21
v_max_f32_e64 v21, v21, v1
v_add_f32 v21, 0x41f80000, v21
v_max_f32 v21, 0, v21
Vs 192,192,21
Vs 193,193,21
Vs 194,194,21
Vs 195,195,21
Vs 196,196,21
Vs 197,197,21
Vs 198,198,21
Vs 199,199,21
Vs 200,200,21
Vs 201,201,21
Vs 202,202,21
Vs 203,203,21
Vs 204,204,21
Vs 205,205,21
Vs 206,206,21
Vs 207,207,21
Vs 128,128,21
Vs 129,129,21
Vs 130,130,21
Vs 131,131,21
Vs 132,132,21
Vs 133,133,21
Vs 134,134,21
Vs 135,135,21
Vs 136,136,21
Vs 137,137,21
Vs 138,138,21
Vs 139,139,21
Vs 140,140,21
Vs 141,141,21
Vs 142,142,21
Vs 143,143,21
Vs 32,32,21
Vs 33,33,21
Vs 34,34,21
v_sub_f32_e64 v35, v35, v21
v_exp_f32 v22, -v21
s_nop 0
Vm 48,48,22
Vm 49,49,22
Vm 50,50,22
v_mul_f32_e64 v51, v51, v22
Ar 8,0
Ar 9,1
Ar 10,2
Ar 11,3
Ar 12,4
Ar 13,5
Ar 14,6
Ar 15,7
Vm 8,8,22
Vm 9,9,22
Vm 10,10,22
Vm 11,11,22
Vm 12,12,22
Vm 13,13,22
Vm 14,14,22
Vm 15,15,22
Aw 0,8
Aw 1,9
Aw 2,10
Aw 3,11
Aw 4,12
Aw 5,13
Aw 6,14
Aw 7,15
Ar 8,8
Ar 9,9
Ar 10,10
Ar 11,11
Ar 12,12
Ar 13,13
Ar 14,14
Ar 15,15
Vm 8,8,22
Vm 9,9,22
Vm 10,10,22
Vm 11,11,22
Vm 12,12,22
Vm 13,13,22
Vm 14,14,22
Vm 15,15,22
Aw 8,8
Aw 9,9
Aw 10,10
Aw 11,11
Aw 12,12
Aw 13,13
Aw 14,14
Aw 15,15
Ar 8,16
Ar 9,17
Ar 10,18
Ar 11,19
Ar 12,20
Ar 13,21
Ar 14,22
Ar 15,23
Vm 8,8,22
Vm 9,9,22
Vm 10,10,22
Vm 11,11,22
Vm 12,12,22
Vm 13,13,22
Vm 14,14,22
Vm 15,15,22
Aw 16,8
Aw 17,9
Aw 18,10
Aw 19,11
Aw 20,12
Aw 21,13
Aw 22,14
Aw 23,15
Ar 8,24
Ar 9,25
Ar 10,26
Ar 11,27
Ar 12,28
Ar 13,29
Ar 14,30
Ar 15,31
Vm 8,8,22
Vm 9,9,22
Vm 10,10,22
Vm 11,11,22
Vm 12,12,22
Vm 13,13,22
Vm 14,14,22
Vm 15,15,22
Aw 24,8
Aw 25,9
Aw 26,10
Aw 27,11
Aw 28,12
Aw 29,13
Aw 30,14
Aw 31,15
v_max3_f32 v21, v208, v209, v210
v_max3_f32 v21, v21, v211, v212
v_max3_f32 v21, v21, v213, v214
v_max3_f32 v21, v21, v215, v216
v_max3_f32 v21, v21, v217, v218
v_max3_f32 v21, v21, v219, v220
v_max3_f32 v21, v21, v221, v222
v_max_f32 v21, v21, v223
v_mov_b32 v1, v21
s_nop 1
v_permlane16_swap_b32 v1, v21
v_max_f32 v21, v21, v1
v_mov_b32 v1, v21
s_nop 1
v_permlane32_swap_b32 v1, v21
v_max_f32_e64 v21, v21, v1
v_add_f32 v21, 0x41f80000, v21
v_max_f32 v21, 0, v21
Vs 208,208,21
Vs 209,209,21
Vs 210,210,21
Vs 211,211,21
Vs 212,212,21
Vs 213,213,21
Vs 214,214,21
Vs 215,215,21
Vs 216,216,21
Vs 217,217,21
Vs 218,218,21
Vs 219,219,21
Vs 220,220,21
Vs 221,221,21
Vs 222,222,21
Vs 223,223,21
Vs 144,144,21
Vs 145,145,21
Vs 146,146,21
Vs 147,147,21
Vs 148,148,21
Vs 149,149,21
Vs 150,150,21
Vs 151,151,21
Vs 152,152,21
Vs 153,153,21
Vs 154,154,21
Vs 155,155,21
Vs 156,156,21
Vs 157,157,21
Vs 158,158,21
Vs 159,159,21
Vs 36,36,21
Vs 37,37,21
Vs 38,38,21
v_sub_f32_e64 v39, v39, v21
v_exp_f32 v22, -v21
s_nop 0
Vm 52,52,22
Vm 53,53,22
Vm 54,54,22
v_mul_f32_e64 v55, v55, v22
Ar 8,32
Ar 9,33
Ar 10,34
Ar 11,35
Ar 12,36
Ar 13,37
Ar 14,38
Ar 15,39
Vm 8,8,22
Vm 9,9,22
Vm 10,10,22
Vm 11,11,22
Vm 12,12,22
Vm 13,13,22
Vm 14,14,22
Vm 15,15,22
Aw 32,8
Aw 33,9
Aw 34,10
Aw 35,11
Aw 36,12
Aw 37,13
Aw 38,14
Aw 39,15
Ar 8,40
Ar 9,41
Ar 10,42
Ar 11,43
Ar 12,44
Ar 13,45
Ar 14,46
Ar 15,47
Vm 8,8,22
Vm 9,9,22
Vm 10,10,22
Vm 11,11,22
Vm 12,12,22
Vm 13,13,22
Vm 14,14,22
Vm 15,15,22
Aw 40,8
Aw 41,9
Aw 42,10
Aw 43,11
Aw 44,12
Aw 45,13
Aw 46,14
Aw 47,15
Ar 8,48
Ar 9,49
Ar 10,50
Ar 11,51
Ar 12,52
Ar 13,53
Ar 14,54
Ar 15,55
Vm 8,8,22
Vm 9,9,22
Vm 10,10,22
Vm 11,11,22
Vm 12,12,22
Vm 13,13,22
Vm 14,14,22
Vm 15,15,22
Aw 48,8
Aw 49,9
Aw 50,10
Aw 51,11
Aw 52,12
Aw 53,13
Aw 54,14
Aw 55,15
Ar 8,56
Ar 9,57
Ar 10,58
Ar 11,59
Ar 12,60
Ar 13,61
Ar 14,62
Ar 15,63
Vm 8,8,22
Vm 9,9,22
Vm 10,10,22
Vm 11,11,22
Vm 12,12,22
Vm 13,13,22
Vm 14,14,22
Vm 15,15,22
Aw 56,8
Aw 57,9
Aw 58,10
Aw 59,11
Aw 60,12
Aw 61,13
Aw 62,14
Aw 63,15
v_max3_f32 v21, v224, v225, v226
v_max3_f32 v21, v21, v227, v228
v_max3_f32 v21, v21, v229, v230
v_max3_f32 v21, v21, v231, v232
v_max3_f32 v21, v21, v233, v234
v_max3_f32 v21, v21, v235, v236
v_max3_f32 v21, v21, v237, v238
v_max_f32 v21, v21, v239
v_mov_b32 v1, v21
s_nop 1
v_permlane16_swap_b32 v1, v21
v_max_f32 v21, v21, v1
v_mov_b32 v1, v21
s_nop 1
v_permlane32_swap_b32 v1, v21
v_max_f32_e64 v21, v21, v1
v_add_f32 v21, 0x41f80000, v21
v_max_f32 v21, 0, v21
Vs 224,224,21
Vs 225,225,21
Vs 226,226,21
Vs 227,227,21
Vs 228,228,21
Vs 229,229,21
Vs 230,230,21
Vs 231,231,21
Vs 232,232,21
Vs 233,233,21
Vs 234,234,21
Vs 235,235,21
Vs 236,236,21
Vs 237,237,21
Vs 238,238,21
Vs 239,239,21
Vs 160,160,21
Vs 161,161,21
Vs 162,162,21
Vs 163,163,21
Vs 164,164,21
Vs 165,165,21
Vs 166,166,21
Vs 167,167,21
Vs 168,168,21
Vs 169,169,21
Vs 170,170,21
Vs 171,171,21
Vs 172,172,21
Vs 173,173,21
Vs 174,174,21
Vs 175,175,21
Vs 40,40,21
Vs 41,41,21
Vs 42,42,21
v_sub_f32_e64 v43, v43, v21
v_exp_f32 v22, -v21
s_nop 0
Vm 56,56,22
Vm 57,57,22
Vm 58,58,22
v_mul_f32_e64 v59, v59, v22
Ar 8,64
Ar 9,65
Ar 10,66
Ar 11,67
Ar 12,68
Ar 13,69
Ar 14,70
Ar 15,71
Vm 8,8,22
Vm 9,9,22
Vm 10,10,22
Vm 11,11,22
Vm 12,12,22
Vm 13,13,22
Vm 14,14,22
Vm 15,15,22
Aw 64,8
Aw 65,9
Aw 66,10
Aw 67,11
Aw 68,12
Aw 69,13
Aw 70,14
Aw 71,15
Ar 8,72
Ar 9,73
Ar 10,74
Ar 11,75
Ar 12,76
Ar 13,77
Ar 14,78
Ar 15,79
Vm 8,8,22
Vm 9,9,22
Vm 10,10,22
Vm 11,11,22
Vm 12,12,22
Vm 13,13,22
Vm 14,14,22
Vm 15,15,22
Aw 72,8
Aw 73,9
Aw 74,10
Aw 75,11
Aw 76,12
Aw 77,13
Aw 78,14
Aw 79,15
Ar 8,80
Ar 9,81
Ar 10,82
Ar 11,83
Ar 12,84
Ar 13,85
Ar 14,86
Ar 15,87
Vm 8,8,22
Vm 9,9,22
Vm 10,10,22
Vm 11,11,22
Vm 12,12,22
Vm 13,13,22
Vm 14,14,22
Vm 15,15,22
Aw 80,8
Aw 81,9
Aw 82,10
Aw 83,11
Aw 84,12
Aw 85,13
Aw 86,14
Aw 87,15
Ar 8,88
Ar 9,89
Ar 10,90
Ar 11,91
Ar 12,92
Ar 13,93
Ar 14,94
Ar 15,95
Vm 8,8,22
Vm 9,9,22
Vm 10,10,22
Vm 11,11,22
Vm 12,12,22
Vm 13,13,22
Vm 14,14,22
Vm 15,15,22
Aw 88,8
Aw 89,9
Aw 90,10
Aw 91,11
Aw 92,12
Aw 93,13
Aw 94,14
Aw 95,15
v_max3_f32 v21, v240, v241, v242
v_max3_f32 v21, v21, v243, v244
v_max3_f32 v21, v21, v245, v246
v_max3_f32 v21, v21, v247, v248
v_max3_f32 v21, v21, v249, v250
v_max3_f32 v21, v21, v251, v252
v_max3_f32 v21, v21, v253, v254
v_max_f32 v21, v21, v255
v_mov_b32 v1, v21
s_nop 1
v_permlane16_swap_b32 v1, v21
v_max_f32 v21, v21, v1
v_mov_b32 v1, v21
s_nop 1
v_permlane32_swap_b32 v1, v21
v_max_f32_e64 v21, v21, v1
v_add_f32 v21, 0x41f80000, v21
v_max_f32 v21, 0, v21
Vs 240,240,21
Vs 241,241,21
Vs 242,242,21
Vs 243,243,21
Vs 244,244,21
Vs 245,245,21
Vs 246,246,21
Vs 247,247,21
Vs 248,248,21
Vs 249,249,21
Vs 250,250,21
Vs 251,251,21
Vs 252,252,21
Vs 253,253,21
Vs 254,254,21
Vs 255,255,21
Vs 176,176,21
Vs 177,177,21
Vs 178,178,21
Vs 179,179,21
Vs 180,180,21
Vs 181,181,21
Vs 182,182,21
Vs 183,183,21
Vs 184,184,21
Vs 185,185,21
Vs 186,186,21
Vs 187,187,21
Vs 188,188,21
Vs 189,189,21
Vs 190,190,21
Vs 191,191,21
Vs 44,44,21
Vs 45,45,21
Vs 46,46,21
v_sub_f32_e64 v47, v47, v21
v_exp_f32 v22, -v21
s_nop 0
Vm 60,60,22
Vm 61,61,22
Vm 62,62,22
v_mul_f32_e64 v63, v63, v22
Ar 8,96
Ar 9,97
Ar 10,98
Ar 11,99
Ar 12,100
Ar 13,101
Ar 14,102
Ar 15,103
Vm 8,8,22
Vm 9,9,22
Vm 10,10,22
Vm 11,11,22
Vm 12,12,22
Vm 13,13,22
Vm 14,14,22
Vm 15,15,22
Aw 96,8
Aw 97,9
Aw 98,10
Aw 99,11
Aw 100,12
Aw 101,13
Aw 102,14
Aw 103,15
Ar 8,104
Ar 9,105
Ar 10,106
Ar 11,107
Ar 12,108
Ar 13,109
Ar 14,110
Ar 15,111
Vm 8,8,22
Vm 9,9,22
Vm 10,10,22
Vm 11,11,22
Vm 12,12,22
Vm 13,13,22
Vm 14,14,22
Vm 15,15,22
Aw 104,8
Aw 105,9
Aw 106,10
Aw 107,11
Aw 108,12
Aw 109,13
Aw 110,14
Aw 111,15
Ar 8,112
Ar 9,113
Ar 10,114
Ar 11,115
Ar 12,116
Ar 13,117
Ar 14,118
Ar 15,119
Vm 8,8,22
Vm 9,9,22
Vm 10,10,22
Vm 11,11,22
Vm 12,12,22
Vm 13,13,22
Vm 14,14,22
Vm 15,15,22
Aw 112,8
Aw 113,9
Aw 114,10
Aw 115,11
Aw 116,12
Aw 117,13
Aw 118,14
Aw 119,15
Ar 8,120
Ar 9,121
Ar 10,122
Ar 11,123
Ar 12,124
Ar 13,125
Ar 14,126
Ar 15,127
Vm 8,8,22
Vm 9,9,22
Vm 10,10,22
Vm 11,11,22
Vm 12,12,22
Vm 13,13,22
Vm 14,14,22
Vm 15,15,22
Aw 120,8
Aw 121,9
Aw 122,10
Aw 123,11
Aw 124,12
Aw 125,13
Aw 126,14
Aw 127,15
Ve 8,192
Ve 9,193
s_nop 0
Vc 96,8,9
Ve 8,194
Ve 9,195
s_nop 0
Vc 97,8,9
Ve 8,208
Ve 9,209
s_nop 0
Vc 104,8,9
Ve 8,210
Ve 9,211
s_nop 0
Vc 105,8,9
Ve 8,224
Ve 9,225
s_nop 0
Vc 112,8,9
Ve 8,226
Ve 9,227
s_nop 0
Vc 113,8,9
Ve 8,240
Ve 9,241
s_nop 0
Vc 120,8,9
Ve 8,242
Ve 9,243
s_nop 0
Vc 121,8,9
Ve 8,196
Ve 9,197
s_nop 0
Vc 98,8,9
Ve 8,198
Ve 9,199
s_nop 0
Vc 99,8,9
Ve 8,212
Ve 9,213
s_nop 0
Vc 106,8,9
Ve 8,214
Ve 9,215
s_nop 0
Vc 107,8,9
Ve 8,228
Ve 9,229
s_nop 0
Vc 114,8,9
Ve 8,230
Ve 9,231
s_nop 0
Vc 115,8,9
Ve 8,244
Ve 9,245
s_nop 0
Vc 122,8,9
Ve 8,246
Ve 9,247
s_nop 0
Vc 123,8,9
Ve 8,200
Ve 9,201
s_nop 0
Vc 100,8,9
Ve 8,202
Ve 9,203
s_nop 0
Vc 101,8,9
Ve 8,216
Ve 9,217
s_nop 0
Vc 108,8,9
Ve 8,218
Ve 9,219
s_nop 0
Vc 109,8,9
Ve 8,232
Ve 9,233
s_nop 0
Vc 116,8,9
Ve 8,234
Ve 9,235
s_nop 0
Vc 117,8,9
Ve 8,248
Ve 9,249
s_nop 0
Vc 124,8,9
Ve 8,250
Ve 9,251
s_nop 0
Vc 125,8,9
Ve 8,204
Ve 9,205
s_nop 0
Vc 102,8,9
Ve 8,206
Ve 9,207
s_nop 0
Vc 103,8,9
Ve 8,220
Ve 9,221
s_nop 0
Vc 110,8,9
Ve 8,222
Ve 9,223
s_nop 0
Vc 111,8,9
Ve 8,236
Ve 9,237
s_nop 0
Vc 118,8,9
Ve 8,238
Ve 9,239
s_nop 0
Vc 119,8,9
Ve 8,252
Ve 9,253
s_nop 0
Vc 126,8,9
Ve 8,254
Ve 9,255
s_nop 0
Vc 127,8,9
s_nop 1
s_branch L_k2_fbr_wo
L_k2_mk_wo:
s_nop 7
s_add_u32 s3, s37, 1
s_lshl_b32 s3, s3, 6
v_subrev_u32 v1, s3, v6
v_cmp_gt_i32 s[56:57], -16, v1
v_cmp_gt_i32 s[58:59], -15, v1
v_cmp_gt_i32 s[60:61], -14, v1
v_cmp_gt_i32 s[62:63], -13, v1
v_cndmask_b32 v176, v176, v20, s[56:57]
v_cndmask_b32 v177, v177, v20, s[58:59]
v_cndmask_b32 v178, v178, v20, s[60:61]
v_cndmask_b32 v179, v179, v20, s[62:63]
v_cmp_gt_i32 s[56:57], 0, v1
v_cmp_gt_i32 s[58:59], 1, v1
v_cmp_gt_i32 s[60:61], 2, v1
v_cmp_gt_i32 s[62:63], 3, v1
v_cndmask_b32 v160, v160, v20, s[56:57]
v_cndmask_b32 v161, v161, v20, s[58:59]
v_cndmask_b32 v162, v162, v20, s[60:61]
v_cndmask_b32 v163, v163, v20, s[62:63]
v_cndmask_b32 v180, v180, v20, s[56:57]
v_cndmask_b32 v181, v181, v20, s[58:59]
v_cndmask_b32 v182, v182, v20, s[60:61]
v_cndmask_b32 v183, v183, v20, s[62:63]
v_cmp_gt_i32 s[56:57], 16, v1
v_cmp_gt_i32 s[58:59], 17, v1
v_cmp_gt_i32 s[60:61], 18, v1
v_cmp_gt_i32 s[62:63], 19, v1
v_cndmask_b32 v164, v164, v20, s[56:57]
v_cndmask_b32 v165, v165, v20, s[58:59]
v_cndmask_b32 v166, v166, v20, s[60:61]
v_cndmask_b32 v167, v167, v20, s[62:63]
v_cndmask_b32 v184, v184, v20, s[56:57]
v_cndmask_b32 v185, v185, v20, s[58:59]
v_cndmask_b32 v186, v186, v20, s[60:61]
v_cndmask_b32 v187, v187, v20, s[62:63]
v_cmp_gt_i32 s[56:57], 32, v1
v_cmp_gt_i32 s[58:59], 33, v1
v_cmp_gt_i32 s[60:61], 34, v1
v_cmp_gt_i32 s[62:63], 35, v1
v_cndmask_b32 v168, v168, v20, s[56:57]
v_cndmask_b32 v169, v169, v20, s[58:59]
v_cndmask_b32 v170, v170, v20, s[60:61]
v_cndmask_b32 v171, v171, v20, s[62:63]
v_cndmask_b32 v188, v188, v20, s[56:57]
v_cndmask_b32 v189, v189, v20, s[58:59]
v_cndmask_b32 v190, v190, v20, s[60:61]
v_cndmask_b32 v191, v191, v20, s[62:63]
v_cmp_gt_i32 s[56:57], 48, v1
v_cmp_gt_i32 s[58:59], 49, v1
v_cmp_gt_i32 s[60:61], 50, v1
v_cmp_gt_i32 s[62:63], 51, v1
v_cndmask_b32 v172, v172, v20, s[56:57]
v_cndmask_b32 v173, v173, v20, s[58:59]
v_cndmask_b32 v174, v174, v20, s[60:61]
v_cndmask_b32 v175, v175, v20, s[62:63]
s_nop 1
s_branch L_k2_mkr_wo
L_k2_fb_tr:
s_nop 7
s_nop 0
v_max3_f32 v21, v192, v193, v194
v_max3_f32 v21, v21, v195, v196
v_max3_f32 v21, v21, v197, v198
v_max3_f32 v21, v21, v199, v200
v_max3_f32 v21, v21, v201, v202
v_max3_f32 v21, v21, v203, v204
v_max3_f32 v21, v21, v205, v206
v_max_f32 v21, v21, v207
v_mov_b32 v1, v21
s_nop 1
v_permlane16_swap_b32 v1, v21
v_max_f32 v21, v21, v1
v_mov_b32 v1, v21
s_nop 1
v_permlane32_swap_b32 v1, v21
v_max_f32_e64 v21, v21, v1
v_add_f32 v21, 0x41f80000, v21
v_max_f32 v21, 0, v21
Vs 192,192,21
Vs 193,193,21
Vs 194,194,21
Vs 195,195,21
Vs 196,196,21
Vs 197,197,21
Vs 198,198,21
Vs 199,199,21
Vs 200,200,21
Vs 201,201,21
Vs 202,202,21
Vs 203,203,21
Vs 204,204,21
Vs 205,205,21
Vs 206,206,21
Vs 207,207,21
Vs 128,128,21
Vs 129,129,21
Vs 130,130,21
Vs 131,131,21
Vs 132,132,21
Vs 133,133,21
Vs 134,134,21
Vs 135,135,21
Vs 136,136,21
Vs 137,137,21
Vs 138,138,21
Vs 139,139,21
Vs 140,140,21
Vs 141,141,21
Vs 142,142,21
Vs 143,143,21
Vs 32,32,21
Vs 33,33,21
Vs 34,34,21
v_sub_f32_e64 v35, v35, v21
v_exp_f32 v22, -v21
s_nop 0
Vm 48,48,22
Vm 49,49,22
Vm 50,50,22
v_mul_f32_e64 v51, v51, v22
Ar 8,0
Ar 9,1
Ar 10,2
Ar 11,3
Ar 12,4
Ar 13,5
Ar 14,6
Ar 15,7
Vm 8,8,22
Vm 9,9,22
Vm 10,10,22
Vm 11,11,22
Vm 12,12,22
Vm 13,13,22
Vm 14,14,22
Vm 15,15,22
Aw 0,8
Aw 1,9
Aw 2,10
Aw 3,11
Aw 4,12
Aw 5,13
Aw 6,14
Aw 7,15
Ar 8,8
Ar 9,9
Ar 10,10
Ar 11,11
Ar 12,12
Ar 13,13
Ar 14,14
Ar 15,15
Vm 8,8,22
Vm 9,9,22
Vm 10,10,22
Vm 11,11,22
Vm 12,12,22
Vm 13,13,22
Vm 14,14,22
Vm 15,15,22
Aw 8,8
Aw 9,9
Aw 10,10
Aw 11,11
Aw 12,12
Aw 13,13
Aw 14,14
Aw 15,15
Ar 8,16
Ar 9,17
Ar 10,18
Ar 11,19
Ar 12,20
Ar 13,21
Ar 14,22
Ar 15,23
Vm 8,8,22
Vm 9,9,22
Vm 10,10,22
Vm 11,11,22
Vm 12,12,22
Vm 13,13,22
Vm 14,14,22
Vm 15,15,22
Aw 16,8
Aw 17,9
Aw 18,10
Aw 19,11
Aw 20,12
Aw 21,13
Aw 22,14
Aw 23,15
Ar 8,24
Ar 9,25
Ar 10,26
Ar 11,27
Ar 12,28
Ar 13,29
Ar 14,30
Ar 15,31
Vm 8,8,22
Vm 9,9,22
Vm 10,10,22
Vm 11,11,22
Vm 12,12,22
Vm 13,13,22
Vm 14,14,22
Vm 15,15,22
Aw 24,8
Aw 25,9
Aw 26,10
Aw 27,11
Aw 28,12
Aw 29,13
Aw 30,14
Aw 31,15
v_max3_f32 v21, v208, v209, v210
v_max3_f32 v21, v21, v211, v212
v_max3_f32 v21, v21, v213, v214
v_max3_f32 v21, v21, v215, v216
v_max3_f32 v21, v21, v217, v218
v_max3_f32 v21, v21, v219, v220
v_max3_f32 v21, v21, v221, v222
v_max_f32 v21, v21, v223
v_mov_b32 v1, v21
s_nop 1
v_permlane16_swap_b32 v1, v21
v_max_f32 v21, v21, v1
v_mov_b32 v1, v21
s_nop 1
v_permlane32_swap_b32 v1, v21
v_max_f32_e64 v21, v21, v1
v_add_f32 v21, 0x41f80000, v21
v_max_f32 v21, 0, v21
Vs 208,208,21
Vs 209,209,21
Vs 210,210,21
Vs 211,211,21
Vs 212,212,21
Vs 213,213,21
Vs 214,214,21
Vs 215,215,21
Vs 216,216,21
Vs 217,217,21
Vs 218,218,21
Vs 219,219,21
Vs 220,220,21
Vs 221,221,21
Vs 222,222,21
Vs 223,223,21
Vs 144,144,21
Vs 145,145,21
Vs 146,146,21
Vs 147,147,21
Vs 148,148,21
Vs 149,149,21
Vs 150,150,21
Vs 151,151,21
Vs 152,152,21
Vs 153,153,21
Vs 154,154,21
Vs 155,155,21
Vs 156,156,21
Vs 157,157,21
Vs 158,158,21
Vs 159,159,21
Vs 36,36,21
Vs 37,37,21
Vs 38,38,21
v_sub_f32_e64 v39, v39, v21
v_exp_f32 v22, -v21
s_nop 0
Vm 52,52,22
Vm 53,53,22
Vm 54,54,22
v_mul_f32_e64 v55, v55, v22
Ar 8,32
Ar 9,33
Ar 10,34
Ar 11,35
Ar 12,36
Ar 13,37
Ar 14,38
Ar 15,39
Vm 8,8,22
Vm 9,9,22
Vm 10,10,22
Vm 11,11,22
Vm 12,12,22
Vm 13,13,22
Vm 14,14,22
Vm 15,15,22
Aw 32,8
Aw 33,9
Aw 34,10
Aw 35,11
Aw 36,12
Aw 37,13
Aw 38,14
Aw 39,15
Ar 8,40
Ar 9,41
Ar 10,42
Ar 11,43
Ar 12,44
Ar 13,45
Ar 14,46
Ar 15,47
Vm 8,8,22
Vm 9,9,22
Vm 10,10,22
Vm 11,11,22
Vm 12,12,22
Vm 13,13,22
Vm 14,14,22
Vm 15,15,22
Aw 40,8
Aw 41,9
Aw 42,10
Aw 43,11
Aw 44,12
Aw 45,13
Aw 46,14
Aw 47,15
Ar 8,48
Ar 9,49
Ar 10,50
Ar 11,51
Ar 12,52
Ar 13,53
Ar 14,54
Ar 15,55
Vm 8,8,22
Vm 9,9,22
Vm 10,10,22
Vm 11,11,22
Vm 12,12,22
Vm 13,13,22
Vm 14,14,22
Vm 15,15,22
Aw 48,8
Aw 49,9
Aw 50,10
Aw 51,11
Aw 52,12
Aw 53,13
Aw 54,14
Aw 55,15
Ar 8,56
Ar 9,57
Ar 10,58
Ar 11,59
Ar 12,60
Ar 13,61
Ar 14,62
Ar 15,63
Vm 8,8,22
Vm 9,9,22
Vm 10,10,22
Vm 11,11,22
Vm 12,12,22
Vm 13,13,22
Vm 14,14,22
Vm 15,15,22
Aw 56,8
Aw 57,9
Aw 58,10
Aw 59,11
Aw 60,12
Aw 61,13
Aw 62,14
Aw 63,15
v_max3_f32 v21, v224, v225, v226
v_max3_f32 v21, v21, v227, v228
v_max3_f32 v21, v21, v229, v230
v_max3_f32 v21, v21, v231, v232
v_max3_f32 v21, v21, v233, v234
v_max3_f32 v21, v21, v235, v236
v_max3_f32 v21, v21, v237, v238
v_max_f32 v21, v21, v239
v_mov_b32 v1, v21
s_nop 1
v_permlane16_swap_b32 v1, v21
v_max_f32 v21, v21, v1
v_mov_b32 v1, v21
s_nop 1
v_permlane32_swap_b32 v1, v21
v_max_f32_e64 v21, v21, v1
v_add_f32 v21, 0x41f80000, v21
v_max_f32 v21, 0, v21
Vs 224,224,21
Vs 225,225,21
Vs 226,226,21
Vs 227,227,21
Vs 228,228,21
Vs 229,229,21
Vs 230,230,21
Vs 231,231,21
Vs 232,232,21
Vs 233,233,21
Vs 234,234,21
Vs 235,235,21
Vs 236,236,21
Vs 237,237,21
Vs 238,238,21
Vs 239,239,21
Vs 40,40,21
Vs 41,41,21
Vs 42,42,21
v_sub_f32_e64 v43, v43, v21
v_exp_f32 v22, -v21
s_nop 0
Vm 56,56,22
Vm 57,57,22
Vm 58,58,22
v_mul_f32_e64 v59, v59, v22
Ar 8,64
Ar 9,65
Ar 10,66
Ar 11,67
Ar 12,68
Ar 13,69
Ar 14,70
Ar 15,71
Vm 8,8,22
Vm 9,9,22
Vm 10,10,22
Vm 11,11,22
Vm 12,12,22
Vm 13,13,22
Vm 14,14,22
Vm 15,15,22
Aw 64,8
Aw 65,9
Aw 66,10
Aw 67,11
Aw 68,12
Aw 69,13
Aw 70,14
Aw 71,15
Ar 8,72
Ar 9,73
Ar 10,74
Ar 11,75
Ar 12,76
Ar 13,77
Ar 14,78
Ar 15,79
Vm 8,8,22
Vm 9,9,22
Vm 10,10,22
Vm 11,11,22
Vm 12,12,22
Vm 13,13,22
Vm 14,14,22
Vm 15,15,22
Aw 72,8
Aw 73,9
Aw 74,10
Aw 75,11
Aw 76,12
Aw 77,13
Aw 78,14
Aw 79,15
Ar 8,80
Ar 9,81
Ar 10,82
Ar 11,83
Ar 12,84
Ar 13,85
Ar 14,86
Ar 15,87
Vm 8,8,22
Vm 9,9,22
Vm 10,10,22
Vm 11,11,22
Vm 12,12,22
Vm 13,13,22
Vm 14,14,22
Vm 15,15,22
Aw 80,8
Aw 81,9
Aw 82,10
Aw 83,11
Aw 84,12
Aw 85,13
Aw 86,14
Aw 87,15
Ar 8,88
Ar 9,89
Ar 10,90
Ar 11,91
Ar 12,92
Ar 13,93
Ar 14,94
Ar 15,95
Vm 8,8,22
Vm 9,9,22
Vm 10,10,22
Vm 11,11,22
Vm 12,12,22
Vm 13,13,22
Vm 14,14,22
Vm 15,15,22
Aw 88,8
Aw 89,9
Aw 90,10
Aw 91,11
Aw 92,12
Aw 93,13
Aw 94,14
Aw 95,15
v_max3_f32 v21, v240, v241, v242
v_max3_f32 v21, v21, v243, v244
v_max3_f32 v21, v21, v245, v246
v_max3_f32 v21, v21, v247, v248
v_max3_f32 v21, v21, v249, v250
v_max3_f32 v21, v21, v251, v252
v_max3_f32 v21, v21, v253, v254
v_max_f32 v21, v21, v255
v_mov_b32 v1, v21
s_nop 1
v_permlane16_swap_b32 v1, v21
v_max_f32 v21, v21, v1
v_mov_b32 v1, v21
s_nop 1
v_permlane32_swap_b32 v1, v21
v_max_f32_e64 v21, v21, v1
v_add_f32 v21, 0x41f80000, v21
v_max_f32 v21, 0, v21
Vs 240,240,21
Vs 241,241,21
Vs 242,242,21
Vs 243,243,21
Vs 244,244,21
Vs 245,245,21
Vs 246,246,21
Vs 247,247,21
Vs 248,248,21
Vs 249,249,21
Vs 250,250,21
Vs 251,251,21
Vs 252,252,21
Vs 253,253,21
Vs 254,254,21
Vs 255,255,21
Vs 44,44,21
Vs 45,45,21
Vs 46,46,21
v_sub_f32_e64 v47, v47, v21
v_exp_f32 v22, -v21
s_nop 0
Vm 60,60,22
Vm 61,61,22
Vm 62,62,22
v_mul_f32_e64 v63, v63, v22
Ar 8,96
Ar 9,97
Ar 10,98
Ar 11,99
Ar 12,100
Ar 13,101
Ar 14,102
Ar 15,103
Vm 8,8,22
Vm 9,9,22
Vm 10,10,22
Vm 11,11,22
Vm 12,12,22
Vm 13,13,22
Vm 14,14,22
Vm 15,15,22
Aw 96,8
Aw 97,9
Aw 98,10
Aw 99,11
Aw 100,12
Aw 101,13
Aw 102,14
Aw 103,15
Ar 8,104
Ar 9,105
Ar 10,106
Ar 11,107
Ar 12,108
Ar 13,109
Ar 14,110
Ar 15,111
Vm 8,8,22
Vm 9,9,22
Vm 10,10,22
Vm 11,11,22
Vm 12,12,22
Vm 13,13,22
Vm 14,14,22
Vm 15,15,22
Aw 104,8
Aw 105,9
Aw 106,10
Aw 107,11
Aw 108,12
Aw 109,13
Aw 110,14
Aw 111,15
Ar 8,112
Ar 9,113
Ar 10,114
Ar 11,115
Ar 12,116
Ar 13,117
Ar 14,118
Ar 15,119
Vm 8,8,22
Vm 9,9,22
Vm 10,10,22
Vm 11,11,22
Vm 12,12,22
Vm 13,13,22
Vm 14,14,22
Vm 15,15,22
Aw 112,8
Aw 113,9
Aw 114,10
Aw 115,11
Aw 116,12
Aw 117,13
Aw 118,14
Aw 119,15
Ar 8,120
Ar 9,121
Ar 10,122
Ar 11,123
Ar 12,124
Ar 13,125
Ar 14,126
Ar 15,127
Vm 8,8,22
Vm 9,9,22
Vm 10,10,22
Vm 11,11,22
Vm 12,12,22
Vm 13,13,22
Vm 14,14,22
Vm 15,15,22
Aw 120,8
Aw 121,9
Aw 122,10
Aw 123,11
Aw 124,12
Aw 125,13
Aw 126,14
Aw 127,15
Ve 8,192
Ve 9,193
s_nop 0
Vc 96,8,9
Ve 8,194
Ve 9,195
s_nop 0
Vc 97,8,9
Ve 8,208
Ve 9,209
s_nop 0
Vc 104,8,9
Ve 8,210
Ve 9,211
s_nop 0
Vc 105,8,9
Ve 8,224
Ve 9,225
s_nop 0
Vc 112,8,9
Ve 8,226
Ve 9,227
s_nop 0
Vc 113,8,9
Ve 8,240
Ve 9,241
s_nop 0
Vc 120,8,9
Ve 8,242
Ve 9,243
s_nop 0
Vc 121,8,9
Ve 8,196
Ve 9,197
s_nop 0
Vc 98,8,9
Ve 8,198
Ve 9,199
s_nop 0
Vc 99,8,9
Ve 8,212
Ve 9,213
s_nop 0
Vc 106,8,9
Ve 8,214
Ve 9,215
s_nop 0
Vc 107,8,9
Ve 8,228
Ve 9,229
s_nop 0
Vc 114,8,9
Ve 8,230
Ve 9,231
s_nop 0
Vc 115,8,9
Ve 8,244
Ve 9,245
s_nop 0
Vc 122,8,9
Ve 8,246
Ve 9,247
s_nop 0
Vc 123,8,9
Ve 8,200
Ve 9,201
s_nop 0
Vc 100,8,9
Ve 8,202
Ve 9,203
s_nop 0
Vc 101,8,9
Ve 8,216
Ve 9,217
s_nop 0
Vc 108,8,9
Ve 8,218
Ve 9,219
s_nop 0
Vc 109,8,9
Ve 8,232
Ve 9,233
s_nop 0
Vc 116,8,9
Ve 8,234
Ve 9,235
s_nop 0
Vc 117,8,9
Ve 8,248
Ve 9,249
s_nop 0
Vc 124,8,9
Ve 8,250
Ve 9,251
s_nop 0
Vc 125,8,9
Ve 8,204
Ve 9,205
s_nop 0
Vc 102,8,9
Ve 8,206
Ve 9,207
s_nop 0
Vc 103,8,9
Ve 8,220
Ve 9,221
s_nop 0
Vc 110,8,9
Ve 8,222
Ve 9,223
s_nop 0
Vc 111,8,9
Ve 8,236
Ve 9,237
s_nop 0
Vc 118,8,9
Ve 8,238
Ve 9,239
s_nop 0
Vc 119,8,9
Ve 8,252
Ve 9,253
s_nop 0
Vc 126,8,9
Ve 8,254
Ve 9,255
s_nop 0
Vc 127,8,9
s_nop 1
s_branch L_k2_fbr_tr
L_k2_mk_tr:
s_nop 7
s_add_u32 s3, s37, 1
s_lshl_b32 s3, s3, 6
v_subrev_u32 v1, s3, v5
v_cmp_gt_i32 s[56:57], -16, v1
v_cmp_gt_i32 s[58:59], -15, v1
v_cmp_gt_i32 s[60:61], -14, v1
v_cmp_gt_i32 s[62:63], -13, v1
v_cndmask_b32 v144, v144, v20, s[56:57]
v_cndmask_b32 v145, v145, v20, s[58:59]
v_cndmask_b32 v146, v146, v20, s[60:61]
v_cndmask_b32 v147, v147, v20, s[62:63]
v_cmp_gt_i32 s[56:57], 0, v1
v_cmp_gt_i32 s[58:59], 1, v1
v_cmp_gt_i32 s[60:61], 2, v1
v_cmp_gt_i32 s[62:63], 3, v1
v_cndmask_b32 v128, v128, v20, s[56:57]
v_cndmask_b32 v129, v129, v20, s[58:59]
v_cndmask_b32 v130, v130, v20, s[60:61]
v_cndmask_b32 v131, v131, v20, s[62:63]
v_cndmask_b32 v148, v148, v20, s[56:57]
v_cndmask_b32 v149, v149, v20, s[58:59]
v_cndmask_b32 v150, v150, v20, s[60:61]
v_cndmask_b32 v151, v151, v20, s[62:63]
v_cmp_gt_i32 s[56:57], 16, v1
v_cmp_gt_i32 s[58:59], 17, v1
v_cmp_gt_i32 s[60:61], 18, v1
v_cmp_gt_i32 s[62:63], 19, v1
v_cndmask_b32 v132, v132, v20, s[56:57]
v_cndmask_b32 v133, v133, v20, s[58:59]
v_cndmask_b32 v134, v134, v20, s[60:61]
v_cndmask_b32 v135, v135, v20, s[62:63]
v_cndmask_b32 v152, v152, v20, s[56:57]
v_cndmask_b32 v153, v153, v20, s[58:59]
v_cndmask_b32 v154, v154, v20, s[60:61]
v_cndmask_b32 v155, v155, v20, s[62:63]
v_cmp_gt_i32 s[56:57], 32, v1
v_cmp_gt_i32 s[58:59], 33, v1
v_cmp_gt_i32 s[60:61], 34, v1
v_cmp_gt_i32 s[62:63], 35, v1
v_cndmask_b32 v136, v136, v20, s[56:57]
v_cndmask_b32 v137, v137, v20, s[58:59]
v_cndmask_b32 v138, v138, v20, s[60:61]
v_cndmask_b32 v139, v139, v20, s[62:63]
v_cndmask_b32 v156, v156, v20, s[56:57]
v_cndmask_b32 v157, v157, v20, s[58:59]
v_cndmask_b32 v158, v158, v20, s[60:61]
v_cndmask_b32 v159, v159, v20, s[62:63]
v_cmp_gt_i32 s[56:57], 48, v1
v_cmp_gt_i32 s[58:59], 49, v1
v_cmp_gt_i32 s[60:61], 50, v1
v_cmp_gt_i32 s[62:63], 51, v1
v_cndmask_b32 v140, v140, v20, s[56:57]
v_cndmask_b32 v141, v141, v20, s[58:59]
v_cndmask_b32 v142, v142, v20, s[60:61]
v_cndmask_b32 v143, v143, v20, s[62:63]
s_nop 1
s_branch L_k2_mkr_tr
L_k2_fb_ne:
s_nop 7
s_nop 0
v_max3_f32 v21, v128, v129, v130
v_max3_f32 v21, v21, v131, v132
v_max3_f32 v21, v21, v133, v134
v_max3_f32 v21, v21, v135, v136
v_max3_f32 v21, v21, v137, v138
v_max3_f32 v21, v21, v139, v140
v_max3_f32 v21, v21, v141, v142
v_max_f32 v21, v21, v143
v_mov_b32 v1, v21
s_nop 1
v_permlane16_swap_b32 v1, v21
v_max_f32 v21, v21, v1
v_mov_b32 v1, v21
s_nop 1
v_permlane32_swap_b32 v1, v21
v_max_f32_e64 v21, v21, v1
v_add_f32 v21, 0x41f80000, v21
v_max_f32 v21, 0, v21
Vs 128,128,21
Vs 129,129,21
Vs 130,130,21
Vs 131,131,21
Vs 132,132,21
Vs 133,133,21
Vs 134,134,21
Vs 135,135,21
Vs 136,136,21
Vs 137,137,21
Vs 138,138,21
Vs 139,139,21
Vs 140,140,21
Vs 141,141,21
Vs 142,142,21
Vs 143,143,21
Vs 192,192,21
Vs 193,193,21
Vs 194,194,21
Vs 195,195,21
Vs 196,196,21
Vs 197,197,21
Vs 198,198,21
Vs 199,199,21
Vs 200,200,21
Vs 201,201,21
Vs 202,202,21
Vs 203,203,21
Vs 204,204,21
Vs 205,205,21
Vs 206,206,21
Vs 207,207,21
Vs 32,32,21
Vs 33,33,21
Vs 34,34,21
v_sub_f32_e64 v35, v35, v21
v_exp_f32 v22, -v21
s_nop 0
Vm 48,48,22
Vm 49,49,22
Vm 50,50,22
v_mul_f32_e64 v51, v51, v22
Ar 8,0
Ar 9,1
Ar 10,2
Ar 11,3
Ar 12,4
Ar 13,5
Ar 14,6
Ar 15,7
Vm 8,8,22
Vm 9,9,22
Vm 10,10,22
Vm 11,11,22
Vm 12,12,22
Vm 13,13,22
Vm 14,14,22
Vm 15,15,22
Aw 0,8
Aw 1,9
Aw 2,10
Aw 3,11
Aw 4,12
Aw 5,13
Aw 6,14
Aw 7,15
Ar 8,8
Ar 9,9
Ar 10,10
Ar 11,11
Ar 12,12
Ar 13,13
Ar 14,14
Ar 15,15
Vm 8,8,22
Vm 9,9,22
Vm 10,10,22
Vm 11,11,22
Vm 12,12,22
Vm 13,13,22
Vm 14,14,22
Vm 15,15,22
Aw 8,8
Aw 9,9
Aw 10,10
Aw 11,11
Aw 12,12
Aw 13,13
Aw 14,14
Aw 15,15
Ar 8,16
Ar 9,17
Ar 10,18
Ar 11,19
Ar 12,20
Ar 13,21
Ar 14,22
Ar 15,23
Vm 8,8,22
Vm 9,9,22
Vm 10,10,22
Vm 11,11,22
Vm 12,12,22
Vm 13,13,22
Vm 14,14,22
Vm 15,15,22
Aw 16,8
Aw 17,9
Aw 18,10
Aw 19,11
Aw 20,12
Aw 21,13
Aw 22,14
Aw 23,15
Ar 8,24
Ar 9,25
Ar 10,26
Ar 11,27
Ar 12,28
Ar 13,29
Ar 14,30
Ar 15,31
Vm 8,8,22
Vm 9,9,22
Vm 10,10,22
Vm 11,11,22
Vm 12,12,22
Vm 13,13,22
Vm 14,14,22
Vm 15,15,22
Aw 24,8
Aw 25,9
Aw 26,10
Aw 27,11
Aw 28,12
Aw 29,13
Aw 30,14
Aw 31,15
v_max3_f32 v21, v144, v145, v146
v_max3_f32 v21, v21, v147, v148
v_max3_f32 v21, v21, v149, v150
v_max3_f32 v21, v21, v151, v152
v_max3_f32 v21, v21, v153, v154
v_max3_f32 v21, v21, v155, v156
v_max3_f32 v21, v21, v157, v158
v_max_f32 v21, v21, v159
v_mov_b32 v1, v21
s_nop 1
v_permlane16_swap_b32 v1, v21
v_max_f32 v21, v21, v1
v_mov_b32 v1, v21
s_nop 1
v_permlane32_swap_b32 v1, v21
v_max_f32_e64 v21, v21, v1
v_add_f32 v21, 0x41f80000, v21
v_max_f32 v21, 0, v21
Vs 144,144,21
Vs 145,145,21
Vs 146,146,21
Vs 147,147,21
Vs 148,148,21
Vs 149,149,21
Vs 150,150,21
Vs 151,151,21
Vs 152,152,21
Vs 153,153,21
Vs 154,154,21
Vs 155,155,21
Vs 156,156,21
Vs 157,157,21
Vs 158,158,21
Vs 159,159,21
Vs 208,208,21
Vs 209,209,21
Vs 210,210,21
Vs 211,211,21
Vs 212,212,21
Vs 213,213,21
Vs 214,214,21
Vs 215,215,21
Vs 216,216,21
Vs 217,217,21
Vs 218,218,21
Vs 219,219,21
Vs 220,220,21
Vs 221,221,21
Vs 222,222,21
Vs 223,223,21
Vs 36,36,21
Vs 37,37,21
Vs 38,38,21
v_sub_f32_e64 v39, v39, v21
v_exp_f32 v22, -v21
s_nop 0
Vm 52,52,22
Vm 53,53,22
Vm 54,54,22
v_mul_f32_e64 v55, v55, v22
Ar 8,32
Ar 9,33
Ar 10,34
Ar 11,35
Ar 12,36
Ar 13,37
Ar 14,38
Ar 15,39
Vm 8,8,22
Vm 9,9,22
Vm 10,10,22
Vm 11,11,22
Vm 12,12,22
Vm 13,13,22
Vm 14,14,22
Vm 15,15,22
Aw 32,8
Aw 33,9
Aw 34,10
Aw 35,11
Aw 36,12
Aw 37,13
Aw 38,14
Aw 39,15
Ar 8,40
Ar 9,41
Ar 10,42
Ar 11,43
Ar 12,44
Ar 13,45
Ar 14,46
Ar 15,47
Vm 8,8,22
Vm 9,9,22
Vm 10,10,22
Vm 11,11,22
Vm 12,12,22
Vm 13,13,22
Vm 14,14,22
Vm 15,15,22
Aw 40,8
Aw 41,9
Aw 42,10
Aw 43,11
Aw 44,12
Aw 45,13
Aw 46,14
Aw 47,15
Ar 8,48
Ar 9,49
Ar 10,50
Ar 11,51
Ar 12,52
Ar 13,53
Ar 14,54
Ar 15,55
Vm 8,8,22
Vm 9,9,22
Vm 10,10,22
Vm 11,11,22
Vm 12,12,22
Vm 13,13,22
Vm 14,14,22
Vm 15,15,22
Aw 48,8
Aw 49,9
Aw 50,10
Aw 51,11
Aw 52,12
Aw 53,13
Aw 54,14
Aw 55,15
Ar 8,56
Ar 9,57
Ar 10,58
Ar 11,59
Ar 12,60
Ar 13,61
Ar 14,62
Ar 15,63
Vm 8,8,22
Vm 9,9,22
Vm 10,10,22
Vm 11,11,22
Vm 12,12,22
Vm 13,13,22
Vm 14,14,22
Vm 15,15,22
Aw 56,8
Aw 57,9
Aw 58,10
Aw 59,11
Aw 60,12
Aw 61,13
Aw 62,14
Aw 63,15
Ve 8,128
Ve 9,129
s_nop 0
Vc 64,8,9
Ve 8,130
Ve 9,131
s_nop 0
Vc 65,8,9
Ve 8,144
Ve 9,145
s_nop 0
Vc 72,8,9
Ve 8,146
Ve 9,147
s_nop 0
Vc 73,8,9
Ve 8,132
Ve 9,133
s_nop 0
Vc 66,8,9
Ve 8,134
Ve 9,135
s_nop 0
Vc 67,8,9
Ve 8,148
Ve 9,149
s_nop 0
Vc 74,8,9
Ve 8,150
Ve 9,151
s_nop 0
Vc 75,8,9
Ve 8,136
Ve 9,137
s_nop 0
Vc 68,8,9
Ve 8,138
Ve 9,139
s_nop 0
Vc 69,8,9
Ve 8,152
Ve 9,153
s_nop 0
Vc 76,8,9
Ve 8,154
Ve 9,155
s_nop 0
Vc 77,8,9
Ve 8,140
Ve 9,141
s_nop 0
Vc 70,8,9
Ve 8,142
Ve 9,143
s_nop 0
Vc 71,8,9
Ve 8,156
Ve 9,157
s_nop 0
Vc 78,8,9
Ve 8,158
Ve 9,159
s_nop 0
Vc 79,8,9
s_nop 1
s_branch L_k2_fbr_ne
L_k2_mk_ne:
s_nop 7
s_add_u32 s3, s37, 1
s_lshl_b32 s3, s3, 6
v_subrev_u32 v1, s3, v5
v_cmp_gt_i32 s[56:57], -16, v1
v_cmp_gt_i32 s[58:59], -15, v1
v_cmp_gt_i32 s[60:61], -14, v1
v_cmp_gt_i32 s[62:63], -13, v1
v_cndmask_b32 v208, v208, v20, s[56:57]
v_cndmask_b32 v209, v209, v20, s[58:59]
v_cndmask_b32 v210, v210, v20, s[60:61]
v_cndmask_b32 v211, v211, v20, s[62:63]
v_cmp_gt_i32 s[56:57], 0, v1
v_cmp_gt_i32 s[58:59], 1, v1
v_cmp_gt_i32 s[60:61], 2, v1
v_cmp_gt_i32 s[62:63], 3, v1
v_cndmask_b32 v192, v192, v20, s[56:57]
v_cndmask_b32 v193, v193, v20, s[58:59]
v_cndmask_b32 v194, v194, v20, s[60:61]
v_cndmask_b32 v195, v195, v20, s[62:63]
v_cndmask_b32 v212, v212, v20, s[56:57]
v_cndmask_b32 v213, v213, v20, s[58:59]
v_cndmask_b32 v214, v214, v20, s[60:61]
v_cndmask_b32 v215, v215, v20, s[62:63]
v_cmp_gt_i32 s[56:57], 16, v1
v_cmp_gt_i32 s[58:59], 17, v1
v_cmp_gt_i32 s[60:61], 18, v1
v_cmp_gt_i32 s[62:63], 19, v1
v_cndmask_b32 v196, v196, v20, s[56:57]
v_cndmask_b32 v197, v197, v20, s[58:59]
v_cndmask_b32 v198, v198, v20, s[60:61]
v_cndmask_b32 v199, v199, v20, s[62:63]
v_cndmask_b32 v216, v216, v20, s[56:57]
v_cndmask_b32 v217, v217, v20, s[58:59]
v_cndmask_b32 v218, v218, v20, s[60:61]
v_cndmask_b32 v219, v219, v20, s[62:63]
v_cmp_gt_i32 s[56:57], 32, v1
v_cmp_gt_i32 s[58:59], 33, v1
v_cmp_gt_i32 s[60:61], 34, v1
v_cmp_gt_i32 s[62:63], 35, v1
v_cndmask_b32 v200, v200, v20, s[56:57]
v_cndmask_b32 v201, v201, v20, s[58:59]
v_cndmask_b32 v202, v202, v20, s[60:61]
v_cndmask_b32 v203, v203, v20, s[62:63]
v_cndmask_b32 v220, v220, v20, s[56:57]
v_cndmask_b32 v221, v221, v20, s[58:59]
v_cndmask_b32 v222, v222, v20, s[60:61]
v_cndmask_b32 v223, v223, v20, s[62:63]
v_cmp_gt_i32 s[56:57], 48, v1
v_cmp_gt_i32 s[58:59], 49, v1
v_cmp_gt_i32 s[60:61], 50, v1
v_cmp_gt_i32 s[62:63], 51, v1
v_cndmask_b32 v204, v204, v20, s[56:57]
v_cndmask_b32 v205, v205, v20, s[58:59]
v_cndmask_b32 v206, v206, v20, s[60:61]
v_cndmask_b32 v207, v207, v20, s[62:63]
s_nop 1
s_branch L_k2_mkr_ne
L_pubB:
v_mov_b32 v24, 1
v_mov_b32 v25, 0
s_mov_b64 exec, 1
buffer_store_dword v24, v25, s[20:23], s64 offen sc1
s_mov_b64 exec, -1
s_branch L_pubBr
L_k2_fb_no:
s_nop 7
v_max3_f32 v21, v192, v193, v194
v_max3_f32 v21, v21, v195, v196
v_max3_f32 v21, v21, v197, v198
v_max3_f32 v21, v21, v199, v200
v_max3_f32 v21, v21, v201, v202
v_max3_f32 v21, v21, v203, v204
v_max3_f32 v21, v21, v205, v206
v_max_f32 v21, v21, v207
v_mov_b32 v1, v21
s_nop 1
v_permlane16_swap_b32 v1, v21
v_max_f32 v21, v21, v1
v_mov_b32 v1, v21
s_nop 1
v_permlane32_swap_b32 v1, v21
v_max_f32_e64 v21, v21, v1
v_add_f32 v21, 0x41f80000, v21
v_max_f32 v21, 0, v21
Vs 192,192,21
Vs 193,193,21
Vs 194,194,21
Vs 195,195,21
Vs 196,196,21
Vs 197,197,21
Vs 198,198,21
Vs 199,199,21
Vs 200,200,21
Vs 201,201,21
Vs 202,202,21
Vs 203,203,21
Vs 204,204,21
Vs 205,205,21
Vs 206,206,21
Vs 207,207,21
Vs 128,128,21
Vs 129,129,21
Vs 130,130,21
Vs 131,131,21
Vs 132,132,21
Vs 133,133,21
Vs 134,134,21
Vs 135,135,21
Vs 136,136,21
Vs 137,137,21
Vs 138,138,21
Vs 139,139,21
Vs 140,140,21
Vs 141,141,21
Vs 142,142,21
Vs 143,143,21
Vs 32,32,21
Vs 33,33,21
Vs 34,34,21
v_sub_f32_e64 v35, v35, v21
v_exp_f32 v22, -v21
s_nop 0
Vm 48,48,22
Vm 49,49,22
Vm 50,50,22
v_mul_f32_e64 v51, v51, v22
Ar 8,0
Ar 9,1
Ar 10,2
Ar 11,3
Ar 12,4
Ar 13,5
Ar 14,6
Ar 15,7
Vm 8,8,22
Vm 9,9,22
Vm 10,10,22
Vm 11,11,22
Vm 12,12,22
Vm 13,13,22
Vm 14,14,22
Vm 15,15,22
Aw 0,8
Aw 1,9
Aw 2,10
Aw 3,11
Aw 4,12
Aw 5,13
Aw 6,14
Aw 7,15
Ar 8,8
Ar 9,9
Ar 10,10
Ar 11,11
Ar 12,12
Ar 13,13
Ar 14,14
Ar 15,15
Vm 8,8,22
Vm 9,9,22
Vm 10,10,22
Vm 11,11,22
Vm 12,12,22
Vm 13,13,22
Vm 14,14,22
Vm 15,15,22
Aw 8,8
Aw 9,9
Aw 10,10
Aw 11,11
Aw 12,12
Aw 13,13
Aw 14,14
Aw 15,15
Ar 8,16
Ar 9,17
Ar 10,18
Ar 11,19
Ar 12,20
Ar 13,21
Ar 14,22
Ar 15,23
Vm 8,8,22
Vm 9,9,22
Vm 10,10,22
Vm 11,11,22
Vm 12,12,22
Vm 13,13,22
Vm 14,14,22
Vm 15,15,22
Aw 16,8
Aw 17,9
Aw 18,10
Aw 19,11
Aw 20,12
Aw 21,13
Aw 22,14
Aw 23,15
Ar 8,24
Ar 9,25
Ar 10,26
Ar 11,27
Ar 12,28
Ar 13,29
Ar 14,30
Ar 15,31
Vm 8,8,22
Vm 9,9,22
Vm 10,10,22
Vm 11,11,22
Vm 12,12,22
Vm 13,13,22
Vm 14,14,22
Vm 15,15,22
Aw 24,8
Aw 25,9
Aw 26,10
Aw 27,11
Aw 28,12
Aw 29,13
Aw 30,14
Aw 31,15
v_max3_f32 v21, v208, v209, v210
v_max3_f32 v21, v21, v211, v212
v_max3_f32 v21, v21, v213, v214
v_max3_f32 v21, v21, v215, v216
v_max3_f32 v21, v21, v217, v218
v_max3_f32 v21, v21, v219, v220
v_max3_f32 v21, v21, v221, v222
v_max_f32 v21, v21, v223
v_mov_b32 v1, v21
s_nop 1
v_permlane16_swap_b32 v1, v21
v_max_f32 v21, v21, v1
v_mov_b32 v1, v21
s_nop 1
v_permlane32_swap_b32 v1, v21
v_max_f32_e64 v21, v21, v1
v_add_f32 v21, 0x41f80000, v21
v_max_f32 v21, 0, v21
Vs 208,208,21
Vs 209,209,21
Vs 210,210,21
Vs 211,211,21
Vs 212,212,21
Vs 213,213,21
Vs 214,214,21
Vs 215,215,21
Vs 216,216,21
Vs 217,217,21
Vs 218,218,21
Vs 219,219,21
Vs 220,220,21
Vs 221,221,21
Vs 222,222,21
Vs 223,223,21
Vs 144,144,21
Vs 145,145,21
Vs 146,146,21
Vs 147,147,21
Vs 148,148,21
Vs 149,149,21
Vs 150,150,21
Vs 151,151,21
Vs 152,152,21
Vs 153,153,21
Vs 154,154,21
Vs 155,155,21
Vs 156,156,21
Vs 157,157,21
Vs 158,158,21
Vs 159,159,21
Vs 36,36,21
Vs 37,37,21
Vs 38,38,21
v_sub_f32_e64 v39, v39, v21
v_exp_f32 v22, -v21
s_nop 0
Vm 52,52,22
Vm 53,53,22
Vm 54,54,22
v_mul_f32_e64 v55, v55, v22
Ar 8,32
Ar 9,33
Ar 10,34
Ar 11,35
Ar 12,36
Ar 13,37
Ar 14,38
Ar 15,39
Vm 8,8,22
Vm 9,9,22
Vm 10,10,22
Vm 11,11,22
Vm 12,12,22
Vm 13,13,22
Vm 14,14,22
Vm 15,15,22
Aw 32,8
Aw 33,9
Aw 34,10
Aw 35,11
Aw 36,12
Aw 37,13
Aw 38,14
Aw 39,15
Ar 8,40
Ar 9,41
Ar 10,42
Ar 11,43
Ar 12,44
Ar 13,45
Ar 14,46
Ar 15,47
Vm 8,8,22
Vm 9,9,22
Vm 10,10,22
Vm 11,11,22
Vm 12,12,22
Vm 13,13,22
Vm 14,14,22
Vm 15,15,22
Aw 40,8
Aw 41,9
Aw 42,10
Aw 43,11
Aw 44,12
Aw 45,13
Aw 46,14
Aw 47,15
Ar 8,48
Ar 9,49
Ar 10,50
Ar 11,51
Ar 12,52
Ar 13,53
Ar 14,54
Ar 15,55
Vm 8,8,22
Vm 9,9,22
Vm 10,10,22
Vm 11,11,22
Vm 12,12,22
Vm 13,13,22
Vm 14,14,22
Vm 15,15,22
Aw 48,8
Aw 49,9
Aw 50,10
Aw 51,11
Aw 52,12
Aw 53,13
Aw 54,14
Aw 55,15
Ar 8,56
Ar 9,57
Ar 10,58
Ar 11,59
Ar 12,60
Ar 13,61
Ar 14,62
Ar 15,63
Vm 8,8,22
Vm 9,9,22
Vm 10,10,22
Vm 11,11,22
Vm 12,12,22
Vm 13,13,22
Vm 14,14,22
Vm 15,15,22
Aw 56,8
Aw 57,9
Aw 58,10
Aw 59,11
Aw 60,12
Aw 61,13
Aw 62,14
Aw 63,15
Ve 8,192
Ve 9,193
s_nop 0
Vc 96,8,9
Ve 8,194
Ve 9,195
s_nop 0
Vc 97,8,9
Ve 8,208
Ve 9,209
s_nop 0
Vc 104,8,9
Ve 8,210
Ve 9,211
s_nop 0
Vc 105,8,9
Ve 8,196
Ve 9,197
s_nop 0
Vc 98,8,9
Ve 8,198
Ve 9,199
s_nop 0
Vc 99,8,9
Ve 8,212
Ve 9,213
s_nop 0
Vc 106,8,9
Ve 8,214
Ve 9,215
s_nop 0
Vc 107,8,9
Ve 8,200
Ve 9,201
s_nop 0
Vc 100,8,9
Ve 8,202
Ve 9,203
s_nop 0
Vc 101,8,9
Ve 8,216
Ve 9,217
s_nop 0
Vc 108,8,9
Ve 8,218
Ve 9,219
s_nop 0
Vc 109,8,9
Ve 8,204
Ve 9,205
s_nop 0
Vc 102,8,9
Ve 8,206
Ve 9,207
s_nop 0
Vc 103,8,9
Ve 8,220
Ve 9,221
s_nop 0
Vc 110,8,9
Ve 8,222
Ve 9,223
s_nop 0
Vc 111,8,9
s_nop 1
s_branch L_k2_fbr_no
L_k2_mk_no:
s_nop 7
s_add_u32 s3, s37, 1
s_lshl_b32 s3, s3, 6
v_subrev_u32 v1, s3, v5
v_cmp_gt_i32 s[56:57], -16, v1
v_cmp_gt_i32 s[58:59], -15, v1
v_cmp_gt_i32 s[60:61], -14, v1
v_cmp_gt_i32 s[62:63], -13, v1
v_cndmask_b32 v144, v144, v20, s[56:57]
v_cndmask_b32 v145, v145, v20, s[58:59]
v_cndmask_b32 v146, v146, v20, s[60:61]
v_cndmask_b32 v147, v147, v20, s[62:63]
v_cmp_gt_i32 s[56:57], 0, v1
v_cmp_gt_i32 s[58:59], 1, v1
v_cmp_gt_i32 s[60:61], 2, v1
v_cmp_gt_i32 s[62:63], 3, v1
v_cndmask_b32 v128, v128, v20, s[56:57]
v_cndmask_b32 v129, v129, v20, s[58:59]
v_cndmask_b32 v130, v130, v20, s[60:61]
v_cndmask_b32 v131, v131, v20, s[62:63]
v_cndmask_b32 v148, v148, v20, s[56:57]
v_cndmask_b32 v149, v149, v20, s[58:59]
v_cndmask_b32 v150, v150, v20, s[60:61]
v_cndmask_b32 v151, v151, v20, s[62:63]
v_cmp_gt_i32 s[56:57], 16, v1
v_cmp_gt_i32 s[58:59], 17, v1
v_cmp_gt_i32 s[60:61], 18, v1
v_cmp_gt_i32 s[62:63], 19, v1
v_cndmask_b32 v132, v132, v20, s[56:57]
v_cndmask_b32 v133, v133, v20, s[58:59]
v_cndmask_b32 v134, v134, v20, s[60:61]
v_cndmask_b32 v135, v135, v20, s[62:63]
v_cndmask_b32 v152, v152, v20, s[56:57]
v_cndmask_b32 v153, v153, v20, s[58:59]
v_cndmask_b32 v154, v154, v20, s[60:61]
v_cndmask_b32 v155, v155, v20, s[62:63]
v_cmp_gt_i32 s[56:57], 32, v1
v_cmp_gt_i32 s[58:59], 33, v1
v_cmp_gt_i32 s[60:61], 34, v1
v_cmp_gt_i32 s[62:63], 35, v1
v_cndmask_b32 v136, v136, v20, s[56:57]
v_cndmask_b32 v137, v137, v20, s[58:59]
v_cndmask_b32 v138, v138, v20, s[60:61]
v_cndmask_b32 v139, v139, v20, s[62:63]
v_cndmask_b32 v156, v156, v20, s[56:57]
v_cndmask_b32 v157, v157, v20, s[58:59]
v_cndmask_b32 v158, v158, v20, s[60:61]
v_cndmask_b32 v159, v159, v20, s[62:63]
v_cmp_gt_i32 s[56:57], 48, v1
v_cmp_gt_i32 s[58:59], 49, v1
v_cmp_gt_i32 s[60:61], 50, v1
v_cmp_gt_i32 s[62:63], 51, v1
v_cndmask_b32 v140, v140, v20, s[56:57]
v_cndmask_b32 v141, v141, v20, s[58:59]
v_cndmask_b32 v142, v142, v20, s[60:61]
v_cndmask_b32 v143, v143, v20, s[62:63]
s_nop 1
s_branch L_k2_mkr_no
L_k2_fb_fi:
s_nop 7
s_nop 0
v_max3_f32 v21, v192, v193, v194
v_max3_f32 v21, v21, v195, v196
v_max3_f32 v21, v21, v197, v198
v_max3_f32 v21, v21, v199, v200
v_max3_f32 v21, v21, v201, v202
v_max3_f32 v21, v21, v203, v204
v_max3_f32 v21, v21, v205, v206
v_max_f32 v21, v21, v207
v_mov_b32 v1, v21
s_nop 1
v_permlane16_swap_b32 v1, v21
v_max_f32 v21, v21, v1
v_mov_b32 v1, v21
s_nop 1
v_permlane32_swap_b32 v1, v21
v_max_f32_e64 v21, v21, v1
v_add_f32 v21, 0x41f80000, v21
v_max_f32 v21, 0, v21
Vs 192,192,21
Vs 193,193,21
Vs 194,194,21
Vs 195,195,21
Vs 196,196,21
Vs 197,197,21
Vs 198,198,21
Vs 199,199,21
Vs 200,200,21
Vs 201,201,21
Vs 202,202,21
Vs 203,203,21
Vs 204,204,21
Vs 205,205,21
Vs 206,206,21
Vs 207,207,21
Vs 32,32,21
Vs 33,33,21
Vs 34,34,21
v_sub_f32_e64 v35, v35, v21
v_exp_f32 v22, -v21
s_nop 0
Vm 48,48,22
Vm 49,49,22
Vm 50,50,22
v_mul_f32_e64 v51, v51, v22
Ar 8,0
Ar 9,1
Ar 10,2
Ar 11,3
Ar 12,4
Ar 13,5
Ar 14,6
Ar 15,7
Vm 8,8,22
Vm 9,9,22
Vm 10,10,22
Vm 11,11,22
Vm 12,12,22
Vm 13,13,22
Vm 14,14,22
Vm 15,15,22
Aw 0,8
Aw 1,9
Aw 2,10
Aw 3,11
Aw 4,12
Aw 5,13
Aw 6,14
Aw 7,15
Ar 8,8
Ar 9,9
Ar 10,10
Ar 11,11
Ar 12,12
Ar 13,13
Ar 14,14
Ar 15,15
Vm 8,8,22
Vm 9,9,22
Vm 10,10,22
Vm 11,11,22
Vm 12,12,22
Vm 13,13,22
Vm 14,14,22
Vm 15,15,22
Aw 8,8
Aw 9,9
Aw 10,10
Aw 11,11
Aw 12,12
Aw 13,13
Aw 14,14
Aw 15,15
Ar 8,16
Ar 9,17
Ar 10,18
Ar 11,19
Ar 12,20
Ar 13,21
Ar 14,22
Ar 15,23
Vm 8,8,22
Vm 9,9,22
Vm 10,10,22
Vm 11,11,22
Vm 12,12,22
Vm 13,13,22
Vm 14,14,22
Vm 15,15,22
Aw 16,8
Aw 17,9
Aw 18,10
Aw 19,11
Aw 20,12
Aw 21,13
Aw 22,14
Aw 23,15
Ar 8,24
Ar 9,25
Ar 10,26
Ar 11,27
Ar 12,28
Ar 13,29
Ar 14,30
Ar 15,31
Vm 8,8,22
Vm 9,9,22
Vm 10,10,22
Vm 11,11,22
Vm 12,12,22
Vm 13,13,22
Vm 14,14,22
Vm 15,15,22
Aw 24,8
Aw 25,9
Aw 26,10
Aw 27,11
Aw 28,12
Aw 29,13
Aw 30,14
Aw 31,15
v_max3_f32 v21, v208, v209, v210
v_max3_f32 v21, v21, v211, v212
v_max3_f32 v21, v21, v213, v214
v_max3_f32 v21, v21, v215, v216
v_max3_f32 v21, v21, v217, v218
v_max3_f32 v21, v21, v219, v220
v_max3_f32 v21, v21, v221, v222
v_max_f32 v21, v21, v223
v_mov_b32 v1, v21
s_nop 1
v_permlane16_swap_b32 v1, v21
v_max_f32 v21, v21, v1
v_mov_b32 v1, v21
s_nop 1
v_permlane32_swap_b32 v1, v21
v_max_f32_e64 v21, v21, v1
v_add_f32 v21, 0x41f80000, v21
v_max_f32 v21, 0, v21
Vs 208,208,21
Vs 209,209,21
Vs 210,210,21
Vs 211,211,21
Vs 212,212,21
Vs 213,213,21
Vs 214,214,21
Vs 215,215,21
Vs 216,216,21
Vs 217,217,21
Vs 218,218,21
Vs 219,219,21
Vs 220,220,21
Vs 221,221,21
Vs 222,222,21
Vs 223,223,21
Vs 36,36,21
Vs 37,37,21
Vs 38,38,21
v_sub_f32_e64 v39, v39, v21
v_exp_f32 v22, -v21
s_nop 0
Vm 52,52,22
Vm 53,53,22
Vm 54,54,22
v_mul_f32_e64 v55, v55, v22
Ar 8,32
Ar 9,33
Ar 10,34
Ar 11,35
Ar 12,36
Ar 13,37
Ar 14,38
Ar 15,39
Vm 8,8,22
Vm 9,9,22
Vm 10,10,22
Vm 11,11,22
Vm 12,12,22
Vm 13,13,22
Vm 14,14,22
Vm 15,15,22
Aw 32,8
Aw 33,9
Aw 34,10
Aw 35,11
Aw 36,12
Aw 37,13
Aw 38,14
Aw 39,15
Ar 8,40
Ar 9,41
Ar 10,42
Ar 11,43
Ar 12,44
Ar 13,45
Ar 14,46
Ar 15,47
Vm 8,8,22
Vm 9,9,22
Vm 10,10,22
Vm 11,11,22
Vm 12,12,22
Vm 13,13,22
Vm 14,14,22
Vm 15,15,22
Aw 40,8
Aw 41,9
Aw 42,10
Aw 43,11
Aw 44,12
Aw 45,13
Aw 46,14
Aw 47,15
Ar 8,48
Ar 9,49
Ar 10,50
Ar 11,51
Ar 12,52
Ar 13,53
Ar 14,54
Ar 15,55
Vm 8,8,22
Vm 9,9,22
Vm 10,10,22
Vm 11,11,22
Vm 12,12,22
Vm 13,13,22
Vm 14,14,22
Vm 15,15,22
Aw 48,8
Aw 49,9
Aw 50,10
Aw 51,11
Aw 52,12
Aw 53,13
Aw 54,14
Aw 55,15
Ar 8,56
Ar 9,57
Ar 10,58
Ar 11,59
Ar 12,60
Ar 13,61
Ar 14,62
Ar 15,63
Vm 8,8,22
Vm 9,9,22
Vm 10,10,22
Vm 11,11,22
Vm 12,12,22
Vm 13,13,22
Vm 14,14,22
Vm 15,15,22
Aw 56,8
Aw 57,9
Aw 58,10
Aw 59,11
Aw 60,12
Aw 61,13
Aw 62,14
Aw 63,15
Ve 8,192
Ve 9,193
s_nop 0
Vc 96,8,9
Ve 8,194
Ve 9,195
s_nop 0
Vc 97,8,9
Ve 8,208
Ve 9,209
s_nop 0
Vc 104,8,9
Ve 8,210
Ve 9,211
s_nop 0
Vc 105,8,9
Ve 8,196
Ve 9,197
s_nop 0
Vc 98,8,9
Ve 8,198
Ve 9,199
s_nop 0
Vc 99,8,9
Ve 8,212
Ve 9,213
s_nop 0
Vc 106,8,9
Ve 8,214
Ve 9,215
s_nop 0
Vc 107,8,9
Ve 8,200
Ve 9,201
s_nop 0
Vc 100,8,9
Ve 8,202
Ve 9,203
s_nop 0
Vc 101,8,9
Ve 8,216
Ve 9,217
s_nop 0
Vc 108,8,9
Ve 8,218
Ve 9,219
s_nop 0
Vc 109,8,9
Ve 8,204
Ve 9,205
s_nop 0
Vc 102,8,9
Ve 8,206
Ve 9,207
s_nop 0
Vc 103,8,9
Ve 8,220
Ve 9,221
s_nop 0
Vc 110,8,9
Ve 8,222
Ve 9,223
s_nop 0
Vc 111,8,9
s_nop 1
s_branch L_k2_fbr_fi
L_spinC:
s_mov_b32 s47, 0x400000
L_spinC_l:
s_sleep 4
buffer_load_dword v124, v127, s[20:23], s38 offen sc1
s_sub_u32 s47, s47, 1
s_cmp_eq_u32 s47, 0
s_cbranch_scc1 L_spinCx
s_waitcnt vmcnt(0)
v_cmp_ne_u32 vcc, 1, v124
s_cbranch_vccnz L_spinC_l
L_spinCx:
s_waitcnt vmcnt(0)
s_branch L_spinCr
L_f2A:
s_and_b32 s39, s2, 15
s_lshr_b32 s37, s2, 4
s_sub_u32 s37, s37, 9
s_lshl_b32 s4, s37, 2
s_add_u32 s4, s4, s32
s_lshl_b32 s3, s4, 18
s_lshl_b32 s7, s39, 7
s_add_u32 s3, s3, s7
v_and_b32 v124, 0xffff, v114
v_add_u32 v124, s3, v124
s_cmp_eq_u32 s32, 0
s_cselect_b32 s5, 128, s64
buffer_load_dword v125, v126, s[28:31], s5 offen sc1
s_add_u32 m0, s35, 16384
s_nop 0
buffer_load_dwordx4 v124, s[60:63], s48 offen offset:0 lds
buffer_load_dwordx4 v124, s[60:63], s49 offen offset:1024 lds
buffer_load_dwordx4 v124, s[60:63], s50 offen offset:2048 lds
buffer_load_dwordx4 v124, s[60:63], s51 offen offset:3072 lds
v_add_u32 v124, 65536, v124
s_add_u32 m0, s35, 20480
s_nop 0
s_nop 0
buffer_load_dwordx4 v124, s[60:63], s48 offen offset:0 lds
buffer_load_dwordx4 v124, s[60:63], s49 offen offset:1024 lds
buffer_load_dwordx4 v124, s[60:63], s50 offen offset:2048 lds
buffer_load_dwordx4 v124, s[60:63], s51 offen offset:3072 lds
v_add_u32 v124, 65536, v124
s_add_u32 m0, s35, 24576
s_nop 0
s_nop 0
buffer_load_dwordx4 v124, s[60:63], s48 offen offset:0 lds
buffer_load_dwordx4 v124, s[60:63], s49 offen offset:1024 lds
buffer_load_dwordx4 v124, s[60:63], s50 offen offset:2048 lds
buffer_load_dwordx4 v124, s[60:63], s51 offen offset:3072 lds
v_add_u32 v124, 65536, v124
s_add_u32 m0, s35, 28672
s_nop 0
buffer_load_dwordx4 v124, s[60:63], s48 offen offset:0 lds
buffer_load_dwordx4 v124, s[60:63], s49 offen offset:1024 lds
buffer_load_dwordx4 v124, s[60:63], s50 offen offset:2048 lds
buffer_load_dwordx4 v124, s[60:63], s51 offen offset:3072 lds
s_branch L_f2Ar
L_f2B:
s_waitcnt vmcnt(24)
v_readfirstlane_b32 s3, v125
s_cmp_lg_u32 s32, 0
s_cbranch_scc1 L_f2lx
s_cmp_ge_u32 s3, 224
s_cbranch_scc1 L_f2lx
s_mov_b32 s47, 0x400000
L_f2l:
buffer_load_dword v124, v126, s[28:31], s5 offen sc1
s_waitcnt vmcnt(0)
v_readfirstlane_b32 s3, v124
s_sub_u32 s47, s47, 1
s_cmp_eq_u32 s47, 0
s_cbranch_scc1 L_f2lx
s_cmp_ge_u32 s3, 224
s_cbranch_scc1 L_f2lx
s_sleep 8
s_branch L_f2l
L_f2lx:
s_barrier
s_lshl_b32 s3, s4, 9
s_add_u32 s3, s3, 6291456
v_mul_u32_u24 v124, 14336, v121
v_and_b32 v125, 15, v0
v_lshl_add_u32 v124, v125, 4, v124
buffer_load_dwordx4 a[160:163], v124, s[20:23], s3 offen offset:0 sc1
buffer_load_dwordx4 a[164:167], v124, s[20:23], s3 offen offset:256 sc1
s_add_u32 s3, s3, 57344
buffer_load_dwordx4 a[168:171], v124, s[20:23], s3 offen offset:0 sc1
buffer_load_dwordx4 a[172:175], v124, s[20:23], s3 offen offset:256 sc1
s_add_u32 s3, s3, 57344
buffer_load_dwordx4 a[176:179], v124, s[20:23], s3 offen offset:0 sc1
buffer_load_dwordx4 a[180:183], v124, s[20:23], s3 offen offset:256 sc1
s_add_u32 s3, s3, 57344
buffer_load_dwordx4 a[184:187], v124, s[20:23], s3 offen offset:0 sc1
buffer_load_dwordx4 a[188:191], v124, s[20:23], s3 offen offset:256 sc1
s_add_u32 s3, s3, 57344
buffer_load_dwordx4 a[192:195], v124, s[20:23], s3 offen offset:0 sc1
buffer_load_dwordx4 a[196:199], v124, s[20:23], s3 offen offset:256 sc1
s_add_u32 s3, s3, 57344
buffer_load_dwordx4 a[200:203], v124, s[20:23], s3 offen offset:0 sc1
buffer_load_dwordx4 a[204:207], v124, s[20:23], s3 offen offset:256 sc1
s_add_u32 s3, s3, 57344
buffer_load_dwordx4 a[208:211], v124, s[20:23], s3 offen offset:0 sc1
buffer_load_dwordx4 a[212:215], v124, s[20:23], s3 offen offset:256 sc1
s_add_u32 s3, s3, 57344
buffer_load_dwordx4 a[216:219], v124, s[20:23], s3 offen offset:0 sc1
buffer_load_dwordx4 a[220:223], v124, s[20:23], s3 offen offset:256 sc1
s_branch L_f2Br
L_f2C:
s_waitcnt vmcnt(24) lgkmcnt(0)
Ar 74,160
Ar 75,161
Ar 76,162
Ar 77,163
Ar 78,164
Ar 79,165
Ar 80,166
Ar 81,167
Ar 90,168
Ar 91,169
Ar 92,170
Ar 93,171
Ar 94,172
Ar 95,173
Ar 96,174
Ar 97,175
v_pk_add_f32 v[74:75], v[74:75], v[90:91]
v_pk_add_f32 v[76:77], v[76:77], v[92:93]
v_pk_add_f32 v[78:79], v[78:79], v[94:95]
v_pk_add_f32 v[80:81], v[80:81], v[96:97]
Ta 160,115,16384
Ta 162,115,18432
Ta 164,116,16384
Ta 166,116,18432
Ta 168,117,16384
Ta 170,117,18432
Ta 172,118,16384
Ta 174,118,18432
Ar 82,176
Ar 83,177
Ar 84,178
Ar 85,179
Ar 86,180
Ar 87,181
Ar 88,182
Ar 89,183
v_pk_add_f32 v[74:75], v[74:75], v[82:83]
v_pk_add_f32 v[76:77], v[76:77], v[84:85]
v_pk_add_f32 v[78:79], v[78:79], v[86:87]
v_pk_add_f32 v[80:81], v[80:81], v[88:89]
Ar 90,184
Ar 91,185
Ar 92,186
Ar 93,187
Ar 94,188
Ar 95,189
Ar 96,190
Ar 97,191
v_pk_add_f32 v[74:75], v[74:75], v[90:91]
v_pk_add_f32 v[76:77], v[76:77], v[92:93]
v_pk_add_f32 v[78:79], v[78:79], v[94:95]
v_pk_add_f32 v[80:81], v[80:81], v[96:97]
Ta 176,115,20480
Ta 178,115,22528
Ta 180,116,20480
Ta 182,116,22528
Ta 184,117,20480
Ta 186,117,22528
Ta 188,118,20480
s_waitcnt lgkmcnt(9)
s_nop 0
Ta 190,118,22528
Ar 82,192
Ar 83,193
Ar 84,194
Ar 85,195
Ar 86,196
Ar 87,197
Ar 88,198
Ar 89,199
v_pk_add_f32 v[74:75], v[74:75], v[82:83]
v_pk_add_f32 v[76:77], v[76:77], v[84:85]
v_pk_add_f32 v[78:79], v[78:79], v[86:87]
v_pk_add_f32 v[80:81], v[80:81], v[88:89]
Ar 90,200
Ar 91,201
Ar 92,202
Ar 93,203
Ar 94,204
Ar 95,205
Ar 96,206
Ar 97,207
v_pk_add_f32 v[74:75], v[74:75], v[90:91]
v_pk_add_f32 v[76:77], v[76:77], v[92:93]
v_pk_add_f32 v[78:79], v[78:79], v[94:95]
v_pk_add_f32 v[80:81], v[80:81], v[96:97]
Ta 192,115,24576
Ta 194,115,26624
Ta 196,116,24576
Ta 198,116,26624
Ta 200,117,24576
s_waitcnt lgkmcnt(9)
s_nop 0
Ta 202,117,26624
Ta 204,118,24576
Ta 206,118,26624
Ar 82,208
Ar 83,209
Ar 84,210
Ar 85,211
Ar 86,212
Ar 87,213
Ar 88,214
Ar 89,215
v_pk_add_f32 v[74:75], v[74:75], v[82:83]
v_pk_add_f32 v[76:77], v[76:77], v[84:85]
v_pk_add_f32 v[78:79], v[78:79], v[86:87]
v_pk_add_f32 v[80:81], v[80:81], v[88:89]
Ar 90,216
Ar 91,217
Ar 92,218
Ar 93,219
Ar 94,220
Ar 95,221
Ar 96,222
Ar 97,223
v_pk_add_f32 v[74:75], v[74:75], v[90:91]
v_pk_add_f32 v[76:77], v[76:77], v[92:93]
v_pk_add_f32 v[78:79], v[78:79], v[94:95]
v_pk_add_f32 v[80:81], v[80:81], v[96:97]
Ta 208,115,28672
Ta 210,115,30720
Ta 212,116,28672
s_waitcnt lgkmcnt(9)
s_nop 0
Ta 214,116,30720
Ta 216,117,28672
Ta 218,117,30720
Ta 220,118,28672
Ta 222,118,30720
Vc 125,74,75
v_lshlrev_b32_e64 v74, 16, v125
v_and_b32 v75, 0xffff0000, v125
Vc 125,76,77
v_lshlrev_b32_e64 v76, 16, v125
v_and_b32 v77, 0xffff0000, v125
Vc 125,78,79
v_lshlrev_b32_e64 v78, 16, v125
v_and_b32 v79, 0xffff0000, v125
Vc 125,80,81
v_lshlrev_b32_e64 v80, 16, v125
v_and_b32 v81, 0xffff0000, v125
v_mov_b32 v82, v74
v_mov_b32 v83, v75
v_mov_b32 v84, v76
v_mov_b32 v85, v77
v_mov_b32 v86, v78
v_mov_b32 v87, v79
v_mov_b32 v88, v80
v_mov_b32 v89, v81
v_permlane32_swap_b32 v82, v74
v_permlane32_swap_b32 v83, v75
v_permlane32_swap_b32 v84, v76
v_permlane32_swap_b32 v85, v77
v_permlane32_swap_b32 v86, v78
v_permlane32_swap_b32 v87, v79
v_permlane32_swap_b32 v88, v80
v_permlane32_swap_b32 v89, v81
v_mul_f32 v90, 0xbfb8aa3b, v82
v_mul_f32 v91, 0xbfb8aa3b, v83
v_mul_f32 v92, 0xbfb8aa3b, v84
v_mul_f32 v93, 0xbfb8aa3b, v85
v_mul_f32 v94, 0xbfb8aa3b, v86
v_mul_f32 v95, 0xbfb8aa3b, v87
v_mul_f32 v96, 0xbfb8aa3b, v88
v_mul_f32 v97, 0xbfb8aa3b, v89
Ve 90,90
Ve 91,91
Ve 92,92
Ve 93,93
Ve 94,94
Ve 95,95
Ve 96,96
Ve 97,97
v_add_f32 v90, 1.0, v90
v_add_f32 v91, 1.0, v91
v_add_f32 v92, 1.0, v92
v_add_f32 v93, 1.0, v93
v_add_f32 v94, 1.0, v94
v_add_f32 v95, 1.0, v95
v_add_f32 v96, 1.0, v96
v_add_f32 v97, 1.0, v97
v_rcp_f32 v90, v90
v_rcp_f32 v91, v91
v_rcp_f32 v92, v92
v_rcp_f32 v93, v93
v_rcp_f32 v94, v94
v_rcp_f32 v95, v95
v_rcp_f32 v96, v96
v_rcp_f32 v97, v97
Vm 82,82,90
Vm 83,83,91
Vm 84,84,92
Vm 85,85,93
Vm 86,86,94
Vm 87,87,95
Vm 88,88,96
Vm 89,89,97
Vc 125,82,83
v_lshlrev_b32_e64 v82, 16, v125
v_and_b32 v83, 0xffff0000, v125
Vc 125,84,85
v_lshlrev_b32_e64 v84, 16, v125
v_and_b32 v85, 0xffff0000, v125
Vc 125,86,87
v_lshlrev_b32_e64 v86, 16, v125
v_and_b32 v87, 0xffff0000, v125
Vc 125,88,89
v_lshlrev_b32_e64 v88, 16, v125
v_and_b32 v89, 0xffff0000, v125
Vm 74,74,82
Vm 75,75,83
Vm 76,76,84
Vm 77,77,85
Vm 78,78,86
Vm 79,79,87
Vm 80,80,88
Vm 81,81,89
Vc 90,74,75
Vc 91,76,77
Vc 92,78,79
Vc 93,80,81
s_lshl_b32 s7, s32, 9
s_add_u32 s7, s7, 131072
v_and_b32 v124, 1, v121
v_lshlrev_b32 v124, 8, v124
v_and_b32 v125, 15, v0
v_lshl_add_u32 v124, v125, 3, v124
v_add_u32_e64 v124, s7, v124
ds_write_b64 v124, v[90:91]
s_waitcnt lgkmcnt(9)
ds_write_b64 v124, v[92:93] offset:128
v_and_b32 v124, 1, v0
v_lshlrev_b32_e64 v124, 8, v124
v_lshl_add_u32 v94, v121, 3, v124
v_add_u32_e64 v94, s7, v94
ds_read_b64 v[74:75], v94 offset:0
ds_read_b64 v[76:77], v94 offset:32
ds_read_b64 v[78:79], v94 offset:64
ds_read_b64 v[80:81], v94 offset:96
ds_read_b64 v[82:83], v94 offset:128
s_waitcnt lgkmcnt(9)
ds_read_b64 v[84:85], v94 offset:160
ds_read_b64 v[86:87], v94 offset:192
ds_read_b64 v[88:89], v94 offset:224
v_lshl_add_u32 v124, v121, 4, v124
v_add_u32 v124, s7, v124
s_waitcnt lgkmcnt(0)
Zvav 96,160,74
Zvav 100,164,74
Zvav 104,168,74
Zvav 108,172,74
Mvav 96,176,78
Mvav 100,180,78
Mvav 104,184,78
Mvav 108,188,78
Mvav 96,192,82
Mvav 100,196,82
Mvav 104,200,82
Mvav 108,204,82
Mvav 96,208,86
Mvav 100,212,86
Mvav 104,216,86
Mvav 108,220,86
s_nop 4
ds_write_b128 v124, v[96:99] offset:2048
ds_write_b128 v124, v[100:103] offset:2112
ds_write_b128 v124, v[104:107] offset:2176
ds_write_b128 v124, v[108:111] offset:2240
s_waitcnt lgkmcnt(0)
s_barrier
s_cmp_lg_u32 s32, 0
s_cbranch_scc1 L_f2Cr
v_lshlrev_b32_e64 v124, 3, v0
v_add_u32 v125, 133120, v124
ds_read_b64 v[74:75], v125 offset:0
ds_read_b64 v[76:77], v125 offset:512
ds_read_b64 v[78:79], v125 offset:1024
ds_read_b64 v[80:81], v125 offset:1536
s_lshl_b32 s3, s39, 3
s_add_u32 s3, s3, s37
s_lshl_b32 s3, s3, 9
s_add_u32 s3, s3, 5308416
s_waitcnt lgkmcnt(0)
v_pk_add_f32 v[74:75], v[74:75], v[76:77]
v_pk_add_f32 v[78:79], v[78:79], v[80:81]
v_pk_add_f32 v[74:75], v[74:75], v[78:79]
buffer_store_dwordx2 v[74:75], v124, s[20:23], s3 offen sc1
s_branch L_f2Cr
L_f2E:
s_cmp_lg_u32 s32, 0
s_cbranch_scc1 L_f2Er
v_mov_b32 v125, 1
s_lshl_b32 s3, s39, 2
s_add_u32 s3, s3, 4
s_waitcnt vmcnt(24)
s_mov_b64 exec, 1
buffer_atomic_add v125, v126, s[28:31], s3 offen sc1
s_mov_b64 exec, -1
s_branch L_f2Er
L_yA:
buffer_load_dword v124, v126, s[28:31], s41 offen sc1
s_branch L_yAr
L_yB:
s_waitcnt vmcnt(24)
v_readfirstlane_b32 s3, v124
s_nop 0
s_cmp_lt_u32 s3, 7
s_cbranch_scc1 L_yBr
s_mov_b32 s40, 1
v_lshlrev_b32 v125, 9, v123
v_lshl_add_u32 v125, v122, 5, v125
v_mov_b32 v124, 2146435072
v_cmp_gt_u32 vcc, 7, v123
s_nop 1
v_cndmask_b32 v125, v124, v125, vcc
buffer_load_dwordx4 v[80:83], v125, s[20:23], s44 offen offset:0 sc1
buffer_load_dwordx4 v[84:87], v125, s[20:23], s44 offen offset:16 sc1
buffer_load_dwordx4 v[88:91], v125, s[20:23], s44 offen offset:256 sc1
buffer_load_dwordx4 v[92:95], v125, s[20:23], s44 offen offset:272 sc1
s_branch L_yBr
L_yC:
s_waitcnt vmcnt(8)
s_nop 0
v_add_f32_dpp v80, v80, v80 row_ror:8 row_mask:0xf bank_mask:0xf
v_add_f32_dpp v81, v81, v81 row_ror:8 row_mask:0xf bank_mask:0xf
v_add_f32_dpp v82, v82, v82 row_ror:8 row_mask:0xf bank_mask:0xf
v_add_f32_dpp v83, v83, v83 row_ror:8 row_mask:0xf bank_mask:0xf
v_add_f32_dpp v84, v84, v84 row_ror:8 row_mask:0xf bank_mask:0xf
v_add_f32_dpp v85, v85, v85 row_ror:8 row_mask:0xf bank_mask:0xf
v_add_f32_dpp v86, v86, v86 row_ror:8 row_mask:0xf bank_mask:0xf
v_add_f32_dpp v87, v87, v87 row_ror:8 row_mask:0xf bank_mask:0xf
v_add_f32_dpp v88, v88, v88 row_ror:8 row_mask:0xf bank_mask:0xf
v_add_f32_dpp v89, v89, v89 row_ror:8 row_mask:0xf bank_mask:0xf
v_add_f32_dpp v90, v90, v90 row_ror:8 row_mask:0xf bank_mask:0xf
v_add_f32_dpp v91, v91, v91 row_ror:8 row_mask:0xf bank_mask:0xf
v_add_f32_dpp v92, v92, v92 row_ror:8 row_mask:0xf bank_mask:0xf
v_add_f32_dpp v93, v93, v93 row_ror:8 row_mask:0xf bank_mask:0xf
v_add_f32_dpp v94, v94, v94 row_ror:8 row_mask:0xf bank_mask:0xf
v_add_f32_dpp v95, v95, v95 row_ror:8 row_mask:0xf bank_mask:0xf
v_mov_b32 v96, v80
v_mov_b32 v97, v81
v_mov_b32 v98, v82
v_mov_b32 v99, v83
v_mov_b32 v100, v84
v_mov_b32 v101, v85
v_mov_b32 v102, v86
v_mov_b32 v103, v87
v_mov_b32 v104, v88
v_mov_b32 v105, v89
v_mov_b32 v106, v90
v_mov_b32 v107, v91
v_mov_b32 v108, v92
v_mov_b32 v109, v93
v_mov_b32 v110, v94
v_mov_b32 v111, v95
v_permlane16_swap_b32 v96, v80
v_permlane16_swap_b32 v97, v81
v_permlane16_swap_b32 v98, v82
v_permlane16_swap_b32 v99, v83
v_permlane16_swap_b32 v100, v84
v_permlane16_swap_b32 v101, v85
v_permlane16_swap_b32 v102, v86
v_permlane16_swap_b32 v103, v87
v_permlane16_swap_b32 v104, v88
v_permlane16_swap_b32 v105, v89
v_permlane16_swap_b32 v106, v90
v_permlane16_swap_b32 v107, v91
v_permlane16_swap_b32 v108, v92
v_permlane16_swap_b32 v109, v93
v_permlane16_swap_b32 v110, v94
v_permlane16_swap_b32 v111, v95
Va 80,80,96
Va 81,81,97
Va 82,82,98
Va 83,83,99
Va 84,84,100
Va 85,85,101
Va 86,86,102
Va 87,87,103
Va 88,88,104
Va 89,89,105
Va 90,90,106
Va 91,91,107
Va 92,92,108
Va 93,93,109
Va 94,94,110
Va 95,95,111
v_mov_b32 v96, v80
v_mov_b32 v97, v81
v_mov_b32 v98, v82
v_mov_b32 v99, v83
v_mov_b32 v100, v84
v_mov_b32 v101, v85
v_mov_b32 v102, v86
v_mov_b32 v103, v87
v_mov_b32 v104, v88
v_mov_b32 v105, v89
v_mov_b32 v106, v90
v_mov_b32 v107, v91
v_mov_b32 v108, v92
v_mov_b32 v109, v93
v_mov_b32 v110, v94
v_mov_b32 v111, v95
v_permlane32_swap_b32 v96, v80
v_permlane32_swap_b32 v97, v81
v_permlane32_swap_b32 v98, v82
v_permlane32_swap_b32 v99, v83
v_permlane32_swap_b32 v100, v84
v_permlane32_swap_b32 v101, v85
v_permlane32_swap_b32 v102, v86
v_permlane32_swap_b32 v103, v87
v_permlane32_swap_b32 v104, v88
v_permlane32_swap_b32 v105, v89
v_permlane32_swap_b32 v106, v90
v_permlane32_swap_b32 v107, v91
v_permlane32_swap_b32 v108, v92
v_permlane32_swap_b32 v109, v93
v_permlane32_swap_b32 v110, v94
v_permlane32_swap_b32 v111, v95
Va 80,80,96
Va 81,81,97
Va 82,82,98
Va 83,83,99
Va 84,84,100
Va 85,85,101
Va 86,86,102
Va 87,87,103
Va 88,88,104
Va 89,89,105
Va 90,90,106
Va 91,91,107
Va 92,92,108
Va 93,93,109
Va 94,94,110
Va 95,95,111
Vc 124,80,81
v_lshlrev_b32_e64 v80, 16, v124
v_and_b32 v81, 0xffff0000, v124
Vc 124,82,83
v_lshlrev_b32_e64 v82, 16, v124
v_and_b32 v83, 0xffff0000, v124
Vc 124,84,85
v_lshlrev_b32_e64 v84, 16, v124
v_and_b32 v85, 0xffff0000, v124
Vc 124,86,87
v_lshlrev_b32_e64 v86, 16, v124
v_and_b32 v87, 0xffff0000, v124
Vc 124,88,89
v_lshlrev_b32_e64 v88, 16, v124
v_and_b32 v89, 0xffff0000, v124
Vc 124,90,91
v_lshlrev_b32_e64 v90, 16, v124
v_and_b32 v91, 0xffff0000, v124
Vc 124,92,93
v_lshlrev_b32_e64 v92, 16, v124
v_and_b32 v93, 0xffff0000, v124
Vc 124,94,95
v_lshlrev_b32_e64 v94, 16, v124
v_and_b32 v95, 0xffff0000, v124
v_mul_f32 v80, s100, v80
v_mul_f32 v81, s100, v81
v_mul_f32 v82, s100, v82
v_mul_f32 v83, s100, v83
v_mul_f32 v84, s100, v84
v_mul_f32 v85, s100, v85
v_mul_f32 v86, s100, v86
v_mul_f32 v87, s100, v87
v_mul_f32 v88, s101, v88
v_mul_f32 v89, s101, v89
v_mul_f32 v90, s101, v90
v_mul_f32 v91, s101, v91
v_mul_f32 v92, s101, v92
v_mul_f32 v93, s101, v93
v_mul_f32 v94, s101, v94
v_mul_f32 v95, s101, v95
Vc 124,80,81
v_lshlrev_b32_e64 v80, 16, v124
v_and_b32 v81, 0xffff0000, v124
Vc 124,82,83
v_lshlrev_b32_e64 v82, 16, v124
v_and_b32 v83, 0xffff0000, v124
Vc 124,84,85
v_lshlrev_b32_e64 v84, 16, v124
v_and_b32 v85, 0xffff0000, v124
Vc 124,86,87
v_lshlrev_b32_e64 v86, 16, v124
v_and_b32 v87, 0xffff0000, v124
Vc 124,88,89
v_lshlrev_b32_e64 v88, 16, v124
v_and_b32 v89, 0xffff0000, v124
Vc 124,90,91
v_lshlrev_b32_e64 v90, 16, v124
v_and_b32 v91, 0xffff0000, v124
Vc 124,92,93
v_lshlrev_b32_e64 v92, 16, v124
v_and_b32 v93, 0xffff0000, v124
Vc 124,94,95
v_lshlrev_b32_e64 v94, 16, v124
v_and_b32 v95, 0xffff0000, v124
s_lshl_b32 s3, s45, 7
s_sub_u32 s42, s42, s3
s_sub_u32 s43, s43, s3
v_add_u32 v124, 0, v120
v_cmp_eq_u32 vcc, s42, v124
v_cmp_eq_u32 s[6:7], s43, v124
s_nop 3
s_or_b64 s[4:5], vcc, s[6:7]
s_cbranch_scc0 L_f_selskip1
v_cndmask_b32 v96, 0, v80, vcc
v_cndmask_b32 v96, v96, v88, s[6:7]
v_cndmask_b32 v97, 0, v81, vcc
v_cndmask_b32 v97, v97, v89, s[6:7]
v_cndmask_b32 v98, 0, v82, vcc
v_cndmask_b32 v98, v98, v90, s[6:7]
v_cndmask_b32 v99, 0, v83, vcc
v_cndmask_b32 v99, v99, v91, s[6:7]
v_cndmask_b32 v100, 0, v84, vcc
v_cndmask_b32 v100, v100, v92, s[6:7]
v_cndmask_b32 v101, 0, v85, vcc
v_cndmask_b32 v101, v101, v93, s[6:7]
v_cndmask_b32 v102, 0, v86, vcc
v_cndmask_b32 v102, v102, v94, s[6:7]
v_cndmask_b32 v103, 0, v87, vcc
v_cndmask_b32 v103, v103, v95, s[6:7]
v_lshlrev_b32_e64 v42, 16, v18
v_and_b32 v43, 0xffff0000, v18
v_lshlrev_b32_e64 v44, 16, v19
v_and_b32 v45, 0xffff0000, v19
v_lshlrev_b32_e64 v46, 16, v20
v_and_b32 v47, 0xffff0000, v20
v_lshlrev_b32_e64 v48, 16, v21
v_and_b32 v49, 0xffff0000, v21
Vs 42,42,34
Vs 43,43,34
Vs 44,44,34
Vs 45,45,34
Vs 46,46,34
Vs 47,47,34
Vs 48,48,34
Vs 49,49,34
Vc 2,42,43
v_lshlrev_b32_e64 v42, 16, v2
v_and_b32 v43, 0xffff0000, v2
Vc 3,44,45
v_lshlrev_b32_e64 v44, 16, v3
v_and_b32 v45, 0xffff0000, v3
Vc 4,46,47
v_lshlrev_b32_e64 v46, 16, v4
v_and_b32 v47, 0xffff0000, v4
Vc 5,48,49
v_lshlrev_b32_e64 v48, 16, v5
v_and_b32 v49, 0xffff0000, v5
Vm 42,42,35
Vm 43,43,35
Vm 44,44,35
Vm 45,45,35
Vm 46,46,35
Vm 47,47,35
Vm 48,48,35
Vm 49,49,35
Vc 2,42,43
v_lshlrev_b32_e64 v42, 16, v2
v_and_b32 v43, 0xffff0000, v2
Vc 3,44,45
v_lshlrev_b32_e64 v44, 16, v3
v_and_b32 v45, 0xffff0000, v3
Vc 4,46,47
v_lshlrev_b32_e64 v46, 16, v4
v_and_b32 v47, 0xffff0000, v4
Vc 5,48,49
v_lshlrev_b32_e64 v48, 16, v5
v_and_b32 v49, 0xffff0000, v5
Va 42,42,96
Va 43,43,97
Va 44,44,98
Va 45,45,99
Va 46,46,100
Va 47,47,101
Va 48,48,102
Va 49,49,103
Vc 2,42,43
v_lshlrev_b32_e64 v42, 16, v2
v_and_b32 v43, 0xffff0000, v2
Vc 3,44,45
v_lshlrev_b32_e64 v44, 16, v3
v_and_b32 v45, 0xffff0000, v3
Vc 4,46,47
v_lshlrev_b32_e64 v46, 16, v4
v_and_b32 v47, 0xffff0000, v4
Vc 5,48,49
v_lshlrev_b32_e64 v48, 16, v5
v_and_b32 v49, 0xffff0000, v5
v_mul_f32 v2, 0xbfb8aa3b, v42
v_mul_f32 v3, 0xbfb8aa3b, v43
v_mul_f32 v4, 0xbfb8aa3b, v44
v_mul_f32 v5, 0xbfb8aa3b, v45
v_mul_f32 v6, 0xbfb8aa3b, v46
v_mul_f32 v7, 0xbfb8aa3b, v47
v_mul_f32 v8, 0xbfb8aa3b, v48
v_mul_f32 v9, 0xbfb8aa3b, v49
Ve 2,2
Ve 3,3
Ve 4,4
Ve 5,5
Ve 6,6
Ve 7,7
Ve 8,8
Ve 9,9
v_add_f32 v2, 1.0, v2
v_add_f32 v3, 1.0, v3
v_add_f32 v4, 1.0, v4
v_add_f32 v5, 1.0, v5
v_add_f32 v6, 1.0, v6
v_add_f32 v7, 1.0, v7
v_add_f32 v8, 1.0, v8
v_add_f32 v9, 1.0, v9
v_rcp_f32 v2, v2
v_rcp_f32 v3, v3
v_rcp_f32 v4, v4
v_rcp_f32 v5, v5
v_rcp_f32 v6, v6
v_rcp_f32 v7, v7
v_rcp_f32 v8, v8
v_rcp_f32 v9, v9
Vm 42,42,2
Vm 43,43,3
Vm 44,44,4
Vm 45,45,5
Vm 46,46,6
Vm 47,47,7
Vm 48,48,8
Vm 49,49,9
Vc 2,42,43
v_lshlrev_b32_e64 v42, 16, v2
v_and_b32 v43, 0xffff0000, v2
Vc 3,44,45
v_lshlrev_b32_e64 v44, 16, v3
v_and_b32 v45, 0xffff0000, v3
Vc 4,46,47
v_lshlrev_b32_e64 v46, 16, v4
v_and_b32 v47, 0xffff0000, v4
Vc 5,48,49
v_lshlrev_b32_e64 v48, 16, v5
v_and_b32 v49, 0xffff0000, v5
L_f_selskip1:
v_add_u32 v124, 32, v120
v_cmp_eq_u32 vcc, s42, v124
v_cmp_eq_u32 s[6:7], s43, v124
s_nop 3
s_or_b64 s[4:5], vcc, s[6:7]
s_cbranch_scc0 L_f_selskip2
v_cndmask_b32 v96, 0, v80, vcc
v_cndmask_b32 v96, v96, v88, s[6:7]
v_cndmask_b32 v97, 0, v81, vcc
v_cndmask_b32 v97, v97, v89, s[6:7]
v_cndmask_b32 v98, 0, v82, vcc
v_cndmask_b32 v98, v98, v90, s[6:7]
v_cndmask_b32 v99, 0, v83, vcc
v_cndmask_b32 v99, v99, v91, s[6:7]
v_cndmask_b32 v100, 0, v84, vcc
v_cndmask_b32 v100, v100, v92, s[6:7]
v_cndmask_b32 v101, 0, v85, vcc
v_cndmask_b32 v101, v101, v93, s[6:7]
v_cndmask_b32 v102, 0, v86, vcc
v_cndmask_b32 v102, v102, v94, s[6:7]
v_cndmask_b32 v103, 0, v87, vcc
v_cndmask_b32 v103, v103, v95, s[6:7]
v_lshlrev_b32 v50, 16, v22
v_and_b32 v51, 0xffff0000, v22
v_lshlrev_b32_e64 v52, 16, v23
v_and_b32 v53, 0xffff0000, v23
v_lshlrev_b32_e64 v54, 16, v24
v_and_b32 v55, 0xffff0000, v24
v_lshlrev_b32_e64 v56, 16, v25
v_and_b32 v57, 0xffff0000, v25
Vs 50,50,36
Vs 51,51,36
Vs 52,52,36
Vs 53,53,36
Vs 54,54,36
Vs 55,55,36
Vs 56,56,36
Vs 57,57,36
Vc 2,50,51
v_lshlrev_b32_e64 v50, 16, v2
v_and_b32 v51, 0xffff0000, v2
Vc 3,52,53
v_lshlrev_b32_e64 v52, 16, v3
v_and_b32 v53, 0xffff0000, v3
Vc 4,54,55
v_lshlrev_b32_e64 v54, 16, v4
v_and_b32 v55, 0xffff0000, v4
Vc 5,56,57
v_lshlrev_b32_e64 v56, 16, v5
v_and_b32 v57, 0xffff0000, v5
Vm 50,50,37
Vm 51,51,37
Vm 52,52,37
Vm 53,53,37
Vm 54,54,37
Vm 55,55,37
Vm 56,56,37
Vm 57,57,37
Vc 2,50,51
v_lshlrev_b32_e64 v50, 16, v2
v_and_b32 v51, 0xffff0000, v2
Vc 3,52,53
v_lshlrev_b32_e64 v52, 16, v3
v_and_b32 v53, 0xffff0000, v3
Vc 4,54,55
v_lshlrev_b32_e64 v54, 16, v4
v_and_b32 v55, 0xffff0000, v4
Vc 5,56,57
v_lshlrev_b32_e64 v56, 16, v5
v_and_b32 v57, 0xffff0000, v5
Va 50,50,96
Va 51,51,97
Va 52,52,98
Va 53,53,99
Va 54,54,100
Va 55,55,101
Va 56,56,102
Va 57,57,103
Vc 2,50,51
v_lshlrev_b32_e64 v50, 16, v2
v_and_b32 v51, 0xffff0000, v2
Vc 3,52,53
v_lshlrev_b32_e64 v52, 16, v3
v_and_b32 v53, 0xffff0000, v3
Vc 4,54,55
v_lshlrev_b32_e64 v54, 16, v4
v_and_b32 v55, 0xffff0000, v4
Vc 5,56,57
v_lshlrev_b32_e64 v56, 16, v5
v_and_b32 v57, 0xffff0000, v5
v_mul_f32 v2, 0xbfb8aa3b, v50
v_mul_f32 v3, 0xbfb8aa3b, v51
v_mul_f32 v4, 0xbfb8aa3b, v52
v_mul_f32 v5, 0xbfb8aa3b, v53
v_mul_f32 v6, 0xbfb8aa3b, v54
v_mul_f32 v7, 0xbfb8aa3b, v55
v_mul_f32 v8, 0xbfb8aa3b, v56
v_mul_f32 v9, 0xbfb8aa3b, v57
Ve 2,2
Ve 3,3
Ve 4,4
Ve 5,5
Ve 6,6
Ve 7,7
Ve 8,8
Ve 9,9
v_add_f32 v2, 1.0, v2
v_add_f32 v3, 1.0, v3
v_add_f32 v4, 1.0, v4
v_add_f32 v5, 1.0, v5
v_add_f32 v6, 1.0, v6
v_add_f32 v7, 1.0, v7
v_add_f32 v8, 1.0, v8
v_add_f32 v9, 1.0, v9
v_rcp_f32 v2, v2
v_rcp_f32 v3, v3
v_rcp_f32 v4, v4
v_rcp_f32 v5, v5
v_rcp_f32 v6, v6
v_rcp_f32 v7, v7
v_rcp_f32 v8, v8
v_rcp_f32 v9, v9
Vm 50,50,2
Vm 51,51,3
Vm 52,52,4
Vm 53,53,5
Vm 54,54,6
Vm 55,55,7
Vm 56,56,8
Vm 57,57,9
Vc 2,50,51
v_lshlrev_b32_e64 v50, 16, v2
v_and_b32 v51, 0xffff0000, v2
Vc 3,52,53
v_lshlrev_b32_e64 v52, 16, v3
v_and_b32 v53, 0xffff0000, v3
Vc 4,54,55
v_lshlrev_b32_e64 v54, 16, v4
v_and_b32 v55, 0xffff0000, v4
Vc 5,56,57
v_lshlrev_b32_e64 v56, 16, v5
v_and_b32 v57, 0xffff0000, v5
L_f_selskip2:
v_add_u32 v124, 64, v120
v_cmp_eq_u32 vcc, s42, v124
v_cmp_eq_u32 s[6:7], s43, v124
s_nop 3
s_or_b64 s[4:5], vcc, s[6:7]
s_cbranch_scc0 L_f_selskip3
v_cndmask_b32 v96, 0, v80, vcc
v_cndmask_b32 v96, v96, v88, s[6:7]
v_cndmask_b32 v97, 0, v81, vcc
v_cndmask_b32 v97, v97, v89, s[6:7]
v_cndmask_b32 v98, 0, v82, vcc
v_cndmask_b32 v98, v98, v90, s[6:7]
v_cndmask_b32 v99, 0, v83, vcc
v_cndmask_b32 v99, v99, v91, s[6:7]
v_cndmask_b32 v100, 0, v84, vcc
v_cndmask_b32 v100, v100, v92, s[6:7]
v_cndmask_b32 v101, 0, v85, vcc
v_cndmask_b32 v101, v101, v93, s[6:7]
v_cndmask_b32 v102, 0, v86, vcc
v_cndmask_b32 v102, v102, v94, s[6:7]
v_cndmask_b32 v103, 0, v87, vcc
v_cndmask_b32 v103, v103, v95, s[6:7]
v_lshlrev_b32 v58, 16, v26
v_and_b32 v59, 0xffff0000, v26
v_lshlrev_b32_e64 v60, 16, v27
v_and_b32 v61, 0xffff0000, v27
v_lshlrev_b32_e64 v62, 16, v28
v_and_b32 v63, 0xffff0000, v28
v_lshlrev_b32_e64 v64, 16, v29
v_and_b32 v65, 0xffff0000, v29
Vs 58,58,38
Vs 59,59,38
Vs 60,60,38
Vs 61,61,38
Vs 62,62,38
Vs 63,63,38
Vs 64,64,38
Vs 65,65,38
Vc 2,58,59
v_lshlrev_b32_e64 v58, 16, v2
v_and_b32 v59, 0xffff0000, v2
Vc 3,60,61
v_lshlrev_b32_e64 v60, 16, v3
v_and_b32 v61, 0xffff0000, v3
Vc 4,62,63
v_lshlrev_b32_e64 v62, 16, v4
v_and_b32 v63, 0xffff0000, v4
Vc 5,64,65
v_lshlrev_b32_e64 v64, 16, v5
v_and_b32 v65, 0xffff0000, v5
Vm 58,58,39
Vm 59,59,39
Vm 60,60,39
Vm 61,61,39
Vm 62,62,39
Vm 63,63,39
Vm 64,64,39
Vm 65,65,39
Vc 2,58,59
v_lshlrev_b32_e64 v58, 16, v2
v_and_b32 v59, 0xffff0000, v2
Vc 3,60,61
v_lshlrev_b32_e64 v60, 16, v3
v_and_b32 v61, 0xffff0000, v3
Vc 4,62,63
v_lshlrev_b32_e64 v62, 16, v4
v_and_b32 v63, 0xffff0000, v4
Vc 5,64,65
v_lshlrev_b32_e64 v64, 16, v5
v_and_b32 v65, 0xffff0000, v5
Va 58,58,96
Va 59,59,97
Va 60,60,98
Va 61,61,99
Va 62,62,100
Va 63,63,101
Va 64,64,102
Va 65,65,103
Vc 2,58,59
v_lshlrev_b32_e64 v58, 16, v2
v_and_b32 v59, 0xffff0000, v2
Vc 3,60,61
v_lshlrev_b32_e64 v60, 16, v3
v_and_b32 v61, 0xffff0000, v3
Vc 4,62,63
v_lshlrev_b32_e64 v62, 16, v4
v_and_b32 v63, 0xffff0000, v4
Vc 5,64,65
v_lshlrev_b32_e64 v64, 16, v5
v_and_b32 v65, 0xffff0000, v5
v_mul_f32 v2, 0xbfb8aa3b, v58
v_mul_f32 v3, 0xbfb8aa3b, v59
v_mul_f32 v4, 0xbfb8aa3b, v60
v_mul_f32 v5, 0xbfb8aa3b, v61
v_mul_f32 v6, 0xbfb8aa3b, v62
v_mul_f32 v7, 0xbfb8aa3b, v63
v_mul_f32 v8, 0xbfb8aa3b, v64
v_mul_f32 v9, 0xbfb8aa3b, v65
Ve 2,2
Ve 3,3
Ve 4,4
Ve 5,5
Ve 6,6
Ve 7,7
Ve 8,8
Ve 9,9
v_add_f32 v2, 1.0, v2
v_add_f32 v3, 1.0, v3
v_add_f32 v4, 1.0, v4
v_add_f32 v5, 1.0, v5
v_add_f32 v6, 1.0, v6
v_add_f32 v7, 1.0, v7
v_add_f32 v8, 1.0, v8
v_add_f32 v9, 1.0, v9
v_rcp_f32 v2, v2
v_rcp_f32 v3, v3
v_rcp_f32 v4, v4
v_rcp_f32 v5, v5
v_rcp_f32 v6, v6
v_rcp_f32 v7, v7
v_rcp_f32 v8, v8
v_rcp_f32 v9, v9
Vm 58,58,2
Vm 59,59,3
Vm 60,60,4
Vm 61,61,5
Vm 62,62,6
Vm 63,63,7
Vm 64,64,8
Vm 65,65,9
Vc 2,58,59
v_lshlrev_b32_e64 v58, 16, v2
v_and_b32 v59, 0xffff0000, v2
Vc 3,60,61
v_lshlrev_b32_e64 v60, 16, v3
v_and_b32 v61, 0xffff0000, v3
Vc 4,62,63
v_lshlrev_b32_e64 v62, 16, v4
v_and_b32 v63, 0xffff0000, v4
Vc 5,64,65
v_lshlrev_b32_e64 v64, 16, v5
v_and_b32 v65, 0xffff0000, v5
L_f_selskip3:
v_add_u32 v124, 96, v120
v_cmp_eq_u32 vcc, s42, v124
v_cmp_eq_u32 s[6:7], s43, v124
s_nop 3
s_or_b64 s[4:5], vcc, s[6:7]
s_cbranch_scc0 L_f_selskip4
v_cndmask_b32 v96, 0, v80, vcc
v_cndmask_b32 v96, v96, v88, s[6:7]
v_cndmask_b32 v97, 0, v81, vcc
v_cndmask_b32 v97, v97, v89, s[6:7]
v_cndmask_b32 v98, 0, v82, vcc
v_cndmask_b32 v98, v98, v90, s[6:7]
v_cndmask_b32 v99, 0, v83, vcc
v_cndmask_b32 v99, v99, v91, s[6:7]
v_cndmask_b32 v100, 0, v84, vcc
v_cndmask_b32 v100, v100, v92, s[6:7]
v_cndmask_b32 v101, 0, v85, vcc
v_cndmask_b32 v101, v101, v93, s[6:7]
v_cndmask_b32 v102, 0, v86, vcc
v_cndmask_b32 v102, v102, v94, s[6:7]
v_cndmask_b32 v103, 0, v87, vcc
v_cndmask_b32 v103, v103, v95, s[6:7]
v_lshlrev_b32_e64 v66, 16, v30
v_and_b32 v67, 0xffff0000, v30
v_lshlrev_b32_e64 v68, 16, v31
v_and_b32 v69, 0xffff0000, v31
v_lshlrev_b32_e64 v70, 16, v32
v_and_b32 v71, 0xffff0000, v32
v_lshlrev_b32_e64 v72, 16, v33
v_and_b32 v73, 0xffff0000, v33
Vs 66,66,40
Vs 67,67,40
Vs 68,68,40
Vs 69,69,40
Vs 70,70,40
Vs 71,71,40
Vs 72,72,40
Vs 73,73,40
Vc 2,66,67
v_lshlrev_b32_e64 v66, 16, v2
v_and_b32 v67, 0xffff0000, v2
Vc 3,68,69
v_lshlrev_b32_e64 v68, 16, v3
v_and_b32 v69, 0xffff0000, v3
Vc 4,70,71
v_lshlrev_b32_e64 v70, 16, v4
v_and_b32 v71, 0xffff0000, v4
Vc 5,72,73
v_lshlrev_b32_e64 v72, 16, v5
v_and_b32 v73, 0xffff0000, v5
Vm 66,66,41
Vm 67,67,41
Vm 68,68,41
Vm 69,69,41
Vm 70,70,41
Vm 71,71,41
Vm 72,72,41
Vm 73,73,41
Vc 2,66,67
v_lshlrev_b32_e64 v66, 16, v2
v_and_b32 v67, 0xffff0000, v2
Vc 3,68,69
v_lshlrev_b32_e64 v68, 16, v3
v_and_b32 v69, 0xffff0000, v3
Vc 4,70,71
v_lshlrev_b32_e64 v70, 16, v4
v_and_b32 v71, 0xffff0000, v4
Vc 5,72,73
v_lshlrev_b32_e64 v72, 16, v5
v_and_b32 v73, 0xffff0000, v5
Va 66,66,96
Va 67,67,97
Va 68,68,98
Va 69,69,99
Va 70,70,100
Va 71,71,101
Va 72,72,102
Va 73,73,103
Vc 2,66,67
v_lshlrev_b32_e64 v66, 16, v2
v_and_b32 v67, 0xffff0000, v2
Vc 3,68,69
v_lshlrev_b32_e64 v68, 16, v3
v_and_b32 v69, 0xffff0000, v3
Vc 4,70,71
v_lshlrev_b32_e64 v70, 16, v4
v_and_b32 v71, 0xffff0000, v4
Vc 5,72,73
v_lshlrev_b32_e64 v72, 16, v5
v_and_b32 v73, 0xffff0000, v5
v_mul_f32 v2, 0xbfb8aa3b, v66
v_mul_f32 v3, 0xbfb8aa3b, v67
v_mul_f32 v4, 0xbfb8aa3b, v68
v_mul_f32 v5, 0xbfb8aa3b, v69
v_mul_f32 v6, 0xbfb8aa3b, v70
v_mul_f32 v7, 0xbfb8aa3b, v71
v_mul_f32 v8, 0xbfb8aa3b, v72
v_mul_f32 v9, 0xbfb8aa3b, v73
Ve 2,2
Ve 3,3
Ve 4,4
Ve 5,5
Ve 6,6
Ve 7,7
Ve 8,8
Ve 9,9
v_add_f32 v2, 1.0, v2
v_add_f32 v3, 1.0, v3
v_add_f32 v4, 1.0, v4
v_add_f32 v5, 1.0, v5
v_add_f32 v6, 1.0, v6
v_add_f32 v7, 1.0, v7
v_add_f32 v8, 1.0, v8
v_add_f32 v9, 1.0, v9
v_rcp_f32 v2, v2
v_rcp_f32 v3, v3
v_rcp_f32 v4, v4
v_rcp_f32 v5, v5
v_rcp_f32 v6, v6
v_rcp_f32 v7, v7
v_rcp_f32 v8, v8
v_rcp_f32 v9, v9
Vm 66,66,2
Vm 67,67,3
Vm 68,68,4
Vm 69,69,5
Vm 70,70,6
Vm 71,71,7
Vm 72,72,8
Vm 73,73,9
Vc 2,66,67
v_lshlrev_b32_e64 v66, 16, v2
v_and_b32 v67, 0xffff0000, v2
Vc 3,68,69
v_lshlrev_b32_e64 v68, 16, v3
v_and_b32 v69, 0xffff0000, v3
Vc 4,70,71
v_lshlrev_b32_e64 v70, 16, v4
v_and_b32 v71, 0xffff0000, v4
Vc 5,72,73
v_lshlrev_b32_e64 v72, 16, v5
v_and_b32 v73, 0xffff0000, v5
L_f_selskip4:
s_branch L_yCr
L_ysl:
s_mov_b32 s47, 0x400000
L_ysll:
buffer_load_dword v124, v126, s[28:31], s41 offen sc1
s_waitcnt vmcnt(0)
v_readfirstlane_b32 s3, v124
s_sub_u32 s47, s47, 1
s_cmp_eq_u32 s47, 0
s_cbranch_scc1 L_ysllx
s_cmp_ge_u32 s3, 7
s_cbranch_scc1 L_ysllx
s_sleep 8
s_branch L_ysll
L_ysllx:
v_lshlrev_b32_e64 v125, 9, v123
v_lshl_add_u32 v125, v122, 5, v125
v_mov_b32 v124, 2146435072
v_cmp_gt_u32 vcc, 7, v123
s_nop 1
v_cndmask_b32 v125, v124, v125, vcc
buffer_load_dwordx4 v[80:83], v125, s[20:23], s44 offen offset:0 sc1
buffer_load_dwordx4 v[84:87], v125, s[20:23], s44 offen offset:16 sc1
buffer_load_dwordx4 v[88:91], v125, s[20:23], s44 offen offset:256 sc1
buffer_load_dwordx4 v[92:95], v125, s[20:23], s44 offen offset:272 sc1
s_waitcnt vmcnt(0)
v_add_f32_dpp v80, v80, v80 row_ror:8 row_mask:0xf bank_mask:0xf
v_add_f32_dpp v81, v81, v81 row_ror:8 row_mask:0xf bank_mask:0xf
v_add_f32_dpp v82, v82, v82 row_ror:8 row_mask:0xf bank_mask:0xf
v_add_f32_dpp v83, v83, v83 row_ror:8 row_mask:0xf bank_mask:0xf
v_add_f32_dpp v84, v84, v84 row_ror:8 row_mask:0xf bank_mask:0xf
v_add_f32_dpp v85, v85, v85 row_ror:8 row_mask:0xf bank_mask:0xf
v_add_f32_dpp v86, v86, v86 row_ror:8 row_mask:0xf bank_mask:0xf
v_add_f32_dpp v87, v87, v87 row_ror:8 row_mask:0xf bank_mask:0xf
v_add_f32_dpp v88, v88, v88 row_ror:8 row_mask:0xf bank_mask:0xf
v_add_f32_dpp v89, v89, v89 row_ror:8 row_mask:0xf bank_mask:0xf
v_add_f32_dpp v90, v90, v90 row_ror:8 row_mask:0xf bank_mask:0xf
v_add_f32_dpp v91, v91, v91 row_ror:8 row_mask:0xf bank_mask:0xf
v_add_f32_dpp v92, v92, v92 row_ror:8 row_mask:0xf bank_mask:0xf
v_add_f32_dpp v93, v93, v93 row_ror:8 row_mask:0xf bank_mask:0xf
v_add_f32_dpp v94, v94, v94 row_ror:8 row_mask:0xf bank_mask:0xf
v_add_f32_dpp v95, v95, v95 row_ror:8 row_mask:0xf bank_mask:0xf
v_mov_b32 v96, v80
v_mov_b32 v97, v81
v_mov_b32 v98, v82
v_mov_b32 v99, v83
v_mov_b32 v100, v84
v_mov_b32 v101, v85
v_mov_b32 v102, v86
v_mov_b32 v103, v87
v_mov_b32 v104, v88
v_mov_b32 v105, v89
v_mov_b32 v106, v90
v_mov_b32 v107, v91
v_mov_b32 v108, v92
v_mov_b32 v109, v93
v_mov_b32 v110, v94
v_mov_b32 v111, v95
v_permlane16_swap_b32 v96, v80
v_permlane16_swap_b32 v97, v81
v_permlane16_swap_b32 v98, v82
v_permlane16_swap_b32 v99, v83
v_permlane16_swap_b32 v100, v84
v_permlane16_swap_b32 v101, v85
v_permlane16_swap_b32 v102, v86
v_permlane16_swap_b32 v103, v87
v_permlane16_swap_b32 v104, v88
v_permlane16_swap_b32 v105, v89
v_permlane16_swap_b32 v106, v90
v_permlane16_swap_b32 v107, v91
v_permlane16_swap_b32 v108, v92
v_permlane16_swap_b32 v109, v93
v_permlane16_swap_b32 v110, v94
v_permlane16_swap_b32 v111, v95
Va 80,80,96
Va 81,81,97
Va 82,82,98
Va 83,83,99
Va 84,84,100
Va 85,85,101
Va 86,86,102
Va 87,87,103
Va 88,88,104
Va 89,89,105
Va 90,90,106
Va 91,91,107
Va 92,92,108
Va 93,93,109
Va 94,94,110
Va 95,95,111
v_mov_b32 v96, v80
v_mov_b32 v97, v81
v_mov_b32 v98, v82
v_mov_b32 v99, v83
v_mov_b32 v100, v84
v_mov_b32 v101, v85
v_mov_b32 v102, v86
v_mov_b32 v103, v87
v_mov_b32 v104, v88
v_mov_b32 v105, v89
v_mov_b32 v106, v90
v_mov_b32 v107, v91
v_mov_b32 v108, v92
v_mov_b32 v109, v93
v_mov_b32 v110, v94
v_mov_b32 v111, v95
v_permlane32_swap_b32 v96, v80
v_permlane32_swap_b32 v97, v81
v_permlane32_swap_b32 v98, v82
v_permlane32_swap_b32 v99, v83
v_permlane32_swap_b32 v100, v84
v_permlane32_swap_b32 v101, v85
v_permlane32_swap_b32 v102, v86
v_permlane32_swap_b32 v103, v87
v_permlane32_swap_b32 v104, v88
v_permlane32_swap_b32 v105, v89
v_permlane32_swap_b32 v106, v90
v_permlane32_swap_b32 v107, v91
v_permlane32_swap_b32 v108, v92
v_permlane32_swap_b32 v109, v93
v_permlane32_swap_b32 v110, v94
v_permlane32_swap_b32 v111, v95
Va 80,80,96
Va 81,81,97
Va 82,82,98
Va 83,83,99
Va 84,84,100
Va 85,85,101
Va 86,86,102
Va 87,87,103
Va 88,88,104
Va 89,89,105
Va 90,90,106
Va 91,91,107
Va 92,92,108
Va 93,93,109
Va 94,94,110
Va 95,95,111
Vc 124,80,81
v_lshlrev_b32_e64 v80, 16, v124
v_and_b32 v81, 0xffff0000, v124
Vc 124,82,83
v_lshlrev_b32_e64 v82, 16, v124
v_and_b32 v83, 0xffff0000, v124
Vc 124,84,85
v_lshlrev_b32_e64 v84, 16, v124
v_and_b32 v85, 0xffff0000, v124
Vc 124,86,87
v_lshlrev_b32_e64 v86, 16, v124
v_and_b32 v87, 0xffff0000, v124
Vc 124,88,89
v_lshlrev_b32_e64 v88, 16, v124
v_and_b32 v89, 0xffff0000, v124
Vc 124,90,91
v_lshlrev_b32_e64 v90, 16, v124
v_and_b32 v91, 0xffff0000, v124
Vc 124,92,93
v_lshlrev_b32_e64 v92, 16, v124
v_and_b32 v93, 0xffff0000, v124
Vc 124,94,95
v_lshlrev_b32_e64 v94, 16, v124
v_and_b32 v95, 0xffff0000, v124
v_mul_f32 v80, s100, v80
v_mul_f32 v81, s100, v81
v_mul_f32 v82, s100, v82
v_mul_f32 v83, s100, v83
v_mul_f32 v84, s100, v84
v_mul_f32 v85, s100, v85
v_mul_f32 v86, s100, v86
v_mul_f32 v87, s100, v87
v_mul_f32 v88, s101, v88
v_mul_f32 v89, s101, v89
v_mul_f32 v90, s101, v90
v_mul_f32 v91, s101, v91
v_mul_f32 v92, s101, v92
v_mul_f32 v93, s101, v93
v_mul_f32 v94, s101, v94
v_mul_f32 v95, s101, v95
Vc 124,80,81
v_lshlrev_b32_e64 v80, 16, v124
v_and_b32 v81, 0xffff0000, v124
Vc 124,82,83
v_lshlrev_b32_e64 v82, 16, v124
v_and_b32 v83, 0xffff0000, v124
Vc 124,84,85
v_lshlrev_b32_e64 v84, 16, v124
v_and_b32 v85, 0xffff0000, v124
Vc 124,86,87
v_lshlrev_b32_e64 v86, 16, v124
v_and_b32 v87, 0xffff0000, v124
Vc 124,88,89
v_lshlrev_b32_e64 v88, 16, v124
v_and_b32 v89, 0xffff0000, v124
Vc 124,90,91
v_lshlrev_b32_e64 v90, 16, v124
v_and_b32 v91, 0xffff0000, v124
Vc 124,92,93
v_lshlrev_b32_e64 v92, 16, v124
v_and_b32 v93, 0xffff0000, v124
Vc 124,94,95
v_lshlrev_b32_e64 v94, 16, v124
v_and_b32 v95, 0xffff0000, v124
s_lshl_b32 s3, s45, 7
s_sub_u32 s42, s42, s3
s_sub_u32 s43, s43, s3
v_add_u32 v124, 0, v120
v_cmp_eq_u32 vcc, s42, v124
v_cmp_eq_u32 s[6:7], s43, v124
s_nop 3
s_or_b64 s[4:5], vcc, s[6:7]
s_cbranch_scc0 L_f_selskip5
v_cndmask_b32 v96, 0, v80, vcc
v_cndmask_b32 v96, v96, v88, s[6:7]
v_cndmask_b32 v97, 0, v81, vcc
v_cndmask_b32 v97, v97, v89, s[6:7]
v_cndmask_b32 v98, 0, v82, vcc
v_cndmask_b32 v98, v98, v90, s[6:7]
v_cndmask_b32 v99, 0, v83, vcc
v_cndmask_b32 v99, v99, v91, s[6:7]
v_cndmask_b32 v100, 0, v84, vcc
v_cndmask_b32 v100, v100, v92, s[6:7]
v_cndmask_b32 v101, 0, v85, vcc
v_cndmask_b32 v101, v101, v93, s[6:7]
v_cndmask_b32 v102, 0, v86, vcc
v_cndmask_b32 v102, v102, v94, s[6:7]
v_cndmask_b32 v103, 0, v87, vcc
v_cndmask_b32 v103, v103, v95, s[6:7]
v_lshlrev_b32_e64 v42, 16, v18
v_and_b32 v43, 0xffff0000, v18
v_lshlrev_b32_e64 v44, 16, v19
v_and_b32 v45, 0xffff0000, v19
v_lshlrev_b32_e64 v46, 16, v20
v_and_b32 v47, 0xffff0000, v20
v_lshlrev_b32_e64 v48, 16, v21
v_and_b32 v49, 0xffff0000, v21
Vs 42,42,34
Vs 43,43,34
Vs 44,44,34
Vs 45,45,34
Vs 46,46,34
Vs 47,47,34
Vs 48,48,34
Vs 49,49,34
Vc 2,42,43
v_lshlrev_b32_e64 v42, 16, v2
v_and_b32 v43, 0xffff0000, v2
Vc 3,44,45
v_lshlrev_b32_e64 v44, 16, v3
v_and_b32 v45, 0xffff0000, v3
Vc 4,46,47
v_lshlrev_b32_e64 v46, 16, v4
v_and_b32 v47, 0xffff0000, v4
Vc 5,48,49
v_lshlrev_b32_e64 v48, 16, v5
v_and_b32 v49, 0xffff0000, v5
Vm 42,42,35
Vm 43,43,35
Vm 44,44,35
Vm 45,45,35
Vm 46,46,35
Vm 47,47,35
Vm 48,48,35
Vm 49,49,35
Vc 2,42,43
v_lshlrev_b32_e64 v42, 16, v2
v_and_b32 v43, 0xffff0000, v2
Vc 3,44,45
v_lshlrev_b32_e64 v44, 16, v3
v_and_b32 v45, 0xffff0000, v3
Vc 4,46,47
v_lshlrev_b32_e64 v46, 16, v4
v_and_b32 v47, 0xffff0000, v4
Vc 5,48,49
v_lshlrev_b32_e64 v48, 16, v5
v_and_b32 v49, 0xffff0000, v5
Va 42,42,96
Va 43,43,97
Va 44,44,98
Va 45,45,99
Va 46,46,100
Va 47,47,101
Va 48,48,102
Va 49,49,103
Vc 2,42,43
v_lshlrev_b32_e64 v42, 16, v2
v_and_b32 v43, 0xffff0000, v2
Vc 3,44,45
v_lshlrev_b32_e64 v44, 16, v3
v_and_b32 v45, 0xffff0000, v3
Vc 4,46,47
v_lshlrev_b32_e64 v46, 16, v4
v_and_b32 v47, 0xffff0000, v4
Vc 5,48,49
v_lshlrev_b32_e64 v48, 16, v5
v_and_b32 v49, 0xffff0000, v5
v_mul_f32 v2, 0xbfb8aa3b, v42
v_mul_f32 v3, 0xbfb8aa3b, v43
v_mul_f32 v4, 0xbfb8aa3b, v44
v_mul_f32 v5, 0xbfb8aa3b, v45
v_mul_f32 v6, 0xbfb8aa3b, v46
v_mul_f32 v7, 0xbfb8aa3b, v47
v_mul_f32 v8, 0xbfb8aa3b, v48
v_mul_f32 v9, 0xbfb8aa3b, v49
Ve 2,2
Ve 3,3
Ve 4,4
Ve 5,5
Ve 6,6
Ve 7,7
Ve 8,8
Ve 9,9
v_add_f32 v2, 1.0, v2
v_add_f32 v3, 1.0, v3
v_add_f32 v4, 1.0, v4
v_add_f32 v5, 1.0, v5
v_add_f32 v6, 1.0, v6
v_add_f32 v7, 1.0, v7
v_add_f32 v8, 1.0, v8
v_add_f32 v9, 1.0, v9
v_rcp_f32 v2, v2
v_rcp_f32 v3, v3
v_rcp_f32 v4, v4
v_rcp_f32 v5, v5
v_rcp_f32 v6, v6
v_rcp_f32 v7, v7
v_rcp_f32 v8, v8
v_rcp_f32 v9, v9
Vm 42,42,2
Vm 43,43,3
Vm 44,44,4
Vm 45,45,5
Vm 46,46,6
Vm 47,47,7
Vm 48,48,8
Vm 49,49,9
Vc 2,42,43
v_lshlrev_b32_e64 v42, 16, v2
v_and_b32 v43, 0xffff0000, v2
Vc 3,44,45
v_lshlrev_b32_e64 v44, 16, v3
v_and_b32 v45, 0xffff0000, v3
Vc 4,46,47
v_lshlrev_b32_e64 v46, 16, v4
v_and_b32 v47, 0xffff0000, v4
Vc 5,48,49
v_lshlrev_b32_e64 v48, 16, v5
v_and_b32 v49, 0xffff0000, v5
L_f_selskip5:
v_add_u32 v124, 32, v120
v_cmp_eq_u32 vcc, s42, v124
v_cmp_eq_u32 s[6:7], s43, v124
s_nop 3
s_or_b64 s[4:5], vcc, s[6:7]
s_cbranch_scc0 L_f_selskip6
v_cndmask_b32 v96, 0, v80, vcc
v_cndmask_b32 v96, v96, v88, s[6:7]
v_cndmask_b32 v97, 0, v81, vcc
v_cndmask_b32 v97, v97, v89, s[6:7]
v_cndmask_b32 v98, 0, v82, vcc
v_cndmask_b32 v98, v98, v90, s[6:7]
v_cndmask_b32 v99, 0, v83, vcc
v_cndmask_b32 v99, v99, v91, s[6:7]
v_cndmask_b32 v100, 0, v84, vcc
v_cndmask_b32 v100, v100, v92, s[6:7]
v_cndmask_b32 v101, 0, v85, vcc
v_cndmask_b32 v101, v101, v93, s[6:7]
v_cndmask_b32 v102, 0, v86, vcc
v_cndmask_b32 v102, v102, v94, s[6:7]
v_cndmask_b32 v103, 0, v87, vcc
v_cndmask_b32 v103, v103, v95, s[6:7]
v_lshlrev_b32 v50, 16, v22
v_and_b32 v51, 0xffff0000, v22
v_lshlrev_b32_e64 v52, 16, v23
v_and_b32 v53, 0xffff0000, v23
v_lshlrev_b32_e64 v54, 16, v24
v_and_b32 v55, 0xffff0000, v24
v_lshlrev_b32_e64 v56, 16, v25
v_and_b32 v57, 0xffff0000, v25
Vs 50,50,36
Vs 51,51,36
Vs 52,52,36
Vs 53,53,36
Vs 54,54,36
Vs 55,55,36
Vs 56,56,36
Vs 57,57,36
Vc 2,50,51
v_lshlrev_b32_e64 v50, 16, v2
v_and_b32 v51, 0xffff0000, v2
Vc 3,52,53
v_lshlrev_b32_e64 v52, 16, v3
v_and_b32 v53, 0xffff0000, v3
Vc 4,54,55
v_lshlrev_b32_e64 v54, 16, v4
v_and_b32 v55, 0xffff0000, v4
Vc 5,56,57
v_lshlrev_b32_e64 v56, 16, v5
v_and_b32 v57, 0xffff0000, v5
Vm 50,50,37
Vm 51,51,37
Vm 52,52,37
Vm 53,53,37
Vm 54,54,37
Vm 55,55,37
Vm 56,56,37
Vm 57,57,37
Vc 2,50,51
v_lshlrev_b32_e64 v50, 16, v2
v_and_b32 v51, 0xffff0000, v2
Vc 3,52,53
v_lshlrev_b32_e64 v52, 16, v3
v_and_b32 v53, 0xffff0000, v3
Vc 4,54,55
v_lshlrev_b32_e64 v54, 16, v4
v_and_b32 v55, 0xffff0000, v4
Vc 5,56,57
v_lshlrev_b32_e64 v56, 16, v5
v_and_b32 v57, 0xffff0000, v5
Va 50,50,96
Va 51,51,97
Va 52,52,98
Va 53,53,99
Va 54,54,100
Va 55,55,101
Va 56,56,102
Va 57,57,103
Vc 2,50,51
v_lshlrev_b32_e64 v50, 16, v2
v_and_b32 v51, 0xffff0000, v2
Vc 3,52,53
v_lshlrev_b32_e64 v52, 16, v3
v_and_b32 v53, 0xffff0000, v3
Vc 4,54,55
v_lshlrev_b32_e64 v54, 16, v4
v_and_b32 v55, 0xffff0000, v4
Vc 5,56,57
v_lshlrev_b32_e64 v56, 16, v5
v_and_b32 v57, 0xffff0000, v5
v_mul_f32 v2, 0xbfb8aa3b, v50
v_mul_f32 v3, 0xbfb8aa3b, v51
v_mul_f32 v4, 0xbfb8aa3b, v52
v_mul_f32 v5, 0xbfb8aa3b, v53
v_mul_f32 v6, 0xbfb8aa3b, v54
v_mul_f32 v7, 0xbfb8aa3b, v55
v_mul_f32 v8, 0xbfb8aa3b, v56
v_mul_f32 v9, 0xbfb8aa3b, v57
Ve 2,2
Ve 3,3
Ve 4,4
Ve 5,5
Ve 6,6
Ve 7,7
Ve 8,8
Ve 9,9
v_add_f32 v2, 1.0, v2
v_add_f32 v3, 1.0, v3
v_add_f32 v4, 1.0, v4
v_add_f32 v5, 1.0, v5
v_add_f32 v6, 1.0, v6
v_add_f32 v7, 1.0, v7
v_add_f32 v8, 1.0, v8
v_add_f32 v9, 1.0, v9
v_rcp_f32 v2, v2
v_rcp_f32 v3, v3
v_rcp_f32 v4, v4
v_rcp_f32 v5, v5
v_rcp_f32 v6, v6
v_rcp_f32 v7, v7
v_rcp_f32 v8, v8
v_rcp_f32 v9, v9
Vm 50,50,2
Vm 51,51,3
Vm 52,52,4
Vm 53,53,5
Vm 54,54,6
Vm 55,55,7
Vm 56,56,8
Vm 57,57,9
Vc 2,50,51
v_lshlrev_b32_e64 v50, 16, v2
v_and_b32 v51, 0xffff0000, v2
Vc 3,52,53
v_lshlrev_b32_e64 v52, 16, v3
v_and_b32 v53, 0xffff0000, v3
Vc 4,54,55
v_lshlrev_b32_e64 v54, 16, v4
v_and_b32 v55, 0xffff0000, v4
Vc 5,56,57
v_lshlrev_b32_e64 v56, 16, v5
v_and_b32 v57, 0xffff0000, v5
L_f_selskip6:
v_add_u32 v124, 64, v120
v_cmp_eq_u32 vcc, s42, v124
v_cmp_eq_u32 s[6:7], s43, v124
s_nop 3
s_or_b64 s[4:5], vcc, s[6:7]
s_cbranch_scc0 L_f_selskip7
v_cndmask_b32 v96, 0, v80, vcc
v_cndmask_b32 v96, v96, v88, s[6:7]
v_cndmask_b32 v97, 0, v81, vcc
v_cndmask_b32 v97, v97, v89, s[6:7]
v_cndmask_b32 v98, 0, v82, vcc
v_cndmask_b32 v98, v98, v90, s[6:7]
v_cndmask_b32 v99, 0, v83, vcc
v_cndmask_b32 v99, v99, v91, s[6:7]
v_cndmask_b32 v100, 0, v84, vcc
v_cndmask_b32 v100, v100, v92, s[6:7]
v_cndmask_b32 v101, 0, v85, vcc
v_cndmask_b32 v101, v101, v93, s[6:7]
v_cndmask_b32 v102, 0, v86, vcc
v_cndmask_b32 v102, v102, v94, s[6:7]
v_cndmask_b32 v103, 0, v87, vcc
v_cndmask_b32 v103, v103, v95, s[6:7]
v_lshlrev_b32 v58, 16, v26
v_and_b32 v59, 0xffff0000, v26
v_lshlrev_b32_e64 v60, 16, v27
v_and_b32 v61, 0xffff0000, v27
v_lshlrev_b32_e64 v62, 16, v28
v_and_b32 v63, 0xffff0000, v28
v_lshlrev_b32_e64 v64, 16, v29
v_and_b32 v65, 0xffff0000, v29
Vs 58,58,38
Vs 59,59,38
Vs 60,60,38
Vs 61,61,38
Vs 62,62,38
Vs 63,63,38
Vs 64,64,38
Vs 65,65,38
Vc 2,58,59
v_lshlrev_b32_e64 v58, 16, v2
v_and_b32 v59, 0xffff0000, v2
Vc 3,60,61
v_lshlrev_b32_e64 v60, 16, v3
v_and_b32 v61, 0xffff0000, v3
Vc 4,62,63
v_lshlrev_b32_e64 v62, 16, v4
v_and_b32 v63, 0xffff0000, v4
Vc 5,64,65
v_lshlrev_b32_e64 v64, 16, v5
v_and_b32 v65, 0xffff0000, v5
Vm 58,58,39
Vm 59,59,39
Vm 60,60,39
Vm 61,61,39
Vm 62,62,39
Vm 63,63,39
Vm 64,64,39
Vm 65,65,39
Vc 2,58,59
v_lshlrev_b32_e64 v58, 16, v2
v_and_b32 v59, 0xffff0000, v2
Vc 3,60,61
v_lshlrev_b32_e64 v60, 16, v3
v_and_b32 v61, 0xffff0000, v3
Vc 4,62,63
v_lshlrev_b32_e64 v62, 16, v4
v_and_b32 v63, 0xffff0000, v4
Vc 5,64,65
v_lshlrev_b32_e64 v64, 16, v5
v_and_b32 v65, 0xffff0000, v5
Va 58,58,96
Va 59,59,97
Va 60,60,98
Va 61,61,99
Va 62,62,100
Va 63,63,101
Va 64,64,102
Va 65,65,103
Vc 2,58,59
v_lshlrev_b32_e64 v58, 16, v2
v_and_b32 v59, 0xffff0000, v2
Vc 3,60,61
v_lshlrev_b32_e64 v60, 16, v3
v_and_b32 v61, 0xffff0000, v3
Vc 4,62,63
v_lshlrev_b32_e64 v62, 16, v4
v_and_b32 v63, 0xffff0000, v4
Vc 5,64,65
v_lshlrev_b32_e64 v64, 16, v5
v_and_b32 v65, 0xffff0000, v5
v_mul_f32 v2, 0xbfb8aa3b, v58
v_mul_f32 v3, 0xbfb8aa3b, v59
v_mul_f32 v4, 0xbfb8aa3b, v60
v_mul_f32 v5, 0xbfb8aa3b, v61
v_mul_f32 v6, 0xbfb8aa3b, v62
v_mul_f32 v7, 0xbfb8aa3b, v63
v_mul_f32 v8, 0xbfb8aa3b, v64
v_mul_f32 v9, 0xbfb8aa3b, v65
Ve 2,2
Ve 3,3
Ve 4,4
Ve 5,5
Ve 6,6
Ve 7,7
Ve 8,8
Ve 9,9
v_add_f32 v2, 1.0, v2
v_add_f32 v3, 1.0, v3
v_add_f32 v4, 1.0, v4
v_add_f32 v5, 1.0, v5
v_add_f32 v6, 1.0, v6
v_add_f32 v7, 1.0, v7
v_add_f32 v8, 1.0, v8
v_add_f32 v9, 1.0, v9
v_rcp_f32 v2, v2
v_rcp_f32 v3, v3
v_rcp_f32 v4, v4
v_rcp_f32 v5, v5
v_rcp_f32 v6, v6
v_rcp_f32 v7, v7
v_rcp_f32 v8, v8
v_rcp_f32 v9, v9
Vm 58,58,2
Vm 59,59,3
Vm 60,60,4
Vm 61,61,5
Vm 62,62,6
Vm 63,63,7
Vm 64,64,8
Vm 65,65,9
Vc 2,58,59
v_lshlrev_b32_e64 v58, 16, v2
v_and_b32 v59, 0xffff0000, v2
Vc 3,60,61
v_lshlrev_b32_e64 v60, 16, v3
v_and_b32 v61, 0xffff0000, v3
Vc 4,62,63
v_lshlrev_b32_e64 v62, 16, v4
v_and_b32 v63, 0xffff0000, v4
Vc 5,64,65
v_lshlrev_b32_e64 v64, 16, v5
v_and_b32 v65, 0xffff0000, v5
L_f_selskip7:
v_add_u32 v124, 96, v120
v_cmp_eq_u32 vcc, s42, v124
v_cmp_eq_u32 s[6:7], s43, v124
s_nop 3
s_or_b64 s[4:5], vcc, s[6:7]
s_cbranch_scc0 L_f_selskip8
v_cndmask_b32 v96, 0, v80, vcc
v_cndmask_b32 v96, v96, v88, s[6:7]
v_cndmask_b32 v97, 0, v81, vcc
v_cndmask_b32 v97, v97, v89, s[6:7]
v_cndmask_b32 v98, 0, v82, vcc
v_cndmask_b32 v98, v98, v90, s[6:7]
v_cndmask_b32 v99, 0, v83, vcc
v_cndmask_b32 v99, v99, v91, s[6:7]
v_cndmask_b32 v100, 0, v84, vcc
v_cndmask_b32 v100, v100, v92, s[6:7]
v_cndmask_b32 v101, 0, v85, vcc
v_cndmask_b32 v101, v101, v93, s[6:7]
v_cndmask_b32 v102, 0, v86, vcc
v_cndmask_b32 v102, v102, v94, s[6:7]
v_cndmask_b32 v103, 0, v87, vcc
v_cndmask_b32 v103, v103, v95, s[6:7]
v_lshlrev_b32_e64 v66, 16, v30
v_and_b32 v67, 0xffff0000, v30
v_lshlrev_b32_e64 v68, 16, v31
v_and_b32 v69, 0xffff0000, v31
v_lshlrev_b32_e64 v70, 16, v32
v_and_b32 v71, 0xffff0000, v32
v_lshlrev_b32_e64 v72, 16, v33
v_and_b32 v73, 0xffff0000, v33
Vs 66,66,40
Vs 67,67,40
Vs 68,68,40
Vs 69,69,40
Vs 70,70,40
Vs 71,71,40
Vs 72,72,40
Vs 73,73,40
Vc 2,66,67
v_lshlrev_b32_e64 v66, 16, v2
v_and_b32 v67, 0xffff0000, v2
Vc 3,68,69
v_lshlrev_b32_e64 v68, 16, v3
v_and_b32 v69, 0xffff0000, v3
Vc 4,70,71
v_lshlrev_b32_e64 v70, 16, v4
v_and_b32 v71, 0xffff0000, v4
Vc 5,72,73
v_lshlrev_b32_e64 v72, 16, v5
v_and_b32 v73, 0xffff0000, v5
Vm 66,66,41
Vm 67,67,41
Vm 68,68,41
Vm 69,69,41
Vm 70,70,41
Vm 71,71,41
Vm 72,72,41
Vm 73,73,41
Vc 2,66,67
v_lshlrev_b32_e64 v66, 16, v2
v_and_b32 v67, 0xffff0000, v2
Vc 3,68,69
v_lshlrev_b32_e64 v68, 16, v3
v_and_b32 v69, 0xffff0000, v3
Vc 4,70,71
v_lshlrev_b32_e64 v70, 16, v4
v_and_b32 v71, 0xffff0000, v4
Vc 5,72,73
v_lshlrev_b32_e64 v72, 16, v5
v_and_b32 v73, 0xffff0000, v5
Va 66,66,96
Va 67,67,97
Va 68,68,98
Va 69,69,99
Va 70,70,100
Va 71,71,101
Va 72,72,102
Va 73,73,103
Vc 2,66,67
v_lshlrev_b32_e64 v66, 16, v2
v_and_b32 v67, 0xffff0000, v2
Vc 3,68,69
v_lshlrev_b32_e64 v68, 16, v3
v_and_b32 v69, 0xffff0000, v3
Vc 4,70,71
v_lshlrev_b32_e64 v70, 16, v4
v_and_b32 v71, 0xffff0000, v4
Vc 5,72,73
v_lshlrev_b32_e64 v72, 16, v5
v_and_b32 v73, 0xffff0000, v5
v_mul_f32 v2, 0xbfb8aa3b, v66
v_mul_f32 v3, 0xbfb8aa3b, v67
v_mul_f32 v4, 0xbfb8aa3b, v68
v_mul_f32 v5, 0xbfb8aa3b, v69
v_mul_f32 v6, 0xbfb8aa3b, v70
v_mul_f32 v7, 0xbfb8aa3b, v71
v_mul_f32 v8, 0xbfb8aa3b, v72
v_mul_f32 v9, 0xbfb8aa3b, v73
Ve 2,2
Ve 3,3
Ve 4,4
Ve 5,5
Ve 6,6
Ve 7,7
Ve 8,8
Ve 9,9
v_add_f32 v2, 1.0, v2
v_add_f32 v3, 1.0, v3
v_add_f32 v4, 1.0, v4
v_add_f32 v5, 1.0, v5
v_add_f32 v6, 1.0, v6
v_add_f32 v7, 1.0, v7
v_add_f32 v8, 1.0, v8
v_add_f32 v9, 1.0, v9
v_rcp_f32 v2, v2
v_rcp_f32 v3, v3
v_rcp_f32 v4, v4
v_rcp_f32 v5, v5
v_rcp_f32 v6, v6
v_rcp_f32 v7, v7
v_rcp_f32 v8, v8
v_rcp_f32 v9, v9
Vm 66,66,2
Vm 67,67,3
Vm 68,68,4
Vm 69,69,5
Vm 70,70,6
Vm 71,71,7
Vm 72,72,8
Vm 73,73,9
Vc 2,66,67
v_lshlrev_b32_e64 v66, 16, v2
v_and_b32 v67, 0xffff0000, v2
Vc 3,68,69
v_lshlrev_b32_e64 v68, 16, v3
v_and_b32 v69, 0xffff0000, v3
Vc 4,70,71
v_lshlrev_b32_e64 v70, 16, v4
v_and_b32 v71, 0xffff0000, v4
Vc 5,72,73
v_lshlrev_b32_e64 v72, 16, v5
v_and_b32 v73, 0xffff0000, v5
L_f_selskip8:
s_branch L_yslr
.section .rodata,"a"
.p2align 6
.amdhsa_kernel recurrent_scan__compressed_kv_cla__moe_arch_mod__prompt_kernel
  .amdhsa_next_free_vgpr 512
  .amdhsa_next_free_sgpr 102
  .amdhsa_accum_offset 256
  .amdhsa_group_segment_fixed_size 0
  .amdhsa_kernarg_size 112
  .amdhsa_user_sgpr_count 2
  .amdhsa_user_sgpr_kernarg_segment_ptr 1
  .amdhsa_system_sgpr_workgroup_id_x 1
.end_amdhsa_kernel
```

```asm
; @launch grid=(256,1,1) block=(256,1,1) lds=148480
.amdgcn_target "amdgcn-amd-amdhsa--gfx950"
.macro Va d,x,y
v_add_f32 v\d, v\x, v\y
.endm
.macro Vc d,x,y
v_cvt_pk_bf16_f32 v\d, v\x, v\y
.endm
.macro Ta d,x,o
ds_read_b64_tr_b16 a[\d:\d+1], v\x offset:\o
.endm
.macro Ra d,x,o
ds_read_b128 a[\d:\d+3], v\x offset:\o
.endm
.macro Zvaa d,x,y
v_mfma_f32_16x16x32_bf16 v[\d:\d+3], a[\x:\x+3], a[\y:\y+3], 0
.endm
.macro Rv d,x,o
ds_read_b128 v[\d:\d+3], v\x offset:\o
.endm
.macro Zaaa d,x,y
v_mfma_f32_16x16x32_bf16 a[\d:\d+3], a[\x:\x+3], a[\y:\y+3], 0
.endm
.macro Mvaa d,x,y
v_mfma_f32_16x16x32_bf16 v[\d:\d+3], a[\x:\x+3], a[\y:\y+3], v[\d:\d+3]
.endm
.macro Maaa d,x,y
v_mfma_f32_16x16x32_bf16 a[\d:\d+3], a[\x:\x+3], a[\y:\y+3], a[\d:\d+3]
.endm
.macro Ar d,x
v_accvgpr_read_b32 v\d, a\x
.endm
.macro VE d,x
v_exp_f32_e64 v\d, v\x
.endm
.macro Aw d,x
v_accvgpr_write_b32 a\d, v\x
.endm
.macro Vs d,x,y
v_sub_f32 v\d, v\x, v\y
.endm
.macro Ve d,x
v_exp_f32 v\d, v\x
.endm
.macro Cvaa d,x,y,c
v_mfma_f32_16x16x32_bf16 v[\d:\d+3], a[\x:\x+3], a[\y:\y+3], v[\c:\c+3]
.endm
.macro Maav d,x,y
v_mfma_f32_16x16x32_bf16 a[\d:\d+3], a[\x:\x+3], v[\y:\y+3], a[\d:\d+3]
.endm
.macro Mvvv d,x,y
v_mfma_f32_16x16x32_bf16 v[\d:\d+3], v[\x:\x+3], v[\y:\y+3], v[\d:\d+3]
.endm
.macro Vm d,x,y
v_mul_f32 v\d, v\x, v\y
.endm
.macro Zvva d,x,y
v_mfma_f32_16x16x32_bf16 v[\d:\d+3], v[\x:\x+3], a[\y:\y+3], 0
.endm
.macro Mvva d,x,y
v_mfma_f32_16x16x32_bf16 v[\d:\d+3], v[\x:\x+3], a[\y:\y+3], v[\d:\d+3]
.endm
.macro Zvav d,x,y
v_mfma_f32_16x16x32_bf16 v[\d:\d+3], a[\x:\x+3], v[\y:\y+3], 0
.endm
.macro Mvav d,x,y
v_mfma_f32_16x16x32_bf16 v[\d:\d+3], a[\x:\x+3], v[\y:\y+3], v[\d:\d+3]
.endm
.text
.globl recurrent_scan__compressed_kv_cla__moe_arch_mod__prompt_kernel
.p2align 8
.type recurrent_scan__compressed_kv_cla__moe_arch_mod__prompt_kernel,@function
recurrent_scan__compressed_kv_cla__moe_arch_mod__prompt_kernel:
s_cmp_ge_u32 s2, 256
s_cbranch_scc1 L_k2_end
s_load_dwordx4 s[4:7], s[0:1], 0
s_load_dwordx2 s[44:45], s[0:1], 56
s_load_dwordx4 s[40:43], s[0:1], 24
s_load_dwordx4 s[64:67], s[0:1], 96
v_lshrrev_b32 v1, 6, v0
v_and_b32 v0, 63, v0
v_readfirstlane_b32 s32, v1
v_lshrrev_b32 v33, 5, v0
v_and_b32 v31, 31, v0
v_lshlrev_b32_e64 v36, 4, v31
v_lshl_add_u32 v35, v33, 11, v36
s_lshl_b32 s36, s2, 14
s_lshl_b32 s37, s32, 12
s_add_u32 s36, s36, s37
s_lshr_b32 s3, s2, 3
s_and_b32 s33, s3, 7
s_lshr_b32 s3, s3, 3
s_lshr_b32 s35, s3, 1
s_and_b32 s3, s3, 1
s_and_b32 s34, s2, 7
s_lshl_b32 s34, s34, 1
s_add_u32 s34, s34, s3
s_mov_b32 s48, 0
s_mov_b32 s52, 0
s_nop 0
s_mov_b32 s49, 7168
s_mov_b32 s53, 15360
s_mov_b32 s50, 14336
s_mov_b32 s54, 30720
s_mov_b32 s51, 21504
s_mov_b32 s55, 46080
s_lshl_b32 s56, s32, 13
s_add_u32 s57, s56, 32768
s_lshl_b32 s3, s32, 4
v_add_u32 v30, s3, v33
v_lshlrev_b32 v30, 13, v30
v_lshlrev_b32 v34, 1, v33
v_xor_b32 v31, v31, v34
v_xor_b32_e64 v34, 0, v31
v_lshl_add_u32 v6, v34, 4, v30
v_xor_b32_e64 v34, 4, v31
v_lshl_add_u32 v7, v34, 4, v30
v_xor_b32_e64 v34, 8, v31
v_lshl_add_u32 v8, v34, 4, v30
v_add_u32 v8, 65536, v8
v_xor_b32_e64 v34, 12, v31
v_lshl_add_u32 v9, v34, 4, v30
v_add_u32 v9, 65536, v9
v_lshrrev_b32 v30, 3, v0
s_lshl_b32 s3, s32, 6
v_add_u32 v30, s3, v30
v_lshlrev_b32 v30, 10, v30
v_and_b32 v31, 7, v0
v_lshrrev_b32 v32, 4, v0
v_xor_b32_e64 v31, v31, v32
v_lshl_add_u32 v2, v31, 4, v30
v_xor_b32_e64 v31, 4, v31
v_lshl_add_u32 v3, v31, 4, v30
v_add_u32 v4, 32768, v2
v_add_u32 v5, 32768, v3
s_and_b32 s58, s2, 7
s_lshl_b32 s3, s58, 19
v_xor_b32 v6, s3, v6
v_xor_b32 v7, s3, v7
v_xor_b32 v8, s3, v8
v_xor_b32 v9, s3, v9
s_lshl_b32 s3, s58, 7
v_xor_b32 v2, s3, v2
v_xor_b32 v3, s3, v3
v_xor_b32 v4, s3, v4
v_xor_b32 v5, s3, v5
s_waitcnt lgkmcnt(0)
s_mov_b32 s16, s4
s_nop 0
s_and_b32 s17, s5, 0xffff
s_mov_b32 s18, 4194304
s_mov_b32 s19, 0x20000
buffer_load_dwordx4 v[48:51], v35, s[16:19], s36 offen offset:0 nt
buffer_load_dwordx4 v[52:55], v35, s[16:19], s36 offen offset:512 nt
buffer_load_dwordx4 v[56:59], v35, s[16:19], s36 offen offset:1024 nt
buffer_load_dwordx4 v[60:63], v35, s[16:19], s36 offen offset:1536 nt
s_getpc_b64 s[68:69]
L_cpf1:
s_add_u32 s68, s68, (recurrent_scan__compressed_kv_cla__moe_arch_mod__prompt_kernel-L_cpf1)&0xffffffff
s_addc_u32 s69, s69, ((recurrent_scan__compressed_kv_cla__moe_arch_mod__prompt_kernel-L_cpf1)>>32)&0xffffffff
s_lshr_b32 s70, s2, 3
s_lshl_b32 s70, s70, 2
s_add_u32 s70, s70, s32
s_lshl_b32 s70, s70, 10
v_and_b32 v122, 7, v0
v_lshlrev_b32 v122, 7, v122
v_add_u32 v122, s70, v122
v_min_u32 v122, L_k2_fin-recurrent_scan__compressed_kv_cla__moe_arch_mod__prompt_kernel-4, v122
v_mov_b32 v121, s69
v_add_co_u32 v120, vcc, s68, v122
s_nop 1
v_addc_co_u32 v121, vcc, 0, v121, vcc
global_load_dword v124, v[120:121], off
s_cmp_eq_u32 s35, 0
s_cselect_b32 s40, s40, s42
s_cselect_b32 s41, s41, s43
s_lshl_b32 s3, s34, 9
s_add_u32 s12, s40, s3
s_addc_u32 s13, s41, 0
s_and_b32 s13, s13, 0xffff
s_mov_b32 s14, 0
s_mov_b32 s15, 0x20000
s_sub_u32 s14, 4194304, s3
s_lshl_b32 s3, s33, 18
s_add_u32 s8, s6, s3
s_addc_u32 s9, s7, 0
s_and_b32 s9, s9, 0xffff
s_mov_b32 s10, 262144
s_mov_b32 s11, 0x20000
s_add_u32 m0, s57, 0
s_nop 0
buffer_load_dwordx4 v6, s[12:15], s52 offen offset:0 nt lds
buffer_load_dwordx4 v7, s[12:15], s53 offen offset:1024 nt lds
buffer_load_dwordx4 v6, s[12:15], s54 offen offset:2048 nt lds
buffer_load_dwordx4 v7, s[12:15], s55 offen offset:3072 nt lds
s_add_u32 m0, s57, 4096
s_nop 0
buffer_load_dwordx4 v8, s[12:15], s52 offen offset:0 nt lds
buffer_load_dwordx4 v9, s[12:15], s53 offen offset:1024 nt lds
buffer_load_dwordx4 v8, s[12:15], s54 offen offset:2048 nt lds
buffer_load_dwordx4 v9, s[12:15], s55 offen offset:3072 nt lds
s_mov_b32 s28, s44
s_and_b32 s29, s45, 0xffff
s_mov_b32 s30, 2048
s_mov_b32 s31, 0x20000
s_mov_b32 s20, s66
s_and_b32 s21, s67, 0xffff
s_mov_b32 s22, 8388608
s_mov_b32 s23, 0x20000
s_add_u32 s24, s66, 8388608
s_addc_u32 s25, s67, 0
s_and_b32 s25, s25, 0xffff
s_mov_b32 s26, 35717120
s_mov_b32 s27, 0x20000
v_and_b32 v30, 15, v0
s_lshr_b32 s3, s32, 1
s_lshl_b32 s3, s3, 14
v_lshlrev_b32 v31, 7, v30
v_add_u32 v31, s3, v31
v_lshrrev_b32 v34, 1, v30
v_xor_b32_e64 v34, v34, v32
v_lshl_add_u32 v10, v34, 4, v31
v_xor_b32_e64 v34, 4, v34
v_lshl_add_u32 v11, v34, 4, v31
v_lshrrev_b32_e64 v30, 2, v30
v_lshl_add_u32 v31, v32, 3, v30
v_lshlrev_b32 v31, 9, v31
v_and_b32 v34, 3, v0
v_lshl_add_u32 v31, v34, 3, v31
s_and_b32 s3, s32, 1
s_lshl_b32 s3, s3, 8
s_add_u32 s3, s3, 32768
v_add_u32 v31, s3, v31
v_and_b32 v34, 1, v32
v_lshl_add_u32 v30, v34, 2, v30
v_xor_b32_e64 v34, 0, v30
v_lshl_add_u32 v12, v34, 5, v31
v_xor_b32_e64 v34, 1, v30
v_lshl_add_u32 v13, v34, 5, v31
v_xor_b32_e64 v34, 2, v30
v_lshl_add_u32 v14, v34, 5, v31
v_xor_b32_e64 v34, 3, v30
v_lshl_add_u32 v15, v34, 5, v31
v_xor_b32_e64 v34, 4, v30
v_lshl_add_u32 v16, v34, 5, v31
v_xor_b32_e64 v34, 5, v30
v_lshl_add_u32 v17, v34, 5, v31
v_xor_b32_e64 v34, 6, v30
v_lshl_add_u32 v18, v34, 5, v31
v_xor_b32_e64 v34, 7, v30
v_lshl_add_u32 v19, v34, 5, v31
v_add_u32 v20, 65536, v10
v_add_u32 v21, 65536, v11
v_add_u32 v22, 65536, v12
v_add_u32 v23, 65536, v13
v_add_u32 v24, 65536, v14
v_add_u32 v25, 65536, v15
v_add_u32 v26, 65536, v16
v_add_u32 v27, 65536, v17
v_add_u32 v28, 65536, v18
v_add_u32 v29, 65536, v19
s_cmp_lt_u32 s32, 2
s_cselect_b32 s60, s8, s12
s_cselect_b32 s61, s9, s13
s_cselect_b32 s62, s10, s14
s_mov_b32 s63, 0x20000
s_mov_b32 s59, 524288
s_cselect_b32 s59, 128, s59
s_lshr_b32 s3, s2, 6
s_lshl_b32 s3, s3, 1
s_add_u32 s3, s3, s32
s_lshl_b32 s3, s3, 15
s_add_u32 s3, s3, 256
v_lshlrev_b32 v37, 10, v0
v_add_u32 v37, s3, v37
v_lshrrev_b32 v38, 2, v0
v_lshlrev_b32 v38, 13, v38
v_and_b32_e64 v39, 3, v0
v_lshl_add_u32 v38, v39, 7, v38
s_lshl_b32 s39, s33, 1
s_add_u32 s39, s39, s32
s_lshl_b32 s39, s39, 15
s_add_u32 s39, s39, 983040
v_add_u32 v38, s39, v38
s_cmp_lt_u32 s32, 2
s_cselect_b64 vcc, -1, 0
s_cselect_b32 s3, 32, 16
v_cndmask_b32 v47, v38, v37, vcc
v_cmp_gt_u32 vcc, s3, v0
v_mov_b32 v37, 2146435072
s_nop 0
v_cndmask_b32 v47, v37, v47, vcc
s_mul_i32 s3, s58, s59
v_xor_b32 v47, s3, v47
s_add_u32 m0, s56, 0
s_nop 0
buffer_load_dwordx4 v2, s[8:11], s48 offen offset:0 lds
buffer_load_dwordx4 v3, s[8:11], s49 offen offset:1024 lds
buffer_load_dwordx4 v2, s[8:11], s50 offen offset:2048 lds
buffer_load_dwordx4 v3, s[8:11], s51 offen offset:3072 lds
s_add_u32 m0, s56, 4096
s_nop 0
buffer_load_dwordx4 v4, s[8:11], s48 offen offset:0 lds
buffer_load_dwordx4 v5, s[8:11], s49 offen offset:1024 lds
buffer_load_dwordx4 v4, s[8:11], s50 offen offset:2048 lds
buffer_load_dwordx4 v5, s[8:11], s51 offen offset:3072 lds
buffer_load_dwordx4 v[64:67], v36, s[28:31], 0 offen offset:0
buffer_load_dwordx4 v[68:71], v36, s[28:31], 0 offen offset:512
buffer_load_dwordx4 v[72:75], v36, s[28:31], 0 offen offset:1024
buffer_load_dwordx4 v[76:79], v36, s[28:31], 0 offen offset:1536
v_xor_b32 v6, 524288, v6
v_xor_b32 v7, 524288, v7
v_xor_b32 v8, 524288, v8
v_xor_b32 v9, 524288, v9
v_xor_b32 v2, 128, v2
v_xor_b32 v3, 128, v3
v_xor_b32 v4, 128, v4
v_xor_b32 v5, 128, v5
s_waitcnt vmcnt(21)
v_lshlrev_b32 v80, 16, v48
v_and_b32 v81, 0xffff0000, v48
v_lshlrev_b32_e64 v82, 16, v49
v_and_b32 v83, 0xffff0000, v49
v_lshlrev_b32_e64 v84, 16, v50
v_and_b32 v85, 0xffff0000, v50
v_lshlrev_b32_e64 v86, 16, v51
v_and_b32 v87, 0xffff0000, v51
v_lshlrev_b32_e64 v88, 16, v52
v_and_b32 v89, 0xffff0000, v52
v_lshlrev_b32_e64 v90, 16, v53
v_and_b32 v91, 0xffff0000, v53
v_lshlrev_b32_e64 v92, 16, v54
v_and_b32 v93, 0xffff0000, v54
v_lshlrev_b32_e64 v94, 16, v55
v_and_b32 v95, 0xffff0000, v55
v_lshlrev_b32_e64 v96, 16, v56
v_and_b32 v97, 0xffff0000, v56
v_lshlrev_b32_e64 v98, 16, v57
v_and_b32 v99, 0xffff0000, v57
v_lshlrev_b32_e64 v100, 16, v58
v_and_b32 v101, 0xffff0000, v58
v_lshlrev_b32_e64 v102, 16, v59
v_and_b32 v103, 0xffff0000, v59
v_lshlrev_b32_e64 v104, 16, v60
v_and_b32 v105, 0xffff0000, v60
v_lshlrev_b32_e64 v106, 16, v61
v_and_b32 v107, 0xffff0000, v61
v_lshlrev_b32_e64 v108, 16, v62
v_and_b32 v109, 0xffff0000, v62
v_lshlrev_b32_e64 v110, 16, v63
v_and_b32 v111, 0xffff0000, v63
v_pk_add_f32 v[40:41], v[80:81], v[82:83]
v_pk_add_f32 v[42:43], v[84:85], v[86:87]
v_pk_add_f32 v[40:41], v[40:41], v[88:89]
v_pk_add_f32 v[42:43], v[42:43], v[90:91]
v_pk_add_f32 v[40:41], v[40:41], v[92:93]
v_pk_add_f32 v[42:43], v[42:43], v[94:95]
v_pk_add_f32 v[40:41], v[40:41], v[96:97]
v_pk_add_f32 v[42:43], v[42:43], v[98:99]
v_pk_add_f32 v[40:41], v[40:41], v[100:101]
v_pk_add_f32 v[42:43], v[42:43], v[102:103]
v_pk_add_f32 v[40:41], v[40:41], v[104:105]
v_pk_add_f32 v[42:43], v[42:43], v[106:107]
v_pk_add_f32 v[40:41], v[40:41], v[108:109]
v_pk_add_f32 v[42:43], v[42:43], v[110:111]
v_pk_add_f32 v[40:41], v[40:41], v[42:43]
Va 38,40,41
s_nop 1
v_add_f32_dpp v38, v38, v38 quad_perm:[1,0,3,2] row_mask:0xf bank_mask:0xf
s_nop 1
v_add_f32_dpp v38, v38, v38 quad_perm:[2,3,0,1] row_mask:0xf bank_mask:0xf
s_nop 1
v_add_f32_dpp v38, v38, v38 row_half_mirror row_mask:0xf bank_mask:0xf
s_nop 1
v_add_f32_dpp v38, v38, v38 row_mirror row_mask:0xf bank_mask:0xf
v_mov_b32 v37, v38
s_nop 1
v_permlane16_swap_b32 v37, v38
v_add_f32_e64 v38, v38, v37
s_add_u32 m0, s57, 65536
s_nop 0
buffer_load_dwordx4 v6, s[12:15], s52 offen offset:0 nt lds
buffer_load_dwordx4 v7, s[12:15], s53 offen offset:1024 nt lds
buffer_load_dwordx4 v6, s[12:15], s54 offen offset:2048 nt lds
buffer_load_dwordx4 v7, s[12:15], s55 offen offset:3072 nt lds
s_add_u32 m0, s57, 69632
s_nop 0
buffer_load_dwordx4 v8, s[12:15], s52 offen offset:0 nt lds
buffer_load_dwordx4 v9, s[12:15], s53 offen offset:1024 nt lds
buffer_load_dwordx4 v8, s[12:15], s54 offen offset:2048 nt lds
buffer_load_dwordx4 v9, s[12:15], s55 offen offset:3072 nt lds
v_mul_f32 v38, 0xba800000, v38
v_mov_b32_e64 v39, v38
v_pk_add_f32 v[112:113], v[80:81], v[38:39]
v_pk_mul_f32 v[40:41], v[112:113], v[112:113]
v_pk_add_f32 v[114:115], v[82:83], v[38:39]
v_pk_mul_f32 v[42:43], v[114:115], v[114:115]
v_pk_add_f32 v[116:117], v[84:85], v[38:39]
v_pk_fma_f32 v[40:41], v[116:117], v[116:117], v[40:41]
v_pk_add_f32 v[118:119], v[86:87], v[38:39]
v_pk_fma_f32 v[42:43], v[118:119], v[118:119], v[42:43]
v_pk_add_f32 v[112:113], v[88:89], v[38:39]
v_pk_fma_f32 v[40:41], v[112:113], v[112:113], v[40:41]
v_pk_add_f32 v[114:115], v[90:91], v[38:39]
v_pk_fma_f32 v[42:43], v[114:115], v[114:115], v[42:43]
v_pk_add_f32 v[116:117], v[92:93], v[38:39]
v_pk_fma_f32 v[40:41], v[116:117], v[116:117], v[40:41]
v_pk_add_f32 v[118:119], v[94:95], v[38:39]
v_pk_fma_f32 v[42:43], v[118:119], v[118:119], v[42:43]
v_pk_add_f32 v[112:113], v[96:97], v[38:39]
v_pk_fma_f32 v[40:41], v[112:113], v[112:113], v[40:41]
v_pk_add_f32 v[114:115], v[98:99], v[38:39]
v_pk_fma_f32 v[42:43], v[114:115], v[114:115], v[42:43]
v_pk_add_f32 v[116:117], v[100:101], v[38:39]
v_pk_fma_f32 v[40:41], v[116:117], v[116:117], v[40:41]
v_pk_add_f32 v[118:119], v[102:103], v[38:39]
v_pk_fma_f32 v[42:43], v[118:119], v[118:119], v[42:43]
v_pk_add_f32 v[112:113], v[104:105], v[38:39]
v_pk_fma_f32 v[40:41], v[112:113], v[112:113], v[40:41]
v_pk_add_f32 v[114:115], v[106:107], v[38:39]
v_pk_fma_f32 v[42:43], v[114:115], v[114:115], v[42:43]
v_pk_add_f32 v[116:117], v[108:109], v[38:39]
v_pk_fma_f32 v[40:41], v[116:117], v[116:117], v[40:41]
v_pk_add_f32 v[118:119], v[110:111], v[38:39]
v_pk_fma_f32 v[42:43], v[118:119], v[118:119], v[42:43]
v_pk_add_f32 v[40:41], v[40:41], v[42:43]
Va 40,40,41
s_nop 1
v_add_f32_dpp v40, v40, v40 quad_perm:[1,0,3,2] row_mask:0xf bank_mask:0xf
s_nop 1
v_add_f32_dpp v40, v40, v40 quad_perm:[2,3,0,1] row_mask:0xf bank_mask:0xf
s_nop 1
v_add_f32_dpp v40, v40, v40 row_half_mirror row_mask:0xf bank_mask:0xf
s_nop 1
v_add_f32_dpp v40, v40, v40 row_mirror row_mask:0xf bank_mask:0xf
v_mov_b32 v37, v40
s_nop 1
v_permlane16_swap_b32 v37, v40
v_add_f32_e64 v40, v40, v37
s_add_u32 m0, s56, 65536
s_nop 0
buffer_load_dwordx4 v2, s[8:11], s48 offen offset:0 lds
buffer_load_dwordx4 v3, s[8:11], s49 offen offset:1024 lds
buffer_load_dwordx4 v2, s[8:11], s50 offen offset:2048 lds
buffer_load_dwordx4 v3, s[8:11], s51 offen offset:3072 lds
s_add_u32 m0, s56, 69632
s_nop 0
buffer_load_dwordx4 v4, s[8:11], s48 offen offset:0 lds
buffer_load_dwordx4 v5, s[8:11], s49 offen offset:1024 lds
buffer_load_dwordx4 v4, s[8:11], s50 offen offset:2048 lds
buffer_load_dwordx4 v5, s[8:11], s51 offen offset:3072 lds
v_mul_f32 v40, 0x3a800000, v40
Vc 44,38,40
v_lshlrev_b32_e64 v38, 16, v44
v_and_b32 v40, 0xffff0000, v44
v_add_f32 v40, 0x3727c5ac, v40
Vc 44,40,40
v_lshlrev_b32 v40, 16, v44
v_sqrt_f32 v40, v40
v_mov_b32_e64 v39, v38
Vc 44,40,40
v_lshlrev_b32 v44, 16, v44
v_rcp_f32 v40, v44
v_pk_add_f32 v[80:81], v[80:81], v[38:39]
v_pk_add_f32 v[82:83], v[82:83], v[38:39]
v_pk_add_f32 v[84:85], v[84:85], v[38:39]
v_pk_add_f32 v[86:87], v[86:87], v[38:39]
v_pk_add_f32 v[88:89], v[88:89], v[38:39]
v_pk_add_f32 v[90:91], v[90:91], v[38:39]
v_pk_add_f32 v[92:93], v[92:93], v[38:39]
v_pk_add_f32 v[94:95], v[94:95], v[38:39]
v_pk_add_f32 v[96:97], v[96:97], v[38:39]
v_pk_add_f32 v[98:99], v[98:99], v[38:39]
v_pk_add_f32 v[100:101], v[100:101], v[38:39]
v_pk_add_f32 v[102:103], v[102:103], v[38:39]
v_pk_add_f32 v[104:105], v[104:105], v[38:39]
v_pk_add_f32 v[106:107], v[106:107], v[38:39]
v_pk_add_f32 v[108:109], v[108:109], v[38:39]
v_pk_add_f32 v[110:111], v[110:111], v[38:39]
v_fma_f32 v45, -v44, v40, 1.0
v_fma_f32 v40, v45, v40, v40
v_mov_b32_e64 v41, v40
Vc 48,80,81
Vc 49,82,83
Vc 50,84,85
Vc 51,86,87
Vc 52,88,89
Vc 53,90,91
Vc 54,92,93
Vc 55,94,95
Vc 56,96,97
Vc 57,98,99
Vc 58,100,101
Vc 59,102,103
Vc 60,104,105
Vc 61,106,107
Vc 62,108,109
Vc 63,110,111
v_lshlrev_b32_e64 v80, 16, v48
v_and_b32 v81, 0xffff0000, v48
v_lshlrev_b32_e64 v82, 16, v49
v_and_b32 v83, 0xffff0000, v49
v_lshlrev_b32_e64 v84, 16, v50
v_and_b32 v85, 0xffff0000, v50
v_lshlrev_b32_e64 v86, 16, v51
v_and_b32 v87, 0xffff0000, v51
v_lshlrev_b32_e64 v88, 16, v52
v_and_b32 v89, 0xffff0000, v52
v_lshlrev_b32_e64 v90, 16, v53
v_and_b32 v91, 0xffff0000, v53
v_lshlrev_b32_e64 v92, 16, v54
v_and_b32 v93, 0xffff0000, v54
v_lshlrev_b32_e64 v94, 16, v55
v_and_b32 v95, 0xffff0000, v55
v_lshlrev_b32_e64 v96, 16, v56
v_and_b32 v97, 0xffff0000, v56
v_lshlrev_b32_e64 v98, 16, v57
v_and_b32 v99, 0xffff0000, v57
v_lshlrev_b32_e64 v100, 16, v58
v_and_b32 v101, 0xffff0000, v58
v_lshlrev_b32_e64 v102, 16, v59
v_and_b32 v103, 0xffff0000, v59
v_lshlrev_b32_e64 v104, 16, v60
v_and_b32 v105, 0xffff0000, v60
v_lshlrev_b32_e64 v106, 16, v61
v_and_b32 v107, 0xffff0000, v61
v_lshlrev_b32_e64 v108, 16, v62
v_and_b32 v109, 0xffff0000, v62
v_lshlrev_b32_e64 v110, 16, v63
v_and_b32 v111, 0xffff0000, v63
v_pk_mul_f32 v[80:81], v[80:81], v[40:41]
v_pk_mul_f32 v[82:83], v[82:83], v[40:41]
v_pk_mul_f32 v[84:85], v[84:85], v[40:41]
v_pk_mul_f32 v[86:87], v[86:87], v[40:41]
v_pk_mul_f32 v[88:89], v[88:89], v[40:41]
v_pk_mul_f32 v[90:91], v[90:91], v[40:41]
v_pk_mul_f32 v[92:93], v[92:93], v[40:41]
v_pk_mul_f32 v[94:95], v[94:95], v[40:41]
v_pk_mul_f32 v[96:97], v[96:97], v[40:41]
v_pk_mul_f32 v[98:99], v[98:99], v[40:41]
v_pk_mul_f32 v[100:101], v[100:101], v[40:41]
v_pk_mul_f32 v[102:103], v[102:103], v[40:41]
v_pk_mul_f32 v[104:105], v[104:105], v[40:41]
v_pk_mul_f32 v[106:107], v[106:107], v[40:41]
v_pk_mul_f32 v[108:109], v[108:109], v[40:41]
v_pk_mul_f32 v[110:111], v[110:111], v[40:41]
Vc 48,80,81
Vc 49,82,83
Vc 50,84,85
Vc 51,86,87
Vc 52,88,89
Vc 53,90,91
Vc 54,92,93
Vc 55,94,95
Vc 56,96,97
Vc 57,98,99
Vc 58,100,101
Vc 59,102,103
Vc 60,104,105
Vc 61,106,107
Vc 62,108,109
Vc 63,110,111
s_mul_i32 s3, s32, 4128
s_add_u32 s3, s3, 131072
v_mul_u32_u24 v42, 2064, v33
v_add3_u32 v42, v42, v36, s3
ds_write_b128 v42, v[48:51] offset:0
ds_write_b128 v42, v[52:55] offset:512
ds_write_b128 v42, v[56:59] offset:1024
ds_write_b128 v42, v[60:63] offset:1536
v_xor_b32 v6, 1572864, v6
v_xor_b32 v7, 1572864, v7
v_xor_b32 v8, 1572864, v8
v_xor_b32 v9, 1572864, v9
v_xor_b32 v2, 384, v2
v_xor_b32 v3, 384, v3
v_xor_b32 v4, 384, v4
v_xor_b32 v5, 384, v5
buffer_load_dword v1, v47, s[60:63], 0 offen
s_mul_i32 vcc_lo, s59, 1
v_xor_b32 v47, vcc_lo, v47
buffer_load_dword v1, v47, s[60:63], 0 offen
s_mul_i32 vcc_lo, s59, 7
v_xor_b32 v47, vcc_lo, v47
buffer_load_dword v1, v47, s[60:63], 0 offen
s_mul_i32 vcc_lo, s59, 1
v_xor_b32 v47, vcc_lo, v47
s_waitcnt vmcnt(19)
v_lshlrev_b32 v80, 16, v48
v_and_b32 v81, 0xffff0000, v48
v_lshlrev_b32_e64 v112, 16, v64
v_and_b32 v113, 0xffff0000, v64
v_pk_mul_f32 v[42:43], v[80:81], v[112:113]
v_lshlrev_b32_e64 v82, 16, v49
v_and_b32 v83, 0xffff0000, v49
v_lshlrev_b32_e64 v114, 16, v65
v_and_b32 v115, 0xffff0000, v65
v_pk_mul_f32 v[44:45], v[82:83], v[114:115]
v_lshlrev_b32_e64 v84, 16, v50
v_and_b32 v85, 0xffff0000, v50
v_lshlrev_b32_e64 v116, 16, v66
v_and_b32 v117, 0xffff0000, v66
v_pk_fma_f32 v[42:43], v[84:85], v[116:117], v[42:43]
v_lshlrev_b32_e64 v86, 16, v51
v_and_b32 v87, 0xffff0000, v51
v_lshlrev_b32_e64 v118, 16, v67
v_and_b32 v119, 0xffff0000, v67
v_pk_fma_f32 v[44:45], v[86:87], v[118:119], v[44:45]
v_lshlrev_b32_e64 v88, 16, v52
v_and_b32 v89, 0xffff0000, v52
v_lshlrev_b32_e64 v112, 16, v68
v_and_b32 v113, 0xffff0000, v68
v_pk_fma_f32 v[42:43], v[88:89], v[112:113], v[42:43]
v_lshlrev_b32_e64 v90, 16, v53
v_and_b32 v91, 0xffff0000, v53
v_lshlrev_b32_e64 v114, 16, v69
v_and_b32 v115, 0xffff0000, v69
v_pk_fma_f32 v[44:45], v[90:91], v[114:115], v[44:45]
v_lshlrev_b32_e64 v92, 16, v54
v_and_b32 v93, 0xffff0000, v54
v_lshlrev_b32_e64 v116, 16, v70
v_and_b32 v117, 0xffff0000, v70
v_pk_fma_f32 v[42:43], v[92:93], v[116:117], v[42:43]
v_lshlrev_b32_e64 v94, 16, v55
v_and_b32 v95, 0xffff0000, v55
v_lshlrev_b32_e64 v118, 16, v71
v_and_b32 v119, 0xffff0000, v71
v_pk_fma_f32 v[44:45], v[94:95], v[118:119], v[44:45]
v_lshlrev_b32_e64 v96, 16, v56
v_and_b32 v97, 0xffff0000, v56
v_lshlrev_b32_e64 v112, 16, v72
v_and_b32 v113, 0xffff0000, v72
v_pk_fma_f32 v[42:43], v[96:97], v[112:113], v[42:43]
v_lshlrev_b32_e64 v98, 16, v57
v_and_b32 v99, 0xffff0000, v57
v_lshlrev_b32_e64 v114, 16, v73
v_and_b32 v115, 0xffff0000, v73
v_pk_fma_f32 v[44:45], v[98:99], v[114:115], v[44:45]
v_lshlrev_b32_e64 v100, 16, v58
v_and_b32 v101, 0xffff0000, v58
v_lshlrev_b32_e64 v116, 16, v74
v_and_b32 v117, 0xffff0000, v74
v_pk_fma_f32 v[42:43], v[100:101], v[116:117], v[42:43]
v_lshlrev_b32_e64 v102, 16, v59
v_and_b32 v103, 0xffff0000, v59
v_lshlrev_b32_e64 v118, 16, v75
v_and_b32 v119, 0xffff0000, v75
v_pk_fma_f32 v[44:45], v[102:103], v[118:119], v[44:45]
v_lshlrev_b32_e64 v104, 16, v60
v_and_b32 v105, 0xffff0000, v60
v_lshlrev_b32_e64 v112, 16, v76
v_and_b32 v113, 0xffff0000, v76
v_pk_fma_f32 v[42:43], v[104:105], v[112:113], v[42:43]
v_lshlrev_b32_e64 v106, 16, v61
v_and_b32 v107, 0xffff0000, v61
v_lshlrev_b32_e64 v114, 16, v77
v_and_b32 v115, 0xffff0000, v77
v_pk_fma_f32 v[44:45], v[106:107], v[114:115], v[44:45]
v_lshlrev_b32_e64 v108, 16, v62
v_and_b32 v109, 0xffff0000, v62
v_lshlrev_b32_e64 v116, 16, v78
v_and_b32 v117, 0xffff0000, v78
v_pk_fma_f32 v[42:43], v[108:109], v[116:117], v[42:43]
v_lshlrev_b32_e64 v110, 16, v63
v_and_b32 v111, 0xffff0000, v63
v_lshlrev_b32_e64 v118, 16, v79
v_and_b32 v119, 0xffff0000, v79
v_pk_fma_f32 v[44:45], v[110:111], v[118:119], v[44:45]
v_pk_add_f32 v[42:43], v[42:43], v[44:45]
Va 45,42,43
s_nop 1
v_add_f32_dpp v45, v45, v45 quad_perm:[1,0,3,2] row_mask:0xf bank_mask:0xf
s_nop 1
v_add_f32_dpp v45, v45, v45 quad_perm:[2,3,0,1] row_mask:0xf bank_mask:0xf
s_nop 1
v_add_f32_dpp v45, v45, v45 row_half_mirror row_mask:0xf bank_mask:0xf
s_nop 1
v_add_f32_dpp v45, v45, v45 row_mirror row_mask:0xf bank_mask:0xf
v_mov_b32 v37, v45
s_nop 1
v_permlane16_swap_b32 v37, v45
v_add_f32_e64 v45, v45, v37
Vc 45,45,45
v_ashrrev_i32_e64 v46, 31, v45
v_or_b32 v46, 0x80000000, v46
v_xor_b32_e64 v45, v45, v46
v_and_b32 v45, 0xffff0000, v45
s_lshr_b32 s3, s36, 11
v_add_u32 v46, s3, v33
v_sub_u32 v44, 0xffff, v46
v_or_b32 v45, v45, v44
v_lshlrev_b32 v44, 2, v46
v_lshlrev_b32_e64 v46, 3, v46
v_xor_b32 v38, 0x80000000, v38
v_mov_b32_e64 v39, v40
s_mov_b32 s3, 5242880
s_mov_b32 s39, 5259264
s_mov_b32 exec_lo, 1
s_mov_b32 exec_hi, 1
buffer_store_dword v45, v44, s[20:23], s3 offen sc1
buffer_store_dwordx2 v[38:39], v46, s[20:23], s39 offen sc1
s_mov_b64 exec, -1
s_load_dwordx2 s[4:5], s[0:1], 16
s_load_dwordx4 s[40:43], s[0:1], 64
s_load_dwordx2 s[92:93], s[0:1], 40
s_load_dwordx2 s[94:95], s[0:1], 80
s_load_dwordx2 s[100:101], s[0:1], 0
s_mov_b32 s28, s64
s_and_b32 s29, s65, 0xffff
s_mov_b32 s30, 256
s_mov_b32 s31, 0x20000
s_waitcnt lgkmcnt(0)
s_barrier
Ta 32,12,0
Ta 34,12,2048
Ra 0,10,0
Ta 36,13,0
Ta 38,13,2048
Ra 4,10,2048
Ta 40,14,0
Ta 42,14,2048
Ra 8,10,4096
Ta 44,15,0
Ta 46,15,2048
Ra 12,10,6144
s_waitcnt lgkmcnt(2)
s_nop 0
Ta 48,16,0
Ta 50,16,2048
Ra 16,10,8192
Ta 52,17,0
Ta 54,17,2048
Ra 20,10,10240
Ta 56,18,0
Ta 58,18,2048
Ra 24,10,12288
Ta 60,19,0
Ta 62,19,2048
Ra 28,10,14336
s_cmp_lg_u32 s35, 0
s_cbranch_scc1 L_k1_vpath
s_waitcnt lgkmcnt(0)
Zvaa 48,32,0
v_and_b32 v46, 7, v0
v_mul_u32_u24 v30, 2064, v46
Zvaa 52,36,0
Ta 96,12,16384
Ta 98,12,18432
Zvaa 56,40,0
v_lshrrev_b32_e64 v31, 3, v0
Zvaa 60,44,0
Ra 64,11,0
Zvaa 64,48,0
s_lshl_b32 s3, s32, 9
s_add_u32 s3, s3, 131072
v_lshl_add_u32 v30, v31, 4, v30
Zvaa 68,52,0
Ta 100,13,16384
Ta 102,13,18432
Zvaa 72,56,0
v_add_u32 v30, s3, v30
v_lshlrev_b32_e64 v31, 8, v31
Zvaa 76,60,0
s_waitcnt lgkmcnt(6)
Ra 68,11,2048
Zvaa 80,32,4
v_lshl_add_u32 v46, v46, 4, v31
Zvaa 84,36,4
Ta 104,14,16384
Ta 106,14,18432
Zvaa 88,40,4
Rv 34,30,128
Rv 38,30,256
Zvaa 92,44,4
Ra 72,11,4096
Zvaa 96,48,4
Rv 42,30,384
Rv 30,30,0
Zvaa 100,52,4
Ta 108,15,16384
Ta 110,15,18432
Zvaa 104,56,4
s_lshr_b32 s3, s2, 1
s_mul_i32 s3, s3, 33792
s_add_u32 s3, s3, s56
Zvaa 108,60,4
s_waitcnt lgkmcnt(6)
Ra 76,11,6144
Zvaa 112,32,8
s_and_b32 s39, s2, 1
s_lshl_b32 s39, s39, 7
s_add_u32 s3, s3, s39
Zvaa 116,36,8
Ta 112,16,16384
Ta 114,16,18432
Zvaa 120,40,8
s_add_u32 s39, s3, 4096
Zvaa 124,44,8
Ra 80,11,8192
Zvaa 128,48,8
Zvaa 132,52,8
Ta 116,17,16384
Ta 118,17,18432
Zvaa 136,56,8
Zvaa 140,60,8
s_waitcnt lgkmcnt(6)
Ra 84,11,10240
Zvaa 144,32,12
Zvaa 148,36,12
Ta 120,18,16384
Ta 122,18,18432
Zvaa 152,40,12
Zvaa 156,44,12
Ra 88,11,12288
Zvaa 160,48,12
Zvaa 164,52,12
Ta 124,19,16384
Ta 126,19,18432
Zvaa 168,56,12
Zvaa 172,60,12
s_waitcnt lgkmcnt(6)
Ra 92,11,14336
Zvaa 176,32,16
Zvaa 180,36,16
Zvaa 184,40,16
Zvaa 188,44,16
Zvaa 192,48,16
Zvaa 196,52,16
Zvaa 200,56,16
Zvaa 204,60,16
Zvaa 208,32,20
Zvaa 212,36,20
Zvaa 216,40,20
Zvaa 220,44,20
Zvaa 224,48,20
Zvaa 228,52,20
Zvaa 232,56,20
Zvaa 236,60,20
Zvaa 240,32,24
Zvaa 244,36,24
Zvaa 248,40,24
Zvaa 252,44,24
Zaaa 128,48,24
Zaaa 132,52,24
Zaaa 136,56,24
Zaaa 140,60,24
Zaaa 144,32,28
Zaaa 148,36,28
Zaaa 152,40,28
Zaaa 156,44,28
Zaaa 160,48,28
Zaaa 164,52,28
Zaaa 168,56,28
Zaaa 172,60,28
s_waitcnt vmcnt(5) lgkmcnt(0)
s_add_u32 m0, s57, 0
s_barrier
Mvaa 48,96,64
buffer_load_dwordx4 v6, s[12:15], s52 offen offset:0 nt lds
Mvaa 52,100,64
Ta 32,22,0
Ta 34,22,2048
Mvaa 56,104,64
Mvaa 60,108,64
Ra 0,20,0
Mvaa 64,112,64
buffer_load_dwordx4 v7, s[12:15], s53 offen offset:1024 nt lds
Mvaa 68,116,64
s_waitcnt lgkmcnt(6)
Ta 36,23,0
Ta 38,23,2048
Mvaa 72,120,64
Mvaa 76,124,64
Ra 4,20,2048
Mvaa 80,96,68
buffer_load_dwordx4 v6, s[12:15], s54 offen offset:2048 nt lds
Mvaa 84,100,68
Ta 40,24,0
Ta 42,24,2048
Mvaa 88,104,68
Mvaa 92,108,68
Ra 8,20,4096
Mvaa 96,112,68
buffer_load_dwordx4 v7, s[12:15], s55 offen offset:3072 nt lds
Mvaa 100,116,68
s_waitcnt lgkmcnt(6)
Ta 44,25,0
Ta 46,25,2048
Mvaa 104,120,68
Mvaa 108,124,68
s_add_u32 m0, s57, 4096
Ra 12,20,6144
Mvaa 112,96,72
buffer_load_dwordx4 v8, s[12:15], s52 offen offset:0 nt lds
Mvaa 116,100,72
Ta 48,26,0
Ta 50,26,2048
Mvaa 120,104,72
Mvaa 124,108,72
Ra 16,20,8192
Mvaa 128,112,72
buffer_load_dwordx4 v9, s[12:15], s53 offen offset:1024 nt lds
Mvaa 132,116,72
s_waitcnt lgkmcnt(6)
Ta 52,27,0
Ta 54,27,2048
Mvaa 136,120,72
Mvaa 140,124,72
Ra 20,20,10240
Mvaa 144,96,76
buffer_load_dwordx4 v8, s[12:15], s54 offen offset:2048 nt lds
Mvaa 148,100,76
Ta 56,28,0
Ta 58,28,2048
Mvaa 152,104,76
Mvaa 156,108,76
Ra 24,20,12288
Mvaa 160,112,76
buffer_load_dwordx4 v9, s[12:15], s55 offen offset:3072 nt lds
Mvaa 164,116,76
s_waitcnt lgkmcnt(6)
Ta 60,29,0
Ta 62,29,2048
Mvaa 168,120,76
v_xor_b32 v6, 524288, v6
v_xor_b32 v7, 524288, v7
Mvaa 172,124,76
s_add_u32 m0, s56, 0
Ra 28,20,14336
v_xor_b32 v8, 524288, v8
Mvaa 176,96,80
buffer_load_dwordx4 v2, s[8:11], s48 offen offset:0 lds
Mvaa 180,100,80
v_xor_b32 v9, 524288, v9
Mvaa 184,104,80
Mvaa 188,108,80
Mvaa 192,112,80
buffer_load_dwordx4 v3, s[8:11], s49 offen offset:1024 lds
Mvaa 196,116,80
Mvaa 200,120,80
Mvaa 204,124,80
Mvaa 208,96,84
buffer_load_dwordx4 v2, s[8:11], s50 offen offset:2048 lds
Mvaa 212,100,84
Mvaa 216,104,84
Mvaa 220,108,84
Mvaa 224,112,84
buffer_load_dwordx4 v3, s[8:11], s51 offen offset:3072 lds
Mvaa 228,116,84
Mvaa 232,120,84
Mvaa 236,124,84
s_add_u32 m0, s56, 4096
Mvaa 240,96,88
buffer_load_dwordx4 v4, s[8:11], s48 offen offset:0 lds
Mvaa 244,100,88
Mvaa 248,104,88
Mvaa 252,108,88
Maaa 128,112,88
buffer_load_dwordx4 v5, s[8:11], s49 offen offset:1024 lds
Maaa 132,116,88
Maaa 136,120,88
Maaa 140,124,88
Maaa 144,96,92
buffer_load_dwordx4 v4, s[8:11], s50 offen offset:2048 lds
Maaa 148,100,92
Maaa 152,104,92
Maaa 156,108,92
Maaa 160,112,92
buffer_load_dwordx4 v5, s[8:11], s51 offen offset:3072 lds
Maaa 164,116,92
v_xor_b32 v2, 128, v2
v_xor_b32 v3, 128, v3
Maaa 168,120,92
buffer_load_dword v1, v47, s[60:63], 0 offen
v_xor_b32 v4, 128, v4
v_xor_b32 v5, 128, v5
Maaa 172,124,92
s_mul_i32 vcc_lo, s59, 3
v_xor_b32 v47, vcc_lo, v47
s_waitcnt lgkmcnt(0)
Mvaa 48,32,0
buffer_store_dwordx4 v[30:33], v46, s[20:23], s3 offen offset:0 sc1
Mvaa 52,36,0
Ta 96,22,16384
Ta 98,22,18432
Mvaa 56,40,0
buffer_store_dwordx4 v[34:37], v46, s[20:23], s3 offen offset:2048 sc1
Mvaa 60,44,0
Ra 64,21,0
Mvaa 64,48,0
buffer_store_dwordx4 v[38:41], v46, s[20:23], s39 offen offset:0 sc1
Mvaa 68,52,0
Ta 100,23,16384
Ta 102,23,18432
Mvaa 72,56,0
buffer_store_dwordx4 v[42:45], v46, s[20:23], s39 offen offset:2048 sc1
Mvaa 76,60,0
s_waitcnt lgkmcnt(6)
Ra 68,21,2048
Mvaa 80,32,4
s_lshl_b32 s3, s34, 1
s_and_b32 s36, s32, 1
s_add_u32 s3, s3, s36
Mvaa 84,36,4
Ta 104,24,16384
Ta 106,24,18432
Mvaa 88,40,4
s_mul_i32 s3, s3, 1116160
s_mul_i32 s36, s33, 139264
s_add_u32 s3, s3, s36
Mvaa 92,44,4
Ra 72,21,4096
Mvaa 96,48,4
s_lshr_b32 s36, s32, 1
s_mul_i32 s36, s36, 69632
s_add_u32 s3, s3, s36
Mvaa 100,52,4
Ta 108,25,16384
Ta 110,25,18432
Mvaa 104,56,4
s_add_u32 s38, s3, 0
s_lshl_b32 s39, s34, 7
s_lshl_b32 s36, s33, 2
Mvaa 108,60,4
s_waitcnt lgkmcnt(6)
Ra 76,21,6144
Mvaa 112,32,8
s_add_u32 s39, s39, s36
s_add_u32 s39, s39, 5296128
v_mov_b32_e64 v30, 1
Mvaa 116,36,8
Ta 112,26,16384
Ta 114,26,18432
Mvaa 120,40,8
v_mov_b32_e64 v31, 0
Mvaa 124,44,8
Ra 80,21,8192
Mvaa 128,48,8
s_cmp_eq_u32 s32, 0
s_cselect_b32 s39, s39, 2146435072
Mvaa 132,52,8
Ta 116,27,16384
Ta 118,27,18432
Mvaa 136,56,8
s_mov_b64 exec, 1
buffer_store_dword v31, v31, s[20:23], s39 offen sc1
s_mov_b64 exec, -1
Mvaa 140,60,8
s_waitcnt lgkmcnt(6)
Ra 84,21,10240
Mvaa 144,32,12
s_and_b32 s33, s2, 7
s_lshl_b32 s33, s33, 2
s_bfe_u32 s3, s2, 0x20003
Mvaa 148,36,12
Ta 120,28,16384
Ta 122,28,18432
Mvaa 152,40,12
s_add_u32 s33, s33, s3
s_lshr_b32 s34, s2, 5
s_lshl_b32 s64, s34, 7
Mvaa 156,44,12
Ra 88,21,12288
Mvaa 160,48,12
s_lshl_b32 s3, s33, 2
s_add_u32 s64, s64, s3
s_add_u32 s64, s64, 5300224
Mvaa 164,52,12
Ta 124,29,16384
Ta 126,29,18432
Mvaa 168,56,12
s_lshl_b32 s65, s34, 8
s_sub_u32 s65, 1920, s65
v_mul_u32_u24_e64 v32, s65, v0
Mvaa 172,60,12
s_waitcnt lgkmcnt(6)
Ra 92,21,14336
Mvaa 176,32,16
s_cmp_eq_u32 s32, 0
s_cselect_b32 s64, s64, 2146435072
Mvaa 180,36,16
s_mov_b64 exec, 3
buffer_store_dword v31, v32, s[20:23], s64 offen sc1
s_mov_b64 exec, -1
Mvaa 184,40,16
s_lshl_b32 s3, s2, 2
s_add_u32 s3, s3, 5302272
v_lshlrev_b32 v32, 10, v0
Mvaa 188,44,16
s_cmp_eq_u32 s32, 0
s_cselect_b32 s3, s3, 2146435072
Mvaa 192,48,16
s_mov_b64 exec, 31
buffer_store_dword v31, v32, s[20:23], s3 offen sc1
s_mov_b64 exec, -1
Mvaa 196,52,16
s_lshl_b32 s35, s34, 1
s_sub_u32 s36, 32, s35
s_add_u32 s35, s35, 2
Mvaa 200,56,16
s_lshl_b32 s44, s32, 12
s_mov_b32 s58, 33792
s_sub_u32 s3, 15, s34
Mvaa 204,60,16
s_lshl_b32 s45, s3, 2
s_add_u32 s45, s45, s32
s_lshl_b32 s46, s34, 2
Mvaa 208,32,20
s_add_u32 s46, s46, s32
s_mov_b32 s68, s42
s_and_b32 s69, s43, 0xffff
Mvaa 212,36,20
s_mov_b32 s70, 7340032
s_mov_b32 s71, 0x20000
s_cmp_eq_u32 s32, 0
s_cselect_b32 s37, 0, 2146435072
Mvaa 216,40,20
s_lshl_b32 s3, s33, 8
s_add_u32 s16, s4, s3
s_addc_u32 s17, s5, 0
s_and_b32 s17, s17, 0xffff
Mvaa 220,44,20
s_mov_b32 s18, 0
s_mov_b32 s19, 0x20000
s_sub_u32 s18, 8388608, s3
Mvaa 224,48,20
v_and_b32 v33, 15, v0
v_lshrrev_b32 v32, 1, v33
Mvaa 228,52,20
v_and_b32 v33, 1, v0
v_lshlrev_b32 v32, 13, v32
Mvaa 232,56,20
v_lshl_add_u32 v45, v33, 7, v32
Mvaa 236,60,20
s_lshl_b32 s3, s32, 3
s_add_u32 s3, s3, s34
s_mul_i32 s47, s3, 65536
Mvaa 240,32,24
s_bfe_u32 s6, s2, 131075
s_lshl_b32 s3, s32, 8
s_or_b32 s6, s6, s3
Mvaa 244,36,24
Mvaa 248,40,24
Mvaa 252,44,24
Maaa 128,48,24
Maaa 132,52,24
Maaa 136,56,24
Maaa 140,60,24
Maaa 144,32,28
Maaa 148,36,28
Maaa 152,40,28
Maaa 156,44,28
Maaa 160,48,28
Maaa 164,52,28
Maaa 168,56,28
Maaa 172,60,28
s_waitcnt vmcnt(8) lgkmcnt(0)
s_add_u32 m0, s57, 65536
s_barrier
Mvaa 48,96,64
buffer_load_dwordx4 v6, s[12:15], s52 offen offset:0 nt lds
Mvaa 52,100,64
Ta 32,12,0
Ta 34,12,2048
Mvaa 56,104,64
Mvaa 60,108,64
Ra 0,10,0
Mvaa 64,112,64
buffer_load_dwordx4 v7, s[12:15], s53 offen offset:1024 nt lds
Mvaa 68,116,64
s_waitcnt lgkmcnt(6)
Ta 36,13,0
Ta 38,13,2048
Mvaa 72,120,64
Mvaa 76,124,64
Ra 4,10,2048
Mvaa 80,96,68
buffer_load_dwordx4 v6, s[12:15], s54 offen offset:2048 nt lds
Mvaa 84,100,68
Ta 40,14,0
Ta 42,14,2048
Mvaa 88,104,68
Mvaa 92,108,68
Ra 8,10,4096
Mvaa 96,112,68
buffer_load_dwordx4 v7, s[12:15], s55 offen offset:3072 nt lds
Mvaa 100,116,68
s_waitcnt lgkmcnt(6)
Ta 44,15,0
Ta 46,15,2048
Mvaa 104,120,68
Mvaa 108,124,68
s_add_u32 m0, s57, 69632
Ra 12,10,6144
Mvaa 112,96,72
buffer_load_dwordx4 v8, s[12:15], s52 offen offset:0 nt lds
Mvaa 116,100,72
Ta 48,16,0
Ta 50,16,2048
Mvaa 120,104,72
Mvaa 124,108,72
Ra 16,10,8192
Mvaa 128,112,72
buffer_load_dwordx4 v9, s[12:15], s53 offen offset:1024 nt lds
Mvaa 132,116,72
s_waitcnt lgkmcnt(6)
Ta 52,17,0
Ta 54,17,2048
Mvaa 136,120,72
Mvaa 140,124,72
Ra 20,10,10240
Mvaa 144,96,76
buffer_load_dwordx4 v8, s[12:15], s54 offen offset:2048 nt lds
Mvaa 148,100,76
Ta 56,18,0
Ta 58,18,2048
Mvaa 152,104,76
Mvaa 156,108,76
Ra 24,10,12288
Mvaa 160,112,76
buffer_load_dwordx4 v9, s[12:15], s55 offen offset:3072 nt lds
Mvaa 164,116,76
s_waitcnt lgkmcnt(6)
Ta 60,19,0
Ta 62,19,2048
Mvaa 168,120,76
v_xor_b32 v6, 3670016, v6
v_xor_b32 v7, 3670016, v7
Mvaa 172,124,76
s_add_u32 m0, s56, 65536
Ra 28,10,14336
v_xor_b32 v8, 3670016, v8
Mvaa 176,96,80
buffer_load_dwordx4 v2, s[8:11], s48 offen offset:0 lds
Mvaa 180,100,80
v_xor_b32 v9, 3670016, v9
Mvaa 184,104,80
Mvaa 188,108,80
Mvaa 192,112,80
buffer_load_dwordx4 v3, s[8:11], s49 offen offset:1024 lds
Mvaa 196,116,80
Mvaa 200,120,80
Mvaa 204,124,80
Mvaa 208,96,84
buffer_load_dwordx4 v2, s[8:11], s50 offen offset:2048 lds
Mvaa 212,100,84
Mvaa 216,104,84
Mvaa 220,108,84
Mvaa 224,112,84
buffer_load_dwordx4 v3, s[8:11], s51 offen offset:3072 lds
Mvaa 228,116,84
Mvaa 232,120,84
Mvaa 236,124,84
s_add_u32 m0, s56, 69632
Mvaa 240,96,88
buffer_load_dwordx4 v4, s[8:11], s48 offen offset:0 lds
Mvaa 244,100,88
Mvaa 248,104,88
Mvaa 252,108,88
Maaa 128,112,88
buffer_load_dwordx4 v5, s[8:11], s49 offen offset:1024 lds
Maaa 132,116,88
Maaa 136,120,88
Maaa 140,124,88
Maaa 144,96,92
buffer_load_dwordx4 v4, s[8:11], s50 offen offset:2048 lds
Maaa 148,100,92
Maaa 152,104,92
Maaa 156,108,92
Maaa 160,112,92
buffer_load_dwordx4 v5, s[8:11], s51 offen offset:3072 lds
Maaa 164,116,92
v_xor_b32 v2, 896, v2
v_xor_b32 v3, 896, v3
Maaa 168,120,92
buffer_load_dword v1, v47, s[60:63], 0 offen
v_xor_b32 v4, 896, v4
v_xor_b32 v5, 896, v5
Maaa 172,124,92
s_mul_i32 vcc_lo, s59, 1
v_xor_b32 v47, vcc_lo, v47
s_waitcnt lgkmcnt(0)
Mvaa 48,32,0
Mvaa 52,36,0
Ta 96,12,16384
Ta 98,12,18432
Mvaa 56,40,0
Mvaa 60,44,0
Ra 64,11,0
Mvaa 64,48,0
Mvaa 68,52,0
Ta 100,13,16384
Ta 102,13,18432
Mvaa 72,56,0
Mvaa 76,60,0
s_waitcnt lgkmcnt(6)
Ra 68,11,2048
Mvaa 80,32,4
Mvaa 84,36,4
Ta 104,14,16384
Ta 106,14,18432
Mvaa 88,40,4
Mvaa 92,44,4
Ra 72,11,4096
Mvaa 96,48,4
Mvaa 100,52,4
Ta 108,15,16384
Ta 110,15,18432
Mvaa 104,56,4
Mvaa 108,60,4
s_waitcnt lgkmcnt(6)
Ra 76,11,6144
Mvaa 112,32,8
Mvaa 116,36,8
Ta 112,16,16384
Ta 114,16,18432
Mvaa 120,40,8
Mvaa 124,44,8
Ra 80,11,8192
Mvaa 128,48,8
Mvaa 132,52,8
Ta 116,17,16384
Ta 118,17,18432
Mvaa 136,56,8
Mvaa 140,60,8
s_waitcnt lgkmcnt(6)
Ra 84,11,10240
Mvaa 144,32,12
Mvaa 148,36,12
Ta 120,18,16384
Ta 122,18,18432
Mvaa 152,40,12
Mvaa 156,44,12
Ra 88,11,12288
Mvaa 160,48,12
Mvaa 164,52,12
Ta 124,19,16384
Ta 126,19,18432
Mvaa 168,56,12
Mvaa 172,60,12
s_waitcnt lgkmcnt(6)
Ra 92,11,14336
Mvaa 176,32,16
Mvaa 180,36,16
Mvaa 184,40,16
Mvaa 188,44,16
Mvaa 192,48,16
Mvaa 196,52,16
Mvaa 200,56,16
Mvaa 204,60,16
Mvaa 208,32,20
Mvaa 212,36,20
Mvaa 216,40,20
Mvaa 220,44,20
Mvaa 224,48,20
Mvaa 228,52,20
Mvaa 232,56,20
Mvaa 236,60,20
Mvaa 240,32,24
Mvaa 244,36,24
Mvaa 248,40,24
Mvaa 252,44,24
Maaa 128,48,24
Maaa 132,52,24
Maaa 136,56,24
Maaa 140,60,24
Maaa 144,32,28
Maaa 148,36,28
Maaa 152,40,28
Maaa 156,44,28
Maaa 160,48,28
Maaa 164,52,28
Maaa 168,56,28
Maaa 172,60,28
s_waitcnt vmcnt(1) lgkmcnt(0)
s_add_u32 m0, s57, 0
s_barrier
Mvaa 48,96,64
buffer_load_dwordx4 v6, s[12:15], s52 offen offset:0 nt lds
Mvaa 52,100,64
Ta 32,22,0
Ta 34,22,2048
Mvaa 56,104,64
Mvaa 60,108,64
Ra 0,20,0
Mvaa 64,112,64
buffer_load_dwordx4 v7, s[12:15], s53 offen offset:1024 nt lds
Mvaa 68,116,64
s_waitcnt lgkmcnt(6)
Ta 36,23,0
Ta 38,23,2048
Mvaa 72,120,64
Mvaa 76,124,64
Ra 4,20,2048
Mvaa 80,96,68
buffer_load_dwordx4 v6, s[12:15], s54 offen offset:2048 nt lds
Mvaa 84,100,68
Ta 40,24,0
Ta 42,24,2048
Mvaa 88,104,68
Mvaa 92,108,68
Ra 8,20,4096
Mvaa 96,112,68
buffer_load_dwordx4 v7, s[12:15], s55 offen offset:3072 nt lds
Mvaa 100,116,68
s_waitcnt lgkmcnt(6)
Ta 44,25,0
Ta 46,25,2048
Mvaa 104,120,68
s_cmp_eq_u32 s6, 0
s_cselect_b32 s3, 0, 2146435072
Mvaa 108,124,68
s_add_u32 m0, s57, 4096
Ra 12,20,6144
Mvaa 112,96,72
buffer_load_dwordx4 v8, s[12:15], s52 offen offset:0 nt lds
Mvaa 116,100,72
Ta 48,26,0
Ta 50,26,2048
Mvaa 120,104,72
s_mov_b64 exec, 1
buffer_atomic_add v30, v31, s[28:31], s3 offen sc1
s_mov_b64 exec, -1
Mvaa 124,108,72
Ra 16,20,8192
Mvaa 128,112,72
buffer_load_dwordx4 v9, s[12:15], s53 offen offset:1024 nt lds
Mvaa 132,116,72
s_waitcnt lgkmcnt(6)
Ta 52,27,0
Ta 54,27,2048
Mvaa 136,120,72
Mvaa 140,124,72
Ra 20,20,10240
Mvaa 144,96,76
buffer_load_dwordx4 v8, s[12:15], s54 offen offset:2048 nt lds
Mvaa 148,100,76
Ta 56,28,0
Ta 58,28,2048
Mvaa 152,104,76
Mvaa 156,108,76
Ra 24,20,12288
Mvaa 160,112,76
buffer_load_dwordx4 v9, s[12:15], s55 offen offset:3072 nt lds
Mvaa 164,116,76
s_waitcnt lgkmcnt(6)
Ta 60,29,0
Ta 62,29,2048
Mvaa 168,120,76
v_xor_b32 v6, 524288, v6
v_xor_b32 v7, 524288, v7
Mvaa 172,124,76
s_add_u32 m0, s56, 0
Ra 28,20,14336
v_xor_b32 v8, 524288, v8
Mvaa 176,96,80
buffer_load_dwordx4 v2, s[8:11], s48 offen offset:0 lds
Mvaa 180,100,80
v_xor_b32 v9, 524288, v9
Mvaa 184,104,80
Mvaa 188,108,80
Mvaa 192,112,80
buffer_load_dwordx4 v3, s[8:11], s49 offen offset:1024 lds
Mvaa 196,116,80
Mvaa 200,120,80
Mvaa 204,124,80
Mvaa 208,96,84
buffer_load_dwordx4 v2, s[8:11], s50 offen offset:2048 lds
Mvaa 212,100,84
Mvaa 216,104,84
Mvaa 220,108,84
Mvaa 224,112,84
buffer_load_dwordx4 v3, s[8:11], s51 offen offset:3072 lds
Mvaa 228,116,84
Mvaa 232,120,84
Mvaa 236,124,84
s_add_u32 m0, s56, 4096
Mvaa 240,96,88
buffer_load_dwordx4 v4, s[8:11], s48 offen offset:0 lds
Mvaa 244,100,88
Mvaa 248,104,88
Mvaa 252,108,88
Maaa 128,112,88
buffer_load_dwordx4 v5, s[8:11], s49 offen offset:1024 lds
Maaa 132,116,88
Maaa 136,120,88
Maaa 140,124,88
Maaa 144,96,92
buffer_load_dwordx4 v4, s[8:11], s50 offen offset:2048 lds
Maaa 148,100,92
Maaa 152,104,92
Maaa 156,108,92
Maaa 160,112,92
buffer_load_dwordx4 v5, s[8:11], s51 offen offset:3072 lds
Maaa 164,116,92
v_xor_b32 v2, 128, v2
v_xor_b32 v3, 128, v3
Maaa 168,120,92
buffer_load_dword v1, v47, s[60:63], 0 offen
v_xor_b32 v4, 128, v4
v_xor_b32 v5, 128, v5
Maaa 172,124,92
s_mul_i32 vcc_lo, s59, 7
v_xor_b32 v47, vcc_lo, v47
s_waitcnt lgkmcnt(0)
Mvaa 48,32,0
buffer_load_dword v44, v45, s[16:19], s47 offen
Mvaa 52,36,0
Ta 96,22,16384
Ta 98,22,18432
Mvaa 56,40,0
s_add_u32 s47, s47, 2097152
Mvaa 60,44,0
Ra 64,21,0
Mvaa 64,48,0
Mvaa 68,52,0
Ta 100,23,16384
Ta 102,23,18432
Mvaa 72,56,0
Mvaa 76,60,0
s_waitcnt lgkmcnt(6)
Ra 68,21,2048
Mvaa 80,32,4
Mvaa 84,36,4
Ta 104,24,16384
Ta 106,24,18432
Mvaa 88,40,4
Mvaa 92,44,4
Ra 72,21,4096
Mvaa 96,48,4
Mvaa 100,52,4
Ta 108,25,16384
Ta 110,25,18432
Mvaa 104,56,4
Mvaa 108,60,4
s_waitcnt lgkmcnt(6)
Ra 76,21,6144
Mvaa 112,32,8
Mvaa 116,36,8
Ta 112,26,16384
Ta 114,26,18432
Mvaa 120,40,8
Mvaa 124,44,8
Ra 80,21,8192
Mvaa 128,48,8
Mvaa 132,52,8
Ta 116,27,16384
Ta 118,27,18432
Mvaa 136,56,8
Mvaa 140,60,8
s_waitcnt lgkmcnt(6)
Ra 84,21,10240
Mvaa 144,32,12
Mvaa 148,36,12
Ta 120,28,16384
Ta 122,28,18432
Mvaa 152,40,12
s_cmp_eq_u32 s6, 1
s_cselect_b32 s3, 0, 2146435072
Mvaa 156,44,12
Ra 88,21,12288
Mvaa 160,48,12
s_mov_b64 exec, 1
buffer_atomic_add v30, v31, s[28:31], s3 offen sc1
s_mov_b64 exec, -1
Mvaa 164,52,12
Ta 124,29,16384
Ta 126,29,18432
Mvaa 168,56,12
Mvaa 172,60,12
s_waitcnt lgkmcnt(6)
Ra 92,21,14336
Mvaa 176,32,16
Mvaa 180,36,16
Mvaa 184,40,16
Mvaa 188,44,16
Mvaa 192,48,16
Mvaa 196,52,16
Mvaa 200,56,16
Mvaa 204,60,16
Mvaa 208,32,20
Mvaa 212,36,20
Mvaa 216,40,20
Mvaa 220,44,20
Mvaa 224,48,20
Mvaa 228,52,20
Mvaa 232,56,20
Mvaa 236,60,20
Mvaa 240,32,24
Mvaa 244,36,24
Mvaa 248,40,24
Mvaa 252,44,24
Maaa 128,48,24
Maaa 132,52,24
Maaa 136,56,24
Maaa 140,60,24
Maaa 144,32,28
Maaa 148,36,28
Maaa 152,40,28
Maaa 156,44,28
Maaa 160,48,28
Maaa 164,52,28
Maaa 168,56,28
Maaa 172,60,28
s_waitcnt vmcnt(3) lgkmcnt(0)
s_add_u32 m0, s57, 65536
s_barrier
Mvaa 48,96,64
buffer_load_dwordx4 v6, s[12:15], s52 offen offset:0 nt lds
Mvaa 52,100,64
Ta 32,12,0
Ta 34,12,2048
Mvaa 56,104,64
Mvaa 60,108,64
Ra 0,10,0
Mvaa 64,112,64
buffer_load_dwordx4 v7, s[12:15], s53 offen offset:1024 nt lds
Mvaa 68,116,64
s_waitcnt lgkmcnt(6)
Ta 36,13,0
Ta 38,13,2048
Mvaa 72,120,64
Mvaa 76,124,64
Ra 4,10,2048
Mvaa 80,96,68
buffer_load_dwordx4 v6, s[12:15], s54 offen offset:2048 nt lds
Mvaa 84,100,68
Ta 40,14,0
Ta 42,14,2048
Mvaa 88,104,68
Mvaa 92,108,68
Ra 8,10,4096
Mvaa 96,112,68
buffer_load_dwordx4 v7, s[12:15], s55 offen offset:3072 nt lds
Mvaa 100,116,68
s_waitcnt lgkmcnt(6)
Ta 44,15,0
Ta 46,15,2048
Mvaa 104,120,68
Mvaa 108,124,68
s_add_u32 m0, s57, 69632
Ra 12,10,6144
Mvaa 112,96,72
buffer_load_dwordx4 v8, s[12:15], s52 offen offset:0 nt lds
Mvaa 116,100,72
Ta 48,16,0
Ta 50,16,2048
Mvaa 120,104,72
Mvaa 124,108,72
Ra 16,10,8192
Mvaa 128,112,72
buffer_load_dwordx4 v9, s[12:15], s53 offen offset:1024 nt lds
Mvaa 132,116,72
s_waitcnt lgkmcnt(6)
Ta 52,17,0
Ta 54,17,2048
Mvaa 136,120,72
Mvaa 140,124,72
Ra 20,10,10240
Mvaa 144,96,76
buffer_load_dwordx4 v8, s[12:15], s54 offen offset:2048 nt lds
Mvaa 148,100,76
Ta 56,18,0
Ta 58,18,2048
Mvaa 152,104,76
Mvaa 156,108,76
Ra 24,10,12288
Mvaa 160,112,76
buffer_load_dwordx4 v9, s[12:15], s55 offen offset:3072 nt lds
Mvaa 164,116,76
s_waitcnt lgkmcnt(6)
Ta 60,19,0
Ta 62,19,2048
Mvaa 168,120,76
v_xor_b32 v6, 1572864, v6
v_xor_b32 v7, 1572864, v7
Mvaa 172,124,76
s_add_u32 m0, s56, 65536
Ra 28,10,14336
v_xor_b32 v8, 1572864, v8
Mvaa 176,96,80
buffer_load_dwordx4 v2, s[8:11], s48 offen offset:0 lds
Mvaa 180,100,80
v_xor_b32 v9, 1572864, v9
Mvaa 184,104,80
Mvaa 188,108,80
Mvaa 192,112,80
buffer_load_dwordx4 v3, s[8:11], s49 offen offset:1024 lds
Mvaa 196,116,80
Mvaa 200,120,80
Mvaa 204,124,80
s_cmp_eq_u32 s6, 2
s_cselect_b32 s3, 0, 2146435072
Mvaa 208,96,84
buffer_load_dwordx4 v2, s[8:11], s50 offen offset:2048 lds
Mvaa 212,100,84
s_mov_b64 exec, 1
buffer_atomic_add v30, v31, s[28:31], s3 offen sc1
s_mov_b64 exec, -1
Mvaa 216,104,84
Mvaa 220,108,84
Mvaa 224,112,84
buffer_load_dwordx4 v3, s[8:11], s51 offen offset:3072 lds
Mvaa 228,116,84
Mvaa 232,120,84
Mvaa 236,124,84
s_add_u32 m0, s56, 69632
Mvaa 240,96,88
buffer_load_dwordx4 v4, s[8:11], s48 offen offset:0 lds
Mvaa 244,100,88
Mvaa 248,104,88
Mvaa 252,108,88
Maaa 128,112,88
buffer_load_dwordx4 v5, s[8:11], s49 offen offset:1024 lds
Maaa 132,116,88
Maaa 136,120,88
Maaa 140,124,88
Maaa 144,96,92
buffer_load_dwordx4 v4, s[8:11], s50 offen offset:2048 lds
Maaa 148,100,92
Maaa 152,104,92
Maaa 156,108,92
Maaa 160,112,92
buffer_load_dwordx4 v5, s[8:11], s51 offen offset:3072 lds
Maaa 164,116,92
v_xor_b32 v2, 384, v2
v_xor_b32 v3, 384, v3
Maaa 168,120,92
v_xor_b32 v4, 384, v4
v_xor_b32 v5, 384, v5
Maaa 172,124,92
s_waitcnt lgkmcnt(0)
Mvaa 48,32,0
buffer_load_dword v44, v45, s[16:19], s47 offen
Mvaa 52,36,0
Ta 96,12,16384
Ta 98,12,18432
Mvaa 56,40,0
s_add_u32 s47, s47, 2097152
Mvaa 60,44,0
Ra 64,11,0
Mvaa 64,48,0
Mvaa 68,52,0
Ta 100,13,16384
Ta 102,13,18432
Mvaa 72,56,0
Mvaa 76,60,0
s_waitcnt lgkmcnt(6)
Ra 68,11,2048
Mvaa 80,32,4
Mvaa 84,36,4
Ta 104,14,16384
Ta 106,14,18432
Mvaa 88,40,4
Mvaa 92,44,4
Ra 72,11,4096
Mvaa 96,48,4
Mvaa 100,52,4
Ta 108,15,16384
Ta 110,15,18432
Mvaa 104,56,4
Mvaa 108,60,4
s_waitcnt lgkmcnt(6)
Ra 76,11,6144
Mvaa 112,32,8
Mvaa 116,36,8
Ta 112,16,16384
Ta 114,16,18432
Mvaa 120,40,8
Mvaa 124,44,8
Ra 80,11,8192
Mvaa 128,48,8
Mvaa 132,52,8
Ta 116,17,16384
Ta 118,17,18432
Mvaa 136,56,8
Mvaa 140,60,8
s_waitcnt lgkmcnt(6)
Ra 84,11,10240
Mvaa 144,32,12
Mvaa 148,36,12
Ta 120,18,16384
Ta 122,18,18432
Mvaa 152,40,12
Mvaa 156,44,12
Ra 88,11,12288
Mvaa 160,48,12
Mvaa 164,52,12
Ta 124,19,16384
Ta 126,19,18432
Mvaa 168,56,12
Mvaa 172,60,12
s_waitcnt lgkmcnt(6)
Ra 92,11,14336
Mvaa 176,32,16
Mvaa 180,36,16
Mvaa 184,40,16
Mvaa 188,44,16
Mvaa 192,48,16
Mvaa 196,52,16
Mvaa 200,56,16
Mvaa 204,60,16
Mvaa 208,32,20
Mvaa 212,36,20
Mvaa 216,40,20
Mvaa 220,44,20
Mvaa 224,48,20
Mvaa 228,52,20
Mvaa 232,56,20
Mvaa 236,60,20
Mvaa 240,32,24
Mvaa 244,36,24
Mvaa 248,40,24
Mvaa 252,44,24
Maaa 128,48,24
s_cmp_eq_u32 s6, 3
s_cselect_b32 s3, 0, 2146435072
Maaa 132,52,24
s_mov_b64 exec, 1
buffer_atomic_add v30, v31, s[28:31], s3 offen sc1
s_mov_b64 exec, -1
Maaa 136,56,24
Maaa 140,60,24
Maaa 144,32,28
Maaa 148,36,28
Maaa 152,40,28
Maaa 156,44,28
Maaa 160,48,28
Maaa 164,52,28
Maaa 168,56,28
Maaa 172,60,28
s_waitcnt vmcnt(2) lgkmcnt(0)
s_add_u32 m0, s57, 0
s_barrier
Mvaa 48,96,64
buffer_load_dwordx4 v6, s[12:15], s52 offen offset:0 nt lds
Mvaa 52,100,64
Ta 32,22,0
Ta 34,22,2048
Mvaa 56,104,64
Mvaa 60,108,64
Ra 0,20,0
Mvaa 64,112,64
buffer_load_dwordx4 v7, s[12:15], s53 offen offset:1024 nt lds
Mvaa 68,116,64
s_waitcnt lgkmcnt(6)
Ta 36,23,0
Ta 38,23,2048
Mvaa 72,120,64
Mvaa 76,124,64
Ra 4,20,2048
Mvaa 80,96,68
buffer_load_dwordx4 v6, s[12:15], s54 offen offset:2048 nt lds
Mvaa 84,100,68
Ta 40,24,0
Ta 42,24,2048
Mvaa 88,104,68
Mvaa 92,108,68
Ra 8,20,4096
Mvaa 96,112,68
buffer_load_dwordx4 v7, s[12:15], s55 offen offset:3072 nt lds
Mvaa 100,116,68
s_waitcnt lgkmcnt(6)
Ta 44,25,0
Ta 46,25,2048
Mvaa 104,120,68
Mvaa 108,124,68
s_add_u32 m0, s57, 4096
Ra 12,20,6144
Mvaa 112,96,72
buffer_load_dwordx4 v8, s[12:15], s52 offen offset:0 nt lds
Mvaa 116,100,72
Ta 48,26,0
Ta 50,26,2048
Mvaa 120,104,72
Mvaa 124,108,72
Ra 16,20,8192
Mvaa 128,112,72
buffer_load_dwordx4 v9, s[12:15], s53 offen offset:1024 nt lds
Mvaa 132,116,72
s_waitcnt lgkmcnt(6)
Ta 52,27,0
Ta 54,27,2048
Mvaa 136,120,72
Mvaa 140,124,72
Ra 20,20,10240
Mvaa 144,96,76
buffer_load_dwordx4 v8, s[12:15], s54 offen offset:2048 nt lds
Mvaa 148,100,76
Ta 56,28,0
Ta 58,28,2048
Mvaa 152,104,76
Mvaa 156,108,76
Ra 24,20,12288
Mvaa 160,112,76
buffer_load_dwordx4 v9, s[12:15], s55 offen offset:3072 nt lds
Mvaa 164,116,76
s_waitcnt lgkmcnt(6)
Ta 60,29,0
Ta 62,29,2048
Mvaa 168,120,76
v_xor_b32 v6, 524288, v6
v_xor_b32 v7, 524288, v7
Mvaa 172,124,76
s_add_u32 m0, s56, 0
Ra 28,20,14336
v_xor_b32 v8, 524288, v8
Mvaa 176,96,80
buffer_load_dwordx4 v2, s[8:11], s48 offen offset:0 lds
Mvaa 180,100,80
v_xor_b32 v9, 524288, v9
Mvaa 184,104,80
Mvaa 188,108,80
Mvaa 192,112,80
buffer_load_dwordx4 v3, s[8:11], s49 offen offset:1024 lds
Mvaa 196,116,80
Mvaa 200,120,80
Mvaa 204,124,80
Mvaa 208,96,84
buffer_load_dwordx4 v2, s[8:11], s50 offen offset:2048 lds
Mvaa 212,100,84
Mvaa 216,104,84
Mvaa 220,108,84
Mvaa 224,112,84
buffer_load_dwordx4 v3, s[8:11], s51 offen offset:3072 lds
Mvaa 228,116,84
Mvaa 232,120,84
Mvaa 236,124,84
s_add_u32 m0, s56, 4096
Mvaa 240,96,88
buffer_load_dwordx4 v4, s[8:11], s48 offen offset:0 lds
Mvaa 244,100,88
Mvaa 248,104,88
Mvaa 252,108,88
Maaa 128,112,88
buffer_load_dwordx4 v5, s[8:11], s49 offen offset:1024 lds
Maaa 132,116,88
Maaa 136,120,88
Maaa 140,124,88
Maaa 144,96,92
buffer_load_dwordx4 v4, s[8:11], s50 offen offset:2048 lds
Maaa 148,100,92
Maaa 152,104,92
Maaa 156,108,92
Maaa 160,112,92
buffer_load_dwordx4 v5, s[8:11], s51 offen offset:3072 lds
Maaa 164,116,92
v_xor_b32 v2, 128, v2
v_xor_b32 v3, 128, v3
Maaa 168,120,92
v_xor_b32 v4, 128, v4
v_xor_b32 v5, 128, v5
Maaa 172,124,92
s_waitcnt lgkmcnt(0)
Mvaa 48,32,0
buffer_load_dword v44, v45, s[16:19], s47 offen
Mvaa 52,36,0
Ta 96,22,16384
Ta 98,22,18432
Mvaa 56,40,0
s_add_u32 s47, s47, 2097152
v_lshrrev_b32 v32, 4, v0
v_and_b32 v33, 15, v0
Mvaa 60,44,0
Ra 64,21,0
Mvaa 64,48,0
s_lshl_b32 s3, s32, 4
v_add_u32 v34, s3, v32
v_lshlrev_b32_e64 v36, 1, v32
Mvaa 68,52,0
Ta 100,23,16384
Ta 102,23,18432
Mvaa 72,56,0
v_xor_b32 v36, v36, v33
v_xor_b32 v37, 8, v36
Mvaa 76,60,0
s_waitcnt lgkmcnt(6)
Ra 68,21,2048
Mvaa 80,32,4
s_getpc_b64 s[6:7]
L_cpf2:
s_add_u32 s6, s6, (L_phase2-L_cpf2)&0xffffffff
s_addc_u32 s7, s7, ((L_phase2-L_cpf2)>>32)&0xffffffff
Mvaa 84,36,4
Ta 104,24,16384
Ta 106,24,18432
Mvaa 88,40,4
s_lshr_b32 s3, s2, 3
s_lshl_b32 s3, s3, 2
s_add_u32 s3, s3, s32
Mvaa 92,44,4
Ra 72,21,4096
Mvaa 96,48,4
s_lshl_b32 s3, s3, 10
v_and_b32 v42, 7, v0
v_lshlrev_b32 v42, 7, v42
Mvaa 100,52,4
Ta 108,25,16384
Ta 110,25,18432
Mvaa 104,56,4
v_add_u32_e64 v42, s3, v42
v_min_u32 v42, L_k2_fin-L_phase2-4, v42
Mvaa 108,60,4
s_waitcnt lgkmcnt(6)
Ra 76,21,6144
Mvaa 112,32,8
v_mov_b32 v41, s7
Mvaa 116,36,8
Ta 112,26,16384
Ta 114,26,18432
Mvaa 120,40,8
v_add_co_u32 v40, vcc, s6, v42
s_nop 1
v_addc_co_u32 v41, vcc, 0, v41, vcc
Mvaa 124,44,8
Ra 80,21,8192
Mvaa 128,48,8
global_load_dword v38, v[40:41], off
Mvaa 132,52,8
Ta 116,27,16384
Ta 118,27,18432
Mvaa 136,56,8
Mvaa 140,60,8
s_waitcnt lgkmcnt(6)
Ra 84,21,10240
Mvaa 144,32,12
Mvaa 148,36,12
Ta 120,28,16384
Ta 122,28,18432
Mvaa 152,40,12
Mvaa 156,44,12
Ra 88,21,12288
Mvaa 160,48,12
Mvaa 164,52,12
Ta 124,29,16384
Ta 126,29,18432
Mvaa 168,56,12
Mvaa 172,60,12
s_waitcnt lgkmcnt(6)
Ra 92,21,14336
Mvaa 176,32,16
Mvaa 180,36,16
Mvaa 184,40,16
Mvaa 188,44,16
Mvaa 192,48,16
Mvaa 196,52,16
Mvaa 200,56,16
Mvaa 204,60,16
Mvaa 208,32,20
Mvaa 212,36,20
Mvaa 216,40,20
Mvaa 220,44,20
Mvaa 224,48,20
Mvaa 228,52,20
Mvaa 232,56,20
Mvaa 236,60,20
Mvaa 240,32,24
Mvaa 244,36,24
Mvaa 248,40,24
Mvaa 252,44,24
Maaa 128,48,24
Maaa 132,52,24
Maaa 136,56,24
Maaa 140,60,24
Maaa 144,32,28
Maaa 148,36,28
Maaa 152,40,28
Maaa 156,44,28
Maaa 160,48,28
Maaa 164,52,28
Maaa 168,56,28
Maaa 172,60,28
s_waitcnt vmcnt(2) lgkmcnt(0)
s_add_u32 m0, s57, 65536
s_barrier
Mvaa 48,96,64
buffer_load_dwordx4 v6, s[12:15], s52 offen offset:0 nt lds
Mvaa 52,100,64
Ta 32,12,0
Ta 34,12,2048
Mvaa 56,104,64
Mvaa 60,108,64
Ra 0,10,0
Mvaa 64,112,64
buffer_load_dwordx4 v7, s[12:15], s53 offen offset:1024 nt lds
Mvaa 68,116,64
s_waitcnt lgkmcnt(6)
Ta 36,13,0
Ta 38,13,2048
Mvaa 72,120,64
Mvaa 76,124,64
Ra 4,10,2048
Mvaa 80,96,68
buffer_load_dwordx4 v6, s[12:15], s54 offen offset:2048 nt lds
Mvaa 84,100,68
Ta 40,14,0
Ta 42,14,2048
Mvaa 88,104,68
Mvaa 92,108,68
Ra 8,10,4096
Mvaa 96,112,68
buffer_load_dwordx4 v7, s[12:15], s55 offen offset:3072 nt lds
Mvaa 100,116,68
s_waitcnt lgkmcnt(6)
Ta 44,15,0
Ta 46,15,2048
Mvaa 104,120,68
Mvaa 108,124,68
s_add_u32 m0, s57, 69632
Ra 12,10,6144
Mvaa 112,96,72
buffer_load_dwordx4 v8, s[12:15], s52 offen offset:0 nt lds
Mvaa 116,100,72
Ta 48,16,0
Ta 50,16,2048
Mvaa 120,104,72
Mvaa 124,108,72
Ra 16,10,8192
Mvaa 128,112,72
buffer_load_dwordx4 v9, s[12:15], s53 offen offset:1024 nt lds
Mvaa 132,116,72
s_waitcnt lgkmcnt(6)
Ta 52,17,0
Ta 54,17,2048
Mvaa 136,120,72
Mvaa 140,124,72
Ra 20,10,10240
Mvaa 144,96,76
buffer_load_dwordx4 v8, s[12:15], s54 offen offset:2048 nt lds
Mvaa 148,100,76
Ta 56,18,0
Ta 58,18,2048
Mvaa 152,104,76
Mvaa 156,108,76
Ra 24,10,12288
Mvaa 160,112,76
buffer_load_dwordx4 v9, s[12:15], s55 offen offset:3072 nt lds
Mvaa 164,116,76
s_waitcnt lgkmcnt(6)
Ta 60,19,0
Ta 62,19,2048
Mvaa 168,120,76
Mvaa 172,124,76
s_add_u32 m0, s56, 65536
Ra 28,10,14336
Mvaa 176,96,80
buffer_load_dwordx4 v2, s[8:11], s48 offen offset:0 lds
Mvaa 180,100,80
Mvaa 184,104,80
Mvaa 188,108,80
Mvaa 192,112,80
buffer_load_dwordx4 v3, s[8:11], s49 offen offset:1024 lds
Mvaa 196,116,80
Mvaa 200,120,80
Mvaa 204,124,80
Mvaa 208,96,84
buffer_load_dwordx4 v2, s[8:11], s50 offen offset:2048 lds
Mvaa 212,100,84
Mvaa 216,104,84
Mvaa 220,108,84
Mvaa 224,112,84
buffer_load_dwordx4 v3, s[8:11], s51 offen offset:3072 lds
Mvaa 228,116,84
Mvaa 232,120,84
Mvaa 236,124,84
s_add_u32 m0, s56, 69632
Mvaa 240,96,88
buffer_load_dwordx4 v4, s[8:11], s48 offen offset:0 lds
Mvaa 244,100,88
Mvaa 248,104,88
Mvaa 252,108,88
Maaa 128,112,88
buffer_load_dwordx4 v5, s[8:11], s49 offen offset:1024 lds
Maaa 132,116,88
Maaa 136,120,88
Maaa 140,124,88
Maaa 144,96,92
buffer_load_dwordx4 v4, s[8:11], s50 offen offset:2048 lds
Maaa 148,100,92
Maaa 152,104,92
Maaa 156,108,92
Maaa 160,112,92
buffer_load_dwordx4 v5, s[8:11], s51 offen offset:3072 lds
Maaa 164,116,92
Maaa 168,120,92
Maaa 172,124,92
s_waitcnt lgkmcnt(0)
Mvaa 48,32,0
buffer_load_dword v30, v31, s[28:31], s37 offen sc1
Mvaa 52,36,0
Ta 96,12,16384
Ta 98,12,18432
Mvaa 56,40,0
s_mov_b32 s8, s16
s_mov_b32 s9, s17
s_mov_b32 s10, s18
Mvaa 60,44,0
Ra 64,11,0
Mvaa 64,48,0
s_add_u32 s16, s66, 46137344
s_addc_u32 s17, s67, 0
s_and_b32 s17, s17, 0xffff
Mvaa 68,52,0
Ta 100,13,16384
Ta 102,13,18432
Mvaa 72,56,0
s_mov_b32 s18, 16777216
s_mov_b32 s19, 0x20000
s_mov_b32 s48, 0
Mvaa 76,60,0
s_waitcnt lgkmcnt(6)
Ra 68,11,2048
Mvaa 80,32,4
s_mov_b32 s49, 31744
s_mov_b32 s50, 63488
s_mov_b32 s51, 95232
Mvaa 84,36,4
Ta 104,14,16384
Ta 106,14,18432
Mvaa 88,40,4
v_lshlrev_b32_e64 v35, 13, v34
v_lshl_add_u32 v8, v36, 4, v35
Mvaa 92,44,4
Ra 72,11,4096
Mvaa 96,48,4
v_lshl_add_u32 v9, v37, 4, v35
v_lshlrev_b32_e64 v2, 4, v0
Mvaa 100,52,4
Ta 108,15,16384
Ta 110,15,18432
Mvaa 104,56,4
v_add_u32 v3, 65536, v2
v_add_u32_e64 v4, s44, v2
Mvaa 108,60,4
s_waitcnt lgkmcnt(6)
Ra 76,11,6144
Mvaa 112,32,8
v_mov_b32 v7, 0
v_lshlrev_b32_e64 v35, 2, v32
Mvaa 116,36,8
Ta 112,16,16384
Ta 114,16,18432
Mvaa 120,40,8
v_sub_u32_e64 v35, v33, v35
Mvaa 124,44,8
Ra 80,11,8192
Mvaa 128,48,8
s_lshl_b32 s3, s45, 5
v_add_u32 v5, s3, v35
Mvaa 132,52,8
Ta 116,17,16384
Ta 118,17,18432
Mvaa 136,56,8
s_lshl_b32 s3, s46, 5
v_add_u32 v6, s3, v35
Mvaa 140,60,8
s_waitcnt lgkmcnt(6)
Ra 84,11,10240
Mvaa 144,32,12
s_mul_i32 s3, s33, 1116160
s_add_u32 s3, s3, 8388608
s_add_u32 s12, s66, s3
s_addc_u32 s13, s67, 0
s_and_b32 s13, s13, 0xffff
Mvaa 148,36,12
Ta 120,18,16384
Ta 122,18,18432
Mvaa 152,40,12
s_mov_b32 s14, 0
s_mov_b32 s15, 0x20000
s_mul_i32 s14, s36, 34816
Mvaa 156,44,12
Ra 88,11,12288
Mvaa 160,48,12
buffer_load_dword v44, v45, s[8:11], s47 offen
Mvaa 164,52,12
Ta 124,19,16384
Ta 126,19,18432
Mvaa 168,56,12
s_add_u32 s47, s47, 2097152
Mvaa 172,60,12
s_waitcnt lgkmcnt(6)
Ra 92,11,14336
Mvaa 176,32,16
Mvaa 180,36,16
Mvaa 184,40,16
Mvaa 188,44,16
Mvaa 192,48,16
Mvaa 196,52,16
Mvaa 200,56,16
Mvaa 204,60,16
Mvaa 208,32,20
Mvaa 212,36,20
Mvaa 216,40,20
Mvaa 220,44,20
Mvaa 224,48,20
Mvaa 228,52,20
Mvaa 232,56,20
Mvaa 236,60,20
Mvaa 240,32,24
Mvaa 244,36,24
Mvaa 248,40,24
Mvaa 252,44,24
Maaa 128,48,24
Maaa 132,52,24
Maaa 136,56,24
Maaa 140,60,24
Maaa 144,32,28
Maaa 148,36,28
Maaa 152,40,28
Maaa 156,44,28
Maaa 160,48,28
Maaa 164,52,28
Maaa 168,56,28
Maaa 172,60,28
s_waitcnt vmcnt(2) lgkmcnt(0)
s_add_u32 m0, s44, 0
s_barrier
Mvaa 48,96,64
buffer_load_dwordx4 v8, s[8:11], s48 offen offset:0 lds
Mvaa 52,100,64
Ta 32,22,0
Ta 34,22,2048
Mvaa 56,104,64
s_mul_i32 s3, s45, 67584
v_add_u32_e64 v10, s3, v2
Mvaa 60,108,64
Ra 0,20,0
Mvaa 64,112,64
buffer_load_dwordx4 v8, s[8:11], s49 offen offset:1024 lds
Mvaa 68,116,64
s_waitcnt lgkmcnt(6)
Ta 36,23,0
Ta 38,23,2048
Mvaa 72,120,64
s_mul_i32 s3, s46, 67584
v_add_u32 v11, s3, v2
Mvaa 76,124,64
Ra 4,20,2048
Mvaa 80,96,68
buffer_load_dwordx4 v9, s[8:11], s50 offen offset:2048 lds
Mvaa 84,100,68
Ta 40,24,0
Ta 42,24,2048
Mvaa 88,104,68
Mvaa 92,108,68
Ra 8,20,4096
Mvaa 96,112,68
buffer_load_dwordx4 v9, s[8:11], s51 offen offset:3072 lds
Mvaa 100,116,68
s_waitcnt lgkmcnt(6)
Ta 44,25,0
Ta 46,25,2048
Mvaa 104,120,68
v_add_u32 v8, 524288, v8
v_add_u32 v9, 524288, v9
Mvaa 108,124,68
s_add_u32 m0, s44, 16384
Ra 12,20,6144
Mvaa 112,96,72
buffer_load_dwordx4 v8, s[8:11], s48 offen offset:0 lds
Mvaa 116,100,72
Ta 48,26,0
Ta 50,26,2048
Mvaa 120,104,72
Mvaa 124,108,72
Ra 16,20,8192
Mvaa 128,112,72
buffer_load_dwordx4 v8, s[8:11], s49 offen offset:1024 lds
Mvaa 132,116,72
s_waitcnt lgkmcnt(6)
Ta 52,27,0
Ta 54,27,2048
Mvaa 136,120,72
Mvaa 140,124,72
Ra 20,20,10240
Mvaa 144,96,76
buffer_load_dwordx4 v9, s[8:11], s50 offen offset:2048 lds
Mvaa 148,100,76
Ta 56,28,0
Ta 58,28,2048
Mvaa 152,104,76
Mvaa 156,108,76
Ra 24,20,12288
Mvaa 160,112,76
buffer_load_dwordx4 v9, s[8:11], s51 offen offset:3072 lds
Mvaa 164,116,76
s_waitcnt lgkmcnt(6)
Ta 60,29,0
Ta 62,29,2048
Mvaa 168,120,76
v_add_u32 v8, 524288, v8
v_add_u32 v9, 524288, v9
Mvaa 172,124,76
s_add_u32 m0, s44, 32768
Ra 28,20,14336
Mvaa 176,96,80
buffer_load_dwordx4 v8, s[8:11], s48 offen offset:0 lds
Mvaa 180,100,80
Mvaa 184,104,80
Mvaa 188,108,80
Mvaa 192,112,80
buffer_load_dwordx4 v8, s[8:11], s49 offen offset:1024 lds
Mvaa 196,116,80
Mvaa 200,120,80
Mvaa 204,124,80
Mvaa 208,96,84
buffer_load_dwordx4 v9, s[8:11], s50 offen offset:2048 lds
Mvaa 212,100,84
Mvaa 216,104,84
Mvaa 220,108,84
Mvaa 224,112,84
buffer_load_dwordx4 v9, s[8:11], s51 offen offset:3072 lds
Mvaa 228,116,84
v_add_u32 v8, 524288, v8
v_add_u32 v9, 524288, v9
Mvaa 232,120,84
Mvaa 236,124,84
s_add_u32 m0, s44, 49152
Mvaa 240,96,88
buffer_load_dwordx4 v8, s[8:11], s48 offen offset:0 lds
Mvaa 244,100,88
Mvaa 248,104,88
Mvaa 252,108,88
Maaa 128,112,88
buffer_load_dwordx4 v8, s[8:11], s49 offen offset:1024 lds
Maaa 132,116,88
Maaa 136,120,88
Maaa 140,124,88
Maaa 144,96,92
buffer_load_dwordx4 v9, s[8:11], s50 offen offset:2048 lds
Maaa 148,100,92
Maaa 152,104,92
Maaa 156,108,92
Maaa 160,112,92
buffer_load_dwordx4 v9, s[8:11], s51 offen offset:3072 lds
Maaa 164,116,92
v_add_u32 v8, 524288, v8
v_add_u32 v9, 524288, v9
Maaa 168,120,92
Maaa 172,124,92
s_waitcnt lgkmcnt(0)
Mvaa 48,32,0
Mvaa 52,36,0
Ta 96,22,16384
Ta 98,22,18432
Mvaa 56,40,0
Mvaa 60,44,0
Ra 64,21,0
Mvaa 64,48,0
Mvaa 68,52,0
Ta 100,23,16384
Ta 102,23,18432
Mvaa 72,56,0
Mvaa 76,60,0
s_waitcnt lgkmcnt(6)
Ra 68,21,2048
Mvaa 80,32,4
Mvaa 84,36,4
Ta 104,24,16384
Ta 106,24,18432
Mvaa 88,40,4
Mvaa 92,44,4
Ra 72,21,4096
Mvaa 96,48,4
Mvaa 100,52,4
Ta 108,25,16384
Ta 110,25,18432
Mvaa 104,56,4
Mvaa 108,60,4
s_waitcnt lgkmcnt(6)
Ra 76,21,6144
Mvaa 112,32,8
Mvaa 116,36,8
Ta 112,26,16384
Ta 114,26,18432
Mvaa 120,40,8
Mvaa 124,44,8
Ra 80,21,8192
Mvaa 128,48,8
Mvaa 132,52,8
Ta 116,27,16384
Ta 118,27,18432
Mvaa 136,56,8
Mvaa 140,60,8
s_waitcnt lgkmcnt(6)
Ra 84,21,10240
Mvaa 144,32,12
Mvaa 148,36,12
Ta 120,28,16384
Ta 122,28,18432
Mvaa 152,40,12
Mvaa 156,44,12
Ra 88,21,12288
Mvaa 160,48,12
Mvaa 164,52,12
Ta 124,29,16384
Ta 126,29,18432
Mvaa 168,56,12
Mvaa 172,60,12
s_waitcnt lgkmcnt(6)
Ra 92,21,14336
Mvaa 176,32,16
Mvaa 180,36,16
Mvaa 184,40,16
Mvaa 188,44,16
Mvaa 192,48,16
Mvaa 196,52,16
Mvaa 200,56,16
Mvaa 204,60,16
Mvaa 208,32,20
Mvaa 212,36,20
Mvaa 216,40,20
Mvaa 220,44,20
Mvaa 224,48,20
Mvaa 228,52,20
Mvaa 232,56,20
Mvaa 236,60,20
Mvaa 240,32,24
Mvaa 244,36,24
Mvaa 248,40,24
Mvaa 252,44,24
Maaa 128,48,24
Maaa 132,52,24
Maaa 136,56,24
Maaa 140,60,24
Maaa 144,32,28
Maaa 148,36,28
Maaa 152,40,28
Maaa 156,44,28
Maaa 160,48,28
Maaa 164,52,28
Maaa 168,56,28
Maaa 172,60,28
s_waitcnt vmcnt(12) lgkmcnt(0)
v_readfirstlane_b32 s3, v30
s_nop 0
s_or_b32 s3, s3, s37
s_cmp_lt_u32 s3, 256
s_cbranch_scc1 L_spinAk
L_spinArk:
s_barrier
Mvaa 48,96,64
buffer_load_dwordx4 a[0:3], v10, s[20:23], 0 offen offset:0 sc1
Mvaa 52,100,64
v_lshrrev_b32_e64 v42, 2, v33
v_lshl_add_u32 v43, v32, 3, v42
Mvaa 56,104,64
v_lshlrev_b32 v43, 8, v43
v_and_b32 v44, 3, v0
Mvaa 60,108,64
v_lshl_add_u32 v43, v44, 3, v43
v_and_b32_e64 v44, 1, v32
Mvaa 64,112,64
buffer_load_dwordx4 a[4:7], v10, s[20:23], s58 offen offset:0 sc1
Mvaa 68,116,64
v_lshl_add_u32 v42, v44, 2, v42
v_xor_b32_e64 v44, 0, v42
Mvaa 72,120,64
v_lshl_add_u32 v16, v44, 5, v43
v_xor_b32_e64 v44, 1, v42
Mvaa 76,124,64
v_lshl_add_u32 v17, v44, 5, v43
v_xor_b32_e64 v44, 2, v42
Mvaa 80,96,68
buffer_load_dwordx4 a[8:11], v11, s[20:23], 0 offen offset:0 sc1
Mvaa 84,100,68
v_lshl_add_u32 v18, v44, 5, v43
v_xor_b32_e64 v44, 3, v42
Mvaa 88,104,68
v_lshl_add_u32 v19, v44, 5, v43
v_xor_b32_e64 v44, 4, v42
Mvaa 92,108,68
v_lshl_add_u32 v20, v44, 5, v43
v_xor_b32_e64 v44, 5, v42
Mvaa 96,112,68
buffer_load_dwordx4 a[12:15], v11, s[20:23], s58 offen offset:0 sc1
Mvaa 100,116,68
v_lshl_add_u32 v21, v44, 5, v43
v_xor_b32_e64 v44, 6, v42
Mvaa 104,120,68
v_lshl_add_u32 v22, v44, 5, v43
v_xor_b32_e64 v44, 7, v42
Mvaa 108,124,68
v_lshl_add_u32 v23, v44, 5, v43
Mvaa 112,96,72
buffer_load_dwordx4 a[16:19], v10, s[20:23], 0 offen offset:1024 sc1
Mvaa 116,100,72
Mvaa 120,104,72
Mvaa 124,108,72
Mvaa 128,112,72
buffer_load_dwordx4 a[20:23], v10, s[20:23], s58 offen offset:1024 sc1
Mvaa 132,116,72
Ta 192,16,0
Ta 194,16,1024
Mvaa 136,120,72
Ta 196,17,0
Ta 198,17,1024
Mvaa 140,124,72
Ta 200,18,0
Ta 202,18,1024
Mvaa 144,96,76
buffer_load_dwordx4 a[24:27], v11, s[20:23], 0 offen offset:1024 sc1
Mvaa 148,100,76
Ta 204,19,0
Ta 206,19,1024
Mvaa 152,104,76
Ta 208,20,0
Ta 210,20,1024
Mvaa 156,108,76
Ta 212,21,0
Ta 214,21,1024
Mvaa 160,112,76
buffer_load_dwordx4 a[28:31], v11, s[20:23], s58 offen offset:1024 sc1
Mvaa 164,116,76
Ta 216,22,0
Ta 218,22,1024
Mvaa 168,120,76
Ta 220,23,0
s_waitcnt lgkmcnt(9)
Ta 222,23,1024
Mvaa 172,124,76
s_waitcnt lgkmcnt(8)
Vc 24,48,49
Vc 25,50,51
Mvaa 176,96,80
buffer_load_dwordx4 a[32:35], v10, s[20:23], 0 offen offset:2048 sc1
Mvaa 180,100,80
Vc 26,52,53
Vc 27,54,55
Mvaa 184,104,80
Vc 28,56,57
Vc 29,58,59
Mvaa 188,108,80
Vc 30,60,61
Vc 31,62,63
Mvaa 192,112,80
buffer_load_dwordx4 a[36:39], v10, s[20:23], s58 offen offset:2048 sc1
Mvaa 196,116,80
Vc 32,64,65
Vc 33,66,67
Mvaa 200,120,80
Vc 34,68,69
Vc 35,70,71
Mvaa 204,124,80
Vc 36,72,73
Vc 37,74,75
Mvaa 208,96,84
buffer_load_dwordx4 a[40:43], v11, s[20:23], 0 offen offset:2048 sc1
Mvaa 212,100,84
Vc 38,76,77
Vc 39,78,79
Mvaa 216,104,84
Vc 40,80,81
Vc 41,82,83
Mvaa 220,108,84
Vc 42,84,85
Vc 43,86,87
Mvaa 224,112,84
buffer_load_dwordx4 a[44:47], v11, s[20:23], s58 offen offset:2048 sc1
Mvaa 228,116,84
Vc 44,88,89
Vc 45,90,91
Mvaa 232,120,84
Vc 46,92,93
Vc 47,94,95
Mvaa 236,124,84
Vc 48,96,97
Vc 49,98,99
Mvaa 240,96,88
buffer_load_dwordx4 a[48:51], v10, s[20:23], 0 offen offset:3072 sc1
Mvaa 244,100,88
Vc 50,100,101
Vc 51,102,103
Mvaa 248,104,88
Vc 52,104,105
Vc 53,106,107
Mvaa 252,108,88
Vc 54,108,109
Vc 55,110,111
Maaa 128,112,88
buffer_load_dwordx4 a[52:55], v10, s[20:23], s58 offen offset:3072 sc1
Maaa 132,116,88
Vc 56,112,113
Vc 57,114,115
Maaa 136,120,88
Vc 58,116,117
Vc 59,118,119
Maaa 140,124,88
Vc 60,120,121
Vc 61,122,123
Maaa 144,96,92
buffer_load_dwordx4 a[56:59], v11, s[20:23], 0 offen offset:3072 sc1
Maaa 148,100,92
Vc 62,124,125
Vc 63,126,127
Maaa 152,104,92
Vc 64,128,129
Vc 65,130,131
Maaa 156,108,92
Vc 66,132,133
Vc 67,134,135
Maaa 160,112,92
buffer_load_dwordx4 a[60:63], v11, s[20:23], s58 offen offset:3072 sc1
Maaa 164,116,92
v_add_u32 v10, 4096, v10
v_add_u32 v11, 4096, v11
Maaa 168,120,92
Vc 68,136,137
Vc 69,138,139
Maaa 172,124,92
Vc 70,140,141
Vc 71,142,143
Vc 72,144,145
Vc 73,146,147
Vc 74,148,149
Vc 75,150,151
Vc 76,152,153
Vc 77,154,155
Vc 78,156,157
Vc 79,158,159
Vc 80,160,161
Vc 81,162,163
Vc 82,164,165
Vc 83,166,167
Vc 84,168,169
Vc 85,170,171
Vc 86,172,173
Vc 87,174,175
Vc 88,176,177
Vc 89,178,179
Vc 90,180,181
Vc 91,182,183
Vc 92,184,185
Vc 93,186,187
Vc 94,188,189
Vc 95,190,191
Vc 96,192,193
Vc 97,194,195
Vc 98,196,197
Vc 99,198,199
Vc 100,200,201
Vc 101,202,203
Vc 102,204,205
Vc 103,206,207
Vc 104,208,209
Vc 105,210,211
Vc 106,212,213
Vc 107,214,215
Vc 108,216,217
Vc 109,218,219
Vc 110,220,221
Vc 111,222,223
Vc 112,224,225
Vc 113,226,227
Vc 114,228,229
Vc 115,230,231
Vc 116,232,233
Vc 117,234,235
Vc 118,236,237
Vc 119,238,239
Vc 120,240,241
Vc 121,242,243
Vc 122,244,245
Vc 123,246,247
Vc 124,248,249
Vc 125,250,251
Vc 126,252,253
Vc 127,254,255
s_branch L_phase2
L_k1_vpath:
s_waitcnt lgkmcnt(0)
Zvaa 48,0,32
v_and_b32_e64 v46, 7, v0
v_mul_u32_u24 v30, 2064, v46
Zvaa 64,0,36
Ta 96,12,16384
Ta 98,12,18432
Zvaa 80,0,40
v_lshrrev_b32_e64 v31, 3, v0
Zvaa 96,0,44
Ra 64,11,0
Zvaa 112,0,48
s_lshl_b32 s3, s32, 9
s_add_u32 s3, s3, 131072
v_lshl_add_u32 v30, v31, 4, v30
Zvaa 128,0,52
Ta 100,13,16384
Ta 102,13,18432
Zvaa 144,0,56
v_add_u32 v30, s3, v30
v_lshlrev_b32_e64 v31, 8, v31
Zvaa 160,0,60
s_waitcnt lgkmcnt(6)
Ra 68,11,2048
Zvaa 52,4,32
v_lshl_add_u32 v46, v46, 4, v31
Zvaa 68,4,36
Ta 104,14,16384
Ta 106,14,18432
Zvaa 84,4,40
Rv 34,30,128
Rv 38,30,256
Zvaa 100,4,44
Ra 72,11,4096
Zvaa 116,4,48
Rv 42,30,384
Rv 30,30,0
Zvaa 132,4,52
Ta 108,15,16384
Ta 110,15,18432
Zvaa 148,4,56
s_lshr_b32 s3, s2, 1
s_mul_i32 s3, s3, 33792
s_add_u32 s3, s3, s56
Zvaa 164,4,60
s_waitcnt lgkmcnt(6)
Ra 76,11,6144
Zvaa 56,8,32
s_and_b32 s39, s2, 1
s_lshl_b32 s39, s39, 7
s_add_u32 s3, s3, s39
Zvaa 72,8,36
Ta 112,16,16384
Ta 114,16,18432
Zvaa 88,8,40
s_add_u32 s39, s3, 4096
Zvaa 104,8,44
Ra 80,11,8192
Zvaa 120,8,48
Zvaa 136,8,52
Ta 116,17,16384
Ta 118,17,18432
Zvaa 152,8,56
Zvaa 168,8,60
s_waitcnt lgkmcnt(6)
Ra 84,11,10240
Zvaa 60,12,32
Zvaa 76,12,36
Ta 120,18,16384
Ta 122,18,18432
Zvaa 92,12,40
Zvaa 108,12,44
Ra 88,11,12288
Zvaa 124,12,48
Zvaa 140,12,52
Ta 124,19,16384
Ta 126,19,18432
Zvaa 156,12,56
Zvaa 172,12,60
s_waitcnt lgkmcnt(6)
Ra 92,11,14336
Zvaa 176,16,32
Zvaa 192,16,36
Zvaa 208,16,40
Zvaa 224,16,44
Zvaa 240,16,48
Zaaa 128,16,52
Zaaa 144,16,56
Zaaa 160,16,60
Zvaa 180,20,32
Zvaa 196,20,36
Zvaa 212,20,40
Zvaa 228,20,44
Zvaa 244,20,48
Zaaa 132,20,52
Zaaa 148,20,56
Zaaa 164,20,60
Zvaa 184,24,32
Zvaa 200,24,36
Zvaa 216,24,40
Zvaa 232,24,44
Zvaa 248,24,48
Zaaa 136,24,52
Zaaa 152,24,56
Zaaa 168,24,60
Zvaa 188,28,32
Zvaa 204,28,36
Zvaa 220,28,40
Zvaa 236,28,44
Zvaa 252,28,48
Zaaa 140,28,52
Zaaa 156,28,56
Zaaa 172,28,60
s_waitcnt vmcnt(5) lgkmcnt(0)
s_add_u32 m0, s57, 0
s_barrier
Mvaa 48,64,96
buffer_load_dwordx4 v6, s[12:15], s52 offen offset:0 nt lds
Mvaa 64,64,100
Ta 32,22,0
Ta 34,22,2048
Mvaa 80,64,104
Mvaa 96,64,108
Ra 0,20,0
Mvaa 112,64,112
buffer_load_dwordx4 v7, s[12:15], s53 offen offset:1024 nt lds
Mvaa 128,64,116
s_waitcnt lgkmcnt(6)
Ta 36,23,0
Ta 38,23,2048
Mvaa 144,64,120
Mvaa 160,64,124
Ra 4,20,2048
Mvaa 52,68,96
buffer_load_dwordx4 v6, s[12:15], s54 offen offset:2048 nt lds
Mvaa 68,68,100
Ta 40,24,0
Ta 42,24,2048
Mvaa 84,68,104
Mvaa 100,68,108
Ra 8,20,4096
Mvaa 116,68,112
buffer_load_dwordx4 v7, s[12:15], s55 offen offset:3072 nt lds
Mvaa 132,68,116
s_waitcnt lgkmcnt(6)
Ta 44,25,0
Ta 46,25,2048
Mvaa 148,68,120
Mvaa 164,68,124
s_add_u32 m0, s57, 4096
Ra 12,20,6144
Mvaa 56,72,96
buffer_load_dwordx4 v8, s[12:15], s52 offen offset:0 nt lds
Mvaa 72,72,100
Ta 48,26,0
Ta 50,26,2048
Mvaa 88,72,104
Mvaa 104,72,108
Ra 16,20,8192
Mvaa 120,72,112
buffer_load_dwordx4 v9, s[12:15], s53 offen offset:1024 nt lds
Mvaa 136,72,116
s_waitcnt lgkmcnt(6)
Ta 52,27,0
Ta 54,27,2048
Mvaa 152,72,120
Mvaa 168,72,124
Ra 20,20,10240
Mvaa 60,76,96
buffer_load_dwordx4 v8, s[12:15], s54 offen offset:2048 nt lds
Mvaa 76,76,100
Ta 56,28,0
Ta 58,28,2048
Mvaa 92,76,104
Mvaa 108,76,108
Ra 24,20,12288
Mvaa 124,76,112
buffer_load_dwordx4 v9, s[12:15], s55 offen offset:3072 nt lds
Mvaa 140,76,116
s_waitcnt lgkmcnt(6)
Ta 60,29,0
Ta 62,29,2048
Mvaa 156,76,120
v_xor_b32 v6, 524288, v6
v_xor_b32 v7, 524288, v7
Mvaa 172,76,124
s_add_u32 m0, s56, 0
Ra 28,20,14336
v_xor_b32 v8, 524288, v8
Mvaa 176,80,96
buffer_load_dwordx4 v2, s[8:11], s48 offen offset:0 lds
Mvaa 192,80,100
v_xor_b32 v9, 524288, v9
Mvaa 208,80,104
Mvaa 224,80,108
Mvaa 240,80,112
buffer_load_dwordx4 v3, s[8:11], s49 offen offset:1024 lds
Maaa 128,80,116
Maaa 144,80,120
Maaa 160,80,124
Mvaa 180,84,96
buffer_load_dwordx4 v2, s[8:11], s50 offen offset:2048 lds
Mvaa 196,84,100
Mvaa 212,84,104
Mvaa 228,84,108
Mvaa 244,84,112
buffer_load_dwordx4 v3, s[8:11], s51 offen offset:3072 lds
Maaa 132,84,116
Maaa 148,84,120
Maaa 164,84,124
s_add_u32 m0, s56, 4096
Mvaa 184,88,96
buffer_load_dwordx4 v4, s[8:11], s48 offen offset:0 lds
Mvaa 200,88,100
Mvaa 216,88,104
Mvaa 232,88,108
Mvaa 248,88,112
buffer_load_dwordx4 v5, s[8:11], s49 offen offset:1024 lds
Maaa 136,88,116
Maaa 152,88,120
Maaa 168,88,124
Mvaa 188,92,96
buffer_load_dwordx4 v4, s[8:11], s50 offen offset:2048 lds
Mvaa 204,92,100
Mvaa 220,92,104
Mvaa 236,92,108
Mvaa 252,92,112
buffer_load_dwordx4 v5, s[8:11], s51 offen offset:3072 lds
Maaa 140,92,116
v_xor_b32 v2, 128, v2
v_xor_b32 v3, 128, v3
Maaa 156,92,120
buffer_load_dword v1, v47, s[60:63], 0 offen
v_xor_b32 v4, 128, v4
v_xor_b32 v5, 128, v5
Maaa 172,92,124
s_mul_i32 vcc_lo, s59, 3
v_xor_b32 v47, vcc_lo, v47
s_waitcnt lgkmcnt(0)
Mvaa 48,0,32
buffer_store_dwordx4 v[30:33], v46, s[20:23], s3 offen offset:0 sc1
Mvaa 64,0,36
Ta 96,22,16384
Ta 98,22,18432
Mvaa 80,0,40
buffer_store_dwordx4 v[34:37], v46, s[20:23], s3 offen offset:2048 sc1
Mvaa 96,0,44
Ra 64,21,0
Mvaa 112,0,48
buffer_store_dwordx4 v[38:41], v46, s[20:23], s39 offen offset:0 sc1
Mvaa 128,0,52
Ta 100,23,16384
Ta 102,23,18432
Mvaa 144,0,56
buffer_store_dwordx4 v[42:45], v46, s[20:23], s39 offen offset:2048 sc1
Mvaa 160,0,60
s_waitcnt lgkmcnt(6)
Ra 68,21,2048
Mvaa 52,4,32
s_lshl_b32 s3, s34, 1
s_and_b32 s36, s32, 1
s_add_u32 s3, s3, s36
Mvaa 68,4,36
Ta 104,24,16384
Ta 106,24,18432
Mvaa 84,4,40
s_mul_i32 s3, s3, 1116160
s_mul_i32 s36, s33, 139264
s_add_u32 s3, s3, s36
Mvaa 100,4,44
Ra 72,21,4096
Mvaa 116,4,48
s_lshr_b32 s36, s32, 1
s_mul_i32 s36, s36, 69632
s_add_u32 s3, s3, s36
Mvaa 132,4,52
Ta 108,25,16384
Ta 110,25,18432
Mvaa 148,4,56
s_add_u32 s38, s3, 17408
s_lshl_b32 s39, s34, 7
s_lshl_b32 s36, s33, 2
Mvaa 164,4,60
s_waitcnt lgkmcnt(6)
Ra 76,21,6144
Mvaa 56,8,32
s_add_u32 s39, s39, s36
s_add_u32 s39, s39, 5296160
v_mov_b32 v30, 1
Mvaa 72,8,36
Ta 112,26,16384
Ta 114,26,18432
Mvaa 88,8,40
v_mov_b32_e64 v31, 0
Mvaa 104,8,44
Ra 80,21,8192
Mvaa 120,8,48
s_cmp_eq_u32 s32, 0
s_cselect_b32 s39, s39, 2146435072
Mvaa 136,8,52
Ta 116,27,16384
Ta 118,27,18432
Mvaa 152,8,56
s_mov_b64 exec, 1
buffer_store_dword v31, v31, s[20:23], s39 offen sc1
s_mov_b64 exec, -1
Mvaa 168,8,60
s_waitcnt lgkmcnt(6)
Ra 84,21,10240
Mvaa 60,12,32
s_and_b32 s33, s2, 7
s_lshl_b32 s33, s33, 2
s_bfe_u32 s3, s2, 0x20003
Mvaa 76,12,36
Ta 120,28,16384
Ta 122,28,18432
Mvaa 92,12,40
s_add_u32 s33, s33, s3
s_lshr_b32 s34, s2, 5
s_lshl_b32 s64, s34, 7
Mvaa 108,12,44
Ra 88,21,12288
Mvaa 124,12,48
s_lshl_b32 s3, s33, 2
s_add_u32 s64, s64, s3
s_add_u32 s64, s64, 5300224
Mvaa 140,12,52
Ta 124,29,16384
Ta 126,29,18432
Mvaa 156,12,56
s_lshl_b32 s65, s34, 8
s_sub_u32 s65, 1920, s65
v_mul_u32_u24_e64 v32, s65, v0
Mvaa 172,12,60
s_waitcnt lgkmcnt(6)
Ra 92,21,14336
Mvaa 176,16,32
s_cmp_eq_u32 s32, 0
s_cselect_b32 s64, s64, 2146435072
Mvaa 192,16,36
s_mov_b64 exec, 3
buffer_store_dword v31, v32, s[20:23], s64 offen sc1
s_mov_b64 exec, -1
Mvaa 208,16,40
s_lshl_b32 s3, s2, 2
s_add_u32 s3, s3, 5302272
v_lshlrev_b32 v32, 10, v0
Mvaa 224,16,44
s_cmp_eq_u32 s32, 0
s_cselect_b32 s3, s3, 2146435072
Mvaa 240,16,48
s_mov_b64 exec, 31
buffer_store_dword v31, v32, s[20:23], s3 offen sc1
s_mov_b64 exec, -1
Maaa 128,16,52
s_lshl_b32 s35, s34, 1
s_sub_u32 s36, 32, s35
s_add_u32 s35, s35, 2
Maaa 144,16,56
s_lshl_b32 s44, s32, 12
s_mov_b32 s58, 33792
s_sub_u32 s3, 15, s34
Maaa 160,16,60
s_lshl_b32 s45, s3, 2
s_add_u32 s45, s45, s32
s_lshl_b32 s46, s34, 2
Mvaa 180,20,32
s_add_u32 s46, s46, s32
s_mov_b32 s68, s42
s_and_b32 s69, s43, 0xffff
Mvaa 196,20,36
s_mov_b32 s70, 7340032
s_mov_b32 s71, 0x20000
s_cmp_eq_u32 s32, 0
s_cselect_b32 s37, 0, 2146435072
Mvaa 212,20,40
s_lshl_b32 s3, s33, 8
s_add_u32 s16, s4, s3
s_addc_u32 s17, s5, 0
s_and_b32 s17, s17, 0xffff
Mvaa 228,20,44
s_mov_b32 s18, 0
s_mov_b32 s19, 0x20000
s_sub_u32 s18, 8388608, s3
Mvaa 244,20,48
v_and_b32 v33, 15, v0
v_lshrrev_b32 v32, 1, v33
Maaa 132,20,52
v_and_b32 v33, 1, v0
v_lshlrev_b32 v32, 13, v32
Maaa 148,20,56
v_lshl_add_u32 v45, v33, 7, v32
Maaa 164,20,60
s_lshl_b32 s3, s32, 3
s_add_u32 s3, s3, s34
s_mul_i32 s47, s3, 65536
Mvaa 184,24,32
s_bfe_u32 s6, s2, 131075
s_lshl_b32 s3, s32, 8
s_or_b32 s6, s6, s3
Mvaa 200,24,36
Mvaa 216,24,40
Mvaa 232,24,44
Mvaa 248,24,48
Maaa 136,24,52
Maaa 152,24,56
Maaa 168,24,60
Mvaa 188,28,32
Mvaa 204,28,36
Mvaa 220,28,40
Mvaa 236,28,44
Mvaa 252,28,48
Maaa 140,28,52
Maaa 156,28,56
Maaa 172,28,60
s_waitcnt vmcnt(8) lgkmcnt(0)
s_add_u32 m0, s57, 65536
s_barrier
Mvaa 48,64,96
buffer_load_dwordx4 v6, s[12:15], s52 offen offset:0 nt lds
Mvaa 64,64,100
Ta 32,12,0
Ta 34,12,2048
Mvaa 80,64,104
Mvaa 96,64,108
Ra 0,10,0
Mvaa 112,64,112
buffer_load_dwordx4 v7, s[12:15], s53 offen offset:1024 nt lds
Mvaa 128,64,116
s_waitcnt lgkmcnt(6)
Ta 36,13,0
Ta 38,13,2048
Mvaa 144,64,120
Mvaa 160,64,124
Ra 4,10,2048
Mvaa 52,68,96
buffer_load_dwordx4 v6, s[12:15], s54 offen offset:2048 nt lds
Mvaa 68,68,100
Ta 40,14,0
Ta 42,14,2048
Mvaa 84,68,104
Mvaa 100,68,108
Ra 8,10,4096
Mvaa 116,68,112
buffer_load_dwordx4 v7, s[12:15], s55 offen offset:3072 nt lds
Mvaa 132,68,116
s_waitcnt lgkmcnt(6)
Ta 44,15,0
Ta 46,15,2048
Mvaa 148,68,120
Mvaa 164,68,124
s_add_u32 m0, s57, 69632
Ra 12,10,6144
Mvaa 56,72,96
buffer_load_dwordx4 v8, s[12:15], s52 offen offset:0 nt lds
Mvaa 72,72,100
Ta 48,16,0
Ta 50,16,2048
Mvaa 88,72,104
Mvaa 104,72,108
Ra 16,10,8192
Mvaa 120,72,112
buffer_load_dwordx4 v9, s[12:15], s53 offen offset:1024 nt lds
Mvaa 136,72,116
s_waitcnt lgkmcnt(6)
Ta 52,17,0
Ta 54,17,2048
Mvaa 152,72,120
Mvaa 168,72,124
Ra 20,10,10240
Mvaa 60,76,96
buffer_load_dwordx4 v8, s[12:15], s54 offen offset:2048 nt lds
Mvaa 76,76,100
Ta 56,18,0
Ta 58,18,2048
Mvaa 92,76,104
Mvaa 108,76,108
Ra 24,10,12288
Mvaa 124,76,112
buffer_load_dwordx4 v9, s[12:15], s55 offen offset:3072 nt lds
Mvaa 140,76,116
s_waitcnt lgkmcnt(6)
Ta 60,19,0
Ta 62,19,2048
Mvaa 156,76,120
v_xor_b32 v6, 3670016, v6
v_xor_b32 v7, 3670016, v7
Mvaa 172,76,124
s_add_u32 m0, s56, 65536
Ra 28,10,14336
v_xor_b32 v8, 3670016, v8
Mvaa 176,80,96
buffer_load_dwordx4 v2, s[8:11], s48 offen offset:0 lds
Mvaa 192,80,100
v_xor_b32 v9, 3670016, v9
Mvaa 208,80,104
Mvaa 224,80,108
Mvaa 240,80,112
buffer_load_dwordx4 v3, s[8:11], s49 offen offset:1024 lds
Maaa 128,80,116
Maaa 144,80,120
Maaa 160,80,124
Mvaa 180,84,96
buffer_load_dwordx4 v2, s[8:11], s50 offen offset:2048 lds
Mvaa 196,84,100
Mvaa 212,84,104
Mvaa 228,84,108
Mvaa 244,84,112
buffer_load_dwordx4 v3, s[8:11], s51 offen offset:3072 lds
Maaa 132,84,116
Maaa 148,84,120
Maaa 164,84,124
s_add_u32 m0, s56, 69632
Mvaa 184,88,96
buffer_load_dwordx4 v4, s[8:11], s48 offen offset:0 lds
Mvaa 200,88,100
Mvaa 216,88,104
Mvaa 232,88,108
Mvaa 248,88,112
buffer_load_dwordx4 v5, s[8:11], s49 offen offset:1024 lds
Maaa 136,88,116
Maaa 152,88,120
Maaa 168,88,124
Mvaa 188,92,96
buffer_load_dwordx4 v4, s[8:11], s50 offen offset:2048 lds
Mvaa 204,92,100
Mvaa 220,92,104
Mvaa 236,92,108
Mvaa 252,92,112
buffer_load_dwordx4 v5, s[8:11], s51 offen offset:3072 lds
Maaa 140,92,116
v_xor_b32 v2, 896, v2
v_xor_b32 v3, 896, v3
Maaa 156,92,120
buffer_load_dword v1, v47, s[60:63], 0 offen
v_xor_b32 v4, 896, v4
v_xor_b32 v5, 896, v5
Maaa 172,92,124
s_mul_i32 vcc_lo, s59, 1
v_xor_b32 v47, vcc_lo, v47
s_waitcnt lgkmcnt(0)
Mvaa 48,0,32
Mvaa 64,0,36
Ta 96,12,16384
Ta 98,12,18432
Mvaa 80,0,40
Mvaa 96,0,44
Ra 64,11,0
Mvaa 112,0,48
Mvaa 128,0,52
Ta 100,13,16384
Ta 102,13,18432
Mvaa 144,0,56
Mvaa 160,0,60
s_waitcnt lgkmcnt(6)
Ra 68,11,2048
Mvaa 52,4,32
Mvaa 68,4,36
Ta 104,14,16384
Ta 106,14,18432
Mvaa 84,4,40
Mvaa 100,4,44
Ra 72,11,4096
Mvaa 116,4,48
Mvaa 132,4,52
Ta 108,15,16384
Ta 110,15,18432
Mvaa 148,4,56
Mvaa 164,4,60
s_waitcnt lgkmcnt(6)
Ra 76,11,6144
Mvaa 56,8,32
Mvaa 72,8,36
Ta 112,16,16384
Ta 114,16,18432
Mvaa 88,8,40
Mvaa 104,8,44
Ra 80,11,8192
Mvaa 120,8,48
Mvaa 136,8,52
Ta 116,17,16384
Ta 118,17,18432
Mvaa 152,8,56
Mvaa 168,8,60
s_waitcnt lgkmcnt(6)
Ra 84,11,10240
Mvaa 60,12,32
Mvaa 76,12,36
Ta 120,18,16384
Ta 122,18,18432
Mvaa 92,12,40
Mvaa 108,12,44
Ra 88,11,12288
Mvaa 124,12,48
Mvaa 140,12,52
Ta 124,19,16384
Ta 126,19,18432
Mvaa 156,12,56
Mvaa 172,12,60
s_waitcnt lgkmcnt(6)
Ra 92,11,14336
Mvaa 176,16,32
Mvaa 192,16,36
Mvaa 208,16,40
Mvaa 224,16,44
Mvaa 240,16,48
Maaa 128,16,52
Maaa 144,16,56
Maaa 160,16,60
Mvaa 180,20,32
Mvaa 196,20,36
Mvaa 212,20,40
Mvaa 228,20,44
Mvaa 244,20,48
Maaa 132,20,52
Maaa 148,20,56
Maaa 164,20,60
Mvaa 184,24,32
Mvaa 200,24,36
Mvaa 216,24,40
Mvaa 232,24,44
Mvaa 248,24,48
Maaa 136,24,52
Maaa 152,24,56
Maaa 168,24,60
Mvaa 188,28,32
Mvaa 204,28,36
Mvaa 220,28,40
Mvaa 236,28,44
Mvaa 252,28,48
Maaa 140,28,52
Maaa 156,28,56
Maaa 172,28,60
s_waitcnt vmcnt(1) lgkmcnt(0)
s_add_u32 m0, s57, 0
s_barrier
Mvaa 48,64,96
buffer_load_dwordx4 v6, s[12:15], s52 offen offset:0 nt lds
Mvaa 64,64,100
Ta 32,22,0
Ta 34,22,2048
Mvaa 80,64,104
Mvaa 96,64,108
Ra 0,20,0
Mvaa 112,64,112
buffer_load_dwordx4 v7, s[12:15], s53 offen offset:1024 nt lds
Mvaa 128,64,116
s_waitcnt lgkmcnt(6)
Ta 36,23,0
Ta 38,23,2048
Mvaa 144,64,120
Mvaa 160,64,124
Ra 4,20,2048
Mvaa 52,68,96
buffer_load_dwordx4 v6, s[12:15], s54 offen offset:2048 nt lds
Mvaa 68,68,100
Ta 40,24,0
Ta 42,24,2048
Mvaa 84,68,104
Mvaa 100,68,108
Ra 8,20,4096
Mvaa 116,68,112
buffer_load_dwordx4 v7, s[12:15], s55 offen offset:3072 nt lds
Mvaa 132,68,116
s_waitcnt lgkmcnt(6)
Ta 44,25,0
Ta 46,25,2048
Mvaa 148,68,120
s_cmp_eq_u32 s6, 0
s_cselect_b32 s3, 0, 2146435072
Mvaa 164,68,124
s_add_u32 m0, s57, 4096
Ra 12,20,6144
Mvaa 56,72,96
buffer_load_dwordx4 v8, s[12:15], s52 offen offset:0 nt lds
Mvaa 72,72,100
Ta 48,26,0
Ta 50,26,2048
Mvaa 88,72,104
s_mov_b64 exec, 1
buffer_atomic_add v30, v31, s[28:31], s3 offen sc1
s_mov_b64 exec, -1
Mvaa 104,72,108
Ra 16,20,8192
Mvaa 120,72,112
buffer_load_dwordx4 v9, s[12:15], s53 offen offset:1024 nt lds
Mvaa 136,72,116
s_waitcnt lgkmcnt(6)
Ta 52,27,0
Ta 54,27,2048
Mvaa 152,72,120
Mvaa 168,72,124
Ra 20,20,10240
Mvaa 60,76,96
buffer_load_dwordx4 v8, s[12:15], s54 offen offset:2048 nt lds
Mvaa 76,76,100
Ta 56,28,0
Ta 58,28,2048
Mvaa 92,76,104
Mvaa 108,76,108
Ra 24,20,12288
Mvaa 124,76,112
buffer_load_dwordx4 v9, s[12:15], s55 offen offset:3072 nt lds
Mvaa 140,76,116
s_waitcnt lgkmcnt(6)
Ta 60,29,0
Ta 62,29,2048
Mvaa 156,76,120
v_xor_b32 v6, 524288, v6
v_xor_b32 v7, 524288, v7
Mvaa 172,76,124
s_add_u32 m0, s56, 0
Ra 28,20,14336
v_xor_b32 v8, 524288, v8
Mvaa 176,80,96
buffer_load_dwordx4 v2, s[8:11], s48 offen offset:0 lds
Mvaa 192,80,100
v_xor_b32 v9, 524288, v9
Mvaa 208,80,104
Mvaa 224,80,108
Mvaa 240,80,112
buffer_load_dwordx4 v3, s[8:11], s49 offen offset:1024 lds
Maaa 128,80,116
Maaa 144,80,120
Maaa 160,80,124
Mvaa 180,84,96
buffer_load_dwordx4 v2, s[8:11], s50 offen offset:2048 lds
Mvaa 196,84,100
Mvaa 212,84,104
Mvaa 228,84,108
Mvaa 244,84,112
buffer_load_dwordx4 v3, s[8:11], s51 offen offset:3072 lds
Maaa 132,84,116
Maaa 148,84,120
Maaa 164,84,124
s_add_u32 m0, s56, 4096
Mvaa 184,88,96
buffer_load_dwordx4 v4, s[8:11], s48 offen offset:0 lds
Mvaa 200,88,100
Mvaa 216,88,104
Mvaa 232,88,108
Mvaa 248,88,112
buffer_load_dwordx4 v5, s[8:11], s49 offen offset:1024 lds
Maaa 136,88,116
Maaa 152,88,120
Maaa 168,88,124
Mvaa 188,92,96
buffer_load_dwordx4 v4, s[8:11], s50 offen offset:2048 lds
Mvaa 204,92,100
Mvaa 220,92,104
Mvaa 236,92,108
Mvaa 252,92,112
buffer_load_dwordx4 v5, s[8:11], s51 offen offset:3072 lds
Maaa 140,92,116
v_xor_b32 v2, 128, v2
v_xor_b32 v3, 128, v3
Maaa 156,92,120
buffer_load_dword v1, v47, s[60:63], 0 offen
v_xor_b32 v4, 128, v4
v_xor_b32 v5, 128, v5
Maaa 172,92,124
s_mul_i32 vcc_lo, s59, 7
v_xor_b32 v47, vcc_lo, v47
s_waitcnt lgkmcnt(0)
Mvaa 48,0,32
buffer_load_dword v44, v45, s[16:19], s47 offen
Mvaa 64,0,36
Ta 96,22,16384
Ta 98,22,18432
Mvaa 80,0,40
s_add_u32 s47, s47, 2097152
Mvaa 96,0,44
Ra 64,21,0
Mvaa 112,0,48
Mvaa 128,0,52
Ta 100,23,16384
Ta 102,23,18432
Mvaa 144,0,56
Mvaa 160,0,60
s_waitcnt lgkmcnt(6)
Ra 68,21,2048
Mvaa 52,4,32
Mvaa 68,4,36
Ta 104,24,16384
Ta 106,24,18432
Mvaa 84,4,40
Mvaa 100,4,44
Ra 72,21,4096
Mvaa 116,4,48
Mvaa 132,4,52
Ta 108,25,16384
Ta 110,25,18432
Mvaa 148,4,56
Mvaa 164,4,60
s_waitcnt lgkmcnt(6)
Ra 76,21,6144
Mvaa 56,8,32
Mvaa 72,8,36
Ta 112,26,16384
Ta 114,26,18432
Mvaa 88,8,40
Mvaa 104,8,44
Ra 80,21,8192
Mvaa 120,8,48
Mvaa 136,8,52
Ta 116,27,16384
Ta 118,27,18432
Mvaa 152,8,56
Mvaa 168,8,60
s_waitcnt lgkmcnt(6)
Ra 84,21,10240
Mvaa 60,12,32
Mvaa 76,12,36
Ta 120,28,16384
Ta 122,28,18432
Mvaa 92,12,40
s_cmp_eq_u32 s6, 1
s_cselect_b32 s3, 0, 2146435072
Mvaa 108,12,44
Ra 88,21,12288
Mvaa 124,12,48
s_mov_b64 exec, 1
buffer_atomic_add v30, v31, s[28:31], s3 offen sc1
s_mov_b64 exec, -1
Mvaa 140,12,52
Ta 124,29,16384
Ta 126,29,18432
Mvaa 156,12,56
Mvaa 172,12,60
s_waitcnt lgkmcnt(6)
Ra 92,21,14336
Mvaa 176,16,32
Mvaa 192,16,36
Mvaa 208,16,40
Mvaa 224,16,44
Mvaa 240,16,48
Maaa 128,16,52
Maaa 144,16,56
Maaa 160,16,60
Mvaa 180,20,32
Mvaa 196,20,36
Mvaa 212,20,40
Mvaa 228,20,44
Mvaa 244,20,48
Maaa 132,20,52
Maaa 148,20,56
Maaa 164,20,60
Mvaa 184,24,32
Mvaa 200,24,36
Mvaa 216,24,40
Mvaa 232,24,44
Mvaa 248,24,48
Maaa 136,24,52
Maaa 152,24,56
Maaa 168,24,60
Mvaa 188,28,32
Mvaa 204,28,36
Mvaa 220,28,40
Mvaa 236,28,44
Mvaa 252,28,48
Maaa 140,28,52
Maaa 156,28,56
Maaa 172,28,60
s_waitcnt vmcnt(3) lgkmcnt(0)
s_add_u32 m0, s57, 65536
s_barrier
Mvaa 48,64,96
buffer_load_dwordx4 v6, s[12:15], s52 offen offset:0 nt lds
Mvaa 64,64,100
Ta 32,12,0
Ta 34,12,2048
Mvaa 80,64,104
Mvaa 96,64,108
Ra 0,10,0
Mvaa 112,64,112
buffer_load_dwordx4 v7, s[12:15], s53 offen offset:1024 nt lds
Mvaa 128,64,116
s_waitcnt lgkmcnt(6)
Ta 36,13,0
Ta 38,13,2048
Mvaa 144,64,120
Mvaa 160,64,124
Ra 4,10,2048
Mvaa 52,68,96
buffer_load_dwordx4 v6, s[12:15], s54 offen offset:2048 nt lds
Mvaa 68,68,100
Ta 40,14,0
Ta 42,14,2048
Mvaa 84,68,104
Mvaa 100,68,108
Ra 8,10,4096
Mvaa 116,68,112
buffer_load_dwordx4 v7, s[12:15], s55 offen offset:3072 nt lds
Mvaa 132,68,116
s_waitcnt lgkmcnt(6)
Ta 44,15,0
Ta 46,15,2048
Mvaa 148,68,120
Mvaa 164,68,124
s_add_u32 m0, s57, 69632
Ra 12,10,6144
Mvaa 56,72,96
buffer_load_dwordx4 v8, s[12:15], s52 offen offset:0 nt lds
Mvaa 72,72,100
Ta 48,16,0
Ta 50,16,2048
Mvaa 88,72,104
Mvaa 104,72,108
Ra 16,10,8192
Mvaa 120,72,112
buffer_load_dwordx4 v9, s[12:15], s53 offen offset:1024 nt lds
Mvaa 136,72,116
s_waitcnt lgkmcnt(6)
Ta 52,17,0
Ta 54,17,2048
Mvaa 152,72,120
Mvaa 168,72,124
Ra 20,10,10240
Mvaa 60,76,96
buffer_load_dwordx4 v8, s[12:15], s54 offen offset:2048 nt lds
Mvaa 76,76,100
Ta 56,18,0
Ta 58,18,2048
Mvaa 92,76,104
Mvaa 108,76,108
Ra 24,10,12288
Mvaa 124,76,112
buffer_load_dwordx4 v9, s[12:15], s55 offen offset:3072 nt lds
Mvaa 140,76,116
s_waitcnt lgkmcnt(6)
Ta 60,19,0
Ta 62,19,2048
Mvaa 156,76,120
v_xor_b32 v6, 1572864, v6
v_xor_b32 v7, 1572864, v7
Mvaa 172,76,124
s_add_u32 m0, s56, 65536
Ra 28,10,14336
v_xor_b32 v8, 1572864, v8
Mvaa 176,80,96
buffer_load_dwordx4 v2, s[8:11], s48 offen offset:0 lds
Mvaa 192,80,100
v_xor_b32 v9, 1572864, v9
Mvaa 208,80,104
Mvaa 224,80,108
Mvaa 240,80,112
buffer_load_dwordx4 v3, s[8:11], s49 offen offset:1024 lds
Maaa 128,80,116
Maaa 144,80,120
Maaa 160,80,124
s_cmp_eq_u32 s6, 2
s_cselect_b32 s3, 0, 2146435072
Mvaa 180,84,96
buffer_load_dwordx4 v2, s[8:11], s50 offen offset:2048 lds
Mvaa 196,84,100
s_mov_b64 exec, 1
buffer_atomic_add v30, v31, s[28:31], s3 offen sc1
s_mov_b64 exec, -1
Mvaa 212,84,104
Mvaa 228,84,108
Mvaa 244,84,112
buffer_load_dwordx4 v3, s[8:11], s51 offen offset:3072 lds
Maaa 132,84,116
Maaa 148,84,120
Maaa 164,84,124
s_add_u32 m0, s56, 69632
Mvaa 184,88,96
buffer_load_dwordx4 v4, s[8:11], s48 offen offset:0 lds
Mvaa 200,88,100
Mvaa 216,88,104
Mvaa 232,88,108
Mvaa 248,88,112
buffer_load_dwordx4 v5, s[8:11], s49 offen offset:1024 lds
Maaa 136,88,116
Maaa 152,88,120
Maaa 168,88,124
Mvaa 188,92,96
buffer_load_dwordx4 v4, s[8:11], s50 offen offset:2048 lds
Mvaa 204,92,100
Mvaa 220,92,104
Mvaa 236,92,108
Mvaa 252,92,112
buffer_load_dwordx4 v5, s[8:11], s51 offen offset:3072 lds
Maaa 140,92,116
v_xor_b32 v2, 384, v2
v_xor_b32 v3, 384, v3
Maaa 156,92,120
v_xor_b32 v4, 384, v4
v_xor_b32 v5, 384, v5
Maaa 172,92,124
s_waitcnt lgkmcnt(0)
Mvaa 48,0,32
buffer_load_dword v44, v45, s[16:19], s47 offen
Mvaa 64,0,36
Ta 96,12,16384
Ta 98,12,18432
Mvaa 80,0,40
s_add_u32 s47, s47, 2097152
Mvaa 96,0,44
Ra 64,11,0
Mvaa 112,0,48
Mvaa 128,0,52
Ta 100,13,16384
Ta 102,13,18432
Mvaa 144,0,56
Mvaa 160,0,60
s_waitcnt lgkmcnt(6)
Ra 68,11,2048
Mvaa 52,4,32
Mvaa 68,4,36
Ta 104,14,16384
Ta 106,14,18432
Mvaa 84,4,40
Mvaa 100,4,44
Ra 72,11,4096
Mvaa 116,4,48
Mvaa 132,4,52
Ta 108,15,16384
Ta 110,15,18432
Mvaa 148,4,56
Mvaa 164,4,60
s_waitcnt lgkmcnt(6)
Ra 76,11,6144
Mvaa 56,8,32
Mvaa 72,8,36
Ta 112,16,16384
Ta 114,16,18432
Mvaa 88,8,40
Mvaa 104,8,44
Ra 80,11,8192
Mvaa 120,8,48
Mvaa 136,8,52
Ta 116,17,16384
Ta 118,17,18432
Mvaa 152,8,56
Mvaa 168,8,60
s_waitcnt lgkmcnt(6)
Ra 84,11,10240
Mvaa 60,12,32
Mvaa 76,12,36
Ta 120,18,16384
Ta 122,18,18432
Mvaa 92,12,40
Mvaa 108,12,44
Ra 88,11,12288
Mvaa 124,12,48
Mvaa 140,12,52
Ta 124,19,16384
Ta 126,19,18432
Mvaa 156,12,56
Mvaa 172,12,60
s_waitcnt lgkmcnt(6)
Ra 92,11,14336
Mvaa 176,16,32
Mvaa 192,16,36
Mvaa 208,16,40
Mvaa 224,16,44
Mvaa 240,16,48
Maaa 128,16,52
Maaa 144,16,56
Maaa 160,16,60
Mvaa 180,20,32
Mvaa 196,20,36
Mvaa 212,20,40
Mvaa 228,20,44
Mvaa 244,20,48
Maaa 132,20,52
Maaa 148,20,56
Maaa 164,20,60
Mvaa 184,24,32
Mvaa 200,24,36
Mvaa 216,24,40
Mvaa 232,24,44
Mvaa 248,24,48
s_cmp_eq_u32 s6, 3
s_cselect_b32 s3, 0, 2146435072
Maaa 136,24,52
s_mov_b64 exec, 1
buffer_atomic_add v30, v31, s[28:31], s3 offen sc1
s_mov_b64 exec, -1
Maaa 152,24,56
Maaa 168,24,60
Mvaa 188,28,32
Mvaa 204,28,36
Mvaa 220,28,40
Mvaa 236,28,44
Mvaa 252,28,48
Maaa 140,28,52
Maaa 156,28,56
Maaa 172,28,60
s_waitcnt vmcnt(2) lgkmcnt(0)
s_add_u32 m0, s57, 0
s_barrier
Mvaa 48,64,96
buffer_load_dwordx4 v6, s[12:15], s52 offen offset:0 nt lds
Mvaa 64,64,100
Ta 32,22,0
Ta 34,22,2048
Mvaa 80,64,104
Mvaa 96,64,108
Ra 0,20,0
Mvaa 112,64,112
buffer_load_dwordx4 v7, s[12:15], s53 offen offset:1024 nt lds
Mvaa 128,64,116
s_waitcnt lgkmcnt(6)
Ta 36,23,0
Ta 38,23,2048
Mvaa 144,64,120
Mvaa 160,64,124
Ra 4,20,2048
Mvaa 52,68,96
buffer_load_dwordx4 v6, s[12:15], s54 offen offset:2048 nt lds
Mvaa 68,68,100
Ta 40,24,0
Ta 42,24,2048
Mvaa 84,68,104
Mvaa 100,68,108
Ra 8,20,4096
Mvaa 116,68,112
buffer_load_dwordx4 v7, s[12:15], s55 offen offset:3072 nt lds
Mvaa 132,68,116
s_waitcnt lgkmcnt(6)
Ta 44,25,0
Ta 46,25,2048
Mvaa 148,68,120
Mvaa 164,68,124
s_add_u32 m0, s57, 4096
Ra 12,20,6144
Mvaa 56,72,96
buffer_load_dwordx4 v8, s[12:15], s52 offen offset:0 nt lds
Mvaa 72,72,100
Ta 48,26,0
Ta 50,26,2048
Mvaa 88,72,104
Mvaa 104,72,108
Ra 16,20,8192
Mvaa 120,72,112
buffer_load_dwordx4 v9, s[12:15], s53 offen offset:1024 nt lds
Mvaa 136,72,116
s_waitcnt lgkmcnt(6)
Ta 52,27,0
Ta 54,27,2048
Mvaa 152,72,120
Mvaa 168,72,124
Ra 20,20,10240
Mvaa 60,76,96
buffer_load_dwordx4 v8, s[12:15], s54 offen offset:2048 nt lds
Mvaa 76,76,100
Ta 56,28,0
Ta 58,28,2048
Mvaa 92,76,104
Mvaa 108,76,108
Ra 24,20,12288
Mvaa 124,76,112
buffer_load_dwordx4 v9, s[12:15], s55 offen offset:3072 nt lds
Mvaa 140,76,116
s_waitcnt lgkmcnt(6)
Ta 60,29,0
Ta 62,29,2048
Mvaa 156,76,120
v_xor_b32 v6, 524288, v6
v_xor_b32 v7, 524288, v7
Mvaa 172,76,124
s_add_u32 m0, s56, 0
Ra 28,20,14336
v_xor_b32 v8, 524288, v8
Mvaa 176,80,96
buffer_load_dwordx4 v2, s[8:11], s48 offen offset:0 lds
Mvaa 192,80,100
v_xor_b32 v9, 524288, v9
Mvaa 208,80,104
Mvaa 224,80,108
Mvaa 240,80,112
buffer_load_dwordx4 v3, s[8:11], s49 offen offset:1024 lds
Maaa 128,80,116
Maaa 144,80,120
Maaa 160,80,124
Mvaa 180,84,96
buffer_load_dwordx4 v2, s[8:11], s50 offen offset:2048 lds
Mvaa 196,84,100
Mvaa 212,84,104
Mvaa 228,84,108
Mvaa 244,84,112
buffer_load_dwordx4 v3, s[8:11], s51 offen offset:3072 lds
Maaa 132,84,116
Maaa 148,84,120
Maaa 164,84,124
s_add_u32 m0, s56, 4096
Mvaa 184,88,96
buffer_load_dwordx4 v4, s[8:11], s48 offen offset:0 lds
Mvaa 200,88,100
Mvaa 216,88,104
Mvaa 232,88,108
Mvaa 248,88,112
buffer_load_dwordx4 v5, s[8:11], s49 offen offset:1024 lds
Maaa 136,88,116
Maaa 152,88,120
Maaa 168,88,124
Mvaa 188,92,96
buffer_load_dwordx4 v4, s[8:11], s50 offen offset:2048 lds
Mvaa 204,92,100
Mvaa 220,92,104
Mvaa 236,92,108
Mvaa 252,92,112
buffer_load_dwordx4 v5, s[8:11], s51 offen offset:3072 lds
Maaa 140,92,116
v_xor_b32 v2, 128, v2
v_xor_b32 v3, 128, v3
Maaa 156,92,120
v_xor_b32 v4, 128, v4
v_xor_b32 v5, 128, v5
Maaa 172,92,124
s_waitcnt lgkmcnt(0)
Mvaa 48,0,32
buffer_load_dword v44, v45, s[16:19], s47 offen
Mvaa 64,0,36
Ta 96,22,16384
Ta 98,22,18432
Mvaa 80,0,40
s_add_u32 s47, s47, 2097152
v_lshrrev_b32 v32, 4, v0
v_and_b32 v33, 15, v0
Mvaa 96,0,44
Ra 64,21,0
Mvaa 112,0,48
s_lshl_b32 s3, s32, 4
v_add_u32 v34, s3, v32
v_lshlrev_b32_e64 v36, 1, v32
Mvaa 128,0,52
Ta 100,23,16384
Ta 102,23,18432
Mvaa 144,0,56
v_xor_b32 v36, v36, v33
v_xor_b32 v37, 8, v36
Mvaa 160,0,60
s_waitcnt lgkmcnt(6)
Ra 68,21,2048
Mvaa 52,4,32
s_getpc_b64 s[6:7]
L_cpf3:
s_add_u32 s6, s6, (L_phase2-L_cpf3)&0xffffffff
s_addc_u32 s7, s7, ((L_phase2-L_cpf3)>>32)&0xffffffff
Mvaa 68,4,36
Ta 104,24,16384
Ta 106,24,18432
Mvaa 84,4,40
s_lshr_b32 s3, s2, 3
s_lshl_b32 s3, s3, 2
s_add_u32 s3, s3, s32
Mvaa 100,4,44
Ra 72,21,4096
Mvaa 116,4,48
s_lshl_b32 s3, s3, 10
v_and_b32 v42, 7, v0
v_lshlrev_b32 v42, 7, v42
Mvaa 132,4,52
Ta 108,25,16384
Ta 110,25,18432
Mvaa 148,4,56
v_add_u32_e64 v42, s3, v42
v_min_u32 v42, L_k2_fin-L_phase2-4, v42
Mvaa 164,4,60
s_waitcnt lgkmcnt(6)
Ra 76,21,6144
Mvaa 56,8,32
v_mov_b32 v41, s7
Mvaa 72,8,36
Ta 112,26,16384
Ta 114,26,18432
Mvaa 88,8,40
v_add_co_u32 v40, vcc, s6, v42
s_nop 1
v_addc_co_u32 v41, vcc, 0, v41, vcc
Mvaa 104,8,44
Ra 80,21,8192
Mvaa 120,8,48
global_load_dword v38, v[40:41], off
Mvaa 136,8,52
Ta 116,27,16384
Ta 118,27,18432
Mvaa 152,8,56
Mvaa 168,8,60
s_waitcnt lgkmcnt(6)
Ra 84,21,10240
Mvaa 60,12,32
Mvaa 76,12,36
Ta 120,28,16384
Ta 122,28,18432
Mvaa 92,12,40
Mvaa 108,12,44
Ra 88,21,12288
Mvaa 124,12,48
Mvaa 140,12,52
Ta 124,29,16384
Ta 126,29,18432
Mvaa 156,12,56
Mvaa 172,12,60
s_waitcnt lgkmcnt(6)
Ra 92,21,14336
Mvaa 176,16,32
Mvaa 192,16,36
Mvaa 208,16,40
Mvaa 224,16,44
Mvaa 240,16,48
Maaa 128,16,52
Maaa 144,16,56
Maaa 160,16,60
Mvaa 180,20,32
Mvaa 196,20,36
Mvaa 212,20,40
Mvaa 228,20,44
Mvaa 244,20,48
Maaa 132,20,52
Maaa 148,20,56
Maaa 164,20,60
Mvaa 184,24,32
Mvaa 200,24,36
Mvaa 216,24,40
Mvaa 232,24,44
Mvaa 248,24,48
Maaa 136,24,52
Maaa 152,24,56
Maaa 168,24,60
Mvaa 188,28,32
Mvaa 204,28,36
Mvaa 220,28,40
Mvaa 236,28,44
Mvaa 252,28,48
Maaa 140,28,52
Maaa 156,28,56
Maaa 172,28,60
s_waitcnt vmcnt(2) lgkmcnt(0)
s_add_u32 m0, s57, 65536
s_barrier
Mvaa 48,64,96
buffer_load_dwordx4 v6, s[12:15], s52 offen offset:0 nt lds
Mvaa 64,64,100
Ta 32,12,0
Ta 34,12,2048
Mvaa 80,64,104
Mvaa 96,64,108
Ra 0,10,0
Mvaa 112,64,112
buffer_load_dwordx4 v7, s[12:15], s53 offen offset:1024 nt lds
Mvaa 128,64,116
s_waitcnt lgkmcnt(6)
Ta 36,13,0
Ta 38,13,2048
Mvaa 144,64,120
Mvaa 160,64,124
Ra 4,10,2048
Mvaa 52,68,96
buffer_load_dwordx4 v6, s[12:15], s54 offen offset:2048 nt lds
Mvaa 68,68,100
Ta 40,14,0
Ta 42,14,2048
Mvaa 84,68,104
Mvaa 100,68,108
Ra 8,10,4096
Mvaa 116,68,112
buffer_load_dwordx4 v7, s[12:15], s55 offen offset:3072 nt lds
Mvaa 132,68,116
s_waitcnt lgkmcnt(6)
Ta 44,15,0
Ta 46,15,2048
Mvaa 148,68,120
Mvaa 164,68,124
s_add_u32 m0, s57, 69632
Ra 12,10,6144
Mvaa 56,72,96
buffer_load_dwordx4 v8, s[12:15], s52 offen offset:0 nt lds
Mvaa 72,72,100
Ta 48,16,0
Ta 50,16,2048
Mvaa 88,72,104
Mvaa 104,72,108
Ra 16,10,8192
Mvaa 120,72,112
buffer_load_dwordx4 v9, s[12:15], s53 offen offset:1024 nt lds
Mvaa 136,72,116
s_waitcnt lgkmcnt(6)
Ta 52,17,0
Ta 54,17,2048
Mvaa 152,72,120
Mvaa 168,72,124
Ra 20,10,10240
Mvaa 60,76,96
buffer_load_dwordx4 v8, s[12:15], s54 offen offset:2048 nt lds
Mvaa 76,76,100
Ta 56,18,0
Ta 58,18,2048
Mvaa 92,76,104
Mvaa 108,76,108
Ra 24,10,12288
Mvaa 124,76,112
buffer_load_dwordx4 v9, s[12:15], s55 offen offset:3072 nt lds
Mvaa 140,76,116
s_waitcnt lgkmcnt(6)
Ta 60,19,0
Ta 62,19,2048
Mvaa 156,76,120
Mvaa 172,76,124
s_add_u32 m0, s56, 65536
Ra 28,10,14336
Mvaa 176,80,96
buffer_load_dwordx4 v2, s[8:11], s48 offen offset:0 lds
Mvaa 192,80,100
Mvaa 208,80,104
Mvaa 224,80,108
Mvaa 240,80,112
buffer_load_dwordx4 v3, s[8:11], s49 offen offset:1024 lds
Maaa 128,80,116
Maaa 144,80,120
Maaa 160,80,124
Mvaa 180,84,96
buffer_load_dwordx4 v2, s[8:11], s50 offen offset:2048 lds
Mvaa 196,84,100
Mvaa 212,84,104
Mvaa 228,84,108
Mvaa 244,84,112
buffer_load_dwordx4 v3, s[8:11], s51 offen offset:3072 lds
Maaa 132,84,116
Maaa 148,84,120
Maaa 164,84,124
s_add_u32 m0, s56, 69632
Mvaa 184,88,96
buffer_load_dwordx4 v4, s[8:11], s48 offen offset:0 lds
Mvaa 200,88,100
Mvaa 216,88,104
Mvaa 232,88,108
Mvaa 248,88,112
buffer_load_dwordx4 v5, s[8:11], s49 offen offset:1024 lds
Maaa 136,88,116
Maaa 152,88,120
Maaa 168,88,124
Mvaa 188,92,96
buffer_load_dwordx4 v4, s[8:11], s50 offen offset:2048 lds
Mvaa 204,92,100
Mvaa 220,92,104
Mvaa 236,92,108
Mvaa 252,92,112
buffer_load_dwordx4 v5, s[8:11], s51 offen offset:3072 lds
Maaa 140,92,116
Maaa 156,92,120
Maaa 172,92,124
s_waitcnt lgkmcnt(0)
Mvaa 48,0,32
buffer_load_dword v30, v31, s[28:31], s37 offen sc1
Mvaa 64,0,36
Ta 96,12,16384
Ta 98,12,18432
Mvaa 80,0,40
s_mov_b32 s8, s16
s_mov_b32 s9, s17
s_mov_b32 s10, s18
Mvaa 96,0,44
Ra 64,11,0
Mvaa 112,0,48
s_add_u32 s16, s66, 46137344
s_addc_u32 s17, s67, 0
s_and_b32 s17, s17, 0xffff
Mvaa 128,0,52
Ta 100,13,16384
Ta 102,13,18432
Mvaa 144,0,56
s_mov_b32 s18, 16777216
s_mov_b32 s19, 0x20000
s_mov_b32 s48, 0
Mvaa 160,0,60
s_waitcnt lgkmcnt(6)
Ra 68,11,2048
Mvaa 52,4,32
s_mov_b32 s49, 31744
s_mov_b32 s50, 63488
s_mov_b32 s51, 95232
Mvaa 68,4,36
Ta 104,14,16384
Ta 106,14,18432
Mvaa 84,4,40
v_lshlrev_b32_e64 v35, 13, v34
v_lshl_add_u32 v8, v36, 4, v35
Mvaa 100,4,44
Ra 72,11,4096
Mvaa 116,4,48
v_lshl_add_u32 v9, v37, 4, v35
v_lshlrev_b32_e64 v2, 4, v0
Mvaa 132,4,52
Ta 108,15,16384
Ta 110,15,18432
Mvaa 148,4,56
v_add_u32 v3, 65536, v2
v_add_u32_e64 v4, s44, v2
Mvaa 164,4,60
s_waitcnt lgkmcnt(6)
Ra 76,11,6144
Mvaa 56,8,32
v_mov_b32 v7, 0
v_lshlrev_b32_e64 v35, 2, v32
Mvaa 72,8,36
Ta 112,16,16384
Ta 114,16,18432
Mvaa 88,8,40
v_sub_u32_e64 v35, v33, v35
Mvaa 104,8,44
Ra 80,11,8192
Mvaa 120,8,48
s_lshl_b32 s3, s45, 5
v_add_u32 v5, s3, v35
Mvaa 136,8,52
Ta 116,17,16384
Ta 118,17,18432
Mvaa 152,8,56
s_lshl_b32 s3, s46, 5
v_add_u32 v6, s3, v35
Mvaa 168,8,60
s_waitcnt lgkmcnt(6)
Ra 84,11,10240
Mvaa 60,12,32
s_mul_i32 s3, s33, 1116160
s_add_u32 s3, s3, 8388608
s_add_u32 s12, s66, s3
s_addc_u32 s13, s67, 0
s_and_b32 s13, s13, 0xffff
Mvaa 76,12,36
Ta 120,18,16384
Ta 122,18,18432
Mvaa 92,12,40
s_mov_b32 s14, 0
s_mov_b32 s15, 0x20000
s_mul_i32 s14, s36, 34816
Mvaa 108,12,44
Ra 88,11,12288
Mvaa 124,12,48
buffer_load_dword v44, v45, s[8:11], s47 offen
Mvaa 140,12,52
Ta 124,19,16384
Ta 126,19,18432
Mvaa 156,12,56
s_add_u32 s47, s47, 2097152
Mvaa 172,12,60
s_waitcnt lgkmcnt(6)
Ra 92,11,14336
Mvaa 176,16,32
Mvaa 192,16,36
Mvaa 208,16,40
Mvaa 224,16,44
Mvaa 240,16,48
Maaa 128,16,52
Maaa 144,16,56
Maaa 160,16,60
Mvaa 180,20,32
Mvaa 196,20,36
Mvaa 212,20,40
Mvaa 228,20,44
Mvaa 244,20,48
Maaa 132,20,52
Maaa 148,20,56
Maaa 164,20,60
Mvaa 184,24,32
Mvaa 200,24,36
Mvaa 216,24,40
Mvaa 232,24,44
Mvaa 248,24,48
Maaa 136,24,52
Maaa 152,24,56
Maaa 168,24,60
Mvaa 188,28,32
Mvaa 204,28,36
Mvaa 220,28,40
Mvaa 236,28,44
Mvaa 252,28,48
Maaa 140,28,52
Maaa 156,28,56
Maaa 172,28,60
s_waitcnt vmcnt(2) lgkmcnt(0)
s_add_u32 m0, s44, 0
s_barrier
Mvaa 48,64,96
buffer_load_dwordx4 v8, s[8:11], s48 offen offset:0 lds
Mvaa 64,64,100
Ta 32,22,0
Ta 34,22,2048
Mvaa 80,64,104
s_mul_i32 s3, s45, 67584
v_add_u32_e64 v10, s3, v2
Mvaa 96,64,108
Ra 0,20,0
Mvaa 112,64,112
buffer_load_dwordx4 v8, s[8:11], s49 offen offset:1024 lds
Mvaa 128,64,116
s_waitcnt lgkmcnt(6)
Ta 36,23,0
Ta 38,23,2048
Mvaa 144,64,120
s_mul_i32 s3, s46, 67584
v_add_u32 v11, s3, v2
Mvaa 160,64,124
Ra 4,20,2048
Mvaa 52,68,96
buffer_load_dwordx4 v9, s[8:11], s50 offen offset:2048 lds
Mvaa 68,68,100
Ta 40,24,0
Ta 42,24,2048
Mvaa 84,68,104
Mvaa 100,68,108
Ra 8,20,4096
Mvaa 116,68,112
buffer_load_dwordx4 v9, s[8:11], s51 offen offset:3072 lds
Mvaa 132,68,116
s_waitcnt lgkmcnt(6)
Ta 44,25,0
Ta 46,25,2048
Mvaa 148,68,120
v_add_u32 v8, 524288, v8
v_add_u32 v9, 524288, v9
Mvaa 164,68,124
s_add_u32 m0, s44, 16384
Ra 12,20,6144
Mvaa 56,72,96
buffer_load_dwordx4 v8, s[8:11], s48 offen offset:0 lds
Mvaa 72,72,100
Ta 48,26,0
Ta 50,26,2048
Mvaa 88,72,104
Mvaa 104,72,108
Ra 16,20,8192
Mvaa 120,72,112
buffer_load_dwordx4 v8, s[8:11], s49 offen offset:1024 lds
Mvaa 136,72,116
s_waitcnt lgkmcnt(6)
Ta 52,27,0
Ta 54,27,2048
Mvaa 152,72,120
Mvaa 168,72,124
Ra 20,20,10240
Mvaa 60,76,96
buffer_load_dwordx4 v9, s[8:11], s50 offen offset:2048 lds
Mvaa 76,76,100
Ta 56,28,0
Ta 58,28,2048
Mvaa 92,76,104
Mvaa 108,76,108
Ra 24,20,12288
Mvaa 124,76,112
buffer_load_dwordx4 v9, s[8:11], s51 offen offset:3072 lds
Mvaa 140,76,116
s_waitcnt lgkmcnt(6)
Ta 60,29,0
Ta 62,29,2048
Mvaa 156,76,120
v_add_u32 v8, 524288, v8
v_add_u32 v9, 524288, v9
Mvaa 172,76,124
s_add_u32 m0, s44, 32768
Ra 28,20,14336
Mvaa 176,80,96
buffer_load_dwordx4 v8, s[8:11], s48 offen offset:0 lds
Mvaa 192,80,100
Mvaa 208,80,104
Mvaa 224,80,108
Mvaa 240,80,112
buffer_load_dwordx4 v8, s[8:11], s49 offen offset:1024 lds
Maaa 128,80,116
Maaa 144,80,120
Maaa 160,80,124
Mvaa 180,84,96
buffer_load_dwordx4 v9, s[8:11], s50 offen offset:2048 lds
Mvaa 196,84,100
Mvaa 212,84,104
Mvaa 228,84,108
Mvaa 244,84,112
buffer_load_dwordx4 v9, s[8:11], s51 offen offset:3072 lds
Maaa 132,84,116
v_add_u32 v8, 524288, v8
v_add_u32 v9, 524288, v9
Maaa 148,84,120
Maaa 164,84,124
s_add_u32 m0, s44, 49152
Mvaa 184,88,96
buffer_load_dwordx4 v8, s[8:11], s48 offen offset:0 lds
Mvaa 200,88,100
Mvaa 216,88,104
Mvaa 232,88,108
Mvaa 248,88,112
buffer_load_dwordx4 v8, s[8:11], s49 offen offset:1024 lds
Maaa 136,88,116
Maaa 152,88,120
Maaa 168,88,124
Mvaa 188,92,96
buffer_load_dwordx4 v9, s[8:11], s50 offen offset:2048 lds
Mvaa 204,92,100
Mvaa 220,92,104
Mvaa 236,92,108
Mvaa 252,92,112
buffer_load_dwordx4 v9, s[8:11], s51 offen offset:3072 lds
Maaa 140,92,116
v_add_u32 v8, 524288, v8
v_add_u32 v9, 524288, v9
Maaa 156,92,120
Maaa 172,92,124
s_waitcnt lgkmcnt(0)
Mvaa 48,0,32
Mvaa 64,0,36
Ta 96,22,16384
Ta 98,22,18432
Mvaa 80,0,40
Mvaa 96,0,44
Ra 64,21,0
Mvaa 112,0,48
Mvaa 128,0,52
Ta 100,23,16384
Ta 102,23,18432
Mvaa 144,0,56
Mvaa 160,0,60
s_waitcnt lgkmcnt(6)
Ra 68,21,2048
Mvaa 52,4,32
Mvaa 68,4,36
Ta 104,24,16384
Ta 106,24,18432
Mvaa 84,4,40
Mvaa 100,4,44
Ra 72,21,4096
Mvaa 116,4,48
Mvaa 132,4,52
Ta 108,25,16384
Ta 110,25,18432
Mvaa 148,4,56
Mvaa 164,4,60
s_waitcnt lgkmcnt(6)
Ra 76,21,6144
Mvaa 56,8,32
Mvaa 72,8,36
Ta 112,26,16384
Ta 114,26,18432
Mvaa 88,8,40
Mvaa 104,8,44
Ra 80,21,8192
Mvaa 120,8,48
Mvaa 136,8,52
Ta 116,27,16384
Ta 118,27,18432
Mvaa 152,8,56
Mvaa 168,8,60
s_waitcnt lgkmcnt(6)
Ra 84,21,10240
Mvaa 60,12,32
Mvaa 76,12,36
Ta 120,28,16384
Ta 122,28,18432
Mvaa 92,12,40
Mvaa 108,12,44
Ra 88,21,12288
Mvaa 124,12,48
Mvaa 140,12,52
Ta 124,29,16384
Ta 126,29,18432
Mvaa 156,12,56
Mvaa 172,12,60
s_waitcnt lgkmcnt(6)
Ra 92,21,14336
Mvaa 176,16,32
Mvaa 192,16,36
Mvaa 208,16,40
Mvaa 224,16,44
Mvaa 240,16,48
Maaa 128,16,52
Maaa 144,16,56
Maaa 160,16,60
Mvaa 180,20,32
Mvaa 196,20,36
Mvaa 212,20,40
Mvaa 228,20,44
Mvaa 244,20,48
Maaa 132,20,52
Maaa 148,20,56
Maaa 164,20,60
Mvaa 184,24,32
Mvaa 200,24,36
Mvaa 216,24,40
Mvaa 232,24,44
Mvaa 248,24,48
Maaa 136,24,52
Maaa 152,24,56
Maaa 168,24,60
Mvaa 188,28,32
Mvaa 204,28,36
Mvaa 220,28,40
Mvaa 236,28,44
Mvaa 252,28,48
Maaa 140,28,52
Maaa 156,28,56
Maaa 172,28,60
s_waitcnt vmcnt(12) lgkmcnt(0)
v_readfirstlane_b32 s3, v30
s_nop 0
s_or_b32 s3, s3, s37
s_cmp_lt_u32 s3, 256
s_cbranch_scc1 L_spinAv
L_spinArv:
s_barrier
Mvaa 48,64,96
buffer_load_dwordx4 a[0:3], v10, s[20:23], 0 offen offset:0 sc1
Mvaa 52,68,96
v_lshrrev_b32_e64 v42, 2, v33
v_lshl_add_u32 v43, v32, 3, v42
Mvaa 56,72,96
v_lshlrev_b32 v43, 8, v43
v_and_b32 v44, 3, v0
Mvaa 60,76,96
v_lshl_add_u32 v43, v44, 3, v43
v_and_b32_e64 v44, 1, v32
Mvaa 64,64,100
buffer_load_dwordx4 a[4:7], v10, s[20:23], s58 offen offset:0 sc1
Mvaa 68,68,100
v_lshl_add_u32 v42, v44, 2, v42
v_xor_b32_e64 v44, 0, v42
Mvaa 72,72,100
v_lshl_add_u32 v16, v44, 5, v43
v_xor_b32_e64 v44, 1, v42
Mvaa 76,76,100
v_lshl_add_u32 v17, v44, 5, v43
v_xor_b32_e64 v44, 2, v42
Mvaa 80,64,104
buffer_load_dwordx4 a[8:11], v11, s[20:23], 0 offen offset:0 sc1
Mvaa 84,68,104
v_lshl_add_u32 v18, v44, 5, v43
v_xor_b32_e64 v44, 3, v42
Mvaa 88,72,104
v_lshl_add_u32 v19, v44, 5, v43
v_xor_b32_e64 v44, 4, v42
Mvaa 92,76,104
v_lshl_add_u32 v20, v44, 5, v43
v_xor_b32_e64 v44, 5, v42
Mvaa 96,64,108
buffer_load_dwordx4 a[12:15], v11, s[20:23], s58 offen offset:0 sc1
Mvaa 100,68,108
v_lshl_add_u32 v21, v44, 5, v43
v_xor_b32_e64 v44, 6, v42
Mvaa 104,72,108
v_lshl_add_u32 v22, v44, 5, v43
v_xor_b32_e64 v44, 7, v42
Mvaa 108,76,108
v_lshl_add_u32 v23, v44, 5, v43
Mvaa 112,64,112
buffer_load_dwordx4 a[16:19], v10, s[20:23], 0 offen offset:1024 sc1
Mvaa 116,68,112
Mvaa 120,72,112
Mvaa 124,76,112
Mvaa 128,64,116
buffer_load_dwordx4 a[20:23], v10, s[20:23], s58 offen offset:1024 sc1
Mvaa 132,68,116
Ta 192,16,0
Ta 194,16,1024
Mvaa 136,72,116
Ta 196,17,0
Ta 198,17,1024
Mvaa 140,76,116
Ta 200,18,0
Ta 202,18,1024
Mvaa 144,64,120
buffer_load_dwordx4 a[24:27], v11, s[20:23], 0 offen offset:1024 sc1
Mvaa 148,68,120
Ta 204,19,0
Ta 206,19,1024
Mvaa 152,72,120
Ta 208,20,0
Ta 210,20,1024
Mvaa 156,76,120
Ta 212,21,0
Ta 214,21,1024
Mvaa 160,64,124
buffer_load_dwordx4 a[28:31], v11, s[20:23], s58 offen offset:1024 sc1
Mvaa 164,68,124
Ta 216,22,0
Ta 218,22,1024
Mvaa 168,72,124
Ta 220,23,0
s_waitcnt lgkmcnt(9)
Ta 222,23,1024
Mvaa 172,76,124
s_waitcnt lgkmcnt(8)
Vc 24,48,49
Vc 25,50,51
Mvaa 176,80,96
buffer_load_dwordx4 a[32:35], v10, s[20:23], 0 offen offset:2048 sc1
Mvaa 180,84,96
Vc 26,52,53
Vc 27,54,55
Mvaa 184,88,96
Vc 28,56,57
Vc 29,58,59
Mvaa 188,92,96
Vc 30,60,61
Vc 31,62,63
Mvaa 192,80,100
buffer_load_dwordx4 a[36:39], v10, s[20:23], s58 offen offset:2048 sc1
Mvaa 196,84,100
Vc 32,64,65
Vc 33,66,67
Mvaa 200,88,100
Vc 34,68,69
Vc 35,70,71
Mvaa 204,92,100
Vc 36,72,73
Vc 37,74,75
Mvaa 208,80,104
buffer_load_dwordx4 a[40:43], v11, s[20:23], 0 offen offset:2048 sc1
Mvaa 212,84,104
Vc 38,76,77
Vc 39,78,79
Mvaa 216,88,104
Vc 40,80,81
Vc 41,82,83
Mvaa 220,92,104
Vc 42,84,85
Vc 43,86,87
Mvaa 224,80,108
buffer_load_dwordx4 a[44:47], v11, s[20:23], s58 offen offset:2048 sc1
Mvaa 228,84,108
Vc 44,88,89
Vc 45,90,91
Mvaa 232,88,108
Vc 46,92,93
Vc 47,94,95
Mvaa 236,92,108
Vc 48,96,97
Vc 49,98,99
Mvaa 240,80,112
buffer_load_dwordx4 a[48:51], v10, s[20:23], 0 offen offset:3072 sc1
Mvaa 244,84,112
Vc 50,100,101
Vc 51,102,103
Mvaa 248,88,112
Vc 52,104,105
Vc 53,106,107
Mvaa 252,92,112
Vc 54,108,109
Vc 55,110,111
Maaa 128,80,116
buffer_load_dwordx4 a[52:55], v10, s[20:23], s58 offen offset:3072 sc1
Maaa 132,84,116
Vc 56,112,113
Vc 57,114,115
Maaa 136,88,116
Vc 58,116,117
Vc 59,118,119
Maaa 140,92,116
Vc 60,120,121
Vc 61,122,123
Maaa 144,80,120
buffer_load_dwordx4 a[56:59], v11, s[20:23], 0 offen offset:3072 sc1
Maaa 148,84,120
Vc 62,124,125
Vc 63,126,127
Maaa 152,88,120
Vc 64,128,129
Vc 65,130,131
Maaa 156,92,120
Vc 66,132,133
Vc 67,134,135
Maaa 160,80,124
buffer_load_dwordx4 a[60:63], v11, s[20:23], s58 offen offset:3072 sc1
Maaa 164,84,124
v_add_u32 v10, 4096, v10
v_add_u32 v11, 4096, v11
Maaa 168,88,124
Vc 68,136,137
Vc 69,138,139
Maaa 172,92,124
Vc 70,140,141
Vc 71,142,143
Vc 72,144,145
Vc 73,146,147
Vc 74,148,149
Vc 75,150,151
Vc 76,152,153
Vc 77,154,155
Vc 78,156,157
Vc 79,158,159
Vc 80,160,161
Vc 81,162,163
Vc 82,164,165
Vc 83,166,167
Vc 84,168,169
Vc 85,170,171
Vc 86,172,173
Vc 87,174,175
Vc 88,176,177
Vc 89,178,179
Vc 90,180,181
Vc 91,182,183
Vc 92,184,185
Vc 93,186,187
Vc 94,188,189
Vc 95,190,191
Vc 96,192,193
Vc 97,194,195
Vc 98,196,197
Vc 99,198,199
Vc 100,200,201
Vc 101,202,203
Vc 102,204,205
Vc 103,206,207
Vc 104,208,209
Vc 105,210,211
Vc 106,212,213
Vc 107,214,215
Vc 108,216,217
Vc 109,218,219
Vc 110,220,221
Vc 111,222,223
Vc 112,224,225
Vc 113,226,227
Vc 114,228,229
Vc 115,230,231
Vc 116,232,233
Vc 117,234,235
Vc 118,236,237
Vc 119,238,239
Vc 120,240,241
Vc 121,242,243
Vc 122,244,245
Vc 123,246,247
Vc 124,248,249
Vc 125,250,251
Vc 126,252,253
Vc 127,254,255
L_phase2:
s_nop 7
s_waitcnt vmcnt(12) lgkmcnt(0)
Zvaa 128,192,0
s_add_u32 s37, s38, 0
Zvaa 160,192,4
Ta 224,16,8192
Ta 226,16,9216
Zvaa 192,192,8
buffer_load_dwordx4 a[64:67], v10, s[20:23], 0 offen offset:0 sc1
Zvaa 224,192,12
buffer_store_dwordx4 v[24:27], v2, s[24:27], s37 offen offset:0 sc1
Zvaa 132,196,0
Ta 228,17,8192
Ta 230,17,9216
Zvaa 164,196,4
buffer_load_dwordx4 a[68:71], v10, s[20:23], s58 offen offset:0 sc1
Zvaa 196,196,8
s_mov_b32 s60, s40
s_and_b32 s61, s41, 0xffff
s_mov_b32 s62, 7340032
Zvaa 228,196,12
Ta 232,18,8192
Ta 234,18,9216
Zvaa 136,200,0
s_mov_b32 s63, 0x20000
Zvaa 168,200,4
buffer_load_dwordx4 a[72:75], v11, s[20:23], 0 offen offset:0 sc1
Zvaa 200,200,8
Ta 236,19,8192
Ta 238,19,9216
Zvaa 232,200,12
Zvaa 140,204,0
Zvaa 172,204,4
Ta 240,20,8192
Ta 242,20,9216
Zvaa 204,204,8
buffer_load_dwordx4 a[76:79], v11, s[20:23], s58 offen offset:0 sc1
Zvaa 236,204,12
Zvaa 144,208,0
s_waitcnt lgkmcnt(6)
Ta 244,21,8192
Ta 246,21,9216
Zvaa 176,208,4
buffer_store_dwordx4 v[28:31], v2, s[24:27], s37 offen offset:1024 sc1
Zvaa 208,208,8
buffer_load_dwordx4 a[80:83], v10, s[20:23], 0 offen offset:1024 sc1
Zvaa 240,208,12
Ta 248,22,8192
Ta 250,22,9216
Zvaa 148,212,0
Zvaa 180,212,4
Zvaa 212,212,8
Ta 252,23,8192
Ta 254,23,9216
Zvaa 244,212,12
buffer_load_dwordx4 a[84:87], v10, s[20:23], s58 offen offset:1024 sc1
Zvaa 152,216,0
Zvaa 184,216,4
Zvaa 216,216,8
buffer_load_dwordx4 a[88:91], v11, s[20:23], 0 offen offset:1024 sc1
Zvaa 248,216,12
Zvaa 156,220,0
Zvaa 188,220,4
buffer_load_dwordx4 a[92:95], v11, s[20:23], s58 offen offset:1024 sc1
Zvaa 220,220,8
Zvaa 252,220,12
s_waitcnt vmcnt(18) lgkmcnt(0)
s_barrier
Mvaa 128,224,16
buffer_store_dwordx4 v[32:35], v2, s[24:27], s37 offen offset:2048 sc1
Mvaa 160,224,20
s_add_u32 m0, s44, 0
Ta 192,16,16384
Ta 194,16,17408
Mvaa 192,224,24
buffer_load_dwordx4 v8, s[8:11], s48 offen offset:0 lds
Mvaa 224,224,28
buffer_load_dwordx4 v8, s[8:11], s49 offen offset:1024 lds
Mvaa 132,228,16
Ta 196,17,16384
Ta 198,17,17408
Mvaa 164,228,20
Mvaa 196,228,24
buffer_load_dwordx4 v9, s[8:11], s50 offen offset:2048 lds
Mvaa 228,228,28
Ta 200,18,16384
Ta 202,18,17408
Mvaa 136,232,16
Mvaa 168,232,20
buffer_load_dwordx4 v9, s[8:11], s51 offen offset:3072 lds
v_add_u32 v8, 524288, v8
v_add_u32 v9, 524288, v9
Mvaa 200,232,24
Ta 204,19,16384
Ta 206,19,17408
Mvaa 232,232,28
Mvaa 140,236,16
buffer_load_dwordx4 a[96:99], v10, s[20:23], 0 offen offset:2048 sc1
Mvaa 172,236,20
Ta 208,20,16384
Ta 210,20,17408
Mvaa 204,236,24
Mvaa 236,236,28
buffer_load_dwordx4 a[100:103], v10, s[20:23], s58 offen offset:2048 sc1
Mvaa 144,240,16
s_waitcnt lgkmcnt(6)
Ta 212,21,16384
Ta 214,21,17408
Mvaa 176,240,20
buffer_store_dwordx4 v[36:39], v2, s[24:27], s37 offen offset:3072 sc1
Mvaa 208,240,24
buffer_load_dwordx4 a[104:107], v11, s[20:23], 0 offen offset:2048 sc1
Mvaa 240,240,28
Ta 216,22,16384
Ta 218,22,17408
Mvaa 148,244,16
Mvaa 180,244,20
buffer_load_dwordx4 a[108:111], v11, s[20:23], s58 offen offset:2048 sc1
Mvaa 212,244,24
Ta 220,23,16384
Ta 222,23,17408
Mvaa 244,244,28
Mvaa 152,248,16
buffer_load_dwordx4 a[112:115], v10, s[20:23], 0 offen offset:3072 sc1
Mvaa 184,248,20
Mvaa 216,248,24
buffer_load_dwordx4 a[116:119], v10, s[20:23], s58 offen offset:3072 sc1
Mvaa 248,248,28
Mvaa 156,252,16
buffer_load_dwordx4 a[120:123], v11, s[20:23], 0 offen offset:3072 sc1
Mvaa 188,252,20
Mvaa 220,252,24
buffer_load_dwordx4 a[124:127], v11, s[20:23], s58 offen offset:3072 sc1
v_add_u32 v10, 4096, v10
v_add_u32 v11, 4096, v11
Mvaa 252,252,28
s_waitcnt vmcnt(28) lgkmcnt(0)
Mvaa 128,192,32
s_add_u32 s37, s38, 4096
Mvaa 160,192,36
Ta 224,16,24576
Ta 226,16,25600
Mvaa 192,192,40
buffer_load_dwordx4 a[0:3], v10, s[20:23], 0 offen offset:0 sc1
Mvaa 224,192,44
buffer_store_dwordx4 v[40:43], v2, s[24:27], s37 offen offset:0 sc1
Mvaa 132,196,32
Ta 228,17,24576
Ta 230,17,25600
Mvaa 164,196,36
buffer_load_dwordx4 a[4:7], v10, s[20:23], s58 offen offset:0 sc1
Mvaa 196,196,40
Mvaa 228,196,44
Ta 232,18,24576
Ta 234,18,25600
Mvaa 136,200,32
Mvaa 168,200,36
buffer_load_dwordx4 a[8:11], v11, s[20:23], 0 offen offset:0 sc1
Mvaa 200,200,40
Ta 236,19,24576
Ta 238,19,25600
Mvaa 232,200,44
Mvaa 140,204,32
Mvaa 172,204,36
Ta 240,20,24576
Ta 242,20,25600
Mvaa 204,204,40
buffer_load_dwordx4 a[12:15], v11, s[20:23], s58 offen offset:0 sc1
Mvaa 236,204,44
Mvaa 144,208,32
s_waitcnt lgkmcnt(6)
Ta 244,21,24576
Ta 246,21,25600
Mvaa 176,208,36
buffer_store_dwordx4 v[44:47], v2, s[24:27], s37 offen offset:1024 sc1
Mvaa 208,208,40
buffer_load_dwordx4 a[16:19], v10, s[20:23], 0 offen offset:1024 sc1
Mvaa 240,208,44
Ta 248,22,24576
Ta 250,22,25600
Mvaa 148,212,32
Mvaa 180,212,36
Mvaa 212,212,40
Ta 252,23,24576
Ta 254,23,25600
Mvaa 244,212,44
buffer_load_dwordx4 a[20:23], v10, s[20:23], s58 offen offset:1024 sc1
Mvaa 152,216,32
Mvaa 184,216,36
Mvaa 216,216,40
buffer_load_dwordx4 a[24:27], v11, s[20:23], 0 offen offset:1024 sc1
Mvaa 248,216,44
Mvaa 156,220,32
Mvaa 188,220,36
buffer_load_dwordx4 a[28:31], v11, s[20:23], s58 offen offset:1024 sc1
Mvaa 220,220,40
Mvaa 252,220,44
s_waitcnt vmcnt(34) lgkmcnt(0)
s_barrier
Mvaa 128,224,48
buffer_store_dwordx4 v[48:51], v2, s[24:27], s37 offen offset:2048 sc1
Mvaa 160,224,52
s_add_u32 m0, s44, 16384
Ta 192,16,32768
Ta 194,16,33792
Mvaa 192,224,56
buffer_load_dwordx4 v8, s[8:11], s48 offen offset:0 lds
Mvaa 224,224,60
Mvaa 132,228,48
Ta 196,17,32768
Ta 198,17,33792
Mvaa 164,228,52
buffer_load_dwordx4 v8, s[8:11], s49 offen offset:1024 lds
Mvaa 196,228,56
Mvaa 228,228,60
Ta 200,18,32768
Ta 202,18,33792
Mvaa 136,232,48
Mvaa 168,232,52
buffer_load_dwordx4 v9, s[8:11], s50 offen offset:2048 lds
Mvaa 200,232,56
Ta 204,19,32768
Ta 206,19,33792
Mvaa 232,232,60
Mvaa 140,236,48
Mvaa 172,236,52
Ta 208,20,32768
Ta 210,20,33792
Mvaa 204,236,56
buffer_load_dwordx4 v9, s[8:11], s51 offen offset:3072 lds
v_add_u32 v8, 524288, v8
v_add_u32 v9, 524288, v9
Mvaa 236,236,60
Mvaa 144,240,48
s_waitcnt lgkmcnt(6)
Ta 212,21,32768
Ta 214,21,33792
Mvaa 176,240,52
buffer_store_dwordx4 v[52:55], v2, s[24:27], s37 offen offset:3072 sc1
Mvaa 208,240,56
buffer_load_dwordx4 a[32:35], v10, s[20:23], 0 offen offset:2048 sc1
Mvaa 240,240,60
Ta 216,22,32768
Ta 218,22,33792
Mvaa 148,244,48
Mvaa 180,244,52
Mvaa 212,244,56
Ta 220,23,32768
Ta 222,23,33792
Mvaa 244,244,60
buffer_load_dwordx4 a[36:39], v10, s[20:23], s58 offen offset:2048 sc1
Mvaa 152,248,48
Mvaa 184,248,52
Mvaa 216,248,56
buffer_load_dwordx4 a[40:43], v11, s[20:23], 0 offen offset:2048 sc1
Mvaa 248,248,60
Mvaa 156,252,48
Mvaa 188,252,52
buffer_load_dwordx4 a[44:47], v11, s[20:23], s58 offen offset:2048 sc1
Mvaa 220,252,56
Mvaa 252,252,60
s_waitcnt vmcnt(39) lgkmcnt(0)
Mvaa 128,192,64
s_add_u32 s37, s38, 8192
Mvaa 160,192,68
Ta 224,16,40960
Ta 226,16,41984
Mvaa 192,192,72
buffer_load_dwordx4 a[48:51], v10, s[20:23], 0 offen offset:3072 sc1
Mvaa 224,192,76
buffer_store_dwordx4 v[56:59], v2, s[24:27], s37 offen offset:0 sc1
Mvaa 132,196,64
Ta 228,17,40960
Ta 230,17,41984
Mvaa 164,196,68
Ar 48,128
Ar 49,129
Mvaa 196,196,72
Ar 50,130
Ar 51,131
Mvaa 228,196,76
Ta 232,18,40960
Ta 234,18,41984
Mvaa 136,200,64
Ar 52,132
Ar 53,133
Mvaa 168,200,68
buffer_load_dwordx4 a[52:55], v10, s[20:23], s58 offen offset:3072 sc1
Mvaa 200,200,72
Ta 236,19,40960
Ta 238,19,41984
Mvaa 232,200,76
Ar 54,134
Ar 55,135
Mvaa 140,204,64
Vc 24,48,49
Vc 25,50,51
Mvaa 172,204,68
Ta 240,20,40960
Ta 242,20,41984
Mvaa 204,204,72
Vc 26,52,53
Vc 27,54,55
Mvaa 236,204,76
Mvaa 144,208,64
s_waitcnt lgkmcnt(6)
Ta 244,21,40960
Ta 246,21,41984
Mvaa 176,208,68
buffer_store_dwordx4 v[60:63], v2, s[24:27], s37 offen offset:1024 sc1
Mvaa 208,208,72
buffer_load_dwordx4 a[56:59], v11, s[20:23], 0 offen offset:3072 sc1
Mvaa 240,208,76
Ta 248,22,40960
Ta 250,22,41984
Mvaa 148,212,64
Ar 48,136
Ar 49,137
Mvaa 180,212,68
Ar 50,138
Ar 51,139
Mvaa 212,212,72
Ta 252,23,40960
Ta 254,23,41984
Mvaa 244,212,76
Ar 52,140
Ar 53,141
Mvaa 152,216,64
Ar 54,142
Ar 55,143
Mvaa 184,216,68
Vc 28,48,49
Vc 29,50,51
Mvaa 216,216,72
buffer_load_dwordx4 a[60:63], v11, s[20:23], s58 offen offset:3072 sc1
v_add_u32 v10, 4096, v10
v_add_u32 v11, 4096, v11
Mvaa 248,216,76
Vc 30,52,53
Vc 31,54,55
Mvaa 156,220,64
Mvaa 188,220,68
Mvaa 220,220,72
Mvaa 252,220,76
s_waitcnt vmcnt(40) lgkmcnt(0)
s_barrier
Mvaa 128,224,80
buffer_store_dwordx4 v[64:67], v2, s[24:27], s37 offen offset:2048 sc1
Mvaa 160,224,84
s_add_u32 m0, s44, 32768
Ta 192,16,49152
Ta 194,16,50176
Mvaa 192,224,88
buffer_load_dwordx4 v8, s[8:11], s48 offen offset:0 lds
Mvaa 224,224,92
Ar 48,144
Ar 49,145
Mvaa 132,228,80
Ta 196,17,49152
Ta 198,17,50176
Mvaa 164,228,84
buffer_load_dwordx4 v8, s[8:11], s49 offen offset:1024 lds
Mvaa 196,228,88
Ar 50,146
Ar 51,147
Mvaa 228,228,92
Ta 200,18,49152
Ta 202,18,50176
Mvaa 136,232,80
Ar 52,148
Ar 53,149
Mvaa 168,232,84
buffer_load_dwordx4 v9, s[8:11], s50 offen offset:2048 lds
Mvaa 200,232,88
Ta 204,19,49152
Ta 206,19,50176
Mvaa 232,232,92
Ar 54,150
Ar 55,151
Mvaa 140,236,80
Vc 32,48,49
Vc 33,50,51
Mvaa 172,236,84
Ta 208,20,49152
Ta 210,20,50176
Mvaa 204,236,88
buffer_load_dwordx4 v9, s[8:11], s51 offen offset:3072 lds
v_add_u32 v8, 524288, v8
v_add_u32 v9, 524288, v9
Mvaa 236,236,92
Vc 34,52,53
Vc 35,54,55
Mvaa 144,240,80
s_waitcnt lgkmcnt(6)
Ta 212,21,49152
Ta 214,21,50176
Mvaa 176,240,84
buffer_store_dwordx4 v[68:71], v2, s[24:27], s37 offen offset:3072 sc1
Mvaa 208,240,88
buffer_load_dwordx4 a[64:67], v10, s[20:23], 0 offen offset:0 sc1
Mvaa 240,240,92
Ta 216,22,49152
Ta 218,22,50176
Mvaa 148,244,80
Ar 48,152
Ar 49,153
Mvaa 180,244,84
Ar 50,154
Ar 51,155
Mvaa 212,244,88
Ta 220,23,49152
Ta 222,23,50176
Mvaa 244,244,92
buffer_load_dwordx4 a[68:71], v10, s[20:23], s58 offen offset:0 sc1
Mvaa 152,248,80
Ar 52,156
Ar 53,157
Mvaa 184,248,84
Ar 54,158
Ar 55,159
Mvaa 216,248,88
buffer_load_dwordx4 a[72:75], v11, s[20:23], 0 offen offset:0 sc1
Mvaa 248,248,92
Vc 36,48,49
Vc 37,50,51
Mvaa 156,252,80
Vc 38,52,53
Vc 39,54,55
Mvaa 188,252,84
buffer_load_dwordx4 a[76:79], v11, s[20:23], s58 offen offset:0 sc1
Mvaa 220,252,88
Mvaa 252,252,92
s_waitcnt vmcnt(40) lgkmcnt(0)
Mvaa 128,192,96
s_add_u32 s37, s38, 12288
Mvaa 160,192,100
Ta 224,16,57344
Ta 226,16,58368
Mvaa 192,192,104
buffer_load_dwordx4 a[80:83], v10, s[20:23], 0 offen offset:1024 sc1
Mvaa 224,192,108
buffer_store_dwordx4 v[72:75], v2, s[24:27], s37 offen offset:0 sc1
Mvaa 132,196,96
Ta 228,17,57344
Ta 230,17,58368
Mvaa 164,196,100
Ar 48,160
Ar 49,161
Mvaa 196,196,104
Ar 50,162
Ar 51,163
Mvaa 228,196,108
Ta 232,18,57344
Ta 234,18,58368
Mvaa 136,200,96
Ar 52,164
Ar 53,165
Mvaa 168,200,100
buffer_load_dwordx4 a[84:87], v10, s[20:23], s58 offen offset:1024 sc1
Mvaa 200,200,104
Ta 236,19,57344
Ta 238,19,58368
Mvaa 232,200,108
Ar 54,166
Ar 55,167
Mvaa 140,204,96
Vc 40,48,49
Vc 41,50,51
Mvaa 172,204,100
Ta 240,20,57344
Ta 242,20,58368
Mvaa 204,204,104
Vc 42,52,53
Vc 43,54,55
Mvaa 236,204,108
Mvaa 144,208,96
s_waitcnt lgkmcnt(6)
Ta 244,21,57344
Ta 246,21,58368
Mvaa 176,208,100
buffer_store_dwordx4 v[76:79], v2, s[24:27], s37 offen offset:1024 sc1
Mvaa 208,208,104
buffer_load_dwordx4 a[88:91], v11, s[20:23], 0 offen offset:1024 sc1
Mvaa 240,208,108
Ta 248,22,57344
Ta 250,22,58368
Mvaa 148,212,96
Ar 48,168
Ar 49,169
Mvaa 180,212,100
Ar 50,170
Ar 51,171
Mvaa 212,212,104
Ta 252,23,57344
Ta 254,23,58368
Mvaa 244,212,108
Ar 52,172
Ar 53,173
Mvaa 152,216,96
Ar 54,174
Ar 55,175
Mvaa 184,216,100
Vc 44,48,49
Vc 45,50,51
Mvaa 216,216,104
buffer_load_dwordx4 a[92:95], v11, s[20:23], s58 offen offset:1024 sc1
Mvaa 248,216,108
Vc 46,52,53
Vc 47,54,55
Mvaa 156,220,96
Mvaa 188,220,100
Mvaa 220,220,104
Mvaa 252,220,108
s_waitcnt vmcnt(42) lgkmcnt(0)
s_barrier
Mvaa 128,224,112
buffer_store_dwordx4 v[80:83], v2, s[24:27], s37 offen offset:2048 sc1
Mvaa 160,224,116
s_add_u32 m0, s44, 49152
Ta 192,16,0
Ta 194,16,1024
Mvaa 192,224,120
buffer_load_dwordx4 v8, s[8:11], s48 offen offset:0 lds
Mvaa 224,224,124
Mvaa 132,228,112
Ta 196,17,0
Ta 198,17,1024
Mvaa 164,228,116
buffer_load_dwordx4 v8, s[8:11], s49 offen offset:1024 lds
Mvaa 196,228,120
Mvaa 228,228,124
Ta 200,18,0
Ta 202,18,1024
Mvaa 136,232,112
Mvaa 168,232,116
buffer_load_dwordx4 v9, s[8:11], s50 offen offset:2048 lds
Mvaa 200,232,120
Ta 204,19,0
Ta 206,19,1024
Mvaa 232,232,124
Mvaa 140,236,112
Mvaa 172,236,116
Ta 208,20,0
Ta 210,20,1024
Mvaa 204,236,120
buffer_load_dwordx4 v9, s[8:11], s51 offen offset:3072 lds
v_add_u32 v8, 524288, v8
v_add_u32 v9, 524288, v9
Mvaa 236,236,124
Mvaa 144,240,112
s_waitcnt lgkmcnt(6)
Ta 212,21,0
Ta 214,21,1024
Mvaa 176,240,116
buffer_store_dwordx4 v[84:87], v2, s[24:27], s37 offen offset:3072 sc1
Mvaa 208,240,120
buffer_load_dwordx4 a[96:99], v10, s[20:23], 0 offen offset:2048 sc1
Mvaa 240,240,124
Ta 216,22,0
Ta 218,22,1024
Mvaa 148,244,112
Mvaa 180,244,116
Mvaa 212,244,120
Ta 220,23,0
Ta 222,23,1024
Mvaa 244,244,124
buffer_load_dwordx4 a[100:103], v10, s[20:23], s58 offen offset:2048 sc1
Mvaa 152,248,112
Mvaa 184,248,116
Mvaa 216,248,120
buffer_load_dwordx4 a[104:107], v11, s[20:23], 0 offen offset:2048 sc1
Mvaa 248,248,124
Mvaa 156,252,112
Mvaa 188,252,116
buffer_load_dwordx4 a[108:111], v11, s[20:23], s58 offen offset:2048 sc1
Mvaa 220,252,120
Mvaa 252,252,124
s_waitcnt vmcnt(47) lgkmcnt(0)
Mvaa 128,192,0
s_add_u32 s37, s38, 34816
Mvaa 160,192,4
Ta 224,16,8192
Ta 226,16,9216
Mvaa 192,192,8
buffer_load_dwordx4 a[112:115], v10, s[20:23], 0 offen offset:3072 sc1
Mvaa 224,192,12
buffer_store_dwordx4 v[88:91], v2, s[24:27], s37 offen offset:0 sc1
Mvaa 132,196,0
Ta 228,17,8192
Ta 230,17,9216
Mvaa 164,196,4
Mvaa 196,196,8
Mvaa 228,196,12
Ta 232,18,8192
Ta 234,18,9216
Mvaa 136,200,0
Mvaa 168,200,4
buffer_load_dwordx4 a[116:119], v10, s[20:23], s58 offen offset:3072 sc1
Mvaa 200,200,8
Ta 236,19,8192
Ta 238,19,9216
Mvaa 232,200,12
Mvaa 140,204,0
Mvaa 172,204,4
Ta 240,20,8192
Ta 242,20,9216
Mvaa 204,204,8
Mvaa 236,204,12
Mvaa 144,208,0
s_waitcnt lgkmcnt(6)
Ta 244,21,8192
Ta 246,21,9216
Mvaa 176,208,4
buffer_store_dwordx4 v[92:95], v2, s[24:27], s37 offen offset:1024 sc1
Mvaa 208,208,8
buffer_load_dwordx4 a[120:123], v11, s[20:23], 0 offen offset:3072 sc1
Mvaa 240,208,12
Ta 248,22,8192
Ta 250,22,9216
Mvaa 148,212,0
s_mov_b32 s3, 5242880
s_mov_b32 s47, 5246976
Mvaa 180,212,4
buffer_load_dwordx4 v[56:59], v2, s[20:23], s3 offen offset:0 sc1
Mvaa 212,212,8
Ta 252,23,8192
Ta 254,23,9216
Mvaa 244,212,12
buffer_load_dwordx4 v[60:63], v2, s[20:23], s3 offen offset:1024 sc1
Mvaa 152,216,0
buffer_load_dwordx4 v[64:67], v2, s[20:23], s3 offen offset:2048 sc1
Mvaa 184,216,4
buffer_load_dwordx4 v[68:71], v2, s[20:23], s3 offen offset:3072 sc1
Mvaa 216,216,8
buffer_load_dwordx4 a[124:127], v11, s[20:23], s58 offen offset:3072 sc1
v_add_u32 v10, 4096, v10
v_add_u32 v11, 4096, v11
Mvaa 248,216,12
buffer_load_dwordx4 v[72:75], v2, s[20:23], s47 offen offset:0 sc1
Mvaa 156,220,0
buffer_load_dwordx4 v[76:79], v2, s[20:23], s47 offen offset:1024 sc1
Mvaa 188,220,4
buffer_load_dwordx4 v[80:83], v2, s[20:23], s47 offen offset:2048 sc1
Mvaa 220,220,8
buffer_load_dwordx4 v[84:87], v2, s[20:23], s47 offen offset:3072 sc1
Mvaa 252,220,12
s_waitcnt vmcnt(51) lgkmcnt(0)
s_barrier
Mvaa 128,224,16
buffer_store_dwordx4 v[96:99], v2, s[24:27], s37 offen offset:2048 sc1
Mvaa 160,224,20
s_add_u32 m0, s44, 0
Ta 192,16,16384
Ta 194,16,17408
Mvaa 192,224,24
buffer_load_dwordx4 v8, s[8:11], s48 offen offset:0 lds
Mvaa 224,224,28
Mvaa 132,228,16
Ta 196,17,16384
Ta 198,17,17408
Mvaa 164,228,20
buffer_load_dwordx4 v8, s[8:11], s49 offen offset:1024 lds
Mvaa 196,228,24
Mvaa 228,228,28
Ta 200,18,16384
Ta 202,18,17408
Mvaa 136,232,16
Mvaa 168,232,20
buffer_load_dwordx4 v9, s[8:11], s50 offen offset:2048 lds
Mvaa 200,232,24
Ta 204,19,16384
Ta 206,19,17408
Mvaa 232,232,28
Mvaa 140,236,16
Mvaa 172,236,20
Ta 208,20,16384
Ta 210,20,17408
Mvaa 204,236,24
buffer_load_dwordx4 v9, s[8:11], s51 offen offset:3072 lds
v_add_u32 v8, 524288, v8
v_add_u32 v9, 524288, v9
Mvaa 236,236,28
Mvaa 144,240,16
s_waitcnt lgkmcnt(6)
Ta 212,21,16384
Ta 214,21,17408
Mvaa 176,240,20
buffer_store_dwordx4 v[100:103], v2, s[24:27], s37 offen offset:3072 sc1
Mvaa 208,240,24
buffer_load_dwordx4 a[0:3], v10, s[20:23], 0 offen offset:0 sc1
Mvaa 240,240,28
Ta 216,22,16384
Ta 218,22,17408
Mvaa 148,244,16
Mvaa 180,244,20
Mvaa 212,244,24
Ta 220,23,16384
Ta 222,23,17408
Mvaa 244,244,28
buffer_load_dwordx4 a[4:7], v10, s[20:23], s58 offen offset:0 sc1
Mvaa 152,248,16
Mvaa 184,248,20
Mvaa 216,248,24
buffer_load_dwordx4 a[8:11], v11, s[20:23], 0 offen offset:0 sc1
Mvaa 248,248,28
Mvaa 156,252,16
Mvaa 188,252,20
buffer_load_dwordx4 a[12:15], v11, s[20:23], s58 offen offset:0 sc1
Mvaa 220,252,24
Mvaa 252,252,28
s_waitcnt vmcnt(56) lgkmcnt(0)
Mvaa 128,192,32
s_add_u32 s37, s38, 38912
Mvaa 160,192,36
Ta 224,16,24576
Ta 226,16,25600
Mvaa 192,192,40
buffer_load_dwordx4 a[16:19], v10, s[20:23], 0 offen offset:1024 sc1
Mvaa 224,192,44
buffer_store_dwordx4 v[104:107], v2, s[24:27], s37 offen offset:0 sc1
Mvaa 132,196,32
Ta 228,17,24576
Ta 230,17,25600
Mvaa 164,196,36
Mvaa 196,196,40
Mvaa 228,196,44
Ta 232,18,24576
Ta 234,18,25600
Mvaa 136,200,32
Mvaa 168,200,36
buffer_load_dwordx4 a[20:23], v10, s[20:23], s58 offen offset:1024 sc1
Mvaa 200,200,40
Ta 236,19,24576
Ta 238,19,25600
Mvaa 232,200,44
Mvaa 140,204,32
Mvaa 172,204,36
Ta 240,20,24576
Ta 242,20,25600
Mvaa 204,204,40
Mvaa 236,204,44
Mvaa 144,208,32
s_waitcnt lgkmcnt(6)
Ta 244,21,24576
Ta 246,21,25600
Mvaa 176,208,36
buffer_store_dwordx4 v[108:111], v2, s[24:27], s37 offen offset:1024 sc1
Mvaa 208,208,40
buffer_load_dwordx4 a[24:27], v11, s[20:23], 0 offen offset:1024 sc1
Mvaa 240,208,44
Ta 248,22,24576
Ta 250,22,25600
Mvaa 148,212,32
Mvaa 180,212,36
Mvaa 212,212,40
Ta 252,23,24576
Ta 254,23,25600
Mvaa 244,212,44
Mvaa 152,216,32
Mvaa 184,216,36
Mvaa 216,216,40
buffer_load_dwordx4 a[28:31], v11, s[20:23], s58 offen offset:1024 sc1
Mvaa 248,216,44
Mvaa 156,220,32
Mvaa 188,220,36
Mvaa 220,220,40
Mvaa 252,220,44
s_waitcnt vmcnt(51) lgkmcnt(0)
s_barrier
Mvaa 128,224,48
buffer_store_dwordx4 v[112:115], v2, s[24:27], s37 offen offset:2048 sc1
Mvaa 160,224,52
s_add_u32 m0, s44, 16384
Ta 192,16,32768
Ta 194,16,33792
Mvaa 192,224,56
buffer_load_dwordx4 v8, s[8:11], s48 offen offset:0 lds
Mvaa 224,224,60
Mvaa 132,228,48
Ta 196,17,32768
Ta 198,17,33792
Mvaa 164,228,52
buffer_load_dwordx4 v8, s[8:11], s49 offen offset:1024 lds
Mvaa 196,228,56
Mvaa 228,228,60
Ta 200,18,32768
Ta 202,18,33792
Mvaa 136,232,48
Mvaa 168,232,52
buffer_load_dwordx4 v9, s[8:11], s50 offen offset:2048 lds
Mvaa 200,232,56
Ta 204,19,32768
Ta 206,19,33792
Mvaa 232,232,60
Mvaa 140,236,48
Mvaa 172,236,52
Ta 208,20,32768
Ta 210,20,33792
Mvaa 204,236,56
buffer_load_dwordx4 v9, s[8:11], s51 offen offset:3072 lds
v_add_u32 v8, 524288, v8
v_add_u32 v9, 524288, v9
Mvaa 236,236,60
Mvaa 144,240,48
s_waitcnt lgkmcnt(6)
Ta 212,21,32768
Ta 214,21,33792
Mvaa 176,240,52
buffer_store_dwordx4 v[116:119], v2, s[24:27], s37 offen offset:3072 sc1
Mvaa 208,240,56
buffer_load_dwordx4 a[32:35], v10, s[20:23], 0 offen offset:2048 sc1
Mvaa 240,240,60
Ta 216,22,32768
Ta 218,22,33792
Mvaa 148,244,48
Mvaa 180,244,52
Mvaa 212,244,56
Ta 220,23,32768
Ta 222,23,33792
Mvaa 244,244,60
buffer_load_dwordx4 a[36:39], v10, s[20:23], s58 offen offset:2048 sc1
Mvaa 152,248,48
Mvaa 184,248,52
Mvaa 216,248,56
buffer_load_dwordx4 a[40:43], v11, s[20:23], 0 offen offset:2048 sc1
Mvaa 248,248,60
Mvaa 156,252,48
Mvaa 188,252,52
buffer_load_dwordx4 a[44:47], v11, s[20:23], s58 offen offset:2048 sc1
Mvaa 220,252,56
Mvaa 252,252,60
s_waitcnt vmcnt(56) lgkmcnt(0)
Mvaa 128,192,64
s_add_u32 s37, s38, 43008
Mvaa 160,192,68
Ta 224,16,40960
Ta 226,16,41984
Mvaa 192,192,72
buffer_load_dwordx4 a[48:51], v10, s[20:23], 0 offen offset:3072 sc1
Mvaa 224,192,76
buffer_store_dwordx4 v[120:123], v2, s[24:27], s37 offen offset:0 sc1
Mvaa 132,196,64
Ta 228,17,40960
Ta 230,17,41984
Mvaa 164,196,68
Mvaa 196,196,72
Mvaa 228,196,76
Ta 232,18,40960
Ta 234,18,41984
Mvaa 136,200,64
Mvaa 168,200,68
buffer_load_dwordx4 a[52:55], v10, s[20:23], s58 offen offset:3072 sc1
Mvaa 200,200,72
Ta 236,19,40960
Ta 238,19,41984
Mvaa 232,200,76
Mvaa 140,204,64
Mvaa 172,204,68
Ta 240,20,40960
Ta 242,20,41984
Mvaa 204,204,72
Mvaa 236,204,76
Mvaa 144,208,64
s_waitcnt lgkmcnt(6)
Ta 244,21,40960
Ta 246,21,41984
Mvaa 176,208,68
buffer_store_dwordx4 v[124:127], v2, s[24:27], s37 offen offset:1024 sc1
Mvaa 208,208,72
buffer_load_dwordx4 a[56:59], v11, s[20:23], 0 offen offset:3072 sc1
Mvaa 240,208,76
Ta 248,22,40960
Ta 250,22,41984
Mvaa 148,212,64
Mvaa 180,212,68
Mvaa 212,212,72
Ta 252,23,40960
Ta 254,23,41984
Mvaa 244,212,76
Mvaa 152,216,64
Mvaa 184,216,68
Mvaa 216,216,72
buffer_load_dwordx4 a[60:63], v11, s[20:23], s58 offen offset:3072 sc1
v_add_u32 v10, 4096, v10
v_add_u32 v11, 4096, v11
Mvaa 248,216,76
Mvaa 156,220,64
Mvaa 188,220,68
Mvaa 220,220,72
Mvaa 252,220,76
s_waitcnt vmcnt(51) lgkmcnt(0)
s_barrier
Mvaa 128,224,80
buffer_store_dwordx4 v[24:27], v2, s[24:27], s37 offen offset:2048 sc1
Mvaa 160,224,84
s_add_u32 m0, s44, 32768
Ta 192,16,49152
Ta 194,16,50176
Mvaa 192,224,88
buffer_load_dwordx4 v8, s[8:11], s48 offen offset:0 lds
Mvaa 224,224,92
Mvaa 132,228,80
Ta 196,17,49152
Ta 198,17,50176
Mvaa 164,228,84
buffer_load_dwordx4 v8, s[8:11], s49 offen offset:1024 lds
Mvaa 196,228,88
Mvaa 228,228,92
Ta 200,18,49152
Ta 202,18,50176
Mvaa 136,232,80
Mvaa 168,232,84
buffer_load_dwordx4 v9, s[8:11], s50 offen offset:2048 lds
Mvaa 200,232,88
Ta 204,19,49152
Ta 206,19,50176
Mvaa 232,232,92
Mvaa 140,236,80
Mvaa 172,236,84
Ta 208,20,49152
Ta 210,20,50176
Mvaa 204,236,88
buffer_load_dwordx4 v9, s[8:11], s51 offen offset:3072 lds
v_add_u32 v8, 524288, v8
v_add_u32 v9, 524288, v9
Mvaa 236,236,92
Mvaa 144,240,80
s_waitcnt lgkmcnt(6)
Ta 212,21,49152
Ta 214,21,50176
Mvaa 176,240,84
buffer_store_dwordx4 v[28:31], v2, s[24:27], s37 offen offset:3072 sc1
Mvaa 208,240,88
buffer_load_dwordx4 a[64:67], v10, s[20:23], 0 offen offset:0 sc1
Mvaa 240,240,92
Ta 216,22,49152
Ta 218,22,50176
Mvaa 148,244,80
Mvaa 180,244,84
Mvaa 212,244,88
Ta 220,23,49152
Ta 222,23,50176
Mvaa 244,244,92
buffer_load_dwordx4 a[68:71], v10, s[20:23], s58 offen offset:0 sc1
Mvaa 152,248,80
Mvaa 184,248,84
Mvaa 216,248,88
buffer_load_dwordx4 a[72:75], v11, s[20:23], 0 offen offset:0 sc1
Mvaa 248,248,92
Mvaa 156,252,80
Mvaa 188,252,84
buffer_load_dwordx4 a[76:79], v11, s[20:23], s58 offen offset:0 sc1
Mvaa 220,252,88
Mvaa 252,252,92
s_waitcnt vmcnt(56) lgkmcnt(0)
Mvaa 128,192,96
s_add_u32 s37, s38, 47104
Mvaa 160,192,100
Ta 224,16,57344
Ta 226,16,58368
Mvaa 192,192,104
buffer_load_dwordx4 a[80:83], v10, s[20:23], 0 offen offset:1024 sc1
Mvaa 224,192,108
buffer_store_dwordx4 v[32:35], v2, s[24:27], s37 offen offset:0 sc1
Mvaa 132,196,96
Ta 228,17,57344
Ta 230,17,58368
Mvaa 164,196,100
Mvaa 196,196,104
Mvaa 228,196,108
Ta 232,18,57344
Ta 234,18,58368
Mvaa 136,200,96
Mvaa 168,200,100
buffer_load_dwordx4 a[84:87], v10, s[20:23], s58 offen offset:1024 sc1
Mvaa 200,200,104
Ta 236,19,57344
Ta 238,19,58368
Mvaa 232,200,108
Mvaa 140,204,96
Mvaa 172,204,100
Ta 240,20,57344
Ta 242,20,58368
Mvaa 204,204,104
Mvaa 236,204,108
Mvaa 144,208,96
s_waitcnt lgkmcnt(6)
Ta 244,21,57344
Ta 246,21,58368
Mvaa 176,208,100
buffer_store_dwordx4 v[36:39], v2, s[24:27], s37 offen offset:1024 sc1
Mvaa 208,208,104
buffer_load_dwordx4 a[88:91], v11, s[20:23], 0 offen offset:1024 sc1
Mvaa 240,208,108
Ta 248,22,57344
Ta 250,22,58368
Mvaa 148,212,96
Mvaa 180,212,100
Mvaa 212,212,104
Ta 252,23,57344
Ta 254,23,58368
Mvaa 244,212,108
Mvaa 152,216,96
Mvaa 184,216,100
Mvaa 216,216,104
buffer_load_dwordx4 a[92:95], v11, s[20:23], s58 offen offset:1024 sc1
Mvaa 248,216,108
Mvaa 156,220,96
Mvaa 188,220,100
Mvaa 220,220,104
Mvaa 252,220,108
s_waitcnt vmcnt(43) lgkmcnt(0)
s_barrier
Mvaa 128,224,112
buffer_store_dwordx4 v[40:43], v2, s[24:27], s37 offen offset:2048 sc1
Mvaa 160,224,116
s_add_u32 m0, s44, 49152
Ta 192,16,0
Ta 194,16,1024
Mvaa 192,224,120
buffer_load_dwordx4 v8, s[8:11], s48 offen offset:0 lds
Mvaa 224,224,124
Mvaa 132,228,112
Ta 196,17,0
Ta 198,17,1024
Mvaa 164,228,116
buffer_load_dwordx4 v8, s[8:11], s49 offen offset:1024 lds
Mvaa 196,228,120
Mvaa 228,228,124
Ta 200,18,0
Ta 202,18,1024
Mvaa 136,232,112
Mvaa 168,232,116
buffer_load_dwordx4 v9, s[8:11], s50 offen offset:2048 lds
Mvaa 200,232,120
Ta 204,19,0
Ta 206,19,1024
Mvaa 232,232,124
Mvaa 140,236,112
Mvaa 172,236,116
Ta 208,20,0
Ta 210,20,1024
Mvaa 204,236,120
buffer_load_dwordx4 v9, s[8:11], s51 offen offset:3072 lds
v_add_u32 v8, 524288, v8
v_add_u32 v9, 524288, v9
Mvaa 236,236,124
Mvaa 144,240,112
s_waitcnt lgkmcnt(6)
Ta 212,21,0
Ta 214,21,1024
Mvaa 176,240,116
buffer_store_dwordx4 v[44:47], v2, s[24:27], s37 offen offset:3072 sc1
Mvaa 208,240,120
buffer_load_dwordx4 a[96:99], v10, s[20:23], 0 offen offset:2048 sc1
Mvaa 240,240,124
Ta 216,22,0
Ta 218,22,1024
Mvaa 148,244,112
v_mov_b32 v12, 1
v_and_b32_e64 v1, 15, v0
Mvaa 180,244,116
v_lshlrev_b32_e64 v1, 2, v1
Mvaa 212,244,120
Ta 220,23,0
Ta 222,23,1024
Mvaa 244,244,124
buffer_load_dwordx4 a[100:103], v10, s[20:23], s58 offen offset:2048 sc1
Mvaa 152,248,112
s_lshr_b32 s6, s33, 1
s_lshl_b32 s6, s6, 7
s_add_u32 s6, s6, 5296128
Mvaa 184,248,116
s_cmp_eq_u32 s32, 0
s_cselect_b32 s6, s6, 2146435072
Mvaa 216,248,120
buffer_load_dwordx4 a[104:107], v11, s[20:23], 0 offen offset:2048 sc1
Mvaa 248,248,124
Mvaa 156,252,112
Mvaa 188,252,116
buffer_load_dwordx4 a[108:111], v11, s[20:23], s58 offen offset:2048 sc1
Mvaa 220,252,120
Mvaa 252,252,124
s_waitcnt vmcnt(48) lgkmcnt(0)
Mvaa 128,192,0
Mvaa 160,192,4
Ta 224,16,8192
Ta 226,16,9216
Mvaa 192,192,8
buffer_load_dwordx4 a[112:115], v10, s[20:23], 0 offen offset:3072 sc1
Mvaa 224,192,12
Mvaa 132,196,0
Ta 228,17,8192
Ta 230,17,9216
Mvaa 164,196,4
Mvaa 196,196,8
Mvaa 228,196,12
Ta 232,18,8192
Ta 234,18,9216
Mvaa 136,200,0
Mvaa 168,200,4
buffer_load_dwordx4 a[116:119], v10, s[20:23], s58 offen offset:3072 sc1
Mvaa 200,200,8
Ta 236,19,8192
Ta 238,19,9216
Mvaa 232,200,12
Mvaa 140,204,0
Mvaa 172,204,4
Ta 240,20,8192
Ta 242,20,9216
Mvaa 204,204,8
Mvaa 236,204,12
Mvaa 144,208,0
s_waitcnt lgkmcnt(6)
Ta 244,21,8192
Ta 246,21,9216
Mvaa 176,208,4
v_max_u32 v14, v56, v57
v_min_u32_e64 v15, v56, v57
Mvaa 208,208,8
buffer_load_dwordx4 a[120:123], v11, s[20:23], 0 offen offset:3072 sc1
Mvaa 240,208,12
Ta 248,22,8192
Ta 250,22,9216
Mvaa 148,212,0
v_med3_u32 v15, v14, v15, v58
v_max_u32_e64 v14, v14, v58
Mvaa 180,212,4
v_med3_u32 v15, v14, v15, v59
v_max_u32_e64 v14, v14, v59
Mvaa 212,212,8
Ta 252,23,8192
Ta 254,23,9216
Mvaa 244,212,12
v_med3_u32 v15, v14, v15, v60
v_max_u32_e64 v14, v14, v60
Mvaa 152,216,0
v_med3_u32 v15, v14, v15, v61
v_max_u32_e64 v14, v14, v61
Mvaa 184,216,4
v_med3_u32 v15, v14, v15, v62
v_max_u32_e64 v14, v14, v62
Mvaa 216,216,8
buffer_load_dwordx4 a[124:127], v11, s[20:23], s58 offen offset:3072 sc1
v_add_u32 v10, 4096, v10
v_add_u32 v11, 4096, v11
Mvaa 248,216,12
v_med3_u32 v15, v14, v15, v63
v_max_u32_e64 v14, v14, v63
Mvaa 156,220,0
v_med3_u32 v15, v14, v15, v64
v_max_u32_e64 v14, v14, v64
Mvaa 188,220,4
v_med3_u32 v15, v14, v15, v65
v_max_u32_e64 v14, v14, v65
Mvaa 220,220,8
v_med3_u32 v15, v14, v15, v66
v_max_u32_e64 v14, v14, v66
Mvaa 252,220,12
v_med3_u32 v15, v14, v15, v67
v_max_u32 v14, v14, v67
s_waitcnt vmcnt(41) lgkmcnt(0)
s_barrier
Mvaa 128,224,16
v_med3_u32 v15, v14, v15, v68
v_max_u32 v14, v14, v68
Mvaa 160,224,20
s_add_u32 m0, s44, 0
Ta 192,16,16384
Ta 194,16,17408
Mvaa 192,224,24
buffer_load_dwordx4 v8, s[8:11], s48 offen offset:0 lds
Mvaa 224,224,28
v_med3_u32 v15, v14, v15, v69
v_max_u32 v14, v14, v69
Mvaa 132,228,16
Ta 196,17,16384
Ta 198,17,17408
Mvaa 164,228,20
buffer_load_dwordx4 v8, s[8:11], s49 offen offset:1024 lds
Mvaa 196,228,24
v_med3_u32 v15, v14, v15, v70
v_max_u32_e64 v14, v14, v70
Mvaa 228,228,28
Ta 200,18,16384
Ta 202,18,17408
Mvaa 136,232,16
v_med3_u32 v15, v14, v15, v71
v_max_u32_e64 v14, v14, v71
Mvaa 168,232,20
buffer_load_dwordx4 v9, s[8:11], s50 offen offset:2048 lds
Mvaa 200,232,24
Ta 204,19,16384
Ta 206,19,17408
Mvaa 232,232,28
v_med3_u32 v15, v14, v15, v72
v_max_u32_e64 v14, v14, v72
Mvaa 140,236,16
v_med3_u32 v15, v14, v15, v73
v_max_u32_e64 v14, v14, v73
Mvaa 172,236,20
Ta 208,20,16384
Ta 210,20,17408
Mvaa 204,236,24
buffer_load_dwordx4 v9, s[8:11], s51 offen offset:3072 lds
v_add_u32 v8, 524288, v8
v_add_u32 v9, 524288, v9
Mvaa 236,236,28
v_med3_u32 v15, v14, v15, v74
v_max_u32_e64 v14, v14, v74
Mvaa 144,240,16
s_waitcnt lgkmcnt(6)
Ta 212,21,16384
Ta 214,21,17408
Mvaa 176,240,20
v_med3_u32 v15, v14, v15, v75
v_max_u32 v14, v14, v75
Mvaa 208,240,24
buffer_load_dwordx4 a[0:3], v10, s[20:23], 0 offen offset:0 sc1
Mvaa 240,240,28
Ta 216,22,16384
Ta 218,22,17408
Mvaa 148,244,16
v_med3_u32 v15, v14, v15, v76
v_max_u32_e64 v14, v14, v76
Mvaa 180,244,20
v_med3_u32 v15, v14, v15, v77
v_max_u32_e64 v14, v14, v77
Mvaa 212,244,24
Ta 220,23,16384
Ta 222,23,17408
Mvaa 244,244,28
buffer_load_dwordx4 a[4:7], v10, s[20:23], s58 offen offset:0 sc1
Mvaa 152,248,16
v_med3_u32 v15, v14, v15, v78
v_max_u32_e64 v14, v14, v78
Mvaa 184,248,20
v_med3_u32 v15, v14, v15, v79
v_max_u32_e64 v14, v14, v79
Mvaa 216,248,24
buffer_load_dwordx4 a[8:11], v11, s[20:23], 0 offen offset:0 sc1
Mvaa 248,248,28
v_med3_u32 v15, v14, v15, v80
v_max_u32_e64 v14, v14, v80
Mvaa 156,252,16
v_med3_u32 v15, v14, v15, v81
v_max_u32_e64 v14, v14, v81
Mvaa 188,252,20
buffer_load_dwordx4 a[12:15], v11, s[20:23], s58 offen offset:0 sc1
Mvaa 220,252,24
v_med3_u32 v15, v14, v15, v82
v_max_u32_e64 v14, v14, v82
Mvaa 252,252,28
v_med3_u32 v15, v14, v15, v83
v_max_u32 v14, v14, v83
s_waitcnt vmcnt(44) lgkmcnt(0)
Mvaa 128,192,32
v_med3_u32 v15, v14, v15, v84
v_max_u32_e64 v14, v14, v84
Mvaa 160,192,36
Ta 224,16,24576
Ta 226,16,25600
Mvaa 192,192,40
buffer_load_dwordx4 a[16:19], v10, s[20:23], 0 offen offset:1024 sc1
Mvaa 224,192,44
v_med3_u32 v15, v14, v15, v85
v_max_u32_e64 v14, v14, v85
Mvaa 132,196,32
Ta 228,17,24576
Ta 230,17,25600
Mvaa 164,196,36
v_med3_u32 v15, v14, v15, v86
v_max_u32_e64 v14, v14, v86
Mvaa 196,196,40
v_med3_u32 v15, v14, v15, v87
v_max_u32_e64 v14, v14, v87
Mvaa 228,196,44
Ta 232,18,24576
Ta 234,18,25600
Mvaa 136,200,32
v_mov_b32_e64 v13, v14
Mvaa 168,200,36
buffer_load_dwordx4 a[20:23], v10, s[20:23], s58 offen offset:1024 sc1
Mvaa 200,200,40
Ta 236,19,24576
Ta 238,19,25600
Mvaa 232,200,44
v_max_u32_dpp v13, v13, v13 quad_perm:[1,0,3,2] row_mask:0xf bank_mask:0xf
Mvaa 140,204,32
s_nop 0
v_max_u32_dpp v13, v13, v13 quad_perm:[2,3,0,1] row_mask:0xf bank_mask:0xf
Mvaa 172,204,36
Ta 240,20,24576
Ta 242,20,25600
Mvaa 204,204,40
v_max_u32_dpp v13, v13, v13 row_half_mirror row_mask:0xf bank_mask:0xf
Mvaa 236,204,44
s_nop 0
v_max_u32_dpp v13, v13, v13 row_mirror row_mask:0xf bank_mask:0xf
Mvaa 144,208,32
s_waitcnt lgkmcnt(6)
Ta 244,21,24576
Ta 246,21,25600
Mvaa 176,208,36
v_readlane_b32 s3, v13, 0
v_readlane_b32 s47, v13, 16
Mvaa 208,208,40
buffer_load_dwordx4 a[24:27], v11, s[20:23], 0 offen offset:1024 sc1
Mvaa 240,208,44
Ta 248,22,24576
Ta 250,22,25600
Mvaa 148,212,32
v_readlane_b32 s4, v13, 32
v_readlane_b32 s5, v13, 48
Mvaa 180,212,36
s_max_u32 s3, s3, s47
s_max_u32 s4, s4, s5
s_max_u32 s40, s3, s4
Mvaa 212,212,40
Ta 252,23,24576
Ta 254,23,25600
Mvaa 244,212,44
v_cmp_eq_u32 vcc, s40, v14
Mvaa 152,216,32
s_nop 0
v_cndmask_b32 v13, v14, v15, vcc
Mvaa 184,216,36
s_nop 0
v_max_u32_dpp v13, v13, v13 quad_perm:[1,0,3,2] row_mask:0xf bank_mask:0xf
Mvaa 216,216,40
buffer_load_dwordx4 a[28:31], v11, s[20:23], s58 offen offset:1024 sc1
Mvaa 248,216,44
v_max_u32_dpp v13, v13, v13 quad_perm:[2,3,0,1] row_mask:0xf bank_mask:0xf
Mvaa 156,220,32
s_nop 0
v_max_u32_dpp v13, v13, v13 row_half_mirror row_mask:0xf bank_mask:0xf
Mvaa 188,220,36
s_nop 0
v_max_u32_dpp v13, v13, v13 row_mirror row_mask:0xf bank_mask:0xf
Mvaa 220,220,40
v_readlane_b32 s3, v13, 0
v_readlane_b32 s47, v13, 16
Mvaa 252,220,44
v_readlane_b32 s4, v13, 32
v_readlane_b32 s5, v13, 48
s_waitcnt vmcnt(37) lgkmcnt(0)
s_barrier
Mvaa 128,224,48
s_max_u32 s3, s3, s47
s_max_u32 s4, s4, s5
s_max_u32 s41, s3, s4
Mvaa 160,224,52
s_add_u32 m0, s44, 16384
Ta 192,16,32768
Ta 194,16,33792
Mvaa 192,224,56
buffer_load_dwordx4 v8, s[8:11], s48 offen offset:0 lds
Mvaa 224,224,60
s_and_b32 s3, s40, 0xffff
s_sub_u32 s42, 0xffff, s3
s_and_b32 s3, s41, 0xffff
Mvaa 132,228,48
Ta 196,17,32768
Ta 198,17,33792
Mvaa 164,228,52
buffer_load_dwordx4 v8, s[8:11], s49 offen offset:1024 lds
Mvaa 196,228,56
s_sub_u32 s43, 0xffff, s3
v_mov_b32 v60, s40
v_not_b32_e64 v61, v60
Mvaa 228,228,60
Ta 200,18,32768
Ta 202,18,33792
Mvaa 136,232,48
v_ashrrev_i32_e64 v61, 31, v61
v_or_b32 v61, 0x80000000, v61
Mvaa 168,232,52
buffer_load_dwordx4 v9, s[8:11], s50 offen offset:2048 lds
Mvaa 200,232,56
Ta 204,19,32768
Ta 206,19,33792
Mvaa 232,232,60
v_xor_b32_e64 v60, v60, v61
v_and_b32 v60, 0xffff0000, v60
Mvaa 140,236,48
v_mul_f32 v60, 0xbfb8aa3b, v60
Mvaa 172,236,52
Ta 208,20,32768
Ta 210,20,33792
Mvaa 204,236,56
buffer_load_dwordx4 v9, s[8:11], s51 offen offset:3072 lds
v_add_u32 v8, 524288, v8
v_add_u32 v9, 524288, v9
Mvaa 236,236,60
VE 60,60
Mvaa 144,240,48
s_waitcnt lgkmcnt(6)
Ta 212,21,32768
Ta 214,21,33792
Mvaa 176,240,52
v_add_f32 v60, 1.0, v60
Mvaa 208,240,56
buffer_load_dwordx4 a[32:35], v10, s[20:23], 0 offen offset:2048 sc1
Mvaa 240,240,60
Ta 216,22,32768
Ta 218,22,33792
Mvaa 148,244,48
v_rcp_f32_e64 v60, v60
Mvaa 180,244,52
Vc 60,60,60
v_and_b32 v64, 0xffff0000, v60
Mvaa 212,244,56
Ta 220,23,32768
Ta 222,23,33792
Mvaa 244,244,60
buffer_load_dwordx4 a[36:39], v10, s[20:23], s58 offen offset:2048 sc1
Mvaa 152,248,48
v_mov_b32 v60, s41
v_not_b32 v61, v60
Mvaa 184,248,52
v_ashrrev_i32_e64 v61, 31, v61
v_or_b32 v61, 0x80000000, v61
Mvaa 216,248,56
buffer_load_dwordx4 a[40:43], v11, s[20:23], 0 offen offset:2048 sc1
Mvaa 248,248,60
v_xor_b32_e64 v60, v60, v61
v_and_b32 v60, 0xffff0000, v60
Mvaa 156,252,48
v_mul_f32 v60, 0xbfb8aa3b, v60
Mvaa 188,252,52
buffer_load_dwordx4 a[44:47], v11, s[20:23], s58 offen offset:2048 sc1
Mvaa 220,252,56
VE 60,60
Mvaa 252,252,60
v_add_f32 v60, 1.0, v60
s_waitcnt vmcnt(40) lgkmcnt(0)
Mvaa 128,192,64
v_rcp_f32_e64 v60, v60
Mvaa 160,192,68
Ta 224,16,40960
Ta 226,16,41984
Mvaa 192,192,72
buffer_load_dwordx4 a[48:51], v10, s[20:23], 0 offen offset:3072 sc1
Mvaa 224,192,76
Vc 60,60,60
v_and_b32 v65, 0xffff0000, v60
Mvaa 132,196,64
Ta 228,17,40960
Ta 230,17,41984
Mvaa 164,196,68
v_mov_b32 v48, 0
v_mov_b32 v49, 0
Mvaa 196,196,72
v_mov_b32 v50, 0
v_mov_b32 v51, 0
Mvaa 228,196,76
Ta 232,18,40960
Ta 234,18,41984
Mvaa 136,200,64
v_mov_b32 v52, 0
v_mov_b32 v53, 0
Mvaa 168,200,68
buffer_load_dwordx4 a[52:55], v10, s[20:23], s58 offen offset:3072 sc1
Mvaa 200,200,72
Ta 236,19,40960
Ta 238,19,41984
Mvaa 232,200,76
v_mov_b32 v54, 0
v_mov_b32 v55, 0
Mvaa 140,204,64
v_mov_b32 v56, 0
v_mov_b32 v57, 0
Mvaa 172,204,68
Ta 240,20,40960
Ta 242,20,41984
Mvaa 204,204,72
v_mov_b32 v58, 0
v_mov_b32 v59, 0
Mvaa 236,204,76
v_mov_b32 v60, 0
v_mov_b32 v61, 0
Mvaa 144,208,64
s_waitcnt lgkmcnt(6)
Ta 244,21,40960
Ta 246,21,41984
Mvaa 176,208,68
v_mov_b32 v62, 0
v_mov_b32_e64 v63, 0
Mvaa 208,208,72
buffer_load_dwordx4 a[56:59], v11, s[20:23], 0 offen offset:3072 sc1
Mvaa 240,208,76
Ta 248,22,40960
Ta 250,22,41984
Mvaa 148,212,64
s_mul_i32 s3, s34, s34
s_lshl_b32 s47, s33, 6
s_add_u32 s3, s3, s47
Mvaa 180,212,68
s_lshl_b32 s3, s3, 2
s_add_u32 s3, s3, s32
s_lshl_b32 s3, s3, 7
Mvaa 212,212,72
Ta 252,23,40960
Ta 254,23,41984
Mvaa 244,212,76
s_sub_u32 s3, s3, 512
v_min_u32 v13, 32, v0
v_mov_b32 v28, s94
Mvaa 152,216,64
v_mov_b32 v29, s95
v_mov_b32 v30, v13
Mvaa 184,216,68
v_mov_b32 v14, s100
v_mov_b32 v15, s101
Mvaa 216,216,72
buffer_load_dwordx4 a[60:63], v11, s[20:23], s58 offen offset:3072 sc1
v_add_u32 v10, 4096, v10
v_add_u32 v11, 4096, v11
Mvaa 248,216,76
v_cmp_le_u32 vcc, 7, v13
v_subrev_u32 v31, 7, v13
Mvaa 156,220,64
v_cndmask_b32 v28, v28, v14, vcc
v_cndmask_b32 v29, v29, v15, vcc
Mvaa 188,220,68
v_cndmask_b32 v30, v30, v31, vcc
Mvaa 220,220,72
v_mov_b32 v14, s60
v_mov_b32_e64 v15, s61
Mvaa 252,220,76
v_cmp_le_u32 vcc, 11, v13
v_subrev_u32 v31, 11, v13
s_waitcnt vmcnt(32) lgkmcnt(0)
s_barrier
Mvaa 128,224,80
s_mov_b64 exec, 1
buffer_store_dword v12, v7, s[20:23], s39 offen sc1
s_mov_b64 exec, -1
Mvaa 160,224,84
s_add_u32 m0, s44, 32768
Ta 192,16,49152
Ta 194,16,50176
Mvaa 192,224,88
buffer_load_dwordx4 v8, s[8:11], s48 offen offset:0 lds
Mvaa 224,224,92
v_cndmask_b32 v28, v28, v14, vcc
v_cndmask_b32 v29, v29, v15, vcc
Mvaa 132,228,80
Ta 196,17,49152
Ta 198,17,50176
Mvaa 164,228,84
buffer_load_dwordx4 v8, s[8:11], s49 offen offset:1024 lds
Mvaa 196,228,88
v_cndmask_b32 v30, v30, v31, vcc
Mvaa 228,228,92
Ta 200,18,49152
Ta 202,18,50176
Mvaa 136,232,80
v_mov_b32 v14, s68
v_mov_b32_e64 v15, s69
Mvaa 168,232,84
buffer_load_dwordx4 v9, s[8:11], s50 offen offset:2048 lds
Mvaa 200,232,88
Ta 204,19,49152
Ta 206,19,50176
Mvaa 232,232,92
v_cmp_le_u32 vcc, 18, v13
v_subrev_u32 v31, 18, v13
Mvaa 140,236,80
v_cndmask_b32 v28, v28, v14, vcc
v_cndmask_b32 v29, v29, v15, vcc
Mvaa 172,236,84
Ta 208,20,49152
Ta 210,20,50176
Mvaa 204,236,88
buffer_load_dwordx4 v9, s[8:11], s51 offen offset:3072 lds
v_add_u32 v8, 524288, v8
v_add_u32 v9, 524288, v9
Mvaa 236,236,92
v_cndmask_b32 v30, v30, v31, vcc
Mvaa 144,240,80
s_waitcnt lgkmcnt(6)
Ta 212,21,49152
Ta 214,21,50176
Mvaa 176,240,84
v_mov_b32 v14, s92
v_mov_b32 v15, s93
Mvaa 208,240,88
buffer_load_dwordx4 a[64:67], v10, s[20:23], 0 offen offset:0 sc1
Mvaa 240,240,92
Ta 216,22,49152
Ta 218,22,50176
Mvaa 148,244,80
v_cmp_le_u32 vcc, 25, v13
v_subrev_u32 v31, 25, v13
Mvaa 180,244,84
v_cndmask_b32 v28, v28, v14, vcc
v_cndmask_b32 v29, v29, v15, vcc
Mvaa 212,244,88
Ta 220,23,49152
Ta 222,23,50176
Mvaa 244,244,92
buffer_load_dwordx4 a[68:71], v10, s[20:23], s58 offen offset:0 sc1
Mvaa 152,248,80
v_cndmask_b32 v30, v30, v31, vcc
Mvaa 184,248,84
v_lshlrev_b32 v30, 20, v30
v_add_u32_e64 v30, s3, v30
Mvaa 216,248,88
buffer_load_dwordx4 a[72:75], v11, s[20:23], 0 offen offset:0 sc1
Mvaa 248,248,92
v_ashrrev_i32_e64 v31, 31, v30
v_lshl_add_u64 v[28:29], v[30:31], 0, v[28:29]
Mvaa 156,252,80
s_mov_b32 s40, 512
s_mov_b32 s41, 0
v_readfirstlane_b32 s100, v64
Mvaa 188,252,84
buffer_load_dwordx4 a[76:79], v11, s[20:23], s58 offen offset:0 sc1
Mvaa 220,252,88
v_readfirstlane_b32 s101, v65
Mvaa 252,252,92
s_mov_b32 s24, s60
s_mov_b32 s25, s61
s_mov_b32 s26, s62
s_waitcnt vmcnt(37) lgkmcnt(0)
Mvaa 128,192,96
s_add_u32 s3, s34, 7
s_and_b32 s3, s3, 7
s_lshl_b32 s3, s3, 5
Mvaa 160,192,100
Ta 224,16,57344
Ta 226,16,58368
Mvaa 192,192,104
buffer_load_dwordx4 a[80:83], v10, s[20:23], 0 offen offset:1024 sc1
Mvaa 224,192,108
s_add_u32 s3, s3, s33
s_mul_i32 s92, s3, 2341
s_lshr_b32 s92, s92, 16
Mvaa 132,196,96
Ta 228,17,57344
Ta 230,17,58368
Mvaa 164,196,100
s_mul_i32 s47, s92, 28
s_sub_u32 s4, s3, s47
s_mul_i32 s5, s92, 917504
Mvaa 196,196,104
s_lshl_b32 s47, s4, 8
s_add_u32 s5, s5, s47
s_mov_b32 s94, 1040356334
Mvaa 228,196,108
Ta 232,18,57344
Ta 234,18,58368
Mvaa 136,200,96
s_mov_b32 s95, 1040356334
s_sub_u32 s55, 15, s34
s_sub_u32 s45, s36, 3
Mvaa 168,200,100
buffer_load_dwordx4 a[84:87], v10, s[20:23], s58 offen offset:1024 sc1
Mvaa 200,200,104
Ta 236,19,57344
Ta 238,19,58368
Mvaa 232,200,108
s_sub_u32 s46, s35, 3
s_max_i32 s46, s46, 0
s_mov_b32 s54, s44
Mvaa 140,204,96
s_sub_u32 s35, s35, 1
s_sub_u32 s36, s36, 1
Mvaa 172,204,100
Ta 240,20,57344
Ta 242,20,58368
Mvaa 204,204,104
Mvaa 236,204,108
Mvaa 144,208,96
s_waitcnt lgkmcnt(6)
Ta 244,21,57344
Ta 246,21,58368
Mvaa 176,208,100
Mvaa 208,208,104
buffer_load_dwordx4 a[88:91], v11, s[20:23], 0 offen offset:1024 sc1
Mvaa 240,208,108
Ta 248,22,57344
Ta 250,22,58368
Mvaa 148,212,96
Mvaa 180,212,100
Mvaa 212,212,104
Ta 252,23,57344
Ta 254,23,58368
Mvaa 244,212,108
Mvaa 152,216,96
Mvaa 184,216,100
Mvaa 216,216,104
buffer_load_dwordx4 a[92:95], v11, s[20:23], s58 offen offset:1024 sc1
Mvaa 248,216,108
Mvaa 156,220,96
Mvaa 188,220,100
Mvaa 220,220,104
Mvaa 252,220,108
s_waitcnt vmcnt(33) lgkmcnt(0)
s_barrier
Mvaa 128,224,112
Mvaa 160,224,116
s_add_u32 m0, s44, 49152
Ta 192,16,0
Ta 194,16,1024
Mvaa 192,224,120
buffer_load_dwordx4 v8, s[8:11], s48 offen offset:0 lds
Mvaa 224,224,124
Mvaa 132,228,112
Ta 196,17,0
Ta 198,17,1024
Mvaa 164,228,116
buffer_load_dwordx4 v8, s[8:11], s49 offen offset:1024 lds
Mvaa 196,228,120
Mvaa 228,228,124
Ta 200,18,0
Ta 202,18,1024
Mvaa 136,232,112
Mvaa 168,232,116
buffer_load_dwordx4 v9, s[8:11], s50 offen offset:2048 lds
Mvaa 200,232,120
Ta 204,19,0
Ta 206,19,1024
Mvaa 232,232,124
Mvaa 140,236,112
Mvaa 172,236,116
Ta 208,20,0
Ta 210,20,1024
Mvaa 204,236,120
buffer_load_dwordx4 v9, s[8:11], s51 offen offset:3072 lds
v_add_u32 v8, 524288, v8
v_add_u32 v9, 524288, v9
Mvaa 236,236,124
Mvaa 144,240,112
s_waitcnt lgkmcnt(6)
Ta 212,21,0
Ta 214,21,1024
Mvaa 176,240,116
Mvaa 208,240,120
buffer_load_dwordx4 a[96:99], v10, s[20:23], 0 offen offset:2048 sc1
Mvaa 240,240,124
Ta 216,22,0
Ta 218,22,1024
Mvaa 148,244,112
Mvaa 180,244,116
Mvaa 212,244,120
Ta 220,23,0
Ta 222,23,1024
Mvaa 244,244,124
buffer_load_dwordx4 a[100:103], v10, s[20:23], s58 offen offset:2048 sc1
Mvaa 152,248,112
Mvaa 184,248,116
Mvaa 216,248,120
buffer_load_dwordx4 a[104:107], v11, s[20:23], 0 offen offset:2048 sc1
Mvaa 248,248,124
Mvaa 156,252,112
Mvaa 188,252,116
buffer_load_dwordx4 a[108:111], v11, s[20:23], s58 offen offset:2048 sc1
Mvaa 220,252,120
Mvaa 252,252,124
s_waitcnt vmcnt(37) lgkmcnt(0)
Mvaa 128,192,0
Mvaa 160,192,4
Ta 224,16,8192
Ta 226,16,9216
Mvaa 192,192,8
buffer_load_dwordx4 a[112:115], v10, s[20:23], 0 offen offset:3072 sc1
Mvaa 224,192,12
Mvaa 132,196,0
Ta 228,17,8192
Ta 230,17,9216
Mvaa 164,196,4
Mvaa 196,196,8
Mvaa 228,196,12
Ta 232,18,8192
Ta 234,18,9216
Mvaa 136,200,0
Mvaa 168,200,4
buffer_load_dwordx4 a[116:119], v10, s[20:23], s58 offen offset:3072 sc1
Mvaa 200,200,8
Ta 236,19,8192
Ta 238,19,9216
Mvaa 232,200,12
Mvaa 140,204,0
Mvaa 172,204,4
Ta 240,20,8192
Ta 242,20,9216
Mvaa 204,204,8
Mvaa 236,204,12
Mvaa 144,208,0
s_waitcnt lgkmcnt(6)
Ta 244,21,8192
Ta 246,21,9216
Mvaa 176,208,4
Mvaa 208,208,8
buffer_load_dwordx4 a[120:123], v11, s[20:23], 0 offen offset:3072 sc1
Mvaa 240,208,12
Ta 248,22,8192
Ta 250,22,9216
Mvaa 148,212,0
Mvaa 180,212,4
Mvaa 212,212,8
Ta 252,23,8192
Ta 254,23,9216
Mvaa 244,212,12
Mvaa 152,216,0
Mvaa 184,216,4
Mvaa 216,216,8
buffer_load_dwordx4 a[124:127], v11, s[20:23], s58 offen offset:3072 sc1
v_add_u32 v10, 4096, v10
v_add_u32 v11, 4096, v11
Mvaa 248,216,12
Mvaa 156,220,0
Mvaa 188,220,4
Mvaa 220,220,8
Mvaa 252,220,12
s_waitcnt vmcnt(33) lgkmcnt(0)
s_barrier
Mvaa 128,224,16
v_accvgpr_write_b32 a0, 0
v_accvgpr_write_b32 a1, 0
Mvaa 160,224,20
Ta 192,16,16384
Ta 194,16,17408
Mvaa 192,224,24
v_accvgpr_write_b32 a2, 0
v_accvgpr_write_b32 a3, 0
Mvaa 224,224,28
v_accvgpr_write_b32 a4, 0
v_accvgpr_write_b32 a5, 0
Mvaa 132,228,16
Ta 196,17,16384
Ta 198,17,17408
Mvaa 164,228,20
v_accvgpr_write_b32 a6, 0
v_accvgpr_write_b32 a7, 0
Mvaa 196,228,24
v_accvgpr_write_b32 a8, 0
v_accvgpr_write_b32 a9, 0
Mvaa 228,228,28
Ta 200,18,16384
Ta 202,18,17408
Mvaa 136,232,16
v_accvgpr_write_b32 a10, 0
v_accvgpr_write_b32 a11, 0
Mvaa 168,232,20
v_accvgpr_write_b32 a12, 0
v_accvgpr_write_b32 a13, 0
Mvaa 200,232,24
Ta 204,19,16384
Ta 206,19,17408
Mvaa 232,232,28
v_accvgpr_write_b32 a14, 0
v_accvgpr_write_b32 a15, 0
Mvaa 140,236,16
Mvaa 172,236,20
Ta 208,20,16384
Ta 210,20,17408
Mvaa 204,236,24
Mvaa 236,236,28
Mvaa 144,240,16
s_waitcnt lgkmcnt(6)
Ta 212,21,16384
Ta 214,21,17408
Mvaa 176,240,20
Mvaa 208,240,24
Mvaa 240,240,28
Ta 216,22,16384
Ta 218,22,17408
Mvaa 148,244,16
Mvaa 180,244,20
Mvaa 212,244,24
Ta 220,23,16384
Ta 222,23,17408
Mvaa 244,244,28
Mvaa 152,248,16
Mvaa 184,248,20
Mvaa 216,248,24
Mvaa 248,248,28
Mvaa 156,252,16
Mvaa 188,252,20
Mvaa 220,252,24
Mvaa 252,252,28
s_waitcnt vmcnt(29) lgkmcnt(0)
Mvaa 128,192,32
v_accvgpr_write_b32 a16, 0
v_accvgpr_write_b32 a17, 0
Mvaa 160,192,36
Ta 224,16,24576
Ta 226,16,25600
Mvaa 192,192,40
v_accvgpr_write_b32 a18, 0
v_accvgpr_write_b32 a19, 0
Mvaa 224,192,44
v_accvgpr_write_b32 a20, 0
v_accvgpr_write_b32 a21, 0
Mvaa 132,196,32
Ta 228,17,24576
Ta 230,17,25600
Mvaa 164,196,36
v_accvgpr_write_b32 a22, 0
v_accvgpr_write_b32 a23, 0
Mvaa 196,196,40
v_accvgpr_write_b32 a24, 0
v_accvgpr_write_b32 a25, 0
Mvaa 228,196,44
Ta 232,18,24576
Ta 234,18,25600
Mvaa 136,200,32
v_accvgpr_write_b32 a26, 0
v_accvgpr_write_b32 a27, 0
Mvaa 168,200,36
v_accvgpr_write_b32 a28, 0
v_accvgpr_write_b32 a29, 0
Mvaa 200,200,40
Ta 236,19,24576
Ta 238,19,25600
Mvaa 232,200,44
v_accvgpr_write_b32 a30, 0
v_accvgpr_write_b32 a31, 0
Mvaa 140,204,32
Mvaa 172,204,36
Ta 240,20,24576
Ta 242,20,25600
Mvaa 204,204,40
Mvaa 236,204,44
Mvaa 144,208,32
s_waitcnt lgkmcnt(6)
Ta 244,21,24576
Ta 246,21,25600
Mvaa 176,208,36
buffer_load_dword v12, v1, s[20:23], s6 offen sc1
Mvaa 208,208,40
s_add_u32 m0, s44, 65536
s_mov_b32 s7, 0
Mvaa 240,208,44
Ta 248,22,24576
Ta 250,22,25600
Mvaa 148,212,32
Mvaa 180,212,36
Mvaa 212,212,40
Ta 252,23,24576
Ta 254,23,25600
Mvaa 244,212,44
Mvaa 152,216,32
Mvaa 184,216,36
Mvaa 216,216,40
Mvaa 248,216,44
Mvaa 156,220,32
Mvaa 188,220,36
Mvaa 220,220,40
Mvaa 252,220,44
s_waitcnt vmcnt(21) lgkmcnt(0)
s_barrier
Mvaa 128,224,48
v_accvgpr_write_b32 a32, 0
v_accvgpr_write_b32 a33, 0
Mvaa 160,224,52
Ta 192,16,32768
Ta 194,16,33792
Mvaa 192,224,56
v_accvgpr_write_b32 a34, 0
v_accvgpr_write_b32 a35, 0
Mvaa 224,224,60
v_accvgpr_write_b32 a36, 0
v_accvgpr_write_b32 a37, 0
Mvaa 132,228,48
Ta 196,17,32768
Ta 198,17,33792
Mvaa 164,228,52
v_accvgpr_write_b32 a38, 0
v_accvgpr_write_b32 a39, 0
Mvaa 196,228,56
v_accvgpr_write_b32 a40, 0
v_accvgpr_write_b32 a41, 0
Mvaa 228,228,60
Ta 200,18,32768
Ta 202,18,33792
Mvaa 136,232,48
v_accvgpr_write_b32 a42, 0
v_accvgpr_write_b32 a43, 0
Mvaa 168,232,52
v_accvgpr_write_b32 a44, 0
v_accvgpr_write_b32 a45, 0
Mvaa 200,232,56
Ta 204,19,32768
Ta 206,19,33792
Mvaa 232,232,60
v_accvgpr_write_b32 a46, 0
v_accvgpr_write_b32 a47, 0
Mvaa 140,236,48
Mvaa 172,236,52
Ta 208,20,32768
Ta 210,20,33792
Mvaa 204,236,56
Mvaa 236,236,60
Mvaa 144,240,48
s_waitcnt lgkmcnt(6)
Ta 212,21,32768
Ta 214,21,33792
Mvaa 176,240,52
Mvaa 208,240,56
Mvaa 240,240,60
Ta 216,22,32768
Ta 218,22,33792
Mvaa 148,244,48
Mvaa 180,244,52
Mvaa 212,244,56
Ta 220,23,32768
Ta 222,23,33792
Mvaa 244,244,60
Mvaa 152,248,48
Mvaa 184,248,52
Mvaa 216,248,56
Mvaa 248,248,60
Mvaa 156,252,48
Mvaa 188,252,52
Mvaa 220,252,56
Mvaa 252,252,60
s_waitcnt vmcnt(17) lgkmcnt(0)
Mvaa 128,192,64
v_accvgpr_write_b32 a48, 0
v_accvgpr_write_b32 a49, 0
Mvaa 160,192,68
Ta 224,16,40960
Ta 226,16,41984
Mvaa 192,192,72
v_accvgpr_write_b32 a50, 0
v_accvgpr_write_b32 a51, 0
Mvaa 224,192,76
v_accvgpr_write_b32 a52, 0
v_accvgpr_write_b32 a53, 0
Mvaa 132,196,64
Ta 228,17,40960
Ta 230,17,41984
Mvaa 164,196,68
v_accvgpr_write_b32 a54, 0
v_accvgpr_write_b32 a55, 0
Mvaa 196,196,72
v_accvgpr_write_b32 a56, 0
v_accvgpr_write_b32 a57, 0
Mvaa 228,196,76
Ta 232,18,40960
Ta 234,18,41984
Mvaa 136,200,64
v_accvgpr_write_b32 a58, 0
v_accvgpr_write_b32 a59, 0
Mvaa 168,200,68
v_accvgpr_write_b32 a60, 0
v_accvgpr_write_b32 a61, 0
Mvaa 200,200,72
Ta 236,19,40960
Ta 238,19,41984
Mvaa 232,200,76
v_accvgpr_write_b32 a62, 0
v_accvgpr_write_b32 a63, 0
Mvaa 140,204,64
Mvaa 172,204,68
Ta 240,20,40960
Ta 242,20,41984
Mvaa 204,204,72
Mvaa 236,204,76
Mvaa 144,208,64
s_waitcnt lgkmcnt(6)
Ta 244,21,40960
Ta 246,21,41984
Mvaa 176,208,68
Mvaa 208,208,72
Mvaa 240,208,76
Ta 248,22,40960
Ta 250,22,41984
Mvaa 148,212,64
Mvaa 180,212,68
Mvaa 212,212,72
Ta 252,23,40960
Ta 254,23,41984
Mvaa 244,212,76
Mvaa 152,216,64
Mvaa 184,216,68
Mvaa 216,216,72
Mvaa 248,216,76
Mvaa 156,220,64
Mvaa 188,220,68
Mvaa 220,220,72
Mvaa 252,220,76
s_waitcnt vmcnt(0) lgkmcnt(0)
s_cmp_lg_u32 s32, 0
s_cbranch_scc1 L_spinBr
v_cmp_ne_u32 vcc, 1, v12
s_cbranch_vccnz L_spinB
L_spinBr:
s_barrier
Mvaa 128,224,80
buffer_load_dwordx4 v4, s[12:15], s7 offen offset:0 sc1 lds
Mvaa 160,224,84
Ta 192,16,49152
Ta 194,16,50176
Mvaa 192,224,88
v_accvgpr_write_b32 a64, 0
v_accvgpr_write_b32 a65, 0
Mvaa 224,224,92
buffer_load_dwordx4 v4, s[12:15], s7 offen offset:1024 sc1 lds
Mvaa 132,228,80
Ta 196,17,49152
Ta 198,17,50176
Mvaa 164,228,84
v_accvgpr_write_b32 a66, 0
v_accvgpr_write_b32 a67, 0
Mvaa 196,228,88
buffer_load_dwordx4 v4, s[12:15], s7 offen offset:2048 sc1 lds
Mvaa 228,228,92
Ta 200,18,49152
Ta 202,18,50176
Mvaa 136,232,80
v_accvgpr_write_b32 a68, 0
v_accvgpr_write_b32 a69, 0
Mvaa 168,232,84
buffer_load_dwordx4 v4, s[12:15], s7 offen offset:3072 sc1 lds
Mvaa 200,232,88
Ta 204,19,49152
Ta 206,19,50176
Mvaa 232,232,92
s_add_u32 m0, s44, 98304
s_mov_b32 s7, 34816
Mvaa 140,236,80
buffer_load_dwordx4 v4, s[12:15], s7 offen offset:0 sc1 lds
Mvaa 172,236,84
Ta 208,20,49152
Ta 210,20,50176
Mvaa 204,236,88
v_accvgpr_write_b32 a70, 0
v_accvgpr_write_b32 a71, 0
Mvaa 236,236,92
buffer_load_dwordx4 v4, s[12:15], s7 offen offset:1024 sc1 lds
Mvaa 144,240,80
s_waitcnt lgkmcnt(6)
Ta 212,21,49152
Ta 214,21,50176
Mvaa 176,240,84
v_accvgpr_write_b32 a72, 0
v_accvgpr_write_b32 a73, 0
Mvaa 208,240,88
buffer_load_dwordx4 v4, s[12:15], s7 offen offset:2048 sc1 lds
Mvaa 240,240,92
Ta 216,22,49152
Ta 218,22,50176
Mvaa 148,244,80
v_accvgpr_write_b32 a74, 0
v_accvgpr_write_b32 a75, 0
Mvaa 180,244,84
buffer_load_dwordx4 v4, s[12:15], s7 offen offset:3072 sc1 lds
Mvaa 212,244,88
Ta 220,23,49152
Ta 222,23,50176
Mvaa 244,244,92
s_add_u32 m0, s44, 81920
s_mov_b32 s7, 17408
Mvaa 152,248,80
buffer_load_dwordx4 v4, s[12:15], s7 offen offset:0 sc1 lds
Mvaa 184,248,84
v_accvgpr_write_b32 a76, 0
v_accvgpr_write_b32 a77, 0
Mvaa 216,248,88
buffer_load_dwordx4 v4, s[12:15], s7 offen offset:1024 sc1 lds
Mvaa 248,248,92
v_accvgpr_write_b32 a78, 0
v_accvgpr_write_b32 a79, 0
Mvaa 156,252,80
Mvaa 188,252,84
buffer_load_dwordx4 v4, s[12:15], s7 offen offset:2048 sc1 lds
Mvaa 220,252,88
Mvaa 252,252,92
s_waitcnt lgkmcnt(0)
Mvaa 128,192,96
buffer_load_dwordx4 v4, s[12:15], s7 offen offset:3072 sc1 lds
Mvaa 160,192,100
Ta 224,16,57344
Ta 226,16,58368
Mvaa 192,192,104
s_add_u32 m0, s44, 114688
s_mov_b32 s7, 52224
Mvaa 224,192,108
buffer_load_dwordx4 v4, s[12:15], s7 offen offset:0 sc1 lds
Mvaa 132,196,96
Ta 228,17,57344
Ta 230,17,58368
Mvaa 164,196,100
v_accvgpr_write_b32 a80, 0
v_accvgpr_write_b32 a81, 0
Mvaa 196,196,104
buffer_load_dwordx4 v4, s[12:15], s7 offen offset:1024 sc1 lds
Mvaa 228,196,108
Ta 232,18,57344
Ta 234,18,58368
Mvaa 136,200,96
v_accvgpr_write_b32 a82, 0
v_accvgpr_write_b32 a83, 0
Mvaa 168,200,100
buffer_load_dwordx4 v4, s[12:15], s7 offen offset:2048 sc1 lds
Mvaa 200,200,104
Ta 236,19,57344
Ta 238,19,58368
Mvaa 232,200,108
v_accvgpr_write_b32 a84, 0
v_accvgpr_write_b32 a85, 0
Mvaa 140,204,96
buffer_load_dwordx4 v4, s[12:15], s7 offen offset:3072 sc1 lds
Mvaa 172,204,100
Ta 240,20,57344
Ta 242,20,58368
Mvaa 204,204,104
s_add_u32 m0, s44, 0
s_mov_b32 s7, 69632
Mvaa 236,204,108
buffer_load_dwordx4 v4, s[12:15], s7 offen offset:0 sc1 lds
Mvaa 144,208,96
s_waitcnt lgkmcnt(6)
Ta 244,21,57344
Ta 246,21,58368
Mvaa 176,208,100
buffer_load_dwordx4 v4, s[12:15], s7 offen offset:1024 sc1 lds
Mvaa 208,208,104
v_accvgpr_write_b32 a86, 0
v_accvgpr_write_b32 a87, 0
Mvaa 240,208,108
Ta 248,22,57344
Ta 250,22,58368
Mvaa 148,212,96
buffer_load_dwordx4 v4, s[12:15], s7 offen offset:2048 sc1 lds
Mvaa 180,212,100
v_accvgpr_write_b32 a88, 0
v_accvgpr_write_b32 a89, 0
Mvaa 212,212,104
Ta 252,23,57344
Ta 254,23,58368
Mvaa 244,212,108
buffer_load_dwordx4 v4, s[12:15], s7 offen offset:3072 sc1 lds
Mvaa 152,216,96
s_add_u32 m0, s44, 16384
s_mov_b32 s7, 87040
Mvaa 184,216,100
v_accvgpr_write_b32 a90, 0
v_accvgpr_write_b32 a91, 0
Mvaa 216,216,104
buffer_load_dwordx4 v4, s[12:15], s7 offen offset:0 sc1 lds
Mvaa 248,216,108
v_accvgpr_write_b32 a92, 0
v_accvgpr_write_b32 a93, 0
Mvaa 156,220,96
v_accvgpr_write_b32 a94, 0
v_accvgpr_write_b32 a95, 0
Mvaa 188,220,100
buffer_load_dwordx4 v4, s[12:15], s7 offen offset:1024 sc1 lds
Mvaa 220,220,104
Mvaa 252,220,108
s_waitcnt vmcnt(18) lgkmcnt(0)
s_barrier
Mvaa 128,224,112
buffer_load_dwordx4 v4, s[12:15], s7 offen offset:2048 sc1 lds
Mvaa 132,228,112
Ra 192,3,0
Ra 196,3,1024
Mvaa 136,232,112
Ra 200,3,2048
Ra 204,3,3072
Mvaa 140,236,112
buffer_load_dwordx4 v4, s[12:15], s7 offen offset:3072 sc1 lds
Mvaa 144,240,112
s_add_u32 m0, s44, 32768
s_mov_b32 s7, 104448
Mvaa 148,244,112
Ra 208,3,4096
Ra 212,3,5120
Mvaa 152,248,112
buffer_load_dwordx4 v4, s[12:15], s7 offen offset:0 sc1 lds
Mvaa 156,252,112
Ra 216,3,6144
Ra 220,3,7168
Mvaa 160,224,116
buffer_load_dwordx4 v4, s[12:15], s7 offen offset:1024 sc1 lds
Mvaa 164,228,116
Mvaa 168,232,116
Mvaa 172,236,116
buffer_load_dwordx4 v4, s[12:15], s7 offen offset:2048 sc1 lds
Mvaa 176,240,116
v_mul_f32 v128, s94, v128
v_mul_f32 v129, s94, v129
Mvaa 180,244,116
v_mul_f32 v130, s94, v130
v_mul_f32 v131, s94, v131
Mvaa 184,248,116
buffer_load_dwordx4 v4, s[12:15], s7 offen offset:3072 sc1 lds
Mvaa 188,252,116
v_mul_f32 v132, s94, v132
v_mul_f32 v133, s94, v133
Mvaa 192,224,120
v_mul_f32 v134, s94, v134
v_mul_f32 v135, s94, v135
Mvaa 196,228,120
Vc 128,128,129
Vc 129,130,131
Mvaa 200,232,120
Vc 130,132,133
Vc 131,134,135
Mvaa 204,236,120
Aw 128,128
Aw 129,129
Mvaa 208,240,120
Aw 130,130
Aw 131,131
Mvaa 212,244,120
v_mul_f32 v136, s94, v136
v_mul_f32 v137, s94, v137
Mvaa 216,248,120
v_mul_f32 v138, s94, v138
v_mul_f32 v139, s94, v139
Mvaa 220,252,120
v_mul_f32 v140, s94, v140
v_mul_f32 v141, s94, v141
Mvaa 224,224,124
v_mul_f32 v142, s94, v142
v_mul_f32 v143, s94, v143
Mvaa 228,228,124
Vc 136,136,137
Vc 137,138,139
Mvaa 232,232,124
Vc 138,140,141
Vc 139,142,143
Mvaa 236,236,124
Aw 132,136
Aw 133,137
Mvaa 240,240,124
Aw 134,138
Aw 135,139
Mvaa 244,244,124
v_mul_f32 v144, s94, v144
v_mul_f32 v145, s94, v145
Mvaa 248,248,124
v_mul_f32 v146, s94, v146
v_mul_f32 v147, s94, v147
Mvaa 252,252,124
v_mul_f32 v148, s94, v148
v_mul_f32 v149, s94, v149
Ra 224,3,8192
Ra 228,3,9216
Ra 232,3,10240
Ra 236,3,11264
Ra 240,3,12288
Ra 244,3,13312
Ra 248,3,14336
s_waitcnt lgkmcnt(9)
Ra 252,3,15360
v_mul_f32 v150, s94, v150
v_mul_f32_e64 v151, s94, v151
Vc 144,144,145
Vc 145,146,147
Vc 146,148,149
Vc 147,150,151
Aw 136,144
Aw 137,145
Aw 138,146
Aw 139,147
v_mul_f32 v152, s94, v152
v_mul_f32 v153, s94, v153
v_mul_f32 v154, s94, v154
v_mul_f32 v155, s94, v155
v_mul_f32 v156, s94, v156
v_mul_f32 v157, s94, v157
v_mul_f32 v158, s94, v158
v_mul_f32 v159, s94, v159
Vc 152,152,153
Vc 153,154,155
Vc 154,156,157
Vc 155,158,159
Aw 140,152
Aw 141,153
Aw 142,154
Aw 143,155
Zvaa 128,192,128
v_mul_f32 v160, s94, v160
v_mul_f32 v161, s94, v161
v_mul_f32 v162, s94, v162
v_mul_f32 v163, s94, v163
Mvaa 128,196,132
v_mul_f32 v164, s94, v164
v_mul_f32 v165, s94, v165
v_mul_f32 v166, s94, v166
v_mul_f32 v167, s94, v167
Mvaa 128,200,136
Vc 160,160,161
Vc 161,162,163
Vc 162,164,165
Vc 163,166,167
Mvaa 128,204,140
Aw 144,160
Aw 145,161
Aw 146,162
Aw 147,163
s_waitcnt lgkmcnt(8)
Zvaa 132,208,128
v_mul_f32 v168, s94, v168
v_mul_f32 v169, s94, v169
v_mul_f32 v170, s94, v170
v_mul_f32_e64 v171, s94, v171
Mvaa 132,212,132
v_mul_f32 v172, s94, v172
v_mul_f32 v173, s94, v173
v_mul_f32 v174, s94, v174
v_mul_f32 v175, s94, v175
Mvaa 132,216,136
Vc 168,168,169
Vc 169,170,171
Vc 170,172,173
Vc 171,174,175
Mvaa 132,220,140
Aw 148,168
Aw 149,169
Aw 150,170
Aw 151,171
s_waitcnt lgkmcnt(4)
Zvaa 136,224,128
v_mul_f32 v176, s94, v176
v_mul_f32 v177, s94, v177
v_mul_f32 v178, s94, v178
v_mul_f32_e64 v179, s94, v179
Mvaa 136,228,132
v_mul_f32 v180, s94, v180
v_mul_f32 v181, s94, v181
v_mul_f32 v182, s94, v182
v_mul_f32 v183, s94, v183
Mvaa 136,232,136
Vc 176,176,177
Vc 177,178,179
Vc 178,180,181
Vc 179,182,183
Mvaa 136,236,140
Aw 152,176
Aw 153,177
Aw 154,178
Aw 155,179
s_waitcnt lgkmcnt(0)
Zvaa 140,240,128
v_mul_f32 v184, s94, v184
v_mul_f32 v185, s94, v185
v_mul_f32 v186, s94, v186
v_mul_f32_e64 v187, s94, v187
Mvaa 140,244,132
v_mul_f32 v188, s94, v188
v_mul_f32 v189, s94, v189
v_mul_f32 v190, s94, v190
v_mul_f32 v191, s94, v191
Mvaa 140,248,136
Vc 184,184,185
Vc 185,186,187
Vc 186,188,189
Vc 187,190,191
Mvaa 140,252,140
Aw 156,184
Aw 157,185
Aw 158,186
Aw 159,187
Zvaa 144,192,144
v_mul_f32 v192, s94, v192
v_mul_f32 v193, s94, v193
v_mul_f32 v194, s94, v194
v_mul_f32 v195, s94, v195
Mvaa 144,196,148
v_mul_f32 v196, s94, v196
v_mul_f32 v197, s94, v197
v_mul_f32 v198, s94, v198
v_mul_f32 v199, s94, v199
Mvaa 144,200,152
Vc 192,192,193
Vc 193,194,195
Vc 194,196,197
Vc 195,198,199
Mvaa 144,204,156
Aw 160,192
Aw 161,193
Aw 162,194
Aw 163,195
Zvaa 148,208,144
v_mul_f32 v200, s94, v200
v_mul_f32 v201, s94, v201
v_mul_f32 v202, s94, v202
v_mul_f32 v203, s94, v203
Mvaa 148,212,148
v_mul_f32 v204, s94, v204
v_mul_f32 v205, s94, v205
v_mul_f32 v206, s94, v206
v_mul_f32 v207, s94, v207
Mvaa 148,216,152
Vc 200,200,201
Vc 201,202,203
Vc 202,204,205
Vc 203,206,207
Mvaa 148,220,156
Aw 164,200
Aw 165,201
Aw 166,202
Aw 167,203
Zvaa 152,224,144
v_mul_f32 v208, s94, v208
v_mul_f32 v209, s94, v209
v_mul_f32 v210, s94, v210
v_mul_f32 v211, s94, v211
Mvaa 152,228,148
v_mul_f32 v212, s94, v212
v_mul_f32 v213, s94, v213
v_mul_f32 v214, s94, v214
v_mul_f32 v215, s94, v215
Mvaa 152,232,152
Vc 208,208,209
Vc 209,210,211
Vc 210,212,213
Vc 211,214,215
Mvaa 152,236,156
Aw 168,208
Aw 169,209
Aw 170,210
Aw 171,211
Zvaa 156,240,144
v_mul_f32 v216, s94, v216
v_mul_f32 v217, s94, v217
v_mul_f32 v218, s94, v218
v_mul_f32 v219, s94, v219
Mvaa 156,244,148
v_mul_f32 v220, s94, v220
v_mul_f32 v221, s94, v221
v_mul_f32 v222, s94, v222
v_mul_f32 v223, s94, v223
Mvaa 156,248,152
Vc 216,216,217
Vc 217,218,219
Vc 218,220,221
Vc 219,222,223
Mvaa 156,252,156
Aw 172,216
Aw 173,217
Aw 174,218
Aw 175,219
Zvaa 160,192,160
v_mul_f32 v224, s94, v224
v_mul_f32 v225, s94, v225
v_mul_f32 v226, s94, v226
v_mul_f32 v227, s94, v227
Mvaa 160,196,164
v_mul_f32 v228, s94, v228
v_mul_f32 v229, s94, v229
v_mul_f32 v230, s94, v230
v_mul_f32 v231, s94, v231
Mvaa 160,200,168
Vc 224,224,225
Vc 225,226,227
Vc 226,228,229
Vc 227,230,231
Mvaa 160,204,172
Aw 176,224
Aw 177,225
Aw 178,226
Aw 179,227
Zvaa 164,208,160
v_mul_f32 v232, s94, v232
v_mul_f32 v233, s94, v233
v_mul_f32 v234, s94, v234
v_mul_f32 v235, s94, v235
Mvaa 164,212,164
v_mul_f32 v236, s94, v236
v_mul_f32 v237, s94, v237
v_mul_f32 v238, s94, v238
v_mul_f32 v239, s94, v239
Mvaa 164,216,168
Vc 232,232,233
Vc 233,234,235
Vc 234,236,237
Vc 235,238,239
Mvaa 164,220,172
Aw 180,232
Aw 181,233
Aw 182,234
Aw 183,235
Zvaa 168,224,160
v_mul_f32 v240, s94, v240
v_mul_f32 v241, s94, v241
v_mul_f32 v242, s94, v242
v_mul_f32 v243, s94, v243
Mvaa 168,228,164
v_mul_f32 v244, s94, v244
v_mul_f32 v245, s94, v245
v_mul_f32 v246, s94, v246
v_mul_f32 v247, s94, v247
Mvaa 168,232,168
Vc 240,240,241
Vc 241,242,243
Vc 242,244,245
Vc 243,246,247
Mvaa 168,236,172
Aw 184,240
Aw 185,241
Aw 186,242
Aw 187,243
Zvaa 172,240,160
v_mul_f32 v248, s94, v248
v_mul_f32 v249, s94, v249
v_mul_f32 v250, s94, v250
v_mul_f32 v251, s94, v251
Mvaa 172,244,164
v_mul_f32 v252, s94, v252
v_mul_f32 v253, s94, v253
v_mul_f32 v254, s94, v254
v_mul_f32 v255, s94, v255
Mvaa 172,248,168
Vc 248,248,249
Vc 249,250,251
Vc 250,252,253
Vc 251,254,255
Mvaa 172,252,172
Aw 188,248
Aw 189,249
Aw 190,250
Aw 191,251
Zvaa 176,192,176
v_accvgpr_write_b32 a96, 0
v_accvgpr_write_b32 a97, 0
v_accvgpr_write_b32 a98, 0
v_accvgpr_write_b32 a99, 0
Mvaa 176,196,180
v_accvgpr_write_b32 a100, 0
v_accvgpr_write_b32 a101, 0
v_accvgpr_write_b32 a102, 0
v_accvgpr_write_b32 a103, 0
Mvaa 176,200,184
v_accvgpr_write_b32 a104, 0
v_accvgpr_write_b32 a105, 0
v_accvgpr_write_b32 a106, 0
v_accvgpr_write_b32 a107, 0
Mvaa 176,204,188
v_accvgpr_write_b32 a108, 0
v_accvgpr_write_b32 a109, 0
v_accvgpr_write_b32 a110, 0
v_accvgpr_write_b32 a111, 0
Zvaa 180,208,176
v_accvgpr_write_b32 a112, 0
v_accvgpr_write_b32 a113, 0
v_accvgpr_write_b32 a114, 0
v_accvgpr_write_b32 a115, 0
Mvaa 180,212,180
v_accvgpr_write_b32 a116, 0
v_accvgpr_write_b32 a117, 0
v_accvgpr_write_b32 a118, 0
v_accvgpr_write_b32 a119, 0
Mvaa 180,216,184
v_accvgpr_write_b32 a120, 0
v_accvgpr_write_b32 a121, 0
v_accvgpr_write_b32 a122, 0
v_accvgpr_write_b32 a123, 0
Mvaa 180,220,188
v_accvgpr_write_b32 a124, 0
v_accvgpr_write_b32 a125, 0
v_accvgpr_write_b32 a126, 0
v_accvgpr_write_b32 a127, 0
s_waitcnt vmcnt(16)
s_barrier
s_add_u32 s53, s44, 65536
Zvaa 184,224,176
Ra 192,3,32768
v_mov_b32 v16, 0x3f803f80
v_mov_b32 v17, 0x3f803f80
v_mov_b32 v18, 0x3f803f80
v_mov_b32 v19, 0x3f803f80
Mvaa 184,228,180
Ra 196,3,33792
v_mov_b32 v20, 0xff800000
v_max3_f32 v22, v128, v129, v130
v_max3_f32 v22, v22, v131, v132
v_max3_f32 v22, v22, v133, v134
Mvaa 184,232,184
Ra 200,3,34816
v_max3_f32 v22, v22, v135, v136
v_max3_f32 v22, v22, v137, v138
v_max3_f32 v22, v22, v139, v140
v_max3_f32 v22, v22, v141, v142
Mvaa 184,236,188
Ra 204,3,35840
v_max_f32 v22, v22, v143
v_mov_b32 v1, v22
s_nop 1
v_permlane16_swap_b32 v1, v22
v_max_f32_e64 v22, v22, v1
Zvaa 188,240,176
Ra 208,3,36864
v_mov_b32 v1, v22
s_nop 1
v_permlane32_swap_b32 v1, v22
v_max_f32 v22, v22, v1
v_add_f32 v22, 0x41f80000, v22
Mvaa 188,244,180
Ra 212,3,37888
Vs 128,128,22
Vs 129,129,22
Vs 130,130,22
Vs 131,131,22
Mvaa 188,248,184
Ra 216,3,38912
Vs 132,132,22
Vs 133,133,22
Vs 134,134,22
Vs 135,135,22
Mvaa 188,252,188
Ra 220,3,39936
Vs 136,136,22
Vs 137,137,22
Vs 138,138,22
Vs 139,139,22
Vs 140,140,22
Vs 141,141,22
Vs 142,142,22
Vs 143,143,22
v_sub_f32 v32, 0, v22
v_sub_f32 v33, 0, v22
v_sub_f32 v34, 0, v22
v_sub_f32 v35, 0, v22
v_max3_f32 v22, v144, v145, v146
v_max3_f32 v22, v22, v147, v148
v_max3_f32 v22, v22, v149, v150
v_max3_f32 v22, v22, v151, v152
v_max3_f32 v22, v22, v153, v154
v_max3_f32 v22, v22, v155, v156
v_max3_f32 v22, v22, v157, v158
v_max_f32 v22, v22, v159
v_mov_b32 v1, v22
s_nop 1
v_permlane16_swap_b32 v1, v22
v_max_f32 v22, v22, v1
v_mov_b32 v1, v22
s_nop 1
v_permlane32_swap_b32 v1, v22
v_max_f32_e64 v22, v22, v1
v_add_f32 v22, 0x41f80000, v22
Vs 144,144,22
Vs 145,145,22
Vs 146,146,22
Vs 147,147,22
Vs 148,148,22
Vs 149,149,22
Vs 150,150,22
Vs 151,151,22
Vs 152,152,22
Vs 153,153,22
Vs 154,154,22
Vs 155,155,22
Vs 156,156,22
Vs 157,157,22
Vs 158,158,22
Vs 159,159,22
v_sub_f32 v36, 0, v22
v_sub_f32 v37, 0, v22
v_sub_f32 v38, 0, v22
v_sub_f32 v39, 0, v22
s_mov_b32 s38, 139264
s_mov_b32 s39, 121856
s_mov_b32 s37, -1
s_cmp_lg_u32 s34, 0
s_cbranch_scc1 L_k2_nomask0
s_nop 7
s_add_u32 s3, s37, 1
s_lshl_b32 s3, s3, 6
v_subrev_u32_e64 v1, s3, v6
v_cmp_gt_i32 s[56:57], -16, v1
v_cmp_gt_i32 s[58:59], -15, v1
v_cmp_gt_i32 s[60:61], -14, v1
v_cmp_gt_i32 s[62:63], -13, v1
v_cndmask_b32 v176, v176, v20, s[56:57]
v_cndmask_b32 v177, v177, v20, s[58:59]
v_cndmask_b32 v178, v178, v20, s[60:61]
v_cndmask_b32 v179, v179, v20, s[62:63]
v_cmp_gt_i32 s[56:57], 0, v1
v_cmp_gt_i32 s[58:59], 1, v1
v_cmp_gt_i32 s[60:61], 2, v1
v_cmp_gt_i32 s[62:63], 3, v1
v_cndmask_b32 v160, v160, v20, s[56:57]
v_cndmask_b32 v161, v161, v20, s[58:59]
v_cndmask_b32 v162, v162, v20, s[60:61]
v_cndmask_b32 v163, v163, v20, s[62:63]
v_cndmask_b32 v180, v180, v20, s[56:57]
v_cndmask_b32 v181, v181, v20, s[58:59]
v_cndmask_b32 v182, v182, v20, s[60:61]
v_cndmask_b32 v183, v183, v20, s[62:63]
v_cmp_gt_i32 s[56:57], 16, v1
v_cmp_gt_i32 s[58:59], 17, v1
v_cmp_gt_i32 s[60:61], 18, v1
v_cmp_gt_i32 s[62:63], 19, v1
v_cndmask_b32 v164, v164, v20, s[56:57]
v_cndmask_b32 v165, v165, v20, s[58:59]
v_cndmask_b32 v166, v166, v20, s[60:61]
v_cndmask_b32 v167, v167, v20, s[62:63]
v_cndmask_b32 v184, v184, v20, s[56:57]
v_cndmask_b32 v185, v185, v20, s[58:59]
v_cndmask_b32 v186, v186, v20, s[60:61]
v_cndmask_b32 v187, v187, v20, s[62:63]
v_cmp_gt_i32 s[56:57], 32, v1
v_cmp_gt_i32 s[58:59], 33, v1
v_cmp_gt_i32 s[60:61], 34, v1
v_cmp_gt_i32 s[62:63], 35, v1
v_cndmask_b32 v168, v168, v20, s[56:57]
v_cndmask_b32 v169, v169, v20, s[58:59]
v_cndmask_b32 v170, v170, v20, s[60:61]
v_cndmask_b32 v171, v171, v20, s[62:63]
v_cndmask_b32 v188, v188, v20, s[56:57]
v_cndmask_b32 v189, v189, v20, s[58:59]
v_cndmask_b32 v190, v190, v20, s[60:61]
v_cndmask_b32 v191, v191, v20, s[62:63]
v_cmp_gt_i32 s[56:57], 48, v1
v_cmp_gt_i32 s[58:59], 49, v1
v_cmp_gt_i32 s[60:61], 50, v1
v_cmp_gt_i32 s[62:63], 51, v1
v_cndmask_b32 v172, v172, v20, s[56:57]
v_cndmask_b32 v173, v173, v20, s[58:59]
v_cndmask_b32 v174, v174, v20, s[60:61]
v_cndmask_b32 v175, v175, v20, s[62:63]
s_nop 1
L_k2_nomask0:
s_mov_b32 s37, 0
v_max3_f32 v22, v160, v161, v162
v_max3_f32 v22, v22, v163, v164
v_max3_f32 v22, v22, v165, v166
v_max3_f32 v22, v22, v167, v168
v_max3_f32 v22, v22, v169, v170
v_max3_f32 v22, v22, v171, v172
v_max3_f32 v22, v22, v173, v174
v_max_f32 v22, v22, v175
v_mov_b32 v1, v22
s_nop 1
v_permlane16_swap_b32 v1, v22
v_max_f32 v22, v22, v1
v_mov_b32 v1, v22
s_nop 1
v_permlane32_swap_b32 v1, v22
v_max_f32_e64 v22, v22, v1
v_add_f32 v22, 0x41f80000, v22
Vs 160,160,22
Vs 161,161,22
Vs 162,162,22
Vs 163,163,22
Vs 164,164,22
Vs 165,165,22
Vs 166,166,22
Vs 167,167,22
Vs 168,168,22
Vs 169,169,22
Vs 170,170,22
Vs 171,171,22
Vs 172,172,22
Vs 173,173,22
Vs 174,174,22
Vs 175,175,22
v_sub_f32 v40, 0, v22
v_sub_f32 v41, 0, v22
v_sub_f32 v42, 0, v22
v_sub_f32 v43, 0, v22
v_max3_f32 v22, v176, v177, v178
v_max3_f32 v22, v22, v179, v180
v_max3_f32 v22, v22, v181, v182
v_max3_f32 v22, v22, v183, v184
v_max3_f32 v22, v22, v185, v186
v_max3_f32 v22, v22, v187, v188
v_max3_f32 v22, v22, v189, v190
v_max_f32 v22, v22, v191
v_mov_b32 v1, v22
s_nop 1
v_permlane16_swap_b32 v1, v22
v_max_f32 v22, v22, v1
v_mov_b32 v1, v22
s_nop 1
v_permlane32_swap_b32 v1, v22
v_max_f32_e64 v22, v22, v1
v_add_f32 v22, 0x41f80000, v22
Vs 176,176,22
Vs 177,177,22
Vs 178,178,22
Vs 179,179,22
Vs 180,180,22
Vs 181,181,22
Vs 182,182,22
Vs 183,183,22
Vs 184,184,22
Vs 185,185,22
Vs 186,186,22
Vs 187,187,22
Vs 188,188,22
Vs 189,189,22
Vs 190,190,22
Vs 191,191,22
v_sub_f32 v44, 0, v22
v_sub_f32 v45, 0, v22
v_sub_f32 v46, 0, v22
v_sub_f32 v47, 0, v22
Ve 8,128
Ve 9,129
Ve 10,130
Ve 11,131
Vc 64,8,9
Ve 12,144
Ve 13,145
Vc 65,10,11
Ve 14,146
Ve 15,147
Vc 72,12,13
Ve 8,160
Ve 9,161
Vc 73,14,15
Ve 10,162
Ve 11,163
Vc 80,8,9
Ve 12,176
Ve 13,177
Vc 81,10,11
Ve 14,178
Ve 15,179
Vc 88,12,13
Ve 8,132
Ve 9,133
Vc 89,14,15
Ve 10,134
Ve 11,135
Vc 66,8,9
Ve 12,148
Ve 13,149
Vc 67,10,11
Ve 14,150
Ve 15,151
Vc 74,12,13
Ve 8,164
Ve 9,165
Vc 75,14,15
Ve 10,166
Ve 11,167
Vc 82,8,9
Ve 12,180
Ve 13,181
Vc 83,10,11
Ve 14,182
Ve 15,183
Vc 90,12,13
Vc 91,14,15
v_or_b32_e64 v7, v64, v65
v_or3_b32 v7, v7, v72, v73
v_or3_b32 v7, v7, v80, v81
v_or3_b32 v7, v7, v88, v89
v_or3_b32 v7, v7, v66, v67
v_or3_b32 v7, v7, v74, v75
v_or3_b32 v7, v7, v82, v83
v_or3_b32 v7, v7, v90, v91
s_waitcnt lgkmcnt(4)
L_k2_wloop:
v_xor_b32 v2, 65536, v2
v_xor_b32 v3, 65536, v3
Cvaa 192,192,128,32
s_mov_b32 m0, s53
Ra 224,2,40960
v_lshl_add_u64 v[28:29], s[40:41], 0, v[28:29]
Mvaa 192,196,132
buffer_load_dwordx4 v4, s[12:15], s38 offen offset:0 sc1 lds
Mvaa 192,200,136
VE 8,136
Mvaa 192,204,140
VE 9,137
Cvaa 208,192,144,36
Ra 228,2,41984
Vc 68,8,9
Mvaa 208,196,148
VE 10,138
Mvaa 208,200,152
VE 11,139
Mvaa 208,204,156
Ra 232,2,43008
Vc 69,10,11
Cvaa 224,192,160,40
Ra 236,2,44032
v_or3_b32 v7, v7, v68, v69
Mvaa 224,196,164
VE 12,152
Mvaa 224,200,168
VE 13,153
Mvaa 224,204,172
Ra 240,2,45056
Vc 76,12,13
Cvaa 240,192,176,44
VE 14,154
Mvaa 240,196,180
VE 15,155
Mvaa 240,200,184
Ra 244,2,46080
Vc 77,14,15
Mvaa 240,204,188
s_waitcnt lgkmcnt(6)
Ra 248,2,47104
v_or3_b32 v7, v7, v76, v77
Cvaa 196,208,128,32
buffer_load_dwordx4 v4, s[12:15], s38 offen offset:1024 sc1 lds
Mvaa 196,212,132
Ve 8,168
Mvaa 196,216,136
VE 9,169
Mvaa 196,220,140
Ra 252,2,48128
Vc 84,8,9
Cvaa 212,208,144,36
VE 10,170
Mvaa 212,212,148
VE 11,171
Mvaa 212,216,152
Ra 192,2,16384
Vc 85,10,11
Mvaa 212,220,156
Ra 196,2,17408
v_or3_b32 v7, v7, v84, v85
Cvaa 228,208,160,40
VE 12,184
Mvaa 228,212,164
VE 13,185
Mvaa 228,216,168
Ra 200,2,18432
Vc 92,12,13
Mvaa 228,220,172
VE 14,186
Cvaa 244,208,176,44
VE 15,187
Mvaa 244,212,180
buffer_load_dwordx4 v4, s[12:15], s38 offen offset:2048 sc1 lds
Mvaa 244,216,184
Ra 204,2,19456
Vc 93,14,15
Mvaa 244,220,188
s_waitcnt lgkmcnt(8)
Ve 8,140
Cvaa 200,224,128,32
Ra 208,2,20480
v_or3_b32 v7, v7, v92, v93
Mvaa 200,228,132
VE 9,141
Mvaa 200,232,136
Ra 212,2,21504
Vc 70,8,9
Mvaa 200,236,140
VE 10,142
Cvaa 216,224,144,36
VE 11,143
Mvaa 216,228,148
Ra 216,2,22528
Vc 71,10,11
Mvaa 216,232,152
Ra 220,2,23552
v_or3_b32 v7, v7, v70, v71
Mvaa 216,236,156
VE 12,156
Cvaa 232,224,160,40
VE 13,157
Mvaa 232,228,164
VE 14,158
Mvaa 232,232,168
VE 15,159
Mvaa 232,236,172
buffer_load_dwordx4 v4, s[12:15], s38 offen offset:3072 sc1 lds
Cvaa 248,224,176,44
VE 8,172
Mvaa 248,228,180
VE 9,173
Mvaa 248,232,184
Vc 78,12,13
Vc 79,14,15
Mvaa 248,236,188
s_waitcnt lgkmcnt(8)
Ve 10,174
Cvaa 204,240,128,32
VE 11,175
Mvaa 204,244,132
Vc 86,8,9
Vc 87,10,11
Mvaa 204,248,136
VE 12,188
Mvaa 204,252,140
VE 13,189
Cvaa 220,240,144,36
Vc 94,12,13
v_or3_b32 v7, v7, v78, v79
Mvaa 220,244,148
VE 14,190
Mvaa 220,248,152
VE 15,191
Mvaa 220,252,156
Vc 95,14,15
v_or3_b32 v7, v7, v86, v87
Cvaa 236,240,160,40
v_or3_b32 v7, v7, v94, v95
v_and_b32 v1, 0x40004000, v7
Mvaa 236,244,164
v_cmp_ne_u32 vcc, 0, v1
Mvaa 236,248,168
Mvaa 236,252,172
s_cmp_ge_u32 s37, s46
Cvaa 252,240,176,44
s_waitcnt vmcnt(12)
Mvaa 252,244,180
s_barrier
Mvaa 252,248,184
s_waitcnt lgkmcnt(4)
Mvaa 252,252,188
s_cbranch_vccnz L_k2_fb_we
L_k2_fbr_we:
Maav 0,192,64
s_cbranch_scc1 L_k2_mk_we
L_k2_mkr_we:
Ve 8,192
Maav 0,196,68
s_add_u32 m0, s54, 49152
VE 9,193
Maav 32,192,72
buffer_load_dwordx4 v4, s[12:15], s39 offen offset:0 sc1 lds
Maav 32,196,76
s_add_u32 s37, s37, 1
Ra 224,2,24576
Vc 96,8,9
Maav 64,192,80
s_add_u32 s38, s38, 34816
Ve 10,194
Maav 64,196,84
VE 11,195
Maav 96,192,88
Ra 228,2,25600
Vc 97,10,11
Maav 96,196,92
Ra 232,2,26624
v_or_b32_e64 v7, v96, v97
Maav 4,200,64
VE 12,208
Maav 4,204,68
VE 13,209
Maav 36,200,72
Ra 236,2,27648
Vc 104,12,13
Maav 36,204,76
VE 14,210
Maav 68,200,80
VE 15,211
Maav 68,204,84
Ra 240,2,28672
Vc 105,14,15
Maav 100,200,88
Ra 244,2,29696
v_or3_b32 v7, v7, v104, v105
Maav 100,204,92
buffer_load_dwordx4 v4, s[12:15], s39 offen offset:1024 sc1 lds
Mvvv 48,16,64
VE 8,224
Mvvv 48,16,68
s_waitcnt lgkmcnt(6)
Ve 9,225
Maav 8,208,64
Ra 248,2,30720
Vc 112,8,9
Maav 8,212,68
VE 10,226
Maav 40,208,72
VE 11,227
Maav 40,212,76
Ra 252,2,31744
Vc 113,10,11
Maav 72,208,80
Ra 192,3,0
v_or3_b32 v7, v7, v112, v113
Maav 72,212,84
VE 12,240
Maav 104,208,88
VE 13,241
Maav 104,212,92
Ra 196,3,1024
Vc 120,12,13
Maav 12,216,64
VE 14,242
Maav 12,220,68
VE 15,243
Maav 44,216,72
Ra 200,3,2048
Vc 121,14,15
Maav 44,220,76
buffer_load_dwordx4 v4, s[12:15], s39 offen offset:2048 sc1 lds
Maav 76,216,80
Ra 204,3,3072
v_or3_b32 v7, v7, v120, v121
Maav 76,220,84
VE 8,196
Maav 108,216,88
VE 9,197
Maav 108,220,92
VE 10,198
Mvvv 52,16,72
VE 11,199
Mvvv 52,16,76
s_waitcnt lgkmcnt(8)
Ve 12,212
Maav 16,224,64
Ra 208,3,4096
Vc 98,8,9
Maav 16,228,68
Ra 212,3,5120
Vc 99,10,11
Maav 48,224,72
Ra 216,3,6144
v_or3_b32 v7, v7, v98, v99
Maav 48,228,76
VE 13,213
Maav 80,224,80
Ra 220,3,7168
Vc 106,12,13
Maav 80,228,84
VE 14,214
Maav 112,224,88
buffer_load_dwordx4 v4, s[12:15], s39 offen offset:3072 sc1 lds
Maav 112,228,92
s_add_u32 s39, s39, 34816
VE 15,215
Maav 20,232,64
VE 8,228
Maav 20,236,68
VE 9,229
Maav 52,232,72
VE 10,230
Maav 52,236,76
VE 11,231
Maav 84,232,80
Vc 107,14,15
Vc 114,8,9
Maav 84,236,84
VE 12,244
Maav 116,232,88
VE 13,245
Maav 116,236,92
Vc 115,10,11
Vc 122,12,13
Mvvv 56,16,80
VE 14,246
Mvvv 56,16,84
s_waitcnt lgkmcnt(8)
Ve 15,247
Maav 24,240,64
Vc 123,14,15
v_or3_b32 v7, v7, v106, v107
Maav 24,244,68
v_or3_b32 v7, v7, v114, v115
v_or3_b32 v7, v7, v122, v123
Maav 56,240,72
global_load_dword v30, v[28:29], off
Maav 56,244,76
Maav 88,240,80
Maav 88,244,84
Maav 120,240,88
Maav 120,244,92
Maav 28,248,64
Maav 28,252,68
Maav 60,248,72
Maav 60,252,76
Maav 92,248,80
Maav 92,252,84
Maav 124,248,88
Maav 124,252,92
s_cmp_eq_u32 s37, s35
Mvvv 60,16,88
s_waitcnt lgkmcnt(4)
Mvvv 60,16,92
s_cbranch_scc1 L_k2_trans
Ve 8,200
Cvaa 128,192,128,32
s_add_u32 m0, s53, 32768
Ra 224,3,8192
v_lshl_add_u64 v[28:29], s[40:41], 0, v[28:29]
Mvaa 128,196,132
buffer_load_dwordx4 v4, s[12:15], s38 offen offset:0 sc1 lds
Mvaa 128,200,136
VE 9,201
Mvaa 128,204,140
Ra 228,3,9216
Vc 100,8,9
Cvaa 144,192,144,36
VE 10,202
Mvaa 144,196,148
VE 11,203
Mvaa 144,200,152
Ra 232,3,10240
Vc 101,10,11
Mvaa 144,204,156
Ra 236,3,11264
v_or3_b32 v7, v7, v100, v101
Cvaa 160,192,160,40
VE 12,216
Mvaa 160,196,164
VE 13,217
Mvaa 160,200,168
Ra 240,3,12288
Vc 108,12,13
Mvaa 160,204,172
VE 14,218
Cvaa 176,192,176,44
VE 15,219
Mvaa 176,196,180
Ra 244,3,13312
Vc 109,14,15
Mvaa 176,200,184
Ra 248,3,14336
v_or3_b32 v7, v7, v108, v109
Mvaa 176,204,188
s_waitcnt lgkmcnt(7)
Ve 8,232
Cvaa 132,208,128,32
buffer_load_dwordx4 v4, s[12:15], s38 offen offset:1024 sc1 lds
Mvaa 132,212,132
VE 9,233
Mvaa 132,216,136
Ra 252,3,15360
Vc 116,8,9
Mvaa 132,220,140
VE 10,234
Cvaa 148,208,144,36
VE 11,235
Mvaa 148,212,148
Ra 192,2,49152
Vc 117,10,11
Mvaa 148,216,152
Ra 196,2,50176
v_or3_b32 v7, v7, v116, v117
Mvaa 148,220,156
VE 12,248
Cvaa 164,208,160,40
VE 13,249
Mvaa 164,212,164
Ra 200,2,51200
Vc 124,12,13
Mvaa 164,216,168
VE 14,250
Mvaa 164,220,172
VE 15,251
Cvaa 180,208,176,44
Ra 204,2,52224
Vc 125,14,15
Mvaa 180,212,180
buffer_load_dwordx4 v4, s[12:15], s38 offen offset:2048 sc1 lds
Mvaa 180,216,184
VE 8,204
Mvaa 180,220,188
s_waitcnt lgkmcnt(8)
Ve 9,205
Cvaa 136,224,128,32
Ra 208,2,53248
Vc 102,8,9
Mvaa 136,228,132
Ra 212,2,54272
v_or3_b32 v7, v7, v124, v125
Mvaa 136,232,136
VE 10,206
Mvaa 136,236,140
VE 11,207
Cvaa 152,224,144,36
Ra 216,2,55296
Vc 103,10,11
Mvaa 152,228,148
Ra 220,2,56320
v_or3_b32 v7, v7, v102, v103
Mvaa 152,232,152
VE 12,220
Mvaa 152,236,156
VE 13,221
Cvaa 168,224,160,40
VE 14,222
Mvaa 168,228,164
VE 15,223
Mvaa 168,232,168
VE 8,236
Mvaa 168,236,172
buffer_load_dwordx4 v4, s[12:15], s38 offen offset:3072 sc1 lds
Cvaa 184,224,176,44
VE 9,237
Mvaa 184,228,180
Vc 110,12,13
Vc 111,14,15
Mvaa 184,232,184
VE 10,238
Mvaa 184,236,188
s_waitcnt lgkmcnt(8)
Ve 11,239
Cvaa 140,240,128,32
Vc 118,8,9
Vc 119,10,11
Mvaa 140,244,132
VE 12,252
Mvaa 140,248,136
VE 13,253
Mvaa 140,252,140
Vc 126,12,13
v_or3_b32 v7, v7, v110, v111
Cvaa 156,240,144,36
VE 14,254
Mvaa 156,244,148
VE 15,255
Mvaa 156,248,152
Vc 127,14,15
v_or3_b32 v7, v7, v118, v119
Mvaa 156,252,156
v_or3_b32 v7, v7, v126, v127
v_and_b32 v1, 0x40004000, v7
Cvaa 172,240,160,40
v_cmp_ne_u32 vcc, 0, v1
Mvaa 172,244,164
Mvaa 172,248,168
Mvaa 172,252,172
s_cmp_ge_u32 s37, s46
Cvaa 188,240,176,44
s_waitcnt vmcnt(12)
Mvaa 188,244,180
s_barrier
Mvaa 188,248,184
s_waitcnt lgkmcnt(4)
Mvaa 188,252,188
s_cbranch_vccnz L_k2_fb_wo
L_k2_fbr_wo:
Maav 0,192,96
s_cbranch_scc1 L_k2_mk_wo
L_k2_mkr_wo:
Ve 8,128
Maav 0,196,100
s_add_u32 m0, s53, 16384
VE 9,129
Maav 32,192,104
buffer_load_dwordx4 v4, s[12:15], s39 offen offset:0 sc1 lds
Maav 32,196,108
s_add_u32 s37, s37, 1
Ra 224,2,57344
Vc 64,8,9
Maav 64,192,112
s_add_u32 s38, s38, 34816
Ve 10,130
Maav 64,196,116
s_xor_b32 s53, s53, 65536
VE 11,131
Maav 96,192,120
s_xor_b32 s54, s54, 65536
Ra 228,2,58368
Vc 65,10,11
Maav 96,196,124
Ra 232,2,59392
v_or_b32_e64 v7, v64, v65
Maav 4,200,96
VE 12,144
Maav 4,204,100
VE 13,145
Maav 36,200,104
Ra 236,2,60416
Vc 72,12,13
Maav 36,204,108
VE 14,146
Maav 68,200,112
VE 15,147
Maav 68,204,116
Ra 240,2,61440
Vc 73,14,15
Maav 100,200,120
Ra 244,2,62464
v_or3_b32 v7, v7, v72, v73
Maav 100,204,124
buffer_load_dwordx4 v4, s[12:15], s39 offen offset:1024 sc1 lds
Mvvv 48,16,96
VE 8,160
Mvvv 48,16,100
s_waitcnt lgkmcnt(6)
Ve 9,161
Maav 8,208,96
Ra 248,2,63488
Vc 80,8,9
Maav 8,212,100
VE 10,162
Maav 40,208,104
VE 11,163
Maav 40,212,108
Ra 252,2,64512
Vc 81,10,11
Maav 72,208,112
Ra 192,3,32768
v_or3_b32 v7, v7, v80, v81
Maav 72,212,116
VE 12,176
Maav 104,208,120
VE 13,177
Maav 104,212,124
Ra 196,3,33792
Vc 88,12,13
Maav 12,216,96
VE 14,178
Maav 12,220,100
VE 15,179
Maav 44,216,104
Ra 200,3,34816
Vc 89,14,15
Maav 44,220,108
buffer_load_dwordx4 v4, s[12:15], s39 offen offset:2048 sc1 lds
Maav 76,216,112
Ra 204,3,35840
v_or3_b32 v7, v7, v88, v89
Maav 76,220,116
VE 8,132
Maav 108,216,120
VE 9,133
Maav 108,220,124
VE 10,134
Mvvv 52,16,104
VE 11,135
Mvvv 52,16,108
s_waitcnt lgkmcnt(8)
Ve 12,148
Maav 16,224,96
Ra 208,3,36864
Vc 66,8,9
Maav 16,228,100
Ra 212,3,37888
Vc 67,10,11
Maav 48,224,104
Ra 216,3,38912
v_or3_b32 v7, v7, v66, v67
Maav 48,228,108
VE 13,149
Maav 80,224,112
Ra 220,3,39936
Vc 74,12,13
Maav 80,228,116
VE 14,150
Maav 112,224,120
buffer_load_dwordx4 v4, s[12:15], s39 offen offset:3072 sc1 lds
Maav 112,228,124
s_add_u32 s39, s39, 34816
VE 15,151
Maav 20,232,96
VE 8,164
Maav 20,236,100
VE 9,165
Maav 52,232,104
VE 10,166
Maav 52,236,108
VE 11,167
Maav 84,232,112
Vc 75,14,15
Vc 82,8,9
Maav 84,236,116
VE 12,180
Maav 116,232,120
VE 13,181
Maav 116,236,124
Vc 83,10,11
Vc 90,12,13
Mvvv 56,16,112
VE 14,182
Mvvv 56,16,116
s_waitcnt lgkmcnt(8)
Ve 15,183
Maav 24,240,96
Vc 91,14,15
v_or3_b32 v7, v7, v74, v75
Maav 24,244,100
v_or3_b32 v7, v7, v82, v83
v_or3_b32 v7, v7, v90, v91
Maav 56,240,104
global_load_dword v30, v[28:29], off
Maav 56,244,108
Maav 88,240,112
Maav 88,244,116
Maav 120,240,120
Maav 120,244,124
Maav 28,248,96
Maav 28,252,100
Maav 60,248,104
Maav 60,252,108
Maav 92,248,112
Maav 92,252,116
Maav 124,248,120
Maav 124,252,124
Mvvv 60,16,120
s_waitcnt lgkmcnt(4)
Mvvv 60,16,124
s_branch L_k2_wloop
L_k2_trans:
VE 8,200
Cvaa 128,192,128,32
s_add_u32 m0, s53, 32768
VE 9,201
Mvaa 128,196,132
buffer_load_dwordx4 v4, s[12:15], s38 offen offset:0 sc1 lds
Mvaa 128,200,136
Ra 224,3,8192
Vc 100,8,9
Mvaa 128,204,140
VE 10,202
Cvaa 144,192,144,36
VE 11,203
Mvaa 144,196,148
Ra 228,3,9216
Vc 101,10,11
Mvaa 144,200,152
Ra 232,3,10240
v_or3_b32 v7, v7, v100, v101
Mvaa 144,204,156
s_waitcnt lgkmcnt(3)
Ra 236,3,11264
Ra 240,3,12288
Cvaa 132,208,128,32
buffer_load_dwordx4 v4, s[12:15], s38 offen offset:1024 sc1 lds
Mvaa 132,212,132
Ve 12,216
Mvaa 132,216,136
VE 13,217
Mvaa 132,220,140
Ra 244,3,13312
Vc 108,12,13
Cvaa 148,208,144,36
VE 14,218
Mvaa 148,212,148
buffer_load_dwordx4 v4, s[12:15], s38 offen offset:2048 sc1 lds
Mvaa 148,216,152
VE 15,219
Mvaa 148,220,156
s_waitcnt lgkmcnt(2)
Ra 248,3,14336
Ra 252,3,15360
Cvaa 136,224,128,32
Ra 192,2,49152
Vc 109,14,15
Mvaa 136,228,132
Ra 196,2,50176
v_or3_b32 v7, v7, v108, v109
Mvaa 136,232,136
Ve 8,232
Mvaa 136,236,140
buffer_load_dwordx4 v4, s[12:15], s38 offen offset:3072 sc1 lds
Cvaa 152,224,144,36
VE 9,233
Mvaa 152,228,148
Ra 200,2,51200
Vc 116,8,9
Mvaa 152,232,152
VE 10,234
Mvaa 152,236,156
s_waitcnt lgkmcnt(3)
Ra 204,2,52224
Ra 208,2,53248
Cvaa 140,240,128,32
Ve 11,235
Mvaa 140,244,132
Ra 212,2,54272
Vc 117,10,11
Mvaa 140,248,136
Ra 216,2,55296
v_or3_b32 v7, v7, v116, v117
Mvaa 140,252,140
s_cmp_ge_u32 s37, s45
Ve 12,248
Cvaa 156,240,144,36
s_waitcnt vmcnt(12)
Ve 13,249
Mvaa 156,244,148
s_barrier
Ra 220,2,56320
Vc 124,12,13
Mvaa 156,248,152
s_waitcnt lgkmcnt(4)
Ve 14,250
Ve 15,251
Ve 8,204
Ve 9,205
Ve 10,206
Ve 11,207
Ve 12,220
Ve 13,221
Vc 125,14,15
Ve 14,222
Ve 15,223
Vc 102,8,9
Ve 8,236
Ve 9,237
Vc 103,10,11
Ve 10,238
Ve 11,239
Vc 110,12,13
Ve 12,252
Ve 13,253
Vc 111,14,15
Ve 14,254
Ve 15,255
Vc 118,8,9
Vc 119,10,11
Vc 126,12,13
Vc 127,14,15
v_or3_b32 v7, v7, v124, v125
v_or3_b32 v7, v7, v102, v103
v_or3_b32 v7, v7, v110, v111
v_or3_b32 v7, v7, v118, v119
v_or3_b32 v7, v7, v126, v127
v_and_b32 v1, 0x40004000, v7
v_cmp_ne_u32 vcc, 0, v1
Mvaa 156,252,156
s_cbranch_vccnz L_k2_fb_tr
L_k2_fbr_tr:
Maav 0,192,96
s_cbranch_scc1 L_k2_mk_tr
L_k2_mkr_tr:
Ve 8,128
Maav 0,196,100
s_add_u32 m0, s53, 16384
VE 9,129
Maav 32,192,104
buffer_load_dwordx4 v4, s[12:15], s39 offen offset:0 sc1 lds
Maav 32,196,108
s_add_u32 s37, s37, 1
Ra 224,2,57344
Vc 64,8,9
Maav 64,192,112
s_add_u32 s38, s38, 34816
Ve 10,130
Maav 64,196,116
s_xor_b32 s53, s53, 65536
VE 11,131
Maav 96,192,120
s_xor_b32 s54, s54, 65536
Ra 228,2,58368
Vc 65,10,11
Maav 96,196,124
Ra 232,2,59392
v_or_b32_e64 v7, v64, v65
Maav 4,200,96
VE 12,144
Maav 4,204,100
VE 13,145
Maav 36,200,104
Ra 236,2,60416
Vc 72,12,13
Maav 36,204,108
VE 14,146
Maav 68,200,112
VE 15,147
Maav 68,204,116
Ra 240,2,61440
Vc 73,14,15
Maav 100,200,120
Ra 244,2,62464
v_or3_b32 v7, v7, v72, v73
Maav 100,204,124
VE 8,132
Mvvv 48,16,96
VE 9,133
Mvvv 48,16,100
s_waitcnt lgkmcnt(6)
Ra 248,2,63488
Vc 66,8,9
Maav 8,208,96
Ve 10,134
Maav 8,212,100
buffer_load_dwordx4 v4, s[12:15], s39 offen offset:1024 sc1 lds
Maav 40,208,104
VE 11,135
Maav 40,212,108
Ra 252,2,64512
Vc 67,10,11
Maav 72,208,112
Ra 192,3,32768
v_or3_b32 v7, v7, v66, v67
Maav 72,212,116
VE 12,148
Maav 104,208,120
VE 13,149
Maav 104,212,124
Ra 196,3,33792
Vc 74,12,13
Maav 12,216,96
VE 14,150
Maav 12,220,100
VE 15,151
Maav 44,216,104
Ra 200,3,34816
Vc 75,14,15
Maav 44,220,108
Ra 204,3,35840
v_or3_b32 v7, v7, v74, v75
Maav 76,216,112
VE 8,136
Maav 76,220,116
Maav 108,216,120
Maav 108,220,124
Mvvv 52,16,104
Mvvv 52,16,108
s_waitcnt lgkmcnt(8)
Maav 16,224,96
buffer_load_dwordx4 v4, s[12:15], s39 offen offset:2048 sc1 lds
Maav 16,228,100
Ra 208,3,36864
Ra 212,3,37888
Maav 48,224,104
Ra 216,3,38912
Ra 220,3,39936
Maav 48,228,108
Maav 80,224,112
Maav 80,228,116
Maav 112,224,120
Maav 112,228,124
Maav 20,232,96
Maav 20,236,100
Maav 52,232,104
Maav 52,236,108
Maav 84,232,112
Maav 84,236,116
Maav 116,232,120
Maav 116,236,124
Mvvv 56,16,112
Mvvv 56,16,116
s_waitcnt lgkmcnt(8)
Maav 24,240,96
buffer_load_dwordx4 v4, s[12:15], s39 offen offset:3072 sc1 lds
Maav 24,244,100
s_add_u32 s39, s39, 34816
Maav 56,240,104
Maav 56,244,108
Maav 88,240,112
Maav 88,244,116
Maav 120,240,120
Maav 120,244,124
Maav 28,248,96
Maav 28,252,100
Maav 60,248,104
Maav 60,252,108
Maav 92,248,112
Maav 92,252,116
Maav 124,248,120
Maav 124,252,124
Mvvv 60,16,120
s_waitcnt lgkmcnt(4)
Mvvv 60,16,124
s_getpc_b64 s[56:57]
L_cpf4:
s_add_u32 s56, s56, (L_k2_fin-L_cpf4)&0xffffffff
s_addc_u32 s57, s57, ((L_k2_fin-L_cpf4)>>32)&0xffffffff
s_lshr_b32 s58, s2, 3
s_lshl_b32 s58, s58, 2
s_add_u32 s58, s58, s32
s_lshl_b32 s58, s58, 10
v_and_b32 v162, 7, v0
v_lshlrev_b32 v162, 7, v162
v_add_u32_e64 v162, s58, v162
v_min_u32 v162, L_p4_end-L_k2_fin-4, v162
v_mov_b32 v161, s57
v_add_co_u32 v160, vcc, s56, v162
s_nop 1
v_addc_co_u32 v161, vcc, 0, v161, vcc
global_load_dword v164, v[160:161], off
s_waitcnt vmcnt(9)
s_lshl_b32 s3, s34, 20
s_lshl_b32 s47, s33, 15
s_add_u32 s3, s3, s47
s_lshl_b32 s47, s32, 11
s_add_u32 s3, s3, s47
v_lshlrev_b32 v23, 4, v0
v_rcp_f32 v21, v56
v_rcp_f32_e64 v22, v60
Ar 240,64
Ar 241,65
Ar 242,66
Ar 243,67
Ar 244,68
Ar 245,69
Ar 246,70
Ar 247,71
Vm 240,240,21
Vm 241,241,21
Vm 242,242,21
Vm 243,243,21
Vm 244,244,21
Vm 245,245,21
Vm 246,246,21
Vm 247,247,21
Vc 24,240,241
Vc 25,242,243
Vc 26,244,245
Vc 27,246,247
buffer_store_dwordx4 v[24:27], v23, s[16:19], s3 offen offset:0 sc1
Ar 240,96
Ar 241,97
Ar 242,98
Ar 243,99
Ar 244,100
Ar 245,101
Ar 246,102
Ar 247,103
Vm 240,240,22
Vm 241,241,22
Vm 242,242,22
Vm 243,243,22
Vm 244,244,22
Vm 245,245,22
Vm 246,246,22
Vm 247,247,22
Vc 28,240,241
Vc 29,242,243
Vc 30,244,245
Vc 31,246,247
buffer_store_dwordx4 v[28:31], v23, s[16:19], s3 offen offset:1024 sc1
s_add_u32 s3, s3, 8192
Ar 240,72
Ar 241,73
Ar 242,74
Ar 243,75
Ar 244,76
Ar 245,77
Ar 246,78
Ar 247,79
Vm 240,240,21
Vm 241,241,21
Vm 242,242,21
Vm 243,243,21
Vm 244,244,21
Vm 245,245,21
Vm 246,246,21
Vm 247,247,21
Vc 24,240,241
Vc 25,242,243
Vc 26,244,245
Vc 27,246,247
buffer_store_dwordx4 v[24:27], v23, s[16:19], s3 offen offset:0 sc1
Ar 240,104
Ar 241,105
Ar 242,106
Ar 243,107
Ar 244,108
Ar 245,109
Ar 246,110
Ar 247,111
Vm 240,240,22
Vm 241,241,22
Vm 242,242,22
Vm 243,243,22
Vm 244,244,22
Vm 245,245,22
Vm 246,246,22
Vm 247,247,22
Vc 28,240,241
Vc 29,242,243
Vc 30,244,245
Vc 31,246,247
buffer_store_dwordx4 v[28:31], v23, s[16:19], s3 offen offset:1024 sc1
s_add_u32 s3, s3, 8192
Ar 240,80
Ar 241,81
Ar 242,82
Ar 243,83
Ar 244,84
Ar 245,85
Ar 246,86
Ar 247,87
Vm 240,240,21
Vm 241,241,21
Vm 242,242,21
Vm 243,243,21
Vm 244,244,21
Vm 245,245,21
Vm 246,246,21
Vm 247,247,21
Vc 24,240,241
Vc 25,242,243
Vc 26,244,245
Vc 27,246,247
buffer_store_dwordx4 v[24:27], v23, s[16:19], s3 offen offset:0 sc1
Ar 240,112
Ar 241,113
Ar 242,114
Ar 243,115
Ar 244,116
Ar 245,117
Ar 246,118
Ar 247,119
Vm 240,240,22
Vm 241,241,22
Vm 242,242,22
Vm 243,243,22
Vm 244,244,22
Vm 245,245,22
Vm 246,246,22
Vm 247,247,22
Vc 28,240,241
Vc 29,242,243
Vc 30,244,245
Vc 31,246,247
buffer_store_dwordx4 v[28:31], v23, s[16:19], s3 offen offset:1024 sc1
s_add_u32 s3, s3, 8192
Ar 240,88
Ar 241,89
Ar 242,90
Ar 243,91
Ar 244,92
Ar 245,93
Ar 246,94
Ar 247,95
Vm 240,240,21
Vm 241,241,21
Vm 242,242,21
Vm 243,243,21
Vm 244,244,21
Vm 245,245,21
Vm 246,246,21
Vm 247,247,21
Vc 24,240,241
Vc 25,242,243
Vc 26,244,245
Vc 27,246,247
buffer_store_dwordx4 v[24:27], v23, s[16:19], s3 offen offset:0 sc1
Ar 240,120
Ar 241,121
Ar 242,122
Ar 243,123
Ar 244,124
Ar 245,125
Ar 246,126
Ar 247,127
Vm 240,240,22
Vm 241,241,22
Vm 242,242,22
Vm 243,243,22
Vm 244,244,22
Vm 245,245,22
Vm 246,246,22
Vm 247,247,22
Vc 28,240,241
Vc 29,242,243
Vc 30,244,245
Vc 31,246,247
buffer_store_dwordx4 v[28:31], v23, s[16:19], s3 offen offset:1024 sc1
s_add_u32 s52, s37, 2
s_waitcnt vmcnt(8)
L_k2_nloop:
v_xor_b32 v2, 65536, v2
v_xor_b32 v3, 65536, v3
Cvaa 192,192,128,32
s_mov_b32 m0, s53
Ve 9,137
Mvaa 192,196,132
buffer_load_dwordx4 v4, s[12:15], s38 offen offset:0 sc1 lds
Mvaa 192,200,136
Ra 224,2,40960
Vc 68,8,9
Mvaa 192,204,140
VE 10,138
Cvaa 208,192,144,36
VE 11,139
Mvaa 208,196,148
Ra 228,2,41984
Vc 69,10,11
Mvaa 208,200,152
Ra 232,2,43008
v_or3_b32 v7, v7, v68, v69
Mvaa 208,204,156
s_waitcnt lgkmcnt(3)
Ra 236,2,44032
Ra 240,2,45056
Cvaa 196,208,128,32
buffer_load_dwordx4 v4, s[12:15], s38 offen offset:1024 sc1 lds
Mvaa 196,212,132
Ve 12,152
Mvaa 196,216,136
VE 13,153
Mvaa 196,220,140
Ra 244,2,46080
Vc 76,12,13
Cvaa 212,208,144,36
VE 14,154
Mvaa 212,212,148
buffer_load_dwordx4 v4, s[12:15], s38 offen offset:2048 sc1 lds
Mvaa 212,216,152
VE 15,155
Mvaa 212,220,156
s_waitcnt lgkmcnt(2)
Ra 248,2,47104
Ra 252,2,48128
Cvaa 200,224,128,32
Ra 192,2,16384
Vc 77,14,15
Mvaa 200,228,132
Ra 196,2,17408
v_or3_b32 v7, v7, v76, v77
Mvaa 200,232,136
Ve 8,140
Mvaa 200,236,140
buffer_load_dwordx4 v4, s[12:15], s38 offen offset:3072 sc1 lds
Cvaa 216,224,144,36
VE 9,141
Mvaa 216,228,148
Ra 200,2,18432
Vc 70,8,9
Mvaa 216,232,152
VE 10,142
Mvaa 216,236,156
s_waitcnt lgkmcnt(3)
Ra 204,2,19456
Ra 208,2,20480
Cvaa 204,240,128,32
Ve 11,143
Mvaa 204,244,132
s_cmp_lt_u32 s37, s52
Ra 212,2,21504
Vc 71,10,11
Mvaa 204,248,136
s_cbranch_scc1 L_nw_ne
s_waitcnt vmcnt(12)
L_nw_ne:
Ra 216,2,22528
v_or3_b32 v7, v7, v70, v71
Mvaa 204,252,140
s_cmp_ge_u32 s37, s45
VE 12,156
Cvaa 220,240,144,36
VE 13,157
Mvaa 220,244,148
s_barrier
Ra 220,2,23552
Vc 78,12,13
Mvaa 220,248,152
s_waitcnt lgkmcnt(4)
Ve 14,158
Ve 15,159
s_nop 0
Vc 79,14,15
v_or3_b32 v7, v7, v78, v79
v_and_b32 v1, 0x40004000, v7
v_cmp_ne_u32 vcc, 0, v1
Mvaa 220,252,156
s_cbranch_vccnz L_k2_fb_ne
L_k2_fbr_ne:
Maav 0,192,64
s_cbranch_scc1 L_k2_mk_ne
L_k2_mkr_ne:
VE 8,192
Maav 0,196,68
s_add_u32 m0, s54, 49152
VE 9,193
Maav 32,192,72
buffer_load_dwordx4 v4, s[12:15], s39 offen offset:0 sc1 lds
Maav 32,196,76
s_cmp_eq_u32 s37, s52
Ra 224,2,24576
Vc 96,8,9
Maav 4,200,64
s_cbranch_scc1 L_pubB
L_pubBr:
VE 10,194
Maav 4,204,68
s_add_u32 s37, s37, 1
Ve 11,195
Maav 36,200,72
s_add_u32 s38, s38, 34816
Ra 228,2,25600
Vc 97,10,11
Maav 36,204,76
Ra 232,2,26624
v_or_b32_e64 v7, v96, v97
Mvvv 48,16,64
VE 12,208
Mvvv 48,16,68
s_waitcnt lgkmcnt(3)
Ra 236,2,27648
Ra 240,2,28672
Maav 8,208,64
buffer_load_dwordx4 v4, s[12:15], s39 offen offset:1024 sc1 lds
Maav 8,212,68
Ve 13,209
Maav 40,208,72
Ra 244,2,29696
Vc 104,12,13
Maav 40,212,76
VE 14,210
Maav 12,216,64
VE 15,211
Maav 12,220,68
Ra 248,2,30720
Vc 105,14,15
Maav 44,216,72
Ra 252,2,31744
v_or3_b32 v7, v7, v104, v105
Maav 44,220,76
VE 8,196
Mvvv 52,16,72
buffer_load_dwordx4 v4, s[12:15], s39 offen offset:2048 sc1 lds
Mvvv 52,16,76
s_waitcnt lgkmcnt(4)
Ve 9,197
Maav 16,224,64
Ra 192,3,0
Vc 98,8,9
Maav 16,228,68
VE 10,198
Maav 48,224,72
VE 11,199
Maav 48,228,76
Ra 196,3,1024
Vc 99,10,11
Maav 20,232,64
Ra 200,3,2048
v_or3_b32 v7, v7, v98, v99
Maav 20,236,68
Ra 204,3,3072
Ra 208,3,4096
Maav 52,232,72
buffer_load_dwordx4 v4, s[12:15], s39 offen offset:3072 sc1 lds
Maav 52,236,76
s_waitcnt lgkmcnt(5)
Ve 12,212
Maav 24,240,64
s_add_u32 s39, s39, 34816
VE 13,213
Maav 24,244,68
Ra 212,3,5120
Vc 106,12,13
Maav 56,240,72
VE 14,214
Maav 56,244,76
VE 15,215
Maav 28,248,64
Ra 216,3,6144
Vc 107,14,15
Maav 28,252,68
s_cmp_eq_u32 s37, s36
Ra 220,3,7168
v_or3_b32 v7, v7, v106, v107
Maav 60,248,72
s_waitcnt lgkmcnt(4)
VE 8,200
Maav 60,252,76
s_cbranch_scc1 L_k2_fin
Ve 9,201
Cvaa 128,192,128,32
s_add_u32 m0, s53, 32768
Ra 224,3,8192
Vc 100,8,9
Mvaa 128,196,132
buffer_load_dwordx4 v4, s[12:15], s38 offen offset:0 sc1 lds
Mvaa 128,200,136
VE 10,202
Mvaa 128,204,140
VE 11,203
Cvaa 144,192,144,36
Ra 228,3,9216
Vc 101,10,11
Mvaa 144,196,148
Ra 232,3,10240
v_or3_b32 v7, v7, v100, v101
Mvaa 144,200,152
VE 12,216
Mvaa 144,204,156
s_waitcnt lgkmcnt(3)
Ra 236,3,11264
Ra 240,3,12288
Cvaa 132,208,128,32
buffer_load_dwordx4 v4, s[12:15], s38 offen offset:1024 sc1 lds
Mvaa 132,212,132
Ve 13,217
Mvaa 132,216,136
Ra 244,3,13312
Vc 108,12,13
Mvaa 132,220,140
VE 14,218
Cvaa 148,208,144,36
VE 15,219
Mvaa 148,212,148
buffer_load_dwordx4 v4, s[12:15], s38 offen offset:2048 sc1 lds
Mvaa 148,216,152
Ra 248,3,14336
Vc 109,14,15
Mvaa 148,220,156
s_waitcnt lgkmcnt(3)
Ra 252,3,15360
v_or3_b32 v7, v7, v108, v109
Cvaa 136,224,128,32
Ve 8,204
Mvaa 136,228,132
VE 9,205
Mvaa 136,232,136
Ra 192,2,49152
Vc 102,8,9
Mvaa 136,236,140
buffer_load_dwordx4 v4, s[12:15], s38 offen offset:3072 sc1 lds
Cvaa 152,224,144,36
VE 10,206
Mvaa 152,228,148
VE 11,207
Mvaa 152,232,152
Ra 196,2,50176
Vc 103,10,11
Mvaa 152,236,156
s_waitcnt lgkmcnt(2)
Ra 200,2,51200
Ra 204,2,52224
Cvaa 140,240,128,32
Ra 208,2,53248
v_or3_b32 v7, v7, v102, v103
Mvaa 140,244,132
s_cmp_lt_u32 s37, s52
VE 12,220
Mvaa 140,248,136
s_cbranch_scc1 L_nw_no
s_waitcnt vmcnt(12)
L_nw_no:
VE 13,221
Mvaa 140,252,140
s_cmp_ge_u32 s37, s45
Ra 212,2,54272
Vc 110,12,13
Cvaa 156,240,144,36
Ve 14,222
Mvaa 156,244,148
s_barrier
Ve 15,223
Mvaa 156,248,152
s_waitcnt lgkmcnt(2)
Ra 216,2,55296
Vc 111,14,15
v_or3_b32 v7, v7, v110, v111
v_and_b32 v1, 0x40004000, v7
v_cmp_ne_u32 vcc, 0, v1
Mvaa 156,252,156
s_cbranch_vccnz L_k2_fb_no
L_k2_fbr_no:
Ra 220,2,56320
Maav 0,192,96
s_cbranch_scc1 L_k2_mk_no
L_k2_mkr_no:
VE 8,128
Maav 0,196,100
s_add_u32 m0, s53, 16384
VE 9,129
Maav 32,192,104
buffer_load_dwordx4 v4, s[12:15], s39 offen offset:0 sc1 lds
Maav 32,196,108
s_add_u32 s37, s37, 1
Ra 224,2,57344
Vc 64,8,9
Maav 4,200,96
s_add_u32 s38, s38, 34816
Ve 10,130
Maav 4,204,100
s_xor_b32 s53, s53, 65536
VE 11,131
Maav 36,200,104
s_xor_b32 s54, s54, 65536
Ra 228,2,58368
Vc 65,10,11
Maav 36,204,108
Ra 232,2,59392
v_or_b32_e64 v7, v64, v65
Mvvv 48,16,96
VE 12,144
Mvvv 48,16,100
s_waitcnt lgkmcnt(3)
Ra 236,2,60416
Ra 240,2,61440
Maav 8,208,96
buffer_load_dwordx4 v4, s[12:15], s39 offen offset:1024 sc1 lds
Maav 8,212,100
Ve 13,145
Maav 40,208,104
Ra 244,2,62464
Vc 72,12,13
Maav 40,212,108
VE 14,146
Maav 12,216,96
VE 15,147
Maav 12,220,100
Ra 248,2,63488
Vc 73,14,15
Maav 44,216,104
Ra 252,2,64512
v_or3_b32 v7, v7, v72, v73
Maav 44,220,108
VE 8,132
Mvvv 52,16,104
buffer_load_dwordx4 v4, s[12:15], s39 offen offset:2048 sc1 lds
Mvvv 52,16,108
s_waitcnt lgkmcnt(4)
Ve 9,133
Maav 16,224,96
Ra 192,3,32768
Vc 66,8,9
Maav 16,228,100
VE 10,134
Maav 48,224,104
VE 11,135
Maav 48,228,108
Ra 196,3,33792
Vc 67,10,11
Maav 20,232,96
Ra 200,3,34816
v_or3_b32 v7, v7, v66, v67
Maav 20,236,100
Ra 204,3,35840
Ra 208,3,36864
Maav 52,232,104
buffer_load_dwordx4 v4, s[12:15], s39 offen offset:3072 sc1 lds
Maav 52,236,108
s_waitcnt lgkmcnt(5)
Ve 12,148
Maav 24,240,96
s_add_u32 s39, s39, 34816
VE 13,149
Maav 24,244,100
Ra 212,3,37888
Vc 74,12,13
Maav 56,240,104
VE 14,150
Maav 56,244,108
VE 15,151
Maav 28,248,96
Ra 216,3,38912
Vc 75,14,15
Maav 28,252,100
Ra 220,3,39936
v_or3_b32 v7, v7, v74, v75
Maav 60,248,104
s_waitcnt lgkmcnt(4)
Ve 8,136
Maav 60,252,108
s_branch L_k2_nloop
L_k2_fin:
s_getpc_b64 s[56:57]
L_cpf5:
s_add_u32 s56, s56, (L_k2_fin-L_cpf5)&0xffffffff
s_addc_u32 s57, s57, ((L_k2_fin-L_cpf5)>>32)&0xffffffff
s_lshl_b32 s58, s32, 13
v_lshlrev_b32 v162, 7, v0
v_add_u32_e64 v162, s58, v162
v_min_u32 v162, L_p4_end-L_k2_fin-4, v162
v_mov_b32 v161, s57
v_add_co_u32 v160, vcc, s56, v162
s_nop 1
v_addc_co_u32 v161, vcc, 0, v161, vcc
global_load_dword v164, v[160:161], off
s_load_dwordx2 s[94:95], s[0:1], 40
s_load_dwordx2 s[40:41], s[0:1], 0
s_load_dwordx4 s[8:11], s[0:1], 80
s_waitcnt lgkmcnt(0)
s_nop 0
Ra 192,2,49152
Ra 196,2,50176
Ra 200,2,51200
Ra 204,2,52224
Ra 208,2,53248
Ra 212,2,54272
Ra 216,2,55296
Ra 220,2,56320
s_lshr_b32 s3, s42, 4
s_mul_i32 s3, s3, 33792
s_and_b32 s47, s42, 15
s_lshl_b32 s47, s47, 4
s_add_u32 s3, s3, s47
v_mov_b32 v28, s3
s_lshr_b32 s3, s43, 4
s_mul_i32 s3, s3, 33792
s_and_b32 s47, s43, 15
s_lshl_b32 s47, s47, 4
s_add_u32 s3, s3, s47
v_mov_b32 v29, s3
v_lshrrev_b32 v24, 4, v0
v_and_b32 v25, 15, v0
v_cmp_eq_u32 vcc, 1, v25
s_lshl_b32 s3, s32, 4
v_add_u32 v26, s3, v24
v_cndmask_b32 v28, v28, v29, vcc
v_lshl_add_u32 v28, v24, 8, v28
v_mul_u32_u24 v26, 7168, v26
v_lshlrev_b32 v24, 1, v24
v_xor_b32 v24, v24, v25
v_xor_b32_e64 v25, 8, v24
v_lshl_add_u32 v24, v24, 4, v26
v_lshl_add_u32 v25, v25, 4, v26
s_lshl_b32 s3, s92, 12
buffer_load_dwordx4 a[160:163], v28, s[20:23], s3 offen offset:0 sc1
buffer_load_dwordx4 a[164:167], v28, s[20:23], s3 offen offset:1024 sc1
buffer_load_dwordx4 a[168:171], v28, s[20:23], s3 offen offset:2048 sc1
buffer_load_dwordx4 a[172:175], v28, s[20:23], s3 offen offset:3072 sc1
s_add_u32 m0, s54, 0
s_add_u32 s3, s5, 0
buffer_load_dwordx4 v24, s[24:27], s3 offen offset:0 lds
Ve 9,201
VE 10,202
s_add_u32 s3, s5, 27648
buffer_load_dwordx4 v24, s[24:27], s3 offen offset:1024 lds
Ve 11,203
Ve 12,216
s_add_u32 s3, s5, 55296
buffer_load_dwordx4 v25, s[24:27], s3 offen offset:2048 lds
Ve 13,217
Ve 14,218
s_add_u32 s3, s5, 82944
buffer_load_dwordx4 v25, s[24:27], s3 offen offset:3072 lds
VE 15,219
Vc 100,8,9
s_add_u32 m0, s54, 16384
s_add_u32 s3, s5, 458752
buffer_load_dwordx4 v24, s[24:27], s3 offen offset:0 lds
Ve 8,204
Ve 9,205
s_add_u32 s3, s5, 486400
buffer_load_dwordx4 v24, s[24:27], s3 offen offset:1024 lds
Vc 101,10,11
VE 10,206
s_add_u32 s3, s5, 514048
buffer_load_dwordx4 v25, s[24:27], s3 offen offset:2048 lds
VE 11,207
Vc 108,12,13
s_add_u32 s3, s5, 541696
buffer_load_dwordx4 v25, s[24:27], s3 offen offset:3072 lds
Ve 12,220
Ve 13,221
s_add_u32 m0, s54, 32768
s_add_u32 s3, s5, 0
buffer_load_dwordx4 v24, s[68:71], s3 offen offset:0 lds
Vc 109,14,15
Ve 14,222
s_add_u32 s3, s5, 27648
buffer_load_dwordx4 v24, s[68:71], s3 offen offset:1024 lds
VE 15,223
Vc 102,8,9
s_add_u32 s3, s5, 55296
buffer_load_dwordx4 v25, s[68:71], s3 offen offset:2048 lds
Vc 103,10,11
Vc 110,12,13
s_add_u32 s3, s5, 82944
buffer_load_dwordx4 v25, s[68:71], s3 offen offset:3072 lds
Vc 111,14,15
v_or3_b32 v7, v7, v100, v101
s_add_u32 m0, s54, 49152
s_add_u32 s3, s5, 458752
buffer_load_dwordx4 v24, s[68:71], s3 offen offset:0 lds
v_or3_b32 v7, v7, v108, v109
v_or3_b32 v7, v7, v102, v103
s_add_u32 s3, s5, 486400
buffer_load_dwordx4 v24, s[68:71], s3 offen offset:1024 lds
v_or3_b32 v7, v7, v110, v111
v_and_b32 v1, 0x40004000, v7
s_add_u32 s3, s5, 514048
buffer_load_dwordx4 v25, s[68:71], s3 offen offset:2048 lds
v_cmp_ne_u32 vcc, 0, v1
s_add_u32 s3, s5, 541696
buffer_load_dwordx4 v25, s[68:71], s3 offen offset:3072 lds
s_waitcnt lgkmcnt(4)
s_cbranch_vccnz L_k2_fb_fi
L_k2_fbr_fi:
Maav 0,192,96
Ra 224,2,57344
Ra 228,2,58368
Maav 0,196,100
Ra 232,2,59392
Ra 236,2,60416
Maav 32,192,104
Ra 240,2,61440
Ra 244,2,62464
Maav 32,196,108
Ra 248,2,63488
Ra 252,2,64512
Maav 4,200,96
s_mov_b32 s60, s8
s_and_b32 s61, s9, 0xffff
s_mov_b32 s62, 7340032
Maav 4,204,100
s_mov_b32 s63, 0x20000
s_mov_b32 s68, s10
s_and_b32 s69, s11, 0xffff
Maav 36,200,104
s_mov_b32 s70, 4194304
s_mov_b32 s71, 0x20000
s_mov_b32 s56, s40
Maav 36,204,108
s_and_b32 s57, s41, 0xffff
s_mov_b32 s58, 4194304
s_mov_b32 s59, 0x20000
Mvvv 48,16,96
s_bfe_u32 s6, s2, 0x20001
s_lshr_b32 s7, s34, 1
s_lshl_b32 s45, s7, 2
Mvvv 48,16,100
s_waitcnt lgkmcnt(8)
Maav 8,208,96
s_add_u32 s46, s45, s6
s_sub_u32 s46, 15, s46
s_sub_u32 s45, 12, s45
Maav 8,212,100
s_add_u32 s45, s45, s6
s_cmp_lt_u32 s7, 2
s_cselect_b32 s45, s46, s45
Maav 40,208,104
s_and_b32 s46, s2, 1
s_lshl_b32 s46, s46, 3
s_bfe_u32 s6, s2, 0x30003
Maav 40,212,108
s_add_u32 s46, s46, s6
s_mov_b32 s48, 0
s_mov_b32 s49, 15360
Maav 12,216,96
s_mov_b32 s50, 30720
s_mov_b32 s51, 46080
s_lshl_b32 s35, s32, 15
Maav 12,220,100
s_lshl_b32 s6, s45, 20
s_lshl_b32 s7, s32, 18
s_add_u32 s6, s6, s7
Maav 44,216,104
s_add_u32 s6, s6, 46137344
s_add_u32 s8, s66, s6
s_addc_u32 s9, s67, 0
s_and_b32 s9, s9, 0xffff
Maav 44,220,108
s_mov_b32 s10, 262144
s_mov_b32 s11, 0x20000
s_lshl_b32 s7, s46, 7
Mvvv 52,16,104
s_lshl_b32 s6, s32, 21
s_add_u32 s6, s6, s7
s_add_u32 s12, s94, s6
s_addc_u32 s13, s95, 0
s_and_b32 s13, s13, 0xffff
Mvvv 52,16,108
s_waitcnt lgkmcnt(4)
Maav 16,224,96
s_mov_b32 s14, 0
s_mov_b32 s15, 0x20000
s_sub_u32 s14, 2097152, s7
Maav 16,228,100
s_mov_b32 s28, s94
s_and_b32 s29, s95, 0xffff
s_mov_b32 s30, 8388608
Maav 48,224,104
s_mov_b32 s31, 0x20000
s_lshl_b32 s36, s45, 18
s_add_u32 s36, s36, s7
Maav 48,228,108
s_mov_b32 s52, 0
s_lshl_b32 s38, s45, 7
s_lshl_b32 s6, s32, 5
Maav 20,232,96
s_add_u32 s38, s38, s6
s_add_u32 s38, s38, 5300224
v_lshlrev_b32 v112, 4, v0
v_add_u32 v113, 4096, v112
Maav 20,236,100
v_lshrrev_b32 v121, 4, v0
v_and_b32 v122, 7, v0
v_lshrrev_b32_e64 v123, 3, v0
Maav 52,232,104
v_lshlrev_b32 v124, 1, v121
v_xor_b32 v124, v124, v122
v_lshlrev_b32_e64 v124, 4, v124
Maav 52,236,108
s_waitcnt lgkmcnt(0)
Maav 24,240,96
v_lshl_add_u32 v114, v123, 11, v124
v_lshrrev_b32 v124, 2, v0
v_bfe_u32 v126, v0, 3, 2
Maav 24,244,100
v_lshlrev_b32 v124, 7, v124
v_and_b32 v125, 3, v0
v_lshl_add_u32 v124, v125, 3, v124
Maav 56,240,104
v_add_u32 v124, s35, v124
v_xor_b32 v125, 0, v126
v_lshl_add_u32 v115, v125, 5, v124
Maav 56,244,108
v_xor_b32_e64 v125, 1, v126
v_lshl_add_u32 v116, v125, 5, v124
v_xor_b32_e64 v125, 2, v126
Maav 28,248,96
v_lshl_add_u32 v117, v125, 5, v124
v_xor_b32_e64 v125, 3, v126
v_lshl_add_u32 v118, v125, 5, v124
Maav 28,252,100
s_lshl_b32 s6, s32, 3
v_add_u32 v120, s6, v123
v_lshlrev_b32_e64 v119, 11, v120
v_lshl_add_u32 v119, v122, 4, v119
Maav 60,248,104
v_mov_b32 v126, 0
v_lshlrev_b32 v127, 2, v122
Maav 60,252,108
s_nop 7
s_lshl_b32 s3, s55, 20
s_lshl_b32 s47, s33, 15
s_add_u32 s3, s3, s47
s_lshl_b32 s47, s32, 11
s_add_u32 s3, s3, s47
v_lshlrev_b32 v23, 4, v0
v_rcp_f32 v21, v48
v_rcp_f32_e64 v22, v52
Ar 240,0
Ar 241,1
Ar 242,2
Ar 243,3
Ar 244,4
Ar 245,5
Ar 246,6
Ar 247,7
Vm 240,240,21
Vm 241,241,21
Vm 242,242,21
Vm 243,243,21
Vm 244,244,21
Vm 245,245,21
Vm 246,246,21
Vm 247,247,21
Vc 24,240,241
Vc 25,242,243
Vc 26,244,245
Vc 27,246,247
buffer_store_dwordx4 v[24:27], v23, s[16:19], s3 offen offset:0 sc1
Ar 240,32
Ar 241,33
Ar 242,34
Ar 243,35
Ar 244,36
Ar 245,37
Ar 246,38
Ar 247,39
Vm 240,240,22
Vm 241,241,22
Vm 242,242,22
Vm 243,243,22
Vm 244,244,22
Vm 245,245,22
Vm 246,246,22
Vm 247,247,22
Vc 28,240,241
Vc 29,242,243
Vc 30,244,245
Vc 31,246,247
buffer_store_dwordx4 v[28:31], v23, s[16:19], s3 offen offset:1024 sc1
s_add_u32 s3, s3, 8192
Ar 240,8
Ar 241,9
Ar 242,10
Ar 243,11
Ar 244,12
Ar 245,13
Ar 246,14
Ar 247,15
Vm 240,240,21
Vm 241,241,21
Vm 242,242,21
Vm 243,243,21
Vm 244,244,21
Vm 245,245,21
Vm 246,246,21
Vm 247,247,21
Vc 24,240,241
Vc 25,242,243
Vc 26,244,245
Vc 27,246,247
buffer_store_dwordx4 v[24:27], v23, s[16:19], s3 offen offset:0 sc1
Ar 240,40
Ar 241,41
Ar 242,42
Ar 243,43
Ar 244,44
Ar 245,45
Ar 246,46
Ar 247,47
Vm 240,240,22
Vm 241,241,22
Vm 242,242,22
Vm 243,243,22
Vm 244,244,22
Vm 245,245,22
Vm 246,246,22
Vm 247,247,22
Vc 28,240,241
Vc 29,242,243
Vc 30,244,245
Vc 31,246,247
buffer_store_dwordx4 v[28:31], v23, s[16:19], s3 offen offset:1024 sc1
s_add_u32 s3, s3, 8192
Ar 240,16
Ar 241,17
Ar 242,18
Ar 243,19
Ar 244,20
Ar 245,21
Ar 246,22
Ar 247,23
Vm 240,240,21
Vm 241,241,21
Vm 242,242,21
Vm 243,243,21
Vm 244,244,21
Vm 245,245,21
Vm 246,246,21
Vm 247,247,21
Vc 24,240,241
Vc 25,242,243
Vc 26,244,245
Vc 27,246,247
buffer_store_dwordx4 v[24:27], v23, s[16:19], s3 offen offset:0 sc1
Ar 240,48
Ar 241,49
Ar 242,50
Ar 243,51
Ar 244,52
Ar 245,53
Ar 246,54
Ar 247,55
Vm 240,240,22
Vm 241,241,22
Vm 242,242,22
Vm 243,243,22
Vm 244,244,22
Vm 245,245,22
Vm 246,246,22
Vm 247,247,22
Vc 28,240,241
Vc 29,242,243
Vc 30,244,245
Vc 31,246,247
buffer_store_dwordx4 v[28:31], v23, s[16:19], s3 offen offset:1024 sc1
s_add_u32 s3, s3, 8192
Ar 240,24
Ar 241,25
Ar 242,26
Ar 243,27
Ar 244,28
Ar 245,29
Ar 246,30
Ar 247,31
Vm 240,240,21
Vm 241,241,21
Vm 242,242,21
Vm 243,243,21
Vm 244,244,21
Vm 245,245,21
Vm 246,246,21
Vm 247,247,21
Vc 24,240,241
Vc 25,242,243
Vc 26,244,245
Vc 27,246,247
buffer_store_dwordx4 v[24:27], v23, s[16:19], s3 offen offset:0 sc1
Ar 240,56
Ar 241,57
Ar 242,58
Ar 243,59
Ar 244,60
Ar 245,61
Ar 246,62
Ar 247,63
Vm 240,240,22
Vm 241,241,22
Vm 242,242,22
Vm 243,243,22
Vm 244,244,22
Vm 245,245,22
Vm 246,246,22
Vm 247,247,22
Vc 28,240,241
Vc 29,242,243
Vc 30,244,245
Vc 31,246,247
buffer_store_dwordx4 v[28:31], v23, s[16:19], s3 offen offset:1024 sc1
v_lshrrev_b32_e64 v24, 4, v0
v_bfe_u32 v25, v0, 2, 2
v_lshl_add_u32 v26, v24, 3, v25
v_lshlrev_b32 v26, 8, v26
v_and_b32 v27, 3, v0
v_lshl_add_u32 v26, v27, 3, v26
v_and_b32_e64 v27, 1, v24
v_lshl_add_u32 v25, v27, 2, v25
s_lshl_b32 s3, s32, 1
v_xor_b32 v25, s3, v25
v_lshl_add_u32 v26, v25, 5, v26
s_sub_u32 s3, s54, s44
v_add_u32 v26, s3, v26
v_xor_b32 v27, 32, v26
s_waitcnt vmcnt(8) lgkmcnt(0)
s_barrier
s_nop 0
ds_read_b64_tr_b16 v[128:129], v26 offset:0
ds_read_b64_tr_b16 v[130:131], v26 offset:1024
ds_read_b64_tr_b16 v[132:133], v27 offset:0
ds_read_b64_tr_b16 v[134:135], v27 offset:1024
ds_read_b64_tr_b16 v[136:137], v26 offset:8192
ds_read_b64_tr_b16 v[138:139], v26 offset:9216
ds_read_b64_tr_b16 v[140:141], v27 offset:8192
ds_read_b64_tr_b16 v[142:143], v27 offset:9216
ds_read_b64_tr_b16 v[144:145], v26 offset:16384
ds_read_b64_tr_b16 v[146:147], v26 offset:17408
ds_read_b64_tr_b16 v[148:149], v27 offset:16384
ds_read_b64_tr_b16 v[150:151], v27 offset:17408
ds_read_b64_tr_b16 v[152:153], v26 offset:24576
ds_read_b64_tr_b16 v[154:155], v26 offset:25600
ds_read_b64_tr_b16 v[156:157], v27 offset:24576
s_waitcnt lgkmcnt(9)
s_nop 0
ds_read_b64_tr_b16 v[158:159], v27 offset:25600
ds_read_b64_tr_b16 v[160:161], v26 offset:32768
ds_read_b64_tr_b16 v[162:163], v26 offset:33792
ds_read_b64_tr_b16 v[164:165], v27 offset:32768
ds_read_b64_tr_b16 v[166:167], v27 offset:33792
ds_read_b64_tr_b16 v[168:169], v26 offset:40960
s_waitcnt lgkmcnt(9)
s_nop 0
ds_read_b64_tr_b16 v[170:171], v26 offset:41984
ds_read_b64_tr_b16 v[172:173], v27 offset:40960
ds_read_b64_tr_b16 v[174:175], v27 offset:41984
ds_read_b64_tr_b16 v[176:177], v26 offset:49152
ds_read_b64_tr_b16 v[178:179], v26 offset:50176
ds_read_b64_tr_b16 v[180:181], v27 offset:49152
s_waitcnt lgkmcnt(9)
ds_read_b64_tr_b16 v[182:183], v27 offset:50176
ds_read_b64_tr_b16 v[184:185], v26 offset:57344
ds_read_b64_tr_b16 v[186:187], v26 offset:58368
ds_read_b64_tr_b16 v[188:189], v27 offset:57344
ds_read_b64_tr_b16 v[190:191], v27 offset:58368
v_and_b32 v25, 15, v0
v_mul_u32_u24 v28, 14336, v25
v_lshl_add_u32 v28, v24, 4, v28
v_mov_b32 v29, 2146435072
v_cmp_gt_u32 vcc, 2, v25
s_mul_i32 s3, s92, 57344
s_lshl_b32 s47, s4, 9
s_add_u32 s3, s3, s47
v_cndmask_b32 v28, v29, v28, vcc
s_lshl_b32 s47, s32, 7
s_add_u32 s3, s3, s47
s_add_u32 s3, s3, 6291456
Zvva 224,128,160
Zvva 228,132,160
Mvva 224,136,164
Mvva 228,140,164
Mvva 224,144,168
Mvva 228,148,168
Mvva 224,152,172
Mvva 228,156,172
s_waitcnt lgkmcnt(0)
Zvva 232,160,160
Zvva 236,164,160
Mvva 232,168,164
Mvva 236,172,164
Mvva 232,176,168
Mvva 236,180,168
Mvva 232,184,172
Mvva 236,188,172
v_mov_b32 v24, 1
v_mul_u32_u24 v25, s65, v0
s_waitcnt vmcnt(0)
s_barrier
s_mov_b64 exec, 3
buffer_store_dword v24, v25, s[20:23], s64 offen sc1
s_mov_b64 exec, -1
s_cmp_lg_u32 s34, 0
s_cselect_b32 s3, s3, 8388608
s_add_u32 s7, s3, 28672
buffer_store_dwordx4 v[224:227], v28, s[20:23], s3 offen offset:0 sc1
buffer_store_dwordx4 v[228:231], v28, s[20:23], s3 offen offset:64 sc1
buffer_store_dwordx4 v[232:235], v28, s[20:23], s7 offen offset:0 sc1
buffer_store_dwordx4 v[236:239], v28, s[20:23], s7 offen offset:64 sc1
s_cmp_lt_u32 s2, 128
s_cbranch_scc1 L_noc3
s_bfe_u32 s3, s2, 0x40003
s_mul_i32 s3, s3, 65536
s_lshl_b32 s7, s32, 21
s_add_u32 s3, s3, s7
s_and_b32 s7, s2, 1
s_lshl_b32 s7, s7, 10
s_add_u32 s3, s3, s7
s_add_u32 s3, s3, 384
v_and_b32 v11, 31, v0
v_lshlrev_b32 v11, 11, v11
buffer_load_dword v17, v11, s[28:31], s3 offen
L_noc3:
buffer_load_dword v124, v127, s[20:23], s38 offen sc1
s_add_u32 m0, s35, 0
s_nop 0
buffer_load_dwordx4 v114, s[12:15], s48 offen offset:0 lds
buffer_load_dwordx4 v114, s[12:15], s49 offen offset:1024 lds
buffer_load_dwordx4 v114, s[12:15], s50 offen offset:2048 lds
buffer_load_dwordx4 v114, s[12:15], s51 offen offset:3072 lds
v_add_u32 v114, 65536, v114
s_add_u32 m0, s35, 4096
s_nop 0
s_nop 0
buffer_load_dwordx4 v114, s[12:15], s48 offen offset:0 lds
buffer_load_dwordx4 v114, s[12:15], s49 offen offset:1024 lds
buffer_load_dwordx4 v114, s[12:15], s50 offen offset:2048 lds
buffer_load_dwordx4 v114, s[12:15], s51 offen offset:3072 lds
v_add_u32 v114, 65536, v114
s_add_u32 m0, s35, 8192
s_nop 0
s_nop 0
buffer_load_dwordx4 v114, s[12:15], s48 offen offset:0 lds
buffer_load_dwordx4 v114, s[12:15], s49 offen offset:1024 lds
buffer_load_dwordx4 v114, s[12:15], s50 offen offset:2048 lds
buffer_load_dwordx4 v114, s[12:15], s51 offen offset:3072 lds
v_add_u32 v114, 65536, v114
s_add_u32 m0, s35, 12288
s_nop 0
buffer_load_dwordx4 v114, s[12:15], s48 offen offset:0 lds
buffer_load_dwordx4 v114, s[12:15], s49 offen offset:1024 lds
buffer_load_dwordx4 v114, s[12:15], s50 offen offset:2048 lds
buffer_load_dwordx4 v114, s[12:15], s51 offen offset:3072 lds
v_add_u32 v114, 65536, v114
s_and_b32 s39, s2, 15
s_lshr_b32 s37, s2, 4
s_sub_u32 s37, s37, 2
s_lshl_b32 s54, s37, 2
s_add_u32 s54, s54, s32
s_lshl_b32 s3, s54, 17
s_lshl_b32 s7, s39, 7
s_add_u32 s3, s3, s7
s_cmp_ge_u32 s2, 32
s_cselect_b32 s3, s3, 2146435072
v_and_b32 v125, 0xffff, v114
v_add_u32_e64 v125, s3, v125
s_add_u32 m0, s35, 16384
s_nop 0
s_nop 0
buffer_load_dwordx4 v125, s[60:63], s48 offen offset:0 lds
buffer_load_dwordx4 v125, s[60:63], s49 offen offset:1024 lds
buffer_load_dwordx4 v125, s[60:63], s50 offen offset:2048 lds
buffer_load_dwordx4 v125, s[60:63], s51 offen offset:3072 lds
v_add_u32 v125, 65536, v125
s_add_u32 m0, s35, 20480
s_nop 0
buffer_load_dwordx4 v125, s[60:63], s48 offen offset:0 lds
buffer_load_dwordx4 v125, s[60:63], s49 offen offset:1024 lds
buffer_load_dwordx4 v125, s[60:63], s50 offen offset:2048 lds
buffer_load_dwordx4 v125, s[60:63], s51 offen offset:3072 lds
s_waitcnt vmcnt(24)
v_cmp_ne_u32 vcc, 1, v124
s_cbranch_vccnz L_spinC
L_spinCr:
buffer_load_dwordx4 a[0:3], v112, s[8:11], s52 offen offset:0 sc1
buffer_load_dwordx4 a[4:7], v112, s[8:11], s52 offen offset:1024 sc1
buffer_load_dwordx4 a[8:11], v112, s[8:11], s52 offen offset:2048 sc1
buffer_load_dwordx4 a[12:15], v112, s[8:11], s52 offen offset:3072 sc1
buffer_load_dwordx4 a[16:19], v113, s[8:11], s52 offen offset:0 sc1
buffer_load_dwordx4 a[20:23], v113, s[8:11], s52 offen offset:1024 sc1
buffer_load_dwordx4 a[24:27], v113, s[8:11], s52 offen offset:2048 sc1
buffer_load_dwordx4 a[28:31], v113, s[8:11], s52 offen offset:3072 sc1
s_add_u32 s52, s52, 8192
buffer_load_dwordx4 a[32:35], v112, s[8:11], s52 offen offset:0 sc1
buffer_load_dwordx4 a[36:39], v112, s[8:11], s52 offen offset:1024 sc1
buffer_load_dwordx4 a[40:43], v112, s[8:11], s52 offen offset:2048 sc1
buffer_load_dwordx4 a[44:47], v112, s[8:11], s52 offen offset:3072 sc1
buffer_load_dwordx4 a[48:51], v113, s[8:11], s52 offen offset:0 sc1
buffer_load_dwordx4 a[52:55], v113, s[8:11], s52 offen offset:1024 sc1
buffer_load_dwordx4 a[56:59], v113, s[8:11], s52 offen offset:2048 sc1
buffer_load_dwordx4 a[60:63], v113, s[8:11], s52 offen offset:3072 sc1
s_add_u32 s52, s52, 8192
buffer_load_dwordx4 a[64:67], v112, s[8:11], s52 offen offset:0 sc1
buffer_load_dwordx4 a[68:71], v112, s[8:11], s52 offen offset:1024 sc1
buffer_load_dwordx4 a[72:75], v112, s[8:11], s52 offen offset:2048 sc1
buffer_load_dwordx4 a[76:79], v112, s[8:11], s52 offen offset:3072 sc1
buffer_load_dwordx4 a[80:83], v113, s[8:11], s52 offen offset:0 sc1
buffer_load_dwordx4 a[84:87], v113, s[8:11], s52 offen offset:1024 sc1
buffer_load_dwordx4 a[88:91], v113, s[8:11], s52 offen offset:2048 sc1
buffer_load_dwordx4 a[92:95], v113, s[8:11], s52 offen offset:3072 sc1
s_add_u32 s52, s52, 8192
s_waitcnt vmcnt(44)
s_nop 0
Ta 128,115,0
Ta 130,115,2048
Ta 132,116,0
Ta 134,116,2048
Ta 136,117,0
Ta 138,117,2048
Ta 140,118,0
Ta 142,118,2048
s_waitcnt vmcnt(16) lgkmcnt(0)
Zvaa 128,128,0
s_add_u32 m0, s35, 0
Zvaa 132,132,0
buffer_load_dwordx4 v114, s[12:15], s48 offen offset:0 lds
Zvaa 136,136,0
Ta 144,115,4096
Ta 146,115,6144
Zvaa 140,140,0
buffer_load_dwordx4 v114, s[12:15], s49 offen offset:1024 lds
Zvaa 144,128,4
v_mov_b32_e64 v125, 1
Zvaa 148,132,4
s_lshl_b32 s6, s4, 3
s_add_u32 s6, s6, s92
s_lshl_b32 s6, s6, 2
Zvaa 152,136,4
buffer_load_dwordx4 v114, s[12:15], s50 offen offset:2048 lds
Zvaa 156,140,4
Ta 148,116,4096
Ta 150,116,6144
Zvaa 160,128,8
buffer_load_dwordx4 v114, s[12:15], s51 offen offset:3072 lds
Zvaa 164,132,8
v_add_u32 v114, 65536, v114
Zvaa 168,136,8
s_add_u32 s6, s6, 5302272
s_cmp_eq_u32 s32, 0
s_cselect_b32 s6, s6, s64
s_cmp_lg_u32 s34, 0
s_cselect_b32 s6, s6, 2146435072
Zvaa 172,140,8
buffer_load_dwordx4 a[96:99], v112, s[8:11], s52 offen offset:0 sc1
Zvaa 176,128,12
Ta 152,117,4096
Ta 154,117,6144
Zvaa 180,132,12
buffer_load_dwordx4 a[100:103], v112, s[8:11], s52 offen offset:1024 sc1
Zvaa 184,136,12
s_barrier
s_mov_b64 exec, 1
buffer_store_dword v125, v126, s[20:23], s6 offen sc1
s_mov_b64 exec, -1
Zvaa 188,140,12
Zvaa 192,128,16
buffer_load_dwordx4 a[104:107], v112, s[8:11], s52 offen offset:2048 sc1
Zvaa 196,132,16
Ta 156,118,4096
Ta 158,118,6144
Zvaa 200,136,16
buffer_load_dwordx4 a[108:111], v112, s[8:11], s52 offen offset:3072 sc1
Zvaa 204,140,16
Zvaa 208,128,20
Zvaa 212,132,20
buffer_load_dwordx4 a[112:115], v113, s[8:11], s52 offen offset:0 sc1
Zvaa 216,136,20
Zvaa 220,140,20
buffer_load_dwordx4 a[116:119], v113, s[8:11], s52 offen offset:1024 sc1
Zvaa 224,128,24
Zvaa 228,132,24
Zvaa 232,136,24
buffer_load_dwordx4 a[120:123], v113, s[8:11], s52 offen offset:2048 sc1
Zvaa 236,140,24
Zvaa 240,128,28
buffer_load_dwordx4 a[124:127], v113, s[8:11], s52 offen offset:3072 sc1
Zvaa 244,132,28
s_add_u32 s52, s52, 8192
Zvaa 248,136,28
Zvaa 252,140,28
s_waitcnt vmcnt(21) lgkmcnt(0)
Mvaa 128,144,32
s_add_u32 m0, s35, 4096
Mvaa 132,148,32
buffer_load_dwordx4 v114, s[12:15], s48 offen offset:0 lds
Mvaa 136,152,32
Ta 160,115,8192
Ta 162,115,10240
Mvaa 140,156,32
buffer_load_dwordx4 v114, s[12:15], s49 offen offset:1024 lds
Mvaa 144,144,36
s_mov_b32 s3, s36
Mvaa 148,148,36
buffer_load_dwordx4 v[18:21], v119, s[56:59], s3 offen
Mvaa 152,152,36
buffer_load_dwordx4 v114, s[12:15], s50 offen offset:2048 lds
Mvaa 156,156,36
Ta 164,116,8192
Ta 166,116,10240
Mvaa 160,144,40
buffer_load_dwordx4 v114, s[12:15], s51 offen offset:3072 lds
Mvaa 164,148,40
v_add_u32 v114, 65536, v114
Mvaa 168,152,40
s_add_u32 s3, s3, 65536
Mvaa 172,156,40
buffer_load_dwordx4 a[0:3], v112, s[8:11], s52 offen offset:0 sc1
Mvaa 176,144,44
Ta 168,117,8192
Ta 170,117,10240
Mvaa 180,148,44
buffer_load_dwordx4 a[4:7], v112, s[8:11], s52 offen offset:1024 sc1
Mvaa 184,152,44
buffer_load_dwordx4 v[22:25], v119, s[56:59], s3 offen
Mvaa 188,156,44
s_add_u32 s3, s3, 65536
Mvaa 192,144,48
buffer_load_dwordx4 a[8:11], v112, s[8:11], s52 offen offset:2048 sc1
Mvaa 196,148,48
Ta 172,118,8192
Ta 174,118,10240
Mvaa 200,152,48
buffer_load_dwordx4 a[12:15], v112, s[8:11], s52 offen offset:3072 sc1
Mvaa 204,156,48
buffer_load_dwordx4 v[26:29], v119, s[56:59], s3 offen
Mvaa 208,144,52
s_add_u32 s3, s3, 65536
Mvaa 212,148,52
buffer_load_dwordx4 a[16:19], v113, s[8:11], s52 offen offset:0 sc1
Mvaa 216,152,52
buffer_load_dwordx4 v[30:33], v119, s[56:59], s3 offen
Mvaa 220,156,52
buffer_load_dwordx4 a[20:23], v113, s[8:11], s52 offen offset:1024 sc1
Mvaa 224,144,56
s_lshl_b32 s3, s45, 10
s_add_u32 s3, s3, 5259264
v_lshlrev_b32_e64 v124, 3, v120
Mvaa 228,148,56
buffer_load_dwordx2 v[34:35], v124, s[20:23], s3 offen offset:0 sc1
Mvaa 232,152,56
buffer_load_dwordx4 a[24:27], v113, s[8:11], s52 offen offset:2048 sc1
Mvaa 236,156,56
buffer_load_dwordx2 v[36:37], v124, s[20:23], s3 offen offset:256 sc1
Mvaa 240,144,60
buffer_load_dwordx4 a[28:31], v113, s[8:11], s52 offen offset:3072 sc1
Mvaa 244,148,60
s_add_u32 s52, s52, 8192
Mvaa 248,152,60
buffer_load_dwordx2 v[38:39], v124, s[20:23], s3 offen offset:512 sc1
Mvaa 252,156,60
buffer_load_dwordx2 v[40:41], v124, s[20:23], s3 offen offset:768 sc1
s_waitcnt vmcnt(33) lgkmcnt(0)
Mvaa 128,160,64
s_add_u32 m0, s35, 8192
Mvaa 132,164,64
buffer_load_dwordx4 v114, s[12:15], s48 offen offset:0 lds
Mvaa 136,168,64
Ta 176,115,12288
Ta 178,115,14336
Mvaa 140,172,64
buffer_load_dwordx4 v114, s[12:15], s49 offen offset:1024 lds
Mvaa 144,160,68
s_lshl_b32 s40, s45, 7
s_lshl_b32 s3, s32, 3
s_or_b32 s40, s40, s3
Mvaa 148,164,68
s_and_b32 s3, s42, 0x798
s_and_b32 s47, s43, 0x798
s_cmp_eq_u32 s3, s40
s_cselect_b32 s53, 1, 0
s_cmp_eq_u32 s47, s40
s_cselect_b32 s53, 1, s53
s_mov_b32 s40, 0
Mvaa 152,168,68
buffer_load_dwordx4 v114, s[12:15], s50 offen offset:2048 lds
Mvaa 156,172,68
Ta 180,116,12288
Ta 182,116,14336
Mvaa 160,160,72
buffer_load_dwordx4 v114, s[12:15], s51 offen offset:3072 lds
Mvaa 164,164,72
v_add_u32 v114, 65536, v114
Mvaa 168,168,72
s_lshl_b32 s41, s46, 7
s_add_u32 s41, s41, 5304320
s_lshl_b32 s44, s46, 13
Mvaa 172,172,72
buffer_load_dwordx4 a[32:35], v112, s[8:11], s52 offen offset:0 sc1
Mvaa 176,160,76
Ta 184,117,12288
Ta 186,117,14336
Mvaa 180,164,76
buffer_load_dwordx4 a[36:39], v112, s[8:11], s52 offen offset:1024 sc1
Mvaa 184,168,76
s_add_u32 s44, s44, 5308416
Mvaa 188,172,76
Mvaa 192,160,80
buffer_load_dwordx4 a[40:43], v112, s[8:11], s52 offen offset:2048 sc1
Mvaa 196,164,80
Ta 188,118,12288
Ta 190,118,14336
Mvaa 200,168,80
buffer_load_dwordx4 a[44:47], v112, s[8:11], s52 offen offset:3072 sc1
Mvaa 204,172,80
Mvaa 208,160,84
Mvaa 212,164,84
buffer_load_dwordx4 a[48:51], v113, s[8:11], s52 offen offset:0 sc1
Mvaa 216,168,84
Mvaa 220,172,84
buffer_load_dwordx4 a[52:55], v113, s[8:11], s52 offen offset:1024 sc1
Mvaa 224,160,88
Mvaa 228,164,88
Mvaa 232,168,88
buffer_load_dwordx4 a[56:59], v113, s[8:11], s52 offen offset:2048 sc1
Mvaa 236,172,88
Mvaa 240,160,92
buffer_load_dwordx4 a[60:63], v113, s[8:11], s52 offen offset:3072 sc1
Mvaa 244,164,92
s_add_u32 s52, s52, 8192
Mvaa 248,168,92
Mvaa 252,172,92
s_waitcnt vmcnt(32) lgkmcnt(0)
Mvaa 128,176,96
s_add_u32 m0, s35, 12288
Mvaa 132,180,96
buffer_load_dwordx4 v114, s[12:15], s48 offen offset:0 lds
Mvaa 136,184,96
Ta 128,115,0
Ta 130,115,2048
Mvaa 140,188,96
buffer_load_dwordx4 v114, s[12:15], s49 offen offset:1024 lds
Mvaa 144,176,100
Mvaa 148,180,100
Mvaa 152,184,100
buffer_load_dwordx4 v114, s[12:15], s50 offen offset:2048 lds
Mvaa 156,188,100
Ta 132,116,0
Ta 134,116,2048
Mvaa 160,176,104
buffer_load_dwordx4 v114, s[12:15], s51 offen offset:3072 lds
Mvaa 164,180,104
v_add_u32 v114, 65536, v114
Mvaa 168,184,104
Mvaa 172,188,104
buffer_load_dwordx4 a[64:67], v112, s[8:11], s52 offen offset:0 sc1
Mvaa 176,176,108
Ta 136,117,0
Ta 138,117,2048
Mvaa 180,180,108
buffer_load_dwordx4 a[68:71], v112, s[8:11], s52 offen offset:1024 sc1
Mvaa 184,184,108
s_cmp_ge_u32 s2, 32
s_cbranch_scc1 L_f2A
L_f2Ar:
Mvaa 188,188,108
Mvaa 192,176,112
buffer_load_dwordx4 a[72:75], v112, s[8:11], s52 offen offset:2048 sc1
Mvaa 196,180,112
Ta 140,118,0
Ta 142,118,2048
Mvaa 200,184,112
buffer_load_dwordx4 a[76:79], v112, s[8:11], s52 offen offset:3072 sc1
Mvaa 204,188,112
Mvaa 208,176,116
Mvaa 212,180,116
buffer_load_dwordx4 a[80:83], v113, s[8:11], s52 offen offset:0 sc1
Mvaa 216,184,116
Mvaa 220,188,116
buffer_load_dwordx4 a[84:87], v113, s[8:11], s52 offen offset:1024 sc1
Mvaa 224,176,120
Mvaa 228,180,120
Mvaa 232,184,120
buffer_load_dwordx4 a[88:91], v113, s[8:11], s52 offen offset:2048 sc1
Mvaa 236,188,120
Mvaa 240,176,124
buffer_load_dwordx4 a[92:95], v113, s[8:11], s52 offen offset:3072 sc1
Mvaa 244,180,124
s_add_u32 s52, s52, 8192
Mvaa 248,184,124
Mvaa 252,188,124
s_waitcnt vmcnt(26) lgkmcnt(0)
Mvaa 128,128,0
s_add_u32 m0, s35, 0
Mvaa 132,132,0
buffer_load_dwordx4 v114, s[12:15], s48 offen offset:0 lds
Mvaa 136,136,0
Ta 144,115,4096
Ta 146,115,6144
Mvaa 140,140,0
buffer_load_dwordx4 v114, s[12:15], s49 offen offset:1024 lds
Mvaa 144,128,4
s_waitcnt vmcnt(26)
v_lshlrev_b32 v42, 16, v18
v_and_b32 v43, 0xffff0000, v18
Mvaa 148,132,4
v_lshlrev_b32_e64 v44, 16, v19
v_and_b32 v45, 0xffff0000, v19
Mvaa 152,136,4
buffer_load_dwordx4 v114, s[12:15], s50 offen offset:2048 lds
Mvaa 156,140,4
Ta 148,116,4096
Ta 150,116,6144
Mvaa 160,128,8
buffer_load_dwordx4 v114, s[12:15], s51 offen offset:3072 lds
Mvaa 164,132,8
v_add_u32 v114, 65536, v114
Mvaa 168,136,8
v_lshlrev_b32_e64 v46, 16, v20
v_and_b32 v47, 0xffff0000, v20
Mvaa 172,140,8
buffer_load_dwordx4 a[96:99], v112, s[8:11], s52 offen offset:0 sc1
Mvaa 176,128,12
Ta 152,117,4096
Ta 154,117,6144
Mvaa 180,132,12
buffer_load_dwordx4 a[100:103], v112, s[8:11], s52 offen offset:1024 sc1
Mvaa 184,136,12
v_lshlrev_b32_e64 v48, 16, v21
v_and_b32 v49, 0xffff0000, v21
Mvaa 188,140,12
Vs 42,42,34
Vs 43,43,34
Mvaa 192,128,16
buffer_load_dwordx4 a[104:107], v112, s[8:11], s52 offen offset:2048 sc1
Mvaa 196,132,16
Ta 156,118,4096
Ta 158,118,6144
Mvaa 200,136,16
buffer_load_dwordx4 a[108:111], v112, s[8:11], s52 offen offset:3072 sc1
Mvaa 204,140,16
Vs 44,44,34
Vs 45,45,34
Mvaa 208,128,20
Vs 46,46,34
Vs 47,47,34
Mvaa 212,132,20
buffer_load_dwordx4 a[112:115], v113, s[8:11], s52 offen offset:0 sc1
Mvaa 216,136,20
Vs 48,48,34
Vs 49,49,34
Mvaa 220,140,20
buffer_load_dwordx4 a[116:119], v113, s[8:11], s52 offen offset:1024 sc1
Mvaa 224,128,24
Vc 2,42,43
v_lshlrev_b32_e64 v42, 16, v2
Mvaa 228,132,24
v_and_b32 v43, 0xffff0000, v2
Vc 3,44,45
Mvaa 232,136,24
buffer_load_dwordx4 a[120:123], v113, s[8:11], s52 offen offset:2048 sc1
Mvaa 236,140,24
v_lshlrev_b32_e64 v44, 16, v3
v_and_b32 v45, 0xffff0000, v3
Mvaa 240,128,28
buffer_load_dwordx4 a[124:127], v113, s[8:11], s52 offen offset:3072 sc1
Mvaa 244,132,28
s_add_u32 s52, s52, 8192
Mvaa 248,136,28
Vc 4,46,47
v_lshlrev_b32_e64 v46, 16, v4
Mvaa 252,140,28
v_and_b32 v47, 0xffff0000, v4
Vc 5,48,49
s_waitcnt vmcnt(24) lgkmcnt(0)
Mvaa 128,144,32
s_add_u32 m0, s35, 4096
Mvaa 132,148,32
buffer_load_dwordx4 v114, s[12:15], s48 offen offset:0 lds
Mvaa 136,152,32
Ta 160,115,8192
Ta 162,115,10240
Mvaa 140,156,32
buffer_load_dwordx4 v114, s[12:15], s49 offen offset:1024 lds
Mvaa 144,144,36
v_lshlrev_b32 v48, 16, v5
v_and_b32 v49, 0xffff0000, v5
Mvaa 148,148,36
Vm 42,42,35
Vm 43,43,35
Mvaa 152,152,36
buffer_load_dwordx4 v114, s[12:15], s50 offen offset:2048 lds
Mvaa 156,156,36
Ta 164,116,8192
Ta 166,116,10240
Mvaa 160,144,40
buffer_load_dwordx4 v114, s[12:15], s51 offen offset:3072 lds
Mvaa 164,148,40
v_add_u32 v114, 65536, v114
Mvaa 168,152,40
Vm 44,44,35
Vm 45,45,35
Mvaa 172,156,40
buffer_load_dwordx4 a[0:3], v112, s[8:11], s52 offen offset:0 sc1
Mvaa 176,144,44
Ta 168,117,8192
Ta 170,117,10240
Mvaa 180,148,44
buffer_load_dwordx4 a[4:7], v112, s[8:11], s52 offen offset:1024 sc1
Mvaa 184,152,44
Vm 46,46,35
Vm 47,47,35
Mvaa 188,156,44
Vm 48,48,35
Vm 49,49,35
Mvaa 192,144,48
buffer_load_dwordx4 a[8:11], v112, s[8:11], s52 offen offset:2048 sc1
Mvaa 196,148,48
Ta 172,118,8192
Ta 174,118,10240
Mvaa 200,152,48
buffer_load_dwordx4 a[12:15], v112, s[8:11], s52 offen offset:3072 sc1
Mvaa 204,156,48
Vc 2,42,43
v_lshlrev_b32_e64 v42, 16, v2
Mvaa 208,144,52
v_and_b32 v43, 0xffff0000, v2
Vc 3,44,45
Mvaa 212,148,52
buffer_load_dwordx4 a[16:19], v113, s[8:11], s52 offen offset:0 sc1
Mvaa 216,152,52
v_lshlrev_b32_e64 v44, 16, v3
v_and_b32 v45, 0xffff0000, v3
Mvaa 220,156,52
buffer_load_dwordx4 a[20:23], v113, s[8:11], s52 offen offset:1024 sc1
Mvaa 224,144,56
Vc 4,46,47
v_lshlrev_b32_e64 v46, 16, v4
Mvaa 228,148,56
v_and_b32 v47, 0xffff0000, v4
Vc 5,48,49
Mvaa 232,152,56
buffer_load_dwordx4 a[24:27], v113, s[8:11], s52 offen offset:2048 sc1
Mvaa 236,156,56
v_lshlrev_b32_e64 v48, 16, v5
v_and_b32 v49, 0xffff0000, v5
Mvaa 240,144,60
buffer_load_dwordx4 a[28:31], v113, s[8:11], s52 offen offset:3072 sc1
Mvaa 244,148,60
s_add_u32 s52, s52, 8192
Mvaa 248,152,60
v_mul_f32 v2, 0xbfb8aa3b, v42
v_mul_f32 v3, 0xbfb8aa3b, v43
Mvaa 252,156,60
v_mul_f32 v4, 0xbfb8aa3b, v44
v_mul_f32 v5, 0xbfb8aa3b, v45
s_waitcnt vmcnt(24) lgkmcnt(0)
Mvaa 128,160,64
s_add_u32 m0, s35, 8192
Mvaa 132,164,64
buffer_load_dwordx4 v114, s[12:15], s48 offen offset:0 lds
Mvaa 136,168,64
Ta 176,115,12288
Ta 178,115,14336
Mvaa 140,172,64
buffer_load_dwordx4 v114, s[12:15], s49 offen offset:1024 lds
Mvaa 144,160,68
v_mul_f32 v6, 0xbfb8aa3b, v46
v_mul_f32 v7, 0xbfb8aa3b, v47
Mvaa 148,164,68
v_mul_f32 v8, 0xbfb8aa3b, v48
v_mul_f32 v9, 0xbfb8aa3b, v49
Mvaa 152,168,68
buffer_load_dwordx4 v114, s[12:15], s50 offen offset:2048 lds
Mvaa 156,172,68
Ta 180,116,12288
Ta 182,116,14336
Mvaa 160,160,72
buffer_load_dwordx4 v114, s[12:15], s51 offen offset:3072 lds
Mvaa 164,164,72
v_add_u32 v114, 65536, v114
Mvaa 168,168,72
Ve 2,2
Mvaa 172,172,72
buffer_load_dwordx4 a[32:35], v112, s[8:11], s52 offen offset:0 sc1
Mvaa 176,160,76
Ta 184,117,12288
Ta 186,117,14336
Mvaa 180,164,76
buffer_load_dwordx4 a[36:39], v112, s[8:11], s52 offen offset:1024 sc1
Mvaa 184,168,76
s_cmp_ge_u32 s2, 32
s_cbranch_scc1 L_f2B
L_f2Br:
Mvaa 188,172,76
VE 3,3
Mvaa 192,160,80
buffer_load_dwordx4 a[40:43], v112, s[8:11], s52 offen offset:2048 sc1
Mvaa 196,164,80
Ta 188,118,12288
Ta 190,118,14336
Mvaa 200,168,80
buffer_load_dwordx4 a[44:47], v112, s[8:11], s52 offen offset:3072 sc1
Mvaa 204,172,80
VE 4,4
Mvaa 208,160,84
VE 5,5
Mvaa 212,164,84
buffer_load_dwordx4 a[48:51], v113, s[8:11], s52 offen offset:0 sc1
Mvaa 216,168,84
VE 6,6
Mvaa 220,172,84
buffer_load_dwordx4 a[52:55], v113, s[8:11], s52 offen offset:1024 sc1
Mvaa 224,160,88
VE 7,7
Mvaa 228,164,88
VE 8,8
Mvaa 232,168,88
buffer_load_dwordx4 a[56:59], v113, s[8:11], s52 offen offset:2048 sc1
Mvaa 236,172,88
VE 9,9
Mvaa 240,160,92
buffer_load_dwordx4 a[60:63], v113, s[8:11], s52 offen offset:3072 sc1
Mvaa 244,164,92
s_add_u32 s52, s52, 8192
Mvaa 248,168,92
v_add_f32 v2, 1.0, v2
v_add_f32 v3, 1.0, v3
Mvaa 252,172,92
v_add_f32 v4, 1.0, v4
v_add_f32 v5, 1.0, v5
s_waitcnt vmcnt(24) lgkmcnt(0)
Mvaa 128,176,96
s_add_u32 m0, s35, 12288
Mvaa 132,180,96
buffer_load_dwordx4 v114, s[12:15], s48 offen offset:0 lds
Mvaa 136,184,96
Ta 128,115,0
Ta 130,115,2048
Mvaa 140,188,96
buffer_load_dwordx4 v114, s[12:15], s49 offen offset:1024 lds
Mvaa 144,176,100
v_add_f32 v6, 1.0, v6
v_add_f32_e64 v7, 1.0, v7
Mvaa 148,180,100
v_add_f32 v8, 1.0, v8
v_add_f32 v9, 1.0, v9
Mvaa 152,184,100
buffer_load_dwordx4 v114, s[12:15], s50 offen offset:2048 lds
Mvaa 156,188,100
Ta 132,116,0
Ta 134,116,2048
Mvaa 160,176,104
buffer_load_dwordx4 v114, s[12:15], s51 offen offset:3072 lds
Mvaa 164,180,104
v_add_u32 v114, 65536, v114
Mvaa 168,184,104
v_rcp_f32_e64 v2, v2
Mvaa 172,188,104
buffer_load_dwordx4 a[64:67], v112, s[8:11], s52 offen offset:0 sc1
Mvaa 176,176,108
Ta 136,117,0
Ta 138,117,2048
Mvaa 180,180,108
buffer_load_dwordx4 a[68:71], v112, s[8:11], s52 offen offset:1024 sc1
Mvaa 184,184,108
v_rcp_f32_e64 v3, v3
Mvaa 188,188,108
v_rcp_f32_e64 v4, v4
Mvaa 192,176,112
buffer_load_dwordx4 a[72:75], v112, s[8:11], s52 offen offset:2048 sc1
Mvaa 196,180,112
Ta 140,118,0
Ta 142,118,2048
Mvaa 200,184,112
buffer_load_dwordx4 a[76:79], v112, s[8:11], s52 offen offset:3072 sc1
Mvaa 204,188,112
v_rcp_f32_e64 v5, v5
Mvaa 208,176,116
v_rcp_f32_e64 v6, v6
Mvaa 212,180,116
buffer_load_dwordx4 a[80:83], v113, s[8:11], s52 offen offset:0 sc1
Mvaa 216,184,116
v_rcp_f32_e64 v7, v7
Mvaa 220,188,116
buffer_load_dwordx4 a[84:87], v113, s[8:11], s52 offen offset:1024 sc1
Mvaa 224,176,120
v_rcp_f32_e64 v8, v8
Mvaa 228,180,120
v_rcp_f32_e64 v9, v9
Mvaa 232,184,120
buffer_load_dwordx4 a[88:91], v113, s[8:11], s52 offen offset:2048 sc1
Mvaa 236,188,120
Vm 42,42,2
Vm 43,43,3
Mvaa 240,176,124
buffer_load_dwordx4 a[92:95], v113, s[8:11], s52 offen offset:3072 sc1
Mvaa 244,180,124
s_add_u32 s52, s52, 8192
Mvaa 248,184,124
Vm 44,44,4
Vm 45,45,5
Mvaa 252,188,124
Vm 46,46,6
Vm 47,47,7
s_waitcnt vmcnt(24) lgkmcnt(0)
Mvaa 128,128,0
s_add_u32 m0, s35, 0
Mvaa 132,132,0
buffer_load_dwordx4 v114, s[12:15], s48 offen offset:0 lds
Mvaa 136,136,0
Ta 144,115,4096
Ta 146,115,6144
Mvaa 140,140,0
buffer_load_dwordx4 v114, s[12:15], s49 offen offset:1024 lds
Mvaa 144,128,4
Vm 48,48,8
Vm 49,49,9
Mvaa 148,132,4
Vc 2,42,43
v_lshlrev_b32_e64 v42, 16, v2
Mvaa 152,136,4
buffer_load_dwordx4 v114, s[12:15], s50 offen offset:2048 lds
Mvaa 156,140,4
Ta 148,116,4096
Ta 150,116,6144
Mvaa 160,128,8
buffer_load_dwordx4 v114, s[12:15], s51 offen offset:3072 lds
Mvaa 164,132,8
v_add_u32 v114, 65536, v114
Mvaa 168,136,8
v_and_b32 v43, 0xffff0000, v2
Vc 3,44,45
Mvaa 172,140,8
buffer_load_dwordx4 a[96:99], v112, s[8:11], s52 offen offset:0 sc1
Mvaa 176,128,12
Ta 152,117,4096
Ta 154,117,6144
Mvaa 180,132,12
buffer_load_dwordx4 a[100:103], v112, s[8:11], s52 offen offset:1024 sc1
Mvaa 184,136,12
v_lshlrev_b32_e64 v44, 16, v3
v_and_b32 v45, 0xffff0000, v3
Mvaa 188,140,12
Vc 4,46,47
v_lshlrev_b32_e64 v46, 16, v4
Mvaa 192,128,16
buffer_load_dwordx4 a[104:107], v112, s[8:11], s52 offen offset:2048 sc1
Mvaa 196,132,16
Ta 156,118,4096
Ta 158,118,6144
Mvaa 200,136,16
buffer_load_dwordx4 a[108:111], v112, s[8:11], s52 offen offset:3072 sc1
Mvaa 204,140,16
v_and_b32 v47, 0xffff0000, v4
Vc 5,48,49
Mvaa 208,128,20
v_lshlrev_b32_e64 v48, 16, v5
v_and_b32 v49, 0xffff0000, v5
Mvaa 212,132,20
buffer_load_dwordx4 a[112:115], v113, s[8:11], s52 offen offset:0 sc1
Mvaa 216,136,20
v_lshlrev_b32_e64 v50, 16, v22
v_and_b32 v51, 0xffff0000, v22
Mvaa 220,140,20
buffer_load_dwordx4 a[116:119], v113, s[8:11], s52 offen offset:1024 sc1
Mvaa 224,128,24
v_lshlrev_b32_e64 v52, 16, v23
v_and_b32 v53, 0xffff0000, v23
Mvaa 228,132,24
v_lshlrev_b32_e64 v54, 16, v24
v_and_b32 v55, 0xffff0000, v24
Mvaa 232,136,24
buffer_load_dwordx4 a[120:123], v113, s[8:11], s52 offen offset:2048 sc1
Mvaa 236,140,24
v_lshlrev_b32_e64 v56, 16, v25
v_and_b32 v57, 0xffff0000, v25
Mvaa 240,128,28
buffer_load_dwordx4 a[124:127], v113, s[8:11], s52 offen offset:3072 sc1
Mvaa 244,132,28
s_add_u32 s52, s52, 8192
Mvaa 248,136,28
Vs 50,50,36
Vs 51,51,36
Mvaa 252,140,28
Vs 52,52,36
Vs 53,53,36
s_waitcnt vmcnt(24) lgkmcnt(0)
Mvaa 128,144,32
s_add_u32 m0, s35, 4096
Mvaa 132,148,32
buffer_load_dwordx4 v114, s[12:15], s48 offen offset:0 lds
Mvaa 136,152,32
Ta 160,115,8192
Ta 162,115,10240
Mvaa 140,156,32
buffer_load_dwordx4 v114, s[12:15], s49 offen offset:1024 lds
Mvaa 144,144,36
Vs 54,54,36
v_sub_f32_e64 v55, v55, v36
Mvaa 148,148,36
Vs 56,56,36
Vs 57,57,36
Mvaa 152,152,36
buffer_load_dwordx4 v114, s[12:15], s50 offen offset:2048 lds
Mvaa 156,156,36
Ta 164,116,8192
Ta 166,116,10240
Mvaa 160,144,40
buffer_load_dwordx4 v114, s[12:15], s51 offen offset:3072 lds
Mvaa 164,148,40
v_add_u32 v114, 65536, v114
Mvaa 168,152,40
Vc 2,50,51
v_lshlrev_b32_e64 v50, 16, v2
Mvaa 172,156,40
buffer_load_dwordx4 a[0:3], v112, s[8:11], s52 offen offset:0 sc1
Mvaa 176,144,44
Ta 168,117,8192
Ta 170,117,10240
Mvaa 180,148,44
buffer_load_dwordx4 a[4:7], v112, s[8:11], s52 offen offset:1024 sc1
Mvaa 184,152,44
s_cmp_ge_u32 s2, 32
s_cbranch_scc1 L_f2C
L_f2Cr:
Mvaa 188,156,44
v_and_b32 v51, 0xffff0000, v2
Vc 3,52,53
Mvaa 192,144,48
buffer_load_dwordx4 a[8:11], v112, s[8:11], s52 offen offset:2048 sc1
Mvaa 196,148,48
Ta 172,118,8192
Ta 174,118,10240
Mvaa 200,152,48
buffer_load_dwordx4 a[12:15], v112, s[8:11], s52 offen offset:3072 sc1
Mvaa 204,156,48
v_lshlrev_b32_e64 v52, 16, v3
v_and_b32 v53, 0xffff0000, v3
Mvaa 208,144,52
Vc 4,54,55
v_lshlrev_b32_e64 v54, 16, v4
Mvaa 212,148,52
buffer_load_dwordx4 a[16:19], v113, s[8:11], s52 offen offset:0 sc1
Mvaa 216,152,52
v_and_b32 v55, 0xffff0000, v4
Vc 5,56,57
Mvaa 220,156,52
buffer_load_dwordx4 a[20:23], v113, s[8:11], s52 offen offset:1024 sc1
Mvaa 224,144,56
v_lshlrev_b32_e64 v56, 16, v5
v_and_b32 v57, 0xffff0000, v5
Mvaa 228,148,56
Vm 50,50,37
Vm 51,51,37
Mvaa 232,152,56
buffer_load_dwordx4 a[24:27], v113, s[8:11], s52 offen offset:2048 sc1
Mvaa 236,156,56
Vm 52,52,37
Vm 53,53,37
Mvaa 240,144,60
buffer_load_dwordx4 a[28:31], v113, s[8:11], s52 offen offset:3072 sc1
Mvaa 244,148,60
s_add_u32 s52, s52, 8192
Mvaa 248,152,60
Vm 54,54,37
Vm 55,55,37
Mvaa 252,156,60
Vm 56,56,37
Vm 57,57,37
s_waitcnt vmcnt(24) lgkmcnt(0)
Mvaa 128,160,64
s_add_u32 m0, s35, 8192
Mvaa 132,164,64
buffer_load_dwordx4 v114, s[12:15], s48 offen offset:0 lds
Mvaa 136,168,64
Ta 176,115,12288
Ta 178,115,14336
Mvaa 140,172,64
buffer_load_dwordx4 v114, s[12:15], s49 offen offset:1024 lds
Mvaa 144,160,68
s_cmp_ge_u32 s2, 128
s_cbranch_scc1 L_c31
L_c31r:
Mvaa 148,164,68
Vc 2,50,51
v_lshlrev_b32_e64 v50, 16, v2
Mvaa 152,168,68
buffer_load_dwordx4 v114, s[12:15], s50 offen offset:2048 lds
Mvaa 156,172,68
Ta 180,116,12288
Ta 182,116,14336
Mvaa 160,160,72
buffer_load_dwordx4 v114, s[12:15], s51 offen offset:3072 lds
Mvaa 164,164,72
v_add_u32 v114, 65536, v114
Mvaa 168,168,72
v_and_b32 v51, 0xffff0000, v2
Vc 3,52,53
Mvaa 172,172,72
buffer_load_dwordx4 a[32:35], v112, s[8:11], s52 offen offset:0 sc1
Mvaa 176,160,76
Ta 184,117,12288
Ta 186,117,14336
Mvaa 180,164,76
buffer_load_dwordx4 a[36:39], v112, s[8:11], s52 offen offset:1024 sc1
Mvaa 184,168,76
v_lshlrev_b32_e64 v52, 16, v3
v_and_b32 v53, 0xffff0000, v3
Mvaa 188,172,76
Vc 4,54,55
v_lshlrev_b32_e64 v54, 16, v4
Mvaa 192,160,80
buffer_load_dwordx4 a[40:43], v112, s[8:11], s52 offen offset:2048 sc1
Mvaa 196,164,80
Ta 188,118,12288
Ta 190,118,14336
Mvaa 200,168,80
buffer_load_dwordx4 a[44:47], v112, s[8:11], s52 offen offset:3072 sc1
Mvaa 204,172,80
v_and_b32 v55, 0xffff0000, v4
Vc 5,56,57
Mvaa 208,160,84
v_lshlrev_b32_e64 v56, 16, v5
v_and_b32 v57, 0xffff0000, v5
Mvaa 212,164,84
buffer_load_dwordx4 a[48:51], v113, s[8:11], s52 offen offset:0 sc1
Mvaa 216,168,84
v_mul_f32 v2, 0xbfb8aa3b, v50
v_mul_f32 v3, 0xbfb8aa3b, v51
Mvaa 220,172,84
buffer_load_dwordx4 a[52:55], v113, s[8:11], s52 offen offset:1024 sc1
Mvaa 224,160,88
v_mul_f32 v4, 0xbfb8aa3b, v52
v_mul_f32 v5, 0xbfb8aa3b, v53
Mvaa 228,164,88
v_mul_f32 v6, 0xbfb8aa3b, v54
v_mul_f32 v7, 0xbfb8aa3b, v55
Mvaa 232,168,88
buffer_load_dwordx4 a[56:59], v113, s[8:11], s52 offen offset:2048 sc1
Mvaa 236,172,88
v_mul_f32 v8, 0xbfb8aa3b, v56
v_mul_f32 v9, 0xbfb8aa3b, v57
Mvaa 240,160,92
buffer_load_dwordx4 a[60:63], v113, s[8:11], s52 offen offset:3072 sc1
Mvaa 244,164,92
s_add_u32 s52, s52, 8192
Mvaa 248,168,92
VE 2,2
Mvaa 252,172,92
Ve 3,3
s_waitcnt vmcnt(24) lgkmcnt(0)
Mvaa 128,176,96
s_add_u32 m0, s35, 12288
Mvaa 132,180,96
buffer_load_dwordx4 v114, s[12:15], s48 offen offset:0 lds
Mvaa 136,184,96
Ta 128,115,0
Ta 130,115,2048
Mvaa 140,188,96
buffer_load_dwordx4 v114, s[12:15], s49 offen offset:1024 lds
Mvaa 144,176,100
VE 4,4
Mvaa 148,180,100
VE 5,5
Mvaa 152,184,100
buffer_load_dwordx4 v114, s[12:15], s50 offen offset:2048 lds
Mvaa 156,188,100
Ta 132,116,0
Ta 134,116,2048
Mvaa 160,176,104
buffer_load_dwordx4 v114, s[12:15], s51 offen offset:3072 lds
Mvaa 164,180,104
v_add_u32 v114, 65536, v114
Mvaa 168,184,104
VE 6,6
Mvaa 172,188,104
buffer_load_dwordx4 a[64:67], v112, s[8:11], s52 offen offset:0 sc1
Mvaa 176,176,108
Ta 136,117,0
Ta 138,117,2048
Mvaa 180,180,108
buffer_load_dwordx4 a[68:71], v112, s[8:11], s52 offen offset:1024 sc1
Mvaa 184,184,108
VE 7,7
Mvaa 188,188,108
VE 8,8
Mvaa 192,176,112
buffer_load_dwordx4 a[72:75], v112, s[8:11], s52 offen offset:2048 sc1
Mvaa 196,180,112
Ta 140,118,0
Ta 142,118,2048
Mvaa 200,184,112
buffer_load_dwordx4 a[76:79], v112, s[8:11], s52 offen offset:3072 sc1
Mvaa 204,188,112
VE 9,9
Mvaa 208,176,116
v_add_f32 v2, 1.0, v2
v_add_f32 v3, 1.0, v3
Mvaa 212,180,116
buffer_load_dwordx4 a[80:83], v113, s[8:11], s52 offen offset:0 sc1
Mvaa 216,184,116
v_add_f32 v4, 1.0, v4
v_add_f32 v5, 1.0, v5
Mvaa 220,188,116
buffer_load_dwordx4 a[84:87], v113, s[8:11], s52 offen offset:1024 sc1
Mvaa 224,176,120
v_add_f32 v6, 1.0, v6
v_add_f32 v7, 1.0, v7
Mvaa 228,180,120
v_add_f32 v8, 1.0, v8
v_add_f32 v9, 1.0, v9
Mvaa 232,184,120
buffer_load_dwordx4 a[88:91], v113, s[8:11], s52 offen offset:2048 sc1
Mvaa 236,188,120
v_rcp_f32_e64 v2, v2
Mvaa 240,176,124
buffer_load_dwordx4 a[92:95], v113, s[8:11], s52 offen offset:3072 sc1
Mvaa 244,180,124
s_add_u32 s52, s52, 8192
Mvaa 248,184,124
v_rcp_f32_e64 v3, v3
Mvaa 252,188,124
v_rcp_f32 v4, v4
s_waitcnt vmcnt(24) lgkmcnt(0)
Mvaa 128,128,0
s_add_u32 m0, s35, 0
Mvaa 132,132,0
buffer_load_dwordx4 v114, s[12:15], s48 offen offset:0 lds
Mvaa 136,136,0
Ta 144,115,4096
Ta 146,115,6144
Mvaa 140,140,0
buffer_load_dwordx4 v114, s[12:15], s49 offen offset:1024 lds
Mvaa 144,128,4
v_rcp_f32 v5, v5
Mvaa 148,132,4
v_rcp_f32_e64 v6, v6
Mvaa 152,136,4
buffer_load_dwordx4 v114, s[12:15], s50 offen offset:2048 lds
Mvaa 156,140,4
Ta 148,116,4096
Ta 150,116,6144
Mvaa 160,128,8
buffer_load_dwordx4 v114, s[12:15], s51 offen offset:3072 lds
Mvaa 164,132,8
v_add_u32 v114, 65536, v114
Mvaa 168,136,8
v_rcp_f32_e64 v7, v7
Mvaa 172,140,8
buffer_load_dwordx4 a[96:99], v112, s[8:11], s52 offen offset:0 sc1
Mvaa 176,128,12
Ta 152,117,4096
Ta 154,117,6144
Mvaa 180,132,12
buffer_load_dwordx4 a[100:103], v112, s[8:11], s52 offen offset:1024 sc1
Mvaa 184,136,12
v_rcp_f32_e64 v8, v8
Mvaa 188,140,12
v_rcp_f32_e64 v9, v9
Mvaa 192,128,16
buffer_load_dwordx4 a[104:107], v112, s[8:11], s52 offen offset:2048 sc1
Mvaa 196,132,16
Ta 156,118,4096
Ta 158,118,6144
Mvaa 200,136,16
buffer_load_dwordx4 a[108:111], v112, s[8:11], s52 offen offset:3072 sc1
Mvaa 204,140,16
Vm 50,50,2
Vm 51,51,3
Mvaa 208,128,20
s_cmp_ge_u32 s2, 32
s_cbranch_scc1 L_f2E
L_f2Er:
Mvaa 212,132,20
buffer_load_dwordx4 a[112:115], v113, s[8:11], s52 offen offset:0 sc1
Mvaa 216,136,20
Vm 52,52,4
Vm 53,53,5
Mvaa 220,140,20
buffer_load_dwordx4 a[116:119], v113, s[8:11], s52 offen offset:1024 sc1
Mvaa 224,128,24
Vm 54,54,6
Vm 55,55,7
Mvaa 228,132,24
Vm 56,56,8
Vm 57,57,9
Mvaa 232,136,24
buffer_load_dwordx4 a[120:123], v113, s[8:11], s52 offen offset:2048 sc1
Mvaa 236,140,24
Vc 2,50,51
v_lshlrev_b32_e64 v50, 16, v2
Mvaa 240,128,28
buffer_load_dwordx4 a[124:127], v113, s[8:11], s52 offen offset:3072 sc1
Mvaa 244,132,28
s_add_u32 s52, s52, 8192
Mvaa 248,136,28
v_and_b32 v51, 0xffff0000, v2
Vc 3,52,53
Mvaa 252,140,28
v_lshlrev_b32_e64 v52, 16, v3
v_and_b32 v53, 0xffff0000, v3
s_waitcnt vmcnt(24) lgkmcnt(0)
Mvaa 128,144,32
s_add_u32 m0, s35, 4096
Mvaa 132,148,32
buffer_load_dwordx4 v114, s[12:15], s48 offen offset:0 lds
Mvaa 136,152,32
Ta 160,115,8192
Ta 162,115,10240
Mvaa 140,156,32
buffer_load_dwordx4 v114, s[12:15], s49 offen offset:1024 lds
Mvaa 144,144,36
Vc 4,54,55
v_lshlrev_b32 v54, 16, v4
Mvaa 148,148,36
v_and_b32 v55, 0xffff0000, v4
Vc 5,56,57
Mvaa 152,152,36
buffer_load_dwordx4 v114, s[12:15], s50 offen offset:2048 lds
Mvaa 156,156,36
Ta 164,116,8192
Ta 166,116,10240
Mvaa 160,144,40
buffer_load_dwordx4 v114, s[12:15], s51 offen offset:3072 lds
Mvaa 164,148,40
v_add_u32 v114, 65536, v114
Mvaa 168,152,40
v_lshlrev_b32_e64 v56, 16, v5
v_and_b32 v57, 0xffff0000, v5
Mvaa 172,156,40
buffer_load_dwordx4 a[0:3], v112, s[8:11], s52 offen offset:0 sc1
Mvaa 176,144,44
Ta 168,117,8192
Ta 170,117,10240
Mvaa 180,148,44
buffer_load_dwordx4 a[4:7], v112, s[8:11], s52 offen offset:1024 sc1
Mvaa 184,152,44
v_lshlrev_b32_e64 v58, 16, v26
v_and_b32 v59, 0xffff0000, v26
Mvaa 188,156,44
v_lshlrev_b32_e64 v60, 16, v27
v_and_b32 v61, 0xffff0000, v27
Mvaa 192,144,48
buffer_load_dwordx4 a[8:11], v112, s[8:11], s52 offen offset:2048 sc1
Mvaa 196,148,48
Ta 172,118,8192
Ta 174,118,10240
Mvaa 200,152,48
buffer_load_dwordx4 a[12:15], v112, s[8:11], s52 offen offset:3072 sc1
Mvaa 204,156,48
v_lshlrev_b32_e64 v62, 16, v28
v_and_b32 v63, 0xffff0000, v28
Mvaa 208,144,52
v_lshlrev_b32_e64 v64, 16, v29
v_and_b32 v65, 0xffff0000, v29
Mvaa 212,148,52
buffer_load_dwordx4 a[16:19], v113, s[8:11], s52 offen offset:0 sc1
Mvaa 216,152,52
Vs 58,58,38
Vs 59,59,38
Mvaa 220,156,52
buffer_load_dwordx4 a[20:23], v113, s[8:11], s52 offen offset:1024 sc1
Mvaa 224,144,56
Vs 60,60,38
Vs 61,61,38
Mvaa 228,148,56
Vs 62,62,38
Vs 63,63,38
Mvaa 232,152,56
buffer_load_dwordx4 a[24:27], v113, s[8:11], s52 offen offset:2048 sc1
Mvaa 236,156,56
Vs 64,64,38
Vs 65,65,38
Mvaa 240,144,60
buffer_load_dwordx4 a[28:31], v113, s[8:11], s52 offen offset:3072 sc1
Mvaa 244,148,60
s_add_u32 s52, s52, 8192
Mvaa 248,152,60
Vc 2,58,59
v_lshlrev_b32_e64 v58, 16, v2
Mvaa 252,156,60
v_and_b32 v59, 0xffff0000, v2
Vc 3,60,61
s_waitcnt vmcnt(24) lgkmcnt(0)
Mvaa 128,160,64
s_add_u32 m0, s35, 8192
Mvaa 132,164,64
buffer_load_dwordx4 v114, s[12:15], s48 offen offset:0 lds
Mvaa 136,168,64
Ta 176,115,12288
Ta 178,115,14336
Mvaa 140,172,64
buffer_load_dwordx4 v114, s[12:15], s49 offen offset:1024 lds
Mvaa 144,160,68
v_lshlrev_b32 v60, 16, v3
v_and_b32 v61, 0xffff0000, v3
Mvaa 148,164,68
Vc 4,62,63
v_lshlrev_b32_e64 v62, 16, v4
Mvaa 152,168,68
buffer_load_dwordx4 v114, s[12:15], s50 offen offset:2048 lds
Mvaa 156,172,68
Ta 180,116,12288
Ta 182,116,14336
Mvaa 160,160,72
buffer_load_dwordx4 v114, s[12:15], s51 offen offset:3072 lds
Mvaa 164,164,72
v_add_u32 v114, 65536, v114
Mvaa 168,168,72
v_and_b32 v63, 0xffff0000, v4
Vc 5,64,65
Mvaa 172,172,72
buffer_load_dwordx4 a[32:35], v112, s[8:11], s52 offen offset:0 sc1
Mvaa 176,160,76
Ta 184,117,12288
Ta 186,117,14336
Mvaa 180,164,76
buffer_load_dwordx4 a[36:39], v112, s[8:11], s52 offen offset:1024 sc1
Mvaa 184,168,76
v_lshlrev_b32_e64 v64, 16, v5
v_and_b32 v65, 0xffff0000, v5
Mvaa 188,172,76
Vm 58,58,39
Vm 59,59,39
Mvaa 192,160,80
buffer_load_dwordx4 a[40:43], v112, s[8:11], s52 offen offset:2048 sc1
Mvaa 196,164,80
Ta 188,118,12288
Ta 190,118,14336
Mvaa 200,168,80
buffer_load_dwordx4 a[44:47], v112, s[8:11], s52 offen offset:3072 sc1
Mvaa 204,172,80
Vm 60,60,39
Vm 61,61,39
Mvaa 208,160,84
Vm 62,62,39
Vm 63,63,39
Mvaa 212,164,84
buffer_load_dwordx4 a[48:51], v113, s[8:11], s52 offen offset:0 sc1
Mvaa 216,168,84
Vm 64,64,39
Vm 65,65,39
Mvaa 220,172,84
buffer_load_dwordx4 a[52:55], v113, s[8:11], s52 offen offset:1024 sc1
Mvaa 224,160,88
Vc 2,58,59
v_lshlrev_b32_e64 v58, 16, v2
Mvaa 228,164,88
v_and_b32 v59, 0xffff0000, v2
Vc 3,60,61
Mvaa 232,168,88
buffer_load_dwordx4 a[56:59], v113, s[8:11], s52 offen offset:2048 sc1
Mvaa 236,172,88
v_lshlrev_b32_e64 v60, 16, v3
v_and_b32 v61, 0xffff0000, v3
Mvaa 240,160,92
buffer_load_dwordx4 a[60:63], v113, s[8:11], s52 offen offset:3072 sc1
Mvaa 244,164,92
s_add_u32 s52, s52, 8192
Mvaa 248,168,92
Vc 4,62,63
v_lshlrev_b32_e64 v62, 16, v4
Mvaa 252,172,92
v_and_b32 v63, 0xffff0000, v4
Vc 5,64,65
s_waitcnt vmcnt(24) lgkmcnt(0)
Mvaa 128,176,96
s_add_u32 m0, s35, 12288
Mvaa 132,180,96
buffer_load_dwordx4 v114, s[12:15], s48 offen offset:0 lds
Mvaa 136,184,96
Ta 128,115,0
Ta 130,115,2048
Mvaa 140,188,96
buffer_load_dwordx4 v114, s[12:15], s49 offen offset:1024 lds
Mvaa 144,176,100
v_lshlrev_b32 v64, 16, v5
v_and_b32 v65, 0xffff0000, v5
Mvaa 148,180,100
v_mul_f32 v2, 0xbfb8aa3b, v58
v_mul_f32 v3, 0xbfb8aa3b, v59
Mvaa 152,184,100
buffer_load_dwordx4 v114, s[12:15], s50 offen offset:2048 lds
Mvaa 156,188,100
Ta 132,116,0
Ta 134,116,2048
Mvaa 160,176,104
buffer_load_dwordx4 v114, s[12:15], s51 offen offset:3072 lds
Mvaa 164,180,104
v_add_u32 v114, 65536, v114
Mvaa 168,184,104
v_mul_f32 v4, 0xbfb8aa3b, v60
v_mul_f32 v5, 0xbfb8aa3b, v61
Mvaa 172,188,104
buffer_load_dwordx4 a[64:67], v112, s[8:11], s52 offen offset:0 sc1
Mvaa 176,176,108
Ta 136,117,0
Ta 138,117,2048
Mvaa 180,180,108
buffer_load_dwordx4 a[68:71], v112, s[8:11], s52 offen offset:1024 sc1
Mvaa 184,184,108
v_mul_f32 v6, 0xbfb8aa3b, v62
v_mul_f32 v7, 0xbfb8aa3b, v63
Mvaa 188,188,108
v_mul_f32 v8, 0xbfb8aa3b, v64
v_mul_f32 v9, 0xbfb8aa3b, v65
Mvaa 192,176,112
buffer_load_dwordx4 a[72:75], v112, s[8:11], s52 offen offset:2048 sc1
Mvaa 196,180,112
Ta 140,118,0
Ta 142,118,2048
Mvaa 200,184,112
buffer_load_dwordx4 a[76:79], v112, s[8:11], s52 offen offset:3072 sc1
Mvaa 204,188,112
VE 2,2
Mvaa 208,176,116
VE 3,3
Mvaa 212,180,116
buffer_load_dwordx4 a[80:83], v113, s[8:11], s52 offen offset:0 sc1
Mvaa 216,184,116
VE 4,4
Mvaa 220,188,116
buffer_load_dwordx4 a[84:87], v113, s[8:11], s52 offen offset:1024 sc1
Mvaa 224,176,120
VE 5,5
Mvaa 228,180,120
VE 6,6
Mvaa 232,184,120
buffer_load_dwordx4 a[88:91], v113, s[8:11], s52 offen offset:2048 sc1
Mvaa 236,188,120
VE 7,7
Mvaa 240,176,124
buffer_load_dwordx4 a[92:95], v113, s[8:11], s52 offen offset:3072 sc1
Mvaa 244,180,124
s_add_u32 s52, s52, 8192
Mvaa 248,184,124
VE 8,8
Mvaa 252,188,124
Ve 9,9
s_waitcnt vmcnt(24) lgkmcnt(0)
Mvaa 128,128,0
s_add_u32 m0, s35, 0
Mvaa 132,132,0
buffer_load_dwordx4 v114, s[12:15], s48 offen offset:0 lds
Mvaa 136,136,0
Ta 144,115,4096
Ta 146,115,6144
Mvaa 140,140,0
buffer_load_dwordx4 v114, s[12:15], s49 offen offset:1024 lds
Mvaa 144,128,4
v_add_f32 v2, 1.0, v2
v_add_f32_e64 v3, 1.0, v3
Mvaa 148,132,4
v_add_f32 v4, 1.0, v4
v_add_f32 v5, 1.0, v5
Mvaa 152,136,4
buffer_load_dwordx4 v114, s[12:15], s50 offen offset:2048 lds
Mvaa 156,140,4
Ta 148,116,4096
Ta 150,116,6144
Mvaa 160,128,8
buffer_load_dwordx4 v114, s[12:15], s51 offen offset:3072 lds
Mvaa 164,132,8
v_add_u32 v114, 65536, v114
Mvaa 168,136,8
v_add_f32 v6, 1.0, v6
v_add_f32 v7, 1.0, v7
Mvaa 172,140,8
buffer_load_dwordx4 a[96:99], v112, s[8:11], s52 offen offset:0 sc1
Mvaa 176,128,12
Ta 152,117,4096
Ta 154,117,6144
Mvaa 180,132,12
buffer_load_dwordx4 a[100:103], v112, s[8:11], s52 offen offset:1024 sc1
Mvaa 184,136,12
v_add_f32 v8, 1.0, v8
v_add_f32 v9, 1.0, v9
Mvaa 188,140,12
v_rcp_f32_e64 v2, v2
Mvaa 192,128,16
buffer_load_dwordx4 a[104:107], v112, s[8:11], s52 offen offset:2048 sc1
Mvaa 196,132,16
Ta 156,118,4096
Ta 158,118,6144
Mvaa 200,136,16
buffer_load_dwordx4 a[108:111], v112, s[8:11], s52 offen offset:3072 sc1
Mvaa 204,140,16
v_rcp_f32_e64 v3, v3
Mvaa 208,128,20
v_rcp_f32_e64 v4, v4
Mvaa 212,132,20
buffer_load_dwordx4 a[112:115], v113, s[8:11], s52 offen offset:0 sc1
Mvaa 216,136,20
v_rcp_f32_e64 v5, v5
Mvaa 220,140,20
buffer_load_dwordx4 a[116:119], v113, s[8:11], s52 offen offset:1024 sc1
Mvaa 224,128,24
v_rcp_f32_e64 v6, v6
Mvaa 228,132,24
v_rcp_f32_e64 v7, v7
Mvaa 232,136,24
buffer_load_dwordx4 a[120:123], v113, s[8:11], s52 offen offset:2048 sc1
Mvaa 236,140,24
v_rcp_f32_e64 v8, v8
Mvaa 240,128,28
buffer_load_dwordx4 a[124:127], v113, s[8:11], s52 offen offset:3072 sc1
Mvaa 244,132,28
s_add_u32 s52, s52, 8192
Mvaa 248,136,28
v_rcp_f32_e64 v9, v9
Mvaa 252,140,28
Vm 58,58,2
Vm 59,59,3
s_waitcnt vmcnt(24) lgkmcnt(0)
Mvaa 128,144,32
s_add_u32 m0, s35, 4096
Mvaa 132,148,32
buffer_load_dwordx4 v114, s[12:15], s48 offen offset:0 lds
Mvaa 136,152,32
Ta 160,115,8192
Ta 162,115,10240
Mvaa 140,156,32
buffer_load_dwordx4 v114, s[12:15], s49 offen offset:1024 lds
Mvaa 144,144,36
Vm 60,60,4
v_mul_f32_e64 v61, v61, v5
Mvaa 148,148,36
Vm 62,62,6
Vm 63,63,7
Mvaa 152,152,36
buffer_load_dwordx4 v114, s[12:15], s50 offen offset:2048 lds
Mvaa 156,156,36
Ta 164,116,8192
Ta 166,116,10240
Mvaa 160,144,40
buffer_load_dwordx4 v114, s[12:15], s51 offen offset:3072 lds
Mvaa 164,148,40
v_add_u32 v114, 65536, v114
Mvaa 168,152,40
Vm 64,64,8
Vm 65,65,9
Mvaa 172,156,40
buffer_load_dwordx4 a[0:3], v112, s[8:11], s52 offen offset:0 sc1
Mvaa 176,144,44
Ta 168,117,8192
Ta 170,117,10240
Mvaa 180,148,44
buffer_load_dwordx4 a[4:7], v112, s[8:11], s52 offen offset:1024 sc1
Mvaa 184,152,44
Vc 2,58,59
v_lshlrev_b32_e64 v58, 16, v2
Mvaa 188,156,44
v_and_b32 v59, 0xffff0000, v2
Vc 3,60,61
Mvaa 192,144,48
buffer_load_dwordx4 a[8:11], v112, s[8:11], s52 offen offset:2048 sc1
Mvaa 196,148,48
Ta 172,118,8192
Ta 174,118,10240
Mvaa 200,152,48
buffer_load_dwordx4 a[12:15], v112, s[8:11], s52 offen offset:3072 sc1
Mvaa 204,156,48
v_lshlrev_b32_e64 v60, 16, v3
v_and_b32 v61, 0xffff0000, v3
Mvaa 208,144,52
Vc 4,62,63
v_lshlrev_b32_e64 v62, 16, v4
Mvaa 212,148,52
buffer_load_dwordx4 a[16:19], v113, s[8:11], s52 offen offset:0 sc1
Mvaa 216,152,52
v_and_b32 v63, 0xffff0000, v4
Vc 5,64,65
Mvaa 220,156,52
buffer_load_dwordx4 a[20:23], v113, s[8:11], s52 offen offset:1024 sc1
Mvaa 224,144,56
v_lshlrev_b32_e64 v64, 16, v5
v_and_b32 v65, 0xffff0000, v5
Mvaa 228,148,56
v_lshlrev_b32_e64 v66, 16, v30
v_and_b32 v67, 0xffff0000, v30
Mvaa 232,152,56
buffer_load_dwordx4 a[24:27], v113, s[8:11], s52 offen offset:2048 sc1
Mvaa 236,156,56
v_lshlrev_b32_e64 v68, 16, v31
v_and_b32 v69, 0xffff0000, v31
Mvaa 240,144,60
buffer_load_dwordx4 a[28:31], v113, s[8:11], s52 offen offset:3072 sc1
Mvaa 244,148,60
s_add_u32 s52, s52, 8192
Mvaa 248,152,60
v_lshlrev_b32_e64 v70, 16, v32
v_and_b32 v71, 0xffff0000, v32
Mvaa 252,156,60
v_lshlrev_b32_e64 v72, 16, v33
v_and_b32 v73, 0xffff0000, v33
s_waitcnt vmcnt(24) lgkmcnt(0)
Mvaa 128,160,64
s_add_u32 m0, s35, 8192
Mvaa 132,164,64
buffer_load_dwordx4 v114, s[12:15], s48 offen offset:0 lds
Mvaa 136,168,64
Ta 176,115,12288
Ta 178,115,14336
Mvaa 140,172,64
buffer_load_dwordx4 v114, s[12:15], s49 offen offset:1024 lds
Mvaa 144,160,68
Vs 66,66,40
v_sub_f32_e64 v67, v67, v40
Mvaa 148,164,68
Vs 68,68,40
Vs 69,69,40
Mvaa 152,168,68
buffer_load_dwordx4 v114, s[12:15], s50 offen offset:2048 lds
Mvaa 156,172,68
Ta 180,116,12288
Ta 182,116,14336
Mvaa 160,160,72
buffer_load_dwordx4 v114, s[12:15], s51 offen offset:3072 lds
Mvaa 164,164,72
v_add_u32 v114, 65536, v114
Mvaa 168,168,72
Vs 70,70,40
Vs 71,71,40
Mvaa 172,172,72
buffer_load_dwordx4 a[32:35], v112, s[8:11], s52 offen offset:0 sc1
Mvaa 176,160,76
Ta 184,117,12288
Ta 186,117,14336
Mvaa 180,164,76
buffer_load_dwordx4 a[36:39], v112, s[8:11], s52 offen offset:1024 sc1
Mvaa 184,168,76
Vs 72,72,40
Vs 73,73,40
Mvaa 188,172,76
Vc 2,66,67
v_lshlrev_b32_e64 v66, 16, v2
Mvaa 192,160,80
buffer_load_dwordx4 a[40:43], v112, s[8:11], s52 offen offset:2048 sc1
Mvaa 196,164,80
Ta 188,118,12288
Ta 190,118,14336
Mvaa 200,168,80
buffer_load_dwordx4 a[44:47], v112, s[8:11], s52 offen offset:3072 sc1
Mvaa 204,172,80
v_and_b32 v67, 0xffff0000, v2
Vc 3,68,69
Mvaa 208,160,84
v_lshlrev_b32_e64 v68, 16, v3
v_and_b32 v69, 0xffff0000, v3
Mvaa 212,164,84
buffer_load_dwordx4 a[48:51], v113, s[8:11], s52 offen offset:0 sc1
Mvaa 216,168,84
Vc 4,70,71
v_lshlrev_b32_e64 v70, 16, v4
Mvaa 220,172,84
buffer_load_dwordx4 a[52:55], v113, s[8:11], s52 offen offset:1024 sc1
Mvaa 224,160,88
v_and_b32 v71, 0xffff0000, v4
Vc 5,72,73
Mvaa 228,164,88
v_lshlrev_b32_e64 v72, 16, v5
v_and_b32 v73, 0xffff0000, v5
Mvaa 232,168,88
buffer_load_dwordx4 a[56:59], v113, s[8:11], s52 offen offset:2048 sc1
Mvaa 236,172,88
Vm 66,66,41
Vm 67,67,41
Mvaa 240,160,92
buffer_load_dwordx4 a[60:63], v113, s[8:11], s52 offen offset:3072 sc1
Mvaa 244,164,92
s_add_u32 s52, s52, 8192
Mvaa 248,168,92
Vm 68,68,41
Vm 69,69,41
Mvaa 252,172,92
Vm 70,70,41
Vm 71,71,41
s_waitcnt vmcnt(24) lgkmcnt(0)
Mvaa 128,176,96
s_add_u32 m0, s35, 12288
Mvaa 132,180,96
buffer_load_dwordx4 v114, s[12:15], s48 offen offset:0 lds
Mvaa 136,184,96
Ta 128,115,0
Ta 130,115,2048
Mvaa 140,188,96
buffer_load_dwordx4 v114, s[12:15], s49 offen offset:1024 lds
Mvaa 144,176,100
Vm 72,72,41
v_mul_f32_e64 v73, v73, v41
Mvaa 148,180,100
Vc 2,66,67
v_lshlrev_b32_e64 v66, 16, v2
Mvaa 152,184,100
buffer_load_dwordx4 v114, s[12:15], s50 offen offset:2048 lds
Mvaa 156,188,100
Ta 132,116,0
Ta 134,116,2048
Mvaa 160,176,104
buffer_load_dwordx4 v114, s[12:15], s51 offen offset:3072 lds
Mvaa 164,180,104
v_add_u32 v114, 65536, v114
Mvaa 168,184,104
v_and_b32 v67, 0xffff0000, v2
Vc 3,68,69
Mvaa 172,188,104
buffer_load_dwordx4 a[64:67], v112, s[8:11], s52 offen offset:0 sc1
Mvaa 176,176,108
Ta 136,117,0
Ta 138,117,2048
Mvaa 180,180,108
buffer_load_dwordx4 a[68:71], v112, s[8:11], s52 offen offset:1024 sc1
Mvaa 184,184,108
v_lshlrev_b32_e64 v68, 16, v3
v_and_b32 v69, 0xffff0000, v3
Mvaa 188,188,108
Vc 4,70,71
v_lshlrev_b32_e64 v70, 16, v4
Mvaa 192,176,112
buffer_load_dwordx4 a[72:75], v112, s[8:11], s52 offen offset:2048 sc1
Mvaa 196,180,112
Ta 140,118,0
Ta 142,118,2048
Mvaa 200,184,112
buffer_load_dwordx4 a[76:79], v112, s[8:11], s52 offen offset:3072 sc1
Mvaa 204,188,112
v_and_b32 v71, 0xffff0000, v4
Vc 5,72,73
Mvaa 208,176,116
v_lshlrev_b32_e64 v72, 16, v5
v_and_b32 v73, 0xffff0000, v5
Mvaa 212,180,116
buffer_load_dwordx4 a[80:83], v113, s[8:11], s52 offen offset:0 sc1
Mvaa 216,184,116
v_mul_f32 v2, 0xbfb8aa3b, v66
v_mul_f32 v3, 0xbfb8aa3b, v67
Mvaa 220,188,116
buffer_load_dwordx4 a[84:87], v113, s[8:11], s52 offen offset:1024 sc1
Mvaa 224,176,120
v_mul_f32 v4, 0xbfb8aa3b, v68
v_mul_f32 v5, 0xbfb8aa3b, v69
Mvaa 228,180,120
v_mul_f32 v6, 0xbfb8aa3b, v70
v_mul_f32 v7, 0xbfb8aa3b, v71
Mvaa 232,184,120
buffer_load_dwordx4 a[88:91], v113, s[8:11], s52 offen offset:2048 sc1
Mvaa 236,188,120
v_mul_f32 v8, 0xbfb8aa3b, v72
v_mul_f32 v9, 0xbfb8aa3b, v73
Mvaa 240,176,124
buffer_load_dwordx4 a[92:95], v113, s[8:11], s52 offen offset:3072 sc1
Mvaa 244,180,124
s_add_u32 s52, s52, 8192
Mvaa 248,184,124
VE 2,2
Mvaa 252,188,124
Ve 3,3
s_waitcnt vmcnt(24) lgkmcnt(0)
Mvaa 128,128,0
s_add_u32 m0, s35, 0
Mvaa 132,132,0
buffer_load_dwordx4 v114, s[12:15], s48 offen offset:0 lds
Mvaa 136,136,0
Ta 144,115,4096
Ta 146,115,6144
Mvaa 140,140,0
buffer_load_dwordx4 v114, s[12:15], s49 offen offset:1024 lds
Mvaa 144,128,4
Ve 4,4
Mvaa 148,132,4
VE 5,5
Mvaa 152,136,4
buffer_load_dwordx4 v114, s[12:15], s50 offen offset:2048 lds
Mvaa 156,140,4
Ta 148,116,4096
Ta 150,116,6144
Mvaa 160,128,8
buffer_load_dwordx4 v114, s[12:15], s51 offen offset:3072 lds
Mvaa 164,132,8
v_add_u32 v114, 65536, v114
Mvaa 168,136,8
VE 6,6
Mvaa 172,140,8
buffer_load_dwordx4 a[96:99], v112, s[8:11], s52 offen offset:0 sc1
Mvaa 176,128,12
Ta 152,117,4096
Ta 154,117,6144
Mvaa 180,132,12
buffer_load_dwordx4 a[100:103], v112, s[8:11], s52 offen offset:1024 sc1
Mvaa 184,136,12
VE 7,7
Mvaa 188,140,12
VE 8,8
Mvaa 192,128,16
buffer_load_dwordx4 a[104:107], v112, s[8:11], s52 offen offset:2048 sc1
Mvaa 196,132,16
Ta 156,118,4096
Ta 158,118,6144
Mvaa 200,136,16
buffer_load_dwordx4 a[108:111], v112, s[8:11], s52 offen offset:3072 sc1
Mvaa 204,140,16
VE 9,9
Mvaa 208,128,20
v_add_f32 v2, 1.0, v2
v_add_f32 v3, 1.0, v3
Mvaa 212,132,20
buffer_load_dwordx4 a[112:115], v113, s[8:11], s52 offen offset:0 sc1
Mvaa 216,136,20
v_add_f32 v4, 1.0, v4
v_add_f32 v5, 1.0, v5
Mvaa 220,140,20
buffer_load_dwordx4 a[116:119], v113, s[8:11], s52 offen offset:1024 sc1
Mvaa 224,128,24
v_add_f32 v6, 1.0, v6
v_add_f32 v7, 1.0, v7
Mvaa 228,132,24
v_add_f32 v8, 1.0, v8
v_add_f32 v9, 1.0, v9
Mvaa 232,136,24
buffer_load_dwordx4 a[120:123], v113, s[8:11], s52 offen offset:2048 sc1
Mvaa 236,140,24
v_rcp_f32_e64 v2, v2
Mvaa 240,128,28
buffer_load_dwordx4 a[124:127], v113, s[8:11], s52 offen offset:3072 sc1
Mvaa 244,132,28
s_add_u32 s52, s52, 8192
Mvaa 248,136,28
v_rcp_f32_e64 v3, v3
Mvaa 252,140,28
v_rcp_f32 v4, v4
s_waitcnt vmcnt(24) lgkmcnt(0)
Mvaa 128,144,32
s_add_u32 m0, s35, 4096
Mvaa 132,148,32
buffer_load_dwordx4 v114, s[12:15], s48 offen offset:0 lds
Mvaa 136,152,32
Ta 160,115,8192
Ta 162,115,10240
Mvaa 140,156,32
buffer_load_dwordx4 v114, s[12:15], s49 offen offset:1024 lds
Mvaa 144,144,36
v_rcp_f32_e64 v5, v5
Mvaa 148,148,36
v_rcp_f32_e64 v6, v6
Mvaa 152,152,36
buffer_load_dwordx4 v114, s[12:15], s50 offen offset:2048 lds
Mvaa 156,156,36
Ta 164,116,8192
Ta 166,116,10240
Mvaa 160,144,40
buffer_load_dwordx4 v114, s[12:15], s51 offen offset:3072 lds
Mvaa 164,148,40
v_add_u32 v114, 65536, v114
Mvaa 168,152,40
v_rcp_f32_e64 v7, v7
Mvaa 172,156,40
buffer_load_dwordx4 a[0:3], v112, s[8:11], s52 offen offset:0 sc1
Mvaa 176,144,44
Ta 168,117,8192
Ta 170,117,10240
Mvaa 180,148,44
buffer_load_dwordx4 a[4:7], v112, s[8:11], s52 offen offset:1024 sc1
Mvaa 184,152,44
v_rcp_f32_e64 v8, v8
Mvaa 188,156,44
v_rcp_f32_e64 v9, v9
Mvaa 192,144,48
buffer_load_dwordx4 a[8:11], v112, s[8:11], s52 offen offset:2048 sc1
Mvaa 196,148,48
Ta 172,118,8192
Ta 174,118,10240
Mvaa 200,152,48
buffer_load_dwordx4 a[12:15], v112, s[8:11], s52 offen offset:3072 sc1
Mvaa 204,156,48
Vm 66,66,2
Vm 67,67,3
Mvaa 208,144,52
Vm 68,68,4
Vm 69,69,5
Mvaa 212,148,52
buffer_load_dwordx4 a[16:19], v113, s[8:11], s52 offen offset:0 sc1
Mvaa 216,152,52
Vm 70,70,6
Vm 71,71,7
Mvaa 220,156,52
buffer_load_dwordx4 a[20:23], v113, s[8:11], s52 offen offset:1024 sc1
Mvaa 224,144,56
Vm 72,72,8
Vm 73,73,9
Mvaa 228,148,56
Vc 2,66,67
v_lshlrev_b32_e64 v66, 16, v2
Mvaa 232,152,56
buffer_load_dwordx4 a[24:27], v113, s[8:11], s52 offen offset:2048 sc1
Mvaa 236,156,56
v_and_b32 v67, 0xffff0000, v2
Vc 3,68,69
Mvaa 240,144,60
buffer_load_dwordx4 a[28:31], v113, s[8:11], s52 offen offset:3072 sc1
Mvaa 244,148,60
s_add_u32 s52, s52, 8192
Mvaa 248,152,60
v_lshlrev_b32_e64 v68, 16, v3
v_and_b32 v69, 0xffff0000, v3
Mvaa 252,156,60
Vc 4,70,71
v_lshlrev_b32 v70, 16, v4
s_waitcnt vmcnt(24) lgkmcnt(0)
Mvaa 128,160,64
s_add_u32 m0, s35, 8192
Mvaa 132,164,64
buffer_load_dwordx4 v114, s[12:15], s48 offen offset:0 lds
Mvaa 136,168,64
Ta 176,115,12288
Ta 178,115,14336
Mvaa 140,172,64
buffer_load_dwordx4 v114, s[12:15], s49 offen offset:1024 lds
Mvaa 144,160,68
v_and_b32 v71, 0xffff0000, v4
Vc 5,72,73
Mvaa 148,164,68
v_lshlrev_b32_e64 v72, 16, v5
v_and_b32 v73, 0xffff0000, v5
Mvaa 152,168,68
buffer_load_dwordx4 v114, s[12:15], s50 offen offset:2048 lds
Mvaa 156,172,68
Ta 180,116,12288
Ta 182,116,14336
Mvaa 160,160,72
buffer_load_dwordx4 v114, s[12:15], s51 offen offset:3072 lds
Mvaa 164,164,72
v_add_u32 v114, 65536, v114
Mvaa 168,168,72
s_cmp_lg_u32 s53, 0
s_cbranch_scc1 L_yA
L_yAr:
Mvaa 172,172,72
buffer_load_dwordx4 a[32:35], v112, s[8:11], s52 offen offset:0 sc1
Mvaa 176,160,76
Ta 184,117,12288
Ta 186,117,14336
Mvaa 180,164,76
buffer_load_dwordx4 a[36:39], v112, s[8:11], s52 offen offset:1024 sc1
Mvaa 184,168,76
Mvaa 188,172,76
Mvaa 192,160,80
buffer_load_dwordx4 a[40:43], v112, s[8:11], s52 offen offset:2048 sc1
Mvaa 196,164,80
Ta 188,118,12288
Ta 190,118,14336
Mvaa 200,168,80
buffer_load_dwordx4 a[44:47], v112, s[8:11], s52 offen offset:3072 sc1
Mvaa 204,172,80
Mvaa 208,160,84
Mvaa 212,164,84
buffer_load_dwordx4 a[48:51], v113, s[8:11], s52 offen offset:0 sc1
Mvaa 216,168,84
Mvaa 220,172,84
buffer_load_dwordx4 a[52:55], v113, s[8:11], s52 offen offset:1024 sc1
Mvaa 224,160,88
Mvaa 228,164,88
Mvaa 232,168,88
buffer_load_dwordx4 a[56:59], v113, s[8:11], s52 offen offset:2048 sc1
Mvaa 236,172,88
Mvaa 240,160,92
buffer_load_dwordx4 a[60:63], v113, s[8:11], s52 offen offset:3072 sc1
Mvaa 244,164,92
s_add_u32 s52, s52, 8192
Mvaa 248,168,92
Mvaa 252,172,92
s_waitcnt vmcnt(24) lgkmcnt(0)
Mvaa 128,176,96
s_add_u32 m0, s35, 12288
Mvaa 132,180,96
buffer_load_dwordx4 v114, s[12:15], s48 offen offset:0 lds
Mvaa 136,184,96
Ta 128,115,0
Ta 130,115,2048
Mvaa 140,188,96
buffer_load_dwordx4 v114, s[12:15], s49 offen offset:1024 lds
Mvaa 144,176,100
Mvaa 148,180,100
Mvaa 152,184,100
buffer_load_dwordx4 v114, s[12:15], s50 offen offset:2048 lds
Mvaa 156,188,100
Ta 132,116,0
Ta 134,116,2048
Mvaa 160,176,104
buffer_load_dwordx4 v114, s[12:15], s51 offen offset:3072 lds
Mvaa 164,180,104
v_add_u32 v114, 65536, v114
Mvaa 168,184,104
Mvaa 172,188,104
buffer_load_dwordx4 a[64:67], v112, s[8:11], s52 offen offset:0 sc1
Mvaa 176,176,108
Ta 136,117,0
Ta 138,117,2048
Mvaa 180,180,108
buffer_load_dwordx4 a[68:71], v112, s[8:11], s52 offen offset:1024 sc1
Mvaa 184,184,108
Mvaa 188,188,108
Mvaa 192,176,112
buffer_load_dwordx4 a[72:75], v112, s[8:11], s52 offen offset:2048 sc1
Mvaa 196,180,112
Ta 140,118,0
Ta 142,118,2048
Mvaa 200,184,112
buffer_load_dwordx4 a[76:79], v112, s[8:11], s52 offen offset:3072 sc1
Mvaa 204,188,112
Mvaa 208,176,116
Mvaa 212,180,116
buffer_load_dwordx4 a[80:83], v113, s[8:11], s52 offen offset:0 sc1
Mvaa 216,184,116
Mvaa 220,188,116
buffer_load_dwordx4 a[84:87], v113, s[8:11], s52 offen offset:1024 sc1
Mvaa 224,176,120
Mvaa 228,180,120
Mvaa 232,184,120
buffer_load_dwordx4 a[88:91], v113, s[8:11], s52 offen offset:2048 sc1
Mvaa 236,188,120
Mvaa 240,176,124
buffer_load_dwordx4 a[92:95], v113, s[8:11], s52 offen offset:3072 sc1
Mvaa 244,180,124
s_add_u32 s52, s52, 8192
Mvaa 248,184,124
Mvaa 252,188,124
s_waitcnt vmcnt(24) lgkmcnt(0)
Mvaa 128,128,0
s_add_u32 m0, s35, 0
Mvaa 132,132,0
buffer_load_dwordx4 v114, s[12:15], s48 offen offset:0 lds
Mvaa 136,136,0
Ta 144,115,4096
Ta 146,115,6144
Mvaa 140,140,0
buffer_load_dwordx4 v114, s[12:15], s49 offen offset:1024 lds
Mvaa 144,128,4
Mvaa 148,132,4
Mvaa 152,136,4
buffer_load_dwordx4 v114, s[12:15], s50 offen offset:2048 lds
Mvaa 156,140,4
Ta 148,116,4096
Ta 150,116,6144
Mvaa 160,128,8
buffer_load_dwordx4 v114, s[12:15], s51 offen offset:3072 lds
Mvaa 164,132,8
v_add_u32 v114, 65536, v114
Mvaa 168,136,8
Mvaa 172,140,8
buffer_load_dwordx4 a[96:99], v112, s[8:11], s52 offen offset:0 sc1
Mvaa 176,128,12
Ta 152,117,4096
Ta 154,117,6144
Mvaa 180,132,12
buffer_load_dwordx4 a[100:103], v112, s[8:11], s52 offen offset:1024 sc1
Mvaa 184,136,12
Mvaa 188,140,12
Mvaa 192,128,16
buffer_load_dwordx4 a[104:107], v112, s[8:11], s52 offen offset:2048 sc1
Mvaa 196,132,16
Ta 156,118,4096
Ta 158,118,6144
Mvaa 200,136,16
buffer_load_dwordx4 a[108:111], v112, s[8:11], s52 offen offset:3072 sc1
Mvaa 204,140,16
Mvaa 208,128,20
Mvaa 212,132,20
buffer_load_dwordx4 a[112:115], v113, s[8:11], s52 offen offset:0 sc1
Mvaa 216,136,20
Mvaa 220,140,20
buffer_load_dwordx4 a[116:119], v113, s[8:11], s52 offen offset:1024 sc1
Mvaa 224,128,24
Mvaa 228,132,24
Mvaa 232,136,24
buffer_load_dwordx4 a[120:123], v113, s[8:11], s52 offen offset:2048 sc1
Mvaa 236,140,24
Mvaa 240,128,28
buffer_load_dwordx4 a[124:127], v113, s[8:11], s52 offen offset:3072 sc1
Mvaa 244,132,28
s_add_u32 s52, s52, 8192
Mvaa 248,136,28
Mvaa 252,140,28
s_waitcnt vmcnt(24) lgkmcnt(0)
Mvaa 128,144,32
s_add_u32 m0, s35, 4096
Mvaa 132,148,32
buffer_load_dwordx4 v114, s[12:15], s48 offen offset:0 lds
Mvaa 136,152,32
Ta 160,115,8192
Ta 162,115,10240
Mvaa 140,156,32
buffer_load_dwordx4 v114, s[12:15], s49 offen offset:1024 lds
Mvaa 144,144,36
Mvaa 148,148,36
Mvaa 152,152,36
buffer_load_dwordx4 v114, s[12:15], s50 offen offset:2048 lds
Mvaa 156,156,36
Ta 164,116,8192
Ta 166,116,10240
Mvaa 160,144,40
buffer_load_dwordx4 v114, s[12:15], s51 offen offset:3072 lds
Mvaa 164,148,40
v_add_u32 v114, 65536, v114
Mvaa 168,152,40
s_cmp_lg_u32 s53, 0
s_cbranch_scc1 L_yB
L_yBr:
Mvaa 172,156,40
buffer_load_dwordx4 a[0:3], v112, s[8:11], s52 offen offset:0 sc1
Mvaa 176,144,44
Ta 168,117,8192
Ta 170,117,10240
Mvaa 180,148,44
buffer_load_dwordx4 a[4:7], v112, s[8:11], s52 offen offset:1024 sc1
Mvaa 184,152,44
Mvaa 188,156,44
Mvaa 192,144,48
buffer_load_dwordx4 a[8:11], v112, s[8:11], s52 offen offset:2048 sc1
Mvaa 196,148,48
Ta 172,118,8192
Ta 174,118,10240
Mvaa 200,152,48
buffer_load_dwordx4 a[12:15], v112, s[8:11], s52 offen offset:3072 sc1
Mvaa 204,156,48
Mvaa 208,144,52
Mvaa 212,148,52
buffer_load_dwordx4 a[16:19], v113, s[8:11], s52 offen offset:0 sc1
Mvaa 216,152,52
Mvaa 220,156,52
buffer_load_dwordx4 a[20:23], v113, s[8:11], s52 offen offset:1024 sc1
Mvaa 224,144,56
Mvaa 228,148,56
Mvaa 232,152,56
buffer_load_dwordx4 a[24:27], v113, s[8:11], s52 offen offset:2048 sc1
Mvaa 236,156,56
Mvaa 240,144,60
buffer_load_dwordx4 a[28:31], v113, s[8:11], s52 offen offset:3072 sc1
Mvaa 244,148,60
s_add_u32 s52, s52, 8192
Mvaa 248,152,60
Mvaa 252,156,60
s_waitcnt vmcnt(24) lgkmcnt(0)
Mvaa 128,160,64
s_add_u32 m0, s35, 8192
Mvaa 132,164,64
buffer_load_dwordx4 v114, s[12:15], s48 offen offset:0 lds
Mvaa 136,168,64
Ta 176,115,12288
Ta 178,115,14336
Mvaa 140,172,64
buffer_load_dwordx4 v114, s[12:15], s49 offen offset:1024 lds
Mvaa 144,160,68
Mvaa 148,164,68
Mvaa 152,168,68
buffer_load_dwordx4 v114, s[12:15], s50 offen offset:2048 lds
Mvaa 156,172,68
Ta 180,116,12288
Ta 182,116,14336
Mvaa 160,160,72
buffer_load_dwordx4 v114, s[12:15], s51 offen offset:3072 lds
Mvaa 164,164,72
v_add_u32 v114, 65536, v114
Mvaa 168,168,72
Mvaa 172,172,72
buffer_load_dwordx4 a[32:35], v112, s[8:11], s52 offen offset:0 sc1
Mvaa 176,160,76
Ta 184,117,12288
Ta 186,117,14336
Mvaa 180,164,76
buffer_load_dwordx4 a[36:39], v112, s[8:11], s52 offen offset:1024 sc1
Mvaa 184,168,76
Mvaa 188,172,76
Mvaa 192,160,80
buffer_load_dwordx4 a[40:43], v112, s[8:11], s52 offen offset:2048 sc1
Mvaa 196,164,80
Ta 188,118,12288
Ta 190,118,14336
Mvaa 200,168,80
buffer_load_dwordx4 a[44:47], v112, s[8:11], s52 offen offset:3072 sc1
Mvaa 204,172,80
Mvaa 208,160,84
Mvaa 212,164,84
buffer_load_dwordx4 a[48:51], v113, s[8:11], s52 offen offset:0 sc1
Mvaa 216,168,84
Mvaa 220,172,84
buffer_load_dwordx4 a[52:55], v113, s[8:11], s52 offen offset:1024 sc1
Mvaa 224,160,88
Mvaa 228,164,88
Mvaa 232,168,88
buffer_load_dwordx4 a[56:59], v113, s[8:11], s52 offen offset:2048 sc1
Mvaa 236,172,88
Mvaa 240,160,92
buffer_load_dwordx4 a[60:63], v113, s[8:11], s52 offen offset:3072 sc1
Mvaa 244,164,92
s_add_u32 s52, s52, 8192
Mvaa 248,168,92
Mvaa 252,172,92
s_waitcnt vmcnt(24) lgkmcnt(0)
Mvaa 128,176,96
s_add_u32 m0, s35, 12288
Mvaa 132,180,96
buffer_load_dwordx4 v114, s[12:15], s48 offen offset:0 lds
Mvaa 136,184,96
Ta 128,115,0
Ta 130,115,2048
Mvaa 140,188,96
buffer_load_dwordx4 v114, s[12:15], s49 offen offset:1024 lds
Mvaa 144,176,100
Mvaa 148,180,100
Mvaa 152,184,100
buffer_load_dwordx4 v114, s[12:15], s50 offen offset:2048 lds
Mvaa 156,188,100
Ta 132,116,0
Ta 134,116,2048
Mvaa 160,176,104
buffer_load_dwordx4 v114, s[12:15], s51 offen offset:3072 lds
Mvaa 164,180,104
v_add_u32 v114, 65536, v114
Mvaa 168,184,104
Mvaa 172,188,104
buffer_load_dwordx4 a[64:67], v112, s[8:11], s52 offen offset:0 sc1
Mvaa 176,176,108
Ta 136,117,0
Ta 138,117,2048
Mvaa 180,180,108
buffer_load_dwordx4 a[68:71], v112, s[8:11], s52 offen offset:1024 sc1
Mvaa 184,184,108
Mvaa 188,188,108
Mvaa 192,176,112
buffer_load_dwordx4 a[72:75], v112, s[8:11], s52 offen offset:2048 sc1
Mvaa 196,180,112
Ta 140,118,0
Ta 142,118,2048
Mvaa 200,184,112
buffer_load_dwordx4 a[76:79], v112, s[8:11], s52 offen offset:3072 sc1
Mvaa 204,188,112
Mvaa 208,176,116
Mvaa 212,180,116
buffer_load_dwordx4 a[80:83], v113, s[8:11], s52 offen offset:0 sc1
Mvaa 216,184,116
Mvaa 220,188,116
buffer_load_dwordx4 a[84:87], v113, s[8:11], s52 offen offset:1024 sc1
Mvaa 224,176,120
Mvaa 228,180,120
Mvaa 232,184,120
buffer_load_dwordx4 a[88:91], v113, s[8:11], s52 offen offset:2048 sc1
Mvaa 236,188,120
Mvaa 240,176,124
buffer_load_dwordx4 a[92:95], v113, s[8:11], s52 offen offset:3072 sc1
Mvaa 244,180,124
s_add_u32 s52, s52, 8192
Mvaa 248,184,124
Mvaa 252,188,124
s_waitcnt vmcnt(24) lgkmcnt(0)
Mvaa 128,128,0
Mvaa 132,132,0
buffer_load_dwordx4 a[96:99], v112, s[8:11], s52 offen offset:0 sc1
Mvaa 136,136,0
Ta 144,115,4096
Ta 146,115,6144
Mvaa 140,140,0
buffer_load_dwordx4 a[100:103], v112, s[8:11], s52 offen offset:1024 sc1
Mvaa 144,128,4
Mvaa 148,132,4
Mvaa 152,136,4
buffer_load_dwordx4 a[104:107], v112, s[8:11], s52 offen offset:2048 sc1
Mvaa 156,140,4
Ta 148,116,4096
Ta 150,116,6144
Mvaa 160,128,8
buffer_load_dwordx4 a[108:111], v112, s[8:11], s52 offen offset:3072 sc1
Mvaa 164,132,8
Mvaa 168,136,8
Mvaa 172,140,8
buffer_load_dwordx4 a[112:115], v113, s[8:11], s52 offen offset:0 sc1
Mvaa 176,128,12
Ta 152,117,4096
Ta 154,117,6144
Mvaa 180,132,12
buffer_load_dwordx4 a[116:119], v113, s[8:11], s52 offen offset:1024 sc1
Mvaa 184,136,12
s_cmp_lg_u32 s40, 0
s_cbranch_scc1 L_yC
L_yCr:
Mvaa 188,140,12
Mvaa 192,128,16
buffer_load_dwordx4 a[120:123], v113, s[8:11], s52 offen offset:2048 sc1
Mvaa 196,132,16
Ta 156,118,4096
Ta 158,118,6144
Mvaa 200,136,16
buffer_load_dwordx4 a[124:127], v113, s[8:11], s52 offen offset:3072 sc1
Mvaa 204,140,16
s_add_u32 s52, s52, 8192
Mvaa 208,128,20
Mvaa 212,132,20
Mvaa 216,136,20
Mvaa 220,140,20
Mvaa 224,128,24
Mvaa 228,132,24
Mvaa 232,136,24
Mvaa 236,140,24
Mvaa 240,128,28
Mvaa 244,132,28
Mvaa 248,136,28
Mvaa 252,140,28
s_waitcnt vmcnt(20) lgkmcnt(0)
Mvaa 128,144,32
Mvaa 132,148,32
Mvaa 136,152,32
Ta 160,115,8192
Ta 162,115,10240
Mvaa 140,156,32
Mvaa 144,144,36
Mvaa 148,148,36
Mvaa 152,152,36
Mvaa 156,156,36
Ta 164,116,8192
Ta 166,116,10240
Mvaa 160,144,40
Mvaa 164,148,40
Mvaa 168,152,40
Mvaa 172,156,40
Mvaa 176,144,44
Ta 168,117,8192
Ta 170,117,10240
Mvaa 180,148,44
Mvaa 184,152,44
Mvaa 188,156,44
Mvaa 192,144,48
Mvaa 196,148,48
Ta 172,118,8192
Ta 174,118,10240
Mvaa 200,152,48
Mvaa 204,156,48
Mvaa 208,144,52
Mvaa 212,148,52
Mvaa 216,152,52
Mvaa 220,156,52
Mvaa 224,144,56
Mvaa 228,148,56
Mvaa 232,152,56
Mvaa 236,156,56
Mvaa 240,144,60
Mvaa 244,148,60
Mvaa 248,152,60
Mvaa 252,156,60
s_waitcnt vmcnt(8) lgkmcnt(0)
Mvaa 128,160,64
Mvaa 132,164,64
Mvaa 136,168,64
Ta 176,115,12288
Ta 178,115,14336
Mvaa 140,172,64
Mvaa 144,160,68
Mvaa 148,164,68
Mvaa 152,168,68
Mvaa 156,172,68
Ta 180,116,12288
Ta 182,116,14336
Mvaa 160,160,72
Mvaa 164,164,72
Mvaa 168,168,72
Mvaa 172,172,72
Mvaa 176,160,76
Ta 184,117,12288
Ta 186,117,14336
Mvaa 180,164,76
Mvaa 184,168,76
Mvaa 188,172,76
Mvaa 192,160,80
Mvaa 196,164,80
Ta 188,118,12288
Ta 190,118,14336
Mvaa 200,168,80
Mvaa 204,172,80
Mvaa 208,160,84
Mvaa 212,164,84
Mvaa 216,168,84
Mvaa 220,172,84
Mvaa 224,160,88
Mvaa 228,164,88
Mvaa 232,168,88
Mvaa 236,172,88
Mvaa 240,160,92
Mvaa 244,164,92
Mvaa 248,168,92
Mvaa 252,172,92
s_waitcnt vmcnt(0) lgkmcnt(0)
Mvaa 128,176,96
Mvaa 132,180,96
Mvaa 136,184,96
Mvaa 140,188,96
Mvaa 144,176,100
Mvaa 148,180,100
Mvaa 152,184,100
Mvaa 156,188,100
Mvaa 160,176,104
Mvaa 164,180,104
Mvaa 168,184,104
Mvaa 172,188,104
Mvaa 176,176,108
Mvaa 180,180,108
Mvaa 184,184,108
Mvaa 188,188,108
Mvaa 192,176,112
Mvaa 196,180,112
Mvaa 200,184,112
Mvaa 204,188,112
Mvaa 208,176,116
Mvaa 212,180,116
Mvaa 216,184,116
Mvaa 220,188,116
Mvaa 224,176,120
Mvaa 228,180,120
Mvaa 232,184,120
Mvaa 236,188,120
Mvaa 240,176,124
Mvaa 244,180,124
Mvaa 248,184,124
Mvaa 252,188,124
v_and_b32 v124, 15, v0
v_lshlrev_b32 v10, 8, v124
v_add_u32 v10, s35, v10
v_xor_b32 v124, v124, v121
v_xor_b32_e64 v125, 0, v124
v_lshl_add_u32 v115, v125, 4, v10
v_xor_b32_e64 v125, 4, v124
v_lshl_add_u32 v116, v125, 4, v10
v_xor_b32_e64 v125, 8, v124
v_lshl_add_u32 v117, v125, 4, v10
v_xor_b32_e64 v125, 12, v124
v_lshl_add_u32 v118, v125, 4, v10
ds_write_b128 v115, v[128:131] offset:0
ds_write_b128 v116, v[132:135] offset:0
ds_write_b128 v117, v[136:139] offset:0
ds_write_b128 v118, v[140:143] offset:0
ds_write_b128 v115, v[144:147] offset:4096
ds_write_b128 v116, v[148:151] offset:4096
ds_write_b128 v117, v[152:155] offset:4096
ds_write_b128 v118, v[156:159] offset:4096
ds_write_b128 v115, v[160:163] offset:8192
ds_write_b128 v116, v[164:167] offset:8192
ds_write_b128 v117, v[168:171] offset:8192
ds_write_b128 v118, v[172:175] offset:8192
ds_write_b128 v115, v[176:179] offset:12288
ds_write_b128 v116, v[180:183] offset:12288
ds_write_b128 v117, v[184:187] offset:12288
s_waitcnt lgkmcnt(9)
s_nop 0
ds_write_b128 v118, v[188:191] offset:12288
ds_write_b128 v115, v[192:195] offset:16384
ds_write_b128 v116, v[196:199] offset:16384
ds_write_b128 v117, v[200:203] offset:16384
ds_write_b128 v118, v[204:207] offset:16384
ds_write_b128 v115, v[208:211] offset:20480
s_waitcnt lgkmcnt(9)
s_nop 0
ds_write_b128 v116, v[212:215] offset:20480
ds_write_b128 v117, v[216:219] offset:20480
ds_write_b128 v118, v[220:223] offset:20480
ds_write_b128 v115, v[224:227] offset:24576
ds_write_b128 v116, v[228:231] offset:24576
ds_write_b128 v117, v[232:235] offset:24576
s_waitcnt lgkmcnt(9)
ds_write_b128 v118, v[236:239] offset:24576
ds_write_b128 v115, v[240:243] offset:28672
ds_write_b128 v116, v[244:247] offset:28672
ds_write_b128 v117, v[248:251] offset:28672
ds_write_b128 v118, v[252:255] offset:28672
s_cmp_lg_u32 s53, s40
s_cbranch_scc1 L_ysl
L_yslr:
v_and_b32 v124, 15, v120
v_lshlrev_b32 v125, 1, v122
v_xor_b32 v124, v124, v125
v_lshlrev_b32_e64 v10, 8, v120
v_lshl_add_u32 v12, v124, 4, v10
v_xor_b32_e64 v13, 16, v12
v_add_u32 v14, 65536, v12
v_add_u32 v15, 65536, v13
v_lshlrev_b32_e64 v80, 16, v18
v_and_b32 v81, 0xffff0000, v18
v_lshlrev_b32_e64 v82, 16, v19
v_and_b32 v83, 0xffff0000, v19
v_lshlrev_b32_e64 v84, 16, v20
v_and_b32 v85, 0xffff0000, v20
v_lshlrev_b32_e64 v86, 16, v21
v_and_b32 v87, 0xffff0000, v21
v_lshlrev_b32_e64 v88, 16, v22
v_and_b32 v89, 0xffff0000, v22
v_lshlrev_b32_e64 v90, 16, v23
v_and_b32 v91, 0xffff0000, v23
v_lshlrev_b32_e64 v92, 16, v24
v_and_b32 v93, 0xffff0000, v24
v_lshlrev_b32_e64 v94, 16, v25
v_and_b32 v95, 0xffff0000, v25
v_lshlrev_b32_e64 v96, 16, v26
v_and_b32 v97, 0xffff0000, v26
v_lshlrev_b32_e64 v98, 16, v27
v_and_b32 v99, 0xffff0000, v27
v_lshlrev_b32_e64 v100, 16, v28
v_and_b32 v101, 0xffff0000, v28
v_lshlrev_b32_e64 v102, 16, v29
v_and_b32 v103, 0xffff0000, v29
v_lshlrev_b32_e64 v104, 16, v30
v_and_b32 v105, 0xffff0000, v30
v_lshlrev_b32_e64 v106, 16, v31
v_and_b32 v107, 0xffff0000, v31
v_lshlrev_b32_e64 v108, 16, v32
v_and_b32 v109, 0xffff0000, v32
v_lshlrev_b32_e64 v110, 16, v33
v_and_b32 v111, 0xffff0000, v33
s_waitcnt lgkmcnt(0)
s_barrier
Rv 128,12,0
Rv 132,13,0
Rv 136,12,32768
Rv 140,13,32768
Rv 144,14,0
Rv 148,15,0
Rv 152,14,32768
Rv 156,15,32768
s_waitcnt lgkmcnt(0)
s_nop 0
Rv 160,12,8192
Rv 164,13,8192
Rv 168,12,40960
Rv 172,13,40960
Rv 176,14,8192
Rv 180,15,8192
Rv 184,14,40960
Rv 188,15,40960
v_pk_add_f32 v[128:129], v[128:129], v[136:137]
v_pk_add_f32 v[144:145], v[144:145], v[152:153]
v_pk_add_f32 v[130:131], v[130:131], v[138:139]
v_pk_add_f32 v[146:147], v[146:147], v[154:155]
v_pk_add_f32 v[132:133], v[132:133], v[140:141]
v_pk_add_f32 v[148:149], v[148:149], v[156:157]
v_pk_add_f32 v[134:135], v[134:135], v[142:143]
v_pk_add_f32 v[150:151], v[150:151], v[158:159]
v_pk_add_f32 v[128:129], v[128:129], v[144:145]
v_pk_add_f32 v[130:131], v[130:131], v[146:147]
v_pk_add_f32 v[132:133], v[132:133], v[148:149]
v_pk_add_f32 v[134:135], v[134:135], v[150:151]
Vc 136,128,129
v_lshlrev_b32_e64 v128, 16, v136
v_and_b32 v129, 0xffff0000, v136
Vc 137,130,131
v_lshlrev_b32_e64 v130, 16, v137
v_and_b32 v131, 0xffff0000, v137
Vc 138,132,133
v_lshlrev_b32_e64 v132, 16, v138
v_and_b32 v133, 0xffff0000, v138
Vc 139,134,135
v_lshlrev_b32_e64 v134, 16, v139
v_and_b32 v135, 0xffff0000, v139
v_pk_mul_f32 v[128:129], v[128:129], v[42:43]
v_pk_mul_f32 v[130:131], v[130:131], v[44:45]
v_pk_mul_f32 v[132:133], v[132:133], v[46:47]
v_pk_mul_f32 v[134:135], v[134:135], v[48:49]
Vc 136,128,129
v_lshlrev_b32_e64 v128, 16, v136
v_and_b32 v129, 0xffff0000, v136
Vc 137,130,131
v_lshlrev_b32_e64 v130, 16, v137
v_and_b32 v131, 0xffff0000, v137
Vc 138,132,133
v_lshlrev_b32_e64 v132, 16, v138
v_and_b32 v133, 0xffff0000, v138
Vc 139,134,135
v_lshlrev_b32_e64 v134, 16, v139
v_and_b32 v135, 0xffff0000, v139
v_pk_add_f32 v[128:129], v[128:129], v[80:81]
v_pk_add_f32 v[130:131], v[130:131], v[82:83]
v_pk_add_f32 v[132:133], v[132:133], v[84:85]
v_pk_add_f32 v[134:135], v[134:135], v[86:87]
Vc 136,128,129
Vc 137,130,131
Vc 138,132,133
Vc 139,134,135
buffer_store_dwordx4 v[136:139], v119, s[68:71], s36 offen sc1
s_add_u32 s36, s36, 65536
s_waitcnt lgkmcnt(0)
s_nop 0
Rv 192,12,16384
Rv 196,13,16384
Rv 200,12,49152
Rv 204,13,49152
Rv 208,14,16384
Rv 212,15,16384
Rv 216,14,49152
Rv 220,15,49152
v_pk_add_f32 v[160:161], v[160:161], v[168:169]
v_pk_add_f32 v[176:177], v[176:177], v[184:185]
v_pk_add_f32 v[162:163], v[162:163], v[170:171]
v_pk_add_f32 v[178:179], v[178:179], v[186:187]
v_pk_add_f32 v[164:165], v[164:165], v[172:173]
v_pk_add_f32 v[180:181], v[180:181], v[188:189]
v_pk_add_f32 v[166:167], v[166:167], v[174:175]
v_pk_add_f32 v[182:183], v[182:183], v[190:191]
v_pk_add_f32 v[160:161], v[160:161], v[176:177]
v_pk_add_f32 v[162:163], v[162:163], v[178:179]
v_pk_add_f32 v[164:165], v[164:165], v[180:181]
v_pk_add_f32 v[166:167], v[166:167], v[182:183]
Vc 168,160,161
v_lshlrev_b32_e64 v160, 16, v168
v_and_b32 v161, 0xffff0000, v168
Vc 169,162,163
v_lshlrev_b32_e64 v162, 16, v169
v_and_b32 v163, 0xffff0000, v169
Vc 170,164,165
v_lshlrev_b32_e64 v164, 16, v170
v_and_b32 v165, 0xffff0000, v170
Vc 171,166,167
v_lshlrev_b32_e64 v166, 16, v171
v_and_b32 v167, 0xffff0000, v171
v_pk_mul_f32 v[160:161], v[160:161], v[50:51]
v_pk_mul_f32 v[162:163], v[162:163], v[52:53]
v_pk_mul_f32 v[164:165], v[164:165], v[54:55]
v_pk_mul_f32 v[166:167], v[166:167], v[56:57]
Vc 168,160,161
v_lshlrev_b32_e64 v160, 16, v168
v_and_b32 v161, 0xffff0000, v168
Vc 169,162,163
v_lshlrev_b32_e64 v162, 16, v169
v_and_b32 v163, 0xffff0000, v169
Vc 170,164,165
v_lshlrev_b32_e64 v164, 16, v170
v_and_b32 v165, 0xffff0000, v170
Vc 171,166,167
v_lshlrev_b32_e64 v166, 16, v171
v_and_b32 v167, 0xffff0000, v171
v_pk_add_f32 v[160:161], v[160:161], v[88:89]
v_pk_add_f32 v[162:163], v[162:163], v[90:91]
v_pk_add_f32 v[164:165], v[164:165], v[92:93]
v_pk_add_f32 v[166:167], v[166:167], v[94:95]
Vc 168,160,161
Vc 169,162,163
Vc 170,164,165
Vc 171,166,167
buffer_store_dwordx4 v[168:171], v119, s[68:71], s36 offen sc1
s_add_u32 s36, s36, 65536
s_waitcnt lgkmcnt(0)
s_nop 0
Rv 224,12,24576
Rv 228,13,24576
Rv 232,12,57344
Rv 236,13,57344
Rv 240,14,24576
Rv 244,15,24576
Rv 248,14,57344
Rv 252,15,57344
v_pk_add_f32 v[192:193], v[192:193], v[200:201]
v_pk_add_f32 v[208:209], v[208:209], v[216:217]
v_pk_add_f32 v[194:195], v[194:195], v[202:203]
v_pk_add_f32 v[210:211], v[210:211], v[218:219]
v_pk_add_f32 v[196:197], v[196:197], v[204:205]
v_pk_add_f32 v[212:213], v[212:213], v[220:221]
v_pk_add_f32 v[198:199], v[198:199], v[206:207]
v_pk_add_f32 v[214:215], v[214:215], v[222:223]
v_pk_add_f32 v[192:193], v[192:193], v[208:209]
v_pk_add_f32 v[194:195], v[194:195], v[210:211]
v_pk_add_f32 v[196:197], v[196:197], v[212:213]
v_pk_add_f32 v[198:199], v[198:199], v[214:215]
Vc 200,192,193
v_lshlrev_b32_e64 v192, 16, v200
v_and_b32 v193, 0xffff0000, v200
Vc 201,194,195
v_lshlrev_b32_e64 v194, 16, v201
v_and_b32 v195, 0xffff0000, v201
Vc 202,196,197
v_lshlrev_b32_e64 v196, 16, v202
v_and_b32 v197, 0xffff0000, v202
Vc 203,198,199
v_lshlrev_b32_e64 v198, 16, v203
v_and_b32 v199, 0xffff0000, v203
v_pk_mul_f32 v[192:193], v[192:193], v[58:59]
v_pk_mul_f32 v[194:195], v[194:195], v[60:61]
v_pk_mul_f32 v[196:197], v[196:197], v[62:63]
v_pk_mul_f32 v[198:199], v[198:199], v[64:65]
Vc 200,192,193
v_lshlrev_b32_e64 v192, 16, v200
v_and_b32 v193, 0xffff0000, v200
Vc 201,194,195
v_lshlrev_b32_e64 v194, 16, v201
v_and_b32 v195, 0xffff0000, v201
Vc 202,196,197
v_lshlrev_b32_e64 v196, 16, v202
v_and_b32 v197, 0xffff0000, v202
Vc 203,198,199
v_lshlrev_b32_e64 v198, 16, v203
v_and_b32 v199, 0xffff0000, v203
v_pk_add_f32 v[192:193], v[192:193], v[96:97]
v_pk_add_f32 v[194:195], v[194:195], v[98:99]
v_pk_add_f32 v[196:197], v[196:197], v[100:101]
v_pk_add_f32 v[198:199], v[198:199], v[102:103]
Vc 200,192,193
Vc 201,194,195
Vc 202,196,197
Vc 203,198,199
buffer_store_dwordx4 v[200:203], v119, s[68:71], s36 offen sc1
s_add_u32 s36, s36, 65536
s_waitcnt lgkmcnt(0)
s_nop 0
v_pk_add_f32 v[224:225], v[224:225], v[232:233]
v_pk_add_f32 v[240:241], v[240:241], v[248:249]
v_pk_add_f32 v[226:227], v[226:227], v[234:235]
v_pk_add_f32 v[242:243], v[242:243], v[250:251]
v_pk_add_f32 v[228:229], v[228:229], v[236:237]
v_pk_add_f32 v[244:245], v[244:245], v[252:253]
v_pk_add_f32 v[230:231], v[230:231], v[238:239]
v_pk_add_f32 v[246:247], v[246:247], v[254:255]
v_pk_add_f32 v[224:225], v[224:225], v[240:241]
v_pk_add_f32 v[226:227], v[226:227], v[242:243]
v_pk_add_f32 v[228:229], v[228:229], v[244:245]
v_pk_add_f32 v[230:231], v[230:231], v[246:247]
Vc 232,224,225
v_lshlrev_b32_e64 v224, 16, v232
v_and_b32 v225, 0xffff0000, v232
Vc 233,226,227
v_lshlrev_b32_e64 v226, 16, v233
v_and_b32 v227, 0xffff0000, v233
Vc 234,228,229
v_lshlrev_b32_e64 v228, 16, v234
v_and_b32 v229, 0xffff0000, v234
Vc 235,230,231
v_lshlrev_b32_e64 v230, 16, v235
v_and_b32 v231, 0xffff0000, v235
v_pk_mul_f32 v[224:225], v[224:225], v[66:67]
v_pk_mul_f32 v[226:227], v[226:227], v[68:69]
v_pk_mul_f32 v[228:229], v[228:229], v[70:71]
v_pk_mul_f32 v[230:231], v[230:231], v[72:73]
Vc 232,224,225
v_lshlrev_b32_e64 v224, 16, v232
v_and_b32 v225, 0xffff0000, v232
Vc 233,226,227
v_lshlrev_b32_e64 v226, 16, v233
v_and_b32 v227, 0xffff0000, v233
Vc 234,228,229
v_lshlrev_b32_e64 v228, 16, v234
v_and_b32 v229, 0xffff0000, v234
Vc 235,230,231
v_lshlrev_b32_e64 v230, 16, v235
v_and_b32 v231, 0xffff0000, v235
v_pk_add_f32 v[224:225], v[224:225], v[104:105]
v_pk_add_f32 v[226:227], v[226:227], v[106:107]
v_pk_add_f32 v[228:229], v[228:229], v[108:109]
v_pk_add_f32 v[230:231], v[230:231], v[110:111]
Vc 232,224,225
Vc 233,226,227
Vc 234,228,229
Vc 235,230,231
buffer_store_dwordx4 v[232:235], v119, s[68:71], s36 offen sc1
L_k2_end:
s_endpgm
L_spinC:
s_mov_b32 s47, 0x400000
L_spinC_l:
s_sleep 4
buffer_load_dword v124, v127, s[20:23], s38 offen sc1
s_sub_u32 s47, s47, 1
s_cmp_eq_u32 s47, 0
s_cbranch_scc1 L_spinCx
s_waitcnt vmcnt(0)
v_cmp_ne_u32 vcc, 1, v124
s_cbranch_vccnz L_spinC_l
L_spinCx:
s_waitcnt vmcnt(0)
s_branch L_spinCr
L_c31:
s_bfe_u32 s3, s2, 0x40003
s_mul_i32 s3, s3, 65536
s_lshl_b32 s7, s32, 21
s_add_u32 s3, s3, s7
s_and_b32 s7, s2, 1
s_lshl_b32 s7, s7, 10
s_add_u32 s3, s3, s7
s_add_u32 s3, s3, 1048960
v_and_b32 v11, 31, v0
v_lshlrev_b32_e64 v11, 11, v11
buffer_load_dword v17, v11, s[28:31], s3 offen
s_branch L_c31r
L_f2A:
s_lshr_b32 s5, s54, 1
s_lshl_b32 s5, s5, 5
s_add_u32 s5, s5, 5302272
buffer_load_dword v125, v127, s[20:23], s5 offen sc1
s_branch L_f2Ar
L_f2B:
s_waitcnt vmcnt(24)
v_cmp_ne_u32 vcc, 1, v125
s_cbranch_vccz L_f2lx
s_mov_b32 s47, 0x400000
L_f2l:
buffer_load_dword v125, v127, s[20:23], s5 offen sc1
s_sub_u32 s47, s47, 1
s_waitcnt vmcnt(0)
s_cmp_eq_u32 s47, 0
s_cbranch_scc1 L_f2lx
v_cmp_ne_u32 vcc, 1, v125
s_cbranch_vccz L_f2lx
s_sleep 8
s_branch L_f2l
L_f2lx:
s_lshl_b32 s3, s54, 8
s_add_u32 s3, s3, 6291456
v_mul_u32_u24 v124, 14336, v121
v_and_b32_e64 v125, 15, v0
v_lshl_add_u32 v124, v125, 4, v124
buffer_load_dwordx4 v[74:77], v124, s[20:23], s3 offen sc1
s_add_u32 s3, s3, 57344
buffer_load_dwordx4 v[78:81], v124, s[20:23], s3 offen sc1
s_add_u32 s3, s3, 57344
buffer_load_dwordx4 v[82:85], v124, s[20:23], s3 offen sc1
s_add_u32 s3, s3, 57344
buffer_load_dwordx4 v[86:89], v124, s[20:23], s3 offen sc1
s_add_u32 s3, s3, 57344
buffer_load_dwordx4 v[90:93], v124, s[20:23], s3 offen sc1
s_add_u32 s3, s3, 57344
buffer_load_dwordx4 v[94:97], v124, s[20:23], s3 offen sc1
s_add_u32 s3, s3, 57344
buffer_load_dwordx4 v[98:101], v124, s[20:23], s3 offen sc1
s_add_u32 s3, s3, 57344
buffer_load_dwordx4 v[102:105], v124, s[20:23], s3 offen sc1
s_branch L_f2Br
L_f2C:
s_waitcnt vmcnt(24) lgkmcnt(0)
Ta 192,115,16384
Ta 194,115,18432
Ta 196,116,16384
Ta 198,116,18432
Ta 200,117,16384
Ta 202,117,18432
Ta 204,118,16384
Ta 206,118,18432
v_pk_add_f32 v[74:75], v[74:75], v[78:79]
v_pk_add_f32 v[76:77], v[76:77], v[80:81]
v_pk_add_f32 v[74:75], v[74:75], v[82:83]
v_pk_add_f32 v[76:77], v[76:77], v[84:85]
v_pk_add_f32 v[74:75], v[74:75], v[86:87]
v_pk_add_f32 v[76:77], v[76:77], v[88:89]
Ta 208,115,20480
Ta 210,115,22528
Ta 212,116,20480
Ta 214,116,22528
Ta 216,117,20480
Ta 218,117,22528
Ta 220,118,20480
s_waitcnt lgkmcnt(9)
s_nop 0
Ta 222,118,22528
v_pk_add_f32 v[74:75], v[74:75], v[90:91]
v_pk_add_f32 v[76:77], v[76:77], v[92:93]
v_pk_add_f32 v[74:75], v[74:75], v[94:95]
v_pk_add_f32 v[76:77], v[76:77], v[96:97]
v_pk_add_f32 v[74:75], v[74:75], v[98:99]
v_pk_add_f32 v[76:77], v[76:77], v[100:101]
v_pk_add_f32 v[74:75], v[74:75], v[102:103]
v_pk_add_f32 v[76:77], v[76:77], v[104:105]
Vc 125,74,75
v_lshlrev_b32_e64 v74, 16, v125
v_and_b32 v75, 0xffff0000, v125
Vc 125,76,77
v_lshlrev_b32_e64 v76, 16, v125
v_and_b32 v77, 0xffff0000, v125
v_mov_b32 v82, v74
v_mov_b32 v83, v75
v_mov_b32 v84, v76
v_mov_b32 v85, v77
v_permlane32_swap_b32 v82, v74
v_permlane32_swap_b32 v83, v75
v_permlane32_swap_b32 v84, v76
v_permlane32_swap_b32 v85, v77
v_mul_f32 v90, 0xbfb8aa3b, v82
v_mul_f32 v91, 0xbfb8aa3b, v83
v_mul_f32 v92, 0xbfb8aa3b, v84
v_mul_f32 v93, 0xbfb8aa3b, v85
Ve 90,90
Ve 91,91
Ve 92,92
Ve 93,93
v_add_f32 v90, 1.0, v90
v_add_f32 v91, 1.0, v91
v_add_f32 v92, 1.0, v92
v_add_f32 v93, 1.0, v93
v_rcp_f32 v90, v90
v_rcp_f32 v91, v91
v_rcp_f32 v92, v92
v_rcp_f32 v93, v93
Vm 82,82,90
Vm 83,83,91
Vm 84,84,92
Vm 85,85,93
Vc 125,82,83
v_lshlrev_b32_e64 v82, 16, v125
v_and_b32 v83, 0xffff0000, v125
Vc 125,84,85
v_lshlrev_b32_e64 v84, 16, v125
v_and_b32 v85, 0xffff0000, v125
Vm 74,74,82
Vm 75,75,83
Vm 76,76,84
Vm 77,77,85
Vc 90,74,75
Vc 91,76,77
s_lshl_b32 s7, s32, 9
s_add_u32 s7, s7, 131072
v_and_b32 v124, 1, v121
v_lshlrev_b32 v124, 8, v124
v_and_b32 v125, 15, v0
v_lshl_add_u32 v124, v125, 3, v124
v_add_u32_e64 v124, s7, v124
ds_write_b64 v124, v[90:91]
v_and_b32 v124, 1, v0
v_lshlrev_b32 v124, 8, v124
v_lshl_add_u32 v94, v121, 3, v124
v_add_u32_e64 v94, s7, v94
ds_read_b64 v[74:75], v94 offset:0
ds_read_b64 v[76:77], v94 offset:32
ds_read_b64 v[78:79], v94 offset:64
ds_read_b64 v[80:81], v94 offset:96
v_lshl_add_u32 v124, v121, 4, v124
v_add_u32 v124, s7, v124
s_waitcnt lgkmcnt(0)
Zvav 96,192,74
Zvav 100,196,74
Zvav 104,200,74
Zvav 108,204,74
Mvav 96,208,78
Mvav 100,212,78
Mvav 104,216,78
Mvav 108,220,78
s_nop 4
ds_write_b128 v124, v[96:99] offset:2048
ds_write_b128 v124, v[100:103] offset:2112
ds_write_b128 v124, v[104:107] offset:2176
ds_write_b128 v124, v[108:111] offset:2240
s_waitcnt lgkmcnt(0)
s_barrier
s_cmp_lg_u32 s32, 0
s_cbranch_scc1 L_f2Cr
v_lshlrev_b32 v124, 3, v0
v_add_u32 v125, 133120, v124
ds_read_b64 v[74:75], v125 offset:0
ds_read_b64 v[76:77], v125 offset:512
ds_read_b64 v[78:79], v125 offset:1024
ds_read_b64 v[80:81], v125 offset:1536
s_lshl_b32 s3, s39, 4
s_add_u32 s3, s3, s37
s_lshl_b32 s3, s3, 9
s_add_u32 s3, s3, 5308416
s_waitcnt lgkmcnt(0)
v_pk_add_f32 v[74:75], v[74:75], v[76:77]
v_pk_add_f32 v[78:79], v[78:79], v[80:81]
v_pk_add_f32 v[74:75], v[74:75], v[78:79]
buffer_store_dwordx2 v[74:75], v124, s[20:23], s3 offen sc1
s_branch L_f2Cr
L_f2E:
s_cmp_lg_u32 s32, 0
s_cbranch_scc1 L_f2Er
v_mov_b32 v125, 1
s_lshl_b32 s3, s39, 5
s_add_u32 s3, s3, s37
s_lshl_b32 s3, s3, 2
s_add_u32 s3, s3, 5304320
s_waitcnt vmcnt(24)
s_mov_b64 exec, 1
buffer_store_dword v125, v126, s[20:23], s3 offen sc1
s_mov_b64 exec, -1
s_branch L_f2Er
L_yA:
v_min_u32 v127, 13, v0
v_lshlrev_b32_e64 v127, 2, v127
buffer_load_dword v124, v127, s[20:23], s41 offen sc1
s_branch L_yAr
L_yB:
s_waitcnt vmcnt(24)
v_cmp_ne_u32 vcc, 1, v124
s_cbranch_vccnz L_yBr
s_mov_b32 s40, 1
v_lshlrev_b32 v125, 10, v123
v_lshl_add_u32 v125, v122, 5, v125
v_mov_b32 v124, 2146435072
v_cmp_gt_u32 vcc, 7, v123
s_nop 1
v_cndmask_b32 v125, v124, v125, vcc
s_nop 0
buffer_load_dwordx4 v[80:83], v125, s[20:23], s44 offen offset:0 sc1
buffer_load_dwordx4 v[84:87], v125, s[20:23], s44 offen offset:16 sc1
buffer_load_dwordx4 v[88:91], v125, s[20:23], s44 offen offset:256 sc1
buffer_load_dwordx4 v[92:95], v125, s[20:23], s44 offen offset:272 sc1
buffer_load_dwordx4 v[96:99], v125, s[20:23], s44 offen offset:512 sc1
buffer_load_dwordx4 v[100:103], v125, s[20:23], s44 offen offset:528 sc1
buffer_load_dwordx4 v[104:107], v125, s[20:23], s44 offen offset:768 sc1
buffer_load_dwordx4 v[108:111], v125, s[20:23], s44 offen offset:784 sc1
s_branch L_yBr
L_yC:
s_waitcnt vmcnt(8)
v_pk_add_f32 v[80:81], v[80:81], v[96:97]
v_pk_add_f32 v[82:83], v[82:83], v[98:99]
v_pk_add_f32 v[84:85], v[84:85], v[100:101]
v_pk_add_f32 v[86:87], v[86:87], v[102:103]
v_pk_add_f32 v[88:89], v[88:89], v[104:105]
v_pk_add_f32 v[90:91], v[90:91], v[106:107]
v_pk_add_f32 v[92:93], v[92:93], v[108:109]
v_pk_add_f32 v[94:95], v[94:95], v[110:111]
v_add_f32_dpp v80, v80, v80 row_ror:8 row_mask:0xf bank_mask:0xf
v_add_f32_dpp v81, v81, v81 row_ror:8 row_mask:0xf bank_mask:0xf
v_add_f32_dpp v82, v82, v82 row_ror:8 row_mask:0xf bank_mask:0xf
v_add_f32_dpp v83, v83, v83 row_ror:8 row_mask:0xf bank_mask:0xf
v_add_f32_dpp v84, v84, v84 row_ror:8 row_mask:0xf bank_mask:0xf
v_add_f32_dpp v85, v85, v85 row_ror:8 row_mask:0xf bank_mask:0xf
v_add_f32_dpp v86, v86, v86 row_ror:8 row_mask:0xf bank_mask:0xf
v_add_f32_dpp v87, v87, v87 row_ror:8 row_mask:0xf bank_mask:0xf
v_add_f32_dpp v88, v88, v88 row_ror:8 row_mask:0xf bank_mask:0xf
v_add_f32_dpp v89, v89, v89 row_ror:8 row_mask:0xf bank_mask:0xf
v_add_f32_dpp v90, v90, v90 row_ror:8 row_mask:0xf bank_mask:0xf
v_add_f32_dpp v91, v91, v91 row_ror:8 row_mask:0xf bank_mask:0xf
v_add_f32_dpp v92, v92, v92 row_ror:8 row_mask:0xf bank_mask:0xf
v_add_f32_dpp v93, v93, v93 row_ror:8 row_mask:0xf bank_mask:0xf
v_add_f32_dpp v94, v94, v94 row_ror:8 row_mask:0xf bank_mask:0xf
v_add_f32_dpp v95, v95, v95 row_ror:8 row_mask:0xf bank_mask:0xf
v_mov_b32 v96, v80
v_mov_b32 v97, v81
v_mov_b32 v98, v82
v_mov_b32 v99, v83
v_mov_b32 v100, v84
v_mov_b32 v101, v85
v_mov_b32 v102, v86
v_mov_b32 v103, v87
v_mov_b32 v104, v88
v_mov_b32 v105, v89
v_mov_b32 v106, v90
v_mov_b32 v107, v91
v_mov_b32 v108, v92
v_mov_b32 v109, v93
v_mov_b32 v110, v94
v_mov_b32 v111, v95
v_permlane16_swap_b32 v96, v80
v_permlane16_swap_b32 v97, v81
v_permlane16_swap_b32 v98, v82
v_permlane16_swap_b32 v99, v83
v_permlane16_swap_b32 v100, v84
v_permlane16_swap_b32 v101, v85
v_permlane16_swap_b32 v102, v86
v_permlane16_swap_b32 v103, v87
v_permlane16_swap_b32 v104, v88
v_permlane16_swap_b32 v105, v89
v_permlane16_swap_b32 v106, v90
v_permlane16_swap_b32 v107, v91
v_permlane16_swap_b32 v108, v92
v_permlane16_swap_b32 v109, v93
v_permlane16_swap_b32 v110, v94
v_permlane16_swap_b32 v111, v95
Va 80,80,96
Va 81,81,97
Va 82,82,98
Va 83,83,99
Va 84,84,100
Va 85,85,101
Va 86,86,102
Va 87,87,103
Va 88,88,104
Va 89,89,105
Va 90,90,106
Va 91,91,107
Va 92,92,108
Va 93,93,109
Va 94,94,110
Va 95,95,111
v_mov_b32 v96, v80
v_mov_b32 v97, v81
v_mov_b32 v98, v82
v_mov_b32 v99, v83
v_mov_b32 v100, v84
v_mov_b32 v101, v85
v_mov_b32 v102, v86
v_mov_b32 v103, v87
v_mov_b32 v104, v88
v_mov_b32 v105, v89
v_mov_b32 v106, v90
v_mov_b32 v107, v91
v_mov_b32 v108, v92
v_mov_b32 v109, v93
v_mov_b32 v110, v94
v_mov_b32 v111, v95
v_permlane32_swap_b32 v96, v80
v_permlane32_swap_b32 v97, v81
v_permlane32_swap_b32 v98, v82
v_permlane32_swap_b32 v99, v83
v_permlane32_swap_b32 v100, v84
v_permlane32_swap_b32 v101, v85
v_permlane32_swap_b32 v102, v86
v_permlane32_swap_b32 v103, v87
v_permlane32_swap_b32 v104, v88
v_permlane32_swap_b32 v105, v89
v_permlane32_swap_b32 v106, v90
v_permlane32_swap_b32 v107, v91
v_permlane32_swap_b32 v108, v92
v_permlane32_swap_b32 v109, v93
v_permlane32_swap_b32 v110, v94
v_permlane32_swap_b32 v111, v95
Va 80,80,96
Va 81,81,97
Va 82,82,98
Va 83,83,99
Va 84,84,100
Va 85,85,101
Va 86,86,102
Va 87,87,103
Va 88,88,104
Va 89,89,105
Va 90,90,106
Va 91,91,107
Va 92,92,108
Va 93,93,109
Va 94,94,110
Va 95,95,111
Vc 124,80,81
v_lshlrev_b32_e64 v80, 16, v124
v_and_b32 v81, 0xffff0000, v124
Vc 124,82,83
v_lshlrev_b32_e64 v82, 16, v124
v_and_b32 v83, 0xffff0000, v124
Vc 124,84,85
v_lshlrev_b32_e64 v84, 16, v124
v_and_b32 v85, 0xffff0000, v124
Vc 124,86,87
v_lshlrev_b32_e64 v86, 16, v124
v_and_b32 v87, 0xffff0000, v124
Vc 124,88,89
v_lshlrev_b32_e64 v88, 16, v124
v_and_b32 v89, 0xffff0000, v124
Vc 124,90,91
v_lshlrev_b32_e64 v90, 16, v124
v_and_b32 v91, 0xffff0000, v124
Vc 124,92,93
v_lshlrev_b32_e64 v92, 16, v124
v_and_b32 v93, 0xffff0000, v124
Vc 124,94,95
v_lshlrev_b32_e64 v94, 16, v124
v_and_b32 v95, 0xffff0000, v124
v_mul_f32 v80, s100, v80
v_mul_f32 v81, s100, v81
v_mul_f32 v82, s100, v82
v_mul_f32 v83, s100, v83
v_mul_f32 v84, s100, v84
v_mul_f32 v85, s100, v85
v_mul_f32 v86, s100, v86
v_mul_f32 v87, s100, v87
v_mul_f32 v88, s101, v88
v_mul_f32 v89, s101, v89
v_mul_f32 v90, s101, v90
v_mul_f32 v91, s101, v91
v_mul_f32 v92, s101, v92
v_mul_f32 v93, s101, v93
v_mul_f32 v94, s101, v94
v_mul_f32 v95, s101, v95
Vc 124,80,81
v_lshlrev_b32_e64 v80, 16, v124
v_and_b32 v81, 0xffff0000, v124
Vc 124,82,83
v_lshlrev_b32_e64 v82, 16, v124
v_and_b32 v83, 0xffff0000, v124
Vc 124,84,85
v_lshlrev_b32_e64 v84, 16, v124
v_and_b32 v85, 0xffff0000, v124
Vc 124,86,87
v_lshlrev_b32_e64 v86, 16, v124
v_and_b32 v87, 0xffff0000, v124
Vc 124,88,89
v_lshlrev_b32_e64 v88, 16, v124
v_and_b32 v89, 0xffff0000, v124
Vc 124,90,91
v_lshlrev_b32_e64 v90, 16, v124
v_and_b32 v91, 0xffff0000, v124
Vc 124,92,93
v_lshlrev_b32_e64 v92, 16, v124
v_and_b32 v93, 0xffff0000, v124
Vc 124,94,95
v_lshlrev_b32_e64 v94, 16, v124
v_and_b32 v95, 0xffff0000, v124
s_lshl_b32 s3, s45, 7
s_sub_u32 s42, s42, s3
s_sub_u32 s43, s43, s3
v_add_u32 v124, 0, v120
v_cmp_eq_u32 vcc, s42, v124
v_cmp_eq_u32 s[6:7], s43, v124
s_nop 3
s_or_b64 s[4:5], vcc, s[6:7]
s_cbranch_scc0 L_f_selskip1
v_cndmask_b32 v96, 0, v80, vcc
v_cndmask_b32 v96, v96, v88, s[6:7]
v_cndmask_b32 v97, 0, v81, vcc
v_cndmask_b32 v97, v97, v89, s[6:7]
v_cndmask_b32 v98, 0, v82, vcc
v_cndmask_b32 v98, v98, v90, s[6:7]
v_cndmask_b32 v99, 0, v83, vcc
v_cndmask_b32 v99, v99, v91, s[6:7]
v_cndmask_b32 v100, 0, v84, vcc
v_cndmask_b32 v100, v100, v92, s[6:7]
v_cndmask_b32 v101, 0, v85, vcc
v_cndmask_b32 v101, v101, v93, s[6:7]
v_cndmask_b32 v102, 0, v86, vcc
v_cndmask_b32 v102, v102, v94, s[6:7]
v_cndmask_b32 v103, 0, v87, vcc
v_cndmask_b32 v103, v103, v95, s[6:7]
v_lshlrev_b32_e64 v42, 16, v18
v_and_b32 v43, 0xffff0000, v18
v_lshlrev_b32_e64 v44, 16, v19
v_and_b32 v45, 0xffff0000, v19
v_lshlrev_b32_e64 v46, 16, v20
v_and_b32 v47, 0xffff0000, v20
v_lshlrev_b32_e64 v48, 16, v21
v_and_b32 v49, 0xffff0000, v21
Vs 42,42,34
Vs 43,43,34
Vs 44,44,34
Vs 45,45,34
Vs 46,46,34
Vs 47,47,34
Vs 48,48,34
Vs 49,49,34
Vc 2,42,43
v_lshlrev_b32_e64 v42, 16, v2
v_and_b32 v43, 0xffff0000, v2
Vc 3,44,45
v_lshlrev_b32_e64 v44, 16, v3
v_and_b32 v45, 0xffff0000, v3
Vc 4,46,47
v_lshlrev_b32_e64 v46, 16, v4
v_and_b32 v47, 0xffff0000, v4
Vc 5,48,49
v_lshlrev_b32_e64 v48, 16, v5
v_and_b32 v49, 0xffff0000, v5
Vm 42,42,35
Vm 43,43,35
Vm 44,44,35
Vm 45,45,35
Vm 46,46,35
Vm 47,47,35
Vm 48,48,35
Vm 49,49,35
Vc 2,42,43
v_lshlrev_b32_e64 v42, 16, v2
v_and_b32 v43, 0xffff0000, v2
Vc 3,44,45
v_lshlrev_b32_e64 v44, 16, v3
v_and_b32 v45, 0xffff0000, v3
Vc 4,46,47
v_lshlrev_b32_e64 v46, 16, v4
v_and_b32 v47, 0xffff0000, v4
Vc 5,48,49
v_lshlrev_b32_e64 v48, 16, v5
v_and_b32 v49, 0xffff0000, v5
Va 42,42,96
Va 43,43,97
Va 44,44,98
Va 45,45,99
Va 46,46,100
Va 47,47,101
Va 48,48,102
Va 49,49,103
Vc 2,42,43
v_lshlrev_b32_e64 v42, 16, v2
v_and_b32 v43, 0xffff0000, v2
Vc 3,44,45
v_lshlrev_b32_e64 v44, 16, v3
v_and_b32 v45, 0xffff0000, v3
Vc 4,46,47
v_lshlrev_b32_e64 v46, 16, v4
v_and_b32 v47, 0xffff0000, v4
Vc 5,48,49
v_lshlrev_b32_e64 v48, 16, v5
v_and_b32 v49, 0xffff0000, v5
v_mul_f32 v2, 0xbfb8aa3b, v42
v_mul_f32 v3, 0xbfb8aa3b, v43
v_mul_f32 v4, 0xbfb8aa3b, v44
v_mul_f32 v5, 0xbfb8aa3b, v45
v_mul_f32 v6, 0xbfb8aa3b, v46
v_mul_f32 v7, 0xbfb8aa3b, v47
v_mul_f32 v8, 0xbfb8aa3b, v48
v_mul_f32 v9, 0xbfb8aa3b, v49
Ve 2,2
Ve 3,3
Ve 4,4
Ve 5,5
Ve 6,6
Ve 7,7
Ve 8,8
Ve 9,9
v_add_f32 v2, 1.0, v2
v_add_f32 v3, 1.0, v3
v_add_f32 v4, 1.0, v4
v_add_f32 v5, 1.0, v5
v_add_f32 v6, 1.0, v6
v_add_f32 v7, 1.0, v7
v_add_f32 v8, 1.0, v8
v_add_f32 v9, 1.0, v9
v_rcp_f32 v2, v2
v_rcp_f32 v3, v3
v_rcp_f32 v4, v4
v_rcp_f32 v5, v5
v_rcp_f32 v6, v6
v_rcp_f32 v7, v7
v_rcp_f32 v8, v8
v_rcp_f32 v9, v9
Vm 42,42,2
Vm 43,43,3
Vm 44,44,4
Vm 45,45,5
Vm 46,46,6
Vm 47,47,7
Vm 48,48,8
Vm 49,49,9
Vc 2,42,43
v_lshlrev_b32_e64 v42, 16, v2
v_and_b32 v43, 0xffff0000, v2
Vc 3,44,45
v_lshlrev_b32_e64 v44, 16, v3
v_and_b32 v45, 0xffff0000, v3
Vc 4,46,47
v_lshlrev_b32_e64 v46, 16, v4
v_and_b32 v47, 0xffff0000, v4
Vc 5,48,49
v_lshlrev_b32_e64 v48, 16, v5
v_and_b32 v49, 0xffff0000, v5
L_f_selskip1:
v_add_u32 v124, 32, v120
v_cmp_eq_u32 vcc, s42, v124
v_cmp_eq_u32 s[6:7], s43, v124
s_nop 3
s_or_b64 s[4:5], vcc, s[6:7]
s_cbranch_scc0 L_f_selskip2
v_cndmask_b32 v96, 0, v80, vcc
v_cndmask_b32 v96, v96, v88, s[6:7]
v_cndmask_b32 v97, 0, v81, vcc
v_cndmask_b32 v97, v97, v89, s[6:7]
v_cndmask_b32 v98, 0, v82, vcc
v_cndmask_b32 v98, v98, v90, s[6:7]
v_cndmask_b32 v99, 0, v83, vcc
v_cndmask_b32 v99, v99, v91, s[6:7]
v_cndmask_b32 v100, 0, v84, vcc
v_cndmask_b32 v100, v100, v92, s[6:7]
v_cndmask_b32 v101, 0, v85, vcc
v_cndmask_b32 v101, v101, v93, s[6:7]
v_cndmask_b32 v102, 0, v86, vcc
v_cndmask_b32 v102, v102, v94, s[6:7]
v_cndmask_b32 v103, 0, v87, vcc
v_cndmask_b32 v103, v103, v95, s[6:7]
v_lshlrev_b32 v50, 16, v22
v_and_b32 v51, 0xffff0000, v22
v_lshlrev_b32_e64 v52, 16, v23
v_and_b32 v53, 0xffff0000, v23
v_lshlrev_b32_e64 v54, 16, v24
v_and_b32 v55, 0xffff0000, v24
v_lshlrev_b32_e64 v56, 16, v25
v_and_b32 v57, 0xffff0000, v25
Vs 50,50,36
Vs 51,51,36
Vs 52,52,36
Vs 53,53,36
Vs 54,54,36
Vs 55,55,36
Vs 56,56,36
Vs 57,57,36
Vc 2,50,51
v_lshlrev_b32_e64 v50, 16, v2
v_and_b32 v51, 0xffff0000, v2
Vc 3,52,53
v_lshlrev_b32_e64 v52, 16, v3
v_and_b32 v53, 0xffff0000, v3
Vc 4,54,55
v_lshlrev_b32_e64 v54, 16, v4
v_and_b32 v55, 0xffff0000, v4
Vc 5,56,57
v_lshlrev_b32_e64 v56, 16, v5
v_and_b32 v57, 0xffff0000, v5
Vm 50,50,37
Vm 51,51,37
Vm 52,52,37
Vm 53,53,37
Vm 54,54,37
Vm 55,55,37
Vm 56,56,37
Vm 57,57,37
Vc 2,50,51
v_lshlrev_b32_e64 v50, 16, v2
v_and_b32 v51, 0xffff0000, v2
Vc 3,52,53
v_lshlrev_b32_e64 v52, 16, v3
v_and_b32 v53, 0xffff0000, v3
Vc 4,54,55
v_lshlrev_b32_e64 v54, 16, v4
v_and_b32 v55, 0xffff0000, v4
Vc 5,56,57
v_lshlrev_b32_e64 v56, 16, v5
v_and_b32 v57, 0xffff0000, v5
Va 50,50,96
Va 51,51,97
Va 52,52,98
Va 53,53,99
Va 54,54,100
Va 55,55,101
Va 56,56,102
Va 57,57,103
Vc 2,50,51
v_lshlrev_b32_e64 v50, 16, v2
v_and_b32 v51, 0xffff0000, v2
Vc 3,52,53
v_lshlrev_b32_e64 v52, 16, v3
v_and_b32 v53, 0xffff0000, v3
Vc 4,54,55
v_lshlrev_b32_e64 v54, 16, v4
v_and_b32 v55, 0xffff0000, v4
Vc 5,56,57
v_lshlrev_b32_e64 v56, 16, v5
v_and_b32 v57, 0xffff0000, v5
v_mul_f32 v2, 0xbfb8aa3b, v50
v_mul_f32 v3, 0xbfb8aa3b, v51
v_mul_f32 v4, 0xbfb8aa3b, v52
v_mul_f32 v5, 0xbfb8aa3b, v53
v_mul_f32 v6, 0xbfb8aa3b, v54
v_mul_f32 v7, 0xbfb8aa3b, v55
v_mul_f32 v8, 0xbfb8aa3b, v56
v_mul_f32 v9, 0xbfb8aa3b, v57
Ve 2,2
Ve 3,3
Ve 4,4
Ve 5,5
Ve 6,6
Ve 7,7
Ve 8,8
Ve 9,9
v_add_f32 v2, 1.0, v2
v_add_f32 v3, 1.0, v3
v_add_f32 v4, 1.0, v4
v_add_f32 v5, 1.0, v5
v_add_f32 v6, 1.0, v6
v_add_f32 v7, 1.0, v7
v_add_f32 v8, 1.0, v8
v_add_f32 v9, 1.0, v9
v_rcp_f32 v2, v2
v_rcp_f32 v3, v3
v_rcp_f32 v4, v4
v_rcp_f32 v5, v5
v_rcp_f32 v6, v6
v_rcp_f32 v7, v7
v_rcp_f32 v8, v8
v_rcp_f32 v9, v9
Vm 50,50,2
Vm 51,51,3
Vm 52,52,4
Vm 53,53,5
Vm 54,54,6
Vm 55,55,7
Vm 56,56,8
Vm 57,57,9
Vc 2,50,51
v_lshlrev_b32_e64 v50, 16, v2
v_and_b32 v51, 0xffff0000, v2
Vc 3,52,53
v_lshlrev_b32_e64 v52, 16, v3
v_and_b32 v53, 0xffff0000, v3
Vc 4,54,55
v_lshlrev_b32_e64 v54, 16, v4
v_and_b32 v55, 0xffff0000, v4
Vc 5,56,57
v_lshlrev_b32_e64 v56, 16, v5
v_and_b32 v57, 0xffff0000, v5
L_f_selskip2:
v_add_u32 v124, 64, v120
v_cmp_eq_u32 vcc, s42, v124
v_cmp_eq_u32 s[6:7], s43, v124
s_nop 3
s_or_b64 s[4:5], vcc, s[6:7]
s_cbranch_scc0 L_f_selskip3
v_cndmask_b32 v96, 0, v80, vcc
v_cndmask_b32 v96, v96, v88, s[6:7]
v_cndmask_b32 v97, 0, v81, vcc
v_cndmask_b32 v97, v97, v89, s[6:7]
v_cndmask_b32 v98, 0, v82, vcc
v_cndmask_b32 v98, v98, v90, s[6:7]
v_cndmask_b32 v99, 0, v83, vcc
v_cndmask_b32 v99, v99, v91, s[6:7]
v_cndmask_b32 v100, 0, v84, vcc
v_cndmask_b32 v100, v100, v92, s[6:7]
v_cndmask_b32 v101, 0, v85, vcc
v_cndmask_b32 v101, v101, v93, s[6:7]
v_cndmask_b32 v102, 0, v86, vcc
v_cndmask_b32 v102, v102, v94, s[6:7]
v_cndmask_b32 v103, 0, v87, vcc
v_cndmask_b32 v103, v103, v95, s[6:7]
v_lshlrev_b32 v58, 16, v26
v_and_b32 v59, 0xffff0000, v26
v_lshlrev_b32_e64 v60, 16, v27
v_and_b32 v61, 0xffff0000, v27
v_lshlrev_b32_e64 v62, 16, v28
v_and_b32 v63, 0xffff0000, v28
v_lshlrev_b32_e64 v64, 16, v29
v_and_b32 v65, 0xffff0000, v29
Vs 58,58,38
Vs 59,59,38
Vs 60,60,38
Vs 61,61,38
Vs 62,62,38
Vs 63,63,38
Vs 64,64,38
Vs 65,65,38
Vc 2,58,59
v_lshlrev_b32_e64 v58, 16, v2
v_and_b32 v59, 0xffff0000, v2
Vc 3,60,61
v_lshlrev_b32_e64 v60, 16, v3
v_and_b32 v61, 0xffff0000, v3
Vc 4,62,63
v_lshlrev_b32_e64 v62, 16, v4
v_and_b32 v63, 0xffff0000, v4
Vc 5,64,65
v_lshlrev_b32_e64 v64, 16, v5
v_and_b32 v65, 0xffff0000, v5
Vm 58,58,39
Vm 59,59,39
Vm 60,60,39
Vm 61,61,39
Vm 62,62,39
Vm 63,63,39
Vm 64,64,39
Vm 65,65,39
Vc 2,58,59
v_lshlrev_b32_e64 v58, 16, v2
v_and_b32 v59, 0xffff0000, v2
Vc 3,60,61
v_lshlrev_b32_e64 v60, 16, v3
v_and_b32 v61, 0xffff0000, v3
Vc 4,62,63
v_lshlrev_b32_e64 v62, 16, v4
v_and_b32 v63, 0xffff0000, v4
Vc 5,64,65
v_lshlrev_b32_e64 v64, 16, v5
v_and_b32 v65, 0xffff0000, v5
Va 58,58,96
Va 59,59,97
Va 60,60,98
Va 61,61,99
Va 62,62,100
Va 63,63,101
Va 64,64,102
Va 65,65,103
Vc 2,58,59
v_lshlrev_b32_e64 v58, 16, v2
v_and_b32 v59, 0xffff0000, v2
Vc 3,60,61
v_lshlrev_b32_e64 v60, 16, v3
v_and_b32 v61, 0xffff0000, v3
Vc 4,62,63
v_lshlrev_b32_e64 v62, 16, v4
v_and_b32 v63, 0xffff0000, v4
Vc 5,64,65
v_lshlrev_b32_e64 v64, 16, v5
v_and_b32 v65, 0xffff0000, v5
v_mul_f32 v2, 0xbfb8aa3b, v58
v_mul_f32 v3, 0xbfb8aa3b, v59
v_mul_f32 v4, 0xbfb8aa3b, v60
v_mul_f32 v5, 0xbfb8aa3b, v61
v_mul_f32 v6, 0xbfb8aa3b, v62
v_mul_f32 v7, 0xbfb8aa3b, v63
v_mul_f32 v8, 0xbfb8aa3b, v64
v_mul_f32 v9, 0xbfb8aa3b, v65
Ve 2,2
Ve 3,3
Ve 4,4
Ve 5,5
Ve 6,6
Ve 7,7
Ve 8,8
Ve 9,9
v_add_f32 v2, 1.0, v2
v_add_f32 v3, 1.0, v3
v_add_f32 v4, 1.0, v4
v_add_f32 v5, 1.0, v5
v_add_f32 v6, 1.0, v6
v_add_f32 v7, 1.0, v7
v_add_f32 v8, 1.0, v8
v_add_f32 v9, 1.0, v9
v_rcp_f32 v2, v2
v_rcp_f32 v3, v3
v_rcp_f32 v4, v4
v_rcp_f32 v5, v5
v_rcp_f32 v6, v6
v_rcp_f32 v7, v7
v_rcp_f32 v8, v8
v_rcp_f32 v9, v9
Vm 58,58,2
Vm 59,59,3
Vm 60,60,4
Vm 61,61,5
Vm 62,62,6
Vm 63,63,7
Vm 64,64,8
Vm 65,65,9
Vc 2,58,59
v_lshlrev_b32_e64 v58, 16, v2
v_and_b32 v59, 0xffff0000, v2
Vc 3,60,61
v_lshlrev_b32_e64 v60, 16, v3
v_and_b32 v61, 0xffff0000, v3
Vc 4,62,63
v_lshlrev_b32_e64 v62, 16, v4
v_and_b32 v63, 0xffff0000, v4
Vc 5,64,65
v_lshlrev_b32_e64 v64, 16, v5
v_and_b32 v65, 0xffff0000, v5
L_f_selskip3:
v_add_u32 v124, 96, v120
v_cmp_eq_u32 vcc, s42, v124
v_cmp_eq_u32 s[6:7], s43, v124
s_nop 3
s_or_b64 s[4:5], vcc, s[6:7]
s_cbranch_scc0 L_f_selskip4
v_cndmask_b32 v96, 0, v80, vcc
v_cndmask_b32 v96, v96, v88, s[6:7]
v_cndmask_b32 v97, 0, v81, vcc
v_cndmask_b32 v97, v97, v89, s[6:7]
v_cndmask_b32 v98, 0, v82, vcc
v_cndmask_b32 v98, v98, v90, s[6:7]
v_cndmask_b32 v99, 0, v83, vcc
v_cndmask_b32 v99, v99, v91, s[6:7]
v_cndmask_b32 v100, 0, v84, vcc
v_cndmask_b32 v100, v100, v92, s[6:7]
v_cndmask_b32 v101, 0, v85, vcc
v_cndmask_b32 v101, v101, v93, s[6:7]
v_cndmask_b32 v102, 0, v86, vcc
v_cndmask_b32 v102, v102, v94, s[6:7]
v_cndmask_b32 v103, 0, v87, vcc
v_cndmask_b32 v103, v103, v95, s[6:7]
v_lshlrev_b32_e64 v66, 16, v30
v_and_b32 v67, 0xffff0000, v30
v_lshlrev_b32_e64 v68, 16, v31
v_and_b32 v69, 0xffff0000, v31
v_lshlrev_b32_e64 v70, 16, v32
v_and_b32 v71, 0xffff0000, v32
v_lshlrev_b32_e64 v72, 16, v33
v_and_b32 v73, 0xffff0000, v33
Vs 66,66,40
Vs 67,67,40
Vs 68,68,40
Vs 69,69,40
Vs 70,70,40
Vs 71,71,40
Vs 72,72,40
Vs 73,73,40
Vc 2,66,67
v_lshlrev_b32_e64 v66, 16, v2
v_and_b32 v67, 0xffff0000, v2
Vc 3,68,69
v_lshlrev_b32_e64 v68, 16, v3
v_and_b32 v69, 0xffff0000, v3
Vc 4,70,71
v_lshlrev_b32_e64 v70, 16, v4
v_and_b32 v71, 0xffff0000, v4
Vc 5,72,73
v_lshlrev_b32_e64 v72, 16, v5
v_and_b32 v73, 0xffff0000, v5
Vm 66,66,41
Vm 67,67,41
Vm 68,68,41
Vm 69,69,41
Vm 70,70,41
Vm 71,71,41
Vm 72,72,41
Vm 73,73,41
Vc 2,66,67
v_lshlrev_b32_e64 v66, 16, v2
v_and_b32 v67, 0xffff0000, v2
Vc 3,68,69
v_lshlrev_b32_e64 v68, 16, v3
v_and_b32 v69, 0xffff0000, v3
Vc 4,70,71
v_lshlrev_b32_e64 v70, 16, v4
v_and_b32 v71, 0xffff0000, v4
Vc 5,72,73
v_lshlrev_b32_e64 v72, 16, v5
v_and_b32 v73, 0xffff0000, v5
Va 66,66,96
Va 67,67,97
Va 68,68,98
Va 69,69,99
Va 70,70,100
Va 71,71,101
Va 72,72,102
Va 73,73,103
Vc 2,66,67
v_lshlrev_b32_e64 v66, 16, v2
v_and_b32 v67, 0xffff0000, v2
Vc 3,68,69
v_lshlrev_b32_e64 v68, 16, v3
v_and_b32 v69, 0xffff0000, v3
Vc 4,70,71
v_lshlrev_b32_e64 v70, 16, v4
v_and_b32 v71, 0xffff0000, v4
Vc 5,72,73
v_lshlrev_b32_e64 v72, 16, v5
v_and_b32 v73, 0xffff0000, v5
v_mul_f32 v2, 0xbfb8aa3b, v66
v_mul_f32 v3, 0xbfb8aa3b, v67
v_mul_f32 v4, 0xbfb8aa3b, v68
v_mul_f32 v5, 0xbfb8aa3b, v69
v_mul_f32 v6, 0xbfb8aa3b, v70
v_mul_f32 v7, 0xbfb8aa3b, v71
v_mul_f32 v8, 0xbfb8aa3b, v72
v_mul_f32 v9, 0xbfb8aa3b, v73
Ve 2,2
Ve 3,3
Ve 4,4
Ve 5,5
Ve 6,6
Ve 7,7
Ve 8,8
Ve 9,9
v_add_f32 v2, 1.0, v2
v_add_f32 v3, 1.0, v3
v_add_f32 v4, 1.0, v4
v_add_f32 v5, 1.0, v5
v_add_f32 v6, 1.0, v6
v_add_f32 v7, 1.0, v7
v_add_f32 v8, 1.0, v8
v_add_f32 v9, 1.0, v9
v_rcp_f32 v2, v2
v_rcp_f32 v3, v3
v_rcp_f32 v4, v4
v_rcp_f32 v5, v5
v_rcp_f32 v6, v6
v_rcp_f32 v7, v7
v_rcp_f32 v8, v8
v_rcp_f32 v9, v9
Vm 66,66,2
Vm 67,67,3
Vm 68,68,4
Vm 69,69,5
Vm 70,70,6
Vm 71,71,7
Vm 72,72,8
Vm 73,73,9
Vc 2,66,67
v_lshlrev_b32_e64 v66, 16, v2
v_and_b32 v67, 0xffff0000, v2
Vc 3,68,69
v_lshlrev_b32_e64 v68, 16, v3
v_and_b32 v69, 0xffff0000, v3
Vc 4,70,71
v_lshlrev_b32_e64 v70, 16, v4
v_and_b32 v71, 0xffff0000, v4
Vc 5,72,73
v_lshlrev_b32_e64 v72, 16, v5
v_and_b32 v73, 0xffff0000, v5
L_f_selskip4:
s_branch L_yCr
L_p4_end:
L_spinAk:
s_mov_b32 s47, 0x400000
L_spinAk_l:
s_sleep 8
buffer_load_dword v30, v31, s[28:31], 0 offen sc1
s_waitcnt vmcnt(0)
v_readfirstlane_b32 s3, v30
s_sub_u32 s47, s47, 1
s_cmp_eq_u32 s47, 0
s_cbranch_scc1 L_spinArk
s_cmp_lt_u32 s3, 256
s_cbranch_scc1 L_spinAk_l
s_branch L_spinArk
L_spinAv:
s_mov_b32 s47, 0x400000
L_spinAv_l:
s_sleep 8
buffer_load_dword v30, v31, s[28:31], 0 offen sc1
s_waitcnt vmcnt(0)
v_readfirstlane_b32 s3, v30
s_sub_u32 s47, s47, 1
s_cmp_eq_u32 s47, 0
s_cbranch_scc1 L_spinArv
s_cmp_lt_u32 s3, 256
s_cbranch_scc1 L_spinAv_l
s_branch L_spinArv
L_spinB:
s_mov_b32 s59, 0x400000
L_spinB_l:
s_sleep 4
buffer_load_dword v12, v1, s[20:23], s6 offen sc1
s_sub_u32 s59, s59, 1
s_cmp_eq_u32 s59, 0
s_cbranch_scc1 L_spinBx
s_waitcnt vmcnt(0)
v_cmp_ne_u32 vcc, 1, v12
s_cbranch_vccnz L_spinB_l
L_spinBx:
s_waitcnt vmcnt(0)
s_branch L_spinBr
L_k2_fb_we:
s_nop 7
s_nop 0
v_max3_f32 v21, v128, v129, v130
v_max3_f32 v21, v21, v131, v132
v_max3_f32 v21, v21, v133, v134
v_max3_f32 v21, v21, v135, v136
v_max3_f32 v21, v21, v137, v138
v_max3_f32 v21, v21, v139, v140
v_max3_f32 v21, v21, v141, v142
v_max_f32 v21, v21, v143
v_mov_b32 v1, v21
s_nop 1
v_permlane16_swap_b32 v1, v21
v_max_f32 v21, v21, v1
v_mov_b32 v1, v21
s_nop 1
v_permlane32_swap_b32 v1, v21
v_max_f32_e64 v21, v21, v1
v_add_f32 v21, 0x41f80000, v21
v_max_f32 v21, 0, v21
Vs 128,128,21
Vs 129,129,21
Vs 130,130,21
Vs 131,131,21
Vs 132,132,21
Vs 133,133,21
Vs 134,134,21
Vs 135,135,21
Vs 136,136,21
Vs 137,137,21
Vs 138,138,21
Vs 139,139,21
Vs 140,140,21
Vs 141,141,21
Vs 142,142,21
Vs 143,143,21
Vs 192,192,21
Vs 193,193,21
Vs 194,194,21
Vs 195,195,21
Vs 196,196,21
Vs 197,197,21
Vs 198,198,21
Vs 199,199,21
Vs 200,200,21
Vs 201,201,21
Vs 202,202,21
Vs 203,203,21
Vs 204,204,21
Vs 205,205,21
Vs 206,206,21
Vs 207,207,21
Vs 32,32,21
Vs 33,33,21
Vs 34,34,21
v_sub_f32_e64 v35, v35, v21
v_exp_f32 v22, -v21
s_nop 0
Vm 48,48,22
Vm 49,49,22
Vm 50,50,22
v_mul_f32_e64 v51, v51, v22
Ar 8,0
Ar 9,1
Ar 10,2
Ar 11,3
Ar 12,4
Ar 13,5
Ar 14,6
Ar 15,7
Vm 8,8,22
Vm 9,9,22
Vm 10,10,22
Vm 11,11,22
Vm 12,12,22
Vm 13,13,22
Vm 14,14,22
Vm 15,15,22
Aw 0,8
Aw 1,9
Aw 2,10
Aw 3,11
Aw 4,12
Aw 5,13
Aw 6,14
Aw 7,15
Ar 8,8
Ar 9,9
Ar 10,10
Ar 11,11
Ar 12,12
Ar 13,13
Ar 14,14
Ar 15,15
Vm 8,8,22
Vm 9,9,22
Vm 10,10,22
Vm 11,11,22
Vm 12,12,22
Vm 13,13,22
Vm 14,14,22
Vm 15,15,22
Aw 8,8
Aw 9,9
Aw 10,10
Aw 11,11
Aw 12,12
Aw 13,13
Aw 14,14
Aw 15,15
Ar 8,16
Ar 9,17
Ar 10,18
Ar 11,19
Ar 12,20
Ar 13,21
Ar 14,22
Ar 15,23
Vm 8,8,22
Vm 9,9,22
Vm 10,10,22
Vm 11,11,22
Vm 12,12,22
Vm 13,13,22
Vm 14,14,22
Vm 15,15,22
Aw 16,8
Aw 17,9
Aw 18,10
Aw 19,11
Aw 20,12
Aw 21,13
Aw 22,14
Aw 23,15
Ar 8,24
Ar 9,25
Ar 10,26
Ar 11,27
Ar 12,28
Ar 13,29
Ar 14,30
Ar 15,31
Vm 8,8,22
Vm 9,9,22
Vm 10,10,22
Vm 11,11,22
Vm 12,12,22
Vm 13,13,22
Vm 14,14,22
Vm 15,15,22
Aw 24,8
Aw 25,9
Aw 26,10
Aw 27,11
Aw 28,12
Aw 29,13
Aw 30,14
Aw 31,15
v_max3_f32 v21, v144, v145, v146
v_max3_f32 v21, v21, v147, v148
v_max3_f32 v21, v21, v149, v150
v_max3_f32 v21, v21, v151, v152
v_max3_f32 v21, v21, v153, v154
v_max3_f32 v21, v21, v155, v156
v_max3_f32 v21, v21, v157, v158
v_max_f32 v21, v21, v159
v_mov_b32 v1, v21
s_nop 1
v_permlane16_swap_b32 v1, v21
v_max_f32 v21, v21, v1
v_mov_b32 v1, v21
s_nop 1
v_permlane32_swap_b32 v1, v21
v_max_f32_e64 v21, v21, v1
v_add_f32 v21, 0x41f80000, v21
v_max_f32 v21, 0, v21
Vs 144,144,21
Vs 145,145,21
Vs 146,146,21
Vs 147,147,21
Vs 148,148,21
Vs 149,149,21
Vs 150,150,21
Vs 151,151,21
Vs 152,152,21
Vs 153,153,21
Vs 154,154,21
Vs 155,155,21
Vs 156,156,21
Vs 157,157,21
Vs 158,158,21
Vs 159,159,21
Vs 208,208,21
Vs 209,209,21
Vs 210,210,21
Vs 211,211,21
Vs 212,212,21
Vs 213,213,21
Vs 214,214,21
Vs 215,215,21
Vs 216,216,21
Vs 217,217,21
Vs 218,218,21
Vs 219,219,21
Vs 220,220,21
Vs 221,221,21
Vs 222,222,21
Vs 223,223,21
Vs 36,36,21
Vs 37,37,21
Vs 38,38,21
v_sub_f32_e64 v39, v39, v21
v_exp_f32 v22, -v21
s_nop 0
Vm 52,52,22
Vm 53,53,22
Vm 54,54,22
v_mul_f32_e64 v55, v55, v22
Ar 8,32
Ar 9,33
Ar 10,34
Ar 11,35
Ar 12,36
Ar 13,37
Ar 14,38
Ar 15,39
Vm 8,8,22
Vm 9,9,22
Vm 10,10,22
Vm 11,11,22
Vm 12,12,22
Vm 13,13,22
Vm 14,14,22
Vm 15,15,22
Aw 32,8
Aw 33,9
Aw 34,10
Aw 35,11
Aw 36,12
Aw 37,13
Aw 38,14
Aw 39,15
Ar 8,40
Ar 9,41
Ar 10,42
Ar 11,43
Ar 12,44
Ar 13,45
Ar 14,46
Ar 15,47
Vm 8,8,22
Vm 9,9,22
Vm 10,10,22
Vm 11,11,22
Vm 12,12,22
Vm 13,13,22
Vm 14,14,22
Vm 15,15,22
Aw 40,8
Aw 41,9
Aw 42,10
Aw 43,11
Aw 44,12
Aw 45,13
Aw 46,14
Aw 47,15
Ar 8,48
Ar 9,49
Ar 10,50
Ar 11,51
Ar 12,52
Ar 13,53
Ar 14,54
Ar 15,55
Vm 8,8,22
Vm 9,9,22
Vm 10,10,22
Vm 11,11,22
Vm 12,12,22
Vm 13,13,22
Vm 14,14,22
Vm 15,15,22
Aw 48,8
Aw 49,9
Aw 50,10
Aw 51,11
Aw 52,12
Aw 53,13
Aw 54,14
Aw 55,15
Ar 8,56
Ar 9,57
Ar 10,58
Ar 11,59
Ar 12,60
Ar 13,61
Ar 14,62
Ar 15,63
Vm 8,8,22
Vm 9,9,22
Vm 10,10,22
Vm 11,11,22
Vm 12,12,22
Vm 13,13,22
Vm 14,14,22
Vm 15,15,22
Aw 56,8
Aw 57,9
Aw 58,10
Aw 59,11
Aw 60,12
Aw 61,13
Aw 62,14
Aw 63,15
v_max3_f32 v21, v160, v161, v162
v_max3_f32 v21, v21, v163, v164
v_max3_f32 v21, v21, v165, v166
v_max3_f32 v21, v21, v167, v168
v_max3_f32 v21, v21, v169, v170
v_max3_f32 v21, v21, v171, v172
v_max3_f32 v21, v21, v173, v174
v_max_f32 v21, v21, v175
v_mov_b32 v1, v21
s_nop 1
v_permlane16_swap_b32 v1, v21
v_max_f32 v21, v21, v1
v_mov_b32 v1, v21
s_nop 1
v_permlane32_swap_b32 v1, v21
v_max_f32_e64 v21, v21, v1
v_add_f32 v21, 0x41f80000, v21
v_max_f32 v21, 0, v21
Vs 160,160,21
Vs 161,161,21
Vs 162,162,21
Vs 163,163,21
Vs 164,164,21
Vs 165,165,21
Vs 166,166,21
Vs 167,167,21
Vs 168,168,21
Vs 169,169,21
Vs 170,170,21
Vs 171,171,21
Vs 172,172,21
Vs 173,173,21
Vs 174,174,21
Vs 175,175,21
Vs 224,224,21
Vs 225,225,21
Vs 226,226,21
Vs 227,227,21
Vs 228,228,21
Vs 229,229,21
Vs 230,230,21
Vs 231,231,21
Vs 232,232,21
Vs 233,233,21
Vs 234,234,21
Vs 235,235,21
Vs 236,236,21
Vs 237,237,21
Vs 238,238,21
Vs 239,239,21
Vs 40,40,21
Vs 41,41,21
Vs 42,42,21
v_sub_f32_e64 v43, v43, v21
v_exp_f32 v22, -v21
s_nop 0
Vm 56,56,22
Vm 57,57,22
Vm 58,58,22
v_mul_f32_e64 v59, v59, v22
Ar 8,64
Ar 9,65
Ar 10,66
Ar 11,67
Ar 12,68
Ar 13,69
Ar 14,70
Ar 15,71
Vm 8,8,22
Vm 9,9,22
Vm 10,10,22
Vm 11,11,22
Vm 12,12,22
Vm 13,13,22
Vm 14,14,22
Vm 15,15,22
Aw 64,8
Aw 65,9
Aw 66,10
Aw 67,11
Aw 68,12
Aw 69,13
Aw 70,14
Aw 71,15
Ar 8,72
Ar 9,73
Ar 10,74
Ar 11,75
Ar 12,76
Ar 13,77
Ar 14,78
Ar 15,79
Vm 8,8,22
Vm 9,9,22
Vm 10,10,22
Vm 11,11,22
Vm 12,12,22
Vm 13,13,22
Vm 14,14,22
Vm 15,15,22
Aw 72,8
Aw 73,9
Aw 74,10
Aw 75,11
Aw 76,12
Aw 77,13
Aw 78,14
Aw 79,15
Ar 8,80
Ar 9,81
Ar 10,82
Ar 11,83
Ar 12,84
Ar 13,85
Ar 14,86
Ar 15,87
Vm 8,8,22
Vm 9,9,22
Vm 10,10,22
Vm 11,11,22
Vm 12,12,22
Vm 13,13,22
Vm 14,14,22
Vm 15,15,22
Aw 80,8
Aw 81,9
Aw 82,10
Aw 83,11
Aw 84,12
Aw 85,13
Aw 86,14
Aw 87,15
Ar 8,88
Ar 9,89
Ar 10,90
Ar 11,91
Ar 12,92
Ar 13,93
Ar 14,94
Ar 15,95
Vm 8,8,22
Vm 9,9,22
Vm 10,10,22
Vm 11,11,22
Vm 12,12,22
Vm 13,13,22
Vm 14,14,22
Vm 15,15,22
Aw 88,8
Aw 89,9
Aw 90,10
Aw 91,11
Aw 92,12
Aw 93,13
Aw 94,14
Aw 95,15
v_max3_f32 v21, v176, v177, v178
v_max3_f32 v21, v21, v179, v180
v_max3_f32 v21, v21, v181, v182
v_max3_f32 v21, v21, v183, v184
v_max3_f32 v21, v21, v185, v186
v_max3_f32 v21, v21, v187, v188
v_max3_f32 v21, v21, v189, v190
v_max_f32 v21, v21, v191
v_mov_b32 v1, v21
s_nop 1
v_permlane16_swap_b32 v1, v21
v_max_f32 v21, v21, v1
v_mov_b32 v1, v21
s_nop 1
v_permlane32_swap_b32 v1, v21
v_max_f32_e64 v21, v21, v1
v_add_f32 v21, 0x41f80000, v21
v_max_f32 v21, 0, v21
Vs 176,176,21
Vs 177,177,21
Vs 178,178,21
Vs 179,179,21
Vs 180,180,21
Vs 181,181,21
Vs 182,182,21
Vs 183,183,21
Vs 184,184,21
Vs 185,185,21
Vs 186,186,21
Vs 187,187,21
Vs 188,188,21
Vs 189,189,21
Vs 190,190,21
Vs 191,191,21
Vs 240,240,21
Vs 241,241,21
Vs 242,242,21
Vs 243,243,21
Vs 244,244,21
Vs 245,245,21
Vs 246,246,21
Vs 247,247,21
Vs 248,248,21
Vs 249,249,21
Vs 250,250,21
Vs 251,251,21
Vs 252,252,21
Vs 253,253,21
Vs 254,254,21
Vs 255,255,21
Vs 44,44,21
Vs 45,45,21
Vs 46,46,21
v_sub_f32_e64 v47, v47, v21
v_exp_f32 v22, -v21
s_nop 0
Vm 60,60,22
Vm 61,61,22
Vm 62,62,22
v_mul_f32_e64 v63, v63, v22
Ar 8,96
Ar 9,97
Ar 10,98
Ar 11,99
Ar 12,100
Ar 13,101
Ar 14,102
Ar 15,103
Vm 8,8,22
Vm 9,9,22
Vm 10,10,22
Vm 11,11,22
Vm 12,12,22
Vm 13,13,22
Vm 14,14,22
Vm 15,15,22
Aw 96,8
Aw 97,9
Aw 98,10
Aw 99,11
Aw 100,12
Aw 101,13
Aw 102,14
Aw 103,15
Ar 8,104
Ar 9,105
Ar 10,106
Ar 11,107
Ar 12,108
Ar 13,109
Ar 14,110
Ar 15,111
Vm 8,8,22
Vm 9,9,22
Vm 10,10,22
Vm 11,11,22
Vm 12,12,22
Vm 13,13,22
Vm 14,14,22
Vm 15,15,22
Aw 104,8
Aw 105,9
Aw 106,10
Aw 107,11
Aw 108,12
Aw 109,13
Aw 110,14
Aw 111,15
Ar 8,112
Ar 9,113
Ar 10,114
Ar 11,115
Ar 12,116
Ar 13,117
Ar 14,118
Ar 15,119
Vm 8,8,22
Vm 9,9,22
Vm 10,10,22
Vm 11,11,22
Vm 12,12,22
Vm 13,13,22
Vm 14,14,22
Vm 15,15,22
Aw 112,8
Aw 113,9
Aw 114,10
Aw 115,11
Aw 116,12
Aw 117,13
Aw 118,14
Aw 119,15
Ar 8,120
Ar 9,121
Ar 10,122
Ar 11,123
Ar 12,124
Ar 13,125
Ar 14,126
Ar 15,127
Vm 8,8,22
Vm 9,9,22
Vm 10,10,22
Vm 11,11,22
Vm 12,12,22
Vm 13,13,22
Vm 14,14,22
Vm 15,15,22
Aw 120,8
Aw 121,9
Aw 122,10
Aw 123,11
Aw 124,12
Aw 125,13
Aw 126,14
Aw 127,15
Ve 8,128
Ve 9,129
s_nop 0
Vc 64,8,9
Ve 8,130
Ve 9,131
s_nop 0
Vc 65,8,9
Ve 8,144
Ve 9,145
s_nop 0
Vc 72,8,9
Ve 8,146
Ve 9,147
s_nop 0
Vc 73,8,9
Ve 8,160
Ve 9,161
s_nop 0
Vc 80,8,9
Ve 8,162
Ve 9,163
s_nop 0
Vc 81,8,9
Ve 8,176
Ve 9,177
s_nop 0
Vc 88,8,9
Ve 8,178
Ve 9,179
s_nop 0
Vc 89,8,9
Ve 8,132
Ve 9,133
s_nop 0
Vc 66,8,9
Ve 8,134
Ve 9,135
s_nop 0
Vc 67,8,9
Ve 8,148
Ve 9,149
s_nop 0
Vc 74,8,9
Ve 8,150
Ve 9,151
s_nop 0
Vc 75,8,9
Ve 8,164
Ve 9,165
s_nop 0
Vc 82,8,9
Ve 8,166
Ve 9,167
s_nop 0
Vc 83,8,9
Ve 8,180
Ve 9,181
s_nop 0
Vc 90,8,9
Ve 8,182
Ve 9,183
s_nop 0
Vc 91,8,9
Ve 8,136
Ve 9,137
s_nop 0
Vc 68,8,9
Ve 8,138
Ve 9,139
s_nop 0
Vc 69,8,9
Ve 8,152
Ve 9,153
s_nop 0
Vc 76,8,9
Ve 8,154
Ve 9,155
s_nop 0
Vc 77,8,9
Ve 8,168
Ve 9,169
s_nop 0
Vc 84,8,9
Ve 8,170
Ve 9,171
s_nop 0
Vc 85,8,9
Ve 8,184
Ve 9,185
s_nop 0
Vc 92,8,9
Ve 8,186
Ve 9,187
s_nop 0
Vc 93,8,9
Ve 8,140
Ve 9,141
s_nop 0
Vc 70,8,9
Ve 8,142
Ve 9,143
s_nop 0
Vc 71,8,9
Ve 8,156
Ve 9,157
s_nop 0
Vc 78,8,9
Ve 8,158
Ve 9,159
s_nop 0
Vc 79,8,9
Ve 8,172
Ve 9,173
s_nop 0
Vc 86,8,9
Ve 8,174
Ve 9,175
s_nop 0
Vc 87,8,9
Ve 8,188
Ve 9,189
s_nop 0
Vc 94,8,9
Ve 8,190
Ve 9,191
s_nop 0
Vc 95,8,9
s_nop 1
s_branch L_k2_fbr_we
L_k2_mk_we:
s_nop 7
s_add_u32 s3, s37, 1
s_lshl_b32 s3, s3, 6
v_subrev_u32 v1, s3, v6
v_cmp_gt_i32 s[56:57], -16, v1
v_cmp_gt_i32 s[58:59], -15, v1
v_cmp_gt_i32 s[60:61], -14, v1
v_cmp_gt_i32 s[62:63], -13, v1
v_cndmask_b32 v240, v240, v20, s[56:57]
v_cndmask_b32 v241, v241, v20, s[58:59]
v_cndmask_b32 v242, v242, v20, s[60:61]
v_cndmask_b32 v243, v243, v20, s[62:63]
v_cmp_gt_i32 s[56:57], 0, v1
v_cmp_gt_i32 s[58:59], 1, v1
v_cmp_gt_i32 s[60:61], 2, v1
v_cmp_gt_i32 s[62:63], 3, v1
v_cndmask_b32 v224, v224, v20, s[56:57]
v_cndmask_b32 v225, v225, v20, s[58:59]
v_cndmask_b32 v226, v226, v20, s[60:61]
v_cndmask_b32 v227, v227, v20, s[62:63]
v_cndmask_b32 v244, v244, v20, s[56:57]
v_cndmask_b32 v245, v245, v20, s[58:59]
v_cndmask_b32 v246, v246, v20, s[60:61]
v_cndmask_b32 v247, v247, v20, s[62:63]
v_cmp_gt_i32 s[56:57], 16, v1
v_cmp_gt_i32 s[58:59], 17, v1
v_cmp_gt_i32 s[60:61], 18, v1
v_cmp_gt_i32 s[62:63], 19, v1
v_cndmask_b32 v228, v228, v20, s[56:57]
v_cndmask_b32 v229, v229, v20, s[58:59]
v_cndmask_b32 v230, v230, v20, s[60:61]
v_cndmask_b32 v231, v231, v20, s[62:63]
v_cndmask_b32 v248, v248, v20, s[56:57]
v_cndmask_b32 v249, v249, v20, s[58:59]
v_cndmask_b32 v250, v250, v20, s[60:61]
v_cndmask_b32 v251, v251, v20, s[62:63]
v_cmp_gt_i32 s[56:57], 32, v1
v_cmp_gt_i32 s[58:59], 33, v1
v_cmp_gt_i32 s[60:61], 34, v1
v_cmp_gt_i32 s[62:63], 35, v1
v_cndmask_b32 v232, v232, v20, s[56:57]
v_cndmask_b32 v233, v233, v20, s[58:59]
v_cndmask_b32 v234, v234, v20, s[60:61]
v_cndmask_b32 v235, v235, v20, s[62:63]
v_cndmask_b32 v252, v252, v20, s[56:57]
v_cndmask_b32 v253, v253, v20, s[58:59]
v_cndmask_b32 v254, v254, v20, s[60:61]
v_cndmask_b32 v255, v255, v20, s[62:63]
v_cmp_gt_i32 s[56:57], 48, v1
v_cmp_gt_i32 s[58:59], 49, v1
v_cmp_gt_i32 s[60:61], 50, v1
v_cmp_gt_i32 s[62:63], 51, v1
v_cndmask_b32 v236, v236, v20, s[56:57]
v_cndmask_b32 v237, v237, v20, s[58:59]
v_cndmask_b32 v238, v238, v20, s[60:61]
v_cndmask_b32 v239, v239, v20, s[62:63]
s_nop 1
s_branch L_k2_mkr_we
L_k2_fb_wo:
s_nop 7
s_nop 0
v_max3_f32 v21, v192, v193, v194
v_max3_f32 v21, v21, v195, v196
v_max3_f32 v21, v21, v197, v198
v_max3_f32 v21, v21, v199, v200
v_max3_f32 v21, v21, v201, v202
v_max3_f32 v21, v21, v203, v204
v_max3_f32 v21, v21, v205, v206
v_max_f32 v21, v21, v207
v_mov_b32 v1, v21
s_nop 1
v_permlane16_swap_b32 v1, v21
v_max_f32 v21, v21, v1
v_mov_b32 v1, v21
s_nop 1
v_permlane32_swap_b32 v1, v21
v_max_f32_e64 v21, v21, v1
v_add_f32 v21, 0x41f80000, v21
v_max_f32 v21, 0, v21
Vs 192,192,21
Vs 193,193,21
Vs 194,194,21
Vs 195,195,21
Vs 196,196,21
Vs 197,197,21
Vs 198,198,21
Vs 199,199,21
Vs 200,200,21
Vs 201,201,21
Vs 202,202,21
Vs 203,203,21
Vs 204,204,21
Vs 205,205,21
Vs 206,206,21
Vs 207,207,21
Vs 128,128,21
Vs 129,129,21
Vs 130,130,21
Vs 131,131,21
Vs 132,132,21
Vs 133,133,21
Vs 134,134,21
Vs 135,135,21
Vs 136,136,21
Vs 137,137,21
Vs 138,138,21
Vs 139,139,21
Vs 140,140,21
Vs 141,141,21
Vs 142,142,21
Vs 143,143,21
Vs 32,32,21
Vs 33,33,21
Vs 34,34,21
v_sub_f32_e64 v35, v35, v21
v_exp_f32 v22, -v21
s_nop 0
Vm 48,48,22
Vm 49,49,22
Vm 50,50,22
v_mul_f32_e64 v51, v51, v22
Ar 8,0
Ar 9,1
Ar 10,2
Ar 11,3
Ar 12,4
Ar 13,5
Ar 14,6
Ar 15,7
Vm 8,8,22
Vm 9,9,22
Vm 10,10,22
Vm 11,11,22
Vm 12,12,22
Vm 13,13,22
Vm 14,14,22
Vm 15,15,22
Aw 0,8
Aw 1,9
Aw 2,10
Aw 3,11
Aw 4,12
Aw 5,13
Aw 6,14
Aw 7,15
Ar 8,8
Ar 9,9
Ar 10,10
Ar 11,11
Ar 12,12
Ar 13,13
Ar 14,14
Ar 15,15
Vm 8,8,22
Vm 9,9,22
Vm 10,10,22
Vm 11,11,22
Vm 12,12,22
Vm 13,13,22
Vm 14,14,22
Vm 15,15,22
Aw 8,8
Aw 9,9
Aw 10,10
Aw 11,11
Aw 12,12
Aw 13,13
Aw 14,14
Aw 15,15
Ar 8,16
Ar 9,17
Ar 10,18
Ar 11,19
Ar 12,20
Ar 13,21
Ar 14,22
Ar 15,23
Vm 8,8,22
Vm 9,9,22
Vm 10,10,22
Vm 11,11,22
Vm 12,12,22
Vm 13,13,22
Vm 14,14,22
Vm 15,15,22
Aw 16,8
Aw 17,9
Aw 18,10
Aw 19,11
Aw 20,12
Aw 21,13
Aw 22,14
Aw 23,15
Ar 8,24
Ar 9,25
Ar 10,26
Ar 11,27
Ar 12,28
Ar 13,29
Ar 14,30
Ar 15,31
Vm 8,8,22
Vm 9,9,22
Vm 10,10,22
Vm 11,11,22
Vm 12,12,22
Vm 13,13,22
Vm 14,14,22
Vm 15,15,22
Aw 24,8
Aw 25,9
Aw 26,10
Aw 27,11
Aw 28,12
Aw 29,13
Aw 30,14
Aw 31,15
v_max3_f32 v21, v208, v209, v210
v_max3_f32 v21, v21, v211, v212
v_max3_f32 v21, v21, v213, v214
v_max3_f32 v21, v21, v215, v216
v_max3_f32 v21, v21, v217, v218
v_max3_f32 v21, v21, v219, v220
v_max3_f32 v21, v21, v221, v222
v_max_f32 v21, v21, v223
v_mov_b32 v1, v21
s_nop 1
v_permlane16_swap_b32 v1, v21
v_max_f32 v21, v21, v1
v_mov_b32 v1, v21
s_nop 1
v_permlane32_swap_b32 v1, v21
v_max_f32_e64 v21, v21, v1
v_add_f32 v21, 0x41f80000, v21
v_max_f32 v21, 0, v21
Vs 208,208,21
Vs 209,209,21
Vs 210,210,21
Vs 211,211,21
Vs 212,212,21
Vs 213,213,21
Vs 214,214,21
Vs 215,215,21
Vs 216,216,21
Vs 217,217,21
Vs 218,218,21
Vs 219,219,21
Vs 220,220,21
Vs 221,221,21
Vs 222,222,21
Vs 223,223,21
Vs 144,144,21
Vs 145,145,21
Vs 146,146,21
Vs 147,147,21
Vs 148,148,21
Vs 149,149,21
Vs 150,150,21
Vs 151,151,21
Vs 152,152,21
Vs 153,153,21
Vs 154,154,21
Vs 155,155,21
Vs 156,156,21
Vs 157,157,21
Vs 158,158,21
Vs 159,159,21
Vs 36,36,21
Vs 37,37,21
Vs 38,38,21
v_sub_f32_e64 v39, v39, v21
v_exp_f32 v22, -v21
s_nop 0
Vm 52,52,22
Vm 53,53,22
Vm 54,54,22
v_mul_f32_e64 v55, v55, v22
Ar 8,32
Ar 9,33
Ar 10,34
Ar 11,35
Ar 12,36
Ar 13,37
Ar 14,38
Ar 15,39
Vm 8,8,22
Vm 9,9,22
Vm 10,10,22
Vm 11,11,22
Vm 12,12,22
Vm 13,13,22
Vm 14,14,22
Vm 15,15,22
Aw 32,8
Aw 33,9
Aw 34,10
Aw 35,11
Aw 36,12
Aw 37,13
Aw 38,14
Aw 39,15
Ar 8,40
Ar 9,41
Ar 10,42
Ar 11,43
Ar 12,44
Ar 13,45
Ar 14,46
Ar 15,47
Vm 8,8,22
Vm 9,9,22
Vm 10,10,22
Vm 11,11,22
Vm 12,12,22
Vm 13,13,22
Vm 14,14,22
Vm 15,15,22
Aw 40,8
Aw 41,9
Aw 42,10
Aw 43,11
Aw 44,12
Aw 45,13
Aw 46,14
Aw 47,15
Ar 8,48
Ar 9,49
Ar 10,50
Ar 11,51
Ar 12,52
Ar 13,53
Ar 14,54
Ar 15,55
Vm 8,8,22
Vm 9,9,22
Vm 10,10,22
Vm 11,11,22
Vm 12,12,22
Vm 13,13,22
Vm 14,14,22
Vm 15,15,22
Aw 48,8
Aw 49,9
Aw 50,10
Aw 51,11
Aw 52,12
Aw 53,13
Aw 54,14
Aw 55,15
Ar 8,56
Ar 9,57
Ar 10,58
Ar 11,59
Ar 12,60
Ar 13,61
Ar 14,62
Ar 15,63
Vm 8,8,22
Vm 9,9,22
Vm 10,10,22
Vm 11,11,22
Vm 12,12,22
Vm 13,13,22
Vm 14,14,22
Vm 15,15,22
Aw 56,8
Aw 57,9
Aw 58,10
Aw 59,11
Aw 60,12
Aw 61,13
Aw 62,14
Aw 63,15
v_max3_f32 v21, v224, v225, v226
v_max3_f32 v21, v21, v227, v228
v_max3_f32 v21, v21, v229, v230
v_max3_f32 v21, v21, v231, v232
v_max3_f32 v21, v21, v233, v234
v_max3_f32 v21, v21, v235, v236
v_max3_f32 v21, v21, v237, v238
v_max_f32 v21, v21, v239
v_mov_b32 v1, v21
s_nop 1
v_permlane16_swap_b32 v1, v21
v_max_f32 v21, v21, v1
v_mov_b32 v1, v21
s_nop 1
v_permlane32_swap_b32 v1, v21
v_max_f32_e64 v21, v21, v1
v_add_f32 v21, 0x41f80000, v21
v_max_f32 v21, 0, v21
Vs 224,224,21
Vs 225,225,21
Vs 226,226,21
Vs 227,227,21
Vs 228,228,21
Vs 229,229,21
Vs 230,230,21
Vs 231,231,21
Vs 232,232,21
Vs 233,233,21
Vs 234,234,21
Vs 235,235,21
Vs 236,236,21
Vs 237,237,21
Vs 238,238,21
Vs 239,239,21
Vs 160,160,21
Vs 161,161,21
Vs 162,162,21
Vs 163,163,21
Vs 164,164,21
Vs 165,165,21
Vs 166,166,21
Vs 167,167,21
Vs 168,168,21
Vs 169,169,21
Vs 170,170,21
Vs 171,171,21
Vs 172,172,21
Vs 173,173,21
Vs 174,174,21
Vs 175,175,21
Vs 40,40,21
Vs 41,41,21
Vs 42,42,21
v_sub_f32_e64 v43, v43, v21
v_exp_f32 v22, -v21
s_nop 0
Vm 56,56,22
Vm 57,57,22
Vm 58,58,22
v_mul_f32_e64 v59, v59, v22
Ar 8,64
Ar 9,65
Ar 10,66
Ar 11,67
Ar 12,68
Ar 13,69
Ar 14,70
Ar 15,71
Vm 8,8,22
Vm 9,9,22
Vm 10,10,22
Vm 11,11,22
Vm 12,12,22
Vm 13,13,22
Vm 14,14,22
Vm 15,15,22
Aw 64,8
Aw 65,9
Aw 66,10
Aw 67,11
Aw 68,12
Aw 69,13
Aw 70,14
Aw 71,15
Ar 8,72
Ar 9,73
Ar 10,74
Ar 11,75
Ar 12,76
Ar 13,77
Ar 14,78
Ar 15,79
Vm 8,8,22
Vm 9,9,22
Vm 10,10,22
Vm 11,11,22
Vm 12,12,22
Vm 13,13,22
Vm 14,14,22
Vm 15,15,22
Aw 72,8
Aw 73,9
Aw 74,10
Aw 75,11
Aw 76,12
Aw 77,13
Aw 78,14
Aw 79,15
Ar 8,80
Ar 9,81
Ar 10,82
Ar 11,83
Ar 12,84
Ar 13,85
Ar 14,86
Ar 15,87
Vm 8,8,22
Vm 9,9,22
Vm 10,10,22
Vm 11,11,22
Vm 12,12,22
Vm 13,13,22
Vm 14,14,22
Vm 15,15,22
Aw 80,8
Aw 81,9
Aw 82,10
Aw 83,11
Aw 84,12
Aw 85,13
Aw 86,14
Aw 87,15
Ar 8,88
Ar 9,89
Ar 10,90
Ar 11,91
Ar 12,92
Ar 13,93
Ar 14,94
Ar 15,95
Vm 8,8,22
Vm 9,9,22
Vm 10,10,22
Vm 11,11,22
Vm 12,12,22
Vm 13,13,22
Vm 14,14,22
Vm 15,15,22
Aw 88,8
Aw 89,9
Aw 90,10
Aw 91,11
Aw 92,12
Aw 93,13
Aw 94,14
Aw 95,15
v_max3_f32 v21, v240, v241, v242
v_max3_f32 v21, v21, v243, v244
v_max3_f32 v21, v21, v245, v246
v_max3_f32 v21, v21, v247, v248
v_max3_f32 v21, v21, v249, v250
v_max3_f32 v21, v21, v251, v252
v_max3_f32 v21, v21, v253, v254
v_max_f32 v21, v21, v255
v_mov_b32 v1, v21
s_nop 1
v_permlane16_swap_b32 v1, v21
v_max_f32 v21, v21, v1
v_mov_b32 v1, v21
s_nop 1
v_permlane32_swap_b32 v1, v21
v_max_f32_e64 v21, v21, v1
v_add_f32 v21, 0x41f80000, v21
v_max_f32 v21, 0, v21
Vs 240,240,21
Vs 241,241,21
Vs 242,242,21
Vs 243,243,21
Vs 244,244,21
Vs 245,245,21
Vs 246,246,21
Vs 247,247,21
Vs 248,248,21
Vs 249,249,21
Vs 250,250,21
Vs 251,251,21
Vs 252,252,21
Vs 253,253,21
Vs 254,254,21
Vs 255,255,21
Vs 176,176,21
Vs 177,177,21
Vs 178,178,21
Vs 179,179,21
Vs 180,180,21
Vs 181,181,21
Vs 182,182,21
Vs 183,183,21
Vs 184,184,21
Vs 185,185,21
Vs 186,186,21
Vs 187,187,21
Vs 188,188,21
Vs 189,189,21
Vs 190,190,21
Vs 191,191,21
Vs 44,44,21
Vs 45,45,21
Vs 46,46,21
v_sub_f32_e64 v47, v47, v21
v_exp_f32 v22, -v21
s_nop 0
Vm 60,60,22
Vm 61,61,22
Vm 62,62,22
v_mul_f32_e64 v63, v63, v22
Ar 8,96
Ar 9,97
Ar 10,98
Ar 11,99
Ar 12,100
Ar 13,101
Ar 14,102
Ar 15,103
Vm 8,8,22
Vm 9,9,22
Vm 10,10,22
Vm 11,11,22
Vm 12,12,22
Vm 13,13,22
Vm 14,14,22
Vm 15,15,22
Aw 96,8
Aw 97,9
Aw 98,10
Aw 99,11
Aw 100,12
Aw 101,13
Aw 102,14
Aw 103,15
Ar 8,104
Ar 9,105
Ar 10,106
Ar 11,107
Ar 12,108
Ar 13,109
Ar 14,110
Ar 15,111
Vm 8,8,22
Vm 9,9,22
Vm 10,10,22
Vm 11,11,22
Vm 12,12,22
Vm 13,13,22
Vm 14,14,22
Vm 15,15,22
Aw 104,8
Aw 105,9
Aw 106,10
Aw 107,11
Aw 108,12
Aw 109,13
Aw 110,14
Aw 111,15
Ar 8,112
Ar 9,113
Ar 10,114
Ar 11,115
Ar 12,116
Ar 13,117
Ar 14,118
Ar 15,119
Vm 8,8,22
Vm 9,9,22
Vm 10,10,22
Vm 11,11,22
Vm 12,12,22
Vm 13,13,22
Vm 14,14,22
Vm 15,15,22
Aw 112,8
Aw 113,9
Aw 114,10
Aw 115,11
Aw 116,12
Aw 117,13
Aw 118,14
Aw 119,15
Ar 8,120
Ar 9,121
Ar 10,122
Ar 11,123
Ar 12,124
Ar 13,125
Ar 14,126
Ar 15,127
Vm 8,8,22
Vm 9,9,22
Vm 10,10,22
Vm 11,11,22
Vm 12,12,22
Vm 13,13,22
Vm 14,14,22
Vm 15,15,22
Aw 120,8
Aw 121,9
Aw 122,10
Aw 123,11
Aw 124,12
Aw 125,13
Aw 126,14
Aw 127,15
Ve 8,192
Ve 9,193
s_nop 0
Vc 96,8,9
Ve 8,194
Ve 9,195
s_nop 0
Vc 97,8,9
Ve 8,208
Ve 9,209
s_nop 0
Vc 104,8,9
Ve 8,210
Ve 9,211
s_nop 0
Vc 105,8,9
Ve 8,224
Ve 9,225
s_nop 0
Vc 112,8,9
Ve 8,226
Ve 9,227
s_nop 0
Vc 113,8,9
Ve 8,240
Ve 9,241
s_nop 0
Vc 120,8,9
Ve 8,242
Ve 9,243
s_nop 0
Vc 121,8,9
Ve 8,196
Ve 9,197
s_nop 0
Vc 98,8,9
Ve 8,198
Ve 9,199
s_nop 0
Vc 99,8,9
Ve 8,212
Ve 9,213
s_nop 0
Vc 106,8,9
Ve 8,214
Ve 9,215
s_nop 0
Vc 107,8,9
Ve 8,228
Ve 9,229
s_nop 0
Vc 114,8,9
Ve 8,230
Ve 9,231
s_nop 0
Vc 115,8,9
Ve 8,244
Ve 9,245
s_nop 0
Vc 122,8,9
Ve 8,246
Ve 9,247
s_nop 0
Vc 123,8,9
Ve 8,200
Ve 9,201
s_nop 0
Vc 100,8,9
Ve 8,202
Ve 9,203
s_nop 0
Vc 101,8,9
Ve 8,216
Ve 9,217
s_nop 0
Vc 108,8,9
Ve 8,218
Ve 9,219
s_nop 0
Vc 109,8,9
Ve 8,232
Ve 9,233
s_nop 0
Vc 116,8,9
Ve 8,234
Ve 9,235
s_nop 0
Vc 117,8,9
Ve 8,248
Ve 9,249
s_nop 0
Vc 124,8,9
Ve 8,250
Ve 9,251
s_nop 0
Vc 125,8,9
Ve 8,204
Ve 9,205
s_nop 0
Vc 102,8,9
Ve 8,206
Ve 9,207
s_nop 0
Vc 103,8,9
Ve 8,220
Ve 9,221
s_nop 0
Vc 110,8,9
Ve 8,222
Ve 9,223
s_nop 0
Vc 111,8,9
Ve 8,236
Ve 9,237
s_nop 0
Vc 118,8,9
Ve 8,238
Ve 9,239
s_nop 0
Vc 119,8,9
Ve 8,252
Ve 9,253
s_nop 0
Vc 126,8,9
Ve 8,254
Ve 9,255
s_nop 0
Vc 127,8,9
s_nop 1
s_branch L_k2_fbr_wo
L_k2_mk_wo:
s_nop 7
s_add_u32 s3, s37, 1
s_lshl_b32 s3, s3, 6
v_subrev_u32 v1, s3, v6
v_cmp_gt_i32 s[56:57], -16, v1
v_cmp_gt_i32 s[58:59], -15, v1
v_cmp_gt_i32 s[60:61], -14, v1
v_cmp_gt_i32 s[62:63], -13, v1
v_cndmask_b32 v176, v176, v20, s[56:57]
v_cndmask_b32 v177, v177, v20, s[58:59]
v_cndmask_b32 v178, v178, v20, s[60:61]
v_cndmask_b32 v179, v179, v20, s[62:63]
v_cmp_gt_i32 s[56:57], 0, v1
v_cmp_gt_i32 s[58:59], 1, v1
v_cmp_gt_i32 s[60:61], 2, v1
v_cmp_gt_i32 s[62:63], 3, v1
v_cndmask_b32 v160, v160, v20, s[56:57]
v_cndmask_b32 v161, v161, v20, s[58:59]
v_cndmask_b32 v162, v162, v20, s[60:61]
v_cndmask_b32 v163, v163, v20, s[62:63]
v_cndmask_b32 v180, v180, v20, s[56:57]
v_cndmask_b32 v181, v181, v20, s[58:59]
v_cndmask_b32 v182, v182, v20, s[60:61]
v_cndmask_b32 v183, v183, v20, s[62:63]
v_cmp_gt_i32 s[56:57], 16, v1
v_cmp_gt_i32 s[58:59], 17, v1
v_cmp_gt_i32 s[60:61], 18, v1
v_cmp_gt_i32 s[62:63], 19, v1
v_cndmask_b32 v164, v164, v20, s[56:57]
v_cndmask_b32 v165, v165, v20, s[58:59]
v_cndmask_b32 v166, v166, v20, s[60:61]
v_cndmask_b32 v167, v167, v20, s[62:63]
v_cndmask_b32 v184, v184, v20, s[56:57]
v_cndmask_b32 v185, v185, v20, s[58:59]
v_cndmask_b32 v186, v186, v20, s[60:61]
v_cndmask_b32 v187, v187, v20, s[62:63]
v_cmp_gt_i32 s[56:57], 32, v1
v_cmp_gt_i32 s[58:59], 33, v1
v_cmp_gt_i32 s[60:61], 34, v1
v_cmp_gt_i32 s[62:63], 35, v1
v_cndmask_b32 v168, v168, v20, s[56:57]
v_cndmask_b32 v169, v169, v20, s[58:59]
v_cndmask_b32 v170, v170, v20, s[60:61]
v_cndmask_b32 v171, v171, v20, s[62:63]
v_cndmask_b32 v188, v188, v20, s[56:57]
v_cndmask_b32 v189, v189, v20, s[58:59]
v_cndmask_b32 v190, v190, v20, s[60:61]
v_cndmask_b32 v191, v191, v20, s[62:63]
v_cmp_gt_i32 s[56:57], 48, v1
v_cmp_gt_i32 s[58:59], 49, v1
v_cmp_gt_i32 s[60:61], 50, v1
v_cmp_gt_i32 s[62:63], 51, v1
v_cndmask_b32 v172, v172, v20, s[56:57]
v_cndmask_b32 v173, v173, v20, s[58:59]
v_cndmask_b32 v174, v174, v20, s[60:61]
v_cndmask_b32 v175, v175, v20, s[62:63]
s_nop 1
s_branch L_k2_mkr_wo
L_k2_fb_tr:
s_nop 7
s_nop 0
v_max3_f32 v21, v192, v193, v194
v_max3_f32 v21, v21, v195, v196
v_max3_f32 v21, v21, v197, v198
v_max3_f32 v21, v21, v199, v200
v_max3_f32 v21, v21, v201, v202
v_max3_f32 v21, v21, v203, v204
v_max3_f32 v21, v21, v205, v206
v_max_f32 v21, v21, v207
v_mov_b32 v1, v21
s_nop 1
v_permlane16_swap_b32 v1, v21
v_max_f32 v21, v21, v1
v_mov_b32 v1, v21
s_nop 1
v_permlane32_swap_b32 v1, v21
v_max_f32_e64 v21, v21, v1
v_add_f32 v21, 0x41f80000, v21
v_max_f32 v21, 0, v21
Vs 192,192,21
Vs 193,193,21
Vs 194,194,21
Vs 195,195,21
Vs 196,196,21
Vs 197,197,21
Vs 198,198,21
Vs 199,199,21
Vs 200,200,21
Vs 201,201,21
Vs 202,202,21
Vs 203,203,21
Vs 204,204,21
Vs 205,205,21
Vs 206,206,21
Vs 207,207,21
Vs 128,128,21
Vs 129,129,21
Vs 130,130,21
Vs 131,131,21
Vs 132,132,21
Vs 133,133,21
Vs 134,134,21
Vs 135,135,21
Vs 136,136,21
Vs 137,137,21
Vs 138,138,21
Vs 139,139,21
Vs 140,140,21
Vs 141,141,21
Vs 142,142,21
Vs 143,143,21
Vs 32,32,21
Vs 33,33,21
Vs 34,34,21
v_sub_f32_e64 v35, v35, v21
v_exp_f32 v22, -v21
s_nop 0
Vm 48,48,22
Vm 49,49,22
Vm 50,50,22
v_mul_f32_e64 v51, v51, v22
Ar 8,0
Ar 9,1
Ar 10,2
Ar 11,3
Ar 12,4
Ar 13,5
Ar 14,6
Ar 15,7
Vm 8,8,22
Vm 9,9,22
Vm 10,10,22
Vm 11,11,22
Vm 12,12,22
Vm 13,13,22
Vm 14,14,22
Vm 15,15,22
Aw 0,8
Aw 1,9
Aw 2,10
Aw 3,11
Aw 4,12
Aw 5,13
Aw 6,14
Aw 7,15
Ar 8,8
Ar 9,9
Ar 10,10
Ar 11,11
Ar 12,12
Ar 13,13
Ar 14,14
Ar 15,15
Vm 8,8,22
Vm 9,9,22
Vm 10,10,22
Vm 11,11,22
Vm 12,12,22
Vm 13,13,22
Vm 14,14,22
Vm 15,15,22
Aw 8,8
Aw 9,9
Aw 10,10
Aw 11,11
Aw 12,12
Aw 13,13
Aw 14,14
Aw 15,15
Ar 8,16
Ar 9,17
Ar 10,18
Ar 11,19
Ar 12,20
Ar 13,21
Ar 14,22
Ar 15,23
Vm 8,8,22
Vm 9,9,22
Vm 10,10,22
Vm 11,11,22
Vm 12,12,22
Vm 13,13,22
Vm 14,14,22
Vm 15,15,22
Aw 16,8
Aw 17,9
Aw 18,10
Aw 19,11
Aw 20,12
Aw 21,13
Aw 22,14
Aw 23,15
Ar 8,24
Ar 9,25
Ar 10,26
Ar 11,27
Ar 12,28
Ar 13,29
Ar 14,30
Ar 15,31
Vm 8,8,22
Vm 9,9,22
Vm 10,10,22
Vm 11,11,22
Vm 12,12,22
Vm 13,13,22
Vm 14,14,22
Vm 15,15,22
Aw 24,8
Aw 25,9
Aw 26,10
Aw 27,11
Aw 28,12
Aw 29,13
Aw 30,14
Aw 31,15
v_max3_f32 v21, v208, v209, v210
v_max3_f32 v21, v21, v211, v212
v_max3_f32 v21, v21, v213, v214
v_max3_f32 v21, v21, v215, v216
v_max3_f32 v21, v21, v217, v218
v_max3_f32 v21, v21, v219, v220
v_max3_f32 v21, v21, v221, v222
v_max_f32 v21, v21, v223
v_mov_b32 v1, v21
s_nop 1
v_permlane16_swap_b32 v1, v21
v_max_f32 v21, v21, v1
v_mov_b32 v1, v21
s_nop 1
v_permlane32_swap_b32 v1, v21
v_max_f32_e64 v21, v21, v1
v_add_f32 v21, 0x41f80000, v21
v_max_f32 v21, 0, v21
Vs 208,208,21
Vs 209,209,21
Vs 210,210,21
Vs 211,211,21
Vs 212,212,21
Vs 213,213,21
Vs 214,214,21
Vs 215,215,21
Vs 216,216,21
Vs 217,217,21
Vs 218,218,21
Vs 219,219,21
Vs 220,220,21
Vs 221,221,21
Vs 222,222,21
Vs 223,223,21
Vs 144,144,21
Vs 145,145,21
Vs 146,146,21
Vs 147,147,21
Vs 148,148,21
Vs 149,149,21
Vs 150,150,21
Vs 151,151,21
Vs 152,152,21
Vs 153,153,21
Vs 154,154,21
Vs 155,155,21
Vs 156,156,21
Vs 157,157,21
Vs 158,158,21
Vs 159,159,21
Vs 36,36,21
Vs 37,37,21
Vs 38,38,21
v_sub_f32_e64 v39, v39, v21
v_exp_f32 v22, -v21
s_nop 0
Vm 52,52,22
Vm 53,53,22
Vm 54,54,22
v_mul_f32_e64 v55, v55, v22
Ar 8,32
Ar 9,33
Ar 10,34
Ar 11,35
Ar 12,36
Ar 13,37
Ar 14,38
Ar 15,39
Vm 8,8,22
Vm 9,9,22
Vm 10,10,22
Vm 11,11,22
Vm 12,12,22
Vm 13,13,22
Vm 14,14,22
Vm 15,15,22
Aw 32,8
Aw 33,9
Aw 34,10
Aw 35,11
Aw 36,12
Aw 37,13
Aw 38,14
Aw 39,15
Ar 8,40
Ar 9,41
Ar 10,42
Ar 11,43
Ar 12,44
Ar 13,45
Ar 14,46
Ar 15,47
Vm 8,8,22
Vm 9,9,22
Vm 10,10,22
Vm 11,11,22
Vm 12,12,22
Vm 13,13,22
Vm 14,14,22
Vm 15,15,22
Aw 40,8
Aw 41,9
Aw 42,10
Aw 43,11
Aw 44,12
Aw 45,13
Aw 46,14
Aw 47,15
Ar 8,48
Ar 9,49
Ar 10,50
Ar 11,51
Ar 12,52
Ar 13,53
Ar 14,54
Ar 15,55
Vm 8,8,22
Vm 9,9,22
Vm 10,10,22
Vm 11,11,22
Vm 12,12,22
Vm 13,13,22
Vm 14,14,22
Vm 15,15,22
Aw 48,8
Aw 49,9
Aw 50,10
Aw 51,11
Aw 52,12
Aw 53,13
Aw 54,14
Aw 55,15
Ar 8,56
Ar 9,57
Ar 10,58
Ar 11,59
Ar 12,60
Ar 13,61
Ar 14,62
Ar 15,63
Vm 8,8,22
Vm 9,9,22
Vm 10,10,22
Vm 11,11,22
Vm 12,12,22
Vm 13,13,22
Vm 14,14,22
Vm 15,15,22
Aw 56,8
Aw 57,9
Aw 58,10
Aw 59,11
Aw 60,12
Aw 61,13
Aw 62,14
Aw 63,15
v_max3_f32 v21, v224, v225, v226
v_max3_f32 v21, v21, v227, v228
v_max3_f32 v21, v21, v229, v230
v_max3_f32 v21, v21, v231, v232
v_max3_f32 v21, v21, v233, v234
v_max3_f32 v21, v21, v235, v236
v_max3_f32 v21, v21, v237, v238
v_max_f32 v21, v21, v239
v_mov_b32 v1, v21
s_nop 1
v_permlane16_swap_b32 v1, v21
v_max_f32 v21, v21, v1
v_mov_b32 v1, v21
s_nop 1
v_permlane32_swap_b32 v1, v21
v_max_f32_e64 v21, v21, v1
v_add_f32 v21, 0x41f80000, v21
v_max_f32 v21, 0, v21
Vs 224,224,21
Vs 225,225,21
Vs 226,226,21
Vs 227,227,21
Vs 228,228,21
Vs 229,229,21
Vs 230,230,21
Vs 231,231,21
Vs 232,232,21
Vs 233,233,21
Vs 234,234,21
Vs 235,235,21
Vs 236,236,21
Vs 237,237,21
Vs 238,238,21
Vs 239,239,21
Vs 40,40,21
Vs 41,41,21
Vs 42,42,21
v_sub_f32_e64 v43, v43, v21
v_exp_f32 v22, -v21
s_nop 0
Vm 56,56,22
Vm 57,57,22
Vm 58,58,22
v_mul_f32_e64 v59, v59, v22
Ar 8,64
Ar 9,65
Ar 10,66
Ar 11,67
Ar 12,68
Ar 13,69
Ar 14,70
Ar 15,71
Vm 8,8,22
Vm 9,9,22
Vm 10,10,22
Vm 11,11,22
Vm 12,12,22
Vm 13,13,22
Vm 14,14,22
Vm 15,15,22
Aw 64,8
Aw 65,9
Aw 66,10
Aw 67,11
Aw 68,12
Aw 69,13
Aw 70,14
Aw 71,15
Ar 8,72
Ar 9,73
Ar 10,74
Ar 11,75
Ar 12,76
Ar 13,77
Ar 14,78
Ar 15,79
Vm 8,8,22
Vm 9,9,22
Vm 10,10,22
Vm 11,11,22
Vm 12,12,22
Vm 13,13,22
Vm 14,14,22
Vm 15,15,22
Aw 72,8
Aw 73,9
Aw 74,10
Aw 75,11
Aw 76,12
Aw 77,13
Aw 78,14
Aw 79,15
Ar 8,80
Ar 9,81
Ar 10,82
Ar 11,83
Ar 12,84
Ar 13,85
Ar 14,86
Ar 15,87
Vm 8,8,22
Vm 9,9,22
Vm 10,10,22
Vm 11,11,22
Vm 12,12,22
Vm 13,13,22
Vm 14,14,22
Vm 15,15,22
Aw 80,8
Aw 81,9
Aw 82,10
Aw 83,11
Aw 84,12
Aw 85,13
Aw 86,14
Aw 87,15
Ar 8,88
Ar 9,89
Ar 10,90
Ar 11,91
Ar 12,92
Ar 13,93
Ar 14,94
Ar 15,95
Vm 8,8,22
Vm 9,9,22
Vm 10,10,22
Vm 11,11,22
Vm 12,12,22
Vm 13,13,22
Vm 14,14,22
Vm 15,15,22
Aw 88,8
Aw 89,9
Aw 90,10
Aw 91,11
Aw 92,12
Aw 93,13
Aw 94,14
Aw 95,15
v_max3_f32 v21, v240, v241, v242
v_max3_f32 v21, v21, v243, v244
v_max3_f32 v21, v21, v245, v246
v_max3_f32 v21, v21, v247, v248
v_max3_f32 v21, v21, v249, v250
v_max3_f32 v21, v21, v251, v252
v_max3_f32 v21, v21, v253, v254
v_max_f32 v21, v21, v255
v_mov_b32 v1, v21
s_nop 1
v_permlane16_swap_b32 v1, v21
v_max_f32 v21, v21, v1
v_mov_b32 v1, v21
s_nop 1
v_permlane32_swap_b32 v1, v21
v_max_f32_e64 v21, v21, v1
v_add_f32 v21, 0x41f80000, v21
v_max_f32 v21, 0, v21
Vs 240,240,21
Vs 241,241,21
Vs 242,242,21
Vs 243,243,21
Vs 244,244,21
Vs 245,245,21
Vs 246,246,21
Vs 247,247,21
Vs 248,248,21
Vs 249,249,21
Vs 250,250,21
Vs 251,251,21
Vs 252,252,21
Vs 253,253,21
Vs 254,254,21
Vs 255,255,21
Vs 44,44,21
Vs 45,45,21
Vs 46,46,21
v_sub_f32_e64 v47, v47, v21
v_exp_f32 v22, -v21
s_nop 0
Vm 60,60,22
Vm 61,61,22
Vm 62,62,22
v_mul_f32_e64 v63, v63, v22
Ar 8,96
Ar 9,97
Ar 10,98
Ar 11,99
Ar 12,100
Ar 13,101
Ar 14,102
Ar 15,103
Vm 8,8,22
Vm 9,9,22
Vm 10,10,22
Vm 11,11,22
Vm 12,12,22
Vm 13,13,22
Vm 14,14,22
Vm 15,15,22
Aw 96,8
Aw 97,9
Aw 98,10
Aw 99,11
Aw 100,12
Aw 101,13
Aw 102,14
Aw 103,15
Ar 8,104
Ar 9,105
Ar 10,106
Ar 11,107
Ar 12,108
Ar 13,109
Ar 14,110
Ar 15,111
Vm 8,8,22
Vm 9,9,22
Vm 10,10,22
Vm 11,11,22
Vm 12,12,22
Vm 13,13,22
Vm 14,14,22
Vm 15,15,22
Aw 104,8
Aw 105,9
Aw 106,10
Aw 107,11
Aw 108,12
Aw 109,13
Aw 110,14
Aw 111,15
Ar 8,112
Ar 9,113
Ar 10,114
Ar 11,115
Ar 12,116
Ar 13,117
Ar 14,118
Ar 15,119
Vm 8,8,22
Vm 9,9,22
Vm 10,10,22
Vm 11,11,22
Vm 12,12,22
Vm 13,13,22
Vm 14,14,22
Vm 15,15,22
Aw 112,8
Aw 113,9
Aw 114,10
Aw 115,11
Aw 116,12
Aw 117,13
Aw 118,14
Aw 119,15
Ar 8,120
Ar 9,121
Ar 10,122
Ar 11,123
Ar 12,124
Ar 13,125
Ar 14,126
Ar 15,127
Vm 8,8,22
Vm 9,9,22
Vm 10,10,22
Vm 11,11,22
Vm 12,12,22
Vm 13,13,22
Vm 14,14,22
Vm 15,15,22
Aw 120,8
Aw 121,9
Aw 122,10
Aw 123,11
Aw 124,12
Aw 125,13
Aw 126,14
Aw 127,15
Ve 8,192
Ve 9,193
s_nop 0
Vc 96,8,9
Ve 8,194
Ve 9,195
s_nop 0
Vc 97,8,9
Ve 8,208
Ve 9,209
s_nop 0
Vc 104,8,9
Ve 8,210
Ve 9,211
s_nop 0
Vc 105,8,9
Ve 8,224
Ve 9,225
s_nop 0
Vc 112,8,9
Ve 8,226
Ve 9,227
s_nop 0
Vc 113,8,9
Ve 8,240
Ve 9,241
s_nop 0
Vc 120,8,9
Ve 8,242
Ve 9,243
s_nop 0
Vc 121,8,9
Ve 8,196
Ve 9,197
s_nop 0
Vc 98,8,9
Ve 8,198
Ve 9,199
s_nop 0
Vc 99,8,9
Ve 8,212
Ve 9,213
s_nop 0
Vc 106,8,9
Ve 8,214
Ve 9,215
s_nop 0
Vc 107,8,9
Ve 8,228
Ve 9,229
s_nop 0
Vc 114,8,9
Ve 8,230
Ve 9,231
s_nop 0
Vc 115,8,9
Ve 8,244
Ve 9,245
s_nop 0
Vc 122,8,9
Ve 8,246
Ve 9,247
s_nop 0
Vc 123,8,9
Ve 8,200
Ve 9,201
s_nop 0
Vc 100,8,9
Ve 8,202
Ve 9,203
s_nop 0
Vc 101,8,9
Ve 8,216
Ve 9,217
s_nop 0
Vc 108,8,9
Ve 8,218
Ve 9,219
s_nop 0
Vc 109,8,9
Ve 8,232
Ve 9,233
s_nop 0
Vc 116,8,9
Ve 8,234
Ve 9,235
s_nop 0
Vc 117,8,9
Ve 8,248
Ve 9,249
s_nop 0
Vc 124,8,9
Ve 8,250
Ve 9,251
s_nop 0
Vc 125,8,9
Ve 8,204
Ve 9,205
s_nop 0
Vc 102,8,9
Ve 8,206
Ve 9,207
s_nop 0
Vc 103,8,9
Ve 8,220
Ve 9,221
s_nop 0
Vc 110,8,9
Ve 8,222
Ve 9,223
s_nop 0
Vc 111,8,9
Ve 8,236
Ve 9,237
s_nop 0
Vc 118,8,9
Ve 8,238
Ve 9,239
s_nop 0
Vc 119,8,9
Ve 8,252
Ve 9,253
s_nop 0
Vc 126,8,9
Ve 8,254
Ve 9,255
s_nop 0
Vc 127,8,9
s_nop 1
s_branch L_k2_fbr_tr
L_k2_mk_tr:
s_nop 7
s_add_u32 s3, s37, 1
s_lshl_b32 s3, s3, 6
v_subrev_u32 v1, s3, v5
v_cmp_gt_i32 s[56:57], -16, v1
v_cmp_gt_i32 s[58:59], -15, v1
v_cmp_gt_i32 s[60:61], -14, v1
v_cmp_gt_i32 s[62:63], -13, v1
v_cndmask_b32 v144, v144, v20, s[56:57]
v_cndmask_b32 v145, v145, v20, s[58:59]
v_cndmask_b32 v146, v146, v20, s[60:61]
v_cndmask_b32 v147, v147, v20, s[62:63]
v_cmp_gt_i32 s[56:57], 0, v1
v_cmp_gt_i32 s[58:59], 1, v1
v_cmp_gt_i32 s[60:61], 2, v1
v_cmp_gt_i32 s[62:63], 3, v1
v_cndmask_b32 v128, v128, v20, s[56:57]
v_cndmask_b32 v129, v129, v20, s[58:59]
v_cndmask_b32 v130, v130, v20, s[60:61]
v_cndmask_b32 v131, v131, v20, s[62:63]
v_cndmask_b32 v148, v148, v20, s[56:57]
v_cndmask_b32 v149, v149, v20, s[58:59]
v_cndmask_b32 v150, v150, v20, s[60:61]
v_cndmask_b32 v151, v151, v20, s[62:63]
v_cmp_gt_i32 s[56:57], 16, v1
v_cmp_gt_i32 s[58:59], 17, v1
v_cmp_gt_i32 s[60:61], 18, v1
v_cmp_gt_i32 s[62:63], 19, v1
v_cndmask_b32 v132, v132, v20, s[56:57]
v_cndmask_b32 v133, v133, v20, s[58:59]
v_cndmask_b32 v134, v134, v20, s[60:61]
v_cndmask_b32 v135, v135, v20, s[62:63]
v_cndmask_b32 v152, v152, v20, s[56:57]
v_cndmask_b32 v153, v153, v20, s[58:59]
v_cndmask_b32 v154, v154, v20, s[60:61]
v_cndmask_b32 v155, v155, v20, s[62:63]
v_cmp_gt_i32 s[56:57], 32, v1
v_cmp_gt_i32 s[58:59], 33, v1
v_cmp_gt_i32 s[60:61], 34, v1
v_cmp_gt_i32 s[62:63], 35, v1
v_cndmask_b32 v136, v136, v20, s[56:57]
v_cndmask_b32 v137, v137, v20, s[58:59]
v_cndmask_b32 v138, v138, v20, s[60:61]
v_cndmask_b32 v139, v139, v20, s[62:63]
v_cndmask_b32 v156, v156, v20, s[56:57]
v_cndmask_b32 v157, v157, v20, s[58:59]
v_cndmask_b32 v158, v158, v20, s[60:61]
v_cndmask_b32 v159, v159, v20, s[62:63]
v_cmp_gt_i32 s[56:57], 48, v1
v_cmp_gt_i32 s[58:59], 49, v1
v_cmp_gt_i32 s[60:61], 50, v1
v_cmp_gt_i32 s[62:63], 51, v1
v_cndmask_b32 v140, v140, v20, s[56:57]
v_cndmask_b32 v141, v141, v20, s[58:59]
v_cndmask_b32 v142, v142, v20, s[60:61]
v_cndmask_b32 v143, v143, v20, s[62:63]
s_nop 1
s_branch L_k2_mkr_tr
L_k2_fb_ne:
s_nop 7
s_nop 0
v_max3_f32 v21, v128, v129, v130
v_max3_f32 v21, v21, v131, v132
v_max3_f32 v21, v21, v133, v134
v_max3_f32 v21, v21, v135, v136
v_max3_f32 v21, v21, v137, v138
v_max3_f32 v21, v21, v139, v140
v_max3_f32 v21, v21, v141, v142
v_max_f32 v21, v21, v143
v_mov_b32 v1, v21
s_nop 1
v_permlane16_swap_b32 v1, v21
v_max_f32 v21, v21, v1
v_mov_b32 v1, v21
s_nop 1
v_permlane32_swap_b32 v1, v21
v_max_f32_e64 v21, v21, v1
v_add_f32 v21, 0x41f80000, v21
v_max_f32 v21, 0, v21
Vs 128,128,21
Vs 129,129,21
Vs 130,130,21
Vs 131,131,21
Vs 132,132,21
Vs 133,133,21
Vs 134,134,21
Vs 135,135,21
Vs 136,136,21
Vs 137,137,21
Vs 138,138,21
Vs 139,139,21
Vs 140,140,21
Vs 141,141,21
Vs 142,142,21
Vs 143,143,21
Vs 192,192,21
Vs 193,193,21
Vs 194,194,21
Vs 195,195,21
Vs 196,196,21
Vs 197,197,21
Vs 198,198,21
Vs 199,199,21
Vs 200,200,21
Vs 201,201,21
Vs 202,202,21
Vs 203,203,21
Vs 204,204,21
Vs 205,205,21
Vs 206,206,21
Vs 207,207,21
Vs 32,32,21
Vs 33,33,21
Vs 34,34,21
v_sub_f32_e64 v35, v35, v21
v_exp_f32 v22, -v21
s_nop 0
Vm 48,48,22
Vm 49,49,22
Vm 50,50,22
v_mul_f32_e64 v51, v51, v22
Ar 8,0
Ar 9,1
Ar 10,2
Ar 11,3
Ar 12,4
Ar 13,5
Ar 14,6
Ar 15,7
Vm 8,8,22
Vm 9,9,22
Vm 10,10,22
Vm 11,11,22
Vm 12,12,22
Vm 13,13,22
Vm 14,14,22
Vm 15,15,22
Aw 0,8
Aw 1,9
Aw 2,10
Aw 3,11
Aw 4,12
Aw 5,13
Aw 6,14
Aw 7,15
Ar 8,8
Ar 9,9
Ar 10,10
Ar 11,11
Ar 12,12
Ar 13,13
Ar 14,14
Ar 15,15
Vm 8,8,22
Vm 9,9,22
Vm 10,10,22
Vm 11,11,22
Vm 12,12,22
Vm 13,13,22
Vm 14,14,22
Vm 15,15,22
Aw 8,8
Aw 9,9
Aw 10,10
Aw 11,11
Aw 12,12
Aw 13,13
Aw 14,14
Aw 15,15
Ar 8,16
Ar 9,17
Ar 10,18
Ar 11,19
Ar 12,20
Ar 13,21
Ar 14,22
Ar 15,23
Vm 8,8,22
Vm 9,9,22
Vm 10,10,22
Vm 11,11,22
Vm 12,12,22
Vm 13,13,22
Vm 14,14,22
Vm 15,15,22
Aw 16,8
Aw 17,9
Aw 18,10
Aw 19,11
Aw 20,12
Aw 21,13
Aw 22,14
Aw 23,15
Ar 8,24
Ar 9,25
Ar 10,26
Ar 11,27
Ar 12,28
Ar 13,29
Ar 14,30
Ar 15,31
Vm 8,8,22
Vm 9,9,22
Vm 10,10,22
Vm 11,11,22
Vm 12,12,22
Vm 13,13,22
Vm 14,14,22
Vm 15,15,22
Aw 24,8
Aw 25,9
Aw 26,10
Aw 27,11
Aw 28,12
Aw 29,13
Aw 30,14
Aw 31,15
v_max3_f32 v21, v144, v145, v146
v_max3_f32 v21, v21, v147, v148
v_max3_f32 v21, v21, v149, v150
v_max3_f32 v21, v21, v151, v152
v_max3_f32 v21, v21, v153, v154
v_max3_f32 v21, v21, v155, v156
v_max3_f32 v21, v21, v157, v158
v_max_f32 v21, v21, v159
v_mov_b32 v1, v21
s_nop 1
v_permlane16_swap_b32 v1, v21
v_max_f32 v21, v21, v1
v_mov_b32 v1, v21
s_nop 1
v_permlane32_swap_b32 v1, v21
v_max_f32_e64 v21, v21, v1
v_add_f32 v21, 0x41f80000, v21
v_max_f32 v21, 0, v21
Vs 144,144,21
Vs 145,145,21
Vs 146,146,21
Vs 147,147,21
Vs 148,148,21
Vs 149,149,21
Vs 150,150,21
Vs 151,151,21
Vs 152,152,21
Vs 153,153,21
Vs 154,154,21
Vs 155,155,21
Vs 156,156,21
Vs 157,157,21
Vs 158,158,21
Vs 159,159,21
Vs 208,208,21
Vs 209,209,21
Vs 210,210,21
Vs 211,211,21
Vs 212,212,21
Vs 213,213,21
Vs 214,214,21
Vs 215,215,21
Vs 216,216,21
Vs 217,217,21
Vs 218,218,21
Vs 219,219,21
Vs 220,220,21
Vs 221,221,21
Vs 222,222,21
Vs 223,223,21
Vs 36,36,21
Vs 37,37,21
Vs 38,38,21
v_sub_f32_e64 v39, v39, v21
v_exp_f32 v22, -v21
s_nop 0
Vm 52,52,22
Vm 53,53,22
Vm 54,54,22
v_mul_f32_e64 v55, v55, v22
Ar 8,32
Ar 9,33
Ar 10,34
Ar 11,35
Ar 12,36
Ar 13,37
Ar 14,38
Ar 15,39
Vm 8,8,22
Vm 9,9,22
Vm 10,10,22
Vm 11,11,22
Vm 12,12,22
Vm 13,13,22
Vm 14,14,22
Vm 15,15,22
Aw 32,8
Aw 33,9
Aw 34,10
Aw 35,11
Aw 36,12
Aw 37,13
Aw 38,14
Aw 39,15
Ar 8,40
Ar 9,41
Ar 10,42
Ar 11,43
Ar 12,44
Ar 13,45
Ar 14,46
Ar 15,47
Vm 8,8,22
Vm 9,9,22
Vm 10,10,22
Vm 11,11,22
Vm 12,12,22
Vm 13,13,22
Vm 14,14,22
Vm 15,15,22
Aw 40,8
Aw 41,9
Aw 42,10
Aw 43,11
Aw 44,12
Aw 45,13
Aw 46,14
Aw 47,15
Ar 8,48
Ar 9,49
Ar 10,50
Ar 11,51
Ar 12,52
Ar 13,53
Ar 14,54
Ar 15,55
Vm 8,8,22
Vm 9,9,22
Vm 10,10,22
Vm 11,11,22
Vm 12,12,22
Vm 13,13,22
Vm 14,14,22
Vm 15,15,22
Aw 48,8
Aw 49,9
Aw 50,10
Aw 51,11
Aw 52,12
Aw 53,13
Aw 54,14
Aw 55,15
Ar 8,56
Ar 9,57
Ar 10,58
Ar 11,59
Ar 12,60
Ar 13,61
Ar 14,62
Ar 15,63
Vm 8,8,22
Vm 9,9,22
Vm 10,10,22
Vm 11,11,22
Vm 12,12,22
Vm 13,13,22
Vm 14,14,22
Vm 15,15,22
Aw 56,8
Aw 57,9
Aw 58,10
Aw 59,11
Aw 60,12
Aw 61,13
Aw 62,14
Aw 63,15
Ve 8,128
Ve 9,129
s_nop 0
Vc 64,8,9
Ve 8,130
Ve 9,131
s_nop 0
Vc 65,8,9
Ve 8,144
Ve 9,145
s_nop 0
Vc 72,8,9
Ve 8,146
Ve 9,147
s_nop 0
Vc 73,8,9
Ve 8,132
Ve 9,133
s_nop 0
Vc 66,8,9
Ve 8,134
Ve 9,135
s_nop 0
Vc 67,8,9
Ve 8,148
Ve 9,149
s_nop 0
Vc 74,8,9
Ve 8,150
Ve 9,151
s_nop 0
Vc 75,8,9
Ve 8,136
Ve 9,137
s_nop 0
Vc 68,8,9
Ve 8,138
Ve 9,139
s_nop 0
Vc 69,8,9
Ve 8,152
Ve 9,153
s_nop 0
Vc 76,8,9
Ve 8,154
Ve 9,155
s_nop 0
Vc 77,8,9
Ve 8,140
Ve 9,141
s_nop 0
Vc 70,8,9
Ve 8,142
Ve 9,143
s_nop 0
Vc 71,8,9
Ve 8,156
Ve 9,157
s_nop 0
Vc 78,8,9
Ve 8,158
Ve 9,159
s_nop 0
Vc 79,8,9
s_nop 1
s_branch L_k2_fbr_ne
L_k2_mk_ne:
s_nop 7
s_add_u32 s3, s37, 1
s_lshl_b32 s3, s3, 6
v_subrev_u32 v1, s3, v5
v_cmp_gt_i32 s[56:57], -16, v1
v_cmp_gt_i32 s[58:59], -15, v1
v_cmp_gt_i32 s[60:61], -14, v1
v_cmp_gt_i32 s[62:63], -13, v1
v_cndmask_b32 v208, v208, v20, s[56:57]
v_cndmask_b32 v209, v209, v20, s[58:59]
v_cndmask_b32 v210, v210, v20, s[60:61]
v_cndmask_b32 v211, v211, v20, s[62:63]
v_cmp_gt_i32 s[56:57], 0, v1
v_cmp_gt_i32 s[58:59], 1, v1
v_cmp_gt_i32 s[60:61], 2, v1
v_cmp_gt_i32 s[62:63], 3, v1
v_cndmask_b32 v192, v192, v20, s[56:57]
v_cndmask_b32 v193, v193, v20, s[58:59]
v_cndmask_b32 v194, v194, v20, s[60:61]
v_cndmask_b32 v195, v195, v20, s[62:63]
v_cndmask_b32 v212, v212, v20, s[56:57]
v_cndmask_b32 v213, v213, v20, s[58:59]
v_cndmask_b32 v214, v214, v20, s[60:61]
v_cndmask_b32 v215, v215, v20, s[62:63]
v_cmp_gt_i32 s[56:57], 16, v1
v_cmp_gt_i32 s[58:59], 17, v1
v_cmp_gt_i32 s[60:61], 18, v1
v_cmp_gt_i32 s[62:63], 19, v1
v_cndmask_b32 v196, v196, v20, s[56:57]
v_cndmask_b32 v197, v197, v20, s[58:59]
v_cndmask_b32 v198, v198, v20, s[60:61]
v_cndmask_b32 v199, v199, v20, s[62:63]
v_cndmask_b32 v216, v216, v20, s[56:57]
v_cndmask_b32 v217, v217, v20, s[58:59]
v_cndmask_b32 v218, v218, v20, s[60:61]
v_cndmask_b32 v219, v219, v20, s[62:63]
v_cmp_gt_i32 s[56:57], 32, v1
v_cmp_gt_i32 s[58:59], 33, v1
v_cmp_gt_i32 s[60:61], 34, v1
v_cmp_gt_i32 s[62:63], 35, v1
v_cndmask_b32 v200, v200, v20, s[56:57]
v_cndmask_b32 v201, v201, v20, s[58:59]
v_cndmask_b32 v202, v202, v20, s[60:61]
v_cndmask_b32 v203, v203, v20, s[62:63]
v_cndmask_b32 v220, v220, v20, s[56:57]
v_cndmask_b32 v221, v221, v20, s[58:59]
v_cndmask_b32 v222, v222, v20, s[60:61]
v_cndmask_b32 v223, v223, v20, s[62:63]
v_cmp_gt_i32 s[56:57], 48, v1
v_cmp_gt_i32 s[58:59], 49, v1
v_cmp_gt_i32 s[60:61], 50, v1
v_cmp_gt_i32 s[62:63], 51, v1
v_cndmask_b32 v204, v204, v20, s[56:57]
v_cndmask_b32 v205, v205, v20, s[58:59]
v_cndmask_b32 v206, v206, v20, s[60:61]
v_cndmask_b32 v207, v207, v20, s[62:63]
s_nop 1
s_branch L_k2_mkr_ne
L_pubB:
v_mov_b32 v24, 1
v_mov_b32 v25, 0
s_mov_b64 exec, 1
buffer_store_dword v24, v25, s[20:23], s64 offen sc1
s_mov_b64 exec, -1
s_branch L_pubBr
L_k2_fb_no:
s_nop 7
v_max3_f32 v21, v192, v193, v194
v_max3_f32 v21, v21, v195, v196
v_max3_f32 v21, v21, v197, v198
v_max3_f32 v21, v21, v199, v200
v_max3_f32 v21, v21, v201, v202
v_max3_f32 v21, v21, v203, v204
v_max3_f32 v21, v21, v205, v206
v_max_f32 v21, v21, v207
v_mov_b32 v1, v21
s_nop 1
v_permlane16_swap_b32 v1, v21
v_max_f32 v21, v21, v1
v_mov_b32 v1, v21
s_nop 1
v_permlane32_swap_b32 v1, v21
v_max_f32_e64 v21, v21, v1
v_add_f32 v21, 0x41f80000, v21
v_max_f32 v21, 0, v21
Vs 192,192,21
Vs 193,193,21
Vs 194,194,21
Vs 195,195,21
Vs 196,196,21
Vs 197,197,21
Vs 198,198,21
Vs 199,199,21
Vs 200,200,21
Vs 201,201,21
Vs 202,202,21
Vs 203,203,21
Vs 204,204,21
Vs 205,205,21
Vs 206,206,21
Vs 207,207,21
Vs 128,128,21
Vs 129,129,21
Vs 130,130,21
Vs 131,131,21
Vs 132,132,21
Vs 133,133,21
Vs 134,134,21
Vs 135,135,21
Vs 136,136,21
Vs 137,137,21
Vs 138,138,21
Vs 139,139,21
Vs 140,140,21
Vs 141,141,21
Vs 142,142,21
Vs 143,143,21
Vs 32,32,21
Vs 33,33,21
Vs 34,34,21
v_sub_f32_e64 v35, v35, v21
v_exp_f32 v22, -v21
s_nop 0
Vm 48,48,22
Vm 49,49,22
Vm 50,50,22
v_mul_f32_e64 v51, v51, v22
Ar 8,0
Ar 9,1
Ar 10,2
Ar 11,3
Ar 12,4
Ar 13,5
Ar 14,6
Ar 15,7
Vm 8,8,22
Vm 9,9,22
Vm 10,10,22
Vm 11,11,22
Vm 12,12,22
Vm 13,13,22
Vm 14,14,22
Vm 15,15,22
Aw 0,8
Aw 1,9
Aw 2,10
Aw 3,11
Aw 4,12
Aw 5,13
Aw 6,14
Aw 7,15
Ar 8,8
Ar 9,9
Ar 10,10
Ar 11,11
Ar 12,12
Ar 13,13
Ar 14,14
Ar 15,15
Vm 8,8,22
Vm 9,9,22
Vm 10,10,22
Vm 11,11,22
Vm 12,12,22
Vm 13,13,22
Vm 14,14,22
Vm 15,15,22
Aw 8,8
Aw 9,9
Aw 10,10
Aw 11,11
Aw 12,12
Aw 13,13
Aw 14,14
Aw 15,15
Ar 8,16
Ar 9,17
Ar 10,18
Ar 11,19
Ar 12,20
Ar 13,21
Ar 14,22
Ar 15,23
Vm 8,8,22
Vm 9,9,22
Vm 10,10,22
Vm 11,11,22
Vm 12,12,22
Vm 13,13,22
Vm 14,14,22
Vm 15,15,22
Aw 16,8
Aw 17,9
Aw 18,10
Aw 19,11
Aw 20,12
Aw 21,13
Aw 22,14
Aw 23,15
Ar 8,24
Ar 9,25
Ar 10,26
Ar 11,27
Ar 12,28
Ar 13,29
Ar 14,30
Ar 15,31
Vm 8,8,22
Vm 9,9,22
Vm 10,10,22
Vm 11,11,22
Vm 12,12,22
Vm 13,13,22
Vm 14,14,22
Vm 15,15,22
Aw 24,8
Aw 25,9
Aw 26,10
Aw 27,11
Aw 28,12
Aw 29,13
Aw 30,14
Aw 31,15
v_max3_f32 v21, v208, v209, v210
v_max3_f32 v21, v21, v211, v212
v_max3_f32 v21, v21, v213, v214
v_max3_f32 v21, v21, v215, v216
v_max3_f32 v21, v21, v217, v218
v_max3_f32 v21, v21, v219, v220
v_max3_f32 v21, v21, v221, v222
v_max_f32 v21, v21, v223
v_mov_b32 v1, v21
s_nop 1
v_permlane16_swap_b32 v1, v21
v_max_f32 v21, v21, v1
v_mov_b32 v1, v21
s_nop 1
v_permlane32_swap_b32 v1, v21
v_max_f32_e64 v21, v21, v1
v_add_f32 v21, 0x41f80000, v21
v_max_f32 v21, 0, v21
Vs 208,208,21
Vs 209,209,21
Vs 210,210,21
Vs 211,211,21
Vs 212,212,21
Vs 213,213,21
Vs 214,214,21
Vs 215,215,21
Vs 216,216,21
Vs 217,217,21
Vs 218,218,21
Vs 219,219,21
Vs 220,220,21
Vs 221,221,21
Vs 222,222,21
Vs 223,223,21
Vs 144,144,21
Vs 145,145,21
Vs 146,146,21
Vs 147,147,21
Vs 148,148,21
Vs 149,149,21
Vs 150,150,21
Vs 151,151,21
Vs 152,152,21
Vs 153,153,21
Vs 154,154,21
Vs 155,155,21
Vs 156,156,21
Vs 157,157,21
Vs 158,158,21
Vs 159,159,21
Vs 36,36,21
Vs 37,37,21
Vs 38,38,21
v_sub_f32_e64 v39, v39, v21
v_exp_f32 v22, -v21
s_nop 0
Vm 52,52,22
Vm 53,53,22
Vm 54,54,22
v_mul_f32_e64 v55, v55, v22
Ar 8,32
Ar 9,33
Ar 10,34
Ar 11,35
Ar 12,36
Ar 13,37
Ar 14,38
Ar 15,39
Vm 8,8,22
Vm 9,9,22
Vm 10,10,22
Vm 11,11,22
Vm 12,12,22
Vm 13,13,22
Vm 14,14,22
Vm 15,15,22
Aw 32,8
Aw 33,9
Aw 34,10
Aw 35,11
Aw 36,12
Aw 37,13
Aw 38,14
Aw 39,15
Ar 8,40
Ar 9,41
Ar 10,42
Ar 11,43
Ar 12,44
Ar 13,45
Ar 14,46
Ar 15,47
Vm 8,8,22
Vm 9,9,22
Vm 10,10,22
Vm 11,11,22
Vm 12,12,22
Vm 13,13,22
Vm 14,14,22
Vm 15,15,22
Aw 40,8
Aw 41,9
Aw 42,10
Aw 43,11
Aw 44,12
Aw 45,13
Aw 46,14
Aw 47,15
Ar 8,48
Ar 9,49
Ar 10,50
Ar 11,51
Ar 12,52
Ar 13,53
Ar 14,54
Ar 15,55
Vm 8,8,22
Vm 9,9,22
Vm 10,10,22
Vm 11,11,22
Vm 12,12,22
Vm 13,13,22
Vm 14,14,22
Vm 15,15,22
Aw 48,8
Aw 49,9
Aw 50,10
Aw 51,11
Aw 52,12
Aw 53,13
Aw 54,14
Aw 55,15
Ar 8,56
Ar 9,57
Ar 10,58
Ar 11,59
Ar 12,60
Ar 13,61
Ar 14,62
Ar 15,63
Vm 8,8,22
Vm 9,9,22
Vm 10,10,22
Vm 11,11,22
Vm 12,12,22
Vm 13,13,22
Vm 14,14,22
Vm 15,15,22
Aw 56,8
Aw 57,9
Aw 58,10
Aw 59,11
Aw 60,12
Aw 61,13
Aw 62,14
Aw 63,15
Ve 8,192
Ve 9,193
s_nop 0
Vc 96,8,9
Ve 8,194
Ve 9,195
s_nop 0
Vc 97,8,9
Ve 8,208
Ve 9,209
s_nop 0
Vc 104,8,9
Ve 8,210
Ve 9,211
s_nop 0
Vc 105,8,9
Ve 8,196
Ve 9,197
s_nop 0
Vc 98,8,9
Ve 8,198
Ve 9,199
s_nop 0
Vc 99,8,9
Ve 8,212
Ve 9,213
s_nop 0
Vc 106,8,9
Ve 8,214
Ve 9,215
s_nop 0
Vc 107,8,9
Ve 8,200
Ve 9,201
s_nop 0
Vc 100,8,9
Ve 8,202
Ve 9,203
s_nop 0
Vc 101,8,9
Ve 8,216
Ve 9,217
s_nop 0
Vc 108,8,9
Ve 8,218
Ve 9,219
s_nop 0
Vc 109,8,9
Ve 8,204
Ve 9,205
s_nop 0
Vc 102,8,9
Ve 8,206
Ve 9,207
s_nop 0
Vc 103,8,9
Ve 8,220
Ve 9,221
s_nop 0
Vc 110,8,9
Ve 8,222
Ve 9,223
s_nop 0
Vc 111,8,9
s_nop 1
s_branch L_k2_fbr_no
L_k2_mk_no:
s_nop 7
s_add_u32 s3, s37, 1
s_lshl_b32 s3, s3, 6
v_subrev_u32 v1, s3, v5
v_cmp_gt_i32 s[56:57], -16, v1
v_cmp_gt_i32 s[58:59], -15, v1
v_cmp_gt_i32 s[60:61], -14, v1
v_cmp_gt_i32 s[62:63], -13, v1
v_cndmask_b32 v144, v144, v20, s[56:57]
v_cndmask_b32 v145, v145, v20, s[58:59]
v_cndmask_b32 v146, v146, v20, s[60:61]
v_cndmask_b32 v147, v147, v20, s[62:63]
v_cmp_gt_i32 s[56:57], 0, v1
v_cmp_gt_i32 s[58:59], 1, v1
v_cmp_gt_i32 s[60:61], 2, v1
v_cmp_gt_i32 s[62:63], 3, v1
v_cndmask_b32 v128, v128, v20, s[56:57]
v_cndmask_b32 v129, v129, v20, s[58:59]
v_cndmask_b32 v130, v130, v20, s[60:61]
v_cndmask_b32 v131, v131, v20, s[62:63]
v_cndmask_b32 v148, v148, v20, s[56:57]
v_cndmask_b32 v149, v149, v20, s[58:59]
v_cndmask_b32 v150, v150, v20, s[60:61]
v_cndmask_b32 v151, v151, v20, s[62:63]
v_cmp_gt_i32 s[56:57], 16, v1
v_cmp_gt_i32 s[58:59], 17, v1
v_cmp_gt_i32 s[60:61], 18, v1
v_cmp_gt_i32 s[62:63], 19, v1
v_cndmask_b32 v132, v132, v20, s[56:57]
v_cndmask_b32 v133, v133, v20, s[58:59]
v_cndmask_b32 v134, v134, v20, s[60:61]
v_cndmask_b32 v135, v135, v20, s[62:63]
v_cndmask_b32 v152, v152, v20, s[56:57]
v_cndmask_b32 v153, v153, v20, s[58:59]
v_cndmask_b32 v154, v154, v20, s[60:61]
v_cndmask_b32 v155, v155, v20, s[62:63]
v_cmp_gt_i32 s[56:57], 32, v1
v_cmp_gt_i32 s[58:59], 33, v1
v_cmp_gt_i32 s[60:61], 34, v1
v_cmp_gt_i32 s[62:63], 35, v1
v_cndmask_b32 v136, v136, v20, s[56:57]
v_cndmask_b32 v137, v137, v20, s[58:59]
v_cndmask_b32 v138, v138, v20, s[60:61]
v_cndmask_b32 v139, v139, v20, s[62:63]
v_cndmask_b32 v156, v156, v20, s[56:57]
v_cndmask_b32 v157, v157, v20, s[58:59]
v_cndmask_b32 v158, v158, v20, s[60:61]
v_cndmask_b32 v159, v159, v20, s[62:63]
v_cmp_gt_i32 s[56:57], 48, v1
v_cmp_gt_i32 s[58:59], 49, v1
v_cmp_gt_i32 s[60:61], 50, v1
v_cmp_gt_i32 s[62:63], 51, v1
v_cndmask_b32 v140, v140, v20, s[56:57]
v_cndmask_b32 v141, v141, v20, s[58:59]
v_cndmask_b32 v142, v142, v20, s[60:61]
v_cndmask_b32 v143, v143, v20, s[62:63]
s_nop 1
s_branch L_k2_mkr_no
L_k2_fb_fi:
s_nop 7
s_nop 0
v_max3_f32 v21, v192, v193, v194
v_max3_f32 v21, v21, v195, v196
v_max3_f32 v21, v21, v197, v198
v_max3_f32 v21, v21, v199, v200
v_max3_f32 v21, v21, v201, v202
v_max3_f32 v21, v21, v203, v204
v_max3_f32 v21, v21, v205, v206
v_max_f32 v21, v21, v207
v_mov_b32 v1, v21
s_nop 1
v_permlane16_swap_b32 v1, v21
v_max_f32 v21, v21, v1
v_mov_b32 v1, v21
s_nop 1
v_permlane32_swap_b32 v1, v21
v_max_f32_e64 v21, v21, v1
v_add_f32 v21, 0x41f80000, v21
v_max_f32 v21, 0, v21
Vs 192,192,21
Vs 193,193,21
Vs 194,194,21
Vs 195,195,21
Vs 196,196,21
Vs 197,197,21
Vs 198,198,21
Vs 199,199,21
Vs 200,200,21
Vs 201,201,21
Vs 202,202,21
Vs 203,203,21
Vs 204,204,21
Vs 205,205,21
Vs 206,206,21
Vs 207,207,21
Vs 32,32,21
Vs 33,33,21
Vs 34,34,21
v_sub_f32_e64 v35, v35, v21
v_exp_f32 v22, -v21
s_nop 0
Vm 48,48,22
Vm 49,49,22
Vm 50,50,22
v_mul_f32_e64 v51, v51, v22
Ar 8,0
Ar 9,1
Ar 10,2
Ar 11,3
Ar 12,4
Ar 13,5
Ar 14,6
Ar 15,7
Vm 8,8,22
Vm 9,9,22
Vm 10,10,22
Vm 11,11,22
Vm 12,12,22
Vm 13,13,22
Vm 14,14,22
Vm 15,15,22
Aw 0,8
Aw 1,9
Aw 2,10
Aw 3,11
Aw 4,12
Aw 5,13
Aw 6,14
Aw 7,15
Ar 8,8
Ar 9,9
Ar 10,10
Ar 11,11
Ar 12,12
Ar 13,13
Ar 14,14
Ar 15,15
Vm 8,8,22
Vm 9,9,22
Vm 10,10,22
Vm 11,11,22
Vm 12,12,22
Vm 13,13,22
Vm 14,14,22
Vm 15,15,22
Aw 8,8
Aw 9,9
Aw 10,10
Aw 11,11
Aw 12,12
Aw 13,13
Aw 14,14
Aw 15,15
Ar 8,16
Ar 9,17
Ar 10,18
Ar 11,19
Ar 12,20
Ar 13,21
Ar 14,22
Ar 15,23
Vm 8,8,22
Vm 9,9,22
Vm 10,10,22
Vm 11,11,22
Vm 12,12,22
Vm 13,13,22
Vm 14,14,22
Vm 15,15,22
Aw 16,8
Aw 17,9
Aw 18,10
Aw 19,11
Aw 20,12
Aw 21,13
Aw 22,14
Aw 23,15
Ar 8,24
Ar 9,25
Ar 10,26
Ar 11,27
Ar 12,28
Ar 13,29
Ar 14,30
Ar 15,31
Vm 8,8,22
Vm 9,9,22
Vm 10,10,22
Vm 11,11,22
Vm 12,12,22
Vm 13,13,22
Vm 14,14,22
Vm 15,15,22
Aw 24,8
Aw 25,9
Aw 26,10
Aw 27,11
Aw 28,12
Aw 29,13
Aw 30,14
Aw 31,15
v_max3_f32 v21, v208, v209, v210
v_max3_f32 v21, v21, v211, v212
v_max3_f32 v21, v21, v213, v214
v_max3_f32 v21, v21, v215, v216
v_max3_f32 v21, v21, v217, v218
v_max3_f32 v21, v21, v219, v220
v_max3_f32 v21, v21, v221, v222
v_max_f32 v21, v21, v223
v_mov_b32 v1, v21
s_nop 1
v_permlane16_swap_b32 v1, v21
v_max_f32 v21, v21, v1
v_mov_b32 v1, v21
s_nop 1
v_permlane32_swap_b32 v1, v21
v_max_f32_e64 v21, v21, v1
v_add_f32 v21, 0x41f80000, v21
v_max_f32 v21, 0, v21
Vs 208,208,21
Vs 209,209,21
Vs 210,210,21
Vs 211,211,21
Vs 212,212,21
Vs 213,213,21
Vs 214,214,21
Vs 215,215,21
Vs 216,216,21
Vs 217,217,21
Vs 218,218,21
Vs 219,219,21
Vs 220,220,21
Vs 221,221,21
Vs 222,222,21
Vs 223,223,21
Vs 36,36,21
Vs 37,37,21
Vs 38,38,21
v_sub_f32_e64 v39, v39, v21
v_exp_f32 v22, -v21
s_nop 0
Vm 52,52,22
Vm 53,53,22
Vm 54,54,22
v_mul_f32_e64 v55, v55, v22
Ar 8,32
Ar 9,33
Ar 10,34
Ar 11,35
Ar 12,36
Ar 13,37
Ar 14,38
Ar 15,39
Vm 8,8,22
Vm 9,9,22
Vm 10,10,22
Vm 11,11,22
Vm 12,12,22
Vm 13,13,22
Vm 14,14,22
Vm 15,15,22
Aw 32,8
Aw 33,9
Aw 34,10
Aw 35,11
Aw 36,12
Aw 37,13
Aw 38,14
Aw 39,15
Ar 8,40
Ar 9,41
Ar 10,42
Ar 11,43
Ar 12,44
Ar 13,45
Ar 14,46
Ar 15,47
Vm 8,8,22
Vm 9,9,22
Vm 10,10,22
Vm 11,11,22
Vm 12,12,22
Vm 13,13,22
Vm 14,14,22
Vm 15,15,22
Aw 40,8
Aw 41,9
Aw 42,10
Aw 43,11
Aw 44,12
Aw 45,13
Aw 46,14
Aw 47,15
Ar 8,48
Ar 9,49
Ar 10,50
Ar 11,51
Ar 12,52
Ar 13,53
Ar 14,54
Ar 15,55
Vm 8,8,22
Vm 9,9,22
Vm 10,10,22
Vm 11,11,22
Vm 12,12,22
Vm 13,13,22
Vm 14,14,22
Vm 15,15,22
Aw 48,8
Aw 49,9
Aw 50,10
Aw 51,11
Aw 52,12
Aw 53,13
Aw 54,14
Aw 55,15
Ar 8,56
Ar 9,57
Ar 10,58
Ar 11,59
Ar 12,60
Ar 13,61
Ar 14,62
Ar 15,63
Vm 8,8,22
Vm 9,9,22
Vm 10,10,22
Vm 11,11,22
Vm 12,12,22
Vm 13,13,22
Vm 14,14,22
Vm 15,15,22
Aw 56,8
Aw 57,9
Aw 58,10
Aw 59,11
Aw 60,12
Aw 61,13
Aw 62,14
Aw 63,15
Ve 8,192
Ve 9,193
s_nop 0
Vc 96,8,9
Ve 8,194
Ve 9,195
s_nop 0
Vc 97,8,9
Ve 8,208
Ve 9,209
s_nop 0
Vc 104,8,9
Ve 8,210
Ve 9,211
s_nop 0
Vc 105,8,9
Ve 8,196
Ve 9,197
s_nop 0
Vc 98,8,9
Ve 8,198
Ve 9,199
s_nop 0
Vc 99,8,9
Ve 8,212
Ve 9,213
s_nop 0
Vc 106,8,9
Ve 8,214
Ve 9,215
s_nop 0
Vc 107,8,9
Ve 8,200
Ve 9,201
s_nop 0
Vc 100,8,9
Ve 8,202
Ve 9,203
s_nop 0
Vc 101,8,9
Ve 8,216
Ve 9,217
s_nop 0
Vc 108,8,9
Ve 8,218
Ve 9,219
s_nop 0
Vc 109,8,9
Ve 8,204
Ve 9,205
s_nop 0
Vc 102,8,9
Ve 8,206
Ve 9,207
s_nop 0
Vc 103,8,9
Ve 8,220
Ve 9,221
s_nop 0
Vc 110,8,9
Ve 8,222
Ve 9,223
s_nop 0
Vc 111,8,9
s_nop 1
s_branch L_k2_fbr_fi
L_ysl:
s_mov_b32 s47, 0x400000
L_ysll:
buffer_load_dword v124, v127, s[20:23], s41 offen sc1
s_sub_u32 s47, s47, 1
s_waitcnt vmcnt(0)
s_cmp_eq_u32 s47, 0
s_cbranch_scc1 L_ysllx
v_cmp_ne_u32 vcc, 1, v124
s_cbranch_vccz L_ysllx
s_sleep 8
s_branch L_ysll
L_ysllx:
v_lshlrev_b32_e64 v125, 10, v123
v_lshl_add_u32 v125, v122, 5, v125
v_mov_b32 v124, 2146435072
v_cmp_gt_u32 vcc, 7, v123
s_nop 1
v_cndmask_b32 v125, v124, v125, vcc
s_nop 0
buffer_load_dwordx4 v[80:83], v125, s[20:23], s44 offen offset:0 sc1
buffer_load_dwordx4 v[84:87], v125, s[20:23], s44 offen offset:16 sc1
buffer_load_dwordx4 v[88:91], v125, s[20:23], s44 offen offset:256 sc1
buffer_load_dwordx4 v[92:95], v125, s[20:23], s44 offen offset:272 sc1
buffer_load_dwordx4 v[96:99], v125, s[20:23], s44 offen offset:512 sc1
buffer_load_dwordx4 v[100:103], v125, s[20:23], s44 offen offset:528 sc1
buffer_load_dwordx4 v[104:107], v125, s[20:23], s44 offen offset:768 sc1
buffer_load_dwordx4 v[108:111], v125, s[20:23], s44 offen offset:784 sc1
s_waitcnt vmcnt(0)
s_nop 0
v_pk_add_f32 v[80:81], v[80:81], v[96:97]
v_pk_add_f32 v[82:83], v[82:83], v[98:99]
v_pk_add_f32 v[84:85], v[84:85], v[100:101]
v_pk_add_f32 v[86:87], v[86:87], v[102:103]
v_pk_add_f32 v[88:89], v[88:89], v[104:105]
v_pk_add_f32 v[90:91], v[90:91], v[106:107]
v_pk_add_f32 v[92:93], v[92:93], v[108:109]
v_pk_add_f32 v[94:95], v[94:95], v[110:111]
v_add_f32_dpp v80, v80, v80 row_ror:8 row_mask:0xf bank_mask:0xf
v_add_f32_dpp v81, v81, v81 row_ror:8 row_mask:0xf bank_mask:0xf
v_add_f32_dpp v82, v82, v82 row_ror:8 row_mask:0xf bank_mask:0xf
v_add_f32_dpp v83, v83, v83 row_ror:8 row_mask:0xf bank_mask:0xf
v_add_f32_dpp v84, v84, v84 row_ror:8 row_mask:0xf bank_mask:0xf
v_add_f32_dpp v85, v85, v85 row_ror:8 row_mask:0xf bank_mask:0xf
v_add_f32_dpp v86, v86, v86 row_ror:8 row_mask:0xf bank_mask:0xf
v_add_f32_dpp v87, v87, v87 row_ror:8 row_mask:0xf bank_mask:0xf
v_add_f32_dpp v88, v88, v88 row_ror:8 row_mask:0xf bank_mask:0xf
v_add_f32_dpp v89, v89, v89 row_ror:8 row_mask:0xf bank_mask:0xf
v_add_f32_dpp v90, v90, v90 row_ror:8 row_mask:0xf bank_mask:0xf
v_add_f32_dpp v91, v91, v91 row_ror:8 row_mask:0xf bank_mask:0xf
v_add_f32_dpp v92, v92, v92 row_ror:8 row_mask:0xf bank_mask:0xf
v_add_f32_dpp v93, v93, v93 row_ror:8 row_mask:0xf bank_mask:0xf
v_add_f32_dpp v94, v94, v94 row_ror:8 row_mask:0xf bank_mask:0xf
v_add_f32_dpp v95, v95, v95 row_ror:8 row_mask:0xf bank_mask:0xf
v_mov_b32 v96, v80
v_mov_b32 v97, v81
v_mov_b32 v98, v82
v_mov_b32 v99, v83
v_mov_b32 v100, v84
v_mov_b32 v101, v85
v_mov_b32 v102, v86
v_mov_b32 v103, v87
v_mov_b32 v104, v88
v_mov_b32 v105, v89
v_mov_b32 v106, v90
v_mov_b32 v107, v91
v_mov_b32 v108, v92
v_mov_b32 v109, v93
v_mov_b32 v110, v94
v_mov_b32 v111, v95
v_permlane16_swap_b32 v96, v80
v_permlane16_swap_b32 v97, v81
v_permlane16_swap_b32 v98, v82
v_permlane16_swap_b32 v99, v83
v_permlane16_swap_b32 v100, v84
v_permlane16_swap_b32 v101, v85
v_permlane16_swap_b32 v102, v86
v_permlane16_swap_b32 v103, v87
v_permlane16_swap_b32 v104, v88
v_permlane16_swap_b32 v105, v89
v_permlane16_swap_b32 v106, v90
v_permlane16_swap_b32 v107, v91
v_permlane16_swap_b32 v108, v92
v_permlane16_swap_b32 v109, v93
v_permlane16_swap_b32 v110, v94
v_permlane16_swap_b32 v111, v95
Va 80,80,96
Va 81,81,97
Va 82,82,98
Va 83,83,99
Va 84,84,100
Va 85,85,101
Va 86,86,102
Va 87,87,103
Va 88,88,104
Va 89,89,105
Va 90,90,106
Va 91,91,107
Va 92,92,108
Va 93,93,109
Va 94,94,110
Va 95,95,111
v_mov_b32 v96, v80
v_mov_b32 v97, v81
v_mov_b32 v98, v82
v_mov_b32 v99, v83
v_mov_b32 v100, v84
v_mov_b32 v101, v85
v_mov_b32 v102, v86
v_mov_b32 v103, v87
v_mov_b32 v104, v88
v_mov_b32 v105, v89
v_mov_b32 v106, v90
v_mov_b32 v107, v91
v_mov_b32 v108, v92
v_mov_b32 v109, v93
v_mov_b32 v110, v94
v_mov_b32 v111, v95
v_permlane32_swap_b32 v96, v80
v_permlane32_swap_b32 v97, v81
v_permlane32_swap_b32 v98, v82
v_permlane32_swap_b32 v99, v83
v_permlane32_swap_b32 v100, v84
v_permlane32_swap_b32 v101, v85
v_permlane32_swap_b32 v102, v86
v_permlane32_swap_b32 v103, v87
v_permlane32_swap_b32 v104, v88
v_permlane32_swap_b32 v105, v89
v_permlane32_swap_b32 v106, v90
v_permlane32_swap_b32 v107, v91
v_permlane32_swap_b32 v108, v92
v_permlane32_swap_b32 v109, v93
v_permlane32_swap_b32 v110, v94
v_permlane32_swap_b32 v111, v95
Va 80,80,96
Va 81,81,97
Va 82,82,98
Va 83,83,99
Va 84,84,100
Va 85,85,101
Va 86,86,102
Va 87,87,103
Va 88,88,104
Va 89,89,105
Va 90,90,106
Va 91,91,107
Va 92,92,108
Va 93,93,109
Va 94,94,110
Va 95,95,111
Vc 124,80,81
v_lshlrev_b32_e64 v80, 16, v124
v_and_b32 v81, 0xffff0000, v124
Vc 124,82,83
v_lshlrev_b32_e64 v82, 16, v124
v_and_b32 v83, 0xffff0000, v124
Vc 124,84,85
v_lshlrev_b32_e64 v84, 16, v124
v_and_b32 v85, 0xffff0000, v124
Vc 124,86,87
v_lshlrev_b32_e64 v86, 16, v124
v_and_b32 v87, 0xffff0000, v124
Vc 124,88,89
v_lshlrev_b32_e64 v88, 16, v124
v_and_b32 v89, 0xffff0000, v124
Vc 124,90,91
v_lshlrev_b32_e64 v90, 16, v124
v_and_b32 v91, 0xffff0000, v124
Vc 124,92,93
v_lshlrev_b32_e64 v92, 16, v124
v_and_b32 v93, 0xffff0000, v124
Vc 124,94,95
v_lshlrev_b32_e64 v94, 16, v124
v_and_b32 v95, 0xffff0000, v124
v_mul_f32 v80, s100, v80
v_mul_f32 v81, s100, v81
v_mul_f32 v82, s100, v82
v_mul_f32 v83, s100, v83
v_mul_f32 v84, s100, v84
v_mul_f32 v85, s100, v85
v_mul_f32 v86, s100, v86
v_mul_f32 v87, s100, v87
v_mul_f32 v88, s101, v88
v_mul_f32 v89, s101, v89
v_mul_f32 v90, s101, v90
v_mul_f32 v91, s101, v91
v_mul_f32 v92, s101, v92
v_mul_f32 v93, s101, v93
v_mul_f32 v94, s101, v94
v_mul_f32 v95, s101, v95
Vc 124,80,81
v_lshlrev_b32_e64 v80, 16, v124
v_and_b32 v81, 0xffff0000, v124
Vc 124,82,83
v_lshlrev_b32_e64 v82, 16, v124
v_and_b32 v83, 0xffff0000, v124
Vc 124,84,85
v_lshlrev_b32_e64 v84, 16, v124
v_and_b32 v85, 0xffff0000, v124
Vc 124,86,87
v_lshlrev_b32_e64 v86, 16, v124
v_and_b32 v87, 0xffff0000, v124
Vc 124,88,89
v_lshlrev_b32_e64 v88, 16, v124
v_and_b32 v89, 0xffff0000, v124
Vc 124,90,91
v_lshlrev_b32_e64 v90, 16, v124
v_and_b32 v91, 0xffff0000, v124
Vc 124,92,93
v_lshlrev_b32_e64 v92, 16, v124
v_and_b32 v93, 0xffff0000, v124
Vc 124,94,95
v_lshlrev_b32_e64 v94, 16, v124
v_and_b32 v95, 0xffff0000, v124
s_lshl_b32 s3, s45, 7
s_sub_u32 s42, s42, s3
s_sub_u32 s43, s43, s3
v_add_u32 v124, 0, v120
v_cmp_eq_u32 vcc, s42, v124
v_cmp_eq_u32 s[6:7], s43, v124
s_nop 3
s_or_b64 s[4:5], vcc, s[6:7]
s_cbranch_scc0 L_f_selskip5
v_cndmask_b32 v96, 0, v80, vcc
v_cndmask_b32 v96, v96, v88, s[6:7]
v_cndmask_b32 v97, 0, v81, vcc
v_cndmask_b32 v97, v97, v89, s[6:7]
v_cndmask_b32 v98, 0, v82, vcc
v_cndmask_b32 v98, v98, v90, s[6:7]
v_cndmask_b32 v99, 0, v83, vcc
v_cndmask_b32 v99, v99, v91, s[6:7]
v_cndmask_b32 v100, 0, v84, vcc
v_cndmask_b32 v100, v100, v92, s[6:7]
v_cndmask_b32 v101, 0, v85, vcc
v_cndmask_b32 v101, v101, v93, s[6:7]
v_cndmask_b32 v102, 0, v86, vcc
v_cndmask_b32 v102, v102, v94, s[6:7]
v_cndmask_b32 v103, 0, v87, vcc
v_cndmask_b32 v103, v103, v95, s[6:7]
v_lshlrev_b32_e64 v42, 16, v18
v_and_b32 v43, 0xffff0000, v18
v_lshlrev_b32_e64 v44, 16, v19
v_and_b32 v45, 0xffff0000, v19
v_lshlrev_b32_e64 v46, 16, v20
v_and_b32 v47, 0xffff0000, v20
v_lshlrev_b32_e64 v48, 16, v21
v_and_b32 v49, 0xffff0000, v21
Vs 42,42,34
Vs 43,43,34
Vs 44,44,34
Vs 45,45,34
Vs 46,46,34
Vs 47,47,34
Vs 48,48,34
Vs 49,49,34
Vc 2,42,43
v_lshlrev_b32_e64 v42, 16, v2
v_and_b32 v43, 0xffff0000, v2
Vc 3,44,45
v_lshlrev_b32_e64 v44, 16, v3
v_and_b32 v45, 0xffff0000, v3
Vc 4,46,47
v_lshlrev_b32_e64 v46, 16, v4
v_and_b32 v47, 0xffff0000, v4
Vc 5,48,49
v_lshlrev_b32_e64 v48, 16, v5
v_and_b32 v49, 0xffff0000, v5
Vm 42,42,35
Vm 43,43,35
Vm 44,44,35
Vm 45,45,35
Vm 46,46,35
Vm 47,47,35
Vm 48,48,35
Vm 49,49,35
Vc 2,42,43
v_lshlrev_b32_e64 v42, 16, v2
v_and_b32 v43, 0xffff0000, v2
Vc 3,44,45
v_lshlrev_b32_e64 v44, 16, v3
v_and_b32 v45, 0xffff0000, v3
Vc 4,46,47
v_lshlrev_b32_e64 v46, 16, v4
v_and_b32 v47, 0xffff0000, v4
Vc 5,48,49
v_lshlrev_b32_e64 v48, 16, v5
v_and_b32 v49, 0xffff0000, v5
Va 42,42,96
Va 43,43,97
Va 44,44,98
Va 45,45,99
Va 46,46,100
Va 47,47,101
Va 48,48,102
Va 49,49,103
Vc 2,42,43
v_lshlrev_b32_e64 v42, 16, v2
v_and_b32 v43, 0xffff0000, v2
Vc 3,44,45
v_lshlrev_b32_e64 v44, 16, v3
v_and_b32 v45, 0xffff0000, v3
Vc 4,46,47
v_lshlrev_b32_e64 v46, 16, v4
v_and_b32 v47, 0xffff0000, v4
Vc 5,48,49
v_lshlrev_b32_e64 v48, 16, v5
v_and_b32 v49, 0xffff0000, v5
v_mul_f32 v2, 0xbfb8aa3b, v42
v_mul_f32 v3, 0xbfb8aa3b, v43
v_mul_f32 v4, 0xbfb8aa3b, v44
v_mul_f32 v5, 0xbfb8aa3b, v45
v_mul_f32 v6, 0xbfb8aa3b, v46
v_mul_f32 v7, 0xbfb8aa3b, v47
v_mul_f32 v8, 0xbfb8aa3b, v48
v_mul_f32 v9, 0xbfb8aa3b, v49
Ve 2,2
Ve 3,3
Ve 4,4
Ve 5,5
Ve 6,6
Ve 7,7
Ve 8,8
Ve 9,9
v_add_f32 v2, 1.0, v2
v_add_f32 v3, 1.0, v3
v_add_f32 v4, 1.0, v4
v_add_f32 v5, 1.0, v5
v_add_f32 v6, 1.0, v6
v_add_f32 v7, 1.0, v7
v_add_f32 v8, 1.0, v8
v_add_f32 v9, 1.0, v9
v_rcp_f32 v2, v2
v_rcp_f32 v3, v3
v_rcp_f32 v4, v4
v_rcp_f32 v5, v5
v_rcp_f32 v6, v6
v_rcp_f32 v7, v7
v_rcp_f32 v8, v8
v_rcp_f32 v9, v9
Vm 42,42,2
Vm 43,43,3
Vm 44,44,4
Vm 45,45,5
Vm 46,46,6
Vm 47,47,7
Vm 48,48,8
Vm 49,49,9
Vc 2,42,43
v_lshlrev_b32_e64 v42, 16, v2
v_and_b32 v43, 0xffff0000, v2
Vc 3,44,45
v_lshlrev_b32_e64 v44, 16, v3
v_and_b32 v45, 0xffff0000, v3
Vc 4,46,47
v_lshlrev_b32_e64 v46, 16, v4
v_and_b32 v47, 0xffff0000, v4
Vc 5,48,49
v_lshlrev_b32_e64 v48, 16, v5
v_and_b32 v49, 0xffff0000, v5
L_f_selskip5:
v_add_u32 v124, 32, v120
v_cmp_eq_u32 vcc, s42, v124
v_cmp_eq_u32 s[6:7], s43, v124
s_nop 3
s_or_b64 s[4:5], vcc, s[6:7]
s_cbranch_scc0 L_f_selskip6
v_cndmask_b32 v96, 0, v80, vcc
v_cndmask_b32 v96, v96, v88, s[6:7]
v_cndmask_b32 v97, 0, v81, vcc
v_cndmask_b32 v97, v97, v89, s[6:7]
v_cndmask_b32 v98, 0, v82, vcc
v_cndmask_b32 v98, v98, v90, s[6:7]
v_cndmask_b32 v99, 0, v83, vcc
v_cndmask_b32 v99, v99, v91, s[6:7]
v_cndmask_b32 v100, 0, v84, vcc
v_cndmask_b32 v100, v100, v92, s[6:7]
v_cndmask_b32 v101, 0, v85, vcc
v_cndmask_b32 v101, v101, v93, s[6:7]
v_cndmask_b32 v102, 0, v86, vcc
v_cndmask_b32 v102, v102, v94, s[6:7]
v_cndmask_b32 v103, 0, v87, vcc
v_cndmask_b32 v103, v103, v95, s[6:7]
v_lshlrev_b32 v50, 16, v22
v_and_b32 v51, 0xffff0000, v22
v_lshlrev_b32_e64 v52, 16, v23
v_and_b32 v53, 0xffff0000, v23
v_lshlrev_b32_e64 v54, 16, v24
v_and_b32 v55, 0xffff0000, v24
v_lshlrev_b32_e64 v56, 16, v25
v_and_b32 v57, 0xffff0000, v25
Vs 50,50,36
Vs 51,51,36
Vs 52,52,36
Vs 53,53,36
Vs 54,54,36
Vs 55,55,36
Vs 56,56,36
Vs 57,57,36
Vc 2,50,51
v_lshlrev_b32_e64 v50, 16, v2
v_and_b32 v51, 0xffff0000, v2
Vc 3,52,53
v_lshlrev_b32_e64 v52, 16, v3
v_and_b32 v53, 0xffff0000, v3
Vc 4,54,55
v_lshlrev_b32_e64 v54, 16, v4
v_and_b32 v55, 0xffff0000, v4
Vc 5,56,57
v_lshlrev_b32_e64 v56, 16, v5
v_and_b32 v57, 0xffff0000, v5
Vm 50,50,37
Vm 51,51,37
Vm 52,52,37
Vm 53,53,37
Vm 54,54,37
Vm 55,55,37
Vm 56,56,37
Vm 57,57,37
Vc 2,50,51
v_lshlrev_b32_e64 v50, 16, v2
v_and_b32 v51, 0xffff0000, v2
Vc 3,52,53
v_lshlrev_b32_e64 v52, 16, v3
v_and_b32 v53, 0xffff0000, v3
Vc 4,54,55
v_lshlrev_b32_e64 v54, 16, v4
v_and_b32 v55, 0xffff0000, v4
Vc 5,56,57
v_lshlrev_b32_e64 v56, 16, v5
v_and_b32 v57, 0xffff0000, v5
Va 50,50,96
Va 51,51,97
Va 52,52,98
Va 53,53,99
Va 54,54,100
Va 55,55,101
Va 56,56,102
Va 57,57,103
Vc 2,50,51
v_lshlrev_b32_e64 v50, 16, v2
v_and_b32 v51, 0xffff0000, v2
Vc 3,52,53
v_lshlrev_b32_e64 v52, 16, v3
v_and_b32 v53, 0xffff0000, v3
Vc 4,54,55
v_lshlrev_b32_e64 v54, 16, v4
v_and_b32 v55, 0xffff0000, v4
Vc 5,56,57
v_lshlrev_b32_e64 v56, 16, v5
v_and_b32 v57, 0xffff0000, v5
v_mul_f32 v2, 0xbfb8aa3b, v50
v_mul_f32 v3, 0xbfb8aa3b, v51
v_mul_f32 v4, 0xbfb8aa3b, v52
v_mul_f32 v5, 0xbfb8aa3b, v53
v_mul_f32 v6, 0xbfb8aa3b, v54
v_mul_f32 v7, 0xbfb8aa3b, v55
v_mul_f32 v8, 0xbfb8aa3b, v56
v_mul_f32 v9, 0xbfb8aa3b, v57
Ve 2,2
Ve 3,3
Ve 4,4
Ve 5,5
Ve 6,6
Ve 7,7
Ve 8,8
Ve 9,9
v_add_f32 v2, 1.0, v2
v_add_f32 v3, 1.0, v3
v_add_f32 v4, 1.0, v4
v_add_f32 v5, 1.0, v5
v_add_f32 v6, 1.0, v6
v_add_f32 v7, 1.0, v7
v_add_f32 v8, 1.0, v8
v_add_f32 v9, 1.0, v9
v_rcp_f32 v2, v2
v_rcp_f32 v3, v3
v_rcp_f32 v4, v4
v_rcp_f32 v5, v5
v_rcp_f32 v6, v6
v_rcp_f32 v7, v7
v_rcp_f32 v8, v8
v_rcp_f32 v9, v9
Vm 50,50,2
Vm 51,51,3
Vm 52,52,4
Vm 53,53,5
Vm 54,54,6
Vm 55,55,7
Vm 56,56,8
Vm 57,57,9
Vc 2,50,51
v_lshlrev_b32_e64 v50, 16, v2
v_and_b32 v51, 0xffff0000, v2
Vc 3,52,53
v_lshlrev_b32_e64 v52, 16, v3
v_and_b32 v53, 0xffff0000, v3
Vc 4,54,55
v_lshlrev_b32_e64 v54, 16, v4
v_and_b32 v55, 0xffff0000, v4
Vc 5,56,57
v_lshlrev_b32_e64 v56, 16, v5
v_and_b32 v57, 0xffff0000, v5
L_f_selskip6:
v_add_u32 v124, 64, v120
v_cmp_eq_u32 vcc, s42, v124
v_cmp_eq_u32 s[6:7], s43, v124
s_nop 3
s_or_b64 s[4:5], vcc, s[6:7]
s_cbranch_scc0 L_f_selskip7
v_cndmask_b32 v96, 0, v80, vcc
v_cndmask_b32 v96, v96, v88, s[6:7]
v_cndmask_b32 v97, 0, v81, vcc
v_cndmask_b32 v97, v97, v89, s[6:7]
v_cndmask_b32 v98, 0, v82, vcc
v_cndmask_b32 v98, v98, v90, s[6:7]
v_cndmask_b32 v99, 0, v83, vcc
v_cndmask_b32 v99, v99, v91, s[6:7]
v_cndmask_b32 v100, 0, v84, vcc
v_cndmask_b32 v100, v100, v92, s[6:7]
v_cndmask_b32 v101, 0, v85, vcc
v_cndmask_b32 v101, v101, v93, s[6:7]
v_cndmask_b32 v102, 0, v86, vcc
v_cndmask_b32 v102, v102, v94, s[6:7]
v_cndmask_b32 v103, 0, v87, vcc
v_cndmask_b32 v103, v103, v95, s[6:7]
v_lshlrev_b32 v58, 16, v26
v_and_b32 v59, 0xffff0000, v26
v_lshlrev_b32_e64 v60, 16, v27
v_and_b32 v61, 0xffff0000, v27
v_lshlrev_b32_e64 v62, 16, v28
v_and_b32 v63, 0xffff0000, v28
v_lshlrev_b32_e64 v64, 16, v29
v_and_b32 v65, 0xffff0000, v29
Vs 58,58,38
Vs 59,59,38
Vs 60,60,38
Vs 61,61,38
Vs 62,62,38
Vs 63,63,38
Vs 64,64,38
Vs 65,65,38
Vc 2,58,59
v_lshlrev_b32_e64 v58, 16, v2
v_and_b32 v59, 0xffff0000, v2
Vc 3,60,61
v_lshlrev_b32_e64 v60, 16, v3
v_and_b32 v61, 0xffff0000, v3
Vc 4,62,63
v_lshlrev_b32_e64 v62, 16, v4
v_and_b32 v63, 0xffff0000, v4
Vc 5,64,65
v_lshlrev_b32_e64 v64, 16, v5
v_and_b32 v65, 0xffff0000, v5
Vm 58,58,39
Vm 59,59,39
Vm 60,60,39
Vm 61,61,39
Vm 62,62,39
Vm 63,63,39
Vm 64,64,39
Vm 65,65,39
Vc 2,58,59
v_lshlrev_b32_e64 v58, 16, v2
v_and_b32 v59, 0xffff0000, v2
Vc 3,60,61
v_lshlrev_b32_e64 v60, 16, v3
v_and_b32 v61, 0xffff0000, v3
Vc 4,62,63
v_lshlrev_b32_e64 v62, 16, v4
v_and_b32 v63, 0xffff0000, v4
Vc 5,64,65
v_lshlrev_b32_e64 v64, 16, v5
v_and_b32 v65, 0xffff0000, v5
Va 58,58,96
Va 59,59,97
Va 60,60,98
Va 61,61,99
Va 62,62,100
Va 63,63,101
Va 64,64,102
Va 65,65,103
Vc 2,58,59
v_lshlrev_b32_e64 v58, 16, v2
v_and_b32 v59, 0xffff0000, v2
Vc 3,60,61
v_lshlrev_b32_e64 v60, 16, v3
v_and_b32 v61, 0xffff0000, v3
Vc 4,62,63
v_lshlrev_b32_e64 v62, 16, v4
v_and_b32 v63, 0xffff0000, v4
Vc 5,64,65
v_lshlrev_b32_e64 v64, 16, v5
v_and_b32 v65, 0xffff0000, v5
v_mul_f32 v2, 0xbfb8aa3b, v58
v_mul_f32 v3, 0xbfb8aa3b, v59
v_mul_f32 v4, 0xbfb8aa3b, v60
v_mul_f32 v5, 0xbfb8aa3b, v61
v_mul_f32 v6, 0xbfb8aa3b, v62
v_mul_f32 v7, 0xbfb8aa3b, v63
v_mul_f32 v8, 0xbfb8aa3b, v64
v_mul_f32 v9, 0xbfb8aa3b, v65
Ve 2,2
Ve 3,3
Ve 4,4
Ve 5,5
Ve 6,6
Ve 7,7
Ve 8,8
Ve 9,9
v_add_f32 v2, 1.0, v2
v_add_f32 v3, 1.0, v3
v_add_f32 v4, 1.0, v4
v_add_f32 v5, 1.0, v5
v_add_f32 v6, 1.0, v6
v_add_f32 v7, 1.0, v7
v_add_f32 v8, 1.0, v8
v_add_f32 v9, 1.0, v9
v_rcp_f32 v2, v2
v_rcp_f32 v3, v3
v_rcp_f32 v4, v4
v_rcp_f32 v5, v5
v_rcp_f32 v6, v6
v_rcp_f32 v7, v7
v_rcp_f32 v8, v8
v_rcp_f32 v9, v9
Vm 58,58,2
Vm 59,59,3
Vm 60,60,4
Vm 61,61,5
Vm 62,62,6
Vm 63,63,7
Vm 64,64,8
Vm 65,65,9
Vc 2,58,59
v_lshlrev_b32_e64 v58, 16, v2
v_and_b32 v59, 0xffff0000, v2
Vc 3,60,61
v_lshlrev_b32_e64 v60, 16, v3
v_and_b32 v61, 0xffff0000, v3
Vc 4,62,63
v_lshlrev_b32_e64 v62, 16, v4
v_and_b32 v63, 0xffff0000, v4
Vc 5,64,65
v_lshlrev_b32_e64 v64, 16, v5
v_and_b32 v65, 0xffff0000, v5
L_f_selskip7:
v_add_u32 v124, 96, v120
v_cmp_eq_u32 vcc, s42, v124
v_cmp_eq_u32 s[6:7], s43, v124
s_nop 3
s_or_b64 s[4:5], vcc, s[6:7]
s_cbranch_scc0 L_f_selskip8
v_cndmask_b32 v96, 0, v80, vcc
v_cndmask_b32 v96, v96, v88, s[6:7]
v_cndmask_b32 v97, 0, v81, vcc
v_cndmask_b32 v97, v97, v89, s[6:7]
v_cndmask_b32 v98, 0, v82, vcc
v_cndmask_b32 v98, v98, v90, s[6:7]
v_cndmask_b32 v99, 0, v83, vcc
v_cndmask_b32 v99, v99, v91, s[6:7]
v_cndmask_b32 v100, 0, v84, vcc
v_cndmask_b32 v100, v100, v92, s[6:7]
v_cndmask_b32 v101, 0, v85, vcc
v_cndmask_b32 v101, v101, v93, s[6:7]
v_cndmask_b32 v102, 0, v86, vcc
v_cndmask_b32 v102, v102, v94, s[6:7]
v_cndmask_b32 v103, 0, v87, vcc
v_cndmask_b32 v103, v103, v95, s[6:7]
v_lshlrev_b32_e64 v66, 16, v30
v_and_b32 v67, 0xffff0000, v30
v_lshlrev_b32_e64 v68, 16, v31
v_and_b32 v69, 0xffff0000, v31
v_lshlrev_b32_e64 v70, 16, v32
v_and_b32 v71, 0xffff0000, v32
v_lshlrev_b32_e64 v72, 16, v33
v_and_b32 v73, 0xffff0000, v33
Vs 66,66,40
Vs 67,67,40
Vs 68,68,40
Vs 69,69,40
Vs 70,70,40
Vs 71,71,40
Vs 72,72,40
Vs 73,73,40
Vc 2,66,67
v_lshlrev_b32_e64 v66, 16, v2
v_and_b32 v67, 0xffff0000, v2
Vc 3,68,69
v_lshlrev_b32_e64 v68, 16, v3
v_and_b32 v69, 0xffff0000, v3
Vc 4,70,71
v_lshlrev_b32_e64 v70, 16, v4
v_and_b32 v71, 0xffff0000, v4
Vc 5,72,73
v_lshlrev_b32_e64 v72, 16, v5
v_and_b32 v73, 0xffff0000, v5
Vm 66,66,41
Vm 67,67,41
Vm 68,68,41
Vm 69,69,41
Vm 70,70,41
Vm 71,71,41
Vm 72,72,41
Vm 73,73,41
Vc 2,66,67
v_lshlrev_b32_e64 v66, 16, v2
v_and_b32 v67, 0xffff0000, v2
Vc 3,68,69
v_lshlrev_b32_e64 v68, 16, v3
v_and_b32 v69, 0xffff0000, v3
Vc 4,70,71
v_lshlrev_b32_e64 v70, 16, v4
v_and_b32 v71, 0xffff0000, v4
Vc 5,72,73
v_lshlrev_b32_e64 v72, 16, v5
v_and_b32 v73, 0xffff0000, v5
Va 66,66,96
Va 67,67,97
Va 68,68,98
Va 69,69,99
Va 70,70,100
Va 71,71,101
Va 72,72,102
Va 73,73,103
Vc 2,66,67
v_lshlrev_b32_e64 v66, 16, v2
v_and_b32 v67, 0xffff0000, v2
Vc 3,68,69
v_lshlrev_b32_e64 v68, 16, v3
v_and_b32 v69, 0xffff0000, v3
Vc 4,70,71
v_lshlrev_b32_e64 v70, 16, v4
v_and_b32 v71, 0xffff0000, v4
Vc 5,72,73
v_lshlrev_b32_e64 v72, 16, v5
v_and_b32 v73, 0xffff0000, v5
v_mul_f32 v2, 0xbfb8aa3b, v66
v_mul_f32 v3, 0xbfb8aa3b, v67
v_mul_f32 v4, 0xbfb8aa3b, v68
v_mul_f32 v5, 0xbfb8aa3b, v69
v_mul_f32 v6, 0xbfb8aa3b, v70
v_mul_f32 v7, 0xbfb8aa3b, v71
v_mul_f32 v8, 0xbfb8aa3b, v72
v_mul_f32 v9, 0xbfb8aa3b, v73
Ve 2,2
Ve 3,3
Ve 4,4
Ve 5,5
Ve 6,6
Ve 7,7
Ve 8,8
Ve 9,9
v_add_f32 v2, 1.0, v2
v_add_f32 v3, 1.0, v3
v_add_f32 v4, 1.0, v4
v_add_f32 v5, 1.0, v5
v_add_f32 v6, 1.0, v6
v_add_f32 v7, 1.0, v7
v_add_f32 v8, 1.0, v8
v_add_f32 v9, 1.0, v9
v_rcp_f32 v2, v2
v_rcp_f32 v3, v3
v_rcp_f32 v4, v4
v_rcp_f32 v5, v5
v_rcp_f32 v6, v6
v_rcp_f32 v7, v7
v_rcp_f32 v8, v8
v_rcp_f32 v9, v9
Vm 66,66,2
Vm 67,67,3
Vm 68,68,4
Vm 69,69,5
Vm 70,70,6
Vm 71,71,7
Vm 72,72,8
Vm 73,73,9
Vc 2,66,67
v_lshlrev_b32_e64 v66, 16, v2
v_and_b32 v67, 0xffff0000, v2
Vc 3,68,69
v_lshlrev_b32_e64 v68, 16, v3
v_and_b32 v69, 0xffff0000, v3
Vc 4,70,71
v_lshlrev_b32_e64 v70, 16, v4
v_and_b32 v71, 0xffff0000, v4
Vc 5,72,73
v_lshlrev_b32_e64 v72, 16, v5
v_and_b32 v73, 0xffff0000, v5
L_f_selskip8:
s_branch L_yslr
.section .rodata,"a"
.p2align 6
.amdhsa_kernel recurrent_scan__compressed_kv_cla__moe_arch_mod__prompt_kernel
  .amdhsa_next_free_vgpr 512
  .amdhsa_next_free_sgpr 102
  .amdhsa_accum_offset 256
  .amdhsa_group_segment_fixed_size 0
  .amdhsa_kernarg_size 112
  .amdhsa_user_sgpr_count 2
  .amdhsa_user_sgpr_kernarg_segment_ptr 1
  .amdhsa_system_sgpr_workgroup_id_x 1
.end_amdhsa_kernel
```

```asm
; @launch grid=(256,1,1) block=(256,1,1) lds=148480
.amdgcn_target "amdgcn-amd-amdhsa--gfx950"
.macro Va d,x,y
v_add_f32 v\d, v\x, v\y
.endm
.macro Vc d,x,y
v_cvt_pk_bf16_f32 v\d, v\x, v\y
.endm
.macro Ta d,x,o
ds_read_b64_tr_b16 a[\d:\d+1], v\x offset:\o
.endm
.macro Ra d,x,o
ds_read_b128 a[\d:\d+3], v\x offset:\o
.endm
.macro Zvaa d,x,y
v_mfma_f32_16x16x32_bf16 v[\d:\d+3], a[\x:\x+3], a[\y:\y+3], 0
.endm
.macro Rv d,x,o
ds_read_b128 v[\d:\d+3], v\x offset:\o
.endm
.macro Zaaa d,x,y
v_mfma_f32_16x16x32_bf16 a[\d:\d+3], a[\x:\x+3], a[\y:\y+3], 0
.endm
.macro Mvaa d,x,y
v_mfma_f32_16x16x32_bf16 v[\d:\d+3], a[\x:\x+3], a[\y:\y+3], v[\d:\d+3]
.endm
.macro Maaa d,x,y
v_mfma_f32_16x16x32_bf16 a[\d:\d+3], a[\x:\x+3], a[\y:\y+3], a[\d:\d+3]
.endm
.macro Ar d,x
v_accvgpr_read_b32 v\d, a\x
.endm
.macro VE d,x
v_exp_f32_e64 v\d, v\x
.endm
.macro Aw d,x
v_accvgpr_write_b32 a\d, v\x
.endm
.macro Vs d,x,y
v_sub_f32 v\d, v\x, v\y
.endm
.macro Ve d,x
v_exp_f32 v\d, v\x
.endm
.macro Cvaa d,x,y,c
v_mfma_f32_16x16x32_bf16 v[\d:\d+3], a[\x:\x+3], a[\y:\y+3], v[\c:\c+3]
.endm
.macro Maav d,x,y
v_mfma_f32_16x16x32_bf16 a[\d:\d+3], a[\x:\x+3], v[\y:\y+3], a[\d:\d+3]
.endm
.macro Mvvv d,x,y
v_mfma_f32_16x16x32_bf16 v[\d:\d+3], v[\x:\x+3], v[\y:\y+3], v[\d:\d+3]
.endm
.macro Zvva d,x,y
v_mfma_f32_16x16x32_bf16 v[\d:\d+3], v[\x:\x+3], a[\y:\y+3], 0
.endm
.macro Mvva d,x,y
v_mfma_f32_16x16x32_bf16 v[\d:\d+3], v[\x:\x+3], a[\y:\y+3], v[\d:\d+3]
.endm
.macro Vm d,x,y
v_mul_f32 v\d, v\x, v\y
.endm
.macro Zvav d,x,y
v_mfma_f32_16x16x32_bf16 v[\d:\d+3], a[\x:\x+3], v[\y:\y+3], 0
.endm
.macro Mvav d,x,y
v_mfma_f32_16x16x32_bf16 v[\d:\d+3], a[\x:\x+3], v[\y:\y+3], v[\d:\d+3]
.endm
.text
.globl recurrent_scan__compressed_kv_cla__moe_arch_mod__prompt_kernel
.p2align 8
.type recurrent_scan__compressed_kv_cla__moe_arch_mod__prompt_kernel,@function
recurrent_scan__compressed_kv_cla__moe_arch_mod__prompt_kernel:
s_cmp_ge_u32 s2, 256
s_cbranch_scc1 L_k2_end
s_load_dwordx4 s[4:7], s[0:1], 0
s_load_dwordx2 s[44:45], s[0:1], 56
s_load_dwordx4 s[40:43], s[0:1], 24
s_load_dwordx4 s[64:67], s[0:1], 96
v_lshrrev_b32 v1, 6, v0
v_and_b32 v0, 63, v0
v_readfirstlane_b32 s32, v1
s_getpc_b64 s[68:69]
L_cpf1:
s_add_u32 s68, s68, (recurrent_scan__compressed_kv_cla__moe_arch_mod__prompt_kernel-L_cpf1)&0xffffffff
s_addc_u32 s69, s69, ((recurrent_scan__compressed_kv_cla__moe_arch_mod__prompt_kernel-L_cpf1)>>32)&0xffffffff
s_lshr_b32 s70, s2, 3
s_lshl_b32 s70, s70, 2
s_add_u32 s70, s70, s32
s_lshl_b32 s70, s70, 10
v_and_b32 v122, 7, v0
v_lshlrev_b32 v122, 7, v122
v_add_u32 v122, s70, v122
v_min_u32 v122, L_k2_fin-recurrent_scan__compressed_kv_cla__moe_arch_mod__prompt_kernel-4, v122
v_mov_b32 v121, s69
v_add_co_u32 v120, vcc, s68, v122
s_nop 1
v_addc_co_u32 v121, vcc, 0, v121, vcc
global_load_dword v124, v[120:121], off
v_lshrrev_b32 v33, 5, v0
v_and_b32 v31, 31, v0
v_lshlrev_b32_e64 v36, 4, v31
v_lshl_add_u32 v35, v33, 11, v36
s_lshl_b32 s36, s2, 14
s_lshl_b32 s37, s32, 12
s_add_u32 s36, s36, s37
s_mov_b32 s18, 4194304
s_mov_b32 s19, 0x20000
s_bfe_u32 s33, s2, 0x30003
s_lshr_b32 s35, s2, 7
s_bfe_u32 s3, s2, 0x10006
s_and_b32 s34, s2, 7
s_lshl_b32 s34, s34, 1
s_add_u32 s34, s34, s3
s_waitcnt lgkmcnt(0)
s_mov_b32 s16, s4
s_and_b32 s17, s5, 0xffff
buffer_load_dwordx4 v[48:51], v35, s[16:19], s36 offen offset:0 nt
buffer_load_dwordx4 v[52:55], v35, s[16:19], s36 offen offset:512 nt
buffer_load_dwordx4 v[56:59], v35, s[16:19], s36 offen offset:1024 nt
buffer_load_dwordx4 v[60:63], v35, s[16:19], s36 offen offset:1536 nt
s_cmp_eq_u32 s35, 0
s_cselect_b32 s40, s40, s42
s_cselect_b32 s41, s41, s43
s_lshl_b32 s3, s34, 9
s_add_u32 s12, s40, s3
s_addc_u32 s13, s41, 0
s_and_b32 s13, s13, 0xffff
s_mov_b32 s14, 0
s_mov_b32 s15, 0x20000
s_sub_u32 s14, 4194304, s3
s_lshl_b32 s3, s33, 18
s_add_u32 s8, s6, s3
s_addc_u32 s9, s7, 0
s_and_b32 s9, s9, 0xffff
s_mov_b32 s10, 262144
s_mov_b32 s11, 0x20000
s_and_b32 s58, s2, 7
s_mov_b32 s52, 0
s_mov_b32 s53, 15360
s_mov_b32 s54, 30720
s_mov_b32 s55, 46080
s_lshl_b32 s56, s32, 13
s_add_u32 s57, s56, 32768
s_lshl_b32 s3, s58, 2
s_add_u32 s3, s3, s32
s_lshl_b32 s3, s3, 4
v_add_u32 v30, s3, v33
v_lshlrev_b32 v30, 13, v30
v_lshlrev_b32 v34, 5, v33
v_xor_b32 v34, v34, v36
v_add_u32 v6, v34, v30
v_xor_b32_e64 v7, 64, v6
v_xor_b32 v8, 65664, v6
v_xor_b32 v9, 65728, v6
s_add_u32 m0, s57, 0
s_nop 0
buffer_load_dwordx4 v6, s[12:15], s52 offen offset:0 nt lds
buffer_load_dwordx4 v7, s[12:15], s53 offen offset:1024 nt lds
buffer_load_dwordx4 v6, s[12:15], s54 offen offset:2048 nt lds
buffer_load_dwordx4 v7, s[12:15], s55 offen offset:3072 nt lds
s_add_u32 m0, s57, 4096
s_nop 0
s_nop 0
buffer_load_dwordx4 v8, s[12:15], s52 offen offset:0 nt lds
buffer_load_dwordx4 v9, s[12:15], s53 offen offset:1024 nt lds
buffer_load_dwordx4 v8, s[12:15], s54 offen offset:2048 nt lds
buffer_load_dwordx4 v9, s[12:15], s55 offen offset:3072 nt lds
v_xor_b32 v6, 524288, v6
v_xor_b32 v7, 524288, v7
v_xor_b32 v8, 524288, v8
v_xor_b32 v9, 524288, v9
s_mov_b32 s48, 0
s_mov_b32 s49, 7168
s_mov_b32 s50, 14336
s_mov_b32 s51, 21504
v_lshrrev_b32 v30, 3, v0
v_lshlrev_b32 v30, 10, v30
s_lshl_b32 s3, s32, 16
s_lshl_b32 s39, s58, 7
s_add_u32 s3, s3, s39
v_and_b32 v31, 7, v0
v_lshrrev_b32 v32, 4, v0
v_xor_b32_e64 v31, v31, v32
v_lshl_add_u32 v30, v31, 4, v30
v_add_u32 v2, s3, v30
v_xor_b32 v3, 64, v2
v_xor_b32 v4, 32768, v2
v_xor_b32 v5, 32832, v2
s_cmp_lt_u32 s32, 2
s_cselect_b32 s60, s8, s12
s_cselect_b32 s61, s9, s13
s_cselect_b32 s62, s10, s14
s_mov_b32 s63, 0x20000
s_mov_b32 s59, 524288
s_cselect_b32 s59, 128, s59
s_cselect_b64 vcc, -1, 0
s_cselect_b32 s38, 32, 16
s_lshr_b32 s3, s2, 6
s_cmp_lt_u32 s32, 2
s_cselect_b32 s3, s3, s33
s_lshl_b32 s3, s3, 1
s_and_b32 s39, s32, 1
s_add_u32 s3, s3, s39
s_lshl_b32 s3, s3, 15
s_xor_b32 s39, s58, 1
s_mul_i32 s39, s39, s59
s_add_u32 s3, s3, s39
v_lshlrev_b32 v37, 10, v0
v_lshrrev_b32 v38, 2, v0
v_lshlrev_b32 v38, 13, v38
v_and_b32 v39, 3, v0
v_lshl_add_u32 v38, v39, 7, v38
v_cndmask_b32 v47, v38, v37, vcc
v_add_u32 v47, s3, v47
v_cmp_gt_u32 vcc, s38, v0
v_mov_b32 v37, 2146435072
s_nop 0
v_cndmask_b32 v47, v37, v47, vcc
s_mov_b32 s20, s66
s_and_b32 s21, s67, 0xffff
s_mov_b32 s22, 8388608
s_mov_b32 s23, 0x20000
s_add_u32 s24, s66, 8388608
s_addc_u32 s25, s67, 0
s_and_b32 s25, s25, 0xffff
s_mov_b32 s26, 35717120
s_mov_b32 s27, 0x20000
v_lshrrev_b32 v32, 4, v0
v_and_b32 v30, 15, v0
s_lshr_b32 s3, s32, 1
s_lshl_b32 s3, s3, 14
v_lshlrev_b32 v31, 7, v30
v_add_u32 v31, s3, v31
v_lshrrev_b32 v34, 1, v30
v_xor_b32_e64 v34, v34, v32
v_lshl_add_u32 v10, v34, 4, v31
v_xor_b32 v11, 64, v10
v_lshrrev_b32 v30, 2, v30
v_lshl_add_u32 v31, v32, 3, v30
v_lshlrev_b32 v31, 9, v31
v_and_b32 v34, 3, v0
v_lshl_add_u32 v31, v34, 3, v31
s_and_b32 s3, s32, 1
s_lshl_b32 s3, s3, 8
s_add_u32 s3, s3, 32768
v_add_u32 v31, s3, v31
v_and_b32 v34, 1, v32
v_lshl_add_u32 v30, v34, 2, v30
v_lshl_add_u32 v12, v30, 5, v31
v_xor_b32 v13, 32, v12
v_xor_b32 v14, 64, v12
v_xor_b32 v15, 96, v12
v_xor_b32 v16, 128, v12
v_xor_b32 v17, 160, v12
v_xor_b32 v18, 192, v12
v_xor_b32 v19, 224, v12
v_add_u32 v20, 65536, v10
v_add_u32 v21, 65536, v11
v_add_u32 v22, 65536, v12
v_add_u32 v23, 65536, v13
v_add_u32 v24, 65536, v14
v_add_u32 v25, 65536, v15
v_add_u32 v26, 65536, v16
v_add_u32 v27, 65536, v17
v_add_u32 v28, 65536, v18
v_add_u32 v29, 65536, v19
s_mov_b32 s28, s44
s_nop 0
s_and_b32 s29, s45, 0xffff
s_mov_b32 s30, 2048
s_mov_b32 s31, 0x20000
buffer_load_dwordx4 v[64:67], v36, s[28:31], 0 offen offset:0
buffer_load_dwordx4 v[68:71], v36, s[28:31], 0 offen offset:512
buffer_load_dwordx4 v[72:75], v36, s[28:31], 0 offen offset:1024
buffer_load_dwordx4 v[76:79], v36, s[28:31], 0 offen offset:1536
s_waitcnt vmcnt(12)
v_lshlrev_b32 v80, 16, v48
v_and_b32 v81, 0xffff0000, v48
v_lshlrev_b32_e64 v82, 16, v49
v_and_b32 v83, 0xffff0000, v49
v_lshlrev_b32_e64 v84, 16, v50
v_and_b32 v85, 0xffff0000, v50
v_lshlrev_b32_e64 v86, 16, v51
v_and_b32 v87, 0xffff0000, v51
v_lshlrev_b32_e64 v88, 16, v52
v_and_b32 v89, 0xffff0000, v52
v_lshlrev_b32_e64 v90, 16, v53
v_and_b32 v91, 0xffff0000, v53
v_lshlrev_b32_e64 v92, 16, v54
v_and_b32 v93, 0xffff0000, v54
v_lshlrev_b32_e64 v94, 16, v55
v_and_b32 v95, 0xffff0000, v55
v_lshlrev_b32_e64 v96, 16, v56
v_and_b32 v97, 0xffff0000, v56
v_lshlrev_b32_e64 v98, 16, v57
v_and_b32 v99, 0xffff0000, v57
v_lshlrev_b32_e64 v100, 16, v58
v_and_b32 v101, 0xffff0000, v58
v_lshlrev_b32_e64 v102, 16, v59
v_and_b32 v103, 0xffff0000, v59
v_lshlrev_b32_e64 v104, 16, v60
v_and_b32 v105, 0xffff0000, v60
v_lshlrev_b32_e64 v106, 16, v61
v_and_b32 v107, 0xffff0000, v61
v_lshlrev_b32_e64 v108, 16, v62
v_and_b32 v109, 0xffff0000, v62
v_lshlrev_b32_e64 v110, 16, v63
v_and_b32 v111, 0xffff0000, v63
v_pk_add_f32 v[40:41], v[80:81], v[82:83]
v_pk_add_f32 v[42:43], v[84:85], v[86:87]
v_pk_add_f32 v[40:41], v[40:41], v[88:89]
v_pk_add_f32 v[42:43], v[42:43], v[90:91]
v_pk_add_f32 v[40:41], v[40:41], v[92:93]
v_pk_add_f32 v[42:43], v[42:43], v[94:95]
v_pk_add_f32 v[40:41], v[40:41], v[96:97]
v_pk_add_f32 v[42:43], v[42:43], v[98:99]
v_pk_add_f32 v[40:41], v[40:41], v[100:101]
v_pk_add_f32 v[42:43], v[42:43], v[102:103]
v_pk_add_f32 v[40:41], v[40:41], v[104:105]
v_pk_add_f32 v[42:43], v[42:43], v[106:107]
v_pk_add_f32 v[40:41], v[40:41], v[108:109]
v_pk_add_f32 v[42:43], v[42:43], v[110:111]
v_pk_add_f32 v[40:41], v[40:41], v[42:43]
Va 38,40,41
s_nop 1
v_add_f32_dpp v38, v38, v38 quad_perm:[1,0,3,2] row_mask:0xf bank_mask:0xf
s_nop 1
v_add_f32_dpp v38, v38, v38 quad_perm:[2,3,0,1] row_mask:0xf bank_mask:0xf
s_nop 1
v_add_f32_dpp v38, v38, v38 row_half_mirror row_mask:0xf bank_mask:0xf
s_nop 1
v_add_f32_dpp v38, v38, v38 row_mirror row_mask:0xf bank_mask:0xf
v_mov_b32 v37, v38
s_nop 1
v_permlane16_swap_b32 v37, v38
Va 38,38,37
s_add_u32 m0, s56, 0
s_nop 0
buffer_load_dwordx4 v2, s[8:11], s48 offen offset:0 lds
buffer_load_dwordx4 v3, s[8:11], s49 offen offset:1024 lds
buffer_load_dwordx4 v2, s[8:11], s50 offen offset:2048 lds
buffer_load_dwordx4 v3, s[8:11], s51 offen offset:3072 lds
s_add_u32 m0, s56, 4096
s_nop 0
buffer_load_dwordx4 v4, s[8:11], s48 offen offset:0 lds
buffer_load_dwordx4 v5, s[8:11], s49 offen offset:1024 lds
buffer_load_dwordx4 v4, s[8:11], s50 offen offset:2048 lds
buffer_load_dwordx4 v5, s[8:11], s51 offen offset:3072 lds
v_xor_b32 v2, 128, v2
v_xor_b32 v3, 128, v3
v_xor_b32 v4, 128, v4
v_xor_b32 v5, 128, v5
buffer_load_dword v1, v47, s[60:63], 0 offen
s_mul_i32 vcc_lo, s59, 3
v_xor_b32 v47, vcc_lo, v47
v_mul_f32 v38, 0xba800000, v38
v_mov_b32_e64 v39, v38
v_pk_add_f32 v[112:113], v[80:81], v[38:39]
v_pk_mul_f32 v[40:41], v[112:113], v[112:113]
v_pk_add_f32 v[114:115], v[82:83], v[38:39]
v_pk_mul_f32 v[42:43], v[114:115], v[114:115]
v_pk_add_f32 v[116:117], v[84:85], v[38:39]
v_pk_fma_f32 v[40:41], v[116:117], v[116:117], v[40:41]
v_pk_add_f32 v[118:119], v[86:87], v[38:39]
v_pk_fma_f32 v[42:43], v[118:119], v[118:119], v[42:43]
v_pk_add_f32 v[112:113], v[88:89], v[38:39]
v_pk_fma_f32 v[40:41], v[112:113], v[112:113], v[40:41]
v_pk_add_f32 v[114:115], v[90:91], v[38:39]
v_pk_fma_f32 v[42:43], v[114:115], v[114:115], v[42:43]
v_pk_add_f32 v[116:117], v[92:93], v[38:39]
v_pk_fma_f32 v[40:41], v[116:117], v[116:117], v[40:41]
v_pk_add_f32 v[118:119], v[94:95], v[38:39]
v_pk_fma_f32 v[42:43], v[118:119], v[118:119], v[42:43]
v_pk_add_f32 v[112:113], v[96:97], v[38:39]
v_pk_fma_f32 v[40:41], v[112:113], v[112:113], v[40:41]
v_pk_add_f32 v[114:115], v[98:99], v[38:39]
v_pk_fma_f32 v[42:43], v[114:115], v[114:115], v[42:43]
v_pk_add_f32 v[116:117], v[100:101], v[38:39]
v_pk_fma_f32 v[40:41], v[116:117], v[116:117], v[40:41]
v_pk_add_f32 v[118:119], v[102:103], v[38:39]
v_pk_fma_f32 v[42:43], v[118:119], v[118:119], v[42:43]
v_pk_add_f32 v[112:113], v[104:105], v[38:39]
v_pk_fma_f32 v[40:41], v[112:113], v[112:113], v[40:41]
v_pk_add_f32 v[114:115], v[106:107], v[38:39]
v_pk_fma_f32 v[42:43], v[114:115], v[114:115], v[42:43]
v_pk_add_f32 v[116:117], v[108:109], v[38:39]
v_pk_fma_f32 v[40:41], v[116:117], v[116:117], v[40:41]
v_pk_add_f32 v[118:119], v[110:111], v[38:39]
v_pk_fma_f32 v[42:43], v[118:119], v[118:119], v[42:43]
v_pk_add_f32 v[40:41], v[40:41], v[42:43]
Va 40,40,41
s_nop 1
v_add_f32_dpp v40, v40, v40 quad_perm:[1,0,3,2] row_mask:0xf bank_mask:0xf
s_nop 1
v_add_f32_dpp v40, v40, v40 quad_perm:[2,3,0,1] row_mask:0xf bank_mask:0xf
s_nop 1
v_add_f32_dpp v40, v40, v40 row_half_mirror row_mask:0xf bank_mask:0xf
s_nop 1
v_add_f32_dpp v40, v40, v40 row_mirror row_mask:0xf bank_mask:0xf
v_mov_b32 v37, v40
s_nop 1
v_permlane16_swap_b32 v37, v40
v_add_f32_e64 v40, v40, v37
buffer_load_dword v1, v47, s[60:63], 0 offen
s_mul_i32 vcc_lo, s59, 1
v_xor_b32 v47, vcc_lo, v47
v_mul_f32 v40, 0x3a800000, v40
Vc 44,38,40
v_lshlrev_b32_e64 v38, 16, v44
v_and_b32 v40, 0xffff0000, v44
v_add_f32 v40, 0x3727c5ac, v40
Vc 44,40,40
v_lshlrev_b32 v40, 16, v44
v_sqrt_f32 v40, v40
v_mov_b32_e64 v39, v38
Vc 44,40,40
v_lshlrev_b32 v44, 16, v44
v_rcp_f32 v40, v44
v_pk_add_f32 v[80:81], v[80:81], v[38:39]
v_pk_add_f32 v[82:83], v[82:83], v[38:39]
v_pk_add_f32 v[84:85], v[84:85], v[38:39]
v_pk_add_f32 v[86:87], v[86:87], v[38:39]
v_pk_add_f32 v[88:89], v[88:89], v[38:39]
v_pk_add_f32 v[90:91], v[90:91], v[38:39]
v_pk_add_f32 v[92:93], v[92:93], v[38:39]
v_pk_add_f32 v[94:95], v[94:95], v[38:39]
v_pk_add_f32 v[96:97], v[96:97], v[38:39]
v_pk_add_f32 v[98:99], v[98:99], v[38:39]
v_pk_add_f32 v[100:101], v[100:101], v[38:39]
v_pk_add_f32 v[102:103], v[102:103], v[38:39]
v_pk_add_f32 v[104:105], v[104:105], v[38:39]
v_pk_add_f32 v[106:107], v[106:107], v[38:39]
v_pk_add_f32 v[108:109], v[108:109], v[38:39]
v_pk_add_f32 v[110:111], v[110:111], v[38:39]
v_fma_f32 v45, -v44, v40, 1.0
v_fma_f32 v40, v45, v40, v40
v_mov_b32_e64 v41, v40
Vc 48,80,81
Vc 49,82,83
Vc 50,84,85
Vc 51,86,87
Vc 52,88,89
Vc 53,90,91
Vc 54,92,93
Vc 55,94,95
Vc 56,96,97
Vc 57,98,99
Vc 58,100,101
Vc 59,102,103
Vc 60,104,105
Vc 61,106,107
Vc 62,108,109
Vc 63,110,111
v_lshlrev_b32_e64 v80, 16, v48
v_and_b32 v81, 0xffff0000, v48
v_lshlrev_b32_e64 v82, 16, v49
v_and_b32 v83, 0xffff0000, v49
v_lshlrev_b32_e64 v84, 16, v50
v_and_b32 v85, 0xffff0000, v50
v_lshlrev_b32_e64 v86, 16, v51
v_and_b32 v87, 0xffff0000, v51
v_lshlrev_b32_e64 v88, 16, v52
v_and_b32 v89, 0xffff0000, v52
v_lshlrev_b32_e64 v90, 16, v53
v_and_b32 v91, 0xffff0000, v53
v_lshlrev_b32_e64 v92, 16, v54
v_and_b32 v93, 0xffff0000, v54
v_lshlrev_b32_e64 v94, 16, v55
v_and_b32 v95, 0xffff0000, v55
v_lshlrev_b32_e64 v96, 16, v56
v_and_b32 v97, 0xffff0000, v56
v_lshlrev_b32_e64 v98, 16, v57
v_and_b32 v99, 0xffff0000, v57
v_lshlrev_b32_e64 v100, 16, v58
v_and_b32 v101, 0xffff0000, v58
v_lshlrev_b32_e64 v102, 16, v59
v_and_b32 v103, 0xffff0000, v59
v_lshlrev_b32_e64 v104, 16, v60
v_and_b32 v105, 0xffff0000, v60
v_lshlrev_b32_e64 v106, 16, v61
v_and_b32 v107, 0xffff0000, v61
v_lshlrev_b32_e64 v108, 16, v62
v_and_b32 v109, 0xffff0000, v62
v_lshlrev_b32_e64 v110, 16, v63
v_and_b32 v111, 0xffff0000, v63
v_pk_mul_f32 v[80:81], v[80:81], v[40:41]
v_pk_mul_f32 v[82:83], v[82:83], v[40:41]
v_pk_mul_f32 v[84:85], v[84:85], v[40:41]
v_pk_mul_f32 v[86:87], v[86:87], v[40:41]
v_pk_mul_f32 v[88:89], v[88:89], v[40:41]
v_pk_mul_f32 v[90:91], v[90:91], v[40:41]
v_pk_mul_f32 v[92:93], v[92:93], v[40:41]
v_pk_mul_f32 v[94:95], v[94:95], v[40:41]
v_pk_mul_f32 v[96:97], v[96:97], v[40:41]
v_pk_mul_f32 v[98:99], v[98:99], v[40:41]
v_pk_mul_f32 v[100:101], v[100:101], v[40:41]
v_pk_mul_f32 v[102:103], v[102:103], v[40:41]
v_pk_mul_f32 v[104:105], v[104:105], v[40:41]
v_pk_mul_f32 v[106:107], v[106:107], v[40:41]
v_pk_mul_f32 v[108:109], v[108:109], v[40:41]
v_pk_mul_f32 v[110:111], v[110:111], v[40:41]
Vc 48,80,81
Vc 49,82,83
Vc 50,84,85
Vc 51,86,87
Vc 52,88,89
Vc 53,90,91
Vc 54,92,93
Vc 55,94,95
Vc 56,96,97
Vc 57,98,99
Vc 58,100,101
Vc 59,102,103
Vc 60,104,105
Vc 61,106,107
Vc 62,108,109
Vc 63,110,111
s_mul_i32 s3, s32, 4128
s_add_u32 s3, s3, 131072
v_mul_u32_u24 v42, 2064, v33
v_add3_u32 v42, v42, v36, s3
ds_write_b128 v42, v[48:51] offset:0
ds_write_b128 v42, v[52:55] offset:512
ds_write_b128 v42, v[56:59] offset:1024
ds_write_b128 v42, v[60:63] offset:1536
s_waitcnt vmcnt(10)
v_lshlrev_b32 v80, 16, v48
v_and_b32 v81, 0xffff0000, v48
v_lshlrev_b32_e64 v112, 16, v64
v_and_b32 v113, 0xffff0000, v64
v_pk_mul_f32 v[42:43], v[80:81], v[112:113]
v_lshlrev_b32_e64 v82, 16, v49
v_and_b32 v83, 0xffff0000, v49
v_lshlrev_b32_e64 v114, 16, v65
v_and_b32 v115, 0xffff0000, v65
v_pk_mul_f32 v[44:45], v[82:83], v[114:115]
v_lshlrev_b32_e64 v84, 16, v50
v_and_b32 v85, 0xffff0000, v50
v_lshlrev_b32_e64 v116, 16, v66
v_and_b32 v117, 0xffff0000, v66
v_pk_fma_f32 v[42:43], v[84:85], v[116:117], v[42:43]
v_lshlrev_b32_e64 v86, 16, v51
v_and_b32 v87, 0xffff0000, v51
v_lshlrev_b32_e64 v118, 16, v67
v_and_b32 v119, 0xffff0000, v67
v_pk_fma_f32 v[44:45], v[86:87], v[118:119], v[44:45]
v_lshlrev_b32_e64 v88, 16, v52
v_and_b32 v89, 0xffff0000, v52
v_lshlrev_b32_e64 v112, 16, v68
v_and_b32 v113, 0xffff0000, v68
v_pk_fma_f32 v[42:43], v[88:89], v[112:113], v[42:43]
v_lshlrev_b32_e64 v90, 16, v53
v_and_b32 v91, 0xffff0000, v53
v_lshlrev_b32_e64 v114, 16, v69
v_and_b32 v115, 0xffff0000, v69
v_pk_fma_f32 v[44:45], v[90:91], v[114:115], v[44:45]
v_lshlrev_b32_e64 v92, 16, v54
v_and_b32 v93, 0xffff0000, v54
v_lshlrev_b32_e64 v116, 16, v70
v_and_b32 v117, 0xffff0000, v70
v_pk_fma_f32 v[42:43], v[92:93], v[116:117], v[42:43]
v_lshlrev_b32_e64 v94, 16, v55
v_and_b32 v95, 0xffff0000, v55
v_lshlrev_b32_e64 v118, 16, v71
v_and_b32 v119, 0xffff0000, v71
v_pk_fma_f32 v[44:45], v[94:95], v[118:119], v[44:45]
v_lshlrev_b32_e64 v96, 16, v56
v_and_b32 v97, 0xffff0000, v56
v_lshlrev_b32_e64 v112, 16, v72
v_and_b32 v113, 0xffff0000, v72
v_pk_fma_f32 v[42:43], v[96:97], v[112:113], v[42:43]
v_lshlrev_b32_e64 v98, 16, v57
v_and_b32 v99, 0xffff0000, v57
v_lshlrev_b32_e64 v114, 16, v73
v_and_b32 v115, 0xffff0000, v73
v_pk_fma_f32 v[44:45], v[98:99], v[114:115], v[44:45]
v_lshlrev_b32_e64 v100, 16, v58
v_and_b32 v101, 0xffff0000, v58
v_lshlrev_b32_e64 v116, 16, v74
v_and_b32 v117, 0xffff0000, v74
v_pk_fma_f32 v[42:43], v[100:101], v[116:117], v[42:43]
v_lshlrev_b32_e64 v102, 16, v59
v_and_b32 v103, 0xffff0000, v59
v_lshlrev_b32_e64 v118, 16, v75
v_and_b32 v119, 0xffff0000, v75
v_pk_fma_f32 v[44:45], v[102:103], v[118:119], v[44:45]
v_lshlrev_b32_e64 v104, 16, v60
v_and_b32 v105, 0xffff0000, v60
v_lshlrev_b32_e64 v112, 16, v76
v_and_b32 v113, 0xffff0000, v76
v_pk_fma_f32 v[42:43], v[104:105], v[112:113], v[42:43]
v_lshlrev_b32_e64 v106, 16, v61
v_and_b32 v107, 0xffff0000, v61
v_lshlrev_b32_e64 v114, 16, v77
v_and_b32 v115, 0xffff0000, v77
v_pk_fma_f32 v[44:45], v[106:107], v[114:115], v[44:45]
v_lshlrev_b32_e64 v108, 16, v62
v_and_b32 v109, 0xffff0000, v62
v_lshlrev_b32_e64 v116, 16, v78
v_and_b32 v117, 0xffff0000, v78
v_pk_fma_f32 v[42:43], v[108:109], v[116:117], v[42:43]
v_lshlrev_b32_e64 v110, 16, v63
v_and_b32 v111, 0xffff0000, v63
v_lshlrev_b32_e64 v118, 16, v79
v_and_b32 v119, 0xffff0000, v79
v_pk_fma_f32 v[44:45], v[110:111], v[118:119], v[44:45]
v_pk_add_f32 v[42:43], v[42:43], v[44:45]
Va 45,42,43
s_nop 1
v_add_f32_dpp v45, v45, v45 quad_perm:[1,0,3,2] row_mask:0xf bank_mask:0xf
s_nop 1
v_add_f32_dpp v45, v45, v45 quad_perm:[2,3,0,1] row_mask:0xf bank_mask:0xf
s_nop 1
v_add_f32_dpp v45, v45, v45 row_half_mirror row_mask:0xf bank_mask:0xf
s_nop 1
v_add_f32_dpp v45, v45, v45 row_mirror row_mask:0xf bank_mask:0xf
v_mov_b32 v37, v45
s_nop 1
v_permlane16_swap_b32 v37, v45
v_add_f32_e64 v45, v45, v37
Vc 45,45,45
v_ashrrev_i32_e64 v46, 31, v45
v_or_b32 v46, 0x80000000, v46
v_xor_b32_e64 v45, v45, v46
v_and_b32 v45, 0xffff0000, v45
s_lshr_b32 s3, s36, 11
v_add_u32 v46, s3, v33
v_sub_u32 v44, 0xffff, v46
v_or_b32 v45, v45, v44
v_lshlrev_b32 v44, 2, v46
v_lshlrev_b32_e64 v46, 3, v46
v_xor_b32 v38, 0x80000000, v38
v_mov_b32_e64 v39, v40
s_mov_b32 s3, 5242880
s_mov_b32 s39, 5259264
s_mov_b32 exec_lo, 1
s_mov_b32 exec_hi, 1
buffer_store_dword v45, v44, s[20:23], s3 offen sc1
buffer_store_dwordx2 v[38:39], v46, s[20:23], s39 offen sc1
s_mov_b64 exec, -1
s_load_dwordx2 s[4:5], s[0:1], 16
s_load_dwordx4 s[40:43], s[0:1], 64
s_load_dwordx2 s[92:93], s[0:1], 40
s_load_dwordx2 s[94:95], s[0:1], 80
s_load_dwordx2 s[100:101], s[0:1], 0
s_mov_b32 s28, s64
s_and_b32 s29, s65, 0xffff
s_mov_b32 s30, 256
s_mov_b32 s31, 0x20000
s_waitcnt vmcnt(4)
s_waitcnt lgkmcnt(0)
s_barrier
s_nop 0
Ta 32,12,0
Ta 34,12,2048
Ra 0,10,0
Ta 36,13,0
Ta 38,13,2048
Ra 4,10,2048
Ta 40,14,0
Ta 42,14,2048
Ra 8,10,4096
Ta 44,15,0
Ta 46,15,2048
Ra 12,10,6144
s_waitcnt lgkmcnt(2)
s_nop 0
Ta 48,16,0
Ta 50,16,2048
Ra 16,10,8192
Ta 52,17,0
Ta 54,17,2048
Ra 20,10,10240
Ta 56,18,0
Ta 58,18,2048
Ra 24,10,12288
Ta 60,19,0
Ta 62,19,2048
Ra 28,10,14336
s_cmp_lg_u32 s35, 0
s_cbranch_scc1 L_k1_vpath
s_waitcnt lgkmcnt(0)
s_add_u32 m0, s57, 65536
Zvaa 48,32,0
buffer_load_dwordx4 v6, s[12:15], s52 offen offset:0 nt lds
Zvaa 52,36,0
Ta 96,12,16384
Ta 98,12,18432
Zvaa 56,40,0
buffer_load_dwordx4 v7, s[12:15], s53 offen offset:1024 nt lds
Zvaa 60,44,0
Ra 64,11,0
Zvaa 64,48,0
buffer_load_dwordx4 v6, s[12:15], s54 offen offset:2048 nt lds
Zvaa 68,52,0
Ta 100,13,16384
Ta 102,13,18432
Zvaa 72,56,0
buffer_load_dwordx4 v7, s[12:15], s55 offen offset:3072 nt lds
Zvaa 76,60,0
s_add_u32 m0, s57, 69632
s_waitcnt lgkmcnt(6)
Ra 68,11,2048
Zvaa 80,32,4
buffer_load_dwordx4 v8, s[12:15], s52 offen offset:0 nt lds
Zvaa 84,36,4
Ta 104,14,16384
Ta 106,14,18432
Zvaa 88,40,4
buffer_load_dwordx4 v9, s[12:15], s53 offen offset:1024 nt lds
Zvaa 92,44,4
Ra 72,11,4096
Zvaa 96,48,4
buffer_load_dwordx4 v8, s[12:15], s54 offen offset:2048 nt lds
Zvaa 100,52,4
Ta 108,15,16384
Ta 110,15,18432
Zvaa 104,56,4
buffer_load_dwordx4 v9, s[12:15], s55 offen offset:3072 nt lds
Zvaa 108,60,4
s_add_u32 m0, s56, 65536
s_waitcnt lgkmcnt(6)
Ra 76,11,6144
Zvaa 112,32,8
buffer_load_dwordx4 v2, s[8:11], s48 offen offset:0 lds
Zvaa 116,36,8
Ta 112,16,16384
Ta 114,16,18432
Zvaa 120,40,8
buffer_load_dwordx4 v3, s[8:11], s49 offen offset:1024 lds
Zvaa 124,44,8
Ra 80,11,8192
v_xor_b32 v6, 1572864, v6
Zvaa 128,48,8
buffer_load_dwordx4 v2, s[8:11], s50 offen offset:2048 lds
Zvaa 132,52,8
Ta 116,17,16384
Ta 118,17,18432
Zvaa 136,56,8
buffer_load_dwordx4 v3, s[8:11], s51 offen offset:3072 lds
Zvaa 140,60,8
s_add_u32 m0, s56, 69632
s_waitcnt lgkmcnt(6)
Ra 84,11,10240
Zvaa 144,32,12
buffer_load_dwordx4 v4, s[8:11], s48 offen offset:0 lds
Zvaa 148,36,12
Ta 120,18,16384
Ta 122,18,18432
Zvaa 152,40,12
buffer_load_dwordx4 v5, s[8:11], s49 offen offset:1024 lds
Zvaa 156,44,12
Ra 88,11,12288
v_xor_b32 v7, 1572864, v7
Zvaa 160,48,12
buffer_load_dwordx4 v4, s[8:11], s50 offen offset:2048 lds
Zvaa 164,52,12
Ta 124,19,16384
Ta 126,19,18432
Zvaa 168,56,12
buffer_load_dwordx4 v5, s[8:11], s51 offen offset:3072 lds
Zvaa 172,60,12
s_waitcnt lgkmcnt(6)
Ra 92,11,14336
Zvaa 176,32,16
v_and_b32 v46, 7, v0
v_mul_u32_u24 v30, 2064, v46
Zvaa 180,36,16
v_xor_b32 v8, 1572864, v8
v_xor_b32 v9, 1572864, v9
Zvaa 184,40,16
v_lshrrev_b32_e64 v31, 3, v0
Zvaa 188,44,16
v_xor_b32 v2, 384, v2
v_xor_b32 v3, 384, v3
Zvaa 192,48,16
s_lshl_b32 s3, s32, 9
s_add_u32 s3, s3, 131072
v_lshl_add_u32 v30, v31, 4, v30
Zvaa 196,52,16
v_xor_b32 v4, 384, v4
v_xor_b32 v5, 384, v5
Zvaa 200,56,16
v_add_u32 v30, s3, v30
v_lshlrev_b32_e64 v31, 8, v31
Zvaa 204,60,16
v_lshl_add_u32 v46, v46, 4, v31
Zvaa 208,32,20
buffer_load_dword v1, v47, s[60:63], 0 offen
Zvaa 212,36,20
s_mul_i32 vcc_lo, s59, 7
v_xor_b32 v47, vcc_lo, v47
Zvaa 216,40,20
Rv 34,30,128
Rv 38,30,256
Zvaa 220,44,20
Rv 42,30,384
Rv 30,30,0
Zvaa 224,48,20
buffer_load_dword v1, v47, s[60:63], 0 offen
Zvaa 228,52,20
s_mul_i32 vcc_lo, s59, 1
v_xor_b32 v47, vcc_lo, v47
Zvaa 232,56,20
s_lshr_b32 s3, s2, 1
s_mul_i32 s3, s3, 33792
s_add_u32 s3, s3, s56
Zvaa 236,60,20
s_and_b32 s39, s2, 1
s_lshl_b32 s39, s39, 7
s_add_u32 s3, s3, s39
Zvaa 240,32,24
s_add_u32 s39, s3, 4096
Zvaa 244,36,24
Zvaa 248,40,24
Zvaa 252,44,24
Zaaa 128,48,24
Zaaa 132,52,24
Zaaa 136,56,24
Zaaa 140,60,24
Zaaa 144,32,28
Zaaa 148,36,28
Zaaa 152,40,28
Zaaa 156,44,28
Zaaa 160,48,28
Zaaa 164,52,28
Zaaa 168,56,28
Zaaa 172,60,28
s_waitcnt vmcnt(2) lgkmcnt(0)
s_add_u32 m0, s57, 0
s_barrier
Mvaa 48,96,64
buffer_load_dwordx4 v6, s[12:15], s52 offen offset:0 nt lds
Mvaa 52,100,64
Ta 32,22,0
Ta 34,22,2048
Mvaa 56,104,64
Mvaa 60,108,64
Ra 0,20,0
Mvaa 64,112,64
buffer_load_dwordx4 v7, s[12:15], s53 offen offset:1024 nt lds
Mvaa 68,116,64
s_waitcnt lgkmcnt(6)
Ta 36,23,0
Ta 38,23,2048
Mvaa 72,120,64
Mvaa 76,124,64
Ra 4,20,2048
Mvaa 80,96,68
buffer_load_dwordx4 v6, s[12:15], s54 offen offset:2048 nt lds
Mvaa 84,100,68
Ta 40,24,0
Ta 42,24,2048
Mvaa 88,104,68
Mvaa 92,108,68
Ra 8,20,4096
Mvaa 96,112,68
buffer_load_dwordx4 v7, s[12:15], s55 offen offset:3072 nt lds
Mvaa 100,116,68
s_waitcnt lgkmcnt(6)
Ta 44,25,0
Ta 46,25,2048
Mvaa 104,120,68
Mvaa 108,124,68
s_add_u32 m0, s57, 4096
Ra 12,20,6144
Mvaa 112,96,72
buffer_load_dwordx4 v8, s[12:15], s52 offen offset:0 nt lds
Mvaa 116,100,72
Ta 48,26,0
Ta 50,26,2048
Mvaa 120,104,72
Mvaa 124,108,72
Ra 16,20,8192
Mvaa 128,112,72
buffer_load_dwordx4 v9, s[12:15], s53 offen offset:1024 nt lds
Mvaa 132,116,72
s_waitcnt lgkmcnt(6)
Ta 52,27,0
Ta 54,27,2048
Mvaa 136,120,72
Mvaa 140,124,72
Ra 20,20,10240
Mvaa 144,96,76
buffer_load_dwordx4 v8, s[12:15], s54 offen offset:2048 nt lds
Mvaa 148,100,76
Ta 56,28,0
Ta 58,28,2048
Mvaa 152,104,76
Mvaa 156,108,76
Ra 24,20,12288
Mvaa 160,112,76
buffer_load_dwordx4 v9, s[12:15], s55 offen offset:3072 nt lds
Mvaa 164,116,76
s_waitcnt lgkmcnt(6)
Ta 60,29,0
Ta 62,29,2048
Mvaa 168,120,76
v_xor_b32 v6, 524288, v6
v_xor_b32 v7, 524288, v7
Mvaa 172,124,76
s_add_u32 m0, s56, 0
Ra 28,20,14336
v_xor_b32 v8, 524288, v8
Mvaa 176,96,80
buffer_load_dwordx4 v2, s[8:11], s48 offen offset:0 lds
Mvaa 180,100,80
v_xor_b32 v9, 524288, v9
Mvaa 184,104,80
Mvaa 188,108,80
Mvaa 192,112,80
buffer_load_dwordx4 v3, s[8:11], s49 offen offset:1024 lds
Mvaa 196,116,80
Mvaa 200,120,80
Mvaa 204,124,80
Mvaa 208,96,84
buffer_load_dwordx4 v2, s[8:11], s50 offen offset:2048 lds
Mvaa 212,100,84
Mvaa 216,104,84
Mvaa 220,108,84
Mvaa 224,112,84
buffer_load_dwordx4 v3, s[8:11], s51 offen offset:3072 lds
Mvaa 228,116,84
Mvaa 232,120,84
Mvaa 236,124,84
s_add_u32 m0, s56, 4096
Mvaa 240,96,88
buffer_load_dwordx4 v4, s[8:11], s48 offen offset:0 lds
Mvaa 244,100,88
Mvaa 248,104,88
Mvaa 252,108,88
Maaa 128,112,88
buffer_load_dwordx4 v5, s[8:11], s49 offen offset:1024 lds
Maaa 132,116,88
Maaa 136,120,88
Maaa 140,124,88
Maaa 144,96,92
buffer_load_dwordx4 v4, s[8:11], s50 offen offset:2048 lds
Maaa 148,100,92
Maaa 152,104,92
Maaa 156,108,92
Maaa 160,112,92
buffer_load_dwordx4 v5, s[8:11], s51 offen offset:3072 lds
Maaa 164,116,92
v_xor_b32 v2, 128, v2
v_xor_b32 v3, 128, v3
Maaa 168,120,92
buffer_load_dword v1, v47, s[60:63], 0 offen
v_xor_b32 v4, 128, v4
v_xor_b32 v5, 128, v5
Maaa 172,124,92
s_mul_i32 vcc_lo, s59, 3
v_xor_b32 v47, vcc_lo, v47
s_waitcnt lgkmcnt(0)
Mvaa 48,32,0
buffer_store_dwordx4 v[30:33], v46, s[20:23], s3 offen offset:0 sc1
Mvaa 52,36,0
Ta 96,22,16384
Ta 98,22,18432
Mvaa 56,40,0
buffer_store_dwordx4 v[34:37], v46, s[20:23], s3 offen offset:2048 sc1
Mvaa 60,44,0
Ra 64,21,0
Mvaa 64,48,0
buffer_store_dwordx4 v[38:41], v46, s[20:23], s39 offen offset:0 sc1
Mvaa 68,52,0
Ta 100,23,16384
Ta 102,23,18432
Mvaa 72,56,0
buffer_store_dwordx4 v[42:45], v46, s[20:23], s39 offen offset:2048 sc1
Mvaa 76,60,0
s_waitcnt lgkmcnt(6)
Ra 68,21,2048
Mvaa 80,32,4
s_lshl_b32 s3, s34, 1
s_and_b32 s36, s32, 1
s_add_u32 s3, s3, s36
Mvaa 84,36,4
Ta 104,24,16384
Ta 106,24,18432
Mvaa 88,40,4
s_mul_i32 s3, s3, 1116160
s_mul_i32 s36, s33, 139264
s_add_u32 s3, s3, s36
Mvaa 92,44,4
Ra 72,21,4096
Mvaa 96,48,4
s_lshr_b32 s36, s32, 1
s_mul_i32 s36, s36, 69632
s_add_u32 s3, s3, s36
Mvaa 100,52,4
Ta 108,25,16384
Ta 110,25,18432
Mvaa 104,56,4
s_add_u32 s38, s3, 0
s_lshl_b32 s39, s34, 7
s_lshl_b32 s36, s33, 2
Mvaa 108,60,4
s_waitcnt lgkmcnt(6)
Ra 76,21,6144
Mvaa 112,32,8
s_add_u32 s39, s39, s36
s_add_u32 s39, s39, 5296128
v_mov_b32_e64 v30, 1
Mvaa 116,36,8
Ta 112,26,16384
Ta 114,26,18432
Mvaa 120,40,8
v_mov_b32_e64 v31, 0
Mvaa 124,44,8
Ra 80,21,8192
Mvaa 128,48,8
s_cmp_eq_u32 s32, 0
s_cselect_b32 s39, s39, 2146435072
Mvaa 132,52,8
Ta 116,27,16384
Ta 118,27,18432
Mvaa 136,56,8
s_mov_b64 exec, 1
buffer_store_dword v31, v31, s[20:23], s39 offen sc1
s_mov_b64 exec, -1
Mvaa 140,60,8
s_waitcnt lgkmcnt(6)
Ra 84,21,10240
Mvaa 144,32,12
s_and_b32 s33, s2, 7
s_lshl_b32 s33, s33, 2
s_bfe_u32 s3, s2, 0x20003
Mvaa 148,36,12
Ta 120,28,16384
Ta 122,28,18432
Mvaa 152,40,12
s_add_u32 s33, s33, s3
s_lshr_b32 s34, s2, 5
s_lshl_b32 s64, s34, 7
Mvaa 156,44,12
Ra 88,21,12288
Mvaa 160,48,12
s_lshl_b32 s3, s33, 2
s_add_u32 s64, s64, s3
s_add_u32 s64, s64, 5300224
Mvaa 164,52,12
Ta 124,29,16384
Ta 126,29,18432
Mvaa 168,56,12
s_lshl_b32 s65, s34, 8
s_sub_u32 s65, 1920, s65
v_mul_u32_u24_e64 v32, s65, v0
Mvaa 172,60,12
s_waitcnt lgkmcnt(6)
Ra 92,21,14336
Mvaa 176,32,16
s_cmp_eq_u32 s32, 0
s_cselect_b32 s64, s64, 2146435072
Mvaa 180,36,16
s_mov_b64 exec, 3
buffer_store_dword v31, v32, s[20:23], s64 offen sc1
s_mov_b64 exec, -1
Mvaa 184,40,16
s_lshl_b32 s3, s2, 2
s_add_u32 s3, s3, 5302272
v_lshlrev_b32 v32, 10, v0
Mvaa 188,44,16
s_cmp_eq_u32 s32, 0
s_cselect_b32 s3, s3, 2146435072
Mvaa 192,48,16
s_mov_b64 exec, 31
buffer_store_dword v31, v32, s[20:23], s3 offen sc1
s_mov_b64 exec, -1
Mvaa 196,52,16
s_lshl_b32 s35, s34, 1
s_sub_u32 s36, 32, s35
s_add_u32 s35, s35, 2
Mvaa 200,56,16
s_lshl_b32 s44, s32, 12
s_lshl_b32 s58, s32, 1
s_sub_u32 s58, 7, s58
Mvaa 204,60,16
s_mul_i32 s58, s58, 33792
s_sub_u32 s3, 15, s34
s_lshl_b32 s45, s3, 3
Mvaa 208,32,20
s_add_u32 s45, s45, s32
s_lshl_b32 s46, s34, 3
s_add_u32 s46, s46, s32
Mvaa 212,36,20
s_mov_b32 s68, s42
s_and_b32 s69, s43, 0xffff
s_mov_b32 s70, 7340032
Mvaa 216,40,20
s_mov_b32 s71, 0x20000
s_cmp_eq_u32 s32, 0
s_cselect_b32 s37, 0, 2146435072
Mvaa 220,44,20
s_lshl_b32 s3, s33, 8
s_add_u32 s16, s4, s3
s_addc_u32 s17, s5, 0
s_and_b32 s17, s17, 0xffff
Mvaa 224,48,20
s_mov_b32 s18, 0
s_mov_b32 s19, 0x20000
s_sub_u32 s18, 8388608, s3
Mvaa 228,52,20
v_and_b32 v33, 15, v0
v_lshrrev_b32 v32, 1, v33
Mvaa 232,56,20
v_and_b32 v33, 1, v0
v_lshlrev_b32 v32, 13, v32
Mvaa 236,60,20
v_lshl_add_u32 v45, v33, 7, v32
Mvaa 240,32,24
s_lshl_b32 s3, s32, 3
s_add_u32 s3, s3, s34
s_mul_i32 s47, s3, 65536
Mvaa 244,36,24
s_bfe_u32 s6, s2, 131075
s_lshl_b32 s3, s32, 8
s_or_b32 s6, s6, s3
Mvaa 248,40,24
Mvaa 252,44,24
Maaa 128,48,24
Maaa 132,52,24
Maaa 136,56,24
Maaa 140,60,24
Maaa 144,32,28
Maaa 148,36,28
Maaa 152,40,28
Maaa 156,44,28
Maaa 160,48,28
Maaa 164,52,28
Maaa 168,56,28
Maaa 172,60,28
s_waitcnt vmcnt(8) lgkmcnt(0)
s_add_u32 m0, s57, 65536
s_barrier
Mvaa 48,96,64
buffer_load_dwordx4 v6, s[12:15], s52 offen offset:0 nt lds
Mvaa 52,100,64
Ta 32,12,0
Ta 34,12,2048
Mvaa 56,104,64
Mvaa 60,108,64
Ra 0,10,0
Mvaa 64,112,64
buffer_load_dwordx4 v7, s[12:15], s53 offen offset:1024 nt lds
Mvaa 68,116,64
s_waitcnt lgkmcnt(6)
Ta 36,13,0
Ta 38,13,2048
Mvaa 72,120,64
Mvaa 76,124,64
Ra 4,10,2048
Mvaa 80,96,68
buffer_load_dwordx4 v6, s[12:15], s54 offen offset:2048 nt lds
Mvaa 84,100,68
Ta 40,14,0
Ta 42,14,2048
Mvaa 88,104,68
Mvaa 92,108,68
Ra 8,10,4096
Mvaa 96,112,68
buffer_load_dwordx4 v7, s[12:15], s55 offen offset:3072 nt lds
Mvaa 100,116,68
s_waitcnt lgkmcnt(6)
Ta 44,15,0
Ta 46,15,2048
Mvaa 104,120,68
Mvaa 108,124,68
s_add_u32 m0, s57, 69632
Ra 12,10,6144
Mvaa 112,96,72
buffer_load_dwordx4 v8, s[12:15], s52 offen offset:0 nt lds
Mvaa 116,100,72
Ta 48,16,0
Ta 50,16,2048
Mvaa 120,104,72
Mvaa 124,108,72
Ra 16,10,8192
Mvaa 128,112,72
buffer_load_dwordx4 v9, s[12:15], s53 offen offset:1024 nt lds
Mvaa 132,116,72
s_waitcnt lgkmcnt(6)
Ta 52,17,0
Ta 54,17,2048
Mvaa 136,120,72
Mvaa 140,124,72
Ra 20,10,10240
Mvaa 144,96,76
buffer_load_dwordx4 v8, s[12:15], s54 offen offset:2048 nt lds
Mvaa 148,100,76
Ta 56,18,0
Ta 58,18,2048
Mvaa 152,104,76
Mvaa 156,108,76
Ra 24,10,12288
Mvaa 160,112,76
buffer_load_dwordx4 v9, s[12:15], s55 offen offset:3072 nt lds
Mvaa 164,116,76
s_waitcnt lgkmcnt(6)
Ta 60,19,0
Ta 62,19,2048
Mvaa 168,120,76
v_xor_b32 v6, 3670016, v6
v_xor_b32 v7, 3670016, v7
Mvaa 172,124,76
s_add_u32 m0, s56, 65536
Ra 28,10,14336
v_xor_b32 v8, 3670016, v8
Mvaa 176,96,80
buffer_load_dwordx4 v2, s[8:11], s48 offen offset:0 lds
Mvaa 180,100,80
v_xor_b32 v9, 3670016, v9
Mvaa 184,104,80
Mvaa 188,108,80
Mvaa 192,112,80
buffer_load_dwordx4 v3, s[8:11], s49 offen offset:1024 lds
Mvaa 196,116,80
Mvaa 200,120,80
Mvaa 204,124,80
Mvaa 208,96,84
buffer_load_dwordx4 v2, s[8:11], s50 offen offset:2048 lds
Mvaa 212,100,84
Mvaa 216,104,84
Mvaa 220,108,84
Mvaa 224,112,84
buffer_load_dwordx4 v3, s[8:11], s51 offen offset:3072 lds
Mvaa 228,116,84
Mvaa 232,120,84
Mvaa 236,124,84
s_add_u32 m0, s56, 69632
Mvaa 240,96,88
buffer_load_dwordx4 v4, s[8:11], s48 offen offset:0 lds
Mvaa 244,100,88
Mvaa 248,104,88
Mvaa 252,108,88
Maaa 128,112,88
buffer_load_dwordx4 v5, s[8:11], s49 offen offset:1024 lds
Maaa 132,116,88
Maaa 136,120,88
Maaa 140,124,88
Maaa 144,96,92
buffer_load_dwordx4 v4, s[8:11], s50 offen offset:2048 lds
Maaa 148,100,92
Maaa 152,104,92
Maaa 156,108,92
Maaa 160,112,92
buffer_load_dwordx4 v5, s[8:11], s51 offen offset:3072 lds
Maaa 164,116,92
v_xor_b32 v2, 896, v2
v_xor_b32 v3, 896, v3
Maaa 168,120,92
buffer_load_dword v1, v47, s[60:63], 0 offen
v_xor_b32 v4, 896, v4
v_xor_b32 v5, 896, v5
Maaa 172,124,92
s_mul_i32 vcc_lo, s59, 1
v_xor_b32 v47, vcc_lo, v47
s_waitcnt lgkmcnt(0)
Mvaa 48,32,0
Mvaa 52,36,0
Ta 96,12,16384
Ta 98,12,18432
Mvaa 56,40,0
Mvaa 60,44,0
Ra 64,11,0
Mvaa 64,48,0
Mvaa 68,52,0
Ta 100,13,16384
Ta 102,13,18432
Mvaa 72,56,0
Mvaa 76,60,0
s_waitcnt lgkmcnt(6)
Ra 68,11,2048
Mvaa 80,32,4
Mvaa 84,36,4
Ta 104,14,16384
Ta 106,14,18432
Mvaa 88,40,4
Mvaa 92,44,4
Ra 72,11,4096
Mvaa 96,48,4
Mvaa 100,52,4
Ta 108,15,16384
Ta 110,15,18432
Mvaa 104,56,4
Mvaa 108,60,4
s_waitcnt lgkmcnt(6)
Ra 76,11,6144
Mvaa 112,32,8
Mvaa 116,36,8
Ta 112,16,16384
Ta 114,16,18432
Mvaa 120,40,8
Mvaa 124,44,8
Ra 80,11,8192
Mvaa 128,48,8
Mvaa 132,52,8
Ta 116,17,16384
Ta 118,17,18432
Mvaa 136,56,8
Mvaa 140,60,8
s_waitcnt lgkmcnt(6)
Ra 84,11,10240
Mvaa 144,32,12
Mvaa 148,36,12
Ta 120,18,16384
Ta 122,18,18432
Mvaa 152,40,12
Mvaa 156,44,12
Ra 88,11,12288
Mvaa 160,48,12
Mvaa 164,52,12
Ta 124,19,16384
Ta 126,19,18432
Mvaa 168,56,12
Mvaa 172,60,12
s_waitcnt lgkmcnt(6)
Ra 92,11,14336
Mvaa 176,32,16
Mvaa 180,36,16
Mvaa 184,40,16
Mvaa 188,44,16
Mvaa 192,48,16
Mvaa 196,52,16
Mvaa 200,56,16
Mvaa 204,60,16
Mvaa 208,32,20
Mvaa 212,36,20
Mvaa 216,40,20
Mvaa 220,44,20
Mvaa 224,48,20
Mvaa 228,52,20
Mvaa 232,56,20
Mvaa 236,60,20
Mvaa 240,32,24
Mvaa 244,36,24
Mvaa 248,40,24
Mvaa 252,44,24
Maaa 128,48,24
Maaa 132,52,24
Maaa 136,56,24
Maaa 140,60,24
Maaa 144,32,28
Maaa 148,36,28
Maaa 152,40,28
Maaa 156,44,28
Maaa 160,48,28
Maaa 164,52,28
Maaa 168,56,28
Maaa 172,60,28
s_waitcnt vmcnt(1) lgkmcnt(0)
s_add_u32 m0, s57, 0
s_barrier
Mvaa 48,96,64
buffer_load_dwordx4 v6, s[12:15], s52 offen offset:0 nt lds
Mvaa 52,100,64
Ta 32,22,0
Ta 34,22,2048
Mvaa 56,104,64
Mvaa 60,108,64
Ra 0,20,0
Mvaa 64,112,64
buffer_load_dwordx4 v7, s[12:15], s53 offen offset:1024 nt lds
Mvaa 68,116,64
s_waitcnt lgkmcnt(6)
Ta 36,23,0
Ta 38,23,2048
Mvaa 72,120,64
Mvaa 76,124,64
Ra 4,20,2048
Mvaa 80,96,68
buffer_load_dwordx4 v6, s[12:15], s54 offen offset:2048 nt lds
Mvaa 84,100,68
Ta 40,24,0
Ta 42,24,2048
Mvaa 88,104,68
Mvaa 92,108,68
Ra 8,20,4096
Mvaa 96,112,68
buffer_load_dwordx4 v7, s[12:15], s55 offen offset:3072 nt lds
Mvaa 100,116,68
s_waitcnt lgkmcnt(6)
Ta 44,25,0
Ta 46,25,2048
Mvaa 104,120,68
s_cmp_eq_u32 s6, 0
s_cselect_b32 s3, 0, 2146435072
Mvaa 108,124,68
s_add_u32 m0, s57, 4096
Ra 12,20,6144
Mvaa 112,96,72
buffer_load_dwordx4 v8, s[12:15], s52 offen offset:0 nt lds
Mvaa 116,100,72
Ta 48,26,0
Ta 50,26,2048
Mvaa 120,104,72
s_mov_b64 exec, 1
buffer_atomic_add v30, v31, s[28:31], s3 offen sc1
s_mov_b64 exec, -1
Mvaa 124,108,72
Ra 16,20,8192
Mvaa 128,112,72
buffer_load_dwordx4 v9, s[12:15], s53 offen offset:1024 nt lds
Mvaa 132,116,72
s_waitcnt lgkmcnt(6)
Ta 52,27,0
Ta 54,27,2048
Mvaa 136,120,72
Mvaa 140,124,72
Ra 20,20,10240
Mvaa 144,96,76
buffer_load_dwordx4 v8, s[12:15], s54 offen offset:2048 nt lds
Mvaa 148,100,76
Ta 56,28,0
Ta 58,28,2048
Mvaa 152,104,76
Mvaa 156,108,76
Ra 24,20,12288
Mvaa 160,112,76
buffer_load_dwordx4 v9, s[12:15], s55 offen offset:3072 nt lds
Mvaa 164,116,76
s_waitcnt lgkmcnt(6)
Ta 60,29,0
Ta 62,29,2048
Mvaa 168,120,76
v_xor_b32 v6, 524288, v6
v_xor_b32 v7, 524288, v7
Mvaa 172,124,76
s_add_u32 m0, s56, 0
Ra 28,20,14336
v_xor_b32 v8, 524288, v8
Mvaa 176,96,80
buffer_load_dwordx4 v2, s[8:11], s48 offen offset:0 lds
Mvaa 180,100,80
v_xor_b32 v9, 524288, v9
Mvaa 184,104,80
Mvaa 188,108,80
Mvaa 192,112,80
buffer_load_dwordx4 v3, s[8:11], s49 offen offset:1024 lds
Mvaa 196,116,80
Mvaa 200,120,80
Mvaa 204,124,80
Mvaa 208,96,84
buffer_load_dwordx4 v2, s[8:11], s50 offen offset:2048 lds
Mvaa 212,100,84
Mvaa 216,104,84
Mvaa 220,108,84
Mvaa 224,112,84
buffer_load_dwordx4 v3, s[8:11], s51 offen offset:3072 lds
Mvaa 228,116,84
Mvaa 232,120,84
Mvaa 236,124,84
s_add_u32 m0, s56, 4096
Mvaa 240,96,88
buffer_load_dwordx4 v4, s[8:11], s48 offen offset:0 lds
Mvaa 244,100,88
Mvaa 248,104,88
Mvaa 252,108,88
Maaa 128,112,88
buffer_load_dwordx4 v5, s[8:11], s49 offen offset:1024 lds
Maaa 132,116,88
Maaa 136,120,88
Maaa 140,124,88
Maaa 144,96,92
buffer_load_dwordx4 v4, s[8:11], s50 offen offset:2048 lds
Maaa 148,100,92
Maaa 152,104,92
Maaa 156,108,92
Maaa 160,112,92
buffer_load_dwordx4 v5, s[8:11], s51 offen offset:3072 lds
Maaa 164,116,92
v_xor_b32 v2, 128, v2
v_xor_b32 v3, 128, v3
Maaa 168,120,92
buffer_load_dword v1, v47, s[60:63], 0 offen
v_xor_b32 v4, 128, v4
v_xor_b32 v5, 128, v5
Maaa 172,124,92
s_mul_i32 vcc_lo, s59, 7
v_xor_b32 v47, vcc_lo, v47
s_waitcnt lgkmcnt(0)
Mvaa 48,32,0
buffer_load_dword v44, v45, s[16:19], s47 offen
Mvaa 52,36,0
Ta 96,22,16384
Ta 98,22,18432
Mvaa 56,40,0
s_add_u32 s47, s47, 2097152
Mvaa 60,44,0
Ra 64,21,0
Mvaa 64,48,0
Mvaa 68,52,0
Ta 100,23,16384
Ta 102,23,18432
Mvaa 72,56,0
Mvaa 76,60,0
s_waitcnt lgkmcnt(6)
Ra 68,21,2048
Mvaa 80,32,4
Mvaa 84,36,4
Ta 104,24,16384
Ta 106,24,18432
Mvaa 88,40,4
Mvaa 92,44,4
Ra 72,21,4096
Mvaa 96,48,4
Mvaa 100,52,4
Ta 108,25,16384
Ta 110,25,18432
Mvaa 104,56,4
Mvaa 108,60,4
s_waitcnt lgkmcnt(6)
Ra 76,21,6144
Mvaa 112,32,8
Mvaa 116,36,8
Ta 112,26,16384
Ta 114,26,18432
Mvaa 120,40,8
Mvaa 124,44,8
Ra 80,21,8192
Mvaa 128,48,8
Mvaa 132,52,8
Ta 116,27,16384
Ta 118,27,18432
Mvaa 136,56,8
Mvaa 140,60,8
s_waitcnt lgkmcnt(6)
Ra 84,21,10240
Mvaa 144,32,12
Mvaa 148,36,12
Ta 120,28,16384
Ta 122,28,18432
Mvaa 152,40,12
s_cmp_eq_u32 s6, 1
s_cselect_b32 s3, 0, 2146435072
Mvaa 156,44,12
Ra 88,21,12288
Mvaa 160,48,12
s_mov_b64 exec, 1
buffer_atomic_add v30, v31, s[28:31], s3 offen sc1
s_mov_b64 exec, -1
Mvaa 164,52,12
Ta 124,29,16384
Ta 126,29,18432
Mvaa 168,56,12
Mvaa 172,60,12
s_waitcnt lgkmcnt(6)
Ra 92,21,14336
Mvaa 176,32,16
Mvaa 180,36,16
Mvaa 184,40,16
Mvaa 188,44,16
Mvaa 192,48,16
Mvaa 196,52,16
Mvaa 200,56,16
Mvaa 204,60,16
Mvaa 208,32,20
Mvaa 212,36,20
Mvaa 216,40,20
Mvaa 220,44,20
Mvaa 224,48,20
Mvaa 228,52,20
Mvaa 232,56,20
Mvaa 236,60,20
Mvaa 240,32,24
Mvaa 244,36,24
Mvaa 248,40,24
Mvaa 252,44,24
Maaa 128,48,24
Maaa 132,52,24
Maaa 136,56,24
Maaa 140,60,24
Maaa 144,32,28
Maaa 148,36,28
Maaa 152,40,28
Maaa 156,44,28
Maaa 160,48,28
Maaa 164,52,28
Maaa 168,56,28
Maaa 172,60,28
s_waitcnt vmcnt(3) lgkmcnt(0)
s_add_u32 m0, s57, 65536
s_barrier
Mvaa 48,96,64
buffer_load_dwordx4 v6, s[12:15], s52 offen offset:0 nt lds
Mvaa 52,100,64
Ta 32,12,0
Ta 34,12,2048
Mvaa 56,104,64
Mvaa 60,108,64
Ra 0,10,0
Mvaa 64,112,64
buffer_load_dwordx4 v7, s[12:15], s53 offen offset:1024 nt lds
Mvaa 68,116,64
s_waitcnt lgkmcnt(6)
Ta 36,13,0
Ta 38,13,2048
Mvaa 72,120,64
Mvaa 76,124,64
Ra 4,10,2048
Mvaa 80,96,68
buffer_load_dwordx4 v6, s[12:15], s54 offen offset:2048 nt lds
Mvaa 84,100,68
Ta 40,14,0
Ta 42,14,2048
Mvaa 88,104,68
Mvaa 92,108,68
Ra 8,10,4096
Mvaa 96,112,68
buffer_load_dwordx4 v7, s[12:15], s55 offen offset:3072 nt lds
Mvaa 100,116,68
s_waitcnt lgkmcnt(6)
Ta 44,15,0
Ta 46,15,2048
Mvaa 104,120,68
Mvaa 108,124,68
s_add_u32 m0, s57, 69632
Ra 12,10,6144
Mvaa 112,96,72
buffer_load_dwordx4 v8, s[12:15], s52 offen offset:0 nt lds
Mvaa 116,100,72
Ta 48,16,0
Ta 50,16,2048
Mvaa 120,104,72
Mvaa 124,108,72
Ra 16,10,8192
Mvaa 128,112,72
buffer_load_dwordx4 v9, s[12:15], s53 offen offset:1024 nt lds
Mvaa 132,116,72
s_waitcnt lgkmcnt(6)
Ta 52,17,0
Ta 54,17,2048
Mvaa 136,120,72
Mvaa 140,124,72
Ra 20,10,10240
Mvaa 144,96,76
buffer_load_dwordx4 v8, s[12:15], s54 offen offset:2048 nt lds
Mvaa 148,100,76
Ta 56,18,0
Ta 58,18,2048
Mvaa 152,104,76
Mvaa 156,108,76
Ra 24,10,12288
Mvaa 160,112,76
buffer_load_dwordx4 v9, s[12:15], s55 offen offset:3072 nt lds
Mvaa 164,116,76
s_waitcnt lgkmcnt(6)
Ta 60,19,0
Ta 62,19,2048
Mvaa 168,120,76
v_xor_b32 v6, 1572864, v6
v_xor_b32 v7, 1572864, v7
Mvaa 172,124,76
s_add_u32 m0, s56, 65536
Ra 28,10,14336
v_xor_b32 v8, 1572864, v8
Mvaa 176,96,80
buffer_load_dwordx4 v2, s[8:11], s48 offen offset:0 lds
Mvaa 180,100,80
v_xor_b32 v9, 1572864, v9
Mvaa 184,104,80
Mvaa 188,108,80
Mvaa 192,112,80
buffer_load_dwordx4 v3, s[8:11], s49 offen offset:1024 lds
Mvaa 196,116,80
Mvaa 200,120,80
Mvaa 204,124,80
s_cmp_eq_u32 s6, 2
s_cselect_b32 s3, 0, 2146435072
Mvaa 208,96,84
buffer_load_dwordx4 v2, s[8:11], s50 offen offset:2048 lds
Mvaa 212,100,84
s_mov_b64 exec, 1
buffer_atomic_add v30, v31, s[28:31], s3 offen sc1
s_mov_b64 exec, -1
Mvaa 216,104,84
Mvaa 220,108,84
Mvaa 224,112,84
buffer_load_dwordx4 v3, s[8:11], s51 offen offset:3072 lds
Mvaa 228,116,84
Mvaa 232,120,84
Mvaa 236,124,84
s_add_u32 m0, s56, 69632
Mvaa 240,96,88
buffer_load_dwordx4 v4, s[8:11], s48 offen offset:0 lds
Mvaa 244,100,88
Mvaa 248,104,88
Mvaa 252,108,88
Maaa 128,112,88
buffer_load_dwordx4 v5, s[8:11], s49 offen offset:1024 lds
Maaa 132,116,88
Maaa 136,120,88
Maaa 140,124,88
Maaa 144,96,92
buffer_load_dwordx4 v4, s[8:11], s50 offen offset:2048 lds
Maaa 148,100,92
Maaa 152,104,92
Maaa 156,108,92
Maaa 160,112,92
buffer_load_dwordx4 v5, s[8:11], s51 offen offset:3072 lds
Maaa 164,116,92
v_xor_b32 v2, 384, v2
v_xor_b32 v3, 384, v3
Maaa 168,120,92
v_xor_b32 v4, 384, v4
v_xor_b32 v5, 384, v5
Maaa 172,124,92
s_waitcnt lgkmcnt(0)
Mvaa 48,32,0
buffer_load_dword v44, v45, s[16:19], s47 offen
Mvaa 52,36,0
Ta 96,12,16384
Ta 98,12,18432
Mvaa 56,40,0
s_add_u32 s47, s47, 2097152
Mvaa 60,44,0
Ra 64,11,0
Mvaa 64,48,0
Mvaa 68,52,0
Ta 100,13,16384
Ta 102,13,18432
Mvaa 72,56,0
Mvaa 76,60,0
s_waitcnt lgkmcnt(6)
Ra 68,11,2048
Mvaa 80,32,4
Mvaa 84,36,4
Ta 104,14,16384
Ta 106,14,18432
Mvaa 88,40,4
Mvaa 92,44,4
Ra 72,11,4096
Mvaa 96,48,4
Mvaa 100,52,4
Ta 108,15,16384
Ta 110,15,18432
Mvaa 104,56,4
Mvaa 108,60,4
s_waitcnt lgkmcnt(6)
Ra 76,11,6144
Mvaa 112,32,8
Mvaa 116,36,8
Ta 112,16,16384
Ta 114,16,18432
Mvaa 120,40,8
Mvaa 124,44,8
Ra 80,11,8192
Mvaa 128,48,8
Mvaa 132,52,8
Ta 116,17,16384
Ta 118,17,18432
Mvaa 136,56,8
Mvaa 140,60,8
s_waitcnt lgkmcnt(6)
Ra 84,11,10240
Mvaa 144,32,12
Mvaa 148,36,12
Ta 120,18,16384
Ta 122,18,18432
Mvaa 152,40,12
Mvaa 156,44,12
Ra 88,11,12288
Mvaa 160,48,12
Mvaa 164,52,12
Ta 124,19,16384
Ta 126,19,18432
Mvaa 168,56,12
Mvaa 172,60,12
s_waitcnt lgkmcnt(6)
Ra 92,11,14336
Mvaa 176,32,16
Mvaa 180,36,16
Mvaa 184,40,16
Mvaa 188,44,16
Mvaa 192,48,16
Mvaa 196,52,16
Mvaa 200,56,16
Mvaa 204,60,16
Mvaa 208,32,20
Mvaa 212,36,20
Mvaa 216,40,20
Mvaa 220,44,20
Mvaa 224,48,20
Mvaa 228,52,20
Mvaa 232,56,20
Mvaa 236,60,20
Mvaa 240,32,24
Mvaa 244,36,24
Mvaa 248,40,24
Mvaa 252,44,24
Maaa 128,48,24
s_cmp_eq_u32 s6, 3
s_cselect_b32 s3, 0, 2146435072
Maaa 132,52,24
s_mov_b64 exec, 1
buffer_atomic_add v30, v31, s[28:31], s3 offen sc1
s_mov_b64 exec, -1
Maaa 136,56,24
Maaa 140,60,24
Maaa 144,32,28
Maaa 148,36,28
Maaa 152,40,28
Maaa 156,44,28
Maaa 160,48,28
Maaa 164,52,28
Maaa 168,56,28
Maaa 172,60,28
s_waitcnt vmcnt(2) lgkmcnt(0)
s_add_u32 m0, s57, 0
s_barrier
Mvaa 48,96,64
buffer_load_dwordx4 v6, s[12:15], s52 offen offset:0 nt lds
Mvaa 52,100,64
Ta 32,22,0
Ta 34,22,2048
Mvaa 56,104,64
Mvaa 60,108,64
Ra 0,20,0
Mvaa 64,112,64
buffer_load_dwordx4 v7, s[12:15], s53 offen offset:1024 nt lds
Mvaa 68,116,64
s_waitcnt lgkmcnt(6)
Ta 36,23,0
Ta 38,23,2048
Mvaa 72,120,64
Mvaa 76,124,64
Ra 4,20,2048
Mvaa 80,96,68
buffer_load_dwordx4 v6, s[12:15], s54 offen offset:2048 nt lds
Mvaa 84,100,68
Ta 40,24,0
Ta 42,24,2048
Mvaa 88,104,68
Mvaa 92,108,68
Ra 8,20,4096
Mvaa 96,112,68
buffer_load_dwordx4 v7, s[12:15], s55 offen offset:3072 nt lds
Mvaa 100,116,68
s_waitcnt lgkmcnt(6)
Ta 44,25,0
Ta 46,25,2048
Mvaa 104,120,68
Mvaa 108,124,68
s_add_u32 m0, s57, 4096
Ra 12,20,6144
Mvaa 112,96,72
buffer_load_dwordx4 v8, s[12:15], s52 offen offset:0 nt lds
Mvaa 116,100,72
Ta 48,26,0
Ta 50,26,2048
Mvaa 120,104,72
Mvaa 124,108,72
Ra 16,20,8192
Mvaa 128,112,72
buffer_load_dwordx4 v9, s[12:15], s53 offen offset:1024 nt lds
Mvaa 132,116,72
s_waitcnt lgkmcnt(6)
Ta 52,27,0
Ta 54,27,2048
Mvaa 136,120,72
Mvaa 140,124,72
Ra 20,20,10240
Mvaa 144,96,76
buffer_load_dwordx4 v8, s[12:15], s54 offen offset:2048 nt lds
Mvaa 148,100,76
Ta 56,28,0
Ta 58,28,2048
Mvaa 152,104,76
Mvaa 156,108,76
Ra 24,20,12288
Mvaa 160,112,76
buffer_load_dwordx4 v9, s[12:15], s55 offen offset:3072 nt lds
Mvaa 164,116,76
s_waitcnt lgkmcnt(6)
Ta 60,29,0
Ta 62,29,2048
Mvaa 168,120,76
v_xor_b32 v6, 524288, v6
v_xor_b32 v7, 524288, v7
Mvaa 172,124,76
s_add_u32 m0, s56, 0
Ra 28,20,14336
v_xor_b32 v8, 524288, v8
Mvaa 176,96,80
buffer_load_dwordx4 v2, s[8:11], s48 offen offset:0 lds
Mvaa 180,100,80
v_xor_b32 v9, 524288, v9
Mvaa 184,104,80
Mvaa 188,108,80
Mvaa 192,112,80
buffer_load_dwordx4 v3, s[8:11], s49 offen offset:1024 lds
Mvaa 196,116,80
Mvaa 200,120,80
Mvaa 204,124,80
Mvaa 208,96,84
buffer_load_dwordx4 v2, s[8:11], s50 offen offset:2048 lds
Mvaa 212,100,84
Mvaa 216,104,84
Mvaa 220,108,84
Mvaa 224,112,84
buffer_load_dwordx4 v3, s[8:11], s51 offen offset:3072 lds
Mvaa 228,116,84
Mvaa 232,120,84
Mvaa 236,124,84
s_add_u32 m0, s56, 4096
Mvaa 240,96,88
buffer_load_dwordx4 v4, s[8:11], s48 offen offset:0 lds
Mvaa 244,100,88
Mvaa 248,104,88
Mvaa 252,108,88
Maaa 128,112,88
buffer_load_dwordx4 v5, s[8:11], s49 offen offset:1024 lds
Maaa 132,116,88
Maaa 136,120,88
Maaa 140,124,88
Maaa 144,96,92
buffer_load_dwordx4 v4, s[8:11], s50 offen offset:2048 lds
Maaa 148,100,92
Maaa 152,104,92
Maaa 156,108,92
Maaa 160,112,92
buffer_load_dwordx4 v5, s[8:11], s51 offen offset:3072 lds
Maaa 164,116,92
v_xor_b32 v2, 128, v2
v_xor_b32 v3, 128, v3
Maaa 168,120,92
v_xor_b32 v4, 128, v4
v_xor_b32 v5, 128, v5
Maaa 172,124,92
s_waitcnt lgkmcnt(0)
Mvaa 48,32,0
buffer_load_dword v44, v45, s[16:19], s47 offen
Mvaa 52,36,0
Ta 96,22,16384
Ta 98,22,18432
Mvaa 56,40,0
s_add_u32 s47, s47, 2097152
v_lshrrev_b32 v32, 4, v0
v_and_b32 v33, 15, v0
Mvaa 60,44,0
Ra 64,21,0
Mvaa 64,48,0
s_lshl_b32 s3, s32, 4
v_add_u32 v34, s3, v32
v_lshlrev_b32_e64 v36, 1, v32
Mvaa 68,52,0
Ta 100,23,16384
Ta 102,23,18432
Mvaa 72,56,0
v_xor_b32 v36, v36, v33
v_xor_b32 v37, 8, v36
Mvaa 76,60,0
s_waitcnt lgkmcnt(6)
Ra 68,21,2048
Mvaa 80,32,4
s_getpc_b64 s[6:7]
L_cpf2:
s_add_u32 s6, s6, (L_phase2-L_cpf2)&0xffffffff
s_addc_u32 s7, s7, ((L_phase2-L_cpf2)>>32)&0xffffffff
Mvaa 84,36,4
Ta 104,24,16384
Ta 106,24,18432
Mvaa 88,40,4
s_lshr_b32 s3, s2, 3
s_lshl_b32 s3, s3, 2
s_add_u32 s3, s3, s32
Mvaa 92,44,4
Ra 72,21,4096
Mvaa 96,48,4
s_lshl_b32 s3, s3, 10
v_and_b32 v42, 7, v0
v_lshlrev_b32 v42, 7, v42
Mvaa 100,52,4
Ta 108,25,16384
Ta 110,25,18432
Mvaa 104,56,4
v_add_u32_e64 v42, s3, v42
v_min_u32 v42, L_k2_fin-L_phase2-4, v42
Mvaa 108,60,4
s_waitcnt lgkmcnt(6)
Ra 76,21,6144
Mvaa 112,32,8
v_mov_b32 v41, s7
Mvaa 116,36,8
Ta 112,26,16384
Ta 114,26,18432
Mvaa 120,40,8
v_add_co_u32 v40, vcc, s6, v42
s_nop 1
v_addc_co_u32 v41, vcc, 0, v41, vcc
Mvaa 124,44,8
Ra 80,21,8192
Mvaa 128,48,8
global_load_dword v38, v[40:41], off
Mvaa 132,52,8
Ta 116,27,16384
Ta 118,27,18432
Mvaa 136,56,8
Mvaa 140,60,8
s_waitcnt lgkmcnt(6)
Ra 84,21,10240
Mvaa 144,32,12
Mvaa 148,36,12
Ta 120,28,16384
Ta 122,28,18432
Mvaa 152,40,12
Mvaa 156,44,12
Ra 88,21,12288
Mvaa 160,48,12
Mvaa 164,52,12
Ta 124,29,16384
Ta 126,29,18432
Mvaa 168,56,12
Mvaa 172,60,12
s_waitcnt lgkmcnt(6)
Ra 92,21,14336
Mvaa 176,32,16
Mvaa 180,36,16
Mvaa 184,40,16
Mvaa 188,44,16
Mvaa 192,48,16
Mvaa 196,52,16
Mvaa 200,56,16
Mvaa 204,60,16
Mvaa 208,32,20
Mvaa 212,36,20
Mvaa 216,40,20
Mvaa 220,44,20
Mvaa 224,48,20
Mvaa 228,52,20
Mvaa 232,56,20
Mvaa 236,60,20
Mvaa 240,32,24
Mvaa 244,36,24
Mvaa 248,40,24
Mvaa 252,44,24
Maaa 128,48,24
Maaa 132,52,24
Maaa 136,56,24
Maaa 140,60,24
Maaa 144,32,28
Maaa 148,36,28
Maaa 152,40,28
Maaa 156,44,28
Maaa 160,48,28
Maaa 164,52,28
Maaa 168,56,28
Maaa 172,60,28
s_waitcnt vmcnt(2) lgkmcnt(0)
s_add_u32 m0, s57, 65536
s_barrier
Mvaa 48,96,64
buffer_load_dwordx4 v6, s[12:15], s52 offen offset:0 nt lds
Mvaa 52,100,64
Ta 32,12,0
Ta 34,12,2048
Mvaa 56,104,64
Mvaa 60,108,64
Ra 0,10,0
Mvaa 64,112,64
buffer_load_dwordx4 v7, s[12:15], s53 offen offset:1024 nt lds
Mvaa 68,116,64
s_waitcnt lgkmcnt(6)
Ta 36,13,0
Ta 38,13,2048
Mvaa 72,120,64
Mvaa 76,124,64
Ra 4,10,2048
Mvaa 80,96,68
buffer_load_dwordx4 v6, s[12:15], s54 offen offset:2048 nt lds
Mvaa 84,100,68
Ta 40,14,0
Ta 42,14,2048
Mvaa 88,104,68
Mvaa 92,108,68
Ra 8,10,4096
Mvaa 96,112,68
buffer_load_dwordx4 v7, s[12:15], s55 offen offset:3072 nt lds
Mvaa 100,116,68
s_waitcnt lgkmcnt(6)
Ta 44,15,0
Ta 46,15,2048
Mvaa 104,120,68
Mvaa 108,124,68
s_add_u32 m0, s57, 69632
Ra 12,10,6144
Mvaa 112,96,72
buffer_load_dwordx4 v8, s[12:15], s52 offen offset:0 nt lds
Mvaa 116,100,72
Ta 48,16,0
Ta 50,16,2048
Mvaa 120,104,72
Mvaa 124,108,72
Ra 16,10,8192
Mvaa 128,112,72
buffer_load_dwordx4 v9, s[12:15], s53 offen offset:1024 nt lds
Mvaa 132,116,72
s_waitcnt lgkmcnt(6)
Ta 52,17,0
Ta 54,17,2048
Mvaa 136,120,72
Mvaa 140,124,72
Ra 20,10,10240
Mvaa 144,96,76
buffer_load_dwordx4 v8, s[12:15], s54 offen offset:2048 nt lds
Mvaa 148,100,76
Ta 56,18,0
Ta 58,18,2048
Mvaa 152,104,76
Mvaa 156,108,76
Ra 24,10,12288
Mvaa 160,112,76
buffer_load_dwordx4 v9, s[12:15], s55 offen offset:3072 nt lds
Mvaa 164,116,76
s_waitcnt lgkmcnt(6)
Ta 60,19,0
Ta 62,19,2048
Mvaa 168,120,76
Mvaa 172,124,76
s_add_u32 m0, s56, 65536
Ra 28,10,14336
Mvaa 176,96,80
buffer_load_dwordx4 v2, s[8:11], s48 offen offset:0 lds
Mvaa 180,100,80
Mvaa 184,104,80
Mvaa 188,108,80
Mvaa 192,112,80
buffer_load_dwordx4 v3, s[8:11], s49 offen offset:1024 lds
Mvaa 196,116,80
Mvaa 200,120,80
Mvaa 204,124,80
Mvaa 208,96,84
buffer_load_dwordx4 v2, s[8:11], s50 offen offset:2048 lds
Mvaa 212,100,84
Mvaa 216,104,84
Mvaa 220,108,84
Mvaa 224,112,84
buffer_load_dwordx4 v3, s[8:11], s51 offen offset:3072 lds
Mvaa 228,116,84
Mvaa 232,120,84
Mvaa 236,124,84
s_add_u32 m0, s56, 69632
Mvaa 240,96,88
buffer_load_dwordx4 v4, s[8:11], s48 offen offset:0 lds
Mvaa 244,100,88
Mvaa 248,104,88
Mvaa 252,108,88
Maaa 128,112,88
buffer_load_dwordx4 v5, s[8:11], s49 offen offset:1024 lds
Maaa 132,116,88
Maaa 136,120,88
Maaa 140,124,88
Maaa 144,96,92
buffer_load_dwordx4 v4, s[8:11], s50 offen offset:2048 lds
Maaa 148,100,92
Maaa 152,104,92
Maaa 156,108,92
Maaa 160,112,92
buffer_load_dwordx4 v5, s[8:11], s51 offen offset:3072 lds
Maaa 164,116,92
Maaa 168,120,92
Maaa 172,124,92
s_waitcnt lgkmcnt(0)
Mvaa 48,32,0
buffer_load_dword v30, v31, s[28:31], s37 offen sc1
Mvaa 52,36,0
Ta 96,12,16384
Ta 98,12,18432
Mvaa 56,40,0
s_mov_b32 s8, s16
s_mov_b32 s9, s17
s_mov_b32 s10, s18
Mvaa 60,44,0
Ra 64,11,0
Mvaa 64,48,0
s_add_u32 s16, s66, 46137344
s_addc_u32 s17, s67, 0
s_and_b32 s17, s17, 0xffff
Mvaa 68,52,0
Ta 100,13,16384
Ta 102,13,18432
Mvaa 72,56,0
s_mov_b32 s18, 16777216
s_mov_b32 s19, 0x20000
s_mov_b32 s48, 0
Mvaa 76,60,0
s_waitcnt lgkmcnt(6)
Ra 68,11,2048
Mvaa 80,32,4
s_mov_b32 s49, 31744
s_mov_b32 s50, 63488
s_mov_b32 s51, 95232
Mvaa 84,36,4
Ta 104,14,16384
Ta 106,14,18432
Mvaa 88,40,4
v_lshlrev_b32_e64 v35, 13, v34
v_lshl_add_u32 v8, v36, 4, v35
Mvaa 92,44,4
Ra 72,11,4096
Mvaa 96,48,4
v_lshl_add_u32 v9, v37, 4, v35
v_lshlrev_b32_e64 v2, 4, v0
Mvaa 100,52,4
Ta 108,15,16384
Ta 110,15,18432
Mvaa 104,56,4
v_add_u32 v3, 65536, v2
v_add_u32_e64 v4, s44, v2
Mvaa 108,60,4
s_waitcnt lgkmcnt(6)
Ra 76,11,6144
Mvaa 112,32,8
v_mov_b32 v7, 0
v_lshlrev_b32_e64 v35, 2, v32
Mvaa 116,36,8
Ta 112,16,16384
Ta 114,16,18432
Mvaa 120,40,8
v_sub_u32_e64 v35, v33, v35
Mvaa 124,44,8
Ra 80,11,8192
Mvaa 128,48,8
s_lshl_b32 s3, s32, 4
v_add_u32 v5, s3, v35
Mvaa 132,52,8
Ta 116,17,16384
Ta 118,17,18432
Mvaa 136,56,8
s_sub_u32 s3, 48, s3
v_add_u32 v6, s3, v35
Mvaa 140,60,8
s_waitcnt lgkmcnt(6)
Ra 84,11,10240
Mvaa 144,32,12
s_mul_i32 s3, s33, 1116160
s_add_u32 s3, s3, 8388608
s_add_u32 s12, s66, s3
s_addc_u32 s13, s67, 0
s_and_b32 s13, s13, 0xffff
Mvaa 148,36,12
Ta 120,18,16384
Ta 122,18,18432
Mvaa 152,40,12
s_mov_b32 s14, 0
s_mov_b32 s15, 0x20000
s_mul_i32 s14, s36, 34816
Mvaa 156,44,12
Ra 88,11,12288
Mvaa 160,48,12
buffer_load_dword v44, v45, s[8:11], s47 offen
Mvaa 164,52,12
Ta 124,19,16384
Ta 126,19,18432
Mvaa 168,56,12
s_add_u32 s47, s47, 2097152
Mvaa 172,60,12
s_waitcnt lgkmcnt(6)
Ra 92,11,14336
Mvaa 176,32,16
Mvaa 180,36,16
Mvaa 184,40,16
Mvaa 188,44,16
Mvaa 192,48,16
Mvaa 196,52,16
Mvaa 200,56,16
Mvaa 204,60,16
Mvaa 208,32,20
Mvaa 212,36,20
Mvaa 216,40,20
Mvaa 220,44,20
Mvaa 224,48,20
Mvaa 228,52,20
Mvaa 232,56,20
Mvaa 236,60,20
Mvaa 240,32,24
Mvaa 244,36,24
Mvaa 248,40,24
Mvaa 252,44,24
Maaa 128,48,24
Maaa 132,52,24
Maaa 136,56,24
Maaa 140,60,24
Maaa 144,32,28
Maaa 148,36,28
Maaa 152,40,28
Maaa 156,44,28
Maaa 160,48,28
Maaa 164,52,28
Maaa 168,56,28
Maaa 172,60,28
s_waitcnt vmcnt(2) lgkmcnt(0)
s_add_u32 m0, s44, 0
s_barrier
Mvaa 48,96,64
buffer_load_dwordx4 v8, s[8:11], s48 offen offset:0 lds
Mvaa 52,100,64
Ta 32,22,0
Ta 34,22,2048
Mvaa 56,104,64
s_mul_i32 s3, s45, 33792
v_add_u32_e64 v10, s3, v2
Mvaa 60,108,64
Ra 0,20,0
Mvaa 64,112,64
buffer_load_dwordx4 v8, s[8:11], s49 offen offset:1024 lds
Mvaa 68,116,64
s_waitcnt lgkmcnt(6)
Ta 36,23,0
Ta 38,23,2048
Mvaa 72,120,64
s_mul_i32 s3, s46, 33792
v_add_u32 v11, s3, v2
v_mov_b32_e64 v14, v40
Mvaa 76,124,64
Ra 4,20,2048
Mvaa 80,96,68
buffer_load_dwordx4 v9, s[8:11], s50 offen offset:2048 lds
Mvaa 84,100,68
Ta 40,24,0
Ta 42,24,2048
Mvaa 88,104,68
v_mov_b32_e64 v15, v41
Mvaa 92,108,68
Ra 8,20,4096
Mvaa 96,112,68
buffer_load_dwordx4 v9, s[8:11], s51 offen offset:3072 lds
Mvaa 100,116,68
s_waitcnt lgkmcnt(6)
Ta 44,25,0
Ta 46,25,2048
Mvaa 104,120,68
v_add_u32 v8, 524288, v8
v_add_u32 v9, 524288, v9
Mvaa 108,124,68
s_add_u32 m0, s44, 16384
Ra 12,20,6144
Mvaa 112,96,72
buffer_load_dwordx4 v8, s[8:11], s48 offen offset:0 lds
Mvaa 116,100,72
Ta 48,26,0
Ta 50,26,2048
Mvaa 120,104,72
Mvaa 124,108,72
Ra 16,20,8192
Mvaa 128,112,72
buffer_load_dwordx4 v8, s[8:11], s49 offen offset:1024 lds
Mvaa 132,116,72
s_waitcnt lgkmcnt(6)
Ta 52,27,0
Ta 54,27,2048
Mvaa 136,120,72
Mvaa 140,124,72
Ra 20,20,10240
Mvaa 144,96,76
buffer_load_dwordx4 v9, s[8:11], s50 offen offset:2048 lds
Mvaa 148,100,76
Ta 56,28,0
Ta 58,28,2048
Mvaa 152,104,76
Mvaa 156,108,76
Ra 24,20,12288
Mvaa 160,112,76
buffer_load_dwordx4 v9, s[8:11], s51 offen offset:3072 lds
Mvaa 164,116,76
s_waitcnt lgkmcnt(6)
Ta 60,29,0
Ta 62,29,2048
Mvaa 168,120,76
v_add_u32 v8, 524288, v8
v_add_u32 v9, 524288, v9
Mvaa 172,124,76
s_add_u32 m0, s44, 32768
Ra 28,20,14336
Mvaa 176,96,80
buffer_load_dwordx4 v8, s[8:11], s48 offen offset:0 lds
Mvaa 180,100,80
Mvaa 184,104,80
Mvaa 188,108,80
Mvaa 192,112,80
buffer_load_dwordx4 v8, s[8:11], s49 offen offset:1024 lds
Mvaa 196,116,80
Mvaa 200,120,80
Mvaa 204,124,80
Mvaa 208,96,84
buffer_load_dwordx4 v9, s[8:11], s50 offen offset:2048 lds
Mvaa 212,100,84
Mvaa 216,104,84
Mvaa 220,108,84
Mvaa 224,112,84
buffer_load_dwordx4 v9, s[8:11], s51 offen offset:3072 lds
Mvaa 228,116,84
v_add_u32 v8, 524288, v8
v_add_u32 v9, 524288, v9
Mvaa 232,120,84
Mvaa 236,124,84
s_add_u32 m0, s44, 49152
Mvaa 240,96,88
buffer_load_dwordx4 v8, s[8:11], s48 offen offset:0 lds
Mvaa 244,100,88
Mvaa 248,104,88
Mvaa 252,108,88
Maaa 128,112,88
buffer_load_dwordx4 v8, s[8:11], s49 offen offset:1024 lds
Maaa 132,116,88
Maaa 136,120,88
Maaa 140,124,88
Maaa 144,96,92
buffer_load_dwordx4 v9, s[8:11], s50 offen offset:2048 lds
Maaa 148,100,92
Maaa 152,104,92
Maaa 156,108,92
Maaa 160,112,92
buffer_load_dwordx4 v9, s[8:11], s51 offen offset:3072 lds
Maaa 164,116,92
v_add_u32 v8, 524288, v8
v_add_u32 v9, 524288, v9
Maaa 168,120,92
Maaa 172,124,92
s_waitcnt lgkmcnt(0)
Mvaa 48,32,0
Mvaa 52,36,0
Ta 96,22,16384
Ta 98,22,18432
Mvaa 56,40,0
Mvaa 60,44,0
Ra 64,21,0
Mvaa 64,48,0
Mvaa 68,52,0
Ta 100,23,16384
Ta 102,23,18432
Mvaa 72,56,0
Mvaa 76,60,0
s_waitcnt lgkmcnt(6)
Ra 68,21,2048
Mvaa 80,32,4
Mvaa 84,36,4
Ta 104,24,16384
Ta 106,24,18432
Mvaa 88,40,4
Mvaa 92,44,4
Ra 72,21,4096
Mvaa 96,48,4
Mvaa 100,52,4
Ta 108,25,16384
Ta 110,25,18432
Mvaa 104,56,4
Mvaa 108,60,4
s_waitcnt lgkmcnt(6)
Ra 76,21,6144
Mvaa 112,32,8
Mvaa 116,36,8
Ta 112,26,16384
Ta 114,26,18432
Mvaa 120,40,8
Mvaa 124,44,8
Ra 80,21,8192
Mvaa 128,48,8
Mvaa 132,52,8
Ta 116,27,16384
Ta 118,27,18432
Mvaa 136,56,8
Mvaa 140,60,8
s_waitcnt lgkmcnt(6)
Ra 84,21,10240
Mvaa 144,32,12
Mvaa 148,36,12
Ta 120,28,16384
Ta 122,28,18432
Mvaa 152,40,12
Mvaa 156,44,12
Ra 88,21,12288
Mvaa 160,48,12
Mvaa 164,52,12
Ta 124,29,16384
Ta 126,29,18432
Mvaa 168,56,12
Mvaa 172,60,12
s_waitcnt lgkmcnt(6)
Ra 92,21,14336
Mvaa 176,32,16
Mvaa 180,36,16
Mvaa 184,40,16
Mvaa 188,44,16
Mvaa 192,48,16
Mvaa 196,52,16
Mvaa 200,56,16
Mvaa 204,60,16
Mvaa 208,32,20
Mvaa 212,36,20
Mvaa 216,40,20
Mvaa 220,44,20
Mvaa 224,48,20
Mvaa 228,52,20
Mvaa 232,56,20
Mvaa 236,60,20
Mvaa 240,32,24
Mvaa 244,36,24
Mvaa 248,40,24
Mvaa 252,44,24
Maaa 128,48,24
Maaa 132,52,24
Maaa 136,56,24
Maaa 140,60,24
Maaa 144,32,28
Maaa 148,36,28
Maaa 152,40,28
Maaa 156,44,28
Maaa 160,48,28
Maaa 164,52,28
Maaa 168,56,28
Maaa 172,60,28
s_waitcnt vmcnt(12) lgkmcnt(0)
v_readfirstlane_b32 s3, v30
s_nop 0
s_or_b32 s3, s3, s37
s_cmp_lt_u32 s3, 256
s_cbranch_scc1 L_spinAk
L_spinArk:
s_barrier
Mvaa 48,96,64
buffer_load_dwordx4 a[0:3], v10, s[20:23], s58 offen offset:0 sc1
Mvaa 52,100,64
v_lshrrev_b32_e64 v42, 2, v33
v_lshl_add_u32 v43, v32, 3, v42
Mvaa 56,104,64
v_lshlrev_b32 v43, 8, v43
v_and_b32 v44, 3, v0
Mvaa 60,108,64
v_lshl_add_u32 v43, v44, 3, v43
v_and_b32_e64 v44, 1, v32
Mvaa 64,112,64
buffer_load_dwordx4 a[4:7], v10, s[20:23], 0 offen offset:0 sc1
Mvaa 68,116,64
v_lshl_add_u32 v42, v44, 2, v42
v_xor_b32_e64 v44, 0, v42
Mvaa 72,120,64
v_lshl_add_u32 v16, v44, 5, v43
v_xor_b32_e64 v44, 1, v42
Mvaa 76,124,64
v_lshl_add_u32 v17, v44, 5, v43
v_xor_b32_e64 v44, 2, v42
Mvaa 80,96,68
buffer_load_dwordx4 a[8:11], v11, s[20:23], s58 offen offset:0 sc1
Mvaa 84,100,68
v_lshl_add_u32 v18, v44, 5, v43
v_xor_b32_e64 v44, 3, v42
Mvaa 88,104,68
v_lshl_add_u32 v19, v44, 5, v43
v_xor_b32_e64 v44, 4, v42
Mvaa 92,108,68
v_lshl_add_u32 v20, v44, 5, v43
v_xor_b32_e64 v44, 5, v42
Mvaa 96,112,68
buffer_load_dwordx4 a[12:15], v11, s[20:23], 0 offen offset:0 sc1
Mvaa 100,116,68
v_lshl_add_u32 v21, v44, 5, v43
v_xor_b32_e64 v44, 6, v42
Mvaa 104,120,68
v_lshl_add_u32 v22, v44, 5, v43
v_xor_b32_e64 v44, 7, v42
Mvaa 108,124,68
v_lshl_add_u32 v23, v44, 5, v43
Mvaa 112,96,72
buffer_load_dwordx4 a[16:19], v10, s[20:23], s58 offen offset:1024 sc1
Mvaa 116,100,72
Mvaa 120,104,72
Mvaa 124,108,72
Mvaa 128,112,72
buffer_load_dwordx4 a[20:23], v10, s[20:23], 0 offen offset:1024 sc1
Mvaa 132,116,72
Ta 192,16,0
Ta 194,16,1024
Mvaa 136,120,72
Ta 196,17,0
Ta 198,17,1024
Mvaa 140,124,72
Ta 200,18,0
Ta 202,18,1024
Mvaa 144,96,76
buffer_load_dwordx4 a[24:27], v11, s[20:23], s58 offen offset:1024 sc1
Mvaa 148,100,76
Ta 204,19,0
Ta 206,19,1024
Mvaa 152,104,76
Ta 208,20,0
Ta 210,20,1024
Mvaa 156,108,76
Ta 212,21,0
Ta 214,21,1024
Mvaa 160,112,76
buffer_load_dwordx4 a[28:31], v11, s[20:23], 0 offen offset:1024 sc1
Mvaa 164,116,76
Ta 216,22,0
Ta 218,22,1024
Mvaa 168,120,76
Ta 220,23,0
s_waitcnt lgkmcnt(9)
Ta 222,23,1024
Mvaa 172,124,76
s_waitcnt lgkmcnt(8)
Vc 24,48,49
Vc 25,50,51
Mvaa 176,96,80
buffer_load_dwordx4 a[32:35], v10, s[20:23], s58 offen offset:2048 sc1
Mvaa 180,100,80
Vc 26,52,53
Vc 27,54,55
Mvaa 184,104,80
Vc 28,56,57
Vc 29,58,59
Mvaa 188,108,80
Vc 30,60,61
Vc 31,62,63
Mvaa 192,112,80
buffer_load_dwordx4 a[36:39], v10, s[20:23], 0 offen offset:2048 sc1
Mvaa 196,116,80
Vc 32,64,65
Vc 33,66,67
Mvaa 200,120,80
Vc 34,68,69
Vc 35,70,71
Mvaa 204,124,80
Vc 36,72,73
Vc 37,74,75
Mvaa 208,96,84
buffer_load_dwordx4 a[40:43], v11, s[20:23], s58 offen offset:2048 sc1
Mvaa 212,100,84
Vc 38,76,77
Vc 39,78,79
Mvaa 216,104,84
Vc 40,80,81
Vc 41,82,83
Mvaa 220,108,84
Vc 42,84,85
Vc 43,86,87
Mvaa 224,112,84
buffer_load_dwordx4 a[44:47], v11, s[20:23], 0 offen offset:2048 sc1
Mvaa 228,116,84
Vc 44,88,89
Vc 45,90,91
Mvaa 232,120,84
Vc 46,92,93
Vc 47,94,95
Mvaa 236,124,84
Vc 48,96,97
Vc 49,98,99
Mvaa 240,96,88
buffer_load_dwordx4 a[48:51], v10, s[20:23], s58 offen offset:3072 sc1
Mvaa 244,100,88
Vc 50,100,101
Vc 51,102,103
Mvaa 248,104,88
Vc 52,104,105
Vc 53,106,107
Mvaa 252,108,88
Vc 54,108,109
Vc 55,110,111
Maaa 128,112,88
buffer_load_dwordx4 a[52:55], v10, s[20:23], 0 offen offset:3072 sc1
Maaa 132,116,88
Vc 56,112,113
Vc 57,114,115
Maaa 136,120,88
Vc 58,116,117
Vc 59,118,119
Maaa 140,124,88
Vc 60,120,121
Vc 61,122,123
Maaa 144,96,92
buffer_load_dwordx4 a[56:59], v11, s[20:23], s58 offen offset:3072 sc1
Maaa 148,100,92
Vc 62,124,125
Vc 63,126,127
Maaa 152,104,92
Vc 64,128,129
Vc 65,130,131
Maaa 156,108,92
Vc 66,132,133
Vc 67,134,135
Maaa 160,112,92
buffer_load_dwordx4 a[60:63], v11, s[20:23], 0 offen offset:3072 sc1
Maaa 164,116,92
v_add_u32 v10, 4096, v10
v_add_u32 v11, 4096, v11
Maaa 168,120,92
Vc 68,136,137
Vc 69,138,139
Maaa 172,124,92
Vc 70,140,141
Vc 71,142,143
Vc 72,144,145
Vc 73,146,147
Vc 74,148,149
Vc 75,150,151
Vc 76,152,153
Vc 77,154,155
Vc 78,156,157
Vc 79,158,159
Vc 80,160,161
Vc 81,162,163
Vc 82,164,165
Vc 83,166,167
Vc 84,168,169
Vc 85,170,171
Vc 86,172,173
Vc 87,174,175
Vc 88,176,177
Vc 89,178,179
Vc 90,180,181
Vc 91,182,183
Vc 92,184,185
Vc 93,186,187
Vc 94,188,189
Vc 95,190,191
Vc 96,192,193
Vc 97,194,195
Vc 98,196,197
Vc 99,198,199
Vc 100,200,201
Vc 101,202,203
Vc 102,204,205
Vc 103,206,207
Vc 104,208,209
Vc 105,210,211
Vc 106,212,213
Vc 107,214,215
Vc 108,216,217
Vc 109,218,219
Vc 110,220,221
Vc 111,222,223
Vc 112,224,225
Vc 113,226,227
Vc 114,228,229
Vc 115,230,231
Vc 116,232,233
Vc 117,234,235
Vc 118,236,237
Vc 119,238,239
Vc 120,240,241
Vc 121,242,243
Vc 122,244,245
Vc 123,246,247
Vc 124,248,249
Vc 125,250,251
Vc 126,252,253
Vc 127,254,255
s_branch L_phase2
L_k1_vpath:
s_waitcnt lgkmcnt(0)
s_add_u32 m0, s57, 65536
Zvaa 48,0,32
buffer_load_dwordx4 v6, s[12:15], s52 offen offset:0 nt lds
Zvaa 64,0,36
Ta 96,12,16384
Ta 98,12,18432
Zvaa 80,0,40
buffer_load_dwordx4 v7, s[12:15], s53 offen offset:1024 nt lds
Zvaa 96,0,44
Ra 64,11,0
Zvaa 112,0,48
buffer_load_dwordx4 v6, s[12:15], s54 offen offset:2048 nt lds
Zvaa 128,0,52
Ta 100,13,16384
Ta 102,13,18432
Zvaa 144,0,56
buffer_load_dwordx4 v7, s[12:15], s55 offen offset:3072 nt lds
Zvaa 160,0,60
s_add_u32 m0, s57, 69632
s_waitcnt lgkmcnt(6)
Ra 68,11,2048
Zvaa 52,4,32
buffer_load_dwordx4 v8, s[12:15], s52 offen offset:0 nt lds
Zvaa 68,4,36
Ta 104,14,16384
Ta 106,14,18432
Zvaa 84,4,40
buffer_load_dwordx4 v9, s[12:15], s53 offen offset:1024 nt lds
Zvaa 100,4,44
Ra 72,11,4096
Zvaa 116,4,48
buffer_load_dwordx4 v8, s[12:15], s54 offen offset:2048 nt lds
Zvaa 132,4,52
Ta 108,15,16384
Ta 110,15,18432
Zvaa 148,4,56
buffer_load_dwordx4 v9, s[12:15], s55 offen offset:3072 nt lds
Zvaa 164,4,60
s_add_u32 m0, s56, 65536
s_waitcnt lgkmcnt(6)
Ra 76,11,6144
Zvaa 56,8,32
buffer_load_dwordx4 v2, s[8:11], s48 offen offset:0 lds
Zvaa 72,8,36
Ta 112,16,16384
Ta 114,16,18432
Zvaa 88,8,40
buffer_load_dwordx4 v3, s[8:11], s49 offen offset:1024 lds
Zvaa 104,8,44
Ra 80,11,8192
v_xor_b32 v6, 1572864, v6
Zvaa 120,8,48
buffer_load_dwordx4 v2, s[8:11], s50 offen offset:2048 lds
Zvaa 136,8,52
Ta 116,17,16384
Ta 118,17,18432
Zvaa 152,8,56
buffer_load_dwordx4 v3, s[8:11], s51 offen offset:3072 lds
Zvaa 168,8,60
s_add_u32 m0, s56, 69632
s_waitcnt lgkmcnt(6)
Ra 84,11,10240
Zvaa 60,12,32
buffer_load_dwordx4 v4, s[8:11], s48 offen offset:0 lds
Zvaa 76,12,36
Ta 120,18,16384
Ta 122,18,18432
Zvaa 92,12,40
buffer_load_dwordx4 v5, s[8:11], s49 offen offset:1024 lds
Zvaa 108,12,44
Ra 88,11,12288
v_xor_b32 v7, 1572864, v7
Zvaa 124,12,48
buffer_load_dwordx4 v4, s[8:11], s50 offen offset:2048 lds
Zvaa 140,12,52
Ta 124,19,16384
Ta 126,19,18432
Zvaa 156,12,56
buffer_load_dwordx4 v5, s[8:11], s51 offen offset:3072 lds
Zvaa 172,12,60
s_waitcnt lgkmcnt(6)
Ra 92,11,14336
Zvaa 176,16,32
v_and_b32_e64 v46, 7, v0
v_mul_u32_u24 v30, 2064, v46
Zvaa 192,16,36
v_xor_b32 v8, 1572864, v8
v_xor_b32 v9, 1572864, v9
Zvaa 208,16,40
v_lshrrev_b32_e64 v31, 3, v0
Zvaa 224,16,44
v_xor_b32 v2, 384, v2
v_xor_b32 v3, 384, v3
Zvaa 240,16,48
s_lshl_b32 s3, s32, 9
s_add_u32 s3, s3, 131072
v_lshl_add_u32 v30, v31, 4, v30
Zaaa 128,16,52
v_xor_b32 v4, 384, v4
v_xor_b32 v5, 384, v5
Zaaa 144,16,56
v_add_u32 v30, s3, v30
v_lshlrev_b32_e64 v31, 8, v31
Zaaa 160,16,60
v_lshl_add_u32 v46, v46, 4, v31
Zvaa 180,20,32
buffer_load_dword v1, v47, s[60:63], 0 offen
Zvaa 196,20,36
s_mul_i32 vcc_lo, s59, 7
v_xor_b32 v47, vcc_lo, v47
Zvaa 212,20,40
Rv 34,30,128
Rv 38,30,256
Zvaa 228,20,44
Rv 42,30,384
Rv 30,30,0
Zvaa 244,20,48
buffer_load_dword v1, v47, s[60:63], 0 offen
Zaaa 132,20,52
s_mul_i32 vcc_lo, s59, 1
v_xor_b32 v47, vcc_lo, v47
Zaaa 148,20,56
s_lshr_b32 s3, s2, 1
s_mul_i32 s3, s3, 33792
s_add_u32 s3, s3, s56
Zaaa 164,20,60
s_and_b32 s39, s2, 1
s_lshl_b32 s39, s39, 7
s_add_u32 s3, s3, s39
Zvaa 184,24,32
s_add_u32 s39, s3, 4096
Zvaa 200,24,36
Zvaa 216,24,40
Zvaa 232,24,44
Zvaa 248,24,48
Zaaa 136,24,52
Zaaa 152,24,56
Zaaa 168,24,60
Zvaa 188,28,32
Zvaa 204,28,36
Zvaa 220,28,40
Zvaa 236,28,44
Zvaa 252,28,48
Zaaa 140,28,52
Zaaa 156,28,56
Zaaa 172,28,60
s_waitcnt vmcnt(2) lgkmcnt(0)
s_add_u32 m0, s57, 0
s_barrier
Mvaa 48,64,96
buffer_load_dwordx4 v6, s[12:15], s52 offen offset:0 nt lds
Mvaa 64,64,100
Ta 32,22,0
Ta 34,22,2048
Mvaa 80,64,104
Mvaa 96,64,108
Ra 0,20,0
Mvaa 112,64,112
buffer_load_dwordx4 v7, s[12:15], s53 offen offset:1024 nt lds
Mvaa 128,64,116
s_waitcnt lgkmcnt(6)
Ta 36,23,0
Ta 38,23,2048
Mvaa 144,64,120
Mvaa 160,64,124
Ra 4,20,2048
Mvaa 52,68,96
buffer_load_dwordx4 v6, s[12:15], s54 offen offset:2048 nt lds
Mvaa 68,68,100
Ta 40,24,0
Ta 42,24,2048
Mvaa 84,68,104
Mvaa 100,68,108
Ra 8,20,4096
Mvaa 116,68,112
buffer_load_dwordx4 v7, s[12:15], s55 offen offset:3072 nt lds
Mvaa 132,68,116
s_waitcnt lgkmcnt(6)
Ta 44,25,0
Ta 46,25,2048
Mvaa 148,68,120
Mvaa 164,68,124
s_add_u32 m0, s57, 4096
Ra 12,20,6144
Mvaa 56,72,96
buffer_load_dwordx4 v8, s[12:15], s52 offen offset:0 nt lds
Mvaa 72,72,100
Ta 48,26,0
Ta 50,26,2048
Mvaa 88,72,104
Mvaa 104,72,108
Ra 16,20,8192
Mvaa 120,72,112
buffer_load_dwordx4 v9, s[12:15], s53 offen offset:1024 nt lds
Mvaa 136,72,116
s_waitcnt lgkmcnt(6)
Ta 52,27,0
Ta 54,27,2048
Mvaa 152,72,120
Mvaa 168,72,124
Ra 20,20,10240
Mvaa 60,76,96
buffer_load_dwordx4 v8, s[12:15], s54 offen offset:2048 nt lds
Mvaa 76,76,100
Ta 56,28,0
Ta 58,28,2048
Mvaa 92,76,104
Mvaa 108,76,108
Ra 24,20,12288
Mvaa 124,76,112
buffer_load_dwordx4 v9, s[12:15], s55 offen offset:3072 nt lds
Mvaa 140,76,116
s_waitcnt lgkmcnt(6)
Ta 60,29,0
Ta 62,29,2048
Mvaa 156,76,120
v_xor_b32 v6, 524288, v6
v_xor_b32 v7, 524288, v7
Mvaa 172,76,124
s_add_u32 m0, s56, 0
Ra 28,20,14336
v_xor_b32 v8, 524288, v8
Mvaa 176,80,96
buffer_load_dwordx4 v2, s[8:11], s48 offen offset:0 lds
Mvaa 192,80,100
v_xor_b32 v9, 524288, v9
Mvaa 208,80,104
Mvaa 224,80,108
Mvaa 240,80,112
buffer_load_dwordx4 v3, s[8:11], s49 offen offset:1024 lds
Maaa 128,80,116
Maaa 144,80,120
Maaa 160,80,124
Mvaa 180,84,96
buffer_load_dwordx4 v2, s[8:11], s50 offen offset:2048 lds
Mvaa 196,84,100
Mvaa 212,84,104
Mvaa 228,84,108
Mvaa 244,84,112
buffer_load_dwordx4 v3, s[8:11], s51 offen offset:3072 lds
Maaa 132,84,116
Maaa 148,84,120
Maaa 164,84,124
s_add_u32 m0, s56, 4096
Mvaa 184,88,96
buffer_load_dwordx4 v4, s[8:11], s48 offen offset:0 lds
Mvaa 200,88,100
Mvaa 216,88,104
Mvaa 232,88,108
Mvaa 248,88,112
buffer_load_dwordx4 v5, s[8:11], s49 offen offset:1024 lds
Maaa 136,88,116
Maaa 152,88,120
Maaa 168,88,124
Mvaa 188,92,96
buffer_load_dwordx4 v4, s[8:11], s50 offen offset:2048 lds
Mvaa 204,92,100
Mvaa 220,92,104
Mvaa 236,92,108
Mvaa 252,92,112
buffer_load_dwordx4 v5, s[8:11], s51 offen offset:3072 lds
Maaa 140,92,116
v_xor_b32 v2, 128, v2
v_xor_b32 v3, 128, v3
Maaa 156,92,120
buffer_load_dword v1, v47, s[60:63], 0 offen
v_xor_b32 v4, 128, v4
v_xor_b32 v5, 128, v5
Maaa 172,92,124
s_mul_i32 vcc_lo, s59, 3
v_xor_b32 v47, vcc_lo, v47
s_waitcnt lgkmcnt(0)
Mvaa 48,0,32
buffer_store_dwordx4 v[30:33], v46, s[20:23], s3 offen offset:0 sc1
Mvaa 64,0,36
Ta 96,22,16384
Ta 98,22,18432
Mvaa 80,0,40
buffer_store_dwordx4 v[34:37], v46, s[20:23], s3 offen offset:2048 sc1
Mvaa 96,0,44
Ra 64,21,0
Mvaa 112,0,48
buffer_store_dwordx4 v[38:41], v46, s[20:23], s39 offen offset:0 sc1
Mvaa 128,0,52
Ta 100,23,16384
Ta 102,23,18432
Mvaa 144,0,56
buffer_store_dwordx4 v[42:45], v46, s[20:23], s39 offen offset:2048 sc1
Mvaa 160,0,60
s_waitcnt lgkmcnt(6)
Ra 68,21,2048
Mvaa 52,4,32
s_lshl_b32 s3, s34, 1
s_and_b32 s36, s32, 1
s_add_u32 s3, s3, s36
Mvaa 68,4,36
Ta 104,24,16384
Ta 106,24,18432
Mvaa 84,4,40
s_mul_i32 s3, s3, 1116160
s_mul_i32 s36, s33, 139264
s_add_u32 s3, s3, s36
Mvaa 100,4,44
Ra 72,21,4096
Mvaa 116,4,48
s_lshr_b32 s36, s32, 1
s_mul_i32 s36, s36, 69632
s_add_u32 s3, s3, s36
Mvaa 132,4,52
Ta 108,25,16384
Ta 110,25,18432
Mvaa 148,4,56
s_add_u32 s38, s3, 17408
s_lshl_b32 s39, s34, 7
s_lshl_b32 s36, s33, 2
Mvaa 164,4,60
s_waitcnt lgkmcnt(6)
Ra 76,21,6144
Mvaa 56,8,32
s_add_u32 s39, s39, s36
s_add_u32 s39, s39, 5296160
v_mov_b32 v30, 1
Mvaa 72,8,36
Ta 112,26,16384
Ta 114,26,18432
Mvaa 88,8,40
v_mov_b32_e64 v31, 0
Mvaa 104,8,44
Ra 80,21,8192
Mvaa 120,8,48
s_cmp_eq_u32 s32, 0
s_cselect_b32 s39, s39, 2146435072
Mvaa 136,8,52
Ta 116,27,16384
Ta 118,27,18432
Mvaa 152,8,56
s_mov_b64 exec, 1
buffer_store_dword v31, v31, s[20:23], s39 offen sc1
s_mov_b64 exec, -1
Mvaa 168,8,60
s_waitcnt lgkmcnt(6)
Ra 84,21,10240
Mvaa 60,12,32
s_and_b32 s33, s2, 7
s_lshl_b32 s33, s33, 2
s_bfe_u32 s3, s2, 0x20003
Mvaa 76,12,36
Ta 120,28,16384
Ta 122,28,18432
Mvaa 92,12,40
s_add_u32 s33, s33, s3
s_lshr_b32 s34, s2, 5
s_lshl_b32 s64, s34, 7
Mvaa 108,12,44
Ra 88,21,12288
Mvaa 124,12,48
s_lshl_b32 s3, s33, 2
s_add_u32 s64, s64, s3
s_add_u32 s64, s64, 5300224
Mvaa 140,12,52
Ta 124,29,16384
Ta 126,29,18432
Mvaa 156,12,56
s_lshl_b32 s65, s34, 8
s_sub_u32 s65, 1920, s65
v_mul_u32_u24_e64 v32, s65, v0
Mvaa 172,12,60
s_waitcnt lgkmcnt(6)
Ra 92,21,14336
Mvaa 176,16,32
s_cmp_eq_u32 s32, 0
s_cselect_b32 s64, s64, 2146435072
Mvaa 192,16,36
s_mov_b64 exec, 3
buffer_store_dword v31, v32, s[20:23], s64 offen sc1
s_mov_b64 exec, -1
Mvaa 208,16,40
s_lshl_b32 s3, s2, 2
s_add_u32 s3, s3, 5302272
v_lshlrev_b32 v32, 10, v0
Mvaa 224,16,44
s_cmp_eq_u32 s32, 0
s_cselect_b32 s3, s3, 2146435072
Mvaa 240,16,48
s_mov_b64 exec, 31
buffer_store_dword v31, v32, s[20:23], s3 offen sc1
s_mov_b64 exec, -1
Maaa 128,16,52
s_lshl_b32 s35, s34, 1
s_sub_u32 s36, 32, s35
s_add_u32 s35, s35, 2
Maaa 144,16,56
s_lshl_b32 s44, s32, 12
s_lshl_b32 s58, s32, 1
s_sub_u32 s58, 7, s58
Maaa 160,16,60
s_mul_i32 s58, s58, 33792
s_sub_u32 s3, 15, s34
s_lshl_b32 s45, s3, 3
Mvaa 180,20,32
s_add_u32 s45, s45, s32
s_lshl_b32 s46, s34, 3
s_add_u32 s46, s46, s32
Mvaa 196,20,36
s_mov_b32 s68, s42
s_and_b32 s69, s43, 0xffff
s_mov_b32 s70, 7340032
Mvaa 212,20,40
s_mov_b32 s71, 0x20000
s_cmp_eq_u32 s32, 0
s_cselect_b32 s37, 0, 2146435072
Mvaa 228,20,44
s_lshl_b32 s3, s33, 8
s_add_u32 s16, s4, s3
s_addc_u32 s17, s5, 0
s_and_b32 s17, s17, 0xffff
Mvaa 244,20,48
s_mov_b32 s18, 0
s_mov_b32 s19, 0x20000
s_sub_u32 s18, 8388608, s3
Maaa 132,20,52
v_and_b32 v33, 15, v0
v_lshrrev_b32 v32, 1, v33
Maaa 148,20,56
v_and_b32 v33, 1, v0
v_lshlrev_b32 v32, 13, v32
Maaa 164,20,60
v_lshl_add_u32 v45, v33, 7, v32
Mvaa 184,24,32
s_lshl_b32 s3, s32, 3
s_add_u32 s3, s3, s34
s_mul_i32 s47, s3, 65536
Mvaa 200,24,36
s_bfe_u32 s6, s2, 131075
s_lshl_b32 s3, s32, 8
s_or_b32 s6, s6, s3
Mvaa 216,24,40
Mvaa 232,24,44
Mvaa 248,24,48
Maaa 136,24,52
Maaa 152,24,56
Maaa 168,24,60
Mvaa 188,28,32
Mvaa 204,28,36
Mvaa 220,28,40
Mvaa 236,28,44
Mvaa 252,28,48
Maaa 140,28,52
Maaa 156,28,56
Maaa 172,28,60
s_waitcnt vmcnt(8) lgkmcnt(0)
s_add_u32 m0, s57, 65536
s_barrier
Mvaa 48,64,96
buffer_load_dwordx4 v6, s[12:15], s52 offen offset:0 nt lds
Mvaa 64,64,100
Ta 32,12,0
Ta 34,12,2048
Mvaa 80,64,104
Mvaa 96,64,108
Ra 0,10,0
Mvaa 112,64,112
buffer_load_dwordx4 v7, s[12:15], s53 offen offset:1024 nt lds
Mvaa 128,64,116
s_waitcnt lgkmcnt(6)
Ta 36,13,0
Ta 38,13,2048
Mvaa 144,64,120
Mvaa 160,64,124
Ra 4,10,2048
Mvaa 52,68,96
buffer_load_dwordx4 v6, s[12:15], s54 offen offset:2048 nt lds
Mvaa 68,68,100
Ta 40,14,0
Ta 42,14,2048
Mvaa 84,68,104
Mvaa 100,68,108
Ra 8,10,4096
Mvaa 116,68,112
buffer_load_dwordx4 v7, s[12:15], s55 offen offset:3072 nt lds
Mvaa 132,68,116
s_waitcnt lgkmcnt(6)
Ta 44,15,0
Ta 46,15,2048
Mvaa 148,68,120
Mvaa 164,68,124
s_add_u32 m0, s57, 69632
Ra 12,10,6144
Mvaa 56,72,96
buffer_load_dwordx4 v8, s[12:15], s52 offen offset:0 nt lds
Mvaa 72,72,100
Ta 48,16,0
Ta 50,16,2048
Mvaa 88,72,104
Mvaa 104,72,108
Ra 16,10,8192
Mvaa 120,72,112
buffer_load_dwordx4 v9, s[12:15], s53 offen offset:1024 nt lds
Mvaa 136,72,116
s_waitcnt lgkmcnt(6)
Ta 52,17,0
Ta 54,17,2048
Mvaa 152,72,120
Mvaa 168,72,124
Ra 20,10,10240
Mvaa 60,76,96
buffer_load_dwordx4 v8, s[12:15], s54 offen offset:2048 nt lds
Mvaa 76,76,100
Ta 56,18,0
Ta 58,18,2048
Mvaa 92,76,104
Mvaa 108,76,108
Ra 24,10,12288
Mvaa 124,76,112
buffer_load_dwordx4 v9, s[12:15], s55 offen offset:3072 nt lds
Mvaa 140,76,116
s_waitcnt lgkmcnt(6)
Ta 60,19,0
Ta 62,19,2048
Mvaa 156,76,120
v_xor_b32 v6, 3670016, v6
v_xor_b32 v7, 3670016, v7
Mvaa 172,76,124
s_add_u32 m0, s56, 65536
Ra 28,10,14336
v_xor_b32 v8, 3670016, v8
Mvaa 176,80,96
buffer_load_dwordx4 v2, s[8:11], s48 offen offset:0 lds
Mvaa 192,80,100
v_xor_b32 v9, 3670016, v9
Mvaa 208,80,104
Mvaa 224,80,108
Mvaa 240,80,112
buffer_load_dwordx4 v3, s[8:11], s49 offen offset:1024 lds
Maaa 128,80,116
Maaa 144,80,120
Maaa 160,80,124
Mvaa 180,84,96
buffer_load_dwordx4 v2, s[8:11], s50 offen offset:2048 lds
Mvaa 196,84,100
Mvaa 212,84,104
Mvaa 228,84,108
Mvaa 244,84,112
buffer_load_dwordx4 v3, s[8:11], s51 offen offset:3072 lds
Maaa 132,84,116
Maaa 148,84,120
Maaa 164,84,124
s_add_u32 m0, s56, 69632
Mvaa 184,88,96
buffer_load_dwordx4 v4, s[8:11], s48 offen offset:0 lds
Mvaa 200,88,100
Mvaa 216,88,104
Mvaa 232,88,108
Mvaa 248,88,112
buffer_load_dwordx4 v5, s[8:11], s49 offen offset:1024 lds
Maaa 136,88,116
Maaa 152,88,120
Maaa 168,88,124
Mvaa 188,92,96
buffer_load_dwordx4 v4, s[8:11], s50 offen offset:2048 lds
Mvaa 204,92,100
Mvaa 220,92,104
Mvaa 236,92,108
Mvaa 252,92,112
buffer_load_dwordx4 v5, s[8:11], s51 offen offset:3072 lds
Maaa 140,92,116
v_xor_b32 v2, 896, v2
v_xor_b32 v3, 896, v3
Maaa 156,92,120
buffer_load_dword v1, v47, s[60:63], 0 offen
v_xor_b32 v4, 896, v4
v_xor_b32 v5, 896, v5
Maaa 172,92,124
s_mul_i32 vcc_lo, s59, 1
v_xor_b32 v47, vcc_lo, v47
s_waitcnt lgkmcnt(0)
Mvaa 48,0,32
Mvaa 64,0,36
Ta 96,12,16384
Ta 98,12,18432
Mvaa 80,0,40
Mvaa 96,0,44
Ra 64,11,0
Mvaa 112,0,48
Mvaa 128,0,52
Ta 100,13,16384
Ta 102,13,18432
Mvaa 144,0,56
Mvaa 160,0,60
s_waitcnt lgkmcnt(6)
Ra 68,11,2048
Mvaa 52,4,32
Mvaa 68,4,36
Ta 104,14,16384
Ta 106,14,18432
Mvaa 84,4,40
Mvaa 100,4,44
Ra 72,11,4096
Mvaa 116,4,48
Mvaa 132,4,52
Ta 108,15,16384
Ta 110,15,18432
Mvaa 148,4,56
Mvaa 164,4,60
s_waitcnt lgkmcnt(6)
Ra 76,11,6144
Mvaa 56,8,32
Mvaa 72,8,36
Ta 112,16,16384
Ta 114,16,18432
Mvaa 88,8,40
Mvaa 104,8,44
Ra 80,11,8192
Mvaa 120,8,48
Mvaa 136,8,52
Ta 116,17,16384
Ta 118,17,18432
Mvaa 152,8,56
Mvaa 168,8,60
s_waitcnt lgkmcnt(6)
Ra 84,11,10240
Mvaa 60,12,32
Mvaa 76,12,36
Ta 120,18,16384
Ta 122,18,18432
Mvaa 92,12,40
Mvaa 108,12,44
Ra 88,11,12288
Mvaa 124,12,48
Mvaa 140,12,52
Ta 124,19,16384
Ta 126,19,18432
Mvaa 156,12,56
Mvaa 172,12,60
s_waitcnt lgkmcnt(6)
Ra 92,11,14336
Mvaa 176,16,32
Mvaa 192,16,36
Mvaa 208,16,40
Mvaa 224,16,44
Mvaa 240,16,48
Maaa 128,16,52
Maaa 144,16,56
Maaa 160,16,60
Mvaa 180,20,32
Mvaa 196,20,36
Mvaa 212,20,40
Mvaa 228,20,44
Mvaa 244,20,48
Maaa 132,20,52
Maaa 148,20,56
Maaa 164,20,60
Mvaa 184,24,32
Mvaa 200,24,36
Mvaa 216,24,40
Mvaa 232,24,44
Mvaa 248,24,48
Maaa 136,24,52
Maaa 152,24,56
Maaa 168,24,60
Mvaa 188,28,32
Mvaa 204,28,36
Mvaa 220,28,40
Mvaa 236,28,44
Mvaa 252,28,48
Maaa 140,28,52
Maaa 156,28,56
Maaa 172,28,60
s_waitcnt vmcnt(1) lgkmcnt(0)
s_add_u32 m0, s57, 0
s_barrier
Mvaa 48,64,96
buffer_load_dwordx4 v6, s[12:15], s52 offen offset:0 nt lds
Mvaa 64,64,100
Ta 32,22,0
Ta 34,22,2048
Mvaa 80,64,104
Mvaa 96,64,108
Ra 0,20,0
Mvaa 112,64,112
buffer_load_dwordx4 v7, s[12:15], s53 offen offset:1024 nt lds
Mvaa 128,64,116
s_waitcnt lgkmcnt(6)
Ta 36,23,0
Ta 38,23,2048
Mvaa 144,64,120
Mvaa 160,64,124
Ra 4,20,2048
Mvaa 52,68,96
buffer_load_dwordx4 v6, s[12:15], s54 offen offset:2048 nt lds
Mvaa 68,68,100
Ta 40,24,0
Ta 42,24,2048
Mvaa 84,68,104
Mvaa 100,68,108
Ra 8,20,4096
Mvaa 116,68,112
buffer_load_dwordx4 v7, s[12:15], s55 offen offset:3072 nt lds
Mvaa 132,68,116
s_waitcnt lgkmcnt(6)
Ta 44,25,0
Ta 46,25,2048
Mvaa 148,68,120
s_cmp_eq_u32 s6, 0
s_cselect_b32 s3, 0, 2146435072
Mvaa 164,68,124
s_add_u32 m0, s57, 4096
Ra 12,20,6144
Mvaa 56,72,96
buffer_load_dwordx4 v8, s[12:15], s52 offen offset:0 nt lds
Mvaa 72,72,100
Ta 48,26,0
Ta 50,26,2048
Mvaa 88,72,104
s_mov_b64 exec, 1
buffer_atomic_add v30, v31, s[28:31], s3 offen sc1
s_mov_b64 exec, -1
Mvaa 104,72,108
Ra 16,20,8192
Mvaa 120,72,112
buffer_load_dwordx4 v9, s[12:15], s53 offen offset:1024 nt lds
Mvaa 136,72,116
s_waitcnt lgkmcnt(6)
Ta 52,27,0
Ta 54,27,2048
Mvaa 152,72,120
Mvaa 168,72,124
Ra 20,20,10240
Mvaa 60,76,96
buffer_load_dwordx4 v8, s[12:15], s54 offen offset:2048 nt lds
Mvaa 76,76,100
Ta 56,28,0
Ta 58,28,2048
Mvaa 92,76,104
Mvaa 108,76,108
Ra 24,20,12288
Mvaa 124,76,112
buffer_load_dwordx4 v9, s[12:15], s55 offen offset:3072 nt lds
Mvaa 140,76,116
s_waitcnt lgkmcnt(6)
Ta 60,29,0
Ta 62,29,2048
Mvaa 156,76,120
v_xor_b32 v6, 524288, v6
v_xor_b32 v7, 524288, v7
Mvaa 172,76,124
s_add_u32 m0, s56, 0
Ra 28,20,14336
v_xor_b32 v8, 524288, v8
Mvaa 176,80,96
buffer_load_dwordx4 v2, s[8:11], s48 offen offset:0 lds
Mvaa 192,80,100
v_xor_b32 v9, 524288, v9
Mvaa 208,80,104
Mvaa 224,80,108
Mvaa 240,80,112
buffer_load_dwordx4 v3, s[8:11], s49 offen offset:1024 lds
Maaa 128,80,116
Maaa 144,80,120
Maaa 160,80,124
Mvaa 180,84,96
buffer_load_dwordx4 v2, s[8:11], s50 offen offset:2048 lds
Mvaa 196,84,100
Mvaa 212,84,104
Mvaa 228,84,108
Mvaa 244,84,112
buffer_load_dwordx4 v3, s[8:11], s51 offen offset:3072 lds
Maaa 132,84,116
Maaa 148,84,120
Maaa 164,84,124
s_add_u32 m0, s56, 4096
Mvaa 184,88,96
buffer_load_dwordx4 v4, s[8:11], s48 offen offset:0 lds
Mvaa 200,88,100
Mvaa 216,88,104
Mvaa 232,88,108
Mvaa 248,88,112
buffer_load_dwordx4 v5, s[8:11], s49 offen offset:1024 lds
Maaa 136,88,116
Maaa 152,88,120
Maaa 168,88,124
Mvaa 188,92,96
buffer_load_dwordx4 v4, s[8:11], s50 offen offset:2048 lds
Mvaa 204,92,100
Mvaa 220,92,104
Mvaa 236,92,108
Mvaa 252,92,112
buffer_load_dwordx4 v5, s[8:11], s51 offen offset:3072 lds
Maaa 140,92,116
v_xor_b32 v2, 128, v2
v_xor_b32 v3, 128, v3
Maaa 156,92,120
buffer_load_dword v1, v47, s[60:63], 0 offen
v_xor_b32 v4, 128, v4
v_xor_b32 v5, 128, v5
Maaa 172,92,124
s_mul_i32 vcc_lo, s59, 7
v_xor_b32 v47, vcc_lo, v47
s_waitcnt lgkmcnt(0)
Mvaa 48,0,32
buffer_load_dword v44, v45, s[16:19], s47 offen
Mvaa 64,0,36
Ta 96,22,16384
Ta 98,22,18432
Mvaa 80,0,40
s_add_u32 s47, s47, 2097152
Mvaa 96,0,44
Ra 64,21,0
Mvaa 112,0,48
Mvaa 128,0,52
Ta 100,23,16384
Ta 102,23,18432
Mvaa 144,0,56
Mvaa 160,0,60
s_waitcnt lgkmcnt(6)
Ra 68,21,2048
Mvaa 52,4,32
Mvaa 68,4,36
Ta 104,24,16384
Ta 106,24,18432
Mvaa 84,4,40
Mvaa 100,4,44
Ra 72,21,4096
Mvaa 116,4,48
Mvaa 132,4,52
Ta 108,25,16384
Ta 110,25,18432
Mvaa 148,4,56
Mvaa 164,4,60
s_waitcnt lgkmcnt(6)
Ra 76,21,6144
Mvaa 56,8,32
Mvaa 72,8,36
Ta 112,26,16384
Ta 114,26,18432
Mvaa 88,8,40
Mvaa 104,8,44
Ra 80,21,8192
Mvaa 120,8,48
Mvaa 136,8,52
Ta 116,27,16384
Ta 118,27,18432
Mvaa 152,8,56
Mvaa 168,8,60
s_waitcnt lgkmcnt(6)
Ra 84,21,10240
Mvaa 60,12,32
Mvaa 76,12,36
Ta 120,28,16384
Ta 122,28,18432
Mvaa 92,12,40
s_cmp_eq_u32 s6, 1
s_cselect_b32 s3, 0, 2146435072
Mvaa 108,12,44
Ra 88,21,12288
Mvaa 124,12,48
s_mov_b64 exec, 1
buffer_atomic_add v30, v31, s[28:31], s3 offen sc1
s_mov_b64 exec, -1
Mvaa 140,12,52
Ta 124,29,16384
Ta 126,29,18432
Mvaa 156,12,56
Mvaa 172,12,60
s_waitcnt lgkmcnt(6)
Ra 92,21,14336
Mvaa 176,16,32
Mvaa 192,16,36
Mvaa 208,16,40
Mvaa 224,16,44
Mvaa 240,16,48
Maaa 128,16,52
Maaa 144,16,56
Maaa 160,16,60
Mvaa 180,20,32
Mvaa 196,20,36
Mvaa 212,20,40
Mvaa 228,20,44
Mvaa 244,20,48
Maaa 132,20,52
Maaa 148,20,56
Maaa 164,20,60
Mvaa 184,24,32
Mvaa 200,24,36
Mvaa 216,24,40
Mvaa 232,24,44
Mvaa 248,24,48
Maaa 136,24,52
Maaa 152,24,56
Maaa 168,24,60
Mvaa 188,28,32
Mvaa 204,28,36
Mvaa 220,28,40
Mvaa 236,28,44
Mvaa 252,28,48
Maaa 140,28,52
Maaa 156,28,56
Maaa 172,28,60
s_waitcnt vmcnt(3) lgkmcnt(0)
s_add_u32 m0, s57, 65536
s_barrier
Mvaa 48,64,96
buffer_load_dwordx4 v6, s[12:15], s52 offen offset:0 nt lds
Mvaa 64,64,100
Ta 32,12,0
Ta 34,12,2048
Mvaa 80,64,104
Mvaa 96,64,108
Ra 0,10,0
Mvaa 112,64,112
buffer_load_dwordx4 v7, s[12:15], s53 offen offset:1024 nt lds
Mvaa 128,64,116
s_waitcnt lgkmcnt(6)
Ta 36,13,0
Ta 38,13,2048
Mvaa 144,64,120
Mvaa 160,64,124
Ra 4,10,2048
Mvaa 52,68,96
buffer_load_dwordx4 v6, s[12:15], s54 offen offset:2048 nt lds
Mvaa 68,68,100
Ta 40,14,0
Ta 42,14,2048
Mvaa 84,68,104
Mvaa 100,68,108
Ra 8,10,4096
Mvaa 116,68,112
buffer_load_dwordx4 v7, s[12:15], s55 offen offset:3072 nt lds
Mvaa 132,68,116
s_waitcnt lgkmcnt(6)
Ta 44,15,0
Ta 46,15,2048
Mvaa 148,68,120
Mvaa 164,68,124
s_add_u32 m0, s57, 69632
Ra 12,10,6144
Mvaa 56,72,96
buffer_load_dwordx4 v8, s[12:15], s52 offen offset:0 nt lds
Mvaa 72,72,100
Ta 48,16,0
Ta 50,16,2048
Mvaa 88,72,104
Mvaa 104,72,108
Ra 16,10,8192
Mvaa 120,72,112
buffer_load_dwordx4 v9, s[12:15], s53 offen offset:1024 nt lds
Mvaa 136,72,116
s_waitcnt lgkmcnt(6)
Ta 52,17,0
Ta 54,17,2048
Mvaa 152,72,120
Mvaa 168,72,124
Ra 20,10,10240
Mvaa 60,76,96
buffer_load_dwordx4 v8, s[12:15], s54 offen offset:2048 nt lds
Mvaa 76,76,100
Ta 56,18,0
Ta 58,18,2048
Mvaa 92,76,104
Mvaa 108,76,108
Ra 24,10,12288
Mvaa 124,76,112
buffer_load_dwordx4 v9, s[12:15], s55 offen offset:3072 nt lds
Mvaa 140,76,116
s_waitcnt lgkmcnt(6)
Ta 60,19,0
Ta 62,19,2048
Mvaa 156,76,120
v_xor_b32 v6, 1572864, v6
v_xor_b32 v7, 1572864, v7
Mvaa 172,76,124
s_add_u32 m0, s56, 65536
Ra 28,10,14336
v_xor_b32 v8, 1572864, v8
Mvaa 176,80,96
buffer_load_dwordx4 v2, s[8:11], s48 offen offset:0 lds
Mvaa 192,80,100
v_xor_b32 v9, 1572864, v9
Mvaa 208,80,104
Mvaa 224,80,108
Mvaa 240,80,112
buffer_load_dwordx4 v3, s[8:11], s49 offen offset:1024 lds
Maaa 128,80,116
Maaa 144,80,120
Maaa 160,80,124
s_cmp_eq_u32 s6, 2
s_cselect_b32 s3, 0, 2146435072
Mvaa 180,84,96
buffer_load_dwordx4 v2, s[8:11], s50 offen offset:2048 lds
Mvaa 196,84,100
s_mov_b64 exec, 1
buffer_atomic_add v30, v31, s[28:31], s3 offen sc1
s_mov_b64 exec, -1
Mvaa 212,84,104
Mvaa 228,84,108
Mvaa 244,84,112
buffer_load_dwordx4 v3, s[8:11], s51 offen offset:3072 lds
Maaa 132,84,116
Maaa 148,84,120
Maaa 164,84,124
s_add_u32 m0, s56, 69632
Mvaa 184,88,96
buffer_load_dwordx4 v4, s[8:11], s48 offen offset:0 lds
Mvaa 200,88,100
Mvaa 216,88,104
Mvaa 232,88,108
Mvaa 248,88,112
buffer_load_dwordx4 v5, s[8:11], s49 offen offset:1024 lds
Maaa 136,88,116
Maaa 152,88,120
Maaa 168,88,124
Mvaa 188,92,96
buffer_load_dwordx4 v4, s[8:11], s50 offen offset:2048 lds
Mvaa 204,92,100
Mvaa 220,92,104
Mvaa 236,92,108
Mvaa 252,92,112
buffer_load_dwordx4 v5, s[8:11], s51 offen offset:3072 lds
Maaa 140,92,116
v_xor_b32 v2, 384, v2
v_xor_b32 v3, 384, v3
Maaa 156,92,120
v_xor_b32 v4, 384, v4
v_xor_b32 v5, 384, v5
Maaa 172,92,124
s_waitcnt lgkmcnt(0)
Mvaa 48,0,32
buffer_load_dword v44, v45, s[16:19], s47 offen
Mvaa 64,0,36
Ta 96,12,16384
Ta 98,12,18432
Mvaa 80,0,40
s_add_u32 s47, s47, 2097152
Mvaa 96,0,44
Ra 64,11,0
Mvaa 112,0,48
Mvaa 128,0,52
Ta 100,13,16384
Ta 102,13,18432
Mvaa 144,0,56
Mvaa 160,0,60
s_waitcnt lgkmcnt(6)
Ra 68,11,2048
Mvaa 52,4,32
Mvaa 68,4,36
Ta 104,14,16384
Ta 106,14,18432
Mvaa 84,4,40
Mvaa 100,4,44
Ra 72,11,4096
Mvaa 116,4,48
Mvaa 132,4,52
Ta 108,15,16384
Ta 110,15,18432
Mvaa 148,4,56
Mvaa 164,4,60
s_waitcnt lgkmcnt(6)
Ra 76,11,6144
Mvaa 56,8,32
Mvaa 72,8,36
Ta 112,16,16384
Ta 114,16,18432
Mvaa 88,8,40
Mvaa 104,8,44
Ra 80,11,8192
Mvaa 120,8,48
Mvaa 136,8,52
Ta 116,17,16384
Ta 118,17,18432
Mvaa 152,8,56
Mvaa 168,8,60
s_waitcnt lgkmcnt(6)
Ra 84,11,10240
Mvaa 60,12,32
Mvaa 76,12,36
Ta 120,18,16384
Ta 122,18,18432
Mvaa 92,12,40
Mvaa 108,12,44
Ra 88,11,12288
Mvaa 124,12,48
Mvaa 140,12,52
Ta 124,19,16384
Ta 126,19,18432
Mvaa 156,12,56
Mvaa 172,12,60
s_waitcnt lgkmcnt(6)
Ra 92,11,14336
Mvaa 176,16,32
Mvaa 192,16,36
Mvaa 208,16,40
Mvaa 224,16,44
Mvaa 240,16,48
Maaa 128,16,52
Maaa 144,16,56
Maaa 160,16,60
Mvaa 180,20,32
Mvaa 196,20,36
Mvaa 212,20,40
Mvaa 228,20,44
Mvaa 244,20,48
Maaa 132,20,52
Maaa 148,20,56
Maaa 164,20,60
Mvaa 184,24,32
Mvaa 200,24,36
Mvaa 216,24,40
Mvaa 232,24,44
Mvaa 248,24,48
s_cmp_eq_u32 s6, 3
s_cselect_b32 s3, 0, 2146435072
Maaa 136,24,52
s_mov_b64 exec, 1
buffer_atomic_add v30, v31, s[28:31], s3 offen sc1
s_mov_b64 exec, -1
Maaa 152,24,56
Maaa 168,24,60
Mvaa 188,28,32
Mvaa 204,28,36
Mvaa 220,28,40
Mvaa 236,28,44
Mvaa 252,28,48
Maaa 140,28,52
Maaa 156,28,56
Maaa 172,28,60
s_waitcnt vmcnt(2) lgkmcnt(0)
s_add_u32 m0, s57, 0
s_barrier
Mvaa 48,64,96
buffer_load_dwordx4 v6, s[12:15], s52 offen offset:0 nt lds
Mvaa 64,64,100
Ta 32,22,0
Ta 34,22,2048
Mvaa 80,64,104
Mvaa 96,64,108
Ra 0,20,0
Mvaa 112,64,112
buffer_load_dwordx4 v7, s[12:15], s53 offen offset:1024 nt lds
Mvaa 128,64,116
s_waitcnt lgkmcnt(6)
Ta 36,23,0
Ta 38,23,2048
Mvaa 144,64,120
Mvaa 160,64,124
Ra 4,20,2048
Mvaa 52,68,96
buffer_load_dwordx4 v6, s[12:15], s54 offen offset:2048 nt lds
Mvaa 68,68,100
Ta 40,24,0
Ta 42,24,2048
Mvaa 84,68,104
Mvaa 100,68,108
Ra 8,20,4096
Mvaa 116,68,112
buffer_load_dwordx4 v7, s[12:15], s55 offen offset:3072 nt lds
Mvaa 132,68,116
s_waitcnt lgkmcnt(6)
Ta 44,25,0
Ta 46,25,2048
Mvaa 148,68,120
Mvaa 164,68,124
s_add_u32 m0, s57, 4096
Ra 12,20,6144
Mvaa 56,72,96
buffer_load_dwordx4 v8, s[12:15], s52 offen offset:0 nt lds
Mvaa 72,72,100
Ta 48,26,0
Ta 50,26,2048
Mvaa 88,72,104
Mvaa 104,72,108
Ra 16,20,8192
Mvaa 120,72,112
buffer_load_dwordx4 v9, s[12:15], s53 offen offset:1024 nt lds
Mvaa 136,72,116
s_waitcnt lgkmcnt(6)
Ta 52,27,0
Ta 54,27,2048
Mvaa 152,72,120
Mvaa 168,72,124
Ra 20,20,10240
Mvaa 60,76,96
buffer_load_dwordx4 v8, s[12:15], s54 offen offset:2048 nt lds
Mvaa 76,76,100
Ta 56,28,0
Ta 58,28,2048
Mvaa 92,76,104
Mvaa 108,76,108
Ra 24,20,12288
Mvaa 124,76,112
buffer_load_dwordx4 v9, s[12:15], s55 offen offset:3072 nt lds
Mvaa 140,76,116
s_waitcnt lgkmcnt(6)
Ta 60,29,0
Ta 62,29,2048
Mvaa 156,76,120
v_xor_b32 v6, 524288, v6
v_xor_b32 v7, 524288, v7
Mvaa 172,76,124
s_add_u32 m0, s56, 0
Ra 28,20,14336
v_xor_b32 v8, 524288, v8
Mvaa 176,80,96
buffer_load_dwordx4 v2, s[8:11], s48 offen offset:0 lds
Mvaa 192,80,100
v_xor_b32 v9, 524288, v9
Mvaa 208,80,104
Mvaa 224,80,108
Mvaa 240,80,112
buffer_load_dwordx4 v3, s[8:11], s49 offen offset:1024 lds
Maaa 128,80,116
Maaa 144,80,120
Maaa 160,80,124
Mvaa 180,84,96
buffer_load_dwordx4 v2, s[8:11], s50 offen offset:2048 lds
Mvaa 196,84,100
Mvaa 212,84,104
Mvaa 228,84,108
Mvaa 244,84,112
buffer_load_dwordx4 v3, s[8:11], s51 offen offset:3072 lds
Maaa 132,84,116
Maaa 148,84,120
Maaa 164,84,124
s_add_u32 m0, s56, 4096
Mvaa 184,88,96
buffer_load_dwordx4 v4, s[8:11], s48 offen offset:0 lds
Mvaa 200,88,100
Mvaa 216,88,104
Mvaa 232,88,108
Mvaa 248,88,112
buffer_load_dwordx4 v5, s[8:11], s49 offen offset:1024 lds
Maaa 136,88,116
Maaa 152,88,120
Maaa 168,88,124
Mvaa 188,92,96
buffer_load_dwordx4 v4, s[8:11], s50 offen offset:2048 lds
Mvaa 204,92,100
Mvaa 220,92,104
Mvaa 236,92,108
Mvaa 252,92,112
buffer_load_dwordx4 v5, s[8:11], s51 offen offset:3072 lds
Maaa 140,92,116
v_xor_b32 v2, 128, v2
v_xor_b32 v3, 128, v3
Maaa 156,92,120
v_xor_b32 v4, 128, v4
v_xor_b32 v5, 128, v5
Maaa 172,92,124
s_waitcnt lgkmcnt(0)
Mvaa 48,0,32
buffer_load_dword v44, v45, s[16:19], s47 offen
Mvaa 64,0,36
Ta 96,22,16384
Ta 98,22,18432
Mvaa 80,0,40
s_add_u32 s47, s47, 2097152
v_lshrrev_b32 v32, 4, v0
v_and_b32 v33, 15, v0
Mvaa 96,0,44
Ra 64,21,0
Mvaa 112,0,48
s_lshl_b32 s3, s32, 4
v_add_u32 v34, s3, v32
v_lshlrev_b32_e64 v36, 1, v32
Mvaa 128,0,52
Ta 100,23,16384
Ta 102,23,18432
Mvaa 144,0,56
v_xor_b32 v36, v36, v33
v_xor_b32 v37, 8, v36
Mvaa 160,0,60
s_waitcnt lgkmcnt(6)
Ra 68,21,2048
Mvaa 52,4,32
s_getpc_b64 s[6:7]
L_cpf3:
s_add_u32 s6, s6, (L_phase2-L_cpf3)&0xffffffff
s_addc_u32 s7, s7, ((L_phase2-L_cpf3)>>32)&0xffffffff
Mvaa 68,4,36
Ta 104,24,16384
Ta 106,24,18432
Mvaa 84,4,40
s_lshr_b32 s3, s2, 3
s_lshl_b32 s3, s3, 2
s_add_u32 s3, s3, s32
Mvaa 100,4,44
Ra 72,21,4096
Mvaa 116,4,48
s_lshl_b32 s3, s3, 10
v_and_b32 v42, 7, v0
v_lshlrev_b32 v42, 7, v42
Mvaa 132,4,52
Ta 108,25,16384
Ta 110,25,18432
Mvaa 148,4,56
v_add_u32_e64 v42, s3, v42
v_min_u32 v42, L_k2_fin-L_phase2-4, v42
Mvaa 164,4,60
s_waitcnt lgkmcnt(6)
Ra 76,21,6144
Mvaa 56,8,32
v_mov_b32 v41, s7
Mvaa 72,8,36
Ta 112,26,16384
Ta 114,26,18432
Mvaa 88,8,40
v_add_co_u32 v40, vcc, s6, v42
s_nop 1
v_addc_co_u32 v41, vcc, 0, v41, vcc
Mvaa 104,8,44
Ra 80,21,8192
Mvaa 120,8,48
global_load_dword v38, v[40:41], off
Mvaa 136,8,52
Ta 116,27,16384
Ta 118,27,18432
Mvaa 152,8,56
Mvaa 168,8,60
s_waitcnt lgkmcnt(6)
Ra 84,21,10240
Mvaa 60,12,32
Mvaa 76,12,36
Ta 120,28,16384
Ta 122,28,18432
Mvaa 92,12,40
Mvaa 108,12,44
Ra 88,21,12288
Mvaa 124,12,48
Mvaa 140,12,52
Ta 124,29,16384
Ta 126,29,18432
Mvaa 156,12,56
Mvaa 172,12,60
s_waitcnt lgkmcnt(6)
Ra 92,21,14336
Mvaa 176,16,32
Mvaa 192,16,36
Mvaa 208,16,40
Mvaa 224,16,44
Mvaa 240,16,48
Maaa 128,16,52
Maaa 144,16,56
Maaa 160,16,60
Mvaa 180,20,32
Mvaa 196,20,36
Mvaa 212,20,40
Mvaa 228,20,44
Mvaa 244,20,48
Maaa 132,20,52
Maaa 148,20,56
Maaa 164,20,60
Mvaa 184,24,32
Mvaa 200,24,36
Mvaa 216,24,40
Mvaa 232,24,44
Mvaa 248,24,48
Maaa 136,24,52
Maaa 152,24,56
Maaa 168,24,60
Mvaa 188,28,32
Mvaa 204,28,36
Mvaa 220,28,40
Mvaa 236,28,44
Mvaa 252,28,48
Maaa 140,28,52
Maaa 156,28,56
Maaa 172,28,60
s_waitcnt vmcnt(2) lgkmcnt(0)
s_add_u32 m0, s57, 65536
s_barrier
Mvaa 48,64,96
buffer_load_dwordx4 v6, s[12:15], s52 offen offset:0 nt lds
Mvaa 64,64,100
Ta 32,12,0
Ta 34,12,2048
Mvaa 80,64,104
Mvaa 96,64,108
Ra 0,10,0
Mvaa 112,64,112
buffer_load_dwordx4 v7, s[12:15], s53 offen offset:1024 nt lds
Mvaa 128,64,116
s_waitcnt lgkmcnt(6)
Ta 36,13,0
Ta 38,13,2048
Mvaa 144,64,120
Mvaa 160,64,124
Ra 4,10,2048
Mvaa 52,68,96
buffer_load_dwordx4 v6, s[12:15], s54 offen offset:2048 nt lds
Mvaa 68,68,100
Ta 40,14,0
Ta 42,14,2048
Mvaa 84,68,104
Mvaa 100,68,108
Ra 8,10,4096
Mvaa 116,68,112
buffer_load_dwordx4 v7, s[12:15], s55 offen offset:3072 nt lds
Mvaa 132,68,116
s_waitcnt lgkmcnt(6)
Ta 44,15,0
Ta 46,15,2048
Mvaa 148,68,120
Mvaa 164,68,124
s_add_u32 m0, s57, 69632
Ra 12,10,6144
Mvaa 56,72,96
buffer_load_dwordx4 v8, s[12:15], s52 offen offset:0 nt lds
Mvaa 72,72,100
Ta 48,16,0
Ta 50,16,2048
Mvaa 88,72,104
Mvaa 104,72,108
Ra 16,10,8192
Mvaa 120,72,112
buffer_load_dwordx4 v9, s[12:15], s53 offen offset:1024 nt lds
Mvaa 136,72,116
s_waitcnt lgkmcnt(6)
Ta 52,17,0
Ta 54,17,2048
Mvaa 152,72,120
Mvaa 168,72,124
Ra 20,10,10240
Mvaa 60,76,96
buffer_load_dwordx4 v8, s[12:15], s54 offen offset:2048 nt lds
Mvaa 76,76,100
Ta 56,18,0
Ta 58,18,2048
Mvaa 92,76,104
Mvaa 108,76,108
Ra 24,10,12288
Mvaa 124,76,112
buffer_load_dwordx4 v9, s[12:15], s55 offen offset:3072 nt lds
Mvaa 140,76,116
s_waitcnt lgkmcnt(6)
Ta 60,19,0
Ta 62,19,2048
Mvaa 156,76,120
Mvaa 172,76,124
s_add_u32 m0, s56, 65536
Ra 28,10,14336
Mvaa 176,80,96
buffer_load_dwordx4 v2, s[8:11], s48 offen offset:0 lds
Mvaa 192,80,100
Mvaa 208,80,104
Mvaa 224,80,108
Mvaa 240,80,112
buffer_load_dwordx4 v3, s[8:11], s49 offen offset:1024 lds
Maaa 128,80,116
Maaa 144,80,120
Maaa 160,80,124
Mvaa 180,84,96
buffer_load_dwordx4 v2, s[8:11], s50 offen offset:2048 lds
Mvaa 196,84,100
Mvaa 212,84,104
Mvaa 228,84,108
Mvaa 244,84,112
buffer_load_dwordx4 v3, s[8:11], s51 offen offset:3072 lds
Maaa 132,84,116
Maaa 148,84,120
Maaa 164,84,124
s_add_u32 m0, s56, 69632
Mvaa 184,88,96
buffer_load_dwordx4 v4, s[8:11], s48 offen offset:0 lds
Mvaa 200,88,100
Mvaa 216,88,104
Mvaa 232,88,108
Mvaa 248,88,112
buffer_load_dwordx4 v5, s[8:11], s49 offen offset:1024 lds
Maaa 136,88,116
Maaa 152,88,120
Maaa 168,88,124
Mvaa 188,92,96
buffer_load_dwordx4 v4, s[8:11], s50 offen offset:2048 lds
Mvaa 204,92,100
Mvaa 220,92,104
Mvaa 236,92,108
Mvaa 252,92,112
buffer_load_dwordx4 v5, s[8:11], s51 offen offset:3072 lds
Maaa 140,92,116
Maaa 156,92,120
Maaa 172,92,124
s_waitcnt lgkmcnt(0)
Mvaa 48,0,32
buffer_load_dword v30, v31, s[28:31], s37 offen sc1
Mvaa 64,0,36
Ta 96,12,16384
Ta 98,12,18432
Mvaa 80,0,40
s_mov_b32 s8, s16
s_mov_b32 s9, s17
s_mov_b32 s10, s18
Mvaa 96,0,44
Ra 64,11,0
Mvaa 112,0,48
s_add_u32 s16, s66, 46137344
s_addc_u32 s17, s67, 0
s_and_b32 s17, s17, 0xffff
Mvaa 128,0,52
Ta 100,13,16384
Ta 102,13,18432
Mvaa 144,0,56
s_mov_b32 s18, 16777216
s_mov_b32 s19, 0x20000
s_mov_b32 s48, 0
Mvaa 160,0,60
s_waitcnt lgkmcnt(6)
Ra 68,11,2048
Mvaa 52,4,32
s_mov_b32 s49, 31744
s_mov_b32 s50, 63488
s_mov_b32 s51, 95232
Mvaa 68,4,36
Ta 104,14,16384
Ta 106,14,18432
Mvaa 84,4,40
v_lshlrev_b32_e64 v35, 13, v34
v_lshl_add_u32 v8, v36, 4, v35
Mvaa 100,4,44
Ra 72,11,4096
Mvaa 116,4,48
v_lshl_add_u32 v9, v37, 4, v35
v_lshlrev_b32_e64 v2, 4, v0
Mvaa 132,4,52
Ta 108,15,16384
Ta 110,15,18432
Mvaa 148,4,56
v_add_u32 v3, 65536, v2
v_add_u32_e64 v4, s44, v2
Mvaa 164,4,60
s_waitcnt lgkmcnt(6)
Ra 76,11,6144
Mvaa 56,8,32
v_mov_b32 v7, 0
v_lshlrev_b32_e64 v35, 2, v32
Mvaa 72,8,36
Ta 112,16,16384
Ta 114,16,18432
Mvaa 88,8,40
v_sub_u32_e64 v35, v33, v35
Mvaa 104,8,44
Ra 80,11,8192
Mvaa 120,8,48
s_lshl_b32 s3, s32, 4
v_add_u32 v5, s3, v35
Mvaa 136,8,52
Ta 116,17,16384
Ta 118,17,18432
Mvaa 152,8,56
s_sub_u32 s3, 48, s3
v_add_u32 v6, s3, v35
Mvaa 168,8,60
s_waitcnt lgkmcnt(6)
Ra 84,11,10240
Mvaa 60,12,32
s_mul_i32 s3, s33, 1116160
s_add_u32 s3, s3, 8388608
s_add_u32 s12, s66, s3
s_addc_u32 s13, s67, 0
s_and_b32 s13, s13, 0xffff
Mvaa 76,12,36
Ta 120,18,16384
Ta 122,18,18432
Mvaa 92,12,40
s_mov_b32 s14, 0
s_mov_b32 s15, 0x20000
s_mul_i32 s14, s36, 34816
Mvaa 108,12,44
Ra 88,11,12288
Mvaa 124,12,48
buffer_load_dword v44, v45, s[8:11], s47 offen
Mvaa 140,12,52
Ta 124,19,16384
Ta 126,19,18432
Mvaa 156,12,56
s_add_u32 s47, s47, 2097152
Mvaa 172,12,60
s_waitcnt lgkmcnt(6)
Ra 92,11,14336
Mvaa 176,16,32
Mvaa 192,16,36
Mvaa 208,16,40
Mvaa 224,16,44
Mvaa 240,16,48
Maaa 128,16,52
Maaa 144,16,56
Maaa 160,16,60
Mvaa 180,20,32
Mvaa 196,20,36
Mvaa 212,20,40
Mvaa 228,20,44
Mvaa 244,20,48
Maaa 132,20,52
Maaa 148,20,56
Maaa 164,20,60
Mvaa 184,24,32
Mvaa 200,24,36
Mvaa 216,24,40
Mvaa 232,24,44
Mvaa 248,24,48
Maaa 136,24,52
Maaa 152,24,56
Maaa 168,24,60
Mvaa 188,28,32
Mvaa 204,28,36
Mvaa 220,28,40
Mvaa 236,28,44
Mvaa 252,28,48
Maaa 140,28,52
Maaa 156,28,56
Maaa 172,28,60
s_waitcnt vmcnt(2) lgkmcnt(0)
s_add_u32 m0, s44, 0
s_barrier
Mvaa 48,64,96
buffer_load_dwordx4 v8, s[8:11], s48 offen offset:0 lds
Mvaa 64,64,100
Ta 32,22,0
Ta 34,22,2048
Mvaa 80,64,104
s_mul_i32 s3, s45, 33792
v_add_u32_e64 v10, s3, v2
Mvaa 96,64,108
Ra 0,20,0
Mvaa 112,64,112
buffer_load_dwordx4 v8, s[8:11], s49 offen offset:1024 lds
Mvaa 128,64,116
s_waitcnt lgkmcnt(6)
Ta 36,23,0
Ta 38,23,2048
Mvaa 144,64,120
s_mul_i32 s3, s46, 33792
v_add_u32 v11, s3, v2
v_mov_b32_e64 v14, v40
Mvaa 160,64,124
Ra 4,20,2048
Mvaa 52,68,96
buffer_load_dwordx4 v9, s[8:11], s50 offen offset:2048 lds
Mvaa 68,68,100
Ta 40,24,0
Ta 42,24,2048
Mvaa 84,68,104
v_mov_b32_e64 v15, v41
Mvaa 100,68,108
Ra 8,20,4096
Mvaa 116,68,112
buffer_load_dwordx4 v9, s[8:11], s51 offen offset:3072 lds
Mvaa 132,68,116
s_waitcnt lgkmcnt(6)
Ta 44,25,0
Ta 46,25,2048
Mvaa 148,68,120
v_add_u32 v8, 524288, v8
v_add_u32 v9, 524288, v9
Mvaa 164,68,124
s_add_u32 m0, s44, 16384
Ra 12,20,6144
Mvaa 56,72,96
buffer_load_dwordx4 v8, s[8:11], s48 offen offset:0 lds
Mvaa 72,72,100
Ta 48,26,0
Ta 50,26,2048
Mvaa 88,72,104
Mvaa 104,72,108
Ra 16,20,8192
Mvaa 120,72,112
buffer_load_dwordx4 v8, s[8:11], s49 offen offset:1024 lds
Mvaa 136,72,116
s_waitcnt lgkmcnt(6)
Ta 52,27,0
Ta 54,27,2048
Mvaa 152,72,120
Mvaa 168,72,124
Ra 20,20,10240
Mvaa 60,76,96
buffer_load_dwordx4 v9, s[8:11], s50 offen offset:2048 lds
Mvaa 76,76,100
Ta 56,28,0
Ta 58,28,2048
Mvaa 92,76,104
Mvaa 108,76,108
Ra 24,20,12288
Mvaa 124,76,112
buffer_load_dwordx4 v9, s[8:11], s51 offen offset:3072 lds
Mvaa 140,76,116
s_waitcnt lgkmcnt(6)
Ta 60,29,0
Ta 62,29,2048
Mvaa 156,76,120
v_add_u32 v8, 524288, v8
v_add_u32 v9, 524288, v9
Mvaa 172,76,124
s_add_u32 m0, s44, 32768
Ra 28,20,14336
Mvaa 176,80,96
buffer_load_dwordx4 v8, s[8:11], s48 offen offset:0 lds
Mvaa 192,80,100
Mvaa 208,80,104
Mvaa 224,80,108
Mvaa 240,80,112
buffer_load_dwordx4 v8, s[8:11], s49 offen offset:1024 lds
Maaa 128,80,116
Maaa 144,80,120
Maaa 160,80,124
Mvaa 180,84,96
buffer_load_dwordx4 v9, s[8:11], s50 offen offset:2048 lds
Mvaa 196,84,100
Mvaa 212,84,104
Mvaa 228,84,108
Mvaa 244,84,112
buffer_load_dwordx4 v9, s[8:11], s51 offen offset:3072 lds
Maaa 132,84,116
v_add_u32 v8, 524288, v8
v_add_u32 v9, 524288, v9
Maaa 148,84,120
Maaa 164,84,124
s_add_u32 m0, s44, 49152
Mvaa 184,88,96
buffer_load_dwordx4 v8, s[8:11], s48 offen offset:0 lds
Mvaa 200,88,100
Mvaa 216,88,104
Mvaa 232,88,108
Mvaa 248,88,112
buffer_load_dwordx4 v8, s[8:11], s49 offen offset:1024 lds
Maaa 136,88,116
Maaa 152,88,120
Maaa 168,88,124
Mvaa 188,92,96
buffer_load_dwordx4 v9, s[8:11], s50 offen offset:2048 lds
Mvaa 204,92,100
Mvaa 220,92,104
Mvaa 236,92,108
Mvaa 252,92,112
buffer_load_dwordx4 v9, s[8:11], s51 offen offset:3072 lds
Maaa 140,92,116
v_add_u32 v8, 524288, v8
v_add_u32 v9, 524288, v9
Maaa 156,92,120
Maaa 172,92,124
s_waitcnt lgkmcnt(0)
Mvaa 48,0,32
Mvaa 64,0,36
Ta 96,22,16384
Ta 98,22,18432
Mvaa 80,0,40
Mvaa 96,0,44
Ra 64,21,0
Mvaa 112,0,48
Mvaa 128,0,52
Ta 100,23,16384
Ta 102,23,18432
Mvaa 144,0,56
Mvaa 160,0,60
s_waitcnt lgkmcnt(6)
Ra 68,21,2048
Mvaa 52,4,32
Mvaa 68,4,36
Ta 104,24,16384
Ta 106,24,18432
Mvaa 84,4,40
Mvaa 100,4,44
Ra 72,21,4096
Mvaa 116,4,48
Mvaa 132,4,52
Ta 108,25,16384
Ta 110,25,18432
Mvaa 148,4,56
Mvaa 164,4,60
s_waitcnt lgkmcnt(6)
Ra 76,21,6144
Mvaa 56,8,32
Mvaa 72,8,36
Ta 112,26,16384
Ta 114,26,18432
Mvaa 88,8,40
Mvaa 104,8,44
Ra 80,21,8192
Mvaa 120,8,48
Mvaa 136,8,52
Ta 116,27,16384
Ta 118,27,18432
Mvaa 152,8,56
Mvaa 168,8,60
s_waitcnt lgkmcnt(6)
Ra 84,21,10240
Mvaa 60,12,32
Mvaa 76,12,36
Ta 120,28,16384
Ta 122,28,18432
Mvaa 92,12,40
Mvaa 108,12,44
Ra 88,21,12288
Mvaa 124,12,48
Mvaa 140,12,52
Ta 124,29,16384
Ta 126,29,18432
Mvaa 156,12,56
Mvaa 172,12,60
s_waitcnt lgkmcnt(6)
Ra 92,21,14336
Mvaa 176,16,32
Mvaa 192,16,36
Mvaa 208,16,40
Mvaa 224,16,44
Mvaa 240,16,48
Maaa 128,16,52
Maaa 144,16,56
Maaa 160,16,60
Mvaa 180,20,32
Mvaa 196,20,36
Mvaa 212,20,40
Mvaa 228,20,44
Mvaa 244,20,48
Maaa 132,20,52
Maaa 148,20,56
Maaa 164,20,60
Mvaa 184,24,32
Mvaa 200,24,36
Mvaa 216,24,40
Mvaa 232,24,44
Mvaa 248,24,48
Maaa 136,24,52
Maaa 152,24,56
Maaa 168,24,60
Mvaa 188,28,32
Mvaa 204,28,36
Mvaa 220,28,40
Mvaa 236,28,44
Mvaa 252,28,48
Maaa 140,28,52
Maaa 156,28,56
Maaa 172,28,60
s_waitcnt vmcnt(12) lgkmcnt(0)
v_readfirstlane_b32 s3, v30
s_nop 0
s_or_b32 s3, s3, s37
s_cmp_lt_u32 s3, 256
s_cbranch_scc1 L_spinAv
L_spinArv:
s_barrier
Mvaa 48,64,96
buffer_load_dwordx4 a[0:3], v10, s[20:23], s58 offen offset:0 sc1
Mvaa 52,68,96
v_lshrrev_b32_e64 v42, 2, v33
v_lshl_add_u32 v43, v32, 3, v42
Mvaa 56,72,96
v_lshlrev_b32 v43, 8, v43
v_and_b32 v44, 3, v0
Mvaa 60,76,96
v_lshl_add_u32 v43, v44, 3, v43
v_and_b32_e64 v44, 1, v32
Mvaa 64,64,100
buffer_load_dwordx4 a[4:7], v10, s[20:23], 0 offen offset:0 sc1
Mvaa 68,68,100
v_lshl_add_u32 v42, v44, 2, v42
v_xor_b32_e64 v44, 0, v42
Mvaa 72,72,100
v_lshl_add_u32 v16, v44, 5, v43
v_xor_b32_e64 v44, 1, v42
Mvaa 76,76,100
v_lshl_add_u32 v17, v44, 5, v43
v_xor_b32_e64 v44, 2, v42
Mvaa 80,64,104
buffer_load_dwordx4 a[8:11], v11, s[20:23], s58 offen offset:0 sc1
Mvaa 84,68,104
v_lshl_add_u32 v18, v44, 5, v43
v_xor_b32_e64 v44, 3, v42
Mvaa 88,72,104
v_lshl_add_u32 v19, v44, 5, v43
v_xor_b32_e64 v44, 4, v42
Mvaa 92,76,104
v_lshl_add_u32 v20, v44, 5, v43
v_xor_b32_e64 v44, 5, v42
Mvaa 96,64,108
buffer_load_dwordx4 a[12:15], v11, s[20:23], 0 offen offset:0 sc1
Mvaa 100,68,108
v_lshl_add_u32 v21, v44, 5, v43
v_xor_b32_e64 v44, 6, v42
Mvaa 104,72,108
v_lshl_add_u32 v22, v44, 5, v43
v_xor_b32_e64 v44, 7, v42
Mvaa 108,76,108
v_lshl_add_u32 v23, v44, 5, v43
Mvaa 112,64,112
buffer_load_dwordx4 a[16:19], v10, s[20:23], s58 offen offset:1024 sc1
Mvaa 116,68,112
Mvaa 120,72,112
Mvaa 124,76,112
Mvaa 128,64,116
buffer_load_dwordx4 a[20:23], v10, s[20:23], 0 offen offset:1024 sc1
Mvaa 132,68,116
Ta 192,16,0
Ta 194,16,1024
Mvaa 136,72,116
Ta 196,17,0
Ta 198,17,1024
Mvaa 140,76,116
Ta 200,18,0
Ta 202,18,1024
Mvaa 144,64,120
buffer_load_dwordx4 a[24:27], v11, s[20:23], s58 offen offset:1024 sc1
Mvaa 148,68,120
Ta 204,19,0
Ta 206,19,1024
Mvaa 152,72,120
Ta 208,20,0
Ta 210,20,1024
Mvaa 156,76,120
Ta 212,21,0
Ta 214,21,1024
Mvaa 160,64,124
buffer_load_dwordx4 a[28:31], v11, s[20:23], 0 offen offset:1024 sc1
Mvaa 164,68,124
Ta 216,22,0
Ta 218,22,1024
Mvaa 168,72,124
Ta 220,23,0
s_waitcnt lgkmcnt(9)
Ta 222,23,1024
Mvaa 172,76,124
s_waitcnt lgkmcnt(8)
Vc 24,48,49
Vc 25,50,51
Mvaa 176,80,96
buffer_load_dwordx4 a[32:35], v10, s[20:23], s58 offen offset:2048 sc1
Mvaa 180,84,96
Vc 26,52,53
Vc 27,54,55
Mvaa 184,88,96
Vc 28,56,57
Vc 29,58,59
Mvaa 188,92,96
Vc 30,60,61
Vc 31,62,63
Mvaa 192,80,100
buffer_load_dwordx4 a[36:39], v10, s[20:23], 0 offen offset:2048 sc1
Mvaa 196,84,100
Vc 32,64,65
Vc 33,66,67
Mvaa 200,88,100
Vc 34,68,69
Vc 35,70,71
Mvaa 204,92,100
Vc 36,72,73
Vc 37,74,75
Mvaa 208,80,104
buffer_load_dwordx4 a[40:43], v11, s[20:23], s58 offen offset:2048 sc1
Mvaa 212,84,104
Vc 38,76,77
Vc 39,78,79
Mvaa 216,88,104
Vc 40,80,81
Vc 41,82,83
Mvaa 220,92,104
Vc 42,84,85
Vc 43,86,87
Mvaa 224,80,108
buffer_load_dwordx4 a[44:47], v11, s[20:23], 0 offen offset:2048 sc1
Mvaa 228,84,108
Vc 44,88,89
Vc 45,90,91
Mvaa 232,88,108
Vc 46,92,93
Vc 47,94,95
Mvaa 236,92,108
Vc 48,96,97
Vc 49,98,99
Mvaa 240,80,112
buffer_load_dwordx4 a[48:51], v10, s[20:23], s58 offen offset:3072 sc1
Mvaa 244,84,112
Vc 50,100,101
Vc 51,102,103
Mvaa 248,88,112
Vc 52,104,105
Vc 53,106,107
Mvaa 252,92,112
Vc 54,108,109
Vc 55,110,111
Maaa 128,80,116
buffer_load_dwordx4 a[52:55], v10, s[20:23], 0 offen offset:3072 sc1
Maaa 132,84,116
Vc 56,112,113
Vc 57,114,115
Maaa 136,88,116
Vc 58,116,117
Vc 59,118,119
Maaa 140,92,116
Vc 60,120,121
Vc 61,122,123
Maaa 144,80,120
buffer_load_dwordx4 a[56:59], v11, s[20:23], s58 offen offset:3072 sc1
Maaa 148,84,120
Vc 62,124,125
Vc 63,126,127
Maaa 152,88,120
Vc 64,128,129
Vc 65,130,131
Maaa 156,92,120
Vc 66,132,133
Vc 67,134,135
Maaa 160,80,124
buffer_load_dwordx4 a[60:63], v11, s[20:23], 0 offen offset:3072 sc1
Maaa 164,84,124
v_add_u32 v10, 4096, v10
v_add_u32 v11, 4096, v11
Maaa 168,88,124
Vc 68,136,137
Vc 69,138,139
Maaa 172,92,124
Vc 70,140,141
Vc 71,142,143
Vc 72,144,145
Vc 73,146,147
Vc 74,148,149
Vc 75,150,151
Vc 76,152,153
Vc 77,154,155
Vc 78,156,157
Vc 79,158,159
Vc 80,160,161
Vc 81,162,163
Vc 82,164,165
Vc 83,166,167
Vc 84,168,169
Vc 85,170,171
Vc 86,172,173
Vc 87,174,175
Vc 88,176,177
Vc 89,178,179
Vc 90,180,181
Vc 91,182,183
Vc 92,184,185
Vc 93,186,187
Vc 94,188,189
Vc 95,190,191
Vc 96,192,193
Vc 97,194,195
Vc 98,196,197
Vc 99,198,199
Vc 100,200,201
Vc 101,202,203
Vc 102,204,205
Vc 103,206,207
Vc 104,208,209
Vc 105,210,211
Vc 106,212,213
Vc 107,214,215
Vc 108,216,217
Vc 109,218,219
Vc 110,220,221
Vc 111,222,223
Vc 112,224,225
Vc 113,226,227
Vc 114,228,229
Vc 115,230,231
Vc 116,232,233
Vc 117,234,235
Vc 118,236,237
Vc 119,238,239
Vc 120,240,241
Vc 121,242,243
Vc 122,244,245
Vc 123,246,247
Vc 124,248,249
Vc 125,250,251
Vc 126,252,253
Vc 127,254,255
L_phase2:
s_nop 7
s_waitcnt vmcnt(12) lgkmcnt(0)
Zvaa 128,192,0
s_add_u32 s37, s38, 0
Zvaa 160,192,4
Ta 224,16,8192
Ta 226,16,9216
Zvaa 192,192,8
buffer_load_dwordx4 a[64:67], v10, s[20:23], s58 offen offset:0 sc1
Zvaa 224,192,12
buffer_store_dwordx4 v[24:27], v2, s[24:27], s37 offen offset:0 sc1
Zvaa 132,196,0
Ta 228,17,8192
Ta 230,17,9216
Zvaa 164,196,4
buffer_load_dwordx4 a[68:71], v10, s[20:23], 0 offen offset:0 sc1
Zvaa 196,196,8
s_mov_b32 s60, s40
s_and_b32 s61, s41, 0xffff
s_mov_b32 s62, 7340032
Zvaa 228,196,12
Ta 232,18,8192
Ta 234,18,9216
Zvaa 136,200,0
s_mov_b32 s63, 0x20000
Zvaa 168,200,4
buffer_load_dwordx4 a[72:75], v11, s[20:23], s58 offen offset:0 sc1
Zvaa 200,200,8
Ta 236,19,8192
Ta 238,19,9216
Zvaa 232,200,12
global_load_dword v13, v[14:15], off
Zvaa 140,204,0
Zvaa 172,204,4
Ta 240,20,8192
Ta 242,20,9216
Zvaa 204,204,8
buffer_load_dwordx4 a[76:79], v11, s[20:23], 0 offen offset:0 sc1
Zvaa 236,204,12
Zvaa 144,208,0
s_waitcnt lgkmcnt(6)
Ta 244,21,8192
Ta 246,21,9216
Zvaa 176,208,4
buffer_store_dwordx4 v[28:31], v2, s[24:27], s37 offen offset:1024 sc1
Zvaa 208,208,8
buffer_load_dwordx4 a[80:83], v10, s[20:23], s58 offen offset:1024 sc1
Zvaa 240,208,12
Ta 248,22,8192
Ta 250,22,9216
Zvaa 148,212,0
Zvaa 180,212,4
Zvaa 212,212,8
Ta 252,23,8192
Ta 254,23,9216
Zvaa 244,212,12
buffer_load_dwordx4 a[84:87], v10, s[20:23], 0 offen offset:1024 sc1
Zvaa 152,216,0
Zvaa 184,216,4
Zvaa 216,216,8
buffer_load_dwordx4 a[88:91], v11, s[20:23], s58 offen offset:1024 sc1
Zvaa 248,216,12
Zvaa 156,220,0
Zvaa 188,220,4
buffer_load_dwordx4 a[92:95], v11, s[20:23], 0 offen offset:1024 sc1
Zvaa 220,220,8
Zvaa 252,220,12
s_waitcnt vmcnt(19) lgkmcnt(0)
s_barrier
Mvaa 128,224,16
buffer_store_dwordx4 v[32:35], v2, s[24:27], s37 offen offset:2048 sc1
Mvaa 160,224,20
s_add_u32 m0, s44, 0
Ta 192,16,16384
Ta 194,16,17408
Mvaa 192,224,24
buffer_load_dwordx4 v8, s[8:11], s48 offen offset:0 lds
Mvaa 224,224,28
buffer_load_dwordx4 v8, s[8:11], s49 offen offset:1024 lds
Mvaa 132,228,16
Ta 196,17,16384
Ta 198,17,17408
Mvaa 164,228,20
Mvaa 196,228,24
buffer_load_dwordx4 v9, s[8:11], s50 offen offset:2048 lds
Mvaa 228,228,28
Ta 200,18,16384
Ta 202,18,17408
Mvaa 136,232,16
Mvaa 168,232,20
buffer_load_dwordx4 v9, s[8:11], s51 offen offset:3072 lds
v_add_u32 v8, 524288, v8
v_add_u32 v9, 524288, v9
Mvaa 200,232,24
Ta 204,19,16384
Ta 206,19,17408
Mvaa 232,232,28
Mvaa 140,236,16
buffer_load_dwordx4 a[96:99], v10, s[20:23], s58 offen offset:2048 sc1
Mvaa 172,236,20
Ta 208,20,16384
Ta 210,20,17408
Mvaa 204,236,24
Mvaa 236,236,28
buffer_load_dwordx4 a[100:103], v10, s[20:23], 0 offen offset:2048 sc1
Mvaa 144,240,16
s_waitcnt lgkmcnt(6)
Ta 212,21,16384
Ta 214,21,17408
Mvaa 176,240,20
buffer_store_dwordx4 v[36:39], v2, s[24:27], s37 offen offset:3072 sc1
Mvaa 208,240,24
buffer_load_dwordx4 a[104:107], v11, s[20:23], s58 offen offset:2048 sc1
Mvaa 240,240,28
Ta 216,22,16384
Ta 218,22,17408
Mvaa 148,244,16
Mvaa 180,244,20
buffer_load_dwordx4 a[108:111], v11, s[20:23], 0 offen offset:2048 sc1
Mvaa 212,244,24
Ta 220,23,16384
Ta 222,23,17408
Mvaa 244,244,28
Mvaa 152,248,16
buffer_load_dwordx4 a[112:115], v10, s[20:23], s58 offen offset:3072 sc1
Mvaa 184,248,20
Mvaa 216,248,24
buffer_load_dwordx4 a[116:119], v10, s[20:23], 0 offen offset:3072 sc1
Mvaa 248,248,28
Mvaa 156,252,16
buffer_load_dwordx4 a[120:123], v11, s[20:23], s58 offen offset:3072 sc1
Mvaa 188,252,20
Mvaa 220,252,24
buffer_load_dwordx4 a[124:127], v11, s[20:23], 0 offen offset:3072 sc1
v_add_u32 v10, 4096, v10
v_add_u32 v11, 4096, v11
Mvaa 252,252,28
s_waitcnt vmcnt(29) lgkmcnt(0)
Mvaa 128,192,32
s_add_u32 s37, s38, 4096
Mvaa 160,192,36
Ta 224,16,24576
Ta 226,16,25600
Mvaa 192,192,40
buffer_load_dwordx4 a[0:3], v10, s[20:23], s58 offen offset:0 sc1
Mvaa 224,192,44
buffer_store_dwordx4 v[40:43], v2, s[24:27], s37 offen offset:0 sc1
Mvaa 132,196,32
Ta 228,17,24576
Ta 230,17,25600
Mvaa 164,196,36
buffer_load_dwordx4 a[4:7], v10, s[20:23], 0 offen offset:0 sc1
Mvaa 196,196,40
Mvaa 228,196,44
Ta 232,18,24576
Ta 234,18,25600
Mvaa 136,200,32
Mvaa 168,200,36
buffer_load_dwordx4 a[8:11], v11, s[20:23], s58 offen offset:0 sc1
Mvaa 200,200,40
Ta 236,19,24576
Ta 238,19,25600
Mvaa 232,200,44
Mvaa 140,204,32
Mvaa 172,204,36
Ta 240,20,24576
Ta 242,20,25600
Mvaa 204,204,40
buffer_load_dwordx4 a[12:15], v11, s[20:23], 0 offen offset:0 sc1
Mvaa 236,204,44
Mvaa 144,208,32
s_waitcnt lgkmcnt(6)
Ta 244,21,24576
Ta 246,21,25600
Mvaa 176,208,36
buffer_store_dwordx4 v[44:47], v2, s[24:27], s37 offen offset:1024 sc1
Mvaa 208,208,40
buffer_load_dwordx4 a[16:19], v10, s[20:23], s58 offen offset:1024 sc1
Mvaa 240,208,44
Ta 248,22,24576
Ta 250,22,25600
Mvaa 148,212,32
Mvaa 180,212,36
Mvaa 212,212,40
Ta 252,23,24576
Ta 254,23,25600
Mvaa 244,212,44
buffer_load_dwordx4 a[20:23], v10, s[20:23], 0 offen offset:1024 sc1
Mvaa 152,216,32
Mvaa 184,216,36
Mvaa 216,216,40
buffer_load_dwordx4 a[24:27], v11, s[20:23], s58 offen offset:1024 sc1
Mvaa 248,216,44
Mvaa 156,220,32
Mvaa 188,220,36
buffer_load_dwordx4 a[28:31], v11, s[20:23], 0 offen offset:1024 sc1
Mvaa 220,220,40
Mvaa 252,220,44
s_waitcnt vmcnt(35) lgkmcnt(0)
s_barrier
Mvaa 128,224,48
buffer_store_dwordx4 v[48:51], v2, s[24:27], s37 offen offset:2048 sc1
Mvaa 160,224,52
s_add_u32 m0, s44, 16384
Ta 192,16,32768
Ta 194,16,33792
Mvaa 192,224,56
buffer_load_dwordx4 v8, s[8:11], s48 offen offset:0 lds
Mvaa 224,224,60
Mvaa 132,228,48
Ta 196,17,32768
Ta 198,17,33792
Mvaa 164,228,52
buffer_load_dwordx4 v8, s[8:11], s49 offen offset:1024 lds
Mvaa 196,228,56
Mvaa 228,228,60
Ta 200,18,32768
Ta 202,18,33792
Mvaa 136,232,48
Mvaa 168,232,52
buffer_load_dwordx4 v9, s[8:11], s50 offen offset:2048 lds
Mvaa 200,232,56
Ta 204,19,32768
Ta 206,19,33792
Mvaa 232,232,60
Mvaa 140,236,48
Mvaa 172,236,52
Ta 208,20,32768
Ta 210,20,33792
Mvaa 204,236,56
buffer_load_dwordx4 v9, s[8:11], s51 offen offset:3072 lds
v_add_u32 v8, 524288, v8
v_add_u32 v9, 524288, v9
Mvaa 236,236,60
Mvaa 144,240,48
s_waitcnt lgkmcnt(6)
Ta 212,21,32768
Ta 214,21,33792
Mvaa 176,240,52
buffer_store_dwordx4 v[52:55], v2, s[24:27], s37 offen offset:3072 sc1
Mvaa 208,240,56
buffer_load_dwordx4 a[32:35], v10, s[20:23], s58 offen offset:2048 sc1
Mvaa 240,240,60
Ta 216,22,32768
Ta 218,22,33792
Mvaa 148,244,48
Mvaa 180,244,52
Mvaa 212,244,56
Ta 220,23,32768
Ta 222,23,33792
Mvaa 244,244,60
buffer_load_dwordx4 a[36:39], v10, s[20:23], 0 offen offset:2048 sc1
Mvaa 152,248,48
Mvaa 184,248,52
Mvaa 216,248,56
buffer_load_dwordx4 a[40:43], v11, s[20:23], s58 offen offset:2048 sc1
Mvaa 248,248,60
Mvaa 156,252,48
Mvaa 188,252,52
buffer_load_dwordx4 a[44:47], v11, s[20:23], 0 offen offset:2048 sc1
Mvaa 220,252,56
Mvaa 252,252,60
s_waitcnt vmcnt(39) lgkmcnt(0)
Mvaa 128,192,64
s_add_u32 s37, s38, 8192
Mvaa 160,192,68
Ta 224,16,40960
Ta 226,16,41984
Mvaa 192,192,72
buffer_load_dwordx4 a[48:51], v10, s[20:23], s58 offen offset:3072 sc1
Mvaa 224,192,76
buffer_store_dwordx4 v[56:59], v2, s[24:27], s37 offen offset:0 sc1
Mvaa 132,196,64
Ta 228,17,40960
Ta 230,17,41984
Mvaa 164,196,68
Ar 48,128
Ar 49,129
Mvaa 196,196,72
Ar 50,130
Ar 51,131
Mvaa 228,196,76
Ta 232,18,40960
Ta 234,18,41984
Mvaa 136,200,64
Ar 52,132
Ar 53,133
Mvaa 168,200,68
buffer_load_dwordx4 a[52:55], v10, s[20:23], 0 offen offset:3072 sc1
Mvaa 200,200,72
Ta 236,19,40960
Ta 238,19,41984
Mvaa 232,200,76
Ar 54,134
Ar 55,135
Mvaa 140,204,64
Vc 24,48,49
Vc 25,50,51
Mvaa 172,204,68
Ta 240,20,40960
Ta 242,20,41984
Mvaa 204,204,72
Vc 26,52,53
Vc 27,54,55
Mvaa 236,204,76
Mvaa 144,208,64
s_waitcnt lgkmcnt(6)
Ta 244,21,40960
Ta 246,21,41984
Mvaa 176,208,68
buffer_store_dwordx4 v[60:63], v2, s[24:27], s37 offen offset:1024 sc1
Mvaa 208,208,72
buffer_load_dwordx4 a[56:59], v11, s[20:23], s58 offen offset:3072 sc1
Mvaa 240,208,76
Ta 248,22,40960
Ta 250,22,41984
Mvaa 148,212,64
Ar 48,136
Ar 49,137
Mvaa 180,212,68
Ar 50,138
Ar 51,139
Mvaa 212,212,72
Ta 252,23,40960
Ta 254,23,41984
Mvaa 244,212,76
Ar 52,140
Ar 53,141
Mvaa 152,216,64
Ar 54,142
Ar 55,143
Mvaa 184,216,68
Vc 28,48,49
Vc 29,50,51
Mvaa 216,216,72
buffer_load_dwordx4 a[60:63], v11, s[20:23], 0 offen offset:3072 sc1
v_add_u32 v10, 4096, v10
v_add_u32 v11, 4096, v11
Mvaa 248,216,76
Vc 30,52,53
Vc 31,54,55
Mvaa 156,220,64
Mvaa 188,220,68
Mvaa 220,220,72
Mvaa 252,220,76
s_waitcnt vmcnt(40) lgkmcnt(0)
s_barrier
Mvaa 128,224,80
buffer_store_dwordx4 v[64:67], v2, s[24:27], s37 offen offset:2048 sc1
Mvaa 160,224,84
s_add_u32 m0, s44, 32768
Ta 192,16,49152
Ta 194,16,50176
Mvaa 192,224,88
buffer_load_dwordx4 v8, s[8:11], s48 offen offset:0 lds
Mvaa 224,224,92
Ar 48,144
Ar 49,145
Mvaa 132,228,80
Ta 196,17,49152
Ta 198,17,50176
Mvaa 164,228,84
buffer_load_dwordx4 v8, s[8:11], s49 offen offset:1024 lds
Mvaa 196,228,88
Ar 50,146
Ar 51,147
Mvaa 228,228,92
Ta 200,18,49152
Ta 202,18,50176
Mvaa 136,232,80
Ar 52,148
Ar 53,149
Mvaa 168,232,84
buffer_load_dwordx4 v9, s[8:11], s50 offen offset:2048 lds
Mvaa 200,232,88
Ta 204,19,49152
Ta 206,19,50176
Mvaa 232,232,92
Ar 54,150
Ar 55,151
Mvaa 140,236,80
Vc 32,48,49
Vc 33,50,51
Mvaa 172,236,84
Ta 208,20,49152
Ta 210,20,50176
Mvaa 204,236,88
buffer_load_dwordx4 v9, s[8:11], s51 offen offset:3072 lds
v_add_u32 v8, 524288, v8
v_add_u32 v9, 524288, v9
Mvaa 236,236,92
Vc 34,52,53
Vc 35,54,55
Mvaa 144,240,80
s_waitcnt lgkmcnt(6)
Ta 212,21,49152
Ta 214,21,50176
Mvaa 176,240,84
buffer_store_dwordx4 v[68:71], v2, s[24:27], s37 offen offset:3072 sc1
Mvaa 208,240,88
buffer_load_dwordx4 a[64:67], v10, s[20:23], s58 offen offset:0 sc1
Mvaa 240,240,92
Ta 216,22,49152
Ta 218,22,50176
Mvaa 148,244,80
Ar 48,152
Ar 49,153
Mvaa 180,244,84
Ar 50,154
Ar 51,155
Mvaa 212,244,88
Ta 220,23,49152
Ta 222,23,50176
Mvaa 244,244,92
buffer_load_dwordx4 a[68:71], v10, s[20:23], 0 offen offset:0 sc1
Mvaa 152,248,80
Ar 52,156
Ar 53,157
Mvaa 184,248,84
Ar 54,158
Ar 55,159
Mvaa 216,248,88
buffer_load_dwordx4 a[72:75], v11, s[20:23], s58 offen offset:0 sc1
Mvaa 248,248,92
Vc 36,48,49
Vc 37,50,51
Mvaa 156,252,80
Vc 38,52,53
Vc 39,54,55
Mvaa 188,252,84
buffer_load_dwordx4 a[76:79], v11, s[20:23], 0 offen offset:0 sc1
Mvaa 220,252,88
global_load_dword v13, v[14:15], off
Mvaa 252,252,92
s_waitcnt vmcnt(41) lgkmcnt(0)
Mvaa 128,192,96
s_add_u32 s37, s38, 12288
Mvaa 160,192,100
Ta 224,16,57344
Ta 226,16,58368
Mvaa 192,192,104
buffer_load_dwordx4 a[80:83], v10, s[20:23], s58 offen offset:1024 sc1
Mvaa 224,192,108
buffer_store_dwordx4 v[72:75], v2, s[24:27], s37 offen offset:0 sc1
Mvaa 132,196,96
Ta 228,17,57344
Ta 230,17,58368
Mvaa 164,196,100
Ar 48,160
Ar 49,161
Mvaa 196,196,104
Ar 50,162
Ar 51,163
Mvaa 228,196,108
Ta 232,18,57344
Ta 234,18,58368
Mvaa 136,200,96
Ar 52,164
Ar 53,165
Mvaa 168,200,100
buffer_load_dwordx4 a[84:87], v10, s[20:23], 0 offen offset:1024 sc1
Mvaa 200,200,104
Ta 236,19,57344
Ta 238,19,58368
Mvaa 232,200,108
Ar 54,166
Ar 55,167
Mvaa 140,204,96
Vc 40,48,49
Vc 41,50,51
Mvaa 172,204,100
Ta 240,20,57344
Ta 242,20,58368
Mvaa 204,204,104
Vc 42,52,53
Vc 43,54,55
Mvaa 236,204,108
Mvaa 144,208,96
s_waitcnt lgkmcnt(6)
Ta 244,21,57344
Ta 246,21,58368
Mvaa 176,208,100
buffer_store_dwordx4 v[76:79], v2, s[24:27], s37 offen offset:1024 sc1
Mvaa 208,208,104
buffer_load_dwordx4 a[88:91], v11, s[20:23], s58 offen offset:1024 sc1
Mvaa 240,208,108
Ta 248,22,57344
Ta 250,22,58368
Mvaa 148,212,96
Ar 48,168
Ar 49,169
Mvaa 180,212,100
Ar 50,170
Ar 51,171
Mvaa 212,212,104
Ta 252,23,57344
Ta 254,23,58368
Mvaa 244,212,108
Ar 52,172
Ar 53,173
Mvaa 152,216,96
Ar 54,174
Ar 55,175
Mvaa 184,216,100
Vc 44,48,49
Vc 45,50,51
Mvaa 216,216,104
buffer_load_dwordx4 a[92:95], v11, s[20:23], 0 offen offset:1024 sc1
Mvaa 248,216,108
Vc 46,52,53
Vc 47,54,55
Mvaa 156,220,96
Mvaa 188,220,100
Mvaa 220,220,104
Mvaa 252,220,108
s_waitcnt vmcnt(43) lgkmcnt(0)
s_barrier
Mvaa 128,224,112
buffer_store_dwordx4 v[80:83], v2, s[24:27], s37 offen offset:2048 sc1
Mvaa 160,224,116
s_add_u32 m0, s44, 49152
Ta 192,16,0
Ta 194,16,1024
Mvaa 192,224,120
buffer_load_dwordx4 v8, s[8:11], s48 offen offset:0 lds
Mvaa 224,224,124
Mvaa 132,228,112
Ta 196,17,0
Ta 198,17,1024
Mvaa 164,228,116
buffer_load_dwordx4 v8, s[8:11], s49 offen offset:1024 lds
Mvaa 196,228,120
Mvaa 228,228,124
Ta 200,18,0
Ta 202,18,1024
Mvaa 136,232,112
Mvaa 168,232,116
buffer_load_dwordx4 v9, s[8:11], s50 offen offset:2048 lds
Mvaa 200,232,120
Ta 204,19,0
Ta 206,19,1024
Mvaa 232,232,124
Mvaa 140,236,112
Mvaa 172,236,116
Ta 208,20,0
Ta 210,20,1024
Mvaa 204,236,120
buffer_load_dwordx4 v9, s[8:11], s51 offen offset:3072 lds
v_add_u32 v8, 524288, v8
v_add_u32 v9, 524288, v9
Mvaa 236,236,124
Mvaa 144,240,112
s_waitcnt lgkmcnt(6)
Ta 212,21,0
Ta 214,21,1024
Mvaa 176,240,116
buffer_store_dwordx4 v[84:87], v2, s[24:27], s37 offen offset:3072 sc1
Mvaa 208,240,120
buffer_load_dwordx4 a[96:99], v10, s[20:23], s58 offen offset:2048 sc1
Mvaa 240,240,124
Ta 216,22,0
Ta 218,22,1024
Mvaa 148,244,112
Mvaa 180,244,116
Mvaa 212,244,120
Ta 220,23,0
Ta 222,23,1024
Mvaa 244,244,124
buffer_load_dwordx4 a[100:103], v10, s[20:23], 0 offen offset:2048 sc1
Mvaa 152,248,112
Mvaa 184,248,116
Mvaa 216,248,120
buffer_load_dwordx4 a[104:107], v11, s[20:23], s58 offen offset:2048 sc1
Mvaa 248,248,124
Mvaa 156,252,112
Mvaa 188,252,116
buffer_load_dwordx4 a[108:111], v11, s[20:23], 0 offen offset:2048 sc1
Mvaa 220,252,120
Mvaa 252,252,124
s_waitcnt vmcnt(48) lgkmcnt(0)
Mvaa 128,192,0
s_add_u32 s37, s38, 34816
Mvaa 160,192,4
Ta 224,16,8192
Ta 226,16,9216
Mvaa 192,192,8
buffer_load_dwordx4 a[112:115], v10, s[20:23], s58 offen offset:3072 sc1
Mvaa 224,192,12
buffer_store_dwordx4 v[88:91], v2, s[24:27], s37 offen offset:0 sc1
Mvaa 132,196,0
Ta 228,17,8192
Ta 230,17,9216
Mvaa 164,196,4
Mvaa 196,196,8
Mvaa 228,196,12
Ta 232,18,8192
Ta 234,18,9216
Mvaa 136,200,0
Mvaa 168,200,4
buffer_load_dwordx4 a[116:119], v10, s[20:23], 0 offen offset:3072 sc1
Mvaa 200,200,8
Ta 236,19,8192
Ta 238,19,9216
Mvaa 232,200,12
Mvaa 140,204,0
Mvaa 172,204,4
Ta 240,20,8192
Ta 242,20,9216
Mvaa 204,204,8
Mvaa 236,204,12
Mvaa 144,208,0
s_waitcnt lgkmcnt(6)
Ta 244,21,8192
Ta 246,21,9216
Mvaa 176,208,4
buffer_store_dwordx4 v[92:95], v2, s[24:27], s37 offen offset:1024 sc1
Mvaa 208,208,8
buffer_load_dwordx4 a[120:123], v11, s[20:23], s58 offen offset:3072 sc1
Mvaa 240,208,12
Ta 248,22,8192
Ta 250,22,9216
Mvaa 148,212,0
s_mov_b32 s3, 5242880
s_mov_b32 s47, 5246976
Mvaa 180,212,4
buffer_load_dwordx4 v[56:59], v2, s[20:23], s3 offen offset:0 sc1
Mvaa 212,212,8
Ta 252,23,8192
Ta 254,23,9216
Mvaa 244,212,12
buffer_load_dwordx4 v[60:63], v2, s[20:23], s3 offen offset:1024 sc1
Mvaa 152,216,0
buffer_load_dwordx4 v[64:67], v2, s[20:23], s3 offen offset:2048 sc1
Mvaa 184,216,4
buffer_load_dwordx4 v[68:71], v2, s[20:23], s3 offen offset:3072 sc1
Mvaa 216,216,8
buffer_load_dwordx4 a[124:127], v11, s[20:23], 0 offen offset:3072 sc1
v_add_u32 v10, 4096, v10
v_add_u32 v11, 4096, v11
Mvaa 248,216,12
buffer_load_dwordx4 v[72:75], v2, s[20:23], s47 offen offset:0 sc1
Mvaa 156,220,0
buffer_load_dwordx4 v[76:79], v2, s[20:23], s47 offen offset:1024 sc1
Mvaa 188,220,4
buffer_load_dwordx4 v[80:83], v2, s[20:23], s47 offen offset:2048 sc1
Mvaa 220,220,8
buffer_load_dwordx4 v[84:87], v2, s[20:23], s47 offen offset:3072 sc1
Mvaa 252,220,12
s_waitcnt vmcnt(52) lgkmcnt(0)
s_barrier
Mvaa 128,224,16
buffer_store_dwordx4 v[96:99], v2, s[24:27], s37 offen offset:2048 sc1
Mvaa 160,224,20
s_add_u32 m0, s44, 0
Ta 192,16,16384
Ta 194,16,17408
Mvaa 192,224,24
buffer_load_dwordx4 v8, s[8:11], s48 offen offset:0 lds
Mvaa 224,224,28
Mvaa 132,228,16
Ta 196,17,16384
Ta 198,17,17408
Mvaa 164,228,20
buffer_load_dwordx4 v8, s[8:11], s49 offen offset:1024 lds
Mvaa 196,228,24
Mvaa 228,228,28
Ta 200,18,16384
Ta 202,18,17408
Mvaa 136,232,16
Mvaa 168,232,20
buffer_load_dwordx4 v9, s[8:11], s50 offen offset:2048 lds
Mvaa 200,232,24
Ta 204,19,16384
Ta 206,19,17408
Mvaa 232,232,28
Mvaa 140,236,16
Mvaa 172,236,20
Ta 208,20,16384
Ta 210,20,17408
Mvaa 204,236,24
buffer_load_dwordx4 v9, s[8:11], s51 offen offset:3072 lds
v_add_u32 v8, 524288, v8
v_add_u32 v9, 524288, v9
Mvaa 236,236,28
Mvaa 144,240,16
s_waitcnt lgkmcnt(6)
Ta 212,21,16384
Ta 214,21,17408
Mvaa 176,240,20
buffer_store_dwordx4 v[100:103], v2, s[24:27], s37 offen offset:3072 sc1
Mvaa 208,240,24
buffer_load_dwordx4 a[0:3], v10, s[20:23], s58 offen offset:0 sc1
Mvaa 240,240,28
Ta 216,22,16384
Ta 218,22,17408
Mvaa 148,244,16
Mvaa 180,244,20
Mvaa 212,244,24
Ta 220,23,16384
Ta 222,23,17408
Mvaa 244,244,28
buffer_load_dwordx4 a[4:7], v10, s[20:23], 0 offen offset:0 sc1
Mvaa 152,248,16
Mvaa 184,248,20
Mvaa 216,248,24
buffer_load_dwordx4 a[8:11], v11, s[20:23], s58 offen offset:0 sc1
Mvaa 248,248,28
Mvaa 156,252,16
Mvaa 188,252,20
buffer_load_dwordx4 a[12:15], v11, s[20:23], 0 offen offset:0 sc1
Mvaa 220,252,24
Mvaa 252,252,28
s_waitcnt vmcnt(57) lgkmcnt(0)
Mvaa 128,192,32
s_add_u32 s37, s38, 38912
Mvaa 160,192,36
Ta 224,16,24576
Ta 226,16,25600
Mvaa 192,192,40
buffer_load_dwordx4 a[16:19], v10, s[20:23], s58 offen offset:1024 sc1
Mvaa 224,192,44
buffer_store_dwordx4 v[104:107], v2, s[24:27], s37 offen offset:0 sc1
Mvaa 132,196,32
Ta 228,17,24576
Ta 230,17,25600
Mvaa 164,196,36
Mvaa 196,196,40
Mvaa 228,196,44
Ta 232,18,24576
Ta 234,18,25600
Mvaa 136,200,32
Mvaa 168,200,36
buffer_load_dwordx4 a[20:23], v10, s[20:23], 0 offen offset:1024 sc1
Mvaa 200,200,40
Ta 236,19,24576
Ta 238,19,25600
Mvaa 232,200,44
Mvaa 140,204,32
Mvaa 172,204,36
Ta 240,20,24576
Ta 242,20,25600
Mvaa 204,204,40
Mvaa 236,204,44
Mvaa 144,208,32
s_waitcnt lgkmcnt(6)
Ta 244,21,24576
Ta 246,21,25600
Mvaa 176,208,36
buffer_store_dwordx4 v[108:111], v2, s[24:27], s37 offen offset:1024 sc1
Mvaa 208,208,40
buffer_load_dwordx4 a[24:27], v11, s[20:23], s58 offen offset:1024 sc1
Mvaa 240,208,44
Ta 248,22,24576
Ta 250,22,25600
Mvaa 148,212,32
Mvaa 180,212,36
Mvaa 212,212,40
Ta 252,23,24576
Ta 254,23,25600
Mvaa 244,212,44
Mvaa 152,216,32
Mvaa 184,216,36
Mvaa 216,216,40
buffer_load_dwordx4 a[28:31], v11, s[20:23], 0 offen offset:1024 sc1
Mvaa 248,216,44
Mvaa 156,220,32
Mvaa 188,220,36
Mvaa 220,220,40
Mvaa 252,220,44
s_waitcnt vmcnt(52) lgkmcnt(0)
s_barrier
Mvaa 128,224,48
buffer_store_dwordx4 v[112:115], v2, s[24:27], s37 offen offset:2048 sc1
Mvaa 160,224,52
s_add_u32 m0, s44, 16384
Ta 192,16,32768
Ta 194,16,33792
Mvaa 192,224,56
buffer_load_dwordx4 v8, s[8:11], s48 offen offset:0 lds
Mvaa 224,224,60
Mvaa 132,228,48
Ta 196,17,32768
Ta 198,17,33792
Mvaa 164,228,52
buffer_load_dwordx4 v8, s[8:11], s49 offen offset:1024 lds
Mvaa 196,228,56
Mvaa 228,228,60
Ta 200,18,32768
Ta 202,18,33792
Mvaa 136,232,48
Mvaa 168,232,52
buffer_load_dwordx4 v9, s[8:11], s50 offen offset:2048 lds
Mvaa 200,232,56
Ta 204,19,32768
Ta 206,19,33792
Mvaa 232,232,60
Mvaa 140,236,48
Mvaa 172,236,52
Ta 208,20,32768
Ta 210,20,33792
Mvaa 204,236,56
buffer_load_dwordx4 v9, s[8:11], s51 offen offset:3072 lds
v_add_u32 v8, 524288, v8
v_add_u32 v9, 524288, v9
Mvaa 236,236,60
Mvaa 144,240,48
s_waitcnt lgkmcnt(6)
Ta 212,21,32768
Ta 214,21,33792
Mvaa 176,240,52
buffer_store_dwordx4 v[116:119], v2, s[24:27], s37 offen offset:3072 sc1
Mvaa 208,240,56
buffer_load_dwordx4 a[32:35], v10, s[20:23], s58 offen offset:2048 sc1
Mvaa 240,240,60
Ta 216,22,32768
Ta 218,22,33792
Mvaa 148,244,48
Mvaa 180,244,52
Mvaa 212,244,56
Ta 220,23,32768
Ta 222,23,33792
Mvaa 244,244,60
buffer_load_dwordx4 a[36:39], v10, s[20:23], 0 offen offset:2048 sc1
Mvaa 152,248,48
Mvaa 184,248,52
Mvaa 216,248,56
buffer_load_dwordx4 a[40:43], v11, s[20:23], s58 offen offset:2048 sc1
Mvaa 248,248,60
Mvaa 156,252,48
Mvaa 188,252,52
buffer_load_dwordx4 a[44:47], v11, s[20:23], 0 offen offset:2048 sc1
Mvaa 220,252,56
Mvaa 252,252,60
s_waitcnt vmcnt(57) lgkmcnt(0)
Mvaa 128,192,64
s_add_u32 s37, s38, 43008
Mvaa 160,192,68
Ta 224,16,40960
Ta 226,16,41984
Mvaa 192,192,72
buffer_load_dwordx4 a[48:51], v10, s[20:23], s58 offen offset:3072 sc1
Mvaa 224,192,76
buffer_store_dwordx4 v[120:123], v2, s[24:27], s37 offen offset:0 sc1
Mvaa 132,196,64
Ta 228,17,40960
Ta 230,17,41984
Mvaa 164,196,68
Mvaa 196,196,72
Mvaa 228,196,76
Ta 232,18,40960
Ta 234,18,41984
Mvaa 136,200,64
Mvaa 168,200,68
buffer_load_dwordx4 a[52:55], v10, s[20:23], 0 offen offset:3072 sc1
Mvaa 200,200,72
Ta 236,19,40960
Ta 238,19,41984
Mvaa 232,200,76
Mvaa 140,204,64
Mvaa 172,204,68
Ta 240,20,40960
Ta 242,20,41984
Mvaa 204,204,72
Mvaa 236,204,76
Mvaa 144,208,64
s_waitcnt lgkmcnt(6)
Ta 244,21,40960
Ta 246,21,41984
Mvaa 176,208,68
buffer_store_dwordx4 v[124:127], v2, s[24:27], s37 offen offset:1024 sc1
Mvaa 208,208,72
buffer_load_dwordx4 a[56:59], v11, s[20:23], s58 offen offset:3072 sc1
Mvaa 240,208,76
Ta 248,22,40960
Ta 250,22,41984
Mvaa 148,212,64
Mvaa 180,212,68
Mvaa 212,212,72
Ta 252,23,40960
Ta 254,23,41984
Mvaa 244,212,76
Mvaa 152,216,64
Mvaa 184,216,68
Mvaa 216,216,72
buffer_load_dwordx4 a[60:63], v11, s[20:23], 0 offen offset:3072 sc1
v_add_u32 v10, 4096, v10
v_add_u32 v11, 4096, v11
Mvaa 248,216,76
Mvaa 156,220,64
Mvaa 188,220,68
Mvaa 220,220,72
Mvaa 252,220,76
s_waitcnt vmcnt(51) lgkmcnt(0)
s_barrier
Mvaa 128,224,80
buffer_store_dwordx4 v[24:27], v2, s[24:27], s37 offen offset:2048 sc1
Mvaa 160,224,84
s_add_u32 m0, s44, 32768
Ta 192,16,49152
Ta 194,16,50176
Mvaa 192,224,88
buffer_load_dwordx4 v8, s[8:11], s48 offen offset:0 lds
Mvaa 224,224,92
Mvaa 132,228,80
Ta 196,17,49152
Ta 198,17,50176
Mvaa 164,228,84
buffer_load_dwordx4 v8, s[8:11], s49 offen offset:1024 lds
Mvaa 196,228,88
Mvaa 228,228,92
Ta 200,18,49152
Ta 202,18,50176
Mvaa 136,232,80
Mvaa 168,232,84
buffer_load_dwordx4 v9, s[8:11], s50 offen offset:2048 lds
Mvaa 200,232,88
Ta 204,19,49152
Ta 206,19,50176
Mvaa 232,232,92
Mvaa 140,236,80
Mvaa 172,236,84
Ta 208,20,49152
Ta 210,20,50176
Mvaa 204,236,88
buffer_load_dwordx4 v9, s[8:11], s51 offen offset:3072 lds
v_add_u32 v8, 524288, v8
v_add_u32 v9, 524288, v9
Mvaa 236,236,92
Mvaa 144,240,80
s_waitcnt lgkmcnt(6)
Ta 212,21,49152
Ta 214,21,50176
Mvaa 176,240,84
buffer_store_dwordx4 v[28:31], v2, s[24:27], s37 offen offset:3072 sc1
Mvaa 208,240,88
buffer_load_dwordx4 a[64:67], v10, s[20:23], s58 offen offset:0 sc1
Mvaa 240,240,92
Ta 216,22,49152
Ta 218,22,50176
Mvaa 148,244,80
Mvaa 180,244,84
Mvaa 212,244,88
Ta 220,23,49152
Ta 222,23,50176
Mvaa 244,244,92
buffer_load_dwordx4 a[68:71], v10, s[20:23], 0 offen offset:0 sc1
Mvaa 152,248,80
Mvaa 184,248,84
Mvaa 216,248,88
buffer_load_dwordx4 a[72:75], v11, s[20:23], s58 offen offset:0 sc1
Mvaa 248,248,92
Mvaa 156,252,80
Mvaa 188,252,84
buffer_load_dwordx4 a[76:79], v11, s[20:23], 0 offen offset:0 sc1
Mvaa 220,252,88
Mvaa 252,252,92
s_waitcnt vmcnt(56) lgkmcnt(0)
Mvaa 128,192,96
s_add_u32 s37, s38, 47104
Mvaa 160,192,100
Ta 224,16,57344
Ta 226,16,58368
Mvaa 192,192,104
buffer_load_dwordx4 a[80:83], v10, s[20:23], s58 offen offset:1024 sc1
Mvaa 224,192,108
buffer_store_dwordx4 v[32:35], v2, s[24:27], s37 offen offset:0 sc1
Mvaa 132,196,96
Ta 228,17,57344
Ta 230,17,58368
Mvaa 164,196,100
Mvaa 196,196,104
Mvaa 228,196,108
Ta 232,18,57344
Ta 234,18,58368
Mvaa 136,200,96
Mvaa 168,200,100
buffer_load_dwordx4 a[84:87], v10, s[20:23], 0 offen offset:1024 sc1
Mvaa 200,200,104
Ta 236,19,57344
Ta 238,19,58368
Mvaa 232,200,108
Mvaa 140,204,96
Mvaa 172,204,100
Ta 240,20,57344
Ta 242,20,58368
Mvaa 204,204,104
Mvaa 236,204,108
Mvaa 144,208,96
s_waitcnt lgkmcnt(6)
Ta 244,21,57344
Ta 246,21,58368
Mvaa 176,208,100
buffer_store_dwordx4 v[36:39], v2, s[24:27], s37 offen offset:1024 sc1
Mvaa 208,208,104
buffer_load_dwordx4 a[88:91], v11, s[20:23], s58 offen offset:1024 sc1
Mvaa 240,208,108
Ta 248,22,57344
Ta 250,22,58368
Mvaa 148,212,96
Mvaa 180,212,100
Mvaa 212,212,104
Ta 252,23,57344
Ta 254,23,58368
Mvaa 244,212,108
Mvaa 152,216,96
Mvaa 184,216,100
Mvaa 216,216,104
buffer_load_dwordx4 a[92:95], v11, s[20:23], 0 offen offset:1024 sc1
Mvaa 248,216,108
Mvaa 156,220,96
Mvaa 188,220,100
Mvaa 220,220,104
Mvaa 252,220,108
s_waitcnt vmcnt(43) lgkmcnt(0)
s_barrier
Mvaa 128,224,112
buffer_store_dwordx4 v[40:43], v2, s[24:27], s37 offen offset:2048 sc1
Mvaa 160,224,116
s_add_u32 m0, s44, 49152
Ta 192,16,0
Ta 194,16,1024
Mvaa 192,224,120
buffer_load_dwordx4 v8, s[8:11], s48 offen offset:0 lds
Mvaa 224,224,124
Mvaa 132,228,112
Ta 196,17,0
Ta 198,17,1024
Mvaa 164,228,116
buffer_load_dwordx4 v8, s[8:11], s49 offen offset:1024 lds
Mvaa 196,228,120
Mvaa 228,228,124
Ta 200,18,0
Ta 202,18,1024
Mvaa 136,232,112
Mvaa 168,232,116
buffer_load_dwordx4 v9, s[8:11], s50 offen offset:2048 lds
Mvaa 200,232,120
Ta 204,19,0
Ta 206,19,1024
Mvaa 232,232,124
Mvaa 140,236,112
Mvaa 172,236,116
Ta 208,20,0
Ta 210,20,1024
Mvaa 204,236,120
buffer_load_dwordx4 v9, s[8:11], s51 offen offset:3072 lds
v_add_u32 v8, 524288, v8
v_add_u32 v9, 524288, v9
Mvaa 236,236,124
Mvaa 144,240,112
s_waitcnt lgkmcnt(6)
Ta 212,21,0
Ta 214,21,1024
Mvaa 176,240,116
buffer_store_dwordx4 v[44:47], v2, s[24:27], s37 offen offset:3072 sc1
Mvaa 208,240,120
buffer_load_dwordx4 a[96:99], v10, s[20:23], s58 offen offset:2048 sc1
Mvaa 240,240,124
Ta 216,22,0
Ta 218,22,1024
Mvaa 148,244,112
v_mov_b32 v12, 1
v_and_b32_e64 v1, 15, v0
Mvaa 180,244,116
v_lshlrev_b32_e64 v1, 2, v1
Mvaa 212,244,120
Ta 220,23,0
Ta 222,23,1024
Mvaa 244,244,124
buffer_load_dwordx4 a[100:103], v10, s[20:23], 0 offen offset:2048 sc1
Mvaa 152,248,112
s_lshr_b32 s6, s33, 1
s_lshl_b32 s6, s6, 7
s_add_u32 s6, s6, 5296128
Mvaa 184,248,116
s_cmp_eq_u32 s32, 0
s_cselect_b32 s6, s6, 2146435072
Mvaa 216,248,120
buffer_load_dwordx4 a[104:107], v11, s[20:23], s58 offen offset:2048 sc1
Mvaa 248,248,124
Mvaa 156,252,112
Mvaa 188,252,116
buffer_load_dwordx4 a[108:111], v11, s[20:23], 0 offen offset:2048 sc1
Mvaa 220,252,120
Mvaa 252,252,124
s_waitcnt vmcnt(48) lgkmcnt(0)
Mvaa 128,192,0
Mvaa 160,192,4
Ta 224,16,8192
Ta 226,16,9216
Mvaa 192,192,8
buffer_load_dwordx4 a[112:115], v10, s[20:23], s58 offen offset:3072 sc1
Mvaa 224,192,12
Mvaa 132,196,0
Ta 228,17,8192
Ta 230,17,9216
Mvaa 164,196,4
Mvaa 196,196,8
Mvaa 228,196,12
Ta 232,18,8192
Ta 234,18,9216
Mvaa 136,200,0
Mvaa 168,200,4
buffer_load_dwordx4 a[116:119], v10, s[20:23], 0 offen offset:3072 sc1
Mvaa 200,200,8
Ta 236,19,8192
Ta 238,19,9216
Mvaa 232,200,12
Mvaa 140,204,0
Mvaa 172,204,4
Ta 240,20,8192
Ta 242,20,9216
Mvaa 204,204,8
Mvaa 236,204,12
Mvaa 144,208,0
s_waitcnt lgkmcnt(6)
Ta 244,21,8192
Ta 246,21,9216
Mvaa 176,208,4
v_max_u32 v14, v56, v57
v_min_u32_e64 v15, v56, v57
Mvaa 208,208,8
buffer_load_dwordx4 a[120:123], v11, s[20:23], s58 offen offset:3072 sc1
Mvaa 240,208,12
Ta 248,22,8192
Ta 250,22,9216
Mvaa 148,212,0
v_med3_u32 v15, v14, v15, v58
v_max_u32_e64 v14, v14, v58
Mvaa 180,212,4
v_med3_u32 v15, v14, v15, v59
v_max_u32_e64 v14, v14, v59
Mvaa 212,212,8
Ta 252,23,8192
Ta 254,23,9216
Mvaa 244,212,12
v_med3_u32 v15, v14, v15, v60
v_max_u32_e64 v14, v14, v60
Mvaa 152,216,0
v_med3_u32 v15, v14, v15, v61
v_max_u32_e64 v14, v14, v61
Mvaa 184,216,4
v_med3_u32 v15, v14, v15, v62
v_max_u32_e64 v14, v14, v62
Mvaa 216,216,8
buffer_load_dwordx4 a[124:127], v11, s[20:23], 0 offen offset:3072 sc1
v_add_u32 v10, 4096, v10
v_add_u32 v11, 4096, v11
Mvaa 248,216,12
v_med3_u32 v15, v14, v15, v63
v_max_u32_e64 v14, v14, v63
Mvaa 156,220,0
v_med3_u32 v15, v14, v15, v64
v_max_u32_e64 v14, v14, v64
Mvaa 188,220,4
v_med3_u32 v15, v14, v15, v65
v_max_u32_e64 v14, v14, v65
Mvaa 220,220,8
v_med3_u32 v15, v14, v15, v66
v_max_u32_e64 v14, v14, v66
Mvaa 252,220,12
v_med3_u32 v15, v14, v15, v67
v_max_u32 v14, v14, v67
s_waitcnt vmcnt(41) lgkmcnt(0)
s_barrier
Mvaa 128,224,16
v_med3_u32 v15, v14, v15, v68
v_max_u32 v14, v14, v68
Mvaa 160,224,20
s_add_u32 m0, s44, 0
Ta 192,16,16384
Ta 194,16,17408
Mvaa 192,224,24
buffer_load_dwordx4 v8, s[8:11], s48 offen offset:0 lds
Mvaa 224,224,28
v_med3_u32 v15, v14, v15, v69
v_max_u32 v14, v14, v69
Mvaa 132,228,16
Ta 196,17,16384
Ta 198,17,17408
Mvaa 164,228,20
buffer_load_dwordx4 v8, s[8:11], s49 offen offset:1024 lds
Mvaa 196,228,24
v_med3_u32 v15, v14, v15, v70
v_max_u32_e64 v14, v14, v70
Mvaa 228,228,28
Ta 200,18,16384
Ta 202,18,17408
Mvaa 136,232,16
v_med3_u32 v15, v14, v15, v71
v_max_u32_e64 v14, v14, v71
Mvaa 168,232,20
buffer_load_dwordx4 v9, s[8:11], s50 offen offset:2048 lds
Mvaa 200,232,24
Ta 204,19,16384
Ta 206,19,17408
Mvaa 232,232,28
v_med3_u32 v15, v14, v15, v72
v_max_u32_e64 v14, v14, v72
Mvaa 140,236,16
v_med3_u32 v15, v14, v15, v73
v_max_u32_e64 v14, v14, v73
Mvaa 172,236,20
Ta 208,20,16384
Ta 210,20,17408
Mvaa 204,236,24
buffer_load_dwordx4 v9, s[8:11], s51 offen offset:3072 lds
v_add_u32 v8, 524288, v8
v_add_u32 v9, 524288, v9
Mvaa 236,236,28
v_med3_u32 v15, v14, v15, v74
v_max_u32_e64 v14, v14, v74
Mvaa 144,240,16
s_waitcnt lgkmcnt(6)
Ta 212,21,16384
Ta 214,21,17408
Mvaa 176,240,20
v_med3_u32 v15, v14, v15, v75
v_max_u32 v14, v14, v75
Mvaa 208,240,24
buffer_load_dwordx4 a[0:3], v10, s[20:23], s58 offen offset:0 sc1
Mvaa 240,240,28
Ta 216,22,16384
Ta 218,22,17408
Mvaa 148,244,16
v_med3_u32 v15, v14, v15, v76
v_max_u32_e64 v14, v14, v76
Mvaa 180,244,20
v_med3_u32 v15, v14, v15, v77
v_max_u32_e64 v14, v14, v77
Mvaa 212,244,24
Ta 220,23,16384
Ta 222,23,17408
Mvaa 244,244,28
buffer_load_dwordx4 a[4:7], v10, s[20:23], 0 offen offset:0 sc1
Mvaa 152,248,16
v_med3_u32 v15, v14, v15, v78
v_max_u32_e64 v14, v14, v78
Mvaa 184,248,20
v_med3_u32 v15, v14, v15, v79
v_max_u32_e64 v14, v14, v79
Mvaa 216,248,24
buffer_load_dwordx4 a[8:11], v11, s[20:23], s58 offen offset:0 sc1
Mvaa 248,248,28
v_med3_u32 v15, v14, v15, v80
v_max_u32_e64 v14, v14, v80
Mvaa 156,252,16
v_med3_u32 v15, v14, v15, v81
v_max_u32_e64 v14, v14, v81
Mvaa 188,252,20
buffer_load_dwordx4 a[12:15], v11, s[20:23], 0 offen offset:0 sc1
Mvaa 220,252,24
v_med3_u32 v15, v14, v15, v82
v_max_u32_e64 v14, v14, v82
Mvaa 252,252,28
v_med3_u32 v15, v14, v15, v83
v_max_u32 v14, v14, v83
s_waitcnt vmcnt(44) lgkmcnt(0)
Mvaa 128,192,32
v_med3_u32 v15, v14, v15, v84
v_max_u32_e64 v14, v14, v84
Mvaa 160,192,36
Ta 224,16,24576
Ta 226,16,25600
Mvaa 192,192,40
buffer_load_dwordx4 a[16:19], v10, s[20:23], s58 offen offset:1024 sc1
Mvaa 224,192,44
v_med3_u32 v15, v14, v15, v85
v_max_u32_e64 v14, v14, v85
Mvaa 132,196,32
Ta 228,17,24576
Ta 230,17,25600
Mvaa 164,196,36
v_med3_u32 v15, v14, v15, v86
v_max_u32_e64 v14, v14, v86
Mvaa 196,196,40
v_med3_u32 v15, v14, v15, v87
v_max_u32_e64 v14, v14, v87
Mvaa 228,196,44
Ta 232,18,24576
Ta 234,18,25600
Mvaa 136,200,32
v_mov_b32_e64 v13, v14
Mvaa 168,200,36
buffer_load_dwordx4 a[20:23], v10, s[20:23], 0 offen offset:1024 sc1
Mvaa 200,200,40
Ta 236,19,24576
Ta 238,19,25600
Mvaa 232,200,44
v_max_u32_dpp v13, v13, v13 quad_perm:[1,0,3,2] row_mask:0xf bank_mask:0xf
Mvaa 140,204,32
s_nop 0
v_max_u32_dpp v13, v13, v13 quad_perm:[2,3,0,1] row_mask:0xf bank_mask:0xf
Mvaa 172,204,36
Ta 240,20,24576
Ta 242,20,25600
Mvaa 204,204,40
v_max_u32_dpp v13, v13, v13 row_half_mirror row_mask:0xf bank_mask:0xf
Mvaa 236,204,44
s_nop 0
v_max_u32_dpp v13, v13, v13 row_mirror row_mask:0xf bank_mask:0xf
Mvaa 144,208,32
s_waitcnt lgkmcnt(6)
Ta 244,21,24576
Ta 246,21,25600
Mvaa 176,208,36
v_readlane_b32 s3, v13, 0
v_readlane_b32 s47, v13, 16
Mvaa 208,208,40
buffer_load_dwordx4 a[24:27], v11, s[20:23], s58 offen offset:1024 sc1
Mvaa 240,208,44
Ta 248,22,24576
Ta 250,22,25600
Mvaa 148,212,32
v_readlane_b32 s4, v13, 32
v_readlane_b32 s5, v13, 48
Mvaa 180,212,36
s_max_u32 s3, s3, s47
s_max_u32 s4, s4, s5
s_max_u32 s40, s3, s4
Mvaa 212,212,40
Ta 252,23,24576
Ta 254,23,25600
Mvaa 244,212,44
v_cmp_eq_u32 vcc, s40, v14
Mvaa 152,216,32
s_nop 0
v_cndmask_b32 v13, v14, v15, vcc
Mvaa 184,216,36
s_nop 0
v_max_u32_dpp v13, v13, v13 quad_perm:[1,0,3,2] row_mask:0xf bank_mask:0xf
Mvaa 216,216,40
buffer_load_dwordx4 a[28:31], v11, s[20:23], 0 offen offset:1024 sc1
Mvaa 248,216,44
v_max_u32_dpp v13, v13, v13 quad_perm:[2,3,0,1] row_mask:0xf bank_mask:0xf
Mvaa 156,220,32
s_nop 0
v_max_u32_dpp v13, v13, v13 row_half_mirror row_mask:0xf bank_mask:0xf
Mvaa 188,220,36
s_nop 0
v_max_u32_dpp v13, v13, v13 row_mirror row_mask:0xf bank_mask:0xf
Mvaa 220,220,40
v_readlane_b32 s3, v13, 0
v_readlane_b32 s47, v13, 16
Mvaa 252,220,44
v_readlane_b32 s4, v13, 32
v_readlane_b32 s5, v13, 48
s_waitcnt vmcnt(37) lgkmcnt(0)
s_barrier
Mvaa 128,224,48
s_max_u32 s3, s3, s47
s_max_u32 s4, s4, s5
s_max_u32 s41, s3, s4
Mvaa 160,224,52
s_add_u32 m0, s44, 16384
Ta 192,16,32768
Ta 194,16,33792
Mvaa 192,224,56
buffer_load_dwordx4 v8, s[8:11], s48 offen offset:0 lds
Mvaa 224,224,60
s_and_b32 s3, s40, 0xffff
s_sub_u32 s42, 0xffff, s3
s_and_b32 s3, s41, 0xffff
Mvaa 132,228,48
Ta 196,17,32768
Ta 198,17,33792
Mvaa 164,228,52
buffer_load_dwordx4 v8, s[8:11], s49 offen offset:1024 lds
Mvaa 196,228,56
s_sub_u32 s43, 0xffff, s3
v_mov_b32 v60, s40
v_not_b32_e64 v61, v60
Mvaa 228,228,60
Ta 200,18,32768
Ta 202,18,33792
Mvaa 136,232,48
v_ashrrev_i32_e64 v61, 31, v61
v_or_b32 v61, 0x80000000, v61
Mvaa 168,232,52
buffer_load_dwordx4 v9, s[8:11], s50 offen offset:2048 lds
Mvaa 200,232,56
Ta 204,19,32768
Ta 206,19,33792
Mvaa 232,232,60
v_xor_b32_e64 v60, v60, v61
v_and_b32 v60, 0xffff0000, v60
Mvaa 140,236,48
v_mul_f32 v60, 0xbfb8aa3b, v60
Mvaa 172,236,52
Ta 208,20,32768
Ta 210,20,33792
Mvaa 204,236,56
buffer_load_dwordx4 v9, s[8:11], s51 offen offset:3072 lds
v_add_u32 v8, 524288, v8
v_add_u32 v9, 524288, v9
Mvaa 236,236,60
VE 60,60
Mvaa 144,240,48
s_waitcnt lgkmcnt(6)
Ta 212,21,32768
Ta 214,21,33792
Mvaa 176,240,52
v_add_f32 v60, 1.0, v60
Mvaa 208,240,56
buffer_load_dwordx4 a[32:35], v10, s[20:23], s58 offen offset:2048 sc1
Mvaa 240,240,60
Ta 216,22,32768
Ta 218,22,33792
Mvaa 148,244,48
v_rcp_f32_e64 v60, v60
Mvaa 180,244,52
Vc 60,60,60
v_and_b32 v64, 0xffff0000, v60
Mvaa 212,244,56
Ta 220,23,32768
Ta 222,23,33792
Mvaa 244,244,60
buffer_load_dwordx4 a[36:39], v10, s[20:23], 0 offen offset:2048 sc1
Mvaa 152,248,48
v_mov_b32 v60, s41
v_not_b32 v61, v60
Mvaa 184,248,52
v_ashrrev_i32_e64 v61, 31, v61
v_or_b32 v61, 0x80000000, v61
Mvaa 216,248,56
buffer_load_dwordx4 a[40:43], v11, s[20:23], s58 offen offset:2048 sc1
Mvaa 248,248,60
v_xor_b32_e64 v60, v60, v61
v_and_b32 v60, 0xffff0000, v60
Mvaa 156,252,48
v_mul_f32 v60, 0xbfb8aa3b, v60
Mvaa 188,252,52
buffer_load_dwordx4 a[44:47], v11, s[20:23], 0 offen offset:2048 sc1
Mvaa 220,252,56
VE 60,60
Mvaa 252,252,60
v_add_f32 v60, 1.0, v60
s_waitcnt vmcnt(40) lgkmcnt(0)
Mvaa 128,192,64
v_rcp_f32_e64 v60, v60
Mvaa 160,192,68
Ta 224,16,40960
Ta 226,16,41984
Mvaa 192,192,72
buffer_load_dwordx4 a[48:51], v10, s[20:23], s58 offen offset:3072 sc1
Mvaa 224,192,76
Vc 60,60,60
v_and_b32 v65, 0xffff0000, v60
Mvaa 132,196,64
Ta 228,17,40960
Ta 230,17,41984
Mvaa 164,196,68
v_mov_b32 v48, 0
v_mov_b32 v49, 0
Mvaa 196,196,72
v_mov_b32 v50, 0
v_mov_b32 v51, 0
Mvaa 228,196,76
Ta 232,18,40960
Ta 234,18,41984
Mvaa 136,200,64
v_mov_b32 v52, 0
v_mov_b32 v53, 0
Mvaa 168,200,68
buffer_load_dwordx4 a[52:55], v10, s[20:23], 0 offen offset:3072 sc1
Mvaa 200,200,72
Ta 236,19,40960
Ta 238,19,41984
Mvaa 232,200,76
v_mov_b32 v54, 0
v_mov_b32 v55, 0
Mvaa 140,204,64
v_mov_b32 v56, 0
v_mov_b32 v57, 0
Mvaa 172,204,68
Ta 240,20,40960
Ta 242,20,41984
Mvaa 204,204,72
v_mov_b32 v58, 0
v_mov_b32 v59, 0
Mvaa 236,204,76
v_mov_b32 v60, 0
v_mov_b32 v61, 0
Mvaa 144,208,64
s_waitcnt lgkmcnt(6)
Ta 244,21,40960
Ta 246,21,41984
Mvaa 176,208,68
v_mov_b32 v62, 0
v_mov_b32_e64 v63, 0
Mvaa 208,208,72
buffer_load_dwordx4 a[56:59], v11, s[20:23], s58 offen offset:3072 sc1
Mvaa 240,208,76
Ta 248,22,40960
Ta 250,22,41984
Mvaa 148,212,64
s_mul_i32 s3, s34, s34
s_lshl_b32 s47, s33, 6
s_add_u32 s3, s3, s47
Mvaa 180,212,68
s_lshl_b32 s3, s3, 2
s_add_u32 s3, s3, s32
s_lshl_b32 s3, s3, 7
Mvaa 212,212,72
Ta 252,23,40960
Ta 254,23,41984
Mvaa 244,212,76
s_sub_u32 s3, s3, 512
v_min_u32 v13, 32, v0
v_mov_b32 v28, s94
Mvaa 152,216,64
v_mov_b32 v29, s95
v_mov_b32 v30, v13
Mvaa 184,216,68
v_mov_b32 v14, s100
v_mov_b32 v15, s101
Mvaa 216,216,72
buffer_load_dwordx4 a[60:63], v11, s[20:23], 0 offen offset:3072 sc1
v_add_u32 v10, 4096, v10
v_add_u32 v11, 4096, v11
Mvaa 248,216,76
v_cmp_le_u32 vcc, 7, v13
v_subrev_u32 v31, 7, v13
Mvaa 156,220,64
v_cndmask_b32 v28, v28, v14, vcc
v_cndmask_b32 v29, v29, v15, vcc
Mvaa 188,220,68
v_cndmask_b32 v30, v30, v31, vcc
Mvaa 220,220,72
v_mov_b32 v14, s60
v_mov_b32_e64 v15, s61
Mvaa 252,220,76
v_cmp_le_u32 vcc, 11, v13
v_subrev_u32 v31, 11, v13
s_waitcnt vmcnt(32) lgkmcnt(0)
s_barrier
Mvaa 128,224,80
s_mov_b64 exec, 1
buffer_store_dword v12, v7, s[20:23], s39 offen sc1
s_mov_b64 exec, -1
Mvaa 160,224,84
s_add_u32 m0, s44, 32768
Ta 192,16,49152
Ta 194,16,50176
Mvaa 192,224,88
buffer_load_dwordx4 v8, s[8:11], s48 offen offset:0 lds
Mvaa 224,224,92
v_cndmask_b32 v28, v28, v14, vcc
v_cndmask_b32 v29, v29, v15, vcc
Mvaa 132,228,80
Ta 196,17,49152
Ta 198,17,50176
Mvaa 164,228,84
buffer_load_dwordx4 v8, s[8:11], s49 offen offset:1024 lds
Mvaa 196,228,88
v_cndmask_b32 v30, v30, v31, vcc
Mvaa 228,228,92
Ta 200,18,49152
Ta 202,18,50176
Mvaa 136,232,80
v_mov_b32 v14, s68
v_mov_b32_e64 v15, s69
Mvaa 168,232,84
buffer_load_dwordx4 v9, s[8:11], s50 offen offset:2048 lds
Mvaa 200,232,88
Ta 204,19,49152
Ta 206,19,50176
Mvaa 232,232,92
v_cmp_le_u32 vcc, 18, v13
v_subrev_u32 v31, 18, v13
Mvaa 140,236,80
v_cndmask_b32 v28, v28, v14, vcc
v_cndmask_b32 v29, v29, v15, vcc
Mvaa 172,236,84
Ta 208,20,49152
Ta 210,20,50176
Mvaa 204,236,88
buffer_load_dwordx4 v9, s[8:11], s51 offen offset:3072 lds
v_add_u32 v8, 524288, v8
v_add_u32 v9, 524288, v9
Mvaa 236,236,92
v_cndmask_b32 v30, v30, v31, vcc
Mvaa 144,240,80
s_waitcnt lgkmcnt(6)
Ta 212,21,49152
Ta 214,21,50176
Mvaa 176,240,84
v_mov_b32 v14, s92
v_mov_b32 v15, s93
Mvaa 208,240,88
buffer_load_dwordx4 a[64:67], v10, s[20:23], s58 offen offset:0 sc1
Mvaa 240,240,92
Ta 216,22,49152
Ta 218,22,50176
Mvaa 148,244,80
v_cmp_le_u32 vcc, 25, v13
v_subrev_u32 v31, 25, v13
Mvaa 180,244,84
v_cndmask_b32 v28, v28, v14, vcc
v_cndmask_b32 v29, v29, v15, vcc
Mvaa 212,244,88
Ta 220,23,49152
Ta 222,23,50176
Mvaa 244,244,92
buffer_load_dwordx4 a[68:71], v10, s[20:23], 0 offen offset:0 sc1
Mvaa 152,248,80
v_cndmask_b32 v30, v30, v31, vcc
Mvaa 184,248,84
v_lshlrev_b32 v30, 20, v30
v_add_u32_e64 v30, s3, v30
Mvaa 216,248,88
buffer_load_dwordx4 a[72:75], v11, s[20:23], s58 offen offset:0 sc1
Mvaa 248,248,92
v_ashrrev_i32_e64 v31, 31, v30
v_lshl_add_u64 v[28:29], v[30:31], 0, v[28:29]
Mvaa 156,252,80
s_mov_b32 s40, 512
s_mov_b32 s41, 0
v_readfirstlane_b32 s100, v64
Mvaa 188,252,84
buffer_load_dwordx4 a[76:79], v11, s[20:23], 0 offen offset:0 sc1
Mvaa 220,252,88
v_readfirstlane_b32 s101, v65
Mvaa 252,252,92
s_mov_b32 s24, s60
s_mov_b32 s25, s61
s_mov_b32 s26, s62
s_waitcnt vmcnt(37) lgkmcnt(0)
Mvaa 128,192,96
s_add_u32 s3, s34, 7
s_and_b32 s3, s3, 7
s_lshl_b32 s3, s3, 5
Mvaa 160,192,100
Ta 224,16,57344
Ta 226,16,58368
Mvaa 192,192,104
buffer_load_dwordx4 a[80:83], v10, s[20:23], s58 offen offset:1024 sc1
Mvaa 224,192,108
s_add_u32 s3, s3, s33
s_mul_i32 s92, s3, 2341
s_lshr_b32 s92, s92, 16
Mvaa 132,196,96
Ta 228,17,57344
Ta 230,17,58368
Mvaa 164,196,100
s_mul_i32 s47, s92, 28
s_sub_u32 s4, s3, s47
s_mul_i32 s5, s92, 917504
Mvaa 196,196,104
s_lshl_b32 s47, s4, 8
s_add_u32 s5, s5, s47
s_mov_b32 s94, 1040356334
Mvaa 228,196,108
Ta 232,18,57344
Ta 234,18,58368
Mvaa 136,200,96
s_mov_b32 s95, 1040356334
s_sub_u32 s55, 15, s34
s_sub_u32 s45, s36, 3
Mvaa 168,200,100
buffer_load_dwordx4 a[84:87], v10, s[20:23], 0 offen offset:1024 sc1
Mvaa 200,200,104
Ta 236,19,57344
Ta 238,19,58368
Mvaa 232,200,108
s_sub_u32 s46, s35, 3
s_mov_b32 s54, s44
s_sub_u32 s35, s35, 2
Mvaa 140,204,96
s_sub_u32 s36, s36, 2
Mvaa 172,204,100
Ta 240,20,57344
Ta 242,20,58368
Mvaa 204,204,104
Mvaa 236,204,108
Mvaa 144,208,96
s_waitcnt lgkmcnt(6)
Ta 244,21,57344
Ta 246,21,58368
Mvaa 176,208,100
Mvaa 208,208,104
buffer_load_dwordx4 a[88:91], v11, s[20:23], s58 offen offset:1024 sc1
Mvaa 240,208,108
Ta 248,22,57344
Ta 250,22,58368
Mvaa 148,212,96
Mvaa 180,212,100
Mvaa 212,212,104
Ta 252,23,57344
Ta 254,23,58368
Mvaa 244,212,108
Mvaa 152,216,96
Mvaa 184,216,100
Mvaa 216,216,104
buffer_load_dwordx4 a[92:95], v11, s[20:23], 0 offen offset:1024 sc1
Mvaa 248,216,108
Mvaa 156,220,96
Mvaa 188,220,100
Mvaa 220,220,104
Mvaa 252,220,108
s_waitcnt vmcnt(33) lgkmcnt(0)
s_barrier
Mvaa 128,224,112
Mvaa 160,224,116
s_add_u32 m0, s44, 49152
Ta 192,16,0
Ta 194,16,1024
Mvaa 192,224,120
buffer_load_dwordx4 v8, s[8:11], s48 offen offset:0 lds
Mvaa 224,224,124
Mvaa 132,228,112
Ta 196,17,0
Ta 198,17,1024
Mvaa 164,228,116
buffer_load_dwordx4 v8, s[8:11], s49 offen offset:1024 lds
Mvaa 196,228,120
Mvaa 228,228,124
Ta 200,18,0
Ta 202,18,1024
Mvaa 136,232,112
Mvaa 168,232,116
buffer_load_dwordx4 v9, s[8:11], s50 offen offset:2048 lds
Mvaa 200,232,120
Ta 204,19,0
Ta 206,19,1024
Mvaa 232,232,124
Mvaa 140,236,112
Mvaa 172,236,116
Ta 208,20,0
Ta 210,20,1024
Mvaa 204,236,120
buffer_load_dwordx4 v9, s[8:11], s51 offen offset:3072 lds
v_add_u32 v8, 524288, v8
v_add_u32 v9, 524288, v9
Mvaa 236,236,124
Mvaa 144,240,112
s_waitcnt lgkmcnt(6)
Ta 212,21,0
Ta 214,21,1024
Mvaa 176,240,116
Mvaa 208,240,120
buffer_load_dwordx4 a[96:99], v10, s[20:23], s58 offen offset:2048 sc1
Mvaa 240,240,124
Ta 216,22,0
Ta 218,22,1024
Mvaa 148,244,112
Mvaa 180,244,116
Mvaa 212,244,120
Ta 220,23,0
Ta 222,23,1024
Mvaa 244,244,124
buffer_load_dwordx4 a[100:103], v10, s[20:23], 0 offen offset:2048 sc1
Mvaa 152,248,112
Mvaa 184,248,116
Mvaa 216,248,120
buffer_load_dwordx4 a[104:107], v11, s[20:23], s58 offen offset:2048 sc1
Mvaa 248,248,124
Mvaa 156,252,112
Mvaa 188,252,116
buffer_load_dwordx4 a[108:111], v11, s[20:23], 0 offen offset:2048 sc1
Mvaa 220,252,120
Mvaa 252,252,124
s_waitcnt vmcnt(37) lgkmcnt(0)
Mvaa 128,192,0
Mvaa 160,192,4
Ta 224,16,8192
Ta 226,16,9216
Mvaa 192,192,8
buffer_load_dwordx4 a[112:115], v10, s[20:23], s58 offen offset:3072 sc1
Mvaa 224,192,12
Mvaa 132,196,0
Ta 228,17,8192
Ta 230,17,9216
Mvaa 164,196,4
Mvaa 196,196,8
Mvaa 228,196,12
Ta 232,18,8192
Ta 234,18,9216
Mvaa 136,200,0
Mvaa 168,200,4
buffer_load_dwordx4 a[116:119], v10, s[20:23], 0 offen offset:3072 sc1
Mvaa 200,200,8
Ta 236,19,8192
Ta 238,19,9216
Mvaa 232,200,12
Mvaa 140,204,0
Mvaa 172,204,4
Ta 240,20,8192
Ta 242,20,9216
Mvaa 204,204,8
Mvaa 236,204,12
Mvaa 144,208,0
s_waitcnt lgkmcnt(6)
Ta 244,21,8192
Ta 246,21,9216
Mvaa 176,208,4
Mvaa 208,208,8
buffer_load_dwordx4 a[120:123], v11, s[20:23], s58 offen offset:3072 sc1
Mvaa 240,208,12
Ta 248,22,8192
Ta 250,22,9216
Mvaa 148,212,0
Mvaa 180,212,4
Mvaa 212,212,8
Ta 252,23,8192
Ta 254,23,9216
Mvaa 244,212,12
Mvaa 152,216,0
Mvaa 184,216,4
Mvaa 216,216,8
buffer_load_dwordx4 a[124:127], v11, s[20:23], 0 offen offset:3072 sc1
v_add_u32 v10, 4096, v10
v_add_u32 v11, 4096, v11
Mvaa 248,216,12
Mvaa 156,220,0
Mvaa 188,220,4
Mvaa 220,220,8
Mvaa 252,220,12
s_waitcnt vmcnt(33) lgkmcnt(0)
s_barrier
Mvaa 128,224,16
v_accvgpr_write_b32 a0, 0
v_accvgpr_write_b32 a1, 0
Mvaa 160,224,20
Ta 192,16,16384
Ta 194,16,17408
Mvaa 192,224,24
v_accvgpr_write_b32 a2, 0
v_accvgpr_write_b32 a3, 0
Mvaa 224,224,28
v_accvgpr_write_b32 a4, 0
v_accvgpr_write_b32 a5, 0
Mvaa 132,228,16
Ta 196,17,16384
Ta 198,17,17408
Mvaa 164,228,20
v_accvgpr_write_b32 a6, 0
v_accvgpr_write_b32 a7, 0
Mvaa 196,228,24
v_accvgpr_write_b32 a8, 0
v_accvgpr_write_b32 a9, 0
Mvaa 228,228,28
Ta 200,18,16384
Ta 202,18,17408
Mvaa 136,232,16
v_accvgpr_write_b32 a10, 0
v_accvgpr_write_b32 a11, 0
Mvaa 168,232,20
v_accvgpr_write_b32 a12, 0
v_accvgpr_write_b32 a13, 0
Mvaa 200,232,24
Ta 204,19,16384
Ta 206,19,17408
Mvaa 232,232,28
v_accvgpr_write_b32 a14, 0
v_accvgpr_write_b32 a15, 0
Mvaa 140,236,16
Mvaa 172,236,20
Ta 208,20,16384
Ta 210,20,17408
Mvaa 204,236,24
Mvaa 236,236,28
Mvaa 144,240,16
s_waitcnt lgkmcnt(6)
Ta 212,21,16384
Ta 214,21,17408
Mvaa 176,240,20
Mvaa 208,240,24
Mvaa 240,240,28
Ta 216,22,16384
Ta 218,22,17408
Mvaa 148,244,16
Mvaa 180,244,20
Mvaa 212,244,24
Ta 220,23,16384
Ta 222,23,17408
Mvaa 244,244,28
Mvaa 152,248,16
Mvaa 184,248,20
Mvaa 216,248,24
Mvaa 248,248,28
Mvaa 156,252,16
Mvaa 188,252,20
Mvaa 220,252,24
Mvaa 252,252,28
s_waitcnt vmcnt(29) lgkmcnt(0)
Mvaa 128,192,32
v_accvgpr_write_b32 a16, 0
v_accvgpr_write_b32 a17, 0
Mvaa 160,192,36
Ta 224,16,24576
Ta 226,16,25600
Mvaa 192,192,40
v_accvgpr_write_b32 a18, 0
v_accvgpr_write_b32 a19, 0
Mvaa 224,192,44
v_accvgpr_write_b32 a20, 0
v_accvgpr_write_b32 a21, 0
Mvaa 132,196,32
Ta 228,17,24576
Ta 230,17,25600
Mvaa 164,196,36
v_accvgpr_write_b32 a22, 0
v_accvgpr_write_b32 a23, 0
Mvaa 196,196,40
v_accvgpr_write_b32 a24, 0
v_accvgpr_write_b32 a25, 0
Mvaa 228,196,44
Ta 232,18,24576
Ta 234,18,25600
Mvaa 136,200,32
v_accvgpr_write_b32 a26, 0
v_accvgpr_write_b32 a27, 0
Mvaa 168,200,36
v_accvgpr_write_b32 a28, 0
v_accvgpr_write_b32 a29, 0
Mvaa 200,200,40
Ta 236,19,24576
Ta 238,19,25600
Mvaa 232,200,44
v_accvgpr_write_b32 a30, 0
v_accvgpr_write_b32 a31, 0
Mvaa 140,204,32
Mvaa 172,204,36
Ta 240,20,24576
Ta 242,20,25600
Mvaa 204,204,40
Mvaa 236,204,44
Mvaa 144,208,32
s_waitcnt lgkmcnt(6)
Ta 244,21,24576
Ta 246,21,25600
Mvaa 176,208,36
buffer_load_dword v12, v1, s[20:23], s6 offen sc1
Mvaa 208,208,40
s_add_u32 m0, s44, 65536
s_mov_b32 s7, 0
Mvaa 240,208,44
Ta 248,22,24576
Ta 250,22,25600
Mvaa 148,212,32
Mvaa 180,212,36
Mvaa 212,212,40
Ta 252,23,24576
Ta 254,23,25600
Mvaa 244,212,44
Mvaa 152,216,32
Mvaa 184,216,36
Mvaa 216,216,40
Mvaa 248,216,44
Mvaa 156,220,32
Mvaa 188,220,36
Mvaa 220,220,40
Mvaa 252,220,44
s_waitcnt vmcnt(21) lgkmcnt(0)
s_barrier
Mvaa 128,224,48
v_accvgpr_write_b32 a32, 0
v_accvgpr_write_b32 a33, 0
Mvaa 160,224,52
Ta 192,16,32768
Ta 194,16,33792
Mvaa 192,224,56
v_accvgpr_write_b32 a34, 0
v_accvgpr_write_b32 a35, 0
Mvaa 224,224,60
v_accvgpr_write_b32 a36, 0
v_accvgpr_write_b32 a37, 0
Mvaa 132,228,48
Ta 196,17,32768
Ta 198,17,33792
Mvaa 164,228,52
v_accvgpr_write_b32 a38, 0
v_accvgpr_write_b32 a39, 0
Mvaa 196,228,56
v_accvgpr_write_b32 a40, 0
v_accvgpr_write_b32 a41, 0
Mvaa 228,228,60
Ta 200,18,32768
Ta 202,18,33792
Mvaa 136,232,48
v_accvgpr_write_b32 a42, 0
v_accvgpr_write_b32 a43, 0
Mvaa 168,232,52
v_accvgpr_write_b32 a44, 0
v_accvgpr_write_b32 a45, 0
Mvaa 200,232,56
Ta 204,19,32768
Ta 206,19,33792
Mvaa 232,232,60
v_accvgpr_write_b32 a46, 0
v_accvgpr_write_b32 a47, 0
Mvaa 140,236,48
Mvaa 172,236,52
Ta 208,20,32768
Ta 210,20,33792
Mvaa 204,236,56
Mvaa 236,236,60
Mvaa 144,240,48
s_waitcnt lgkmcnt(6)
Ta 212,21,32768
Ta 214,21,33792
Mvaa 176,240,52
Mvaa 208,240,56
Mvaa 240,240,60
Ta 216,22,32768
Ta 218,22,33792
Mvaa 148,244,48
Mvaa 180,244,52
Mvaa 212,244,56
Ta 220,23,32768
Ta 222,23,33792
Mvaa 244,244,60
Mvaa 152,248,48
Mvaa 184,248,52
Mvaa 216,248,56
Mvaa 248,248,60
Mvaa 156,252,48
Mvaa 188,252,52
Mvaa 220,252,56
Mvaa 252,252,60
s_waitcnt vmcnt(17) lgkmcnt(0)
Mvaa 128,192,64
v_accvgpr_write_b32 a48, 0
v_accvgpr_write_b32 a49, 0
Mvaa 160,192,68
Ta 224,16,40960
Ta 226,16,41984
Mvaa 192,192,72
v_accvgpr_write_b32 a50, 0
v_accvgpr_write_b32 a51, 0
Mvaa 224,192,76
v_accvgpr_write_b32 a52, 0
v_accvgpr_write_b32 a53, 0
Mvaa 132,196,64
Ta 228,17,40960
Ta 230,17,41984
Mvaa 164,196,68
v_accvgpr_write_b32 a54, 0
v_accvgpr_write_b32 a55, 0
Mvaa 196,196,72
v_accvgpr_write_b32 a56, 0
v_accvgpr_write_b32 a57, 0
Mvaa 228,196,76
Ta 232,18,40960
Ta 234,18,41984
Mvaa 136,200,64
v_accvgpr_write_b32 a58, 0
v_accvgpr_write_b32 a59, 0
Mvaa 168,200,68
v_accvgpr_write_b32 a60, 0
v_accvgpr_write_b32 a61, 0
Mvaa 200,200,72
Ta 236,19,40960
Ta 238,19,41984
Mvaa 232,200,76
v_accvgpr_write_b32 a62, 0
v_accvgpr_write_b32 a63, 0
Mvaa 140,204,64
Mvaa 172,204,68
Ta 240,20,40960
Ta 242,20,41984
Mvaa 204,204,72
Mvaa 236,204,76
Mvaa 144,208,64
s_waitcnt lgkmcnt(6)
Ta 244,21,40960
Ta 246,21,41984
Mvaa 176,208,68
Mvaa 208,208,72
Mvaa 240,208,76
Ta 248,22,40960
Ta 250,22,41984
Mvaa 148,212,64
Mvaa 180,212,68
Mvaa 212,212,72
Ta 252,23,40960
Ta 254,23,41984
Mvaa 244,212,76
Mvaa 152,216,64
Mvaa 184,216,68
Mvaa 216,216,72
Mvaa 248,216,76
Mvaa 156,220,64
Mvaa 188,220,68
Mvaa 220,220,72
Mvaa 252,220,76
s_waitcnt vmcnt(0) lgkmcnt(0)
s_cmp_lg_u32 s32, 0
s_cbranch_scc1 L_spinBr
v_cmp_ne_u32 vcc, 1, v12
s_cbranch_vccnz L_spinB
L_spinBr:
s_barrier
Mvaa 128,224,80
buffer_load_dwordx4 v4, s[12:15], s7 offen offset:0 sc1 lds
Mvaa 160,224,84
Ta 192,16,49152
Ta 194,16,50176
Mvaa 192,224,88
v_accvgpr_write_b32 a64, 0
v_accvgpr_write_b32 a65, 0
Mvaa 224,224,92
buffer_load_dwordx4 v4, s[12:15], s7 offen offset:1024 sc1 lds
Mvaa 132,228,80
Ta 196,17,49152
Ta 198,17,50176
Mvaa 164,228,84
v_accvgpr_write_b32 a66, 0
v_accvgpr_write_b32 a67, 0
Mvaa 196,228,88
buffer_load_dwordx4 v4, s[12:15], s7 offen offset:2048 sc1 lds
Mvaa 228,228,92
Ta 200,18,49152
Ta 202,18,50176
Mvaa 136,232,80
v_accvgpr_write_b32 a68, 0
v_accvgpr_write_b32 a69, 0
Mvaa 168,232,84
buffer_load_dwordx4 v4, s[12:15], s7 offen offset:3072 sc1 lds
Mvaa 200,232,88
Ta 204,19,49152
Ta 206,19,50176
Mvaa 232,232,92
s_add_u32 m0, s44, 98304
s_mov_b32 s7, 34816
Mvaa 140,236,80
buffer_load_dwordx4 v4, s[12:15], s7 offen offset:0 sc1 lds
Mvaa 172,236,84
Ta 208,20,49152
Ta 210,20,50176
Mvaa 204,236,88
v_accvgpr_write_b32 a70, 0
v_accvgpr_write_b32 a71, 0
Mvaa 236,236,92
buffer_load_dwordx4 v4, s[12:15], s7 offen offset:1024 sc1 lds
Mvaa 144,240,80
s_waitcnt lgkmcnt(6)
Ta 212,21,49152
Ta 214,21,50176
Mvaa 176,240,84
v_accvgpr_write_b32 a72, 0
v_accvgpr_write_b32 a73, 0
Mvaa 208,240,88
buffer_load_dwordx4 v4, s[12:15], s7 offen offset:2048 sc1 lds
Mvaa 240,240,92
Ta 216,22,49152
Ta 218,22,50176
Mvaa 148,244,80
v_accvgpr_write_b32 a74, 0
v_accvgpr_write_b32 a75, 0
Mvaa 180,244,84
buffer_load_dwordx4 v4, s[12:15], s7 offen offset:3072 sc1 lds
Mvaa 212,244,88
Ta 220,23,49152
Ta 222,23,50176
Mvaa 244,244,92
s_add_u32 m0, s44, 81920
s_mov_b32 s7, 17408
Mvaa 152,248,80
buffer_load_dwordx4 v4, s[12:15], s7 offen offset:0 sc1 lds
Mvaa 184,248,84
v_accvgpr_write_b32 a76, 0
v_accvgpr_write_b32 a77, 0
Mvaa 216,248,88
buffer_load_dwordx4 v4, s[12:15], s7 offen offset:1024 sc1 lds
Mvaa 248,248,92
v_accvgpr_write_b32 a78, 0
v_accvgpr_write_b32 a79, 0
Mvaa 156,252,80
Mvaa 188,252,84
buffer_load_dwordx4 v4, s[12:15], s7 offen offset:2048 sc1 lds
Mvaa 220,252,88
Mvaa 252,252,92
s_waitcnt lgkmcnt(0)
Mvaa 128,192,96
buffer_load_dwordx4 v4, s[12:15], s7 offen offset:3072 sc1 lds
Mvaa 160,192,100
Ta 224,16,57344
Ta 226,16,58368
Mvaa 192,192,104
s_add_u32 m0, s44, 114688
s_mov_b32 s7, 52224
Mvaa 224,192,108
buffer_load_dwordx4 v4, s[12:15], s7 offen offset:0 sc1 lds
Mvaa 132,196,96
Ta 228,17,57344
Ta 230,17,58368
Mvaa 164,196,100
v_accvgpr_write_b32 a80, 0
v_accvgpr_write_b32 a81, 0
Mvaa 196,196,104
buffer_load_dwordx4 v4, s[12:15], s7 offen offset:1024 sc1 lds
Mvaa 228,196,108
Ta 232,18,57344
Ta 234,18,58368
Mvaa 136,200,96
v_accvgpr_write_b32 a82, 0
v_accvgpr_write_b32 a83, 0
Mvaa 168,200,100
buffer_load_dwordx4 v4, s[12:15], s7 offen offset:2048 sc1 lds
Mvaa 200,200,104
Ta 236,19,57344
Ta 238,19,58368
Mvaa 232,200,108
v_accvgpr_write_b32 a84, 0
v_accvgpr_write_b32 a85, 0
Mvaa 140,204,96
buffer_load_dwordx4 v4, s[12:15], s7 offen offset:3072 sc1 lds
Mvaa 172,204,100
Ta 240,20,57344
Ta 242,20,58368
Mvaa 204,204,104
s_add_u32 m0, s44, 0
s_mov_b32 s7, 69632
Mvaa 236,204,108
buffer_load_dwordx4 v4, s[12:15], s7 offen offset:0 sc1 lds
Mvaa 144,208,96
s_waitcnt lgkmcnt(6)
Ta 244,21,57344
Ta 246,21,58368
Mvaa 176,208,100
buffer_load_dwordx4 v4, s[12:15], s7 offen offset:1024 sc1 lds
Mvaa 208,208,104
v_accvgpr_write_b32 a86, 0
v_accvgpr_write_b32 a87, 0
Mvaa 240,208,108
Ta 248,22,57344
Ta 250,22,58368
Mvaa 148,212,96
buffer_load_dwordx4 v4, s[12:15], s7 offen offset:2048 sc1 lds
Mvaa 180,212,100
v_accvgpr_write_b32 a88, 0
v_accvgpr_write_b32 a89, 0
Mvaa 212,212,104
Ta 252,23,57344
Ta 254,23,58368
Mvaa 244,212,108
buffer_load_dwordx4 v4, s[12:15], s7 offen offset:3072 sc1 lds
Mvaa 152,216,96
s_add_u32 m0, s44, 16384
s_mov_b32 s7, 87040
Mvaa 184,216,100
v_accvgpr_write_b32 a90, 0
v_accvgpr_write_b32 a91, 0
Mvaa 216,216,104
buffer_load_dwordx4 v4, s[12:15], s7 offen offset:0 sc1 lds
Mvaa 248,216,108
v_accvgpr_write_b32 a92, 0
v_accvgpr_write_b32 a93, 0
Mvaa 156,220,96
v_accvgpr_write_b32 a94, 0
v_accvgpr_write_b32 a95, 0
Mvaa 188,220,100
buffer_load_dwordx4 v4, s[12:15], s7 offen offset:1024 sc1 lds
Mvaa 220,220,104
Mvaa 252,220,108
s_waitcnt vmcnt(18) lgkmcnt(0)
s_barrier
Mvaa 128,224,112
buffer_load_dwordx4 v4, s[12:15], s7 offen offset:2048 sc1 lds
Mvaa 132,228,112
Ra 192,3,0
Ra 196,3,1024
Mvaa 136,232,112
Ra 200,3,2048
Ra 204,3,3072
Mvaa 140,236,112
buffer_load_dwordx4 v4, s[12:15], s7 offen offset:3072 sc1 lds
Mvaa 144,240,112
s_add_u32 m0, s44, 32768
s_mov_b32 s7, 104448
Mvaa 148,244,112
Ra 208,3,4096
Ra 212,3,5120
Mvaa 152,248,112
buffer_load_dwordx4 v4, s[12:15], s7 offen offset:0 sc1 lds
Mvaa 156,252,112
Ra 216,3,6144
Ra 220,3,7168
Mvaa 160,224,116
buffer_load_dwordx4 v4, s[12:15], s7 offen offset:1024 sc1 lds
Mvaa 164,228,116
Mvaa 168,232,116
Mvaa 172,236,116
buffer_load_dwordx4 v4, s[12:15], s7 offen offset:2048 sc1 lds
Mvaa 176,240,116
v_mul_f32 v128, s94, v128
v_mul_f32_e64 v129, s94, v129
Mvaa 180,244,116
v_mul_f32 v130, s94, v130
v_mul_f32 v131, s94, v131
Mvaa 184,248,116
buffer_load_dwordx4 v4, s[12:15], s7 offen offset:3072 sc1 lds
Mvaa 188,252,116
v_mul_f32 v132, s94, v132
v_mul_f32 v133, s94, v133
Mvaa 192,224,120
v_mul_f32 v134, s94, v134
v_mul_f32 v135, s94, v135
Mvaa 196,228,120
Vc 128,128,129
Vc 129,130,131
Mvaa 200,232,120
Vc 130,132,133
Vc 131,134,135
Mvaa 204,236,120
Aw 128,128
Aw 129,129
Mvaa 208,240,120
Aw 130,130
Aw 131,131
Mvaa 212,244,120
v_mul_f32 v136, s94, v136
v_mul_f32 v137, s94, v137
Mvaa 216,248,120
v_mul_f32 v138, s94, v138
v_mul_f32 v139, s94, v139
Mvaa 220,252,120
v_mul_f32 v140, s94, v140
v_mul_f32 v141, s94, v141
Mvaa 224,224,124
v_mul_f32 v142, s94, v142
v_mul_f32 v143, s94, v143
Mvaa 228,228,124
Vc 136,136,137
Vc 137,138,139
Mvaa 232,232,124
Vc 138,140,141
Vc 139,142,143
Mvaa 236,236,124
Aw 132,136
Aw 133,137
Mvaa 240,240,124
Aw 134,138
Aw 135,139
Mvaa 244,244,124
v_mul_f32 v144, s94, v144
v_mul_f32 v145, s94, v145
Mvaa 248,248,124
v_mul_f32 v146, s94, v146
v_mul_f32 v147, s94, v147
Mvaa 252,252,124
v_mul_f32 v148, s94, v148
v_mul_f32 v149, s94, v149
Ra 224,3,8192
Ra 228,3,9216
Ra 232,3,10240
Ra 236,3,11264
Ra 240,3,12288
Ra 244,3,13312
Ra 248,3,14336
s_waitcnt lgkmcnt(9)
Ra 252,3,15360
v_mul_f32 v150, s94, v150
v_mul_f32_e64 v151, s94, v151
Vc 144,144,145
Vc 145,146,147
Vc 146,148,149
Vc 147,150,151
Aw 136,144
Aw 137,145
Aw 138,146
Aw 139,147
v_mul_f32 v152, s94, v152
v_mul_f32 v153, s94, v153
v_mul_f32 v154, s94, v154
v_mul_f32 v155, s94, v155
v_mul_f32 v156, s94, v156
v_mul_f32 v157, s94, v157
v_mul_f32 v158, s94, v158
v_mul_f32 v159, s94, v159
Vc 152,152,153
Vc 153,154,155
Vc 154,156,157
Vc 155,158,159
Aw 140,152
Aw 141,153
Aw 142,154
Aw 143,155
Zvaa 128,192,128
v_mul_f32 v160, s94, v160
v_mul_f32 v161, s94, v161
v_mul_f32 v162, s94, v162
v_mul_f32 v163, s94, v163
Mvaa 128,196,132
v_mul_f32 v164, s94, v164
v_mul_f32 v165, s94, v165
v_mul_f32 v166, s94, v166
v_mul_f32 v167, s94, v167
Mvaa 128,200,136
Vc 160,160,161
Vc 161,162,163
Vc 162,164,165
Vc 163,166,167
Mvaa 128,204,140
Aw 144,160
Aw 145,161
Aw 146,162
Aw 147,163
s_waitcnt lgkmcnt(8)
Zvaa 132,208,128
v_mul_f32 v168, s94, v168
v_mul_f32 v169, s94, v169
v_mul_f32 v170, s94, v170
v_mul_f32_e64 v171, s94, v171
Mvaa 132,212,132
v_mul_f32 v172, s94, v172
v_mul_f32 v173, s94, v173
v_mul_f32 v174, s94, v174
v_mul_f32 v175, s94, v175
Mvaa 132,216,136
Vc 168,168,169
Vc 169,170,171
Vc 170,172,173
Vc 171,174,175
Mvaa 132,220,140
Aw 148,168
Aw 149,169
Aw 150,170
Aw 151,171
s_waitcnt lgkmcnt(4)
Zvaa 136,224,128
v_mul_f32 v176, s94, v176
v_mul_f32 v177, s94, v177
v_mul_f32 v178, s94, v178
v_mul_f32_e64 v179, s94, v179
Mvaa 136,228,132
v_mul_f32 v180, s94, v180
v_mul_f32 v181, s94, v181
v_mul_f32 v182, s94, v182
v_mul_f32 v183, s94, v183
Mvaa 136,232,136
Vc 176,176,177
Vc 177,178,179
Vc 178,180,181
Vc 179,182,183
Mvaa 136,236,140
Aw 152,176
Aw 153,177
Aw 154,178
Aw 155,179
s_waitcnt lgkmcnt(0)
Zvaa 140,240,128
v_mul_f32 v184, s94, v184
v_mul_f32 v185, s94, v185
v_mul_f32 v186, s94, v186
v_mul_f32_e64 v187, s94, v187
Mvaa 140,244,132
v_mul_f32 v188, s94, v188
v_mul_f32 v189, s94, v189
v_mul_f32 v190, s94, v190
v_mul_f32 v191, s94, v191
Mvaa 140,248,136
Vc 184,184,185
Vc 185,186,187
Vc 186,188,189
Vc 187,190,191
Mvaa 140,252,140
Aw 156,184
Aw 157,185
Aw 158,186
Aw 159,187
Zvaa 144,192,144
v_mul_f32 v192, s94, v192
v_mul_f32 v193, s94, v193
v_mul_f32 v194, s94, v194
v_mul_f32 v195, s94, v195
Mvaa 144,196,148
v_mul_f32 v196, s94, v196
v_mul_f32 v197, s94, v197
v_mul_f32 v198, s94, v198
v_mul_f32 v199, s94, v199
Mvaa 144,200,152
Vc 192,192,193
Vc 193,194,195
Vc 194,196,197
Vc 195,198,199
Mvaa 144,204,156
Aw 160,192
Aw 161,193
Aw 162,194
Aw 163,195
Zvaa 148,208,144
v_mul_f32 v200, s94, v200
v_mul_f32 v201, s94, v201
v_mul_f32 v202, s94, v202
v_mul_f32 v203, s94, v203
Mvaa 148,212,148
v_mul_f32 v204, s94, v204
v_mul_f32 v205, s94, v205
v_mul_f32 v206, s94, v206
v_mul_f32 v207, s94, v207
Mvaa 148,216,152
Vc 200,200,201
Vc 201,202,203
Vc 202,204,205
Vc 203,206,207
Mvaa 148,220,156
Aw 164,200
Aw 165,201
Aw 166,202
Aw 167,203
Zvaa 152,224,144
v_mul_f32 v208, s94, v208
v_mul_f32 v209, s94, v209
v_mul_f32 v210, s94, v210
v_mul_f32 v211, s94, v211
Mvaa 152,228,148
v_mul_f32 v212, s94, v212
v_mul_f32 v213, s94, v213
v_mul_f32 v214, s94, v214
v_mul_f32 v215, s94, v215
Mvaa 152,232,152
Vc 208,208,209
Vc 209,210,211
Vc 210,212,213
Vc 211,214,215
Mvaa 152,236,156
Aw 168,208
Aw 169,209
Aw 170,210
Aw 171,211
Zvaa 156,240,144
v_mul_f32 v216, s94, v216
v_mul_f32 v217, s94, v217
v_mul_f32 v218, s94, v218
v_mul_f32 v219, s94, v219
Mvaa 156,244,148
v_mul_f32 v220, s94, v220
v_mul_f32 v221, s94, v221
v_mul_f32 v222, s94, v222
v_mul_f32 v223, s94, v223
Mvaa 156,248,152
Vc 216,216,217
Vc 217,218,219
Vc 218,220,221
Vc 219,222,223
Mvaa 156,252,156
Aw 172,216
Aw 173,217
Aw 174,218
Aw 175,219
Zvaa 160,192,160
v_mul_f32 v224, s94, v224
v_mul_f32 v225, s94, v225
v_mul_f32 v226, s94, v226
v_mul_f32 v227, s94, v227
Mvaa 160,196,164
v_mul_f32 v228, s94, v228
v_mul_f32 v229, s94, v229
v_mul_f32 v230, s94, v230
v_mul_f32 v231, s94, v231
Mvaa 160,200,168
Vc 224,224,225
Vc 225,226,227
Vc 226,228,229
Vc 227,230,231
Mvaa 160,204,172
Aw 176,224
Aw 177,225
Aw 178,226
Aw 179,227
Zvaa 164,208,160
v_mul_f32 v232, s94, v232
v_mul_f32 v233, s94, v233
v_mul_f32 v234, s94, v234
v_mul_f32 v235, s94, v235
Mvaa 164,212,164
v_mul_f32 v236, s94, v236
v_mul_f32 v237, s94, v237
v_mul_f32 v238, s94, v238
v_mul_f32 v239, s94, v239
Mvaa 164,216,168
Vc 232,232,233
Vc 233,234,235
Vc 234,236,237
Vc 235,238,239
Mvaa 164,220,172
Aw 180,232
Aw 181,233
Aw 182,234
Aw 183,235
Zvaa 168,224,160
v_mul_f32 v240, s94, v240
v_mul_f32 v241, s94, v241
v_mul_f32 v242, s94, v242
v_mul_f32 v243, s94, v243
Mvaa 168,228,164
v_mul_f32 v244, s94, v244
v_mul_f32 v245, s94, v245
v_mul_f32 v246, s94, v246
v_mul_f32 v247, s94, v247
Mvaa 168,232,168
Vc 240,240,241
Vc 241,242,243
Vc 242,244,245
Vc 243,246,247
Mvaa 168,236,172
Aw 184,240
Aw 185,241
Aw 186,242
Aw 187,243
Zvaa 172,240,160
v_mul_f32 v248, s94, v248
v_mul_f32 v249, s94, v249
v_mul_f32 v250, s94, v250
v_mul_f32 v251, s94, v251
Mvaa 172,244,164
v_mul_f32 v252, s94, v252
v_mul_f32 v253, s94, v253
v_mul_f32 v254, s94, v254
v_mul_f32 v255, s94, v255
Mvaa 172,248,168
Vc 248,248,249
Vc 249,250,251
Vc 250,252,253
Vc 251,254,255
Mvaa 172,252,172
Aw 188,248
Aw 189,249
Aw 190,250
Aw 191,251
Zvaa 176,192,176
v_accvgpr_write_b32 a96, 0
v_accvgpr_write_b32 a97, 0
v_accvgpr_write_b32 a98, 0
v_accvgpr_write_b32 a99, 0
Mvaa 176,196,180
v_accvgpr_write_b32 a100, 0
v_accvgpr_write_b32 a101, 0
v_accvgpr_write_b32 a102, 0
v_accvgpr_write_b32 a103, 0
Mvaa 176,200,184
v_accvgpr_write_b32 a104, 0
v_accvgpr_write_b32 a105, 0
v_accvgpr_write_b32 a106, 0
v_accvgpr_write_b32 a107, 0
Mvaa 176,204,188
v_accvgpr_write_b32 a108, 0
v_accvgpr_write_b32 a109, 0
v_accvgpr_write_b32 a110, 0
v_accvgpr_write_b32 a111, 0
Zvaa 180,208,176
v_accvgpr_write_b32 a112, 0
v_accvgpr_write_b32 a113, 0
v_accvgpr_write_b32 a114, 0
v_accvgpr_write_b32 a115, 0
Mvaa 180,212,180
v_accvgpr_write_b32 a116, 0
v_accvgpr_write_b32 a117, 0
v_accvgpr_write_b32 a118, 0
v_accvgpr_write_b32 a119, 0
Mvaa 180,216,184
v_accvgpr_write_b32 a120, 0
v_accvgpr_write_b32 a121, 0
v_accvgpr_write_b32 a122, 0
v_accvgpr_write_b32 a123, 0
Mvaa 180,220,188
v_accvgpr_write_b32 a124, 0
v_accvgpr_write_b32 a125, 0
v_accvgpr_write_b32 a126, 0
v_accvgpr_write_b32 a127, 0
s_waitcnt vmcnt(16)
s_barrier
s_add_u32 s53, s44, 65536
Zvaa 184,224,176
Ra 192,3,32768
v_mov_b32 v16, 0x3f803f80
v_mov_b32 v17, 0x3f803f80
v_mov_b32 v18, 0x3f803f80
v_mov_b32 v19, 0x3f803f80
Mvaa 184,228,180
Ra 196,3,33792
v_mov_b32 v20, 0xff800000
v_max3_f32 v22, v128, v129, v130
v_max3_f32 v22, v22, v131, v132
v_max3_f32 v22, v22, v133, v134
Mvaa 184,232,184
Ra 200,3,34816
v_max3_f32 v22, v22, v135, v136
v_max3_f32 v22, v22, v137, v138
v_max3_f32 v22, v22, v139, v140
v_max3_f32 v22, v22, v141, v142
Mvaa 184,236,188
Ra 204,3,35840
v_max_f32 v22, v22, v143
v_mov_b32 v1, v22
s_nop 1
v_permlane16_swap_b32 v1, v22
v_max_f32_e64 v22, v22, v1
Zvaa 188,240,176
Ra 208,3,36864
v_mov_b32 v1, v22
s_nop 1
v_permlane32_swap_b32 v1, v22
v_max_f32 v22, v22, v1
v_add_f32 v22, 0x41f80000, v22
Mvaa 188,244,180
Ra 212,3,37888
Vs 128,128,22
Vs 129,129,22
Vs 130,130,22
Vs 131,131,22
Mvaa 188,248,184
Ra 216,3,38912
Vs 132,132,22
Vs 133,133,22
Vs 134,134,22
Vs 135,135,22
Mvaa 188,252,188
Ra 220,3,39936
Vs 136,136,22
Vs 137,137,22
Vs 138,138,22
Vs 139,139,22
Vs 140,140,22
Vs 141,141,22
Vs 142,142,22
Vs 143,143,22
v_sub_f32 v32, 0, v22
v_sub_f32 v33, 0, v22
v_sub_f32 v34, 0, v22
v_sub_f32 v35, 0, v22
v_max3_f32 v22, v144, v145, v146
v_max3_f32 v22, v22, v147, v148
v_max3_f32 v22, v22, v149, v150
v_max3_f32 v22, v22, v151, v152
v_max3_f32 v22, v22, v153, v154
v_max3_f32 v22, v22, v155, v156
v_max3_f32 v22, v22, v157, v158
v_max_f32 v22, v22, v159
v_mov_b32 v1, v22
s_nop 1
v_permlane16_swap_b32 v1, v22
v_max_f32 v22, v22, v1
v_mov_b32 v1, v22
s_nop 1
v_permlane32_swap_b32 v1, v22
v_max_f32_e64 v22, v22, v1
v_add_f32 v22, 0x41f80000, v22
Vs 144,144,22
Vs 145,145,22
Vs 146,146,22
Vs 147,147,22
Vs 148,148,22
Vs 149,149,22
Vs 150,150,22
Vs 151,151,22
Vs 152,152,22
Vs 153,153,22
Vs 154,154,22
Vs 155,155,22
Vs 156,156,22
Vs 157,157,22
Vs 158,158,22
Vs 159,159,22
v_sub_f32 v36, 0, v22
v_sub_f32 v37, 0, v22
v_sub_f32 v38, 0, v22
v_sub_f32 v39, 0, v22
s_mov_b32 s38, 139264
s_mov_b32 s39, 121856
s_cmp_lg_u32 s34, 0
s_cbranch_scc1 L_k2_nomask0
v_cmp_gt_i32 s[56:57], 0, v5
v_cmp_gt_i32 s[58:59], 1, v5
v_cmp_gt_i32 s[60:61], 2, v5
v_cmp_gt_i32 s[62:63], 3, v5
s_nop 3
s_nop 0
v_cndmask_b32 v176, v176, v20, s[56:57]
v_cndmask_b32 v177, v177, v20, s[58:59]
v_cndmask_b32 v178, v178, v20, s[60:61]
v_cndmask_b32 v179, v179, v20, s[62:63]
v_cmp_gt_i32 s[56:57], 16, v5
v_cmp_gt_i32 s[58:59], 17, v5
v_cmp_gt_i32 s[60:61], 18, v5
v_cmp_gt_i32 s[62:63], 19, v5
v_cndmask_b32 v180, v180, v20, s[56:57]
v_cndmask_b32 v181, v181, v20, s[58:59]
v_cndmask_b32 v182, v182, v20, s[60:61]
v_cndmask_b32 v183, v183, v20, s[62:63]
v_cmp_gt_i32 s[56:57], 32, v5
v_cmp_gt_i32 s[58:59], 33, v5
v_cmp_gt_i32 s[60:61], 34, v5
v_cmp_gt_i32 s[62:63], 35, v5
v_cndmask_b32 v184, v184, v20, s[56:57]
v_cndmask_b32 v185, v185, v20, s[58:59]
v_cndmask_b32 v186, v186, v20, s[60:61]
v_cndmask_b32 v187, v187, v20, s[62:63]
v_cmp_gt_i32 s[56:57], 48, v5
v_cmp_gt_i32 s[58:59], 49, v5
v_cmp_gt_i32 s[60:61], 50, v5
v_cmp_gt_i32 s[62:63], 51, v5
v_cndmask_b32 v188, v188, v20, s[56:57]
v_cndmask_b32 v189, v189, v20, s[58:59]
v_cndmask_b32 v190, v190, v20, s[60:61]
v_cndmask_b32 v191, v191, v20, s[62:63]
L_k2_nomask0:
s_mov_b32 s37, 0
s_nop 0
v_max3_f32 v22, v160, v161, v162
v_max3_f32 v22, v22, v163, v164
v_max3_f32 v22, v22, v165, v166
v_max3_f32 v22, v22, v167, v168
v_max3_f32 v22, v22, v169, v170
v_max3_f32 v22, v22, v171, v172
v_max3_f32 v22, v22, v173, v174
v_max_f32 v22, v22, v175
v_mov_b32 v1, v22
s_nop 1
v_permlane16_swap_b32 v1, v22
v_max_f32 v22, v22, v1
v_mov_b32 v1, v22
s_nop 1
v_permlane32_swap_b32 v1, v22
v_max_f32_e64 v22, v22, v1
v_add_f32 v22, 0x41f80000, v22
Vs 160,160,22
Vs 161,161,22
Vs 162,162,22
Vs 163,163,22
Vs 164,164,22
Vs 165,165,22
Vs 166,166,22
Vs 167,167,22
Vs 168,168,22
Vs 169,169,22
Vs 170,170,22
Vs 171,171,22
Vs 172,172,22
Vs 173,173,22
Vs 174,174,22
Vs 175,175,22
v_sub_f32 v40, 0, v22
v_sub_f32 v41, 0, v22
v_sub_f32 v42, 0, v22
v_sub_f32 v43, 0, v22
v_max3_f32 v22, v176, v177, v178
v_max3_f32 v22, v22, v179, v180
v_max3_f32 v22, v22, v181, v182
v_max3_f32 v22, v22, v183, v184
v_max3_f32 v22, v22, v185, v186
v_max3_f32 v22, v22, v187, v188
v_max3_f32 v22, v22, v189, v190
v_max_f32 v22, v22, v191
v_mov_b32 v1, v22
s_nop 1
v_permlane16_swap_b32 v1, v22
v_max_f32 v22, v22, v1
v_mov_b32 v1, v22
s_nop 1
v_permlane32_swap_b32 v1, v22
v_max_f32_e64 v22, v22, v1
v_add_f32 v22, 0x41f80000, v22
Vs 176,176,22
Vs 177,177,22
Vs 178,178,22
Vs 179,179,22
Vs 180,180,22
Vs 181,181,22
Vs 182,182,22
Vs 183,183,22
Vs 184,184,22
Vs 185,185,22
Vs 186,186,22
Vs 187,187,22
Vs 188,188,22
Vs 189,189,22
Vs 190,190,22
Vs 191,191,22
v_sub_f32 v44, 0, v22
v_sub_f32 v45, 0, v22
v_sub_f32 v46, 0, v22
v_sub_f32 v47, 0, v22
Ve 8,128
Ve 9,129
Ve 10,130
Ve 11,131
Vc 64,8,9
Ve 12,144
Ve 13,145
Vc 65,10,11
Ve 14,146
Ve 15,147
Vc 72,12,13
Ve 8,160
Ve 9,161
Vc 73,14,15
Ve 10,162
Ve 11,163
Vc 80,8,9
Ve 12,176
Ve 13,177
Vc 81,10,11
Ve 14,178
Ve 15,179
Vc 88,12,13
Ve 8,132
Ve 9,133
Vc 89,14,15
Ve 10,134
Ve 11,135
Vc 66,8,9
Ve 12,148
Ve 13,149
Vc 67,10,11
Ve 14,150
Ve 15,151
Vc 74,12,13
Ve 8,164
Ve 9,165
Vc 75,14,15
Ve 10,166
Ve 11,167
Vc 82,8,9
Ve 12,180
Ve 13,181
Vc 83,10,11
Ve 14,182
Ve 15,183
Vc 90,12,13
Vc 91,14,15
v_or_b32_e64 v7, v64, v65
v_or3_b32 v7, v7, v72, v73
v_or3_b32 v7, v7, v80, v81
v_or3_b32 v7, v7, v88, v89
v_or3_b32 v7, v7, v66, v67
v_or3_b32 v7, v7, v74, v75
v_or3_b32 v7, v7, v82, v83
v_or3_b32 v7, v7, v90, v91
s_waitcnt lgkmcnt(4)
s_cmp_eq_u32 s34, 0
s_cbranch_scc1 L_k2_wlast
L_k2_wloop:
v_xor_b32 v2, 65536, v2
v_xor_b32 v3, 65536, v3
Cvaa 192,192,128,32
s_mov_b32 m0, s53
Ra 224,2,40960
v_lshl_add_u64 v[28:29], s[40:41], 0, v[28:29]
Mvaa 192,196,132
buffer_load_dwordx4 v4, s[12:15], s38 offen offset:0 sc1 lds
Mvaa 192,200,136
VE 8,136
Mvaa 192,204,140
VE 9,137
Cvaa 208,192,144,36
Ra 228,2,41984
Vc 68,8,9
Mvaa 208,196,148
VE 10,138
Mvaa 208,200,152
VE 11,139
Mvaa 208,204,156
Ra 232,2,43008
Vc 69,10,11
Cvaa 224,192,160,40
Ra 236,2,44032
v_or3_b32 v7, v7, v68, v69
Mvaa 224,196,164
VE 12,152
Mvaa 224,200,168
VE 13,153
Mvaa 224,204,172
Ra 240,2,45056
Vc 76,12,13
Cvaa 240,192,176,44
VE 14,154
Mvaa 240,196,180
VE 15,155
Mvaa 240,200,184
Ra 244,2,46080
Vc 77,14,15
Mvaa 240,204,188
s_waitcnt lgkmcnt(6)
Ra 248,2,47104
v_or3_b32 v7, v7, v76, v77
Cvaa 196,208,128,32
buffer_load_dwordx4 v4, s[12:15], s38 offen offset:1024 sc1 lds
Mvaa 196,212,132
Ve 8,168
Mvaa 196,216,136
VE 9,169
Mvaa 196,220,140
Ra 252,2,48128
Vc 84,8,9
Cvaa 212,208,144,36
VE 10,170
Mvaa 212,212,148
VE 11,171
Mvaa 212,216,152
Ra 192,2,16384
Vc 85,10,11
Mvaa 212,220,156
Ra 196,2,17408
v_or3_b32 v7, v7, v84, v85
Cvaa 228,208,160,40
VE 12,184
Mvaa 228,212,164
VE 13,185
Mvaa 228,216,168
Ra 200,2,18432
Vc 92,12,13
Mvaa 228,220,172
VE 14,186
Cvaa 244,208,176,44
VE 15,187
Mvaa 244,212,180
buffer_load_dwordx4 v4, s[12:15], s38 offen offset:2048 sc1 lds
Mvaa 244,216,184
Ra 204,2,19456
Vc 93,14,15
Mvaa 244,220,188
s_waitcnt lgkmcnt(8)
Ve 8,140
Cvaa 200,224,128,32
Ra 208,2,20480
v_or3_b32 v7, v7, v92, v93
Mvaa 200,228,132
VE 9,141
Mvaa 200,232,136
Ra 212,2,21504
Vc 70,8,9
Mvaa 200,236,140
VE 10,142
Cvaa 216,224,144,36
VE 11,143
Mvaa 216,228,148
Ra 216,2,22528
Vc 71,10,11
Mvaa 216,232,152
Ra 220,2,23552
v_or3_b32 v7, v7, v70, v71
Mvaa 216,236,156
VE 12,156
Cvaa 232,224,160,40
VE 13,157
Mvaa 232,228,164
VE 14,158
Mvaa 232,232,168
VE 15,159
Mvaa 232,236,172
buffer_load_dwordx4 v4, s[12:15], s38 offen offset:3072 sc1 lds
Cvaa 248,224,176,44
VE 8,172
Mvaa 248,228,180
VE 9,173
Mvaa 248,232,184
Vc 78,12,13
Vc 79,14,15
Mvaa 248,236,188
s_waitcnt lgkmcnt(8)
Ve 10,174
Cvaa 204,240,128,32
VE 11,175
Mvaa 204,244,132
Vc 86,8,9
Vc 87,10,11
Mvaa 204,248,136
VE 12,188
Mvaa 204,252,140
VE 13,189
Cvaa 220,240,144,36
Vc 94,12,13
v_or3_b32 v7, v7, v78, v79
Mvaa 220,244,148
VE 14,190
Mvaa 220,248,152
VE 15,191
Mvaa 220,252,156
Vc 95,14,15
v_or3_b32 v7, v7, v86, v87
Cvaa 236,240,160,40
v_or3_b32 v7, v7, v94, v95
v_and_b32 v1, 0x40004000, v7
Mvaa 236,244,164
v_cmp_ne_u32 vcc, 0, v1
Mvaa 236,248,168
Mvaa 236,252,172
s_waitcnt vmcnt(12)
Cvaa 252,240,176,44
Mvaa 252,244,180
s_barrier
Mvaa 252,248,184
s_waitcnt lgkmcnt(4)
Mvaa 252,252,188
s_cbranch_vccnz L_k2_fb_we
L_k2_fbr_we:
Maav 0,192,64
Ve 8,192
Maav 0,196,68
s_add_u32 m0, s54, 49152
VE 9,193
Maav 32,192,72
buffer_load_dwordx4 v4, s[12:15], s39 offen offset:0 sc1 lds
Maav 32,196,76
s_add_u32 s37, s37, 1
Ra 224,2,24576
Vc 96,8,9
Maav 64,192,80
s_add_u32 s38, s38, 34816
Ve 10,194
Maav 64,196,84
VE 11,195
Maav 96,192,88
Ra 228,2,25600
Vc 97,10,11
Maav 96,196,92
Ra 232,2,26624
v_or_b32_e64 v7, v96, v97
Maav 4,200,64
VE 12,208
Maav 4,204,68
VE 13,209
Maav 36,200,72
Ra 236,2,27648
Vc 104,12,13
Maav 36,204,76
VE 14,210
Maav 68,200,80
VE 15,211
Maav 68,204,84
Ra 240,2,28672
Vc 105,14,15
Maav 100,200,88
Ra 244,2,29696
v_or3_b32 v7, v7, v104, v105
Maav 100,204,92
buffer_load_dwordx4 v4, s[12:15], s39 offen offset:1024 sc1 lds
Mvvv 48,16,64
VE 8,224
Mvvv 48,16,68
s_waitcnt lgkmcnt(6)
Ve 9,225
Maav 8,208,64
Ra 248,2,30720
Vc 112,8,9
Maav 8,212,68
VE 10,226
Maav 40,208,72
VE 11,227
Maav 40,212,76
Ra 252,2,31744
Vc 113,10,11
Maav 72,208,80
Ra 192,3,0
v_or3_b32 v7, v7, v112, v113
Maav 72,212,84
VE 12,240
Maav 104,208,88
VE 13,241
Maav 104,212,92
Ra 196,3,1024
Vc 120,12,13
Maav 12,216,64
VE 14,242
Maav 12,220,68
VE 15,243
Maav 44,216,72
Ra 200,3,2048
Vc 121,14,15
Maav 44,220,76
buffer_load_dwordx4 v4, s[12:15], s39 offen offset:2048 sc1 lds
Maav 76,216,80
Ra 204,3,3072
v_or3_b32 v7, v7, v120, v121
Maav 76,220,84
VE 8,196
Maav 108,216,88
VE 9,197
Maav 108,220,92
VE 10,198
Mvvv 52,16,72
VE 11,199
Mvvv 52,16,76
s_waitcnt lgkmcnt(8)
Ve 12,212
Maav 16,224,64
Ra 208,3,4096
Vc 98,8,9
Maav 16,228,68
Ra 212,3,5120
Vc 99,10,11
Maav 48,224,72
Ra 216,3,6144
v_or3_b32 v7, v7, v98, v99
Maav 48,228,76
VE 13,213
Maav 80,224,80
Ra 220,3,7168
Vc 106,12,13
Maav 80,228,84
VE 14,214
Maav 112,224,88
buffer_load_dwordx4 v4, s[12:15], s39 offen offset:3072 sc1 lds
Maav 112,228,92
s_add_u32 s39, s39, 34816
VE 15,215
Maav 20,232,64
VE 8,228
Maav 20,236,68
VE 9,229
Maav 52,232,72
VE 10,230
Maav 52,236,76
VE 11,231
Maav 84,232,80
Vc 107,14,15
Vc 114,8,9
Maav 84,236,84
VE 12,244
Maav 116,232,88
VE 13,245
Maav 116,236,92
Vc 115,10,11
Vc 122,12,13
Mvvv 56,16,80
VE 14,246
Mvvv 56,16,84
s_waitcnt lgkmcnt(8)
Ve 15,247
Maav 24,240,64
Vc 123,14,15
v_or3_b32 v7, v7, v106, v107
Maav 24,244,68
v_or3_b32 v7, v7, v114, v115
v_or3_b32 v7, v7, v122, v123
Maav 56,240,72
global_load_dword v30, v[28:29], off
Maav 56,244,76
Maav 88,240,80
Maav 88,244,84
Maav 120,240,88
Maav 120,244,92
Maav 28,248,64
Maav 28,252,68
Maav 60,248,72
Maav 60,252,76
Maav 92,248,80
Maav 92,252,84
Maav 124,248,88
Maav 124,252,92
Mvvv 60,16,88
s_waitcnt lgkmcnt(4)
Mvvv 60,16,92
Ve 8,200
Cvaa 128,192,128,32
s_add_u32 m0, s53, 32768
Ra 224,3,8192
v_lshl_add_u64 v[28:29], s[40:41], 0, v[28:29]
Mvaa 128,196,132
buffer_load_dwordx4 v4, s[12:15], s38 offen offset:0 sc1 lds
Mvaa 128,200,136
VE 9,201
Mvaa 128,204,140
Ra 228,3,9216
Vc 100,8,9
Cvaa 144,192,144,36
VE 10,202
Mvaa 144,196,148
VE 11,203
Mvaa 144,200,152
Ra 232,3,10240
Vc 101,10,11
Mvaa 144,204,156
Ra 236,3,11264
v_or3_b32 v7, v7, v100, v101
Cvaa 160,192,160,40
VE 12,216
Mvaa 160,196,164
VE 13,217
Mvaa 160,200,168
Ra 240,3,12288
Vc 108,12,13
Mvaa 160,204,172
VE 14,218
Cvaa 176,192,176,44
VE 15,219
Mvaa 176,196,180
Ra 244,3,13312
Vc 109,14,15
Mvaa 176,200,184
Ra 248,3,14336
v_or3_b32 v7, v7, v108, v109
Mvaa 176,204,188
s_waitcnt lgkmcnt(7)
Ve 8,232
Cvaa 132,208,128,32
buffer_load_dwordx4 v4, s[12:15], s38 offen offset:1024 sc1 lds
Mvaa 132,212,132
VE 9,233
Mvaa 132,216,136
Ra 252,3,15360
Vc 116,8,9
Mvaa 132,220,140
VE 10,234
Cvaa 148,208,144,36
VE 11,235
Mvaa 148,212,148
Ra 192,2,49152
Vc 117,10,11
Mvaa 148,216,152
Ra 196,2,50176
v_or3_b32 v7, v7, v116, v117
Mvaa 148,220,156
VE 12,248
Cvaa 164,208,160,40
VE 13,249
Mvaa 164,212,164
Ra 200,2,51200
Vc 124,12,13
Mvaa 164,216,168
VE 14,250
Mvaa 164,220,172
VE 15,251
Cvaa 180,208,176,44
Ra 204,2,52224
Vc 125,14,15
Mvaa 180,212,180
buffer_load_dwordx4 v4, s[12:15], s38 offen offset:2048 sc1 lds
Mvaa 180,216,184
VE 8,204
Mvaa 180,220,188
s_waitcnt lgkmcnt(8)
Ve 9,205
Cvaa 136,224,128,32
Ra 208,2,53248
Vc 102,8,9
Mvaa 136,228,132
Ra 212,2,54272
v_or3_b32 v7, v7, v124, v125
Mvaa 136,232,136
VE 10,206
Mvaa 136,236,140
VE 11,207
Cvaa 152,224,144,36
Ra 216,2,55296
Vc 103,10,11
Mvaa 152,228,148
Ra 220,2,56320
v_or3_b32 v7, v7, v102, v103
Mvaa 152,232,152
VE 12,220
Mvaa 152,236,156
VE 13,221
Cvaa 168,224,160,40
VE 14,222
Mvaa 168,228,164
VE 15,223
Mvaa 168,232,168
VE 8,236
Mvaa 168,236,172
buffer_load_dwordx4 v4, s[12:15], s38 offen offset:3072 sc1 lds
Cvaa 184,224,176,44
VE 9,237
Mvaa 184,228,180
Vc 110,12,13
Vc 111,14,15
Mvaa 184,232,184
VE 10,238
Mvaa 184,236,188
s_waitcnt lgkmcnt(8)
Ve 11,239
Cvaa 140,240,128,32
Vc 118,8,9
Vc 119,10,11
Mvaa 140,244,132
VE 12,252
Mvaa 140,248,136
VE 13,253
Mvaa 140,252,140
Vc 126,12,13
v_or3_b32 v7, v7, v110, v111
Cvaa 156,240,144,36
VE 14,254
Mvaa 156,244,148
VE 15,255
Mvaa 156,248,152
Vc 127,14,15
v_or3_b32 v7, v7, v118, v119
Mvaa 156,252,156
v_or3_b32 v7, v7, v126, v127
v_and_b32 v1, 0x40004000, v7
Cvaa 172,240,160,40
v_cmp_ne_u32 vcc, 0, v1
Mvaa 172,244,164
Mvaa 172,248,168
Mvaa 172,252,172
s_waitcnt vmcnt(12)
Cvaa 188,240,176,44
s_cmp_eq_u32 s37, s46
Mvaa 188,244,180
s_barrier
Mvaa 188,248,184
s_waitcnt lgkmcnt(4)
Mvaa 188,252,188
s_cbranch_vccnz L_k2_fb_wo
L_k2_fbr_wo:
Maav 0,192,96
s_cbranch_scc1 L_k2_mk_wo
L_k2_mkr_wo:
Ve 8,128
Maav 0,196,100
s_add_u32 m0, s53, 16384
VE 9,129
Maav 32,192,104
buffer_load_dwordx4 v4, s[12:15], s39 offen offset:0 sc1 lds
Maav 32,196,108
s_add_u32 s37, s37, 1
Ra 224,2,57344
Vc 64,8,9
Maav 64,192,112
s_add_u32 s38, s38, 34816
Ve 10,130
Maav 64,196,116
s_xor_b32 s53, s53, 65536
VE 11,131
Maav 96,192,120
s_xor_b32 s54, s54, 65536
Ra 228,2,58368
Vc 65,10,11
Maav 96,196,124
Ra 232,2,59392
v_or_b32_e64 v7, v64, v65
Maav 4,200,96
VE 12,144
Maav 4,204,100
VE 13,145
Maav 36,200,104
Ra 236,2,60416
Vc 72,12,13
Maav 36,204,108
VE 14,146
Maav 68,200,112
VE 15,147
Maav 68,204,116
Ra 240,2,61440
Vc 73,14,15
Maav 100,200,120
Ra 244,2,62464
v_or3_b32 v7, v7, v72, v73
Maav 100,204,124
buffer_load_dwordx4 v4, s[12:15], s39 offen offset:1024 sc1 lds
Mvvv 48,16,96
VE 8,160
Mvvv 48,16,100
s_waitcnt lgkmcnt(6)
Ve 9,161
Maav 8,208,96
Ra 248,2,63488
Vc 80,8,9
Maav 8,212,100
VE 10,162
Maav 40,208,104
VE 11,163
Maav 40,212,108
Ra 252,2,64512
Vc 81,10,11
Maav 72,208,112
Ra 192,3,32768
v_or3_b32 v7, v7, v80, v81
Maav 72,212,116
VE 12,176
Maav 104,208,120
VE 13,177
Maav 104,212,124
Ra 196,3,33792
Vc 88,12,13
Maav 12,216,96
VE 14,178
Maav 12,220,100
VE 15,179
Maav 44,216,104
Ra 200,3,34816
Vc 89,14,15
Maav 44,220,108
buffer_load_dwordx4 v4, s[12:15], s39 offen offset:2048 sc1 lds
Maav 76,216,112
Ra 204,3,35840
v_or3_b32 v7, v7, v88, v89
Maav 76,220,116
VE 8,132
Maav 108,216,120
VE 9,133
Maav 108,220,124
VE 10,134
Mvvv 52,16,104
VE 11,135
Mvvv 52,16,108
s_waitcnt lgkmcnt(8)
Ve 12,148
Maav 16,224,96
Ra 208,3,36864
Vc 66,8,9
Maav 16,228,100
Ra 212,3,37888
Vc 67,10,11
Maav 48,224,104
Ra 216,3,38912
v_or3_b32 v7, v7, v66, v67
Maav 48,228,108
VE 13,149
Maav 80,224,112
Ra 220,3,39936
Vc 74,12,13
Maav 80,228,116
VE 14,150
Maav 112,224,120
buffer_load_dwordx4 v4, s[12:15], s39 offen offset:3072 sc1 lds
Maav 112,228,124
s_add_u32 s39, s39, 34816
VE 15,151
Maav 20,232,96
VE 8,164
Maav 20,236,100
VE 9,165
Maav 52,232,104
VE 10,166
Maav 52,236,108
VE 11,167
Maav 84,232,112
Vc 75,14,15
Vc 82,8,9
Maav 84,236,116
VE 12,180
Maav 116,232,120
VE 13,181
Maav 116,236,124
Vc 83,10,11
Vc 90,12,13
Mvvv 56,16,112
VE 14,182
Mvvv 56,16,116
s_waitcnt lgkmcnt(8)
Ve 15,183
Maav 24,240,96
Vc 91,14,15
v_or3_b32 v7, v7, v74, v75
Maav 24,244,100
v_or3_b32 v7, v7, v82, v83
v_or3_b32 v7, v7, v90, v91
Maav 56,240,104
global_load_dword v30, v[28:29], off
Maav 56,244,108
Maav 88,240,112
Maav 88,244,116
Maav 120,240,120
Maav 120,244,124
Maav 28,248,96
Maav 28,252,100
Maav 60,248,104
Maav 60,252,108
Maav 92,248,112
Maav 92,252,116
Maav 124,248,120
Maav 124,252,124
s_cmp_lg_u32 s37, s35
Mvvv 60,16,120
s_waitcnt lgkmcnt(4)
Mvvv 60,16,124
s_cbranch_scc1 L_k2_wloop
L_k2_wlast:
v_xor_b32 v2, 65536, v2
v_xor_b32 v3, 65536, v3
Cvaa 192,192,128,32
s_mov_b32 m0, s53
Ra 224,2,40960
v_lshl_add_u64 v[28:29], s[40:41], 0, v[28:29]
Mvaa 192,196,132
buffer_load_dwordx4 v4, s[12:15], s38 offen offset:0 sc1 lds
Mvaa 192,200,136
VE 8,136
Mvaa 192,204,140
VE 9,137
Cvaa 208,192,144,36
Ra 228,2,41984
Vc 68,8,9
Mvaa 208,196,148
VE 10,138
Mvaa 208,200,152
VE 11,139
Mvaa 208,204,156
Ra 232,2,43008
Vc 69,10,11
Cvaa 224,192,160,40
Ra 236,2,44032
v_or3_b32 v7, v7, v68, v69
Mvaa 224,196,164
VE 12,152
Mvaa 224,200,168
VE 13,153
Mvaa 224,204,172
s_waitcnt lgkmcnt(4)
Ra 240,2,45056
Vc 76,12,13
Cvaa 196,208,128,32
buffer_load_dwordx4 v4, s[12:15], s38 offen offset:1024 sc1 lds
Mvaa 196,212,132
Ve 14,154
Mvaa 196,216,136
VE 15,155
Mvaa 196,220,140
Ra 244,2,46080
Vc 77,14,15
Cvaa 212,208,144,36
Ra 248,2,47104
v_or3_b32 v7, v7, v76, v77
Mvaa 212,212,148
VE 8,168
Mvaa 212,216,152
VE 9,169
Mvaa 212,220,156
Ra 252,2,48128
Vc 84,8,9
Cvaa 228,208,160,40
VE 10,170
Mvaa 228,212,164
buffer_load_dwordx4 v4, s[12:15], s38 offen offset:2048 sc1 lds
Mvaa 228,216,168
VE 11,171
Mvaa 228,220,172
s_waitcnt lgkmcnt(4)
Ra 192,2,16384
Vc 85,10,11
Cvaa 200,224,128,32
Ra 196,2,17408
v_or3_b32 v7, v7, v84, v85
Mvaa 200,228,132
Ve 12,184
Mvaa 200,232,136
VE 13,185
Mvaa 200,236,140
Ra 200,2,18432
Vc 92,12,13
Cvaa 216,224,144,36
VE 14,186
Mvaa 216,228,148
VE 15,187
Mvaa 216,232,152
Ra 204,2,19456
Vc 93,14,15
Mvaa 216,236,156
buffer_load_dwordx4 v4, s[12:15], s38 offen offset:3072 sc1 lds
Cvaa 232,224,160,40
Ra 208,2,20480
v_or3_b32 v7, v7, v92, v93
Mvaa 232,228,164
VE 8,140
Mvaa 232,232,168
VE 9,141
Mvaa 232,236,172
s_waitcnt lgkmcnt(5)
Ra 212,2,21504
Vc 70,8,9
Cvaa 204,240,128,32
Ve 10,142
Mvaa 204,244,132
VE 11,143
Mvaa 204,248,136
Ra 216,2,22528
Vc 71,10,11
Mvaa 204,252,140
Ra 220,2,23552
v_or3_b32 v7, v7, v70, v71
Cvaa 220,240,144,36
VE 12,156
Mvaa 220,244,148
VE 13,157
Mvaa 220,248,152
VE 14,158
Mvaa 220,252,156
s_waitcnt vmcnt(12)
Ve 15,159
Cvaa 236,240,160,40
VE 8,172
Mvaa 236,244,164
s_barrier
Ve 9,173
Mvaa 236,248,168
s_waitcnt lgkmcnt(4)
Vc 78,12,13
Vc 79,14,15
Ve 10,174
Ve 11,175
Ve 12,188
Ve 13,189
Ve 14,190
VE 15,191
Vc 86,8,9
Vc 87,10,11
Vc 94,12,13
Vc 95,14,15
v_or3_b32 v7, v7, v78, v79
v_or3_b32 v7, v7, v86, v87
v_or3_b32 v7, v7, v94, v95
v_and_b32 v1, 0x40004000, v7
v_cmp_ne_u32 vcc, 0, v1
Mvaa 236,252,172
s_cbranch_vccnz L_k2_fb_wl
L_k2_fbr_wl:
Maav 0,192,64
s_branch L_k2_mk_wl
L_k2_mkr_wl:
Ve 8,192
Maav 0,196,68
s_add_u32 m0, s54, 49152
VE 9,193
Maav 32,192,72
buffer_load_dwordx4 v4, s[12:15], s39 offen offset:0 sc1 lds
Maav 32,196,76
s_add_u32 s37, s37, 1
Ra 224,2,24576
Vc 96,8,9
Maav 64,192,80
s_add_u32 s38, s38, 34816
Ve 10,194
Maav 64,196,84
VE 11,195
Maav 96,192,88
Ra 228,2,25600
Vc 97,10,11
Maav 96,196,92
Ra 232,2,26624
v_or_b32_e64 v7, v96, v97
Maav 4,200,64
VE 12,208
Maav 4,204,68
VE 13,209
Maav 36,200,72
Ra 236,2,27648
Vc 104,12,13
Maav 36,204,76
VE 14,210
Maav 68,200,80
VE 15,211
Maav 68,204,84
Ra 240,2,28672
Vc 105,14,15
Maav 100,200,88
Ra 244,2,29696
v_or3_b32 v7, v7, v104, v105
Maav 100,204,92
buffer_load_dwordx4 v4, s[12:15], s39 offen offset:1024 sc1 lds
Mvvv 48,16,64
VE 8,224
Mvvv 48,16,68
s_waitcnt lgkmcnt(6)
Ve 9,225
Maav 8,208,64
Ra 248,2,30720
Vc 112,8,9
Maav 8,212,68
VE 10,226
Maav 40,208,72
VE 11,227
Maav 40,212,76
Ra 252,2,31744
Vc 113,10,11
Maav 72,208,80
Ra 192,3,0
v_or3_b32 v7, v7, v112, v113
Maav 72,212,84
VE 12,196
Maav 104,208,88
VE 13,197
Maav 104,212,92
Ra 196,3,1024
Vc 98,12,13
Maav 12,216,64
VE 14,198
Maav 12,220,68
VE 15,199
Maav 44,216,72
Ra 200,3,2048
Vc 99,14,15
Maav 44,220,76
buffer_load_dwordx4 v4, s[12:15], s39 offen offset:2048 sc1 lds
Maav 76,216,80
Ra 204,3,3072
v_or3_b32 v7, v7, v98, v99
Maav 76,220,84
VE 8,212
Maav 108,216,88
VE 9,213
Maav 108,220,92
VE 10,214
Mvvv 52,16,72
VE 11,215
Mvvv 52,16,76
s_waitcnt lgkmcnt(8)
Ve 12,228
Maav 16,224,64
Ra 208,3,4096
Vc 106,8,9
Maav 16,228,68
Ra 212,3,5120
Vc 107,10,11
Maav 48,224,72
Ra 216,3,6144
v_or3_b32 v7, v7, v106, v107
Maav 48,228,76
VE 13,229
Maav 80,224,80
Ra 220,3,7168
Vc 114,12,13
Maav 80,228,84
VE 14,230
Maav 112,224,88
buffer_load_dwordx4 v4, s[12:15], s39 offen offset:3072 sc1 lds
Maav 112,228,92
s_add_u32 s39, s39, 34816
VE 15,231
Maav 20,232,64
VE 8,200
Maav 20,236,68
VE 9,201
Maav 52,232,72
VE 10,202
Maav 52,236,76
VE 11,203
Maav 84,232,80
Vc 115,14,15
Vc 100,8,9
Maav 84,236,84
VE 12,216
Maav 116,232,88
VE 13,217
Maav 116,236,92
Vc 101,10,11
Vc 108,12,13
Mvvv 56,16,80
VE 14,218
Mvvv 56,16,84
s_waitcnt lgkmcnt(8)
Ve 15,219
Maav 24,240,64
Vc 109,14,15
v_or3_b32 v7, v7, v114, v115
Maav 24,244,68
VE 8,232
Maav 56,240,72
global_load_dword v30, v[28:29], off
Maav 56,244,76
VE 9,233
Maav 88,240,80
Vc 116,8,9
v_or3_b32 v7, v7, v100, v101
Maav 88,244,84
VE 10,234
Maav 120,240,88
VE 11,235
Maav 120,244,92
Vc 117,10,11
v_or3_b32 v7, v7, v108, v109
Maav 28,248,64
v_or3_b32 v7, v7, v116, v117
Maav 28,252,68
Maav 60,248,72
Maav 60,252,76
Maav 92,248,80
Maav 92,252,84
Maav 124,248,88
Maav 124,252,92
Mvvv 60,16,88
s_waitcnt lgkmcnt(4)
Mvvv 60,16,92
Ve 12,204
Cvaa 128,192,128,32
s_add_u32 m0, s53, 32768
VE 13,205
Mvaa 128,196,132
buffer_load_dwordx4 v4, s[12:15], s38 offen offset:0 sc1 lds
Mvaa 128,200,136
Ra 224,3,8192
Vc 102,12,13
Mvaa 128,204,140
VE 14,206
Cvaa 144,192,144,36
VE 15,207
Mvaa 144,196,148
Ra 228,3,9216
Vc 103,14,15
Mvaa 144,200,152
Ra 232,3,10240
v_or3_b32 v7, v7, v102, v103
Mvaa 144,204,156
s_waitcnt lgkmcnt(3)
Ra 236,3,11264
Ra 240,3,12288
Cvaa 132,208,128,32
buffer_load_dwordx4 v4, s[12:15], s38 offen offset:1024 sc1 lds
Mvaa 132,212,132
Ve 8,220
Mvaa 132,216,136
VE 9,221
Mvaa 132,220,140
Ra 244,3,13312
Vc 110,8,9
Cvaa 148,208,144,36
VE 10,222
Mvaa 148,212,148
buffer_load_dwordx4 v4, s[12:15], s38 offen offset:2048 sc1 lds
Mvaa 148,216,152
VE 11,223
Mvaa 148,220,156
s_waitcnt lgkmcnt(2)
Ra 248,3,14336
Ra 252,3,15360
Cvaa 136,224,128,32
Ra 192,2,49152
Vc 111,10,11
Mvaa 136,228,132
Ra 196,2,50176
v_or3_b32 v7, v7, v110, v111
Mvaa 136,232,136
Ve 12,236
Mvaa 136,236,140
buffer_load_dwordx4 v4, s[12:15], s38 offen offset:3072 sc1 lds
Cvaa 152,224,144,36
VE 13,237
Mvaa 152,228,148
Ra 200,2,51200
Vc 118,12,13
Mvaa 152,232,152
VE 14,238
Mvaa 152,236,156
s_waitcnt lgkmcnt(3)
Ra 204,2,52224
Ra 208,2,53248
Cvaa 140,240,128,32
Ve 15,239
Mvaa 140,244,132
Ra 212,2,54272
Vc 119,14,15
Mvaa 140,248,136
Ra 216,2,55296
v_or3_b32 v7, v7, v118, v119
Mvaa 140,252,140
s_waitcnt vmcnt(12)
Ra 220,2,56320
v_and_b32 v1, 0x40004000, v7
Cvaa 156,240,144,36
s_cmp_eq_u32 s37, s45
v_cmp_ne_u32 vcc, 0, v1
Mvaa 156,244,148
s_barrier
Mvaa 156,248,152
s_waitcnt lgkmcnt(4)
Mvaa 156,252,156
s_cbranch_vccnz L_k2_fb_tr
L_k2_fbr_tr:
Maav 0,192,96
s_cbranch_scc1 L_k2_mk_tr
L_k2_mkr_tr:
Ve 8,128
Maav 0,196,100
s_add_u32 m0, s53, 16384
VE 9,129
Maav 32,192,104
buffer_load_dwordx4 v4, s[12:15], s39 offen offset:0 sc1 lds
Maav 32,196,108
s_add_u32 s37, s37, 1
Ra 224,2,57344
Vc 64,8,9
Maav 64,192,112
s_add_u32 s38, s38, 34816
Ve 10,130
Maav 64,196,116
s_xor_b32 s53, s53, 65536
VE 11,131
Maav 4,200,96
s_xor_b32 s54, s54, 65536
Ra 228,2,58368
Vc 65,10,11
Maav 4,204,100
Ra 232,2,59392
v_or_b32_e64 v7, v64, v65
Maav 36,200,104
VE 12,144
Maav 36,204,108
VE 13,145
Maav 68,200,112
Ra 236,2,60416
Vc 72,12,13
Maav 68,204,116
VE 14,146
Mvvv 48,16,96
VE 15,147
Mvvv 48,16,100
s_waitcnt lgkmcnt(4)
Ra 240,2,61440
Vc 73,14,15
Maav 8,208,96
buffer_load_dwordx4 v4, s[12:15], s39 offen offset:1024 sc1 lds
Maav 8,212,100
Ra 244,2,62464
v_or3_b32 v7, v7, v72, v73
Maav 40,208,104
Ve 8,132
Maav 40,212,108
VE 9,133
Maav 72,208,112
Ra 248,2,63488
Vc 66,8,9
Maav 72,212,116
VE 10,134
Maav 12,216,96
VE 11,135
Maav 12,220,100
Ra 252,2,64512
Vc 67,10,11
Maav 44,216,104
Ra 192,3,32768
v_or3_b32 v7, v7, v66, v67
Maav 44,220,108
VE 12,148
Maav 76,216,112
VE 13,149
Maav 76,220,116
Ra 196,3,33792
Vc 74,12,13
Mvvv 52,16,104
VE 14,150
Mvvv 52,16,108
s_waitcnt lgkmcnt(6)
Ve 15,151
Maav 16,224,96
buffer_load_dwordx4 v4, s[12:15], s39 offen offset:2048 sc1 lds
Maav 16,228,100
Ra 200,3,34816
Vc 75,14,15
Maav 48,224,104
Ra 204,3,35840
v_or3_b32 v7, v7, v74, v75
Maav 48,228,108
VE 8,136
Maav 80,224,112
Ra 208,3,36864
Ra 212,3,37888
Maav 80,228,116
Ra 216,3,38912
Ra 220,3,39936
Maav 20,232,96
Maav 20,236,100
Maav 52,232,104
Maav 52,236,108
Maav 84,232,112
Maav 84,236,116
buffer_load_dwordx4 v4, s[12:15], s39 offen offset:3072 sc1 lds
Mvvv 56,16,112
s_add_u32 s39, s39, 34816
Mvvv 56,16,116
s_waitcnt lgkmcnt(8)
Maav 24,240,96
Maav 24,244,100
Maav 56,240,104
Maav 56,244,108
Maav 88,240,112
Maav 88,244,116
Maav 28,248,96
Maav 28,252,100
Maav 60,248,104
Maav 60,252,108
Maav 92,248,112
s_waitcnt lgkmcnt(4)
Maav 92,252,116
s_getpc_b64 s[56:57]
L_cpf4:
s_add_u32 s56, s56, (L_k2_fin-L_cpf4)&0xffffffff
s_addc_u32 s57, s57, ((L_k2_fin-L_cpf4)>>32)&0xffffffff
s_lshr_b32 s58, s2, 3
s_lshl_b32 s58, s58, 2
s_add_u32 s58, s58, s32
s_lshl_b32 s58, s58, 10
v_and_b32 v162, 7, v0
v_lshlrev_b32 v162, 7, v162
v_add_u32 v162, s58, v162
v_min_u32 v162, L_p4_end-L_k2_fin-4, v162
v_mov_b32 v161, s57
v_add_co_u32 v160, vcc, s56, v162
s_nop 1
v_addc_co_u32 v161, vcc, 0, v161, vcc
global_load_dword v164, v[160:161], off
s_waitcnt vmcnt(9)
s_lshl_b32 s3, s34, 20
s_lshl_b32 s47, s33, 15
s_add_u32 s3, s3, s47
s_lshl_b32 s47, s32, 10
v_lshlrev_b32 v248, 4, v0
v_add_u32_e64 v249, s47, v248
s_sub_u32 s47, 7168, s47
v_add_u32 v248, s47, v248
v_rcp_f32 v250, v56
v_rcp_f32 v252, v60
v_mov_b32 v251, v250
v_mov_b32_e64 v253, v252
Ar 240,96
Ar 241,97
Ar 242,98
Ar 243,99
Ar 244,100
Ar 245,101
Ar 246,102
Ar 247,103
v_pk_mul_f32 v[240:241], v[240:241], v[252:253]
v_pk_mul_f32 v[242:243], v[242:243], v[252:253]
v_pk_mul_f32 v[244:245], v[244:245], v[252:253]
v_pk_mul_f32 v[246:247], v[246:247], v[252:253]
Vc 28,240,241
Vc 29,242,243
Vc 30,244,245
Vc 31,246,247
buffer_store_dwordx4 v[28:31], v249, s[16:19], s3 offen sc1
Ar 240,64
Ar 241,65
Ar 242,66
Ar 243,67
Ar 244,68
Ar 245,69
Ar 246,70
Ar 247,71
v_pk_mul_f32 v[240:241], v[240:241], v[250:251]
v_pk_mul_f32 v[242:243], v[242:243], v[250:251]
v_pk_mul_f32 v[244:245], v[244:245], v[250:251]
v_pk_mul_f32 v[246:247], v[246:247], v[250:251]
Vc 24,240,241
Vc 25,242,243
Vc 26,244,245
Vc 27,246,247
buffer_store_dwordx4 v[24:27], v248, s[16:19], s3 offen sc1
s_add_u32 s3, s3, 8192
Ar 240,104
Ar 241,105
Ar 242,106
Ar 243,107
Ar 244,108
Ar 245,109
Ar 246,110
Ar 247,111
v_pk_mul_f32 v[240:241], v[240:241], v[252:253]
v_pk_mul_f32 v[242:243], v[242:243], v[252:253]
v_pk_mul_f32 v[244:245], v[244:245], v[252:253]
v_pk_mul_f32 v[246:247], v[246:247], v[252:253]
Vc 28,240,241
Vc 29,242,243
Vc 30,244,245
Vc 31,246,247
buffer_store_dwordx4 v[28:31], v249, s[16:19], s3 offen sc1
Ar 240,72
Ar 241,73
Ar 242,74
Ar 243,75
Ar 244,76
Ar 245,77
Ar 246,78
Ar 247,79
v_pk_mul_f32 v[240:241], v[240:241], v[250:251]
v_pk_mul_f32 v[242:243], v[242:243], v[250:251]
v_pk_mul_f32 v[244:245], v[244:245], v[250:251]
v_pk_mul_f32 v[246:247], v[246:247], v[250:251]
Vc 24,240,241
Vc 25,242,243
Vc 26,244,245
Vc 27,246,247
buffer_store_dwordx4 v[24:27], v248, s[16:19], s3 offen sc1
s_add_u32 s3, s3, 8192
Ar 240,112
Ar 241,113
Ar 242,114
Ar 243,115
Ar 244,116
Ar 245,117
Ar 246,118
Ar 247,119
v_pk_mul_f32 v[240:241], v[240:241], v[252:253]
v_pk_mul_f32 v[242:243], v[242:243], v[252:253]
v_pk_mul_f32 v[244:245], v[244:245], v[252:253]
v_pk_mul_f32 v[246:247], v[246:247], v[252:253]
Vc 28,240,241
Vc 29,242,243
Vc 30,244,245
Vc 31,246,247
buffer_store_dwordx4 v[28:31], v249, s[16:19], s3 offen sc1
Ar 240,80
Ar 241,81
Ar 242,82
Ar 243,83
Ar 244,84
Ar 245,85
Ar 246,86
Ar 247,87
v_pk_mul_f32 v[240:241], v[240:241], v[250:251]
v_pk_mul_f32 v[242:243], v[242:243], v[250:251]
v_pk_mul_f32 v[244:245], v[244:245], v[250:251]
v_pk_mul_f32 v[246:247], v[246:247], v[250:251]
Vc 24,240,241
Vc 25,242,243
Vc 26,244,245
Vc 27,246,247
buffer_store_dwordx4 v[24:27], v248, s[16:19], s3 offen sc1
s_add_u32 s3, s3, 8192
Ar 240,120
Ar 241,121
Ar 242,122
Ar 243,123
Ar 244,124
Ar 245,125
Ar 246,126
Ar 247,127
v_pk_mul_f32 v[240:241], v[240:241], v[252:253]
v_pk_mul_f32 v[242:243], v[242:243], v[252:253]
v_pk_mul_f32 v[244:245], v[244:245], v[252:253]
v_pk_mul_f32 v[246:247], v[246:247], v[252:253]
Vc 28,240,241
Vc 29,242,243
Vc 30,244,245
Vc 31,246,247
buffer_store_dwordx4 v[28:31], v249, s[16:19], s3 offen sc1
Ar 240,88
Ar 241,89
Ar 242,90
Ar 243,91
Ar 244,92
Ar 245,93
Ar 246,94
Ar 247,95
v_pk_mul_f32 v[240:241], v[240:241], v[250:251]
v_pk_mul_f32 v[242:243], v[242:243], v[250:251]
v_pk_mul_f32 v[244:245], v[244:245], v[250:251]
v_pk_mul_f32 v[246:247], v[246:247], v[250:251]
Vc 24,240,241
Vc 25,242,243
Vc 26,244,245
Vc 27,246,247
buffer_store_dwordx4 v[24:27], v248, s[16:19], s3 offen sc1
s_add_u32 s52, s37, 2
s_load_dwordx2 s[94:95], s[0:1], 40
s_load_dwordx2 s[40:41], s[0:1], 0
s_load_dwordx4 s[8:11], s[0:1], 80
s_waitcnt vmcnt(8) lgkmcnt(0)
s_cmp_eq_u32 s34, 7
s_cbranch_scc1 L_k2_fin
L_k2_nloop:
v_xor_b32 v2, 65536, v2
v_xor_b32 v3, 65536, v3
Cvaa 192,192,128,32
s_mov_b32 m0, s53
Ve 9,137
Mvaa 192,196,132
buffer_load_dwordx4 v4, s[12:15], s38 offen offset:0 sc1 lds
Mvaa 192,200,136
Ra 224,2,40960
Vc 68,8,9
Mvaa 192,204,140
VE 10,138
Cvaa 208,192,144,36
VE 11,139
Mvaa 208,196,148
Ra 228,2,41984
Vc 69,10,11
Mvaa 208,200,152
Ra 232,2,43008
v_or3_b32 v7, v7, v68, v69
Mvaa 208,204,156
s_waitcnt lgkmcnt(3)
Ra 236,2,44032
Ra 240,2,45056
Cvaa 196,208,128,32
buffer_load_dwordx4 v4, s[12:15], s38 offen offset:1024 sc1 lds
Mvaa 196,212,132
Ve 12,152
Mvaa 196,216,136
VE 13,153
Mvaa 196,220,140
Ra 244,2,46080
Vc 76,12,13
Cvaa 212,208,144,36
VE 14,154
Mvaa 212,212,148
buffer_load_dwordx4 v4, s[12:15], s38 offen offset:2048 sc1 lds
Mvaa 212,216,152
VE 15,155
Mvaa 212,220,156
s_waitcnt lgkmcnt(2)
Ra 248,2,47104
Ra 252,2,48128
Cvaa 200,224,128,32
Ra 192,2,16384
Vc 77,14,15
Mvaa 200,228,132
Ra 196,2,17408
v_or3_b32 v7, v7, v76, v77
Mvaa 200,232,136
Ve 8,140
Mvaa 200,236,140
buffer_load_dwordx4 v4, s[12:15], s38 offen offset:3072 sc1 lds
Cvaa 216,224,144,36
VE 9,141
Mvaa 216,228,148
Ra 200,2,18432
Vc 70,8,9
Mvaa 216,232,152
VE 10,142
Mvaa 216,236,156
s_waitcnt lgkmcnt(3)
Ra 204,2,19456
Ra 208,2,20480
Cvaa 204,240,128,32
Ve 11,143
Mvaa 204,244,132
s_cmp_lt_u32 s37, s52
Ra 212,2,21504
Vc 71,10,11
Mvaa 204,248,136
s_cbranch_scc1 L_nw_ne
s_waitcnt vmcnt(12)
L_nw_ne:
Ra 216,2,22528
v_or3_b32 v7, v7, v70, v71
Mvaa 204,252,140
Ve 12,156
Cvaa 220,240,144,36
VE 13,157
Mvaa 220,244,148
s_barrier
Ra 220,2,23552
Vc 78,12,13
Mvaa 220,248,152
s_waitcnt lgkmcnt(4)
Ve 14,158
Ve 15,159
s_nop 0
Vc 79,14,15
v_or3_b32 v7, v7, v78, v79
v_and_b32 v1, 0x40004000, v7
v_cmp_ne_u32 vcc, 0, v1
Mvaa 220,252,156
s_cbranch_vccnz L_k2_fb_ne
L_k2_fbr_ne:
Maav 0,192,64
Ve 8,192
Maav 0,196,68
s_add_u32 m0, s54, 49152
VE 9,193
Maav 32,192,72
buffer_load_dwordx4 v4, s[12:15], s39 offen offset:0 sc1 lds
Maav 32,196,76
s_cmp_eq_u32 s37, s52
Ra 224,2,24576
Vc 96,8,9
Maav 4,200,64
s_cbranch_scc1 L_pubB
L_pubBr:
VE 10,194
Maav 4,204,68
s_add_u32 s37, s37, 1
Ve 11,195
Maav 36,200,72
s_add_u32 s38, s38, 34816
Ra 228,2,25600
Vc 97,10,11
Maav 36,204,76
Ra 232,2,26624
v_or_b32_e64 v7, v96, v97
Mvvv 48,16,64
VE 12,208
Mvvv 48,16,68
s_waitcnt lgkmcnt(3)
Ra 236,2,27648
Ra 240,2,28672
Maav 8,208,64
buffer_load_dwordx4 v4, s[12:15], s39 offen offset:1024 sc1 lds
Maav 8,212,68
Ve 13,209
Maav 40,208,72
Ra 244,2,29696
Vc 104,12,13
Maav 40,212,76
VE 14,210
Maav 12,216,64
VE 15,211
Maav 12,220,68
Ra 248,2,30720
Vc 105,14,15
Maav 44,216,72
Ra 252,2,31744
v_or3_b32 v7, v7, v104, v105
Maav 44,220,76
VE 8,196
Mvvv 52,16,72
buffer_load_dwordx4 v4, s[12:15], s39 offen offset:2048 sc1 lds
Mvvv 52,16,76
s_waitcnt lgkmcnt(4)
Ve 9,197
Maav 16,224,64
Ra 192,3,0
Vc 98,8,9
Maav 16,228,68
VE 10,198
Maav 48,224,72
VE 11,199
Maav 48,228,76
Ra 196,3,1024
Vc 99,10,11
Maav 20,232,64
Ra 200,3,2048
v_or3_b32 v7, v7, v98, v99
Maav 20,236,68
Ra 204,3,3072
Ra 208,3,4096
Maav 52,232,72
buffer_load_dwordx4 v4, s[12:15], s39 offen offset:3072 sc1 lds
Maav 52,236,76
s_waitcnt lgkmcnt(5)
Ve 12,212
Maav 24,240,64
s_add_u32 s39, s39, 34816
VE 13,213
Maav 24,244,68
Ra 212,3,5120
Vc 106,12,13
Maav 56,240,72
VE 14,214
Maav 56,244,76
VE 15,215
Maav 28,248,64
Ra 216,3,6144
Vc 107,14,15
Maav 28,252,68
Ra 220,3,7168
v_or3_b32 v7, v7, v106, v107
Maav 60,248,72
s_waitcnt lgkmcnt(4)
Ve 8,200
Maav 60,252,76
VE 9,201
Cvaa 128,192,128,32
s_add_u32 m0, s53, 32768
Ra 224,3,8192
Vc 100,8,9
Mvaa 128,196,132
buffer_load_dwordx4 v4, s[12:15], s38 offen offset:0 sc1 lds
Mvaa 128,200,136
VE 10,202
Mvaa 128,204,140
VE 11,203
Cvaa 144,192,144,36
Ra 228,3,9216
Vc 101,10,11
Mvaa 144,196,148
Ra 232,3,10240
v_or3_b32 v7, v7, v100, v101
Mvaa 144,200,152
VE 12,216
Mvaa 144,204,156
s_waitcnt lgkmcnt(3)
Ra 236,3,11264
Ra 240,3,12288
Cvaa 132,208,128,32
buffer_load_dwordx4 v4, s[12:15], s38 offen offset:1024 sc1 lds
Mvaa 132,212,132
Ve 13,217
Mvaa 132,216,136
Ra 244,3,13312
Vc 108,12,13
Mvaa 132,220,140
VE 14,218
Cvaa 148,208,144,36
VE 15,219
Mvaa 148,212,148
buffer_load_dwordx4 v4, s[12:15], s38 offen offset:2048 sc1 lds
Mvaa 148,216,152
Ra 248,3,14336
Vc 109,14,15
Mvaa 148,220,156
s_waitcnt lgkmcnt(3)
Ra 252,3,15360
v_or3_b32 v7, v7, v108, v109
Cvaa 136,224,128,32
Ve 8,204
Mvaa 136,228,132
VE 9,205
Mvaa 136,232,136
Ra 192,2,49152
Vc 102,8,9
Mvaa 136,236,140
buffer_load_dwordx4 v4, s[12:15], s38 offen offset:3072 sc1 lds
Cvaa 152,224,144,36
VE 10,206
Mvaa 152,228,148
VE 11,207
Mvaa 152,232,152
Ra 196,2,50176
Vc 103,10,11
Mvaa 152,236,156
s_waitcnt lgkmcnt(2)
Ra 200,2,51200
Ra 204,2,52224
Cvaa 140,240,128,32
Ra 208,2,53248
v_or3_b32 v7, v7, v102, v103
Mvaa 140,244,132
s_cmp_lt_u32 s37, s52
VE 12,220
Mvaa 140,248,136
s_cbranch_scc1 L_nw_no
s_waitcnt vmcnt(12)
L_nw_no:
VE 13,221
Mvaa 140,252,140
Ra 212,2,54272
Vc 110,12,13
Cvaa 156,240,144,36
s_cmp_eq_u32 s37, s45
Ve 14,222
Mvaa 156,244,148
s_barrier
Ve 15,223
Mvaa 156,248,152
s_waitcnt lgkmcnt(2)
Ra 216,2,55296
Vc 111,14,15
v_or3_b32 v7, v7, v110, v111
v_and_b32 v1, 0x40004000, v7
v_cmp_ne_u32 vcc, 0, v1
Mvaa 156,252,156
s_cbranch_vccnz L_k2_fb_no
L_k2_fbr_no:
Ra 220,2,56320
Maav 0,192,96
s_cbranch_scc1 L_k2_mk_no
L_k2_mkr_no:
VE 8,128
Maav 0,196,100
s_add_u32 m0, s53, 16384
VE 9,129
Maav 32,192,104
buffer_load_dwordx4 v4, s[12:15], s39 offen offset:0 sc1 lds
Maav 32,196,108
s_add_u32 s37, s37, 1
Ra 224,2,57344
Vc 64,8,9
Maav 4,200,96
s_add_u32 s38, s38, 34816
Ve 10,130
Maav 4,204,100
s_xor_b32 s53, s53, 65536
VE 11,131
Maav 36,200,104
s_xor_b32 s54, s54, 65536
Ra 228,2,58368
Vc 65,10,11
Maav 36,204,108
Ra 232,2,59392
v_or_b32_e64 v7, v64, v65
Mvvv 48,16,96
VE 12,144
Mvvv 48,16,100
s_waitcnt lgkmcnt(3)
Ra 236,2,60416
Ra 240,2,61440
Maav 8,208,96
buffer_load_dwordx4 v4, s[12:15], s39 offen offset:1024 sc1 lds
Maav 8,212,100
Ve 13,145
Maav 40,208,104
Ra 244,2,62464
Vc 72,12,13
Maav 40,212,108
VE 14,146
Maav 12,216,96
VE 15,147
Maav 12,220,100
Ra 248,2,63488
Vc 73,14,15
Maav 44,216,104
Ra 252,2,64512
v_or3_b32 v7, v7, v72, v73
Maav 44,220,108
VE 8,132
Mvvv 52,16,104
buffer_load_dwordx4 v4, s[12:15], s39 offen offset:2048 sc1 lds
Mvvv 52,16,108
s_waitcnt lgkmcnt(4)
Ve 9,133
Maav 16,224,96
Ra 192,3,32768
Vc 66,8,9
Maav 16,228,100
VE 10,134
Maav 48,224,104
VE 11,135
Maav 48,228,108
Ra 196,3,33792
Vc 67,10,11
Maav 20,232,96
Ra 200,3,34816
v_or3_b32 v7, v7, v66, v67
Maav 20,236,100
Ra 204,3,35840
Ra 208,3,36864
Maav 52,232,104
buffer_load_dwordx4 v4, s[12:15], s39 offen offset:3072 sc1 lds
Maav 52,236,108
s_waitcnt lgkmcnt(5)
Ve 12,148
Maav 24,240,96
s_add_u32 s39, s39, 34816
VE 13,149
Maav 24,244,100
Ra 212,3,37888
Vc 74,12,13
Maav 56,240,104
VE 14,150
Maav 56,244,108
VE 15,151
Maav 28,248,96
Ra 216,3,38912
Vc 75,14,15
Maav 28,252,100
s_cmp_lg_u32 s37, s36
Ra 220,3,39936
v_or3_b32 v7, v7, v74, v75
Maav 60,248,104
s_waitcnt lgkmcnt(4)
VE 8,136
Maav 60,252,108
s_cbranch_scc1 L_k2_nloop
L_k2_fin:
v_xor_b32 v2, 65536, v2
v_xor_b32 v3, 65536, v3
Cvaa 192,192,128,32
Ve 9,137
Mvaa 192,196,132
Ra 224,2,40960
Vc 68,8,9
Mvaa 192,200,136
Ra 228,2,41984
Ra 232,2,43008
Mvaa 192,204,140
s_waitcnt lgkmcnt(3)
Ra 236,2,44032
Ra 240,2,45056
Cvaa 196,208,128,32
Ve 10,138
Mvaa 196,212,132
VE 11,139
Mvaa 196,216,136
Ra 244,2,46080
Vc 69,10,11
Mvaa 196,220,140
s_waitcnt lgkmcnt(2)
Ra 248,2,47104
Ra 252,2,48128
Cvaa 200,224,128,32
Ra 192,2,16384
v_or3_b32 v7, v7, v68, v69
Mvaa 200,228,132
s_cmp_lt_u32 s37, s52
VE 12,152
Mvaa 200,232,136
s_cbranch_scc1 L_nw_nl
s_waitcnt vmcnt(8)
L_nw_nl:
Ra 196,2,17408
Ra 200,2,18432
Mvaa 200,236,140
s_waitcnt lgkmcnt(3)
Ra 204,2,19456
Ra 208,2,20480
Cvaa 204,240,128,32
Ve 13,153
Mvaa 204,244,132
s_barrier
Ra 212,2,21504
Vc 76,12,13
Mvaa 204,248,136
s_waitcnt lgkmcnt(2)
Ve 14,154
Ve 15,155
Ve 8,140
Ve 9,141
Ve 10,142
Ve 11,143
Ve 12,156
Ve 13,157
Vc 77,14,15
Ve 14,158
Ve 15,159
Vc 70,8,9
Vc 71,10,11
Vc 78,12,13
Vc 79,14,15
v_or3_b32 v7, v7, v76, v77
v_or3_b32 v7, v7, v70, v71
v_or3_b32 v7, v7, v78, v79
v_and_b32 v1, 0x40004000, v7
v_cmp_ne_u32 vcc, 0, v1
Mvaa 204,252,140
s_cbranch_vccnz L_k2_fb_nl
L_k2_fbr_nl:
Ra 216,2,22528
Ra 220,2,23552
s_lshr_b32 s3, s42, 4
s_mul_i32 s3, s3, 33792
s_and_b32 s47, s42, 15
s_lshl_b32 s47, s47, 4
s_add_u32 s3, s3, s47
v_mov_b32 v28, s3
s_lshr_b32 s3, s43, 4
s_mul_i32 s3, s3, 33792
s_and_b32 s47, s43, 15
s_lshl_b32 s47, s47, 4
s_add_u32 s3, s3, s47
v_mov_b32 v29, s3
v_lshrrev_b32 v24, 4, v0
v_and_b32 v25, 15, v0
v_cmp_eq_u32 vcc, 1, v25
s_lshl_b32 s3, s32, 4
v_add_u32 v26, s3, v24
v_cndmask_b32 v28, v28, v29, vcc
v_lshl_add_u32 v28, v24, 8, v28
v_mul_u32_u24 v26, 7168, v26
v_lshlrev_b32 v24, 1, v24
v_xor_b32 v24, v24, v25
v_xor_b32_e64 v25, 8, v24
v_lshl_add_u32 v24, v24, 4, v26
v_lshl_add_u32 v25, v25, 4, v26
s_lshl_b32 s3, s92, 12
buffer_load_dwordx4 a[160:163], v28, s[20:23], s3 offen offset:0 sc1
buffer_load_dwordx4 a[164:167], v28, s[20:23], s3 offen offset:1024 sc1
buffer_load_dwordx4 a[168:171], v28, s[20:23], s3 offen offset:2048 sc1
buffer_load_dwordx4 a[172:175], v28, s[20:23], s3 offen offset:3072 sc1
Maav 0,192,64
s_branch L_k2_mk_nl
L_k2_mkr_nl:
VE 8,192
Maav 0,196,68
s_add_u32 m0, s54, 0
s_add_u32 s3, s5, 0
VE 9,193
Maav 32,192,72
buffer_load_dwordx4 v24, s[24:27], s3 offen offset:0 lds
Maav 32,196,76
s_add_u32 s3, s5, 27648
Ra 224,2,24576
Vc 96,8,9
Maav 4,200,64
buffer_load_dwordx4 v24, s[24:27], s3 offen offset:1024 lds
Maav 4,204,68
s_add_u32 s3, s5, 55296
VE 10,194
Maav 36,200,72
buffer_load_dwordx4 v25, s[24:27], s3 offen offset:2048 lds
Maav 36,204,76
s_add_u32 s3, s5, 82944
Ra 228,2,25600
Ra 232,2,26624
Mvvv 48,16,64
buffer_load_dwordx4 v25, s[24:27], s3 offen offset:3072 lds
Mvvv 48,16,68
s_waitcnt lgkmcnt(3)
s_add_u32 m0, s54, 16384
s_add_u32 s3, s5, 458752
Ra 236,2,27648
Ra 240,2,28672
Maav 8,208,64
buffer_load_dwordx4 v24, s[24:27], s3 offen offset:0 lds
Maav 8,212,68
s_add_u32 s3, s5, 486400
Ve 11,195
Maav 40,208,72
buffer_load_dwordx4 v24, s[24:27], s3 offen offset:1024 lds
Maav 40,212,76
s_add_u32 s3, s5, 514048
Ra 244,2,29696
Vc 97,10,11
Maav 12,216,64
buffer_load_dwordx4 v25, s[24:27], s3 offen offset:2048 lds
Maav 12,220,68
s_add_u32 s3, s5, 541696
Ra 248,2,30720
v_or_b32_e64 v7, v96, v97
Maav 44,216,72
buffer_load_dwordx4 v25, s[24:27], s3 offen offset:3072 lds
Maav 44,220,76
s_add_u32 m0, s54, 32768
s_add_u32 s3, s5, 0
Ve 12,196
Mvvv 52,16,72
buffer_load_dwordx4 v24, s[68:71], s3 offen offset:0 lds
Mvvv 52,16,76
s_waitcnt lgkmcnt(3)
s_add_u32 s3, s5, 27648
Ra 252,2,31744
Ra 192,2,49152
Maav 16,224,64
buffer_load_dwordx4 v24, s[68:71], s3 offen offset:1024 lds
Maav 16,228,68
s_add_u32 s3, s5, 55296
Ve 13,197
Maav 48,224,72
buffer_load_dwordx4 v25, s[68:71], s3 offen offset:2048 lds
Maav 48,228,76
s_add_u32 s3, s5, 82944
Ra 196,2,50176
Vc 98,12,13
Maav 20,232,64
buffer_load_dwordx4 v25, s[68:71], s3 offen offset:3072 lds
Maav 20,236,68
s_add_u32 m0, s54, 49152
s_add_u32 s3, s5, 458752
Ra 200,2,51200
Ra 204,2,52224
Maav 52,232,72
buffer_load_dwordx4 v24, s[68:71], s3 offen offset:0 lds
Maav 52,236,76
s_waitcnt lgkmcnt(4)
s_add_u32 s3, s5, 486400
Ve 14,198
Maav 24,240,64
buffer_load_dwordx4 v24, s[68:71], s3 offen offset:1024 lds
Maav 24,244,68
s_add_u32 s3, s5, 514048
VE 15,199
Maav 56,240,72
buffer_load_dwordx4 v25, s[68:71], s3 offen offset:2048 lds
Maav 56,244,76
s_add_u32 s3, s5, 541696
Ra 208,2,53248
Vc 99,14,15
Maav 28,248,64
buffer_load_dwordx4 v25, s[68:71], s3 offen offset:3072 lds
Maav 28,252,68
Ra 212,2,54272
v_or3_b32 v7, v7, v98, v99
Maav 60,248,72
s_waitcnt lgkmcnt(2)
Ra 216,2,55296
Ra 220,2,56320
Ve 8,200
Ve 9,201
Ve 10,202
Ve 11,203
Ve 12,204
Ve 13,205
Ve 14,206
VE 15,207
Vc 100,8,9
Vc 101,10,11
Vc 102,12,13
Vc 103,14,15
v_or3_b32 v7, v7, v100, v101
v_or3_b32 v7, v7, v102, v103
Maav 60,252,76
v_and_b32 v1, 0x40004000, v7
v_cmp_ne_u32 vcc, 0, v1
s_cbranch_vccnz L_k2_fb_fi
L_k2_fbr_fi:
Maav 0,192,96
Ra 224,2,57344
Ra 228,2,58368
Maav 0,196,100
Ra 232,2,59392
Ra 236,2,60416
Maav 4,200,96
Ra 240,2,61440
Ra 244,2,62464
Maav 4,204,100
Ra 248,2,63488
Ra 252,2,64512
Mvvv 48,16,96
s_mov_b32 s60, s8
s_and_b32 s61, s9, 0xffff
s_mov_b32 s62, 7340032
Mvvv 48,16,100
s_waitcnt lgkmcnt(8)
Maav 8,208,96
s_mov_b32 s63, 0x20000
s_mov_b32 s68, s10
s_and_b32 s69, s11, 0xffff
Maav 8,212,100
s_mov_b32 s70, 4194304
s_mov_b32 s71, 0x20000
s_mov_b32 s56, s40
Maav 12,216,96
s_and_b32 s57, s41, 0xffff
s_mov_b32 s58, 4194304
s_mov_b32 s59, 0x20000
Maav 12,220,100
s_waitcnt lgkmcnt(4)
Maav 16,224,96
s_bfe_u32 s6, s2, 0x20001
s_lshr_b32 s7, s34, 1
s_lshl_b32 s45, s7, 2
Maav 16,228,100
s_add_u32 s46, s45, s6
s_sub_u32 s46, 15, s46
s_sub_u32 s45, 12, s45
Maav 20,232,96
s_add_u32 s45, s45, s6
s_cmp_lt_u32 s7, 2
s_cselect_b32 s45, s46, s45
Maav 20,236,100
s_waitcnt lgkmcnt(0)
Maav 24,240,96
s_and_b32 s46, s2, 1
s_lshl_b32 s46, s46, 3
s_bfe_u32 s6, s2, 0x30003
Maav 24,244,100
s_add_u32 s46, s46, s6
s_mov_b32 s48, 0
s_mov_b32 s49, 15360
Maav 28,248,96
s_mov_b32 s50, 30720
s_mov_b32 s51, 46080
s_lshl_b32 s35, s32, 15
Maav 28,252,100
s_lshl_b32 s6, s45, 20
s_lshl_b32 s7, s32, 18
s_add_u32 s6, s6, s7
s_add_u32 s6, s6, 46137344
s_add_u32 s8, s66, s6
s_addc_u32 s9, s67, 0
s_and_b32 s9, s9, 0xffff
s_mov_b32 s10, 262144
s_mov_b32 s11, 0x20000
s_lshl_b32 s7, s46, 7
s_lshl_b32 s6, s32, 21
s_add_u32 s6, s6, s7
s_add_u32 s12, s94, s6
s_addc_u32 s13, s95, 0
s_and_b32 s13, s13, 0xffff
s_mov_b32 s14, 0
s_mov_b32 s15, 0x20000
s_sub_u32 s14, 2097152, s7
s_mov_b32 s28, s94
s_and_b32 s29, s95, 0xffff
s_mov_b32 s30, 8388608
s_mov_b32 s31, 0x20000
s_lshl_b32 s36, s45, 18
s_add_u32 s36, s36, s7
s_mov_b32 s52, 0
s_lshl_b32 s38, s45, 7
s_lshl_b32 s6, s32, 5
s_add_u32 s38, s38, s6
s_add_u32 s38, s38, 5300224
v_lshlrev_b32 v112, 4, v0
v_add_u32 v113, 4096, v112
v_lshrrev_b32 v121, 4, v0
v_and_b32 v122, 7, v0
v_lshrrev_b32 v123, 3, v0
v_lshlrev_b32 v124, 1, v121
v_xor_b32 v124, v124, v122
v_lshlrev_b32 v124, 4, v124
v_lshl_add_u32 v114, v123, 11, v124
v_lshrrev_b32_e64 v124, 2, v0
v_bfe_u32 v126, v0, 3, 2
v_lshlrev_b32 v124, 7, v124
v_and_b32 v125, 3, v0
v_lshl_add_u32 v124, v125, 3, v124
v_add_u32 v124, s35, v124
v_xor_b32 v125, 0, v126
v_lshl_add_u32 v115, v125, 5, v124
v_xor_b32_e64 v125, 1, v126
v_lshl_add_u32 v116, v125, 5, v124
v_xor_b32_e64 v125, 2, v126
v_lshl_add_u32 v117, v125, 5, v124
v_xor_b32_e64 v125, 3, v126
v_lshl_add_u32 v118, v125, 5, v124
s_lshl_b32 s6, s32, 3
v_add_u32 v120, s6, v123
v_lshlrev_b32_e64 v119, 11, v120
v_lshl_add_u32 v119, v122, 4, v119
v_mov_b32 v126, 0
v_lshlrev_b32 v127, 2, v122
s_nop 7
s_lshl_b32 s3, s55, 20
s_lshl_b32 s47, s33, 15
s_add_u32 s3, s3, s47
s_lshl_b32 s47, s32, 10
v_lshlrev_b32 v248, 4, v0
v_add_u32_e64 v249, s47, v248
s_sub_u32 s47, 7168, s47
v_add_u32 v248, s47, v248
v_rcp_f32 v250, v48
v_rcp_f32 v252, v52
v_mov_b32 v251, v250
v_mov_b32_e64 v253, v252
Ar 240,32
Ar 241,33
Ar 242,34
Ar 243,35
Ar 244,36
Ar 245,37
Ar 246,38
Ar 247,39
v_pk_mul_f32 v[240:241], v[240:241], v[252:253]
v_pk_mul_f32 v[242:243], v[242:243], v[252:253]
v_pk_mul_f32 v[244:245], v[244:245], v[252:253]
v_pk_mul_f32 v[246:247], v[246:247], v[252:253]
Vc 28,240,241
Vc 29,242,243
Vc 30,244,245
Vc 31,246,247
buffer_store_dwordx4 v[28:31], v249, s[16:19], s3 offen sc1
Ar 240,0
Ar 241,1
Ar 242,2
Ar 243,3
Ar 244,4
Ar 245,5
Ar 246,6
Ar 247,7
v_pk_mul_f32 v[240:241], v[240:241], v[250:251]
v_pk_mul_f32 v[242:243], v[242:243], v[250:251]
v_pk_mul_f32 v[244:245], v[244:245], v[250:251]
v_pk_mul_f32 v[246:247], v[246:247], v[250:251]
Vc 24,240,241
Vc 25,242,243
Vc 26,244,245
Vc 27,246,247
buffer_store_dwordx4 v[24:27], v248, s[16:19], s3 offen sc1
s_add_u32 s3, s3, 8192
Ar 240,40
Ar 241,41
Ar 242,42
Ar 243,43
Ar 244,44
Ar 245,45
Ar 246,46
Ar 247,47
v_pk_mul_f32 v[240:241], v[240:241], v[252:253]
v_pk_mul_f32 v[242:243], v[242:243], v[252:253]
v_pk_mul_f32 v[244:245], v[244:245], v[252:253]
v_pk_mul_f32 v[246:247], v[246:247], v[252:253]
Vc 28,240,241
Vc 29,242,243
Vc 30,244,245
Vc 31,246,247
buffer_store_dwordx4 v[28:31], v249, s[16:19], s3 offen sc1
Ar 240,8
Ar 241,9
Ar 242,10
Ar 243,11
Ar 244,12
Ar 245,13
Ar 246,14
Ar 247,15
v_pk_mul_f32 v[240:241], v[240:241], v[250:251]
v_pk_mul_f32 v[242:243], v[242:243], v[250:251]
v_pk_mul_f32 v[244:245], v[244:245], v[250:251]
v_pk_mul_f32 v[246:247], v[246:247], v[250:251]
Vc 24,240,241
Vc 25,242,243
Vc 26,244,245
Vc 27,246,247
buffer_store_dwordx4 v[24:27], v248, s[16:19], s3 offen sc1
s_add_u32 s3, s3, 8192
Ar 240,48
Ar 241,49
Ar 242,50
Ar 243,51
Ar 244,52
Ar 245,53
Ar 246,54
Ar 247,55
v_pk_mul_f32 v[240:241], v[240:241], v[252:253]
v_pk_mul_f32 v[242:243], v[242:243], v[252:253]
v_pk_mul_f32 v[244:245], v[244:245], v[252:253]
v_pk_mul_f32 v[246:247], v[246:247], v[252:253]
Vc 28,240,241
Vc 29,242,243
Vc 30,244,245
Vc 31,246,247
buffer_store_dwordx4 v[28:31], v249, s[16:19], s3 offen sc1
Ar 240,16
Ar 241,17
Ar 242,18
Ar 243,19
Ar 244,20
Ar 245,21
Ar 246,22
Ar 247,23
v_pk_mul_f32 v[240:241], v[240:241], v[250:251]
v_pk_mul_f32 v[242:243], v[242:243], v[250:251]
v_pk_mul_f32 v[244:245], v[244:245], v[250:251]
v_pk_mul_f32 v[246:247], v[246:247], v[250:251]
Vc 24,240,241
Vc 25,242,243
Vc 26,244,245
Vc 27,246,247
buffer_store_dwordx4 v[24:27], v248, s[16:19], s3 offen sc1
s_add_u32 s3, s3, 8192
Ar 240,56
Ar 241,57
Ar 242,58
Ar 243,59
Ar 244,60
Ar 245,61
Ar 246,62
Ar 247,63
v_pk_mul_f32 v[240:241], v[240:241], v[252:253]
v_pk_mul_f32 v[242:243], v[242:243], v[252:253]
v_pk_mul_f32 v[244:245], v[244:245], v[252:253]
v_pk_mul_f32 v[246:247], v[246:247], v[252:253]
Vc 28,240,241
Vc 29,242,243
Vc 30,244,245
Vc 31,246,247
buffer_store_dwordx4 v[28:31], v249, s[16:19], s3 offen sc1
Ar 240,24
Ar 241,25
Ar 242,26
Ar 243,27
Ar 244,28
Ar 245,29
Ar 246,30
Ar 247,31
v_pk_mul_f32 v[240:241], v[240:241], v[250:251]
v_pk_mul_f32 v[242:243], v[242:243], v[250:251]
v_pk_mul_f32 v[244:245], v[244:245], v[250:251]
v_pk_mul_f32 v[246:247], v[246:247], v[250:251]
Vc 24,240,241
Vc 25,242,243
Vc 26,244,245
Vc 27,246,247
buffer_store_dwordx4 v[24:27], v248, s[16:19], s3 offen sc1
s_nop 1
v_lshrrev_b32 v24, 4, v0
v_bfe_u32 v25, v0, 2, 2
v_lshl_add_u32 v26, v24, 3, v25
v_lshlrev_b32 v26, 8, v26
v_and_b32 v27, 3, v0
v_lshl_add_u32 v26, v27, 3, v26
v_and_b32_e64 v27, 1, v24
v_lshl_add_u32 v25, v27, 2, v25
s_lshl_b32 s3, s32, 1
v_xor_b32 v25, s3, v25
v_lshl_add_u32 v26, v25, 5, v26
s_sub_u32 s3, s54, s44
v_add_u32 v26, s3, v26
v_xor_b32 v27, 32, v26
s_waitcnt vmcnt(8) lgkmcnt(0)
s_barrier
s_nop 0
ds_read_b64_tr_b16 v[128:129], v26 offset:0
ds_read_b64_tr_b16 v[130:131], v26 offset:1024
ds_read_b64_tr_b16 v[132:133], v27 offset:0
ds_read_b64_tr_b16 v[134:135], v27 offset:1024
ds_read_b64_tr_b16 v[136:137], v26 offset:8192
ds_read_b64_tr_b16 v[138:139], v26 offset:9216
ds_read_b64_tr_b16 v[140:141], v27 offset:8192
ds_read_b64_tr_b16 v[142:143], v27 offset:9216
ds_read_b64_tr_b16 v[144:145], v26 offset:16384
ds_read_b64_tr_b16 v[146:147], v26 offset:17408
ds_read_b64_tr_b16 v[148:149], v27 offset:16384
ds_read_b64_tr_b16 v[150:151], v27 offset:17408
ds_read_b64_tr_b16 v[152:153], v26 offset:24576
ds_read_b64_tr_b16 v[154:155], v26 offset:25600
ds_read_b64_tr_b16 v[156:157], v27 offset:24576
s_waitcnt lgkmcnt(9)
s_nop 0
ds_read_b64_tr_b16 v[158:159], v27 offset:25600
ds_read_b64_tr_b16 v[160:161], v26 offset:32768
ds_read_b64_tr_b16 v[162:163], v26 offset:33792
ds_read_b64_tr_b16 v[164:165], v27 offset:32768
ds_read_b64_tr_b16 v[166:167], v27 offset:33792
ds_read_b64_tr_b16 v[168:169], v26 offset:40960
s_waitcnt lgkmcnt(9)
s_nop 0
ds_read_b64_tr_b16 v[170:171], v26 offset:41984
ds_read_b64_tr_b16 v[172:173], v27 offset:40960
ds_read_b64_tr_b16 v[174:175], v27 offset:41984
ds_read_b64_tr_b16 v[176:177], v26 offset:49152
ds_read_b64_tr_b16 v[178:179], v26 offset:50176
ds_read_b64_tr_b16 v[180:181], v27 offset:49152
s_waitcnt lgkmcnt(9)
ds_read_b64_tr_b16 v[182:183], v27 offset:50176
ds_read_b64_tr_b16 v[184:185], v26 offset:57344
ds_read_b64_tr_b16 v[186:187], v26 offset:58368
ds_read_b64_tr_b16 v[188:189], v27 offset:57344
ds_read_b64_tr_b16 v[190:191], v27 offset:58368
v_and_b32 v25, 15, v0
v_mul_u32_u24 v28, 14336, v25
v_lshl_add_u32 v28, v24, 4, v28
v_mov_b32 v29, 2146435072
v_cmp_gt_u32 vcc, 2, v25
s_mul_i32 s3, s92, 57344
s_lshl_b32 s47, s4, 9
s_add_u32 s3, s3, s47
v_cndmask_b32 v28, v29, v28, vcc
s_lshl_b32 s47, s32, 7
s_add_u32 s3, s3, s47
s_add_u32 s3, s3, 6291456
Zvva 224,128,160
Zvva 228,132,160
Mvva 224,136,164
Mvva 228,140,164
Mvva 224,144,168
Mvva 228,148,168
Mvva 224,152,172
Mvva 228,156,172
s_waitcnt lgkmcnt(0)
Zvva 232,160,160
Zvva 236,164,160
Mvva 232,168,164
Mvva 236,172,164
Mvva 232,176,168
Mvva 236,180,168
Mvva 232,184,172
Mvva 236,188,172
v_mov_b32 v24, 1
v_mul_u32_u24 v25, s65, v0
s_waitcnt vmcnt(0)
s_barrier
s_mov_b64 exec, 3
buffer_store_dword v24, v25, s[20:23], s64 offen sc1
s_mov_b64 exec, -1
s_cmp_lg_u32 s34, 0
s_cselect_b32 s3, s3, 8388608
s_add_u32 s7, s3, 28672
buffer_store_dwordx4 v[224:227], v28, s[20:23], s3 offen offset:0 sc1
buffer_store_dwordx4 v[228:231], v28, s[20:23], s3 offen offset:64 sc1
buffer_store_dwordx4 v[232:235], v28, s[20:23], s7 offen offset:0 sc1
buffer_store_dwordx4 v[236:239], v28, s[20:23], s7 offen offset:64 sc1
buffer_load_dword v124, v127, s[20:23], s38 offen sc1
s_add_u32 m0, s35, 0
s_nop 0
buffer_load_dwordx4 v114, s[12:15], s48 offen offset:0 lds
buffer_load_dwordx4 v114, s[12:15], s49 offen offset:1024 lds
buffer_load_dwordx4 v114, s[12:15], s50 offen offset:2048 lds
buffer_load_dwordx4 v114, s[12:15], s51 offen offset:3072 lds
v_add_u32 v114, 65536, v114
s_add_u32 m0, s35, 4096
s_nop 0
s_nop 0
buffer_load_dwordx4 v114, s[12:15], s48 offen offset:0 lds
buffer_load_dwordx4 v114, s[12:15], s49 offen offset:1024 lds
buffer_load_dwordx4 v114, s[12:15], s50 offen offset:2048 lds
buffer_load_dwordx4 v114, s[12:15], s51 offen offset:3072 lds
v_add_u32 v114, 65536, v114
s_add_u32 m0, s35, 8192
s_nop 0
s_nop 0
buffer_load_dwordx4 v114, s[12:15], s48 offen offset:0 lds
buffer_load_dwordx4 v114, s[12:15], s49 offen offset:1024 lds
buffer_load_dwordx4 v114, s[12:15], s50 offen offset:2048 lds
buffer_load_dwordx4 v114, s[12:15], s51 offen offset:3072 lds
v_add_u32 v114, 65536, v114
s_add_u32 m0, s35, 12288
s_nop 0
buffer_load_dwordx4 v114, s[12:15], s48 offen offset:0 lds
buffer_load_dwordx4 v114, s[12:15], s49 offen offset:1024 lds
buffer_load_dwordx4 v114, s[12:15], s50 offen offset:2048 lds
buffer_load_dwordx4 v114, s[12:15], s51 offen offset:3072 lds
v_add_u32 v114, 65536, v114
s_and_b32 s39, s2, 15
s_lshr_b32 s37, s2, 4
s_sub_u32 s37, s37, 2
s_lshl_b32 s54, s37, 2
s_add_u32 s54, s54, s32
s_lshl_b32 s3, s54, 17
s_lshl_b32 s7, s39, 7
s_add_u32 s3, s3, s7
s_cmp_ge_u32 s2, 32
s_cselect_b32 s3, s3, 2146435072
v_and_b32 v125, 0xffff, v114
v_add_u32 v125, s3, v125
s_mov_b32 s40, 0
s_waitcnt vmcnt(16)
v_cmp_ne_u32 vcc, 1, v124
s_cbranch_vccnz L_spinC
s_nop 0
L_spinCr:
buffer_load_dwordx4 a[0:3], v112, s[8:11], s52 offen offset:0 sc1
buffer_load_dwordx4 a[4:7], v112, s[8:11], s52 offen offset:1024 sc1
buffer_load_dwordx4 a[8:11], v112, s[8:11], s52 offen offset:2048 sc1
buffer_load_dwordx4 a[12:15], v112, s[8:11], s52 offen offset:3072 sc1
buffer_load_dwordx4 a[16:19], v113, s[8:11], s52 offen offset:0 sc1
buffer_load_dwordx4 a[20:23], v113, s[8:11], s52 offen offset:1024 sc1
buffer_load_dwordx4 a[24:27], v113, s[8:11], s52 offen offset:2048 sc1
buffer_load_dwordx4 a[28:31], v113, s[8:11], s52 offen offset:3072 sc1
s_add_u32 s52, s52, 8192
buffer_load_dwordx4 a[32:35], v112, s[8:11], s52 offen offset:0 sc1
buffer_load_dwordx4 a[36:39], v112, s[8:11], s52 offen offset:1024 sc1
buffer_load_dwordx4 a[40:43], v112, s[8:11], s52 offen offset:2048 sc1
buffer_load_dwordx4 a[44:47], v112, s[8:11], s52 offen offset:3072 sc1
buffer_load_dwordx4 a[48:51], v113, s[8:11], s52 offen offset:0 sc1
buffer_load_dwordx4 a[52:55], v113, s[8:11], s52 offen offset:1024 sc1
buffer_load_dwordx4 a[56:59], v113, s[8:11], s52 offen offset:2048 sc1
buffer_load_dwordx4 a[60:63], v113, s[8:11], s52 offen offset:3072 sc1
s_add_u32 s52, s52, 8192
buffer_load_dwordx4 a[64:67], v112, s[8:11], s52 offen offset:0 sc1
buffer_load_dwordx4 a[68:71], v112, s[8:11], s52 offen offset:1024 sc1
buffer_load_dwordx4 a[72:75], v112, s[8:11], s52 offen offset:2048 sc1
buffer_load_dwordx4 a[76:79], v112, s[8:11], s52 offen offset:3072 sc1
buffer_load_dwordx4 a[80:83], v113, s[8:11], s52 offen offset:0 sc1
buffer_load_dwordx4 a[84:87], v113, s[8:11], s52 offen offset:1024 sc1
buffer_load_dwordx4 a[88:91], v113, s[8:11], s52 offen offset:2048 sc1
buffer_load_dwordx4 a[92:95], v113, s[8:11], s52 offen offset:3072 sc1
s_add_u32 s52, s52, 8192
s_cmp_lg_u32 s40, 0
s_cbranch_scc1 L_nowd
s_add_u32 m0, s35, 16384
s_nop 0
s_nop 0
buffer_load_dwordx4 v125, s[60:63], s48 offen offset:0 lds
buffer_load_dwordx4 v125, s[60:63], s49 offen offset:1024 lds
buffer_load_dwordx4 v125, s[60:63], s50 offen offset:2048 lds
buffer_load_dwordx4 v125, s[60:63], s51 offen offset:3072 lds
v_add_u32 v125, 65536, v125
s_add_u32 m0, s35, 20480
s_nop 0
buffer_load_dwordx4 v125, s[60:63], s48 offen offset:0 lds
buffer_load_dwordx4 v125, s[60:63], s49 offen offset:1024 lds
buffer_load_dwordx4 v125, s[60:63], s50 offen offset:2048 lds
buffer_load_dwordx4 v125, s[60:63], s51 offen offset:3072 lds
L_nowd:
s_cmp_lt_u32 s2, 128
s_cbranch_scc1 L_noc3
s_bfe_u32 s3, s2, 0x40003
s_mul_i32 s3, s3, 65536
s_lshl_b32 s7, s32, 21
s_add_u32 s3, s3, s7
s_and_b32 s7, s2, 1
s_lshl_b32 s7, s7, 10
s_add_u32 s3, s3, s7
s_add_u32 s3, s3, 384
v_and_b32 v11, 31, v0
v_lshlrev_b32_e64 v11, 11, v11
buffer_load_dword v17, v11, s[28:31], s3 offen
L_noc3:
s_waitcnt vmcnt(36)
s_nop 0
Ta 128,115,0
Ta 130,115,2048
Ta 132,116,0
Ta 134,116,2048
Ta 136,117,0
Ta 138,117,2048
Ta 140,118,0
Ta 142,118,2048
s_waitcnt vmcnt(16) lgkmcnt(0)
Zvaa 128,128,0
s_add_u32 m0, s35, 0
Zvaa 132,132,0
buffer_load_dwordx4 v114, s[12:15], s48 offen offset:0 lds
Zvaa 136,136,0
Ta 144,115,4096
Ta 146,115,6144
Zvaa 140,140,0
buffer_load_dwordx4 v114, s[12:15], s49 offen offset:1024 lds
Zvaa 144,128,4
v_mov_b32_e64 v125, 1
Zvaa 148,132,4
s_lshl_b32 s6, s4, 3
s_add_u32 s6, s6, s92
s_lshl_b32 s6, s6, 2
Zvaa 152,136,4
buffer_load_dwordx4 v114, s[12:15], s50 offen offset:2048 lds
Zvaa 156,140,4
Ta 148,116,4096
Ta 150,116,6144
Zvaa 160,128,8
buffer_load_dwordx4 v114, s[12:15], s51 offen offset:3072 lds
Zvaa 164,132,8
v_add_u32 v114, 65536, v114
Zvaa 168,136,8
s_add_u32 s6, s6, 5302272
s_cmp_eq_u32 s32, 0
s_cselect_b32 s6, s6, s64
s_cmp_lg_u32 s34, 0
s_cselect_b32 s6, s6, 2146435072
Zvaa 172,140,8
buffer_load_dwordx4 a[96:99], v112, s[8:11], s52 offen offset:0 sc1
Zvaa 176,128,12
Ta 152,117,4096
Ta 154,117,6144
Zvaa 180,132,12
buffer_load_dwordx4 a[100:103], v112, s[8:11], s52 offen offset:1024 sc1
Zvaa 184,136,12
s_barrier
s_mov_b64 exec, 1
buffer_store_dword v125, v126, s[20:23], s6 offen sc1
s_mov_b64 exec, -1
Zvaa 188,140,12
Zvaa 192,128,16
buffer_load_dwordx4 a[104:107], v112, s[8:11], s52 offen offset:2048 sc1
Zvaa 196,132,16
Ta 156,118,4096
Ta 158,118,6144
Zvaa 200,136,16
buffer_load_dwordx4 a[108:111], v112, s[8:11], s52 offen offset:3072 sc1
Zvaa 204,140,16
Zvaa 208,128,20
Zvaa 212,132,20
buffer_load_dwordx4 a[112:115], v113, s[8:11], s52 offen offset:0 sc1
Zvaa 216,136,20
Zvaa 220,140,20
buffer_load_dwordx4 a[116:119], v113, s[8:11], s52 offen offset:1024 sc1
Zvaa 224,128,24
Zvaa 228,132,24
Zvaa 232,136,24
buffer_load_dwordx4 a[120:123], v113, s[8:11], s52 offen offset:2048 sc1
Zvaa 236,140,24
Zvaa 240,128,28
buffer_load_dwordx4 a[124:127], v113, s[8:11], s52 offen offset:3072 sc1
Zvaa 244,132,28
s_add_u32 s52, s52, 8192
Zvaa 248,136,28
Zvaa 252,140,28
s_waitcnt vmcnt(21) lgkmcnt(0)
Mvaa 128,144,32
s_add_u32 m0, s35, 4096
Mvaa 132,148,32
buffer_load_dwordx4 v114, s[12:15], s48 offen offset:0 lds
Mvaa 136,152,32
Ta 160,115,8192
Ta 162,115,10240
Mvaa 140,156,32
buffer_load_dwordx4 v114, s[12:15], s49 offen offset:1024 lds
Mvaa 144,144,36
s_mov_b32 s3, s36
Mvaa 148,148,36
buffer_load_dwordx4 v[18:21], v119, s[56:59], s3 offen
Mvaa 152,152,36
buffer_load_dwordx4 v114, s[12:15], s50 offen offset:2048 lds
Mvaa 156,156,36
Ta 164,116,8192
Ta 166,116,10240
Mvaa 160,144,40
buffer_load_dwordx4 v114, s[12:15], s51 offen offset:3072 lds
Mvaa 164,148,40
v_add_u32 v114, 65536, v114
Mvaa 168,152,40
s_add_u32 s3, s3, 65536
Mvaa 172,156,40
buffer_load_dwordx4 a[0:3], v112, s[8:11], s52 offen offset:0 sc1
Mvaa 176,144,44
Ta 168,117,8192
Ta 170,117,10240
Mvaa 180,148,44
buffer_load_dwordx4 a[4:7], v112, s[8:11], s52 offen offset:1024 sc1
Mvaa 184,152,44
buffer_load_dwordx4 v[22:25], v119, s[56:59], s3 offen
Mvaa 188,156,44
s_add_u32 s3, s3, 65536
Mvaa 192,144,48
buffer_load_dwordx4 a[8:11], v112, s[8:11], s52 offen offset:2048 sc1
Mvaa 196,148,48
Ta 172,118,8192
Ta 174,118,10240
Mvaa 200,152,48
buffer_load_dwordx4 a[12:15], v112, s[8:11], s52 offen offset:3072 sc1
Mvaa 204,156,48
buffer_load_dwordx4 v[26:29], v119, s[56:59], s3 offen
Mvaa 208,144,52
s_add_u32 s3, s3, 65536
Mvaa 212,148,52
buffer_load_dwordx4 a[16:19], v113, s[8:11], s52 offen offset:0 sc1
Mvaa 216,152,52
buffer_load_dwordx4 v[30:33], v119, s[56:59], s3 offen
Mvaa 220,156,52
buffer_load_dwordx4 a[20:23], v113, s[8:11], s52 offen offset:1024 sc1
Mvaa 224,144,56
s_lshl_b32 s3, s45, 10
s_add_u32 s3, s3, 5259264
v_lshlrev_b32_e64 v124, 3, v120
Mvaa 228,148,56
buffer_load_dwordx2 v[34:35], v124, s[20:23], s3 offen offset:0 sc1
Mvaa 232,152,56
buffer_load_dwordx4 a[24:27], v113, s[8:11], s52 offen offset:2048 sc1
Mvaa 236,156,56
buffer_load_dwordx2 v[36:37], v124, s[20:23], s3 offen offset:256 sc1
Mvaa 240,144,60
buffer_load_dwordx4 a[28:31], v113, s[8:11], s52 offen offset:3072 sc1
Mvaa 244,148,60
s_add_u32 s52, s52, 8192
Mvaa 248,152,60
buffer_load_dwordx2 v[38:39], v124, s[20:23], s3 offen offset:512 sc1
Mvaa 252,156,60
buffer_load_dwordx2 v[40:41], v124, s[20:23], s3 offen offset:768 sc1
s_waitcnt vmcnt(33) lgkmcnt(0)
Mvaa 128,160,64
s_add_u32 m0, s35, 8192
Mvaa 132,164,64
buffer_load_dwordx4 v114, s[12:15], s48 offen offset:0 lds
Mvaa 136,168,64
Ta 176,115,12288
Ta 178,115,14336
Mvaa 140,172,64
buffer_load_dwordx4 v114, s[12:15], s49 offen offset:1024 lds
Mvaa 144,160,68
s_lshl_b32 s40, s45, 7
s_lshl_b32 s3, s32, 3
s_or_b32 s40, s40, s3
Mvaa 148,164,68
s_and_b32 s3, s42, 0x798
s_and_b32 s47, s43, 0x798
s_cmp_eq_u32 s3, s40
s_cselect_b32 s53, 1, 0
s_cmp_eq_u32 s47, s40
s_cselect_b32 s53, 1, s53
s_mov_b32 s40, 0
Mvaa 152,168,68
buffer_load_dwordx4 v114, s[12:15], s50 offen offset:2048 lds
Mvaa 156,172,68
Ta 180,116,12288
Ta 182,116,14336
Mvaa 160,160,72
buffer_load_dwordx4 v114, s[12:15], s51 offen offset:3072 lds
Mvaa 164,164,72
v_add_u32 v114, 65536, v114
Mvaa 168,168,72
s_lshl_b32 s41, s46, 7
s_add_u32 s41, s41, 5304320
s_lshl_b32 s44, s46, 13
Mvaa 172,172,72
buffer_load_dwordx4 a[32:35], v112, s[8:11], s52 offen offset:0 sc1
Mvaa 176,160,76
Ta 184,117,12288
Ta 186,117,14336
Mvaa 180,164,76
buffer_load_dwordx4 a[36:39], v112, s[8:11], s52 offen offset:1024 sc1
Mvaa 184,168,76
s_add_u32 s44, s44, 5308416
Mvaa 188,172,76
Mvaa 192,160,80
buffer_load_dwordx4 a[40:43], v112, s[8:11], s52 offen offset:2048 sc1
Mvaa 196,164,80
Ta 188,118,12288
Ta 190,118,14336
Mvaa 200,168,80
buffer_load_dwordx4 a[44:47], v112, s[8:11], s52 offen offset:3072 sc1
Mvaa 204,172,80
Mvaa 208,160,84
Mvaa 212,164,84
buffer_load_dwordx4 a[48:51], v113, s[8:11], s52 offen offset:0 sc1
Mvaa 216,168,84
Mvaa 220,172,84
buffer_load_dwordx4 a[52:55], v113, s[8:11], s52 offen offset:1024 sc1
Mvaa 224,160,88
Mvaa 228,164,88
Mvaa 232,168,88
buffer_load_dwordx4 a[56:59], v113, s[8:11], s52 offen offset:2048 sc1
Mvaa 236,172,88
Mvaa 240,160,92
buffer_load_dwordx4 a[60:63], v113, s[8:11], s52 offen offset:3072 sc1
Mvaa 244,164,92
s_add_u32 s52, s52, 8192
Mvaa 248,168,92
Mvaa 252,172,92
s_waitcnt vmcnt(32) lgkmcnt(0)
Mvaa 128,176,96
s_add_u32 m0, s35, 12288
Mvaa 132,180,96
buffer_load_dwordx4 v114, s[12:15], s48 offen offset:0 lds
Mvaa 136,184,96
Ta 128,115,0
Ta 130,115,2048
Mvaa 140,188,96
buffer_load_dwordx4 v114, s[12:15], s49 offen offset:1024 lds
Mvaa 144,176,100
Mvaa 148,180,100
Mvaa 152,184,100
buffer_load_dwordx4 v114, s[12:15], s50 offen offset:2048 lds
Mvaa 156,188,100
Ta 132,116,0
Ta 134,116,2048
Mvaa 160,176,104
buffer_load_dwordx4 v114, s[12:15], s51 offen offset:3072 lds
Mvaa 164,180,104
v_add_u32 v114, 65536, v114
Mvaa 168,184,104
Mvaa 172,188,104
buffer_load_dwordx4 a[64:67], v112, s[8:11], s52 offen offset:0 sc1
Mvaa 176,176,108
Ta 136,117,0
Ta 138,117,2048
Mvaa 180,180,108
buffer_load_dwordx4 a[68:71], v112, s[8:11], s52 offen offset:1024 sc1
Mvaa 184,184,108
s_cmp_ge_u32 s2, 32
s_cbranch_scc1 L_f2A
L_f2Ar:
Mvaa 188,188,108
Mvaa 192,176,112
buffer_load_dwordx4 a[72:75], v112, s[8:11], s52 offen offset:2048 sc1
Mvaa 196,180,112
Ta 140,118,0
Ta 142,118,2048
Mvaa 200,184,112
buffer_load_dwordx4 a[76:79], v112, s[8:11], s52 offen offset:3072 sc1
Mvaa 204,188,112
Mvaa 208,176,116
Mvaa 212,180,116
buffer_load_dwordx4 a[80:83], v113, s[8:11], s52 offen offset:0 sc1
Mvaa 216,184,116
Mvaa 220,188,116
buffer_load_dwordx4 a[84:87], v113, s[8:11], s52 offen offset:1024 sc1
Mvaa 224,176,120
Mvaa 228,180,120
Mvaa 232,184,120
buffer_load_dwordx4 a[88:91], v113, s[8:11], s52 offen offset:2048 sc1
Mvaa 236,188,120
Mvaa 240,176,124
buffer_load_dwordx4 a[92:95], v113, s[8:11], s52 offen offset:3072 sc1
Mvaa 244,180,124
s_add_u32 s52, s52, 8192
Mvaa 248,184,124
Mvaa 252,188,124
s_waitcnt vmcnt(26) lgkmcnt(0)
Mvaa 128,128,0
s_add_u32 m0, s35, 0
Mvaa 132,132,0
buffer_load_dwordx4 v114, s[12:15], s48 offen offset:0 lds
Mvaa 136,136,0
Ta 144,115,4096
Ta 146,115,6144
Mvaa 140,140,0
buffer_load_dwordx4 v114, s[12:15], s49 offen offset:1024 lds
Mvaa 144,128,4
s_waitcnt vmcnt(26)
v_lshlrev_b32 v42, 16, v18
v_and_b32 v43, 0xffff0000, v18
Mvaa 148,132,4
v_lshlrev_b32_e64 v44, 16, v19
v_and_b32 v45, 0xffff0000, v19
Mvaa 152,136,4
buffer_load_dwordx4 v114, s[12:15], s50 offen offset:2048 lds
Mvaa 156,140,4
Ta 148,116,4096
Ta 150,116,6144
Mvaa 160,128,8
buffer_load_dwordx4 v114, s[12:15], s51 offen offset:3072 lds
Mvaa 164,132,8
v_add_u32 v114, 65536, v114
Mvaa 168,136,8
v_lshlrev_b32_e64 v46, 16, v20
v_and_b32 v47, 0xffff0000, v20
Mvaa 172,140,8
buffer_load_dwordx4 a[96:99], v112, s[8:11], s52 offen offset:0 sc1
Mvaa 176,128,12
Ta 152,117,4096
Ta 154,117,6144
Mvaa 180,132,12
buffer_load_dwordx4 a[100:103], v112, s[8:11], s52 offen offset:1024 sc1
Mvaa 184,136,12
v_lshlrev_b32_e64 v48, 16, v21
v_and_b32 v49, 0xffff0000, v21
Mvaa 188,140,12
Vs 42,42,34
Vs 43,43,34
Mvaa 192,128,16
buffer_load_dwordx4 a[104:107], v112, s[8:11], s52 offen offset:2048 sc1
Mvaa 196,132,16
Ta 156,118,4096
Ta 158,118,6144
Mvaa 200,136,16
buffer_load_dwordx4 a[108:111], v112, s[8:11], s52 offen offset:3072 sc1
Mvaa 204,140,16
Vs 44,44,34
Vs 45,45,34
Mvaa 208,128,20
Vs 46,46,34
Vs 47,47,34
Mvaa 212,132,20
buffer_load_dwordx4 a[112:115], v113, s[8:11], s52 offen offset:0 sc1
Mvaa 216,136,20
Vs 48,48,34
Vs 49,49,34
Mvaa 220,140,20
buffer_load_dwordx4 a[116:119], v113, s[8:11], s52 offen offset:1024 sc1
Mvaa 224,128,24
Vc 2,42,43
v_lshlrev_b32_e64 v42, 16, v2
Mvaa 228,132,24
v_and_b32 v43, 0xffff0000, v2
Vc 3,44,45
Mvaa 232,136,24
buffer_load_dwordx4 a[120:123], v113, s[8:11], s52 offen offset:2048 sc1
Mvaa 236,140,24
v_lshlrev_b32_e64 v44, 16, v3
v_and_b32 v45, 0xffff0000, v3
Mvaa 240,128,28
buffer_load_dwordx4 a[124:127], v113, s[8:11], s52 offen offset:3072 sc1
Mvaa 244,132,28
s_add_u32 s52, s52, 8192
Mvaa 248,136,28
Vc 4,46,47
v_lshlrev_b32_e64 v46, 16, v4
Mvaa 252,140,28
v_and_b32 v47, 0xffff0000, v4
Vc 5,48,49
s_waitcnt vmcnt(24) lgkmcnt(0)
Mvaa 128,144,32
s_add_u32 m0, s35, 4096
Mvaa 132,148,32
buffer_load_dwordx4 v114, s[12:15], s48 offen offset:0 lds
Mvaa 136,152,32
Ta 160,115,8192
Ta 162,115,10240
Mvaa 140,156,32
buffer_load_dwordx4 v114, s[12:15], s49 offen offset:1024 lds
Mvaa 144,144,36
v_lshlrev_b32 v48, 16, v5
v_and_b32 v49, 0xffff0000, v5
Mvaa 148,148,36
Vm 42,42,35
Vm 43,43,35
Mvaa 152,152,36
buffer_load_dwordx4 v114, s[12:15], s50 offen offset:2048 lds
Mvaa 156,156,36
Ta 164,116,8192
Ta 166,116,10240
Mvaa 160,144,40
buffer_load_dwordx4 v114, s[12:15], s51 offen offset:3072 lds
Mvaa 164,148,40
v_add_u32 v114, 65536, v114
Mvaa 168,152,40
Vm 44,44,35
Vm 45,45,35
Mvaa 172,156,40
buffer_load_dwordx4 a[0:3], v112, s[8:11], s52 offen offset:0 sc1
Mvaa 176,144,44
Ta 168,117,8192
Ta 170,117,10240
Mvaa 180,148,44
buffer_load_dwordx4 a[4:7], v112, s[8:11], s52 offen offset:1024 sc1
Mvaa 184,152,44
Vm 46,46,35
Vm 47,47,35
Mvaa 188,156,44
Vm 48,48,35
Vm 49,49,35
Mvaa 192,144,48
buffer_load_dwordx4 a[8:11], v112, s[8:11], s52 offen offset:2048 sc1
Mvaa 196,148,48
Ta 172,118,8192
Ta 174,118,10240
Mvaa 200,152,48
buffer_load_dwordx4 a[12:15], v112, s[8:11], s52 offen offset:3072 sc1
Mvaa 204,156,48
Vc 2,42,43
v_lshlrev_b32_e64 v42, 16, v2
Mvaa 208,144,52
v_and_b32 v43, 0xffff0000, v2
Vc 3,44,45
Mvaa 212,148,52
buffer_load_dwordx4 a[16:19], v113, s[8:11], s52 offen offset:0 sc1
Mvaa 216,152,52
v_lshlrev_b32_e64 v44, 16, v3
v_and_b32 v45, 0xffff0000, v3
Mvaa 220,156,52
buffer_load_dwordx4 a[20:23], v113, s[8:11], s52 offen offset:1024 sc1
Mvaa 224,144,56
Vc 4,46,47
v_lshlrev_b32_e64 v46, 16, v4
Mvaa 228,148,56
v_and_b32 v47, 0xffff0000, v4
Vc 5,48,49
Mvaa 232,152,56
buffer_load_dwordx4 a[24:27], v113, s[8:11], s52 offen offset:2048 sc1
Mvaa 236,156,56
v_lshlrev_b32_e64 v48, 16, v5
v_and_b32 v49, 0xffff0000, v5
Mvaa 240,144,60
buffer_load_dwordx4 a[28:31], v113, s[8:11], s52 offen offset:3072 sc1
Mvaa 244,148,60
s_add_u32 s52, s52, 8192
Mvaa 248,152,60
v_mul_f32 v2, 0xbfb8aa3b, v42
v_mul_f32 v3, 0xbfb8aa3b, v43
Mvaa 252,156,60
v_mul_f32 v4, 0xbfb8aa3b, v44
v_mul_f32 v5, 0xbfb8aa3b, v45
s_waitcnt vmcnt(24) lgkmcnt(0)
Mvaa 128,160,64
s_add_u32 m0, s35, 8192
Mvaa 132,164,64
buffer_load_dwordx4 v114, s[12:15], s48 offen offset:0 lds
Mvaa 136,168,64
Ta 176,115,12288
Ta 178,115,14336
Mvaa 140,172,64
buffer_load_dwordx4 v114, s[12:15], s49 offen offset:1024 lds
Mvaa 144,160,68
v_mul_f32 v6, 0xbfb8aa3b, v46
v_mul_f32 v7, 0xbfb8aa3b, v47
Mvaa 148,164,68
v_mul_f32 v8, 0xbfb8aa3b, v48
v_mul_f32 v9, 0xbfb8aa3b, v49
Mvaa 152,168,68
buffer_load_dwordx4 v114, s[12:15], s50 offen offset:2048 lds
Mvaa 156,172,68
Ta 180,116,12288
Ta 182,116,14336
Mvaa 160,160,72
buffer_load_dwordx4 v114, s[12:15], s51 offen offset:3072 lds
Mvaa 164,164,72
v_add_u32 v114, 65536, v114
Mvaa 168,168,72
Ve 2,2
Mvaa 172,172,72
buffer_load_dwordx4 a[32:35], v112, s[8:11], s52 offen offset:0 sc1
Mvaa 176,160,76
Ta 184,117,12288
Ta 186,117,14336
Mvaa 180,164,76
buffer_load_dwordx4 a[36:39], v112, s[8:11], s52 offen offset:1024 sc1
Mvaa 184,168,76
s_cmp_ge_u32 s2, 32
s_cbranch_scc1 L_f2B
L_f2Br:
Mvaa 188,172,76
VE 3,3
Mvaa 192,160,80
buffer_load_dwordx4 a[40:43], v112, s[8:11], s52 offen offset:2048 sc1
Mvaa 196,164,80
Ta 188,118,12288
Ta 190,118,14336
Mvaa 200,168,80
buffer_load_dwordx4 a[44:47], v112, s[8:11], s52 offen offset:3072 sc1
Mvaa 204,172,80
VE 4,4
Mvaa 208,160,84
VE 5,5
Mvaa 212,164,84
buffer_load_dwordx4 a[48:51], v113, s[8:11], s52 offen offset:0 sc1
Mvaa 216,168,84
VE 6,6
Mvaa 220,172,84
buffer_load_dwordx4 a[52:55], v113, s[8:11], s52 offen offset:1024 sc1
Mvaa 224,160,88
VE 7,7
Mvaa 228,164,88
VE 8,8
Mvaa 232,168,88
buffer_load_dwordx4 a[56:59], v113, s[8:11], s52 offen offset:2048 sc1
Mvaa 236,172,88
VE 9,9
Mvaa 240,160,92
buffer_load_dwordx4 a[60:63], v113, s[8:11], s52 offen offset:3072 sc1
Mvaa 244,164,92
s_add_u32 s52, s52, 8192
Mvaa 248,168,92
v_add_f32 v2, 1.0, v2
v_add_f32 v3, 1.0, v3
Mvaa 252,172,92
v_add_f32 v4, 1.0, v4
v_add_f32 v5, 1.0, v5
s_waitcnt vmcnt(24) lgkmcnt(0)
Mvaa 128,176,96
s_add_u32 m0, s35, 12288
Mvaa 132,180,96
buffer_load_dwordx4 v114, s[12:15], s48 offen offset:0 lds
Mvaa 136,184,96
Ta 128,115,0
Ta 130,115,2048
Mvaa 140,188,96
buffer_load_dwordx4 v114, s[12:15], s49 offen offset:1024 lds
Mvaa 144,176,100
v_add_f32 v6, 1.0, v6
v_add_f32_e64 v7, 1.0, v7
Mvaa 148,180,100
v_add_f32 v8, 1.0, v8
v_add_f32 v9, 1.0, v9
Mvaa 152,184,100
buffer_load_dwordx4 v114, s[12:15], s50 offen offset:2048 lds
Mvaa 156,188,100
Ta 132,116,0
Ta 134,116,2048
Mvaa 160,176,104
buffer_load_dwordx4 v114, s[12:15], s51 offen offset:3072 lds
Mvaa 164,180,104
v_add_u32 v114, 65536, v114
Mvaa 168,184,104
v_rcp_f32_e64 v2, v2
Mvaa 172,188,104
buffer_load_dwordx4 a[64:67], v112, s[8:11], s52 offen offset:0 sc1
Mvaa 176,176,108
Ta 136,117,0
Ta 138,117,2048
Mvaa 180,180,108
buffer_load_dwordx4 a[68:71], v112, s[8:11], s52 offen offset:1024 sc1
Mvaa 184,184,108
v_rcp_f32_e64 v3, v3
Mvaa 188,188,108
v_rcp_f32_e64 v4, v4
Mvaa 192,176,112
buffer_load_dwordx4 a[72:75], v112, s[8:11], s52 offen offset:2048 sc1
Mvaa 196,180,112
Ta 140,118,0
Ta 142,118,2048
Mvaa 200,184,112
buffer_load_dwordx4 a[76:79], v112, s[8:11], s52 offen offset:3072 sc1
Mvaa 204,188,112
v_rcp_f32_e64 v5, v5
Mvaa 208,176,116
v_rcp_f32_e64 v6, v6
Mvaa 212,180,116
buffer_load_dwordx4 a[80:83], v113, s[8:11], s52 offen offset:0 sc1
Mvaa 216,184,116
v_rcp_f32_e64 v7, v7
Mvaa 220,188,116
buffer_load_dwordx4 a[84:87], v113, s[8:11], s52 offen offset:1024 sc1
Mvaa 224,176,120
v_rcp_f32_e64 v8, v8
Mvaa 228,180,120
v_rcp_f32_e64 v9, v9
Mvaa 232,184,120
buffer_load_dwordx4 a[88:91], v113, s[8:11], s52 offen offset:2048 sc1
Mvaa 236,188,120
Vm 42,42,2
Vm 43,43,3
Mvaa 240,176,124
buffer_load_dwordx4 a[92:95], v113, s[8:11], s52 offen offset:3072 sc1
Mvaa 244,180,124
s_add_u32 s52, s52, 8192
Mvaa 248,184,124
Vm 44,44,4
Vm 45,45,5
Mvaa 252,188,124
Vm 46,46,6
Vm 47,47,7
s_waitcnt vmcnt(24) lgkmcnt(0)
Mvaa 128,128,0
s_add_u32 m0, s35, 0
Mvaa 132,132,0
buffer_load_dwordx4 v114, s[12:15], s48 offen offset:0 lds
Mvaa 136,136,0
Ta 144,115,4096
Ta 146,115,6144
Mvaa 140,140,0
buffer_load_dwordx4 v114, s[12:15], s49 offen offset:1024 lds
Mvaa 144,128,4
Vm 48,48,8
Vm 49,49,9
Mvaa 148,132,4
Vc 2,42,43
v_lshlrev_b32_e64 v42, 16, v2
Mvaa 152,136,4
buffer_load_dwordx4 v114, s[12:15], s50 offen offset:2048 lds
Mvaa 156,140,4
Ta 148,116,4096
Ta 150,116,6144
Mvaa 160,128,8
buffer_load_dwordx4 v114, s[12:15], s51 offen offset:3072 lds
Mvaa 164,132,8
v_add_u32 v114, 65536, v114
Mvaa 168,136,8
v_and_b32 v43, 0xffff0000, v2
Vc 3,44,45
Mvaa 172,140,8
buffer_load_dwordx4 a[96:99], v112, s[8:11], s52 offen offset:0 sc1
Mvaa 176,128,12
Ta 152,117,4096
Ta 154,117,6144
Mvaa 180,132,12
buffer_load_dwordx4 a[100:103], v112, s[8:11], s52 offen offset:1024 sc1
Mvaa 184,136,12
v_lshlrev_b32_e64 v44, 16, v3
v_and_b32 v45, 0xffff0000, v3
Mvaa 188,140,12
Vc 4,46,47
v_lshlrev_b32_e64 v46, 16, v4
Mvaa 192,128,16
buffer_load_dwordx4 a[104:107], v112, s[8:11], s52 offen offset:2048 sc1
Mvaa 196,132,16
Ta 156,118,4096
Ta 158,118,6144
Mvaa 200,136,16
buffer_load_dwordx4 a[108:111], v112, s[8:11], s52 offen offset:3072 sc1
Mvaa 204,140,16
v_and_b32 v47, 0xffff0000, v4
Vc 5,48,49
Mvaa 208,128,20
v_lshlrev_b32_e64 v48, 16, v5
v_and_b32 v49, 0xffff0000, v5
Mvaa 212,132,20
buffer_load_dwordx4 a[112:115], v113, s[8:11], s52 offen offset:0 sc1
Mvaa 216,136,20
v_lshlrev_b32_e64 v50, 16, v22
v_and_b32 v51, 0xffff0000, v22
Mvaa 220,140,20
buffer_load_dwordx4 a[116:119], v113, s[8:11], s52 offen offset:1024 sc1
Mvaa 224,128,24
v_lshlrev_b32_e64 v52, 16, v23
v_and_b32 v53, 0xffff0000, v23
Mvaa 228,132,24
v_lshlrev_b32_e64 v54, 16, v24
v_and_b32 v55, 0xffff0000, v24
Mvaa 232,136,24
buffer_load_dwordx4 a[120:123], v113, s[8:11], s52 offen offset:2048 sc1
Mvaa 236,140,24
v_lshlrev_b32_e64 v56, 16, v25
v_and_b32 v57, 0xffff0000, v25
Mvaa 240,128,28
buffer_load_dwordx4 a[124:127], v113, s[8:11], s52 offen offset:3072 sc1
Mvaa 244,132,28
s_add_u32 s52, s52, 8192
Mvaa 248,136,28
Vs 50,50,36
Vs 51,51,36
Mvaa 252,140,28
Vs 52,52,36
Vs 53,53,36
s_waitcnt vmcnt(24) lgkmcnt(0)
Mvaa 128,144,32
s_add_u32 m0, s35, 4096
Mvaa 132,148,32
buffer_load_dwordx4 v114, s[12:15], s48 offen offset:0 lds
Mvaa 136,152,32
Ta 160,115,8192
Ta 162,115,10240
Mvaa 140,156,32
buffer_load_dwordx4 v114, s[12:15], s49 offen offset:1024 lds
Mvaa 144,144,36
Vs 54,54,36
v_sub_f32_e64 v55, v55, v36
Mvaa 148,148,36
Vs 56,56,36
Vs 57,57,36
Mvaa 152,152,36
buffer_load_dwordx4 v114, s[12:15], s50 offen offset:2048 lds
Mvaa 156,156,36
Ta 164,116,8192
Ta 166,116,10240
Mvaa 160,144,40
buffer_load_dwordx4 v114, s[12:15], s51 offen offset:3072 lds
Mvaa 164,148,40
v_add_u32 v114, 65536, v114
Mvaa 168,152,40
Vc 2,50,51
v_lshlrev_b32_e64 v50, 16, v2
Mvaa 172,156,40
buffer_load_dwordx4 a[0:3], v112, s[8:11], s52 offen offset:0 sc1
Mvaa 176,144,44
Ta 168,117,8192
Ta 170,117,10240
Mvaa 180,148,44
buffer_load_dwordx4 a[4:7], v112, s[8:11], s52 offen offset:1024 sc1
Mvaa 184,152,44
s_cmp_ge_u32 s2, 32
s_cbranch_scc1 L_f2C
L_f2Cr:
Mvaa 188,156,44
v_and_b32 v51, 0xffff0000, v2
Vc 3,52,53
Mvaa 192,144,48
buffer_load_dwordx4 a[8:11], v112, s[8:11], s52 offen offset:2048 sc1
Mvaa 196,148,48
Ta 172,118,8192
Ta 174,118,10240
Mvaa 200,152,48
buffer_load_dwordx4 a[12:15], v112, s[8:11], s52 offen offset:3072 sc1
Mvaa 204,156,48
v_lshlrev_b32_e64 v52, 16, v3
v_and_b32 v53, 0xffff0000, v3
Mvaa 208,144,52
Vc 4,54,55
v_lshlrev_b32_e64 v54, 16, v4
Mvaa 212,148,52
buffer_load_dwordx4 a[16:19], v113, s[8:11], s52 offen offset:0 sc1
Mvaa 216,152,52
v_and_b32 v55, 0xffff0000, v4
Vc 5,56,57
Mvaa 220,156,52
buffer_load_dwordx4 a[20:23], v113, s[8:11], s52 offen offset:1024 sc1
Mvaa 224,144,56
v_lshlrev_b32_e64 v56, 16, v5
v_and_b32 v57, 0xffff0000, v5
Mvaa 228,148,56
Vm 50,50,37
Vm 51,51,37
Mvaa 232,152,56
buffer_load_dwordx4 a[24:27], v113, s[8:11], s52 offen offset:2048 sc1
Mvaa 236,156,56
Vm 52,52,37
Vm 53,53,37
Mvaa 240,144,60
buffer_load_dwordx4 a[28:31], v113, s[8:11], s52 offen offset:3072 sc1
Mvaa 244,148,60
s_add_u32 s52, s52, 8192
Mvaa 248,152,60
Vm 54,54,37
Vm 55,55,37
Mvaa 252,156,60
Vm 56,56,37
Vm 57,57,37
s_waitcnt vmcnt(24) lgkmcnt(0)
Mvaa 128,160,64
s_add_u32 m0, s35, 8192
Mvaa 132,164,64
buffer_load_dwordx4 v114, s[12:15], s48 offen offset:0 lds
Mvaa 136,168,64
Ta 176,115,12288
Ta 178,115,14336
Mvaa 140,172,64
buffer_load_dwordx4 v114, s[12:15], s49 offen offset:1024 lds
Mvaa 144,160,68
s_cmp_ge_u32 s2, 128
s_cbranch_scc1 L_c31
L_c31r:
Mvaa 148,164,68
Vc 2,50,51
v_lshlrev_b32_e64 v50, 16, v2
Mvaa 152,168,68
buffer_load_dwordx4 v114, s[12:15], s50 offen offset:2048 lds
Mvaa 156,172,68
Ta 180,116,12288
Ta 182,116,14336
Mvaa 160,160,72
buffer_load_dwordx4 v114, s[12:15], s51 offen offset:3072 lds
Mvaa 164,164,72
v_add_u32 v114, 65536, v114
Mvaa 168,168,72
v_and_b32 v51, 0xffff0000, v2
Vc 3,52,53
Mvaa 172,172,72
buffer_load_dwordx4 a[32:35], v112, s[8:11], s52 offen offset:0 sc1
Mvaa 176,160,76
Ta 184,117,12288
Ta 186,117,14336
Mvaa 180,164,76
buffer_load_dwordx4 a[36:39], v112, s[8:11], s52 offen offset:1024 sc1
Mvaa 184,168,76
v_lshlrev_b32_e64 v52, 16, v3
v_and_b32 v53, 0xffff0000, v3
Mvaa 188,172,76
Vc 4,54,55
v_lshlrev_b32_e64 v54, 16, v4
Mvaa 192,160,80
buffer_load_dwordx4 a[40:43], v112, s[8:11], s52 offen offset:2048 sc1
Mvaa 196,164,80
Ta 188,118,12288
Ta 190,118,14336
Mvaa 200,168,80
buffer_load_dwordx4 a[44:47], v112, s[8:11], s52 offen offset:3072 sc1
Mvaa 204,172,80
v_and_b32 v55, 0xffff0000, v4
Vc 5,56,57
Mvaa 208,160,84
v_lshlrev_b32_e64 v56, 16, v5
v_and_b32 v57, 0xffff0000, v5
Mvaa 212,164,84
buffer_load_dwordx4 a[48:51], v113, s[8:11], s52 offen offset:0 sc1
Mvaa 216,168,84
v_mul_f32 v2, 0xbfb8aa3b, v50
v_mul_f32 v3, 0xbfb8aa3b, v51
Mvaa 220,172,84
buffer_load_dwordx4 a[52:55], v113, s[8:11], s52 offen offset:1024 sc1
Mvaa 224,160,88
v_mul_f32 v4, 0xbfb8aa3b, v52
v_mul_f32 v5, 0xbfb8aa3b, v53
Mvaa 228,164,88
v_mul_f32 v6, 0xbfb8aa3b, v54
v_mul_f32 v7, 0xbfb8aa3b, v55
Mvaa 232,168,88
buffer_load_dwordx4 a[56:59], v113, s[8:11], s52 offen offset:2048 sc1
Mvaa 236,172,88
v_mul_f32 v8, 0xbfb8aa3b, v56
v_mul_f32 v9, 0xbfb8aa3b, v57
Mvaa 240,160,92
buffer_load_dwordx4 a[60:63], v113, s[8:11], s52 offen offset:3072 sc1
Mvaa 244,164,92
s_add_u32 s52, s52, 8192
Mvaa 248,168,92
VE 2,2
Mvaa 252,172,92
Ve 3,3
s_waitcnt vmcnt(24) lgkmcnt(0)
Mvaa 128,176,96
s_add_u32 m0, s35, 12288
Mvaa 132,180,96
buffer_load_dwordx4 v114, s[12:15], s48 offen offset:0 lds
Mvaa 136,184,96
Ta 128,115,0
Ta 130,115,2048
Mvaa 140,188,96
buffer_load_dwordx4 v114, s[12:15], s49 offen offset:1024 lds
Mvaa 144,176,100
VE 4,4
Mvaa 148,180,100
VE 5,5
Mvaa 152,184,100
buffer_load_dwordx4 v114, s[12:15], s50 offen offset:2048 lds
Mvaa 156,188,100
Ta 132,116,0
Ta 134,116,2048
Mvaa 160,176,104
buffer_load_dwordx4 v114, s[12:15], s51 offen offset:3072 lds
Mvaa 164,180,104
v_add_u32 v114, 65536, v114
Mvaa 168,184,104
VE 6,6
Mvaa 172,188,104
buffer_load_dwordx4 a[64:67], v112, s[8:11], s52 offen offset:0 sc1
Mvaa 176,176,108
Ta 136,117,0
Ta 138,117,2048
Mvaa 180,180,108
buffer_load_dwordx4 a[68:71], v112, s[8:11], s52 offen offset:1024 sc1
Mvaa 184,184,108
VE 7,7
Mvaa 188,188,108
VE 8,8
Mvaa 192,176,112
buffer_load_dwordx4 a[72:75], v112, s[8:11], s52 offen offset:2048 sc1
Mvaa 196,180,112
Ta 140,118,0
Ta 142,118,2048
Mvaa 200,184,112
buffer_load_dwordx4 a[76:79], v112, s[8:11], s52 offen offset:3072 sc1
Mvaa 204,188,112
VE 9,9
Mvaa 208,176,116
v_add_f32 v2, 1.0, v2
v_add_f32 v3, 1.0, v3
Mvaa 212,180,116
buffer_load_dwordx4 a[80:83], v113, s[8:11], s52 offen offset:0 sc1
Mvaa 216,184,116
v_add_f32 v4, 1.0, v4
v_add_f32 v5, 1.0, v5
Mvaa 220,188,116
buffer_load_dwordx4 a[84:87], v113, s[8:11], s52 offen offset:1024 sc1
Mvaa 224,176,120
v_add_f32 v6, 1.0, v6
v_add_f32 v7, 1.0, v7
Mvaa 228,180,120
v_add_f32 v8, 1.0, v8
v_add_f32 v9, 1.0, v9
Mvaa 232,184,120
buffer_load_dwordx4 a[88:91], v113, s[8:11], s52 offen offset:2048 sc1
Mvaa 236,188,120
v_rcp_f32_e64 v2, v2
Mvaa 240,176,124
buffer_load_dwordx4 a[92:95], v113, s[8:11], s52 offen offset:3072 sc1
Mvaa 244,180,124
s_add_u32 s52, s52, 8192
Mvaa 248,184,124
v_rcp_f32_e64 v3, v3
Mvaa 252,188,124
v_rcp_f32 v4, v4
s_waitcnt vmcnt(24) lgkmcnt(0)
Mvaa 128,128,0
s_add_u32 m0, s35, 0
Mvaa 132,132,0
buffer_load_dwordx4 v114, s[12:15], s48 offen offset:0 lds
Mvaa 136,136,0
Ta 144,115,4096
Ta 146,115,6144
Mvaa 140,140,0
buffer_load_dwordx4 v114, s[12:15], s49 offen offset:1024 lds
Mvaa 144,128,4
v_rcp_f32 v5, v5
Mvaa 148,132,4
v_rcp_f32_e64 v6, v6
Mvaa 152,136,4
buffer_load_dwordx4 v114, s[12:15], s50 offen offset:2048 lds
Mvaa 156,140,4
Ta 148,116,4096
Ta 150,116,6144
Mvaa 160,128,8
buffer_load_dwordx4 v114, s[12:15], s51 offen offset:3072 lds
Mvaa 164,132,8
v_add_u32 v114, 65536, v114
Mvaa 168,136,8
v_rcp_f32_e64 v7, v7
Mvaa 172,140,8
buffer_load_dwordx4 a[96:99], v112, s[8:11], s52 offen offset:0 sc1
Mvaa 176,128,12
Ta 152,117,4096
Ta 154,117,6144
Mvaa 180,132,12
buffer_load_dwordx4 a[100:103], v112, s[8:11], s52 offen offset:1024 sc1
Mvaa 184,136,12
v_rcp_f32_e64 v8, v8
Mvaa 188,140,12
v_rcp_f32_e64 v9, v9
Mvaa 192,128,16
buffer_load_dwordx4 a[104:107], v112, s[8:11], s52 offen offset:2048 sc1
Mvaa 196,132,16
Ta 156,118,4096
Ta 158,118,6144
Mvaa 200,136,16
buffer_load_dwordx4 a[108:111], v112, s[8:11], s52 offen offset:3072 sc1
Mvaa 204,140,16
Vm 50,50,2
Vm 51,51,3
Mvaa 208,128,20
s_cmp_ge_u32 s2, 32
s_cbranch_scc1 L_f2E
L_f2Er:
Mvaa 212,132,20
buffer_load_dwordx4 a[112:115], v113, s[8:11], s52 offen offset:0 sc1
Mvaa 216,136,20
Vm 52,52,4
Vm 53,53,5
Mvaa 220,140,20
buffer_load_dwordx4 a[116:119], v113, s[8:11], s52 offen offset:1024 sc1
Mvaa 224,128,24
Vm 54,54,6
Vm 55,55,7
Mvaa 228,132,24
Vm 56,56,8
Vm 57,57,9
Mvaa 232,136,24
buffer_load_dwordx4 a[120:123], v113, s[8:11], s52 offen offset:2048 sc1
Mvaa 236,140,24
Vc 2,50,51
v_lshlrev_b32_e64 v50, 16, v2
Mvaa 240,128,28
buffer_load_dwordx4 a[124:127], v113, s[8:11], s52 offen offset:3072 sc1
Mvaa 244,132,28
s_add_u32 s52, s52, 8192
Mvaa 248,136,28
v_and_b32 v51, 0xffff0000, v2
Vc 3,52,53
Mvaa 252,140,28
v_lshlrev_b32_e64 v52, 16, v3
v_and_b32 v53, 0xffff0000, v3
s_waitcnt vmcnt(24) lgkmcnt(0)
Mvaa 128,144,32
s_add_u32 m0, s35, 4096
Mvaa 132,148,32
buffer_load_dwordx4 v114, s[12:15], s48 offen offset:0 lds
Mvaa 136,152,32
Ta 160,115,8192
Ta 162,115,10240
Mvaa 140,156,32
buffer_load_dwordx4 v114, s[12:15], s49 offen offset:1024 lds
Mvaa 144,144,36
Vc 4,54,55
v_lshlrev_b32 v54, 16, v4
Mvaa 148,148,36
v_and_b32 v55, 0xffff0000, v4
Vc 5,56,57
Mvaa 152,152,36
buffer_load_dwordx4 v114, s[12:15], s50 offen offset:2048 lds
Mvaa 156,156,36
Ta 164,116,8192
Ta 166,116,10240
Mvaa 160,144,40
buffer_load_dwordx4 v114, s[12:15], s51 offen offset:3072 lds
Mvaa 164,148,40
v_add_u32 v114, 65536, v114
Mvaa 168,152,40
v_lshlrev_b32_e64 v56, 16, v5
v_and_b32 v57, 0xffff0000, v5
Mvaa 172,156,40
buffer_load_dwordx4 a[0:3], v112, s[8:11], s52 offen offset:0 sc1
Mvaa 176,144,44
Ta 168,117,8192
Ta 170,117,10240
Mvaa 180,148,44
buffer_load_dwordx4 a[4:7], v112, s[8:11], s52 offen offset:1024 sc1
Mvaa 184,152,44
v_lshlrev_b32_e64 v58, 16, v26
v_and_b32 v59, 0xffff0000, v26
Mvaa 188,156,44
v_lshlrev_b32_e64 v60, 16, v27
v_and_b32 v61, 0xffff0000, v27
Mvaa 192,144,48
buffer_load_dwordx4 a[8:11], v112, s[8:11], s52 offen offset:2048 sc1
Mvaa 196,148,48
Ta 172,118,8192
Ta 174,118,10240
Mvaa 200,152,48
buffer_load_dwordx4 a[12:15], v112, s[8:11], s52 offen offset:3072 sc1
Mvaa 204,156,48
v_lshlrev_b32_e64 v62, 16, v28
v_and_b32 v63, 0xffff0000, v28
Mvaa 208,144,52
v_lshlrev_b32_e64 v64, 16, v29
v_and_b32 v65, 0xffff0000, v29
Mvaa 212,148,52
buffer_load_dwordx4 a[16:19], v113, s[8:11], s52 offen offset:0 sc1
Mvaa 216,152,52
Vs 58,58,38
Vs 59,59,38
Mvaa 220,156,52
buffer_load_dwordx4 a[20:23], v113, s[8:11], s52 offen offset:1024 sc1
Mvaa 224,144,56
Vs 60,60,38
Vs 61,61,38
Mvaa 228,148,56
Vs 62,62,38
Vs 63,63,38
Mvaa 232,152,56
buffer_load_dwordx4 a[24:27], v113, s[8:11], s52 offen offset:2048 sc1
Mvaa 236,156,56
Vs 64,64,38
Vs 65,65,38
Mvaa 240,144,60
buffer_load_dwordx4 a[28:31], v113, s[8:11], s52 offen offset:3072 sc1
Mvaa 244,148,60
s_add_u32 s52, s52, 8192
Mvaa 248,152,60
Vc 2,58,59
v_lshlrev_b32_e64 v58, 16, v2
Mvaa 252,156,60
v_and_b32 v59, 0xffff0000, v2
Vc 3,60,61
s_waitcnt vmcnt(24) lgkmcnt(0)
Mvaa 128,160,64
s_add_u32 m0, s35, 8192
Mvaa 132,164,64
buffer_load_dwordx4 v114, s[12:15], s48 offen offset:0 lds
Mvaa 136,168,64
Ta 176,115,12288
Ta 178,115,14336
Mvaa 140,172,64
buffer_load_dwordx4 v114, s[12:15], s49 offen offset:1024 lds
Mvaa 144,160,68
v_lshlrev_b32 v60, 16, v3
v_and_b32 v61, 0xffff0000, v3
Mvaa 148,164,68
Vc 4,62,63
v_lshlrev_b32_e64 v62, 16, v4
Mvaa 152,168,68
buffer_load_dwordx4 v114, s[12:15], s50 offen offset:2048 lds
Mvaa 156,172,68
Ta 180,116,12288
Ta 182,116,14336
Mvaa 160,160,72
buffer_load_dwordx4 v114, s[12:15], s51 offen offset:3072 lds
Mvaa 164,164,72
v_add_u32 v114, 65536, v114
Mvaa 168,168,72
v_and_b32 v63, 0xffff0000, v4
Vc 5,64,65
Mvaa 172,172,72
buffer_load_dwordx4 a[32:35], v112, s[8:11], s52 offen offset:0 sc1
Mvaa 176,160,76
Ta 184,117,12288
Ta 186,117,14336
Mvaa 180,164,76
buffer_load_dwordx4 a[36:39], v112, s[8:11], s52 offen offset:1024 sc1
Mvaa 184,168,76
v_lshlrev_b32_e64 v64, 16, v5
v_and_b32 v65, 0xffff0000, v5
Mvaa 188,172,76
Vm 58,58,39
Vm 59,59,39
Mvaa 192,160,80
buffer_load_dwordx4 a[40:43], v112, s[8:11], s52 offen offset:2048 sc1
Mvaa 196,164,80
Ta 188,118,12288
Ta 190,118,14336
Mvaa 200,168,80
buffer_load_dwordx4 a[44:47], v112, s[8:11], s52 offen offset:3072 sc1
Mvaa 204,172,80
Vm 60,60,39
Vm 61,61,39
Mvaa 208,160,84
Vm 62,62,39
Vm 63,63,39
Mvaa 212,164,84
buffer_load_dwordx4 a[48:51], v113, s[8:11], s52 offen offset:0 sc1
Mvaa 216,168,84
Vm 64,64,39
Vm 65,65,39
Mvaa 220,172,84
buffer_load_dwordx4 a[52:55], v113, s[8:11], s52 offen offset:1024 sc1
Mvaa 224,160,88
Vc 2,58,59
v_lshlrev_b32_e64 v58, 16, v2
Mvaa 228,164,88
v_and_b32 v59, 0xffff0000, v2
Vc 3,60,61
Mvaa 232,168,88
buffer_load_dwordx4 a[56:59], v113, s[8:11], s52 offen offset:2048 sc1
Mvaa 236,172,88
v_lshlrev_b32_e64 v60, 16, v3
v_and_b32 v61, 0xffff0000, v3
Mvaa 240,160,92
buffer_load_dwordx4 a[60:63], v113, s[8:11], s52 offen offset:3072 sc1
Mvaa 244,164,92
s_add_u32 s52, s52, 8192
Mvaa 248,168,92
Vc 4,62,63
v_lshlrev_b32_e64 v62, 16, v4
Mvaa 252,172,92
v_and_b32 v63, 0xffff0000, v4
Vc 5,64,65
s_waitcnt vmcnt(24) lgkmcnt(0)
Mvaa 128,176,96
s_add_u32 m0, s35, 12288
Mvaa 132,180,96
buffer_load_dwordx4 v114, s[12:15], s48 offen offset:0 lds
Mvaa 136,184,96
Ta 128,115,0
Ta 130,115,2048
Mvaa 140,188,96
buffer_load_dwordx4 v114, s[12:15], s49 offen offset:1024 lds
Mvaa 144,176,100
v_lshlrev_b32 v64, 16, v5
v_and_b32 v65, 0xffff0000, v5
Mvaa 148,180,100
v_mul_f32 v2, 0xbfb8aa3b, v58
v_mul_f32 v3, 0xbfb8aa3b, v59
Mvaa 152,184,100
buffer_load_dwordx4 v114, s[12:15], s50 offen offset:2048 lds
Mvaa 156,188,100
Ta 132,116,0
Ta 134,116,2048
Mvaa 160,176,104
buffer_load_dwordx4 v114, s[12:15], s51 offen offset:3072 lds
Mvaa 164,180,104
v_add_u32 v114, 65536, v114
Mvaa 168,184,104
v_mul_f32 v4, 0xbfb8aa3b, v60
v_mul_f32 v5, 0xbfb8aa3b, v61
Mvaa 172,188,104
buffer_load_dwordx4 a[64:67], v112, s[8:11], s52 offen offset:0 sc1
Mvaa 176,176,108
Ta 136,117,0
Ta 138,117,2048
Mvaa 180,180,108
buffer_load_dwordx4 a[68:71], v112, s[8:11], s52 offen offset:1024 sc1
Mvaa 184,184,108
v_mul_f32 v6, 0xbfb8aa3b, v62
v_mul_f32 v7, 0xbfb8aa3b, v63
Mvaa 188,188,108
v_mul_f32 v8, 0xbfb8aa3b, v64
v_mul_f32 v9, 0xbfb8aa3b, v65
Mvaa 192,176,112
buffer_load_dwordx4 a[72:75], v112, s[8:11], s52 offen offset:2048 sc1
Mvaa 196,180,112
Ta 140,118,0
Ta 142,118,2048
Mvaa 200,184,112
buffer_load_dwordx4 a[76:79], v112, s[8:11], s52 offen offset:3072 sc1
Mvaa 204,188,112
VE 2,2
Mvaa 208,176,116
VE 3,3
Mvaa 212,180,116
buffer_load_dwordx4 a[80:83], v113, s[8:11], s52 offen offset:0 sc1
Mvaa 216,184,116
VE 4,4
Mvaa 220,188,116
buffer_load_dwordx4 a[84:87], v113, s[8:11], s52 offen offset:1024 sc1
Mvaa 224,176,120
VE 5,5
Mvaa 228,180,120
VE 6,6
Mvaa 232,184,120
buffer_load_dwordx4 a[88:91], v113, s[8:11], s52 offen offset:2048 sc1
Mvaa 236,188,120
VE 7,7
Mvaa 240,176,124
buffer_load_dwordx4 a[92:95], v113, s[8:11], s52 offen offset:3072 sc1
Mvaa 244,180,124
s_add_u32 s52, s52, 8192
Mvaa 248,184,124
VE 8,8
Mvaa 252,188,124
Ve 9,9
s_waitcnt vmcnt(24) lgkmcnt(0)
Mvaa 128,128,0
s_add_u32 m0, s35, 0
Mvaa 132,132,0
buffer_load_dwordx4 v114, s[12:15], s48 offen offset:0 lds
Mvaa 136,136,0
Ta 144,115,4096
Ta 146,115,6144
Mvaa 140,140,0
buffer_load_dwordx4 v114, s[12:15], s49 offen offset:1024 lds
Mvaa 144,128,4
v_add_f32 v2, 1.0, v2
v_add_f32_e64 v3, 1.0, v3
Mvaa 148,132,4
v_add_f32 v4, 1.0, v4
v_add_f32 v5, 1.0, v5
Mvaa 152,136,4
buffer_load_dwordx4 v114, s[12:15], s50 offen offset:2048 lds
Mvaa 156,140,4
Ta 148,116,4096
Ta 150,116,6144
Mvaa 160,128,8
buffer_load_dwordx4 v114, s[12:15], s51 offen offset:3072 lds
Mvaa 164,132,8
v_add_u32 v114, 65536, v114
Mvaa 168,136,8
v_add_f32 v6, 1.0, v6
v_add_f32 v7, 1.0, v7
Mvaa 172,140,8
buffer_load_dwordx4 a[96:99], v112, s[8:11], s52 offen offset:0 sc1
Mvaa 176,128,12
Ta 152,117,4096
Ta 154,117,6144
Mvaa 180,132,12
buffer_load_dwordx4 a[100:103], v112, s[8:11], s52 offen offset:1024 sc1
Mvaa 184,136,12
v_add_f32 v8, 1.0, v8
v_add_f32 v9, 1.0, v9
Mvaa 188,140,12
v_rcp_f32_e64 v2, v2
Mvaa 192,128,16
buffer_load_dwordx4 a[104:107], v112, s[8:11], s52 offen offset:2048 sc1
Mvaa 196,132,16
Ta 156,118,4096
Ta 158,118,6144
Mvaa 200,136,16
buffer_load_dwordx4 a[108:111], v112, s[8:11], s52 offen offset:3072 sc1
Mvaa 204,140,16
v_rcp_f32_e64 v3, v3
Mvaa 208,128,20
v_rcp_f32_e64 v4, v4
Mvaa 212,132,20
buffer_load_dwordx4 a[112:115], v113, s[8:11], s52 offen offset:0 sc1
Mvaa 216,136,20
v_rcp_f32_e64 v5, v5
Mvaa 220,140,20
buffer_load_dwordx4 a[116:119], v113, s[8:11], s52 offen offset:1024 sc1
Mvaa 224,128,24
v_rcp_f32_e64 v6, v6
Mvaa 228,132,24
v_rcp_f32_e64 v7, v7
Mvaa 232,136,24
buffer_load_dwordx4 a[120:123], v113, s[8:11], s52 offen offset:2048 sc1
Mvaa 236,140,24
v_rcp_f32_e64 v8, v8
Mvaa 240,128,28
buffer_load_dwordx4 a[124:127], v113, s[8:11], s52 offen offset:3072 sc1
Mvaa 244,132,28
s_add_u32 s52, s52, 8192
Mvaa 248,136,28
v_rcp_f32_e64 v9, v9
Mvaa 252,140,28
Vm 58,58,2
Vm 59,59,3
s_waitcnt vmcnt(24) lgkmcnt(0)
Mvaa 128,144,32
s_add_u32 m0, s35, 4096
Mvaa 132,148,32
buffer_load_dwordx4 v114, s[12:15], s48 offen offset:0 lds
Mvaa 136,152,32
Ta 160,115,8192
Ta 162,115,10240
Mvaa 140,156,32
buffer_load_dwordx4 v114, s[12:15], s49 offen offset:1024 lds
Mvaa 144,144,36
Vm 60,60,4
v_mul_f32_e64 v61, v61, v5
Mvaa 148,148,36
Vm 62,62,6
Vm 63,63,7
Mvaa 152,152,36
buffer_load_dwordx4 v114, s[12:15], s50 offen offset:2048 lds
Mvaa 156,156,36
Ta 164,116,8192
Ta 166,116,10240
Mvaa 160,144,40
buffer_load_dwordx4 v114, s[12:15], s51 offen offset:3072 lds
Mvaa 164,148,40
v_add_u32 v114, 65536, v114
Mvaa 168,152,40
Vm 64,64,8
Vm 65,65,9
Mvaa 172,156,40
buffer_load_dwordx4 a[0:3], v112, s[8:11], s52 offen offset:0 sc1
Mvaa 176,144,44
Ta 168,117,8192
Ta 170,117,10240
Mvaa 180,148,44
buffer_load_dwordx4 a[4:7], v112, s[8:11], s52 offen offset:1024 sc1
Mvaa 184,152,44
Vc 2,58,59
v_lshlrev_b32_e64 v58, 16, v2
Mvaa 188,156,44
v_and_b32 v59, 0xffff0000, v2
Vc 3,60,61
Mvaa 192,144,48
buffer_load_dwordx4 a[8:11], v112, s[8:11], s52 offen offset:2048 sc1
Mvaa 196,148,48
Ta 172,118,8192
Ta 174,118,10240
Mvaa 200,152,48
buffer_load_dwordx4 a[12:15], v112, s[8:11], s52 offen offset:3072 sc1
Mvaa 204,156,48
v_lshlrev_b32_e64 v60, 16, v3
v_and_b32 v61, 0xffff0000, v3
Mvaa 208,144,52
Vc 4,62,63
v_lshlrev_b32_e64 v62, 16, v4
Mvaa 212,148,52
buffer_load_dwordx4 a[16:19], v113, s[8:11], s52 offen offset:0 sc1
Mvaa 216,152,52
v_and_b32 v63, 0xffff0000, v4
Vc 5,64,65
Mvaa 220,156,52
buffer_load_dwordx4 a[20:23], v113, s[8:11], s52 offen offset:1024 sc1
Mvaa 224,144,56
v_lshlrev_b32_e64 v64, 16, v5
v_and_b32 v65, 0xffff0000, v5
Mvaa 228,148,56
v_lshlrev_b32_e64 v66, 16, v30
v_and_b32 v67, 0xffff0000, v30
Mvaa 232,152,56
buffer_load_dwordx4 a[24:27], v113, s[8:11], s52 offen offset:2048 sc1
Mvaa 236,156,56
v_lshlrev_b32_e64 v68, 16, v31
v_and_b32 v69, 0xffff0000, v31
Mvaa 240,144,60
buffer_load_dwordx4 a[28:31], v113, s[8:11], s52 offen offset:3072 sc1
Mvaa 244,148,60
s_add_u32 s52, s52, 8192
Mvaa 248,152,60
v_lshlrev_b32_e64 v70, 16, v32
v_and_b32 v71, 0xffff0000, v32
Mvaa 252,156,60
v_lshlrev_b32_e64 v72, 16, v33
v_and_b32 v73, 0xffff0000, v33
s_waitcnt vmcnt(24) lgkmcnt(0)
Mvaa 128,160,64
s_add_u32 m0, s35, 8192
Mvaa 132,164,64
buffer_load_dwordx4 v114, s[12:15], s48 offen offset:0 lds
Mvaa 136,168,64
Ta 176,115,12288
Ta 178,115,14336
Mvaa 140,172,64
buffer_load_dwordx4 v114, s[12:15], s49 offen offset:1024 lds
Mvaa 144,160,68
Vs 66,66,40
v_sub_f32_e64 v67, v67, v40
Mvaa 148,164,68
Vs 68,68,40
Vs 69,69,40
Mvaa 152,168,68
buffer_load_dwordx4 v114, s[12:15], s50 offen offset:2048 lds
Mvaa 156,172,68
Ta 180,116,12288
Ta 182,116,14336
Mvaa 160,160,72
buffer_load_dwordx4 v114, s[12:15], s51 offen offset:3072 lds
Mvaa 164,164,72
v_add_u32 v114, 65536, v114
Mvaa 168,168,72
Vs 70,70,40
Vs 71,71,40
Mvaa 172,172,72
buffer_load_dwordx4 a[32:35], v112, s[8:11], s52 offen offset:0 sc1
Mvaa 176,160,76
Ta 184,117,12288
Ta 186,117,14336
Mvaa 180,164,76
buffer_load_dwordx4 a[36:39], v112, s[8:11], s52 offen offset:1024 sc1
Mvaa 184,168,76
Vs 72,72,40
Vs 73,73,40
Mvaa 188,172,76
Vc 2,66,67
v_lshlrev_b32_e64 v66, 16, v2
Mvaa 192,160,80
buffer_load_dwordx4 a[40:43], v112, s[8:11], s52 offen offset:2048 sc1
Mvaa 196,164,80
Ta 188,118,12288
Ta 190,118,14336
Mvaa 200,168,80
buffer_load_dwordx4 a[44:47], v112, s[8:11], s52 offen offset:3072 sc1
Mvaa 204,172,80
v_and_b32 v67, 0xffff0000, v2
Vc 3,68,69
Mvaa 208,160,84
v_lshlrev_b32_e64 v68, 16, v3
v_and_b32 v69, 0xffff0000, v3
Mvaa 212,164,84
buffer_load_dwordx4 a[48:51], v113, s[8:11], s52 offen offset:0 sc1
Mvaa 216,168,84
Vc 4,70,71
v_lshlrev_b32_e64 v70, 16, v4
Mvaa 220,172,84
buffer_load_dwordx4 a[52:55], v113, s[8:11], s52 offen offset:1024 sc1
Mvaa 224,160,88
v_and_b32 v71, 0xffff0000, v4
Vc 5,72,73
Mvaa 228,164,88
v_lshlrev_b32_e64 v72, 16, v5
v_and_b32 v73, 0xffff0000, v5
Mvaa 232,168,88
buffer_load_dwordx4 a[56:59], v113, s[8:11], s52 offen offset:2048 sc1
Mvaa 236,172,88
Vm 66,66,41
Vm 67,67,41
Mvaa 240,160,92
buffer_load_dwordx4 a[60:63], v113, s[8:11], s52 offen offset:3072 sc1
Mvaa 244,164,92
s_add_u32 s52, s52, 8192
Mvaa 248,168,92
Vm 68,68,41
Vm 69,69,41
Mvaa 252,172,92
Vm 70,70,41
Vm 71,71,41
s_waitcnt vmcnt(24) lgkmcnt(0)
Mvaa 128,176,96
s_add_u32 m0, s35, 12288
Mvaa 132,180,96
buffer_load_dwordx4 v114, s[12:15], s48 offen offset:0 lds
Mvaa 136,184,96
Ta 128,115,0
Ta 130,115,2048
Mvaa 140,188,96
buffer_load_dwordx4 v114, s[12:15], s49 offen offset:1024 lds
Mvaa 144,176,100
Vm 72,72,41
v_mul_f32_e64 v73, v73, v41
Mvaa 148,180,100
Vc 2,66,67
v_lshlrev_b32_e64 v66, 16, v2
Mvaa 152,184,100
buffer_load_dwordx4 v114, s[12:15], s50 offen offset:2048 lds
Mvaa 156,188,100
Ta 132,116,0
Ta 134,116,2048
Mvaa 160,176,104
buffer_load_dwordx4 v114, s[12:15], s51 offen offset:3072 lds
Mvaa 164,180,104
v_add_u32 v114, 65536, v114
Mvaa 168,184,104
v_and_b32 v67, 0xffff0000, v2
Vc 3,68,69
Mvaa 172,188,104
buffer_load_dwordx4 a[64:67], v112, s[8:11], s52 offen offset:0 sc1
Mvaa 176,176,108
Ta 136,117,0
Ta 138,117,2048
Mvaa 180,180,108
buffer_load_dwordx4 a[68:71], v112, s[8:11], s52 offen offset:1024 sc1
Mvaa 184,184,108
v_lshlrev_b32_e64 v68, 16, v3
v_and_b32 v69, 0xffff0000, v3
Mvaa 188,188,108
Vc 4,70,71
v_lshlrev_b32_e64 v70, 16, v4
Mvaa 192,176,112
buffer_load_dwordx4 a[72:75], v112, s[8:11], s52 offen offset:2048 sc1
Mvaa 196,180,112
Ta 140,118,0
Ta 142,118,2048
Mvaa 200,184,112
buffer_load_dwordx4 a[76:79], v112, s[8:11], s52 offen offset:3072 sc1
Mvaa 204,188,112
v_and_b32 v71, 0xffff0000, v4
Vc 5,72,73
Mvaa 208,176,116
v_lshlrev_b32_e64 v72, 16, v5
v_and_b32 v73, 0xffff0000, v5
Mvaa 212,180,116
buffer_load_dwordx4 a[80:83], v113, s[8:11], s52 offen offset:0 sc1
Mvaa 216,184,116
v_mul_f32 v2, 0xbfb8aa3b, v66
v_mul_f32 v3, 0xbfb8aa3b, v67
Mvaa 220,188,116
buffer_load_dwordx4 a[84:87], v113, s[8:11], s52 offen offset:1024 sc1
Mvaa 224,176,120
v_mul_f32 v4, 0xbfb8aa3b, v68
v_mul_f32 v5, 0xbfb8aa3b, v69
Mvaa 228,180,120
v_mul_f32 v6, 0xbfb8aa3b, v70
v_mul_f32 v7, 0xbfb8aa3b, v71
Mvaa 232,184,120
buffer_load_dwordx4 a[88:91], v113, s[8:11], s52 offen offset:2048 sc1
Mvaa 236,188,120
v_mul_f32 v8, 0xbfb8aa3b, v72
v_mul_f32 v9, 0xbfb8aa3b, v73
Mvaa 240,176,124
buffer_load_dwordx4 a[92:95], v113, s[8:11], s52 offen offset:3072 sc1
Mvaa 244,180,124
s_add_u32 s52, s52, 8192
Mvaa 248,184,124
VE 2,2
Mvaa 252,188,124
Ve 3,3
s_waitcnt vmcnt(24) lgkmcnt(0)
Mvaa 128,128,0
s_add_u32 m0, s35, 0
Mvaa 132,132,0
buffer_load_dwordx4 v114, s[12:15], s48 offen offset:0 lds
Mvaa 136,136,0
Ta 144,115,4096
Ta 146,115,6144
Mvaa 140,140,0
buffer_load_dwordx4 v114, s[12:15], s49 offen offset:1024 lds
Mvaa 144,128,4
Ve 4,4
Mvaa 148,132,4
VE 5,5
Mvaa 152,136,4
buffer_load_dwordx4 v114, s[12:15], s50 offen offset:2048 lds
Mvaa 156,140,4
Ta 148,116,4096
Ta 150,116,6144
Mvaa 160,128,8
buffer_load_dwordx4 v114, s[12:15], s51 offen offset:3072 lds
Mvaa 164,132,8
v_add_u32 v114, 65536, v114
Mvaa 168,136,8
VE 6,6
Mvaa 172,140,8
buffer_load_dwordx4 a[96:99], v112, s[8:11], s52 offen offset:0 sc1
Mvaa 176,128,12
Ta 152,117,4096
Ta 154,117,6144
Mvaa 180,132,12
buffer_load_dwordx4 a[100:103], v112, s[8:11], s52 offen offset:1024 sc1
Mvaa 184,136,12
VE 7,7
Mvaa 188,140,12
VE 8,8
Mvaa 192,128,16
buffer_load_dwordx4 a[104:107], v112, s[8:11], s52 offen offset:2048 sc1
Mvaa 196,132,16
Ta 156,118,4096
Ta 158,118,6144
Mvaa 200,136,16
buffer_load_dwordx4 a[108:111], v112, s[8:11], s52 offen offset:3072 sc1
Mvaa 204,140,16
VE 9,9
Mvaa 208,128,20
v_add_f32 v2, 1.0, v2
v_add_f32 v3, 1.0, v3
Mvaa 212,132,20
buffer_load_dwordx4 a[112:115], v113, s[8:11], s52 offen offset:0 sc1
Mvaa 216,136,20
v_add_f32 v4, 1.0, v4
v_add_f32 v5, 1.0, v5
Mvaa 220,140,20
buffer_load_dwordx4 a[116:119], v113, s[8:11], s52 offen offset:1024 sc1
Mvaa 224,128,24
v_add_f32 v6, 1.0, v6
v_add_f32 v7, 1.0, v7
Mvaa 228,132,24
v_add_f32 v8, 1.0, v8
v_add_f32 v9, 1.0, v9
Mvaa 232,136,24
buffer_load_dwordx4 a[120:123], v113, s[8:11], s52 offen offset:2048 sc1
Mvaa 236,140,24
v_rcp_f32_e64 v2, v2
Mvaa 240,128,28
buffer_load_dwordx4 a[124:127], v113, s[8:11], s52 offen offset:3072 sc1
Mvaa 244,132,28
s_add_u32 s52, s52, 8192
Mvaa 248,136,28
v_rcp_f32_e64 v3, v3
Mvaa 252,140,28
v_rcp_f32 v4, v4
s_waitcnt vmcnt(24) lgkmcnt(0)
Mvaa 128,144,32
s_add_u32 m0, s35, 4096
Mvaa 132,148,32
buffer_load_dwordx4 v114, s[12:15], s48 offen offset:0 lds
Mvaa 136,152,32
Ta 160,115,8192
Ta 162,115,10240
Mvaa 140,156,32
buffer_load_dwordx4 v114, s[12:15], s49 offen offset:1024 lds
Mvaa 144,144,36
v_rcp_f32_e64 v5, v5
Mvaa 148,148,36
v_rcp_f32_e64 v6, v6
Mvaa 152,152,36
buffer_load_dwordx4 v114, s[12:15], s50 offen offset:2048 lds
Mvaa 156,156,36
Ta 164,116,8192
Ta 166,116,10240
Mvaa 160,144,40
buffer_load_dwordx4 v114, s[12:15], s51 offen offset:3072 lds
Mvaa 164,148,40
v_add_u32 v114, 65536, v114
Mvaa 168,152,40
v_rcp_f32_e64 v7, v7
Mvaa 172,156,40
buffer_load_dwordx4 a[0:3], v112, s[8:11], s52 offen offset:0 sc1
Mvaa 176,144,44
Ta 168,117,8192
Ta 170,117,10240
Mvaa 180,148,44
buffer_load_dwordx4 a[4:7], v112, s[8:11], s52 offen offset:1024 sc1
Mvaa 184,152,44
v_rcp_f32_e64 v8, v8
Mvaa 188,156,44
v_rcp_f32_e64 v9, v9
Mvaa 192,144,48
buffer_load_dwordx4 a[8:11], v112, s[8:11], s52 offen offset:2048 sc1
Mvaa 196,148,48
Ta 172,118,8192
Ta 174,118,10240
Mvaa 200,152,48
buffer_load_dwordx4 a[12:15], v112, s[8:11], s52 offen offset:3072 sc1
Mvaa 204,156,48
Vm 66,66,2
Vm 67,67,3
Mvaa 208,144,52
Vm 68,68,4
Vm 69,69,5
Mvaa 212,148,52
buffer_load_dwordx4 a[16:19], v113, s[8:11], s52 offen offset:0 sc1
Mvaa 216,152,52
Vm 70,70,6
Vm 71,71,7
Mvaa 220,156,52
buffer_load_dwordx4 a[20:23], v113, s[8:11], s52 offen offset:1024 sc1
Mvaa 224,144,56
Vm 72,72,8
Vm 73,73,9
Mvaa 228,148,56
Vc 2,66,67
v_lshlrev_b32_e64 v66, 16, v2
Mvaa 232,152,56
buffer_load_dwordx4 a[24:27], v113, s[8:11], s52 offen offset:2048 sc1
Mvaa 236,156,56
v_and_b32 v67, 0xffff0000, v2
Vc 3,68,69
Mvaa 240,144,60
buffer_load_dwordx4 a[28:31], v113, s[8:11], s52 offen offset:3072 sc1
Mvaa 244,148,60
s_add_u32 s52, s52, 8192
Mvaa 248,152,60
v_lshlrev_b32_e64 v68, 16, v3
v_and_b32 v69, 0xffff0000, v3
Mvaa 252,156,60
Vc 4,70,71
v_lshlrev_b32 v70, 16, v4
s_waitcnt vmcnt(24) lgkmcnt(0)
Mvaa 128,160,64
s_add_u32 m0, s35, 8192
Mvaa 132,164,64
buffer_load_dwordx4 v114, s[12:15], s48 offen offset:0 lds
Mvaa 136,168,64
Ta 176,115,12288
Ta 178,115,14336
Mvaa 140,172,64
buffer_load_dwordx4 v114, s[12:15], s49 offen offset:1024 lds
Mvaa 144,160,68
v_and_b32 v71, 0xffff0000, v4
Vc 5,72,73
Mvaa 148,164,68
v_lshlrev_b32_e64 v72, 16, v5
v_and_b32 v73, 0xffff0000, v5
Mvaa 152,168,68
buffer_load_dwordx4 v114, s[12:15], s50 offen offset:2048 lds
Mvaa 156,172,68
Ta 180,116,12288
Ta 182,116,14336
Mvaa 160,160,72
buffer_load_dwordx4 v114, s[12:15], s51 offen offset:3072 lds
Mvaa 164,164,72
v_add_u32 v114, 65536, v114
Mvaa 168,168,72
s_cmp_lg_u32 s53, 0
s_cbranch_scc1 L_yA
L_yAr:
Mvaa 172,172,72
buffer_load_dwordx4 a[32:35], v112, s[8:11], s52 offen offset:0 sc1
Mvaa 176,160,76
Ta 184,117,12288
Ta 186,117,14336
Mvaa 180,164,76
buffer_load_dwordx4 a[36:39], v112, s[8:11], s52 offen offset:1024 sc1
Mvaa 184,168,76
Mvaa 188,172,76
Mvaa 192,160,80
buffer_load_dwordx4 a[40:43], v112, s[8:11], s52 offen offset:2048 sc1
Mvaa 196,164,80
Ta 188,118,12288
Ta 190,118,14336
Mvaa 200,168,80
buffer_load_dwordx4 a[44:47], v112, s[8:11], s52 offen offset:3072 sc1
Mvaa 204,172,80
Mvaa 208,160,84
Mvaa 212,164,84
buffer_load_dwordx4 a[48:51], v113, s[8:11], s52 offen offset:0 sc1
Mvaa 216,168,84
Mvaa 220,172,84
buffer_load_dwordx4 a[52:55], v113, s[8:11], s52 offen offset:1024 sc1
Mvaa 224,160,88
Mvaa 228,164,88
Mvaa 232,168,88
buffer_load_dwordx4 a[56:59], v113, s[8:11], s52 offen offset:2048 sc1
Mvaa 236,172,88
Mvaa 240,160,92
buffer_load_dwordx4 a[60:63], v113, s[8:11], s52 offen offset:3072 sc1
Mvaa 244,164,92
s_add_u32 s52, s52, 8192
Mvaa 248,168,92
Mvaa 252,172,92
s_waitcnt vmcnt(24) lgkmcnt(0)
Mvaa 128,176,96
s_add_u32 m0, s35, 12288
Mvaa 132,180,96
buffer_load_dwordx4 v114, s[12:15], s48 offen offset:0 lds
Mvaa 136,184,96
Ta 128,115,0
Ta 130,115,2048
Mvaa 140,188,96
buffer_load_dwordx4 v114, s[12:15], s49 offen offset:1024 lds
Mvaa 144,176,100
Mvaa 148,180,100
Mvaa 152,184,100
buffer_load_dwordx4 v114, s[12:15], s50 offen offset:2048 lds
Mvaa 156,188,100
Ta 132,116,0
Ta 134,116,2048
Mvaa 160,176,104
buffer_load_dwordx4 v114, s[12:15], s51 offen offset:3072 lds
Mvaa 164,180,104
v_add_u32 v114, 65536, v114
Mvaa 168,184,104
Mvaa 172,188,104
buffer_load_dwordx4 a[64:67], v112, s[8:11], s52 offen offset:0 sc1
Mvaa 176,176,108
Ta 136,117,0
Ta 138,117,2048
Mvaa 180,180,108
buffer_load_dwordx4 a[68:71], v112, s[8:11], s52 offen offset:1024 sc1
Mvaa 184,184,108
Mvaa 188,188,108
Mvaa 192,176,112
buffer_load_dwordx4 a[72:75], v112, s[8:11], s52 offen offset:2048 sc1
Mvaa 196,180,112
Ta 140,118,0
Ta 142,118,2048
Mvaa 200,184,112
buffer_load_dwordx4 a[76:79], v112, s[8:11], s52 offen offset:3072 sc1
Mvaa 204,188,112
Mvaa 208,176,116
Mvaa 212,180,116
buffer_load_dwordx4 a[80:83], v113, s[8:11], s52 offen offset:0 sc1
Mvaa 216,184,116
Mvaa 220,188,116
buffer_load_dwordx4 a[84:87], v113, s[8:11], s52 offen offset:1024 sc1
Mvaa 224,176,120
Mvaa 228,180,120
Mvaa 232,184,120
buffer_load_dwordx4 a[88:91], v113, s[8:11], s52 offen offset:2048 sc1
Mvaa 236,188,120
Mvaa 240,176,124
buffer_load_dwordx4 a[92:95], v113, s[8:11], s52 offen offset:3072 sc1
Mvaa 244,180,124
s_add_u32 s52, s52, 8192
Mvaa 248,184,124
Mvaa 252,188,124
s_waitcnt vmcnt(24) lgkmcnt(0)
Mvaa 128,128,0
s_add_u32 m0, s35, 0
Mvaa 132,132,0
buffer_load_dwordx4 v114, s[12:15], s48 offen offset:0 lds
Mvaa 136,136,0
Ta 144,115,4096
Ta 146,115,6144
Mvaa 140,140,0
buffer_load_dwordx4 v114, s[12:15], s49 offen offset:1024 lds
Mvaa 144,128,4
Mvaa 148,132,4
Mvaa 152,136,4
buffer_load_dwordx4 v114, s[12:15], s50 offen offset:2048 lds
Mvaa 156,140,4
Ta 148,116,4096
Ta 150,116,6144
Mvaa 160,128,8
buffer_load_dwordx4 v114, s[12:15], s51 offen offset:3072 lds
Mvaa 164,132,8
v_add_u32 v114, 65536, v114
Mvaa 168,136,8
Mvaa 172,140,8
buffer_load_dwordx4 a[96:99], v112, s[8:11], s52 offen offset:0 sc1
Mvaa 176,128,12
Ta 152,117,4096
Ta 154,117,6144
Mvaa 180,132,12
buffer_load_dwordx4 a[100:103], v112, s[8:11], s52 offen offset:1024 sc1
Mvaa 184,136,12
Mvaa 188,140,12
Mvaa 192,128,16
buffer_load_dwordx4 a[104:107], v112, s[8:11], s52 offen offset:2048 sc1
Mvaa 196,132,16
Ta 156,118,4096
Ta 158,118,6144
Mvaa 200,136,16
buffer_load_dwordx4 a[108:111], v112, s[8:11], s52 offen offset:3072 sc1
Mvaa 204,140,16
Mvaa 208,128,20
Mvaa 212,132,20
buffer_load_dwordx4 a[112:115], v113, s[8:11], s52 offen offset:0 sc1
Mvaa 216,136,20
Mvaa 220,140,20
buffer_load_dwordx4 a[116:119], v113, s[8:11], s52 offen offset:1024 sc1
Mvaa 224,128,24
Mvaa 228,132,24
Mvaa 232,136,24
buffer_load_dwordx4 a[120:123], v113, s[8:11], s52 offen offset:2048 sc1
Mvaa 236,140,24
Mvaa 240,128,28
buffer_load_dwordx4 a[124:127], v113, s[8:11], s52 offen offset:3072 sc1
Mvaa 244,132,28
s_add_u32 s52, s52, 8192
Mvaa 248,136,28
Mvaa 252,140,28
s_waitcnt vmcnt(24) lgkmcnt(0)
Mvaa 128,144,32
s_add_u32 m0, s35, 4096
Mvaa 132,148,32
buffer_load_dwordx4 v114, s[12:15], s48 offen offset:0 lds
Mvaa 136,152,32
Ta 160,115,8192
Ta 162,115,10240
Mvaa 140,156,32
buffer_load_dwordx4 v114, s[12:15], s49 offen offset:1024 lds
Mvaa 144,144,36
Mvaa 148,148,36
Mvaa 152,152,36
buffer_load_dwordx4 v114, s[12:15], s50 offen offset:2048 lds
Mvaa 156,156,36
Ta 164,116,8192
Ta 166,116,10240
Mvaa 160,144,40
buffer_load_dwordx4 v114, s[12:15], s51 offen offset:3072 lds
Mvaa 164,148,40
v_add_u32 v114, 65536, v114
Mvaa 168,152,40
s_cmp_lg_u32 s53, 0
s_cbranch_scc1 L_yB
L_yBr:
Mvaa 172,156,40
buffer_load_dwordx4 a[0:3], v112, s[8:11], s52 offen offset:0 sc1
Mvaa 176,144,44
Ta 168,117,8192
Ta 170,117,10240
Mvaa 180,148,44
buffer_load_dwordx4 a[4:7], v112, s[8:11], s52 offen offset:1024 sc1
Mvaa 184,152,44
Mvaa 188,156,44
Mvaa 192,144,48
buffer_load_dwordx4 a[8:11], v112, s[8:11], s52 offen offset:2048 sc1
Mvaa 196,148,48
Ta 172,118,8192
Ta 174,118,10240
Mvaa 200,152,48
buffer_load_dwordx4 a[12:15], v112, s[8:11], s52 offen offset:3072 sc1
Mvaa 204,156,48
Mvaa 208,144,52
Mvaa 212,148,52
buffer_load_dwordx4 a[16:19], v113, s[8:11], s52 offen offset:0 sc1
Mvaa 216,152,52
Mvaa 220,156,52
buffer_load_dwordx4 a[20:23], v113, s[8:11], s52 offen offset:1024 sc1
Mvaa 224,144,56
Mvaa 228,148,56
Mvaa 232,152,56
buffer_load_dwordx4 a[24:27], v113, s[8:11], s52 offen offset:2048 sc1
Mvaa 236,156,56
Mvaa 240,144,60
buffer_load_dwordx4 a[28:31], v113, s[8:11], s52 offen offset:3072 sc1
Mvaa 244,148,60
s_add_u32 s52, s52, 8192
Mvaa 248,152,60
Mvaa 252,156,60
s_waitcnt vmcnt(24) lgkmcnt(0)
Mvaa 128,160,64
s_add_u32 m0, s35, 8192
Mvaa 132,164,64
buffer_load_dwordx4 v114, s[12:15], s48 offen offset:0 lds
Mvaa 136,168,64
Ta 176,115,12288
Ta 178,115,14336
Mvaa 140,172,64
buffer_load_dwordx4 v114, s[12:15], s49 offen offset:1024 lds
Mvaa 144,160,68
Mvaa 148,164,68
Mvaa 152,168,68
buffer_load_dwordx4 v114, s[12:15], s50 offen offset:2048 lds
Mvaa 156,172,68
Ta 180,116,12288
Ta 182,116,14336
Mvaa 160,160,72
buffer_load_dwordx4 v114, s[12:15], s51 offen offset:3072 lds
Mvaa 164,164,72
v_add_u32 v114, 65536, v114
Mvaa 168,168,72
Mvaa 172,172,72
buffer_load_dwordx4 a[32:35], v112, s[8:11], s52 offen offset:0 sc1
Mvaa 176,160,76
Ta 184,117,12288
Ta 186,117,14336
Mvaa 180,164,76
buffer_load_dwordx4 a[36:39], v112, s[8:11], s52 offen offset:1024 sc1
Mvaa 184,168,76
Mvaa 188,172,76
Mvaa 192,160,80
buffer_load_dwordx4 a[40:43], v112, s[8:11], s52 offen offset:2048 sc1
Mvaa 196,164,80
Ta 188,118,12288
Ta 190,118,14336
Mvaa 200,168,80
buffer_load_dwordx4 a[44:47], v112, s[8:11], s52 offen offset:3072 sc1
Mvaa 204,172,80
Mvaa 208,160,84
Mvaa 212,164,84
buffer_load_dwordx4 a[48:51], v113, s[8:11], s52 offen offset:0 sc1
Mvaa 216,168,84
Mvaa 220,172,84
buffer_load_dwordx4 a[52:55], v113, s[8:11], s52 offen offset:1024 sc1
Mvaa 224,160,88
Mvaa 228,164,88
Mvaa 232,168,88
buffer_load_dwordx4 a[56:59], v113, s[8:11], s52 offen offset:2048 sc1
Mvaa 236,172,88
Mvaa 240,160,92
buffer_load_dwordx4 a[60:63], v113, s[8:11], s52 offen offset:3072 sc1
Mvaa 244,164,92
s_add_u32 s52, s52, 8192
Mvaa 248,168,92
Mvaa 252,172,92
s_waitcnt vmcnt(24) lgkmcnt(0)
Mvaa 128,176,96
s_add_u32 m0, s35, 12288
Mvaa 132,180,96
buffer_load_dwordx4 v114, s[12:15], s48 offen offset:0 lds
Mvaa 136,184,96
Ta 128,115,0
Ta 130,115,2048
Mvaa 140,188,96
buffer_load_dwordx4 v114, s[12:15], s49 offen offset:1024 lds
Mvaa 144,176,100
Mvaa 148,180,100
Mvaa 152,184,100
buffer_load_dwordx4 v114, s[12:15], s50 offen offset:2048 lds
Mvaa 156,188,100
Ta 132,116,0
Ta 134,116,2048
Mvaa 160,176,104
buffer_load_dwordx4 v114, s[12:15], s51 offen offset:3072 lds
Mvaa 164,180,104
v_add_u32 v114, 65536, v114
Mvaa 168,184,104
Mvaa 172,188,104
buffer_load_dwordx4 a[64:67], v112, s[8:11], s52 offen offset:0 sc1
Mvaa 176,176,108
Ta 136,117,0
Ta 138,117,2048
Mvaa 180,180,108
buffer_load_dwordx4 a[68:71], v112, s[8:11], s52 offen offset:1024 sc1
Mvaa 184,184,108
Mvaa 188,188,108
Mvaa 192,176,112
buffer_load_dwordx4 a[72:75], v112, s[8:11], s52 offen offset:2048 sc1
Mvaa 196,180,112
Ta 140,118,0
Ta 142,118,2048
Mvaa 200,184,112
buffer_load_dwordx4 a[76:79], v112, s[8:11], s52 offen offset:3072 sc1
Mvaa 204,188,112
Mvaa 208,176,116
Mvaa 212,180,116
buffer_load_dwordx4 a[80:83], v113, s[8:11], s52 offen offset:0 sc1
Mvaa 216,184,116
Mvaa 220,188,116
buffer_load_dwordx4 a[84:87], v113, s[8:11], s52 offen offset:1024 sc1
Mvaa 224,176,120
Mvaa 228,180,120
Mvaa 232,184,120
buffer_load_dwordx4 a[88:91], v113, s[8:11], s52 offen offset:2048 sc1
Mvaa 236,188,120
Mvaa 240,176,124
buffer_load_dwordx4 a[92:95], v113, s[8:11], s52 offen offset:3072 sc1
Mvaa 244,180,124
s_add_u32 s52, s52, 8192
Mvaa 248,184,124
Mvaa 252,188,124
s_waitcnt vmcnt(24) lgkmcnt(0)
Mvaa 128,128,0
Mvaa 132,132,0
buffer_load_dwordx4 a[96:99], v112, s[8:11], s52 offen offset:0 sc1
Mvaa 136,136,0
Ta 144,115,4096
Ta 146,115,6144
Mvaa 140,140,0
buffer_load_dwordx4 a[100:103], v112, s[8:11], s52 offen offset:1024 sc1
Mvaa 144,128,4
Mvaa 148,132,4
Mvaa 152,136,4
buffer_load_dwordx4 a[104:107], v112, s[8:11], s52 offen offset:2048 sc1
Mvaa 156,140,4
Ta 148,116,4096
Ta 150,116,6144
Mvaa 160,128,8
buffer_load_dwordx4 a[108:111], v112, s[8:11], s52 offen offset:3072 sc1
Mvaa 164,132,8
Mvaa 168,136,8
Mvaa 172,140,8
buffer_load_dwordx4 a[112:115], v113, s[8:11], s52 offen offset:0 sc1
Mvaa 176,128,12
Ta 152,117,4096
Ta 154,117,6144
Mvaa 180,132,12
buffer_load_dwordx4 a[116:119], v113, s[8:11], s52 offen offset:1024 sc1
Mvaa 184,136,12
s_cmp_lg_u32 s40, 0
s_cbranch_scc1 L_yC
L_yCr:
Mvaa 188,140,12
Mvaa 192,128,16
buffer_load_dwordx4 a[120:123], v113, s[8:11], s52 offen offset:2048 sc1
Mvaa 196,132,16
Ta 156,118,4096
Ta 158,118,6144
Mvaa 200,136,16
buffer_load_dwordx4 a[124:127], v113, s[8:11], s52 offen offset:3072 sc1
Mvaa 204,140,16
s_add_u32 s52, s52, 8192
Mvaa 208,128,20
Mvaa 212,132,20
Mvaa 216,136,20
Mvaa 220,140,20
Mvaa 224,128,24
Mvaa 228,132,24
Mvaa 232,136,24
Mvaa 236,140,24
Mvaa 240,128,28
Mvaa 244,132,28
Mvaa 248,136,28
Mvaa 252,140,28
s_waitcnt vmcnt(20) lgkmcnt(0)
Mvaa 128,144,32
Mvaa 132,148,32
Mvaa 136,152,32
Ta 160,115,8192
Ta 162,115,10240
Mvaa 140,156,32
Mvaa 144,144,36
Mvaa 148,148,36
Mvaa 152,152,36
Mvaa 156,156,36
Ta 164,116,8192
Ta 166,116,10240
Mvaa 160,144,40
Mvaa 164,148,40
Mvaa 168,152,40
Mvaa 172,156,40
Mvaa 176,144,44
Ta 168,117,8192
Ta 170,117,10240
Mvaa 180,148,44
Mvaa 184,152,44
Mvaa 188,156,44
Mvaa 192,144,48
Mvaa 196,148,48
Ta 172,118,8192
Ta 174,118,10240
Mvaa 200,152,48
Mvaa 204,156,48
Mvaa 208,144,52
Mvaa 212,148,52
Mvaa 216,152,52
Mvaa 220,156,52
Mvaa 224,144,56
Mvaa 228,148,56
Mvaa 232,152,56
Mvaa 236,156,56
Mvaa 240,144,60
Mvaa 244,148,60
Mvaa 248,152,60
Mvaa 252,156,60
s_waitcnt vmcnt(8) lgkmcnt(0)
Mvaa 128,160,64
Mvaa 132,164,64
Mvaa 136,168,64
Ta 176,115,12288
Ta 178,115,14336
Mvaa 140,172,64
Mvaa 144,160,68
Mvaa 148,164,68
Mvaa 152,168,68
Mvaa 156,172,68
Ta 180,116,12288
Ta 182,116,14336
Mvaa 160,160,72
Mvaa 164,164,72
Mvaa 168,168,72
Mvaa 172,172,72
Mvaa 176,160,76
Ta 184,117,12288
Ta 186,117,14336
Mvaa 180,164,76
Mvaa 184,168,76
Mvaa 188,172,76
Mvaa 192,160,80
Mvaa 196,164,80
Ta 188,118,12288
Ta 190,118,14336
Mvaa 200,168,80
Mvaa 204,172,80
Mvaa 208,160,84
Mvaa 212,164,84
Mvaa 216,168,84
Mvaa 220,172,84
Mvaa 224,160,88
Mvaa 228,164,88
Mvaa 232,168,88
Mvaa 236,172,88
Mvaa 240,160,92
Mvaa 244,164,92
Mvaa 248,168,92
Mvaa 252,172,92
s_waitcnt vmcnt(0) lgkmcnt(0)
Mvaa 128,176,96
Mvaa 132,180,96
Mvaa 136,184,96
Mvaa 140,188,96
Mvaa 144,176,100
Mvaa 148,180,100
Mvaa 152,184,100
Mvaa 156,188,100
Mvaa 160,176,104
Mvaa 164,180,104
Mvaa 168,184,104
Mvaa 172,188,104
Mvaa 176,176,108
Mvaa 180,180,108
Mvaa 184,184,108
Mvaa 188,188,108
Mvaa 192,176,112
Mvaa 196,180,112
Mvaa 200,184,112
Mvaa 204,188,112
Mvaa 208,176,116
Mvaa 212,180,116
Mvaa 216,184,116
Mvaa 220,188,116
Mvaa 224,176,120
Mvaa 228,180,120
Mvaa 232,184,120
Mvaa 236,188,120
Mvaa 240,176,124
Mvaa 244,180,124
Mvaa 248,184,124
Mvaa 252,188,124
v_and_b32 v124, 15, v0
v_lshlrev_b32 v10, 8, v124
v_add_u32 v10, s35, v10
v_xor_b32 v124, v124, v121
v_xor_b32_e64 v125, 0, v124
v_lshl_add_u32 v115, v125, 4, v10
v_xor_b32_e64 v125, 4, v124
v_lshl_add_u32 v116, v125, 4, v10
v_xor_b32_e64 v125, 8, v124
v_lshl_add_u32 v117, v125, 4, v10
v_xor_b32_e64 v125, 12, v124
v_lshl_add_u32 v118, v125, 4, v10
ds_write_b128 v115, v[128:131] offset:0
ds_write_b128 v116, v[132:135] offset:0
ds_write_b128 v117, v[136:139] offset:0
ds_write_b128 v118, v[140:143] offset:0
ds_write_b128 v115, v[144:147] offset:4096
ds_write_b128 v116, v[148:151] offset:4096
ds_write_b128 v117, v[152:155] offset:4096
ds_write_b128 v118, v[156:159] offset:4096
ds_write_b128 v115, v[160:163] offset:8192
ds_write_b128 v116, v[164:167] offset:8192
ds_write_b128 v117, v[168:171] offset:8192
ds_write_b128 v118, v[172:175] offset:8192
ds_write_b128 v115, v[176:179] offset:12288
ds_write_b128 v116, v[180:183] offset:12288
ds_write_b128 v117, v[184:187] offset:12288
s_waitcnt lgkmcnt(9)
s_nop 0
ds_write_b128 v118, v[188:191] offset:12288
ds_write_b128 v115, v[192:195] offset:16384
ds_write_b128 v116, v[196:199] offset:16384
ds_write_b128 v117, v[200:203] offset:16384
ds_write_b128 v118, v[204:207] offset:16384
ds_write_b128 v115, v[208:211] offset:20480
s_waitcnt lgkmcnt(9)
s_nop 0
ds_write_b128 v116, v[212:215] offset:20480
ds_write_b128 v117, v[216:219] offset:20480
ds_write_b128 v118, v[220:223] offset:20480
ds_write_b128 v115, v[224:227] offset:24576
ds_write_b128 v116, v[228:231] offset:24576
ds_write_b128 v117, v[232:235] offset:24576
s_waitcnt lgkmcnt(9)
ds_write_b128 v118, v[236:239] offset:24576
ds_write_b128 v115, v[240:243] offset:28672
ds_write_b128 v116, v[244:247] offset:28672
ds_write_b128 v117, v[248:251] offset:28672
ds_write_b128 v118, v[252:255] offset:28672
s_cmp_lg_u32 s53, s40
s_cbranch_scc1 L_ysl
L_yslr:
v_and_b32 v124, 15, v120
v_lshlrev_b32 v125, 1, v122
v_xor_b32 v124, v124, v125
v_lshlrev_b32_e64 v10, 8, v120
v_lshl_add_u32 v12, v124, 4, v10
v_xor_b32_e64 v13, 16, v12
v_add_u32 v14, 65536, v12
v_add_u32 v15, 65536, v13
v_lshlrev_b32_e64 v80, 16, v18
v_and_b32 v81, 0xffff0000, v18
v_lshlrev_b32_e64 v82, 16, v19
v_and_b32 v83, 0xffff0000, v19
v_lshlrev_b32_e64 v84, 16, v20
v_and_b32 v85, 0xffff0000, v20
v_lshlrev_b32_e64 v86, 16, v21
v_and_b32 v87, 0xffff0000, v21
v_lshlrev_b32_e64 v88, 16, v22
v_and_b32 v89, 0xffff0000, v22
v_lshlrev_b32_e64 v90, 16, v23
v_and_b32 v91, 0xffff0000, v23
v_lshlrev_b32_e64 v92, 16, v24
v_and_b32 v93, 0xffff0000, v24
v_lshlrev_b32_e64 v94, 16, v25
v_and_b32 v95, 0xffff0000, v25
v_lshlrev_b32_e64 v96, 16, v26
v_and_b32 v97, 0xffff0000, v26
v_lshlrev_b32_e64 v98, 16, v27
v_and_b32 v99, 0xffff0000, v27
v_lshlrev_b32_e64 v100, 16, v28
v_and_b32 v101, 0xffff0000, v28
v_lshlrev_b32_e64 v102, 16, v29
v_and_b32 v103, 0xffff0000, v29
v_lshlrev_b32_e64 v104, 16, v30
v_and_b32 v105, 0xffff0000, v30
v_lshlrev_b32_e64 v106, 16, v31
v_and_b32 v107, 0xffff0000, v31
v_lshlrev_b32_e64 v108, 16, v32
v_and_b32 v109, 0xffff0000, v32
v_lshlrev_b32_e64 v110, 16, v33
v_and_b32 v111, 0xffff0000, v33
s_waitcnt lgkmcnt(0)
s_barrier
Rv 128,12,0
Rv 132,13,0
Rv 136,12,32768
Rv 140,13,32768
Rv 144,14,0
Rv 148,15,0
Rv 152,14,32768
Rv 156,15,32768
s_waitcnt lgkmcnt(0)
s_nop 0
Rv 160,12,8192
Rv 164,13,8192
Rv 168,12,40960
Rv 172,13,40960
Rv 176,14,8192
Rv 180,15,8192
Rv 184,14,40960
Rv 188,15,40960
v_pk_add_f32 v[128:129], v[128:129], v[136:137]
v_pk_add_f32 v[144:145], v[144:145], v[152:153]
v_pk_add_f32 v[130:131], v[130:131], v[138:139]
v_pk_add_f32 v[146:147], v[146:147], v[154:155]
v_pk_add_f32 v[132:133], v[132:133], v[140:141]
v_pk_add_f32 v[148:149], v[148:149], v[156:157]
v_pk_add_f32 v[134:135], v[134:135], v[142:143]
v_pk_add_f32 v[150:151], v[150:151], v[158:159]
v_pk_add_f32 v[128:129], v[128:129], v[144:145]
v_pk_add_f32 v[130:131], v[130:131], v[146:147]
v_pk_add_f32 v[132:133], v[132:133], v[148:149]
v_pk_add_f32 v[134:135], v[134:135], v[150:151]
Vc 136,128,129
v_lshlrev_b32_e64 v128, 16, v136
v_and_b32 v129, 0xffff0000, v136
Vc 137,130,131
v_lshlrev_b32_e64 v130, 16, v137
v_and_b32 v131, 0xffff0000, v137
Vc 138,132,133
v_lshlrev_b32_e64 v132, 16, v138
v_and_b32 v133, 0xffff0000, v138
Vc 139,134,135
v_lshlrev_b32_e64 v134, 16, v139
v_and_b32 v135, 0xffff0000, v139
v_pk_mul_f32 v[128:129], v[128:129], v[42:43]
v_pk_mul_f32 v[130:131], v[130:131], v[44:45]
v_pk_mul_f32 v[132:133], v[132:133], v[46:47]
v_pk_mul_f32 v[134:135], v[134:135], v[48:49]
Vc 136,128,129
v_lshlrev_b32_e64 v128, 16, v136
v_and_b32 v129, 0xffff0000, v136
Vc 137,130,131
v_lshlrev_b32_e64 v130, 16, v137
v_and_b32 v131, 0xffff0000, v137
Vc 138,132,133
v_lshlrev_b32_e64 v132, 16, v138
v_and_b32 v133, 0xffff0000, v138
Vc 139,134,135
v_lshlrev_b32_e64 v134, 16, v139
v_and_b32 v135, 0xffff0000, v139
v_pk_add_f32 v[128:129], v[128:129], v[80:81]
v_pk_add_f32 v[130:131], v[130:131], v[82:83]
v_pk_add_f32 v[132:133], v[132:133], v[84:85]
v_pk_add_f32 v[134:135], v[134:135], v[86:87]
Vc 136,128,129
Vc 137,130,131
Vc 138,132,133
Vc 139,134,135
buffer_store_dwordx4 v[136:139], v119, s[68:71], s36 offen sc1
s_add_u32 s36, s36, 65536
s_waitcnt lgkmcnt(0)
s_nop 0
Rv 192,12,16384
Rv 196,13,16384
Rv 200,12,49152
Rv 204,13,49152
Rv 208,14,16384
Rv 212,15,16384
Rv 216,14,49152
Rv 220,15,49152
v_pk_add_f32 v[160:161], v[160:161], v[168:169]
v_pk_add_f32 v[176:177], v[176:177], v[184:185]
v_pk_add_f32 v[162:163], v[162:163], v[170:171]
v_pk_add_f32 v[178:179], v[178:179], v[186:187]
v_pk_add_f32 v[164:165], v[164:165], v[172:173]
v_pk_add_f32 v[180:181], v[180:181], v[188:189]
v_pk_add_f32 v[166:167], v[166:167], v[174:175]
v_pk_add_f32 v[182:183], v[182:183], v[190:191]
v_pk_add_f32 v[160:161], v[160:161], v[176:177]
v_pk_add_f32 v[162:163], v[162:163], v[178:179]
v_pk_add_f32 v[164:165], v[164:165], v[180:181]
v_pk_add_f32 v[166:167], v[166:167], v[182:183]
Vc 168,160,161
v_lshlrev_b32_e64 v160, 16, v168
v_and_b32 v161, 0xffff0000, v168
Vc 169,162,163
v_lshlrev_b32_e64 v162, 16, v169
v_and_b32 v163, 0xffff0000, v169
Vc 170,164,165
v_lshlrev_b32_e64 v164, 16, v170
v_and_b32 v165, 0xffff0000, v170
Vc 171,166,167
v_lshlrev_b32_e64 v166, 16, v171
v_and_b32 v167, 0xffff0000, v171
v_pk_mul_f32 v[160:161], v[160:161], v[50:51]
v_pk_mul_f32 v[162:163], v[162:163], v[52:53]
v_pk_mul_f32 v[164:165], v[164:165], v[54:55]
v_pk_mul_f32 v[166:167], v[166:167], v[56:57]
Vc 168,160,161
v_lshlrev_b32_e64 v160, 16, v168
v_and_b32 v161, 0xffff0000, v168
Vc 169,162,163
v_lshlrev_b32_e64 v162, 16, v169
v_and_b32 v163, 0xffff0000, v169
Vc 170,164,165
v_lshlrev_b32_e64 v164, 16, v170
v_and_b32 v165, 0xffff0000, v170
Vc 171,166,167
v_lshlrev_b32_e64 v166, 16, v171
v_and_b32 v167, 0xffff0000, v171
v_pk_add_f32 v[160:161], v[160:161], v[88:89]
v_pk_add_f32 v[162:163], v[162:163], v[90:91]
v_pk_add_f32 v[164:165], v[164:165], v[92:93]
v_pk_add_f32 v[166:167], v[166:167], v[94:95]
Vc 168,160,161
Vc 169,162,163
Vc 170,164,165
Vc 171,166,167
buffer_store_dwordx4 v[168:171], v119, s[68:71], s36 offen sc1
s_add_u32 s36, s36, 65536
s_waitcnt lgkmcnt(0)
s_nop 0
Rv 224,12,24576
Rv 228,13,24576
Rv 232,12,57344
Rv 236,13,57344
Rv 240,14,24576
Rv 244,15,24576
Rv 248,14,57344
Rv 252,15,57344
v_pk_add_f32 v[192:193], v[192:193], v[200:201]
v_pk_add_f32 v[208:209], v[208:209], v[216:217]
v_pk_add_f32 v[194:195], v[194:195], v[202:203]
v_pk_add_f32 v[210:211], v[210:211], v[218:219]
v_pk_add_f32 v[196:197], v[196:197], v[204:205]
v_pk_add_f32 v[212:213], v[212:213], v[220:221]
v_pk_add_f32 v[198:199], v[198:199], v[206:207]
v_pk_add_f32 v[214:215], v[214:215], v[222:223]
v_pk_add_f32 v[192:193], v[192:193], v[208:209]
v_pk_add_f32 v[194:195], v[194:195], v[210:211]
v_pk_add_f32 v[196:197], v[196:197], v[212:213]
v_pk_add_f32 v[198:199], v[198:199], v[214:215]
Vc 200,192,193
v_lshlrev_b32_e64 v192, 16, v200
v_and_b32 v193, 0xffff0000, v200
Vc 201,194,195
v_lshlrev_b32_e64 v194, 16, v201
v_and_b32 v195, 0xffff0000, v201
Vc 202,196,197
v_lshlrev_b32_e64 v196, 16, v202
v_and_b32 v197, 0xffff0000, v202
Vc 203,198,199
v_lshlrev_b32_e64 v198, 16, v203
v_and_b32 v199, 0xffff0000, v203
v_pk_mul_f32 v[192:193], v[192:193], v[58:59]
v_pk_mul_f32 v[194:195], v[194:195], v[60:61]
v_pk_mul_f32 v[196:197], v[196:197], v[62:63]
v_pk_mul_f32 v[198:199], v[198:199], v[64:65]
Vc 200,192,193
v_lshlrev_b32_e64 v192, 16, v200
v_and_b32 v193, 0xffff0000, v200
Vc 201,194,195
v_lshlrev_b32_e64 v194, 16, v201
v_and_b32 v195, 0xffff0000, v201
Vc 202,196,197
v_lshlrev_b32_e64 v196, 16, v202
v_and_b32 v197, 0xffff0000, v202
Vc 203,198,199
v_lshlrev_b32_e64 v198, 16, v203
v_and_b32 v199, 0xffff0000, v203
v_pk_add_f32 v[192:193], v[192:193], v[96:97]
v_pk_add_f32 v[194:195], v[194:195], v[98:99]
v_pk_add_f32 v[196:197], v[196:197], v[100:101]
v_pk_add_f32 v[198:199], v[198:199], v[102:103]
Vc 200,192,193
Vc 201,194,195
Vc 202,196,197
Vc 203,198,199
buffer_store_dwordx4 v[200:203], v119, s[68:71], s36 offen sc1
s_add_u32 s36, s36, 65536
s_waitcnt lgkmcnt(0)
s_nop 0
v_pk_add_f32 v[224:225], v[224:225], v[232:233]
v_pk_add_f32 v[240:241], v[240:241], v[248:249]
v_pk_add_f32 v[226:227], v[226:227], v[234:235]
v_pk_add_f32 v[242:243], v[242:243], v[250:251]
v_pk_add_f32 v[228:229], v[228:229], v[236:237]
v_pk_add_f32 v[244:245], v[244:245], v[252:253]
v_pk_add_f32 v[230:231], v[230:231], v[238:239]
v_pk_add_f32 v[246:247], v[246:247], v[254:255]
v_pk_add_f32 v[224:225], v[224:225], v[240:241]
v_pk_add_f32 v[226:227], v[226:227], v[242:243]
v_pk_add_f32 v[228:229], v[228:229], v[244:245]
v_pk_add_f32 v[230:231], v[230:231], v[246:247]
Vc 232,224,225
v_lshlrev_b32_e64 v224, 16, v232
v_and_b32 v225, 0xffff0000, v232
Vc 233,226,227
v_lshlrev_b32_e64 v226, 16, v233
v_and_b32 v227, 0xffff0000, v233
Vc 234,228,229
v_lshlrev_b32_e64 v228, 16, v234
v_and_b32 v229, 0xffff0000, v234
Vc 235,230,231
v_lshlrev_b32_e64 v230, 16, v235
v_and_b32 v231, 0xffff0000, v235
v_pk_mul_f32 v[224:225], v[224:225], v[66:67]
v_pk_mul_f32 v[226:227], v[226:227], v[68:69]
v_pk_mul_f32 v[228:229], v[228:229], v[70:71]
v_pk_mul_f32 v[230:231], v[230:231], v[72:73]
Vc 232,224,225
v_lshlrev_b32_e64 v224, 16, v232
v_and_b32 v225, 0xffff0000, v232
Vc 233,226,227
v_lshlrev_b32_e64 v226, 16, v233
v_and_b32 v227, 0xffff0000, v233
Vc 234,228,229
v_lshlrev_b32_e64 v228, 16, v234
v_and_b32 v229, 0xffff0000, v234
Vc 235,230,231
v_lshlrev_b32_e64 v230, 16, v235
v_and_b32 v231, 0xffff0000, v235
v_pk_add_f32 v[224:225], v[224:225], v[104:105]
v_pk_add_f32 v[226:227], v[226:227], v[106:107]
v_pk_add_f32 v[228:229], v[228:229], v[108:109]
v_pk_add_f32 v[230:231], v[230:231], v[110:111]
Vc 232,224,225
Vc 233,226,227
Vc 234,228,229
Vc 235,230,231
buffer_store_dwordx4 v[232:235], v119, s[68:71], s36 offen sc1
L_k2_end:
s_endpgm
L_spinC:
s_add_u32 m0, s35, 16384
s_nop 0
buffer_load_dwordx4 v125, s[60:63], s48 offen offset:0 lds
buffer_load_dwordx4 v125, s[60:63], s49 offen offset:1024 lds
buffer_load_dwordx4 v125, s[60:63], s50 offen offset:2048 lds
buffer_load_dwordx4 v125, s[60:63], s51 offen offset:3072 lds
v_add_u32 v125, 65536, v125
s_add_u32 m0, s35, 20480
s_nop 0
buffer_load_dwordx4 v125, s[60:63], s48 offen offset:0 lds
buffer_load_dwordx4 v125, s[60:63], s49 offen offset:1024 lds
buffer_load_dwordx4 v125, s[60:63], s50 offen offset:2048 lds
buffer_load_dwordx4 v125, s[60:63], s51 offen offset:3072 lds
s_mov_b32 s40, 1
s_mov_b32 s47, 0x400000
L_spinC_l:
s_sleep 4
buffer_load_dword v124, v127, s[20:23], s38 offen sc1
s_sub_u32 s47, s47, 1
s_cmp_eq_u32 s47, 0
s_cbranch_scc1 L_spinCx
s_waitcnt vmcnt(0)
v_cmp_ne_u32 vcc, 1, v124
s_cbranch_vccnz L_spinC_l
L_spinCx:
s_waitcnt vmcnt(0)
s_branch L_spinCr
L_c31:
s_bfe_u32 s3, s2, 0x40003
s_mul_i32 s3, s3, 65536
s_lshl_b32 s7, s32, 21
s_add_u32 s3, s3, s7
s_and_b32 s7, s2, 1
s_lshl_b32 s7, s7, 10
s_add_u32 s3, s3, s7
s_add_u32 s3, s3, 1048960
v_and_b32 v11, 31, v0
v_lshlrev_b32 v11, 11, v11
buffer_load_dword v17, v11, s[28:31], s3 offen
s_branch L_c31r
L_f2A:
s_lshr_b32 s5, s54, 1
s_lshl_b32 s5, s5, 5
s_add_u32 s5, s5, 5302272
buffer_load_dword v125, v127, s[20:23], s5 offen sc1
s_branch L_f2Ar
L_f2B:
s_waitcnt vmcnt(24)
v_cmp_ne_u32 vcc, 1, v125
s_cbranch_vccz L_f2lx
s_mov_b32 s47, 0x400000
L_f2l:
buffer_load_dword v125, v127, s[20:23], s5 offen sc1
s_sub_u32 s47, s47, 1
s_waitcnt vmcnt(0)
s_cmp_eq_u32 s47, 0
s_cbranch_scc1 L_f2lx
v_cmp_ne_u32 vcc, 1, v125
s_cbranch_vccz L_f2lx
s_sleep 8
s_branch L_f2l
L_f2lx:
s_lshl_b32 s3, s54, 8
s_add_u32 s3, s3, 6291456
v_mul_u32_u24 v124, 14336, v121
v_and_b32_e64 v125, 15, v0
v_lshl_add_u32 v124, v125, 4, v124
buffer_load_dwordx4 v[74:77], v124, s[20:23], s3 offen sc1
s_add_u32 s3, s3, 57344
buffer_load_dwordx4 v[78:81], v124, s[20:23], s3 offen sc1
s_add_u32 s3, s3, 57344
buffer_load_dwordx4 v[82:85], v124, s[20:23], s3 offen sc1
s_add_u32 s3, s3, 57344
buffer_load_dwordx4 v[86:89], v124, s[20:23], s3 offen sc1
s_add_u32 s3, s3, 57344
buffer_load_dwordx4 v[90:93], v124, s[20:23], s3 offen sc1
s_add_u32 s3, s3, 57344
buffer_load_dwordx4 v[94:97], v124, s[20:23], s3 offen sc1
s_add_u32 s3, s3, 57344
buffer_load_dwordx4 v[98:101], v124, s[20:23], s3 offen sc1
s_add_u32 s3, s3, 57344
buffer_load_dwordx4 v[102:105], v124, s[20:23], s3 offen sc1
s_branch L_f2Br
L_f2C:
s_waitcnt vmcnt(24) lgkmcnt(0)
Ta 192,115,16384
Ta 194,115,18432
Ta 196,116,16384
Ta 198,116,18432
Ta 200,117,16384
Ta 202,117,18432
Ta 204,118,16384
Ta 206,118,18432
v_pk_add_f32 v[74:75], v[74:75], v[78:79]
v_pk_add_f32 v[76:77], v[76:77], v[80:81]
v_pk_add_f32 v[74:75], v[74:75], v[82:83]
v_pk_add_f32 v[76:77], v[76:77], v[84:85]
v_pk_add_f32 v[74:75], v[74:75], v[86:87]
v_pk_add_f32 v[76:77], v[76:77], v[88:89]
Ta 208,115,20480
Ta 210,115,22528
Ta 212,116,20480
Ta 214,116,22528
Ta 216,117,20480
Ta 218,117,22528
Ta 220,118,20480
s_waitcnt lgkmcnt(9)
s_nop 0
Ta 222,118,22528
v_pk_add_f32 v[74:75], v[74:75], v[90:91]
v_pk_add_f32 v[76:77], v[76:77], v[92:93]
v_pk_add_f32 v[74:75], v[74:75], v[94:95]
v_pk_add_f32 v[76:77], v[76:77], v[96:97]
v_pk_add_f32 v[74:75], v[74:75], v[98:99]
v_pk_add_f32 v[76:77], v[76:77], v[100:101]
v_pk_add_f32 v[74:75], v[74:75], v[102:103]
v_pk_add_f32 v[76:77], v[76:77], v[104:105]
Vc 125,74,75
v_lshlrev_b32_e64 v74, 16, v125
v_and_b32 v75, 0xffff0000, v125
Vc 125,76,77
v_lshlrev_b32_e64 v76, 16, v125
v_and_b32 v77, 0xffff0000, v125
v_mov_b32 v82, v74
v_mov_b32 v83, v75
v_mov_b32 v84, v76
v_mov_b32 v85, v77
v_permlane32_swap_b32 v82, v74
v_permlane32_swap_b32 v83, v75
v_permlane32_swap_b32 v84, v76
v_permlane32_swap_b32 v85, v77
v_mul_f32 v90, 0xbfb8aa3b, v82
v_mul_f32 v91, 0xbfb8aa3b, v83
v_mul_f32 v92, 0xbfb8aa3b, v84
v_mul_f32 v93, 0xbfb8aa3b, v85
Ve 90,90
Ve 91,91
Ve 92,92
Ve 93,93
v_add_f32 v90, 1.0, v90
v_add_f32 v91, 1.0, v91
v_add_f32 v92, 1.0, v92
v_add_f32 v93, 1.0, v93
v_rcp_f32 v90, v90
v_rcp_f32 v91, v91
v_rcp_f32 v92, v92
v_rcp_f32 v93, v93
Vm 82,82,90
Vm 83,83,91
Vm 84,84,92
Vm 85,85,93
Vc 125,82,83
v_lshlrev_b32_e64 v82, 16, v125
v_and_b32 v83, 0xffff0000, v125
Vc 125,84,85
v_lshlrev_b32_e64 v84, 16, v125
v_and_b32 v85, 0xffff0000, v125
Vm 74,74,82
Vm 75,75,83
Vm 76,76,84
Vm 77,77,85
Vc 90,74,75
Vc 91,76,77
s_lshl_b32 s7, s32, 9
s_add_u32 s7, s7, 131072
v_and_b32 v124, 1, v121
v_lshlrev_b32 v124, 8, v124
v_and_b32 v125, 15, v0
v_lshl_add_u32 v124, v125, 3, v124
v_add_u32_e64 v124, s7, v124
ds_write_b64 v124, v[90:91]
v_and_b32 v124, 1, v0
v_lshlrev_b32 v124, 8, v124
v_lshl_add_u32 v94, v121, 3, v124
v_add_u32_e64 v94, s7, v94
ds_read_b64 v[74:75], v94 offset:0
ds_read_b64 v[76:77], v94 offset:32
ds_read_b64 v[78:79], v94 offset:64
ds_read_b64 v[80:81], v94 offset:96
v_lshl_add_u32 v124, v121, 4, v124
v_add_u32 v124, s7, v124
s_waitcnt lgkmcnt(0)
Zvav 96,192,74
Zvav 100,196,74
Zvav 104,200,74
Zvav 108,204,74
Mvav 96,208,78
Mvav 100,212,78
Mvav 104,216,78
Mvav 108,220,78
s_nop 4
ds_write_b128 v124, v[96:99] offset:2048
ds_write_b128 v124, v[100:103] offset:2112
ds_write_b128 v124, v[104:107] offset:2176
ds_write_b128 v124, v[108:111] offset:2240
s_waitcnt lgkmcnt(0)
s_barrier
s_cmp_lg_u32 s32, 0
s_cbranch_scc1 L_f2Cr
v_lshlrev_b32 v124, 3, v0
v_add_u32 v125, 133120, v124
ds_read_b64 v[74:75], v125 offset:0
ds_read_b64 v[76:77], v125 offset:512
ds_read_b64 v[78:79], v125 offset:1024
ds_read_b64 v[80:81], v125 offset:1536
s_lshl_b32 s3, s39, 4
s_add_u32 s3, s3, s37
s_lshl_b32 s3, s3, 9
s_add_u32 s3, s3, 5308416
s_waitcnt lgkmcnt(0)
v_pk_add_f32 v[74:75], v[74:75], v[76:77]
v_pk_add_f32 v[78:79], v[78:79], v[80:81]
v_pk_add_f32 v[74:75], v[74:75], v[78:79]
buffer_store_dwordx2 v[74:75], v124, s[20:23], s3 offen sc1
s_branch L_f2Cr
L_f2E:
s_cmp_lg_u32 s32, 0
s_cbranch_scc1 L_f2Er
v_mov_b32 v125, 1
s_lshl_b32 s3, s39, 5
s_add_u32 s3, s3, s37
s_lshl_b32 s3, s3, 2
s_add_u32 s3, s3, 5304320
s_waitcnt vmcnt(24)
s_mov_b64 exec, 1
buffer_store_dword v125, v126, s[20:23], s3 offen sc1
s_mov_b64 exec, -1
s_branch L_f2Er
L_yA:
v_min_u32 v127, 13, v0
v_lshlrev_b32_e64 v127, 2, v127
buffer_load_dword v124, v127, s[20:23], s41 offen sc1
s_branch L_yAr
L_yB:
s_waitcnt vmcnt(24)
v_cmp_ne_u32 vcc, 1, v124
s_cbranch_vccnz L_yBr
s_mov_b32 s40, 1
v_lshlrev_b32 v125, 10, v123
v_lshl_add_u32 v125, v122, 5, v125
v_mov_b32 v124, 2146435072
v_cmp_gt_u32 vcc, 7, v123
s_nop 1
v_cndmask_b32 v125, v124, v125, vcc
s_nop 0
buffer_load_dwordx4 v[80:83], v125, s[20:23], s44 offen offset:0 sc1
buffer_load_dwordx4 v[84:87], v125, s[20:23], s44 offen offset:16 sc1
buffer_load_dwordx4 v[88:91], v125, s[20:23], s44 offen offset:256 sc1
buffer_load_dwordx4 v[92:95], v125, s[20:23], s44 offen offset:272 sc1
buffer_load_dwordx4 v[96:99], v125, s[20:23], s44 offen offset:512 sc1
buffer_load_dwordx4 v[100:103], v125, s[20:23], s44 offen offset:528 sc1
buffer_load_dwordx4 v[104:107], v125, s[20:23], s44 offen offset:768 sc1
buffer_load_dwordx4 v[108:111], v125, s[20:23], s44 offen offset:784 sc1
s_branch L_yBr
L_yC:
s_waitcnt vmcnt(8)
v_pk_add_f32 v[80:81], v[80:81], v[96:97]
v_pk_add_f32 v[82:83], v[82:83], v[98:99]
v_pk_add_f32 v[84:85], v[84:85], v[100:101]
v_pk_add_f32 v[86:87], v[86:87], v[102:103]
v_pk_add_f32 v[88:89], v[88:89], v[104:105]
v_pk_add_f32 v[90:91], v[90:91], v[106:107]
v_pk_add_f32 v[92:93], v[92:93], v[108:109]
v_pk_add_f32 v[94:95], v[94:95], v[110:111]
v_add_f32_dpp v80, v80, v80 row_ror:8 row_mask:0xf bank_mask:0xf
v_add_f32_dpp v81, v81, v81 row_ror:8 row_mask:0xf bank_mask:0xf
v_add_f32_dpp v82, v82, v82 row_ror:8 row_mask:0xf bank_mask:0xf
v_add_f32_dpp v83, v83, v83 row_ror:8 row_mask:0xf bank_mask:0xf
v_add_f32_dpp v84, v84, v84 row_ror:8 row_mask:0xf bank_mask:0xf
v_add_f32_dpp v85, v85, v85 row_ror:8 row_mask:0xf bank_mask:0xf
v_add_f32_dpp v86, v86, v86 row_ror:8 row_mask:0xf bank_mask:0xf
v_add_f32_dpp v87, v87, v87 row_ror:8 row_mask:0xf bank_mask:0xf
v_add_f32_dpp v88, v88, v88 row_ror:8 row_mask:0xf bank_mask:0xf
v_add_f32_dpp v89, v89, v89 row_ror:8 row_mask:0xf bank_mask:0xf
v_add_f32_dpp v90, v90, v90 row_ror:8 row_mask:0xf bank_mask:0xf
v_add_f32_dpp v91, v91, v91 row_ror:8 row_mask:0xf bank_mask:0xf
v_add_f32_dpp v92, v92, v92 row_ror:8 row_mask:0xf bank_mask:0xf
v_add_f32_dpp v93, v93, v93 row_ror:8 row_mask:0xf bank_mask:0xf
v_add_f32_dpp v94, v94, v94 row_ror:8 row_mask:0xf bank_mask:0xf
v_add_f32_dpp v95, v95, v95 row_ror:8 row_mask:0xf bank_mask:0xf
v_mov_b32 v96, v80
v_mov_b32 v97, v81
v_mov_b32 v98, v82
v_mov_b32 v99, v83
v_mov_b32 v100, v84
v_mov_b32 v101, v85
v_mov_b32 v102, v86
v_mov_b32 v103, v87
v_mov_b32 v104, v88
v_mov_b32 v105, v89
v_mov_b32 v106, v90
v_mov_b32 v107, v91
v_mov_b32 v108, v92
v_mov_b32 v109, v93
v_mov_b32 v110, v94
v_mov_b32 v111, v95
v_permlane16_swap_b32 v96, v80
v_permlane16_swap_b32 v97, v81
v_permlane16_swap_b32 v98, v82
v_permlane16_swap_b32 v99, v83
v_permlane16_swap_b32 v100, v84
v_permlane16_swap_b32 v101, v85
v_permlane16_swap_b32 v102, v86
v_permlane16_swap_b32 v103, v87
v_permlane16_swap_b32 v104, v88
v_permlane16_swap_b32 v105, v89
v_permlane16_swap_b32 v106, v90
v_permlane16_swap_b32 v107, v91
v_permlane16_swap_b32 v108, v92
v_permlane16_swap_b32 v109, v93
v_permlane16_swap_b32 v110, v94
v_permlane16_swap_b32 v111, v95
Va 80,80,96
Va 81,81,97
Va 82,82,98
Va 83,83,99
Va 84,84,100
Va 85,85,101
Va 86,86,102
Va 87,87,103
Va 88,88,104
Va 89,89,105
Va 90,90,106
Va 91,91,107
Va 92,92,108
Va 93,93,109
Va 94,94,110
Va 95,95,111
v_mov_b32 v96, v80
v_mov_b32 v97, v81
v_mov_b32 v98, v82
v_mov_b32 v99, v83
v_mov_b32 v100, v84
v_mov_b32 v101, v85
v_mov_b32 v102, v86
v_mov_b32 v103, v87
v_mov_b32 v104, v88
v_mov_b32 v105, v89
v_mov_b32 v106, v90
v_mov_b32 v107, v91
v_mov_b32 v108, v92
v_mov_b32 v109, v93
v_mov_b32 v110, v94
v_mov_b32 v111, v95
v_permlane32_swap_b32 v96, v80
v_permlane32_swap_b32 v97, v81
v_permlane32_swap_b32 v98, v82
v_permlane32_swap_b32 v99, v83
v_permlane32_swap_b32 v100, v84
v_permlane32_swap_b32 v101, v85
v_permlane32_swap_b32 v102, v86
v_permlane32_swap_b32 v103, v87
v_permlane32_swap_b32 v104, v88
v_permlane32_swap_b32 v105, v89
v_permlane32_swap_b32 v106, v90
v_permlane32_swap_b32 v107, v91
v_permlane32_swap_b32 v108, v92
v_permlane32_swap_b32 v109, v93
v_permlane32_swap_b32 v110, v94
v_permlane32_swap_b32 v111, v95
Va 80,80,96
Va 81,81,97
Va 82,82,98
Va 83,83,99
Va 84,84,100
Va 85,85,101
Va 86,86,102
Va 87,87,103
Va 88,88,104
Va 89,89,105
Va 90,90,106
Va 91,91,107
Va 92,92,108
Va 93,93,109
Va 94,94,110
Va 95,95,111
Vc 124,80,81
v_lshlrev_b32_e64 v80, 16, v124
v_and_b32 v81, 0xffff0000, v124
Vc 124,82,83
v_lshlrev_b32_e64 v82, 16, v124
v_and_b32 v83, 0xffff0000, v124
Vc 124,84,85
v_lshlrev_b32_e64 v84, 16, v124
v_and_b32 v85, 0xffff0000, v124
Vc 124,86,87
v_lshlrev_b32_e64 v86, 16, v124
v_and_b32 v87, 0xffff0000, v124
Vc 124,88,89
v_lshlrev_b32_e64 v88, 16, v124
v_and_b32 v89, 0xffff0000, v124
Vc 124,90,91
v_lshlrev_b32_e64 v90, 16, v124
v_and_b32 v91, 0xffff0000, v124
Vc 124,92,93
v_lshlrev_b32_e64 v92, 16, v124
v_and_b32 v93, 0xffff0000, v124
Vc 124,94,95
v_lshlrev_b32_e64 v94, 16, v124
v_and_b32 v95, 0xffff0000, v124
v_mul_f32 v80, s100, v80
v_mul_f32 v81, s100, v81
v_mul_f32 v82, s100, v82
v_mul_f32 v83, s100, v83
v_mul_f32 v84, s100, v84
v_mul_f32 v85, s100, v85
v_mul_f32 v86, s100, v86
v_mul_f32 v87, s100, v87
v_mul_f32 v88, s101, v88
v_mul_f32 v89, s101, v89
v_mul_f32 v90, s101, v90
v_mul_f32 v91, s101, v91
v_mul_f32 v92, s101, v92
v_mul_f32 v93, s101, v93
v_mul_f32 v94, s101, v94
v_mul_f32 v95, s101, v95
Vc 124,80,81
v_lshlrev_b32_e64 v80, 16, v124
v_and_b32 v81, 0xffff0000, v124
Vc 124,82,83
v_lshlrev_b32_e64 v82, 16, v124
v_and_b32 v83, 0xffff0000, v124
Vc 124,84,85
v_lshlrev_b32_e64 v84, 16, v124
v_and_b32 v85, 0xffff0000, v124
Vc 124,86,87
v_lshlrev_b32_e64 v86, 16, v124
v_and_b32 v87, 0xffff0000, v124
Vc 124,88,89
v_lshlrev_b32_e64 v88, 16, v124
v_and_b32 v89, 0xffff0000, v124
Vc 124,90,91
v_lshlrev_b32_e64 v90, 16, v124
v_and_b32 v91, 0xffff0000, v124
Vc 124,92,93
v_lshlrev_b32_e64 v92, 16, v124
v_and_b32 v93, 0xffff0000, v124
Vc 124,94,95
v_lshlrev_b32_e64 v94, 16, v124
v_and_b32 v95, 0xffff0000, v124
s_lshl_b32 s3, s45, 7
s_sub_u32 s42, s42, s3
s_sub_u32 s43, s43, s3
v_add_u32 v124, 0, v120
v_cmp_eq_u32 vcc, s42, v124
v_cmp_eq_u32 s[6:7], s43, v124
s_nop 3
s_or_b64 s[4:5], vcc, s[6:7]
s_cbranch_scc0 L_f_selskip1
v_cndmask_b32 v96, 0, v80, vcc
v_cndmask_b32 v96, v96, v88, s[6:7]
v_cndmask_b32 v97, 0, v81, vcc
v_cndmask_b32 v97, v97, v89, s[6:7]
v_cndmask_b32 v98, 0, v82, vcc
v_cndmask_b32 v98, v98, v90, s[6:7]
v_cndmask_b32 v99, 0, v83, vcc
v_cndmask_b32 v99, v99, v91, s[6:7]
v_cndmask_b32 v100, 0, v84, vcc
v_cndmask_b32 v100, v100, v92, s[6:7]
v_cndmask_b32 v101, 0, v85, vcc
v_cndmask_b32 v101, v101, v93, s[6:7]
v_cndmask_b32 v102, 0, v86, vcc
v_cndmask_b32 v102, v102, v94, s[6:7]
v_cndmask_b32 v103, 0, v87, vcc
v_cndmask_b32 v103, v103, v95, s[6:7]
v_lshlrev_b32_e64 v42, 16, v18
v_and_b32 v43, 0xffff0000, v18
v_lshlrev_b32_e64 v44, 16, v19
v_and_b32 v45, 0xffff0000, v19
v_lshlrev_b32_e64 v46, 16, v20
v_and_b32 v47, 0xffff0000, v20
v_lshlrev_b32_e64 v48, 16, v21
v_and_b32 v49, 0xffff0000, v21
Vs 42,42,34
Vs 43,43,34
Vs 44,44,34
Vs 45,45,34
Vs 46,46,34
Vs 47,47,34
Vs 48,48,34
Vs 49,49,34
Vc 2,42,43
v_lshlrev_b32_e64 v42, 16, v2
v_and_b32 v43, 0xffff0000, v2
Vc 3,44,45
v_lshlrev_b32_e64 v44, 16, v3
v_and_b32 v45, 0xffff0000, v3
Vc 4,46,47
v_lshlrev_b32_e64 v46, 16, v4
v_and_b32 v47, 0xffff0000, v4
Vc 5,48,49
v_lshlrev_b32_e64 v48, 16, v5
v_and_b32 v49, 0xffff0000, v5
Vm 42,42,35
Vm 43,43,35
Vm 44,44,35
Vm 45,45,35
Vm 46,46,35
Vm 47,47,35
Vm 48,48,35
Vm 49,49,35
Vc 2,42,43
v_lshlrev_b32_e64 v42, 16, v2
v_and_b32 v43, 0xffff0000, v2
Vc 3,44,45
v_lshlrev_b32_e64 v44, 16, v3
v_and_b32 v45, 0xffff0000, v3
Vc 4,46,47
v_lshlrev_b32_e64 v46, 16, v4
v_and_b32 v47, 0xffff0000, v4
Vc 5,48,49
v_lshlrev_b32_e64 v48, 16, v5
v_and_b32 v49, 0xffff0000, v5
Va 42,42,96
Va 43,43,97
Va 44,44,98
Va 45,45,99
Va 46,46,100
Va 47,47,101
Va 48,48,102
Va 49,49,103
Vc 2,42,43
v_lshlrev_b32_e64 v42, 16, v2
v_and_b32 v43, 0xffff0000, v2
Vc 3,44,45
v_lshlrev_b32_e64 v44, 16, v3
v_and_b32 v45, 0xffff0000, v3
Vc 4,46,47
v_lshlrev_b32_e64 v46, 16, v4
v_and_b32 v47, 0xffff0000, v4
Vc 5,48,49
v_lshlrev_b32_e64 v48, 16, v5
v_and_b32 v49, 0xffff0000, v5
v_mul_f32 v2, 0xbfb8aa3b, v42
v_mul_f32 v3, 0xbfb8aa3b, v43
v_mul_f32 v4, 0xbfb8aa3b, v44
v_mul_f32 v5, 0xbfb8aa3b, v45
v_mul_f32 v6, 0xbfb8aa3b, v46
v_mul_f32 v7, 0xbfb8aa3b, v47
v_mul_f32 v8, 0xbfb8aa3b, v48
v_mul_f32 v9, 0xbfb8aa3b, v49
Ve 2,2
Ve 3,3
Ve 4,4
Ve 5,5
Ve 6,6
Ve 7,7
Ve 8,8
Ve 9,9
v_add_f32 v2, 1.0, v2
v_add_f32 v3, 1.0, v3
v_add_f32 v4, 1.0, v4
v_add_f32 v5, 1.0, v5
v_add_f32 v6, 1.0, v6
v_add_f32 v7, 1.0, v7
v_add_f32 v8, 1.0, v8
v_add_f32 v9, 1.0, v9
v_rcp_f32 v2, v2
v_rcp_f32 v3, v3
v_rcp_f32 v4, v4
v_rcp_f32 v5, v5
v_rcp_f32 v6, v6
v_rcp_f32 v7, v7
v_rcp_f32 v8, v8
v_rcp_f32 v9, v9
Vm 42,42,2
Vm 43,43,3
Vm 44,44,4
Vm 45,45,5
Vm 46,46,6
Vm 47,47,7
Vm 48,48,8
Vm 49,49,9
Vc 2,42,43
v_lshlrev_b32_e64 v42, 16, v2
v_and_b32 v43, 0xffff0000, v2
Vc 3,44,45
v_lshlrev_b32_e64 v44, 16, v3
v_and_b32 v45, 0xffff0000, v3
Vc 4,46,47
v_lshlrev_b32_e64 v46, 16, v4
v_and_b32 v47, 0xffff0000, v4
Vc 5,48,49
v_lshlrev_b32_e64 v48, 16, v5
v_and_b32 v49, 0xffff0000, v5
L_f_selskip1:
v_add_u32 v124, 32, v120
v_cmp_eq_u32 vcc, s42, v124
v_cmp_eq_u32 s[6:7], s43, v124
s_nop 3
s_or_b64 s[4:5], vcc, s[6:7]
s_cbranch_scc0 L_f_selskip2
v_cndmask_b32 v96, 0, v80, vcc
v_cndmask_b32 v96, v96, v88, s[6:7]
v_cndmask_b32 v97, 0, v81, vcc
v_cndmask_b32 v97, v97, v89, s[6:7]
v_cndmask_b32 v98, 0, v82, vcc
v_cndmask_b32 v98, v98, v90, s[6:7]
v_cndmask_b32 v99, 0, v83, vcc
v_cndmask_b32 v99, v99, v91, s[6:7]
v_cndmask_b32 v100, 0, v84, vcc
v_cndmask_b32 v100, v100, v92, s[6:7]
v_cndmask_b32 v101, 0, v85, vcc
v_cndmask_b32 v101, v101, v93, s[6:7]
v_cndmask_b32 v102, 0, v86, vcc
v_cndmask_b32 v102, v102, v94, s[6:7]
v_cndmask_b32 v103, 0, v87, vcc
v_cndmask_b32 v103, v103, v95, s[6:7]
v_lshlrev_b32 v50, 16, v22
v_and_b32 v51, 0xffff0000, v22
v_lshlrev_b32_e64 v52, 16, v23
v_and_b32 v53, 0xffff0000, v23
v_lshlrev_b32_e64 v54, 16, v24
v_and_b32 v55, 0xffff0000, v24
v_lshlrev_b32_e64 v56, 16, v25
v_and_b32 v57, 0xffff0000, v25
Vs 50,50,36
Vs 51,51,36
Vs 52,52,36
Vs 53,53,36
Vs 54,54,36
Vs 55,55,36
Vs 56,56,36
Vs 57,57,36
Vc 2,50,51
v_lshlrev_b32_e64 v50, 16, v2
v_and_b32 v51, 0xffff0000, v2
Vc 3,52,53
v_lshlrev_b32_e64 v52, 16, v3
v_and_b32 v53, 0xffff0000, v3
Vc 4,54,55
v_lshlrev_b32_e64 v54, 16, v4
v_and_b32 v55, 0xffff0000, v4
Vc 5,56,57
v_lshlrev_b32_e64 v56, 16, v5
v_and_b32 v57, 0xffff0000, v5
Vm 50,50,37
Vm 51,51,37
Vm 52,52,37
Vm 53,53,37
Vm 54,54,37
Vm 55,55,37
Vm 56,56,37
Vm 57,57,37
Vc 2,50,51
v_lshlrev_b32_e64 v50, 16, v2
v_and_b32 v51, 0xffff0000, v2
Vc 3,52,53
v_lshlrev_b32_e64 v52, 16, v3
v_and_b32 v53, 0xffff0000, v3
Vc 4,54,55
v_lshlrev_b32_e64 v54, 16, v4
v_and_b32 v55, 0xffff0000, v4
Vc 5,56,57
v_lshlrev_b32_e64 v56, 16, v5
v_and_b32 v57, 0xffff0000, v5
Va 50,50,96
Va 51,51,97
Va 52,52,98
Va 53,53,99
Va 54,54,100
Va 55,55,101
Va 56,56,102
Va 57,57,103
Vc 2,50,51
v_lshlrev_b32_e64 v50, 16, v2
v_and_b32 v51, 0xffff0000, v2
Vc 3,52,53
v_lshlrev_b32_e64 v52, 16, v3
v_and_b32 v53, 0xffff0000, v3
Vc 4,54,55
v_lshlrev_b32_e64 v54, 16, v4
v_and_b32 v55, 0xffff0000, v4
Vc 5,56,57
v_lshlrev_b32_e64 v56, 16, v5
v_and_b32 v57, 0xffff0000, v5
v_mul_f32 v2, 0xbfb8aa3b, v50
v_mul_f32 v3, 0xbfb8aa3b, v51
v_mul_f32 v4, 0xbfb8aa3b, v52
v_mul_f32 v5, 0xbfb8aa3b, v53
v_mul_f32 v6, 0xbfb8aa3b, v54
v_mul_f32 v7, 0xbfb8aa3b, v55
v_mul_f32 v8, 0xbfb8aa3b, v56
v_mul_f32 v9, 0xbfb8aa3b, v57
Ve 2,2
Ve 3,3
Ve 4,4
Ve 5,5
Ve 6,6
Ve 7,7
Ve 8,8
Ve 9,9
v_add_f32 v2, 1.0, v2
v_add_f32 v3, 1.0, v3
v_add_f32 v4, 1.0, v4
v_add_f32 v5, 1.0, v5
v_add_f32 v6, 1.0, v6
v_add_f32 v7, 1.0, v7
v_add_f32 v8, 1.0, v8
v_add_f32 v9, 1.0, v9
v_rcp_f32 v2, v2
v_rcp_f32 v3, v3
v_rcp_f32 v4, v4
v_rcp_f32 v5, v5
v_rcp_f32 v6, v6
v_rcp_f32 v7, v7
v_rcp_f32 v8, v8
v_rcp_f32 v9, v9
Vm 50,50,2
Vm 51,51,3
Vm 52,52,4
Vm 53,53,5
Vm 54,54,6
Vm 55,55,7
Vm 56,56,8
Vm 57,57,9
Vc 2,50,51
v_lshlrev_b32_e64 v50, 16, v2
v_and_b32 v51, 0xffff0000, v2
Vc 3,52,53
v_lshlrev_b32_e64 v52, 16, v3
v_and_b32 v53, 0xffff0000, v3
Vc 4,54,55
v_lshlrev_b32_e64 v54, 16, v4
v_and_b32 v55, 0xffff0000, v4
Vc 5,56,57
v_lshlrev_b32_e64 v56, 16, v5
v_and_b32 v57, 0xffff0000, v5
L_f_selskip2:
v_add_u32 v124, 64, v120
v_cmp_eq_u32 vcc, s42, v124
v_cmp_eq_u32 s[6:7], s43, v124
s_nop 3
s_or_b64 s[4:5], vcc, s[6:7]
s_cbranch_scc0 L_f_selskip3
v_cndmask_b32 v96, 0, v80, vcc
v_cndmask_b32 v96, v96, v88, s[6:7]
v_cndmask_b32 v97, 0, v81, vcc
v_cndmask_b32 v97, v97, v89, s[6:7]
v_cndmask_b32 v98, 0, v82, vcc
v_cndmask_b32 v98, v98, v90, s[6:7]
v_cndmask_b32 v99, 0, v83, vcc
v_cndmask_b32 v99, v99, v91, s[6:7]
v_cndmask_b32 v100, 0, v84, vcc
v_cndmask_b32 v100, v100, v92, s[6:7]
v_cndmask_b32 v101, 0, v85, vcc
v_cndmask_b32 v101, v101, v93, s[6:7]
v_cndmask_b32 v102, 0, v86, vcc
v_cndmask_b32 v102, v102, v94, s[6:7]
v_cndmask_b32 v103, 0, v87, vcc
v_cndmask_b32 v103, v103, v95, s[6:7]
v_lshlrev_b32 v58, 16, v26
v_and_b32 v59, 0xffff0000, v26
v_lshlrev_b32_e64 v60, 16, v27
v_and_b32 v61, 0xffff0000, v27
v_lshlrev_b32_e64 v62, 16, v28
v_and_b32 v63, 0xffff0000, v28
v_lshlrev_b32_e64 v64, 16, v29
v_and_b32 v65, 0xffff0000, v29
Vs 58,58,38
Vs 59,59,38
Vs 60,60,38
Vs 61,61,38
Vs 62,62,38
Vs 63,63,38
Vs 64,64,38
Vs 65,65,38
Vc 2,58,59
v_lshlrev_b32_e64 v58, 16, v2
v_and_b32 v59, 0xffff0000, v2
Vc 3,60,61
v_lshlrev_b32_e64 v60, 16, v3
v_and_b32 v61, 0xffff0000, v3
Vc 4,62,63
v_lshlrev_b32_e64 v62, 16, v4
v_and_b32 v63, 0xffff0000, v4
Vc 5,64,65
v_lshlrev_b32_e64 v64, 16, v5
v_and_b32 v65, 0xffff0000, v5
Vm 58,58,39
Vm 59,59,39
Vm 60,60,39
Vm 61,61,39
Vm 62,62,39
Vm 63,63,39
Vm 64,64,39
Vm 65,65,39
Vc 2,58,59
v_lshlrev_b32_e64 v58, 16, v2
v_and_b32 v59, 0xffff0000, v2
Vc 3,60,61
v_lshlrev_b32_e64 v60, 16, v3
v_and_b32 v61, 0xffff0000, v3
Vc 4,62,63
v_lshlrev_b32_e64 v62, 16, v4
v_and_b32 v63, 0xffff0000, v4
Vc 5,64,65
v_lshlrev_b32_e64 v64, 16, v5
v_and_b32 v65, 0xffff0000, v5
Va 58,58,96
Va 59,59,97
Va 60,60,98
Va 61,61,99
Va 62,62,100
Va 63,63,101
Va 64,64,102
Va 65,65,103
Vc 2,58,59
v_lshlrev_b32_e64 v58, 16, v2
v_and_b32 v59, 0xffff0000, v2
Vc 3,60,61
v_lshlrev_b32_e64 v60, 16, v3
v_and_b32 v61, 0xffff0000, v3
Vc 4,62,63
v_lshlrev_b32_e64 v62, 16, v4
v_and_b32 v63, 0xffff0000, v4
Vc 5,64,65
v_lshlrev_b32_e64 v64, 16, v5
v_and_b32 v65, 0xffff0000, v5
v_mul_f32 v2, 0xbfb8aa3b, v58
v_mul_f32 v3, 0xbfb8aa3b, v59
v_mul_f32 v4, 0xbfb8aa3b, v60
v_mul_f32 v5, 0xbfb8aa3b, v61
v_mul_f32 v6, 0xbfb8aa3b, v62
v_mul_f32 v7, 0xbfb8aa3b, v63
v_mul_f32 v8, 0xbfb8aa3b, v64
v_mul_f32 v9, 0xbfb8aa3b, v65
Ve 2,2
Ve 3,3
Ve 4,4
Ve 5,5
Ve 6,6
Ve 7,7
Ve 8,8
Ve 9,9
v_add_f32 v2, 1.0, v2
v_add_f32 v3, 1.0, v3
v_add_f32 v4, 1.0, v4
v_add_f32 v5, 1.0, v5
v_add_f32 v6, 1.0, v6
v_add_f32 v7, 1.0, v7
v_add_f32 v8, 1.0, v8
v_add_f32 v9, 1.0, v9
v_rcp_f32 v2, v2
v_rcp_f32 v3, v3
v_rcp_f32 v4, v4
v_rcp_f32 v5, v5
v_rcp_f32 v6, v6
v_rcp_f32 v7, v7
v_rcp_f32 v8, v8
v_rcp_f32 v9, v9
Vm 58,58,2
Vm 59,59,3
Vm 60,60,4
Vm 61,61,5
Vm 62,62,6
Vm 63,63,7
Vm 64,64,8
Vm 65,65,9
Vc 2,58,59
v_lshlrev_b32_e64 v58, 16, v2
v_and_b32 v59, 0xffff0000, v2
Vc 3,60,61
v_lshlrev_b32_e64 v60, 16, v3
v_and_b32 v61, 0xffff0000, v3
Vc 4,62,63
v_lshlrev_b32_e64 v62, 16, v4
v_and_b32 v63, 0xffff0000, v4
Vc 5,64,65
v_lshlrev_b32_e64 v64, 16, v5
v_and_b32 v65, 0xffff0000, v5
L_f_selskip3:
v_add_u32 v124, 96, v120
v_cmp_eq_u32 vcc, s42, v124
v_cmp_eq_u32 s[6:7], s43, v124
s_nop 3
s_or_b64 s[4:5], vcc, s[6:7]
s_cbranch_scc0 L_f_selskip4
v_cndmask_b32 v96, 0, v80, vcc
v_cndmask_b32 v96, v96, v88, s[6:7]
v_cndmask_b32 v97, 0, v81, vcc
v_cndmask_b32 v97, v97, v89, s[6:7]
v_cndmask_b32 v98, 0, v82, vcc
v_cndmask_b32 v98, v98, v90, s[6:7]
v_cndmask_b32 v99, 0, v83, vcc
v_cndmask_b32 v99, v99, v91, s[6:7]
v_cndmask_b32 v100, 0, v84, vcc
v_cndmask_b32 v100, v100, v92, s[6:7]
v_cndmask_b32 v101, 0, v85, vcc
v_cndmask_b32 v101, v101, v93, s[6:7]
v_cndmask_b32 v102, 0, v86, vcc
v_cndmask_b32 v102, v102, v94, s[6:7]
v_cndmask_b32 v103, 0, v87, vcc
v_cndmask_b32 v103, v103, v95, s[6:7]
v_lshlrev_b32_e64 v66, 16, v30
v_and_b32 v67, 0xffff0000, v30
v_lshlrev_b32_e64 v68, 16, v31
v_and_b32 v69, 0xffff0000, v31
v_lshlrev_b32_e64 v70, 16, v32
v_and_b32 v71, 0xffff0000, v32
v_lshlrev_b32_e64 v72, 16, v33
v_and_b32 v73, 0xffff0000, v33
Vs 66,66,40
Vs 67,67,40
Vs 68,68,40
Vs 69,69,40
Vs 70,70,40
Vs 71,71,40
Vs 72,72,40
Vs 73,73,40
Vc 2,66,67
v_lshlrev_b32_e64 v66, 16, v2
v_and_b32 v67, 0xffff0000, v2
Vc 3,68,69
v_lshlrev_b32_e64 v68, 16, v3
v_and_b32 v69, 0xffff0000, v3
Vc 4,70,71
v_lshlrev_b32_e64 v70, 16, v4
v_and_b32 v71, 0xffff0000, v4
Vc 5,72,73
v_lshlrev_b32_e64 v72, 16, v5
v_and_b32 v73, 0xffff0000, v5
Vm 66,66,41
Vm 67,67,41
Vm 68,68,41
Vm 69,69,41
Vm 70,70,41
Vm 71,71,41
Vm 72,72,41
Vm 73,73,41
Vc 2,66,67
v_lshlrev_b32_e64 v66, 16, v2
v_and_b32 v67, 0xffff0000, v2
Vc 3,68,69
v_lshlrev_b32_e64 v68, 16, v3
v_and_b32 v69, 0xffff0000, v3
Vc 4,70,71
v_lshlrev_b32_e64 v70, 16, v4
v_and_b32 v71, 0xffff0000, v4
Vc 5,72,73
v_lshlrev_b32_e64 v72, 16, v5
v_and_b32 v73, 0xffff0000, v5
Va 66,66,96
Va 67,67,97
Va 68,68,98
Va 69,69,99
Va 70,70,100
Va 71,71,101
Va 72,72,102
Va 73,73,103
Vc 2,66,67
v_lshlrev_b32_e64 v66, 16, v2
v_and_b32 v67, 0xffff0000, v2
Vc 3,68,69
v_lshlrev_b32_e64 v68, 16, v3
v_and_b32 v69, 0xffff0000, v3
Vc 4,70,71
v_lshlrev_b32_e64 v70, 16, v4
v_and_b32 v71, 0xffff0000, v4
Vc 5,72,73
v_lshlrev_b32_e64 v72, 16, v5
v_and_b32 v73, 0xffff0000, v5
v_mul_f32 v2, 0xbfb8aa3b, v66
v_mul_f32 v3, 0xbfb8aa3b, v67
v_mul_f32 v4, 0xbfb8aa3b, v68
v_mul_f32 v5, 0xbfb8aa3b, v69
v_mul_f32 v6, 0xbfb8aa3b, v70
v_mul_f32 v7, 0xbfb8aa3b, v71
v_mul_f32 v8, 0xbfb8aa3b, v72
v_mul_f32 v9, 0xbfb8aa3b, v73
Ve 2,2
Ve 3,3
Ve 4,4
Ve 5,5
Ve 6,6
Ve 7,7
Ve 8,8
Ve 9,9
v_add_f32 v2, 1.0, v2
v_add_f32 v3, 1.0, v3
v_add_f32 v4, 1.0, v4
v_add_f32 v5, 1.0, v5
v_add_f32 v6, 1.0, v6
v_add_f32 v7, 1.0, v7
v_add_f32 v8, 1.0, v8
v_add_f32 v9, 1.0, v9
v_rcp_f32 v2, v2
v_rcp_f32 v3, v3
v_rcp_f32 v4, v4
v_rcp_f32 v5, v5
v_rcp_f32 v6, v6
v_rcp_f32 v7, v7
v_rcp_f32 v8, v8
v_rcp_f32 v9, v9
Vm 66,66,2
Vm 67,67,3
Vm 68,68,4
Vm 69,69,5
Vm 70,70,6
Vm 71,71,7
Vm 72,72,8
Vm 73,73,9
Vc 2,66,67
v_lshlrev_b32_e64 v66, 16, v2
v_and_b32 v67, 0xffff0000, v2
Vc 3,68,69
v_lshlrev_b32_e64 v68, 16, v3
v_and_b32 v69, 0xffff0000, v3
Vc 4,70,71
v_lshlrev_b32_e64 v70, 16, v4
v_and_b32 v71, 0xffff0000, v4
Vc 5,72,73
v_lshlrev_b32_e64 v72, 16, v5
v_and_b32 v73, 0xffff0000, v5
L_f_selskip4:
s_branch L_yCr
L_p4_end:
L_spinAk:
s_mov_b32 s47, 0x400000
L_spinAk_l:
s_sleep 8
buffer_load_dword v30, v31, s[28:31], 0 offen sc1
s_waitcnt vmcnt(0)
v_readfirstlane_b32 s3, v30
s_sub_u32 s47, s47, 1
s_cmp_eq_u32 s47, 0
s_cbranch_scc1 L_spinArk
s_cmp_lt_u32 s3, 256
s_cbranch_scc1 L_spinAk_l
s_branch L_spinArk
L_spinAv:
s_mov_b32 s47, 0x400000
L_spinAv_l:
s_sleep 8
buffer_load_dword v30, v31, s[28:31], 0 offen sc1
s_waitcnt vmcnt(0)
v_readfirstlane_b32 s3, v30
s_sub_u32 s47, s47, 1
s_cmp_eq_u32 s47, 0
s_cbranch_scc1 L_spinArv
s_cmp_lt_u32 s3, 256
s_cbranch_scc1 L_spinAv_l
s_branch L_spinArv
L_spinB:
s_mov_b32 s59, 0x400000
L_spinB_l:
s_sleep 4
buffer_load_dword v12, v1, s[20:23], s6 offen sc1
s_sub_u32 s59, s59, 1
s_cmp_eq_u32 s59, 0
s_cbranch_scc1 L_spinBx
s_waitcnt vmcnt(0)
v_cmp_ne_u32 vcc, 1, v12
s_cbranch_vccnz L_spinB_l
L_spinBx:
s_waitcnt vmcnt(0)
s_branch L_spinBr
L_k2_fb_we:
s_nop 7
s_nop 0
v_max3_f32 v21, v128, v129, v130
v_max3_f32 v21, v21, v131, v132
v_max3_f32 v21, v21, v133, v134
v_max3_f32 v21, v21, v135, v136
v_max3_f32 v21, v21, v137, v138
v_max3_f32 v21, v21, v139, v140
v_max3_f32 v21, v21, v141, v142
v_max_f32 v21, v21, v143
v_mov_b32 v1, v21
s_nop 1
v_permlane16_swap_b32 v1, v21
v_max_f32 v21, v21, v1
v_mov_b32 v1, v21
s_nop 1
v_permlane32_swap_b32 v1, v21
v_max_f32_e64 v21, v21, v1
v_add_f32 v21, 0x41f80000, v21
v_max_f32 v21, 0, v21
Vs 128,128,21
Vs 129,129,21
Vs 130,130,21
Vs 131,131,21
Vs 132,132,21
Vs 133,133,21
Vs 134,134,21
Vs 135,135,21
Vs 136,136,21
Vs 137,137,21
Vs 138,138,21
Vs 139,139,21
Vs 140,140,21
Vs 141,141,21
Vs 142,142,21
Vs 143,143,21
Vs 192,192,21
Vs 193,193,21
Vs 194,194,21
Vs 195,195,21
Vs 196,196,21
Vs 197,197,21
Vs 198,198,21
Vs 199,199,21
Vs 200,200,21
Vs 201,201,21
Vs 202,202,21
Vs 203,203,21
Vs 204,204,21
Vs 205,205,21
Vs 206,206,21
Vs 207,207,21
Vs 32,32,21
Vs 33,33,21
Vs 34,34,21
v_sub_f32_e64 v35, v35, v21
v_exp_f32 v22, -v21
s_nop 0
Vm 48,48,22
Vm 49,49,22
Vm 50,50,22
v_mul_f32_e64 v51, v51, v22
Ar 8,0
Ar 9,1
Ar 10,2
Ar 11,3
Ar 12,4
Ar 13,5
Ar 14,6
Ar 15,7
Vm 8,8,22
Vm 9,9,22
Vm 10,10,22
Vm 11,11,22
Vm 12,12,22
Vm 13,13,22
Vm 14,14,22
Vm 15,15,22
Aw 0,8
Aw 1,9
Aw 2,10
Aw 3,11
Aw 4,12
Aw 5,13
Aw 6,14
Aw 7,15
Ar 8,8
Ar 9,9
Ar 10,10
Ar 11,11
Ar 12,12
Ar 13,13
Ar 14,14
Ar 15,15
Vm 8,8,22
Vm 9,9,22
Vm 10,10,22
Vm 11,11,22
Vm 12,12,22
Vm 13,13,22
Vm 14,14,22
Vm 15,15,22
Aw 8,8
Aw 9,9
Aw 10,10
Aw 11,11
Aw 12,12
Aw 13,13
Aw 14,14
Aw 15,15
Ar 8,16
Ar 9,17
Ar 10,18
Ar 11,19
Ar 12,20
Ar 13,21
Ar 14,22
Ar 15,23
Vm 8,8,22
Vm 9,9,22
Vm 10,10,22
Vm 11,11,22
Vm 12,12,22
Vm 13,13,22
Vm 14,14,22
Vm 15,15,22
Aw 16,8
Aw 17,9
Aw 18,10
Aw 19,11
Aw 20,12
Aw 21,13
Aw 22,14
Aw 23,15
Ar 8,24
Ar 9,25
Ar 10,26
Ar 11,27
Ar 12,28
Ar 13,29
Ar 14,30
Ar 15,31
Vm 8,8,22
Vm 9,9,22
Vm 10,10,22
Vm 11,11,22
Vm 12,12,22
Vm 13,13,22
Vm 14,14,22
Vm 15,15,22
Aw 24,8
Aw 25,9
Aw 26,10
Aw 27,11
Aw 28,12
Aw 29,13
Aw 30,14
Aw 31,15
v_max3_f32 v21, v144, v145, v146
v_max3_f32 v21, v21, v147, v148
v_max3_f32 v21, v21, v149, v150
v_max3_f32 v21, v21, v151, v152
v_max3_f32 v21, v21, v153, v154
v_max3_f32 v21, v21, v155, v156
v_max3_f32 v21, v21, v157, v158
v_max_f32 v21, v21, v159
v_mov_b32 v1, v21
s_nop 1
v_permlane16_swap_b32 v1, v21
v_max_f32 v21, v21, v1
v_mov_b32 v1, v21
s_nop 1
v_permlane32_swap_b32 v1, v21
v_max_f32_e64 v21, v21, v1
v_add_f32 v21, 0x41f80000, v21
v_max_f32 v21, 0, v21
Vs 144,144,21
Vs 145,145,21
Vs 146,146,21
Vs 147,147,21
Vs 148,148,21
Vs 149,149,21
Vs 150,150,21
Vs 151,151,21
Vs 152,152,21
Vs 153,153,21
Vs 154,154,21
Vs 155,155,21
Vs 156,156,21
Vs 157,157,21
Vs 158,158,21
Vs 159,159,21
Vs 208,208,21
Vs 209,209,21
Vs 210,210,21
Vs 211,211,21
Vs 212,212,21
Vs 213,213,21
Vs 214,214,21
Vs 215,215,21
Vs 216,216,21
Vs 217,217,21
Vs 218,218,21
Vs 219,219,21
Vs 220,220,21
Vs 221,221,21
Vs 222,222,21
Vs 223,223,21
Vs 36,36,21
Vs 37,37,21
Vs 38,38,21
v_sub_f32_e64 v39, v39, v21
v_exp_f32 v22, -v21
s_nop 0
Vm 52,52,22
Vm 53,53,22
Vm 54,54,22
v_mul_f32_e64 v55, v55, v22
Ar 8,32
Ar 9,33
Ar 10,34
Ar 11,35
Ar 12,36
Ar 13,37
Ar 14,38
Ar 15,39
Vm 8,8,22
Vm 9,9,22
Vm 10,10,22
Vm 11,11,22
Vm 12,12,22
Vm 13,13,22
Vm 14,14,22
Vm 15,15,22
Aw 32,8
Aw 33,9
Aw 34,10
Aw 35,11
Aw 36,12
Aw 37,13
Aw 38,14
Aw 39,15
Ar 8,40
Ar 9,41
Ar 10,42
Ar 11,43
Ar 12,44
Ar 13,45
Ar 14,46
Ar 15,47
Vm 8,8,22
Vm 9,9,22
Vm 10,10,22
Vm 11,11,22
Vm 12,12,22
Vm 13,13,22
Vm 14,14,22
Vm 15,15,22
Aw 40,8
Aw 41,9
Aw 42,10
Aw 43,11
Aw 44,12
Aw 45,13
Aw 46,14
Aw 47,15
Ar 8,48
Ar 9,49
Ar 10,50
Ar 11,51
Ar 12,52
Ar 13,53
Ar 14,54
Ar 15,55
Vm 8,8,22
Vm 9,9,22
Vm 10,10,22
Vm 11,11,22
Vm 12,12,22
Vm 13,13,22
Vm 14,14,22
Vm 15,15,22
Aw 48,8
Aw 49,9
Aw 50,10
Aw 51,11
Aw 52,12
Aw 53,13
Aw 54,14
Aw 55,15
Ar 8,56
Ar 9,57
Ar 10,58
Ar 11,59
Ar 12,60
Ar 13,61
Ar 14,62
Ar 15,63
Vm 8,8,22
Vm 9,9,22
Vm 10,10,22
Vm 11,11,22
Vm 12,12,22
Vm 13,13,22
Vm 14,14,22
Vm 15,15,22
Aw 56,8
Aw 57,9
Aw 58,10
Aw 59,11
Aw 60,12
Aw 61,13
Aw 62,14
Aw 63,15
v_max3_f32 v21, v160, v161, v162
v_max3_f32 v21, v21, v163, v164
v_max3_f32 v21, v21, v165, v166
v_max3_f32 v21, v21, v167, v168
v_max3_f32 v21, v21, v169, v170
v_max3_f32 v21, v21, v171, v172
v_max3_f32 v21, v21, v173, v174
v_max_f32 v21, v21, v175
v_mov_b32 v1, v21
s_nop 1
v_permlane16_swap_b32 v1, v21
v_max_f32 v21, v21, v1
v_mov_b32 v1, v21
s_nop 1
v_permlane32_swap_b32 v1, v21
v_max_f32_e64 v21, v21, v1
v_add_f32 v21, 0x41f80000, v21
v_max_f32 v21, 0, v21
Vs 160,160,21
Vs 161,161,21
Vs 162,162,21
Vs 163,163,21
Vs 164,164,21
Vs 165,165,21
Vs 166,166,21
Vs 167,167,21
Vs 168,168,21
Vs 169,169,21
Vs 170,170,21
Vs 171,171,21
Vs 172,172,21
Vs 173,173,21
Vs 174,174,21
Vs 175,175,21
Vs 224,224,21
Vs 225,225,21
Vs 226,226,21
Vs 227,227,21
Vs 228,228,21
Vs 229,229,21
Vs 230,230,21
Vs 231,231,21
Vs 232,232,21
Vs 233,233,21
Vs 234,234,21
Vs 235,235,21
Vs 236,236,21
Vs 237,237,21
Vs 238,238,21
Vs 239,239,21
Vs 40,40,21
Vs 41,41,21
Vs 42,42,21
v_sub_f32_e64 v43, v43, v21
v_exp_f32 v22, -v21
s_nop 0
Vm 56,56,22
Vm 57,57,22
Vm 58,58,22
v_mul_f32_e64 v59, v59, v22
Ar 8,64
Ar 9,65
Ar 10,66
Ar 11,67
Ar 12,68
Ar 13,69
Ar 14,70
Ar 15,71
Vm 8,8,22
Vm 9,9,22
Vm 10,10,22
Vm 11,11,22
Vm 12,12,22
Vm 13,13,22
Vm 14,14,22
Vm 15,15,22
Aw 64,8
Aw 65,9
Aw 66,10
Aw 67,11
Aw 68,12
Aw 69,13
Aw 70,14
Aw 71,15
Ar 8,72
Ar 9,73
Ar 10,74
Ar 11,75
Ar 12,76
Ar 13,77
Ar 14,78
Ar 15,79
Vm 8,8,22
Vm 9,9,22
Vm 10,10,22
Vm 11,11,22
Vm 12,12,22
Vm 13,13,22
Vm 14,14,22
Vm 15,15,22
Aw 72,8
Aw 73,9
Aw 74,10
Aw 75,11
Aw 76,12
Aw 77,13
Aw 78,14
Aw 79,15
Ar 8,80
Ar 9,81
Ar 10,82
Ar 11,83
Ar 12,84
Ar 13,85
Ar 14,86
Ar 15,87
Vm 8,8,22
Vm 9,9,22
Vm 10,10,22
Vm 11,11,22
Vm 12,12,22
Vm 13,13,22
Vm 14,14,22
Vm 15,15,22
Aw 80,8
Aw 81,9
Aw 82,10
Aw 83,11
Aw 84,12
Aw 85,13
Aw 86,14
Aw 87,15
Ar 8,88
Ar 9,89
Ar 10,90
Ar 11,91
Ar 12,92
Ar 13,93
Ar 14,94
Ar 15,95
Vm 8,8,22
Vm 9,9,22
Vm 10,10,22
Vm 11,11,22
Vm 12,12,22
Vm 13,13,22
Vm 14,14,22
Vm 15,15,22
Aw 88,8
Aw 89,9
Aw 90,10
Aw 91,11
Aw 92,12
Aw 93,13
Aw 94,14
Aw 95,15
v_max3_f32 v21, v176, v177, v178
v_max3_f32 v21, v21, v179, v180
v_max3_f32 v21, v21, v181, v182
v_max3_f32 v21, v21, v183, v184
v_max3_f32 v21, v21, v185, v186
v_max3_f32 v21, v21, v187, v188
v_max3_f32 v21, v21, v189, v190
v_max_f32 v21, v21, v191
v_mov_b32 v1, v21
s_nop 1
v_permlane16_swap_b32 v1, v21
v_max_f32 v21, v21, v1
v_mov_b32 v1, v21
s_nop 1
v_permlane32_swap_b32 v1, v21
v_max_f32_e64 v21, v21, v1
v_add_f32 v21, 0x41f80000, v21
v_max_f32 v21, 0, v21
Vs 176,176,21
Vs 177,177,21
Vs 178,178,21
Vs 179,179,21
Vs 180,180,21
Vs 181,181,21
Vs 182,182,21
Vs 183,183,21
Vs 184,184,21
Vs 185,185,21
Vs 186,186,21
Vs 187,187,21
Vs 188,188,21
Vs 189,189,21
Vs 190,190,21
Vs 191,191,21
Vs 240,240,21
Vs 241,241,21
Vs 242,242,21
Vs 243,243,21
Vs 244,244,21
Vs 245,245,21
Vs 246,246,21
Vs 247,247,21
Vs 248,248,21
Vs 249,249,21
Vs 250,250,21
Vs 251,251,21
Vs 252,252,21
Vs 253,253,21
Vs 254,254,21
Vs 255,255,21
Vs 44,44,21
Vs 45,45,21
Vs 46,46,21
v_sub_f32_e64 v47, v47, v21
v_exp_f32 v22, -v21
s_nop 0
Vm 60,60,22
Vm 61,61,22
Vm 62,62,22
v_mul_f32_e64 v63, v63, v22
Ar 8,96
Ar 9,97
Ar 10,98
Ar 11,99
Ar 12,100
Ar 13,101
Ar 14,102
Ar 15,103
Vm 8,8,22
Vm 9,9,22
Vm 10,10,22
Vm 11,11,22
Vm 12,12,22
Vm 13,13,22
Vm 14,14,22
Vm 15,15,22
Aw 96,8
Aw 97,9
Aw 98,10
Aw 99,11
Aw 100,12
Aw 101,13
Aw 102,14
Aw 103,15
Ar 8,104
Ar 9,105
Ar 10,106
Ar 11,107
Ar 12,108
Ar 13,109
Ar 14,110
Ar 15,111
Vm 8,8,22
Vm 9,9,22
Vm 10,10,22
Vm 11,11,22
Vm 12,12,22
Vm 13,13,22
Vm 14,14,22
Vm 15,15,22
Aw 104,8
Aw 105,9
Aw 106,10
Aw 107,11
Aw 108,12
Aw 109,13
Aw 110,14
Aw 111,15
Ar 8,112
Ar 9,113
Ar 10,114
Ar 11,115
Ar 12,116
Ar 13,117
Ar 14,118
Ar 15,119
Vm 8,8,22
Vm 9,9,22
Vm 10,10,22
Vm 11,11,22
Vm 12,12,22
Vm 13,13,22
Vm 14,14,22
Vm 15,15,22
Aw 112,8
Aw 113,9
Aw 114,10
Aw 115,11
Aw 116,12
Aw 117,13
Aw 118,14
Aw 119,15
Ar 8,120
Ar 9,121
Ar 10,122
Ar 11,123
Ar 12,124
Ar 13,125
Ar 14,126
Ar 15,127
Vm 8,8,22
Vm 9,9,22
Vm 10,10,22
Vm 11,11,22
Vm 12,12,22
Vm 13,13,22
Vm 14,14,22
Vm 15,15,22
Aw 120,8
Aw 121,9
Aw 122,10
Aw 123,11
Aw 124,12
Aw 125,13
Aw 126,14
Aw 127,15
Ve 8,128
Ve 9,129
s_nop 0
Vc 64,8,9
Ve 8,130
Ve 9,131
s_nop 0
Vc 65,8,9
Ve 8,144
Ve 9,145
s_nop 0
Vc 72,8,9
Ve 8,146
Ve 9,147
s_nop 0
Vc 73,8,9
Ve 8,160
Ve 9,161
s_nop 0
Vc 80,8,9
Ve 8,162
Ve 9,163
s_nop 0
Vc 81,8,9
Ve 8,176
Ve 9,177
s_nop 0
Vc 88,8,9
Ve 8,178
Ve 9,179
s_nop 0
Vc 89,8,9
Ve 8,132
Ve 9,133
s_nop 0
Vc 66,8,9
Ve 8,134
Ve 9,135
s_nop 0
Vc 67,8,9
Ve 8,148
Ve 9,149
s_nop 0
Vc 74,8,9
Ve 8,150
Ve 9,151
s_nop 0
Vc 75,8,9
Ve 8,164
Ve 9,165
s_nop 0
Vc 82,8,9
Ve 8,166
Ve 9,167
s_nop 0
Vc 83,8,9
Ve 8,180
Ve 9,181
s_nop 0
Vc 90,8,9
Ve 8,182
Ve 9,183
s_nop 0
Vc 91,8,9
Ve 8,136
Ve 9,137
s_nop 0
Vc 68,8,9
Ve 8,138
Ve 9,139
s_nop 0
Vc 69,8,9
Ve 8,152
Ve 9,153
s_nop 0
Vc 76,8,9
Ve 8,154
Ve 9,155
s_nop 0
Vc 77,8,9
Ve 8,168
Ve 9,169
s_nop 0
Vc 84,8,9
Ve 8,170
Ve 9,171
s_nop 0
Vc 85,8,9
Ve 8,184
Ve 9,185
s_nop 0
Vc 92,8,9
Ve 8,186
Ve 9,187
s_nop 0
Vc 93,8,9
Ve 8,140
Ve 9,141
s_nop 0
Vc 70,8,9
Ve 8,142
Ve 9,143
s_nop 0
Vc 71,8,9
Ve 8,156
Ve 9,157
s_nop 0
Vc 78,8,9
Ve 8,158
Ve 9,159
s_nop 0
Vc 79,8,9
Ve 8,172
Ve 9,173
s_nop 0
Vc 86,8,9
Ve 8,174
Ve 9,175
s_nop 0
Vc 87,8,9
Ve 8,188
Ve 9,189
s_nop 0
Vc 94,8,9
Ve 8,190
Ve 9,191
s_nop 0
Vc 95,8,9
s_nop 1
s_branch L_k2_fbr_we
L_k2_fb_wo:
s_nop 7
s_nop 0
v_max3_f32 v21, v192, v193, v194
v_max3_f32 v21, v21, v195, v196
v_max3_f32 v21, v21, v197, v198
v_max3_f32 v21, v21, v199, v200
v_max3_f32 v21, v21, v201, v202
v_max3_f32 v21, v21, v203, v204
v_max3_f32 v21, v21, v205, v206
v_max_f32 v21, v21, v207
v_mov_b32 v1, v21
s_nop 1
v_permlane16_swap_b32 v1, v21
v_max_f32 v21, v21, v1
v_mov_b32 v1, v21
s_nop 1
v_permlane32_swap_b32 v1, v21
v_max_f32_e64 v21, v21, v1
v_add_f32 v21, 0x41f80000, v21
v_max_f32 v21, 0, v21
Vs 192,192,21
Vs 193,193,21
Vs 194,194,21
Vs 195,195,21
Vs 196,196,21
Vs 197,197,21
Vs 198,198,21
Vs 199,199,21
Vs 200,200,21
Vs 201,201,21
Vs 202,202,21
Vs 203,203,21
Vs 204,204,21
Vs 205,205,21
Vs 206,206,21
Vs 207,207,21
Vs 128,128,21
Vs 129,129,21
Vs 130,130,21
Vs 131,131,21
Vs 132,132,21
Vs 133,133,21
Vs 134,134,21
Vs 135,135,21
Vs 136,136,21
Vs 137,137,21
Vs 138,138,21
Vs 139,139,21
Vs 140,140,21
Vs 141,141,21
Vs 142,142,21
Vs 143,143,21
Vs 32,32,21
Vs 33,33,21
Vs 34,34,21
v_sub_f32_e64 v35, v35, v21
v_exp_f32 v22, -v21
s_nop 0
Vm 48,48,22
Vm 49,49,22
Vm 50,50,22
v_mul_f32_e64 v51, v51, v22
Ar 8,0
Ar 9,1
Ar 10,2
Ar 11,3
Ar 12,4
Ar 13,5
Ar 14,6
Ar 15,7
Vm 8,8,22
Vm 9,9,22
Vm 10,10,22
Vm 11,11,22
Vm 12,12,22
Vm 13,13,22
Vm 14,14,22
Vm 15,15,22
Aw 0,8
Aw 1,9
Aw 2,10
Aw 3,11
Aw 4,12
Aw 5,13
Aw 6,14
Aw 7,15
Ar 8,8
Ar 9,9
Ar 10,10
Ar 11,11
Ar 12,12
Ar 13,13
Ar 14,14
Ar 15,15
Vm 8,8,22
Vm 9,9,22
Vm 10,10,22
Vm 11,11,22
Vm 12,12,22
Vm 13,13,22
Vm 14,14,22
Vm 15,15,22
Aw 8,8
Aw 9,9
Aw 10,10
Aw 11,11
Aw 12,12
Aw 13,13
Aw 14,14
Aw 15,15
Ar 8,16
Ar 9,17
Ar 10,18
Ar 11,19
Ar 12,20
Ar 13,21
Ar 14,22
Ar 15,23
Vm 8,8,22
Vm 9,9,22
Vm 10,10,22
Vm 11,11,22
Vm 12,12,22
Vm 13,13,22
Vm 14,14,22
Vm 15,15,22
Aw 16,8
Aw 17,9
Aw 18,10
Aw 19,11
Aw 20,12
Aw 21,13
Aw 22,14
Aw 23,15
Ar 8,24
Ar 9,25
Ar 10,26
Ar 11,27
Ar 12,28
Ar 13,29
Ar 14,30
Ar 15,31
Vm 8,8,22
Vm 9,9,22
Vm 10,10,22
Vm 11,11,22
Vm 12,12,22
Vm 13,13,22
Vm 14,14,22
Vm 15,15,22
Aw 24,8
Aw 25,9
Aw 26,10
Aw 27,11
Aw 28,12
Aw 29,13
Aw 30,14
Aw 31,15
v_max3_f32 v21, v208, v209, v210
v_max3_f32 v21, v21, v211, v212
v_max3_f32 v21, v21, v213, v214
v_max3_f32 v21, v21, v215, v216
v_max3_f32 v21, v21, v217, v218
v_max3_f32 v21, v21, v219, v220
v_max3_f32 v21, v21, v221, v222
v_max_f32 v21, v21, v223
v_mov_b32 v1, v21
s_nop 1
v_permlane16_swap_b32 v1, v21
v_max_f32 v21, v21, v1
v_mov_b32 v1, v21
s_nop 1
v_permlane32_swap_b32 v1, v21
v_max_f32_e64 v21, v21, v1
v_add_f32 v21, 0x41f80000, v21
v_max_f32 v21, 0, v21
Vs 208,208,21
Vs 209,209,21
Vs 210,210,21
Vs 211,211,21
Vs 212,212,21
Vs 213,213,21
Vs 214,214,21
Vs 215,215,21
Vs 216,216,21
Vs 217,217,21
Vs 218,218,21
Vs 219,219,21
Vs 220,220,21
Vs 221,221,21
Vs 222,222,21
Vs 223,223,21
Vs 144,144,21
Vs 145,145,21
Vs 146,146,21
Vs 147,147,21
Vs 148,148,21
Vs 149,149,21
Vs 150,150,21
Vs 151,151,21
Vs 152,152,21
Vs 153,153,21
Vs 154,154,21
Vs 155,155,21
Vs 156,156,21
Vs 157,157,21
Vs 158,158,21
Vs 159,159,21
Vs 36,36,21
Vs 37,37,21
Vs 38,38,21
v_sub_f32_e64 v39, v39, v21
v_exp_f32 v22, -v21
s_nop 0
Vm 52,52,22
Vm 53,53,22
Vm 54,54,22
v_mul_f32_e64 v55, v55, v22
Ar 8,32
Ar 9,33
Ar 10,34
Ar 11,35
Ar 12,36
Ar 13,37
Ar 14,38
Ar 15,39
Vm 8,8,22
Vm 9,9,22
Vm 10,10,22
Vm 11,11,22
Vm 12,12,22
Vm 13,13,22
Vm 14,14,22
Vm 15,15,22
Aw 32,8
Aw 33,9
Aw 34,10
Aw 35,11
Aw 36,12
Aw 37,13
Aw 38,14
Aw 39,15
Ar 8,40
Ar 9,41
Ar 10,42
Ar 11,43
Ar 12,44
Ar 13,45
Ar 14,46
Ar 15,47
Vm 8,8,22
Vm 9,9,22
Vm 10,10,22
Vm 11,11,22
Vm 12,12,22
Vm 13,13,22
Vm 14,14,22
Vm 15,15,22
Aw 40,8
Aw 41,9
Aw 42,10
Aw 43,11
Aw 44,12
Aw 45,13
Aw 46,14
Aw 47,15
Ar 8,48
Ar 9,49
Ar 10,50
Ar 11,51
Ar 12,52
Ar 13,53
Ar 14,54
Ar 15,55
Vm 8,8,22
Vm 9,9,22
Vm 10,10,22
Vm 11,11,22
Vm 12,12,22
Vm 13,13,22
Vm 14,14,22
Vm 15,15,22
Aw 48,8
Aw 49,9
Aw 50,10
Aw 51,11
Aw 52,12
Aw 53,13
Aw 54,14
Aw 55,15
Ar 8,56
Ar 9,57
Ar 10,58
Ar 11,59
Ar 12,60
Ar 13,61
Ar 14,62
Ar 15,63
Vm 8,8,22
Vm 9,9,22
Vm 10,10,22
Vm 11,11,22
Vm 12,12,22
Vm 13,13,22
Vm 14,14,22
Vm 15,15,22
Aw 56,8
Aw 57,9
Aw 58,10
Aw 59,11
Aw 60,12
Aw 61,13
Aw 62,14
Aw 63,15
v_max3_f32 v21, v224, v225, v226
v_max3_f32 v21, v21, v227, v228
v_max3_f32 v21, v21, v229, v230
v_max3_f32 v21, v21, v231, v232
v_max3_f32 v21, v21, v233, v234
v_max3_f32 v21, v21, v235, v236
v_max3_f32 v21, v21, v237, v238
v_max_f32 v21, v21, v239
v_mov_b32 v1, v21
s_nop 1
v_permlane16_swap_b32 v1, v21
v_max_f32 v21, v21, v1
v_mov_b32 v1, v21
s_nop 1
v_permlane32_swap_b32 v1, v21
v_max_f32_e64 v21, v21, v1
v_add_f32 v21, 0x41f80000, v21
v_max_f32 v21, 0, v21
Vs 224,224,21
Vs 225,225,21
Vs 226,226,21
Vs 227,227,21
Vs 228,228,21
Vs 229,229,21
Vs 230,230,21
Vs 231,231,21
Vs 232,232,21
Vs 233,233,21
Vs 234,234,21
Vs 235,235,21
Vs 236,236,21
Vs 237,237,21
Vs 238,238,21
Vs 239,239,21
Vs 160,160,21
Vs 161,161,21
Vs 162,162,21
Vs 163,163,21
Vs 164,164,21
Vs 165,165,21
Vs 166,166,21
Vs 167,167,21
Vs 168,168,21
Vs 169,169,21
Vs 170,170,21
Vs 171,171,21
Vs 172,172,21
Vs 173,173,21
Vs 174,174,21
Vs 175,175,21
Vs 40,40,21
Vs 41,41,21
Vs 42,42,21
v_sub_f32_e64 v43, v43, v21
v_exp_f32 v22, -v21
s_nop 0
Vm 56,56,22
Vm 57,57,22
Vm 58,58,22
v_mul_f32_e64 v59, v59, v22
Ar 8,64
Ar 9,65
Ar 10,66
Ar 11,67
Ar 12,68
Ar 13,69
Ar 14,70
Ar 15,71
Vm 8,8,22
Vm 9,9,22
Vm 10,10,22
Vm 11,11,22
Vm 12,12,22
Vm 13,13,22
Vm 14,14,22
Vm 15,15,22
Aw 64,8
Aw 65,9
Aw 66,10
Aw 67,11
Aw 68,12
Aw 69,13
Aw 70,14
Aw 71,15
Ar 8,72
Ar 9,73
Ar 10,74
Ar 11,75
Ar 12,76
Ar 13,77
Ar 14,78
Ar 15,79
Vm 8,8,22
Vm 9,9,22
Vm 10,10,22
Vm 11,11,22
Vm 12,12,22
Vm 13,13,22
Vm 14,14,22
Vm 15,15,22
Aw 72,8
Aw 73,9
Aw 74,10
Aw 75,11
Aw 76,12
Aw 77,13
Aw 78,14
Aw 79,15
Ar 8,80
Ar 9,81
Ar 10,82
Ar 11,83
Ar 12,84
Ar 13,85
Ar 14,86
Ar 15,87
Vm 8,8,22
Vm 9,9,22
Vm 10,10,22
Vm 11,11,22
Vm 12,12,22
Vm 13,13,22
Vm 14,14,22
Vm 15,15,22
Aw 80,8
Aw 81,9
Aw 82,10
Aw 83,11
Aw 84,12
Aw 85,13
Aw 86,14
Aw 87,15
Ar 8,88
Ar 9,89
Ar 10,90
Ar 11,91
Ar 12,92
Ar 13,93
Ar 14,94
Ar 15,95
Vm 8,8,22
Vm 9,9,22
Vm 10,10,22
Vm 11,11,22
Vm 12,12,22
Vm 13,13,22
Vm 14,14,22
Vm 15,15,22
Aw 88,8
Aw 89,9
Aw 90,10
Aw 91,11
Aw 92,12
Aw 93,13
Aw 94,14
Aw 95,15
v_max3_f32 v21, v240, v241, v242
v_max3_f32 v21, v21, v243, v244
v_max3_f32 v21, v21, v245, v246
v_max3_f32 v21, v21, v247, v248
v_max3_f32 v21, v21, v249, v250
v_max3_f32 v21, v21, v251, v252
v_max3_f32 v21, v21, v253, v254
v_max_f32 v21, v21, v255
v_mov_b32 v1, v21
s_nop 1
v_permlane16_swap_b32 v1, v21
v_max_f32 v21, v21, v1
v_mov_b32 v1, v21
s_nop 1
v_permlane32_swap_b32 v1, v21
v_max_f32_e64 v21, v21, v1
v_add_f32 v21, 0x41f80000, v21
v_max_f32 v21, 0, v21
Vs 240,240,21
Vs 241,241,21
Vs 242,242,21
Vs 243,243,21
Vs 244,244,21
Vs 245,245,21
Vs 246,246,21
Vs 247,247,21
Vs 248,248,21
Vs 249,249,21
Vs 250,250,21
Vs 251,251,21
Vs 252,252,21
Vs 253,253,21
Vs 254,254,21
Vs 255,255,21
Vs 176,176,21
Vs 177,177,21
Vs 178,178,21
Vs 179,179,21
Vs 180,180,21
Vs 181,181,21
Vs 182,182,21
Vs 183,183,21
Vs 184,184,21
Vs 185,185,21
Vs 186,186,21
Vs 187,187,21
Vs 188,188,21
Vs 189,189,21
Vs 190,190,21
Vs 191,191,21
Vs 44,44,21
Vs 45,45,21
Vs 46,46,21
v_sub_f32_e64 v47, v47, v21
v_exp_f32 v22, -v21
s_nop 0
Vm 60,60,22
Vm 61,61,22
Vm 62,62,22
v_mul_f32_e64 v63, v63, v22
Ar 8,96
Ar 9,97
Ar 10,98
Ar 11,99
Ar 12,100
Ar 13,101
Ar 14,102
Ar 15,103
Vm 8,8,22
Vm 9,9,22
Vm 10,10,22
Vm 11,11,22
Vm 12,12,22
Vm 13,13,22
Vm 14,14,22
Vm 15,15,22
Aw 96,8
Aw 97,9
Aw 98,10
Aw 99,11
Aw 100,12
Aw 101,13
Aw 102,14
Aw 103,15
Ar 8,104
Ar 9,105
Ar 10,106
Ar 11,107
Ar 12,108
Ar 13,109
Ar 14,110
Ar 15,111
Vm 8,8,22
Vm 9,9,22
Vm 10,10,22
Vm 11,11,22
Vm 12,12,22
Vm 13,13,22
Vm 14,14,22
Vm 15,15,22
Aw 104,8
Aw 105,9
Aw 106,10
Aw 107,11
Aw 108,12
Aw 109,13
Aw 110,14
Aw 111,15
Ar 8,112
Ar 9,113
Ar 10,114
Ar 11,115
Ar 12,116
Ar 13,117
Ar 14,118
Ar 15,119
Vm 8,8,22
Vm 9,9,22
Vm 10,10,22
Vm 11,11,22
Vm 12,12,22
Vm 13,13,22
Vm 14,14,22
Vm 15,15,22
Aw 112,8
Aw 113,9
Aw 114,10
Aw 115,11
Aw 116,12
Aw 117,13
Aw 118,14
Aw 119,15
Ar 8,120
Ar 9,121
Ar 10,122
Ar 11,123
Ar 12,124
Ar 13,125
Ar 14,126
Ar 15,127
Vm 8,8,22
Vm 9,9,22
Vm 10,10,22
Vm 11,11,22
Vm 12,12,22
Vm 13,13,22
Vm 14,14,22
Vm 15,15,22
Aw 120,8
Aw 121,9
Aw 122,10
Aw 123,11
Aw 124,12
Aw 125,13
Aw 126,14
Aw 127,15
Ve 8,192
Ve 9,193
s_nop 0
Vc 96,8,9
Ve 8,194
Ve 9,195
s_nop 0
Vc 97,8,9
Ve 8,208
Ve 9,209
s_nop 0
Vc 104,8,9
Ve 8,210
Ve 9,211
s_nop 0
Vc 105,8,9
Ve 8,224
Ve 9,225
s_nop 0
Vc 112,8,9
Ve 8,226
Ve 9,227
s_nop 0
Vc 113,8,9
Ve 8,240
Ve 9,241
s_nop 0
Vc 120,8,9
Ve 8,242
Ve 9,243
s_nop 0
Vc 121,8,9
Ve 8,196
Ve 9,197
s_nop 0
Vc 98,8,9
Ve 8,198
Ve 9,199
s_nop 0
Vc 99,8,9
Ve 8,212
Ve 9,213
s_nop 0
Vc 106,8,9
Ve 8,214
Ve 9,215
s_nop 0
Vc 107,8,9
Ve 8,228
Ve 9,229
s_nop 0
Vc 114,8,9
Ve 8,230
Ve 9,231
s_nop 0
Vc 115,8,9
Ve 8,244
Ve 9,245
s_nop 0
Vc 122,8,9
Ve 8,246
Ve 9,247
s_nop 0
Vc 123,8,9
Ve 8,200
Ve 9,201
s_nop 0
Vc 100,8,9
Ve 8,202
Ve 9,203
s_nop 0
Vc 101,8,9
Ve 8,216
Ve 9,217
s_nop 0
Vc 108,8,9
Ve 8,218
Ve 9,219
s_nop 0
Vc 109,8,9
Ve 8,232
Ve 9,233
s_nop 0
Vc 116,8,9
Ve 8,234
Ve 9,235
s_nop 0
Vc 117,8,9
Ve 8,248
Ve 9,249
s_nop 0
Vc 124,8,9
Ve 8,250
Ve 9,251
s_nop 0
Vc 125,8,9
Ve 8,204
Ve 9,205
s_nop 0
Vc 102,8,9
Ve 8,206
Ve 9,207
s_nop 0
Vc 103,8,9
Ve 8,220
Ve 9,221
s_nop 0
Vc 110,8,9
Ve 8,222
Ve 9,223
s_nop 0
Vc 111,8,9
Ve 8,236
Ve 9,237
s_nop 0
Vc 118,8,9
Ve 8,238
Ve 9,239
s_nop 0
Vc 119,8,9
Ve 8,252
Ve 9,253
s_nop 0
Vc 126,8,9
Ve 8,254
Ve 9,255
s_nop 0
Vc 127,8,9
s_nop 1
s_branch L_k2_fbr_wo
L_k2_mk_wo:
v_cmp_gt_i32 s[56:57], 0, v5
v_cmp_gt_i32 s[58:59], 1, v5
v_cmp_gt_i32 s[60:61], 2, v5
v_cmp_gt_i32 s[62:63], 3, v5
s_nop 3
s_nop 0
v_cndmask_b32 v176, v176, v20, s[56:57]
v_cndmask_b32 v177, v177, v20, s[58:59]
v_cndmask_b32 v178, v178, v20, s[60:61]
v_cndmask_b32 v179, v179, v20, s[62:63]
v_cmp_gt_i32 s[56:57], 16, v5
v_cmp_gt_i32 s[58:59], 17, v5
v_cmp_gt_i32 s[60:61], 18, v5
v_cmp_gt_i32 s[62:63], 19, v5
v_cndmask_b32 v180, v180, v20, s[56:57]
v_cndmask_b32 v181, v181, v20, s[58:59]
v_cndmask_b32 v182, v182, v20, s[60:61]
v_cndmask_b32 v183, v183, v20, s[62:63]
v_cmp_gt_i32 s[56:57], 32, v5
v_cmp_gt_i32 s[58:59], 33, v5
v_cmp_gt_i32 s[60:61], 34, v5
v_cmp_gt_i32 s[62:63], 35, v5
v_cndmask_b32 v184, v184, v20, s[56:57]
v_cndmask_b32 v185, v185, v20, s[58:59]
v_cndmask_b32 v186, v186, v20, s[60:61]
v_cndmask_b32 v187, v187, v20, s[62:63]
v_cmp_gt_i32 s[56:57], 48, v5
v_cmp_gt_i32 s[58:59], 49, v5
v_cmp_gt_i32 s[60:61], 50, v5
v_cmp_gt_i32 s[62:63], 51, v5
v_cndmask_b32 v188, v188, v20, s[56:57]
v_cndmask_b32 v189, v189, v20, s[58:59]
v_cndmask_b32 v190, v190, v20, s[60:61]
v_cndmask_b32 v191, v191, v20, s[62:63]
s_branch L_k2_mkr_wo
L_k2_fb_wl:
s_nop 7
v_max3_f32 v21, v128, v129, v130
v_max3_f32 v21, v21, v131, v132
v_max3_f32 v21, v21, v133, v134
v_max3_f32 v21, v21, v135, v136
v_max3_f32 v21, v21, v137, v138
v_max3_f32 v21, v21, v139, v140
v_max3_f32 v21, v21, v141, v142
v_max_f32 v21, v21, v143
v_mov_b32 v1, v21
s_nop 1
v_permlane16_swap_b32 v1, v21
v_max_f32 v21, v21, v1
v_mov_b32 v1, v21
s_nop 1
v_permlane32_swap_b32 v1, v21
v_max_f32_e64 v21, v21, v1
v_add_f32 v21, 0x41f80000, v21
v_max_f32 v21, 0, v21
Vs 128,128,21
Vs 129,129,21
Vs 130,130,21
Vs 131,131,21
Vs 132,132,21
Vs 133,133,21
Vs 134,134,21
Vs 135,135,21
Vs 136,136,21
Vs 137,137,21
Vs 138,138,21
Vs 139,139,21
Vs 140,140,21
Vs 141,141,21
Vs 142,142,21
Vs 143,143,21
Vs 192,192,21
Vs 193,193,21
Vs 194,194,21
Vs 195,195,21
Vs 196,196,21
Vs 197,197,21
Vs 198,198,21
Vs 199,199,21
Vs 200,200,21
Vs 201,201,21
Vs 202,202,21
Vs 203,203,21
Vs 204,204,21
Vs 205,205,21
Vs 206,206,21
Vs 207,207,21
Vs 32,32,21
Vs 33,33,21
Vs 34,34,21
v_sub_f32_e64 v35, v35, v21
v_exp_f32 v22, -v21
s_nop 0
Vm 48,48,22
Vm 49,49,22
Vm 50,50,22
v_mul_f32_e64 v51, v51, v22
Ar 8,0
Ar 9,1
Ar 10,2
Ar 11,3
Ar 12,4
Ar 13,5
Ar 14,6
Ar 15,7
Vm 8,8,22
Vm 9,9,22
Vm 10,10,22
Vm 11,11,22
Vm 12,12,22
Vm 13,13,22
Vm 14,14,22
Vm 15,15,22
Aw 0,8
Aw 1,9
Aw 2,10
Aw 3,11
Aw 4,12
Aw 5,13
Aw 6,14
Aw 7,15
Ar 8,8
Ar 9,9
Ar 10,10
Ar 11,11
Ar 12,12
Ar 13,13
Ar 14,14
Ar 15,15
Vm 8,8,22
Vm 9,9,22
Vm 10,10,22
Vm 11,11,22
Vm 12,12,22
Vm 13,13,22
Vm 14,14,22
Vm 15,15,22
Aw 8,8
Aw 9,9
Aw 10,10
Aw 11,11
Aw 12,12
Aw 13,13
Aw 14,14
Aw 15,15
Ar 8,16
Ar 9,17
Ar 10,18
Ar 11,19
Ar 12,20
Ar 13,21
Ar 14,22
Ar 15,23
Vm 8,8,22
Vm 9,9,22
Vm 10,10,22
Vm 11,11,22
Vm 12,12,22
Vm 13,13,22
Vm 14,14,22
Vm 15,15,22
Aw 16,8
Aw 17,9
Aw 18,10
Aw 19,11
Aw 20,12
Aw 21,13
Aw 22,14
Aw 23,15
Ar 8,24
Ar 9,25
Ar 10,26
Ar 11,27
Ar 12,28
Ar 13,29
Ar 14,30
Ar 15,31
Vm 8,8,22
Vm 9,9,22
Vm 10,10,22
Vm 11,11,22
Vm 12,12,22
Vm 13,13,22
Vm 14,14,22
Vm 15,15,22
Aw 24,8
Aw 25,9
Aw 26,10
Aw 27,11
Aw 28,12
Aw 29,13
Aw 30,14
Aw 31,15
v_max3_f32 v21, v144, v145, v146
v_max3_f32 v21, v21, v147, v148
v_max3_f32 v21, v21, v149, v150
v_max3_f32 v21, v21, v151, v152
v_max3_f32 v21, v21, v153, v154
v_max3_f32 v21, v21, v155, v156
v_max3_f32 v21, v21, v157, v158
v_max_f32 v21, v21, v159
v_mov_b32 v1, v21
s_nop 1
v_permlane16_swap_b32 v1, v21
v_max_f32 v21, v21, v1
v_mov_b32 v1, v21
s_nop 1
v_permlane32_swap_b32 v1, v21
v_max_f32_e64 v21, v21, v1
v_add_f32 v21, 0x41f80000, v21
v_max_f32 v21, 0, v21
Vs 144,144,21
Vs 145,145,21
Vs 146,146,21
Vs 147,147,21
Vs 148,148,21
Vs 149,149,21
Vs 150,150,21
Vs 151,151,21
Vs 152,152,21
Vs 153,153,21
Vs 154,154,21
Vs 155,155,21
Vs 156,156,21
Vs 157,157,21
Vs 158,158,21
Vs 159,159,21
Vs 208,208,21
Vs 209,209,21
Vs 210,210,21
Vs 211,211,21
Vs 212,212,21
Vs 213,213,21
Vs 214,214,21
Vs 215,215,21
Vs 216,216,21
Vs 217,217,21
Vs 218,218,21
Vs 219,219,21
Vs 220,220,21
Vs 221,221,21
Vs 222,222,21
Vs 223,223,21
Vs 36,36,21
Vs 37,37,21
Vs 38,38,21
v_sub_f32_e64 v39, v39, v21
v_exp_f32 v22, -v21
s_nop 0
Vm 52,52,22
Vm 53,53,22
Vm 54,54,22
v_mul_f32_e64 v55, v55, v22
Ar 8,32
Ar 9,33
Ar 10,34
Ar 11,35
Ar 12,36
Ar 13,37
Ar 14,38
Ar 15,39
Vm 8,8,22
Vm 9,9,22
Vm 10,10,22
Vm 11,11,22
Vm 12,12,22
Vm 13,13,22
Vm 14,14,22
Vm 15,15,22
Aw 32,8
Aw 33,9
Aw 34,10
Aw 35,11
Aw 36,12
Aw 37,13
Aw 38,14
Aw 39,15
Ar 8,40
Ar 9,41
Ar 10,42
Ar 11,43
Ar 12,44
Ar 13,45
Ar 14,46
Ar 15,47
Vm 8,8,22
Vm 9,9,22
Vm 10,10,22
Vm 11,11,22
Vm 12,12,22
Vm 13,13,22
Vm 14,14,22
Vm 15,15,22
Aw 40,8
Aw 41,9
Aw 42,10
Aw 43,11
Aw 44,12
Aw 45,13
Aw 46,14
Aw 47,15
Ar 8,48
Ar 9,49
Ar 10,50
Ar 11,51
Ar 12,52
Ar 13,53
Ar 14,54
Ar 15,55
Vm 8,8,22
Vm 9,9,22
Vm 10,10,22
Vm 11,11,22
Vm 12,12,22
Vm 13,13,22
Vm 14,14,22
Vm 15,15,22
Aw 48,8
Aw 49,9
Aw 50,10
Aw 51,11
Aw 52,12
Aw 53,13
Aw 54,14
Aw 55,15
Ar 8,56
Ar 9,57
Ar 10,58
Ar 11,59
Ar 12,60
Ar 13,61
Ar 14,62
Ar 15,63
Vm 8,8,22
Vm 9,9,22
Vm 10,10,22
Vm 11,11,22
Vm 12,12,22
Vm 13,13,22
Vm 14,14,22
Vm 15,15,22
Aw 56,8
Aw 57,9
Aw 58,10
Aw 59,11
Aw 60,12
Aw 61,13
Aw 62,14
Aw 63,15
v_max3_f32 v21, v160, v161, v162
v_max3_f32 v21, v21, v163, v164
v_max3_f32 v21, v21, v165, v166
v_max3_f32 v21, v21, v167, v168
v_max3_f32 v21, v21, v169, v170
v_max3_f32 v21, v21, v171, v172
v_max3_f32 v21, v21, v173, v174
v_max_f32 v21, v21, v175
v_mov_b32 v1, v21
s_nop 1
v_permlane16_swap_b32 v1, v21
v_max_f32 v21, v21, v1
v_mov_b32 v1, v21
s_nop 1
v_permlane32_swap_b32 v1, v21
v_max_f32_e64 v21, v21, v1
v_add_f32 v21, 0x41f80000, v21
v_max_f32 v21, 0, v21
Vs 160,160,21
Vs 161,161,21
Vs 162,162,21
Vs 163,163,21
Vs 164,164,21
Vs 165,165,21
Vs 166,166,21
Vs 167,167,21
Vs 168,168,21
Vs 169,169,21
Vs 170,170,21
Vs 171,171,21
Vs 172,172,21
Vs 173,173,21
Vs 174,174,21
Vs 175,175,21
Vs 224,224,21
Vs 225,225,21
Vs 226,226,21
Vs 227,227,21
Vs 228,228,21
Vs 229,229,21
Vs 230,230,21
Vs 231,231,21
Vs 232,232,21
Vs 233,233,21
Vs 234,234,21
Vs 235,235,21
Vs 236,236,21
Vs 237,237,21
Vs 238,238,21
Vs 239,239,21
Vs 40,40,21
Vs 41,41,21
Vs 42,42,21
v_sub_f32_e64 v43, v43, v21
v_exp_f32 v22, -v21
s_nop 0
Vm 56,56,22
Vm 57,57,22
Vm 58,58,22
v_mul_f32_e64 v59, v59, v22
Ar 8,64
Ar 9,65
Ar 10,66
Ar 11,67
Ar 12,68
Ar 13,69
Ar 14,70
Ar 15,71
Vm 8,8,22
Vm 9,9,22
Vm 10,10,22
Vm 11,11,22
Vm 12,12,22
Vm 13,13,22
Vm 14,14,22
Vm 15,15,22
Aw 64,8
Aw 65,9
Aw 66,10
Aw 67,11
Aw 68,12
Aw 69,13
Aw 70,14
Aw 71,15
Ar 8,72
Ar 9,73
Ar 10,74
Ar 11,75
Ar 12,76
Ar 13,77
Ar 14,78
Ar 15,79
Vm 8,8,22
Vm 9,9,22
Vm 10,10,22
Vm 11,11,22
Vm 12,12,22
Vm 13,13,22
Vm 14,14,22
Vm 15,15,22
Aw 72,8
Aw 73,9
Aw 74,10
Aw 75,11
Aw 76,12
Aw 77,13
Aw 78,14
Aw 79,15
Ar 8,80
Ar 9,81
Ar 10,82
Ar 11,83
Ar 12,84
Ar 13,85
Ar 14,86
Ar 15,87
Vm 8,8,22
Vm 9,9,22
Vm 10,10,22
Vm 11,11,22
Vm 12,12,22
Vm 13,13,22
Vm 14,14,22
Vm 15,15,22
Aw 80,8
Aw 81,9
Aw 82,10
Aw 83,11
Aw 84,12
Aw 85,13
Aw 86,14
Aw 87,15
Ar 8,88
Ar 9,89
Ar 10,90
Ar 11,91
Ar 12,92
Ar 13,93
Ar 14,94
Ar 15,95
Vm 8,8,22
Vm 9,9,22
Vm 10,10,22
Vm 11,11,22
Vm 12,12,22
Vm 13,13,22
Vm 14,14,22
Vm 15,15,22
Aw 88,8
Aw 89,9
Aw 90,10
Aw 91,11
Aw 92,12
Aw 93,13
Aw 94,14
Aw 95,15
v_max3_f32 v21, v176, v177, v178
v_max3_f32 v21, v21, v179, v180
v_max3_f32 v21, v21, v181, v182
v_max3_f32 v21, v21, v183, v184
v_max3_f32 v21, v21, v185, v186
v_max3_f32 v21, v21, v187, v188
v_max3_f32 v21, v21, v189, v190
v_max_f32 v21, v21, v191
v_mov_b32 v1, v21
s_nop 1
v_permlane16_swap_b32 v1, v21
v_max_f32 v21, v21, v1
v_mov_b32 v1, v21
s_nop 1
v_permlane32_swap_b32 v1, v21
v_max_f32_e64 v21, v21, v1
v_add_f32 v21, 0x41f80000, v21
v_max_f32 v21, 0, v21
Vs 176,176,21
Vs 177,177,21
Vs 178,178,21
Vs 179,179,21
Vs 180,180,21
Vs 181,181,21
Vs 182,182,21
Vs 183,183,21
Vs 184,184,21
Vs 185,185,21
Vs 186,186,21
Vs 187,187,21
Vs 188,188,21
Vs 189,189,21
Vs 190,190,21
Vs 191,191,21
Vs 44,44,21
Vs 45,45,21
Vs 46,46,21
v_sub_f32_e64 v47, v47, v21
v_exp_f32 v22, -v21
s_nop 0
Vm 60,60,22
Vm 61,61,22
Vm 62,62,22
v_mul_f32_e64 v63, v63, v22
Ar 8,96
Ar 9,97
Ar 10,98
Ar 11,99
Ar 12,100
Ar 13,101
Ar 14,102
Ar 15,103
Vm 8,8,22
Vm 9,9,22
Vm 10,10,22
Vm 11,11,22
Vm 12,12,22
Vm 13,13,22
Vm 14,14,22
Vm 15,15,22
Aw 96,8
Aw 97,9
Aw 98,10
Aw 99,11
Aw 100,12
Aw 101,13
Aw 102,14
Aw 103,15
Ar 8,104
Ar 9,105
Ar 10,106
Ar 11,107
Ar 12,108
Ar 13,109
Ar 14,110
Ar 15,111
Vm 8,8,22
Vm 9,9,22
Vm 10,10,22
Vm 11,11,22
Vm 12,12,22
Vm 13,13,22
Vm 14,14,22
Vm 15,15,22
Aw 104,8
Aw 105,9
Aw 106,10
Aw 107,11
Aw 108,12
Aw 109,13
Aw 110,14
Aw 111,15
Ar 8,112
Ar 9,113
Ar 10,114
Ar 11,115
Ar 12,116
Ar 13,117
Ar 14,118
Ar 15,119
Vm 8,8,22
Vm 9,9,22
Vm 10,10,22
Vm 11,11,22
Vm 12,12,22
Vm 13,13,22
Vm 14,14,22
Vm 15,15,22
Aw 112,8
Aw 113,9
Aw 114,10
Aw 115,11
Aw 116,12
Aw 117,13
Aw 118,14
Aw 119,15
Ar 8,120
Ar 9,121
Ar 10,122
Ar 11,123
Ar 12,124
Ar 13,125
Ar 14,126
Ar 15,127
Vm 8,8,22
Vm 9,9,22
Vm 10,10,22
Vm 11,11,22
Vm 12,12,22
Vm 13,13,22
Vm 14,14,22
Vm 15,15,22
Aw 120,8
Aw 121,9
Aw 122,10
Aw 123,11
Aw 124,12
Aw 125,13
Aw 126,14
Aw 127,15
Ve 8,128
Ve 9,129
s_nop 0
Vc 64,8,9
Ve 8,130
Ve 9,131
s_nop 0
Vc 65,8,9
Ve 8,144
Ve 9,145
s_nop 0
Vc 72,8,9
Ve 8,146
Ve 9,147
s_nop 0
Vc 73,8,9
Ve 8,160
Ve 9,161
s_nop 0
Vc 80,8,9
Ve 8,162
Ve 9,163
s_nop 0
Vc 81,8,9
Ve 8,176
Ve 9,177
s_nop 0
Vc 88,8,9
Ve 8,178
Ve 9,179
s_nop 0
Vc 89,8,9
Ve 8,132
Ve 9,133
s_nop 0
Vc 66,8,9
Ve 8,134
Ve 9,135
s_nop 0
Vc 67,8,9
Ve 8,148
Ve 9,149
s_nop 0
Vc 74,8,9
Ve 8,150
Ve 9,151
s_nop 0
Vc 75,8,9
Ve 8,164
Ve 9,165
s_nop 0
Vc 82,8,9
Ve 8,166
Ve 9,167
s_nop 0
Vc 83,8,9
Ve 8,180
Ve 9,181
s_nop 0
Vc 90,8,9
Ve 8,182
Ve 9,183
s_nop 0
Vc 91,8,9
Ve 8,136
Ve 9,137
s_nop 0
Vc 68,8,9
Ve 8,138
Ve 9,139
s_nop 0
Vc 69,8,9
Ve 8,152
Ve 9,153
s_nop 0
Vc 76,8,9
Ve 8,154
Ve 9,155
s_nop 0
Vc 77,8,9
Ve 8,168
Ve 9,169
s_nop 0
Vc 84,8,9
Ve 8,170
Ve 9,171
s_nop 0
Vc 85,8,9
Ve 8,184
Ve 9,185
s_nop 0
Vc 92,8,9
Ve 8,186
Ve 9,187
s_nop 0
Vc 93,8,9
Ve 8,140
Ve 9,141
s_nop 0
Vc 70,8,9
Ve 8,142
Ve 9,143
s_nop 0
Vc 71,8,9
Ve 8,156
Ve 9,157
s_nop 0
Vc 78,8,9
Ve 8,158
Ve 9,159
s_nop 0
Vc 79,8,9
Ve 8,172
Ve 9,173
s_nop 0
Vc 86,8,9
Ve 8,174
Ve 9,175
s_nop 0
Vc 87,8,9
Ve 8,188
Ve 9,189
s_nop 0
Vc 94,8,9
Ve 8,190
Ve 9,191
s_nop 0
Vc 95,8,9
s_nop 1
s_branch L_k2_fbr_wl
L_k2_mk_wl:
v_cmp_gt_i32 s[56:57], 0, v6
v_cmp_gt_i32 s[58:59], 1, v6
v_cmp_gt_i32 s[60:61], 2, v6
v_cmp_gt_i32 s[62:63], 3, v6
s_nop 3
s_nop 0
v_cndmask_b32 v224, v224, v20, s[56:57]
v_cndmask_b32 v225, v225, v20, s[58:59]
v_cndmask_b32 v226, v226, v20, s[60:61]
v_cndmask_b32 v227, v227, v20, s[62:63]
v_cmp_gt_i32 s[56:57], 16, v6
v_cmp_gt_i32 s[58:59], 17, v6
v_cmp_gt_i32 s[60:61], 18, v6
v_cmp_gt_i32 s[62:63], 19, v6
v_cndmask_b32 v228, v228, v20, s[56:57]
v_cndmask_b32 v229, v229, v20, s[58:59]
v_cndmask_b32 v230, v230, v20, s[60:61]
v_cndmask_b32 v231, v231, v20, s[62:63]
v_cmp_gt_i32 s[56:57], 32, v6
v_cmp_gt_i32 s[58:59], 33, v6
v_cmp_gt_i32 s[60:61], 34, v6
v_cmp_gt_i32 s[62:63], 35, v6
v_cndmask_b32 v232, v232, v20, s[56:57]
v_cndmask_b32 v233, v233, v20, s[58:59]
v_cndmask_b32 v234, v234, v20, s[60:61]
v_cndmask_b32 v235, v235, v20, s[62:63]
v_cmp_gt_i32 s[56:57], 48, v6
v_cmp_gt_i32 s[58:59], 49, v6
v_cmp_gt_i32 s[60:61], 50, v6
v_cmp_gt_i32 s[62:63], 51, v6
v_cndmask_b32 v236, v236, v20, s[56:57]
v_cndmask_b32 v237, v237, v20, s[58:59]
v_cndmask_b32 v238, v238, v20, s[60:61]
v_cndmask_b32 v239, v239, v20, s[62:63]
s_branch L_k2_mkr_wl
L_k2_fb_tr:
s_nop 7
v_max3_f32 v21, v192, v193, v194
v_max3_f32 v21, v21, v195, v196
v_max3_f32 v21, v21, v197, v198
v_max3_f32 v21, v21, v199, v200
v_max3_f32 v21, v21, v201, v202
v_max3_f32 v21, v21, v203, v204
v_max3_f32 v21, v21, v205, v206
v_max_f32 v21, v21, v207
v_mov_b32 v1, v21
s_nop 1
v_permlane16_swap_b32 v1, v21
v_max_f32 v21, v21, v1
v_mov_b32 v1, v21
s_nop 1
v_permlane32_swap_b32 v1, v21
v_max_f32_e64 v21, v21, v1
v_add_f32 v21, 0x41f80000, v21
v_max_f32 v21, 0, v21
Vs 192,192,21
Vs 193,193,21
Vs 194,194,21
Vs 195,195,21
Vs 196,196,21
Vs 197,197,21
Vs 198,198,21
Vs 199,199,21
Vs 200,200,21
Vs 201,201,21
Vs 202,202,21
Vs 203,203,21
Vs 204,204,21
Vs 205,205,21
Vs 206,206,21
Vs 207,207,21
Vs 128,128,21
Vs 129,129,21
Vs 130,130,21
Vs 131,131,21
Vs 132,132,21
Vs 133,133,21
Vs 134,134,21
Vs 135,135,21
Vs 136,136,21
Vs 137,137,21
Vs 138,138,21
Vs 139,139,21
Vs 140,140,21
Vs 141,141,21
Vs 142,142,21
Vs 143,143,21
Vs 32,32,21
Vs 33,33,21
Vs 34,34,21
v_sub_f32_e64 v35, v35, v21
v_exp_f32 v22, -v21
s_nop 0
Vm 48,48,22
Vm 49,49,22
Vm 50,50,22
v_mul_f32_e64 v51, v51, v22
Ar 8,0
Ar 9,1
Ar 10,2
Ar 11,3
Ar 12,4
Ar 13,5
Ar 14,6
Ar 15,7
Vm 8,8,22
Vm 9,9,22
Vm 10,10,22
Vm 11,11,22
Vm 12,12,22
Vm 13,13,22
Vm 14,14,22
Vm 15,15,22
Aw 0,8
Aw 1,9
Aw 2,10
Aw 3,11
Aw 4,12
Aw 5,13
Aw 6,14
Aw 7,15
Ar 8,8
Ar 9,9
Ar 10,10
Ar 11,11
Ar 12,12
Ar 13,13
Ar 14,14
Ar 15,15
Vm 8,8,22
Vm 9,9,22
Vm 10,10,22
Vm 11,11,22
Vm 12,12,22
Vm 13,13,22
Vm 14,14,22
Vm 15,15,22
Aw 8,8
Aw 9,9
Aw 10,10
Aw 11,11
Aw 12,12
Aw 13,13
Aw 14,14
Aw 15,15
Ar 8,16
Ar 9,17
Ar 10,18
Ar 11,19
Ar 12,20
Ar 13,21
Ar 14,22
Ar 15,23
Vm 8,8,22
Vm 9,9,22
Vm 10,10,22
Vm 11,11,22
Vm 12,12,22
Vm 13,13,22
Vm 14,14,22
Vm 15,15,22
Aw 16,8
Aw 17,9
Aw 18,10
Aw 19,11
Aw 20,12
Aw 21,13
Aw 22,14
Aw 23,15
Ar 8,24
Ar 9,25
Ar 10,26
Ar 11,27
Ar 12,28
Ar 13,29
Ar 14,30
Ar 15,31
Vm 8,8,22
Vm 9,9,22
Vm 10,10,22
Vm 11,11,22
Vm 12,12,22
Vm 13,13,22
Vm 14,14,22
Vm 15,15,22
Aw 24,8
Aw 25,9
Aw 26,10
Aw 27,11
Aw 28,12
Aw 29,13
Aw 30,14
Aw 31,15
v_max3_f32 v21, v208, v209, v210
v_max3_f32 v21, v21, v211, v212
v_max3_f32 v21, v21, v213, v214
v_max3_f32 v21, v21, v215, v216
v_max3_f32 v21, v21, v217, v218
v_max3_f32 v21, v21, v219, v220
v_max3_f32 v21, v21, v221, v222
v_max_f32 v21, v21, v223
v_mov_b32 v1, v21
s_nop 1
v_permlane16_swap_b32 v1, v21
v_max_f32 v21, v21, v1
v_mov_b32 v1, v21
s_nop 1
v_permlane32_swap_b32 v1, v21
v_max_f32_e64 v21, v21, v1
v_add_f32 v21, 0x41f80000, v21
v_max_f32 v21, 0, v21
Vs 208,208,21
Vs 209,209,21
Vs 210,210,21
Vs 211,211,21
Vs 212,212,21
Vs 213,213,21
Vs 214,214,21
Vs 215,215,21
Vs 216,216,21
Vs 217,217,21
Vs 218,218,21
Vs 219,219,21
Vs 220,220,21
Vs 221,221,21
Vs 222,222,21
Vs 223,223,21
Vs 144,144,21
Vs 145,145,21
Vs 146,146,21
Vs 147,147,21
Vs 148,148,21
Vs 149,149,21
Vs 150,150,21
Vs 151,151,21
Vs 152,152,21
Vs 153,153,21
Vs 154,154,21
Vs 155,155,21
Vs 156,156,21
Vs 157,157,21
Vs 158,158,21
Vs 159,159,21
Vs 36,36,21
Vs 37,37,21
Vs 38,38,21
v_sub_f32_e64 v39, v39, v21
v_exp_f32 v22, -v21
s_nop 0
Vm 52,52,22
Vm 53,53,22
Vm 54,54,22
v_mul_f32_e64 v55, v55, v22
Ar 8,32
Ar 9,33
Ar 10,34
Ar 11,35
Ar 12,36
Ar 13,37
Ar 14,38
Ar 15,39
Vm 8,8,22
Vm 9,9,22
Vm 10,10,22
Vm 11,11,22
Vm 12,12,22
Vm 13,13,22
Vm 14,14,22
Vm 15,15,22
Aw 32,8
Aw 33,9
Aw 34,10
Aw 35,11
Aw 36,12
Aw 37,13
Aw 38,14
Aw 39,15
Ar 8,40
Ar 9,41
Ar 10,42
Ar 11,43
Ar 12,44
Ar 13,45
Ar 14,46
Ar 15,47
Vm 8,8,22
Vm 9,9,22
Vm 10,10,22
Vm 11,11,22
Vm 12,12,22
Vm 13,13,22
Vm 14,14,22
Vm 15,15,22
Aw 40,8
Aw 41,9
Aw 42,10
Aw 43,11
Aw 44,12
Aw 45,13
Aw 46,14
Aw 47,15
Ar 8,48
Ar 9,49
Ar 10,50
Ar 11,51
Ar 12,52
Ar 13,53
Ar 14,54
Ar 15,55
Vm 8,8,22
Vm 9,9,22
Vm 10,10,22
Vm 11,11,22
Vm 12,12,22
Vm 13,13,22
Vm 14,14,22
Vm 15,15,22
Aw 48,8
Aw 49,9
Aw 50,10
Aw 51,11
Aw 52,12
Aw 53,13
Aw 54,14
Aw 55,15
Ar 8,56
Ar 9,57
Ar 10,58
Ar 11,59
Ar 12,60
Ar 13,61
Ar 14,62
Ar 15,63
Vm 8,8,22
Vm 9,9,22
Vm 10,10,22
Vm 11,11,22
Vm 12,12,22
Vm 13,13,22
Vm 14,14,22
Vm 15,15,22
Aw 56,8
Aw 57,9
Aw 58,10
Aw 59,11
Aw 60,12
Aw 61,13
Aw 62,14
Aw 63,15
v_max3_f32 v21, v224, v225, v226
v_max3_f32 v21, v21, v227, v228
v_max3_f32 v21, v21, v229, v230
v_max3_f32 v21, v21, v231, v232
v_max3_f32 v21, v21, v233, v234
v_max3_f32 v21, v21, v235, v236
v_max3_f32 v21, v21, v237, v238
v_max_f32 v21, v21, v239
v_mov_b32 v1, v21
s_nop 1
v_permlane16_swap_b32 v1, v21
v_max_f32 v21, v21, v1
v_mov_b32 v1, v21
s_nop 1
v_permlane32_swap_b32 v1, v21
v_max_f32_e64 v21, v21, v1
v_add_f32 v21, 0x41f80000, v21
v_max_f32 v21, 0, v21
Vs 224,224,21
Vs 225,225,21
Vs 226,226,21
Vs 227,227,21
Vs 228,228,21
Vs 229,229,21
Vs 230,230,21
Vs 231,231,21
Vs 232,232,21
Vs 233,233,21
Vs 234,234,21
Vs 235,235,21
Vs 236,236,21
Vs 237,237,21
Vs 238,238,21
Vs 239,239,21
Vs 40,40,21
Vs 41,41,21
Vs 42,42,21
v_sub_f32_e64 v43, v43, v21
v_exp_f32 v22, -v21
s_nop 0
Vm 56,56,22
Vm 57,57,22
Vm 58,58,22
v_mul_f32_e64 v59, v59, v22
Ar 8,64
Ar 9,65
Ar 10,66
Ar 11,67
Ar 12,68
Ar 13,69
Ar 14,70
Ar 15,71
Vm 8,8,22
Vm 9,9,22
Vm 10,10,22
Vm 11,11,22
Vm 12,12,22
Vm 13,13,22
Vm 14,14,22
Vm 15,15,22
Aw 64,8
Aw 65,9
Aw 66,10
Aw 67,11
Aw 68,12
Aw 69,13
Aw 70,14
Aw 71,15
Ar 8,72
Ar 9,73
Ar 10,74
Ar 11,75
Ar 12,76
Ar 13,77
Ar 14,78
Ar 15,79
Vm 8,8,22
Vm 9,9,22
Vm 10,10,22
Vm 11,11,22
Vm 12,12,22
Vm 13,13,22
Vm 14,14,22
Vm 15,15,22
Aw 72,8
Aw 73,9
Aw 74,10
Aw 75,11
Aw 76,12
Aw 77,13
Aw 78,14
Aw 79,15
Ar 8,80
Ar 9,81
Ar 10,82
Ar 11,83
Ar 12,84
Ar 13,85
Ar 14,86
Ar 15,87
Vm 8,8,22
Vm 9,9,22
Vm 10,10,22
Vm 11,11,22
Vm 12,12,22
Vm 13,13,22
Vm 14,14,22
Vm 15,15,22
Aw 80,8
Aw 81,9
Aw 82,10
Aw 83,11
Aw 84,12
Aw 85,13
Aw 86,14
Aw 87,15
Ar 8,88
Ar 9,89
Ar 10,90
Ar 11,91
Ar 12,92
Ar 13,93
Ar 14,94
Ar 15,95
Vm 8,8,22
Vm 9,9,22
Vm 10,10,22
Vm 11,11,22
Vm 12,12,22
Vm 13,13,22
Vm 14,14,22
Vm 15,15,22
Aw 88,8
Aw 89,9
Aw 90,10
Aw 91,11
Aw 92,12
Aw 93,13
Aw 94,14
Aw 95,15
Ve 8,192
Ve 9,193
s_nop 0
Vc 96,8,9
Ve 8,194
Ve 9,195
s_nop 0
Vc 97,8,9
Ve 8,208
Ve 9,209
s_nop 0
Vc 104,8,9
Ve 8,210
Ve 9,211
s_nop 0
Vc 105,8,9
Ve 8,224
Ve 9,225
s_nop 0
Vc 112,8,9
Ve 8,226
Ve 9,227
s_nop 0
Vc 113,8,9
Ve 8,196
Ve 9,197
s_nop 0
Vc 98,8,9
Ve 8,198
Ve 9,199
s_nop 0
Vc 99,8,9
Ve 8,212
Ve 9,213
s_nop 0
Vc 106,8,9
Ve 8,214
Ve 9,215
s_nop 0
Vc 107,8,9
Ve 8,228
Ve 9,229
s_nop 0
Vc 114,8,9
Ve 8,230
Ve 9,231
s_nop 0
Vc 115,8,9
Ve 8,200
Ve 9,201
s_nop 0
Vc 100,8,9
Ve 8,202
Ve 9,203
s_nop 0
Vc 101,8,9
Ve 8,216
Ve 9,217
s_nop 0
Vc 108,8,9
Ve 8,218
Ve 9,219
s_nop 0
Vc 109,8,9
Ve 8,232
Ve 9,233
s_nop 0
Vc 116,8,9
Ve 8,234
Ve 9,235
s_nop 0
Vc 117,8,9
Ve 8,204
Ve 9,205
s_nop 0
Vc 102,8,9
Ve 8,206
Ve 9,207
s_nop 0
Vc 103,8,9
Ve 8,220
Ve 9,221
s_nop 0
Vc 110,8,9
Ve 8,222
Ve 9,223
s_nop 0
Vc 111,8,9
Ve 8,236
Ve 9,237
s_nop 0
Vc 118,8,9
Ve 8,238
Ve 9,239
s_nop 0
Vc 119,8,9
s_nop 1
s_branch L_k2_fbr_tr
L_k2_mk_tr:
v_cmp_gt_i32 s[56:57], 0, v5
v_cmp_gt_i32 s[58:59], 1, v5
v_cmp_gt_i32 s[60:61], 2, v5
v_cmp_gt_i32 s[62:63], 3, v5
s_nop 3
s_nop 0
v_cndmask_b32 v144, v144, v20, s[56:57]
v_cndmask_b32 v145, v145, v20, s[58:59]
v_cndmask_b32 v146, v146, v20, s[60:61]
v_cndmask_b32 v147, v147, v20, s[62:63]
v_cmp_gt_i32 s[56:57], 16, v5
v_cmp_gt_i32 s[58:59], 17, v5
v_cmp_gt_i32 s[60:61], 18, v5
v_cmp_gt_i32 s[62:63], 19, v5
v_cndmask_b32 v148, v148, v20, s[56:57]
v_cndmask_b32 v149, v149, v20, s[58:59]
v_cndmask_b32 v150, v150, v20, s[60:61]
v_cndmask_b32 v151, v151, v20, s[62:63]
v_cmp_gt_i32 s[56:57], 32, v5
v_cmp_gt_i32 s[58:59], 33, v5
v_cmp_gt_i32 s[60:61], 34, v5
v_cmp_gt_i32 s[62:63], 35, v5
v_cndmask_b32 v152, v152, v20, s[56:57]
v_cndmask_b32 v153, v153, v20, s[58:59]
v_cndmask_b32 v154, v154, v20, s[60:61]
v_cndmask_b32 v155, v155, v20, s[62:63]
v_cmp_gt_i32 s[56:57], 48, v5
v_cmp_gt_i32 s[58:59], 49, v5
v_cmp_gt_i32 s[60:61], 50, v5
v_cmp_gt_i32 s[62:63], 51, v5
v_cndmask_b32 v156, v156, v20, s[56:57]
v_cndmask_b32 v157, v157, v20, s[58:59]
v_cndmask_b32 v158, v158, v20, s[60:61]
v_cndmask_b32 v159, v159, v20, s[62:63]
s_branch L_k2_mkr_tr
L_k2_fb_ne:
s_nop 7
v_max3_f32 v21, v128, v129, v130
v_max3_f32 v21, v21, v131, v132
v_max3_f32 v21, v21, v133, v134
v_max3_f32 v21, v21, v135, v136
v_max3_f32 v21, v21, v137, v138
v_max3_f32 v21, v21, v139, v140
v_max3_f32 v21, v21, v141, v142
v_max_f32 v21, v21, v143
v_mov_b32 v1, v21
s_nop 1
v_permlane16_swap_b32 v1, v21
v_max_f32 v21, v21, v1
v_mov_b32 v1, v21
s_nop 1
v_permlane32_swap_b32 v1, v21
v_max_f32_e64 v21, v21, v1
v_add_f32 v21, 0x41f80000, v21
v_max_f32 v21, 0, v21
Vs 128,128,21
Vs 129,129,21
Vs 130,130,21
Vs 131,131,21
Vs 132,132,21
Vs 133,133,21
Vs 134,134,21
Vs 135,135,21
Vs 136,136,21
Vs 137,137,21
Vs 138,138,21
Vs 139,139,21
Vs 140,140,21
Vs 141,141,21
Vs 142,142,21
Vs 143,143,21
Vs 192,192,21
Vs 193,193,21
Vs 194,194,21
Vs 195,195,21
Vs 196,196,21
Vs 197,197,21
Vs 198,198,21
Vs 199,199,21
Vs 200,200,21
Vs 201,201,21
Vs 202,202,21
Vs 203,203,21
Vs 204,204,21
Vs 205,205,21
Vs 206,206,21
Vs 207,207,21
Vs 32,32,21
Vs 33,33,21
Vs 34,34,21
v_sub_f32_e64 v35, v35, v21
v_exp_f32 v22, -v21
s_nop 0
Vm 48,48,22
Vm 49,49,22
Vm 50,50,22
v_mul_f32_e64 v51, v51, v22
Ar 8,0
Ar 9,1
Ar 10,2
Ar 11,3
Ar 12,4
Ar 13,5
Ar 14,6
Ar 15,7
Vm 8,8,22
Vm 9,9,22
Vm 10,10,22
Vm 11,11,22
Vm 12,12,22
Vm 13,13,22
Vm 14,14,22
Vm 15,15,22
Aw 0,8
Aw 1,9
Aw 2,10
Aw 3,11
Aw 4,12
Aw 5,13
Aw 6,14
Aw 7,15
Ar 8,8
Ar 9,9
Ar 10,10
Ar 11,11
Ar 12,12
Ar 13,13
Ar 14,14
Ar 15,15
Vm 8,8,22
Vm 9,9,22
Vm 10,10,22
Vm 11,11,22
Vm 12,12,22
Vm 13,13,22
Vm 14,14,22
Vm 15,15,22
Aw 8,8
Aw 9,9
Aw 10,10
Aw 11,11
Aw 12,12
Aw 13,13
Aw 14,14
Aw 15,15
Ar 8,16
Ar 9,17
Ar 10,18
Ar 11,19
Ar 12,20
Ar 13,21
Ar 14,22
Ar 15,23
Vm 8,8,22
Vm 9,9,22
Vm 10,10,22
Vm 11,11,22
Vm 12,12,22
Vm 13,13,22
Vm 14,14,22
Vm 15,15,22
Aw 16,8
Aw 17,9
Aw 18,10
Aw 19,11
Aw 20,12
Aw 21,13
Aw 22,14
Aw 23,15
Ar 8,24
Ar 9,25
Ar 10,26
Ar 11,27
Ar 12,28
Ar 13,29
Ar 14,30
Ar 15,31
Vm 8,8,22
Vm 9,9,22
Vm 10,10,22
Vm 11,11,22
Vm 12,12,22
Vm 13,13,22
Vm 14,14,22
Vm 15,15,22
Aw 24,8
Aw 25,9
Aw 26,10
Aw 27,11
Aw 28,12
Aw 29,13
Aw 30,14
Aw 31,15
v_max3_f32 v21, v144, v145, v146
v_max3_f32 v21, v21, v147, v148
v_max3_f32 v21, v21, v149, v150
v_max3_f32 v21, v21, v151, v152
v_max3_f32 v21, v21, v153, v154
v_max3_f32 v21, v21, v155, v156
v_max3_f32 v21, v21, v157, v158
v_max_f32 v21, v21, v159
v_mov_b32 v1, v21
s_nop 1
v_permlane16_swap_b32 v1, v21
v_max_f32 v21, v21, v1
v_mov_b32 v1, v21
s_nop 1
v_permlane32_swap_b32 v1, v21
v_max_f32_e64 v21, v21, v1
v_add_f32 v21, 0x41f80000, v21
v_max_f32 v21, 0, v21
Vs 144,144,21
Vs 145,145,21
Vs 146,146,21
Vs 147,147,21
Vs 148,148,21
Vs 149,149,21
Vs 150,150,21
Vs 151,151,21
Vs 152,152,21
Vs 153,153,21
Vs 154,154,21
Vs 155,155,21
Vs 156,156,21
Vs 157,157,21
Vs 158,158,21
Vs 159,159,21
Vs 208,208,21
Vs 209,209,21
Vs 210,210,21
Vs 211,211,21
Vs 212,212,21
Vs 213,213,21
Vs 214,214,21
Vs 215,215,21
Vs 216,216,21
Vs 217,217,21
Vs 218,218,21
Vs 219,219,21
Vs 220,220,21
Vs 221,221,21
Vs 222,222,21
Vs 223,223,21
Vs 36,36,21
Vs 37,37,21
Vs 38,38,21
v_sub_f32_e64 v39, v39, v21
v_exp_f32 v22, -v21
s_nop 0
Vm 52,52,22
Vm 53,53,22
Vm 54,54,22
v_mul_f32_e64 v55, v55, v22
Ar 8,32
Ar 9,33
Ar 10,34
Ar 11,35
Ar 12,36
Ar 13,37
Ar 14,38
Ar 15,39
Vm 8,8,22
Vm 9,9,22
Vm 10,10,22
Vm 11,11,22
Vm 12,12,22
Vm 13,13,22
Vm 14,14,22
Vm 15,15,22
Aw 32,8
Aw 33,9
Aw 34,10
Aw 35,11
Aw 36,12
Aw 37,13
Aw 38,14
Aw 39,15
Ar 8,40
Ar 9,41
Ar 10,42
Ar 11,43
Ar 12,44
Ar 13,45
Ar 14,46
Ar 15,47
Vm 8,8,22
Vm 9,9,22
Vm 10,10,22
Vm 11,11,22
Vm 12,12,22
Vm 13,13,22
Vm 14,14,22
Vm 15,15,22
Aw 40,8
Aw 41,9
Aw 42,10
Aw 43,11
Aw 44,12
Aw 45,13
Aw 46,14
Aw 47,15
Ar 8,48
Ar 9,49
Ar 10,50
Ar 11,51
Ar 12,52
Ar 13,53
Ar 14,54
Ar 15,55
Vm 8,8,22
Vm 9,9,22
Vm 10,10,22
Vm 11,11,22
Vm 12,12,22
Vm 13,13,22
Vm 14,14,22
Vm 15,15,22
Aw 48,8
Aw 49,9
Aw 50,10
Aw 51,11
Aw 52,12
Aw 53,13
Aw 54,14
Aw 55,15
Ar 8,56
Ar 9,57
Ar 10,58
Ar 11,59
Ar 12,60
Ar 13,61
Ar 14,62
Ar 15,63
Vm 8,8,22
Vm 9,9,22
Vm 10,10,22
Vm 11,11,22
Vm 12,12,22
Vm 13,13,22
Vm 14,14,22
Vm 15,15,22
Aw 56,8
Aw 57,9
Aw 58,10
Aw 59,11
Aw 60,12
Aw 61,13
Aw 62,14
Aw 63,15
Ve 8,128
Ve 9,129
s_nop 0
Vc 64,8,9
Ve 8,130
Ve 9,131
s_nop 0
Vc 65,8,9
Ve 8,144
Ve 9,145
s_nop 0
Vc 72,8,9
Ve 8,146
Ve 9,147
s_nop 0
Vc 73,8,9
Ve 8,132
Ve 9,133
s_nop 0
Vc 66,8,9
Ve 8,134
Ve 9,135
s_nop 0
Vc 67,8,9
Ve 8,148
Ve 9,149
s_nop 0
Vc 74,8,9
Ve 8,150
Ve 9,151
s_nop 0
Vc 75,8,9
Ve 8,136
Ve 9,137
s_nop 0
Vc 68,8,9
Ve 8,138
Ve 9,139
s_nop 0
Vc 69,8,9
Ve 8,152
Ve 9,153
s_nop 0
Vc 76,8,9
Ve 8,154
Ve 9,155
s_nop 0
Vc 77,8,9
Ve 8,140
Ve 9,141
s_nop 0
Vc 70,8,9
Ve 8,142
Ve 9,143
s_nop 0
Vc 71,8,9
Ve 8,156
Ve 9,157
s_nop 0
Vc 78,8,9
Ve 8,158
Ve 9,159
s_nop 0
Vc 79,8,9
s_nop 1
s_branch L_k2_fbr_ne
L_pubB:
v_mov_b32 v24, 1
v_mov_b32 v25, 0
s_mov_b64 exec, 1
buffer_store_dword v24, v25, s[20:23], s64 offen sc1
s_mov_b64 exec, -1
s_branch L_pubBr
L_k2_fb_no:
s_nop 7
v_max3_f32 v21, v192, v193, v194
v_max3_f32 v21, v21, v195, v196
v_max3_f32 v21, v21, v197, v198
v_max3_f32 v21, v21, v199, v200
v_max3_f32 v21, v21, v201, v202
v_max3_f32 v21, v21, v203, v204
v_max3_f32 v21, v21, v205, v206
v_max_f32 v21, v21, v207
v_mov_b32 v1, v21
s_nop 1
v_permlane16_swap_b32 v1, v21
v_max_f32 v21, v21, v1
v_mov_b32 v1, v21
s_nop 1
v_permlane32_swap_b32 v1, v21
v_max_f32_e64 v21, v21, v1
v_add_f32 v21, 0x41f80000, v21
v_max_f32 v21, 0, v21
Vs 192,192,21
Vs 193,193,21
Vs 194,194,21
Vs 195,195,21
Vs 196,196,21
Vs 197,197,21
Vs 198,198,21
Vs 199,199,21
Vs 200,200,21
Vs 201,201,21
Vs 202,202,21
Vs 203,203,21
Vs 204,204,21
Vs 205,205,21
Vs 206,206,21
Vs 207,207,21
Vs 128,128,21
Vs 129,129,21
Vs 130,130,21
Vs 131,131,21
Vs 132,132,21
Vs 133,133,21
Vs 134,134,21
Vs 135,135,21
Vs 136,136,21
Vs 137,137,21
Vs 138,138,21
Vs 139,139,21
Vs 140,140,21
Vs 141,141,21
Vs 142,142,21
Vs 143,143,21
Vs 32,32,21
Vs 33,33,21
Vs 34,34,21
v_sub_f32_e64 v35, v35, v21
v_exp_f32 v22, -v21
s_nop 0
Vm 48,48,22
Vm 49,49,22
Vm 50,50,22
v_mul_f32_e64 v51, v51, v22
Ar 8,0
Ar 9,1
Ar 10,2
Ar 11,3
Ar 12,4
Ar 13,5
Ar 14,6
Ar 15,7
Vm 8,8,22
Vm 9,9,22
Vm 10,10,22
Vm 11,11,22
Vm 12,12,22
Vm 13,13,22
Vm 14,14,22
Vm 15,15,22
Aw 0,8
Aw 1,9
Aw 2,10
Aw 3,11
Aw 4,12
Aw 5,13
Aw 6,14
Aw 7,15
Ar 8,8
Ar 9,9
Ar 10,10
Ar 11,11
Ar 12,12
Ar 13,13
Ar 14,14
Ar 15,15
Vm 8,8,22
Vm 9,9,22
Vm 10,10,22
Vm 11,11,22
Vm 12,12,22
Vm 13,13,22
Vm 14,14,22
Vm 15,15,22
Aw 8,8
Aw 9,9
Aw 10,10
Aw 11,11
Aw 12,12
Aw 13,13
Aw 14,14
Aw 15,15
Ar 8,16
Ar 9,17
Ar 10,18
Ar 11,19
Ar 12,20
Ar 13,21
Ar 14,22
Ar 15,23
Vm 8,8,22
Vm 9,9,22
Vm 10,10,22
Vm 11,11,22
Vm 12,12,22
Vm 13,13,22
Vm 14,14,22
Vm 15,15,22
Aw 16,8
Aw 17,9
Aw 18,10
Aw 19,11
Aw 20,12
Aw 21,13
Aw 22,14
Aw 23,15
Ar 8,24
Ar 9,25
Ar 10,26
Ar 11,27
Ar 12,28
Ar 13,29
Ar 14,30
Ar 15,31
Vm 8,8,22
Vm 9,9,22
Vm 10,10,22
Vm 11,11,22
Vm 12,12,22
Vm 13,13,22
Vm 14,14,22
Vm 15,15,22
Aw 24,8
Aw 25,9
Aw 26,10
Aw 27,11
Aw 28,12
Aw 29,13
Aw 30,14
Aw 31,15
v_max3_f32 v21, v208, v209, v210
v_max3_f32 v21, v21, v211, v212
v_max3_f32 v21, v21, v213, v214
v_max3_f32 v21, v21, v215, v216
v_max3_f32 v21, v21, v217, v218
v_max3_f32 v21, v21, v219, v220
v_max3_f32 v21, v21, v221, v222
v_max_f32 v21, v21, v223
v_mov_b32 v1, v21
s_nop 1
v_permlane16_swap_b32 v1, v21
v_max_f32 v21, v21, v1
v_mov_b32 v1, v21
s_nop 1
v_permlane32_swap_b32 v1, v21
v_max_f32_e64 v21, v21, v1
v_add_f32 v21, 0x41f80000, v21
v_max_f32 v21, 0, v21
Vs 208,208,21
Vs 209,209,21
Vs 210,210,21
Vs 211,211,21
Vs 212,212,21
Vs 213,213,21
Vs 214,214,21
Vs 215,215,21
Vs 216,216,21
Vs 217,217,21
Vs 218,218,21
Vs 219,219,21
Vs 220,220,21
Vs 221,221,21
Vs 222,222,21
Vs 223,223,21
Vs 144,144,21
Vs 145,145,21
Vs 146,146,21
Vs 147,147,21
Vs 148,148,21
Vs 149,149,21
Vs 150,150,21
Vs 151,151,21
Vs 152,152,21
Vs 153,153,21
Vs 154,154,21
Vs 155,155,21
Vs 156,156,21
Vs 157,157,21
Vs 158,158,21
Vs 159,159,21
Vs 36,36,21
Vs 37,37,21
Vs 38,38,21
v_sub_f32_e64 v39, v39, v21
v_exp_f32 v22, -v21
s_nop 0
Vm 52,52,22
Vm 53,53,22
Vm 54,54,22
v_mul_f32_e64 v55, v55, v22
Ar 8,32
Ar 9,33
Ar 10,34
Ar 11,35
Ar 12,36
Ar 13,37
Ar 14,38
Ar 15,39
Vm 8,8,22
Vm 9,9,22
Vm 10,10,22
Vm 11,11,22
Vm 12,12,22
Vm 13,13,22
Vm 14,14,22
Vm 15,15,22
Aw 32,8
Aw 33,9
Aw 34,10
Aw 35,11
Aw 36,12
Aw 37,13
Aw 38,14
Aw 39,15
Ar 8,40
Ar 9,41
Ar 10,42
Ar 11,43
Ar 12,44
Ar 13,45
Ar 14,46
Ar 15,47
Vm 8,8,22
Vm 9,9,22
Vm 10,10,22
Vm 11,11,22
Vm 12,12,22
Vm 13,13,22
Vm 14,14,22
Vm 15,15,22
Aw 40,8
Aw 41,9
Aw 42,10
Aw 43,11
Aw 44,12
Aw 45,13
Aw 46,14
Aw 47,15
Ar 8,48
Ar 9,49
Ar 10,50
Ar 11,51
Ar 12,52
Ar 13,53
Ar 14,54
Ar 15,55
Vm 8,8,22
Vm 9,9,22
Vm 10,10,22
Vm 11,11,22
Vm 12,12,22
Vm 13,13,22
Vm 14,14,22
Vm 15,15,22
Aw 48,8
Aw 49,9
Aw 50,10
Aw 51,11
Aw 52,12
Aw 53,13
Aw 54,14
Aw 55,15
Ar 8,56
Ar 9,57
Ar 10,58
Ar 11,59
Ar 12,60
Ar 13,61
Ar 14,62
Ar 15,63
Vm 8,8,22
Vm 9,9,22
Vm 10,10,22
Vm 11,11,22
Vm 12,12,22
Vm 13,13,22
Vm 14,14,22
Vm 15,15,22
Aw 56,8
Aw 57,9
Aw 58,10
Aw 59,11
Aw 60,12
Aw 61,13
Aw 62,14
Aw 63,15
Ve 8,192
Ve 9,193
s_nop 0
Vc 96,8,9
Ve 8,194
Ve 9,195
s_nop 0
Vc 97,8,9
Ve 8,208
Ve 9,209
s_nop 0
Vc 104,8,9
Ve 8,210
Ve 9,211
s_nop 0
Vc 105,8,9
Ve 8,196
Ve 9,197
s_nop 0
Vc 98,8,9
Ve 8,198
Ve 9,199
s_nop 0
Vc 99,8,9
Ve 8,212
Ve 9,213
s_nop 0
Vc 106,8,9
Ve 8,214
Ve 9,215
s_nop 0
Vc 107,8,9
Ve 8,200
Ve 9,201
s_nop 0
Vc 100,8,9
Ve 8,202
Ve 9,203
s_nop 0
Vc 101,8,9
Ve 8,216
Ve 9,217
s_nop 0
Vc 108,8,9
Ve 8,218
Ve 9,219
s_nop 0
Vc 109,8,9
Ve 8,204
Ve 9,205
s_nop 0
Vc 102,8,9
Ve 8,206
Ve 9,207
s_nop 0
Vc 103,8,9
Ve 8,220
Ve 9,221
s_nop 0
Vc 110,8,9
Ve 8,222
Ve 9,223
s_nop 0
Vc 111,8,9
s_nop 1
s_branch L_k2_fbr_no
L_k2_mk_no:
v_cmp_gt_i32 s[56:57], 0, v5
v_cmp_gt_i32 s[58:59], 1, v5
v_cmp_gt_i32 s[60:61], 2, v5
v_cmp_gt_i32 s[62:63], 3, v5
s_nop 3
s_nop 0
v_cndmask_b32 v144, v144, v20, s[56:57]
v_cndmask_b32 v145, v145, v20, s[58:59]
v_cndmask_b32 v146, v146, v20, s[60:61]
v_cndmask_b32 v147, v147, v20, s[62:63]
v_cmp_gt_i32 s[56:57], 16, v5
v_cmp_gt_i32 s[58:59], 17, v5
v_cmp_gt_i32 s[60:61], 18, v5
v_cmp_gt_i32 s[62:63], 19, v5
v_cndmask_b32 v148, v148, v20, s[56:57]
v_cndmask_b32 v149, v149, v20, s[58:59]
v_cndmask_b32 v150, v150, v20, s[60:61]
v_cndmask_b32 v151, v151, v20, s[62:63]
v_cmp_gt_i32 s[56:57], 32, v5
v_cmp_gt_i32 s[58:59], 33, v5
v_cmp_gt_i32 s[60:61], 34, v5
v_cmp_gt_i32 s[62:63], 35, v5
v_cndmask_b32 v152, v152, v20, s[56:57]
v_cndmask_b32 v153, v153, v20, s[58:59]
v_cndmask_b32 v154, v154, v20, s[60:61]
v_cndmask_b32 v155, v155, v20, s[62:63]
v_cmp_gt_i32 s[56:57], 48, v5
v_cmp_gt_i32 s[58:59], 49, v5
v_cmp_gt_i32 s[60:61], 50, v5
v_cmp_gt_i32 s[62:63], 51, v5
v_cndmask_b32 v156, v156, v20, s[56:57]
v_cndmask_b32 v157, v157, v20, s[58:59]
v_cndmask_b32 v158, v158, v20, s[60:61]
v_cndmask_b32 v159, v159, v20, s[62:63]
s_branch L_k2_mkr_no
L_k2_fb_nl:
s_nop 7
v_max3_f32 v21, v128, v129, v130
v_max3_f32 v21, v21, v131, v132
v_max3_f32 v21, v21, v133, v134
v_max3_f32 v21, v21, v135, v136
v_max3_f32 v21, v21, v137, v138
v_max3_f32 v21, v21, v139, v140
v_max3_f32 v21, v21, v141, v142
v_max_f32 v21, v21, v143
v_mov_b32 v1, v21
s_nop 1
v_permlane16_swap_b32 v1, v21
v_max_f32 v21, v21, v1
v_mov_b32 v1, v21
s_nop 1
v_permlane32_swap_b32 v1, v21
v_max_f32_e64 v21, v21, v1
v_add_f32 v21, 0x41f80000, v21
v_max_f32 v21, 0, v21
Vs 128,128,21
Vs 129,129,21
Vs 130,130,21
Vs 131,131,21
Vs 132,132,21
Vs 133,133,21
Vs 134,134,21
Vs 135,135,21
Vs 136,136,21
Vs 137,137,21
Vs 138,138,21
Vs 139,139,21
Vs 140,140,21
Vs 141,141,21
Vs 142,142,21
Vs 143,143,21
Vs 192,192,21
Vs 193,193,21
Vs 194,194,21
Vs 195,195,21
Vs 196,196,21
Vs 197,197,21
Vs 198,198,21
Vs 199,199,21
Vs 200,200,21
Vs 201,201,21
Vs 202,202,21
Vs 203,203,21
Vs 204,204,21
Vs 205,205,21
Vs 206,206,21
Vs 207,207,21
Vs 32,32,21
Vs 33,33,21
Vs 34,34,21
v_sub_f32_e64 v35, v35, v21
v_exp_f32 v22, -v21
s_nop 0
Vm 48,48,22
Vm 49,49,22
Vm 50,50,22
v_mul_f32_e64 v51, v51, v22
Ar 8,0
Ar 9,1
Ar 10,2
Ar 11,3
Ar 12,4
Ar 13,5
Ar 14,6
Ar 15,7
Vm 8,8,22
Vm 9,9,22
Vm 10,10,22
Vm 11,11,22
Vm 12,12,22
Vm 13,13,22
Vm 14,14,22
Vm 15,15,22
Aw 0,8
Aw 1,9
Aw 2,10
Aw 3,11
Aw 4,12
Aw 5,13
Aw 6,14
Aw 7,15
Ar 8,8
Ar 9,9
Ar 10,10
Ar 11,11
Ar 12,12
Ar 13,13
Ar 14,14
Ar 15,15
Vm 8,8,22
Vm 9,9,22
Vm 10,10,22
Vm 11,11,22
Vm 12,12,22
Vm 13,13,22
Vm 14,14,22
Vm 15,15,22
Aw 8,8
Aw 9,9
Aw 10,10
Aw 11,11
Aw 12,12
Aw 13,13
Aw 14,14
Aw 15,15
Ar 8,16
Ar 9,17
Ar 10,18
Ar 11,19
Ar 12,20
Ar 13,21
Ar 14,22
Ar 15,23
Vm 8,8,22
Vm 9,9,22
Vm 10,10,22
Vm 11,11,22
Vm 12,12,22
Vm 13,13,22
Vm 14,14,22
Vm 15,15,22
Aw 16,8
Aw 17,9
Aw 18,10
Aw 19,11
Aw 20,12
Aw 21,13
Aw 22,14
Aw 23,15
Ar 8,24
Ar 9,25
Ar 10,26
Ar 11,27
Ar 12,28
Ar 13,29
Ar 14,30
Ar 15,31
Vm 8,8,22
Vm 9,9,22
Vm 10,10,22
Vm 11,11,22
Vm 12,12,22
Vm 13,13,22
Vm 14,14,22
Vm 15,15,22
Aw 24,8
Aw 25,9
Aw 26,10
Aw 27,11
Aw 28,12
Aw 29,13
Aw 30,14
Aw 31,15
v_max3_f32 v21, v144, v145, v146
v_max3_f32 v21, v21, v147, v148
v_max3_f32 v21, v21, v149, v150
v_max3_f32 v21, v21, v151, v152
v_max3_f32 v21, v21, v153, v154
v_max3_f32 v21, v21, v155, v156
v_max3_f32 v21, v21, v157, v158
v_max_f32 v21, v21, v159
v_mov_b32 v1, v21
s_nop 1
v_permlane16_swap_b32 v1, v21
v_max_f32 v21, v21, v1
v_mov_b32 v1, v21
s_nop 1
v_permlane32_swap_b32 v1, v21
v_max_f32_e64 v21, v21, v1
v_add_f32 v21, 0x41f80000, v21
v_max_f32 v21, 0, v21
Vs 144,144,21
Vs 145,145,21
Vs 146,146,21
Vs 147,147,21
Vs 148,148,21
Vs 149,149,21
Vs 150,150,21
Vs 151,151,21
Vs 152,152,21
Vs 153,153,21
Vs 154,154,21
Vs 155,155,21
Vs 156,156,21
Vs 157,157,21
Vs 158,158,21
Vs 159,159,21
Vs 36,36,21
Vs 37,37,21
Vs 38,38,21
v_sub_f32_e64 v39, v39, v21
v_exp_f32 v22, -v21
s_nop 0
Vm 52,52,22
Vm 53,53,22
Vm 54,54,22
v_mul_f32_e64 v55, v55, v22
Ar 8,32
Ar 9,33
Ar 10,34
Ar 11,35
Ar 12,36
Ar 13,37
Ar 14,38
Ar 15,39
Vm 8,8,22
Vm 9,9,22
Vm 10,10,22
Vm 11,11,22
Vm 12,12,22
Vm 13,13,22
Vm 14,14,22
Vm 15,15,22
Aw 32,8
Aw 33,9
Aw 34,10
Aw 35,11
Aw 36,12
Aw 37,13
Aw 38,14
Aw 39,15
Ar 8,40
Ar 9,41
Ar 10,42
Ar 11,43
Ar 12,44
Ar 13,45
Ar 14,46
Ar 15,47
Vm 8,8,22
Vm 9,9,22
Vm 10,10,22
Vm 11,11,22
Vm 12,12,22
Vm 13,13,22
Vm 14,14,22
Vm 15,15,22
Aw 40,8
Aw 41,9
Aw 42,10
Aw 43,11
Aw 44,12
Aw 45,13
Aw 46,14
Aw 47,15
Ar 8,48
Ar 9,49
Ar 10,50
Ar 11,51
Ar 12,52
Ar 13,53
Ar 14,54
Ar 15,55
Vm 8,8,22
Vm 9,9,22
Vm 10,10,22
Vm 11,11,22
Vm 12,12,22
Vm 13,13,22
Vm 14,14,22
Vm 15,15,22
Aw 48,8
Aw 49,9
Aw 50,10
Aw 51,11
Aw 52,12
Aw 53,13
Aw 54,14
Aw 55,15
Ar 8,56
Ar 9,57
Ar 10,58
Ar 11,59
Ar 12,60
Ar 13,61
Ar 14,62
Ar 15,63
Vm 8,8,22
Vm 9,9,22
Vm 10,10,22
Vm 11,11,22
Vm 12,12,22
Vm 13,13,22
Vm 14,14,22
Vm 15,15,22
Aw 56,8
Aw 57,9
Aw 58,10
Aw 59,11
Aw 60,12
Aw 61,13
Aw 62,14
Aw 63,15
Ve 8,128
Ve 9,129
s_nop 0
Vc 64,8,9
Ve 8,130
Ve 9,131
s_nop 0
Vc 65,8,9
Ve 8,144
Ve 9,145
s_nop 0
Vc 72,8,9
Ve 8,146
Ve 9,147
s_nop 0
Vc 73,8,9
Ve 8,132
Ve 9,133
s_nop 0
Vc 66,8,9
Ve 8,134
Ve 9,135
s_nop 0
Vc 67,8,9
Ve 8,148
Ve 9,149
s_nop 0
Vc 74,8,9
Ve 8,150
Ve 9,151
s_nop 0
Vc 75,8,9
Ve 8,136
Ve 9,137
s_nop 0
Vc 68,8,9
Ve 8,138
Ve 9,139
s_nop 0
Vc 69,8,9
Ve 8,152
Ve 9,153
s_nop 0
Vc 76,8,9
Ve 8,154
Ve 9,155
s_nop 0
Vc 77,8,9
Ve 8,140
Ve 9,141
s_nop 0
Vc 70,8,9
Ve 8,142
Ve 9,143
s_nop 0
Vc 71,8,9
Ve 8,156
Ve 9,157
s_nop 0
Vc 78,8,9
Ve 8,158
Ve 9,159
s_nop 0
Vc 79,8,9
s_nop 1
s_branch L_k2_fbr_nl
L_k2_mk_nl:
v_cmp_gt_i32 s[56:57], 0, v6
v_cmp_gt_i32 s[58:59], 1, v6
v_cmp_gt_i32 s[60:61], 2, v6
v_cmp_gt_i32 s[62:63], 3, v6
s_nop 3
s_nop 0
v_cndmask_b32 v192, v192, v20, s[56:57]
v_cndmask_b32 v193, v193, v20, s[58:59]
v_cndmask_b32 v194, v194, v20, s[60:61]
v_cndmask_b32 v195, v195, v20, s[62:63]
v_cmp_gt_i32 s[56:57], 16, v6
v_cmp_gt_i32 s[58:59], 17, v6
v_cmp_gt_i32 s[60:61], 18, v6
v_cmp_gt_i32 s[62:63], 19, v6
v_cndmask_b32 v196, v196, v20, s[56:57]
v_cndmask_b32 v197, v197, v20, s[58:59]
v_cndmask_b32 v198, v198, v20, s[60:61]
v_cndmask_b32 v199, v199, v20, s[62:63]
v_cmp_gt_i32 s[56:57], 32, v6
v_cmp_gt_i32 s[58:59], 33, v6
v_cmp_gt_i32 s[60:61], 34, v6
v_cmp_gt_i32 s[62:63], 35, v6
v_cndmask_b32 v200, v200, v20, s[56:57]
v_cndmask_b32 v201, v201, v20, s[58:59]
v_cndmask_b32 v202, v202, v20, s[60:61]
v_cndmask_b32 v203, v203, v20, s[62:63]
v_cmp_gt_i32 s[56:57], 48, v6
v_cmp_gt_i32 s[58:59], 49, v6
v_cmp_gt_i32 s[60:61], 50, v6
v_cmp_gt_i32 s[62:63], 51, v6
v_cndmask_b32 v204, v204, v20, s[56:57]
v_cndmask_b32 v205, v205, v20, s[58:59]
v_cndmask_b32 v206, v206, v20, s[60:61]
v_cndmask_b32 v207, v207, v20, s[62:63]
s_branch L_k2_mkr_nl
L_k2_fb_fi:
s_nop 7
v_max3_f32 v21, v192, v193, v194
v_max3_f32 v21, v21, v195, v196
v_max3_f32 v21, v21, v197, v198
v_max3_f32 v21, v21, v199, v200
v_max3_f32 v21, v21, v201, v202
v_max3_f32 v21, v21, v203, v204
v_max3_f32 v21, v21, v205, v206
v_max_f32 v21, v21, v207
v_mov_b32 v1, v21
s_nop 1
v_permlane16_swap_b32 v1, v21
v_max_f32 v21, v21, v1
v_mov_b32 v1, v21
s_nop 1
v_permlane32_swap_b32 v1, v21
v_max_f32_e64 v21, v21, v1
v_add_f32 v21, 0x41f80000, v21
v_max_f32 v21, 0, v21
Vs 192,192,21
Vs 193,193,21
Vs 194,194,21
Vs 195,195,21
Vs 196,196,21
Vs 197,197,21
Vs 198,198,21
Vs 199,199,21
Vs 200,200,21
Vs 201,201,21
Vs 202,202,21
Vs 203,203,21
Vs 204,204,21
Vs 205,205,21
Vs 206,206,21
Vs 207,207,21
Vs 32,32,21
Vs 33,33,21
Vs 34,34,21
v_sub_f32_e64 v35, v35, v21
v_exp_f32 v22, -v21
s_nop 0
Vm 48,48,22
Vm 49,49,22
Vm 50,50,22
v_mul_f32_e64 v51, v51, v22
Ar 8,0
Ar 9,1
Ar 10,2
Ar 11,3
Ar 12,4
Ar 13,5
Ar 14,6
Ar 15,7
Vm 8,8,22
Vm 9,9,22
Vm 10,10,22
Vm 11,11,22
Vm 12,12,22
Vm 13,13,22
Vm 14,14,22
Vm 15,15,22
Aw 0,8
Aw 1,9
Aw 2,10
Aw 3,11
Aw 4,12
Aw 5,13
Aw 6,14
Aw 7,15
Ar 8,8
Ar 9,9
Ar 10,10
Ar 11,11
Ar 12,12
Ar 13,13
Ar 14,14
Ar 15,15
Vm 8,8,22
Vm 9,9,22
Vm 10,10,22
Vm 11,11,22
Vm 12,12,22
Vm 13,13,22
Vm 14,14,22
Vm 15,15,22
Aw 8,8
Aw 9,9
Aw 10,10
Aw 11,11
Aw 12,12
Aw 13,13
Aw 14,14
Aw 15,15
Ar 8,16
Ar 9,17
Ar 10,18
Ar 11,19
Ar 12,20
Ar 13,21
Ar 14,22
Ar 15,23
Vm 8,8,22
Vm 9,9,22
Vm 10,10,22
Vm 11,11,22
Vm 12,12,22
Vm 13,13,22
Vm 14,14,22
Vm 15,15,22
Aw 16,8
Aw 17,9
Aw 18,10
Aw 19,11
Aw 20,12
Aw 21,13
Aw 22,14
Aw 23,15
Ar 8,24
Ar 9,25
Ar 10,26
Ar 11,27
Ar 12,28
Ar 13,29
Ar 14,30
Ar 15,31
Vm 8,8,22
Vm 9,9,22
Vm 10,10,22
Vm 11,11,22
Vm 12,12,22
Vm 13,13,22
Vm 14,14,22
Vm 15,15,22
Aw 24,8
Aw 25,9
Aw 26,10
Aw 27,11
Aw 28,12
Aw 29,13
Aw 30,14
Aw 31,15
Ve 8,192
Ve 9,193
s_nop 0
Vc 96,8,9
Ve 8,194
Ve 9,195
s_nop 0
Vc 97,8,9
Ve 8,196
Ve 9,197
s_nop 0
Vc 98,8,9
Ve 8,198
Ve 9,199
s_nop 0
Vc 99,8,9
Ve 8,200
Ve 9,201
s_nop 0
Vc 100,8,9
Ve 8,202
Ve 9,203
s_nop 0
Vc 101,8,9
Ve 8,204
Ve 9,205
s_nop 0
Vc 102,8,9
Ve 8,206
Ve 9,207
s_nop 0
Vc 103,8,9
s_nop 1
s_branch L_k2_fbr_fi
L_ysl:
s_mov_b32 s47, 0x400000
L_ysll:
buffer_load_dword v124, v127, s[20:23], s41 offen sc1
s_sub_u32 s47, s47, 1
s_waitcnt vmcnt(0)
s_cmp_eq_u32 s47, 0
s_cbranch_scc1 L_ysllx
v_cmp_ne_u32 vcc, 1, v124
s_cbranch_vccz L_ysllx
s_sleep 8
s_branch L_ysll
L_ysllx:
v_lshlrev_b32_e64 v125, 10, v123
v_lshl_add_u32 v125, v122, 5, v125
v_mov_b32 v124, 2146435072
v_cmp_gt_u32 vcc, 7, v123
s_nop 1
v_cndmask_b32 v125, v124, v125, vcc
s_nop 0
buffer_load_dwordx4 v[80:83], v125, s[20:23], s44 offen offset:0 sc1
buffer_load_dwordx4 v[84:87], v125, s[20:23], s44 offen offset:16 sc1
buffer_load_dwordx4 v[88:91], v125, s[20:23], s44 offen offset:256 sc1
buffer_load_dwordx4 v[92:95], v125, s[20:23], s44 offen offset:272 sc1
buffer_load_dwordx4 v[96:99], v125, s[20:23], s44 offen offset:512 sc1
buffer_load_dwordx4 v[100:103], v125, s[20:23], s44 offen offset:528 sc1
buffer_load_dwordx4 v[104:107], v125, s[20:23], s44 offen offset:768 sc1
buffer_load_dwordx4 v[108:111], v125, s[20:23], s44 offen offset:784 sc1
s_waitcnt vmcnt(0)
s_nop 0
v_pk_add_f32 v[80:81], v[80:81], v[96:97]
v_pk_add_f32 v[82:83], v[82:83], v[98:99]
v_pk_add_f32 v[84:85], v[84:85], v[100:101]
v_pk_add_f32 v[86:87], v[86:87], v[102:103]
v_pk_add_f32 v[88:89], v[88:89], v[104:105]
v_pk_add_f32 v[90:91], v[90:91], v[106:107]
v_pk_add_f32 v[92:93], v[92:93], v[108:109]
v_pk_add_f32 v[94:95], v[94:95], v[110:111]
v_add_f32_dpp v80, v80, v80 row_ror:8 row_mask:0xf bank_mask:0xf
v_add_f32_dpp v81, v81, v81 row_ror:8 row_mask:0xf bank_mask:0xf
v_add_f32_dpp v82, v82, v82 row_ror:8 row_mask:0xf bank_mask:0xf
v_add_f32_dpp v83, v83, v83 row_ror:8 row_mask:0xf bank_mask:0xf
v_add_f32_dpp v84, v84, v84 row_ror:8 row_mask:0xf bank_mask:0xf
v_add_f32_dpp v85, v85, v85 row_ror:8 row_mask:0xf bank_mask:0xf
v_add_f32_dpp v86, v86, v86 row_ror:8 row_mask:0xf bank_mask:0xf
v_add_f32_dpp v87, v87, v87 row_ror:8 row_mask:0xf bank_mask:0xf
v_add_f32_dpp v88, v88, v88 row_ror:8 row_mask:0xf bank_mask:0xf
v_add_f32_dpp v89, v89, v89 row_ror:8 row_mask:0xf bank_mask:0xf
v_add_f32_dpp v90, v90, v90 row_ror:8 row_mask:0xf bank_mask:0xf
v_add_f32_dpp v91, v91, v91 row_ror:8 row_mask:0xf bank_mask:0xf
v_add_f32_dpp v92, v92, v92 row_ror:8 row_mask:0xf bank_mask:0xf
v_add_f32_dpp v93, v93, v93 row_ror:8 row_mask:0xf bank_mask:0xf
v_add_f32_dpp v94, v94, v94 row_ror:8 row_mask:0xf bank_mask:0xf
v_add_f32_dpp v95, v95, v95 row_ror:8 row_mask:0xf bank_mask:0xf
v_mov_b32 v96, v80
v_mov_b32 v97, v81
v_mov_b32 v98, v82
v_mov_b32 v99, v83
v_mov_b32 v100, v84
v_mov_b32 v101, v85
v_mov_b32 v102, v86
v_mov_b32 v103, v87
v_mov_b32 v104, v88
v_mov_b32 v105, v89
v_mov_b32 v106, v90
v_mov_b32 v107, v91
v_mov_b32 v108, v92
v_mov_b32 v109, v93
v_mov_b32 v110, v94
v_mov_b32 v111, v95
v_permlane16_swap_b32 v96, v80
v_permlane16_swap_b32 v97, v81
v_permlane16_swap_b32 v98, v82
v_permlane16_swap_b32 v99, v83
v_permlane16_swap_b32 v100, v84
v_permlane16_swap_b32 v101, v85
v_permlane16_swap_b32 v102, v86
v_permlane16_swap_b32 v103, v87
v_permlane16_swap_b32 v104, v88
v_permlane16_swap_b32 v105, v89
v_permlane16_swap_b32 v106, v90
v_permlane16_swap_b32 v107, v91
v_permlane16_swap_b32 v108, v92
v_permlane16_swap_b32 v109, v93
v_permlane16_swap_b32 v110, v94
v_permlane16_swap_b32 v111, v95
Va 80,80,96
Va 81,81,97
Va 82,82,98
Va 83,83,99
Va 84,84,100
Va 85,85,101
Va 86,86,102
Va 87,87,103
Va 88,88,104
Va 89,89,105
Va 90,90,106
Va 91,91,107
Va 92,92,108
Va 93,93,109
Va 94,94,110
Va 95,95,111
v_mov_b32 v96, v80
v_mov_b32 v97, v81
v_mov_b32 v98, v82
v_mov_b32 v99, v83
v_mov_b32 v100, v84
v_mov_b32 v101, v85
v_mov_b32 v102, v86
v_mov_b32 v103, v87
v_mov_b32 v104, v88
v_mov_b32 v105, v89
v_mov_b32 v106, v90
v_mov_b32 v107, v91
v_mov_b32 v108, v92
v_mov_b32 v109, v93
v_mov_b32 v110, v94
v_mov_b32 v111, v95
v_permlane32_swap_b32 v96, v80
v_permlane32_swap_b32 v97, v81
v_permlane32_swap_b32 v98, v82
v_permlane32_swap_b32 v99, v83
v_permlane32_swap_b32 v100, v84
v_permlane32_swap_b32 v101, v85
v_permlane32_swap_b32 v102, v86
v_permlane32_swap_b32 v103, v87
v_permlane32_swap_b32 v104, v88
v_permlane32_swap_b32 v105, v89
v_permlane32_swap_b32 v106, v90
v_permlane32_swap_b32 v107, v91
v_permlane32_swap_b32 v108, v92
v_permlane32_swap_b32 v109, v93
v_permlane32_swap_b32 v110, v94
v_permlane32_swap_b32 v111, v95
Va 80,80,96
Va 81,81,97
Va 82,82,98
Va 83,83,99
Va 84,84,100
Va 85,85,101
Va 86,86,102
Va 87,87,103
Va 88,88,104
Va 89,89,105
Va 90,90,106
Va 91,91,107
Va 92,92,108
Va 93,93,109
Va 94,94,110
Va 95,95,111
Vc 124,80,81
v_lshlrev_b32_e64 v80, 16, v124
v_and_b32 v81, 0xffff0000, v124
Vc 124,82,83
v_lshlrev_b32_e64 v82, 16, v124
v_and_b32 v83, 0xffff0000, v124
Vc 124,84,85
v_lshlrev_b32_e64 v84, 16, v124
v_and_b32 v85, 0xffff0000, v124
Vc 124,86,87
v_lshlrev_b32_e64 v86, 16, v124
v_and_b32 v87, 0xffff0000, v124
Vc 124,88,89
v_lshlrev_b32_e64 v88, 16, v124
v_and_b32 v89, 0xffff0000, v124
Vc 124,90,91
v_lshlrev_b32_e64 v90, 16, v124
v_and_b32 v91, 0xffff0000, v124
Vc 124,92,93
v_lshlrev_b32_e64 v92, 16, v124
v_and_b32 v93, 0xffff0000, v124
Vc 124,94,95
v_lshlrev_b32_e64 v94, 16, v124
v_and_b32 v95, 0xffff0000, v124
v_mul_f32 v80, s100, v80
v_mul_f32 v81, s100, v81
v_mul_f32 v82, s100, v82
v_mul_f32 v83, s100, v83
v_mul_f32 v84, s100, v84
v_mul_f32 v85, s100, v85
v_mul_f32 v86, s100, v86
v_mul_f32 v87, s100, v87
v_mul_f32 v88, s101, v88
v_mul_f32 v89, s101, v89
v_mul_f32 v90, s101, v90
v_mul_f32 v91, s101, v91
v_mul_f32 v92, s101, v92
v_mul_f32 v93, s101, v93
v_mul_f32 v94, s101, v94
v_mul_f32 v95, s101, v95
Vc 124,80,81
v_lshlrev_b32_e64 v80, 16, v124
v_and_b32 v81, 0xffff0000, v124
Vc 124,82,83
v_lshlrev_b32_e64 v82, 16, v124
v_and_b32 v83, 0xffff0000, v124
Vc 124,84,85
v_lshlrev_b32_e64 v84, 16, v124
v_and_b32 v85, 0xffff0000, v124
Vc 124,86,87
v_lshlrev_b32_e64 v86, 16, v124
v_and_b32 v87, 0xffff0000, v124
Vc 124,88,89
v_lshlrev_b32_e64 v88, 16, v124
v_and_b32 v89, 0xffff0000, v124
Vc 124,90,91
v_lshlrev_b32_e64 v90, 16, v124
v_and_b32 v91, 0xffff0000, v124
Vc 124,92,93
v_lshlrev_b32_e64 v92, 16, v124
v_and_b32 v93, 0xffff0000, v124
Vc 124,94,95
v_lshlrev_b32_e64 v94, 16, v124
v_and_b32 v95, 0xffff0000, v124
s_lshl_b32 s3, s45, 7
s_sub_u32 s42, s42, s3
s_sub_u32 s43, s43, s3
v_add_u32 v124, 0, v120
v_cmp_eq_u32 vcc, s42, v124
v_cmp_eq_u32 s[6:7], s43, v124
s_nop 3
s_or_b64 s[4:5], vcc, s[6:7]
s_cbranch_scc0 L_f_selskip5
v_cndmask_b32 v96, 0, v80, vcc
v_cndmask_b32 v96, v96, v88, s[6:7]
v_cndmask_b32 v97, 0, v81, vcc
v_cndmask_b32 v97, v97, v89, s[6:7]
v_cndmask_b32 v98, 0, v82, vcc
v_cndmask_b32 v98, v98, v90, s[6:7]
v_cndmask_b32 v99, 0, v83, vcc
v_cndmask_b32 v99, v99, v91, s[6:7]
v_cndmask_b32 v100, 0, v84, vcc
v_cndmask_b32 v100, v100, v92, s[6:7]
v_cndmask_b32 v101, 0, v85, vcc
v_cndmask_b32 v101, v101, v93, s[6:7]
v_cndmask_b32 v102, 0, v86, vcc
v_cndmask_b32 v102, v102, v94, s[6:7]
v_cndmask_b32 v103, 0, v87, vcc
v_cndmask_b32 v103, v103, v95, s[6:7]
v_lshlrev_b32_e64 v42, 16, v18
v_and_b32 v43, 0xffff0000, v18
v_lshlrev_b32_e64 v44, 16, v19
v_and_b32 v45, 0xffff0000, v19
v_lshlrev_b32_e64 v46, 16, v20
v_and_b32 v47, 0xffff0000, v20
v_lshlrev_b32_e64 v48, 16, v21
v_and_b32 v49, 0xffff0000, v21
Vs 42,42,34
Vs 43,43,34
Vs 44,44,34
Vs 45,45,34
Vs 46,46,34
Vs 47,47,34
Vs 48,48,34
Vs 49,49,34
Vc 2,42,43
v_lshlrev_b32_e64 v42, 16, v2
v_and_b32 v43, 0xffff0000, v2
Vc 3,44,45
v_lshlrev_b32_e64 v44, 16, v3
v_and_b32 v45, 0xffff0000, v3
Vc 4,46,47
v_lshlrev_b32_e64 v46, 16, v4
v_and_b32 v47, 0xffff0000, v4
Vc 5,48,49
v_lshlrev_b32_e64 v48, 16, v5
v_and_b32 v49, 0xffff0000, v5
Vm 42,42,35
Vm 43,43,35
Vm 44,44,35
Vm 45,45,35
Vm 46,46,35
Vm 47,47,35
Vm 48,48,35
Vm 49,49,35
Vc 2,42,43
v_lshlrev_b32_e64 v42, 16, v2
v_and_b32 v43, 0xffff0000, v2
Vc 3,44,45
v_lshlrev_b32_e64 v44, 16, v3
v_and_b32 v45, 0xffff0000, v3
Vc 4,46,47
v_lshlrev_b32_e64 v46, 16, v4
v_and_b32 v47, 0xffff0000, v4
Vc 5,48,49
v_lshlrev_b32_e64 v48, 16, v5
v_and_b32 v49, 0xffff0000, v5
Va 42,42,96
Va 43,43,97
Va 44,44,98
Va 45,45,99
Va 46,46,100
Va 47,47,101
Va 48,48,102
Va 49,49,103
Vc 2,42,43
v_lshlrev_b32_e64 v42, 16, v2
v_and_b32 v43, 0xffff0000, v2
Vc 3,44,45
v_lshlrev_b32_e64 v44, 16, v3
v_and_b32 v45, 0xffff0000, v3
Vc 4,46,47
v_lshlrev_b32_e64 v46, 16, v4
v_and_b32 v47, 0xffff0000, v4
Vc 5,48,49
v_lshlrev_b32_e64 v48, 16, v5
v_and_b32 v49, 0xffff0000, v5
v_mul_f32 v2, 0xbfb8aa3b, v42
v_mul_f32 v3, 0xbfb8aa3b, v43
v_mul_f32 v4, 0xbfb8aa3b, v44
v_mul_f32 v5, 0xbfb8aa3b, v45
v_mul_f32 v6, 0xbfb8aa3b, v46
v_mul_f32 v7, 0xbfb8aa3b, v47
v_mul_f32 v8, 0xbfb8aa3b, v48
v_mul_f32 v9, 0xbfb8aa3b, v49
Ve 2,2
Ve 3,3
Ve 4,4
Ve 5,5
Ve 6,6
Ve 7,7
Ve 8,8
Ve 9,9
v_add_f32 v2, 1.0, v2
v_add_f32 v3, 1.0, v3
v_add_f32 v4, 1.0, v4
v_add_f32 v5, 1.0, v5
v_add_f32 v6, 1.0, v6
v_add_f32 v7, 1.0, v7
v_add_f32 v8, 1.0, v8
v_add_f32 v9, 1.0, v9
v_rcp_f32 v2, v2
v_rcp_f32 v3, v3
v_rcp_f32 v4, v4
v_rcp_f32 v5, v5
v_rcp_f32 v6, v6
v_rcp_f32 v7, v7
v_rcp_f32 v8, v8
v_rcp_f32 v9, v9
Vm 42,42,2
Vm 43,43,3
Vm 44,44,4
Vm 45,45,5
Vm 46,46,6
Vm 47,47,7
Vm 48,48,8
Vm 49,49,9
Vc 2,42,43
v_lshlrev_b32_e64 v42, 16, v2
v_and_b32 v43, 0xffff0000, v2
Vc 3,44,45
v_lshlrev_b32_e64 v44, 16, v3
v_and_b32 v45, 0xffff0000, v3
Vc 4,46,47
v_lshlrev_b32_e64 v46, 16, v4
v_and_b32 v47, 0xffff0000, v4
Vc 5,48,49
v_lshlrev_b32_e64 v48, 16, v5
v_and_b32 v49, 0xffff0000, v5
L_f_selskip5:
v_add_u32 v124, 32, v120
v_cmp_eq_u32 vcc, s42, v124
v_cmp_eq_u32 s[6:7], s43, v124
s_nop 3
s_or_b64 s[4:5], vcc, s[6:7]
s_cbranch_scc0 L_f_selskip6
v_cndmask_b32 v96, 0, v80, vcc
v_cndmask_b32 v96, v96, v88, s[6:7]
v_cndmask_b32 v97, 0, v81, vcc
v_cndmask_b32 v97, v97, v89, s[6:7]
v_cndmask_b32 v98, 0, v82, vcc
v_cndmask_b32 v98, v98, v90, s[6:7]
v_cndmask_b32 v99, 0, v83, vcc
v_cndmask_b32 v99, v99, v91, s[6:7]
v_cndmask_b32 v100, 0, v84, vcc
v_cndmask_b32 v100, v100, v92, s[6:7]
v_cndmask_b32 v101, 0, v85, vcc
v_cndmask_b32 v101, v101, v93, s[6:7]
v_cndmask_b32 v102, 0, v86, vcc
v_cndmask_b32 v102, v102, v94, s[6:7]
v_cndmask_b32 v103, 0, v87, vcc
v_cndmask_b32 v103, v103, v95, s[6:7]
v_lshlrev_b32 v50, 16, v22
v_and_b32 v51, 0xffff0000, v22
v_lshlrev_b32_e64 v52, 16, v23
v_and_b32 v53, 0xffff0000, v23
v_lshlrev_b32_e64 v54, 16, v24
v_and_b32 v55, 0xffff0000, v24
v_lshlrev_b32_e64 v56, 16, v25
v_and_b32 v57, 0xffff0000, v25
Vs 50,50,36
Vs 51,51,36
Vs 52,52,36
Vs 53,53,36
Vs 54,54,36
Vs 55,55,36
Vs 56,56,36
Vs 57,57,36
Vc 2,50,51
v_lshlrev_b32_e64 v50, 16, v2
v_and_b32 v51, 0xffff0000, v2
Vc 3,52,53
v_lshlrev_b32_e64 v52, 16, v3
v_and_b32 v53, 0xffff0000, v3
Vc 4,54,55
v_lshlrev_b32_e64 v54, 16, v4
v_and_b32 v55, 0xffff0000, v4
Vc 5,56,57
v_lshlrev_b32_e64 v56, 16, v5
v_and_b32 v57, 0xffff0000, v5
Vm 50,50,37
Vm 51,51,37
Vm 52,52,37
Vm 53,53,37
Vm 54,54,37
Vm 55,55,37
Vm 56,56,37
Vm 57,57,37
Vc 2,50,51
v_lshlrev_b32_e64 v50, 16, v2
v_and_b32 v51, 0xffff0000, v2
Vc 3,52,53
v_lshlrev_b32_e64 v52, 16, v3
v_and_b32 v53, 0xffff0000, v3
Vc 4,54,55
v_lshlrev_b32_e64 v54, 16, v4
v_and_b32 v55, 0xffff0000, v4
Vc 5,56,57
v_lshlrev_b32_e64 v56, 16, v5
v_and_b32 v57, 0xffff0000, v5
Va 50,50,96
Va 51,51,97
Va 52,52,98
Va 53,53,99
Va 54,54,100
Va 55,55,101
Va 56,56,102
Va 57,57,103
Vc 2,50,51
v_lshlrev_b32_e64 v50, 16, v2
v_and_b32 v51, 0xffff0000, v2
Vc 3,52,53
v_lshlrev_b32_e64 v52, 16, v3
v_and_b32 v53, 0xffff0000, v3
Vc 4,54,55
v_lshlrev_b32_e64 v54, 16, v4
v_and_b32 v55, 0xffff0000, v4
Vc 5,56,57
v_lshlrev_b32_e64 v56, 16, v5
v_and_b32 v57, 0xffff0000, v5
v_mul_f32 v2, 0xbfb8aa3b, v50
v_mul_f32 v3, 0xbfb8aa3b, v51
v_mul_f32 v4, 0xbfb8aa3b, v52
v_mul_f32 v5, 0xbfb8aa3b, v53
v_mul_f32 v6, 0xbfb8aa3b, v54
v_mul_f32 v7, 0xbfb8aa3b, v55
v_mul_f32 v8, 0xbfb8aa3b, v56
v_mul_f32 v9, 0xbfb8aa3b, v57
Ve 2,2
Ve 3,3
Ve 4,4
Ve 5,5
Ve 6,6
Ve 7,7
Ve 8,8
Ve 9,9
v_add_f32 v2, 1.0, v2
v_add_f32 v3, 1.0, v3
v_add_f32 v4, 1.0, v4
v_add_f32 v5, 1.0, v5
v_add_f32 v6, 1.0, v6
v_add_f32 v7, 1.0, v7
v_add_f32 v8, 1.0, v8
v_add_f32 v9, 1.0, v9
v_rcp_f32 v2, v2
v_rcp_f32 v3, v3
v_rcp_f32 v4, v4
v_rcp_f32 v5, v5
v_rcp_f32 v6, v6
v_rcp_f32 v7, v7
v_rcp_f32 v8, v8
v_rcp_f32 v9, v9
Vm 50,50,2
Vm 51,51,3
Vm 52,52,4
Vm 53,53,5
Vm 54,54,6
Vm 55,55,7
Vm 56,56,8
Vm 57,57,9
Vc 2,50,51
v_lshlrev_b32_e64 v50, 16, v2
v_and_b32 v51, 0xffff0000, v2
Vc 3,52,53
v_lshlrev_b32_e64 v52, 16, v3
v_and_b32 v53, 0xffff0000, v3
Vc 4,54,55
v_lshlrev_b32_e64 v54, 16, v4
v_and_b32 v55, 0xffff0000, v4
Vc 5,56,57
v_lshlrev_b32_e64 v56, 16, v5
v_and_b32 v57, 0xffff0000, v5
L_f_selskip6:
v_add_u32 v124, 64, v120
v_cmp_eq_u32 vcc, s42, v124
v_cmp_eq_u32 s[6:7], s43, v124
s_nop 3
s_or_b64 s[4:5], vcc, s[6:7]
s_cbranch_scc0 L_f_selskip7
v_cndmask_b32 v96, 0, v80, vcc
v_cndmask_b32 v96, v96, v88, s[6:7]
v_cndmask_b32 v97, 0, v81, vcc
v_cndmask_b32 v97, v97, v89, s[6:7]
v_cndmask_b32 v98, 0, v82, vcc
v_cndmask_b32 v98, v98, v90, s[6:7]
v_cndmask_b32 v99, 0, v83, vcc
v_cndmask_b32 v99, v99, v91, s[6:7]
v_cndmask_b32 v100, 0, v84, vcc
v_cndmask_b32 v100, v100, v92, s[6:7]
v_cndmask_b32 v101, 0, v85, vcc
v_cndmask_b32 v101, v101, v93, s[6:7]
v_cndmask_b32 v102, 0, v86, vcc
v_cndmask_b32 v102, v102, v94, s[6:7]
v_cndmask_b32 v103, 0, v87, vcc
v_cndmask_b32 v103, v103, v95, s[6:7]
v_lshlrev_b32 v58, 16, v26
v_and_b32 v59, 0xffff0000, v26
v_lshlrev_b32_e64 v60, 16, v27
v_and_b32 v61, 0xffff0000, v27
v_lshlrev_b32_e64 v62, 16, v28
v_and_b32 v63, 0xffff0000, v28
v_lshlrev_b32_e64 v64, 16, v29
v_and_b32 v65, 0xffff0000, v29
Vs 58,58,38
Vs 59,59,38
Vs 60,60,38
Vs 61,61,38
Vs 62,62,38
Vs 63,63,38
Vs 64,64,38
Vs 65,65,38
Vc 2,58,59
v_lshlrev_b32_e64 v58, 16, v2
v_and_b32 v59, 0xffff0000, v2
Vc 3,60,61
v_lshlrev_b32_e64 v60, 16, v3
v_and_b32 v61, 0xffff0000, v3
Vc 4,62,63
v_lshlrev_b32_e64 v62, 16, v4
v_and_b32 v63, 0xffff0000, v4
Vc 5,64,65
v_lshlrev_b32_e64 v64, 16, v5
v_and_b32 v65, 0xffff0000, v5
Vm 58,58,39
Vm 59,59,39
Vm 60,60,39
Vm 61,61,39
Vm 62,62,39
Vm 63,63,39
Vm 64,64,39
Vm 65,65,39
Vc 2,58,59
v_lshlrev_b32_e64 v58, 16, v2
v_and_b32 v59, 0xffff0000, v2
Vc 3,60,61
v_lshlrev_b32_e64 v60, 16, v3
v_and_b32 v61, 0xffff0000, v3
Vc 4,62,63
v_lshlrev_b32_e64 v62, 16, v4
v_and_b32 v63, 0xffff0000, v4
Vc 5,64,65
v_lshlrev_b32_e64 v64, 16, v5
v_and_b32 v65, 0xffff0000, v5
Va 58,58,96
Va 59,59,97
Va 60,60,98
Va 61,61,99
Va 62,62,100
Va 63,63,101
Va 64,64,102
Va 65,65,103
Vc 2,58,59
v_lshlrev_b32_e64 v58, 16, v2
v_and_b32 v59, 0xffff0000, v2
Vc 3,60,61
v_lshlrev_b32_e64 v60, 16, v3
v_and_b32 v61, 0xffff0000, v3
Vc 4,62,63
v_lshlrev_b32_e64 v62, 16, v4
v_and_b32 v63, 0xffff0000, v4
Vc 5,64,65
v_lshlrev_b32_e64 v64, 16, v5
v_and_b32 v65, 0xffff0000, v5
v_mul_f32 v2, 0xbfb8aa3b, v58
v_mul_f32 v3, 0xbfb8aa3b, v59
v_mul_f32 v4, 0xbfb8aa3b, v60
v_mul_f32 v5, 0xbfb8aa3b, v61
v_mul_f32 v6, 0xbfb8aa3b, v62
v_mul_f32 v7, 0xbfb8aa3b, v63
v_mul_f32 v8, 0xbfb8aa3b, v64
v_mul_f32 v9, 0xbfb8aa3b, v65
Ve 2,2
Ve 3,3
Ve 4,4
Ve 5,5
Ve 6,6
Ve 7,7
Ve 8,8
Ve 9,9
v_add_f32 v2, 1.0, v2
v_add_f32 v3, 1.0, v3
v_add_f32 v4, 1.0, v4
v_add_f32 v5, 1.0, v5
v_add_f32 v6, 1.0, v6
v_add_f32 v7, 1.0, v7
v_add_f32 v8, 1.0, v8
v_add_f32 v9, 1.0, v9
v_rcp_f32 v2, v2
v_rcp_f32 v3, v3
v_rcp_f32 v4, v4
v_rcp_f32 v5, v5
v_rcp_f32 v6, v6
v_rcp_f32 v7, v7
v_rcp_f32 v8, v8
v_rcp_f32 v9, v9
Vm 58,58,2
Vm 59,59,3
Vm 60,60,4
Vm 61,61,5
Vm 62,62,6
Vm 63,63,7
Vm 64,64,8
Vm 65,65,9
Vc 2,58,59
v_lshlrev_b32_e64 v58, 16, v2
v_and_b32 v59, 0xffff0000, v2
Vc 3,60,61
v_lshlrev_b32_e64 v60, 16, v3
v_and_b32 v61, 0xffff0000, v3
Vc 4,62,63
v_lshlrev_b32_e64 v62, 16, v4
v_and_b32 v63, 0xffff0000, v4
Vc 5,64,65
v_lshlrev_b32_e64 v64, 16, v5
v_and_b32 v65, 0xffff0000, v5
L_f_selskip7:
v_add_u32 v124, 96, v120
v_cmp_eq_u32 vcc, s42, v124
v_cmp_eq_u32 s[6:7], s43, v124
s_nop 3
s_or_b64 s[4:5], vcc, s[6:7]
s_cbranch_scc0 L_f_selskip8
v_cndmask_b32 v96, 0, v80, vcc
v_cndmask_b32 v96, v96, v88, s[6:7]
v_cndmask_b32 v97, 0, v81, vcc
v_cndmask_b32 v97, v97, v89, s[6:7]
v_cndmask_b32 v98, 0, v82, vcc
v_cndmask_b32 v98, v98, v90, s[6:7]
v_cndmask_b32 v99, 0, v83, vcc
v_cndmask_b32 v99, v99, v91, s[6:7]
v_cndmask_b32 v100, 0, v84, vcc
v_cndmask_b32 v100, v100, v92, s[6:7]
v_cndmask_b32 v101, 0, v85, vcc
v_cndmask_b32 v101, v101, v93, s[6:7]
v_cndmask_b32 v102, 0, v86, vcc
v_cndmask_b32 v102, v102, v94, s[6:7]
v_cndmask_b32 v103, 0, v87, vcc
v_cndmask_b32 v103, v103, v95, s[6:7]
v_lshlrev_b32_e64 v66, 16, v30
v_and_b32 v67, 0xffff0000, v30
v_lshlrev_b32_e64 v68, 16, v31
v_and_b32 v69, 0xffff0000, v31
v_lshlrev_b32_e64 v70, 16, v32
v_and_b32 v71, 0xffff0000, v32
v_lshlrev_b32_e64 v72, 16, v33
v_and_b32 v73, 0xffff0000, v33
Vs 66,66,40
Vs 67,67,40
Vs 68,68,40
Vs 69,69,40
Vs 70,70,40
Vs 71,71,40
Vs 72,72,40
Vs 73,73,40
Vc 2,66,67
v_lshlrev_b32_e64 v66, 16, v2
v_and_b32 v67, 0xffff0000, v2
Vc 3,68,69
v_lshlrev_b32_e64 v68, 16, v3
v_and_b32 v69, 0xffff0000, v3
Vc 4,70,71
v_lshlrev_b32_e64 v70, 16, v4
v_and_b32 v71, 0xffff0000, v4
Vc 5,72,73
v_lshlrev_b32_e64 v72, 16, v5
v_and_b32 v73, 0xffff0000, v5
Vm 66,66,41
Vm 67,67,41
Vm 68,68,41
Vm 69,69,41
Vm 70,70,41
Vm 71,71,41
Vm 72,72,41
Vm 73,73,41
Vc 2,66,67
v_lshlrev_b32_e64 v66, 16, v2
v_and_b32 v67, 0xffff0000, v2
Vc 3,68,69
v_lshlrev_b32_e64 v68, 16, v3
v_and_b32 v69, 0xffff0000, v3
Vc 4,70,71
v_lshlrev_b32_e64 v70, 16, v4
v_and_b32 v71, 0xffff0000, v4
Vc 5,72,73
v_lshlrev_b32_e64 v72, 16, v5
v_and_b32 v73, 0xffff0000, v5
Va 66,66,96
Va 67,67,97
Va 68,68,98
Va 69,69,99
Va 70,70,100
Va 71,71,101
Va 72,72,102
Va 73,73,103
Vc 2,66,67
v_lshlrev_b32_e64 v66, 16, v2
v_and_b32 v67, 0xffff0000, v2
Vc 3,68,69
v_lshlrev_b32_e64 v68, 16, v3
v_and_b32 v69, 0xffff0000, v3
Vc 4,70,71
v_lshlrev_b32_e64 v70, 16, v4
v_and_b32 v71, 0xffff0000, v4
Vc 5,72,73
v_lshlrev_b32_e64 v72, 16, v5
v_and_b32 v73, 0xffff0000, v5
v_mul_f32 v2, 0xbfb8aa3b, v66
v_mul_f32 v3, 0xbfb8aa3b, v67
v_mul_f32 v4, 0xbfb8aa3b, v68
v_mul_f32 v5, 0xbfb8aa3b, v69
v_mul_f32 v6, 0xbfb8aa3b, v70
v_mul_f32 v7, 0xbfb8aa3b, v71
v_mul_f32 v8, 0xbfb8aa3b, v72
v_mul_f32 v9, 0xbfb8aa3b, v73
Ve 2,2
Ve 3,3
Ve 4,4
Ve 5,5
Ve 6,6
Ve 7,7
Ve 8,8
Ve 9,9
v_add_f32 v2, 1.0, v2
v_add_f32 v3, 1.0, v3
v_add_f32 v4, 1.0, v4
v_add_f32 v5, 1.0, v5
v_add_f32 v6, 1.0, v6
v_add_f32 v7, 1.0, v7
v_add_f32 v8, 1.0, v8
v_add_f32 v9, 1.0, v9
v_rcp_f32 v2, v2
v_rcp_f32 v3, v3
v_rcp_f32 v4, v4
v_rcp_f32 v5, v5
v_rcp_f32 v6, v6
v_rcp_f32 v7, v7
v_rcp_f32 v8, v8
v_rcp_f32 v9, v9
Vm 66,66,2
Vm 67,67,3
Vm 68,68,4
Vm 69,69,5
Vm 70,70,6
Vm 71,71,7
Vm 72,72,8
Vm 73,73,9
Vc 2,66,67
v_lshlrev_b32_e64 v66, 16, v2
v_and_b32 v67, 0xffff0000, v2
Vc 3,68,69
v_lshlrev_b32_e64 v68, 16, v3
v_and_b32 v69, 0xffff0000, v3
Vc 4,70,71
v_lshlrev_b32_e64 v70, 16, v4
v_and_b32 v71, 0xffff0000, v4
Vc 5,72,73
v_lshlrev_b32_e64 v72, 16, v5
v_and_b32 v73, 0xffff0000, v5
L_f_selskip8:
s_branch L_yslr
.section .rodata,"a"
.p2align 6
.amdhsa_kernel recurrent_scan__compressed_kv_cla__moe_arch_mod__prompt_kernel
  .amdhsa_next_free_vgpr 512
  .amdhsa_next_free_sgpr 102
  .amdhsa_accum_offset 256
  .amdhsa_group_segment_fixed_size 0
  .amdhsa_kernarg_size 112
  .amdhsa_user_sgpr_count 2
  .amdhsa_user_sgpr_kernarg_segment_ptr 1
  .amdhsa_system_sgpr_workgroup_id_x 1
.end_amdhsa_kernel
```

```asm
; @launch grid=(256,1,1) block=(256,1,1) lds=163840
.amdgcn_target "amdgcn-amd-amdhsa--gfx950"
.macro Va d,x,y
v_add_f32 v\d, v\x, v\y
.endm
.macro Vc d,x,y
v_cvt_pk_bf16_f32 v\d, v\x, v\y
.endm
.macro Ta d,x,o
ds_read_b64_tr_b16 a[\d:\d+1], v\x offset:\o
.endm
.macro Ra d,x,o
ds_read_b128 a[\d:\d+3], v\x offset:\o
.endm
.macro Zvaa d,x,y
v_mfma_f32_16x16x32_bf16 v[\d:\d+3], a[\x:\x+3], a[\y:\y+3], 0
.endm
.macro Rv d,x,o
ds_read_b128 v[\d:\d+3], v\x offset:\o
.endm
.macro Zaaa d,x,y
v_mfma_f32_16x16x32_bf16 a[\d:\d+3], a[\x:\x+3], a[\y:\y+3], 0
.endm
.macro Mvaa d,x,y
v_mfma_f32_16x16x32_bf16 v[\d:\d+3], a[\x:\x+3], a[\y:\y+3], v[\d:\d+3]
.endm
.macro Maaa d,x,y
v_mfma_f32_16x16x32_bf16 a[\d:\d+3], a[\x:\x+3], a[\y:\y+3], a[\d:\d+3]
.endm
.macro Ar d,x
v_accvgpr_read_b32 v\d, a\x
.endm
.macro VE d,x
v_exp_f32_e64 v\d, v\x
.endm
.macro Aw d,x
v_accvgpr_write_b32 a\d, v\x
.endm
.macro Vs d,x,y
v_sub_f32 v\d, v\x, v\y
.endm
.macro Ve d,x
v_exp_f32 v\d, v\x
.endm
.macro Cvaa d,x,y,c
v_mfma_f32_16x16x32_bf16 v[\d:\d+3], a[\x:\x+3], a[\y:\y+3], v[\c:\c+3]
.endm
.macro Maav d,x,y
v_mfma_f32_16x16x32_bf16 a[\d:\d+3], a[\x:\x+3], v[\y:\y+3], a[\d:\d+3]
.endm
.macro Mvvv d,x,y
v_mfma_f32_16x16x32_bf16 v[\d:\d+3], v[\x:\x+3], v[\y:\y+3], v[\d:\d+3]
.endm
.macro Zvva d,x,y
v_mfma_f32_16x16x32_bf16 v[\d:\d+3], v[\x:\x+3], a[\y:\y+3], 0
.endm
.macro Mvva d,x,y
v_mfma_f32_16x16x32_bf16 v[\d:\d+3], v[\x:\x+3], a[\y:\y+3], v[\d:\d+3]
.endm
.macro Vm d,x,y
v_mul_f32 v\d, v\x, v\y
.endm
.macro Zvvv d,x,y
v_mfma_f32_16x16x32_bf16 v[\d:\d+3], v[\x:\x+3], v[\y:\y+3], 0
.endm
.text
.globl recurrent_scan__compressed_kv_cla__moe_arch_mod__prompt_kernel
.p2align 8
.type recurrent_scan__compressed_kv_cla__moe_arch_mod__prompt_kernel,@function
recurrent_scan__compressed_kv_cla__moe_arch_mod__prompt_kernel:
s_cmp_ge_u32 s2, 256
s_cbranch_scc1 L_k2_end
s_load_dwordx4 s[4:7], s[0:1], 0
s_load_dwordx2 s[44:45], s[0:1], 56
s_load_dwordx4 s[40:43], s[0:1], 24
s_load_dwordx4 s[64:67], s[0:1], 96
v_lshrrev_b32 v1, 6, v0
v_and_b32 v0, 63, v0
v_readfirstlane_b32 s32, v1
s_getpc_b64 s[68:69]
L_cpf1:
s_add_u32 s68, s68, (recurrent_scan__compressed_kv_cla__moe_arch_mod__prompt_kernel-L_cpf1)&0xffffffff
s_addc_u32 s69, s69, ((recurrent_scan__compressed_kv_cla__moe_arch_mod__prompt_kernel-L_cpf1)>>32)&0xffffffff
s_lshr_b32 s70, s2, 3
s_lshl_b32 s70, s70, 2
s_add_u32 s70, s70, s32
s_lshl_b32 s70, s70, 10
v_and_b32 v122, 7, v0
v_lshlrev_b32 v122, 7, v122
v_add_u32 v122, s70, v122
v_min_u32 v122, L_k2_fin-recurrent_scan__compressed_kv_cla__moe_arch_mod__prompt_kernel-4, v122
v_mov_b32 v121, s69
v_add_co_u32 v120, vcc, s68, v122
s_nop 1
v_addc_co_u32 v121, vcc, 0, v121, vcc
global_load_dword v124, v[120:121], off
v_lshrrev_b32 v33, 5, v0
v_and_b32 v31, 31, v0
v_lshlrev_b32_e64 v36, 4, v31
v_lshl_add_u32 v35, v33, 11, v36
s_lshl_b32 s36, s2, 14
s_lshl_b32 s37, s32, 12
s_add_u32 s36, s36, s37
s_mov_b32 s18, 4194304
s_mov_b32 s19, 0x20000
s_bfe_u32 s33, s2, 0x30003
s_lshr_b32 s35, s2, 7
s_bfe_u32 s3, s2, 0x10006
s_and_b32 s34, s2, 7
s_lshl_b32 s34, s34, 1
s_add_u32 s34, s34, s3
s_waitcnt lgkmcnt(0)
s_mov_b32 s16, s4
s_and_b32 s17, s5, 0xffff
buffer_load_dwordx4 v[48:51], v35, s[16:19], s36 offen offset:0 nt
buffer_load_dwordx4 v[52:55], v35, s[16:19], s36 offen offset:512 nt
buffer_load_dwordx4 v[56:59], v35, s[16:19], s36 offen offset:1024 nt
buffer_load_dwordx4 v[60:63], v35, s[16:19], s36 offen offset:1536 nt
s_cmp_eq_u32 s35, 0
s_cselect_b32 s40, s40, s42
s_cselect_b32 s41, s41, s43
s_lshl_b32 s3, s34, 9
s_add_u32 s12, s40, s3
s_addc_u32 s13, s41, 0
s_and_b32 s13, s13, 0xffff
s_mov_b32 s14, 0
s_mov_b32 s15, 0x20000
s_sub_u32 s14, 4194304, s3
s_lshl_b32 s3, s33, 18
s_add_u32 s8, s6, s3
s_addc_u32 s9, s7, 0
s_and_b32 s9, s9, 0xffff
s_mov_b32 s10, 262144
s_mov_b32 s11, 0x20000
s_and_b32 s58, s2, 7
s_mov_b32 s52, 0
s_mov_b32 s53, 15360
s_mov_b32 s54, 30720
s_mov_b32 s55, 46080
s_lshl_b32 s56, s32, 13
s_add_u32 s57, s56, 32768
s_lshl_b32 s3, s58, 2
s_add_u32 s3, s3, s32
s_lshl_b32 s3, s3, 4
v_add_u32 v30, s3, v33
v_lshlrev_b32 v30, 13, v30
v_lshlrev_b32 v34, 5, v33
v_xor_b32 v34, v34, v36
v_add_u32 v6, v34, v30
v_xor_b32_e64 v7, 64, v6
v_xor_b32 v8, 65664, v6
v_xor_b32 v9, 65728, v6
s_add_u32 m0, s57, 0
s_nop 0
buffer_load_dwordx4 v6, s[12:15], s52 offen offset:0 nt lds
buffer_load_dwordx4 v7, s[12:15], s53 offen offset:1024 nt lds
buffer_load_dwordx4 v6, s[12:15], s54 offen offset:2048 nt lds
buffer_load_dwordx4 v7, s[12:15], s55 offen offset:3072 nt lds
s_add_u32 m0, s57, 4096
s_nop 0
s_nop 0
buffer_load_dwordx4 v8, s[12:15], s52 offen offset:0 nt lds
buffer_load_dwordx4 v9, s[12:15], s53 offen offset:1024 nt lds
buffer_load_dwordx4 v8, s[12:15], s54 offen offset:2048 nt lds
buffer_load_dwordx4 v9, s[12:15], s55 offen offset:3072 nt lds
v_xor_b32 v6, 524288, v6
v_xor_b32 v7, 524288, v7
v_xor_b32 v8, 524288, v8
v_xor_b32 v9, 524288, v9
s_mov_b32 s48, 0
s_mov_b32 s49, 7168
s_mov_b32 s50, 14336
s_mov_b32 s51, 21504
v_lshrrev_b32 v30, 3, v0
v_lshlrev_b32 v30, 10, v30
s_lshl_b32 s3, s32, 16
s_lshl_b32 s39, s58, 7
s_add_u32 s3, s3, s39
v_and_b32 v31, 7, v0
v_lshrrev_b32 v32, 4, v0
v_xor_b32_e64 v31, v31, v32
v_lshl_add_u32 v30, v31, 4, v30
v_add_u32 v2, s3, v30
v_xor_b32 v3, 64, v2
v_xor_b32 v4, 32768, v2
v_xor_b32 v5, 32832, v2
s_cmp_lt_u32 s32, 2
s_cselect_b32 s60, s8, s12
s_cselect_b32 s61, s9, s13
s_cselect_b32 s62, s10, s14
s_mov_b32 s63, 0x20000
s_mov_b32 s59, 524288
s_cselect_b32 s59, 128, s59
s_cselect_b64 vcc, -1, 0
s_cselect_b32 s38, 32, 16
s_lshr_b32 s3, s2, 6
s_cmp_lt_u32 s32, 2
s_cselect_b32 s3, s3, s33
s_lshl_b32 s3, s3, 1
s_and_b32 s39, s32, 1
s_add_u32 s3, s3, s39
s_lshl_b32 s3, s3, 15
s_xor_b32 s39, s58, 1
s_mul_i32 s39, s39, s59
s_add_u32 s3, s3, s39
v_lshlrev_b32 v37, 10, v0
v_lshrrev_b32 v38, 2, v0
v_lshlrev_b32 v38, 13, v38
v_and_b32 v39, 3, v0
v_lshl_add_u32 v38, v39, 7, v38
v_cndmask_b32 v47, v38, v37, vcc
v_add_u32 v47, s3, v47
v_cmp_gt_u32 vcc, s38, v0
v_mov_b32 v37, 2146435072
s_nop 0
v_cndmask_b32 v47, v37, v47, vcc
s_mov_b32 s20, s66
s_and_b32 s21, s67, 0xffff
s_mov_b32 s22, 8388608
s_mov_b32 s23, 0x20000
s_add_u32 s24, s66, 8388608
s_addc_u32 s25, s67, 0
s_and_b32 s25, s25, 0xffff
s_mov_b32 s26, 35717120
s_mov_b32 s27, 0x20000
v_lshrrev_b32 v32, 4, v0
v_and_b32 v30, 15, v0
s_lshr_b32 s3, s32, 1
s_lshl_b32 s3, s3, 14
v_lshlrev_b32 v31, 7, v30
v_add_u32 v31, s3, v31
v_lshrrev_b32 v34, 1, v30
v_xor_b32_e64 v34, v34, v32
v_lshl_add_u32 v10, v34, 4, v31
v_xor_b32 v11, 64, v10
v_lshrrev_b32 v30, 2, v30
v_lshl_add_u32 v31, v32, 3, v30
v_lshlrev_b32 v31, 9, v31
v_and_b32 v34, 3, v0
v_lshl_add_u32 v31, v34, 3, v31
s_and_b32 s3, s32, 1
s_lshl_b32 s3, s3, 8
s_add_u32 s3, s3, 32768
v_add_u32 v31, s3, v31
v_and_b32 v34, 1, v32
v_lshl_add_u32 v30, v34, 2, v30
v_lshl_add_u32 v12, v30, 5, v31
v_xor_b32 v13, 32, v12
v_xor_b32 v14, 64, v12
v_xor_b32 v15, 96, v12
v_xor_b32 v16, 128, v12
v_xor_b32 v17, 160, v12
v_xor_b32 v18, 192, v12
v_xor_b32 v19, 224, v12
v_add_u32 v20, 65536, v10
v_add_u32 v21, 65536, v11
v_add_u32 v22, 65536, v12
v_add_u32 v23, 65536, v13
v_add_u32 v24, 65536, v14
v_add_u32 v25, 65536, v15
v_add_u32 v26, 65536, v16
v_add_u32 v27, 65536, v17
v_add_u32 v28, 65536, v18
v_add_u32 v29, 65536, v19
s_mov_b32 s28, s44
s_nop 0
s_and_b32 s29, s45, 0xffff
s_mov_b32 s30, 2048
s_mov_b32 s31, 0x20000
buffer_load_dwordx4 v[64:67], v36, s[28:31], 0 offen offset:0
buffer_load_dwordx4 v[68:71], v36, s[28:31], 0 offen offset:512
buffer_load_dwordx4 v[72:75], v36, s[28:31], 0 offen offset:1024
buffer_load_dwordx4 v[76:79], v36, s[28:31], 0 offen offset:1536
s_waitcnt vmcnt(12)
v_lshlrev_b32 v80, 16, v48
v_and_b32 v81, 0xffff0000, v48
v_lshlrev_b32_e64 v82, 16, v49
v_and_b32 v83, 0xffff0000, v49
v_lshlrev_b32_e64 v84, 16, v50
v_and_b32 v85, 0xffff0000, v50
v_lshlrev_b32_e64 v86, 16, v51
v_and_b32 v87, 0xffff0000, v51
v_lshlrev_b32_e64 v88, 16, v52
v_and_b32 v89, 0xffff0000, v52
v_lshlrev_b32_e64 v90, 16, v53
v_and_b32 v91, 0xffff0000, v53
v_lshlrev_b32_e64 v92, 16, v54
v_and_b32 v93, 0xffff0000, v54
v_lshlrev_b32_e64 v94, 16, v55
v_and_b32 v95, 0xffff0000, v55
v_lshlrev_b32_e64 v96, 16, v56
v_and_b32 v97, 0xffff0000, v56
v_lshlrev_b32_e64 v98, 16, v57
v_and_b32 v99, 0xffff0000, v57
v_lshlrev_b32_e64 v100, 16, v58
v_and_b32 v101, 0xffff0000, v58
v_lshlrev_b32_e64 v102, 16, v59
v_and_b32 v103, 0xffff0000, v59
v_lshlrev_b32_e64 v104, 16, v60
v_and_b32 v105, 0xffff0000, v60
v_lshlrev_b32_e64 v106, 16, v61
v_and_b32 v107, 0xffff0000, v61
v_lshlrev_b32_e64 v108, 16, v62
v_and_b32 v109, 0xffff0000, v62
v_lshlrev_b32_e64 v110, 16, v63
v_and_b32 v111, 0xffff0000, v63
v_pk_add_f32 v[40:41], v[80:81], v[82:83]
v_pk_add_f32 v[42:43], v[84:85], v[86:87]
v_pk_add_f32 v[40:41], v[40:41], v[88:89]
v_pk_add_f32 v[42:43], v[42:43], v[90:91]
v_pk_add_f32 v[40:41], v[40:41], v[92:93]
v_pk_add_f32 v[42:43], v[42:43], v[94:95]
v_pk_add_f32 v[40:41], v[40:41], v[96:97]
v_pk_add_f32 v[42:43], v[42:43], v[98:99]
v_pk_add_f32 v[40:41], v[40:41], v[100:101]
v_pk_add_f32 v[42:43], v[42:43], v[102:103]
v_pk_add_f32 v[40:41], v[40:41], v[104:105]
v_pk_add_f32 v[42:43], v[42:43], v[106:107]
v_pk_add_f32 v[40:41], v[40:41], v[108:109]
v_pk_add_f32 v[42:43], v[42:43], v[110:111]
v_pk_add_f32 v[40:41], v[40:41], v[42:43]
Va 38,40,41
s_nop 1
v_add_f32_dpp v38, v38, v38 quad_perm:[1,0,3,2] row_mask:0xf bank_mask:0xf
s_nop 1
v_add_f32_dpp v38, v38, v38 quad_perm:[2,3,0,1] row_mask:0xf bank_mask:0xf
s_nop 1
v_add_f32_dpp v38, v38, v38 row_half_mirror row_mask:0xf bank_mask:0xf
s_nop 1
v_add_f32_dpp v38, v38, v38 row_mirror row_mask:0xf bank_mask:0xf
v_mov_b32 v37, v38
s_nop 1
v_permlane16_swap_b32 v37, v38
Va 38,38,37
s_add_u32 m0, s56, 0
s_nop 0
buffer_load_dwordx4 v2, s[8:11], s48 offen offset:0 lds
buffer_load_dwordx4 v3, s[8:11], s49 offen offset:1024 lds
buffer_load_dwordx4 v2, s[8:11], s50 offen offset:2048 lds
buffer_load_dwordx4 v3, s[8:11], s51 offen offset:3072 lds
s_add_u32 m0, s56, 4096
s_nop 0
buffer_load_dwordx4 v4, s[8:11], s48 offen offset:0 lds
buffer_load_dwordx4 v5, s[8:11], s49 offen offset:1024 lds
buffer_load_dwordx4 v4, s[8:11], s50 offen offset:2048 lds
buffer_load_dwordx4 v5, s[8:11], s51 offen offset:3072 lds
v_xor_b32 v2, 128, v2
v_xor_b32 v3, 128, v3
v_xor_b32 v4, 128, v4
v_xor_b32 v5, 128, v5
buffer_load_dword v1, v47, s[60:63], 0 offen
s_mul_i32 vcc_lo, s59, 3
v_xor_b32 v47, vcc_lo, v47
v_mul_f32 v38, 0xba800000, v38
v_mov_b32_e64 v39, v38
v_pk_add_f32 v[112:113], v[80:81], v[38:39]
v_pk_mul_f32 v[40:41], v[112:113], v[112:113]
v_pk_add_f32 v[114:115], v[82:83], v[38:39]
v_pk_mul_f32 v[42:43], v[114:115], v[114:115]
v_pk_add_f32 v[116:117], v[84:85], v[38:39]
v_pk_fma_f32 v[40:41], v[116:117], v[116:117], v[40:41]
v_pk_add_f32 v[118:119], v[86:87], v[38:39]
v_pk_fma_f32 v[42:43], v[118:119], v[118:119], v[42:43]
v_pk_add_f32 v[112:113], v[88:89], v[38:39]
v_pk_fma_f32 v[40:41], v[112:113], v[112:113], v[40:41]
v_pk_add_f32 v[114:115], v[90:91], v[38:39]
v_pk_fma_f32 v[42:43], v[114:115], v[114:115], v[42:43]
v_pk_add_f32 v[116:117], v[92:93], v[38:39]
v_pk_fma_f32 v[40:41], v[116:117], v[116:117], v[40:41]
v_pk_add_f32 v[118:119], v[94:95], v[38:39]
v_pk_fma_f32 v[42:43], v[118:119], v[118:119], v[42:43]
v_pk_add_f32 v[112:113], v[96:97], v[38:39]
v_pk_fma_f32 v[40:41], v[112:113], v[112:113], v[40:41]
v_pk_add_f32 v[114:115], v[98:99], v[38:39]
v_pk_fma_f32 v[42:43], v[114:115], v[114:115], v[42:43]
v_pk_add_f32 v[116:117], v[100:101], v[38:39]
v_pk_fma_f32 v[40:41], v[116:117], v[116:117], v[40:41]
v_pk_add_f32 v[118:119], v[102:103], v[38:39]
v_pk_fma_f32 v[42:43], v[118:119], v[118:119], v[42:43]
v_pk_add_f32 v[112:113], v[104:105], v[38:39]
v_pk_fma_f32 v[40:41], v[112:113], v[112:113], v[40:41]
v_pk_add_f32 v[114:115], v[106:107], v[38:39]
v_pk_fma_f32 v[42:43], v[114:115], v[114:115], v[42:43]
v_pk_add_f32 v[116:117], v[108:109], v[38:39]
v_pk_fma_f32 v[40:41], v[116:117], v[116:117], v[40:41]
v_pk_add_f32 v[118:119], v[110:111], v[38:39]
v_pk_fma_f32 v[42:43], v[118:119], v[118:119], v[42:43]
v_pk_add_f32 v[40:41], v[40:41], v[42:43]
Va 40,40,41
s_nop 1
v_add_f32_dpp v40, v40, v40 quad_perm:[1,0,3,2] row_mask:0xf bank_mask:0xf
s_nop 1
v_add_f32_dpp v40, v40, v40 quad_perm:[2,3,0,1] row_mask:0xf bank_mask:0xf
s_nop 1
v_add_f32_dpp v40, v40, v40 row_half_mirror row_mask:0xf bank_mask:0xf
s_nop 1
v_add_f32_dpp v40, v40, v40 row_mirror row_mask:0xf bank_mask:0xf
v_mov_b32 v37, v40
s_nop 1
v_permlane16_swap_b32 v37, v40
v_add_f32_e64 v40, v40, v37
buffer_load_dword v1, v47, s[60:63], 0 offen
s_mul_i32 vcc_lo, s59, 1
v_xor_b32 v47, vcc_lo, v47
v_mul_f32 v40, 0x3a800000, v40
Vc 44,38,40
v_lshlrev_b32_e64 v38, 16, v44
v_and_b32 v40, 0xffff0000, v44
v_add_f32 v40, 0x3727c5ac, v40
Vc 44,40,40
v_lshlrev_b32 v40, 16, v44
v_sqrt_f32 v40, v40
v_mov_b32_e64 v39, v38
Vc 44,40,40
v_lshlrev_b32 v44, 16, v44
v_rcp_f32 v40, v44
v_pk_add_f32 v[80:81], v[80:81], v[38:39]
v_pk_add_f32 v[82:83], v[82:83], v[38:39]
v_pk_add_f32 v[84:85], v[84:85], v[38:39]
v_pk_add_f32 v[86:87], v[86:87], v[38:39]
v_pk_add_f32 v[88:89], v[88:89], v[38:39]
v_pk_add_f32 v[90:91], v[90:91], v[38:39]
v_pk_add_f32 v[92:93], v[92:93], v[38:39]
v_pk_add_f32 v[94:95], v[94:95], v[38:39]
v_pk_add_f32 v[96:97], v[96:97], v[38:39]
v_pk_add_f32 v[98:99], v[98:99], v[38:39]
v_pk_add_f32 v[100:101], v[100:101], v[38:39]
v_pk_add_f32 v[102:103], v[102:103], v[38:39]
v_pk_add_f32 v[104:105], v[104:105], v[38:39]
v_pk_add_f32 v[106:107], v[106:107], v[38:39]
v_pk_add_f32 v[108:109], v[108:109], v[38:39]
v_pk_add_f32 v[110:111], v[110:111], v[38:39]
v_fma_f32 v45, -v44, v40, 1.0
v_fma_f32 v40, v45, v40, v40
v_mov_b32_e64 v41, v40
Vc 48,80,81
Vc 49,82,83
Vc 50,84,85
Vc 51,86,87
Vc 52,88,89
Vc 53,90,91
Vc 54,92,93
Vc 55,94,95
Vc 56,96,97
Vc 57,98,99
Vc 58,100,101
Vc 59,102,103
Vc 60,104,105
Vc 61,106,107
Vc 62,108,109
Vc 63,110,111
v_lshlrev_b32_e64 v80, 16, v48
v_and_b32 v81, 0xffff0000, v48
v_lshlrev_b32_e64 v82, 16, v49
v_and_b32 v83, 0xffff0000, v49
v_lshlrev_b32_e64 v84, 16, v50
v_and_b32 v85, 0xffff0000, v50
v_lshlrev_b32_e64 v86, 16, v51
v_and_b32 v87, 0xffff0000, v51
v_lshlrev_b32_e64 v88, 16, v52
v_and_b32 v89, 0xffff0000, v52
v_lshlrev_b32_e64 v90, 16, v53
v_and_b32 v91, 0xffff0000, v53
v_lshlrev_b32_e64 v92, 16, v54
v_and_b32 v93, 0xffff0000, v54
v_lshlrev_b32_e64 v94, 16, v55
v_and_b32 v95, 0xffff0000, v55
v_lshlrev_b32_e64 v96, 16, v56
v_and_b32 v97, 0xffff0000, v56
v_lshlrev_b32_e64 v98, 16, v57
v_and_b32 v99, 0xffff0000, v57
v_lshlrev_b32_e64 v100, 16, v58
v_and_b32 v101, 0xffff0000, v58
v_lshlrev_b32_e64 v102, 16, v59
v_and_b32 v103, 0xffff0000, v59
v_lshlrev_b32_e64 v104, 16, v60
v_and_b32 v105, 0xffff0000, v60
v_lshlrev_b32_e64 v106, 16, v61
v_and_b32 v107, 0xffff0000, v61
v_lshlrev_b32_e64 v108, 16, v62
v_and_b32 v109, 0xffff0000, v62
v_lshlrev_b32_e64 v110, 16, v63
v_and_b32 v111, 0xffff0000, v63
v_pk_mul_f32 v[80:81], v[80:81], v[40:41]
v_pk_mul_f32 v[82:83], v[82:83], v[40:41]
v_pk_mul_f32 v[84:85], v[84:85], v[40:41]
v_pk_mul_f32 v[86:87], v[86:87], v[40:41]
v_pk_mul_f32 v[88:89], v[88:89], v[40:41]
v_pk_mul_f32 v[90:91], v[90:91], v[40:41]
v_pk_mul_f32 v[92:93], v[92:93], v[40:41]
v_pk_mul_f32 v[94:95], v[94:95], v[40:41]
v_pk_mul_f32 v[96:97], v[96:97], v[40:41]
v_pk_mul_f32 v[98:99], v[98:99], v[40:41]
v_pk_mul_f32 v[100:101], v[100:101], v[40:41]
v_pk_mul_f32 v[102:103], v[102:103], v[40:41]
v_pk_mul_f32 v[104:105], v[104:105], v[40:41]
v_pk_mul_f32 v[106:107], v[106:107], v[40:41]
v_pk_mul_f32 v[108:109], v[108:109], v[40:41]
v_pk_mul_f32 v[110:111], v[110:111], v[40:41]
Vc 48,80,81
Vc 49,82,83
Vc 50,84,85
Vc 51,86,87
Vc 52,88,89
Vc 53,90,91
Vc 54,92,93
Vc 55,94,95
Vc 56,96,97
Vc 57,98,99
Vc 58,100,101
Vc 59,102,103
Vc 60,104,105
Vc 61,106,107
Vc 62,108,109
Vc 63,110,111
s_mul_i32 s3, s32, 4128
s_add_u32 s3, s3, 131072
v_mul_u32_u24 v42, 2064, v33
v_add3_u32 v42, v42, v36, s3
ds_write_b128 v42, v[48:51] offset:0
ds_write_b128 v42, v[52:55] offset:512
ds_write_b128 v42, v[56:59] offset:1024
ds_write_b128 v42, v[60:63] offset:1536
s_waitcnt vmcnt(10)
v_lshlrev_b32 v80, 16, v48
v_and_b32 v81, 0xffff0000, v48
v_lshlrev_b32_e64 v112, 16, v64
v_and_b32 v113, 0xffff0000, v64
v_pk_mul_f32 v[42:43], v[80:81], v[112:113]
v_lshlrev_b32_e64 v82, 16, v49
v_and_b32 v83, 0xffff0000, v49
v_lshlrev_b32_e64 v114, 16, v65
v_and_b32 v115, 0xffff0000, v65
v_pk_mul_f32 v[44:45], v[82:83], v[114:115]
v_lshlrev_b32_e64 v84, 16, v50
v_and_b32 v85, 0xffff0000, v50
v_lshlrev_b32_e64 v116, 16, v66
v_and_b32 v117, 0xffff0000, v66
v_pk_fma_f32 v[42:43], v[84:85], v[116:117], v[42:43]
v_lshlrev_b32_e64 v86, 16, v51
v_and_b32 v87, 0xffff0000, v51
v_lshlrev_b32_e64 v118, 16, v67
v_and_b32 v119, 0xffff0000, v67
v_pk_fma_f32 v[44:45], v[86:87], v[118:119], v[44:45]
v_lshlrev_b32_e64 v88, 16, v52
v_and_b32 v89, 0xffff0000, v52
v_lshlrev_b32_e64 v112, 16, v68
v_and_b32 v113, 0xffff0000, v68
v_pk_fma_f32 v[42:43], v[88:89], v[112:113], v[42:43]
v_lshlrev_b32_e64 v90, 16, v53
v_and_b32 v91, 0xffff0000, v53
v_lshlrev_b32_e64 v114, 16, v69
v_and_b32 v115, 0xffff0000, v69
v_pk_fma_f32 v[44:45], v[90:91], v[114:115], v[44:45]
v_lshlrev_b32_e64 v92, 16, v54
v_and_b32 v93, 0xffff0000, v54
v_lshlrev_b32_e64 v116, 16, v70
v_and_b32 v117, 0xffff0000, v70
v_pk_fma_f32 v[42:43], v[92:93], v[116:117], v[42:43]
v_lshlrev_b32_e64 v94, 16, v55
v_and_b32 v95, 0xffff0000, v55
v_lshlrev_b32_e64 v118, 16, v71
v_and_b32 v119, 0xffff0000, v71
v_pk_fma_f32 v[44:45], v[94:95], v[118:119], v[44:45]
v_lshlrev_b32_e64 v96, 16, v56
v_and_b32 v97, 0xffff0000, v56
v_lshlrev_b32_e64 v112, 16, v72
v_and_b32 v113, 0xffff0000, v72
v_pk_fma_f32 v[42:43], v[96:97], v[112:113], v[42:43]
v_lshlrev_b32_e64 v98, 16, v57
v_and_b32 v99, 0xffff0000, v57
v_lshlrev_b32_e64 v114, 16, v73
v_and_b32 v115, 0xffff0000, v73
v_pk_fma_f32 v[44:45], v[98:99], v[114:115], v[44:45]
v_lshlrev_b32_e64 v100, 16, v58
v_and_b32 v101, 0xffff0000, v58
v_lshlrev_b32_e64 v116, 16, v74
v_and_b32 v117, 0xffff0000, v74
v_pk_fma_f32 v[42:43], v[100:101], v[116:117], v[42:43]
v_lshlrev_b32_e64 v102, 16, v59
v_and_b32 v103, 0xffff0000, v59
v_lshlrev_b32_e64 v118, 16, v75
v_and_b32 v119, 0xffff0000, v75
v_pk_fma_f32 v[44:45], v[102:103], v[118:119], v[44:45]
v_lshlrev_b32_e64 v104, 16, v60
v_and_b32 v105, 0xffff0000, v60
v_lshlrev_b32_e64 v112, 16, v76
v_and_b32 v113, 0xffff0000, v76
v_pk_fma_f32 v[42:43], v[104:105], v[112:113], v[42:43]
v_lshlrev_b32_e64 v106, 16, v61
v_and_b32 v107, 0xffff0000, v61
v_lshlrev_b32_e64 v114, 16, v77
v_and_b32 v115, 0xffff0000, v77
v_pk_fma_f32 v[44:45], v[106:107], v[114:115], v[44:45]
v_lshlrev_b32_e64 v108, 16, v62
v_and_b32 v109, 0xffff0000, v62
v_lshlrev_b32_e64 v116, 16, v78
v_and_b32 v117, 0xffff0000, v78
v_pk_fma_f32 v[42:43], v[108:109], v[116:117], v[42:43]
v_lshlrev_b32_e64 v110, 16, v63
v_and_b32 v111, 0xffff0000, v63
v_lshlrev_b32_e64 v118, 16, v79
v_and_b32 v119, 0xffff0000, v79
v_pk_fma_f32 v[44:45], v[110:111], v[118:119], v[44:45]
v_pk_add_f32 v[42:43], v[42:43], v[44:45]
Va 45,42,43
s_nop 1
v_add_f32_dpp v45, v45, v45 quad_perm:[1,0,3,2] row_mask:0xf bank_mask:0xf
s_nop 1
v_add_f32_dpp v45, v45, v45 quad_perm:[2,3,0,1] row_mask:0xf bank_mask:0xf
s_nop 1
v_add_f32_dpp v45, v45, v45 row_half_mirror row_mask:0xf bank_mask:0xf
s_nop 1
v_add_f32_dpp v45, v45, v45 row_mirror row_mask:0xf bank_mask:0xf
v_mov_b32 v37, v45
s_nop 1
v_permlane16_swap_b32 v37, v45
v_add_f32_e64 v45, v45, v37
Vc 45,45,45
v_ashrrev_i32_e64 v46, 31, v45
v_or_b32 v46, 0x80000000, v46
v_xor_b32_e64 v45, v45, v46
v_and_b32 v45, 0xffff0000, v45
s_lshr_b32 s3, s36, 11
v_add_u32 v46, s3, v33
v_sub_u32 v44, 0xffff, v46
v_or_b32 v45, v45, v44
v_lshlrev_b32 v44, 2, v46
v_lshlrev_b32_e64 v46, 3, v46
v_xor_b32 v38, 0x80000000, v38
v_mov_b32_e64 v39, v40
s_mov_b32 s3, 5242880
s_mov_b32 s39, 5259264
s_mov_b32 exec_lo, 1
s_mov_b32 exec_hi, 1
buffer_store_dword v45, v44, s[20:23], s3 offen sc1
buffer_store_dwordx2 v[38:39], v46, s[20:23], s39 offen sc1
s_mov_b64 exec, -1
s_load_dwordx2 s[4:5], s[0:1], 16
s_load_dwordx4 s[40:43], s[0:1], 64
s_load_dwordx2 s[92:93], s[0:1], 40
s_load_dwordx2 s[94:95], s[0:1], 80
s_load_dwordx2 s[100:101], s[0:1], 0
s_mov_b32 s28, s64
s_and_b32 s29, s65, 0xffff
s_mov_b32 s30, 256
s_mov_b32 s31, 0x20000
s_waitcnt vmcnt(4)
s_waitcnt lgkmcnt(0)
s_barrier
s_nop 0
Ta 32,12,0
Ta 34,12,2048
Ra 0,10,0
Ta 36,13,0
Ta 38,13,2048
Ra 4,10,2048
Ta 40,14,0
Ta 42,14,2048
Ra 8,10,4096
Ta 44,15,0
Ta 46,15,2048
Ra 12,10,6144
s_waitcnt lgkmcnt(2)
s_nop 0
Ta 48,16,0
Ta 50,16,2048
Ra 16,10,8192
Ta 52,17,0
Ta 54,17,2048
Ra 20,10,10240
Ta 56,18,0
Ta 58,18,2048
Ra 24,10,12288
Ta 60,19,0
Ta 62,19,2048
Ra 28,10,14336
s_cmp_lg_u32 s35, 0
s_cbranch_scc1 L_k1_vpath
s_waitcnt lgkmcnt(0)
s_add_u32 m0, s57, 65536
Zvaa 48,32,0
buffer_load_dwordx4 v6, s[12:15], s52 offen offset:0 nt lds
Zvaa 52,36,0
Ta 96,12,16384
Ta 98,12,18432
Zvaa 56,40,0
buffer_load_dwordx4 v7, s[12:15], s53 offen offset:1024 nt lds
Zvaa 60,44,0
Ra 64,11,0
Zvaa 64,48,0
buffer_load_dwordx4 v6, s[12:15], s54 offen offset:2048 nt lds
Zvaa 68,52,0
Ta 100,13,16384
Ta 102,13,18432
Zvaa 72,56,0
buffer_load_dwordx4 v7, s[12:15], s55 offen offset:3072 nt lds
Zvaa 76,60,0
s_add_u32 m0, s57, 69632
s_waitcnt lgkmcnt(6)
Ra 68,11,2048
Zvaa 80,32,4
buffer_load_dwordx4 v8, s[12:15], s52 offen offset:0 nt lds
Zvaa 84,36,4
Ta 104,14,16384
Ta 106,14,18432
Zvaa 88,40,4
buffer_load_dwordx4 v9, s[12:15], s53 offen offset:1024 nt lds
Zvaa 92,44,4
Ra 72,11,4096
Zvaa 96,48,4
buffer_load_dwordx4 v8, s[12:15], s54 offen offset:2048 nt lds
Zvaa 100,52,4
Ta 108,15,16384
Ta 110,15,18432
Zvaa 104,56,4
buffer_load_dwordx4 v9, s[12:15], s55 offen offset:3072 nt lds
Zvaa 108,60,4
s_add_u32 m0, s56, 65536
s_waitcnt lgkmcnt(6)
Ra 76,11,6144
Zvaa 112,32,8
buffer_load_dwordx4 v2, s[8:11], s48 offen offset:0 lds
Zvaa 116,36,8
Ta 112,16,16384
Ta 114,16,18432
Zvaa 120,40,8
buffer_load_dwordx4 v3, s[8:11], s49 offen offset:1024 lds
Zvaa 124,44,8
Ra 80,11,8192
v_xor_b32 v6, 1572864, v6
Zvaa 128,48,8
buffer_load_dwordx4 v2, s[8:11], s50 offen offset:2048 lds
Zvaa 132,52,8
Ta 116,17,16384
Ta 118,17,18432
Zvaa 136,56,8
buffer_load_dwordx4 v3, s[8:11], s51 offen offset:3072 lds
Zvaa 140,60,8
s_add_u32 m0, s56, 69632
s_waitcnt lgkmcnt(6)
Ra 84,11,10240
Zvaa 144,32,12
buffer_load_dwordx4 v4, s[8:11], s48 offen offset:0 lds
Zvaa 148,36,12
Ta 120,18,16384
Ta 122,18,18432
Zvaa 152,40,12
buffer_load_dwordx4 v5, s[8:11], s49 offen offset:1024 lds
Zvaa 156,44,12
Ra 88,11,12288
v_xor_b32 v7, 1572864, v7
Zvaa 160,48,12
buffer_load_dwordx4 v4, s[8:11], s50 offen offset:2048 lds
Zvaa 164,52,12
Ta 124,19,16384
Ta 126,19,18432
Zvaa 168,56,12
buffer_load_dwordx4 v5, s[8:11], s51 offen offset:3072 lds
Zvaa 172,60,12
s_waitcnt lgkmcnt(6)
Ra 92,11,14336
Zvaa 176,32,16
v_and_b32 v46, 7, v0
v_mul_u32_u24 v30, 2064, v46
Zvaa 180,36,16
v_xor_b32 v8, 1572864, v8
v_xor_b32 v9, 1572864, v9
Zvaa 184,40,16
v_lshrrev_b32_e64 v31, 3, v0
Zvaa 188,44,16
v_xor_b32 v2, 384, v2
v_xor_b32 v3, 384, v3
Zvaa 192,48,16
s_lshl_b32 s3, s32, 9
s_add_u32 s3, s3, 131072
v_lshl_add_u32 v30, v31, 4, v30
Zvaa 196,52,16
v_xor_b32 v4, 384, v4
v_xor_b32 v5, 384, v5
Zvaa 200,56,16
v_add_u32 v30, s3, v30
v_lshlrev_b32_e64 v31, 8, v31
Zvaa 204,60,16
v_lshl_add_u32 v46, v46, 4, v31
Zvaa 208,32,20
buffer_load_dword v1, v47, s[60:63], 0 offen
Zvaa 212,36,20
s_mul_i32 vcc_lo, s59, 7
v_xor_b32 v47, vcc_lo, v47
Zvaa 216,40,20
Rv 34,30,128
Rv 38,30,256
Zvaa 220,44,20
Rv 42,30,384
Rv 30,30,0
Zvaa 224,48,20
buffer_load_dword v1, v47, s[60:63], 0 offen
Zvaa 228,52,20
s_mul_i32 vcc_lo, s59, 1
v_xor_b32 v47, vcc_lo, v47
Zvaa 232,56,20
s_lshr_b32 s3, s2, 1
s_mul_i32 s3, s3, 33792
s_add_u32 s3, s3, s56
Zvaa 236,60,20
s_and_b32 s39, s2, 1
s_lshl_b32 s39, s39, 7
s_add_u32 s3, s3, s39
Zvaa 240,32,24
s_add_u32 s39, s3, 4096
Zvaa 244,36,24
Zvaa 248,40,24
Zvaa 252,44,24
Zaaa 128,48,24
Zaaa 132,52,24
Zaaa 136,56,24
Zaaa 140,60,24
Zaaa 144,32,28
Zaaa 148,36,28
Zaaa 152,40,28
Zaaa 156,44,28
Zaaa 160,48,28
Zaaa 164,52,28
Zaaa 168,56,28
Zaaa 172,60,28
s_waitcnt vmcnt(2) lgkmcnt(0)
s_add_u32 m0, s57, 0
s_barrier
Mvaa 48,96,64
buffer_load_dwordx4 v6, s[12:15], s52 offen offset:0 nt lds
Mvaa 52,100,64
Ta 32,22,0
Ta 34,22,2048
Mvaa 56,104,64
Mvaa 60,108,64
Ra 0,20,0
Mvaa 64,112,64
buffer_load_dwordx4 v7, s[12:15], s53 offen offset:1024 nt lds
Mvaa 68,116,64
s_waitcnt lgkmcnt(6)
Ta 36,23,0
Ta 38,23,2048
Mvaa 72,120,64
Mvaa 76,124,64
Ra 4,20,2048
Mvaa 80,96,68
buffer_load_dwordx4 v6, s[12:15], s54 offen offset:2048 nt lds
Mvaa 84,100,68
Ta 40,24,0
Ta 42,24,2048
Mvaa 88,104,68
Mvaa 92,108,68
Ra 8,20,4096
Mvaa 96,112,68
buffer_load_dwordx4 v7, s[12:15], s55 offen offset:3072 nt lds
Mvaa 100,116,68
s_waitcnt lgkmcnt(6)
Ta 44,25,0
Ta 46,25,2048
Mvaa 104,120,68
Mvaa 108,124,68
s_add_u32 m0, s57, 4096
Ra 12,20,6144
Mvaa 112,96,72
buffer_load_dwordx4 v8, s[12:15], s52 offen offset:0 nt lds
Mvaa 116,100,72
Ta 48,26,0
Ta 50,26,2048
Mvaa 120,104,72
Mvaa 124,108,72
Ra 16,20,8192
Mvaa 128,112,72
buffer_load_dwordx4 v9, s[12:15], s53 offen offset:1024 nt lds
Mvaa 132,116,72
s_waitcnt lgkmcnt(6)
Ta 52,27,0
Ta 54,27,2048
Mvaa 136,120,72
Mvaa 140,124,72
Ra 20,20,10240
Mvaa 144,96,76
buffer_load_dwordx4 v8, s[12:15], s54 offen offset:2048 nt lds
Mvaa 148,100,76
Ta 56,28,0
Ta 58,28,2048
Mvaa 152,104,76
Mvaa 156,108,76
Ra 24,20,12288
Mvaa 160,112,76
buffer_load_dwordx4 v9, s[12:15], s55 offen offset:3072 nt lds
Mvaa 164,116,76
s_waitcnt lgkmcnt(6)
Ta 60,29,0
Ta 62,29,2048
Mvaa 168,120,76
v_xor_b32 v6, 524288, v6
v_xor_b32 v7, 524288, v7
Mvaa 172,124,76
s_add_u32 m0, s56, 0
Ra 28,20,14336
v_xor_b32 v8, 524288, v8
Mvaa 176,96,80
buffer_load_dwordx4 v2, s[8:11], s48 offen offset:0 lds
Mvaa 180,100,80
v_xor_b32 v9, 524288, v9
Mvaa 184,104,80
Mvaa 188,108,80
Mvaa 192,112,80
buffer_load_dwordx4 v3, s[8:11], s49 offen offset:1024 lds
Mvaa 196,116,80
Mvaa 200,120,80
Mvaa 204,124,80
Mvaa 208,96,84
buffer_load_dwordx4 v2, s[8:11], s50 offen offset:2048 lds
Mvaa 212,100,84
Mvaa 216,104,84
Mvaa 220,108,84
Mvaa 224,112,84
buffer_load_dwordx4 v3, s[8:11], s51 offen offset:3072 lds
Mvaa 228,116,84
Mvaa 232,120,84
Mvaa 236,124,84
s_add_u32 m0, s56, 4096
Mvaa 240,96,88
buffer_load_dwordx4 v4, s[8:11], s48 offen offset:0 lds
Mvaa 244,100,88
Mvaa 248,104,88
Mvaa 252,108,88
Maaa 128,112,88
buffer_load_dwordx4 v5, s[8:11], s49 offen offset:1024 lds
Maaa 132,116,88
Maaa 136,120,88
Maaa 140,124,88
Maaa 144,96,92
buffer_load_dwordx4 v4, s[8:11], s50 offen offset:2048 lds
Maaa 148,100,92
Maaa 152,104,92
Maaa 156,108,92
Maaa 160,112,92
buffer_load_dwordx4 v5, s[8:11], s51 offen offset:3072 lds
Maaa 164,116,92
v_xor_b32 v2, 128, v2
v_xor_b32 v3, 128, v3
Maaa 168,120,92
buffer_load_dword v1, v47, s[60:63], 0 offen
v_xor_b32 v4, 128, v4
v_xor_b32 v5, 128, v5
Maaa 172,124,92
s_mul_i32 vcc_lo, s59, 3
v_xor_b32 v47, vcc_lo, v47
s_waitcnt lgkmcnt(0)
Mvaa 48,32,0
buffer_store_dwordx4 v[30:33], v46, s[20:23], s3 offen offset:0 sc1
Mvaa 52,36,0
Ta 96,22,16384
Ta 98,22,18432
Mvaa 56,40,0
buffer_store_dwordx4 v[34:37], v46, s[20:23], s3 offen offset:2048 sc1
Mvaa 60,44,0
Ra 64,21,0
Mvaa 64,48,0
buffer_store_dwordx4 v[38:41], v46, s[20:23], s39 offen offset:0 sc1
Mvaa 68,52,0
Ta 100,23,16384
Ta 102,23,18432
Mvaa 72,56,0
buffer_store_dwordx4 v[42:45], v46, s[20:23], s39 offen offset:2048 sc1
Mvaa 76,60,0
s_waitcnt lgkmcnt(6)
Ra 68,21,2048
Mvaa 80,32,4
s_lshl_b32 s3, s34, 1
s_and_b32 s36, s32, 1
s_add_u32 s3, s3, s36
Mvaa 84,36,4
Ta 104,24,16384
Ta 106,24,18432
Mvaa 88,40,4
s_mul_i32 s3, s3, 1116160
s_mul_i32 s36, s33, 139264
s_add_u32 s3, s3, s36
Mvaa 92,44,4
Ra 72,21,4096
Mvaa 96,48,4
s_lshr_b32 s36, s32, 1
s_mul_i32 s36, s36, 69632
s_add_u32 s3, s3, s36
Mvaa 100,52,4
Ta 108,25,16384
Ta 110,25,18432
Mvaa 104,56,4
s_add_u32 s38, s3, 0
s_lshl_b32 s39, s34, 7
s_lshl_b32 s36, s33, 2
Mvaa 108,60,4
s_waitcnt lgkmcnt(6)
Ra 76,21,6144
Mvaa 112,32,8
s_add_u32 s39, s39, s36
s_add_u32 s39, s39, 5296128
v_mov_b32_e64 v30, 1
Mvaa 116,36,8
Ta 112,26,16384
Ta 114,26,18432
Mvaa 120,40,8
v_mov_b32_e64 v31, 0
Mvaa 124,44,8
Ra 80,21,8192
Mvaa 128,48,8
s_cmp_eq_u32 s32, 0
s_cselect_b32 s39, s39, 2146435072
Mvaa 132,52,8
Ta 116,27,16384
Ta 118,27,18432
Mvaa 136,56,8
s_mov_b64 exec, 1
buffer_store_dword v31, v31, s[20:23], s39 offen sc1
s_mov_b64 exec, -1
Mvaa 140,60,8
s_waitcnt lgkmcnt(6)
Ra 84,21,10240
Mvaa 144,32,12
s_and_b32 s33, s2, 7
s_lshl_b32 s33, s33, 2
s_bfe_u32 s3, s2, 0x20003
Mvaa 148,36,12
Ta 120,28,16384
Ta 122,28,18432
Mvaa 152,40,12
s_add_u32 s33, s33, s3
s_lshr_b32 s34, s2, 5
s_lshl_b32 s64, s34, 7
Mvaa 156,44,12
Ra 88,21,12288
Mvaa 160,48,12
s_lshl_b32 s3, s33, 2
s_add_u32 s64, s64, s3
s_add_u32 s64, s64, 5300224
Mvaa 164,52,12
Ta 124,29,16384
Ta 126,29,18432
Mvaa 168,56,12
s_lshl_b32 s65, s34, 8
s_sub_u32 s65, 1920, s65
v_mul_u32_u24_e64 v32, s65, v0
Mvaa 172,60,12
s_waitcnt lgkmcnt(6)
Ra 92,21,14336
Mvaa 176,32,16
s_cmp_eq_u32 s32, 0
s_cselect_b32 s64, s64, 2146435072
Mvaa 180,36,16
s_mov_b64 exec, 3
buffer_store_dword v31, v32, s[20:23], s64 offen sc1
s_mov_b64 exec, -1
Mvaa 184,40,16
s_lshl_b32 s3, s2, 2
s_add_u32 s3, s3, 5447680
v_lshlrev_b32 v32, 10, v0
Mvaa 188,44,16
s_cmp_eq_u32 s32, 0
s_cselect_b32 s3, s3, 2146435072
Mvaa 192,48,16
s_mov_b64 exec, 0x1ff
buffer_store_dword v31, v32, s[20:23], s3 offen sc1
s_mov_b64 exec, -1
Mvaa 196,52,16
s_lshl_b32 s35, s34, 1
s_sub_u32 s36, 32, s35
s_add_u32 s35, s35, 2
Mvaa 200,56,16
s_lshl_b32 s44, s32, 12
s_lshl_b32 s58, s32, 1
s_sub_u32 s58, 7, s58
Mvaa 204,60,16
s_mul_i32 s58, s58, 33792
s_sub_u32 s3, 15, s34
s_lshl_b32 s45, s3, 3
Mvaa 208,32,20
s_add_u32 s45, s45, s32
s_lshl_b32 s46, s34, 3
s_add_u32 s46, s46, s32
Mvaa 212,36,20
s_mov_b32 s68, s42
s_and_b32 s69, s43, 0xffff
s_mov_b32 s70, 7340032
Mvaa 216,40,20
s_mov_b32 s71, 0x20000
s_cmp_eq_u32 s32, 0
s_cselect_b32 s37, 0, 2146435072
Mvaa 220,44,20
s_lshl_b32 s3, s33, 8
s_add_u32 s16, s4, s3
s_addc_u32 s17, s5, 0
s_and_b32 s17, s17, 0xffff
Mvaa 224,48,20
s_mov_b32 s18, 0
s_mov_b32 s19, 0x20000
s_sub_u32 s18, 8388608, s3
Mvaa 228,52,20
v_and_b32 v33, 15, v0
v_lshrrev_b32_e64 v32, 1, v33
Mvaa 232,56,20
v_and_b32 v33, 1, v0
v_lshlrev_b32 v32, 13, v32
Mvaa 236,60,20
v_lshl_add_u32 v45, v33, 7, v32
Mvaa 240,32,24
s_lshl_b32 s3, s32, 3
s_add_u32 s3, s3, s34
s_mul_i32 s47, s3, 65536
Mvaa 244,36,24
s_bfe_u32 s6, s2, 131075
s_lshl_b32 s3, s32, 8
s_or_b32 s6, s6, s3
Mvaa 248,40,24
Mvaa 252,44,24
Maaa 128,48,24
Maaa 132,52,24
Maaa 136,56,24
Maaa 140,60,24
Maaa 144,32,28
Maaa 148,36,28
Maaa 152,40,28
Maaa 156,44,28
Maaa 160,48,28
Maaa 164,52,28
Maaa 168,56,28
Maaa 172,60,28
s_waitcnt vmcnt(8) lgkmcnt(0)
s_add_u32 m0, s57, 65536
s_barrier
Mvaa 48,96,64
buffer_load_dwordx4 v6, s[12:15], s52 offen offset:0 nt lds
Mvaa 52,100,64
Ta 32,12,0
Ta 34,12,2048
Mvaa 56,104,64
Mvaa 60,108,64
Ra 0,10,0
Mvaa 64,112,64
buffer_load_dwordx4 v7, s[12:15], s53 offen offset:1024 nt lds
Mvaa 68,116,64
s_waitcnt lgkmcnt(6)
Ta 36,13,0
Ta 38,13,2048
Mvaa 72,120,64
Mvaa 76,124,64
Ra 4,10,2048
Mvaa 80,96,68
buffer_load_dwordx4 v6, s[12:15], s54 offen offset:2048 nt lds
Mvaa 84,100,68
Ta 40,14,0
Ta 42,14,2048
Mvaa 88,104,68
Mvaa 92,108,68
Ra 8,10,4096
Mvaa 96,112,68
buffer_load_dwordx4 v7, s[12:15], s55 offen offset:3072 nt lds
Mvaa 100,116,68
s_waitcnt lgkmcnt(6)
Ta 44,15,0
Ta 46,15,2048
Mvaa 104,120,68
Mvaa 108,124,68
s_add_u32 m0, s57, 69632
Ra 12,10,6144
Mvaa 112,96,72
buffer_load_dwordx4 v8, s[12:15], s52 offen offset:0 nt lds
Mvaa 116,100,72
Ta 48,16,0
Ta 50,16,2048
Mvaa 120,104,72
Mvaa 124,108,72
Ra 16,10,8192
Mvaa 128,112,72
buffer_load_dwordx4 v9, s[12:15], s53 offen offset:1024 nt lds
Mvaa 132,116,72
s_waitcnt lgkmcnt(6)
Ta 52,17,0
Ta 54,17,2048
Mvaa 136,120,72
Mvaa 140,124,72
Ra 20,10,10240
Mvaa 144,96,76
buffer_load_dwordx4 v8, s[12:15], s54 offen offset:2048 nt lds
Mvaa 148,100,76
Ta 56,18,0
Ta 58,18,2048
Mvaa 152,104,76
Mvaa 156,108,76
Ra 24,10,12288
Mvaa 160,112,76
buffer_load_dwordx4 v9, s[12:15], s55 offen offset:3072 nt lds
Mvaa 164,116,76
s_waitcnt lgkmcnt(6)
Ta 60,19,0
Ta 62,19,2048
Mvaa 168,120,76
v_xor_b32 v6, 3670016, v6
v_xor_b32 v7, 3670016, v7
Mvaa 172,124,76
s_add_u32 m0, s56, 65536
Ra 28,10,14336
v_xor_b32 v8, 3670016, v8
Mvaa 176,96,80
buffer_load_dwordx4 v2, s[8:11], s48 offen offset:0 lds
Mvaa 180,100,80
v_xor_b32 v9, 3670016, v9
Mvaa 184,104,80
Mvaa 188,108,80
Mvaa 192,112,80
buffer_load_dwordx4 v3, s[8:11], s49 offen offset:1024 lds
Mvaa 196,116,80
Mvaa 200,120,80
Mvaa 204,124,80
Mvaa 208,96,84
buffer_load_dwordx4 v2, s[8:11], s50 offen offset:2048 lds
Mvaa 212,100,84
Mvaa 216,104,84
Mvaa 220,108,84
Mvaa 224,112,84
buffer_load_dwordx4 v3, s[8:11], s51 offen offset:3072 lds
Mvaa 228,116,84
Mvaa 232,120,84
Mvaa 236,124,84
s_add_u32 m0, s56, 69632
Mvaa 240,96,88
buffer_load_dwordx4 v4, s[8:11], s48 offen offset:0 lds
Mvaa 244,100,88
Mvaa 248,104,88
Mvaa 252,108,88
Maaa 128,112,88
buffer_load_dwordx4 v5, s[8:11], s49 offen offset:1024 lds
Maaa 132,116,88
Maaa 136,120,88
Maaa 140,124,88
Maaa 144,96,92
buffer_load_dwordx4 v4, s[8:11], s50 offen offset:2048 lds
Maaa 148,100,92
Maaa 152,104,92
Maaa 156,108,92
Maaa 160,112,92
buffer_load_dwordx4 v5, s[8:11], s51 offen offset:3072 lds
Maaa 164,116,92
v_xor_b32 v2, 896, v2
v_xor_b32 v3, 896, v3
Maaa 168,120,92
buffer_load_dword v1, v47, s[60:63], 0 offen
v_xor_b32 v4, 896, v4
v_xor_b32 v5, 896, v5
Maaa 172,124,92
s_mul_i32 vcc_lo, s59, 1
v_xor_b32 v47, vcc_lo, v47
s_waitcnt lgkmcnt(0)
Mvaa 48,32,0
Mvaa 52,36,0
Ta 96,12,16384
Ta 98,12,18432
Mvaa 56,40,0
Mvaa 60,44,0
Ra 64,11,0
Mvaa 64,48,0
Mvaa 68,52,0
Ta 100,13,16384
Ta 102,13,18432
Mvaa 72,56,0
Mvaa 76,60,0
s_waitcnt lgkmcnt(6)
Ra 68,11,2048
Mvaa 80,32,4
Mvaa 84,36,4
Ta 104,14,16384
Ta 106,14,18432
Mvaa 88,40,4
Mvaa 92,44,4
Ra 72,11,4096
Mvaa 96,48,4
Mvaa 100,52,4
Ta 108,15,16384
Ta 110,15,18432
Mvaa 104,56,4
Mvaa 108,60,4
s_waitcnt lgkmcnt(6)
Ra 76,11,6144
Mvaa 112,32,8
Mvaa 116,36,8
Ta 112,16,16384
Ta 114,16,18432
Mvaa 120,40,8
Mvaa 124,44,8
Ra 80,11,8192
Mvaa 128,48,8
Mvaa 132,52,8
Ta 116,17,16384
Ta 118,17,18432
Mvaa 136,56,8
Mvaa 140,60,8
s_waitcnt lgkmcnt(6)
Ra 84,11,10240
Mvaa 144,32,12
Mvaa 148,36,12
Ta 120,18,16384
Ta 122,18,18432
Mvaa 152,40,12
Mvaa 156,44,12
Ra 88,11,12288
Mvaa 160,48,12
Mvaa 164,52,12
Ta 124,19,16384
Ta 126,19,18432
Mvaa 168,56,12
Mvaa 172,60,12
s_waitcnt lgkmcnt(6)
Ra 92,11,14336
Mvaa 176,32,16
Mvaa 180,36,16
Mvaa 184,40,16
Mvaa 188,44,16
Mvaa 192,48,16
Mvaa 196,52,16
Mvaa 200,56,16
Mvaa 204,60,16
Mvaa 208,32,20
Mvaa 212,36,20
Mvaa 216,40,20
Mvaa 220,44,20
Mvaa 224,48,20
Mvaa 228,52,20
Mvaa 232,56,20
Mvaa 236,60,20
Mvaa 240,32,24
Mvaa 244,36,24
Mvaa 248,40,24
Mvaa 252,44,24
Maaa 128,48,24
Maaa 132,52,24
Maaa 136,56,24
Maaa 140,60,24
Maaa 144,32,28
Maaa 148,36,28
Maaa 152,40,28
Maaa 156,44,28
Maaa 160,48,28
Maaa 164,52,28
Maaa 168,56,28
Maaa 172,60,28
s_waitcnt vmcnt(1) lgkmcnt(0)
s_add_u32 m0, s57, 0
s_barrier
Mvaa 48,96,64
buffer_load_dwordx4 v6, s[12:15], s52 offen offset:0 nt lds
Mvaa 52,100,64
Ta 32,22,0
Ta 34,22,2048
Mvaa 56,104,64
Mvaa 60,108,64
Ra 0,20,0
Mvaa 64,112,64
buffer_load_dwordx4 v7, s[12:15], s53 offen offset:1024 nt lds
Mvaa 68,116,64
s_waitcnt lgkmcnt(6)
Ta 36,23,0
Ta 38,23,2048
Mvaa 72,120,64
Mvaa 76,124,64
Ra 4,20,2048
Mvaa 80,96,68
buffer_load_dwordx4 v6, s[12:15], s54 offen offset:2048 nt lds
Mvaa 84,100,68
Ta 40,24,0
Ta 42,24,2048
Mvaa 88,104,68
Mvaa 92,108,68
Ra 8,20,4096
Mvaa 96,112,68
buffer_load_dwordx4 v7, s[12:15], s55 offen offset:3072 nt lds
Mvaa 100,116,68
s_waitcnt lgkmcnt(6)
Ta 44,25,0
Ta 46,25,2048
Mvaa 104,120,68
s_cmp_eq_u32 s6, 0
s_cselect_b32 s3, 0, 2146435072
Mvaa 108,124,68
s_add_u32 m0, s57, 4096
Ra 12,20,6144
Mvaa 112,96,72
buffer_load_dwordx4 v8, s[12:15], s52 offen offset:0 nt lds
Mvaa 116,100,72
Ta 48,26,0
Ta 50,26,2048
Mvaa 120,104,72
s_mov_b64 exec, 1
buffer_atomic_add v30, v31, s[28:31], s3 offen sc1
s_mov_b64 exec, -1
Mvaa 124,108,72
Ra 16,20,8192
Mvaa 128,112,72
buffer_load_dwordx4 v9, s[12:15], s53 offen offset:1024 nt lds
Mvaa 132,116,72
s_waitcnt lgkmcnt(6)
Ta 52,27,0
Ta 54,27,2048
Mvaa 136,120,72
Mvaa 140,124,72
Ra 20,20,10240
Mvaa 144,96,76
buffer_load_dwordx4 v8, s[12:15], s54 offen offset:2048 nt lds
Mvaa 148,100,76
Ta 56,28,0
Ta 58,28,2048
Mvaa 152,104,76
Mvaa 156,108,76
Ra 24,20,12288
Mvaa 160,112,76
buffer_load_dwordx4 v9, s[12:15], s55 offen offset:3072 nt lds
Mvaa 164,116,76
s_waitcnt lgkmcnt(6)
Ta 60,29,0
Ta 62,29,2048
Mvaa 168,120,76
v_xor_b32 v6, 524288, v6
v_xor_b32 v7, 524288, v7
Mvaa 172,124,76
s_add_u32 m0, s56, 0
Ra 28,20,14336
v_xor_b32 v8, 524288, v8
Mvaa 176,96,80
buffer_load_dwordx4 v2, s[8:11], s48 offen offset:0 lds
Mvaa 180,100,80
v_xor_b32 v9, 524288, v9
Mvaa 184,104,80
Mvaa 188,108,80
Mvaa 192,112,80
buffer_load_dwordx4 v3, s[8:11], s49 offen offset:1024 lds
Mvaa 196,116,80
Mvaa 200,120,80
Mvaa 204,124,80
Mvaa 208,96,84
buffer_load_dwordx4 v2, s[8:11], s50 offen offset:2048 lds
Mvaa 212,100,84
Mvaa 216,104,84
Mvaa 220,108,84
Mvaa 224,112,84
buffer_load_dwordx4 v3, s[8:11], s51 offen offset:3072 lds
Mvaa 228,116,84
Mvaa 232,120,84
Mvaa 236,124,84
s_add_u32 m0, s56, 4096
Mvaa 240,96,88
buffer_load_dwordx4 v4, s[8:11], s48 offen offset:0 lds
Mvaa 244,100,88
Mvaa 248,104,88
Mvaa 252,108,88
Maaa 128,112,88
buffer_load_dwordx4 v5, s[8:11], s49 offen offset:1024 lds
Maaa 132,116,88
Maaa 136,120,88
Maaa 140,124,88
Maaa 144,96,92
buffer_load_dwordx4 v4, s[8:11], s50 offen offset:2048 lds
Maaa 148,100,92
Maaa 152,104,92
Maaa 156,108,92
Maaa 160,112,92
buffer_load_dwordx4 v5, s[8:11], s51 offen offset:3072 lds
Maaa 164,116,92
v_xor_b32 v2, 128, v2
v_xor_b32 v3, 128, v3
Maaa 168,120,92
buffer_load_dword v1, v47, s[60:63], 0 offen
v_xor_b32 v4, 128, v4
v_xor_b32 v5, 128, v5
Maaa 172,124,92
s_mul_i32 vcc_lo, s59, 7
v_xor_b32 v47, vcc_lo, v47
s_waitcnt lgkmcnt(0)
Mvaa 48,32,0
buffer_load_dword v44, v45, s[16:19], s47 offen
Mvaa 52,36,0
Ta 96,22,16384
Ta 98,22,18432
Mvaa 56,40,0
s_add_u32 s47, s47, 2097152
Mvaa 60,44,0
Ra 64,21,0
Mvaa 64,48,0
Mvaa 68,52,0
Ta 100,23,16384
Ta 102,23,18432
Mvaa 72,56,0
Mvaa 76,60,0
s_waitcnt lgkmcnt(6)
Ra 68,21,2048
Mvaa 80,32,4
Mvaa 84,36,4
Ta 104,24,16384
Ta 106,24,18432
Mvaa 88,40,4
Mvaa 92,44,4
Ra 72,21,4096
Mvaa 96,48,4
Mvaa 100,52,4
Ta 108,25,16384
Ta 110,25,18432
Mvaa 104,56,4
Mvaa 108,60,4
s_waitcnt lgkmcnt(6)
Ra 76,21,6144
Mvaa 112,32,8
Mvaa 116,36,8
Ta 112,26,16384
Ta 114,26,18432
Mvaa 120,40,8
Mvaa 124,44,8
Ra 80,21,8192
Mvaa 128,48,8
Mvaa 132,52,8
Ta 116,27,16384
Ta 118,27,18432
Mvaa 136,56,8
Mvaa 140,60,8
s_waitcnt lgkmcnt(6)
Ra 84,21,10240
Mvaa 144,32,12
Mvaa 148,36,12
Ta 120,28,16384
Ta 122,28,18432
Mvaa 152,40,12
s_cmp_eq_u32 s6, 1
s_cselect_b32 s3, 0, 2146435072
Mvaa 156,44,12
Ra 88,21,12288
Mvaa 160,48,12
s_mov_b64 exec, 1
buffer_atomic_add v30, v31, s[28:31], s3 offen sc1
s_mov_b64 exec, -1
Mvaa 164,52,12
Ta 124,29,16384
Ta 126,29,18432
Mvaa 168,56,12
Mvaa 172,60,12
s_waitcnt lgkmcnt(6)
Ra 92,21,14336
Mvaa 176,32,16
Mvaa 180,36,16
Mvaa 184,40,16
Mvaa 188,44,16
Mvaa 192,48,16
Mvaa 196,52,16
Mvaa 200,56,16
Mvaa 204,60,16
Mvaa 208,32,20
Mvaa 212,36,20
Mvaa 216,40,20
Mvaa 220,44,20
Mvaa 224,48,20
Mvaa 228,52,20
Mvaa 232,56,20
Mvaa 236,60,20
Mvaa 240,32,24
Mvaa 244,36,24
Mvaa 248,40,24
Mvaa 252,44,24
Maaa 128,48,24
Maaa 132,52,24
Maaa 136,56,24
Maaa 140,60,24
Maaa 144,32,28
Maaa 148,36,28
Maaa 152,40,28
Maaa 156,44,28
Maaa 160,48,28
Maaa 164,52,28
Maaa 168,56,28
Maaa 172,60,28
s_waitcnt vmcnt(3) lgkmcnt(0)
s_add_u32 m0, s57, 65536
s_barrier
Mvaa 48,96,64
buffer_load_dwordx4 v6, s[12:15], s52 offen offset:0 nt lds
Mvaa 52,100,64
Ta 32,12,0
Ta 34,12,2048
Mvaa 56,104,64
Mvaa 60,108,64
Ra 0,10,0
Mvaa 64,112,64
buffer_load_dwordx4 v7, s[12:15], s53 offen offset:1024 nt lds
Mvaa 68,116,64
s_waitcnt lgkmcnt(6)
Ta 36,13,0
Ta 38,13,2048
Mvaa 72,120,64
Mvaa 76,124,64
Ra 4,10,2048
Mvaa 80,96,68
buffer_load_dwordx4 v6, s[12:15], s54 offen offset:2048 nt lds
Mvaa 84,100,68
Ta 40,14,0
Ta 42,14,2048
Mvaa 88,104,68
Mvaa 92,108,68
Ra 8,10,4096
Mvaa 96,112,68
buffer_load_dwordx4 v7, s[12:15], s55 offen offset:3072 nt lds
Mvaa 100,116,68
s_waitcnt lgkmcnt(6)
Ta 44,15,0
Ta 46,15,2048
Mvaa 104,120,68
Mvaa 108,124,68
s_add_u32 m0, s57, 69632
Ra 12,10,6144
Mvaa 112,96,72
buffer_load_dwordx4 v8, s[12:15], s52 offen offset:0 nt lds
Mvaa 116,100,72
Ta 48,16,0
Ta 50,16,2048
Mvaa 120,104,72
Mvaa 124,108,72
Ra 16,10,8192
Mvaa 128,112,72
buffer_load_dwordx4 v9, s[12:15], s53 offen offset:1024 nt lds
Mvaa 132,116,72
s_waitcnt lgkmcnt(6)
Ta 52,17,0
Ta 54,17,2048
Mvaa 136,120,72
Mvaa 140,124,72
Ra 20,10,10240
Mvaa 144,96,76
buffer_load_dwordx4 v8, s[12:15], s54 offen offset:2048 nt lds
Mvaa 148,100,76
Ta 56,18,0
Ta 58,18,2048
Mvaa 152,104,76
Mvaa 156,108,76
Ra 24,10,12288
Mvaa 160,112,76
buffer_load_dwordx4 v9, s[12:15], s55 offen offset:3072 nt lds
Mvaa 164,116,76
s_waitcnt lgkmcnt(6)
Ta 60,19,0
Ta 62,19,2048
Mvaa 168,120,76
v_xor_b32 v6, 1572864, v6
v_xor_b32 v7, 1572864, v7
Mvaa 172,124,76
s_add_u32 m0, s56, 65536
Ra 28,10,14336
v_xor_b32 v8, 1572864, v8
Mvaa 176,96,80
buffer_load_dwordx4 v2, s[8:11], s48 offen offset:0 lds
Mvaa 180,100,80
v_xor_b32 v9, 1572864, v9
Mvaa 184,104,80
Mvaa 188,108,80
Mvaa 192,112,80
buffer_load_dwordx4 v3, s[8:11], s49 offen offset:1024 lds
Mvaa 196,116,80
Mvaa 200,120,80
Mvaa 204,124,80
s_cmp_eq_u32 s6, 2
s_cselect_b32 s3, 0, 2146435072
Mvaa 208,96,84
buffer_load_dwordx4 v2, s[8:11], s50 offen offset:2048 lds
Mvaa 212,100,84
s_mov_b64 exec, 1
buffer_atomic_add v30, v31, s[28:31], s3 offen sc1
s_mov_b64 exec, -1
Mvaa 216,104,84
Mvaa 220,108,84
Mvaa 224,112,84
buffer_load_dwordx4 v3, s[8:11], s51 offen offset:3072 lds
Mvaa 228,116,84
Mvaa 232,120,84
Mvaa 236,124,84
s_add_u32 m0, s56, 69632
Mvaa 240,96,88
buffer_load_dwordx4 v4, s[8:11], s48 offen offset:0 lds
Mvaa 244,100,88
Mvaa 248,104,88
Mvaa 252,108,88
Maaa 128,112,88
buffer_load_dwordx4 v5, s[8:11], s49 offen offset:1024 lds
Maaa 132,116,88
Maaa 136,120,88
Maaa 140,124,88
Maaa 144,96,92
buffer_load_dwordx4 v4, s[8:11], s50 offen offset:2048 lds
Maaa 148,100,92
Maaa 152,104,92
Maaa 156,108,92
Maaa 160,112,92
buffer_load_dwordx4 v5, s[8:11], s51 offen offset:3072 lds
Maaa 164,116,92
v_xor_b32 v2, 384, v2
v_xor_b32 v3, 384, v3
Maaa 168,120,92
v_xor_b32 v4, 384, v4
v_xor_b32 v5, 384, v5
Maaa 172,124,92
s_waitcnt lgkmcnt(0)
Mvaa 48,32,0
buffer_load_dword v44, v45, s[16:19], s47 offen
Mvaa 52,36,0
Ta 96,12,16384
Ta 98,12,18432
Mvaa 56,40,0
s_add_u32 s47, s47, 2097152
Mvaa 60,44,0
Ra 64,11,0
Mvaa 64,48,0
Mvaa 68,52,0
Ta 100,13,16384
Ta 102,13,18432
Mvaa 72,56,0
Mvaa 76,60,0
s_waitcnt lgkmcnt(6)
Ra 68,11,2048
Mvaa 80,32,4
Mvaa 84,36,4
Ta 104,14,16384
Ta 106,14,18432
Mvaa 88,40,4
Mvaa 92,44,4
Ra 72,11,4096
Mvaa 96,48,4
Mvaa 100,52,4
Ta 108,15,16384
Ta 110,15,18432
Mvaa 104,56,4
Mvaa 108,60,4
s_waitcnt lgkmcnt(6)
Ra 76,11,6144
Mvaa 112,32,8
Mvaa 116,36,8
Ta 112,16,16384
Ta 114,16,18432
Mvaa 120,40,8
Mvaa 124,44,8
Ra 80,11,8192
Mvaa 128,48,8
Mvaa 132,52,8
Ta 116,17,16384
Ta 118,17,18432
Mvaa 136,56,8
Mvaa 140,60,8
s_waitcnt lgkmcnt(6)
Ra 84,11,10240
Mvaa 144,32,12
Mvaa 148,36,12
Ta 120,18,16384
Ta 122,18,18432
Mvaa 152,40,12
Mvaa 156,44,12
Ra 88,11,12288
Mvaa 160,48,12
Mvaa 164,52,12
Ta 124,19,16384
Ta 126,19,18432
Mvaa 168,56,12
Mvaa 172,60,12
s_waitcnt lgkmcnt(6)
Ra 92,11,14336
Mvaa 176,32,16
Mvaa 180,36,16
Mvaa 184,40,16
Mvaa 188,44,16
Mvaa 192,48,16
Mvaa 196,52,16
Mvaa 200,56,16
Mvaa 204,60,16
Mvaa 208,32,20
Mvaa 212,36,20
Mvaa 216,40,20
Mvaa 220,44,20
Mvaa 224,48,20
Mvaa 228,52,20
Mvaa 232,56,20
Mvaa 236,60,20
Mvaa 240,32,24
Mvaa 244,36,24
Mvaa 248,40,24
Mvaa 252,44,24
Maaa 128,48,24
s_cmp_eq_u32 s6, 3
s_cselect_b32 s3, 0, 2146435072
Maaa 132,52,24
s_mov_b64 exec, 1
buffer_atomic_add v30, v31, s[28:31], s3 offen sc1
s_mov_b64 exec, -1
Maaa 136,56,24
Maaa 140,60,24
Maaa 144,32,28
Maaa 148,36,28
Maaa 152,40,28
Maaa 156,44,28
Maaa 160,48,28
Maaa 164,52,28
Maaa 168,56,28
Maaa 172,60,28
s_waitcnt vmcnt(2) lgkmcnt(0)
s_add_u32 m0, s57, 0
s_barrier
Mvaa 48,96,64
buffer_load_dwordx4 v6, s[12:15], s52 offen offset:0 nt lds
Mvaa 52,100,64
Ta 32,22,0
Ta 34,22,2048
Mvaa 56,104,64
Mvaa 60,108,64
Ra 0,20,0
Mvaa 64,112,64
buffer_load_dwordx4 v7, s[12:15], s53 offen offset:1024 nt lds
Mvaa 68,116,64
s_waitcnt lgkmcnt(6)
Ta 36,23,0
Ta 38,23,2048
Mvaa 72,120,64
Mvaa 76,124,64
Ra 4,20,2048
Mvaa 80,96,68
buffer_load_dwordx4 v6, s[12:15], s54 offen offset:2048 nt lds
Mvaa 84,100,68
Ta 40,24,0
Ta 42,24,2048
Mvaa 88,104,68
Mvaa 92,108,68
Ra 8,20,4096
Mvaa 96,112,68
buffer_load_dwordx4 v7, s[12:15], s55 offen offset:3072 nt lds
Mvaa 100,116,68
s_waitcnt lgkmcnt(6)
Ta 44,25,0
Ta 46,25,2048
Mvaa 104,120,68
Mvaa 108,124,68
s_add_u32 m0, s57, 4096
Ra 12,20,6144
Mvaa 112,96,72
buffer_load_dwordx4 v8, s[12:15], s52 offen offset:0 nt lds
Mvaa 116,100,72
Ta 48,26,0
Ta 50,26,2048
Mvaa 120,104,72
Mvaa 124,108,72
Ra 16,20,8192
Mvaa 128,112,72
buffer_load_dwordx4 v9, s[12:15], s53 offen offset:1024 nt lds
Mvaa 132,116,72
s_waitcnt lgkmcnt(6)
Ta 52,27,0
Ta 54,27,2048
Mvaa 136,120,72
Mvaa 140,124,72
Ra 20,20,10240
Mvaa 144,96,76
buffer_load_dwordx4 v8, s[12:15], s54 offen offset:2048 nt lds
Mvaa 148,100,76
Ta 56,28,0
Ta 58,28,2048
Mvaa 152,104,76
Mvaa 156,108,76
Ra 24,20,12288
Mvaa 160,112,76
buffer_load_dwordx4 v9, s[12:15], s55 offen offset:3072 nt lds
Mvaa 164,116,76
s_waitcnt lgkmcnt(6)
Ta 60,29,0
Ta 62,29,2048
Mvaa 168,120,76
v_xor_b32 v6, 524288, v6
v_xor_b32 v7, 524288, v7
Mvaa 172,124,76
s_add_u32 m0, s56, 0
Ra 28,20,14336
v_xor_b32 v8, 524288, v8
Mvaa 176,96,80
buffer_load_dwordx4 v2, s[8:11], s48 offen offset:0 lds
Mvaa 180,100,80
v_xor_b32 v9, 524288, v9
Mvaa 184,104,80
Mvaa 188,108,80
Mvaa 192,112,80
buffer_load_dwordx4 v3, s[8:11], s49 offen offset:1024 lds
Mvaa 196,116,80
Mvaa 200,120,80
Mvaa 204,124,80
Mvaa 208,96,84
buffer_load_dwordx4 v2, s[8:11], s50 offen offset:2048 lds
Mvaa 212,100,84
Mvaa 216,104,84
Mvaa 220,108,84
Mvaa 224,112,84
buffer_load_dwordx4 v3, s[8:11], s51 offen offset:3072 lds
Mvaa 228,116,84
Mvaa 232,120,84
Mvaa 236,124,84
s_add_u32 m0, s56, 4096
Mvaa 240,96,88
buffer_load_dwordx4 v4, s[8:11], s48 offen offset:0 lds
Mvaa 244,100,88
Mvaa 248,104,88
Mvaa 252,108,88
Maaa 128,112,88
buffer_load_dwordx4 v5, s[8:11], s49 offen offset:1024 lds
Maaa 132,116,88
Maaa 136,120,88
Maaa 140,124,88
Maaa 144,96,92
buffer_load_dwordx4 v4, s[8:11], s50 offen offset:2048 lds
Maaa 148,100,92
Maaa 152,104,92
Maaa 156,108,92
Maaa 160,112,92
buffer_load_dwordx4 v5, s[8:11], s51 offen offset:3072 lds
Maaa 164,116,92
v_xor_b32 v2, 128, v2
v_xor_b32 v3, 128, v3
Maaa 168,120,92
v_xor_b32 v4, 128, v4
v_xor_b32 v5, 128, v5
Maaa 172,124,92
s_waitcnt lgkmcnt(0)
Mvaa 48,32,0
buffer_load_dword v44, v45, s[16:19], s47 offen
Mvaa 52,36,0
Ta 96,22,16384
Ta 98,22,18432
Mvaa 56,40,0
s_add_u32 s47, s47, 2097152
v_lshrrev_b32 v32, 4, v0
v_and_b32 v33, 15, v0
Mvaa 60,44,0
Ra 64,21,0
Mvaa 64,48,0
s_lshl_b32 s3, s32, 4
v_add_u32 v34, s3, v32
v_lshlrev_b32_e64 v36, 1, v32
Mvaa 68,52,0
Ta 100,23,16384
Ta 102,23,18432
Mvaa 72,56,0
v_xor_b32 v36, v36, v33
v_xor_b32 v37, 8, v36
Mvaa 76,60,0
s_waitcnt lgkmcnt(6)
Ra 68,21,2048
Mvaa 80,32,4
s_getpc_b64 s[6:7]
L_cpf2:
s_add_u32 s6, s6, (L_phase2-L_cpf2)&0xffffffff
s_addc_u32 s7, s7, ((L_phase2-L_cpf2)>>32)&0xffffffff
Mvaa 84,36,4
Ta 104,24,16384
Ta 106,24,18432
Mvaa 88,40,4
s_lshr_b32 s3, s2, 3
s_lshl_b32 s3, s3, 2
s_add_u32 s3, s3, s32
Mvaa 92,44,4
Ra 72,21,4096
Mvaa 96,48,4
s_lshl_b32 s3, s3, 10
v_and_b32 v42, 7, v0
v_lshlrev_b32 v42, 7, v42
Mvaa 100,52,4
Ta 108,25,16384
Ta 110,25,18432
Mvaa 104,56,4
v_add_u32_e64 v42, s3, v42
v_min_u32 v42, L_k2_fin-L_phase2-4, v42
Mvaa 108,60,4
s_waitcnt lgkmcnt(6)
Ra 76,21,6144
Mvaa 112,32,8
v_mov_b32 v41, s7
Mvaa 116,36,8
Ta 112,26,16384
Ta 114,26,18432
Mvaa 120,40,8
v_add_co_u32 v40, vcc, s6, v42
s_nop 1
v_addc_co_u32 v41, vcc, 0, v41, vcc
Mvaa 124,44,8
Ra 80,21,8192
Mvaa 128,48,8
global_load_dword v38, v[40:41], off
Mvaa 132,52,8
Ta 116,27,16384
Ta 118,27,18432
Mvaa 136,56,8
Mvaa 140,60,8
s_waitcnt lgkmcnt(6)
Ra 84,21,10240
Mvaa 144,32,12
Mvaa 148,36,12
Ta 120,28,16384
Ta 122,28,18432
Mvaa 152,40,12
Mvaa 156,44,12
Ra 88,21,12288
Mvaa 160,48,12
Mvaa 164,52,12
Ta 124,29,16384
Ta 126,29,18432
Mvaa 168,56,12
Mvaa 172,60,12
s_waitcnt lgkmcnt(6)
Ra 92,21,14336
Mvaa 176,32,16
Mvaa 180,36,16
Mvaa 184,40,16
Mvaa 188,44,16
Mvaa 192,48,16
Mvaa 196,52,16
Mvaa 200,56,16
Mvaa 204,60,16
Mvaa 208,32,20
Mvaa 212,36,20
Mvaa 216,40,20
Mvaa 220,44,20
Mvaa 224,48,20
Mvaa 228,52,20
Mvaa 232,56,20
Mvaa 236,60,20
Mvaa 240,32,24
Mvaa 244,36,24
Mvaa 248,40,24
Mvaa 252,44,24
Maaa 128,48,24
Maaa 132,52,24
Maaa 136,56,24
Maaa 140,60,24
Maaa 144,32,28
Maaa 148,36,28
Maaa 152,40,28
Maaa 156,44,28
Maaa 160,48,28
Maaa 164,52,28
Maaa 168,56,28
Maaa 172,60,28
s_waitcnt vmcnt(2) lgkmcnt(0)
s_add_u32 m0, s57, 65536
s_barrier
Mvaa 48,96,64
buffer_load_dwordx4 v6, s[12:15], s52 offen offset:0 nt lds
Mvaa 52,100,64
Ta 32,12,0
Ta 34,12,2048
Mvaa 56,104,64
Mvaa 60,108,64
Ra 0,10,0
Mvaa 64,112,64
buffer_load_dwordx4 v7, s[12:15], s53 offen offset:1024 nt lds
Mvaa 68,116,64
s_waitcnt lgkmcnt(6)
Ta 36,13,0
Ta 38,13,2048
Mvaa 72,120,64
Mvaa 76,124,64
Ra 4,10,2048
Mvaa 80,96,68
buffer_load_dwordx4 v6, s[12:15], s54 offen offset:2048 nt lds
Mvaa 84,100,68
Ta 40,14,0
Ta 42,14,2048
Mvaa 88,104,68
Mvaa 92,108,68
Ra 8,10,4096
Mvaa 96,112,68
buffer_load_dwordx4 v7, s[12:15], s55 offen offset:3072 nt lds
Mvaa 100,116,68
s_waitcnt lgkmcnt(6)
Ta 44,15,0
Ta 46,15,2048
Mvaa 104,120,68
Mvaa 108,124,68
s_add_u32 m0, s57, 69632
Ra 12,10,6144
Mvaa 112,96,72
buffer_load_dwordx4 v8, s[12:15], s52 offen offset:0 nt lds
Mvaa 116,100,72
Ta 48,16,0
Ta 50,16,2048
Mvaa 120,104,72
Mvaa 124,108,72
Ra 16,10,8192
Mvaa 128,112,72
buffer_load_dwordx4 v9, s[12:15], s53 offen offset:1024 nt lds
Mvaa 132,116,72
s_waitcnt lgkmcnt(6)
Ta 52,17,0
Ta 54,17,2048
Mvaa 136,120,72
Mvaa 140,124,72
Ra 20,10,10240
Mvaa 144,96,76
buffer_load_dwordx4 v8, s[12:15], s54 offen offset:2048 nt lds
Mvaa 148,100,76
Ta 56,18,0
Ta 58,18,2048
Mvaa 152,104,76
Mvaa 156,108,76
Ra 24,10,12288
Mvaa 160,112,76
buffer_load_dwordx4 v9, s[12:15], s55 offen offset:3072 nt lds
Mvaa 164,116,76
s_waitcnt lgkmcnt(6)
Ta 60,19,0
Ta 62,19,2048
Mvaa 168,120,76
Mvaa 172,124,76
s_add_u32 m0, s56, 65536
Ra 28,10,14336
Mvaa 176,96,80
buffer_load_dwordx4 v2, s[8:11], s48 offen offset:0 lds
Mvaa 180,100,80
Mvaa 184,104,80
Mvaa 188,108,80
Mvaa 192,112,80
buffer_load_dwordx4 v3, s[8:11], s49 offen offset:1024 lds
Mvaa 196,116,80
Mvaa 200,120,80
Mvaa 204,124,80
Mvaa 208,96,84
buffer_load_dwordx4 v2, s[8:11], s50 offen offset:2048 lds
Mvaa 212,100,84
Mvaa 216,104,84
Mvaa 220,108,84
Mvaa 224,112,84
buffer_load_dwordx4 v3, s[8:11], s51 offen offset:3072 lds
Mvaa 228,116,84
Mvaa 232,120,84
Mvaa 236,124,84
s_add_u32 m0, s56, 69632
Mvaa 240,96,88
buffer_load_dwordx4 v4, s[8:11], s48 offen offset:0 lds
Mvaa 244,100,88
Mvaa 248,104,88
Mvaa 252,108,88
Maaa 128,112,88
buffer_load_dwordx4 v5, s[8:11], s49 offen offset:1024 lds
Maaa 132,116,88
Maaa 136,120,88
Maaa 140,124,88
Maaa 144,96,92
buffer_load_dwordx4 v4, s[8:11], s50 offen offset:2048 lds
Maaa 148,100,92
Maaa 152,104,92
Maaa 156,108,92
Maaa 160,112,92
buffer_load_dwordx4 v5, s[8:11], s51 offen offset:3072 lds
Maaa 164,116,92
Maaa 168,120,92
Maaa 172,124,92
s_waitcnt lgkmcnt(0)
Mvaa 48,32,0
buffer_load_dword v30, v31, s[28:31], s37 offen sc1
Mvaa 52,36,0
Ta 96,12,16384
Ta 98,12,18432
Mvaa 56,40,0
s_mov_b32 s8, s16
s_mov_b32 s9, s17
s_mov_b32 s10, s18
Mvaa 60,44,0
Ra 64,11,0
Mvaa 64,48,0
s_add_u32 s16, s66, 46137344
s_addc_u32 s17, s67, 0
s_and_b32 s17, s17, 0xffff
Mvaa 68,52,0
Ta 100,13,16384
Ta 102,13,18432
Mvaa 72,56,0
s_mov_b32 s18, 16777216
s_mov_b32 s19, 0x20000
s_mov_b32 s48, 0
Mvaa 76,60,0
s_waitcnt lgkmcnt(6)
Ra 68,11,2048
Mvaa 80,32,4
s_mov_b32 s49, 31744
s_mov_b32 s50, 63488
s_mov_b32 s51, 95232
Mvaa 84,36,4
Ta 104,14,16384
Ta 106,14,18432
Mvaa 88,40,4
v_lshlrev_b32_e64 v35, 13, v34
v_lshl_add_u32 v8, v36, 4, v35
Mvaa 92,44,4
Ra 72,11,4096
Mvaa 96,48,4
v_lshl_add_u32 v9, v37, 4, v35
v_lshlrev_b32_e64 v2, 4, v0
Mvaa 100,52,4
Ta 108,15,16384
Ta 110,15,18432
Mvaa 104,56,4
v_add_u32 v3, 65536, v2
v_add_u32_e64 v4, s44, v2
Mvaa 108,60,4
s_waitcnt lgkmcnt(6)
Ra 76,11,6144
Mvaa 112,32,8
v_mov_b32 v7, 0
v_lshlrev_b32_e64 v35, 2, v32
Mvaa 116,36,8
Ta 112,16,16384
Ta 114,16,18432
Mvaa 120,40,8
v_sub_u32_e64 v35, v33, v35
Mvaa 124,44,8
Ra 80,11,8192
Mvaa 128,48,8
s_lshl_b32 s3, s32, 4
v_add_u32 v5, s3, v35
Mvaa 132,52,8
Ta 116,17,16384
Ta 118,17,18432
Mvaa 136,56,8
s_sub_u32 s3, 48, s3
v_add_u32 v6, s3, v35
Mvaa 140,60,8
s_waitcnt lgkmcnt(6)
Ra 84,11,10240
Mvaa 144,32,12
s_mul_i32 s3, s33, 1116160
s_add_u32 s3, s3, 8388608
s_add_u32 s12, s66, s3
s_addc_u32 s13, s67, 0
s_and_b32 s13, s13, 0xffff
Mvaa 148,36,12
Ta 120,18,16384
Ta 122,18,18432
Mvaa 152,40,12
s_mov_b32 s14, 0
s_mov_b32 s15, 0x20000
s_mul_i32 s14, s36, 34816
Mvaa 156,44,12
Ra 88,11,12288
Mvaa 160,48,12
buffer_load_dword v44, v45, s[8:11], s47 offen
Mvaa 164,52,12
Ta 124,19,16384
Ta 126,19,18432
Mvaa 168,56,12
s_add_u32 s47, s47, 2097152
Mvaa 172,60,12
s_waitcnt lgkmcnt(6)
Ra 92,11,14336
Mvaa 176,32,16
Mvaa 180,36,16
Mvaa 184,40,16
Mvaa 188,44,16
Mvaa 192,48,16
Mvaa 196,52,16
Mvaa 200,56,16
Mvaa 204,60,16
Mvaa 208,32,20
Mvaa 212,36,20
Mvaa 216,40,20
Mvaa 220,44,20
Mvaa 224,48,20
Mvaa 228,52,20
Mvaa 232,56,20
Mvaa 236,60,20
Mvaa 240,32,24
Mvaa 244,36,24
Mvaa 248,40,24
Mvaa 252,44,24
Maaa 128,48,24
Maaa 132,52,24
Maaa 136,56,24
Maaa 140,60,24
Maaa 144,32,28
Maaa 148,36,28
Maaa 152,40,28
Maaa 156,44,28
Maaa 160,48,28
Maaa 164,52,28
Maaa 168,56,28
Maaa 172,60,28
s_waitcnt vmcnt(2) lgkmcnt(0)
s_add_u32 m0, s44, 0
s_barrier
Mvaa 48,96,64
buffer_load_dwordx4 v8, s[8:11], s48 offen offset:0 lds
Mvaa 52,100,64
Ta 32,22,0
Ta 34,22,2048
Mvaa 56,104,64
s_mul_i32 s3, s45, 33792
v_add_u32_e64 v10, s3, v2
Mvaa 60,108,64
Ra 0,20,0
Mvaa 64,112,64
buffer_load_dwordx4 v8, s[8:11], s49 offen offset:1024 lds
Mvaa 68,116,64
s_waitcnt lgkmcnt(6)
Ta 36,23,0
Ta 38,23,2048
Mvaa 72,120,64
s_mul_i32 s3, s46, 33792
v_add_u32 v11, s3, v2
v_mov_b32_e64 v14, v40
Mvaa 76,124,64
Ra 4,20,2048
Mvaa 80,96,68
buffer_load_dwordx4 v9, s[8:11], s50 offen offset:2048 lds
Mvaa 84,100,68
Ta 40,24,0
Ta 42,24,2048
Mvaa 88,104,68
v_mov_b32_e64 v15, v41
Mvaa 92,108,68
Ra 8,20,4096
Mvaa 96,112,68
buffer_load_dwordx4 v9, s[8:11], s51 offen offset:3072 lds
Mvaa 100,116,68
s_waitcnt lgkmcnt(6)
Ta 44,25,0
Ta 46,25,2048
Mvaa 104,120,68
v_add_u32 v8, 524288, v8
v_add_u32 v9, 524288, v9
Mvaa 108,124,68
s_add_u32 m0, s44, 16384
Ra 12,20,6144
Mvaa 112,96,72
buffer_load_dwordx4 v8, s[8:11], s48 offen offset:0 lds
Mvaa 116,100,72
Ta 48,26,0
Ta 50,26,2048
Mvaa 120,104,72
Mvaa 124,108,72
Ra 16,20,8192
Mvaa 128,112,72
buffer_load_dwordx4 v8, s[8:11], s49 offen offset:1024 lds
Mvaa 132,116,72
s_waitcnt lgkmcnt(6)
Ta 52,27,0
Ta 54,27,2048
Mvaa 136,120,72
Mvaa 140,124,72
Ra 20,20,10240
Mvaa 144,96,76
buffer_load_dwordx4 v9, s[8:11], s50 offen offset:2048 lds
Mvaa 148,100,76
Ta 56,28,0
Ta 58,28,2048
Mvaa 152,104,76
Mvaa 156,108,76
Ra 24,20,12288
Mvaa 160,112,76
buffer_load_dwordx4 v9, s[8:11], s51 offen offset:3072 lds
Mvaa 164,116,76
s_waitcnt lgkmcnt(6)
Ta 60,29,0
Ta 62,29,2048
Mvaa 168,120,76
v_add_u32 v8, 524288, v8
v_add_u32 v9, 524288, v9
Mvaa 172,124,76
s_add_u32 m0, s44, 32768
Ra 28,20,14336
Mvaa 176,96,80
buffer_load_dwordx4 v8, s[8:11], s48 offen offset:0 lds
Mvaa 180,100,80
Mvaa 184,104,80
Mvaa 188,108,80
Mvaa 192,112,80
buffer_load_dwordx4 v8, s[8:11], s49 offen offset:1024 lds
Mvaa 196,116,80
Mvaa 200,120,80
Mvaa 204,124,80
Mvaa 208,96,84
buffer_load_dwordx4 v9, s[8:11], s50 offen offset:2048 lds
Mvaa 212,100,84
Mvaa 216,104,84
Mvaa 220,108,84
Mvaa 224,112,84
buffer_load_dwordx4 v9, s[8:11], s51 offen offset:3072 lds
Mvaa 228,116,84
v_add_u32 v8, 524288, v8
v_add_u32 v9, 524288, v9
Mvaa 232,120,84
Mvaa 236,124,84
s_add_u32 m0, s44, 49152
Mvaa 240,96,88
buffer_load_dwordx4 v8, s[8:11], s48 offen offset:0 lds
Mvaa 244,100,88
Mvaa 248,104,88
Mvaa 252,108,88
Maaa 128,112,88
buffer_load_dwordx4 v8, s[8:11], s49 offen offset:1024 lds
Maaa 132,116,88
Maaa 136,120,88
Maaa 140,124,88
Maaa 144,96,92
buffer_load_dwordx4 v9, s[8:11], s50 offen offset:2048 lds
Maaa 148,100,92
Maaa 152,104,92
Maaa 156,108,92
Maaa 160,112,92
buffer_load_dwordx4 v9, s[8:11], s51 offen offset:3072 lds
Maaa 164,116,92
v_add_u32 v8, 524288, v8
v_add_u32 v9, 524288, v9
Maaa 168,120,92
Maaa 172,124,92
s_waitcnt lgkmcnt(0)
Mvaa 48,32,0
Mvaa 52,36,0
Ta 96,22,16384
Ta 98,22,18432
Mvaa 56,40,0
Mvaa 60,44,0
Ra 64,21,0
Mvaa 64,48,0
Mvaa 68,52,0
Ta 100,23,16384
Ta 102,23,18432
Mvaa 72,56,0
Mvaa 76,60,0
s_waitcnt lgkmcnt(6)
Ra 68,21,2048
Mvaa 80,32,4
Mvaa 84,36,4
Ta 104,24,16384
Ta 106,24,18432
Mvaa 88,40,4
Mvaa 92,44,4
Ra 72,21,4096
Mvaa 96,48,4
Mvaa 100,52,4
Ta 108,25,16384
Ta 110,25,18432
Mvaa 104,56,4
Mvaa 108,60,4
s_waitcnt lgkmcnt(6)
Ra 76,21,6144
Mvaa 112,32,8
Mvaa 116,36,8
Ta 112,26,16384
Ta 114,26,18432
Mvaa 120,40,8
Mvaa 124,44,8
Ra 80,21,8192
Mvaa 128,48,8
Mvaa 132,52,8
Ta 116,27,16384
Ta 118,27,18432
Mvaa 136,56,8
Mvaa 140,60,8
s_waitcnt lgkmcnt(6)
Ra 84,21,10240
Mvaa 144,32,12
Mvaa 148,36,12
Ta 120,28,16384
Ta 122,28,18432
Mvaa 152,40,12
Mvaa 156,44,12
Ra 88,21,12288
Mvaa 160,48,12
Mvaa 164,52,12
Ta 124,29,16384
Ta 126,29,18432
Mvaa 168,56,12
Mvaa 172,60,12
s_waitcnt lgkmcnt(6)
Ra 92,21,14336
Mvaa 176,32,16
Mvaa 180,36,16
Mvaa 184,40,16
Mvaa 188,44,16
Mvaa 192,48,16
Mvaa 196,52,16
Mvaa 200,56,16
Mvaa 204,60,16
Mvaa 208,32,20
Mvaa 212,36,20
Mvaa 216,40,20
Mvaa 220,44,20
Mvaa 224,48,20
Mvaa 228,52,20
Mvaa 232,56,20
Mvaa 236,60,20
Mvaa 240,32,24
Mvaa 244,36,24
Mvaa 248,40,24
Mvaa 252,44,24
Maaa 128,48,24
Maaa 132,52,24
Maaa 136,56,24
Maaa 140,60,24
Maaa 144,32,28
Maaa 148,36,28
Maaa 152,40,28
Maaa 156,44,28
Maaa 160,48,28
Maaa 164,52,28
Maaa 168,56,28
Maaa 172,60,28
s_waitcnt vmcnt(12) lgkmcnt(0)
v_readfirstlane_b32 s3, v30
s_nop 0
s_or_b32 s3, s3, s37
s_cmp_lt_u32 s3, 256
s_cbranch_scc1 L_spinAk
L_spinArk:
s_barrier
Mvaa 48,96,64
buffer_load_dwordx4 a[0:3], v10, s[20:23], s58 offen offset:0 sc1
Mvaa 52,100,64
v_lshrrev_b32_e64 v42, 2, v33
v_lshl_add_u32 v43, v32, 3, v42
Mvaa 56,104,64
v_lshlrev_b32 v43, 8, v43
v_and_b32 v44, 3, v0
Mvaa 60,108,64
v_lshl_add_u32 v43, v44, 3, v43
v_and_b32_e64 v44, 1, v32
Mvaa 64,112,64
buffer_load_dwordx4 a[4:7], v10, s[20:23], 0 offen offset:0 sc1
Mvaa 68,116,64
v_lshl_add_u32 v42, v44, 2, v42
v_xor_b32_e64 v44, 0, v42
Mvaa 72,120,64
v_lshl_add_u32 v16, v44, 5, v43
v_xor_b32_e64 v44, 1, v42
Mvaa 76,124,64
v_lshl_add_u32 v17, v44, 5, v43
v_xor_b32_e64 v44, 2, v42
Mvaa 80,96,68
buffer_load_dwordx4 a[8:11], v11, s[20:23], s58 offen offset:0 sc1
Mvaa 84,100,68
v_lshl_add_u32 v18, v44, 5, v43
v_xor_b32_e64 v44, 3, v42
Mvaa 88,104,68
v_lshl_add_u32 v19, v44, 5, v43
v_xor_b32_e64 v44, 4, v42
Mvaa 92,108,68
v_lshl_add_u32 v20, v44, 5, v43
v_xor_b32_e64 v44, 5, v42
Mvaa 96,112,68
buffer_load_dwordx4 a[12:15], v11, s[20:23], 0 offen offset:0 sc1
Mvaa 100,116,68
v_lshl_add_u32 v21, v44, 5, v43
v_xor_b32_e64 v44, 6, v42
Mvaa 104,120,68
v_lshl_add_u32 v22, v44, 5, v43
v_xor_b32_e64 v44, 7, v42
Mvaa 108,124,68
v_lshl_add_u32 v23, v44, 5, v43
Mvaa 112,96,72
buffer_load_dwordx4 a[16:19], v10, s[20:23], s58 offen offset:1024 sc1
Mvaa 116,100,72
Mvaa 120,104,72
Mvaa 124,108,72
Mvaa 128,112,72
buffer_load_dwordx4 a[20:23], v10, s[20:23], 0 offen offset:1024 sc1
Mvaa 132,116,72
Ta 192,16,0
Ta 194,16,1024
Mvaa 136,120,72
Ta 196,17,0
Ta 198,17,1024
Mvaa 140,124,72
Ta 200,18,0
Ta 202,18,1024
Mvaa 144,96,76
buffer_load_dwordx4 a[24:27], v11, s[20:23], s58 offen offset:1024 sc1
Mvaa 148,100,76
Ta 204,19,0
Ta 206,19,1024
Mvaa 152,104,76
Ta 208,20,0
Ta 210,20,1024
Mvaa 156,108,76
Ta 212,21,0
Ta 214,21,1024
Mvaa 160,112,76
buffer_load_dwordx4 a[28:31], v11, s[20:23], 0 offen offset:1024 sc1
Mvaa 164,116,76
Ta 216,22,0
Ta 218,22,1024
Mvaa 168,120,76
Ta 220,23,0
s_waitcnt lgkmcnt(9)
Ta 222,23,1024
Mvaa 172,124,76
s_waitcnt lgkmcnt(8)
Vc 24,48,49
Vc 25,50,51
Mvaa 176,96,80
buffer_load_dwordx4 a[32:35], v10, s[20:23], s58 offen offset:2048 sc1
Mvaa 180,100,80
Vc 26,52,53
Vc 27,54,55
Mvaa 184,104,80
Vc 28,56,57
Vc 29,58,59
Mvaa 188,108,80
Vc 30,60,61
Vc 31,62,63
Mvaa 192,112,80
buffer_load_dwordx4 a[36:39], v10, s[20:23], 0 offen offset:2048 sc1
Mvaa 196,116,80
Vc 32,64,65
Vc 33,66,67
Mvaa 200,120,80
Vc 34,68,69
Vc 35,70,71
Mvaa 204,124,80
Vc 36,72,73
Vc 37,74,75
Mvaa 208,96,84
buffer_load_dwordx4 a[40:43], v11, s[20:23], s58 offen offset:2048 sc1
Mvaa 212,100,84
Vc 38,76,77
Vc 39,78,79
Mvaa 216,104,84
Vc 40,80,81
Vc 41,82,83
Mvaa 220,108,84
Vc 42,84,85
Vc 43,86,87
Mvaa 224,112,84
buffer_load_dwordx4 a[44:47], v11, s[20:23], 0 offen offset:2048 sc1
Mvaa 228,116,84
Vc 44,88,89
Vc 45,90,91
Mvaa 232,120,84
Vc 46,92,93
Vc 47,94,95
Mvaa 236,124,84
Vc 48,96,97
Vc 49,98,99
Mvaa 240,96,88
buffer_load_dwordx4 a[48:51], v10, s[20:23], s58 offen offset:3072 sc1
Mvaa 244,100,88
Vc 50,100,101
Vc 51,102,103
Mvaa 248,104,88
Vc 52,104,105
Vc 53,106,107
Mvaa 252,108,88
Vc 54,108,109
Vc 55,110,111
Maaa 128,112,88
buffer_load_dwordx4 a[52:55], v10, s[20:23], 0 offen offset:3072 sc1
Maaa 132,116,88
Vc 56,112,113
Vc 57,114,115
Maaa 136,120,88
Vc 58,116,117
Vc 59,118,119
Maaa 140,124,88
Vc 60,120,121
Vc 61,122,123
Maaa 144,96,92
buffer_load_dwordx4 a[56:59], v11, s[20:23], s58 offen offset:3072 sc1
Maaa 148,100,92
Vc 62,124,125
Vc 63,126,127
Maaa 152,104,92
Vc 64,128,129
Vc 65,130,131
Maaa 156,108,92
Vc 66,132,133
Vc 67,134,135
Maaa 160,112,92
buffer_load_dwordx4 a[60:63], v11, s[20:23], 0 offen offset:3072 sc1
Maaa 164,116,92
v_add_u32 v10, 4096, v10
v_add_u32 v11, 4096, v11
Maaa 168,120,92
Vc 68,136,137
Vc 69,138,139
Maaa 172,124,92
Vc 70,140,141
Vc 71,142,143
Vc 72,144,145
Vc 73,146,147
Vc 74,148,149
Vc 75,150,151
Vc 76,152,153
Vc 77,154,155
Vc 78,156,157
Vc 79,158,159
Vc 80,160,161
Vc 81,162,163
Vc 82,164,165
Vc 83,166,167
Vc 84,168,169
Vc 85,170,171
Vc 86,172,173
Vc 87,174,175
Vc 88,176,177
Vc 89,178,179
Vc 90,180,181
Vc 91,182,183
Vc 92,184,185
Vc 93,186,187
Vc 94,188,189
Vc 95,190,191
Vc 96,192,193
Vc 97,194,195
Vc 98,196,197
Vc 99,198,199
Vc 100,200,201
Vc 101,202,203
Vc 102,204,205
Vc 103,206,207
Vc 104,208,209
Vc 105,210,211
Vc 106,212,213
Vc 107,214,215
Vc 108,216,217
Vc 109,218,219
Vc 110,220,221
Vc 111,222,223
Vc 112,224,225
Vc 113,226,227
Vc 114,228,229
Vc 115,230,231
Vc 116,232,233
Vc 117,234,235
Vc 118,236,237
Vc 119,238,239
Vc 120,240,241
Vc 121,242,243
Vc 122,244,245
Vc 123,246,247
Vc 124,248,249
Vc 125,250,251
Vc 126,252,253
Vc 127,254,255
s_branch L_phase2
L_k1_vpath:
s_waitcnt lgkmcnt(0)
s_add_u32 m0, s57, 65536
Zvaa 48,0,32
buffer_load_dwordx4 v6, s[12:15], s52 offen offset:0 nt lds
Zvaa 64,0,36
Ta 96,12,16384
Ta 98,12,18432
Zvaa 80,0,40
buffer_load_dwordx4 v7, s[12:15], s53 offen offset:1024 nt lds
Zvaa 96,0,44
Ra 64,11,0
Zvaa 112,0,48
buffer_load_dwordx4 v6, s[12:15], s54 offen offset:2048 nt lds
Zvaa 128,0,52
Ta 100,13,16384
Ta 102,13,18432
Zvaa 144,0,56
buffer_load_dwordx4 v7, s[12:15], s55 offen offset:3072 nt lds
Zvaa 160,0,60
s_add_u32 m0, s57, 69632
s_waitcnt lgkmcnt(6)
Ra 68,11,2048
Zvaa 52,4,32
buffer_load_dwordx4 v8, s[12:15], s52 offen offset:0 nt lds
Zvaa 68,4,36
Ta 104,14,16384
Ta 106,14,18432
Zvaa 84,4,40
buffer_load_dwordx4 v9, s[12:15], s53 offen offset:1024 nt lds
Zvaa 100,4,44
Ra 72,11,4096
Zvaa 116,4,48
buffer_load_dwordx4 v8, s[12:15], s54 offen offset:2048 nt lds
Zvaa 132,4,52
Ta 108,15,16384
Ta 110,15,18432
Zvaa 148,4,56
buffer_load_dwordx4 v9, s[12:15], s55 offen offset:3072 nt lds
Zvaa 164,4,60
s_add_u32 m0, s56, 65536
s_waitcnt lgkmcnt(6)
Ra 76,11,6144
Zvaa 56,8,32
buffer_load_dwordx4 v2, s[8:11], s48 offen offset:0 lds
Zvaa 72,8,36
Ta 112,16,16384
Ta 114,16,18432
Zvaa 88,8,40
buffer_load_dwordx4 v3, s[8:11], s49 offen offset:1024 lds
Zvaa 104,8,44
Ra 80,11,8192
v_xor_b32 v6, 1572864, v6
Zvaa 120,8,48
buffer_load_dwordx4 v2, s[8:11], s50 offen offset:2048 lds
Zvaa 136,8,52
Ta 116,17,16384
Ta 118,17,18432
Zvaa 152,8,56
buffer_load_dwordx4 v3, s[8:11], s51 offen offset:3072 lds
Zvaa 168,8,60
s_add_u32 m0, s56, 69632
s_waitcnt lgkmcnt(6)
Ra 84,11,10240
Zvaa 60,12,32
buffer_load_dwordx4 v4, s[8:11], s48 offen offset:0 lds
Zvaa 76,12,36
Ta 120,18,16384
Ta 122,18,18432
Zvaa 92,12,40
buffer_load_dwordx4 v5, s[8:11], s49 offen offset:1024 lds
Zvaa 108,12,44
Ra 88,11,12288
v_xor_b32 v7, 1572864, v7
Zvaa 124,12,48
buffer_load_dwordx4 v4, s[8:11], s50 offen offset:2048 lds
Zvaa 140,12,52
Ta 124,19,16384
Ta 126,19,18432
Zvaa 156,12,56
buffer_load_dwordx4 v5, s[8:11], s51 offen offset:3072 lds
Zvaa 172,12,60
s_waitcnt lgkmcnt(6)
Ra 92,11,14336
Zvaa 176,16,32
v_and_b32_e64 v46, 7, v0
v_mul_u32_u24 v30, 2064, v46
Zvaa 192,16,36
v_xor_b32 v8, 1572864, v8
v_xor_b32 v9, 1572864, v9
Zvaa 208,16,40
v_lshrrev_b32_e64 v31, 3, v0
Zvaa 224,16,44
v_xor_b32 v2, 384, v2
v_xor_b32 v3, 384, v3
Zvaa 240,16,48
s_lshl_b32 s3, s32, 9
s_add_u32 s3, s3, 131072
v_lshl_add_u32 v30, v31, 4, v30
Zaaa 128,16,52
v_xor_b32 v4, 384, v4
v_xor_b32 v5, 384, v5
Zaaa 144,16,56
v_add_u32 v30, s3, v30
v_lshlrev_b32_e64 v31, 8, v31
Zaaa 160,16,60
v_lshl_add_u32 v46, v46, 4, v31
Zvaa 180,20,32
buffer_load_dword v1, v47, s[60:63], 0 offen
Zvaa 196,20,36
s_mul_i32 vcc_lo, s59, 7
v_xor_b32 v47, vcc_lo, v47
Zvaa 212,20,40
Rv 34,30,128
Rv 38,30,256
Zvaa 228,20,44
Rv 42,30,384
Rv 30,30,0
Zvaa 244,20,48
buffer_load_dword v1, v47, s[60:63], 0 offen
Zaaa 132,20,52
s_mul_i32 vcc_lo, s59, 1
v_xor_b32 v47, vcc_lo, v47
Zaaa 148,20,56
s_lshr_b32 s3, s2, 1
s_mul_i32 s3, s3, 33792
s_add_u32 s3, s3, s56
Zaaa 164,20,60
s_and_b32 s39, s2, 1
s_lshl_b32 s39, s39, 7
s_add_u32 s3, s3, s39
Zvaa 184,24,32
s_add_u32 s39, s3, 4096
Zvaa 200,24,36
Zvaa 216,24,40
Zvaa 232,24,44
Zvaa 248,24,48
Zaaa 136,24,52
Zaaa 152,24,56
Zaaa 168,24,60
Zvaa 188,28,32
Zvaa 204,28,36
Zvaa 220,28,40
Zvaa 236,28,44
Zvaa 252,28,48
Zaaa 140,28,52
Zaaa 156,28,56
Zaaa 172,28,60
s_waitcnt vmcnt(2) lgkmcnt(0)
s_add_u32 m0, s57, 0
s_barrier
Mvaa 48,64,96
buffer_load_dwordx4 v6, s[12:15], s52 offen offset:0 nt lds
Mvaa 64,64,100
Ta 32,22,0
Ta 34,22,2048
Mvaa 80,64,104
Mvaa 96,64,108
Ra 0,20,0
Mvaa 112,64,112
buffer_load_dwordx4 v7, s[12:15], s53 offen offset:1024 nt lds
Mvaa 128,64,116
s_waitcnt lgkmcnt(6)
Ta 36,23,0
Ta 38,23,2048
Mvaa 144,64,120
Mvaa 160,64,124
Ra 4,20,2048
Mvaa 52,68,96
buffer_load_dwordx4 v6, s[12:15], s54 offen offset:2048 nt lds
Mvaa 68,68,100
Ta 40,24,0
Ta 42,24,2048
Mvaa 84,68,104
Mvaa 100,68,108
Ra 8,20,4096
Mvaa 116,68,112
buffer_load_dwordx4 v7, s[12:15], s55 offen offset:3072 nt lds
Mvaa 132,68,116
s_waitcnt lgkmcnt(6)
Ta 44,25,0
Ta 46,25,2048
Mvaa 148,68,120
Mvaa 164,68,124
s_add_u32 m0, s57, 4096
Ra 12,20,6144
Mvaa 56,72,96
buffer_load_dwordx4 v8, s[12:15], s52 offen offset:0 nt lds
Mvaa 72,72,100
Ta 48,26,0
Ta 50,26,2048
Mvaa 88,72,104
Mvaa 104,72,108
Ra 16,20,8192
Mvaa 120,72,112
buffer_load_dwordx4 v9, s[12:15], s53 offen offset:1024 nt lds
Mvaa 136,72,116
s_waitcnt lgkmcnt(6)
Ta 52,27,0
Ta 54,27,2048
Mvaa 152,72,120
Mvaa 168,72,124
Ra 20,20,10240
Mvaa 60,76,96
buffer_load_dwordx4 v8, s[12:15], s54 offen offset:2048 nt lds
Mvaa 76,76,100
Ta 56,28,0
Ta 58,28,2048
Mvaa 92,76,104
Mvaa 108,76,108
Ra 24,20,12288
Mvaa 124,76,112
buffer_load_dwordx4 v9, s[12:15], s55 offen offset:3072 nt lds
Mvaa 140,76,116
s_waitcnt lgkmcnt(6)
Ta 60,29,0
Ta 62,29,2048
Mvaa 156,76,120
v_xor_b32 v6, 524288, v6
v_xor_b32 v7, 524288, v7
Mvaa 172,76,124
s_add_u32 m0, s56, 0
Ra 28,20,14336
v_xor_b32 v8, 524288, v8
Mvaa 176,80,96
buffer_load_dwordx4 v2, s[8:11], s48 offen offset:0 lds
Mvaa 192,80,100
v_xor_b32 v9, 524288, v9
Mvaa 208,80,104
Mvaa 224,80,108
Mvaa 240,80,112
buffer_load_dwordx4 v3, s[8:11], s49 offen offset:1024 lds
Maaa 128,80,116
Maaa 144,80,120
Maaa 160,80,124
Mvaa 180,84,96
buffer_load_dwordx4 v2, s[8:11], s50 offen offset:2048 lds
Mvaa 196,84,100
Mvaa 212,84,104
Mvaa 228,84,108
Mvaa 244,84,112
buffer_load_dwordx4 v3, s[8:11], s51 offen offset:3072 lds
Maaa 132,84,116
Maaa 148,84,120
Maaa 164,84,124
s_add_u32 m0, s56, 4096
Mvaa 184,88,96
buffer_load_dwordx4 v4, s[8:11], s48 offen offset:0 lds
Mvaa 200,88,100
Mvaa 216,88,104
Mvaa 232,88,108
Mvaa 248,88,112
buffer_load_dwordx4 v5, s[8:11], s49 offen offset:1024 lds
Maaa 136,88,116
Maaa 152,88,120
Maaa 168,88,124
Mvaa 188,92,96
buffer_load_dwordx4 v4, s[8:11], s50 offen offset:2048 lds
Mvaa 204,92,100
Mvaa 220,92,104
Mvaa 236,92,108
Mvaa 252,92,112
buffer_load_dwordx4 v5, s[8:11], s51 offen offset:3072 lds
Maaa 140,92,116
v_xor_b32 v2, 128, v2
v_xor_b32 v3, 128, v3
Maaa 156,92,120
buffer_load_dword v1, v47, s[60:63], 0 offen
v_xor_b32 v4, 128, v4
v_xor_b32 v5, 128, v5
Maaa 172,92,124
s_mul_i32 vcc_lo, s59, 3
v_xor_b32 v47, vcc_lo, v47
s_waitcnt lgkmcnt(0)
Mvaa 48,0,32
buffer_store_dwordx4 v[30:33], v46, s[20:23], s3 offen offset:0 sc1
Mvaa 64,0,36
Ta 96,22,16384
Ta 98,22,18432
Mvaa 80,0,40
buffer_store_dwordx4 v[34:37], v46, s[20:23], s3 offen offset:2048 sc1
Mvaa 96,0,44
Ra 64,21,0
Mvaa 112,0,48
buffer_store_dwordx4 v[38:41], v46, s[20:23], s39 offen offset:0 sc1
Mvaa 128,0,52
Ta 100,23,16384
Ta 102,23,18432
Mvaa 144,0,56
buffer_store_dwordx4 v[42:45], v46, s[20:23], s39 offen offset:2048 sc1
Mvaa 160,0,60
s_waitcnt lgkmcnt(6)
Ra 68,21,2048
Mvaa 52,4,32
s_lshl_b32 s3, s34, 1
s_and_b32 s36, s32, 1
s_add_u32 s3, s3, s36
Mvaa 68,4,36
Ta 104,24,16384
Ta 106,24,18432
Mvaa 84,4,40
s_mul_i32 s3, s3, 1116160
s_mul_i32 s36, s33, 139264
s_add_u32 s3, s3, s36
Mvaa 100,4,44
Ra 72,21,4096
Mvaa 116,4,48
s_lshr_b32 s36, s32, 1
s_mul_i32 s36, s36, 69632
s_add_u32 s3, s3, s36
Mvaa 132,4,52
Ta 108,25,16384
Ta 110,25,18432
Mvaa 148,4,56
s_add_u32 s38, s3, 17408
s_lshl_b32 s39, s34, 7
s_lshl_b32 s36, s33, 2
Mvaa 164,4,60
s_waitcnt lgkmcnt(6)
Ra 76,21,6144
Mvaa 56,8,32
s_add_u32 s39, s39, s36
s_add_u32 s39, s39, 5296160
v_mov_b32 v30, 1
Mvaa 72,8,36
Ta 112,26,16384
Ta 114,26,18432
Mvaa 88,8,40
v_mov_b32_e64 v31, 0
Mvaa 104,8,44
Ra 80,21,8192
Mvaa 120,8,48
s_cmp_eq_u32 s32, 0
s_cselect_b32 s39, s39, 2146435072
Mvaa 136,8,52
Ta 116,27,16384
Ta 118,27,18432
Mvaa 152,8,56
s_mov_b64 exec, 1
buffer_store_dword v31, v31, s[20:23], s39 offen sc1
s_mov_b64 exec, -1
Mvaa 168,8,60
s_waitcnt lgkmcnt(6)
Ra 84,21,10240
Mvaa 60,12,32
s_and_b32 s33, s2, 7
s_lshl_b32 s33, s33, 2
s_bfe_u32 s3, s2, 0x20003
Mvaa 76,12,36
Ta 120,28,16384
Ta 122,28,18432
Mvaa 92,12,40
s_add_u32 s33, s33, s3
s_lshr_b32 s34, s2, 5
s_lshl_b32 s64, s34, 7
Mvaa 108,12,44
Ra 88,21,12288
Mvaa 124,12,48
s_lshl_b32 s3, s33, 2
s_add_u32 s64, s64, s3
s_add_u32 s64, s64, 5300224
Mvaa 140,12,52
Ta 124,29,16384
Ta 126,29,18432
Mvaa 156,12,56
s_lshl_b32 s65, s34, 8
s_sub_u32 s65, 1920, s65
v_mul_u32_u24_e64 v32, s65, v0
Mvaa 172,12,60
s_waitcnt lgkmcnt(6)
Ra 92,21,14336
Mvaa 176,16,32
s_cmp_eq_u32 s32, 0
s_cselect_b32 s64, s64, 2146435072
Mvaa 192,16,36
s_mov_b64 exec, 3
buffer_store_dword v31, v32, s[20:23], s64 offen sc1
s_mov_b64 exec, -1
Mvaa 208,16,40
s_lshl_b32 s3, s2, 2
s_add_u32 s3, s3, 5447680
v_lshlrev_b32 v32, 10, v0
Mvaa 224,16,44
s_cmp_eq_u32 s32, 0
s_cselect_b32 s3, s3, 2146435072
Mvaa 240,16,48
s_mov_b64 exec, 0x1ff
buffer_store_dword v31, v32, s[20:23], s3 offen sc1
s_mov_b64 exec, -1
Maaa 128,16,52
s_lshl_b32 s35, s34, 1
s_sub_u32 s36, 32, s35
s_add_u32 s35, s35, 2
Maaa 144,16,56
s_lshl_b32 s44, s32, 12
s_lshl_b32 s58, s32, 1
s_sub_u32 s58, 7, s58
Maaa 160,16,60
s_mul_i32 s58, s58, 33792
s_sub_u32 s3, 15, s34
s_lshl_b32 s45, s3, 3
Mvaa 180,20,32
s_add_u32 s45, s45, s32
s_lshl_b32 s46, s34, 3
s_add_u32 s46, s46, s32
Mvaa 196,20,36
s_mov_b32 s68, s42
s_and_b32 s69, s43, 0xffff
s_mov_b32 s70, 7340032
Mvaa 212,20,40
s_mov_b32 s71, 0x20000
s_cmp_eq_u32 s32, 0
s_cselect_b32 s37, 0, 2146435072
Mvaa 228,20,44
s_lshl_b32 s3, s33, 8
s_add_u32 s16, s4, s3
s_addc_u32 s17, s5, 0
s_and_b32 s17, s17, 0xffff
Mvaa 244,20,48
s_mov_b32 s18, 0
s_mov_b32 s19, 0x20000
s_sub_u32 s18, 8388608, s3
Maaa 132,20,52
v_and_b32 v33, 15, v0
v_lshrrev_b32_e64 v32, 1, v33
Maaa 148,20,56
v_and_b32 v33, 1, v0
v_lshlrev_b32 v32, 13, v32
Maaa 164,20,60
v_lshl_add_u32 v45, v33, 7, v32
Mvaa 184,24,32
s_lshl_b32 s3, s32, 3
s_add_u32 s3, s3, s34
s_mul_i32 s47, s3, 65536
Mvaa 200,24,36
s_bfe_u32 s6, s2, 131075
s_lshl_b32 s3, s32, 8
s_or_b32 s6, s6, s3
Mvaa 216,24,40
Mvaa 232,24,44
Mvaa 248,24,48
Maaa 136,24,52
Maaa 152,24,56
Maaa 168,24,60
Mvaa 188,28,32
Mvaa 204,28,36
Mvaa 220,28,40
Mvaa 236,28,44
Mvaa 252,28,48
Maaa 140,28,52
Maaa 156,28,56
Maaa 172,28,60
s_waitcnt vmcnt(8) lgkmcnt(0)
s_add_u32 m0, s57, 65536
s_barrier
Mvaa 48,64,96
buffer_load_dwordx4 v6, s[12:15], s52 offen offset:0 nt lds
Mvaa 64,64,100
Ta 32,12,0
Ta 34,12,2048
Mvaa 80,64,104
Mvaa 96,64,108
Ra 0,10,0
Mvaa 112,64,112
buffer_load_dwordx4 v7, s[12:15], s53 offen offset:1024 nt lds
Mvaa 128,64,116
s_waitcnt lgkmcnt(6)
Ta 36,13,0
Ta 38,13,2048
Mvaa 144,64,120
Mvaa 160,64,124
Ra 4,10,2048
Mvaa 52,68,96
buffer_load_dwordx4 v6, s[12:15], s54 offen offset:2048 nt lds
Mvaa 68,68,100
Ta 40,14,0
Ta 42,14,2048
Mvaa 84,68,104
Mvaa 100,68,108
Ra 8,10,4096
Mvaa 116,68,112
buffer_load_dwordx4 v7, s[12:15], s55 offen offset:3072 nt lds
Mvaa 132,68,116
s_waitcnt lgkmcnt(6)
Ta 44,15,0
Ta 46,15,2048
Mvaa 148,68,120
Mvaa 164,68,124
s_add_u32 m0, s57, 69632
Ra 12,10,6144
Mvaa 56,72,96
buffer_load_dwordx4 v8, s[12:15], s52 offen offset:0 nt lds
Mvaa 72,72,100
Ta 48,16,0
Ta 50,16,2048
Mvaa 88,72,104
Mvaa 104,72,108
Ra 16,10,8192
Mvaa 120,72,112
buffer_load_dwordx4 v9, s[12:15], s53 offen offset:1024 nt lds
Mvaa 136,72,116
s_waitcnt lgkmcnt(6)
Ta 52,17,0
Ta 54,17,2048
Mvaa 152,72,120
Mvaa 168,72,124
Ra 20,10,10240
Mvaa 60,76,96
buffer_load_dwordx4 v8, s[12:15], s54 offen offset:2048 nt lds
Mvaa 76,76,100
Ta 56,18,0
Ta 58,18,2048
Mvaa 92,76,104
Mvaa 108,76,108
Ra 24,10,12288
Mvaa 124,76,112
buffer_load_dwordx4 v9, s[12:15], s55 offen offset:3072 nt lds
Mvaa 140,76,116
s_waitcnt lgkmcnt(6)
Ta 60,19,0
Ta 62,19,2048
Mvaa 156,76,120
v_xor_b32 v6, 3670016, v6
v_xor_b32 v7, 3670016, v7
Mvaa 172,76,124
s_add_u32 m0, s56, 65536
Ra 28,10,14336
v_xor_b32 v8, 3670016, v8
Mvaa 176,80,96
buffer_load_dwordx4 v2, s[8:11], s48 offen offset:0 lds
Mvaa 192,80,100
v_xor_b32 v9, 3670016, v9
Mvaa 208,80,104
Mvaa 224,80,108
Mvaa 240,80,112
buffer_load_dwordx4 v3, s[8:11], s49 offen offset:1024 lds
Maaa 128,80,116
Maaa 144,80,120
Maaa 160,80,124
Mvaa 180,84,96
buffer_load_dwordx4 v2, s[8:11], s50 offen offset:2048 lds
Mvaa 196,84,100
Mvaa 212,84,104
Mvaa 228,84,108
Mvaa 244,84,112
buffer_load_dwordx4 v3, s[8:11], s51 offen offset:3072 lds
Maaa 132,84,116
Maaa 148,84,120
Maaa 164,84,124
s_add_u32 m0, s56, 69632
Mvaa 184,88,96
buffer_load_dwordx4 v4, s[8:11], s48 offen offset:0 lds
Mvaa 200,88,100
Mvaa 216,88,104
Mvaa 232,88,108
Mvaa 248,88,112
buffer_load_dwordx4 v5, s[8:11], s49 offen offset:1024 lds
Maaa 136,88,116
Maaa 152,88,120
Maaa 168,88,124
Mvaa 188,92,96
buffer_load_dwordx4 v4, s[8:11], s50 offen offset:2048 lds
Mvaa 204,92,100
Mvaa 220,92,104
Mvaa 236,92,108
Mvaa 252,92,112
buffer_load_dwordx4 v5, s[8:11], s51 offen offset:3072 lds
Maaa 140,92,116
v_xor_b32 v2, 896, v2
v_xor_b32 v3, 896, v3
Maaa 156,92,120
buffer_load_dword v1, v47, s[60:63], 0 offen
v_xor_b32 v4, 896, v4
v_xor_b32 v5, 896, v5
Maaa 172,92,124
s_mul_i32 vcc_lo, s59, 1
v_xor_b32 v47, vcc_lo, v47
s_waitcnt lgkmcnt(0)
Mvaa 48,0,32
Mvaa 64,0,36
Ta 96,12,16384
Ta 98,12,18432
Mvaa 80,0,40
Mvaa 96,0,44
Ra 64,11,0
Mvaa 112,0,48
Mvaa 128,0,52
Ta 100,13,16384
Ta 102,13,18432
Mvaa 144,0,56
Mvaa 160,0,60
s_waitcnt lgkmcnt(6)
Ra 68,11,2048
Mvaa 52,4,32
Mvaa 68,4,36
Ta 104,14,16384
Ta 106,14,18432
Mvaa 84,4,40
Mvaa 100,4,44
Ra 72,11,4096
Mvaa 116,4,48
Mvaa 132,4,52
Ta 108,15,16384
Ta 110,15,18432
Mvaa 148,4,56
Mvaa 164,4,60
s_waitcnt lgkmcnt(6)
Ra 76,11,6144
Mvaa 56,8,32
Mvaa 72,8,36
Ta 112,16,16384
Ta 114,16,18432
Mvaa 88,8,40
Mvaa 104,8,44
Ra 80,11,8192
Mvaa 120,8,48
Mvaa 136,8,52
Ta 116,17,16384
Ta 118,17,18432
Mvaa 152,8,56
Mvaa 168,8,60
s_waitcnt lgkmcnt(6)
Ra 84,11,10240
Mvaa 60,12,32
Mvaa 76,12,36
Ta 120,18,16384
Ta 122,18,18432
Mvaa 92,12,40
Mvaa 108,12,44
Ra 88,11,12288
Mvaa 124,12,48
Mvaa 140,12,52
Ta 124,19,16384
Ta 126,19,18432
Mvaa 156,12,56
Mvaa 172,12,60
s_waitcnt lgkmcnt(6)
Ra 92,11,14336
Mvaa 176,16,32
Mvaa 192,16,36
Mvaa 208,16,40
Mvaa 224,16,44
Mvaa 240,16,48
Maaa 128,16,52
Maaa 144,16,56
Maaa 160,16,60
Mvaa 180,20,32
Mvaa 196,20,36
Mvaa 212,20,40
Mvaa 228,20,44
Mvaa 244,20,48
Maaa 132,20,52
Maaa 148,20,56
Maaa 164,20,60
Mvaa 184,24,32
Mvaa 200,24,36
Mvaa 216,24,40
Mvaa 232,24,44
Mvaa 248,24,48
Maaa 136,24,52
Maaa 152,24,56
Maaa 168,24,60
Mvaa 188,28,32
Mvaa 204,28,36
Mvaa 220,28,40
Mvaa 236,28,44
Mvaa 252,28,48
Maaa 140,28,52
Maaa 156,28,56
Maaa 172,28,60
s_waitcnt vmcnt(1) lgkmcnt(0)
s_add_u32 m0, s57, 0
s_barrier
Mvaa 48,64,96
buffer_load_dwordx4 v6, s[12:15], s52 offen offset:0 nt lds
Mvaa 64,64,100
Ta 32,22,0
Ta 34,22,2048
Mvaa 80,64,104
Mvaa 96,64,108
Ra 0,20,0
Mvaa 112,64,112
buffer_load_dwordx4 v7, s[12:15], s53 offen offset:1024 nt lds
Mvaa 128,64,116
s_waitcnt lgkmcnt(6)
Ta 36,23,0
Ta 38,23,2048
Mvaa 144,64,120
Mvaa 160,64,124
Ra 4,20,2048
Mvaa 52,68,96
buffer_load_dwordx4 v6, s[12:15], s54 offen offset:2048 nt lds
Mvaa 68,68,100
Ta 40,24,0
Ta 42,24,2048
Mvaa 84,68,104
Mvaa 100,68,108
Ra 8,20,4096
Mvaa 116,68,112
buffer_load_dwordx4 v7, s[12:15], s55 offen offset:3072 nt lds
Mvaa 132,68,116
s_waitcnt lgkmcnt(6)
Ta 44,25,0
Ta 46,25,2048
Mvaa 148,68,120
s_cmp_eq_u32 s6, 0
s_cselect_b32 s3, 0, 2146435072
Mvaa 164,68,124
s_add_u32 m0, s57, 4096
Ra 12,20,6144
Mvaa 56,72,96
buffer_load_dwordx4 v8, s[12:15], s52 offen offset:0 nt lds
Mvaa 72,72,100
Ta 48,26,0
Ta 50,26,2048
Mvaa 88,72,104
s_mov_b64 exec, 1
buffer_atomic_add v30, v31, s[28:31], s3 offen sc1
s_mov_b64 exec, -1
Mvaa 104,72,108
Ra 16,20,8192
Mvaa 120,72,112
buffer_load_dwordx4 v9, s[12:15], s53 offen offset:1024 nt lds
Mvaa 136,72,116
s_waitcnt lgkmcnt(6)
Ta 52,27,0
Ta 54,27,2048
Mvaa 152,72,120
Mvaa 168,72,124
Ra 20,20,10240
Mvaa 60,76,96
buffer_load_dwordx4 v8, s[12:15], s54 offen offset:2048 nt lds
Mvaa 76,76,100
Ta 56,28,0
Ta 58,28,2048
Mvaa 92,76,104
Mvaa 108,76,108
Ra 24,20,12288
Mvaa 124,76,112
buffer_load_dwordx4 v9, s[12:15], s55 offen offset:3072 nt lds
Mvaa 140,76,116
s_waitcnt lgkmcnt(6)
Ta 60,29,0
Ta 62,29,2048
Mvaa 156,76,120
v_xor_b32 v6, 524288, v6
v_xor_b32 v7, 524288, v7
Mvaa 172,76,124
s_add_u32 m0, s56, 0
Ra 28,20,14336
v_xor_b32 v8, 524288, v8
Mvaa 176,80,96
buffer_load_dwordx4 v2, s[8:11], s48 offen offset:0 lds
Mvaa 192,80,100
v_xor_b32 v9, 524288, v9
Mvaa 208,80,104
Mvaa 224,80,108
Mvaa 240,80,112
buffer_load_dwordx4 v3, s[8:11], s49 offen offset:1024 lds
Maaa 128,80,116
Maaa 144,80,120
Maaa 160,80,124
Mvaa 180,84,96
buffer_load_dwordx4 v2, s[8:11], s50 offen offset:2048 lds
Mvaa 196,84,100
Mvaa 212,84,104
Mvaa 228,84,108
Mvaa 244,84,112
buffer_load_dwordx4 v3, s[8:11], s51 offen offset:3072 lds
Maaa 132,84,116
Maaa 148,84,120
Maaa 164,84,124
s_add_u32 m0, s56, 4096
Mvaa 184,88,96
buffer_load_dwordx4 v4, s[8:11], s48 offen offset:0 lds
Mvaa 200,88,100
Mvaa 216,88,104
Mvaa 232,88,108
Mvaa 248,88,112
buffer_load_dwordx4 v5, s[8:11], s49 offen offset:1024 lds
Maaa 136,88,116
Maaa 152,88,120
Maaa 168,88,124
Mvaa 188,92,96
buffer_load_dwordx4 v4, s[8:11], s50 offen offset:2048 lds
Mvaa 204,92,100
Mvaa 220,92,104
Mvaa 236,92,108
Mvaa 252,92,112
buffer_load_dwordx4 v5, s[8:11], s51 offen offset:3072 lds
Maaa 140,92,116
v_xor_b32 v2, 128, v2
v_xor_b32 v3, 128, v3
Maaa 156,92,120
buffer_load_dword v1, v47, s[60:63], 0 offen
v_xor_b32 v4, 128, v4
v_xor_b32 v5, 128, v5
Maaa 172,92,124
s_mul_i32 vcc_lo, s59, 7
v_xor_b32 v47, vcc_lo, v47
s_waitcnt lgkmcnt(0)
Mvaa 48,0,32
buffer_load_dword v44, v45, s[16:19], s47 offen
Mvaa 64,0,36
Ta 96,22,16384
Ta 98,22,18432
Mvaa 80,0,40
s_add_u32 s47, s47, 2097152
Mvaa 96,0,44
Ra 64,21,0
Mvaa 112,0,48
Mvaa 128,0,52
Ta 100,23,16384
Ta 102,23,18432
Mvaa 144,0,56
Mvaa 160,0,60
s_waitcnt lgkmcnt(6)
Ra 68,21,2048
Mvaa 52,4,32
Mvaa 68,4,36
Ta 104,24,16384
Ta 106,24,18432
Mvaa 84,4,40
Mvaa 100,4,44
Ra 72,21,4096
Mvaa 116,4,48
Mvaa 132,4,52
Ta 108,25,16384
Ta 110,25,18432
Mvaa 148,4,56
Mvaa 164,4,60
s_waitcnt lgkmcnt(6)
Ra 76,21,6144
Mvaa 56,8,32
Mvaa 72,8,36
Ta 112,26,16384
Ta 114,26,18432
Mvaa 88,8,40
Mvaa 104,8,44
Ra 80,21,8192
Mvaa 120,8,48
Mvaa 136,8,52
Ta 116,27,16384
Ta 118,27,18432
Mvaa 152,8,56
Mvaa 168,8,60
s_waitcnt lgkmcnt(6)
Ra 84,21,10240
Mvaa 60,12,32
Mvaa 76,12,36
Ta 120,28,16384
Ta 122,28,18432
Mvaa 92,12,40
s_cmp_eq_u32 s6, 1
s_cselect_b32 s3, 0, 2146435072
Mvaa 108,12,44
Ra 88,21,12288
Mvaa 124,12,48
s_mov_b64 exec, 1
buffer_atomic_add v30, v31, s[28:31], s3 offen sc1
s_mov_b64 exec, -1
Mvaa 140,12,52
Ta 124,29,16384
Ta 126,29,18432
Mvaa 156,12,56
Mvaa 172,12,60
s_waitcnt lgkmcnt(6)
Ra 92,21,14336
Mvaa 176,16,32
Mvaa 192,16,36
Mvaa 208,16,40
Mvaa 224,16,44
Mvaa 240,16,48
Maaa 128,16,52
Maaa 144,16,56
Maaa 160,16,60
Mvaa 180,20,32
Mvaa 196,20,36
Mvaa 212,20,40
Mvaa 228,20,44
Mvaa 244,20,48
Maaa 132,20,52
Maaa 148,20,56
Maaa 164,20,60
Mvaa 184,24,32
Mvaa 200,24,36
Mvaa 216,24,40
Mvaa 232,24,44
Mvaa 248,24,48
Maaa 136,24,52
Maaa 152,24,56
Maaa 168,24,60
Mvaa 188,28,32
Mvaa 204,28,36
Mvaa 220,28,40
Mvaa 236,28,44
Mvaa 252,28,48
Maaa 140,28,52
Maaa 156,28,56
Maaa 172,28,60
s_waitcnt vmcnt(3) lgkmcnt(0)
s_add_u32 m0, s57, 65536
s_barrier
Mvaa 48,64,96
buffer_load_dwordx4 v6, s[12:15], s52 offen offset:0 nt lds
Mvaa 64,64,100
Ta 32,12,0
Ta 34,12,2048
Mvaa 80,64,104
Mvaa 96,64,108
Ra 0,10,0
Mvaa 112,64,112
buffer_load_dwordx4 v7, s[12:15], s53 offen offset:1024 nt lds
Mvaa 128,64,116
s_waitcnt lgkmcnt(6)
Ta 36,13,0
Ta 38,13,2048
Mvaa 144,64,120
Mvaa 160,64,124
Ra 4,10,2048
Mvaa 52,68,96
buffer_load_dwordx4 v6, s[12:15], s54 offen offset:2048 nt lds
Mvaa 68,68,100
Ta 40,14,0
Ta 42,14,2048
Mvaa 84,68,104
Mvaa 100,68,108
Ra 8,10,4096
Mvaa 116,68,112
buffer_load_dwordx4 v7, s[12:15], s55 offen offset:3072 nt lds
Mvaa 132,68,116
s_waitcnt lgkmcnt(6)
Ta 44,15,0
Ta 46,15,2048
Mvaa 148,68,120
Mvaa 164,68,124
s_add_u32 m0, s57, 69632
Ra 12,10,6144
Mvaa 56,72,96
buffer_load_dwordx4 v8, s[12:15], s52 offen offset:0 nt lds
Mvaa 72,72,100
Ta 48,16,0
Ta 50,16,2048
Mvaa 88,72,104
Mvaa 104,72,108
Ra 16,10,8192
Mvaa 120,72,112
buffer_load_dwordx4 v9, s[12:15], s53 offen offset:1024 nt lds
Mvaa 136,72,116
s_waitcnt lgkmcnt(6)
Ta 52,17,0
Ta 54,17,2048
Mvaa 152,72,120
Mvaa 168,72,124
Ra 20,10,10240
Mvaa 60,76,96
buffer_load_dwordx4 v8, s[12:15], s54 offen offset:2048 nt lds
Mvaa 76,76,100
Ta 56,18,0
Ta 58,18,2048
Mvaa 92,76,104
Mvaa 108,76,108
Ra 24,10,12288
Mvaa 124,76,112
buffer_load_dwordx4 v9, s[12:15], s55 offen offset:3072 nt lds
Mvaa 140,76,116
s_waitcnt lgkmcnt(6)
Ta 60,19,0
Ta 62,19,2048
Mvaa 156,76,120
v_xor_b32 v6, 1572864, v6
v_xor_b32 v7, 1572864, v7
Mvaa 172,76,124
s_add_u32 m0, s56, 65536
Ra 28,10,14336
v_xor_b32 v8, 1572864, v8
Mvaa 176,80,96
buffer_load_dwordx4 v2, s[8:11], s48 offen offset:0 lds
Mvaa 192,80,100
v_xor_b32 v9, 1572864, v9
Mvaa 208,80,104
Mvaa 224,80,108
Mvaa 240,80,112
buffer_load_dwordx4 v3, s[8:11], s49 offen offset:1024 lds
Maaa 128,80,116
Maaa 144,80,120
Maaa 160,80,124
s_cmp_eq_u32 s6, 2
s_cselect_b32 s3, 0, 2146435072
Mvaa 180,84,96
buffer_load_dwordx4 v2, s[8:11], s50 offen offset:2048 lds
Mvaa 196,84,100
s_mov_b64 exec, 1
buffer_atomic_add v30, v31, s[28:31], s3 offen sc1
s_mov_b64 exec, -1
Mvaa 212,84,104
Mvaa 228,84,108
Mvaa 244,84,112
buffer_load_dwordx4 v3, s[8:11], s51 offen offset:3072 lds
Maaa 132,84,116
Maaa 148,84,120
Maaa 164,84,124
s_add_u32 m0, s56, 69632
Mvaa 184,88,96
buffer_load_dwordx4 v4, s[8:11], s48 offen offset:0 lds
Mvaa 200,88,100
Mvaa 216,88,104
Mvaa 232,88,108
Mvaa 248,88,112
buffer_load_dwordx4 v5, s[8:11], s49 offen offset:1024 lds
Maaa 136,88,116
Maaa 152,88,120
Maaa 168,88,124
Mvaa 188,92,96
buffer_load_dwordx4 v4, s[8:11], s50 offen offset:2048 lds
Mvaa 204,92,100
Mvaa 220,92,104
Mvaa 236,92,108
Mvaa 252,92,112
buffer_load_dwordx4 v5, s[8:11], s51 offen offset:3072 lds
Maaa 140,92,116
v_xor_b32 v2, 384, v2
v_xor_b32 v3, 384, v3
Maaa 156,92,120
v_xor_b32 v4, 384, v4
v_xor_b32 v5, 384, v5
Maaa 172,92,124
s_waitcnt lgkmcnt(0)
Mvaa 48,0,32
buffer_load_dword v44, v45, s[16:19], s47 offen
Mvaa 64,0,36
Ta 96,12,16384
Ta 98,12,18432
Mvaa 80,0,40
s_add_u32 s47, s47, 2097152
Mvaa 96,0,44
Ra 64,11,0
Mvaa 112,0,48
Mvaa 128,0,52
Ta 100,13,16384
Ta 102,13,18432
Mvaa 144,0,56
Mvaa 160,0,60
s_waitcnt lgkmcnt(6)
Ra 68,11,2048
Mvaa 52,4,32
Mvaa 68,4,36
Ta 104,14,16384
Ta 106,14,18432
Mvaa 84,4,40
Mvaa 100,4,44
Ra 72,11,4096
Mvaa 116,4,48
Mvaa 132,4,52
Ta 108,15,16384
Ta 110,15,18432
Mvaa 148,4,56
Mvaa 164,4,60
s_waitcnt lgkmcnt(6)
Ra 76,11,6144
Mvaa 56,8,32
Mvaa 72,8,36
Ta 112,16,16384
Ta 114,16,18432
Mvaa 88,8,40
Mvaa 104,8,44
Ra 80,11,8192
Mvaa 120,8,48
Mvaa 136,8,52
Ta 116,17,16384
Ta 118,17,18432
Mvaa 152,8,56
Mvaa 168,8,60
s_waitcnt lgkmcnt(6)
Ra 84,11,10240
Mvaa 60,12,32
Mvaa 76,12,36
Ta 120,18,16384
Ta 122,18,18432
Mvaa 92,12,40
Mvaa 108,12,44
Ra 88,11,12288
Mvaa 124,12,48
Mvaa 140,12,52
Ta 124,19,16384
Ta 126,19,18432
Mvaa 156,12,56
Mvaa 172,12,60
s_waitcnt lgkmcnt(6)
Ra 92,11,14336
Mvaa 176,16,32
Mvaa 192,16,36
Mvaa 208,16,40
Mvaa 224,16,44
Mvaa 240,16,48
Maaa 128,16,52
Maaa 144,16,56
Maaa 160,16,60
Mvaa 180,20,32
Mvaa 196,20,36
Mvaa 212,20,40
Mvaa 228,20,44
Mvaa 244,20,48
Maaa 132,20,52
Maaa 148,20,56
Maaa 164,20,60
Mvaa 184,24,32
Mvaa 200,24,36
Mvaa 216,24,40
Mvaa 232,24,44
Mvaa 248,24,48
s_cmp_eq_u32 s6, 3
s_cselect_b32 s3, 0, 2146435072
Maaa 136,24,52
s_mov_b64 exec, 1
buffer_atomic_add v30, v31, s[28:31], s3 offen sc1
s_mov_b64 exec, -1
Maaa 152,24,56
Maaa 168,24,60
Mvaa 188,28,32
Mvaa 204,28,36
Mvaa 220,28,40
Mvaa 236,28,44
Mvaa 252,28,48
Maaa 140,28,52
Maaa 156,28,56
Maaa 172,28,60
s_waitcnt vmcnt(2) lgkmcnt(0)
s_add_u32 m0, s57, 0
s_barrier
Mvaa 48,64,96
buffer_load_dwordx4 v6, s[12:15], s52 offen offset:0 nt lds
Mvaa 64,64,100
Ta 32,22,0
Ta 34,22,2048
Mvaa 80,64,104
Mvaa 96,64,108
Ra 0,20,0
Mvaa 112,64,112
buffer_load_dwordx4 v7, s[12:15], s53 offen offset:1024 nt lds
Mvaa 128,64,116
s_waitcnt lgkmcnt(6)
Ta 36,23,0
Ta 38,23,2048
Mvaa 144,64,120
Mvaa 160,64,124
Ra 4,20,2048
Mvaa 52,68,96
buffer_load_dwordx4 v6, s[12:15], s54 offen offset:2048 nt lds
Mvaa 68,68,100
Ta 40,24,0
Ta 42,24,2048
Mvaa 84,68,104
Mvaa 100,68,108
Ra 8,20,4096
Mvaa 116,68,112
buffer_load_dwordx4 v7, s[12:15], s55 offen offset:3072 nt lds
Mvaa 132,68,116
s_waitcnt lgkmcnt(6)
Ta 44,25,0
Ta 46,25,2048
Mvaa 148,68,120
Mvaa 164,68,124
s_add_u32 m0, s57, 4096
Ra 12,20,6144
Mvaa 56,72,96
buffer_load_dwordx4 v8, s[12:15], s52 offen offset:0 nt lds
Mvaa 72,72,100
Ta 48,26,0
Ta 50,26,2048
Mvaa 88,72,104
Mvaa 104,72,108
Ra 16,20,8192
Mvaa 120,72,112
buffer_load_dwordx4 v9, s[12:15], s53 offen offset:1024 nt lds
Mvaa 136,72,116
s_waitcnt lgkmcnt(6)
Ta 52,27,0
Ta 54,27,2048
Mvaa 152,72,120
Mvaa 168,72,124
Ra 20,20,10240
Mvaa 60,76,96
buffer_load_dwordx4 v8, s[12:15], s54 offen offset:2048 nt lds
Mvaa 76,76,100
Ta 56,28,0
Ta 58,28,2048
Mvaa 92,76,104
Mvaa 108,76,108
Ra 24,20,12288
Mvaa 124,76,112
buffer_load_dwordx4 v9, s[12:15], s55 offen offset:3072 nt lds
Mvaa 140,76,116
s_waitcnt lgkmcnt(6)
Ta 60,29,0
Ta 62,29,2048
Mvaa 156,76,120
v_xor_b32 v6, 524288, v6
v_xor_b32 v7, 524288, v7
Mvaa 172,76,124
s_add_u32 m0, s56, 0
Ra 28,20,14336
v_xor_b32 v8, 524288, v8
Mvaa 176,80,96
buffer_load_dwordx4 v2, s[8:11], s48 offen offset:0 lds
Mvaa 192,80,100
v_xor_b32 v9, 524288, v9
Mvaa 208,80,104
Mvaa 224,80,108
Mvaa 240,80,112
buffer_load_dwordx4 v3, s[8:11], s49 offen offset:1024 lds
Maaa 128,80,116
Maaa 144,80,120
Maaa 160,80,124
Mvaa 180,84,96
buffer_load_dwordx4 v2, s[8:11], s50 offen offset:2048 lds
Mvaa 196,84,100
Mvaa 212,84,104
Mvaa 228,84,108
Mvaa 244,84,112
buffer_load_dwordx4 v3, s[8:11], s51 offen offset:3072 lds
Maaa 132,84,116
Maaa 148,84,120
Maaa 164,84,124
s_add_u32 m0, s56, 4096
Mvaa 184,88,96
buffer_load_dwordx4 v4, s[8:11], s48 offen offset:0 lds
Mvaa 200,88,100
Mvaa 216,88,104
Mvaa 232,88,108
Mvaa 248,88,112
buffer_load_dwordx4 v5, s[8:11], s49 offen offset:1024 lds
Maaa 136,88,116
Maaa 152,88,120
Maaa 168,88,124
Mvaa 188,92,96
buffer_load_dwordx4 v4, s[8:11], s50 offen offset:2048 lds
Mvaa 204,92,100
Mvaa 220,92,104
Mvaa 236,92,108
Mvaa 252,92,112
buffer_load_dwordx4 v5, s[8:11], s51 offen offset:3072 lds
Maaa 140,92,116
v_xor_b32 v2, 128, v2
v_xor_b32 v3, 128, v3
Maaa 156,92,120
v_xor_b32 v4, 128, v4
v_xor_b32 v5, 128, v5
Maaa 172,92,124
s_waitcnt lgkmcnt(0)
Mvaa 48,0,32
buffer_load_dword v44, v45, s[16:19], s47 offen
Mvaa 64,0,36
Ta 96,22,16384
Ta 98,22,18432
Mvaa 80,0,40
s_add_u32 s47, s47, 2097152
v_lshrrev_b32 v32, 4, v0
v_and_b32 v33, 15, v0
Mvaa 96,0,44
Ra 64,21,0
Mvaa 112,0,48
s_lshl_b32 s3, s32, 4
v_add_u32 v34, s3, v32
v_lshlrev_b32_e64 v36, 1, v32
Mvaa 128,0,52
Ta 100,23,16384
Ta 102,23,18432
Mvaa 144,0,56
v_xor_b32 v36, v36, v33
v_xor_b32 v37, 8, v36
Mvaa 160,0,60
s_waitcnt lgkmcnt(6)
Ra 68,21,2048
Mvaa 52,4,32
s_getpc_b64 s[6:7]
L_cpf3:
s_add_u32 s6, s6, (L_phase2-L_cpf3)&0xffffffff
s_addc_u32 s7, s7, ((L_phase2-L_cpf3)>>32)&0xffffffff
Mvaa 68,4,36
Ta 104,24,16384
Ta 106,24,18432
Mvaa 84,4,40
s_lshr_b32 s3, s2, 3
s_lshl_b32 s3, s3, 2
s_add_u32 s3, s3, s32
Mvaa 100,4,44
Ra 72,21,4096
Mvaa 116,4,48
s_lshl_b32 s3, s3, 10
v_and_b32 v42, 7, v0
v_lshlrev_b32 v42, 7, v42
Mvaa 132,4,52
Ta 108,25,16384
Ta 110,25,18432
Mvaa 148,4,56
v_add_u32_e64 v42, s3, v42
v_min_u32 v42, L_k2_fin-L_phase2-4, v42
Mvaa 164,4,60
s_waitcnt lgkmcnt(6)
Ra 76,21,6144
Mvaa 56,8,32
v_mov_b32 v41, s7
Mvaa 72,8,36
Ta 112,26,16384
Ta 114,26,18432
Mvaa 88,8,40
v_add_co_u32 v40, vcc, s6, v42
s_nop 1
v_addc_co_u32 v41, vcc, 0, v41, vcc
Mvaa 104,8,44
Ra 80,21,8192
Mvaa 120,8,48
global_load_dword v38, v[40:41], off
Mvaa 136,8,52
Ta 116,27,16384
Ta 118,27,18432
Mvaa 152,8,56
Mvaa 168,8,60
s_waitcnt lgkmcnt(6)
Ra 84,21,10240
Mvaa 60,12,32
Mvaa 76,12,36
Ta 120,28,16384
Ta 122,28,18432
Mvaa 92,12,40
Mvaa 108,12,44
Ra 88,21,12288
Mvaa 124,12,48
Mvaa 140,12,52
Ta 124,29,16384
Ta 126,29,18432
Mvaa 156,12,56
Mvaa 172,12,60
s_waitcnt lgkmcnt(6)
Ra 92,21,14336
Mvaa 176,16,32
Mvaa 192,16,36
Mvaa 208,16,40
Mvaa 224,16,44
Mvaa 240,16,48
Maaa 128,16,52
Maaa 144,16,56
Maaa 160,16,60
Mvaa 180,20,32
Mvaa 196,20,36
Mvaa 212,20,40
Mvaa 228,20,44
Mvaa 244,20,48
Maaa 132,20,52
Maaa 148,20,56
Maaa 164,20,60
Mvaa 184,24,32
Mvaa 200,24,36
Mvaa 216,24,40
Mvaa 232,24,44
Mvaa 248,24,48
Maaa 136,24,52
Maaa 152,24,56
Maaa 168,24,60
Mvaa 188,28,32
Mvaa 204,28,36
Mvaa 220,28,40
Mvaa 236,28,44
Mvaa 252,28,48
Maaa 140,28,52
Maaa 156,28,56
Maaa 172,28,60
s_waitcnt vmcnt(2) lgkmcnt(0)
s_add_u32 m0, s57, 65536
s_barrier
Mvaa 48,64,96
buffer_load_dwordx4 v6, s[12:15], s52 offen offset:0 nt lds
Mvaa 64,64,100
Ta 32,12,0
Ta 34,12,2048
Mvaa 80,64,104
Mvaa 96,64,108
Ra 0,10,0
Mvaa 112,64,112
buffer_load_dwordx4 v7, s[12:15], s53 offen offset:1024 nt lds
Mvaa 128,64,116
s_waitcnt lgkmcnt(6)
Ta 36,13,0
Ta 38,13,2048
Mvaa 144,64,120
Mvaa 160,64,124
Ra 4,10,2048
Mvaa 52,68,96
buffer_load_dwordx4 v6, s[12:15], s54 offen offset:2048 nt lds
Mvaa 68,68,100
Ta 40,14,0
Ta 42,14,2048
Mvaa 84,68,104
Mvaa 100,68,108
Ra 8,10,4096
Mvaa 116,68,112
buffer_load_dwordx4 v7, s[12:15], s55 offen offset:3072 nt lds
Mvaa 132,68,116
s_waitcnt lgkmcnt(6)
Ta 44,15,0
Ta 46,15,2048
Mvaa 148,68,120
Mvaa 164,68,124
s_add_u32 m0, s57, 69632
Ra 12,10,6144
Mvaa 56,72,96
buffer_load_dwordx4 v8, s[12:15], s52 offen offset:0 nt lds
Mvaa 72,72,100
Ta 48,16,0
Ta 50,16,2048
Mvaa 88,72,104
Mvaa 104,72,108
Ra 16,10,8192
Mvaa 120,72,112
buffer_load_dwordx4 v9, s[12:15], s53 offen offset:1024 nt lds
Mvaa 136,72,116
s_waitcnt lgkmcnt(6)
Ta 52,17,0
Ta 54,17,2048
Mvaa 152,72,120
Mvaa 168,72,124
Ra 20,10,10240
Mvaa 60,76,96
buffer_load_dwordx4 v8, s[12:15], s54 offen offset:2048 nt lds
Mvaa 76,76,100
Ta 56,18,0
Ta 58,18,2048
Mvaa 92,76,104
Mvaa 108,76,108
Ra 24,10,12288
Mvaa 124,76,112
buffer_load_dwordx4 v9, s[12:15], s55 offen offset:3072 nt lds
Mvaa 140,76,116
s_waitcnt lgkmcnt(6)
Ta 60,19,0
Ta 62,19,2048
Mvaa 156,76,120
Mvaa 172,76,124
s_add_u32 m0, s56, 65536
Ra 28,10,14336
Mvaa 176,80,96
buffer_load_dwordx4 v2, s[8:11], s48 offen offset:0 lds
Mvaa 192,80,100
Mvaa 208,80,104
Mvaa 224,80,108
Mvaa 240,80,112
buffer_load_dwordx4 v3, s[8:11], s49 offen offset:1024 lds
Maaa 128,80,116
Maaa 144,80,120
Maaa 160,80,124
Mvaa 180,84,96
buffer_load_dwordx4 v2, s[8:11], s50 offen offset:2048 lds
Mvaa 196,84,100
Mvaa 212,84,104
Mvaa 228,84,108
Mvaa 244,84,112
buffer_load_dwordx4 v3, s[8:11], s51 offen offset:3072 lds
Maaa 132,84,116
Maaa 148,84,120
Maaa 164,84,124
s_add_u32 m0, s56, 69632
Mvaa 184,88,96
buffer_load_dwordx4 v4, s[8:11], s48 offen offset:0 lds
Mvaa 200,88,100
Mvaa 216,88,104
Mvaa 232,88,108
Mvaa 248,88,112
buffer_load_dwordx4 v5, s[8:11], s49 offen offset:1024 lds
Maaa 136,88,116
Maaa 152,88,120
Maaa 168,88,124
Mvaa 188,92,96
buffer_load_dwordx4 v4, s[8:11], s50 offen offset:2048 lds
Mvaa 204,92,100
Mvaa 220,92,104
Mvaa 236,92,108
Mvaa 252,92,112
buffer_load_dwordx4 v5, s[8:11], s51 offen offset:3072 lds
Maaa 140,92,116
Maaa 156,92,120
Maaa 172,92,124
s_waitcnt lgkmcnt(0)
Mvaa 48,0,32
buffer_load_dword v30, v31, s[28:31], s37 offen sc1
Mvaa 64,0,36
Ta 96,12,16384
Ta 98,12,18432
Mvaa 80,0,40
s_mov_b32 s8, s16
s_mov_b32 s9, s17
s_mov_b32 s10, s18
Mvaa 96,0,44
Ra 64,11,0
Mvaa 112,0,48
s_add_u32 s16, s66, 46137344
s_addc_u32 s17, s67, 0
s_and_b32 s17, s17, 0xffff
Mvaa 128,0,52
Ta 100,13,16384
Ta 102,13,18432
Mvaa 144,0,56
s_mov_b32 s18, 16777216
s_mov_b32 s19, 0x20000
s_mov_b32 s48, 0
Mvaa 160,0,60
s_waitcnt lgkmcnt(6)
Ra 68,11,2048
Mvaa 52,4,32
s_mov_b32 s49, 31744
s_mov_b32 s50, 63488
s_mov_b32 s51, 95232
Mvaa 68,4,36
Ta 104,14,16384
Ta 106,14,18432
Mvaa 84,4,40
v_lshlrev_b32_e64 v35, 13, v34
v_lshl_add_u32 v8, v36, 4, v35
Mvaa 100,4,44
Ra 72,11,4096
Mvaa 116,4,48
v_lshl_add_u32 v9, v37, 4, v35
v_lshlrev_b32_e64 v2, 4, v0
Mvaa 132,4,52
Ta 108,15,16384
Ta 110,15,18432
Mvaa 148,4,56
v_add_u32 v3, 65536, v2
v_add_u32_e64 v4, s44, v2
Mvaa 164,4,60
s_waitcnt lgkmcnt(6)
Ra 76,11,6144
Mvaa 56,8,32
v_mov_b32 v7, 0
v_lshlrev_b32_e64 v35, 2, v32
Mvaa 72,8,36
Ta 112,16,16384
Ta 114,16,18432
Mvaa 88,8,40
v_sub_u32_e64 v35, v33, v35
Mvaa 104,8,44
Ra 80,11,8192
Mvaa 120,8,48
s_lshl_b32 s3, s32, 4
v_add_u32 v5, s3, v35
Mvaa 136,8,52
Ta 116,17,16384
Ta 118,17,18432
Mvaa 152,8,56
s_sub_u32 s3, 48, s3
v_add_u32 v6, s3, v35
Mvaa 168,8,60
s_waitcnt lgkmcnt(6)
Ra 84,11,10240
Mvaa 60,12,32
s_mul_i32 s3, s33, 1116160
s_add_u32 s3, s3, 8388608
s_add_u32 s12, s66, s3
s_addc_u32 s13, s67, 0
s_and_b32 s13, s13, 0xffff
Mvaa 76,12,36
Ta 120,18,16384
Ta 122,18,18432
Mvaa 92,12,40
s_mov_b32 s14, 0
s_mov_b32 s15, 0x20000
s_mul_i32 s14, s36, 34816
Mvaa 108,12,44
Ra 88,11,12288
Mvaa 124,12,48
buffer_load_dword v44, v45, s[8:11], s47 offen
Mvaa 140,12,52
Ta 124,19,16384
Ta 126,19,18432
Mvaa 156,12,56
s_add_u32 s47, s47, 2097152
Mvaa 172,12,60
s_waitcnt lgkmcnt(6)
Ra 92,11,14336
Mvaa 176,16,32
Mvaa 192,16,36
Mvaa 208,16,40
Mvaa 224,16,44
Mvaa 240,16,48
Maaa 128,16,52
Maaa 144,16,56
Maaa 160,16,60
Mvaa 180,20,32
Mvaa 196,20,36
Mvaa 212,20,40
Mvaa 228,20,44
Mvaa 244,20,48
Maaa 132,20,52
Maaa 148,20,56
Maaa 164,20,60
Mvaa 184,24,32
Mvaa 200,24,36
Mvaa 216,24,40
Mvaa 232,24,44
Mvaa 248,24,48
Maaa 136,24,52
Maaa 152,24,56
Maaa 168,24,60
Mvaa 188,28,32
Mvaa 204,28,36
Mvaa 220,28,40
Mvaa 236,28,44
Mvaa 252,28,48
Maaa 140,28,52
Maaa 156,28,56
Maaa 172,28,60
s_waitcnt vmcnt(2) lgkmcnt(0)
s_add_u32 m0, s44, 0
s_barrier
Mvaa 48,64,96
buffer_load_dwordx4 v8, s[8:11], s48 offen offset:0 lds
Mvaa 64,64,100
Ta 32,22,0
Ta 34,22,2048
Mvaa 80,64,104
s_mul_i32 s3, s45, 33792
v_add_u32_e64 v10, s3, v2
Mvaa 96,64,108
Ra 0,20,0
Mvaa 112,64,112
buffer_load_dwordx4 v8, s[8:11], s49 offen offset:1024 lds
Mvaa 128,64,116
s_waitcnt lgkmcnt(6)
Ta 36,23,0
Ta 38,23,2048
Mvaa 144,64,120
s_mul_i32 s3, s46, 33792
v_add_u32 v11, s3, v2
v_mov_b32_e64 v14, v40
Mvaa 160,64,124
Ra 4,20,2048
Mvaa 52,68,96
buffer_load_dwordx4 v9, s[8:11], s50 offen offset:2048 lds
Mvaa 68,68,100
Ta 40,24,0
Ta 42,24,2048
Mvaa 84,68,104
v_mov_b32_e64 v15, v41
Mvaa 100,68,108
Ra 8,20,4096
Mvaa 116,68,112
buffer_load_dwordx4 v9, s[8:11], s51 offen offset:3072 lds
Mvaa 132,68,116
s_waitcnt lgkmcnt(6)
Ta 44,25,0
Ta 46,25,2048
Mvaa 148,68,120
v_add_u32 v8, 524288, v8
v_add_u32 v9, 524288, v9
Mvaa 164,68,124
s_add_u32 m0, s44, 16384
Ra 12,20,6144
Mvaa 56,72,96
buffer_load_dwordx4 v8, s[8:11], s48 offen offset:0 lds
Mvaa 72,72,100
Ta 48,26,0
Ta 50,26,2048
Mvaa 88,72,104
Mvaa 104,72,108
Ra 16,20,8192
Mvaa 120,72,112
buffer_load_dwordx4 v8, s[8:11], s49 offen offset:1024 lds
Mvaa 136,72,116
s_waitcnt lgkmcnt(6)
Ta 52,27,0
Ta 54,27,2048
Mvaa 152,72,120
Mvaa 168,72,124
Ra 20,20,10240
Mvaa 60,76,96
buffer_load_dwordx4 v9, s[8:11], s50 offen offset:2048 lds
Mvaa 76,76,100
Ta 56,28,0
Ta 58,28,2048
Mvaa 92,76,104
Mvaa 108,76,108
Ra 24,20,12288
Mvaa 124,76,112
buffer_load_dwordx4 v9, s[8:11], s51 offen offset:3072 lds
Mvaa 140,76,116
s_waitcnt lgkmcnt(6)
Ta 60,29,0
Ta 62,29,2048
Mvaa 156,76,120
v_add_u32 v8, 524288, v8
v_add_u32 v9, 524288, v9
Mvaa 172,76,124
s_add_u32 m0, s44, 32768
Ra 28,20,14336
Mvaa 176,80,96
buffer_load_dwordx4 v8, s[8:11], s48 offen offset:0 lds
Mvaa 192,80,100
Mvaa 208,80,104
Mvaa 224,80,108
Mvaa 240,80,112
buffer_load_dwordx4 v8, s[8:11], s49 offen offset:1024 lds
Maaa 128,80,116
Maaa 144,80,120
Maaa 160,80,124
Mvaa 180,84,96
buffer_load_dwordx4 v9, s[8:11], s50 offen offset:2048 lds
Mvaa 196,84,100
Mvaa 212,84,104
Mvaa 228,84,108
Mvaa 244,84,112
buffer_load_dwordx4 v9, s[8:11], s51 offen offset:3072 lds
Maaa 132,84,116
v_add_u32 v8, 524288, v8
v_add_u32 v9, 524288, v9
Maaa 148,84,120
Maaa 164,84,124
s_add_u32 m0, s44, 49152
Mvaa 184,88,96
buffer_load_dwordx4 v8, s[8:11], s48 offen offset:0 lds
Mvaa 200,88,100
Mvaa 216,88,104
Mvaa 232,88,108
Mvaa 248,88,112
buffer_load_dwordx4 v8, s[8:11], s49 offen offset:1024 lds
Maaa 136,88,116
Maaa 152,88,120
Maaa 168,88,124
Mvaa 188,92,96
buffer_load_dwordx4 v9, s[8:11], s50 offen offset:2048 lds
Mvaa 204,92,100
Mvaa 220,92,104
Mvaa 236,92,108
Mvaa 252,92,112
buffer_load_dwordx4 v9, s[8:11], s51 offen offset:3072 lds
Maaa 140,92,116
v_add_u32 v8, 524288, v8
v_add_u32 v9, 524288, v9
Maaa 156,92,120
Maaa 172,92,124
s_waitcnt lgkmcnt(0)
Mvaa 48,0,32
Mvaa 64,0,36
Ta 96,22,16384
Ta 98,22,18432
Mvaa 80,0,40
Mvaa 96,0,44
Ra 64,21,0
Mvaa 112,0,48
Mvaa 128,0,52
Ta 100,23,16384
Ta 102,23,18432
Mvaa 144,0,56
Mvaa 160,0,60
s_waitcnt lgkmcnt(6)
Ra 68,21,2048
Mvaa 52,4,32
Mvaa 68,4,36
Ta 104,24,16384
Ta 106,24,18432
Mvaa 84,4,40
Mvaa 100,4,44
Ra 72,21,4096
Mvaa 116,4,48
Mvaa 132,4,52
Ta 108,25,16384
Ta 110,25,18432
Mvaa 148,4,56
Mvaa 164,4,60
s_waitcnt lgkmcnt(6)
Ra 76,21,6144
Mvaa 56,8,32
Mvaa 72,8,36
Ta 112,26,16384
Ta 114,26,18432
Mvaa 88,8,40
Mvaa 104,8,44
Ra 80,21,8192
Mvaa 120,8,48
Mvaa 136,8,52
Ta 116,27,16384
Ta 118,27,18432
Mvaa 152,8,56
Mvaa 168,8,60
s_waitcnt lgkmcnt(6)
Ra 84,21,10240
Mvaa 60,12,32
Mvaa 76,12,36
Ta 120,28,16384
Ta 122,28,18432
Mvaa 92,12,40
Mvaa 108,12,44
Ra 88,21,12288
Mvaa 124,12,48
Mvaa 140,12,52
Ta 124,29,16384
Ta 126,29,18432
Mvaa 156,12,56
Mvaa 172,12,60
s_waitcnt lgkmcnt(6)
Ra 92,21,14336
Mvaa 176,16,32
Mvaa 192,16,36
Mvaa 208,16,40
Mvaa 224,16,44
Mvaa 240,16,48
Maaa 128,16,52
Maaa 144,16,56
Maaa 160,16,60
Mvaa 180,20,32
Mvaa 196,20,36
Mvaa 212,20,40
Mvaa 228,20,44
Mvaa 244,20,48
Maaa 132,20,52
Maaa 148,20,56
Maaa 164,20,60
Mvaa 184,24,32
Mvaa 200,24,36
Mvaa 216,24,40
Mvaa 232,24,44
Mvaa 248,24,48
Maaa 136,24,52
Maaa 152,24,56
Maaa 168,24,60
Mvaa 188,28,32
Mvaa 204,28,36
Mvaa 220,28,40
Mvaa 236,28,44
Mvaa 252,28,48
Maaa 140,28,52
Maaa 156,28,56
Maaa 172,28,60
s_waitcnt vmcnt(12) lgkmcnt(0)
v_readfirstlane_b32 s3, v30
s_nop 0
s_or_b32 s3, s3, s37
s_cmp_lt_u32 s3, 256
s_cbranch_scc1 L_spinAv
L_spinArv:
s_barrier
Mvaa 48,64,96
buffer_load_dwordx4 a[0:3], v10, s[20:23], s58 offen offset:0 sc1
Mvaa 52,68,96
v_lshrrev_b32_e64 v42, 2, v33
v_lshl_add_u32 v43, v32, 3, v42
Mvaa 56,72,96
v_lshlrev_b32 v43, 8, v43
v_and_b32 v44, 3, v0
Mvaa 60,76,96
v_lshl_add_u32 v43, v44, 3, v43
v_and_b32_e64 v44, 1, v32
Mvaa 64,64,100
buffer_load_dwordx4 a[4:7], v10, s[20:23], 0 offen offset:0 sc1
Mvaa 68,68,100
v_lshl_add_u32 v42, v44, 2, v42
v_xor_b32_e64 v44, 0, v42
Mvaa 72,72,100
v_lshl_add_u32 v16, v44, 5, v43
v_xor_b32_e64 v44, 1, v42
Mvaa 76,76,100
v_lshl_add_u32 v17, v44, 5, v43
v_xor_b32_e64 v44, 2, v42
Mvaa 80,64,104
buffer_load_dwordx4 a[8:11], v11, s[20:23], s58 offen offset:0 sc1
Mvaa 84,68,104
v_lshl_add_u32 v18, v44, 5, v43
v_xor_b32_e64 v44, 3, v42
Mvaa 88,72,104
v_lshl_add_u32 v19, v44, 5, v43
v_xor_b32_e64 v44, 4, v42
Mvaa 92,76,104
v_lshl_add_u32 v20, v44, 5, v43
v_xor_b32_e64 v44, 5, v42
Mvaa 96,64,108
buffer_load_dwordx4 a[12:15], v11, s[20:23], 0 offen offset:0 sc1
Mvaa 100,68,108
v_lshl_add_u32 v21, v44, 5, v43
v_xor_b32_e64 v44, 6, v42
Mvaa 104,72,108
v_lshl_add_u32 v22, v44, 5, v43
v_xor_b32_e64 v44, 7, v42
Mvaa 108,76,108
v_lshl_add_u32 v23, v44, 5, v43
Mvaa 112,64,112
buffer_load_dwordx4 a[16:19], v10, s[20:23], s58 offen offset:1024 sc1
Mvaa 116,68,112
Mvaa 120,72,112
Mvaa 124,76,112
Mvaa 128,64,116
buffer_load_dwordx4 a[20:23], v10, s[20:23], 0 offen offset:1024 sc1
Mvaa 132,68,116
Ta 192,16,0
Ta 194,16,1024
Mvaa 136,72,116
Ta 196,17,0
Ta 198,17,1024
Mvaa 140,76,116
Ta 200,18,0
Ta 202,18,1024
Mvaa 144,64,120
buffer_load_dwordx4 a[24:27], v11, s[20:23], s58 offen offset:1024 sc1
Mvaa 148,68,120
Ta 204,19,0
Ta 206,19,1024
Mvaa 152,72,120
Ta 208,20,0
Ta 210,20,1024
Mvaa 156,76,120
Ta 212,21,0
Ta 214,21,1024
Mvaa 160,64,124
buffer_load_dwordx4 a[28:31], v11, s[20:23], 0 offen offset:1024 sc1
Mvaa 164,68,124
Ta 216,22,0
Ta 218,22,1024
Mvaa 168,72,124
Ta 220,23,0
s_waitcnt lgkmcnt(9)
Ta 222,23,1024
Mvaa 172,76,124
s_waitcnt lgkmcnt(8)
Vc 24,48,49
Vc 25,50,51
Mvaa 176,80,96
buffer_load_dwordx4 a[32:35], v10, s[20:23], s58 offen offset:2048 sc1
Mvaa 180,84,96
Vc 26,52,53
Vc 27,54,55
Mvaa 184,88,96
Vc 28,56,57
Vc 29,58,59
Mvaa 188,92,96
Vc 30,60,61
Vc 31,62,63
Mvaa 192,80,100
buffer_load_dwordx4 a[36:39], v10, s[20:23], 0 offen offset:2048 sc1
Mvaa 196,84,100
Vc 32,64,65
Vc 33,66,67
Mvaa 200,88,100
Vc 34,68,69
Vc 35,70,71
Mvaa 204,92,100
Vc 36,72,73
Vc 37,74,75
Mvaa 208,80,104
buffer_load_dwordx4 a[40:43], v11, s[20:23], s58 offen offset:2048 sc1
Mvaa 212,84,104
Vc 38,76,77
Vc 39,78,79
Mvaa 216,88,104
Vc 40,80,81
Vc 41,82,83
Mvaa 220,92,104
Vc 42,84,85
Vc 43,86,87
Mvaa 224,80,108
buffer_load_dwordx4 a[44:47], v11, s[20:23], 0 offen offset:2048 sc1
Mvaa 228,84,108
Vc 44,88,89
Vc 45,90,91
Mvaa 232,88,108
Vc 46,92,93
Vc 47,94,95
Mvaa 236,92,108
Vc 48,96,97
Vc 49,98,99
Mvaa 240,80,112
buffer_load_dwordx4 a[48:51], v10, s[20:23], s58 offen offset:3072 sc1
Mvaa 244,84,112
Vc 50,100,101
Vc 51,102,103
Mvaa 248,88,112
Vc 52,104,105
Vc 53,106,107
Mvaa 252,92,112
Vc 54,108,109
Vc 55,110,111
Maaa 128,80,116
buffer_load_dwordx4 a[52:55], v10, s[20:23], 0 offen offset:3072 sc1
Maaa 132,84,116
Vc 56,112,113
Vc 57,114,115
Maaa 136,88,116
Vc 58,116,117
Vc 59,118,119
Maaa 140,92,116
Vc 60,120,121
Vc 61,122,123
Maaa 144,80,120
buffer_load_dwordx4 a[56:59], v11, s[20:23], s58 offen offset:3072 sc1
Maaa 148,84,120
Vc 62,124,125
Vc 63,126,127
Maaa 152,88,120
Vc 64,128,129
Vc 65,130,131
Maaa 156,92,120
Vc 66,132,133
Vc 67,134,135
Maaa 160,80,124
buffer_load_dwordx4 a[60:63], v11, s[20:23], 0 offen offset:3072 sc1
Maaa 164,84,124
v_add_u32 v10, 4096, v10
v_add_u32 v11, 4096, v11
Maaa 168,88,124
Vc 68,136,137
Vc 69,138,139
Maaa 172,92,124
Vc 70,140,141
Vc 71,142,143
Vc 72,144,145
Vc 73,146,147
Vc 74,148,149
Vc 75,150,151
Vc 76,152,153
Vc 77,154,155
Vc 78,156,157
Vc 79,158,159
Vc 80,160,161
Vc 81,162,163
Vc 82,164,165
Vc 83,166,167
Vc 84,168,169
Vc 85,170,171
Vc 86,172,173
Vc 87,174,175
Vc 88,176,177
Vc 89,178,179
Vc 90,180,181
Vc 91,182,183
Vc 92,184,185
Vc 93,186,187
Vc 94,188,189
Vc 95,190,191
Vc 96,192,193
Vc 97,194,195
Vc 98,196,197
Vc 99,198,199
Vc 100,200,201
Vc 101,202,203
Vc 102,204,205
Vc 103,206,207
Vc 104,208,209
Vc 105,210,211
Vc 106,212,213
Vc 107,214,215
Vc 108,216,217
Vc 109,218,219
Vc 110,220,221
Vc 111,222,223
Vc 112,224,225
Vc 113,226,227
Vc 114,228,229
Vc 115,230,231
Vc 116,232,233
Vc 117,234,235
Vc 118,236,237
Vc 119,238,239
Vc 120,240,241
Vc 121,242,243
Vc 122,244,245
Vc 123,246,247
Vc 124,248,249
Vc 125,250,251
Vc 126,252,253
Vc 127,254,255
L_phase2:
s_nop 7
s_waitcnt vmcnt(12) lgkmcnt(0)
Zvaa 128,192,0
s_add_u32 s37, s38, 0
Zvaa 160,192,4
Ta 224,16,8192
Ta 226,16,9216
Zvaa 192,192,8
buffer_load_dwordx4 a[64:67], v10, s[20:23], s58 offen offset:0 sc1
Zvaa 224,192,12
buffer_store_dwordx4 v[24:27], v2, s[24:27], s37 offen offset:0 sc1
Zvaa 132,196,0
Ta 228,17,8192
Ta 230,17,9216
Zvaa 164,196,4
buffer_load_dwordx4 a[68:71], v10, s[20:23], 0 offen offset:0 sc1
Zvaa 196,196,8
s_mov_b32 s60, s40
s_and_b32 s61, s41, 0xffff
s_mov_b32 s62, 7340032
Zvaa 228,196,12
Ta 232,18,8192
Ta 234,18,9216
Zvaa 136,200,0
s_mov_b32 s63, 0x20000
Zvaa 168,200,4
buffer_load_dwordx4 a[72:75], v11, s[20:23], s58 offen offset:0 sc1
Zvaa 200,200,8
Ta 236,19,8192
Ta 238,19,9216
Zvaa 232,200,12
global_load_dword v13, v[14:15], off
Zvaa 140,204,0
Zvaa 172,204,4
Ta 240,20,8192
Ta 242,20,9216
Zvaa 204,204,8
buffer_load_dwordx4 a[76:79], v11, s[20:23], 0 offen offset:0 sc1
Zvaa 236,204,12
Zvaa 144,208,0
s_waitcnt lgkmcnt(6)
Ta 244,21,8192
Ta 246,21,9216
Zvaa 176,208,4
buffer_store_dwordx4 v[28:31], v2, s[24:27], s37 offen offset:1024 sc1
Zvaa 208,208,8
buffer_load_dwordx4 a[80:83], v10, s[20:23], s58 offen offset:1024 sc1
Zvaa 240,208,12
Ta 248,22,8192
Ta 250,22,9216
Zvaa 148,212,0
Zvaa 180,212,4
Zvaa 212,212,8
Ta 252,23,8192
Ta 254,23,9216
Zvaa 244,212,12
buffer_load_dwordx4 a[84:87], v10, s[20:23], 0 offen offset:1024 sc1
Zvaa 152,216,0
Zvaa 184,216,4
Zvaa 216,216,8
buffer_load_dwordx4 a[88:91], v11, s[20:23], s58 offen offset:1024 sc1
Zvaa 248,216,12
Zvaa 156,220,0
Zvaa 188,220,4
buffer_load_dwordx4 a[92:95], v11, s[20:23], 0 offen offset:1024 sc1
Zvaa 220,220,8
Zvaa 252,220,12
s_waitcnt vmcnt(19) lgkmcnt(0)
s_barrier
Mvaa 128,224,16
buffer_store_dwordx4 v[32:35], v2, s[24:27], s37 offen offset:2048 sc1
Mvaa 160,224,20
s_add_u32 m0, s44, 0
Ta 192,16,16384
Ta 194,16,17408
Mvaa 192,224,24
buffer_load_dwordx4 v8, s[8:11], s48 offen offset:0 lds
Mvaa 224,224,28
Mvaa 132,228,16
Ta 196,17,16384
Ta 198,17,17408
Mvaa 164,228,20
buffer_load_dwordx4 v8, s[8:11], s49 offen offset:1024 lds
Mvaa 196,228,24
Mvaa 228,228,28
Ta 200,18,16384
Ta 202,18,17408
Mvaa 136,232,16
Mvaa 168,232,20
buffer_load_dwordx4 v9, s[8:11], s50 offen offset:2048 lds
Mvaa 200,232,24
Ta 204,19,16384
Ta 206,19,17408
Mvaa 232,232,28
Mvaa 140,236,16
Mvaa 172,236,20
Ta 208,20,16384
Ta 210,20,17408
Mvaa 204,236,24
buffer_load_dwordx4 v9, s[8:11], s51 offen offset:3072 lds
v_add_u32 v8, 524288, v8
v_add_u32 v9, 524288, v9
Mvaa 236,236,28
Mvaa 144,240,16
s_waitcnt lgkmcnt(6)
Ta 212,21,16384
Ta 214,21,17408
Mvaa 176,240,20
buffer_store_dwordx4 v[36:39], v2, s[24:27], s37 offen offset:3072 sc1
Mvaa 208,240,24
buffer_load_dwordx4 a[96:99], v10, s[20:23], s58 offen offset:2048 sc1
Mvaa 240,240,28
Ta 216,22,16384
Ta 218,22,17408
Mvaa 148,244,16
Mvaa 180,244,20
Mvaa 212,244,24
Ta 220,23,16384
Ta 222,23,17408
Mvaa 244,244,28
buffer_load_dwordx4 a[100:103], v10, s[20:23], 0 offen offset:2048 sc1
Mvaa 152,248,16
Mvaa 184,248,20
Mvaa 216,248,24
buffer_load_dwordx4 a[104:107], v11, s[20:23], s58 offen offset:2048 sc1
Mvaa 248,248,28
Mvaa 156,252,16
Mvaa 188,252,20
buffer_load_dwordx4 a[108:111], v11, s[20:23], 0 offen offset:2048 sc1
Mvaa 220,252,24
Mvaa 252,252,28
s_waitcnt vmcnt(25) lgkmcnt(0)
Mvaa 128,192,32
s_add_u32 s37, s38, 4096
Mvaa 160,192,36
Ta 224,16,24576
Ta 226,16,25600
Mvaa 192,192,40
buffer_load_dwordx4 a[112:115], v10, s[20:23], s58 offen offset:3072 sc1
Mvaa 224,192,44
buffer_store_dwordx4 v[40:43], v2, s[24:27], s37 offen offset:0 sc1
Mvaa 132,196,32
Ta 228,17,24576
Ta 230,17,25600
Mvaa 164,196,36
Mvaa 196,196,40
Mvaa 228,196,44
Ta 232,18,24576
Ta 234,18,25600
Mvaa 136,200,32
Mvaa 168,200,36
buffer_load_dwordx4 a[116:119], v10, s[20:23], 0 offen offset:3072 sc1
Mvaa 200,200,40
Ta 236,19,24576
Ta 238,19,25600
Mvaa 232,200,44
Mvaa 140,204,32
Mvaa 172,204,36
Ta 240,20,24576
Ta 242,20,25600
Mvaa 204,204,40
Mvaa 236,204,44
Mvaa 144,208,32
s_waitcnt lgkmcnt(6)
Ta 244,21,24576
Ta 246,21,25600
Mvaa 176,208,36
buffer_store_dwordx4 v[44:47], v2, s[24:27], s37 offen offset:1024 sc1
Mvaa 208,208,40
buffer_load_dwordx4 a[120:123], v11, s[20:23], s58 offen offset:3072 sc1
Mvaa 240,208,44
Ta 248,22,24576
Ta 250,22,25600
Mvaa 148,212,32
Mvaa 180,212,36
Mvaa 212,212,40
Ta 252,23,24576
Ta 254,23,25600
Mvaa 244,212,44
Mvaa 152,216,32
Mvaa 184,216,36
Mvaa 216,216,40
buffer_load_dwordx4 a[124:127], v11, s[20:23], 0 offen offset:3072 sc1
v_add_u32 v10, 4096, v10
v_add_u32 v11, 4096, v11
Mvaa 248,216,44
Mvaa 156,220,32
Mvaa 188,220,36
Mvaa 220,220,40
Mvaa 252,220,44
s_waitcnt vmcnt(27) lgkmcnt(0)
s_barrier
Mvaa 128,224,48
buffer_store_dwordx4 v[48:51], v2, s[24:27], s37 offen offset:2048 sc1
Mvaa 160,224,52
s_add_u32 m0, s44, 16384
Ta 192,16,32768
Ta 194,16,33792
Mvaa 192,224,56
buffer_load_dwordx4 v8, s[8:11], s48 offen offset:0 lds
Mvaa 224,224,60
Mvaa 132,228,48
Ta 196,17,32768
Ta 198,17,33792
Mvaa 164,228,52
buffer_load_dwordx4 v8, s[8:11], s49 offen offset:1024 lds
Mvaa 196,228,56
Mvaa 228,228,60
Ta 200,18,32768
Ta 202,18,33792
Mvaa 136,232,48
Mvaa 168,232,52
buffer_load_dwordx4 v9, s[8:11], s50 offen offset:2048 lds
Mvaa 200,232,56
Ta 204,19,32768
Ta 206,19,33792
Mvaa 232,232,60
Mvaa 140,236,48
Mvaa 172,236,52
Ta 208,20,32768
Ta 210,20,33792
Mvaa 204,236,56
buffer_load_dwordx4 v9, s[8:11], s51 offen offset:3072 lds
v_add_u32 v8, 524288, v8
v_add_u32 v9, 524288, v9
Mvaa 236,236,60
Mvaa 144,240,48
s_waitcnt lgkmcnt(6)
Ta 212,21,32768
Ta 214,21,33792
Mvaa 176,240,52
buffer_store_dwordx4 v[52:55], v2, s[24:27], s37 offen offset:3072 sc1
Mvaa 208,240,56
buffer_load_dwordx4 a[0:3], v10, s[20:23], s58 offen offset:0 sc1
Mvaa 240,240,60
Ta 216,22,32768
Ta 218,22,33792
Mvaa 148,244,48
Mvaa 180,244,52
Mvaa 212,244,56
Ta 220,23,32768
Ta 222,23,33792
Mvaa 244,244,60
buffer_load_dwordx4 a[4:7], v10, s[20:23], 0 offen offset:0 sc1
Mvaa 152,248,48
Mvaa 184,248,52
Mvaa 216,248,56
buffer_load_dwordx4 a[8:11], v11, s[20:23], s58 offen offset:0 sc1
Mvaa 248,248,60
Mvaa 156,252,48
Mvaa 188,252,52
buffer_load_dwordx4 a[12:15], v11, s[20:23], 0 offen offset:0 sc1
Mvaa 220,252,56
Mvaa 252,252,60
s_waitcnt vmcnt(31) lgkmcnt(0)
Mvaa 128,192,64
s_add_u32 s37, s38, 8192
Mvaa 160,192,68
Ta 224,16,40960
Ta 226,16,41984
Mvaa 192,192,72
buffer_load_dwordx4 a[16:19], v10, s[20:23], s58 offen offset:1024 sc1
Mvaa 224,192,76
buffer_store_dwordx4 v[56:59], v2, s[24:27], s37 offen offset:0 sc1
Mvaa 132,196,64
Ta 228,17,40960
Ta 230,17,41984
Mvaa 164,196,68
Ar 48,128
Ar 49,129
Mvaa 196,196,72
Ar 50,130
Ar 51,131
Mvaa 228,196,76
Ta 232,18,40960
Ta 234,18,41984
Mvaa 136,200,64
Ar 52,132
Ar 53,133
Mvaa 168,200,68
buffer_load_dwordx4 a[20:23], v10, s[20:23], 0 offen offset:1024 sc1
Mvaa 200,200,72
Ta 236,19,40960
Ta 238,19,41984
Mvaa 232,200,76
Ar 54,134
Ar 55,135
Mvaa 140,204,64
Vc 24,48,49
Vc 25,50,51
Mvaa 172,204,68
Ta 240,20,40960
Ta 242,20,41984
Mvaa 204,204,72
Vc 26,52,53
Vc 27,54,55
Mvaa 236,204,76
Mvaa 144,208,64
s_waitcnt lgkmcnt(6)
Ta 244,21,40960
Ta 246,21,41984
Mvaa 176,208,68
buffer_store_dwordx4 v[60:63], v2, s[24:27], s37 offen offset:1024 sc1
Mvaa 208,208,72
buffer_load_dwordx4 a[24:27], v11, s[20:23], s58 offen offset:1024 sc1
Mvaa 240,208,76
Ta 248,22,40960
Ta 250,22,41984
Mvaa 148,212,64
Ar 48,136
Ar 49,137
Mvaa 180,212,68
Ar 50,138
Ar 51,139
Mvaa 212,212,72
Ta 252,23,40960
Ta 254,23,41984
Mvaa 244,212,76
Ar 52,140
Ar 53,141
Mvaa 152,216,64
Ar 54,142
Ar 55,143
Mvaa 184,216,68
Vc 28,48,49
Vc 29,50,51
Mvaa 216,216,72
buffer_load_dwordx4 a[28:31], v11, s[20:23], 0 offen offset:1024 sc1
Mvaa 248,216,76
Vc 30,52,53
Vc 31,54,55
Mvaa 156,220,64
Mvaa 188,220,68
Mvaa 220,220,72
Mvaa 252,220,76
s_waitcnt vmcnt(32) lgkmcnt(0)
s_barrier
Mvaa 128,224,80
buffer_store_dwordx4 v[64:67], v2, s[24:27], s37 offen offset:2048 sc1
Mvaa 160,224,84
s_add_u32 m0, s44, 32768
Ta 192,16,49152
Ta 194,16,50176
Mvaa 192,224,88
buffer_load_dwordx4 v8, s[8:11], s48 offen offset:0 lds
Mvaa 224,224,92
Ar 48,144
Ar 49,145
Mvaa 132,228,80
Ta 196,17,49152
Ta 198,17,50176
Mvaa 164,228,84
buffer_load_dwordx4 v8, s[8:11], s49 offen offset:1024 lds
Mvaa 196,228,88
Ar 50,146
Ar 51,147
Mvaa 228,228,92
Ta 200,18,49152
Ta 202,18,50176
Mvaa 136,232,80
Ar 52,148
Ar 53,149
Mvaa 168,232,84
buffer_load_dwordx4 v9, s[8:11], s50 offen offset:2048 lds
Mvaa 200,232,88
Ta 204,19,49152
Ta 206,19,50176
Mvaa 232,232,92
Ar 54,150
Ar 55,151
Mvaa 140,236,80
Vc 32,48,49
Vc 33,50,51
Mvaa 172,236,84
Ta 208,20,49152
Ta 210,20,50176
Mvaa 204,236,88
buffer_load_dwordx4 v9, s[8:11], s51 offen offset:3072 lds
v_add_u32 v8, 524288, v8
v_add_u32 v9, 524288, v9
Mvaa 236,236,92
Vc 34,52,53
Vc 35,54,55
Mvaa 144,240,80
s_waitcnt lgkmcnt(6)
Ta 212,21,49152
Ta 214,21,50176
Mvaa 176,240,84
buffer_store_dwordx4 v[68:71], v2, s[24:27], s37 offen offset:3072 sc1
Mvaa 208,240,88
buffer_load_dwordx4 a[32:35], v10, s[20:23], s58 offen offset:2048 sc1
Mvaa 240,240,92
Ta 216,22,49152
Ta 218,22,50176
Mvaa 148,244,80
Ar 48,152
Ar 49,153
Mvaa 180,244,84
Ar 50,154
Ar 51,155
Mvaa 212,244,88
Ta 220,23,49152
Ta 222,23,50176
Mvaa 244,244,92
buffer_load_dwordx4 a[36:39], v10, s[20:23], 0 offen offset:2048 sc1
Mvaa 152,248,80
Ar 52,156
Ar 53,157
Mvaa 184,248,84
Ar 54,158
Ar 55,159
Mvaa 216,248,88
buffer_load_dwordx4 a[40:43], v11, s[20:23], s58 offen offset:2048 sc1
Mvaa 248,248,92
Vc 36,48,49
Vc 37,50,51
Mvaa 156,252,80
Vc 38,52,53
Vc 39,54,55
Mvaa 188,252,84
buffer_load_dwordx4 a[44:47], v11, s[20:23], 0 offen offset:2048 sc1
Mvaa 220,252,88
global_load_dword v13, v[14:15], off
Mvaa 252,252,92
s_waitcnt vmcnt(33) lgkmcnt(0)
Mvaa 128,192,96
s_add_u32 s37, s38, 12288
Mvaa 160,192,100
Ta 224,16,57344
Ta 226,16,58368
Mvaa 192,192,104
buffer_load_dwordx4 a[48:51], v10, s[20:23], s58 offen offset:3072 sc1
Mvaa 224,192,108
buffer_store_dwordx4 v[72:75], v2, s[24:27], s37 offen offset:0 sc1
Mvaa 132,196,96
Ta 228,17,57344
Ta 230,17,58368
Mvaa 164,196,100
Ar 48,160
Ar 49,161
Mvaa 196,196,104
Ar 50,162
Ar 51,163
Mvaa 228,196,108
Ta 232,18,57344
Ta 234,18,58368
Mvaa 136,200,96
Ar 52,164
Ar 53,165
Mvaa 168,200,100
buffer_load_dwordx4 a[52:55], v10, s[20:23], 0 offen offset:3072 sc1
Mvaa 200,200,104
Ta 236,19,57344
Ta 238,19,58368
Mvaa 232,200,108
Ar 54,166
Ar 55,167
Mvaa 140,204,96
Vc 40,48,49
Vc 41,50,51
Mvaa 172,204,100
Ta 240,20,57344
Ta 242,20,58368
Mvaa 204,204,104
Vc 42,52,53
Vc 43,54,55
Mvaa 236,204,108
Mvaa 144,208,96
s_waitcnt lgkmcnt(6)
Ta 244,21,57344
Ta 246,21,58368
Mvaa 176,208,100
buffer_store_dwordx4 v[76:79], v2, s[24:27], s37 offen offset:1024 sc1
Mvaa 208,208,104
buffer_load_dwordx4 a[56:59], v11, s[20:23], s58 offen offset:3072 sc1
Mvaa 240,208,108
Ta 248,22,57344
Ta 250,22,58368
Mvaa 148,212,96
Ar 48,168
Ar 49,169
Mvaa 180,212,100
Ar 50,170
Ar 51,171
Mvaa 212,212,104
Ta 252,23,57344
Ta 254,23,58368
Mvaa 244,212,108
Ar 52,172
Ar 53,173
Mvaa 152,216,96
Ar 54,174
Ar 55,175
Mvaa 184,216,100
Vc 44,48,49
Vc 45,50,51
Mvaa 216,216,104
buffer_load_dwordx4 a[60:63], v11, s[20:23], 0 offen offset:3072 sc1
v_add_u32 v10, 4096, v10
v_add_u32 v11, 4096, v11
Mvaa 248,216,108
Vc 46,52,53
Vc 47,54,55
Mvaa 156,220,96
Mvaa 188,220,100
Mvaa 220,220,104
Mvaa 252,220,108
s_waitcnt vmcnt(33) lgkmcnt(0)
s_barrier
Mvaa 128,224,112
buffer_store_dwordx4 v[80:83], v2, s[24:27], s37 offen offset:2048 sc1
Mvaa 160,224,116
s_add_u32 m0, s44, 49152
Ta 192,16,0
Ta 194,16,1024
Mvaa 192,224,120
buffer_load_dwordx4 v8, s[8:11], s48 offen offset:0 lds
Mvaa 224,224,124
Mvaa 132,228,112
Ta 196,17,0
Ta 198,17,1024
Mvaa 164,228,116
buffer_load_dwordx4 v8, s[8:11], s49 offen offset:1024 lds
Mvaa 196,228,120
Mvaa 228,228,124
Ta 200,18,0
Ta 202,18,1024
Mvaa 136,232,112
Mvaa 168,232,116
buffer_load_dwordx4 v9, s[8:11], s50 offen offset:2048 lds
Mvaa 200,232,120
Ta 204,19,0
Ta 206,19,1024
Mvaa 232,232,124
Mvaa 140,236,112
Mvaa 172,236,116
Ta 208,20,0
Ta 210,20,1024
Mvaa 204,236,120
buffer_load_dwordx4 v9, s[8:11], s51 offen offset:3072 lds
v_add_u32 v8, 524288, v8
v_add_u32 v9, 524288, v9
Mvaa 236,236,124
Mvaa 144,240,112
s_waitcnt lgkmcnt(6)
Ta 212,21,0
Ta 214,21,1024
Mvaa 176,240,116
buffer_store_dwordx4 v[84:87], v2, s[24:27], s37 offen offset:3072 sc1
Mvaa 208,240,120
buffer_load_dwordx4 a[64:67], v10, s[20:23], s58 offen offset:0 sc1
Mvaa 240,240,124
Ta 216,22,0
Ta 218,22,1024
Mvaa 148,244,112
Mvaa 180,244,116
Mvaa 212,244,120
Ta 220,23,0
Ta 222,23,1024
Mvaa 244,244,124
buffer_load_dwordx4 a[68:71], v10, s[20:23], 0 offen offset:0 sc1
Mvaa 152,248,112
Mvaa 184,248,116
Mvaa 216,248,120
buffer_load_dwordx4 a[72:75], v11, s[20:23], s58 offen offset:0 sc1
Mvaa 248,248,124
Mvaa 156,252,112
Mvaa 188,252,116
buffer_load_dwordx4 a[76:79], v11, s[20:23], 0 offen offset:0 sc1
Mvaa 220,252,120
Mvaa 252,252,124
s_waitcnt vmcnt(33) lgkmcnt(0)
Mvaa 128,192,0
s_add_u32 s37, s38, 34816
Mvaa 160,192,4
Ta 224,16,8192
Ta 226,16,9216
Mvaa 192,192,8
buffer_load_dwordx4 a[80:83], v10, s[20:23], s58 offen offset:1024 sc1
Mvaa 224,192,12
buffer_store_dwordx4 v[88:91], v2, s[24:27], s37 offen offset:0 sc1
Mvaa 132,196,0
Ta 228,17,8192
Ta 230,17,9216
Mvaa 164,196,4
Mvaa 196,196,8
Mvaa 228,196,12
Ta 232,18,8192
Ta 234,18,9216
Mvaa 136,200,0
Mvaa 168,200,4
buffer_load_dwordx4 a[84:87], v10, s[20:23], 0 offen offset:1024 sc1
Mvaa 200,200,8
Ta 236,19,8192
Ta 238,19,9216
Mvaa 232,200,12
Mvaa 140,204,0
Mvaa 172,204,4
Ta 240,20,8192
Ta 242,20,9216
Mvaa 204,204,8
Mvaa 236,204,12
Mvaa 144,208,0
s_waitcnt lgkmcnt(6)
Ta 244,21,8192
Ta 246,21,9216
Mvaa 176,208,4
buffer_store_dwordx4 v[92:95], v2, s[24:27], s37 offen offset:1024 sc1
Mvaa 208,208,8
buffer_load_dwordx4 a[88:91], v11, s[20:23], s58 offen offset:1024 sc1
Mvaa 240,208,12
Ta 248,22,8192
Ta 250,22,9216
Mvaa 148,212,0
s_mov_b32 s3, 5242880
s_mov_b32 s47, 5246976
Mvaa 180,212,4
buffer_load_dwordx4 v[56:59], v2, s[20:23], s3 offen offset:0 sc1
Mvaa 212,212,8
Ta 252,23,8192
Ta 254,23,9216
Mvaa 244,212,12
buffer_load_dwordx4 v[60:63], v2, s[20:23], s3 offen offset:1024 sc1
Mvaa 152,216,0
buffer_load_dwordx4 v[64:67], v2, s[20:23], s3 offen offset:2048 sc1
Mvaa 184,216,4
buffer_load_dwordx4 v[68:71], v2, s[20:23], s3 offen offset:3072 sc1
Mvaa 216,216,8
buffer_load_dwordx4 a[92:95], v11, s[20:23], 0 offen offset:1024 sc1
Mvaa 248,216,12
buffer_load_dwordx4 v[72:75], v2, s[20:23], s47 offen offset:0 sc1
Mvaa 156,220,0
buffer_load_dwordx4 v[76:79], v2, s[20:23], s47 offen offset:1024 sc1
Mvaa 188,220,4
buffer_load_dwordx4 v[80:83], v2, s[20:23], s47 offen offset:2048 sc1
Mvaa 220,220,8
buffer_load_dwordx4 v[84:87], v2, s[20:23], s47 offen offset:3072 sc1
Mvaa 252,220,12
s_waitcnt vmcnt(41) lgkmcnt(0)
s_barrier
Mvaa 128,224,16
buffer_store_dwordx4 v[96:99], v2, s[24:27], s37 offen offset:2048 sc1
Mvaa 160,224,20
s_add_u32 m0, s44, 0
Ta 192,16,16384
Ta 194,16,17408
Mvaa 192,224,24
buffer_load_dwordx4 v8, s[8:11], s48 offen offset:0 lds
Mvaa 224,224,28
Mvaa 132,228,16
Ta 196,17,16384
Ta 198,17,17408
Mvaa 164,228,20
buffer_load_dwordx4 v8, s[8:11], s49 offen offset:1024 lds
Mvaa 196,228,24
Mvaa 228,228,28
Ta 200,18,16384
Ta 202,18,17408
Mvaa 136,232,16
Mvaa 168,232,20
buffer_load_dwordx4 v9, s[8:11], s50 offen offset:2048 lds
Mvaa 200,232,24
Ta 204,19,16384
Ta 206,19,17408
Mvaa 232,232,28
Mvaa 140,236,16
Mvaa 172,236,20
Ta 208,20,16384
Ta 210,20,17408
Mvaa 204,236,24
buffer_load_dwordx4 v9, s[8:11], s51 offen offset:3072 lds
v_add_u32 v8, 524288, v8
v_add_u32 v9, 524288, v9
Mvaa 236,236,28
Mvaa 144,240,16
s_waitcnt lgkmcnt(6)
Ta 212,21,16384
Ta 214,21,17408
Mvaa 176,240,20
buffer_store_dwordx4 v[100:103], v2, s[24:27], s37 offen offset:3072 sc1
Mvaa 208,240,24
buffer_load_dwordx4 a[96:99], v10, s[20:23], s58 offen offset:2048 sc1
Mvaa 240,240,28
Ta 216,22,16384
Ta 218,22,17408
Mvaa 148,244,16
Mvaa 180,244,20
Mvaa 212,244,24
Ta 220,23,16384
Ta 222,23,17408
Mvaa 244,244,28
buffer_load_dwordx4 a[100:103], v10, s[20:23], 0 offen offset:2048 sc1
Mvaa 152,248,16
Mvaa 184,248,20
Mvaa 216,248,24
buffer_load_dwordx4 a[104:107], v11, s[20:23], s58 offen offset:2048 sc1
Mvaa 248,248,28
Mvaa 156,252,16
Mvaa 188,252,20
buffer_load_dwordx4 a[108:111], v11, s[20:23], 0 offen offset:2048 sc1
Mvaa 220,252,24
Mvaa 252,252,28
s_waitcnt vmcnt(41) lgkmcnt(0)
Mvaa 128,192,32
s_add_u32 s37, s38, 38912
Mvaa 160,192,36
Ta 224,16,24576
Ta 226,16,25600
Mvaa 192,192,40
buffer_load_dwordx4 a[112:115], v10, s[20:23], s58 offen offset:3072 sc1
Mvaa 224,192,44
buffer_store_dwordx4 v[104:107], v2, s[24:27], s37 offen offset:0 sc1
Mvaa 132,196,32
Ta 228,17,24576
Ta 230,17,25600
Mvaa 164,196,36
Mvaa 196,196,40
Mvaa 228,196,44
Ta 232,18,24576
Ta 234,18,25600
Mvaa 136,200,32
Mvaa 168,200,36
buffer_load_dwordx4 a[116:119], v10, s[20:23], 0 offen offset:3072 sc1
Mvaa 200,200,40
Ta 236,19,24576
Ta 238,19,25600
Mvaa 232,200,44
Mvaa 140,204,32
Mvaa 172,204,36
Ta 240,20,24576
Ta 242,20,25600
Mvaa 204,204,40
Mvaa 236,204,44
Mvaa 144,208,32
s_waitcnt lgkmcnt(6)
Ta 244,21,24576
Ta 246,21,25600
Mvaa 176,208,36
buffer_store_dwordx4 v[108:111], v2, s[24:27], s37 offen offset:1024 sc1
Mvaa 208,208,40
buffer_load_dwordx4 a[120:123], v11, s[20:23], s58 offen offset:3072 sc1
Mvaa 240,208,44
Ta 248,22,24576
Ta 250,22,25600
Mvaa 148,212,32
Mvaa 180,212,36
Mvaa 212,212,40
Ta 252,23,24576
Ta 254,23,25600
Mvaa 244,212,44
Mvaa 152,216,32
Mvaa 184,216,36
Mvaa 216,216,40
buffer_load_dwordx4 a[124:127], v11, s[20:23], 0 offen offset:3072 sc1
v_add_u32 v10, 4096, v10
v_add_u32 v11, 4096, v11
Mvaa 248,216,44
Mvaa 156,220,32
Mvaa 188,220,36
Mvaa 220,220,40
Mvaa 252,220,44
s_waitcnt vmcnt(40) lgkmcnt(0)
s_barrier
Mvaa 128,224,48
buffer_store_dwordx4 v[112:115], v2, s[24:27], s37 offen offset:2048 sc1
Mvaa 160,224,52
s_add_u32 m0, s44, 16384
Ta 192,16,32768
Ta 194,16,33792
Mvaa 192,224,56
buffer_load_dwordx4 v8, s[8:11], s48 offen offset:0 lds
Mvaa 224,224,60
Mvaa 132,228,48
Ta 196,17,32768
Ta 198,17,33792
Mvaa 164,228,52
buffer_load_dwordx4 v8, s[8:11], s49 offen offset:1024 lds
Mvaa 196,228,56
Mvaa 228,228,60
Ta 200,18,32768
Ta 202,18,33792
Mvaa 136,232,48
Mvaa 168,232,52
buffer_load_dwordx4 v9, s[8:11], s50 offen offset:2048 lds
Mvaa 200,232,56
Ta 204,19,32768
Ta 206,19,33792
Mvaa 232,232,60
Mvaa 140,236,48
Mvaa 172,236,52
Ta 208,20,32768
Ta 210,20,33792
Mvaa 204,236,56
buffer_load_dwordx4 v9, s[8:11], s51 offen offset:3072 lds
v_add_u32 v8, 524288, v8
v_add_u32 v9, 524288, v9
Mvaa 236,236,60
Mvaa 144,240,48
s_waitcnt lgkmcnt(6)
Ta 212,21,32768
Ta 214,21,33792
Mvaa 176,240,52
buffer_store_dwordx4 v[116:119], v2, s[24:27], s37 offen offset:3072 sc1
Mvaa 208,240,56
buffer_load_dwordx4 a[0:3], v10, s[20:23], s58 offen offset:0 sc1
Mvaa 240,240,60
Ta 216,22,32768
Ta 218,22,33792
Mvaa 148,244,48
Mvaa 180,244,52
Mvaa 212,244,56
Ta 220,23,32768
Ta 222,23,33792
Mvaa 244,244,60
buffer_load_dwordx4 a[4:7], v10, s[20:23], 0 offen offset:0 sc1
Mvaa 152,248,48
Mvaa 184,248,52
Mvaa 216,248,56
buffer_load_dwordx4 a[8:11], v11, s[20:23], s58 offen offset:0 sc1
Mvaa 248,248,60
Mvaa 156,252,48
Mvaa 188,252,52
buffer_load_dwordx4 a[12:15], v11, s[20:23], 0 offen offset:0 sc1
Mvaa 220,252,56
Mvaa 252,252,60
s_waitcnt vmcnt(40) lgkmcnt(0)
Mvaa 128,192,64
s_add_u32 s37, s38, 43008
Mvaa 160,192,68
Ta 224,16,40960
Ta 226,16,41984
Mvaa 192,192,72
buffer_load_dwordx4 a[16:19], v10, s[20:23], s58 offen offset:1024 sc1
Mvaa 224,192,76
buffer_store_dwordx4 v[120:123], v2, s[24:27], s37 offen offset:0 sc1
Mvaa 132,196,64
Ta 228,17,40960
Ta 230,17,41984
Mvaa 164,196,68
Mvaa 196,196,72
Mvaa 228,196,76
Ta 232,18,40960
Ta 234,18,41984
Mvaa 136,200,64
Mvaa 168,200,68
buffer_load_dwordx4 a[20:23], v10, s[20:23], 0 offen offset:1024 sc1
Mvaa 200,200,72
Ta 236,19,40960
Ta 238,19,41984
Mvaa 232,200,76
Mvaa 140,204,64
Mvaa 172,204,68
Ta 240,20,40960
Ta 242,20,41984
Mvaa 204,204,72
Mvaa 236,204,76
Mvaa 144,208,64
s_waitcnt lgkmcnt(6)
Ta 244,21,40960
Ta 246,21,41984
Mvaa 176,208,68
buffer_store_dwordx4 v[124:127], v2, s[24:27], s37 offen offset:1024 sc1
Mvaa 208,208,72
buffer_load_dwordx4 a[24:27], v11, s[20:23], s58 offen offset:1024 sc1
Mvaa 240,208,76
Ta 248,22,40960
Ta 250,22,41984
Mvaa 148,212,64
Mvaa 180,212,68
Mvaa 212,212,72
Ta 252,23,40960
Ta 254,23,41984
Mvaa 244,212,76
Mvaa 152,216,64
Mvaa 184,216,68
Mvaa 216,216,72
buffer_load_dwordx4 a[28:31], v11, s[20:23], 0 offen offset:1024 sc1
Mvaa 248,216,76
Mvaa 156,220,64
Mvaa 188,220,68
Mvaa 220,220,72
Mvaa 252,220,76
s_waitcnt vmcnt(36) lgkmcnt(0)
s_barrier
Mvaa 128,224,80
buffer_store_dwordx4 v[24:27], v2, s[24:27], s37 offen offset:2048 sc1
Mvaa 160,224,84
s_add_u32 m0, s44, 32768
Ta 192,16,49152
Ta 194,16,50176
Mvaa 192,224,88
buffer_load_dwordx4 v8, s[8:11], s48 offen offset:0 lds
Mvaa 224,224,92
Mvaa 132,228,80
Ta 196,17,49152
Ta 198,17,50176
Mvaa 164,228,84
buffer_load_dwordx4 v8, s[8:11], s49 offen offset:1024 lds
Mvaa 196,228,88
Mvaa 228,228,92
Ta 200,18,49152
Ta 202,18,50176
Mvaa 136,232,80
Mvaa 168,232,84
buffer_load_dwordx4 v9, s[8:11], s50 offen offset:2048 lds
Mvaa 200,232,88
Ta 204,19,49152
Ta 206,19,50176
Mvaa 232,232,92
Mvaa 140,236,80
Mvaa 172,236,84
Ta 208,20,49152
Ta 210,20,50176
Mvaa 204,236,88
buffer_load_dwordx4 v9, s[8:11], s51 offen offset:3072 lds
v_add_u32 v8, 524288, v8
v_add_u32 v9, 524288, v9
Mvaa 236,236,92
Mvaa 144,240,80
s_waitcnt lgkmcnt(6)
Ta 212,21,49152
Ta 214,21,50176
Mvaa 176,240,84
buffer_store_dwordx4 v[28:31], v2, s[24:27], s37 offen offset:3072 sc1
Mvaa 208,240,88
buffer_load_dwordx4 a[32:35], v10, s[20:23], s58 offen offset:2048 sc1
Mvaa 240,240,92
Ta 216,22,49152
Ta 218,22,50176
Mvaa 148,244,80
Mvaa 180,244,84
Mvaa 212,244,88
Ta 220,23,49152
Ta 222,23,50176
Mvaa 244,244,92
buffer_load_dwordx4 a[36:39], v10, s[20:23], 0 offen offset:2048 sc1
Mvaa 152,248,80
Mvaa 184,248,84
Mvaa 216,248,88
buffer_load_dwordx4 a[40:43], v11, s[20:23], s58 offen offset:2048 sc1
Mvaa 248,248,92
Mvaa 156,252,80
Mvaa 188,252,84
buffer_load_dwordx4 a[44:47], v11, s[20:23], 0 offen offset:2048 sc1
Mvaa 220,252,88
Mvaa 252,252,92
s_waitcnt vmcnt(32) lgkmcnt(0)
Mvaa 128,192,96
s_add_u32 s37, s38, 47104
Mvaa 160,192,100
Ta 224,16,57344
Ta 226,16,58368
Mvaa 192,192,104
buffer_load_dwordx4 a[48:51], v10, s[20:23], s58 offen offset:3072 sc1
Mvaa 224,192,108
buffer_store_dwordx4 v[32:35], v2, s[24:27], s37 offen offset:0 sc1
Mvaa 132,196,96
Ta 228,17,57344
Ta 230,17,58368
Mvaa 164,196,100
Mvaa 196,196,104
Mvaa 228,196,108
Ta 232,18,57344
Ta 234,18,58368
Mvaa 136,200,96
Mvaa 168,200,100
buffer_load_dwordx4 a[52:55], v10, s[20:23], 0 offen offset:3072 sc1
Mvaa 200,200,104
Ta 236,19,57344
Ta 238,19,58368
Mvaa 232,200,108
Mvaa 140,204,96
Mvaa 172,204,100
Ta 240,20,57344
Ta 242,20,58368
Mvaa 204,204,104
Mvaa 236,204,108
Mvaa 144,208,96
s_waitcnt lgkmcnt(6)
Ta 244,21,57344
Ta 246,21,58368
Mvaa 176,208,100
buffer_store_dwordx4 v[36:39], v2, s[24:27], s37 offen offset:1024 sc1
Mvaa 208,208,104
buffer_load_dwordx4 a[56:59], v11, s[20:23], s58 offen offset:3072 sc1
Mvaa 240,208,108
Ta 248,22,57344
Ta 250,22,58368
Mvaa 148,212,96
Mvaa 180,212,100
Mvaa 212,212,104
Ta 252,23,57344
Ta 254,23,58368
Mvaa 244,212,108
Mvaa 152,216,96
Mvaa 184,216,100
Mvaa 216,216,104
buffer_load_dwordx4 a[60:63], v11, s[20:23], 0 offen offset:3072 sc1
v_add_u32 v10, 4096, v10
v_add_u32 v11, 4096, v11
Mvaa 248,216,108
Mvaa 156,220,96
Mvaa 188,220,100
Mvaa 220,220,104
Mvaa 252,220,108
s_waitcnt vmcnt(32) lgkmcnt(0)
s_barrier
Mvaa 128,224,112
buffer_store_dwordx4 v[40:43], v2, s[24:27], s37 offen offset:2048 sc1
Mvaa 160,224,116
s_add_u32 m0, s44, 49152
Ta 192,16,0
Ta 194,16,1024
Mvaa 192,224,120
buffer_load_dwordx4 v8, s[8:11], s48 offen offset:0 lds
Mvaa 224,224,124
Mvaa 132,228,112
Ta 196,17,0
Ta 198,17,1024
Mvaa 164,228,116
buffer_load_dwordx4 v8, s[8:11], s49 offen offset:1024 lds
Mvaa 196,228,120
Mvaa 228,228,124
Ta 200,18,0
Ta 202,18,1024
Mvaa 136,232,112
Mvaa 168,232,116
buffer_load_dwordx4 v9, s[8:11], s50 offen offset:2048 lds
Mvaa 200,232,120
Ta 204,19,0
Ta 206,19,1024
Mvaa 232,232,124
Mvaa 140,236,112
Mvaa 172,236,116
Ta 208,20,0
Ta 210,20,1024
Mvaa 204,236,120
buffer_load_dwordx4 v9, s[8:11], s51 offen offset:3072 lds
v_add_u32 v8, 524288, v8
v_add_u32 v9, 524288, v9
Mvaa 236,236,124
Mvaa 144,240,112
s_waitcnt lgkmcnt(6)
Ta 212,21,0
Ta 214,21,1024
Mvaa 176,240,116
buffer_store_dwordx4 v[44:47], v2, s[24:27], s37 offen offset:3072 sc1
Mvaa 208,240,120
buffer_load_dwordx4 a[64:67], v10, s[20:23], s58 offen offset:0 sc1
Mvaa 240,240,124
Ta 216,22,0
Ta 218,22,1024
Mvaa 148,244,112
v_mov_b32 v12, 1
v_and_b32_e64 v1, 15, v0
Mvaa 180,244,116
v_lshlrev_b32_e64 v1, 2, v1
Mvaa 212,244,120
Ta 220,23,0
Ta 222,23,1024
Mvaa 244,244,124
buffer_load_dwordx4 a[68:71], v10, s[20:23], 0 offen offset:0 sc1
Mvaa 152,248,112
s_lshr_b32 s6, s33, 1
s_lshl_b32 s6, s6, 7
s_add_u32 s6, s6, 5296128
Mvaa 184,248,116
s_cmp_eq_u32 s32, 0
s_cselect_b32 s6, s6, 2146435072
Mvaa 216,248,120
buffer_load_dwordx4 a[72:75], v11, s[20:23], s58 offen offset:0 sc1
Mvaa 248,248,124
Mvaa 156,252,112
Mvaa 188,252,116
buffer_load_dwordx4 a[76:79], v11, s[20:23], 0 offen offset:0 sc1
Mvaa 220,252,120
Mvaa 252,252,124
s_waitcnt vmcnt(32) lgkmcnt(0)
Mvaa 128,192,0
Mvaa 160,192,4
Ta 224,16,8192
Ta 226,16,9216
Mvaa 192,192,8
buffer_load_dwordx4 a[80:83], v10, s[20:23], s58 offen offset:1024 sc1
Mvaa 224,192,12
Mvaa 132,196,0
Ta 228,17,8192
Ta 230,17,9216
Mvaa 164,196,4
Mvaa 196,196,8
Mvaa 228,196,12
Ta 232,18,8192
Ta 234,18,9216
Mvaa 136,200,0
Mvaa 168,200,4
buffer_load_dwordx4 a[84:87], v10, s[20:23], 0 offen offset:1024 sc1
Mvaa 200,200,8
Ta 236,19,8192
Ta 238,19,9216
Mvaa 232,200,12
Mvaa 140,204,0
Mvaa 172,204,4
Ta 240,20,8192
Ta 242,20,9216
Mvaa 204,204,8
Mvaa 236,204,12
Mvaa 144,208,0
s_waitcnt lgkmcnt(6)
Ta 244,21,8192
Ta 246,21,9216
Mvaa 176,208,4
v_max_u32 v14, v56, v57
v_min_u32_e64 v15, v56, v57
Mvaa 208,208,8
buffer_load_dwordx4 a[88:91], v11, s[20:23], s58 offen offset:1024 sc1
Mvaa 240,208,12
Ta 248,22,8192
Ta 250,22,9216
Mvaa 148,212,0
v_med3_u32 v15, v14, v15, v58
v_max_u32_e64 v14, v14, v58
Mvaa 180,212,4
v_med3_u32 v15, v14, v15, v59
v_max_u32_e64 v14, v14, v59
Mvaa 212,212,8
Ta 252,23,8192
Ta 254,23,9216
Mvaa 244,212,12
v_med3_u32 v15, v14, v15, v60
v_max_u32_e64 v14, v14, v60
Mvaa 152,216,0
v_med3_u32 v15, v14, v15, v61
v_max_u32_e64 v14, v14, v61
Mvaa 184,216,4
v_med3_u32 v15, v14, v15, v62
v_max_u32_e64 v14, v14, v62
Mvaa 216,216,8
buffer_load_dwordx4 a[92:95], v11, s[20:23], 0 offen offset:1024 sc1
Mvaa 248,216,12
v_med3_u32 v15, v14, v15, v63
v_max_u32_e64 v14, v14, v63
Mvaa 156,220,0
v_med3_u32 v15, v14, v15, v64
v_max_u32_e64 v14, v14, v64
Mvaa 188,220,4
v_med3_u32 v15, v14, v15, v65
v_max_u32_e64 v14, v14, v65
Mvaa 220,220,8
v_med3_u32 v15, v14, v15, v66
v_max_u32_e64 v14, v14, v66
Mvaa 252,220,12
v_med3_u32 v15, v14, v15, v67
v_max_u32 v14, v14, v67
s_waitcnt vmcnt(30) lgkmcnt(0)
s_barrier
Mvaa 128,224,16
v_med3_u32 v15, v14, v15, v68
v_max_u32 v14, v14, v68
Mvaa 160,224,20
s_add_u32 m0, s44, 0
Ta 192,16,16384
Ta 194,16,17408
Mvaa 192,224,24
buffer_load_dwordx4 v8, s[8:11], s48 offen offset:0 lds
Mvaa 224,224,28
v_med3_u32 v15, v14, v15, v69
v_max_u32 v14, v14, v69
Mvaa 132,228,16
Ta 196,17,16384
Ta 198,17,17408
Mvaa 164,228,20
buffer_load_dwordx4 v8, s[8:11], s49 offen offset:1024 lds
Mvaa 196,228,24
v_med3_u32 v15, v14, v15, v70
v_max_u32_e64 v14, v14, v70
Mvaa 228,228,28
Ta 200,18,16384
Ta 202,18,17408
Mvaa 136,232,16
v_med3_u32 v15, v14, v15, v71
v_max_u32_e64 v14, v14, v71
Mvaa 168,232,20
buffer_load_dwordx4 v9, s[8:11], s50 offen offset:2048 lds
Mvaa 200,232,24
Ta 204,19,16384
Ta 206,19,17408
Mvaa 232,232,28
v_med3_u32 v15, v14, v15, v72
v_max_u32_e64 v14, v14, v72
Mvaa 140,236,16
v_med3_u32 v15, v14, v15, v73
v_max_u32_e64 v14, v14, v73
Mvaa 172,236,20
Ta 208,20,16384
Ta 210,20,17408
Mvaa 204,236,24
buffer_load_dwordx4 v9, s[8:11], s51 offen offset:3072 lds
v_add_u32 v8, 524288, v8
v_add_u32 v9, 524288, v9
Mvaa 236,236,28
v_med3_u32 v15, v14, v15, v74
v_max_u32_e64 v14, v14, v74
Mvaa 144,240,16
s_waitcnt lgkmcnt(6)
Ta 212,21,16384
Ta 214,21,17408
Mvaa 176,240,20
v_med3_u32 v15, v14, v15, v75
v_max_u32 v14, v14, v75
Mvaa 208,240,24
buffer_load_dwordx4 a[96:99], v10, s[20:23], s58 offen offset:2048 sc1
Mvaa 240,240,28
Ta 216,22,16384
Ta 218,22,17408
Mvaa 148,244,16
v_med3_u32 v15, v14, v15, v76
v_max_u32_e64 v14, v14, v76
Mvaa 180,244,20
v_med3_u32 v15, v14, v15, v77
v_max_u32_e64 v14, v14, v77
Mvaa 212,244,24
Ta 220,23,16384
Ta 222,23,17408
Mvaa 244,244,28
buffer_load_dwordx4 a[100:103], v10, s[20:23], 0 offen offset:2048 sc1
Mvaa 152,248,16
v_med3_u32 v15, v14, v15, v78
v_max_u32_e64 v14, v14, v78
Mvaa 184,248,20
v_med3_u32 v15, v14, v15, v79
v_max_u32_e64 v14, v14, v79
Mvaa 216,248,24
buffer_load_dwordx4 a[104:107], v11, s[20:23], s58 offen offset:2048 sc1
Mvaa 248,248,28
v_med3_u32 v15, v14, v15, v80
v_max_u32_e64 v14, v14, v80
Mvaa 156,252,16
v_med3_u32 v15, v14, v15, v81
v_max_u32_e64 v14, v14, v81
Mvaa 188,252,20
buffer_load_dwordx4 a[108:111], v11, s[20:23], 0 offen offset:2048 sc1
Mvaa 220,252,24
v_med3_u32 v15, v14, v15, v82
v_max_u32_e64 v14, v14, v82
Mvaa 252,252,28
v_med3_u32 v15, v14, v15, v83
v_max_u32 v14, v14, v83
s_waitcnt vmcnt(28) lgkmcnt(0)
Mvaa 128,192,32
v_med3_u32 v15, v14, v15, v84
v_max_u32_e64 v14, v14, v84
Mvaa 160,192,36
Ta 224,16,24576
Ta 226,16,25600
Mvaa 192,192,40
buffer_load_dwordx4 a[112:115], v10, s[20:23], s58 offen offset:3072 sc1
Mvaa 224,192,44
v_med3_u32 v15, v14, v15, v85
v_max_u32_e64 v14, v14, v85
Mvaa 132,196,32
Ta 228,17,24576
Ta 230,17,25600
Mvaa 164,196,36
v_med3_u32 v15, v14, v15, v86
v_max_u32_e64 v14, v14, v86
Mvaa 196,196,40
v_med3_u32 v15, v14, v15, v87
v_max_u32_e64 v14, v14, v87
Mvaa 228,196,44
Ta 232,18,24576
Ta 234,18,25600
Mvaa 136,200,32
v_mov_b32_e64 v13, v14
Mvaa 168,200,36
buffer_load_dwordx4 a[116:119], v10, s[20:23], 0 offen offset:3072 sc1
Mvaa 200,200,40
Ta 236,19,24576
Ta 238,19,25600
Mvaa 232,200,44
v_max_u32_dpp v13, v13, v13 quad_perm:[1,0,3,2] row_mask:0xf bank_mask:0xf
Mvaa 140,204,32
s_nop 0
v_max_u32_dpp v13, v13, v13 quad_perm:[2,3,0,1] row_mask:0xf bank_mask:0xf
Mvaa 172,204,36
Ta 240,20,24576
Ta 242,20,25600
Mvaa 204,204,40
v_max_u32_dpp v13, v13, v13 row_half_mirror row_mask:0xf bank_mask:0xf
Mvaa 236,204,44
s_nop 0
v_max_u32_dpp v13, v13, v13 row_mirror row_mask:0xf bank_mask:0xf
Mvaa 144,208,32
s_waitcnt lgkmcnt(6)
Ta 244,21,24576
Ta 246,21,25600
Mvaa 176,208,36
v_readlane_b32 s3, v13, 0
v_readlane_b32 s47, v13, 16
Mvaa 208,208,40
buffer_load_dwordx4 a[120:123], v11, s[20:23], s58 offen offset:3072 sc1
Mvaa 240,208,44
Ta 248,22,24576
Ta 250,22,25600
Mvaa 148,212,32
v_readlane_b32 s4, v13, 32
v_readlane_b32 s5, v13, 48
Mvaa 180,212,36
s_max_u32 s3, s3, s47
s_max_u32 s4, s4, s5
s_max_u32 s40, s3, s4
Mvaa 212,212,40
Ta 252,23,24576
Ta 254,23,25600
Mvaa 244,212,44
v_cmp_eq_u32 vcc, s40, v14
Mvaa 152,216,32
s_nop 0
v_cndmask_b32 v13, v14, v15, vcc
Mvaa 184,216,36
s_nop 0
v_max_u32_dpp v13, v13, v13 quad_perm:[1,0,3,2] row_mask:0xf bank_mask:0xf
Mvaa 216,216,40
buffer_load_dwordx4 a[124:127], v11, s[20:23], 0 offen offset:3072 sc1
v_add_u32 v10, 4096, v10
v_add_u32 v11, 4096, v11
Mvaa 248,216,44
v_max_u32_dpp v13, v13, v13 quad_perm:[2,3,0,1] row_mask:0xf bank_mask:0xf
Mvaa 156,220,32
s_nop 0
v_max_u32_dpp v13, v13, v13 row_half_mirror row_mask:0xf bank_mask:0xf
Mvaa 188,220,36
s_nop 0
v_max_u32_dpp v13, v13, v13 row_mirror row_mask:0xf bank_mask:0xf
Mvaa 220,220,40
v_readlane_b32 s3, v13, 0
v_readlane_b32 s47, v13, 16
Mvaa 252,220,44
v_readlane_b32 s4, v13, 32
v_readlane_b32 s5, v13, 48
s_waitcnt vmcnt(26) lgkmcnt(0)
s_barrier
Mvaa 128,224,48
s_max_u32 s3, s3, s47
s_max_u32 s4, s4, s5
s_max_u32 s41, s3, s4
Mvaa 160,224,52
s_add_u32 m0, s44, 16384
Ta 192,16,32768
Ta 194,16,33792
Mvaa 192,224,56
buffer_load_dwordx4 v8, s[8:11], s48 offen offset:0 lds
Mvaa 224,224,60
s_and_b32 s3, s40, 0xffff
s_sub_u32 s42, 0xffff, s3
s_and_b32 s3, s41, 0xffff
Mvaa 132,228,48
Ta 196,17,32768
Ta 198,17,33792
Mvaa 164,228,52
buffer_load_dwordx4 v8, s[8:11], s49 offen offset:1024 lds
Mvaa 196,228,56
s_sub_u32 s43, 0xffff, s3
v_mov_b32 v60, s40
v_not_b32_e64 v61, v60
Mvaa 228,228,60
Ta 200,18,32768
Ta 202,18,33792
Mvaa 136,232,48
v_ashrrev_i32_e64 v61, 31, v61
v_or_b32 v61, 0x80000000, v61
Mvaa 168,232,52
buffer_load_dwordx4 v9, s[8:11], s50 offen offset:2048 lds
Mvaa 200,232,56
Ta 204,19,32768
Ta 206,19,33792
Mvaa 232,232,60
v_xor_b32_e64 v60, v60, v61
v_and_b32 v60, 0xffff0000, v60
Mvaa 140,236,48
v_mul_f32 v60, 0xbfb8aa3b, v60
Mvaa 172,236,52
Ta 208,20,32768
Ta 210,20,33792
Mvaa 204,236,56
buffer_load_dwordx4 v9, s[8:11], s51 offen offset:3072 lds
v_add_u32 v8, 524288, v8
v_add_u32 v9, 524288, v9
Mvaa 236,236,60
VE 60,60
Mvaa 144,240,48
s_waitcnt lgkmcnt(6)
Ta 212,21,32768
Ta 214,21,33792
Mvaa 176,240,52
v_add_f32 v60, 1.0, v60
Mvaa 208,240,56
buffer_load_dwordx4 a[0:3], v10, s[20:23], s58 offen offset:0 sc1
Mvaa 240,240,60
Ta 216,22,32768
Ta 218,22,33792
Mvaa 148,244,48
v_rcp_f32_e64 v60, v60
Mvaa 180,244,52
Vc 60,60,60
v_and_b32 v64, 0xffff0000, v60
Mvaa 212,244,56
Ta 220,23,32768
Ta 222,23,33792
Mvaa 244,244,60
buffer_load_dwordx4 a[4:7], v10, s[20:23], 0 offen offset:0 sc1
Mvaa 152,248,48
v_mov_b32 v60, s41
v_not_b32 v61, v60
Mvaa 184,248,52
v_ashrrev_i32_e64 v61, 31, v61
v_or_b32 v61, 0x80000000, v61
Mvaa 216,248,56
buffer_load_dwordx4 a[8:11], v11, s[20:23], s58 offen offset:0 sc1
Mvaa 248,248,60
v_xor_b32_e64 v60, v60, v61
v_and_b32 v60, 0xffff0000, v60
Mvaa 156,252,48
v_mul_f32 v60, 0xbfb8aa3b, v60
Mvaa 188,252,52
buffer_load_dwordx4 a[12:15], v11, s[20:23], 0 offen offset:0 sc1
Mvaa 220,252,56
VE 60,60
Mvaa 252,252,60
v_add_f32 v60, 1.0, v60
s_waitcnt vmcnt(24) lgkmcnt(0)
Mvaa 128,192,64
v_rcp_f32_e64 v60, v60
Mvaa 160,192,68
Ta 224,16,40960
Ta 226,16,41984
Mvaa 192,192,72
buffer_load_dwordx4 a[16:19], v10, s[20:23], s58 offen offset:1024 sc1
Mvaa 224,192,76
Vc 60,60,60
v_and_b32 v65, 0xffff0000, v60
Mvaa 132,196,64
Ta 228,17,40960
Ta 230,17,41984
Mvaa 164,196,68
v_mov_b32 v48, 0
v_mov_b32 v49, 0
Mvaa 196,196,72
v_mov_b32 v50, 0
v_mov_b32 v51, 0
Mvaa 228,196,76
Ta 232,18,40960
Ta 234,18,41984
Mvaa 136,200,64
v_mov_b32 v52, 0
v_mov_b32 v53, 0
Mvaa 168,200,68
buffer_load_dwordx4 a[20:23], v10, s[20:23], 0 offen offset:1024 sc1
Mvaa 200,200,72
Ta 236,19,40960
Ta 238,19,41984
Mvaa 232,200,76
v_mov_b32 v54, 0
v_mov_b32 v55, 0
Mvaa 140,204,64
v_mov_b32 v56, 0
v_mov_b32 v57, 0
Mvaa 172,204,68
Ta 240,20,40960
Ta 242,20,41984
Mvaa 204,204,72
v_mov_b32 v58, 0
v_mov_b32 v59, 0
Mvaa 236,204,76
v_mov_b32 v60, 0
v_mov_b32 v61, 0
Mvaa 144,208,64
s_waitcnt lgkmcnt(6)
Ta 244,21,40960
Ta 246,21,41984
Mvaa 176,208,68
v_mov_b32 v62, 0
v_mov_b32_e64 v63, 0
Mvaa 208,208,72
buffer_load_dwordx4 a[24:27], v11, s[20:23], s58 offen offset:1024 sc1
Mvaa 240,208,76
Ta 248,22,40960
Ta 250,22,41984
Mvaa 148,212,64
s_mul_i32 s3, s34, s34
s_mul_i32 s47, s33, 48
s_add_u32 s3, s3, s47
Mvaa 180,212,68
s_lshl_b32 s3, s3, 2
s_add_u32 s3, s3, s32
s_lshl_b32 s3, s3, 7
Mvaa 212,212,72
Ta 252,23,40960
Ta 254,23,41984
Mvaa 244,212,76
s_sub_u32 s3, s3, 8704
s_cmp_ge_u32 s34, 4
s_cselect_b32 s3, s3, 0
s_cselect_b32 s40, 512, 0
s_cselect_b32 s47, 786432, 0
Mvaa 152,216,64
v_subrev_u32_e64 v31, 0, v0
v_mul_lo_u32 v31, v31, s47
Mvaa 184,216,68
v_min_u32 v31, 6553600, v31
v_mov_b32_e64 v28, s94
Mvaa 216,216,72
buffer_load_dwordx4 a[28:31], v11, s[20:23], 0 offen offset:1024 sc1
Mvaa 248,216,76
v_mov_b32 v29, s95
v_mov_b32 v30, v31
Mvaa 156,220,64
v_subrev_u32_e64 v31, 10, v0
v_mul_lo_u32 v31, v31, s47
Mvaa 188,220,68
v_min_u32 v31, 3407872, v31
v_mov_b32_e64 v14, s100
Mvaa 220,220,72
v_mov_b32_e64 v15, s101
Mvaa 252,220,76
v_cmp_le_u32 vcc, 10, v0
s_waitcnt vmcnt(24) lgkmcnt(0)
s_barrier
Mvaa 128,224,80
s_mov_b64 exec, 1
buffer_store_dword v12, v7, s[20:23], s39 offen sc1
s_mov_b64 exec, -1
Mvaa 160,224,84
s_add_u32 m0, s44, 32768
Ta 192,16,49152
Ta 194,16,50176
Mvaa 192,224,88
buffer_load_dwordx4 v8, s[8:11], s48 offen offset:0 lds
Mvaa 224,224,92
v_cndmask_b32 v28, v28, v14, vcc
v_cndmask_b32 v29, v29, v15, vcc
Mvaa 132,228,80
Ta 196,17,49152
Ta 198,17,50176
Mvaa 164,228,84
buffer_load_dwordx4 v8, s[8:11], s49 offen offset:1024 lds
Mvaa 196,228,88
v_cndmask_b32 v30, v30, v31, vcc
Mvaa 228,228,92
Ta 200,18,49152
Ta 202,18,50176
Mvaa 136,232,80
v_subrev_u32_e64 v31, 16, v0
v_mul_lo_u32 v31, v31, s47
Mvaa 168,232,84
buffer_load_dwordx4 v9, s[8:11], s50 offen offset:2048 lds
Mvaa 200,232,88
Ta 204,19,49152
Ta 206,19,50176
Mvaa 232,232,92
v_min_u32 v31, 6553600, v31
v_mov_b32_e64 v14, s60
Mvaa 140,236,80
v_mov_b32_e64 v15, s61
Mvaa 172,236,84
Ta 208,20,49152
Ta 210,20,50176
Mvaa 204,236,88
buffer_load_dwordx4 v9, s[8:11], s51 offen offset:3072 lds
v_add_u32 v8, 524288, v8
v_add_u32 v9, 524288, v9
Mvaa 236,236,92
v_cmp_le_u32 vcc, 16, v0
Mvaa 144,240,80
s_waitcnt lgkmcnt(6)
Ta 212,21,49152
Ta 214,21,50176
Mvaa 176,240,84
v_cndmask_b32 v28, v28, v14, vcc
v_cndmask_b32 v29, v29, v15, vcc
Mvaa 208,240,88
buffer_load_dwordx4 a[32:35], v10, s[20:23], s58 offen offset:2048 sc1
Mvaa 240,240,92
Ta 216,22,49152
Ta 218,22,50176
Mvaa 148,244,80
v_cndmask_b32 v30, v30, v31, vcc
Mvaa 180,244,84
v_subrev_u32 v31, 26, v0
v_mul_lo_u32 v31, v31, s47
Mvaa 212,244,88
Ta 220,23,49152
Ta 222,23,50176
Mvaa 244,244,92
buffer_load_dwordx4 a[36:39], v10, s[20:23], 0 offen offset:2048 sc1
Mvaa 152,248,80
v_min_u32 v31, 6553600, v31
v_mov_b32_e64 v14, s68
Mvaa 184,248,84
v_mov_b32_e64 v15, s69
Mvaa 216,248,88
buffer_load_dwordx4 a[40:43], v11, s[20:23], s58 offen offset:2048 sc1
Mvaa 248,248,92
v_cmp_le_u32 vcc, 26, v0
Mvaa 156,252,80
s_nop 0
v_cndmask_b32 v28, v28, v14, vcc
v_cndmask_b32 v29, v29, v15, vcc
Mvaa 188,252,84
buffer_load_dwordx4 a[44:47], v11, s[20:23], 0 offen offset:2048 sc1
Mvaa 220,252,88
v_cndmask_b32 v30, v30, v31, vcc
Mvaa 252,252,92
v_subrev_u32 v31, 36, v0
v_mul_lo_u32 v31, v31, s47
s_waitcnt vmcnt(25) lgkmcnt(0)
Mvaa 128,192,96
v_min_u32 v31, 7602176, v31
v_mov_b32 v14, s92
Mvaa 160,192,100
Ta 224,16,57344
Ta 226,16,58368
Mvaa 192,192,104
buffer_load_dwordx4 a[48:51], v10, s[20:23], s58 offen offset:3072 sc1
Mvaa 224,192,108
v_mov_b32_e64 v15, s93
Mvaa 132,196,96
Ta 228,17,57344
Ta 230,17,58368
Mvaa 164,196,100
v_cmp_le_u32 vcc, 36, v0
Mvaa 196,196,104
s_nop 0
v_cndmask_b32 v28, v28, v14, vcc
v_cndmask_b32 v29, v29, v15, vcc
Mvaa 228,196,108
Ta 232,18,57344
Ta 234,18,58368
Mvaa 136,200,96
v_cndmask_b32 v30, v30, v31, vcc
Mvaa 168,200,100
buffer_load_dwordx4 a[52:55], v10, s[20:23], 0 offen offset:3072 sc1
Mvaa 200,200,104
Ta 236,19,57344
Ta 238,19,58368
Mvaa 232,200,108
v_add_u32 v30, s3, v30
v_ashrrev_i32_e64 v31, 31, v30
Mvaa 140,204,96
v_lshl_add_u64 v[28:29], v[30:31], 0, v[28:29]
Mvaa 172,204,100
Ta 240,20,57344
Ta 242,20,58368
Mvaa 204,204,104
s_mov_b32 s41, 0
v_readfirstlane_b32 s100, v64
v_readfirstlane_b32 s101, v65
Mvaa 236,204,108
s_mov_b32 s24, s60
s_mov_b32 s25, s61
s_mov_b32 s26, s62
Mvaa 144,208,96
s_waitcnt lgkmcnt(6)
Ta 244,21,57344
Ta 246,21,58368
Mvaa 176,208,100
s_add_u32 s3, s34, 7
s_and_b32 s3, s3, 7
s_lshl_b32 s3, s3, 5
Mvaa 208,208,104
buffer_load_dwordx4 a[56:59], v11, s[20:23], s58 offen offset:3072 sc1
Mvaa 240,208,108
Ta 248,22,57344
Ta 250,22,58368
Mvaa 148,212,96
s_add_u32 s3, s3, s33
s_mul_i32 s92, s3, 2341
s_lshr_b32 s92, s92, 16
Mvaa 180,212,100
s_mul_i32 s47, s92, 28
s_sub_u32 s4, s3, s47
s_mul_i32 s5, s92, 917504
Mvaa 212,212,104
Ta 252,23,57344
Ta 254,23,58368
Mvaa 244,212,108
s_lshl_b32 s47, s4, 8
s_add_u32 s5, s5, s47
s_mov_b32 s94, 1040356334
Mvaa 152,216,96
s_mov_b32 s95, 1040356334
s_sub_u32 s55, 15, s34
s_sub_u32 s45, s36, 3
Mvaa 184,216,100
s_sub_u32 s46, s35, 3
s_mov_b32 s54, s44
s_sub_u32 s35, s35, 2
Mvaa 216,216,104
buffer_load_dwordx4 a[60:63], v11, s[20:23], 0 offen offset:3072 sc1
v_add_u32 v10, 4096, v10
v_add_u32 v11, 4096, v11
Mvaa 248,216,108
s_sub_u32 s36, s36, 2
Mvaa 156,220,96
Mvaa 188,220,100
Mvaa 220,220,104
Mvaa 252,220,108
s_waitcnt vmcnt(25) lgkmcnt(0)
s_barrier
Mvaa 128,224,112
Mvaa 160,224,116
s_add_u32 m0, s44, 49152
Ta 192,16,0
Ta 194,16,1024
Mvaa 192,224,120
buffer_load_dwordx4 v8, s[8:11], s48 offen offset:0 lds
Mvaa 224,224,124
Mvaa 132,228,112
Ta 196,17,0
Ta 198,17,1024
Mvaa 164,228,116
buffer_load_dwordx4 v8, s[8:11], s49 offen offset:1024 lds
Mvaa 196,228,120
Mvaa 228,228,124
Ta 200,18,0
Ta 202,18,1024
Mvaa 136,232,112
Mvaa 168,232,116
buffer_load_dwordx4 v9, s[8:11], s50 offen offset:2048 lds
Mvaa 200,232,120
Ta 204,19,0
Ta 206,19,1024
Mvaa 232,232,124
Mvaa 140,236,112
Mvaa 172,236,116
Ta 208,20,0
Ta 210,20,1024
Mvaa 204,236,120
buffer_load_dwordx4 v9, s[8:11], s51 offen offset:3072 lds
v_add_u32 v8, 524288, v8
v_add_u32 v9, 524288, v9
Mvaa 236,236,124
Mvaa 144,240,112
s_waitcnt lgkmcnt(6)
Ta 212,21,0
Ta 214,21,1024
Mvaa 176,240,116
Mvaa 208,240,120
buffer_load_dwordx4 a[64:67], v10, s[20:23], s58 offen offset:0 sc1
Mvaa 240,240,124
Ta 216,22,0
Ta 218,22,1024
Mvaa 148,244,112
Mvaa 180,244,116
Mvaa 212,244,120
Ta 220,23,0
Ta 222,23,1024
Mvaa 244,244,124
buffer_load_dwordx4 a[68:71], v10, s[20:23], 0 offen offset:0 sc1
Mvaa 152,248,112
Mvaa 184,248,116
Mvaa 216,248,120
buffer_load_dwordx4 a[72:75], v11, s[20:23], s58 offen offset:0 sc1
Mvaa 248,248,124
Mvaa 156,252,112
Mvaa 188,252,116
buffer_load_dwordx4 a[76:79], v11, s[20:23], 0 offen offset:0 sc1
Mvaa 220,252,120
Mvaa 252,252,124
s_waitcnt vmcnt(25) lgkmcnt(0)
Mvaa 128,192,0
Mvaa 160,192,4
Ta 224,16,8192
Ta 226,16,9216
Mvaa 192,192,8
buffer_load_dwordx4 a[80:83], v10, s[20:23], s58 offen offset:1024 sc1
Mvaa 224,192,12
Mvaa 132,196,0
Ta 228,17,8192
Ta 230,17,9216
Mvaa 164,196,4
Mvaa 196,196,8
Mvaa 228,196,12
Ta 232,18,8192
Ta 234,18,9216
Mvaa 136,200,0
Mvaa 168,200,4
buffer_load_dwordx4 a[84:87], v10, s[20:23], 0 offen offset:1024 sc1
Mvaa 200,200,8
Ta 236,19,8192
Ta 238,19,9216
Mvaa 232,200,12
Mvaa 140,204,0
Mvaa 172,204,4
Ta 240,20,8192
Ta 242,20,9216
Mvaa 204,204,8
Mvaa 236,204,12
Mvaa 144,208,0
s_waitcnt lgkmcnt(6)
Ta 244,21,8192
Ta 246,21,9216
Mvaa 176,208,4
Mvaa 208,208,8
buffer_load_dwordx4 a[88:91], v11, s[20:23], s58 offen offset:1024 sc1
Mvaa 240,208,12
Ta 248,22,8192
Ta 250,22,9216
Mvaa 148,212,0
Mvaa 180,212,4
Mvaa 212,212,8
Ta 252,23,8192
Ta 254,23,9216
Mvaa 244,212,12
Mvaa 152,216,0
Mvaa 184,216,4
Mvaa 216,216,8
buffer_load_dwordx4 a[92:95], v11, s[20:23], 0 offen offset:1024 sc1
Mvaa 248,216,12
Mvaa 156,220,0
Mvaa 188,220,4
Mvaa 220,220,8
Mvaa 252,220,12
s_waitcnt vmcnt(25) lgkmcnt(0)
s_barrier
Mvaa 128,224,16
v_accvgpr_write_b32 a0, 0
v_accvgpr_write_b32 a1, 0
Mvaa 160,224,20
Ta 192,16,16384
Ta 194,16,17408
Mvaa 192,224,24
buffer_load_dwordx4 a[96:99], v10, s[20:23], s58 offen offset:2048 sc1
Mvaa 224,224,28
v_accvgpr_write_b32 a2, 0
v_accvgpr_write_b32 a3, 0
Mvaa 132,228,16
Ta 196,17,16384
Ta 198,17,17408
Mvaa 164,228,20
v_accvgpr_write_b32 a4, 0
v_accvgpr_write_b32 a5, 0
Mvaa 196,228,24
v_accvgpr_write_b32 a6, 0
v_accvgpr_write_b32 a7, 0
Mvaa 228,228,28
Ta 200,18,16384
Ta 202,18,17408
Mvaa 136,232,16
v_accvgpr_write_b32 a8, 0
v_accvgpr_write_b32 a9, 0
Mvaa 168,232,20
buffer_load_dwordx4 a[100:103], v10, s[20:23], 0 offen offset:2048 sc1
Mvaa 200,232,24
Ta 204,19,16384
Ta 206,19,17408
Mvaa 232,232,28
v_accvgpr_write_b32 a10, 0
v_accvgpr_write_b32 a11, 0
Mvaa 140,236,16
v_accvgpr_write_b32 a12, 0
v_accvgpr_write_b32 a13, 0
Mvaa 172,236,20
Ta 208,20,16384
Ta 210,20,17408
Mvaa 204,236,24
v_accvgpr_write_b32 a14, 0
v_accvgpr_write_b32 a15, 0
Mvaa 236,236,28
Mvaa 144,240,16
s_waitcnt lgkmcnt(6)
Ta 212,21,16384
Ta 214,21,17408
Mvaa 176,240,20
Mvaa 208,240,24
buffer_load_dwordx4 a[104:107], v11, s[20:23], s58 offen offset:2048 sc1
Mvaa 240,240,28
Ta 216,22,16384
Ta 218,22,17408
Mvaa 148,244,16
Mvaa 180,244,20
Mvaa 212,244,24
Ta 220,23,16384
Ta 222,23,17408
Mvaa 244,244,28
Mvaa 152,248,16
Mvaa 184,248,20
Mvaa 216,248,24
buffer_load_dwordx4 a[108:111], v11, s[20:23], 0 offen offset:2048 sc1
Mvaa 248,248,28
Mvaa 156,252,16
Mvaa 188,252,20
Mvaa 220,252,24
Mvaa 252,252,28
s_waitcnt vmcnt(20) lgkmcnt(0)
Mvaa 128,192,32
v_accvgpr_write_b32 a16, 0
v_accvgpr_write_b32 a17, 0
Mvaa 160,192,36
Ta 224,16,24576
Ta 226,16,25600
Mvaa 192,192,40
buffer_load_dwordx4 a[112:115], v10, s[20:23], s58 offen offset:3072 sc1
Mvaa 224,192,44
v_accvgpr_write_b32 a18, 0
v_accvgpr_write_b32 a19, 0
Mvaa 132,196,32
Ta 228,17,24576
Ta 230,17,25600
Mvaa 164,196,36
v_accvgpr_write_b32 a20, 0
v_accvgpr_write_b32 a21, 0
Mvaa 196,196,40
v_accvgpr_write_b32 a22, 0
v_accvgpr_write_b32 a23, 0
Mvaa 228,196,44
Ta 232,18,24576
Ta 234,18,25600
Mvaa 136,200,32
v_accvgpr_write_b32 a24, 0
v_accvgpr_write_b32 a25, 0
Mvaa 168,200,36
buffer_load_dwordx4 a[116:119], v10, s[20:23], 0 offen offset:3072 sc1
Mvaa 200,200,40
Ta 236,19,24576
Ta 238,19,25600
Mvaa 232,200,44
v_accvgpr_write_b32 a26, 0
v_accvgpr_write_b32 a27, 0
Mvaa 140,204,32
v_accvgpr_write_b32 a28, 0
v_accvgpr_write_b32 a29, 0
Mvaa 172,204,36
Ta 240,20,24576
Ta 242,20,25600
Mvaa 204,204,40
v_accvgpr_write_b32 a30, 0
v_accvgpr_write_b32 a31, 0
Mvaa 236,204,44
Mvaa 144,208,32
s_waitcnt lgkmcnt(6)
Ta 244,21,24576
Ta 246,21,25600
Mvaa 176,208,36
buffer_load_dword v12, v1, s[20:23], s6 offen sc1
Mvaa 208,208,40
buffer_load_dwordx4 a[120:123], v11, s[20:23], s58 offen offset:3072 sc1
Mvaa 240,208,44
Ta 248,22,24576
Ta 250,22,25600
Mvaa 148,212,32
s_add_u32 m0, s44, 65536
s_mov_b32 s7, 0
Mvaa 180,212,36
Mvaa 212,212,40
Ta 252,23,24576
Ta 254,23,25600
Mvaa 244,212,44
Mvaa 152,216,32
Mvaa 184,216,36
Mvaa 216,216,40
buffer_load_dwordx4 a[124:127], v11, s[20:23], 0 offen offset:3072 sc1
v_add_u32 v10, 4096, v10
v_add_u32 v11, 4096, v11
Mvaa 248,216,44
Mvaa 156,220,32
Mvaa 188,220,36
Mvaa 220,220,40
Mvaa 252,220,44
s_waitcnt vmcnt(21) lgkmcnt(0)
s_barrier
Mvaa 128,224,48
v_accvgpr_write_b32 a32, 0
v_accvgpr_write_b32 a33, 0
Mvaa 160,224,52
Ta 192,16,32768
Ta 194,16,33792
Mvaa 192,224,56
v_accvgpr_write_b32 a34, 0
v_accvgpr_write_b32 a35, 0
Mvaa 224,224,60
v_accvgpr_write_b32 a36, 0
v_accvgpr_write_b32 a37, 0
Mvaa 132,228,48
Ta 196,17,32768
Ta 198,17,33792
Mvaa 164,228,52
v_accvgpr_write_b32 a38, 0
v_accvgpr_write_b32 a39, 0
Mvaa 196,228,56
v_accvgpr_write_b32 a40, 0
v_accvgpr_write_b32 a41, 0
Mvaa 228,228,60
Ta 200,18,32768
Ta 202,18,33792
Mvaa 136,232,48
v_accvgpr_write_b32 a42, 0
v_accvgpr_write_b32 a43, 0
Mvaa 168,232,52
v_accvgpr_write_b32 a44, 0
v_accvgpr_write_b32 a45, 0
Mvaa 200,232,56
Ta 204,19,32768
Ta 206,19,33792
Mvaa 232,232,60
v_accvgpr_write_b32 a46, 0
v_accvgpr_write_b32 a47, 0
Mvaa 140,236,48
Mvaa 172,236,52
Ta 208,20,32768
Ta 210,20,33792
Mvaa 204,236,56
Mvaa 236,236,60
Mvaa 144,240,48
s_waitcnt lgkmcnt(6)
Ta 212,21,32768
Ta 214,21,33792
Mvaa 176,240,52
Mvaa 208,240,56
Mvaa 240,240,60
Ta 216,22,32768
Ta 218,22,33792
Mvaa 148,244,48
Mvaa 180,244,52
Mvaa 212,244,56
Ta 220,23,32768
Ta 222,23,33792
Mvaa 244,244,60
Mvaa 152,248,48
Mvaa 184,248,52
Mvaa 216,248,56
Mvaa 248,248,60
Mvaa 156,252,48
Mvaa 188,252,52
Mvaa 220,252,56
Mvaa 252,252,60
s_waitcnt vmcnt(13) lgkmcnt(0)
Mvaa 128,192,64
v_accvgpr_write_b32 a48, 0
v_accvgpr_write_b32 a49, 0
Mvaa 160,192,68
Ta 224,16,40960
Ta 226,16,41984
Mvaa 192,192,72
v_accvgpr_write_b32 a50, 0
v_accvgpr_write_b32 a51, 0
Mvaa 224,192,76
v_accvgpr_write_b32 a52, 0
v_accvgpr_write_b32 a53, 0
Mvaa 132,196,64
Ta 228,17,40960
Ta 230,17,41984
Mvaa 164,196,68
v_accvgpr_write_b32 a54, 0
v_accvgpr_write_b32 a55, 0
Mvaa 196,196,72
v_accvgpr_write_b32 a56, 0
v_accvgpr_write_b32 a57, 0
Mvaa 228,196,76
Ta 232,18,40960
Ta 234,18,41984
Mvaa 136,200,64
v_accvgpr_write_b32 a58, 0
v_accvgpr_write_b32 a59, 0
Mvaa 168,200,68
v_accvgpr_write_b32 a60, 0
v_accvgpr_write_b32 a61, 0
Mvaa 200,200,72
Ta 236,19,40960
Ta 238,19,41984
Mvaa 232,200,76
v_accvgpr_write_b32 a62, 0
v_accvgpr_write_b32 a63, 0
Mvaa 140,204,64
Mvaa 172,204,68
Ta 240,20,40960
Ta 242,20,41984
Mvaa 204,204,72
Mvaa 236,204,76
Mvaa 144,208,64
s_waitcnt lgkmcnt(6)
Ta 244,21,40960
Ta 246,21,41984
Mvaa 176,208,68
Mvaa 208,208,72
Mvaa 240,208,76
Ta 248,22,40960
Ta 250,22,41984
Mvaa 148,212,64
Mvaa 180,212,68
Mvaa 212,212,72
Ta 252,23,40960
Ta 254,23,41984
Mvaa 244,212,76
Mvaa 152,216,64
Mvaa 184,216,68
Mvaa 216,216,72
Mvaa 248,216,76
Mvaa 156,220,64
Mvaa 188,220,68
Mvaa 220,220,72
Mvaa 252,220,76
s_waitcnt vmcnt(2) lgkmcnt(0)
s_cmp_lg_u32 s32, 0
s_cbranch_scc1 L_spinBr
v_cmp_ne_u32 vcc, 1, v12
s_cbranch_vccnz L_spinB
L_spinBr:
s_barrier
Mvaa 128,224,80
buffer_load_dwordx4 v4, s[12:15], s7 offen offset:0 sc1 lds
Mvaa 160,224,84
Ta 192,16,49152
Ta 194,16,50176
Mvaa 192,224,88
v_accvgpr_write_b32 a64, 0
v_accvgpr_write_b32 a65, 0
Mvaa 224,224,92
buffer_load_dwordx4 v4, s[12:15], s7 offen offset:1024 sc1 lds
Mvaa 132,228,80
Ta 196,17,49152
Ta 198,17,50176
Mvaa 164,228,84
v_accvgpr_write_b32 a66, 0
v_accvgpr_write_b32 a67, 0
Mvaa 196,228,88
buffer_load_dwordx4 v4, s[12:15], s7 offen offset:2048 sc1 lds
Mvaa 228,228,92
Ta 200,18,49152
Ta 202,18,50176
Mvaa 136,232,80
v_accvgpr_write_b32 a68, 0
v_accvgpr_write_b32 a69, 0
Mvaa 168,232,84
buffer_load_dwordx4 v4, s[12:15], s7 offen offset:3072 sc1 lds
Mvaa 200,232,88
Ta 204,19,49152
Ta 206,19,50176
Mvaa 232,232,92
s_add_u32 m0, s44, 98304
s_mov_b32 s7, 34816
Mvaa 140,236,80
buffer_load_dwordx4 v4, s[12:15], s7 offen offset:0 sc1 lds
Mvaa 172,236,84
Ta 208,20,49152
Ta 210,20,50176
Mvaa 204,236,88
v_accvgpr_write_b32 a70, 0
v_accvgpr_write_b32 a71, 0
Mvaa 236,236,92
buffer_load_dwordx4 v4, s[12:15], s7 offen offset:1024 sc1 lds
Mvaa 144,240,80
s_waitcnt lgkmcnt(6)
Ta 212,21,49152
Ta 214,21,50176
Mvaa 176,240,84
v_accvgpr_write_b32 a72, 0
v_accvgpr_write_b32 a73, 0
Mvaa 208,240,88
buffer_load_dwordx4 v4, s[12:15], s7 offen offset:2048 sc1 lds
Mvaa 240,240,92
Ta 216,22,49152
Ta 218,22,50176
Mvaa 148,244,80
v_accvgpr_write_b32 a74, 0
v_accvgpr_write_b32 a75, 0
Mvaa 180,244,84
buffer_load_dwordx4 v4, s[12:15], s7 offen offset:3072 sc1 lds
Mvaa 212,244,88
Ta 220,23,49152
Ta 222,23,50176
Mvaa 244,244,92
s_add_u32 m0, s44, 81920
s_mov_b32 s7, 17408
Mvaa 152,248,80
buffer_load_dwordx4 v4, s[12:15], s7 offen offset:0 sc1 lds
Mvaa 184,248,84
v_accvgpr_write_b32 a76, 0
v_accvgpr_write_b32 a77, 0
Mvaa 216,248,88
buffer_load_dwordx4 v4, s[12:15], s7 offen offset:1024 sc1 lds
Mvaa 248,248,92
v_accvgpr_write_b32 a78, 0
v_accvgpr_write_b32 a79, 0
Mvaa 156,252,80
Mvaa 188,252,84
buffer_load_dwordx4 v4, s[12:15], s7 offen offset:2048 sc1 lds
Mvaa 220,252,88
Mvaa 252,252,92
s_waitcnt lgkmcnt(0)
Mvaa 128,192,96
buffer_load_dwordx4 v4, s[12:15], s7 offen offset:3072 sc1 lds
Mvaa 160,192,100
Ta 224,16,57344
Ta 226,16,58368
Mvaa 192,192,104
s_add_u32 m0, s44, 114688
s_mov_b32 s7, 52224
Mvaa 224,192,108
buffer_load_dwordx4 v4, s[12:15], s7 offen offset:0 sc1 lds
Mvaa 132,196,96
Ta 228,17,57344
Ta 230,17,58368
Mvaa 164,196,100
v_accvgpr_write_b32 a80, 0
v_accvgpr_write_b32 a81, 0
Mvaa 196,196,104
buffer_load_dwordx4 v4, s[12:15], s7 offen offset:1024 sc1 lds
Mvaa 228,196,108
Ta 232,18,57344
Ta 234,18,58368
Mvaa 136,200,96
v_accvgpr_write_b32 a82, 0
v_accvgpr_write_b32 a83, 0
Mvaa 168,200,100
buffer_load_dwordx4 v4, s[12:15], s7 offen offset:2048 sc1 lds
Mvaa 200,200,104
Ta 236,19,57344
Ta 238,19,58368
Mvaa 232,200,108
v_accvgpr_write_b32 a84, 0
v_accvgpr_write_b32 a85, 0
Mvaa 140,204,96
buffer_load_dwordx4 v4, s[12:15], s7 offen offset:3072 sc1 lds
Mvaa 172,204,100
Ta 240,20,57344
Ta 242,20,58368
Mvaa 204,204,104
s_add_u32 m0, s44, 0
s_mov_b32 s7, 69632
Mvaa 236,204,108
buffer_load_dwordx4 v4, s[12:15], s7 offen offset:0 sc1 lds
Mvaa 144,208,96
s_waitcnt lgkmcnt(6)
Ta 244,21,57344
Ta 246,21,58368
Mvaa 176,208,100
buffer_load_dwordx4 v4, s[12:15], s7 offen offset:1024 sc1 lds
Mvaa 208,208,104
v_accvgpr_write_b32 a86, 0
v_accvgpr_write_b32 a87, 0
Mvaa 240,208,108
Ta 248,22,57344
Ta 250,22,58368
Mvaa 148,212,96
buffer_load_dwordx4 v4, s[12:15], s7 offen offset:2048 sc1 lds
Mvaa 180,212,100
v_accvgpr_write_b32 a88, 0
v_accvgpr_write_b32 a89, 0
Mvaa 212,212,104
Ta 252,23,57344
Ta 254,23,58368
Mvaa 244,212,108
buffer_load_dwordx4 v4, s[12:15], s7 offen offset:3072 sc1 lds
Mvaa 152,216,96
s_add_u32 m0, s44, 16384
s_mov_b32 s7, 87040
Mvaa 184,216,100
v_accvgpr_write_b32 a90, 0
v_accvgpr_write_b32 a91, 0
Mvaa 216,216,104
buffer_load_dwordx4 v4, s[12:15], s7 offen offset:0 sc1 lds
Mvaa 248,216,108
v_accvgpr_write_b32 a92, 0
v_accvgpr_write_b32 a93, 0
Mvaa 156,220,96
v_accvgpr_write_b32 a94, 0
v_accvgpr_write_b32 a95, 0
Mvaa 188,220,100
buffer_load_dwordx4 v4, s[12:15], s7 offen offset:1024 sc1 lds
Mvaa 220,220,104
Mvaa 252,220,108
s_waitcnt vmcnt(18) lgkmcnt(0)
s_barrier
Mvaa 128,224,112
buffer_load_dwordx4 v4, s[12:15], s7 offen offset:2048 sc1 lds
Mvaa 132,228,112
Ra 192,3,0
Ra 196,3,1024
Mvaa 136,232,112
Ra 200,3,2048
Ra 204,3,3072
Mvaa 140,236,112
buffer_load_dwordx4 v4, s[12:15], s7 offen offset:3072 sc1 lds
Mvaa 144,240,112
s_add_u32 m0, s44, 32768
s_mov_b32 s7, 104448
Mvaa 148,244,112
Ra 208,3,4096
Ra 212,3,5120
Mvaa 152,248,112
buffer_load_dwordx4 v4, s[12:15], s7 offen offset:0 sc1 lds
Mvaa 156,252,112
Ra 216,3,6144
Ra 220,3,7168
Mvaa 160,224,116
buffer_load_dwordx4 v4, s[12:15], s7 offen offset:1024 sc1 lds
Mvaa 164,228,116
Mvaa 168,232,116
Mvaa 172,236,116
buffer_load_dwordx4 v4, s[12:15], s7 offen offset:2048 sc1 lds
Mvaa 176,240,116
v_mul_f32 v128, s94, v128
v_mul_f32 v129, s94, v129
Mvaa 180,244,116
v_mul_f32 v130, s94, v130
v_mul_f32 v131, s94, v131
Mvaa 184,248,116
buffer_load_dwordx4 v4, s[12:15], s7 offen offset:3072 sc1 lds
Mvaa 188,252,116
v_mul_f32 v132, s94, v132
v_mul_f32 v133, s94, v133
Mvaa 192,224,120
v_mul_f32 v134, s94, v134
v_mul_f32 v135, s94, v135
Mvaa 196,228,120
Vc 128,128,129
Vc 129,130,131
Mvaa 200,232,120
Vc 130,132,133
Vc 131,134,135
Mvaa 204,236,120
Aw 128,128
Aw 129,129
Mvaa 208,240,120
Aw 130,130
Aw 131,131
Mvaa 212,244,120
v_mul_f32 v136, s94, v136
v_mul_f32 v137, s94, v137
Mvaa 216,248,120
v_mul_f32 v138, s94, v138
v_mul_f32 v139, s94, v139
Mvaa 220,252,120
v_mul_f32 v140, s94, v140
v_mul_f32 v141, s94, v141
Mvaa 224,224,124
v_mul_f32 v142, s94, v142
v_mul_f32 v143, s94, v143
Mvaa 228,228,124
Vc 136,136,137
Vc 137,138,139
Mvaa 232,232,124
Vc 138,140,141
Vc 139,142,143
Mvaa 236,236,124
Aw 132,136
Aw 133,137
Mvaa 240,240,124
Aw 134,138
Aw 135,139
Mvaa 244,244,124
v_mul_f32 v144, s94, v144
v_mul_f32 v145, s94, v145
Mvaa 248,248,124
v_mul_f32 v146, s94, v146
v_mul_f32 v147, s94, v147
Mvaa 252,252,124
v_mul_f32 v148, s94, v148
v_mul_f32 v149, s94, v149
Ra 224,3,8192
Ra 228,3,9216
Ra 232,3,10240
Ra 236,3,11264
Ra 240,3,12288
Ra 244,3,13312
Ra 248,3,14336
s_waitcnt lgkmcnt(9)
Ra 252,3,15360
v_mul_f32 v150, s94, v150
v_mul_f32_e64 v151, s94, v151
Vc 144,144,145
Vc 145,146,147
Vc 146,148,149
Vc 147,150,151
Aw 136,144
Aw 137,145
Aw 138,146
Aw 139,147
v_mul_f32 v152, s94, v152
v_mul_f32 v153, s94, v153
v_mul_f32 v154, s94, v154
v_mul_f32 v155, s94, v155
v_mul_f32 v156, s94, v156
v_mul_f32 v157, s94, v157
v_mul_f32 v158, s94, v158
v_mul_f32 v159, s94, v159
Vc 152,152,153
Vc 153,154,155
Vc 154,156,157
Vc 155,158,159
Aw 140,152
Aw 141,153
Aw 142,154
Aw 143,155
Zvaa 128,192,128
v_mul_f32 v160, s94, v160
v_mul_f32 v161, s94, v161
v_mul_f32 v162, s94, v162
v_mul_f32 v163, s94, v163
Mvaa 128,196,132
v_mul_f32 v164, s94, v164
v_mul_f32 v165, s94, v165
v_mul_f32 v166, s94, v166
v_mul_f32 v167, s94, v167
Mvaa 128,200,136
Vc 160,160,161
Vc 161,162,163
Vc 162,164,165
Vc 163,166,167
Mvaa 128,204,140
Aw 144,160
Aw 145,161
Aw 146,162
Aw 147,163
s_waitcnt lgkmcnt(8)
Zvaa 132,208,128
v_mul_f32 v168, s94, v168
v_mul_f32 v169, s94, v169
v_mul_f32 v170, s94, v170
v_mul_f32_e64 v171, s94, v171
Mvaa 132,212,132
v_mul_f32 v172, s94, v172
v_mul_f32 v173, s94, v173
v_mul_f32 v174, s94, v174
v_mul_f32 v175, s94, v175
Mvaa 132,216,136
Vc 168,168,169
Vc 169,170,171
Vc 170,172,173
Vc 171,174,175
Mvaa 132,220,140
Aw 148,168
Aw 149,169
Aw 150,170
Aw 151,171
s_waitcnt lgkmcnt(4)
Zvaa 136,224,128
v_mul_f32 v176, s94, v176
v_mul_f32 v177, s94, v177
v_mul_f32 v178, s94, v178
v_mul_f32_e64 v179, s94, v179
Mvaa 136,228,132
v_mul_f32 v180, s94, v180
v_mul_f32 v181, s94, v181
v_mul_f32 v182, s94, v182
v_mul_f32 v183, s94, v183
Mvaa 136,232,136
Vc 176,176,177
Vc 177,178,179
Vc 178,180,181
Vc 179,182,183
Mvaa 136,236,140
Aw 152,176
Aw 153,177
Aw 154,178
Aw 155,179
s_waitcnt lgkmcnt(0)
Zvaa 140,240,128
v_mul_f32 v184, s94, v184
v_mul_f32 v185, s94, v185
v_mul_f32 v186, s94, v186
v_mul_f32_e64 v187, s94, v187
Mvaa 140,244,132
v_mul_f32 v188, s94, v188
v_mul_f32 v189, s94, v189
v_mul_f32 v190, s94, v190
v_mul_f32 v191, s94, v191
Mvaa 140,248,136
Vc 184,184,185
Vc 185,186,187
Vc 186,188,189
Vc 187,190,191
Mvaa 140,252,140
Aw 156,184
Aw 157,185
Aw 158,186
Aw 159,187
Zvaa 144,192,144
v_mul_f32 v192, s94, v192
v_mul_f32 v193, s94, v193
v_mul_f32 v194, s94, v194
v_mul_f32 v195, s94, v195
Mvaa 144,196,148
v_mul_f32 v196, s94, v196
v_mul_f32 v197, s94, v197
v_mul_f32 v198, s94, v198
v_mul_f32 v199, s94, v199
Mvaa 144,200,152
Vc 192,192,193
Vc 193,194,195
Vc 194,196,197
Vc 195,198,199
Mvaa 144,204,156
Aw 160,192
Aw 161,193
Aw 162,194
Aw 163,195
Zvaa 148,208,144
v_mul_f32 v200, s94, v200
v_mul_f32 v201, s94, v201
v_mul_f32 v202, s94, v202
v_mul_f32 v203, s94, v203
Mvaa 148,212,148
v_mul_f32 v204, s94, v204
v_mul_f32 v205, s94, v205
v_mul_f32 v206, s94, v206
v_mul_f32 v207, s94, v207
Mvaa 148,216,152
Vc 200,200,201
Vc 201,202,203
Vc 202,204,205
Vc 203,206,207
Mvaa 148,220,156
Aw 164,200
Aw 165,201
Aw 166,202
Aw 167,203
Zvaa 152,224,144
v_mul_f32 v208, s94, v208
v_mul_f32 v209, s94, v209
v_mul_f32 v210, s94, v210
v_mul_f32 v211, s94, v211
Mvaa 152,228,148
v_mul_f32 v212, s94, v212
v_mul_f32 v213, s94, v213
v_mul_f32 v214, s94, v214
v_mul_f32 v215, s94, v215
Mvaa 152,232,152
Vc 208,208,209
Vc 209,210,211
Vc 210,212,213
Vc 211,214,215
Mvaa 152,236,156
Aw 168,208
Aw 169,209
Aw 170,210
Aw 171,211
Zvaa 156,240,144
v_mul_f32 v216, s94, v216
v_mul_f32 v217, s94, v217
v_mul_f32 v218, s94, v218
v_mul_f32 v219, s94, v219
Mvaa 156,244,148
v_mul_f32 v220, s94, v220
v_mul_f32 v221, s94, v221
v_mul_f32 v222, s94, v222
v_mul_f32 v223, s94, v223
Mvaa 156,248,152
Vc 216,216,217
Vc 217,218,219
Vc 218,220,221
Vc 219,222,223
Mvaa 156,252,156
Aw 172,216
Aw 173,217
Aw 174,218
Aw 175,219
Zvaa 160,192,160
v_mul_f32 v224, s94, v224
v_mul_f32 v225, s94, v225
v_mul_f32 v226, s94, v226
v_mul_f32 v227, s94, v227
Mvaa 160,196,164
v_mul_f32 v228, s94, v228
v_mul_f32 v229, s94, v229
v_mul_f32 v230, s94, v230
v_mul_f32 v231, s94, v231
Mvaa 160,200,168
Vc 224,224,225
Vc 225,226,227
Vc 226,228,229
Vc 227,230,231
Mvaa 160,204,172
Aw 176,224
Aw 177,225
Aw 178,226
Aw 179,227
Zvaa 164,208,160
v_mul_f32 v232, s94, v232
v_mul_f32 v233, s94, v233
v_mul_f32 v234, s94, v234
v_mul_f32 v235, s94, v235
Mvaa 164,212,164
v_mul_f32 v236, s94, v236
v_mul_f32 v237, s94, v237
v_mul_f32 v238, s94, v238
v_mul_f32 v239, s94, v239
Mvaa 164,216,168
Vc 232,232,233
Vc 233,234,235
Vc 234,236,237
Vc 235,238,239
Mvaa 164,220,172
Aw 180,232
Aw 181,233
Aw 182,234
Aw 183,235
Zvaa 168,224,160
v_mul_f32 v240, s94, v240
v_mul_f32 v241, s94, v241
v_mul_f32 v242, s94, v242
v_mul_f32 v243, s94, v243
Mvaa 168,228,164
v_mul_f32 v244, s94, v244
v_mul_f32 v245, s94, v245
v_mul_f32 v246, s94, v246
v_mul_f32 v247, s94, v247
Mvaa 168,232,168
Vc 240,240,241
Vc 241,242,243
Vc 242,244,245
Vc 243,246,247
Mvaa 168,236,172
Aw 184,240
Aw 185,241
Aw 186,242
Aw 187,243
Zvaa 172,240,160
v_mul_f32 v248, s94, v248
v_mul_f32 v249, s94, v249
v_mul_f32 v250, s94, v250
v_mul_f32 v251, s94, v251
Mvaa 172,244,164
v_mul_f32 v252, s94, v252
v_mul_f32 v253, s94, v253
v_mul_f32 v254, s94, v254
v_mul_f32 v255, s94, v255
Mvaa 172,248,168
Vc 248,248,249
Vc 249,250,251
Vc 250,252,253
Vc 251,254,255
Mvaa 172,252,172
Aw 188,248
Aw 189,249
Aw 190,250
Aw 191,251
Zvaa 176,192,176
v_accvgpr_write_b32 a96, 0
v_accvgpr_write_b32 a97, 0
v_accvgpr_write_b32 a98, 0
v_accvgpr_write_b32 a99, 0
Mvaa 176,196,180
v_accvgpr_write_b32 a100, 0
v_accvgpr_write_b32 a101, 0
v_accvgpr_write_b32 a102, 0
v_accvgpr_write_b32 a103, 0
Mvaa 176,200,184
v_accvgpr_write_b32 a104, 0
v_accvgpr_write_b32 a105, 0
v_accvgpr_write_b32 a106, 0
v_accvgpr_write_b32 a107, 0
Mvaa 176,204,188
v_accvgpr_write_b32 a108, 0
v_accvgpr_write_b32 a109, 0
v_accvgpr_write_b32 a110, 0
v_accvgpr_write_b32 a111, 0
Zvaa 180,208,176
v_accvgpr_write_b32 a112, 0
v_accvgpr_write_b32 a113, 0
v_accvgpr_write_b32 a114, 0
v_accvgpr_write_b32 a115, 0
Mvaa 180,212,180
v_accvgpr_write_b32 a116, 0
v_accvgpr_write_b32 a117, 0
v_accvgpr_write_b32 a118, 0
v_accvgpr_write_b32 a119, 0
Mvaa 180,216,184
v_accvgpr_write_b32 a120, 0
v_accvgpr_write_b32 a121, 0
v_accvgpr_write_b32 a122, 0
v_accvgpr_write_b32 a123, 0
Mvaa 180,220,188
v_accvgpr_write_b32 a124, 0
v_accvgpr_write_b32 a125, 0
v_accvgpr_write_b32 a126, 0
v_accvgpr_write_b32 a127, 0
s_waitcnt vmcnt(16)
s_barrier
s_add_u32 s53, s44, 65536
Zvaa 184,224,176
Ra 192,3,32768
v_mov_b32 v16, 0x3f803f80
v_mov_b32 v17, 0x3f803f80
v_mov_b32 v18, 0x3f803f80
v_mov_b32 v19, 0x3f803f80
Mvaa 184,228,180
Ra 196,3,33792
v_mov_b32 v20, 0xff800000
v_max3_f32 v22, v128, v129, v130
v_max3_f32 v22, v22, v131, v132
v_max3_f32 v22, v22, v133, v134
Mvaa 184,232,184
Ra 200,3,34816
v_max3_f32 v22, v22, v135, v136
v_max3_f32 v22, v22, v137, v138
v_max3_f32 v22, v22, v139, v140
v_max3_f32 v22, v22, v141, v142
Mvaa 184,236,188
Ra 204,3,35840
v_max_f32 v22, v22, v143
v_mov_b32 v1, v22
s_nop 1
v_permlane16_swap_b32 v1, v22
v_max_f32_e64 v22, v22, v1
Zvaa 188,240,176
Ra 208,3,36864
v_mov_b32 v1, v22
s_nop 1
v_permlane32_swap_b32 v1, v22
v_max_f32 v22, v22, v1
v_add_f32 v22, 0x41f80000, v22
Mvaa 188,244,180
Ra 212,3,37888
Vs 128,128,22
Vs 129,129,22
Vs 130,130,22
Vs 131,131,22
Mvaa 188,248,184
Ra 216,3,38912
Vs 132,132,22
Vs 133,133,22
Vs 134,134,22
Vs 135,135,22
Mvaa 188,252,188
Ra 220,3,39936
Vs 136,136,22
Vs 137,137,22
Vs 138,138,22
Vs 139,139,22
Vs 140,140,22
Vs 141,141,22
Vs 142,142,22
Vs 143,143,22
v_sub_f32 v32, 0, v22
v_sub_f32 v33, 0, v22
v_sub_f32 v34, 0, v22
v_sub_f32 v35, 0, v22
v_max3_f32 v22, v144, v145, v146
v_max3_f32 v22, v22, v147, v148
v_max3_f32 v22, v22, v149, v150
v_max3_f32 v22, v22, v151, v152
v_max3_f32 v22, v22, v153, v154
v_max3_f32 v22, v22, v155, v156
v_max3_f32 v22, v22, v157, v158
v_max_f32 v22, v22, v159
v_mov_b32 v1, v22
s_nop 1
v_permlane16_swap_b32 v1, v22
v_max_f32 v22, v22, v1
v_mov_b32 v1, v22
s_nop 1
v_permlane32_swap_b32 v1, v22
v_max_f32_e64 v22, v22, v1
v_add_f32 v22, 0x41f80000, v22
Vs 144,144,22
Vs 145,145,22
Vs 146,146,22
Vs 147,147,22
Vs 148,148,22
Vs 149,149,22
Vs 150,150,22
Vs 151,151,22
Vs 152,152,22
Vs 153,153,22
Vs 154,154,22
Vs 155,155,22
Vs 156,156,22
Vs 157,157,22
Vs 158,158,22
Vs 159,159,22
v_sub_f32 v36, 0, v22
v_sub_f32 v37, 0, v22
v_sub_f32 v38, 0, v22
v_sub_f32 v39, 0, v22
s_mov_b32 s38, 139264
s_mov_b32 s39, 121856
s_cmp_lg_u32 s34, 0
s_cbranch_scc1 L_k2_nomask0
v_cmp_gt_i32 s[56:57], 0, v5
v_cmp_gt_i32 s[58:59], 1, v5
v_cmp_gt_i32 s[60:61], 2, v5
v_cmp_gt_i32 s[62:63], 3, v5
s_nop 3
s_nop 0
v_cndmask_b32 v176, v176, v20, s[56:57]
v_cndmask_b32 v177, v177, v20, s[58:59]
v_cndmask_b32 v178, v178, v20, s[60:61]
v_cndmask_b32 v179, v179, v20, s[62:63]
v_cmp_gt_i32 s[56:57], 16, v5
v_cmp_gt_i32 s[58:59], 17, v5
v_cmp_gt_i32 s[60:61], 18, v5
v_cmp_gt_i32 s[62:63], 19, v5
v_cndmask_b32 v180, v180, v20, s[56:57]
v_cndmask_b32 v181, v181, v20, s[58:59]
v_cndmask_b32 v182, v182, v20, s[60:61]
v_cndmask_b32 v183, v183, v20, s[62:63]
v_cmp_gt_i32 s[56:57], 32, v5
v_cmp_gt_i32 s[58:59], 33, v5
v_cmp_gt_i32 s[60:61], 34, v5
v_cmp_gt_i32 s[62:63], 35, v5
v_cndmask_b32 v184, v184, v20, s[56:57]
v_cndmask_b32 v185, v185, v20, s[58:59]
v_cndmask_b32 v186, v186, v20, s[60:61]
v_cndmask_b32 v187, v187, v20, s[62:63]
v_cmp_gt_i32 s[56:57], 48, v5
v_cmp_gt_i32 s[58:59], 49, v5
v_cmp_gt_i32 s[60:61], 50, v5
v_cmp_gt_i32 s[62:63], 51, v5
v_cndmask_b32 v188, v188, v20, s[56:57]
v_cndmask_b32 v189, v189, v20, s[58:59]
v_cndmask_b32 v190, v190, v20, s[60:61]
v_cndmask_b32 v191, v191, v20, s[62:63]
L_k2_nomask0:
s_mov_b32 s37, 0
s_nop 0
v_max3_f32 v22, v160, v161, v162
v_max3_f32 v22, v22, v163, v164
v_max3_f32 v22, v22, v165, v166
v_max3_f32 v22, v22, v167, v168
v_max3_f32 v22, v22, v169, v170
v_max3_f32 v22, v22, v171, v172
v_max3_f32 v22, v22, v173, v174
v_max_f32 v22, v22, v175
v_mov_b32 v1, v22
s_nop 1
v_permlane16_swap_b32 v1, v22
v_max_f32 v22, v22, v1
v_mov_b32 v1, v22
s_nop 1
v_permlane32_swap_b32 v1, v22
v_max_f32_e64 v22, v22, v1
v_add_f32 v22, 0x41f80000, v22
Vs 160,160,22
Vs 161,161,22
Vs 162,162,22
Vs 163,163,22
Vs 164,164,22
Vs 165,165,22
Vs 166,166,22
Vs 167,167,22
Vs 168,168,22
Vs 169,169,22
Vs 170,170,22
Vs 171,171,22
Vs 172,172,22
Vs 173,173,22
Vs 174,174,22
Vs 175,175,22
v_sub_f32 v40, 0, v22
v_sub_f32 v41, 0, v22
v_sub_f32 v42, 0, v22
v_sub_f32 v43, 0, v22
v_max3_f32 v22, v176, v177, v178
v_max3_f32 v22, v22, v179, v180
v_max3_f32 v22, v22, v181, v182
v_max3_f32 v22, v22, v183, v184
v_max3_f32 v22, v22, v185, v186
v_max3_f32 v22, v22, v187, v188
v_max3_f32 v22, v22, v189, v190
v_max_f32 v22, v22, v191
v_mov_b32 v1, v22
s_nop 1
v_permlane16_swap_b32 v1, v22
v_max_f32 v22, v22, v1
v_mov_b32 v1, v22
s_nop 1
v_permlane32_swap_b32 v1, v22
v_max_f32_e64 v22, v22, v1
v_add_f32 v22, 0x41f80000, v22
Vs 176,176,22
Vs 177,177,22
Vs 178,178,22
Vs 179,179,22
Vs 180,180,22
Vs 181,181,22
Vs 182,182,22
Vs 183,183,22
Vs 184,184,22
Vs 185,185,22
Vs 186,186,22
Vs 187,187,22
Vs 188,188,22
Vs 189,189,22
Vs 190,190,22
Vs 191,191,22
v_sub_f32 v44, 0, v22
v_sub_f32 v45, 0, v22
v_sub_f32 v46, 0, v22
v_sub_f32 v47, 0, v22
Ve 8,128
Ve 9,129
Ve 10,130
Ve 11,131
Vc 64,8,9
Ve 12,144
Ve 13,145
Vc 65,10,11
Ve 14,146
Ve 15,147
Vc 72,12,13
Ve 8,160
Ve 9,161
Vc 73,14,15
Ve 10,162
Ve 11,163
Vc 80,8,9
Ve 12,176
Ve 13,177
Vc 81,10,11
Ve 14,178
Ve 15,179
Vc 88,12,13
Ve 8,132
Ve 9,133
Vc 89,14,15
Ve 10,134
Ve 11,135
Vc 66,8,9
Ve 12,148
Ve 13,149
Vc 67,10,11
Ve 14,150
Ve 15,151
Vc 74,12,13
Ve 8,164
Ve 9,165
Vc 75,14,15
Ve 10,166
Ve 11,167
Vc 82,8,9
Ve 12,180
Ve 13,181
Vc 83,10,11
Ve 14,182
Ve 15,183
Vc 90,12,13
Vc 91,14,15
v_or_b32_e64 v7, v64, v65
v_or3_b32 v7, v7, v72, v73
v_or3_b32 v7, v7, v80, v81
v_or3_b32 v7, v7, v88, v89
v_or3_b32 v7, v7, v66, v67
v_or3_b32 v7, v7, v74, v75
v_or3_b32 v7, v7, v82, v83
v_or3_b32 v7, v7, v90, v91
s_waitcnt lgkmcnt(4)
s_cmp_eq_u32 s34, 0
s_cbranch_scc1 L_k2_wlast
L_k2_wloop:
v_xor_b32 v2, 65536, v2
v_xor_b32 v3, 65536, v3
Cvaa 192,192,128,32
s_mov_b32 m0, s53
Ra 224,2,40960
v_lshl_add_u64 v[28:29], s[40:41], 0, v[28:29]
Mvaa 192,196,132
buffer_load_dwordx4 v4, s[12:15], s38 offen offset:0 sc1 lds
Mvaa 192,200,136
VE 8,136
Mvaa 192,204,140
VE 9,137
Cvaa 208,192,144,36
Ra 228,2,41984
Vc 68,8,9
Mvaa 208,196,148
VE 10,138
Mvaa 208,200,152
VE 11,139
Mvaa 208,204,156
Ra 232,2,43008
Vc 69,10,11
Cvaa 224,192,160,40
Ra 236,2,44032
v_or3_b32 v7, v7, v68, v69
Mvaa 224,196,164
VE 12,152
Mvaa 224,200,168
VE 13,153
Mvaa 224,204,172
Ra 240,2,45056
Vc 76,12,13
Cvaa 240,192,176,44
VE 14,154
Mvaa 240,196,180
VE 15,155
Mvaa 240,200,184
Ra 244,2,46080
Vc 77,14,15
Mvaa 240,204,188
s_waitcnt lgkmcnt(6)
Ra 248,2,47104
v_or3_b32 v7, v7, v76, v77
Cvaa 196,208,128,32
buffer_load_dwordx4 v4, s[12:15], s38 offen offset:1024 sc1 lds
Mvaa 196,212,132
Ve 8,168
Mvaa 196,216,136
VE 9,169
Mvaa 196,220,140
Ra 252,2,48128
Vc 84,8,9
Cvaa 212,208,144,36
VE 10,170
Mvaa 212,212,148
VE 11,171
Mvaa 212,216,152
Ra 192,2,16384
Vc 85,10,11
Mvaa 212,220,156
Ra 196,2,17408
v_or3_b32 v7, v7, v84, v85
Cvaa 228,208,160,40
VE 12,184
Mvaa 228,212,164
VE 13,185
Mvaa 228,216,168
Ra 200,2,18432
Vc 92,12,13
Mvaa 228,220,172
VE 14,186
Cvaa 244,208,176,44
VE 15,187
Mvaa 244,212,180
buffer_load_dwordx4 v4, s[12:15], s38 offen offset:2048 sc1 lds
Mvaa 244,216,184
Ra 204,2,19456
Vc 93,14,15
Mvaa 244,220,188
s_waitcnt lgkmcnt(8)
Ve 8,140
Cvaa 200,224,128,32
Ra 208,2,20480
v_or3_b32 v7, v7, v92, v93
Mvaa 200,228,132
VE 9,141
Mvaa 200,232,136
Ra 212,2,21504
Vc 70,8,9
Mvaa 200,236,140
VE 10,142
Cvaa 216,224,144,36
VE 11,143
Mvaa 216,228,148
Ra 216,2,22528
Vc 71,10,11
Mvaa 216,232,152
Ra 220,2,23552
v_or3_b32 v7, v7, v70, v71
Mvaa 216,236,156
VE 12,156
Cvaa 232,224,160,40
VE 13,157
Mvaa 232,228,164
VE 14,158
Mvaa 232,232,168
VE 15,159
Mvaa 232,236,172
buffer_load_dwordx4 v4, s[12:15], s38 offen offset:3072 sc1 lds
Cvaa 248,224,176,44
VE 8,172
Mvaa 248,228,180
VE 9,173
Mvaa 248,232,184
Vc 78,12,13
Vc 79,14,15
Mvaa 248,236,188
s_waitcnt lgkmcnt(8)
Ve 10,174
Cvaa 204,240,128,32
VE 11,175
Mvaa 204,244,132
Vc 86,8,9
Vc 87,10,11
Mvaa 204,248,136
VE 12,188
Mvaa 204,252,140
VE 13,189
Cvaa 220,240,144,36
Vc 94,12,13
v_or3_b32 v7, v7, v78, v79
Mvaa 220,244,148
VE 14,190
Mvaa 220,248,152
VE 15,191
Mvaa 220,252,156
Vc 95,14,15
v_or3_b32 v7, v7, v86, v87
Cvaa 236,240,160,40
v_or3_b32 v7, v7, v94, v95
v_and_b32 v1, 0x40004000, v7
Mvaa 236,244,164
v_cmp_ne_u32 vcc, 0, v1
Mvaa 236,248,168
Mvaa 236,252,172
s_waitcnt vmcnt(12)
Cvaa 252,240,176,44
Mvaa 252,244,180
s_barrier
Mvaa 252,248,184
s_waitcnt lgkmcnt(4)
Mvaa 252,252,188
s_cbranch_vccnz L_k2_fb_we
L_k2_fbr_we:
Maav 0,192,64
Ve 8,192
Maav 0,196,68
s_add_u32 m0, s54, 49152
VE 9,193
Maav 32,192,72
buffer_load_dwordx4 v4, s[12:15], s39 offen offset:0 sc1 lds
Maav 32,196,76
s_add_u32 s37, s37, 1
Ra 224,2,24576
Vc 96,8,9
Maav 64,192,80
s_add_u32 s38, s38, 34816
Ve 10,194
Maav 64,196,84
VE 11,195
Maav 96,192,88
Ra 228,2,25600
Vc 97,10,11
Maav 96,196,92
Ra 232,2,26624
v_or_b32_e64 v7, v96, v97
Maav 4,200,64
VE 12,208
Maav 4,204,68
VE 13,209
Maav 36,200,72
Ra 236,2,27648
Vc 104,12,13
Maav 36,204,76
VE 14,210
Maav 68,200,80
VE 15,211
Maav 68,204,84
Ra 240,2,28672
Vc 105,14,15
Maav 100,200,88
Ra 244,2,29696
v_or3_b32 v7, v7, v104, v105
Maav 100,204,92
buffer_load_dwordx4 v4, s[12:15], s39 offen offset:1024 sc1 lds
Mvvv 48,16,64
VE 8,224
Mvvv 48,16,68
s_waitcnt lgkmcnt(6)
Ve 9,225
Maav 8,208,64
Ra 248,2,30720
Vc 112,8,9
Maav 8,212,68
VE 10,226
Maav 40,208,72
VE 11,227
Maav 40,212,76
Ra 252,2,31744
Vc 113,10,11
Maav 72,208,80
Ra 192,3,0
v_or3_b32 v7, v7, v112, v113
Maav 72,212,84
VE 12,240
Maav 104,208,88
VE 13,241
Maav 104,212,92
Ra 196,3,1024
Vc 120,12,13
Maav 12,216,64
VE 14,242
Maav 12,220,68
VE 15,243
Maav 44,216,72
Ra 200,3,2048
Vc 121,14,15
Maav 44,220,76
buffer_load_dwordx4 v4, s[12:15], s39 offen offset:2048 sc1 lds
Maav 76,216,80
Ra 204,3,3072
v_or3_b32 v7, v7, v120, v121
Maav 76,220,84
VE 8,196
Maav 108,216,88
VE 9,197
Maav 108,220,92
VE 10,198
Mvvv 52,16,72
VE 11,199
Mvvv 52,16,76
s_waitcnt lgkmcnt(8)
Ve 12,212
Maav 16,224,64
Ra 208,3,4096
Vc 98,8,9
Maav 16,228,68
Ra 212,3,5120
Vc 99,10,11
Maav 48,224,72
Ra 216,3,6144
v_or3_b32 v7, v7, v98, v99
Maav 48,228,76
VE 13,213
Maav 80,224,80
Ra 220,3,7168
Vc 106,12,13
Maav 80,228,84
VE 14,214
Maav 112,224,88
buffer_load_dwordx4 v4, s[12:15], s39 offen offset:3072 sc1 lds
Maav 112,228,92
s_add_u32 s39, s39, 34816
VE 15,215
Maav 20,232,64
VE 8,228
Maav 20,236,68
VE 9,229
Maav 52,232,72
VE 10,230
Maav 52,236,76
VE 11,231
Maav 84,232,80
Vc 107,14,15
Vc 114,8,9
Maav 84,236,84
VE 12,244
Maav 116,232,88
VE 13,245
Maav 116,236,92
Vc 115,10,11
Vc 122,12,13
Mvvv 56,16,80
VE 14,246
Mvvv 56,16,84
s_waitcnt lgkmcnt(8)
Ve 15,247
Maav 24,240,64
Vc 123,14,15
v_or3_b32 v7, v7, v106, v107
Maav 24,244,68
v_or3_b32 v7, v7, v114, v115
v_or3_b32 v7, v7, v122, v123
Maav 56,240,72
global_load_dword v30, v[28:29], off
Maav 56,244,76
Maav 88,240,80
Maav 88,244,84
Maav 120,240,88
Maav 120,244,92
Maav 28,248,64
Maav 28,252,68
Maav 60,248,72
Maav 60,252,76
Maav 92,248,80
Maav 92,252,84
Maav 124,248,88
Maav 124,252,92
Mvvv 60,16,88
s_waitcnt lgkmcnt(4)
Mvvv 60,16,92
Ve 8,200
Cvaa 128,192,128,32
s_add_u32 m0, s53, 32768
Ra 224,3,8192
v_lshl_add_u64 v[28:29], s[40:41], 0, v[28:29]
Mvaa 128,196,132
buffer_load_dwordx4 v4, s[12:15], s38 offen offset:0 sc1 lds
Mvaa 128,200,136
VE 9,201
Mvaa 128,204,140
Ra 228,3,9216
Vc 100,8,9
Cvaa 144,192,144,36
VE 10,202
Mvaa 144,196,148
VE 11,203
Mvaa 144,200,152
Ra 232,3,10240
Vc 101,10,11
Mvaa 144,204,156
Ra 236,3,11264
v_or3_b32 v7, v7, v100, v101
Cvaa 160,192,160,40
VE 12,216
Mvaa 160,196,164
VE 13,217
Mvaa 160,200,168
Ra 240,3,12288
Vc 108,12,13
Mvaa 160,204,172
VE 14,218
Cvaa 176,192,176,44
VE 15,219
Mvaa 176,196,180
Ra 244,3,13312
Vc 109,14,15
Mvaa 176,200,184
Ra 248,3,14336
v_or3_b32 v7, v7, v108, v109
Mvaa 176,204,188
s_waitcnt lgkmcnt(7)
Ve 8,232
Cvaa 132,208,128,32
buffer_load_dwordx4 v4, s[12:15], s38 offen offset:1024 sc1 lds
Mvaa 132,212,132
VE 9,233
Mvaa 132,216,136
Ra 252,3,15360
Vc 116,8,9
Mvaa 132,220,140
VE 10,234
Cvaa 148,208,144,36
VE 11,235
Mvaa 148,212,148
Ra 192,2,49152
Vc 117,10,11
Mvaa 148,216,152
Ra 196,2,50176
v_or3_b32 v7, v7, v116, v117
Mvaa 148,220,156
VE 12,248
Cvaa 164,208,160,40
VE 13,249
Mvaa 164,212,164
Ra 200,2,51200
Vc 124,12,13
Mvaa 164,216,168
VE 14,250
Mvaa 164,220,172
VE 15,251
Cvaa 180,208,176,44
Ra 204,2,52224
Vc 125,14,15
Mvaa 180,212,180
buffer_load_dwordx4 v4, s[12:15], s38 offen offset:2048 sc1 lds
Mvaa 180,216,184
VE 8,204
Mvaa 180,220,188
s_waitcnt lgkmcnt(8)
Ve 9,205
Cvaa 136,224,128,32
Ra 208,2,53248
Vc 102,8,9
Mvaa 136,228,132
Ra 212,2,54272
v_or3_b32 v7, v7, v124, v125
Mvaa 136,232,136
VE 10,206
Mvaa 136,236,140
VE 11,207
Cvaa 152,224,144,36
Ra 216,2,55296
Vc 103,10,11
Mvaa 152,228,148
Ra 220,2,56320
v_or3_b32 v7, v7, v102, v103
Mvaa 152,232,152
VE 12,220
Mvaa 152,236,156
VE 13,221
Cvaa 168,224,160,40
VE 14,222
Mvaa 168,228,164
VE 15,223
Mvaa 168,232,168
VE 8,236
Mvaa 168,236,172
buffer_load_dwordx4 v4, s[12:15], s38 offen offset:3072 sc1 lds
Cvaa 184,224,176,44
VE 9,237
Mvaa 184,228,180
Vc 110,12,13
Vc 111,14,15
Mvaa 184,232,184
VE 10,238
Mvaa 184,236,188
s_waitcnt lgkmcnt(8)
Ve 11,239
Cvaa 140,240,128,32
Vc 118,8,9
Vc 119,10,11
Mvaa 140,244,132
VE 12,252
Mvaa 140,248,136
VE 13,253
Mvaa 140,252,140
Vc 126,12,13
v_or3_b32 v7, v7, v110, v111
Cvaa 156,240,144,36
VE 14,254
Mvaa 156,244,148
VE 15,255
Mvaa 156,248,152
Vc 127,14,15
v_or3_b32 v7, v7, v118, v119
Mvaa 156,252,156
v_or3_b32 v7, v7, v126, v127
v_and_b32 v1, 0x40004000, v7
Cvaa 172,240,160,40
v_cmp_ne_u32 vcc, 0, v1
Mvaa 172,244,164
Mvaa 172,248,168
Mvaa 172,252,172
s_waitcnt vmcnt(12)
Cvaa 188,240,176,44
s_cmp_eq_u32 s37, s46
Mvaa 188,244,180
s_barrier
Mvaa 188,248,184
s_waitcnt lgkmcnt(4)
Mvaa 188,252,188
s_cbranch_vccnz L_k2_fb_wo
L_k2_fbr_wo:
Maav 0,192,96
s_cbranch_scc1 L_k2_mk_wo
L_k2_mkr_wo:
Ve 8,128
Maav 0,196,100
s_add_u32 m0, s53, 16384
VE 9,129
Maav 32,192,104
buffer_load_dwordx4 v4, s[12:15], s39 offen offset:0 sc1 lds
Maav 32,196,108
s_add_u32 s37, s37, 1
Ra 224,2,57344
Vc 64,8,9
Maav 64,192,112
s_add_u32 s38, s38, 34816
Ve 10,130
Maav 64,196,116
s_xor_b32 s53, s53, 65536
VE 11,131
Maav 96,192,120
s_xor_b32 s54, s54, 65536
Ra 228,2,58368
Vc 65,10,11
Maav 96,196,124
Ra 232,2,59392
v_or_b32_e64 v7, v64, v65
Maav 4,200,96
VE 12,144
Maav 4,204,100
VE 13,145
Maav 36,200,104
Ra 236,2,60416
Vc 72,12,13
Maav 36,204,108
VE 14,146
Maav 68,200,112
VE 15,147
Maav 68,204,116
Ra 240,2,61440
Vc 73,14,15
Maav 100,200,120
Ra 244,2,62464
v_or3_b32 v7, v7, v72, v73
Maav 100,204,124
buffer_load_dwordx4 v4, s[12:15], s39 offen offset:1024 sc1 lds
Mvvv 48,16,96
VE 8,160
Mvvv 48,16,100
s_waitcnt lgkmcnt(6)
Ve 9,161
Maav 8,208,96
Ra 248,2,63488
Vc 80,8,9
Maav 8,212,100
VE 10,162
Maav 40,208,104
VE 11,163
Maav 40,212,108
Ra 252,2,64512
Vc 81,10,11
Maav 72,208,112
Ra 192,3,32768
v_or3_b32 v7, v7, v80, v81
Maav 72,212,116
VE 12,176
Maav 104,208,120
VE 13,177
Maav 104,212,124
Ra 196,3,33792
Vc 88,12,13
Maav 12,216,96
VE 14,178
Maav 12,220,100
VE 15,179
Maav 44,216,104
Ra 200,3,34816
Vc 89,14,15
Maav 44,220,108
buffer_load_dwordx4 v4, s[12:15], s39 offen offset:2048 sc1 lds
Maav 76,216,112
Ra 204,3,35840
v_or3_b32 v7, v7, v88, v89
Maav 76,220,116
VE 8,132
Maav 108,216,120
VE 9,133
Maav 108,220,124
VE 10,134
Mvvv 52,16,104
VE 11,135
Mvvv 52,16,108
s_waitcnt lgkmcnt(8)
Ve 12,148
Maav 16,224,96
Ra 208,3,36864
Vc 66,8,9
Maav 16,228,100
Ra 212,3,37888
Vc 67,10,11
Maav 48,224,104
Ra 216,3,38912
v_or3_b32 v7, v7, v66, v67
Maav 48,228,108
VE 13,149
Maav 80,224,112
Ra 220,3,39936
Vc 74,12,13
Maav 80,228,116
VE 14,150
Maav 112,224,120
buffer_load_dwordx4 v4, s[12:15], s39 offen offset:3072 sc1 lds
Maav 112,228,124
s_add_u32 s39, s39, 34816
VE 15,151
Maav 20,232,96
VE 8,164
Maav 20,236,100
VE 9,165
Maav 52,232,104
VE 10,166
Maav 52,236,108
VE 11,167
Maav 84,232,112
Vc 75,14,15
Vc 82,8,9
Maav 84,236,116
VE 12,180
Maav 116,232,120
VE 13,181
Maav 116,236,124
Vc 83,10,11
Vc 90,12,13
Mvvv 56,16,112
VE 14,182
Mvvv 56,16,116
s_waitcnt lgkmcnt(8)
Ve 15,183
Maav 24,240,96
Vc 91,14,15
v_or3_b32 v7, v7, v74, v75
Maav 24,244,100
v_or3_b32 v7, v7, v82, v83
v_or3_b32 v7, v7, v90, v91
Maav 56,240,104
global_load_dword v30, v[28:29], off
Maav 56,244,108
Maav 88,240,112
Maav 88,244,116
Maav 120,240,120
Maav 120,244,124
Maav 28,248,96
Maav 28,252,100
Maav 60,248,104
Maav 60,252,108
Maav 92,248,112
Maav 92,252,116
Maav 124,248,120
Maav 124,252,124
s_cmp_lg_u32 s37, s35
Mvvv 60,16,120
s_waitcnt lgkmcnt(4)
Mvvv 60,16,124
s_cbranch_scc1 L_k2_wloop
L_k2_wlast:
v_xor_b32 v2, 65536, v2
v_xor_b32 v3, 65536, v3
Cvaa 192,192,128,32
s_mov_b32 m0, s53
Ra 224,2,40960
v_lshl_add_u64 v[28:29], s[40:41], 0, v[28:29]
Mvaa 192,196,132
buffer_load_dwordx4 v4, s[12:15], s38 offen offset:0 sc1 lds
Mvaa 192,200,136
VE 8,136
Mvaa 192,204,140
VE 9,137
Cvaa 208,192,144,36
Ra 228,2,41984
Vc 68,8,9
Mvaa 208,196,148
VE 10,138
Mvaa 208,200,152
VE 11,139
Mvaa 208,204,156
Ra 232,2,43008
Vc 69,10,11
Cvaa 224,192,160,40
Ra 236,2,44032
v_or3_b32 v7, v7, v68, v69
Mvaa 224,196,164
VE 12,152
Mvaa 224,200,168
VE 13,153
Mvaa 224,204,172
s_waitcnt lgkmcnt(4)
Ra 240,2,45056
Vc 76,12,13
Cvaa 196,208,128,32
buffer_load_dwordx4 v4, s[12:15], s38 offen offset:1024 sc1 lds
Mvaa 196,212,132
Ve 14,154
Mvaa 196,216,136
VE 15,155
Mvaa 196,220,140
Ra 244,2,46080
Vc 77,14,15
Cvaa 212,208,144,36
Ra 248,2,47104
v_or3_b32 v7, v7, v76, v77
Mvaa 212,212,148
VE 8,168
Mvaa 212,216,152
VE 9,169
Mvaa 212,220,156
Ra 252,2,48128
Vc 84,8,9
Cvaa 228,208,160,40
VE 10,170
Mvaa 228,212,164
buffer_load_dwordx4 v4, s[12:15], s38 offen offset:2048 sc1 lds
Mvaa 228,216,168
VE 11,171
Mvaa 228,220,172
s_waitcnt lgkmcnt(4)
Ra 192,2,16384
Vc 85,10,11
Cvaa 200,224,128,32
Ra 196,2,17408
v_or3_b32 v7, v7, v84, v85
Mvaa 200,228,132
Ve 12,184
Mvaa 200,232,136
VE 13,185
Mvaa 200,236,140
Ra 200,2,18432
Vc 92,12,13
Cvaa 216,224,144,36
VE 14,186
Mvaa 216,228,148
VE 15,187
Mvaa 216,232,152
Ra 204,2,19456
Vc 93,14,15
Mvaa 216,236,156
buffer_load_dwordx4 v4, s[12:15], s38 offen offset:3072 sc1 lds
Cvaa 232,224,160,40
Ra 208,2,20480
v_or3_b32 v7, v7, v92, v93
Mvaa 232,228,164
VE 8,140
Mvaa 232,232,168
VE 9,141
Mvaa 232,236,172
s_waitcnt lgkmcnt(5)
Ra 212,2,21504
Vc 70,8,9
Cvaa 204,240,128,32
Ve 10,142
Mvaa 204,244,132
VE 11,143
Mvaa 204,248,136
Ra 216,2,22528
Vc 71,10,11
Mvaa 204,252,140
Ra 220,2,23552
v_or3_b32 v7, v7, v70, v71
Cvaa 220,240,144,36
VE 12,156
Mvaa 220,244,148
VE 13,157
Mvaa 220,248,152
VE 14,158
Mvaa 220,252,156
s_waitcnt vmcnt(12)
Ve 15,159
Cvaa 236,240,160,40
VE 8,172
Mvaa 236,244,164
s_barrier
Ve 9,173
Mvaa 236,248,168
s_waitcnt lgkmcnt(4)
Vc 78,12,13
Vc 79,14,15
Ve 10,174
Ve 11,175
Ve 12,188
Ve 13,189
Ve 14,190
VE 15,191
Vc 86,8,9
Vc 87,10,11
Vc 94,12,13
Vc 95,14,15
v_or3_b32 v7, v7, v78, v79
v_or3_b32 v7, v7, v86, v87
v_or3_b32 v7, v7, v94, v95
v_and_b32 v1, 0x40004000, v7
v_cmp_ne_u32 vcc, 0, v1
Mvaa 236,252,172
s_cbranch_vccnz L_k2_fb_wl
L_k2_fbr_wl:
Maav 0,192,64
s_branch L_k2_mk_wl
L_k2_mkr_wl:
Ve 8,192
Maav 0,196,68
s_add_u32 m0, s54, 49152
VE 9,193
Maav 32,192,72
buffer_load_dwordx4 v4, s[12:15], s39 offen offset:0 sc1 lds
Maav 32,196,76
s_add_u32 s37, s37, 1
Ra 224,2,24576
Vc 96,8,9
Maav 64,192,80
s_add_u32 s38, s38, 34816
Ve 10,194
Maav 64,196,84
VE 11,195
Maav 96,192,88
Ra 228,2,25600
Vc 97,10,11
Maav 96,196,92
Ra 232,2,26624
v_or_b32_e64 v7, v96, v97
Maav 4,200,64
VE 12,208
Maav 4,204,68
VE 13,209
Maav 36,200,72
Ra 236,2,27648
Vc 104,12,13
Maav 36,204,76
VE 14,210
Maav 68,200,80
VE 15,211
Maav 68,204,84
Ra 240,2,28672
Vc 105,14,15
Maav 100,200,88
Ra 244,2,29696
v_or3_b32 v7, v7, v104, v105
Maav 100,204,92
buffer_load_dwordx4 v4, s[12:15], s39 offen offset:1024 sc1 lds
Mvvv 48,16,64
VE 8,224
Mvvv 48,16,68
s_waitcnt lgkmcnt(6)
Ve 9,225
Maav 8,208,64
Ra 248,2,30720
Vc 112,8,9
Maav 8,212,68
VE 10,226
Maav 40,208,72
VE 11,227
Maav 40,212,76
Ra 252,2,31744
Vc 113,10,11
Maav 72,208,80
Ra 192,3,0
v_or3_b32 v7, v7, v112, v113
Maav 72,212,84
VE 12,196
Maav 104,208,88
VE 13,197
Maav 104,212,92
Ra 196,3,1024
Vc 98,12,13
Maav 12,216,64
VE 14,198
Maav 12,220,68
VE 15,199
Maav 44,216,72
Ra 200,3,2048
Vc 99,14,15
Maav 44,220,76
buffer_load_dwordx4 v4, s[12:15], s39 offen offset:2048 sc1 lds
Maav 76,216,80
Ra 204,3,3072
v_or3_b32 v7, v7, v98, v99
Maav 76,220,84
VE 8,212
Maav 108,216,88
VE 9,213
Maav 108,220,92
VE 10,214
Mvvv 52,16,72
VE 11,215
Mvvv 52,16,76
s_waitcnt lgkmcnt(8)
Ve 12,228
Maav 16,224,64
Ra 208,3,4096
Vc 106,8,9
Maav 16,228,68
Ra 212,3,5120
Vc 107,10,11
Maav 48,224,72
Ra 216,3,6144
v_or3_b32 v7, v7, v106, v107
Maav 48,228,76
VE 13,229
Maav 80,224,80
Ra 220,3,7168
Vc 114,12,13
Maav 80,228,84
VE 14,230
Maav 112,224,88
buffer_load_dwordx4 v4, s[12:15], s39 offen offset:3072 sc1 lds
Maav 112,228,92
s_add_u32 s39, s39, 34816
VE 15,231
Maav 20,232,64
VE 8,200
Maav 20,236,68
VE 9,201
Maav 52,232,72
VE 10,202
Maav 52,236,76
VE 11,203
Maav 84,232,80
Vc 115,14,15
Vc 100,8,9
Maav 84,236,84
VE 12,216
Maav 116,232,88
VE 13,217
Maav 116,236,92
Vc 101,10,11
Vc 108,12,13
Mvvv 56,16,80
VE 14,218
Mvvv 56,16,84
s_waitcnt lgkmcnt(8)
Ve 15,219
Maav 24,240,64
Vc 109,14,15
v_or3_b32 v7, v7, v114, v115
Maav 24,244,68
VE 8,232
Maav 56,240,72
global_load_dword v30, v[28:29], off
Maav 56,244,76
VE 9,233
Maav 88,240,80
Vc 116,8,9
v_or3_b32 v7, v7, v100, v101
Maav 88,244,84
VE 10,234
Maav 120,240,88
VE 11,235
Maav 120,244,92
Vc 117,10,11
v_or3_b32 v7, v7, v108, v109
Maav 28,248,64
v_or3_b32 v7, v7, v116, v117
Maav 28,252,68
Maav 60,248,72
Maav 60,252,76
Maav 92,248,80
Maav 92,252,84
Maav 124,248,88
Maav 124,252,92
Mvvv 60,16,88
s_waitcnt lgkmcnt(4)
Mvvv 60,16,92
Ve 12,204
Cvaa 128,192,128,32
s_add_u32 m0, s53, 32768
VE 13,205
Mvaa 128,196,132
buffer_load_dwordx4 v4, s[12:15], s38 offen offset:0 sc1 lds
Mvaa 128,200,136
Ra 224,3,8192
Vc 102,12,13
Mvaa 128,204,140
VE 14,206
Cvaa 144,192,144,36
VE 15,207
Mvaa 144,196,148
Ra 228,3,9216
Vc 103,14,15
Mvaa 144,200,152
Ra 232,3,10240
v_or3_b32 v7, v7, v102, v103
Mvaa 144,204,156
s_waitcnt lgkmcnt(3)
Ra 236,3,11264
Ra 240,3,12288
Cvaa 132,208,128,32
buffer_load_dwordx4 v4, s[12:15], s38 offen offset:1024 sc1 lds
Mvaa 132,212,132
Ve 8,220
Mvaa 132,216,136
VE 9,221
Mvaa 132,220,140
Ra 244,3,13312
Vc 110,8,9
Cvaa 148,208,144,36
VE 10,222
Mvaa 148,212,148
buffer_load_dwordx4 v4, s[12:15], s38 offen offset:2048 sc1 lds
Mvaa 148,216,152
VE 11,223
Mvaa 148,220,156
s_waitcnt lgkmcnt(2)
Ra 248,3,14336
Ra 252,3,15360
Cvaa 136,224,128,32
Ra 192,2,49152
Vc 111,10,11
Mvaa 136,228,132
Ra 196,2,50176
v_or3_b32 v7, v7, v110, v111
Mvaa 136,232,136
Ve 12,236
Mvaa 136,236,140
buffer_load_dwordx4 v4, s[12:15], s38 offen offset:3072 sc1 lds
Cvaa 152,224,144,36
VE 13,237
Mvaa 152,228,148
Ra 200,2,51200
Vc 118,12,13
Mvaa 152,232,152
VE 14,238
Mvaa 152,236,156
s_waitcnt lgkmcnt(3)
Ra 204,2,52224
Ra 208,2,53248
Cvaa 140,240,128,32
Ve 15,239
Mvaa 140,244,132
Ra 212,2,54272
Vc 119,14,15
Mvaa 140,248,136
Ra 216,2,55296
v_or3_b32 v7, v7, v118, v119
Mvaa 140,252,140
s_waitcnt vmcnt(12)
Ra 220,2,56320
v_and_b32 v1, 0x40004000, v7
Cvaa 156,240,144,36
s_cmp_eq_u32 s37, s45
v_cmp_ne_u32 vcc, 0, v1
Mvaa 156,244,148
s_barrier
Mvaa 156,248,152
s_waitcnt lgkmcnt(4)
Mvaa 156,252,156
s_cbranch_vccnz L_k2_fb_tr
L_k2_fbr_tr:
Maav 0,192,96
s_cbranch_scc1 L_k2_mk_tr
L_k2_mkr_tr:
Ve 8,128
Maav 0,196,100
s_add_u32 m0, s53, 16384
VE 9,129
Maav 32,192,104
buffer_load_dwordx4 v4, s[12:15], s39 offen offset:0 sc1 lds
Maav 32,196,108
s_add_u32 s37, s37, 1
Ra 224,2,57344
Vc 64,8,9
Maav 64,192,112
s_add_u32 s38, s38, 34816
Ve 10,130
Maav 64,196,116
s_xor_b32 s53, s53, 65536
VE 11,131
Maav 4,200,96
s_xor_b32 s54, s54, 65536
Ra 228,2,58368
Vc 65,10,11
Maav 4,204,100
Ra 232,2,59392
v_or_b32_e64 v7, v64, v65
Maav 36,200,104
VE 12,144
Maav 36,204,108
VE 13,145
Maav 68,200,112
Ra 236,2,60416
Vc 72,12,13
Maav 68,204,116
VE 14,146
Mvvv 48,16,96
VE 15,147
Mvvv 48,16,100
s_waitcnt lgkmcnt(4)
Ra 240,2,61440
Vc 73,14,15
Maav 8,208,96
buffer_load_dwordx4 v4, s[12:15], s39 offen offset:1024 sc1 lds
Maav 8,212,100
Ra 244,2,62464
v_or3_b32 v7, v7, v72, v73
Maav 40,208,104
Ve 8,132
Maav 40,212,108
VE 9,133
Maav 72,208,112
Ra 248,2,63488
Vc 66,8,9
Maav 72,212,116
VE 10,134
Maav 12,216,96
VE 11,135
Maav 12,220,100
Ra 252,2,64512
Vc 67,10,11
Maav 44,216,104
Ra 192,3,32768
v_or3_b32 v7, v7, v66, v67
Maav 44,220,108
VE 12,148
Maav 76,216,112
VE 13,149
Maav 76,220,116
Ra 196,3,33792
Vc 74,12,13
Mvvv 52,16,104
VE 14,150
Mvvv 52,16,108
s_waitcnt lgkmcnt(6)
Ve 15,151
Maav 16,224,96
buffer_load_dwordx4 v4, s[12:15], s39 offen offset:2048 sc1 lds
Maav 16,228,100
Ra 200,3,34816
Vc 75,14,15
Maav 48,224,104
Ra 204,3,35840
v_or3_b32 v7, v7, v74, v75
Maav 48,228,108
VE 8,136
Maav 80,224,112
Ra 208,3,36864
Ra 212,3,37888
Maav 80,228,116
Ra 216,3,38912
Ra 220,3,39936
Maav 20,232,96
Maav 20,236,100
Maav 52,232,104
Maav 52,236,108
Maav 84,232,112
Maav 84,236,116
buffer_load_dwordx4 v4, s[12:15], s39 offen offset:3072 sc1 lds
Mvvv 56,16,112
s_add_u32 s39, s39, 34816
Mvvv 56,16,116
s_waitcnt lgkmcnt(8)
Maav 24,240,96
Maav 24,244,100
Maav 56,240,104
Maav 56,244,108
Maav 88,240,112
Maav 88,244,116
Maav 28,248,96
Maav 28,252,100
Maav 60,248,104
Maav 60,252,108
Maav 92,248,112
s_waitcnt lgkmcnt(4)
Maav 92,252,116
s_getpc_b64 s[56:57]
L_cpf4:
s_add_u32 s56, s56, (L_k2_fin-L_cpf4)&0xffffffff
s_addc_u32 s57, s57, ((L_k2_fin-L_cpf4)>>32)&0xffffffff
s_lshr_b32 s58, s2, 3
s_lshl_b32 s58, s58, 2
s_add_u32 s58, s58, s32
s_lshl_b32 s58, s58, 10
v_and_b32 v162, 7, v0
v_lshlrev_b32 v162, 7, v162
v_add_u32 v162, s58, v162
v_min_u32 v162, L_p4_end-L_k2_fin-4, v162
v_mov_b32 v161, s57
v_add_co_u32 v160, vcc, s56, v162
s_nop 1
v_addc_co_u32 v161, vcc, 0, v161, vcc
global_load_dword v164, v[160:161], off
s_waitcnt vmcnt(9)
s_lshl_b32 s3, s34, 20
s_lshl_b32 s47, s33, 15
s_add_u32 s3, s3, s47
s_lshl_b32 s47, s32, 10
v_lshlrev_b32 v248, 4, v0
v_add_u32_e64 v249, s47, v248
s_sub_u32 s47, 7168, s47
v_add_u32 v248, s47, v248
v_rcp_f32 v250, v56
v_rcp_f32 v252, v60
v_mov_b32 v251, v250
v_mov_b32_e64 v253, v252
Ar 240,96
Ar 241,97
Ar 242,98
Ar 243,99
Ar 244,100
Ar 245,101
Ar 246,102
Ar 247,103
v_pk_mul_f32 v[240:241], v[240:241], v[252:253]
v_pk_mul_f32 v[242:243], v[242:243], v[252:253]
v_pk_mul_f32 v[244:245], v[244:245], v[252:253]
v_pk_mul_f32 v[246:247], v[246:247], v[252:253]
Vc 28,240,241
Vc 29,242,243
Vc 30,244,245
Vc 31,246,247
buffer_store_dwordx4 v[28:31], v249, s[16:19], s3 offen sc1
Ar 240,64
Ar 241,65
Ar 242,66
Ar 243,67
Ar 244,68
Ar 245,69
Ar 246,70
Ar 247,71
v_pk_mul_f32 v[240:241], v[240:241], v[250:251]
v_pk_mul_f32 v[242:243], v[242:243], v[250:251]
v_pk_mul_f32 v[244:245], v[244:245], v[250:251]
v_pk_mul_f32 v[246:247], v[246:247], v[250:251]
Vc 24,240,241
Vc 25,242,243
Vc 26,244,245
Vc 27,246,247
buffer_store_dwordx4 v[24:27], v248, s[16:19], s3 offen sc1
s_add_u32 s3, s3, 8192
Ar 240,104
Ar 241,105
Ar 242,106
Ar 243,107
Ar 244,108
Ar 245,109
Ar 246,110
Ar 247,111
v_pk_mul_f32 v[240:241], v[240:241], v[252:253]
v_pk_mul_f32 v[242:243], v[242:243], v[252:253]
v_pk_mul_f32 v[244:245], v[244:245], v[252:253]
v_pk_mul_f32 v[246:247], v[246:247], v[252:253]
Vc 28,240,241
Vc 29,242,243
Vc 30,244,245
Vc 31,246,247
buffer_store_dwordx4 v[28:31], v249, s[16:19], s3 offen sc1
Ar 240,72
Ar 241,73
Ar 242,74
Ar 243,75
Ar 244,76
Ar 245,77
Ar 246,78
Ar 247,79
v_pk_mul_f32 v[240:241], v[240:241], v[250:251]
v_pk_mul_f32 v[242:243], v[242:243], v[250:251]
v_pk_mul_f32 v[244:245], v[244:245], v[250:251]
v_pk_mul_f32 v[246:247], v[246:247], v[250:251]
Vc 24,240,241
Vc 25,242,243
Vc 26,244,245
Vc 27,246,247
buffer_store_dwordx4 v[24:27], v248, s[16:19], s3 offen sc1
s_add_u32 s3, s3, 8192
Ar 240,112
Ar 241,113
Ar 242,114
Ar 243,115
Ar 244,116
Ar 245,117
Ar 246,118
Ar 247,119
v_pk_mul_f32 v[240:241], v[240:241], v[252:253]
v_pk_mul_f32 v[242:243], v[242:243], v[252:253]
v_pk_mul_f32 v[244:245], v[244:245], v[252:253]
v_pk_mul_f32 v[246:247], v[246:247], v[252:253]
Vc 28,240,241
Vc 29,242,243
Vc 30,244,245
Vc 31,246,247
buffer_store_dwordx4 v[28:31], v249, s[16:19], s3 offen sc1
Ar 240,80
Ar 241,81
Ar 242,82
Ar 243,83
Ar 244,84
Ar 245,85
Ar 246,86
Ar 247,87
v_pk_mul_f32 v[240:241], v[240:241], v[250:251]
v_pk_mul_f32 v[242:243], v[242:243], v[250:251]
v_pk_mul_f32 v[244:245], v[244:245], v[250:251]
v_pk_mul_f32 v[246:247], v[246:247], v[250:251]
Vc 24,240,241
Vc 25,242,243
Vc 26,244,245
Vc 27,246,247
buffer_store_dwordx4 v[24:27], v248, s[16:19], s3 offen sc1
s_add_u32 s3, s3, 8192
Ar 240,120
Ar 241,121
Ar 242,122
Ar 243,123
Ar 244,124
Ar 245,125
Ar 246,126
Ar 247,127
v_pk_mul_f32 v[240:241], v[240:241], v[252:253]
v_pk_mul_f32 v[242:243], v[242:243], v[252:253]
v_pk_mul_f32 v[244:245], v[244:245], v[252:253]
v_pk_mul_f32 v[246:247], v[246:247], v[252:253]
Vc 28,240,241
Vc 29,242,243
Vc 30,244,245
Vc 31,246,247
buffer_store_dwordx4 v[28:31], v249, s[16:19], s3 offen sc1
Ar 240,88
Ar 241,89
Ar 242,90
Ar 243,91
Ar 244,92
Ar 245,93
Ar 246,94
Ar 247,95
v_pk_mul_f32 v[240:241], v[240:241], v[250:251]
v_pk_mul_f32 v[242:243], v[242:243], v[250:251]
v_pk_mul_f32 v[244:245], v[244:245], v[250:251]
v_pk_mul_f32 v[246:247], v[246:247], v[250:251]
Vc 24,240,241
Vc 25,242,243
Vc 26,244,245
Vc 27,246,247
buffer_store_dwordx4 v[24:27], v248, s[16:19], s3 offen sc1
s_add_u32 s52, s37, 2
s_load_dwordx2 s[94:95], s[0:1], 40
s_load_dwordx2 s[40:41], s[0:1], 0
s_load_dwordx4 s[8:11], s[0:1], 80
s_waitcnt vmcnt(8) lgkmcnt(0)
s_cmp_eq_u32 s34, 7
s_cbranch_scc1 L_k2_fin
L_k2_nloop:
v_xor_b32 v2, 65536, v2
v_xor_b32 v3, 65536, v3
Cvaa 192,192,128,32
s_mov_b32 m0, s53
Ve 9,137
Mvaa 192,196,132
buffer_load_dwordx4 v4, s[12:15], s38 offen offset:0 sc1 lds
Mvaa 192,200,136
Ra 224,2,40960
Vc 68,8,9
Mvaa 192,204,140
VE 10,138
Cvaa 208,192,144,36
VE 11,139
Mvaa 208,196,148
Ra 228,2,41984
Vc 69,10,11
Mvaa 208,200,152
Ra 232,2,43008
v_or3_b32 v7, v7, v68, v69
Mvaa 208,204,156
s_waitcnt lgkmcnt(3)
Ra 236,2,44032
Ra 240,2,45056
Cvaa 196,208,128,32
buffer_load_dwordx4 v4, s[12:15], s38 offen offset:1024 sc1 lds
Mvaa 196,212,132
Ve 12,152
Mvaa 196,216,136
VE 13,153
Mvaa 196,220,140
Ra 244,2,46080
Vc 76,12,13
Cvaa 212,208,144,36
VE 14,154
Mvaa 212,212,148
buffer_load_dwordx4 v4, s[12:15], s38 offen offset:2048 sc1 lds
Mvaa 212,216,152
VE 15,155
Mvaa 212,220,156
s_waitcnt lgkmcnt(2)
Ra 248,2,47104
Ra 252,2,48128
Cvaa 200,224,128,32
Ra 192,2,16384
Vc 77,14,15
Mvaa 200,228,132
Ra 196,2,17408
v_or3_b32 v7, v7, v76, v77
Mvaa 200,232,136
Ve 8,140
Mvaa 200,236,140
buffer_load_dwordx4 v4, s[12:15], s38 offen offset:3072 sc1 lds
Cvaa 216,224,144,36
VE 9,141
Mvaa 216,228,148
Ra 200,2,18432
Vc 70,8,9
Mvaa 216,232,152
VE 10,142
Mvaa 216,236,156
s_waitcnt lgkmcnt(3)
Ra 204,2,19456
Ra 208,2,20480
Cvaa 204,240,128,32
Ve 11,143
Mvaa 204,244,132
s_cmp_lt_u32 s37, s52
Ra 212,2,21504
Vc 71,10,11
Mvaa 204,248,136
s_cbranch_scc1 L_nw_ne
s_waitcnt vmcnt(12)
L_nw_ne:
Ra 216,2,22528
v_or3_b32 v7, v7, v70, v71
Mvaa 204,252,140
Ve 12,156
Cvaa 220,240,144,36
VE 13,157
Mvaa 220,244,148
s_barrier
Ra 220,2,23552
Vc 78,12,13
Mvaa 220,248,152
s_waitcnt lgkmcnt(4)
Ve 14,158
Ve 15,159
s_nop 0
Vc 79,14,15
v_or3_b32 v7, v7, v78, v79
v_and_b32 v1, 0x40004000, v7
v_cmp_ne_u32 vcc, 0, v1
Mvaa 220,252,156
s_cbranch_vccnz L_k2_fb_ne
L_k2_fbr_ne:
Maav 0,192,64
Ve 8,192
Maav 0,196,68
s_add_u32 m0, s54, 49152
VE 9,193
Maav 32,192,72
buffer_load_dwordx4 v4, s[12:15], s39 offen offset:0 sc1 lds
Maav 32,196,76
s_cmp_eq_u32 s37, s52
Ra 224,2,24576
Vc 96,8,9
Maav 4,200,64
s_cbranch_scc1 L_pubB
L_pubBr:
VE 10,194
Maav 4,204,68
s_add_u32 s37, s37, 1
Ve 11,195
Maav 36,200,72
s_add_u32 s38, s38, 34816
Ra 228,2,25600
Vc 97,10,11
Maav 36,204,76
Ra 232,2,26624
v_or_b32_e64 v7, v96, v97
Mvvv 48,16,64
VE 12,208
Mvvv 48,16,68
s_waitcnt lgkmcnt(3)
Ra 236,2,27648
Ra 240,2,28672
Maav 8,208,64
buffer_load_dwordx4 v4, s[12:15], s39 offen offset:1024 sc1 lds
Maav 8,212,68
Ve 13,209
Maav 40,208,72
Ra 244,2,29696
Vc 104,12,13
Maav 40,212,76
VE 14,210
Maav 12,216,64
VE 15,211
Maav 12,220,68
Ra 248,2,30720
Vc 105,14,15
Maav 44,216,72
Ra 252,2,31744
v_or3_b32 v7, v7, v104, v105
Maav 44,220,76
VE 8,196
Mvvv 52,16,72
buffer_load_dwordx4 v4, s[12:15], s39 offen offset:2048 sc1 lds
Mvvv 52,16,76
s_waitcnt lgkmcnt(4)
Ve 9,197
Maav 16,224,64
Ra 192,3,0
Vc 98,8,9
Maav 16,228,68
VE 10,198
Maav 48,224,72
VE 11,199
Maav 48,228,76
Ra 196,3,1024
Vc 99,10,11
Maav 20,232,64
Ra 200,3,2048
v_or3_b32 v7, v7, v98, v99
Maav 20,236,68
Ra 204,3,3072
Ra 208,3,4096
Maav 52,232,72
buffer_load_dwordx4 v4, s[12:15], s39 offen offset:3072 sc1 lds
Maav 52,236,76
s_waitcnt lgkmcnt(5)
Ve 12,212
Maav 24,240,64
s_add_u32 s39, s39, 34816
VE 13,213
Maav 24,244,68
Ra 212,3,5120
Vc 106,12,13
Maav 56,240,72
VE 14,214
Maav 56,244,76
VE 15,215
Maav 28,248,64
Ra 216,3,6144
Vc 107,14,15
Maav 28,252,68
Ra 220,3,7168
v_or3_b32 v7, v7, v106, v107
Maav 60,248,72
s_waitcnt lgkmcnt(4)
Ve 8,200
Maav 60,252,76
VE 9,201
Cvaa 128,192,128,32
s_add_u32 m0, s53, 32768
Ra 224,3,8192
Vc 100,8,9
Mvaa 128,196,132
buffer_load_dwordx4 v4, s[12:15], s38 offen offset:0 sc1 lds
Mvaa 128,200,136
VE 10,202
Mvaa 128,204,140
VE 11,203
Cvaa 144,192,144,36
Ra 228,3,9216
Vc 101,10,11
Mvaa 144,196,148
Ra 232,3,10240
v_or3_b32 v7, v7, v100, v101
Mvaa 144,200,152
VE 12,216
Mvaa 144,204,156
s_waitcnt lgkmcnt(3)
Ra 236,3,11264
Ra 240,3,12288
Cvaa 132,208,128,32
buffer_load_dwordx4 v4, s[12:15], s38 offen offset:1024 sc1 lds
Mvaa 132,212,132
Ve 13,217
Mvaa 132,216,136
Ra 244,3,13312
Vc 108,12,13
Mvaa 132,220,140
VE 14,218
Cvaa 148,208,144,36
VE 15,219
Mvaa 148,212,148
buffer_load_dwordx4 v4, s[12:15], s38 offen offset:2048 sc1 lds
Mvaa 148,216,152
Ra 248,3,14336
Vc 109,14,15
Mvaa 148,220,156
s_waitcnt lgkmcnt(3)
Ra 252,3,15360
v_or3_b32 v7, v7, v108, v109
Cvaa 136,224,128,32
Ve 8,204
Mvaa 136,228,132
VE 9,205
Mvaa 136,232,136
Ra 192,2,49152
Vc 102,8,9
Mvaa 136,236,140
buffer_load_dwordx4 v4, s[12:15], s38 offen offset:3072 sc1 lds
Cvaa 152,224,144,36
VE 10,206
Mvaa 152,228,148
VE 11,207
Mvaa 152,232,152
Ra 196,2,50176
Vc 103,10,11
Mvaa 152,236,156
s_waitcnt lgkmcnt(2)
Ra 200,2,51200
Ra 204,2,52224
Cvaa 140,240,128,32
Ra 208,2,53248
v_or3_b32 v7, v7, v102, v103
Mvaa 140,244,132
s_cmp_lt_u32 s37, s52
VE 12,220
Mvaa 140,248,136
s_cbranch_scc1 L_nw_no
s_waitcnt vmcnt(12)
L_nw_no:
VE 13,221
Mvaa 140,252,140
Ra 212,2,54272
Vc 110,12,13
Cvaa 156,240,144,36
s_cmp_eq_u32 s37, s45
Ve 14,222
Mvaa 156,244,148
s_barrier
Ve 15,223
Mvaa 156,248,152
s_waitcnt lgkmcnt(2)
Ra 216,2,55296
Vc 111,14,15
v_or3_b32 v7, v7, v110, v111
v_and_b32 v1, 0x40004000, v7
v_cmp_ne_u32 vcc, 0, v1
Mvaa 156,252,156
s_cbranch_vccnz L_k2_fb_no
L_k2_fbr_no:
Ra 220,2,56320
Maav 0,192,96
s_cbranch_scc1 L_k2_mk_no
L_k2_mkr_no:
VE 8,128
Maav 0,196,100
s_add_u32 m0, s53, 16384
VE 9,129
Maav 32,192,104
buffer_load_dwordx4 v4, s[12:15], s39 offen offset:0 sc1 lds
Maav 32,196,108
s_add_u32 s37, s37, 1
Ra 224,2,57344
Vc 64,8,9
Maav 4,200,96
s_add_u32 s38, s38, 34816
Ve 10,130
Maav 4,204,100
s_xor_b32 s53, s53, 65536
VE 11,131
Maav 36,200,104
s_xor_b32 s54, s54, 65536
Ra 228,2,58368
Vc 65,10,11
Maav 36,204,108
Ra 232,2,59392
v_or_b32_e64 v7, v64, v65
Mvvv 48,16,96
VE 12,144
Mvvv 48,16,100
s_waitcnt lgkmcnt(3)
Ra 236,2,60416
Ra 240,2,61440
Maav 8,208,96
buffer_load_dwordx4 v4, s[12:15], s39 offen offset:1024 sc1 lds
Maav 8,212,100
Ve 13,145
Maav 40,208,104
Ra 244,2,62464
Vc 72,12,13
Maav 40,212,108
VE 14,146
Maav 12,216,96
VE 15,147
Maav 12,220,100
Ra 248,2,63488
Vc 73,14,15
Maav 44,216,104
Ra 252,2,64512
v_or3_b32 v7, v7, v72, v73
Maav 44,220,108
VE 8,132
Mvvv 52,16,104
buffer_load_dwordx4 v4, s[12:15], s39 offen offset:2048 sc1 lds
Mvvv 52,16,108
s_waitcnt lgkmcnt(4)
Ve 9,133
Maav 16,224,96
Ra 192,3,32768
Vc 66,8,9
Maav 16,228,100
VE 10,134
Maav 48,224,104
VE 11,135
Maav 48,228,108
Ra 196,3,33792
Vc 67,10,11
Maav 20,232,96
Ra 200,3,34816
v_or3_b32 v7, v7, v66, v67
Maav 20,236,100
Ra 204,3,35840
Ra 208,3,36864
Maav 52,232,104
buffer_load_dwordx4 v4, s[12:15], s39 offen offset:3072 sc1 lds
Maav 52,236,108
s_waitcnt lgkmcnt(5)
Ve 12,148
Maav 24,240,96
s_add_u32 s39, s39, 34816
VE 13,149
Maav 24,244,100
Ra 212,3,37888
Vc 74,12,13
Maav 56,240,104
VE 14,150
Maav 56,244,108
VE 15,151
Maav 28,248,96
Ra 216,3,38912
Vc 75,14,15
Maav 28,252,100
s_cmp_lg_u32 s37, s36
Ra 220,3,39936
v_or3_b32 v7, v7, v74, v75
Maav 60,248,104
s_waitcnt lgkmcnt(4)
VE 8,136
Maav 60,252,108
s_cbranch_scc1 L_k2_nloop
L_k2_fin:
v_xor_b32 v2, 65536, v2
v_xor_b32 v3, 65536, v3
Cvaa 192,192,128,32
Ve 9,137
Mvaa 192,196,132
Ra 224,2,40960
Vc 68,8,9
Mvaa 192,200,136
Ra 228,2,41984
Ra 232,2,43008
Mvaa 192,204,140
s_waitcnt lgkmcnt(3)
Ra 236,2,44032
Ra 240,2,45056
Cvaa 196,208,128,32
Ve 10,138
Mvaa 196,212,132
VE 11,139
Mvaa 196,216,136
Ra 244,2,46080
Vc 69,10,11
Mvaa 196,220,140
s_waitcnt lgkmcnt(2)
Ra 248,2,47104
Ra 252,2,48128
Cvaa 200,224,128,32
Ra 192,2,16384
v_or3_b32 v7, v7, v68, v69
Mvaa 200,228,132
s_cmp_lt_u32 s37, s52
VE 12,152
Mvaa 200,232,136
s_cbranch_scc1 L_nw_nl
s_waitcnt vmcnt(8)
L_nw_nl:
Ra 196,2,17408
Ra 200,2,18432
Mvaa 200,236,140
s_waitcnt lgkmcnt(3)
Ra 204,2,19456
Ra 208,2,20480
Cvaa 204,240,128,32
Ve 13,153
Mvaa 204,244,132
s_barrier
Ra 212,2,21504
Vc 76,12,13
Mvaa 204,248,136
s_waitcnt lgkmcnt(2)
Ve 14,154
Ve 15,155
Ve 8,140
Ve 9,141
Ve 10,142
Ve 11,143
Ve 12,156
Ve 13,157
Vc 77,14,15
Ve 14,158
Ve 15,159
Vc 70,8,9
Vc 71,10,11
Vc 78,12,13
Vc 79,14,15
v_or3_b32 v7, v7, v76, v77
v_or3_b32 v7, v7, v70, v71
v_or3_b32 v7, v7, v78, v79
v_and_b32 v1, 0x40004000, v7
v_cmp_ne_u32 vcc, 0, v1
Mvaa 204,252,140
s_cbranch_vccnz L_k2_fb_nl
L_k2_fbr_nl:
Ra 216,2,22528
Ra 220,2,23552
s_lshr_b32 s3, s42, 4
s_mul_i32 s3, s3, 33792
s_and_b32 s47, s42, 15
s_lshl_b32 s47, s47, 4
s_add_u32 s3, s3, s47
v_mov_b32 v28, s3
s_lshr_b32 s3, s43, 4
s_mul_i32 s3, s3, 33792
s_and_b32 s47, s43, 15
s_lshl_b32 s47, s47, 4
s_add_u32 s3, s3, s47
v_mov_b32 v29, s3
v_lshrrev_b32 v24, 4, v0
v_and_b32 v25, 15, v0
v_cmp_eq_u32 vcc, 1, v25
s_lshl_b32 s3, s32, 4
v_add_u32 v26, s3, v24
v_cndmask_b32 v28, v28, v29, vcc
v_lshl_add_u32 v28, v24, 8, v28
v_mul_u32_u24 v26, 7168, v26
v_lshlrev_b32 v24, 1, v24
v_xor_b32 v24, v24, v25
v_xor_b32_e64 v25, 8, v24
v_lshl_add_u32 v24, v24, 4, v26
v_lshl_add_u32 v25, v25, 4, v26
s_lshl_b32 s3, s92, 12
buffer_load_dwordx4 a[160:163], v28, s[20:23], s3 offen offset:0 sc1
buffer_load_dwordx4 a[164:167], v28, s[20:23], s3 offen offset:1024 sc1
buffer_load_dwordx4 a[168:171], v28, s[20:23], s3 offen offset:2048 sc1
buffer_load_dwordx4 a[172:175], v28, s[20:23], s3 offen offset:3072 sc1
Maav 0,192,64
s_branch L_k2_mk_nl
L_k2_mkr_nl:
VE 8,192
Maav 0,196,68
s_add_u32 m0, s54, 0
s_add_u32 s3, s5, 0
VE 9,193
Maav 32,192,72
buffer_load_dwordx4 v24, s[24:27], s3 offen offset:0 lds
Maav 32,196,76
s_add_u32 s3, s5, 27648
Ra 224,2,24576
Vc 96,8,9
Maav 4,200,64
buffer_load_dwordx4 v24, s[24:27], s3 offen offset:1024 lds
Maav 4,204,68
s_add_u32 s3, s5, 55296
VE 10,194
Maav 36,200,72
buffer_load_dwordx4 v25, s[24:27], s3 offen offset:2048 lds
Maav 36,204,76
s_add_u32 s3, s5, 82944
Ra 228,2,25600
Ra 232,2,26624
Mvvv 48,16,64
buffer_load_dwordx4 v25, s[24:27], s3 offen offset:3072 lds
Mvvv 48,16,68
s_waitcnt lgkmcnt(3)
s_add_u32 m0, s54, 16384
s_add_u32 s3, s5, 458752
Ra 236,2,27648
Ra 240,2,28672
Maav 8,208,64
buffer_load_dwordx4 v24, s[24:27], s3 offen offset:0 lds
Maav 8,212,68
s_add_u32 s3, s5, 486400
Ve 11,195
Maav 40,208,72
buffer_load_dwordx4 v24, s[24:27], s3 offen offset:1024 lds
Maav 40,212,76
s_add_u32 s3, s5, 514048
Ra 244,2,29696
Vc 97,10,11
Maav 12,216,64
buffer_load_dwordx4 v25, s[24:27], s3 offen offset:2048 lds
Maav 12,220,68
s_add_u32 s3, s5, 541696
Ra 248,2,30720
v_or_b32_e64 v7, v96, v97
Maav 44,216,72
buffer_load_dwordx4 v25, s[24:27], s3 offen offset:3072 lds
Maav 44,220,76
s_add_u32 m0, s54, 32768
s_add_u32 s3, s5, 0
Ve 12,196
Mvvv 52,16,72
buffer_load_dwordx4 v24, s[68:71], s3 offen offset:0 lds
Mvvv 52,16,76
s_waitcnt lgkmcnt(3)
s_add_u32 s3, s5, 27648
Ra 252,2,31744
Ra 192,2,49152
Maav 16,224,64
buffer_load_dwordx4 v24, s[68:71], s3 offen offset:1024 lds
Maav 16,228,68
s_add_u32 s3, s5, 55296
Ve 13,197
Maav 48,224,72
buffer_load_dwordx4 v25, s[68:71], s3 offen offset:2048 lds
Maav 48,228,76
s_add_u32 s3, s5, 82944
Ra 196,2,50176
Vc 98,12,13
Maav 20,232,64
buffer_load_dwordx4 v25, s[68:71], s3 offen offset:3072 lds
Maav 20,236,68
s_add_u32 m0, s54, 49152
s_add_u32 s3, s5, 458752
Ra 200,2,51200
Ra 204,2,52224
Maav 52,232,72
buffer_load_dwordx4 v24, s[68:71], s3 offen offset:0 lds
Maav 52,236,76
s_waitcnt lgkmcnt(4)
s_add_u32 s3, s5, 486400
Ve 14,198
Maav 24,240,64
buffer_load_dwordx4 v24, s[68:71], s3 offen offset:1024 lds
Maav 24,244,68
s_add_u32 s3, s5, 514048
VE 15,199
Maav 56,240,72
buffer_load_dwordx4 v25, s[68:71], s3 offen offset:2048 lds
Maav 56,244,76
s_add_u32 s3, s5, 541696
Ra 208,2,53248
Vc 99,14,15
Maav 28,248,64
buffer_load_dwordx4 v25, s[68:71], s3 offen offset:3072 lds
Maav 28,252,68
Ra 212,2,54272
v_or3_b32 v7, v7, v98, v99
Maav 60,248,72
s_waitcnt lgkmcnt(2)
Ra 216,2,55296
Ra 220,2,56320
Ve 8,200
Ve 9,201
Ve 10,202
Ve 11,203
Ve 12,204
Ve 13,205
Ve 14,206
VE 15,207
Vc 100,8,9
Vc 101,10,11
Vc 102,12,13
Vc 103,14,15
v_or3_b32 v7, v7, v100, v101
v_or3_b32 v7, v7, v102, v103
Maav 60,252,76
v_and_b32 v1, 0x40004000, v7
v_cmp_ne_u32 vcc, 0, v1
s_cbranch_vccnz L_k2_fb_fi
L_k2_fbr_fi:
Maav 0,192,96
Ra 224,2,57344
Ra 228,2,58368
Maav 0,196,100
Ra 232,2,59392
Ra 236,2,60416
Maav 4,200,96
Ra 240,2,61440
Ra 244,2,62464
Maav 4,204,100
Ra 248,2,63488
Ra 252,2,64512
Mvvv 48,16,96
s_mov_b32 s60, s8
s_and_b32 s61, s9, 0xffff
s_mov_b32 s62, 7340032
Mvvv 48,16,100
s_waitcnt lgkmcnt(8)
Maav 8,208,96
s_mov_b32 s63, 0x20000
s_mov_b32 s68, s10
s_and_b32 s69, s11, 0xffff
Maav 8,212,100
s_mov_b32 s70, 4194304
s_mov_b32 s71, 0x20000
s_mov_b32 s56, s40
Maav 12,216,96
s_and_b32 s57, s41, 0xffff
s_mov_b32 s58, 4194304
s_mov_b32 s59, 0x20000
Maav 12,220,100
s_waitcnt lgkmcnt(4)
Maav 16,224,96
s_bfe_u32 s6, s2, 0x20001
s_lshr_b32 s7, s34, 1
s_lshl_b32 s45, s7, 2
Maav 16,228,100
s_add_u32 s46, s45, s6
s_sub_u32 s46, 15, s46
s_sub_u32 s45, 12, s45
Maav 20,232,96
s_add_u32 s45, s45, s6
s_cmp_lt_u32 s7, 2
s_cselect_b32 s45, s46, s45
Maav 20,236,100
s_waitcnt lgkmcnt(0)
Maav 24,240,96
s_and_b32 s46, s2, 1
s_lshl_b32 s46, s46, 3
s_bfe_u32 s6, s2, 0x30003
Maav 24,244,100
s_add_u32 s46, s46, s6
s_mov_b32 s48, 0
s_mov_b32 s49, 15360
Maav 28,248,96
s_mov_b32 s50, 30720
s_mov_b32 s51, 46080
s_lshl_b32 s35, s32, 13
Maav 28,252,100
s_add_u32 s35, s35, 131072
s_and_b32 s52, s46, 1
s_lshl_b32 s6, s45, 20
s_lshl_b32 s7, s52, 19
s_add_u32 s6, s6, s7
s_add_u32 s6, s6, 46137344
s_add_u32 s8, s66, s6
s_addc_u32 s9, s67, 0
s_and_b32 s9, s9, 0xffff
s_mov_b32 s10, 524288
s_mov_b32 s11, 0x20000
s_lshr_b32 s7, s46, 1
s_lshl_b32 s7, s7, 8
s_lshl_b32 s6, s52, 22
s_add_u32 s6, s6, s7
s_add_u32 s12, s94, s6
s_addc_u32 s13, s95, 0
s_and_b32 s13, s13, 0xffff
s_mov_b32 s14, 0
s_mov_b32 s15, 0x20000
s_sub_u32 s14, 4194304, s7
s_mov_b32 s28, s94
s_and_b32 s29, s95, 0xffff
s_mov_b32 s30, 8388608
s_mov_b32 s31, 0x20000
s_lshl_b32 s7, s46, 7
s_lshl_b32 s36, s45, 18
s_add_u32 s36, s36, s7
s_and_b32 s94, s7, 128
s_lshl_b32 s38, s45, 7
s_lshl_b32 s6, s52, 6
s_add_u32 s38, s38, s6
s_add_u32 s38, s38, 5300224
s_lshl_b32 s52, s32, 11
v_lshlrev_b32 v112, 4, v0
v_lshrrev_b32 v121, 4, v0
v_and_b32 v122, 7, v0
v_lshrrev_b32 v123, 3, v0
v_lshlrev_b32 v124, 1, v121
v_xor_b32 v124, v124, v122
v_lshlrev_b32_e64 v124, 4, v124
v_lshl_add_u32 v113, v123, 11, v124
s_lshr_b32 s6, s32, 1
s_lshl_b32 s6, s6, 16
s_and_b32 s7, s32, 1
s_lshl_b32 s7, s7, 7
s_xor_b32 s7, s7, s94
s_xor_b32 s7, s7, 128
s_add_u32 s6, s6, s7
v_add_u32 v114, s6, v113
v_lshrrev_b32 v124, 2, v0
v_bfe_u32 v126, v0, 3, 2
v_lshlrev_b32 v124, 7, v124
v_and_b32 v125, 3, v0
v_lshl_add_u32 v124, v125, 3, v124
v_lshl_add_u32 v115, v126, 5, v124
v_xor_b32 v116, 32, v115
v_xor_b32 v117, 64, v115
v_xor_b32 v118, 96, v115
s_lshl_b32 s6, s32, 5
v_add_u32 v120, s6, v123
v_lshlrev_b32_e64 v119, 11, v120
v_lshl_add_u32 v119, v122, 4, v119
v_mov_b32 v126, 0
v_lshlrev_b32 v127, 2, v122
s_nop 7
s_lshl_b32 s3, s55, 20
s_lshl_b32 s47, s33, 15
s_add_u32 s3, s3, s47
s_lshl_b32 s47, s32, 10
v_lshlrev_b32 v248, 4, v0
v_add_u32_e64 v249, s47, v248
s_sub_u32 s47, 7168, s47
v_add_u32 v248, s47, v248
v_rcp_f32 v250, v48
v_rcp_f32 v252, v52
v_mov_b32 v251, v250
v_mov_b32_e64 v253, v252
Ar 240,32
Ar 241,33
Ar 242,34
Ar 243,35
Ar 244,36
Ar 245,37
Ar 246,38
Ar 247,39
v_pk_mul_f32 v[240:241], v[240:241], v[252:253]
v_pk_mul_f32 v[242:243], v[242:243], v[252:253]
v_pk_mul_f32 v[244:245], v[244:245], v[252:253]
v_pk_mul_f32 v[246:247], v[246:247], v[252:253]
Vc 28,240,241
Vc 29,242,243
Vc 30,244,245
Vc 31,246,247
buffer_store_dwordx4 v[28:31], v249, s[16:19], s3 offen sc1
Ar 240,0
Ar 241,1
Ar 242,2
Ar 243,3
Ar 244,4
Ar 245,5
Ar 246,6
Ar 247,7
v_pk_mul_f32 v[240:241], v[240:241], v[250:251]
v_pk_mul_f32 v[242:243], v[242:243], v[250:251]
v_pk_mul_f32 v[244:245], v[244:245], v[250:251]
v_pk_mul_f32 v[246:247], v[246:247], v[250:251]
Vc 24,240,241
Vc 25,242,243
Vc 26,244,245
Vc 27,246,247
buffer_store_dwordx4 v[24:27], v248, s[16:19], s3 offen sc1
s_add_u32 s3, s3, 8192
Ar 240,40
Ar 241,41
Ar 242,42
Ar 243,43
Ar 244,44
Ar 245,45
Ar 246,46
Ar 247,47
v_pk_mul_f32 v[240:241], v[240:241], v[252:253]
v_pk_mul_f32 v[242:243], v[242:243], v[252:253]
v_pk_mul_f32 v[244:245], v[244:245], v[252:253]
v_pk_mul_f32 v[246:247], v[246:247], v[252:253]
Vc 28,240,241
Vc 29,242,243
Vc 30,244,245
Vc 31,246,247
buffer_store_dwordx4 v[28:31], v249, s[16:19], s3 offen sc1
Ar 240,8
Ar 241,9
Ar 242,10
Ar 243,11
Ar 244,12
Ar 245,13
Ar 246,14
Ar 247,15
v_pk_mul_f32 v[240:241], v[240:241], v[250:251]
v_pk_mul_f32 v[242:243], v[242:243], v[250:251]
v_pk_mul_f32 v[244:245], v[244:245], v[250:251]
v_pk_mul_f32 v[246:247], v[246:247], v[250:251]
Vc 24,240,241
Vc 25,242,243
Vc 26,244,245
Vc 27,246,247
buffer_store_dwordx4 v[24:27], v248, s[16:19], s3 offen sc1
s_add_u32 s3, s3, 8192
Ar 240,48
Ar 241,49
Ar 242,50
Ar 243,51
Ar 244,52
Ar 245,53
Ar 246,54
Ar 247,55
v_pk_mul_f32 v[240:241], v[240:241], v[252:253]
v_pk_mul_f32 v[242:243], v[242:243], v[252:253]
v_pk_mul_f32 v[244:245], v[244:245], v[252:253]
v_pk_mul_f32 v[246:247], v[246:247], v[252:253]
Vc 28,240,241
Vc 29,242,243
Vc 30,244,245
Vc 31,246,247
buffer_store_dwordx4 v[28:31], v249, s[16:19], s3 offen sc1
Ar 240,16
Ar 241,17
Ar 242,18
Ar 243,19
Ar 244,20
Ar 245,21
Ar 246,22
Ar 247,23
v_pk_mul_f32 v[240:241], v[240:241], v[250:251]
v_pk_mul_f32 v[242:243], v[242:243], v[250:251]
v_pk_mul_f32 v[244:245], v[244:245], v[250:251]
v_pk_mul_f32 v[246:247], v[246:247], v[250:251]
Vc 24,240,241
Vc 25,242,243
Vc 26,244,245
Vc 27,246,247
buffer_store_dwordx4 v[24:27], v248, s[16:19], s3 offen sc1
s_add_u32 s3, s3, 8192
Ar 240,56
Ar 241,57
Ar 242,58
Ar 243,59
Ar 244,60
Ar 245,61
Ar 246,62
Ar 247,63
v_pk_mul_f32 v[240:241], v[240:241], v[252:253]
v_pk_mul_f32 v[242:243], v[242:243], v[252:253]
v_pk_mul_f32 v[244:245], v[244:245], v[252:253]
v_pk_mul_f32 v[246:247], v[246:247], v[252:253]
Vc 28,240,241
Vc 29,242,243
Vc 30,244,245
Vc 31,246,247
buffer_store_dwordx4 v[28:31], v249, s[16:19], s3 offen sc1
Ar 240,24
Ar 241,25
Ar 242,26
Ar 243,27
Ar 244,28
Ar 245,29
Ar 246,30
Ar 247,31
v_pk_mul_f32 v[240:241], v[240:241], v[250:251]
v_pk_mul_f32 v[242:243], v[242:243], v[250:251]
v_pk_mul_f32 v[244:245], v[244:245], v[250:251]
v_pk_mul_f32 v[246:247], v[246:247], v[250:251]
Vc 24,240,241
Vc 25,242,243
Vc 26,244,245
Vc 27,246,247
buffer_store_dwordx4 v[24:27], v248, s[16:19], s3 offen sc1
s_nop 1
v_lshrrev_b32 v24, 4, v0
v_bfe_u32 v25, v0, 2, 2
v_lshl_add_u32 v26, v24, 3, v25
v_lshlrev_b32 v26, 8, v26
v_and_b32 v27, 3, v0
v_lshl_add_u32 v26, v27, 3, v26
v_and_b32_e64 v27, 1, v24
v_lshl_add_u32 v25, v27, 2, v25
s_lshl_b32 s3, s32, 1
v_xor_b32 v25, s3, v25
v_lshl_add_u32 v26, v25, 5, v26
s_sub_u32 s3, s54, s44
v_add_u32 v26, s3, v26
v_xor_b32 v27, 32, v26
s_waitcnt vmcnt(8) lgkmcnt(0)
s_barrier
s_nop 0
ds_read_b64_tr_b16 v[128:129], v26 offset:0
ds_read_b64_tr_b16 v[130:131], v26 offset:1024
ds_read_b64_tr_b16 v[132:133], v27 offset:0
ds_read_b64_tr_b16 v[134:135], v27 offset:1024
ds_read_b64_tr_b16 v[136:137], v26 offset:8192
ds_read_b64_tr_b16 v[138:139], v26 offset:9216
ds_read_b64_tr_b16 v[140:141], v27 offset:8192
ds_read_b64_tr_b16 v[142:143], v27 offset:9216
ds_read_b64_tr_b16 v[144:145], v26 offset:16384
ds_read_b64_tr_b16 v[146:147], v26 offset:17408
ds_read_b64_tr_b16 v[148:149], v27 offset:16384
ds_read_b64_tr_b16 v[150:151], v27 offset:17408
ds_read_b64_tr_b16 v[152:153], v26 offset:24576
ds_read_b64_tr_b16 v[154:155], v26 offset:25600
ds_read_b64_tr_b16 v[156:157], v27 offset:24576
s_waitcnt lgkmcnt(9)
s_nop 0
ds_read_b64_tr_b16 v[158:159], v27 offset:25600
ds_read_b64_tr_b16 v[160:161], v26 offset:32768
ds_read_b64_tr_b16 v[162:163], v26 offset:33792
ds_read_b64_tr_b16 v[164:165], v27 offset:32768
ds_read_b64_tr_b16 v[166:167], v27 offset:33792
ds_read_b64_tr_b16 v[168:169], v26 offset:40960
s_waitcnt lgkmcnt(9)
s_nop 0
ds_read_b64_tr_b16 v[170:171], v26 offset:41984
ds_read_b64_tr_b16 v[172:173], v27 offset:40960
ds_read_b64_tr_b16 v[174:175], v27 offset:41984
ds_read_b64_tr_b16 v[176:177], v26 offset:49152
ds_read_b64_tr_b16 v[178:179], v26 offset:50176
ds_read_b64_tr_b16 v[180:181], v27 offset:49152
s_waitcnt lgkmcnt(9)
ds_read_b64_tr_b16 v[182:183], v27 offset:50176
ds_read_b64_tr_b16 v[184:185], v26 offset:57344
ds_read_b64_tr_b16 v[186:187], v26 offset:58368
ds_read_b64_tr_b16 v[188:189], v27 offset:57344
ds_read_b64_tr_b16 v[190:191], v27 offset:58368
v_and_b32 v25, 15, v0
v_mul_u32_u24 v28, 14336, v25
v_lshl_add_u32 v28, v24, 4, v28
v_mov_b32 v29, 2146435072
v_cmp_gt_u32 vcc, 2, v25
s_mul_i32 s3, s92, 57344
s_lshl_b32 s47, s4, 9
s_add_u32 s3, s3, s47
v_cndmask_b32 v28, v29, v28, vcc
s_lshl_b32 s47, s32, 7
s_add_u32 s3, s3, s47
s_add_u32 s3, s3, 6291456
Zvva 224,128,160
Zvva 228,132,160
Mvva 224,136,164
Mvva 228,140,164
Mvva 224,144,168
Mvva 228,148,168
Mvva 224,152,172
Mvva 228,156,172
s_waitcnt lgkmcnt(0)
Zvva 232,160,160
Zvva 236,164,160
Mvva 232,168,164
Mvva 236,172,164
Mvva 232,176,168
Mvva 236,180,168
Mvva 232,184,172
Mvva 236,188,172
v_mov_b32 v24, 1
v_mul_u32_u24 v25, s65, v0
s_waitcnt vmcnt(0)
s_barrier
s_mov_b64 exec, 3
buffer_store_dword v24, v25, s[20:23], s64 offen sc1
s_mov_b64 exec, -1
s_cmp_lg_u32 s34, 0
s_cselect_b32 s3, s3, 8388608
s_add_u32 s7, s3, 28672
buffer_store_dwordx4 v[224:227], v28, s[20:23], s3 offen offset:0 sc1
buffer_store_dwordx4 v[228:231], v28, s[20:23], s3 offen offset:64 sc1
buffer_store_dwordx4 v[232:235], v28, s[20:23], s7 offen offset:0 sc1
buffer_store_dwordx4 v[236:239], v28, s[20:23], s7 offen offset:64 sc1
s_mov_b32 s3, s36
s_nop 0
buffer_load_dwordx4 v[18:21], v119, s[56:59], s3 offen
s_add_u32 s3, s3, 16384
buffer_load_dwordx4 v[22:25], v119, s[56:59], s3 offen
s_add_u32 s3, s3, 16384
buffer_load_dwordx4 v[26:29], v119, s[56:59], s3 offen
s_add_u32 s3, s3, 16384
buffer_load_dwordx4 v[30:33], v119, s[56:59], s3 offen
s_lshl_b32 s3, s45, 10
s_add_u32 s3, s3, 5259264
v_lshlrev_b32 v124, 3, v120
buffer_load_dwordx2 v[34:35], v124, s[20:23], s3 offen offset:0 sc1
buffer_load_dwordx2 v[36:37], v124, s[20:23], s3 offen offset:64 sc1
buffer_load_dwordx2 v[38:39], v124, s[20:23], s3 offen offset:128 sc1
buffer_load_dwordx2 v[40:41], v124, s[20:23], s3 offen offset:192 sc1
v_and_b32 v10, 15, v0
v_lshlrev_b32 v10, 2, v10
s_add_u32 s95, s32, 32
s_lshl_b32 s95, s95, 16
s_add_u32 s95, s95, s94
s_xor_b32 s95, s95, 128
s_add_u32 m0, s44, 0
s_nop 0
s_nop 0
buffer_load_dwordx4 v114, s[12:15], s48 offen offset:0 lds
buffer_load_dwordx4 v114, s[12:15], s49 offen offset:1024 lds
buffer_load_dwordx4 v114, s[12:15], s50 offen offset:2048 lds
buffer_load_dwordx4 v114, s[12:15], s51 offen offset:3072 lds
v_add_u32 v114, 131072, v114
s_add_u32 m0, s44, 16384
s_nop 0
s_nop 0
buffer_load_dwordx4 v114, s[12:15], s48 offen offset:0 lds
buffer_load_dwordx4 v114, s[12:15], s49 offen offset:1024 lds
buffer_load_dwordx4 v114, s[12:15], s50 offen offset:2048 lds
buffer_load_dwordx4 v114, s[12:15], s51 offen offset:3072 lds
v_add_u32 v114, 131072, v114
buffer_load_dword v124, v10, s[20:23], s38 offen sc1
v_add_u32 v12, 65536, v115
v_add_u32 v13, 65536, v116
v_add_u32 v14, 65536, v117
v_add_u32 v15, 65536, v118
s_and_b32 s39, s2, 15
s_lshr_b32 s37, s2, 4
s_sub_u32 s37, s37, 2
s_lshl_b32 s54, s37, 2
s_add_u32 s54, s54, s32
s_lshl_b32 s3, s54, 17
s_lshl_b32 s7, s39, 7
s_add_u32 s3, s3, s7
s_cmp_ge_u32 s2, 32
s_cselect_b32 s3, s3, 2146435072
v_add_u32 v125, s3, v113
s_mov_b32 s40, 0
s_waitcnt vmcnt(9)
v_lshlrev_b32_e64 v42, 16, v18
v_and_b32 v43, 0xffff0000, v18
v_lshlrev_b32_e64 v44, 16, v19
v_and_b32 v45, 0xffff0000, v19
v_lshlrev_b32_e64 v46, 16, v20
v_and_b32 v47, 0xffff0000, v20
v_lshlrev_b32_e64 v48, 16, v21
v_and_b32 v49, 0xffff0000, v21
v_pk_add_f32 v[42:43], v[42:43], v[34:35] op_sel_hi:[1,0] neg_lo:[0,1] neg_hi:[0,1]
v_pk_add_f32 v[44:45], v[44:45], v[34:35] op_sel_hi:[1,0] neg_lo:[0,1] neg_hi:[0,1]
v_pk_add_f32 v[46:47], v[46:47], v[34:35] op_sel_hi:[1,0] neg_lo:[0,1] neg_hi:[0,1]
v_pk_add_f32 v[48:49], v[48:49], v[34:35] op_sel_hi:[1,0] neg_lo:[0,1] neg_hi:[0,1]
Vc 2,42,43
v_lshlrev_b32_e64 v42, 16, v2
v_and_b32 v43, 0xffff0000, v2
Vc 3,44,45
v_lshlrev_b32_e64 v44, 16, v3
v_and_b32 v45, 0xffff0000, v3
Vc 4,46,47
v_lshlrev_b32_e64 v46, 16, v4
v_and_b32 v47, 0xffff0000, v4
Vc 5,48,49
v_lshlrev_b32_e64 v48, 16, v5
v_and_b32 v49, 0xffff0000, v5
v_pk_mul_f32 v[42:43], v[42:43], v[34:35] op_sel:[0,1] op_sel_hi:[1,1]
v_pk_mul_f32 v[44:45], v[44:45], v[34:35] op_sel:[0,1] op_sel_hi:[1,1]
v_pk_mul_f32 v[46:47], v[46:47], v[34:35] op_sel:[0,1] op_sel_hi:[1,1]
v_pk_mul_f32 v[48:49], v[48:49], v[34:35] op_sel:[0,1] op_sel_hi:[1,1]
Vc 2,42,43
v_lshlrev_b32_e64 v42, 16, v2
v_and_b32 v43, 0xffff0000, v2
Vc 3,44,45
v_lshlrev_b32_e64 v44, 16, v3
v_and_b32 v45, 0xffff0000, v3
Vc 4,46,47
v_lshlrev_b32_e64 v46, 16, v4
v_and_b32 v47, 0xffff0000, v4
Vc 5,48,49
v_lshlrev_b32_e64 v48, 16, v5
v_and_b32 v49, 0xffff0000, v5
v_mul_f32 v2, 0xbfb8aa3b, v42
v_mul_f32 v3, 0xbfb8aa3b, v43
v_mul_f32 v4, 0xbfb8aa3b, v44
v_mul_f32 v5, 0xbfb8aa3b, v45
v_mul_f32 v6, 0xbfb8aa3b, v46
v_mul_f32 v7, 0xbfb8aa3b, v47
v_mul_f32 v8, 0xbfb8aa3b, v48
v_mul_f32 v9, 0xbfb8aa3b, v49
Ve 2,2
Ve 3,3
Ve 4,4
Ve 5,5
Ve 6,6
Ve 7,7
Ve 8,8
Ve 9,9
v_add_f32 v2, 1.0, v2
v_add_f32 v3, 1.0, v3
v_add_f32 v4, 1.0, v4
v_add_f32 v5, 1.0, v5
v_add_f32 v6, 1.0, v6
v_add_f32 v7, 1.0, v7
v_add_f32 v8, 1.0, v8
v_add_f32 v9, 1.0, v9
v_rcp_f32 v2, v2
v_rcp_f32 v3, v3
v_rcp_f32 v4, v4
v_rcp_f32 v5, v5
v_rcp_f32 v6, v6
v_rcp_f32 v7, v7
v_rcp_f32 v8, v8
v_rcp_f32 v9, v9
v_pk_mul_f32 v[42:43], v[42:43], v[2:3]
v_pk_mul_f32 v[44:45], v[44:45], v[4:5]
v_pk_mul_f32 v[46:47], v[46:47], v[6:7]
v_pk_mul_f32 v[48:49], v[48:49], v[8:9]
Vc 2,42,43
v_lshlrev_b32_e64 v42, 16, v2
v_and_b32 v43, 0xffff0000, v2
Vc 3,44,45
v_lshlrev_b32_e64 v44, 16, v3
v_and_b32 v45, 0xffff0000, v3
Vc 4,46,47
v_lshlrev_b32_e64 v46, 16, v4
v_and_b32 v47, 0xffff0000, v4
Vc 5,48,49
v_lshlrev_b32_e64 v48, 16, v5
v_and_b32 v49, 0xffff0000, v5
s_waitcnt vmcnt(0)
v_cmp_ne_u32 vcc, 1, v124
s_cbranch_vccnz L_spinC
s_nop 0
L_spinCr:
buffer_load_dwordx4 a[0:3], v112, s[8:11], s52 offen offset:0 sc1
buffer_load_dwordx4 a[4:7], v112, s[8:11], s52 offen offset:1024 sc1
s_add_u32 s52, s52, 8192
buffer_load_dwordx4 a[8:11], v112, s[8:11], s52 offen offset:0 sc1
buffer_load_dwordx4 a[12:15], v112, s[8:11], s52 offen offset:1024 sc1
s_add_u32 s52, s52, 8192
buffer_load_dwordx4 a[16:19], v112, s[8:11], s52 offen offset:0 sc1
buffer_load_dwordx4 a[20:23], v112, s[8:11], s52 offen offset:1024 sc1
s_add_u32 s52, s52, 8192
buffer_load_dwordx4 a[24:27], v112, s[8:11], s52 offen offset:0 sc1
buffer_load_dwordx4 a[28:31], v112, s[8:11], s52 offen offset:1024 sc1
s_add_u32 s52, s52, 8192
v_lshlrev_b32_e64 v50, 16, v22
v_and_b32 v51, 0xffff0000, v22
v_lshlrev_b32_e64 v52, 16, v23
v_and_b32 v53, 0xffff0000, v23
v_lshlrev_b32_e64 v54, 16, v24
v_and_b32 v55, 0xffff0000, v24
v_lshlrev_b32_e64 v56, 16, v25
v_and_b32 v57, 0xffff0000, v25
v_pk_add_f32 v[50:51], v[50:51], v[36:37] op_sel_hi:[1,0] neg_lo:[0,1] neg_hi:[0,1]
v_pk_add_f32 v[52:53], v[52:53], v[36:37] op_sel_hi:[1,0] neg_lo:[0,1] neg_hi:[0,1]
v_pk_add_f32 v[54:55], v[54:55], v[36:37] op_sel_hi:[1,0] neg_lo:[0,1] neg_hi:[0,1]
v_pk_add_f32 v[56:57], v[56:57], v[36:37] op_sel_hi:[1,0] neg_lo:[0,1] neg_hi:[0,1]
Vc 2,50,51
v_lshlrev_b32_e64 v50, 16, v2
v_and_b32 v51, 0xffff0000, v2
Vc 3,52,53
v_lshlrev_b32_e64 v52, 16, v3
v_and_b32 v53, 0xffff0000, v3
Vc 4,54,55
v_lshlrev_b32_e64 v54, 16, v4
v_and_b32 v55, 0xffff0000, v4
Vc 5,56,57
v_lshlrev_b32_e64 v56, 16, v5
v_and_b32 v57, 0xffff0000, v5
v_pk_mul_f32 v[50:51], v[50:51], v[36:37] op_sel:[0,1] op_sel_hi:[1,1]
v_pk_mul_f32 v[52:53], v[52:53], v[36:37] op_sel:[0,1] op_sel_hi:[1,1]
v_pk_mul_f32 v[54:55], v[54:55], v[36:37] op_sel:[0,1] op_sel_hi:[1,1]
v_pk_mul_f32 v[56:57], v[56:57], v[36:37] op_sel:[0,1] op_sel_hi:[1,1]
Vc 2,50,51
v_lshlrev_b32_e64 v50, 16, v2
v_and_b32 v51, 0xffff0000, v2
Vc 3,52,53
v_lshlrev_b32_e64 v52, 16, v3
v_and_b32 v53, 0xffff0000, v3
Vc 4,54,55
v_lshlrev_b32_e64 v54, 16, v4
v_and_b32 v55, 0xffff0000, v4
Vc 5,56,57
v_lshlrev_b32_e64 v56, 16, v5
v_and_b32 v57, 0xffff0000, v5
v_mul_f32 v2, 0xbfb8aa3b, v50
v_mul_f32 v3, 0xbfb8aa3b, v51
v_mul_f32 v4, 0xbfb8aa3b, v52
v_mul_f32 v5, 0xbfb8aa3b, v53
v_mul_f32 v6, 0xbfb8aa3b, v54
v_mul_f32 v7, 0xbfb8aa3b, v55
v_mul_f32 v8, 0xbfb8aa3b, v56
v_mul_f32 v9, 0xbfb8aa3b, v57
Ve 2,2
Ve 3,3
Ve 4,4
Ve 5,5
Ve 6,6
Ve 7,7
Ve 8,8
Ve 9,9
v_add_f32 v2, 1.0, v2
v_add_f32 v3, 1.0, v3
v_add_f32 v4, 1.0, v4
v_add_f32 v5, 1.0, v5
v_add_f32 v6, 1.0, v6
v_add_f32 v7, 1.0, v7
v_add_f32 v8, 1.0, v8
v_add_f32 v9, 1.0, v9
v_rcp_f32 v2, v2
v_rcp_f32 v3, v3
v_rcp_f32 v4, v4
v_rcp_f32 v5, v5
v_rcp_f32 v6, v6
v_rcp_f32 v7, v7
v_rcp_f32 v8, v8
v_rcp_f32 v9, v9
v_pk_mul_f32 v[50:51], v[50:51], v[2:3]
v_pk_mul_f32 v[52:53], v[52:53], v[4:5]
v_pk_mul_f32 v[54:55], v[54:55], v[6:7]
v_pk_mul_f32 v[56:57], v[56:57], v[8:9]
Vc 2,50,51
v_lshlrev_b32_e64 v50, 16, v2
v_and_b32 v51, 0xffff0000, v2
Vc 3,52,53
v_lshlrev_b32_e64 v52, 16, v3
v_and_b32 v53, 0xffff0000, v3
Vc 4,54,55
v_lshlrev_b32_e64 v54, 16, v4
v_and_b32 v55, 0xffff0000, v4
Vc 5,56,57
v_lshlrev_b32_e64 v56, 16, v5
v_and_b32 v57, 0xffff0000, v5
buffer_load_dwordx4 a[32:35], v112, s[8:11], s52 offen offset:0 sc1
buffer_load_dwordx4 a[36:39], v112, s[8:11], s52 offen offset:1024 sc1
s_add_u32 s52, s52, 8192
buffer_load_dwordx4 a[40:43], v112, s[8:11], s52 offen offset:0 sc1
buffer_load_dwordx4 a[44:47], v112, s[8:11], s52 offen offset:1024 sc1
s_add_u32 s52, s52, 8192
s_add_u32 m0, s44, 32768
s_nop 0
buffer_load_dwordx4 v114, s[12:15], s48 offen offset:0 lds
buffer_load_dwordx4 v114, s[12:15], s49 offen offset:1024 lds
buffer_load_dwordx4 v114, s[12:15], s50 offen offset:2048 lds
buffer_load_dwordx4 v114, s[12:15], s51 offen offset:3072 lds
v_add_u32 v114, 131072, v114
s_cmp_lg_u32 s40, 0
s_cbranch_scc1 L_nowd
s_add_u32 m0, s35, 0
s_nop 0
s_nop 0
buffer_load_dwordx4 v125, s[60:63], s48 offen offset:0 lds
buffer_load_dwordx4 v125, s[60:63], s49 offen offset:1024 lds
buffer_load_dwordx4 v125, s[60:63], s50 offen offset:2048 lds
buffer_load_dwordx4 v125, s[60:63], s51 offen offset:3072 lds
v_add_u32 v125, 65536, v125
s_add_u32 m0, s35, 4096
s_nop 0
buffer_load_dwordx4 v125, s[60:63], s48 offen offset:0 lds
buffer_load_dwordx4 v125, s[60:63], s49 offen offset:1024 lds
buffer_load_dwordx4 v125, s[60:63], s50 offen offset:2048 lds
buffer_load_dwordx4 v125, s[60:63], s51 offen offset:3072 lds
L_nowd:
s_cmp_lt_u32 s2, 128
s_cbranch_scc1 L_noc3
s_bfe_u32 s3, s2, 0x40003
s_lshl_b32 s3, s3, 2
s_add_u32 s3, s3, s32
s_lshl_b32 s3, s3, 15
s_and_b32 s7, s2, 1
s_lshl_b32 s7, s7, 10
s_add_u32 s3, s3, s7
s_add_u32 s3, s3, 384
v_and_b32 v1, 15, v0
v_lshlrev_b32 v1, 11, v1
v_lshrrev_b32_e64 v11, 5, v0
v_lshl_add_u32 v1, v11, 22, v1
buffer_load_dword v11, v1, s[28:31], s3 offen
L_noc3:
s_barrier
s_nop 0
ds_read_b64_tr_b16 v[192:193], v115 offset:0
ds_read_b64_tr_b16 v[194:195], v115 offset:2048
ds_read_b64_tr_b16 v[196:197], v116 offset:0
ds_read_b64_tr_b16 v[198:199], v116 offset:2048
ds_read_b64_tr_b16 v[200:201], v117 offset:0
ds_read_b64_tr_b16 v[202:203], v117 offset:2048
ds_read_b64_tr_b16 v[204:205], v118 offset:0
ds_read_b64_tr_b16 v[206:207], v118 offset:2048
ds_read_b64_tr_b16 v[208:209], v115 offset:4096
ds_read_b64_tr_b16 v[210:211], v115 offset:6144
ds_read_b64_tr_b16 v[212:213], v116 offset:4096
ds_read_b64_tr_b16 v[214:215], v116 offset:6144
ds_read_b64_tr_b16 v[216:217], v117 offset:4096
ds_read_b64_tr_b16 v[218:219], v117 offset:6144
ds_read_b64_tr_b16 v[220:221], v118 offset:4096
s_waitcnt lgkmcnt(9)
ds_read_b64_tr_b16 v[222:223], v118 offset:6144
s_waitcnt vmcnt(14)
s_waitcnt lgkmcnt(8)
Zvva 160,192,0
s_add_u32 m0, s44, 49152
ds_read_b64_tr_b16 v[224:225], v115 offset:8192
ds_read_b64_tr_b16 v[226:227], v115 offset:10240
v_mov_b32 v125, 1
Zvva 176,192,4
s_lshl_b32 s6, s4, 3
s_add_u32 s6, s6, s92
s_lshl_b32 s6, s6, 2
Zvva 164,196,0
ds_read_b64_tr_b16 v[228:229], v116 offset:8192
ds_read_b64_tr_b16 v[230:231], v116 offset:10240
Zvva 180,196,4
buffer_load_dwordx4 v114, s[12:15], s48 offen offset:0 lds
Zvva 168,200,0
s_waitcnt lgkmcnt(4)
ds_read_b64_tr_b16 v[232:233], v117 offset:8192
ds_read_b64_tr_b16 v[234:235], v117 offset:10240
Zvva 184,200,4
s_add_u32 s6, s6, 5447680
s_cmp_eq_u32 s32, 0
s_cselect_b32 s6, s6, s64
s_cmp_lg_u32 s34, 0
s_cselect_b32 s6, s6, 2146435072
Zvva 172,204,0
ds_read_b64_tr_b16 v[236:237], v118 offset:8192
ds_read_b64_tr_b16 v[238:239], v118 offset:10240
Zvva 188,204,4
buffer_load_dwordx4 v114, s[12:15], s49 offen offset:1024 lds
Zvva 128,208,0
ds_read_b64_tr_b16 v[240:241], v115 offset:12288
ds_read_b64_tr_b16 v[242:243], v115 offset:14336
Zvva 144,208,4
s_mov_b64 exec, 1
buffer_store_dword v125, v126, s[20:23], s6 offen sc1
s_mov_b64 exec, -1
Zvva 132,212,0
ds_read_b64_tr_b16 v[244:245], v116 offset:12288
ds_read_b64_tr_b16 v[246:247], v116 offset:14336
Zvva 148,212,4
buffer_load_dwordx4 v114, s[12:15], s50 offen offset:2048 lds
Zvva 136,216,0
s_waitcnt lgkmcnt(4)
ds_read_b64_tr_b16 v[248:249], v117 offset:12288
ds_read_b64_tr_b16 v[250:251], v117 offset:14336
Zvva 152,216,4
s_lshl_b32 s40, s45, 2
s_add_u32 s40, s40, s32
s_lshr_b32 s3, s42, 5
s_lshr_b32 s47, s43, 5
s_cmp_eq_u32 s3, s40
s_cselect_b32 s53, 1, 0
s_cmp_eq_u32 s47, s40
s_cselect_b32 s53, 1, s53
s_mov_b32 s40, 0
Zvva 140,220,0
s_barrier
ds_read_b64_tr_b16 v[252:253], v118 offset:12288
ds_read_b64_tr_b16 v[254:255], v118 offset:14336
Zvva 156,220,4
buffer_load_dwordx4 v114, s[12:15], s51 offen offset:3072 lds
v_add_u32 v114, 131072, v114
s_waitcnt vmcnt(17)
Mvva 160,224,8
ds_read_b64_tr_b16 v[192:193], v115 offset:16384
ds_read_b64_tr_b16 v[194:195], v115 offset:18432
Mvva 176,224,12
s_lshl_b32 s41, s46, 7
s_add_u32 s41, s41, 5449728
s_lshl_b32 s55, s46, 13
Mvva 164,228,8
ds_read_b64_tr_b16 v[196:197], v116 offset:16384
ds_read_b64_tr_b16 v[198:199], v116 offset:18432
Mvva 180,228,12
buffer_load_dwordx4 a[48:51], v112, s[8:11], s52 offen offset:0 sc1
Mvva 168,232,8
s_waitcnt lgkmcnt(4)
ds_read_b64_tr_b16 v[200:201], v117 offset:16384
ds_read_b64_tr_b16 v[202:203], v117 offset:18432
Mvva 184,232,12
s_add_u32 s55, s55, 5308416
s_add_u32 s16, s66, 88080384
s_addc_u32 s17, s67, 0
s_and_b32 s17, s17, 0xffff
Mvva 172,236,8
ds_read_b64_tr_b16 v[204:205], v118 offset:16384
ds_read_b64_tr_b16 v[206:207], v118 offset:18432
Mvva 188,236,12
buffer_load_dwordx4 a[52:55], v112, s[8:11], s52 offen offset:1024 sc1
s_add_u32 s52, s52, 8192
Mvva 128,240,8
ds_read_b64_tr_b16 v[208:209], v115 offset:20480
ds_read_b64_tr_b16 v[210:211], v115 offset:22528
Mvva 144,240,12
s_mov_b32 s18, 8388608
s_mov_b32 s19, 0x20000
s_lshl_b32 s24, s2, 2
Mvva 132,244,8
ds_read_b64_tr_b16 v[212:213], v116 offset:20480
ds_read_b64_tr_b16 v[214:215], v116 offset:22528
Mvva 148,244,12
buffer_load_dwordx4 a[56:59], v112, s[8:11], s52 offen offset:0 sc1
Mvva 136,248,8
s_waitcnt lgkmcnt(4)
ds_read_b64_tr_b16 v[216:217], v117 offset:20480
ds_read_b64_tr_b16 v[218:219], v117 offset:22528
Mvva 152,248,12
s_add_u32 s24, s24, s32
s_lshl_b32 s25, s24, 13
s_xor_b32 s26, s25, 262144
Mvva 140,252,8
ds_read_b64_tr_b16 v[220:221], v118 offset:20480
ds_read_b64_tr_b16 v[222:223], v118 offset:22528
Mvva 156,252,12
buffer_load_dwordx4 a[60:63], v112, s[8:11], s52 offen offset:1024 sc1
s_add_u32 s52, s52, 8192
s_waitcnt vmcnt(19)
Mvva 160,192,16
s_add_u32 m0, s44, 65536
ds_read_b64_tr_b16 v[224:225], v115 offset:24576
ds_read_b64_tr_b16 v[226:227], v115 offset:26624
Mvva 176,192,20
s_lshl_b32 s24, s24, 2
s_xor_b32 s27, s24, 128
s_add_u32 s24, s24, 5452800
Mvva 164,196,16
ds_read_b64_tr_b16 v[228:229], v116 offset:24576
ds_read_b64_tr_b16 v[230:231], v116 offset:26624
Mvva 180,196,20
buffer_load_dwordx4 v114, s[12:15], s48 offen offset:0 lds
Mvva 168,200,16
s_waitcnt lgkmcnt(4)
ds_read_b64_tr_b16 v[232:233], v117 offset:24576
ds_read_b64_tr_b16 v[234:235], v117 offset:26624
Mvva 184,200,20
s_add_u32 s27, s27, 5452800
v_lshlrev_b32_e64 v58, 16, v26
v_and_b32 v59, 0xffff0000, v26
v_lshlrev_b32_e64 v60, 16, v27
v_and_b32 v61, 0xffff0000, v27
v_lshlrev_b32_e64 v62, 16, v28
Mvva 172,204,16
ds_read_b64_tr_b16 v[236:237], v118 offset:24576
ds_read_b64_tr_b16 v[238:239], v118 offset:26624
v_and_b32 v63, 0xffff0000, v28
Mvva 188,204,20
buffer_load_dwordx4 v114, s[12:15], s49 offen offset:1024 lds
Mvva 128,208,16
ds_read_b64_tr_b16 v[240:241], v115 offset:28672
ds_read_b64_tr_b16 v[242:243], v115 offset:30720
v_lshlrev_b32_e64 v64, 16, v29
Mvva 144,208,20
v_and_b32 v65, 0xffff0000, v29
Vs 58,58,38
Vs 59,59,38
Vs 60,60,38
Vs 61,61,38
Mvva 132,212,16
ds_read_b64_tr_b16 v[244:245], v116 offset:28672
ds_read_b64_tr_b16 v[246:247], v116 offset:30720
v_sub_f32_e64 v62, v62, v38
Mvva 148,212,20
buffer_load_dwordx4 v114, s[12:15], s50 offen offset:2048 lds
Mvva 136,216,16
s_waitcnt vmcnt(12)
s_waitcnt lgkmcnt(4)
ds_read_b64_tr_b16 v[248:249], v117 offset:28672
ds_read_b64_tr_b16 v[250:251], v117 offset:30720
v_sub_f32_e64 v63, v63, v38
Mvva 152,216,20
Vs 64,64,38
Vs 65,65,38
Vc 2,58,59
v_lshlrev_b32_e64 v58, 16, v2
v_and_b32 v59, 0xffff0000, v2
Mvva 140,220,16
s_barrier
ds_read_b64_tr_b16 v[252:253], v118 offset:28672
ds_read_b64_tr_b16 v[254:255], v118 offset:30720
Vc 3,60,61
Mvva 156,220,20
buffer_load_dwordx4 v114, s[12:15], s51 offen offset:3072 lds
v_add_u32 v114, 131072, v114
Mvva 160,224,24
ds_read_b64_tr_b16 v[192:193], v115 offset:32768
ds_read_b64_tr_b16 v[194:195], v115 offset:34816
v_lshlrev_b32 v60, 16, v3
Mvva 176,224,28
v_and_b32 v61, 0xffff0000, v3
Vc 4,62,63
v_lshlrev_b32_e64 v62, 16, v4
v_and_b32 v63, 0xffff0000, v4
Vc 5,64,65
Mvva 164,228,24
ds_read_b64_tr_b16 v[196:197], v116 offset:32768
ds_read_b64_tr_b16 v[198:199], v116 offset:34816
v_lshlrev_b32_e64 v64, 16, v5
Mvva 180,228,28
buffer_load_dwordx4 a[64:67], v112, s[8:11], s52 offen offset:0 sc1
Mvva 168,232,24
s_waitcnt lgkmcnt(4)
ds_read_b64_tr_b16 v[200:201], v117 offset:32768
ds_read_b64_tr_b16 v[202:203], v117 offset:34816
v_and_b32 v65, 0xffff0000, v5
Mvva 184,232,28
Vm 58,58,39
Vm 59,59,39
Vm 60,60,39
Vm 61,61,39
Vm 62,62,39
Mvva 172,236,24
ds_read_b64_tr_b16 v[204:205], v118 offset:32768
ds_read_b64_tr_b16 v[206:207], v118 offset:34816
v_mul_f32_e64 v63, v63, v39
Mvva 188,236,28
buffer_load_dwordx4 a[68:71], v112, s[8:11], s52 offen offset:1024 sc1
s_add_u32 s52, s52, 8192
Mvva 128,240,24
ds_read_b64_tr_b16 v[208:209], v115 offset:36864
ds_read_b64_tr_b16 v[210:211], v115 offset:38912
v_mul_f32_e64 v64, v64, v39
Mvva 144,240,28
v_mul_f32_e64 v65, v65, v39
Vc 2,58,59
v_lshlrev_b32_e64 v58, 16, v2
v_and_b32 v59, 0xffff0000, v2
Vc 3,60,61
Mvva 132,244,24
ds_read_b64_tr_b16 v[212:213], v116 offset:36864
ds_read_b64_tr_b16 v[214:215], v116 offset:38912
v_lshlrev_b32_e64 v60, 16, v3
Mvva 148,244,28
buffer_load_dwordx4 a[72:75], v112, s[8:11], s52 offen offset:0 sc1
Mvva 136,248,24
s_waitcnt lgkmcnt(4)
ds_read_b64_tr_b16 v[216:217], v117 offset:36864
ds_read_b64_tr_b16 v[218:219], v117 offset:38912
v_and_b32 v61, 0xffff0000, v3
Mvva 152,248,28
Vc 4,62,63
v_lshlrev_b32 v62, 16, v4
v_and_b32 v63, 0xffff0000, v4
Vc 5,64,65
v_lshlrev_b32_e64 v64, 16, v5
Mvva 140,252,24
ds_read_b64_tr_b16 v[220:221], v118 offset:36864
ds_read_b64_tr_b16 v[222:223], v118 offset:38912
v_and_b32 v65, 0xffff0000, v5
Mvva 156,252,28
buffer_load_dwordx4 a[76:79], v112, s[8:11], s52 offen offset:1024 sc1
s_add_u32 s52, s52, 8192
Mvva 160,192,32
s_add_u32 m0, s44, 81920
ds_read_b64_tr_b16 v[224:225], v115 offset:40960
ds_read_b64_tr_b16 v[226:227], v115 offset:43008
v_mul_f32 v2, 0xbfb8aa3b, v58
Mvva 176,192,36
v_mul_f32 v3, 0xbfb8aa3b, v59
v_mul_f32 v4, 0xbfb8aa3b, v60
v_mul_f32 v5, 0xbfb8aa3b, v61
v_mul_f32 v6, 0xbfb8aa3b, v62
v_mul_f32 v7, 0xbfb8aa3b, v63
Mvva 164,196,32
ds_read_b64_tr_b16 v[228:229], v116 offset:40960
ds_read_b64_tr_b16 v[230:231], v116 offset:43008
v_mul_f32 v8, 0xbfb8aa3b, v64
Mvva 180,196,36
buffer_load_dwordx4 v114, s[12:15], s48 offen offset:0 lds
Mvva 168,200,32
s_waitcnt lgkmcnt(4)
ds_read_b64_tr_b16 v[232:233], v117 offset:40960
ds_read_b64_tr_b16 v[234:235], v117 offset:43008
v_mul_f32 v9, 0xbfb8aa3b, v65
Mvva 184,200,36
Ve 2,2
VE 3,3
Mvva 172,204,32
ds_read_b64_tr_b16 v[236:237], v118 offset:40960
ds_read_b64_tr_b16 v[238:239], v118 offset:43008
Mvva 188,204,36
buffer_load_dwordx4 v114, s[12:15], s49 offen offset:1024 lds
Mvva 128,208,32
ds_read_b64_tr_b16 v[240:241], v115 offset:45056
ds_read_b64_tr_b16 v[242:243], v115 offset:47104
Mvva 144,208,36
Ve 4,4
Ve 5,5
Mvva 132,212,32
ds_read_b64_tr_b16 v[244:245], v116 offset:45056
ds_read_b64_tr_b16 v[246:247], v116 offset:47104
Mvva 148,212,36
buffer_load_dwordx4 v114, s[12:15], s50 offen offset:2048 lds
Mvva 136,216,32
s_waitcnt vmcnt(15)
s_waitcnt lgkmcnt(4)
ds_read_b64_tr_b16 v[248:249], v117 offset:45056
ds_read_b64_tr_b16 v[250:251], v117 offset:47104
Mvva 152,216,36
Ve 6,6
Ve 7,7
Mvva 140,220,32
s_barrier
ds_read_b64_tr_b16 v[252:253], v118 offset:45056
ds_read_b64_tr_b16 v[254:255], v118 offset:47104
Mvva 156,220,36
buffer_load_dwordx4 v114, s[12:15], s51 offen offset:3072 lds
v_add_u32 v114, 131072, v114
Mvva 160,224,40
ds_read_b64_tr_b16 v[192:193], v115 offset:49152
ds_read_b64_tr_b16 v[194:195], v115 offset:51200
Mvva 176,224,44
Ve 8,8
Ve 9,9
v_add_f32 v2, 1.0, v2
Mvva 164,228,40
ds_read_b64_tr_b16 v[196:197], v116 offset:49152
ds_read_b64_tr_b16 v[198:199], v116 offset:51200
v_add_f32_e64 v3, 1.0, v3
Mvva 180,228,44
buffer_load_dwordx4 a[80:83], v112, s[8:11], s52 offen offset:0 sc1
Mvva 168,232,40
s_waitcnt lgkmcnt(4)
ds_read_b64_tr_b16 v[200:201], v117 offset:49152
ds_read_b64_tr_b16 v[202:203], v117 offset:51200
v_add_f32 v4, 1.0, v4
Mvva 184,232,44
v_add_f32 v5, 1.0, v5
v_add_f32 v6, 1.0, v6
v_add_f32 v7, 1.0, v7
v_add_f32 v8, 1.0, v8
v_add_f32_e64 v9, 1.0, v9
Mvva 172,236,40
ds_read_b64_tr_b16 v[204:205], v118 offset:49152
ds_read_b64_tr_b16 v[206:207], v118 offset:51200
Mvva 188,236,44
buffer_load_dwordx4 a[84:87], v112, s[8:11], s52 offen offset:1024 sc1
s_add_u32 s52, s52, 8192
Mvva 128,240,40
ds_read_b64_tr_b16 v[208:209], v115 offset:53248
ds_read_b64_tr_b16 v[210:211], v115 offset:55296
Mvva 144,240,44
v_rcp_f32 v2, v2
v_rcp_f32 v3, v3
Mvva 132,244,40
ds_read_b64_tr_b16 v[212:213], v116 offset:53248
ds_read_b64_tr_b16 v[214:215], v116 offset:55296
Mvva 148,244,44
buffer_load_dwordx4 a[88:91], v112, s[8:11], s52 offen offset:0 sc1
Mvva 136,248,40
s_waitcnt lgkmcnt(4)
ds_read_b64_tr_b16 v[216:217], v117 offset:53248
ds_read_b64_tr_b16 v[218:219], v117 offset:55296
Mvva 152,248,44
v_rcp_f32 v4, v4
v_rcp_f32_e64 v5, v5
Mvva 140,252,40
ds_read_b64_tr_b16 v[220:221], v118 offset:53248
ds_read_b64_tr_b16 v[222:223], v118 offset:55296
Mvva 156,252,44
buffer_load_dwordx4 a[92:95], v112, s[8:11], s52 offen offset:1024 sc1
s_add_u32 s52, s52, 8192
s_waitcnt vmcnt(18)
Mvva 160,192,48
s_add_u32 m0, s44, 98304
ds_read_b64_tr_b16 v[224:225], v115 offset:57344
ds_read_b64_tr_b16 v[226:227], v115 offset:59392
Mvva 176,192,52
v_rcp_f32 v6, v6
v_rcp_f32_e64 v7, v7
Mvva 164,196,48
ds_read_b64_tr_b16 v[228:229], v116 offset:57344
ds_read_b64_tr_b16 v[230:231], v116 offset:59392
Mvva 180,196,52
buffer_load_dwordx4 v114, s[12:15], s48 offen offset:0 lds
Mvva 168,200,48
s_waitcnt lgkmcnt(4)
ds_read_b64_tr_b16 v[232:233], v117 offset:57344
ds_read_b64_tr_b16 v[234:235], v117 offset:59392
Mvva 184,200,52
v_rcp_f32 v8, v8
v_rcp_f32 v9, v9
Vm 58,58,2
Mvva 172,204,48
ds_read_b64_tr_b16 v[236:237], v118 offset:57344
ds_read_b64_tr_b16 v[238:239], v118 offset:59392
v_mul_f32_e64 v59, v59, v3
Mvva 188,204,52
buffer_load_dwordx4 v114, s[12:15], s49 offen offset:1024 lds
Mvva 128,208,48
ds_read_b64_tr_b16 v[240:241], v115 offset:61440
ds_read_b64_tr_b16 v[242:243], v115 offset:63488
v_mul_f32_e64 v60, v60, v4
Mvva 144,208,52
Vm 61,61,5
Vm 62,62,6
Vm 63,63,7
Vm 64,64,8
v_mul_f32_e64 v65, v65, v9
Mvva 132,212,48
ds_read_b64_tr_b16 v[244:245], v116 offset:61440
ds_read_b64_tr_b16 v[246:247], v116 offset:63488
Vc 2,58,59
Mvva 148,212,52
buffer_load_dwordx4 v114, s[12:15], s50 offen offset:2048 lds
Mvva 136,216,48
s_waitcnt vmcnt(15)
s_waitcnt lgkmcnt(4)
ds_read_b64_tr_b16 v[248:249], v117 offset:61440
ds_read_b64_tr_b16 v[250:251], v117 offset:63488
v_lshlrev_b32_e64 v58, 16, v2
Mvva 152,216,52
v_and_b32 v59, 0xffff0000, v2
Vc 3,60,61
v_lshlrev_b32_e64 v60, 16, v3
v_and_b32 v61, 0xffff0000, v3
Vc 4,62,63
Mvva 140,220,48
s_barrier
ds_read_b64_tr_b16 v[252:253], v118 offset:61440
ds_read_b64_tr_b16 v[254:255], v118 offset:63488
v_lshlrev_b32 v62, 16, v4
Mvva 156,220,52
buffer_load_dwordx4 v114, s[12:15], s51 offen offset:3072 lds
v_add_u32 v114, 131072, v114
Mvva 160,224,56
ds_read_b64_tr_b16 v[192:193], v12 offset:0
ds_read_b64_tr_b16 v[194:195], v12 offset:2048
v_and_b32 v63, 0xffff0000, v4
Mvva 176,224,60
Vc 5,64,65
v_lshlrev_b32_e64 v64, 16, v5
v_and_b32 v65, 0xffff0000, v5
v_lshlrev_b32_e64 v66, 16, v30
v_and_b32 v67, 0xffff0000, v30
Mvva 164,228,56
ds_read_b64_tr_b16 v[196:197], v13 offset:0
ds_read_b64_tr_b16 v[198:199], v13 offset:2048
v_lshlrev_b32_e64 v68, 16, v31
Mvva 180,228,60
buffer_load_dwordx4 a[96:99], v112, s[8:11], s52 offen offset:0 sc1
Mvva 168,232,56
s_waitcnt lgkmcnt(4)
ds_read_b64_tr_b16 v[200:201], v14 offset:0
ds_read_b64_tr_b16 v[202:203], v14 offset:2048
v_and_b32 v69, 0xffff0000, v31
Mvva 184,232,60
v_lshlrev_b32 v70, 16, v32
v_and_b32 v71, 0xffff0000, v32
v_lshlrev_b32_e64 v72, 16, v33
v_and_b32 v73, 0xffff0000, v33
v_sub_f32_e64 v66, v66, v40
Mvva 172,236,56
ds_read_b64_tr_b16 v[204:205], v15 offset:0
ds_read_b64_tr_b16 v[206:207], v15 offset:2048
v_sub_f32_e64 v67, v67, v40
Mvva 188,236,60
buffer_load_dwordx4 a[100:103], v112, s[8:11], s52 offen offset:1024 sc1
s_add_u32 s52, s52, 8192
Mvva 128,240,56
ds_read_b64_tr_b16 v[208:209], v12 offset:4096
ds_read_b64_tr_b16 v[210:211], v12 offset:6144
v_sub_f32_e64 v68, v68, v40
Mvva 144,240,60
Vs 69,69,40
Vs 70,70,40
Vs 71,71,40
Vs 72,72,40
v_sub_f32_e64 v73, v73, v40
Mvva 132,244,56
ds_read_b64_tr_b16 v[212:213], v13 offset:4096
ds_read_b64_tr_b16 v[214:215], v13 offset:6144
Vc 2,66,67
Mvva 148,244,60
buffer_load_dwordx4 a[104:107], v112, s[8:11], s52 offen offset:0 sc1
Mvva 136,248,56
s_waitcnt lgkmcnt(4)
ds_read_b64_tr_b16 v[216:217], v14 offset:4096
ds_read_b64_tr_b16 v[218:219], v14 offset:6144
v_lshlrev_b32 v66, 16, v2
Mvva 152,248,60
v_and_b32 v67, 0xffff0000, v2
Vc 3,68,69
v_lshlrev_b32_e64 v68, 16, v3
v_and_b32 v69, 0xffff0000, v3
Vc 4,70,71
Mvva 140,252,56
ds_read_b64_tr_b16 v[220:221], v15 offset:4096
ds_read_b64_tr_b16 v[222:223], v15 offset:6144
v_lshlrev_b32_e64 v70, 16, v4
Mvva 156,252,60
buffer_load_dwordx4 a[108:111], v112, s[8:11], s52 offen offset:1024 sc1
s_add_u32 s52, s52, 8192
s_waitcnt vmcnt(18)
Mvva 160,192,64
s_add_u32 m0, s44, 114688
ds_read_b64_tr_b16 v[224:225], v12 offset:8192
ds_read_b64_tr_b16 v[226:227], v12 offset:10240
v_and_b32 v71, 0xffff0000, v4
Mvva 176,192,68
s_cmp_ge_u32 s2, 32
s_cbranch_scc1 L_f2A
L_f2Ar:
Mvva 164,196,64
ds_read_b64_tr_b16 v[228:229], v13 offset:8192
ds_read_b64_tr_b16 v[230:231], v13 offset:10240
Vc 5,72,73
Mvva 180,196,68
buffer_load_dwordx4 v114, s[12:15], s48 offen offset:0 lds
Mvva 168,200,64
s_waitcnt lgkmcnt(4)
ds_read_b64_tr_b16 v[232:233], v14 offset:8192
ds_read_b64_tr_b16 v[234:235], v14 offset:10240
v_lshlrev_b32_e64 v72, 16, v5
Mvva 184,200,68
v_and_b32 v73, 0xffff0000, v5
Vm 66,66,41
Vm 67,67,41
Vm 68,68,41
Vm 69,69,41
Mvva 172,204,64
ds_read_b64_tr_b16 v[236:237], v15 offset:8192
ds_read_b64_tr_b16 v[238:239], v15 offset:10240
v_mul_f32_e64 v70, v70, v41
Mvva 188,204,68
buffer_load_dwordx4 v114, s[12:15], s49 offen offset:1024 lds
Mvva 128,208,64
ds_read_b64_tr_b16 v[240:241], v12 offset:12288
ds_read_b64_tr_b16 v[242:243], v12 offset:14336
v_mul_f32_e64 v71, v71, v41
Mvva 144,208,68
Vm 72,72,41
Vm 73,73,41
Vc 2,66,67
v_lshlrev_b32_e64 v66, 16, v2
v_and_b32 v67, 0xffff0000, v2
Mvva 132,212,64
ds_read_b64_tr_b16 v[244:245], v13 offset:12288
ds_read_b64_tr_b16 v[246:247], v13 offset:14336
Vc 3,68,69
Mvva 148,212,68
buffer_load_dwordx4 v114, s[12:15], s50 offen offset:2048 lds
Mvva 136,216,64
s_waitcnt vmcnt(15)
s_waitcnt lgkmcnt(4)
ds_read_b64_tr_b16 v[248:249], v14 offset:12288
ds_read_b64_tr_b16 v[250:251], v14 offset:14336
v_lshlrev_b32_e64 v68, 16, v3
Mvva 152,216,68
v_and_b32 v69, 0xffff0000, v3
Vc 4,70,71
v_lshlrev_b32_e64 v70, 16, v4
v_and_b32 v71, 0xffff0000, v4
Vc 5,72,73
Mvva 140,220,64
s_barrier
ds_read_b64_tr_b16 v[252:253], v15 offset:12288
ds_read_b64_tr_b16 v[254:255], v15 offset:14336
v_lshlrev_b32 v72, 16, v5
Mvva 156,220,68
buffer_load_dwordx4 v114, s[12:15], s51 offen offset:3072 lds
v_add_u32 v114, 131072, v114
Mvva 160,224,72
ds_read_b64_tr_b16 v[192:193], v12 offset:16384
ds_read_b64_tr_b16 v[194:195], v12 offset:18432
v_and_b32 v73, 0xffff0000, v5
Mvva 176,224,76
v_mul_f32 v2, 0xbfb8aa3b, v66
v_mul_f32 v3, 0xbfb8aa3b, v67
v_mul_f32 v4, 0xbfb8aa3b, v68
v_mul_f32 v5, 0xbfb8aa3b, v69
v_mul_f32 v6, 0xbfb8aa3b, v70
Mvva 164,228,72
ds_read_b64_tr_b16 v[196:197], v13 offset:16384
ds_read_b64_tr_b16 v[198:199], v13 offset:18432
v_mul_f32 v7, 0xbfb8aa3b, v71
Mvva 180,228,76
buffer_load_dwordx4 a[112:115], v112, s[8:11], s52 offen offset:0 sc1
Mvva 168,232,72
s_waitcnt lgkmcnt(4)
ds_read_b64_tr_b16 v[200:201], v14 offset:16384
ds_read_b64_tr_b16 v[202:203], v14 offset:18432
v_mul_f32 v8, 0xbfb8aa3b, v72
Mvva 184,232,76
v_mul_f32 v9, 0xbfb8aa3b, v73
Ve 2,2
VE 3,3
Mvva 172,236,72
ds_read_b64_tr_b16 v[204:205], v15 offset:16384
ds_read_b64_tr_b16 v[206:207], v15 offset:18432
Mvva 188,236,76
buffer_load_dwordx4 a[116:119], v112, s[8:11], s52 offen offset:1024 sc1
s_add_u32 s52, s52, 8192
Mvva 128,240,72
ds_read_b64_tr_b16 v[208:209], v12 offset:20480
ds_read_b64_tr_b16 v[210:211], v12 offset:22528
Mvva 144,240,76
Ve 4,4
Ve 5,5
Mvva 132,244,72
ds_read_b64_tr_b16 v[212:213], v13 offset:20480
ds_read_b64_tr_b16 v[214:215], v13 offset:22528
Mvva 148,244,76
buffer_load_dwordx4 a[120:123], v112, s[8:11], s52 offen offset:0 sc1
Mvva 136,248,72
s_waitcnt lgkmcnt(4)
ds_read_b64_tr_b16 v[216:217], v14 offset:20480
ds_read_b64_tr_b16 v[218:219], v14 offset:22528
Mvva 152,248,76
Ve 6,6
VE 7,7
Mvva 140,252,72
ds_read_b64_tr_b16 v[220:221], v15 offset:20480
ds_read_b64_tr_b16 v[222:223], v15 offset:22528
Mvva 156,252,76
buffer_load_dwordx4 a[124:127], v112, s[8:11], s52 offen offset:1024 sc1
s_add_u32 s52, s52, 8192
s_waitcnt vmcnt(18)
Mvva 160,192,80
s_add_u32 m0, s44, 0
ds_read_b64_tr_b16 v[224:225], v12 offset:24576
ds_read_b64_tr_b16 v[226:227], v12 offset:26624
Mvva 176,192,84
Ve 8,8
Ve 9,9
v_add_f32_e64 v2, 1.0, v2
Mvva 164,196,80
ds_read_b64_tr_b16 v[228:229], v13 offset:24576
ds_read_b64_tr_b16 v[230:231], v13 offset:26624
v_add_f32_e64 v3, 1.0, v3
Mvva 180,196,84
buffer_load_dwordx4 v114, s[12:15], s48 offen offset:0 lds
Mvva 168,200,80
s_waitcnt lgkmcnt(4)
ds_read_b64_tr_b16 v[232:233], v14 offset:24576
ds_read_b64_tr_b16 v[234:235], v14 offset:26624
v_add_f32 v4, 1.0, v4
Mvva 184,200,84
v_add_f32 v5, 1.0, v5
v_add_f32 v6, 1.0, v6
v_add_f32 v7, 1.0, v7
v_add_f32 v8, 1.0, v8
v_add_f32_e64 v9, 1.0, v9
Mvva 172,204,80
ds_read_b64_tr_b16 v[236:237], v15 offset:24576
ds_read_b64_tr_b16 v[238:239], v15 offset:26624
Mvva 188,204,84
buffer_load_dwordx4 v114, s[12:15], s49 offen offset:1024 lds
Mvva 128,208,80
ds_read_b64_tr_b16 v[240:241], v12 offset:28672
ds_read_b64_tr_b16 v[242:243], v12 offset:30720
Mvva 144,208,84
v_rcp_f32 v2, v2
v_rcp_f32 v3, v3
Mvva 132,212,80
ds_read_b64_tr_b16 v[244:245], v13 offset:28672
ds_read_b64_tr_b16 v[246:247], v13 offset:30720
Mvva 148,212,84
buffer_load_dwordx4 v114, s[12:15], s50 offen offset:2048 lds
Mvva 136,216,80
s_waitcnt vmcnt(15)
s_waitcnt lgkmcnt(4)
ds_read_b64_tr_b16 v[248:249], v14 offset:28672
ds_read_b64_tr_b16 v[250:251], v14 offset:30720
Mvva 152,216,84
v_rcp_f32 v4, v4
v_rcp_f32 v5, v5
Mvva 140,220,80
s_barrier
ds_read_b64_tr_b16 v[252:253], v15 offset:28672
ds_read_b64_tr_b16 v[254:255], v15 offset:30720
Mvva 156,220,84
buffer_load_dwordx4 v114, s[12:15], s51 offen offset:3072 lds
v_add_u32 v114, 131072, v114
Mvva 160,224,88
ds_read_b64_tr_b16 v[192:193], v12 offset:32768
ds_read_b64_tr_b16 v[194:195], v12 offset:34816
Mvva 176,224,92
v_rcp_f32 v6, v6
v_rcp_f32_e64 v7, v7
Mvva 164,228,88
ds_read_b64_tr_b16 v[196:197], v13 offset:32768
ds_read_b64_tr_b16 v[198:199], v13 offset:34816
Mvva 180,228,92
buffer_load_dwordx4 a[128:131], v112, s[8:11], s52 offen offset:0 sc1
Mvva 168,232,88
s_waitcnt lgkmcnt(4)
ds_read_b64_tr_b16 v[200:201], v14 offset:32768
ds_read_b64_tr_b16 v[202:203], v14 offset:34816
Mvva 184,232,92
v_rcp_f32 v8, v8
v_rcp_f32 v9, v9
Vm 66,66,2
Mvva 172,236,88
ds_read_b64_tr_b16 v[204:205], v15 offset:32768
ds_read_b64_tr_b16 v[206:207], v15 offset:34816
v_mul_f32_e64 v67, v67, v3
Mvva 188,236,92
buffer_load_dwordx4 a[132:135], v112, s[8:11], s52 offen offset:1024 sc1
s_add_u32 s52, s52, 8192
Mvva 128,240,88
ds_read_b64_tr_b16 v[208:209], v12 offset:36864
ds_read_b64_tr_b16 v[210:211], v12 offset:38912
v_mul_f32_e64 v68, v68, v4
Mvva 144,240,92
Vm 69,69,5
Vm 70,70,6
Vm 71,71,7
Vm 72,72,8
v_mul_f32_e64 v73, v73, v9
Mvva 132,244,88
ds_read_b64_tr_b16 v[212:213], v13 offset:36864
ds_read_b64_tr_b16 v[214:215], v13 offset:38912
Vc 2,66,67
Mvva 148,244,92
buffer_load_dwordx4 a[136:139], v112, s[8:11], s52 offen offset:0 sc1
Mvva 136,248,88
s_waitcnt lgkmcnt(4)
ds_read_b64_tr_b16 v[216:217], v14 offset:36864
ds_read_b64_tr_b16 v[218:219], v14 offset:38912
v_lshlrev_b32 v66, 16, v2
Mvva 152,248,92
v_and_b32 v67, 0xffff0000, v2
Vc 3,68,69
v_lshlrev_b32_e64 v68, 16, v3
v_and_b32 v69, 0xffff0000, v3
Vc 4,70,71
Mvva 140,252,88
ds_read_b64_tr_b16 v[220:221], v15 offset:36864
ds_read_b64_tr_b16 v[222:223], v15 offset:38912
v_lshlrev_b32_e64 v70, 16, v4
Mvva 156,252,92
buffer_load_dwordx4 a[140:143], v112, s[8:11], s52 offen offset:1024 sc1
s_add_u32 s52, s52, 8192
s_waitcnt vmcnt(18)
Mvva 160,192,96
s_add_u32 m0, s44, 16384
ds_read_b64_tr_b16 v[224:225], v12 offset:40960
ds_read_b64_tr_b16 v[226:227], v12 offset:43008
v_and_b32 v71, 0xffff0000, v4
Mvva 176,192,100
Vc 5,72,73
v_lshlrev_b32 v72, 16, v5
v_and_b32 v73, 0xffff0000, v5
Mvva 164,196,96
ds_read_b64_tr_b16 v[228:229], v13 offset:40960
ds_read_b64_tr_b16 v[230:231], v13 offset:43008
Mvva 180,196,100
buffer_load_dwordx4 v114, s[12:15], s48 offen offset:0 lds
Mvva 168,200,96
s_waitcnt lgkmcnt(4)
ds_read_b64_tr_b16 v[232:233], v14 offset:40960
ds_read_b64_tr_b16 v[234:235], v14 offset:43008
Mvva 184,200,100
Mvva 172,204,96
ds_read_b64_tr_b16 v[236:237], v15 offset:40960
ds_read_b64_tr_b16 v[238:239], v15 offset:43008
Mvva 188,204,100
buffer_load_dwordx4 v114, s[12:15], s49 offen offset:1024 lds
Mvva 128,208,96
ds_read_b64_tr_b16 v[240:241], v12 offset:45056
ds_read_b64_tr_b16 v[242:243], v12 offset:47104
Mvva 144,208,100
Mvva 132,212,96
ds_read_b64_tr_b16 v[244:245], v13 offset:45056
ds_read_b64_tr_b16 v[246:247], v13 offset:47104
Mvva 148,212,100
buffer_load_dwordx4 v114, s[12:15], s50 offen offset:2048 lds
Mvva 136,216,96
s_waitcnt vmcnt(15)
s_waitcnt lgkmcnt(4)
ds_read_b64_tr_b16 v[248:249], v14 offset:45056
ds_read_b64_tr_b16 v[250:251], v14 offset:47104
Mvva 152,216,100
s_cmp_ge_u32 s2, 32
s_cbranch_scc1 L_f2B
L_f2Br:
Mvva 140,220,96
s_barrier
ds_read_b64_tr_b16 v[252:253], v15 offset:45056
ds_read_b64_tr_b16 v[254:255], v15 offset:47104
Mvva 156,220,100
buffer_load_dwordx4 v114, s[12:15], s51 offen offset:3072 lds
v_add_u32 v114, 131072, v114
Mvva 160,224,104
ds_read_b64_tr_b16 v[192:193], v12 offset:49152
ds_read_b64_tr_b16 v[194:195], v12 offset:51200
Mvva 176,224,108
Mvva 164,228,104
ds_read_b64_tr_b16 v[196:197], v13 offset:49152
ds_read_b64_tr_b16 v[198:199], v13 offset:51200
Mvva 180,228,108
buffer_load_dwordx4 a[144:147], v112, s[8:11], s52 offen offset:0 sc1
Mvva 168,232,104
s_waitcnt lgkmcnt(4)
ds_read_b64_tr_b16 v[200:201], v14 offset:49152
ds_read_b64_tr_b16 v[202:203], v14 offset:51200
Mvva 184,232,108
Mvva 172,236,104
ds_read_b64_tr_b16 v[204:205], v15 offset:49152
ds_read_b64_tr_b16 v[206:207], v15 offset:51200
Mvva 188,236,108
buffer_load_dwordx4 a[148:151], v112, s[8:11], s52 offen offset:1024 sc1
s_add_u32 s52, s52, 8192
Mvva 128,240,104
ds_read_b64_tr_b16 v[208:209], v12 offset:53248
ds_read_b64_tr_b16 v[210:211], v12 offset:55296
Mvva 144,240,108
Mvva 132,244,104
ds_read_b64_tr_b16 v[212:213], v13 offset:53248
ds_read_b64_tr_b16 v[214:215], v13 offset:55296
Mvva 148,244,108
buffer_load_dwordx4 a[152:155], v112, s[8:11], s52 offen offset:0 sc1
Mvva 136,248,104
s_waitcnt lgkmcnt(4)
ds_read_b64_tr_b16 v[216:217], v14 offset:53248
ds_read_b64_tr_b16 v[218:219], v14 offset:55296
Mvva 152,248,108
Mvva 140,252,104
ds_read_b64_tr_b16 v[220:221], v15 offset:53248
ds_read_b64_tr_b16 v[222:223], v15 offset:55296
Mvva 156,252,108
buffer_load_dwordx4 a[156:159], v112, s[8:11], s52 offen offset:1024 sc1
s_add_u32 s52, s52, 8192
s_waitcnt vmcnt(18)
Mvva 160,192,112
s_add_u32 m0, s44, 32768
ds_read_b64_tr_b16 v[224:225], v12 offset:57344
ds_read_b64_tr_b16 v[226:227], v12 offset:59392
Mvva 176,192,116
Mvva 164,196,112
ds_read_b64_tr_b16 v[228:229], v13 offset:57344
ds_read_b64_tr_b16 v[230:231], v13 offset:59392
Mvva 180,196,116
buffer_load_dwordx4 v114, s[12:15], s48 offen offset:0 lds
Mvva 168,200,112
s_waitcnt lgkmcnt(4)
ds_read_b64_tr_b16 v[232:233], v14 offset:57344
ds_read_b64_tr_b16 v[234:235], v14 offset:59392
Mvva 184,200,116
Mvva 172,204,112
ds_read_b64_tr_b16 v[236:237], v15 offset:57344
ds_read_b64_tr_b16 v[238:239], v15 offset:59392
Mvva 188,204,116
buffer_load_dwordx4 v114, s[12:15], s49 offen offset:1024 lds
Mvva 128,208,112
ds_read_b64_tr_b16 v[240:241], v12 offset:61440
ds_read_b64_tr_b16 v[242:243], v12 offset:63488
Mvva 144,208,116
Mvva 132,212,112
ds_read_b64_tr_b16 v[244:245], v13 offset:61440
ds_read_b64_tr_b16 v[246:247], v13 offset:63488
Mvva 148,212,116
buffer_load_dwordx4 v114, s[12:15], s50 offen offset:2048 lds
Mvva 136,216,112
s_waitcnt vmcnt(15)
s_waitcnt lgkmcnt(4)
ds_read_b64_tr_b16 v[248:249], v14 offset:61440
ds_read_b64_tr_b16 v[250:251], v14 offset:63488
Mvva 152,216,116
Mvva 140,220,112
s_barrier
ds_read_b64_tr_b16 v[252:253], v15 offset:61440
ds_read_b64_tr_b16 v[254:255], v15 offset:63488
Mvva 156,220,116
buffer_load_dwordx4 v114, s[12:15], s51 offen offset:3072 lds
v_add_u32 v114, 131072, v114
Mvva 160,224,120
ds_read_b64_tr_b16 v[192:193], v115 offset:0
ds_read_b64_tr_b16 v[194:195], v115 offset:2048
Mvva 176,224,124
Mvva 164,228,120
ds_read_b64_tr_b16 v[196:197], v116 offset:0
ds_read_b64_tr_b16 v[198:199], v116 offset:2048
Mvva 180,228,124
buffer_load_dwordx4 a[160:163], v112, s[8:11], s52 offen offset:0 sc1
Mvva 168,232,120
s_waitcnt lgkmcnt(4)
ds_read_b64_tr_b16 v[200:201], v117 offset:0
ds_read_b64_tr_b16 v[202:203], v117 offset:2048
Mvva 184,232,124
Mvva 172,236,120
ds_read_b64_tr_b16 v[204:205], v118 offset:0
ds_read_b64_tr_b16 v[206:207], v118 offset:2048
Mvva 188,236,124
buffer_load_dwordx4 a[164:167], v112, s[8:11], s52 offen offset:1024 sc1
s_add_u32 s52, s52, 8192
Mvva 128,240,120
ds_read_b64_tr_b16 v[208:209], v115 offset:4096
ds_read_b64_tr_b16 v[210:211], v115 offset:6144
Mvva 144,240,124
Mvva 132,244,120
ds_read_b64_tr_b16 v[212:213], v116 offset:4096
ds_read_b64_tr_b16 v[214:215], v116 offset:6144
Mvva 148,244,124
buffer_load_dwordx4 a[168:171], v112, s[8:11], s52 offen offset:0 sc1
Mvva 136,248,120
s_waitcnt lgkmcnt(4)
ds_read_b64_tr_b16 v[216:217], v117 offset:4096
ds_read_b64_tr_b16 v[218:219], v117 offset:6144
Mvva 152,248,124
Mvva 140,252,120
ds_read_b64_tr_b16 v[220:221], v118 offset:4096
ds_read_b64_tr_b16 v[222:223], v118 offset:6144
Mvva 156,252,124
buffer_load_dwordx4 a[172:175], v112, s[8:11], s52 offen offset:1024 sc1
s_add_u32 s52, s52, 8192
s_waitcnt vmcnt(18)
Mvva 160,192,128
s_add_u32 m0, s44, 49152
ds_read_b64_tr_b16 v[224:225], v115 offset:8192
ds_read_b64_tr_b16 v[226:227], v115 offset:10240
Mvva 176,192,132
Mvva 164,196,128
ds_read_b64_tr_b16 v[228:229], v116 offset:8192
ds_read_b64_tr_b16 v[230:231], v116 offset:10240
Mvva 180,196,132
buffer_load_dwordx4 v114, s[12:15], s48 offen offset:0 lds
Mvva 168,200,128
s_waitcnt lgkmcnt(4)
ds_read_b64_tr_b16 v[232:233], v117 offset:8192
ds_read_b64_tr_b16 v[234:235], v117 offset:10240
Mvva 184,200,132
Mvva 172,204,128
ds_read_b64_tr_b16 v[236:237], v118 offset:8192
ds_read_b64_tr_b16 v[238:239], v118 offset:10240
Mvva 188,204,132
buffer_load_dwordx4 v114, s[12:15], s49 offen offset:1024 lds
Mvva 128,208,128
ds_read_b64_tr_b16 v[240:241], v115 offset:12288
ds_read_b64_tr_b16 v[242:243], v115 offset:14336
Mvva 144,208,132
Mvva 132,212,128
ds_read_b64_tr_b16 v[244:245], v116 offset:12288
ds_read_b64_tr_b16 v[246:247], v116 offset:14336
Mvva 148,212,132
buffer_load_dwordx4 v114, s[12:15], s50 offen offset:2048 lds
Mvva 136,216,128
s_waitcnt vmcnt(15)
s_waitcnt lgkmcnt(4)
ds_read_b64_tr_b16 v[248:249], v117 offset:12288
ds_read_b64_tr_b16 v[250:251], v117 offset:14336
Mvva 152,216,132
Mvva 140,220,128
s_barrier
ds_read_b64_tr_b16 v[252:253], v118 offset:12288
ds_read_b64_tr_b16 v[254:255], v118 offset:14336
Mvva 156,220,132
buffer_load_dwordx4 v114, s[12:15], s51 offen offset:3072 lds
v_add_u32 v114, 131072, v114
Mvva 160,224,136
ds_read_b64_tr_b16 v[192:193], v115 offset:16384
ds_read_b64_tr_b16 v[194:195], v115 offset:18432
Mvva 176,224,140
Mvva 164,228,136
ds_read_b64_tr_b16 v[196:197], v116 offset:16384
ds_read_b64_tr_b16 v[198:199], v116 offset:18432
Mvva 180,228,140
buffer_load_dwordx4 a[176:179], v112, s[8:11], s52 offen offset:0 sc1
Mvva 168,232,136
s_waitcnt lgkmcnt(4)
ds_read_b64_tr_b16 v[200:201], v117 offset:16384
ds_read_b64_tr_b16 v[202:203], v117 offset:18432
Mvva 184,232,140
Mvva 172,236,136
ds_read_b64_tr_b16 v[204:205], v118 offset:16384
ds_read_b64_tr_b16 v[206:207], v118 offset:18432
Mvva 188,236,140
buffer_load_dwordx4 a[180:183], v112, s[8:11], s52 offen offset:1024 sc1
s_add_u32 s52, s52, 8192
Mvva 128,240,136
ds_read_b64_tr_b16 v[208:209], v115 offset:20480
ds_read_b64_tr_b16 v[210:211], v115 offset:22528
Mvva 144,240,140
Mvva 132,244,136
ds_read_b64_tr_b16 v[212:213], v116 offset:20480
ds_read_b64_tr_b16 v[214:215], v116 offset:22528
Mvva 148,244,140
buffer_load_dwordx4 a[184:187], v112, s[8:11], s52 offen offset:0 sc1
Mvva 136,248,136
s_waitcnt lgkmcnt(4)
ds_read_b64_tr_b16 v[216:217], v117 offset:20480
ds_read_b64_tr_b16 v[218:219], v117 offset:22528
Mvva 152,248,140
s_cmp_ge_u32 s2, 32
s_cbranch_scc1 L_f2C
L_f2Cr:
Mvva 140,252,136
ds_read_b64_tr_b16 v[220:221], v118 offset:20480
ds_read_b64_tr_b16 v[222:223], v118 offset:22528
Mvva 156,252,140
buffer_load_dwordx4 a[188:191], v112, s[8:11], s52 offen offset:1024 sc1
s_add_u32 s52, s52, 8192
s_waitcnt vmcnt(18)
Mvva 160,192,144
s_add_u32 m0, s44, 65536
ds_read_b64_tr_b16 v[224:225], v115 offset:24576
ds_read_b64_tr_b16 v[226:227], v115 offset:26624
Mvva 176,192,148
Mvva 164,196,144
ds_read_b64_tr_b16 v[228:229], v116 offset:24576
ds_read_b64_tr_b16 v[230:231], v116 offset:26624
Mvva 180,196,148
buffer_load_dwordx4 v114, s[12:15], s48 offen offset:0 lds
Mvva 168,200,144
s_waitcnt lgkmcnt(4)
ds_read_b64_tr_b16 v[232:233], v117 offset:24576
ds_read_b64_tr_b16 v[234:235], v117 offset:26624
Mvva 184,200,148
Mvva 172,204,144
ds_read_b64_tr_b16 v[236:237], v118 offset:24576
ds_read_b64_tr_b16 v[238:239], v118 offset:26624
Mvva 188,204,148
buffer_load_dwordx4 v114, s[12:15], s49 offen offset:1024 lds
Mvva 128,208,144
ds_read_b64_tr_b16 v[240:241], v115 offset:28672
ds_read_b64_tr_b16 v[242:243], v115 offset:30720
Mvva 144,208,148
Mvva 132,212,144
ds_read_b64_tr_b16 v[244:245], v116 offset:28672
ds_read_b64_tr_b16 v[246:247], v116 offset:30720
Mvva 148,212,148
buffer_load_dwordx4 v114, s[12:15], s50 offen offset:2048 lds
Mvva 136,216,144
s_waitcnt vmcnt(15)
s_waitcnt lgkmcnt(4)
ds_read_b64_tr_b16 v[248:249], v117 offset:28672
ds_read_b64_tr_b16 v[250:251], v117 offset:30720
Mvva 152,216,148
Mvva 140,220,144
s_barrier
ds_read_b64_tr_b16 v[252:253], v118 offset:28672
ds_read_b64_tr_b16 v[254:255], v118 offset:30720
Mvva 156,220,148
buffer_load_dwordx4 v114, s[12:15], s51 offen offset:3072 lds
v_add_u32 v114, 131072, v114
Mvva 160,224,152
ds_read_b64_tr_b16 v[192:193], v115 offset:32768
ds_read_b64_tr_b16 v[194:195], v115 offset:34816
Mvva 176,224,156
s_cmp_ge_u32 s2, 128
s_cbranch_scc1 L_c31
L_c31r:
Mvva 164,228,152
ds_read_b64_tr_b16 v[196:197], v116 offset:32768
ds_read_b64_tr_b16 v[198:199], v116 offset:34816
Mvva 180,228,156
buffer_load_dwordx4 a[192:195], v112, s[8:11], s52 offen offset:0 sc1
Mvva 168,232,152
s_waitcnt lgkmcnt(4)
ds_read_b64_tr_b16 v[200:201], v117 offset:32768
ds_read_b64_tr_b16 v[202:203], v117 offset:34816
Mvva 184,232,156
Mvva 172,236,152
ds_read_b64_tr_b16 v[204:205], v118 offset:32768
ds_read_b64_tr_b16 v[206:207], v118 offset:34816
Mvva 188,236,156
buffer_load_dwordx4 a[196:199], v112, s[8:11], s52 offen offset:1024 sc1
s_add_u32 s52, s52, 8192
Mvva 128,240,152
ds_read_b64_tr_b16 v[208:209], v115 offset:36864
ds_read_b64_tr_b16 v[210:211], v115 offset:38912
Mvva 144,240,156
Mvva 132,244,152
ds_read_b64_tr_b16 v[212:213], v116 offset:36864
ds_read_b64_tr_b16 v[214:215], v116 offset:38912
Mvva 148,244,156
buffer_load_dwordx4 a[200:203], v112, s[8:11], s52 offen offset:0 sc1
Mvva 136,248,152
s_waitcnt lgkmcnt(4)
ds_read_b64_tr_b16 v[216:217], v117 offset:36864
ds_read_b64_tr_b16 v[218:219], v117 offset:38912
Mvva 152,248,156
Mvva 140,252,152
ds_read_b64_tr_b16 v[220:221], v118 offset:36864
ds_read_b64_tr_b16 v[222:223], v118 offset:38912
Mvva 156,252,156
buffer_load_dwordx4 a[204:207], v112, s[8:11], s52 offen offset:1024 sc1
s_add_u32 s52, s52, 8192
s_waitcnt vmcnt(18)
Mvva 160,192,160
s_add_u32 m0, s44, 81920
ds_read_b64_tr_b16 v[224:225], v115 offset:40960
ds_read_b64_tr_b16 v[226:227], v115 offset:43008
Mvva 176,192,164
Mvva 164,196,160
ds_read_b64_tr_b16 v[228:229], v116 offset:40960
ds_read_b64_tr_b16 v[230:231], v116 offset:43008
Mvva 180,196,164
buffer_load_dwordx4 v114, s[12:15], s48 offen offset:0 lds
Mvva 168,200,160
s_waitcnt lgkmcnt(4)
ds_read_b64_tr_b16 v[232:233], v117 offset:40960
ds_read_b64_tr_b16 v[234:235], v117 offset:43008
Mvva 184,200,164
Mvva 172,204,160
ds_read_b64_tr_b16 v[236:237], v118 offset:40960
ds_read_b64_tr_b16 v[238:239], v118 offset:43008
Mvva 188,204,164
buffer_load_dwordx4 v114, s[12:15], s49 offen offset:1024 lds
Mvva 128,208,160
ds_read_b64_tr_b16 v[240:241], v115 offset:45056
ds_read_b64_tr_b16 v[242:243], v115 offset:47104
Mvva 144,208,164
Mvva 132,212,160
ds_read_b64_tr_b16 v[244:245], v116 offset:45056
ds_read_b64_tr_b16 v[246:247], v116 offset:47104
Mvva 148,212,164
buffer_load_dwordx4 v114, s[12:15], s50 offen offset:2048 lds
Mvva 136,216,160
s_waitcnt vmcnt(15)
s_waitcnt lgkmcnt(4)
ds_read_b64_tr_b16 v[248:249], v117 offset:45056
ds_read_b64_tr_b16 v[250:251], v117 offset:47104
Mvva 152,216,164
Mvva 140,220,160
s_barrier
ds_read_b64_tr_b16 v[252:253], v118 offset:45056
ds_read_b64_tr_b16 v[254:255], v118 offset:47104
Mvva 156,220,164
buffer_load_dwordx4 v114, s[12:15], s51 offen offset:3072 lds
v_add_u32 v114, 131072, v114
Mvva 160,224,168
ds_read_b64_tr_b16 v[192:193], v115 offset:49152
ds_read_b64_tr_b16 v[194:195], v115 offset:51200
Mvva 176,224,172
Mvva 164,228,168
ds_read_b64_tr_b16 v[196:197], v116 offset:49152
ds_read_b64_tr_b16 v[198:199], v116 offset:51200
Mvva 180,228,172
buffer_load_dwordx4 a[208:211], v112, s[8:11], s52 offen offset:0 sc1
Mvva 168,232,168
s_waitcnt lgkmcnt(4)
ds_read_b64_tr_b16 v[200:201], v117 offset:49152
ds_read_b64_tr_b16 v[202:203], v117 offset:51200
Mvva 184,232,172
Mvva 172,236,168
ds_read_b64_tr_b16 v[204:205], v118 offset:49152
ds_read_b64_tr_b16 v[206:207], v118 offset:51200
Mvva 188,236,172
buffer_load_dwordx4 a[212:215], v112, s[8:11], s52 offen offset:1024 sc1
s_add_u32 s52, s52, 8192
Mvva 128,240,168
ds_read_b64_tr_b16 v[208:209], v115 offset:53248
ds_read_b64_tr_b16 v[210:211], v115 offset:55296
Mvva 144,240,172
Mvva 132,244,168
ds_read_b64_tr_b16 v[212:213], v116 offset:53248
ds_read_b64_tr_b16 v[214:215], v116 offset:55296
Mvva 148,244,172
buffer_load_dwordx4 a[216:219], v112, s[8:11], s52 offen offset:0 sc1
Mvva 136,248,168
s_waitcnt lgkmcnt(4)
ds_read_b64_tr_b16 v[216:217], v117 offset:53248
ds_read_b64_tr_b16 v[218:219], v117 offset:55296
Mvva 152,248,172
Mvva 140,252,168
ds_read_b64_tr_b16 v[220:221], v118 offset:53248
ds_read_b64_tr_b16 v[222:223], v118 offset:55296
Mvva 156,252,172
buffer_load_dwordx4 a[220:223], v112, s[8:11], s52 offen offset:1024 sc1
s_add_u32 s52, s52, 8192
s_waitcnt vmcnt(18)
Mvva 160,192,176
s_add_u32 m0, s44, 98304
ds_read_b64_tr_b16 v[224:225], v115 offset:57344
ds_read_b64_tr_b16 v[226:227], v115 offset:59392
Mvva 176,192,180
Mvva 164,196,176
ds_read_b64_tr_b16 v[228:229], v116 offset:57344
ds_read_b64_tr_b16 v[230:231], v116 offset:59392
Mvva 180,196,180
buffer_load_dwordx4 v114, s[12:15], s48 offen offset:0 lds
Mvva 168,200,176
s_waitcnt lgkmcnt(4)
ds_read_b64_tr_b16 v[232:233], v117 offset:57344
ds_read_b64_tr_b16 v[234:235], v117 offset:59392
Mvva 184,200,180
Mvva 172,204,176
ds_read_b64_tr_b16 v[236:237], v118 offset:57344
ds_read_b64_tr_b16 v[238:239], v118 offset:59392
Mvva 188,204,180
buffer_load_dwordx4 v114, s[12:15], s49 offen offset:1024 lds
Mvva 128,208,176
ds_read_b64_tr_b16 v[240:241], v115 offset:61440
ds_read_b64_tr_b16 v[242:243], v115 offset:63488
Mvva 144,208,180
s_cmp_ge_u32 s2, 32
s_cbranch_scc1 L_f2E
L_f2Er:
Mvva 132,212,176
ds_read_b64_tr_b16 v[244:245], v116 offset:61440
ds_read_b64_tr_b16 v[246:247], v116 offset:63488
Mvva 148,212,180
buffer_load_dwordx4 v114, s[12:15], s50 offen offset:2048 lds
Mvva 136,216,176
s_waitcnt vmcnt(15)
s_waitcnt lgkmcnt(4)
ds_read_b64_tr_b16 v[248:249], v117 offset:61440
ds_read_b64_tr_b16 v[250:251], v117 offset:63488
Mvva 152,216,180
Mvva 140,220,176
s_barrier
ds_read_b64_tr_b16 v[252:253], v118 offset:61440
ds_read_b64_tr_b16 v[254:255], v118 offset:63488
Mvva 156,220,180
buffer_load_dwordx4 v114, s[12:15], s51 offen offset:3072 lds
v_add_u32 v114, 131072, v114
Mvva 160,224,184
ds_read_b64_tr_b16 v[192:193], v12 offset:0
ds_read_b64_tr_b16 v[194:195], v12 offset:2048
Mvva 176,224,188
Mvva 164,228,184
ds_read_b64_tr_b16 v[196:197], v13 offset:0
ds_read_b64_tr_b16 v[198:199], v13 offset:2048
Mvva 180,228,188
buffer_load_dwordx4 a[224:227], v112, s[8:11], s52 offen offset:0 sc1
Mvva 168,232,184
s_waitcnt lgkmcnt(4)
ds_read_b64_tr_b16 v[200:201], v14 offset:0
ds_read_b64_tr_b16 v[202:203], v14 offset:2048
Mvva 184,232,188
Mvva 172,236,184
ds_read_b64_tr_b16 v[204:205], v15 offset:0
ds_read_b64_tr_b16 v[206:207], v15 offset:2048
Mvva 188,236,188
buffer_load_dwordx4 a[228:231], v112, s[8:11], s52 offen offset:1024 sc1
s_add_u32 s52, s52, 8192
Mvva 128,240,184
ds_read_b64_tr_b16 v[208:209], v12 offset:4096
ds_read_b64_tr_b16 v[210:211], v12 offset:6144
Mvva 144,240,188
Mvva 132,244,184
ds_read_b64_tr_b16 v[212:213], v13 offset:4096
ds_read_b64_tr_b16 v[214:215], v13 offset:6144
Mvva 148,244,188
buffer_load_dwordx4 a[232:235], v112, s[8:11], s52 offen offset:0 sc1
Mvva 136,248,184
s_waitcnt lgkmcnt(4)
ds_read_b64_tr_b16 v[216:217], v14 offset:4096
ds_read_b64_tr_b16 v[218:219], v14 offset:6144
Mvva 152,248,188
Mvva 140,252,184
ds_read_b64_tr_b16 v[220:221], v15 offset:4096
ds_read_b64_tr_b16 v[222:223], v15 offset:6144
Mvva 156,252,188
buffer_load_dwordx4 a[236:239], v112, s[8:11], s52 offen offset:1024 sc1
s_add_u32 s52, s52, 8192
s_waitcnt vmcnt(18)
Mvva 160,192,192
s_add_u32 m0, s44, 114688
ds_read_b64_tr_b16 v[224:225], v12 offset:8192
ds_read_b64_tr_b16 v[226:227], v12 offset:10240
Mvva 176,192,196
Mvva 164,196,192
ds_read_b64_tr_b16 v[228:229], v13 offset:8192
ds_read_b64_tr_b16 v[230:231], v13 offset:10240
Mvva 180,196,196
buffer_load_dwordx4 v114, s[12:15], s48 offen offset:0 lds
Mvva 168,200,192
s_waitcnt lgkmcnt(4)
ds_read_b64_tr_b16 v[232:233], v14 offset:8192
ds_read_b64_tr_b16 v[234:235], v14 offset:10240
Mvva 184,200,196
Mvva 172,204,192
ds_read_b64_tr_b16 v[236:237], v15 offset:8192
ds_read_b64_tr_b16 v[238:239], v15 offset:10240
Mvva 188,204,196
buffer_load_dwordx4 v114, s[12:15], s49 offen offset:1024 lds
Mvva 128,208,192
ds_read_b64_tr_b16 v[240:241], v12 offset:12288
ds_read_b64_tr_b16 v[242:243], v12 offset:14336
Mvva 144,208,196
Mvva 132,212,192
ds_read_b64_tr_b16 v[244:245], v13 offset:12288
ds_read_b64_tr_b16 v[246:247], v13 offset:14336
Mvva 148,212,196
buffer_load_dwordx4 v114, s[12:15], s50 offen offset:2048 lds
Mvva 136,216,192
s_waitcnt vmcnt(15)
s_waitcnt lgkmcnt(4)
ds_read_b64_tr_b16 v[248:249], v14 offset:12288
ds_read_b64_tr_b16 v[250:251], v14 offset:14336
Mvva 152,216,196
Mvva 140,220,192
s_barrier
ds_read_b64_tr_b16 v[252:253], v15 offset:12288
ds_read_b64_tr_b16 v[254:255], v15 offset:14336
Mvva 156,220,196
buffer_load_dwordx4 v114, s[12:15], s51 offen offset:3072 lds
v_add_u32 v114, s95, v113
Mvva 160,224,200
ds_read_b64_tr_b16 v[192:193], v12 offset:16384
ds_read_b64_tr_b16 v[194:195], v12 offset:18432
Mvva 176,224,204
Mvva 164,228,200
ds_read_b64_tr_b16 v[196:197], v13 offset:16384
ds_read_b64_tr_b16 v[198:199], v13 offset:18432
Mvva 180,228,204
buffer_load_dwordx4 a[240:243], v112, s[8:11], s52 offen offset:0 sc1
Mvva 168,232,200
s_waitcnt lgkmcnt(4)
ds_read_b64_tr_b16 v[200:201], v14 offset:16384
ds_read_b64_tr_b16 v[202:203], v14 offset:18432
Mvva 184,232,204
Mvva 172,236,200
ds_read_b64_tr_b16 v[204:205], v15 offset:16384
ds_read_b64_tr_b16 v[206:207], v15 offset:18432
Mvva 188,236,204
buffer_load_dwordx4 a[244:247], v112, s[8:11], s52 offen offset:1024 sc1
s_add_u32 s52, s52, 8192
Mvva 128,240,200
ds_read_b64_tr_b16 v[208:209], v12 offset:20480
ds_read_b64_tr_b16 v[210:211], v12 offset:22528
Mvva 144,240,204
Mvva 132,244,200
ds_read_b64_tr_b16 v[212:213], v13 offset:20480
ds_read_b64_tr_b16 v[214:215], v13 offset:22528
Mvva 148,244,204
buffer_load_dwordx4 a[248:251], v112, s[8:11], s52 offen offset:0 sc1
Mvva 136,248,200
s_waitcnt lgkmcnt(4)
ds_read_b64_tr_b16 v[216:217], v14 offset:20480
ds_read_b64_tr_b16 v[218:219], v14 offset:22528
Mvva 152,248,204
Mvva 140,252,200
ds_read_b64_tr_b16 v[220:221], v15 offset:20480
ds_read_b64_tr_b16 v[222:223], v15 offset:22528
Mvva 156,252,204
buffer_load_dwordx4 a[252:255], v112, s[8:11], s52 offen offset:1024 sc1
s_add_u32 s52, s52, 8192
s_waitcnt vmcnt(18)
Mvva 160,192,208
s_add_u32 m0, s44, 0
ds_read_b64_tr_b16 v[224:225], v12 offset:24576
ds_read_b64_tr_b16 v[226:227], v12 offset:26624
Mvva 176,192,212
buffer_load_dwordx4 v114, s[12:15], s48 offen offset:0 lds
Mvva 164,196,208
ds_read_b64_tr_b16 v[228:229], v13 offset:24576
ds_read_b64_tr_b16 v[230:231], v13 offset:26624
Mvva 180,196,212
Mvva 168,200,208
s_waitcnt lgkmcnt(4)
ds_read_b64_tr_b16 v[232:233], v14 offset:24576
ds_read_b64_tr_b16 v[234:235], v14 offset:26624
Mvva 184,200,212
buffer_load_dwordx4 v114, s[12:15], s49 offen offset:1024 lds
Mvva 172,204,208
ds_read_b64_tr_b16 v[236:237], v15 offset:24576
ds_read_b64_tr_b16 v[238:239], v15 offset:26624
Mvva 188,204,212
buffer_load_dwordx4 v114, s[12:15], s50 offen offset:2048 lds
Mvva 128,208,208
ds_read_b64_tr_b16 v[240:241], v12 offset:28672
ds_read_b64_tr_b16 v[242:243], v12 offset:30720
Mvva 144,208,212
buffer_load_dwordx4 v114, s[12:15], s51 offen offset:3072 lds
v_add_u32 v114, 262144, v114
Mvva 132,212,208
ds_read_b64_tr_b16 v[244:245], v13 offset:28672
ds_read_b64_tr_b16 v[246:247], v13 offset:30720
Mvva 148,212,212
Mvva 136,216,208
s_waitcnt vmcnt(16)
s_waitcnt lgkmcnt(4)
ds_read_b64_tr_b16 v[248:249], v14 offset:28672
ds_read_b64_tr_b16 v[250:251], v14 offset:30720
Mvva 152,216,212
buffer_load_dwordx4 a[0:3], v112, s[8:11], s52 offen offset:0 sc1
Mvva 140,220,208
s_barrier
ds_read_b64_tr_b16 v[252:253], v15 offset:28672
ds_read_b64_tr_b16 v[254:255], v15 offset:30720
Mvva 156,220,212
buffer_load_dwordx4 a[4:7], v112, s[8:11], s52 offen offset:1024 sc1
s_add_u32 s52, s52, 8192
Mvva 160,224,216
ds_read_b64_tr_b16 v[192:193], v12 offset:32768
ds_read_b64_tr_b16 v[194:195], v12 offset:34816
Mvva 176,224,220
buffer_load_dwordx4 a[8:11], v112, s[8:11], s52 offen offset:0 sc1
Mvva 164,228,216
ds_read_b64_tr_b16 v[196:197], v13 offset:32768
ds_read_b64_tr_b16 v[198:199], v13 offset:34816
Mvva 180,228,220
Mvva 168,232,216
s_waitcnt lgkmcnt(4)
ds_read_b64_tr_b16 v[200:201], v14 offset:32768
ds_read_b64_tr_b16 v[202:203], v14 offset:34816
Mvva 184,232,220
buffer_load_dwordx4 a[12:15], v112, s[8:11], s52 offen offset:1024 sc1
s_add_u32 s52, s52, 8192
Mvva 172,236,216
ds_read_b64_tr_b16 v[204:205], v15 offset:32768
ds_read_b64_tr_b16 v[206:207], v15 offset:34816
Mvva 188,236,220
buffer_load_dwordx4 a[16:19], v112, s[8:11], s52 offen offset:0 sc1
Mvva 128,240,216
ds_read_b64_tr_b16 v[208:209], v12 offset:36864
ds_read_b64_tr_b16 v[210:211], v12 offset:38912
Mvva 144,240,220
buffer_load_dwordx4 a[20:23], v112, s[8:11], s52 offen offset:1024 sc1
s_add_u32 s52, s52, 8192
Mvva 132,244,216
ds_read_b64_tr_b16 v[212:213], v13 offset:36864
ds_read_b64_tr_b16 v[214:215], v13 offset:38912
Mvva 148,244,220
Mvva 136,248,216
s_waitcnt lgkmcnt(4)
ds_read_b64_tr_b16 v[216:217], v14 offset:36864
ds_read_b64_tr_b16 v[218:219], v14 offset:38912
Mvva 152,248,220
buffer_load_dwordx4 a[24:27], v112, s[8:11], s52 offen offset:0 sc1
Mvva 140,252,216
ds_read_b64_tr_b16 v[220:221], v15 offset:36864
ds_read_b64_tr_b16 v[222:223], v15 offset:38912
Mvva 156,252,220
buffer_load_dwordx4 a[28:31], v112, s[8:11], s52 offen offset:1024 sc1
s_add_u32 s52, s52, 8192
s_waitcnt vmcnt(22)
Mvva 160,192,224
s_add_u32 m0, s44, 16384
ds_read_b64_tr_b16 v[224:225], v12 offset:40960
ds_read_b64_tr_b16 v[226:227], v12 offset:43008
Mvva 176,192,228
buffer_load_dwordx4 v114, s[12:15], s48 offen offset:0 lds
Mvva 164,196,224
ds_read_b64_tr_b16 v[228:229], v13 offset:40960
ds_read_b64_tr_b16 v[230:231], v13 offset:43008
Mvva 180,196,228
Mvva 168,200,224
s_waitcnt lgkmcnt(4)
ds_read_b64_tr_b16 v[232:233], v14 offset:40960
ds_read_b64_tr_b16 v[234:235], v14 offset:43008
Mvva 184,200,228
buffer_load_dwordx4 v114, s[12:15], s49 offen offset:1024 lds
Mvva 172,204,224
ds_read_b64_tr_b16 v[236:237], v15 offset:40960
ds_read_b64_tr_b16 v[238:239], v15 offset:43008
Mvva 188,204,228
buffer_load_dwordx4 v114, s[12:15], s50 offen offset:2048 lds
Mvva 128,208,224
ds_read_b64_tr_b16 v[240:241], v12 offset:45056
ds_read_b64_tr_b16 v[242:243], v12 offset:47104
Mvva 144,208,228
buffer_load_dwordx4 v114, s[12:15], s51 offen offset:3072 lds
v_add_u32 v114, 262144, v114
Mvva 132,212,224
ds_read_b64_tr_b16 v[244:245], v13 offset:45056
ds_read_b64_tr_b16 v[246:247], v13 offset:47104
Mvva 148,212,228
Mvva 136,216,224
s_waitcnt vmcnt(20)
s_waitcnt lgkmcnt(4)
ds_read_b64_tr_b16 v[248:249], v14 offset:45056
ds_read_b64_tr_b16 v[250:251], v14 offset:47104
Mvva 152,216,228
buffer_load_dwordx4 a[32:35], v112, s[8:11], s52 offen offset:0 sc1
Mvva 140,220,224
s_barrier
ds_read_b64_tr_b16 v[252:253], v15 offset:45056
ds_read_b64_tr_b16 v[254:255], v15 offset:47104
Mvva 156,220,228
buffer_load_dwordx4 a[36:39], v112, s[8:11], s52 offen offset:1024 sc1
s_add_u32 s52, s52, 8192
Mvva 160,224,232
ds_read_b64_tr_b16 v[192:193], v12 offset:49152
ds_read_b64_tr_b16 v[194:195], v12 offset:51200
Mvva 176,224,236
buffer_load_dwordx4 a[40:43], v112, s[8:11], s52 offen offset:0 sc1
Mvva 164,228,232
ds_read_b64_tr_b16 v[196:197], v13 offset:49152
ds_read_b64_tr_b16 v[198:199], v13 offset:51200
Mvva 180,228,236
Mvva 168,232,232
s_waitcnt lgkmcnt(4)
ds_read_b64_tr_b16 v[200:201], v14 offset:49152
ds_read_b64_tr_b16 v[202:203], v14 offset:51200
Mvva 184,232,236
buffer_load_dwordx4 a[44:47], v112, s[8:11], s52 offen offset:1024 sc1
s_add_u32 s52, s52, 8192
Mvva 172,236,232
ds_read_b64_tr_b16 v[204:205], v15 offset:49152
ds_read_b64_tr_b16 v[206:207], v15 offset:51200
Mvva 188,236,236
buffer_load_dwordx4 a[48:51], v112, s[8:11], s52 offen offset:0 sc1
Mvva 128,240,232
ds_read_b64_tr_b16 v[208:209], v12 offset:53248
ds_read_b64_tr_b16 v[210:211], v12 offset:55296
Mvva 144,240,236
buffer_load_dwordx4 a[52:55], v112, s[8:11], s52 offen offset:1024 sc1
s_add_u32 s52, s52, 8192
Mvva 132,244,232
ds_read_b64_tr_b16 v[212:213], v13 offset:53248
ds_read_b64_tr_b16 v[214:215], v13 offset:55296
Mvva 148,244,236
Mvva 136,248,232
s_waitcnt lgkmcnt(4)
ds_read_b64_tr_b16 v[216:217], v14 offset:53248
ds_read_b64_tr_b16 v[218:219], v14 offset:55296
Mvva 152,248,236
buffer_load_dwordx4 a[56:59], v112, s[8:11], s52 offen offset:0 sc1
Mvva 140,252,232
ds_read_b64_tr_b16 v[220:221], v15 offset:53248
ds_read_b64_tr_b16 v[222:223], v15 offset:55296
Mvva 156,252,236
buffer_load_dwordx4 a[60:63], v112, s[8:11], s52 offen offset:1024 sc1
s_add_u32 s52, s52, 8192
s_waitcnt vmcnt(26)
Mvva 160,192,240
s_add_u32 m0, s44, 32768
ds_read_b64_tr_b16 v[224:225], v12 offset:57344
ds_read_b64_tr_b16 v[226:227], v12 offset:59392
Mvva 176,192,244
buffer_load_dwordx4 v114, s[12:15], s48 offen offset:0 lds
Mvva 164,196,240
ds_read_b64_tr_b16 v[228:229], v13 offset:57344
ds_read_b64_tr_b16 v[230:231], v13 offset:59392
Mvva 180,196,244
Mvva 168,200,240
s_waitcnt lgkmcnt(4)
ds_read_b64_tr_b16 v[232:233], v14 offset:57344
ds_read_b64_tr_b16 v[234:235], v14 offset:59392
Mvva 184,200,244
buffer_load_dwordx4 v114, s[12:15], s49 offen offset:1024 lds
Mvva 172,204,240
ds_read_b64_tr_b16 v[236:237], v15 offset:57344
ds_read_b64_tr_b16 v[238:239], v15 offset:59392
Mvva 188,204,244
buffer_load_dwordx4 v114, s[12:15], s50 offen offset:2048 lds
Mvva 128,208,240
ds_read_b64_tr_b16 v[240:241], v12 offset:61440
ds_read_b64_tr_b16 v[242:243], v12 offset:63488
Mvva 144,208,244
buffer_load_dwordx4 v114, s[12:15], s51 offen offset:3072 lds
v_add_u32 v114, 262144, v114
Mvva 132,212,240
ds_read_b64_tr_b16 v[244:245], v13 offset:61440
ds_read_b64_tr_b16 v[246:247], v13 offset:63488
Mvva 148,212,244
Mvva 136,216,240
s_waitcnt vmcnt(24)
s_waitcnt lgkmcnt(4)
ds_read_b64_tr_b16 v[248:249], v14 offset:61440
ds_read_b64_tr_b16 v[250:251], v14 offset:63488
Mvva 152,216,244
buffer_load_dwordx4 a[64:67], v112, s[8:11], s52 offen offset:0 sc1
Mvva 140,220,240
s_barrier
ds_read_b64_tr_b16 v[252:253], v15 offset:61440
ds_read_b64_tr_b16 v[254:255], v15 offset:63488
Mvva 156,220,244
buffer_load_dwordx4 a[68:71], v112, s[8:11], s52 offen offset:1024 sc1
s_add_u32 s52, s52, 8192
Mvva 160,224,248
ds_read_b64_tr_b16 v[192:193], v115 offset:0
ds_read_b64_tr_b16 v[194:195], v115 offset:2048
Mvva 176,224,252
buffer_load_dwordx4 a[72:75], v112, s[8:11], s52 offen offset:0 sc1
Mvva 164,228,248
ds_read_b64_tr_b16 v[196:197], v116 offset:0
ds_read_b64_tr_b16 v[198:199], v116 offset:2048
Mvva 180,228,252
Mvva 168,232,248
s_waitcnt lgkmcnt(4)
ds_read_b64_tr_b16 v[200:201], v117 offset:0
ds_read_b64_tr_b16 v[202:203], v117 offset:2048
Mvva 184,232,252
buffer_load_dwordx4 a[76:79], v112, s[8:11], s52 offen offset:1024 sc1
s_add_u32 s52, s52, 8192
Mvva 172,236,248
ds_read_b64_tr_b16 v[204:205], v118 offset:0
ds_read_b64_tr_b16 v[206:207], v118 offset:2048
Mvva 188,236,252
buffer_load_dwordx4 a[80:83], v112, s[8:11], s52 offen offset:0 sc1
Mvva 128,240,248
ds_read_b64_tr_b16 v[208:209], v115 offset:4096
ds_read_b64_tr_b16 v[210:211], v115 offset:6144
Mvva 144,240,252
buffer_load_dwordx4 a[84:87], v112, s[8:11], s52 offen offset:1024 sc1
s_add_u32 s52, s52, 8192
Mvva 132,244,248
ds_read_b64_tr_b16 v[212:213], v116 offset:4096
ds_read_b64_tr_b16 v[214:215], v116 offset:6144
Mvva 148,244,252
Mvva 136,248,248
s_waitcnt lgkmcnt(4)
ds_read_b64_tr_b16 v[216:217], v117 offset:4096
ds_read_b64_tr_b16 v[218:219], v117 offset:6144
Mvva 152,248,252
buffer_load_dwordx4 a[88:91], v112, s[8:11], s52 offen offset:0 sc1
Mvva 140,252,248
ds_read_b64_tr_b16 v[220:221], v118 offset:4096
ds_read_b64_tr_b16 v[222:223], v118 offset:6144
Mvva 156,252,252
buffer_load_dwordx4 a[92:95], v112, s[8:11], s52 offen offset:1024 sc1
s_add_u32 s52, s52, 8192
s_waitcnt vmcnt(30)
Mvva 160,192,0
s_add_u32 m0, s44, 49152
ds_read_b64_tr_b16 v[224:225], v115 offset:8192
ds_read_b64_tr_b16 v[226:227], v115 offset:10240
Mvva 176,192,4
buffer_load_dwordx4 v114, s[12:15], s48 offen offset:0 lds
Mvva 164,196,0
ds_read_b64_tr_b16 v[228:229], v116 offset:8192
ds_read_b64_tr_b16 v[230:231], v116 offset:10240
Mvva 180,196,4
Mvva 168,200,0
s_waitcnt lgkmcnt(4)
ds_read_b64_tr_b16 v[232:233], v117 offset:8192
ds_read_b64_tr_b16 v[234:235], v117 offset:10240
Mvva 184,200,4
buffer_load_dwordx4 v114, s[12:15], s49 offen offset:1024 lds
Mvva 172,204,0
ds_read_b64_tr_b16 v[236:237], v118 offset:8192
ds_read_b64_tr_b16 v[238:239], v118 offset:10240
Mvva 188,204,4
buffer_load_dwordx4 v114, s[12:15], s50 offen offset:2048 lds
s_waitcnt vmcnt(31)
Mvva 160,208,8
ds_read_b64_tr_b16 v[240:241], v115 offset:12288
ds_read_b64_tr_b16 v[242:243], v115 offset:14336
Mvva 176,208,12
buffer_load_dwordx4 v114, s[12:15], s51 offen offset:3072 lds
v_add_u32 v114, 262144, v114
Mvva 164,212,8
ds_read_b64_tr_b16 v[244:245], v116 offset:12288
ds_read_b64_tr_b16 v[246:247], v116 offset:14336
Mvva 180,212,12
Mvva 168,216,8
s_waitcnt vmcnt(24)
s_waitcnt lgkmcnt(4)
ds_read_b64_tr_b16 v[248:249], v117 offset:12288
ds_read_b64_tr_b16 v[250:251], v117 offset:14336
Mvva 184,216,12
buffer_load_dwordx4 a[96:99], v112, s[8:11], s52 offen offset:0 sc1
Mvva 172,220,8
s_barrier
ds_read_b64_tr_b16 v[252:253], v118 offset:12288
ds_read_b64_tr_b16 v[254:255], v118 offset:14336
Mvva 188,220,12
buffer_load_dwordx4 a[100:103], v112, s[8:11], s52 offen offset:1024 sc1
s_add_u32 s52, s52, 8192
Mvva 160,224,16
ds_read_b64_tr_b16 v[192:193], v115 offset:16384
ds_read_b64_tr_b16 v[194:195], v115 offset:18432
Mvva 176,224,20
buffer_load_dwordx4 a[104:107], v112, s[8:11], s52 offen offset:0 sc1
Mvva 164,228,16
ds_read_b64_tr_b16 v[196:197], v116 offset:16384
ds_read_b64_tr_b16 v[198:199], v116 offset:18432
Mvva 180,228,20
Mvva 168,232,16
s_waitcnt lgkmcnt(4)
ds_read_b64_tr_b16 v[200:201], v117 offset:16384
ds_read_b64_tr_b16 v[202:203], v117 offset:18432
Mvva 184,232,20
buffer_load_dwordx4 a[108:111], v112, s[8:11], s52 offen offset:1024 sc1
s_add_u32 s52, s52, 8192
Mvva 172,236,16
ds_read_b64_tr_b16 v[204:205], v118 offset:16384
ds_read_b64_tr_b16 v[206:207], v118 offset:18432
Mvva 188,236,20
buffer_load_dwordx4 a[112:115], v112, s[8:11], s52 offen offset:0 sc1
Mvva 160,240,24
ds_read_b64_tr_b16 v[208:209], v115 offset:20480
ds_read_b64_tr_b16 v[210:211], v115 offset:22528
Mvva 176,240,28
buffer_load_dwordx4 a[116:119], v112, s[8:11], s52 offen offset:1024 sc1
s_add_u32 s52, s52, 8192
Mvva 164,244,24
ds_read_b64_tr_b16 v[212:213], v116 offset:20480
ds_read_b64_tr_b16 v[214:215], v116 offset:22528
Mvva 180,244,28
Mvva 168,248,24
s_waitcnt lgkmcnt(4)
ds_read_b64_tr_b16 v[216:217], v117 offset:20480
ds_read_b64_tr_b16 v[218:219], v117 offset:22528
Mvva 184,248,28
buffer_load_dwordx4 a[120:123], v112, s[8:11], s52 offen offset:0 sc1
Mvva 172,252,24
ds_read_b64_tr_b16 v[220:221], v118 offset:20480
ds_read_b64_tr_b16 v[222:223], v118 offset:22528
Mvva 188,252,28
buffer_load_dwordx4 a[124:127], v112, s[8:11], s52 offen offset:1024 sc1
s_add_u32 s52, s52, 8192
s_waitcnt vmcnt(30)
Mvva 160,192,32
s_add_u32 m0, s44, 65536
ds_read_b64_tr_b16 v[224:225], v115 offset:24576
ds_read_b64_tr_b16 v[226:227], v115 offset:26624
Mvva 176,192,36
buffer_load_dwordx4 v114, s[12:15], s48 offen offset:0 lds
Mvva 164,196,32
ds_read_b64_tr_b16 v[228:229], v116 offset:24576
ds_read_b64_tr_b16 v[230:231], v116 offset:26624
Mvva 180,196,36
Mvva 168,200,32
s_waitcnt lgkmcnt(4)
ds_read_b64_tr_b16 v[232:233], v117 offset:24576
ds_read_b64_tr_b16 v[234:235], v117 offset:26624
Mvva 184,200,36
buffer_load_dwordx4 v114, s[12:15], s49 offen offset:1024 lds
Mvva 172,204,32
ds_read_b64_tr_b16 v[236:237], v118 offset:24576
ds_read_b64_tr_b16 v[238:239], v118 offset:26624
Mvva 188,204,36
buffer_load_dwordx4 v114, s[12:15], s50 offen offset:2048 lds
s_waitcnt vmcnt(31)
Mvva 160,208,40
ds_read_b64_tr_b16 v[240:241], v115 offset:28672
ds_read_b64_tr_b16 v[242:243], v115 offset:30720
Mvva 176,208,44
buffer_load_dwordx4 v114, s[12:15], s51 offen offset:3072 lds
v_add_u32 v114, 262144, v114
Mvva 164,212,40
ds_read_b64_tr_b16 v[244:245], v116 offset:28672
ds_read_b64_tr_b16 v[246:247], v116 offset:30720
Mvva 180,212,44
Mvva 168,216,40
s_waitcnt vmcnt(24)
s_waitcnt lgkmcnt(4)
ds_read_b64_tr_b16 v[248:249], v117 offset:28672
ds_read_b64_tr_b16 v[250:251], v117 offset:30720
Mvva 184,216,44
buffer_load_dwordx4 a[128:131], v112, s[8:11], s52 offen offset:0 sc1
Mvva 172,220,40
s_barrier
ds_read_b64_tr_b16 v[252:253], v118 offset:28672
ds_read_b64_tr_b16 v[254:255], v118 offset:30720
Mvva 188,220,44
buffer_load_dwordx4 a[132:135], v112, s[8:11], s52 offen offset:1024 sc1
s_add_u32 s52, s52, 8192
Mvva 160,224,48
ds_read_b64_tr_b16 v[192:193], v115 offset:32768
ds_read_b64_tr_b16 v[194:195], v115 offset:34816
Mvva 176,224,52
buffer_load_dwordx4 a[136:139], v112, s[8:11], s52 offen offset:0 sc1
Mvva 164,228,48
ds_read_b64_tr_b16 v[196:197], v116 offset:32768
ds_read_b64_tr_b16 v[198:199], v116 offset:34816
Mvva 180,228,52
Mvva 168,232,48
s_waitcnt lgkmcnt(4)
ds_read_b64_tr_b16 v[200:201], v117 offset:32768
ds_read_b64_tr_b16 v[202:203], v117 offset:34816
Mvva 184,232,52
buffer_load_dwordx4 a[140:143], v112, s[8:11], s52 offen offset:1024 sc1
s_add_u32 s52, s52, 8192
Mvva 172,236,48
ds_read_b64_tr_b16 v[204:205], v118 offset:32768
ds_read_b64_tr_b16 v[206:207], v118 offset:34816
Mvva 188,236,52
buffer_load_dwordx4 a[144:147], v112, s[8:11], s52 offen offset:0 sc1
Mvva 160,240,56
ds_read_b64_tr_b16 v[208:209], v115 offset:36864
ds_read_b64_tr_b16 v[210:211], v115 offset:38912
Mvva 176,240,60
buffer_load_dwordx4 a[148:151], v112, s[8:11], s52 offen offset:1024 sc1
s_add_u32 s52, s52, 8192
Mvva 164,244,56
ds_read_b64_tr_b16 v[212:213], v116 offset:36864
ds_read_b64_tr_b16 v[214:215], v116 offset:38912
Mvva 180,244,60
Mvva 168,248,56
s_waitcnt lgkmcnt(4)
ds_read_b64_tr_b16 v[216:217], v117 offset:36864
ds_read_b64_tr_b16 v[218:219], v117 offset:38912
Mvva 184,248,60
buffer_load_dwordx4 a[152:155], v112, s[8:11], s52 offen offset:0 sc1
Mvva 172,252,56
ds_read_b64_tr_b16 v[220:221], v118 offset:36864
ds_read_b64_tr_b16 v[222:223], v118 offset:38912
Mvva 188,252,60
buffer_load_dwordx4 a[156:159], v112, s[8:11], s52 offen offset:1024 sc1
s_add_u32 s52, s52, 8192
s_waitcnt vmcnt(30)
Mvva 160,192,64
s_add_u32 m0, s44, 81920
ds_read_b64_tr_b16 v[224:225], v115 offset:40960
ds_read_b64_tr_b16 v[226:227], v115 offset:43008
Mvva 176,192,68
buffer_load_dwordx4 v114, s[12:15], s48 offen offset:0 lds
Mvva 164,196,64
ds_read_b64_tr_b16 v[228:229], v116 offset:40960
ds_read_b64_tr_b16 v[230:231], v116 offset:43008
Mvva 180,196,68
Mvva 168,200,64
s_waitcnt lgkmcnt(4)
ds_read_b64_tr_b16 v[232:233], v117 offset:40960
ds_read_b64_tr_b16 v[234:235], v117 offset:43008
Mvva 184,200,68
buffer_load_dwordx4 v114, s[12:15], s49 offen offset:1024 lds
Mvva 172,204,64
ds_read_b64_tr_b16 v[236:237], v118 offset:40960
ds_read_b64_tr_b16 v[238:239], v118 offset:43008
Mvva 188,204,68
buffer_load_dwordx4 v114, s[12:15], s50 offen offset:2048 lds
s_waitcnt vmcnt(31)
Mvva 160,208,72
ds_read_b64_tr_b16 v[240:241], v115 offset:45056
ds_read_b64_tr_b16 v[242:243], v115 offset:47104
Mvva 176,208,76
buffer_load_dwordx4 v114, s[12:15], s51 offen offset:3072 lds
v_add_u32 v114, 262144, v114
Mvva 164,212,72
ds_read_b64_tr_b16 v[244:245], v116 offset:45056
ds_read_b64_tr_b16 v[246:247], v116 offset:47104
Mvva 180,212,76
Mvva 168,216,72
s_waitcnt vmcnt(24)
s_waitcnt lgkmcnt(4)
ds_read_b64_tr_b16 v[248:249], v117 offset:45056
ds_read_b64_tr_b16 v[250:251], v117 offset:47104
Mvva 184,216,76
buffer_load_dwordx4 a[160:163], v112, s[8:11], s52 offen offset:0 sc1
Mvva 172,220,72
s_barrier
ds_read_b64_tr_b16 v[252:253], v118 offset:45056
ds_read_b64_tr_b16 v[254:255], v118 offset:47104
Mvva 188,220,76
buffer_load_dwordx4 a[164:167], v112, s[8:11], s52 offen offset:1024 sc1
s_add_u32 s52, s52, 8192
Mvva 160,224,80
ds_read_b64_tr_b16 v[192:193], v115 offset:49152
ds_read_b64_tr_b16 v[194:195], v115 offset:51200
Mvva 176,224,84
buffer_load_dwordx4 a[168:171], v112, s[8:11], s52 offen offset:0 sc1
Mvva 164,228,80
ds_read_b64_tr_b16 v[196:197], v116 offset:49152
ds_read_b64_tr_b16 v[198:199], v116 offset:51200
Mvva 180,228,84
Mvva 168,232,80
s_waitcnt lgkmcnt(4)
ds_read_b64_tr_b16 v[200:201], v117 offset:49152
ds_read_b64_tr_b16 v[202:203], v117 offset:51200
Mvva 184,232,84
buffer_load_dwordx4 a[172:175], v112, s[8:11], s52 offen offset:1024 sc1
s_add_u32 s52, s52, 8192
Mvva 172,236,80
ds_read_b64_tr_b16 v[204:205], v118 offset:49152
ds_read_b64_tr_b16 v[206:207], v118 offset:51200
Mvva 188,236,84
buffer_load_dwordx4 a[176:179], v112, s[8:11], s52 offen offset:0 sc1
Mvva 160,240,88
ds_read_b64_tr_b16 v[208:209], v115 offset:53248
ds_read_b64_tr_b16 v[210:211], v115 offset:55296
Mvva 176,240,92
buffer_load_dwordx4 a[180:183], v112, s[8:11], s52 offen offset:1024 sc1
s_add_u32 s52, s52, 8192
Mvva 164,244,88
ds_read_b64_tr_b16 v[212:213], v116 offset:53248
ds_read_b64_tr_b16 v[214:215], v116 offset:55296
Mvva 180,244,92
Mvva 168,248,88
s_waitcnt lgkmcnt(4)
ds_read_b64_tr_b16 v[216:217], v117 offset:53248
ds_read_b64_tr_b16 v[218:219], v117 offset:55296
Mvva 184,248,92
buffer_load_dwordx4 a[184:187], v112, s[8:11], s52 offen offset:0 sc1
Mvva 172,252,88
ds_read_b64_tr_b16 v[220:221], v118 offset:53248
ds_read_b64_tr_b16 v[222:223], v118 offset:55296
Mvva 188,252,92
buffer_load_dwordx4 a[188:191], v112, s[8:11], s52 offen offset:1024 sc1
s_add_u32 s52, s52, 8192
s_waitcnt vmcnt(30)
Mvva 160,192,96
s_add_u32 m0, s44, 98304
ds_read_b64_tr_b16 v[224:225], v115 offset:57344
ds_read_b64_tr_b16 v[226:227], v115 offset:59392
Mvva 176,192,100
buffer_load_dwordx4 v114, s[12:15], s48 offen offset:0 lds
Mvva 164,196,96
ds_read_b64_tr_b16 v[228:229], v116 offset:57344
ds_read_b64_tr_b16 v[230:231], v116 offset:59392
Mvva 180,196,100
s_cmp_lg_u32 s53, 0
s_cbranch_scc1 L_yA
L_yAr:
Mvva 168,200,96
s_waitcnt lgkmcnt(4)
ds_read_b64_tr_b16 v[232:233], v117 offset:57344
ds_read_b64_tr_b16 v[234:235], v117 offset:59392
Mvva 184,200,100
buffer_load_dwordx4 v114, s[12:15], s49 offen offset:1024 lds
Mvva 172,204,96
ds_read_b64_tr_b16 v[236:237], v118 offset:57344
ds_read_b64_tr_b16 v[238:239], v118 offset:59392
Mvva 188,204,100
buffer_load_dwordx4 v114, s[12:15], s50 offen offset:2048 lds
s_waitcnt vmcnt(31)
Mvva 160,208,104
ds_read_b64_tr_b16 v[240:241], v115 offset:61440
ds_read_b64_tr_b16 v[242:243], v115 offset:63488
Mvva 176,208,108
buffer_load_dwordx4 v114, s[12:15], s51 offen offset:3072 lds
v_add_u32 v114, 262144, v114
Mvva 164,212,104
ds_read_b64_tr_b16 v[244:245], v116 offset:61440
ds_read_b64_tr_b16 v[246:247], v116 offset:63488
Mvva 180,212,108
Mvva 168,216,104
s_waitcnt vmcnt(24)
s_waitcnt lgkmcnt(4)
ds_read_b64_tr_b16 v[248:249], v117 offset:61440
ds_read_b64_tr_b16 v[250:251], v117 offset:63488
Mvva 184,216,108
buffer_load_dwordx4 a[192:195], v112, s[8:11], s52 offen offset:0 sc1
Mvva 172,220,104
s_barrier
ds_read_b64_tr_b16 v[252:253], v118 offset:61440
ds_read_b64_tr_b16 v[254:255], v118 offset:63488
Mvva 188,220,108
buffer_load_dwordx4 a[196:199], v112, s[8:11], s52 offen offset:1024 sc1
s_add_u32 s52, s52, 8192
Mvva 160,224,112
ds_read_b64_tr_b16 v[192:193], v12 offset:0
ds_read_b64_tr_b16 v[194:195], v12 offset:2048
Mvva 176,224,116
buffer_load_dwordx4 a[200:203], v112, s[8:11], s52 offen offset:0 sc1
Mvva 164,228,112
ds_read_b64_tr_b16 v[196:197], v13 offset:0
ds_read_b64_tr_b16 v[198:199], v13 offset:2048
Mvva 180,228,116
Mvva 168,232,112
s_waitcnt lgkmcnt(4)
ds_read_b64_tr_b16 v[200:201], v14 offset:0
ds_read_b64_tr_b16 v[202:203], v14 offset:2048
Mvva 184,232,116
buffer_load_dwordx4 a[204:207], v112, s[8:11], s52 offen offset:1024 sc1
s_add_u32 s52, s52, 8192
Mvva 172,236,112
ds_read_b64_tr_b16 v[204:205], v15 offset:0
ds_read_b64_tr_b16 v[206:207], v15 offset:2048
Mvva 188,236,116
buffer_load_dwordx4 a[208:211], v112, s[8:11], s52 offen offset:0 sc1
Mvva 160,240,120
ds_read_b64_tr_b16 v[208:209], v12 offset:4096
ds_read_b64_tr_b16 v[210:211], v12 offset:6144
Mvva 176,240,124
buffer_load_dwordx4 a[212:215], v112, s[8:11], s52 offen offset:1024 sc1
s_add_u32 s52, s52, 8192
Mvva 164,244,120
ds_read_b64_tr_b16 v[212:213], v13 offset:4096
ds_read_b64_tr_b16 v[214:215], v13 offset:6144
Mvva 180,244,124
Mvva 168,248,120
s_waitcnt lgkmcnt(4)
ds_read_b64_tr_b16 v[216:217], v14 offset:4096
ds_read_b64_tr_b16 v[218:219], v14 offset:6144
Mvva 184,248,124
buffer_load_dwordx4 a[216:219], v112, s[8:11], s52 offen offset:0 sc1
Mvva 172,252,120
ds_read_b64_tr_b16 v[220:221], v15 offset:4096
ds_read_b64_tr_b16 v[222:223], v15 offset:6144
Mvva 188,252,124
buffer_load_dwordx4 a[220:223], v112, s[8:11], s52 offen offset:1024 sc1
s_add_u32 s52, s52, 8192
s_waitcnt vmcnt(30)
Mvva 160,192,128
s_add_u32 m0, s44, 114688
ds_read_b64_tr_b16 v[224:225], v12 offset:8192
ds_read_b64_tr_b16 v[226:227], v12 offset:10240
Mvva 176,192,132
buffer_load_dwordx4 v114, s[12:15], s48 offen offset:0 lds
Mvva 164,196,128
ds_read_b64_tr_b16 v[228:229], v13 offset:8192
ds_read_b64_tr_b16 v[230:231], v13 offset:10240
Mvva 180,196,132
Mvva 168,200,128
s_waitcnt lgkmcnt(4)
ds_read_b64_tr_b16 v[232:233], v14 offset:8192
ds_read_b64_tr_b16 v[234:235], v14 offset:10240
Mvva 184,200,132
buffer_load_dwordx4 v114, s[12:15], s49 offen offset:1024 lds
Mvva 172,204,128
ds_read_b64_tr_b16 v[236:237], v15 offset:8192
ds_read_b64_tr_b16 v[238:239], v15 offset:10240
Mvva 188,204,132
buffer_load_dwordx4 v114, s[12:15], s50 offen offset:2048 lds
s_waitcnt vmcnt(31)
Mvva 160,208,136
ds_read_b64_tr_b16 v[240:241], v12 offset:12288
ds_read_b64_tr_b16 v[242:243], v12 offset:14336
Mvva 176,208,140
buffer_load_dwordx4 v114, s[12:15], s51 offen offset:3072 lds
s_xor_b32 s95, s95, 128
v_add_u32 v114, s95, v113
Mvva 164,212,136
ds_read_b64_tr_b16 v[244:245], v13 offset:12288
ds_read_b64_tr_b16 v[246:247], v13 offset:14336
Mvva 180,212,140
Mvva 168,216,136
s_waitcnt vmcnt(24)
s_waitcnt lgkmcnt(4)
ds_read_b64_tr_b16 v[248:249], v14 offset:12288
ds_read_b64_tr_b16 v[250:251], v14 offset:14336
Mvva 184,216,140
buffer_load_dwordx4 a[224:227], v112, s[8:11], s52 offen offset:0 sc1
Mvva 172,220,136
s_barrier
ds_read_b64_tr_b16 v[252:253], v15 offset:12288
ds_read_b64_tr_b16 v[254:255], v15 offset:14336
Mvva 188,220,140
buffer_load_dwordx4 a[228:231], v112, s[8:11], s52 offen offset:1024 sc1
s_add_u32 s52, s52, 8192
Mvva 160,224,144
ds_read_b64_tr_b16 v[192:193], v12 offset:16384
ds_read_b64_tr_b16 v[194:195], v12 offset:18432
Mvva 176,224,148
buffer_load_dwordx4 a[232:235], v112, s[8:11], s52 offen offset:0 sc1
Mvva 164,228,144
ds_read_b64_tr_b16 v[196:197], v13 offset:16384
ds_read_b64_tr_b16 v[198:199], v13 offset:18432
Mvva 180,228,148
Mvva 168,232,144
s_waitcnt lgkmcnt(4)
ds_read_b64_tr_b16 v[200:201], v14 offset:16384
ds_read_b64_tr_b16 v[202:203], v14 offset:18432
Mvva 184,232,148
buffer_load_dwordx4 a[236:239], v112, s[8:11], s52 offen offset:1024 sc1
s_add_u32 s52, s52, 8192
Mvva 172,236,144
ds_read_b64_tr_b16 v[204:205], v15 offset:16384
ds_read_b64_tr_b16 v[206:207], v15 offset:18432
Mvva 188,236,148
buffer_load_dwordx4 a[240:243], v112, s[8:11], s52 offen offset:0 sc1
Mvva 160,240,152
ds_read_b64_tr_b16 v[208:209], v12 offset:20480
ds_read_b64_tr_b16 v[210:211], v12 offset:22528
Mvva 176,240,156
buffer_load_dwordx4 a[244:247], v112, s[8:11], s52 offen offset:1024 sc1
s_add_u32 s52, s52, 8192
Mvva 164,244,152
ds_read_b64_tr_b16 v[212:213], v13 offset:20480
ds_read_b64_tr_b16 v[214:215], v13 offset:22528
Mvva 180,244,156
Mvva 168,248,152
s_waitcnt lgkmcnt(4)
ds_read_b64_tr_b16 v[216:217], v14 offset:20480
ds_read_b64_tr_b16 v[218:219], v14 offset:22528
Mvva 184,248,156
buffer_load_dwordx4 a[248:251], v112, s[8:11], s52 offen offset:0 sc1
Mvva 172,252,152
ds_read_b64_tr_b16 v[220:221], v15 offset:20480
ds_read_b64_tr_b16 v[222:223], v15 offset:22528
Mvva 188,252,156
buffer_load_dwordx4 a[252:255], v112, s[8:11], s52 offen offset:1024 sc1
s_add_u32 s52, s52, 8192
s_waitcnt vmcnt(30)
Mvva 160,192,160
s_add_u32 m0, s44, 0
ds_read_b64_tr_b16 v[224:225], v12 offset:24576
ds_read_b64_tr_b16 v[226:227], v12 offset:26624
Mvva 176,192,164
Mvva 164,196,160
ds_read_b64_tr_b16 v[228:229], v13 offset:24576
ds_read_b64_tr_b16 v[230:231], v13 offset:26624
Mvva 180,196,164
Mvva 168,200,160
s_waitcnt lgkmcnt(4)
ds_read_b64_tr_b16 v[232:233], v14 offset:24576
ds_read_b64_tr_b16 v[234:235], v14 offset:26624
Mvva 184,200,164
buffer_load_dwordx4 v114, s[12:15], s48 offen offset:0 lds
Mvva 172,204,160
ds_read_b64_tr_b16 v[236:237], v15 offset:24576
ds_read_b64_tr_b16 v[238:239], v15 offset:26624
Mvva 188,204,164
s_waitcnt vmcnt(29)
Mvva 160,208,168
ds_read_b64_tr_b16 v[240:241], v12 offset:28672
ds_read_b64_tr_b16 v[242:243], v12 offset:30720
Mvva 176,208,172
Mvva 164,212,168
ds_read_b64_tr_b16 v[244:245], v13 offset:28672
ds_read_b64_tr_b16 v[246:247], v13 offset:30720
Mvva 180,212,172
Mvva 168,216,168
s_waitcnt vmcnt(21)
s_waitcnt lgkmcnt(4)
ds_read_b64_tr_b16 v[248:249], v14 offset:28672
ds_read_b64_tr_b16 v[250:251], v14 offset:30720
Mvva 184,216,172
buffer_load_dwordx4 v114, s[12:15], s49 offen offset:1024 lds
Mvva 172,220,168
s_barrier
ds_read_b64_tr_b16 v[252:253], v15 offset:28672
ds_read_b64_tr_b16 v[254:255], v15 offset:30720
Mvva 188,220,172
Mvva 160,224,176
ds_read_b64_tr_b16 v[192:193], v12 offset:32768
ds_read_b64_tr_b16 v[194:195], v12 offset:34816
Mvva 176,224,180
s_cmp_lg_u32 s53, 0
s_cbranch_scc1 L_yB
L_yBr:
Mvva 164,228,176
ds_read_b64_tr_b16 v[196:197], v13 offset:32768
ds_read_b64_tr_b16 v[198:199], v13 offset:34816
Mvva 180,228,180
Mvva 168,232,176
s_waitcnt lgkmcnt(4)
ds_read_b64_tr_b16 v[200:201], v14 offset:32768
ds_read_b64_tr_b16 v[202:203], v14 offset:34816
Mvva 184,232,180
buffer_load_dwordx4 v114, s[12:15], s50 offen offset:2048 lds
Mvva 172,236,176
ds_read_b64_tr_b16 v[204:205], v15 offset:32768
ds_read_b64_tr_b16 v[206:207], v15 offset:34816
Mvva 188,236,180
Mvva 160,240,184
ds_read_b64_tr_b16 v[208:209], v12 offset:36864
ds_read_b64_tr_b16 v[210:211], v12 offset:38912
Mvva 176,240,188
Mvva 164,244,184
ds_read_b64_tr_b16 v[212:213], v13 offset:36864
ds_read_b64_tr_b16 v[214:215], v13 offset:38912
Mvva 180,244,188
Mvva 168,248,184
s_waitcnt lgkmcnt(4)
ds_read_b64_tr_b16 v[216:217], v14 offset:36864
ds_read_b64_tr_b16 v[218:219], v14 offset:38912
Mvva 184,248,188
buffer_load_dwordx4 v114, s[12:15], s51 offen offset:3072 lds
v_add_u32 v114, 262144, v114
Mvva 172,252,184
ds_read_b64_tr_b16 v[220:221], v15 offset:36864
ds_read_b64_tr_b16 v[222:223], v15 offset:38912
Mvva 188,252,188
s_waitcnt vmcnt(22)
Mvva 160,192,192
s_add_u32 m0, s44, 16384
ds_read_b64_tr_b16 v[224:225], v12 offset:40960
ds_read_b64_tr_b16 v[226:227], v12 offset:43008
Mvva 176,192,196
Mvva 164,196,192
ds_read_b64_tr_b16 v[228:229], v13 offset:40960
ds_read_b64_tr_b16 v[230:231], v13 offset:43008
Mvva 180,196,196
Mvva 168,200,192
s_waitcnt lgkmcnt(4)
ds_read_b64_tr_b16 v[232:233], v14 offset:40960
ds_read_b64_tr_b16 v[234:235], v14 offset:43008
Mvva 184,200,196
buffer_load_dwordx4 v114, s[12:15], s48 offen offset:0 lds
Mvva 172,204,192
ds_read_b64_tr_b16 v[236:237], v15 offset:40960
ds_read_b64_tr_b16 v[238:239], v15 offset:43008
Mvva 188,204,196
s_waitcnt vmcnt(21)
Mvva 160,208,200
ds_read_b64_tr_b16 v[240:241], v12 offset:45056
ds_read_b64_tr_b16 v[242:243], v12 offset:47104
Mvva 176,208,204
Mvva 164,212,200
ds_read_b64_tr_b16 v[244:245], v13 offset:45056
ds_read_b64_tr_b16 v[246:247], v13 offset:47104
Mvva 180,212,204
Mvva 168,216,200
s_waitcnt vmcnt(13)
s_waitcnt lgkmcnt(4)
ds_read_b64_tr_b16 v[248:249], v14 offset:45056
ds_read_b64_tr_b16 v[250:251], v14 offset:47104
Mvva 184,216,204
buffer_load_dwordx4 v114, s[12:15], s49 offen offset:1024 lds
Mvva 172,220,200
s_barrier
ds_read_b64_tr_b16 v[252:253], v15 offset:45056
ds_read_b64_tr_b16 v[254:255], v15 offset:47104
Mvva 188,220,204
Mvva 160,224,208
ds_read_b64_tr_b16 v[192:193], v12 offset:49152
ds_read_b64_tr_b16 v[194:195], v12 offset:51200
Mvva 176,224,212
Mvva 164,228,208
ds_read_b64_tr_b16 v[196:197], v13 offset:49152
ds_read_b64_tr_b16 v[198:199], v13 offset:51200
Mvva 180,228,212
Mvva 168,232,208
s_waitcnt lgkmcnt(4)
ds_read_b64_tr_b16 v[200:201], v14 offset:49152
ds_read_b64_tr_b16 v[202:203], v14 offset:51200
Mvva 184,232,212
buffer_load_dwordx4 v114, s[12:15], s50 offen offset:2048 lds
Mvva 172,236,208
ds_read_b64_tr_b16 v[204:205], v15 offset:49152
ds_read_b64_tr_b16 v[206:207], v15 offset:51200
Mvva 188,236,212
Mvva 160,240,216
ds_read_b64_tr_b16 v[208:209], v12 offset:53248
ds_read_b64_tr_b16 v[210:211], v12 offset:55296
Mvva 176,240,220
Mvva 164,244,216
ds_read_b64_tr_b16 v[212:213], v13 offset:53248
ds_read_b64_tr_b16 v[214:215], v13 offset:55296
Mvva 180,244,220
Mvva 168,248,216
s_waitcnt lgkmcnt(4)
ds_read_b64_tr_b16 v[216:217], v14 offset:53248
ds_read_b64_tr_b16 v[218:219], v14 offset:55296
Mvva 184,248,220
buffer_load_dwordx4 v114, s[12:15], s51 offen offset:3072 lds
v_add_u32 v114, 262144, v114
Mvva 172,252,216
ds_read_b64_tr_b16 v[220:221], v15 offset:53248
ds_read_b64_tr_b16 v[222:223], v15 offset:55296
Mvva 188,252,220
s_waitcnt vmcnt(14)
Mvva 160,192,224
s_add_u32 m0, s44, 32768
ds_read_b64_tr_b16 v[224:225], v12 offset:57344
ds_read_b64_tr_b16 v[226:227], v12 offset:59392
Mvva 176,192,228
Mvva 164,196,224
ds_read_b64_tr_b16 v[228:229], v13 offset:57344
ds_read_b64_tr_b16 v[230:231], v13 offset:59392
Mvva 180,196,228
Mvva 168,200,224
s_waitcnt lgkmcnt(4)
ds_read_b64_tr_b16 v[232:233], v14 offset:57344
ds_read_b64_tr_b16 v[234:235], v14 offset:59392
Mvva 184,200,228
buffer_load_dwordx4 v114, s[12:15], s48 offen offset:0 lds
Mvva 172,204,224
ds_read_b64_tr_b16 v[236:237], v15 offset:57344
ds_read_b64_tr_b16 v[238:239], v15 offset:59392
Mvva 188,204,228
s_waitcnt vmcnt(13)
Mvva 160,208,232
ds_read_b64_tr_b16 v[240:241], v12 offset:61440
ds_read_b64_tr_b16 v[242:243], v12 offset:63488
Mvva 176,208,236
Mvva 164,212,232
ds_read_b64_tr_b16 v[244:245], v13 offset:61440
ds_read_b64_tr_b16 v[246:247], v13 offset:63488
Mvva 180,212,236
Mvva 168,216,232
s_waitcnt vmcnt(5)
s_waitcnt lgkmcnt(4)
ds_read_b64_tr_b16 v[248:249], v14 offset:61440
ds_read_b64_tr_b16 v[250:251], v14 offset:63488
Mvva 184,216,236
buffer_load_dwordx4 v114, s[12:15], s49 offen offset:1024 lds
Mvva 172,220,232
s_barrier
ds_read_b64_tr_b16 v[252:253], v15 offset:61440
ds_read_b64_tr_b16 v[254:255], v15 offset:63488
Mvva 188,220,236
Mvva 160,224,240
ds_read_b64_tr_b16 v[192:193], v115 offset:0
ds_read_b64_tr_b16 v[194:195], v115 offset:2048
Mvva 176,224,244
s_cmp_lg_u32 s40, 0
s_cbranch_scc1 L_yC
L_yCr:
Mvva 164,228,240
ds_read_b64_tr_b16 v[196:197], v116 offset:0
ds_read_b64_tr_b16 v[198:199], v116 offset:2048
Mvva 180,228,244
Mvva 168,232,240
s_waitcnt lgkmcnt(4)
ds_read_b64_tr_b16 v[200:201], v117 offset:0
ds_read_b64_tr_b16 v[202:203], v117 offset:2048
Mvva 184,232,244
buffer_load_dwordx4 v114, s[12:15], s50 offen offset:2048 lds
Mvva 172,236,240
ds_read_b64_tr_b16 v[204:205], v118 offset:0
ds_read_b64_tr_b16 v[206:207], v118 offset:2048
Mvva 188,236,244
Mvva 160,240,248
ds_read_b64_tr_b16 v[208:209], v115 offset:4096
ds_read_b64_tr_b16 v[210:211], v115 offset:6144
Mvva 176,240,252
Mvva 164,244,248
ds_read_b64_tr_b16 v[212:213], v116 offset:4096
ds_read_b64_tr_b16 v[214:215], v116 offset:6144
Mvva 180,244,252
Mvva 168,248,248
s_waitcnt lgkmcnt(4)
ds_read_b64_tr_b16 v[216:217], v117 offset:4096
ds_read_b64_tr_b16 v[218:219], v117 offset:6144
Mvva 184,248,252
buffer_load_dwordx4 v114, s[12:15], s51 offen offset:3072 lds
v_add_u32 v114, 262144, v114
Mvva 172,252,248
ds_read_b64_tr_b16 v[220:221], v118 offset:4096
ds_read_b64_tr_b16 v[222:223], v118 offset:6144
Mvva 188,252,252
Mvva 128,192,0
s_add_u32 m0, s44, 49152
ds_read_b64_tr_b16 v[224:225], v115 offset:8192
ds_read_b64_tr_b16 v[226:227], v115 offset:10240
Mvva 144,192,4
Mvva 132,196,0
ds_read_b64_tr_b16 v[228:229], v116 offset:8192
ds_read_b64_tr_b16 v[230:231], v116 offset:10240
Mvva 148,196,4
Mvva 136,200,0
s_waitcnt lgkmcnt(4)
ds_read_b64_tr_b16 v[232:233], v117 offset:8192
ds_read_b64_tr_b16 v[234:235], v117 offset:10240
Mvva 152,200,4
buffer_load_dwordx4 v114, s[12:15], s48 offen offset:0 lds
Mvva 140,204,0
ds_read_b64_tr_b16 v[236:237], v118 offset:8192
ds_read_b64_tr_b16 v[238:239], v118 offset:10240
Mvva 156,204,4
v_add_u32 v10, 4096, v112
Mvva 128,208,8
ds_read_b64_tr_b16 v[240:241], v115 offset:12288
ds_read_b64_tr_b16 v[242:243], v115 offset:14336
Mvva 144,208,12
buffer_store_dwordx4 v[160:163], v112, s[16:19], s26 offen offset:0 sc1
Mvva 132,212,8
ds_read_b64_tr_b16 v[244:245], v116 offset:12288
ds_read_b64_tr_b16 v[246:247], v116 offset:14336
Mvva 148,212,12
buffer_store_dwordx4 v[164:167], v112, s[16:19], s26 offen offset:1024 sc1
Mvva 136,216,8
s_waitcnt vmcnt(7)
s_waitcnt lgkmcnt(4)
ds_read_b64_tr_b16 v[248:249], v117 offset:12288
ds_read_b64_tr_b16 v[250:251], v117 offset:14336
Mvva 152,216,12
buffer_load_dwordx4 v114, s[12:15], s49 offen offset:1024 lds
Mvva 140,220,8
s_barrier
ds_read_b64_tr_b16 v[252:253], v118 offset:12288
ds_read_b64_tr_b16 v[254:255], v118 offset:14336
Mvva 156,220,12
buffer_store_dwordx4 v[168:171], v112, s[16:19], s26 offen offset:2048 sc1
Mvva 128,224,16
ds_read_b64_tr_b16 v[192:193], v115 offset:16384
ds_read_b64_tr_b16 v[194:195], v115 offset:18432
Mvva 144,224,20
buffer_store_dwordx4 v[172:175], v112, s[16:19], s26 offen offset:3072 sc1
Mvva 132,228,16
ds_read_b64_tr_b16 v[196:197], v116 offset:16384
ds_read_b64_tr_b16 v[198:199], v116 offset:18432
Mvva 148,228,20
buffer_store_dwordx4 v[176:179], v10, s[16:19], s26 offen offset:0 sc1
Mvva 136,232,16
s_waitcnt lgkmcnt(4)
ds_read_b64_tr_b16 v[200:201], v117 offset:16384
ds_read_b64_tr_b16 v[202:203], v117 offset:18432
Mvva 152,232,20
buffer_load_dwordx4 v114, s[12:15], s50 offen offset:2048 lds
Mvva 140,236,16
ds_read_b64_tr_b16 v[204:205], v118 offset:16384
ds_read_b64_tr_b16 v[206:207], v118 offset:18432
Mvva 156,236,20
buffer_store_dwordx4 v[180:183], v10, s[16:19], s26 offen offset:1024 sc1
Mvva 128,240,24
ds_read_b64_tr_b16 v[208:209], v115 offset:20480
ds_read_b64_tr_b16 v[210:211], v115 offset:22528
Mvva 144,240,28
buffer_store_dwordx4 v[184:187], v10, s[16:19], s26 offen offset:2048 sc1
Mvva 132,244,24
ds_read_b64_tr_b16 v[212:213], v116 offset:20480
ds_read_b64_tr_b16 v[214:215], v116 offset:22528
Mvva 148,244,28
buffer_store_dwordx4 v[188:191], v10, s[16:19], s26 offen offset:3072 sc1
Mvva 136,248,24
s_waitcnt lgkmcnt(4)
ds_read_b64_tr_b16 v[216:217], v117 offset:20480
ds_read_b64_tr_b16 v[218:219], v117 offset:22528
Mvva 152,248,28
buffer_load_dwordx4 v114, s[12:15], s51 offen offset:3072 lds
v_add_u32 v114, 262144, v114
Mvva 140,252,24
ds_read_b64_tr_b16 v[220:221], v118 offset:20480
ds_read_b64_tr_b16 v[222:223], v118 offset:22528
Mvva 156,252,28
v_mov_b32_e64 v16, 1
Mvva 128,192,32
s_add_u32 m0, s44, 65536
ds_read_b64_tr_b16 v[224:225], v115 offset:24576
ds_read_b64_tr_b16 v[226:227], v115 offset:26624
Mvva 144,192,36
Mvva 132,196,32
ds_read_b64_tr_b16 v[228:229], v116 offset:24576
ds_read_b64_tr_b16 v[230:231], v116 offset:26624
Mvva 148,196,36
Mvva 136,200,32
s_waitcnt lgkmcnt(4)
ds_read_b64_tr_b16 v[232:233], v117 offset:24576
ds_read_b64_tr_b16 v[234:235], v117 offset:26624
Mvva 152,200,36
buffer_load_dwordx4 v114, s[12:15], s48 offen offset:0 lds
Mvva 140,204,32
ds_read_b64_tr_b16 v[236:237], v118 offset:24576
ds_read_b64_tr_b16 v[238:239], v118 offset:26624
Mvva 156,204,36
Mvva 128,208,40
ds_read_b64_tr_b16 v[240:241], v115 offset:28672
ds_read_b64_tr_b16 v[242:243], v115 offset:30720
Mvva 144,208,44
Mvva 132,212,40
ds_read_b64_tr_b16 v[244:245], v116 offset:28672
ds_read_b64_tr_b16 v[246:247], v116 offset:30720
Mvva 148,212,44
Mvva 136,216,40
s_waitcnt vmcnt(13)
s_waitcnt lgkmcnt(4)
ds_read_b64_tr_b16 v[248:249], v117 offset:28672
ds_read_b64_tr_b16 v[250:251], v117 offset:30720
Mvva 152,216,44
buffer_load_dwordx4 v114, s[12:15], s49 offen offset:1024 lds
Mvva 140,220,40
s_barrier
ds_read_b64_tr_b16 v[252:253], v118 offset:28672
ds_read_b64_tr_b16 v[254:255], v118 offset:30720
Mvva 156,220,44
Mvva 128,224,48
ds_read_b64_tr_b16 v[192:193], v115 offset:32768
ds_read_b64_tr_b16 v[194:195], v115 offset:34816
Mvva 144,224,52
Mvva 132,228,48
ds_read_b64_tr_b16 v[196:197], v116 offset:32768
ds_read_b64_tr_b16 v[198:199], v116 offset:34816
Mvva 148,228,52
Mvva 136,232,48
s_waitcnt lgkmcnt(4)
ds_read_b64_tr_b16 v[200:201], v117 offset:32768
ds_read_b64_tr_b16 v[202:203], v117 offset:34816
Mvva 152,232,52
buffer_load_dwordx4 v114, s[12:15], s50 offen offset:2048 lds
Mvva 140,236,48
ds_read_b64_tr_b16 v[204:205], v118 offset:32768
ds_read_b64_tr_b16 v[206:207], v118 offset:34816
Mvva 156,236,52
Mvva 128,240,56
ds_read_b64_tr_b16 v[208:209], v115 offset:36864
ds_read_b64_tr_b16 v[210:211], v115 offset:38912
Mvva 144,240,60
Mvva 132,244,56
ds_read_b64_tr_b16 v[212:213], v116 offset:36864
ds_read_b64_tr_b16 v[214:215], v116 offset:38912
Mvva 148,244,60
Mvva 136,248,56
s_waitcnt lgkmcnt(4)
ds_read_b64_tr_b16 v[216:217], v117 offset:36864
ds_read_b64_tr_b16 v[218:219], v117 offset:38912
Mvva 152,248,60
buffer_load_dwordx4 v114, s[12:15], s51 offen offset:3072 lds
v_add_u32 v114, 262144, v114
Mvva 140,252,56
ds_read_b64_tr_b16 v[220:221], v118 offset:36864
ds_read_b64_tr_b16 v[222:223], v118 offset:38912
Mvva 156,252,60
Mvva 128,192,64
s_add_u32 m0, s44, 81920
ds_read_b64_tr_b16 v[224:225], v115 offset:40960
ds_read_b64_tr_b16 v[226:227], v115 offset:43008
Mvva 144,192,68
Mvva 132,196,64
ds_read_b64_tr_b16 v[228:229], v116 offset:40960
ds_read_b64_tr_b16 v[230:231], v116 offset:43008
Mvva 148,196,68
Mvva 136,200,64
s_waitcnt lgkmcnt(4)
ds_read_b64_tr_b16 v[232:233], v117 offset:40960
ds_read_b64_tr_b16 v[234:235], v117 offset:43008
Mvva 152,200,68
buffer_load_dwordx4 v114, s[12:15], s48 offen offset:0 lds
Mvva 140,204,64
ds_read_b64_tr_b16 v[236:237], v118 offset:40960
ds_read_b64_tr_b16 v[238:239], v118 offset:43008
Mvva 156,204,68
Mvva 128,208,72
ds_read_b64_tr_b16 v[240:241], v115 offset:45056
ds_read_b64_tr_b16 v[242:243], v115 offset:47104
Mvva 144,208,76
Mvva 132,212,72
ds_read_b64_tr_b16 v[244:245], v116 offset:45056
ds_read_b64_tr_b16 v[246:247], v116 offset:47104
Mvva 148,212,76
Mvva 136,216,72
s_waitcnt vmcnt(5)
s_waitcnt lgkmcnt(4)
ds_read_b64_tr_b16 v[248:249], v117 offset:45056
ds_read_b64_tr_b16 v[250:251], v117 offset:47104
Mvva 152,216,76
buffer_load_dwordx4 v114, s[12:15], s49 offen offset:1024 lds
Mvva 140,220,72
s_barrier
ds_read_b64_tr_b16 v[252:253], v118 offset:45056
ds_read_b64_tr_b16 v[254:255], v118 offset:47104
Mvva 156,220,76
Mvva 128,224,80
ds_read_b64_tr_b16 v[192:193], v115 offset:49152
ds_read_b64_tr_b16 v[194:195], v115 offset:51200
Mvva 144,224,84
Mvva 132,228,80
ds_read_b64_tr_b16 v[196:197], v116 offset:49152
ds_read_b64_tr_b16 v[198:199], v116 offset:51200
Mvva 148,228,84
Mvva 136,232,80
s_waitcnt lgkmcnt(4)
ds_read_b64_tr_b16 v[200:201], v117 offset:49152
ds_read_b64_tr_b16 v[202:203], v117 offset:51200
Mvva 152,232,84
buffer_load_dwordx4 v114, s[12:15], s50 offen offset:2048 lds
Mvva 140,236,80
ds_read_b64_tr_b16 v[204:205], v118 offset:49152
ds_read_b64_tr_b16 v[206:207], v118 offset:51200
Mvva 156,236,84
Mvva 128,240,88
ds_read_b64_tr_b16 v[208:209], v115 offset:53248
ds_read_b64_tr_b16 v[210:211], v115 offset:55296
Mvva 144,240,92
Mvva 132,244,88
ds_read_b64_tr_b16 v[212:213], v116 offset:53248
ds_read_b64_tr_b16 v[214:215], v116 offset:55296
Mvva 148,244,92
Mvva 136,248,88
s_waitcnt lgkmcnt(4)
ds_read_b64_tr_b16 v[216:217], v117 offset:53248
ds_read_b64_tr_b16 v[218:219], v117 offset:55296
Mvva 152,248,92
buffer_load_dwordx4 v114, s[12:15], s51 offen offset:3072 lds
v_add_u32 v114, 262144, v114
Mvva 140,252,88
ds_read_b64_tr_b16 v[220:221], v118 offset:53248
ds_read_b64_tr_b16 v[222:223], v118 offset:55296
Mvva 156,252,92
Mvva 128,192,96
s_add_u32 m0, s44, 98304
ds_read_b64_tr_b16 v[224:225], v115 offset:57344
ds_read_b64_tr_b16 v[226:227], v115 offset:59392
Mvva 144,192,100
Mvva 132,196,96
ds_read_b64_tr_b16 v[228:229], v116 offset:57344
ds_read_b64_tr_b16 v[230:231], v116 offset:59392
Mvva 148,196,100
Mvva 136,200,96
s_waitcnt lgkmcnt(4)
ds_read_b64_tr_b16 v[232:233], v117 offset:57344
ds_read_b64_tr_b16 v[234:235], v117 offset:59392
Mvva 152,200,100
buffer_load_dwordx4 v114, s[12:15], s48 offen offset:0 lds
Mvva 140,204,96
ds_read_b64_tr_b16 v[236:237], v118 offset:57344
ds_read_b64_tr_b16 v[238:239], v118 offset:59392
Mvva 156,204,100
s_mov_b64 exec, 1
buffer_store_dword v16, v126, s[20:23], s27 offen sc1
s_mov_b64 exec, -1
Mvva 128,208,104
ds_read_b64_tr_b16 v[240:241], v115 offset:61440
ds_read_b64_tr_b16 v[242:243], v115 offset:63488
Mvva 144,208,108
Mvva 132,212,104
ds_read_b64_tr_b16 v[244:245], v116 offset:61440
ds_read_b64_tr_b16 v[246:247], v116 offset:63488
Mvva 148,212,108
Mvva 136,216,104
s_waitcnt vmcnt(6)
s_waitcnt lgkmcnt(4)
ds_read_b64_tr_b16 v[248:249], v117 offset:61440
ds_read_b64_tr_b16 v[250:251], v117 offset:63488
Mvva 152,216,108
buffer_load_dwordx4 v114, s[12:15], s49 offen offset:1024 lds
Mvva 140,220,104
s_barrier
ds_read_b64_tr_b16 v[252:253], v118 offset:61440
ds_read_b64_tr_b16 v[254:255], v118 offset:63488
Mvva 156,220,108
Mvva 128,224,112
ds_read_b64_tr_b16 v[192:193], v12 offset:0
ds_read_b64_tr_b16 v[194:195], v12 offset:2048
Mvva 144,224,116
Mvva 132,228,112
ds_read_b64_tr_b16 v[196:197], v13 offset:0
ds_read_b64_tr_b16 v[198:199], v13 offset:2048
Mvva 148,228,116
Mvva 136,232,112
s_waitcnt lgkmcnt(4)
ds_read_b64_tr_b16 v[200:201], v14 offset:0
ds_read_b64_tr_b16 v[202:203], v14 offset:2048
Mvva 152,232,116
buffer_load_dwordx4 v114, s[12:15], s50 offen offset:2048 lds
Mvva 140,236,112
ds_read_b64_tr_b16 v[204:205], v15 offset:0
ds_read_b64_tr_b16 v[206:207], v15 offset:2048
Mvva 156,236,116
Mvva 128,240,120
ds_read_b64_tr_b16 v[208:209], v12 offset:4096
ds_read_b64_tr_b16 v[210:211], v12 offset:6144
Mvva 144,240,124
Mvva 132,244,120
ds_read_b64_tr_b16 v[212:213], v13 offset:4096
ds_read_b64_tr_b16 v[214:215], v13 offset:6144
Mvva 148,244,124
Mvva 136,248,120
s_waitcnt lgkmcnt(4)
ds_read_b64_tr_b16 v[216:217], v14 offset:4096
ds_read_b64_tr_b16 v[218:219], v14 offset:6144
Mvva 152,248,124
buffer_load_dwordx4 v114, s[12:15], s51 offen offset:3072 lds
v_add_u32 v114, 262144, v114
Mvva 140,252,120
ds_read_b64_tr_b16 v[220:221], v15 offset:4096
ds_read_b64_tr_b16 v[222:223], v15 offset:6144
Mvva 156,252,124
Mvva 128,192,128
s_add_u32 m0, s44, 114688
ds_read_b64_tr_b16 v[224:225], v12 offset:8192
ds_read_b64_tr_b16 v[226:227], v12 offset:10240
Mvva 144,192,132
Mvva 132,196,128
ds_read_b64_tr_b16 v[228:229], v13 offset:8192
ds_read_b64_tr_b16 v[230:231], v13 offset:10240
Mvva 148,196,132
Mvva 136,200,128
s_waitcnt lgkmcnt(4)
ds_read_b64_tr_b16 v[232:233], v14 offset:8192
ds_read_b64_tr_b16 v[234:235], v14 offset:10240
Mvva 152,200,132
buffer_load_dwordx4 v114, s[12:15], s48 offen offset:0 lds
Mvva 140,204,128
ds_read_b64_tr_b16 v[236:237], v15 offset:8192
ds_read_b64_tr_b16 v[238:239], v15 offset:10240
Mvva 156,204,132
Mvva 128,208,136
ds_read_b64_tr_b16 v[240:241], v12 offset:12288
ds_read_b64_tr_b16 v[242:243], v12 offset:14336
Mvva 144,208,140
Mvva 132,212,136
ds_read_b64_tr_b16 v[244:245], v13 offset:12288
ds_read_b64_tr_b16 v[246:247], v13 offset:14336
Mvva 148,212,140
Mvva 136,216,136
s_waitcnt vmcnt(6)
s_waitcnt lgkmcnt(4)
ds_read_b64_tr_b16 v[248:249], v14 offset:12288
ds_read_b64_tr_b16 v[250:251], v14 offset:14336
Mvva 152,216,140
buffer_load_dwordx4 v114, s[12:15], s49 offen offset:1024 lds
Mvva 140,220,136
s_barrier
ds_read_b64_tr_b16 v[252:253], v15 offset:12288
ds_read_b64_tr_b16 v[254:255], v15 offset:14336
Mvva 156,220,140
Mvva 128,224,144
ds_read_b64_tr_b16 v[192:193], v12 offset:16384
ds_read_b64_tr_b16 v[194:195], v12 offset:18432
Mvva 144,224,148
Mvva 132,228,144
ds_read_b64_tr_b16 v[196:197], v13 offset:16384
ds_read_b64_tr_b16 v[198:199], v13 offset:18432
Mvva 148,228,148
Mvva 136,232,144
s_waitcnt lgkmcnt(4)
ds_read_b64_tr_b16 v[200:201], v14 offset:16384
ds_read_b64_tr_b16 v[202:203], v14 offset:18432
Mvva 152,232,148
buffer_load_dwordx4 v114, s[12:15], s50 offen offset:2048 lds
Mvva 140,236,144
ds_read_b64_tr_b16 v[204:205], v15 offset:16384
ds_read_b64_tr_b16 v[206:207], v15 offset:18432
Mvva 156,236,148
buffer_load_dword v17, v126, s[20:23], s24 offen sc1
Mvva 128,240,152
ds_read_b64_tr_b16 v[208:209], v12 offset:20480
ds_read_b64_tr_b16 v[210:211], v12 offset:22528
Mvva 144,240,156
Mvva 132,244,152
ds_read_b64_tr_b16 v[212:213], v13 offset:20480
ds_read_b64_tr_b16 v[214:215], v13 offset:22528
Mvva 148,244,156
Mvva 136,248,152
s_waitcnt lgkmcnt(4)
ds_read_b64_tr_b16 v[216:217], v14 offset:20480
ds_read_b64_tr_b16 v[218:219], v14 offset:22528
Mvva 152,248,156
buffer_load_dwordx4 v114, s[12:15], s51 offen offset:3072 lds
v_add_u32 v114, 262144, v114
Mvva 140,252,152
ds_read_b64_tr_b16 v[220:221], v15 offset:20480
ds_read_b64_tr_b16 v[222:223], v15 offset:22528
Mvva 156,252,156
Mvva 128,192,160
ds_read_b64_tr_b16 v[224:225], v12 offset:24576
ds_read_b64_tr_b16 v[226:227], v12 offset:26624
Mvva 144,192,164
Mvva 132,196,160
ds_read_b64_tr_b16 v[228:229], v13 offset:24576
ds_read_b64_tr_b16 v[230:231], v13 offset:26624
Mvva 148,196,164
Mvva 136,200,160
s_waitcnt lgkmcnt(4)
ds_read_b64_tr_b16 v[232:233], v14 offset:24576
ds_read_b64_tr_b16 v[234:235], v14 offset:26624
Mvva 152,200,164
Mvva 140,204,160
ds_read_b64_tr_b16 v[236:237], v15 offset:24576
ds_read_b64_tr_b16 v[238:239], v15 offset:26624
Mvva 156,204,164
Mvva 128,208,168
ds_read_b64_tr_b16 v[240:241], v12 offset:28672
ds_read_b64_tr_b16 v[242:243], v12 offset:30720
Mvva 144,208,172
Mvva 132,212,168
ds_read_b64_tr_b16 v[244:245], v13 offset:28672
ds_read_b64_tr_b16 v[246:247], v13 offset:30720
Mvva 148,212,172
Mvva 136,216,168
s_waitcnt vmcnt(5)
s_waitcnt lgkmcnt(4)
ds_read_b64_tr_b16 v[248:249], v14 offset:28672
ds_read_b64_tr_b16 v[250:251], v14 offset:30720
Mvva 152,216,172
Mvva 140,220,168
s_barrier
ds_read_b64_tr_b16 v[252:253], v15 offset:28672
ds_read_b64_tr_b16 v[254:255], v15 offset:30720
Mvva 156,220,172
Mvva 128,224,176
ds_read_b64_tr_b16 v[192:193], v12 offset:32768
ds_read_b64_tr_b16 v[194:195], v12 offset:34816
Mvva 144,224,180
Mvva 132,228,176
ds_read_b64_tr_b16 v[196:197], v13 offset:32768
ds_read_b64_tr_b16 v[198:199], v13 offset:34816
Mvva 148,228,180
Mvva 136,232,176
s_waitcnt lgkmcnt(4)
ds_read_b64_tr_b16 v[200:201], v14 offset:32768
ds_read_b64_tr_b16 v[202:203], v14 offset:34816
Mvva 152,232,180
Mvva 140,236,176
ds_read_b64_tr_b16 v[204:205], v15 offset:32768
ds_read_b64_tr_b16 v[206:207], v15 offset:34816
Mvva 156,236,180
Mvva 128,240,184
ds_read_b64_tr_b16 v[208:209], v12 offset:36864
ds_read_b64_tr_b16 v[210:211], v12 offset:38912
Mvva 144,240,188
Mvva 132,244,184
ds_read_b64_tr_b16 v[212:213], v13 offset:36864
ds_read_b64_tr_b16 v[214:215], v13 offset:38912
Mvva 148,244,188
s_waitcnt vmcnt(1)
v_cmp_ne_u32 vcc, 1, v17
s_mov_b32 s33, 0
s_cbranch_vccnz L_xno
s_nop 0
buffer_load_dwordx4 v[160:163], v112, s[16:19], s25 offen offset:0 sc1
buffer_load_dwordx4 v[164:167], v112, s[16:19], s25 offen offset:1024 sc1
buffer_load_dwordx4 v[168:171], v112, s[16:19], s25 offen offset:2048 sc1
buffer_load_dwordx4 v[172:175], v112, s[16:19], s25 offen offset:3072 sc1
buffer_load_dwordx4 v[176:179], v10, s[16:19], s25 offen offset:0 sc1
buffer_load_dwordx4 v[180:183], v10, s[16:19], s25 offen offset:1024 sc1
buffer_load_dwordx4 v[184:187], v10, s[16:19], s25 offen offset:2048 sc1
buffer_load_dwordx4 v[188:191], v10, s[16:19], s25 offen offset:3072 sc1
s_mov_b32 s33, 1
L_xno:
Mvva 136,248,184
s_waitcnt lgkmcnt(4)
ds_read_b64_tr_b16 v[216:217], v14 offset:36864
ds_read_b64_tr_b16 v[218:219], v14 offset:38912
Mvva 152,248,188
Mvva 140,252,184
ds_read_b64_tr_b16 v[220:221], v15 offset:36864
ds_read_b64_tr_b16 v[222:223], v15 offset:38912
Mvva 156,252,188
Mvva 128,192,192
ds_read_b64_tr_b16 v[224:225], v12 offset:40960
ds_read_b64_tr_b16 v[226:227], v12 offset:43008
Mvva 144,192,196
Mvva 132,196,192
ds_read_b64_tr_b16 v[228:229], v13 offset:40960
ds_read_b64_tr_b16 v[230:231], v13 offset:43008
Mvva 148,196,196
Mvva 136,200,192
s_waitcnt lgkmcnt(4)
ds_read_b64_tr_b16 v[232:233], v14 offset:40960
ds_read_b64_tr_b16 v[234:235], v14 offset:43008
Mvva 152,200,196
Mvva 140,204,192
ds_read_b64_tr_b16 v[236:237], v15 offset:40960
ds_read_b64_tr_b16 v[238:239], v15 offset:43008
Mvva 156,204,196
Mvva 128,208,200
ds_read_b64_tr_b16 v[240:241], v12 offset:45056
ds_read_b64_tr_b16 v[242:243], v12 offset:47104
Mvva 144,208,204
Mvva 132,212,200
ds_read_b64_tr_b16 v[244:245], v13 offset:45056
ds_read_b64_tr_b16 v[246:247], v13 offset:47104
Mvva 148,212,204
Mvva 136,216,200
s_waitcnt vmcnt(0)
s_waitcnt lgkmcnt(4)
ds_read_b64_tr_b16 v[248:249], v14 offset:45056
ds_read_b64_tr_b16 v[250:251], v14 offset:47104
Mvva 152,216,204
Mvva 140,220,200
s_barrier
ds_read_b64_tr_b16 v[252:253], v15 offset:45056
ds_read_b64_tr_b16 v[254:255], v15 offset:47104
Mvva 156,220,204
Mvva 128,224,208
ds_read_b64_tr_b16 v[192:193], v12 offset:49152
ds_read_b64_tr_b16 v[194:195], v12 offset:51200
Mvva 144,224,212
Mvva 132,228,208
ds_read_b64_tr_b16 v[196:197], v13 offset:49152
ds_read_b64_tr_b16 v[198:199], v13 offset:51200
Mvva 148,228,212
Mvva 136,232,208
s_waitcnt lgkmcnt(4)
ds_read_b64_tr_b16 v[200:201], v14 offset:49152
ds_read_b64_tr_b16 v[202:203], v14 offset:51200
Mvva 152,232,212
Mvva 140,236,208
ds_read_b64_tr_b16 v[204:205], v15 offset:49152
ds_read_b64_tr_b16 v[206:207], v15 offset:51200
Mvva 156,236,212
Mvva 128,240,216
ds_read_b64_tr_b16 v[208:209], v12 offset:53248
ds_read_b64_tr_b16 v[210:211], v12 offset:55296
Mvva 144,240,220
Mvva 132,244,216
ds_read_b64_tr_b16 v[212:213], v13 offset:53248
ds_read_b64_tr_b16 v[214:215], v13 offset:55296
Mvva 148,244,220
Mvva 136,248,216
s_waitcnt lgkmcnt(4)
ds_read_b64_tr_b16 v[216:217], v14 offset:53248
ds_read_b64_tr_b16 v[218:219], v14 offset:55296
Mvva 152,248,220
Mvva 140,252,216
ds_read_b64_tr_b16 v[220:221], v15 offset:53248
ds_read_b64_tr_b16 v[222:223], v15 offset:55296
Mvva 156,252,220
Mvva 128,192,224
ds_read_b64_tr_b16 v[224:225], v12 offset:57344
ds_read_b64_tr_b16 v[226:227], v12 offset:59392
Mvva 144,192,228
Mvva 132,196,224
ds_read_b64_tr_b16 v[228:229], v13 offset:57344
ds_read_b64_tr_b16 v[230:231], v13 offset:59392
Mvva 148,196,228
Mvva 136,200,224
s_waitcnt lgkmcnt(4)
ds_read_b64_tr_b16 v[232:233], v14 offset:57344
ds_read_b64_tr_b16 v[234:235], v14 offset:59392
Mvva 152,200,228
Mvva 140,204,224
ds_read_b64_tr_b16 v[236:237], v15 offset:57344
ds_read_b64_tr_b16 v[238:239], v15 offset:59392
Mvva 156,204,228
Mvva 128,208,232
ds_read_b64_tr_b16 v[240:241], v12 offset:61440
ds_read_b64_tr_b16 v[242:243], v12 offset:63488
Mvva 144,208,236
Mvva 132,212,232
ds_read_b64_tr_b16 v[244:245], v13 offset:61440
ds_read_b64_tr_b16 v[246:247], v13 offset:63488
Mvva 148,212,236
Mvva 136,216,232
s_waitcnt lgkmcnt(4)
ds_read_b64_tr_b16 v[248:249], v14 offset:61440
ds_read_b64_tr_b16 v[250:251], v14 offset:63488
Mvva 152,216,236
Mvva 140,220,232
ds_read_b64_tr_b16 v[252:253], v15 offset:61440
ds_read_b64_tr_b16 v[254:255], v15 offset:63488
Mvva 156,220,236
Mvva 128,224,240
Mvva 144,224,244
Mvva 132,228,240
Mvva 148,228,244
Mvva 136,232,240
s_waitcnt lgkmcnt(0)
Mvva 152,232,244
Mvva 140,236,240
Mvva 156,236,244
Mvva 128,240,248
Mvva 144,240,252
Mvva 132,244,248
Mvva 148,244,252
Mvva 136,248,248
Mvva 152,248,252
Mvva 140,252,248
Mvva 156,252,252
v_and_b32 v124, 15, v0
v_lshlrev_b32 v74, 8, v124
v_add_u32 v74, s35, v74
v_xor_b32_e64 v124, v124, v121
v_lshl_add_u32 v74, v124, 4, v74
v_xor_b32_e64 v75, 64, v74
v_xor_b32 v76, 128, v74
v_xor_b32 v77, 192, v74
v_lshlrev_b32 v125, 1, v122
v_xor_b32 v124, v123, v125
v_lshlrev_b32 v12, 8, v123
v_add_u32 v12, s35, v12
v_lshl_add_u32 v12, v124, 4, v12
v_xor_b32_e64 v13, 16, v12
v_xor_b32 v14, 128, v12
v_xor_b32 v15, 144, v12
s_cmp_lg_u32 s53, s40
s_cbranch_scc1 L_ysl
L_yslr:
s_cmp_eq_u32 s33, 0
s_cbranch_scc1 L_spinX
L_spinXr:
v_lshlrev_b32_e64 v80, 16, v18
v_and_b32 v81, 0xffff0000, v18
v_lshlrev_b32_e64 v82, 16, v19
v_and_b32 v83, 0xffff0000, v19
v_lshlrev_b32_e64 v84, 16, v20
v_and_b32 v85, 0xffff0000, v20
v_lshlrev_b32_e64 v86, 16, v21
v_and_b32 v87, 0xffff0000, v21
v_lshlrev_b32_e64 v88, 16, v22
v_and_b32 v89, 0xffff0000, v22
v_lshlrev_b32_e64 v90, 16, v23
v_and_b32 v91, 0xffff0000, v23
v_lshlrev_b32_e64 v92, 16, v24
v_and_b32 v93, 0xffff0000, v24
v_lshlrev_b32_e64 v94, 16, v25
v_and_b32 v95, 0xffff0000, v25
v_lshlrev_b32_e64 v96, 16, v26
v_and_b32 v97, 0xffff0000, v26
v_lshlrev_b32_e64 v98, 16, v27
v_and_b32 v99, 0xffff0000, v27
v_lshlrev_b32_e64 v100, 16, v28
v_and_b32 v101, 0xffff0000, v28
v_lshlrev_b32_e64 v102, 16, v29
v_and_b32 v103, 0xffff0000, v29
v_lshlrev_b32_e64 v104, 16, v30
v_and_b32 v105, 0xffff0000, v30
v_lshlrev_b32_e64 v106, 16, v31
v_and_b32 v107, 0xffff0000, v31
v_lshlrev_b32_e64 v108, 16, v32
v_and_b32 v109, 0xffff0000, v32
v_lshlrev_b32_e64 v110, 16, v33
v_and_b32 v111, 0xffff0000, v33
s_waitcnt vmcnt(0)
s_nop 0
v_pk_add_f32 v[128:129], v[128:129], v[160:161]
v_pk_add_f32 v[130:131], v[130:131], v[162:163]
ds_write_b128 v74, v[128:131] offset:0
v_pk_add_f32 v[132:133], v[132:133], v[164:165]
v_pk_add_f32 v[134:135], v[134:135], v[166:167]
ds_write_b128 v75, v[132:135] offset:0
v_pk_add_f32 v[136:137], v[136:137], v[168:169]
v_pk_add_f32 v[138:139], v[138:139], v[170:171]
ds_write_b128 v76, v[136:139] offset:0
v_pk_add_f32 v[140:141], v[140:141], v[172:173]
v_pk_add_f32 v[142:143], v[142:143], v[174:175]
ds_write_b128 v77, v[140:143] offset:0
v_pk_add_f32 v[144:145], v[144:145], v[176:177]
v_pk_add_f32 v[146:147], v[146:147], v[178:179]
ds_write_b128 v74, v[144:147] offset:4096
v_pk_add_f32 v[148:149], v[148:149], v[180:181]
v_pk_add_f32 v[150:151], v[150:151], v[182:183]
ds_write_b128 v75, v[148:151] offset:4096
v_pk_add_f32 v[152:153], v[152:153], v[184:185]
v_pk_add_f32 v[154:155], v[154:155], v[186:187]
ds_write_b128 v76, v[152:155] offset:4096
v_pk_add_f32 v[156:157], v[156:157], v[188:189]
v_pk_add_f32 v[158:159], v[158:159], v[190:191]
ds_write_b128 v77, v[156:159] offset:4096
Rv 192,12,0
Rv 196,13,0
Rv 200,14,2048
Rv 204,15,2048
Rv 208,12,4096
Rv 212,13,4096
Rv 216,14,6144
s_waitcnt lgkmcnt(9)
Rv 220,15,6144
s_waitcnt lgkmcnt(6)
Vc 224,192,193
v_lshlrev_b32_e64 v192, 16, v224
v_and_b32 v193, 0xffff0000, v224
Vc 225,194,195
v_lshlrev_b32_e64 v194, 16, v225
v_and_b32 v195, 0xffff0000, v225
Vc 226,196,197
v_lshlrev_b32_e64 v196, 16, v226
v_and_b32 v197, 0xffff0000, v226
Vc 227,198,199
v_lshlrev_b32_e64 v198, 16, v227
v_and_b32 v199, 0xffff0000, v227
v_pk_mul_f32 v[192:193], v[192:193], v[42:43]
v_pk_mul_f32 v[194:195], v[194:195], v[44:45]
v_pk_mul_f32 v[196:197], v[196:197], v[46:47]
v_pk_mul_f32 v[198:199], v[198:199], v[48:49]
Vc 224,192,193
v_lshlrev_b32_e64 v192, 16, v224
v_and_b32 v193, 0xffff0000, v224
Vc 225,194,195
v_lshlrev_b32_e64 v194, 16, v225
v_and_b32 v195, 0xffff0000, v225
Vc 226,196,197
v_lshlrev_b32_e64 v196, 16, v226
v_and_b32 v197, 0xffff0000, v226
Vc 227,198,199
v_lshlrev_b32_e64 v198, 16, v227
v_and_b32 v199, 0xffff0000, v227
v_pk_add_f32 v[192:193], v[192:193], v[80:81]
v_pk_add_f32 v[194:195], v[194:195], v[82:83]
v_pk_add_f32 v[196:197], v[196:197], v[84:85]
v_pk_add_f32 v[198:199], v[198:199], v[86:87]
Vc 224,192,193
Vc 225,194,195
Vc 226,196,197
Vc 227,198,199
buffer_store_dwordx4 v[224:227], v119, s[68:71], s36 offen sc1
s_add_u32 s36, s36, 16384
s_waitcnt lgkmcnt(4)
Vc 228,200,201
v_lshlrev_b32 v200, 16, v228
v_and_b32 v201, 0xffff0000, v228
Vc 229,202,203
v_lshlrev_b32_e64 v202, 16, v229
v_and_b32 v203, 0xffff0000, v229
Vc 230,204,205
v_lshlrev_b32_e64 v204, 16, v230
v_and_b32 v205, 0xffff0000, v230
Vc 231,206,207
v_lshlrev_b32_e64 v206, 16, v231
v_and_b32 v207, 0xffff0000, v231
v_pk_mul_f32 v[200:201], v[200:201], v[50:51]
v_pk_mul_f32 v[202:203], v[202:203], v[52:53]
v_pk_mul_f32 v[204:205], v[204:205], v[54:55]
v_pk_mul_f32 v[206:207], v[206:207], v[56:57]
Vc 228,200,201
v_lshlrev_b32_e64 v200, 16, v228
v_and_b32 v201, 0xffff0000, v228
Vc 229,202,203
v_lshlrev_b32_e64 v202, 16, v229
v_and_b32 v203, 0xffff0000, v229
Vc 230,204,205
v_lshlrev_b32_e64 v204, 16, v230
v_and_b32 v205, 0xffff0000, v230
Vc 231,206,207
v_lshlrev_b32_e64 v206, 16, v231
v_and_b32 v207, 0xffff0000, v231
v_pk_add_f32 v[200:201], v[200:201], v[88:89]
v_pk_add_f32 v[202:203], v[202:203], v[90:91]
v_pk_add_f32 v[204:205], v[204:205], v[92:93]
v_pk_add_f32 v[206:207], v[206:207], v[94:95]
Vc 228,200,201
Vc 229,202,203
Vc 230,204,205
Vc 231,206,207
buffer_store_dwordx4 v[228:231], v119, s[68:71], s36 offen sc1
s_add_u32 s36, s36, 16384
s_waitcnt lgkmcnt(2)
Vc 232,208,209
v_lshlrev_b32 v208, 16, v232
v_and_b32 v209, 0xffff0000, v232
Vc 233,210,211
v_lshlrev_b32_e64 v210, 16, v233
v_and_b32 v211, 0xffff0000, v233
Vc 234,212,213
v_lshlrev_b32_e64 v212, 16, v234
v_and_b32 v213, 0xffff0000, v234
Vc 235,214,215
v_lshlrev_b32_e64 v214, 16, v235
v_and_b32 v215, 0xffff0000, v235
v_pk_mul_f32 v[208:209], v[208:209], v[58:59]
v_pk_mul_f32 v[210:211], v[210:211], v[60:61]
v_pk_mul_f32 v[212:213], v[212:213], v[62:63]
v_pk_mul_f32 v[214:215], v[214:215], v[64:65]
Vc 232,208,209
v_lshlrev_b32_e64 v208, 16, v232
v_and_b32 v209, 0xffff0000, v232
Vc 233,210,211
v_lshlrev_b32_e64 v210, 16, v233
v_and_b32 v211, 0xffff0000, v233
Vc 234,212,213
v_lshlrev_b32_e64 v212, 16, v234
v_and_b32 v213, 0xffff0000, v234
Vc 235,214,215
v_lshlrev_b32_e64 v214, 16, v235
v_and_b32 v215, 0xffff0000, v235
v_pk_add_f32 v[208:209], v[208:209], v[96:97]
v_pk_add_f32 v[210:211], v[210:211], v[98:99]
v_pk_add_f32 v[212:213], v[212:213], v[100:101]
v_pk_add_f32 v[214:215], v[214:215], v[102:103]
Vc 232,208,209
Vc 233,210,211
Vc 234,212,213
Vc 235,214,215
buffer_store_dwordx4 v[232:235], v119, s[68:71], s36 offen sc1
s_add_u32 s36, s36, 16384
s_waitcnt lgkmcnt(0)
Vc 236,216,217
v_lshlrev_b32 v216, 16, v236
v_and_b32 v217, 0xffff0000, v236
Vc 237,218,219
v_lshlrev_b32_e64 v218, 16, v237
v_and_b32 v219, 0xffff0000, v237
Vc 238,220,221
v_lshlrev_b32_e64 v220, 16, v238
v_and_b32 v221, 0xffff0000, v238
Vc 239,222,223
v_lshlrev_b32_e64 v222, 16, v239
v_and_b32 v223, 0xffff0000, v239
v_pk_mul_f32 v[216:217], v[216:217], v[66:67]
v_pk_mul_f32 v[218:219], v[218:219], v[68:69]
v_pk_mul_f32 v[220:221], v[220:221], v[70:71]
v_pk_mul_f32 v[222:223], v[222:223], v[72:73]
Vc 236,216,217
v_lshlrev_b32_e64 v216, 16, v236
v_and_b32 v217, 0xffff0000, v236
Vc 237,218,219
v_lshlrev_b32_e64 v218, 16, v237
v_and_b32 v219, 0xffff0000, v237
Vc 238,220,221
v_lshlrev_b32_e64 v220, 16, v238
v_and_b32 v221, 0xffff0000, v238
Vc 239,222,223
v_lshlrev_b32_e64 v222, 16, v239
v_and_b32 v223, 0xffff0000, v239
v_pk_add_f32 v[216:217], v[216:217], v[104:105]
v_pk_add_f32 v[218:219], v[218:219], v[106:107]
v_pk_add_f32 v[220:221], v[220:221], v[108:109]
v_pk_add_f32 v[222:223], v[222:223], v[110:111]
Vc 236,216,217
Vc 237,218,219
Vc 238,220,221
Vc 239,222,223
buffer_store_dwordx4 v[236:239], v119, s[68:71], s36 offen sc1
L_k2_end:
s_endpgm
L_spinC:
s_add_u32 m0, s35, 0
s_nop 0
s_nop 0
buffer_load_dwordx4 v125, s[60:63], s48 offen offset:0 lds
buffer_load_dwordx4 v125, s[60:63], s49 offen offset:1024 lds
buffer_load_dwordx4 v125, s[60:63], s50 offen offset:2048 lds
buffer_load_dwordx4 v125, s[60:63], s51 offen offset:3072 lds
v_add_u32 v125, 65536, v125
s_add_u32 m0, s35, 4096
s_nop 0
buffer_load_dwordx4 v125, s[60:63], s48 offen offset:0 lds
buffer_load_dwordx4 v125, s[60:63], s49 offen offset:1024 lds
buffer_load_dwordx4 v125, s[60:63], s50 offen offset:2048 lds
buffer_load_dwordx4 v125, s[60:63], s51 offen offset:3072 lds
s_mov_b32 s40, 1
s_mov_b32 s47, 0x400000
L_spinC_l:
buffer_load_dword v124, v10, s[20:23], s38 offen sc1
s_sub_u32 s47, s47, 1
s_waitcnt vmcnt(0)
s_cmp_eq_u32 s47, 0
s_cbranch_scc1 L_spinC_lx
v_cmp_ne_u32 vcc, 1, v124
s_cbranch_vccz L_spinC_lx
s_sleep 4
s_branch L_spinC_l
L_spinC_lx:
s_branch L_spinCr
L_c31:
s_bfe_u32 s3, s2, 0x40003
s_lshl_b32 s3, s3, 2
s_add_u32 s3, s3, s32
s_lshl_b32 s3, s3, 15
s_and_b32 s7, s2, 1
s_lshl_b32 s7, s7, 10
s_add_u32 s3, s3, s7
s_add_u32 s3, s3, 2097536
v_and_b32 v1, 15, v0
v_lshlrev_b32 v1, 11, v1
v_lshrrev_b32 v11, 5, v0
v_lshl_add_u32 v1, v11, 22, v1
buffer_load_dword v11, v1, s[28:31], s3 offen
s_branch L_c31r
L_f2A:
s_lshr_b32 s5, s54, 1
s_lshl_b32 s5, s5, 5
s_add_u32 s5, s5, 5447680
buffer_load_dword v125, v127, s[20:23], s5 offen sc1
s_branch L_f2Ar
L_f2B:
s_waitcnt vmcnt(16)
v_cmp_ne_u32 vcc, 1, v125
s_cbranch_vccz L_f2lx
s_mov_b32 s47, 0x400000
L_f2l:
buffer_load_dword v125, v127, s[20:23], s5 offen sc1
s_sub_u32 s47, s47, 1
s_waitcnt vmcnt(0)
s_cmp_eq_u32 s47, 0
s_cbranch_scc1 L_f2lx
v_cmp_ne_u32 vcc, 1, v125
s_cbranch_vccz L_f2lx
s_sleep 8
s_branch L_f2l
L_f2lx:
s_lshl_b32 s3, s54, 8
s_add_u32 s3, s3, 6291456
v_mul_u32_u24 v124, 14336, v121
v_and_b32_e64 v125, 15, v0
v_lshl_add_u32 v124, v125, 4, v124
buffer_load_dwordx4 v[74:77], v124, s[20:23], s3 offen sc1
s_add_u32 s3, s3, 57344
buffer_load_dwordx4 v[78:81], v124, s[20:23], s3 offen sc1
s_add_u32 s3, s3, 57344
buffer_load_dwordx4 v[82:85], v124, s[20:23], s3 offen sc1
s_add_u32 s3, s3, 57344
buffer_load_dwordx4 v[86:89], v124, s[20:23], s3 offen sc1
s_add_u32 s3, s3, 57344
buffer_load_dwordx4 v[90:93], v124, s[20:23], s3 offen sc1
s_add_u32 s3, s3, 57344
buffer_load_dwordx4 v[94:97], v124, s[20:23], s3 offen sc1
s_add_u32 s3, s3, 57344
buffer_load_dwordx4 v[98:101], v124, s[20:23], s3 offen sc1
s_add_u32 s3, s3, 57344
buffer_load_dwordx4 v[102:105], v124, s[20:23], s3 offen sc1
s_branch L_f2Br
L_f2C:
v_add_u32 v106, s35, v115
v_add_u32 v107, s35, v116
v_add_u32 v108, s35, v117
v_add_u32 v109, s35, v118
s_waitcnt vmcnt(16) lgkmcnt(0)
v_pk_add_f32 v[74:75], v[74:75], v[78:79]
v_pk_add_f32 v[76:77], v[76:77], v[80:81]
v_pk_add_f32 v[74:75], v[74:75], v[82:83]
v_pk_add_f32 v[76:77], v[76:77], v[84:85]
v_pk_add_f32 v[74:75], v[74:75], v[86:87]
v_pk_add_f32 v[76:77], v[76:77], v[88:89]
v_pk_add_f32 v[74:75], v[74:75], v[90:91]
v_pk_add_f32 v[76:77], v[76:77], v[92:93]
v_pk_add_f32 v[74:75], v[74:75], v[94:95]
v_pk_add_f32 v[76:77], v[76:77], v[96:97]
v_pk_add_f32 v[74:75], v[74:75], v[98:99]
v_pk_add_f32 v[76:77], v[76:77], v[100:101]
v_pk_add_f32 v[74:75], v[74:75], v[102:103]
v_pk_add_f32 v[76:77], v[76:77], v[104:105]
Vc 125,74,75
v_lshlrev_b32_e64 v74, 16, v125
v_and_b32 v75, 0xffff0000, v125
Vc 125,76,77
v_lshlrev_b32_e64 v76, 16, v125
v_and_b32 v77, 0xffff0000, v125
v_mov_b32 v82, v74
v_mov_b32 v83, v75
v_mov_b32 v84, v76
v_mov_b32 v85, v77
v_permlane32_swap_b32 v82, v74
v_permlane32_swap_b32 v83, v75
v_permlane32_swap_b32 v84, v76
v_permlane32_swap_b32 v85, v77
v_mul_f32 v90, 0xbfb8aa3b, v82
v_mul_f32 v91, 0xbfb8aa3b, v83
v_mul_f32 v92, 0xbfb8aa3b, v84
v_mul_f32 v93, 0xbfb8aa3b, v85
Ve 90,90
Ve 91,91
Ve 92,92
Ve 93,93
v_add_f32 v90, 1.0, v90
v_add_f32 v91, 1.0, v91
v_add_f32 v92, 1.0, v92
v_add_f32 v93, 1.0, v93
v_rcp_f32 v90, v90
v_rcp_f32 v91, v91
v_rcp_f32 v92, v92
v_rcp_f32 v93, v93
Vm 82,82,90
Vm 83,83,91
Vm 84,84,92
Vm 85,85,93
Vc 125,82,83
v_lshlrev_b32_e64 v82, 16, v125
v_and_b32 v83, 0xffff0000, v125
Vc 125,84,85
v_lshlrev_b32_e64 v84, 16, v125
v_and_b32 v85, 0xffff0000, v125
Vm 74,74,82
Vm 75,75,83
Vm 76,76,84
Vm 77,77,85
Vc 90,74,75
Vc 91,76,77
v_and_b32 v124, 1, v121
v_lshlrev_b32 v124, 8, v124
v_and_b32_e64 v125, 15, v0
v_lshl_add_u32 v124, v125, 3, v124
v_add_u32_e64 v124, s35, v124
ds_read_b64_tr_b16 v[74:75], v106 offset:0
ds_read_b64_tr_b16 v[76:77], v106 offset:2048
ds_read_b64_tr_b16 v[78:79], v107 offset:0
ds_read_b64_tr_b16 v[80:81], v107 offset:2048
ds_read_b64_tr_b16 v[82:83], v108 offset:0
ds_read_b64_tr_b16 v[84:85], v108 offset:2048
ds_read_b64_tr_b16 v[86:87], v109 offset:0
ds_read_b64_tr_b16 v[88:89], v109 offset:2048
ds_write_b64 v124, v[90:91]
v_and_b32 v124, 1, v0
v_lshlrev_b32 v124, 8, v124
v_lshl_add_u32 v125, v121, 3, v124
v_add_u32_e64 v125, s35, v125
ds_read_b64 v[90:91], v125 offset:0
ds_read_b64 v[92:93], v125 offset:32
ds_read_b64 v[94:95], v125 offset:64
ds_read_b64 v[96:97], v125 offset:96
v_lshl_add_u32 v124, v121, 4, v124
v_add_u32 v124, s35, v124
s_waitcnt lgkmcnt(0)
Zvvv 98,74,90
ds_read_b64_tr_b16 v[74:75], v106 offset:4096
ds_read_b64_tr_b16 v[76:77], v106 offset:6144
Zvvv 102,78,90
ds_read_b64_tr_b16 v[78:79], v107 offset:4096
ds_read_b64_tr_b16 v[80:81], v107 offset:6144
s_waitcnt lgkmcnt(0)
Mvvv 98,74,94
Mvvv 102,78,94
s_nop 6
ds_write_b128 v124, v[98:101] offset:2048
ds_write_b128 v124, v[102:105] offset:2112
s_waitcnt lgkmcnt(0)
Zvvv 98,82,90
ds_read_b64_tr_b16 v[82:83], v108 offset:4096
ds_read_b64_tr_b16 v[84:85], v108 offset:6144
Zvvv 102,86,90
ds_read_b64_tr_b16 v[86:87], v109 offset:4096
ds_read_b64_tr_b16 v[88:89], v109 offset:6144
s_waitcnt lgkmcnt(0)
Mvvv 98,82,94
Mvvv 102,86,94
s_nop 6
ds_write_b128 v124, v[98:101] offset:2176
ds_write_b128 v124, v[102:105] offset:2240
s_waitcnt lgkmcnt(0)
s_barrier
s_cmp_lg_u32 s32, 0
s_cbranch_scc1 L_f2Cr
v_lshlrev_b32 v124, 3, v0
v_add_u32 v125, 133120, v124
ds_read_b64 v[74:75], v125 offset:0
ds_read_b64 v[76:77], v125 offset:8192
ds_read_b64 v[78:79], v125 offset:16384
ds_read_b64 v[80:81], v125 offset:24576
s_lshl_b32 s3, s39, 4
s_add_u32 s3, s3, s37
s_lshl_b32 s3, s3, 9
s_add_u32 s3, s3, 5308416
s_waitcnt lgkmcnt(0)
v_pk_add_f32 v[74:75], v[74:75], v[76:77]
v_pk_add_f32 v[78:79], v[78:79], v[80:81]
v_pk_add_f32 v[74:75], v[74:75], v[78:79]
buffer_store_dwordx2 v[74:75], v124, s[20:23], s3 offen sc1
s_branch L_f2Cr
L_f2E:
s_cmp_lg_u32 s32, 0
s_cbranch_scc1 L_f2Er
v_mov_b32 v125, 1
s_lshl_b32 s3, s39, 5
s_add_u32 s3, s3, s37
s_lshl_b32 s3, s3, 2
s_add_u32 s3, s3, 5449728
s_waitcnt vmcnt(16)
s_mov_b64 exec, 1
buffer_store_dword v125, v126, s[20:23], s3 offen sc1
s_mov_b64 exec, -1
s_branch L_f2Er
L_yA:
v_min_u32 v127, 13, v0
v_lshlrev_b32_e64 v127, 2, v127
buffer_load_dword v79, v127, s[20:23], s41 offen sc1
s_branch L_yAr
L_yB:
s_waitcnt vmcnt(6)
v_cmp_ne_u32 vcc, 1, v79
s_cbranch_vccnz L_yBr
s_mov_b32 s40, 1
v_lshlrev_b32 v125, 10, v123
v_lshl_add_u32 v125, v122, 5, v125
v_mov_b32 v124, 2146435072
v_cmp_gt_u32 vcc, 7, v123
s_nop 1
v_cndmask_b32 v125, v124, v125, vcc
s_nop 0
buffer_load_dwordx4 v[80:83], v125, s[20:23], s55 offen offset:0 sc1
buffer_load_dwordx4 v[84:87], v125, s[20:23], s55 offen offset:16 sc1
buffer_load_dwordx4 v[88:91], v125, s[20:23], s55 offen offset:256 sc1
buffer_load_dwordx4 v[92:95], v125, s[20:23], s55 offen offset:272 sc1
buffer_load_dwordx4 v[96:99], v125, s[20:23], s55 offen offset:512 sc1
buffer_load_dwordx4 v[100:103], v125, s[20:23], s55 offen offset:528 sc1
buffer_load_dwordx4 v[104:107], v125, s[20:23], s55 offen offset:768 sc1
buffer_load_dwordx4 v[108:111], v125, s[20:23], s55 offen offset:784 sc1
s_branch L_yBr
L_yC:
s_waitcnt vmcnt(4)
v_pk_add_f32 v[80:81], v[80:81], v[96:97]
v_pk_add_f32 v[82:83], v[82:83], v[98:99]
v_pk_add_f32 v[84:85], v[84:85], v[100:101]
v_pk_add_f32 v[86:87], v[86:87], v[102:103]
v_pk_add_f32 v[88:89], v[88:89], v[104:105]
v_pk_add_f32 v[90:91], v[90:91], v[106:107]
v_pk_add_f32 v[92:93], v[92:93], v[108:109]
v_pk_add_f32 v[94:95], v[94:95], v[110:111]
v_add_f32_dpp v80, v80, v80 row_ror:8 row_mask:0xf bank_mask:0xf
v_add_f32_dpp v81, v81, v81 row_ror:8 row_mask:0xf bank_mask:0xf
v_add_f32_dpp v82, v82, v82 row_ror:8 row_mask:0xf bank_mask:0xf
v_add_f32_dpp v83, v83, v83 row_ror:8 row_mask:0xf bank_mask:0xf
v_add_f32_dpp v84, v84, v84 row_ror:8 row_mask:0xf bank_mask:0xf
v_add_f32_dpp v85, v85, v85 row_ror:8 row_mask:0xf bank_mask:0xf
v_add_f32_dpp v86, v86, v86 row_ror:8 row_mask:0xf bank_mask:0xf
v_add_f32_dpp v87, v87, v87 row_ror:8 row_mask:0xf bank_mask:0xf
v_add_f32_dpp v88, v88, v88 row_ror:8 row_mask:0xf bank_mask:0xf
v_add_f32_dpp v89, v89, v89 row_ror:8 row_mask:0xf bank_mask:0xf
v_add_f32_dpp v90, v90, v90 row_ror:8 row_mask:0xf bank_mask:0xf
v_add_f32_dpp v91, v91, v91 row_ror:8 row_mask:0xf bank_mask:0xf
v_add_f32_dpp v92, v92, v92 row_ror:8 row_mask:0xf bank_mask:0xf
v_add_f32_dpp v93, v93, v93 row_ror:8 row_mask:0xf bank_mask:0xf
v_add_f32_dpp v94, v94, v94 row_ror:8 row_mask:0xf bank_mask:0xf
v_add_f32_dpp v95, v95, v95 row_ror:8 row_mask:0xf bank_mask:0xf
v_mov_b32 v96, v80
v_mov_b32 v97, v81
v_mov_b32 v98, v82
v_mov_b32 v99, v83
v_mov_b32 v100, v84
v_mov_b32 v101, v85
v_mov_b32 v102, v86
v_mov_b32 v103, v87
v_mov_b32 v104, v88
v_mov_b32 v105, v89
v_mov_b32 v106, v90
v_mov_b32 v107, v91
v_mov_b32 v108, v92
v_mov_b32 v109, v93
v_mov_b32 v110, v94
v_mov_b32 v111, v95
v_permlane16_swap_b32 v96, v80
v_permlane16_swap_b32 v97, v81
v_permlane16_swap_b32 v98, v82
v_permlane16_swap_b32 v99, v83
v_permlane16_swap_b32 v100, v84
v_permlane16_swap_b32 v101, v85
v_permlane16_swap_b32 v102, v86
v_permlane16_swap_b32 v103, v87
v_permlane16_swap_b32 v104, v88
v_permlane16_swap_b32 v105, v89
v_permlane16_swap_b32 v106, v90
v_permlane16_swap_b32 v107, v91
v_permlane16_swap_b32 v108, v92
v_permlane16_swap_b32 v109, v93
v_permlane16_swap_b32 v110, v94
v_permlane16_swap_b32 v111, v95
v_pk_add_f32 v[80:81], v[80:81], v[96:97]
v_pk_add_f32 v[82:83], v[82:83], v[98:99]
v_pk_add_f32 v[84:85], v[84:85], v[100:101]
v_pk_add_f32 v[86:87], v[86:87], v[102:103]
v_pk_add_f32 v[88:89], v[88:89], v[104:105]
v_pk_add_f32 v[90:91], v[90:91], v[106:107]
v_pk_add_f32 v[92:93], v[92:93], v[108:109]
v_pk_add_f32 v[94:95], v[94:95], v[110:111]
v_mov_b32 v96, v80
v_mov_b32 v97, v81
v_mov_b32 v98, v82
v_mov_b32 v99, v83
v_mov_b32 v100, v84
v_mov_b32 v101, v85
v_mov_b32 v102, v86
v_mov_b32 v103, v87
v_mov_b32 v104, v88
v_mov_b32 v105, v89
v_mov_b32 v106, v90
v_mov_b32 v107, v91
v_mov_b32 v108, v92
v_mov_b32 v109, v93
v_mov_b32 v110, v94
v_mov_b32 v111, v95
v_permlane32_swap_b32 v96, v80
v_permlane32_swap_b32 v97, v81
v_permlane32_swap_b32 v98, v82
v_permlane32_swap_b32 v99, v83
v_permlane32_swap_b32 v100, v84
v_permlane32_swap_b32 v101, v85
v_permlane32_swap_b32 v102, v86
v_permlane32_swap_b32 v103, v87
v_permlane32_swap_b32 v104, v88
v_permlane32_swap_b32 v105, v89
v_permlane32_swap_b32 v106, v90
v_permlane32_swap_b32 v107, v91
v_permlane32_swap_b32 v108, v92
v_permlane32_swap_b32 v109, v93
v_permlane32_swap_b32 v110, v94
v_permlane32_swap_b32 v111, v95
v_pk_add_f32 v[80:81], v[80:81], v[96:97]
v_pk_add_f32 v[82:83], v[82:83], v[98:99]
v_pk_add_f32 v[84:85], v[84:85], v[100:101]
v_pk_add_f32 v[86:87], v[86:87], v[102:103]
v_pk_add_f32 v[88:89], v[88:89], v[104:105]
v_pk_add_f32 v[90:91], v[90:91], v[106:107]
v_pk_add_f32 v[92:93], v[92:93], v[108:109]
v_pk_add_f32 v[94:95], v[94:95], v[110:111]
Vc 124,80,81
v_lshlrev_b32_e64 v80, 16, v124
v_and_b32 v81, 0xffff0000, v124
Vc 124,82,83
v_lshlrev_b32_e64 v82, 16, v124
v_and_b32 v83, 0xffff0000, v124
Vc 124,84,85
v_lshlrev_b32_e64 v84, 16, v124
v_and_b32 v85, 0xffff0000, v124
Vc 124,86,87
v_lshlrev_b32_e64 v86, 16, v124
v_and_b32 v87, 0xffff0000, v124
Vc 124,88,89
v_lshlrev_b32_e64 v88, 16, v124
v_and_b32 v89, 0xffff0000, v124
Vc 124,90,91
v_lshlrev_b32_e64 v90, 16, v124
v_and_b32 v91, 0xffff0000, v124
Vc 124,92,93
v_lshlrev_b32_e64 v92, 16, v124
v_and_b32 v93, 0xffff0000, v124
Vc 124,94,95
v_lshlrev_b32_e64 v94, 16, v124
v_and_b32 v95, 0xffff0000, v124
v_mul_f32 v80, s100, v80
v_mul_f32 v81, s100, v81
v_mul_f32 v82, s100, v82
v_mul_f32 v83, s100, v83
v_mul_f32 v84, s100, v84
v_mul_f32 v85, s100, v85
v_mul_f32 v86, s100, v86
v_mul_f32 v87, s100, v87
v_mul_f32 v88, s101, v88
v_mul_f32 v89, s101, v89
v_mul_f32 v90, s101, v90
v_mul_f32 v91, s101, v91
v_mul_f32 v92, s101, v92
v_mul_f32 v93, s101, v93
v_mul_f32 v94, s101, v94
v_mul_f32 v95, s101, v95
Vc 124,80,81
v_lshlrev_b32_e64 v80, 16, v124
v_and_b32 v81, 0xffff0000, v124
Vc 124,82,83
v_lshlrev_b32_e64 v82, 16, v124
v_and_b32 v83, 0xffff0000, v124
Vc 124,84,85
v_lshlrev_b32_e64 v84, 16, v124
v_and_b32 v85, 0xffff0000, v124
Vc 124,86,87
v_lshlrev_b32_e64 v86, 16, v124
v_and_b32 v87, 0xffff0000, v124
Vc 124,88,89
v_lshlrev_b32_e64 v88, 16, v124
v_and_b32 v89, 0xffff0000, v124
Vc 124,90,91
v_lshlrev_b32_e64 v90, 16, v124
v_and_b32 v91, 0xffff0000, v124
Vc 124,92,93
v_lshlrev_b32_e64 v92, 16, v124
v_and_b32 v93, 0xffff0000, v124
Vc 124,94,95
v_lshlrev_b32_e64 v94, 16, v124
v_and_b32 v95, 0xffff0000, v124
s_lshl_b32 s3, s45, 7
s_sub_u32 s42, s42, s3
s_sub_u32 s43, s43, s3
v_add_u32 v124, 0, v120
v_cmp_eq_u32 vcc, s42, v124
v_cmp_eq_u32 s[6:7], s43, v124
s_nop 3
s_or_b64 s[4:5], vcc, s[6:7]
s_cbranch_scc0 L_f_selskip1
v_cndmask_b32 v96, 0, v80, vcc
v_cndmask_b32 v96, v96, v88, s[6:7]
v_cndmask_b32 v97, 0, v81, vcc
v_cndmask_b32 v97, v97, v89, s[6:7]
v_cndmask_b32 v98, 0, v82, vcc
v_cndmask_b32 v98, v98, v90, s[6:7]
v_cndmask_b32 v99, 0, v83, vcc
v_cndmask_b32 v99, v99, v91, s[6:7]
v_cndmask_b32 v100, 0, v84, vcc
v_cndmask_b32 v100, v100, v92, s[6:7]
v_cndmask_b32 v101, 0, v85, vcc
v_cndmask_b32 v101, v101, v93, s[6:7]
v_cndmask_b32 v102, 0, v86, vcc
v_cndmask_b32 v102, v102, v94, s[6:7]
v_cndmask_b32 v103, 0, v87, vcc
v_cndmask_b32 v103, v103, v95, s[6:7]
v_lshlrev_b32_e64 v42, 16, v18
v_and_b32 v43, 0xffff0000, v18
v_lshlrev_b32_e64 v44, 16, v19
v_and_b32 v45, 0xffff0000, v19
v_lshlrev_b32_e64 v46, 16, v20
v_and_b32 v47, 0xffff0000, v20
v_lshlrev_b32_e64 v48, 16, v21
v_and_b32 v49, 0xffff0000, v21
v_pk_add_f32 v[42:43], v[42:43], v[34:35] op_sel_hi:[1,0] neg_lo:[0,1] neg_hi:[0,1]
v_pk_add_f32 v[44:45], v[44:45], v[34:35] op_sel_hi:[1,0] neg_lo:[0,1] neg_hi:[0,1]
v_pk_add_f32 v[46:47], v[46:47], v[34:35] op_sel_hi:[1,0] neg_lo:[0,1] neg_hi:[0,1]
v_pk_add_f32 v[48:49], v[48:49], v[34:35] op_sel_hi:[1,0] neg_lo:[0,1] neg_hi:[0,1]
Vc 2,42,43
v_lshlrev_b32_e64 v42, 16, v2
v_and_b32 v43, 0xffff0000, v2
Vc 3,44,45
v_lshlrev_b32_e64 v44, 16, v3
v_and_b32 v45, 0xffff0000, v3
Vc 4,46,47
v_lshlrev_b32_e64 v46, 16, v4
v_and_b32 v47, 0xffff0000, v4
Vc 5,48,49
v_lshlrev_b32_e64 v48, 16, v5
v_and_b32 v49, 0xffff0000, v5
v_pk_mul_f32 v[42:43], v[42:43], v[34:35] op_sel:[0,1] op_sel_hi:[1,1]
v_pk_mul_f32 v[44:45], v[44:45], v[34:35] op_sel:[0,1] op_sel_hi:[1,1]
v_pk_mul_f32 v[46:47], v[46:47], v[34:35] op_sel:[0,1] op_sel_hi:[1,1]
v_pk_mul_f32 v[48:49], v[48:49], v[34:35] op_sel:[0,1] op_sel_hi:[1,1]
Vc 2,42,43
v_lshlrev_b32_e64 v42, 16, v2
v_and_b32 v43, 0xffff0000, v2
Vc 3,44,45
v_lshlrev_b32_e64 v44, 16, v3
v_and_b32 v45, 0xffff0000, v3
Vc 4,46,47
v_lshlrev_b32_e64 v46, 16, v4
v_and_b32 v47, 0xffff0000, v4
Vc 5,48,49
v_lshlrev_b32_e64 v48, 16, v5
v_and_b32 v49, 0xffff0000, v5
v_pk_add_f32 v[42:43], v[42:43], v[96:97]
v_pk_add_f32 v[44:45], v[44:45], v[98:99]
v_pk_add_f32 v[46:47], v[46:47], v[100:101]
v_pk_add_f32 v[48:49], v[48:49], v[102:103]
Vc 2,42,43
v_lshlrev_b32_e64 v42, 16, v2
v_and_b32 v43, 0xffff0000, v2
Vc 3,44,45
v_lshlrev_b32_e64 v44, 16, v3
v_and_b32 v45, 0xffff0000, v3
Vc 4,46,47
v_lshlrev_b32_e64 v46, 16, v4
v_and_b32 v47, 0xffff0000, v4
Vc 5,48,49
v_lshlrev_b32_e64 v48, 16, v5
v_and_b32 v49, 0xffff0000, v5
v_mul_f32 v2, 0xbfb8aa3b, v42
v_mul_f32 v3, 0xbfb8aa3b, v43
v_mul_f32 v4, 0xbfb8aa3b, v44
v_mul_f32 v5, 0xbfb8aa3b, v45
v_mul_f32 v6, 0xbfb8aa3b, v46
v_mul_f32 v7, 0xbfb8aa3b, v47
v_mul_f32 v8, 0xbfb8aa3b, v48
v_mul_f32 v9, 0xbfb8aa3b, v49
Ve 2,2
Ve 3,3
Ve 4,4
Ve 5,5
Ve 6,6
Ve 7,7
Ve 8,8
Ve 9,9
v_add_f32 v2, 1.0, v2
v_add_f32 v3, 1.0, v3
v_add_f32 v4, 1.0, v4
v_add_f32 v5, 1.0, v5
v_add_f32 v6, 1.0, v6
v_add_f32 v7, 1.0, v7
v_add_f32 v8, 1.0, v8
v_add_f32 v9, 1.0, v9
v_rcp_f32 v2, v2
v_rcp_f32 v3, v3
v_rcp_f32 v4, v4
v_rcp_f32 v5, v5
v_rcp_f32 v6, v6
v_rcp_f32 v7, v7
v_rcp_f32 v8, v8
v_rcp_f32 v9, v9
v_pk_mul_f32 v[42:43], v[42:43], v[2:3]
v_pk_mul_f32 v[44:45], v[44:45], v[4:5]
v_pk_mul_f32 v[46:47], v[46:47], v[6:7]
v_pk_mul_f32 v[48:49], v[48:49], v[8:9]
Vc 2,42,43
v_lshlrev_b32_e64 v42, 16, v2
v_and_b32 v43, 0xffff0000, v2
Vc 3,44,45
v_lshlrev_b32_e64 v44, 16, v3
v_and_b32 v45, 0xffff0000, v3
Vc 4,46,47
v_lshlrev_b32_e64 v46, 16, v4
v_and_b32 v47, 0xffff0000, v4
Vc 5,48,49
v_lshlrev_b32_e64 v48, 16, v5
v_and_b32 v49, 0xffff0000, v5
L_f_selskip1:
v_add_u32 v124, 8, v120
v_cmp_eq_u32 vcc, s42, v124
v_cmp_eq_u32 s[6:7], s43, v124
s_nop 3
s_or_b64 s[4:5], vcc, s[6:7]
s_cbranch_scc0 L_f_selskip2
v_cndmask_b32 v96, 0, v80, vcc
v_cndmask_b32 v96, v96, v88, s[6:7]
v_cndmask_b32 v97, 0, v81, vcc
v_cndmask_b32 v97, v97, v89, s[6:7]
v_cndmask_b32 v98, 0, v82, vcc
v_cndmask_b32 v98, v98, v90, s[6:7]
v_cndmask_b32 v99, 0, v83, vcc
v_cndmask_b32 v99, v99, v91, s[6:7]
v_cndmask_b32 v100, 0, v84, vcc
v_cndmask_b32 v100, v100, v92, s[6:7]
v_cndmask_b32 v101, 0, v85, vcc
v_cndmask_b32 v101, v101, v93, s[6:7]
v_cndmask_b32 v102, 0, v86, vcc
v_cndmask_b32 v102, v102, v94, s[6:7]
v_cndmask_b32 v103, 0, v87, vcc
v_cndmask_b32 v103, v103, v95, s[6:7]
v_lshlrev_b32 v50, 16, v22
v_and_b32 v51, 0xffff0000, v22
v_lshlrev_b32_e64 v52, 16, v23
v_and_b32 v53, 0xffff0000, v23
v_lshlrev_b32_e64 v54, 16, v24
v_and_b32 v55, 0xffff0000, v24
v_lshlrev_b32_e64 v56, 16, v25
v_and_b32 v57, 0xffff0000, v25
v_pk_add_f32 v[50:51], v[50:51], v[36:37] op_sel_hi:[1,0] neg_lo:[0,1] neg_hi:[0,1]
v_pk_add_f32 v[52:53], v[52:53], v[36:37] op_sel_hi:[1,0] neg_lo:[0,1] neg_hi:[0,1]
v_pk_add_f32 v[54:55], v[54:55], v[36:37] op_sel_hi:[1,0] neg_lo:[0,1] neg_hi:[0,1]
v_pk_add_f32 v[56:57], v[56:57], v[36:37] op_sel_hi:[1,0] neg_lo:[0,1] neg_hi:[0,1]
Vc 2,50,51
v_lshlrev_b32_e64 v50, 16, v2
v_and_b32 v51, 0xffff0000, v2
Vc 3,52,53
v_lshlrev_b32_e64 v52, 16, v3
v_and_b32 v53, 0xffff0000, v3
Vc 4,54,55
v_lshlrev_b32_e64 v54, 16, v4
v_and_b32 v55, 0xffff0000, v4
Vc 5,56,57
v_lshlrev_b32_e64 v56, 16, v5
v_and_b32 v57, 0xffff0000, v5
v_pk_mul_f32 v[50:51], v[50:51], v[36:37] op_sel:[0,1] op_sel_hi:[1,1]
v_pk_mul_f32 v[52:53], v[52:53], v[36:37] op_sel:[0,1] op_sel_hi:[1,1]
v_pk_mul_f32 v[54:55], v[54:55], v[36:37] op_sel:[0,1] op_sel_hi:[1,1]
v_pk_mul_f32 v[56:57], v[56:57], v[36:37] op_sel:[0,1] op_sel_hi:[1,1]
Vc 2,50,51
v_lshlrev_b32_e64 v50, 16, v2
v_and_b32 v51, 0xffff0000, v2
Vc 3,52,53
v_lshlrev_b32_e64 v52, 16, v3
v_and_b32 v53, 0xffff0000, v3
Vc 4,54,55
v_lshlrev_b32_e64 v54, 16, v4
v_and_b32 v55, 0xffff0000, v4
Vc 5,56,57
v_lshlrev_b32_e64 v56, 16, v5
v_and_b32 v57, 0xffff0000, v5
v_pk_add_f32 v[50:51], v[50:51], v[96:97]
v_pk_add_f32 v[52:53], v[52:53], v[98:99]
v_pk_add_f32 v[54:55], v[54:55], v[100:101]
v_pk_add_f32 v[56:57], v[56:57], v[102:103]
Vc 2,50,51
v_lshlrev_b32_e64 v50, 16, v2
v_and_b32 v51, 0xffff0000, v2
Vc 3,52,53
v_lshlrev_b32_e64 v52, 16, v3
v_and_b32 v53, 0xffff0000, v3
Vc 4,54,55
v_lshlrev_b32_e64 v54, 16, v4
v_and_b32 v55, 0xffff0000, v4
Vc 5,56,57
v_lshlrev_b32_e64 v56, 16, v5
v_and_b32 v57, 0xffff0000, v5
v_mul_f32 v2, 0xbfb8aa3b, v50
v_mul_f32 v3, 0xbfb8aa3b, v51
v_mul_f32 v4, 0xbfb8aa3b, v52
v_mul_f32 v5, 0xbfb8aa3b, v53
v_mul_f32 v6, 0xbfb8aa3b, v54
v_mul_f32 v7, 0xbfb8aa3b, v55
v_mul_f32 v8, 0xbfb8aa3b, v56
v_mul_f32 v9, 0xbfb8aa3b, v57
Ve 2,2
Ve 3,3
Ve 4,4
Ve 5,5
Ve 6,6
Ve 7,7
Ve 8,8
Ve 9,9
v_add_f32 v2, 1.0, v2
v_add_f32 v3, 1.0, v3
v_add_f32 v4, 1.0, v4
v_add_f32 v5, 1.0, v5
v_add_f32 v6, 1.0, v6
v_add_f32 v7, 1.0, v7
v_add_f32 v8, 1.0, v8
v_add_f32 v9, 1.0, v9
v_rcp_f32 v2, v2
v_rcp_f32 v3, v3
v_rcp_f32 v4, v4
v_rcp_f32 v5, v5
v_rcp_f32 v6, v6
v_rcp_f32 v7, v7
v_rcp_f32 v8, v8
v_rcp_f32 v9, v9
v_pk_mul_f32 v[50:51], v[50:51], v[2:3]
v_pk_mul_f32 v[52:53], v[52:53], v[4:5]
v_pk_mul_f32 v[54:55], v[54:55], v[6:7]
v_pk_mul_f32 v[56:57], v[56:57], v[8:9]
Vc 2,50,51
v_lshlrev_b32_e64 v50, 16, v2
v_and_b32 v51, 0xffff0000, v2
Vc 3,52,53
v_lshlrev_b32_e64 v52, 16, v3
v_and_b32 v53, 0xffff0000, v3
Vc 4,54,55
v_lshlrev_b32_e64 v54, 16, v4
v_and_b32 v55, 0xffff0000, v4
Vc 5,56,57
v_lshlrev_b32_e64 v56, 16, v5
v_and_b32 v57, 0xffff0000, v5
L_f_selskip2:
v_add_u32 v124, 16, v120
v_cmp_eq_u32 vcc, s42, v124
v_cmp_eq_u32 s[6:7], s43, v124
s_nop 3
s_or_b64 s[4:5], vcc, s[6:7]
s_cbranch_scc0 L_f_selskip3
v_cndmask_b32 v96, 0, v80, vcc
v_cndmask_b32 v96, v96, v88, s[6:7]
v_cndmask_b32 v97, 0, v81, vcc
v_cndmask_b32 v97, v97, v89, s[6:7]
v_cndmask_b32 v98, 0, v82, vcc
v_cndmask_b32 v98, v98, v90, s[6:7]
v_cndmask_b32 v99, 0, v83, vcc
v_cndmask_b32 v99, v99, v91, s[6:7]
v_cndmask_b32 v100, 0, v84, vcc
v_cndmask_b32 v100, v100, v92, s[6:7]
v_cndmask_b32 v101, 0, v85, vcc
v_cndmask_b32 v101, v101, v93, s[6:7]
v_cndmask_b32 v102, 0, v86, vcc
v_cndmask_b32 v102, v102, v94, s[6:7]
v_cndmask_b32 v103, 0, v87, vcc
v_cndmask_b32 v103, v103, v95, s[6:7]
v_lshlrev_b32 v58, 16, v26
v_and_b32 v59, 0xffff0000, v26
v_lshlrev_b32_e64 v60, 16, v27
v_and_b32 v61, 0xffff0000, v27
v_lshlrev_b32_e64 v62, 16, v28
v_and_b32 v63, 0xffff0000, v28
v_lshlrev_b32_e64 v64, 16, v29
v_and_b32 v65, 0xffff0000, v29
v_pk_add_f32 v[58:59], v[58:59], v[38:39] op_sel_hi:[1,0] neg_lo:[0,1] neg_hi:[0,1]
v_pk_add_f32 v[60:61], v[60:61], v[38:39] op_sel_hi:[1,0] neg_lo:[0,1] neg_hi:[0,1]
v_pk_add_f32 v[62:63], v[62:63], v[38:39] op_sel_hi:[1,0] neg_lo:[0,1] neg_hi:[0,1]
v_pk_add_f32 v[64:65], v[64:65], v[38:39] op_sel_hi:[1,0] neg_lo:[0,1] neg_hi:[0,1]
Vc 2,58,59
v_lshlrev_b32_e64 v58, 16, v2
v_and_b32 v59, 0xffff0000, v2
Vc 3,60,61
v_lshlrev_b32_e64 v60, 16, v3
v_and_b32 v61, 0xffff0000, v3
Vc 4,62,63
v_lshlrev_b32_e64 v62, 16, v4
v_and_b32 v63, 0xffff0000, v4
Vc 5,64,65
v_lshlrev_b32_e64 v64, 16, v5
v_and_b32 v65, 0xffff0000, v5
v_pk_mul_f32 v[58:59], v[58:59], v[38:39] op_sel:[0,1] op_sel_hi:[1,1]
v_pk_mul_f32 v[60:61], v[60:61], v[38:39] op_sel:[0,1] op_sel_hi:[1,1]
v_pk_mul_f32 v[62:63], v[62:63], v[38:39] op_sel:[0,1] op_sel_hi:[1,1]
v_pk_mul_f32 v[64:65], v[64:65], v[38:39] op_sel:[0,1] op_sel_hi:[1,1]
Vc 2,58,59
v_lshlrev_b32_e64 v58, 16, v2
v_and_b32 v59, 0xffff0000, v2
Vc 3,60,61
v_lshlrev_b32_e64 v60, 16, v3
v_and_b32 v61, 0xffff0000, v3
Vc 4,62,63
v_lshlrev_b32_e64 v62, 16, v4
v_and_b32 v63, 0xffff0000, v4
Vc 5,64,65
v_lshlrev_b32_e64 v64, 16, v5
v_and_b32 v65, 0xffff0000, v5
v_pk_add_f32 v[58:59], v[58:59], v[96:97]
v_pk_add_f32 v[60:61], v[60:61], v[98:99]
v_pk_add_f32 v[62:63], v[62:63], v[100:101]
v_pk_add_f32 v[64:65], v[64:65], v[102:103]
Vc 2,58,59
v_lshlrev_b32_e64 v58, 16, v2
v_and_b32 v59, 0xffff0000, v2
Vc 3,60,61
v_lshlrev_b32_e64 v60, 16, v3
v_and_b32 v61, 0xffff0000, v3
Vc 4,62,63
v_lshlrev_b32_e64 v62, 16, v4
v_and_b32 v63, 0xffff0000, v4
Vc 5,64,65
v_lshlrev_b32_e64 v64, 16, v5
v_and_b32 v65, 0xffff0000, v5
v_mul_f32 v2, 0xbfb8aa3b, v58
v_mul_f32 v3, 0xbfb8aa3b, v59
v_mul_f32 v4, 0xbfb8aa3b, v60
v_mul_f32 v5, 0xbfb8aa3b, v61
v_mul_f32 v6, 0xbfb8aa3b, v62
v_mul_f32 v7, 0xbfb8aa3b, v63
v_mul_f32 v8, 0xbfb8aa3b, v64
v_mul_f32 v9, 0xbfb8aa3b, v65
Ve 2,2
Ve 3,3
Ve 4,4
Ve 5,5
Ve 6,6
Ve 7,7
Ve 8,8
Ve 9,9
v_add_f32 v2, 1.0, v2
v_add_f32 v3, 1.0, v3
v_add_f32 v4, 1.0, v4
v_add_f32 v5, 1.0, v5
v_add_f32 v6, 1.0, v6
v_add_f32 v7, 1.0, v7
v_add_f32 v8, 1.0, v8
v_add_f32 v9, 1.0, v9
v_rcp_f32 v2, v2
v_rcp_f32 v3, v3
v_rcp_f32 v4, v4
v_rcp_f32 v5, v5
v_rcp_f32 v6, v6
v_rcp_f32 v7, v7
v_rcp_f32 v8, v8
v_rcp_f32 v9, v9
v_pk_mul_f32 v[58:59], v[58:59], v[2:3]
v_pk_mul_f32 v[60:61], v[60:61], v[4:5]
v_pk_mul_f32 v[62:63], v[62:63], v[6:7]
v_pk_mul_f32 v[64:65], v[64:65], v[8:9]
Vc 2,58,59
v_lshlrev_b32_e64 v58, 16, v2
v_and_b32 v59, 0xffff0000, v2
Vc 3,60,61
v_lshlrev_b32_e64 v60, 16, v3
v_and_b32 v61, 0xffff0000, v3
Vc 4,62,63
v_lshlrev_b32_e64 v62, 16, v4
v_and_b32 v63, 0xffff0000, v4
Vc 5,64,65
v_lshlrev_b32_e64 v64, 16, v5
v_and_b32 v65, 0xffff0000, v5
L_f_selskip3:
v_add_u32 v124, 24, v120
v_cmp_eq_u32 vcc, s42, v124
v_cmp_eq_u32 s[6:7], s43, v124
s_nop 3
s_or_b64 s[4:5], vcc, s[6:7]
s_cbranch_scc0 L_f_selskip4
v_cndmask_b32 v96, 0, v80, vcc
v_cndmask_b32 v96, v96, v88, s[6:7]
v_cndmask_b32 v97, 0, v81, vcc
v_cndmask_b32 v97, v97, v89, s[6:7]
v_cndmask_b32 v98, 0, v82, vcc
v_cndmask_b32 v98, v98, v90, s[6:7]
v_cndmask_b32 v99, 0, v83, vcc
v_cndmask_b32 v99, v99, v91, s[6:7]
v_cndmask_b32 v100, 0, v84, vcc
v_cndmask_b32 v100, v100, v92, s[6:7]
v_cndmask_b32 v101, 0, v85, vcc
v_cndmask_b32 v101, v101, v93, s[6:7]
v_cndmask_b32 v102, 0, v86, vcc
v_cndmask_b32 v102, v102, v94, s[6:7]
v_cndmask_b32 v103, 0, v87, vcc
v_cndmask_b32 v103, v103, v95, s[6:7]
v_lshlrev_b32 v66, 16, v30
v_and_b32 v67, 0xffff0000, v30
v_lshlrev_b32_e64 v68, 16, v31
v_and_b32 v69, 0xffff0000, v31
v_lshlrev_b32_e64 v70, 16, v32
v_and_b32 v71, 0xffff0000, v32
v_lshlrev_b32_e64 v72, 16, v33
v_and_b32 v73, 0xffff0000, v33
v_pk_add_f32 v[66:67], v[66:67], v[40:41] op_sel_hi:[1,0] neg_lo:[0,1] neg_hi:[0,1]
v_pk_add_f32 v[68:69], v[68:69], v[40:41] op_sel_hi:[1,0] neg_lo:[0,1] neg_hi:[0,1]
v_pk_add_f32 v[70:71], v[70:71], v[40:41] op_sel_hi:[1,0] neg_lo:[0,1] neg_hi:[0,1]
v_pk_add_f32 v[72:73], v[72:73], v[40:41] op_sel_hi:[1,0] neg_lo:[0,1] neg_hi:[0,1]
Vc 2,66,67
v_lshlrev_b32_e64 v66, 16, v2
v_and_b32 v67, 0xffff0000, v2
Vc 3,68,69
v_lshlrev_b32_e64 v68, 16, v3
v_and_b32 v69, 0xffff0000, v3
Vc 4,70,71
v_lshlrev_b32_e64 v70, 16, v4
v_and_b32 v71, 0xffff0000, v4
Vc 5,72,73
v_lshlrev_b32_e64 v72, 16, v5
v_and_b32 v73, 0xffff0000, v5
v_pk_mul_f32 v[66:67], v[66:67], v[40:41] op_sel:[0,1] op_sel_hi:[1,1]
v_pk_mul_f32 v[68:69], v[68:69], v[40:41] op_sel:[0,1] op_sel_hi:[1,1]
v_pk_mul_f32 v[70:71], v[70:71], v[40:41] op_sel:[0,1] op_sel_hi:[1,1]
v_pk_mul_f32 v[72:73], v[72:73], v[40:41] op_sel:[0,1] op_sel_hi:[1,1]
Vc 2,66,67
v_lshlrev_b32_e64 v66, 16, v2
v_and_b32 v67, 0xffff0000, v2
Vc 3,68,69
v_lshlrev_b32_e64 v68, 16, v3
v_and_b32 v69, 0xffff0000, v3
Vc 4,70,71
v_lshlrev_b32_e64 v70, 16, v4
v_and_b32 v71, 0xffff0000, v4
Vc 5,72,73
v_lshlrev_b32_e64 v72, 16, v5
v_and_b32 v73, 0xffff0000, v5
v_pk_add_f32 v[66:67], v[66:67], v[96:97]
v_pk_add_f32 v[68:69], v[68:69], v[98:99]
v_pk_add_f32 v[70:71], v[70:71], v[100:101]
v_pk_add_f32 v[72:73], v[72:73], v[102:103]
Vc 2,66,67
v_lshlrev_b32_e64 v66, 16, v2
v_and_b32 v67, 0xffff0000, v2
Vc 3,68,69
v_lshlrev_b32_e64 v68, 16, v3
v_and_b32 v69, 0xffff0000, v3
Vc 4,70,71
v_lshlrev_b32_e64 v70, 16, v4
v_and_b32 v71, 0xffff0000, v4
Vc 5,72,73
v_lshlrev_b32_e64 v72, 16, v5
v_and_b32 v73, 0xffff0000, v5
v_mul_f32 v2, 0xbfb8aa3b, v66
v_mul_f32 v3, 0xbfb8aa3b, v67
v_mul_f32 v4, 0xbfb8aa3b, v68
v_mul_f32 v5, 0xbfb8aa3b, v69
v_mul_f32 v6, 0xbfb8aa3b, v70
v_mul_f32 v7, 0xbfb8aa3b, v71
v_mul_f32 v8, 0xbfb8aa3b, v72
v_mul_f32 v9, 0xbfb8aa3b, v73
Ve 2,2
Ve 3,3
Ve 4,4
Ve 5,5
Ve 6,6
Ve 7,7
Ve 8,8
Ve 9,9
v_add_f32 v2, 1.0, v2
v_add_f32 v3, 1.0, v3
v_add_f32 v4, 1.0, v4
v_add_f32 v5, 1.0, v5
v_add_f32 v6, 1.0, v6
v_add_f32 v7, 1.0, v7
v_add_f32 v8, 1.0, v8
v_add_f32 v9, 1.0, v9
v_rcp_f32 v2, v2
v_rcp_f32 v3, v3
v_rcp_f32 v4, v4
v_rcp_f32 v5, v5
v_rcp_f32 v6, v6
v_rcp_f32 v7, v7
v_rcp_f32 v8, v8
v_rcp_f32 v9, v9
v_pk_mul_f32 v[66:67], v[66:67], v[2:3]
v_pk_mul_f32 v[68:69], v[68:69], v[4:5]
v_pk_mul_f32 v[70:71], v[70:71], v[6:7]
v_pk_mul_f32 v[72:73], v[72:73], v[8:9]
Vc 2,66,67
v_lshlrev_b32_e64 v66, 16, v2
v_and_b32 v67, 0xffff0000, v2
Vc 3,68,69
v_lshlrev_b32_e64 v68, 16, v3
v_and_b32 v69, 0xffff0000, v3
Vc 4,70,71
v_lshlrev_b32_e64 v70, 16, v4
v_and_b32 v71, 0xffff0000, v4
Vc 5,72,73
v_lshlrev_b32_e64 v72, 16, v5
v_and_b32 v73, 0xffff0000, v5
L_f_selskip4:
s_branch L_yCr
L_p4_end:
L_spinAk:
s_mov_b32 s47, 0x400000
L_spinAk_l:
s_sleep 8
buffer_load_dword v30, v31, s[28:31], 0 offen sc1
s_waitcnt vmcnt(0)
v_readfirstlane_b32 s3, v30
s_sub_u32 s47, s47, 1
s_cmp_eq_u32 s47, 0
s_cbranch_scc1 L_spinArk
s_cmp_lt_u32 s3, 256
s_cbranch_scc1 L_spinAk_l
s_branch L_spinArk
L_spinAv:
s_mov_b32 s47, 0x400000
L_spinAv_l:
s_sleep 8
buffer_load_dword v30, v31, s[28:31], 0 offen sc1
s_waitcnt vmcnt(0)
v_readfirstlane_b32 s3, v30
s_sub_u32 s47, s47, 1
s_cmp_eq_u32 s47, 0
s_cbranch_scc1 L_spinArv
s_cmp_lt_u32 s3, 256
s_cbranch_scc1 L_spinAv_l
s_branch L_spinArv
L_spinB:
s_mov_b32 s59, 0x400000
L_spinB_l:
s_sleep 4
buffer_load_dword v12, v1, s[20:23], s6 offen sc1
s_sub_u32 s59, s59, 1
s_cmp_eq_u32 s59, 0
s_cbranch_scc1 L_spinBx
s_waitcnt vmcnt(0)
v_cmp_ne_u32 vcc, 1, v12
s_cbranch_vccnz L_spinB_l
L_spinBx:
s_waitcnt vmcnt(0)
s_branch L_spinBr
L_k2_fb_we:
s_nop 7
s_nop 0
v_max3_f32 v21, v128, v129, v130
v_max3_f32 v21, v21, v131, v132
v_max3_f32 v21, v21, v133, v134
v_max3_f32 v21, v21, v135, v136
v_max3_f32 v21, v21, v137, v138
v_max3_f32 v21, v21, v139, v140
v_max3_f32 v21, v21, v141, v142
v_max_f32 v21, v21, v143
v_mov_b32 v1, v21
s_nop 1
v_permlane16_swap_b32 v1, v21
v_max_f32 v21, v21, v1
v_mov_b32 v1, v21
s_nop 1
v_permlane32_swap_b32 v1, v21
v_max_f32_e64 v21, v21, v1
v_add_f32 v21, 0x41f80000, v21
v_max_f32 v21, 0, v21
Vs 128,128,21
Vs 129,129,21
Vs 130,130,21
Vs 131,131,21
Vs 132,132,21
Vs 133,133,21
Vs 134,134,21
Vs 135,135,21
Vs 136,136,21
Vs 137,137,21
Vs 138,138,21
Vs 139,139,21
Vs 140,140,21
Vs 141,141,21
Vs 142,142,21
Vs 143,143,21
Vs 192,192,21
Vs 193,193,21
Vs 194,194,21
Vs 195,195,21
Vs 196,196,21
Vs 197,197,21
Vs 198,198,21
Vs 199,199,21
Vs 200,200,21
Vs 201,201,21
Vs 202,202,21
Vs 203,203,21
Vs 204,204,21
Vs 205,205,21
Vs 206,206,21
Vs 207,207,21
Vs 32,32,21
Vs 33,33,21
Vs 34,34,21
v_sub_f32_e64 v35, v35, v21
v_exp_f32 v22, -v21
s_nop 0
Vm 48,48,22
Vm 49,49,22
Vm 50,50,22
v_mul_f32_e64 v51, v51, v22
Ar 8,0
Ar 9,1
Ar 10,2
Ar 11,3
Ar 12,4
Ar 13,5
Ar 14,6
Ar 15,7
Vm 8,8,22
Vm 9,9,22
Vm 10,10,22
Vm 11,11,22
Vm 12,12,22
Vm 13,13,22
Vm 14,14,22
Vm 15,15,22
Aw 0,8
Aw 1,9
Aw 2,10
Aw 3,11
Aw 4,12
Aw 5,13
Aw 6,14
Aw 7,15
Ar 8,8
Ar 9,9
Ar 10,10
Ar 11,11
Ar 12,12
Ar 13,13
Ar 14,14
Ar 15,15
Vm 8,8,22
Vm 9,9,22
Vm 10,10,22
Vm 11,11,22
Vm 12,12,22
Vm 13,13,22
Vm 14,14,22
Vm 15,15,22
Aw 8,8
Aw 9,9
Aw 10,10
Aw 11,11
Aw 12,12
Aw 13,13
Aw 14,14
Aw 15,15
Ar 8,16
Ar 9,17
Ar 10,18
Ar 11,19
Ar 12,20
Ar 13,21
Ar 14,22
Ar 15,23
Vm 8,8,22
Vm 9,9,22
Vm 10,10,22
Vm 11,11,22
Vm 12,12,22
Vm 13,13,22
Vm 14,14,22
Vm 15,15,22
Aw 16,8
Aw 17,9
Aw 18,10
Aw 19,11
Aw 20,12
Aw 21,13
Aw 22,14
Aw 23,15
Ar 8,24
Ar 9,25
Ar 10,26
Ar 11,27
Ar 12,28
Ar 13,29
Ar 14,30
Ar 15,31
Vm 8,8,22
Vm 9,9,22
Vm 10,10,22
Vm 11,11,22
Vm 12,12,22
Vm 13,13,22
Vm 14,14,22
Vm 15,15,22
Aw 24,8
Aw 25,9
Aw 26,10
Aw 27,11
Aw 28,12
Aw 29,13
Aw 30,14
Aw 31,15
v_max3_f32 v21, v144, v145, v146
v_max3_f32 v21, v21, v147, v148
v_max3_f32 v21, v21, v149, v150
v_max3_f32 v21, v21, v151, v152
v_max3_f32 v21, v21, v153, v154
v_max3_f32 v21, v21, v155, v156
v_max3_f32 v21, v21, v157, v158
v_max_f32 v21, v21, v159
v_mov_b32 v1, v21
s_nop 1
v_permlane16_swap_b32 v1, v21
v_max_f32 v21, v21, v1
v_mov_b32 v1, v21
s_nop 1
v_permlane32_swap_b32 v1, v21
v_max_f32_e64 v21, v21, v1
v_add_f32 v21, 0x41f80000, v21
v_max_f32 v21, 0, v21
Vs 144,144,21
Vs 145,145,21
Vs 146,146,21
Vs 147,147,21
Vs 148,148,21
Vs 149,149,21
Vs 150,150,21
Vs 151,151,21
Vs 152,152,21
Vs 153,153,21
Vs 154,154,21
Vs 155,155,21
Vs 156,156,21
Vs 157,157,21
Vs 158,158,21
Vs 159,159,21
Vs 208,208,21
Vs 209,209,21
Vs 210,210,21
Vs 211,211,21
Vs 212,212,21
Vs 213,213,21
Vs 214,214,21
Vs 215,215,21
Vs 216,216,21
Vs 217,217,21
Vs 218,218,21
Vs 219,219,21
Vs 220,220,21
Vs 221,221,21
Vs 222,222,21
Vs 223,223,21
Vs 36,36,21
Vs 37,37,21
Vs 38,38,21
v_sub_f32_e64 v39, v39, v21
v_exp_f32 v22, -v21
s_nop 0
Vm 52,52,22
Vm 53,53,22
Vm 54,54,22
v_mul_f32_e64 v55, v55, v22
Ar 8,32
Ar 9,33
Ar 10,34
Ar 11,35
Ar 12,36
Ar 13,37
Ar 14,38
Ar 15,39
Vm 8,8,22
Vm 9,9,22
Vm 10,10,22
Vm 11,11,22
Vm 12,12,22
Vm 13,13,22
Vm 14,14,22
Vm 15,15,22
Aw 32,8
Aw 33,9
Aw 34,10
Aw 35,11
Aw 36,12
Aw 37,13
Aw 38,14
Aw 39,15
Ar 8,40
Ar 9,41
Ar 10,42
Ar 11,43
Ar 12,44
Ar 13,45
Ar 14,46
Ar 15,47
Vm 8,8,22
Vm 9,9,22
Vm 10,10,22
Vm 11,11,22
Vm 12,12,22
Vm 13,13,22
Vm 14,14,22
Vm 15,15,22
Aw 40,8
Aw 41,9
Aw 42,10
Aw 43,11
Aw 44,12
Aw 45,13
Aw 46,14
Aw 47,15
Ar 8,48
Ar 9,49
Ar 10,50
Ar 11,51
Ar 12,52
Ar 13,53
Ar 14,54
Ar 15,55
Vm 8,8,22
Vm 9,9,22
Vm 10,10,22
Vm 11,11,22
Vm 12,12,22
Vm 13,13,22
Vm 14,14,22
Vm 15,15,22
Aw 48,8
Aw 49,9
Aw 50,10
Aw 51,11
Aw 52,12
Aw 53,13
Aw 54,14
Aw 55,15
Ar 8,56
Ar 9,57
Ar 10,58
Ar 11,59
Ar 12,60
Ar 13,61
Ar 14,62
Ar 15,63
Vm 8,8,22
Vm 9,9,22
Vm 10,10,22
Vm 11,11,22
Vm 12,12,22
Vm 13,13,22
Vm 14,14,22
Vm 15,15,22
Aw 56,8
Aw 57,9
Aw 58,10
Aw 59,11
Aw 60,12
Aw 61,13
Aw 62,14
Aw 63,15
v_max3_f32 v21, v160, v161, v162
v_max3_f32 v21, v21, v163, v164
v_max3_f32 v21, v21, v165, v166
v_max3_f32 v21, v21, v167, v168
v_max3_f32 v21, v21, v169, v170
v_max3_f32 v21, v21, v171, v172
v_max3_f32 v21, v21, v173, v174
v_max_f32 v21, v21, v175
v_mov_b32 v1, v21
s_nop 1
v_permlane16_swap_b32 v1, v21
v_max_f32 v21, v21, v1
v_mov_b32 v1, v21
s_nop 1
v_permlane32_swap_b32 v1, v21
v_max_f32_e64 v21, v21, v1
v_add_f32 v21, 0x41f80000, v21
v_max_f32 v21, 0, v21
Vs 160,160,21
Vs 161,161,21
Vs 162,162,21
Vs 163,163,21
Vs 164,164,21
Vs 165,165,21
Vs 166,166,21
Vs 167,167,21
Vs 168,168,21
Vs 169,169,21
Vs 170,170,21
Vs 171,171,21
Vs 172,172,21
Vs 173,173,21
Vs 174,174,21
Vs 175,175,21
Vs 224,224,21
Vs 225,225,21
Vs 226,226,21
Vs 227,227,21
Vs 228,228,21
Vs 229,229,21
Vs 230,230,21
Vs 231,231,21
Vs 232,232,21
Vs 233,233,21
Vs 234,234,21
Vs 235,235,21
Vs 236,236,21
Vs 237,237,21
Vs 238,238,21
Vs 239,239,21
Vs 40,40,21
Vs 41,41,21
Vs 42,42,21
v_sub_f32_e64 v43, v43, v21
v_exp_f32 v22, -v21
s_nop 0
Vm 56,56,22
Vm 57,57,22
Vm 58,58,22
v_mul_f32_e64 v59, v59, v22
Ar 8,64
Ar 9,65
Ar 10,66
Ar 11,67
Ar 12,68
Ar 13,69
Ar 14,70
Ar 15,71
Vm 8,8,22
Vm 9,9,22
Vm 10,10,22
Vm 11,11,22
Vm 12,12,22
Vm 13,13,22
Vm 14,14,22
Vm 15,15,22
Aw 64,8
Aw 65,9
Aw 66,10
Aw 67,11
Aw 68,12
Aw 69,13
Aw 70,14
Aw 71,15
Ar 8,72
Ar 9,73
Ar 10,74
Ar 11,75
Ar 12,76
Ar 13,77
Ar 14,78
Ar 15,79
Vm 8,8,22
Vm 9,9,22
Vm 10,10,22
Vm 11,11,22
Vm 12,12,22
Vm 13,13,22
Vm 14,14,22
Vm 15,15,22
Aw 72,8
Aw 73,9
Aw 74,10
Aw 75,11
Aw 76,12
Aw 77,13
Aw 78,14
Aw 79,15
Ar 8,80
Ar 9,81
Ar 10,82
Ar 11,83
Ar 12,84
Ar 13,85
Ar 14,86
Ar 15,87
Vm 8,8,22
Vm 9,9,22
Vm 10,10,22
Vm 11,11,22
Vm 12,12,22
Vm 13,13,22
Vm 14,14,22
Vm 15,15,22
Aw 80,8
Aw 81,9
Aw 82,10
Aw 83,11
Aw 84,12
Aw 85,13
Aw 86,14
Aw 87,15
Ar 8,88
Ar 9,89
Ar 10,90
Ar 11,91
Ar 12,92
Ar 13,93
Ar 14,94
Ar 15,95
Vm 8,8,22
Vm 9,9,22
Vm 10,10,22
Vm 11,11,22
Vm 12,12,22
Vm 13,13,22
Vm 14,14,22
Vm 15,15,22
Aw 88,8
Aw 89,9
Aw 90,10
Aw 91,11
Aw 92,12
Aw 93,13
Aw 94,14
Aw 95,15
v_max3_f32 v21, v176, v177, v178
v_max3_f32 v21, v21, v179, v180
v_max3_f32 v21, v21, v181, v182
v_max3_f32 v21, v21, v183, v184
v_max3_f32 v21, v21, v185, v186
v_max3_f32 v21, v21, v187, v188
v_max3_f32 v21, v21, v189, v190
v_max_f32 v21, v21, v191
v_mov_b32 v1, v21
s_nop 1
v_permlane16_swap_b32 v1, v21
v_max_f32 v21, v21, v1
v_mov_b32 v1, v21
s_nop 1
v_permlane32_swap_b32 v1, v21
v_max_f32_e64 v21, v21, v1
v_add_f32 v21, 0x41f80000, v21
v_max_f32 v21, 0, v21
Vs 176,176,21
Vs 177,177,21
Vs 178,178,21
Vs 179,179,21
Vs 180,180,21
Vs 181,181,21
Vs 182,182,21
Vs 183,183,21
Vs 184,184,21
Vs 185,185,21
Vs 186,186,21
Vs 187,187,21
Vs 188,188,21
Vs 189,189,21
Vs 190,190,21
Vs 191,191,21
Vs 240,240,21
Vs 241,241,21
Vs 242,242,21
Vs 243,243,21
Vs 244,244,21
Vs 245,245,21
Vs 246,246,21
Vs 247,247,21
Vs 248,248,21
Vs 249,249,21
Vs 250,250,21
Vs 251,251,21
Vs 252,252,21
Vs 253,253,21
Vs 254,254,21
Vs 255,255,21
Vs 44,44,21
Vs 45,45,21
Vs 46,46,21
v_sub_f32_e64 v47, v47, v21
v_exp_f32 v22, -v21
s_nop 0
Vm 60,60,22
Vm 61,61,22
Vm 62,62,22
v_mul_f32_e64 v63, v63, v22
Ar 8,96
Ar 9,97
Ar 10,98
Ar 11,99
Ar 12,100
Ar 13,101
Ar 14,102
Ar 15,103
Vm 8,8,22
Vm 9,9,22
Vm 10,10,22
Vm 11,11,22
Vm 12,12,22
Vm 13,13,22
Vm 14,14,22
Vm 15,15,22
Aw 96,8
Aw 97,9
Aw 98,10
Aw 99,11
Aw 100,12
Aw 101,13
Aw 102,14
Aw 103,15
Ar 8,104
Ar 9,105
Ar 10,106
Ar 11,107
Ar 12,108
Ar 13,109
Ar 14,110
Ar 15,111
Vm 8,8,22
Vm 9,9,22
Vm 10,10,22
Vm 11,11,22
Vm 12,12,22
Vm 13,13,22
Vm 14,14,22
Vm 15,15,22
Aw 104,8
Aw 105,9
Aw 106,10
Aw 107,11
Aw 108,12
Aw 109,13
Aw 110,14
Aw 111,15
Ar 8,112
Ar 9,113
Ar 10,114
Ar 11,115
Ar 12,116
Ar 13,117
Ar 14,118
Ar 15,119
Vm 8,8,22
Vm 9,9,22
Vm 10,10,22
Vm 11,11,22
Vm 12,12,22
Vm 13,13,22
Vm 14,14,22
Vm 15,15,22
Aw 112,8
Aw 113,9
Aw 114,10
Aw 115,11
Aw 116,12
Aw 117,13
Aw 118,14
Aw 119,15
Ar 8,120
Ar 9,121
Ar 10,122
Ar 11,123
Ar 12,124
Ar 13,125
Ar 14,126
Ar 15,127
Vm 8,8,22
Vm 9,9,22
Vm 10,10,22
Vm 11,11,22
Vm 12,12,22
Vm 13,13,22
Vm 14,14,22
Vm 15,15,22
Aw 120,8
Aw 121,9
Aw 122,10
Aw 123,11
Aw 124,12
Aw 125,13
Aw 126,14
Aw 127,15
Ve 8,128
Ve 9,129
s_nop 0
Vc 64,8,9
Ve 8,130
Ve 9,131
s_nop 0
Vc 65,8,9
Ve 8,144
Ve 9,145
s_nop 0
Vc 72,8,9
Ve 8,146
Ve 9,147
s_nop 0
Vc 73,8,9
Ve 8,160
Ve 9,161
s_nop 0
Vc 80,8,9
Ve 8,162
Ve 9,163
s_nop 0
Vc 81,8,9
Ve 8,176
Ve 9,177
s_nop 0
Vc 88,8,9
Ve 8,178
Ve 9,179
s_nop 0
Vc 89,8,9
Ve 8,132
Ve 9,133
s_nop 0
Vc 66,8,9
Ve 8,134
Ve 9,135
s_nop 0
Vc 67,8,9
Ve 8,148
Ve 9,149
s_nop 0
Vc 74,8,9
Ve 8,150
Ve 9,151
s_nop 0
Vc 75,8,9
Ve 8,164
Ve 9,165
s_nop 0
Vc 82,8,9
Ve 8,166
Ve 9,167
s_nop 0
Vc 83,8,9
Ve 8,180
Ve 9,181
s_nop 0
Vc 90,8,9
Ve 8,182
Ve 9,183
s_nop 0
Vc 91,8,9
Ve 8,136
Ve 9,137
s_nop 0
Vc 68,8,9
Ve 8,138
Ve 9,139
s_nop 0
Vc 69,8,9
Ve 8,152
Ve 9,153
s_nop 0
Vc 76,8,9
Ve 8,154
Ve 9,155
s_nop 0
Vc 77,8,9
Ve 8,168
Ve 9,169
s_nop 0
Vc 84,8,9
Ve 8,170
Ve 9,171
s_nop 0
Vc 85,8,9
Ve 8,184
Ve 9,185
s_nop 0
Vc 92,8,9
Ve 8,186
Ve 9,187
s_nop 0
Vc 93,8,9
Ve 8,140
Ve 9,141
s_nop 0
Vc 70,8,9
Ve 8,142
Ve 9,143
s_nop 0
Vc 71,8,9
Ve 8,156
Ve 9,157
s_nop 0
Vc 78,8,9
Ve 8,158
Ve 9,159
s_nop 0
Vc 79,8,9
Ve 8,172
Ve 9,173
s_nop 0
Vc 86,8,9
Ve 8,174
Ve 9,175
s_nop 0
Vc 87,8,9
Ve 8,188
Ve 9,189
s_nop 0
Vc 94,8,9
Ve 8,190
Ve 9,191
s_nop 0
Vc 95,8,9
s_nop 1
s_branch L_k2_fbr_we
L_k2_fb_wo:
s_nop 7
s_nop 0
v_max3_f32 v21, v192, v193, v194
v_max3_f32 v21, v21, v195, v196
v_max3_f32 v21, v21, v197, v198
v_max3_f32 v21, v21, v199, v200
v_max3_f32 v21, v21, v201, v202
v_max3_f32 v21, v21, v203, v204
v_max3_f32 v21, v21, v205, v206
v_max_f32 v21, v21, v207
v_mov_b32 v1, v21
s_nop 1
v_permlane16_swap_b32 v1, v21
v_max_f32 v21, v21, v1
v_mov_b32 v1, v21
s_nop 1
v_permlane32_swap_b32 v1, v21
v_max_f32_e64 v21, v21, v1
v_add_f32 v21, 0x41f80000, v21
v_max_f32 v21, 0, v21
Vs 192,192,21
Vs 193,193,21
Vs 194,194,21
Vs 195,195,21
Vs 196,196,21
Vs 197,197,21
Vs 198,198,21
Vs 199,199,21
Vs 200,200,21
Vs 201,201,21
Vs 202,202,21
Vs 203,203,21
Vs 204,204,21
Vs 205,205,21
Vs 206,206,21
Vs 207,207,21
Vs 128,128,21
Vs 129,129,21
Vs 130,130,21
Vs 131,131,21
Vs 132,132,21
Vs 133,133,21
Vs 134,134,21
Vs 135,135,21
Vs 136,136,21
Vs 137,137,21
Vs 138,138,21
Vs 139,139,21
Vs 140,140,21
Vs 141,141,21
Vs 142,142,21
Vs 143,143,21
Vs 32,32,21
Vs 33,33,21
Vs 34,34,21
v_sub_f32_e64 v35, v35, v21
v_exp_f32 v22, -v21
s_nop 0
Vm 48,48,22
Vm 49,49,22
Vm 50,50,22
v_mul_f32_e64 v51, v51, v22
Ar 8,0
Ar 9,1
Ar 10,2
Ar 11,3
Ar 12,4
Ar 13,5
Ar 14,6
Ar 15,7
Vm 8,8,22
Vm 9,9,22
Vm 10,10,22
Vm 11,11,22
Vm 12,12,22
Vm 13,13,22
Vm 14,14,22
Vm 15,15,22
Aw 0,8
Aw 1,9
Aw 2,10
Aw 3,11
Aw 4,12
Aw 5,13
Aw 6,14
Aw 7,15
Ar 8,8
Ar 9,9
Ar 10,10
Ar 11,11
Ar 12,12
Ar 13,13
Ar 14,14
Ar 15,15
Vm 8,8,22
Vm 9,9,22
Vm 10,10,22
Vm 11,11,22
Vm 12,12,22
Vm 13,13,22
Vm 14,14,22
Vm 15,15,22
Aw 8,8
Aw 9,9
Aw 10,10
Aw 11,11
Aw 12,12
Aw 13,13
Aw 14,14
Aw 15,15
Ar 8,16
Ar 9,17
Ar 10,18
Ar 11,19
Ar 12,20
Ar 13,21
Ar 14,22
Ar 15,23
Vm 8,8,22
Vm 9,9,22
Vm 10,10,22
Vm 11,11,22
Vm 12,12,22
Vm 13,13,22
Vm 14,14,22
Vm 15,15,22
Aw 16,8
Aw 17,9
Aw 18,10
Aw 19,11
Aw 20,12
Aw 21,13
Aw 22,14
Aw 23,15
Ar 8,24
Ar 9,25
Ar 10,26
Ar 11,27
Ar 12,28
Ar 13,29
Ar 14,30
Ar 15,31
Vm 8,8,22
Vm 9,9,22
Vm 10,10,22
Vm 11,11,22
Vm 12,12,22
Vm 13,13,22
Vm 14,14,22
Vm 15,15,22
Aw 24,8
Aw 25,9
Aw 26,10
Aw 27,11
Aw 28,12
Aw 29,13
Aw 30,14
Aw 31,15
v_max3_f32 v21, v208, v209, v210
v_max3_f32 v21, v21, v211, v212
v_max3_f32 v21, v21, v213, v214
v_max3_f32 v21, v21, v215, v216
v_max3_f32 v21, v21, v217, v218
v_max3_f32 v21, v21, v219, v220
v_max3_f32 v21, v21, v221, v222
v_max_f32 v21, v21, v223
v_mov_b32 v1, v21
s_nop 1
v_permlane16_swap_b32 v1, v21
v_max_f32 v21, v21, v1
v_mov_b32 v1, v21
s_nop 1
v_permlane32_swap_b32 v1, v21
v_max_f32_e64 v21, v21, v1
v_add_f32 v21, 0x41f80000, v21
v_max_f32 v21, 0, v21
Vs 208,208,21
Vs 209,209,21
Vs 210,210,21
Vs 211,211,21
Vs 212,212,21
Vs 213,213,21
Vs 214,214,21
Vs 215,215,21
Vs 216,216,21
Vs 217,217,21
Vs 218,218,21
Vs 219,219,21
Vs 220,220,21
Vs 221,221,21
Vs 222,222,21
Vs 223,223,21
Vs 144,144,21
Vs 145,145,21
Vs 146,146,21
Vs 147,147,21
Vs 148,148,21
Vs 149,149,21
Vs 150,150,21
Vs 151,151,21
Vs 152,152,21
Vs 153,153,21
Vs 154,154,21
Vs 155,155,21
Vs 156,156,21
Vs 157,157,21
Vs 158,158,21
Vs 159,159,21
Vs 36,36,21
Vs 37,37,21
Vs 38,38,21
v_sub_f32_e64 v39, v39, v21
v_exp_f32 v22, -v21
s_nop 0
Vm 52,52,22
Vm 53,53,22
Vm 54,54,22
v_mul_f32_e64 v55, v55, v22
Ar 8,32
Ar 9,33
Ar 10,34
Ar 11,35
Ar 12,36
Ar 13,37
Ar 14,38
Ar 15,39
Vm 8,8,22
Vm 9,9,22
Vm 10,10,22
Vm 11,11,22
Vm 12,12,22
Vm 13,13,22
Vm 14,14,22
Vm 15,15,22
Aw 32,8
Aw 33,9
Aw 34,10
Aw 35,11
Aw 36,12
Aw 37,13
Aw 38,14
Aw 39,15
Ar 8,40
Ar 9,41
Ar 10,42
Ar 11,43
Ar 12,44
Ar 13,45
Ar 14,46
Ar 15,47
Vm 8,8,22
Vm 9,9,22
Vm 10,10,22
Vm 11,11,22
Vm 12,12,22
Vm 13,13,22
Vm 14,14,22
Vm 15,15,22
Aw 40,8
Aw 41,9
Aw 42,10
Aw 43,11
Aw 44,12
Aw 45,13
Aw 46,14
Aw 47,15
Ar 8,48
Ar 9,49
Ar 10,50
Ar 11,51
Ar 12,52
Ar 13,53
Ar 14,54
Ar 15,55
Vm 8,8,22
Vm 9,9,22
Vm 10,10,22
Vm 11,11,22
Vm 12,12,22
Vm 13,13,22
Vm 14,14,22
Vm 15,15,22
Aw 48,8
Aw 49,9
Aw 50,10
Aw 51,11
Aw 52,12
Aw 53,13
Aw 54,14
Aw 55,15
Ar 8,56
Ar 9,57
Ar 10,58
Ar 11,59
Ar 12,60
Ar 13,61
Ar 14,62
Ar 15,63
Vm 8,8,22
Vm 9,9,22
Vm 10,10,22
Vm 11,11,22
Vm 12,12,22
Vm 13,13,22
Vm 14,14,22
Vm 15,15,22
Aw 56,8
Aw 57,9
Aw 58,10
Aw 59,11
Aw 60,12
Aw 61,13
Aw 62,14
Aw 63,15
v_max3_f32 v21, v224, v225, v226
v_max3_f32 v21, v21, v227, v228
v_max3_f32 v21, v21, v229, v230
v_max3_f32 v21, v21, v231, v232
v_max3_f32 v21, v21, v233, v234
v_max3_f32 v21, v21, v235, v236
v_max3_f32 v21, v21, v237, v238
v_max_f32 v21, v21, v239
v_mov_b32 v1, v21
s_nop 1
v_permlane16_swap_b32 v1, v21
v_max_f32 v21, v21, v1
v_mov_b32 v1, v21
s_nop 1
v_permlane32_swap_b32 v1, v21
v_max_f32_e64 v21, v21, v1
v_add_f32 v21, 0x41f80000, v21
v_max_f32 v21, 0, v21
Vs 224,224,21
Vs 225,225,21
Vs 226,226,21
Vs 227,227,21
Vs 228,228,21
Vs 229,229,21
Vs 230,230,21
Vs 231,231,21
Vs 232,232,21
Vs 233,233,21
Vs 234,234,21
Vs 235,235,21
Vs 236,236,21
Vs 237,237,21
Vs 238,238,21
Vs 239,239,21
Vs 160,160,21
Vs 161,161,21
Vs 162,162,21
Vs 163,163,21
Vs 164,164,21
Vs 165,165,21
Vs 166,166,21
Vs 167,167,21
Vs 168,168,21
Vs 169,169,21
Vs 170,170,21
Vs 171,171,21
Vs 172,172,21
Vs 173,173,21
Vs 174,174,21
Vs 175,175,21
Vs 40,40,21
Vs 41,41,21
Vs 42,42,21
v_sub_f32_e64 v43, v43, v21
v_exp_f32 v22, -v21
s_nop 0
Vm 56,56,22
Vm 57,57,22
Vm 58,58,22
v_mul_f32_e64 v59, v59, v22
Ar 8,64
Ar 9,65
Ar 10,66
Ar 11,67
Ar 12,68
Ar 13,69
Ar 14,70
Ar 15,71
Vm 8,8,22
Vm 9,9,22
Vm 10,10,22
Vm 11,11,22
Vm 12,12,22
Vm 13,13,22
Vm 14,14,22
Vm 15,15,22
Aw 64,8
Aw 65,9
Aw 66,10
Aw 67,11
Aw 68,12
Aw 69,13
Aw 70,14
Aw 71,15
Ar 8,72
Ar 9,73
Ar 10,74
Ar 11,75
Ar 12,76
Ar 13,77
Ar 14,78
Ar 15,79
Vm 8,8,22
Vm 9,9,22
Vm 10,10,22
Vm 11,11,22
Vm 12,12,22
Vm 13,13,22
Vm 14,14,22
Vm 15,15,22
Aw 72,8
Aw 73,9
Aw 74,10
Aw 75,11
Aw 76,12
Aw 77,13
Aw 78,14
Aw 79,15
Ar 8,80
Ar 9,81
Ar 10,82
Ar 11,83
Ar 12,84
Ar 13,85
Ar 14,86
Ar 15,87
Vm 8,8,22
Vm 9,9,22
Vm 10,10,22
Vm 11,11,22
Vm 12,12,22
Vm 13,13,22
Vm 14,14,22
Vm 15,15,22
Aw 80,8
Aw 81,9
Aw 82,10
Aw 83,11
Aw 84,12
Aw 85,13
Aw 86,14
Aw 87,15
Ar 8,88
Ar 9,89
Ar 10,90
Ar 11,91
Ar 12,92
Ar 13,93
Ar 14,94
Ar 15,95
Vm 8,8,22
Vm 9,9,22
Vm 10,10,22
Vm 11,11,22
Vm 12,12,22
Vm 13,13,22
Vm 14,14,22
Vm 15,15,22
Aw 88,8
Aw 89,9
Aw 90,10
Aw 91,11
Aw 92,12
Aw 93,13
Aw 94,14
Aw 95,15
v_max3_f32 v21, v240, v241, v242
v_max3_f32 v21, v21, v243, v244
v_max3_f32 v21, v21, v245, v246
v_max3_f32 v21, v21, v247, v248
v_max3_f32 v21, v21, v249, v250
v_max3_f32 v21, v21, v251, v252
v_max3_f32 v21, v21, v253, v254
v_max_f32 v21, v21, v255
v_mov_b32 v1, v21
s_nop 1
v_permlane16_swap_b32 v1, v21
v_max_f32 v21, v21, v1
v_mov_b32 v1, v21
s_nop 1
v_permlane32_swap_b32 v1, v21
v_max_f32_e64 v21, v21, v1
v_add_f32 v21, 0x41f80000, v21
v_max_f32 v21, 0, v21
Vs 240,240,21
Vs 241,241,21
Vs 242,242,21
Vs 243,243,21
Vs 244,244,21
Vs 245,245,21
Vs 246,246,21
Vs 247,247,21
Vs 248,248,21
Vs 249,249,21
Vs 250,250,21
Vs 251,251,21
Vs 252,252,21
Vs 253,253,21
Vs 254,254,21
Vs 255,255,21
Vs 176,176,21
Vs 177,177,21
Vs 178,178,21
Vs 179,179,21
Vs 180,180,21
Vs 181,181,21
Vs 182,182,21
Vs 183,183,21
Vs 184,184,21
Vs 185,185,21
Vs 186,186,21
Vs 187,187,21
Vs 188,188,21
Vs 189,189,21
Vs 190,190,21
Vs 191,191,21
Vs 44,44,21
Vs 45,45,21
Vs 46,46,21
v_sub_f32_e64 v47, v47, v21
v_exp_f32 v22, -v21
s_nop 0
Vm 60,60,22
Vm 61,61,22
Vm 62,62,22
v_mul_f32_e64 v63, v63, v22
Ar 8,96
Ar 9,97
Ar 10,98
Ar 11,99
Ar 12,100
Ar 13,101
Ar 14,102
Ar 15,103
Vm 8,8,22
Vm 9,9,22
Vm 10,10,22
Vm 11,11,22
Vm 12,12,22
Vm 13,13,22
Vm 14,14,22
Vm 15,15,22
Aw 96,8
Aw 97,9
Aw 98,10
Aw 99,11
Aw 100,12
Aw 101,13
Aw 102,14
Aw 103,15
Ar 8,104
Ar 9,105
Ar 10,106
Ar 11,107
Ar 12,108
Ar 13,109
Ar 14,110
Ar 15,111
Vm 8,8,22
Vm 9,9,22
Vm 10,10,22
Vm 11,11,22
Vm 12,12,22
Vm 13,13,22
Vm 14,14,22
Vm 15,15,22
Aw 104,8
Aw 105,9
Aw 106,10
Aw 107,11
Aw 108,12
Aw 109,13
Aw 110,14
Aw 111,15
Ar 8,112
Ar 9,113
Ar 10,114
Ar 11,115
Ar 12,116
Ar 13,117
Ar 14,118
Ar 15,119
Vm 8,8,22
Vm 9,9,22
Vm 10,10,22
Vm 11,11,22
Vm 12,12,22
Vm 13,13,22
Vm 14,14,22
Vm 15,15,22
Aw 112,8
Aw 113,9
Aw 114,10
Aw 115,11
Aw 116,12
Aw 117,13
Aw 118,14
Aw 119,15
Ar 8,120
Ar 9,121
Ar 10,122
Ar 11,123
Ar 12,124
Ar 13,125
Ar 14,126
Ar 15,127
Vm 8,8,22
Vm 9,9,22
Vm 10,10,22
Vm 11,11,22
Vm 12,12,22
Vm 13,13,22
Vm 14,14,22
Vm 15,15,22
Aw 120,8
Aw 121,9
Aw 122,10
Aw 123,11
Aw 124,12
Aw 125,13
Aw 126,14
Aw 127,15
Ve 8,192
Ve 9,193
s_nop 0
Vc 96,8,9
Ve 8,194
Ve 9,195
s_nop 0
Vc 97,8,9
Ve 8,208
Ve 9,209
s_nop 0
Vc 104,8,9
Ve 8,210
Ve 9,211
s_nop 0
Vc 105,8,9
Ve 8,224
Ve 9,225
s_nop 0
Vc 112,8,9
Ve 8,226
Ve 9,227
s_nop 0
Vc 113,8,9
Ve 8,240
Ve 9,241
s_nop 0
Vc 120,8,9
Ve 8,242
Ve 9,243
s_nop 0
Vc 121,8,9
Ve 8,196
Ve 9,197
s_nop 0
Vc 98,8,9
Ve 8,198
Ve 9,199
s_nop 0
Vc 99,8,9
Ve 8,212
Ve 9,213
s_nop 0
Vc 106,8,9
Ve 8,214
Ve 9,215
s_nop 0
Vc 107,8,9
Ve 8,228
Ve 9,229
s_nop 0
Vc 114,8,9
Ve 8,230
Ve 9,231
s_nop 0
Vc 115,8,9
Ve 8,244
Ve 9,245
s_nop 0
Vc 122,8,9
Ve 8,246
Ve 9,247
s_nop 0
Vc 123,8,9
Ve 8,200
Ve 9,201
s_nop 0
Vc 100,8,9
Ve 8,202
Ve 9,203
s_nop 0
Vc 101,8,9
Ve 8,216
Ve 9,217
s_nop 0
Vc 108,8,9
Ve 8,218
Ve 9,219
s_nop 0
Vc 109,8,9
Ve 8,232
Ve 9,233
s_nop 0
Vc 116,8,9
Ve 8,234
Ve 9,235
s_nop 0
Vc 117,8,9
Ve 8,248
Ve 9,249
s_nop 0
Vc 124,8,9
Ve 8,250
Ve 9,251
s_nop 0
Vc 125,8,9
Ve 8,204
Ve 9,205
s_nop 0
Vc 102,8,9
Ve 8,206
Ve 9,207
s_nop 0
Vc 103,8,9
Ve 8,220
Ve 9,221
s_nop 0
Vc 110,8,9
Ve 8,222
Ve 9,223
s_nop 0
Vc 111,8,9
Ve 8,236
Ve 9,237
s_nop 0
Vc 118,8,9
Ve 8,238
Ve 9,239
s_nop 0
Vc 119,8,9
Ve 8,252
Ve 9,253
s_nop 0
Vc 126,8,9
Ve 8,254
Ve 9,255
s_nop 0
Vc 127,8,9
s_nop 1
s_branch L_k2_fbr_wo
L_k2_mk_wo:
v_cmp_gt_i32 s[56:57], 0, v5
v_cmp_gt_i32 s[58:59], 1, v5
v_cmp_gt_i32 s[60:61], 2, v5
v_cmp_gt_i32 s[62:63], 3, v5
s_nop 3
s_nop 0
v_cndmask_b32 v176, v176, v20, s[56:57]
v_cndmask_b32 v177, v177, v20, s[58:59]
v_cndmask_b32 v178, v178, v20, s[60:61]
v_cndmask_b32 v179, v179, v20, s[62:63]
v_cmp_gt_i32 s[56:57], 16, v5
v_cmp_gt_i32 s[58:59], 17, v5
v_cmp_gt_i32 s[60:61], 18, v5
v_cmp_gt_i32 s[62:63], 19, v5
v_cndmask_b32 v180, v180, v20, s[56:57]
v_cndmask_b32 v181, v181, v20, s[58:59]
v_cndmask_b32 v182, v182, v20, s[60:61]
v_cndmask_b32 v183, v183, v20, s[62:63]
v_cmp_gt_i32 s[56:57], 32, v5
v_cmp_gt_i32 s[58:59], 33, v5
v_cmp_gt_i32 s[60:61], 34, v5
v_cmp_gt_i32 s[62:63], 35, v5
v_cndmask_b32 v184, v184, v20, s[56:57]
v_cndmask_b32 v185, v185, v20, s[58:59]
v_cndmask_b32 v186, v186, v20, s[60:61]
v_cndmask_b32 v187, v187, v20, s[62:63]
v_cmp_gt_i32 s[56:57], 48, v5
v_cmp_gt_i32 s[58:59], 49, v5
v_cmp_gt_i32 s[60:61], 50, v5
v_cmp_gt_i32 s[62:63], 51, v5
v_cndmask_b32 v188, v188, v20, s[56:57]
v_cndmask_b32 v189, v189, v20, s[58:59]
v_cndmask_b32 v190, v190, v20, s[60:61]
v_cndmask_b32 v191, v191, v20, s[62:63]
s_branch L_k2_mkr_wo
L_k2_fb_wl:
s_nop 7
v_max3_f32 v21, v128, v129, v130
v_max3_f32 v21, v21, v131, v132
v_max3_f32 v21, v21, v133, v134
v_max3_f32 v21, v21, v135, v136
v_max3_f32 v21, v21, v137, v138
v_max3_f32 v21, v21, v139, v140
v_max3_f32 v21, v21, v141, v142
v_max_f32 v21, v21, v143
v_mov_b32 v1, v21
s_nop 1
v_permlane16_swap_b32 v1, v21
v_max_f32 v21, v21, v1
v_mov_b32 v1, v21
s_nop 1
v_permlane32_swap_b32 v1, v21
v_max_f32_e64 v21, v21, v1
v_add_f32 v21, 0x41f80000, v21
v_max_f32 v21, 0, v21
Vs 128,128,21
Vs 129,129,21
Vs 130,130,21
Vs 131,131,21
Vs 132,132,21
Vs 133,133,21
Vs 134,134,21
Vs 135,135,21
Vs 136,136,21
Vs 137,137,21
Vs 138,138,21
Vs 139,139,21
Vs 140,140,21
Vs 141,141,21
Vs 142,142,21
Vs 143,143,21
Vs 192,192,21
Vs 193,193,21
Vs 194,194,21
Vs 195,195,21
Vs 196,196,21
Vs 197,197,21
Vs 198,198,21
Vs 199,199,21
Vs 200,200,21
Vs 201,201,21
Vs 202,202,21
Vs 203,203,21
Vs 204,204,21
Vs 205,205,21
Vs 206,206,21
Vs 207,207,21
Vs 32,32,21
Vs 33,33,21
Vs 34,34,21
v_sub_f32_e64 v35, v35, v21
v_exp_f32 v22, -v21
s_nop 0
Vm 48,48,22
Vm 49,49,22
Vm 50,50,22
v_mul_f32_e64 v51, v51, v22
Ar 8,0
Ar 9,1
Ar 10,2
Ar 11,3
Ar 12,4
Ar 13,5
Ar 14,6
Ar 15,7
Vm 8,8,22
Vm 9,9,22
Vm 10,10,22
Vm 11,11,22
Vm 12,12,22
Vm 13,13,22
Vm 14,14,22
Vm 15,15,22
Aw 0,8
Aw 1,9
Aw 2,10
Aw 3,11
Aw 4,12
Aw 5,13
Aw 6,14
Aw 7,15
Ar 8,8
Ar 9,9
Ar 10,10
Ar 11,11
Ar 12,12
Ar 13,13
Ar 14,14
Ar 15,15
Vm 8,8,22
Vm 9,9,22
Vm 10,10,22
Vm 11,11,22
Vm 12,12,22
Vm 13,13,22
Vm 14,14,22
Vm 15,15,22
Aw 8,8
Aw 9,9
Aw 10,10
Aw 11,11
Aw 12,12
Aw 13,13
Aw 14,14
Aw 15,15
Ar 8,16
Ar 9,17
Ar 10,18
Ar 11,19
Ar 12,20
Ar 13,21
Ar 14,22
Ar 15,23
Vm 8,8,22
Vm 9,9,22
Vm 10,10,22
Vm 11,11,22
Vm 12,12,22
Vm 13,13,22
Vm 14,14,22
Vm 15,15,22
Aw 16,8
Aw 17,9
Aw 18,10
Aw 19,11
Aw 20,12
Aw 21,13
Aw 22,14
Aw 23,15
Ar 8,24
Ar 9,25
Ar 10,26
Ar 11,27
Ar 12,28
Ar 13,29
Ar 14,30
Ar 15,31
Vm 8,8,22
Vm 9,9,22
Vm 10,10,22
Vm 11,11,22
Vm 12,12,22
Vm 13,13,22
Vm 14,14,22
Vm 15,15,22
Aw 24,8
Aw 25,9
Aw 26,10
Aw 27,11
Aw 28,12
Aw 29,13
Aw 30,14
Aw 31,15
v_max3_f32 v21, v144, v145, v146
v_max3_f32 v21, v21, v147, v148
v_max3_f32 v21, v21, v149, v150
v_max3_f32 v21, v21, v151, v152
v_max3_f32 v21, v21, v153, v154
v_max3_f32 v21, v21, v155, v156
v_max3_f32 v21, v21, v157, v158
v_max_f32 v21, v21, v159
v_mov_b32 v1, v21
s_nop 1
v_permlane16_swap_b32 v1, v21
v_max_f32 v21, v21, v1
v_mov_b32 v1, v21
s_nop 1
v_permlane32_swap_b32 v1, v21
v_max_f32_e64 v21, v21, v1
v_add_f32 v21, 0x41f80000, v21
v_max_f32 v21, 0, v21
Vs 144,144,21
Vs 145,145,21
Vs 146,146,21
Vs 147,147,21
Vs 148,148,21
Vs 149,149,21
Vs 150,150,21
Vs 151,151,21
Vs 152,152,21
Vs 153,153,21
Vs 154,154,21
Vs 155,155,21
Vs 156,156,21
Vs 157,157,21
Vs 158,158,21
Vs 159,159,21
Vs 208,208,21
Vs 209,209,21
Vs 210,210,21
Vs 211,211,21
Vs 212,212,21
Vs 213,213,21
Vs 214,214,21
Vs 215,215,21
Vs 216,216,21
Vs 217,217,21
Vs 218,218,21
Vs 219,219,21
Vs 220,220,21
Vs 221,221,21
Vs 222,222,21
Vs 223,223,21
Vs 36,36,21
Vs 37,37,21
Vs 38,38,21
v_sub_f32_e64 v39, v39, v21
v_exp_f32 v22, -v21
s_nop 0
Vm 52,52,22
Vm 53,53,22
Vm 54,54,22
v_mul_f32_e64 v55, v55, v22
Ar 8,32
Ar 9,33
Ar 10,34
Ar 11,35
Ar 12,36
Ar 13,37
Ar 14,38
Ar 15,39
Vm 8,8,22
Vm 9,9,22
Vm 10,10,22
Vm 11,11,22
Vm 12,12,22
Vm 13,13,22
Vm 14,14,22
Vm 15,15,22
Aw 32,8
Aw 33,9
Aw 34,10
Aw 35,11
Aw 36,12
Aw 37,13
Aw 38,14
Aw 39,15
Ar 8,40
Ar 9,41
Ar 10,42
Ar 11,43
Ar 12,44
Ar 13,45
Ar 14,46
Ar 15,47
Vm 8,8,22
Vm 9,9,22
Vm 10,10,22
Vm 11,11,22
Vm 12,12,22
Vm 13,13,22
Vm 14,14,22
Vm 15,15,22
Aw 40,8
Aw 41,9
Aw 42,10
Aw 43,11
Aw 44,12
Aw 45,13
Aw 46,14
Aw 47,15
Ar 8,48
Ar 9,49
Ar 10,50
Ar 11,51
Ar 12,52
Ar 13,53
Ar 14,54
Ar 15,55
Vm 8,8,22
Vm 9,9,22
Vm 10,10,22
Vm 11,11,22
Vm 12,12,22
Vm 13,13,22
Vm 14,14,22
Vm 15,15,22
Aw 48,8
Aw 49,9
Aw 50,10
Aw 51,11
Aw 52,12
Aw 53,13
Aw 54,14
Aw 55,15
Ar 8,56
Ar 9,57
Ar 10,58
Ar 11,59
Ar 12,60
Ar 13,61
Ar 14,62
Ar 15,63
Vm 8,8,22
Vm 9,9,22
Vm 10,10,22
Vm 11,11,22
Vm 12,12,22
Vm 13,13,22
Vm 14,14,22
Vm 15,15,22
Aw 56,8
Aw 57,9
Aw 58,10
Aw 59,11
Aw 60,12
Aw 61,13
Aw 62,14
Aw 63,15
v_max3_f32 v21, v160, v161, v162
v_max3_f32 v21, v21, v163, v164
v_max3_f32 v21, v21, v165, v166
v_max3_f32 v21, v21, v167, v168
v_max3_f32 v21, v21, v169, v170
v_max3_f32 v21, v21, v171, v172
v_max3_f32 v21, v21, v173, v174
v_max_f32 v21, v21, v175
v_mov_b32 v1, v21
s_nop 1
v_permlane16_swap_b32 v1, v21
v_max_f32 v21, v21, v1
v_mov_b32 v1, v21
s_nop 1
v_permlane32_swap_b32 v1, v21
v_max_f32_e64 v21, v21, v1
v_add_f32 v21, 0x41f80000, v21
v_max_f32 v21, 0, v21
Vs 160,160,21
Vs 161,161,21
Vs 162,162,21
Vs 163,163,21
Vs 164,164,21
Vs 165,165,21
Vs 166,166,21
Vs 167,167,21
Vs 168,168,21
Vs 169,169,21
Vs 170,170,21
Vs 171,171,21
Vs 172,172,21
Vs 173,173,21
Vs 174,174,21
Vs 175,175,21
Vs 224,224,21
Vs 225,225,21
Vs 226,226,21
Vs 227,227,21
Vs 228,228,21
Vs 229,229,21
Vs 230,230,21
Vs 231,231,21
Vs 232,232,21
Vs 233,233,21
Vs 234,234,21
Vs 235,235,21
Vs 236,236,21
Vs 237,237,21
Vs 238,238,21
Vs 239,239,21
Vs 40,40,21
Vs 41,41,21
Vs 42,42,21
v_sub_f32_e64 v43, v43, v21
v_exp_f32 v22, -v21
s_nop 0
Vm 56,56,22
Vm 57,57,22
Vm 58,58,22
v_mul_f32_e64 v59, v59, v22
Ar 8,64
Ar 9,65
Ar 10,66
Ar 11,67
Ar 12,68
Ar 13,69
Ar 14,70
Ar 15,71
Vm 8,8,22
Vm 9,9,22
Vm 10,10,22
Vm 11,11,22
Vm 12,12,22
Vm 13,13,22
Vm 14,14,22
Vm 15,15,22
Aw 64,8
Aw 65,9
Aw 66,10
Aw 67,11
Aw 68,12
Aw 69,13
Aw 70,14
Aw 71,15
Ar 8,72
Ar 9,73
Ar 10,74
Ar 11,75
Ar 12,76
Ar 13,77
Ar 14,78
Ar 15,79
Vm 8,8,22
Vm 9,9,22
Vm 10,10,22
Vm 11,11,22
Vm 12,12,22
Vm 13,13,22
Vm 14,14,22
Vm 15,15,22
Aw 72,8
Aw 73,9
Aw 74,10
Aw 75,11
Aw 76,12
Aw 77,13
Aw 78,14
Aw 79,15
Ar 8,80
Ar 9,81
Ar 10,82
Ar 11,83
Ar 12,84
Ar 13,85
Ar 14,86
Ar 15,87
Vm 8,8,22
Vm 9,9,22
Vm 10,10,22
Vm 11,11,22
Vm 12,12,22
Vm 13,13,22
Vm 14,14,22
Vm 15,15,22
Aw 80,8
Aw 81,9
Aw 82,10
Aw 83,11
Aw 84,12
Aw 85,13
Aw 86,14
Aw 87,15
Ar 8,88
Ar 9,89
Ar 10,90
Ar 11,91
Ar 12,92
Ar 13,93
Ar 14,94
Ar 15,95
Vm 8,8,22
Vm 9,9,22
Vm 10,10,22
Vm 11,11,22
Vm 12,12,22
Vm 13,13,22
Vm 14,14,22
Vm 15,15,22
Aw 88,8
Aw 89,9
Aw 90,10
Aw 91,11
Aw 92,12
Aw 93,13
Aw 94,14
Aw 95,15
v_max3_f32 v21, v176, v177, v178
v_max3_f32 v21, v21, v179, v180
v_max3_f32 v21, v21, v181, v182
v_max3_f32 v21, v21, v183, v184
v_max3_f32 v21, v21, v185, v186
v_max3_f32 v21, v21, v187, v188
v_max3_f32 v21, v21, v189, v190
v_max_f32 v21, v21, v191
v_mov_b32 v1, v21
s_nop 1
v_permlane16_swap_b32 v1, v21
v_max_f32 v21, v21, v1
v_mov_b32 v1, v21
s_nop 1
v_permlane32_swap_b32 v1, v21
v_max_f32_e64 v21, v21, v1
v_add_f32 v21, 0x41f80000, v21
v_max_f32 v21, 0, v21
Vs 176,176,21
Vs 177,177,21
Vs 178,178,21
Vs 179,179,21
Vs 180,180,21
Vs 181,181,21
Vs 182,182,21
Vs 183,183,21
Vs 184,184,21
Vs 185,185,21
Vs 186,186,21
Vs 187,187,21
Vs 188,188,21
Vs 189,189,21
Vs 190,190,21
Vs 191,191,21
Vs 44,44,21
Vs 45,45,21
Vs 46,46,21
v_sub_f32_e64 v47, v47, v21
v_exp_f32 v22, -v21
s_nop 0
Vm 60,60,22
Vm 61,61,22
Vm 62,62,22
v_mul_f32_e64 v63, v63, v22
Ar 8,96
Ar 9,97
Ar 10,98
Ar 11,99
Ar 12,100
Ar 13,101
Ar 14,102
Ar 15,103
Vm 8,8,22
Vm 9,9,22
Vm 10,10,22
Vm 11,11,22
Vm 12,12,22
Vm 13,13,22
Vm 14,14,22
Vm 15,15,22
Aw 96,8
Aw 97,9
Aw 98,10
Aw 99,11
Aw 100,12
Aw 101,13
Aw 102,14
Aw 103,15
Ar 8,104
Ar 9,105
Ar 10,106
Ar 11,107
Ar 12,108
Ar 13,109
Ar 14,110
Ar 15,111
Vm 8,8,22
Vm 9,9,22
Vm 10,10,22
Vm 11,11,22
Vm 12,12,22
Vm 13,13,22
Vm 14,14,22
Vm 15,15,22
Aw 104,8
Aw 105,9
Aw 106,10
Aw 107,11
Aw 108,12
Aw 109,13
Aw 110,14
Aw 111,15
Ar 8,112
Ar 9,113
Ar 10,114
Ar 11,115
Ar 12,116
Ar 13,117
Ar 14,118
Ar 15,119
Vm 8,8,22
Vm 9,9,22
Vm 10,10,22
Vm 11,11,22
Vm 12,12,22
Vm 13,13,22
Vm 14,14,22
Vm 15,15,22
Aw 112,8
Aw 113,9
Aw 114,10
Aw 115,11
Aw 116,12
Aw 117,13
Aw 118,14
Aw 119,15
Ar 8,120
Ar 9,121
Ar 10,122
Ar 11,123
Ar 12,124
Ar 13,125
Ar 14,126
Ar 15,127
Vm 8,8,22
Vm 9,9,22
Vm 10,10,22
Vm 11,11,22
Vm 12,12,22
Vm 13,13,22
Vm 14,14,22
Vm 15,15,22
Aw 120,8
Aw 121,9
Aw 122,10
Aw 123,11
Aw 124,12
Aw 125,13
Aw 126,14
Aw 127,15
Ve 8,128
Ve 9,129
s_nop 0
Vc 64,8,9
Ve 8,130
Ve 9,131
s_nop 0
Vc 65,8,9
Ve 8,144
Ve 9,145
s_nop 0
Vc 72,8,9
Ve 8,146
Ve 9,147
s_nop 0
Vc 73,8,9
Ve 8,160
Ve 9,161
s_nop 0
Vc 80,8,9
Ve 8,162
Ve 9,163
s_nop 0
Vc 81,8,9
Ve 8,176
Ve 9,177
s_nop 0
Vc 88,8,9
Ve 8,178
Ve 9,179
s_nop 0
Vc 89,8,9
Ve 8,132
Ve 9,133
s_nop 0
Vc 66,8,9
Ve 8,134
Ve 9,135
s_nop 0
Vc 67,8,9
Ve 8,148
Ve 9,149
s_nop 0
Vc 74,8,9
Ve 8,150
Ve 9,151
s_nop 0
Vc 75,8,9
Ve 8,164
Ve 9,165
s_nop 0
Vc 82,8,9
Ve 8,166
Ve 9,167
s_nop 0
Vc 83,8,9
Ve 8,180
Ve 9,181
s_nop 0
Vc 90,8,9
Ve 8,182
Ve 9,183
s_nop 0
Vc 91,8,9
Ve 8,136
Ve 9,137
s_nop 0
Vc 68,8,9
Ve 8,138
Ve 9,139
s_nop 0
Vc 69,8,9
Ve 8,152
Ve 9,153
s_nop 0
Vc 76,8,9
Ve 8,154
Ve 9,155
s_nop 0
Vc 77,8,9
Ve 8,168
Ve 9,169
s_nop 0
Vc 84,8,9
Ve 8,170
Ve 9,171
s_nop 0
Vc 85,8,9
Ve 8,184
Ve 9,185
s_nop 0
Vc 92,8,9
Ve 8,186
Ve 9,187
s_nop 0
Vc 93,8,9
Ve 8,140
Ve 9,141
s_nop 0
Vc 70,8,9
Ve 8,142
Ve 9,143
s_nop 0
Vc 71,8,9
Ve 8,156
Ve 9,157
s_nop 0
Vc 78,8,9
Ve 8,158
Ve 9,159
s_nop 0
Vc 79,8,9
Ve 8,172
Ve 9,173
s_nop 0
Vc 86,8,9
Ve 8,174
Ve 9,175
s_nop 0
Vc 87,8,9
Ve 8,188
Ve 9,189
s_nop 0
Vc 94,8,9
Ve 8,190
Ve 9,191
s_nop 0
Vc 95,8,9
s_nop 1
s_branch L_k2_fbr_wl
L_k2_mk_wl:
v_cmp_gt_i32 s[56:57], 0, v6
v_cmp_gt_i32 s[58:59], 1, v6
v_cmp_gt_i32 s[60:61], 2, v6
v_cmp_gt_i32 s[62:63], 3, v6
s_nop 3
s_nop 0
v_cndmask_b32 v224, v224, v20, s[56:57]
v_cndmask_b32 v225, v225, v20, s[58:59]
v_cndmask_b32 v226, v226, v20, s[60:61]
v_cndmask_b32 v227, v227, v20, s[62:63]
v_cmp_gt_i32 s[56:57], 16, v6
v_cmp_gt_i32 s[58:59], 17, v6
v_cmp_gt_i32 s[60:61], 18, v6
v_cmp_gt_i32 s[62:63], 19, v6
v_cndmask_b32 v228, v228, v20, s[56:57]
v_cndmask_b32 v229, v229, v20, s[58:59]
v_cndmask_b32 v230, v230, v20, s[60:61]
v_cndmask_b32 v231, v231, v20, s[62:63]
v_cmp_gt_i32 s[56:57], 32, v6
v_cmp_gt_i32 s[58:59], 33, v6
v_cmp_gt_i32 s[60:61], 34, v6
v_cmp_gt_i32 s[62:63], 35, v6
v_cndmask_b32 v232, v232, v20, s[56:57]
v_cndmask_b32 v233, v233, v20, s[58:59]
v_cndmask_b32 v234, v234, v20, s[60:61]
v_cndmask_b32 v235, v235, v20, s[62:63]
v_cmp_gt_i32 s[56:57], 48, v6
v_cmp_gt_i32 s[58:59], 49, v6
v_cmp_gt_i32 s[60:61], 50, v6
v_cmp_gt_i32 s[62:63], 51, v6
v_cndmask_b32 v236, v236, v20, s[56:57]
v_cndmask_b32 v237, v237, v20, s[58:59]
v_cndmask_b32 v238, v238, v20, s[60:61]
v_cndmask_b32 v239, v239, v20, s[62:63]
s_branch L_k2_mkr_wl
L_k2_fb_tr:
s_nop 7
v_max3_f32 v21, v192, v193, v194
v_max3_f32 v21, v21, v195, v196
v_max3_f32 v21, v21, v197, v198
v_max3_f32 v21, v21, v199, v200
v_max3_f32 v21, v21, v201, v202
v_max3_f32 v21, v21, v203, v204
v_max3_f32 v21, v21, v205, v206
v_max_f32 v21, v21, v207
v_mov_b32 v1, v21
s_nop 1
v_permlane16_swap_b32 v1, v21
v_max_f32 v21, v21, v1
v_mov_b32 v1, v21
s_nop 1
v_permlane32_swap_b32 v1, v21
v_max_f32_e64 v21, v21, v1
v_add_f32 v21, 0x41f80000, v21
v_max_f32 v21, 0, v21
Vs 192,192,21
Vs 193,193,21
Vs 194,194,21
Vs 195,195,21
Vs 196,196,21
Vs 197,197,21
Vs 198,198,21
Vs 199,199,21
Vs 200,200,21
Vs 201,201,21
Vs 202,202,21
Vs 203,203,21
Vs 204,204,21
Vs 205,205,21
Vs 206,206,21
Vs 207,207,21
Vs 128,128,21
Vs 129,129,21
Vs 130,130,21
Vs 131,131,21
Vs 132,132,21
Vs 133,133,21
Vs 134,134,21
Vs 135,135,21
Vs 136,136,21
Vs 137,137,21
Vs 138,138,21
Vs 139,139,21
Vs 140,140,21
Vs 141,141,21
Vs 142,142,21
Vs 143,143,21
Vs 32,32,21
Vs 33,33,21
Vs 34,34,21
v_sub_f32_e64 v35, v35, v21
v_exp_f32 v22, -v21
s_nop 0
Vm 48,48,22
Vm 49,49,22
Vm 50,50,22
v_mul_f32_e64 v51, v51, v22
Ar 8,0
Ar 9,1
Ar 10,2
Ar 11,3
Ar 12,4
Ar 13,5
Ar 14,6
Ar 15,7
Vm 8,8,22
Vm 9,9,22
Vm 10,10,22
Vm 11,11,22
Vm 12,12,22
Vm 13,13,22
Vm 14,14,22
Vm 15,15,22
Aw 0,8
Aw 1,9
Aw 2,10
Aw 3,11
Aw 4,12
Aw 5,13
Aw 6,14
Aw 7,15
Ar 8,8
Ar 9,9
Ar 10,10
Ar 11,11
Ar 12,12
Ar 13,13
Ar 14,14
Ar 15,15
Vm 8,8,22
Vm 9,9,22
Vm 10,10,22
Vm 11,11,22
Vm 12,12,22
Vm 13,13,22
Vm 14,14,22
Vm 15,15,22
Aw 8,8
Aw 9,9
Aw 10,10
Aw 11,11
Aw 12,12
Aw 13,13
Aw 14,14
Aw 15,15
Ar 8,16
Ar 9,17
Ar 10,18
Ar 11,19
Ar 12,20
Ar 13,21
Ar 14,22
Ar 15,23
Vm 8,8,22
Vm 9,9,22
Vm 10,10,22
Vm 11,11,22
Vm 12,12,22
Vm 13,13,22
Vm 14,14,22
Vm 15,15,22
Aw 16,8
Aw 17,9
Aw 18,10
Aw 19,11
Aw 20,12
Aw 21,13
Aw 22,14
Aw 23,15
Ar 8,24
Ar 9,25
Ar 10,26
Ar 11,27
Ar 12,28
Ar 13,29
Ar 14,30
Ar 15,31
Vm 8,8,22
Vm 9,9,22
Vm 10,10,22
Vm 11,11,22
Vm 12,12,22
Vm 13,13,22
Vm 14,14,22
Vm 15,15,22
Aw 24,8
Aw 25,9
Aw 26,10
Aw 27,11
Aw 28,12
Aw 29,13
Aw 30,14
Aw 31,15
v_max3_f32 v21, v208, v209, v210
v_max3_f32 v21, v21, v211, v212
v_max3_f32 v21, v21, v213, v214
v_max3_f32 v21, v21, v215, v216
v_max3_f32 v21, v21, v217, v218
v_max3_f32 v21, v21, v219, v220
v_max3_f32 v21, v21, v221, v222
v_max_f32 v21, v21, v223
v_mov_b32 v1, v21
s_nop 1
v_permlane16_swap_b32 v1, v21
v_max_f32 v21, v21, v1
v_mov_b32 v1, v21
s_nop 1
v_permlane32_swap_b32 v1, v21
v_max_f32_e64 v21, v21, v1
v_add_f32 v21, 0x41f80000, v21
v_max_f32 v21, 0, v21
Vs 208,208,21
Vs 209,209,21
Vs 210,210,21
Vs 211,211,21
Vs 212,212,21
Vs 213,213,21
Vs 214,214,21
Vs 215,215,21
Vs 216,216,21
Vs 217,217,21
Vs 218,218,21
Vs 219,219,21
Vs 220,220,21
Vs 221,221,21
Vs 222,222,21
Vs 223,223,21
Vs 144,144,21
Vs 145,145,21
Vs 146,146,21
Vs 147,147,21
Vs 148,148,21
Vs 149,149,21
Vs 150,150,21
Vs 151,151,21
Vs 152,152,21
Vs 153,153,21
Vs 154,154,21
Vs 155,155,21
Vs 156,156,21
Vs 157,157,21
Vs 158,158,21
Vs 159,159,21
Vs 36,36,21
Vs 37,37,21
Vs 38,38,21
v_sub_f32_e64 v39, v39, v21
v_exp_f32 v22, -v21
s_nop 0
Vm 52,52,22
Vm 53,53,22
Vm 54,54,22
v_mul_f32_e64 v55, v55, v22
Ar 8,32
Ar 9,33
Ar 10,34
Ar 11,35
Ar 12,36
Ar 13,37
Ar 14,38
Ar 15,39
Vm 8,8,22
Vm 9,9,22
Vm 10,10,22
Vm 11,11,22
Vm 12,12,22
Vm 13,13,22
Vm 14,14,22
Vm 15,15,22
Aw 32,8
Aw 33,9
Aw 34,10
Aw 35,11
Aw 36,12
Aw 37,13
Aw 38,14
Aw 39,15
Ar 8,40
Ar 9,41
Ar 10,42
Ar 11,43
Ar 12,44
Ar 13,45
Ar 14,46
Ar 15,47
Vm 8,8,22
Vm 9,9,22
Vm 10,10,22
Vm 11,11,22
Vm 12,12,22
Vm 13,13,22
Vm 14,14,22
Vm 15,15,22
Aw 40,8
Aw 41,9
Aw 42,10
Aw 43,11
Aw 44,12
Aw 45,13
Aw 46,14
Aw 47,15
Ar 8,48
Ar 9,49
Ar 10,50
Ar 11,51
Ar 12,52
Ar 13,53
Ar 14,54
Ar 15,55
Vm 8,8,22
Vm 9,9,22
Vm 10,10,22
Vm 11,11,22
Vm 12,12,22
Vm 13,13,22
Vm 14,14,22
Vm 15,15,22
Aw 48,8
Aw 49,9
Aw 50,10
Aw 51,11
Aw 52,12
Aw 53,13
Aw 54,14
Aw 55,15
Ar 8,56
Ar 9,57
Ar 10,58
Ar 11,59
Ar 12,60
Ar 13,61
Ar 14,62
Ar 15,63
Vm 8,8,22
Vm 9,9,22
Vm 10,10,22
Vm 11,11,22
Vm 12,12,22
Vm 13,13,22
Vm 14,14,22
Vm 15,15,22
Aw 56,8
Aw 57,9
Aw 58,10
Aw 59,11
Aw 60,12
Aw 61,13
Aw 62,14
Aw 63,15
v_max3_f32 v21, v224, v225, v226
v_max3_f32 v21, v21, v227, v228
v_max3_f32 v21, v21, v229, v230
v_max3_f32 v21, v21, v231, v232
v_max3_f32 v21, v21, v233, v234
v_max3_f32 v21, v21, v235, v236
v_max3_f32 v21, v21, v237, v238
v_max_f32 v21, v21, v239
v_mov_b32 v1, v21
s_nop 1
v_permlane16_swap_b32 v1, v21
v_max_f32 v21, v21, v1
v_mov_b32 v1, v21
s_nop 1
v_permlane32_swap_b32 v1, v21
v_max_f32_e64 v21, v21, v1
v_add_f32 v21, 0x41f80000, v21
v_max_f32 v21, 0, v21
Vs 224,224,21
Vs 225,225,21
Vs 226,226,21
Vs 227,227,21
Vs 228,228,21
Vs 229,229,21
Vs 230,230,21
Vs 231,231,21
Vs 232,232,21
Vs 233,233,21
Vs 234,234,21
Vs 235,235,21
Vs 236,236,21
Vs 237,237,21
Vs 238,238,21
Vs 239,239,21
Vs 40,40,21
Vs 41,41,21
Vs 42,42,21
v_sub_f32_e64 v43, v43, v21
v_exp_f32 v22, -v21
s_nop 0
Vm 56,56,22
Vm 57,57,22
Vm 58,58,22
v_mul_f32_e64 v59, v59, v22
Ar 8,64
Ar 9,65
Ar 10,66
Ar 11,67
Ar 12,68
Ar 13,69
Ar 14,70
Ar 15,71
Vm 8,8,22
Vm 9,9,22
Vm 10,10,22
Vm 11,11,22
Vm 12,12,22
Vm 13,13,22
Vm 14,14,22
Vm 15,15,22
Aw 64,8
Aw 65,9
Aw 66,10
Aw 67,11
Aw 68,12
Aw 69,13
Aw 70,14
Aw 71,15
Ar 8,72
Ar 9,73
Ar 10,74
Ar 11,75
Ar 12,76
Ar 13,77
Ar 14,78
Ar 15,79
Vm 8,8,22
Vm 9,9,22
Vm 10,10,22
Vm 11,11,22
Vm 12,12,22
Vm 13,13,22
Vm 14,14,22
Vm 15,15,22
Aw 72,8
Aw 73,9
Aw 74,10
Aw 75,11
Aw 76,12
Aw 77,13
Aw 78,14
Aw 79,15
Ar 8,80
Ar 9,81
Ar 10,82
Ar 11,83
Ar 12,84
Ar 13,85
Ar 14,86
Ar 15,87
Vm 8,8,22
Vm 9,9,22
Vm 10,10,22
Vm 11,11,22
Vm 12,12,22
Vm 13,13,22
Vm 14,14,22
Vm 15,15,22
Aw 80,8
Aw 81,9
Aw 82,10
Aw 83,11
Aw 84,12
Aw 85,13
Aw 86,14
Aw 87,15
Ar 8,88
Ar 9,89
Ar 10,90
Ar 11,91
Ar 12,92
Ar 13,93
Ar 14,94
Ar 15,95
Vm 8,8,22
Vm 9,9,22
Vm 10,10,22
Vm 11,11,22
Vm 12,12,22
Vm 13,13,22
Vm 14,14,22
Vm 15,15,22
Aw 88,8
Aw 89,9
Aw 90,10
Aw 91,11
Aw 92,12
Aw 93,13
Aw 94,14
Aw 95,15
Ve 8,192
Ve 9,193
s_nop 0
Vc 96,8,9
Ve 8,194
Ve 9,195
s_nop 0
Vc 97,8,9
Ve 8,208
Ve 9,209
s_nop 0
Vc 104,8,9
Ve 8,210
Ve 9,211
s_nop 0
Vc 105,8,9
Ve 8,224
Ve 9,225
s_nop 0
Vc 112,8,9
Ve 8,226
Ve 9,227
s_nop 0
Vc 113,8,9
Ve 8,196
Ve 9,197
s_nop 0
Vc 98,8,9
Ve 8,198
Ve 9,199
s_nop 0
Vc 99,8,9
Ve 8,212
Ve 9,213
s_nop 0
Vc 106,8,9
Ve 8,214
Ve 9,215
s_nop 0
Vc 107,8,9
Ve 8,228
Ve 9,229
s_nop 0
Vc 114,8,9
Ve 8,230
Ve 9,231
s_nop 0
Vc 115,8,9
Ve 8,200
Ve 9,201
s_nop 0
Vc 100,8,9
Ve 8,202
Ve 9,203
s_nop 0
Vc 101,8,9
Ve 8,216
Ve 9,217
s_nop 0
Vc 108,8,9
Ve 8,218
Ve 9,219
s_nop 0
Vc 109,8,9
Ve 8,232
Ve 9,233
s_nop 0
Vc 116,8,9
Ve 8,234
Ve 9,235
s_nop 0
Vc 117,8,9
Ve 8,204
Ve 9,205
s_nop 0
Vc 102,8,9
Ve 8,206
Ve 9,207
s_nop 0
Vc 103,8,9
Ve 8,220
Ve 9,221
s_nop 0
Vc 110,8,9
Ve 8,222
Ve 9,223
s_nop 0
Vc 111,8,9
Ve 8,236
Ve 9,237
s_nop 0
Vc 118,8,9
Ve 8,238
Ve 9,239
s_nop 0
Vc 119,8,9
s_nop 1
s_branch L_k2_fbr_tr
L_k2_mk_tr:
v_cmp_gt_i32 s[56:57], 0, v5
v_cmp_gt_i32 s[58:59], 1, v5
v_cmp_gt_i32 s[60:61], 2, v5
v_cmp_gt_i32 s[62:63], 3, v5
s_nop 3
s_nop 0
v_cndmask_b32 v144, v144, v20, s[56:57]
v_cndmask_b32 v145, v145, v20, s[58:59]
v_cndmask_b32 v146, v146, v20, s[60:61]
v_cndmask_b32 v147, v147, v20, s[62:63]
v_cmp_gt_i32 s[56:57], 16, v5
v_cmp_gt_i32 s[58:59], 17, v5
v_cmp_gt_i32 s[60:61], 18, v5
v_cmp_gt_i32 s[62:63], 19, v5
v_cndmask_b32 v148, v148, v20, s[56:57]
v_cndmask_b32 v149, v149, v20, s[58:59]
v_cndmask_b32 v150, v150, v20, s[60:61]
v_cndmask_b32 v151, v151, v20, s[62:63]
v_cmp_gt_i32 s[56:57], 32, v5
v_cmp_gt_i32 s[58:59], 33, v5
v_cmp_gt_i32 s[60:61], 34, v5
v_cmp_gt_i32 s[62:63], 35, v5
v_cndmask_b32 v152, v152, v20, s[56:57]
v_cndmask_b32 v153, v153, v20, s[58:59]
v_cndmask_b32 v154, v154, v20, s[60:61]
v_cndmask_b32 v155, v155, v20, s[62:63]
v_cmp_gt_i32 s[56:57], 48, v5
v_cmp_gt_i32 s[58:59], 49, v5
v_cmp_gt_i32 s[60:61], 50, v5
v_cmp_gt_i32 s[62:63], 51, v5
v_cndmask_b32 v156, v156, v20, s[56:57]
v_cndmask_b32 v157, v157, v20, s[58:59]
v_cndmask_b32 v158, v158, v20, s[60:61]
v_cndmask_b32 v159, v159, v20, s[62:63]
s_branch L_k2_mkr_tr
L_k2_fb_ne:
s_nop 7
v_max3_f32 v21, v128, v129, v130
v_max3_f32 v21, v21, v131, v132
v_max3_f32 v21, v21, v133, v134
v_max3_f32 v21, v21, v135, v136
v_max3_f32 v21, v21, v137, v138
v_max3_f32 v21, v21, v139, v140
v_max3_f32 v21, v21, v141, v142
v_max_f32 v21, v21, v143
v_mov_b32 v1, v21
s_nop 1
v_permlane16_swap_b32 v1, v21
v_max_f32 v21, v21, v1
v_mov_b32 v1, v21
s_nop 1
v_permlane32_swap_b32 v1, v21
v_max_f32_e64 v21, v21, v1
v_add_f32 v21, 0x41f80000, v21
v_max_f32 v21, 0, v21
Vs 128,128,21
Vs 129,129,21
Vs 130,130,21
Vs 131,131,21
Vs 132,132,21
Vs 133,133,21
Vs 134,134,21
Vs 135,135,21
Vs 136,136,21
Vs 137,137,21
Vs 138,138,21
Vs 139,139,21
Vs 140,140,21
Vs 141,141,21
Vs 142,142,21
Vs 143,143,21
Vs 192,192,21
Vs 193,193,21
Vs 194,194,21
Vs 195,195,21
Vs 196,196,21
Vs 197,197,21
Vs 198,198,21
Vs 199,199,21
Vs 200,200,21
Vs 201,201,21
Vs 202,202,21
Vs 203,203,21
Vs 204,204,21
Vs 205,205,21
Vs 206,206,21
Vs 207,207,21
Vs 32,32,21
Vs 33,33,21
Vs 34,34,21
v_sub_f32_e64 v35, v35, v21
v_exp_f32 v22, -v21
s_nop 0
Vm 48,48,22
Vm 49,49,22
Vm 50,50,22
v_mul_f32_e64 v51, v51, v22
Ar 8,0
Ar 9,1
Ar 10,2
Ar 11,3
Ar 12,4
Ar 13,5
Ar 14,6
Ar 15,7
Vm 8,8,22
Vm 9,9,22
Vm 10,10,22
Vm 11,11,22
Vm 12,12,22
Vm 13,13,22
Vm 14,14,22
Vm 15,15,22
Aw 0,8
Aw 1,9
Aw 2,10
Aw 3,11
Aw 4,12
Aw 5,13
Aw 6,14
Aw 7,15
Ar 8,8
Ar 9,9
Ar 10,10
Ar 11,11
Ar 12,12
Ar 13,13
Ar 14,14
Ar 15,15
Vm 8,8,22
Vm 9,9,22
Vm 10,10,22
Vm 11,11,22
Vm 12,12,22
Vm 13,13,22
Vm 14,14,22
Vm 15,15,22
Aw 8,8
Aw 9,9
Aw 10,10
Aw 11,11
Aw 12,12
Aw 13,13
Aw 14,14
Aw 15,15
Ar 8,16
Ar 9,17
Ar 10,18
Ar 11,19
Ar 12,20
Ar 13,21
Ar 14,22
Ar 15,23
Vm 8,8,22
Vm 9,9,22
Vm 10,10,22
Vm 11,11,22
Vm 12,12,22
Vm 13,13,22
Vm 14,14,22
Vm 15,15,22
Aw 16,8
Aw 17,9
Aw 18,10
Aw 19,11
Aw 20,12
Aw 21,13
Aw 22,14
Aw 23,15
Ar 8,24
Ar 9,25
Ar 10,26
Ar 11,27
Ar 12,28
Ar 13,29
Ar 14,30
Ar 15,31
Vm 8,8,22
Vm 9,9,22
Vm 10,10,22
Vm 11,11,22
Vm 12,12,22
Vm 13,13,22
Vm 14,14,22
Vm 15,15,22
Aw 24,8
Aw 25,9
Aw 26,10
Aw 27,11
Aw 28,12
Aw 29,13
Aw 30,14
Aw 31,15
v_max3_f32 v21, v144, v145, v146
v_max3_f32 v21, v21, v147, v148
v_max3_f32 v21, v21, v149, v150
v_max3_f32 v21, v21, v151, v152
v_max3_f32 v21, v21, v153, v154
v_max3_f32 v21, v21, v155, v156
v_max3_f32 v21, v21, v157, v158
v_max_f32 v21, v21, v159
v_mov_b32 v1, v21
s_nop 1
v_permlane16_swap_b32 v1, v21
v_max_f32 v21, v21, v1
v_mov_b32 v1, v21
s_nop 1
v_permlane32_swap_b32 v1, v21
v_max_f32_e64 v21, v21, v1
v_add_f32 v21, 0x41f80000, v21
v_max_f32 v21, 0, v21
Vs 144,144,21
Vs 145,145,21
Vs 146,146,21
Vs 147,147,21
Vs 148,148,21
Vs 149,149,21
Vs 150,150,21
Vs 151,151,21
Vs 152,152,21
Vs 153,153,21
Vs 154,154,21
Vs 155,155,21
Vs 156,156,21
Vs 157,157,21
Vs 158,158,21
Vs 159,159,21
Vs 208,208,21
Vs 209,209,21
Vs 210,210,21
Vs 211,211,21
Vs 212,212,21
Vs 213,213,21
Vs 214,214,21
Vs 215,215,21
Vs 216,216,21
Vs 217,217,21
Vs 218,218,21
Vs 219,219,21
Vs 220,220,21
Vs 221,221,21
Vs 222,222,21
Vs 223,223,21
Vs 36,36,21
Vs 37,37,21
Vs 38,38,21
v_sub_f32_e64 v39, v39, v21
v_exp_f32 v22, -v21
s_nop 0
Vm 52,52,22
Vm 53,53,22
Vm 54,54,22
v_mul_f32_e64 v55, v55, v22
Ar 8,32
Ar 9,33
Ar 10,34
Ar 11,35
Ar 12,36
Ar 13,37
Ar 14,38
Ar 15,39
Vm 8,8,22
Vm 9,9,22
Vm 10,10,22
Vm 11,11,22
Vm 12,12,22
Vm 13,13,22
Vm 14,14,22
Vm 15,15,22
Aw 32,8
Aw 33,9
Aw 34,10
Aw 35,11
Aw 36,12
Aw 37,13
Aw 38,14
Aw 39,15
Ar 8,40
Ar 9,41
Ar 10,42
Ar 11,43
Ar 12,44
Ar 13,45
Ar 14,46
Ar 15,47
Vm 8,8,22
Vm 9,9,22
Vm 10,10,22
Vm 11,11,22
Vm 12,12,22
Vm 13,13,22
Vm 14,14,22
Vm 15,15,22
Aw 40,8
Aw 41,9
Aw 42,10
Aw 43,11
Aw 44,12
Aw 45,13
Aw 46,14
Aw 47,15
Ar 8,48
Ar 9,49
Ar 10,50
Ar 11,51
Ar 12,52
Ar 13,53
Ar 14,54
Ar 15,55
Vm 8,8,22
Vm 9,9,22
Vm 10,10,22
Vm 11,11,22
Vm 12,12,22
Vm 13,13,22
Vm 14,14,22
Vm 15,15,22
Aw 48,8
Aw 49,9
Aw 50,10
Aw 51,11
Aw 52,12
Aw 53,13
Aw 54,14
Aw 55,15
Ar 8,56
Ar 9,57
Ar 10,58
Ar 11,59
Ar 12,60
Ar 13,61
Ar 14,62
Ar 15,63
Vm 8,8,22
Vm 9,9,22
Vm 10,10,22
Vm 11,11,22
Vm 12,12,22
Vm 13,13,22
Vm 14,14,22
Vm 15,15,22
Aw 56,8
Aw 57,9
Aw 58,10
Aw 59,11
Aw 60,12
Aw 61,13
Aw 62,14
Aw 63,15
Ve 8,128
Ve 9,129
s_nop 0
Vc 64,8,9
Ve 8,130
Ve 9,131
s_nop 0
Vc 65,8,9
Ve 8,144
Ve 9,145
s_nop 0
Vc 72,8,9
Ve 8,146
Ve 9,147
s_nop 0
Vc 73,8,9
Ve 8,132
Ve 9,133
s_nop 0
Vc 66,8,9
Ve 8,134
Ve 9,135
s_nop 0
Vc 67,8,9
Ve 8,148
Ve 9,149
s_nop 0
Vc 74,8,9
Ve 8,150
Ve 9,151
s_nop 0
Vc 75,8,9
Ve 8,136
Ve 9,137
s_nop 0
Vc 68,8,9
Ve 8,138
Ve 9,139
s_nop 0
Vc 69,8,9
Ve 8,152
Ve 9,153
s_nop 0
Vc 76,8,9
Ve 8,154
Ve 9,155
s_nop 0
Vc 77,8,9
Ve 8,140
Ve 9,141
s_nop 0
Vc 70,8,9
Ve 8,142
Ve 9,143
s_nop 0
Vc 71,8,9
Ve 8,156
Ve 9,157
s_nop 0
Vc 78,8,9
Ve 8,158
Ve 9,159
s_nop 0
Vc 79,8,9
s_nop 1
s_branch L_k2_fbr_ne
L_pubB:
v_mov_b32 v24, 1
v_mov_b32 v25, 0
s_mov_b64 exec, 1
buffer_store_dword v24, v25, s[20:23], s64 offen sc1
s_mov_b64 exec, -1
s_branch L_pubBr
L_k2_fb_no:
s_nop 7
v_max3_f32 v21, v192, v193, v194
v_max3_f32 v21, v21, v195, v196
v_max3_f32 v21, v21, v197, v198
v_max3_f32 v21, v21, v199, v200
v_max3_f32 v21, v21, v201, v202
v_max3_f32 v21, v21, v203, v204
v_max3_f32 v21, v21, v205, v206
v_max_f32 v21, v21, v207
v_mov_b32 v1, v21
s_nop 1
v_permlane16_swap_b32 v1, v21
v_max_f32 v21, v21, v1
v_mov_b32 v1, v21
s_nop 1
v_permlane32_swap_b32 v1, v21
v_max_f32_e64 v21, v21, v1
v_add_f32 v21, 0x41f80000, v21
v_max_f32 v21, 0, v21
Vs 192,192,21
Vs 193,193,21
Vs 194,194,21
Vs 195,195,21
Vs 196,196,21
Vs 197,197,21
Vs 198,198,21
Vs 199,199,21
Vs 200,200,21
Vs 201,201,21
Vs 202,202,21
Vs 203,203,21
Vs 204,204,21
Vs 205,205,21
Vs 206,206,21
Vs 207,207,21
Vs 128,128,21
Vs 129,129,21
Vs 130,130,21
Vs 131,131,21
Vs 132,132,21
Vs 133,133,21
Vs 134,134,21
Vs 135,135,21
Vs 136,136,21
Vs 137,137,21
Vs 138,138,21
Vs 139,139,21
Vs 140,140,21
Vs 141,141,21
Vs 142,142,21
Vs 143,143,21
Vs 32,32,21
Vs 33,33,21
Vs 34,34,21
v_sub_f32_e64 v35, v35, v21
v_exp_f32 v22, -v21
s_nop 0
Vm 48,48,22
Vm 49,49,22
Vm 50,50,22
v_mul_f32_e64 v51, v51, v22
Ar 8,0
Ar 9,1
Ar 10,2
Ar 11,3
Ar 12,4
Ar 13,5
Ar 14,6
Ar 15,7
Vm 8,8,22
Vm 9,9,22
Vm 10,10,22
Vm 11,11,22
Vm 12,12,22
Vm 13,13,22
Vm 14,14,22
Vm 15,15,22
Aw 0,8
Aw 1,9
Aw 2,10
Aw 3,11
Aw 4,12
Aw 5,13
Aw 6,14
Aw 7,15
Ar 8,8
Ar 9,9
Ar 10,10
Ar 11,11
Ar 12,12
Ar 13,13
Ar 14,14
Ar 15,15
Vm 8,8,22
Vm 9,9,22
Vm 10,10,22
Vm 11,11,22
Vm 12,12,22
Vm 13,13,22
Vm 14,14,22
Vm 15,15,22
Aw 8,8
Aw 9,9
Aw 10,10
Aw 11,11
Aw 12,12
Aw 13,13
Aw 14,14
Aw 15,15
Ar 8,16
Ar 9,17
Ar 10,18
Ar 11,19
Ar 12,20
Ar 13,21
Ar 14,22
Ar 15,23
Vm 8,8,22
Vm 9,9,22
Vm 10,10,22
Vm 11,11,22
Vm 12,12,22
Vm 13,13,22
Vm 14,14,22
Vm 15,15,22
Aw 16,8
Aw 17,9
Aw 18,10
Aw 19,11
Aw 20,12
Aw 21,13
Aw 22,14
Aw 23,15
Ar 8,24
Ar 9,25
Ar 10,26
Ar 11,27
Ar 12,28
Ar 13,29
Ar 14,30
Ar 15,31
Vm 8,8,22
Vm 9,9,22
Vm 10,10,22
Vm 11,11,22
Vm 12,12,22
Vm 13,13,22
Vm 14,14,22
Vm 15,15,22
Aw 24,8
Aw 25,9
Aw 26,10
Aw 27,11
Aw 28,12
Aw 29,13
Aw 30,14
Aw 31,15
v_max3_f32 v21, v208, v209, v210
v_max3_f32 v21, v21, v211, v212
v_max3_f32 v21, v21, v213, v214
v_max3_f32 v21, v21, v215, v216
v_max3_f32 v21, v21, v217, v218
v_max3_f32 v21, v21, v219, v220
v_max3_f32 v21, v21, v221, v222
v_max_f32 v21, v21, v223
v_mov_b32 v1, v21
s_nop 1
v_permlane16_swap_b32 v1, v21
v_max_f32 v21, v21, v1
v_mov_b32 v1, v21
s_nop 1
v_permlane32_swap_b32 v1, v21
v_max_f32_e64 v21, v21, v1
v_add_f32 v21, 0x41f80000, v21
v_max_f32 v21, 0, v21
Vs 208,208,21
Vs 209,209,21
Vs 210,210,21
Vs 211,211,21
Vs 212,212,21
Vs 213,213,21
Vs 214,214,21
Vs 215,215,21
Vs 216,216,21
Vs 217,217,21
Vs 218,218,21
Vs 219,219,21
Vs 220,220,21
Vs 221,221,21
Vs 222,222,21
Vs 223,223,21
Vs 144,144,21
Vs 145,145,21
Vs 146,146,21
Vs 147,147,21
Vs 148,148,21
Vs 149,149,21
Vs 150,150,21
Vs 151,151,21
Vs 152,152,21
Vs 153,153,21
Vs 154,154,21
Vs 155,155,21
Vs 156,156,21
Vs 157,157,21
Vs 158,158,21
Vs 159,159,21
Vs 36,36,21
Vs 37,37,21
Vs 38,38,21
v_sub_f32_e64 v39, v39, v21
v_exp_f32 v22, -v21
s_nop 0
Vm 52,52,22
Vm 53,53,22
Vm 54,54,22
v_mul_f32_e64 v55, v55, v22
Ar 8,32
Ar 9,33
Ar 10,34
Ar 11,35
Ar 12,36
Ar 13,37
Ar 14,38
Ar 15,39
Vm 8,8,22
Vm 9,9,22
Vm 10,10,22
Vm 11,11,22
Vm 12,12,22
Vm 13,13,22
Vm 14,14,22
Vm 15,15,22
Aw 32,8
Aw 33,9
Aw 34,10
Aw 35,11
Aw 36,12
Aw 37,13
Aw 38,14
Aw 39,15
Ar 8,40
Ar 9,41
Ar 10,42
Ar 11,43
Ar 12,44
Ar 13,45
Ar 14,46
Ar 15,47
Vm 8,8,22
Vm 9,9,22
Vm 10,10,22
Vm 11,11,22
Vm 12,12,22
Vm 13,13,22
Vm 14,14,22
Vm 15,15,22
Aw 40,8
Aw 41,9
Aw 42,10
Aw 43,11
Aw 44,12
Aw 45,13
Aw 46,14
Aw 47,15
Ar 8,48
Ar 9,49
Ar 10,50
Ar 11,51
Ar 12,52
Ar 13,53
Ar 14,54
Ar 15,55
Vm 8,8,22
Vm 9,9,22
Vm 10,10,22
Vm 11,11,22
Vm 12,12,22
Vm 13,13,22
Vm 14,14,22
Vm 15,15,22
Aw 48,8
Aw 49,9
Aw 50,10
Aw 51,11
Aw 52,12
Aw 53,13
Aw 54,14
Aw 55,15
Ar 8,56
Ar 9,57
Ar 10,58
Ar 11,59
Ar 12,60
Ar 13,61
Ar 14,62
Ar 15,63
Vm 8,8,22
Vm 9,9,22
Vm 10,10,22
Vm 11,11,22
Vm 12,12,22
Vm 13,13,22
Vm 14,14,22
Vm 15,15,22
Aw 56,8
Aw 57,9
Aw 58,10
Aw 59,11
Aw 60,12
Aw 61,13
Aw 62,14
Aw 63,15
Ve 8,192
Ve 9,193
s_nop 0
Vc 96,8,9
Ve 8,194
Ve 9,195
s_nop 0
Vc 97,8,9
Ve 8,208
Ve 9,209
s_nop 0
Vc 104,8,9
Ve 8,210
Ve 9,211
s_nop 0
Vc 105,8,9
Ve 8,196
Ve 9,197
s_nop 0
Vc 98,8,9
Ve 8,198
Ve 9,199
s_nop 0
Vc 99,8,9
Ve 8,212
Ve 9,213
s_nop 0
Vc 106,8,9
Ve 8,214
Ve 9,215
s_nop 0
Vc 107,8,9
Ve 8,200
Ve 9,201
s_nop 0
Vc 100,8,9
Ve 8,202
Ve 9,203
s_nop 0
Vc 101,8,9
Ve 8,216
Ve 9,217
s_nop 0
Vc 108,8,9
Ve 8,218
Ve 9,219
s_nop 0
Vc 109,8,9
Ve 8,204
Ve 9,205
s_nop 0
Vc 102,8,9
Ve 8,206
Ve 9,207
s_nop 0
Vc 103,8,9
Ve 8,220
Ve 9,221
s_nop 0
Vc 110,8,9
Ve 8,222
Ve 9,223
s_nop 0
Vc 111,8,9
s_nop 1
s_branch L_k2_fbr_no
L_k2_mk_no:
v_cmp_gt_i32 s[56:57], 0, v5
v_cmp_gt_i32 s[58:59], 1, v5
v_cmp_gt_i32 s[60:61], 2, v5
v_cmp_gt_i32 s[62:63], 3, v5
s_nop 3
s_nop 0
v_cndmask_b32 v144, v144, v20, s[56:57]
v_cndmask_b32 v145, v145, v20, s[58:59]
v_cndmask_b32 v146, v146, v20, s[60:61]
v_cndmask_b32 v147, v147, v20, s[62:63]
v_cmp_gt_i32 s[56:57], 16, v5
v_cmp_gt_i32 s[58:59], 17, v5
v_cmp_gt_i32 s[60:61], 18, v5
v_cmp_gt_i32 s[62:63], 19, v5
v_cndmask_b32 v148, v148, v20, s[56:57]
v_cndmask_b32 v149, v149, v20, s[58:59]
v_cndmask_b32 v150, v150, v20, s[60:61]
v_cndmask_b32 v151, v151, v20, s[62:63]
v_cmp_gt_i32 s[56:57], 32, v5
v_cmp_gt_i32 s[58:59], 33, v5
v_cmp_gt_i32 s[60:61], 34, v5
v_cmp_gt_i32 s[62:63], 35, v5
v_cndmask_b32 v152, v152, v20, s[56:57]
v_cndmask_b32 v153, v153, v20, s[58:59]
v_cndmask_b32 v154, v154, v20, s[60:61]
v_cndmask_b32 v155, v155, v20, s[62:63]
v_cmp_gt_i32 s[56:57], 48, v5
v_cmp_gt_i32 s[58:59], 49, v5
v_cmp_gt_i32 s[60:61], 50, v5
v_cmp_gt_i32 s[62:63], 51, v5
v_cndmask_b32 v156, v156, v20, s[56:57]
v_cndmask_b32 v157, v157, v20, s[58:59]
v_cndmask_b32 v158, v158, v20, s[60:61]
v_cndmask_b32 v159, v159, v20, s[62:63]
s_branch L_k2_mkr_no
L_k2_fb_nl:
s_nop 7
v_max3_f32 v21, v128, v129, v130
v_max3_f32 v21, v21, v131, v132
v_max3_f32 v21, v21, v133, v134
v_max3_f32 v21, v21, v135, v136
v_max3_f32 v21, v21, v137, v138
v_max3_f32 v21, v21, v139, v140
v_max3_f32 v21, v21, v141, v142
v_max_f32 v21, v21, v143
v_mov_b32 v1, v21
s_nop 1
v_permlane16_swap_b32 v1, v21
v_max_f32 v21, v21, v1
v_mov_b32 v1, v21
s_nop 1
v_permlane32_swap_b32 v1, v21
v_max_f32_e64 v21, v21, v1
v_add_f32 v21, 0x41f80000, v21
v_max_f32 v21, 0, v21
Vs 128,128,21
Vs 129,129,21
Vs 130,130,21
Vs 131,131,21
Vs 132,132,21
Vs 133,133,21
Vs 134,134,21
Vs 135,135,21
Vs 136,136,21
Vs 137,137,21
Vs 138,138,21
Vs 139,139,21
Vs 140,140,21
Vs 141,141,21
Vs 142,142,21
Vs 143,143,21
Vs 192,192,21
Vs 193,193,21
Vs 194,194,21
Vs 195,195,21
Vs 196,196,21
Vs 197,197,21
Vs 198,198,21
Vs 199,199,21
Vs 200,200,21
Vs 201,201,21
Vs 202,202,21
Vs 203,203,21
Vs 204,204,21
Vs 205,205,21
Vs 206,206,21
Vs 207,207,21
Vs 32,32,21
Vs 33,33,21
Vs 34,34,21
v_sub_f32_e64 v35, v35, v21
v_exp_f32 v22, -v21
s_nop 0
Vm 48,48,22
Vm 49,49,22
Vm 50,50,22
v_mul_f32_e64 v51, v51, v22
Ar 8,0
Ar 9,1
Ar 10,2
Ar 11,3
Ar 12,4
Ar 13,5
Ar 14,6
Ar 15,7
Vm 8,8,22
Vm 9,9,22
Vm 10,10,22
Vm 11,11,22
Vm 12,12,22
Vm 13,13,22
Vm 14,14,22
Vm 15,15,22
Aw 0,8
Aw 1,9
Aw 2,10
Aw 3,11
Aw 4,12
Aw 5,13
Aw 6,14
Aw 7,15
Ar 8,8
Ar 9,9
Ar 10,10
Ar 11,11
Ar 12,12
Ar 13,13
Ar 14,14
Ar 15,15
Vm 8,8,22
Vm 9,9,22
Vm 10,10,22
Vm 11,11,22
Vm 12,12,22
Vm 13,13,22
Vm 14,14,22
Vm 15,15,22
Aw 8,8
Aw 9,9
Aw 10,10
Aw 11,11
Aw 12,12
Aw 13,13
Aw 14,14
Aw 15,15
Ar 8,16
Ar 9,17
Ar 10,18
Ar 11,19
Ar 12,20
Ar 13,21
Ar 14,22
Ar 15,23
Vm 8,8,22
Vm 9,9,22
Vm 10,10,22
Vm 11,11,22
Vm 12,12,22
Vm 13,13,22
Vm 14,14,22
Vm 15,15,22
Aw 16,8
Aw 17,9
Aw 18,10
Aw 19,11
Aw 20,12
Aw 21,13
Aw 22,14
Aw 23,15
Ar 8,24
Ar 9,25
Ar 10,26
Ar 11,27
Ar 12,28
Ar 13,29
Ar 14,30
Ar 15,31
Vm 8,8,22
Vm 9,9,22
Vm 10,10,22
Vm 11,11,22
Vm 12,12,22
Vm 13,13,22
Vm 14,14,22
Vm 15,15,22
Aw 24,8
Aw 25,9
Aw 26,10
Aw 27,11
Aw 28,12
Aw 29,13
Aw 30,14
Aw 31,15
v_max3_f32 v21, v144, v145, v146
v_max3_f32 v21, v21, v147, v148
v_max3_f32 v21, v21, v149, v150
v_max3_f32 v21, v21, v151, v152
v_max3_f32 v21, v21, v153, v154
v_max3_f32 v21, v21, v155, v156
v_max3_f32 v21, v21, v157, v158
v_max_f32 v21, v21, v159
v_mov_b32 v1, v21
s_nop 1
v_permlane16_swap_b32 v1, v21
v_max_f32 v21, v21, v1
v_mov_b32 v1, v21
s_nop 1
v_permlane32_swap_b32 v1, v21
v_max_f32_e64 v21, v21, v1
v_add_f32 v21, 0x41f80000, v21
v_max_f32 v21, 0, v21
Vs 144,144,21
Vs 145,145,21
Vs 146,146,21
Vs 147,147,21
Vs 148,148,21
Vs 149,149,21
Vs 150,150,21
Vs 151,151,21
Vs 152,152,21
Vs 153,153,21
Vs 154,154,21
Vs 155,155,21
Vs 156,156,21
Vs 157,157,21
Vs 158,158,21
Vs 159,159,21
Vs 36,36,21
Vs 37,37,21
Vs 38,38,21
v_sub_f32_e64 v39, v39, v21
v_exp_f32 v22, -v21
s_nop 0
Vm 52,52,22
Vm 53,53,22
Vm 54,54,22
v_mul_f32_e64 v55, v55, v22
Ar 8,32
Ar 9,33
Ar 10,34
Ar 11,35
Ar 12,36
Ar 13,37
Ar 14,38
Ar 15,39
Vm 8,8,22
Vm 9,9,22
Vm 10,10,22
Vm 11,11,22
Vm 12,12,22
Vm 13,13,22
Vm 14,14,22
Vm 15,15,22
Aw 32,8
Aw 33,9
Aw 34,10
Aw 35,11
Aw 36,12
Aw 37,13
Aw 38,14
Aw 39,15
Ar 8,40
Ar 9,41
Ar 10,42
Ar 11,43
Ar 12,44
Ar 13,45
Ar 14,46
Ar 15,47
Vm 8,8,22
Vm 9,9,22
Vm 10,10,22
Vm 11,11,22
Vm 12,12,22
Vm 13,13,22
Vm 14,14,22
Vm 15,15,22
Aw 40,8
Aw 41,9
Aw 42,10
Aw 43,11
Aw 44,12
Aw 45,13
Aw 46,14
Aw 47,15
Ar 8,48
Ar 9,49
Ar 10,50
Ar 11,51
Ar 12,52
Ar 13,53
Ar 14,54
Ar 15,55
Vm 8,8,22
Vm 9,9,22
Vm 10,10,22
Vm 11,11,22
Vm 12,12,22
Vm 13,13,22
Vm 14,14,22
Vm 15,15,22
Aw 48,8
Aw 49,9
Aw 50,10
Aw 51,11
Aw 52,12
Aw 53,13
Aw 54,14
Aw 55,15
Ar 8,56
Ar 9,57
Ar 10,58
Ar 11,59
Ar 12,60
Ar 13,61
Ar 14,62
Ar 15,63
Vm 8,8,22
Vm 9,9,22
Vm 10,10,22
Vm 11,11,22
Vm 12,12,22
Vm 13,13,22
Vm 14,14,22
Vm 15,15,22
Aw 56,8
Aw 57,9
Aw 58,10
Aw 59,11
Aw 60,12
Aw 61,13
Aw 62,14
Aw 63,15
Ve 8,128
Ve 9,129
s_nop 0
Vc 64,8,9
Ve 8,130
Ve 9,131
s_nop 0
Vc 65,8,9
Ve 8,144
Ve 9,145
s_nop 0
Vc 72,8,9
Ve 8,146
Ve 9,147
s_nop 0
Vc 73,8,9
Ve 8,132
Ve 9,133
s_nop 0
Vc 66,8,9
Ve 8,134
Ve 9,135
s_nop 0
Vc 67,8,9
Ve 8,148
Ve 9,149
s_nop 0
Vc 74,8,9
Ve 8,150
Ve 9,151
s_nop 0
Vc 75,8,9
Ve 8,136
Ve 9,137
s_nop 0
Vc 68,8,9
Ve 8,138
Ve 9,139
s_nop 0
Vc 69,8,9
Ve 8,152
Ve 9,153
s_nop 0
Vc 76,8,9
Ve 8,154
Ve 9,155
s_nop 0
Vc 77,8,9
Ve 8,140
Ve 9,141
s_nop 0
Vc 70,8,9
Ve 8,142
Ve 9,143
s_nop 0
Vc 71,8,9
Ve 8,156
Ve 9,157
s_nop 0
Vc 78,8,9
Ve 8,158
Ve 9,159
s_nop 0
Vc 79,8,9
s_nop 1
s_branch L_k2_fbr_nl
L_k2_mk_nl:
v_cmp_gt_i32 s[56:57], 0, v6
v_cmp_gt_i32 s[58:59], 1, v6
v_cmp_gt_i32 s[60:61], 2, v6
v_cmp_gt_i32 s[62:63], 3, v6
s_nop 3
s_nop 0
v_cndmask_b32 v192, v192, v20, s[56:57]
v_cndmask_b32 v193, v193, v20, s[58:59]
v_cndmask_b32 v194, v194, v20, s[60:61]
v_cndmask_b32 v195, v195, v20, s[62:63]
v_cmp_gt_i32 s[56:57], 16, v6
v_cmp_gt_i32 s[58:59], 17, v6
v_cmp_gt_i32 s[60:61], 18, v6
v_cmp_gt_i32 s[62:63], 19, v6
v_cndmask_b32 v196, v196, v20, s[56:57]
v_cndmask_b32 v197, v197, v20, s[58:59]
v_cndmask_b32 v198, v198, v20, s[60:61]
v_cndmask_b32 v199, v199, v20, s[62:63]
v_cmp_gt_i32 s[56:57], 32, v6
v_cmp_gt_i32 s[58:59], 33, v6
v_cmp_gt_i32 s[60:61], 34, v6
v_cmp_gt_i32 s[62:63], 35, v6
v_cndmask_b32 v200, v200, v20, s[56:57]
v_cndmask_b32 v201, v201, v20, s[58:59]
v_cndmask_b32 v202, v202, v20, s[60:61]
v_cndmask_b32 v203, v203, v20, s[62:63]
v_cmp_gt_i32 s[56:57], 48, v6
v_cmp_gt_i32 s[58:59], 49, v6
v_cmp_gt_i32 s[60:61], 50, v6
v_cmp_gt_i32 s[62:63], 51, v6
v_cndmask_b32 v204, v204, v20, s[56:57]
v_cndmask_b32 v205, v205, v20, s[58:59]
v_cndmask_b32 v206, v206, v20, s[60:61]
v_cndmask_b32 v207, v207, v20, s[62:63]
s_branch L_k2_mkr_nl
L_k2_fb_fi:
s_nop 7
v_max3_f32 v21, v192, v193, v194
v_max3_f32 v21, v21, v195, v196
v_max3_f32 v21, v21, v197, v198
v_max3_f32 v21, v21, v199, v200
v_max3_f32 v21, v21, v201, v202
v_max3_f32 v21, v21, v203, v204
v_max3_f32 v21, v21, v205, v206
v_max_f32 v21, v21, v207
v_mov_b32 v1, v21
s_nop 1
v_permlane16_swap_b32 v1, v21
v_max_f32 v21, v21, v1
v_mov_b32 v1, v21
s_nop 1
v_permlane32_swap_b32 v1, v21
v_max_f32_e64 v21, v21, v1
v_add_f32 v21, 0x41f80000, v21
v_max_f32 v21, 0, v21
Vs 192,192,21
Vs 193,193,21
Vs 194,194,21
Vs 195,195,21
Vs 196,196,21
Vs 197,197,21
Vs 198,198,21
Vs 199,199,21
Vs 200,200,21
Vs 201,201,21
Vs 202,202,21
Vs 203,203,21
Vs 204,204,21
Vs 205,205,21
Vs 206,206,21
Vs 207,207,21
Vs 32,32,21
Vs 33,33,21
Vs 34,34,21
v_sub_f32_e64 v35, v35, v21
v_exp_f32 v22, -v21
s_nop 0
Vm 48,48,22
Vm 49,49,22
Vm 50,50,22
v_mul_f32_e64 v51, v51, v22
Ar 8,0
Ar 9,1
Ar 10,2
Ar 11,3
Ar 12,4
Ar 13,5
Ar 14,6
Ar 15,7
Vm 8,8,22
Vm 9,9,22
Vm 10,10,22
Vm 11,11,22
Vm 12,12,22
Vm 13,13,22
Vm 14,14,22
Vm 15,15,22
Aw 0,8
Aw 1,9
Aw 2,10
Aw 3,11
Aw 4,12
Aw 5,13
Aw 6,14
Aw 7,15
Ar 8,8
Ar 9,9
Ar 10,10
Ar 11,11
Ar 12,12
Ar 13,13
Ar 14,14
Ar 15,15
Vm 8,8,22
Vm 9,9,22
Vm 10,10,22
Vm 11,11,22
Vm 12,12,22
Vm 13,13,22
Vm 14,14,22
Vm 15,15,22
Aw 8,8
Aw 9,9
Aw 10,10
Aw 11,11
Aw 12,12
Aw 13,13
Aw 14,14
Aw 15,15
Ar 8,16
Ar 9,17
Ar 10,18
Ar 11,19
Ar 12,20
Ar 13,21
Ar 14,22
Ar 15,23
Vm 8,8,22
Vm 9,9,22
Vm 10,10,22
Vm 11,11,22
Vm 12,12,22
Vm 13,13,22
Vm 14,14,22
Vm 15,15,22
Aw 16,8
Aw 17,9
Aw 18,10
Aw 19,11
Aw 20,12
Aw 21,13
Aw 22,14
Aw 23,15
Ar 8,24
Ar 9,25
Ar 10,26
Ar 11,27
Ar 12,28
Ar 13,29
Ar 14,30
Ar 15,31
Vm 8,8,22
Vm 9,9,22
Vm 10,10,22
Vm 11,11,22
Vm 12,12,22
Vm 13,13,22
Vm 14,14,22
Vm 15,15,22
Aw 24,8
Aw 25,9
Aw 26,10
Aw 27,11
Aw 28,12
Aw 29,13
Aw 30,14
Aw 31,15
Ve 8,192
Ve 9,193
s_nop 0
Vc 96,8,9
Ve 8,194
Ve 9,195
s_nop 0
Vc 97,8,9
Ve 8,196
Ve 9,197
s_nop 0
Vc 98,8,9
Ve 8,198
Ve 9,199
s_nop 0
Vc 99,8,9
Ve 8,200
Ve 9,201
s_nop 0
Vc 100,8,9
Ve 8,202
Ve 9,203
s_nop 0
Vc 101,8,9
Ve 8,204
Ve 9,205
s_nop 0
Vc 102,8,9
Ve 8,206
Ve 9,207
s_nop 0
Vc 103,8,9
s_nop 1
s_branch L_k2_fbr_fi
L_spinX:
s_mov_b32 s47, 0x400000
L_spinXl:
buffer_load_dword v17, v126, s[20:23], s24 offen sc1
s_sub_u32 s47, s47, 1
s_waitcnt vmcnt(0)
s_cmp_eq_u32 s47, 0
s_cbranch_scc1 L_spinXlx
v_cmp_ne_u32 vcc, 1, v17
s_cbranch_vccz L_spinXlx
s_sleep 1
s_branch L_spinXl
L_spinXlx:
buffer_load_dwordx4 v[160:163], v112, s[16:19], s25 offen offset:0 sc1
buffer_load_dwordx4 v[164:167], v112, s[16:19], s25 offen offset:1024 sc1
buffer_load_dwordx4 v[168:171], v112, s[16:19], s25 offen offset:2048 sc1
buffer_load_dwordx4 v[172:175], v112, s[16:19], s25 offen offset:3072 sc1
buffer_load_dwordx4 v[176:179], v10, s[16:19], s25 offen offset:0 sc1
buffer_load_dwordx4 v[180:183], v10, s[16:19], s25 offen offset:1024 sc1
buffer_load_dwordx4 v[184:187], v10, s[16:19], s25 offen offset:2048 sc1
buffer_load_dwordx4 v[188:191], v10, s[16:19], s25 offen offset:3072 sc1
s_branch L_spinXr
L_ysl:
s_mov_b32 s47, 0x400000
L_ysll:
buffer_load_dword v124, v127, s[20:23], s41 offen sc1
s_sub_u32 s47, s47, 1
s_waitcnt vmcnt(0)
s_cmp_eq_u32 s47, 0
s_cbranch_scc1 L_ysllx
v_cmp_ne_u32 vcc, 1, v124
s_cbranch_vccz L_ysllx
s_sleep 8
s_branch L_ysll
L_ysllx:
v_lshlrev_b32 v125, 10, v123
v_lshl_add_u32 v125, v122, 5, v125
v_mov_b32 v124, 2146435072
v_cmp_gt_u32 vcc, 7, v123
s_nop 1
v_cndmask_b32 v125, v124, v125, vcc
s_nop 0
buffer_load_dwordx4 v[80:83], v125, s[20:23], s55 offen offset:0 sc1
buffer_load_dwordx4 v[84:87], v125, s[20:23], s55 offen offset:16 sc1
buffer_load_dwordx4 v[88:91], v125, s[20:23], s55 offen offset:256 sc1
buffer_load_dwordx4 v[92:95], v125, s[20:23], s55 offen offset:272 sc1
buffer_load_dwordx4 v[96:99], v125, s[20:23], s55 offen offset:512 sc1
buffer_load_dwordx4 v[100:103], v125, s[20:23], s55 offen offset:528 sc1
buffer_load_dwordx4 v[104:107], v125, s[20:23], s55 offen offset:768 sc1
buffer_load_dwordx4 v[108:111], v125, s[20:23], s55 offen offset:784 sc1
s_waitcnt vmcnt(0)
s_nop 0
v_pk_add_f32 v[80:81], v[80:81], v[96:97]
v_pk_add_f32 v[82:83], v[82:83], v[98:99]
v_pk_add_f32 v[84:85], v[84:85], v[100:101]
v_pk_add_f32 v[86:87], v[86:87], v[102:103]
v_pk_add_f32 v[88:89], v[88:89], v[104:105]
v_pk_add_f32 v[90:91], v[90:91], v[106:107]
v_pk_add_f32 v[92:93], v[92:93], v[108:109]
v_pk_add_f32 v[94:95], v[94:95], v[110:111]
v_add_f32_dpp v80, v80, v80 row_ror:8 row_mask:0xf bank_mask:0xf
v_add_f32_dpp v81, v81, v81 row_ror:8 row_mask:0xf bank_mask:0xf
v_add_f32_dpp v82, v82, v82 row_ror:8 row_mask:0xf bank_mask:0xf
v_add_f32_dpp v83, v83, v83 row_ror:8 row_mask:0xf bank_mask:0xf
v_add_f32_dpp v84, v84, v84 row_ror:8 row_mask:0xf bank_mask:0xf
v_add_f32_dpp v85, v85, v85 row_ror:8 row_mask:0xf bank_mask:0xf
v_add_f32_dpp v86, v86, v86 row_ror:8 row_mask:0xf bank_mask:0xf
v_add_f32_dpp v87, v87, v87 row_ror:8 row_mask:0xf bank_mask:0xf
v_add_f32_dpp v88, v88, v88 row_ror:8 row_mask:0xf bank_mask:0xf
v_add_f32_dpp v89, v89, v89 row_ror:8 row_mask:0xf bank_mask:0xf
v_add_f32_dpp v90, v90, v90 row_ror:8 row_mask:0xf bank_mask:0xf
v_add_f32_dpp v91, v91, v91 row_ror:8 row_mask:0xf bank_mask:0xf
v_add_f32_dpp v92, v92, v92 row_ror:8 row_mask:0xf bank_mask:0xf
v_add_f32_dpp v93, v93, v93 row_ror:8 row_mask:0xf bank_mask:0xf
v_add_f32_dpp v94, v94, v94 row_ror:8 row_mask:0xf bank_mask:0xf
v_add_f32_dpp v95, v95, v95 row_ror:8 row_mask:0xf bank_mask:0xf
v_mov_b32 v96, v80
v_mov_b32 v97, v81
v_mov_b32 v98, v82
v_mov_b32 v99, v83
v_mov_b32 v100, v84
v_mov_b32 v101, v85
v_mov_b32 v102, v86
v_mov_b32 v103, v87
v_mov_b32 v104, v88
v_mov_b32 v105, v89
v_mov_b32 v106, v90
v_mov_b32 v107, v91
v_mov_b32 v108, v92
v_mov_b32 v109, v93
v_mov_b32 v110, v94
v_mov_b32 v111, v95
v_permlane16_swap_b32 v96, v80
v_permlane16_swap_b32 v97, v81
v_permlane16_swap_b32 v98, v82
v_permlane16_swap_b32 v99, v83
v_permlane16_swap_b32 v100, v84
v_permlane16_swap_b32 v101, v85
v_permlane16_swap_b32 v102, v86
v_permlane16_swap_b32 v103, v87
v_permlane16_swap_b32 v104, v88
v_permlane16_swap_b32 v105, v89
v_permlane16_swap_b32 v106, v90
v_permlane16_swap_b32 v107, v91
v_permlane16_swap_b32 v108, v92
v_permlane16_swap_b32 v109, v93
v_permlane16_swap_b32 v110, v94
v_permlane16_swap_b32 v111, v95
v_pk_add_f32 v[80:81], v[80:81], v[96:97]
v_pk_add_f32 v[82:83], v[82:83], v[98:99]
v_pk_add_f32 v[84:85], v[84:85], v[100:101]
v_pk_add_f32 v[86:87], v[86:87], v[102:103]
v_pk_add_f32 v[88:89], v[88:89], v[104:105]
v_pk_add_f32 v[90:91], v[90:91], v[106:107]
v_pk_add_f32 v[92:93], v[92:93], v[108:109]
v_pk_add_f32 v[94:95], v[94:95], v[110:111]
v_mov_b32 v96, v80
v_mov_b32 v97, v81
v_mov_b32 v98, v82
v_mov_b32 v99, v83
v_mov_b32 v100, v84
v_mov_b32 v101, v85
v_mov_b32 v102, v86
v_mov_b32 v103, v87
v_mov_b32 v104, v88
v_mov_b32 v105, v89
v_mov_b32 v106, v90
v_mov_b32 v107, v91
v_mov_b32 v108, v92
v_mov_b32 v109, v93
v_mov_b32 v110, v94
v_mov_b32 v111, v95
v_permlane32_swap_b32 v96, v80
v_permlane32_swap_b32 v97, v81
v_permlane32_swap_b32 v98, v82
v_permlane32_swap_b32 v99, v83
v_permlane32_swap_b32 v100, v84
v_permlane32_swap_b32 v101, v85
v_permlane32_swap_b32 v102, v86
v_permlane32_swap_b32 v103, v87
v_permlane32_swap_b32 v104, v88
v_permlane32_swap_b32 v105, v89
v_permlane32_swap_b32 v106, v90
v_permlane32_swap_b32 v107, v91
v_permlane32_swap_b32 v108, v92
v_permlane32_swap_b32 v109, v93
v_permlane32_swap_b32 v110, v94
v_permlane32_swap_b32 v111, v95
v_pk_add_f32 v[80:81], v[80:81], v[96:97]
v_pk_add_f32 v[82:83], v[82:83], v[98:99]
v_pk_add_f32 v[84:85], v[84:85], v[100:101]
v_pk_add_f32 v[86:87], v[86:87], v[102:103]
v_pk_add_f32 v[88:89], v[88:89], v[104:105]
v_pk_add_f32 v[90:91], v[90:91], v[106:107]
v_pk_add_f32 v[92:93], v[92:93], v[108:109]
v_pk_add_f32 v[94:95], v[94:95], v[110:111]
Vc 124,80,81
v_lshlrev_b32_e64 v80, 16, v124
v_and_b32 v81, 0xffff0000, v124
Vc 124,82,83
v_lshlrev_b32_e64 v82, 16, v124
v_and_b32 v83, 0xffff0000, v124
Vc 124,84,85
v_lshlrev_b32_e64 v84, 16, v124
v_and_b32 v85, 0xffff0000, v124
Vc 124,86,87
v_lshlrev_b32_e64 v86, 16, v124
v_and_b32 v87, 0xffff0000, v124
Vc 124,88,89
v_lshlrev_b32_e64 v88, 16, v124
v_and_b32 v89, 0xffff0000, v124
Vc 124,90,91
v_lshlrev_b32_e64 v90, 16, v124
v_and_b32 v91, 0xffff0000, v124
Vc 124,92,93
v_lshlrev_b32_e64 v92, 16, v124
v_and_b32 v93, 0xffff0000, v124
Vc 124,94,95
v_lshlrev_b32_e64 v94, 16, v124
v_and_b32 v95, 0xffff0000, v124
v_mul_f32 v80, s100, v80
v_mul_f32 v81, s100, v81
v_mul_f32 v82, s100, v82
v_mul_f32 v83, s100, v83
v_mul_f32 v84, s100, v84
v_mul_f32 v85, s100, v85
v_mul_f32 v86, s100, v86
v_mul_f32 v87, s100, v87
v_mul_f32 v88, s101, v88
v_mul_f32 v89, s101, v89
v_mul_f32 v90, s101, v90
v_mul_f32 v91, s101, v91
v_mul_f32 v92, s101, v92
v_mul_f32 v93, s101, v93
v_mul_f32 v94, s101, v94
v_mul_f32 v95, s101, v95
Vc 124,80,81
v_lshlrev_b32_e64 v80, 16, v124
v_and_b32 v81, 0xffff0000, v124
Vc 124,82,83
v_lshlrev_b32_e64 v82, 16, v124
v_and_b32 v83, 0xffff0000, v124
Vc 124,84,85
v_lshlrev_b32_e64 v84, 16, v124
v_and_b32 v85, 0xffff0000, v124
Vc 124,86,87
v_lshlrev_b32_e64 v86, 16, v124
v_and_b32 v87, 0xffff0000, v124
Vc 124,88,89
v_lshlrev_b32_e64 v88, 16, v124
v_and_b32 v89, 0xffff0000, v124
Vc 124,90,91
v_lshlrev_b32_e64 v90, 16, v124
v_and_b32 v91, 0xffff0000, v124
Vc 124,92,93
v_lshlrev_b32_e64 v92, 16, v124
v_and_b32 v93, 0xffff0000, v124
Vc 124,94,95
v_lshlrev_b32_e64 v94, 16, v124
v_and_b32 v95, 0xffff0000, v124
s_lshl_b32 s3, s45, 7
s_sub_u32 s42, s42, s3
s_sub_u32 s43, s43, s3
v_add_u32 v124, 0, v120
v_cmp_eq_u32 vcc, s42, v124
v_cmp_eq_u32 s[6:7], s43, v124
s_nop 3
s_or_b64 s[4:5], vcc, s[6:7]
s_cbranch_scc0 L_f_selskip5
v_cndmask_b32 v96, 0, v80, vcc
v_cndmask_b32 v96, v96, v88, s[6:7]
v_cndmask_b32 v97, 0, v81, vcc
v_cndmask_b32 v97, v97, v89, s[6:7]
v_cndmask_b32 v98, 0, v82, vcc
v_cndmask_b32 v98, v98, v90, s[6:7]
v_cndmask_b32 v99, 0, v83, vcc
v_cndmask_b32 v99, v99, v91, s[6:7]
v_cndmask_b32 v100, 0, v84, vcc
v_cndmask_b32 v100, v100, v92, s[6:7]
v_cndmask_b32 v101, 0, v85, vcc
v_cndmask_b32 v101, v101, v93, s[6:7]
v_cndmask_b32 v102, 0, v86, vcc
v_cndmask_b32 v102, v102, v94, s[6:7]
v_cndmask_b32 v103, 0, v87, vcc
v_cndmask_b32 v103, v103, v95, s[6:7]
v_lshlrev_b32_e64 v42, 16, v18
v_and_b32 v43, 0xffff0000, v18
v_lshlrev_b32_e64 v44, 16, v19
v_and_b32 v45, 0xffff0000, v19
v_lshlrev_b32_e64 v46, 16, v20
v_and_b32 v47, 0xffff0000, v20
v_lshlrev_b32_e64 v48, 16, v21
v_and_b32 v49, 0xffff0000, v21
v_pk_add_f32 v[42:43], v[42:43], v[34:35] op_sel_hi:[1,0] neg_lo:[0,1] neg_hi:[0,1]
v_pk_add_f32 v[44:45], v[44:45], v[34:35] op_sel_hi:[1,0] neg_lo:[0,1] neg_hi:[0,1]
v_pk_add_f32 v[46:47], v[46:47], v[34:35] op_sel_hi:[1,0] neg_lo:[0,1] neg_hi:[0,1]
v_pk_add_f32 v[48:49], v[48:49], v[34:35] op_sel_hi:[1,0] neg_lo:[0,1] neg_hi:[0,1]
Vc 2,42,43
v_lshlrev_b32_e64 v42, 16, v2
v_and_b32 v43, 0xffff0000, v2
Vc 3,44,45
v_lshlrev_b32_e64 v44, 16, v3
v_and_b32 v45, 0xffff0000, v3
Vc 4,46,47
v_lshlrev_b32_e64 v46, 16, v4
v_and_b32 v47, 0xffff0000, v4
Vc 5,48,49
v_lshlrev_b32_e64 v48, 16, v5
v_and_b32 v49, 0xffff0000, v5
v_pk_mul_f32 v[42:43], v[42:43], v[34:35] op_sel:[0,1] op_sel_hi:[1,1]
v_pk_mul_f32 v[44:45], v[44:45], v[34:35] op_sel:[0,1] op_sel_hi:[1,1]
v_pk_mul_f32 v[46:47], v[46:47], v[34:35] op_sel:[0,1] op_sel_hi:[1,1]
v_pk_mul_f32 v[48:49], v[48:49], v[34:35] op_sel:[0,1] op_sel_hi:[1,1]
Vc 2,42,43
v_lshlrev_b32_e64 v42, 16, v2
v_and_b32 v43, 0xffff0000, v2
Vc 3,44,45
v_lshlrev_b32_e64 v44, 16, v3
v_and_b32 v45, 0xffff0000, v3
Vc 4,46,47
v_lshlrev_b32_e64 v46, 16, v4
v_and_b32 v47, 0xffff0000, v4
Vc 5,48,49
v_lshlrev_b32_e64 v48, 16, v5
v_and_b32 v49, 0xffff0000, v5
v_pk_add_f32 v[42:43], v[42:43], v[96:97]
v_pk_add_f32 v[44:45], v[44:45], v[98:99]
v_pk_add_f32 v[46:47], v[46:47], v[100:101]
v_pk_add_f32 v[48:49], v[48:49], v[102:103]
Vc 2,42,43
v_lshlrev_b32_e64 v42, 16, v2
v_and_b32 v43, 0xffff0000, v2
Vc 3,44,45
v_lshlrev_b32_e64 v44, 16, v3
v_and_b32 v45, 0xffff0000, v3
Vc 4,46,47
v_lshlrev_b32_e64 v46, 16, v4
v_and_b32 v47, 0xffff0000, v4
Vc 5,48,49
v_lshlrev_b32_e64 v48, 16, v5
v_and_b32 v49, 0xffff0000, v5
v_mul_f32 v2, 0xbfb8aa3b, v42
v_mul_f32 v3, 0xbfb8aa3b, v43
v_mul_f32 v4, 0xbfb8aa3b, v44
v_mul_f32 v5, 0xbfb8aa3b, v45
v_mul_f32 v6, 0xbfb8aa3b, v46
v_mul_f32 v7, 0xbfb8aa3b, v47
v_mul_f32 v8, 0xbfb8aa3b, v48
v_mul_f32 v9, 0xbfb8aa3b, v49
Ve 2,2
Ve 3,3
Ve 4,4
Ve 5,5
Ve 6,6
Ve 7,7
Ve 8,8
Ve 9,9
v_add_f32 v2, 1.0, v2
v_add_f32 v3, 1.0, v3
v_add_f32 v4, 1.0, v4
v_add_f32 v5, 1.0, v5
v_add_f32 v6, 1.0, v6
v_add_f32 v7, 1.0, v7
v_add_f32 v8, 1.0, v8
v_add_f32 v9, 1.0, v9
v_rcp_f32 v2, v2
v_rcp_f32 v3, v3
v_rcp_f32 v4, v4
v_rcp_f32 v5, v5
v_rcp_f32 v6, v6
v_rcp_f32 v7, v7
v_rcp_f32 v8, v8
v_rcp_f32 v9, v9
v_pk_mul_f32 v[42:43], v[42:43], v[2:3]
v_pk_mul_f32 v[44:45], v[44:45], v[4:5]
v_pk_mul_f32 v[46:47], v[46:47], v[6:7]
v_pk_mul_f32 v[48:49], v[48:49], v[8:9]
Vc 2,42,43
v_lshlrev_b32_e64 v42, 16, v2
v_and_b32 v43, 0xffff0000, v2
Vc 3,44,45
v_lshlrev_b32_e64 v44, 16, v3
v_and_b32 v45, 0xffff0000, v3
Vc 4,46,47
v_lshlrev_b32_e64 v46, 16, v4
v_and_b32 v47, 0xffff0000, v4
Vc 5,48,49
v_lshlrev_b32_e64 v48, 16, v5
v_and_b32 v49, 0xffff0000, v5
L_f_selskip5:
v_add_u32 v124, 8, v120
v_cmp_eq_u32 vcc, s42, v124
v_cmp_eq_u32 s[6:7], s43, v124
s_nop 3
s_or_b64 s[4:5], vcc, s[6:7]
s_cbranch_scc0 L_f_selskip6
v_cndmask_b32 v96, 0, v80, vcc
v_cndmask_b32 v96, v96, v88, s[6:7]
v_cndmask_b32 v97, 0, v81, vcc
v_cndmask_b32 v97, v97, v89, s[6:7]
v_cndmask_b32 v98, 0, v82, vcc
v_cndmask_b32 v98, v98, v90, s[6:7]
v_cndmask_b32 v99, 0, v83, vcc
v_cndmask_b32 v99, v99, v91, s[6:7]
v_cndmask_b32 v100, 0, v84, vcc
v_cndmask_b32 v100, v100, v92, s[6:7]
v_cndmask_b32 v101, 0, v85, vcc
v_cndmask_b32 v101, v101, v93, s[6:7]
v_cndmask_b32 v102, 0, v86, vcc
v_cndmask_b32 v102, v102, v94, s[6:7]
v_cndmask_b32 v103, 0, v87, vcc
v_cndmask_b32 v103, v103, v95, s[6:7]
v_lshlrev_b32 v50, 16, v22
v_and_b32 v51, 0xffff0000, v22
v_lshlrev_b32_e64 v52, 16, v23
v_and_b32 v53, 0xffff0000, v23
v_lshlrev_b32_e64 v54, 16, v24
v_and_b32 v55, 0xffff0000, v24
v_lshlrev_b32_e64 v56, 16, v25
v_and_b32 v57, 0xffff0000, v25
v_pk_add_f32 v[50:51], v[50:51], v[36:37] op_sel_hi:[1,0] neg_lo:[0,1] neg_hi:[0,1]
v_pk_add_f32 v[52:53], v[52:53], v[36:37] op_sel_hi:[1,0] neg_lo:[0,1] neg_hi:[0,1]
v_pk_add_f32 v[54:55], v[54:55], v[36:37] op_sel_hi:[1,0] neg_lo:[0,1] neg_hi:[0,1]
v_pk_add_f32 v[56:57], v[56:57], v[36:37] op_sel_hi:[1,0] neg_lo:[0,1] neg_hi:[0,1]
Vc 2,50,51
v_lshlrev_b32_e64 v50, 16, v2
v_and_b32 v51, 0xffff0000, v2
Vc 3,52,53
v_lshlrev_b32_e64 v52, 16, v3
v_and_b32 v53, 0xffff0000, v3
Vc 4,54,55
v_lshlrev_b32_e64 v54, 16, v4
v_and_b32 v55, 0xffff0000, v4
Vc 5,56,57
v_lshlrev_b32_e64 v56, 16, v5
v_and_b32 v57, 0xffff0000, v5
v_pk_mul_f32 v[50:51], v[50:51], v[36:37] op_sel:[0,1] op_sel_hi:[1,1]
v_pk_mul_f32 v[52:53], v[52:53], v[36:37] op_sel:[0,1] op_sel_hi:[1,1]
v_pk_mul_f32 v[54:55], v[54:55], v[36:37] op_sel:[0,1] op_sel_hi:[1,1]
v_pk_mul_f32 v[56:57], v[56:57], v[36:37] op_sel:[0,1] op_sel_hi:[1,1]
Vc 2,50,51
v_lshlrev_b32_e64 v50, 16, v2
v_and_b32 v51, 0xffff0000, v2
Vc 3,52,53
v_lshlrev_b32_e64 v52, 16, v3
v_and_b32 v53, 0xffff0000, v3
Vc 4,54,55
v_lshlrev_b32_e64 v54, 16, v4
v_and_b32 v55, 0xffff0000, v4
Vc 5,56,57
v_lshlrev_b32_e64 v56, 16, v5
v_and_b32 v57, 0xffff0000, v5
v_pk_add_f32 v[50:51], v[50:51], v[96:97]
v_pk_add_f32 v[52:53], v[52:53], v[98:99]
v_pk_add_f32 v[54:55], v[54:55], v[100:101]
v_pk_add_f32 v[56:57], v[56:57], v[102:103]
Vc 2,50,51
v_lshlrev_b32_e64 v50, 16, v2
v_and_b32 v51, 0xffff0000, v2
Vc 3,52,53
v_lshlrev_b32_e64 v52, 16, v3
v_and_b32 v53, 0xffff0000, v3
Vc 4,54,55
v_lshlrev_b32_e64 v54, 16, v4
v_and_b32 v55, 0xffff0000, v4
Vc 5,56,57
v_lshlrev_b32_e64 v56, 16, v5
v_and_b32 v57, 0xffff0000, v5
v_mul_f32 v2, 0xbfb8aa3b, v50
v_mul_f32 v3, 0xbfb8aa3b, v51
v_mul_f32 v4, 0xbfb8aa3b, v52
v_mul_f32 v5, 0xbfb8aa3b, v53
v_mul_f32 v6, 0xbfb8aa3b, v54
v_mul_f32 v7, 0xbfb8aa3b, v55
v_mul_f32 v8, 0xbfb8aa3b, v56
v_mul_f32 v9, 0xbfb8aa3b, v57
Ve 2,2
Ve 3,3
Ve 4,4
Ve 5,5
Ve 6,6
Ve 7,7
Ve 8,8
Ve 9,9
v_add_f32 v2, 1.0, v2
v_add_f32 v3, 1.0, v3
v_add_f32 v4, 1.0, v4
v_add_f32 v5, 1.0, v5
v_add_f32 v6, 1.0, v6
v_add_f32 v7, 1.0, v7
v_add_f32 v8, 1.0, v8
v_add_f32 v9, 1.0, v9
v_rcp_f32 v2, v2
v_rcp_f32 v3, v3
v_rcp_f32 v4, v4
v_rcp_f32 v5, v5
v_rcp_f32 v6, v6
v_rcp_f32 v7, v7
v_rcp_f32 v8, v8
v_rcp_f32 v9, v9
v_pk_mul_f32 v[50:51], v[50:51], v[2:3]
v_pk_mul_f32 v[52:53], v[52:53], v[4:5]
v_pk_mul_f32 v[54:55], v[54:55], v[6:7]
v_pk_mul_f32 v[56:57], v[56:57], v[8:9]
Vc 2,50,51
v_lshlrev_b32_e64 v50, 16, v2
v_and_b32 v51, 0xffff0000, v2
Vc 3,52,53
v_lshlrev_b32_e64 v52, 16, v3
v_and_b32 v53, 0xffff0000, v3
Vc 4,54,55
v_lshlrev_b32_e64 v54, 16, v4
v_and_b32 v55, 0xffff0000, v4
Vc 5,56,57
v_lshlrev_b32_e64 v56, 16, v5
v_and_b32 v57, 0xffff0000, v5
L_f_selskip6:
v_add_u32 v124, 16, v120
v_cmp_eq_u32 vcc, s42, v124
v_cmp_eq_u32 s[6:7], s43, v124
s_nop 3
s_or_b64 s[4:5], vcc, s[6:7]
s_cbranch_scc0 L_f_selskip7
v_cndmask_b32 v96, 0, v80, vcc
v_cndmask_b32 v96, v96, v88, s[6:7]
v_cndmask_b32 v97, 0, v81, vcc
v_cndmask_b32 v97, v97, v89, s[6:7]
v_cndmask_b32 v98, 0, v82, vcc
v_cndmask_b32 v98, v98, v90, s[6:7]
v_cndmask_b32 v99, 0, v83, vcc
v_cndmask_b32 v99, v99, v91, s[6:7]
v_cndmask_b32 v100, 0, v84, vcc
v_cndmask_b32 v100, v100, v92, s[6:7]
v_cndmask_b32 v101, 0, v85, vcc
v_cndmask_b32 v101, v101, v93, s[6:7]
v_cndmask_b32 v102, 0, v86, vcc
v_cndmask_b32 v102, v102, v94, s[6:7]
v_cndmask_b32 v103, 0, v87, vcc
v_cndmask_b32 v103, v103, v95, s[6:7]
v_lshlrev_b32 v58, 16, v26
v_and_b32 v59, 0xffff0000, v26
v_lshlrev_b32_e64 v60, 16, v27
v_and_b32 v61, 0xffff0000, v27
v_lshlrev_b32_e64 v62, 16, v28
v_and_b32 v63, 0xffff0000, v28
v_lshlrev_b32_e64 v64, 16, v29
v_and_b32 v65, 0xffff0000, v29
v_pk_add_f32 v[58:59], v[58:59], v[38:39] op_sel_hi:[1,0] neg_lo:[0,1] neg_hi:[0,1]
v_pk_add_f32 v[60:61], v[60:61], v[38:39] op_sel_hi:[1,0] neg_lo:[0,1] neg_hi:[0,1]
v_pk_add_f32 v[62:63], v[62:63], v[38:39] op_sel_hi:[1,0] neg_lo:[0,1] neg_hi:[0,1]
v_pk_add_f32 v[64:65], v[64:65], v[38:39] op_sel_hi:[1,0] neg_lo:[0,1] neg_hi:[0,1]
Vc 2,58,59
v_lshlrev_b32_e64 v58, 16, v2
v_and_b32 v59, 0xffff0000, v2
Vc 3,60,61
v_lshlrev_b32_e64 v60, 16, v3
v_and_b32 v61, 0xffff0000, v3
Vc 4,62,63
v_lshlrev_b32_e64 v62, 16, v4
v_and_b32 v63, 0xffff0000, v4
Vc 5,64,65
v_lshlrev_b32_e64 v64, 16, v5
v_and_b32 v65, 0xffff0000, v5
v_pk_mul_f32 v[58:59], v[58:59], v[38:39] op_sel:[0,1] op_sel_hi:[1,1]
v_pk_mul_f32 v[60:61], v[60:61], v[38:39] op_sel:[0,1] op_sel_hi:[1,1]
v_pk_mul_f32 v[62:63], v[62:63], v[38:39] op_sel:[0,1] op_sel_hi:[1,1]
v_pk_mul_f32 v[64:65], v[64:65], v[38:39] op_sel:[0,1] op_sel_hi:[1,1]
Vc 2,58,59
v_lshlrev_b32_e64 v58, 16, v2
v_and_b32 v59, 0xffff0000, v2
Vc 3,60,61
v_lshlrev_b32_e64 v60, 16, v3
v_and_b32 v61, 0xffff0000, v3
Vc 4,62,63
v_lshlrev_b32_e64 v62, 16, v4
v_and_b32 v63, 0xffff0000, v4
Vc 5,64,65
v_lshlrev_b32_e64 v64, 16, v5
v_and_b32 v65, 0xffff0000, v5
v_pk_add_f32 v[58:59], v[58:59], v[96:97]
v_pk_add_f32 v[60:61], v[60:61], v[98:99]
v_pk_add_f32 v[62:63], v[62:63], v[100:101]
v_pk_add_f32 v[64:65], v[64:65], v[102:103]
Vc 2,58,59
v_lshlrev_b32_e64 v58, 16, v2
v_and_b32 v59, 0xffff0000, v2
Vc 3,60,61
v_lshlrev_b32_e64 v60, 16, v3
v_and_b32 v61, 0xffff0000, v3
Vc 4,62,63
v_lshlrev_b32_e64 v62, 16, v4
v_and_b32 v63, 0xffff0000, v4
Vc 5,64,65
v_lshlrev_b32_e64 v64, 16, v5
v_and_b32 v65, 0xffff0000, v5
v_mul_f32 v2, 0xbfb8aa3b, v58
v_mul_f32 v3, 0xbfb8aa3b, v59
v_mul_f32 v4, 0xbfb8aa3b, v60
v_mul_f32 v5, 0xbfb8aa3b, v61
v_mul_f32 v6, 0xbfb8aa3b, v62
v_mul_f32 v7, 0xbfb8aa3b, v63
v_mul_f32 v8, 0xbfb8aa3b, v64
v_mul_f32 v9, 0xbfb8aa3b, v65
Ve 2,2
Ve 3,3
Ve 4,4
Ve 5,5
Ve 6,6
Ve 7,7
Ve 8,8
Ve 9,9
v_add_f32 v2, 1.0, v2
v_add_f32 v3, 1.0, v3
v_add_f32 v4, 1.0, v4
v_add_f32 v5, 1.0, v5
v_add_f32 v6, 1.0, v6
v_add_f32 v7, 1.0, v7
v_add_f32 v8, 1.0, v8
v_add_f32 v9, 1.0, v9
v_rcp_f32 v2, v2
v_rcp_f32 v3, v3
v_rcp_f32 v4, v4
v_rcp_f32 v5, v5
v_rcp_f32 v6, v6
v_rcp_f32 v7, v7
v_rcp_f32 v8, v8
v_rcp_f32 v9, v9
v_pk_mul_f32 v[58:59], v[58:59], v[2:3]
v_pk_mul_f32 v[60:61], v[60:61], v[4:5]
v_pk_mul_f32 v[62:63], v[62:63], v[6:7]
v_pk_mul_f32 v[64:65], v[64:65], v[8:9]
Vc 2,58,59
v_lshlrev_b32_e64 v58, 16, v2
v_and_b32 v59, 0xffff0000, v2
Vc 3,60,61
v_lshlrev_b32_e64 v60, 16, v3
v_and_b32 v61, 0xffff0000, v3
Vc 4,62,63
v_lshlrev_b32_e64 v62, 16, v4
v_and_b32 v63, 0xffff0000, v4
Vc 5,64,65
v_lshlrev_b32_e64 v64, 16, v5
v_and_b32 v65, 0xffff0000, v5
L_f_selskip7:
v_add_u32 v124, 24, v120
v_cmp_eq_u32 vcc, s42, v124
v_cmp_eq_u32 s[6:7], s43, v124
s_nop 3
s_or_b64 s[4:5], vcc, s[6:7]
s_cbranch_scc0 L_f_selskip8
v_cndmask_b32 v96, 0, v80, vcc
v_cndmask_b32 v96, v96, v88, s[6:7]
v_cndmask_b32 v97, 0, v81, vcc
v_cndmask_b32 v97, v97, v89, s[6:7]
v_cndmask_b32 v98, 0, v82, vcc
v_cndmask_b32 v98, v98, v90, s[6:7]
v_cndmask_b32 v99, 0, v83, vcc
v_cndmask_b32 v99, v99, v91, s[6:7]
v_cndmask_b32 v100, 0, v84, vcc
v_cndmask_b32 v100, v100, v92, s[6:7]
v_cndmask_b32 v101, 0, v85, vcc
v_cndmask_b32 v101, v101, v93, s[6:7]
v_cndmask_b32 v102, 0, v86, vcc
v_cndmask_b32 v102, v102, v94, s[6:7]
v_cndmask_b32 v103, 0, v87, vcc
v_cndmask_b32 v103, v103, v95, s[6:7]
v_lshlrev_b32 v66, 16, v30
v_and_b32 v67, 0xffff0000, v30
v_lshlrev_b32_e64 v68, 16, v31
v_and_b32 v69, 0xffff0000, v31
v_lshlrev_b32_e64 v70, 16, v32
v_and_b32 v71, 0xffff0000, v32
v_lshlrev_b32_e64 v72, 16, v33
v_and_b32 v73, 0xffff0000, v33
v_pk_add_f32 v[66:67], v[66:67], v[40:41] op_sel_hi:[1,0] neg_lo:[0,1] neg_hi:[0,1]
v_pk_add_f32 v[68:69], v[68:69], v[40:41] op_sel_hi:[1,0] neg_lo:[0,1] neg_hi:[0,1]
v_pk_add_f32 v[70:71], v[70:71], v[40:41] op_sel_hi:[1,0] neg_lo:[0,1] neg_hi:[0,1]
v_pk_add_f32 v[72:73], v[72:73], v[40:41] op_sel_hi:[1,0] neg_lo:[0,1] neg_hi:[0,1]
Vc 2,66,67
v_lshlrev_b32_e64 v66, 16, v2
v_and_b32 v67, 0xffff0000, v2
Vc 3,68,69
v_lshlrev_b32_e64 v68, 16, v3
v_and_b32 v69, 0xffff0000, v3
Vc 4,70,71
v_lshlrev_b32_e64 v70, 16, v4
v_and_b32 v71, 0xffff0000, v4
Vc 5,72,73
v_lshlrev_b32_e64 v72, 16, v5
v_and_b32 v73, 0xffff0000, v5
v_pk_mul_f32 v[66:67], v[66:67], v[40:41] op_sel:[0,1] op_sel_hi:[1,1]
v_pk_mul_f32 v[68:69], v[68:69], v[40:41] op_sel:[0,1] op_sel_hi:[1,1]
v_pk_mul_f32 v[70:71], v[70:71], v[40:41] op_sel:[0,1] op_sel_hi:[1,1]
v_pk_mul_f32 v[72:73], v[72:73], v[40:41] op_sel:[0,1] op_sel_hi:[1,1]
Vc 2,66,67
v_lshlrev_b32_e64 v66, 16, v2
v_and_b32 v67, 0xffff0000, v2
Vc 3,68,69
v_lshlrev_b32_e64 v68, 16, v3
v_and_b32 v69, 0xffff0000, v3
Vc 4,70,71
v_lshlrev_b32_e64 v70, 16, v4
v_and_b32 v71, 0xffff0000, v4
Vc 5,72,73
v_lshlrev_b32_e64 v72, 16, v5
v_and_b32 v73, 0xffff0000, v5
v_pk_add_f32 v[66:67], v[66:67], v[96:97]
v_pk_add_f32 v[68:69], v[68:69], v[98:99]
v_pk_add_f32 v[70:71], v[70:71], v[100:101]
v_pk_add_f32 v[72:73], v[72:73], v[102:103]
Vc 2,66,67
v_lshlrev_b32_e64 v66, 16, v2
v_and_b32 v67, 0xffff0000, v2
Vc 3,68,69
v_lshlrev_b32_e64 v68, 16, v3
v_and_b32 v69, 0xffff0000, v3
Vc 4,70,71
v_lshlrev_b32_e64 v70, 16, v4
v_and_b32 v71, 0xffff0000, v4
Vc 5,72,73
v_lshlrev_b32_e64 v72, 16, v5
v_and_b32 v73, 0xffff0000, v5
v_mul_f32 v2, 0xbfb8aa3b, v66
v_mul_f32 v3, 0xbfb8aa3b, v67
v_mul_f32 v4, 0xbfb8aa3b, v68
v_mul_f32 v5, 0xbfb8aa3b, v69
v_mul_f32 v6, 0xbfb8aa3b, v70
v_mul_f32 v7, 0xbfb8aa3b, v71
v_mul_f32 v8, 0xbfb8aa3b, v72
v_mul_f32 v9, 0xbfb8aa3b, v73
Ve 2,2
Ve 3,3
Ve 4,4
Ve 5,5
Ve 6,6
Ve 7,7
Ve 8,8
Ve 9,9
v_add_f32 v2, 1.0, v2
v_add_f32 v3, 1.0, v3
v_add_f32 v4, 1.0, v4
v_add_f32 v5, 1.0, v5
v_add_f32 v6, 1.0, v6
v_add_f32 v7, 1.0, v7
v_add_f32 v8, 1.0, v8
v_add_f32 v9, 1.0, v9
v_rcp_f32 v2, v2
v_rcp_f32 v3, v3
v_rcp_f32 v4, v4
v_rcp_f32 v5, v5
v_rcp_f32 v6, v6
v_rcp_f32 v7, v7
v_rcp_f32 v8, v8
v_rcp_f32 v9, v9
v_pk_mul_f32 v[66:67], v[66:67], v[2:3]
v_pk_mul_f32 v[68:69], v[68:69], v[4:5]
v_pk_mul_f32 v[70:71], v[70:71], v[6:7]
v_pk_mul_f32 v[72:73], v[72:73], v[8:9]
Vc 2,66,67
v_lshlrev_b32_e64 v66, 16, v2
v_and_b32 v67, 0xffff0000, v2
Vc 3,68,69
v_lshlrev_b32_e64 v68, 16, v3
v_and_b32 v69, 0xffff0000, v3
Vc 4,70,71
v_lshlrev_b32_e64 v70, 16, v4
v_and_b32 v71, 0xffff0000, v4
Vc 5,72,73
v_lshlrev_b32_e64 v72, 16, v5
v_and_b32 v73, 0xffff0000, v5
L_f_selskip8:
s_branch L_yslr
.section .rodata,"a"
.p2align 6
.amdhsa_kernel recurrent_scan__compressed_kv_cla__moe_arch_mod__prompt_kernel
  .amdhsa_next_free_vgpr 512
  .amdhsa_next_free_sgpr 102
  .amdhsa_accum_offset 256
  .amdhsa_group_segment_fixed_size 0
  .amdhsa_kernarg_size 112
  .amdhsa_user_sgpr_count 2
  .amdhsa_user_sgpr_kernarg_segment_ptr 1
  .amdhsa_system_sgpr_workgroup_id_x 1
.end_amdhsa_kernel
```

```asm
; @launch grid=(256,1,1) block=(256,1,1) lds=163840
.amdgcn_target "amdgcn-amd-amdhsa--gfx950"
.macro Va d,x,y
v_add_f32 v\d, v\x, v\y
.endm
.macro Vc d,x,y
v_cvt_pk_bf16_f32 v\d, v\x, v\y
.endm
.macro Ta d,x,o
ds_read_b64_tr_b16 a[\d:\d+1], v\x offset:\o
.endm
.macro Ra d,x,o
ds_read_b128 a[\d:\d+3], v\x offset:\o
.endm
.macro Zvaa d,x,y
v_mfma_f32_16x16x32_bf16 v[\d:\d+3], a[\x:\x+3], a[\y:\y+3], 0
.endm
.macro Rv d,x,o
ds_read_b128 v[\d:\d+3], v\x offset:\o
.endm
.macro Zaaa d,x,y
v_mfma_f32_16x16x32_bf16 a[\d:\d+3], a[\x:\x+3], a[\y:\y+3], 0
.endm
.macro Mvaa d,x,y
v_mfma_f32_16x16x32_bf16 v[\d:\d+3], a[\x:\x+3], a[\y:\y+3], v[\d:\d+3]
.endm
.macro Maaa d,x,y
v_mfma_f32_16x16x32_bf16 a[\d:\d+3], a[\x:\x+3], a[\y:\y+3], a[\d:\d+3]
.endm
.macro Ar d,x
v_accvgpr_read_b32 v\d, a\x
.endm
.macro VE d,x
v_exp_f32_e64 v\d, v\x
.endm
.macro Aw d,x
v_accvgpr_write_b32 a\d, v\x
.endm
.macro Vs d,x,y
v_sub_f32 v\d, v\x, v\y
.endm
.macro Ve d,x
v_exp_f32 v\d, v\x
.endm
.macro Cvaa d,x,y,c
v_mfma_f32_16x16x32_bf16 v[\d:\d+3], a[\x:\x+3], a[\y:\y+3], v[\c:\c+3]
.endm
.macro Maav d,x,y
v_mfma_f32_16x16x32_bf16 a[\d:\d+3], a[\x:\x+3], v[\y:\y+3], a[\d:\d+3]
.endm
.macro Mvvv d,x,y
v_mfma_f32_16x16x32_bf16 v[\d:\d+3], v[\x:\x+3], v[\y:\y+3], v[\d:\d+3]
.endm
.macro Zvva d,x,y
v_mfma_f32_16x16x32_bf16 v[\d:\d+3], v[\x:\x+3], a[\y:\y+3], 0
.endm
.macro Mvva d,x,y
v_mfma_f32_16x16x32_bf16 v[\d:\d+3], v[\x:\x+3], a[\y:\y+3], v[\d:\d+3]
.endm
.macro Vm d,x,y
v_mul_f32 v\d, v\x, v\y
.endm
.macro Zvvv d,x,y
v_mfma_f32_16x16x32_bf16 v[\d:\d+3], v[\x:\x+3], v[\y:\y+3], 0
.endm
.text
.globl recurrent_scan__compressed_kv_cla__moe_arch_mod__prompt_kernel
.p2align 8
.type recurrent_scan__compressed_kv_cla__moe_arch_mod__prompt_kernel,@function
recurrent_scan__compressed_kv_cla__moe_arch_mod__prompt_kernel:
s_cmp_ge_u32 s2, 256
s_cbranch_scc1 L_k2_end
s_load_dwordx4 s[4:7], s[0:1], 0
s_load_dwordx2 s[44:45], s[0:1], 56
s_load_dwordx4 s[40:43], s[0:1], 24
s_load_dwordx4 s[64:67], s[0:1], 96
v_lshrrev_b32 v1, 6, v0
v_and_b32 v0, 63, v0
v_readfirstlane_b32 s32, v1
s_getpc_b64 s[68:69]
L_cpf1:
s_add_u32 s68, s68, (recurrent_scan__compressed_kv_cla__moe_arch_mod__prompt_kernel-L_cpf1)&0xffffffff
s_addc_u32 s69, s69, ((recurrent_scan__compressed_kv_cla__moe_arch_mod__prompt_kernel-L_cpf1)>>32)&0xffffffff
s_lshr_b32 s70, s2, 3
s_lshl_b32 s70, s70, 2
s_add_u32 s70, s70, s32
s_lshl_b32 s70, s70, 10
v_and_b32 v122, 7, v0
v_lshlrev_b32 v122, 7, v122
v_add_u32 v122, s70, v122
v_min_u32 v122, L_k2_fin-recurrent_scan__compressed_kv_cla__moe_arch_mod__prompt_kernel-4, v122
v_mov_b32 v121, s69
v_add_co_u32 v120, vcc, s68, v122
s_nop 1
v_addc_co_u32 v121, vcc, 0, v121, vcc
global_load_dword v124, v[120:121], off
v_lshrrev_b32 v33, 5, v0
v_and_b32 v31, 31, v0
v_lshlrev_b32_e64 v36, 4, v31
v_lshl_add_u32 v35, v33, 11, v36
s_lshl_b32 s36, s2, 14
s_lshl_b32 s37, s32, 12
s_add_u32 s36, s36, s37
s_mov_b32 s18, 4194304
s_mov_b32 s19, 0x20000
s_bfe_u32 s33, s2, 0x30003
s_lshr_b32 s35, s2, 7
s_bfe_u32 s3, s2, 0x10006
s_and_b32 s34, s2, 7
s_lshl_b32 s34, s34, 1
s_add_u32 s34, s34, s3
s_waitcnt lgkmcnt(0)
s_mov_b32 s16, s4
s_and_b32 s17, s5, 0xffff
buffer_load_dwordx4 v[48:51], v35, s[16:19], s36 offen offset:0 nt
buffer_load_dwordx4 v[52:55], v35, s[16:19], s36 offen offset:512 nt
buffer_load_dwordx4 v[56:59], v35, s[16:19], s36 offen offset:1024 nt
buffer_load_dwordx4 v[60:63], v35, s[16:19], s36 offen offset:1536 nt
s_cmp_eq_u32 s35, 0
s_cselect_b32 s40, s40, s42
s_cselect_b32 s41, s41, s43
s_lshl_b32 s3, s34, 9
s_add_u32 s12, s40, s3
s_addc_u32 s13, s41, 0
s_and_b32 s13, s13, 0xffff
s_mov_b32 s14, 0
s_mov_b32 s15, 0x20000
s_sub_u32 s14, 4194304, s3
s_lshl_b32 s3, s33, 18
s_add_u32 s8, s6, s3
s_addc_u32 s9, s7, 0
s_and_b32 s9, s9, 0xffff
s_mov_b32 s10, 262144
s_mov_b32 s11, 0x20000
s_and_b32 s58, s2, 7
s_mov_b32 s52, 0
s_mov_b32 s53, 15360
s_mov_b32 s54, 30720
s_mov_b32 s55, 46080
s_lshl_b32 s56, s32, 13
s_add_u32 s57, s56, 32768
s_lshl_b32 s3, s58, 2
s_add_u32 s3, s3, s32
s_lshl_b32 s3, s3, 4
v_add_u32 v30, s3, v33
v_lshlrev_b32 v30, 13, v30
v_lshlrev_b32 v34, 5, v33
v_xor_b32 v34, v34, v36
v_add_u32 v6, v34, v30
v_xor_b32_e64 v7, 64, v6
v_xor_b32 v8, 65664, v6
v_xor_b32 v9, 65728, v6
s_add_u32 m0, s57, 0
s_nop 0
buffer_load_dwordx4 v6, s[12:15], s52 offen offset:0 nt lds
buffer_load_dwordx4 v7, s[12:15], s53 offen offset:1024 nt lds
buffer_load_dwordx4 v6, s[12:15], s54 offen offset:2048 nt lds
buffer_load_dwordx4 v7, s[12:15], s55 offen offset:3072 nt lds
s_add_u32 m0, s57, 4096
s_nop 0
s_nop 0
buffer_load_dwordx4 v8, s[12:15], s52 offen offset:0 nt lds
buffer_load_dwordx4 v9, s[12:15], s53 offen offset:1024 nt lds
buffer_load_dwordx4 v8, s[12:15], s54 offen offset:2048 nt lds
buffer_load_dwordx4 v9, s[12:15], s55 offen offset:3072 nt lds
v_xor_b32 v6, 524288, v6
v_xor_b32 v7, 524288, v7
v_xor_b32 v8, 524288, v8
v_xor_b32 v9, 524288, v9
s_mov_b32 s48, 0
s_mov_b32 s49, 7168
s_mov_b32 s50, 14336
s_mov_b32 s51, 21504
v_lshrrev_b32 v30, 3, v0
v_lshlrev_b32 v30, 10, v30
s_lshl_b32 s3, s32, 16
s_lshl_b32 s39, s58, 7
s_add_u32 s3, s3, s39
v_and_b32 v31, 7, v0
v_lshrrev_b32 v32, 4, v0
v_xor_b32_e64 v31, v31, v32
v_lshl_add_u32 v30, v31, 4, v30
v_add_u32 v2, s3, v30
v_xor_b32 v3, 64, v2
v_xor_b32 v4, 32768, v2
v_xor_b32 v5, 32832, v2
s_cmp_lt_u32 s32, 2
s_cselect_b32 s60, s8, s12
s_cselect_b32 s61, s9, s13
s_cselect_b32 s62, s10, s14
s_mov_b32 s63, 0x20000
s_mov_b32 s59, 524288
s_cselect_b32 s59, 128, s59
s_cselect_b64 vcc, -1, 0
s_cselect_b32 s38, 32, 16
s_lshr_b32 s3, s2, 6
s_cmp_lt_u32 s32, 2
s_cselect_b32 s3, s3, s33
s_lshl_b32 s3, s3, 1
s_and_b32 s39, s32, 1
s_add_u32 s3, s3, s39
s_lshl_b32 s3, s3, 15
s_xor_b32 s39, s58, 1
s_mul_i32 s39, s39, s59
s_add_u32 s3, s3, s39
v_lshlrev_b32 v37, 10, v0
v_lshrrev_b32 v38, 2, v0
v_lshlrev_b32 v38, 13, v38
v_and_b32 v39, 3, v0
v_lshl_add_u32 v38, v39, 7, v38
v_cndmask_b32 v47, v38, v37, vcc
v_add_u32 v47, s3, v47
v_cmp_gt_u32 vcc, s38, v0
v_mov_b32 v37, 2146435072
s_nop 0
v_cndmask_b32 v47, v37, v47, vcc
s_mov_b32 s20, s66
s_and_b32 s21, s67, 0xffff
s_mov_b32 s22, 8388608
s_mov_b32 s23, 0x20000
s_add_u32 s24, s66, 8388608
s_addc_u32 s25, s67, 0
s_and_b32 s25, s25, 0xffff
s_mov_b32 s26, 35717120
s_mov_b32 s27, 0x20000
v_lshrrev_b32 v32, 4, v0
v_and_b32 v30, 15, v0
s_lshr_b32 s3, s32, 1
s_lshl_b32 s3, s3, 14
v_lshlrev_b32 v31, 7, v30
v_add_u32 v31, s3, v31
v_lshrrev_b32 v34, 1, v30
v_xor_b32_e64 v34, v34, v32
v_lshl_add_u32 v10, v34, 4, v31
v_xor_b32 v11, 64, v10
v_lshrrev_b32 v30, 2, v30
v_lshl_add_u32 v31, v32, 3, v30
v_lshlrev_b32 v31, 9, v31
v_and_b32 v34, 3, v0
v_lshl_add_u32 v31, v34, 3, v31
s_and_b32 s3, s32, 1
s_lshl_b32 s3, s3, 8
s_add_u32 s3, s3, 32768
v_add_u32 v31, s3, v31
v_and_b32 v34, 1, v32
v_lshl_add_u32 v30, v34, 2, v30
v_lshl_add_u32 v12, v30, 5, v31
v_xor_b32 v13, 32, v12
v_xor_b32 v14, 64, v12
v_xor_b32 v15, 96, v12
v_xor_b32 v16, 128, v12
v_xor_b32 v17, 160, v12
v_xor_b32 v18, 192, v12
v_xor_b32 v19, 224, v12
v_add_u32 v20, 65536, v10
v_add_u32 v21, 65536, v11
v_add_u32 v22, 65536, v12
v_add_u32 v23, 65536, v13
v_add_u32 v24, 65536, v14
v_add_u32 v25, 65536, v15
v_add_u32 v26, 65536, v16
v_add_u32 v27, 65536, v17
v_add_u32 v28, 65536, v18
v_add_u32 v29, 65536, v19
s_mov_b32 s28, s44
s_nop 0
s_and_b32 s29, s45, 0xffff
s_mov_b32 s30, 2048
s_mov_b32 s31, 0x20000
buffer_load_dwordx4 v[64:67], v36, s[28:31], 0 offen offset:0
buffer_load_dwordx4 v[68:71], v36, s[28:31], 0 offen offset:512
buffer_load_dwordx4 v[72:75], v36, s[28:31], 0 offen offset:1024
buffer_load_dwordx4 v[76:79], v36, s[28:31], 0 offen offset:1536
s_waitcnt vmcnt(12)
v_lshlrev_b32 v80, 16, v48
v_and_b32 v81, 0xffff0000, v48
v_lshlrev_b32_e64 v82, 16, v49
v_and_b32 v83, 0xffff0000, v49
v_lshlrev_b32_e64 v84, 16, v50
v_and_b32 v85, 0xffff0000, v50
v_lshlrev_b32_e64 v86, 16, v51
v_and_b32 v87, 0xffff0000, v51
v_lshlrev_b32_e64 v88, 16, v52
v_and_b32 v89, 0xffff0000, v52
v_lshlrev_b32_e64 v90, 16, v53
v_and_b32 v91, 0xffff0000, v53
v_lshlrev_b32_e64 v92, 16, v54
v_and_b32 v93, 0xffff0000, v54
v_lshlrev_b32_e64 v94, 16, v55
v_and_b32 v95, 0xffff0000, v55
v_lshlrev_b32_e64 v96, 16, v56
v_and_b32 v97, 0xffff0000, v56
v_lshlrev_b32_e64 v98, 16, v57
v_and_b32 v99, 0xffff0000, v57
v_lshlrev_b32_e64 v100, 16, v58
v_and_b32 v101, 0xffff0000, v58
v_lshlrev_b32_e64 v102, 16, v59
v_and_b32 v103, 0xffff0000, v59
v_lshlrev_b32_e64 v104, 16, v60
v_and_b32 v105, 0xffff0000, v60
v_lshlrev_b32_e64 v106, 16, v61
v_and_b32 v107, 0xffff0000, v61
v_lshlrev_b32_e64 v108, 16, v62
v_and_b32 v109, 0xffff0000, v62
v_lshlrev_b32_e64 v110, 16, v63
v_and_b32 v111, 0xffff0000, v63
v_pk_add_f32 v[40:41], v[80:81], v[82:83]
v_pk_add_f32 v[42:43], v[84:85], v[86:87]
v_pk_add_f32 v[40:41], v[40:41], v[88:89]
v_pk_add_f32 v[42:43], v[42:43], v[90:91]
v_pk_add_f32 v[40:41], v[40:41], v[92:93]
v_pk_add_f32 v[42:43], v[42:43], v[94:95]
v_pk_add_f32 v[40:41], v[40:41], v[96:97]
v_pk_add_f32 v[42:43], v[42:43], v[98:99]
v_pk_add_f32 v[40:41], v[40:41], v[100:101]
v_pk_add_f32 v[42:43], v[42:43], v[102:103]
v_pk_add_f32 v[40:41], v[40:41], v[104:105]
v_pk_add_f32 v[42:43], v[42:43], v[106:107]
v_pk_add_f32 v[40:41], v[40:41], v[108:109]
v_pk_add_f32 v[42:43], v[42:43], v[110:111]
v_pk_add_f32 v[40:41], v[40:41], v[42:43]
Va 38,40,41
s_nop 1
v_add_f32_dpp v38, v38, v38 quad_perm:[1,0,3,2] row_mask:0xf bank_mask:0xf
s_nop 1
v_add_f32_dpp v38, v38, v38 quad_perm:[2,3,0,1] row_mask:0xf bank_mask:0xf
s_nop 1
v_add_f32_dpp v38, v38, v38 row_half_mirror row_mask:0xf bank_mask:0xf
s_nop 1
v_add_f32_dpp v38, v38, v38 row_mirror row_mask:0xf bank_mask:0xf
v_mov_b32 v37, v38
s_nop 1
v_permlane16_swap_b32 v37, v38
Va 38,38,37
s_add_u32 m0, s56, 0
s_nop 0
buffer_load_dwordx4 v2, s[8:11], s48 offen offset:0 lds
buffer_load_dwordx4 v3, s[8:11], s49 offen offset:1024 lds
buffer_load_dwordx4 v2, s[8:11], s50 offen offset:2048 lds
buffer_load_dwordx4 v3, s[8:11], s51 offen offset:3072 lds
s_add_u32 m0, s56, 4096
s_nop 0
buffer_load_dwordx4 v4, s[8:11], s48 offen offset:0 lds
buffer_load_dwordx4 v5, s[8:11], s49 offen offset:1024 lds
buffer_load_dwordx4 v4, s[8:11], s50 offen offset:2048 lds
buffer_load_dwordx4 v5, s[8:11], s51 offen offset:3072 lds
v_xor_b32 v2, 128, v2
v_xor_b32 v3, 128, v3
v_xor_b32 v4, 128, v4
v_xor_b32 v5, 128, v5
buffer_load_dword v1, v47, s[60:63], 0 offen
s_mul_i32 vcc_lo, s59, 3
v_xor_b32 v47, vcc_lo, v47
v_mul_f32 v38, 0xba800000, v38
v_mov_b32_e64 v39, v38
v_pk_add_f32 v[112:113], v[80:81], v[38:39]
v_pk_mul_f32 v[40:41], v[112:113], v[112:113]
v_pk_add_f32 v[114:115], v[82:83], v[38:39]
v_pk_mul_f32 v[42:43], v[114:115], v[114:115]
v_pk_add_f32 v[116:117], v[84:85], v[38:39]
v_pk_fma_f32 v[40:41], v[116:117], v[116:117], v[40:41]
v_pk_add_f32 v[118:119], v[86:87], v[38:39]
v_pk_fma_f32 v[42:43], v[118:119], v[118:119], v[42:43]
v_pk_add_f32 v[112:113], v[88:89], v[38:39]
v_pk_fma_f32 v[40:41], v[112:113], v[112:113], v[40:41]
v_pk_add_f32 v[114:115], v[90:91], v[38:39]
v_pk_fma_f32 v[42:43], v[114:115], v[114:115], v[42:43]
v_pk_add_f32 v[116:117], v[92:93], v[38:39]
v_pk_fma_f32 v[40:41], v[116:117], v[116:117], v[40:41]
v_pk_add_f32 v[118:119], v[94:95], v[38:39]
v_pk_fma_f32 v[42:43], v[118:119], v[118:119], v[42:43]
v_pk_add_f32 v[112:113], v[96:97], v[38:39]
v_pk_fma_f32 v[40:41], v[112:113], v[112:113], v[40:41]
v_pk_add_f32 v[114:115], v[98:99], v[38:39]
v_pk_fma_f32 v[42:43], v[114:115], v[114:115], v[42:43]
v_pk_add_f32 v[116:117], v[100:101], v[38:39]
v_pk_fma_f32 v[40:41], v[116:117], v[116:117], v[40:41]
v_pk_add_f32 v[118:119], v[102:103], v[38:39]
v_pk_fma_f32 v[42:43], v[118:119], v[118:119], v[42:43]
v_pk_add_f32 v[112:113], v[104:105], v[38:39]
v_pk_fma_f32 v[40:41], v[112:113], v[112:113], v[40:41]
v_pk_add_f32 v[114:115], v[106:107], v[38:39]
v_pk_fma_f32 v[42:43], v[114:115], v[114:115], v[42:43]
v_pk_add_f32 v[116:117], v[108:109], v[38:39]
v_pk_fma_f32 v[40:41], v[116:117], v[116:117], v[40:41]
v_pk_add_f32 v[118:119], v[110:111], v[38:39]
v_pk_fma_f32 v[42:43], v[118:119], v[118:119], v[42:43]
v_pk_add_f32 v[40:41], v[40:41], v[42:43]
Va 40,40,41
s_nop 1
v_add_f32_dpp v40, v40, v40 quad_perm:[1,0,3,2] row_mask:0xf bank_mask:0xf
s_nop 1
v_add_f32_dpp v40, v40, v40 quad_perm:[2,3,0,1] row_mask:0xf bank_mask:0xf
s_nop 1
v_add_f32_dpp v40, v40, v40 row_half_mirror row_mask:0xf bank_mask:0xf
s_nop 1
v_add_f32_dpp v40, v40, v40 row_mirror row_mask:0xf bank_mask:0xf
v_mov_b32 v37, v40
s_nop 1
v_permlane16_swap_b32 v37, v40
v_add_f32_e64 v40, v40, v37
buffer_load_dword v1, v47, s[60:63], 0 offen
s_mul_i32 vcc_lo, s59, 1
v_xor_b32 v47, vcc_lo, v47
v_mul_f32 v40, 0x3a800000, v40
Vc 44,38,40
v_lshlrev_b32_e64 v38, 16, v44
v_and_b32 v40, 0xffff0000, v44
v_add_f32 v40, 0x3727c5ac, v40
Vc 44,40,40
v_lshlrev_b32 v40, 16, v44
v_sqrt_f32 v40, v40
v_mov_b32_e64 v39, v38
Vc 44,40,40
v_lshlrev_b32 v44, 16, v44
v_rcp_f32 v40, v44
v_pk_add_f32 v[80:81], v[80:81], v[38:39]
v_pk_add_f32 v[82:83], v[82:83], v[38:39]
v_pk_add_f32 v[84:85], v[84:85], v[38:39]
v_pk_add_f32 v[86:87], v[86:87], v[38:39]
v_pk_add_f32 v[88:89], v[88:89], v[38:39]
v_pk_add_f32 v[90:91], v[90:91], v[38:39]
v_pk_add_f32 v[92:93], v[92:93], v[38:39]
v_pk_add_f32 v[94:95], v[94:95], v[38:39]
v_pk_add_f32 v[96:97], v[96:97], v[38:39]
v_pk_add_f32 v[98:99], v[98:99], v[38:39]
v_pk_add_f32 v[100:101], v[100:101], v[38:39]
v_pk_add_f32 v[102:103], v[102:103], v[38:39]
v_pk_add_f32 v[104:105], v[104:105], v[38:39]
v_pk_add_f32 v[106:107], v[106:107], v[38:39]
v_pk_add_f32 v[108:109], v[108:109], v[38:39]
v_pk_add_f32 v[110:111], v[110:111], v[38:39]
v_fma_f32 v45, -v44, v40, 1.0
v_fma_f32 v40, v45, v40, v40
v_mov_b32_e64 v41, v40
Vc 48,80,81
Vc 49,82,83
Vc 50,84,85
Vc 51,86,87
Vc 52,88,89
Vc 53,90,91
Vc 54,92,93
Vc 55,94,95
Vc 56,96,97
Vc 57,98,99
Vc 58,100,101
Vc 59,102,103
Vc 60,104,105
Vc 61,106,107
Vc 62,108,109
Vc 63,110,111
v_lshlrev_b32_e64 v80, 16, v48
v_and_b32 v81, 0xffff0000, v48
v_lshlrev_b32_e64 v82, 16, v49
v_and_b32 v83, 0xffff0000, v49
v_lshlrev_b32_e64 v84, 16, v50
v_and_b32 v85, 0xffff0000, v50
v_lshlrev_b32_e64 v86, 16, v51
v_and_b32 v87, 0xffff0000, v51
v_lshlrev_b32_e64 v88, 16, v52
v_and_b32 v89, 0xffff0000, v52
v_lshlrev_b32_e64 v90, 16, v53
v_and_b32 v91, 0xffff0000, v53
v_lshlrev_b32_e64 v92, 16, v54
v_and_b32 v93, 0xffff0000, v54
v_lshlrev_b32_e64 v94, 16, v55
v_and_b32 v95, 0xffff0000, v55
v_lshlrev_b32_e64 v96, 16, v56
v_and_b32 v97, 0xffff0000, v56
v_lshlrev_b32_e64 v98, 16, v57
v_and_b32 v99, 0xffff0000, v57
v_lshlrev_b32_e64 v100, 16, v58
v_and_b32 v101, 0xffff0000, v58
v_lshlrev_b32_e64 v102, 16, v59
v_and_b32 v103, 0xffff0000, v59
v_lshlrev_b32_e64 v104, 16, v60
v_and_b32 v105, 0xffff0000, v60
v_lshlrev_b32_e64 v106, 16, v61
v_and_b32 v107, 0xffff0000, v61
v_lshlrev_b32_e64 v108, 16, v62
v_and_b32 v109, 0xffff0000, v62
v_lshlrev_b32_e64 v110, 16, v63
v_and_b32 v111, 0xffff0000, v63
v_pk_mul_f32 v[80:81], v[80:81], v[40:41]
v_pk_mul_f32 v[82:83], v[82:83], v[40:41]
v_pk_mul_f32 v[84:85], v[84:85], v[40:41]
v_pk_mul_f32 v[86:87], v[86:87], v[40:41]
v_pk_mul_f32 v[88:89], v[88:89], v[40:41]
v_pk_mul_f32 v[90:91], v[90:91], v[40:41]
v_pk_mul_f32 v[92:93], v[92:93], v[40:41]
v_pk_mul_f32 v[94:95], v[94:95], v[40:41]
v_pk_mul_f32 v[96:97], v[96:97], v[40:41]
v_pk_mul_f32 v[98:99], v[98:99], v[40:41]
v_pk_mul_f32 v[100:101], v[100:101], v[40:41]
v_pk_mul_f32 v[102:103], v[102:103], v[40:41]
v_pk_mul_f32 v[104:105], v[104:105], v[40:41]
v_pk_mul_f32 v[106:107], v[106:107], v[40:41]
v_pk_mul_f32 v[108:109], v[108:109], v[40:41]
v_pk_mul_f32 v[110:111], v[110:111], v[40:41]
Vc 48,80,81
Vc 49,82,83
Vc 50,84,85
Vc 51,86,87
Vc 52,88,89
Vc 53,90,91
Vc 54,92,93
Vc 55,94,95
Vc 56,96,97
Vc 57,98,99
Vc 58,100,101
Vc 59,102,103
Vc 60,104,105
Vc 61,106,107
Vc 62,108,109
Vc 63,110,111
s_mul_i32 s3, s32, 4128
s_add_u32 s3, s3, 131072
v_mul_u32_u24 v42, 2064, v33
v_add3_u32 v42, v42, v36, s3
ds_write_b128 v42, v[48:51] offset:0
ds_write_b128 v42, v[52:55] offset:512
ds_write_b128 v42, v[56:59] offset:1024
ds_write_b128 v42, v[60:63] offset:1536
s_waitcnt vmcnt(10)
v_lshlrev_b32 v80, 16, v48
v_and_b32 v81, 0xffff0000, v48
v_lshlrev_b32_e64 v112, 16, v64
v_and_b32 v113, 0xffff0000, v64
v_pk_mul_f32 v[42:43], v[80:81], v[112:113]
v_lshlrev_b32_e64 v82, 16, v49
v_and_b32 v83, 0xffff0000, v49
v_lshlrev_b32_e64 v114, 16, v65
v_and_b32 v115, 0xffff0000, v65
v_pk_mul_f32 v[44:45], v[82:83], v[114:115]
v_lshlrev_b32_e64 v84, 16, v50
v_and_b32 v85, 0xffff0000, v50
v_lshlrev_b32_e64 v116, 16, v66
v_and_b32 v117, 0xffff0000, v66
v_pk_fma_f32 v[42:43], v[84:85], v[116:117], v[42:43]
v_lshlrev_b32_e64 v86, 16, v51
v_and_b32 v87, 0xffff0000, v51
v_lshlrev_b32_e64 v118, 16, v67
v_and_b32 v119, 0xffff0000, v67
v_pk_fma_f32 v[44:45], v[86:87], v[118:119], v[44:45]
v_lshlrev_b32_e64 v88, 16, v52
v_and_b32 v89, 0xffff0000, v52
v_lshlrev_b32_e64 v112, 16, v68
v_and_b32 v113, 0xffff0000, v68
v_pk_fma_f32 v[42:43], v[88:89], v[112:113], v[42:43]
v_lshlrev_b32_e64 v90, 16, v53
v_and_b32 v91, 0xffff0000, v53
v_lshlrev_b32_e64 v114, 16, v69
v_and_b32 v115, 0xffff0000, v69
v_pk_fma_f32 v[44:45], v[90:91], v[114:115], v[44:45]
v_lshlrev_b32_e64 v92, 16, v54
v_and_b32 v93, 0xffff0000, v54
v_lshlrev_b32_e64 v116, 16, v70
v_and_b32 v117, 0xffff0000, v70
v_pk_fma_f32 v[42:43], v[92:93], v[116:117], v[42:43]
v_lshlrev_b32_e64 v94, 16, v55
v_and_b32 v95, 0xffff0000, v55
v_lshlrev_b32_e64 v118, 16, v71
v_and_b32 v119, 0xffff0000, v71
v_pk_fma_f32 v[44:45], v[94:95], v[118:119], v[44:45]
v_lshlrev_b32_e64 v96, 16, v56
v_and_b32 v97, 0xffff0000, v56
v_lshlrev_b32_e64 v112, 16, v72
v_and_b32 v113, 0xffff0000, v72
v_pk_fma_f32 v[42:43], v[96:97], v[112:113], v[42:43]
v_lshlrev_b32_e64 v98, 16, v57
v_and_b32 v99, 0xffff0000, v57
v_lshlrev_b32_e64 v114, 16, v73
v_and_b32 v115, 0xffff0000, v73
v_pk_fma_f32 v[44:45], v[98:99], v[114:115], v[44:45]
v_lshlrev_b32_e64 v100, 16, v58
v_and_b32 v101, 0xffff0000, v58
v_lshlrev_b32_e64 v116, 16, v74
v_and_b32 v117, 0xffff0000, v74
v_pk_fma_f32 v[42:43], v[100:101], v[116:117], v[42:43]
v_lshlrev_b32_e64 v102, 16, v59
v_and_b32 v103, 0xffff0000, v59
v_lshlrev_b32_e64 v118, 16, v75
v_and_b32 v119, 0xffff0000, v75
v_pk_fma_f32 v[44:45], v[102:103], v[118:119], v[44:45]
v_lshlrev_b32_e64 v104, 16, v60
v_and_b32 v105, 0xffff0000, v60
v_lshlrev_b32_e64 v112, 16, v76
v_and_b32 v113, 0xffff0000, v76
v_pk_fma_f32 v[42:43], v[104:105], v[112:113], v[42:43]
v_lshlrev_b32_e64 v106, 16, v61
v_and_b32 v107, 0xffff0000, v61
v_lshlrev_b32_e64 v114, 16, v77
v_and_b32 v115, 0xffff0000, v77
v_pk_fma_f32 v[44:45], v[106:107], v[114:115], v[44:45]
v_lshlrev_b32_e64 v108, 16, v62
v_and_b32 v109, 0xffff0000, v62
v_lshlrev_b32_e64 v116, 16, v78
v_and_b32 v117, 0xffff0000, v78
v_pk_fma_f32 v[42:43], v[108:109], v[116:117], v[42:43]
v_lshlrev_b32_e64 v110, 16, v63
v_and_b32 v111, 0xffff0000, v63
v_lshlrev_b32_e64 v118, 16, v79
v_and_b32 v119, 0xffff0000, v79
v_pk_fma_f32 v[44:45], v[110:111], v[118:119], v[44:45]
v_pk_add_f32 v[42:43], v[42:43], v[44:45]
Va 45,42,43
s_nop 1
v_add_f32_dpp v45, v45, v45 quad_perm:[1,0,3,2] row_mask:0xf bank_mask:0xf
s_nop 1
v_add_f32_dpp v45, v45, v45 quad_perm:[2,3,0,1] row_mask:0xf bank_mask:0xf
s_nop 1
v_add_f32_dpp v45, v45, v45 row_half_mirror row_mask:0xf bank_mask:0xf
s_nop 1
v_add_f32_dpp v45, v45, v45 row_mirror row_mask:0xf bank_mask:0xf
v_mov_b32 v37, v45
s_nop 1
v_permlane16_swap_b32 v37, v45
v_add_f32_e64 v45, v45, v37
Vc 45,45,45
v_ashrrev_i32_e64 v46, 31, v45
v_or_b32 v46, 0x80000000, v46
v_xor_b32_e64 v45, v45, v46
v_and_b32 v45, 0xffff0000, v45
s_lshr_b32 s3, s36, 11
v_add_u32 v46, s3, v33
v_sub_u32 v44, 0xffff, v46
v_or_b32 v45, v45, v44
v_lshlrev_b32 v44, 2, v46
v_lshlrev_b32_e64 v46, 3, v46
v_xor_b32 v38, 0x80000000, v38
v_mov_b32_e64 v39, v40
s_mov_b32 s3, 5242880
s_mov_b32 s39, 5259264
s_mov_b32 exec_lo, 1
s_mov_b32 exec_hi, 1
buffer_store_dword v45, v44, s[20:23], s3 offen sc1
buffer_store_dwordx2 v[38:39], v46, s[20:23], s39 offen sc1
s_mov_b64 exec, -1
s_load_dwordx2 s[4:5], s[0:1], 16
s_load_dwordx4 s[40:43], s[0:1], 64
s_load_dwordx2 s[92:93], s[0:1], 40
s_load_dwordx2 s[94:95], s[0:1], 80
s_load_dwordx2 s[100:101], s[0:1], 0
s_mov_b32 s28, s64
s_and_b32 s29, s65, 0xffff
s_mov_b32 s30, 256
s_mov_b32 s31, 0x20000
s_waitcnt vmcnt(4)
s_waitcnt lgkmcnt(0)
s_barrier
s_nop 0
Ta 32,12,0
Ta 34,12,2048
Ra 0,10,0
Ta 36,13,0
Ta 38,13,2048
Ra 4,10,2048
Ta 40,14,0
Ta 42,14,2048
Ra 8,10,4096
Ta 44,15,0
Ta 46,15,2048
Ra 12,10,6144
s_waitcnt lgkmcnt(2)
s_nop 0
Ta 48,16,0
Ta 50,16,2048
Ra 16,10,8192
Ta 52,17,0
Ta 54,17,2048
Ra 20,10,10240
Ta 56,18,0
Ta 58,18,2048
Ra 24,10,12288
Ta 60,19,0
Ta 62,19,2048
Ra 28,10,14336
s_cmp_lg_u32 s35, 0
s_cbranch_scc1 L_k1_vpath
s_waitcnt lgkmcnt(0)
s_add_u32 m0, s57, 65536
Zvaa 48,32,0
buffer_load_dwordx4 v6, s[12:15], s52 offen offset:0 nt lds
Zvaa 52,36,0
Ta 96,12,16384
Ta 98,12,18432
Zvaa 56,40,0
buffer_load_dwordx4 v7, s[12:15], s53 offen offset:1024 nt lds
Zvaa 60,44,0
Ra 64,11,0
Zvaa 64,48,0
buffer_load_dwordx4 v6, s[12:15], s54 offen offset:2048 nt lds
Zvaa 68,52,0
Ta 100,13,16384
Ta 102,13,18432
Zvaa 72,56,0
buffer_load_dwordx4 v7, s[12:15], s55 offen offset:3072 nt lds
Zvaa 76,60,0
s_add_u32 m0, s57, 69632
s_waitcnt lgkmcnt(6)
Ra 68,11,2048
Zvaa 80,32,4
buffer_load_dwordx4 v8, s[12:15], s52 offen offset:0 nt lds
Zvaa 84,36,4
Ta 104,14,16384
Ta 106,14,18432
Zvaa 88,40,4
buffer_load_dwordx4 v9, s[12:15], s53 offen offset:1024 nt lds
Zvaa 92,44,4
Ra 72,11,4096
Zvaa 96,48,4
buffer_load_dwordx4 v8, s[12:15], s54 offen offset:2048 nt lds
Zvaa 100,52,4
Ta 108,15,16384
Ta 110,15,18432
Zvaa 104,56,4
buffer_load_dwordx4 v9, s[12:15], s55 offen offset:3072 nt lds
Zvaa 108,60,4
s_add_u32 m0, s56, 65536
s_waitcnt lgkmcnt(6)
Ra 76,11,6144
Zvaa 112,32,8
buffer_load_dwordx4 v2, s[8:11], s48 offen offset:0 lds
Zvaa 116,36,8
Ta 112,16,16384
Ta 114,16,18432
Zvaa 120,40,8
buffer_load_dwordx4 v3, s[8:11], s49 offen offset:1024 lds
Zvaa 124,44,8
Ra 80,11,8192
v_xor_b32 v6, 1572864, v6
Zvaa 128,48,8
buffer_load_dwordx4 v2, s[8:11], s50 offen offset:2048 lds
Zvaa 132,52,8
Ta 116,17,16384
Ta 118,17,18432
Zvaa 136,56,8
buffer_load_dwordx4 v3, s[8:11], s51 offen offset:3072 lds
Zvaa 140,60,8
s_add_u32 m0, s56, 69632
s_waitcnt lgkmcnt(6)
Ra 84,11,10240
Zvaa 144,32,12
buffer_load_dwordx4 v4, s[8:11], s48 offen offset:0 lds
Zvaa 148,36,12
Ta 120,18,16384
Ta 122,18,18432
Zvaa 152,40,12
buffer_load_dwordx4 v5, s[8:11], s49 offen offset:1024 lds
Zvaa 156,44,12
Ra 88,11,12288
v_xor_b32 v7, 1572864, v7
Zvaa 160,48,12
buffer_load_dwordx4 v4, s[8:11], s50 offen offset:2048 lds
Zvaa 164,52,12
Ta 124,19,16384
Ta 126,19,18432
Zvaa 168,56,12
buffer_load_dwordx4 v5, s[8:11], s51 offen offset:3072 lds
Zvaa 172,60,12
s_waitcnt lgkmcnt(6)
Ra 92,11,14336
Zvaa 176,32,16
v_and_b32 v46, 7, v0
v_mul_u32_u24 v30, 2064, v46
Zvaa 180,36,16
v_xor_b32 v8, 1572864, v8
v_xor_b32 v9, 1572864, v9
Zvaa 184,40,16
v_lshrrev_b32_e64 v31, 3, v0
Zvaa 188,44,16
v_xor_b32 v2, 384, v2
v_xor_b32 v3, 384, v3
Zvaa 192,48,16
s_lshl_b32 s3, s32, 9
s_add_u32 s3, s3, 131072
v_lshl_add_u32 v30, v31, 4, v30
Zvaa 196,52,16
v_xor_b32 v4, 384, v4
v_xor_b32 v5, 384, v5
Zvaa 200,56,16
v_add_u32 v30, s3, v30
v_lshlrev_b32_e64 v31, 8, v31
Zvaa 204,60,16
v_lshl_add_u32 v46, v46, 4, v31
Zvaa 208,32,20
buffer_load_dword v1, v47, s[60:63], 0 offen
Zvaa 212,36,20
s_mul_i32 vcc_lo, s59, 7
v_xor_b32 v47, vcc_lo, v47
Zvaa 216,40,20
Rv 34,30,128
Rv 38,30,256
Zvaa 220,44,20
Rv 42,30,384
Rv 30,30,0
Zvaa 224,48,20
buffer_load_dword v1, v47, s[60:63], 0 offen
Zvaa 228,52,20
s_mul_i32 vcc_lo, s59, 1
v_xor_b32 v47, vcc_lo, v47
Zvaa 232,56,20
s_lshr_b32 s3, s2, 1
s_mul_i32 s3, s3, 33792
s_add_u32 s3, s3, s56
Zvaa 236,60,20
s_and_b32 s39, s2, 1
s_lshl_b32 s39, s39, 7
s_add_u32 s3, s3, s39
Zvaa 240,32,24
s_add_u32 s39, s3, 4096
Zvaa 244,36,24
Zvaa 248,40,24
Zvaa 252,44,24
Zaaa 128,48,24
Zaaa 132,52,24
Zaaa 136,56,24
Zaaa 140,60,24
Zaaa 144,32,28
Zaaa 148,36,28
Zaaa 152,40,28
Zaaa 156,44,28
Zaaa 160,48,28
Zaaa 164,52,28
Zaaa 168,56,28
Zaaa 172,60,28
s_waitcnt vmcnt(2) lgkmcnt(0)
s_add_u32 m0, s57, 0
s_barrier
Mvaa 48,96,64
buffer_load_dwordx4 v6, s[12:15], s52 offen offset:0 nt lds
Mvaa 52,100,64
Ta 32,22,0
Ta 34,22,2048
Mvaa 56,104,64
Mvaa 60,108,64
Ra 0,20,0
Mvaa 64,112,64
buffer_load_dwordx4 v7, s[12:15], s53 offen offset:1024 nt lds
Mvaa 68,116,64
s_waitcnt lgkmcnt(6)
Ta 36,23,0
Ta 38,23,2048
Mvaa 72,120,64
Mvaa 76,124,64
Ra 4,20,2048
Mvaa 80,96,68
buffer_load_dwordx4 v6, s[12:15], s54 offen offset:2048 nt lds
Mvaa 84,100,68
Ta 40,24,0
Ta 42,24,2048
Mvaa 88,104,68
Mvaa 92,108,68
Ra 8,20,4096
Mvaa 96,112,68
buffer_load_dwordx4 v7, s[12:15], s55 offen offset:3072 nt lds
Mvaa 100,116,68
s_waitcnt lgkmcnt(6)
Ta 44,25,0
Ta 46,25,2048
Mvaa 104,120,68
Mvaa 108,124,68
s_add_u32 m0, s57, 4096
Ra 12,20,6144
Mvaa 112,96,72
buffer_load_dwordx4 v8, s[12:15], s52 offen offset:0 nt lds
Mvaa 116,100,72
Ta 48,26,0
Ta 50,26,2048
Mvaa 120,104,72
Mvaa 124,108,72
Ra 16,20,8192
Mvaa 128,112,72
buffer_load_dwordx4 v9, s[12:15], s53 offen offset:1024 nt lds
Mvaa 132,116,72
s_waitcnt lgkmcnt(6)
Ta 52,27,0
Ta 54,27,2048
Mvaa 136,120,72
Mvaa 140,124,72
Ra 20,20,10240
Mvaa 144,96,76
buffer_load_dwordx4 v8, s[12:15], s54 offen offset:2048 nt lds
Mvaa 148,100,76
Ta 56,28,0
Ta 58,28,2048
Mvaa 152,104,76
Mvaa 156,108,76
Ra 24,20,12288
Mvaa 160,112,76
buffer_load_dwordx4 v9, s[12:15], s55 offen offset:3072 nt lds
Mvaa 164,116,76
s_waitcnt lgkmcnt(6)
Ta 60,29,0
Ta 62,29,2048
Mvaa 168,120,76
v_xor_b32 v6, 524288, v6
v_xor_b32 v7, 524288, v7
Mvaa 172,124,76
s_add_u32 m0, s56, 0
Ra 28,20,14336
v_xor_b32 v8, 524288, v8
Mvaa 176,96,80
buffer_load_dwordx4 v2, s[8:11], s48 offen offset:0 lds
Mvaa 180,100,80
v_xor_b32 v9, 524288, v9
Mvaa 184,104,80
Mvaa 188,108,80
Mvaa 192,112,80
buffer_load_dwordx4 v3, s[8:11], s49 offen offset:1024 lds
Mvaa 196,116,80
Mvaa 200,120,80
Mvaa 204,124,80
Mvaa 208,96,84
buffer_load_dwordx4 v2, s[8:11], s50 offen offset:2048 lds
Mvaa 212,100,84
Mvaa 216,104,84
Mvaa 220,108,84
Mvaa 224,112,84
buffer_load_dwordx4 v3, s[8:11], s51 offen offset:3072 lds
Mvaa 228,116,84
Mvaa 232,120,84
Mvaa 236,124,84
s_add_u32 m0, s56, 4096
Mvaa 240,96,88
buffer_load_dwordx4 v4, s[8:11], s48 offen offset:0 lds
Mvaa 244,100,88
Mvaa 248,104,88
Mvaa 252,108,88
Maaa 128,112,88
buffer_load_dwordx4 v5, s[8:11], s49 offen offset:1024 lds
Maaa 132,116,88
Maaa 136,120,88
Maaa 140,124,88
Maaa 144,96,92
buffer_load_dwordx4 v4, s[8:11], s50 offen offset:2048 lds
Maaa 148,100,92
Maaa 152,104,92
Maaa 156,108,92
Maaa 160,112,92
buffer_load_dwordx4 v5, s[8:11], s51 offen offset:3072 lds
Maaa 164,116,92
v_xor_b32 v2, 128, v2
v_xor_b32 v3, 128, v3
Maaa 168,120,92
buffer_load_dword v1, v47, s[60:63], 0 offen
v_xor_b32 v4, 128, v4
v_xor_b32 v5, 128, v5
Maaa 172,124,92
s_mul_i32 vcc_lo, s59, 3
v_xor_b32 v47, vcc_lo, v47
s_waitcnt lgkmcnt(0)
Mvaa 48,32,0
buffer_store_dwordx4 v[30:33], v46, s[20:23], s3 offen offset:0 sc1
Mvaa 52,36,0
Ta 96,22,16384
Ta 98,22,18432
Mvaa 56,40,0
buffer_store_dwordx4 v[34:37], v46, s[20:23], s3 offen offset:2048 sc1
Mvaa 60,44,0
Ra 64,21,0
Mvaa 64,48,0
buffer_store_dwordx4 v[38:41], v46, s[20:23], s39 offen offset:0 sc1
Mvaa 68,52,0
Ta 100,23,16384
Ta 102,23,18432
Mvaa 72,56,0
buffer_store_dwordx4 v[42:45], v46, s[20:23], s39 offen offset:2048 sc1
Mvaa 76,60,0
s_waitcnt lgkmcnt(6)
Ra 68,21,2048
Mvaa 80,32,4
s_lshl_b32 s3, s34, 1
s_and_b32 s36, s32, 1
s_add_u32 s3, s3, s36
Mvaa 84,36,4
Ta 104,24,16384
Ta 106,24,18432
Mvaa 88,40,4
s_mul_i32 s3, s3, 1116160
s_mul_i32 s36, s33, 139264
s_add_u32 s3, s3, s36
Mvaa 92,44,4
Ra 72,21,4096
Mvaa 96,48,4
s_lshr_b32 s36, s32, 1
s_mul_i32 s36, s36, 69632
s_add_u32 s3, s3, s36
Mvaa 100,52,4
Ta 108,25,16384
Ta 110,25,18432
Mvaa 104,56,4
s_add_u32 s38, s3, 0
s_lshl_b32 s39, s34, 7
s_lshl_b32 s36, s33, 2
Mvaa 108,60,4
s_waitcnt lgkmcnt(6)
Ra 76,21,6144
Mvaa 112,32,8
s_add_u32 s39, s39, s36
s_add_u32 s39, s39, 5296128
v_mov_b32_e64 v30, 1
Mvaa 116,36,8
Ta 112,26,16384
Ta 114,26,18432
Mvaa 120,40,8
v_mov_b32_e64 v31, 0
Mvaa 124,44,8
Ra 80,21,8192
Mvaa 128,48,8
s_cmp_eq_u32 s32, 0
s_cselect_b32 s39, s39, 2146435072
Mvaa 132,52,8
Ta 116,27,16384
Ta 118,27,18432
Mvaa 136,56,8
s_mov_b64 exec, 1
buffer_store_dword v31, v31, s[20:23], s39 offen sc1
s_mov_b64 exec, -1
Mvaa 140,60,8
s_waitcnt lgkmcnt(6)
Ra 84,21,10240
Mvaa 144,32,12
s_and_b32 s33, s2, 7
s_lshl_b32 s33, s33, 2
s_bfe_u32 s3, s2, 0x20003
Mvaa 148,36,12
Ta 120,28,16384
Ta 122,28,18432
Mvaa 152,40,12
s_add_u32 s33, s33, s3
s_lshr_b32 s34, s2, 5
s_lshl_b32 s64, s34, 7
Mvaa 156,44,12
Ra 88,21,12288
Mvaa 160,48,12
s_lshl_b32 s3, s33, 2
s_add_u32 s64, s64, s3
s_add_u32 s64, s64, 5300224
Mvaa 164,52,12
Ta 124,29,16384
Ta 126,29,18432
Mvaa 168,56,12
s_lshl_b32 s65, s34, 8
s_sub_u32 s65, 1920, s65
v_mul_u32_u24_e64 v32, s65, v0
Mvaa 172,60,12
s_waitcnt lgkmcnt(6)
Ra 92,21,14336
Mvaa 176,32,16
s_cmp_eq_u32 s32, 0
s_cselect_b32 s64, s64, 2146435072
Mvaa 180,36,16
s_mov_b64 exec, 3
buffer_store_dword v31, v32, s[20:23], s64 offen sc1
s_mov_b64 exec, -1
Mvaa 184,40,16
s_lshl_b32 s3, s2, 2
s_add_u32 s3, s3, 5447680
v_lshlrev_b32 v32, 10, v0
Mvaa 188,44,16
s_cmp_eq_u32 s32, 0
s_cselect_b32 s3, s3, 2146435072
Mvaa 192,48,16
s_mov_b64 exec, 0x1ff
buffer_store_dword v31, v32, s[20:23], s3 offen sc1
s_mov_b64 exec, -1
Mvaa 196,52,16
s_lshl_b32 s35, s34, 1
s_sub_u32 s36, 32, s35
s_add_u32 s35, s35, 2
Mvaa 200,56,16
s_lshl_b32 s44, s32, 12
s_lshl_b32 s58, s32, 1
s_sub_u32 s58, 7, s58
Mvaa 204,60,16
s_mul_i32 s58, s58, 33792
s_sub_u32 s3, 15, s34
s_lshl_b32 s45, s3, 3
Mvaa 208,32,20
s_add_u32 s45, s45, s32
s_lshl_b32 s46, s34, 3
s_add_u32 s46, s46, s32
Mvaa 212,36,20
s_mov_b32 s68, s42
s_and_b32 s69, s43, 0xffff
s_mov_b32 s70, 7340032
Mvaa 216,40,20
s_mov_b32 s71, 0x20000
s_cmp_eq_u32 s32, 0
s_cselect_b32 s37, 0, 2146435072
Mvaa 220,44,20
s_lshl_b32 s3, s33, 8
s_add_u32 s16, s4, s3
s_addc_u32 s17, s5, 0
s_and_b32 s17, s17, 0xffff
Mvaa 224,48,20
s_mov_b32 s18, 0
s_mov_b32 s19, 0x20000
s_sub_u32 s18, 8388608, s3
Mvaa 228,52,20
v_and_b32 v33, 15, v0
v_lshrrev_b32_e64 v32, 1, v33
Mvaa 232,56,20
v_and_b32 v33, 1, v0
v_lshlrev_b32 v32, 13, v32
Mvaa 236,60,20
v_lshl_add_u32 v45, v33, 7, v32
Mvaa 240,32,24
s_lshl_b32 s3, s32, 3
s_add_u32 s3, s3, s34
s_mul_i32 s47, s3, 65536
Mvaa 244,36,24
s_bfe_u32 s6, s2, 131075
s_lshl_b32 s3, s32, 8
s_or_b32 s6, s6, s3
Mvaa 248,40,24
Mvaa 252,44,24
Maaa 128,48,24
Maaa 132,52,24
Maaa 136,56,24
Maaa 140,60,24
Maaa 144,32,28
Maaa 148,36,28
Maaa 152,40,28
Maaa 156,44,28
Maaa 160,48,28
Maaa 164,52,28
Maaa 168,56,28
Maaa 172,60,28
s_waitcnt vmcnt(8) lgkmcnt(0)
s_add_u32 m0, s57, 65536
s_barrier
Mvaa 48,96,64
buffer_load_dwordx4 v6, s[12:15], s52 offen offset:0 nt lds
Mvaa 52,100,64
Ta 32,12,0
Ta 34,12,2048
Mvaa 56,104,64
Mvaa 60,108,64
Ra 0,10,0
Mvaa 64,112,64
buffer_load_dwordx4 v7, s[12:15], s53 offen offset:1024 nt lds
Mvaa 68,116,64
s_waitcnt lgkmcnt(6)
Ta 36,13,0
Ta 38,13,2048
Mvaa 72,120,64
Mvaa 76,124,64
Ra 4,10,2048
Mvaa 80,96,68
buffer_load_dwordx4 v6, s[12:15], s54 offen offset:2048 nt lds
Mvaa 84,100,68
Ta 40,14,0
Ta 42,14,2048
Mvaa 88,104,68
Mvaa 92,108,68
Ra 8,10,4096
Mvaa 96,112,68
buffer_load_dwordx4 v7, s[12:15], s55 offen offset:3072 nt lds
Mvaa 100,116,68
s_waitcnt lgkmcnt(6)
Ta 44,15,0
Ta 46,15,2048
Mvaa 104,120,68
Mvaa 108,124,68
s_add_u32 m0, s57, 69632
Ra 12,10,6144
Mvaa 112,96,72
buffer_load_dwordx4 v8, s[12:15], s52 offen offset:0 nt lds
Mvaa 116,100,72
Ta 48,16,0
Ta 50,16,2048
Mvaa 120,104,72
Mvaa 124,108,72
Ra 16,10,8192
Mvaa 128,112,72
buffer_load_dwordx4 v9, s[12:15], s53 offen offset:1024 nt lds
Mvaa 132,116,72
s_waitcnt lgkmcnt(6)
Ta 52,17,0
Ta 54,17,2048
Mvaa 136,120,72
Mvaa 140,124,72
Ra 20,10,10240
Mvaa 144,96,76
buffer_load_dwordx4 v8, s[12:15], s54 offen offset:2048 nt lds
Mvaa 148,100,76
Ta 56,18,0
Ta 58,18,2048
Mvaa 152,104,76
Mvaa 156,108,76
Ra 24,10,12288
Mvaa 160,112,76
buffer_load_dwordx4 v9, s[12:15], s55 offen offset:3072 nt lds
Mvaa 164,116,76
s_waitcnt lgkmcnt(6)
Ta 60,19,0
Ta 62,19,2048
Mvaa 168,120,76
v_xor_b32 v6, 3670016, v6
v_xor_b32 v7, 3670016, v7
Mvaa 172,124,76
s_add_u32 m0, s56, 65536
Ra 28,10,14336
v_xor_b32 v8, 3670016, v8
Mvaa 176,96,80
buffer_load_dwordx4 v2, s[8:11], s48 offen offset:0 lds
Mvaa 180,100,80
v_xor_b32 v9, 3670016, v9
Mvaa 184,104,80
Mvaa 188,108,80
Mvaa 192,112,80
buffer_load_dwordx4 v3, s[8:11], s49 offen offset:1024 lds
Mvaa 196,116,80
Mvaa 200,120,80
Mvaa 204,124,80
Mvaa 208,96,84
buffer_load_dwordx4 v2, s[8:11], s50 offen offset:2048 lds
Mvaa 212,100,84
Mvaa 216,104,84
Mvaa 220,108,84
Mvaa 224,112,84
buffer_load_dwordx4 v3, s[8:11], s51 offen offset:3072 lds
Mvaa 228,116,84
Mvaa 232,120,84
Mvaa 236,124,84
s_add_u32 m0, s56, 69632
Mvaa 240,96,88
buffer_load_dwordx4 v4, s[8:11], s48 offen offset:0 lds
Mvaa 244,100,88
Mvaa 248,104,88
Mvaa 252,108,88
Maaa 128,112,88
buffer_load_dwordx4 v5, s[8:11], s49 offen offset:1024 lds
Maaa 132,116,88
Maaa 136,120,88
Maaa 140,124,88
Maaa 144,96,92
buffer_load_dwordx4 v4, s[8:11], s50 offen offset:2048 lds
Maaa 148,100,92
Maaa 152,104,92
Maaa 156,108,92
Maaa 160,112,92
buffer_load_dwordx4 v5, s[8:11], s51 offen offset:3072 lds
Maaa 164,116,92
v_xor_b32 v2, 896, v2
v_xor_b32 v3, 896, v3
Maaa 168,120,92
buffer_load_dword v1, v47, s[60:63], 0 offen
v_xor_b32 v4, 896, v4
v_xor_b32 v5, 896, v5
Maaa 172,124,92
s_mul_i32 vcc_lo, s59, 1
v_xor_b32 v47, vcc_lo, v47
s_waitcnt lgkmcnt(0)
Mvaa 48,32,0
Mvaa 52,36,0
Ta 96,12,16384
Ta 98,12,18432
Mvaa 56,40,0
Mvaa 60,44,0
Ra 64,11,0
Mvaa 64,48,0
Mvaa 68,52,0
Ta 100,13,16384
Ta 102,13,18432
Mvaa 72,56,0
Mvaa 76,60,0
s_waitcnt lgkmcnt(6)
Ra 68,11,2048
Mvaa 80,32,4
Mvaa 84,36,4
Ta 104,14,16384
Ta 106,14,18432
Mvaa 88,40,4
Mvaa 92,44,4
Ra 72,11,4096
Mvaa 96,48,4
Mvaa 100,52,4
Ta 108,15,16384
Ta 110,15,18432
Mvaa 104,56,4
Mvaa 108,60,4
s_waitcnt lgkmcnt(6)
Ra 76,11,6144
Mvaa 112,32,8
Mvaa 116,36,8
Ta 112,16,16384
Ta 114,16,18432
Mvaa 120,40,8
Mvaa 124,44,8
Ra 80,11,8192
Mvaa 128,48,8
Mvaa 132,52,8
Ta 116,17,16384
Ta 118,17,18432
Mvaa 136,56,8
Mvaa 140,60,8
s_waitcnt lgkmcnt(6)
Ra 84,11,10240
Mvaa 144,32,12
Mvaa 148,36,12
Ta 120,18,16384
Ta 122,18,18432
Mvaa 152,40,12
Mvaa 156,44,12
Ra 88,11,12288
Mvaa 160,48,12
Mvaa 164,52,12
Ta 124,19,16384
Ta 126,19,18432
Mvaa 168,56,12
Mvaa 172,60,12
s_waitcnt lgkmcnt(6)
Ra 92,11,14336
Mvaa 176,32,16
Mvaa 180,36,16
Mvaa 184,40,16
Mvaa 188,44,16
Mvaa 192,48,16
Mvaa 196,52,16
Mvaa 200,56,16
Mvaa 204,60,16
Mvaa 208,32,20
Mvaa 212,36,20
Mvaa 216,40,20
Mvaa 220,44,20
Mvaa 224,48,20
Mvaa 228,52,20
Mvaa 232,56,20
Mvaa 236,60,20
Mvaa 240,32,24
Mvaa 244,36,24
Mvaa 248,40,24
Mvaa 252,44,24
Maaa 128,48,24
Maaa 132,52,24
Maaa 136,56,24
Maaa 140,60,24
Maaa 144,32,28
Maaa 148,36,28
Maaa 152,40,28
Maaa 156,44,28
Maaa 160,48,28
Maaa 164,52,28
Maaa 168,56,28
Maaa 172,60,28
s_waitcnt vmcnt(1) lgkmcnt(0)
s_add_u32 m0, s57, 0
s_barrier
Mvaa 48,96,64
buffer_load_dwordx4 v6, s[12:15], s52 offen offset:0 nt lds
Mvaa 52,100,64
Ta 32,22,0
Ta 34,22,2048
Mvaa 56,104,64
Mvaa 60,108,64
Ra 0,20,0
Mvaa 64,112,64
buffer_load_dwordx4 v7, s[12:15], s53 offen offset:1024 nt lds
Mvaa 68,116,64
s_waitcnt lgkmcnt(6)
Ta 36,23,0
Ta 38,23,2048
Mvaa 72,120,64
Mvaa 76,124,64
Ra 4,20,2048
Mvaa 80,96,68
buffer_load_dwordx4 v6, s[12:15], s54 offen offset:2048 nt lds
Mvaa 84,100,68
Ta 40,24,0
Ta 42,24,2048
Mvaa 88,104,68
Mvaa 92,108,68
Ra 8,20,4096
Mvaa 96,112,68
buffer_load_dwordx4 v7, s[12:15], s55 offen offset:3072 nt lds
Mvaa 100,116,68
s_waitcnt lgkmcnt(6)
Ta 44,25,0
Ta 46,25,2048
Mvaa 104,120,68
s_cmp_eq_u32 s6, 0
s_cselect_b32 s3, 0, 2146435072
Mvaa 108,124,68
s_add_u32 m0, s57, 4096
Ra 12,20,6144
Mvaa 112,96,72
buffer_load_dwordx4 v8, s[12:15], s52 offen offset:0 nt lds
Mvaa 116,100,72
Ta 48,26,0
Ta 50,26,2048
Mvaa 120,104,72
s_mov_b64 exec, 1
buffer_atomic_add v30, v31, s[28:31], s3 offen sc1
s_mov_b64 exec, -1
Mvaa 124,108,72
Ra 16,20,8192
Mvaa 128,112,72
buffer_load_dwordx4 v9, s[12:15], s53 offen offset:1024 nt lds
Mvaa 132,116,72
s_waitcnt lgkmcnt(6)
Ta 52,27,0
Ta 54,27,2048
Mvaa 136,120,72
Mvaa 140,124,72
Ra 20,20,10240
Mvaa 144,96,76
buffer_load_dwordx4 v8, s[12:15], s54 offen offset:2048 nt lds
Mvaa 148,100,76
Ta 56,28,0
Ta 58,28,2048
Mvaa 152,104,76
Mvaa 156,108,76
Ra 24,20,12288
Mvaa 160,112,76
buffer_load_dwordx4 v9, s[12:15], s55 offen offset:3072 nt lds
Mvaa 164,116,76
s_waitcnt lgkmcnt(6)
Ta 60,29,0
Ta 62,29,2048
Mvaa 168,120,76
v_xor_b32 v6, 524288, v6
v_xor_b32 v7, 524288, v7
Mvaa 172,124,76
s_add_u32 m0, s56, 0
Ra 28,20,14336
v_xor_b32 v8, 524288, v8
Mvaa 176,96,80
buffer_load_dwordx4 v2, s[8:11], s48 offen offset:0 lds
Mvaa 180,100,80
v_xor_b32 v9, 524288, v9
Mvaa 184,104,80
Mvaa 188,108,80
Mvaa 192,112,80
buffer_load_dwordx4 v3, s[8:11], s49 offen offset:1024 lds
Mvaa 196,116,80
Mvaa 200,120,80
Mvaa 204,124,80
Mvaa 208,96,84
buffer_load_dwordx4 v2, s[8:11], s50 offen offset:2048 lds
Mvaa 212,100,84
Mvaa 216,104,84
Mvaa 220,108,84
Mvaa 224,112,84
buffer_load_dwordx4 v3, s[8:11], s51 offen offset:3072 lds
Mvaa 228,116,84
Mvaa 232,120,84
Mvaa 236,124,84
s_add_u32 m0, s56, 4096
Mvaa 240,96,88
buffer_load_dwordx4 v4, s[8:11], s48 offen offset:0 lds
Mvaa 244,100,88
Mvaa 248,104,88
Mvaa 252,108,88
Maaa 128,112,88
buffer_load_dwordx4 v5, s[8:11], s49 offen offset:1024 lds
Maaa 132,116,88
Maaa 136,120,88
Maaa 140,124,88
Maaa 144,96,92
buffer_load_dwordx4 v4, s[8:11], s50 offen offset:2048 lds
Maaa 148,100,92
Maaa 152,104,92
Maaa 156,108,92
Maaa 160,112,92
buffer_load_dwordx4 v5, s[8:11], s51 offen offset:3072 lds
Maaa 164,116,92
v_xor_b32 v2, 128, v2
v_xor_b32 v3, 128, v3
Maaa 168,120,92
buffer_load_dword v1, v47, s[60:63], 0 offen
v_xor_b32 v4, 128, v4
v_xor_b32 v5, 128, v5
Maaa 172,124,92
s_mul_i32 vcc_lo, s59, 7
v_xor_b32 v47, vcc_lo, v47
s_waitcnt lgkmcnt(0)
Mvaa 48,32,0
buffer_load_dword v44, v45, s[16:19], s47 offen
Mvaa 52,36,0
Ta 96,22,16384
Ta 98,22,18432
Mvaa 56,40,0
s_add_u32 s47, s47, 2097152
Mvaa 60,44,0
Ra 64,21,0
Mvaa 64,48,0
Mvaa 68,52,0
Ta 100,23,16384
Ta 102,23,18432
Mvaa 72,56,0
Mvaa 76,60,0
s_waitcnt lgkmcnt(6)
Ra 68,21,2048
Mvaa 80,32,4
Mvaa 84,36,4
Ta 104,24,16384
Ta 106,24,18432
Mvaa 88,40,4
Mvaa 92,44,4
Ra 72,21,4096
Mvaa 96,48,4
Mvaa 100,52,4
Ta 108,25,16384
Ta 110,25,18432
Mvaa 104,56,4
Mvaa 108,60,4
s_waitcnt lgkmcnt(6)
Ra 76,21,6144
Mvaa 112,32,8
Mvaa 116,36,8
Ta 112,26,16384
Ta 114,26,18432
Mvaa 120,40,8
Mvaa 124,44,8
Ra 80,21,8192
Mvaa 128,48,8
Mvaa 132,52,8
Ta 116,27,16384
Ta 118,27,18432
Mvaa 136,56,8
Mvaa 140,60,8
s_waitcnt lgkmcnt(6)
Ra 84,21,10240
Mvaa 144,32,12
Mvaa 148,36,12
Ta 120,28,16384
Ta 122,28,18432
Mvaa 152,40,12
s_cmp_eq_u32 s6, 1
s_cselect_b32 s3, 0, 2146435072
Mvaa 156,44,12
Ra 88,21,12288
Mvaa 160,48,12
s_mov_b64 exec, 1
buffer_atomic_add v30, v31, s[28:31], s3 offen sc1
s_mov_b64 exec, -1
Mvaa 164,52,12
Ta 124,29,16384
Ta 126,29,18432
Mvaa 168,56,12
Mvaa 172,60,12
s_waitcnt lgkmcnt(6)
Ra 92,21,14336
Mvaa 176,32,16
Mvaa 180,36,16
Mvaa 184,40,16
Mvaa 188,44,16
Mvaa 192,48,16
Mvaa 196,52,16
Mvaa 200,56,16
Mvaa 204,60,16
Mvaa 208,32,20
Mvaa 212,36,20
Mvaa 216,40,20
Mvaa 220,44,20
Mvaa 224,48,20
Mvaa 228,52,20
Mvaa 232,56,20
Mvaa 236,60,20
Mvaa 240,32,24
Mvaa 244,36,24
Mvaa 248,40,24
Mvaa 252,44,24
Maaa 128,48,24
Maaa 132,52,24
Maaa 136,56,24
Maaa 140,60,24
Maaa 144,32,28
Maaa 148,36,28
Maaa 152,40,28
Maaa 156,44,28
Maaa 160,48,28
Maaa 164,52,28
Maaa 168,56,28
Maaa 172,60,28
s_waitcnt vmcnt(3) lgkmcnt(0)
s_add_u32 m0, s57, 65536
s_barrier
Mvaa 48,96,64
buffer_load_dwordx4 v6, s[12:15], s52 offen offset:0 nt lds
Mvaa 52,100,64
Ta 32,12,0
Ta 34,12,2048
Mvaa 56,104,64
Mvaa 60,108,64
Ra 0,10,0
Mvaa 64,112,64
buffer_load_dwordx4 v7, s[12:15], s53 offen offset:1024 nt lds
Mvaa 68,116,64
s_waitcnt lgkmcnt(6)
Ta 36,13,0
Ta 38,13,2048
Mvaa 72,120,64
Mvaa 76,124,64
Ra 4,10,2048
Mvaa 80,96,68
buffer_load_dwordx4 v6, s[12:15], s54 offen offset:2048 nt lds
Mvaa 84,100,68
Ta 40,14,0
Ta 42,14,2048
Mvaa 88,104,68
Mvaa 92,108,68
Ra 8,10,4096
Mvaa 96,112,68
buffer_load_dwordx4 v7, s[12:15], s55 offen offset:3072 nt lds
Mvaa 100,116,68
s_waitcnt lgkmcnt(6)
Ta 44,15,0
Ta 46,15,2048
Mvaa 104,120,68
Mvaa 108,124,68
s_add_u32 m0, s57, 69632
Ra 12,10,6144
Mvaa 112,96,72
buffer_load_dwordx4 v8, s[12:15], s52 offen offset:0 nt lds
Mvaa 116,100,72
Ta 48,16,0
Ta 50,16,2048
Mvaa 120,104,72
Mvaa 124,108,72
Ra 16,10,8192
Mvaa 128,112,72
buffer_load_dwordx4 v9, s[12:15], s53 offen offset:1024 nt lds
Mvaa 132,116,72
s_waitcnt lgkmcnt(6)
Ta 52,17,0
Ta 54,17,2048
Mvaa 136,120,72
Mvaa 140,124,72
Ra 20,10,10240
Mvaa 144,96,76
buffer_load_dwordx4 v8, s[12:15], s54 offen offset:2048 nt lds
Mvaa 148,100,76
Ta 56,18,0
Ta 58,18,2048
Mvaa 152,104,76
Mvaa 156,108,76
Ra 24,10,12288
Mvaa 160,112,76
buffer_load_dwordx4 v9, s[12:15], s55 offen offset:3072 nt lds
Mvaa 164,116,76
s_waitcnt lgkmcnt(6)
Ta 60,19,0
Ta 62,19,2048
Mvaa 168,120,76
v_xor_b32 v6, 1572864, v6
v_xor_b32 v7, 1572864, v7
Mvaa 172,124,76
s_add_u32 m0, s56, 65536
Ra 28,10,14336
v_xor_b32 v8, 1572864, v8
Mvaa 176,96,80
buffer_load_dwordx4 v2, s[8:11], s48 offen offset:0 lds
Mvaa 180,100,80
v_xor_b32 v9, 1572864, v9
Mvaa 184,104,80
Mvaa 188,108,80
Mvaa 192,112,80
buffer_load_dwordx4 v3, s[8:11], s49 offen offset:1024 lds
Mvaa 196,116,80
Mvaa 200,120,80
Mvaa 204,124,80
s_cmp_eq_u32 s6, 2
s_cselect_b32 s3, 0, 2146435072
Mvaa 208,96,84
buffer_load_dwordx4 v2, s[8:11], s50 offen offset:2048 lds
Mvaa 212,100,84
s_mov_b64 exec, 1
buffer_atomic_add v30, v31, s[28:31], s3 offen sc1
s_mov_b64 exec, -1
Mvaa 216,104,84
Mvaa 220,108,84
Mvaa 224,112,84
buffer_load_dwordx4 v3, s[8:11], s51 offen offset:3072 lds
Mvaa 228,116,84
Mvaa 232,120,84
Mvaa 236,124,84
s_add_u32 m0, s56, 69632
Mvaa 240,96,88
buffer_load_dwordx4 v4, s[8:11], s48 offen offset:0 lds
Mvaa 244,100,88
Mvaa 248,104,88
Mvaa 252,108,88
Maaa 128,112,88
buffer_load_dwordx4 v5, s[8:11], s49 offen offset:1024 lds
Maaa 132,116,88
Maaa 136,120,88
Maaa 140,124,88
Maaa 144,96,92
buffer_load_dwordx4 v4, s[8:11], s50 offen offset:2048 lds
Maaa 148,100,92
Maaa 152,104,92
Maaa 156,108,92
Maaa 160,112,92
buffer_load_dwordx4 v5, s[8:11], s51 offen offset:3072 lds
Maaa 164,116,92
v_xor_b32 v2, 384, v2
v_xor_b32 v3, 384, v3
Maaa 168,120,92
v_xor_b32 v4, 384, v4
v_xor_b32 v5, 384, v5
Maaa 172,124,92
s_waitcnt lgkmcnt(0)
Mvaa 48,32,0
buffer_load_dword v44, v45, s[16:19], s47 offen
Mvaa 52,36,0
Ta 96,12,16384
Ta 98,12,18432
Mvaa 56,40,0
s_add_u32 s47, s47, 2097152
Mvaa 60,44,0
Ra 64,11,0
Mvaa 64,48,0
Mvaa 68,52,0
Ta 100,13,16384
Ta 102,13,18432
Mvaa 72,56,0
Mvaa 76,60,0
s_waitcnt lgkmcnt(6)
Ra 68,11,2048
Mvaa 80,32,4
Mvaa 84,36,4
Ta 104,14,16384
Ta 106,14,18432
Mvaa 88,40,4
Mvaa 92,44,4
Ra 72,11,4096
Mvaa 96,48,4
Mvaa 100,52,4
Ta 108,15,16384
Ta 110,15,18432
Mvaa 104,56,4
Mvaa 108,60,4
s_waitcnt lgkmcnt(6)
Ra 76,11,6144
Mvaa 112,32,8
Mvaa 116,36,8
Ta 112,16,16384
Ta 114,16,18432
Mvaa 120,40,8
Mvaa 124,44,8
Ra 80,11,8192
Mvaa 128,48,8
Mvaa 132,52,8
Ta 116,17,16384
Ta 118,17,18432
Mvaa 136,56,8
Mvaa 140,60,8
s_waitcnt lgkmcnt(6)
Ra 84,11,10240
Mvaa 144,32,12
Mvaa 148,36,12
Ta 120,18,16384
Ta 122,18,18432
Mvaa 152,40,12
Mvaa 156,44,12
Ra 88,11,12288
Mvaa 160,48,12
Mvaa 164,52,12
Ta 124,19,16384
Ta 126,19,18432
Mvaa 168,56,12
Mvaa 172,60,12
s_waitcnt lgkmcnt(6)
Ra 92,11,14336
Mvaa 176,32,16
Mvaa 180,36,16
Mvaa 184,40,16
Mvaa 188,44,16
Mvaa 192,48,16
Mvaa 196,52,16
Mvaa 200,56,16
Mvaa 204,60,16
Mvaa 208,32,20
Mvaa 212,36,20
Mvaa 216,40,20
Mvaa 220,44,20
Mvaa 224,48,20
Mvaa 228,52,20
Mvaa 232,56,20
Mvaa 236,60,20
Mvaa 240,32,24
Mvaa 244,36,24
Mvaa 248,40,24
Mvaa 252,44,24
Maaa 128,48,24
s_cmp_eq_u32 s6, 3
s_cselect_b32 s3, 0, 2146435072
Maaa 132,52,24
s_mov_b64 exec, 1
buffer_atomic_add v30, v31, s[28:31], s3 offen sc1
s_mov_b64 exec, -1
Maaa 136,56,24
Maaa 140,60,24
Maaa 144,32,28
Maaa 148,36,28
Maaa 152,40,28
Maaa 156,44,28
Maaa 160,48,28
Maaa 164,52,28
Maaa 168,56,28
Maaa 172,60,28
s_waitcnt vmcnt(2) lgkmcnt(0)
s_add_u32 m0, s57, 0
s_barrier
Mvaa 48,96,64
buffer_load_dwordx4 v6, s[12:15], s52 offen offset:0 nt lds
Mvaa 52,100,64
Ta 32,22,0
Ta 34,22,2048
Mvaa 56,104,64
Mvaa 60,108,64
Ra 0,20,0
Mvaa 64,112,64
buffer_load_dwordx4 v7, s[12:15], s53 offen offset:1024 nt lds
Mvaa 68,116,64
s_waitcnt lgkmcnt(6)
Ta 36,23,0
Ta 38,23,2048
Mvaa 72,120,64
Mvaa 76,124,64
Ra 4,20,2048
Mvaa 80,96,68
buffer_load_dwordx4 v6, s[12:15], s54 offen offset:2048 nt lds
Mvaa 84,100,68
Ta 40,24,0
Ta 42,24,2048
Mvaa 88,104,68
Mvaa 92,108,68
Ra 8,20,4096
Mvaa 96,112,68
buffer_load_dwordx4 v7, s[12:15], s55 offen offset:3072 nt lds
Mvaa 100,116,68
s_waitcnt lgkmcnt(6)
Ta 44,25,0
Ta 46,25,2048
Mvaa 104,120,68
Mvaa 108,124,68
s_add_u32 m0, s57, 4096
Ra 12,20,6144
Mvaa 112,96,72
buffer_load_dwordx4 v8, s[12:15], s52 offen offset:0 nt lds
Mvaa 116,100,72
Ta 48,26,0
Ta 50,26,2048
Mvaa 120,104,72
Mvaa 124,108,72
Ra 16,20,8192
Mvaa 128,112,72
buffer_load_dwordx4 v9, s[12:15], s53 offen offset:1024 nt lds
Mvaa 132,116,72
s_waitcnt lgkmcnt(6)
Ta 52,27,0
Ta 54,27,2048
Mvaa 136,120,72
Mvaa 140,124,72
Ra 20,20,10240
Mvaa 144,96,76
buffer_load_dwordx4 v8, s[12:15], s54 offen offset:2048 nt lds
Mvaa 148,100,76
Ta 56,28,0
Ta 58,28,2048
Mvaa 152,104,76
Mvaa 156,108,76
Ra 24,20,12288
Mvaa 160,112,76
buffer_load_dwordx4 v9, s[12:15], s55 offen offset:3072 nt lds
Mvaa 164,116,76
s_waitcnt lgkmcnt(6)
Ta 60,29,0
Ta 62,29,2048
Mvaa 168,120,76
v_xor_b32 v6, 524288, v6
v_xor_b32 v7, 524288, v7
Mvaa 172,124,76
s_add_u32 m0, s56, 0
Ra 28,20,14336
v_xor_b32 v8, 524288, v8
Mvaa 176,96,80
buffer_load_dwordx4 v2, s[8:11], s48 offen offset:0 lds
Mvaa 180,100,80
v_xor_b32 v9, 524288, v9
Mvaa 184,104,80
Mvaa 188,108,80
Mvaa 192,112,80
buffer_load_dwordx4 v3, s[8:11], s49 offen offset:1024 lds
Mvaa 196,116,80
Mvaa 200,120,80
Mvaa 204,124,80
Mvaa 208,96,84
buffer_load_dwordx4 v2, s[8:11], s50 offen offset:2048 lds
Mvaa 212,100,84
Mvaa 216,104,84
Mvaa 220,108,84
Mvaa 224,112,84
buffer_load_dwordx4 v3, s[8:11], s51 offen offset:3072 lds
Mvaa 228,116,84
Mvaa 232,120,84
Mvaa 236,124,84
s_add_u32 m0, s56, 4096
Mvaa 240,96,88
buffer_load_dwordx4 v4, s[8:11], s48 offen offset:0 lds
Mvaa 244,100,88
Mvaa 248,104,88
Mvaa 252,108,88
Maaa 128,112,88
buffer_load_dwordx4 v5, s[8:11], s49 offen offset:1024 lds
Maaa 132,116,88
Maaa 136,120,88
Maaa 140,124,88
Maaa 144,96,92
buffer_load_dwordx4 v4, s[8:11], s50 offen offset:2048 lds
Maaa 148,100,92
Maaa 152,104,92
Maaa 156,108,92
Maaa 160,112,92
buffer_load_dwordx4 v5, s[8:11], s51 offen offset:3072 lds
Maaa 164,116,92
v_xor_b32 v2, 128, v2
v_xor_b32 v3, 128, v3
Maaa 168,120,92
v_xor_b32 v4, 128, v4
v_xor_b32 v5, 128, v5
Maaa 172,124,92
s_waitcnt lgkmcnt(0)
Mvaa 48,32,0
buffer_load_dword v44, v45, s[16:19], s47 offen
Mvaa 52,36,0
Ta 96,22,16384
Ta 98,22,18432
Mvaa 56,40,0
s_add_u32 s47, s47, 2097152
v_lshrrev_b32 v32, 4, v0
v_and_b32 v33, 15, v0
Mvaa 60,44,0
Ra 64,21,0
Mvaa 64,48,0
s_lshl_b32 s3, s32, 4
v_add_u32 v34, s3, v32
v_lshlrev_b32_e64 v36, 1, v32
Mvaa 68,52,0
Ta 100,23,16384
Ta 102,23,18432
Mvaa 72,56,0
v_xor_b32 v36, v36, v33
v_xor_b32 v37, 8, v36
Mvaa 76,60,0
s_waitcnt lgkmcnt(6)
Ra 68,21,2048
Mvaa 80,32,4
s_getpc_b64 s[6:7]
L_cpf2:
s_add_u32 s6, s6, (L_phase2-L_cpf2)&0xffffffff
s_addc_u32 s7, s7, ((L_phase2-L_cpf2)>>32)&0xffffffff
Mvaa 84,36,4
Ta 104,24,16384
Ta 106,24,18432
Mvaa 88,40,4
s_lshr_b32 s3, s2, 3
s_lshl_b32 s3, s3, 2
s_add_u32 s3, s3, s32
Mvaa 92,44,4
Ra 72,21,4096
Mvaa 96,48,4
s_lshl_b32 s3, s3, 10
v_and_b32 v42, 7, v0
v_lshlrev_b32 v42, 7, v42
Mvaa 100,52,4
Ta 108,25,16384
Ta 110,25,18432
Mvaa 104,56,4
v_add_u32_e64 v42, s3, v42
v_min_u32 v42, L_k2_fin-L_phase2-4, v42
Mvaa 108,60,4
s_waitcnt lgkmcnt(6)
Ra 76,21,6144
Mvaa 112,32,8
v_mov_b32 v41, s7
Mvaa 116,36,8
Ta 112,26,16384
Ta 114,26,18432
Mvaa 120,40,8
v_add_co_u32 v40, vcc, s6, v42
s_nop 1
v_addc_co_u32 v41, vcc, 0, v41, vcc
Mvaa 124,44,8
Ra 80,21,8192
Mvaa 128,48,8
global_load_dword v38, v[40:41], off
Mvaa 132,52,8
Ta 116,27,16384
Ta 118,27,18432
Mvaa 136,56,8
Mvaa 140,60,8
s_waitcnt lgkmcnt(6)
Ra 84,21,10240
Mvaa 144,32,12
Mvaa 148,36,12
Ta 120,28,16384
Ta 122,28,18432
Mvaa 152,40,12
Mvaa 156,44,12
Ra 88,21,12288
Mvaa 160,48,12
Mvaa 164,52,12
Ta 124,29,16384
Ta 126,29,18432
Mvaa 168,56,12
Mvaa 172,60,12
s_waitcnt lgkmcnt(6)
Ra 92,21,14336
Mvaa 176,32,16
Mvaa 180,36,16
Mvaa 184,40,16
Mvaa 188,44,16
Mvaa 192,48,16
Mvaa 196,52,16
Mvaa 200,56,16
Mvaa 204,60,16
Mvaa 208,32,20
Mvaa 212,36,20
Mvaa 216,40,20
Mvaa 220,44,20
Mvaa 224,48,20
Mvaa 228,52,20
Mvaa 232,56,20
Mvaa 236,60,20
Mvaa 240,32,24
Mvaa 244,36,24
Mvaa 248,40,24
Mvaa 252,44,24
Maaa 128,48,24
Maaa 132,52,24
Maaa 136,56,24
Maaa 140,60,24
Maaa 144,32,28
Maaa 148,36,28
Maaa 152,40,28
Maaa 156,44,28
Maaa 160,48,28
Maaa 164,52,28
Maaa 168,56,28
Maaa 172,60,28
s_waitcnt vmcnt(2) lgkmcnt(0)
s_add_u32 m0, s57, 65536
s_barrier
Mvaa 48,96,64
buffer_load_dwordx4 v6, s[12:15], s52 offen offset:0 nt lds
Mvaa 52,100,64
Ta 32,12,0
Ta 34,12,2048
Mvaa 56,104,64
Mvaa 60,108,64
Ra 0,10,0
Mvaa 64,112,64
buffer_load_dwordx4 v7, s[12:15], s53 offen offset:1024 nt lds
Mvaa 68,116,64
s_waitcnt lgkmcnt(6)
Ta 36,13,0
Ta 38,13,2048
Mvaa 72,120,64
Mvaa 76,124,64
Ra 4,10,2048
Mvaa 80,96,68
buffer_load_dwordx4 v6, s[12:15], s54 offen offset:2048 nt lds
Mvaa 84,100,68
Ta 40,14,0
Ta 42,14,2048
Mvaa 88,104,68
Mvaa 92,108,68
Ra 8,10,4096
Mvaa 96,112,68
buffer_load_dwordx4 v7, s[12:15], s55 offen offset:3072 nt lds
Mvaa 100,116,68
s_waitcnt lgkmcnt(6)
Ta 44,15,0
Ta 46,15,2048
Mvaa 104,120,68
Mvaa 108,124,68
s_add_u32 m0, s57, 69632
Ra 12,10,6144
Mvaa 112,96,72
buffer_load_dwordx4 v8, s[12:15], s52 offen offset:0 nt lds
Mvaa 116,100,72
Ta 48,16,0
Ta 50,16,2048
Mvaa 120,104,72
Mvaa 124,108,72
Ra 16,10,8192
Mvaa 128,112,72
buffer_load_dwordx4 v9, s[12:15], s53 offen offset:1024 nt lds
Mvaa 132,116,72
s_waitcnt lgkmcnt(6)
Ta 52,17,0
Ta 54,17,2048
Mvaa 136,120,72
Mvaa 140,124,72
Ra 20,10,10240
Mvaa 144,96,76
buffer_load_dwordx4 v8, s[12:15], s54 offen offset:2048 nt lds
Mvaa 148,100,76
Ta 56,18,0
Ta 58,18,2048
Mvaa 152,104,76
Mvaa 156,108,76
Ra 24,10,12288
Mvaa 160,112,76
buffer_load_dwordx4 v9, s[12:15], s55 offen offset:3072 nt lds
Mvaa 164,116,76
s_waitcnt lgkmcnt(6)
Ta 60,19,0
Ta 62,19,2048
Mvaa 168,120,76
Mvaa 172,124,76
s_add_u32 m0, s56, 65536
Ra 28,10,14336
Mvaa 176,96,80
buffer_load_dwordx4 v2, s[8:11], s48 offen offset:0 lds
Mvaa 180,100,80
Mvaa 184,104,80
Mvaa 188,108,80
Mvaa 192,112,80
buffer_load_dwordx4 v3, s[8:11], s49 offen offset:1024 lds
Mvaa 196,116,80
Mvaa 200,120,80
Mvaa 204,124,80
Mvaa 208,96,84
buffer_load_dwordx4 v2, s[8:11], s50 offen offset:2048 lds
Mvaa 212,100,84
Mvaa 216,104,84
Mvaa 220,108,84
Mvaa 224,112,84
buffer_load_dwordx4 v3, s[8:11], s51 offen offset:3072 lds
Mvaa 228,116,84
Mvaa 232,120,84
Mvaa 236,124,84
s_add_u32 m0, s56, 69632
Mvaa 240,96,88
buffer_load_dwordx4 v4, s[8:11], s48 offen offset:0 lds
Mvaa 244,100,88
Mvaa 248,104,88
Mvaa 252,108,88
Maaa 128,112,88
buffer_load_dwordx4 v5, s[8:11], s49 offen offset:1024 lds
Maaa 132,116,88
Maaa 136,120,88
Maaa 140,124,88
Maaa 144,96,92
buffer_load_dwordx4 v4, s[8:11], s50 offen offset:2048 lds
Maaa 148,100,92
Maaa 152,104,92
Maaa 156,108,92
Maaa 160,112,92
buffer_load_dwordx4 v5, s[8:11], s51 offen offset:3072 lds
Maaa 164,116,92
Maaa 168,120,92
Maaa 172,124,92
s_waitcnt lgkmcnt(0)
Mvaa 48,32,0
buffer_load_dword v30, v31, s[28:31], s37 offen sc1
Mvaa 52,36,0
Ta 96,12,16384
Ta 98,12,18432
Mvaa 56,40,0
s_mov_b32 s8, s16
s_mov_b32 s9, s17
s_mov_b32 s10, s18
Mvaa 60,44,0
Ra 64,11,0
Mvaa 64,48,0
s_add_u32 s16, s66, 46137344
s_addc_u32 s17, s67, 0
s_and_b32 s17, s17, 0xffff
Mvaa 68,52,0
Ta 100,13,16384
Ta 102,13,18432
Mvaa 72,56,0
s_mov_b32 s18, 16777216
s_mov_b32 s19, 0x20000
s_mov_b32 s48, 0
Mvaa 76,60,0
s_waitcnt lgkmcnt(6)
Ra 68,11,2048
Mvaa 80,32,4
s_mov_b32 s49, 31744
s_mov_b32 s50, 63488
s_mov_b32 s51, 95232
Mvaa 84,36,4
Ta 104,14,16384
Ta 106,14,18432
Mvaa 88,40,4
v_lshlrev_b32_e64 v35, 13, v34
v_lshl_add_u32 v8, v36, 4, v35
Mvaa 92,44,4
Ra 72,11,4096
Mvaa 96,48,4
v_lshl_add_u32 v9, v37, 4, v35
v_lshlrev_b32_e64 v2, 4, v0
Mvaa 100,52,4
Ta 108,15,16384
Ta 110,15,18432
Mvaa 104,56,4
v_add_u32 v3, 65536, v2
v_add_u32_e64 v4, s44, v2
Mvaa 108,60,4
s_waitcnt lgkmcnt(6)
Ra 76,11,6144
Mvaa 112,32,8
v_mov_b32 v7, 0
v_lshlrev_b32_e64 v35, 2, v32
Mvaa 116,36,8
Ta 112,16,16384
Ta 114,16,18432
Mvaa 120,40,8
v_sub_u32_e64 v35, v33, v35
Mvaa 124,44,8
Ra 80,11,8192
Mvaa 128,48,8
s_lshl_b32 s3, s32, 4
v_add_u32 v5, s3, v35
Mvaa 132,52,8
Ta 116,17,16384
Ta 118,17,18432
Mvaa 136,56,8
s_sub_u32 s3, 48, s3
v_add_u32 v6, s3, v35
Mvaa 140,60,8
s_waitcnt lgkmcnt(6)
Ra 84,11,10240
Mvaa 144,32,12
s_mul_i32 s3, s33, 1116160
s_add_u32 s3, s3, 8388608
s_add_u32 s12, s66, s3
s_addc_u32 s13, s67, 0
s_and_b32 s13, s13, 0xffff
Mvaa 148,36,12
Ta 120,18,16384
Ta 122,18,18432
Mvaa 152,40,12
s_mov_b32 s14, 0
s_mov_b32 s15, 0x20000
s_mul_i32 s14, s36, 34816
Mvaa 156,44,12
Ra 88,11,12288
Mvaa 160,48,12
buffer_load_dword v44, v45, s[8:11], s47 offen
Mvaa 164,52,12
Ta 124,19,16384
Ta 126,19,18432
Mvaa 168,56,12
s_add_u32 s47, s47, 2097152
Mvaa 172,60,12
s_waitcnt lgkmcnt(6)
Ra 92,11,14336
Mvaa 176,32,16
Mvaa 180,36,16
Mvaa 184,40,16
Mvaa 188,44,16
Mvaa 192,48,16
Mvaa 196,52,16
Mvaa 200,56,16
Mvaa 204,60,16
Mvaa 208,32,20
Mvaa 212,36,20
Mvaa 216,40,20
Mvaa 220,44,20
Mvaa 224,48,20
Mvaa 228,52,20
Mvaa 232,56,20
Mvaa 236,60,20
Mvaa 240,32,24
Mvaa 244,36,24
Mvaa 248,40,24
Mvaa 252,44,24
Maaa 128,48,24
Maaa 132,52,24
Maaa 136,56,24
Maaa 140,60,24
Maaa 144,32,28
Maaa 148,36,28
Maaa 152,40,28
Maaa 156,44,28
Maaa 160,48,28
Maaa 164,52,28
Maaa 168,56,28
Maaa 172,60,28
s_waitcnt vmcnt(2) lgkmcnt(0)
s_add_u32 m0, s44, 0
s_barrier
Mvaa 48,96,64
buffer_load_dwordx4 v8, s[8:11], s48 offen offset:0 lds
Mvaa 52,100,64
Ta 32,22,0
Ta 34,22,2048
Mvaa 56,104,64
s_mul_i32 s3, s45, 33792
v_add_u32_e64 v10, s3, v2
Mvaa 60,108,64
Ra 0,20,0
Mvaa 64,112,64
buffer_load_dwordx4 v8, s[8:11], s49 offen offset:1024 lds
Mvaa 68,116,64
s_waitcnt lgkmcnt(6)
Ta 36,23,0
Ta 38,23,2048
Mvaa 72,120,64
s_mul_i32 s3, s46, 33792
v_add_u32 v11, s3, v2
v_mov_b32_e64 v14, v40
Mvaa 76,124,64
Ra 4,20,2048
Mvaa 80,96,68
buffer_load_dwordx4 v9, s[8:11], s50 offen offset:2048 lds
Mvaa 84,100,68
Ta 40,24,0
Ta 42,24,2048
Mvaa 88,104,68
v_mov_b32_e64 v15, v41
Mvaa 92,108,68
Ra 8,20,4096
Mvaa 96,112,68
buffer_load_dwordx4 v9, s[8:11], s51 offen offset:3072 lds
Mvaa 100,116,68
s_waitcnt lgkmcnt(6)
Ta 44,25,0
Ta 46,25,2048
Mvaa 104,120,68
v_add_u32 v8, 524288, v8
v_add_u32 v9, 524288, v9
Mvaa 108,124,68
s_add_u32 m0, s44, 16384
Ra 12,20,6144
Mvaa 112,96,72
buffer_load_dwordx4 v8, s[8:11], s48 offen offset:0 lds
Mvaa 116,100,72
Ta 48,26,0
Ta 50,26,2048
Mvaa 120,104,72
Mvaa 124,108,72
Ra 16,20,8192
Mvaa 128,112,72
buffer_load_dwordx4 v8, s[8:11], s49 offen offset:1024 lds
Mvaa 132,116,72
s_waitcnt lgkmcnt(6)
Ta 52,27,0
Ta 54,27,2048
Mvaa 136,120,72
Mvaa 140,124,72
Ra 20,20,10240
Mvaa 144,96,76
buffer_load_dwordx4 v9, s[8:11], s50 offen offset:2048 lds
Mvaa 148,100,76
Ta 56,28,0
Ta 58,28,2048
Mvaa 152,104,76
Mvaa 156,108,76
Ra 24,20,12288
Mvaa 160,112,76
buffer_load_dwordx4 v9, s[8:11], s51 offen offset:3072 lds
Mvaa 164,116,76
s_waitcnt lgkmcnt(6)
Ta 60,29,0
Ta 62,29,2048
Mvaa 168,120,76
v_add_u32 v8, 524288, v8
v_add_u32 v9, 524288, v9
Mvaa 172,124,76
s_add_u32 m0, s44, 32768
Ra 28,20,14336
Mvaa 176,96,80
buffer_load_dwordx4 v8, s[8:11], s48 offen offset:0 lds
Mvaa 180,100,80
Mvaa 184,104,80
Mvaa 188,108,80
Mvaa 192,112,80
buffer_load_dwordx4 v8, s[8:11], s49 offen offset:1024 lds
Mvaa 196,116,80
Mvaa 200,120,80
Mvaa 204,124,80
Mvaa 208,96,84
buffer_load_dwordx4 v9, s[8:11], s50 offen offset:2048 lds
Mvaa 212,100,84
Mvaa 216,104,84
Mvaa 220,108,84
Mvaa 224,112,84
buffer_load_dwordx4 v9, s[8:11], s51 offen offset:3072 lds
Mvaa 228,116,84
v_add_u32 v8, 524288, v8
v_add_u32 v9, 524288, v9
Mvaa 232,120,84
Mvaa 236,124,84
s_add_u32 m0, s44, 49152
Mvaa 240,96,88
buffer_load_dwordx4 v8, s[8:11], s48 offen offset:0 lds
Mvaa 244,100,88
Mvaa 248,104,88
Mvaa 252,108,88
Maaa 128,112,88
buffer_load_dwordx4 v8, s[8:11], s49 offen offset:1024 lds
Maaa 132,116,88
Maaa 136,120,88
Maaa 140,124,88
Maaa 144,96,92
buffer_load_dwordx4 v9, s[8:11], s50 offen offset:2048 lds
Maaa 148,100,92
Maaa 152,104,92
Maaa 156,108,92
Maaa 160,112,92
buffer_load_dwordx4 v9, s[8:11], s51 offen offset:3072 lds
Maaa 164,116,92
v_add_u32 v8, 524288, v8
v_add_u32 v9, 524288, v9
Maaa 168,120,92
Maaa 172,124,92
s_waitcnt lgkmcnt(0)
Mvaa 48,32,0
Mvaa 52,36,0
Ta 96,22,16384
Ta 98,22,18432
Mvaa 56,40,0
Mvaa 60,44,0
Ra 64,21,0
Mvaa 64,48,0
Mvaa 68,52,0
Ta 100,23,16384
Ta 102,23,18432
Mvaa 72,56,0
Mvaa 76,60,0
s_waitcnt lgkmcnt(6)
Ra 68,21,2048
Mvaa 80,32,4
Mvaa 84,36,4
Ta 104,24,16384
Ta 106,24,18432
Mvaa 88,40,4
Mvaa 92,44,4
Ra 72,21,4096
Mvaa 96,48,4
Mvaa 100,52,4
Ta 108,25,16384
Ta 110,25,18432
Mvaa 104,56,4
Mvaa 108,60,4
s_waitcnt lgkmcnt(6)
Ra 76,21,6144
Mvaa 112,32,8
Mvaa 116,36,8
Ta 112,26,16384
Ta 114,26,18432
Mvaa 120,40,8
Mvaa 124,44,8
Ra 80,21,8192
Mvaa 128,48,8
Mvaa 132,52,8
Ta 116,27,16384
Ta 118,27,18432
Mvaa 136,56,8
Mvaa 140,60,8
s_waitcnt lgkmcnt(6)
Ra 84,21,10240
Mvaa 144,32,12
Mvaa 148,36,12
Ta 120,28,16384
Ta 122,28,18432
Mvaa 152,40,12
Mvaa 156,44,12
Ra 88,21,12288
Mvaa 160,48,12
Mvaa 164,52,12
Ta 124,29,16384
Ta 126,29,18432
Mvaa 168,56,12
Mvaa 172,60,12
s_waitcnt lgkmcnt(6)
Ra 92,21,14336
Mvaa 176,32,16
Mvaa 180,36,16
Mvaa 184,40,16
Mvaa 188,44,16
Mvaa 192,48,16
Mvaa 196,52,16
Mvaa 200,56,16
Mvaa 204,60,16
Mvaa 208,32,20
Mvaa 212,36,20
Mvaa 216,40,20
Mvaa 220,44,20
Mvaa 224,48,20
Mvaa 228,52,20
Mvaa 232,56,20
Mvaa 236,60,20
Mvaa 240,32,24
Mvaa 244,36,24
Mvaa 248,40,24
Mvaa 252,44,24
Maaa 128,48,24
Maaa 132,52,24
Maaa 136,56,24
Maaa 140,60,24
Maaa 144,32,28
Maaa 148,36,28
Maaa 152,40,28
Maaa 156,44,28
Maaa 160,48,28
Maaa 164,52,28
Maaa 168,56,28
Maaa 172,60,28
s_waitcnt vmcnt(12) lgkmcnt(0)
v_readfirstlane_b32 s3, v30
s_nop 0
s_or_b32 s3, s3, s37
s_cmp_lt_u32 s3, 256
s_cbranch_scc1 L_spinAk
L_spinArk:
s_barrier
Mvaa 48,96,64
buffer_load_dwordx4 a[0:3], v10, s[20:23], s58 offen offset:0 sc1
Mvaa 52,100,64
v_lshrrev_b32_e64 v42, 2, v33
v_lshl_add_u32 v43, v32, 3, v42
Mvaa 56,104,64
v_lshlrev_b32 v43, 8, v43
v_and_b32 v44, 3, v0
Mvaa 60,108,64
v_lshl_add_u32 v43, v44, 3, v43
v_and_b32_e64 v44, 1, v32
Mvaa 64,112,64
buffer_load_dwordx4 a[4:7], v10, s[20:23], 0 offen offset:0 sc1
Mvaa 68,116,64
v_lshl_add_u32 v42, v44, 2, v42
v_xor_b32_e64 v44, 0, v42
Mvaa 72,120,64
v_lshl_add_u32 v16, v44, 5, v43
v_xor_b32_e64 v44, 1, v42
Mvaa 76,124,64
v_lshl_add_u32 v17, v44, 5, v43
v_xor_b32_e64 v44, 2, v42
Mvaa 80,96,68
buffer_load_dwordx4 a[8:11], v11, s[20:23], s58 offen offset:0 sc1
Mvaa 84,100,68
v_lshl_add_u32 v18, v44, 5, v43
v_xor_b32_e64 v44, 3, v42
Mvaa 88,104,68
v_lshl_add_u32 v19, v44, 5, v43
v_xor_b32_e64 v44, 4, v42
Mvaa 92,108,68
v_lshl_add_u32 v20, v44, 5, v43
v_xor_b32_e64 v44, 5, v42
Mvaa 96,112,68
buffer_load_dwordx4 a[12:15], v11, s[20:23], 0 offen offset:0 sc1
Mvaa 100,116,68
v_lshl_add_u32 v21, v44, 5, v43
v_xor_b32_e64 v44, 6, v42
Mvaa 104,120,68
v_lshl_add_u32 v22, v44, 5, v43
v_xor_b32_e64 v44, 7, v42
Mvaa 108,124,68
v_lshl_add_u32 v23, v44, 5, v43
Mvaa 112,96,72
buffer_load_dwordx4 a[16:19], v10, s[20:23], s58 offen offset:1024 sc1
Mvaa 116,100,72
Mvaa 120,104,72
Mvaa 124,108,72
Mvaa 128,112,72
buffer_load_dwordx4 a[20:23], v10, s[20:23], 0 offen offset:1024 sc1
Mvaa 132,116,72
Ta 192,16,0
Ta 194,16,1024
Mvaa 136,120,72
Ta 196,17,0
Ta 198,17,1024
Mvaa 140,124,72
Ta 200,18,0
Ta 202,18,1024
Mvaa 144,96,76
buffer_load_dwordx4 a[24:27], v11, s[20:23], s58 offen offset:1024 sc1
Mvaa 148,100,76
Ta 204,19,0
Ta 206,19,1024
Mvaa 152,104,76
Ta 208,20,0
Ta 210,20,1024
Mvaa 156,108,76
Ta 212,21,0
Ta 214,21,1024
Mvaa 160,112,76
buffer_load_dwordx4 a[28:31], v11, s[20:23], 0 offen offset:1024 sc1
Mvaa 164,116,76
Ta 216,22,0
Ta 218,22,1024
Mvaa 168,120,76
Ta 220,23,0
s_waitcnt lgkmcnt(9)
Ta 222,23,1024
Mvaa 172,124,76
s_waitcnt lgkmcnt(8)
Vc 24,48,49
Vc 25,50,51
Mvaa 176,96,80
buffer_load_dwordx4 a[32:35], v10, s[20:23], s58 offen offset:2048 sc1
Mvaa 180,100,80
Vc 26,52,53
Vc 27,54,55
Mvaa 184,104,80
Vc 28,56,57
Vc 29,58,59
Mvaa 188,108,80
Vc 30,60,61
Vc 31,62,63
Mvaa 192,112,80
buffer_load_dwordx4 a[36:39], v10, s[20:23], 0 offen offset:2048 sc1
Mvaa 196,116,80
Vc 32,64,65
Vc 33,66,67
Mvaa 200,120,80
Vc 34,68,69
Vc 35,70,71
Mvaa 204,124,80
Vc 36,72,73
Vc 37,74,75
Mvaa 208,96,84
buffer_load_dwordx4 a[40:43], v11, s[20:23], s58 offen offset:2048 sc1
Mvaa 212,100,84
Vc 38,76,77
Vc 39,78,79
Mvaa 216,104,84
Vc 40,80,81
Vc 41,82,83
Mvaa 220,108,84
Vc 42,84,85
Vc 43,86,87
Mvaa 224,112,84
buffer_load_dwordx4 a[44:47], v11, s[20:23], 0 offen offset:2048 sc1
Mvaa 228,116,84
Vc 44,88,89
Vc 45,90,91
Mvaa 232,120,84
Vc 46,92,93
Vc 47,94,95
Mvaa 236,124,84
Vc 48,96,97
Vc 49,98,99
Mvaa 240,96,88
buffer_load_dwordx4 a[48:51], v10, s[20:23], s58 offen offset:3072 sc1
Mvaa 244,100,88
Vc 50,100,101
Vc 51,102,103
Mvaa 248,104,88
Vc 52,104,105
Vc 53,106,107
Mvaa 252,108,88
Vc 54,108,109
Vc 55,110,111
Maaa 128,112,88
buffer_load_dwordx4 a[52:55], v10, s[20:23], 0 offen offset:3072 sc1
Maaa 132,116,88
Vc 56,112,113
Vc 57,114,115
Maaa 136,120,88
Vc 58,116,117
Vc 59,118,119
Maaa 140,124,88
Vc 60,120,121
Vc 61,122,123
Maaa 144,96,92
buffer_load_dwordx4 a[56:59], v11, s[20:23], s58 offen offset:3072 sc1
Maaa 148,100,92
Vc 62,124,125
Vc 63,126,127
Maaa 152,104,92
Vc 64,128,129
Vc 65,130,131
Maaa 156,108,92
Vc 66,132,133
Vc 67,134,135
Maaa 160,112,92
buffer_load_dwordx4 a[60:63], v11, s[20:23], 0 offen offset:3072 sc1
Maaa 164,116,92
v_add_u32 v10, 4096, v10
v_add_u32 v11, 4096, v11
Maaa 168,120,92
Vc 68,136,137
Vc 69,138,139
Maaa 172,124,92
Vc 70,140,141
Vc 71,142,143
Vc 72,144,145
Vc 73,146,147
Vc 74,148,149
Vc 75,150,151
Vc 76,152,153
Vc 77,154,155
Vc 78,156,157
Vc 79,158,159
Vc 80,160,161
Vc 81,162,163
Vc 82,164,165
Vc 83,166,167
Vc 84,168,169
Vc 85,170,171
Vc 86,172,173
Vc 87,174,175
Vc 88,176,177
Vc 89,178,179
Vc 90,180,181
Vc 91,182,183
Vc 92,184,185
Vc 93,186,187
Vc 94,188,189
Vc 95,190,191
Vc 96,192,193
Vc 97,194,195
Vc 98,196,197
Vc 99,198,199
Vc 100,200,201
Vc 101,202,203
Vc 102,204,205
Vc 103,206,207
Vc 104,208,209
Vc 105,210,211
Vc 106,212,213
Vc 107,214,215
Vc 108,216,217
Vc 109,218,219
Vc 110,220,221
Vc 111,222,223
Vc 112,224,225
Vc 113,226,227
Vc 114,228,229
Vc 115,230,231
Vc 116,232,233
Vc 117,234,235
Vc 118,236,237
Vc 119,238,239
Vc 120,240,241
Vc 121,242,243
Vc 122,244,245
Vc 123,246,247
Vc 124,248,249
Vc 125,250,251
Vc 126,252,253
Vc 127,254,255
s_branch L_phase2
L_k1_vpath:
s_waitcnt lgkmcnt(0)
s_add_u32 m0, s57, 65536
Zvaa 48,0,32
buffer_load_dwordx4 v6, s[12:15], s52 offen offset:0 nt lds
Zvaa 64,0,36
Ta 96,12,16384
Ta 98,12,18432
Zvaa 80,0,40
buffer_load_dwordx4 v7, s[12:15], s53 offen offset:1024 nt lds
Zvaa 96,0,44
Ra 64,11,0
Zvaa 112,0,48
buffer_load_dwordx4 v6, s[12:15], s54 offen offset:2048 nt lds
Zvaa 128,0,52
Ta 100,13,16384
Ta 102,13,18432
Zvaa 144,0,56
buffer_load_dwordx4 v7, s[12:15], s55 offen offset:3072 nt lds
Zvaa 160,0,60
s_add_u32 m0, s57, 69632
s_waitcnt lgkmcnt(6)
Ra 68,11,2048
Zvaa 52,4,32
buffer_load_dwordx4 v8, s[12:15], s52 offen offset:0 nt lds
Zvaa 68,4,36
Ta 104,14,16384
Ta 106,14,18432
Zvaa 84,4,40
buffer_load_dwordx4 v9, s[12:15], s53 offen offset:1024 nt lds
Zvaa 100,4,44
Ra 72,11,4096
Zvaa 116,4,48
buffer_load_dwordx4 v8, s[12:15], s54 offen offset:2048 nt lds
Zvaa 132,4,52
Ta 108,15,16384
Ta 110,15,18432
Zvaa 148,4,56
buffer_load_dwordx4 v9, s[12:15], s55 offen offset:3072 nt lds
Zvaa 164,4,60
s_add_u32 m0, s56, 65536
s_waitcnt lgkmcnt(6)
Ra 76,11,6144
Zvaa 56,8,32
buffer_load_dwordx4 v2, s[8:11], s48 offen offset:0 lds
Zvaa 72,8,36
Ta 112,16,16384
Ta 114,16,18432
Zvaa 88,8,40
buffer_load_dwordx4 v3, s[8:11], s49 offen offset:1024 lds
Zvaa 104,8,44
Ra 80,11,8192
v_xor_b32 v6, 1572864, v6
Zvaa 120,8,48
buffer_load_dwordx4 v2, s[8:11], s50 offen offset:2048 lds
Zvaa 136,8,52
Ta 116,17,16384
Ta 118,17,18432
Zvaa 152,8,56
buffer_load_dwordx4 v3, s[8:11], s51 offen offset:3072 lds
Zvaa 168,8,60
s_add_u32 m0, s56, 69632
s_waitcnt lgkmcnt(6)
Ra 84,11,10240
Zvaa 60,12,32
buffer_load_dwordx4 v4, s[8:11], s48 offen offset:0 lds
Zvaa 76,12,36
Ta 120,18,16384
Ta 122,18,18432
Zvaa 92,12,40
buffer_load_dwordx4 v5, s[8:11], s49 offen offset:1024 lds
Zvaa 108,12,44
Ra 88,11,12288
v_xor_b32 v7, 1572864, v7
Zvaa 124,12,48
buffer_load_dwordx4 v4, s[8:11], s50 offen offset:2048 lds
Zvaa 140,12,52
Ta 124,19,16384
Ta 126,19,18432
Zvaa 156,12,56
buffer_load_dwordx4 v5, s[8:11], s51 offen offset:3072 lds
Zvaa 172,12,60
s_waitcnt lgkmcnt(6)
Ra 92,11,14336
Zvaa 176,16,32
v_and_b32_e64 v46, 7, v0
v_mul_u32_u24 v30, 2064, v46
Zvaa 192,16,36
v_xor_b32 v8, 1572864, v8
v_xor_b32 v9, 1572864, v9
Zvaa 208,16,40
v_lshrrev_b32_e64 v31, 3, v0
Zvaa 224,16,44
v_xor_b32 v2, 384, v2
v_xor_b32 v3, 384, v3
Zvaa 240,16,48
s_lshl_b32 s3, s32, 9
s_add_u32 s3, s3, 131072
v_lshl_add_u32 v30, v31, 4, v30
Zaaa 128,16,52
v_xor_b32 v4, 384, v4
v_xor_b32 v5, 384, v5
Zaaa 144,16,56
v_add_u32 v30, s3, v30
v_lshlrev_b32_e64 v31, 8, v31
Zaaa 160,16,60
v_lshl_add_u32 v46, v46, 4, v31
Zvaa 180,20,32
buffer_load_dword v1, v47, s[60:63], 0 offen
Zvaa 196,20,36
s_mul_i32 vcc_lo, s59, 7
v_xor_b32 v47, vcc_lo, v47
Zvaa 212,20,40
Rv 34,30,128
Rv 38,30,256
Zvaa 228,20,44
Rv 42,30,384
Rv 30,30,0
Zvaa 244,20,48
buffer_load_dword v1, v47, s[60:63], 0 offen
Zaaa 132,20,52
s_mul_i32 vcc_lo, s59, 1
v_xor_b32 v47, vcc_lo, v47
Zaaa 148,20,56
s_lshr_b32 s3, s2, 1
s_mul_i32 s3, s3, 33792
s_add_u32 s3, s3, s56
Zaaa 164,20,60
s_and_b32 s39, s2, 1
s_lshl_b32 s39, s39, 7
s_add_u32 s3, s3, s39
Zvaa 184,24,32
s_add_u32 s39, s3, 4096
Zvaa 200,24,36
Zvaa 216,24,40
Zvaa 232,24,44
Zvaa 248,24,48
Zaaa 136,24,52
Zaaa 152,24,56
Zaaa 168,24,60
Zvaa 188,28,32
Zvaa 204,28,36
Zvaa 220,28,40
Zvaa 236,28,44
Zvaa 252,28,48
Zaaa 140,28,52
Zaaa 156,28,56
Zaaa 172,28,60
s_waitcnt vmcnt(2) lgkmcnt(0)
s_add_u32 m0, s57, 0
s_barrier
Mvaa 48,64,96
buffer_load_dwordx4 v6, s[12:15], s52 offen offset:0 nt lds
Mvaa 64,64,100
Ta 32,22,0
Ta 34,22,2048
Mvaa 80,64,104
Mvaa 96,64,108
Ra 0,20,0
Mvaa 112,64,112
buffer_load_dwordx4 v7, s[12:15], s53 offen offset:1024 nt lds
Mvaa 128,64,116
s_waitcnt lgkmcnt(6)
Ta 36,23,0
Ta 38,23,2048
Mvaa 144,64,120
Mvaa 160,64,124
Ra 4,20,2048
Mvaa 52,68,96
buffer_load_dwordx4 v6, s[12:15], s54 offen offset:2048 nt lds
Mvaa 68,68,100
Ta 40,24,0
Ta 42,24,2048
Mvaa 84,68,104
Mvaa 100,68,108
Ra 8,20,4096
Mvaa 116,68,112
buffer_load_dwordx4 v7, s[12:15], s55 offen offset:3072 nt lds
Mvaa 132,68,116
s_waitcnt lgkmcnt(6)
Ta 44,25,0
Ta 46,25,2048
Mvaa 148,68,120
Mvaa 164,68,124
s_add_u32 m0, s57, 4096
Ra 12,20,6144
Mvaa 56,72,96
buffer_load_dwordx4 v8, s[12:15], s52 offen offset:0 nt lds
Mvaa 72,72,100
Ta 48,26,0
Ta 50,26,2048
Mvaa 88,72,104
Mvaa 104,72,108
Ra 16,20,8192
Mvaa 120,72,112
buffer_load_dwordx4 v9, s[12:15], s53 offen offset:1024 nt lds
Mvaa 136,72,116
s_waitcnt lgkmcnt(6)
Ta 52,27,0
Ta 54,27,2048
Mvaa 152,72,120
Mvaa 168,72,124
Ra 20,20,10240
Mvaa 60,76,96
buffer_load_dwordx4 v8, s[12:15], s54 offen offset:2048 nt lds
Mvaa 76,76,100
Ta 56,28,0
Ta 58,28,2048
Mvaa 92,76,104
Mvaa 108,76,108
Ra 24,20,12288
Mvaa 124,76,112
buffer_load_dwordx4 v9, s[12:15], s55 offen offset:3072 nt lds
Mvaa 140,76,116
s_waitcnt lgkmcnt(6)
Ta 60,29,0
Ta 62,29,2048
Mvaa 156,76,120
v_xor_b32 v6, 524288, v6
v_xor_b32 v7, 524288, v7
Mvaa 172,76,124
s_add_u32 m0, s56, 0
Ra 28,20,14336
v_xor_b32 v8, 524288, v8
Mvaa 176,80,96
buffer_load_dwordx4 v2, s[8:11], s48 offen offset:0 lds
Mvaa 192,80,100
v_xor_b32 v9, 524288, v9
Mvaa 208,80,104
Mvaa 224,80,108
Mvaa 240,80,112
buffer_load_dwordx4 v3, s[8:11], s49 offen offset:1024 lds
Maaa 128,80,116
Maaa 144,80,120
Maaa 160,80,124
Mvaa 180,84,96
buffer_load_dwordx4 v2, s[8:11], s50 offen offset:2048 lds
Mvaa 196,84,100
Mvaa 212,84,104
Mvaa 228,84,108
Mvaa 244,84,112
buffer_load_dwordx4 v3, s[8:11], s51 offen offset:3072 lds
Maaa 132,84,116
Maaa 148,84,120
Maaa 164,84,124
s_add_u32 m0, s56, 4096
Mvaa 184,88,96
buffer_load_dwordx4 v4, s[8:11], s48 offen offset:0 lds
Mvaa 200,88,100
Mvaa 216,88,104
Mvaa 232,88,108
Mvaa 248,88,112
buffer_load_dwordx4 v5, s[8:11], s49 offen offset:1024 lds
Maaa 136,88,116
Maaa 152,88,120
Maaa 168,88,124
Mvaa 188,92,96
buffer_load_dwordx4 v4, s[8:11], s50 offen offset:2048 lds
Mvaa 204,92,100
Mvaa 220,92,104
Mvaa 236,92,108
Mvaa 252,92,112
buffer_load_dwordx4 v5, s[8:11], s51 offen offset:3072 lds
Maaa 140,92,116
v_xor_b32 v2, 128, v2
v_xor_b32 v3, 128, v3
Maaa 156,92,120
buffer_load_dword v1, v47, s[60:63], 0 offen
v_xor_b32 v4, 128, v4
v_xor_b32 v5, 128, v5
Maaa 172,92,124
s_mul_i32 vcc_lo, s59, 3
v_xor_b32 v47, vcc_lo, v47
s_waitcnt lgkmcnt(0)
Mvaa 48,0,32
buffer_store_dwordx4 v[30:33], v46, s[20:23], s3 offen offset:0 sc1
Mvaa 64,0,36
Ta 96,22,16384
Ta 98,22,18432
Mvaa 80,0,40
buffer_store_dwordx4 v[34:37], v46, s[20:23], s3 offen offset:2048 sc1
Mvaa 96,0,44
Ra 64,21,0
Mvaa 112,0,48
buffer_store_dwordx4 v[38:41], v46, s[20:23], s39 offen offset:0 sc1
Mvaa 128,0,52
Ta 100,23,16384
Ta 102,23,18432
Mvaa 144,0,56
buffer_store_dwordx4 v[42:45], v46, s[20:23], s39 offen offset:2048 sc1
Mvaa 160,0,60
s_waitcnt lgkmcnt(6)
Ra 68,21,2048
Mvaa 52,4,32
s_lshl_b32 s3, s34, 1
s_and_b32 s36, s32, 1
s_add_u32 s3, s3, s36
Mvaa 68,4,36
Ta 104,24,16384
Ta 106,24,18432
Mvaa 84,4,40
s_mul_i32 s3, s3, 1116160
s_mul_i32 s36, s33, 139264
s_add_u32 s3, s3, s36
Mvaa 100,4,44
Ra 72,21,4096
Mvaa 116,4,48
s_lshr_b32 s36, s32, 1
s_mul_i32 s36, s36, 69632
s_add_u32 s3, s3, s36
Mvaa 132,4,52
Ta 108,25,16384
Ta 110,25,18432
Mvaa 148,4,56
s_add_u32 s38, s3, 17408
s_lshl_b32 s39, s34, 7
s_lshl_b32 s36, s33, 2
Mvaa 164,4,60
s_waitcnt lgkmcnt(6)
Ra 76,21,6144
Mvaa 56,8,32
s_add_u32 s39, s39, s36
s_add_u32 s39, s39, 5296160
v_mov_b32 v30, 1
Mvaa 72,8,36
Ta 112,26,16384
Ta 114,26,18432
Mvaa 88,8,40
v_mov_b32_e64 v31, 0
Mvaa 104,8,44
Ra 80,21,8192
Mvaa 120,8,48
s_cmp_eq_u32 s32, 0
s_cselect_b32 s39, s39, 2146435072
Mvaa 136,8,52
Ta 116,27,16384
Ta 118,27,18432
Mvaa 152,8,56
s_mov_b64 exec, 1
buffer_store_dword v31, v31, s[20:23], s39 offen sc1
s_mov_b64 exec, -1
Mvaa 168,8,60
s_waitcnt lgkmcnt(6)
Ra 84,21,10240
Mvaa 60,12,32
s_and_b32 s33, s2, 7
s_lshl_b32 s33, s33, 2
s_bfe_u32 s3, s2, 0x20003
Mvaa 76,12,36
Ta 120,28,16384
Ta 122,28,18432
Mvaa 92,12,40
s_add_u32 s33, s33, s3
s_lshr_b32 s34, s2, 5
s_lshl_b32 s64, s34, 7
Mvaa 108,12,44
Ra 88,21,12288
Mvaa 124,12,48
s_lshl_b32 s3, s33, 2
s_add_u32 s64, s64, s3
s_add_u32 s64, s64, 5300224
Mvaa 140,12,52
Ta 124,29,16384
Ta 126,29,18432
Mvaa 156,12,56
s_lshl_b32 s65, s34, 8
s_sub_u32 s65, 1920, s65
v_mul_u32_u24_e64 v32, s65, v0
Mvaa 172,12,60
s_waitcnt lgkmcnt(6)
Ra 92,21,14336
Mvaa 176,16,32
s_cmp_eq_u32 s32, 0
s_cselect_b32 s64, s64, 2146435072
Mvaa 192,16,36
s_mov_b64 exec, 3
buffer_store_dword v31, v32, s[20:23], s64 offen sc1
s_mov_b64 exec, -1
Mvaa 208,16,40
s_lshl_b32 s3, s2, 2
s_add_u32 s3, s3, 5447680
v_lshlrev_b32 v32, 10, v0
Mvaa 224,16,44
s_cmp_eq_u32 s32, 0
s_cselect_b32 s3, s3, 2146435072
Mvaa 240,16,48
s_mov_b64 exec, 0x1ff
buffer_store_dword v31, v32, s[20:23], s3 offen sc1
s_mov_b64 exec, -1
Maaa 128,16,52
s_lshl_b32 s35, s34, 1
s_sub_u32 s36, 32, s35
s_add_u32 s35, s35, 2
Maaa 144,16,56
s_lshl_b32 s44, s32, 12
s_lshl_b32 s58, s32, 1
s_sub_u32 s58, 7, s58
Maaa 160,16,60
s_mul_i32 s58, s58, 33792
s_sub_u32 s3, 15, s34
s_lshl_b32 s45, s3, 3
Mvaa 180,20,32
s_add_u32 s45, s45, s32
s_lshl_b32 s46, s34, 3
s_add_u32 s46, s46, s32
Mvaa 196,20,36
s_mov_b32 s68, s42
s_and_b32 s69, s43, 0xffff
s_mov_b32 s70, 7340032
Mvaa 212,20,40
s_mov_b32 s71, 0x20000
s_cmp_eq_u32 s32, 0
s_cselect_b32 s37, 0, 2146435072
Mvaa 228,20,44
s_lshl_b32 s3, s33, 8
s_add_u32 s16, s4, s3
s_addc_u32 s17, s5, 0
s_and_b32 s17, s17, 0xffff
Mvaa 244,20,48
s_mov_b32 s18, 0
s_mov_b32 s19, 0x20000
s_sub_u32 s18, 8388608, s3
Maaa 132,20,52
v_and_b32 v33, 15, v0
v_lshrrev_b32_e64 v32, 1, v33
Maaa 148,20,56
v_and_b32 v33, 1, v0
v_lshlrev_b32 v32, 13, v32
Maaa 164,20,60
v_lshl_add_u32 v45, v33, 7, v32
Mvaa 184,24,32
s_lshl_b32 s3, s32, 3
s_add_u32 s3, s3, s34
s_mul_i32 s47, s3, 65536
Mvaa 200,24,36
s_bfe_u32 s6, s2, 131075
s_lshl_b32 s3, s32, 8
s_or_b32 s6, s6, s3
Mvaa 216,24,40
Mvaa 232,24,44
Mvaa 248,24,48
Maaa 136,24,52
Maaa 152,24,56
Maaa 168,24,60
Mvaa 188,28,32
Mvaa 204,28,36
Mvaa 220,28,40
Mvaa 236,28,44
Mvaa 252,28,48
Maaa 140,28,52
Maaa 156,28,56
Maaa 172,28,60
s_waitcnt vmcnt(8) lgkmcnt(0)
s_add_u32 m0, s57, 65536
s_barrier
Mvaa 48,64,96
buffer_load_dwordx4 v6, s[12:15], s52 offen offset:0 nt lds
Mvaa 64,64,100
Ta 32,12,0
Ta 34,12,2048
Mvaa 80,64,104
Mvaa 96,64,108
Ra 0,10,0
Mvaa 112,64,112
buffer_load_dwordx4 v7, s[12:15], s53 offen offset:1024 nt lds
Mvaa 128,64,116
s_waitcnt lgkmcnt(6)
Ta 36,13,0
Ta 38,13,2048
Mvaa 144,64,120
Mvaa 160,64,124
Ra 4,10,2048
Mvaa 52,68,96
buffer_load_dwordx4 v6, s[12:15], s54 offen offset:2048 nt lds
Mvaa 68,68,100
Ta 40,14,0
Ta 42,14,2048
Mvaa 84,68,104
Mvaa 100,68,108
Ra 8,10,4096
Mvaa 116,68,112
buffer_load_dwordx4 v7, s[12:15], s55 offen offset:3072 nt lds
Mvaa 132,68,116
s_waitcnt lgkmcnt(6)
Ta 44,15,0
Ta 46,15,2048
Mvaa 148,68,120
Mvaa 164,68,124
s_add_u32 m0, s57, 69632
Ra 12,10,6144
Mvaa 56,72,96
buffer_load_dwordx4 v8, s[12:15], s52 offen offset:0 nt lds
Mvaa 72,72,100
Ta 48,16,0
Ta 50,16,2048
Mvaa 88,72,104
Mvaa 104,72,108
Ra 16,10,8192
Mvaa 120,72,112
buffer_load_dwordx4 v9, s[12:15], s53 offen offset:1024 nt lds
Mvaa 136,72,116
s_waitcnt lgkmcnt(6)
Ta 52,17,0
Ta 54,17,2048
Mvaa 152,72,120
Mvaa 168,72,124
Ra 20,10,10240
Mvaa 60,76,96
buffer_load_dwordx4 v8, s[12:15], s54 offen offset:2048 nt lds
Mvaa 76,76,100
Ta 56,18,0
Ta 58,18,2048
Mvaa 92,76,104
Mvaa 108,76,108
Ra 24,10,12288
Mvaa 124,76,112
buffer_load_dwordx4 v9, s[12:15], s55 offen offset:3072 nt lds
Mvaa 140,76,116
s_waitcnt lgkmcnt(6)
Ta 60,19,0
Ta 62,19,2048
Mvaa 156,76,120
v_xor_b32 v6, 3670016, v6
v_xor_b32 v7, 3670016, v7
Mvaa 172,76,124
s_add_u32 m0, s56, 65536
Ra 28,10,14336
v_xor_b32 v8, 3670016, v8
Mvaa 176,80,96
buffer_load_dwordx4 v2, s[8:11], s48 offen offset:0 lds
Mvaa 192,80,100
v_xor_b32 v9, 3670016, v9
Mvaa 208,80,104
Mvaa 224,80,108
Mvaa 240,80,112
buffer_load_dwordx4 v3, s[8:11], s49 offen offset:1024 lds
Maaa 128,80,116
Maaa 144,80,120
Maaa 160,80,124
Mvaa 180,84,96
buffer_load_dwordx4 v2, s[8:11], s50 offen offset:2048 lds
Mvaa 196,84,100
Mvaa 212,84,104
Mvaa 228,84,108
Mvaa 244,84,112
buffer_load_dwordx4 v3, s[8:11], s51 offen offset:3072 lds
Maaa 132,84,116
Maaa 148,84,120
Maaa 164,84,124
s_add_u32 m0, s56, 69632
Mvaa 184,88,96
buffer_load_dwordx4 v4, s[8:11], s48 offen offset:0 lds
Mvaa 200,88,100
Mvaa 216,88,104
Mvaa 232,88,108
Mvaa 248,88,112
buffer_load_dwordx4 v5, s[8:11], s49 offen offset:1024 lds
Maaa 136,88,116
Maaa 152,88,120
Maaa 168,88,124
Mvaa 188,92,96
buffer_load_dwordx4 v4, s[8:11], s50 offen offset:2048 lds
Mvaa 204,92,100
Mvaa 220,92,104
Mvaa 236,92,108
Mvaa 252,92,112
buffer_load_dwordx4 v5, s[8:11], s51 offen offset:3072 lds
Maaa 140,92,116
v_xor_b32 v2, 896, v2
v_xor_b32 v3, 896, v3
Maaa 156,92,120
buffer_load_dword v1, v47, s[60:63], 0 offen
v_xor_b32 v4, 896, v4
v_xor_b32 v5, 896, v5
Maaa 172,92,124
s_mul_i32 vcc_lo, s59, 1
v_xor_b32 v47, vcc_lo, v47
s_waitcnt lgkmcnt(0)
Mvaa 48,0,32
Mvaa 64,0,36
Ta 96,12,16384
Ta 98,12,18432
Mvaa 80,0,40
Mvaa 96,0,44
Ra 64,11,0
Mvaa 112,0,48
Mvaa 128,0,52
Ta 100,13,16384
Ta 102,13,18432
Mvaa 144,0,56
Mvaa 160,0,60
s_waitcnt lgkmcnt(6)
Ra 68,11,2048
Mvaa 52,4,32
Mvaa 68,4,36
Ta 104,14,16384
Ta 106,14,18432
Mvaa 84,4,40
Mvaa 100,4,44
Ra 72,11,4096
Mvaa 116,4,48
Mvaa 132,4,52
Ta 108,15,16384
Ta 110,15,18432
Mvaa 148,4,56
Mvaa 164,4,60
s_waitcnt lgkmcnt(6)
Ra 76,11,6144
Mvaa 56,8,32
Mvaa 72,8,36
Ta 112,16,16384
Ta 114,16,18432
Mvaa 88,8,40
Mvaa 104,8,44
Ra 80,11,8192
Mvaa 120,8,48
Mvaa 136,8,52
Ta 116,17,16384
Ta 118,17,18432
Mvaa 152,8,56
Mvaa 168,8,60
s_waitcnt lgkmcnt(6)
Ra 84,11,10240
Mvaa 60,12,32
Mvaa 76,12,36
Ta 120,18,16384
Ta 122,18,18432
Mvaa 92,12,40
Mvaa 108,12,44
Ra 88,11,12288
Mvaa 124,12,48
Mvaa 140,12,52
Ta 124,19,16384
Ta 126,19,18432
Mvaa 156,12,56
Mvaa 172,12,60
s_waitcnt lgkmcnt(6)
Ra 92,11,14336
Mvaa 176,16,32
Mvaa 192,16,36
Mvaa 208,16,40
Mvaa 224,16,44
Mvaa 240,16,48
Maaa 128,16,52
Maaa 144,16,56
Maaa 160,16,60
Mvaa 180,20,32
Mvaa 196,20,36
Mvaa 212,20,40
Mvaa 228,20,44
Mvaa 244,20,48
Maaa 132,20,52
Maaa 148,20,56
Maaa 164,20,60
Mvaa 184,24,32
Mvaa 200,24,36
Mvaa 216,24,40
Mvaa 232,24,44
Mvaa 248,24,48
Maaa 136,24,52
Maaa 152,24,56
Maaa 168,24,60
Mvaa 188,28,32
Mvaa 204,28,36
Mvaa 220,28,40
Mvaa 236,28,44
Mvaa 252,28,48
Maaa 140,28,52
Maaa 156,28,56
Maaa 172,28,60
s_waitcnt vmcnt(1) lgkmcnt(0)
s_add_u32 m0, s57, 0
s_barrier
Mvaa 48,64,96
buffer_load_dwordx4 v6, s[12:15], s52 offen offset:0 nt lds
Mvaa 64,64,100
Ta 32,22,0
Ta 34,22,2048
Mvaa 80,64,104
Mvaa 96,64,108
Ra 0,20,0
Mvaa 112,64,112
buffer_load_dwordx4 v7, s[12:15], s53 offen offset:1024 nt lds
Mvaa 128,64,116
s_waitcnt lgkmcnt(6)
Ta 36,23,0
Ta 38,23,2048
Mvaa 144,64,120
Mvaa 160,64,124
Ra 4,20,2048
Mvaa 52,68,96
buffer_load_dwordx4 v6, s[12:15], s54 offen offset:2048 nt lds
Mvaa 68,68,100
Ta 40,24,0
Ta 42,24,2048
Mvaa 84,68,104
Mvaa 100,68,108
Ra 8,20,4096
Mvaa 116,68,112
buffer_load_dwordx4 v7, s[12:15], s55 offen offset:3072 nt lds
Mvaa 132,68,116
s_waitcnt lgkmcnt(6)
Ta 44,25,0
Ta 46,25,2048
Mvaa 148,68,120
s_cmp_eq_u32 s6, 0
s_cselect_b32 s3, 0, 2146435072
Mvaa 164,68,124
s_add_u32 m0, s57, 4096
Ra 12,20,6144
Mvaa 56,72,96
buffer_load_dwordx4 v8, s[12:15], s52 offen offset:0 nt lds
Mvaa 72,72,100
Ta 48,26,0
Ta 50,26,2048
Mvaa 88,72,104
s_mov_b64 exec, 1
buffer_atomic_add v30, v31, s[28:31], s3 offen sc1
s_mov_b64 exec, -1
Mvaa 104,72,108
Ra 16,20,8192
Mvaa 120,72,112
buffer_load_dwordx4 v9, s[12:15], s53 offen offset:1024 nt lds
Mvaa 136,72,116
s_waitcnt lgkmcnt(6)
Ta 52,27,0
Ta 54,27,2048
Mvaa 152,72,120
Mvaa 168,72,124
Ra 20,20,10240
Mvaa 60,76,96
buffer_load_dwordx4 v8, s[12:15], s54 offen offset:2048 nt lds
Mvaa 76,76,100
Ta 56,28,0
Ta 58,28,2048
Mvaa 92,76,104
Mvaa 108,76,108
Ra 24,20,12288
Mvaa 124,76,112
buffer_load_dwordx4 v9, s[12:15], s55 offen offset:3072 nt lds
Mvaa 140,76,116
s_waitcnt lgkmcnt(6)
Ta 60,29,0
Ta 62,29,2048
Mvaa 156,76,120
v_xor_b32 v6, 524288, v6
v_xor_b32 v7, 524288, v7
Mvaa 172,76,124
s_add_u32 m0, s56, 0
Ra 28,20,14336
v_xor_b32 v8, 524288, v8
Mvaa 176,80,96
buffer_load_dwordx4 v2, s[8:11], s48 offen offset:0 lds
Mvaa 192,80,100
v_xor_b32 v9, 524288, v9
Mvaa 208,80,104
Mvaa 224,80,108
Mvaa 240,80,112
buffer_load_dwordx4 v3, s[8:11], s49 offen offset:1024 lds
Maaa 128,80,116
Maaa 144,80,120
Maaa 160,80,124
Mvaa 180,84,96
buffer_load_dwordx4 v2, s[8:11], s50 offen offset:2048 lds
Mvaa 196,84,100
Mvaa 212,84,104
Mvaa 228,84,108
Mvaa 244,84,112
buffer_load_dwordx4 v3, s[8:11], s51 offen offset:3072 lds
Maaa 132,84,116
Maaa 148,84,120
Maaa 164,84,124
s_add_u32 m0, s56, 4096
Mvaa 184,88,96
buffer_load_dwordx4 v4, s[8:11], s48 offen offset:0 lds
Mvaa 200,88,100
Mvaa 216,88,104
Mvaa 232,88,108
Mvaa 248,88,112
buffer_load_dwordx4 v5, s[8:11], s49 offen offset:1024 lds
Maaa 136,88,116
Maaa 152,88,120
Maaa 168,88,124
Mvaa 188,92,96
buffer_load_dwordx4 v4, s[8:11], s50 offen offset:2048 lds
Mvaa 204,92,100
Mvaa 220,92,104
Mvaa 236,92,108
Mvaa 252,92,112
buffer_load_dwordx4 v5, s[8:11], s51 offen offset:3072 lds
Maaa 140,92,116
v_xor_b32 v2, 128, v2
v_xor_b32 v3, 128, v3
Maaa 156,92,120
buffer_load_dword v1, v47, s[60:63], 0 offen
v_xor_b32 v4, 128, v4
v_xor_b32 v5, 128, v5
Maaa 172,92,124
s_mul_i32 vcc_lo, s59, 7
v_xor_b32 v47, vcc_lo, v47
s_waitcnt lgkmcnt(0)
Mvaa 48,0,32
buffer_load_dword v44, v45, s[16:19], s47 offen
Mvaa 64,0,36
Ta 96,22,16384
Ta 98,22,18432
Mvaa 80,0,40
s_add_u32 s47, s47, 2097152
Mvaa 96,0,44
Ra 64,21,0
Mvaa 112,0,48
Mvaa 128,0,52
Ta 100,23,16384
Ta 102,23,18432
Mvaa 144,0,56
Mvaa 160,0,60
s_waitcnt lgkmcnt(6)
Ra 68,21,2048
Mvaa 52,4,32
Mvaa 68,4,36
Ta 104,24,16384
Ta 106,24,18432
Mvaa 84,4,40
Mvaa 100,4,44
Ra 72,21,4096
Mvaa 116,4,48
Mvaa 132,4,52
Ta 108,25,16384
Ta 110,25,18432
Mvaa 148,4,56
Mvaa 164,4,60
s_waitcnt lgkmcnt(6)
Ra 76,21,6144
Mvaa 56,8,32
Mvaa 72,8,36
Ta 112,26,16384
Ta 114,26,18432
Mvaa 88,8,40
Mvaa 104,8,44
Ra 80,21,8192
Mvaa 120,8,48
Mvaa 136,8,52
Ta 116,27,16384
Ta 118,27,18432
Mvaa 152,8,56
Mvaa 168,8,60
s_waitcnt lgkmcnt(6)
Ra 84,21,10240
Mvaa 60,12,32
Mvaa 76,12,36
Ta 120,28,16384
Ta 122,28,18432
Mvaa 92,12,40
s_cmp_eq_u32 s6, 1
s_cselect_b32 s3, 0, 2146435072
Mvaa 108,12,44
Ra 88,21,12288
Mvaa 124,12,48
s_mov_b64 exec, 1
buffer_atomic_add v30, v31, s[28:31], s3 offen sc1
s_mov_b64 exec, -1
Mvaa 140,12,52
Ta 124,29,16384
Ta 126,29,18432
Mvaa 156,12,56
Mvaa 172,12,60
s_waitcnt lgkmcnt(6)
Ra 92,21,14336
Mvaa 176,16,32
Mvaa 192,16,36
Mvaa 208,16,40
Mvaa 224,16,44
Mvaa 240,16,48
Maaa 128,16,52
Maaa 144,16,56
Maaa 160,16,60
Mvaa 180,20,32
Mvaa 196,20,36
Mvaa 212,20,40
Mvaa 228,20,44
Mvaa 244,20,48
Maaa 132,20,52
Maaa 148,20,56
Maaa 164,20,60
Mvaa 184,24,32
Mvaa 200,24,36
Mvaa 216,24,40
Mvaa 232,24,44
Mvaa 248,24,48
Maaa 136,24,52
Maaa 152,24,56
Maaa 168,24,60
Mvaa 188,28,32
Mvaa 204,28,36
Mvaa 220,28,40
Mvaa 236,28,44
Mvaa 252,28,48
Maaa 140,28,52
Maaa 156,28,56
Maaa 172,28,60
s_waitcnt vmcnt(3) lgkmcnt(0)
s_add_u32 m0, s57, 65536
s_barrier
Mvaa 48,64,96
buffer_load_dwordx4 v6, s[12:15], s52 offen offset:0 nt lds
Mvaa 64,64,100
Ta 32,12,0
Ta 34,12,2048
Mvaa 80,64,104
Mvaa 96,64,108
Ra 0,10,0
Mvaa 112,64,112
buffer_load_dwordx4 v7, s[12:15], s53 offen offset:1024 nt lds
Mvaa 128,64,116
s_waitcnt lgkmcnt(6)
Ta 36,13,0
Ta 38,13,2048
Mvaa 144,64,120
Mvaa 160,64,124
Ra 4,10,2048
Mvaa 52,68,96
buffer_load_dwordx4 v6, s[12:15], s54 offen offset:2048 nt lds
Mvaa 68,68,100
Ta 40,14,0
Ta 42,14,2048
Mvaa 84,68,104
Mvaa 100,68,108
Ra 8,10,4096
Mvaa 116,68,112
buffer_load_dwordx4 v7, s[12:15], s55 offen offset:3072 nt lds
Mvaa 132,68,116
s_waitcnt lgkmcnt(6)
Ta 44,15,0
Ta 46,15,2048
Mvaa 148,68,120
Mvaa 164,68,124
s_add_u32 m0, s57, 69632
Ra 12,10,6144
Mvaa 56,72,96
buffer_load_dwordx4 v8, s[12:15], s52 offen offset:0 nt lds
Mvaa 72,72,100
Ta 48,16,0
Ta 50,16,2048
Mvaa 88,72,104
Mvaa 104,72,108
Ra 16,10,8192
Mvaa 120,72,112
buffer_load_dwordx4 v9, s[12:15], s53 offen offset:1024 nt lds
Mvaa 136,72,116
s_waitcnt lgkmcnt(6)
Ta 52,17,0
Ta 54,17,2048
Mvaa 152,72,120
Mvaa 168,72,124
Ra 20,10,10240
Mvaa 60,76,96
buffer_load_dwordx4 v8, s[12:15], s54 offen offset:2048 nt lds
Mvaa 76,76,100
Ta 56,18,0
Ta 58,18,2048
Mvaa 92,76,104
Mvaa 108,76,108
Ra 24,10,12288
Mvaa 124,76,112
buffer_load_dwordx4 v9, s[12:15], s55 offen offset:3072 nt lds
Mvaa 140,76,116
s_waitcnt lgkmcnt(6)
Ta 60,19,0
Ta 62,19,2048
Mvaa 156,76,120
v_xor_b32 v6, 1572864, v6
v_xor_b32 v7, 1572864, v7
Mvaa 172,76,124
s_add_u32 m0, s56, 65536
Ra 28,10,14336
v_xor_b32 v8, 1572864, v8
Mvaa 176,80,96
buffer_load_dwordx4 v2, s[8:11], s48 offen offset:0 lds
Mvaa 192,80,100
v_xor_b32 v9, 1572864, v9
Mvaa 208,80,104
Mvaa 224,80,108
Mvaa 240,80,112
buffer_load_dwordx4 v3, s[8:11], s49 offen offset:1024 lds
Maaa 128,80,116
Maaa 144,80,120
Maaa 160,80,124
s_cmp_eq_u32 s6, 2
s_cselect_b32 s3, 0, 2146435072
Mvaa 180,84,96
buffer_load_dwordx4 v2, s[8:11], s50 offen offset:2048 lds
Mvaa 196,84,100
s_mov_b64 exec, 1
buffer_atomic_add v30, v31, s[28:31], s3 offen sc1
s_mov_b64 exec, -1
Mvaa 212,84,104
Mvaa 228,84,108
Mvaa 244,84,112
buffer_load_dwordx4 v3, s[8:11], s51 offen offset:3072 lds
Maaa 132,84,116
Maaa 148,84,120
Maaa 164,84,124
s_add_u32 m0, s56, 69632
Mvaa 184,88,96
buffer_load_dwordx4 v4, s[8:11], s48 offen offset:0 lds
Mvaa 200,88,100
Mvaa 216,88,104
Mvaa 232,88,108
Mvaa 248,88,112
buffer_load_dwordx4 v5, s[8:11], s49 offen offset:1024 lds
Maaa 136,88,116
Maaa 152,88,120
Maaa 168,88,124
Mvaa 188,92,96
buffer_load_dwordx4 v4, s[8:11], s50 offen offset:2048 lds
Mvaa 204,92,100
Mvaa 220,92,104
Mvaa 236,92,108
Mvaa 252,92,112
buffer_load_dwordx4 v5, s[8:11], s51 offen offset:3072 lds
Maaa 140,92,116
v_xor_b32 v2, 384, v2
v_xor_b32 v3, 384, v3
Maaa 156,92,120
v_xor_b32 v4, 384, v4
v_xor_b32 v5, 384, v5
Maaa 172,92,124
s_waitcnt lgkmcnt(0)
Mvaa 48,0,32
buffer_load_dword v44, v45, s[16:19], s47 offen
Mvaa 64,0,36
Ta 96,12,16384
Ta 98,12,18432
Mvaa 80,0,40
s_add_u32 s47, s47, 2097152
Mvaa 96,0,44
Ra 64,11,0
Mvaa 112,0,48
Mvaa 128,0,52
Ta 100,13,16384
Ta 102,13,18432
Mvaa 144,0,56
Mvaa 160,0,60
s_waitcnt lgkmcnt(6)
Ra 68,11,2048
Mvaa 52,4,32
Mvaa 68,4,36
Ta 104,14,16384
Ta 106,14,18432
Mvaa 84,4,40
Mvaa 100,4,44
Ra 72,11,4096
Mvaa 116,4,48
Mvaa 132,4,52
Ta 108,15,16384
Ta 110,15,18432
Mvaa 148,4,56
Mvaa 164,4,60
s_waitcnt lgkmcnt(6)
Ra 76,11,6144
Mvaa 56,8,32
Mvaa 72,8,36
Ta 112,16,16384
Ta 114,16,18432
Mvaa 88,8,40
Mvaa 104,8,44
Ra 80,11,8192
Mvaa 120,8,48
Mvaa 136,8,52
Ta 116,17,16384
Ta 118,17,18432
Mvaa 152,8,56
Mvaa 168,8,60
s_waitcnt lgkmcnt(6)
Ra 84,11,10240
Mvaa 60,12,32
Mvaa 76,12,36
Ta 120,18,16384
Ta 122,18,18432
Mvaa 92,12,40
Mvaa 108,12,44
Ra 88,11,12288
Mvaa 124,12,48
Mvaa 140,12,52
Ta 124,19,16384
Ta 126,19,18432
Mvaa 156,12,56
Mvaa 172,12,60
s_waitcnt lgkmcnt(6)
Ra 92,11,14336
Mvaa 176,16,32
Mvaa 192,16,36
Mvaa 208,16,40
Mvaa 224,16,44
Mvaa 240,16,48
Maaa 128,16,52
Maaa 144,16,56
Maaa 160,16,60
Mvaa 180,20,32
Mvaa 196,20,36
Mvaa 212,20,40
Mvaa 228,20,44
Mvaa 244,20,48
Maaa 132,20,52
Maaa 148,20,56
Maaa 164,20,60
Mvaa 184,24,32
Mvaa 200,24,36
Mvaa 216,24,40
Mvaa 232,24,44
Mvaa 248,24,48
s_cmp_eq_u32 s6, 3
s_cselect_b32 s3, 0, 2146435072
Maaa 136,24,52
s_mov_b64 exec, 1
buffer_atomic_add v30, v31, s[28:31], s3 offen sc1
s_mov_b64 exec, -1
Maaa 152,24,56
Maaa 168,24,60
Mvaa 188,28,32
Mvaa 204,28,36
Mvaa 220,28,40
Mvaa 236,28,44
Mvaa 252,28,48
Maaa 140,28,52
Maaa 156,28,56
Maaa 172,28,60
s_waitcnt vmcnt(2) lgkmcnt(0)
s_add_u32 m0, s57, 0
s_barrier
Mvaa 48,64,96
buffer_load_dwordx4 v6, s[12:15], s52 offen offset:0 nt lds
Mvaa 64,64,100
Ta 32,22,0
Ta 34,22,2048
Mvaa 80,64,104
Mvaa 96,64,108
Ra 0,20,0
Mvaa 112,64,112
buffer_load_dwordx4 v7, s[12:15], s53 offen offset:1024 nt lds
Mvaa 128,64,116
s_waitcnt lgkmcnt(6)
Ta 36,23,0
Ta 38,23,2048
Mvaa 144,64,120
Mvaa 160,64,124
Ra 4,20,2048
Mvaa 52,68,96
buffer_load_dwordx4 v6, s[12:15], s54 offen offset:2048 nt lds
Mvaa 68,68,100
Ta 40,24,0
Ta 42,24,2048
Mvaa 84,68,104
Mvaa 100,68,108
Ra 8,20,4096
Mvaa 116,68,112
buffer_load_dwordx4 v7, s[12:15], s55 offen offset:3072 nt lds
Mvaa 132,68,116
s_waitcnt lgkmcnt(6)
Ta 44,25,0
Ta 46,25,2048
Mvaa 148,68,120
Mvaa 164,68,124
s_add_u32 m0, s57, 4096
Ra 12,20,6144
Mvaa 56,72,96
buffer_load_dwordx4 v8, s[12:15], s52 offen offset:0 nt lds
Mvaa 72,72,100
Ta 48,26,0
Ta 50,26,2048
Mvaa 88,72,104
Mvaa 104,72,108
Ra 16,20,8192
Mvaa 120,72,112
buffer_load_dwordx4 v9, s[12:15], s53 offen offset:1024 nt lds
Mvaa 136,72,116
s_waitcnt lgkmcnt(6)
Ta 52,27,0
Ta 54,27,2048
Mvaa 152,72,120
Mvaa 168,72,124
Ra 20,20,10240
Mvaa 60,76,96
buffer_load_dwordx4 v8, s[12:15], s54 offen offset:2048 nt lds
Mvaa 76,76,100
Ta 56,28,0
Ta 58,28,2048
Mvaa 92,76,104
Mvaa 108,76,108
Ra 24,20,12288
Mvaa 124,76,112
buffer_load_dwordx4 v9, s[12:15], s55 offen offset:3072 nt lds
Mvaa 140,76,116
s_waitcnt lgkmcnt(6)
Ta 60,29,0
Ta 62,29,2048
Mvaa 156,76,120
v_xor_b32 v6, 524288, v6
v_xor_b32 v7, 524288, v7
Mvaa 172,76,124
s_add_u32 m0, s56, 0
Ra 28,20,14336
v_xor_b32 v8, 524288, v8
Mvaa 176,80,96
buffer_load_dwordx4 v2, s[8:11], s48 offen offset:0 lds
Mvaa 192,80,100
v_xor_b32 v9, 524288, v9
Mvaa 208,80,104
Mvaa 224,80,108
Mvaa 240,80,112
buffer_load_dwordx4 v3, s[8:11], s49 offen offset:1024 lds
Maaa 128,80,116
Maaa 144,80,120
Maaa 160,80,124
Mvaa 180,84,96
buffer_load_dwordx4 v2, s[8:11], s50 offen offset:2048 lds
Mvaa 196,84,100
Mvaa 212,84,104
Mvaa 228,84,108
Mvaa 244,84,112
buffer_load_dwordx4 v3, s[8:11], s51 offen offset:3072 lds
Maaa 132,84,116
Maaa 148,84,120
Maaa 164,84,124
s_add_u32 m0, s56, 4096
Mvaa 184,88,96
buffer_load_dwordx4 v4, s[8:11], s48 offen offset:0 lds
Mvaa 200,88,100
Mvaa 216,88,104
Mvaa 232,88,108
Mvaa 248,88,112
buffer_load_dwordx4 v5, s[8:11], s49 offen offset:1024 lds
Maaa 136,88,116
Maaa 152,88,120
Maaa 168,88,124
Mvaa 188,92,96
buffer_load_dwordx4 v4, s[8:11], s50 offen offset:2048 lds
Mvaa 204,92,100
Mvaa 220,92,104
Mvaa 236,92,108
Mvaa 252,92,112
buffer_load_dwordx4 v5, s[8:11], s51 offen offset:3072 lds
Maaa 140,92,116
v_xor_b32 v2, 128, v2
v_xor_b32 v3, 128, v3
Maaa 156,92,120
v_xor_b32 v4, 128, v4
v_xor_b32 v5, 128, v5
Maaa 172,92,124
s_waitcnt lgkmcnt(0)
Mvaa 48,0,32
buffer_load_dword v44, v45, s[16:19], s47 offen
Mvaa 64,0,36
Ta 96,22,16384
Ta 98,22,18432
Mvaa 80,0,40
s_add_u32 s47, s47, 2097152
v_lshrrev_b32 v32, 4, v0
v_and_b32 v33, 15, v0
Mvaa 96,0,44
Ra 64,21,0
Mvaa 112,0,48
s_lshl_b32 s3, s32, 4
v_add_u32 v34, s3, v32
v_lshlrev_b32_e64 v36, 1, v32
Mvaa 128,0,52
Ta 100,23,16384
Ta 102,23,18432
Mvaa 144,0,56
v_xor_b32 v36, v36, v33
v_xor_b32 v37, 8, v36
Mvaa 160,0,60
s_waitcnt lgkmcnt(6)
Ra 68,21,2048
Mvaa 52,4,32
s_getpc_b64 s[6:7]
L_cpf3:
s_add_u32 s6, s6, (L_phase2-L_cpf3)&0xffffffff
s_addc_u32 s7, s7, ((L_phase2-L_cpf3)>>32)&0xffffffff
Mvaa 68,4,36
Ta 104,24,16384
Ta 106,24,18432
Mvaa 84,4,40
s_lshr_b32 s3, s2, 3
s_lshl_b32 s3, s3, 2
s_add_u32 s3, s3, s32
Mvaa 100,4,44
Ra 72,21,4096
Mvaa 116,4,48
s_lshl_b32 s3, s3, 10
v_and_b32 v42, 7, v0
v_lshlrev_b32 v42, 7, v42
Mvaa 132,4,52
Ta 108,25,16384
Ta 110,25,18432
Mvaa 148,4,56
v_add_u32_e64 v42, s3, v42
v_min_u32 v42, L_k2_fin-L_phase2-4, v42
Mvaa 164,4,60
s_waitcnt lgkmcnt(6)
Ra 76,21,6144
Mvaa 56,8,32
v_mov_b32 v41, s7
Mvaa 72,8,36
Ta 112,26,16384
Ta 114,26,18432
Mvaa 88,8,40
v_add_co_u32 v40, vcc, s6, v42
s_nop 1
v_addc_co_u32 v41, vcc, 0, v41, vcc
Mvaa 104,8,44
Ra 80,21,8192
Mvaa 120,8,48
global_load_dword v38, v[40:41], off
Mvaa 136,8,52
Ta 116,27,16384
Ta 118,27,18432
Mvaa 152,8,56
Mvaa 168,8,60
s_waitcnt lgkmcnt(6)
Ra 84,21,10240
Mvaa 60,12,32
Mvaa 76,12,36
Ta 120,28,16384
Ta 122,28,18432
Mvaa 92,12,40
Mvaa 108,12,44
Ra 88,21,12288
Mvaa 124,12,48
Mvaa 140,12,52
Ta 124,29,16384
Ta 126,29,18432
Mvaa 156,12,56
Mvaa 172,12,60
s_waitcnt lgkmcnt(6)
Ra 92,21,14336
Mvaa 176,16,32
Mvaa 192,16,36
Mvaa 208,16,40
Mvaa 224,16,44
Mvaa 240,16,48
Maaa 128,16,52
Maaa 144,16,56
Maaa 160,16,60
Mvaa 180,20,32
Mvaa 196,20,36
Mvaa 212,20,40
Mvaa 228,20,44
Mvaa 244,20,48
Maaa 132,20,52
Maaa 148,20,56
Maaa 164,20,60
Mvaa 184,24,32
Mvaa 200,24,36
Mvaa 216,24,40
Mvaa 232,24,44
Mvaa 248,24,48
Maaa 136,24,52
Maaa 152,24,56
Maaa 168,24,60
Mvaa 188,28,32
Mvaa 204,28,36
Mvaa 220,28,40
Mvaa 236,28,44
Mvaa 252,28,48
Maaa 140,28,52
Maaa 156,28,56
Maaa 172,28,60
s_waitcnt vmcnt(2) lgkmcnt(0)
s_add_u32 m0, s57, 65536
s_barrier
Mvaa 48,64,96
buffer_load_dwordx4 v6, s[12:15], s52 offen offset:0 nt lds
Mvaa 64,64,100
Ta 32,12,0
Ta 34,12,2048
Mvaa 80,64,104
Mvaa 96,64,108
Ra 0,10,0
Mvaa 112,64,112
buffer_load_dwordx4 v7, s[12:15], s53 offen offset:1024 nt lds
Mvaa 128,64,116
s_waitcnt lgkmcnt(6)
Ta 36,13,0
Ta 38,13,2048
Mvaa 144,64,120
Mvaa 160,64,124
Ra 4,10,2048
Mvaa 52,68,96
buffer_load_dwordx4 v6, s[12:15], s54 offen offset:2048 nt lds
Mvaa 68,68,100
Ta 40,14,0
Ta 42,14,2048
Mvaa 84,68,104
Mvaa 100,68,108
Ra 8,10,4096
Mvaa 116,68,112
buffer_load_dwordx4 v7, s[12:15], s55 offen offset:3072 nt lds
Mvaa 132,68,116
s_waitcnt lgkmcnt(6)
Ta 44,15,0
Ta 46,15,2048
Mvaa 148,68,120
Mvaa 164,68,124
s_add_u32 m0, s57, 69632
Ra 12,10,6144
Mvaa 56,72,96
buffer_load_dwordx4 v8, s[12:15], s52 offen offset:0 nt lds
Mvaa 72,72,100
Ta 48,16,0
Ta 50,16,2048
Mvaa 88,72,104
Mvaa 104,72,108
Ra 16,10,8192
Mvaa 120,72,112
buffer_load_dwordx4 v9, s[12:15], s53 offen offset:1024 nt lds
Mvaa 136,72,116
s_waitcnt lgkmcnt(6)
Ta 52,17,0
Ta 54,17,2048
Mvaa 152,72,120
Mvaa 168,72,124
Ra 20,10,10240
Mvaa 60,76,96
buffer_load_dwordx4 v8, s[12:15], s54 offen offset:2048 nt lds
Mvaa 76,76,100
Ta 56,18,0
Ta 58,18,2048
Mvaa 92,76,104
Mvaa 108,76,108
Ra 24,10,12288
Mvaa 124,76,112
buffer_load_dwordx4 v9, s[12:15], s55 offen offset:3072 nt lds
Mvaa 140,76,116
s_waitcnt lgkmcnt(6)
Ta 60,19,0
Ta 62,19,2048
Mvaa 156,76,120
Mvaa 172,76,124
s_add_u32 m0, s56, 65536
Ra 28,10,14336
Mvaa 176,80,96
buffer_load_dwordx4 v2, s[8:11], s48 offen offset:0 lds
Mvaa 192,80,100
Mvaa 208,80,104
Mvaa 224,80,108
Mvaa 240,80,112
buffer_load_dwordx4 v3, s[8:11], s49 offen offset:1024 lds
Maaa 128,80,116
Maaa 144,80,120
Maaa 160,80,124
Mvaa 180,84,96
buffer_load_dwordx4 v2, s[8:11], s50 offen offset:2048 lds
Mvaa 196,84,100
Mvaa 212,84,104
Mvaa 228,84,108
Mvaa 244,84,112
buffer_load_dwordx4 v3, s[8:11], s51 offen offset:3072 lds
Maaa 132,84,116
Maaa 148,84,120
Maaa 164,84,124
s_add_u32 m0, s56, 69632
Mvaa 184,88,96
buffer_load_dwordx4 v4, s[8:11], s48 offen offset:0 lds
Mvaa 200,88,100
Mvaa 216,88,104
Mvaa 232,88,108
Mvaa 248,88,112
buffer_load_dwordx4 v5, s[8:11], s49 offen offset:1024 lds
Maaa 136,88,116
Maaa 152,88,120
Maaa 168,88,124
Mvaa 188,92,96
buffer_load_dwordx4 v4, s[8:11], s50 offen offset:2048 lds
Mvaa 204,92,100
Mvaa 220,92,104
Mvaa 236,92,108
Mvaa 252,92,112
buffer_load_dwordx4 v5, s[8:11], s51 offen offset:3072 lds
Maaa 140,92,116
Maaa 156,92,120
Maaa 172,92,124
s_waitcnt lgkmcnt(0)
Mvaa 48,0,32
buffer_load_dword v30, v31, s[28:31], s37 offen sc1
Mvaa 64,0,36
Ta 96,12,16384
Ta 98,12,18432
Mvaa 80,0,40
s_mov_b32 s8, s16
s_mov_b32 s9, s17
s_mov_b32 s10, s18
Mvaa 96,0,44
Ra 64,11,0
Mvaa 112,0,48
s_add_u32 s16, s66, 46137344
s_addc_u32 s17, s67, 0
s_and_b32 s17, s17, 0xffff
Mvaa 128,0,52
Ta 100,13,16384
Ta 102,13,18432
Mvaa 144,0,56
s_mov_b32 s18, 16777216
s_mov_b32 s19, 0x20000
s_mov_b32 s48, 0
Mvaa 160,0,60
s_waitcnt lgkmcnt(6)
Ra 68,11,2048
Mvaa 52,4,32
s_mov_b32 s49, 31744
s_mov_b32 s50, 63488
s_mov_b32 s51, 95232
Mvaa 68,4,36
Ta 104,14,16384
Ta 106,14,18432
Mvaa 84,4,40
v_lshlrev_b32_e64 v35, 13, v34
v_lshl_add_u32 v8, v36, 4, v35
Mvaa 100,4,44
Ra 72,11,4096
Mvaa 116,4,48
v_lshl_add_u32 v9, v37, 4, v35
v_lshlrev_b32_e64 v2, 4, v0
Mvaa 132,4,52
Ta 108,15,16384
Ta 110,15,18432
Mvaa 148,4,56
v_add_u32 v3, 65536, v2
v_add_u32_e64 v4, s44, v2
Mvaa 164,4,60
s_waitcnt lgkmcnt(6)
Ra 76,11,6144
Mvaa 56,8,32
v_mov_b32 v7, 0
v_lshlrev_b32_e64 v35, 2, v32
Mvaa 72,8,36
Ta 112,16,16384
Ta 114,16,18432
Mvaa 88,8,40
v_sub_u32_e64 v35, v33, v35
Mvaa 104,8,44
Ra 80,11,8192
Mvaa 120,8,48
s_lshl_b32 s3, s32, 4
v_add_u32 v5, s3, v35
Mvaa 136,8,52
Ta 116,17,16384
Ta 118,17,18432
Mvaa 152,8,56
s_sub_u32 s3, 48, s3
v_add_u32 v6, s3, v35
Mvaa 168,8,60
s_waitcnt lgkmcnt(6)
Ra 84,11,10240
Mvaa 60,12,32
s_mul_i32 s3, s33, 1116160
s_add_u32 s3, s3, 8388608
s_add_u32 s12, s66, s3
s_addc_u32 s13, s67, 0
s_and_b32 s13, s13, 0xffff
Mvaa 76,12,36
Ta 120,18,16384
Ta 122,18,18432
Mvaa 92,12,40
s_mov_b32 s14, 0
s_mov_b32 s15, 0x20000
s_mul_i32 s14, s36, 34816
Mvaa 108,12,44
Ra 88,11,12288
Mvaa 124,12,48
buffer_load_dword v44, v45, s[8:11], s47 offen
Mvaa 140,12,52
Ta 124,19,16384
Ta 126,19,18432
Mvaa 156,12,56
s_add_u32 s47, s47, 2097152
Mvaa 172,12,60
s_waitcnt lgkmcnt(6)
Ra 92,11,14336
Mvaa 176,16,32
Mvaa 192,16,36
Mvaa 208,16,40
Mvaa 224,16,44
Mvaa 240,16,48
Maaa 128,16,52
Maaa 144,16,56
Maaa 160,16,60
Mvaa 180,20,32
Mvaa 196,20,36
Mvaa 212,20,40
Mvaa 228,20,44
Mvaa 244,20,48
Maaa 132,20,52
Maaa 148,20,56
Maaa 164,20,60
Mvaa 184,24,32
Mvaa 200,24,36
Mvaa 216,24,40
Mvaa 232,24,44
Mvaa 248,24,48
Maaa 136,24,52
Maaa 152,24,56
Maaa 168,24,60
Mvaa 188,28,32
Mvaa 204,28,36
Mvaa 220,28,40
Mvaa 236,28,44
Mvaa 252,28,48
Maaa 140,28,52
Maaa 156,28,56
Maaa 172,28,60
s_waitcnt vmcnt(2) lgkmcnt(0)
s_add_u32 m0, s44, 0
s_barrier
Mvaa 48,64,96
buffer_load_dwordx4 v8, s[8:11], s48 offen offset:0 lds
Mvaa 64,64,100
Ta 32,22,0
Ta 34,22,2048
Mvaa 80,64,104
s_mul_i32 s3, s45, 33792
v_add_u32_e64 v10, s3, v2
Mvaa 96,64,108
Ra 0,20,0
Mvaa 112,64,112
buffer_load_dwordx4 v8, s[8:11], s49 offen offset:1024 lds
Mvaa 128,64,116
s_waitcnt lgkmcnt(6)
Ta 36,23,0
Ta 38,23,2048
Mvaa 144,64,120
s_mul_i32 s3, s46, 33792
v_add_u32 v11, s3, v2
v_mov_b32_e64 v14, v40
Mvaa 160,64,124
Ra 4,20,2048
Mvaa 52,68,96
buffer_load_dwordx4 v9, s[8:11], s50 offen offset:2048 lds
Mvaa 68,68,100
Ta 40,24,0
Ta 42,24,2048
Mvaa 84,68,104
v_mov_b32_e64 v15, v41
Mvaa 100,68,108
Ra 8,20,4096
Mvaa 116,68,112
buffer_load_dwordx4 v9, s[8:11], s51 offen offset:3072 lds
Mvaa 132,68,116
s_waitcnt lgkmcnt(6)
Ta 44,25,0
Ta 46,25,2048
Mvaa 148,68,120
v_add_u32 v8, 524288, v8
v_add_u32 v9, 524288, v9
Mvaa 164,68,124
s_add_u32 m0, s44, 16384
Ra 12,20,6144
Mvaa 56,72,96
buffer_load_dwordx4 v8, s[8:11], s48 offen offset:0 lds
Mvaa 72,72,100
Ta 48,26,0
Ta 50,26,2048
Mvaa 88,72,104
Mvaa 104,72,108
Ra 16,20,8192
Mvaa 120,72,112
buffer_load_dwordx4 v8, s[8:11], s49 offen offset:1024 lds
Mvaa 136,72,116
s_waitcnt lgkmcnt(6)
Ta 52,27,0
Ta 54,27,2048
Mvaa 152,72,120
Mvaa 168,72,124
Ra 20,20,10240
Mvaa 60,76,96
buffer_load_dwordx4 v9, s[8:11], s50 offen offset:2048 lds
Mvaa 76,76,100
Ta 56,28,0
Ta 58,28,2048
Mvaa 92,76,104
Mvaa 108,76,108
Ra 24,20,12288
Mvaa 124,76,112
buffer_load_dwordx4 v9, s[8:11], s51 offen offset:3072 lds
Mvaa 140,76,116
s_waitcnt lgkmcnt(6)
Ta 60,29,0
Ta 62,29,2048
Mvaa 156,76,120
v_add_u32 v8, 524288, v8
v_add_u32 v9, 524288, v9
Mvaa 172,76,124
s_add_u32 m0, s44, 32768
Ra 28,20,14336
Mvaa 176,80,96
buffer_load_dwordx4 v8, s[8:11], s48 offen offset:0 lds
Mvaa 192,80,100
Mvaa 208,80,104
Mvaa 224,80,108
Mvaa 240,80,112
buffer_load_dwordx4 v8, s[8:11], s49 offen offset:1024 lds
Maaa 128,80,116
Maaa 144,80,120
Maaa 160,80,124
Mvaa 180,84,96
buffer_load_dwordx4 v9, s[8:11], s50 offen offset:2048 lds
Mvaa 196,84,100
Mvaa 212,84,104
Mvaa 228,84,108
Mvaa 244,84,112
buffer_load_dwordx4 v9, s[8:11], s51 offen offset:3072 lds
Maaa 132,84,116
v_add_u32 v8, 524288, v8
v_add_u32 v9, 524288, v9
Maaa 148,84,120
Maaa 164,84,124
s_add_u32 m0, s44, 49152
Mvaa 184,88,96
buffer_load_dwordx4 v8, s[8:11], s48 offen offset:0 lds
Mvaa 200,88,100
Mvaa 216,88,104
Mvaa 232,88,108
Mvaa 248,88,112
buffer_load_dwordx4 v8, s[8:11], s49 offen offset:1024 lds
Maaa 136,88,116
Maaa 152,88,120
Maaa 168,88,124
Mvaa 188,92,96
buffer_load_dwordx4 v9, s[8:11], s50 offen offset:2048 lds
Mvaa 204,92,100
Mvaa 220,92,104
Mvaa 236,92,108
Mvaa 252,92,112
buffer_load_dwordx4 v9, s[8:11], s51 offen offset:3072 lds
Maaa 140,92,116
v_add_u32 v8, 524288, v8
v_add_u32 v9, 524288, v9
Maaa 156,92,120
Maaa 172,92,124
s_waitcnt lgkmcnt(0)
Mvaa 48,0,32
Mvaa 64,0,36
Ta 96,22,16384
Ta 98,22,18432
Mvaa 80,0,40
Mvaa 96,0,44
Ra 64,21,0
Mvaa 112,0,48
Mvaa 128,0,52
Ta 100,23,16384
Ta 102,23,18432
Mvaa 144,0,56
Mvaa 160,0,60
s_waitcnt lgkmcnt(6)
Ra 68,21,2048
Mvaa 52,4,32
Mvaa 68,4,36
Ta 104,24,16384
Ta 106,24,18432
Mvaa 84,4,40
Mvaa 100,4,44
Ra 72,21,4096
Mvaa 116,4,48
Mvaa 132,4,52
Ta 108,25,16384
Ta 110,25,18432
Mvaa 148,4,56
Mvaa 164,4,60
s_waitcnt lgkmcnt(6)
Ra 76,21,6144
Mvaa 56,8,32
Mvaa 72,8,36
Ta 112,26,16384
Ta 114,26,18432
Mvaa 88,8,40
Mvaa 104,8,44
Ra 80,21,8192
Mvaa 120,8,48
Mvaa 136,8,52
Ta 116,27,16384
Ta 118,27,18432
Mvaa 152,8,56
Mvaa 168,8,60
s_waitcnt lgkmcnt(6)
Ra 84,21,10240
Mvaa 60,12,32
Mvaa 76,12,36
Ta 120,28,16384
Ta 122,28,18432
Mvaa 92,12,40
Mvaa 108,12,44
Ra 88,21,12288
Mvaa 124,12,48
Mvaa 140,12,52
Ta 124,29,16384
Ta 126,29,18432
Mvaa 156,12,56
Mvaa 172,12,60
s_waitcnt lgkmcnt(6)
Ra 92,21,14336
Mvaa 176,16,32
Mvaa 192,16,36
Mvaa 208,16,40
Mvaa 224,16,44
Mvaa 240,16,48
Maaa 128,16,52
Maaa 144,16,56
Maaa 160,16,60
Mvaa 180,20,32
Mvaa 196,20,36
Mvaa 212,20,40
Mvaa 228,20,44
Mvaa 244,20,48
Maaa 132,20,52
Maaa 148,20,56
Maaa 164,20,60
Mvaa 184,24,32
Mvaa 200,24,36
Mvaa 216,24,40
Mvaa 232,24,44
Mvaa 248,24,48
Maaa 136,24,52
Maaa 152,24,56
Maaa 168,24,60
Mvaa 188,28,32
Mvaa 204,28,36
Mvaa 220,28,40
Mvaa 236,28,44
Mvaa 252,28,48
Maaa 140,28,52
Maaa 156,28,56
Maaa 172,28,60
s_waitcnt vmcnt(12) lgkmcnt(0)
v_readfirstlane_b32 s3, v30
s_nop 0
s_or_b32 s3, s3, s37
s_cmp_lt_u32 s3, 256
s_cbranch_scc1 L_spinAv
L_spinArv:
s_barrier
Mvaa 48,64,96
buffer_load_dwordx4 a[0:3], v10, s[20:23], s58 offen offset:0 sc1
Mvaa 52,68,96
v_lshrrev_b32_e64 v42, 2, v33
v_lshl_add_u32 v43, v32, 3, v42
Mvaa 56,72,96
v_lshlrev_b32 v43, 8, v43
v_and_b32 v44, 3, v0
Mvaa 60,76,96
v_lshl_add_u32 v43, v44, 3, v43
v_and_b32_e64 v44, 1, v32
Mvaa 64,64,100
buffer_load_dwordx4 a[4:7], v10, s[20:23], 0 offen offset:0 sc1
Mvaa 68,68,100
v_lshl_add_u32 v42, v44, 2, v42
v_xor_b32_e64 v44, 0, v42
Mvaa 72,72,100
v_lshl_add_u32 v16, v44, 5, v43
v_xor_b32_e64 v44, 1, v42
Mvaa 76,76,100
v_lshl_add_u32 v17, v44, 5, v43
v_xor_b32_e64 v44, 2, v42
Mvaa 80,64,104
buffer_load_dwordx4 a[8:11], v11, s[20:23], s58 offen offset:0 sc1
Mvaa 84,68,104
v_lshl_add_u32 v18, v44, 5, v43
v_xor_b32_e64 v44, 3, v42
Mvaa 88,72,104
v_lshl_add_u32 v19, v44, 5, v43
v_xor_b32_e64 v44, 4, v42
Mvaa 92,76,104
v_lshl_add_u32 v20, v44, 5, v43
v_xor_b32_e64 v44, 5, v42
Mvaa 96,64,108
buffer_load_dwordx4 a[12:15], v11, s[20:23], 0 offen offset:0 sc1
Mvaa 100,68,108
v_lshl_add_u32 v21, v44, 5, v43
v_xor_b32_e64 v44, 6, v42
Mvaa 104,72,108
v_lshl_add_u32 v22, v44, 5, v43
v_xor_b32_e64 v44, 7, v42
Mvaa 108,76,108
v_lshl_add_u32 v23, v44, 5, v43
Mvaa 112,64,112
buffer_load_dwordx4 a[16:19], v10, s[20:23], s58 offen offset:1024 sc1
Mvaa 116,68,112
Mvaa 120,72,112
Mvaa 124,76,112
Mvaa 128,64,116
buffer_load_dwordx4 a[20:23], v10, s[20:23], 0 offen offset:1024 sc1
Mvaa 132,68,116
Ta 192,16,0
Ta 194,16,1024
Mvaa 136,72,116
Ta 196,17,0
Ta 198,17,1024
Mvaa 140,76,116
Ta 200,18,0
Ta 202,18,1024
Mvaa 144,64,120
buffer_load_dwordx4 a[24:27], v11, s[20:23], s58 offen offset:1024 sc1
Mvaa 148,68,120
Ta 204,19,0
Ta 206,19,1024
Mvaa 152,72,120
Ta 208,20,0
Ta 210,20,1024
Mvaa 156,76,120
Ta 212,21,0
Ta 214,21,1024
Mvaa 160,64,124
buffer_load_dwordx4 a[28:31], v11, s[20:23], 0 offen offset:1024 sc1
Mvaa 164,68,124
Ta 216,22,0
Ta 218,22,1024
Mvaa 168,72,124
Ta 220,23,0
s_waitcnt lgkmcnt(9)
Ta 222,23,1024
Mvaa 172,76,124
s_waitcnt lgkmcnt(8)
Vc 24,48,49
Vc 25,50,51
Mvaa 176,80,96
buffer_load_dwordx4 a[32:35], v10, s[20:23], s58 offen offset:2048 sc1
Mvaa 180,84,96
Vc 26,52,53
Vc 27,54,55
Mvaa 184,88,96
Vc 28,56,57
Vc 29,58,59
Mvaa 188,92,96
Vc 30,60,61
Vc 31,62,63
Mvaa 192,80,100
buffer_load_dwordx4 a[36:39], v10, s[20:23], 0 offen offset:2048 sc1
Mvaa 196,84,100
Vc 32,64,65
Vc 33,66,67
Mvaa 200,88,100
Vc 34,68,69
Vc 35,70,71
Mvaa 204,92,100
Vc 36,72,73
Vc 37,74,75
Mvaa 208,80,104
buffer_load_dwordx4 a[40:43], v11, s[20:23], s58 offen offset:2048 sc1
Mvaa 212,84,104
Vc 38,76,77
Vc 39,78,79
Mvaa 216,88,104
Vc 40,80,81
Vc 41,82,83
Mvaa 220,92,104
Vc 42,84,85
Vc 43,86,87
Mvaa 224,80,108
buffer_load_dwordx4 a[44:47], v11, s[20:23], 0 offen offset:2048 sc1
Mvaa 228,84,108
Vc 44,88,89
Vc 45,90,91
Mvaa 232,88,108
Vc 46,92,93
Vc 47,94,95
Mvaa 236,92,108
Vc 48,96,97
Vc 49,98,99
Mvaa 240,80,112
buffer_load_dwordx4 a[48:51], v10, s[20:23], s58 offen offset:3072 sc1
Mvaa 244,84,112
Vc 50,100,101
Vc 51,102,103
Mvaa 248,88,112
Vc 52,104,105
Vc 53,106,107
Mvaa 252,92,112
Vc 54,108,109
Vc 55,110,111
Maaa 128,80,116
buffer_load_dwordx4 a[52:55], v10, s[20:23], 0 offen offset:3072 sc1
Maaa 132,84,116
Vc 56,112,113
Vc 57,114,115
Maaa 136,88,116
Vc 58,116,117
Vc 59,118,119
Maaa 140,92,116
Vc 60,120,121
Vc 61,122,123
Maaa 144,80,120
buffer_load_dwordx4 a[56:59], v11, s[20:23], s58 offen offset:3072 sc1
Maaa 148,84,120
Vc 62,124,125
Vc 63,126,127
Maaa 152,88,120
Vc 64,128,129
Vc 65,130,131
Maaa 156,92,120
Vc 66,132,133
Vc 67,134,135
Maaa 160,80,124
buffer_load_dwordx4 a[60:63], v11, s[20:23], 0 offen offset:3072 sc1
Maaa 164,84,124
v_add_u32 v10, 4096, v10
v_add_u32 v11, 4096, v11
Maaa 168,88,124
Vc 68,136,137
Vc 69,138,139
Maaa 172,92,124
Vc 70,140,141
Vc 71,142,143
Vc 72,144,145
Vc 73,146,147
Vc 74,148,149
Vc 75,150,151
Vc 76,152,153
Vc 77,154,155
Vc 78,156,157
Vc 79,158,159
Vc 80,160,161
Vc 81,162,163
Vc 82,164,165
Vc 83,166,167
Vc 84,168,169
Vc 85,170,171
Vc 86,172,173
Vc 87,174,175
Vc 88,176,177
Vc 89,178,179
Vc 90,180,181
Vc 91,182,183
Vc 92,184,185
Vc 93,186,187
Vc 94,188,189
Vc 95,190,191
Vc 96,192,193
Vc 97,194,195
Vc 98,196,197
Vc 99,198,199
Vc 100,200,201
Vc 101,202,203
Vc 102,204,205
Vc 103,206,207
Vc 104,208,209
Vc 105,210,211
Vc 106,212,213
Vc 107,214,215
Vc 108,216,217
Vc 109,218,219
Vc 110,220,221
Vc 111,222,223
Vc 112,224,225
Vc 113,226,227
Vc 114,228,229
Vc 115,230,231
Vc 116,232,233
Vc 117,234,235
Vc 118,236,237
Vc 119,238,239
Vc 120,240,241
Vc 121,242,243
Vc 122,244,245
Vc 123,246,247
Vc 124,248,249
Vc 125,250,251
Vc 126,252,253
Vc 127,254,255
L_phase2:
s_nop 7
s_waitcnt vmcnt(12) lgkmcnt(0)
Zvaa 128,192,0
s_add_u32 s37, s38, 0
Zvaa 160,192,4
Ta 224,16,8192
Ta 226,16,9216
Zvaa 192,192,8
buffer_load_dwordx4 a[64:67], v10, s[20:23], s58 offen offset:0 sc1
Zvaa 224,192,12
buffer_store_dwordx4 v[24:27], v2, s[24:27], s37 offen offset:0 sc1
Zvaa 132,196,0
Ta 228,17,8192
Ta 230,17,9216
Zvaa 164,196,4
buffer_load_dwordx4 a[68:71], v10, s[20:23], 0 offen offset:0 sc1
Zvaa 196,196,8
s_mov_b32 s60, s40
s_and_b32 s61, s41, 0xffff
s_mov_b32 s62, 7340032
Zvaa 228,196,12
Ta 232,18,8192
Ta 234,18,9216
Zvaa 136,200,0
s_mov_b32 s63, 0x20000
Zvaa 168,200,4
buffer_load_dwordx4 a[72:75], v11, s[20:23], s58 offen offset:0 sc1
Zvaa 200,200,8
Ta 236,19,8192
Ta 238,19,9216
Zvaa 232,200,12
global_load_dword v13, v[14:15], off
Zvaa 140,204,0
Zvaa 172,204,4
Ta 240,20,8192
Ta 242,20,9216
Zvaa 204,204,8
buffer_load_dwordx4 a[76:79], v11, s[20:23], 0 offen offset:0 sc1
Zvaa 236,204,12
Zvaa 144,208,0
s_waitcnt lgkmcnt(6)
Ta 244,21,8192
Ta 246,21,9216
Zvaa 176,208,4
buffer_store_dwordx4 v[28:31], v2, s[24:27], s37 offen offset:1024 sc1
Zvaa 208,208,8
buffer_load_dwordx4 a[80:83], v10, s[20:23], s58 offen offset:1024 sc1
Zvaa 240,208,12
Ta 248,22,8192
Ta 250,22,9216
Zvaa 148,212,0
Zvaa 180,212,4
Zvaa 212,212,8
Ta 252,23,8192
Ta 254,23,9216
Zvaa 244,212,12
buffer_load_dwordx4 a[84:87], v10, s[20:23], 0 offen offset:1024 sc1
Zvaa 152,216,0
Zvaa 184,216,4
Zvaa 216,216,8
buffer_load_dwordx4 a[88:91], v11, s[20:23], s58 offen offset:1024 sc1
Zvaa 248,216,12
Zvaa 156,220,0
Zvaa 188,220,4
buffer_load_dwordx4 a[92:95], v11, s[20:23], 0 offen offset:1024 sc1
Zvaa 220,220,8
Zvaa 252,220,12
s_waitcnt vmcnt(19) lgkmcnt(0)
s_barrier
Mvaa 128,224,16
buffer_store_dwordx4 v[32:35], v2, s[24:27], s37 offen offset:2048 sc1
Mvaa 160,224,20
s_add_u32 m0, s44, 0
Ta 192,16,16384
Ta 194,16,17408
Mvaa 192,224,24
buffer_load_dwordx4 v8, s[8:11], s48 offen offset:0 lds
Mvaa 224,224,28
Mvaa 132,228,16
Ta 196,17,16384
Ta 198,17,17408
Mvaa 164,228,20
buffer_load_dwordx4 v8, s[8:11], s49 offen offset:1024 lds
Mvaa 196,228,24
Mvaa 228,228,28
Ta 200,18,16384
Ta 202,18,17408
Mvaa 136,232,16
Mvaa 168,232,20
buffer_load_dwordx4 v9, s[8:11], s50 offen offset:2048 lds
Mvaa 200,232,24
Ta 204,19,16384
Ta 206,19,17408
Mvaa 232,232,28
Mvaa 140,236,16
Mvaa 172,236,20
Ta 208,20,16384
Ta 210,20,17408
Mvaa 204,236,24
buffer_load_dwordx4 v9, s[8:11], s51 offen offset:3072 lds
v_add_u32 v8, 524288, v8
v_add_u32 v9, 524288, v9
Mvaa 236,236,28
Mvaa 144,240,16
s_waitcnt lgkmcnt(6)
Ta 212,21,16384
Ta 214,21,17408
Mvaa 176,240,20
buffer_store_dwordx4 v[36:39], v2, s[24:27], s37 offen offset:3072 sc1
Mvaa 208,240,24
buffer_load_dwordx4 a[96:99], v10, s[20:23], s58 offen offset:2048 sc1
Mvaa 240,240,28
Ta 216,22,16384
Ta 218,22,17408
Mvaa 148,244,16
Mvaa 180,244,20
Mvaa 212,244,24
Ta 220,23,16384
Ta 222,23,17408
Mvaa 244,244,28
buffer_load_dwordx4 a[100:103], v10, s[20:23], 0 offen offset:2048 sc1
Mvaa 152,248,16
Mvaa 184,248,20
Mvaa 216,248,24
buffer_load_dwordx4 a[104:107], v11, s[20:23], s58 offen offset:2048 sc1
Mvaa 248,248,28
Mvaa 156,252,16
Mvaa 188,252,20
buffer_load_dwordx4 a[108:111], v11, s[20:23], 0 offen offset:2048 sc1
Mvaa 220,252,24
Mvaa 252,252,28
s_waitcnt vmcnt(25) lgkmcnt(0)
Mvaa 128,192,32
s_add_u32 s37, s38, 4096
Mvaa 160,192,36
Ta 224,16,24576
Ta 226,16,25600
Mvaa 192,192,40
buffer_load_dwordx4 a[112:115], v10, s[20:23], s58 offen offset:3072 sc1
Mvaa 224,192,44
buffer_store_dwordx4 v[40:43], v2, s[24:27], s37 offen offset:0 sc1
Mvaa 132,196,32
Ta 228,17,24576
Ta 230,17,25600
Mvaa 164,196,36
Mvaa 196,196,40
Mvaa 228,196,44
Ta 232,18,24576
Ta 234,18,25600
Mvaa 136,200,32
Mvaa 168,200,36
buffer_load_dwordx4 a[116:119], v10, s[20:23], 0 offen offset:3072 sc1
Mvaa 200,200,40
Ta 236,19,24576
Ta 238,19,25600
Mvaa 232,200,44
Mvaa 140,204,32
Mvaa 172,204,36
Ta 240,20,24576
Ta 242,20,25600
Mvaa 204,204,40
Mvaa 236,204,44
Mvaa 144,208,32
s_waitcnt lgkmcnt(6)
Ta 244,21,24576
Ta 246,21,25600
Mvaa 176,208,36
buffer_store_dwordx4 v[44:47], v2, s[24:27], s37 offen offset:1024 sc1
Mvaa 208,208,40
buffer_load_dwordx4 a[120:123], v11, s[20:23], s58 offen offset:3072 sc1
Mvaa 240,208,44
Ta 248,22,24576
Ta 250,22,25600
Mvaa 148,212,32
Mvaa 180,212,36
Mvaa 212,212,40
Ta 252,23,24576
Ta 254,23,25600
Mvaa 244,212,44
Mvaa 152,216,32
Mvaa 184,216,36
Mvaa 216,216,40
buffer_load_dwordx4 a[124:127], v11, s[20:23], 0 offen offset:3072 sc1
v_add_u32 v10, 4096, v10
v_add_u32 v11, 4096, v11
Mvaa 248,216,44
Mvaa 156,220,32
Mvaa 188,220,36
Mvaa 220,220,40
Mvaa 252,220,44
s_waitcnt vmcnt(27) lgkmcnt(0)
s_barrier
Mvaa 128,224,48
buffer_store_dwordx4 v[48:51], v2, s[24:27], s37 offen offset:2048 sc1
Mvaa 160,224,52
s_add_u32 m0, s44, 16384
Ta 192,16,32768
Ta 194,16,33792
Mvaa 192,224,56
buffer_load_dwordx4 v8, s[8:11], s48 offen offset:0 lds
Mvaa 224,224,60
Mvaa 132,228,48
Ta 196,17,32768
Ta 198,17,33792
Mvaa 164,228,52
buffer_load_dwordx4 v8, s[8:11], s49 offen offset:1024 lds
Mvaa 196,228,56
Mvaa 228,228,60
Ta 200,18,32768
Ta 202,18,33792
Mvaa 136,232,48
Mvaa 168,232,52
buffer_load_dwordx4 v9, s[8:11], s50 offen offset:2048 lds
Mvaa 200,232,56
Ta 204,19,32768
Ta 206,19,33792
Mvaa 232,232,60
Mvaa 140,236,48
Mvaa 172,236,52
Ta 208,20,32768
Ta 210,20,33792
Mvaa 204,236,56
buffer_load_dwordx4 v9, s[8:11], s51 offen offset:3072 lds
v_add_u32 v8, 524288, v8
v_add_u32 v9, 524288, v9
Mvaa 236,236,60
Mvaa 144,240,48
s_waitcnt lgkmcnt(6)
Ta 212,21,32768
Ta 214,21,33792
Mvaa 176,240,52
buffer_store_dwordx4 v[52:55], v2, s[24:27], s37 offen offset:3072 sc1
Mvaa 208,240,56
buffer_load_dwordx4 a[0:3], v10, s[20:23], s58 offen offset:0 sc1
Mvaa 240,240,60
Ta 216,22,32768
Ta 218,22,33792
Mvaa 148,244,48
Mvaa 180,244,52
Mvaa 212,244,56
Ta 220,23,32768
Ta 222,23,33792
Mvaa 244,244,60
buffer_load_dwordx4 a[4:7], v10, s[20:23], 0 offen offset:0 sc1
Mvaa 152,248,48
Mvaa 184,248,52
Mvaa 216,248,56
buffer_load_dwordx4 a[8:11], v11, s[20:23], s58 offen offset:0 sc1
Mvaa 248,248,60
Mvaa 156,252,48
Mvaa 188,252,52
buffer_load_dwordx4 a[12:15], v11, s[20:23], 0 offen offset:0 sc1
Mvaa 220,252,56
Mvaa 252,252,60
s_waitcnt vmcnt(31) lgkmcnt(0)
Mvaa 128,192,64
s_add_u32 s37, s38, 8192
Mvaa 160,192,68
Ta 224,16,40960
Ta 226,16,41984
Mvaa 192,192,72
buffer_load_dwordx4 a[16:19], v10, s[20:23], s58 offen offset:1024 sc1
Mvaa 224,192,76
buffer_store_dwordx4 v[56:59], v2, s[24:27], s37 offen offset:0 sc1
Mvaa 132,196,64
Ta 228,17,40960
Ta 230,17,41984
Mvaa 164,196,68
Ar 48,128
Ar 49,129
Mvaa 196,196,72
Ar 50,130
Ar 51,131
Mvaa 228,196,76
Ta 232,18,40960
Ta 234,18,41984
Mvaa 136,200,64
Ar 52,132
Ar 53,133
Mvaa 168,200,68
buffer_load_dwordx4 a[20:23], v10, s[20:23], 0 offen offset:1024 sc1
Mvaa 200,200,72
Ta 236,19,40960
Ta 238,19,41984
Mvaa 232,200,76
Ar 54,134
Ar 55,135
Mvaa 140,204,64
Vc 24,48,49
Vc 25,50,51
Mvaa 172,204,68
Ta 240,20,40960
Ta 242,20,41984
Mvaa 204,204,72
Vc 26,52,53
Vc 27,54,55
Mvaa 236,204,76
Mvaa 144,208,64
s_waitcnt lgkmcnt(6)
Ta 244,21,40960
Ta 246,21,41984
Mvaa 176,208,68
buffer_store_dwordx4 v[60:63], v2, s[24:27], s37 offen offset:1024 sc1
Mvaa 208,208,72
buffer_load_dwordx4 a[24:27], v11, s[20:23], s58 offen offset:1024 sc1
Mvaa 240,208,76
Ta 248,22,40960
Ta 250,22,41984
Mvaa 148,212,64
Ar 48,136
Ar 49,137
Mvaa 180,212,68
Ar 50,138
Ar 51,139
Mvaa 212,212,72
Ta 252,23,40960
Ta 254,23,41984
Mvaa 244,212,76
Ar 52,140
Ar 53,141
Mvaa 152,216,64
Ar 54,142
Ar 55,143
Mvaa 184,216,68
Vc 28,48,49
Vc 29,50,51
Mvaa 216,216,72
buffer_load_dwordx4 a[28:31], v11, s[20:23], 0 offen offset:1024 sc1
Mvaa 248,216,76
Vc 30,52,53
Vc 31,54,55
Mvaa 156,220,64
Mvaa 188,220,68
Mvaa 220,220,72
Mvaa 252,220,76
s_waitcnt vmcnt(32) lgkmcnt(0)
s_barrier
Mvaa 128,224,80
buffer_store_dwordx4 v[64:67], v2, s[24:27], s37 offen offset:2048 sc1
Mvaa 160,224,84
s_add_u32 m0, s44, 32768
Ta 192,16,49152
Ta 194,16,50176
Mvaa 192,224,88
buffer_load_dwordx4 v8, s[8:11], s48 offen offset:0 lds
Mvaa 224,224,92
Ar 48,144
Ar 49,145
Mvaa 132,228,80
Ta 196,17,49152
Ta 198,17,50176
Mvaa 164,228,84
buffer_load_dwordx4 v8, s[8:11], s49 offen offset:1024 lds
Mvaa 196,228,88
Ar 50,146
Ar 51,147
Mvaa 228,228,92
Ta 200,18,49152
Ta 202,18,50176
Mvaa 136,232,80
Ar 52,148
Ar 53,149
Mvaa 168,232,84
buffer_load_dwordx4 v9, s[8:11], s50 offen offset:2048 lds
Mvaa 200,232,88
Ta 204,19,49152
Ta 206,19,50176
Mvaa 232,232,92
Ar 54,150
Ar 55,151
Mvaa 140,236,80
Vc 32,48,49
Vc 33,50,51
Mvaa 172,236,84
Ta 208,20,49152
Ta 210,20,50176
Mvaa 204,236,88
buffer_load_dwordx4 v9, s[8:11], s51 offen offset:3072 lds
v_add_u32 v8, 524288, v8
v_add_u32 v9, 524288, v9
Mvaa 236,236,92
Vc 34,52,53
Vc 35,54,55
Mvaa 144,240,80
s_waitcnt lgkmcnt(6)
Ta 212,21,49152
Ta 214,21,50176
Mvaa 176,240,84
buffer_store_dwordx4 v[68:71], v2, s[24:27], s37 offen offset:3072 sc1
Mvaa 208,240,88
buffer_load_dwordx4 a[32:35], v10, s[20:23], s58 offen offset:2048 sc1
Mvaa 240,240,92
Ta 216,22,49152
Ta 218,22,50176
Mvaa 148,244,80
Ar 48,152
Ar 49,153
Mvaa 180,244,84
Ar 50,154
Ar 51,155
Mvaa 212,244,88
Ta 220,23,49152
Ta 222,23,50176
Mvaa 244,244,92
buffer_load_dwordx4 a[36:39], v10, s[20:23], 0 offen offset:2048 sc1
Mvaa 152,248,80
Ar 52,156
Ar 53,157
Mvaa 184,248,84
Ar 54,158
Ar 55,159
Mvaa 216,248,88
buffer_load_dwordx4 a[40:43], v11, s[20:23], s58 offen offset:2048 sc1
Mvaa 248,248,92
Vc 36,48,49
Vc 37,50,51
Mvaa 156,252,80
Vc 38,52,53
Vc 39,54,55
Mvaa 188,252,84
buffer_load_dwordx4 a[44:47], v11, s[20:23], 0 offen offset:2048 sc1
Mvaa 220,252,88
global_load_dword v13, v[14:15], off
Mvaa 252,252,92
s_waitcnt vmcnt(33) lgkmcnt(0)
Mvaa 128,192,96
s_add_u32 s37, s38, 12288
Mvaa 160,192,100
Ta 224,16,57344
Ta 226,16,58368
Mvaa 192,192,104
buffer_load_dwordx4 a[48:51], v10, s[20:23], s58 offen offset:3072 sc1
Mvaa 224,192,108
buffer_store_dwordx4 v[72:75], v2, s[24:27], s37 offen offset:0 sc1
Mvaa 132,196,96
Ta 228,17,57344
Ta 230,17,58368
Mvaa 164,196,100
Ar 48,160
Ar 49,161
Mvaa 196,196,104
Ar 50,162
Ar 51,163
Mvaa 228,196,108
Ta 232,18,57344
Ta 234,18,58368
Mvaa 136,200,96
Ar 52,164
Ar 53,165
Mvaa 168,200,100
buffer_load_dwordx4 a[52:55], v10, s[20:23], 0 offen offset:3072 sc1
Mvaa 200,200,104
Ta 236,19,57344
Ta 238,19,58368
Mvaa 232,200,108
Ar 54,166
Ar 55,167
Mvaa 140,204,96
Vc 40,48,49
Vc 41,50,51
Mvaa 172,204,100
Ta 240,20,57344
Ta 242,20,58368
Mvaa 204,204,104
Vc 42,52,53
Vc 43,54,55
Mvaa 236,204,108
Mvaa 144,208,96
s_waitcnt lgkmcnt(6)
Ta 244,21,57344
Ta 246,21,58368
Mvaa 176,208,100
buffer_store_dwordx4 v[76:79], v2, s[24:27], s37 offen offset:1024 sc1
Mvaa 208,208,104
buffer_load_dwordx4 a[56:59], v11, s[20:23], s58 offen offset:3072 sc1
Mvaa 240,208,108
Ta 248,22,57344
Ta 250,22,58368
Mvaa 148,212,96
Ar 48,168
Ar 49,169
Mvaa 180,212,100
Ar 50,170
Ar 51,171
Mvaa 212,212,104
Ta 252,23,57344
Ta 254,23,58368
Mvaa 244,212,108
Ar 52,172
Ar 53,173
Mvaa 152,216,96
Ar 54,174
Ar 55,175
Mvaa 184,216,100
Vc 44,48,49
Vc 45,50,51
Mvaa 216,216,104
buffer_load_dwordx4 a[60:63], v11, s[20:23], 0 offen offset:3072 sc1
v_add_u32 v10, 4096, v10
v_add_u32 v11, 4096, v11
Mvaa 248,216,108
Vc 46,52,53
Vc 47,54,55
Mvaa 156,220,96
Mvaa 188,220,100
Mvaa 220,220,104
Mvaa 252,220,108
s_waitcnt vmcnt(33) lgkmcnt(0)
s_barrier
Mvaa 128,224,112
buffer_store_dwordx4 v[80:83], v2, s[24:27], s37 offen offset:2048 sc1
Mvaa 160,224,116
s_add_u32 m0, s44, 49152
Ta 192,16,0
Ta 194,16,1024
Mvaa 192,224,120
buffer_load_dwordx4 v8, s[8:11], s48 offen offset:0 lds
Mvaa 224,224,124
Mvaa 132,228,112
Ta 196,17,0
Ta 198,17,1024
Mvaa 164,228,116
buffer_load_dwordx4 v8, s[8:11], s49 offen offset:1024 lds
Mvaa 196,228,120
Mvaa 228,228,124
Ta 200,18,0
Ta 202,18,1024
Mvaa 136,232,112
Mvaa 168,232,116
buffer_load_dwordx4 v9, s[8:11], s50 offen offset:2048 lds
Mvaa 200,232,120
Ta 204,19,0
Ta 206,19,1024
Mvaa 232,232,124
Mvaa 140,236,112
Mvaa 172,236,116
Ta 208,20,0
Ta 210,20,1024
Mvaa 204,236,120
buffer_load_dwordx4 v9, s[8:11], s51 offen offset:3072 lds
v_add_u32 v8, 524288, v8
v_add_u32 v9, 524288, v9
Mvaa 236,236,124
Mvaa 144,240,112
s_waitcnt lgkmcnt(6)
Ta 212,21,0
Ta 214,21,1024
Mvaa 176,240,116
buffer_store_dwordx4 v[84:87], v2, s[24:27], s37 offen offset:3072 sc1
Mvaa 208,240,120
buffer_load_dwordx4 a[64:67], v10, s[20:23], s58 offen offset:0 sc1
Mvaa 240,240,124
Ta 216,22,0
Ta 218,22,1024
Mvaa 148,244,112
Mvaa 180,244,116
Mvaa 212,244,120
Ta 220,23,0
Ta 222,23,1024
Mvaa 244,244,124
buffer_load_dwordx4 a[68:71], v10, s[20:23], 0 offen offset:0 sc1
Mvaa 152,248,112
Mvaa 184,248,116
Mvaa 216,248,120
buffer_load_dwordx4 a[72:75], v11, s[20:23], s58 offen offset:0 sc1
Mvaa 248,248,124
Mvaa 156,252,112
Mvaa 188,252,116
buffer_load_dwordx4 a[76:79], v11, s[20:23], 0 offen offset:0 sc1
Mvaa 220,252,120
Mvaa 252,252,124
s_waitcnt vmcnt(33) lgkmcnt(0)
Mvaa 128,192,0
s_add_u32 s37, s38, 34816
Mvaa 160,192,4
Ta 224,16,8192
Ta 226,16,9216
Mvaa 192,192,8
buffer_load_dwordx4 a[80:83], v10, s[20:23], s58 offen offset:1024 sc1
Mvaa 224,192,12
buffer_store_dwordx4 v[88:91], v2, s[24:27], s37 offen offset:0 sc1
Mvaa 132,196,0
Ta 228,17,8192
Ta 230,17,9216
Mvaa 164,196,4
Mvaa 196,196,8
Mvaa 228,196,12
Ta 232,18,8192
Ta 234,18,9216
Mvaa 136,200,0
Mvaa 168,200,4
buffer_load_dwordx4 a[84:87], v10, s[20:23], 0 offen offset:1024 sc1
Mvaa 200,200,8
Ta 236,19,8192
Ta 238,19,9216
Mvaa 232,200,12
Mvaa 140,204,0
Mvaa 172,204,4
Ta 240,20,8192
Ta 242,20,9216
Mvaa 204,204,8
Mvaa 236,204,12
Mvaa 144,208,0
s_waitcnt lgkmcnt(6)
Ta 244,21,8192
Ta 246,21,9216
Mvaa 176,208,4
buffer_store_dwordx4 v[92:95], v2, s[24:27], s37 offen offset:1024 sc1
Mvaa 208,208,8
buffer_load_dwordx4 a[88:91], v11, s[20:23], s58 offen offset:1024 sc1
Mvaa 240,208,12
Ta 248,22,8192
Ta 250,22,9216
Mvaa 148,212,0
s_mov_b32 s3, 5242880
s_mov_b32 s47, 5246976
Mvaa 180,212,4
buffer_load_dwordx4 v[56:59], v2, s[20:23], s3 offen offset:0 sc1
Mvaa 212,212,8
Ta 252,23,8192
Ta 254,23,9216
Mvaa 244,212,12
buffer_load_dwordx4 v[60:63], v2, s[20:23], s3 offen offset:1024 sc1
Mvaa 152,216,0
buffer_load_dwordx4 v[64:67], v2, s[20:23], s3 offen offset:2048 sc1
Mvaa 184,216,4
buffer_load_dwordx4 v[68:71], v2, s[20:23], s3 offen offset:3072 sc1
Mvaa 216,216,8
buffer_load_dwordx4 a[92:95], v11, s[20:23], 0 offen offset:1024 sc1
Mvaa 248,216,12
buffer_load_dwordx4 v[72:75], v2, s[20:23], s47 offen offset:0 sc1
Mvaa 156,220,0
buffer_load_dwordx4 v[76:79], v2, s[20:23], s47 offen offset:1024 sc1
Mvaa 188,220,4
buffer_load_dwordx4 v[80:83], v2, s[20:23], s47 offen offset:2048 sc1
Mvaa 220,220,8
buffer_load_dwordx4 v[84:87], v2, s[20:23], s47 offen offset:3072 sc1
Mvaa 252,220,12
s_waitcnt vmcnt(41) lgkmcnt(0)
s_barrier
Mvaa 128,224,16
buffer_store_dwordx4 v[96:99], v2, s[24:27], s37 offen offset:2048 sc1
Mvaa 160,224,20
s_add_u32 m0, s44, 0
Ta 192,16,16384
Ta 194,16,17408
Mvaa 192,224,24
buffer_load_dwordx4 v8, s[8:11], s48 offen offset:0 lds
Mvaa 224,224,28
Mvaa 132,228,16
Ta 196,17,16384
Ta 198,17,17408
Mvaa 164,228,20
buffer_load_dwordx4 v8, s[8:11], s49 offen offset:1024 lds
Mvaa 196,228,24
Mvaa 228,228,28
Ta 200,18,16384
Ta 202,18,17408
Mvaa 136,232,16
Mvaa 168,232,20
buffer_load_dwordx4 v9, s[8:11], s50 offen offset:2048 lds
Mvaa 200,232,24
Ta 204,19,16384
Ta 206,19,17408
Mvaa 232,232,28
Mvaa 140,236,16
Mvaa 172,236,20
Ta 208,20,16384
Ta 210,20,17408
Mvaa 204,236,24
buffer_load_dwordx4 v9, s[8:11], s51 offen offset:3072 lds
v_add_u32 v8, 524288, v8
v_add_u32 v9, 524288, v9
Mvaa 236,236,28
Mvaa 144,240,16
s_waitcnt lgkmcnt(6)
Ta 212,21,16384
Ta 214,21,17408
Mvaa 176,240,20
buffer_store_dwordx4 v[100:103], v2, s[24:27], s37 offen offset:3072 sc1
Mvaa 208,240,24
buffer_load_dwordx4 a[96:99], v10, s[20:23], s58 offen offset:2048 sc1
Mvaa 240,240,28
Ta 216,22,16384
Ta 218,22,17408
Mvaa 148,244,16
Mvaa 180,244,20
Mvaa 212,244,24
Ta 220,23,16384
Ta 222,23,17408
Mvaa 244,244,28
buffer_load_dwordx4 a[100:103], v10, s[20:23], 0 offen offset:2048 sc1
Mvaa 152,248,16
Mvaa 184,248,20
Mvaa 216,248,24
buffer_load_dwordx4 a[104:107], v11, s[20:23], s58 offen offset:2048 sc1
Mvaa 248,248,28
Mvaa 156,252,16
Mvaa 188,252,20
buffer_load_dwordx4 a[108:111], v11, s[20:23], 0 offen offset:2048 sc1
Mvaa 220,252,24
Mvaa 252,252,28
s_waitcnt vmcnt(41) lgkmcnt(0)
Mvaa 128,192,32
s_add_u32 s37, s38, 38912
Mvaa 160,192,36
Ta 224,16,24576
Ta 226,16,25600
Mvaa 192,192,40
buffer_load_dwordx4 a[112:115], v10, s[20:23], s58 offen offset:3072 sc1
Mvaa 224,192,44
buffer_store_dwordx4 v[104:107], v2, s[24:27], s37 offen offset:0 sc1
Mvaa 132,196,32
Ta 228,17,24576
Ta 230,17,25600
Mvaa 164,196,36
Mvaa 196,196,40
Mvaa 228,196,44
Ta 232,18,24576
Ta 234,18,25600
Mvaa 136,200,32
Mvaa 168,200,36
buffer_load_dwordx4 a[116:119], v10, s[20:23], 0 offen offset:3072 sc1
Mvaa 200,200,40
Ta 236,19,24576
Ta 238,19,25600
Mvaa 232,200,44
Mvaa 140,204,32
Mvaa 172,204,36
Ta 240,20,24576
Ta 242,20,25600
Mvaa 204,204,40
Mvaa 236,204,44
Mvaa 144,208,32
s_waitcnt lgkmcnt(6)
Ta 244,21,24576
Ta 246,21,25600
Mvaa 176,208,36
buffer_store_dwordx4 v[108:111], v2, s[24:27], s37 offen offset:1024 sc1
Mvaa 208,208,40
buffer_load_dwordx4 a[120:123], v11, s[20:23], s58 offen offset:3072 sc1
Mvaa 240,208,44
Ta 248,22,24576
Ta 250,22,25600
Mvaa 148,212,32
Mvaa 180,212,36
Mvaa 212,212,40
Ta 252,23,24576
Ta 254,23,25600
Mvaa 244,212,44
Mvaa 152,216,32
Mvaa 184,216,36
Mvaa 216,216,40
buffer_load_dwordx4 a[124:127], v11, s[20:23], 0 offen offset:3072 sc1
v_add_u32 v10, 4096, v10
v_add_u32 v11, 4096, v11
Mvaa 248,216,44
Mvaa 156,220,32
Mvaa 188,220,36
Mvaa 220,220,40
Mvaa 252,220,44
s_waitcnt vmcnt(40) lgkmcnt(0)
s_barrier
Mvaa 128,224,48
buffer_store_dwordx4 v[112:115], v2, s[24:27], s37 offen offset:2048 sc1
Mvaa 160,224,52
s_add_u32 m0, s44, 16384
Ta 192,16,32768
Ta 194,16,33792
Mvaa 192,224,56
buffer_load_dwordx4 v8, s[8:11], s48 offen offset:0 lds
Mvaa 224,224,60
Mvaa 132,228,48
Ta 196,17,32768
Ta 198,17,33792
Mvaa 164,228,52
buffer_load_dwordx4 v8, s[8:11], s49 offen offset:1024 lds
Mvaa 196,228,56
Mvaa 228,228,60
Ta 200,18,32768
Ta 202,18,33792
Mvaa 136,232,48
Mvaa 168,232,52
buffer_load_dwordx4 v9, s[8:11], s50 offen offset:2048 lds
Mvaa 200,232,56
Ta 204,19,32768
Ta 206,19,33792
Mvaa 232,232,60
Mvaa 140,236,48
Mvaa 172,236,52
Ta 208,20,32768
Ta 210,20,33792
Mvaa 204,236,56
buffer_load_dwordx4 v9, s[8:11], s51 offen offset:3072 lds
v_add_u32 v8, 524288, v8
v_add_u32 v9, 524288, v9
Mvaa 236,236,60
Mvaa 144,240,48
s_waitcnt lgkmcnt(6)
Ta 212,21,32768
Ta 214,21,33792
Mvaa 176,240,52
buffer_store_dwordx4 v[116:119], v2, s[24:27], s37 offen offset:3072 sc1
Mvaa 208,240,56
buffer_load_dwordx4 a[0:3], v10, s[20:23], s58 offen offset:0 sc1
Mvaa 240,240,60
Ta 216,22,32768
Ta 218,22,33792
Mvaa 148,244,48
Mvaa 180,244,52
Mvaa 212,244,56
Ta 220,23,32768
Ta 222,23,33792
Mvaa 244,244,60
buffer_load_dwordx4 a[4:7], v10, s[20:23], 0 offen offset:0 sc1
Mvaa 152,248,48
Mvaa 184,248,52
Mvaa 216,248,56
buffer_load_dwordx4 a[8:11], v11, s[20:23], s58 offen offset:0 sc1
Mvaa 248,248,60
Mvaa 156,252,48
Mvaa 188,252,52
buffer_load_dwordx4 a[12:15], v11, s[20:23], 0 offen offset:0 sc1
Mvaa 220,252,56
Mvaa 252,252,60
s_waitcnt vmcnt(40) lgkmcnt(0)
Mvaa 128,192,64
s_add_u32 s37, s38, 43008
Mvaa 160,192,68
Ta 224,16,40960
Ta 226,16,41984
Mvaa 192,192,72
buffer_load_dwordx4 a[16:19], v10, s[20:23], s58 offen offset:1024 sc1
Mvaa 224,192,76
buffer_store_dwordx4 v[120:123], v2, s[24:27], s37 offen offset:0 sc1
Mvaa 132,196,64
Ta 228,17,40960
Ta 230,17,41984
Mvaa 164,196,68
Mvaa 196,196,72
Mvaa 228,196,76
Ta 232,18,40960
Ta 234,18,41984
Mvaa 136,200,64
Mvaa 168,200,68
buffer_load_dwordx4 a[20:23], v10, s[20:23], 0 offen offset:1024 sc1
Mvaa 200,200,72
Ta 236,19,40960
Ta 238,19,41984
Mvaa 232,200,76
Mvaa 140,204,64
Mvaa 172,204,68
Ta 240,20,40960
Ta 242,20,41984
Mvaa 204,204,72
Mvaa 236,204,76
Mvaa 144,208,64
s_waitcnt lgkmcnt(6)
Ta 244,21,40960
Ta 246,21,41984
Mvaa 176,208,68
buffer_store_dwordx4 v[124:127], v2, s[24:27], s37 offen offset:1024 sc1
Mvaa 208,208,72
buffer_load_dwordx4 a[24:27], v11, s[20:23], s58 offen offset:1024 sc1
Mvaa 240,208,76
Ta 248,22,40960
Ta 250,22,41984
Mvaa 148,212,64
Mvaa 180,212,68
Mvaa 212,212,72
Ta 252,23,40960
Ta 254,23,41984
Mvaa 244,212,76
Mvaa 152,216,64
Mvaa 184,216,68
Mvaa 216,216,72
buffer_load_dwordx4 a[28:31], v11, s[20:23], 0 offen offset:1024 sc1
Mvaa 248,216,76
Mvaa 156,220,64
Mvaa 188,220,68
Mvaa 220,220,72
Mvaa 252,220,76
s_waitcnt vmcnt(36) lgkmcnt(0)
s_barrier
Mvaa 128,224,80
buffer_store_dwordx4 v[24:27], v2, s[24:27], s37 offen offset:2048 sc1
Mvaa 160,224,84
s_add_u32 m0, s44, 32768
Ta 192,16,49152
Ta 194,16,50176
Mvaa 192,224,88
buffer_load_dwordx4 v8, s[8:11], s48 offen offset:0 lds
Mvaa 224,224,92
Mvaa 132,228,80
Ta 196,17,49152
Ta 198,17,50176
Mvaa 164,228,84
buffer_load_dwordx4 v8, s[8:11], s49 offen offset:1024 lds
Mvaa 196,228,88
Mvaa 228,228,92
Ta 200,18,49152
Ta 202,18,50176
Mvaa 136,232,80
Mvaa 168,232,84
buffer_load_dwordx4 v9, s[8:11], s50 offen offset:2048 lds
Mvaa 200,232,88
Ta 204,19,49152
Ta 206,19,50176
Mvaa 232,232,92
Mvaa 140,236,80
Mvaa 172,236,84
Ta 208,20,49152
Ta 210,20,50176
Mvaa 204,236,88
buffer_load_dwordx4 v9, s[8:11], s51 offen offset:3072 lds
v_add_u32 v8, 524288, v8
v_add_u32 v9, 524288, v9
Mvaa 236,236,92
Mvaa 144,240,80
s_waitcnt lgkmcnt(6)
Ta 212,21,49152
Ta 214,21,50176
Mvaa 176,240,84
buffer_store_dwordx4 v[28:31], v2, s[24:27], s37 offen offset:3072 sc1
Mvaa 208,240,88
buffer_load_dwordx4 a[32:35], v10, s[20:23], s58 offen offset:2048 sc1
Mvaa 240,240,92
Ta 216,22,49152
Ta 218,22,50176
Mvaa 148,244,80
Mvaa 180,244,84
Mvaa 212,244,88
Ta 220,23,49152
Ta 222,23,50176
Mvaa 244,244,92
buffer_load_dwordx4 a[36:39], v10, s[20:23], 0 offen offset:2048 sc1
Mvaa 152,248,80
Mvaa 184,248,84
Mvaa 216,248,88
buffer_load_dwordx4 a[40:43], v11, s[20:23], s58 offen offset:2048 sc1
Mvaa 248,248,92
Mvaa 156,252,80
Mvaa 188,252,84
buffer_load_dwordx4 a[44:47], v11, s[20:23], 0 offen offset:2048 sc1
Mvaa 220,252,88
Mvaa 252,252,92
s_waitcnt vmcnt(32) lgkmcnt(0)
Mvaa 128,192,96
s_add_u32 s37, s38, 47104
Mvaa 160,192,100
Ta 224,16,57344
Ta 226,16,58368
Mvaa 192,192,104
buffer_load_dwordx4 a[48:51], v10, s[20:23], s58 offen offset:3072 sc1
Mvaa 224,192,108
buffer_store_dwordx4 v[32:35], v2, s[24:27], s37 offen offset:0 sc1
Mvaa 132,196,96
Ta 228,17,57344
Ta 230,17,58368
Mvaa 164,196,100
Mvaa 196,196,104
Mvaa 228,196,108
Ta 232,18,57344
Ta 234,18,58368
Mvaa 136,200,96
Mvaa 168,200,100
buffer_load_dwordx4 a[52:55], v10, s[20:23], 0 offen offset:3072 sc1
Mvaa 200,200,104
Ta 236,19,57344
Ta 238,19,58368
Mvaa 232,200,108
Mvaa 140,204,96
Mvaa 172,204,100
Ta 240,20,57344
Ta 242,20,58368
Mvaa 204,204,104
Mvaa 236,204,108
Mvaa 144,208,96
s_waitcnt lgkmcnt(6)
Ta 244,21,57344
Ta 246,21,58368
Mvaa 176,208,100
buffer_store_dwordx4 v[36:39], v2, s[24:27], s37 offen offset:1024 sc1
Mvaa 208,208,104
buffer_load_dwordx4 a[56:59], v11, s[20:23], s58 offen offset:3072 sc1
Mvaa 240,208,108
Ta 248,22,57344
Ta 250,22,58368
Mvaa 148,212,96
Mvaa 180,212,100
Mvaa 212,212,104
Ta 252,23,57344
Ta 254,23,58368
Mvaa 244,212,108
Mvaa 152,216,96
Mvaa 184,216,100
Mvaa 216,216,104
buffer_load_dwordx4 a[60:63], v11, s[20:23], 0 offen offset:3072 sc1
v_add_u32 v10, 4096, v10
v_add_u32 v11, 4096, v11
Mvaa 248,216,108
Mvaa 156,220,96
Mvaa 188,220,100
Mvaa 220,220,104
Mvaa 252,220,108
s_waitcnt vmcnt(32) lgkmcnt(0)
s_barrier
Mvaa 128,224,112
buffer_store_dwordx4 v[40:43], v2, s[24:27], s37 offen offset:2048 sc1
Mvaa 160,224,116
s_add_u32 m0, s44, 49152
Ta 192,16,0
Ta 194,16,1024
Mvaa 192,224,120
buffer_load_dwordx4 v8, s[8:11], s48 offen offset:0 lds
Mvaa 224,224,124
Mvaa 132,228,112
Ta 196,17,0
Ta 198,17,1024
Mvaa 164,228,116
buffer_load_dwordx4 v8, s[8:11], s49 offen offset:1024 lds
Mvaa 196,228,120
Mvaa 228,228,124
Ta 200,18,0
Ta 202,18,1024
Mvaa 136,232,112
Mvaa 168,232,116
buffer_load_dwordx4 v9, s[8:11], s50 offen offset:2048 lds
Mvaa 200,232,120
Ta 204,19,0
Ta 206,19,1024
Mvaa 232,232,124
Mvaa 140,236,112
Mvaa 172,236,116
Ta 208,20,0
Ta 210,20,1024
Mvaa 204,236,120
buffer_load_dwordx4 v9, s[8:11], s51 offen offset:3072 lds
v_add_u32 v8, 524288, v8
v_add_u32 v9, 524288, v9
Mvaa 236,236,124
Mvaa 144,240,112
s_waitcnt lgkmcnt(6)
Ta 212,21,0
Ta 214,21,1024
Mvaa 176,240,116
buffer_store_dwordx4 v[44:47], v2, s[24:27], s37 offen offset:3072 sc1
Mvaa 208,240,120
buffer_load_dwordx4 a[64:67], v10, s[20:23], s58 offen offset:0 sc1
Mvaa 240,240,124
Ta 216,22,0
Ta 218,22,1024
Mvaa 148,244,112
v_mov_b32 v12, 1
v_and_b32_e64 v1, 15, v0
Mvaa 180,244,116
v_lshlrev_b32_e64 v1, 2, v1
Mvaa 212,244,120
Ta 220,23,0
Ta 222,23,1024
Mvaa 244,244,124
buffer_load_dwordx4 a[68:71], v10, s[20:23], 0 offen offset:0 sc1
Mvaa 152,248,112
s_lshr_b32 s6, s33, 1
s_lshl_b32 s6, s6, 7
s_add_u32 s6, s6, 5296128
Mvaa 184,248,116
s_cmp_eq_u32 s32, 0
s_cselect_b32 s6, s6, 2146435072
Mvaa 216,248,120
buffer_load_dwordx4 a[72:75], v11, s[20:23], s58 offen offset:0 sc1
Mvaa 248,248,124
Mvaa 156,252,112
Mvaa 188,252,116
buffer_load_dwordx4 a[76:79], v11, s[20:23], 0 offen offset:0 sc1
Mvaa 220,252,120
Mvaa 252,252,124
s_waitcnt vmcnt(32) lgkmcnt(0)
Mvaa 128,192,0
Mvaa 160,192,4
Ta 224,16,8192
Ta 226,16,9216
Mvaa 192,192,8
buffer_load_dwordx4 a[80:83], v10, s[20:23], s58 offen offset:1024 sc1
Mvaa 224,192,12
Mvaa 132,196,0
Ta 228,17,8192
Ta 230,17,9216
Mvaa 164,196,4
Mvaa 196,196,8
Mvaa 228,196,12
Ta 232,18,8192
Ta 234,18,9216
Mvaa 136,200,0
Mvaa 168,200,4
buffer_load_dwordx4 a[84:87], v10, s[20:23], 0 offen offset:1024 sc1
Mvaa 200,200,8
Ta 236,19,8192
Ta 238,19,9216
Mvaa 232,200,12
Mvaa 140,204,0
Mvaa 172,204,4
Ta 240,20,8192
Ta 242,20,9216
Mvaa 204,204,8
Mvaa 236,204,12
Mvaa 144,208,0
s_waitcnt lgkmcnt(6)
Ta 244,21,8192
Ta 246,21,9216
Mvaa 176,208,4
v_max_u32 v14, v56, v57
v_min_u32_e64 v15, v56, v57
Mvaa 208,208,8
buffer_load_dwordx4 a[88:91], v11, s[20:23], s58 offen offset:1024 sc1
Mvaa 240,208,12
Ta 248,22,8192
Ta 250,22,9216
Mvaa 148,212,0
v_med3_u32 v15, v14, v15, v58
v_max_u32_e64 v14, v14, v58
Mvaa 180,212,4
v_med3_u32 v15, v14, v15, v59
v_max_u32_e64 v14, v14, v59
Mvaa 212,212,8
Ta 252,23,8192
Ta 254,23,9216
Mvaa 244,212,12
v_med3_u32 v15, v14, v15, v60
v_max_u32_e64 v14, v14, v60
Mvaa 152,216,0
v_med3_u32 v15, v14, v15, v61
v_max_u32_e64 v14, v14, v61
Mvaa 184,216,4
v_med3_u32 v15, v14, v15, v62
v_max_u32_e64 v14, v14, v62
Mvaa 216,216,8
buffer_load_dwordx4 a[92:95], v11, s[20:23], 0 offen offset:1024 sc1
Mvaa 248,216,12
v_med3_u32 v15, v14, v15, v63
v_max_u32_e64 v14, v14, v63
Mvaa 156,220,0
v_med3_u32 v15, v14, v15, v64
v_max_u32_e64 v14, v14, v64
Mvaa 188,220,4
v_med3_u32 v15, v14, v15, v65
v_max_u32_e64 v14, v14, v65
Mvaa 220,220,8
v_med3_u32 v15, v14, v15, v66
v_max_u32_e64 v14, v14, v66
Mvaa 252,220,12
v_med3_u32 v15, v14, v15, v67
v_max_u32 v14, v14, v67
s_waitcnt vmcnt(30) lgkmcnt(0)
s_barrier
Mvaa 128,224,16
v_med3_u32 v15, v14, v15, v68
v_max_u32 v14, v14, v68
Mvaa 160,224,20
s_add_u32 m0, s44, 0
Ta 192,16,16384
Ta 194,16,17408
Mvaa 192,224,24
buffer_load_dwordx4 v8, s[8:11], s48 offen offset:0 lds
Mvaa 224,224,28
v_med3_u32 v15, v14, v15, v69
v_max_u32 v14, v14, v69
Mvaa 132,228,16
Ta 196,17,16384
Ta 198,17,17408
Mvaa 164,228,20
buffer_load_dwordx4 v8, s[8:11], s49 offen offset:1024 lds
Mvaa 196,228,24
v_med3_u32 v15, v14, v15, v70
v_max_u32_e64 v14, v14, v70
Mvaa 228,228,28
Ta 200,18,16384
Ta 202,18,17408
Mvaa 136,232,16
v_med3_u32 v15, v14, v15, v71
v_max_u32_e64 v14, v14, v71
Mvaa 168,232,20
buffer_load_dwordx4 v9, s[8:11], s50 offen offset:2048 lds
Mvaa 200,232,24
Ta 204,19,16384
Ta 206,19,17408
Mvaa 232,232,28
v_med3_u32 v15, v14, v15, v72
v_max_u32_e64 v14, v14, v72
Mvaa 140,236,16
v_med3_u32 v15, v14, v15, v73
v_max_u32_e64 v14, v14, v73
Mvaa 172,236,20
Ta 208,20,16384
Ta 210,20,17408
Mvaa 204,236,24
buffer_load_dwordx4 v9, s[8:11], s51 offen offset:3072 lds
v_add_u32 v8, 524288, v8
v_add_u32 v9, 524288, v9
Mvaa 236,236,28
v_med3_u32 v15, v14, v15, v74
v_max_u32_e64 v14, v14, v74
Mvaa 144,240,16
s_waitcnt lgkmcnt(6)
Ta 212,21,16384
Ta 214,21,17408
Mvaa 176,240,20
v_med3_u32 v15, v14, v15, v75
v_max_u32 v14, v14, v75
Mvaa 208,240,24
buffer_load_dwordx4 a[96:99], v10, s[20:23], s58 offen offset:2048 sc1
Mvaa 240,240,28
Ta 216,22,16384
Ta 218,22,17408
Mvaa 148,244,16
v_med3_u32 v15, v14, v15, v76
v_max_u32_e64 v14, v14, v76
Mvaa 180,244,20
v_med3_u32 v15, v14, v15, v77
v_max_u32_e64 v14, v14, v77
Mvaa 212,244,24
Ta 220,23,16384
Ta 222,23,17408
Mvaa 244,244,28
buffer_load_dwordx4 a[100:103], v10, s[20:23], 0 offen offset:2048 sc1
Mvaa 152,248,16
v_med3_u32 v15, v14, v15, v78
v_max_u32_e64 v14, v14, v78
Mvaa 184,248,20
v_med3_u32 v15, v14, v15, v79
v_max_u32_e64 v14, v14, v79
Mvaa 216,248,24
buffer_load_dwordx4 a[104:107], v11, s[20:23], s58 offen offset:2048 sc1
Mvaa 248,248,28
v_med3_u32 v15, v14, v15, v80
v_max_u32_e64 v14, v14, v80
Mvaa 156,252,16
v_med3_u32 v15, v14, v15, v81
v_max_u32_e64 v14, v14, v81
Mvaa 188,252,20
buffer_load_dwordx4 a[108:111], v11, s[20:23], 0 offen offset:2048 sc1
Mvaa 220,252,24
v_med3_u32 v15, v14, v15, v82
v_max_u32_e64 v14, v14, v82
Mvaa 252,252,28
v_med3_u32 v15, v14, v15, v83
v_max_u32 v14, v14, v83
s_waitcnt vmcnt(28) lgkmcnt(0)
Mvaa 128,192,32
v_med3_u32 v15, v14, v15, v84
v_max_u32_e64 v14, v14, v84
Mvaa 160,192,36
Ta 224,16,24576
Ta 226,16,25600
Mvaa 192,192,40
buffer_load_dwordx4 a[112:115], v10, s[20:23], s58 offen offset:3072 sc1
Mvaa 224,192,44
v_med3_u32 v15, v14, v15, v85
v_max_u32_e64 v14, v14, v85
Mvaa 132,196,32
Ta 228,17,24576
Ta 230,17,25600
Mvaa 164,196,36
v_med3_u32 v15, v14, v15, v86
v_max_u32_e64 v14, v14, v86
Mvaa 196,196,40
v_med3_u32 v15, v14, v15, v87
v_max_u32_e64 v14, v14, v87
Mvaa 228,196,44
Ta 232,18,24576
Ta 234,18,25600
Mvaa 136,200,32
v_mov_b32_e64 v13, v14
Mvaa 168,200,36
buffer_load_dwordx4 a[116:119], v10, s[20:23], 0 offen offset:3072 sc1
Mvaa 200,200,40
Ta 236,19,24576
Ta 238,19,25600
Mvaa 232,200,44
v_max_u32_dpp v13, v13, v13 quad_perm:[1,0,3,2] row_mask:0xf bank_mask:0xf
Mvaa 140,204,32
s_nop 0
v_max_u32_dpp v13, v13, v13 quad_perm:[2,3,0,1] row_mask:0xf bank_mask:0xf
Mvaa 172,204,36
Ta 240,20,24576
Ta 242,20,25600
Mvaa 204,204,40
v_max_u32_dpp v13, v13, v13 row_half_mirror row_mask:0xf bank_mask:0xf
Mvaa 236,204,44
s_nop 0
v_max_u32_dpp v13, v13, v13 row_mirror row_mask:0xf bank_mask:0xf
Mvaa 144,208,32
s_waitcnt lgkmcnt(6)
Ta 244,21,24576
Ta 246,21,25600
Mvaa 176,208,36
v_readlane_b32 s3, v13, 0
v_readlane_b32 s47, v13, 16
Mvaa 208,208,40
buffer_load_dwordx4 a[120:123], v11, s[20:23], s58 offen offset:3072 sc1
Mvaa 240,208,44
Ta 248,22,24576
Ta 250,22,25600
Mvaa 148,212,32
v_readlane_b32 s4, v13, 32
v_readlane_b32 s5, v13, 48
Mvaa 180,212,36
s_max_u32 s3, s3, s47
s_max_u32 s4, s4, s5
s_max_u32 s40, s3, s4
Mvaa 212,212,40
Ta 252,23,24576
Ta 254,23,25600
Mvaa 244,212,44
v_cmp_eq_u32 vcc, s40, v14
Mvaa 152,216,32
s_nop 0
v_cndmask_b32 v13, v14, v15, vcc
Mvaa 184,216,36
s_nop 0
v_max_u32_dpp v13, v13, v13 quad_perm:[1,0,3,2] row_mask:0xf bank_mask:0xf
Mvaa 216,216,40
buffer_load_dwordx4 a[124:127], v11, s[20:23], 0 offen offset:3072 sc1
v_add_u32 v10, 4096, v10
v_add_u32 v11, 4096, v11
Mvaa 248,216,44
v_max_u32_dpp v13, v13, v13 quad_perm:[2,3,0,1] row_mask:0xf bank_mask:0xf
Mvaa 156,220,32
s_nop 0
v_max_u32_dpp v13, v13, v13 row_half_mirror row_mask:0xf bank_mask:0xf
Mvaa 188,220,36
s_nop 0
v_max_u32_dpp v13, v13, v13 row_mirror row_mask:0xf bank_mask:0xf
Mvaa 220,220,40
v_readlane_b32 s3, v13, 0
v_readlane_b32 s47, v13, 16
Mvaa 252,220,44
v_readlane_b32 s4, v13, 32
v_readlane_b32 s5, v13, 48
s_waitcnt vmcnt(26) lgkmcnt(0)
s_barrier
Mvaa 128,224,48
s_max_u32 s3, s3, s47
s_max_u32 s4, s4, s5
s_max_u32 s41, s3, s4
Mvaa 160,224,52
s_add_u32 m0, s44, 16384
Ta 192,16,32768
Ta 194,16,33792
Mvaa 192,224,56
buffer_load_dwordx4 v8, s[8:11], s48 offen offset:0 lds
Mvaa 224,224,60
s_and_b32 s3, s40, 0xffff
s_sub_u32 s42, 0xffff, s3
s_and_b32 s3, s41, 0xffff
Mvaa 132,228,48
Ta 196,17,32768
Ta 198,17,33792
Mvaa 164,228,52
buffer_load_dwordx4 v8, s[8:11], s49 offen offset:1024 lds
Mvaa 196,228,56
s_sub_u32 s43, 0xffff, s3
v_mov_b32 v60, s40
v_not_b32_e64 v61, v60
Mvaa 228,228,60
Ta 200,18,32768
Ta 202,18,33792
Mvaa 136,232,48
v_ashrrev_i32_e64 v61, 31, v61
v_or_b32 v61, 0x80000000, v61
Mvaa 168,232,52
buffer_load_dwordx4 v9, s[8:11], s50 offen offset:2048 lds
Mvaa 200,232,56
Ta 204,19,32768
Ta 206,19,33792
Mvaa 232,232,60
v_xor_b32_e64 v60, v60, v61
v_and_b32 v60, 0xffff0000, v60
Mvaa 140,236,48
v_mul_f32 v60, 0xbfb8aa3b, v60
Mvaa 172,236,52
Ta 208,20,32768
Ta 210,20,33792
Mvaa 204,236,56
buffer_load_dwordx4 v9, s[8:11], s51 offen offset:3072 lds
v_add_u32 v8, 524288, v8
v_add_u32 v9, 524288, v9
Mvaa 236,236,60
VE 60,60
Mvaa 144,240,48
s_waitcnt lgkmcnt(6)
Ta 212,21,32768
Ta 214,21,33792
Mvaa 176,240,52
v_add_f32 v60, 1.0, v60
Mvaa 208,240,56
buffer_load_dwordx4 a[0:3], v10, s[20:23], s58 offen offset:0 sc1
Mvaa 240,240,60
Ta 216,22,32768
Ta 218,22,33792
Mvaa 148,244,48
v_rcp_f32_e64 v60, v60
Mvaa 180,244,52
Vc 60,60,60
v_and_b32 v64, 0xffff0000, v60
Mvaa 212,244,56
Ta 220,23,32768
Ta 222,23,33792
Mvaa 244,244,60
buffer_load_dwordx4 a[4:7], v10, s[20:23], 0 offen offset:0 sc1
Mvaa 152,248,48
v_mov_b32 v60, s41
v_not_b32 v61, v60
Mvaa 184,248,52
v_ashrrev_i32_e64 v61, 31, v61
v_or_b32 v61, 0x80000000, v61
Mvaa 216,248,56
buffer_load_dwordx4 a[8:11], v11, s[20:23], s58 offen offset:0 sc1
Mvaa 248,248,60
v_xor_b32_e64 v60, v60, v61
v_and_b32 v60, 0xffff0000, v60
Mvaa 156,252,48
v_mul_f32 v60, 0xbfb8aa3b, v60
Mvaa 188,252,52
buffer_load_dwordx4 a[12:15], v11, s[20:23], 0 offen offset:0 sc1
Mvaa 220,252,56
VE 60,60
Mvaa 252,252,60
v_add_f32 v60, 1.0, v60
s_waitcnt vmcnt(24) lgkmcnt(0)
Mvaa 128,192,64
v_rcp_f32_e64 v60, v60
Mvaa 160,192,68
Ta 224,16,40960
Ta 226,16,41984
Mvaa 192,192,72
buffer_load_dwordx4 a[16:19], v10, s[20:23], s58 offen offset:1024 sc1
Mvaa 224,192,76
Vc 60,60,60
v_and_b32 v65, 0xffff0000, v60
Mvaa 132,196,64
Ta 228,17,40960
Ta 230,17,41984
Mvaa 164,196,68
v_mov_b32 v48, 0
v_mov_b32 v49, 0
Mvaa 196,196,72
v_mov_b32 v50, 0
v_mov_b32 v51, 0
Mvaa 228,196,76
Ta 232,18,40960
Ta 234,18,41984
Mvaa 136,200,64
v_mov_b32 v52, 0
v_mov_b32 v53, 0
Mvaa 168,200,68
buffer_load_dwordx4 a[20:23], v10, s[20:23], 0 offen offset:1024 sc1
Mvaa 200,200,72
Ta 236,19,40960
Ta 238,19,41984
Mvaa 232,200,76
v_mov_b32 v54, 0
v_mov_b32 v55, 0
Mvaa 140,204,64
v_mov_b32 v56, 0
v_mov_b32 v57, 0
Mvaa 172,204,68
Ta 240,20,40960
Ta 242,20,41984
Mvaa 204,204,72
v_mov_b32 v58, 0
v_mov_b32 v59, 0
Mvaa 236,204,76
v_mov_b32 v60, 0
v_mov_b32 v61, 0
Mvaa 144,208,64
s_waitcnt lgkmcnt(6)
Ta 244,21,40960
Ta 246,21,41984
Mvaa 176,208,68
v_mov_b32 v62, 0
v_mov_b32_e64 v63, 0
Mvaa 208,208,72
buffer_load_dwordx4 a[24:27], v11, s[20:23], s58 offen offset:1024 sc1
Mvaa 240,208,76
Ta 248,22,40960
Ta 250,22,41984
Mvaa 148,212,64
s_mul_i32 s3, s34, s34
s_mul_i32 s47, s33, 48
s_add_u32 s3, s3, s47
Mvaa 180,212,68
s_lshl_b32 s3, s3, 2
s_add_u32 s3, s3, s32
s_lshl_b32 s3, s3, 7
Mvaa 212,212,72
Ta 252,23,40960
Ta 254,23,41984
Mvaa 244,212,76
s_sub_u32 s3, s3, 8704
s_cmp_ge_u32 s34, 4
s_cselect_b32 s3, s3, 0
s_cselect_b32 s40, 512, 0
s_cselect_b32 s47, 786432, 0
Mvaa 152,216,64
v_subrev_u32_e64 v31, 0, v0
v_mul_lo_u32 v31, v31, s47
Mvaa 184,216,68
v_min_u32 v31, 6553600, v31
v_mov_b32_e64 v28, s94
Mvaa 216,216,72
buffer_load_dwordx4 a[28:31], v11, s[20:23], 0 offen offset:1024 sc1
Mvaa 248,216,76
v_mov_b32 v29, s95
v_mov_b32 v30, v31
Mvaa 156,220,64
v_subrev_u32_e64 v31, 10, v0
v_mul_lo_u32 v31, v31, s47
Mvaa 188,220,68
v_min_u32 v31, 3407872, v31
v_mov_b32_e64 v14, s100
Mvaa 220,220,72
v_mov_b32_e64 v15, s101
Mvaa 252,220,76
v_cmp_le_u32 vcc, 10, v0
s_waitcnt vmcnt(24) lgkmcnt(0)
s_barrier
Mvaa 128,224,80
s_mov_b64 exec, 1
buffer_store_dword v12, v7, s[20:23], s39 offen sc1
s_mov_b64 exec, -1
Mvaa 160,224,84
s_add_u32 m0, s44, 32768
Ta 192,16,49152
Ta 194,16,50176
Mvaa 192,224,88
buffer_load_dwordx4 v8, s[8:11], s48 offen offset:0 lds
Mvaa 224,224,92
v_cndmask_b32 v28, v28, v14, vcc
v_cndmask_b32 v29, v29, v15, vcc
Mvaa 132,228,80
Ta 196,17,49152
Ta 198,17,50176
Mvaa 164,228,84
buffer_load_dwordx4 v8, s[8:11], s49 offen offset:1024 lds
Mvaa 196,228,88
v_cndmask_b32 v30, v30, v31, vcc
Mvaa 228,228,92
Ta 200,18,49152
Ta 202,18,50176
Mvaa 136,232,80
v_subrev_u32_e64 v31, 16, v0
v_mul_lo_u32 v31, v31, s47
Mvaa 168,232,84
buffer_load_dwordx4 v9, s[8:11], s50 offen offset:2048 lds
Mvaa 200,232,88
Ta 204,19,49152
Ta 206,19,50176
Mvaa 232,232,92
v_min_u32 v31, 6553600, v31
v_mov_b32_e64 v14, s60
Mvaa 140,236,80
v_mov_b32_e64 v15, s61
Mvaa 172,236,84
Ta 208,20,49152
Ta 210,20,50176
Mvaa 204,236,88
buffer_load_dwordx4 v9, s[8:11], s51 offen offset:3072 lds
v_add_u32 v8, 524288, v8
v_add_u32 v9, 524288, v9
Mvaa 236,236,92
v_cmp_le_u32 vcc, 16, v0
Mvaa 144,240,80
s_waitcnt lgkmcnt(6)
Ta 212,21,49152
Ta 214,21,50176
Mvaa 176,240,84
v_cndmask_b32 v28, v28, v14, vcc
v_cndmask_b32 v29, v29, v15, vcc
Mvaa 208,240,88
buffer_load_dwordx4 a[32:35], v10, s[20:23], s58 offen offset:2048 sc1
Mvaa 240,240,92
Ta 216,22,49152
Ta 218,22,50176
Mvaa 148,244,80
v_cndmask_b32 v30, v30, v31, vcc
Mvaa 180,244,84
v_subrev_u32 v31, 26, v0
v_mul_lo_u32 v31, v31, s47
Mvaa 212,244,88
Ta 220,23,49152
Ta 222,23,50176
Mvaa 244,244,92
buffer_load_dwordx4 a[36:39], v10, s[20:23], 0 offen offset:2048 sc1
Mvaa 152,248,80
v_min_u32 v31, 6553600, v31
v_mov_b32_e64 v14, s68
Mvaa 184,248,84
v_mov_b32_e64 v15, s69
Mvaa 216,248,88
buffer_load_dwordx4 a[40:43], v11, s[20:23], s58 offen offset:2048 sc1
Mvaa 248,248,92
v_cmp_le_u32 vcc, 26, v0
Mvaa 156,252,80
s_nop 0
v_cndmask_b32 v28, v28, v14, vcc
v_cndmask_b32 v29, v29, v15, vcc
Mvaa 188,252,84
buffer_load_dwordx4 a[44:47], v11, s[20:23], 0 offen offset:2048 sc1
Mvaa 220,252,88
v_cndmask_b32 v30, v30, v31, vcc
Mvaa 252,252,92
v_subrev_u32 v31, 36, v0
v_mul_lo_u32 v31, v31, s47
s_waitcnt vmcnt(25) lgkmcnt(0)
Mvaa 128,192,96
v_min_u32 v31, 7602176, v31
v_mov_b32 v14, s92
Mvaa 160,192,100
Ta 224,16,57344
Ta 226,16,58368
Mvaa 192,192,104
buffer_load_dwordx4 a[48:51], v10, s[20:23], s58 offen offset:3072 sc1
Mvaa 224,192,108
v_mov_b32_e64 v15, s93
Mvaa 132,196,96
Ta 228,17,57344
Ta 230,17,58368
Mvaa 164,196,100
v_cmp_le_u32 vcc, 36, v0
Mvaa 196,196,104
s_nop 0
v_cndmask_b32 v28, v28, v14, vcc
v_cndmask_b32 v29, v29, v15, vcc
Mvaa 228,196,108
Ta 232,18,57344
Ta 234,18,58368
Mvaa 136,200,96
v_cndmask_b32 v30, v30, v31, vcc
Mvaa 168,200,100
buffer_load_dwordx4 a[52:55], v10, s[20:23], 0 offen offset:3072 sc1
Mvaa 200,200,104
Ta 236,19,57344
Ta 238,19,58368
Mvaa 232,200,108
v_add_u32 v30, s3, v30
v_ashrrev_i32_e64 v31, 31, v30
Mvaa 140,204,96
v_lshl_add_u64 v[28:29], v[30:31], 0, v[28:29]
Mvaa 172,204,100
Ta 240,20,57344
Ta 242,20,58368
Mvaa 204,204,104
s_mov_b32 s41, 0
v_readfirstlane_b32 s100, v64
v_readfirstlane_b32 s101, v65
Mvaa 236,204,108
s_mov_b32 s24, s60
s_mov_b32 s25, s61
s_mov_b32 s26, s62
Mvaa 144,208,96
s_waitcnt lgkmcnt(6)
Ta 244,21,57344
Ta 246,21,58368
Mvaa 176,208,100
s_add_u32 s3, s34, 7
s_and_b32 s3, s3, 7
s_lshl_b32 s3, s3, 5
Mvaa 208,208,104
buffer_load_dwordx4 a[56:59], v11, s[20:23], s58 offen offset:3072 sc1
Mvaa 240,208,108
Ta 248,22,57344
Ta 250,22,58368
Mvaa 148,212,96
s_add_u32 s3, s3, s33
s_mul_i32 s92, s3, 2341
s_lshr_b32 s92, s92, 16
Mvaa 180,212,100
s_mul_i32 s47, s92, 28
s_sub_u32 s4, s3, s47
s_mul_i32 s5, s92, 917504
Mvaa 212,212,104
Ta 252,23,57344
Ta 254,23,58368
Mvaa 244,212,108
s_lshl_b32 s47, s4, 8
s_add_u32 s5, s5, s47
s_mov_b32 s94, 1040356334
Mvaa 152,216,96
s_mov_b32 s95, 1040356334
s_sub_u32 s55, 15, s34
s_sub_u32 s45, s36, 3
Mvaa 184,216,100
s_sub_u32 s46, s35, 3
s_mov_b32 s54, s44
s_sub_u32 s35, s35, 2
Mvaa 216,216,104
buffer_load_dwordx4 a[60:63], v11, s[20:23], 0 offen offset:3072 sc1
v_add_u32 v10, 4096, v10
v_add_u32 v11, 4096, v11
Mvaa 248,216,108
s_sub_u32 s36, s36, 2
Mvaa 156,220,96
Mvaa 188,220,100
Mvaa 220,220,104
Mvaa 252,220,108
s_waitcnt vmcnt(25) lgkmcnt(0)
s_barrier
Mvaa 128,224,112
Mvaa 160,224,116
s_add_u32 m0, s44, 49152
Ta 192,16,0
Ta 194,16,1024
Mvaa 192,224,120
buffer_load_dwordx4 v8, s[8:11], s48 offen offset:0 lds
Mvaa 224,224,124
Mvaa 132,228,112
Ta 196,17,0
Ta 198,17,1024
Mvaa 164,228,116
buffer_load_dwordx4 v8, s[8:11], s49 offen offset:1024 lds
Mvaa 196,228,120
Mvaa 228,228,124
Ta 200,18,0
Ta 202,18,1024
Mvaa 136,232,112
Mvaa 168,232,116
buffer_load_dwordx4 v9, s[8:11], s50 offen offset:2048 lds
Mvaa 200,232,120
Ta 204,19,0
Ta 206,19,1024
Mvaa 232,232,124
Mvaa 140,236,112
Mvaa 172,236,116
Ta 208,20,0
Ta 210,20,1024
Mvaa 204,236,120
buffer_load_dwordx4 v9, s[8:11], s51 offen offset:3072 lds
v_add_u32 v8, 524288, v8
v_add_u32 v9, 524288, v9
Mvaa 236,236,124
Mvaa 144,240,112
s_waitcnt lgkmcnt(6)
Ta 212,21,0
Ta 214,21,1024
Mvaa 176,240,116
Mvaa 208,240,120
buffer_load_dwordx4 a[64:67], v10, s[20:23], s58 offen offset:0 sc1
Mvaa 240,240,124
Ta 216,22,0
Ta 218,22,1024
Mvaa 148,244,112
Mvaa 180,244,116
Mvaa 212,244,120
Ta 220,23,0
Ta 222,23,1024
Mvaa 244,244,124
buffer_load_dwordx4 a[68:71], v10, s[20:23], 0 offen offset:0 sc1
Mvaa 152,248,112
Mvaa 184,248,116
Mvaa 216,248,120
buffer_load_dwordx4 a[72:75], v11, s[20:23], s58 offen offset:0 sc1
Mvaa 248,248,124
Mvaa 156,252,112
Mvaa 188,252,116
buffer_load_dwordx4 a[76:79], v11, s[20:23], 0 offen offset:0 sc1
Mvaa 220,252,120
Mvaa 252,252,124
s_waitcnt vmcnt(25) lgkmcnt(0)
Mvaa 128,192,0
Mvaa 160,192,4
Ta 224,16,8192
Ta 226,16,9216
Mvaa 192,192,8
buffer_load_dwordx4 a[80:83], v10, s[20:23], s58 offen offset:1024 sc1
Mvaa 224,192,12
Mvaa 132,196,0
Ta 228,17,8192
Ta 230,17,9216
Mvaa 164,196,4
Mvaa 196,196,8
Mvaa 228,196,12
Ta 232,18,8192
Ta 234,18,9216
Mvaa 136,200,0
Mvaa 168,200,4
buffer_load_dwordx4 a[84:87], v10, s[20:23], 0 offen offset:1024 sc1
Mvaa 200,200,8
Ta 236,19,8192
Ta 238,19,9216
Mvaa 232,200,12
Mvaa 140,204,0
Mvaa 172,204,4
Ta 240,20,8192
Ta 242,20,9216
Mvaa 204,204,8
Mvaa 236,204,12
Mvaa 144,208,0
s_waitcnt lgkmcnt(6)
Ta 244,21,8192
Ta 246,21,9216
Mvaa 176,208,4
Mvaa 208,208,8
buffer_load_dwordx4 a[88:91], v11, s[20:23], s58 offen offset:1024 sc1
Mvaa 240,208,12
Ta 248,22,8192
Ta 250,22,9216
Mvaa 148,212,0
Mvaa 180,212,4
Mvaa 212,212,8
Ta 252,23,8192
Ta 254,23,9216
Mvaa 244,212,12
Mvaa 152,216,0
Mvaa 184,216,4
Mvaa 216,216,8
buffer_load_dwordx4 a[92:95], v11, s[20:23], 0 offen offset:1024 sc1
Mvaa 248,216,12
Mvaa 156,220,0
Mvaa 188,220,4
Mvaa 220,220,8
Mvaa 252,220,12
s_waitcnt vmcnt(25) lgkmcnt(0)
s_barrier
Mvaa 128,224,16
v_accvgpr_write_b32 a0, 0
v_accvgpr_write_b32 a1, 0
Mvaa 160,224,20
Ta 192,16,16384
Ta 194,16,17408
Mvaa 192,224,24
buffer_load_dwordx4 a[96:99], v10, s[20:23], s58 offen offset:2048 sc1
Mvaa 224,224,28
v_accvgpr_write_b32 a2, 0
v_accvgpr_write_b32 a3, 0
Mvaa 132,228,16
Ta 196,17,16384
Ta 198,17,17408
Mvaa 164,228,20
v_accvgpr_write_b32 a4, 0
v_accvgpr_write_b32 a5, 0
Mvaa 196,228,24
v_accvgpr_write_b32 a6, 0
v_accvgpr_write_b32 a7, 0
Mvaa 228,228,28
Ta 200,18,16384
Ta 202,18,17408
Mvaa 136,232,16
v_accvgpr_write_b32 a8, 0
v_accvgpr_write_b32 a9, 0
Mvaa 168,232,20
buffer_load_dwordx4 a[100:103], v10, s[20:23], 0 offen offset:2048 sc1
Mvaa 200,232,24
Ta 204,19,16384
Ta 206,19,17408
Mvaa 232,232,28
v_accvgpr_write_b32 a10, 0
v_accvgpr_write_b32 a11, 0
Mvaa 140,236,16
v_accvgpr_write_b32 a12, 0
v_accvgpr_write_b32 a13, 0
Mvaa 172,236,20
Ta 208,20,16384
Ta 210,20,17408
Mvaa 204,236,24
v_accvgpr_write_b32 a14, 0
v_accvgpr_write_b32 a15, 0
Mvaa 236,236,28
Mvaa 144,240,16
s_waitcnt lgkmcnt(6)
Ta 212,21,16384
Ta 214,21,17408
Mvaa 176,240,20
Mvaa 208,240,24
buffer_load_dwordx4 a[104:107], v11, s[20:23], s58 offen offset:2048 sc1
Mvaa 240,240,28
Ta 216,22,16384
Ta 218,22,17408
Mvaa 148,244,16
Mvaa 180,244,20
Mvaa 212,244,24
Ta 220,23,16384
Ta 222,23,17408
Mvaa 244,244,28
Mvaa 152,248,16
Mvaa 184,248,20
Mvaa 216,248,24
buffer_load_dwordx4 a[108:111], v11, s[20:23], 0 offen offset:2048 sc1
Mvaa 248,248,28
Mvaa 156,252,16
Mvaa 188,252,20
Mvaa 220,252,24
Mvaa 252,252,28
s_waitcnt vmcnt(20) lgkmcnt(0)
Mvaa 128,192,32
v_accvgpr_write_b32 a16, 0
v_accvgpr_write_b32 a17, 0
Mvaa 160,192,36
Ta 224,16,24576
Ta 226,16,25600
Mvaa 192,192,40
buffer_load_dwordx4 a[112:115], v10, s[20:23], s58 offen offset:3072 sc1
Mvaa 224,192,44
v_accvgpr_write_b32 a18, 0
v_accvgpr_write_b32 a19, 0
Mvaa 132,196,32
Ta 228,17,24576
Ta 230,17,25600
Mvaa 164,196,36
v_accvgpr_write_b32 a20, 0
v_accvgpr_write_b32 a21, 0
Mvaa 196,196,40
v_accvgpr_write_b32 a22, 0
v_accvgpr_write_b32 a23, 0
Mvaa 228,196,44
Ta 232,18,24576
Ta 234,18,25600
Mvaa 136,200,32
v_accvgpr_write_b32 a24, 0
v_accvgpr_write_b32 a25, 0
Mvaa 168,200,36
buffer_load_dwordx4 a[116:119], v10, s[20:23], 0 offen offset:3072 sc1
Mvaa 200,200,40
Ta 236,19,24576
Ta 238,19,25600
Mvaa 232,200,44
v_accvgpr_write_b32 a26, 0
v_accvgpr_write_b32 a27, 0
Mvaa 140,204,32
v_accvgpr_write_b32 a28, 0
v_accvgpr_write_b32 a29, 0
Mvaa 172,204,36
Ta 240,20,24576
Ta 242,20,25600
Mvaa 204,204,40
v_accvgpr_write_b32 a30, 0
v_accvgpr_write_b32 a31, 0
Mvaa 236,204,44
Mvaa 144,208,32
s_waitcnt lgkmcnt(6)
Ta 244,21,24576
Ta 246,21,25600
Mvaa 176,208,36
buffer_load_dword v12, v1, s[20:23], s6 offen sc1
Mvaa 208,208,40
buffer_load_dwordx4 a[120:123], v11, s[20:23], s58 offen offset:3072 sc1
Mvaa 240,208,44
Ta 248,22,24576
Ta 250,22,25600
Mvaa 148,212,32
s_add_u32 m0, s44, 65536
s_mov_b32 s7, 0
Mvaa 180,212,36
Mvaa 212,212,40
Ta 252,23,24576
Ta 254,23,25600
Mvaa 244,212,44
Mvaa 152,216,32
Mvaa 184,216,36
Mvaa 216,216,40
buffer_load_dwordx4 a[124:127], v11, s[20:23], 0 offen offset:3072 sc1
v_add_u32 v10, 4096, v10
v_add_u32 v11, 4096, v11
Mvaa 248,216,44
Mvaa 156,220,32
Mvaa 188,220,36
Mvaa 220,220,40
Mvaa 252,220,44
s_waitcnt vmcnt(21) lgkmcnt(0)
s_barrier
Mvaa 128,224,48
v_accvgpr_write_b32 a32, 0
v_accvgpr_write_b32 a33, 0
Mvaa 160,224,52
Ta 192,16,32768
Ta 194,16,33792
Mvaa 192,224,56
v_accvgpr_write_b32 a34, 0
v_accvgpr_write_b32 a35, 0
Mvaa 224,224,60
v_accvgpr_write_b32 a36, 0
v_accvgpr_write_b32 a37, 0
Mvaa 132,228,48
Ta 196,17,32768
Ta 198,17,33792
Mvaa 164,228,52
v_accvgpr_write_b32 a38, 0
v_accvgpr_write_b32 a39, 0
Mvaa 196,228,56
v_accvgpr_write_b32 a40, 0
v_accvgpr_write_b32 a41, 0
Mvaa 228,228,60
Ta 200,18,32768
Ta 202,18,33792
Mvaa 136,232,48
v_accvgpr_write_b32 a42, 0
v_accvgpr_write_b32 a43, 0
Mvaa 168,232,52
v_accvgpr_write_b32 a44, 0
v_accvgpr_write_b32 a45, 0
Mvaa 200,232,56
Ta 204,19,32768
Ta 206,19,33792
Mvaa 232,232,60
v_accvgpr_write_b32 a46, 0
v_accvgpr_write_b32 a47, 0
Mvaa 140,236,48
Mvaa 172,236,52
Ta 208,20,32768
Ta 210,20,33792
Mvaa 204,236,56
Mvaa 236,236,60
Mvaa 144,240,48
s_waitcnt lgkmcnt(6)
Ta 212,21,32768
Ta 214,21,33792
Mvaa 176,240,52
Mvaa 208,240,56
Mvaa 240,240,60
Ta 216,22,32768
Ta 218,22,33792
Mvaa 148,244,48
Mvaa 180,244,52
Mvaa 212,244,56
Ta 220,23,32768
Ta 222,23,33792
Mvaa 244,244,60
Mvaa 152,248,48
Mvaa 184,248,52
Mvaa 216,248,56
Mvaa 248,248,60
Mvaa 156,252,48
Mvaa 188,252,52
Mvaa 220,252,56
Mvaa 252,252,60
s_waitcnt vmcnt(13) lgkmcnt(0)
Mvaa 128,192,64
v_accvgpr_write_b32 a48, 0
v_accvgpr_write_b32 a49, 0
Mvaa 160,192,68
Ta 224,16,40960
Ta 226,16,41984
Mvaa 192,192,72
v_accvgpr_write_b32 a50, 0
v_accvgpr_write_b32 a51, 0
Mvaa 224,192,76
v_accvgpr_write_b32 a52, 0
v_accvgpr_write_b32 a53, 0
Mvaa 132,196,64
Ta 228,17,40960
Ta 230,17,41984
Mvaa 164,196,68
v_accvgpr_write_b32 a54, 0
v_accvgpr_write_b32 a55, 0
Mvaa 196,196,72
v_accvgpr_write_b32 a56, 0
v_accvgpr_write_b32 a57, 0
Mvaa 228,196,76
Ta 232,18,40960
Ta 234,18,41984
Mvaa 136,200,64
v_accvgpr_write_b32 a58, 0
v_accvgpr_write_b32 a59, 0
Mvaa 168,200,68
v_accvgpr_write_b32 a60, 0
v_accvgpr_write_b32 a61, 0
Mvaa 200,200,72
Ta 236,19,40960
Ta 238,19,41984
Mvaa 232,200,76
v_accvgpr_write_b32 a62, 0
v_accvgpr_write_b32 a63, 0
Mvaa 140,204,64
Mvaa 172,204,68
Ta 240,20,40960
Ta 242,20,41984
Mvaa 204,204,72
Mvaa 236,204,76
Mvaa 144,208,64
s_waitcnt lgkmcnt(6)
Ta 244,21,40960
Ta 246,21,41984
Mvaa 176,208,68
Mvaa 208,208,72
Mvaa 240,208,76
Ta 248,22,40960
Ta 250,22,41984
Mvaa 148,212,64
Mvaa 180,212,68
Mvaa 212,212,72
Ta 252,23,40960
Ta 254,23,41984
Mvaa 244,212,76
Mvaa 152,216,64
Mvaa 184,216,68
Mvaa 216,216,72
Mvaa 248,216,76
Mvaa 156,220,64
Mvaa 188,220,68
Mvaa 220,220,72
Mvaa 252,220,76
s_waitcnt vmcnt(2) lgkmcnt(0)
s_cmp_lg_u32 s32, 0
s_cbranch_scc1 L_spinBr
v_cmp_ne_u32 vcc, 1, v12
s_cbranch_vccnz L_spinB
L_spinBr:
s_barrier
Mvaa 128,224,80
buffer_load_dwordx4 v4, s[12:15], s7 offen offset:0 sc1 lds
Mvaa 160,224,84
Ta 192,16,49152
Ta 194,16,50176
Mvaa 192,224,88
v_accvgpr_write_b32 a64, 0
v_accvgpr_write_b32 a65, 0
Mvaa 224,224,92
buffer_load_dwordx4 v4, s[12:15], s7 offen offset:1024 sc1 lds
Mvaa 132,228,80
Ta 196,17,49152
Ta 198,17,50176
Mvaa 164,228,84
v_accvgpr_write_b32 a66, 0
v_accvgpr_write_b32 a67, 0
Mvaa 196,228,88
buffer_load_dwordx4 v4, s[12:15], s7 offen offset:2048 sc1 lds
Mvaa 228,228,92
Ta 200,18,49152
Ta 202,18,50176
Mvaa 136,232,80
v_accvgpr_write_b32 a68, 0
v_accvgpr_write_b32 a69, 0
Mvaa 168,232,84
buffer_load_dwordx4 v4, s[12:15], s7 offen offset:3072 sc1 lds
Mvaa 200,232,88
Ta 204,19,49152
Ta 206,19,50176
Mvaa 232,232,92
s_add_u32 m0, s44, 98304
s_mov_b32 s7, 34816
Mvaa 140,236,80
buffer_load_dwordx4 v4, s[12:15], s7 offen offset:0 sc1 lds
Mvaa 172,236,84
Ta 208,20,49152
Ta 210,20,50176
Mvaa 204,236,88
v_accvgpr_write_b32 a70, 0
v_accvgpr_write_b32 a71, 0
Mvaa 236,236,92
buffer_load_dwordx4 v4, s[12:15], s7 offen offset:1024 sc1 lds
Mvaa 144,240,80
s_waitcnt lgkmcnt(6)
Ta 212,21,49152
Ta 214,21,50176
Mvaa 176,240,84
v_accvgpr_write_b32 a72, 0
v_accvgpr_write_b32 a73, 0
Mvaa 208,240,88
buffer_load_dwordx4 v4, s[12:15], s7 offen offset:2048 sc1 lds
Mvaa 240,240,92
Ta 216,22,49152
Ta 218,22,50176
Mvaa 148,244,80
v_accvgpr_write_b32 a74, 0
v_accvgpr_write_b32 a75, 0
Mvaa 180,244,84
buffer_load_dwordx4 v4, s[12:15], s7 offen offset:3072 sc1 lds
Mvaa 212,244,88
Ta 220,23,49152
Ta 222,23,50176
Mvaa 244,244,92
s_add_u32 m0, s44, 81920
s_mov_b32 s7, 17408
Mvaa 152,248,80
buffer_load_dwordx4 v4, s[12:15], s7 offen offset:0 sc1 lds
Mvaa 184,248,84
v_accvgpr_write_b32 a76, 0
v_accvgpr_write_b32 a77, 0
Mvaa 216,248,88
buffer_load_dwordx4 v4, s[12:15], s7 offen offset:1024 sc1 lds
Mvaa 248,248,92
v_accvgpr_write_b32 a78, 0
v_accvgpr_write_b32 a79, 0
Mvaa 156,252,80
Mvaa 188,252,84
buffer_load_dwordx4 v4, s[12:15], s7 offen offset:2048 sc1 lds
Mvaa 220,252,88
Mvaa 252,252,92
s_waitcnt lgkmcnt(0)
Mvaa 128,192,96
buffer_load_dwordx4 v4, s[12:15], s7 offen offset:3072 sc1 lds
Mvaa 160,192,100
Ta 224,16,57344
Ta 226,16,58368
Mvaa 192,192,104
s_add_u32 m0, s44, 114688
s_mov_b32 s7, 52224
Mvaa 224,192,108
buffer_load_dwordx4 v4, s[12:15], s7 offen offset:0 sc1 lds
Mvaa 132,196,96
Ta 228,17,57344
Ta 230,17,58368
Mvaa 164,196,100
v_accvgpr_write_b32 a80, 0
v_accvgpr_write_b32 a81, 0
Mvaa 196,196,104
buffer_load_dwordx4 v4, s[12:15], s7 offen offset:1024 sc1 lds
Mvaa 228,196,108
Ta 232,18,57344
Ta 234,18,58368
Mvaa 136,200,96
v_accvgpr_write_b32 a82, 0
v_accvgpr_write_b32 a83, 0
Mvaa 168,200,100
buffer_load_dwordx4 v4, s[12:15], s7 offen offset:2048 sc1 lds
Mvaa 200,200,104
Ta 236,19,57344
Ta 238,19,58368
Mvaa 232,200,108
v_accvgpr_write_b32 a84, 0
v_accvgpr_write_b32 a85, 0
Mvaa 140,204,96
buffer_load_dwordx4 v4, s[12:15], s7 offen offset:3072 sc1 lds
Mvaa 172,204,100
Ta 240,20,57344
Ta 242,20,58368
Mvaa 204,204,104
s_add_u32 m0, s44, 0
s_mov_b32 s7, 69632
Mvaa 236,204,108
buffer_load_dwordx4 v4, s[12:15], s7 offen offset:0 sc1 lds
Mvaa 144,208,96
s_waitcnt lgkmcnt(6)
Ta 244,21,57344
Ta 246,21,58368
Mvaa 176,208,100
buffer_load_dwordx4 v4, s[12:15], s7 offen offset:1024 sc1 lds
Mvaa 208,208,104
v_accvgpr_write_b32 a86, 0
v_accvgpr_write_b32 a87, 0
Mvaa 240,208,108
Ta 248,22,57344
Ta 250,22,58368
Mvaa 148,212,96
buffer_load_dwordx4 v4, s[12:15], s7 offen offset:2048 sc1 lds
Mvaa 180,212,100
v_accvgpr_write_b32 a88, 0
v_accvgpr_write_b32 a89, 0
Mvaa 212,212,104
Ta 252,23,57344
Ta 254,23,58368
Mvaa 244,212,108
buffer_load_dwordx4 v4, s[12:15], s7 offen offset:3072 sc1 lds
Mvaa 152,216,96
s_add_u32 m0, s44, 16384
s_mov_b32 s7, 87040
Mvaa 184,216,100
v_accvgpr_write_b32 a90, 0
v_accvgpr_write_b32 a91, 0
Mvaa 216,216,104
buffer_load_dwordx4 v4, s[12:15], s7 offen offset:0 sc1 lds
Mvaa 248,216,108
v_accvgpr_write_b32 a92, 0
v_accvgpr_write_b32 a93, 0
Mvaa 156,220,96
v_accvgpr_write_b32 a94, 0
v_accvgpr_write_b32 a95, 0
Mvaa 188,220,100
buffer_load_dwordx4 v4, s[12:15], s7 offen offset:1024 sc1 lds
Mvaa 220,220,104
Mvaa 252,220,108
s_waitcnt vmcnt(18) lgkmcnt(0)
s_barrier
Mvaa 128,224,112
buffer_load_dwordx4 v4, s[12:15], s7 offen offset:2048 sc1 lds
Mvaa 132,228,112
Ra 192,3,0
Ra 196,3,1024
Mvaa 136,232,112
Ra 200,3,2048
Ra 204,3,3072
Mvaa 140,236,112
buffer_load_dwordx4 v4, s[12:15], s7 offen offset:3072 sc1 lds
Mvaa 144,240,112
s_add_u32 m0, s44, 32768
s_mov_b32 s7, 104448
Mvaa 148,244,112
Ra 208,3,4096
Ra 212,3,5120
Mvaa 152,248,112
buffer_load_dwordx4 v4, s[12:15], s7 offen offset:0 sc1 lds
Mvaa 156,252,112
Ra 216,3,6144
Ra 220,3,7168
Mvaa 160,224,116
buffer_load_dwordx4 v4, s[12:15], s7 offen offset:1024 sc1 lds
Mvaa 164,228,116
Mvaa 168,232,116
Mvaa 172,236,116
buffer_load_dwordx4 v4, s[12:15], s7 offen offset:2048 sc1 lds
Mvaa 176,240,116
v_mul_f32 v128, s94, v128
v_mul_f32 v129, s94, v129
Mvaa 180,244,116
v_mul_f32 v130, s94, v130
v_mul_f32 v131, s94, v131
Mvaa 184,248,116
buffer_load_dwordx4 v4, s[12:15], s7 offen offset:3072 sc1 lds
Mvaa 188,252,116
v_mul_f32 v132, s94, v132
v_mul_f32 v133, s94, v133
Mvaa 192,224,120
v_mul_f32 v134, s94, v134
v_mul_f32 v135, s94, v135
Mvaa 196,228,120
Vc 128,128,129
Vc 129,130,131
Mvaa 200,232,120
Vc 130,132,133
Vc 131,134,135
Mvaa 204,236,120
Aw 128,128
Aw 129,129
Mvaa 208,240,120
Aw 130,130
Aw 131,131
Mvaa 212,244,120
v_mul_f32 v136, s94, v136
v_mul_f32 v137, s94, v137
Mvaa 216,248,120
v_mul_f32 v138, s94, v138
v_mul_f32 v139, s94, v139
Mvaa 220,252,120
v_mul_f32 v140, s94, v140
v_mul_f32 v141, s94, v141
Mvaa 224,224,124
v_mul_f32 v142, s94, v142
v_mul_f32 v143, s94, v143
Mvaa 228,228,124
Vc 136,136,137
Vc 137,138,139
Mvaa 232,232,124
Vc 138,140,141
Vc 139,142,143
Mvaa 236,236,124
Aw 132,136
Aw 133,137
Mvaa 240,240,124
Aw 134,138
Aw 135,139
Mvaa 244,244,124
v_mul_f32 v144, s94, v144
v_mul_f32 v145, s94, v145
Mvaa 248,248,124
v_mul_f32 v146, s94, v146
v_mul_f32 v147, s94, v147
Mvaa 252,252,124
v_mul_f32 v148, s94, v148
v_mul_f32 v149, s94, v149
Ra 224,3,8192
Ra 228,3,9216
Ra 232,3,10240
Ra 236,3,11264
Ra 240,3,12288
Ra 244,3,13312
Ra 248,3,14336
s_waitcnt lgkmcnt(9)
Ra 252,3,15360
v_mul_f32 v150, s94, v150
v_mul_f32_e64 v151, s94, v151
Vc 144,144,145
Vc 145,146,147
Vc 146,148,149
Vc 147,150,151
Aw 136,144
Aw 137,145
Aw 138,146
Aw 139,147
v_mul_f32 v152, s94, v152
v_mul_f32 v153, s94, v153
v_mul_f32 v154, s94, v154
v_mul_f32 v155, s94, v155
v_mul_f32 v156, s94, v156
v_mul_f32 v157, s94, v157
v_mul_f32 v158, s94, v158
v_mul_f32 v159, s94, v159
Vc 152,152,153
Vc 153,154,155
Vc 154,156,157
Vc 155,158,159
Aw 140,152
Aw 141,153
Aw 142,154
Aw 143,155
Zvaa 128,192,128
v_mul_f32 v160, s94, v160
v_mul_f32 v161, s94, v161
v_mul_f32 v162, s94, v162
v_mul_f32 v163, s94, v163
Mvaa 128,196,132
v_mul_f32 v164, s94, v164
v_mul_f32 v165, s94, v165
v_mul_f32 v166, s94, v166
v_mul_f32 v167, s94, v167
Mvaa 128,200,136
Vc 160,160,161
Vc 161,162,163
Vc 162,164,165
Vc 163,166,167
Mvaa 128,204,140
Aw 144,160
Aw 145,161
Aw 146,162
Aw 147,163
s_waitcnt lgkmcnt(8)
Zvaa 132,208,128
v_mul_f32 v168, s94, v168
v_mul_f32 v169, s94, v169
v_mul_f32 v170, s94, v170
v_mul_f32_e64 v171, s94, v171
Mvaa 132,212,132
v_mul_f32 v172, s94, v172
v_mul_f32 v173, s94, v173
v_mul_f32 v174, s94, v174
v_mul_f32 v175, s94, v175
Mvaa 132,216,136
Vc 168,168,169
Vc 169,170,171
Vc 170,172,173
Vc 171,174,175
Mvaa 132,220,140
Aw 148,168
Aw 149,169
Aw 150,170
Aw 151,171
s_waitcnt lgkmcnt(4)
Zvaa 136,224,128
v_mul_f32 v176, s94, v176
v_mul_f32 v177, s94, v177
v_mul_f32 v178, s94, v178
v_mul_f32_e64 v179, s94, v179
Mvaa 136,228,132
v_mul_f32 v180, s94, v180
v_mul_f32 v181, s94, v181
v_mul_f32 v182, s94, v182
v_mul_f32 v183, s94, v183
Mvaa 136,232,136
Vc 176,176,177
Vc 177,178,179
Vc 178,180,181
Vc 179,182,183
Mvaa 136,236,140
Aw 152,176
Aw 153,177
Aw 154,178
Aw 155,179
s_waitcnt lgkmcnt(0)
Zvaa 140,240,128
v_mul_f32 v184, s94, v184
v_mul_f32 v185, s94, v185
v_mul_f32 v186, s94, v186
v_mul_f32_e64 v187, s94, v187
Mvaa 140,244,132
v_mul_f32 v188, s94, v188
v_mul_f32 v189, s94, v189
v_mul_f32 v190, s94, v190
v_mul_f32 v191, s94, v191
Mvaa 140,248,136
Vc 184,184,185
Vc 185,186,187
Vc 186,188,189
Vc 187,190,191
Mvaa 140,252,140
Aw 156,184
Aw 157,185
Aw 158,186
Aw 159,187
Zvaa 144,192,144
v_mul_f32 v192, s94, v192
v_mul_f32 v193, s94, v193
v_mul_f32 v194, s94, v194
v_mul_f32 v195, s94, v195
Mvaa 144,196,148
v_mul_f32 v196, s94, v196
v_mul_f32 v197, s94, v197
v_mul_f32 v198, s94, v198
v_mul_f32 v199, s94, v199
Mvaa 144,200,152
Vc 192,192,193
Vc 193,194,195
Vc 194,196,197
Vc 195,198,199
Mvaa 144,204,156
Aw 160,192
Aw 161,193
Aw 162,194
Aw 163,195
Zvaa 148,208,144
v_mul_f32 v200, s94, v200
v_mul_f32 v201, s94, v201
v_mul_f32 v202, s94, v202
v_mul_f32 v203, s94, v203
Mvaa 148,212,148
v_mul_f32 v204, s94, v204
v_mul_f32 v205, s94, v205
v_mul_f32 v206, s94, v206
v_mul_f32 v207, s94, v207
Mvaa 148,216,152
Vc 200,200,201
Vc 201,202,203
Vc 202,204,205
Vc 203,206,207
Mvaa 148,220,156
Aw 164,200
Aw 165,201
Aw 166,202
Aw 167,203
Zvaa 152,224,144
v_mul_f32 v208, s94, v208
v_mul_f32 v209, s94, v209
v_mul_f32 v210, s94, v210
v_mul_f32 v211, s94, v211
Mvaa 152,228,148
v_mul_f32 v212, s94, v212
v_mul_f32 v213, s94, v213
v_mul_f32 v214, s94, v214
v_mul_f32 v215, s94, v215
Mvaa 152,232,152
Vc 208,208,209
Vc 209,210,211
Vc 210,212,213
Vc 211,214,215
Mvaa 152,236,156
Aw 168,208
Aw 169,209
Aw 170,210
Aw 171,211
Zvaa 156,240,144
v_mul_f32 v216, s94, v216
v_mul_f32 v217, s94, v217
v_mul_f32 v218, s94, v218
v_mul_f32 v219, s94, v219
Mvaa 156,244,148
v_mul_f32 v220, s94, v220
v_mul_f32 v221, s94, v221
v_mul_f32 v222, s94, v222
v_mul_f32 v223, s94, v223
Mvaa 156,248,152
Vc 216,216,217
Vc 217,218,219
Vc 218,220,221
Vc 219,222,223
Mvaa 156,252,156
Aw 172,216
Aw 173,217
Aw 174,218
Aw 175,219
Zvaa 160,192,160
v_mul_f32 v224, s94, v224
v_mul_f32 v225, s94, v225
v_mul_f32 v226, s94, v226
v_mul_f32 v227, s94, v227
Mvaa 160,196,164
v_mul_f32 v228, s94, v228
v_mul_f32 v229, s94, v229
v_mul_f32 v230, s94, v230
v_mul_f32 v231, s94, v231
Mvaa 160,200,168
Vc 224,224,225
Vc 225,226,227
Vc 226,228,229
Vc 227,230,231
Mvaa 160,204,172
Aw 176,224
Aw 177,225
Aw 178,226
Aw 179,227
Zvaa 164,208,160
v_mul_f32 v232, s94, v232
v_mul_f32 v233, s94, v233
v_mul_f32 v234, s94, v234
v_mul_f32 v235, s94, v235
Mvaa 164,212,164
v_mul_f32 v236, s94, v236
v_mul_f32 v237, s94, v237
v_mul_f32 v238, s94, v238
v_mul_f32 v239, s94, v239
Mvaa 164,216,168
Vc 232,232,233
Vc 233,234,235
Vc 234,236,237
Vc 235,238,239
Mvaa 164,220,172
Aw 180,232
Aw 181,233
Aw 182,234
Aw 183,235
Zvaa 168,224,160
v_mul_f32 v240, s94, v240
v_mul_f32 v241, s94, v241
v_mul_f32 v242, s94, v242
v_mul_f32 v243, s94, v243
Mvaa 168,228,164
v_mul_f32 v244, s94, v244
v_mul_f32 v245, s94, v245
v_mul_f32 v246, s94, v246
v_mul_f32 v247, s94, v247
Mvaa 168,232,168
Vc 240,240,241
Vc 241,242,243
Vc 242,244,245
Vc 243,246,247
Mvaa 168,236,172
Aw 184,240
Aw 185,241
Aw 186,242
Aw 187,243
Zvaa 172,240,160
v_mul_f32 v248, s94, v248
v_mul_f32 v249, s94, v249
v_mul_f32 v250, s94, v250
v_mul_f32 v251, s94, v251
Mvaa 172,244,164
v_mul_f32 v252, s94, v252
v_mul_f32 v253, s94, v253
v_mul_f32 v254, s94, v254
v_mul_f32 v255, s94, v255
Mvaa 172,248,168
Vc 248,248,249
Vc 249,250,251
Vc 250,252,253
Vc 251,254,255
Mvaa 172,252,172
Aw 188,248
Aw 189,249
Aw 190,250
Aw 191,251
Zvaa 176,192,176
v_accvgpr_write_b32 a96, 0
v_accvgpr_write_b32 a97, 0
v_accvgpr_write_b32 a98, 0
v_accvgpr_write_b32 a99, 0
Mvaa 176,196,180
v_accvgpr_write_b32 a100, 0
v_accvgpr_write_b32 a101, 0
v_accvgpr_write_b32 a102, 0
v_accvgpr_write_b32 a103, 0
Mvaa 176,200,184
v_accvgpr_write_b32 a104, 0
v_accvgpr_write_b32 a105, 0
v_accvgpr_write_b32 a106, 0
v_accvgpr_write_b32 a107, 0
Mvaa 176,204,188
v_accvgpr_write_b32 a108, 0
v_accvgpr_write_b32 a109, 0
v_accvgpr_write_b32 a110, 0
v_accvgpr_write_b32 a111, 0
Zvaa 180,208,176
v_accvgpr_write_b32 a112, 0
v_accvgpr_write_b32 a113, 0
v_accvgpr_write_b32 a114, 0
v_accvgpr_write_b32 a115, 0
Mvaa 180,212,180
v_accvgpr_write_b32 a116, 0
v_accvgpr_write_b32 a117, 0
v_accvgpr_write_b32 a118, 0
v_accvgpr_write_b32 a119, 0
Mvaa 180,216,184
v_accvgpr_write_b32 a120, 0
v_accvgpr_write_b32 a121, 0
v_accvgpr_write_b32 a122, 0
v_accvgpr_write_b32 a123, 0
Mvaa 180,220,188
v_accvgpr_write_b32 a124, 0
v_accvgpr_write_b32 a125, 0
v_accvgpr_write_b32 a126, 0
v_accvgpr_write_b32 a127, 0
s_waitcnt vmcnt(16)
s_barrier
s_add_u32 s53, s44, 65536
Zvaa 184,224,176
Ra 192,3,32768
v_mov_b32 v16, 0x3f803f80
v_mov_b32 v17, 0x3f803f80
v_mov_b32 v18, 0x3f803f80
v_mov_b32 v19, 0x3f803f80
Mvaa 184,228,180
Ra 196,3,33792
v_mov_b32 v20, 0xff800000
v_max3_f32 v22, v128, v129, v130
v_max3_f32 v22, v22, v131, v132
v_max3_f32 v22, v22, v133, v134
Mvaa 184,232,184
Ra 200,3,34816
v_max3_f32 v22, v22, v135, v136
v_max3_f32 v22, v22, v137, v138
v_max3_f32 v22, v22, v139, v140
v_max3_f32 v22, v22, v141, v142
Mvaa 184,236,188
Ra 204,3,35840
v_max_f32 v22, v22, v143
v_mov_b32 v1, v22
s_nop 1
v_permlane16_swap_b32 v1, v22
v_max_f32_e64 v22, v22, v1
Zvaa 188,240,176
Ra 208,3,36864
v_mov_b32 v1, v22
s_nop 1
v_permlane32_swap_b32 v1, v22
v_max_f32 v22, v22, v1
v_add_f32 v22, 0x41f80000, v22
Mvaa 188,244,180
Ra 212,3,37888
Vs 128,128,22
Vs 129,129,22
Vs 130,130,22
Vs 131,131,22
Mvaa 188,248,184
Ra 216,3,38912
Vs 132,132,22
Vs 133,133,22
Vs 134,134,22
Vs 135,135,22
Mvaa 188,252,188
Ra 220,3,39936
Vs 136,136,22
Vs 137,137,22
Vs 138,138,22
Vs 139,139,22
Vs 140,140,22
Vs 141,141,22
Vs 142,142,22
Vs 143,143,22
v_sub_f32 v32, 0, v22
v_sub_f32 v33, 0, v22
v_sub_f32 v34, 0, v22
v_sub_f32 v35, 0, v22
v_max3_f32 v22, v144, v145, v146
v_max3_f32 v22, v22, v147, v148
v_max3_f32 v22, v22, v149, v150
v_max3_f32 v22, v22, v151, v152
v_max3_f32 v22, v22, v153, v154
v_max3_f32 v22, v22, v155, v156
v_max3_f32 v22, v22, v157, v158
v_max_f32 v22, v22, v159
v_mov_b32 v1, v22
s_nop 1
v_permlane16_swap_b32 v1, v22
v_max_f32 v22, v22, v1
v_mov_b32 v1, v22
s_nop 1
v_permlane32_swap_b32 v1, v22
v_max_f32_e64 v22, v22, v1
v_add_f32 v22, 0x41f80000, v22
Vs 144,144,22
Vs 145,145,22
Vs 146,146,22
Vs 147,147,22
Vs 148,148,22
Vs 149,149,22
Vs 150,150,22
Vs 151,151,22
Vs 152,152,22
Vs 153,153,22
Vs 154,154,22
Vs 155,155,22
Vs 156,156,22
Vs 157,157,22
Vs 158,158,22
Vs 159,159,22
v_sub_f32 v36, 0, v22
v_sub_f32 v37, 0, v22
v_sub_f32 v38, 0, v22
v_sub_f32 v39, 0, v22
s_mov_b32 s38, 139264
s_mov_b32 s39, 121856
s_cmp_lg_u32 s34, 0
s_cbranch_scc1 L_k2_nomask0
v_cmp_gt_i32 s[56:57], 0, v5
v_cmp_gt_i32 s[58:59], 1, v5
v_cmp_gt_i32 s[60:61], 2, v5
v_cmp_gt_i32 s[62:63], 3, v5
s_nop 3
s_nop 0
v_cndmask_b32 v176, v176, v20, s[56:57]
v_cndmask_b32 v177, v177, v20, s[58:59]
v_cndmask_b32 v178, v178, v20, s[60:61]
v_cndmask_b32 v179, v179, v20, s[62:63]
v_cmp_gt_i32 s[56:57], 16, v5
v_cmp_gt_i32 s[58:59], 17, v5
v_cmp_gt_i32 s[60:61], 18, v5
v_cmp_gt_i32 s[62:63], 19, v5
v_cndmask_b32 v180, v180, v20, s[56:57]
v_cndmask_b32 v181, v181, v20, s[58:59]
v_cndmask_b32 v182, v182, v20, s[60:61]
v_cndmask_b32 v183, v183, v20, s[62:63]
v_cmp_gt_i32 s[56:57], 32, v5
v_cmp_gt_i32 s[58:59], 33, v5
v_cmp_gt_i32 s[60:61], 34, v5
v_cmp_gt_i32 s[62:63], 35, v5
v_cndmask_b32 v184, v184, v20, s[56:57]
v_cndmask_b32 v185, v185, v20, s[58:59]
v_cndmask_b32 v186, v186, v20, s[60:61]
v_cndmask_b32 v187, v187, v20, s[62:63]
v_cmp_gt_i32 s[56:57], 48, v5
v_cmp_gt_i32 s[58:59], 49, v5
v_cmp_gt_i32 s[60:61], 50, v5
v_cmp_gt_i32 s[62:63], 51, v5
v_cndmask_b32 v188, v188, v20, s[56:57]
v_cndmask_b32 v189, v189, v20, s[58:59]
v_cndmask_b32 v190, v190, v20, s[60:61]
v_cndmask_b32 v191, v191, v20, s[62:63]
L_k2_nomask0:
s_mov_b32 s37, 0
s_nop 0
v_max3_f32 v22, v160, v161, v162
v_max3_f32 v22, v22, v163, v164
v_max3_f32 v22, v22, v165, v166
v_max3_f32 v22, v22, v167, v168
v_max3_f32 v22, v22, v169, v170
v_max3_f32 v22, v22, v171, v172
v_max3_f32 v22, v22, v173, v174
v_max_f32 v22, v22, v175
v_mov_b32 v1, v22
s_nop 1
v_permlane16_swap_b32 v1, v22
v_max_f32 v22, v22, v1
v_mov_b32 v1, v22
s_nop 1
v_permlane32_swap_b32 v1, v22
v_max_f32_e64 v22, v22, v1
v_add_f32 v22, 0x41f80000, v22
Vs 160,160,22
Vs 161,161,22
Vs 162,162,22
Vs 163,163,22
Vs 164,164,22
Vs 165,165,22
Vs 166,166,22
Vs 167,167,22
Vs 168,168,22
Vs 169,169,22
Vs 170,170,22
Vs 171,171,22
Vs 172,172,22
Vs 173,173,22
Vs 174,174,22
Vs 175,175,22
v_sub_f32 v40, 0, v22
v_sub_f32 v41, 0, v22
v_sub_f32 v42, 0, v22
v_sub_f32 v43, 0, v22
v_max3_f32 v22, v176, v177, v178
v_max3_f32 v22, v22, v179, v180
v_max3_f32 v22, v22, v181, v182
v_max3_f32 v22, v22, v183, v184
v_max3_f32 v22, v22, v185, v186
v_max3_f32 v22, v22, v187, v188
v_max3_f32 v22, v22, v189, v190
v_max_f32 v22, v22, v191
v_mov_b32 v1, v22
s_nop 1
v_permlane16_swap_b32 v1, v22
v_max_f32 v22, v22, v1
v_mov_b32 v1, v22
s_nop 1
v_permlane32_swap_b32 v1, v22
v_max_f32_e64 v22, v22, v1
v_add_f32 v22, 0x41f80000, v22
Vs 176,176,22
Vs 177,177,22
Vs 178,178,22
Vs 179,179,22
Vs 180,180,22
Vs 181,181,22
Vs 182,182,22
Vs 183,183,22
Vs 184,184,22
Vs 185,185,22
Vs 186,186,22
Vs 187,187,22
Vs 188,188,22
Vs 189,189,22
Vs 190,190,22
Vs 191,191,22
v_sub_f32 v44, 0, v22
v_sub_f32 v45, 0, v22
v_sub_f32 v46, 0, v22
v_sub_f32 v47, 0, v22
Ve 8,128
Ve 9,129
Ve 10,130
Ve 11,131
Vc 64,8,9
Ve 12,144
Ve 13,145
Vc 65,10,11
Ve 14,146
Ve 15,147
Vc 72,12,13
Ve 8,160
Ve 9,161
Vc 73,14,15
Ve 10,162
Ve 11,163
Vc 80,8,9
Ve 12,176
Ve 13,177
Vc 81,10,11
Ve 14,178
Ve 15,179
Vc 88,12,13
Ve 8,132
Ve 9,133
Vc 89,14,15
Ve 10,134
Ve 11,135
Vc 66,8,9
Ve 12,148
Ve 13,149
Vc 67,10,11
Ve 14,150
Ve 15,151
Vc 74,12,13
Ve 8,164
Ve 9,165
Vc 75,14,15
Ve 10,166
Ve 11,167
Vc 82,8,9
Ve 12,180
Ve 13,181
Vc 83,10,11
Ve 14,182
Ve 15,183
Vc 90,12,13
Vc 91,14,15
v_or_b32_e64 v7, v64, v65
v_or3_b32 v7, v7, v72, v73
v_or3_b32 v7, v7, v80, v81
v_or3_b32 v7, v7, v88, v89
v_or3_b32 v7, v7, v66, v67
v_or3_b32 v7, v7, v74, v75
v_or3_b32 v7, v7, v82, v83
v_or3_b32 v7, v7, v90, v91
s_waitcnt lgkmcnt(4)
s_cmp_eq_u32 s34, 0
s_cbranch_scc1 L_k2_wlast
L_k2_wloop:
v_xor_b32 v2, 65536, v2
v_xor_b32 v3, 65536, v3
Cvaa 192,192,128,32
s_mov_b32 m0, s53
Ra 224,2,40960
v_lshl_add_u64 v[28:29], s[40:41], 0, v[28:29]
Mvaa 192,196,132
buffer_load_dwordx4 v4, s[12:15], s38 offen offset:0 sc1 lds
Mvaa 192,200,136
VE 8,136
Mvaa 192,204,140
VE 9,137
Cvaa 208,192,144,36
Ra 228,2,41984
Vc 68,8,9
Mvaa 208,196,148
VE 10,138
Mvaa 208,200,152
VE 11,139
Mvaa 208,204,156
Ra 232,2,43008
Vc 69,10,11
Cvaa 224,192,160,40
Ra 236,2,44032
v_or3_b32 v7, v7, v68, v69
Mvaa 224,196,164
VE 12,152
Mvaa 224,200,168
VE 13,153
Mvaa 224,204,172
Ra 240,2,45056
Vc 76,12,13
Cvaa 240,192,176,44
VE 14,154
Mvaa 240,196,180
VE 15,155
Mvaa 240,200,184
Ra 244,2,46080
Vc 77,14,15
Mvaa 240,204,188
s_waitcnt lgkmcnt(6)
Ra 248,2,47104
v_or3_b32 v7, v7, v76, v77
Cvaa 196,208,128,32
buffer_load_dwordx4 v4, s[12:15], s38 offen offset:1024 sc1 lds
Mvaa 196,212,132
Ve 8,168
Mvaa 196,216,136
VE 9,169
Mvaa 196,220,140
Ra 252,2,48128
Vc 84,8,9
Cvaa 212,208,144,36
VE 10,170
Mvaa 212,212,148
VE 11,171
Mvaa 212,216,152
Ra 192,2,16384
Vc 85,10,11
Mvaa 212,220,156
Ra 196,2,17408
v_or3_b32 v7, v7, v84, v85
Cvaa 228,208,160,40
VE 12,184
Mvaa 228,212,164
VE 13,185
Mvaa 228,216,168
Ra 200,2,18432
Vc 92,12,13
Mvaa 228,220,172
VE 14,186
Cvaa 244,208,176,44
VE 15,187
Mvaa 244,212,180
buffer_load_dwordx4 v4, s[12:15], s38 offen offset:2048 sc1 lds
Mvaa 244,216,184
Ra 204,2,19456
Vc 93,14,15
Mvaa 244,220,188
s_waitcnt lgkmcnt(8)
Ve 8,140
Cvaa 200,224,128,32
Ra 208,2,20480
v_or3_b32 v7, v7, v92, v93
Mvaa 200,228,132
VE 9,141
Mvaa 200,232,136
Ra 212,2,21504
Vc 70,8,9
Mvaa 200,236,140
VE 10,142
Cvaa 216,224,144,36
VE 11,143
Mvaa 216,228,148
Ra 216,2,22528
Vc 71,10,11
Mvaa 216,232,152
Ra 220,2,23552
v_or3_b32 v7, v7, v70, v71
Mvaa 216,236,156
VE 12,156
Cvaa 232,224,160,40
VE 13,157
Mvaa 232,228,164
VE 14,158
Mvaa 232,232,168
VE 15,159
Mvaa 232,236,172
buffer_load_dwordx4 v4, s[12:15], s38 offen offset:3072 sc1 lds
Cvaa 248,224,176,44
VE 8,172
Mvaa 248,228,180
VE 9,173
Mvaa 248,232,184
Vc 78,12,13
Vc 79,14,15
Mvaa 248,236,188
s_waitcnt lgkmcnt(8)
Ve 10,174
Cvaa 204,240,128,32
VE 11,175
Mvaa 204,244,132
Vc 86,8,9
Vc 87,10,11
Mvaa 204,248,136
VE 12,188
Mvaa 204,252,140
VE 13,189
Cvaa 220,240,144,36
Vc 94,12,13
v_or3_b32 v7, v7, v78, v79
Mvaa 220,244,148
VE 14,190
Mvaa 220,248,152
VE 15,191
Mvaa 220,252,156
Vc 95,14,15
v_or3_b32 v7, v7, v86, v87
Cvaa 236,240,160,40
v_or3_b32 v7, v7, v94, v95
v_and_b32 v1, 0x40004000, v7
Mvaa 236,244,164
v_cmp_ne_u32 vcc, 0, v1
Mvaa 236,248,168
Mvaa 236,252,172
s_waitcnt vmcnt(12)
Cvaa 252,240,176,44
Mvaa 252,244,180
s_barrier
Mvaa 252,248,184
s_waitcnt lgkmcnt(4)
Mvaa 252,252,188
s_cbranch_vccnz L_k2_fb_we
L_k2_fbr_we:
Maav 0,192,64
Ve 8,192
Maav 0,196,68
s_add_u32 m0, s54, 49152
VE 9,193
Maav 32,192,72
buffer_load_dwordx4 v4, s[12:15], s39 offen offset:0 sc1 lds
Maav 32,196,76
s_add_u32 s37, s37, 1
Ra 224,2,24576
Vc 96,8,9
Maav 64,192,80
s_add_u32 s38, s38, 34816
Ve 10,194
Maav 64,196,84
VE 11,195
Maav 96,192,88
Ra 228,2,25600
Vc 97,10,11
Maav 96,196,92
Ra 232,2,26624
v_or_b32_e64 v7, v96, v97
Maav 4,200,64
VE 12,208
Maav 4,204,68
VE 13,209
Maav 36,200,72
Ra 236,2,27648
Vc 104,12,13
Maav 36,204,76
VE 14,210
Maav 68,200,80
VE 15,211
Maav 68,204,84
Ra 240,2,28672
Vc 105,14,15
Maav 100,200,88
Ra 244,2,29696
v_or3_b32 v7, v7, v104, v105
Maav 100,204,92
buffer_load_dwordx4 v4, s[12:15], s39 offen offset:1024 sc1 lds
Mvvv 48,16,64
VE 8,224
Mvvv 48,16,68
s_waitcnt lgkmcnt(6)
Ve 9,225
Maav 8,208,64
Ra 248,2,30720
Vc 112,8,9
Maav 8,212,68
VE 10,226
Maav 40,208,72
VE 11,227
Maav 40,212,76
Ra 252,2,31744
Vc 113,10,11
Maav 72,208,80
Ra 192,3,0
v_or3_b32 v7, v7, v112, v113
Maav 72,212,84
VE 12,240
Maav 104,208,88
VE 13,241
Maav 104,212,92
Ra 196,3,1024
Vc 120,12,13
Maav 12,216,64
VE 14,242
Maav 12,220,68
VE 15,243
Maav 44,216,72
Ra 200,3,2048
Vc 121,14,15
Maav 44,220,76
buffer_load_dwordx4 v4, s[12:15], s39 offen offset:2048 sc1 lds
Maav 76,216,80
Ra 204,3,3072
v_or3_b32 v7, v7, v120, v121
Maav 76,220,84
VE 8,196
Maav 108,216,88
VE 9,197
Maav 108,220,92
VE 10,198
Mvvv 52,16,72
VE 11,199
Mvvv 52,16,76
s_waitcnt lgkmcnt(8)
Ve 12,212
Maav 16,224,64
Ra 208,3,4096
Vc 98,8,9
Maav 16,228,68
Ra 212,3,5120
Vc 99,10,11
Maav 48,224,72
Ra 216,3,6144
v_or3_b32 v7, v7, v98, v99
Maav 48,228,76
VE 13,213
Maav 80,224,80
Ra 220,3,7168
Vc 106,12,13
Maav 80,228,84
VE 14,214
Maav 112,224,88
buffer_load_dwordx4 v4, s[12:15], s39 offen offset:3072 sc1 lds
Maav 112,228,92
s_add_u32 s39, s39, 34816
VE 15,215
Maav 20,232,64
VE 8,228
Maav 20,236,68
VE 9,229
Maav 52,232,72
VE 10,230
Maav 52,236,76
VE 11,231
Maav 84,232,80
Vc 107,14,15
Vc 114,8,9
Maav 84,236,84
VE 12,244
Maav 116,232,88
VE 13,245
Maav 116,236,92
Vc 115,10,11
Vc 122,12,13
Mvvv 56,16,80
VE 14,246
Mvvv 56,16,84
s_waitcnt lgkmcnt(8)
Ve 15,247
Maav 24,240,64
Vc 123,14,15
v_or3_b32 v7, v7, v106, v107
Maav 24,244,68
v_or3_b32 v7, v7, v114, v115
v_or3_b32 v7, v7, v122, v123
Maav 56,240,72
global_load_dword v30, v[28:29], off
Maav 56,244,76
Maav 88,240,80
Maav 88,244,84
Maav 120,240,88
Maav 120,244,92
Maav 28,248,64
Maav 28,252,68
Maav 60,248,72
Maav 60,252,76
Maav 92,248,80
Maav 92,252,84
Maav 124,248,88
Maav 124,252,92
Mvvv 60,16,88
s_waitcnt lgkmcnt(4)
Mvvv 60,16,92
Ve 8,200
Cvaa 128,192,128,32
s_add_u32 m0, s53, 32768
Ra 224,3,8192
v_lshl_add_u64 v[28:29], s[40:41], 0, v[28:29]
Mvaa 128,196,132
buffer_load_dwordx4 v4, s[12:15], s38 offen offset:0 sc1 lds
Mvaa 128,200,136
VE 9,201
Mvaa 128,204,140
Ra 228,3,9216
Vc 100,8,9
Cvaa 144,192,144,36
VE 10,202
Mvaa 144,196,148
VE 11,203
Mvaa 144,200,152
Ra 232,3,10240
Vc 101,10,11
Mvaa 144,204,156
Ra 236,3,11264
v_or3_b32 v7, v7, v100, v101
Cvaa 160,192,160,40
VE 12,216
Mvaa 160,196,164
VE 13,217
Mvaa 160,200,168
Ra 240,3,12288
Vc 108,12,13
Mvaa 160,204,172
VE 14,218
Cvaa 176,192,176,44
VE 15,219
Mvaa 176,196,180
Ra 244,3,13312
Vc 109,14,15
Mvaa 176,200,184
Ra 248,3,14336
v_or3_b32 v7, v7, v108, v109
Mvaa 176,204,188
s_waitcnt lgkmcnt(7)
Ve 8,232
Cvaa 132,208,128,32
buffer_load_dwordx4 v4, s[12:15], s38 offen offset:1024 sc1 lds
Mvaa 132,212,132
VE 9,233
Mvaa 132,216,136
Ra 252,3,15360
Vc 116,8,9
Mvaa 132,220,140
VE 10,234
Cvaa 148,208,144,36
VE 11,235
Mvaa 148,212,148
Ra 192,2,49152
Vc 117,10,11
Mvaa 148,216,152
Ra 196,2,50176
v_or3_b32 v7, v7, v116, v117
Mvaa 148,220,156
VE 12,248
Cvaa 164,208,160,40
VE 13,249
Mvaa 164,212,164
Ra 200,2,51200
Vc 124,12,13
Mvaa 164,216,168
VE 14,250
Mvaa 164,220,172
VE 15,251
Cvaa 180,208,176,44
Ra 204,2,52224
Vc 125,14,15
Mvaa 180,212,180
buffer_load_dwordx4 v4, s[12:15], s38 offen offset:2048 sc1 lds
Mvaa 180,216,184
VE 8,204
Mvaa 180,220,188
s_waitcnt lgkmcnt(8)
Ve 9,205
Cvaa 136,224,128,32
Ra 208,2,53248
Vc 102,8,9
Mvaa 136,228,132
Ra 212,2,54272
v_or3_b32 v7, v7, v124, v125
Mvaa 136,232,136
VE 10,206
Mvaa 136,236,140
VE 11,207
Cvaa 152,224,144,36
Ra 216,2,55296
Vc 103,10,11
Mvaa 152,228,148
Ra 220,2,56320
v_or3_b32 v7, v7, v102, v103
Mvaa 152,232,152
VE 12,220
Mvaa 152,236,156
VE 13,221
Cvaa 168,224,160,40
VE 14,222
Mvaa 168,228,164
VE 15,223
Mvaa 168,232,168
VE 8,236
Mvaa 168,236,172
buffer_load_dwordx4 v4, s[12:15], s38 offen offset:3072 sc1 lds
Cvaa 184,224,176,44
VE 9,237
Mvaa 184,228,180
Vc 110,12,13
Vc 111,14,15
Mvaa 184,232,184
VE 10,238
Mvaa 184,236,188
s_waitcnt lgkmcnt(8)
Ve 11,239
Cvaa 140,240,128,32
Vc 118,8,9
Vc 119,10,11
Mvaa 140,244,132
VE 12,252
Mvaa 140,248,136
VE 13,253
Mvaa 140,252,140
Vc 126,12,13
v_or3_b32 v7, v7, v110, v111
Cvaa 156,240,144,36
VE 14,254
Mvaa 156,244,148
VE 15,255
Mvaa 156,248,152
Vc 127,14,15
v_or3_b32 v7, v7, v118, v119
Mvaa 156,252,156
v_or3_b32 v7, v7, v126, v127
v_and_b32 v1, 0x40004000, v7
Cvaa 172,240,160,40
v_cmp_ne_u32 vcc, 0, v1
Mvaa 172,244,164
Mvaa 172,248,168
Mvaa 172,252,172
s_waitcnt vmcnt(12)
Cvaa 188,240,176,44
s_cmp_eq_u32 s37, s46
Mvaa 188,244,180
s_barrier
Mvaa 188,248,184
s_waitcnt lgkmcnt(4)
Mvaa 188,252,188
s_cbranch_vccnz L_k2_fb_wo
L_k2_fbr_wo:
Maav 0,192,96
s_cbranch_scc1 L_k2_mk_wo
L_k2_mkr_wo:
Ve 8,128
Maav 0,196,100
s_add_u32 m0, s53, 16384
VE 9,129
Maav 32,192,104
buffer_load_dwordx4 v4, s[12:15], s39 offen offset:0 sc1 lds
Maav 32,196,108
s_add_u32 s37, s37, 1
Ra 224,2,57344
Vc 64,8,9
Maav 64,192,112
s_add_u32 s38, s38, 34816
Ve 10,130
Maav 64,196,116
s_xor_b32 s53, s53, 65536
VE 11,131
Maav 96,192,120
s_xor_b32 s54, s54, 65536
Ra 228,2,58368
Vc 65,10,11
Maav 96,196,124
Ra 232,2,59392
v_or_b32_e64 v7, v64, v65
Maav 4,200,96
VE 12,144
Maav 4,204,100
VE 13,145
Maav 36,200,104
Ra 236,2,60416
Vc 72,12,13
Maav 36,204,108
VE 14,146
Maav 68,200,112
VE 15,147
Maav 68,204,116
Ra 240,2,61440
Vc 73,14,15
Maav 100,200,120
Ra 244,2,62464
v_or3_b32 v7, v7, v72, v73
Maav 100,204,124
buffer_load_dwordx4 v4, s[12:15], s39 offen offset:1024 sc1 lds
Mvvv 48,16,96
VE 8,160
Mvvv 48,16,100
s_waitcnt lgkmcnt(6)
Ve 9,161
Maav 8,208,96
Ra 248,2,63488
Vc 80,8,9
Maav 8,212,100
VE 10,162
Maav 40,208,104
VE 11,163
Maav 40,212,108
Ra 252,2,64512
Vc 81,10,11
Maav 72,208,112
Ra 192,3,32768
v_or3_b32 v7, v7, v80, v81
Maav 72,212,116
VE 12,176
Maav 104,208,120
VE 13,177
Maav 104,212,124
Ra 196,3,33792
Vc 88,12,13
Maav 12,216,96
VE 14,178
Maav 12,220,100
VE 15,179
Maav 44,216,104
Ra 200,3,34816
Vc 89,14,15
Maav 44,220,108
buffer_load_dwordx4 v4, s[12:15], s39 offen offset:2048 sc1 lds
Maav 76,216,112
Ra 204,3,35840
v_or3_b32 v7, v7, v88, v89
Maav 76,220,116
VE 8,132
Maav 108,216,120
VE 9,133
Maav 108,220,124
VE 10,134
Mvvv 52,16,104
VE 11,135
Mvvv 52,16,108
s_waitcnt lgkmcnt(8)
Ve 12,148
Maav 16,224,96
Ra 208,3,36864
Vc 66,8,9
Maav 16,228,100
Ra 212,3,37888
Vc 67,10,11
Maav 48,224,104
Ra 216,3,38912
v_or3_b32 v7, v7, v66, v67
Maav 48,228,108
VE 13,149
Maav 80,224,112
Ra 220,3,39936
Vc 74,12,13
Maav 80,228,116
VE 14,150
Maav 112,224,120
buffer_load_dwordx4 v4, s[12:15], s39 offen offset:3072 sc1 lds
Maav 112,228,124
s_add_u32 s39, s39, 34816
VE 15,151
Maav 20,232,96
VE 8,164
Maav 20,236,100
VE 9,165
Maav 52,232,104
VE 10,166
Maav 52,236,108
VE 11,167
Maav 84,232,112
Vc 75,14,15
Vc 82,8,9
Maav 84,236,116
VE 12,180
Maav 116,232,120
VE 13,181
Maav 116,236,124
Vc 83,10,11
Vc 90,12,13
Mvvv 56,16,112
VE 14,182
Mvvv 56,16,116
s_waitcnt lgkmcnt(8)
Ve 15,183
Maav 24,240,96
Vc 91,14,15
v_or3_b32 v7, v7, v74, v75
Maav 24,244,100
v_or3_b32 v7, v7, v82, v83
v_or3_b32 v7, v7, v90, v91
Maav 56,240,104
global_load_dword v30, v[28:29], off
Maav 56,244,108
Maav 88,240,112
Maav 88,244,116
Maav 120,240,120
Maav 120,244,124
Maav 28,248,96
Maav 28,252,100
Maav 60,248,104
Maav 60,252,108
Maav 92,248,112
Maav 92,252,116
Maav 124,248,120
Maav 124,252,124
s_cmp_lg_u32 s37, s35
Mvvv 60,16,120
s_waitcnt lgkmcnt(4)
Mvvv 60,16,124
s_cbranch_scc1 L_k2_wloop
L_k2_wlast:
v_xor_b32 v2, 65536, v2
v_xor_b32 v3, 65536, v3
Cvaa 192,192,128,32
s_mov_b32 m0, s53
Ra 224,2,40960
v_lshl_add_u64 v[28:29], s[40:41], 0, v[28:29]
Mvaa 192,196,132
buffer_load_dwordx4 v4, s[12:15], s38 offen offset:0 sc1 lds
Mvaa 192,200,136
VE 8,136
Mvaa 192,204,140
VE 9,137
Cvaa 208,192,144,36
Ra 228,2,41984
Vc 68,8,9
Mvaa 208,196,148
VE 10,138
Mvaa 208,200,152
VE 11,139
Mvaa 208,204,156
Ra 232,2,43008
Vc 69,10,11
Cvaa 224,192,160,40
Ra 236,2,44032
v_or3_b32 v7, v7, v68, v69
Mvaa 224,196,164
VE 12,152
Mvaa 224,200,168
VE 13,153
Mvaa 224,204,172
s_waitcnt lgkmcnt(4)
Ra 240,2,45056
Vc 76,12,13
Cvaa 196,208,128,32
buffer_load_dwordx4 v4, s[12:15], s38 offen offset:1024 sc1 lds
Mvaa 196,212,132
Ve 14,154
Mvaa 196,216,136
VE 15,155
Mvaa 196,220,140
Ra 244,2,46080
Vc 77,14,15
Cvaa 212,208,144,36
Ra 248,2,47104
v_or3_b32 v7, v7, v76, v77
Mvaa 212,212,148
VE 8,168
Mvaa 212,216,152
VE 9,169
Mvaa 212,220,156
Ra 252,2,48128
Vc 84,8,9
Cvaa 228,208,160,40
VE 10,170
Mvaa 228,212,164
buffer_load_dwordx4 v4, s[12:15], s38 offen offset:2048 sc1 lds
Mvaa 228,216,168
VE 11,171
Mvaa 228,220,172
s_waitcnt lgkmcnt(4)
Ra 192,2,16384
Vc 85,10,11
Cvaa 200,224,128,32
Ra 196,2,17408
v_or3_b32 v7, v7, v84, v85
Mvaa 200,228,132
Ve 12,184
Mvaa 200,232,136
VE 13,185
Mvaa 200,236,140
Ra 200,2,18432
Vc 92,12,13
Cvaa 216,224,144,36
VE 14,186
Mvaa 216,228,148
VE 15,187
Mvaa 216,232,152
Ra 204,2,19456
Vc 93,14,15
Mvaa 216,236,156
buffer_load_dwordx4 v4, s[12:15], s38 offen offset:3072 sc1 lds
Cvaa 232,224,160,40
Ra 208,2,20480
v_or3_b32 v7, v7, v92, v93
Mvaa 232,228,164
VE 8,140
Mvaa 232,232,168
VE 9,141
Mvaa 232,236,172
s_waitcnt lgkmcnt(5)
Ra 212,2,21504
Vc 70,8,9
Cvaa 204,240,128,32
Ve 10,142
Mvaa 204,244,132
VE 11,143
Mvaa 204,248,136
Ra 216,2,22528
Vc 71,10,11
Mvaa 204,252,140
Ra 220,2,23552
v_or3_b32 v7, v7, v70, v71
Cvaa 220,240,144,36
VE 12,156
Mvaa 220,244,148
VE 13,157
Mvaa 220,248,152
VE 14,158
Mvaa 220,252,156
s_waitcnt vmcnt(12)
Ve 15,159
Cvaa 236,240,160,40
VE 8,172
Mvaa 236,244,164
s_barrier
Ve 9,173
Mvaa 236,248,168
s_waitcnt lgkmcnt(4)
Vc 78,12,13
Vc 79,14,15
Ve 10,174
Ve 11,175
Ve 12,188
Ve 13,189
Ve 14,190
VE 15,191
Vc 86,8,9
Vc 87,10,11
Vc 94,12,13
Vc 95,14,15
v_or3_b32 v7, v7, v78, v79
v_or3_b32 v7, v7, v86, v87
v_or3_b32 v7, v7, v94, v95
v_and_b32 v1, 0x40004000, v7
v_cmp_ne_u32 vcc, 0, v1
Mvaa 236,252,172
s_cbranch_vccnz L_k2_fb_wl
L_k2_fbr_wl:
Maav 0,192,64
s_branch L_k2_mk_wl
L_k2_mkr_wl:
Ve 8,192
Maav 0,196,68
s_add_u32 m0, s54, 49152
VE 9,193
Maav 32,192,72
buffer_load_dwordx4 v4, s[12:15], s39 offen offset:0 sc1 lds
Maav 32,196,76
s_add_u32 s37, s37, 1
Ra 224,2,24576
Vc 96,8,9
Maav 64,192,80
s_add_u32 s38, s38, 34816
Ve 10,194
Maav 64,196,84
VE 11,195
Maav 96,192,88
Ra 228,2,25600
Vc 97,10,11
Maav 96,196,92
Ra 232,2,26624
v_or_b32_e64 v7, v96, v97
Maav 4,200,64
VE 12,208
Maav 4,204,68
VE 13,209
Maav 36,200,72
Ra 236,2,27648
Vc 104,12,13
Maav 36,204,76
VE 14,210
Maav 68,200,80
VE 15,211
Maav 68,204,84
Ra 240,2,28672
Vc 105,14,15
Maav 100,200,88
Ra 244,2,29696
v_or3_b32 v7, v7, v104, v105
Maav 100,204,92
buffer_load_dwordx4 v4, s[12:15], s39 offen offset:1024 sc1 lds
Mvvv 48,16,64
VE 8,224
Mvvv 48,16,68
s_waitcnt lgkmcnt(6)
Ve 9,225
Maav 8,208,64
Ra 248,2,30720
Vc 112,8,9
Maav 8,212,68
VE 10,226
Maav 40,208,72
VE 11,227
Maav 40,212,76
Ra 252,2,31744
Vc 113,10,11
Maav 72,208,80
Ra 192,3,0
v_or3_b32 v7, v7, v112, v113
Maav 72,212,84
VE 12,196
Maav 104,208,88
VE 13,197
Maav 104,212,92
Ra 196,3,1024
Vc 98,12,13
Maav 12,216,64
VE 14,198
Maav 12,220,68
VE 15,199
Maav 44,216,72
Ra 200,3,2048
Vc 99,14,15
Maav 44,220,76
buffer_load_dwordx4 v4, s[12:15], s39 offen offset:2048 sc1 lds
Maav 76,216,80
Ra 204,3,3072
v_or3_b32 v7, v7, v98, v99
Maav 76,220,84
VE 8,212
Maav 108,216,88
VE 9,213
Maav 108,220,92
VE 10,214
Mvvv 52,16,72
VE 11,215
Mvvv 52,16,76
s_waitcnt lgkmcnt(8)
Ve 12,228
Maav 16,224,64
Ra 208,3,4096
Vc 106,8,9
Maav 16,228,68
Ra 212,3,5120
Vc 107,10,11
Maav 48,224,72
Ra 216,3,6144
v_or3_b32 v7, v7, v106, v107
Maav 48,228,76
VE 13,229
Maav 80,224,80
Ra 220,3,7168
Vc 114,12,13
Maav 80,228,84
VE 14,230
Maav 112,224,88
buffer_load_dwordx4 v4, s[12:15], s39 offen offset:3072 sc1 lds
Maav 112,228,92
s_add_u32 s39, s39, 34816
VE 15,231
Maav 20,232,64
VE 8,200
Maav 20,236,68
VE 9,201
Maav 52,232,72
VE 10,202
Maav 52,236,76
VE 11,203
Maav 84,232,80
Vc 115,14,15
Vc 100,8,9
Maav 84,236,84
VE 12,216
Maav 116,232,88
VE 13,217
Maav 116,236,92
Vc 101,10,11
Vc 108,12,13
Mvvv 56,16,80
VE 14,218
Mvvv 56,16,84
s_waitcnt lgkmcnt(8)
Ve 15,219
Maav 24,240,64
Vc 109,14,15
v_or3_b32 v7, v7, v114, v115
Maav 24,244,68
VE 8,232
Maav 56,240,72
global_load_dword v30, v[28:29], off
Maav 56,244,76
VE 9,233
Maav 88,240,80
Vc 116,8,9
v_or3_b32 v7, v7, v100, v101
Maav 88,244,84
VE 10,234
Maav 120,240,88
VE 11,235
Maav 120,244,92
Vc 117,10,11
v_or3_b32 v7, v7, v108, v109
Maav 28,248,64
v_or3_b32 v7, v7, v116, v117
Maav 28,252,68
Maav 60,248,72
Maav 60,252,76
Maav 92,248,80
Maav 92,252,84
Maav 124,248,88
Maav 124,252,92
Mvvv 60,16,88
s_waitcnt lgkmcnt(4)
Mvvv 60,16,92
Ve 12,204
Cvaa 128,192,128,32
s_add_u32 m0, s53, 32768
VE 13,205
Mvaa 128,196,132
buffer_load_dwordx4 v4, s[12:15], s38 offen offset:0 sc1 lds
Mvaa 128,200,136
Ra 224,3,8192
Vc 102,12,13
Mvaa 128,204,140
VE 14,206
Cvaa 144,192,144,36
VE 15,207
Mvaa 144,196,148
Ra 228,3,9216
Vc 103,14,15
Mvaa 144,200,152
Ra 232,3,10240
v_or3_b32 v7, v7, v102, v103
Mvaa 144,204,156
s_waitcnt lgkmcnt(3)
Ra 236,3,11264
Ra 240,3,12288
Cvaa 132,208,128,32
buffer_load_dwordx4 v4, s[12:15], s38 offen offset:1024 sc1 lds
Mvaa 132,212,132
Ve 8,220
Mvaa 132,216,136
VE 9,221
Mvaa 132,220,140
Ra 244,3,13312
Vc 110,8,9
Cvaa 148,208,144,36
VE 10,222
Mvaa 148,212,148
buffer_load_dwordx4 v4, s[12:15], s38 offen offset:2048 sc1 lds
Mvaa 148,216,152
VE 11,223
Mvaa 148,220,156
s_waitcnt lgkmcnt(2)
Ra 248,3,14336
Ra 252,3,15360
Cvaa 136,224,128,32
Ra 192,2,49152
Vc 111,10,11
Mvaa 136,228,132
Ra 196,2,50176
v_or3_b32 v7, v7, v110, v111
Mvaa 136,232,136
Ve 12,236
Mvaa 136,236,140
buffer_load_dwordx4 v4, s[12:15], s38 offen offset:3072 sc1 lds
Cvaa 152,224,144,36
VE 13,237
Mvaa 152,228,148
Ra 200,2,51200
Vc 118,12,13
Mvaa 152,232,152
VE 14,238
Mvaa 152,236,156
s_waitcnt lgkmcnt(3)
Ra 204,2,52224
Ra 208,2,53248
Cvaa 140,240,128,32
Ve 15,239
Mvaa 140,244,132
Ra 212,2,54272
Vc 119,14,15
Mvaa 140,248,136
Ra 216,2,55296
v_or3_b32 v7, v7, v118, v119
Mvaa 140,252,140
s_waitcnt vmcnt(12)
Ra 220,2,56320
v_and_b32 v1, 0x40004000, v7
Cvaa 156,240,144,36
s_cmp_eq_u32 s37, s45
v_cmp_ne_u32 vcc, 0, v1
Mvaa 156,244,148
s_barrier
Mvaa 156,248,152
s_waitcnt lgkmcnt(4)
Mvaa 156,252,156
s_cbranch_vccnz L_k2_fb_tr
L_k2_fbr_tr:
Maav 0,192,96
s_cbranch_scc1 L_k2_mk_tr
L_k2_mkr_tr:
Ve 8,128
Maav 0,196,100
s_add_u32 m0, s53, 16384
VE 9,129
Maav 32,192,104
buffer_load_dwordx4 v4, s[12:15], s39 offen offset:0 sc1 lds
Maav 32,196,108
s_add_u32 s37, s37, 1
Ra 224,2,57344
Vc 64,8,9
Maav 64,192,112
s_add_u32 s38, s38, 34816
Ve 10,130
Maav 64,196,116
s_xor_b32 s53, s53, 65536
VE 11,131
Maav 4,200,96
s_xor_b32 s54, s54, 65536
Ra 228,2,58368
Vc 65,10,11
Maav 4,204,100
Ra 232,2,59392
v_or_b32_e64 v7, v64, v65
Maav 36,200,104
VE 12,144
Maav 36,204,108
VE 13,145
Maav 68,200,112
Ra 236,2,60416
Vc 72,12,13
Maav 68,204,116
VE 14,146
Mvvv 48,16,96
VE 15,147
Mvvv 48,16,100
s_waitcnt lgkmcnt(4)
Ra 240,2,61440
Vc 73,14,15
Maav 8,208,96
buffer_load_dwordx4 v4, s[12:15], s39 offen offset:1024 sc1 lds
Maav 8,212,100
Ra 244,2,62464
v_or3_b32 v7, v7, v72, v73
Maav 40,208,104
Ve 8,132
Maav 40,212,108
VE 9,133
Maav 72,208,112
Ra 248,2,63488
Vc 66,8,9
Maav 72,212,116
VE 10,134
Maav 12,216,96
VE 11,135
Maav 12,220,100
Ra 252,2,64512
Vc 67,10,11
Maav 44,216,104
Ra 192,3,32768
v_or3_b32 v7, v7, v66, v67
Maav 44,220,108
VE 12,148
Maav 76,216,112
VE 13,149
Maav 76,220,116
Ra 196,3,33792
Vc 74,12,13
Mvvv 52,16,104
VE 14,150
Mvvv 52,16,108
s_waitcnt lgkmcnt(6)
Ve 15,151
Maav 16,224,96
buffer_load_dwordx4 v4, s[12:15], s39 offen offset:2048 sc1 lds
Maav 16,228,100
Ra 200,3,34816
Vc 75,14,15
Maav 48,224,104
Ra 204,3,35840
v_or3_b32 v7, v7, v74, v75
Maav 48,228,108
VE 8,136
Maav 80,224,112
Ra 208,3,36864
Ra 212,3,37888
Maav 80,228,116
Ra 216,3,38912
Ra 220,3,39936
Maav 20,232,96
Maav 20,236,100
Maav 52,232,104
Maav 52,236,108
Maav 84,232,112
Maav 84,236,116
buffer_load_dwordx4 v4, s[12:15], s39 offen offset:3072 sc1 lds
Mvvv 56,16,112
s_add_u32 s39, s39, 34816
Mvvv 56,16,116
s_waitcnt lgkmcnt(8)
Maav 24,240,96
Maav 24,244,100
Maav 56,240,104
Maav 56,244,108
Maav 88,240,112
Maav 88,244,116
Maav 28,248,96
Maav 28,252,100
Maav 60,248,104
Maav 60,252,108
Maav 92,248,112
s_waitcnt lgkmcnt(4)
Maav 92,252,116
s_getpc_b64 s[56:57]
L_cpf4:
s_add_u32 s56, s56, (L_k2_fin-L_cpf4)&0xffffffff
s_addc_u32 s57, s57, ((L_k2_fin-L_cpf4)>>32)&0xffffffff
s_lshr_b32 s58, s2, 3
s_lshl_b32 s58, s58, 2
s_add_u32 s58, s58, s32
s_lshl_b32 s58, s58, 10
v_and_b32 v162, 7, v0
v_lshlrev_b32 v162, 7, v162
v_add_u32 v162, s58, v162
v_min_u32 v162, L_p4_end-L_k2_fin-4, v162
v_mov_b32 v161, s57
v_add_co_u32 v160, vcc, s56, v162
s_nop 1
v_addc_co_u32 v161, vcc, 0, v161, vcc
global_load_dword v164, v[160:161], off
s_waitcnt vmcnt(9)
s_lshl_b32 s3, s34, 20
s_lshl_b32 s47, s33, 15
s_add_u32 s3, s3, s47
s_lshl_b32 s47, s32, 10
v_lshlrev_b32 v248, 4, v0
v_add_u32_e64 v249, s47, v248
s_sub_u32 s47, 7168, s47
v_add_u32 v248, s47, v248
v_rcp_f32 v250, v56
v_rcp_f32 v252, v60
v_mov_b32 v251, v250
v_mov_b32_e64 v253, v252
Ar 240,96
Ar 241,97
Ar 242,98
Ar 243,99
Ar 244,100
Ar 245,101
Ar 246,102
Ar 247,103
v_pk_mul_f32 v[240:241], v[240:241], v[252:253]
v_pk_mul_f32 v[242:243], v[242:243], v[252:253]
v_pk_mul_f32 v[244:245], v[244:245], v[252:253]
v_pk_mul_f32 v[246:247], v[246:247], v[252:253]
Vc 28,240,241
Vc 29,242,243
Vc 30,244,245
Vc 31,246,247
buffer_store_dwordx4 v[28:31], v249, s[16:19], s3 offen sc1
Ar 240,64
Ar 241,65
Ar 242,66
Ar 243,67
Ar 244,68
Ar 245,69
Ar 246,70
Ar 247,71
v_pk_mul_f32 v[240:241], v[240:241], v[250:251]
v_pk_mul_f32 v[242:243], v[242:243], v[250:251]
v_pk_mul_f32 v[244:245], v[244:245], v[250:251]
v_pk_mul_f32 v[246:247], v[246:247], v[250:251]
Vc 24,240,241
Vc 25,242,243
Vc 26,244,245
Vc 27,246,247
buffer_store_dwordx4 v[24:27], v248, s[16:19], s3 offen sc1
s_add_u32 s3, s3, 8192
Ar 240,104
Ar 241,105
Ar 242,106
Ar 243,107
Ar 244,108
Ar 245,109
Ar 246,110
Ar 247,111
v_pk_mul_f32 v[240:241], v[240:241], v[252:253]
v_pk_mul_f32 v[242:243], v[242:243], v[252:253]
v_pk_mul_f32 v[244:245], v[244:245], v[252:253]
v_pk_mul_f32 v[246:247], v[246:247], v[252:253]
Vc 28,240,241
Vc 29,242,243
Vc 30,244,245
Vc 31,246,247
buffer_store_dwordx4 v[28:31], v249, s[16:19], s3 offen sc1
Ar 240,72
Ar 241,73
Ar 242,74
Ar 243,75
Ar 244,76
Ar 245,77
Ar 246,78
Ar 247,79
v_pk_mul_f32 v[240:241], v[240:241], v[250:251]
v_pk_mul_f32 v[242:243], v[242:243], v[250:251]
v_pk_mul_f32 v[244:245], v[244:245], v[250:251]
v_pk_mul_f32 v[246:247], v[246:247], v[250:251]
Vc 24,240,241
Vc 25,242,243
Vc 26,244,245
Vc 27,246,247
buffer_store_dwordx4 v[24:27], v248, s[16:19], s3 offen sc1
s_add_u32 s3, s3, 8192
Ar 240,112
Ar 241,113
Ar 242,114
Ar 243,115
Ar 244,116
Ar 245,117
Ar 246,118
Ar 247,119
v_pk_mul_f32 v[240:241], v[240:241], v[252:253]
v_pk_mul_f32 v[242:243], v[242:243], v[252:253]
v_pk_mul_f32 v[244:245], v[244:245], v[252:253]
v_pk_mul_f32 v[246:247], v[246:247], v[252:253]
Vc 28,240,241
Vc 29,242,243
Vc 30,244,245
Vc 31,246,247
buffer_store_dwordx4 v[28:31], v249, s[16:19], s3 offen sc1
Ar 240,80
Ar 241,81
Ar 242,82
Ar 243,83
Ar 244,84
Ar 245,85
Ar 246,86
Ar 247,87
v_pk_mul_f32 v[240:241], v[240:241], v[250:251]
v_pk_mul_f32 v[242:243], v[242:243], v[250:251]
v_pk_mul_f32 v[244:245], v[244:245], v[250:251]
v_pk_mul_f32 v[246:247], v[246:247], v[250:251]
Vc 24,240,241
Vc 25,242,243
Vc 26,244,245
Vc 27,246,247
buffer_store_dwordx4 v[24:27], v248, s[16:19], s3 offen sc1
s_add_u32 s3, s3, 8192
Ar 240,120
Ar 241,121
Ar 242,122
Ar 243,123
Ar 244,124
Ar 245,125
Ar 246,126
Ar 247,127
v_pk_mul_f32 v[240:241], v[240:241], v[252:253]
v_pk_mul_f32 v[242:243], v[242:243], v[252:253]
v_pk_mul_f32 v[244:245], v[244:245], v[252:253]
v_pk_mul_f32 v[246:247], v[246:247], v[252:253]
Vc 28,240,241
Vc 29,242,243
Vc 30,244,245
Vc 31,246,247
buffer_store_dwordx4 v[28:31], v249, s[16:19], s3 offen sc1
Ar 240,88
Ar 241,89
Ar 242,90
Ar 243,91
Ar 244,92
Ar 245,93
Ar 246,94
Ar 247,95
v_pk_mul_f32 v[240:241], v[240:241], v[250:251]
v_pk_mul_f32 v[242:243], v[242:243], v[250:251]
v_pk_mul_f32 v[244:245], v[244:245], v[250:251]
v_pk_mul_f32 v[246:247], v[246:247], v[250:251]
Vc 24,240,241
Vc 25,242,243
Vc 26,244,245
Vc 27,246,247
buffer_store_dwordx4 v[24:27], v248, s[16:19], s3 offen sc1
s_add_u32 s52, s37, 2
s_load_dwordx2 s[94:95], s[0:1], 40
s_load_dwordx2 s[40:41], s[0:1], 0
s_load_dwordx4 s[8:11], s[0:1], 80
s_waitcnt vmcnt(8) lgkmcnt(0)
s_cmp_eq_u32 s34, 7
s_cbranch_scc1 L_k2_fin
L_k2_nloop:
v_xor_b32 v2, 65536, v2
v_xor_b32 v3, 65536, v3
Cvaa 192,192,128,32
s_mov_b32 m0, s53
Ve 9,137
Mvaa 192,196,132
buffer_load_dwordx4 v4, s[12:15], s38 offen offset:0 sc1 lds
Mvaa 192,200,136
Ra 224,2,40960
Vc 68,8,9
Mvaa 192,204,140
VE 10,138
Cvaa 208,192,144,36
VE 11,139
Mvaa 208,196,148
Ra 228,2,41984
Vc 69,10,11
Mvaa 208,200,152
Ra 232,2,43008
v_or3_b32 v7, v7, v68, v69
Mvaa 208,204,156
s_waitcnt lgkmcnt(3)
Ra 236,2,44032
Ra 240,2,45056
Cvaa 196,208,128,32
buffer_load_dwordx4 v4, s[12:15], s38 offen offset:1024 sc1 lds
Mvaa 196,212,132
Ve 12,152
Mvaa 196,216,136
VE 13,153
Mvaa 196,220,140
Ra 244,2,46080
Vc 76,12,13
Cvaa 212,208,144,36
VE 14,154
Mvaa 212,212,148
buffer_load_dwordx4 v4, s[12:15], s38 offen offset:2048 sc1 lds
Mvaa 212,216,152
VE 15,155
Mvaa 212,220,156
s_waitcnt lgkmcnt(2)
Ra 248,2,47104
Ra 252,2,48128
Cvaa 200,224,128,32
Ra 192,2,16384
Vc 77,14,15
Mvaa 200,228,132
Ra 196,2,17408
v_or3_b32 v7, v7, v76, v77
Mvaa 200,232,136
Ve 8,140
Mvaa 200,236,140
buffer_load_dwordx4 v4, s[12:15], s38 offen offset:3072 sc1 lds
Cvaa 216,224,144,36
VE 9,141
Mvaa 216,228,148
Ra 200,2,18432
Vc 70,8,9
Mvaa 216,232,152
VE 10,142
Mvaa 216,236,156
s_waitcnt lgkmcnt(3)
Ra 204,2,19456
Ra 208,2,20480
Cvaa 204,240,128,32
Ve 11,143
Mvaa 204,244,132
s_cmp_lt_u32 s37, s52
Ra 212,2,21504
Vc 71,10,11
Mvaa 204,248,136
s_cbranch_scc1 L_nw_ne
s_waitcnt vmcnt(12)
L_nw_ne:
Ra 216,2,22528
v_or3_b32 v7, v7, v70, v71
Mvaa 204,252,140
Ve 12,156
Cvaa 220,240,144,36
VE 13,157
Mvaa 220,244,148
s_barrier
Ra 220,2,23552
Vc 78,12,13
Mvaa 220,248,152
s_waitcnt lgkmcnt(4)
Ve 14,158
Ve 15,159
s_nop 0
Vc 79,14,15
v_or3_b32 v7, v7, v78, v79
v_and_b32 v1, 0x40004000, v7
v_cmp_ne_u32 vcc, 0, v1
Mvaa 220,252,156
s_cbranch_vccnz L_k2_fb_ne
L_k2_fbr_ne:
Maav 0,192,64
Ve 8,192
Maav 0,196,68
s_add_u32 m0, s54, 49152
VE 9,193
Maav 32,192,72
buffer_load_dwordx4 v4, s[12:15], s39 offen offset:0 sc1 lds
Maav 32,196,76
s_cmp_eq_u32 s37, s52
Ra 224,2,24576
Vc 96,8,9
Maav 4,200,64
s_cbranch_scc1 L_pubB
L_pubBr:
VE 10,194
Maav 4,204,68
s_add_u32 s37, s37, 1
Ve 11,195
Maav 36,200,72
s_add_u32 s38, s38, 34816
Ra 228,2,25600
Vc 97,10,11
Maav 36,204,76
Ra 232,2,26624
v_or_b32_e64 v7, v96, v97
Mvvv 48,16,64
VE 12,208
Mvvv 48,16,68
s_waitcnt lgkmcnt(3)
Ra 236,2,27648
Ra 240,2,28672
Maav 8,208,64
buffer_load_dwordx4 v4, s[12:15], s39 offen offset:1024 sc1 lds
Maav 8,212,68
Ve 13,209
Maav 40,208,72
Ra 244,2,29696
Vc 104,12,13
Maav 40,212,76
VE 14,210
Maav 12,216,64
VE 15,211
Maav 12,220,68
Ra 248,2,30720
Vc 105,14,15
Maav 44,216,72
Ra 252,2,31744
v_or3_b32 v7, v7, v104, v105
Maav 44,220,76
VE 8,196
Mvvv 52,16,72
buffer_load_dwordx4 v4, s[12:15], s39 offen offset:2048 sc1 lds
Mvvv 52,16,76
s_waitcnt lgkmcnt(4)
Ve 9,197
Maav 16,224,64
Ra 192,3,0
Vc 98,8,9
Maav 16,228,68
VE 10,198
Maav 48,224,72
VE 11,199
Maav 48,228,76
Ra 196,3,1024
Vc 99,10,11
Maav 20,232,64
Ra 200,3,2048
v_or3_b32 v7, v7, v98, v99
Maav 20,236,68
Ra 204,3,3072
Ra 208,3,4096
Maav 52,232,72
buffer_load_dwordx4 v4, s[12:15], s39 offen offset:3072 sc1 lds
Maav 52,236,76
s_waitcnt lgkmcnt(5)
Ve 12,212
Maav 24,240,64
s_add_u32 s39, s39, 34816
VE 13,213
Maav 24,244,68
Ra 212,3,5120
Vc 106,12,13
Maav 56,240,72
VE 14,214
Maav 56,244,76
VE 15,215
Maav 28,248,64
Ra 216,3,6144
Vc 107,14,15
Maav 28,252,68
Ra 220,3,7168
v_or3_b32 v7, v7, v106, v107
Maav 60,248,72
s_waitcnt lgkmcnt(4)
Ve 8,200
Maav 60,252,76
VE 9,201
Cvaa 128,192,128,32
s_add_u32 m0, s53, 32768
Ra 224,3,8192
Vc 100,8,9
Mvaa 128,196,132
buffer_load_dwordx4 v4, s[12:15], s38 offen offset:0 sc1 lds
Mvaa 128,200,136
VE 10,202
Mvaa 128,204,140
VE 11,203
Cvaa 144,192,144,36
Ra 228,3,9216
Vc 101,10,11
Mvaa 144,196,148
Ra 232,3,10240
v_or3_b32 v7, v7, v100, v101
Mvaa 144,200,152
VE 12,216
Mvaa 144,204,156
s_waitcnt lgkmcnt(3)
Ra 236,3,11264
Ra 240,3,12288
Cvaa 132,208,128,32
buffer_load_dwordx4 v4, s[12:15], s38 offen offset:1024 sc1 lds
Mvaa 132,212,132
Ve 13,217
Mvaa 132,216,136
Ra 244,3,13312
Vc 108,12,13
Mvaa 132,220,140
VE 14,218
Cvaa 148,208,144,36
VE 15,219
Mvaa 148,212,148
buffer_load_dwordx4 v4, s[12:15], s38 offen offset:2048 sc1 lds
Mvaa 148,216,152
Ra 248,3,14336
Vc 109,14,15
Mvaa 148,220,156
s_waitcnt lgkmcnt(3)
Ra 252,3,15360
v_or3_b32 v7, v7, v108, v109
Cvaa 136,224,128,32
Ve 8,204
Mvaa 136,228,132
VE 9,205
Mvaa 136,232,136
Ra 192,2,49152
Vc 102,8,9
Mvaa 136,236,140
buffer_load_dwordx4 v4, s[12:15], s38 offen offset:3072 sc1 lds
Cvaa 152,224,144,36
VE 10,206
Mvaa 152,228,148
VE 11,207
Mvaa 152,232,152
Ra 196,2,50176
Vc 103,10,11
Mvaa 152,236,156
s_waitcnt lgkmcnt(2)
Ra 200,2,51200
Ra 204,2,52224
Cvaa 140,240,128,32
Ra 208,2,53248
v_or3_b32 v7, v7, v102, v103
Mvaa 140,244,132
s_cmp_lt_u32 s37, s52
VE 12,220
Mvaa 140,248,136
s_cbranch_scc1 L_nw_no
s_waitcnt vmcnt(12)
L_nw_no:
VE 13,221
Mvaa 140,252,140
Ra 212,2,54272
Vc 110,12,13
Cvaa 156,240,144,36
s_cmp_eq_u32 s37, s45
Ve 14,222
Mvaa 156,244,148
s_barrier
Ve 15,223
Mvaa 156,248,152
s_waitcnt lgkmcnt(2)
Ra 216,2,55296
Vc 111,14,15
v_or3_b32 v7, v7, v110, v111
v_and_b32 v1, 0x40004000, v7
v_cmp_ne_u32 vcc, 0, v1
Mvaa 156,252,156
s_cbranch_vccnz L_k2_fb_no
L_k2_fbr_no:
Ra 220,2,56320
Maav 0,192,96
s_cbranch_scc1 L_k2_mk_no
L_k2_mkr_no:
VE 8,128
Maav 0,196,100
s_add_u32 m0, s53, 16384
VE 9,129
Maav 32,192,104
buffer_load_dwordx4 v4, s[12:15], s39 offen offset:0 sc1 lds
Maav 32,196,108
s_add_u32 s37, s37, 1
Ra 224,2,57344
Vc 64,8,9
Maav 4,200,96
s_add_u32 s38, s38, 34816
Ve 10,130
Maav 4,204,100
s_xor_b32 s53, s53, 65536
VE 11,131
Maav 36,200,104
s_xor_b32 s54, s54, 65536
Ra 228,2,58368
Vc 65,10,11
Maav 36,204,108
Ra 232,2,59392
v_or_b32_e64 v7, v64, v65
Mvvv 48,16,96
VE 12,144
Mvvv 48,16,100
s_waitcnt lgkmcnt(3)
Ra 236,2,60416
Ra 240,2,61440
Maav 8,208,96
buffer_load_dwordx4 v4, s[12:15], s39 offen offset:1024 sc1 lds
Maav 8,212,100
Ve 13,145
Maav 40,208,104
Ra 244,2,62464
Vc 72,12,13
Maav 40,212,108
VE 14,146
Maav 12,216,96
VE 15,147
Maav 12,220,100
Ra 248,2,63488
Vc 73,14,15
Maav 44,216,104
Ra 252,2,64512
v_or3_b32 v7, v7, v72, v73
Maav 44,220,108
VE 8,132
Mvvv 52,16,104
buffer_load_dwordx4 v4, s[12:15], s39 offen offset:2048 sc1 lds
Mvvv 52,16,108
s_waitcnt lgkmcnt(4)
Ve 9,133
Maav 16,224,96
Ra 192,3,32768
Vc 66,8,9
Maav 16,228,100
VE 10,134
Maav 48,224,104
VE 11,135
Maav 48,228,108
Ra 196,3,33792
Vc 67,10,11
Maav 20,232,96
Ra 200,3,34816
v_or3_b32 v7, v7, v66, v67
Maav 20,236,100
Ra 204,3,35840
Ra 208,3,36864
Maav 52,232,104
buffer_load_dwordx4 v4, s[12:15], s39 offen offset:3072 sc1 lds
Maav 52,236,108
s_waitcnt lgkmcnt(5)
Ve 12,148
Maav 24,240,96
s_add_u32 s39, s39, 34816
VE 13,149
Maav 24,244,100
Ra 212,3,37888
Vc 74,12,13
Maav 56,240,104
VE 14,150
Maav 56,244,108
VE 15,151
Maav 28,248,96
Ra 216,3,38912
Vc 75,14,15
Maav 28,252,100
s_cmp_lg_u32 s37, s36
Ra 220,3,39936
v_or3_b32 v7, v7, v74, v75
Maav 60,248,104
s_waitcnt lgkmcnt(4)
VE 8,136
Maav 60,252,108
s_cbranch_scc1 L_k2_nloop
L_k2_fin:
v_xor_b32 v2, 65536, v2
v_xor_b32 v3, 65536, v3
Cvaa 192,192,128,32
Ve 9,137
Mvaa 192,196,132
Ra 224,2,40960
Vc 68,8,9
Mvaa 192,200,136
Ra 228,2,41984
Ra 232,2,43008
Mvaa 192,204,140
s_waitcnt lgkmcnt(3)
Ra 236,2,44032
Ra 240,2,45056
Cvaa 196,208,128,32
Ve 10,138
Mvaa 196,212,132
VE 11,139
Mvaa 196,216,136
Ra 244,2,46080
Vc 69,10,11
Mvaa 196,220,140
s_waitcnt lgkmcnt(2)
Ra 248,2,47104
Ra 252,2,48128
Cvaa 200,224,128,32
Ra 192,2,16384
v_or3_b32 v7, v7, v68, v69
Mvaa 200,228,132
s_cmp_lt_u32 s37, s52
VE 12,152
Mvaa 200,232,136
s_cbranch_scc1 L_nw_nl
s_waitcnt vmcnt(8)
L_nw_nl:
Ra 196,2,17408
Ra 200,2,18432
Mvaa 200,236,140
s_waitcnt lgkmcnt(3)
Ra 204,2,19456
Ra 208,2,20480
Cvaa 204,240,128,32
Ve 13,153
Mvaa 204,244,132
s_barrier
Ra 212,2,21504
Vc 76,12,13
Mvaa 204,248,136
s_waitcnt lgkmcnt(2)
Ve 14,154
Ve 15,155
Ve 8,140
Ve 9,141
Ve 10,142
Ve 11,143
Ve 12,156
Ve 13,157
Vc 77,14,15
Ve 14,158
Ve 15,159
Vc 70,8,9
Vc 71,10,11
Vc 78,12,13
Vc 79,14,15
v_or3_b32 v7, v7, v76, v77
v_or3_b32 v7, v7, v70, v71
v_or3_b32 v7, v7, v78, v79
v_and_b32 v1, 0x40004000, v7
v_cmp_ne_u32 vcc, 0, v1
Mvaa 204,252,140
s_cbranch_vccnz L_k2_fb_nl
L_k2_fbr_nl:
Ra 216,2,22528
Ra 220,2,23552
s_lshr_b32 s3, s42, 4
s_mul_i32 s3, s3, 33792
s_and_b32 s47, s42, 15
s_lshl_b32 s47, s47, 4
s_add_u32 s3, s3, s47
v_mov_b32 v28, s3
s_lshr_b32 s3, s43, 4
s_mul_i32 s3, s3, 33792
s_and_b32 s47, s43, 15
s_lshl_b32 s47, s47, 4
s_add_u32 s3, s3, s47
v_mov_b32 v29, s3
v_lshrrev_b32 v24, 4, v0
v_and_b32 v25, 15, v0
v_cmp_eq_u32 vcc, 1, v25
s_lshl_b32 s3, s32, 4
v_add_u32 v26, s3, v24
v_cndmask_b32 v28, v28, v29, vcc
v_lshl_add_u32 v28, v24, 8, v28
v_mul_u32_u24 v26, 7168, v26
v_lshlrev_b32 v24, 1, v24
v_xor_b32 v24, v24, v25
v_xor_b32_e64 v25, 8, v24
v_lshl_add_u32 v24, v24, 4, v26
v_lshl_add_u32 v25, v25, 4, v26
s_lshl_b32 s3, s92, 12
buffer_load_dwordx4 a[160:163], v28, s[20:23], s3 offen offset:0 sc1
buffer_load_dwordx4 a[164:167], v28, s[20:23], s3 offen offset:1024 sc1
buffer_load_dwordx4 a[168:171], v28, s[20:23], s3 offen offset:2048 sc1
buffer_load_dwordx4 a[172:175], v28, s[20:23], s3 offen offset:3072 sc1
Maav 0,192,64
s_branch L_k2_mk_nl
L_k2_mkr_nl:
VE 8,192
Maav 0,196,68
s_add_u32 m0, s54, 0
s_add_u32 s3, s5, 0
VE 9,193
Maav 32,192,72
buffer_load_dwordx4 v24, s[24:27], s3 offen offset:0 lds
Maav 32,196,76
s_add_u32 s3, s5, 27648
Ra 224,2,24576
Vc 96,8,9
Maav 4,200,64
buffer_load_dwordx4 v24, s[24:27], s3 offen offset:1024 lds
Maav 4,204,68
s_add_u32 s3, s5, 55296
VE 10,194
Maav 36,200,72
buffer_load_dwordx4 v25, s[24:27], s3 offen offset:2048 lds
Maav 36,204,76
s_add_u32 s3, s5, 82944
Ra 228,2,25600
Ra 232,2,26624
Mvvv 48,16,64
buffer_load_dwordx4 v25, s[24:27], s3 offen offset:3072 lds
Mvvv 48,16,68
s_waitcnt lgkmcnt(3)
s_add_u32 m0, s54, 16384
s_add_u32 s3, s5, 458752
Ra 236,2,27648
Ra 240,2,28672
Maav 8,208,64
buffer_load_dwordx4 v24, s[24:27], s3 offen offset:0 lds
Maav 8,212,68
s_add_u32 s3, s5, 486400
Ve 11,195
Maav 40,208,72
buffer_load_dwordx4 v24, s[24:27], s3 offen offset:1024 lds
Maav 40,212,76
s_add_u32 s3, s5, 514048
Ra 244,2,29696
Vc 97,10,11
Maav 12,216,64
buffer_load_dwordx4 v25, s[24:27], s3 offen offset:2048 lds
Maav 12,220,68
s_add_u32 s3, s5, 541696
Ra 248,2,30720
v_or_b32_e64 v7, v96, v97
Maav 44,216,72
buffer_load_dwordx4 v25, s[24:27], s3 offen offset:3072 lds
Maav 44,220,76
s_add_u32 m0, s54, 32768
s_add_u32 s3, s5, 0
Ve 12,196
Mvvv 52,16,72
buffer_load_dwordx4 v24, s[68:71], s3 offen offset:0 lds
Mvvv 52,16,76
s_waitcnt lgkmcnt(3)
s_add_u32 s3, s5, 27648
Ra 252,2,31744
Ra 192,2,49152
Maav 16,224,64
buffer_load_dwordx4 v24, s[68:71], s3 offen offset:1024 lds
Maav 16,228,68
s_add_u32 s3, s5, 55296
Ve 13,197
Maav 48,224,72
buffer_load_dwordx4 v25, s[68:71], s3 offen offset:2048 lds
Maav 48,228,76
s_add_u32 s3, s5, 82944
Ra 196,2,50176
Vc 98,12,13
Maav 20,232,64
buffer_load_dwordx4 v25, s[68:71], s3 offen offset:3072 lds
Maav 20,236,68
s_add_u32 m0, s54, 49152
s_add_u32 s3, s5, 458752
Ra 200,2,51200
Ra 204,2,52224
Maav 52,232,72
buffer_load_dwordx4 v24, s[68:71], s3 offen offset:0 lds
Maav 52,236,76
s_waitcnt lgkmcnt(4)
s_add_u32 s3, s5, 486400
Ve 14,198
Maav 24,240,64
buffer_load_dwordx4 v24, s[68:71], s3 offen offset:1024 lds
Maav 24,244,68
s_add_u32 s3, s5, 514048
VE 15,199
Maav 56,240,72
buffer_load_dwordx4 v25, s[68:71], s3 offen offset:2048 lds
Maav 56,244,76
s_add_u32 s3, s5, 541696
Ra 208,2,53248
Vc 99,14,15
Maav 28,248,64
buffer_load_dwordx4 v25, s[68:71], s3 offen offset:3072 lds
Maav 28,252,68
Ra 212,2,54272
v_or3_b32 v7, v7, v98, v99
Maav 60,248,72
s_waitcnt lgkmcnt(2)
Ra 216,2,55296
Ra 220,2,56320
Ve 8,200
Ve 9,201
Ve 10,202
Ve 11,203
Ve 12,204
Ve 13,205
Ve 14,206
VE 15,207
Vc 100,8,9
Vc 101,10,11
Vc 102,12,13
Vc 103,14,15
v_or3_b32 v7, v7, v100, v101
v_or3_b32 v7, v7, v102, v103
Maav 60,252,76
v_and_b32 v1, 0x40004000, v7
v_cmp_ne_u32 vcc, 0, v1
s_cbranch_vccnz L_k2_fb_fi
L_k2_fbr_fi:
Maav 0,192,96
Ra 224,2,57344
Ra 228,2,58368
Maav 0,196,100
Ra 232,2,59392
Ra 236,2,60416
Maav 4,200,96
Ra 240,2,61440
Ra 244,2,62464
Maav 4,204,100
Ra 248,2,63488
Ra 252,2,64512
Mvvv 48,16,96
s_mov_b32 s60, s8
s_and_b32 s61, s9, 0xffff
s_mov_b32 s62, 7340032
Mvvv 48,16,100
s_waitcnt lgkmcnt(8)
Maav 8,208,96
s_mov_b32 s63, 0x20000
s_mov_b32 s68, s10
s_and_b32 s69, s11, 0xffff
Maav 8,212,100
s_mov_b32 s70, 4194304
s_mov_b32 s71, 0x20000
s_mov_b32 s56, s40
Maav 12,216,96
s_and_b32 s57, s41, 0xffff
s_mov_b32 s58, 4194304
s_mov_b32 s59, 0x20000
Maav 12,220,100
s_waitcnt lgkmcnt(4)
Maav 16,224,96
s_bfe_u32 s6, s2, 0x20001
s_lshr_b32 s7, s34, 1
s_lshl_b32 s45, s7, 2
Maav 16,228,100
s_add_u32 s46, s45, s6
s_sub_u32 s46, 15, s46
s_sub_u32 s45, 12, s45
Maav 20,232,96
s_add_u32 s45, s45, s6
s_cmp_lt_u32 s7, 2
s_cselect_b32 s45, s46, s45
Maav 20,236,100
s_waitcnt lgkmcnt(0)
Maav 24,240,96
s_and_b32 s46, s2, 1
s_lshl_b32 s46, s46, 3
s_bfe_u32 s6, s2, 0x30003
Maav 24,244,100
s_add_u32 s46, s46, s6
s_mov_b32 s48, 0
s_mov_b32 s49, 15360
Maav 28,248,96
s_mov_b32 s50, 30720
s_mov_b32 s51, 46080
s_lshl_b32 s35, s32, 13
Maav 28,252,100
s_add_u32 s35, s35, 131072
s_and_b32 s52, s46, 1
s_lshl_b32 s6, s45, 20
s_lshl_b32 s7, s52, 19
s_add_u32 s6, s6, s7
s_add_u32 s6, s6, 46137344
s_add_u32 s8, s66, s6
s_addc_u32 s9, s67, 0
s_and_b32 s9, s9, 0xffff
s_mov_b32 s10, 524288
s_mov_b32 s11, 0x20000
s_lshr_b32 s7, s46, 1
s_lshl_b32 s7, s7, 8
s_lshl_b32 s6, s52, 22
s_add_u32 s6, s6, s7
s_add_u32 s12, s94, s6
s_addc_u32 s13, s95, 0
s_and_b32 s13, s13, 0xffff
s_mov_b32 s14, 0
s_mov_b32 s15, 0x20000
s_sub_u32 s14, 4194304, s7
s_mov_b32 s28, s94
s_and_b32 s29, s95, 0xffff
s_mov_b32 s30, 8388608
s_mov_b32 s31, 0x20000
s_lshl_b32 s7, s46, 7
s_lshl_b32 s36, s45, 18
s_add_u32 s36, s36, s7
s_and_b32 s94, s7, 128
s_lshl_b32 s38, s45, 7
s_lshl_b32 s6, s52, 6
s_add_u32 s38, s38, s6
s_add_u32 s38, s38, 5300224
s_lshl_b32 s52, s32, 11
v_lshlrev_b32 v112, 4, v0
v_lshrrev_b32 v121, 4, v0
v_and_b32 v122, 7, v0
v_lshrrev_b32 v123, 3, v0
v_lshlrev_b32 v124, 1, v121
v_xor_b32 v124, v124, v122
v_lshlrev_b32_e64 v124, 4, v124
v_lshl_add_u32 v113, v123, 11, v124
s_and_b32 s6, s32, 1
s_lshl_b32 s6, s6, 16
s_lshr_b32 s7, s32, 1
s_lshl_b32 s7, s7, 7
s_xor_b32 s7, s7, s94
s_xor_b32 s7, s7, 128
s_add_u32 s6, s6, s7
v_add_u32 v114, s6, v113
v_lshrrev_b32 v124, 2, v0
v_bfe_u32 v126, v0, 3, 2
v_lshlrev_b32 v124, 7, v124
v_and_b32 v125, 3, v0
v_lshl_add_u32 v124, v125, 3, v124
v_lshl_add_u32 v115, v126, 5, v124
v_xor_b32 v116, 32, v115
v_xor_b32 v117, 64, v115
v_xor_b32 v118, 96, v115
s_lshl_b32 s6, s32, 5
v_add_u32 v120, s6, v123
v_lshlrev_b32_e64 v119, 11, v120
v_lshl_add_u32 v119, v122, 4, v119
v_mov_b32 v126, 0
v_lshlrev_b32 v127, 2, v122
s_nop 7
s_lshl_b32 s3, s55, 20
s_lshl_b32 s47, s33, 15
s_add_u32 s3, s3, s47
s_lshl_b32 s47, s32, 10
v_lshlrev_b32 v248, 4, v0
v_add_u32_e64 v249, s47, v248
s_sub_u32 s47, 7168, s47
v_add_u32 v248, s47, v248
v_rcp_f32 v250, v48
v_rcp_f32 v252, v52
v_mov_b32 v251, v250
v_mov_b32_e64 v253, v252
Ar 240,32
Ar 241,33
Ar 242,34
Ar 243,35
Ar 244,36
Ar 245,37
Ar 246,38
Ar 247,39
v_pk_mul_f32 v[240:241], v[240:241], v[252:253]
v_pk_mul_f32 v[242:243], v[242:243], v[252:253]
v_pk_mul_f32 v[244:245], v[244:245], v[252:253]
v_pk_mul_f32 v[246:247], v[246:247], v[252:253]
Vc 28,240,241
Vc 29,242,243
Vc 30,244,245
Vc 31,246,247
buffer_store_dwordx4 v[28:31], v249, s[16:19], s3 offen sc1
Ar 240,0
Ar 241,1
Ar 242,2
Ar 243,3
Ar 244,4
Ar 245,5
Ar 246,6
Ar 247,7
v_pk_mul_f32 v[240:241], v[240:241], v[250:251]
v_pk_mul_f32 v[242:243], v[242:243], v[250:251]
v_pk_mul_f32 v[244:245], v[244:245], v[250:251]
v_pk_mul_f32 v[246:247], v[246:247], v[250:251]
Vc 24,240,241
Vc 25,242,243
Vc 26,244,245
Vc 27,246,247
buffer_store_dwordx4 v[24:27], v248, s[16:19], s3 offen sc1
s_add_u32 s3, s3, 8192
Ar 240,40
Ar 241,41
Ar 242,42
Ar 243,43
Ar 244,44
Ar 245,45
Ar 246,46
Ar 247,47
v_pk_mul_f32 v[240:241], v[240:241], v[252:253]
v_pk_mul_f32 v[242:243], v[242:243], v[252:253]
v_pk_mul_f32 v[244:245], v[244:245], v[252:253]
v_pk_mul_f32 v[246:247], v[246:247], v[252:253]
Vc 28,240,241
Vc 29,242,243
Vc 30,244,245
Vc 31,246,247
buffer_store_dwordx4 v[28:31], v249, s[16:19], s3 offen sc1
Ar 240,8
Ar 241,9
Ar 242,10
Ar 243,11
Ar 244,12
Ar 245,13
Ar 246,14
Ar 247,15
v_pk_mul_f32 v[240:241], v[240:241], v[250:251]
v_pk_mul_f32 v[242:243], v[242:243], v[250:251]
v_pk_mul_f32 v[244:245], v[244:245], v[250:251]
v_pk_mul_f32 v[246:247], v[246:247], v[250:251]
Vc 24,240,241
Vc 25,242,243
Vc 26,244,245
Vc 27,246,247
buffer_store_dwordx4 v[24:27], v248, s[16:19], s3 offen sc1
s_add_u32 s3, s3, 8192
Ar 240,48
Ar 241,49
Ar 242,50
Ar 243,51
Ar 244,52
Ar 245,53
Ar 246,54
Ar 247,55
v_pk_mul_f32 v[240:241], v[240:241], v[252:253]
v_pk_mul_f32 v[242:243], v[242:243], v[252:253]
v_pk_mul_f32 v[244:245], v[244:245], v[252:253]
v_pk_mul_f32 v[246:247], v[246:247], v[252:253]
Vc 28,240,241
Vc 29,242,243
Vc 30,244,245
Vc 31,246,247
buffer_store_dwordx4 v[28:31], v249, s[16:19], s3 offen sc1
Ar 240,16
Ar 241,17
Ar 242,18
Ar 243,19
Ar 244,20
Ar 245,21
Ar 246,22
Ar 247,23
v_pk_mul_f32 v[240:241], v[240:241], v[250:251]
v_pk_mul_f32 v[242:243], v[242:243], v[250:251]
v_pk_mul_f32 v[244:245], v[244:245], v[250:251]
v_pk_mul_f32 v[246:247], v[246:247], v[250:251]
Vc 24,240,241
Vc 25,242,243
Vc 26,244,245
Vc 27,246,247
buffer_store_dwordx4 v[24:27], v248, s[16:19], s3 offen sc1
s_add_u32 s3, s3, 8192
Ar 240,56
Ar 241,57
Ar 242,58
Ar 243,59
Ar 244,60
Ar 245,61
Ar 246,62
Ar 247,63
v_pk_mul_f32 v[240:241], v[240:241], v[252:253]
v_pk_mul_f32 v[242:243], v[242:243], v[252:253]
v_pk_mul_f32 v[244:245], v[244:245], v[252:253]
v_pk_mul_f32 v[246:247], v[246:247], v[252:253]
Vc 28,240,241
Vc 29,242,243
Vc 30,244,245
Vc 31,246,247
buffer_store_dwordx4 v[28:31], v249, s[16:19], s3 offen sc1
Ar 240,24
Ar 241,25
Ar 242,26
Ar 243,27
Ar 244,28
Ar 245,29
Ar 246,30
Ar 247,31
v_pk_mul_f32 v[240:241], v[240:241], v[250:251]
v_pk_mul_f32 v[242:243], v[242:243], v[250:251]
v_pk_mul_f32 v[244:245], v[244:245], v[250:251]
v_pk_mul_f32 v[246:247], v[246:247], v[250:251]
Vc 24,240,241
Vc 25,242,243
Vc 26,244,245
Vc 27,246,247
buffer_store_dwordx4 v[24:27], v248, s[16:19], s3 offen sc1
s_nop 1
v_lshrrev_b32 v24, 4, v0
v_bfe_u32 v25, v0, 2, 2
v_lshl_add_u32 v26, v24, 3, v25
v_lshlrev_b32 v26, 8, v26
v_and_b32 v27, 3, v0
v_lshl_add_u32 v26, v27, 3, v26
v_and_b32_e64 v27, 1, v24
v_lshl_add_u32 v25, v27, 2, v25
s_lshl_b32 s3, s32, 1
v_xor_b32 v25, s3, v25
v_lshl_add_u32 v26, v25, 5, v26
s_sub_u32 s3, s54, s44
v_add_u32 v26, s3, v26
v_xor_b32 v27, 32, v26
s_waitcnt vmcnt(8) lgkmcnt(0)
s_barrier
s_nop 0
ds_read_b64_tr_b16 v[128:129], v26 offset:0
ds_read_b64_tr_b16 v[130:131], v26 offset:1024
ds_read_b64_tr_b16 v[132:133], v27 offset:0
ds_read_b64_tr_b16 v[134:135], v27 offset:1024
ds_read_b64_tr_b16 v[136:137], v26 offset:8192
ds_read_b64_tr_b16 v[138:139], v26 offset:9216
ds_read_b64_tr_b16 v[140:141], v27 offset:8192
ds_read_b64_tr_b16 v[142:143], v27 offset:9216
ds_read_b64_tr_b16 v[144:145], v26 offset:16384
ds_read_b64_tr_b16 v[146:147], v26 offset:17408
ds_read_b64_tr_b16 v[148:149], v27 offset:16384
ds_read_b64_tr_b16 v[150:151], v27 offset:17408
ds_read_b64_tr_b16 v[152:153], v26 offset:24576
ds_read_b64_tr_b16 v[154:155], v26 offset:25600
ds_read_b64_tr_b16 v[156:157], v27 offset:24576
s_waitcnt lgkmcnt(9)
s_nop 0
ds_read_b64_tr_b16 v[158:159], v27 offset:25600
ds_read_b64_tr_b16 v[160:161], v26 offset:32768
ds_read_b64_tr_b16 v[162:163], v26 offset:33792
ds_read_b64_tr_b16 v[164:165], v27 offset:32768
ds_read_b64_tr_b16 v[166:167], v27 offset:33792
ds_read_b64_tr_b16 v[168:169], v26 offset:40960
s_waitcnt lgkmcnt(9)
s_nop 0
ds_read_b64_tr_b16 v[170:171], v26 offset:41984
ds_read_b64_tr_b16 v[172:173], v27 offset:40960
ds_read_b64_tr_b16 v[174:175], v27 offset:41984
ds_read_b64_tr_b16 v[176:177], v26 offset:49152
ds_read_b64_tr_b16 v[178:179], v26 offset:50176
ds_read_b64_tr_b16 v[180:181], v27 offset:49152
s_waitcnt lgkmcnt(9)
ds_read_b64_tr_b16 v[182:183], v27 offset:50176
ds_read_b64_tr_b16 v[184:185], v26 offset:57344
ds_read_b64_tr_b16 v[186:187], v26 offset:58368
ds_read_b64_tr_b16 v[188:189], v27 offset:57344
ds_read_b64_tr_b16 v[190:191], v27 offset:58368
v_and_b32 v25, 15, v0
v_mul_u32_u24 v28, 14336, v25
v_lshl_add_u32 v28, v24, 4, v28
v_mov_b32 v29, 2146435072
v_cmp_gt_u32 vcc, 2, v25
s_mul_i32 s3, s92, 57344
s_lshl_b32 s47, s4, 9
s_add_u32 s3, s3, s47
v_cndmask_b32 v28, v29, v28, vcc
s_lshl_b32 s47, s32, 7
s_add_u32 s3, s3, s47
s_add_u32 s3, s3, 6291456
Zvva 224,128,160
Zvva 228,132,160
Mvva 224,136,164
Mvva 228,140,164
Mvva 224,144,168
Mvva 228,148,168
Mvva 224,152,172
Mvva 228,156,172
s_waitcnt lgkmcnt(0)
Zvva 232,160,160
Zvva 236,164,160
Mvva 232,168,164
Mvva 236,172,164
Mvva 232,176,168
Mvva 236,180,168
Mvva 232,184,172
Mvva 236,188,172
v_mov_b32 v24, 1
v_mul_u32_u24 v25, s65, v0
s_waitcnt vmcnt(0)
s_barrier
s_mov_b64 exec, 3
buffer_store_dword v24, v25, s[20:23], s64 offen sc1
s_mov_b64 exec, -1
s_cmp_lg_u32 s34, 0
s_cselect_b32 s3, s3, 8388608
s_add_u32 s7, s3, 28672
buffer_store_dwordx4 v[224:227], v28, s[20:23], s3 offen offset:0 sc1
buffer_store_dwordx4 v[228:231], v28, s[20:23], s3 offen offset:64 sc1
buffer_store_dwordx4 v[232:235], v28, s[20:23], s7 offen offset:0 sc1
buffer_store_dwordx4 v[236:239], v28, s[20:23], s7 offen offset:64 sc1
s_mov_b32 s3, s36
s_nop 0
buffer_load_dwordx4 v[18:21], v119, s[56:59], s3 offen
s_add_u32 s3, s3, 16384
buffer_load_dwordx4 v[22:25], v119, s[56:59], s3 offen
s_add_u32 s3, s3, 16384
buffer_load_dwordx4 v[26:29], v119, s[56:59], s3 offen
s_add_u32 s3, s3, 16384
buffer_load_dwordx4 v[30:33], v119, s[56:59], s3 offen
s_lshl_b32 s3, s45, 10
s_add_u32 s3, s3, 5259264
v_lshlrev_b32 v124, 3, v120
buffer_load_dwordx2 v[34:35], v124, s[20:23], s3 offen offset:0 sc1
buffer_load_dwordx2 v[36:37], v124, s[20:23], s3 offen offset:64 sc1
buffer_load_dwordx2 v[38:39], v124, s[20:23], s3 offen offset:128 sc1
buffer_load_dwordx2 v[40:41], v124, s[20:23], s3 offen offset:192 sc1
v_and_b32 v10, 15, v0
v_lshlrev_b32 v10, 2, v10
s_add_u32 s95, s32, 32
s_lshl_b32 s95, s95, 16
s_add_u32 s95, s95, s94
s_xor_b32 s95, s95, 128
s_add_u32 m0, s44, 0
s_nop 0
s_nop 0
buffer_load_dwordx4 v114, s[12:15], s48 offen offset:0 lds
buffer_load_dwordx4 v114, s[12:15], s49 offen offset:1024 lds
buffer_load_dwordx4 v114, s[12:15], s50 offen offset:2048 lds
buffer_load_dwordx4 v114, s[12:15], s51 offen offset:3072 lds
v_add_u32 v114, 131072, v114
s_add_u32 m0, s44, 16384
s_nop 0
s_nop 0
buffer_load_dwordx4 v114, s[12:15], s48 offen offset:0 lds
buffer_load_dwordx4 v114, s[12:15], s49 offen offset:1024 lds
buffer_load_dwordx4 v114, s[12:15], s50 offen offset:2048 lds
buffer_load_dwordx4 v114, s[12:15], s51 offen offset:3072 lds
v_add_u32 v114, 131072, v114
buffer_load_dword v124, v10, s[20:23], s38 offen sc1
v_add_u32 v12, 65536, v115
v_add_u32 v13, 65536, v116
v_add_u32 v14, 65536, v117
v_add_u32 v15, 65536, v118
s_and_b32 s39, s2, 15
s_lshr_b32 s37, s2, 4
s_sub_u32 s37, s37, 2
s_lshl_b32 s54, s37, 2
s_add_u32 s54, s54, s32
s_lshl_b32 s3, s54, 17
s_lshl_b32 s7, s39, 7
s_add_u32 s3, s3, s7
s_cmp_ge_u32 s2, 32
s_cselect_b32 s3, s3, 2146435072
v_add_u32 v125, s3, v113
s_mov_b32 s40, 0
s_waitcnt vmcnt(9)
v_lshlrev_b32_e64 v42, 16, v18
v_and_b32 v43, 0xffff0000, v18
v_lshlrev_b32_e64 v44, 16, v19
v_and_b32 v45, 0xffff0000, v19
v_lshlrev_b32_e64 v46, 16, v20
v_and_b32 v47, 0xffff0000, v20
v_lshlrev_b32_e64 v48, 16, v21
v_and_b32 v49, 0xffff0000, v21
v_pk_add_f32 v[42:43], v[42:43], v[34:35] op_sel_hi:[1,0] neg_lo:[0,1] neg_hi:[0,1]
v_pk_add_f32 v[44:45], v[44:45], v[34:35] op_sel_hi:[1,0] neg_lo:[0,1] neg_hi:[0,1]
v_pk_add_f32 v[46:47], v[46:47], v[34:35] op_sel_hi:[1,0] neg_lo:[0,1] neg_hi:[0,1]
v_pk_add_f32 v[48:49], v[48:49], v[34:35] op_sel_hi:[1,0] neg_lo:[0,1] neg_hi:[0,1]
Vc 2,42,43
v_lshlrev_b32_e64 v42, 16, v2
v_and_b32 v43, 0xffff0000, v2
Vc 3,44,45
v_lshlrev_b32_e64 v44, 16, v3
v_and_b32 v45, 0xffff0000, v3
Vc 4,46,47
v_lshlrev_b32_e64 v46, 16, v4
v_and_b32 v47, 0xffff0000, v4
Vc 5,48,49
v_lshlrev_b32_e64 v48, 16, v5
v_and_b32 v49, 0xffff0000, v5
v_pk_mul_f32 v[42:43], v[42:43], v[34:35] op_sel:[0,1] op_sel_hi:[1,1]
v_pk_mul_f32 v[44:45], v[44:45], v[34:35] op_sel:[0,1] op_sel_hi:[1,1]
v_pk_mul_f32 v[46:47], v[46:47], v[34:35] op_sel:[0,1] op_sel_hi:[1,1]
v_pk_mul_f32 v[48:49], v[48:49], v[34:35] op_sel:[0,1] op_sel_hi:[1,1]
Vc 2,42,43
v_lshlrev_b32_e64 v42, 16, v2
v_and_b32 v43, 0xffff0000, v2
Vc 3,44,45
v_lshlrev_b32_e64 v44, 16, v3
v_and_b32 v45, 0xffff0000, v3
Vc 4,46,47
v_lshlrev_b32_e64 v46, 16, v4
v_and_b32 v47, 0xffff0000, v4
Vc 5,48,49
v_lshlrev_b32_e64 v48, 16, v5
v_and_b32 v49, 0xffff0000, v5
v_mul_f32 v2, 0xbfb8aa3b, v42
v_mul_f32 v3, 0xbfb8aa3b, v43
v_mul_f32 v4, 0xbfb8aa3b, v44
v_mul_f32 v5, 0xbfb8aa3b, v45
v_mul_f32 v6, 0xbfb8aa3b, v46
v_mul_f32 v7, 0xbfb8aa3b, v47
v_mul_f32 v8, 0xbfb8aa3b, v48
v_mul_f32 v9, 0xbfb8aa3b, v49
Ve 2,2
Ve 3,3
Ve 4,4
Ve 5,5
Ve 6,6
Ve 7,7
Ve 8,8
Ve 9,9
v_add_f32 v2, 1.0, v2
v_add_f32 v3, 1.0, v3
v_add_f32 v4, 1.0, v4
v_add_f32 v5, 1.0, v5
v_add_f32 v6, 1.0, v6
v_add_f32 v7, 1.0, v7
v_add_f32 v8, 1.0, v8
v_add_f32 v9, 1.0, v9
v_rcp_f32 v2, v2
v_rcp_f32 v3, v3
v_rcp_f32 v4, v4
v_rcp_f32 v5, v5
v_rcp_f32 v6, v6
v_rcp_f32 v7, v7
v_rcp_f32 v8, v8
v_rcp_f32 v9, v9
v_pk_mul_f32 v[42:43], v[42:43], v[2:3]
v_pk_mul_f32 v[44:45], v[44:45], v[4:5]
v_pk_mul_f32 v[46:47], v[46:47], v[6:7]
v_pk_mul_f32 v[48:49], v[48:49], v[8:9]
Vc 2,42,43
v_lshlrev_b32_e64 v42, 16, v2
v_and_b32 v43, 0xffff0000, v2
Vc 3,44,45
v_lshlrev_b32_e64 v44, 16, v3
v_and_b32 v45, 0xffff0000, v3
Vc 4,46,47
v_lshlrev_b32_e64 v46, 16, v4
v_and_b32 v47, 0xffff0000, v4
Vc 5,48,49
v_lshlrev_b32_e64 v48, 16, v5
v_and_b32 v49, 0xffff0000, v5
s_waitcnt vmcnt(0)
v_cmp_ne_u32 vcc, 1, v124
s_cbranch_vccnz L_spinC
s_nop 0
L_spinCr:
buffer_load_dwordx4 a[0:3], v112, s[8:11], s52 offen offset:0 sc1
buffer_load_dwordx4 a[4:7], v112, s[8:11], s52 offen offset:1024 sc1
s_add_u32 s52, s52, 8192
buffer_load_dwordx4 a[8:11], v112, s[8:11], s52 offen offset:0 sc1
buffer_load_dwordx4 a[12:15], v112, s[8:11], s52 offen offset:1024 sc1
s_add_u32 s52, s52, 8192
buffer_load_dwordx4 a[16:19], v112, s[8:11], s52 offen offset:0 sc1
buffer_load_dwordx4 a[20:23], v112, s[8:11], s52 offen offset:1024 sc1
s_add_u32 s52, s52, 8192
buffer_load_dwordx4 a[24:27], v112, s[8:11], s52 offen offset:0 sc1
buffer_load_dwordx4 a[28:31], v112, s[8:11], s52 offen offset:1024 sc1
s_add_u32 s52, s52, 8192
v_lshlrev_b32_e64 v50, 16, v22
v_and_b32 v51, 0xffff0000, v22
v_lshlrev_b32_e64 v52, 16, v23
v_and_b32 v53, 0xffff0000, v23
v_lshlrev_b32_e64 v54, 16, v24
v_and_b32 v55, 0xffff0000, v24
v_lshlrev_b32_e64 v56, 16, v25
v_and_b32 v57, 0xffff0000, v25
v_pk_add_f32 v[50:51], v[50:51], v[36:37] op_sel_hi:[1,0] neg_lo:[0,1] neg_hi:[0,1]
v_pk_add_f32 v[52:53], v[52:53], v[36:37] op_sel_hi:[1,0] neg_lo:[0,1] neg_hi:[0,1]
v_pk_add_f32 v[54:55], v[54:55], v[36:37] op_sel_hi:[1,0] neg_lo:[0,1] neg_hi:[0,1]
v_pk_add_f32 v[56:57], v[56:57], v[36:37] op_sel_hi:[1,0] neg_lo:[0,1] neg_hi:[0,1]
Vc 2,50,51
v_lshlrev_b32_e64 v50, 16, v2
v_and_b32 v51, 0xffff0000, v2
Vc 3,52,53
v_lshlrev_b32_e64 v52, 16, v3
v_and_b32 v53, 0xffff0000, v3
Vc 4,54,55
v_lshlrev_b32_e64 v54, 16, v4
v_and_b32 v55, 0xffff0000, v4
Vc 5,56,57
v_lshlrev_b32_e64 v56, 16, v5
v_and_b32 v57, 0xffff0000, v5
v_pk_mul_f32 v[50:51], v[50:51], v[36:37] op_sel:[0,1] op_sel_hi:[1,1]
v_pk_mul_f32 v[52:53], v[52:53], v[36:37] op_sel:[0,1] op_sel_hi:[1,1]
v_pk_mul_f32 v[54:55], v[54:55], v[36:37] op_sel:[0,1] op_sel_hi:[1,1]
v_pk_mul_f32 v[56:57], v[56:57], v[36:37] op_sel:[0,1] op_sel_hi:[1,1]
Vc 2,50,51
v_lshlrev_b32_e64 v50, 16, v2
v_and_b32 v51, 0xffff0000, v2
Vc 3,52,53
v_lshlrev_b32_e64 v52, 16, v3
v_and_b32 v53, 0xffff0000, v3
Vc 4,54,55
v_lshlrev_b32_e64 v54, 16, v4
v_and_b32 v55, 0xffff0000, v4
Vc 5,56,57
v_lshlrev_b32_e64 v56, 16, v5
v_and_b32 v57, 0xffff0000, v5
v_mul_f32 v2, 0xbfb8aa3b, v50
v_mul_f32 v3, 0xbfb8aa3b, v51
v_mul_f32 v4, 0xbfb8aa3b, v52
v_mul_f32 v5, 0xbfb8aa3b, v53
v_mul_f32 v6, 0xbfb8aa3b, v54
v_mul_f32 v7, 0xbfb8aa3b, v55
v_mul_f32 v8, 0xbfb8aa3b, v56
v_mul_f32 v9, 0xbfb8aa3b, v57
Ve 2,2
Ve 3,3
Ve 4,4
Ve 5,5
Ve 6,6
Ve 7,7
Ve 8,8
Ve 9,9
v_add_f32 v2, 1.0, v2
v_add_f32 v3, 1.0, v3
v_add_f32 v4, 1.0, v4
v_add_f32 v5, 1.0, v5
v_add_f32 v6, 1.0, v6
v_add_f32 v7, 1.0, v7
v_add_f32 v8, 1.0, v8
v_add_f32 v9, 1.0, v9
v_rcp_f32 v2, v2
v_rcp_f32 v3, v3
v_rcp_f32 v4, v4
v_rcp_f32 v5, v5
v_rcp_f32 v6, v6
v_rcp_f32 v7, v7
v_rcp_f32 v8, v8
v_rcp_f32 v9, v9
v_pk_mul_f32 v[50:51], v[50:51], v[2:3]
v_pk_mul_f32 v[52:53], v[52:53], v[4:5]
v_pk_mul_f32 v[54:55], v[54:55], v[6:7]
v_pk_mul_f32 v[56:57], v[56:57], v[8:9]
Vc 2,50,51
v_lshlrev_b32_e64 v50, 16, v2
v_and_b32 v51, 0xffff0000, v2
Vc 3,52,53
v_lshlrev_b32_e64 v52, 16, v3
v_and_b32 v53, 0xffff0000, v3
Vc 4,54,55
v_lshlrev_b32_e64 v54, 16, v4
v_and_b32 v55, 0xffff0000, v4
Vc 5,56,57
v_lshlrev_b32_e64 v56, 16, v5
v_and_b32 v57, 0xffff0000, v5
buffer_load_dwordx4 a[32:35], v112, s[8:11], s52 offen offset:0 sc1
buffer_load_dwordx4 a[36:39], v112, s[8:11], s52 offen offset:1024 sc1
s_add_u32 s52, s52, 8192
buffer_load_dwordx4 a[40:43], v112, s[8:11], s52 offen offset:0 sc1
buffer_load_dwordx4 a[44:47], v112, s[8:11], s52 offen offset:1024 sc1
s_add_u32 s52, s52, 8192
s_add_u32 m0, s44, 32768
s_nop 0
buffer_load_dwordx4 v114, s[12:15], s48 offen offset:0 lds
buffer_load_dwordx4 v114, s[12:15], s49 offen offset:1024 lds
buffer_load_dwordx4 v114, s[12:15], s50 offen offset:2048 lds
buffer_load_dwordx4 v114, s[12:15], s51 offen offset:3072 lds
v_add_u32 v114, 131072, v114
s_cmp_lg_u32 s40, 0
s_cbranch_scc1 L_nowd
s_add_u32 m0, s35, 0
s_nop 0
s_nop 0
buffer_load_dwordx4 v125, s[60:63], s48 offen offset:0 lds
buffer_load_dwordx4 v125, s[60:63], s49 offen offset:1024 lds
buffer_load_dwordx4 v125, s[60:63], s50 offen offset:2048 lds
buffer_load_dwordx4 v125, s[60:63], s51 offen offset:3072 lds
v_add_u32 v125, 65536, v125
s_add_u32 m0, s35, 4096
s_nop 0
buffer_load_dwordx4 v125, s[60:63], s48 offen offset:0 lds
buffer_load_dwordx4 v125, s[60:63], s49 offen offset:1024 lds
buffer_load_dwordx4 v125, s[60:63], s50 offen offset:2048 lds
buffer_load_dwordx4 v125, s[60:63], s51 offen offset:3072 lds
L_nowd:
s_cmp_lt_u32 s2, 128
s_cbranch_scc1 L_noc3
s_bfe_u32 s3, s2, 0x40003
s_lshl_b32 s3, s3, 2
s_add_u32 s3, s3, s32
s_lshl_b32 s3, s3, 15
s_and_b32 s7, s2, 1
s_lshl_b32 s7, s7, 10
s_add_u32 s3, s3, s7
s_add_u32 s3, s3, 384
v_and_b32 v1, 15, v0
v_lshlrev_b32 v1, 11, v1
v_lshrrev_b32_e64 v11, 5, v0
v_lshl_add_u32 v1, v11, 22, v1
buffer_load_dword v11, v1, s[28:31], s3 offen
L_noc3:
s_barrier
s_nop 0
ds_read_b64_tr_b16 v[192:193], v115 offset:0
ds_read_b64_tr_b16 v[194:195], v115 offset:2048
ds_read_b64_tr_b16 v[196:197], v116 offset:0
ds_read_b64_tr_b16 v[198:199], v116 offset:2048
ds_read_b64_tr_b16 v[200:201], v117 offset:0
ds_read_b64_tr_b16 v[202:203], v117 offset:2048
ds_read_b64_tr_b16 v[204:205], v118 offset:0
ds_read_b64_tr_b16 v[206:207], v118 offset:2048
ds_read_b64_tr_b16 v[208:209], v115 offset:4096
ds_read_b64_tr_b16 v[210:211], v115 offset:6144
ds_read_b64_tr_b16 v[212:213], v116 offset:4096
ds_read_b64_tr_b16 v[214:215], v116 offset:6144
ds_read_b64_tr_b16 v[216:217], v117 offset:4096
ds_read_b64_tr_b16 v[218:219], v117 offset:6144
ds_read_b64_tr_b16 v[220:221], v118 offset:4096
s_waitcnt lgkmcnt(9)
ds_read_b64_tr_b16 v[222:223], v118 offset:6144
s_waitcnt vmcnt(12)
Zvva 160,192,0
ds_read_b64_tr_b16 v[224:225], v115 offset:8192
ds_read_b64_tr_b16 v[226:227], v115 offset:10240
v_mov_b32 v125, 1
s_waitcnt lgkmcnt(8)
Mvva 160,208,8
s_lshl_b32 s6, s4, 3
s_add_u32 s6, s6, s92
s_lshl_b32 s6, s6, 2
Zvva 176,192,4
s_waitcnt lgkmcnt(6)
s_add_u32 m0, s44, 49152
ds_read_b64_tr_b16 v[240:241], v115 offset:12288
ds_read_b64_tr_b16 v[242:243], v115 offset:14336
Mvva 176,208,12
buffer_load_dwordx4 v114, s[12:15], s48 offen offset:0 lds
Zvva 164,196,0
ds_read_b64_tr_b16 v[228:229], v116 offset:8192
ds_read_b64_tr_b16 v[230:231], v116 offset:10240
Mvva 164,212,8
s_add_u32 s6, s6, 5447680
s_cmp_eq_u32 s32, 0
s_cselect_b32 s6, s6, s64
s_cmp_lg_u32 s34, 0
s_cselect_b32 s6, s6, 2146435072
Zvva 180,196,4
s_waitcnt lgkmcnt(8)
ds_read_b64_tr_b16 v[244:245], v116 offset:12288
ds_read_b64_tr_b16 v[246:247], v116 offset:14336
Mvva 180,212,12
buffer_load_dwordx4 v114, s[12:15], s49 offen offset:1024 lds
Zvva 168,200,0
ds_read_b64_tr_b16 v[232:233], v117 offset:8192
ds_read_b64_tr_b16 v[234:235], v117 offset:10240
Mvva 168,216,8
s_mov_b64 exec, 1
buffer_store_dword v125, v126, s[20:23], s6 offen sc1
s_mov_b64 exec, -1
Zvva 184,200,4
s_waitcnt lgkmcnt(10)
ds_read_b64_tr_b16 v[248:249], v117 offset:12288
ds_read_b64_tr_b16 v[250:251], v117 offset:14336
Mvva 184,216,12
buffer_load_dwordx4 v114, s[12:15], s50 offen offset:2048 lds
Zvva 172,204,0
ds_read_b64_tr_b16 v[236:237], v118 offset:8192
ds_read_b64_tr_b16 v[238:239], v118 offset:10240
Mvva 172,220,8
s_waitcnt lgkmcnt(10)
s_lshl_b32 s40, s45, 2
s_add_u32 s40, s40, s32
s_lshr_b32 s3, s42, 5
s_lshr_b32 s47, s43, 5
s_cmp_eq_u32 s3, s40
s_cselect_b32 s53, 1, 0
s_cmp_eq_u32 s47, s40
s_cselect_b32 s53, 1, s53
s_mov_b32 s40, 0
Zvva 188,204,4
s_barrier
ds_read_b64_tr_b16 v[252:253], v118 offset:12288
ds_read_b64_tr_b16 v[254:255], v118 offset:14336
Mvva 188,220,12
buffer_load_dwordx4 v114, s[12:15], s51 offen offset:3072 lds
v_add_u32 v114, 131072, v114
Zvva 128,224,0
ds_read_b64_tr_b16 v[192:193], v115 offset:16384
ds_read_b64_tr_b16 v[194:195], v115 offset:18432
Mvva 128,240,8
s_lshl_b32 s41, s46, 7
s_add_u32 s41, s41, 5449728
s_lshl_b32 s55, s46, 13
Zvva 144,224,4
s_waitcnt lgkmcnt(10)
ds_read_b64_tr_b16 v[208:209], v115 offset:20480
ds_read_b64_tr_b16 v[210:211], v115 offset:22528
Mvva 144,240,12
buffer_load_dwordx4 a[48:51], v112, s[8:11], s52 offen offset:0 sc1
Zvva 132,228,0
ds_read_b64_tr_b16 v[196:197], v116 offset:16384
ds_read_b64_tr_b16 v[198:199], v116 offset:18432
Mvva 132,244,8
s_add_u32 s55, s55, 5308416
s_add_u32 s16, s66, 88080384
s_addc_u32 s17, s67, 0
s_and_b32 s17, s17, 0xffff
Zvva 148,228,4
s_waitcnt lgkmcnt(10)
ds_read_b64_tr_b16 v[212:213], v116 offset:20480
ds_read_b64_tr_b16 v[214:215], v116 offset:22528
Mvva 148,244,12
buffer_load_dwordx4 a[52:55], v112, s[8:11], s52 offen offset:1024 sc1
s_add_u32 s52, s52, 8192
Zvva 136,232,0
ds_read_b64_tr_b16 v[200:201], v117 offset:16384
ds_read_b64_tr_b16 v[202:203], v117 offset:18432
Mvva 136,248,8
s_mov_b32 s18, 8388608
s_mov_b32 s19, 0x20000
s_lshl_b32 s24, s2, 2
Zvva 152,232,4
s_waitcnt lgkmcnt(10)
ds_read_b64_tr_b16 v[216:217], v117 offset:20480
ds_read_b64_tr_b16 v[218:219], v117 offset:22528
Mvva 152,248,12
buffer_load_dwordx4 a[56:59], v112, s[8:11], s52 offen offset:0 sc1
Zvva 140,236,0
ds_read_b64_tr_b16 v[204:205], v118 offset:16384
ds_read_b64_tr_b16 v[206:207], v118 offset:18432
Mvva 140,252,8
s_add_u32 s24, s24, s32
s_lshl_b32 s25, s24, 13
s_xor_b32 s26, s25, 262144
Zvva 156,236,4
s_waitcnt lgkmcnt(10)
ds_read_b64_tr_b16 v[220:221], v118 offset:20480
ds_read_b64_tr_b16 v[222:223], v118 offset:22528
Mvva 156,252,12
buffer_load_dwordx4 a[60:63], v112, s[8:11], s52 offen offset:1024 sc1
s_add_u32 s52, s52, 8192
s_waitcnt vmcnt(17)
Mvva 160,192,16
ds_read_b64_tr_b16 v[224:225], v115 offset:24576
ds_read_b64_tr_b16 v[226:227], v115 offset:26624
Mvva 160,208,24
s_lshl_b32 s24, s24, 2
s_xor_b32 s27, s24, 128
s_add_u32 s24, s24, 5452800
Mvva 176,192,20
s_waitcnt lgkmcnt(10)
s_add_u32 m0, s44, 65536
ds_read_b64_tr_b16 v[240:241], v115 offset:28672
ds_read_b64_tr_b16 v[242:243], v115 offset:30720
Mvva 176,208,28
buffer_load_dwordx4 v114, s[12:15], s48 offen offset:0 lds
Mvva 164,196,16
ds_read_b64_tr_b16 v[228:229], v116 offset:24576
ds_read_b64_tr_b16 v[230:231], v116 offset:26624
Mvva 164,212,24
s_add_u32 s27, s27, 5452800
v_lshlrev_b32 v58, 16, v26
v_and_b32 v59, 0xffff0000, v26
v_lshlrev_b32_e64 v60, 16, v27
v_and_b32 v61, 0xffff0000, v27
v_lshlrev_b32_e64 v62, 16, v28
Mvva 180,196,20
s_waitcnt lgkmcnt(10)
ds_read_b64_tr_b16 v[244:245], v116 offset:28672
ds_read_b64_tr_b16 v[246:247], v116 offset:30720
v_and_b32 v63, 0xffff0000, v28
Mvva 180,212,28
buffer_load_dwordx4 v114, s[12:15], s49 offen offset:1024 lds
Mvva 168,200,16
ds_read_b64_tr_b16 v[232:233], v117 offset:24576
ds_read_b64_tr_b16 v[234:235], v117 offset:26624
v_lshlrev_b32 v64, 16, v29
Mvva 168,216,24
v_and_b32 v65, 0xffff0000, v29
Vs 58,58,38
Vs 59,59,38
Vs 60,60,38
Vs 61,61,38
Mvva 184,200,20
s_waitcnt lgkmcnt(10)
ds_read_b64_tr_b16 v[248:249], v117 offset:28672
ds_read_b64_tr_b16 v[250:251], v117 offset:30720
Vs 62,62,38
Mvva 184,216,28
buffer_load_dwordx4 v114, s[12:15], s50 offen offset:2048 lds
Mvva 172,204,16
s_waitcnt vmcnt(12)
ds_read_b64_tr_b16 v[236:237], v118 offset:24576
ds_read_b64_tr_b16 v[238:239], v118 offset:26624
Vs 63,63,38
Mvva 172,220,24
s_waitcnt lgkmcnt(10)
Vs 64,64,38
v_sub_f32_e64 v65, v65, v38
Vc 2,58,59
v_lshlrev_b32_e64 v58, 16, v2
v_and_b32 v59, 0xffff0000, v2
Mvva 188,204,20
s_barrier
ds_read_b64_tr_b16 v[252:253], v118 offset:28672
ds_read_b64_tr_b16 v[254:255], v118 offset:30720
Vc 3,60,61
Mvva 188,220,28
buffer_load_dwordx4 v114, s[12:15], s51 offen offset:3072 lds
v_add_u32 v114, 131072, v114
Mvva 128,224,16
ds_read_b64_tr_b16 v[192:193], v115 offset:32768
ds_read_b64_tr_b16 v[194:195], v115 offset:34816
v_lshlrev_b32 v60, 16, v3
Mvva 128,240,24
v_and_b32 v61, 0xffff0000, v3
Vc 4,62,63
v_lshlrev_b32_e64 v62, 16, v4
v_and_b32 v63, 0xffff0000, v4
Vc 5,64,65
Mvva 144,224,20
s_waitcnt lgkmcnt(10)
ds_read_b64_tr_b16 v[208:209], v115 offset:36864
ds_read_b64_tr_b16 v[210:211], v115 offset:38912
v_lshlrev_b32 v64, 16, v5
Mvva 144,240,28
buffer_load_dwordx4 a[64:67], v112, s[8:11], s52 offen offset:0 sc1
Mvva 132,228,16
ds_read_b64_tr_b16 v[196:197], v116 offset:32768
ds_read_b64_tr_b16 v[198:199], v116 offset:34816
v_and_b32 v65, 0xffff0000, v5
Mvva 132,244,24
Vm 58,58,39
Vm 59,59,39
Vm 60,60,39
Vm 61,61,39
v_mul_f32_e64 v62, v62, v39
Mvva 148,228,20
s_waitcnt lgkmcnt(10)
ds_read_b64_tr_b16 v[212:213], v116 offset:36864
ds_read_b64_tr_b16 v[214:215], v116 offset:38912
Vm 63,63,39
Mvva 148,244,28
buffer_load_dwordx4 a[68:71], v112, s[8:11], s52 offen offset:1024 sc1
s_add_u32 s52, s52, 8192
Mvva 136,232,16
ds_read_b64_tr_b16 v[200:201], v117 offset:32768
ds_read_b64_tr_b16 v[202:203], v117 offset:34816
v_mul_f32_e64 v64, v64, v39
Mvva 136,248,24
v_mul_f32_e64 v65, v65, v39
Vc 2,58,59
v_lshlrev_b32_e64 v58, 16, v2
v_and_b32 v59, 0xffff0000, v2
Vc 3,60,61
Mvva 152,232,20
s_waitcnt lgkmcnt(10)
ds_read_b64_tr_b16 v[216:217], v117 offset:36864
ds_read_b64_tr_b16 v[218:219], v117 offset:38912
v_lshlrev_b32 v60, 16, v3
Mvva 152,248,28
buffer_load_dwordx4 a[72:75], v112, s[8:11], s52 offen offset:0 sc1
Mvva 140,236,16
ds_read_b64_tr_b16 v[204:205], v118 offset:32768
ds_read_b64_tr_b16 v[206:207], v118 offset:34816
v_and_b32 v61, 0xffff0000, v3
Mvva 140,252,24
Vc 4,62,63
v_lshlrev_b32_e64 v62, 16, v4
v_and_b32 v63, 0xffff0000, v4
Vc 5,64,65
v_lshlrev_b32_e64 v64, 16, v5
Mvva 156,236,20
s_waitcnt lgkmcnt(10)
ds_read_b64_tr_b16 v[220:221], v118 offset:36864
ds_read_b64_tr_b16 v[222:223], v118 offset:38912
v_and_b32 v65, 0xffff0000, v5
Mvva 156,252,28
buffer_load_dwordx4 a[76:79], v112, s[8:11], s52 offen offset:1024 sc1
s_add_u32 s52, s52, 8192
Mvva 160,192,32
ds_read_b64_tr_b16 v[224:225], v115 offset:40960
ds_read_b64_tr_b16 v[226:227], v115 offset:43008
v_mul_f32 v2, 0xbfb8aa3b, v58
Mvva 160,208,40
v_mul_f32 v3, 0xbfb8aa3b, v59
v_mul_f32 v4, 0xbfb8aa3b, v60
v_mul_f32 v5, 0xbfb8aa3b, v61
v_mul_f32 v6, 0xbfb8aa3b, v62
v_mul_f32 v7, 0xbfb8aa3b, v63
Mvva 176,192,36
s_waitcnt lgkmcnt(10)
s_add_u32 m0, s44, 81920
ds_read_b64_tr_b16 v[240:241], v115 offset:45056
ds_read_b64_tr_b16 v[242:243], v115 offset:47104
v_mul_f32 v8, 0xbfb8aa3b, v64
Mvva 176,208,44
buffer_load_dwordx4 v114, s[12:15], s48 offen offset:0 lds
Mvva 164,196,32
ds_read_b64_tr_b16 v[228:229], v116 offset:40960
ds_read_b64_tr_b16 v[230:231], v116 offset:43008
v_mul_f32 v9, 0xbfb8aa3b, v65
Mvva 164,212,40
Ve 2,2
Ve 3,3
Mvva 180,196,36
s_waitcnt lgkmcnt(10)
ds_read_b64_tr_b16 v[244:245], v116 offset:45056
ds_read_b64_tr_b16 v[246:247], v116 offset:47104
Mvva 180,212,44
buffer_load_dwordx4 v114, s[12:15], s49 offen offset:1024 lds
Mvva 168,200,32
ds_read_b64_tr_b16 v[232:233], v117 offset:40960
ds_read_b64_tr_b16 v[234:235], v117 offset:43008
Mvva 168,216,40
Ve 4,4
VE 5,5
Mvva 184,200,36
s_waitcnt lgkmcnt(10)
ds_read_b64_tr_b16 v[248:249], v117 offset:45056
ds_read_b64_tr_b16 v[250:251], v117 offset:47104
Mvva 184,216,44
buffer_load_dwordx4 v114, s[12:15], s50 offen offset:2048 lds
Mvva 172,204,32
s_waitcnt vmcnt(15)
ds_read_b64_tr_b16 v[236:237], v118 offset:40960
ds_read_b64_tr_b16 v[238:239], v118 offset:43008
Mvva 172,220,40
s_waitcnt lgkmcnt(10)
Ve 6,6
VE 7,7
Mvva 188,204,36
s_barrier
ds_read_b64_tr_b16 v[252:253], v118 offset:45056
ds_read_b64_tr_b16 v[254:255], v118 offset:47104
Mvva 188,220,44
buffer_load_dwordx4 v114, s[12:15], s51 offen offset:3072 lds
v_add_u32 v114, 131072, v114
Mvva 128,224,32
ds_read_b64_tr_b16 v[192:193], v115 offset:49152
ds_read_b64_tr_b16 v[194:195], v115 offset:51200
Mvva 128,240,40
Ve 8,8
Ve 9,9
v_add_f32 v2, 1.0, v2
Mvva 144,224,36
s_waitcnt lgkmcnt(10)
ds_read_b64_tr_b16 v[208:209], v115 offset:53248
ds_read_b64_tr_b16 v[210:211], v115 offset:55296
v_add_f32 v3, 1.0, v3
Mvva 144,240,44
buffer_load_dwordx4 a[80:83], v112, s[8:11], s52 offen offset:0 sc1
Mvva 132,228,32
ds_read_b64_tr_b16 v[196:197], v116 offset:49152
ds_read_b64_tr_b16 v[198:199], v116 offset:51200
v_add_f32_e64 v4, 1.0, v4
Mvva 132,244,40
v_add_f32 v5, 1.0, v5
v_add_f32 v6, 1.0, v6
v_add_f32 v7, 1.0, v7
v_add_f32 v8, 1.0, v8
v_add_f32_e64 v9, 1.0, v9
Mvva 148,228,36
s_waitcnt lgkmcnt(10)
ds_read_b64_tr_b16 v[212:213], v116 offset:53248
ds_read_b64_tr_b16 v[214:215], v116 offset:55296
Mvva 148,244,44
buffer_load_dwordx4 a[84:87], v112, s[8:11], s52 offen offset:1024 sc1
s_add_u32 s52, s52, 8192
Mvva 136,232,32
ds_read_b64_tr_b16 v[200:201], v117 offset:49152
ds_read_b64_tr_b16 v[202:203], v117 offset:51200
Mvva 136,248,40
v_rcp_f32 v2, v2
v_rcp_f32_e64 v3, v3
Mvva 152,232,36
s_waitcnt lgkmcnt(10)
ds_read_b64_tr_b16 v[216:217], v117 offset:53248
ds_read_b64_tr_b16 v[218:219], v117 offset:55296
Mvva 152,248,44
buffer_load_dwordx4 a[88:91], v112, s[8:11], s52 offen offset:0 sc1
Mvva 140,236,32
ds_read_b64_tr_b16 v[204:205], v118 offset:49152
ds_read_b64_tr_b16 v[206:207], v118 offset:51200
Mvva 140,252,40
v_rcp_f32 v4, v4
v_rcp_f32_e64 v5, v5
Mvva 156,236,36
s_waitcnt lgkmcnt(10)
ds_read_b64_tr_b16 v[220:221], v118 offset:53248
ds_read_b64_tr_b16 v[222:223], v118 offset:55296
Mvva 156,252,44
buffer_load_dwordx4 a[92:95], v112, s[8:11], s52 offen offset:1024 sc1
s_add_u32 s52, s52, 8192
s_waitcnt vmcnt(16)
Mvva 160,192,48
ds_read_b64_tr_b16 v[224:225], v115 offset:57344
ds_read_b64_tr_b16 v[226:227], v115 offset:59392
Mvva 160,208,56
v_rcp_f32 v6, v6
v_rcp_f32 v7, v7
Mvva 176,192,52
s_waitcnt lgkmcnt(10)
s_add_u32 m0, s44, 98304
ds_read_b64_tr_b16 v[240:241], v115 offset:61440
ds_read_b64_tr_b16 v[242:243], v115 offset:63488
Mvva 176,208,60
buffer_load_dwordx4 v114, s[12:15], s48 offen offset:0 lds
Mvva 164,196,48
ds_read_b64_tr_b16 v[228:229], v116 offset:57344
ds_read_b64_tr_b16 v[230:231], v116 offset:59392
Mvva 164,212,56
v_rcp_f32 v8, v8
v_rcp_f32 v9, v9
Vm 58,58,2
Mvva 180,196,52
s_waitcnt lgkmcnt(10)
ds_read_b64_tr_b16 v[244:245], v116 offset:61440
ds_read_b64_tr_b16 v[246:247], v116 offset:63488
Vm 59,59,3
Mvva 180,212,60
buffer_load_dwordx4 v114, s[12:15], s49 offen offset:1024 lds
Mvva 168,200,48
ds_read_b64_tr_b16 v[232:233], v117 offset:57344
ds_read_b64_tr_b16 v[234:235], v117 offset:59392
v_mul_f32_e64 v60, v60, v4
Mvva 168,216,56
Vm 61,61,5
Vm 62,62,6
Vm 63,63,7
Vm 64,64,8
v_mul_f32_e64 v65, v65, v9
Mvva 184,200,52
s_waitcnt lgkmcnt(10)
ds_read_b64_tr_b16 v[248:249], v117 offset:61440
ds_read_b64_tr_b16 v[250:251], v117 offset:63488
Vc 2,58,59
Mvva 184,216,60
buffer_load_dwordx4 v114, s[12:15], s50 offen offset:2048 lds
Mvva 172,204,48
s_waitcnt vmcnt(15)
ds_read_b64_tr_b16 v[236:237], v118 offset:57344
ds_read_b64_tr_b16 v[238:239], v118 offset:59392
v_lshlrev_b32_e64 v58, 16, v2
Mvva 172,220,56
s_waitcnt lgkmcnt(10)
v_and_b32 v59, 0xffff0000, v2
Vc 3,60,61
v_lshlrev_b32 v60, 16, v3
v_and_b32 v61, 0xffff0000, v3
Vc 4,62,63
Mvva 188,204,52
s_barrier
ds_read_b64_tr_b16 v[252:253], v118 offset:61440
ds_read_b64_tr_b16 v[254:255], v118 offset:63488
v_lshlrev_b32 v62, 16, v4
Mvva 188,220,60
buffer_load_dwordx4 v114, s[12:15], s51 offen offset:3072 lds
v_add_u32 v114, 131072, v114
Mvva 128,224,48
ds_read_b64_tr_b16 v[192:193], v12 offset:0
ds_read_b64_tr_b16 v[194:195], v12 offset:2048
v_and_b32 v63, 0xffff0000, v4
Mvva 128,240,56
Vc 5,64,65
v_lshlrev_b32_e64 v64, 16, v5
v_and_b32 v65, 0xffff0000, v5
v_lshlrev_b32_e64 v66, 16, v30
v_and_b32 v67, 0xffff0000, v30
Mvva 144,224,52
s_waitcnt lgkmcnt(10)
ds_read_b64_tr_b16 v[208:209], v12 offset:4096
ds_read_b64_tr_b16 v[210:211], v12 offset:6144
v_lshlrev_b32 v68, 16, v31
Mvva 144,240,60
buffer_load_dwordx4 a[96:99], v112, s[8:11], s52 offen offset:0 sc1
Mvva 132,228,48
ds_read_b64_tr_b16 v[196:197], v13 offset:0
ds_read_b64_tr_b16 v[198:199], v13 offset:2048
v_and_b32 v69, 0xffff0000, v31
Mvva 132,244,56
v_lshlrev_b32_e64 v70, 16, v32
v_and_b32 v71, 0xffff0000, v32
v_lshlrev_b32_e64 v72, 16, v33
v_and_b32 v73, 0xffff0000, v33
v_sub_f32_e64 v66, v66, v40
Mvva 148,228,52
s_waitcnt lgkmcnt(10)
ds_read_b64_tr_b16 v[212:213], v13 offset:4096
ds_read_b64_tr_b16 v[214:215], v13 offset:6144
Vs 67,67,40
Mvva 148,244,60
buffer_load_dwordx4 a[100:103], v112, s[8:11], s52 offen offset:1024 sc1
s_add_u32 s52, s52, 8192
Mvva 136,232,48
ds_read_b64_tr_b16 v[200:201], v14 offset:0
ds_read_b64_tr_b16 v[202:203], v14 offset:2048
v_sub_f32_e64 v68, v68, v40
Mvva 136,248,56
Vs 69,69,40
Vs 70,70,40
Vs 71,71,40
Vs 72,72,40
v_sub_f32_e64 v73, v73, v40
Mvva 152,232,52
s_waitcnt lgkmcnt(10)
ds_read_b64_tr_b16 v[216:217], v14 offset:4096
ds_read_b64_tr_b16 v[218:219], v14 offset:6144
Vc 2,66,67
Mvva 152,248,60
buffer_load_dwordx4 a[104:107], v112, s[8:11], s52 offen offset:0 sc1
Mvva 140,236,48
ds_read_b64_tr_b16 v[204:205], v15 offset:0
ds_read_b64_tr_b16 v[206:207], v15 offset:2048
v_lshlrev_b32 v66, 16, v2
Mvva 140,252,56
v_and_b32 v67, 0xffff0000, v2
Vc 3,68,69
v_lshlrev_b32_e64 v68, 16, v3
v_and_b32 v69, 0xffff0000, v3
Vc 4,70,71
Mvva 156,236,52
s_waitcnt lgkmcnt(10)
ds_read_b64_tr_b16 v[220:221], v15 offset:4096
ds_read_b64_tr_b16 v[222:223], v15 offset:6144
v_lshlrev_b32 v70, 16, v4
Mvva 156,252,60
buffer_load_dwordx4 a[108:111], v112, s[8:11], s52 offen offset:1024 sc1
s_add_u32 s52, s52, 8192
s_waitcnt vmcnt(16)
Mvva 160,192,64
ds_read_b64_tr_b16 v[224:225], v12 offset:8192
ds_read_b64_tr_b16 v[226:227], v12 offset:10240
v_and_b32 v71, 0xffff0000, v4
Mvva 160,208,72
s_cmp_ge_u32 s2, 32
s_cbranch_scc1 L_f2A
L_f2Ar:
Mvva 176,192,68
s_waitcnt lgkmcnt(10)
s_add_u32 m0, s44, 114688
ds_read_b64_tr_b16 v[240:241], v12 offset:12288
ds_read_b64_tr_b16 v[242:243], v12 offset:14336
Vc 5,72,73
Mvva 176,208,76
buffer_load_dwordx4 v114, s[12:15], s48 offen offset:0 lds
Mvva 164,196,64
ds_read_b64_tr_b16 v[228:229], v13 offset:8192
ds_read_b64_tr_b16 v[230:231], v13 offset:10240
v_lshlrev_b32_e64 v72, 16, v5
Mvva 164,212,72
v_and_b32 v73, 0xffff0000, v5
Vm 66,66,41
Vm 67,67,41
Vm 68,68,41
Vm 69,69,41
Mvva 180,196,68
s_waitcnt lgkmcnt(10)
ds_read_b64_tr_b16 v[244:245], v13 offset:12288
ds_read_b64_tr_b16 v[246:247], v13 offset:14336
Vm 70,70,41
Mvva 180,212,76
buffer_load_dwordx4 v114, s[12:15], s49 offen offset:1024 lds
Mvva 168,200,64
ds_read_b64_tr_b16 v[232:233], v14 offset:8192
ds_read_b64_tr_b16 v[234:235], v14 offset:10240
v_mul_f32_e64 v71, v71, v41
Mvva 168,216,72
Vm 72,72,41
Vm 73,73,41
Vc 2,66,67
v_lshlrev_b32_e64 v66, 16, v2
v_and_b32 v67, 0xffff0000, v2
Mvva 184,200,68
s_waitcnt lgkmcnt(10)
ds_read_b64_tr_b16 v[248:249], v14 offset:12288
ds_read_b64_tr_b16 v[250:251], v14 offset:14336
Vc 3,68,69
Mvva 184,216,76
buffer_load_dwordx4 v114, s[12:15], s50 offen offset:2048 lds
Mvva 172,204,64
s_waitcnt vmcnt(15)
ds_read_b64_tr_b16 v[236:237], v15 offset:8192
ds_read_b64_tr_b16 v[238:239], v15 offset:10240
v_lshlrev_b32_e64 v68, 16, v3
Mvva 172,220,72
s_waitcnt lgkmcnt(10)
v_and_b32 v69, 0xffff0000, v3
Vc 4,70,71
v_lshlrev_b32 v70, 16, v4
v_and_b32 v71, 0xffff0000, v4
Vc 5,72,73
Mvva 188,204,68
s_barrier
ds_read_b64_tr_b16 v[252:253], v15 offset:12288
ds_read_b64_tr_b16 v[254:255], v15 offset:14336
v_lshlrev_b32 v72, 16, v5
Mvva 188,220,76
buffer_load_dwordx4 v114, s[12:15], s51 offen offset:3072 lds
v_add_u32 v114, 131072, v114
Mvva 128,224,64
ds_read_b64_tr_b16 v[192:193], v12 offset:16384
ds_read_b64_tr_b16 v[194:195], v12 offset:18432
v_and_b32 v73, 0xffff0000, v5
Mvva 128,240,72
v_mul_f32 v2, 0xbfb8aa3b, v66
v_mul_f32 v3, 0xbfb8aa3b, v67
v_mul_f32 v4, 0xbfb8aa3b, v68
v_mul_f32 v5, 0xbfb8aa3b, v69
v_mul_f32 v6, 0xbfb8aa3b, v70
Mvva 144,224,68
s_waitcnt lgkmcnt(10)
ds_read_b64_tr_b16 v[208:209], v12 offset:20480
ds_read_b64_tr_b16 v[210:211], v12 offset:22528
v_mul_f32 v7, 0xbfb8aa3b, v71
Mvva 144,240,76
buffer_load_dwordx4 a[112:115], v112, s[8:11], s52 offen offset:0 sc1
Mvva 132,228,64
ds_read_b64_tr_b16 v[196:197], v13 offset:16384
ds_read_b64_tr_b16 v[198:199], v13 offset:18432
v_mul_f32 v8, 0xbfb8aa3b, v72
Mvva 132,244,72
v_mul_f32 v9, 0xbfb8aa3b, v73
Ve 2,2
VE 3,3
Mvva 148,228,68
s_waitcnt lgkmcnt(10)
ds_read_b64_tr_b16 v[212:213], v13 offset:20480
ds_read_b64_tr_b16 v[214:215], v13 offset:22528
Mvva 148,244,76
buffer_load_dwordx4 a[116:119], v112, s[8:11], s52 offen offset:1024 sc1
s_add_u32 s52, s52, 8192
Mvva 136,232,64
ds_read_b64_tr_b16 v[200:201], v14 offset:16384
ds_read_b64_tr_b16 v[202:203], v14 offset:18432
Mvva 136,248,72
Ve 4,4
VE 5,5
Mvva 152,232,68
s_waitcnt lgkmcnt(10)
ds_read_b64_tr_b16 v[216:217], v14 offset:20480
ds_read_b64_tr_b16 v[218:219], v14 offset:22528
Mvva 152,248,76
buffer_load_dwordx4 a[120:123], v112, s[8:11], s52 offen offset:0 sc1
Mvva 140,236,64
ds_read_b64_tr_b16 v[204:205], v15 offset:16384
ds_read_b64_tr_b16 v[206:207], v15 offset:18432
Mvva 140,252,72
Ve 6,6
VE 7,7
Mvva 156,236,68
s_waitcnt lgkmcnt(10)
ds_read_b64_tr_b16 v[220:221], v15 offset:20480
ds_read_b64_tr_b16 v[222:223], v15 offset:22528
Mvva 156,252,76
buffer_load_dwordx4 a[124:127], v112, s[8:11], s52 offen offset:1024 sc1
s_add_u32 s52, s52, 8192
s_waitcnt vmcnt(16)
Mvva 160,192,80
ds_read_b64_tr_b16 v[224:225], v12 offset:24576
ds_read_b64_tr_b16 v[226:227], v12 offset:26624
Mvva 160,208,88
Ve 8,8
Ve 9,9
v_add_f32_e64 v2, 1.0, v2
Mvva 176,192,84
s_waitcnt lgkmcnt(10)
s_add_u32 m0, s44, 0
ds_read_b64_tr_b16 v[240:241], v12 offset:28672
ds_read_b64_tr_b16 v[242:243], v12 offset:30720
v_add_f32_e64 v3, 1.0, v3
Mvva 176,208,92
buffer_load_dwordx4 v114, s[12:15], s48 offen offset:0 lds
Mvva 164,196,80
ds_read_b64_tr_b16 v[228:229], v13 offset:24576
ds_read_b64_tr_b16 v[230:231], v13 offset:26624
v_add_f32_e64 v4, 1.0, v4
Mvva 164,212,88
v_add_f32 v5, 1.0, v5
v_add_f32 v6, 1.0, v6
v_add_f32 v7, 1.0, v7
v_add_f32 v8, 1.0, v8
v_add_f32_e64 v9, 1.0, v9
Mvva 180,196,84
s_waitcnt lgkmcnt(10)
ds_read_b64_tr_b16 v[244:245], v13 offset:28672
ds_read_b64_tr_b16 v[246:247], v13 offset:30720
Mvva 180,212,92
buffer_load_dwordx4 v114, s[12:15], s49 offen offset:1024 lds
Mvva 168,200,80
ds_read_b64_tr_b16 v[232:233], v14 offset:24576
ds_read_b64_tr_b16 v[234:235], v14 offset:26624
Mvva 168,216,88
v_rcp_f32 v2, v2
v_rcp_f32_e64 v3, v3
Mvva 184,200,84
s_waitcnt lgkmcnt(10)
ds_read_b64_tr_b16 v[248:249], v14 offset:28672
ds_read_b64_tr_b16 v[250:251], v14 offset:30720
Mvva 184,216,92
buffer_load_dwordx4 v114, s[12:15], s50 offen offset:2048 lds
Mvva 172,204,80
s_waitcnt vmcnt(15)
ds_read_b64_tr_b16 v[236:237], v15 offset:24576
ds_read_b64_tr_b16 v[238:239], v15 offset:26624
Mvva 172,220,88
s_waitcnt lgkmcnt(10)
v_rcp_f32 v4, v4
v_rcp_f32_e64 v5, v5
Mvva 188,204,84
s_barrier
ds_read_b64_tr_b16 v[252:253], v15 offset:28672
ds_read_b64_tr_b16 v[254:255], v15 offset:30720
Mvva 188,220,92
buffer_load_dwordx4 v114, s[12:15], s51 offen offset:3072 lds
v_add_u32 v114, 131072, v114
Mvva 128,224,80
ds_read_b64_tr_b16 v[192:193], v12 offset:32768
ds_read_b64_tr_b16 v[194:195], v12 offset:34816
Mvva 128,240,88
v_rcp_f32 v6, v6
v_rcp_f32_e64 v7, v7
Mvva 144,224,84
s_waitcnt lgkmcnt(10)
ds_read_b64_tr_b16 v[208:209], v12 offset:36864
ds_read_b64_tr_b16 v[210:211], v12 offset:38912
Mvva 144,240,92
buffer_load_dwordx4 a[128:131], v112, s[8:11], s52 offen offset:0 sc1
Mvva 132,228,80
ds_read_b64_tr_b16 v[196:197], v13 offset:32768
ds_read_b64_tr_b16 v[198:199], v13 offset:34816
Mvva 132,244,88
v_rcp_f32 v8, v8
v_rcp_f32 v9, v9
Vm 66,66,2
Mvva 148,228,84
s_waitcnt lgkmcnt(10)
ds_read_b64_tr_b16 v[212:213], v13 offset:36864
ds_read_b64_tr_b16 v[214:215], v13 offset:38912
Vm 67,67,3
Mvva 148,244,92
buffer_load_dwordx4 a[132:135], v112, s[8:11], s52 offen offset:1024 sc1
s_add_u32 s52, s52, 8192
Mvva 136,232,80
ds_read_b64_tr_b16 v[200:201], v14 offset:32768
ds_read_b64_tr_b16 v[202:203], v14 offset:34816
v_mul_f32_e64 v68, v68, v4
Mvva 136,248,88
Vm 69,69,5
Vm 70,70,6
Vm 71,71,7
Vm 72,72,8
v_mul_f32_e64 v73, v73, v9
Mvva 152,232,84
s_waitcnt lgkmcnt(10)
ds_read_b64_tr_b16 v[216:217], v14 offset:36864
ds_read_b64_tr_b16 v[218:219], v14 offset:38912
Vc 2,66,67
Mvva 152,248,92
buffer_load_dwordx4 a[136:139], v112, s[8:11], s52 offen offset:0 sc1
Mvva 140,236,80
ds_read_b64_tr_b16 v[204:205], v15 offset:32768
ds_read_b64_tr_b16 v[206:207], v15 offset:34816
v_lshlrev_b32 v66, 16, v2
Mvva 140,252,88
v_and_b32 v67, 0xffff0000, v2
Vc 3,68,69
v_lshlrev_b32_e64 v68, 16, v3
v_and_b32 v69, 0xffff0000, v3
Vc 4,70,71
Mvva 156,236,84
s_waitcnt lgkmcnt(10)
ds_read_b64_tr_b16 v[220:221], v15 offset:36864
ds_read_b64_tr_b16 v[222:223], v15 offset:38912
v_lshlrev_b32 v70, 16, v4
Mvva 156,252,92
buffer_load_dwordx4 a[140:143], v112, s[8:11], s52 offen offset:1024 sc1
s_add_u32 s52, s52, 8192
s_waitcnt vmcnt(16)
Mvva 160,192,96
ds_read_b64_tr_b16 v[224:225], v12 offset:40960
ds_read_b64_tr_b16 v[226:227], v12 offset:43008
v_and_b32 v71, 0xffff0000, v4
Mvva 160,208,104
Vc 5,72,73
v_lshlrev_b32 v72, 16, v5
v_and_b32 v73, 0xffff0000, v5
Mvva 176,192,100
s_waitcnt lgkmcnt(10)
s_add_u32 m0, s44, 16384
ds_read_b64_tr_b16 v[240:241], v12 offset:45056
ds_read_b64_tr_b16 v[242:243], v12 offset:47104
Mvva 176,208,108
buffer_load_dwordx4 v114, s[12:15], s48 offen offset:0 lds
Mvva 164,196,96
ds_read_b64_tr_b16 v[228:229], v13 offset:40960
ds_read_b64_tr_b16 v[230:231], v13 offset:43008
Mvva 164,212,104
Mvva 180,196,100
s_waitcnt lgkmcnt(10)
ds_read_b64_tr_b16 v[244:245], v13 offset:45056
ds_read_b64_tr_b16 v[246:247], v13 offset:47104
Mvva 180,212,108
buffer_load_dwordx4 v114, s[12:15], s49 offen offset:1024 lds
Mvva 168,200,96
ds_read_b64_tr_b16 v[232:233], v14 offset:40960
ds_read_b64_tr_b16 v[234:235], v14 offset:43008
Mvva 168,216,104
Mvva 184,200,100
s_waitcnt lgkmcnt(10)
ds_read_b64_tr_b16 v[248:249], v14 offset:45056
ds_read_b64_tr_b16 v[250:251], v14 offset:47104
Mvva 184,216,108
buffer_load_dwordx4 v114, s[12:15], s50 offen offset:2048 lds
Mvva 172,204,96
s_waitcnt vmcnt(15)
ds_read_b64_tr_b16 v[236:237], v15 offset:40960
ds_read_b64_tr_b16 v[238:239], v15 offset:43008
Mvva 172,220,104
s_waitcnt lgkmcnt(10)
s_cmp_ge_u32 s2, 32
s_cbranch_scc1 L_f2B
L_f2Br:
Mvva 188,204,100
s_barrier
ds_read_b64_tr_b16 v[252:253], v15 offset:45056
ds_read_b64_tr_b16 v[254:255], v15 offset:47104
Mvva 188,220,108
buffer_load_dwordx4 v114, s[12:15], s51 offen offset:3072 lds
v_add_u32 v114, 131072, v114
Mvva 128,224,96
ds_read_b64_tr_b16 v[192:193], v12 offset:49152
ds_read_b64_tr_b16 v[194:195], v12 offset:51200
Mvva 128,240,104
Mvva 144,224,100
s_waitcnt lgkmcnt(10)
ds_read_b64_tr_b16 v[208:209], v12 offset:53248
ds_read_b64_tr_b16 v[210:211], v12 offset:55296
Mvva 144,240,108
buffer_load_dwordx4 a[144:147], v112, s[8:11], s52 offen offset:0 sc1
Mvva 132,228,96
ds_read_b64_tr_b16 v[196:197], v13 offset:49152
ds_read_b64_tr_b16 v[198:199], v13 offset:51200
Mvva 132,244,104
Mvva 148,228,100
s_waitcnt lgkmcnt(10)
ds_read_b64_tr_b16 v[212:213], v13 offset:53248
ds_read_b64_tr_b16 v[214:215], v13 offset:55296
Mvva 148,244,108
buffer_load_dwordx4 a[148:151], v112, s[8:11], s52 offen offset:1024 sc1
s_add_u32 s52, s52, 8192
Mvva 136,232,96
ds_read_b64_tr_b16 v[200:201], v14 offset:49152
ds_read_b64_tr_b16 v[202:203], v14 offset:51200
Mvva 136,248,104
Mvva 152,232,100
s_waitcnt lgkmcnt(10)
ds_read_b64_tr_b16 v[216:217], v14 offset:53248
ds_read_b64_tr_b16 v[218:219], v14 offset:55296
Mvva 152,248,108
buffer_load_dwordx4 a[152:155], v112, s[8:11], s52 offen offset:0 sc1
Mvva 140,236,96
ds_read_b64_tr_b16 v[204:205], v15 offset:49152
ds_read_b64_tr_b16 v[206:207], v15 offset:51200
Mvva 140,252,104
Mvva 156,236,100
s_waitcnt lgkmcnt(10)
ds_read_b64_tr_b16 v[220:221], v15 offset:53248
ds_read_b64_tr_b16 v[222:223], v15 offset:55296
Mvva 156,252,108
buffer_load_dwordx4 a[156:159], v112, s[8:11], s52 offen offset:1024 sc1
s_add_u32 s52, s52, 8192
s_waitcnt vmcnt(16)
Mvva 160,192,112
ds_read_b64_tr_b16 v[224:225], v12 offset:57344
ds_read_b64_tr_b16 v[226:227], v12 offset:59392
Mvva 160,208,120
Mvva 176,192,116
s_waitcnt lgkmcnt(10)
s_add_u32 m0, s44, 32768
ds_read_b64_tr_b16 v[240:241], v12 offset:61440
ds_read_b64_tr_b16 v[242:243], v12 offset:63488
Mvva 176,208,124
buffer_load_dwordx4 v114, s[12:15], s48 offen offset:0 lds
Mvva 164,196,112
ds_read_b64_tr_b16 v[228:229], v13 offset:57344
ds_read_b64_tr_b16 v[230:231], v13 offset:59392
Mvva 164,212,120
Mvva 180,196,116
s_waitcnt lgkmcnt(10)
ds_read_b64_tr_b16 v[244:245], v13 offset:61440
ds_read_b64_tr_b16 v[246:247], v13 offset:63488
Mvva 180,212,124
buffer_load_dwordx4 v114, s[12:15], s49 offen offset:1024 lds
Mvva 168,200,112
ds_read_b64_tr_b16 v[232:233], v14 offset:57344
ds_read_b64_tr_b16 v[234:235], v14 offset:59392
Mvva 168,216,120
Mvva 184,200,116
s_waitcnt lgkmcnt(10)
ds_read_b64_tr_b16 v[248:249], v14 offset:61440
ds_read_b64_tr_b16 v[250:251], v14 offset:63488
Mvva 184,216,124
buffer_load_dwordx4 v114, s[12:15], s50 offen offset:2048 lds
Mvva 172,204,112
s_waitcnt vmcnt(15)
ds_read_b64_tr_b16 v[236:237], v15 offset:57344
ds_read_b64_tr_b16 v[238:239], v15 offset:59392
Mvva 172,220,120
s_waitcnt lgkmcnt(10)
Mvva 188,204,116
s_barrier
ds_read_b64_tr_b16 v[252:253], v15 offset:61440
ds_read_b64_tr_b16 v[254:255], v15 offset:63488
Mvva 188,220,124
buffer_load_dwordx4 v114, s[12:15], s51 offen offset:3072 lds
v_add_u32 v114, 131072, v114
Mvva 128,224,112
ds_read_b64_tr_b16 v[192:193], v115 offset:0
ds_read_b64_tr_b16 v[194:195], v115 offset:2048
Mvva 128,240,120
Mvva 144,224,116
s_waitcnt lgkmcnt(10)
ds_read_b64_tr_b16 v[208:209], v115 offset:4096
ds_read_b64_tr_b16 v[210:211], v115 offset:6144
Mvva 144,240,124
buffer_load_dwordx4 a[160:163], v112, s[8:11], s52 offen offset:0 sc1
Mvva 132,228,112
ds_read_b64_tr_b16 v[196:197], v116 offset:0
ds_read_b64_tr_b16 v[198:199], v116 offset:2048
Mvva 132,244,120
Mvva 148,228,116
s_waitcnt lgkmcnt(10)
ds_read_b64_tr_b16 v[212:213], v116 offset:4096
ds_read_b64_tr_b16 v[214:215], v116 offset:6144
Mvva 148,244,124
buffer_load_dwordx4 a[164:167], v112, s[8:11], s52 offen offset:1024 sc1
s_add_u32 s52, s52, 8192
Mvva 136,232,112
ds_read_b64_tr_b16 v[200:201], v117 offset:0
ds_read_b64_tr_b16 v[202:203], v117 offset:2048
Mvva 136,248,120
Mvva 152,232,116
s_waitcnt lgkmcnt(10)
ds_read_b64_tr_b16 v[216:217], v117 offset:4096
ds_read_b64_tr_b16 v[218:219], v117 offset:6144
Mvva 152,248,124
buffer_load_dwordx4 a[168:171], v112, s[8:11], s52 offen offset:0 sc1
Mvva 140,236,112
ds_read_b64_tr_b16 v[204:205], v118 offset:0
ds_read_b64_tr_b16 v[206:207], v118 offset:2048
Mvva 140,252,120
Mvva 156,236,116
s_waitcnt lgkmcnt(10)
ds_read_b64_tr_b16 v[220:221], v118 offset:4096
ds_read_b64_tr_b16 v[222:223], v118 offset:6144
Mvva 156,252,124
buffer_load_dwordx4 a[172:175], v112, s[8:11], s52 offen offset:1024 sc1
s_add_u32 s52, s52, 8192
s_waitcnt vmcnt(16)
Mvva 160,192,128
ds_read_b64_tr_b16 v[224:225], v115 offset:8192
ds_read_b64_tr_b16 v[226:227], v115 offset:10240
Mvva 160,208,136
Mvva 176,192,132
s_waitcnt lgkmcnt(10)
s_add_u32 m0, s44, 49152
ds_read_b64_tr_b16 v[240:241], v115 offset:12288
ds_read_b64_tr_b16 v[242:243], v115 offset:14336
Mvva 176,208,140
buffer_load_dwordx4 v114, s[12:15], s48 offen offset:0 lds
Mvva 164,196,128
ds_read_b64_tr_b16 v[228:229], v116 offset:8192
ds_read_b64_tr_b16 v[230:231], v116 offset:10240
Mvva 164,212,136
Mvva 180,196,132
s_waitcnt lgkmcnt(10)
ds_read_b64_tr_b16 v[244:245], v116 offset:12288
ds_read_b64_tr_b16 v[246:247], v116 offset:14336
Mvva 180,212,140
buffer_load_dwordx4 v114, s[12:15], s49 offen offset:1024 lds
Mvva 168,200,128
ds_read_b64_tr_b16 v[232:233], v117 offset:8192
ds_read_b64_tr_b16 v[234:235], v117 offset:10240
Mvva 168,216,136
Mvva 184,200,132
s_waitcnt lgkmcnt(10)
ds_read_b64_tr_b16 v[248:249], v117 offset:12288
ds_read_b64_tr_b16 v[250:251], v117 offset:14336
Mvva 184,216,140
buffer_load_dwordx4 v114, s[12:15], s50 offen offset:2048 lds
Mvva 172,204,128
s_waitcnt vmcnt(15)
ds_read_b64_tr_b16 v[236:237], v118 offset:8192
ds_read_b64_tr_b16 v[238:239], v118 offset:10240
Mvva 172,220,136
s_waitcnt lgkmcnt(10)
Mvva 188,204,132
s_barrier
ds_read_b64_tr_b16 v[252:253], v118 offset:12288
ds_read_b64_tr_b16 v[254:255], v118 offset:14336
Mvva 188,220,140
buffer_load_dwordx4 v114, s[12:15], s51 offen offset:3072 lds
v_add_u32 v114, 131072, v114
Mvva 128,224,128
ds_read_b64_tr_b16 v[192:193], v115 offset:16384
ds_read_b64_tr_b16 v[194:195], v115 offset:18432
Mvva 128,240,136
Mvva 144,224,132
s_waitcnt lgkmcnt(10)
ds_read_b64_tr_b16 v[208:209], v115 offset:20480
ds_read_b64_tr_b16 v[210:211], v115 offset:22528
Mvva 144,240,140
buffer_load_dwordx4 a[176:179], v112, s[8:11], s52 offen offset:0 sc1
Mvva 132,228,128
ds_read_b64_tr_b16 v[196:197], v116 offset:16384
ds_read_b64_tr_b16 v[198:199], v116 offset:18432
Mvva 132,244,136
Mvva 148,228,132
s_waitcnt lgkmcnt(10)
ds_read_b64_tr_b16 v[212:213], v116 offset:20480
ds_read_b64_tr_b16 v[214:215], v116 offset:22528
Mvva 148,244,140
buffer_load_dwordx4 a[180:183], v112, s[8:11], s52 offen offset:1024 sc1
s_add_u32 s52, s52, 8192
Mvva 136,232,128
ds_read_b64_tr_b16 v[200:201], v117 offset:16384
ds_read_b64_tr_b16 v[202:203], v117 offset:18432
Mvva 136,248,136
Mvva 152,232,132
s_waitcnt lgkmcnt(10)
ds_read_b64_tr_b16 v[216:217], v117 offset:20480
ds_read_b64_tr_b16 v[218:219], v117 offset:22528
Mvva 152,248,140
buffer_load_dwordx4 a[184:187], v112, s[8:11], s52 offen offset:0 sc1
Mvva 140,236,128
ds_read_b64_tr_b16 v[204:205], v118 offset:16384
ds_read_b64_tr_b16 v[206:207], v118 offset:18432
Mvva 140,252,136
s_cmp_ge_u32 s2, 32
s_cbranch_scc1 L_f2C
L_f2Cr:
Mvva 156,236,132
s_waitcnt lgkmcnt(10)
ds_read_b64_tr_b16 v[220:221], v118 offset:20480
ds_read_b64_tr_b16 v[222:223], v118 offset:22528
Mvva 156,252,140
buffer_load_dwordx4 a[188:191], v112, s[8:11], s52 offen offset:1024 sc1
s_add_u32 s52, s52, 8192
s_waitcnt vmcnt(16)
Mvva 160,192,144
ds_read_b64_tr_b16 v[224:225], v115 offset:24576
ds_read_b64_tr_b16 v[226:227], v115 offset:26624
Mvva 160,208,152
Mvva 176,192,148
s_waitcnt lgkmcnt(10)
s_add_u32 m0, s44, 65536
ds_read_b64_tr_b16 v[240:241], v115 offset:28672
ds_read_b64_tr_b16 v[242:243], v115 offset:30720
Mvva 176,208,156
buffer_load_dwordx4 v114, s[12:15], s48 offen offset:0 lds
Mvva 164,196,144
ds_read_b64_tr_b16 v[228:229], v116 offset:24576
ds_read_b64_tr_b16 v[230:231], v116 offset:26624
Mvva 164,212,152
Mvva 180,196,148
s_waitcnt lgkmcnt(10)
ds_read_b64_tr_b16 v[244:245], v116 offset:28672
ds_read_b64_tr_b16 v[246:247], v116 offset:30720
Mvva 180,212,156
buffer_load_dwordx4 v114, s[12:15], s49 offen offset:1024 lds
Mvva 168,200,144
ds_read_b64_tr_b16 v[232:233], v117 offset:24576
ds_read_b64_tr_b16 v[234:235], v117 offset:26624
Mvva 168,216,152
Mvva 184,200,148
s_waitcnt lgkmcnt(10)
ds_read_b64_tr_b16 v[248:249], v117 offset:28672
ds_read_b64_tr_b16 v[250:251], v117 offset:30720
Mvva 184,216,156
buffer_load_dwordx4 v114, s[12:15], s50 offen offset:2048 lds
Mvva 172,204,144
s_waitcnt vmcnt(15)
ds_read_b64_tr_b16 v[236:237], v118 offset:24576
ds_read_b64_tr_b16 v[238:239], v118 offset:26624
Mvva 172,220,152
s_waitcnt lgkmcnt(10)
Mvva 188,204,148
s_barrier
ds_read_b64_tr_b16 v[252:253], v118 offset:28672
ds_read_b64_tr_b16 v[254:255], v118 offset:30720
Mvva 188,220,156
buffer_load_dwordx4 v114, s[12:15], s51 offen offset:3072 lds
v_add_u32 v114, 131072, v114
Mvva 128,224,144
ds_read_b64_tr_b16 v[192:193], v115 offset:32768
ds_read_b64_tr_b16 v[194:195], v115 offset:34816
Mvva 128,240,152
s_cmp_ge_u32 s2, 128
s_cbranch_scc1 L_c31
L_c31r:
Mvva 144,224,148
s_waitcnt lgkmcnt(10)
ds_read_b64_tr_b16 v[208:209], v115 offset:36864
ds_read_b64_tr_b16 v[210:211], v115 offset:38912
Mvva 144,240,156
buffer_load_dwordx4 a[192:195], v112, s[8:11], s52 offen offset:0 sc1
Mvva 132,228,144
ds_read_b64_tr_b16 v[196:197], v116 offset:32768
ds_read_b64_tr_b16 v[198:199], v116 offset:34816
Mvva 132,244,152
Mvva 148,228,148
s_waitcnt lgkmcnt(10)
ds_read_b64_tr_b16 v[212:213], v116 offset:36864
ds_read_b64_tr_b16 v[214:215], v116 offset:38912
Mvva 148,244,156
buffer_load_dwordx4 a[196:199], v112, s[8:11], s52 offen offset:1024 sc1
s_add_u32 s52, s52, 8192
Mvva 136,232,144
ds_read_b64_tr_b16 v[200:201], v117 offset:32768
ds_read_b64_tr_b16 v[202:203], v117 offset:34816
Mvva 136,248,152
Mvva 152,232,148
s_waitcnt lgkmcnt(10)
ds_read_b64_tr_b16 v[216:217], v117 offset:36864
ds_read_b64_tr_b16 v[218:219], v117 offset:38912
Mvva 152,248,156
buffer_load_dwordx4 a[200:203], v112, s[8:11], s52 offen offset:0 sc1
Mvva 140,236,144
ds_read_b64_tr_b16 v[204:205], v118 offset:32768
ds_read_b64_tr_b16 v[206:207], v118 offset:34816
Mvva 140,252,152
Mvva 156,236,148
s_waitcnt lgkmcnt(10)
ds_read_b64_tr_b16 v[220:221], v118 offset:36864
ds_read_b64_tr_b16 v[222:223], v118 offset:38912
Mvva 156,252,156
buffer_load_dwordx4 a[204:207], v112, s[8:11], s52 offen offset:1024 sc1
s_add_u32 s52, s52, 8192
s_waitcnt vmcnt(16)
Mvva 160,192,160
ds_read_b64_tr_b16 v[224:225], v115 offset:40960
ds_read_b64_tr_b16 v[226:227], v115 offset:43008
Mvva 160,208,168
Mvva 176,192,164
s_waitcnt lgkmcnt(10)
s_add_u32 m0, s44, 81920
ds_read_b64_tr_b16 v[240:241], v115 offset:45056
ds_read_b64_tr_b16 v[242:243], v115 offset:47104
Mvva 176,208,172
buffer_load_dwordx4 v114, s[12:15], s48 offen offset:0 lds
Mvva 164,196,160
ds_read_b64_tr_b16 v[228:229], v116 offset:40960
ds_read_b64_tr_b16 v[230:231], v116 offset:43008
Mvva 164,212,168
Mvva 180,196,164
s_waitcnt lgkmcnt(10)
ds_read_b64_tr_b16 v[244:245], v116 offset:45056
ds_read_b64_tr_b16 v[246:247], v116 offset:47104
Mvva 180,212,172
buffer_load_dwordx4 v114, s[12:15], s49 offen offset:1024 lds
Mvva 168,200,160
ds_read_b64_tr_b16 v[232:233], v117 offset:40960
ds_read_b64_tr_b16 v[234:235], v117 offset:43008
Mvva 168,216,168
Mvva 184,200,164
s_waitcnt lgkmcnt(10)
ds_read_b64_tr_b16 v[248:249], v117 offset:45056
ds_read_b64_tr_b16 v[250:251], v117 offset:47104
Mvva 184,216,172
buffer_load_dwordx4 v114, s[12:15], s50 offen offset:2048 lds
Mvva 172,204,160
s_waitcnt vmcnt(15)
ds_read_b64_tr_b16 v[236:237], v118 offset:40960
ds_read_b64_tr_b16 v[238:239], v118 offset:43008
Mvva 172,220,168
s_waitcnt lgkmcnt(10)
Mvva 188,204,164
s_barrier
ds_read_b64_tr_b16 v[252:253], v118 offset:45056
ds_read_b64_tr_b16 v[254:255], v118 offset:47104
Mvva 188,220,172
buffer_load_dwordx4 v114, s[12:15], s51 offen offset:3072 lds
v_add_u32 v114, 131072, v114
Mvva 128,224,160
ds_read_b64_tr_b16 v[192:193], v115 offset:49152
ds_read_b64_tr_b16 v[194:195], v115 offset:51200
Mvva 128,240,168
Mvva 144,224,164
s_waitcnt lgkmcnt(10)
ds_read_b64_tr_b16 v[208:209], v115 offset:53248
ds_read_b64_tr_b16 v[210:211], v115 offset:55296
Mvva 144,240,172
buffer_load_dwordx4 a[208:211], v112, s[8:11], s52 offen offset:0 sc1
Mvva 132,228,160
ds_read_b64_tr_b16 v[196:197], v116 offset:49152
ds_read_b64_tr_b16 v[198:199], v116 offset:51200
Mvva 132,244,168
Mvva 148,228,164
s_waitcnt lgkmcnt(10)
ds_read_b64_tr_b16 v[212:213], v116 offset:53248
ds_read_b64_tr_b16 v[214:215], v116 offset:55296
Mvva 148,244,172
buffer_load_dwordx4 a[212:215], v112, s[8:11], s52 offen offset:1024 sc1
s_add_u32 s52, s52, 8192
Mvva 136,232,160
ds_read_b64_tr_b16 v[200:201], v117 offset:49152
ds_read_b64_tr_b16 v[202:203], v117 offset:51200
Mvva 136,248,168
Mvva 152,232,164
s_waitcnt lgkmcnt(10)
ds_read_b64_tr_b16 v[216:217], v117 offset:53248
ds_read_b64_tr_b16 v[218:219], v117 offset:55296
Mvva 152,248,172
buffer_load_dwordx4 a[216:219], v112, s[8:11], s52 offen offset:0 sc1
Mvva 140,236,160
ds_read_b64_tr_b16 v[204:205], v118 offset:49152
ds_read_b64_tr_b16 v[206:207], v118 offset:51200
Mvva 140,252,168
Mvva 156,236,164
s_waitcnt lgkmcnt(10)
ds_read_b64_tr_b16 v[220:221], v118 offset:53248
ds_read_b64_tr_b16 v[222:223], v118 offset:55296
Mvva 156,252,172
buffer_load_dwordx4 a[220:223], v112, s[8:11], s52 offen offset:1024 sc1
s_add_u32 s52, s52, 8192
s_waitcnt vmcnt(16)
Mvva 160,192,176
ds_read_b64_tr_b16 v[224:225], v115 offset:57344
ds_read_b64_tr_b16 v[226:227], v115 offset:59392
Mvva 160,208,184
Mvva 176,192,180
s_waitcnt lgkmcnt(10)
s_add_u32 m0, s44, 98304
ds_read_b64_tr_b16 v[240:241], v115 offset:61440
ds_read_b64_tr_b16 v[242:243], v115 offset:63488
Mvva 176,208,188
buffer_load_dwordx4 v114, s[12:15], s48 offen offset:0 lds
Mvva 164,196,176
ds_read_b64_tr_b16 v[228:229], v116 offset:57344
ds_read_b64_tr_b16 v[230:231], v116 offset:59392
Mvva 164,212,184
Mvva 180,196,180
s_waitcnt lgkmcnt(10)
ds_read_b64_tr_b16 v[244:245], v116 offset:61440
ds_read_b64_tr_b16 v[246:247], v116 offset:63488
Mvva 180,212,188
buffer_load_dwordx4 v114, s[12:15], s49 offen offset:1024 lds
Mvva 168,200,176
ds_read_b64_tr_b16 v[232:233], v117 offset:57344
ds_read_b64_tr_b16 v[234:235], v117 offset:59392
Mvva 168,216,184
s_cmp_ge_u32 s2, 32
s_cbranch_scc1 L_f2E
L_f2Er:
Mvva 184,200,180
s_waitcnt lgkmcnt(10)
ds_read_b64_tr_b16 v[248:249], v117 offset:61440
ds_read_b64_tr_b16 v[250:251], v117 offset:63488
Mvva 184,216,188
buffer_load_dwordx4 v114, s[12:15], s50 offen offset:2048 lds
Mvva 172,204,176
s_waitcnt vmcnt(15)
ds_read_b64_tr_b16 v[236:237], v118 offset:57344
ds_read_b64_tr_b16 v[238:239], v118 offset:59392
Mvva 172,220,184
s_waitcnt lgkmcnt(10)
Mvva 188,204,180
s_barrier
ds_read_b64_tr_b16 v[252:253], v118 offset:61440
ds_read_b64_tr_b16 v[254:255], v118 offset:63488
Mvva 188,220,188
buffer_load_dwordx4 v114, s[12:15], s51 offen offset:3072 lds
v_add_u32 v114, 131072, v114
Mvva 128,224,176
ds_read_b64_tr_b16 v[192:193], v12 offset:0
ds_read_b64_tr_b16 v[194:195], v12 offset:2048
Mvva 128,240,184
Mvva 144,224,180
s_waitcnt lgkmcnt(10)
ds_read_b64_tr_b16 v[208:209], v12 offset:4096
ds_read_b64_tr_b16 v[210:211], v12 offset:6144
Mvva 144,240,188
buffer_load_dwordx4 a[224:227], v112, s[8:11], s52 offen offset:0 sc1
Mvva 132,228,176
ds_read_b64_tr_b16 v[196:197], v13 offset:0
ds_read_b64_tr_b16 v[198:199], v13 offset:2048
Mvva 132,244,184
Mvva 148,228,180
s_waitcnt lgkmcnt(10)
ds_read_b64_tr_b16 v[212:213], v13 offset:4096
ds_read_b64_tr_b16 v[214:215], v13 offset:6144
Mvva 148,244,188
buffer_load_dwordx4 a[228:231], v112, s[8:11], s52 offen offset:1024 sc1
s_add_u32 s52, s52, 8192
Mvva 136,232,176
ds_read_b64_tr_b16 v[200:201], v14 offset:0
ds_read_b64_tr_b16 v[202:203], v14 offset:2048
Mvva 136,248,184
Mvva 152,232,180
s_waitcnt lgkmcnt(10)
ds_read_b64_tr_b16 v[216:217], v14 offset:4096
ds_read_b64_tr_b16 v[218:219], v14 offset:6144
Mvva 152,248,188
buffer_load_dwordx4 a[232:235], v112, s[8:11], s52 offen offset:0 sc1
Mvva 140,236,176
ds_read_b64_tr_b16 v[204:205], v15 offset:0
ds_read_b64_tr_b16 v[206:207], v15 offset:2048
Mvva 140,252,184
Mvva 156,236,180
s_waitcnt lgkmcnt(10)
ds_read_b64_tr_b16 v[220:221], v15 offset:4096
ds_read_b64_tr_b16 v[222:223], v15 offset:6144
Mvva 156,252,188
buffer_load_dwordx4 a[236:239], v112, s[8:11], s52 offen offset:1024 sc1
s_add_u32 s52, s52, 8192
s_waitcnt vmcnt(16)
Mvva 160,192,192
ds_read_b64_tr_b16 v[224:225], v12 offset:8192
ds_read_b64_tr_b16 v[226:227], v12 offset:10240
Mvva 160,208,200
Mvva 176,192,196
s_waitcnt lgkmcnt(10)
s_add_u32 m0, s44, 114688
ds_read_b64_tr_b16 v[240:241], v12 offset:12288
ds_read_b64_tr_b16 v[242:243], v12 offset:14336
Mvva 176,208,204
buffer_load_dwordx4 v114, s[12:15], s48 offen offset:0 lds
Mvva 164,196,192
ds_read_b64_tr_b16 v[228:229], v13 offset:8192
ds_read_b64_tr_b16 v[230:231], v13 offset:10240
Mvva 164,212,200
Mvva 180,196,196
s_waitcnt lgkmcnt(10)
ds_read_b64_tr_b16 v[244:245], v13 offset:12288
ds_read_b64_tr_b16 v[246:247], v13 offset:14336
Mvva 180,212,204
buffer_load_dwordx4 v114, s[12:15], s49 offen offset:1024 lds
Mvva 168,200,192
ds_read_b64_tr_b16 v[232:233], v14 offset:8192
ds_read_b64_tr_b16 v[234:235], v14 offset:10240
Mvva 168,216,200
Mvva 184,200,196
s_waitcnt lgkmcnt(10)
ds_read_b64_tr_b16 v[248:249], v14 offset:12288
ds_read_b64_tr_b16 v[250:251], v14 offset:14336
Mvva 184,216,204
buffer_load_dwordx4 v114, s[12:15], s50 offen offset:2048 lds
Mvva 172,204,192
s_waitcnt vmcnt(15)
ds_read_b64_tr_b16 v[236:237], v15 offset:8192
ds_read_b64_tr_b16 v[238:239], v15 offset:10240
Mvva 172,220,200
s_waitcnt lgkmcnt(10)
Mvva 188,204,196
s_barrier
ds_read_b64_tr_b16 v[252:253], v15 offset:12288
ds_read_b64_tr_b16 v[254:255], v15 offset:14336
Mvva 188,220,204
buffer_load_dwordx4 v114, s[12:15], s51 offen offset:3072 lds
v_add_u32 v114, s95, v113
Mvva 128,224,192
ds_read_b64_tr_b16 v[192:193], v12 offset:16384
ds_read_b64_tr_b16 v[194:195], v12 offset:18432
Mvva 128,240,200
Mvva 144,224,196
s_waitcnt lgkmcnt(10)
ds_read_b64_tr_b16 v[208:209], v12 offset:20480
ds_read_b64_tr_b16 v[210:211], v12 offset:22528
Mvva 144,240,204
buffer_load_dwordx4 a[240:243], v112, s[8:11], s52 offen offset:0 sc1
Mvva 132,228,192
ds_read_b64_tr_b16 v[196:197], v13 offset:16384
ds_read_b64_tr_b16 v[198:199], v13 offset:18432
Mvva 132,244,200
Mvva 148,228,196
s_waitcnt lgkmcnt(10)
ds_read_b64_tr_b16 v[212:213], v13 offset:20480
ds_read_b64_tr_b16 v[214:215], v13 offset:22528
Mvva 148,244,204
buffer_load_dwordx4 a[244:247], v112, s[8:11], s52 offen offset:1024 sc1
s_add_u32 s52, s52, 8192
Mvva 136,232,192
ds_read_b64_tr_b16 v[200:201], v14 offset:16384
ds_read_b64_tr_b16 v[202:203], v14 offset:18432
Mvva 136,248,200
Mvva 152,232,196
s_waitcnt lgkmcnt(10)
ds_read_b64_tr_b16 v[216:217], v14 offset:20480
ds_read_b64_tr_b16 v[218:219], v14 offset:22528
Mvva 152,248,204
buffer_load_dwordx4 a[248:251], v112, s[8:11], s52 offen offset:0 sc1
Mvva 140,236,192
ds_read_b64_tr_b16 v[204:205], v15 offset:16384
ds_read_b64_tr_b16 v[206:207], v15 offset:18432
Mvva 140,252,200
Mvva 156,236,196
s_waitcnt lgkmcnt(10)
ds_read_b64_tr_b16 v[220:221], v15 offset:20480
ds_read_b64_tr_b16 v[222:223], v15 offset:22528
Mvva 156,252,204
buffer_load_dwordx4 a[252:255], v112, s[8:11], s52 offen offset:1024 sc1
s_add_u32 s52, s52, 8192
s_waitcnt vmcnt(16)
Mvva 160,192,208
s_add_u32 m0, s44, 0
ds_read_b64_tr_b16 v[224:225], v12 offset:24576
ds_read_b64_tr_b16 v[226:227], v12 offset:26624
Mvva 160,208,216
buffer_load_dwordx4 v114, s[12:15], s48 offen offset:0 lds
Mvva 176,192,212
s_waitcnt lgkmcnt(10)
ds_read_b64_tr_b16 v[240:241], v12 offset:28672
ds_read_b64_tr_b16 v[242:243], v12 offset:30720
Mvva 176,208,220
Mvva 164,196,208
ds_read_b64_tr_b16 v[228:229], v13 offset:24576
ds_read_b64_tr_b16 v[230:231], v13 offset:26624
Mvva 164,212,216
buffer_load_dwordx4 v114, s[12:15], s49 offen offset:1024 lds
Mvva 180,196,212
s_waitcnt lgkmcnt(10)
ds_read_b64_tr_b16 v[244:245], v13 offset:28672
ds_read_b64_tr_b16 v[246:247], v13 offset:30720
Mvva 180,212,220
buffer_load_dwordx4 v114, s[12:15], s50 offen offset:2048 lds
Mvva 168,200,208
ds_read_b64_tr_b16 v[232:233], v14 offset:24576
ds_read_b64_tr_b16 v[234:235], v14 offset:26624
Mvva 168,216,216
buffer_load_dwordx4 v114, s[12:15], s51 offen offset:3072 lds
v_add_u32 v114, 262144, v114
Mvva 184,200,212
s_waitcnt lgkmcnt(10)
ds_read_b64_tr_b16 v[248:249], v14 offset:28672
ds_read_b64_tr_b16 v[250:251], v14 offset:30720
Mvva 184,216,220
Mvva 172,204,208
s_waitcnt vmcnt(16)
ds_read_b64_tr_b16 v[236:237], v15 offset:24576
ds_read_b64_tr_b16 v[238:239], v15 offset:26624
Mvva 172,220,216
s_waitcnt lgkmcnt(10)
buffer_load_dwordx4 a[0:3], v112, s[8:11], s52 offen offset:0 sc1
Mvva 188,204,212
s_barrier
ds_read_b64_tr_b16 v[252:253], v15 offset:28672
ds_read_b64_tr_b16 v[254:255], v15 offset:30720
Mvva 188,220,220
buffer_load_dwordx4 a[4:7], v112, s[8:11], s52 offen offset:1024 sc1
s_add_u32 s52, s52, 8192
Mvva 128,224,208
ds_read_b64_tr_b16 v[192:193], v12 offset:32768
ds_read_b64_tr_b16 v[194:195], v12 offset:34816
Mvva 128,240,216
buffer_load_dwordx4 a[8:11], v112, s[8:11], s52 offen offset:0 sc1
Mvva 144,224,212
s_waitcnt lgkmcnt(10)
ds_read_b64_tr_b16 v[208:209], v12 offset:36864
ds_read_b64_tr_b16 v[210:211], v12 offset:38912
Mvva 144,240,220
Mvva 132,228,208
ds_read_b64_tr_b16 v[196:197], v13 offset:32768
ds_read_b64_tr_b16 v[198:199], v13 offset:34816
Mvva 132,244,216
buffer_load_dwordx4 a[12:15], v112, s[8:11], s52 offen offset:1024 sc1
s_add_u32 s52, s52, 8192
Mvva 148,228,212
s_waitcnt lgkmcnt(10)
ds_read_b64_tr_b16 v[212:213], v13 offset:36864
ds_read_b64_tr_b16 v[214:215], v13 offset:38912
Mvva 148,244,220
buffer_load_dwordx4 a[16:19], v112, s[8:11], s52 offen offset:0 sc1
Mvva 136,232,208
ds_read_b64_tr_b16 v[200:201], v14 offset:32768
ds_read_b64_tr_b16 v[202:203], v14 offset:34816
Mvva 136,248,216
buffer_load_dwordx4 a[20:23], v112, s[8:11], s52 offen offset:1024 sc1
s_add_u32 s52, s52, 8192
Mvva 152,232,212
s_waitcnt lgkmcnt(10)
ds_read_b64_tr_b16 v[216:217], v14 offset:36864
ds_read_b64_tr_b16 v[218:219], v14 offset:38912
Mvva 152,248,220
Mvva 140,236,208
ds_read_b64_tr_b16 v[204:205], v15 offset:32768
ds_read_b64_tr_b16 v[206:207], v15 offset:34816
Mvva 140,252,216
buffer_load_dwordx4 a[24:27], v112, s[8:11], s52 offen offset:0 sc1
Mvva 156,236,212
s_waitcnt lgkmcnt(10)
ds_read_b64_tr_b16 v[220:221], v15 offset:36864
ds_read_b64_tr_b16 v[222:223], v15 offset:38912
Mvva 156,252,220
buffer_load_dwordx4 a[28:31], v112, s[8:11], s52 offen offset:1024 sc1
s_add_u32 s52, s52, 8192
s_waitcnt vmcnt(20)
Mvva 160,192,224
s_add_u32 m0, s44, 16384
ds_read_b64_tr_b16 v[224:225], v12 offset:40960
ds_read_b64_tr_b16 v[226:227], v12 offset:43008
Mvva 160,208,232
buffer_load_dwordx4 v114, s[12:15], s48 offen offset:0 lds
Mvva 176,192,228
s_waitcnt lgkmcnt(10)
ds_read_b64_tr_b16 v[240:241], v12 offset:45056
ds_read_b64_tr_b16 v[242:243], v12 offset:47104
Mvva 176,208,236
Mvva 164,196,224
ds_read_b64_tr_b16 v[228:229], v13 offset:40960
ds_read_b64_tr_b16 v[230:231], v13 offset:43008
Mvva 164,212,232
buffer_load_dwordx4 v114, s[12:15], s49 offen offset:1024 lds
Mvva 180,196,228
s_waitcnt lgkmcnt(10)
ds_read_b64_tr_b16 v[244:245], v13 offset:45056
ds_read_b64_tr_b16 v[246:247], v13 offset:47104
Mvva 180,212,236
buffer_load_dwordx4 v114, s[12:15], s50 offen offset:2048 lds
Mvva 168,200,224
ds_read_b64_tr_b16 v[232:233], v14 offset:40960
ds_read_b64_tr_b16 v[234:235], v14 offset:43008
Mvva 168,216,232
buffer_load_dwordx4 v114, s[12:15], s51 offen offset:3072 lds
v_add_u32 v114, 262144, v114
Mvva 184,200,228
s_waitcnt lgkmcnt(10)
ds_read_b64_tr_b16 v[248:249], v14 offset:45056
ds_read_b64_tr_b16 v[250:251], v14 offset:47104
Mvva 184,216,236
Mvva 172,204,224
s_waitcnt vmcnt(20)
ds_read_b64_tr_b16 v[236:237], v15 offset:40960
ds_read_b64_tr_b16 v[238:239], v15 offset:43008
Mvva 172,220,232
s_waitcnt lgkmcnt(10)
buffer_load_dwordx4 a[32:35], v112, s[8:11], s52 offen offset:0 sc1
Mvva 188,204,228
s_barrier
ds_read_b64_tr_b16 v[252:253], v15 offset:45056
ds_read_b64_tr_b16 v[254:255], v15 offset:47104
Mvva 188,220,236
buffer_load_dwordx4 a[36:39], v112, s[8:11], s52 offen offset:1024 sc1
s_add_u32 s52, s52, 8192
Mvva 128,224,224
ds_read_b64_tr_b16 v[192:193], v12 offset:49152
ds_read_b64_tr_b16 v[194:195], v12 offset:51200
Mvva 128,240,232
buffer_load_dwordx4 a[40:43], v112, s[8:11], s52 offen offset:0 sc1
Mvva 144,224,228
s_waitcnt lgkmcnt(10)
ds_read_b64_tr_b16 v[208:209], v12 offset:53248
ds_read_b64_tr_b16 v[210:211], v12 offset:55296
Mvva 144,240,236
Mvva 132,228,224
ds_read_b64_tr_b16 v[196:197], v13 offset:49152
ds_read_b64_tr_b16 v[198:199], v13 offset:51200
Mvva 132,244,232
buffer_load_dwordx4 a[44:47], v112, s[8:11], s52 offen offset:1024 sc1
s_add_u32 s52, s52, 8192
Mvva 148,228,228
s_waitcnt lgkmcnt(10)
ds_read_b64_tr_b16 v[212:213], v13 offset:53248
ds_read_b64_tr_b16 v[214:215], v13 offset:55296
Mvva 148,244,236
buffer_load_dwordx4 a[48:51], v112, s[8:11], s52 offen offset:0 sc1
Mvva 136,232,224
ds_read_b64_tr_b16 v[200:201], v14 offset:49152
ds_read_b64_tr_b16 v[202:203], v14 offset:51200
Mvva 136,248,232
buffer_load_dwordx4 a[52:55], v112, s[8:11], s52 offen offset:1024 sc1
s_add_u32 s52, s52, 8192
Mvva 152,232,228
s_waitcnt lgkmcnt(10)
ds_read_b64_tr_b16 v[216:217], v14 offset:53248
ds_read_b64_tr_b16 v[218:219], v14 offset:55296
Mvva 152,248,236
Mvva 140,236,224
ds_read_b64_tr_b16 v[204:205], v15 offset:49152
ds_read_b64_tr_b16 v[206:207], v15 offset:51200
Mvva 140,252,232
buffer_load_dwordx4 a[56:59], v112, s[8:11], s52 offen offset:0 sc1
Mvva 156,236,228
s_waitcnt lgkmcnt(10)
ds_read_b64_tr_b16 v[220:221], v15 offset:53248
ds_read_b64_tr_b16 v[222:223], v15 offset:55296
Mvva 156,252,236
buffer_load_dwordx4 a[60:63], v112, s[8:11], s52 offen offset:1024 sc1
s_add_u32 s52, s52, 8192
s_waitcnt vmcnt(24)
Mvva 160,192,240
s_add_u32 m0, s44, 32768
ds_read_b64_tr_b16 v[224:225], v12 offset:57344
ds_read_b64_tr_b16 v[226:227], v12 offset:59392
Mvva 160,208,248
buffer_load_dwordx4 v114, s[12:15], s48 offen offset:0 lds
Mvva 176,192,244
s_waitcnt lgkmcnt(10)
ds_read_b64_tr_b16 v[240:241], v12 offset:61440
ds_read_b64_tr_b16 v[242:243], v12 offset:63488
Mvva 176,208,252
Mvva 164,196,240
ds_read_b64_tr_b16 v[228:229], v13 offset:57344
ds_read_b64_tr_b16 v[230:231], v13 offset:59392
Mvva 164,212,248
buffer_load_dwordx4 v114, s[12:15], s49 offen offset:1024 lds
Mvva 180,196,244
s_waitcnt lgkmcnt(10)
ds_read_b64_tr_b16 v[244:245], v13 offset:61440
ds_read_b64_tr_b16 v[246:247], v13 offset:63488
Mvva 180,212,252
buffer_load_dwordx4 v114, s[12:15], s50 offen offset:2048 lds
Mvva 168,200,240
ds_read_b64_tr_b16 v[232:233], v14 offset:57344
ds_read_b64_tr_b16 v[234:235], v14 offset:59392
Mvva 168,216,248
buffer_load_dwordx4 v114, s[12:15], s51 offen offset:3072 lds
v_add_u32 v114, 262144, v114
Mvva 184,200,244
s_waitcnt lgkmcnt(10)
ds_read_b64_tr_b16 v[248:249], v14 offset:61440
ds_read_b64_tr_b16 v[250:251], v14 offset:63488
Mvva 184,216,252
Mvva 172,204,240
s_waitcnt vmcnt(24)
ds_read_b64_tr_b16 v[236:237], v15 offset:57344
ds_read_b64_tr_b16 v[238:239], v15 offset:59392
Mvva 172,220,248
s_waitcnt lgkmcnt(10)
buffer_load_dwordx4 a[64:67], v112, s[8:11], s52 offen offset:0 sc1
Mvva 188,204,244
s_barrier
ds_read_b64_tr_b16 v[252:253], v15 offset:61440
ds_read_b64_tr_b16 v[254:255], v15 offset:63488
Mvva 188,220,252
buffer_load_dwordx4 a[68:71], v112, s[8:11], s52 offen offset:1024 sc1
s_add_u32 s52, s52, 8192
Mvva 128,224,240
ds_read_b64_tr_b16 v[192:193], v115 offset:0
ds_read_b64_tr_b16 v[194:195], v115 offset:2048
Mvva 128,240,248
buffer_load_dwordx4 a[72:75], v112, s[8:11], s52 offen offset:0 sc1
Mvva 144,224,244
s_waitcnt lgkmcnt(10)
ds_read_b64_tr_b16 v[208:209], v115 offset:4096
ds_read_b64_tr_b16 v[210:211], v115 offset:6144
Mvva 144,240,252
Mvva 132,228,240
ds_read_b64_tr_b16 v[196:197], v116 offset:0
ds_read_b64_tr_b16 v[198:199], v116 offset:2048
Mvva 132,244,248
buffer_load_dwordx4 a[76:79], v112, s[8:11], s52 offen offset:1024 sc1
s_add_u32 s52, s52, 8192
Mvva 148,228,244
s_waitcnt lgkmcnt(10)
ds_read_b64_tr_b16 v[212:213], v116 offset:4096
ds_read_b64_tr_b16 v[214:215], v116 offset:6144
Mvva 148,244,252
buffer_load_dwordx4 a[80:83], v112, s[8:11], s52 offen offset:0 sc1
Mvva 136,232,240
ds_read_b64_tr_b16 v[200:201], v117 offset:0
ds_read_b64_tr_b16 v[202:203], v117 offset:2048
Mvva 136,248,248
buffer_load_dwordx4 a[84:87], v112, s[8:11], s52 offen offset:1024 sc1
s_add_u32 s52, s52, 8192
Mvva 152,232,244
s_waitcnt lgkmcnt(10)
ds_read_b64_tr_b16 v[216:217], v117 offset:4096
ds_read_b64_tr_b16 v[218:219], v117 offset:6144
Mvva 152,248,252
Mvva 140,236,240
ds_read_b64_tr_b16 v[204:205], v118 offset:0
ds_read_b64_tr_b16 v[206:207], v118 offset:2048
Mvva 140,252,248
buffer_load_dwordx4 a[88:91], v112, s[8:11], s52 offen offset:0 sc1
Mvva 156,236,244
s_waitcnt lgkmcnt(10)
ds_read_b64_tr_b16 v[220:221], v118 offset:4096
ds_read_b64_tr_b16 v[222:223], v118 offset:6144
Mvva 156,252,252
buffer_load_dwordx4 a[92:95], v112, s[8:11], s52 offen offset:1024 sc1
s_add_u32 s52, s52, 8192
s_waitcnt vmcnt(28)
Mvva 160,192,0
s_add_u32 m0, s44, 49152
ds_read_b64_tr_b16 v[224:225], v115 offset:8192
ds_read_b64_tr_b16 v[226:227], v115 offset:10240
Mvva 160,208,8
buffer_load_dwordx4 v114, s[12:15], s48 offen offset:0 lds
Mvva 176,192,4
s_waitcnt lgkmcnt(10)
ds_read_b64_tr_b16 v[240:241], v115 offset:12288
ds_read_b64_tr_b16 v[242:243], v115 offset:14336
Mvva 176,208,12
Mvva 164,196,0
ds_read_b64_tr_b16 v[228:229], v116 offset:8192
ds_read_b64_tr_b16 v[230:231], v116 offset:10240
Mvva 164,212,8
buffer_load_dwordx4 v114, s[12:15], s49 offen offset:1024 lds
Mvva 180,196,4
s_waitcnt lgkmcnt(10)
ds_read_b64_tr_b16 v[244:245], v116 offset:12288
ds_read_b64_tr_b16 v[246:247], v116 offset:14336
Mvva 180,212,12
buffer_load_dwordx4 v114, s[12:15], s50 offen offset:2048 lds
Mvva 168,200,0
ds_read_b64_tr_b16 v[232:233], v117 offset:8192
ds_read_b64_tr_b16 v[234:235], v117 offset:10240
Mvva 168,216,8
buffer_load_dwordx4 v114, s[12:15], s51 offen offset:3072 lds
v_add_u32 v114, 262144, v114
Mvva 184,200,4
s_waitcnt lgkmcnt(10)
ds_read_b64_tr_b16 v[248:249], v117 offset:12288
ds_read_b64_tr_b16 v[250:251], v117 offset:14336
Mvva 184,216,12
Mvva 172,204,0
s_waitcnt vmcnt(24)
ds_read_b64_tr_b16 v[236:237], v118 offset:8192
ds_read_b64_tr_b16 v[238:239], v118 offset:10240
Mvva 172,220,8
s_waitcnt lgkmcnt(10)
buffer_load_dwordx4 a[96:99], v112, s[8:11], s52 offen offset:0 sc1
Mvva 188,204,4
s_barrier
ds_read_b64_tr_b16 v[252:253], v118 offset:12288
ds_read_b64_tr_b16 v[254:255], v118 offset:14336
Mvva 188,220,12
buffer_load_dwordx4 a[100:103], v112, s[8:11], s52 offen offset:1024 sc1
s_add_u32 s52, s52, 8192
Mvva 160,224,16
ds_read_b64_tr_b16 v[192:193], v115 offset:16384
ds_read_b64_tr_b16 v[194:195], v115 offset:18432
Mvva 160,240,24
buffer_load_dwordx4 a[104:107], v112, s[8:11], s52 offen offset:0 sc1
Mvva 176,224,20
s_waitcnt lgkmcnt(10)
ds_read_b64_tr_b16 v[208:209], v115 offset:20480
ds_read_b64_tr_b16 v[210:211], v115 offset:22528
Mvva 176,240,28
Mvva 164,228,16
ds_read_b64_tr_b16 v[196:197], v116 offset:16384
ds_read_b64_tr_b16 v[198:199], v116 offset:18432
Mvva 164,244,24
buffer_load_dwordx4 a[108:111], v112, s[8:11], s52 offen offset:1024 sc1
s_add_u32 s52, s52, 8192
Mvva 180,228,20
s_waitcnt lgkmcnt(10)
ds_read_b64_tr_b16 v[212:213], v116 offset:20480
ds_read_b64_tr_b16 v[214:215], v116 offset:22528
Mvva 180,244,28
buffer_load_dwordx4 a[112:115], v112, s[8:11], s52 offen offset:0 sc1
Mvva 168,232,16
ds_read_b64_tr_b16 v[200:201], v117 offset:16384
ds_read_b64_tr_b16 v[202:203], v117 offset:18432
Mvva 168,248,24
buffer_load_dwordx4 a[116:119], v112, s[8:11], s52 offen offset:1024 sc1
s_add_u32 s52, s52, 8192
Mvva 184,232,20
s_waitcnt lgkmcnt(10)
ds_read_b64_tr_b16 v[216:217], v117 offset:20480
ds_read_b64_tr_b16 v[218:219], v117 offset:22528
Mvva 184,248,28
Mvva 172,236,16
ds_read_b64_tr_b16 v[204:205], v118 offset:16384
ds_read_b64_tr_b16 v[206:207], v118 offset:18432
Mvva 172,252,24
buffer_load_dwordx4 a[120:123], v112, s[8:11], s52 offen offset:0 sc1
Mvva 188,236,20
s_waitcnt lgkmcnt(10)
ds_read_b64_tr_b16 v[220:221], v118 offset:20480
ds_read_b64_tr_b16 v[222:223], v118 offset:22528
Mvva 188,252,28
buffer_load_dwordx4 a[124:127], v112, s[8:11], s52 offen offset:1024 sc1
s_add_u32 s52, s52, 8192
s_waitcnt vmcnt(28)
Mvva 160,192,32
s_add_u32 m0, s44, 65536
ds_read_b64_tr_b16 v[224:225], v115 offset:24576
ds_read_b64_tr_b16 v[226:227], v115 offset:26624
Mvva 160,208,40
buffer_load_dwordx4 v114, s[12:15], s48 offen offset:0 lds
Mvva 176,192,36
s_waitcnt lgkmcnt(10)
ds_read_b64_tr_b16 v[240:241], v115 offset:28672
ds_read_b64_tr_b16 v[242:243], v115 offset:30720
Mvva 176,208,44
Mvva 164,196,32
ds_read_b64_tr_b16 v[228:229], v116 offset:24576
ds_read_b64_tr_b16 v[230:231], v116 offset:26624
Mvva 164,212,40
buffer_load_dwordx4 v114, s[12:15], s49 offen offset:1024 lds
Mvva 180,196,36
s_waitcnt lgkmcnt(10)
ds_read_b64_tr_b16 v[244:245], v116 offset:28672
ds_read_b64_tr_b16 v[246:247], v116 offset:30720
Mvva 180,212,44
buffer_load_dwordx4 v114, s[12:15], s50 offen offset:2048 lds
Mvva 168,200,32
ds_read_b64_tr_b16 v[232:233], v117 offset:24576
ds_read_b64_tr_b16 v[234:235], v117 offset:26624
Mvva 168,216,40
buffer_load_dwordx4 v114, s[12:15], s51 offen offset:3072 lds
v_add_u32 v114, 262144, v114
Mvva 184,200,36
s_waitcnt lgkmcnt(10)
ds_read_b64_tr_b16 v[248:249], v117 offset:28672
ds_read_b64_tr_b16 v[250:251], v117 offset:30720
Mvva 184,216,44
Mvva 172,204,32
s_waitcnt vmcnt(24)
ds_read_b64_tr_b16 v[236:237], v118 offset:24576
ds_read_b64_tr_b16 v[238:239], v118 offset:26624
Mvva 172,220,40
s_waitcnt lgkmcnt(10)
buffer_load_dwordx4 a[128:131], v112, s[8:11], s52 offen offset:0 sc1
Mvva 188,204,36
s_barrier
ds_read_b64_tr_b16 v[252:253], v118 offset:28672
ds_read_b64_tr_b16 v[254:255], v118 offset:30720
Mvva 188,220,44
buffer_load_dwordx4 a[132:135], v112, s[8:11], s52 offen offset:1024 sc1
s_add_u32 s52, s52, 8192
Mvva 160,224,48
ds_read_b64_tr_b16 v[192:193], v115 offset:32768
ds_read_b64_tr_b16 v[194:195], v115 offset:34816
Mvva 160,240,56
buffer_load_dwordx4 a[136:139], v112, s[8:11], s52 offen offset:0 sc1
Mvva 176,224,52
s_waitcnt lgkmcnt(10)
ds_read_b64_tr_b16 v[208:209], v115 offset:36864
ds_read_b64_tr_b16 v[210:211], v115 offset:38912
Mvva 176,240,60
Mvva 164,228,48
ds_read_b64_tr_b16 v[196:197], v116 offset:32768
ds_read_b64_tr_b16 v[198:199], v116 offset:34816
Mvva 164,244,56
buffer_load_dwordx4 a[140:143], v112, s[8:11], s52 offen offset:1024 sc1
s_add_u32 s52, s52, 8192
Mvva 180,228,52
s_waitcnt lgkmcnt(10)
ds_read_b64_tr_b16 v[212:213], v116 offset:36864
ds_read_b64_tr_b16 v[214:215], v116 offset:38912
Mvva 180,244,60
buffer_load_dwordx4 a[144:147], v112, s[8:11], s52 offen offset:0 sc1
Mvva 168,232,48
ds_read_b64_tr_b16 v[200:201], v117 offset:32768
ds_read_b64_tr_b16 v[202:203], v117 offset:34816
Mvva 168,248,56
buffer_load_dwordx4 a[148:151], v112, s[8:11], s52 offen offset:1024 sc1
s_add_u32 s52, s52, 8192
Mvva 184,232,52
s_waitcnt lgkmcnt(10)
ds_read_b64_tr_b16 v[216:217], v117 offset:36864
ds_read_b64_tr_b16 v[218:219], v117 offset:38912
Mvva 184,248,60
Mvva 172,236,48
ds_read_b64_tr_b16 v[204:205], v118 offset:32768
ds_read_b64_tr_b16 v[206:207], v118 offset:34816
Mvva 172,252,56
buffer_load_dwordx4 a[152:155], v112, s[8:11], s52 offen offset:0 sc1
Mvva 188,236,52
s_waitcnt lgkmcnt(10)
ds_read_b64_tr_b16 v[220:221], v118 offset:36864
ds_read_b64_tr_b16 v[222:223], v118 offset:38912
Mvva 188,252,60
buffer_load_dwordx4 a[156:159], v112, s[8:11], s52 offen offset:1024 sc1
s_add_u32 s52, s52, 8192
s_waitcnt vmcnt(28)
Mvva 160,192,64
s_add_u32 m0, s44, 81920
ds_read_b64_tr_b16 v[224:225], v115 offset:40960
ds_read_b64_tr_b16 v[226:227], v115 offset:43008
Mvva 160,208,72
buffer_load_dwordx4 v114, s[12:15], s48 offen offset:0 lds
Mvva 176,192,68
s_waitcnt lgkmcnt(10)
ds_read_b64_tr_b16 v[240:241], v115 offset:45056
ds_read_b64_tr_b16 v[242:243], v115 offset:47104
Mvva 176,208,76
Mvva 164,196,64
ds_read_b64_tr_b16 v[228:229], v116 offset:40960
ds_read_b64_tr_b16 v[230:231], v116 offset:43008
Mvva 164,212,72
buffer_load_dwordx4 v114, s[12:15], s49 offen offset:1024 lds
Mvva 180,196,68
s_waitcnt lgkmcnt(10)
ds_read_b64_tr_b16 v[244:245], v116 offset:45056
ds_read_b64_tr_b16 v[246:247], v116 offset:47104
Mvva 180,212,76
buffer_load_dwordx4 v114, s[12:15], s50 offen offset:2048 lds
Mvva 168,200,64
ds_read_b64_tr_b16 v[232:233], v117 offset:40960
ds_read_b64_tr_b16 v[234:235], v117 offset:43008
Mvva 168,216,72
buffer_load_dwordx4 v114, s[12:15], s51 offen offset:3072 lds
v_add_u32 v114, 262144, v114
Mvva 184,200,68
s_waitcnt lgkmcnt(10)
ds_read_b64_tr_b16 v[248:249], v117 offset:45056
ds_read_b64_tr_b16 v[250:251], v117 offset:47104
Mvva 184,216,76
Mvva 172,204,64
s_waitcnt vmcnt(24)
ds_read_b64_tr_b16 v[236:237], v118 offset:40960
ds_read_b64_tr_b16 v[238:239], v118 offset:43008
Mvva 172,220,72
s_waitcnt lgkmcnt(10)
buffer_load_dwordx4 a[160:163], v112, s[8:11], s52 offen offset:0 sc1
Mvva 188,204,68
s_barrier
ds_read_b64_tr_b16 v[252:253], v118 offset:45056
ds_read_b64_tr_b16 v[254:255], v118 offset:47104
Mvva 188,220,76
buffer_load_dwordx4 a[164:167], v112, s[8:11], s52 offen offset:1024 sc1
s_add_u32 s52, s52, 8192
Mvva 160,224,80
ds_read_b64_tr_b16 v[192:193], v115 offset:49152
ds_read_b64_tr_b16 v[194:195], v115 offset:51200
Mvva 160,240,88
buffer_load_dwordx4 a[168:171], v112, s[8:11], s52 offen offset:0 sc1
Mvva 176,224,84
s_waitcnt lgkmcnt(10)
ds_read_b64_tr_b16 v[208:209], v115 offset:53248
ds_read_b64_tr_b16 v[210:211], v115 offset:55296
Mvva 176,240,92
Mvva 164,228,80
ds_read_b64_tr_b16 v[196:197], v116 offset:49152
ds_read_b64_tr_b16 v[198:199], v116 offset:51200
Mvva 164,244,88
buffer_load_dwordx4 a[172:175], v112, s[8:11], s52 offen offset:1024 sc1
s_add_u32 s52, s52, 8192
Mvva 180,228,84
s_waitcnt lgkmcnt(10)
ds_read_b64_tr_b16 v[212:213], v116 offset:53248
ds_read_b64_tr_b16 v[214:215], v116 offset:55296
Mvva 180,244,92
buffer_load_dwordx4 a[176:179], v112, s[8:11], s52 offen offset:0 sc1
Mvva 168,232,80
ds_read_b64_tr_b16 v[200:201], v117 offset:49152
ds_read_b64_tr_b16 v[202:203], v117 offset:51200
Mvva 168,248,88
buffer_load_dwordx4 a[180:183], v112, s[8:11], s52 offen offset:1024 sc1
s_add_u32 s52, s52, 8192
Mvva 184,232,84
s_waitcnt lgkmcnt(10)
ds_read_b64_tr_b16 v[216:217], v117 offset:53248
ds_read_b64_tr_b16 v[218:219], v117 offset:55296
Mvva 184,248,92
Mvva 172,236,80
ds_read_b64_tr_b16 v[204:205], v118 offset:49152
ds_read_b64_tr_b16 v[206:207], v118 offset:51200
Mvva 172,252,88
buffer_load_dwordx4 a[184:187], v112, s[8:11], s52 offen offset:0 sc1
Mvva 188,236,84
s_waitcnt lgkmcnt(10)
ds_read_b64_tr_b16 v[220:221], v118 offset:53248
ds_read_b64_tr_b16 v[222:223], v118 offset:55296
Mvva 188,252,92
buffer_load_dwordx4 a[188:191], v112, s[8:11], s52 offen offset:1024 sc1
s_add_u32 s52, s52, 8192
s_waitcnt vmcnt(28)
Mvva 160,192,96
s_add_u32 m0, s44, 98304
ds_read_b64_tr_b16 v[224:225], v115 offset:57344
ds_read_b64_tr_b16 v[226:227], v115 offset:59392
Mvva 160,208,104
buffer_load_dwordx4 v114, s[12:15], s48 offen offset:0 lds
Mvva 176,192,100
s_waitcnt lgkmcnt(10)
ds_read_b64_tr_b16 v[240:241], v115 offset:61440
ds_read_b64_tr_b16 v[242:243], v115 offset:63488
Mvva 176,208,108
s_cmp_lg_u32 s53, 0
s_cbranch_scc1 L_yA
L_yAr:
Mvva 164,196,96
ds_read_b64_tr_b16 v[228:229], v116 offset:57344
ds_read_b64_tr_b16 v[230:231], v116 offset:59392
Mvva 164,212,104
buffer_load_dwordx4 v114, s[12:15], s49 offen offset:1024 lds
Mvva 180,196,100
s_waitcnt lgkmcnt(10)
ds_read_b64_tr_b16 v[244:245], v116 offset:61440
ds_read_b64_tr_b16 v[246:247], v116 offset:63488
Mvva 180,212,108
buffer_load_dwordx4 v114, s[12:15], s50 offen offset:2048 lds
Mvva 168,200,96
ds_read_b64_tr_b16 v[232:233], v117 offset:57344
ds_read_b64_tr_b16 v[234:235], v117 offset:59392
Mvva 168,216,104
buffer_load_dwordx4 v114, s[12:15], s51 offen offset:3072 lds
v_add_u32 v114, 262144, v114
Mvva 184,200,100
s_waitcnt lgkmcnt(10)
ds_read_b64_tr_b16 v[248:249], v117 offset:61440
ds_read_b64_tr_b16 v[250:251], v117 offset:63488
Mvva 184,216,108
Mvva 172,204,96
s_waitcnt vmcnt(24)
ds_read_b64_tr_b16 v[236:237], v118 offset:57344
ds_read_b64_tr_b16 v[238:239], v118 offset:59392
Mvva 172,220,104
s_waitcnt lgkmcnt(10)
buffer_load_dwordx4 a[192:195], v112, s[8:11], s52 offen offset:0 sc1
Mvva 188,204,100
s_barrier
ds_read_b64_tr_b16 v[252:253], v118 offset:61440
ds_read_b64_tr_b16 v[254:255], v118 offset:63488
Mvva 188,220,108
buffer_load_dwordx4 a[196:199], v112, s[8:11], s52 offen offset:1024 sc1
s_add_u32 s52, s52, 8192
Mvva 160,224,112
ds_read_b64_tr_b16 v[192:193], v12 offset:0
ds_read_b64_tr_b16 v[194:195], v12 offset:2048
Mvva 160,240,120
buffer_load_dwordx4 a[200:203], v112, s[8:11], s52 offen offset:0 sc1
Mvva 176,224,116
s_waitcnt lgkmcnt(10)
ds_read_b64_tr_b16 v[208:209], v12 offset:4096
ds_read_b64_tr_b16 v[210:211], v12 offset:6144
Mvva 176,240,124
Mvva 164,228,112
ds_read_b64_tr_b16 v[196:197], v13 offset:0
ds_read_b64_tr_b16 v[198:199], v13 offset:2048
Mvva 164,244,120
buffer_load_dwordx4 a[204:207], v112, s[8:11], s52 offen offset:1024 sc1
s_add_u32 s52, s52, 8192
Mvva 180,228,116
s_waitcnt lgkmcnt(10)
ds_read_b64_tr_b16 v[212:213], v13 offset:4096
ds_read_b64_tr_b16 v[214:215], v13 offset:6144
Mvva 180,244,124
buffer_load_dwordx4 a[208:211], v112, s[8:11], s52 offen offset:0 sc1
Mvva 168,232,112
ds_read_b64_tr_b16 v[200:201], v14 offset:0
ds_read_b64_tr_b16 v[202:203], v14 offset:2048
Mvva 168,248,120
buffer_load_dwordx4 a[212:215], v112, s[8:11], s52 offen offset:1024 sc1
s_add_u32 s52, s52, 8192
Mvva 184,232,116
s_waitcnt lgkmcnt(10)
ds_read_b64_tr_b16 v[216:217], v14 offset:4096
ds_read_b64_tr_b16 v[218:219], v14 offset:6144
Mvva 184,248,124
Mvva 172,236,112
ds_read_b64_tr_b16 v[204:205], v15 offset:0
ds_read_b64_tr_b16 v[206:207], v15 offset:2048
Mvva 172,252,120
buffer_load_dwordx4 a[216:219], v112, s[8:11], s52 offen offset:0 sc1
Mvva 188,236,116
s_waitcnt lgkmcnt(10)
ds_read_b64_tr_b16 v[220:221], v15 offset:4096
ds_read_b64_tr_b16 v[222:223], v15 offset:6144
Mvva 188,252,124
buffer_load_dwordx4 a[220:223], v112, s[8:11], s52 offen offset:1024 sc1
s_add_u32 s52, s52, 8192
s_waitcnt vmcnt(28)
Mvva 160,192,128
s_add_u32 m0, s44, 114688
ds_read_b64_tr_b16 v[224:225], v12 offset:8192
ds_read_b64_tr_b16 v[226:227], v12 offset:10240
Mvva 160,208,136
buffer_load_dwordx4 v114, s[12:15], s48 offen offset:0 lds
Mvva 176,192,132
s_waitcnt lgkmcnt(10)
ds_read_b64_tr_b16 v[240:241], v12 offset:12288
ds_read_b64_tr_b16 v[242:243], v12 offset:14336
Mvva 176,208,140
Mvva 164,196,128
ds_read_b64_tr_b16 v[228:229], v13 offset:8192
ds_read_b64_tr_b16 v[230:231], v13 offset:10240
Mvva 164,212,136
buffer_load_dwordx4 v114, s[12:15], s49 offen offset:1024 lds
Mvva 180,196,132
s_waitcnt lgkmcnt(10)
ds_read_b64_tr_b16 v[244:245], v13 offset:12288
ds_read_b64_tr_b16 v[246:247], v13 offset:14336
Mvva 180,212,140
buffer_load_dwordx4 v114, s[12:15], s50 offen offset:2048 lds
Mvva 168,200,128
ds_read_b64_tr_b16 v[232:233], v14 offset:8192
ds_read_b64_tr_b16 v[234:235], v14 offset:10240
Mvva 168,216,136
buffer_load_dwordx4 v114, s[12:15], s51 offen offset:3072 lds
s_xor_b32 s95, s95, 128
v_add_u32 v114, s95, v113
Mvva 184,200,132
s_waitcnt lgkmcnt(10)
ds_read_b64_tr_b16 v[248:249], v14 offset:12288
ds_read_b64_tr_b16 v[250:251], v14 offset:14336
Mvva 184,216,140
Mvva 172,204,128
s_waitcnt vmcnt(24)
ds_read_b64_tr_b16 v[236:237], v15 offset:8192
ds_read_b64_tr_b16 v[238:239], v15 offset:10240
Mvva 172,220,136
s_waitcnt lgkmcnt(10)
buffer_load_dwordx4 a[224:227], v112, s[8:11], s52 offen offset:0 sc1
Mvva 188,204,132
s_barrier
ds_read_b64_tr_b16 v[252:253], v15 offset:12288
ds_read_b64_tr_b16 v[254:255], v15 offset:14336
Mvva 188,220,140
buffer_load_dwordx4 a[228:231], v112, s[8:11], s52 offen offset:1024 sc1
s_add_u32 s52, s52, 8192
Mvva 160,224,144
ds_read_b64_tr_b16 v[192:193], v12 offset:16384
ds_read_b64_tr_b16 v[194:195], v12 offset:18432
Mvva 160,240,152
buffer_load_dwordx4 a[232:235], v112, s[8:11], s52 offen offset:0 sc1
Mvva 176,224,148
s_waitcnt lgkmcnt(10)
ds_read_b64_tr_b16 v[208:209], v12 offset:20480
ds_read_b64_tr_b16 v[210:211], v12 offset:22528
Mvva 176,240,156
Mvva 164,228,144
ds_read_b64_tr_b16 v[196:197], v13 offset:16384
ds_read_b64_tr_b16 v[198:199], v13 offset:18432
Mvva 164,244,152
buffer_load_dwordx4 a[236:239], v112, s[8:11], s52 offen offset:1024 sc1
s_add_u32 s52, s52, 8192
Mvva 180,228,148
s_waitcnt lgkmcnt(10)
ds_read_b64_tr_b16 v[212:213], v13 offset:20480
ds_read_b64_tr_b16 v[214:215], v13 offset:22528
Mvva 180,244,156
buffer_load_dwordx4 a[240:243], v112, s[8:11], s52 offen offset:0 sc1
Mvva 168,232,144
ds_read_b64_tr_b16 v[200:201], v14 offset:16384
ds_read_b64_tr_b16 v[202:203], v14 offset:18432
Mvva 168,248,152
buffer_load_dwordx4 a[244:247], v112, s[8:11], s52 offen offset:1024 sc1
s_add_u32 s52, s52, 8192
Mvva 184,232,148
s_waitcnt lgkmcnt(10)
ds_read_b64_tr_b16 v[216:217], v14 offset:20480
ds_read_b64_tr_b16 v[218:219], v14 offset:22528
Mvva 184,248,156
Mvva 172,236,144
ds_read_b64_tr_b16 v[204:205], v15 offset:16384
ds_read_b64_tr_b16 v[206:207], v15 offset:18432
Mvva 172,252,152
buffer_load_dwordx4 a[248:251], v112, s[8:11], s52 offen offset:0 sc1
Mvva 188,236,148
s_waitcnt lgkmcnt(10)
ds_read_b64_tr_b16 v[220:221], v15 offset:20480
ds_read_b64_tr_b16 v[222:223], v15 offset:22528
Mvva 188,252,156
buffer_load_dwordx4 a[252:255], v112, s[8:11], s52 offen offset:1024 sc1
s_add_u32 s52, s52, 8192
s_waitcnt vmcnt(28)
Mvva 160,192,160
s_add_u32 m0, s44, 0
ds_read_b64_tr_b16 v[224:225], v12 offset:24576
ds_read_b64_tr_b16 v[226:227], v12 offset:26624
Mvva 160,208,168
buffer_load_dwordx4 v114, s[12:15], s48 offen offset:0 lds
Mvva 176,192,164
s_waitcnt lgkmcnt(10)
ds_read_b64_tr_b16 v[240:241], v12 offset:28672
ds_read_b64_tr_b16 v[242:243], v12 offset:30720
Mvva 176,208,172
Mvva 164,196,160
ds_read_b64_tr_b16 v[228:229], v13 offset:24576
ds_read_b64_tr_b16 v[230:231], v13 offset:26624
Mvva 164,212,168
buffer_load_dwordx4 v114, s[12:15], s49 offen offset:1024 lds
Mvva 180,196,164
s_waitcnt lgkmcnt(10)
ds_read_b64_tr_b16 v[244:245], v13 offset:28672
ds_read_b64_tr_b16 v[246:247], v13 offset:30720
Mvva 180,212,172
buffer_load_dwordx4 v114, s[12:15], s50 offen offset:2048 lds
Mvva 168,200,160
ds_read_b64_tr_b16 v[232:233], v14 offset:24576
ds_read_b64_tr_b16 v[234:235], v14 offset:26624
Mvva 168,216,168
buffer_load_dwordx4 v114, s[12:15], s51 offen offset:3072 lds
v_add_u32 v114, 262144, v114
Mvva 184,200,164
s_waitcnt lgkmcnt(10)
ds_read_b64_tr_b16 v[248:249], v14 offset:28672
ds_read_b64_tr_b16 v[250:251], v14 offset:30720
Mvva 184,216,172
Mvva 172,204,160
s_waitcnt vmcnt(24)
s_add_u32 m0, s44, 16384
ds_read_b64_tr_b16 v[236:237], v15 offset:24576
ds_read_b64_tr_b16 v[238:239], v15 offset:26624
Mvva 172,220,168
s_waitcnt lgkmcnt(10)
buffer_load_dwordx4 v114, s[12:15], s48 offen offset:0 lds
Mvva 188,204,164
s_barrier
ds_read_b64_tr_b16 v[252:253], v15 offset:28672
ds_read_b64_tr_b16 v[254:255], v15 offset:30720
Mvva 188,220,172
buffer_load_dwordx4 v114, s[12:15], s49 offen offset:1024 lds
Mvva 160,224,176
ds_read_b64_tr_b16 v[192:193], v12 offset:32768
ds_read_b64_tr_b16 v[194:195], v12 offset:34816
Mvva 160,240,184
buffer_load_dwordx4 v114, s[12:15], s50 offen offset:2048 lds
Mvva 176,224,180
s_waitcnt lgkmcnt(10)
ds_read_b64_tr_b16 v[208:209], v12 offset:36864
ds_read_b64_tr_b16 v[210:211], v12 offset:38912
Mvva 176,240,188
s_cmp_lg_u32 s53, 0
s_cbranch_scc1 L_yB
L_yBr:
Mvva 164,228,176
ds_read_b64_tr_b16 v[196:197], v13 offset:32768
ds_read_b64_tr_b16 v[198:199], v13 offset:34816
Mvva 164,244,184
buffer_load_dwordx4 v114, s[12:15], s51 offen offset:3072 lds
v_add_u32 v114, 262144, v114
Mvva 180,228,180
s_waitcnt lgkmcnt(10)
s_add_u32 m0, s44, 32768
ds_read_b64_tr_b16 v[212:213], v13 offset:36864
ds_read_b64_tr_b16 v[214:215], v13 offset:38912
Mvva 180,244,188
buffer_load_dwordx4 v114, s[12:15], s48 offen offset:0 lds
Mvva 168,232,176
ds_read_b64_tr_b16 v[200:201], v14 offset:32768
ds_read_b64_tr_b16 v[202:203], v14 offset:34816
Mvva 168,248,184
buffer_load_dwordx4 v114, s[12:15], s49 offen offset:1024 lds
Mvva 184,232,180
s_waitcnt lgkmcnt(10)
ds_read_b64_tr_b16 v[216:217], v14 offset:36864
ds_read_b64_tr_b16 v[218:219], v14 offset:38912
Mvva 184,248,188
Mvva 172,236,176
ds_read_b64_tr_b16 v[204:205], v15 offset:32768
ds_read_b64_tr_b16 v[206:207], v15 offset:34816
Mvva 172,252,184
buffer_load_dwordx4 v114, s[12:15], s50 offen offset:2048 lds
Mvva 188,236,180
s_waitcnt lgkmcnt(10)
ds_read_b64_tr_b16 v[220:221], v15 offset:36864
ds_read_b64_tr_b16 v[222:223], v15 offset:38912
Mvva 188,252,188
buffer_load_dwordx4 v114, s[12:15], s51 offen offset:3072 lds
v_add_u32 v114, 262144, v114
s_waitcnt vmcnt(28)
Mvva 160,192,192
ds_read_b64_tr_b16 v[224:225], v12 offset:40960
ds_read_b64_tr_b16 v[226:227], v12 offset:43008
Mvva 160,208,200
Mvva 176,192,196
s_waitcnt lgkmcnt(10)
s_add_u32 m0, s44, 49152
ds_read_b64_tr_b16 v[240:241], v12 offset:45056
ds_read_b64_tr_b16 v[242:243], v12 offset:47104
Mvva 176,208,204
buffer_load_dwordx4 v114, s[12:15], s48 offen offset:0 lds
Mvva 164,196,192
ds_read_b64_tr_b16 v[228:229], v13 offset:40960
ds_read_b64_tr_b16 v[230:231], v13 offset:43008
Mvva 164,212,200
Mvva 180,196,196
s_waitcnt lgkmcnt(10)
ds_read_b64_tr_b16 v[244:245], v13 offset:45056
ds_read_b64_tr_b16 v[246:247], v13 offset:47104
Mvva 180,212,204
buffer_load_dwordx4 v114, s[12:15], s49 offen offset:1024 lds
Mvva 168,200,192
ds_read_b64_tr_b16 v[232:233], v14 offset:40960
ds_read_b64_tr_b16 v[234:235], v14 offset:43008
Mvva 168,216,200
Mvva 184,200,196
s_waitcnt lgkmcnt(10)
ds_read_b64_tr_b16 v[248:249], v14 offset:45056
ds_read_b64_tr_b16 v[250:251], v14 offset:47104
Mvva 184,216,204
buffer_load_dwordx4 v114, s[12:15], s50 offen offset:2048 lds
Mvva 172,204,192
s_waitcnt vmcnt(23)
ds_read_b64_tr_b16 v[236:237], v15 offset:40960
ds_read_b64_tr_b16 v[238:239], v15 offset:43008
Mvva 172,220,200
s_waitcnt lgkmcnt(10)
Mvva 188,204,196
s_barrier
ds_read_b64_tr_b16 v[252:253], v15 offset:45056
ds_read_b64_tr_b16 v[254:255], v15 offset:47104
Mvva 188,220,204
buffer_load_dwordx4 v114, s[12:15], s51 offen offset:3072 lds
v_add_u32 v114, 262144, v114
Mvva 160,224,208
ds_read_b64_tr_b16 v[192:193], v12 offset:49152
ds_read_b64_tr_b16 v[194:195], v12 offset:51200
Mvva 160,240,216
Mvva 176,224,212
s_waitcnt lgkmcnt(10)
s_add_u32 m0, s44, 65536
ds_read_b64_tr_b16 v[208:209], v12 offset:53248
ds_read_b64_tr_b16 v[210:211], v12 offset:55296
Mvva 176,240,220
buffer_load_dwordx4 v114, s[12:15], s48 offen offset:0 lds
Mvva 164,228,208
ds_read_b64_tr_b16 v[196:197], v13 offset:49152
ds_read_b64_tr_b16 v[198:199], v13 offset:51200
Mvva 164,244,216
Mvva 180,228,212
s_waitcnt lgkmcnt(10)
ds_read_b64_tr_b16 v[212:213], v13 offset:53248
ds_read_b64_tr_b16 v[214:215], v13 offset:55296
Mvva 180,244,220
buffer_load_dwordx4 v114, s[12:15], s49 offen offset:1024 lds
Mvva 168,232,208
ds_read_b64_tr_b16 v[200:201], v14 offset:49152
ds_read_b64_tr_b16 v[202:203], v14 offset:51200
Mvva 168,248,216
Mvva 184,232,212
s_waitcnt lgkmcnt(10)
ds_read_b64_tr_b16 v[216:217], v14 offset:53248
ds_read_b64_tr_b16 v[218:219], v14 offset:55296
Mvva 184,248,220
buffer_load_dwordx4 v114, s[12:15], s50 offen offset:2048 lds
Mvva 172,236,208
ds_read_b64_tr_b16 v[204:205], v15 offset:49152
ds_read_b64_tr_b16 v[206:207], v15 offset:51200
Mvva 172,252,216
Mvva 188,236,212
s_waitcnt lgkmcnt(10)
ds_read_b64_tr_b16 v[220:221], v15 offset:53248
ds_read_b64_tr_b16 v[222:223], v15 offset:55296
Mvva 188,252,220
buffer_load_dwordx4 v114, s[12:15], s51 offen offset:3072 lds
v_add_u32 v114, 262144, v114
s_waitcnt vmcnt(24)
Mvva 160,192,224
ds_read_b64_tr_b16 v[224:225], v12 offset:57344
ds_read_b64_tr_b16 v[226:227], v12 offset:59392
Mvva 160,208,232
Mvva 176,192,228
s_waitcnt lgkmcnt(10)
ds_read_b64_tr_b16 v[240:241], v12 offset:61440
ds_read_b64_tr_b16 v[242:243], v12 offset:63488
Mvva 176,208,236
Mvva 164,196,224
s_add_u32 m0, s44, 81920
ds_read_b64_tr_b16 v[228:229], v13 offset:57344
ds_read_b64_tr_b16 v[230:231], v13 offset:59392
Mvva 164,212,232
buffer_load_dwordx4 v114, s[12:15], s48 offen offset:0 lds
Mvva 180,196,228
s_waitcnt lgkmcnt(10)
ds_read_b64_tr_b16 v[244:245], v13 offset:61440
ds_read_b64_tr_b16 v[246:247], v13 offset:63488
Mvva 180,212,236
Mvva 168,200,224
ds_read_b64_tr_b16 v[232:233], v14 offset:57344
ds_read_b64_tr_b16 v[234:235], v14 offset:59392
Mvva 168,216,232
Mvva 184,200,228
s_waitcnt lgkmcnt(10)
ds_read_b64_tr_b16 v[248:249], v14 offset:61440
ds_read_b64_tr_b16 v[250:251], v14 offset:63488
Mvva 184,216,236
Mvva 172,204,224
s_waitcnt vmcnt(17)
ds_read_b64_tr_b16 v[236:237], v15 offset:57344
ds_read_b64_tr_b16 v[238:239], v15 offset:59392
Mvva 172,220,232
s_waitcnt lgkmcnt(10)
buffer_load_dwordx4 v114, s[12:15], s49 offen offset:1024 lds
Mvva 188,204,228
s_barrier
ds_read_b64_tr_b16 v[252:253], v15 offset:61440
ds_read_b64_tr_b16 v[254:255], v15 offset:63488
Mvva 188,220,236
Mvva 160,224,240
ds_read_b64_tr_b16 v[192:193], v115 offset:0
ds_read_b64_tr_b16 v[194:195], v115 offset:2048
Mvva 160,240,248
s_cmp_lg_u32 s40, 0
s_cbranch_scc1 L_yC
L_yCr:
Mvva 176,224,244
s_waitcnt lgkmcnt(10)
ds_read_b64_tr_b16 v[208:209], v115 offset:4096
ds_read_b64_tr_b16 v[210:211], v115 offset:6144
Mvva 176,240,252
Mvva 164,228,240
ds_read_b64_tr_b16 v[196:197], v116 offset:0
ds_read_b64_tr_b16 v[198:199], v116 offset:2048
Mvva 164,244,248
buffer_load_dwordx4 v114, s[12:15], s50 offen offset:2048 lds
Mvva 180,228,244
s_waitcnt lgkmcnt(10)
ds_read_b64_tr_b16 v[212:213], v116 offset:4096
ds_read_b64_tr_b16 v[214:215], v116 offset:6144
Mvva 180,244,252
Mvva 168,232,240
ds_read_b64_tr_b16 v[200:201], v117 offset:0
ds_read_b64_tr_b16 v[202:203], v117 offset:2048
Mvva 168,248,248
Mvva 184,232,244
s_waitcnt lgkmcnt(10)
ds_read_b64_tr_b16 v[216:217], v117 offset:4096
ds_read_b64_tr_b16 v[218:219], v117 offset:6144
Mvva 184,248,252
Mvva 172,236,240
ds_read_b64_tr_b16 v[204:205], v118 offset:0
ds_read_b64_tr_b16 v[206:207], v118 offset:2048
Mvva 172,252,248
buffer_load_dwordx4 v114, s[12:15], s51 offen offset:3072 lds
v_add_u32 v114, 262144, v114
Mvva 188,236,244
s_waitcnt lgkmcnt(10)
ds_read_b64_tr_b16 v[220:221], v118 offset:4096
ds_read_b64_tr_b16 v[222:223], v118 offset:6144
Mvva 188,252,252
Mvva 128,192,0
ds_read_b64_tr_b16 v[224:225], v115 offset:8192
ds_read_b64_tr_b16 v[226:227], v115 offset:10240
Mvva 128,208,8
Mvva 144,192,4
s_waitcnt lgkmcnt(10)
ds_read_b64_tr_b16 v[240:241], v115 offset:12288
ds_read_b64_tr_b16 v[242:243], v115 offset:14336
Mvva 144,208,12
Mvva 132,196,0
s_add_u32 m0, s44, 98304
ds_read_b64_tr_b16 v[228:229], v116 offset:8192
ds_read_b64_tr_b16 v[230:231], v116 offset:10240
Mvva 132,212,8
buffer_load_dwordx4 v114, s[12:15], s48 offen offset:0 lds
Mvva 148,196,4
s_waitcnt lgkmcnt(10)
ds_read_b64_tr_b16 v[244:245], v116 offset:12288
ds_read_b64_tr_b16 v[246:247], v116 offset:14336
Mvva 148,212,12
v_add_u32 v10, 4096, v112
Mvva 136,200,0
ds_read_b64_tr_b16 v[232:233], v117 offset:8192
ds_read_b64_tr_b16 v[234:235], v117 offset:10240
Mvva 136,216,8
buffer_store_dwordx4 v[160:163], v112, s[16:19], s26 offen offset:0 sc1
Mvva 152,200,4
s_waitcnt lgkmcnt(10)
ds_read_b64_tr_b16 v[248:249], v117 offset:12288
ds_read_b64_tr_b16 v[250:251], v117 offset:14336
Mvva 152,216,12
buffer_store_dwordx4 v[164:167], v112, s[16:19], s26 offen offset:1024 sc1
Mvva 140,204,0
s_waitcnt vmcnt(19)
ds_read_b64_tr_b16 v[236:237], v118 offset:8192
ds_read_b64_tr_b16 v[238:239], v118 offset:10240
Mvva 140,220,8
s_waitcnt lgkmcnt(10)
buffer_load_dwordx4 v114, s[12:15], s49 offen offset:1024 lds
Mvva 156,204,4
s_barrier
ds_read_b64_tr_b16 v[252:253], v118 offset:12288
ds_read_b64_tr_b16 v[254:255], v118 offset:14336
Mvva 156,220,12
buffer_store_dwordx4 v[168:171], v112, s[16:19], s26 offen offset:2048 sc1
Mvva 128,224,16
ds_read_b64_tr_b16 v[192:193], v115 offset:16384
ds_read_b64_tr_b16 v[194:195], v115 offset:18432
Mvva 128,240,24
buffer_store_dwordx4 v[172:175], v112, s[16:19], s26 offen offset:3072 sc1
Mvva 144,224,20
s_waitcnt lgkmcnt(10)
ds_read_b64_tr_b16 v[208:209], v115 offset:20480
ds_read_b64_tr_b16 v[210:211], v115 offset:22528
Mvva 144,240,28
buffer_store_dwordx4 v[176:179], v10, s[16:19], s26 offen offset:0 sc1
Mvva 132,228,16
ds_read_b64_tr_b16 v[196:197], v116 offset:16384
ds_read_b64_tr_b16 v[198:199], v116 offset:18432
Mvva 132,244,24
buffer_load_dwordx4 v114, s[12:15], s50 offen offset:2048 lds
Mvva 148,228,20
s_waitcnt lgkmcnt(10)
ds_read_b64_tr_b16 v[212:213], v116 offset:20480
ds_read_b64_tr_b16 v[214:215], v116 offset:22528
Mvva 148,244,28
buffer_store_dwordx4 v[180:183], v10, s[16:19], s26 offen offset:1024 sc1
Mvva 136,232,16
ds_read_b64_tr_b16 v[200:201], v117 offset:16384
ds_read_b64_tr_b16 v[202:203], v117 offset:18432
Mvva 136,248,24
buffer_store_dwordx4 v[184:187], v10, s[16:19], s26 offen offset:2048 sc1
Mvva 152,232,20
s_waitcnt lgkmcnt(10)
ds_read_b64_tr_b16 v[216:217], v117 offset:20480
ds_read_b64_tr_b16 v[218:219], v117 offset:22528
Mvva 152,248,28
buffer_store_dwordx4 v[188:191], v10, s[16:19], s26 offen offset:3072 sc1
Mvva 140,236,16
ds_read_b64_tr_b16 v[204:205], v118 offset:16384
ds_read_b64_tr_b16 v[206:207], v118 offset:18432
Mvva 140,252,24
buffer_load_dwordx4 v114, s[12:15], s51 offen offset:3072 lds
v_add_u32 v114, 262144, v114
Mvva 156,236,20
s_waitcnt lgkmcnt(10)
ds_read_b64_tr_b16 v[220:221], v118 offset:20480
ds_read_b64_tr_b16 v[222:223], v118 offset:22528
Mvva 156,252,28
v_mov_b32_e64 v16, 1
Mvva 128,192,32
ds_read_b64_tr_b16 v[224:225], v115 offset:24576
ds_read_b64_tr_b16 v[226:227], v115 offset:26624
Mvva 128,208,40
Mvva 144,192,36
s_waitcnt lgkmcnt(10)
ds_read_b64_tr_b16 v[240:241], v115 offset:28672
ds_read_b64_tr_b16 v[242:243], v115 offset:30720
Mvva 144,208,44
Mvva 132,196,32
s_add_u32 m0, s44, 114688
ds_read_b64_tr_b16 v[228:229], v116 offset:24576
ds_read_b64_tr_b16 v[230:231], v116 offset:26624
Mvva 132,212,40
buffer_load_dwordx4 v114, s[12:15], s48 offen offset:0 lds
Mvva 148,196,36
s_waitcnt lgkmcnt(10)
ds_read_b64_tr_b16 v[244:245], v116 offset:28672
ds_read_b64_tr_b16 v[246:247], v116 offset:30720
Mvva 148,212,44
Mvva 136,200,32
ds_read_b64_tr_b16 v[232:233], v117 offset:24576
ds_read_b64_tr_b16 v[234:235], v117 offset:26624
Mvva 136,216,40
Mvva 152,200,36
s_waitcnt lgkmcnt(10)
ds_read_b64_tr_b16 v[248:249], v117 offset:28672
ds_read_b64_tr_b16 v[250:251], v117 offset:30720
Mvva 152,216,44
Mvva 140,204,32
s_waitcnt vmcnt(25)
ds_read_b64_tr_b16 v[236:237], v118 offset:24576
ds_read_b64_tr_b16 v[238:239], v118 offset:26624
Mvva 140,220,40
s_waitcnt lgkmcnt(10)
buffer_load_dwordx4 v114, s[12:15], s49 offen offset:1024 lds
Mvva 156,204,36
s_barrier
ds_read_b64_tr_b16 v[252:253], v118 offset:28672
ds_read_b64_tr_b16 v[254:255], v118 offset:30720
Mvva 156,220,44
Mvva 128,224,48
ds_read_b64_tr_b16 v[192:193], v115 offset:32768
ds_read_b64_tr_b16 v[194:195], v115 offset:34816
Mvva 128,240,56
Mvva 144,224,52
s_waitcnt lgkmcnt(10)
ds_read_b64_tr_b16 v[208:209], v115 offset:36864
ds_read_b64_tr_b16 v[210:211], v115 offset:38912
Mvva 144,240,60
Mvva 132,228,48
ds_read_b64_tr_b16 v[196:197], v116 offset:32768
ds_read_b64_tr_b16 v[198:199], v116 offset:34816
Mvva 132,244,56
buffer_load_dwordx4 v114, s[12:15], s50 offen offset:2048 lds
Mvva 148,228,52
s_waitcnt lgkmcnt(10)
ds_read_b64_tr_b16 v[212:213], v116 offset:36864
ds_read_b64_tr_b16 v[214:215], v116 offset:38912
Mvva 148,244,60
Mvva 136,232,48
ds_read_b64_tr_b16 v[200:201], v117 offset:32768
ds_read_b64_tr_b16 v[202:203], v117 offset:34816
Mvva 136,248,56
Mvva 152,232,52
s_waitcnt lgkmcnt(10)
ds_read_b64_tr_b16 v[216:217], v117 offset:36864
ds_read_b64_tr_b16 v[218:219], v117 offset:38912
Mvva 152,248,60
Mvva 140,236,48
ds_read_b64_tr_b16 v[204:205], v118 offset:32768
ds_read_b64_tr_b16 v[206:207], v118 offset:34816
Mvva 140,252,56
buffer_load_dwordx4 v114, s[12:15], s51 offen offset:3072 lds
v_add_u32 v114, 262144, v114
Mvva 156,236,52
s_waitcnt lgkmcnt(10)
ds_read_b64_tr_b16 v[220:221], v118 offset:36864
ds_read_b64_tr_b16 v[222:223], v118 offset:38912
Mvva 156,252,60
Mvva 128,192,64
ds_read_b64_tr_b16 v[224:225], v115 offset:40960
ds_read_b64_tr_b16 v[226:227], v115 offset:43008
Mvva 128,208,72
Mvva 144,192,68
s_waitcnt lgkmcnt(10)
ds_read_b64_tr_b16 v[240:241], v115 offset:45056
ds_read_b64_tr_b16 v[242:243], v115 offset:47104
Mvva 144,208,76
Mvva 132,196,64
ds_read_b64_tr_b16 v[228:229], v116 offset:40960
ds_read_b64_tr_b16 v[230:231], v116 offset:43008
Mvva 132,212,72
Mvva 148,196,68
s_waitcnt lgkmcnt(10)
ds_read_b64_tr_b16 v[244:245], v116 offset:45056
ds_read_b64_tr_b16 v[246:247], v116 offset:47104
Mvva 148,212,76
Mvva 136,200,64
ds_read_b64_tr_b16 v[232:233], v117 offset:40960
ds_read_b64_tr_b16 v[234:235], v117 offset:43008
Mvva 136,216,72
Mvva 152,200,68
s_waitcnt lgkmcnt(10)
ds_read_b64_tr_b16 v[248:249], v117 offset:45056
ds_read_b64_tr_b16 v[250:251], v117 offset:47104
Mvva 152,216,76
Mvva 140,204,64
s_waitcnt vmcnt(24)
ds_read_b64_tr_b16 v[236:237], v118 offset:40960
ds_read_b64_tr_b16 v[238:239], v118 offset:43008
Mvva 140,220,72
s_waitcnt lgkmcnt(10)
Mvva 156,204,68
s_barrier
ds_read_b64_tr_b16 v[252:253], v118 offset:45056
ds_read_b64_tr_b16 v[254:255], v118 offset:47104
Mvva 156,220,76
Mvva 128,224,80
ds_read_b64_tr_b16 v[192:193], v115 offset:49152
ds_read_b64_tr_b16 v[194:195], v115 offset:51200
Mvva 128,240,88
Mvva 144,224,84
s_waitcnt lgkmcnt(10)
ds_read_b64_tr_b16 v[208:209], v115 offset:53248
ds_read_b64_tr_b16 v[210:211], v115 offset:55296
Mvva 144,240,92
Mvva 132,228,80
ds_read_b64_tr_b16 v[196:197], v116 offset:49152
ds_read_b64_tr_b16 v[198:199], v116 offset:51200
Mvva 132,244,88
Mvva 148,228,84
s_waitcnt lgkmcnt(10)
ds_read_b64_tr_b16 v[212:213], v116 offset:53248
ds_read_b64_tr_b16 v[214:215], v116 offset:55296
Mvva 148,244,92
Mvva 136,232,80
ds_read_b64_tr_b16 v[200:201], v117 offset:49152
ds_read_b64_tr_b16 v[202:203], v117 offset:51200
Mvva 136,248,88
Mvva 152,232,84
s_waitcnt lgkmcnt(10)
ds_read_b64_tr_b16 v[216:217], v117 offset:53248
ds_read_b64_tr_b16 v[218:219], v117 offset:55296
Mvva 152,248,92
Mvva 140,236,80
ds_read_b64_tr_b16 v[204:205], v118 offset:49152
ds_read_b64_tr_b16 v[206:207], v118 offset:51200
Mvva 140,252,88
Mvva 156,236,84
s_waitcnt lgkmcnt(10)
ds_read_b64_tr_b16 v[220:221], v118 offset:53248
ds_read_b64_tr_b16 v[222:223], v118 offset:55296
Mvva 156,252,92
Mvva 128,192,96
ds_read_b64_tr_b16 v[224:225], v115 offset:57344
ds_read_b64_tr_b16 v[226:227], v115 offset:59392
Mvva 128,208,104
Mvva 144,192,100
s_waitcnt lgkmcnt(10)
ds_read_b64_tr_b16 v[240:241], v115 offset:61440
ds_read_b64_tr_b16 v[242:243], v115 offset:63488
Mvva 144,208,108
Mvva 132,196,96
ds_read_b64_tr_b16 v[228:229], v116 offset:57344
ds_read_b64_tr_b16 v[230:231], v116 offset:59392
Mvva 132,212,104
Mvva 148,196,100
s_waitcnt lgkmcnt(10)
ds_read_b64_tr_b16 v[244:245], v116 offset:61440
ds_read_b64_tr_b16 v[246:247], v116 offset:63488
Mvva 148,212,108
s_waitcnt vmcnt(5)
s_mov_b64 exec, 1
buffer_store_dword v16, v126, s[20:23], s27 offen sc1
s_mov_b64 exec, -1
Mvva 136,200,96
ds_read_b64_tr_b16 v[232:233], v117 offset:57344
ds_read_b64_tr_b16 v[234:235], v117 offset:59392
Mvva 136,216,104
Mvva 152,200,100
s_waitcnt lgkmcnt(10)
ds_read_b64_tr_b16 v[248:249], v117 offset:61440
ds_read_b64_tr_b16 v[250:251], v117 offset:63488
Mvva 152,216,108
Mvva 140,204,96
ds_read_b64_tr_b16 v[236:237], v118 offset:57344
ds_read_b64_tr_b16 v[238:239], v118 offset:59392
Mvva 140,220,104
s_waitcnt lgkmcnt(10)
Mvva 156,204,100
s_barrier
ds_read_b64_tr_b16 v[252:253], v118 offset:61440
ds_read_b64_tr_b16 v[254:255], v118 offset:63488
Mvva 156,220,108
Mvva 128,224,112
ds_read_b64_tr_b16 v[192:193], v12 offset:0
ds_read_b64_tr_b16 v[194:195], v12 offset:2048
Mvva 128,240,120
Mvva 144,224,116
s_waitcnt lgkmcnt(10)
ds_read_b64_tr_b16 v[208:209], v12 offset:4096
ds_read_b64_tr_b16 v[210:211], v12 offset:6144
Mvva 144,240,124
Mvva 132,228,112
ds_read_b64_tr_b16 v[196:197], v13 offset:0
ds_read_b64_tr_b16 v[198:199], v13 offset:2048
Mvva 132,244,120
Mvva 148,228,116
s_waitcnt lgkmcnt(10)
ds_read_b64_tr_b16 v[212:213], v13 offset:4096
ds_read_b64_tr_b16 v[214:215], v13 offset:6144
Mvva 148,244,124
Mvva 136,232,112
ds_read_b64_tr_b16 v[200:201], v14 offset:0
ds_read_b64_tr_b16 v[202:203], v14 offset:2048
Mvva 136,248,120
Mvva 152,232,116
s_waitcnt lgkmcnt(10)
ds_read_b64_tr_b16 v[216:217], v14 offset:4096
ds_read_b64_tr_b16 v[218:219], v14 offset:6144
Mvva 152,248,124
Mvva 140,236,112
ds_read_b64_tr_b16 v[204:205], v15 offset:0
ds_read_b64_tr_b16 v[206:207], v15 offset:2048
Mvva 140,252,120
Mvva 156,236,116
s_waitcnt lgkmcnt(10)
ds_read_b64_tr_b16 v[220:221], v15 offset:4096
ds_read_b64_tr_b16 v[222:223], v15 offset:6144
Mvva 156,252,124
Mvva 128,192,128
ds_read_b64_tr_b16 v[224:225], v12 offset:8192
ds_read_b64_tr_b16 v[226:227], v12 offset:10240
Mvva 128,208,136
Mvva 144,192,132
s_waitcnt lgkmcnt(10)
ds_read_b64_tr_b16 v[240:241], v12 offset:12288
ds_read_b64_tr_b16 v[242:243], v12 offset:14336
Mvva 144,208,140
Mvva 132,196,128
ds_read_b64_tr_b16 v[228:229], v13 offset:8192
ds_read_b64_tr_b16 v[230:231], v13 offset:10240
Mvva 132,212,136
Mvva 148,196,132
s_waitcnt lgkmcnt(10)
ds_read_b64_tr_b16 v[244:245], v13 offset:12288
ds_read_b64_tr_b16 v[246:247], v13 offset:14336
Mvva 148,212,140
Mvva 136,200,128
ds_read_b64_tr_b16 v[232:233], v14 offset:8192
ds_read_b64_tr_b16 v[234:235], v14 offset:10240
Mvva 136,216,136
Mvva 152,200,132
s_waitcnt lgkmcnt(10)
ds_read_b64_tr_b16 v[248:249], v14 offset:12288
ds_read_b64_tr_b16 v[250:251], v14 offset:14336
Mvva 152,216,140
Mvva 140,204,128
ds_read_b64_tr_b16 v[236:237], v15 offset:8192
ds_read_b64_tr_b16 v[238:239], v15 offset:10240
Mvva 140,220,136
s_waitcnt lgkmcnt(10)
Mvva 156,204,132
s_barrier
ds_read_b64_tr_b16 v[252:253], v15 offset:12288
ds_read_b64_tr_b16 v[254:255], v15 offset:14336
Mvva 156,220,140
Mvva 128,224,144
ds_read_b64_tr_b16 v[192:193], v12 offset:16384
ds_read_b64_tr_b16 v[194:195], v12 offset:18432
Mvva 128,240,152
Mvva 144,224,148
s_waitcnt lgkmcnt(10)
ds_read_b64_tr_b16 v[208:209], v12 offset:20480
ds_read_b64_tr_b16 v[210:211], v12 offset:22528
Mvva 144,240,156
Mvva 132,228,144
ds_read_b64_tr_b16 v[196:197], v13 offset:16384
ds_read_b64_tr_b16 v[198:199], v13 offset:18432
Mvva 132,244,152
buffer_load_dword v17, v126, s[20:23], s24 offen sc1
Mvva 148,228,148
s_waitcnt lgkmcnt(10)
ds_read_b64_tr_b16 v[212:213], v13 offset:20480
ds_read_b64_tr_b16 v[214:215], v13 offset:22528
Mvva 148,244,156
Mvva 136,232,144
ds_read_b64_tr_b16 v[200:201], v14 offset:16384
ds_read_b64_tr_b16 v[202:203], v14 offset:18432
Mvva 136,248,152
Mvva 152,232,148
s_waitcnt lgkmcnt(10)
ds_read_b64_tr_b16 v[216:217], v14 offset:20480
ds_read_b64_tr_b16 v[218:219], v14 offset:22528
Mvva 152,248,156
Mvva 140,236,144
ds_read_b64_tr_b16 v[204:205], v15 offset:16384
ds_read_b64_tr_b16 v[206:207], v15 offset:18432
Mvva 140,252,152
Mvva 156,236,148
s_waitcnt lgkmcnt(10)
ds_read_b64_tr_b16 v[220:221], v15 offset:20480
ds_read_b64_tr_b16 v[222:223], v15 offset:22528
Mvva 156,252,156
Mvva 128,192,160
ds_read_b64_tr_b16 v[224:225], v12 offset:24576
ds_read_b64_tr_b16 v[226:227], v12 offset:26624
Mvva 128,208,168
Mvva 144,192,164
s_waitcnt lgkmcnt(10)
ds_read_b64_tr_b16 v[240:241], v12 offset:28672
ds_read_b64_tr_b16 v[242:243], v12 offset:30720
Mvva 144,208,172
Mvva 132,196,160
ds_read_b64_tr_b16 v[228:229], v13 offset:24576
ds_read_b64_tr_b16 v[230:231], v13 offset:26624
Mvva 132,212,168
Mvva 148,196,164
s_waitcnt lgkmcnt(10)
ds_read_b64_tr_b16 v[244:245], v13 offset:28672
ds_read_b64_tr_b16 v[246:247], v13 offset:30720
Mvva 148,212,172
Mvva 136,200,160
ds_read_b64_tr_b16 v[232:233], v14 offset:24576
ds_read_b64_tr_b16 v[234:235], v14 offset:26624
Mvva 136,216,168
Mvva 152,200,164
s_waitcnt lgkmcnt(10)
ds_read_b64_tr_b16 v[248:249], v14 offset:28672
ds_read_b64_tr_b16 v[250:251], v14 offset:30720
Mvva 152,216,172
Mvva 140,204,160
s_waitcnt vmcnt(6)
ds_read_b64_tr_b16 v[236:237], v15 offset:24576
ds_read_b64_tr_b16 v[238:239], v15 offset:26624
Mvva 140,220,168
s_waitcnt lgkmcnt(10)
Mvva 156,204,164
s_barrier
ds_read_b64_tr_b16 v[252:253], v15 offset:28672
ds_read_b64_tr_b16 v[254:255], v15 offset:30720
Mvva 156,220,172
Mvva 128,224,176
ds_read_b64_tr_b16 v[192:193], v12 offset:32768
ds_read_b64_tr_b16 v[194:195], v12 offset:34816
Mvva 128,240,184
Mvva 144,224,180
s_waitcnt lgkmcnt(10)
ds_read_b64_tr_b16 v[208:209], v12 offset:36864
ds_read_b64_tr_b16 v[210:211], v12 offset:38912
Mvva 144,240,188
Mvva 132,228,176
ds_read_b64_tr_b16 v[196:197], v13 offset:32768
ds_read_b64_tr_b16 v[198:199], v13 offset:34816
Mvva 132,244,184
Mvva 148,228,180
s_waitcnt lgkmcnt(10)
ds_read_b64_tr_b16 v[212:213], v13 offset:36864
ds_read_b64_tr_b16 v[214:215], v13 offset:38912
Mvva 148,244,188
Mvva 136,232,176
ds_read_b64_tr_b16 v[200:201], v14 offset:32768
ds_read_b64_tr_b16 v[202:203], v14 offset:34816
Mvva 136,248,184
Mvva 152,232,180
s_waitcnt lgkmcnt(10)
ds_read_b64_tr_b16 v[216:217], v14 offset:36864
ds_read_b64_tr_b16 v[218:219], v14 offset:38912
Mvva 152,248,188
s_waitcnt vmcnt(0)
v_cmp_ne_u32 vcc, 1, v17
s_mov_b32 s33, 0
s_cbranch_vccnz L_xno
buffer_load_dwordx4 v[160:163], v112, s[16:19], s25 offen offset:0 sc1
buffer_load_dwordx4 v[164:167], v112, s[16:19], s25 offen offset:1024 sc1
buffer_load_dwordx4 v[168:171], v112, s[16:19], s25 offen offset:2048 sc1
buffer_load_dwordx4 v[172:175], v112, s[16:19], s25 offen offset:3072 sc1
buffer_load_dwordx4 v[176:179], v10, s[16:19], s25 offen offset:0 sc1
buffer_load_dwordx4 v[180:183], v10, s[16:19], s25 offen offset:1024 sc1
buffer_load_dwordx4 v[184:187], v10, s[16:19], s25 offen offset:2048 sc1
buffer_load_dwordx4 v[188:191], v10, s[16:19], s25 offen offset:3072 sc1
s_mov_b32 s33, 1
L_xno:
Mvva 140,236,176
ds_read_b64_tr_b16 v[204:205], v15 offset:32768
ds_read_b64_tr_b16 v[206:207], v15 offset:34816
Mvva 140,252,184
Mvva 156,236,180
s_waitcnt lgkmcnt(10)
ds_read_b64_tr_b16 v[220:221], v15 offset:36864
ds_read_b64_tr_b16 v[222:223], v15 offset:38912
Mvva 156,252,188
Mvva 128,192,192
ds_read_b64_tr_b16 v[224:225], v12 offset:40960
ds_read_b64_tr_b16 v[226:227], v12 offset:43008
Mvva 128,208,200
Mvva 144,192,196
s_waitcnt lgkmcnt(10)
ds_read_b64_tr_b16 v[240:241], v12 offset:45056
ds_read_b64_tr_b16 v[242:243], v12 offset:47104
Mvva 144,208,204
Mvva 132,196,192
ds_read_b64_tr_b16 v[228:229], v13 offset:40960
ds_read_b64_tr_b16 v[230:231], v13 offset:43008
Mvva 132,212,200
Mvva 148,196,196
s_waitcnt lgkmcnt(10)
ds_read_b64_tr_b16 v[244:245], v13 offset:45056
ds_read_b64_tr_b16 v[246:247], v13 offset:47104
Mvva 148,212,204
Mvva 136,200,192
ds_read_b64_tr_b16 v[232:233], v14 offset:40960
ds_read_b64_tr_b16 v[234:235], v14 offset:43008
Mvva 136,216,200
Mvva 152,200,196
s_waitcnt lgkmcnt(10)
ds_read_b64_tr_b16 v[248:249], v14 offset:45056
ds_read_b64_tr_b16 v[250:251], v14 offset:47104
Mvva 152,216,204
Mvva 140,204,192
ds_read_b64_tr_b16 v[236:237], v15 offset:40960
ds_read_b64_tr_b16 v[238:239], v15 offset:43008
Mvva 140,220,200
s_waitcnt lgkmcnt(10)
Mvva 156,204,196
s_barrier
ds_read_b64_tr_b16 v[252:253], v15 offset:45056
ds_read_b64_tr_b16 v[254:255], v15 offset:47104
Mvva 156,220,204
Mvva 128,224,208
ds_read_b64_tr_b16 v[192:193], v12 offset:49152
ds_read_b64_tr_b16 v[194:195], v12 offset:51200
Mvva 128,240,216
Mvva 144,224,212
s_waitcnt lgkmcnt(10)
ds_read_b64_tr_b16 v[208:209], v12 offset:53248
ds_read_b64_tr_b16 v[210:211], v12 offset:55296
Mvva 144,240,220
Mvva 132,228,208
ds_read_b64_tr_b16 v[196:197], v13 offset:49152
ds_read_b64_tr_b16 v[198:199], v13 offset:51200
Mvva 132,244,216
Mvva 148,228,212
s_waitcnt lgkmcnt(10)
ds_read_b64_tr_b16 v[212:213], v13 offset:53248
ds_read_b64_tr_b16 v[214:215], v13 offset:55296
Mvva 148,244,220
Mvva 136,232,208
ds_read_b64_tr_b16 v[200:201], v14 offset:49152
ds_read_b64_tr_b16 v[202:203], v14 offset:51200
Mvva 136,248,216
Mvva 152,232,212
s_waitcnt lgkmcnt(10)
ds_read_b64_tr_b16 v[216:217], v14 offset:53248
ds_read_b64_tr_b16 v[218:219], v14 offset:55296
Mvva 152,248,220
Mvva 140,236,208
ds_read_b64_tr_b16 v[204:205], v15 offset:49152
ds_read_b64_tr_b16 v[206:207], v15 offset:51200
Mvva 140,252,216
Mvva 156,236,212
s_waitcnt lgkmcnt(10)
ds_read_b64_tr_b16 v[220:221], v15 offset:53248
ds_read_b64_tr_b16 v[222:223], v15 offset:55296
Mvva 156,252,220
Mvva 128,192,224
ds_read_b64_tr_b16 v[224:225], v12 offset:57344
ds_read_b64_tr_b16 v[226:227], v12 offset:59392
Mvva 128,208,232
Mvva 144,192,228
s_waitcnt lgkmcnt(10)
ds_read_b64_tr_b16 v[240:241], v12 offset:61440
ds_read_b64_tr_b16 v[242:243], v12 offset:63488
Mvva 144,208,236
Mvva 132,196,224
ds_read_b64_tr_b16 v[228:229], v13 offset:57344
ds_read_b64_tr_b16 v[230:231], v13 offset:59392
Mvva 132,212,232
Mvva 148,196,228
s_waitcnt lgkmcnt(10)
ds_read_b64_tr_b16 v[244:245], v13 offset:61440
ds_read_b64_tr_b16 v[246:247], v13 offset:63488
Mvva 148,212,236
Mvva 136,200,224
ds_read_b64_tr_b16 v[232:233], v14 offset:57344
ds_read_b64_tr_b16 v[234:235], v14 offset:59392
Mvva 136,216,232
Mvva 152,200,228
s_waitcnt lgkmcnt(10)
ds_read_b64_tr_b16 v[248:249], v14 offset:61440
ds_read_b64_tr_b16 v[250:251], v14 offset:63488
Mvva 152,216,236
Mvva 140,204,224
ds_read_b64_tr_b16 v[236:237], v15 offset:57344
ds_read_b64_tr_b16 v[238:239], v15 offset:59392
Mvva 140,220,232
s_waitcnt lgkmcnt(10)
Mvva 156,204,228
ds_read_b64_tr_b16 v[252:253], v15 offset:61440
ds_read_b64_tr_b16 v[254:255], v15 offset:63488
Mvva 156,220,236
Mvva 128,224,240
Mvva 128,240,248
Mvva 144,224,244
s_waitcnt lgkmcnt(8)
Mvva 144,240,252
Mvva 132,228,240
Mvva 132,244,248
Mvva 148,228,244
s_waitcnt lgkmcnt(4)
Mvva 148,244,252
Mvva 136,232,240
Mvva 136,248,248
Mvva 152,232,244
s_waitcnt lgkmcnt(0)
Mvva 152,248,252
Mvva 140,236,240
Mvva 140,252,248
Mvva 156,236,244
Mvva 156,252,252
s_cmp_lg_u32 s53, s40
s_cbranch_scc1 L_ysl
L_yslr:
v_and_b32 v124, 15, v0
v_lshlrev_b32 v74, 8, v124
v_add_u32 v74, s35, v74
v_xor_b32 v124, v124, v121
v_lshl_add_u32 v74, v124, 4, v74
v_xor_b32_e64 v75, 64, v74
v_xor_b32 v76, 128, v74
v_xor_b32 v77, 192, v74
v_lshlrev_b32 v125, 1, v122
v_xor_b32 v124, v123, v125
v_lshlrev_b32 v12, 8, v123
v_add_u32 v12, s35, v12
v_lshl_add_u32 v12, v124, 4, v12
v_xor_b32_e64 v13, 16, v12
v_xor_b32 v14, 128, v12
v_xor_b32 v15, 144, v12
s_cmp_eq_u32 s33, 0
s_cbranch_scc1 L_spinX
L_spinXr:
v_lshlrev_b32_e64 v80, 16, v18
v_and_b32 v81, 0xffff0000, v18
v_lshlrev_b32_e64 v82, 16, v19
v_and_b32 v83, 0xffff0000, v19
v_lshlrev_b32_e64 v84, 16, v20
v_and_b32 v85, 0xffff0000, v20
v_lshlrev_b32_e64 v86, 16, v21
v_and_b32 v87, 0xffff0000, v21
v_lshlrev_b32_e64 v88, 16, v22
v_and_b32 v89, 0xffff0000, v22
v_lshlrev_b32_e64 v90, 16, v23
v_and_b32 v91, 0xffff0000, v23
v_lshlrev_b32_e64 v92, 16, v24
v_and_b32 v93, 0xffff0000, v24
v_lshlrev_b32_e64 v94, 16, v25
v_and_b32 v95, 0xffff0000, v25
v_lshlrev_b32_e64 v96, 16, v26
v_and_b32 v97, 0xffff0000, v26
v_lshlrev_b32_e64 v98, 16, v27
v_and_b32 v99, 0xffff0000, v27
v_lshlrev_b32_e64 v100, 16, v28
v_and_b32 v101, 0xffff0000, v28
v_lshlrev_b32_e64 v102, 16, v29
v_and_b32 v103, 0xffff0000, v29
v_lshlrev_b32_e64 v104, 16, v30
v_and_b32 v105, 0xffff0000, v30
v_lshlrev_b32_e64 v106, 16, v31
v_and_b32 v107, 0xffff0000, v31
v_lshlrev_b32_e64 v108, 16, v32
v_and_b32 v109, 0xffff0000, v32
v_lshlrev_b32_e64 v110, 16, v33
v_and_b32 v111, 0xffff0000, v33
s_waitcnt vmcnt(0)
s_nop 0
v_pk_add_f32 v[128:129], v[128:129], v[160:161]
v_pk_add_f32 v[130:131], v[130:131], v[162:163]
ds_write_b128 v74, v[128:131] offset:0
v_pk_add_f32 v[132:133], v[132:133], v[164:165]
v_pk_add_f32 v[134:135], v[134:135], v[166:167]
ds_write_b128 v75, v[132:135] offset:0
v_pk_add_f32 v[136:137], v[136:137], v[168:169]
v_pk_add_f32 v[138:139], v[138:139], v[170:171]
ds_write_b128 v76, v[136:139] offset:0
v_pk_add_f32 v[140:141], v[140:141], v[172:173]
v_pk_add_f32 v[142:143], v[142:143], v[174:175]
ds_write_b128 v77, v[140:143] offset:0
v_pk_add_f32 v[144:145], v[144:145], v[176:177]
v_pk_add_f32 v[146:147], v[146:147], v[178:179]
ds_write_b128 v74, v[144:147] offset:4096
v_pk_add_f32 v[148:149], v[148:149], v[180:181]
v_pk_add_f32 v[150:151], v[150:151], v[182:183]
ds_write_b128 v75, v[148:151] offset:4096
v_pk_add_f32 v[152:153], v[152:153], v[184:185]
v_pk_add_f32 v[154:155], v[154:155], v[186:187]
ds_write_b128 v76, v[152:155] offset:4096
v_pk_add_f32 v[156:157], v[156:157], v[188:189]
v_pk_add_f32 v[158:159], v[158:159], v[190:191]
ds_write_b128 v77, v[156:159] offset:4096
Rv 192,12,0
Rv 196,13,0
Rv 200,14,2048
Rv 204,15,2048
Rv 208,12,4096
Rv 212,13,4096
Rv 216,14,6144
s_waitcnt lgkmcnt(9)
Rv 220,15,6144
s_waitcnt lgkmcnt(6)
Vc 224,192,193
v_lshlrev_b32_e64 v192, 16, v224
v_and_b32 v193, 0xffff0000, v224
Vc 225,194,195
v_lshlrev_b32_e64 v194, 16, v225
v_and_b32 v195, 0xffff0000, v225
Vc 226,196,197
v_lshlrev_b32_e64 v196, 16, v226
v_and_b32 v197, 0xffff0000, v226
Vc 227,198,199
v_lshlrev_b32_e64 v198, 16, v227
v_and_b32 v199, 0xffff0000, v227
v_pk_mul_f32 v[192:193], v[192:193], v[42:43]
v_pk_mul_f32 v[194:195], v[194:195], v[44:45]
v_pk_mul_f32 v[196:197], v[196:197], v[46:47]
v_pk_mul_f32 v[198:199], v[198:199], v[48:49]
Vc 224,192,193
v_lshlrev_b32_e64 v192, 16, v224
v_and_b32 v193, 0xffff0000, v224
Vc 225,194,195
v_lshlrev_b32_e64 v194, 16, v225
v_and_b32 v195, 0xffff0000, v225
Vc 226,196,197
v_lshlrev_b32_e64 v196, 16, v226
v_and_b32 v197, 0xffff0000, v226
Vc 227,198,199
v_lshlrev_b32_e64 v198, 16, v227
v_and_b32 v199, 0xffff0000, v227
v_pk_add_f32 v[192:193], v[192:193], v[80:81]
v_pk_add_f32 v[194:195], v[194:195], v[82:83]
v_pk_add_f32 v[196:197], v[196:197], v[84:85]
v_pk_add_f32 v[198:199], v[198:199], v[86:87]
Vc 224,192,193
Vc 225,194,195
Vc 226,196,197
Vc 227,198,199
buffer_store_dwordx4 v[224:227], v119, s[68:71], s36 offen sc1
s_add_u32 s36, s36, 16384
s_waitcnt lgkmcnt(4)
Vc 228,200,201
v_lshlrev_b32 v200, 16, v228
v_and_b32 v201, 0xffff0000, v228
Vc 229,202,203
v_lshlrev_b32_e64 v202, 16, v229
v_and_b32 v203, 0xffff0000, v229
Vc 230,204,205
v_lshlrev_b32_e64 v204, 16, v230
v_and_b32 v205, 0xffff0000, v230
Vc 231,206,207
v_lshlrev_b32_e64 v206, 16, v231
v_and_b32 v207, 0xffff0000, v231
v_pk_mul_f32 v[200:201], v[200:201], v[50:51]
v_pk_mul_f32 v[202:203], v[202:203], v[52:53]
v_pk_mul_f32 v[204:205], v[204:205], v[54:55]
v_pk_mul_f32 v[206:207], v[206:207], v[56:57]
Vc 228,200,201
v_lshlrev_b32_e64 v200, 16, v228
v_and_b32 v201, 0xffff0000, v228
Vc 229,202,203
v_lshlrev_b32_e64 v202, 16, v229
v_and_b32 v203, 0xffff0000, v229
Vc 230,204,205
v_lshlrev_b32_e64 v204, 16, v230
v_and_b32 v205, 0xffff0000, v230
Vc 231,206,207
v_lshlrev_b32_e64 v206, 16, v231
v_and_b32 v207, 0xffff0000, v231
v_pk_add_f32 v[200:201], v[200:201], v[88:89]
v_pk_add_f32 v[202:203], v[202:203], v[90:91]
v_pk_add_f32 v[204:205], v[204:205], v[92:93]
v_pk_add_f32 v[206:207], v[206:207], v[94:95]
Vc 228,200,201
Vc 229,202,203
Vc 230,204,205
Vc 231,206,207
buffer_store_dwordx4 v[228:231], v119, s[68:71], s36 offen sc1
s_add_u32 s36, s36, 16384
s_waitcnt lgkmcnt(2)
Vc 232,208,209
v_lshlrev_b32 v208, 16, v232
v_and_b32 v209, 0xffff0000, v232
Vc 233,210,211
v_lshlrev_b32_e64 v210, 16, v233
v_and_b32 v211, 0xffff0000, v233
Vc 234,212,213
v_lshlrev_b32_e64 v212, 16, v234
v_and_b32 v213, 0xffff0000, v234
Vc 235,214,215
v_lshlrev_b32_e64 v214, 16, v235
v_and_b32 v215, 0xffff0000, v235
v_pk_mul_f32 v[208:209], v[208:209], v[58:59]
v_pk_mul_f32 v[210:211], v[210:211], v[60:61]
v_pk_mul_f32 v[212:213], v[212:213], v[62:63]
v_pk_mul_f32 v[214:215], v[214:215], v[64:65]
Vc 232,208,209
v_lshlrev_b32_e64 v208, 16, v232
v_and_b32 v209, 0xffff0000, v232
Vc 233,210,211
v_lshlrev_b32_e64 v210, 16, v233
v_and_b32 v211, 0xffff0000, v233
Vc 234,212,213
v_lshlrev_b32_e64 v212, 16, v234
v_and_b32 v213, 0xffff0000, v234
Vc 235,214,215
v_lshlrev_b32_e64 v214, 16, v235
v_and_b32 v215, 0xffff0000, v235
v_pk_add_f32 v[208:209], v[208:209], v[96:97]
v_pk_add_f32 v[210:211], v[210:211], v[98:99]
v_pk_add_f32 v[212:213], v[212:213], v[100:101]
v_pk_add_f32 v[214:215], v[214:215], v[102:103]
Vc 232,208,209
Vc 233,210,211
Vc 234,212,213
Vc 235,214,215
buffer_store_dwordx4 v[232:235], v119, s[68:71], s36 offen sc1
s_add_u32 s36, s36, 16384
s_waitcnt lgkmcnt(0)
Vc 236,216,217
v_lshlrev_b32 v216, 16, v236
v_and_b32 v217, 0xffff0000, v236
Vc 237,218,219
v_lshlrev_b32_e64 v218, 16, v237
v_and_b32 v219, 0xffff0000, v237
Vc 238,220,221
v_lshlrev_b32_e64 v220, 16, v238
v_and_b32 v221, 0xffff0000, v238
Vc 239,222,223
v_lshlrev_b32_e64 v222, 16, v239
v_and_b32 v223, 0xffff0000, v239
v_pk_mul_f32 v[216:217], v[216:217], v[66:67]
v_pk_mul_f32 v[218:219], v[218:219], v[68:69]
v_pk_mul_f32 v[220:221], v[220:221], v[70:71]
v_pk_mul_f32 v[222:223], v[222:223], v[72:73]
Vc 236,216,217
v_lshlrev_b32_e64 v216, 16, v236
v_and_b32 v217, 0xffff0000, v236
Vc 237,218,219
v_lshlrev_b32_e64 v218, 16, v237
v_and_b32 v219, 0xffff0000, v237
Vc 238,220,221
v_lshlrev_b32_e64 v220, 16, v238
v_and_b32 v221, 0xffff0000, v238
Vc 239,222,223
v_lshlrev_b32_e64 v222, 16, v239
v_and_b32 v223, 0xffff0000, v239
v_pk_add_f32 v[216:217], v[216:217], v[104:105]
v_pk_add_f32 v[218:219], v[218:219], v[106:107]
v_pk_add_f32 v[220:221], v[220:221], v[108:109]
v_pk_add_f32 v[222:223], v[222:223], v[110:111]
Vc 236,216,217
Vc 237,218,219
Vc 238,220,221
Vc 239,222,223
buffer_store_dwordx4 v[236:239], v119, s[68:71], s36 offen sc1
L_k2_end:
s_endpgm
L_spinC:
s_add_u32 m0, s35, 0
s_nop 0
s_nop 0
buffer_load_dwordx4 v125, s[60:63], s48 offen offset:0 lds
buffer_load_dwordx4 v125, s[60:63], s49 offen offset:1024 lds
buffer_load_dwordx4 v125, s[60:63], s50 offen offset:2048 lds
buffer_load_dwordx4 v125, s[60:63], s51 offen offset:3072 lds
v_add_u32 v125, 65536, v125
s_add_u32 m0, s35, 4096
s_nop 0
buffer_load_dwordx4 v125, s[60:63], s48 offen offset:0 lds
buffer_load_dwordx4 v125, s[60:63], s49 offen offset:1024 lds
buffer_load_dwordx4 v125, s[60:63], s50 offen offset:2048 lds
buffer_load_dwordx4 v125, s[60:63], s51 offen offset:3072 lds
s_mov_b32 s40, 1
s_mov_b32 s47, 0x400000
L_spinC_l:
buffer_load_dword v124, v10, s[20:23], s38 offen sc1
s_sub_u32 s47, s47, 1
s_waitcnt vmcnt(0)
s_cmp_eq_u32 s47, 0
s_cbranch_scc1 L_spinC_lx
v_cmp_ne_u32 vcc, 1, v124
s_cbranch_vccz L_spinC_lx
s_sleep 4
s_branch L_spinC_l
L_spinC_lx:
s_branch L_spinCr
L_c31:
s_bfe_u32 s3, s2, 0x40003
s_lshl_b32 s3, s3, 2
s_add_u32 s3, s3, s32
s_lshl_b32 s3, s3, 15
s_and_b32 s7, s2, 1
s_lshl_b32 s7, s7, 10
s_add_u32 s3, s3, s7
s_add_u32 s3, s3, 2097536
v_and_b32 v1, 15, v0
v_lshlrev_b32 v1, 11, v1
v_lshrrev_b32 v11, 5, v0
v_lshl_add_u32 v1, v11, 22, v1
buffer_load_dword v11, v1, s[28:31], s3 offen
s_branch L_c31r
L_f2A:
s_lshr_b32 s5, s54, 1
s_lshl_b32 s5, s5, 5
s_add_u32 s5, s5, 5447680
buffer_load_dword v125, v127, s[20:23], s5 offen sc1
s_branch L_f2Ar
L_f2B:
s_waitcnt vmcnt(16)
v_cmp_ne_u32 vcc, 1, v125
s_cbranch_vccz L_f2lx
s_mov_b32 s47, 0x400000
L_f2l:
buffer_load_dword v125, v127, s[20:23], s5 offen sc1
s_sub_u32 s47, s47, 1
s_waitcnt vmcnt(0)
s_cmp_eq_u32 s47, 0
s_cbranch_scc1 L_f2lx
v_cmp_ne_u32 vcc, 1, v125
s_cbranch_vccz L_f2lx
s_sleep 8
s_branch L_f2l
L_f2lx:
s_lshl_b32 s3, s54, 8
s_add_u32 s3, s3, 6291456
v_mul_u32_u24 v124, 14336, v121
v_and_b32_e64 v125, 15, v0
v_lshl_add_u32 v124, v125, 4, v124
buffer_load_dwordx4 v[74:77], v124, s[20:23], s3 offen sc1
s_add_u32 s3, s3, 57344
buffer_load_dwordx4 v[78:81], v124, s[20:23], s3 offen sc1
s_add_u32 s3, s3, 57344
buffer_load_dwordx4 v[82:85], v124, s[20:23], s3 offen sc1
s_add_u32 s3, s3, 57344
buffer_load_dwordx4 v[86:89], v124, s[20:23], s3 offen sc1
s_add_u32 s3, s3, 57344
buffer_load_dwordx4 v[90:93], v124, s[20:23], s3 offen sc1
s_add_u32 s3, s3, 57344
buffer_load_dwordx4 v[94:97], v124, s[20:23], s3 offen sc1
s_add_u32 s3, s3, 57344
buffer_load_dwordx4 v[98:101], v124, s[20:23], s3 offen sc1
s_add_u32 s3, s3, 57344
buffer_load_dwordx4 v[102:105], v124, s[20:23], s3 offen sc1
s_branch L_f2Br
L_f2C:
v_add_u32 v106, s35, v115
v_add_u32 v107, s35, v116
v_add_u32 v108, s35, v117
v_add_u32 v109, s35, v118
s_waitcnt vmcnt(16) lgkmcnt(0)
v_pk_add_f32 v[74:75], v[74:75], v[78:79]
v_pk_add_f32 v[76:77], v[76:77], v[80:81]
v_pk_add_f32 v[74:75], v[74:75], v[82:83]
v_pk_add_f32 v[76:77], v[76:77], v[84:85]
v_pk_add_f32 v[74:75], v[74:75], v[86:87]
v_pk_add_f32 v[76:77], v[76:77], v[88:89]
v_pk_add_f32 v[74:75], v[74:75], v[90:91]
v_pk_add_f32 v[76:77], v[76:77], v[92:93]
v_pk_add_f32 v[74:75], v[74:75], v[94:95]
v_pk_add_f32 v[76:77], v[76:77], v[96:97]
v_pk_add_f32 v[74:75], v[74:75], v[98:99]
v_pk_add_f32 v[76:77], v[76:77], v[100:101]
v_pk_add_f32 v[74:75], v[74:75], v[102:103]
v_pk_add_f32 v[76:77], v[76:77], v[104:105]
Vc 125,74,75
v_lshlrev_b32_e64 v74, 16, v125
v_and_b32 v75, 0xffff0000, v125
Vc 125,76,77
v_lshlrev_b32_e64 v76, 16, v125
v_and_b32 v77, 0xffff0000, v125
v_mov_b32 v82, v74
v_mov_b32 v83, v75
v_mov_b32 v84, v76
v_mov_b32 v85, v77
v_permlane32_swap_b32 v82, v74
v_permlane32_swap_b32 v83, v75
v_permlane32_swap_b32 v84, v76
v_permlane32_swap_b32 v85, v77
v_mul_f32 v90, 0xbfb8aa3b, v82
v_mul_f32 v91, 0xbfb8aa3b, v83
v_mul_f32 v92, 0xbfb8aa3b, v84
v_mul_f32 v93, 0xbfb8aa3b, v85
Ve 90,90
Ve 91,91
Ve 92,92
Ve 93,93
v_add_f32 v90, 1.0, v90
v_add_f32 v91, 1.0, v91
v_add_f32 v92, 1.0, v92
v_add_f32 v93, 1.0, v93
v_rcp_f32 v90, v90
v_rcp_f32 v91, v91
v_rcp_f32 v92, v92
v_rcp_f32 v93, v93
Vm 82,82,90
Vm 83,83,91
Vm 84,84,92
Vm 85,85,93
Vc 125,82,83
v_lshlrev_b32_e64 v82, 16, v125
v_and_b32 v83, 0xffff0000, v125
Vc 125,84,85
v_lshlrev_b32_e64 v84, 16, v125
v_and_b32 v85, 0xffff0000, v125
Vm 74,74,82
Vm 75,75,83
Vm 76,76,84
Vm 77,77,85
Vc 90,74,75
Vc 91,76,77
v_and_b32 v124, 1, v121
v_lshlrev_b32 v124, 8, v124
v_and_b32_e64 v125, 15, v0
v_lshl_add_u32 v124, v125, 3, v124
v_add_u32_e64 v124, s35, v124
ds_read_b64_tr_b16 v[74:75], v106 offset:0
ds_read_b64_tr_b16 v[76:77], v106 offset:2048
ds_read_b64_tr_b16 v[78:79], v107 offset:0
ds_read_b64_tr_b16 v[80:81], v107 offset:2048
ds_read_b64_tr_b16 v[82:83], v108 offset:0
ds_read_b64_tr_b16 v[84:85], v108 offset:2048
ds_read_b64_tr_b16 v[86:87], v109 offset:0
ds_read_b64_tr_b16 v[88:89], v109 offset:2048
ds_write_b64 v124, v[90:91]
v_and_b32 v124, 1, v0
v_lshlrev_b32 v124, 8, v124
v_lshl_add_u32 v125, v121, 3, v124
v_add_u32_e64 v125, s35, v125
ds_read_b64 v[90:91], v125 offset:0
ds_read_b64 v[92:93], v125 offset:32
ds_read_b64 v[94:95], v125 offset:64
ds_read_b64 v[96:97], v125 offset:96
v_lshl_add_u32 v124, v121, 4, v124
v_add_u32 v124, s35, v124
s_waitcnt lgkmcnt(0)
Zvvv 98,74,90
ds_read_b64_tr_b16 v[74:75], v106 offset:4096
ds_read_b64_tr_b16 v[76:77], v106 offset:6144
Zvvv 102,78,90
ds_read_b64_tr_b16 v[78:79], v107 offset:4096
ds_read_b64_tr_b16 v[80:81], v107 offset:6144
s_waitcnt lgkmcnt(0)
Mvvv 98,74,94
Mvvv 102,78,94
s_nop 6
ds_write_b128 v124, v[98:101] offset:2048
ds_write_b128 v124, v[102:105] offset:2112
s_waitcnt lgkmcnt(0)
Zvvv 98,82,90
ds_read_b64_tr_b16 v[82:83], v108 offset:4096
ds_read_b64_tr_b16 v[84:85], v108 offset:6144
Zvvv 102,86,90
ds_read_b64_tr_b16 v[86:87], v109 offset:4096
ds_read_b64_tr_b16 v[88:89], v109 offset:6144
s_waitcnt lgkmcnt(0)
Mvvv 98,82,94
Mvvv 102,86,94
s_nop 6
ds_write_b128 v124, v[98:101] offset:2176
ds_write_b128 v124, v[102:105] offset:2240
s_waitcnt lgkmcnt(0)
s_barrier
s_cmp_lg_u32 s32, 0
s_cbranch_scc1 L_f2Cr
v_lshlrev_b32 v124, 3, v0
v_add_u32 v125, 133120, v124
ds_read_b64 v[74:75], v125 offset:0
ds_read_b64 v[76:77], v125 offset:8192
ds_read_b64 v[78:79], v125 offset:16384
ds_read_b64 v[80:81], v125 offset:24576
s_lshl_b32 s3, s39, 4
s_add_u32 s3, s3, s37
s_lshl_b32 s3, s3, 9
s_add_u32 s3, s3, 5308416
s_waitcnt lgkmcnt(0)
v_pk_add_f32 v[74:75], v[74:75], v[76:77]
v_pk_add_f32 v[78:79], v[78:79], v[80:81]
v_pk_add_f32 v[74:75], v[74:75], v[78:79]
buffer_store_dwordx2 v[74:75], v124, s[20:23], s3 offen sc1
s_branch L_f2Cr
L_f2E:
s_cmp_lg_u32 s32, 0
s_cbranch_scc1 L_f2Er
v_mov_b32 v125, 1
s_lshl_b32 s3, s39, 5
s_add_u32 s3, s3, s37
s_lshl_b32 s3, s3, 2
s_add_u32 s3, s3, 5449728
s_waitcnt vmcnt(16)
s_mov_b64 exec, 1
buffer_store_dword v125, v126, s[20:23], s3 offen sc1
s_mov_b64 exec, -1
s_branch L_f2Er
L_yA:
v_min_u32 v127, 13, v0
v_lshlrev_b32_e64 v127, 2, v127
buffer_load_dword v74, v127, s[20:23], s41 offen sc1
s_branch L_yAr
L_yB:
s_waitcnt vmcnt(6)
v_cmp_ne_u32 vcc, 1, v74
s_cbranch_vccnz L_yBr
s_mov_b32 s40, 1
v_lshlrev_b32 v124, 2, v0
v_lshlrev_b32 v125, 1, v0
s_lshl_b32 s7, s45, 2
s_add_u32 s7, s7, s32
s_lshr_b32 s3, s42, 5
s_cmp_lg_u32 s3, s7
s_cbranch_scc1 L_f_yl1
s_add_u32 s3, s55, 0
s_nop 0
s_add_u32 s7, s3, 4096
buffer_load_dword v76, v124, s[20:23], s3 offen offset:0 sc1
buffer_load_dword v77, v124, s[20:23], s3 offen offset:512 sc1
buffer_load_dword v78, v124, s[20:23], s3 offen offset:1024 sc1
buffer_load_dword v79, v124, s[20:23], s3 offen offset:1536 sc1
buffer_load_dword v80, v124, s[20:23], s3 offen offset:2048 sc1
buffer_load_dword v81, v124, s[20:23], s3 offen offset:2560 sc1
buffer_load_dword v82, v124, s[20:23], s3 offen offset:3072 sc1
buffer_load_dword v83, v124, s[20:23], s3 offen offset:3584 sc1
buffer_load_dword v84, v124, s[20:23], s7 offen offset:0 sc1
buffer_load_dword v85, v124, s[20:23], s7 offen offset:512 sc1
buffer_load_dword v86, v124, s[20:23], s7 offen offset:1024 sc1
buffer_load_dword v87, v124, s[20:23], s7 offen offset:1536 sc1
buffer_load_dword v88, v124, s[20:23], s7 offen offset:2048 sc1
buffer_load_dword v89, v124, s[20:23], s7 offen offset:2560 sc1
s_lshl_b32 s3, s42, 11
s_lshl_b32 s7, s46, 7
s_add_u32 s3, s3, s7
buffer_load_ushort v90, v125, s[56:59], s3 offen
s_lshl_b32 s3, s42, 3
s_add_u32 s3, s3, 5259264
buffer_load_dwordx2 v[92:93], v126, s[20:23], s3 offen sc1
L_f_yl1:
s_lshl_b32 s7, s45, 2
s_add_u32 s7, s7, s32
s_lshr_b32 s3, s43, 5
s_cmp_lg_u32 s3, s7
s_cbranch_scc1 L_f_yl2
s_nop 0
s_add_u32 s3, s55, 256
s_add_u32 s7, s3, 4096
buffer_load_dword v94, v124, s[20:23], s3 offen offset:0 sc1
buffer_load_dword v95, v124, s[20:23], s3 offen offset:512 sc1
buffer_load_dword v96, v124, s[20:23], s3 offen offset:1024 sc1
buffer_load_dword v97, v124, s[20:23], s3 offen offset:1536 sc1
buffer_load_dword v98, v124, s[20:23], s3 offen offset:2048 sc1
buffer_load_dword v99, v124, s[20:23], s3 offen offset:2560 sc1
buffer_load_dword v100, v124, s[20:23], s3 offen offset:3072 sc1
buffer_load_dword v101, v124, s[20:23], s3 offen offset:3584 sc1
buffer_load_dword v102, v124, s[20:23], s7 offen offset:0 sc1
buffer_load_dword v103, v124, s[20:23], s7 offen offset:512 sc1
buffer_load_dword v104, v124, s[20:23], s7 offen offset:1024 sc1
buffer_load_dword v105, v124, s[20:23], s7 offen offset:1536 sc1
buffer_load_dword v106, v124, s[20:23], s7 offen offset:2048 sc1
buffer_load_dword v107, v124, s[20:23], s7 offen offset:2560 sc1
s_lshl_b32 s3, s43, 11
s_lshl_b32 s7, s46, 7
s_add_u32 s3, s3, s7
buffer_load_ushort v108, v125, s[56:59], s3 offen
s_lshl_b32 s3, s43, 3
s_add_u32 s3, s3, 5259264
buffer_load_dwordx2 v[110:111], v126, s[20:23], s3 offen sc1
L_f_yl2:
s_branch L_yBr
L_yC:
s_waitcnt vmcnt(4)
s_lshl_b32 s7, s45, 2
s_add_u32 s7, s7, s32
s_lshr_b32 s3, s42, 5
s_cmp_lg_u32 s3, s7
s_cbranch_scc1 L_f_ys3
s_nop 0
v_pk_add_f32 v[76:77], v[76:77], v[78:79]
v_pk_add_f32 v[76:77], v[76:77], v[80:81]
v_pk_add_f32 v[76:77], v[76:77], v[82:83]
v_pk_add_f32 v[76:77], v[76:77], v[84:85]
v_pk_add_f32 v[76:77], v[76:77], v[86:87]
v_pk_add_f32 v[76:77], v[76:77], v[88:89]
Va 76,76,77
v_lshlrev_b32 v90, 16, v90
v_sub_f32_e64 v90, v90, v92
Vc 76,76,76
v_lshlrev_b32_e64 v76, 16, v76
Vc 90,90,90
v_lshlrev_b32 v90, 16, v90
v_mul_f32 v76, s100, v76
v_mul_f32_e64 v90, v90, v93
Vc 76,76,76
v_lshlrev_b32_e64 v76, 16, v76
Vc 90,90,90
v_lshlrev_b32 v90, 16, v90
Va 90,90,76
Vc 90,90,90
v_lshlrev_b32_e64 v90, 16, v90
v_mul_f32 v76, 0xbfb8aa3b, v90
Ve 76,76
s_nop 0
v_add_f32 v76, 1.0, v76
v_rcp_f32 v76, v76
s_nop 0
Vm 90,90,76
Vc 90,90,90
v_lshlrev_b32 v90, 16, v90
v_lshlrev_b32 v124, 2, v0
v_add_u32 v124, s35, v124
v_lshlrev_b32 v125, 5, v122
v_add_u32 v125, s35, v125
s_waitcnt lgkmcnt(0)
ds_write_b32 v124, v90
s_and_b32 s3, s42, 7
s_lshl_b32 s3, s3, 3
s_lshl_b64 s[4:5], 0xff, s3
s_bfe_u32 s3, s42, 0x20003
s_mov_b64 exec, s[4:5]
s_cmp_lg_u32 s3, 0
s_cbranch_scc1 L_f_yp4
ds_read_b64 v[42:43], v125
ds_read_b64 v[44:45], v125 offset:8
ds_read_b64 v[46:47], v125 offset:16
ds_read_b64 v[48:49], v125 offset:24
L_f_yp4:
s_cmp_lg_u32 s3, 1
s_cbranch_scc1 L_f_yp5
ds_read_b64 v[50:51], v125
ds_read_b64 v[52:53], v125 offset:8
ds_read_b64 v[54:55], v125 offset:16
ds_read_b64 v[56:57], v125 offset:24
L_f_yp5:
s_cmp_lg_u32 s3, 2
s_cbranch_scc1 L_f_yp6
ds_read_b64 v[58:59], v125
ds_read_b64 v[60:61], v125 offset:8
ds_read_b64 v[62:63], v125 offset:16
ds_read_b64 v[64:65], v125 offset:24
L_f_yp6:
s_cmp_lg_u32 s3, 3
s_cbranch_scc1 L_f_yp7
ds_read_b64 v[66:67], v125
ds_read_b64 v[68:69], v125 offset:8
s_waitcnt lgkmcnt(9)
ds_read_b64 v[70:71], v125 offset:16
ds_read_b64 v[72:73], v125 offset:24
L_f_yp7:
s_mov_b64 exec, -1
s_waitcnt lgkmcnt(0)
L_f_ys3:
s_lshl_b32 s7, s45, 2
s_add_u32 s7, s7, s32
s_lshr_b32 s3, s43, 5
s_cmp_lg_u32 s3, s7
s_cbranch_scc1 L_f_ys8
s_nop 0
v_pk_add_f32 v[94:95], v[94:95], v[96:97]
v_pk_add_f32 v[94:95], v[94:95], v[98:99]
v_pk_add_f32 v[94:95], v[94:95], v[100:101]
v_pk_add_f32 v[94:95], v[94:95], v[102:103]
v_pk_add_f32 v[94:95], v[94:95], v[104:105]
v_pk_add_f32 v[94:95], v[94:95], v[106:107]
Va 94,94,95
v_lshlrev_b32 v108, 16, v108
v_sub_f32_e64 v108, v108, v110
Vc 94,94,94
v_lshlrev_b32_e64 v94, 16, v94
Vc 108,108,108
v_lshlrev_b32 v108, 16, v108
v_mul_f32 v94, s101, v94
v_mul_f32_e64 v108, v108, v111
Vc 94,94,94
v_lshlrev_b32_e64 v94, 16, v94
Vc 108,108,108
v_lshlrev_b32 v108, 16, v108
Va 108,108,94
Vc 108,108,108
v_lshlrev_b32_e64 v108, 16, v108
v_mul_f32 v94, 0xbfb8aa3b, v108
Ve 94,94
s_nop 0
v_add_f32 v94, 1.0, v94
v_rcp_f32 v94, v94
s_nop 0
Vm 108,108,94
Vc 108,108,108
v_lshlrev_b32 v108, 16, v108
v_lshlrev_b32 v124, 2, v0
v_add_u32 v124, s35, v124
v_lshlrev_b32 v125, 5, v122
v_add_u32 v125, s35, v125
s_waitcnt lgkmcnt(0)
ds_write_b32 v124, v108
s_and_b32 s3, s43, 7
s_lshl_b32 s3, s3, 3
s_lshl_b64 s[4:5], 0xff, s3
s_bfe_u32 s3, s43, 0x20003
s_mov_b64 exec, s[4:5]
s_cmp_lg_u32 s3, 0
s_cbranch_scc1 L_f_yp9
ds_read_b64 v[42:43], v125
ds_read_b64 v[44:45], v125 offset:8
ds_read_b64 v[46:47], v125 offset:16
ds_read_b64 v[48:49], v125 offset:24
L_f_yp9:
s_cmp_lg_u32 s3, 1
s_cbranch_scc1 L_f_yp10
ds_read_b64 v[50:51], v125
ds_read_b64 v[52:53], v125 offset:8
ds_read_b64 v[54:55], v125 offset:16
ds_read_b64 v[56:57], v125 offset:24
L_f_yp10:
s_cmp_lg_u32 s3, 2
s_cbranch_scc1 L_f_yp11
ds_read_b64 v[58:59], v125
ds_read_b64 v[60:61], v125 offset:8
ds_read_b64 v[62:63], v125 offset:16
ds_read_b64 v[64:65], v125 offset:24
L_f_yp11:
s_cmp_lg_u32 s3, 3
s_cbranch_scc1 L_f_yp12
ds_read_b64 v[66:67], v125
ds_read_b64 v[68:69], v125 offset:8
s_waitcnt lgkmcnt(9)
ds_read_b64 v[70:71], v125 offset:16
ds_read_b64 v[72:73], v125 offset:24
L_f_yp12:
s_mov_b64 exec, -1
s_waitcnt lgkmcnt(0)
L_f_ys8:
s_branch L_yCr
L_p4_end:
L_spinAk:
s_mov_b32 s47, 0x400000
L_spinAk_l:
s_sleep 8
buffer_load_dword v30, v31, s[28:31], 0 offen sc1
s_waitcnt vmcnt(0)
v_readfirstlane_b32 s3, v30
s_sub_u32 s47, s47, 1
s_cmp_eq_u32 s47, 0
s_cbranch_scc1 L_spinArk
s_cmp_lt_u32 s3, 256
s_cbranch_scc1 L_spinAk_l
s_branch L_spinArk
L_spinAv:
s_mov_b32 s47, 0x400000
L_spinAv_l:
s_sleep 8
buffer_load_dword v30, v31, s[28:31], 0 offen sc1
s_waitcnt vmcnt(0)
v_readfirstlane_b32 s3, v30
s_sub_u32 s47, s47, 1
s_cmp_eq_u32 s47, 0
s_cbranch_scc1 L_spinArv
s_cmp_lt_u32 s3, 256
s_cbranch_scc1 L_spinAv_l
s_branch L_spinArv
L_spinB:
s_mov_b32 s59, 0x400000
L_spinB_l:
s_sleep 4
buffer_load_dword v12, v1, s[20:23], s6 offen sc1
s_sub_u32 s59, s59, 1
s_cmp_eq_u32 s59, 0
s_cbranch_scc1 L_spinBx
s_waitcnt vmcnt(0)
v_cmp_ne_u32 vcc, 1, v12
s_cbranch_vccnz L_spinB_l
L_spinBx:
s_waitcnt vmcnt(0)
s_branch L_spinBr
L_k2_fb_we:
s_nop 7
s_nop 0
v_max3_f32 v21, v128, v129, v130
v_max3_f32 v21, v21, v131, v132
v_max3_f32 v21, v21, v133, v134
v_max3_f32 v21, v21, v135, v136
v_max3_f32 v21, v21, v137, v138
v_max3_f32 v21, v21, v139, v140
v_max3_f32 v21, v21, v141, v142
v_max_f32 v21, v21, v143
v_mov_b32 v1, v21
s_nop 1
v_permlane16_swap_b32 v1, v21
v_max_f32 v21, v21, v1
v_mov_b32 v1, v21
s_nop 1
v_permlane32_swap_b32 v1, v21
v_max_f32_e64 v21, v21, v1
v_add_f32 v21, 0x41f80000, v21
v_max_f32 v21, 0, v21
Vs 128,128,21
Vs 129,129,21
Vs 130,130,21
Vs 131,131,21
Vs 132,132,21
Vs 133,133,21
Vs 134,134,21
Vs 135,135,21
Vs 136,136,21
Vs 137,137,21
Vs 138,138,21
Vs 139,139,21
Vs 140,140,21
Vs 141,141,21
Vs 142,142,21
Vs 143,143,21
Vs 192,192,21
Vs 193,193,21
Vs 194,194,21
Vs 195,195,21
Vs 196,196,21
Vs 197,197,21
Vs 198,198,21
Vs 199,199,21
Vs 200,200,21
Vs 201,201,21
Vs 202,202,21
Vs 203,203,21
Vs 204,204,21
Vs 205,205,21
Vs 206,206,21
Vs 207,207,21
Vs 32,32,21
Vs 33,33,21
Vs 34,34,21
v_sub_f32_e64 v35, v35, v21
v_exp_f32 v22, -v21
s_nop 0
Vm 48,48,22
Vm 49,49,22
Vm 50,50,22
v_mul_f32_e64 v51, v51, v22
Ar 8,0
Ar 9,1
Ar 10,2
Ar 11,3
Ar 12,4
Ar 13,5
Ar 14,6
Ar 15,7
Vm 8,8,22
Vm 9,9,22
Vm 10,10,22
Vm 11,11,22
Vm 12,12,22
Vm 13,13,22
Vm 14,14,22
Vm 15,15,22
Aw 0,8
Aw 1,9
Aw 2,10
Aw 3,11
Aw 4,12
Aw 5,13
Aw 6,14
Aw 7,15
Ar 8,8
Ar 9,9
Ar 10,10
Ar 11,11
Ar 12,12
Ar 13,13
Ar 14,14
Ar 15,15
Vm 8,8,22
Vm 9,9,22
Vm 10,10,22
Vm 11,11,22
Vm 12,12,22
Vm 13,13,22
Vm 14,14,22
Vm 15,15,22
Aw 8,8
Aw 9,9
Aw 10,10
Aw 11,11
Aw 12,12
Aw 13,13
Aw 14,14
Aw 15,15
Ar 8,16
Ar 9,17
Ar 10,18
Ar 11,19
Ar 12,20
Ar 13,21
Ar 14,22
Ar 15,23
Vm 8,8,22
Vm 9,9,22
Vm 10,10,22
Vm 11,11,22
Vm 12,12,22
Vm 13,13,22
Vm 14,14,22
Vm 15,15,22
Aw 16,8
Aw 17,9
Aw 18,10
Aw 19,11
Aw 20,12
Aw 21,13
Aw 22,14
Aw 23,15
Ar 8,24
Ar 9,25
Ar 10,26
Ar 11,27
Ar 12,28
Ar 13,29
Ar 14,30
Ar 15,31
Vm 8,8,22
Vm 9,9,22
Vm 10,10,22
Vm 11,11,22
Vm 12,12,22
Vm 13,13,22
Vm 14,14,22
Vm 15,15,22
Aw 24,8
Aw 25,9
Aw 26,10
Aw 27,11
Aw 28,12
Aw 29,13
Aw 30,14
Aw 31,15
v_max3_f32 v21, v144, v145, v146
v_max3_f32 v21, v21, v147, v148
v_max3_f32 v21, v21, v149, v150
v_max3_f32 v21, v21, v151, v152
v_max3_f32 v21, v21, v153, v154
v_max3_f32 v21, v21, v155, v156
v_max3_f32 v21, v21, v157, v158
v_max_f32 v21, v21, v159
v_mov_b32 v1, v21
s_nop 1
v_permlane16_swap_b32 v1, v21
v_max_f32 v21, v21, v1
v_mov_b32 v1, v21
s_nop 1
v_permlane32_swap_b32 v1, v21
v_max_f32_e64 v21, v21, v1
v_add_f32 v21, 0x41f80000, v21
v_max_f32 v21, 0, v21
Vs 144,144,21
Vs 145,145,21
Vs 146,146,21
Vs 147,147,21
Vs 148,148,21
Vs 149,149,21
Vs 150,150,21
Vs 151,151,21
Vs 152,152,21
Vs 153,153,21
Vs 154,154,21
Vs 155,155,21
Vs 156,156,21
Vs 157,157,21
Vs 158,158,21
Vs 159,159,21
Vs 208,208,21
Vs 209,209,21
Vs 210,210,21
Vs 211,211,21
Vs 212,212,21
Vs 213,213,21
Vs 214,214,21
Vs 215,215,21
Vs 216,216,21
Vs 217,217,21
Vs 218,218,21
Vs 219,219,21
Vs 220,220,21
Vs 221,221,21
Vs 222,222,21
Vs 223,223,21
Vs 36,36,21
Vs 37,37,21
Vs 38,38,21
v_sub_f32_e64 v39, v39, v21
v_exp_f32 v22, -v21
s_nop 0
Vm 52,52,22
Vm 53,53,22
Vm 54,54,22
v_mul_f32_e64 v55, v55, v22
Ar 8,32
Ar 9,33
Ar 10,34
Ar 11,35
Ar 12,36
Ar 13,37
Ar 14,38
Ar 15,39
Vm 8,8,22
Vm 9,9,22
Vm 10,10,22
Vm 11,11,22
Vm 12,12,22
Vm 13,13,22
Vm 14,14,22
Vm 15,15,22
Aw 32,8
Aw 33,9
Aw 34,10
Aw 35,11
Aw 36,12
Aw 37,13
Aw 38,14
Aw 39,15
Ar 8,40
Ar 9,41
Ar 10,42
Ar 11,43
Ar 12,44
Ar 13,45
Ar 14,46
Ar 15,47
Vm 8,8,22
Vm 9,9,22
Vm 10,10,22
Vm 11,11,22
Vm 12,12,22
Vm 13,13,22
Vm 14,14,22
Vm 15,15,22
Aw 40,8
Aw 41,9
Aw 42,10
Aw 43,11
Aw 44,12
Aw 45,13
Aw 46,14
Aw 47,15
Ar 8,48
Ar 9,49
Ar 10,50
Ar 11,51
Ar 12,52
Ar 13,53
Ar 14,54
Ar 15,55
Vm 8,8,22
Vm 9,9,22
Vm 10,10,22
Vm 11,11,22
Vm 12,12,22
Vm 13,13,22
Vm 14,14,22
Vm 15,15,22
Aw 48,8
Aw 49,9
Aw 50,10
Aw 51,11
Aw 52,12
Aw 53,13
Aw 54,14
Aw 55,15
Ar 8,56
Ar 9,57
Ar 10,58
Ar 11,59
Ar 12,60
Ar 13,61
Ar 14,62
Ar 15,63
Vm 8,8,22
Vm 9,9,22
Vm 10,10,22
Vm 11,11,22
Vm 12,12,22
Vm 13,13,22
Vm 14,14,22
Vm 15,15,22
Aw 56,8
Aw 57,9
Aw 58,10
Aw 59,11
Aw 60,12
Aw 61,13
Aw 62,14
Aw 63,15
v_max3_f32 v21, v160, v161, v162
v_max3_f32 v21, v21, v163, v164
v_max3_f32 v21, v21, v165, v166
v_max3_f32 v21, v21, v167, v168
v_max3_f32 v21, v21, v169, v170
v_max3_f32 v21, v21, v171, v172
v_max3_f32 v21, v21, v173, v174
v_max_f32 v21, v21, v175
v_mov_b32 v1, v21
s_nop 1
v_permlane16_swap_b32 v1, v21
v_max_f32 v21, v21, v1
v_mov_b32 v1, v21
s_nop 1
v_permlane32_swap_b32 v1, v21
v_max_f32_e64 v21, v21, v1
v_add_f32 v21, 0x41f80000, v21
v_max_f32 v21, 0, v21
Vs 160,160,21
Vs 161,161,21
Vs 162,162,21
Vs 163,163,21
Vs 164,164,21
Vs 165,165,21
Vs 166,166,21
Vs 167,167,21
Vs 168,168,21
Vs 169,169,21
Vs 170,170,21
Vs 171,171,21
Vs 172,172,21
Vs 173,173,21
Vs 174,174,21
Vs 175,175,21
Vs 224,224,21
Vs 225,225,21
Vs 226,226,21
Vs 227,227,21
Vs 228,228,21
Vs 229,229,21
Vs 230,230,21
Vs 231,231,21
Vs 232,232,21
Vs 233,233,21
Vs 234,234,21
Vs 235,235,21
Vs 236,236,21
Vs 237,237,21
Vs 238,238,21
Vs 239,239,21
Vs 40,40,21
Vs 41,41,21
Vs 42,42,21
v_sub_f32_e64 v43, v43, v21
v_exp_f32 v22, -v21
s_nop 0
Vm 56,56,22
Vm 57,57,22
Vm 58,58,22
v_mul_f32_e64 v59, v59, v22
Ar 8,64
Ar 9,65
Ar 10,66
Ar 11,67
Ar 12,68
Ar 13,69
Ar 14,70
Ar 15,71
Vm 8,8,22
Vm 9,9,22
Vm 10,10,22
Vm 11,11,22
Vm 12,12,22
Vm 13,13,22
Vm 14,14,22
Vm 15,15,22
Aw 64,8
Aw 65,9
Aw 66,10
Aw 67,11
Aw 68,12
Aw 69,13
Aw 70,14
Aw 71,15
Ar 8,72
Ar 9,73
Ar 10,74
Ar 11,75
Ar 12,76
Ar 13,77
Ar 14,78
Ar 15,79
Vm 8,8,22
Vm 9,9,22
Vm 10,10,22
Vm 11,11,22
Vm 12,12,22
Vm 13,13,22
Vm 14,14,22
Vm 15,15,22
Aw 72,8
Aw 73,9
Aw 74,10
Aw 75,11
Aw 76,12
Aw 77,13
Aw 78,14
Aw 79,15
Ar 8,80
Ar 9,81
Ar 10,82
Ar 11,83
Ar 12,84
Ar 13,85
Ar 14,86
Ar 15,87
Vm 8,8,22
Vm 9,9,22
Vm 10,10,22
Vm 11,11,22
Vm 12,12,22
Vm 13,13,22
Vm 14,14,22
Vm 15,15,22
Aw 80,8
Aw 81,9
Aw 82,10
Aw 83,11
Aw 84,12
Aw 85,13
Aw 86,14
Aw 87,15
Ar 8,88
Ar 9,89
Ar 10,90
Ar 11,91
Ar 12,92
Ar 13,93
Ar 14,94
Ar 15,95
Vm 8,8,22
Vm 9,9,22
Vm 10,10,22
Vm 11,11,22
Vm 12,12,22
Vm 13,13,22
Vm 14,14,22
Vm 15,15,22
Aw 88,8
Aw 89,9
Aw 90,10
Aw 91,11
Aw 92,12
Aw 93,13
Aw 94,14
Aw 95,15
v_max3_f32 v21, v176, v177, v178
v_max3_f32 v21, v21, v179, v180
v_max3_f32 v21, v21, v181, v182
v_max3_f32 v21, v21, v183, v184
v_max3_f32 v21, v21, v185, v186
v_max3_f32 v21, v21, v187, v188
v_max3_f32 v21, v21, v189, v190
v_max_f32 v21, v21, v191
v_mov_b32 v1, v21
s_nop 1
v_permlane16_swap_b32 v1, v21
v_max_f32 v21, v21, v1
v_mov_b32 v1, v21
s_nop 1
v_permlane32_swap_b32 v1, v21
v_max_f32_e64 v21, v21, v1
v_add_f32 v21, 0x41f80000, v21
v_max_f32 v21, 0, v21
Vs 176,176,21
Vs 177,177,21
Vs 178,178,21
Vs 179,179,21
Vs 180,180,21
Vs 181,181,21
Vs 182,182,21
Vs 183,183,21
Vs 184,184,21
Vs 185,185,21
Vs 186,186,21
Vs 187,187,21
Vs 188,188,21
Vs 189,189,21
Vs 190,190,21
Vs 191,191,21
Vs 240,240,21
Vs 241,241,21
Vs 242,242,21
Vs 243,243,21
Vs 244,244,21
Vs 245,245,21
Vs 246,246,21
Vs 247,247,21
Vs 248,248,21
Vs 249,249,21
Vs 250,250,21
Vs 251,251,21
Vs 252,252,21
Vs 253,253,21
Vs 254,254,21
Vs 255,255,21
Vs 44,44,21
Vs 45,45,21
Vs 46,46,21
v_sub_f32_e64 v47, v47, v21
v_exp_f32 v22, -v21
s_nop 0
Vm 60,60,22
Vm 61,61,22
Vm 62,62,22
v_mul_f32_e64 v63, v63, v22
Ar 8,96
Ar 9,97
Ar 10,98
Ar 11,99
Ar 12,100
Ar 13,101
Ar 14,102
Ar 15,103
Vm 8,8,22
Vm 9,9,22
Vm 10,10,22
Vm 11,11,22
Vm 12,12,22
Vm 13,13,22
Vm 14,14,22
Vm 15,15,22
Aw 96,8
Aw 97,9
Aw 98,10
Aw 99,11
Aw 100,12
Aw 101,13
Aw 102,14
Aw 103,15
Ar 8,104
Ar 9,105
Ar 10,106
Ar 11,107
Ar 12,108
Ar 13,109
Ar 14,110
Ar 15,111
Vm 8,8,22
Vm 9,9,22
Vm 10,10,22
Vm 11,11,22
Vm 12,12,22
Vm 13,13,22
Vm 14,14,22
Vm 15,15,22
Aw 104,8
Aw 105,9
Aw 106,10
Aw 107,11
Aw 108,12
Aw 109,13
Aw 110,14
Aw 111,15
Ar 8,112
Ar 9,113
Ar 10,114
Ar 11,115
Ar 12,116
Ar 13,117
Ar 14,118
Ar 15,119
Vm 8,8,22
Vm 9,9,22
Vm 10,10,22
Vm 11,11,22
Vm 12,12,22
Vm 13,13,22
Vm 14,14,22
Vm 15,15,22
Aw 112,8
Aw 113,9
Aw 114,10
Aw 115,11
Aw 116,12
Aw 117,13
Aw 118,14
Aw 119,15
Ar 8,120
Ar 9,121
Ar 10,122
Ar 11,123
Ar 12,124
Ar 13,125
Ar 14,126
Ar 15,127
Vm 8,8,22
Vm 9,9,22
Vm 10,10,22
Vm 11,11,22
Vm 12,12,22
Vm 13,13,22
Vm 14,14,22
Vm 15,15,22
Aw 120,8
Aw 121,9
Aw 122,10
Aw 123,11
Aw 124,12
Aw 125,13
Aw 126,14
Aw 127,15
Ve 8,128
Ve 9,129
s_nop 0
Vc 64,8,9
Ve 8,130
Ve 9,131
s_nop 0
Vc 65,8,9
Ve 8,144
Ve 9,145
s_nop 0
Vc 72,8,9
Ve 8,146
Ve 9,147
s_nop 0
Vc 73,8,9
Ve 8,160
Ve 9,161
s_nop 0
Vc 80,8,9
Ve 8,162
Ve 9,163
s_nop 0
Vc 81,8,9
Ve 8,176
Ve 9,177
s_nop 0
Vc 88,8,9
Ve 8,178
Ve 9,179
s_nop 0
Vc 89,8,9
Ve 8,132
Ve 9,133
s_nop 0
Vc 66,8,9
Ve 8,134
Ve 9,135
s_nop 0
Vc 67,8,9
Ve 8,148
Ve 9,149
s_nop 0
Vc 74,8,9
Ve 8,150
Ve 9,151
s_nop 0
Vc 75,8,9
Ve 8,164
Ve 9,165
s_nop 0
Vc 82,8,9
Ve 8,166
Ve 9,167
s_nop 0
Vc 83,8,9
Ve 8,180
Ve 9,181
s_nop 0
Vc 90,8,9
Ve 8,182
Ve 9,183
s_nop 0
Vc 91,8,9
Ve 8,136
Ve 9,137
s_nop 0
Vc 68,8,9
Ve 8,138
Ve 9,139
s_nop 0
Vc 69,8,9
Ve 8,152
Ve 9,153
s_nop 0
Vc 76,8,9
Ve 8,154
Ve 9,155
s_nop 0
Vc 77,8,9
Ve 8,168
Ve 9,169
s_nop 0
Vc 84,8,9
Ve 8,170
Ve 9,171
s_nop 0
Vc 85,8,9
Ve 8,184
Ve 9,185
s_nop 0
Vc 92,8,9
Ve 8,186
Ve 9,187
s_nop 0
Vc 93,8,9
Ve 8,140
Ve 9,141
s_nop 0
Vc 70,8,9
Ve 8,142
Ve 9,143
s_nop 0
Vc 71,8,9
Ve 8,156
Ve 9,157
s_nop 0
Vc 78,8,9
Ve 8,158
Ve 9,159
s_nop 0
Vc 79,8,9
Ve 8,172
Ve 9,173
s_nop 0
Vc 86,8,9
Ve 8,174
Ve 9,175
s_nop 0
Vc 87,8,9
Ve 8,188
Ve 9,189
s_nop 0
Vc 94,8,9
Ve 8,190
Ve 9,191
s_nop 0
Vc 95,8,9
s_nop 1
s_branch L_k2_fbr_we
L_k2_fb_wo:
s_nop 7
s_nop 0
v_max3_f32 v21, v192, v193, v194
v_max3_f32 v21, v21, v195, v196
v_max3_f32 v21, v21, v197, v198
v_max3_f32 v21, v21, v199, v200
v_max3_f32 v21, v21, v201, v202
v_max3_f32 v21, v21, v203, v204
v_max3_f32 v21, v21, v205, v206
v_max_f32 v21, v21, v207
v_mov_b32 v1, v21
s_nop 1
v_permlane16_swap_b32 v1, v21
v_max_f32 v21, v21, v1
v_mov_b32 v1, v21
s_nop 1
v_permlane32_swap_b32 v1, v21
v_max_f32_e64 v21, v21, v1
v_add_f32 v21, 0x41f80000, v21
v_max_f32 v21, 0, v21
Vs 192,192,21
Vs 193,193,21
Vs 194,194,21
Vs 195,195,21
Vs 196,196,21
Vs 197,197,21
Vs 198,198,21
Vs 199,199,21
Vs 200,200,21
Vs 201,201,21
Vs 202,202,21
Vs 203,203,21
Vs 204,204,21
Vs 205,205,21
Vs 206,206,21
Vs 207,207,21
Vs 128,128,21
Vs 129,129,21
Vs 130,130,21
Vs 131,131,21
Vs 132,132,21
Vs 133,133,21
Vs 134,134,21
Vs 135,135,21
Vs 136,136,21
Vs 137,137,21
Vs 138,138,21
Vs 139,139,21
Vs 140,140,21
Vs 141,141,21
Vs 142,142,21
Vs 143,143,21
Vs 32,32,21
Vs 33,33,21
Vs 34,34,21
v_sub_f32_e64 v35, v35, v21
v_exp_f32 v22, -v21
s_nop 0
Vm 48,48,22
Vm 49,49,22
Vm 50,50,22
v_mul_f32_e64 v51, v51, v22
Ar 8,0
Ar 9,1
Ar 10,2
Ar 11,3
Ar 12,4
Ar 13,5
Ar 14,6
Ar 15,7
Vm 8,8,22
Vm 9,9,22
Vm 10,10,22
Vm 11,11,22
Vm 12,12,22
Vm 13,13,22
Vm 14,14,22
Vm 15,15,22
Aw 0,8
Aw 1,9
Aw 2,10
Aw 3,11
Aw 4,12
Aw 5,13
Aw 6,14
Aw 7,15
Ar 8,8
Ar 9,9
Ar 10,10
Ar 11,11
Ar 12,12
Ar 13,13
Ar 14,14
Ar 15,15
Vm 8,8,22
Vm 9,9,22
Vm 10,10,22
Vm 11,11,22
Vm 12,12,22
Vm 13,13,22
Vm 14,14,22
Vm 15,15,22
Aw 8,8
Aw 9,9
Aw 10,10
Aw 11,11
Aw 12,12
Aw 13,13
Aw 14,14
Aw 15,15
Ar 8,16
Ar 9,17
Ar 10,18
Ar 11,19
Ar 12,20
Ar 13,21
Ar 14,22
Ar 15,23
Vm 8,8,22
Vm 9,9,22
Vm 10,10,22
Vm 11,11,22
Vm 12,12,22
Vm 13,13,22
Vm 14,14,22
Vm 15,15,22
Aw 16,8
Aw 17,9
Aw 18,10
Aw 19,11
Aw 20,12
Aw 21,13
Aw 22,14
Aw 23,15
Ar 8,24
Ar 9,25
Ar 10,26
Ar 11,27
Ar 12,28
Ar 13,29
Ar 14,30
Ar 15,31
Vm 8,8,22
Vm 9,9,22
Vm 10,10,22
Vm 11,11,22
Vm 12,12,22
Vm 13,13,22
Vm 14,14,22
Vm 15,15,22
Aw 24,8
Aw 25,9
Aw 26,10
Aw 27,11
Aw 28,12
Aw 29,13
Aw 30,14
Aw 31,15
v_max3_f32 v21, v208, v209, v210
v_max3_f32 v21, v21, v211, v212
v_max3_f32 v21, v21, v213, v214
v_max3_f32 v21, v21, v215, v216
v_max3_f32 v21, v21, v217, v218
v_max3_f32 v21, v21, v219, v220
v_max3_f32 v21, v21, v221, v222
v_max_f32 v21, v21, v223
v_mov_b32 v1, v21
s_nop 1
v_permlane16_swap_b32 v1, v21
v_max_f32 v21, v21, v1
v_mov_b32 v1, v21
s_nop 1
v_permlane32_swap_b32 v1, v21
v_max_f32_e64 v21, v21, v1
v_add_f32 v21, 0x41f80000, v21
v_max_f32 v21, 0, v21
Vs 208,208,21
Vs 209,209,21
Vs 210,210,21
Vs 211,211,21
Vs 212,212,21
Vs 213,213,21
Vs 214,214,21
Vs 215,215,21
Vs 216,216,21
Vs 217,217,21
Vs 218,218,21
Vs 219,219,21
Vs 220,220,21
Vs 221,221,21
Vs 222,222,21
Vs 223,223,21
Vs 144,144,21
Vs 145,145,21
Vs 146,146,21
Vs 147,147,21
Vs 148,148,21
Vs 149,149,21
Vs 150,150,21
Vs 151,151,21
Vs 152,152,21
Vs 153,153,21
Vs 154,154,21
Vs 155,155,21
Vs 156,156,21
Vs 157,157,21
Vs 158,158,21
Vs 159,159,21
Vs 36,36,21
Vs 37,37,21
Vs 38,38,21
v_sub_f32_e64 v39, v39, v21
v_exp_f32 v22, -v21
s_nop 0
Vm 52,52,22
Vm 53,53,22
Vm 54,54,22
v_mul_f32_e64 v55, v55, v22
Ar 8,32
Ar 9,33
Ar 10,34
Ar 11,35
Ar 12,36
Ar 13,37
Ar 14,38
Ar 15,39
Vm 8,8,22
Vm 9,9,22
Vm 10,10,22
Vm 11,11,22
Vm 12,12,22
Vm 13,13,22
Vm 14,14,22
Vm 15,15,22
Aw 32,8
Aw 33,9
Aw 34,10
Aw 35,11
Aw 36,12
Aw 37,13
Aw 38,14
Aw 39,15
Ar 8,40
Ar 9,41
Ar 10,42
Ar 11,43
Ar 12,44
Ar 13,45
Ar 14,46
Ar 15,47
Vm 8,8,22
Vm 9,9,22
Vm 10,10,22
Vm 11,11,22
Vm 12,12,22
Vm 13,13,22
Vm 14,14,22
Vm 15,15,22
Aw 40,8
Aw 41,9
Aw 42,10
Aw 43,11
Aw 44,12
Aw 45,13
Aw 46,14
Aw 47,15
Ar 8,48
Ar 9,49
Ar 10,50
Ar 11,51
Ar 12,52
Ar 13,53
Ar 14,54
Ar 15,55
Vm 8,8,22
Vm 9,9,22
Vm 10,10,22
Vm 11,11,22
Vm 12,12,22
Vm 13,13,22
Vm 14,14,22
Vm 15,15,22
Aw 48,8
Aw 49,9
Aw 50,10
Aw 51,11
Aw 52,12
Aw 53,13
Aw 54,14
Aw 55,15
Ar 8,56
Ar 9,57
Ar 10,58
Ar 11,59
Ar 12,60
Ar 13,61
Ar 14,62
Ar 15,63
Vm 8,8,22
Vm 9,9,22
Vm 10,10,22
Vm 11,11,22
Vm 12,12,22
Vm 13,13,22
Vm 14,14,22
Vm 15,15,22
Aw 56,8
Aw 57,9
Aw 58,10
Aw 59,11
Aw 60,12
Aw 61,13
Aw 62,14
Aw 63,15
v_max3_f32 v21, v224, v225, v226
v_max3_f32 v21, v21, v227, v228
v_max3_f32 v21, v21, v229, v230
v_max3_f32 v21, v21, v231, v232
v_max3_f32 v21, v21, v233, v234
v_max3_f32 v21, v21, v235, v236
v_max3_f32 v21, v21, v237, v238
v_max_f32 v21, v21, v239
v_mov_b32 v1, v21
s_nop 1
v_permlane16_swap_b32 v1, v21
v_max_f32 v21, v21, v1
v_mov_b32 v1, v21
s_nop 1
v_permlane32_swap_b32 v1, v21
v_max_f32_e64 v21, v21, v1
v_add_f32 v21, 0x41f80000, v21
v_max_f32 v21, 0, v21
Vs 224,224,21
Vs 225,225,21
Vs 226,226,21
Vs 227,227,21
Vs 228,228,21
Vs 229,229,21
Vs 230,230,21
Vs 231,231,21
Vs 232,232,21
Vs 233,233,21
Vs 234,234,21
Vs 235,235,21
Vs 236,236,21
Vs 237,237,21
Vs 238,238,21
Vs 239,239,21
Vs 160,160,21
Vs 161,161,21
Vs 162,162,21
Vs 163,163,21
Vs 164,164,21
Vs 165,165,21
Vs 166,166,21
Vs 167,167,21
Vs 168,168,21
Vs 169,169,21
Vs 170,170,21
Vs 171,171,21
Vs 172,172,21
Vs 173,173,21
Vs 174,174,21
Vs 175,175,21
Vs 40,40,21
Vs 41,41,21
Vs 42,42,21
v_sub_f32_e64 v43, v43, v21
v_exp_f32 v22, -v21
s_nop 0
Vm 56,56,22
Vm 57,57,22
Vm 58,58,22
v_mul_f32_e64 v59, v59, v22
Ar 8,64
Ar 9,65
Ar 10,66
Ar 11,67
Ar 12,68
Ar 13,69
Ar 14,70
Ar 15,71
Vm 8,8,22
Vm 9,9,22
Vm 10,10,22
Vm 11,11,22
Vm 12,12,22
Vm 13,13,22
Vm 14,14,22
Vm 15,15,22
Aw 64,8
Aw 65,9
Aw 66,10
Aw 67,11
Aw 68,12
Aw 69,13
Aw 70,14
Aw 71,15
Ar 8,72
Ar 9,73
Ar 10,74
Ar 11,75
Ar 12,76
Ar 13,77
Ar 14,78
Ar 15,79
Vm 8,8,22
Vm 9,9,22
Vm 10,10,22
Vm 11,11,22
Vm 12,12,22
Vm 13,13,22
Vm 14,14,22
Vm 15,15,22
Aw 72,8
Aw 73,9
Aw 74,10
Aw 75,11
Aw 76,12
Aw 77,13
Aw 78,14
Aw 79,15
Ar 8,80
Ar 9,81
Ar 10,82
Ar 11,83
Ar 12,84
Ar 13,85
Ar 14,86
Ar 15,87
Vm 8,8,22
Vm 9,9,22
Vm 10,10,22
Vm 11,11,22
Vm 12,12,22
Vm 13,13,22
Vm 14,14,22
Vm 15,15,22
Aw 80,8
Aw 81,9
Aw 82,10
Aw 83,11
Aw 84,12
Aw 85,13
Aw 86,14
Aw 87,15
Ar 8,88
Ar 9,89
Ar 10,90
Ar 11,91
Ar 12,92
Ar 13,93
Ar 14,94
Ar 15,95
Vm 8,8,22
Vm 9,9,22
Vm 10,10,22
Vm 11,11,22
Vm 12,12,22
Vm 13,13,22
Vm 14,14,22
Vm 15,15,22
Aw 88,8
Aw 89,9
Aw 90,10
Aw 91,11
Aw 92,12
Aw 93,13
Aw 94,14
Aw 95,15
v_max3_f32 v21, v240, v241, v242
v_max3_f32 v21, v21, v243, v244
v_max3_f32 v21, v21, v245, v246
v_max3_f32 v21, v21, v247, v248
v_max3_f32 v21, v21, v249, v250
v_max3_f32 v21, v21, v251, v252
v_max3_f32 v21, v21, v253, v254
v_max_f32 v21, v21, v255
v_mov_b32 v1, v21
s_nop 1
v_permlane16_swap_b32 v1, v21
v_max_f32 v21, v21, v1
v_mov_b32 v1, v21
s_nop 1
v_permlane32_swap_b32 v1, v21
v_max_f32_e64 v21, v21, v1
v_add_f32 v21, 0x41f80000, v21
v_max_f32 v21, 0, v21
Vs 240,240,21
Vs 241,241,21
Vs 242,242,21
Vs 243,243,21
Vs 244,244,21
Vs 245,245,21
Vs 246,246,21
Vs 247,247,21
Vs 248,248,21
Vs 249,249,21
Vs 250,250,21
Vs 251,251,21
Vs 252,252,21
Vs 253,253,21
Vs 254,254,21
Vs 255,255,21
Vs 176,176,21
Vs 177,177,21
Vs 178,178,21
Vs 179,179,21
Vs 180,180,21
Vs 181,181,21
Vs 182,182,21
Vs 183,183,21
Vs 184,184,21
Vs 185,185,21
Vs 186,186,21
Vs 187,187,21
Vs 188,188,21
Vs 189,189,21
Vs 190,190,21
Vs 191,191,21
Vs 44,44,21
Vs 45,45,21
Vs 46,46,21
v_sub_f32_e64 v47, v47, v21
v_exp_f32 v22, -v21
s_nop 0
Vm 60,60,22
Vm 61,61,22
Vm 62,62,22
v_mul_f32_e64 v63, v63, v22
Ar 8,96
Ar 9,97
Ar 10,98
Ar 11,99
Ar 12,100
Ar 13,101
Ar 14,102
Ar 15,103
Vm 8,8,22
Vm 9,9,22
Vm 10,10,22
Vm 11,11,22
Vm 12,12,22
Vm 13,13,22
Vm 14,14,22
Vm 15,15,22
Aw 96,8
Aw 97,9
Aw 98,10
Aw 99,11
Aw 100,12
Aw 101,13
Aw 102,14
Aw 103,15
Ar 8,104
Ar 9,105
Ar 10,106
Ar 11,107
Ar 12,108
Ar 13,109
Ar 14,110
Ar 15,111
Vm 8,8,22
Vm 9,9,22
Vm 10,10,22
Vm 11,11,22
Vm 12,12,22
Vm 13,13,22
Vm 14,14,22
Vm 15,15,22
Aw 104,8
Aw 105,9
Aw 106,10
Aw 107,11
Aw 108,12
Aw 109,13
Aw 110,14
Aw 111,15
Ar 8,112
Ar 9,113
Ar 10,114
Ar 11,115
Ar 12,116
Ar 13,117
Ar 14,118
Ar 15,119
Vm 8,8,22
Vm 9,9,22
Vm 10,10,22
Vm 11,11,22
Vm 12,12,22
Vm 13,13,22
Vm 14,14,22
Vm 15,15,22
Aw 112,8
Aw 113,9
Aw 114,10
Aw 115,11
Aw 116,12
Aw 117,13
Aw 118,14
Aw 119,15
Ar 8,120
Ar 9,121
Ar 10,122
Ar 11,123
Ar 12,124
Ar 13,125
Ar 14,126
Ar 15,127
Vm 8,8,22
Vm 9,9,22
Vm 10,10,22
Vm 11,11,22
Vm 12,12,22
Vm 13,13,22
Vm 14,14,22
Vm 15,15,22
Aw 120,8
Aw 121,9
Aw 122,10
Aw 123,11
Aw 124,12
Aw 125,13
Aw 126,14
Aw 127,15
Ve 8,192
Ve 9,193
s_nop 0
Vc 96,8,9
Ve 8,194
Ve 9,195
s_nop 0
Vc 97,8,9
Ve 8,208
Ve 9,209
s_nop 0
Vc 104,8,9
Ve 8,210
Ve 9,211
s_nop 0
Vc 105,8,9
Ve 8,224
Ve 9,225
s_nop 0
Vc 112,8,9
Ve 8,226
Ve 9,227
s_nop 0
Vc 113,8,9
Ve 8,240
Ve 9,241
s_nop 0
Vc 120,8,9
Ve 8,242
Ve 9,243
s_nop 0
Vc 121,8,9
Ve 8,196
Ve 9,197
s_nop 0
Vc 98,8,9
Ve 8,198
Ve 9,199
s_nop 0
Vc 99,8,9
Ve 8,212
Ve 9,213
s_nop 0
Vc 106,8,9
Ve 8,214
Ve 9,215
s_nop 0
Vc 107,8,9
Ve 8,228
Ve 9,229
s_nop 0
Vc 114,8,9
Ve 8,230
Ve 9,231
s_nop 0
Vc 115,8,9
Ve 8,244
Ve 9,245
s_nop 0
Vc 122,8,9
Ve 8,246
Ve 9,247
s_nop 0
Vc 123,8,9
Ve 8,200
Ve 9,201
s_nop 0
Vc 100,8,9
Ve 8,202
Ve 9,203
s_nop 0
Vc 101,8,9
Ve 8,216
Ve 9,217
s_nop 0
Vc 108,8,9
Ve 8,218
Ve 9,219
s_nop 0
Vc 109,8,9
Ve 8,232
Ve 9,233
s_nop 0
Vc 116,8,9
Ve 8,234
Ve 9,235
s_nop 0
Vc 117,8,9
Ve 8,248
Ve 9,249
s_nop 0
Vc 124,8,9
Ve 8,250
Ve 9,251
s_nop 0
Vc 125,8,9
Ve 8,204
Ve 9,205
s_nop 0
Vc 102,8,9
Ve 8,206
Ve 9,207
s_nop 0
Vc 103,8,9
Ve 8,220
Ve 9,221
s_nop 0
Vc 110,8,9
Ve 8,222
Ve 9,223
s_nop 0
Vc 111,8,9
Ve 8,236
Ve 9,237
s_nop 0
Vc 118,8,9
Ve 8,238
Ve 9,239
s_nop 0
Vc 119,8,9
Ve 8,252
Ve 9,253
s_nop 0
Vc 126,8,9
Ve 8,254
Ve 9,255
s_nop 0
Vc 127,8,9
s_nop 1
s_branch L_k2_fbr_wo
L_k2_mk_wo:
v_cmp_gt_i32 s[56:57], 0, v5
v_cmp_gt_i32 s[58:59], 1, v5
v_cmp_gt_i32 s[60:61], 2, v5
v_cmp_gt_i32 s[62:63], 3, v5
s_nop 3
s_nop 0
v_cndmask_b32 v176, v176, v20, s[56:57]
v_cndmask_b32 v177, v177, v20, s[58:59]
v_cndmask_b32 v178, v178, v20, s[60:61]
v_cndmask_b32 v179, v179, v20, s[62:63]
v_cmp_gt_i32 s[56:57], 16, v5
v_cmp_gt_i32 s[58:59], 17, v5
v_cmp_gt_i32 s[60:61], 18, v5
v_cmp_gt_i32 s[62:63], 19, v5
v_cndmask_b32 v180, v180, v20, s[56:57]
v_cndmask_b32 v181, v181, v20, s[58:59]
v_cndmask_b32 v182, v182, v20, s[60:61]
v_cndmask_b32 v183, v183, v20, s[62:63]
v_cmp_gt_i32 s[56:57], 32, v5
v_cmp_gt_i32 s[58:59], 33, v5
v_cmp_gt_i32 s[60:61], 34, v5
v_cmp_gt_i32 s[62:63], 35, v5
v_cndmask_b32 v184, v184, v20, s[56:57]
v_cndmask_b32 v185, v185, v20, s[58:59]
v_cndmask_b32 v186, v186, v20, s[60:61]
v_cndmask_b32 v187, v187, v20, s[62:63]
v_cmp_gt_i32 s[56:57], 48, v5
v_cmp_gt_i32 s[58:59], 49, v5
v_cmp_gt_i32 s[60:61], 50, v5
v_cmp_gt_i32 s[62:63], 51, v5
v_cndmask_b32 v188, v188, v20, s[56:57]
v_cndmask_b32 v189, v189, v20, s[58:59]
v_cndmask_b32 v190, v190, v20, s[60:61]
v_cndmask_b32 v191, v191, v20, s[62:63]
s_branch L_k2_mkr_wo
L_k2_fb_wl:
s_nop 7
v_max3_f32 v21, v128, v129, v130
v_max3_f32 v21, v21, v131, v132
v_max3_f32 v21, v21, v133, v134
v_max3_f32 v21, v21, v135, v136
v_max3_f32 v21, v21, v137, v138
v_max3_f32 v21, v21, v139, v140
v_max3_f32 v21, v21, v141, v142
v_max_f32 v21, v21, v143
v_mov_b32 v1, v21
s_nop 1
v_permlane16_swap_b32 v1, v21
v_max_f32 v21, v21, v1
v_mov_b32 v1, v21
s_nop 1
v_permlane32_swap_b32 v1, v21
v_max_f32_e64 v21, v21, v1
v_add_f32 v21, 0x41f80000, v21
v_max_f32 v21, 0, v21
Vs 128,128,21
Vs 129,129,21
Vs 130,130,21
Vs 131,131,21
Vs 132,132,21
Vs 133,133,21
Vs 134,134,21
Vs 135,135,21
Vs 136,136,21
Vs 137,137,21
Vs 138,138,21
Vs 139,139,21
Vs 140,140,21
Vs 141,141,21
Vs 142,142,21
Vs 143,143,21
Vs 192,192,21
Vs 193,193,21
Vs 194,194,21
Vs 195,195,21
Vs 196,196,21
Vs 197,197,21
Vs 198,198,21
Vs 199,199,21
Vs 200,200,21
Vs 201,201,21
Vs 202,202,21
Vs 203,203,21
Vs 204,204,21
Vs 205,205,21
Vs 206,206,21
Vs 207,207,21
Vs 32,32,21
Vs 33,33,21
Vs 34,34,21
v_sub_f32_e64 v35, v35, v21
v_exp_f32 v22, -v21
s_nop 0
Vm 48,48,22
Vm 49,49,22
Vm 50,50,22
v_mul_f32_e64 v51, v51, v22
Ar 8,0
Ar 9,1
Ar 10,2
Ar 11,3
Ar 12,4
Ar 13,5
Ar 14,6
Ar 15,7
Vm 8,8,22
Vm 9,9,22
Vm 10,10,22
Vm 11,11,22
Vm 12,12,22
Vm 13,13,22
Vm 14,14,22
Vm 15,15,22
Aw 0,8
Aw 1,9
Aw 2,10
Aw 3,11
Aw 4,12
Aw 5,13
Aw 6,14
Aw 7,15
Ar 8,8
Ar 9,9
Ar 10,10
Ar 11,11
Ar 12,12
Ar 13,13
Ar 14,14
Ar 15,15
Vm 8,8,22
Vm 9,9,22
Vm 10,10,22
Vm 11,11,22
Vm 12,12,22
Vm 13,13,22
Vm 14,14,22
Vm 15,15,22
Aw 8,8
Aw 9,9
Aw 10,10
Aw 11,11
Aw 12,12
Aw 13,13
Aw 14,14
Aw 15,15
Ar 8,16
Ar 9,17
Ar 10,18
Ar 11,19
Ar 12,20
Ar 13,21
Ar 14,22
Ar 15,23
Vm 8,8,22
Vm 9,9,22
Vm 10,10,22
Vm 11,11,22
Vm 12,12,22
Vm 13,13,22
Vm 14,14,22
Vm 15,15,22
Aw 16,8
Aw 17,9
Aw 18,10
Aw 19,11
Aw 20,12
Aw 21,13
Aw 22,14
Aw 23,15
Ar 8,24
Ar 9,25
Ar 10,26
Ar 11,27
Ar 12,28
Ar 13,29
Ar 14,30
Ar 15,31
Vm 8,8,22
Vm 9,9,22
Vm 10,10,22
Vm 11,11,22
Vm 12,12,22
Vm 13,13,22
Vm 14,14,22
Vm 15,15,22
Aw 24,8
Aw 25,9
Aw 26,10
Aw 27,11
Aw 28,12
Aw 29,13
Aw 30,14
Aw 31,15
v_max3_f32 v21, v144, v145, v146
v_max3_f32 v21, v21, v147, v148
v_max3_f32 v21, v21, v149, v150
v_max3_f32 v21, v21, v151, v152
v_max3_f32 v21, v21, v153, v154
v_max3_f32 v21, v21, v155, v156
v_max3_f32 v21, v21, v157, v158
v_max_f32 v21, v21, v159
v_mov_b32 v1, v21
s_nop 1
v_permlane16_swap_b32 v1, v21
v_max_f32 v21, v21, v1
v_mov_b32 v1, v21
s_nop 1
v_permlane32_swap_b32 v1, v21
v_max_f32_e64 v21, v21, v1
v_add_f32 v21, 0x41f80000, v21
v_max_f32 v21, 0, v21
Vs 144,144,21
Vs 145,145,21
Vs 146,146,21
Vs 147,147,21
Vs 148,148,21
Vs 149,149,21
Vs 150,150,21
Vs 151,151,21
Vs 152,152,21
Vs 153,153,21
Vs 154,154,21
Vs 155,155,21
Vs 156,156,21
Vs 157,157,21
Vs 158,158,21
Vs 159,159,21
Vs 208,208,21
Vs 209,209,21
Vs 210,210,21
Vs 211,211,21
Vs 212,212,21
Vs 213,213,21
Vs 214,214,21
Vs 215,215,21
Vs 216,216,21
Vs 217,217,21
Vs 218,218,21
Vs 219,219,21
Vs 220,220,21
Vs 221,221,21
Vs 222,222,21
Vs 223,223,21
Vs 36,36,21
Vs 37,37,21
Vs 38,38,21
v_sub_f32_e64 v39, v39, v21
v_exp_f32 v22, -v21
s_nop 0
Vm 52,52,22
Vm 53,53,22
Vm 54,54,22
v_mul_f32_e64 v55, v55, v22
Ar 8,32
Ar 9,33
Ar 10,34
Ar 11,35
Ar 12,36
Ar 13,37
Ar 14,38
Ar 15,39
Vm 8,8,22
Vm 9,9,22
Vm 10,10,22
Vm 11,11,22
Vm 12,12,22
Vm 13,13,22
Vm 14,14,22
Vm 15,15,22
Aw 32,8
Aw 33,9
Aw 34,10
Aw 35,11
Aw 36,12
Aw 37,13
Aw 38,14
Aw 39,15
Ar 8,40
Ar 9,41
Ar 10,42
Ar 11,43
Ar 12,44
Ar 13,45
Ar 14,46
Ar 15,47
Vm 8,8,22
Vm 9,9,22
Vm 10,10,22
Vm 11,11,22
Vm 12,12,22
Vm 13,13,22
Vm 14,14,22
Vm 15,15,22
Aw 40,8
Aw 41,9
Aw 42,10
Aw 43,11
Aw 44,12
Aw 45,13
Aw 46,14
Aw 47,15
Ar 8,48
Ar 9,49
Ar 10,50
Ar 11,51
Ar 12,52
Ar 13,53
Ar 14,54
Ar 15,55
Vm 8,8,22
Vm 9,9,22
Vm 10,10,22
Vm 11,11,22
Vm 12,12,22
Vm 13,13,22
Vm 14,14,22
Vm 15,15,22
Aw 48,8
Aw 49,9
Aw 50,10
Aw 51,11
Aw 52,12
Aw 53,13
Aw 54,14
Aw 55,15
Ar 8,56
Ar 9,57
Ar 10,58
Ar 11,59
Ar 12,60
Ar 13,61
Ar 14,62
Ar 15,63
Vm 8,8,22
Vm 9,9,22
Vm 10,10,22
Vm 11,11,22
Vm 12,12,22
Vm 13,13,22
Vm 14,14,22
Vm 15,15,22
Aw 56,8
Aw 57,9
Aw 58,10
Aw 59,11
Aw 60,12
Aw 61,13
Aw 62,14
Aw 63,15
v_max3_f32 v21, v160, v161, v162
v_max3_f32 v21, v21, v163, v164
v_max3_f32 v21, v21, v165, v166
v_max3_f32 v21, v21, v167, v168
v_max3_f32 v21, v21, v169, v170
v_max3_f32 v21, v21, v171, v172
v_max3_f32 v21, v21, v173, v174
v_max_f32 v21, v21, v175
v_mov_b32 v1, v21
s_nop 1
v_permlane16_swap_b32 v1, v21
v_max_f32 v21, v21, v1
v_mov_b32 v1, v21
s_nop 1
v_permlane32_swap_b32 v1, v21
v_max_f32_e64 v21, v21, v1
v_add_f32 v21, 0x41f80000, v21
v_max_f32 v21, 0, v21
Vs 160,160,21
Vs 161,161,21
Vs 162,162,21
Vs 163,163,21
Vs 164,164,21
Vs 165,165,21
Vs 166,166,21
Vs 167,167,21
Vs 168,168,21
Vs 169,169,21
Vs 170,170,21
Vs 171,171,21
Vs 172,172,21
Vs 173,173,21
Vs 174,174,21
Vs 175,175,21
Vs 224,224,21
Vs 225,225,21
Vs 226,226,21
Vs 227,227,21
Vs 228,228,21
Vs 229,229,21
Vs 230,230,21
Vs 231,231,21
Vs 232,232,21
Vs 233,233,21
Vs 234,234,21
Vs 235,235,21
Vs 236,236,21
Vs 237,237,21
Vs 238,238,21
Vs 239,239,21
Vs 40,40,21
Vs 41,41,21
Vs 42,42,21
v_sub_f32_e64 v43, v43, v21
v_exp_f32 v22, -v21
s_nop 0
Vm 56,56,22
Vm 57,57,22
Vm 58,58,22
v_mul_f32_e64 v59, v59, v22
Ar 8,64
Ar 9,65
Ar 10,66
Ar 11,67
Ar 12,68
Ar 13,69
Ar 14,70
Ar 15,71
Vm 8,8,22
Vm 9,9,22
Vm 10,10,22
Vm 11,11,22
Vm 12,12,22
Vm 13,13,22
Vm 14,14,22
Vm 15,15,22
Aw 64,8
Aw 65,9
Aw 66,10
Aw 67,11
Aw 68,12
Aw 69,13
Aw 70,14
Aw 71,15
Ar 8,72
Ar 9,73
Ar 10,74
Ar 11,75
Ar 12,76
Ar 13,77
Ar 14,78
Ar 15,79
Vm 8,8,22
Vm 9,9,22
Vm 10,10,22
Vm 11,11,22
Vm 12,12,22
Vm 13,13,22
Vm 14,14,22
Vm 15,15,22
Aw 72,8
Aw 73,9
Aw 74,10
Aw 75,11
Aw 76,12
Aw 77,13
Aw 78,14
Aw 79,15
Ar 8,80
Ar 9,81
Ar 10,82
Ar 11,83
Ar 12,84
Ar 13,85
Ar 14,86
Ar 15,87
Vm 8,8,22
Vm 9,9,22
Vm 10,10,22
Vm 11,11,22
Vm 12,12,22
Vm 13,13,22
Vm 14,14,22
Vm 15,15,22
Aw 80,8
Aw 81,9
Aw 82,10
Aw 83,11
Aw 84,12
Aw 85,13
Aw 86,14
Aw 87,15
Ar 8,88
Ar 9,89
Ar 10,90
Ar 11,91
Ar 12,92
Ar 13,93
Ar 14,94
Ar 15,95
Vm 8,8,22
Vm 9,9,22
Vm 10,10,22
Vm 11,11,22
Vm 12,12,22
Vm 13,13,22
Vm 14,14,22
Vm 15,15,22
Aw 88,8
Aw 89,9
Aw 90,10
Aw 91,11
Aw 92,12
Aw 93,13
Aw 94,14
Aw 95,15
v_max3_f32 v21, v176, v177, v178
v_max3_f32 v21, v21, v179, v180
v_max3_f32 v21, v21, v181, v182
v_max3_f32 v21, v21, v183, v184
v_max3_f32 v21, v21, v185, v186
v_max3_f32 v21, v21, v187, v188
v_max3_f32 v21, v21, v189, v190
v_max_f32 v21, v21, v191
v_mov_b32 v1, v21
s_nop 1
v_permlane16_swap_b32 v1, v21
v_max_f32 v21, v21, v1
v_mov_b32 v1, v21
s_nop 1
v_permlane32_swap_b32 v1, v21
v_max_f32_e64 v21, v21, v1
v_add_f32 v21, 0x41f80000, v21
v_max_f32 v21, 0, v21
Vs 176,176,21
Vs 177,177,21
Vs 178,178,21
Vs 179,179,21
Vs 180,180,21
Vs 181,181,21
Vs 182,182,21
Vs 183,183,21
Vs 184,184,21
Vs 185,185,21
Vs 186,186,21
Vs 187,187,21
Vs 188,188,21
Vs 189,189,21
Vs 190,190,21
Vs 191,191,21
Vs 44,44,21
Vs 45,45,21
Vs 46,46,21
v_sub_f32_e64 v47, v47, v21
v_exp_f32 v22, -v21
s_nop 0
Vm 60,60,22
Vm 61,61,22
Vm 62,62,22
v_mul_f32_e64 v63, v63, v22
Ar 8,96
Ar 9,97
Ar 10,98
Ar 11,99
Ar 12,100
Ar 13,101
Ar 14,102
Ar 15,103
Vm 8,8,22
Vm 9,9,22
Vm 10,10,22
Vm 11,11,22
Vm 12,12,22
Vm 13,13,22
Vm 14,14,22
Vm 15,15,22
Aw 96,8
Aw 97,9
Aw 98,10
Aw 99,11
Aw 100,12
Aw 101,13
Aw 102,14
Aw 103,15
Ar 8,104
Ar 9,105
Ar 10,106
Ar 11,107
Ar 12,108
Ar 13,109
Ar 14,110
Ar 15,111
Vm 8,8,22
Vm 9,9,22
Vm 10,10,22
Vm 11,11,22
Vm 12,12,22
Vm 13,13,22
Vm 14,14,22
Vm 15,15,22
Aw 104,8
Aw 105,9
Aw 106,10
Aw 107,11
Aw 108,12
Aw 109,13
Aw 110,14
Aw 111,15
Ar 8,112
Ar 9,113
Ar 10,114
Ar 11,115
Ar 12,116
Ar 13,117
Ar 14,118
Ar 15,119
Vm 8,8,22
Vm 9,9,22
Vm 10,10,22
Vm 11,11,22
Vm 12,12,22
Vm 13,13,22
Vm 14,14,22
Vm 15,15,22
Aw 112,8
Aw 113,9
Aw 114,10
Aw 115,11
Aw 116,12
Aw 117,13
Aw 118,14
Aw 119,15
Ar 8,120
Ar 9,121
Ar 10,122
Ar 11,123
Ar 12,124
Ar 13,125
Ar 14,126
Ar 15,127
Vm 8,8,22
Vm 9,9,22
Vm 10,10,22
Vm 11,11,22
Vm 12,12,22
Vm 13,13,22
Vm 14,14,22
Vm 15,15,22
Aw 120,8
Aw 121,9
Aw 122,10
Aw 123,11
Aw 124,12
Aw 125,13
Aw 126,14
Aw 127,15
Ve 8,128
Ve 9,129
s_nop 0
Vc 64,8,9
Ve 8,130
Ve 9,131
s_nop 0
Vc 65,8,9
Ve 8,144
Ve 9,145
s_nop 0
Vc 72,8,9
Ve 8,146
Ve 9,147
s_nop 0
Vc 73,8,9
Ve 8,160
Ve 9,161
s_nop 0
Vc 80,8,9
Ve 8,162
Ve 9,163
s_nop 0
Vc 81,8,9
Ve 8,176
Ve 9,177
s_nop 0
Vc 88,8,9
Ve 8,178
Ve 9,179
s_nop 0
Vc 89,8,9
Ve 8,132
Ve 9,133
s_nop 0
Vc 66,8,9
Ve 8,134
Ve 9,135
s_nop 0
Vc 67,8,9
Ve 8,148
Ve 9,149
s_nop 0
Vc 74,8,9
Ve 8,150
Ve 9,151
s_nop 0
Vc 75,8,9
Ve 8,164
Ve 9,165
s_nop 0
Vc 82,8,9
Ve 8,166
Ve 9,167
s_nop 0
Vc 83,8,9
Ve 8,180
Ve 9,181
s_nop 0
Vc 90,8,9
Ve 8,182
Ve 9,183
s_nop 0
Vc 91,8,9
Ve 8,136
Ve 9,137
s_nop 0
Vc 68,8,9
Ve 8,138
Ve 9,139
s_nop 0
Vc 69,8,9
Ve 8,152
Ve 9,153
s_nop 0
Vc 76,8,9
Ve 8,154
Ve 9,155
s_nop 0
Vc 77,8,9
Ve 8,168
Ve 9,169
s_nop 0
Vc 84,8,9
Ve 8,170
Ve 9,171
s_nop 0
Vc 85,8,9
Ve 8,184
Ve 9,185
s_nop 0
Vc 92,8,9
Ve 8,186
Ve 9,187
s_nop 0
Vc 93,8,9
Ve 8,140
Ve 9,141
s_nop 0
Vc 70,8,9
Ve 8,142
Ve 9,143
s_nop 0
Vc 71,8,9
Ve 8,156
Ve 9,157
s_nop 0
Vc 78,8,9
Ve 8,158
Ve 9,159
s_nop 0
Vc 79,8,9
Ve 8,172
Ve 9,173
s_nop 0
Vc 86,8,9
Ve 8,174
Ve 9,175
s_nop 0
Vc 87,8,9
Ve 8,188
Ve 9,189
s_nop 0
Vc 94,8,9
Ve 8,190
Ve 9,191
s_nop 0
Vc 95,8,9
s_nop 1
s_branch L_k2_fbr_wl
L_k2_mk_wl:
v_cmp_gt_i32 s[56:57], 0, v6
v_cmp_gt_i32 s[58:59], 1, v6
v_cmp_gt_i32 s[60:61], 2, v6
v_cmp_gt_i32 s[62:63], 3, v6
s_nop 3
s_nop 0
v_cndmask_b32 v224, v224, v20, s[56:57]
v_cndmask_b32 v225, v225, v20, s[58:59]
v_cndmask_b32 v226, v226, v20, s[60:61]
v_cndmask_b32 v227, v227, v20, s[62:63]
v_cmp_gt_i32 s[56:57], 16, v6
v_cmp_gt_i32 s[58:59], 17, v6
v_cmp_gt_i32 s[60:61], 18, v6
v_cmp_gt_i32 s[62:63], 19, v6
v_cndmask_b32 v228, v228, v20, s[56:57]
v_cndmask_b32 v229, v229, v20, s[58:59]
v_cndmask_b32 v230, v230, v20, s[60:61]
v_cndmask_b32 v231, v231, v20, s[62:63]
v_cmp_gt_i32 s[56:57], 32, v6
v_cmp_gt_i32 s[58:59], 33, v6
v_cmp_gt_i32 s[60:61], 34, v6
v_cmp_gt_i32 s[62:63], 35, v6
v_cndmask_b32 v232, v232, v20, s[56:57]
v_cndmask_b32 v233, v233, v20, s[58:59]
v_cndmask_b32 v234, v234, v20, s[60:61]
v_cndmask_b32 v235, v235, v20, s[62:63]
v_cmp_gt_i32 s[56:57], 48, v6
v_cmp_gt_i32 s[58:59], 49, v6
v_cmp_gt_i32 s[60:61], 50, v6
v_cmp_gt_i32 s[62:63], 51, v6
v_cndmask_b32 v236, v236, v20, s[56:57]
v_cndmask_b32 v237, v237, v20, s[58:59]
v_cndmask_b32 v238, v238, v20, s[60:61]
v_cndmask_b32 v239, v239, v20, s[62:63]
s_branch L_k2_mkr_wl
L_k2_fb_tr:
s_nop 7
v_max3_f32 v21, v192, v193, v194
v_max3_f32 v21, v21, v195, v196
v_max3_f32 v21, v21, v197, v198
v_max3_f32 v21, v21, v199, v200
v_max3_f32 v21, v21, v201, v202
v_max3_f32 v21, v21, v203, v204
v_max3_f32 v21, v21, v205, v206
v_max_f32 v21, v21, v207
v_mov_b32 v1, v21
s_nop 1
v_permlane16_swap_b32 v1, v21
v_max_f32 v21, v21, v1
v_mov_b32 v1, v21
s_nop 1
v_permlane32_swap_b32 v1, v21
v_max_f32_e64 v21, v21, v1
v_add_f32 v21, 0x41f80000, v21
v_max_f32 v21, 0, v21
Vs 192,192,21
Vs 193,193,21
Vs 194,194,21
Vs 195,195,21
Vs 196,196,21
Vs 197,197,21
Vs 198,198,21
Vs 199,199,21
Vs 200,200,21
Vs 201,201,21
Vs 202,202,21
Vs 203,203,21
Vs 204,204,21
Vs 205,205,21
Vs 206,206,21
Vs 207,207,21
Vs 128,128,21
Vs 129,129,21
Vs 130,130,21
Vs 131,131,21
Vs 132,132,21
Vs 133,133,21
Vs 134,134,21
Vs 135,135,21
Vs 136,136,21
Vs 137,137,21
Vs 138,138,21
Vs 139,139,21
Vs 140,140,21
Vs 141,141,21
Vs 142,142,21
Vs 143,143,21
Vs 32,32,21
Vs 33,33,21
Vs 34,34,21
v_sub_f32_e64 v35, v35, v21
v_exp_f32 v22, -v21
s_nop 0
Vm 48,48,22
Vm 49,49,22
Vm 50,50,22
v_mul_f32_e64 v51, v51, v22
Ar 8,0
Ar 9,1
Ar 10,2
Ar 11,3
Ar 12,4
Ar 13,5
Ar 14,6
Ar 15,7
Vm 8,8,22
Vm 9,9,22
Vm 10,10,22
Vm 11,11,22
Vm 12,12,22
Vm 13,13,22
Vm 14,14,22
Vm 15,15,22
Aw 0,8
Aw 1,9
Aw 2,10
Aw 3,11
Aw 4,12
Aw 5,13
Aw 6,14
Aw 7,15
Ar 8,8
Ar 9,9
Ar 10,10
Ar 11,11
Ar 12,12
Ar 13,13
Ar 14,14
Ar 15,15
Vm 8,8,22
Vm 9,9,22
Vm 10,10,22
Vm 11,11,22
Vm 12,12,22
Vm 13,13,22
Vm 14,14,22
Vm 15,15,22
Aw 8,8
Aw 9,9
Aw 10,10
Aw 11,11
Aw 12,12
Aw 13,13
Aw 14,14
Aw 15,15
Ar 8,16
Ar 9,17
Ar 10,18
Ar 11,19
Ar 12,20
Ar 13,21
Ar 14,22
Ar 15,23
Vm 8,8,22
Vm 9,9,22
Vm 10,10,22
Vm 11,11,22
Vm 12,12,22
Vm 13,13,22
Vm 14,14,22
Vm 15,15,22
Aw 16,8
Aw 17,9
Aw 18,10
Aw 19,11
Aw 20,12
Aw 21,13
Aw 22,14
Aw 23,15
Ar 8,24
Ar 9,25
Ar 10,26
Ar 11,27
Ar 12,28
Ar 13,29
Ar 14,30
Ar 15,31
Vm 8,8,22
Vm 9,9,22
Vm 10,10,22
Vm 11,11,22
Vm 12,12,22
Vm 13,13,22
Vm 14,14,22
Vm 15,15,22
Aw 24,8
Aw 25,9
Aw 26,10
Aw 27,11
Aw 28,12
Aw 29,13
Aw 30,14
Aw 31,15
v_max3_f32 v21, v208, v209, v210
v_max3_f32 v21, v21, v211, v212
v_max3_f32 v21, v21, v213, v214
v_max3_f32 v21, v21, v215, v216
v_max3_f32 v21, v21, v217, v218
v_max3_f32 v21, v21, v219, v220
v_max3_f32 v21, v21, v221, v222
v_max_f32 v21, v21, v223
v_mov_b32 v1, v21
s_nop 1
v_permlane16_swap_b32 v1, v21
v_max_f32 v21, v21, v1
v_mov_b32 v1, v21
s_nop 1
v_permlane32_swap_b32 v1, v21
v_max_f32_e64 v21, v21, v1
v_add_f32 v21, 0x41f80000, v21
v_max_f32 v21, 0, v21
Vs 208,208,21
Vs 209,209,21
Vs 210,210,21
Vs 211,211,21
Vs 212,212,21
Vs 213,213,21
Vs 214,214,21
Vs 215,215,21
Vs 216,216,21
Vs 217,217,21
Vs 218,218,21
Vs 219,219,21
Vs 220,220,21
Vs 221,221,21
Vs 222,222,21
Vs 223,223,21
Vs 144,144,21
Vs 145,145,21
Vs 146,146,21
Vs 147,147,21
Vs 148,148,21
Vs 149,149,21
Vs 150,150,21
Vs 151,151,21
Vs 152,152,21
Vs 153,153,21
Vs 154,154,21
Vs 155,155,21
Vs 156,156,21
Vs 157,157,21
Vs 158,158,21
Vs 159,159,21
Vs 36,36,21
Vs 37,37,21
Vs 38,38,21
v_sub_f32_e64 v39, v39, v21
v_exp_f32 v22, -v21
s_nop 0
Vm 52,52,22
Vm 53,53,22
Vm 54,54,22
v_mul_f32_e64 v55, v55, v22
Ar 8,32
Ar 9,33
Ar 10,34
Ar 11,35
Ar 12,36
Ar 13,37
Ar 14,38
Ar 15,39
Vm 8,8,22
Vm 9,9,22
Vm 10,10,22
Vm 11,11,22
Vm 12,12,22
Vm 13,13,22
Vm 14,14,22
Vm 15,15,22
Aw 32,8
Aw 33,9
Aw 34,10
Aw 35,11
Aw 36,12
Aw 37,13
Aw 38,14
Aw 39,15
Ar 8,40
Ar 9,41
Ar 10,42
Ar 11,43
Ar 12,44
Ar 13,45
Ar 14,46
Ar 15,47
Vm 8,8,22
Vm 9,9,22
Vm 10,10,22
Vm 11,11,22
Vm 12,12,22
Vm 13,13,22
Vm 14,14,22
Vm 15,15,22
Aw 40,8
Aw 41,9
Aw 42,10
Aw 43,11
Aw 44,12
Aw 45,13
Aw 46,14
Aw 47,15
Ar 8,48
Ar 9,49
Ar 10,50
Ar 11,51
Ar 12,52
Ar 13,53
Ar 14,54
Ar 15,55
Vm 8,8,22
Vm 9,9,22
Vm 10,10,22
Vm 11,11,22
Vm 12,12,22
Vm 13,13,22
Vm 14,14,22
Vm 15,15,22
Aw 48,8
Aw 49,9
Aw 50,10
Aw 51,11
Aw 52,12
Aw 53,13
Aw 54,14
Aw 55,15
Ar 8,56
Ar 9,57
Ar 10,58
Ar 11,59
Ar 12,60
Ar 13,61
Ar 14,62
Ar 15,63
Vm 8,8,22
Vm 9,9,22
Vm 10,10,22
Vm 11,11,22
Vm 12,12,22
Vm 13,13,22
Vm 14,14,22
Vm 15,15,22
Aw 56,8
Aw 57,9
Aw 58,10
Aw 59,11
Aw 60,12
Aw 61,13
Aw 62,14
Aw 63,15
v_max3_f32 v21, v224, v225, v226
v_max3_f32 v21, v21, v227, v228
v_max3_f32 v21, v21, v229, v230
v_max3_f32 v21, v21, v231, v232
v_max3_f32 v21, v21, v233, v234
v_max3_f32 v21, v21, v235, v236
v_max3_f32 v21, v21, v237, v238
v_max_f32 v21, v21, v239
v_mov_b32 v1, v21
s_nop 1
v_permlane16_swap_b32 v1, v21
v_max_f32 v21, v21, v1
v_mov_b32 v1, v21
s_nop 1
v_permlane32_swap_b32 v1, v21
v_max_f32_e64 v21, v21, v1
v_add_f32 v21, 0x41f80000, v21
v_max_f32 v21, 0, v21
Vs 224,224,21
Vs 225,225,21
Vs 226,226,21
Vs 227,227,21
Vs 228,228,21
Vs 229,229,21
Vs 230,230,21
Vs 231,231,21
Vs 232,232,21
Vs 233,233,21
Vs 234,234,21
Vs 235,235,21
Vs 236,236,21
Vs 237,237,21
Vs 238,238,21
Vs 239,239,21
Vs 40,40,21
Vs 41,41,21
Vs 42,42,21
v_sub_f32_e64 v43, v43, v21
v_exp_f32 v22, -v21
s_nop 0
Vm 56,56,22
Vm 57,57,22
Vm 58,58,22
v_mul_f32_e64 v59, v59, v22
Ar 8,64
Ar 9,65
Ar 10,66
Ar 11,67
Ar 12,68
Ar 13,69
Ar 14,70
Ar 15,71
Vm 8,8,22
Vm 9,9,22
Vm 10,10,22
Vm 11,11,22
Vm 12,12,22
Vm 13,13,22
Vm 14,14,22
Vm 15,15,22
Aw 64,8
Aw 65,9
Aw 66,10
Aw 67,11
Aw 68,12
Aw 69,13
Aw 70,14
Aw 71,15
Ar 8,72
Ar 9,73
Ar 10,74
Ar 11,75
Ar 12,76
Ar 13,77
Ar 14,78
Ar 15,79
Vm 8,8,22
Vm 9,9,22
Vm 10,10,22
Vm 11,11,22
Vm 12,12,22
Vm 13,13,22
Vm 14,14,22
Vm 15,15,22
Aw 72,8
Aw 73,9
Aw 74,10
Aw 75,11
Aw 76,12
Aw 77,13
Aw 78,14
Aw 79,15
Ar 8,80
Ar 9,81
Ar 10,82
Ar 11,83
Ar 12,84
Ar 13,85
Ar 14,86
Ar 15,87
Vm 8,8,22
Vm 9,9,22
Vm 10,10,22
Vm 11,11,22
Vm 12,12,22
Vm 13,13,22
Vm 14,14,22
Vm 15,15,22
Aw 80,8
Aw 81,9
Aw 82,10
Aw 83,11
Aw 84,12
Aw 85,13
Aw 86,14
Aw 87,15
Ar 8,88
Ar 9,89
Ar 10,90
Ar 11,91
Ar 12,92
Ar 13,93
Ar 14,94
Ar 15,95
Vm 8,8,22
Vm 9,9,22
Vm 10,10,22
Vm 11,11,22
Vm 12,12,22
Vm 13,13,22
Vm 14,14,22
Vm 15,15,22
Aw 88,8
Aw 89,9
Aw 90,10
Aw 91,11
Aw 92,12
Aw 93,13
Aw 94,14
Aw 95,15
Ve 8,192
Ve 9,193
s_nop 0
Vc 96,8,9
Ve 8,194
Ve 9,195
s_nop 0
Vc 97,8,9
Ve 8,208
Ve 9,209
s_nop 0
Vc 104,8,9
Ve 8,210
Ve 9,211
s_nop 0
Vc 105,8,9
Ve 8,224
Ve 9,225
s_nop 0
Vc 112,8,9
Ve 8,226
Ve 9,227
s_nop 0
Vc 113,8,9
Ve 8,196
Ve 9,197
s_nop 0
Vc 98,8,9
Ve 8,198
Ve 9,199
s_nop 0
Vc 99,8,9
Ve 8,212
Ve 9,213
s_nop 0
Vc 106,8,9
Ve 8,214
Ve 9,215
s_nop 0
Vc 107,8,9
Ve 8,228
Ve 9,229
s_nop 0
Vc 114,8,9
Ve 8,230
Ve 9,231
s_nop 0
Vc 115,8,9
Ve 8,200
Ve 9,201
s_nop 0
Vc 100,8,9
Ve 8,202
Ve 9,203
s_nop 0
Vc 101,8,9
Ve 8,216
Ve 9,217
s_nop 0
Vc 108,8,9
Ve 8,218
Ve 9,219
s_nop 0
Vc 109,8,9
Ve 8,232
Ve 9,233
s_nop 0
Vc 116,8,9
Ve 8,234
Ve 9,235
s_nop 0
Vc 117,8,9
Ve 8,204
Ve 9,205
s_nop 0
Vc 102,8,9
Ve 8,206
Ve 9,207
s_nop 0
Vc 103,8,9
Ve 8,220
Ve 9,221
s_nop 0
Vc 110,8,9
Ve 8,222
Ve 9,223
s_nop 0
Vc 111,8,9
Ve 8,236
Ve 9,237
s_nop 0
Vc 118,8,9
Ve 8,238
Ve 9,239
s_nop 0
Vc 119,8,9
s_nop 1
s_branch L_k2_fbr_tr
L_k2_mk_tr:
v_cmp_gt_i32 s[56:57], 0, v5
v_cmp_gt_i32 s[58:59], 1, v5
v_cmp_gt_i32 s[60:61], 2, v5
v_cmp_gt_i32 s[62:63], 3, v5
s_nop 3
s_nop 0
v_cndmask_b32 v144, v144, v20, s[56:57]
v_cndmask_b32 v145, v145, v20, s[58:59]
v_cndmask_b32 v146, v146, v20, s[60:61]
v_cndmask_b32 v147, v147, v20, s[62:63]
v_cmp_gt_i32 s[56:57], 16, v5
v_cmp_gt_i32 s[58:59], 17, v5
v_cmp_gt_i32 s[60:61], 18, v5
v_cmp_gt_i32 s[62:63], 19, v5
v_cndmask_b32 v148, v148, v20, s[56:57]
v_cndmask_b32 v149, v149, v20, s[58:59]
v_cndmask_b32 v150, v150, v20, s[60:61]
v_cndmask_b32 v151, v151, v20, s[62:63]
v_cmp_gt_i32 s[56:57], 32, v5
v_cmp_gt_i32 s[58:59], 33, v5
v_cmp_gt_i32 s[60:61], 34, v5
v_cmp_gt_i32 s[62:63], 35, v5
v_cndmask_b32 v152, v152, v20, s[56:57]
v_cndmask_b32 v153, v153, v20, s[58:59]
v_cndmask_b32 v154, v154, v20, s[60:61]
v_cndmask_b32 v155, v155, v20, s[62:63]
v_cmp_gt_i32 s[56:57], 48, v5
v_cmp_gt_i32 s[58:59], 49, v5
v_cmp_gt_i32 s[60:61], 50, v5
v_cmp_gt_i32 s[62:63], 51, v5
v_cndmask_b32 v156, v156, v20, s[56:57]
v_cndmask_b32 v157, v157, v20, s[58:59]
v_cndmask_b32 v158, v158, v20, s[60:61]
v_cndmask_b32 v159, v159, v20, s[62:63]
s_branch L_k2_mkr_tr
L_k2_fb_ne:
s_nop 7
v_max3_f32 v21, v128, v129, v130
v_max3_f32 v21, v21, v131, v132
v_max3_f32 v21, v21, v133, v134
v_max3_f32 v21, v21, v135, v136
v_max3_f32 v21, v21, v137, v138
v_max3_f32 v21, v21, v139, v140
v_max3_f32 v21, v21, v141, v142
v_max_f32 v21, v21, v143
v_mov_b32 v1, v21
s_nop 1
v_permlane16_swap_b32 v1, v21
v_max_f32 v21, v21, v1
v_mov_b32 v1, v21
s_nop 1
v_permlane32_swap_b32 v1, v21
v_max_f32_e64 v21, v21, v1
v_add_f32 v21, 0x41f80000, v21
v_max_f32 v21, 0, v21
Vs 128,128,21
Vs 129,129,21
Vs 130,130,21
Vs 131,131,21
Vs 132,132,21
Vs 133,133,21
Vs 134,134,21
Vs 135,135,21
Vs 136,136,21
Vs 137,137,21
Vs 138,138,21
Vs 139,139,21
Vs 140,140,21
Vs 141,141,21
Vs 142,142,21
Vs 143,143,21
Vs 192,192,21
Vs 193,193,21
Vs 194,194,21
Vs 195,195,21
Vs 196,196,21
Vs 197,197,21
Vs 198,198,21
Vs 199,199,21
Vs 200,200,21
Vs 201,201,21
Vs 202,202,21
Vs 203,203,21
Vs 204,204,21
Vs 205,205,21
Vs 206,206,21
Vs 207,207,21
Vs 32,32,21
Vs 33,33,21
Vs 34,34,21
v_sub_f32_e64 v35, v35, v21
v_exp_f32 v22, -v21
s_nop 0
Vm 48,48,22
Vm 49,49,22
Vm 50,50,22
v_mul_f32_e64 v51, v51, v22
Ar 8,0
Ar 9,1
Ar 10,2
Ar 11,3
Ar 12,4
Ar 13,5
Ar 14,6
Ar 15,7
Vm 8,8,22
Vm 9,9,22
Vm 10,10,22
Vm 11,11,22
Vm 12,12,22
Vm 13,13,22
Vm 14,14,22
Vm 15,15,22
Aw 0,8
Aw 1,9
Aw 2,10
Aw 3,11
Aw 4,12
Aw 5,13
Aw 6,14
Aw 7,15
Ar 8,8
Ar 9,9
Ar 10,10
Ar 11,11
Ar 12,12
Ar 13,13
Ar 14,14
Ar 15,15
Vm 8,8,22
Vm 9,9,22
Vm 10,10,22
Vm 11,11,22
Vm 12,12,22
Vm 13,13,22
Vm 14,14,22
Vm 15,15,22
Aw 8,8
Aw 9,9
Aw 10,10
Aw 11,11
Aw 12,12
Aw 13,13
Aw 14,14
Aw 15,15
Ar 8,16
Ar 9,17
Ar 10,18
Ar 11,19
Ar 12,20
Ar 13,21
Ar 14,22
Ar 15,23
Vm 8,8,22
Vm 9,9,22
Vm 10,10,22
Vm 11,11,22
Vm 12,12,22
Vm 13,13,22
Vm 14,14,22
Vm 15,15,22
Aw 16,8
Aw 17,9
Aw 18,10
Aw 19,11
Aw 20,12
Aw 21,13
Aw 22,14
Aw 23,15
Ar 8,24
Ar 9,25
Ar 10,26
Ar 11,27
Ar 12,28
Ar 13,29
Ar 14,30
Ar 15,31
Vm 8,8,22
Vm 9,9,22
Vm 10,10,22
Vm 11,11,22
Vm 12,12,22
Vm 13,13,22
Vm 14,14,22
Vm 15,15,22
Aw 24,8
Aw 25,9
Aw 26,10
Aw 27,11
Aw 28,12
Aw 29,13
Aw 30,14
Aw 31,15
v_max3_f32 v21, v144, v145, v146
v_max3_f32 v21, v21, v147, v148
v_max3_f32 v21, v21, v149, v150
v_max3_f32 v21, v21, v151, v152
v_max3_f32 v21, v21, v153, v154
v_max3_f32 v21, v21, v155, v156
v_max3_f32 v21, v21, v157, v158
v_max_f32 v21, v21, v159
v_mov_b32 v1, v21
s_nop 1
v_permlane16_swap_b32 v1, v21
v_max_f32 v21, v21, v1
v_mov_b32 v1, v21
s_nop 1
v_permlane32_swap_b32 v1, v21
v_max_f32_e64 v21, v21, v1
v_add_f32 v21, 0x41f80000, v21
v_max_f32 v21, 0, v21
Vs 144,144,21
Vs 145,145,21
Vs 146,146,21
Vs 147,147,21
Vs 148,148,21
Vs 149,149,21
Vs 150,150,21
Vs 151,151,21
Vs 152,152,21
Vs 153,153,21
Vs 154,154,21
Vs 155,155,21
Vs 156,156,21
Vs 157,157,21
Vs 158,158,21
Vs 159,159,21
Vs 208,208,21
Vs 209,209,21
Vs 210,210,21
Vs 211,211,21
Vs 212,212,21
Vs 213,213,21
Vs 214,214,21
Vs 215,215,21
Vs 216,216,21
Vs 217,217,21
Vs 218,218,21
Vs 219,219,21
Vs 220,220,21
Vs 221,221,21
Vs 222,222,21
Vs 223,223,21
Vs 36,36,21
Vs 37,37,21
Vs 38,38,21
v_sub_f32_e64 v39, v39, v21
v_exp_f32 v22, -v21
s_nop 0
Vm 52,52,22
Vm 53,53,22
Vm 54,54,22
v_mul_f32_e64 v55, v55, v22
Ar 8,32
Ar 9,33
Ar 10,34
Ar 11,35
Ar 12,36
Ar 13,37
Ar 14,38
Ar 15,39
Vm 8,8,22
Vm 9,9,22
Vm 10,10,22
Vm 11,11,22
Vm 12,12,22
Vm 13,13,22
Vm 14,14,22
Vm 15,15,22
Aw 32,8
Aw 33,9
Aw 34,10
Aw 35,11
Aw 36,12
Aw 37,13
Aw 38,14
Aw 39,15
Ar 8,40
Ar 9,41
Ar 10,42
Ar 11,43
Ar 12,44
Ar 13,45
Ar 14,46
Ar 15,47
Vm 8,8,22
Vm 9,9,22
Vm 10,10,22
Vm 11,11,22
Vm 12,12,22
Vm 13,13,22
Vm 14,14,22
Vm 15,15,22
Aw 40,8
Aw 41,9
Aw 42,10
Aw 43,11
Aw 44,12
Aw 45,13
Aw 46,14
Aw 47,15
Ar 8,48
Ar 9,49
Ar 10,50
Ar 11,51
Ar 12,52
Ar 13,53
Ar 14,54
Ar 15,55
Vm 8,8,22
Vm 9,9,22
Vm 10,10,22
Vm 11,11,22
Vm 12,12,22
Vm 13,13,22
Vm 14,14,22
Vm 15,15,22
Aw 48,8
Aw 49,9
Aw 50,10
Aw 51,11
Aw 52,12
Aw 53,13
Aw 54,14
Aw 55,15
Ar 8,56
Ar 9,57
Ar 10,58
Ar 11,59
Ar 12,60
Ar 13,61
Ar 14,62
Ar 15,63
Vm 8,8,22
Vm 9,9,22
Vm 10,10,22
Vm 11,11,22
Vm 12,12,22
Vm 13,13,22
Vm 14,14,22
Vm 15,15,22
Aw 56,8
Aw 57,9
Aw 58,10
Aw 59,11
Aw 60,12
Aw 61,13
Aw 62,14
Aw 63,15
Ve 8,128
Ve 9,129
s_nop 0
Vc 64,8,9
Ve 8,130
Ve 9,131
s_nop 0
Vc 65,8,9
Ve 8,144
Ve 9,145
s_nop 0
Vc 72,8,9
Ve 8,146
Ve 9,147
s_nop 0
Vc 73,8,9
Ve 8,132
Ve 9,133
s_nop 0
Vc 66,8,9
Ve 8,134
Ve 9,135
s_nop 0
Vc 67,8,9
Ve 8,148
Ve 9,149
s_nop 0
Vc 74,8,9
Ve 8,150
Ve 9,151
s_nop 0
Vc 75,8,9
Ve 8,136
Ve 9,137
s_nop 0
Vc 68,8,9
Ve 8,138
Ve 9,139
s_nop 0
Vc 69,8,9
Ve 8,152
Ve 9,153
s_nop 0
Vc 76,8,9
Ve 8,154
Ve 9,155
s_nop 0
Vc 77,8,9
Ve 8,140
Ve 9,141
s_nop 0
Vc 70,8,9
Ve 8,142
Ve 9,143
s_nop 0
Vc 71,8,9
Ve 8,156
Ve 9,157
s_nop 0
Vc 78,8,9
Ve 8,158
Ve 9,159
s_nop 0
Vc 79,8,9
s_nop 1
s_branch L_k2_fbr_ne
L_pubB:
v_mov_b32 v24, 1
v_mov_b32 v25, 0
s_mov_b64 exec, 1
buffer_store_dword v24, v25, s[20:23], s64 offen sc1
s_mov_b64 exec, -1
s_branch L_pubBr
L_k2_fb_no:
s_nop 7
v_max3_f32 v21, v192, v193, v194
v_max3_f32 v21, v21, v195, v196
v_max3_f32 v21, v21, v197, v198
v_max3_f32 v21, v21, v199, v200
v_max3_f32 v21, v21, v201, v202
v_max3_f32 v21, v21, v203, v204
v_max3_f32 v21, v21, v205, v206
v_max_f32 v21, v21, v207
v_mov_b32 v1, v21
s_nop 1
v_permlane16_swap_b32 v1, v21
v_max_f32 v21, v21, v1
v_mov_b32 v1, v21
s_nop 1
v_permlane32_swap_b32 v1, v21
v_max_f32_e64 v21, v21, v1
v_add_f32 v21, 0x41f80000, v21
v_max_f32 v21, 0, v21
Vs 192,192,21
Vs 193,193,21
Vs 194,194,21
Vs 195,195,21
Vs 196,196,21
Vs 197,197,21
Vs 198,198,21
Vs 199,199,21
Vs 200,200,21
Vs 201,201,21
Vs 202,202,21
Vs 203,203,21
Vs 204,204,21
Vs 205,205,21
Vs 206,206,21
Vs 207,207,21
Vs 128,128,21
Vs 129,129,21
Vs 130,130,21
Vs 131,131,21
Vs 132,132,21
Vs 133,133,21
Vs 134,134,21
Vs 135,135,21
Vs 136,136,21
Vs 137,137,21
Vs 138,138,21
Vs 139,139,21
Vs 140,140,21
Vs 141,141,21
Vs 142,142,21
Vs 143,143,21
Vs 32,32,21
Vs 33,33,21
Vs 34,34,21
v_sub_f32_e64 v35, v35, v21
v_exp_f32 v22, -v21
s_nop 0
Vm 48,48,22
Vm 49,49,22
Vm 50,50,22
v_mul_f32_e64 v51, v51, v22
Ar 8,0
Ar 9,1
Ar 10,2
Ar 11,3
Ar 12,4
Ar 13,5
Ar 14,6
Ar 15,7
Vm 8,8,22
Vm 9,9,22
Vm 10,10,22
Vm 11,11,22
Vm 12,12,22
Vm 13,13,22
Vm 14,14,22
Vm 15,15,22
Aw 0,8
Aw 1,9
Aw 2,10
Aw 3,11
Aw 4,12
Aw 5,13
Aw 6,14
Aw 7,15
Ar 8,8
Ar 9,9
Ar 10,10
Ar 11,11
Ar 12,12
Ar 13,13
Ar 14,14
Ar 15,15
Vm 8,8,22
Vm 9,9,22
Vm 10,10,22
Vm 11,11,22
Vm 12,12,22
Vm 13,13,22
Vm 14,14,22
Vm 15,15,22
Aw 8,8
Aw 9,9
Aw 10,10
Aw 11,11
Aw 12,12
Aw 13,13
Aw 14,14
Aw 15,15
Ar 8,16
Ar 9,17
Ar 10,18
Ar 11,19
Ar 12,20
Ar 13,21
Ar 14,22
Ar 15,23
Vm 8,8,22
Vm 9,9,22
Vm 10,10,22
Vm 11,11,22
Vm 12,12,22
Vm 13,13,22
Vm 14,14,22
Vm 15,15,22
Aw 16,8
Aw 17,9
Aw 18,10
Aw 19,11
Aw 20,12
Aw 21,13
Aw 22,14
Aw 23,15
Ar 8,24
Ar 9,25
Ar 10,26
Ar 11,27
Ar 12,28
Ar 13,29
Ar 14,30
Ar 15,31
Vm 8,8,22
Vm 9,9,22
Vm 10,10,22
Vm 11,11,22
Vm 12,12,22
Vm 13,13,22
Vm 14,14,22
Vm 15,15,22
Aw 24,8
Aw 25,9
Aw 26,10
Aw 27,11
Aw 28,12
Aw 29,13
Aw 30,14
Aw 31,15
v_max3_f32 v21, v208, v209, v210
v_max3_f32 v21, v21, v211, v212
v_max3_f32 v21, v21, v213, v214
v_max3_f32 v21, v21, v215, v216
v_max3_f32 v21, v21, v217, v218
v_max3_f32 v21, v21, v219, v220
v_max3_f32 v21, v21, v221, v222
v_max_f32 v21, v21, v223
v_mov_b32 v1, v21
s_nop 1
v_permlane16_swap_b32 v1, v21
v_max_f32 v21, v21, v1
v_mov_b32 v1, v21
s_nop 1
v_permlane32_swap_b32 v1, v21
v_max_f32_e64 v21, v21, v1
v_add_f32 v21, 0x41f80000, v21
v_max_f32 v21, 0, v21
Vs 208,208,21
Vs 209,209,21
Vs 210,210,21
Vs 211,211,21
Vs 212,212,21
Vs 213,213,21
Vs 214,214,21
Vs 215,215,21
Vs 216,216,21
Vs 217,217,21
Vs 218,218,21
Vs 219,219,21
Vs 220,220,21
Vs 221,221,21
Vs 222,222,21
Vs 223,223,21
Vs 144,144,21
Vs 145,145,21
Vs 146,146,21
Vs 147,147,21
Vs 148,148,21
Vs 149,149,21
Vs 150,150,21
Vs 151,151,21
Vs 152,152,21
Vs 153,153,21
Vs 154,154,21
Vs 155,155,21
Vs 156,156,21
Vs 157,157,21
Vs 158,158,21
Vs 159,159,21
Vs 36,36,21
Vs 37,37,21
Vs 38,38,21
v_sub_f32_e64 v39, v39, v21
v_exp_f32 v22, -v21
s_nop 0
Vm 52,52,22
Vm 53,53,22
Vm 54,54,22
v_mul_f32_e64 v55, v55, v22
Ar 8,32
Ar 9,33
Ar 10,34
Ar 11,35
Ar 12,36
Ar 13,37
Ar 14,38
Ar 15,39
Vm 8,8,22
Vm 9,9,22
Vm 10,10,22
Vm 11,11,22
Vm 12,12,22
Vm 13,13,22
Vm 14,14,22
Vm 15,15,22
Aw 32,8
Aw 33,9
Aw 34,10
Aw 35,11
Aw 36,12
Aw 37,13
Aw 38,14
Aw 39,15
Ar 8,40
Ar 9,41
Ar 10,42
Ar 11,43
Ar 12,44
Ar 13,45
Ar 14,46
Ar 15,47
Vm 8,8,22
Vm 9,9,22
Vm 10,10,22
Vm 11,11,22
Vm 12,12,22
Vm 13,13,22
Vm 14,14,22
Vm 15,15,22
Aw 40,8
Aw 41,9
Aw 42,10
Aw 43,11
Aw 44,12
Aw 45,13
Aw 46,14
Aw 47,15
Ar 8,48
Ar 9,49
Ar 10,50
Ar 11,51
Ar 12,52
Ar 13,53
Ar 14,54
Ar 15,55
Vm 8,8,22
Vm 9,9,22
Vm 10,10,22
Vm 11,11,22
Vm 12,12,22
Vm 13,13,22
Vm 14,14,22
Vm 15,15,22
Aw 48,8
Aw 49,9
Aw 50,10
Aw 51,11
Aw 52,12
Aw 53,13
Aw 54,14
Aw 55,15
Ar 8,56
Ar 9,57
Ar 10,58
Ar 11,59
Ar 12,60
Ar 13,61
Ar 14,62
Ar 15,63
Vm 8,8,22
Vm 9,9,22
Vm 10,10,22
Vm 11,11,22
Vm 12,12,22
Vm 13,13,22
Vm 14,14,22
Vm 15,15,22
Aw 56,8
Aw 57,9
Aw 58,10
Aw 59,11
Aw 60,12
Aw 61,13
Aw 62,14
Aw 63,15
Ve 8,192
Ve 9,193
s_nop 0
Vc 96,8,9
Ve 8,194
Ve 9,195
s_nop 0
Vc 97,8,9
Ve 8,208
Ve 9,209
s_nop 0
Vc 104,8,9
Ve 8,210
Ve 9,211
s_nop 0
Vc 105,8,9
Ve 8,196
Ve 9,197
s_nop 0
Vc 98,8,9
Ve 8,198
Ve 9,199
s_nop 0
Vc 99,8,9
Ve 8,212
Ve 9,213
s_nop 0
Vc 106,8,9
Ve 8,214
Ve 9,215
s_nop 0
Vc 107,8,9
Ve 8,200
Ve 9,201
s_nop 0
Vc 100,8,9
Ve 8,202
Ve 9,203
s_nop 0
Vc 101,8,9
Ve 8,216
Ve 9,217
s_nop 0
Vc 108,8,9
Ve 8,218
Ve 9,219
s_nop 0
Vc 109,8,9
Ve 8,204
Ve 9,205
s_nop 0
Vc 102,8,9
Ve 8,206
Ve 9,207
s_nop 0
Vc 103,8,9
Ve 8,220
Ve 9,221
s_nop 0
Vc 110,8,9
Ve 8,222
Ve 9,223
s_nop 0
Vc 111,8,9
s_nop 1
s_branch L_k2_fbr_no
L_k2_mk_no:
v_cmp_gt_i32 s[56:57], 0, v5
v_cmp_gt_i32 s[58:59], 1, v5
v_cmp_gt_i32 s[60:61], 2, v5
v_cmp_gt_i32 s[62:63], 3, v5
s_nop 3
s_nop 0
v_cndmask_b32 v144, v144, v20, s[56:57]
v_cndmask_b32 v145, v145, v20, s[58:59]
v_cndmask_b32 v146, v146, v20, s[60:61]
v_cndmask_b32 v147, v147, v20, s[62:63]
v_cmp_gt_i32 s[56:57], 16, v5
v_cmp_gt_i32 s[58:59], 17, v5
v_cmp_gt_i32 s[60:61], 18, v5
v_cmp_gt_i32 s[62:63], 19, v5
v_cndmask_b32 v148, v148, v20, s[56:57]
v_cndmask_b32 v149, v149, v20, s[58:59]
v_cndmask_b32 v150, v150, v20, s[60:61]
v_cndmask_b32 v151, v151, v20, s[62:63]
v_cmp_gt_i32 s[56:57], 32, v5
v_cmp_gt_i32 s[58:59], 33, v5
v_cmp_gt_i32 s[60:61], 34, v5
v_cmp_gt_i32 s[62:63], 35, v5
v_cndmask_b32 v152, v152, v20, s[56:57]
v_cndmask_b32 v153, v153, v20, s[58:59]
v_cndmask_b32 v154, v154, v20, s[60:61]
v_cndmask_b32 v155, v155, v20, s[62:63]
v_cmp_gt_i32 s[56:57], 48, v5
v_cmp_gt_i32 s[58:59], 49, v5
v_cmp_gt_i32 s[60:61], 50, v5
v_cmp_gt_i32 s[62:63], 51, v5
v_cndmask_b32 v156, v156, v20, s[56:57]
v_cndmask_b32 v157, v157, v20, s[58:59]
v_cndmask_b32 v158, v158, v20, s[60:61]
v_cndmask_b32 v159, v159, v20, s[62:63]
s_branch L_k2_mkr_no
L_k2_fb_nl:
s_nop 7
v_max3_f32 v21, v128, v129, v130
v_max3_f32 v21, v21, v131, v132
v_max3_f32 v21, v21, v133, v134
v_max3_f32 v21, v21, v135, v136
v_max3_f32 v21, v21, v137, v138
v_max3_f32 v21, v21, v139, v140
v_max3_f32 v21, v21, v141, v142
v_max_f32 v21, v21, v143
v_mov_b32 v1, v21
s_nop 1
v_permlane16_swap_b32 v1, v21
v_max_f32 v21, v21, v1
v_mov_b32 v1, v21
s_nop 1
v_permlane32_swap_b32 v1, v21
v_max_f32_e64 v21, v21, v1
v_add_f32 v21, 0x41f80000, v21
v_max_f32 v21, 0, v21
Vs 128,128,21
Vs 129,129,21
Vs 130,130,21
Vs 131,131,21
Vs 132,132,21
Vs 133,133,21
Vs 134,134,21
Vs 135,135,21
Vs 136,136,21
Vs 137,137,21
Vs 138,138,21
Vs 139,139,21
Vs 140,140,21
Vs 141,141,21
Vs 142,142,21
Vs 143,143,21
Vs 192,192,21
Vs 193,193,21
Vs 194,194,21
Vs 195,195,21
Vs 196,196,21
Vs 197,197,21
Vs 198,198,21
Vs 199,199,21
Vs 200,200,21
Vs 201,201,21
Vs 202,202,21
Vs 203,203,21
Vs 204,204,21
Vs 205,205,21
Vs 206,206,21
Vs 207,207,21
Vs 32,32,21
Vs 33,33,21
Vs 34,34,21
v_sub_f32_e64 v35, v35, v21
v_exp_f32 v22, -v21
s_nop 0
Vm 48,48,22
Vm 49,49,22
Vm 50,50,22
v_mul_f32_e64 v51, v51, v22
Ar 8,0
Ar 9,1
Ar 10,2
Ar 11,3
Ar 12,4
Ar 13,5
Ar 14,6
Ar 15,7
Vm 8,8,22
Vm 9,9,22
Vm 10,10,22
Vm 11,11,22
Vm 12,12,22
Vm 13,13,22
Vm 14,14,22
Vm 15,15,22
Aw 0,8
Aw 1,9
Aw 2,10
Aw 3,11
Aw 4,12
Aw 5,13
Aw 6,14
Aw 7,15
Ar 8,8
Ar 9,9
Ar 10,10
Ar 11,11
Ar 12,12
Ar 13,13
Ar 14,14
Ar 15,15
Vm 8,8,22
Vm 9,9,22
Vm 10,10,22
Vm 11,11,22
Vm 12,12,22
Vm 13,13,22
Vm 14,14,22
Vm 15,15,22
Aw 8,8
Aw 9,9
Aw 10,10
Aw 11,11
Aw 12,12
Aw 13,13
Aw 14,14
Aw 15,15
Ar 8,16
Ar 9,17
Ar 10,18
Ar 11,19
Ar 12,20
Ar 13,21
Ar 14,22
Ar 15,23
Vm 8,8,22
Vm 9,9,22
Vm 10,10,22
Vm 11,11,22
Vm 12,12,22
Vm 13,13,22
Vm 14,14,22
Vm 15,15,22
Aw 16,8
Aw 17,9
Aw 18,10
Aw 19,11
Aw 20,12
Aw 21,13
Aw 22,14
Aw 23,15
Ar 8,24
Ar 9,25
Ar 10,26
Ar 11,27
Ar 12,28
Ar 13,29
Ar 14,30
Ar 15,31
Vm 8,8,22
Vm 9,9,22
Vm 10,10,22
Vm 11,11,22
Vm 12,12,22
Vm 13,13,22
Vm 14,14,22
Vm 15,15,22
Aw 24,8
Aw 25,9
Aw 26,10
Aw 27,11
Aw 28,12
Aw 29,13
Aw 30,14
Aw 31,15
v_max3_f32 v21, v144, v145, v146
v_max3_f32 v21, v21, v147, v148
v_max3_f32 v21, v21, v149, v150
v_max3_f32 v21, v21, v151, v152
v_max3_f32 v21, v21, v153, v154
v_max3_f32 v21, v21, v155, v156
v_max3_f32 v21, v21, v157, v158
v_max_f32 v21, v21, v159
v_mov_b32 v1, v21
s_nop 1
v_permlane16_swap_b32 v1, v21
v_max_f32 v21, v21, v1
v_mov_b32 v1, v21
s_nop 1
v_permlane32_swap_b32 v1, v21
v_max_f32_e64 v21, v21, v1
v_add_f32 v21, 0x41f80000, v21
v_max_f32 v21, 0, v21
Vs 144,144,21
Vs 145,145,21
Vs 146,146,21
Vs 147,147,21
Vs 148,148,21
Vs 149,149,21
Vs 150,150,21
Vs 151,151,21
Vs 152,152,21
Vs 153,153,21
Vs 154,154,21
Vs 155,155,21
Vs 156,156,21
Vs 157,157,21
Vs 158,158,21
Vs 159,159,21
Vs 36,36,21
Vs 37,37,21
Vs 38,38,21
v_sub_f32_e64 v39, v39, v21
v_exp_f32 v22, -v21
s_nop 0
Vm 52,52,22
Vm 53,53,22
Vm 54,54,22
v_mul_f32_e64 v55, v55, v22
Ar 8,32
Ar 9,33
Ar 10,34
Ar 11,35
Ar 12,36
Ar 13,37
Ar 14,38
Ar 15,39
Vm 8,8,22
Vm 9,9,22
Vm 10,10,22
Vm 11,11,22
Vm 12,12,22
Vm 13,13,22
Vm 14,14,22
Vm 15,15,22
Aw 32,8
Aw 33,9
Aw 34,10
Aw 35,11
Aw 36,12
Aw 37,13
Aw 38,14
Aw 39,15
Ar 8,40
Ar 9,41
Ar 10,42
Ar 11,43
Ar 12,44
Ar 13,45
Ar 14,46
Ar 15,47
Vm 8,8,22
Vm 9,9,22
Vm 10,10,22
Vm 11,11,22
Vm 12,12,22
Vm 13,13,22
Vm 14,14,22
Vm 15,15,22
Aw 40,8
Aw 41,9
Aw 42,10
Aw 43,11
Aw 44,12
Aw 45,13
Aw 46,14
Aw 47,15
Ar 8,48
Ar 9,49
Ar 10,50
Ar 11,51
Ar 12,52
Ar 13,53
Ar 14,54
Ar 15,55
Vm 8,8,22
Vm 9,9,22
Vm 10,10,22
Vm 11,11,22
Vm 12,12,22
Vm 13,13,22
Vm 14,14,22
Vm 15,15,22
Aw 48,8
Aw 49,9
Aw 50,10
Aw 51,11
Aw 52,12
Aw 53,13
Aw 54,14
Aw 55,15
Ar 8,56
Ar 9,57
Ar 10,58
Ar 11,59
Ar 12,60
Ar 13,61
Ar 14,62
Ar 15,63
Vm 8,8,22
Vm 9,9,22
Vm 10,10,22
Vm 11,11,22
Vm 12,12,22
Vm 13,13,22
Vm 14,14,22
Vm 15,15,22
Aw 56,8
Aw 57,9
Aw 58,10
Aw 59,11
Aw 60,12
Aw 61,13
Aw 62,14
Aw 63,15
Ve 8,128
Ve 9,129
s_nop 0
Vc 64,8,9
Ve 8,130
Ve 9,131
s_nop 0
Vc 65,8,9
Ve 8,144
Ve 9,145
s_nop 0
Vc 72,8,9
Ve 8,146
Ve 9,147
s_nop 0
Vc 73,8,9
Ve 8,132
Ve 9,133
s_nop 0
Vc 66,8,9
Ve 8,134
Ve 9,135
s_nop 0
Vc 67,8,9
Ve 8,148
Ve 9,149
s_nop 0
Vc 74,8,9
Ve 8,150
Ve 9,151
s_nop 0
Vc 75,8,9
Ve 8,136
Ve 9,137
s_nop 0
Vc 68,8,9
Ve 8,138
Ve 9,139
s_nop 0
Vc 69,8,9
Ve 8,152
Ve 9,153
s_nop 0
Vc 76,8,9
Ve 8,154
Ve 9,155
s_nop 0
Vc 77,8,9
Ve 8,140
Ve 9,141
s_nop 0
Vc 70,8,9
Ve 8,142
Ve 9,143
s_nop 0
Vc 71,8,9
Ve 8,156
Ve 9,157
s_nop 0
Vc 78,8,9
Ve 8,158
Ve 9,159
s_nop 0
Vc 79,8,9
s_nop 1
s_branch L_k2_fbr_nl
L_k2_mk_nl:
v_cmp_gt_i32 s[56:57], 0, v6
v_cmp_gt_i32 s[58:59], 1, v6
v_cmp_gt_i32 s[60:61], 2, v6
v_cmp_gt_i32 s[62:63], 3, v6
s_nop 3
s_nop 0
v_cndmask_b32 v192, v192, v20, s[56:57]
v_cndmask_b32 v193, v193, v20, s[58:59]
v_cndmask_b32 v194, v194, v20, s[60:61]
v_cndmask_b32 v195, v195, v20, s[62:63]
v_cmp_gt_i32 s[56:57], 16, v6
v_cmp_gt_i32 s[58:59], 17, v6
v_cmp_gt_i32 s[60:61], 18, v6
v_cmp_gt_i32 s[62:63], 19, v6
v_cndmask_b32 v196, v196, v20, s[56:57]
v_cndmask_b32 v197, v197, v20, s[58:59]
v_cndmask_b32 v198, v198, v20, s[60:61]
v_cndmask_b32 v199, v199, v20, s[62:63]
v_cmp_gt_i32 s[56:57], 32, v6
v_cmp_gt_i32 s[58:59], 33, v6
v_cmp_gt_i32 s[60:61], 34, v6
v_cmp_gt_i32 s[62:63], 35, v6
v_cndmask_b32 v200, v200, v20, s[56:57]
v_cndmask_b32 v201, v201, v20, s[58:59]
v_cndmask_b32 v202, v202, v20, s[60:61]
v_cndmask_b32 v203, v203, v20, s[62:63]
v_cmp_gt_i32 s[56:57], 48, v6
v_cmp_gt_i32 s[58:59], 49, v6
v_cmp_gt_i32 s[60:61], 50, v6
v_cmp_gt_i32 s[62:63], 51, v6
v_cndmask_b32 v204, v204, v20, s[56:57]
v_cndmask_b32 v205, v205, v20, s[58:59]
v_cndmask_b32 v206, v206, v20, s[60:61]
v_cndmask_b32 v207, v207, v20, s[62:63]
s_branch L_k2_mkr_nl
L_k2_fb_fi:
s_nop 7
v_max3_f32 v21, v192, v193, v194
v_max3_f32 v21, v21, v195, v196
v_max3_f32 v21, v21, v197, v198
v_max3_f32 v21, v21, v199, v200
v_max3_f32 v21, v21, v201, v202
v_max3_f32 v21, v21, v203, v204
v_max3_f32 v21, v21, v205, v206
v_max_f32 v21, v21, v207
v_mov_b32 v1, v21
s_nop 1
v_permlane16_swap_b32 v1, v21
v_max_f32 v21, v21, v1
v_mov_b32 v1, v21
s_nop 1
v_permlane32_swap_b32 v1, v21
v_max_f32_e64 v21, v21, v1
v_add_f32 v21, 0x41f80000, v21
v_max_f32 v21, 0, v21
Vs 192,192,21
Vs 193,193,21
Vs 194,194,21
Vs 195,195,21
Vs 196,196,21
Vs 197,197,21
Vs 198,198,21
Vs 199,199,21
Vs 200,200,21
Vs 201,201,21
Vs 202,202,21
Vs 203,203,21
Vs 204,204,21
Vs 205,205,21
Vs 206,206,21
Vs 207,207,21
Vs 32,32,21
Vs 33,33,21
Vs 34,34,21
v_sub_f32_e64 v35, v35, v21
v_exp_f32 v22, -v21
s_nop 0
Vm 48,48,22
Vm 49,49,22
Vm 50,50,22
v_mul_f32_e64 v51, v51, v22
Ar 8,0
Ar 9,1
Ar 10,2
Ar 11,3
Ar 12,4
Ar 13,5
Ar 14,6
Ar 15,7
Vm 8,8,22
Vm 9,9,22
Vm 10,10,22
Vm 11,11,22
Vm 12,12,22
Vm 13,13,22
Vm 14,14,22
Vm 15,15,22
Aw 0,8
Aw 1,9
Aw 2,10
Aw 3,11
Aw 4,12
Aw 5,13
Aw 6,14
Aw 7,15
Ar 8,8
Ar 9,9
Ar 10,10
Ar 11,11
Ar 12,12
Ar 13,13
Ar 14,14
Ar 15,15
Vm 8,8,22
Vm 9,9,22
Vm 10,10,22
Vm 11,11,22
Vm 12,12,22
Vm 13,13,22
Vm 14,14,22
Vm 15,15,22
Aw 8,8
Aw 9,9
Aw 10,10
Aw 11,11
Aw 12,12
Aw 13,13
Aw 14,14
Aw 15,15
Ar 8,16
Ar 9,17
Ar 10,18
Ar 11,19
Ar 12,20
Ar 13,21
Ar 14,22
Ar 15,23
Vm 8,8,22
Vm 9,9,22
Vm 10,10,22
Vm 11,11,22
Vm 12,12,22
Vm 13,13,22
Vm 14,14,22
Vm 15,15,22
Aw 16,8
Aw 17,9
Aw 18,10
Aw 19,11
Aw 20,12
Aw 21,13
Aw 22,14
Aw 23,15
Ar 8,24
Ar 9,25
Ar 10,26
Ar 11,27
Ar 12,28
Ar 13,29
Ar 14,30
Ar 15,31
Vm 8,8,22
Vm 9,9,22
Vm 10,10,22
Vm 11,11,22
Vm 12,12,22
Vm 13,13,22
Vm 14,14,22
Vm 15,15,22
Aw 24,8
Aw 25,9
Aw 26,10
Aw 27,11
Aw 28,12
Aw 29,13
Aw 30,14
Aw 31,15
Ve 8,192
Ve 9,193
s_nop 0
Vc 96,8,9
Ve 8,194
Ve 9,195
s_nop 0
Vc 97,8,9
Ve 8,196
Ve 9,197
s_nop 0
Vc 98,8,9
Ve 8,198
Ve 9,199
s_nop 0
Vc 99,8,9
Ve 8,200
Ve 9,201
s_nop 0
Vc 100,8,9
Ve 8,202
Ve 9,203
s_nop 0
Vc 101,8,9
Ve 8,204
Ve 9,205
s_nop 0
Vc 102,8,9
Ve 8,206
Ve 9,207
s_nop 0
Vc 103,8,9
s_nop 1
s_branch L_k2_fbr_fi
L_spinX:
s_mov_b32 s47, 0x400000
L_spinXl:
buffer_load_dword v17, v126, s[20:23], s24 offen sc1
s_sub_u32 s47, s47, 1
s_waitcnt vmcnt(0)
s_cmp_eq_u32 s47, 0
s_cbranch_scc1 L_spinXlx
v_cmp_ne_u32 vcc, 1, v17
s_cbranch_vccz L_spinXlx
s_sleep 1
s_branch L_spinXl
L_spinXlx:
buffer_load_dwordx4 v[160:163], v112, s[16:19], s25 offen offset:0 sc1
buffer_load_dwordx4 v[164:167], v112, s[16:19], s25 offen offset:1024 sc1
buffer_load_dwordx4 v[168:171], v112, s[16:19], s25 offen offset:2048 sc1
buffer_load_dwordx4 v[172:175], v112, s[16:19], s25 offen offset:3072 sc1
buffer_load_dwordx4 v[176:179], v10, s[16:19], s25 offen offset:0 sc1
buffer_load_dwordx4 v[180:183], v10, s[16:19], s25 offen offset:1024 sc1
buffer_load_dwordx4 v[184:187], v10, s[16:19], s25 offen offset:2048 sc1
buffer_load_dwordx4 v[188:191], v10, s[16:19], s25 offen offset:3072 sc1
s_branch L_spinXr
L_ysl:
s_mov_b32 s47, 0x400000
L_ysll:
buffer_load_dword v124, v127, s[20:23], s41 offen sc1
s_sub_u32 s47, s47, 1
s_waitcnt vmcnt(0)
s_cmp_eq_u32 s47, 0
s_cbranch_scc1 L_ysllx
v_cmp_ne_u32 vcc, 1, v124
s_cbranch_vccz L_ysllx
s_sleep 8
s_branch L_ysll
L_ysllx:
v_lshlrev_b32 v124, 2, v0
v_lshlrev_b32 v125, 1, v0
s_lshl_b32 s7, s45, 2
s_add_u32 s7, s7, s32
s_lshr_b32 s3, s42, 5
s_cmp_lg_u32 s3, s7
s_cbranch_scc1 L_f_yl13
s_add_u32 s3, s55, 0
s_nop 0
s_add_u32 s7, s3, 4096
buffer_load_dword v76, v124, s[20:23], s3 offen offset:0 sc1
buffer_load_dword v77, v124, s[20:23], s3 offen offset:512 sc1
buffer_load_dword v78, v124, s[20:23], s3 offen offset:1024 sc1
buffer_load_dword v79, v124, s[20:23], s3 offen offset:1536 sc1
buffer_load_dword v80, v124, s[20:23], s3 offen offset:2048 sc1
buffer_load_dword v81, v124, s[20:23], s3 offen offset:2560 sc1
buffer_load_dword v82, v124, s[20:23], s3 offen offset:3072 sc1
buffer_load_dword v83, v124, s[20:23], s3 offen offset:3584 sc1
buffer_load_dword v84, v124, s[20:23], s7 offen offset:0 sc1
buffer_load_dword v85, v124, s[20:23], s7 offen offset:512 sc1
buffer_load_dword v86, v124, s[20:23], s7 offen offset:1024 sc1
buffer_load_dword v87, v124, s[20:23], s7 offen offset:1536 sc1
buffer_load_dword v88, v124, s[20:23], s7 offen offset:2048 sc1
buffer_load_dword v89, v124, s[20:23], s7 offen offset:2560 sc1
s_lshl_b32 s3, s42, 11
s_lshl_b32 s7, s46, 7
s_add_u32 s3, s3, s7
buffer_load_ushort v90, v125, s[56:59], s3 offen
s_lshl_b32 s3, s42, 3
s_add_u32 s3, s3, 5259264
buffer_load_dwordx2 v[92:93], v126, s[20:23], s3 offen sc1
L_f_yl13:
s_lshl_b32 s7, s45, 2
s_add_u32 s7, s7, s32
s_lshr_b32 s3, s43, 5
s_cmp_lg_u32 s3, s7
s_cbranch_scc1 L_f_yl14
s_nop 0
s_add_u32 s3, s55, 256
s_add_u32 s7, s3, 4096
buffer_load_dword v94, v124, s[20:23], s3 offen offset:0 sc1
buffer_load_dword v95, v124, s[20:23], s3 offen offset:512 sc1
buffer_load_dword v96, v124, s[20:23], s3 offen offset:1024 sc1
buffer_load_dword v97, v124, s[20:23], s3 offen offset:1536 sc1
buffer_load_dword v98, v124, s[20:23], s3 offen offset:2048 sc1
buffer_load_dword v99, v124, s[20:23], s3 offen offset:2560 sc1
buffer_load_dword v100, v124, s[20:23], s3 offen offset:3072 sc1
buffer_load_dword v101, v124, s[20:23], s3 offen offset:3584 sc1
buffer_load_dword v102, v124, s[20:23], s7 offen offset:0 sc1
buffer_load_dword v103, v124, s[20:23], s7 offen offset:512 sc1
buffer_load_dword v104, v124, s[20:23], s7 offen offset:1024 sc1
buffer_load_dword v105, v124, s[20:23], s7 offen offset:1536 sc1
buffer_load_dword v106, v124, s[20:23], s7 offen offset:2048 sc1
buffer_load_dword v107, v124, s[20:23], s7 offen offset:2560 sc1
s_lshl_b32 s3, s43, 11
s_lshl_b32 s7, s46, 7
s_add_u32 s3, s3, s7
buffer_load_ushort v108, v125, s[56:59], s3 offen
s_lshl_b32 s3, s43, 3
s_add_u32 s3, s3, 5259264
buffer_load_dwordx2 v[110:111], v126, s[20:23], s3 offen sc1
L_f_yl14:
s_waitcnt vmcnt(0)
s_lshl_b32 s7, s45, 2
s_add_u32 s7, s7, s32
s_lshr_b32 s3, s42, 5
s_cmp_lg_u32 s3, s7
s_cbranch_scc1 L_f_ys15
v_pk_add_f32 v[76:77], v[76:77], v[78:79]
v_pk_add_f32 v[76:77], v[76:77], v[80:81]
v_pk_add_f32 v[76:77], v[76:77], v[82:83]
v_pk_add_f32 v[76:77], v[76:77], v[84:85]
v_pk_add_f32 v[76:77], v[76:77], v[86:87]
v_pk_add_f32 v[76:77], v[76:77], v[88:89]
Va 76,76,77
v_lshlrev_b32 v90, 16, v90
v_sub_f32_e64 v90, v90, v92
Vc 76,76,76
v_lshlrev_b32_e64 v76, 16, v76
Vc 90,90,90
v_lshlrev_b32 v90, 16, v90
v_mul_f32 v76, s100, v76
v_mul_f32_e64 v90, v90, v93
Vc 76,76,76
v_lshlrev_b32_e64 v76, 16, v76
Vc 90,90,90
v_lshlrev_b32 v90, 16, v90
Va 90,90,76
Vc 90,90,90
v_lshlrev_b32_e64 v90, 16, v90
v_mul_f32 v76, 0xbfb8aa3b, v90
Ve 76,76
s_nop 0
v_add_f32 v76, 1.0, v76
v_rcp_f32 v76, v76
s_nop 0
Vm 90,90,76
Vc 90,90,90
v_lshlrev_b32 v90, 16, v90
v_lshlrev_b32 v124, 2, v0
v_add_u32 v124, s35, v124
v_lshlrev_b32 v125, 5, v122
v_add_u32 v125, s35, v125
s_waitcnt lgkmcnt(0)
ds_write_b32 v124, v90
s_and_b32 s3, s42, 7
s_lshl_b32 s3, s3, 3
s_lshl_b64 s[4:5], 0xff, s3
s_bfe_u32 s3, s42, 0x20003
s_mov_b64 exec, s[4:5]
s_cmp_lg_u32 s3, 0
s_cbranch_scc1 L_f_yp16
ds_read_b64 v[42:43], v125
ds_read_b64 v[44:45], v125 offset:8
ds_read_b64 v[46:47], v125 offset:16
ds_read_b64 v[48:49], v125 offset:24
L_f_yp16:
s_cmp_lg_u32 s3, 1
s_cbranch_scc1 L_f_yp17
ds_read_b64 v[50:51], v125
ds_read_b64 v[52:53], v125 offset:8
ds_read_b64 v[54:55], v125 offset:16
ds_read_b64 v[56:57], v125 offset:24
L_f_yp17:
s_cmp_lg_u32 s3, 2
s_cbranch_scc1 L_f_yp18
ds_read_b64 v[58:59], v125
ds_read_b64 v[60:61], v125 offset:8
ds_read_b64 v[62:63], v125 offset:16
ds_read_b64 v[64:65], v125 offset:24
L_f_yp18:
s_cmp_lg_u32 s3, 3
s_cbranch_scc1 L_f_yp19
ds_read_b64 v[66:67], v125
ds_read_b64 v[68:69], v125 offset:8
s_waitcnt lgkmcnt(9)
ds_read_b64 v[70:71], v125 offset:16
ds_read_b64 v[72:73], v125 offset:24
L_f_yp19:
s_mov_b64 exec, -1
s_waitcnt lgkmcnt(0)
L_f_ys15:
s_lshl_b32 s7, s45, 2
s_add_u32 s7, s7, s32
s_lshr_b32 s3, s43, 5
s_cmp_lg_u32 s3, s7
s_cbranch_scc1 L_f_ys20
s_nop 0
v_pk_add_f32 v[94:95], v[94:95], v[96:97]
v_pk_add_f32 v[94:95], v[94:95], v[98:99]
v_pk_add_f32 v[94:95], v[94:95], v[100:101]
v_pk_add_f32 v[94:95], v[94:95], v[102:103]
v_pk_add_f32 v[94:95], v[94:95], v[104:105]
v_pk_add_f32 v[94:95], v[94:95], v[106:107]
Va 94,94,95
v_lshlrev_b32 v108, 16, v108
v_sub_f32_e64 v108, v108, v110
Vc 94,94,94
v_lshlrev_b32_e64 v94, 16, v94
Vc 108,108,108
v_lshlrev_b32 v108, 16, v108
v_mul_f32 v94, s101, v94
v_mul_f32_e64 v108, v108, v111
Vc 94,94,94
v_lshlrev_b32_e64 v94, 16, v94
Vc 108,108,108
v_lshlrev_b32 v108, 16, v108
Va 108,108,94
Vc 108,108,108
v_lshlrev_b32_e64 v108, 16, v108
v_mul_f32 v94, 0xbfb8aa3b, v108
Ve 94,94
s_nop 0
v_add_f32 v94, 1.0, v94
v_rcp_f32 v94, v94
s_nop 0
Vm 108,108,94
Vc 108,108,108
v_lshlrev_b32 v108, 16, v108
v_lshlrev_b32 v124, 2, v0
v_add_u32 v124, s35, v124
v_lshlrev_b32 v125, 5, v122
v_add_u32 v125, s35, v125
s_waitcnt lgkmcnt(0)
ds_write_b32 v124, v108
s_and_b32 s3, s43, 7
s_lshl_b32 s3, s3, 3
s_lshl_b64 s[4:5], 0xff, s3
s_bfe_u32 s3, s43, 0x20003
s_mov_b64 exec, s[4:5]
s_cmp_lg_u32 s3, 0
s_cbranch_scc1 L_f_yp21
ds_read_b64 v[42:43], v125
ds_read_b64 v[44:45], v125 offset:8
ds_read_b64 v[46:47], v125 offset:16
ds_read_b64 v[48:49], v125 offset:24
L_f_yp21:
s_cmp_lg_u32 s3, 1
s_cbranch_scc1 L_f_yp22
ds_read_b64 v[50:51], v125
ds_read_b64 v[52:53], v125 offset:8
ds_read_b64 v[54:55], v125 offset:16
ds_read_b64 v[56:57], v125 offset:24
L_f_yp22:
s_cmp_lg_u32 s3, 2
s_cbranch_scc1 L_f_yp23
ds_read_b64 v[58:59], v125
ds_read_b64 v[60:61], v125 offset:8
ds_read_b64 v[62:63], v125 offset:16
ds_read_b64 v[64:65], v125 offset:24
L_f_yp23:
s_cmp_lg_u32 s3, 3
s_cbranch_scc1 L_f_yp24
ds_read_b64 v[66:67], v125
ds_read_b64 v[68:69], v125 offset:8
s_waitcnt lgkmcnt(9)
ds_read_b64 v[70:71], v125 offset:16
ds_read_b64 v[72:73], v125 offset:24
L_f_yp24:
s_mov_b64 exec, -1
s_waitcnt lgkmcnt(0)
L_f_ys20:
s_branch L_yslr
.section .rodata,"a"
.p2align 6
.amdhsa_kernel recurrent_scan__compressed_kv_cla__moe_arch_mod__prompt_kernel
  .amdhsa_next_free_vgpr 512
  .amdhsa_next_free_sgpr 102
  .amdhsa_accum_offset 256
  .amdhsa_group_segment_fixed_size 0
  .amdhsa_kernarg_size 112
  .amdhsa_user_sgpr_count 2
  .amdhsa_user_sgpr_kernarg_segment_ptr 1
  .amdhsa_system_sgpr_workgroup_id_x 1
.end_amdhsa_kernel
```

```asm
; @launch grid=(256,1,1) block=(256,1,1) lds=163840
.amdgcn_target "amdgcn-amd-amdhsa--gfx950"
.macro Va d,x,y
v_add_f32 v\d, v\x, v\y
.endm
.macro Vc d,x,y
v_cvt_pk_bf16_f32 v\d, v\x, v\y
.endm
.macro Ta d,x,o
ds_read_b64_tr_b16 a[\d:\d+1], v\x offset:\o
.endm
.macro Ra d,x,o
ds_read_b128 a[\d:\d+3], v\x offset:\o
.endm
.macro Zvaa d,x,y
v_mfma_f32_16x16x32_bf16 v[\d:\d+3], a[\x:\x+3], a[\y:\y+3], 0
.endm
.macro Rv d,x,o
ds_read_b128 v[\d:\d+3], v\x offset:\o
.endm
.macro Zaaa d,x,y
v_mfma_f32_16x16x32_bf16 a[\d:\d+3], a[\x:\x+3], a[\y:\y+3], 0
.endm
.macro Mvaa d,x,y
v_mfma_f32_16x16x32_bf16 v[\d:\d+3], a[\x:\x+3], a[\y:\y+3], v[\d:\d+3]
.endm
.macro Maaa d,x,y
v_mfma_f32_16x16x32_bf16 a[\d:\d+3], a[\x:\x+3], a[\y:\y+3], a[\d:\d+3]
.endm
.macro Ar d,x
v_accvgpr_read_b32 v\d, a\x
.endm
.macro VE d,x
v_exp_f32_e64 v\d, v\x
.endm
.macro Aw d,x
v_accvgpr_write_b32 a\d, v\x
.endm
.macro Vs d,x,y
v_sub_f32 v\d, v\x, v\y
.endm
.macro Ve d,x
v_exp_f32 v\d, v\x
.endm
.macro Cvaa d,x,y,c
v_mfma_f32_16x16x32_bf16 v[\d:\d+3], a[\x:\x+3], a[\y:\y+3], v[\c:\c+3]
.endm
.macro Maav d,x,y
v_mfma_f32_16x16x32_bf16 a[\d:\d+3], a[\x:\x+3], v[\y:\y+3], a[\d:\d+3]
.endm
.macro Mvvv d,x,y
v_mfma_f32_16x16x32_bf16 v[\d:\d+3], v[\x:\x+3], v[\y:\y+3], v[\d:\d+3]
.endm
.macro Zvva d,x,y
v_mfma_f32_16x16x32_bf16 v[\d:\d+3], v[\x:\x+3], a[\y:\y+3], 0
.endm
.macro Mvva d,x,y
v_mfma_f32_16x16x32_bf16 v[\d:\d+3], v[\x:\x+3], a[\y:\y+3], v[\d:\d+3]
.endm
.macro Vm d,x,y
v_mul_f32 v\d, v\x, v\y
.endm
.macro Zvvv d,x,y
v_mfma_f32_16x16x32_bf16 v[\d:\d+3], v[\x:\x+3], v[\y:\y+3], 0
.endm
.text
.globl recurrent_scan__compressed_kv_cla__moe_arch_mod__prompt_kernel
.p2align 8
.type recurrent_scan__compressed_kv_cla__moe_arch_mod__prompt_kernel,@function
recurrent_scan__compressed_kv_cla__moe_arch_mod__prompt_kernel:
s_cmp_ge_u32 s2, 256
s_cbranch_scc1 L_k2_end
s_load_dwordx4 s[4:7], s[0:1], 0
s_load_dwordx2 s[44:45], s[0:1], 56
s_load_dwordx4 s[40:43], s[0:1], 24
s_load_dwordx4 s[64:67], s[0:1], 96
v_lshrrev_b32 v1, 6, v0
v_and_b32 v0, 63, v0
v_readfirstlane_b32 s32, v1
s_getpc_b64 s[68:69]
L_cpf1:
s_add_u32 s68, s68, (recurrent_scan__compressed_kv_cla__moe_arch_mod__prompt_kernel-L_cpf1)&0xffffffff
s_addc_u32 s69, s69, ((recurrent_scan__compressed_kv_cla__moe_arch_mod__prompt_kernel-L_cpf1)>>32)&0xffffffff
s_lshr_b32 s70, s2, 3
s_lshl_b32 s70, s70, 2
s_add_u32 s70, s70, s32
s_lshl_b32 s70, s70, 10
v_and_b32 v122, 7, v0
v_lshlrev_b32 v122, 7, v122
v_add_u32 v122, s70, v122
v_min_u32 v122, L_k2_fin-recurrent_scan__compressed_kv_cla__moe_arch_mod__prompt_kernel-4, v122
v_mov_b32 v121, s69
v_add_co_u32 v120, vcc, s68, v122
s_nop 1
v_addc_co_u32 v121, vcc, 0, v121, vcc
global_load_dword v124, v[120:121], off
v_lshrrev_b32 v33, 5, v0
v_and_b32 v31, 31, v0
v_lshlrev_b32_e64 v36, 4, v31
v_lshl_add_u32 v35, v33, 11, v36
s_lshl_b32 s36, s2, 14
s_lshl_b32 s37, s32, 12
s_add_u32 s36, s36, s37
s_mov_b32 s18, 4194304
s_mov_b32 s19, 0x20000
s_bfe_u32 s33, s2, 0x30003
s_lshr_b32 s35, s2, 7
s_bfe_u32 s3, s2, 0x10006
s_and_b32 s34, s2, 7
s_lshl_b32 s34, s34, 1
s_add_u32 s34, s34, s3
s_waitcnt lgkmcnt(0)
s_mov_b32 s16, s4
s_and_b32 s17, s5, 0xffff
buffer_load_dwordx4 v[48:51], v35, s[16:19], s36 offen offset:0 nt
buffer_load_dwordx4 v[52:55], v35, s[16:19], s36 offen offset:512 nt
buffer_load_dwordx4 v[56:59], v35, s[16:19], s36 offen offset:1024 nt
buffer_load_dwordx4 v[60:63], v35, s[16:19], s36 offen offset:1536 nt
s_cmp_eq_u32 s35, 0
s_cselect_b32 s40, s40, s42
s_cselect_b32 s41, s41, s43
s_lshl_b32 s3, s34, 9
s_add_u32 s12, s40, s3
s_addc_u32 s13, s41, 0
s_and_b32 s13, s13, 0xffff
s_mov_b32 s14, 0
s_mov_b32 s15, 0x20000
s_sub_u32 s14, 4194304, s3
s_lshl_b32 s3, s33, 18
s_add_u32 s8, s6, s3
s_addc_u32 s9, s7, 0
s_and_b32 s9, s9, 0xffff
s_mov_b32 s10, 262144
s_mov_b32 s11, 0x20000
s_and_b32 s58, s2, 7
s_mov_b32 s52, 0
s_mov_b32 s53, 15360
s_mov_b32 s54, 30720
s_mov_b32 s55, 46080
s_lshl_b32 s56, s32, 13
s_add_u32 s57, s56, 32768
s_lshl_b32 s3, s58, 2
s_add_u32 s3, s3, s32
s_lshl_b32 s3, s3, 4
v_add_u32 v30, s3, v33
v_lshlrev_b32 v30, 13, v30
v_lshlrev_b32 v34, 5, v33
v_xor_b32 v34, v34, v36
v_add_u32 v6, v34, v30
v_xor_b32_e64 v7, 64, v6
v_xor_b32 v8, 65664, v6
v_xor_b32 v9, 65728, v6
s_add_u32 m0, s57, 0
s_nop 0
buffer_load_dwordx4 v6, s[12:15], s52 offen offset:0 nt lds
buffer_load_dwordx4 v7, s[12:15], s53 offen offset:1024 nt lds
buffer_load_dwordx4 v6, s[12:15], s54 offen offset:2048 nt lds
buffer_load_dwordx4 v7, s[12:15], s55 offen offset:3072 nt lds
s_add_u32 m0, s57, 4096
s_nop 0
s_nop 0
buffer_load_dwordx4 v8, s[12:15], s52 offen offset:0 nt lds
buffer_load_dwordx4 v9, s[12:15], s53 offen offset:1024 nt lds
buffer_load_dwordx4 v8, s[12:15], s54 offen offset:2048 nt lds
buffer_load_dwordx4 v9, s[12:15], s55 offen offset:3072 nt lds
v_xor_b32 v6, 524288, v6
v_xor_b32 v7, 524288, v7
v_xor_b32 v8, 524288, v8
v_xor_b32 v9, 524288, v9
s_mov_b32 s48, 0
s_mov_b32 s49, 7168
s_mov_b32 s50, 14336
s_mov_b32 s51, 21504
v_lshrrev_b32 v30, 3, v0
v_lshlrev_b32 v30, 10, v30
s_lshl_b32 s3, s32, 16
s_lshl_b32 s39, s58, 7
s_add_u32 s3, s3, s39
v_and_b32 v31, 7, v0
v_lshrrev_b32 v32, 4, v0
v_xor_b32_e64 v31, v31, v32
v_lshl_add_u32 v30, v31, 4, v30
v_add_u32 v2, s3, v30
v_xor_b32 v3, 64, v2
v_xor_b32 v4, 32768, v2
v_xor_b32 v5, 32832, v2
s_cmp_lt_u32 s32, 2
s_cselect_b32 s60, s8, s12
s_cselect_b32 s61, s9, s13
s_cselect_b32 s62, s10, s14
s_mov_b32 s63, 0x20000
s_mov_b32 s59, 524288
s_cselect_b32 s59, 128, s59
s_cselect_b64 vcc, -1, 0
s_cselect_b32 s38, 32, 16
s_lshr_b32 s3, s2, 6
s_cmp_lt_u32 s32, 2
s_cselect_b32 s3, s3, s33
s_lshl_b32 s3, s3, 1
s_and_b32 s39, s32, 1
s_add_u32 s3, s3, s39
s_lshl_b32 s3, s3, 15
s_xor_b32 s39, s58, 1
s_mul_i32 s39, s39, s59
s_add_u32 s3, s3, s39
v_lshlrev_b32 v37, 10, v0
v_lshrrev_b32 v38, 2, v0
v_lshlrev_b32 v38, 13, v38
v_and_b32 v39, 3, v0
v_lshl_add_u32 v38, v39, 7, v38
v_cndmask_b32 v47, v38, v37, vcc
v_add_u32 v47, s3, v47
v_cmp_gt_u32 vcc, s38, v0
v_mov_b32 v37, 2146435072
s_nop 0
v_cndmask_b32 v47, v37, v47, vcc
s_mov_b32 s20, s66
s_and_b32 s21, s67, 0xffff
s_mov_b32 s22, 8388608
s_mov_b32 s23, 0x20000
s_add_u32 s24, s66, 8388608
s_addc_u32 s25, s67, 0
s_and_b32 s25, s25, 0xffff
s_mov_b32 s26, 35717120
s_mov_b32 s27, 0x20000
v_lshrrev_b32 v32, 4, v0
v_and_b32 v30, 15, v0
s_lshr_b32 s3, s32, 1
s_lshl_b32 s3, s3, 14
v_lshlrev_b32 v31, 7, v30
v_add_u32 v31, s3, v31
v_lshrrev_b32 v34, 1, v30
v_xor_b32_e64 v34, v34, v32
v_lshl_add_u32 v10, v34, 4, v31
v_xor_b32 v11, 64, v10
v_lshrrev_b32 v30, 2, v30
v_lshl_add_u32 v31, v32, 3, v30
v_lshlrev_b32 v31, 9, v31
v_and_b32 v34, 3, v0
v_lshl_add_u32 v31, v34, 3, v31
s_and_b32 s3, s32, 1
s_lshl_b32 s3, s3, 8
s_add_u32 s3, s3, 32768
v_add_u32 v31, s3, v31
v_and_b32 v34, 1, v32
v_lshl_add_u32 v30, v34, 2, v30
v_lshl_add_u32 v12, v30, 5, v31
v_xor_b32 v13, 32, v12
v_xor_b32 v14, 64, v12
v_xor_b32 v15, 96, v12
v_xor_b32 v16, 128, v12
v_xor_b32 v17, 160, v12
v_xor_b32 v18, 192, v12
v_xor_b32 v19, 224, v12
v_add_u32 v20, 65536, v10
v_add_u32 v21, 65536, v11
v_add_u32 v22, 65536, v12
v_add_u32 v23, 65536, v13
v_add_u32 v24, 65536, v14
v_add_u32 v25, 65536, v15
v_add_u32 v26, 65536, v16
v_add_u32 v27, 65536, v17
v_add_u32 v28, 65536, v18
v_add_u32 v29, 65536, v19
s_mov_b32 s28, s44
s_nop 0
s_and_b32 s29, s45, 0xffff
s_mov_b32 s30, 2048
s_mov_b32 s31, 0x20000
buffer_load_dwordx4 v[64:67], v36, s[28:31], 0 offen offset:0
buffer_load_dwordx4 v[68:71], v36, s[28:31], 0 offen offset:512
buffer_load_dwordx4 v[72:75], v36, s[28:31], 0 offen offset:1024
buffer_load_dwordx4 v[76:79], v36, s[28:31], 0 offen offset:1536
s_waitcnt vmcnt(12)
v_lshlrev_b32 v80, 16, v48
v_and_b32 v81, 0xffff0000, v48
v_lshlrev_b32_e64 v82, 16, v49
v_and_b32 v83, 0xffff0000, v49
v_lshlrev_b32_e64 v84, 16, v50
v_and_b32 v85, 0xffff0000, v50
v_lshlrev_b32_e64 v86, 16, v51
v_and_b32 v87, 0xffff0000, v51
v_lshlrev_b32_e64 v88, 16, v52
v_and_b32 v89, 0xffff0000, v52
v_lshlrev_b32_e64 v90, 16, v53
v_and_b32 v91, 0xffff0000, v53
v_lshlrev_b32_e64 v92, 16, v54
v_and_b32 v93, 0xffff0000, v54
v_lshlrev_b32_e64 v94, 16, v55
v_and_b32 v95, 0xffff0000, v55
v_lshlrev_b32_e64 v96, 16, v56
v_and_b32 v97, 0xffff0000, v56
v_lshlrev_b32_e64 v98, 16, v57
v_and_b32 v99, 0xffff0000, v57
v_lshlrev_b32_e64 v100, 16, v58
v_and_b32 v101, 0xffff0000, v58
v_lshlrev_b32_e64 v102, 16, v59
v_and_b32 v103, 0xffff0000, v59
v_lshlrev_b32_e64 v104, 16, v60
v_and_b32 v105, 0xffff0000, v60
v_lshlrev_b32_e64 v106, 16, v61
v_and_b32 v107, 0xffff0000, v61
v_lshlrev_b32_e64 v108, 16, v62
v_and_b32 v109, 0xffff0000, v62
v_lshlrev_b32_e64 v110, 16, v63
v_and_b32 v111, 0xffff0000, v63
v_pk_add_f32 v[40:41], v[80:81], v[82:83]
v_pk_add_f32 v[42:43], v[84:85], v[86:87]
v_pk_add_f32 v[40:41], v[40:41], v[88:89]
v_pk_add_f32 v[42:43], v[42:43], v[90:91]
v_pk_add_f32 v[40:41], v[40:41], v[92:93]
v_pk_add_f32 v[42:43], v[42:43], v[94:95]
v_pk_add_f32 v[40:41], v[40:41], v[96:97]
v_pk_add_f32 v[42:43], v[42:43], v[98:99]
v_pk_add_f32 v[40:41], v[40:41], v[100:101]
v_pk_add_f32 v[42:43], v[42:43], v[102:103]
v_pk_add_f32 v[40:41], v[40:41], v[104:105]
v_pk_add_f32 v[42:43], v[42:43], v[106:107]
v_pk_add_f32 v[40:41], v[40:41], v[108:109]
v_pk_add_f32 v[42:43], v[42:43], v[110:111]
v_pk_add_f32 v[40:41], v[40:41], v[42:43]
Va 38,40,41
s_nop 1
v_add_f32_dpp v38, v38, v38 quad_perm:[1,0,3,2] row_mask:0xf bank_mask:0xf
s_nop 1
v_add_f32_dpp v38, v38, v38 quad_perm:[2,3,0,1] row_mask:0xf bank_mask:0xf
s_nop 1
v_add_f32_dpp v38, v38, v38 row_half_mirror row_mask:0xf bank_mask:0xf
s_nop 1
v_add_f32_dpp v38, v38, v38 row_mirror row_mask:0xf bank_mask:0xf
v_mov_b32 v37, v38
s_nop 1
v_permlane16_swap_b32 v37, v38
Va 38,38,37
s_add_u32 m0, s56, 0
s_nop 0
buffer_load_dwordx4 v2, s[8:11], s48 offen offset:0 lds
buffer_load_dwordx4 v3, s[8:11], s49 offen offset:1024 lds
buffer_load_dwordx4 v2, s[8:11], s50 offen offset:2048 lds
buffer_load_dwordx4 v3, s[8:11], s51 offen offset:3072 lds
s_add_u32 m0, s56, 4096
s_nop 0
buffer_load_dwordx4 v4, s[8:11], s48 offen offset:0 lds
buffer_load_dwordx4 v5, s[8:11], s49 offen offset:1024 lds
buffer_load_dwordx4 v4, s[8:11], s50 offen offset:2048 lds
buffer_load_dwordx4 v5, s[8:11], s51 offen offset:3072 lds
v_xor_b32 v2, 128, v2
v_xor_b32 v3, 128, v3
v_xor_b32 v4, 128, v4
v_xor_b32 v5, 128, v5
buffer_load_dword v1, v47, s[60:63], 0 offen
s_mul_i32 vcc_lo, s59, 3
v_xor_b32 v47, vcc_lo, v47
v_mul_f32 v38, 0xba800000, v38
v_mov_b32_e64 v39, v38
v_pk_add_f32 v[112:113], v[80:81], v[38:39]
v_pk_mul_f32 v[40:41], v[112:113], v[112:113]
v_pk_add_f32 v[114:115], v[82:83], v[38:39]
v_pk_mul_f32 v[42:43], v[114:115], v[114:115]
v_pk_add_f32 v[116:117], v[84:85], v[38:39]
v_pk_fma_f32 v[40:41], v[116:117], v[116:117], v[40:41]
v_pk_add_f32 v[118:119], v[86:87], v[38:39]
v_pk_fma_f32 v[42:43], v[118:119], v[118:119], v[42:43]
v_pk_add_f32 v[112:113], v[88:89], v[38:39]
v_pk_fma_f32 v[40:41], v[112:113], v[112:113], v[40:41]
v_pk_add_f32 v[114:115], v[90:91], v[38:39]
v_pk_fma_f32 v[42:43], v[114:115], v[114:115], v[42:43]
v_pk_add_f32 v[116:117], v[92:93], v[38:39]
v_pk_fma_f32 v[40:41], v[116:117], v[116:117], v[40:41]
v_pk_add_f32 v[118:119], v[94:95], v[38:39]
v_pk_fma_f32 v[42:43], v[118:119], v[118:119], v[42:43]
v_pk_add_f32 v[112:113], v[96:97], v[38:39]
v_pk_fma_f32 v[40:41], v[112:113], v[112:113], v[40:41]
v_pk_add_f32 v[114:115], v[98:99], v[38:39]
v_pk_fma_f32 v[42:43], v[114:115], v[114:115], v[42:43]
v_pk_add_f32 v[116:117], v[100:101], v[38:39]
v_pk_fma_f32 v[40:41], v[116:117], v[116:117], v[40:41]
v_pk_add_f32 v[118:119], v[102:103], v[38:39]
v_pk_fma_f32 v[42:43], v[118:119], v[118:119], v[42:43]
v_pk_add_f32 v[112:113], v[104:105], v[38:39]
v_pk_fma_f32 v[40:41], v[112:113], v[112:113], v[40:41]
v_pk_add_f32 v[114:115], v[106:107], v[38:39]
v_pk_fma_f32 v[42:43], v[114:115], v[114:115], v[42:43]
v_pk_add_f32 v[116:117], v[108:109], v[38:39]
v_pk_fma_f32 v[40:41], v[116:117], v[116:117], v[40:41]
v_pk_add_f32 v[118:119], v[110:111], v[38:39]
v_pk_fma_f32 v[42:43], v[118:119], v[118:119], v[42:43]
v_pk_add_f32 v[40:41], v[40:41], v[42:43]
Va 40,40,41
s_nop 1
v_add_f32_dpp v40, v40, v40 quad_perm:[1,0,3,2] row_mask:0xf bank_mask:0xf
s_nop 1
v_add_f32_dpp v40, v40, v40 quad_perm:[2,3,0,1] row_mask:0xf bank_mask:0xf
s_nop 1
v_add_f32_dpp v40, v40, v40 row_half_mirror row_mask:0xf bank_mask:0xf
s_nop 1
v_add_f32_dpp v40, v40, v40 row_mirror row_mask:0xf bank_mask:0xf
v_mov_b32 v37, v40
s_nop 1
v_permlane16_swap_b32 v37, v40
v_add_f32_e64 v40, v40, v37
buffer_load_dword v1, v47, s[60:63], 0 offen
s_mul_i32 vcc_lo, s59, 1
v_xor_b32 v47, vcc_lo, v47
v_mul_f32 v40, 0x3a800000, v40
Vc 44,38,40
v_lshlrev_b32_e64 v38, 16, v44
v_and_b32 v40, 0xffff0000, v44
v_add_f32 v40, 0x3727c5ac, v40
Vc 44,40,40
v_lshlrev_b32 v40, 16, v44
v_sqrt_f32 v40, v40
v_mov_b32_e64 v39, v38
Vc 44,40,40
v_lshlrev_b32 v44, 16, v44
v_rcp_f32 v40, v44
v_pk_add_f32 v[80:81], v[80:81], v[38:39]
v_pk_add_f32 v[82:83], v[82:83], v[38:39]
v_pk_add_f32 v[84:85], v[84:85], v[38:39]
v_pk_add_f32 v[86:87], v[86:87], v[38:39]
v_pk_add_f32 v[88:89], v[88:89], v[38:39]
v_pk_add_f32 v[90:91], v[90:91], v[38:39]
v_pk_add_f32 v[92:93], v[92:93], v[38:39]
v_pk_add_f32 v[94:95], v[94:95], v[38:39]
v_pk_add_f32 v[96:97], v[96:97], v[38:39]
v_pk_add_f32 v[98:99], v[98:99], v[38:39]
v_pk_add_f32 v[100:101], v[100:101], v[38:39]
v_pk_add_f32 v[102:103], v[102:103], v[38:39]
v_pk_add_f32 v[104:105], v[104:105], v[38:39]
v_pk_add_f32 v[106:107], v[106:107], v[38:39]
v_pk_add_f32 v[108:109], v[108:109], v[38:39]
v_pk_add_f32 v[110:111], v[110:111], v[38:39]
v_fma_f32 v45, -v44, v40, 1.0
v_fma_f32 v40, v45, v40, v40
v_mov_b32_e64 v41, v40
Vc 48,80,81
Vc 49,82,83
Vc 50,84,85
Vc 51,86,87
Vc 52,88,89
Vc 53,90,91
Vc 54,92,93
Vc 55,94,95
Vc 56,96,97
Vc 57,98,99
Vc 58,100,101
Vc 59,102,103
Vc 60,104,105
Vc 61,106,107
Vc 62,108,109
Vc 63,110,111
v_lshlrev_b32_e64 v80, 16, v48
v_and_b32 v81, 0xffff0000, v48
v_lshlrev_b32_e64 v82, 16, v49
v_and_b32 v83, 0xffff0000, v49
v_lshlrev_b32_e64 v84, 16, v50
v_and_b32 v85, 0xffff0000, v50
v_lshlrev_b32_e64 v86, 16, v51
v_and_b32 v87, 0xffff0000, v51
v_lshlrev_b32_e64 v88, 16, v52
v_and_b32 v89, 0xffff0000, v52
v_lshlrev_b32_e64 v90, 16, v53
v_and_b32 v91, 0xffff0000, v53
v_lshlrev_b32_e64 v92, 16, v54
v_and_b32 v93, 0xffff0000, v54
v_lshlrev_b32_e64 v94, 16, v55
v_and_b32 v95, 0xffff0000, v55
v_lshlrev_b32_e64 v96, 16, v56
v_and_b32 v97, 0xffff0000, v56
v_lshlrev_b32_e64 v98, 16, v57
v_and_b32 v99, 0xffff0000, v57
v_lshlrev_b32_e64 v100, 16, v58
v_and_b32 v101, 0xffff0000, v58
v_lshlrev_b32_e64 v102, 16, v59
v_and_b32 v103, 0xffff0000, v59
v_lshlrev_b32_e64 v104, 16, v60
v_and_b32 v105, 0xffff0000, v60
v_lshlrev_b32_e64 v106, 16, v61
v_and_b32 v107, 0xffff0000, v61
v_lshlrev_b32_e64 v108, 16, v62
v_and_b32 v109, 0xffff0000, v62
v_lshlrev_b32_e64 v110, 16, v63
v_and_b32 v111, 0xffff0000, v63
v_pk_mul_f32 v[80:81], v[80:81], v[40:41]
v_pk_mul_f32 v[82:83], v[82:83], v[40:41]
v_pk_mul_f32 v[84:85], v[84:85], v[40:41]
v_pk_mul_f32 v[86:87], v[86:87], v[40:41]
v_pk_mul_f32 v[88:89], v[88:89], v[40:41]
v_pk_mul_f32 v[90:91], v[90:91], v[40:41]
v_pk_mul_f32 v[92:93], v[92:93], v[40:41]
v_pk_mul_f32 v[94:95], v[94:95], v[40:41]
v_pk_mul_f32 v[96:97], v[96:97], v[40:41]
v_pk_mul_f32 v[98:99], v[98:99], v[40:41]
v_pk_mul_f32 v[100:101], v[100:101], v[40:41]
v_pk_mul_f32 v[102:103], v[102:103], v[40:41]
v_pk_mul_f32 v[104:105], v[104:105], v[40:41]
v_pk_mul_f32 v[106:107], v[106:107], v[40:41]
v_pk_mul_f32 v[108:109], v[108:109], v[40:41]
v_pk_mul_f32 v[110:111], v[110:111], v[40:41]
Vc 48,80,81
Vc 49,82,83
Vc 50,84,85
Vc 51,86,87
Vc 52,88,89
Vc 53,90,91
Vc 54,92,93
Vc 55,94,95
Vc 56,96,97
Vc 57,98,99
Vc 58,100,101
Vc 59,102,103
Vc 60,104,105
Vc 61,106,107
Vc 62,108,109
Vc 63,110,111
s_mul_i32 s3, s32, 4128
s_add_u32 s3, s3, 131072
v_mul_u32_u24 v42, 2064, v33
v_add3_u32 v42, v42, v36, s3
ds_write_b128 v42, v[48:51] offset:0
ds_write_b128 v42, v[52:55] offset:512
ds_write_b128 v42, v[56:59] offset:1024
ds_write_b128 v42, v[60:63] offset:1536
s_waitcnt vmcnt(10)
v_lshlrev_b32 v80, 16, v48
v_and_b32 v81, 0xffff0000, v48
v_lshlrev_b32_e64 v112, 16, v64
v_and_b32 v113, 0xffff0000, v64
v_pk_mul_f32 v[42:43], v[80:81], v[112:113]
v_lshlrev_b32_e64 v82, 16, v49
v_and_b32 v83, 0xffff0000, v49
v_lshlrev_b32_e64 v114, 16, v65
v_and_b32 v115, 0xffff0000, v65
v_pk_mul_f32 v[44:45], v[82:83], v[114:115]
v_lshlrev_b32_e64 v84, 16, v50
v_and_b32 v85, 0xffff0000, v50
v_lshlrev_b32_e64 v116, 16, v66
v_and_b32 v117, 0xffff0000, v66
v_pk_fma_f32 v[42:43], v[84:85], v[116:117], v[42:43]
v_lshlrev_b32_e64 v86, 16, v51
v_and_b32 v87, 0xffff0000, v51
v_lshlrev_b32_e64 v118, 16, v67
v_and_b32 v119, 0xffff0000, v67
v_pk_fma_f32 v[44:45], v[86:87], v[118:119], v[44:45]
v_lshlrev_b32_e64 v88, 16, v52
v_and_b32 v89, 0xffff0000, v52
v_lshlrev_b32_e64 v112, 16, v68
v_and_b32 v113, 0xffff0000, v68
v_pk_fma_f32 v[42:43], v[88:89], v[112:113], v[42:43]
v_lshlrev_b32_e64 v90, 16, v53
v_and_b32 v91, 0xffff0000, v53
v_lshlrev_b32_e64 v114, 16, v69
v_and_b32 v115, 0xffff0000, v69
v_pk_fma_f32 v[44:45], v[90:91], v[114:115], v[44:45]
v_lshlrev_b32_e64 v92, 16, v54
v_and_b32 v93, 0xffff0000, v54
v_lshlrev_b32_e64 v116, 16, v70
v_and_b32 v117, 0xffff0000, v70
v_pk_fma_f32 v[42:43], v[92:93], v[116:117], v[42:43]
v_lshlrev_b32_e64 v94, 16, v55
v_and_b32 v95, 0xffff0000, v55
v_lshlrev_b32_e64 v118, 16, v71
v_and_b32 v119, 0xffff0000, v71
v_pk_fma_f32 v[44:45], v[94:95], v[118:119], v[44:45]
v_lshlrev_b32_e64 v96, 16, v56
v_and_b32 v97, 0xffff0000, v56
v_lshlrev_b32_e64 v112, 16, v72
v_and_b32 v113, 0xffff0000, v72
v_pk_fma_f32 v[42:43], v[96:97], v[112:113], v[42:43]
v_lshlrev_b32_e64 v98, 16, v57
v_and_b32 v99, 0xffff0000, v57
v_lshlrev_b32_e64 v114, 16, v73
v_and_b32 v115, 0xffff0000, v73
v_pk_fma_f32 v[44:45], v[98:99], v[114:115], v[44:45]
v_lshlrev_b32_e64 v100, 16, v58
v_and_b32 v101, 0xffff0000, v58
v_lshlrev_b32_e64 v116, 16, v74
v_and_b32 v117, 0xffff0000, v74
v_pk_fma_f32 v[42:43], v[100:101], v[116:117], v[42:43]
v_lshlrev_b32_e64 v102, 16, v59
v_and_b32 v103, 0xffff0000, v59
v_lshlrev_b32_e64 v118, 16, v75
v_and_b32 v119, 0xffff0000, v75
v_pk_fma_f32 v[44:45], v[102:103], v[118:119], v[44:45]
v_lshlrev_b32_e64 v104, 16, v60
v_and_b32 v105, 0xffff0000, v60
v_lshlrev_b32_e64 v112, 16, v76
v_and_b32 v113, 0xffff0000, v76
v_pk_fma_f32 v[42:43], v[104:105], v[112:113], v[42:43]
v_lshlrev_b32_e64 v106, 16, v61
v_and_b32 v107, 0xffff0000, v61
v_lshlrev_b32_e64 v114, 16, v77
v_and_b32 v115, 0xffff0000, v77
v_pk_fma_f32 v[44:45], v[106:107], v[114:115], v[44:45]
v_lshlrev_b32_e64 v108, 16, v62
v_and_b32 v109, 0xffff0000, v62
v_lshlrev_b32_e64 v116, 16, v78
v_and_b32 v117, 0xffff0000, v78
v_pk_fma_f32 v[42:43], v[108:109], v[116:117], v[42:43]
v_lshlrev_b32_e64 v110, 16, v63
v_and_b32 v111, 0xffff0000, v63
v_lshlrev_b32_e64 v118, 16, v79
v_and_b32 v119, 0xffff0000, v79
v_pk_fma_f32 v[44:45], v[110:111], v[118:119], v[44:45]
v_pk_add_f32 v[42:43], v[42:43], v[44:45]
Va 45,42,43
s_nop 1
v_add_f32_dpp v45, v45, v45 quad_perm:[1,0,3,2] row_mask:0xf bank_mask:0xf
s_nop 1
v_add_f32_dpp v45, v45, v45 quad_perm:[2,3,0,1] row_mask:0xf bank_mask:0xf
s_nop 1
v_add_f32_dpp v45, v45, v45 row_half_mirror row_mask:0xf bank_mask:0xf
s_nop 1
v_add_f32_dpp v45, v45, v45 row_mirror row_mask:0xf bank_mask:0xf
v_mov_b32 v37, v45
s_nop 1
v_permlane16_swap_b32 v37, v45
v_add_f32_e64 v45, v45, v37
Vc 45,45,45
v_ashrrev_i32_e64 v46, 31, v45
v_or_b32 v46, 0x80000000, v46
v_xor_b32_e64 v45, v45, v46
v_and_b32 v45, 0xffff0000, v45
s_lshr_b32 s3, s36, 11
v_add_u32 v46, s3, v33
v_sub_u32 v44, 0xffff, v46
v_or_b32 v45, v45, v44
v_lshlrev_b32 v44, 2, v46
v_lshlrev_b32_e64 v46, 3, v46
v_xor_b32 v38, 0x80000000, v38
v_mov_b32_e64 v39, v40
s_mov_b32 s3, 5242880
s_mov_b32 s39, 5259264
s_mov_b32 exec_lo, 1
s_mov_b32 exec_hi, 1
buffer_store_dword v45, v44, s[20:23], s3 offen sc1
buffer_store_dwordx2 v[38:39], v46, s[20:23], s39 offen sc1
s_mov_b64 exec, -1
s_load_dwordx2 s[4:5], s[0:1], 16
s_load_dwordx4 s[40:43], s[0:1], 64
s_load_dwordx2 s[92:93], s[0:1], 40
s_load_dwordx2 s[94:95], s[0:1], 80
s_load_dwordx2 s[100:101], s[0:1], 0
s_mov_b32 s28, s64
s_and_b32 s29, s65, 0xffff
s_mov_b32 s30, 256
s_mov_b32 s31, 0x20000
s_waitcnt vmcnt(4)
s_waitcnt lgkmcnt(0)
s_barrier
s_nop 0
Ta 32,12,0
Ta 34,12,2048
Ra 0,10,0
Ta 36,13,0
Ta 38,13,2048
Ra 4,10,2048
Ta 40,14,0
Ta 42,14,2048
Ra 8,10,4096
Ta 44,15,0
Ta 46,15,2048
Ra 12,10,6144
s_waitcnt lgkmcnt(2)
s_nop 0
Ta 48,16,0
Ta 50,16,2048
Ra 16,10,8192
Ta 52,17,0
Ta 54,17,2048
Ra 20,10,10240
Ta 56,18,0
Ta 58,18,2048
Ra 24,10,12288
Ta 60,19,0
Ta 62,19,2048
Ra 28,10,14336
s_cmp_lg_u32 s35, 0
s_cbranch_scc1 L_k1_vpath
s_waitcnt lgkmcnt(0)
s_add_u32 m0, s57, 65536
Zvaa 48,32,0
buffer_load_dwordx4 v6, s[12:15], s52 offen offset:0 nt lds
Zvaa 52,36,0
Ta 96,12,16384
Ta 98,12,18432
Zvaa 56,40,0
buffer_load_dwordx4 v7, s[12:15], s53 offen offset:1024 nt lds
Zvaa 60,44,0
Ra 64,11,0
Zvaa 64,48,0
buffer_load_dwordx4 v6, s[12:15], s54 offen offset:2048 nt lds
Zvaa 68,52,0
Ta 100,13,16384
Ta 102,13,18432
Zvaa 72,56,0
buffer_load_dwordx4 v7, s[12:15], s55 offen offset:3072 nt lds
Zvaa 76,60,0
s_add_u32 m0, s57, 69632
s_waitcnt lgkmcnt(6)
Ra 68,11,2048
Zvaa 80,32,4
buffer_load_dwordx4 v8, s[12:15], s52 offen offset:0 nt lds
Zvaa 84,36,4
Ta 104,14,16384
Ta 106,14,18432
Zvaa 88,40,4
buffer_load_dwordx4 v9, s[12:15], s53 offen offset:1024 nt lds
Zvaa 92,44,4
Ra 72,11,4096
Zvaa 96,48,4
buffer_load_dwordx4 v8, s[12:15], s54 offen offset:2048 nt lds
Zvaa 100,52,4
Ta 108,15,16384
Ta 110,15,18432
Zvaa 104,56,4
buffer_load_dwordx4 v9, s[12:15], s55 offen offset:3072 nt lds
Zvaa 108,60,4
s_add_u32 m0, s56, 65536
s_waitcnt lgkmcnt(6)
Ra 76,11,6144
Zvaa 112,32,8
buffer_load_dwordx4 v2, s[8:11], s48 offen offset:0 lds
Zvaa 116,36,8
Ta 112,16,16384
Ta 114,16,18432
Zvaa 120,40,8
buffer_load_dwordx4 v3, s[8:11], s49 offen offset:1024 lds
Zvaa 124,44,8
Ra 80,11,8192
v_xor_b32 v6, 1572864, v6
Zvaa 128,48,8
buffer_load_dwordx4 v2, s[8:11], s50 offen offset:2048 lds
Zvaa 132,52,8
Ta 116,17,16384
Ta 118,17,18432
Zvaa 136,56,8
buffer_load_dwordx4 v3, s[8:11], s51 offen offset:3072 lds
Zvaa 140,60,8
s_add_u32 m0, s56, 69632
s_waitcnt lgkmcnt(6)
Ra 84,11,10240
Zvaa 144,32,12
buffer_load_dwordx4 v4, s[8:11], s48 offen offset:0 lds
Zvaa 148,36,12
Ta 120,18,16384
Ta 122,18,18432
Zvaa 152,40,12
buffer_load_dwordx4 v5, s[8:11], s49 offen offset:1024 lds
Zvaa 156,44,12
Ra 88,11,12288
v_xor_b32 v7, 1572864, v7
Zvaa 160,48,12
buffer_load_dwordx4 v4, s[8:11], s50 offen offset:2048 lds
Zvaa 164,52,12
Ta 124,19,16384
Ta 126,19,18432
Zvaa 168,56,12
buffer_load_dwordx4 v5, s[8:11], s51 offen offset:3072 lds
Zvaa 172,60,12
s_waitcnt lgkmcnt(6)
Ra 92,11,14336
Zvaa 176,32,16
v_and_b32 v46, 7, v0
v_mul_u32_u24 v30, 2064, v46
Zvaa 180,36,16
v_xor_b32 v8, 1572864, v8
v_xor_b32 v9, 1572864, v9
Zvaa 184,40,16
v_lshrrev_b32_e64 v31, 3, v0
Zvaa 188,44,16
v_xor_b32 v2, 384, v2
v_xor_b32 v3, 384, v3
Zvaa 192,48,16
s_lshl_b32 s3, s32, 9
s_add_u32 s3, s3, 131072
v_lshl_add_u32 v30, v31, 4, v30
Zvaa 196,52,16
v_xor_b32 v4, 384, v4
v_xor_b32 v5, 384, v5
Zvaa 200,56,16
v_add_u32 v30, s3, v30
v_lshlrev_b32_e64 v31, 8, v31
Zvaa 204,60,16
v_lshl_add_u32 v46, v46, 4, v31
Zvaa 208,32,20
buffer_load_dword v1, v47, s[60:63], 0 offen
Zvaa 212,36,20
s_mul_i32 vcc_lo, s59, 7
v_xor_b32 v47, vcc_lo, v47
Zvaa 216,40,20
Rv 34,30,128
Rv 38,30,256
Zvaa 220,44,20
Rv 42,30,384
Rv 30,30,0
Zvaa 224,48,20
buffer_load_dword v1, v47, s[60:63], 0 offen
Zvaa 228,52,20
s_mul_i32 vcc_lo, s59, 1
v_xor_b32 v47, vcc_lo, v47
Zvaa 232,56,20
s_lshr_b32 s3, s2, 1
s_mul_i32 s3, s3, 33792
s_add_u32 s3, s3, s56
Zvaa 236,60,20
s_and_b32 s39, s2, 1
s_lshl_b32 s39, s39, 7
s_add_u32 s3, s3, s39
Zvaa 240,32,24
s_add_u32 s39, s3, 4096
Zvaa 244,36,24
Zvaa 248,40,24
Zvaa 252,44,24
Zaaa 128,48,24
Zaaa 132,52,24
Zaaa 136,56,24
Zaaa 140,60,24
Zaaa 144,32,28
Zaaa 148,36,28
Zaaa 152,40,28
Zaaa 156,44,28
Zaaa 160,48,28
Zaaa 164,52,28
Zaaa 168,56,28
Zaaa 172,60,28
s_waitcnt vmcnt(2) lgkmcnt(0)
s_add_u32 m0, s57, 0
s_barrier
Mvaa 48,96,64
buffer_load_dwordx4 v6, s[12:15], s52 offen offset:0 nt lds
Mvaa 52,100,64
Ta 32,22,0
Ta 34,22,2048
Mvaa 56,104,64
Mvaa 60,108,64
Ra 0,20,0
Mvaa 64,112,64
buffer_load_dwordx4 v7, s[12:15], s53 offen offset:1024 nt lds
Mvaa 68,116,64
s_waitcnt lgkmcnt(6)
Ta 36,23,0
Ta 38,23,2048
Mvaa 72,120,64
Mvaa 76,124,64
Ra 4,20,2048
Mvaa 80,96,68
buffer_load_dwordx4 v6, s[12:15], s54 offen offset:2048 nt lds
Mvaa 84,100,68
Ta 40,24,0
Ta 42,24,2048
Mvaa 88,104,68
Mvaa 92,108,68
Ra 8,20,4096
Mvaa 96,112,68
buffer_load_dwordx4 v7, s[12:15], s55 offen offset:3072 nt lds
Mvaa 100,116,68
s_waitcnt lgkmcnt(6)
Ta 44,25,0
Ta 46,25,2048
Mvaa 104,120,68
Mvaa 108,124,68
s_add_u32 m0, s57, 4096
Ra 12,20,6144
Mvaa 112,96,72
buffer_load_dwordx4 v8, s[12:15], s52 offen offset:0 nt lds
Mvaa 116,100,72
Ta 48,26,0
Ta 50,26,2048
Mvaa 120,104,72
Mvaa 124,108,72
Ra 16,20,8192
Mvaa 128,112,72
buffer_load_dwordx4 v9, s[12:15], s53 offen offset:1024 nt lds
Mvaa 132,116,72
s_waitcnt lgkmcnt(6)
Ta 52,27,0
Ta 54,27,2048
Mvaa 136,120,72
Mvaa 140,124,72
Ra 20,20,10240
Mvaa 144,96,76
buffer_load_dwordx4 v8, s[12:15], s54 offen offset:2048 nt lds
Mvaa 148,100,76
Ta 56,28,0
Ta 58,28,2048
Mvaa 152,104,76
Mvaa 156,108,76
Ra 24,20,12288
Mvaa 160,112,76
buffer_load_dwordx4 v9, s[12:15], s55 offen offset:3072 nt lds
Mvaa 164,116,76
s_waitcnt lgkmcnt(6)
Ta 60,29,0
Ta 62,29,2048
Mvaa 168,120,76
v_xor_b32 v6, 524288, v6
v_xor_b32 v7, 524288, v7
Mvaa 172,124,76
s_add_u32 m0, s56, 0
Ra 28,20,14336
v_xor_b32 v8, 524288, v8
Mvaa 176,96,80
buffer_load_dwordx4 v2, s[8:11], s48 offen offset:0 lds
Mvaa 180,100,80
v_xor_b32 v9, 524288, v9
Mvaa 184,104,80
Mvaa 188,108,80
Mvaa 192,112,80
buffer_load_dwordx4 v3, s[8:11], s49 offen offset:1024 lds
Mvaa 196,116,80
Mvaa 200,120,80
Mvaa 204,124,80
Mvaa 208,96,84
buffer_load_dwordx4 v2, s[8:11], s50 offen offset:2048 lds
Mvaa 212,100,84
Mvaa 216,104,84
Mvaa 220,108,84
Mvaa 224,112,84
buffer_load_dwordx4 v3, s[8:11], s51 offen offset:3072 lds
Mvaa 228,116,84
Mvaa 232,120,84
Mvaa 236,124,84
s_add_u32 m0, s56, 4096
Mvaa 240,96,88
buffer_load_dwordx4 v4, s[8:11], s48 offen offset:0 lds
Mvaa 244,100,88
Mvaa 248,104,88
Mvaa 252,108,88
Maaa 128,112,88
buffer_load_dwordx4 v5, s[8:11], s49 offen offset:1024 lds
Maaa 132,116,88
Maaa 136,120,88
Maaa 140,124,88
Maaa 144,96,92
buffer_load_dwordx4 v4, s[8:11], s50 offen offset:2048 lds
Maaa 148,100,92
Maaa 152,104,92
Maaa 156,108,92
Maaa 160,112,92
buffer_load_dwordx4 v5, s[8:11], s51 offen offset:3072 lds
Maaa 164,116,92
v_xor_b32 v2, 128, v2
v_xor_b32 v3, 128, v3
Maaa 168,120,92
buffer_load_dword v1, v47, s[60:63], 0 offen
v_xor_b32 v4, 128, v4
v_xor_b32 v5, 128, v5
Maaa 172,124,92
s_mul_i32 vcc_lo, s59, 3
v_xor_b32 v47, vcc_lo, v47
s_waitcnt lgkmcnt(0)
Mvaa 48,32,0
buffer_store_dwordx4 v[30:33], v46, s[20:23], s3 offen offset:0 sc1
Mvaa 52,36,0
Ta 96,22,16384
Ta 98,22,18432
Mvaa 56,40,0
buffer_store_dwordx4 v[34:37], v46, s[20:23], s3 offen offset:2048 sc1
Mvaa 60,44,0
Ra 64,21,0
Mvaa 64,48,0
buffer_store_dwordx4 v[38:41], v46, s[20:23], s39 offen offset:0 sc1
Mvaa 68,52,0
Ta 100,23,16384
Ta 102,23,18432
Mvaa 72,56,0
buffer_store_dwordx4 v[42:45], v46, s[20:23], s39 offen offset:2048 sc1
Mvaa 76,60,0
s_waitcnt lgkmcnt(6)
Ra 68,21,2048
Mvaa 80,32,4
s_lshl_b32 s3, s34, 1
s_and_b32 s36, s32, 1
s_add_u32 s3, s3, s36
Mvaa 84,36,4
Ta 104,24,16384
Ta 106,24,18432
Mvaa 88,40,4
s_mul_i32 s3, s3, 1116160
s_mul_i32 s36, s33, 139264
s_add_u32 s3, s3, s36
Mvaa 92,44,4
Ra 72,21,4096
Mvaa 96,48,4
s_lshr_b32 s36, s32, 1
s_mul_i32 s36, s36, 69632
s_add_u32 s3, s3, s36
Mvaa 100,52,4
Ta 108,25,16384
Ta 110,25,18432
Mvaa 104,56,4
s_add_u32 s38, s3, 0
s_lshl_b32 s39, s34, 7
s_lshl_b32 s36, s33, 2
Mvaa 108,60,4
s_waitcnt lgkmcnt(6)
Ra 76,21,6144
Mvaa 112,32,8
s_add_u32 s39, s39, s36
s_add_u32 s39, s39, 5296128
v_mov_b32_e64 v30, 1
Mvaa 116,36,8
Ta 112,26,16384
Ta 114,26,18432
Mvaa 120,40,8
v_mov_b32_e64 v31, 0
Mvaa 124,44,8
Ra 80,21,8192
Mvaa 128,48,8
s_cmp_eq_u32 s32, 0
s_cselect_b32 s39, s39, 2146435072
Mvaa 132,52,8
Ta 116,27,16384
Ta 118,27,18432
Mvaa 136,56,8
s_mov_b64 exec, 1
buffer_store_dword v31, v31, s[20:23], s39 offen sc1
s_mov_b64 exec, -1
Mvaa 140,60,8
s_waitcnt lgkmcnt(6)
Ra 84,21,10240
Mvaa 144,32,12
s_and_b32 s33, s2, 7
s_lshl_b32 s33, s33, 2
s_bfe_u32 s3, s2, 0x20003
Mvaa 148,36,12
Ta 120,28,16384
Ta 122,28,18432
Mvaa 152,40,12
s_add_u32 s33, s33, s3
s_lshr_b32 s34, s2, 5
s_lshl_b32 s64, s34, 7
Mvaa 156,44,12
Ra 88,21,12288
Mvaa 160,48,12
s_lshl_b32 s3, s33, 2
s_add_u32 s64, s64, s3
s_add_u32 s64, s64, 5300224
Mvaa 164,52,12
Ta 124,29,16384
Ta 126,29,18432
Mvaa 168,56,12
s_lshl_b32 s65, s34, 8
s_sub_u32 s65, 1920, s65
v_mul_u32_u24_e64 v32, s65, v0
Mvaa 172,60,12
s_waitcnt lgkmcnt(6)
Ra 92,21,14336
Mvaa 176,32,16
s_cmp_eq_u32 s32, 0
s_cselect_b32 s64, s64, 2146435072
Mvaa 180,36,16
s_mov_b64 exec, 3
buffer_store_dword v31, v32, s[20:23], s64 offen sc1
s_mov_b64 exec, -1
Mvaa 184,40,16
s_lshl_b32 s3, s2, 2
s_add_u32 s3, s3, 5447680
v_lshlrev_b32 v32, 10, v0
Mvaa 188,44,16
s_cmp_eq_u32 s32, 0
s_cselect_b32 s3, s3, 2146435072
Mvaa 192,48,16
s_mov_b64 exec, 0x1ff
buffer_store_dword v31, v32, s[20:23], s3 offen sc1
s_mov_b64 exec, -1
Mvaa 196,52,16
s_lshl_b32 s35, s34, 1
s_sub_u32 s36, 32, s35
s_add_u32 s35, s35, 2
Mvaa 200,56,16
s_lshl_b32 s44, s32, 12
s_lshl_b32 s58, s32, 1
s_sub_u32 s58, 7, s58
Mvaa 204,60,16
s_mul_i32 s58, s58, 33792
s_sub_u32 s3, 15, s34
s_lshl_b32 s45, s3, 3
Mvaa 208,32,20
s_add_u32 s45, s45, s32
s_lshl_b32 s46, s34, 3
s_add_u32 s46, s46, s32
Mvaa 212,36,20
s_mov_b32 s68, s42
s_and_b32 s69, s43, 0xffff
s_mov_b32 s70, 7340032
Mvaa 216,40,20
s_mov_b32 s71, 0x20000
s_cmp_eq_u32 s32, 0
s_cselect_b32 s37, 0, 2146435072
Mvaa 220,44,20
s_lshl_b32 s3, s33, 8
s_add_u32 s16, s4, s3
s_addc_u32 s17, s5, 0
s_and_b32 s17, s17, 0xffff
Mvaa 224,48,20
s_mov_b32 s18, 0
s_mov_b32 s19, 0x20000
s_sub_u32 s18, 8388608, s3
Mvaa 228,52,20
v_and_b32 v33, 15, v0
v_lshrrev_b32_e64 v32, 1, v33
Mvaa 232,56,20
v_and_b32 v33, 1, v0
v_lshlrev_b32 v32, 13, v32
Mvaa 236,60,20
v_lshl_add_u32 v45, v33, 7, v32
Mvaa 240,32,24
s_lshl_b32 s3, s32, 3
s_add_u32 s3, s3, s34
s_mul_i32 s47, s3, 65536
Mvaa 244,36,24
s_bfe_u32 s6, s2, 131075
s_lshl_b32 s3, s32, 8
s_or_b32 s6, s6, s3
Mvaa 248,40,24
Mvaa 252,44,24
Maaa 128,48,24
Maaa 132,52,24
Maaa 136,56,24
Maaa 140,60,24
Maaa 144,32,28
Maaa 148,36,28
Maaa 152,40,28
Maaa 156,44,28
Maaa 160,48,28
Maaa 164,52,28
Maaa 168,56,28
Maaa 172,60,28
s_waitcnt vmcnt(8) lgkmcnt(0)
s_add_u32 m0, s57, 65536
s_barrier
Mvaa 48,96,64
buffer_load_dwordx4 v6, s[12:15], s52 offen offset:0 nt lds
Mvaa 52,100,64
Ta 32,12,0
Ta 34,12,2048
Mvaa 56,104,64
Mvaa 60,108,64
Ra 0,10,0
Mvaa 64,112,64
buffer_load_dwordx4 v7, s[12:15], s53 offen offset:1024 nt lds
Mvaa 68,116,64
s_waitcnt lgkmcnt(6)
Ta 36,13,0
Ta 38,13,2048
Mvaa 72,120,64
Mvaa 76,124,64
Ra 4,10,2048
Mvaa 80,96,68
buffer_load_dwordx4 v6, s[12:15], s54 offen offset:2048 nt lds
Mvaa 84,100,68
Ta 40,14,0
Ta 42,14,2048
Mvaa 88,104,68
Mvaa 92,108,68
Ra 8,10,4096
Mvaa 96,112,68
buffer_load_dwordx4 v7, s[12:15], s55 offen offset:3072 nt lds
Mvaa 100,116,68
s_waitcnt lgkmcnt(6)
Ta 44,15,0
Ta 46,15,2048
Mvaa 104,120,68
Mvaa 108,124,68
s_add_u32 m0, s57, 69632
Ra 12,10,6144
Mvaa 112,96,72
buffer_load_dwordx4 v8, s[12:15], s52 offen offset:0 nt lds
Mvaa 116,100,72
Ta 48,16,0
Ta 50,16,2048
Mvaa 120,104,72
Mvaa 124,108,72
Ra 16,10,8192
Mvaa 128,112,72
buffer_load_dwordx4 v9, s[12:15], s53 offen offset:1024 nt lds
Mvaa 132,116,72
s_waitcnt lgkmcnt(6)
Ta 52,17,0
Ta 54,17,2048
Mvaa 136,120,72
Mvaa 140,124,72
Ra 20,10,10240
Mvaa 144,96,76
buffer_load_dwordx4 v8, s[12:15], s54 offen offset:2048 nt lds
Mvaa 148,100,76
Ta 56,18,0
Ta 58,18,2048
Mvaa 152,104,76
Mvaa 156,108,76
Ra 24,10,12288
Mvaa 160,112,76
buffer_load_dwordx4 v9, s[12:15], s55 offen offset:3072 nt lds
Mvaa 164,116,76
s_waitcnt lgkmcnt(6)
Ta 60,19,0
Ta 62,19,2048
Mvaa 168,120,76
v_xor_b32 v6, 3670016, v6
v_xor_b32 v7, 3670016, v7
Mvaa 172,124,76
s_add_u32 m0, s56, 65536
Ra 28,10,14336
v_xor_b32 v8, 3670016, v8
Mvaa 176,96,80
buffer_load_dwordx4 v2, s[8:11], s48 offen offset:0 lds
Mvaa 180,100,80
v_xor_b32 v9, 3670016, v9
Mvaa 184,104,80
Mvaa 188,108,80
Mvaa 192,112,80
buffer_load_dwordx4 v3, s[8:11], s49 offen offset:1024 lds
Mvaa 196,116,80
Mvaa 200,120,80
Mvaa 204,124,80
Mvaa 208,96,84
buffer_load_dwordx4 v2, s[8:11], s50 offen offset:2048 lds
Mvaa 212,100,84
Mvaa 216,104,84
Mvaa 220,108,84
Mvaa 224,112,84
buffer_load_dwordx4 v3, s[8:11], s51 offen offset:3072 lds
Mvaa 228,116,84
Mvaa 232,120,84
Mvaa 236,124,84
s_add_u32 m0, s56, 69632
Mvaa 240,96,88
buffer_load_dwordx4 v4, s[8:11], s48 offen offset:0 lds
Mvaa 244,100,88
Mvaa 248,104,88
Mvaa 252,108,88
Maaa 128,112,88
buffer_load_dwordx4 v5, s[8:11], s49 offen offset:1024 lds
Maaa 132,116,88
Maaa 136,120,88
Maaa 140,124,88
Maaa 144,96,92
buffer_load_dwordx4 v4, s[8:11], s50 offen offset:2048 lds
Maaa 148,100,92
Maaa 152,104,92
Maaa 156,108,92
Maaa 160,112,92
buffer_load_dwordx4 v5, s[8:11], s51 offen offset:3072 lds
Maaa 164,116,92
v_xor_b32 v2, 896, v2
v_xor_b32 v3, 896, v3
Maaa 168,120,92
buffer_load_dword v1, v47, s[60:63], 0 offen
v_xor_b32 v4, 896, v4
v_xor_b32 v5, 896, v5
Maaa 172,124,92
s_mul_i32 vcc_lo, s59, 1
v_xor_b32 v47, vcc_lo, v47
s_waitcnt lgkmcnt(0)
Mvaa 48,32,0
Mvaa 52,36,0
Ta 96,12,16384
Ta 98,12,18432
Mvaa 56,40,0
Mvaa 60,44,0
Ra 64,11,0
Mvaa 64,48,0
Mvaa 68,52,0
Ta 100,13,16384
Ta 102,13,18432
Mvaa 72,56,0
Mvaa 76,60,0
s_waitcnt lgkmcnt(6)
Ra 68,11,2048
Mvaa 80,32,4
Mvaa 84,36,4
Ta 104,14,16384
Ta 106,14,18432
Mvaa 88,40,4
Mvaa 92,44,4
Ra 72,11,4096
Mvaa 96,48,4
Mvaa 100,52,4
Ta 108,15,16384
Ta 110,15,18432
Mvaa 104,56,4
Mvaa 108,60,4
s_waitcnt lgkmcnt(6)
Ra 76,11,6144
Mvaa 112,32,8
Mvaa 116,36,8
Ta 112,16,16384
Ta 114,16,18432
Mvaa 120,40,8
Mvaa 124,44,8
Ra 80,11,8192
Mvaa 128,48,8
Mvaa 132,52,8
Ta 116,17,16384
Ta 118,17,18432
Mvaa 136,56,8
Mvaa 140,60,8
s_waitcnt lgkmcnt(6)
Ra 84,11,10240
Mvaa 144,32,12
Mvaa 148,36,12
Ta 120,18,16384
Ta 122,18,18432
Mvaa 152,40,12
Mvaa 156,44,12
Ra 88,11,12288
Mvaa 160,48,12
Mvaa 164,52,12
Ta 124,19,16384
Ta 126,19,18432
Mvaa 168,56,12
Mvaa 172,60,12
s_waitcnt lgkmcnt(6)
Ra 92,11,14336
Mvaa 176,32,16
Mvaa 180,36,16
Mvaa 184,40,16
Mvaa 188,44,16
Mvaa 192,48,16
Mvaa 196,52,16
Mvaa 200,56,16
Mvaa 204,60,16
Mvaa 208,32,20
Mvaa 212,36,20
Mvaa 216,40,20
Mvaa 220,44,20
Mvaa 224,48,20
Mvaa 228,52,20
Mvaa 232,56,20
Mvaa 236,60,20
Mvaa 240,32,24
Mvaa 244,36,24
Mvaa 248,40,24
Mvaa 252,44,24
Maaa 128,48,24
Maaa 132,52,24
Maaa 136,56,24
Maaa 140,60,24
Maaa 144,32,28
Maaa 148,36,28
Maaa 152,40,28
Maaa 156,44,28
Maaa 160,48,28
Maaa 164,52,28
Maaa 168,56,28
Maaa 172,60,28
s_waitcnt vmcnt(1) lgkmcnt(0)
s_add_u32 m0, s57, 0
s_barrier
Mvaa 48,96,64
buffer_load_dwordx4 v6, s[12:15], s52 offen offset:0 nt lds
Mvaa 52,100,64
Ta 32,22,0
Ta 34,22,2048
Mvaa 56,104,64
Mvaa 60,108,64
Ra 0,20,0
Mvaa 64,112,64
buffer_load_dwordx4 v7, s[12:15], s53 offen offset:1024 nt lds
Mvaa 68,116,64
s_waitcnt lgkmcnt(6)
Ta 36,23,0
Ta 38,23,2048
Mvaa 72,120,64
Mvaa 76,124,64
Ra 4,20,2048
Mvaa 80,96,68
buffer_load_dwordx4 v6, s[12:15], s54 offen offset:2048 nt lds
Mvaa 84,100,68
Ta 40,24,0
Ta 42,24,2048
Mvaa 88,104,68
Mvaa 92,108,68
Ra 8,20,4096
Mvaa 96,112,68
buffer_load_dwordx4 v7, s[12:15], s55 offen offset:3072 nt lds
Mvaa 100,116,68
s_waitcnt lgkmcnt(6)
Ta 44,25,0
Ta 46,25,2048
Mvaa 104,120,68
s_cmp_eq_u32 s6, 0
s_cselect_b32 s3, 0, 2146435072
Mvaa 108,124,68
s_add_u32 m0, s57, 4096
Ra 12,20,6144
Mvaa 112,96,72
buffer_load_dwordx4 v8, s[12:15], s52 offen offset:0 nt lds
Mvaa 116,100,72
Ta 48,26,0
Ta 50,26,2048
Mvaa 120,104,72
s_mov_b64 exec, 1
buffer_atomic_add v30, v31, s[28:31], s3 offen sc1
s_mov_b64 exec, -1
Mvaa 124,108,72
Ra 16,20,8192
Mvaa 128,112,72
buffer_load_dwordx4 v9, s[12:15], s53 offen offset:1024 nt lds
Mvaa 132,116,72
s_waitcnt lgkmcnt(6)
Ta 52,27,0
Ta 54,27,2048
Mvaa 136,120,72
Mvaa 140,124,72
Ra 20,20,10240
Mvaa 144,96,76
buffer_load_dwordx4 v8, s[12:15], s54 offen offset:2048 nt lds
Mvaa 148,100,76
Ta 56,28,0
Ta 58,28,2048
Mvaa 152,104,76
Mvaa 156,108,76
Ra 24,20,12288
Mvaa 160,112,76
buffer_load_dwordx4 v9, s[12:15], s55 offen offset:3072 nt lds
Mvaa 164,116,76
s_waitcnt lgkmcnt(6)
Ta 60,29,0
Ta 62,29,2048
Mvaa 168,120,76
v_xor_b32 v6, 524288, v6
v_xor_b32 v7, 524288, v7
Mvaa 172,124,76
s_add_u32 m0, s56, 0
Ra 28,20,14336
v_xor_b32 v8, 524288, v8
Mvaa 176,96,80
buffer_load_dwordx4 v2, s[8:11], s48 offen offset:0 lds
Mvaa 180,100,80
v_xor_b32 v9, 524288, v9
Mvaa 184,104,80
Mvaa 188,108,80
Mvaa 192,112,80
buffer_load_dwordx4 v3, s[8:11], s49 offen offset:1024 lds
Mvaa 196,116,80
Mvaa 200,120,80
Mvaa 204,124,80
Mvaa 208,96,84
buffer_load_dwordx4 v2, s[8:11], s50 offen offset:2048 lds
Mvaa 212,100,84
Mvaa 216,104,84
Mvaa 220,108,84
Mvaa 224,112,84
buffer_load_dwordx4 v3, s[8:11], s51 offen offset:3072 lds
Mvaa 228,116,84
Mvaa 232,120,84
Mvaa 236,124,84
s_add_u32 m0, s56, 4096
Mvaa 240,96,88
buffer_load_dwordx4 v4, s[8:11], s48 offen offset:0 lds
Mvaa 244,100,88
Mvaa 248,104,88
Mvaa 252,108,88
Maaa 128,112,88
buffer_load_dwordx4 v5, s[8:11], s49 offen offset:1024 lds
Maaa 132,116,88
Maaa 136,120,88
Maaa 140,124,88
Maaa 144,96,92
buffer_load_dwordx4 v4, s[8:11], s50 offen offset:2048 lds
Maaa 148,100,92
Maaa 152,104,92
Maaa 156,108,92
Maaa 160,112,92
buffer_load_dwordx4 v5, s[8:11], s51 offen offset:3072 lds
Maaa 164,116,92
v_xor_b32 v2, 128, v2
v_xor_b32 v3, 128, v3
Maaa 168,120,92
buffer_load_dword v1, v47, s[60:63], 0 offen
v_xor_b32 v4, 128, v4
v_xor_b32 v5, 128, v5
Maaa 172,124,92
s_mul_i32 vcc_lo, s59, 7
v_xor_b32 v47, vcc_lo, v47
s_waitcnt lgkmcnt(0)
Mvaa 48,32,0
buffer_load_dword v44, v45, s[16:19], s47 offen
Mvaa 52,36,0
Ta 96,22,16384
Ta 98,22,18432
Mvaa 56,40,0
s_add_u32 s47, s47, 2097152
Mvaa 60,44,0
Ra 64,21,0
Mvaa 64,48,0
Mvaa 68,52,0
Ta 100,23,16384
Ta 102,23,18432
Mvaa 72,56,0
Mvaa 76,60,0
s_waitcnt lgkmcnt(6)
Ra 68,21,2048
Mvaa 80,32,4
Mvaa 84,36,4
Ta 104,24,16384
Ta 106,24,18432
Mvaa 88,40,4
Mvaa 92,44,4
Ra 72,21,4096
Mvaa 96,48,4
Mvaa 100,52,4
Ta 108,25,16384
Ta 110,25,18432
Mvaa 104,56,4
Mvaa 108,60,4
s_waitcnt lgkmcnt(6)
Ra 76,21,6144
Mvaa 112,32,8
Mvaa 116,36,8
Ta 112,26,16384
Ta 114,26,18432
Mvaa 120,40,8
Mvaa 124,44,8
Ra 80,21,8192
Mvaa 128,48,8
Mvaa 132,52,8
Ta 116,27,16384
Ta 118,27,18432
Mvaa 136,56,8
Mvaa 140,60,8
s_waitcnt lgkmcnt(6)
Ra 84,21,10240
Mvaa 144,32,12
Mvaa 148,36,12
Ta 120,28,16384
Ta 122,28,18432
Mvaa 152,40,12
s_cmp_eq_u32 s6, 1
s_cselect_b32 s3, 0, 2146435072
Mvaa 156,44,12
Ra 88,21,12288
Mvaa 160,48,12
s_mov_b64 exec, 1
buffer_atomic_add v30, v31, s[28:31], s3 offen sc1
s_mov_b64 exec, -1
Mvaa 164,52,12
Ta 124,29,16384
Ta 126,29,18432
Mvaa 168,56,12
Mvaa 172,60,12
s_waitcnt lgkmcnt(6)
Ra 92,21,14336
Mvaa 176,32,16
Mvaa 180,36,16
Mvaa 184,40,16
Mvaa 188,44,16
Mvaa 192,48,16
Mvaa 196,52,16
Mvaa 200,56,16
Mvaa 204,60,16
Mvaa 208,32,20
Mvaa 212,36,20
Mvaa 216,40,20
Mvaa 220,44,20
Mvaa 224,48,20
Mvaa 228,52,20
Mvaa 232,56,20
Mvaa 236,60,20
Mvaa 240,32,24
Mvaa 244,36,24
Mvaa 248,40,24
Mvaa 252,44,24
Maaa 128,48,24
Maaa 132,52,24
Maaa 136,56,24
Maaa 140,60,24
Maaa 144,32,28
Maaa 148,36,28
Maaa 152,40,28
Maaa 156,44,28
Maaa 160,48,28
Maaa 164,52,28
Maaa 168,56,28
Maaa 172,60,28
s_waitcnt vmcnt(3) lgkmcnt(0)
s_add_u32 m0, s57, 65536
s_barrier
Mvaa 48,96,64
buffer_load_dwordx4 v6, s[12:15], s52 offen offset:0 nt lds
Mvaa 52,100,64
Ta 32,12,0
Ta 34,12,2048
Mvaa 56,104,64
Mvaa 60,108,64
Ra 0,10,0
Mvaa 64,112,64
buffer_load_dwordx4 v7, s[12:15], s53 offen offset:1024 nt lds
Mvaa 68,116,64
s_waitcnt lgkmcnt(6)
Ta 36,13,0
Ta 38,13,2048
Mvaa 72,120,64
Mvaa 76,124,64
Ra 4,10,2048
Mvaa 80,96,68
buffer_load_dwordx4 v6, s[12:15], s54 offen offset:2048 nt lds
Mvaa 84,100,68
Ta 40,14,0
Ta 42,14,2048
Mvaa 88,104,68
Mvaa 92,108,68
Ra 8,10,4096
Mvaa 96,112,68
buffer_load_dwordx4 v7, s[12:15], s55 offen offset:3072 nt lds
Mvaa 100,116,68
s_waitcnt lgkmcnt(6)
Ta 44,15,0
Ta 46,15,2048
Mvaa 104,120,68
Mvaa 108,124,68
s_add_u32 m0, s57, 69632
Ra 12,10,6144
Mvaa 112,96,72
buffer_load_dwordx4 v8, s[12:15], s52 offen offset:0 nt lds
Mvaa 116,100,72
Ta 48,16,0
Ta 50,16,2048
Mvaa 120,104,72
Mvaa 124,108,72
Ra 16,10,8192
Mvaa 128,112,72
buffer_load_dwordx4 v9, s[12:15], s53 offen offset:1024 nt lds
Mvaa 132,116,72
s_waitcnt lgkmcnt(6)
Ta 52,17,0
Ta 54,17,2048
Mvaa 136,120,72
Mvaa 140,124,72
Ra 20,10,10240
Mvaa 144,96,76
buffer_load_dwordx4 v8, s[12:15], s54 offen offset:2048 nt lds
Mvaa 148,100,76
Ta 56,18,0
Ta 58,18,2048
Mvaa 152,104,76
Mvaa 156,108,76
Ra 24,10,12288
Mvaa 160,112,76
buffer_load_dwordx4 v9, s[12:15], s55 offen offset:3072 nt lds
Mvaa 164,116,76
s_waitcnt lgkmcnt(6)
Ta 60,19,0
Ta 62,19,2048
Mvaa 168,120,76
v_xor_b32 v6, 1572864, v6
v_xor_b32 v7, 1572864, v7
Mvaa 172,124,76
s_add_u32 m0, s56, 65536
Ra 28,10,14336
v_xor_b32 v8, 1572864, v8
Mvaa 176,96,80
buffer_load_dwordx4 v2, s[8:11], s48 offen offset:0 lds
Mvaa 180,100,80
v_xor_b32 v9, 1572864, v9
Mvaa 184,104,80
Mvaa 188,108,80
Mvaa 192,112,80
buffer_load_dwordx4 v3, s[8:11], s49 offen offset:1024 lds
Mvaa 196,116,80
Mvaa 200,120,80
Mvaa 204,124,80
s_cmp_eq_u32 s6, 2
s_cselect_b32 s3, 0, 2146435072
Mvaa 208,96,84
buffer_load_dwordx4 v2, s[8:11], s50 offen offset:2048 lds
Mvaa 212,100,84
s_mov_b64 exec, 1
buffer_atomic_add v30, v31, s[28:31], s3 offen sc1
s_mov_b64 exec, -1
Mvaa 216,104,84
Mvaa 220,108,84
Mvaa 224,112,84
buffer_load_dwordx4 v3, s[8:11], s51 offen offset:3072 lds
Mvaa 228,116,84
Mvaa 232,120,84
Mvaa 236,124,84
s_add_u32 m0, s56, 69632
Mvaa 240,96,88
buffer_load_dwordx4 v4, s[8:11], s48 offen offset:0 lds
Mvaa 244,100,88
Mvaa 248,104,88
Mvaa 252,108,88
Maaa 128,112,88
buffer_load_dwordx4 v5, s[8:11], s49 offen offset:1024 lds
Maaa 132,116,88
Maaa 136,120,88
Maaa 140,124,88
Maaa 144,96,92
buffer_load_dwordx4 v4, s[8:11], s50 offen offset:2048 lds
Maaa 148,100,92
Maaa 152,104,92
Maaa 156,108,92
Maaa 160,112,92
buffer_load_dwordx4 v5, s[8:11], s51 offen offset:3072 lds
Maaa 164,116,92
v_xor_b32 v2, 384, v2
v_xor_b32 v3, 384, v3
Maaa 168,120,92
v_xor_b32 v4, 384, v4
v_xor_b32 v5, 384, v5
Maaa 172,124,92
s_waitcnt lgkmcnt(0)
Mvaa 48,32,0
buffer_load_dword v44, v45, s[16:19], s47 offen
Mvaa 52,36,0
Ta 96,12,16384
Ta 98,12,18432
Mvaa 56,40,0
s_add_u32 s47, s47, 2097152
Mvaa 60,44,0
Ra 64,11,0
Mvaa 64,48,0
Mvaa 68,52,0
Ta 100,13,16384
Ta 102,13,18432
Mvaa 72,56,0
Mvaa 76,60,0
s_waitcnt lgkmcnt(6)
Ra 68,11,2048
Mvaa 80,32,4
Mvaa 84,36,4
Ta 104,14,16384
Ta 106,14,18432
Mvaa 88,40,4
Mvaa 92,44,4
Ra 72,11,4096
Mvaa 96,48,4
Mvaa 100,52,4
Ta 108,15,16384
Ta 110,15,18432
Mvaa 104,56,4
Mvaa 108,60,4
s_waitcnt lgkmcnt(6)
Ra 76,11,6144
Mvaa 112,32,8
Mvaa 116,36,8
Ta 112,16,16384
Ta 114,16,18432
Mvaa 120,40,8
Mvaa 124,44,8
Ra 80,11,8192
Mvaa 128,48,8
Mvaa 132,52,8
Ta 116,17,16384
Ta 118,17,18432
Mvaa 136,56,8
Mvaa 140,60,8
s_waitcnt lgkmcnt(6)
Ra 84,11,10240
Mvaa 144,32,12
Mvaa 148,36,12
Ta 120,18,16384
Ta 122,18,18432
Mvaa 152,40,12
Mvaa 156,44,12
Ra 88,11,12288
Mvaa 160,48,12
Mvaa 164,52,12
Ta 124,19,16384
Ta 126,19,18432
Mvaa 168,56,12
Mvaa 172,60,12
s_waitcnt lgkmcnt(6)
Ra 92,11,14336
Mvaa 176,32,16
Mvaa 180,36,16
Mvaa 184,40,16
Mvaa 188,44,16
Mvaa 192,48,16
Mvaa 196,52,16
Mvaa 200,56,16
Mvaa 204,60,16
Mvaa 208,32,20
Mvaa 212,36,20
Mvaa 216,40,20
Mvaa 220,44,20
Mvaa 224,48,20
Mvaa 228,52,20
Mvaa 232,56,20
Mvaa 236,60,20
Mvaa 240,32,24
Mvaa 244,36,24
Mvaa 248,40,24
Mvaa 252,44,24
Maaa 128,48,24
s_cmp_eq_u32 s6, 3
s_cselect_b32 s3, 0, 2146435072
Maaa 132,52,24
s_mov_b64 exec, 1
buffer_atomic_add v30, v31, s[28:31], s3 offen sc1
s_mov_b64 exec, -1
Maaa 136,56,24
Maaa 140,60,24
Maaa 144,32,28
Maaa 148,36,28
Maaa 152,40,28
Maaa 156,44,28
Maaa 160,48,28
Maaa 164,52,28
Maaa 168,56,28
Maaa 172,60,28
s_waitcnt vmcnt(2) lgkmcnt(0)
s_add_u32 m0, s57, 0
s_barrier
Mvaa 48,96,64
buffer_load_dwordx4 v6, s[12:15], s52 offen offset:0 nt lds
Mvaa 52,100,64
Ta 32,22,0
Ta 34,22,2048
Mvaa 56,104,64
Mvaa 60,108,64
Ra 0,20,0
Mvaa 64,112,64
buffer_load_dwordx4 v7, s[12:15], s53 offen offset:1024 nt lds
Mvaa 68,116,64
s_waitcnt lgkmcnt(6)
Ta 36,23,0
Ta 38,23,2048
Mvaa 72,120,64
Mvaa 76,124,64
Ra 4,20,2048
Mvaa 80,96,68
buffer_load_dwordx4 v6, s[12:15], s54 offen offset:2048 nt lds
Mvaa 84,100,68
Ta 40,24,0
Ta 42,24,2048
Mvaa 88,104,68
Mvaa 92,108,68
Ra 8,20,4096
Mvaa 96,112,68
buffer_load_dwordx4 v7, s[12:15], s55 offen offset:3072 nt lds
Mvaa 100,116,68
s_waitcnt lgkmcnt(6)
Ta 44,25,0
Ta 46,25,2048
Mvaa 104,120,68
Mvaa 108,124,68
s_add_u32 m0, s57, 4096
Ra 12,20,6144
Mvaa 112,96,72
buffer_load_dwordx4 v8, s[12:15], s52 offen offset:0 nt lds
Mvaa 116,100,72
Ta 48,26,0
Ta 50,26,2048
Mvaa 120,104,72
Mvaa 124,108,72
Ra 16,20,8192
Mvaa 128,112,72
buffer_load_dwordx4 v9, s[12:15], s53 offen offset:1024 nt lds
Mvaa 132,116,72
s_waitcnt lgkmcnt(6)
Ta 52,27,0
Ta 54,27,2048
Mvaa 136,120,72
Mvaa 140,124,72
Ra 20,20,10240
Mvaa 144,96,76
buffer_load_dwordx4 v8, s[12:15], s54 offen offset:2048 nt lds
Mvaa 148,100,76
Ta 56,28,0
Ta 58,28,2048
Mvaa 152,104,76
Mvaa 156,108,76
Ra 24,20,12288
Mvaa 160,112,76
buffer_load_dwordx4 v9, s[12:15], s55 offen offset:3072 nt lds
Mvaa 164,116,76
s_waitcnt lgkmcnt(6)
Ta 60,29,0
Ta 62,29,2048
Mvaa 168,120,76
v_xor_b32 v6, 524288, v6
v_xor_b32 v7, 524288, v7
Mvaa 172,124,76
s_add_u32 m0, s56, 0
Ra 28,20,14336
v_xor_b32 v8, 524288, v8
Mvaa 176,96,80
buffer_load_dwordx4 v2, s[8:11], s48 offen offset:0 lds
Mvaa 180,100,80
v_xor_b32 v9, 524288, v9
Mvaa 184,104,80
Mvaa 188,108,80
Mvaa 192,112,80
buffer_load_dwordx4 v3, s[8:11], s49 offen offset:1024 lds
Mvaa 196,116,80
Mvaa 200,120,80
Mvaa 204,124,80
Mvaa 208,96,84
buffer_load_dwordx4 v2, s[8:11], s50 offen offset:2048 lds
Mvaa 212,100,84
Mvaa 216,104,84
Mvaa 220,108,84
Mvaa 224,112,84
buffer_load_dwordx4 v3, s[8:11], s51 offen offset:3072 lds
Mvaa 228,116,84
Mvaa 232,120,84
Mvaa 236,124,84
s_add_u32 m0, s56, 4096
Mvaa 240,96,88
buffer_load_dwordx4 v4, s[8:11], s48 offen offset:0 lds
Mvaa 244,100,88
Mvaa 248,104,88
Mvaa 252,108,88
Maaa 128,112,88
buffer_load_dwordx4 v5, s[8:11], s49 offen offset:1024 lds
Maaa 132,116,88
Maaa 136,120,88
Maaa 140,124,88
Maaa 144,96,92
buffer_load_dwordx4 v4, s[8:11], s50 offen offset:2048 lds
Maaa 148,100,92
Maaa 152,104,92
Maaa 156,108,92
Maaa 160,112,92
buffer_load_dwordx4 v5, s[8:11], s51 offen offset:3072 lds
Maaa 164,116,92
v_xor_b32 v2, 128, v2
v_xor_b32 v3, 128, v3
Maaa 168,120,92
v_xor_b32 v4, 128, v4
v_xor_b32 v5, 128, v5
Maaa 172,124,92
s_waitcnt lgkmcnt(0)
Mvaa 48,32,0
buffer_load_dword v44, v45, s[16:19], s47 offen
Mvaa 52,36,0
Ta 96,22,16384
Ta 98,22,18432
Mvaa 56,40,0
s_add_u32 s47, s47, 2097152
v_lshrrev_b32 v32, 4, v0
v_and_b32 v33, 15, v0
Mvaa 60,44,0
Ra 64,21,0
Mvaa 64,48,0
s_lshl_b32 s3, s32, 4
v_add_u32 v34, s3, v32
v_lshlrev_b32_e64 v36, 1, v32
Mvaa 68,52,0
Ta 100,23,16384
Ta 102,23,18432
Mvaa 72,56,0
v_xor_b32 v36, v36, v33
v_xor_b32 v37, 8, v36
Mvaa 76,60,0
s_waitcnt lgkmcnt(6)
Ra 68,21,2048
Mvaa 80,32,4
s_getpc_b64 s[6:7]
L_cpf2:
s_add_u32 s6, s6, (L_phase2-L_cpf2)&0xffffffff
s_addc_u32 s7, s7, ((L_phase2-L_cpf2)>>32)&0xffffffff
Mvaa 84,36,4
Ta 104,24,16384
Ta 106,24,18432
Mvaa 88,40,4
s_lshr_b32 s3, s2, 3
s_lshl_b32 s3, s3, 2
s_add_u32 s3, s3, s32
Mvaa 92,44,4
Ra 72,21,4096
Mvaa 96,48,4
s_lshl_b32 s3, s3, 10
v_and_b32 v42, 7, v0
v_lshlrev_b32 v42, 7, v42
Mvaa 100,52,4
Ta 108,25,16384
Ta 110,25,18432
Mvaa 104,56,4
v_add_u32_e64 v42, s3, v42
v_min_u32 v42, L_k2_fin-L_phase2-4, v42
Mvaa 108,60,4
s_waitcnt lgkmcnt(6)
Ra 76,21,6144
Mvaa 112,32,8
v_mov_b32 v41, s7
Mvaa 116,36,8
Ta 112,26,16384
Ta 114,26,18432
Mvaa 120,40,8
v_add_co_u32 v40, vcc, s6, v42
s_nop 1
v_addc_co_u32 v41, vcc, 0, v41, vcc
Mvaa 124,44,8
Ra 80,21,8192
Mvaa 128,48,8
global_load_dword v38, v[40:41], off
Mvaa 132,52,8
Ta 116,27,16384
Ta 118,27,18432
Mvaa 136,56,8
Mvaa 140,60,8
s_waitcnt lgkmcnt(6)
Ra 84,21,10240
Mvaa 144,32,12
Mvaa 148,36,12
Ta 120,28,16384
Ta 122,28,18432
Mvaa 152,40,12
Mvaa 156,44,12
Ra 88,21,12288
Mvaa 160,48,12
Mvaa 164,52,12
Ta 124,29,16384
Ta 126,29,18432
Mvaa 168,56,12
Mvaa 172,60,12
s_waitcnt lgkmcnt(6)
Ra 92,21,14336
Mvaa 176,32,16
Mvaa 180,36,16
Mvaa 184,40,16
Mvaa 188,44,16
Mvaa 192,48,16
Mvaa 196,52,16
Mvaa 200,56,16
Mvaa 204,60,16
Mvaa 208,32,20
Mvaa 212,36,20
Mvaa 216,40,20
Mvaa 220,44,20
Mvaa 224,48,20
Mvaa 228,52,20
Mvaa 232,56,20
Mvaa 236,60,20
Mvaa 240,32,24
Mvaa 244,36,24
Mvaa 248,40,24
Mvaa 252,44,24
Maaa 128,48,24
Maaa 132,52,24
Maaa 136,56,24
Maaa 140,60,24
Maaa 144,32,28
Maaa 148,36,28
Maaa 152,40,28
Maaa 156,44,28
Maaa 160,48,28
Maaa 164,52,28
Maaa 168,56,28
Maaa 172,60,28
s_waitcnt vmcnt(2) lgkmcnt(0)
s_add_u32 m0, s57, 65536
s_barrier
Mvaa 48,96,64
buffer_load_dwordx4 v6, s[12:15], s52 offen offset:0 nt lds
Mvaa 52,100,64
Ta 32,12,0
Ta 34,12,2048
Mvaa 56,104,64
Mvaa 60,108,64
Ra 0,10,0
Mvaa 64,112,64
buffer_load_dwordx4 v7, s[12:15], s53 offen offset:1024 nt lds
Mvaa 68,116,64
s_waitcnt lgkmcnt(6)
Ta 36,13,0
Ta 38,13,2048
Mvaa 72,120,64
Mvaa 76,124,64
Ra 4,10,2048
Mvaa 80,96,68
buffer_load_dwordx4 v6, s[12:15], s54 offen offset:2048 nt lds
Mvaa 84,100,68
Ta 40,14,0
Ta 42,14,2048
Mvaa 88,104,68
Mvaa 92,108,68
Ra 8,10,4096
Mvaa 96,112,68
buffer_load_dwordx4 v7, s[12:15], s55 offen offset:3072 nt lds
Mvaa 100,116,68
s_waitcnt lgkmcnt(6)
Ta 44,15,0
Ta 46,15,2048
Mvaa 104,120,68
Mvaa 108,124,68
s_add_u32 m0, s57, 69632
Ra 12,10,6144
Mvaa 112,96,72
buffer_load_dwordx4 v8, s[12:15], s52 offen offset:0 nt lds
Mvaa 116,100,72
Ta 48,16,0
Ta 50,16,2048
Mvaa 120,104,72
Mvaa 124,108,72
Ra 16,10,8192
Mvaa 128,112,72
buffer_load_dwordx4 v9, s[12:15], s53 offen offset:1024 nt lds
Mvaa 132,116,72
s_waitcnt lgkmcnt(6)
Ta 52,17,0
Ta 54,17,2048
Mvaa 136,120,72
Mvaa 140,124,72
Ra 20,10,10240
Mvaa 144,96,76
buffer_load_dwordx4 v8, s[12:15], s54 offen offset:2048 nt lds
Mvaa 148,100,76
Ta 56,18,0
Ta 58,18,2048
Mvaa 152,104,76
Mvaa 156,108,76
Ra 24,10,12288
Mvaa 160,112,76
buffer_load_dwordx4 v9, s[12:15], s55 offen offset:3072 nt lds
Mvaa 164,116,76
s_waitcnt lgkmcnt(6)
Ta 60,19,0
Ta 62,19,2048
Mvaa 168,120,76
Mvaa 172,124,76
s_add_u32 m0, s56, 65536
Ra 28,10,14336
Mvaa 176,96,80
buffer_load_dwordx4 v2, s[8:11], s48 offen offset:0 lds
Mvaa 180,100,80
Mvaa 184,104,80
Mvaa 188,108,80
Mvaa 192,112,80
buffer_load_dwordx4 v3, s[8:11], s49 offen offset:1024 lds
Mvaa 196,116,80
Mvaa 200,120,80
Mvaa 204,124,80
Mvaa 208,96,84
buffer_load_dwordx4 v2, s[8:11], s50 offen offset:2048 lds
Mvaa 212,100,84
Mvaa 216,104,84
Mvaa 220,108,84
Mvaa 224,112,84
buffer_load_dwordx4 v3, s[8:11], s51 offen offset:3072 lds
Mvaa 228,116,84
Mvaa 232,120,84
Mvaa 236,124,84
s_add_u32 m0, s56, 69632
Mvaa 240,96,88
buffer_load_dwordx4 v4, s[8:11], s48 offen offset:0 lds
Mvaa 244,100,88
Mvaa 248,104,88
Mvaa 252,108,88
Maaa 128,112,88
buffer_load_dwordx4 v5, s[8:11], s49 offen offset:1024 lds
Maaa 132,116,88
Maaa 136,120,88
Maaa 140,124,88
Maaa 144,96,92
buffer_load_dwordx4 v4, s[8:11], s50 offen offset:2048 lds
Maaa 148,100,92
Maaa 152,104,92
Maaa 156,108,92
Maaa 160,112,92
buffer_load_dwordx4 v5, s[8:11], s51 offen offset:3072 lds
Maaa 164,116,92
Maaa 168,120,92
Maaa 172,124,92
s_waitcnt lgkmcnt(0)
Mvaa 48,32,0
buffer_load_dword v30, v31, s[28:31], s37 offen sc1
Mvaa 52,36,0
Ta 96,12,16384
Ta 98,12,18432
Mvaa 56,40,0
s_mov_b32 s8, s16
s_mov_b32 s9, s17
s_mov_b32 s10, s18
Mvaa 60,44,0
Ra 64,11,0
Mvaa 64,48,0
s_add_u32 s16, s66, 46137344
s_addc_u32 s17, s67, 0
s_and_b32 s17, s17, 0xffff
Mvaa 68,52,0
Ta 100,13,16384
Ta 102,13,18432
Mvaa 72,56,0
s_mov_b32 s18, 16777216
s_mov_b32 s19, 0x20000
s_mov_b32 s48, 0
Mvaa 76,60,0
s_waitcnt lgkmcnt(6)
Ra 68,11,2048
Mvaa 80,32,4
s_mov_b32 s49, 31744
s_mov_b32 s50, 63488
s_mov_b32 s51, 95232
Mvaa 84,36,4
Ta 104,14,16384
Ta 106,14,18432
Mvaa 88,40,4
v_lshlrev_b32_e64 v35, 13, v34
v_lshl_add_u32 v8, v36, 4, v35
Mvaa 92,44,4
Ra 72,11,4096
Mvaa 96,48,4
v_lshl_add_u32 v9, v37, 4, v35
v_lshlrev_b32_e64 v2, 4, v0
Mvaa 100,52,4
Ta 108,15,16384
Ta 110,15,18432
Mvaa 104,56,4
v_add_u32 v3, 65536, v2
v_add_u32_e64 v4, s44, v2
Mvaa 108,60,4
s_waitcnt lgkmcnt(6)
Ra 76,11,6144
Mvaa 112,32,8
v_mov_b32 v7, 0
v_lshlrev_b32_e64 v35, 2, v32
Mvaa 116,36,8
Ta 112,16,16384
Ta 114,16,18432
Mvaa 120,40,8
v_sub_u32_e64 v35, v33, v35
Mvaa 124,44,8
Ra 80,11,8192
Mvaa 128,48,8
s_lshl_b32 s3, s32, 4
v_add_u32 v5, s3, v35
Mvaa 132,52,8
Ta 116,17,16384
Ta 118,17,18432
Mvaa 136,56,8
s_sub_u32 s3, 48, s3
v_add_u32 v6, s3, v35
Mvaa 140,60,8
s_waitcnt lgkmcnt(6)
Ra 84,11,10240
Mvaa 144,32,12
s_mul_i32 s3, s33, 1116160
s_add_u32 s3, s3, 8388608
s_add_u32 s12, s66, s3
s_addc_u32 s13, s67, 0
s_and_b32 s13, s13, 0xffff
Mvaa 148,36,12
Ta 120,18,16384
Ta 122,18,18432
Mvaa 152,40,12
s_mov_b32 s14, 0
s_mov_b32 s15, 0x20000
s_mul_i32 s14, s36, 34816
Mvaa 156,44,12
Ra 88,11,12288
Mvaa 160,48,12
buffer_load_dword v44, v45, s[8:11], s47 offen
Mvaa 164,52,12
Ta 124,19,16384
Ta 126,19,18432
Mvaa 168,56,12
s_add_u32 s47, s47, 2097152
Mvaa 172,60,12
s_waitcnt lgkmcnt(6)
Ra 92,11,14336
Mvaa 176,32,16
Mvaa 180,36,16
Mvaa 184,40,16
Mvaa 188,44,16
Mvaa 192,48,16
Mvaa 196,52,16
Mvaa 200,56,16
Mvaa 204,60,16
Mvaa 208,32,20
Mvaa 212,36,20
Mvaa 216,40,20
Mvaa 220,44,20
Mvaa 224,48,20
Mvaa 228,52,20
Mvaa 232,56,20
Mvaa 236,60,20
Mvaa 240,32,24
Mvaa 244,36,24
Mvaa 248,40,24
Mvaa 252,44,24
Maaa 128,48,24
Maaa 132,52,24
Maaa 136,56,24
Maaa 140,60,24
Maaa 144,32,28
Maaa 148,36,28
Maaa 152,40,28
Maaa 156,44,28
Maaa 160,48,28
Maaa 164,52,28
Maaa 168,56,28
Maaa 172,60,28
s_waitcnt vmcnt(2) lgkmcnt(0)
s_add_u32 m0, s44, 0
s_barrier
Mvaa 48,96,64
buffer_load_dwordx4 v8, s[8:11], s48 offen offset:0 lds
Mvaa 52,100,64
Ta 32,22,0
Ta 34,22,2048
Mvaa 56,104,64
s_mul_i32 s3, s45, 33792
v_add_u32_e64 v10, s3, v2
Mvaa 60,108,64
Ra 0,20,0
Mvaa 64,112,64
buffer_load_dwordx4 v8, s[8:11], s49 offen offset:1024 lds
Mvaa 68,116,64
s_waitcnt lgkmcnt(6)
Ta 36,23,0
Ta 38,23,2048
Mvaa 72,120,64
s_mul_i32 s3, s46, 33792
v_add_u32 v11, s3, v2
v_mov_b32_e64 v14, v40
Mvaa 76,124,64
Ra 4,20,2048
Mvaa 80,96,68
buffer_load_dwordx4 v9, s[8:11], s50 offen offset:2048 lds
Mvaa 84,100,68
Ta 40,24,0
Ta 42,24,2048
Mvaa 88,104,68
v_mov_b32_e64 v15, v41
Mvaa 92,108,68
Ra 8,20,4096
Mvaa 96,112,68
buffer_load_dwordx4 v9, s[8:11], s51 offen offset:3072 lds
Mvaa 100,116,68
s_waitcnt lgkmcnt(6)
Ta 44,25,0
Ta 46,25,2048
Mvaa 104,120,68
v_add_u32 v8, 524288, v8
v_add_u32 v9, 524288, v9
Mvaa 108,124,68
s_add_u32 m0, s44, 16384
Ra 12,20,6144
Mvaa 112,96,72
buffer_load_dwordx4 v8, s[8:11], s48 offen offset:0 lds
Mvaa 116,100,72
Ta 48,26,0
Ta 50,26,2048
Mvaa 120,104,72
Mvaa 124,108,72
Ra 16,20,8192
Mvaa 128,112,72
buffer_load_dwordx4 v8, s[8:11], s49 offen offset:1024 lds
Mvaa 132,116,72
s_waitcnt lgkmcnt(6)
Ta 52,27,0
Ta 54,27,2048
Mvaa 136,120,72
Mvaa 140,124,72
Ra 20,20,10240
Mvaa 144,96,76
buffer_load_dwordx4 v9, s[8:11], s50 offen offset:2048 lds
Mvaa 148,100,76
Ta 56,28,0
Ta 58,28,2048
Mvaa 152,104,76
Mvaa 156,108,76
Ra 24,20,12288
Mvaa 160,112,76
buffer_load_dwordx4 v9, s[8:11], s51 offen offset:3072 lds
Mvaa 164,116,76
s_waitcnt lgkmcnt(6)
Ta 60,29,0
Ta 62,29,2048
Mvaa 168,120,76
v_add_u32 v8, 524288, v8
v_add_u32 v9, 524288, v9
Mvaa 172,124,76
s_add_u32 m0, s44, 32768
Ra 28,20,14336
Mvaa 176,96,80
buffer_load_dwordx4 v8, s[8:11], s48 offen offset:0 lds
Mvaa 180,100,80
Mvaa 184,104,80
Mvaa 188,108,80
Mvaa 192,112,80
buffer_load_dwordx4 v8, s[8:11], s49 offen offset:1024 lds
Mvaa 196,116,80
Mvaa 200,120,80
Mvaa 204,124,80
Mvaa 208,96,84
buffer_load_dwordx4 v9, s[8:11], s50 offen offset:2048 lds
Mvaa 212,100,84
Mvaa 216,104,84
Mvaa 220,108,84
Mvaa 224,112,84
buffer_load_dwordx4 v9, s[8:11], s51 offen offset:3072 lds
Mvaa 228,116,84
v_add_u32 v8, 524288, v8
v_add_u32 v9, 524288, v9
Mvaa 232,120,84
Mvaa 236,124,84
s_add_u32 m0, s44, 49152
Mvaa 240,96,88
buffer_load_dwordx4 v8, s[8:11], s48 offen offset:0 lds
Mvaa 244,100,88
Mvaa 248,104,88
Mvaa 252,108,88
Maaa 128,112,88
buffer_load_dwordx4 v8, s[8:11], s49 offen offset:1024 lds
Maaa 132,116,88
Maaa 136,120,88
Maaa 140,124,88
Maaa 144,96,92
buffer_load_dwordx4 v9, s[8:11], s50 offen offset:2048 lds
Maaa 148,100,92
Maaa 152,104,92
Maaa 156,108,92
Maaa 160,112,92
buffer_load_dwordx4 v9, s[8:11], s51 offen offset:3072 lds
Maaa 164,116,92
v_add_u32 v8, 524288, v8
v_add_u32 v9, 524288, v9
Maaa 168,120,92
Maaa 172,124,92
s_waitcnt lgkmcnt(0)
Mvaa 48,32,0
Mvaa 52,36,0
Ta 96,22,16384
Ta 98,22,18432
Mvaa 56,40,0
Mvaa 60,44,0
Ra 64,21,0
Mvaa 64,48,0
Mvaa 68,52,0
Ta 100,23,16384
Ta 102,23,18432
Mvaa 72,56,0
Mvaa 76,60,0
s_waitcnt lgkmcnt(6)
Ra 68,21,2048
Mvaa 80,32,4
Mvaa 84,36,4
Ta 104,24,16384
Ta 106,24,18432
Mvaa 88,40,4
Mvaa 92,44,4
Ra 72,21,4096
Mvaa 96,48,4
Mvaa 100,52,4
Ta 108,25,16384
Ta 110,25,18432
Mvaa 104,56,4
Mvaa 108,60,4
s_waitcnt lgkmcnt(6)
Ra 76,21,6144
Mvaa 112,32,8
Mvaa 116,36,8
Ta 112,26,16384
Ta 114,26,18432
Mvaa 120,40,8
Mvaa 124,44,8
Ra 80,21,8192
Mvaa 128,48,8
Mvaa 132,52,8
Ta 116,27,16384
Ta 118,27,18432
Mvaa 136,56,8
Mvaa 140,60,8
s_waitcnt lgkmcnt(6)
Ra 84,21,10240
Mvaa 144,32,12
Mvaa 148,36,12
Ta 120,28,16384
Ta 122,28,18432
Mvaa 152,40,12
Mvaa 156,44,12
Ra 88,21,12288
Mvaa 160,48,12
Mvaa 164,52,12
Ta 124,29,16384
Ta 126,29,18432
Mvaa 168,56,12
Mvaa 172,60,12
s_waitcnt lgkmcnt(6)
Ra 92,21,14336
Mvaa 176,32,16
Mvaa 180,36,16
Mvaa 184,40,16
Mvaa 188,44,16
Mvaa 192,48,16
Mvaa 196,52,16
Mvaa 200,56,16
Mvaa 204,60,16
Mvaa 208,32,20
Mvaa 212,36,20
Mvaa 216,40,20
Mvaa 220,44,20
Mvaa 224,48,20
Mvaa 228,52,20
Mvaa 232,56,20
Mvaa 236,60,20
Mvaa 240,32,24
Mvaa 244,36,24
Mvaa 248,40,24
Mvaa 252,44,24
Maaa 128,48,24
Maaa 132,52,24
Maaa 136,56,24
Maaa 140,60,24
Maaa 144,32,28
Maaa 148,36,28
Maaa 152,40,28
Maaa 156,44,28
Maaa 160,48,28
Maaa 164,52,28
Maaa 168,56,28
Maaa 172,60,28
s_waitcnt vmcnt(12) lgkmcnt(0)
v_readfirstlane_b32 s3, v30
s_nop 0
s_or_b32 s3, s3, s37
s_cmp_lt_u32 s3, 256
s_cbranch_scc1 L_spinAk
L_spinArk:
s_barrier
Mvaa 48,96,64
buffer_load_dwordx4 a[0:3], v10, s[20:23], s58 offen offset:0 sc1
Mvaa 52,100,64
v_lshrrev_b32_e64 v42, 2, v33
v_lshl_add_u32 v43, v32, 3, v42
Mvaa 56,104,64
v_lshlrev_b32 v43, 8, v43
v_and_b32 v44, 3, v0
Mvaa 60,108,64
v_lshl_add_u32 v43, v44, 3, v43
v_and_b32_e64 v44, 1, v32
Mvaa 64,112,64
buffer_load_dwordx4 a[4:7], v10, s[20:23], 0 offen offset:0 sc1
Mvaa 68,116,64
v_lshl_add_u32 v42, v44, 2, v42
v_xor_b32_e64 v44, 0, v42
Mvaa 72,120,64
v_lshl_add_u32 v16, v44, 5, v43
v_xor_b32_e64 v44, 1, v42
Mvaa 76,124,64
v_lshl_add_u32 v17, v44, 5, v43
v_xor_b32_e64 v44, 2, v42
Mvaa 80,96,68
buffer_load_dwordx4 a[8:11], v11, s[20:23], s58 offen offset:0 sc1
Mvaa 84,100,68
v_lshl_add_u32 v18, v44, 5, v43
v_xor_b32_e64 v44, 3, v42
Mvaa 88,104,68
v_lshl_add_u32 v19, v44, 5, v43
v_xor_b32_e64 v44, 4, v42
Mvaa 92,108,68
v_lshl_add_u32 v20, v44, 5, v43
v_xor_b32_e64 v44, 5, v42
Mvaa 96,112,68
buffer_load_dwordx4 a[12:15], v11, s[20:23], 0 offen offset:0 sc1
Mvaa 100,116,68
v_lshl_add_u32 v21, v44, 5, v43
v_xor_b32_e64 v44, 6, v42
Mvaa 104,120,68
v_lshl_add_u32 v22, v44, 5, v43
v_xor_b32_e64 v44, 7, v42
Mvaa 108,124,68
v_lshl_add_u32 v23, v44, 5, v43
Mvaa 112,96,72
buffer_load_dwordx4 a[16:19], v10, s[20:23], s58 offen offset:1024 sc1
Mvaa 116,100,72
Mvaa 120,104,72
Mvaa 124,108,72
Mvaa 128,112,72
buffer_load_dwordx4 a[20:23], v10, s[20:23], 0 offen offset:1024 sc1
Mvaa 132,116,72
Ta 192,16,0
Ta 194,16,1024
Mvaa 136,120,72
Ta 196,17,0
Ta 198,17,1024
Mvaa 140,124,72
Ta 200,18,0
Ta 202,18,1024
Mvaa 144,96,76
buffer_load_dwordx4 a[24:27], v11, s[20:23], s58 offen offset:1024 sc1
Mvaa 148,100,76
Ta 204,19,0
Ta 206,19,1024
Mvaa 152,104,76
Ta 208,20,0
Ta 210,20,1024
Mvaa 156,108,76
Ta 212,21,0
Ta 214,21,1024
Mvaa 160,112,76
buffer_load_dwordx4 a[28:31], v11, s[20:23], 0 offen offset:1024 sc1
Mvaa 164,116,76
Ta 216,22,0
Ta 218,22,1024
Mvaa 168,120,76
Ta 220,23,0
s_waitcnt lgkmcnt(9)
Ta 222,23,1024
Mvaa 172,124,76
s_waitcnt lgkmcnt(8)
Vc 24,48,49
Vc 25,50,51
Mvaa 176,96,80
buffer_load_dwordx4 a[32:35], v10, s[20:23], s58 offen offset:2048 sc1
Mvaa 180,100,80
Vc 26,52,53
Vc 27,54,55
Mvaa 184,104,80
Vc 28,56,57
Vc 29,58,59
Mvaa 188,108,80
Vc 30,60,61
Vc 31,62,63
Mvaa 192,112,80
buffer_load_dwordx4 a[36:39], v10, s[20:23], 0 offen offset:2048 sc1
Mvaa 196,116,80
Vc 32,64,65
Vc 33,66,67
Mvaa 200,120,80
Vc 34,68,69
Vc 35,70,71
Mvaa 204,124,80
Vc 36,72,73
Vc 37,74,75
Mvaa 208,96,84
buffer_load_dwordx4 a[40:43], v11, s[20:23], s58 offen offset:2048 sc1
Mvaa 212,100,84
Vc 38,76,77
Vc 39,78,79
Mvaa 216,104,84
Vc 40,80,81
Vc 41,82,83
Mvaa 220,108,84
Vc 42,84,85
Vc 43,86,87
Mvaa 224,112,84
buffer_load_dwordx4 a[44:47], v11, s[20:23], 0 offen offset:2048 sc1
Mvaa 228,116,84
Vc 44,88,89
Vc 45,90,91
Mvaa 232,120,84
Vc 46,92,93
Vc 47,94,95
Mvaa 236,124,84
Vc 48,96,97
Vc 49,98,99
Mvaa 240,96,88
buffer_load_dwordx4 a[48:51], v10, s[20:23], s58 offen offset:3072 sc1
Mvaa 244,100,88
Vc 50,100,101
Vc 51,102,103
Mvaa 248,104,88
Vc 52,104,105
Vc 53,106,107
Mvaa 252,108,88
Vc 54,108,109
Vc 55,110,111
Maaa 128,112,88
buffer_load_dwordx4 a[52:55], v10, s[20:23], 0 offen offset:3072 sc1
Maaa 132,116,88
Vc 56,112,113
Vc 57,114,115
Maaa 136,120,88
Vc 58,116,117
Vc 59,118,119
Maaa 140,124,88
Vc 60,120,121
Vc 61,122,123
Maaa 144,96,92
buffer_load_dwordx4 a[56:59], v11, s[20:23], s58 offen offset:3072 sc1
Maaa 148,100,92
Vc 62,124,125
Vc 63,126,127
Maaa 152,104,92
Vc 64,128,129
Vc 65,130,131
Maaa 156,108,92
Vc 66,132,133
Vc 67,134,135
Maaa 160,112,92
buffer_load_dwordx4 a[60:63], v11, s[20:23], 0 offen offset:3072 sc1
Maaa 164,116,92
v_add_u32 v10, 4096, v10
v_add_u32 v11, 4096, v11
Maaa 168,120,92
Vc 68,136,137
Vc 69,138,139
Maaa 172,124,92
Vc 70,140,141
Vc 71,142,143
Vc 72,144,145
Vc 73,146,147
Vc 74,148,149
Vc 75,150,151
Vc 76,152,153
Vc 77,154,155
Vc 78,156,157
Vc 79,158,159
Vc 80,160,161
Vc 81,162,163
Vc 82,164,165
Vc 83,166,167
Vc 84,168,169
Vc 85,170,171
Vc 86,172,173
Vc 87,174,175
Vc 88,176,177
Vc 89,178,179
Vc 90,180,181
Vc 91,182,183
Vc 92,184,185
Vc 93,186,187
Vc 94,188,189
Vc 95,190,191
Vc 96,192,193
Vc 97,194,195
Vc 98,196,197
Vc 99,198,199
Vc 100,200,201
Vc 101,202,203
Vc 102,204,205
Vc 103,206,207
Vc 104,208,209
Vc 105,210,211
Vc 106,212,213
Vc 107,214,215
Vc 108,216,217
Vc 109,218,219
Vc 110,220,221
Vc 111,222,223
Vc 112,224,225
Vc 113,226,227
Vc 114,228,229
Vc 115,230,231
Vc 116,232,233
Vc 117,234,235
Vc 118,236,237
Vc 119,238,239
Vc 120,240,241
Vc 121,242,243
Vc 122,244,245
Vc 123,246,247
Vc 124,248,249
Vc 125,250,251
Vc 126,252,253
Vc 127,254,255
s_branch L_phase2
L_k1_vpath:
s_waitcnt lgkmcnt(0)
s_add_u32 m0, s57, 65536
Zvaa 48,0,32
buffer_load_dwordx4 v6, s[12:15], s52 offen offset:0 nt lds
Zvaa 64,0,36
Ta 96,12,16384
Ta 98,12,18432
Zvaa 80,0,40
buffer_load_dwordx4 v7, s[12:15], s53 offen offset:1024 nt lds
Zvaa 96,0,44
Ra 64,11,0
Zvaa 112,0,48
buffer_load_dwordx4 v6, s[12:15], s54 offen offset:2048 nt lds
Zvaa 128,0,52
Ta 100,13,16384
Ta 102,13,18432
Zvaa 144,0,56
buffer_load_dwordx4 v7, s[12:15], s55 offen offset:3072 nt lds
Zvaa 160,0,60
s_add_u32 m0, s57, 69632
s_waitcnt lgkmcnt(6)
Ra 68,11,2048
Zvaa 52,4,32
buffer_load_dwordx4 v8, s[12:15], s52 offen offset:0 nt lds
Zvaa 68,4,36
Ta 104,14,16384
Ta 106,14,18432
Zvaa 84,4,40
buffer_load_dwordx4 v9, s[12:15], s53 offen offset:1024 nt lds
Zvaa 100,4,44
Ra 72,11,4096
Zvaa 116,4,48
buffer_load_dwordx4 v8, s[12:15], s54 offen offset:2048 nt lds
Zvaa 132,4,52
Ta 108,15,16384
Ta 110,15,18432
Zvaa 148,4,56
buffer_load_dwordx4 v9, s[12:15], s55 offen offset:3072 nt lds
Zvaa 164,4,60
s_add_u32 m0, s56, 65536
s_waitcnt lgkmcnt(6)
Ra 76,11,6144
Zvaa 56,8,32
buffer_load_dwordx4 v2, s[8:11], s48 offen offset:0 lds
Zvaa 72,8,36
Ta 112,16,16384
Ta 114,16,18432
Zvaa 88,8,40
buffer_load_dwordx4 v3, s[8:11], s49 offen offset:1024 lds
Zvaa 104,8,44
Ra 80,11,8192
v_xor_b32 v6, 1572864, v6
Zvaa 120,8,48
buffer_load_dwordx4 v2, s[8:11], s50 offen offset:2048 lds
Zvaa 136,8,52
Ta 116,17,16384
Ta 118,17,18432
Zvaa 152,8,56
buffer_load_dwordx4 v3, s[8:11], s51 offen offset:3072 lds
Zvaa 168,8,60
s_add_u32 m0, s56, 69632
s_waitcnt lgkmcnt(6)
Ra 84,11,10240
Zvaa 60,12,32
buffer_load_dwordx4 v4, s[8:11], s48 offen offset:0 lds
Zvaa 76,12,36
Ta 120,18,16384
Ta 122,18,18432
Zvaa 92,12,40
buffer_load_dwordx4 v5, s[8:11], s49 offen offset:1024 lds
Zvaa 108,12,44
Ra 88,11,12288
v_xor_b32 v7, 1572864, v7
Zvaa 124,12,48
buffer_load_dwordx4 v4, s[8:11], s50 offen offset:2048 lds
Zvaa 140,12,52
Ta 124,19,16384
Ta 126,19,18432
Zvaa 156,12,56
buffer_load_dwordx4 v5, s[8:11], s51 offen offset:3072 lds
Zvaa 172,12,60
s_waitcnt lgkmcnt(6)
Ra 92,11,14336
Zvaa 176,16,32
v_and_b32_e64 v46, 7, v0
v_mul_u32_u24 v30, 2064, v46
Zvaa 192,16,36
v_xor_b32 v8, 1572864, v8
v_xor_b32 v9, 1572864, v9
Zvaa 208,16,40
v_lshrrev_b32_e64 v31, 3, v0
Zvaa 224,16,44
v_xor_b32 v2, 384, v2
v_xor_b32 v3, 384, v3
Zvaa 240,16,48
s_lshl_b32 s3, s32, 9
s_add_u32 s3, s3, 131072
v_lshl_add_u32 v30, v31, 4, v30
Zaaa 128,16,52
v_xor_b32 v4, 384, v4
v_xor_b32 v5, 384, v5
Zaaa 144,16,56
v_add_u32 v30, s3, v30
v_lshlrev_b32_e64 v31, 8, v31
Zaaa 160,16,60
v_lshl_add_u32 v46, v46, 4, v31
Zvaa 180,20,32
buffer_load_dword v1, v47, s[60:63], 0 offen
Zvaa 196,20,36
s_mul_i32 vcc_lo, s59, 7
v_xor_b32 v47, vcc_lo, v47
Zvaa 212,20,40
Rv 34,30,128
Rv 38,30,256
Zvaa 228,20,44
Rv 42,30,384
Rv 30,30,0
Zvaa 244,20,48
buffer_load_dword v1, v47, s[60:63], 0 offen
Zaaa 132,20,52
s_mul_i32 vcc_lo, s59, 1
v_xor_b32 v47, vcc_lo, v47
Zaaa 148,20,56
s_lshr_b32 s3, s2, 1
s_mul_i32 s3, s3, 33792
s_add_u32 s3, s3, s56
Zaaa 164,20,60
s_and_b32 s39, s2, 1
s_lshl_b32 s39, s39, 7
s_add_u32 s3, s3, s39
Zvaa 184,24,32
s_add_u32 s39, s3, 4096
Zvaa 200,24,36
Zvaa 216,24,40
Zvaa 232,24,44
Zvaa 248,24,48
Zaaa 136,24,52
Zaaa 152,24,56
Zaaa 168,24,60
Zvaa 188,28,32
Zvaa 204,28,36
Zvaa 220,28,40
Zvaa 236,28,44
Zvaa 252,28,48
Zaaa 140,28,52
Zaaa 156,28,56
Zaaa 172,28,60
s_waitcnt vmcnt(2) lgkmcnt(0)
s_add_u32 m0, s57, 0
s_barrier
Mvaa 48,64,96
buffer_load_dwordx4 v6, s[12:15], s52 offen offset:0 nt lds
Mvaa 64,64,100
Ta 32,22,0
Ta 34,22,2048
Mvaa 80,64,104
Mvaa 96,64,108
Ra 0,20,0
Mvaa 112,64,112
buffer_load_dwordx4 v7, s[12:15], s53 offen offset:1024 nt lds
Mvaa 128,64,116
s_waitcnt lgkmcnt(6)
Ta 36,23,0
Ta 38,23,2048
Mvaa 144,64,120
Mvaa 160,64,124
Ra 4,20,2048
Mvaa 52,68,96
buffer_load_dwordx4 v6, s[12:15], s54 offen offset:2048 nt lds
Mvaa 68,68,100
Ta 40,24,0
Ta 42,24,2048
Mvaa 84,68,104
Mvaa 100,68,108
Ra 8,20,4096
Mvaa 116,68,112
buffer_load_dwordx4 v7, s[12:15], s55 offen offset:3072 nt lds
Mvaa 132,68,116
s_waitcnt lgkmcnt(6)
Ta 44,25,0
Ta 46,25,2048
Mvaa 148,68,120
Mvaa 164,68,124
s_add_u32 m0, s57, 4096
Ra 12,20,6144
Mvaa 56,72,96
buffer_load_dwordx4 v8, s[12:15], s52 offen offset:0 nt lds
Mvaa 72,72,100
Ta 48,26,0
Ta 50,26,2048
Mvaa 88,72,104
Mvaa 104,72,108
Ra 16,20,8192
Mvaa 120,72,112
buffer_load_dwordx4 v9, s[12:15], s53 offen offset:1024 nt lds
Mvaa 136,72,116
s_waitcnt lgkmcnt(6)
Ta 52,27,0
Ta 54,27,2048
Mvaa 152,72,120
Mvaa 168,72,124
Ra 20,20,10240
Mvaa 60,76,96
buffer_load_dwordx4 v8, s[12:15], s54 offen offset:2048 nt lds
Mvaa 76,76,100
Ta 56,28,0
Ta 58,28,2048
Mvaa 92,76,104
Mvaa 108,76,108
Ra 24,20,12288
Mvaa 124,76,112
buffer_load_dwordx4 v9, s[12:15], s55 offen offset:3072 nt lds
Mvaa 140,76,116
s_waitcnt lgkmcnt(6)
Ta 60,29,0
Ta 62,29,2048
Mvaa 156,76,120
v_xor_b32 v6, 524288, v6
v_xor_b32 v7, 524288, v7
Mvaa 172,76,124
s_add_u32 m0, s56, 0
Ra 28,20,14336
v_xor_b32 v8, 524288, v8
Mvaa 176,80,96
buffer_load_dwordx4 v2, s[8:11], s48 offen offset:0 lds
Mvaa 192,80,100
v_xor_b32 v9, 524288, v9
Mvaa 208,80,104
Mvaa 224,80,108
Mvaa 240,80,112
buffer_load_dwordx4 v3, s[8:11], s49 offen offset:1024 lds
Maaa 128,80,116
Maaa 144,80,120
Maaa 160,80,124
Mvaa 180,84,96
buffer_load_dwordx4 v2, s[8:11], s50 offen offset:2048 lds
Mvaa 196,84,100
Mvaa 212,84,104
Mvaa 228,84,108
Mvaa 244,84,112
buffer_load_dwordx4 v3, s[8:11], s51 offen offset:3072 lds
Maaa 132,84,116
Maaa 148,84,120
Maaa 164,84,124
s_add_u32 m0, s56, 4096
Mvaa 184,88,96
buffer_load_dwordx4 v4, s[8:11], s48 offen offset:0 lds
Mvaa 200,88,100
Mvaa 216,88,104
Mvaa 232,88,108
Mvaa 248,88,112
buffer_load_dwordx4 v5, s[8:11], s49 offen offset:1024 lds
Maaa 136,88,116
Maaa 152,88,120
Maaa 168,88,124
Mvaa 188,92,96
buffer_load_dwordx4 v4, s[8:11], s50 offen offset:2048 lds
Mvaa 204,92,100
Mvaa 220,92,104
Mvaa 236,92,108
Mvaa 252,92,112
buffer_load_dwordx4 v5, s[8:11], s51 offen offset:3072 lds
Maaa 140,92,116
v_xor_b32 v2, 128, v2
v_xor_b32 v3, 128, v3
Maaa 156,92,120
buffer_load_dword v1, v47, s[60:63], 0 offen
v_xor_b32 v4, 128, v4
v_xor_b32 v5, 128, v5
Maaa 172,92,124
s_mul_i32 vcc_lo, s59, 3
v_xor_b32 v47, vcc_lo, v47
s_waitcnt lgkmcnt(0)
Mvaa 48,0,32
buffer_store_dwordx4 v[30:33], v46, s[20:23], s3 offen offset:0 sc1
Mvaa 64,0,36
Ta 96,22,16384
Ta 98,22,18432
Mvaa 80,0,40
buffer_store_dwordx4 v[34:37], v46, s[20:23], s3 offen offset:2048 sc1
Mvaa 96,0,44
Ra 64,21,0
Mvaa 112,0,48
buffer_store_dwordx4 v[38:41], v46, s[20:23], s39 offen offset:0 sc1
Mvaa 128,0,52
Ta 100,23,16384
Ta 102,23,18432
Mvaa 144,0,56
buffer_store_dwordx4 v[42:45], v46, s[20:23], s39 offen offset:2048 sc1
Mvaa 160,0,60
s_waitcnt lgkmcnt(6)
Ra 68,21,2048
Mvaa 52,4,32
s_lshl_b32 s3, s34, 1
s_and_b32 s36, s32, 1
s_add_u32 s3, s3, s36
Mvaa 68,4,36
Ta 104,24,16384
Ta 106,24,18432
Mvaa 84,4,40
s_mul_i32 s3, s3, 1116160
s_mul_i32 s36, s33, 139264
s_add_u32 s3, s3, s36
Mvaa 100,4,44
Ra 72,21,4096
Mvaa 116,4,48
s_lshr_b32 s36, s32, 1
s_mul_i32 s36, s36, 69632
s_add_u32 s3, s3, s36
Mvaa 132,4,52
Ta 108,25,16384
Ta 110,25,18432
Mvaa 148,4,56
s_add_u32 s38, s3, 17408
s_lshl_b32 s39, s34, 7
s_lshl_b32 s36, s33, 2
Mvaa 164,4,60
s_waitcnt lgkmcnt(6)
Ra 76,21,6144
Mvaa 56,8,32
s_add_u32 s39, s39, s36
s_add_u32 s39, s39, 5296160
v_mov_b32 v30, 1
Mvaa 72,8,36
Ta 112,26,16384
Ta 114,26,18432
Mvaa 88,8,40
v_mov_b32_e64 v31, 0
Mvaa 104,8,44
Ra 80,21,8192
Mvaa 120,8,48
s_cmp_eq_u32 s32, 0
s_cselect_b32 s39, s39, 2146435072
Mvaa 136,8,52
Ta 116,27,16384
Ta 118,27,18432
Mvaa 152,8,56
s_mov_b64 exec, 1
buffer_store_dword v31, v31, s[20:23], s39 offen sc1
s_mov_b64 exec, -1
Mvaa 168,8,60
s_waitcnt lgkmcnt(6)
Ra 84,21,10240
Mvaa 60,12,32
s_and_b32 s33, s2, 7
s_lshl_b32 s33, s33, 2
s_bfe_u32 s3, s2, 0x20003
Mvaa 76,12,36
Ta 120,28,16384
Ta 122,28,18432
Mvaa 92,12,40
s_add_u32 s33, s33, s3
s_lshr_b32 s34, s2, 5
s_lshl_b32 s64, s34, 7
Mvaa 108,12,44
Ra 88,21,12288
Mvaa 124,12,48
s_lshl_b32 s3, s33, 2
s_add_u32 s64, s64, s3
s_add_u32 s64, s64, 5300224
Mvaa 140,12,52
Ta 124,29,16384
Ta 126,29,18432
Mvaa 156,12,56
s_lshl_b32 s65, s34, 8
s_sub_u32 s65, 1920, s65
v_mul_u32_u24_e64 v32, s65, v0
Mvaa 172,12,60
s_waitcnt lgkmcnt(6)
Ra 92,21,14336
Mvaa 176,16,32
s_cmp_eq_u32 s32, 0
s_cselect_b32 s64, s64, 2146435072
Mvaa 192,16,36
s_mov_b64 exec, 3
buffer_store_dword v31, v32, s[20:23], s64 offen sc1
s_mov_b64 exec, -1
Mvaa 208,16,40
s_lshl_b32 s3, s2, 2
s_add_u32 s3, s3, 5447680
v_lshlrev_b32 v32, 10, v0
Mvaa 224,16,44
s_cmp_eq_u32 s32, 0
s_cselect_b32 s3, s3, 2146435072
Mvaa 240,16,48
s_mov_b64 exec, 0x1ff
buffer_store_dword v31, v32, s[20:23], s3 offen sc1
s_mov_b64 exec, -1
Maaa 128,16,52
s_lshl_b32 s35, s34, 1
s_sub_u32 s36, 32, s35
s_add_u32 s35, s35, 2
Maaa 144,16,56
s_lshl_b32 s44, s32, 12
s_lshl_b32 s58, s32, 1
s_sub_u32 s58, 7, s58
Maaa 160,16,60
s_mul_i32 s58, s58, 33792
s_sub_u32 s3, 15, s34
s_lshl_b32 s45, s3, 3
Mvaa 180,20,32
s_add_u32 s45, s45, s32
s_lshl_b32 s46, s34, 3
s_add_u32 s46, s46, s32
Mvaa 196,20,36
s_mov_b32 s68, s42
s_and_b32 s69, s43, 0xffff
s_mov_b32 s70, 7340032
Mvaa 212,20,40
s_mov_b32 s71, 0x20000
s_cmp_eq_u32 s32, 0
s_cselect_b32 s37, 0, 2146435072
Mvaa 228,20,44
s_lshl_b32 s3, s33, 8
s_add_u32 s16, s4, s3
s_addc_u32 s17, s5, 0
s_and_b32 s17, s17, 0xffff
Mvaa 244,20,48
s_mov_b32 s18, 0
s_mov_b32 s19, 0x20000
s_sub_u32 s18, 8388608, s3
Maaa 132,20,52
v_and_b32 v33, 15, v0
v_lshrrev_b32_e64 v32, 1, v33
Maaa 148,20,56
v_and_b32 v33, 1, v0
v_lshlrev_b32 v32, 13, v32
Maaa 164,20,60
v_lshl_add_u32 v45, v33, 7, v32
Mvaa 184,24,32
s_lshl_b32 s3, s32, 3
s_add_u32 s3, s3, s34
s_mul_i32 s47, s3, 65536
Mvaa 200,24,36
s_bfe_u32 s6, s2, 131075
s_lshl_b32 s3, s32, 8
s_or_b32 s6, s6, s3
Mvaa 216,24,40
Mvaa 232,24,44
Mvaa 248,24,48
Maaa 136,24,52
Maaa 152,24,56
Maaa 168,24,60
Mvaa 188,28,32
Mvaa 204,28,36
Mvaa 220,28,40
Mvaa 236,28,44
Mvaa 252,28,48
Maaa 140,28,52
Maaa 156,28,56
Maaa 172,28,60
s_waitcnt vmcnt(8) lgkmcnt(0)
s_add_u32 m0, s57, 65536
s_barrier
Mvaa 48,64,96
buffer_load_dwordx4 v6, s[12:15], s52 offen offset:0 nt lds
Mvaa 64,64,100
Ta 32,12,0
Ta 34,12,2048
Mvaa 80,64,104
Mvaa 96,64,108
Ra 0,10,0
Mvaa 112,64,112
buffer_load_dwordx4 v7, s[12:15], s53 offen offset:1024 nt lds
Mvaa 128,64,116
s_waitcnt lgkmcnt(6)
Ta 36,13,0
Ta 38,13,2048
Mvaa 144,64,120
Mvaa 160,64,124
Ra 4,10,2048
Mvaa 52,68,96
buffer_load_dwordx4 v6, s[12:15], s54 offen offset:2048 nt lds
Mvaa 68,68,100
Ta 40,14,0
Ta 42,14,2048
Mvaa 84,68,104
Mvaa 100,68,108
Ra 8,10,4096
Mvaa 116,68,112
buffer_load_dwordx4 v7, s[12:15], s55 offen offset:3072 nt lds
Mvaa 132,68,116
s_waitcnt lgkmcnt(6)
Ta 44,15,0
Ta 46,15,2048
Mvaa 148,68,120
Mvaa 164,68,124
s_add_u32 m0, s57, 69632
Ra 12,10,6144
Mvaa 56,72,96
buffer_load_dwordx4 v8, s[12:15], s52 offen offset:0 nt lds
Mvaa 72,72,100
Ta 48,16,0
Ta 50,16,2048
Mvaa 88,72,104
Mvaa 104,72,108
Ra 16,10,8192
Mvaa 120,72,112
buffer_load_dwordx4 v9, s[12:15], s53 offen offset:1024 nt lds
Mvaa 136,72,116
s_waitcnt lgkmcnt(6)
Ta 52,17,0
Ta 54,17,2048
Mvaa 152,72,120
Mvaa 168,72,124
Ra 20,10,10240
Mvaa 60,76,96
buffer_load_dwordx4 v8, s[12:15], s54 offen offset:2048 nt lds
Mvaa 76,76,100
Ta 56,18,0
Ta 58,18,2048
Mvaa 92,76,104
Mvaa 108,76,108
Ra 24,10,12288
Mvaa 124,76,112
buffer_load_dwordx4 v9, s[12:15], s55 offen offset:3072 nt lds
Mvaa 140,76,116
s_waitcnt lgkmcnt(6)
Ta 60,19,0
Ta 62,19,2048
Mvaa 156,76,120
v_xor_b32 v6, 3670016, v6
v_xor_b32 v7, 3670016, v7
Mvaa 172,76,124
s_add_u32 m0, s56, 65536
Ra 28,10,14336
v_xor_b32 v8, 3670016, v8
Mvaa 176,80,96
buffer_load_dwordx4 v2, s[8:11], s48 offen offset:0 lds
Mvaa 192,80,100
v_xor_b32 v9, 3670016, v9
Mvaa 208,80,104
Mvaa 224,80,108
Mvaa 240,80,112
buffer_load_dwordx4 v3, s[8:11], s49 offen offset:1024 lds
Maaa 128,80,116
Maaa 144,80,120
Maaa 160,80,124
Mvaa 180,84,96
buffer_load_dwordx4 v2, s[8:11], s50 offen offset:2048 lds
Mvaa 196,84,100
Mvaa 212,84,104
Mvaa 228,84,108
Mvaa 244,84,112
buffer_load_dwordx4 v3, s[8:11], s51 offen offset:3072 lds
Maaa 132,84,116
Maaa 148,84,120
Maaa 164,84,124
s_add_u32 m0, s56, 69632
Mvaa 184,88,96
buffer_load_dwordx4 v4, s[8:11], s48 offen offset:0 lds
Mvaa 200,88,100
Mvaa 216,88,104
Mvaa 232,88,108
Mvaa 248,88,112
buffer_load_dwordx4 v5, s[8:11], s49 offen offset:1024 lds
Maaa 136,88,116
Maaa 152,88,120
Maaa 168,88,124
Mvaa 188,92,96
buffer_load_dwordx4 v4, s[8:11], s50 offen offset:2048 lds
Mvaa 204,92,100
Mvaa 220,92,104
Mvaa 236,92,108
Mvaa 252,92,112
buffer_load_dwordx4 v5, s[8:11], s51 offen offset:3072 lds
Maaa 140,92,116
v_xor_b32 v2, 896, v2
v_xor_b32 v3, 896, v3
Maaa 156,92,120
buffer_load_dword v1, v47, s[60:63], 0 offen
v_xor_b32 v4, 896, v4
v_xor_b32 v5, 896, v5
Maaa 172,92,124
s_mul_i32 vcc_lo, s59, 1
v_xor_b32 v47, vcc_lo, v47
s_waitcnt lgkmcnt(0)
Mvaa 48,0,32
Mvaa 64,0,36
Ta 96,12,16384
Ta 98,12,18432
Mvaa 80,0,40
Mvaa 96,0,44
Ra 64,11,0
Mvaa 112,0,48
Mvaa 128,0,52
Ta 100,13,16384
Ta 102,13,18432
Mvaa 144,0,56
Mvaa 160,0,60
s_waitcnt lgkmcnt(6)
Ra 68,11,2048
Mvaa 52,4,32
Mvaa 68,4,36
Ta 104,14,16384
Ta 106,14,18432
Mvaa 84,4,40
Mvaa 100,4,44
Ra 72,11,4096
Mvaa 116,4,48
Mvaa 132,4,52
Ta 108,15,16384
Ta 110,15,18432
Mvaa 148,4,56
Mvaa 164,4,60
s_waitcnt lgkmcnt(6)
Ra 76,11,6144
Mvaa 56,8,32
Mvaa 72,8,36
Ta 112,16,16384
Ta 114,16,18432
Mvaa 88,8,40
Mvaa 104,8,44
Ra 80,11,8192
Mvaa 120,8,48
Mvaa 136,8,52
Ta 116,17,16384
Ta 118,17,18432
Mvaa 152,8,56
Mvaa 168,8,60
s_waitcnt lgkmcnt(6)
Ra 84,11,10240
Mvaa 60,12,32
Mvaa 76,12,36
Ta 120,18,16384
Ta 122,18,18432
Mvaa 92,12,40
Mvaa 108,12,44
Ra 88,11,12288
Mvaa 124,12,48
Mvaa 140,12,52
Ta 124,19,16384
Ta 126,19,18432
Mvaa 156,12,56
Mvaa 172,12,60
s_waitcnt lgkmcnt(6)
Ra 92,11,14336
Mvaa 176,16,32
Mvaa 192,16,36
Mvaa 208,16,40
Mvaa 224,16,44
Mvaa 240,16,48
Maaa 128,16,52
Maaa 144,16,56
Maaa 160,16,60
Mvaa 180,20,32
Mvaa 196,20,36
Mvaa 212,20,40
Mvaa 228,20,44
Mvaa 244,20,48
Maaa 132,20,52
Maaa 148,20,56
Maaa 164,20,60
Mvaa 184,24,32
Mvaa 200,24,36
Mvaa 216,24,40
Mvaa 232,24,44
Mvaa 248,24,48
Maaa 136,24,52
Maaa 152,24,56
Maaa 168,24,60
Mvaa 188,28,32
Mvaa 204,28,36
Mvaa 220,28,40
Mvaa 236,28,44
Mvaa 252,28,48
Maaa 140,28,52
Maaa 156,28,56
Maaa 172,28,60
s_waitcnt vmcnt(1) lgkmcnt(0)
s_add_u32 m0, s57, 0
s_barrier
Mvaa 48,64,96
buffer_load_dwordx4 v6, s[12:15], s52 offen offset:0 nt lds
Mvaa 64,64,100
Ta 32,22,0
Ta 34,22,2048
Mvaa 80,64,104
Mvaa 96,64,108
Ra 0,20,0
Mvaa 112,64,112
buffer_load_dwordx4 v7, s[12:15], s53 offen offset:1024 nt lds
Mvaa 128,64,116
s_waitcnt lgkmcnt(6)
Ta 36,23,0
Ta 38,23,2048
Mvaa 144,64,120
Mvaa 160,64,124
Ra 4,20,2048
Mvaa 52,68,96
buffer_load_dwordx4 v6, s[12:15], s54 offen offset:2048 nt lds
Mvaa 68,68,100
Ta 40,24,0
Ta 42,24,2048
Mvaa 84,68,104
Mvaa 100,68,108
Ra 8,20,4096
Mvaa 116,68,112
buffer_load_dwordx4 v7, s[12:15], s55 offen offset:3072 nt lds
Mvaa 132,68,116
s_waitcnt lgkmcnt(6)
Ta 44,25,0
Ta 46,25,2048
Mvaa 148,68,120
s_cmp_eq_u32 s6, 0
s_cselect_b32 s3, 0, 2146435072
Mvaa 164,68,124
s_add_u32 m0, s57, 4096
Ra 12,20,6144
Mvaa 56,72,96
buffer_load_dwordx4 v8, s[12:15], s52 offen offset:0 nt lds
Mvaa 72,72,100
Ta 48,26,0
Ta 50,26,2048
Mvaa 88,72,104
s_mov_b64 exec, 1
buffer_atomic_add v30, v31, s[28:31], s3 offen sc1
s_mov_b64 exec, -1
Mvaa 104,72,108
Ra 16,20,8192
Mvaa 120,72,112
buffer_load_dwordx4 v9, s[12:15], s53 offen offset:1024 nt lds
Mvaa 136,72,116
s_waitcnt lgkmcnt(6)
Ta 52,27,0
Ta 54,27,2048
Mvaa 152,72,120
Mvaa 168,72,124
Ra 20,20,10240
Mvaa 60,76,96
buffer_load_dwordx4 v8, s[12:15], s54 offen offset:2048 nt lds
Mvaa 76,76,100
Ta 56,28,0
Ta 58,28,2048
Mvaa 92,76,104
Mvaa 108,76,108
Ra 24,20,12288
Mvaa 124,76,112
buffer_load_dwordx4 v9, s[12:15], s55 offen offset:3072 nt lds
Mvaa 140,76,116
s_waitcnt lgkmcnt(6)
Ta 60,29,0
Ta 62,29,2048
Mvaa 156,76,120
v_xor_b32 v6, 524288, v6
v_xor_b32 v7, 524288, v7
Mvaa 172,76,124
s_add_u32 m0, s56, 0
Ra 28,20,14336
v_xor_b32 v8, 524288, v8
Mvaa 176,80,96
buffer_load_dwordx4 v2, s[8:11], s48 offen offset:0 lds
Mvaa 192,80,100
v_xor_b32 v9, 524288, v9
Mvaa 208,80,104
Mvaa 224,80,108
Mvaa 240,80,112
buffer_load_dwordx4 v3, s[8:11], s49 offen offset:1024 lds
Maaa 128,80,116
Maaa 144,80,120
Maaa 160,80,124
Mvaa 180,84,96
buffer_load_dwordx4 v2, s[8:11], s50 offen offset:2048 lds
Mvaa 196,84,100
Mvaa 212,84,104
Mvaa 228,84,108
Mvaa 244,84,112
buffer_load_dwordx4 v3, s[8:11], s51 offen offset:3072 lds
Maaa 132,84,116
Maaa 148,84,120
Maaa 164,84,124
s_add_u32 m0, s56, 4096
Mvaa 184,88,96
buffer_load_dwordx4 v4, s[8:11], s48 offen offset:0 lds
Mvaa 200,88,100
Mvaa 216,88,104
Mvaa 232,88,108
Mvaa 248,88,112
buffer_load_dwordx4 v5, s[8:11], s49 offen offset:1024 lds
Maaa 136,88,116
Maaa 152,88,120
Maaa 168,88,124
Mvaa 188,92,96
buffer_load_dwordx4 v4, s[8:11], s50 offen offset:2048 lds
Mvaa 204,92,100
Mvaa 220,92,104
Mvaa 236,92,108
Mvaa 252,92,112
buffer_load_dwordx4 v5, s[8:11], s51 offen offset:3072 lds
Maaa 140,92,116
v_xor_b32 v2, 128, v2
v_xor_b32 v3, 128, v3
Maaa 156,92,120
buffer_load_dword v1, v47, s[60:63], 0 offen
v_xor_b32 v4, 128, v4
v_xor_b32 v5, 128, v5
Maaa 172,92,124
s_mul_i32 vcc_lo, s59, 7
v_xor_b32 v47, vcc_lo, v47
s_waitcnt lgkmcnt(0)
Mvaa 48,0,32
buffer_load_dword v44, v45, s[16:19], s47 offen
Mvaa 64,0,36
Ta 96,22,16384
Ta 98,22,18432
Mvaa 80,0,40
s_add_u32 s47, s47, 2097152
Mvaa 96,0,44
Ra 64,21,0
Mvaa 112,0,48
Mvaa 128,0,52
Ta 100,23,16384
Ta 102,23,18432
Mvaa 144,0,56
Mvaa 160,0,60
s_waitcnt lgkmcnt(6)
Ra 68,21,2048
Mvaa 52,4,32
Mvaa 68,4,36
Ta 104,24,16384
Ta 106,24,18432
Mvaa 84,4,40
Mvaa 100,4,44
Ra 72,21,4096
Mvaa 116,4,48
Mvaa 132,4,52
Ta 108,25,16384
Ta 110,25,18432
Mvaa 148,4,56
Mvaa 164,4,60
s_waitcnt lgkmcnt(6)
Ra 76,21,6144
Mvaa 56,8,32
Mvaa 72,8,36
Ta 112,26,16384
Ta 114,26,18432
Mvaa 88,8,40
Mvaa 104,8,44
Ra 80,21,8192
Mvaa 120,8,48
Mvaa 136,8,52
Ta 116,27,16384
Ta 118,27,18432
Mvaa 152,8,56
Mvaa 168,8,60
s_waitcnt lgkmcnt(6)
Ra 84,21,10240
Mvaa 60,12,32
Mvaa 76,12,36
Ta 120,28,16384
Ta 122,28,18432
Mvaa 92,12,40
s_cmp_eq_u32 s6, 1
s_cselect_b32 s3, 0, 2146435072
Mvaa 108,12,44
Ra 88,21,12288
Mvaa 124,12,48
s_mov_b64 exec, 1
buffer_atomic_add v30, v31, s[28:31], s3 offen sc1
s_mov_b64 exec, -1
Mvaa 140,12,52
Ta 124,29,16384
Ta 126,29,18432
Mvaa 156,12,56
Mvaa 172,12,60
s_waitcnt lgkmcnt(6)
Ra 92,21,14336
Mvaa 176,16,32
Mvaa 192,16,36
Mvaa 208,16,40
Mvaa 224,16,44
Mvaa 240,16,48
Maaa 128,16,52
Maaa 144,16,56
Maaa 160,16,60
Mvaa 180,20,32
Mvaa 196,20,36
Mvaa 212,20,40
Mvaa 228,20,44
Mvaa 244,20,48
Maaa 132,20,52
Maaa 148,20,56
Maaa 164,20,60
Mvaa 184,24,32
Mvaa 200,24,36
Mvaa 216,24,40
Mvaa 232,24,44
Mvaa 248,24,48
Maaa 136,24,52
Maaa 152,24,56
Maaa 168,24,60
Mvaa 188,28,32
Mvaa 204,28,36
Mvaa 220,28,40
Mvaa 236,28,44
Mvaa 252,28,48
Maaa 140,28,52
Maaa 156,28,56
Maaa 172,28,60
s_waitcnt vmcnt(3) lgkmcnt(0)
s_add_u32 m0, s57, 65536
s_barrier
Mvaa 48,64,96
buffer_load_dwordx4 v6, s[12:15], s52 offen offset:0 nt lds
Mvaa 64,64,100
Ta 32,12,0
Ta 34,12,2048
Mvaa 80,64,104
Mvaa 96,64,108
Ra 0,10,0
Mvaa 112,64,112
buffer_load_dwordx4 v7, s[12:15], s53 offen offset:1024 nt lds
Mvaa 128,64,116
s_waitcnt lgkmcnt(6)
Ta 36,13,0
Ta 38,13,2048
Mvaa 144,64,120
Mvaa 160,64,124
Ra 4,10,2048
Mvaa 52,68,96
buffer_load_dwordx4 v6, s[12:15], s54 offen offset:2048 nt lds
Mvaa 68,68,100
Ta 40,14,0
Ta 42,14,2048
Mvaa 84,68,104
Mvaa 100,68,108
Ra 8,10,4096
Mvaa 116,68,112
buffer_load_dwordx4 v7, s[12:15], s55 offen offset:3072 nt lds
Mvaa 132,68,116
s_waitcnt lgkmcnt(6)
Ta 44,15,0
Ta 46,15,2048
Mvaa 148,68,120
Mvaa 164,68,124
s_add_u32 m0, s57, 69632
Ra 12,10,6144
Mvaa 56,72,96
buffer_load_dwordx4 v8, s[12:15], s52 offen offset:0 nt lds
Mvaa 72,72,100
Ta 48,16,0
Ta 50,16,2048
Mvaa 88,72,104
Mvaa 104,72,108
Ra 16,10,8192
Mvaa 120,72,112
buffer_load_dwordx4 v9, s[12:15], s53 offen offset:1024 nt lds
Mvaa 136,72,116
s_waitcnt lgkmcnt(6)
Ta 52,17,0
Ta 54,17,2048
Mvaa 152,72,120
Mvaa 168,72,124
Ra 20,10,10240
Mvaa 60,76,96
buffer_load_dwordx4 v8, s[12:15], s54 offen offset:2048 nt lds
Mvaa 76,76,100
Ta 56,18,0
Ta 58,18,2048
Mvaa 92,76,104
Mvaa 108,76,108
Ra 24,10,12288
Mvaa 124,76,112
buffer_load_dwordx4 v9, s[12:15], s55 offen offset:3072 nt lds
Mvaa 140,76,116
s_waitcnt lgkmcnt(6)
Ta 60,19,0
Ta 62,19,2048
Mvaa 156,76,120
v_xor_b32 v6, 1572864, v6
v_xor_b32 v7, 1572864, v7
Mvaa 172,76,124
s_add_u32 m0, s56, 65536
Ra 28,10,14336
v_xor_b32 v8, 1572864, v8
Mvaa 176,80,96
buffer_load_dwordx4 v2, s[8:11], s48 offen offset:0 lds
Mvaa 192,80,100
v_xor_b32 v9, 1572864, v9
Mvaa 208,80,104
Mvaa 224,80,108
Mvaa 240,80,112
buffer_load_dwordx4 v3, s[8:11], s49 offen offset:1024 lds
Maaa 128,80,116
Maaa 144,80,120
Maaa 160,80,124
s_cmp_eq_u32 s6, 2
s_cselect_b32 s3, 0, 2146435072
Mvaa 180,84,96
buffer_load_dwordx4 v2, s[8:11], s50 offen offset:2048 lds
Mvaa 196,84,100
s_mov_b64 exec, 1
buffer_atomic_add v30, v31, s[28:31], s3 offen sc1
s_mov_b64 exec, -1
Mvaa 212,84,104
Mvaa 228,84,108
Mvaa 244,84,112
buffer_load_dwordx4 v3, s[8:11], s51 offen offset:3072 lds
Maaa 132,84,116
Maaa 148,84,120
Maaa 164,84,124
s_add_u32 m0, s56, 69632
Mvaa 184,88,96
buffer_load_dwordx4 v4, s[8:11], s48 offen offset:0 lds
Mvaa 200,88,100
Mvaa 216,88,104
Mvaa 232,88,108
Mvaa 248,88,112
buffer_load_dwordx4 v5, s[8:11], s49 offen offset:1024 lds
Maaa 136,88,116
Maaa 152,88,120
Maaa 168,88,124
Mvaa 188,92,96
buffer_load_dwordx4 v4, s[8:11], s50 offen offset:2048 lds
Mvaa 204,92,100
Mvaa 220,92,104
Mvaa 236,92,108
Mvaa 252,92,112
buffer_load_dwordx4 v5, s[8:11], s51 offen offset:3072 lds
Maaa 140,92,116
v_xor_b32 v2, 384, v2
v_xor_b32 v3, 384, v3
Maaa 156,92,120
v_xor_b32 v4, 384, v4
v_xor_b32 v5, 384, v5
Maaa 172,92,124
s_waitcnt lgkmcnt(0)
Mvaa 48,0,32
buffer_load_dword v44, v45, s[16:19], s47 offen
Mvaa 64,0,36
Ta 96,12,16384
Ta 98,12,18432
Mvaa 80,0,40
s_add_u32 s47, s47, 2097152
Mvaa 96,0,44
Ra 64,11,0
Mvaa 112,0,48
Mvaa 128,0,52
Ta 100,13,16384
Ta 102,13,18432
Mvaa 144,0,56
Mvaa 160,0,60
s_waitcnt lgkmcnt(6)
Ra 68,11,2048
Mvaa 52,4,32
Mvaa 68,4,36
Ta 104,14,16384
Ta 106,14,18432
Mvaa 84,4,40
Mvaa 100,4,44
Ra 72,11,4096
Mvaa 116,4,48
Mvaa 132,4,52
Ta 108,15,16384
Ta 110,15,18432
Mvaa 148,4,56
Mvaa 164,4,60
s_waitcnt lgkmcnt(6)
Ra 76,11,6144
Mvaa 56,8,32
Mvaa 72,8,36
Ta 112,16,16384
Ta 114,16,18432
Mvaa 88,8,40
Mvaa 104,8,44
Ra 80,11,8192
Mvaa 120,8,48
Mvaa 136,8,52
Ta 116,17,16384
Ta 118,17,18432
Mvaa 152,8,56
Mvaa 168,8,60
s_waitcnt lgkmcnt(6)
Ra 84,11,10240
Mvaa 60,12,32
Mvaa 76,12,36
Ta 120,18,16384
Ta 122,18,18432
Mvaa 92,12,40
Mvaa 108,12,44
Ra 88,11,12288
Mvaa 124,12,48
Mvaa 140,12,52
Ta 124,19,16384
Ta 126,19,18432
Mvaa 156,12,56
Mvaa 172,12,60
s_waitcnt lgkmcnt(6)
Ra 92,11,14336
Mvaa 176,16,32
Mvaa 192,16,36
Mvaa 208,16,40
Mvaa 224,16,44
Mvaa 240,16,48
Maaa 128,16,52
Maaa 144,16,56
Maaa 160,16,60
Mvaa 180,20,32
Mvaa 196,20,36
Mvaa 212,20,40
Mvaa 228,20,44
Mvaa 244,20,48
Maaa 132,20,52
Maaa 148,20,56
Maaa 164,20,60
Mvaa 184,24,32
Mvaa 200,24,36
Mvaa 216,24,40
Mvaa 232,24,44
Mvaa 248,24,48
s_cmp_eq_u32 s6, 3
s_cselect_b32 s3, 0, 2146435072
Maaa 136,24,52
s_mov_b64 exec, 1
buffer_atomic_add v30, v31, s[28:31], s3 offen sc1
s_mov_b64 exec, -1
Maaa 152,24,56
Maaa 168,24,60
Mvaa 188,28,32
Mvaa 204,28,36
Mvaa 220,28,40
Mvaa 236,28,44
Mvaa 252,28,48
Maaa 140,28,52
Maaa 156,28,56
Maaa 172,28,60
s_waitcnt vmcnt(2) lgkmcnt(0)
s_add_u32 m0, s57, 0
s_barrier
Mvaa 48,64,96
buffer_load_dwordx4 v6, s[12:15], s52 offen offset:0 nt lds
Mvaa 64,64,100
Ta 32,22,0
Ta 34,22,2048
Mvaa 80,64,104
Mvaa 96,64,108
Ra 0,20,0
Mvaa 112,64,112
buffer_load_dwordx4 v7, s[12:15], s53 offen offset:1024 nt lds
Mvaa 128,64,116
s_waitcnt lgkmcnt(6)
Ta 36,23,0
Ta 38,23,2048
Mvaa 144,64,120
Mvaa 160,64,124
Ra 4,20,2048
Mvaa 52,68,96
buffer_load_dwordx4 v6, s[12:15], s54 offen offset:2048 nt lds
Mvaa 68,68,100
Ta 40,24,0
Ta 42,24,2048
Mvaa 84,68,104
Mvaa 100,68,108
Ra 8,20,4096
Mvaa 116,68,112
buffer_load_dwordx4 v7, s[12:15], s55 offen offset:3072 nt lds
Mvaa 132,68,116
s_waitcnt lgkmcnt(6)
Ta 44,25,0
Ta 46,25,2048
Mvaa 148,68,120
Mvaa 164,68,124
s_add_u32 m0, s57, 4096
Ra 12,20,6144
Mvaa 56,72,96
buffer_load_dwordx4 v8, s[12:15], s52 offen offset:0 nt lds
Mvaa 72,72,100
Ta 48,26,0
Ta 50,26,2048
Mvaa 88,72,104
Mvaa 104,72,108
Ra 16,20,8192
Mvaa 120,72,112
buffer_load_dwordx4 v9, s[12:15], s53 offen offset:1024 nt lds
Mvaa 136,72,116
s_waitcnt lgkmcnt(6)
Ta 52,27,0
Ta 54,27,2048
Mvaa 152,72,120
Mvaa 168,72,124
Ra 20,20,10240
Mvaa 60,76,96
buffer_load_dwordx4 v8, s[12:15], s54 offen offset:2048 nt lds
Mvaa 76,76,100
Ta 56,28,0
Ta 58,28,2048
Mvaa 92,76,104
Mvaa 108,76,108
Ra 24,20,12288
Mvaa 124,76,112
buffer_load_dwordx4 v9, s[12:15], s55 offen offset:3072 nt lds
Mvaa 140,76,116
s_waitcnt lgkmcnt(6)
Ta 60,29,0
Ta 62,29,2048
Mvaa 156,76,120
v_xor_b32 v6, 524288, v6
v_xor_b32 v7, 524288, v7
Mvaa 172,76,124
s_add_u32 m0, s56, 0
Ra 28,20,14336
v_xor_b32 v8, 524288, v8
Mvaa 176,80,96
buffer_load_dwordx4 v2, s[8:11], s48 offen offset:0 lds
Mvaa 192,80,100
v_xor_b32 v9, 524288, v9
Mvaa 208,80,104
Mvaa 224,80,108
Mvaa 240,80,112
buffer_load_dwordx4 v3, s[8:11], s49 offen offset:1024 lds
Maaa 128,80,116
Maaa 144,80,120
Maaa 160,80,124
Mvaa 180,84,96
buffer_load_dwordx4 v2, s[8:11], s50 offen offset:2048 lds
Mvaa 196,84,100
Mvaa 212,84,104
Mvaa 228,84,108
Mvaa 244,84,112
buffer_load_dwordx4 v3, s[8:11], s51 offen offset:3072 lds
Maaa 132,84,116
Maaa 148,84,120
Maaa 164,84,124
s_add_u32 m0, s56, 4096
Mvaa 184,88,96
buffer_load_dwordx4 v4, s[8:11], s48 offen offset:0 lds
Mvaa 200,88,100
Mvaa 216,88,104
Mvaa 232,88,108
Mvaa 248,88,112
buffer_load_dwordx4 v5, s[8:11], s49 offen offset:1024 lds
Maaa 136,88,116
Maaa 152,88,120
Maaa 168,88,124
Mvaa 188,92,96
buffer_load_dwordx4 v4, s[8:11], s50 offen offset:2048 lds
Mvaa 204,92,100
Mvaa 220,92,104
Mvaa 236,92,108
Mvaa 252,92,112
buffer_load_dwordx4 v5, s[8:11], s51 offen offset:3072 lds
Maaa 140,92,116
v_xor_b32 v2, 128, v2
v_xor_b32 v3, 128, v3
Maaa 156,92,120
v_xor_b32 v4, 128, v4
v_xor_b32 v5, 128, v5
Maaa 172,92,124
s_waitcnt lgkmcnt(0)
Mvaa 48,0,32
buffer_load_dword v44, v45, s[16:19], s47 offen
Mvaa 64,0,36
Ta 96,22,16384
Ta 98,22,18432
Mvaa 80,0,40
s_add_u32 s47, s47, 2097152
v_lshrrev_b32 v32, 4, v0
v_and_b32 v33, 15, v0
Mvaa 96,0,44
Ra 64,21,0
Mvaa 112,0,48
s_lshl_b32 s3, s32, 4
v_add_u32 v34, s3, v32
v_lshlrev_b32_e64 v36, 1, v32
Mvaa 128,0,52
Ta 100,23,16384
Ta 102,23,18432
Mvaa 144,0,56
v_xor_b32 v36, v36, v33
v_xor_b32 v37, 8, v36
Mvaa 160,0,60
s_waitcnt lgkmcnt(6)
Ra 68,21,2048
Mvaa 52,4,32
s_getpc_b64 s[6:7]
L_cpf3:
s_add_u32 s6, s6, (L_phase2-L_cpf3)&0xffffffff
s_addc_u32 s7, s7, ((L_phase2-L_cpf3)>>32)&0xffffffff
Mvaa 68,4,36
Ta 104,24,16384
Ta 106,24,18432
Mvaa 84,4,40
s_lshr_b32 s3, s2, 3
s_lshl_b32 s3, s3, 2
s_add_u32 s3, s3, s32
Mvaa 100,4,44
Ra 72,21,4096
Mvaa 116,4,48
s_lshl_b32 s3, s3, 10
v_and_b32 v42, 7, v0
v_lshlrev_b32 v42, 7, v42
Mvaa 132,4,52
Ta 108,25,16384
Ta 110,25,18432
Mvaa 148,4,56
v_add_u32_e64 v42, s3, v42
v_min_u32 v42, L_k2_fin-L_phase2-4, v42
Mvaa 164,4,60
s_waitcnt lgkmcnt(6)
Ra 76,21,6144
Mvaa 56,8,32
v_mov_b32 v41, s7
Mvaa 72,8,36
Ta 112,26,16384
Ta 114,26,18432
Mvaa 88,8,40
v_add_co_u32 v40, vcc, s6, v42
s_nop 1
v_addc_co_u32 v41, vcc, 0, v41, vcc
Mvaa 104,8,44
Ra 80,21,8192
Mvaa 120,8,48
global_load_dword v38, v[40:41], off
Mvaa 136,8,52
Ta 116,27,16384
Ta 118,27,18432
Mvaa 152,8,56
Mvaa 168,8,60
s_waitcnt lgkmcnt(6)
Ra 84,21,10240
Mvaa 60,12,32
Mvaa 76,12,36
Ta 120,28,16384
Ta 122,28,18432
Mvaa 92,12,40
Mvaa 108,12,44
Ra 88,21,12288
Mvaa 124,12,48
Mvaa 140,12,52
Ta 124,29,16384
Ta 126,29,18432
Mvaa 156,12,56
Mvaa 172,12,60
s_waitcnt lgkmcnt(6)
Ra 92,21,14336
Mvaa 176,16,32
Mvaa 192,16,36
Mvaa 208,16,40
Mvaa 224,16,44
Mvaa 240,16,48
Maaa 128,16,52
Maaa 144,16,56
Maaa 160,16,60
Mvaa 180,20,32
Mvaa 196,20,36
Mvaa 212,20,40
Mvaa 228,20,44
Mvaa 244,20,48
Maaa 132,20,52
Maaa 148,20,56
Maaa 164,20,60
Mvaa 184,24,32
Mvaa 200,24,36
Mvaa 216,24,40
Mvaa 232,24,44
Mvaa 248,24,48
Maaa 136,24,52
Maaa 152,24,56
Maaa 168,24,60
Mvaa 188,28,32
Mvaa 204,28,36
Mvaa 220,28,40
Mvaa 236,28,44
Mvaa 252,28,48
Maaa 140,28,52
Maaa 156,28,56
Maaa 172,28,60
s_waitcnt vmcnt(2) lgkmcnt(0)
s_add_u32 m0, s57, 65536
s_barrier
Mvaa 48,64,96
buffer_load_dwordx4 v6, s[12:15], s52 offen offset:0 nt lds
Mvaa 64,64,100
Ta 32,12,0
Ta 34,12,2048
Mvaa 80,64,104
Mvaa 96,64,108
Ra 0,10,0
Mvaa 112,64,112
buffer_load_dwordx4 v7, s[12:15], s53 offen offset:1024 nt lds
Mvaa 128,64,116
s_waitcnt lgkmcnt(6)
Ta 36,13,0
Ta 38,13,2048
Mvaa 144,64,120
Mvaa 160,64,124
Ra 4,10,2048
Mvaa 52,68,96
buffer_load_dwordx4 v6, s[12:15], s54 offen offset:2048 nt lds
Mvaa 68,68,100
Ta 40,14,0
Ta 42,14,2048
Mvaa 84,68,104
Mvaa 100,68,108
Ra 8,10,4096
Mvaa 116,68,112
buffer_load_dwordx4 v7, s[12:15], s55 offen offset:3072 nt lds
Mvaa 132,68,116
s_waitcnt lgkmcnt(6)
Ta 44,15,0
Ta 46,15,2048
Mvaa 148,68,120
Mvaa 164,68,124
s_add_u32 m0, s57, 69632
Ra 12,10,6144
Mvaa 56,72,96
buffer_load_dwordx4 v8, s[12:15], s52 offen offset:0 nt lds
Mvaa 72,72,100
Ta 48,16,0
Ta 50,16,2048
Mvaa 88,72,104
Mvaa 104,72,108
Ra 16,10,8192
Mvaa 120,72,112
buffer_load_dwordx4 v9, s[12:15], s53 offen offset:1024 nt lds
Mvaa 136,72,116
s_waitcnt lgkmcnt(6)
Ta 52,17,0
Ta 54,17,2048
Mvaa 152,72,120
Mvaa 168,72,124
Ra 20,10,10240
Mvaa 60,76,96
buffer_load_dwordx4 v8, s[12:15], s54 offen offset:2048 nt lds
Mvaa 76,76,100
Ta 56,18,0
Ta 58,18,2048
Mvaa 92,76,104
Mvaa 108,76,108
Ra 24,10,12288
Mvaa 124,76,112
buffer_load_dwordx4 v9, s[12:15], s55 offen offset:3072 nt lds
Mvaa 140,76,116
s_waitcnt lgkmcnt(6)
Ta 60,19,0
Ta 62,19,2048
Mvaa 156,76,120
Mvaa 172,76,124
s_add_u32 m0, s56, 65536
Ra 28,10,14336
Mvaa 176,80,96
buffer_load_dwordx4 v2, s[8:11], s48 offen offset:0 lds
Mvaa 192,80,100
Mvaa 208,80,104
Mvaa 224,80,108
Mvaa 240,80,112
buffer_load_dwordx4 v3, s[8:11], s49 offen offset:1024 lds
Maaa 128,80,116
Maaa 144,80,120
Maaa 160,80,124
Mvaa 180,84,96
buffer_load_dwordx4 v2, s[8:11], s50 offen offset:2048 lds
Mvaa 196,84,100
Mvaa 212,84,104
Mvaa 228,84,108
Mvaa 244,84,112
buffer_load_dwordx4 v3, s[8:11], s51 offen offset:3072 lds
Maaa 132,84,116
Maaa 148,84,120
Maaa 164,84,124
s_add_u32 m0, s56, 69632
Mvaa 184,88,96
buffer_load_dwordx4 v4, s[8:11], s48 offen offset:0 lds
Mvaa 200,88,100
Mvaa 216,88,104
Mvaa 232,88,108
Mvaa 248,88,112
buffer_load_dwordx4 v5, s[8:11], s49 offen offset:1024 lds
Maaa 136,88,116
Maaa 152,88,120
Maaa 168,88,124
Mvaa 188,92,96
buffer_load_dwordx4 v4, s[8:11], s50 offen offset:2048 lds
Mvaa 204,92,100
Mvaa 220,92,104
Mvaa 236,92,108
Mvaa 252,92,112
buffer_load_dwordx4 v5, s[8:11], s51 offen offset:3072 lds
Maaa 140,92,116
Maaa 156,92,120
Maaa 172,92,124
s_waitcnt lgkmcnt(0)
Mvaa 48,0,32
buffer_load_dword v30, v31, s[28:31], s37 offen sc1
Mvaa 64,0,36
Ta 96,12,16384
Ta 98,12,18432
Mvaa 80,0,40
s_mov_b32 s8, s16
s_mov_b32 s9, s17
s_mov_b32 s10, s18
Mvaa 96,0,44
Ra 64,11,0
Mvaa 112,0,48
s_add_u32 s16, s66, 46137344
s_addc_u32 s17, s67, 0
s_and_b32 s17, s17, 0xffff
Mvaa 128,0,52
Ta 100,13,16384
Ta 102,13,18432
Mvaa 144,0,56
s_mov_b32 s18, 16777216
s_mov_b32 s19, 0x20000
s_mov_b32 s48, 0
Mvaa 160,0,60
s_waitcnt lgkmcnt(6)
Ra 68,11,2048
Mvaa 52,4,32
s_mov_b32 s49, 31744
s_mov_b32 s50, 63488
s_mov_b32 s51, 95232
Mvaa 68,4,36
Ta 104,14,16384
Ta 106,14,18432
Mvaa 84,4,40
v_lshlrev_b32_e64 v35, 13, v34
v_lshl_add_u32 v8, v36, 4, v35
Mvaa 100,4,44
Ra 72,11,4096
Mvaa 116,4,48
v_lshl_add_u32 v9, v37, 4, v35
v_lshlrev_b32_e64 v2, 4, v0
Mvaa 132,4,52
Ta 108,15,16384
Ta 110,15,18432
Mvaa 148,4,56
v_add_u32 v3, 65536, v2
v_add_u32_e64 v4, s44, v2
Mvaa 164,4,60
s_waitcnt lgkmcnt(6)
Ra 76,11,6144
Mvaa 56,8,32
v_mov_b32 v7, 0
v_lshlrev_b32_e64 v35, 2, v32
Mvaa 72,8,36
Ta 112,16,16384
Ta 114,16,18432
Mvaa 88,8,40
v_sub_u32_e64 v35, v33, v35
Mvaa 104,8,44
Ra 80,11,8192
Mvaa 120,8,48
s_lshl_b32 s3, s32, 4
v_add_u32 v5, s3, v35
Mvaa 136,8,52
Ta 116,17,16384
Ta 118,17,18432
Mvaa 152,8,56
s_sub_u32 s3, 48, s3
v_add_u32 v6, s3, v35
Mvaa 168,8,60
s_waitcnt lgkmcnt(6)
Ra 84,11,10240
Mvaa 60,12,32
s_mul_i32 s3, s33, 1116160
s_add_u32 s3, s3, 8388608
s_add_u32 s12, s66, s3
s_addc_u32 s13, s67, 0
s_and_b32 s13, s13, 0xffff
Mvaa 76,12,36
Ta 120,18,16384
Ta 122,18,18432
Mvaa 92,12,40
s_mov_b32 s14, 0
s_mov_b32 s15, 0x20000
s_mul_i32 s14, s36, 34816
Mvaa 108,12,44
Ra 88,11,12288
Mvaa 124,12,48
buffer_load_dword v44, v45, s[8:11], s47 offen
Mvaa 140,12,52
Ta 124,19,16384
Ta 126,19,18432
Mvaa 156,12,56
s_add_u32 s47, s47, 2097152
Mvaa 172,12,60
s_waitcnt lgkmcnt(6)
Ra 92,11,14336
Mvaa 176,16,32
Mvaa 192,16,36
Mvaa 208,16,40
Mvaa 224,16,44
Mvaa 240,16,48
Maaa 128,16,52
Maaa 144,16,56
Maaa 160,16,60
Mvaa 180,20,32
Mvaa 196,20,36
Mvaa 212,20,40
Mvaa 228,20,44
Mvaa 244,20,48
Maaa 132,20,52
Maaa 148,20,56
Maaa 164,20,60
Mvaa 184,24,32
Mvaa 200,24,36
Mvaa 216,24,40
Mvaa 232,24,44
Mvaa 248,24,48
Maaa 136,24,52
Maaa 152,24,56
Maaa 168,24,60
Mvaa 188,28,32
Mvaa 204,28,36
Mvaa 220,28,40
Mvaa 236,28,44
Mvaa 252,28,48
Maaa 140,28,52
Maaa 156,28,56
Maaa 172,28,60
s_waitcnt vmcnt(2) lgkmcnt(0)
s_add_u32 m0, s44, 0
s_barrier
Mvaa 48,64,96
buffer_load_dwordx4 v8, s[8:11], s48 offen offset:0 lds
Mvaa 64,64,100
Ta 32,22,0
Ta 34,22,2048
Mvaa 80,64,104
s_mul_i32 s3, s45, 33792
v_add_u32_e64 v10, s3, v2
Mvaa 96,64,108
Ra 0,20,0
Mvaa 112,64,112
buffer_load_dwordx4 v8, s[8:11], s49 offen offset:1024 lds
Mvaa 128,64,116
s_waitcnt lgkmcnt(6)
Ta 36,23,0
Ta 38,23,2048
Mvaa 144,64,120
s_mul_i32 s3, s46, 33792
v_add_u32 v11, s3, v2
v_mov_b32_e64 v14, v40
Mvaa 160,64,124
Ra 4,20,2048
Mvaa 52,68,96
buffer_load_dwordx4 v9, s[8:11], s50 offen offset:2048 lds
Mvaa 68,68,100
Ta 40,24,0
Ta 42,24,2048
Mvaa 84,68,104
v_mov_b32_e64 v15, v41
Mvaa 100,68,108
Ra 8,20,4096
Mvaa 116,68,112
buffer_load_dwordx4 v9, s[8:11], s51 offen offset:3072 lds
Mvaa 132,68,116
s_waitcnt lgkmcnt(6)
Ta 44,25,0
Ta 46,25,2048
Mvaa 148,68,120
v_add_u32 v8, 524288, v8
v_add_u32 v9, 524288, v9
Mvaa 164,68,124
s_add_u32 m0, s44, 16384
Ra 12,20,6144
Mvaa 56,72,96
buffer_load_dwordx4 v8, s[8:11], s48 offen offset:0 lds
Mvaa 72,72,100
Ta 48,26,0
Ta 50,26,2048
Mvaa 88,72,104
Mvaa 104,72,108
Ra 16,20,8192
Mvaa 120,72,112
buffer_load_dwordx4 v8, s[8:11], s49 offen offset:1024 lds
Mvaa 136,72,116
s_waitcnt lgkmcnt(6)
Ta 52,27,0
Ta 54,27,2048
Mvaa 152,72,120
Mvaa 168,72,124
Ra 20,20,10240
Mvaa 60,76,96
buffer_load_dwordx4 v9, s[8:11], s50 offen offset:2048 lds
Mvaa 76,76,100
Ta 56,28,0
Ta 58,28,2048
Mvaa 92,76,104
Mvaa 108,76,108
Ra 24,20,12288
Mvaa 124,76,112
buffer_load_dwordx4 v9, s[8:11], s51 offen offset:3072 lds
Mvaa 140,76,116
s_waitcnt lgkmcnt(6)
Ta 60,29,0
Ta 62,29,2048
Mvaa 156,76,120
v_add_u32 v8, 524288, v8
v_add_u32 v9, 524288, v9
Mvaa 172,76,124
s_add_u32 m0, s44, 32768
Ra 28,20,14336
Mvaa 176,80,96
buffer_load_dwordx4 v8, s[8:11], s48 offen offset:0 lds
Mvaa 192,80,100
Mvaa 208,80,104
Mvaa 224,80,108
Mvaa 240,80,112
buffer_load_dwordx4 v8, s[8:11], s49 offen offset:1024 lds
Maaa 128,80,116
Maaa 144,80,120
Maaa 160,80,124
Mvaa 180,84,96
buffer_load_dwordx4 v9, s[8:11], s50 offen offset:2048 lds
Mvaa 196,84,100
Mvaa 212,84,104
Mvaa 228,84,108
Mvaa 244,84,112
buffer_load_dwordx4 v9, s[8:11], s51 offen offset:3072 lds
Maaa 132,84,116
v_add_u32 v8, 524288, v8
v_add_u32 v9, 524288, v9
Maaa 148,84,120
Maaa 164,84,124
s_add_u32 m0, s44, 49152
Mvaa 184,88,96
buffer_load_dwordx4 v8, s[8:11], s48 offen offset:0 lds
Mvaa 200,88,100
Mvaa 216,88,104
Mvaa 232,88,108
Mvaa 248,88,112
buffer_load_dwordx4 v8, s[8:11], s49 offen offset:1024 lds
Maaa 136,88,116
Maaa 152,88,120
Maaa 168,88,124
Mvaa 188,92,96
buffer_load_dwordx4 v9, s[8:11], s50 offen offset:2048 lds
Mvaa 204,92,100
Mvaa 220,92,104
Mvaa 236,92,108
Mvaa 252,92,112
buffer_load_dwordx4 v9, s[8:11], s51 offen offset:3072 lds
Maaa 140,92,116
v_add_u32 v8, 524288, v8
v_add_u32 v9, 524288, v9
Maaa 156,92,120
Maaa 172,92,124
s_waitcnt lgkmcnt(0)
Mvaa 48,0,32
Mvaa 64,0,36
Ta 96,22,16384
Ta 98,22,18432
Mvaa 80,0,40
Mvaa 96,0,44
Ra 64,21,0
Mvaa 112,0,48
Mvaa 128,0,52
Ta 100,23,16384
Ta 102,23,18432
Mvaa 144,0,56
Mvaa 160,0,60
s_waitcnt lgkmcnt(6)
Ra 68,21,2048
Mvaa 52,4,32
Mvaa 68,4,36
Ta 104,24,16384
Ta 106,24,18432
Mvaa 84,4,40
Mvaa 100,4,44
Ra 72,21,4096
Mvaa 116,4,48
Mvaa 132,4,52
Ta 108,25,16384
Ta 110,25,18432
Mvaa 148,4,56
Mvaa 164,4,60
s_waitcnt lgkmcnt(6)
Ra 76,21,6144
Mvaa 56,8,32
Mvaa 72,8,36
Ta 112,26,16384
Ta 114,26,18432
Mvaa 88,8,40
Mvaa 104,8,44
Ra 80,21,8192
Mvaa 120,8,48
Mvaa 136,8,52
Ta 116,27,16384
Ta 118,27,18432
Mvaa 152,8,56
Mvaa 168,8,60
s_waitcnt lgkmcnt(6)
Ra 84,21,10240
Mvaa 60,12,32
Mvaa 76,12,36
Ta 120,28,16384
Ta 122,28,18432
Mvaa 92,12,40
Mvaa 108,12,44
Ra 88,21,12288
Mvaa 124,12,48
Mvaa 140,12,52
Ta 124,29,16384
Ta 126,29,18432
Mvaa 156,12,56
Mvaa 172,12,60
s_waitcnt lgkmcnt(6)
Ra 92,21,14336
Mvaa 176,16,32
Mvaa 192,16,36
Mvaa 208,16,40
Mvaa 224,16,44
Mvaa 240,16,48
Maaa 128,16,52
Maaa 144,16,56
Maaa 160,16,60
Mvaa 180,20,32
Mvaa 196,20,36
Mvaa 212,20,40
Mvaa 228,20,44
Mvaa 244,20,48
Maaa 132,20,52
Maaa 148,20,56
Maaa 164,20,60
Mvaa 184,24,32
Mvaa 200,24,36
Mvaa 216,24,40
Mvaa 232,24,44
Mvaa 248,24,48
Maaa 136,24,52
Maaa 152,24,56
Maaa 168,24,60
Mvaa 188,28,32
Mvaa 204,28,36
Mvaa 220,28,40
Mvaa 236,28,44
Mvaa 252,28,48
Maaa 140,28,52
Maaa 156,28,56
Maaa 172,28,60
s_waitcnt vmcnt(12) lgkmcnt(0)
v_readfirstlane_b32 s3, v30
s_nop 0
s_or_b32 s3, s3, s37
s_cmp_lt_u32 s3, 256
s_cbranch_scc1 L_spinAv
L_spinArv:
s_barrier
Mvaa 48,64,96
buffer_load_dwordx4 a[0:3], v10, s[20:23], s58 offen offset:0 sc1
Mvaa 52,68,96
v_lshrrev_b32_e64 v42, 2, v33
v_lshl_add_u32 v43, v32, 3, v42
Mvaa 56,72,96
v_lshlrev_b32 v43, 8, v43
v_and_b32 v44, 3, v0
Mvaa 60,76,96
v_lshl_add_u32 v43, v44, 3, v43
v_and_b32_e64 v44, 1, v32
Mvaa 64,64,100
buffer_load_dwordx4 a[4:7], v10, s[20:23], 0 offen offset:0 sc1
Mvaa 68,68,100
v_lshl_add_u32 v42, v44, 2, v42
v_xor_b32_e64 v44, 0, v42
Mvaa 72,72,100
v_lshl_add_u32 v16, v44, 5, v43
v_xor_b32_e64 v44, 1, v42
Mvaa 76,76,100
v_lshl_add_u32 v17, v44, 5, v43
v_xor_b32_e64 v44, 2, v42
Mvaa 80,64,104
buffer_load_dwordx4 a[8:11], v11, s[20:23], s58 offen offset:0 sc1
Mvaa 84,68,104
v_lshl_add_u32 v18, v44, 5, v43
v_xor_b32_e64 v44, 3, v42
Mvaa 88,72,104
v_lshl_add_u32 v19, v44, 5, v43
v_xor_b32_e64 v44, 4, v42
Mvaa 92,76,104
v_lshl_add_u32 v20, v44, 5, v43
v_xor_b32_e64 v44, 5, v42
Mvaa 96,64,108
buffer_load_dwordx4 a[12:15], v11, s[20:23], 0 offen offset:0 sc1
Mvaa 100,68,108
v_lshl_add_u32 v21, v44, 5, v43
v_xor_b32_e64 v44, 6, v42
Mvaa 104,72,108
v_lshl_add_u32 v22, v44, 5, v43
v_xor_b32_e64 v44, 7, v42
Mvaa 108,76,108
v_lshl_add_u32 v23, v44, 5, v43
Mvaa 112,64,112
buffer_load_dwordx4 a[16:19], v10, s[20:23], s58 offen offset:1024 sc1
Mvaa 116,68,112
Mvaa 120,72,112
Mvaa 124,76,112
Mvaa 128,64,116
buffer_load_dwordx4 a[20:23], v10, s[20:23], 0 offen offset:1024 sc1
Mvaa 132,68,116
Ta 192,16,0
Ta 194,16,1024
Mvaa 136,72,116
Ta 196,17,0
Ta 198,17,1024
Mvaa 140,76,116
Ta 200,18,0
Ta 202,18,1024
Mvaa 144,64,120
buffer_load_dwordx4 a[24:27], v11, s[20:23], s58 offen offset:1024 sc1
Mvaa 148,68,120
Ta 204,19,0
Ta 206,19,1024
Mvaa 152,72,120
Ta 208,20,0
Ta 210,20,1024
Mvaa 156,76,120
Ta 212,21,0
Ta 214,21,1024
Mvaa 160,64,124
buffer_load_dwordx4 a[28:31], v11, s[20:23], 0 offen offset:1024 sc1
Mvaa 164,68,124
Ta 216,22,0
Ta 218,22,1024
Mvaa 168,72,124
Ta 220,23,0
s_waitcnt lgkmcnt(9)
Ta 222,23,1024
Mvaa 172,76,124
s_waitcnt lgkmcnt(8)
Vc 24,48,49
Vc 25,50,51
Mvaa 176,80,96
buffer_load_dwordx4 a[32:35], v10, s[20:23], s58 offen offset:2048 sc1
Mvaa 180,84,96
Vc 26,52,53
Vc 27,54,55
Mvaa 184,88,96
Vc 28,56,57
Vc 29,58,59
Mvaa 188,92,96
Vc 30,60,61
Vc 31,62,63
Mvaa 192,80,100
buffer_load_dwordx4 a[36:39], v10, s[20:23], 0 offen offset:2048 sc1
Mvaa 196,84,100
Vc 32,64,65
Vc 33,66,67
Mvaa 200,88,100
Vc 34,68,69
Vc 35,70,71
Mvaa 204,92,100
Vc 36,72,73
Vc 37,74,75
Mvaa 208,80,104
buffer_load_dwordx4 a[40:43], v11, s[20:23], s58 offen offset:2048 sc1
Mvaa 212,84,104
Vc 38,76,77
Vc 39,78,79
Mvaa 216,88,104
Vc 40,80,81
Vc 41,82,83
Mvaa 220,92,104
Vc 42,84,85
Vc 43,86,87
Mvaa 224,80,108
buffer_load_dwordx4 a[44:47], v11, s[20:23], 0 offen offset:2048 sc1
Mvaa 228,84,108
Vc 44,88,89
Vc 45,90,91
Mvaa 232,88,108
Vc 46,92,93
Vc 47,94,95
Mvaa 236,92,108
Vc 48,96,97
Vc 49,98,99
Mvaa 240,80,112
buffer_load_dwordx4 a[48:51], v10, s[20:23], s58 offen offset:3072 sc1
Mvaa 244,84,112
Vc 50,100,101
Vc 51,102,103
Mvaa 248,88,112
Vc 52,104,105
Vc 53,106,107
Mvaa 252,92,112
Vc 54,108,109
Vc 55,110,111
Maaa 128,80,116
buffer_load_dwordx4 a[52:55], v10, s[20:23], 0 offen offset:3072 sc1
Maaa 132,84,116
Vc 56,112,113
Vc 57,114,115
Maaa 136,88,116
Vc 58,116,117
Vc 59,118,119
Maaa 140,92,116
Vc 60,120,121
Vc 61,122,123
Maaa 144,80,120
buffer_load_dwordx4 a[56:59], v11, s[20:23], s58 offen offset:3072 sc1
Maaa 148,84,120
Vc 62,124,125
Vc 63,126,127
Maaa 152,88,120
Vc 64,128,129
Vc 65,130,131
Maaa 156,92,120
Vc 66,132,133
Vc 67,134,135
Maaa 160,80,124
buffer_load_dwordx4 a[60:63], v11, s[20:23], 0 offen offset:3072 sc1
Maaa 164,84,124
v_add_u32 v10, 4096, v10
v_add_u32 v11, 4096, v11
Maaa 168,88,124
Vc 68,136,137
Vc 69,138,139
Maaa 172,92,124
Vc 70,140,141
Vc 71,142,143
Vc 72,144,145
Vc 73,146,147
Vc 74,148,149
Vc 75,150,151
Vc 76,152,153
Vc 77,154,155
Vc 78,156,157
Vc 79,158,159
Vc 80,160,161
Vc 81,162,163
Vc 82,164,165
Vc 83,166,167
Vc 84,168,169
Vc 85,170,171
Vc 86,172,173
Vc 87,174,175
Vc 88,176,177
Vc 89,178,179
Vc 90,180,181
Vc 91,182,183
Vc 92,184,185
Vc 93,186,187
Vc 94,188,189
Vc 95,190,191
Vc 96,192,193
Vc 97,194,195
Vc 98,196,197
Vc 99,198,199
Vc 100,200,201
Vc 101,202,203
Vc 102,204,205
Vc 103,206,207
Vc 104,208,209
Vc 105,210,211
Vc 106,212,213
Vc 107,214,215
Vc 108,216,217
Vc 109,218,219
Vc 110,220,221
Vc 111,222,223
Vc 112,224,225
Vc 113,226,227
Vc 114,228,229
Vc 115,230,231
Vc 116,232,233
Vc 117,234,235
Vc 118,236,237
Vc 119,238,239
Vc 120,240,241
Vc 121,242,243
Vc 122,244,245
Vc 123,246,247
Vc 124,248,249
Vc 125,250,251
Vc 126,252,253
Vc 127,254,255
L_phase2:
s_nop 7
s_waitcnt vmcnt(12) lgkmcnt(0)
Zvaa 128,192,0
s_add_u32 s37, s38, 0
Zvaa 160,192,4
Ta 224,16,8192
Ta 226,16,9216
Zvaa 192,192,8
buffer_load_dwordx4 a[64:67], v10, s[20:23], s58 offen offset:0 sc1
Zvaa 224,192,12
buffer_store_dwordx4 v[24:27], v2, s[24:27], s37 offen offset:0 sc1
Zvaa 132,196,0
Ta 228,17,8192
Ta 230,17,9216
Zvaa 164,196,4
buffer_load_dwordx4 a[68:71], v10, s[20:23], 0 offen offset:0 sc1
Zvaa 196,196,8
s_mov_b32 s60, s40
s_and_b32 s61, s41, 0xffff
s_mov_b32 s62, 7340032
Zvaa 228,196,12
Ta 232,18,8192
Ta 234,18,9216
Zvaa 136,200,0
s_mov_b32 s63, 0x20000
Zvaa 168,200,4
buffer_load_dwordx4 a[72:75], v11, s[20:23], s58 offen offset:0 sc1
Zvaa 200,200,8
Ta 236,19,8192
Ta 238,19,9216
Zvaa 232,200,12
global_load_dword v13, v[14:15], off
Zvaa 140,204,0
Zvaa 172,204,4
Ta 240,20,8192
Ta 242,20,9216
Zvaa 204,204,8
buffer_load_dwordx4 a[76:79], v11, s[20:23], 0 offen offset:0 sc1
Zvaa 236,204,12
Zvaa 144,208,0
s_waitcnt lgkmcnt(6)
Ta 244,21,8192
Ta 246,21,9216
Zvaa 176,208,4
buffer_store_dwordx4 v[28:31], v2, s[24:27], s37 offen offset:1024 sc1
Zvaa 208,208,8
buffer_load_dwordx4 a[80:83], v10, s[20:23], s58 offen offset:1024 sc1
Zvaa 240,208,12
Ta 248,22,8192
Ta 250,22,9216
Zvaa 148,212,0
Zvaa 180,212,4
Zvaa 212,212,8
Ta 252,23,8192
Ta 254,23,9216
Zvaa 244,212,12
buffer_load_dwordx4 a[84:87], v10, s[20:23], 0 offen offset:1024 sc1
Zvaa 152,216,0
Zvaa 184,216,4
Zvaa 216,216,8
buffer_load_dwordx4 a[88:91], v11, s[20:23], s58 offen offset:1024 sc1
Zvaa 248,216,12
Zvaa 156,220,0
Zvaa 188,220,4
buffer_load_dwordx4 a[92:95], v11, s[20:23], 0 offen offset:1024 sc1
Zvaa 220,220,8
Zvaa 252,220,12
s_waitcnt vmcnt(19) lgkmcnt(0)
s_barrier
Mvaa 128,224,16
buffer_store_dwordx4 v[32:35], v2, s[24:27], s37 offen offset:2048 sc1
Mvaa 160,224,20
s_add_u32 m0, s44, 0
Ta 192,16,16384
Ta 194,16,17408
Mvaa 192,224,24
buffer_load_dwordx4 v8, s[8:11], s48 offen offset:0 lds
Mvaa 224,224,28
Mvaa 132,228,16
Ta 196,17,16384
Ta 198,17,17408
Mvaa 164,228,20
buffer_load_dwordx4 v8, s[8:11], s49 offen offset:1024 lds
Mvaa 196,228,24
Mvaa 228,228,28
Ta 200,18,16384
Ta 202,18,17408
Mvaa 136,232,16
Mvaa 168,232,20
buffer_load_dwordx4 v9, s[8:11], s50 offen offset:2048 lds
Mvaa 200,232,24
Ta 204,19,16384
Ta 206,19,17408
Mvaa 232,232,28
Mvaa 140,236,16
Mvaa 172,236,20
Ta 208,20,16384
Ta 210,20,17408
Mvaa 204,236,24
buffer_load_dwordx4 v9, s[8:11], s51 offen offset:3072 lds
v_add_u32 v8, 524288, v8
v_add_u32 v9, 524288, v9
Mvaa 236,236,28
Mvaa 144,240,16
s_waitcnt lgkmcnt(6)
Ta 212,21,16384
Ta 214,21,17408
Mvaa 176,240,20
buffer_store_dwordx4 v[36:39], v2, s[24:27], s37 offen offset:3072 sc1
Mvaa 208,240,24
buffer_load_dwordx4 a[96:99], v10, s[20:23], s58 offen offset:2048 sc1
Mvaa 240,240,28
Ta 216,22,16384
Ta 218,22,17408
Mvaa 148,244,16
Mvaa 180,244,20
Mvaa 212,244,24
Ta 220,23,16384
Ta 222,23,17408
Mvaa 244,244,28
buffer_load_dwordx4 a[100:103], v10, s[20:23], 0 offen offset:2048 sc1
Mvaa 152,248,16
Mvaa 184,248,20
Mvaa 216,248,24
buffer_load_dwordx4 a[104:107], v11, s[20:23], s58 offen offset:2048 sc1
Mvaa 248,248,28
Mvaa 156,252,16
Mvaa 188,252,20
buffer_load_dwordx4 a[108:111], v11, s[20:23], 0 offen offset:2048 sc1
Mvaa 220,252,24
Mvaa 252,252,28
s_waitcnt vmcnt(25) lgkmcnt(0)
Mvaa 128,192,32
s_add_u32 s37, s38, 4096
Mvaa 160,192,36
Ta 224,16,24576
Ta 226,16,25600
Mvaa 192,192,40
buffer_load_dwordx4 a[112:115], v10, s[20:23], s58 offen offset:3072 sc1
Mvaa 224,192,44
buffer_store_dwordx4 v[40:43], v2, s[24:27], s37 offen offset:0 sc1
Mvaa 132,196,32
Ta 228,17,24576
Ta 230,17,25600
Mvaa 164,196,36
Mvaa 196,196,40
Mvaa 228,196,44
Ta 232,18,24576
Ta 234,18,25600
Mvaa 136,200,32
Mvaa 168,200,36
buffer_load_dwordx4 a[116:119], v10, s[20:23], 0 offen offset:3072 sc1
Mvaa 200,200,40
Ta 236,19,24576
Ta 238,19,25600
Mvaa 232,200,44
Mvaa 140,204,32
Mvaa 172,204,36
Ta 240,20,24576
Ta 242,20,25600
Mvaa 204,204,40
Mvaa 236,204,44
Mvaa 144,208,32
s_waitcnt lgkmcnt(6)
Ta 244,21,24576
Ta 246,21,25600
Mvaa 176,208,36
buffer_store_dwordx4 v[44:47], v2, s[24:27], s37 offen offset:1024 sc1
Mvaa 208,208,40
buffer_load_dwordx4 a[120:123], v11, s[20:23], s58 offen offset:3072 sc1
Mvaa 240,208,44
Ta 248,22,24576
Ta 250,22,25600
Mvaa 148,212,32
Mvaa 180,212,36
Mvaa 212,212,40
Ta 252,23,24576
Ta 254,23,25600
Mvaa 244,212,44
Mvaa 152,216,32
Mvaa 184,216,36
Mvaa 216,216,40
buffer_load_dwordx4 a[124:127], v11, s[20:23], 0 offen offset:3072 sc1
v_add_u32 v10, 4096, v10
v_add_u32 v11, 4096, v11
Mvaa 248,216,44
Mvaa 156,220,32
Mvaa 188,220,36
Mvaa 220,220,40
Mvaa 252,220,44
s_waitcnt vmcnt(27) lgkmcnt(0)
s_barrier
Mvaa 128,224,48
buffer_store_dwordx4 v[48:51], v2, s[24:27], s37 offen offset:2048 sc1
Mvaa 160,224,52
s_add_u32 m0, s44, 16384
Ta 192,16,32768
Ta 194,16,33792
Mvaa 192,224,56
buffer_load_dwordx4 v8, s[8:11], s48 offen offset:0 lds
Mvaa 224,224,60
Mvaa 132,228,48
Ta 196,17,32768
Ta 198,17,33792
Mvaa 164,228,52
buffer_load_dwordx4 v8, s[8:11], s49 offen offset:1024 lds
Mvaa 196,228,56
Mvaa 228,228,60
Ta 200,18,32768
Ta 202,18,33792
Mvaa 136,232,48
Mvaa 168,232,52
buffer_load_dwordx4 v9, s[8:11], s50 offen offset:2048 lds
Mvaa 200,232,56
Ta 204,19,32768
Ta 206,19,33792
Mvaa 232,232,60
Mvaa 140,236,48
Mvaa 172,236,52
Ta 208,20,32768
Ta 210,20,33792
Mvaa 204,236,56
buffer_load_dwordx4 v9, s[8:11], s51 offen offset:3072 lds
v_add_u32 v8, 524288, v8
v_add_u32 v9, 524288, v9
Mvaa 236,236,60
Mvaa 144,240,48
s_waitcnt lgkmcnt(6)
Ta 212,21,32768
Ta 214,21,33792
Mvaa 176,240,52
buffer_store_dwordx4 v[52:55], v2, s[24:27], s37 offen offset:3072 sc1
Mvaa 208,240,56
buffer_load_dwordx4 a[0:3], v10, s[20:23], s58 offen offset:0 sc1
Mvaa 240,240,60
Ta 216,22,32768
Ta 218,22,33792
Mvaa 148,244,48
Mvaa 180,244,52
Mvaa 212,244,56
Ta 220,23,32768
Ta 222,23,33792
Mvaa 244,244,60
buffer_load_dwordx4 a[4:7], v10, s[20:23], 0 offen offset:0 sc1
Mvaa 152,248,48
Mvaa 184,248,52
Mvaa 216,248,56
buffer_load_dwordx4 a[8:11], v11, s[20:23], s58 offen offset:0 sc1
Mvaa 248,248,60
Mvaa 156,252,48
Mvaa 188,252,52
buffer_load_dwordx4 a[12:15], v11, s[20:23], 0 offen offset:0 sc1
Mvaa 220,252,56
Mvaa 252,252,60
s_waitcnt vmcnt(31) lgkmcnt(0)
Mvaa 128,192,64
s_add_u32 s37, s38, 8192
Mvaa 160,192,68
Ta 224,16,40960
Ta 226,16,41984
Mvaa 192,192,72
buffer_load_dwordx4 a[16:19], v10, s[20:23], s58 offen offset:1024 sc1
Mvaa 224,192,76
buffer_store_dwordx4 v[56:59], v2, s[24:27], s37 offen offset:0 sc1
Mvaa 132,196,64
Ta 228,17,40960
Ta 230,17,41984
Mvaa 164,196,68
Ar 48,128
Ar 49,129
Mvaa 196,196,72
Ar 50,130
Ar 51,131
Mvaa 228,196,76
Ta 232,18,40960
Ta 234,18,41984
Mvaa 136,200,64
Ar 52,132
Ar 53,133
Mvaa 168,200,68
buffer_load_dwordx4 a[20:23], v10, s[20:23], 0 offen offset:1024 sc1
Mvaa 200,200,72
Ta 236,19,40960
Ta 238,19,41984
Mvaa 232,200,76
Ar 54,134
Ar 55,135
Mvaa 140,204,64
Vc 24,48,49
Vc 25,50,51
Mvaa 172,204,68
Ta 240,20,40960
Ta 242,20,41984
Mvaa 204,204,72
Vc 26,52,53
Vc 27,54,55
Mvaa 236,204,76
Mvaa 144,208,64
s_waitcnt lgkmcnt(6)
Ta 244,21,40960
Ta 246,21,41984
Mvaa 176,208,68
buffer_store_dwordx4 v[60:63], v2, s[24:27], s37 offen offset:1024 sc1
Mvaa 208,208,72
buffer_load_dwordx4 a[24:27], v11, s[20:23], s58 offen offset:1024 sc1
Mvaa 240,208,76
Ta 248,22,40960
Ta 250,22,41984
Mvaa 148,212,64
Ar 48,136
Ar 49,137
Mvaa 180,212,68
Ar 50,138
Ar 51,139
Mvaa 212,212,72
Ta 252,23,40960
Ta 254,23,41984
Mvaa 244,212,76
Ar 52,140
Ar 53,141
Mvaa 152,216,64
Ar 54,142
Ar 55,143
Mvaa 184,216,68
Vc 28,48,49
Vc 29,50,51
Mvaa 216,216,72
buffer_load_dwordx4 a[28:31], v11, s[20:23], 0 offen offset:1024 sc1
Mvaa 248,216,76
Vc 30,52,53
Vc 31,54,55
Mvaa 156,220,64
Mvaa 188,220,68
Mvaa 220,220,72
Mvaa 252,220,76
s_waitcnt vmcnt(32) lgkmcnt(0)
s_barrier
Mvaa 128,224,80
buffer_store_dwordx4 v[64:67], v2, s[24:27], s37 offen offset:2048 sc1
Mvaa 160,224,84
s_add_u32 m0, s44, 32768
Ta 192,16,49152
Ta 194,16,50176
Mvaa 192,224,88
buffer_load_dwordx4 v8, s[8:11], s48 offen offset:0 lds
Mvaa 224,224,92
Ar 48,144
Ar 49,145
Mvaa 132,228,80
Ta 196,17,49152
Ta 198,17,50176
Mvaa 164,228,84
buffer_load_dwordx4 v8, s[8:11], s49 offen offset:1024 lds
Mvaa 196,228,88
Ar 50,146
Ar 51,147
Mvaa 228,228,92
Ta 200,18,49152
Ta 202,18,50176
Mvaa 136,232,80
Ar 52,148
Ar 53,149
Mvaa 168,232,84
buffer_load_dwordx4 v9, s[8:11], s50 offen offset:2048 lds
Mvaa 200,232,88
Ta 204,19,49152
Ta 206,19,50176
Mvaa 232,232,92
Ar 54,150
Ar 55,151
Mvaa 140,236,80
Vc 32,48,49
Vc 33,50,51
Mvaa 172,236,84
Ta 208,20,49152
Ta 210,20,50176
Mvaa 204,236,88
buffer_load_dwordx4 v9, s[8:11], s51 offen offset:3072 lds
v_add_u32 v8, 524288, v8
v_add_u32 v9, 524288, v9
Mvaa 236,236,92
Vc 34,52,53
Vc 35,54,55
Mvaa 144,240,80
s_waitcnt lgkmcnt(6)
Ta 212,21,49152
Ta 214,21,50176
Mvaa 176,240,84
buffer_store_dwordx4 v[68:71], v2, s[24:27], s37 offen offset:3072 sc1
Mvaa 208,240,88
buffer_load_dwordx4 a[32:35], v10, s[20:23], s58 offen offset:2048 sc1
Mvaa 240,240,92
Ta 216,22,49152
Ta 218,22,50176
Mvaa 148,244,80
Ar 48,152
Ar 49,153
Mvaa 180,244,84
Ar 50,154
Ar 51,155
Mvaa 212,244,88
Ta 220,23,49152
Ta 222,23,50176
Mvaa 244,244,92
buffer_load_dwordx4 a[36:39], v10, s[20:23], 0 offen offset:2048 sc1
Mvaa 152,248,80
Ar 52,156
Ar 53,157
Mvaa 184,248,84
Ar 54,158
Ar 55,159
Mvaa 216,248,88
buffer_load_dwordx4 a[40:43], v11, s[20:23], s58 offen offset:2048 sc1
Mvaa 248,248,92
Vc 36,48,49
Vc 37,50,51
Mvaa 156,252,80
Vc 38,52,53
Vc 39,54,55
Mvaa 188,252,84
buffer_load_dwordx4 a[44:47], v11, s[20:23], 0 offen offset:2048 sc1
Mvaa 220,252,88
global_load_dword v13, v[14:15], off
Mvaa 252,252,92
s_waitcnt vmcnt(33) lgkmcnt(0)
Mvaa 128,192,96
s_add_u32 s37, s38, 12288
Mvaa 160,192,100
Ta 224,16,57344
Ta 226,16,58368
Mvaa 192,192,104
buffer_load_dwordx4 a[48:51], v10, s[20:23], s58 offen offset:3072 sc1
Mvaa 224,192,108
buffer_store_dwordx4 v[72:75], v2, s[24:27], s37 offen offset:0 sc1
Mvaa 132,196,96
Ta 228,17,57344
Ta 230,17,58368
Mvaa 164,196,100
Ar 48,160
Ar 49,161
Mvaa 196,196,104
Ar 50,162
Ar 51,163
Mvaa 228,196,108
Ta 232,18,57344
Ta 234,18,58368
Mvaa 136,200,96
Ar 52,164
Ar 53,165
Mvaa 168,200,100
buffer_load_dwordx4 a[52:55], v10, s[20:23], 0 offen offset:3072 sc1
Mvaa 200,200,104
Ta 236,19,57344
Ta 238,19,58368
Mvaa 232,200,108
Ar 54,166
Ar 55,167
Mvaa 140,204,96
Vc 40,48,49
Vc 41,50,51
Mvaa 172,204,100
Ta 240,20,57344
Ta 242,20,58368
Mvaa 204,204,104
Vc 42,52,53
Vc 43,54,55
Mvaa 236,204,108
Mvaa 144,208,96
s_waitcnt lgkmcnt(6)
Ta 244,21,57344
Ta 246,21,58368
Mvaa 176,208,100
buffer_store_dwordx4 v[76:79], v2, s[24:27], s37 offen offset:1024 sc1
Mvaa 208,208,104
buffer_load_dwordx4 a[56:59], v11, s[20:23], s58 offen offset:3072 sc1
Mvaa 240,208,108
Ta 248,22,57344
Ta 250,22,58368
Mvaa 148,212,96
Ar 48,168
Ar 49,169
Mvaa 180,212,100
Ar 50,170
Ar 51,171
Mvaa 212,212,104
Ta 252,23,57344
Ta 254,23,58368
Mvaa 244,212,108
Ar 52,172
Ar 53,173
Mvaa 152,216,96
Ar 54,174
Ar 55,175
Mvaa 184,216,100
Vc 44,48,49
Vc 45,50,51
Mvaa 216,216,104
buffer_load_dwordx4 a[60:63], v11, s[20:23], 0 offen offset:3072 sc1
v_add_u32 v10, 4096, v10
v_add_u32 v11, 4096, v11
Mvaa 248,216,108
Vc 46,52,53
Vc 47,54,55
Mvaa 156,220,96
Mvaa 188,220,100
Mvaa 220,220,104
Mvaa 252,220,108
s_waitcnt vmcnt(33) lgkmcnt(0)
s_barrier
Mvaa 128,224,112
buffer_store_dwordx4 v[80:83], v2, s[24:27], s37 offen offset:2048 sc1
Mvaa 160,224,116
s_add_u32 m0, s44, 49152
Ta 192,16,0
Ta 194,16,1024
Mvaa 192,224,120
buffer_load_dwordx4 v8, s[8:11], s48 offen offset:0 lds
Mvaa 224,224,124
Mvaa 132,228,112
Ta 196,17,0
Ta 198,17,1024
Mvaa 164,228,116
buffer_load_dwordx4 v8, s[8:11], s49 offen offset:1024 lds
Mvaa 196,228,120
Mvaa 228,228,124
Ta 200,18,0
Ta 202,18,1024
Mvaa 136,232,112
Mvaa 168,232,116
buffer_load_dwordx4 v9, s[8:11], s50 offen offset:2048 lds
Mvaa 200,232,120
Ta 204,19,0
Ta 206,19,1024
Mvaa 232,232,124
Mvaa 140,236,112
Mvaa 172,236,116
Ta 208,20,0
Ta 210,20,1024
Mvaa 204,236,120
buffer_load_dwordx4 v9, s[8:11], s51 offen offset:3072 lds
v_add_u32 v8, 524288, v8
v_add_u32 v9, 524288, v9
Mvaa 236,236,124
Mvaa 144,240,112
s_waitcnt lgkmcnt(6)
Ta 212,21,0
Ta 214,21,1024
Mvaa 176,240,116
buffer_store_dwordx4 v[84:87], v2, s[24:27], s37 offen offset:3072 sc1
Mvaa 208,240,120
buffer_load_dwordx4 a[64:67], v10, s[20:23], s58 offen offset:0 sc1
Mvaa 240,240,124
Ta 216,22,0
Ta 218,22,1024
Mvaa 148,244,112
Mvaa 180,244,116
Mvaa 212,244,120
Ta 220,23,0
Ta 222,23,1024
Mvaa 244,244,124
buffer_load_dwordx4 a[68:71], v10, s[20:23], 0 offen offset:0 sc1
Mvaa 152,248,112
Mvaa 184,248,116
Mvaa 216,248,120
buffer_load_dwordx4 a[72:75], v11, s[20:23], s58 offen offset:0 sc1
Mvaa 248,248,124
Mvaa 156,252,112
Mvaa 188,252,116
buffer_load_dwordx4 a[76:79], v11, s[20:23], 0 offen offset:0 sc1
Mvaa 220,252,120
Mvaa 252,252,124
s_waitcnt vmcnt(33) lgkmcnt(0)
Mvaa 128,192,0
s_add_u32 s37, s38, 34816
Mvaa 160,192,4
Ta 224,16,8192
Ta 226,16,9216
Mvaa 192,192,8
buffer_load_dwordx4 a[80:83], v10, s[20:23], s58 offen offset:1024 sc1
Mvaa 224,192,12
buffer_store_dwordx4 v[88:91], v2, s[24:27], s37 offen offset:0 sc1
Mvaa 132,196,0
Ta 228,17,8192
Ta 230,17,9216
Mvaa 164,196,4
Mvaa 196,196,8
Mvaa 228,196,12
Ta 232,18,8192
Ta 234,18,9216
Mvaa 136,200,0
Mvaa 168,200,4
buffer_load_dwordx4 a[84:87], v10, s[20:23], 0 offen offset:1024 sc1
Mvaa 200,200,8
Ta 236,19,8192
Ta 238,19,9216
Mvaa 232,200,12
Mvaa 140,204,0
Mvaa 172,204,4
Ta 240,20,8192
Ta 242,20,9216
Mvaa 204,204,8
Mvaa 236,204,12
Mvaa 144,208,0
s_waitcnt lgkmcnt(6)
Ta 244,21,8192
Ta 246,21,9216
Mvaa 176,208,4
buffer_store_dwordx4 v[92:95], v2, s[24:27], s37 offen offset:1024 sc1
Mvaa 208,208,8
buffer_load_dwordx4 a[88:91], v11, s[20:23], s58 offen offset:1024 sc1
Mvaa 240,208,12
Ta 248,22,8192
Ta 250,22,9216
Mvaa 148,212,0
s_mov_b32 s3, 5242880
s_mov_b32 s47, 5246976
Mvaa 180,212,4
buffer_load_dwordx4 v[56:59], v2, s[20:23], s3 offen offset:0 sc1
Mvaa 212,212,8
Ta 252,23,8192
Ta 254,23,9216
Mvaa 244,212,12
buffer_load_dwordx4 v[60:63], v2, s[20:23], s3 offen offset:1024 sc1
Mvaa 152,216,0
buffer_load_dwordx4 v[64:67], v2, s[20:23], s3 offen offset:2048 sc1
Mvaa 184,216,4
buffer_load_dwordx4 v[68:71], v2, s[20:23], s3 offen offset:3072 sc1
Mvaa 216,216,8
buffer_load_dwordx4 a[92:95], v11, s[20:23], 0 offen offset:1024 sc1
Mvaa 248,216,12
buffer_load_dwordx4 v[72:75], v2, s[20:23], s47 offen offset:0 sc1
Mvaa 156,220,0
buffer_load_dwordx4 v[76:79], v2, s[20:23], s47 offen offset:1024 sc1
Mvaa 188,220,4
buffer_load_dwordx4 v[80:83], v2, s[20:23], s47 offen offset:2048 sc1
Mvaa 220,220,8
buffer_load_dwordx4 v[84:87], v2, s[20:23], s47 offen offset:3072 sc1
Mvaa 252,220,12
s_waitcnt vmcnt(41) lgkmcnt(0)
s_barrier
Mvaa 128,224,16
buffer_store_dwordx4 v[96:99], v2, s[24:27], s37 offen offset:2048 sc1
Mvaa 160,224,20
s_add_u32 m0, s44, 0
Ta 192,16,16384
Ta 194,16,17408
Mvaa 192,224,24
buffer_load_dwordx4 v8, s[8:11], s48 offen offset:0 lds
Mvaa 224,224,28
Mvaa 132,228,16
Ta 196,17,16384
Ta 198,17,17408
Mvaa 164,228,20
buffer_load_dwordx4 v8, s[8:11], s49 offen offset:1024 lds
Mvaa 196,228,24
Mvaa 228,228,28
Ta 200,18,16384
Ta 202,18,17408
Mvaa 136,232,16
Mvaa 168,232,20
buffer_load_dwordx4 v9, s[8:11], s50 offen offset:2048 lds
Mvaa 200,232,24
Ta 204,19,16384
Ta 206,19,17408
Mvaa 232,232,28
Mvaa 140,236,16
Mvaa 172,236,20
Ta 208,20,16384
Ta 210,20,17408
Mvaa 204,236,24
buffer_load_dwordx4 v9, s[8:11], s51 offen offset:3072 lds
v_add_u32 v8, 524288, v8
v_add_u32 v9, 524288, v9
Mvaa 236,236,28
Mvaa 144,240,16
s_waitcnt lgkmcnt(6)
Ta 212,21,16384
Ta 214,21,17408
Mvaa 176,240,20
buffer_store_dwordx4 v[100:103], v2, s[24:27], s37 offen offset:3072 sc1
Mvaa 208,240,24
buffer_load_dwordx4 a[96:99], v10, s[20:23], s58 offen offset:2048 sc1
Mvaa 240,240,28
Ta 216,22,16384
Ta 218,22,17408
Mvaa 148,244,16
Mvaa 180,244,20
Mvaa 212,244,24
Ta 220,23,16384
Ta 222,23,17408
Mvaa 244,244,28
buffer_load_dwordx4 a[100:103], v10, s[20:23], 0 offen offset:2048 sc1
Mvaa 152,248,16
Mvaa 184,248,20
Mvaa 216,248,24
buffer_load_dwordx4 a[104:107], v11, s[20:23], s58 offen offset:2048 sc1
Mvaa 248,248,28
Mvaa 156,252,16
Mvaa 188,252,20
buffer_load_dwordx4 a[108:111], v11, s[20:23], 0 offen offset:2048 sc1
Mvaa 220,252,24
Mvaa 252,252,28
s_waitcnt vmcnt(41) lgkmcnt(0)
Mvaa 128,192,32
s_add_u32 s37, s38, 38912
Mvaa 160,192,36
Ta 224,16,24576
Ta 226,16,25600
Mvaa 192,192,40
buffer_load_dwordx4 a[112:115], v10, s[20:23], s58 offen offset:3072 sc1
Mvaa 224,192,44
buffer_store_dwordx4 v[104:107], v2, s[24:27], s37 offen offset:0 sc1
Mvaa 132,196,32
Ta 228,17,24576
Ta 230,17,25600
Mvaa 164,196,36
Mvaa 196,196,40
Mvaa 228,196,44
Ta 232,18,24576
Ta 234,18,25600
Mvaa 136,200,32
Mvaa 168,200,36
buffer_load_dwordx4 a[116:119], v10, s[20:23], 0 offen offset:3072 sc1
Mvaa 200,200,40
Ta 236,19,24576
Ta 238,19,25600
Mvaa 232,200,44
Mvaa 140,204,32
Mvaa 172,204,36
Ta 240,20,24576
Ta 242,20,25600
Mvaa 204,204,40
Mvaa 236,204,44
Mvaa 144,208,32
s_waitcnt lgkmcnt(6)
Ta 244,21,24576
Ta 246,21,25600
Mvaa 176,208,36
buffer_store_dwordx4 v[108:111], v2, s[24:27], s37 offen offset:1024 sc1
Mvaa 208,208,40
buffer_load_dwordx4 a[120:123], v11, s[20:23], s58 offen offset:3072 sc1
Mvaa 240,208,44
Ta 248,22,24576
Ta 250,22,25600
Mvaa 148,212,32
Mvaa 180,212,36
Mvaa 212,212,40
Ta 252,23,24576
Ta 254,23,25600
Mvaa 244,212,44
Mvaa 152,216,32
Mvaa 184,216,36
Mvaa 216,216,40
buffer_load_dwordx4 a[124:127], v11, s[20:23], 0 offen offset:3072 sc1
v_add_u32 v10, 4096, v10
v_add_u32 v11, 4096, v11
Mvaa 248,216,44
Mvaa 156,220,32
Mvaa 188,220,36
Mvaa 220,220,40
Mvaa 252,220,44
s_waitcnt vmcnt(40) lgkmcnt(0)
s_barrier
Mvaa 128,224,48
buffer_store_dwordx4 v[112:115], v2, s[24:27], s37 offen offset:2048 sc1
Mvaa 160,224,52
s_add_u32 m0, s44, 16384
Ta 192,16,32768
Ta 194,16,33792
Mvaa 192,224,56
buffer_load_dwordx4 v8, s[8:11], s48 offen offset:0 lds
Mvaa 224,224,60
Mvaa 132,228,48
Ta 196,17,32768
Ta 198,17,33792
Mvaa 164,228,52
buffer_load_dwordx4 v8, s[8:11], s49 offen offset:1024 lds
Mvaa 196,228,56
Mvaa 228,228,60
Ta 200,18,32768
Ta 202,18,33792
Mvaa 136,232,48
Mvaa 168,232,52
buffer_load_dwordx4 v9, s[8:11], s50 offen offset:2048 lds
Mvaa 200,232,56
Ta 204,19,32768
Ta 206,19,33792
Mvaa 232,232,60
Mvaa 140,236,48
Mvaa 172,236,52
Ta 208,20,32768
Ta 210,20,33792
Mvaa 204,236,56
buffer_load_dwordx4 v9, s[8:11], s51 offen offset:3072 lds
v_add_u32 v8, 524288, v8
v_add_u32 v9, 524288, v9
Mvaa 236,236,60
Mvaa 144,240,48
s_waitcnt lgkmcnt(6)
Ta 212,21,32768
Ta 214,21,33792
Mvaa 176,240,52
buffer_store_dwordx4 v[116:119], v2, s[24:27], s37 offen offset:3072 sc1
Mvaa 208,240,56
buffer_load_dwordx4 a[0:3], v10, s[20:23], s58 offen offset:0 sc1
Mvaa 240,240,60
Ta 216,22,32768
Ta 218,22,33792
Mvaa 148,244,48
Mvaa 180,244,52
Mvaa 212,244,56
Ta 220,23,32768
Ta 222,23,33792
Mvaa 244,244,60
buffer_load_dwordx4 a[4:7], v10, s[20:23], 0 offen offset:0 sc1
Mvaa 152,248,48
Mvaa 184,248,52
Mvaa 216,248,56
buffer_load_dwordx4 a[8:11], v11, s[20:23], s58 offen offset:0 sc1
Mvaa 248,248,60
Mvaa 156,252,48
Mvaa 188,252,52
buffer_load_dwordx4 a[12:15], v11, s[20:23], 0 offen offset:0 sc1
Mvaa 220,252,56
Mvaa 252,252,60
s_waitcnt vmcnt(40) lgkmcnt(0)
Mvaa 128,192,64
s_add_u32 s37, s38, 43008
Mvaa 160,192,68
Ta 224,16,40960
Ta 226,16,41984
Mvaa 192,192,72
buffer_load_dwordx4 a[16:19], v10, s[20:23], s58 offen offset:1024 sc1
Mvaa 224,192,76
buffer_store_dwordx4 v[120:123], v2, s[24:27], s37 offen offset:0 sc1
Mvaa 132,196,64
Ta 228,17,40960
Ta 230,17,41984
Mvaa 164,196,68
Mvaa 196,196,72
Mvaa 228,196,76
Ta 232,18,40960
Ta 234,18,41984
Mvaa 136,200,64
Mvaa 168,200,68
buffer_load_dwordx4 a[20:23], v10, s[20:23], 0 offen offset:1024 sc1
Mvaa 200,200,72
Ta 236,19,40960
Ta 238,19,41984
Mvaa 232,200,76
Mvaa 140,204,64
Mvaa 172,204,68
Ta 240,20,40960
Ta 242,20,41984
Mvaa 204,204,72
Mvaa 236,204,76
Mvaa 144,208,64
s_waitcnt lgkmcnt(6)
Ta 244,21,40960
Ta 246,21,41984
Mvaa 176,208,68
buffer_store_dwordx4 v[124:127], v2, s[24:27], s37 offen offset:1024 sc1
Mvaa 208,208,72
buffer_load_dwordx4 a[24:27], v11, s[20:23], s58 offen offset:1024 sc1
Mvaa 240,208,76
Ta 248,22,40960
Ta 250,22,41984
Mvaa 148,212,64
Mvaa 180,212,68
Mvaa 212,212,72
Ta 252,23,40960
Ta 254,23,41984
Mvaa 244,212,76
Mvaa 152,216,64
Mvaa 184,216,68
Mvaa 216,216,72
buffer_load_dwordx4 a[28:31], v11, s[20:23], 0 offen offset:1024 sc1
Mvaa 248,216,76
Mvaa 156,220,64
Mvaa 188,220,68
Mvaa 220,220,72
Mvaa 252,220,76
s_waitcnt vmcnt(36) lgkmcnt(0)
s_barrier
Mvaa 128,224,80
buffer_store_dwordx4 v[24:27], v2, s[24:27], s37 offen offset:2048 sc1
Mvaa 160,224,84
s_add_u32 m0, s44, 32768
Ta 192,16,49152
Ta 194,16,50176
Mvaa 192,224,88
buffer_load_dwordx4 v8, s[8:11], s48 offen offset:0 lds
Mvaa 224,224,92
Mvaa 132,228,80
Ta 196,17,49152
Ta 198,17,50176
Mvaa 164,228,84
buffer_load_dwordx4 v8, s[8:11], s49 offen offset:1024 lds
Mvaa 196,228,88
Mvaa 228,228,92
Ta 200,18,49152
Ta 202,18,50176
Mvaa 136,232,80
Mvaa 168,232,84
buffer_load_dwordx4 v9, s[8:11], s50 offen offset:2048 lds
Mvaa 200,232,88
Ta 204,19,49152
Ta 206,19,50176
Mvaa 232,232,92
Mvaa 140,236,80
Mvaa 172,236,84
Ta 208,20,49152
Ta 210,20,50176
Mvaa 204,236,88
buffer_load_dwordx4 v9, s[8:11], s51 offen offset:3072 lds
v_add_u32 v8, 524288, v8
v_add_u32 v9, 524288, v9
Mvaa 236,236,92
Mvaa 144,240,80
s_waitcnt lgkmcnt(6)
Ta 212,21,49152
Ta 214,21,50176
Mvaa 176,240,84
buffer_store_dwordx4 v[28:31], v2, s[24:27], s37 offen offset:3072 sc1
Mvaa 208,240,88
buffer_load_dwordx4 a[32:35], v10, s[20:23], s58 offen offset:2048 sc1
Mvaa 240,240,92
Ta 216,22,49152
Ta 218,22,50176
Mvaa 148,244,80
Mvaa 180,244,84
Mvaa 212,244,88
Ta 220,23,49152
Ta 222,23,50176
Mvaa 244,244,92
buffer_load_dwordx4 a[36:39], v10, s[20:23], 0 offen offset:2048 sc1
Mvaa 152,248,80
Mvaa 184,248,84
Mvaa 216,248,88
buffer_load_dwordx4 a[40:43], v11, s[20:23], s58 offen offset:2048 sc1
Mvaa 248,248,92
Mvaa 156,252,80
Mvaa 188,252,84
buffer_load_dwordx4 a[44:47], v11, s[20:23], 0 offen offset:2048 sc1
Mvaa 220,252,88
Mvaa 252,252,92
s_waitcnt vmcnt(32) lgkmcnt(0)
Mvaa 128,192,96
s_add_u32 s37, s38, 47104
Mvaa 160,192,100
Ta 224,16,57344
Ta 226,16,58368
Mvaa 192,192,104
buffer_load_dwordx4 a[48:51], v10, s[20:23], s58 offen offset:3072 sc1
Mvaa 224,192,108
buffer_store_dwordx4 v[32:35], v2, s[24:27], s37 offen offset:0 sc1
Mvaa 132,196,96
Ta 228,17,57344
Ta 230,17,58368
Mvaa 164,196,100
Mvaa 196,196,104
Mvaa 228,196,108
Ta 232,18,57344
Ta 234,18,58368
Mvaa 136,200,96
Mvaa 168,200,100
buffer_load_dwordx4 a[52:55], v10, s[20:23], 0 offen offset:3072 sc1
Mvaa 200,200,104
Ta 236,19,57344
Ta 238,19,58368
Mvaa 232,200,108
Mvaa 140,204,96
Mvaa 172,204,100
Ta 240,20,57344
Ta 242,20,58368
Mvaa 204,204,104
Mvaa 236,204,108
Mvaa 144,208,96
s_waitcnt lgkmcnt(6)
Ta 244,21,57344
Ta 246,21,58368
Mvaa 176,208,100
buffer_store_dwordx4 v[36:39], v2, s[24:27], s37 offen offset:1024 sc1
Mvaa 208,208,104
buffer_load_dwordx4 a[56:59], v11, s[20:23], s58 offen offset:3072 sc1
Mvaa 240,208,108
Ta 248,22,57344
Ta 250,22,58368
Mvaa 148,212,96
Mvaa 180,212,100
Mvaa 212,212,104
Ta 252,23,57344
Ta 254,23,58368
Mvaa 244,212,108
Mvaa 152,216,96
Mvaa 184,216,100
Mvaa 216,216,104
buffer_load_dwordx4 a[60:63], v11, s[20:23], 0 offen offset:3072 sc1
v_add_u32 v10, 4096, v10
v_add_u32 v11, 4096, v11
Mvaa 248,216,108
Mvaa 156,220,96
Mvaa 188,220,100
Mvaa 220,220,104
Mvaa 252,220,108
s_waitcnt vmcnt(32) lgkmcnt(0)
s_barrier
Mvaa 128,224,112
buffer_store_dwordx4 v[40:43], v2, s[24:27], s37 offen offset:2048 sc1
Mvaa 160,224,116
s_add_u32 m0, s44, 49152
Ta 192,16,0
Ta 194,16,1024
Mvaa 192,224,120
buffer_load_dwordx4 v8, s[8:11], s48 offen offset:0 lds
Mvaa 224,224,124
Mvaa 132,228,112
Ta 196,17,0
Ta 198,17,1024
Mvaa 164,228,116
buffer_load_dwordx4 v8, s[8:11], s49 offen offset:1024 lds
Mvaa 196,228,120
Mvaa 228,228,124
Ta 200,18,0
Ta 202,18,1024
Mvaa 136,232,112
Mvaa 168,232,116
buffer_load_dwordx4 v9, s[8:11], s50 offen offset:2048 lds
Mvaa 200,232,120
Ta 204,19,0
Ta 206,19,1024
Mvaa 232,232,124
Mvaa 140,236,112
Mvaa 172,236,116
Ta 208,20,0
Ta 210,20,1024
Mvaa 204,236,120
buffer_load_dwordx4 v9, s[8:11], s51 offen offset:3072 lds
v_add_u32 v8, 524288, v8
v_add_u32 v9, 524288, v9
Mvaa 236,236,124
Mvaa 144,240,112
s_waitcnt lgkmcnt(6)
Ta 212,21,0
Ta 214,21,1024
Mvaa 176,240,116
buffer_store_dwordx4 v[44:47], v2, s[24:27], s37 offen offset:3072 sc1
Mvaa 208,240,120
buffer_load_dwordx4 a[64:67], v10, s[20:23], s58 offen offset:0 sc1
Mvaa 240,240,124
Ta 216,22,0
Ta 218,22,1024
Mvaa 148,244,112
v_mov_b32 v12, 1
v_and_b32_e64 v1, 15, v0
Mvaa 180,244,116
v_lshlrev_b32_e64 v1, 2, v1
Mvaa 212,244,120
Ta 220,23,0
Ta 222,23,1024
Mvaa 244,244,124
buffer_load_dwordx4 a[68:71], v10, s[20:23], 0 offen offset:0 sc1
Mvaa 152,248,112
s_lshr_b32 s6, s33, 1
s_lshl_b32 s6, s6, 7
s_add_u32 s6, s6, 5296128
Mvaa 184,248,116
s_cmp_eq_u32 s32, 0
s_cselect_b32 s6, s6, 2146435072
Mvaa 216,248,120
buffer_load_dwordx4 a[72:75], v11, s[20:23], s58 offen offset:0 sc1
Mvaa 248,248,124
Mvaa 156,252,112
Mvaa 188,252,116
buffer_load_dwordx4 a[76:79], v11, s[20:23], 0 offen offset:0 sc1
Mvaa 220,252,120
Mvaa 252,252,124
s_waitcnt vmcnt(32) lgkmcnt(0)
Mvaa 128,192,0
Mvaa 160,192,4
Ta 224,16,8192
Ta 226,16,9216
Mvaa 192,192,8
buffer_load_dwordx4 a[80:83], v10, s[20:23], s58 offen offset:1024 sc1
Mvaa 224,192,12
Mvaa 132,196,0
Ta 228,17,8192
Ta 230,17,9216
Mvaa 164,196,4
Mvaa 196,196,8
Mvaa 228,196,12
Ta 232,18,8192
Ta 234,18,9216
Mvaa 136,200,0
Mvaa 168,200,4
buffer_load_dwordx4 a[84:87], v10, s[20:23], 0 offen offset:1024 sc1
Mvaa 200,200,8
Ta 236,19,8192
Ta 238,19,9216
Mvaa 232,200,12
Mvaa 140,204,0
Mvaa 172,204,4
Ta 240,20,8192
Ta 242,20,9216
Mvaa 204,204,8
Mvaa 236,204,12
Mvaa 144,208,0
s_waitcnt lgkmcnt(6)
Ta 244,21,8192
Ta 246,21,9216
Mvaa 176,208,4
v_max_u32 v14, v56, v57
v_min_u32_e64 v15, v56, v57
Mvaa 208,208,8
buffer_load_dwordx4 a[88:91], v11, s[20:23], s58 offen offset:1024 sc1
Mvaa 240,208,12
Ta 248,22,8192
Ta 250,22,9216
Mvaa 148,212,0
v_med3_u32 v15, v14, v15, v58
v_max_u32_e64 v14, v14, v58
Mvaa 180,212,4
v_med3_u32 v15, v14, v15, v59
v_max_u32_e64 v14, v14, v59
Mvaa 212,212,8
Ta 252,23,8192
Ta 254,23,9216
Mvaa 244,212,12
v_med3_u32 v15, v14, v15, v60
v_max_u32_e64 v14, v14, v60
Mvaa 152,216,0
v_med3_u32 v15, v14, v15, v61
v_max_u32_e64 v14, v14, v61
Mvaa 184,216,4
v_med3_u32 v15, v14, v15, v62
v_max_u32_e64 v14, v14, v62
Mvaa 216,216,8
buffer_load_dwordx4 a[92:95], v11, s[20:23], 0 offen offset:1024 sc1
Mvaa 248,216,12
v_med3_u32 v15, v14, v15, v63
v_max_u32_e64 v14, v14, v63
Mvaa 156,220,0
v_med3_u32 v15, v14, v15, v64
v_max_u32_e64 v14, v14, v64
Mvaa 188,220,4
v_med3_u32 v15, v14, v15, v65
v_max_u32_e64 v14, v14, v65
Mvaa 220,220,8
v_med3_u32 v15, v14, v15, v66
v_max_u32_e64 v14, v14, v66
Mvaa 252,220,12
v_med3_u32 v15, v14, v15, v67
v_max_u32 v14, v14, v67
s_waitcnt vmcnt(30) lgkmcnt(0)
s_barrier
Mvaa 128,224,16
v_med3_u32 v15, v14, v15, v68
v_max_u32 v14, v14, v68
Mvaa 160,224,20
s_add_u32 m0, s44, 0
Ta 192,16,16384
Ta 194,16,17408
Mvaa 192,224,24
buffer_load_dwordx4 v8, s[8:11], s48 offen offset:0 lds
Mvaa 224,224,28
v_med3_u32 v15, v14, v15, v69
v_max_u32 v14, v14, v69
Mvaa 132,228,16
Ta 196,17,16384
Ta 198,17,17408
Mvaa 164,228,20
buffer_load_dwordx4 v8, s[8:11], s49 offen offset:1024 lds
Mvaa 196,228,24
v_med3_u32 v15, v14, v15, v70
v_max_u32_e64 v14, v14, v70
Mvaa 228,228,28
Ta 200,18,16384
Ta 202,18,17408
Mvaa 136,232,16
v_med3_u32 v15, v14, v15, v71
v_max_u32_e64 v14, v14, v71
Mvaa 168,232,20
buffer_load_dwordx4 v9, s[8:11], s50 offen offset:2048 lds
Mvaa 200,232,24
Ta 204,19,16384
Ta 206,19,17408
Mvaa 232,232,28
v_med3_u32 v15, v14, v15, v72
v_max_u32_e64 v14, v14, v72
Mvaa 140,236,16
v_med3_u32 v15, v14, v15, v73
v_max_u32_e64 v14, v14, v73
Mvaa 172,236,20
Ta 208,20,16384
Ta 210,20,17408
Mvaa 204,236,24
buffer_load_dwordx4 v9, s[8:11], s51 offen offset:3072 lds
v_add_u32 v8, 524288, v8
v_add_u32 v9, 524288, v9
Mvaa 236,236,28
v_med3_u32 v15, v14, v15, v74
v_max_u32_e64 v14, v14, v74
Mvaa 144,240,16
s_waitcnt lgkmcnt(6)
Ta 212,21,16384
Ta 214,21,17408
Mvaa 176,240,20
v_med3_u32 v15, v14, v15, v75
v_max_u32 v14, v14, v75
Mvaa 208,240,24
buffer_load_dwordx4 a[96:99], v10, s[20:23], s58 offen offset:2048 sc1
Mvaa 240,240,28
Ta 216,22,16384
Ta 218,22,17408
Mvaa 148,244,16
v_med3_u32 v15, v14, v15, v76
v_max_u32_e64 v14, v14, v76
Mvaa 180,244,20
v_med3_u32 v15, v14, v15, v77
v_max_u32_e64 v14, v14, v77
Mvaa 212,244,24
Ta 220,23,16384
Ta 222,23,17408
Mvaa 244,244,28
buffer_load_dwordx4 a[100:103], v10, s[20:23], 0 offen offset:2048 sc1
Mvaa 152,248,16
v_med3_u32 v15, v14, v15, v78
v_max_u32_e64 v14, v14, v78
Mvaa 184,248,20
v_med3_u32 v15, v14, v15, v79
v_max_u32_e64 v14, v14, v79
Mvaa 216,248,24
buffer_load_dwordx4 a[104:107], v11, s[20:23], s58 offen offset:2048 sc1
Mvaa 248,248,28
v_med3_u32 v15, v14, v15, v80
v_max_u32_e64 v14, v14, v80
Mvaa 156,252,16
v_med3_u32 v15, v14, v15, v81
v_max_u32_e64 v14, v14, v81
Mvaa 188,252,20
buffer_load_dwordx4 a[108:111], v11, s[20:23], 0 offen offset:2048 sc1
Mvaa 220,252,24
v_med3_u32 v15, v14, v15, v82
v_max_u32_e64 v14, v14, v82
Mvaa 252,252,28
v_med3_u32 v15, v14, v15, v83
v_max_u32 v14, v14, v83
s_waitcnt vmcnt(28) lgkmcnt(0)
Mvaa 128,192,32
v_med3_u32 v15, v14, v15, v84
v_max_u32_e64 v14, v14, v84
Mvaa 160,192,36
Ta 224,16,24576
Ta 226,16,25600
Mvaa 192,192,40
buffer_load_dwordx4 a[112:115], v10, s[20:23], s58 offen offset:3072 sc1
Mvaa 224,192,44
v_med3_u32 v15, v14, v15, v85
v_max_u32_e64 v14, v14, v85
Mvaa 132,196,32
Ta 228,17,24576
Ta 230,17,25600
Mvaa 164,196,36
v_med3_u32 v15, v14, v15, v86
v_max_u32_e64 v14, v14, v86
Mvaa 196,196,40
v_med3_u32 v15, v14, v15, v87
v_max_u32_e64 v14, v14, v87
Mvaa 228,196,44
Ta 232,18,24576
Ta 234,18,25600
Mvaa 136,200,32
v_mov_b32_e64 v13, v14
Mvaa 168,200,36
buffer_load_dwordx4 a[116:119], v10, s[20:23], 0 offen offset:3072 sc1
Mvaa 200,200,40
Ta 236,19,24576
Ta 238,19,25600
Mvaa 232,200,44
v_max_u32_dpp v13, v13, v13 quad_perm:[1,0,3,2] row_mask:0xf bank_mask:0xf
Mvaa 140,204,32
s_nop 0
v_max_u32_dpp v13, v13, v13 quad_perm:[2,3,0,1] row_mask:0xf bank_mask:0xf
Mvaa 172,204,36
Ta 240,20,24576
Ta 242,20,25600
Mvaa 204,204,40
v_max_u32_dpp v13, v13, v13 row_half_mirror row_mask:0xf bank_mask:0xf
Mvaa 236,204,44
s_nop 0
v_max_u32_dpp v13, v13, v13 row_mirror row_mask:0xf bank_mask:0xf
Mvaa 144,208,32
s_waitcnt lgkmcnt(6)
Ta 244,21,24576
Ta 246,21,25600
Mvaa 176,208,36
v_readlane_b32 s3, v13, 0
v_readlane_b32 s47, v13, 16
Mvaa 208,208,40
buffer_load_dwordx4 a[120:123], v11, s[20:23], s58 offen offset:3072 sc1
Mvaa 240,208,44
Ta 248,22,24576
Ta 250,22,25600
Mvaa 148,212,32
v_readlane_b32 s4, v13, 32
v_readlane_b32 s5, v13, 48
Mvaa 180,212,36
s_max_u32 s3, s3, s47
s_max_u32 s4, s4, s5
s_max_u32 s40, s3, s4
Mvaa 212,212,40
Ta 252,23,24576
Ta 254,23,25600
Mvaa 244,212,44
v_cmp_eq_u32 vcc, s40, v14
Mvaa 152,216,32
s_nop 0
v_cndmask_b32 v13, v14, v15, vcc
Mvaa 184,216,36
s_nop 0
v_max_u32_dpp v13, v13, v13 quad_perm:[1,0,3,2] row_mask:0xf bank_mask:0xf
Mvaa 216,216,40
buffer_load_dwordx4 a[124:127], v11, s[20:23], 0 offen offset:3072 sc1
v_add_u32 v10, 4096, v10
v_add_u32 v11, 4096, v11
Mvaa 248,216,44
v_max_u32_dpp v13, v13, v13 quad_perm:[2,3,0,1] row_mask:0xf bank_mask:0xf
Mvaa 156,220,32
s_nop 0
v_max_u32_dpp v13, v13, v13 row_half_mirror row_mask:0xf bank_mask:0xf
Mvaa 188,220,36
s_nop 0
v_max_u32_dpp v13, v13, v13 row_mirror row_mask:0xf bank_mask:0xf
Mvaa 220,220,40
v_readlane_b32 s3, v13, 0
v_readlane_b32 s47, v13, 16
Mvaa 252,220,44
v_readlane_b32 s4, v13, 32
v_readlane_b32 s5, v13, 48
s_waitcnt vmcnt(26) lgkmcnt(0)
s_barrier
Mvaa 128,224,48
s_max_u32 s3, s3, s47
s_max_u32 s4, s4, s5
s_max_u32 s41, s3, s4
Mvaa 160,224,52
s_add_u32 m0, s44, 16384
Ta 192,16,32768
Ta 194,16,33792
Mvaa 192,224,56
buffer_load_dwordx4 v8, s[8:11], s48 offen offset:0 lds
Mvaa 224,224,60
s_and_b32 s3, s40, 0xffff
s_sub_u32 s42, 0xffff, s3
s_and_b32 s3, s41, 0xffff
Mvaa 132,228,48
Ta 196,17,32768
Ta 198,17,33792
Mvaa 164,228,52
buffer_load_dwordx4 v8, s[8:11], s49 offen offset:1024 lds
Mvaa 196,228,56
s_sub_u32 s43, 0xffff, s3
v_mov_b32 v60, s40
v_not_b32_e64 v61, v60
Mvaa 228,228,60
Ta 200,18,32768
Ta 202,18,33792
Mvaa 136,232,48
v_ashrrev_i32_e64 v61, 31, v61
v_or_b32 v61, 0x80000000, v61
Mvaa 168,232,52
buffer_load_dwordx4 v9, s[8:11], s50 offen offset:2048 lds
Mvaa 200,232,56
Ta 204,19,32768
Ta 206,19,33792
Mvaa 232,232,60
v_xor_b32_e64 v60, v60, v61
v_and_b32 v60, 0xffff0000, v60
Mvaa 140,236,48
v_mul_f32 v60, 0xbfb8aa3b, v60
Mvaa 172,236,52
Ta 208,20,32768
Ta 210,20,33792
Mvaa 204,236,56
buffer_load_dwordx4 v9, s[8:11], s51 offen offset:3072 lds
v_add_u32 v8, 524288, v8
v_add_u32 v9, 524288, v9
Mvaa 236,236,60
VE 60,60
Mvaa 144,240,48
s_waitcnt lgkmcnt(6)
Ta 212,21,32768
Ta 214,21,33792
Mvaa 176,240,52
v_add_f32 v60, 1.0, v60
Mvaa 208,240,56
buffer_load_dwordx4 a[0:3], v10, s[20:23], s58 offen offset:0 sc1
Mvaa 240,240,60
Ta 216,22,32768
Ta 218,22,33792
Mvaa 148,244,48
v_rcp_f32_e64 v60, v60
Mvaa 180,244,52
Vc 60,60,60
v_and_b32 v64, 0xffff0000, v60
Mvaa 212,244,56
Ta 220,23,32768
Ta 222,23,33792
Mvaa 244,244,60
buffer_load_dwordx4 a[4:7], v10, s[20:23], 0 offen offset:0 sc1
Mvaa 152,248,48
v_mov_b32 v60, s41
v_not_b32 v61, v60
Mvaa 184,248,52
v_ashrrev_i32_e64 v61, 31, v61
v_or_b32 v61, 0x80000000, v61
Mvaa 216,248,56
buffer_load_dwordx4 a[8:11], v11, s[20:23], s58 offen offset:0 sc1
Mvaa 248,248,60
v_xor_b32_e64 v60, v60, v61
v_and_b32 v60, 0xffff0000, v60
Mvaa 156,252,48
v_mul_f32 v60, 0xbfb8aa3b, v60
Mvaa 188,252,52
buffer_load_dwordx4 a[12:15], v11, s[20:23], 0 offen offset:0 sc1
Mvaa 220,252,56
VE 60,60
Mvaa 252,252,60
v_add_f32 v60, 1.0, v60
s_waitcnt vmcnt(24) lgkmcnt(0)
Mvaa 128,192,64
v_rcp_f32_e64 v60, v60
Mvaa 160,192,68
Ta 224,16,40960
Ta 226,16,41984
Mvaa 192,192,72
buffer_load_dwordx4 a[16:19], v10, s[20:23], s58 offen offset:1024 sc1
Mvaa 224,192,76
Vc 60,60,60
v_and_b32 v65, 0xffff0000, v60
Mvaa 132,196,64
Ta 228,17,40960
Ta 230,17,41984
Mvaa 164,196,68
v_mov_b32 v48, 0
v_mov_b32 v49, 0
Mvaa 196,196,72
v_mov_b32 v50, 0
v_mov_b32 v51, 0
Mvaa 228,196,76
Ta 232,18,40960
Ta 234,18,41984
Mvaa 136,200,64
v_mov_b32 v52, 0
v_mov_b32 v53, 0
Mvaa 168,200,68
buffer_load_dwordx4 a[20:23], v10, s[20:23], 0 offen offset:1024 sc1
Mvaa 200,200,72
Ta 236,19,40960
Ta 238,19,41984
Mvaa 232,200,76
v_mov_b32 v54, 0
v_mov_b32 v55, 0
Mvaa 140,204,64
v_mov_b32 v56, 0
v_mov_b32 v57, 0
Mvaa 172,204,68
Ta 240,20,40960
Ta 242,20,41984
Mvaa 204,204,72
v_mov_b32 v58, 0
v_mov_b32 v59, 0
Mvaa 236,204,76
v_mov_b32 v60, 0
v_mov_b32 v61, 0
Mvaa 144,208,64
s_waitcnt lgkmcnt(6)
Ta 244,21,40960
Ta 246,21,41984
Mvaa 176,208,68
v_mov_b32 v62, 0
v_mov_b32_e64 v63, 0
Mvaa 208,208,72
buffer_load_dwordx4 a[24:27], v11, s[20:23], s58 offen offset:1024 sc1
Mvaa 240,208,76
Ta 248,22,40960
Ta 250,22,41984
Mvaa 148,212,64
s_mul_i32 s3, s34, s34
s_mul_i32 s47, s33, 48
s_add_u32 s3, s3, s47
Mvaa 180,212,68
s_lshl_b32 s3, s3, 2
s_add_u32 s3, s3, s32
s_lshl_b32 s3, s3, 7
Mvaa 212,212,72
Ta 252,23,40960
Ta 254,23,41984
Mvaa 244,212,76
s_sub_u32 s3, s3, 8704
s_cmp_ge_u32 s34, 4
s_cselect_b32 s3, s3, 0
s_cselect_b32 s40, 512, 0
s_cselect_b32 s47, 786432, 0
Mvaa 152,216,64
v_subrev_u32_e64 v31, 0, v0
v_mul_lo_u32 v31, v31, s47
Mvaa 184,216,68
v_min_u32 v31, 6553600, v31
v_mov_b32_e64 v28, s94
Mvaa 216,216,72
buffer_load_dwordx4 a[28:31], v11, s[20:23], 0 offen offset:1024 sc1
Mvaa 248,216,76
v_mov_b32 v29, s95
v_mov_b32 v30, v31
Mvaa 156,220,64
v_subrev_u32_e64 v31, 10, v0
v_mul_lo_u32 v31, v31, s47
Mvaa 188,220,68
v_min_u32 v31, 3407872, v31
v_mov_b32_e64 v14, s100
Mvaa 220,220,72
v_mov_b32_e64 v15, s101
Mvaa 252,220,76
v_cmp_le_u32 vcc, 10, v0
s_waitcnt vmcnt(24) lgkmcnt(0)
s_barrier
Mvaa 128,224,80
s_mov_b64 exec, 1
buffer_store_dword v12, v7, s[20:23], s39 offen sc1
s_mov_b64 exec, -1
Mvaa 160,224,84
s_add_u32 m0, s44, 32768
Ta 192,16,49152
Ta 194,16,50176
Mvaa 192,224,88
buffer_load_dwordx4 v8, s[8:11], s48 offen offset:0 lds
Mvaa 224,224,92
v_cndmask_b32 v28, v28, v14, vcc
v_cndmask_b32 v29, v29, v15, vcc
Mvaa 132,228,80
Ta 196,17,49152
Ta 198,17,50176
Mvaa 164,228,84
buffer_load_dwordx4 v8, s[8:11], s49 offen offset:1024 lds
Mvaa 196,228,88
v_cndmask_b32 v30, v30, v31, vcc
Mvaa 228,228,92
Ta 200,18,49152
Ta 202,18,50176
Mvaa 136,232,80
v_subrev_u32_e64 v31, 16, v0
v_mul_lo_u32 v31, v31, s47
Mvaa 168,232,84
buffer_load_dwordx4 v9, s[8:11], s50 offen offset:2048 lds
Mvaa 200,232,88
Ta 204,19,49152
Ta 206,19,50176
Mvaa 232,232,92
v_min_u32 v31, 6553600, v31
v_mov_b32_e64 v14, s60
Mvaa 140,236,80
v_mov_b32_e64 v15, s61
Mvaa 172,236,84
Ta 208,20,49152
Ta 210,20,50176
Mvaa 204,236,88
buffer_load_dwordx4 v9, s[8:11], s51 offen offset:3072 lds
v_add_u32 v8, 524288, v8
v_add_u32 v9, 524288, v9
Mvaa 236,236,92
v_cmp_le_u32 vcc, 16, v0
Mvaa 144,240,80
s_waitcnt lgkmcnt(6)
Ta 212,21,49152
Ta 214,21,50176
Mvaa 176,240,84
v_cndmask_b32 v28, v28, v14, vcc
v_cndmask_b32 v29, v29, v15, vcc
Mvaa 208,240,88
buffer_load_dwordx4 a[32:35], v10, s[20:23], s58 offen offset:2048 sc1
Mvaa 240,240,92
Ta 216,22,49152
Ta 218,22,50176
Mvaa 148,244,80
v_cndmask_b32 v30, v30, v31, vcc
Mvaa 180,244,84
v_subrev_u32 v31, 26, v0
v_mul_lo_u32 v31, v31, s47
Mvaa 212,244,88
Ta 220,23,49152
Ta 222,23,50176
Mvaa 244,244,92
buffer_load_dwordx4 a[36:39], v10, s[20:23], 0 offen offset:2048 sc1
Mvaa 152,248,80
v_min_u32 v31, 6553600, v31
v_mov_b32_e64 v14, s68
Mvaa 184,248,84
v_mov_b32_e64 v15, s69
Mvaa 216,248,88
buffer_load_dwordx4 a[40:43], v11, s[20:23], s58 offen offset:2048 sc1
Mvaa 248,248,92
v_cmp_le_u32 vcc, 26, v0
Mvaa 156,252,80
s_nop 0
v_cndmask_b32 v28, v28, v14, vcc
v_cndmask_b32 v29, v29, v15, vcc
Mvaa 188,252,84
buffer_load_dwordx4 a[44:47], v11, s[20:23], 0 offen offset:2048 sc1
Mvaa 220,252,88
v_cndmask_b32 v30, v30, v31, vcc
Mvaa 252,252,92
v_subrev_u32 v31, 36, v0
v_mul_lo_u32 v31, v31, s47
s_waitcnt vmcnt(25) lgkmcnt(0)
Mvaa 128,192,96
v_min_u32 v31, 7602176, v31
v_mov_b32 v14, s92
Mvaa 160,192,100
Ta 224,16,57344
Ta 226,16,58368
Mvaa 192,192,104
buffer_load_dwordx4 a[48:51], v10, s[20:23], s58 offen offset:3072 sc1
Mvaa 224,192,108
v_mov_b32_e64 v15, s93
Mvaa 132,196,96
Ta 228,17,57344
Ta 230,17,58368
Mvaa 164,196,100
v_cmp_le_u32 vcc, 36, v0
Mvaa 196,196,104
s_nop 0
v_cndmask_b32 v28, v28, v14, vcc
v_cndmask_b32 v29, v29, v15, vcc
Mvaa 228,196,108
Ta 232,18,57344
Ta 234,18,58368
Mvaa 136,200,96
v_cndmask_b32 v30, v30, v31, vcc
Mvaa 168,200,100
buffer_load_dwordx4 a[52:55], v10, s[20:23], 0 offen offset:3072 sc1
Mvaa 200,200,104
Ta 236,19,57344
Ta 238,19,58368
Mvaa 232,200,108
v_add_u32 v30, s3, v30
v_ashrrev_i32_e64 v31, 31, v30
Mvaa 140,204,96
v_lshl_add_u64 v[28:29], v[30:31], 0, v[28:29]
Mvaa 172,204,100
Ta 240,20,57344
Ta 242,20,58368
Mvaa 204,204,104
s_mov_b32 s41, 0
v_readfirstlane_b32 s100, v64
v_readfirstlane_b32 s101, v65
Mvaa 236,204,108
s_mov_b32 s24, s60
s_mov_b32 s25, s61
s_mov_b32 s26, s62
Mvaa 144,208,96
s_waitcnt lgkmcnt(6)
Ta 244,21,57344
Ta 246,21,58368
Mvaa 176,208,100
s_mov_b32 s94, 1040356334
s_mov_b32 s95, 1040356334
s_sub_u32 s55, 15, s34
Mvaa 208,208,104
buffer_load_dwordx4 a[56:59], v11, s[20:23], s58 offen offset:3072 sc1
Mvaa 240,208,108
Ta 248,22,57344
Ta 250,22,58368
Mvaa 148,212,96
s_sub_u32 s45, s36, 3
s_sub_u32 s46, s35, 3
s_mov_b32 s54, s44
Mvaa 180,212,100
s_sub_u32 s35, s35, 2
s_sub_u32 s36, s36, 2
Mvaa 212,212,104
Ta 252,23,57344
Ta 254,23,58368
Mvaa 244,212,108
Mvaa 152,216,96
Mvaa 184,216,100
Mvaa 216,216,104
buffer_load_dwordx4 a[60:63], v11, s[20:23], 0 offen offset:3072 sc1
v_add_u32 v10, 4096, v10
v_add_u32 v11, 4096, v11
Mvaa 248,216,108
Mvaa 156,220,96
Mvaa 188,220,100
Mvaa 220,220,104
Mvaa 252,220,108
s_waitcnt vmcnt(25) lgkmcnt(0)
s_barrier
Mvaa 128,224,112
Mvaa 160,224,116
s_add_u32 m0, s44, 49152
Ta 192,16,0
Ta 194,16,1024
Mvaa 192,224,120
buffer_load_dwordx4 v8, s[8:11], s48 offen offset:0 lds
Mvaa 224,224,124
Mvaa 132,228,112
Ta 196,17,0
Ta 198,17,1024
Mvaa 164,228,116
buffer_load_dwordx4 v8, s[8:11], s49 offen offset:1024 lds
Mvaa 196,228,120
Mvaa 228,228,124
Ta 200,18,0
Ta 202,18,1024
Mvaa 136,232,112
Mvaa 168,232,116
buffer_load_dwordx4 v9, s[8:11], s50 offen offset:2048 lds
Mvaa 200,232,120
Ta 204,19,0
Ta 206,19,1024
Mvaa 232,232,124
Mvaa 140,236,112
Mvaa 172,236,116
Ta 208,20,0
Ta 210,20,1024
Mvaa 204,236,120
buffer_load_dwordx4 v9, s[8:11], s51 offen offset:3072 lds
v_add_u32 v8, 524288, v8
v_add_u32 v9, 524288, v9
Mvaa 236,236,124
Mvaa 144,240,112
s_waitcnt lgkmcnt(6)
Ta 212,21,0
Ta 214,21,1024
Mvaa 176,240,116
Mvaa 208,240,120
buffer_load_dwordx4 a[64:67], v10, s[20:23], s58 offen offset:0 sc1
Mvaa 240,240,124
Ta 216,22,0
Ta 218,22,1024
Mvaa 148,244,112
Mvaa 180,244,116
Mvaa 212,244,120
Ta 220,23,0
Ta 222,23,1024
Mvaa 244,244,124
buffer_load_dwordx4 a[68:71], v10, s[20:23], 0 offen offset:0 sc1
Mvaa 152,248,112
Mvaa 184,248,116
Mvaa 216,248,120
buffer_load_dwordx4 a[72:75], v11, s[20:23], s58 offen offset:0 sc1
Mvaa 248,248,124
Mvaa 156,252,112
Mvaa 188,252,116
buffer_load_dwordx4 a[76:79], v11, s[20:23], 0 offen offset:0 sc1
Mvaa 220,252,120
Mvaa 252,252,124
s_waitcnt vmcnt(25) lgkmcnt(0)
Mvaa 128,192,0
Mvaa 160,192,4
Ta 224,16,8192
Ta 226,16,9216
Mvaa 192,192,8
buffer_load_dwordx4 a[80:83], v10, s[20:23], s58 offen offset:1024 sc1
Mvaa 224,192,12
Mvaa 132,196,0
Ta 228,17,8192
Ta 230,17,9216
Mvaa 164,196,4
Mvaa 196,196,8
Mvaa 228,196,12
Ta 232,18,8192
Ta 234,18,9216
Mvaa 136,200,0
Mvaa 168,200,4
buffer_load_dwordx4 a[84:87], v10, s[20:23], 0 offen offset:1024 sc1
Mvaa 200,200,8
Ta 236,19,8192
Ta 238,19,9216
Mvaa 232,200,12
Mvaa 140,204,0
Mvaa 172,204,4
Ta 240,20,8192
Ta 242,20,9216
Mvaa 204,204,8
Mvaa 236,204,12
Mvaa 144,208,0
s_waitcnt lgkmcnt(6)
Ta 244,21,8192
Ta 246,21,9216
Mvaa 176,208,4
Mvaa 208,208,8
buffer_load_dwordx4 a[88:91], v11, s[20:23], s58 offen offset:1024 sc1
Mvaa 240,208,12
Ta 248,22,8192
Ta 250,22,9216
Mvaa 148,212,0
Mvaa 180,212,4
Mvaa 212,212,8
Ta 252,23,8192
Ta 254,23,9216
Mvaa 244,212,12
Mvaa 152,216,0
Mvaa 184,216,4
Mvaa 216,216,8
buffer_load_dwordx4 a[92:95], v11, s[20:23], 0 offen offset:1024 sc1
Mvaa 248,216,12
Mvaa 156,220,0
Mvaa 188,220,4
Mvaa 220,220,8
Mvaa 252,220,12
s_waitcnt vmcnt(25) lgkmcnt(0)
s_barrier
Mvaa 128,224,16
v_accvgpr_write_b32 a0, 0
v_accvgpr_write_b32 a1, 0
Mvaa 160,224,20
Ta 192,16,16384
Ta 194,16,17408
Mvaa 192,224,24
buffer_load_dwordx4 a[96:99], v10, s[20:23], s58 offen offset:2048 sc1
Mvaa 224,224,28
v_accvgpr_write_b32 a2, 0
v_accvgpr_write_b32 a3, 0
Mvaa 132,228,16
Ta 196,17,16384
Ta 198,17,17408
Mvaa 164,228,20
v_accvgpr_write_b32 a4, 0
v_accvgpr_write_b32 a5, 0
Mvaa 196,228,24
v_accvgpr_write_b32 a6, 0
v_accvgpr_write_b32 a7, 0
Mvaa 228,228,28
Ta 200,18,16384
Ta 202,18,17408
Mvaa 136,232,16
v_accvgpr_write_b32 a8, 0
v_accvgpr_write_b32 a9, 0
Mvaa 168,232,20
buffer_load_dwordx4 a[100:103], v10, s[20:23], 0 offen offset:2048 sc1
Mvaa 200,232,24
Ta 204,19,16384
Ta 206,19,17408
Mvaa 232,232,28
v_accvgpr_write_b32 a10, 0
v_accvgpr_write_b32 a11, 0
Mvaa 140,236,16
v_accvgpr_write_b32 a12, 0
v_accvgpr_write_b32 a13, 0
Mvaa 172,236,20
Ta 208,20,16384
Ta 210,20,17408
Mvaa 204,236,24
v_accvgpr_write_b32 a14, 0
v_accvgpr_write_b32 a15, 0
Mvaa 236,236,28
Mvaa 144,240,16
s_waitcnt lgkmcnt(6)
Ta 212,21,16384
Ta 214,21,17408
Mvaa 176,240,20
Mvaa 208,240,24
buffer_load_dwordx4 a[104:107], v11, s[20:23], s58 offen offset:2048 sc1
Mvaa 240,240,28
Ta 216,22,16384
Ta 218,22,17408
Mvaa 148,244,16
Mvaa 180,244,20
Mvaa 212,244,24
Ta 220,23,16384
Ta 222,23,17408
Mvaa 244,244,28
Mvaa 152,248,16
Mvaa 184,248,20
Mvaa 216,248,24
buffer_load_dwordx4 a[108:111], v11, s[20:23], 0 offen offset:2048 sc1
Mvaa 248,248,28
Mvaa 156,252,16
Mvaa 188,252,20
Mvaa 220,252,24
Mvaa 252,252,28
s_waitcnt vmcnt(20) lgkmcnt(0)
Mvaa 128,192,32
v_accvgpr_write_b32 a16, 0
v_accvgpr_write_b32 a17, 0
Mvaa 160,192,36
Ta 224,16,24576
Ta 226,16,25600
Mvaa 192,192,40
buffer_load_dwordx4 a[112:115], v10, s[20:23], s58 offen offset:3072 sc1
Mvaa 224,192,44
v_accvgpr_write_b32 a18, 0
v_accvgpr_write_b32 a19, 0
Mvaa 132,196,32
Ta 228,17,24576
Ta 230,17,25600
Mvaa 164,196,36
v_accvgpr_write_b32 a20, 0
v_accvgpr_write_b32 a21, 0
Mvaa 196,196,40
v_accvgpr_write_b32 a22, 0
v_accvgpr_write_b32 a23, 0
Mvaa 228,196,44
Ta 232,18,24576
Ta 234,18,25600
Mvaa 136,200,32
v_accvgpr_write_b32 a24, 0
v_accvgpr_write_b32 a25, 0
Mvaa 168,200,36
buffer_load_dwordx4 a[116:119], v10, s[20:23], 0 offen offset:3072 sc1
Mvaa 200,200,40
Ta 236,19,24576
Ta 238,19,25600
Mvaa 232,200,44
v_accvgpr_write_b32 a26, 0
v_accvgpr_write_b32 a27, 0
Mvaa 140,204,32
v_accvgpr_write_b32 a28, 0
v_accvgpr_write_b32 a29, 0
Mvaa 172,204,36
Ta 240,20,24576
Ta 242,20,25600
Mvaa 204,204,40
v_accvgpr_write_b32 a30, 0
v_accvgpr_write_b32 a31, 0
Mvaa 236,204,44
Mvaa 144,208,32
s_waitcnt lgkmcnt(6)
Ta 244,21,24576
Ta 246,21,25600
Mvaa 176,208,36
buffer_load_dword v12, v1, s[20:23], s6 offen sc1
Mvaa 208,208,40
buffer_load_dwordx4 a[120:123], v11, s[20:23], s58 offen offset:3072 sc1
Mvaa 240,208,44
Ta 248,22,24576
Ta 250,22,25600
Mvaa 148,212,32
s_add_u32 m0, s44, 65536
s_mov_b32 s7, 0
Mvaa 180,212,36
Mvaa 212,212,40
Ta 252,23,24576
Ta 254,23,25600
Mvaa 244,212,44
Mvaa 152,216,32
Mvaa 184,216,36
Mvaa 216,216,40
buffer_load_dwordx4 a[124:127], v11, s[20:23], 0 offen offset:3072 sc1
v_add_u32 v10, 4096, v10
v_add_u32 v11, 4096, v11
Mvaa 248,216,44
Mvaa 156,220,32
Mvaa 188,220,36
Mvaa 220,220,40
Mvaa 252,220,44
s_waitcnt vmcnt(21) lgkmcnt(0)
s_barrier
Mvaa 128,224,48
v_accvgpr_write_b32 a32, 0
v_accvgpr_write_b32 a33, 0
Mvaa 160,224,52
Ta 192,16,32768
Ta 194,16,33792
Mvaa 192,224,56
v_accvgpr_write_b32 a34, 0
v_accvgpr_write_b32 a35, 0
Mvaa 224,224,60
v_accvgpr_write_b32 a36, 0
v_accvgpr_write_b32 a37, 0
Mvaa 132,228,48
Ta 196,17,32768
Ta 198,17,33792
Mvaa 164,228,52
v_accvgpr_write_b32 a38, 0
v_accvgpr_write_b32 a39, 0
Mvaa 196,228,56
v_accvgpr_write_b32 a40, 0
v_accvgpr_write_b32 a41, 0
Mvaa 228,228,60
Ta 200,18,32768
Ta 202,18,33792
Mvaa 136,232,48
v_accvgpr_write_b32 a42, 0
v_accvgpr_write_b32 a43, 0
Mvaa 168,232,52
v_accvgpr_write_b32 a44, 0
v_accvgpr_write_b32 a45, 0
Mvaa 200,232,56
Ta 204,19,32768
Ta 206,19,33792
Mvaa 232,232,60
v_accvgpr_write_b32 a46, 0
v_accvgpr_write_b32 a47, 0
Mvaa 140,236,48
Mvaa 172,236,52
Ta 208,20,32768
Ta 210,20,33792
Mvaa 204,236,56
Mvaa 236,236,60
Mvaa 144,240,48
s_waitcnt lgkmcnt(6)
Ta 212,21,32768
Ta 214,21,33792
Mvaa 176,240,52
Mvaa 208,240,56
Mvaa 240,240,60
Ta 216,22,32768
Ta 218,22,33792
Mvaa 148,244,48
Mvaa 180,244,52
Mvaa 212,244,56
Ta 220,23,32768
Ta 222,23,33792
Mvaa 244,244,60
Mvaa 152,248,48
Mvaa 184,248,52
Mvaa 216,248,56
Mvaa 248,248,60
Mvaa 156,252,48
Mvaa 188,252,52
Mvaa 220,252,56
Mvaa 252,252,60
s_waitcnt vmcnt(13) lgkmcnt(0)
Mvaa 128,192,64
v_accvgpr_write_b32 a48, 0
v_accvgpr_write_b32 a49, 0
Mvaa 160,192,68
Ta 224,16,40960
Ta 226,16,41984
Mvaa 192,192,72
v_accvgpr_write_b32 a50, 0
v_accvgpr_write_b32 a51, 0
Mvaa 224,192,76
v_accvgpr_write_b32 a52, 0
v_accvgpr_write_b32 a53, 0
Mvaa 132,196,64
Ta 228,17,40960
Ta 230,17,41984
Mvaa 164,196,68
v_accvgpr_write_b32 a54, 0
v_accvgpr_write_b32 a55, 0
Mvaa 196,196,72
v_accvgpr_write_b32 a56, 0
v_accvgpr_write_b32 a57, 0
Mvaa 228,196,76
Ta 232,18,40960
Ta 234,18,41984
Mvaa 136,200,64
v_accvgpr_write_b32 a58, 0
v_accvgpr_write_b32 a59, 0
Mvaa 168,200,68
v_accvgpr_write_b32 a60, 0
v_accvgpr_write_b32 a61, 0
Mvaa 200,200,72
Ta 236,19,40960
Ta 238,19,41984
Mvaa 232,200,76
v_accvgpr_write_b32 a62, 0
v_accvgpr_write_b32 a63, 0
Mvaa 140,204,64
Mvaa 172,204,68
Ta 240,20,40960
Ta 242,20,41984
Mvaa 204,204,72
Mvaa 236,204,76
Mvaa 144,208,64
s_waitcnt lgkmcnt(6)
Ta 244,21,40960
Ta 246,21,41984
Mvaa 176,208,68
Mvaa 208,208,72
Mvaa 240,208,76
Ta 248,22,40960
Ta 250,22,41984
Mvaa 148,212,64
Mvaa 180,212,68
Mvaa 212,212,72
Ta 252,23,40960
Ta 254,23,41984
Mvaa 244,212,76
Mvaa 152,216,64
Mvaa 184,216,68
Mvaa 216,216,72
Mvaa 248,216,76
Mvaa 156,220,64
Mvaa 188,220,68
Mvaa 220,220,72
Mvaa 252,220,76
s_waitcnt vmcnt(2) lgkmcnt(0)
s_cmp_lg_u32 s32, 0
s_cbranch_scc1 L_spinBr
v_cmp_ne_u32 vcc, 1, v12
s_cbranch_vccnz L_spinB
L_spinBr:
s_barrier
Mvaa 128,224,80
buffer_load_dwordx4 v4, s[12:15], s7 offen offset:0 sc1 lds
Mvaa 160,224,84
Ta 192,16,49152
Ta 194,16,50176
Mvaa 192,224,88
v_accvgpr_write_b32 a64, 0
v_accvgpr_write_b32 a65, 0
Mvaa 224,224,92
buffer_load_dwordx4 v4, s[12:15], s7 offen offset:1024 sc1 lds
Mvaa 132,228,80
Ta 196,17,49152
Ta 198,17,50176
Mvaa 164,228,84
v_accvgpr_write_b32 a66, 0
v_accvgpr_write_b32 a67, 0
Mvaa 196,228,88
buffer_load_dwordx4 v4, s[12:15], s7 offen offset:2048 sc1 lds
Mvaa 228,228,92
Ta 200,18,49152
Ta 202,18,50176
Mvaa 136,232,80
v_accvgpr_write_b32 a68, 0
v_accvgpr_write_b32 a69, 0
Mvaa 168,232,84
buffer_load_dwordx4 v4, s[12:15], s7 offen offset:3072 sc1 lds
Mvaa 200,232,88
Ta 204,19,49152
Ta 206,19,50176
Mvaa 232,232,92
s_add_u32 m0, s44, 98304
s_mov_b32 s7, 34816
Mvaa 140,236,80
buffer_load_dwordx4 v4, s[12:15], s7 offen offset:0 sc1 lds
Mvaa 172,236,84
Ta 208,20,49152
Ta 210,20,50176
Mvaa 204,236,88
v_accvgpr_write_b32 a70, 0
v_accvgpr_write_b32 a71, 0
Mvaa 236,236,92
buffer_load_dwordx4 v4, s[12:15], s7 offen offset:1024 sc1 lds
Mvaa 144,240,80
s_waitcnt lgkmcnt(6)
Ta 212,21,49152
Ta 214,21,50176
Mvaa 176,240,84
v_accvgpr_write_b32 a72, 0
v_accvgpr_write_b32 a73, 0
Mvaa 208,240,88
buffer_load_dwordx4 v4, s[12:15], s7 offen offset:2048 sc1 lds
Mvaa 240,240,92
Ta 216,22,49152
Ta 218,22,50176
Mvaa 148,244,80
v_accvgpr_write_b32 a74, 0
v_accvgpr_write_b32 a75, 0
Mvaa 180,244,84
buffer_load_dwordx4 v4, s[12:15], s7 offen offset:3072 sc1 lds
Mvaa 212,244,88
Ta 220,23,49152
Ta 222,23,50176
Mvaa 244,244,92
s_add_u32 m0, s44, 81920
s_mov_b32 s7, 17408
Mvaa 152,248,80
buffer_load_dwordx4 v4, s[12:15], s7 offen offset:0 sc1 lds
Mvaa 184,248,84
v_accvgpr_write_b32 a76, 0
v_accvgpr_write_b32 a77, 0
Mvaa 216,248,88
buffer_load_dwordx4 v4, s[12:15], s7 offen offset:1024 sc1 lds
Mvaa 248,248,92
v_accvgpr_write_b32 a78, 0
v_accvgpr_write_b32 a79, 0
Mvaa 156,252,80
Mvaa 188,252,84
buffer_load_dwordx4 v4, s[12:15], s7 offen offset:2048 sc1 lds
Mvaa 220,252,88
Mvaa 252,252,92
s_waitcnt lgkmcnt(0)
Mvaa 128,192,96
buffer_load_dwordx4 v4, s[12:15], s7 offen offset:3072 sc1 lds
Mvaa 160,192,100
Ta 224,16,57344
Ta 226,16,58368
Mvaa 192,192,104
s_add_u32 m0, s44, 114688
s_mov_b32 s7, 52224
Mvaa 224,192,108
buffer_load_dwordx4 v4, s[12:15], s7 offen offset:0 sc1 lds
Mvaa 132,196,96
Ta 228,17,57344
Ta 230,17,58368
Mvaa 164,196,100
v_accvgpr_write_b32 a80, 0
v_accvgpr_write_b32 a81, 0
Mvaa 196,196,104
buffer_load_dwordx4 v4, s[12:15], s7 offen offset:1024 sc1 lds
Mvaa 228,196,108
Ta 232,18,57344
Ta 234,18,58368
Mvaa 136,200,96
v_accvgpr_write_b32 a82, 0
v_accvgpr_write_b32 a83, 0
Mvaa 168,200,100
buffer_load_dwordx4 v4, s[12:15], s7 offen offset:2048 sc1 lds
Mvaa 200,200,104
Ta 236,19,57344
Ta 238,19,58368
Mvaa 232,200,108
v_accvgpr_write_b32 a84, 0
v_accvgpr_write_b32 a85, 0
Mvaa 140,204,96
buffer_load_dwordx4 v4, s[12:15], s7 offen offset:3072 sc1 lds
Mvaa 172,204,100
Ta 240,20,57344
Ta 242,20,58368
Mvaa 204,204,104
s_add_u32 m0, s44, 0
s_mov_b32 s7, 69632
Mvaa 236,204,108
buffer_load_dwordx4 v4, s[12:15], s7 offen offset:0 sc1 lds
Mvaa 144,208,96
s_waitcnt lgkmcnt(6)
Ta 244,21,57344
Ta 246,21,58368
Mvaa 176,208,100
buffer_load_dwordx4 v4, s[12:15], s7 offen offset:1024 sc1 lds
Mvaa 208,208,104
v_accvgpr_write_b32 a86, 0
v_accvgpr_write_b32 a87, 0
Mvaa 240,208,108
Ta 248,22,57344
Ta 250,22,58368
Mvaa 148,212,96
buffer_load_dwordx4 v4, s[12:15], s7 offen offset:2048 sc1 lds
Mvaa 180,212,100
v_accvgpr_write_b32 a88, 0
v_accvgpr_write_b32 a89, 0
Mvaa 212,212,104
Ta 252,23,57344
Ta 254,23,58368
Mvaa 244,212,108
buffer_load_dwordx4 v4, s[12:15], s7 offen offset:3072 sc1 lds
Mvaa 152,216,96
s_add_u32 m0, s44, 16384
s_mov_b32 s7, 87040
Mvaa 184,216,100
v_accvgpr_write_b32 a90, 0
v_accvgpr_write_b32 a91, 0
Mvaa 216,216,104
buffer_load_dwordx4 v4, s[12:15], s7 offen offset:0 sc1 lds
Mvaa 248,216,108
v_accvgpr_write_b32 a92, 0
v_accvgpr_write_b32 a93, 0
Mvaa 156,220,96
v_accvgpr_write_b32 a94, 0
v_accvgpr_write_b32 a95, 0
Mvaa 188,220,100
buffer_load_dwordx4 v4, s[12:15], s7 offen offset:1024 sc1 lds
Mvaa 220,220,104
Mvaa 252,220,108
s_waitcnt vmcnt(18) lgkmcnt(0)
s_barrier
Mvaa 128,224,112
buffer_load_dwordx4 v4, s[12:15], s7 offen offset:2048 sc1 lds
Mvaa 132,228,112
Ra 192,3,0
Ra 196,3,1024
Mvaa 136,232,112
Ra 200,3,2048
Ra 204,3,3072
Mvaa 140,236,112
buffer_load_dwordx4 v4, s[12:15], s7 offen offset:3072 sc1 lds
Mvaa 144,240,112
s_add_u32 m0, s44, 32768
s_mov_b32 s7, 104448
Mvaa 148,244,112
Ra 208,3,4096
Ra 212,3,5120
Mvaa 152,248,112
buffer_load_dwordx4 v4, s[12:15], s7 offen offset:0 sc1 lds
Mvaa 156,252,112
Ra 216,3,6144
Ra 220,3,7168
Mvaa 160,224,116
buffer_load_dwordx4 v4, s[12:15], s7 offen offset:1024 sc1 lds
Mvaa 164,228,116
Mvaa 168,232,116
Mvaa 172,236,116
buffer_load_dwordx4 v4, s[12:15], s7 offen offset:2048 sc1 lds
Mvaa 176,240,116
v_mul_f32 v128, s94, v128
v_mul_f32_e64 v129, s94, v129
Mvaa 180,244,116
v_mul_f32 v130, s94, v130
v_mul_f32 v131, s94, v131
Mvaa 184,248,116
buffer_load_dwordx4 v4, s[12:15], s7 offen offset:3072 sc1 lds
Mvaa 188,252,116
v_mul_f32 v132, s94, v132
v_mul_f32 v133, s94, v133
Mvaa 192,224,120
v_mul_f32 v134, s94, v134
v_mul_f32 v135, s94, v135
Mvaa 196,228,120
Vc 128,128,129
Vc 129,130,131
Mvaa 200,232,120
Vc 130,132,133
Vc 131,134,135
Mvaa 204,236,120
Aw 128,128
Aw 129,129
Mvaa 208,240,120
Aw 130,130
Aw 131,131
Mvaa 212,244,120
v_mul_f32 v136, s94, v136
v_mul_f32 v137, s94, v137
Mvaa 216,248,120
v_mul_f32 v138, s94, v138
v_mul_f32 v139, s94, v139
Mvaa 220,252,120
v_mul_f32 v140, s94, v140
v_mul_f32 v141, s94, v141
Mvaa 224,224,124
v_mul_f32 v142, s94, v142
v_mul_f32 v143, s94, v143
Mvaa 228,228,124
Vc 136,136,137
Vc 137,138,139
Mvaa 232,232,124
Vc 138,140,141
Vc 139,142,143
Mvaa 236,236,124
Aw 132,136
Aw 133,137
Mvaa 240,240,124
Aw 134,138
Aw 135,139
Mvaa 244,244,124
v_mul_f32 v144, s94, v144
v_mul_f32 v145, s94, v145
Mvaa 248,248,124
v_mul_f32 v146, s94, v146
v_mul_f32 v147, s94, v147
Mvaa 252,252,124
v_mul_f32 v148, s94, v148
v_mul_f32 v149, s94, v149
Ra 224,3,8192
Ra 228,3,9216
Ra 232,3,10240
Ra 236,3,11264
Ra 240,3,12288
Ra 244,3,13312
Ra 248,3,14336
s_waitcnt lgkmcnt(9)
Ra 252,3,15360
v_mul_f32 v150, s94, v150
v_mul_f32_e64 v151, s94, v151
Vc 144,144,145
Vc 145,146,147
Vc 146,148,149
Vc 147,150,151
Aw 136,144
Aw 137,145
Aw 138,146
Aw 139,147
v_mul_f32 v152, s94, v152
v_mul_f32 v153, s94, v153
v_mul_f32 v154, s94, v154
v_mul_f32 v155, s94, v155
v_mul_f32 v156, s94, v156
v_mul_f32 v157, s94, v157
v_mul_f32 v158, s94, v158
v_mul_f32 v159, s94, v159
Vc 152,152,153
Vc 153,154,155
Vc 154,156,157
Vc 155,158,159
Aw 140,152
Aw 141,153
Aw 142,154
Aw 143,155
Zvaa 128,192,128
v_mul_f32 v160, s94, v160
v_mul_f32 v161, s94, v161
v_mul_f32 v162, s94, v162
v_mul_f32 v163, s94, v163
Mvaa 128,196,132
v_mul_f32 v164, s94, v164
v_mul_f32 v165, s94, v165
v_mul_f32 v166, s94, v166
v_mul_f32 v167, s94, v167
Mvaa 128,200,136
Vc 160,160,161
Vc 161,162,163
Vc 162,164,165
Vc 163,166,167
Mvaa 128,204,140
Aw 144,160
Aw 145,161
Aw 146,162
Aw 147,163
s_waitcnt lgkmcnt(8)
Zvaa 132,208,128
v_mul_f32 v168, s94, v168
v_mul_f32 v169, s94, v169
v_mul_f32 v170, s94, v170
v_mul_f32_e64 v171, s94, v171
Mvaa 132,212,132
v_mul_f32 v172, s94, v172
v_mul_f32 v173, s94, v173
v_mul_f32 v174, s94, v174
v_mul_f32 v175, s94, v175
Mvaa 132,216,136
Vc 168,168,169
Vc 169,170,171
Vc 170,172,173
Vc 171,174,175
Mvaa 132,220,140
Aw 148,168
Aw 149,169
Aw 150,170
Aw 151,171
s_waitcnt lgkmcnt(4)
Zvaa 136,224,128
v_mul_f32 v176, s94, v176
v_mul_f32 v177, s94, v177
v_mul_f32 v178, s94, v178
v_mul_f32_e64 v179, s94, v179
Mvaa 136,228,132
v_mul_f32 v180, s94, v180
v_mul_f32 v181, s94, v181
v_mul_f32 v182, s94, v182
v_mul_f32 v183, s94, v183
Mvaa 136,232,136
Vc 176,176,177
Vc 177,178,179
Vc 178,180,181
Vc 179,182,183
Mvaa 136,236,140
Aw 152,176
Aw 153,177
Aw 154,178
Aw 155,179
s_waitcnt lgkmcnt(0)
Zvaa 140,240,128
v_mul_f32 v184, s94, v184
v_mul_f32 v185, s94, v185
v_mul_f32 v186, s94, v186
v_mul_f32_e64 v187, s94, v187
Mvaa 140,244,132
v_mul_f32 v188, s94, v188
v_mul_f32 v189, s94, v189
v_mul_f32 v190, s94, v190
v_mul_f32 v191, s94, v191
Mvaa 140,248,136
Vc 184,184,185
Vc 185,186,187
Vc 186,188,189
Vc 187,190,191
Mvaa 140,252,140
Aw 156,184
Aw 157,185
Aw 158,186
Aw 159,187
Zvaa 144,192,144
v_mul_f32 v192, s94, v192
v_mul_f32 v193, s94, v193
v_mul_f32 v194, s94, v194
v_mul_f32 v195, s94, v195
Mvaa 144,196,148
v_mul_f32 v196, s94, v196
v_mul_f32 v197, s94, v197
v_mul_f32 v198, s94, v198
v_mul_f32 v199, s94, v199
Mvaa 144,200,152
Vc 192,192,193
Vc 193,194,195
Vc 194,196,197
Vc 195,198,199
Mvaa 144,204,156
Aw 160,192
Aw 161,193
Aw 162,194
Aw 163,195
Zvaa 148,208,144
v_mul_f32 v200, s94, v200
v_mul_f32 v201, s94, v201
v_mul_f32 v202, s94, v202
v_mul_f32 v203, s94, v203
Mvaa 148,212,148
v_mul_f32 v204, s94, v204
v_mul_f32 v205, s94, v205
v_mul_f32 v206, s94, v206
v_mul_f32 v207, s94, v207
Mvaa 148,216,152
Vc 200,200,201
Vc 201,202,203
Vc 202,204,205
Vc 203,206,207
Mvaa 148,220,156
Aw 164,200
Aw 165,201
Aw 166,202
Aw 167,203
Zvaa 152,224,144
v_mul_f32 v208, s94, v208
v_mul_f32 v209, s94, v209
v_mul_f32 v210, s94, v210
v_mul_f32 v211, s94, v211
Mvaa 152,228,148
v_mul_f32 v212, s94, v212
v_mul_f32 v213, s94, v213
v_mul_f32 v214, s94, v214
v_mul_f32 v215, s94, v215
Mvaa 152,232,152
Vc 208,208,209
Vc 209,210,211
Vc 210,212,213
Vc 211,214,215
Mvaa 152,236,156
Aw 168,208
Aw 169,209
Aw 170,210
Aw 171,211
Zvaa 156,240,144
v_mul_f32 v216, s94, v216
v_mul_f32 v217, s94, v217
v_mul_f32 v218, s94, v218
v_mul_f32 v219, s94, v219
Mvaa 156,244,148
v_mul_f32 v220, s94, v220
v_mul_f32 v221, s94, v221
v_mul_f32 v222, s94, v222
v_mul_f32 v223, s94, v223
Mvaa 156,248,152
Vc 216,216,217
Vc 217,218,219
Vc 218,220,221
Vc 219,222,223
Mvaa 156,252,156
Aw 172,216
Aw 173,217
Aw 174,218
Aw 175,219
Zvaa 160,192,160
v_mul_f32 v224, s94, v224
v_mul_f32 v225, s94, v225
v_mul_f32 v226, s94, v226
v_mul_f32 v227, s94, v227
Mvaa 160,196,164
v_mul_f32 v228, s94, v228
v_mul_f32 v229, s94, v229
v_mul_f32 v230, s94, v230
v_mul_f32 v231, s94, v231
Mvaa 160,200,168
Vc 224,224,225
Vc 225,226,227
Vc 226,228,229
Vc 227,230,231
Mvaa 160,204,172
Aw 176,224
Aw 177,225
Aw 178,226
Aw 179,227
Zvaa 164,208,160
v_mul_f32 v232, s94, v232
v_mul_f32 v233, s94, v233
v_mul_f32 v234, s94, v234
v_mul_f32 v235, s94, v235
Mvaa 164,212,164
v_mul_f32 v236, s94, v236
v_mul_f32 v237, s94, v237
v_mul_f32 v238, s94, v238
v_mul_f32 v239, s94, v239
Mvaa 164,216,168
Vc 232,232,233
Vc 233,234,235
Vc 234,236,237
Vc 235,238,239
Mvaa 164,220,172
Aw 180,232
Aw 181,233
Aw 182,234
Aw 183,235
Zvaa 168,224,160
v_mul_f32 v240, s94, v240
v_mul_f32 v241, s94, v241
v_mul_f32 v242, s94, v242
v_mul_f32 v243, s94, v243
Mvaa 168,228,164
v_mul_f32 v244, s94, v244
v_mul_f32 v245, s94, v245
v_mul_f32 v246, s94, v246
v_mul_f32 v247, s94, v247
Mvaa 168,232,168
Vc 240,240,241
Vc 241,242,243
Vc 242,244,245
Vc 243,246,247
Mvaa 168,236,172
Aw 184,240
Aw 185,241
Aw 186,242
Aw 187,243
Zvaa 172,240,160
v_mul_f32 v248, s94, v248
v_mul_f32 v249, s94, v249
v_mul_f32 v250, s94, v250
v_mul_f32 v251, s94, v251
Mvaa 172,244,164
v_mul_f32 v252, s94, v252
v_mul_f32 v253, s94, v253
v_mul_f32 v254, s94, v254
v_mul_f32 v255, s94, v255
Mvaa 172,248,168
Vc 248,248,249
Vc 249,250,251
Vc 250,252,253
Vc 251,254,255
Mvaa 172,252,172
Aw 188,248
Aw 189,249
Aw 190,250
Aw 191,251
Zvaa 176,192,176
v_accvgpr_write_b32 a96, 0
v_accvgpr_write_b32 a97, 0
v_accvgpr_write_b32 a98, 0
v_accvgpr_write_b32 a99, 0
Mvaa 176,196,180
v_accvgpr_write_b32 a100, 0
v_accvgpr_write_b32 a101, 0
v_accvgpr_write_b32 a102, 0
v_accvgpr_write_b32 a103, 0
Mvaa 176,200,184
v_accvgpr_write_b32 a104, 0
v_accvgpr_write_b32 a105, 0
v_accvgpr_write_b32 a106, 0
v_accvgpr_write_b32 a107, 0
Mvaa 176,204,188
v_accvgpr_write_b32 a108, 0
v_accvgpr_write_b32 a109, 0
v_accvgpr_write_b32 a110, 0
v_accvgpr_write_b32 a111, 0
Zvaa 180,208,176
v_accvgpr_write_b32 a112, 0
v_accvgpr_write_b32 a113, 0
v_accvgpr_write_b32 a114, 0
v_accvgpr_write_b32 a115, 0
Mvaa 180,212,180
v_accvgpr_write_b32 a116, 0
v_accvgpr_write_b32 a117, 0
v_accvgpr_write_b32 a118, 0
v_accvgpr_write_b32 a119, 0
Mvaa 180,216,184
v_accvgpr_write_b32 a120, 0
v_accvgpr_write_b32 a121, 0
v_accvgpr_write_b32 a122, 0
v_accvgpr_write_b32 a123, 0
Mvaa 180,220,188
v_accvgpr_write_b32 a124, 0
v_accvgpr_write_b32 a125, 0
v_accvgpr_write_b32 a126, 0
v_accvgpr_write_b32 a127, 0
s_waitcnt vmcnt(16)
s_barrier
s_add_u32 s53, s44, 65536
Zvaa 184,224,176
Ra 192,3,32768
v_mov_b32 v16, 0x3f803f80
v_mov_b32 v17, 0x3f803f80
v_mov_b32 v18, 0x3f803f80
v_mov_b32 v19, 0x3f803f80
Mvaa 184,228,180
Ra 196,3,33792
v_mov_b32 v20, 0xff800000
v_max3_f32 v22, v128, v129, v130
v_max3_f32 v22, v22, v131, v132
v_max3_f32 v22, v22, v133, v134
Mvaa 184,232,184
Ra 200,3,34816
v_max3_f32 v22, v22, v135, v136
v_max3_f32 v22, v22, v137, v138
v_max3_f32 v22, v22, v139, v140
v_max3_f32 v22, v22, v141, v142
Mvaa 184,236,188
Ra 204,3,35840
v_max_f32 v22, v22, v143
v_mov_b32 v1, v22
s_nop 1
v_permlane16_swap_b32 v1, v22
v_max_f32_e64 v22, v22, v1
Zvaa 188,240,176
Ra 208,3,36864
v_mov_b32 v1, v22
s_nop 1
v_permlane32_swap_b32 v1, v22
v_max_f32 v22, v22, v1
v_add_f32 v22, 0x41f80000, v22
Mvaa 188,244,180
Ra 212,3,37888
Vs 128,128,22
Vs 129,129,22
Vs 130,130,22
Vs 131,131,22
Mvaa 188,248,184
Ra 216,3,38912
Vs 132,132,22
Vs 133,133,22
Vs 134,134,22
Vs 135,135,22
Mvaa 188,252,188
Ra 220,3,39936
Vs 136,136,22
Vs 137,137,22
Vs 138,138,22
Vs 139,139,22
Vs 140,140,22
Vs 141,141,22
Vs 142,142,22
Vs 143,143,22
v_sub_f32 v32, 0, v22
v_sub_f32 v33, 0, v22
v_sub_f32 v34, 0, v22
v_sub_f32 v35, 0, v22
v_max3_f32 v22, v144, v145, v146
v_max3_f32 v22, v22, v147, v148
v_max3_f32 v22, v22, v149, v150
v_max3_f32 v22, v22, v151, v152
v_max3_f32 v22, v22, v153, v154
v_max3_f32 v22, v22, v155, v156
v_max3_f32 v22, v22, v157, v158
v_max_f32 v22, v22, v159
v_mov_b32 v1, v22
s_nop 1
v_permlane16_swap_b32 v1, v22
v_max_f32 v22, v22, v1
v_mov_b32 v1, v22
s_nop 1
v_permlane32_swap_b32 v1, v22
v_max_f32_e64 v22, v22, v1
v_add_f32 v22, 0x41f80000, v22
Vs 144,144,22
Vs 145,145,22
Vs 146,146,22
Vs 147,147,22
Vs 148,148,22
Vs 149,149,22
Vs 150,150,22
Vs 151,151,22
Vs 152,152,22
Vs 153,153,22
Vs 154,154,22
Vs 155,155,22
Vs 156,156,22
Vs 157,157,22
Vs 158,158,22
Vs 159,159,22
v_sub_f32 v36, 0, v22
v_sub_f32 v37, 0, v22
v_sub_f32 v38, 0, v22
v_sub_f32 v39, 0, v22
s_mov_b32 s38, 139264
s_mov_b32 s39, 121856
s_cmp_lg_u32 s34, 0
s_cbranch_scc1 L_k2_nomask0
v_cmp_gt_i32 s[56:57], 0, v5
v_cmp_gt_i32 s[58:59], 1, v5
v_cmp_gt_i32 s[60:61], 2, v5
v_cmp_gt_i32 s[62:63], 3, v5
s_nop 3
s_nop 0
v_cndmask_b32 v176, v176, v20, s[56:57]
v_cndmask_b32 v177, v177, v20, s[58:59]
v_cndmask_b32 v178, v178, v20, s[60:61]
v_cndmask_b32 v179, v179, v20, s[62:63]
v_cmp_gt_i32 s[56:57], 16, v5
v_cmp_gt_i32 s[58:59], 17, v5
v_cmp_gt_i32 s[60:61], 18, v5
v_cmp_gt_i32 s[62:63], 19, v5
v_cndmask_b32 v180, v180, v20, s[56:57]
v_cndmask_b32 v181, v181, v20, s[58:59]
v_cndmask_b32 v182, v182, v20, s[60:61]
v_cndmask_b32 v183, v183, v20, s[62:63]
v_cmp_gt_i32 s[56:57], 32, v5
v_cmp_gt_i32 s[58:59], 33, v5
v_cmp_gt_i32 s[60:61], 34, v5
v_cmp_gt_i32 s[62:63], 35, v5
v_cndmask_b32 v184, v184, v20, s[56:57]
v_cndmask_b32 v185, v185, v20, s[58:59]
v_cndmask_b32 v186, v186, v20, s[60:61]
v_cndmask_b32 v187, v187, v20, s[62:63]
v_cmp_gt_i32 s[56:57], 48, v5
v_cmp_gt_i32 s[58:59], 49, v5
v_cmp_gt_i32 s[60:61], 50, v5
v_cmp_gt_i32 s[62:63], 51, v5
v_cndmask_b32 v188, v188, v20, s[56:57]
v_cndmask_b32 v189, v189, v20, s[58:59]
v_cndmask_b32 v190, v190, v20, s[60:61]
v_cndmask_b32 v191, v191, v20, s[62:63]
L_k2_nomask0:
s_mov_b32 s37, 0
s_nop 0
v_max3_f32 v22, v160, v161, v162
v_max3_f32 v22, v22, v163, v164
v_max3_f32 v22, v22, v165, v166
v_max3_f32 v22, v22, v167, v168
v_max3_f32 v22, v22, v169, v170
v_max3_f32 v22, v22, v171, v172
v_max3_f32 v22, v22, v173, v174
v_max_f32 v22, v22, v175
v_mov_b32 v1, v22
s_nop 1
v_permlane16_swap_b32 v1, v22
v_max_f32 v22, v22, v1
v_mov_b32 v1, v22
s_nop 1
v_permlane32_swap_b32 v1, v22
v_max_f32_e64 v22, v22, v1
v_add_f32 v22, 0x41f80000, v22
Vs 160,160,22
Vs 161,161,22
Vs 162,162,22
Vs 163,163,22
Vs 164,164,22
Vs 165,165,22
Vs 166,166,22
Vs 167,167,22
Vs 168,168,22
Vs 169,169,22
Vs 170,170,22
Vs 171,171,22
Vs 172,172,22
Vs 173,173,22
Vs 174,174,22
Vs 175,175,22
v_sub_f32 v40, 0, v22
v_sub_f32 v41, 0, v22
v_sub_f32 v42, 0, v22
v_sub_f32 v43, 0, v22
v_max3_f32 v22, v176, v177, v178
v_max3_f32 v22, v22, v179, v180
v_max3_f32 v22, v22, v181, v182
v_max3_f32 v22, v22, v183, v184
v_max3_f32 v22, v22, v185, v186
v_max3_f32 v22, v22, v187, v188
v_max3_f32 v22, v22, v189, v190
v_max_f32 v22, v22, v191
v_mov_b32 v1, v22
s_nop 1
v_permlane16_swap_b32 v1, v22
v_max_f32 v22, v22, v1
v_mov_b32 v1, v22
s_nop 1
v_permlane32_swap_b32 v1, v22
v_max_f32_e64 v22, v22, v1
v_add_f32 v22, 0x41f80000, v22
Vs 176,176,22
Vs 177,177,22
Vs 178,178,22
Vs 179,179,22
Vs 180,180,22
Vs 181,181,22
Vs 182,182,22
Vs 183,183,22
Vs 184,184,22
Vs 185,185,22
Vs 186,186,22
Vs 187,187,22
Vs 188,188,22
Vs 189,189,22
Vs 190,190,22
Vs 191,191,22
v_sub_f32 v44, 0, v22
v_sub_f32 v45, 0, v22
v_sub_f32 v46, 0, v22
v_sub_f32 v47, 0, v22
Ve 8,128
Ve 9,129
Ve 10,130
Ve 11,131
Vc 64,8,9
Ve 12,144
Ve 13,145
Vc 65,10,11
Ve 14,146
Ve 15,147
Vc 72,12,13
Ve 8,160
Ve 9,161
Vc 73,14,15
Ve 10,162
Ve 11,163
Vc 80,8,9
Ve 12,176
Ve 13,177
Vc 81,10,11
Ve 14,178
Ve 15,179
Vc 88,12,13
Ve 8,132
Ve 9,133
Vc 89,14,15
Ve 10,134
Ve 11,135
Vc 66,8,9
Ve 12,148
Ve 13,149
Vc 67,10,11
Ve 14,150
Ve 15,151
Vc 74,12,13
Ve 8,164
Ve 9,165
Vc 75,14,15
Ve 10,166
Ve 11,167
Vc 82,8,9
Ve 12,180
Ve 13,181
Vc 83,10,11
Ve 14,182
Ve 15,183
Vc 90,12,13
Vc 91,14,15
v_or_b32_e64 v7, v64, v65
v_or3_b32 v7, v7, v72, v73
v_or3_b32 v7, v7, v80, v81
v_or3_b32 v7, v7, v88, v89
v_or3_b32 v7, v7, v66, v67
v_or3_b32 v7, v7, v74, v75
v_or3_b32 v7, v7, v82, v83
v_or3_b32 v7, v7, v90, v91
s_waitcnt lgkmcnt(4)
s_cmp_eq_u32 s34, 0
s_cbranch_scc1 L_k2_wlast
L_k2_wloop:
v_xor_b32 v2, 65536, v2
v_xor_b32 v3, 65536, v3
Cvaa 192,192,128,32
s_mov_b32 m0, s53
Ra 224,2,40960
v_lshl_add_u64 v[28:29], s[40:41], 0, v[28:29]
Mvaa 192,196,132
buffer_load_dwordx4 v4, s[12:15], s38 offen offset:0 sc1 lds
Mvaa 192,200,136
VE 8,136
Mvaa 192,204,140
VE 9,137
Cvaa 208,192,144,36
Ra 228,2,41984
Vc 68,8,9
Mvaa 208,196,148
VE 10,138
Mvaa 208,200,152
VE 11,139
Mvaa 208,204,156
Ra 232,2,43008
Vc 69,10,11
Cvaa 224,192,160,40
Ra 236,2,44032
v_or3_b32 v7, v7, v68, v69
Mvaa 224,196,164
VE 12,152
Mvaa 224,200,168
VE 13,153
Mvaa 224,204,172
Ra 240,2,45056
Vc 76,12,13
Cvaa 240,192,176,44
VE 14,154
Mvaa 240,196,180
VE 15,155
Mvaa 240,200,184
Ra 244,2,46080
Vc 77,14,15
Mvaa 240,204,188
s_waitcnt lgkmcnt(6)
Ra 248,2,47104
v_or3_b32 v7, v7, v76, v77
Cvaa 196,208,128,32
buffer_load_dwordx4 v4, s[12:15], s38 offen offset:1024 sc1 lds
Mvaa 196,212,132
Ve 8,168
Mvaa 196,216,136
VE 9,169
Mvaa 196,220,140
Ra 252,2,48128
Vc 84,8,9
Cvaa 212,208,144,36
VE 10,170
Mvaa 212,212,148
VE 11,171
Mvaa 212,216,152
Ra 192,2,16384
Vc 85,10,11
Mvaa 212,220,156
Ra 196,2,17408
v_or3_b32 v7, v7, v84, v85
Cvaa 228,208,160,40
VE 12,184
Mvaa 228,212,164
VE 13,185
Mvaa 228,216,168
Ra 200,2,18432
Vc 92,12,13
Mvaa 228,220,172
VE 14,186
Cvaa 244,208,176,44
VE 15,187
Mvaa 244,212,180
buffer_load_dwordx4 v4, s[12:15], s38 offen offset:2048 sc1 lds
Mvaa 244,216,184
Ra 204,2,19456
Vc 93,14,15
Mvaa 244,220,188
s_waitcnt lgkmcnt(8)
Ve 8,140
Cvaa 200,224,128,32
Ra 208,2,20480
v_or3_b32 v7, v7, v92, v93
Mvaa 200,228,132
VE 9,141
Mvaa 200,232,136
Ra 212,2,21504
Vc 70,8,9
Mvaa 200,236,140
VE 10,142
Cvaa 216,224,144,36
VE 11,143
Mvaa 216,228,148
Ra 216,2,22528
Vc 71,10,11
Mvaa 216,232,152
Ra 220,2,23552
v_or3_b32 v7, v7, v70, v71
Mvaa 216,236,156
VE 12,156
Cvaa 232,224,160,40
VE 13,157
Mvaa 232,228,164
VE 14,158
Mvaa 232,232,168
VE 15,159
Mvaa 232,236,172
buffer_load_dwordx4 v4, s[12:15], s38 offen offset:3072 sc1 lds
Cvaa 248,224,176,44
VE 8,172
Mvaa 248,228,180
VE 9,173
Mvaa 248,232,184
Vc 78,12,13
Vc 79,14,15
Mvaa 248,236,188
s_waitcnt lgkmcnt(8)
Ve 10,174
Cvaa 204,240,128,32
VE 11,175
Mvaa 204,244,132
Vc 86,8,9
Vc 87,10,11
Mvaa 204,248,136
VE 12,188
Mvaa 204,252,140
VE 13,189
Cvaa 220,240,144,36
Vc 94,12,13
v_or3_b32 v7, v7, v78, v79
Mvaa 220,244,148
VE 14,190
Mvaa 220,248,152
VE 15,191
Mvaa 220,252,156
Vc 95,14,15
v_or3_b32 v7, v7, v86, v87
Cvaa 236,240,160,40
v_or3_b32 v7, v7, v94, v95
v_and_b32 v1, 0x40004000, v7
Mvaa 236,244,164
v_cmp_ne_u32 vcc, 0, v1
Mvaa 236,248,168
Mvaa 236,252,172
s_waitcnt vmcnt(12)
Cvaa 252,240,176,44
Mvaa 252,244,180
s_barrier
Mvaa 252,248,184
s_waitcnt lgkmcnt(4)
Mvaa 252,252,188
s_cbranch_vccnz L_k2_fb_we
L_k2_fbr_we:
Maav 0,192,64
Ve 8,192
Maav 0,196,68
s_add_u32 m0, s54, 49152
VE 9,193
Maav 32,192,72
buffer_load_dwordx4 v4, s[12:15], s39 offen offset:0 sc1 lds
Maav 32,196,76
s_add_u32 s37, s37, 1
Ra 224,2,24576
Vc 96,8,9
Maav 64,192,80
s_add_u32 s38, s38, 34816
Ve 10,194
Maav 64,196,84
VE 11,195
Maav 96,192,88
Ra 228,2,25600
Vc 97,10,11
Maav 96,196,92
Ra 232,2,26624
v_or_b32_e64 v7, v96, v97
Maav 4,200,64
VE 12,208
Maav 4,204,68
VE 13,209
Maav 36,200,72
Ra 236,2,27648
Vc 104,12,13
Maav 36,204,76
VE 14,210
Maav 68,200,80
VE 15,211
Maav 68,204,84
Ra 240,2,28672
Vc 105,14,15
Maav 100,200,88
Ra 244,2,29696
v_or3_b32 v7, v7, v104, v105
Maav 100,204,92
buffer_load_dwordx4 v4, s[12:15], s39 offen offset:1024 sc1 lds
Mvvv 48,16,64
VE 8,224
Mvvv 48,16,68
s_waitcnt lgkmcnt(6)
Ve 9,225
Maav 8,208,64
Ra 248,2,30720
Vc 112,8,9
Maav 8,212,68
VE 10,226
Maav 40,208,72
VE 11,227
Maav 40,212,76
Ra 252,2,31744
Vc 113,10,11
Maav 72,208,80
Ra 192,3,0
v_or3_b32 v7, v7, v112, v113
Maav 72,212,84
VE 12,240
Maav 104,208,88
VE 13,241
Maav 104,212,92
Ra 196,3,1024
Vc 120,12,13
Maav 12,216,64
VE 14,242
Maav 12,220,68
VE 15,243
Maav 44,216,72
Ra 200,3,2048
Vc 121,14,15
Maav 44,220,76
buffer_load_dwordx4 v4, s[12:15], s39 offen offset:2048 sc1 lds
Maav 76,216,80
Ra 204,3,3072
v_or3_b32 v7, v7, v120, v121
Maav 76,220,84
VE 8,196
Maav 108,216,88
VE 9,197
Maav 108,220,92
VE 10,198
Mvvv 52,16,72
VE 11,199
Mvvv 52,16,76
s_waitcnt lgkmcnt(8)
Ve 12,212
Maav 16,224,64
Ra 208,3,4096
Vc 98,8,9
Maav 16,228,68
Ra 212,3,5120
Vc 99,10,11
Maav 48,224,72
Ra 216,3,6144
v_or3_b32 v7, v7, v98, v99
Maav 48,228,76
VE 13,213
Maav 80,224,80
Ra 220,3,7168
Vc 106,12,13
Maav 80,228,84
VE 14,214
Maav 112,224,88
buffer_load_dwordx4 v4, s[12:15], s39 offen offset:3072 sc1 lds
Maav 112,228,92
s_add_u32 s39, s39, 34816
VE 15,215
Maav 20,232,64
VE 8,228
Maav 20,236,68
VE 9,229
Maav 52,232,72
VE 10,230
Maav 52,236,76
VE 11,231
Maav 84,232,80
Vc 107,14,15
Vc 114,8,9
Maav 84,236,84
VE 12,244
Maav 116,232,88
VE 13,245
Maav 116,236,92
Vc 115,10,11
Vc 122,12,13
Mvvv 56,16,80
VE 14,246
Mvvv 56,16,84
s_waitcnt lgkmcnt(8)
Ve 15,247
Maav 24,240,64
Vc 123,14,15
v_or3_b32 v7, v7, v106, v107
Maav 24,244,68
v_or3_b32 v7, v7, v114, v115
v_or3_b32 v7, v7, v122, v123
Maav 56,240,72
global_load_dword v30, v[28:29], off
Maav 56,244,76
Maav 88,240,80
Maav 88,244,84
Maav 120,240,88
Maav 120,244,92
Maav 28,248,64
Maav 28,252,68
Maav 60,248,72
Maav 60,252,76
Maav 92,248,80
Maav 92,252,84
Maav 124,248,88
Maav 124,252,92
Mvvv 60,16,88
s_waitcnt lgkmcnt(4)
Mvvv 60,16,92
Ve 8,200
Cvaa 128,192,128,32
s_add_u32 m0, s53, 32768
Ra 224,3,8192
v_lshl_add_u64 v[28:29], s[40:41], 0, v[28:29]
Mvaa 128,196,132
buffer_load_dwordx4 v4, s[12:15], s38 offen offset:0 sc1 lds
Mvaa 128,200,136
VE 9,201
Mvaa 128,204,140
Ra 228,3,9216
Vc 100,8,9
Cvaa 144,192,144,36
VE 10,202
Mvaa 144,196,148
VE 11,203
Mvaa 144,200,152
Ra 232,3,10240
Vc 101,10,11
Mvaa 144,204,156
Ra 236,3,11264
v_or3_b32 v7, v7, v100, v101
Cvaa 160,192,160,40
VE 12,216
Mvaa 160,196,164
VE 13,217
Mvaa 160,200,168
Ra 240,3,12288
Vc 108,12,13
Mvaa 160,204,172
VE 14,218
Cvaa 176,192,176,44
VE 15,219
Mvaa 176,196,180
Ra 244,3,13312
Vc 109,14,15
Mvaa 176,200,184
Ra 248,3,14336
v_or3_b32 v7, v7, v108, v109
Mvaa 176,204,188
s_waitcnt lgkmcnt(7)
Ve 8,232
Cvaa 132,208,128,32
buffer_load_dwordx4 v4, s[12:15], s38 offen offset:1024 sc1 lds
Mvaa 132,212,132
VE 9,233
Mvaa 132,216,136
Ra 252,3,15360
Vc 116,8,9
Mvaa 132,220,140
VE 10,234
Cvaa 148,208,144,36
VE 11,235
Mvaa 148,212,148
Ra 192,2,49152
Vc 117,10,11
Mvaa 148,216,152
Ra 196,2,50176
v_or3_b32 v7, v7, v116, v117
Mvaa 148,220,156
VE 12,248
Cvaa 164,208,160,40
VE 13,249
Mvaa 164,212,164
Ra 200,2,51200
Vc 124,12,13
Mvaa 164,216,168
VE 14,250
Mvaa 164,220,172
VE 15,251
Cvaa 180,208,176,44
Ra 204,2,52224
Vc 125,14,15
Mvaa 180,212,180
buffer_load_dwordx4 v4, s[12:15], s38 offen offset:2048 sc1 lds
Mvaa 180,216,184
VE 8,204
Mvaa 180,220,188
s_waitcnt lgkmcnt(8)
Ve 9,205
Cvaa 136,224,128,32
Ra 208,2,53248
Vc 102,8,9
Mvaa 136,228,132
Ra 212,2,54272
v_or3_b32 v7, v7, v124, v125
Mvaa 136,232,136
VE 10,206
Mvaa 136,236,140
VE 11,207
Cvaa 152,224,144,36
Ra 216,2,55296
Vc 103,10,11
Mvaa 152,228,148
Ra 220,2,56320
v_or3_b32 v7, v7, v102, v103
Mvaa 152,232,152
VE 12,220
Mvaa 152,236,156
VE 13,221
Cvaa 168,224,160,40
VE 14,222
Mvaa 168,228,164
VE 15,223
Mvaa 168,232,168
VE 8,236
Mvaa 168,236,172
buffer_load_dwordx4 v4, s[12:15], s38 offen offset:3072 sc1 lds
Cvaa 184,224,176,44
VE 9,237
Mvaa 184,228,180
Vc 110,12,13
Vc 111,14,15
Mvaa 184,232,184
VE 10,238
Mvaa 184,236,188
s_waitcnt lgkmcnt(8)
Ve 11,239
Cvaa 140,240,128,32
Vc 118,8,9
Vc 119,10,11
Mvaa 140,244,132
VE 12,252
Mvaa 140,248,136
VE 13,253
Mvaa 140,252,140
Vc 126,12,13
v_or3_b32 v7, v7, v110, v111
Cvaa 156,240,144,36
VE 14,254
Mvaa 156,244,148
VE 15,255
Mvaa 156,248,152
Vc 127,14,15
v_or3_b32 v7, v7, v118, v119
Mvaa 156,252,156
v_or3_b32 v7, v7, v126, v127
v_and_b32 v1, 0x40004000, v7
Cvaa 172,240,160,40
v_cmp_ne_u32 vcc, 0, v1
Mvaa 172,244,164
Mvaa 172,248,168
Mvaa 172,252,172
s_waitcnt vmcnt(12)
Cvaa 188,240,176,44
s_cmp_eq_u32 s37, s46
Mvaa 188,244,180
s_barrier
Mvaa 188,248,184
s_waitcnt lgkmcnt(4)
Mvaa 188,252,188
s_cbranch_vccnz L_k2_fb_wo
L_k2_fbr_wo:
Maav 0,192,96
s_cbranch_scc1 L_k2_mk_wo
L_k2_mkr_wo:
Ve 8,128
Maav 0,196,100
s_add_u32 m0, s53, 16384
VE 9,129
Maav 32,192,104
buffer_load_dwordx4 v4, s[12:15], s39 offen offset:0 sc1 lds
Maav 32,196,108
s_add_u32 s37, s37, 1
Ra 224,2,57344
Vc 64,8,9
Maav 64,192,112
s_add_u32 s38, s38, 34816
Ve 10,130
Maav 64,196,116
s_xor_b32 s53, s53, 65536
VE 11,131
Maav 96,192,120
s_xor_b32 s54, s54, 65536
Ra 228,2,58368
Vc 65,10,11
Maav 96,196,124
Ra 232,2,59392
v_or_b32_e64 v7, v64, v65
Maav 4,200,96
VE 12,144
Maav 4,204,100
VE 13,145
Maav 36,200,104
Ra 236,2,60416
Vc 72,12,13
Maav 36,204,108
VE 14,146
Maav 68,200,112
VE 15,147
Maav 68,204,116
Ra 240,2,61440
Vc 73,14,15
Maav 100,200,120
Ra 244,2,62464
v_or3_b32 v7, v7, v72, v73
Maav 100,204,124
buffer_load_dwordx4 v4, s[12:15], s39 offen offset:1024 sc1 lds
Mvvv 48,16,96
VE 8,160
Mvvv 48,16,100
s_waitcnt lgkmcnt(6)
Ve 9,161
Maav 8,208,96
Ra 248,2,63488
Vc 80,8,9
Maav 8,212,100
VE 10,162
Maav 40,208,104
VE 11,163
Maav 40,212,108
Ra 252,2,64512
Vc 81,10,11
Maav 72,208,112
Ra 192,3,32768
v_or3_b32 v7, v7, v80, v81
Maav 72,212,116
VE 12,176
Maav 104,208,120
VE 13,177
Maav 104,212,124
Ra 196,3,33792
Vc 88,12,13
Maav 12,216,96
VE 14,178
Maav 12,220,100
VE 15,179
Maav 44,216,104
Ra 200,3,34816
Vc 89,14,15
Maav 44,220,108
buffer_load_dwordx4 v4, s[12:15], s39 offen offset:2048 sc1 lds
Maav 76,216,112
Ra 204,3,35840
v_or3_b32 v7, v7, v88, v89
Maav 76,220,116
VE 8,132
Maav 108,216,120
VE 9,133
Maav 108,220,124
VE 10,134
Mvvv 52,16,104
VE 11,135
Mvvv 52,16,108
s_waitcnt lgkmcnt(8)
Ve 12,148
Maav 16,224,96
Ra 208,3,36864
Vc 66,8,9
Maav 16,228,100
Ra 212,3,37888
Vc 67,10,11
Maav 48,224,104
Ra 216,3,38912
v_or3_b32 v7, v7, v66, v67
Maav 48,228,108
VE 13,149
Maav 80,224,112
Ra 220,3,39936
Vc 74,12,13
Maav 80,228,116
VE 14,150
Maav 112,224,120
buffer_load_dwordx4 v4, s[12:15], s39 offen offset:3072 sc1 lds
Maav 112,228,124
s_add_u32 s39, s39, 34816
VE 15,151
Maav 20,232,96
VE 8,164
Maav 20,236,100
VE 9,165
Maav 52,232,104
VE 10,166
Maav 52,236,108
VE 11,167
Maav 84,232,112
Vc 75,14,15
Vc 82,8,9
Maav 84,236,116
VE 12,180
Maav 116,232,120
VE 13,181
Maav 116,236,124
Vc 83,10,11
Vc 90,12,13
Mvvv 56,16,112
VE 14,182
Mvvv 56,16,116
s_waitcnt lgkmcnt(8)
Ve 15,183
Maav 24,240,96
Vc 91,14,15
v_or3_b32 v7, v7, v74, v75
Maav 24,244,100
v_or3_b32 v7, v7, v82, v83
v_or3_b32 v7, v7, v90, v91
Maav 56,240,104
global_load_dword v30, v[28:29], off
Maav 56,244,108
Maav 88,240,112
Maav 88,244,116
Maav 120,240,120
Maav 120,244,124
Maav 28,248,96
Maav 28,252,100
Maav 60,248,104
Maav 60,252,108
Maav 92,248,112
Maav 92,252,116
Maav 124,248,120
Maav 124,252,124
s_cmp_lg_u32 s37, s35
Mvvv 60,16,120
s_waitcnt lgkmcnt(4)
Mvvv 60,16,124
s_cbranch_scc1 L_k2_wloop
L_k2_wlast:
v_xor_b32 v2, 65536, v2
v_xor_b32 v3, 65536, v3
Cvaa 192,192,128,32
s_mov_b32 m0, s53
Ra 224,2,40960
v_lshl_add_u64 v[28:29], s[40:41], 0, v[28:29]
Mvaa 192,196,132
buffer_load_dwordx4 v4, s[12:15], s38 offen offset:0 sc1 lds
Mvaa 192,200,136
VE 8,136
Mvaa 192,204,140
VE 9,137
Cvaa 208,192,144,36
Ra 228,2,41984
Vc 68,8,9
Mvaa 208,196,148
VE 10,138
Mvaa 208,200,152
VE 11,139
Mvaa 208,204,156
Ra 232,2,43008
Vc 69,10,11
Cvaa 224,192,160,40
Ra 236,2,44032
v_or3_b32 v7, v7, v68, v69
Mvaa 224,196,164
VE 12,152
Mvaa 224,200,168
VE 13,153
Mvaa 224,204,172
s_waitcnt lgkmcnt(4)
Ra 240,2,45056
Vc 76,12,13
Cvaa 196,208,128,32
buffer_load_dwordx4 v4, s[12:15], s38 offen offset:1024 sc1 lds
Mvaa 196,212,132
Ve 14,154
Mvaa 196,216,136
VE 15,155
Mvaa 196,220,140
Ra 244,2,46080
Vc 77,14,15
Cvaa 212,208,144,36
Ra 248,2,47104
v_or3_b32 v7, v7, v76, v77
Mvaa 212,212,148
VE 8,168
Mvaa 212,216,152
VE 9,169
Mvaa 212,220,156
Ra 252,2,48128
Vc 84,8,9
Cvaa 228,208,160,40
VE 10,170
Mvaa 228,212,164
buffer_load_dwordx4 v4, s[12:15], s38 offen offset:2048 sc1 lds
Mvaa 228,216,168
VE 11,171
Mvaa 228,220,172
s_waitcnt lgkmcnt(4)
Ra 192,2,16384
Vc 85,10,11
Cvaa 200,224,128,32
Ra 196,2,17408
v_or3_b32 v7, v7, v84, v85
Mvaa 200,228,132
Ve 12,184
Mvaa 200,232,136
VE 13,185
Mvaa 200,236,140
Ra 200,2,18432
Vc 92,12,13
Cvaa 216,224,144,36
VE 14,186
Mvaa 216,228,148
VE 15,187
Mvaa 216,232,152
Ra 204,2,19456
Vc 93,14,15
Mvaa 216,236,156
buffer_load_dwordx4 v4, s[12:15], s38 offen offset:3072 sc1 lds
Cvaa 232,224,160,40
Ra 208,2,20480
v_or3_b32 v7, v7, v92, v93
Mvaa 232,228,164
VE 8,140
Mvaa 232,232,168
VE 9,141
Mvaa 232,236,172
s_waitcnt lgkmcnt(5)
Ra 212,2,21504
Vc 70,8,9
Cvaa 204,240,128,32
Ve 10,142
Mvaa 204,244,132
VE 11,143
Mvaa 204,248,136
Ra 216,2,22528
Vc 71,10,11
Mvaa 204,252,140
Ra 220,2,23552
v_or3_b32 v7, v7, v70, v71
Cvaa 220,240,144,36
VE 12,156
Mvaa 220,244,148
VE 13,157
Mvaa 220,248,152
VE 14,158
Mvaa 220,252,156
s_waitcnt vmcnt(12)
Ve 15,159
Cvaa 236,240,160,40
VE 8,172
Mvaa 236,244,164
s_barrier
Ve 9,173
Mvaa 236,248,168
s_waitcnt lgkmcnt(4)
Vc 78,12,13
Vc 79,14,15
Ve 10,174
Ve 11,175
Ve 12,188
Ve 13,189
Ve 14,190
VE 15,191
Vc 86,8,9
Vc 87,10,11
Vc 94,12,13
Vc 95,14,15
v_or3_b32 v7, v7, v78, v79
v_or3_b32 v7, v7, v86, v87
v_or3_b32 v7, v7, v94, v95
v_and_b32 v1, 0x40004000, v7
v_cmp_ne_u32 vcc, 0, v1
Mvaa 236,252,172
s_cbranch_vccnz L_k2_fb_wl
L_k2_fbr_wl:
Maav 0,192,64
s_branch L_k2_mk_wl
L_k2_mkr_wl:
Ve 8,192
Maav 0,196,68
s_add_u32 m0, s54, 49152
VE 9,193
Maav 32,192,72
buffer_load_dwordx4 v4, s[12:15], s39 offen offset:0 sc1 lds
Maav 32,196,76
s_add_u32 s37, s37, 1
Ra 224,2,24576
Vc 96,8,9
Maav 64,192,80
s_add_u32 s38, s38, 34816
Ve 10,194
Maav 64,196,84
VE 11,195
Maav 96,192,88
Ra 228,2,25600
Vc 97,10,11
Maav 96,196,92
Ra 232,2,26624
v_or_b32_e64 v7, v96, v97
Maav 4,200,64
VE 12,208
Maav 4,204,68
VE 13,209
Maav 36,200,72
Ra 236,2,27648
Vc 104,12,13
Maav 36,204,76
VE 14,210
Maav 68,200,80
VE 15,211
Maav 68,204,84
Ra 240,2,28672
Vc 105,14,15
Maav 100,200,88
Ra 244,2,29696
v_or3_b32 v7, v7, v104, v105
Maav 100,204,92
buffer_load_dwordx4 v4, s[12:15], s39 offen offset:1024 sc1 lds
Mvvv 48,16,64
VE 8,224
Mvvv 48,16,68
s_waitcnt lgkmcnt(6)
Ve 9,225
Maav 8,208,64
Ra 248,2,30720
Vc 112,8,9
Maav 8,212,68
VE 10,226
Maav 40,208,72
VE 11,227
Maav 40,212,76
Ra 252,2,31744
Vc 113,10,11
Maav 72,208,80
Ra 192,3,0
v_or3_b32 v7, v7, v112, v113
Maav 72,212,84
VE 12,196
Maav 104,208,88
VE 13,197
Maav 104,212,92
Ra 196,3,1024
Vc 98,12,13
Maav 12,216,64
VE 14,198
Maav 12,220,68
VE 15,199
Maav 44,216,72
Ra 200,3,2048
Vc 99,14,15
Maav 44,220,76
buffer_load_dwordx4 v4, s[12:15], s39 offen offset:2048 sc1 lds
Maav 76,216,80
Ra 204,3,3072
v_or3_b32 v7, v7, v98, v99
Maav 76,220,84
VE 8,212
Maav 108,216,88
VE 9,213
Maav 108,220,92
VE 10,214
Mvvv 52,16,72
VE 11,215
Mvvv 52,16,76
s_waitcnt lgkmcnt(8)
Ve 12,228
Maav 16,224,64
Ra 208,3,4096
Vc 106,8,9
Maav 16,228,68
Ra 212,3,5120
Vc 107,10,11
Maav 48,224,72
Ra 216,3,6144
v_or3_b32 v7, v7, v106, v107
Maav 48,228,76
VE 13,229
Maav 80,224,80
Ra 220,3,7168
Vc 114,12,13
Maav 80,228,84
VE 14,230
Maav 112,224,88
buffer_load_dwordx4 v4, s[12:15], s39 offen offset:3072 sc1 lds
Maav 112,228,92
s_add_u32 s39, s39, 34816
VE 15,231
Maav 20,232,64
VE 8,200
Maav 20,236,68
VE 9,201
Maav 52,232,72
VE 10,202
Maav 52,236,76
VE 11,203
Maav 84,232,80
Vc 115,14,15
Vc 100,8,9
Maav 84,236,84
VE 12,216
Maav 116,232,88
VE 13,217
Maav 116,236,92
Vc 101,10,11
Vc 108,12,13
Mvvv 56,16,80
VE 14,218
Mvvv 56,16,84
s_waitcnt lgkmcnt(8)
Ve 15,219
Maav 24,240,64
Vc 109,14,15
v_or3_b32 v7, v7, v114, v115
Maav 24,244,68
VE 8,232
Maav 56,240,72
global_load_dword v30, v[28:29], off
Maav 56,244,76
VE 9,233
Maav 88,240,80
Vc 116,8,9
v_or3_b32 v7, v7, v100, v101
Maav 88,244,84
VE 10,234
Maav 120,240,88
VE 11,235
Maav 120,244,92
Vc 117,10,11
v_or3_b32 v7, v7, v108, v109
Maav 28,248,64
v_or3_b32 v7, v7, v116, v117
Maav 28,252,68
Maav 60,248,72
Maav 60,252,76
Maav 92,248,80
Maav 92,252,84
Maav 124,248,88
Maav 124,252,92
Mvvv 60,16,88
s_waitcnt lgkmcnt(4)
Mvvv 60,16,92
Ve 12,204
Cvaa 128,192,128,32
s_add_u32 m0, s53, 32768
VE 13,205
Mvaa 128,196,132
buffer_load_dwordx4 v4, s[12:15], s38 offen offset:0 sc1 lds
Mvaa 128,200,136
Ra 224,3,8192
Vc 102,12,13
Mvaa 128,204,140
VE 14,206
Cvaa 144,192,144,36
VE 15,207
Mvaa 144,196,148
Ra 228,3,9216
Vc 103,14,15
Mvaa 144,200,152
Ra 232,3,10240
v_or3_b32 v7, v7, v102, v103
Mvaa 144,204,156
s_waitcnt lgkmcnt(3)
Ra 236,3,11264
Ra 240,3,12288
Cvaa 132,208,128,32
buffer_load_dwordx4 v4, s[12:15], s38 offen offset:1024 sc1 lds
Mvaa 132,212,132
Ve 8,220
Mvaa 132,216,136
VE 9,221
Mvaa 132,220,140
Ra 244,3,13312
Vc 110,8,9
Cvaa 148,208,144,36
VE 10,222
Mvaa 148,212,148
buffer_load_dwordx4 v4, s[12:15], s38 offen offset:2048 sc1 lds
Mvaa 148,216,152
VE 11,223
Mvaa 148,220,156
s_waitcnt lgkmcnt(2)
Ra 248,3,14336
Ra 252,3,15360
Cvaa 136,224,128,32
Ra 192,2,49152
Vc 111,10,11
Mvaa 136,228,132
Ra 196,2,50176
v_or3_b32 v7, v7, v110, v111
Mvaa 136,232,136
Ve 12,236
Mvaa 136,236,140
buffer_load_dwordx4 v4, s[12:15], s38 offen offset:3072 sc1 lds
Cvaa 152,224,144,36
VE 13,237
Mvaa 152,228,148
Ra 200,2,51200
Vc 118,12,13
Mvaa 152,232,152
VE 14,238
Mvaa 152,236,156
s_waitcnt lgkmcnt(3)
Ra 204,2,52224
Ra 208,2,53248
Cvaa 140,240,128,32
Ve 15,239
Mvaa 140,244,132
Ra 212,2,54272
Vc 119,14,15
Mvaa 140,248,136
Ra 216,2,55296
v_or3_b32 v7, v7, v118, v119
Mvaa 140,252,140
s_waitcnt vmcnt(12)
Ra 220,2,56320
v_and_b32 v1, 0x40004000, v7
Cvaa 156,240,144,36
s_cmp_eq_u32 s37, s45
v_cmp_ne_u32 vcc, 0, v1
Mvaa 156,244,148
s_barrier
Mvaa 156,248,152
s_waitcnt lgkmcnt(4)
Mvaa 156,252,156
s_cbranch_vccnz L_k2_fb_tr
L_k2_fbr_tr:
Maav 0,192,96
s_cbranch_scc1 L_k2_mk_tr
L_k2_mkr_tr:
Ve 8,128
Maav 0,196,100
s_add_u32 m0, s53, 16384
VE 9,129
Maav 32,192,104
buffer_load_dwordx4 v4, s[12:15], s39 offen offset:0 sc1 lds
Maav 32,196,108
s_add_u32 s37, s37, 1
Ra 224,2,57344
Vc 64,8,9
Maav 64,192,112
s_add_u32 s38, s38, 34816
Ve 10,130
Maav 64,196,116
s_xor_b32 s53, s53, 65536
VE 11,131
Maav 4,200,96
s_xor_b32 s54, s54, 65536
Ra 228,2,58368
Vc 65,10,11
Maav 4,204,100
Ra 232,2,59392
v_or_b32_e64 v7, v64, v65
Maav 36,200,104
VE 12,144
Maav 36,204,108
VE 13,145
Maav 68,200,112
Ra 236,2,60416
Vc 72,12,13
Maav 68,204,116
VE 14,146
Mvvv 48,16,96
VE 15,147
Mvvv 48,16,100
s_waitcnt lgkmcnt(4)
Ra 240,2,61440
Vc 73,14,15
Maav 8,208,96
buffer_load_dwordx4 v4, s[12:15], s39 offen offset:1024 sc1 lds
Maav 8,212,100
Ra 244,2,62464
v_or3_b32 v7, v7, v72, v73
Maav 40,208,104
Ve 8,132
Maav 40,212,108
VE 9,133
Maav 72,208,112
Ra 248,2,63488
Vc 66,8,9
Maav 72,212,116
VE 10,134
Maav 12,216,96
VE 11,135
Maav 12,220,100
Ra 252,2,64512
Vc 67,10,11
Maav 44,216,104
Ra 192,3,32768
v_or3_b32 v7, v7, v66, v67
Maav 44,220,108
VE 12,148
Maav 76,216,112
VE 13,149
Maav 76,220,116
Ra 196,3,33792
Vc 74,12,13
Mvvv 52,16,104
VE 14,150
Mvvv 52,16,108
s_waitcnt lgkmcnt(6)
Ve 15,151
Maav 16,224,96
buffer_load_dwordx4 v4, s[12:15], s39 offen offset:2048 sc1 lds
Maav 16,228,100
Ra 200,3,34816
Vc 75,14,15
Maav 48,224,104
Ra 204,3,35840
v_or3_b32 v7, v7, v74, v75
Maav 48,228,108
VE 8,136
Maav 80,224,112
Ra 208,3,36864
Ra 212,3,37888
Maav 80,228,116
Ra 216,3,38912
Ra 220,3,39936
Maav 20,232,96
Maav 20,236,100
Maav 52,232,104
Maav 52,236,108
Maav 84,232,112
Maav 84,236,116
buffer_load_dwordx4 v4, s[12:15], s39 offen offset:3072 sc1 lds
Mvvv 56,16,112
s_add_u32 s39, s39, 34816
Mvvv 56,16,116
s_waitcnt lgkmcnt(8)
Maav 24,240,96
Maav 24,244,100
Maav 56,240,104
Maav 56,244,108
Maav 88,240,112
Maav 88,244,116
Maav 28,248,96
Maav 28,252,100
Maav 60,248,104
Maav 60,252,108
Maav 92,248,112
s_waitcnt lgkmcnt(4)
Maav 92,252,116
s_getpc_b64 s[56:57]
L_cpf4:
s_add_u32 s56, s56, (L_k2_fin-L_cpf4)&0xffffffff
s_addc_u32 s57, s57, ((L_k2_fin-L_cpf4)>>32)&0xffffffff
s_lshr_b32 s58, s2, 3
s_lshl_b32 s58, s58, 2
s_add_u32 s58, s58, s32
s_lshl_b32 s58, s58, 10
v_and_b32 v162, 7, v0
v_lshlrev_b32 v162, 7, v162
v_add_u32 v162, s58, v162
v_min_u32 v162, L_p4_end-L_k2_fin-4, v162
v_mov_b32 v161, s57
v_add_co_u32 v160, vcc, s56, v162
s_nop 1
v_addc_co_u32 v161, vcc, 0, v161, vcc
global_load_dword v164, v[160:161], off
s_waitcnt vmcnt(9)
s_lshl_b32 s3, s34, 20
s_lshl_b32 s47, s33, 15
s_add_u32 s3, s3, s47
s_lshl_b32 s47, s32, 10
v_lshlrev_b32 v248, 4, v0
v_add_u32_e64 v249, s47, v248
s_sub_u32 s47, 7168, s47
v_add_u32 v248, s47, v248
v_rcp_f32 v250, v56
v_rcp_f32 v252, v60
v_mov_b32 v251, v250
v_mov_b32_e64 v253, v252
Ar 240,96
Ar 241,97
Ar 242,98
Ar 243,99
Ar 244,100
Ar 245,101
Ar 246,102
Ar 247,103
v_pk_mul_f32 v[240:241], v[240:241], v[252:253]
v_pk_mul_f32 v[242:243], v[242:243], v[252:253]
v_pk_mul_f32 v[244:245], v[244:245], v[252:253]
v_pk_mul_f32 v[246:247], v[246:247], v[252:253]
Vc 28,240,241
Vc 29,242,243
Vc 30,244,245
Vc 31,246,247
buffer_store_dwordx4 v[28:31], v249, s[16:19], s3 offen sc1
Ar 240,64
Ar 241,65
Ar 242,66
Ar 243,67
Ar 244,68
Ar 245,69
Ar 246,70
Ar 247,71
v_pk_mul_f32 v[240:241], v[240:241], v[250:251]
v_pk_mul_f32 v[242:243], v[242:243], v[250:251]
v_pk_mul_f32 v[244:245], v[244:245], v[250:251]
v_pk_mul_f32 v[246:247], v[246:247], v[250:251]
Vc 24,240,241
Vc 25,242,243
Vc 26,244,245
Vc 27,246,247
buffer_store_dwordx4 v[24:27], v248, s[16:19], s3 offen sc1
s_add_u32 s3, s3, 8192
Ar 240,104
Ar 241,105
Ar 242,106
Ar 243,107
Ar 244,108
Ar 245,109
Ar 246,110
Ar 247,111
v_pk_mul_f32 v[240:241], v[240:241], v[252:253]
v_pk_mul_f32 v[242:243], v[242:243], v[252:253]
v_pk_mul_f32 v[244:245], v[244:245], v[252:253]
v_pk_mul_f32 v[246:247], v[246:247], v[252:253]
Vc 28,240,241
Vc 29,242,243
Vc 30,244,245
Vc 31,246,247
buffer_store_dwordx4 v[28:31], v249, s[16:19], s3 offen sc1
Ar 240,72
Ar 241,73
Ar 242,74
Ar 243,75
Ar 244,76
Ar 245,77
Ar 246,78
Ar 247,79
v_pk_mul_f32 v[240:241], v[240:241], v[250:251]
v_pk_mul_f32 v[242:243], v[242:243], v[250:251]
v_pk_mul_f32 v[244:245], v[244:245], v[250:251]
v_pk_mul_f32 v[246:247], v[246:247], v[250:251]
Vc 24,240,241
Vc 25,242,243
Vc 26,244,245
Vc 27,246,247
buffer_store_dwordx4 v[24:27], v248, s[16:19], s3 offen sc1
s_add_u32 s3, s3, 8192
Ar 240,112
Ar 241,113
Ar 242,114
Ar 243,115
Ar 244,116
Ar 245,117
Ar 246,118
Ar 247,119
v_pk_mul_f32 v[240:241], v[240:241], v[252:253]
v_pk_mul_f32 v[242:243], v[242:243], v[252:253]
v_pk_mul_f32 v[244:245], v[244:245], v[252:253]
v_pk_mul_f32 v[246:247], v[246:247], v[252:253]
Vc 28,240,241
Vc 29,242,243
Vc 30,244,245
Vc 31,246,247
buffer_store_dwordx4 v[28:31], v249, s[16:19], s3 offen sc1
Ar 240,80
Ar 241,81
Ar 242,82
Ar 243,83
Ar 244,84
Ar 245,85
Ar 246,86
Ar 247,87
v_pk_mul_f32 v[240:241], v[240:241], v[250:251]
v_pk_mul_f32 v[242:243], v[242:243], v[250:251]
v_pk_mul_f32 v[244:245], v[244:245], v[250:251]
v_pk_mul_f32 v[246:247], v[246:247], v[250:251]
Vc 24,240,241
Vc 25,242,243
Vc 26,244,245
Vc 27,246,247
buffer_store_dwordx4 v[24:27], v248, s[16:19], s3 offen sc1
s_add_u32 s3, s3, 8192
Ar 240,120
Ar 241,121
Ar 242,122
Ar 243,123
Ar 244,124
Ar 245,125
Ar 246,126
Ar 247,127
v_pk_mul_f32 v[240:241], v[240:241], v[252:253]
v_pk_mul_f32 v[242:243], v[242:243], v[252:253]
v_pk_mul_f32 v[244:245], v[244:245], v[252:253]
v_pk_mul_f32 v[246:247], v[246:247], v[252:253]
Vc 28,240,241
Vc 29,242,243
Vc 30,244,245
Vc 31,246,247
buffer_store_dwordx4 v[28:31], v249, s[16:19], s3 offen sc1
Ar 240,88
Ar 241,89
Ar 242,90
Ar 243,91
Ar 244,92
Ar 245,93
Ar 246,94
Ar 247,95
v_pk_mul_f32 v[240:241], v[240:241], v[250:251]
v_pk_mul_f32 v[242:243], v[242:243], v[250:251]
v_pk_mul_f32 v[244:245], v[244:245], v[250:251]
v_pk_mul_f32 v[246:247], v[246:247], v[250:251]
Vc 24,240,241
Vc 25,242,243
Vc 26,244,245
Vc 27,246,247
buffer_store_dwordx4 v[24:27], v248, s[16:19], s3 offen sc1
s_add_u32 s52, s37, 2
s_load_dwordx2 s[94:95], s[0:1], 40
s_load_dwordx2 s[40:41], s[0:1], 0
s_load_dwordx4 s[8:11], s[0:1], 80
s_waitcnt vmcnt(8) lgkmcnt(0)
s_add_u32 s93, s2, 224
s_and_b32 s93, s93, 255
s_nop 0
s_mul_i32 s92, s93, 2341
s_lshr_b32 s92, s92, 16
s_mul_i32 s47, s92, 28
s_sub_u32 s4, s93, s47
s_mul_i32 s5, s92, 917504
s_lshl_b32 s47, s4, 8
s_add_u32 s5, s5, s47
s_cmp_eq_u32 s34, 7
s_cbranch_scc1 L_k2_fin
L_k2_nloop:
v_xor_b32 v2, 65536, v2
v_xor_b32 v3, 65536, v3
Cvaa 192,192,128,32
s_mov_b32 m0, s53
Ve 9,137
Mvaa 192,196,132
buffer_load_dwordx4 v4, s[12:15], s38 offen offset:0 sc1 lds
Mvaa 192,200,136
Ra 224,2,40960
Vc 68,8,9
Mvaa 192,204,140
VE 10,138
Cvaa 208,192,144,36
VE 11,139
Mvaa 208,196,148
Ra 228,2,41984
Vc 69,10,11
Mvaa 208,200,152
Ra 232,2,43008
v_or3_b32 v7, v7, v68, v69
Mvaa 208,204,156
s_waitcnt lgkmcnt(3)
Ra 236,2,44032
Ra 240,2,45056
Cvaa 196,208,128,32
buffer_load_dwordx4 v4, s[12:15], s38 offen offset:1024 sc1 lds
Mvaa 196,212,132
Ve 12,152
Mvaa 196,216,136
VE 13,153
Mvaa 196,220,140
Ra 244,2,46080
Vc 76,12,13
Cvaa 212,208,144,36
VE 14,154
Mvaa 212,212,148
buffer_load_dwordx4 v4, s[12:15], s38 offen offset:2048 sc1 lds
Mvaa 212,216,152
VE 15,155
Mvaa 212,220,156
s_waitcnt lgkmcnt(2)
Ra 248,2,47104
Ra 252,2,48128
Cvaa 200,224,128,32
Ra 192,2,16384
Vc 77,14,15
Mvaa 200,228,132
Ra 196,2,17408
v_or3_b32 v7, v7, v76, v77
Mvaa 200,232,136
Ve 8,140
Mvaa 200,236,140
buffer_load_dwordx4 v4, s[12:15], s38 offen offset:3072 sc1 lds
Cvaa 216,224,144,36
VE 9,141
Mvaa 216,228,148
Ra 200,2,18432
Vc 70,8,9
Mvaa 216,232,152
VE 10,142
Mvaa 216,236,156
s_waitcnt lgkmcnt(3)
Ra 204,2,19456
Ra 208,2,20480
Cvaa 204,240,128,32
Ve 11,143
Mvaa 204,244,132
s_cmp_lt_u32 s37, s52
Ra 212,2,21504
Vc 71,10,11
Mvaa 204,248,136
s_cbranch_scc1 L_nw_ne
s_waitcnt vmcnt(12)
L_nw_ne:
Ra 216,2,22528
v_or3_b32 v7, v7, v70, v71
Mvaa 204,252,140
Ve 12,156
Cvaa 220,240,144,36
VE 13,157
Mvaa 220,244,148
s_barrier
Ra 220,2,23552
Vc 78,12,13
Mvaa 220,248,152
s_waitcnt lgkmcnt(4)
Ve 14,158
Ve 15,159
s_nop 0
Vc 79,14,15
v_or3_b32 v7, v7, v78, v79
v_and_b32 v1, 0x40004000, v7
v_cmp_ne_u32 vcc, 0, v1
Mvaa 220,252,156
s_cbranch_vccnz L_k2_fb_ne
L_k2_fbr_ne:
Maav 0,192,64
Ve 8,192
Maav 0,196,68
s_add_u32 m0, s54, 49152
VE 9,193
Maav 32,192,72
buffer_load_dwordx4 v4, s[12:15], s39 offen offset:0 sc1 lds
Maav 32,196,76
s_cmp_eq_u32 s37, s52
Ra 224,2,24576
Vc 96,8,9
Maav 4,200,64
s_cbranch_scc1 L_pubB
L_pubBr:
VE 10,194
Maav 4,204,68
s_add_u32 s37, s37, 1
Ve 11,195
Maav 36,200,72
s_add_u32 s38, s38, 34816
Ra 228,2,25600
Vc 97,10,11
Maav 36,204,76
Ra 232,2,26624
v_or_b32_e64 v7, v96, v97
Mvvv 48,16,64
VE 12,208
Mvvv 48,16,68
s_waitcnt lgkmcnt(3)
Ra 236,2,27648
Ra 240,2,28672
Maav 8,208,64
buffer_load_dwordx4 v4, s[12:15], s39 offen offset:1024 sc1 lds
Maav 8,212,68
Ve 13,209
Maav 40,208,72
Ra 244,2,29696
Vc 104,12,13
Maav 40,212,76
VE 14,210
Maav 12,216,64
VE 15,211
Maav 12,220,68
Ra 248,2,30720
Vc 105,14,15
Maav 44,216,72
Ra 252,2,31744
v_or3_b32 v7, v7, v104, v105
Maav 44,220,76
VE 8,196
Mvvv 52,16,72
buffer_load_dwordx4 v4, s[12:15], s39 offen offset:2048 sc1 lds
Mvvv 52,16,76
s_waitcnt lgkmcnt(4)
Ve 9,197
Maav 16,224,64
Ra 192,3,0
Vc 98,8,9
Maav 16,228,68
VE 10,198
Maav 48,224,72
VE 11,199
Maav 48,228,76
Ra 196,3,1024
Vc 99,10,11
Maav 20,232,64
Ra 200,3,2048
v_or3_b32 v7, v7, v98, v99
Maav 20,236,68
Ra 204,3,3072
Ra 208,3,4096
Maav 52,232,72
buffer_load_dwordx4 v4, s[12:15], s39 offen offset:3072 sc1 lds
Maav 52,236,76
s_waitcnt lgkmcnt(5)
Ve 12,212
Maav 24,240,64
s_add_u32 s39, s39, 34816
VE 13,213
Maav 24,244,68
Ra 212,3,5120
Vc 106,12,13
Maav 56,240,72
VE 14,214
Maav 56,244,76
VE 15,215
Maav 28,248,64
Ra 216,3,6144
Vc 107,14,15
Maav 28,252,68
Ra 220,3,7168
v_or3_b32 v7, v7, v106, v107
Maav 60,248,72
s_waitcnt lgkmcnt(4)
Ve 8,200
Maav 60,252,76
VE 9,201
Cvaa 128,192,128,32
s_add_u32 m0, s53, 32768
Ra 224,3,8192
Vc 100,8,9
Mvaa 128,196,132
buffer_load_dwordx4 v4, s[12:15], s38 offen offset:0 sc1 lds
Mvaa 128,200,136
VE 10,202
Mvaa 128,204,140
VE 11,203
Cvaa 144,192,144,36
Ra 228,3,9216
Vc 101,10,11
Mvaa 144,196,148
Ra 232,3,10240
v_or3_b32 v7, v7, v100, v101
Mvaa 144,200,152
VE 12,216
Mvaa 144,204,156
s_waitcnt lgkmcnt(3)
Ra 236,3,11264
Ra 240,3,12288
Cvaa 132,208,128,32
buffer_load_dwordx4 v4, s[12:15], s38 offen offset:1024 sc1 lds
Mvaa 132,212,132
Ve 13,217
Mvaa 132,216,136
Ra 244,3,13312
Vc 108,12,13
Mvaa 132,220,140
VE 14,218
Cvaa 148,208,144,36
VE 15,219
Mvaa 148,212,148
buffer_load_dwordx4 v4, s[12:15], s38 offen offset:2048 sc1 lds
Mvaa 148,216,152
Ra 248,3,14336
Vc 109,14,15
Mvaa 148,220,156
s_waitcnt lgkmcnt(3)
Ra 252,3,15360
v_or3_b32 v7, v7, v108, v109
Cvaa 136,224,128,32
Ve 8,204
Mvaa 136,228,132
VE 9,205
Mvaa 136,232,136
Ra 192,2,49152
Vc 102,8,9
Mvaa 136,236,140
buffer_load_dwordx4 v4, s[12:15], s38 offen offset:3072 sc1 lds
Cvaa 152,224,144,36
VE 10,206
Mvaa 152,228,148
VE 11,207
Mvaa 152,232,152
Ra 196,2,50176
Vc 103,10,11
Mvaa 152,236,156
s_waitcnt lgkmcnt(2)
Ra 200,2,51200
Ra 204,2,52224
Cvaa 140,240,128,32
Ra 208,2,53248
v_or3_b32 v7, v7, v102, v103
Mvaa 140,244,132
s_cmp_lt_u32 s37, s52
VE 12,220
Mvaa 140,248,136
s_cbranch_scc1 L_nw_no
s_waitcnt vmcnt(12)
L_nw_no:
VE 13,221
Mvaa 140,252,140
Ra 212,2,54272
Vc 110,12,13
Cvaa 156,240,144,36
s_cmp_eq_u32 s37, s45
Ve 14,222
Mvaa 156,244,148
s_barrier
Ve 15,223
Mvaa 156,248,152
s_waitcnt lgkmcnt(2)
Ra 216,2,55296
Vc 111,14,15
v_or3_b32 v7, v7, v110, v111
v_and_b32 v1, 0x40004000, v7
v_cmp_ne_u32 vcc, 0, v1
Mvaa 156,252,156
s_cbranch_vccnz L_k2_fb_no
L_k2_fbr_no:
Ra 220,2,56320
Maav 0,192,96
s_cbranch_scc1 L_k2_mk_no
L_k2_mkr_no:
VE 8,128
Maav 0,196,100
s_add_u32 m0, s53, 16384
VE 9,129
Maav 32,192,104
buffer_load_dwordx4 v4, s[12:15], s39 offen offset:0 sc1 lds
Maav 32,196,108
s_add_u32 s37, s37, 1
Ra 224,2,57344
Vc 64,8,9
Maav 4,200,96
s_add_u32 s38, s38, 34816
Ve 10,130
Maav 4,204,100
s_xor_b32 s53, s53, 65536
VE 11,131
Maav 36,200,104
s_xor_b32 s54, s54, 65536
Ra 228,2,58368
Vc 65,10,11
Maav 36,204,108
Ra 232,2,59392
v_or_b32_e64 v7, v64, v65
Mvvv 48,16,96
VE 12,144
Mvvv 48,16,100
s_waitcnt lgkmcnt(3)
Ra 236,2,60416
Ra 240,2,61440
Maav 8,208,96
buffer_load_dwordx4 v4, s[12:15], s39 offen offset:1024 sc1 lds
Maav 8,212,100
Ve 13,145
Maav 40,208,104
Ra 244,2,62464
Vc 72,12,13
Maav 40,212,108
VE 14,146
Maav 12,216,96
VE 15,147
Maav 12,220,100
Ra 248,2,63488
Vc 73,14,15
Maav 44,216,104
Ra 252,2,64512
v_or3_b32 v7, v7, v72, v73
Maav 44,220,108
VE 8,132
Mvvv 52,16,104
buffer_load_dwordx4 v4, s[12:15], s39 offen offset:2048 sc1 lds
Mvvv 52,16,108
s_waitcnt lgkmcnt(4)
Ve 9,133
Maav 16,224,96
Ra 192,3,32768
Vc 66,8,9
Maav 16,228,100
VE 10,134
Maav 48,224,104
VE 11,135
Maav 48,228,108
Ra 196,3,33792
Vc 67,10,11
Maav 20,232,96
Ra 200,3,34816
v_or3_b32 v7, v7, v66, v67
Maav 20,236,100
Ra 204,3,35840
Ra 208,3,36864
Maav 52,232,104
buffer_load_dwordx4 v4, s[12:15], s39 offen offset:3072 sc1 lds
Maav 52,236,108
s_waitcnt lgkmcnt(5)
Ve 12,148
Maav 24,240,96
s_add_u32 s39, s39, 34816
VE 13,149
Maav 24,244,100
Ra 212,3,37888
Vc 74,12,13
Maav 56,240,104
VE 14,150
Maav 56,244,108
VE 15,151
Maav 28,248,96
Ra 216,3,38912
Vc 75,14,15
Maav 28,252,100
s_cmp_lg_u32 s37, s36
Ra 220,3,39936
v_or3_b32 v7, v7, v74, v75
Maav 60,248,104
s_waitcnt lgkmcnt(4)
VE 8,136
Maav 60,252,108
s_cbranch_scc1 L_k2_nloop
L_k2_fin:
v_xor_b32 v2, 65536, v2
v_xor_b32 v3, 65536, v3
Cvaa 192,192,128,32
Ve 9,137
Mvaa 192,196,132
Ra 224,2,40960
Vc 68,8,9
Mvaa 192,200,136
Ra 228,2,41984
Ra 232,2,43008
Mvaa 192,204,140
s_waitcnt lgkmcnt(3)
Ra 236,2,44032
Ra 240,2,45056
Cvaa 196,208,128,32
Ve 10,138
Mvaa 196,212,132
VE 11,139
Mvaa 196,216,136
Ra 244,2,46080
Vc 69,10,11
Mvaa 196,220,140
s_waitcnt lgkmcnt(2)
Ra 248,2,47104
Ra 252,2,48128
Cvaa 200,224,128,32
Ra 192,2,16384
v_or3_b32 v7, v7, v68, v69
Mvaa 200,228,132
s_cmp_lt_u32 s37, s52
VE 12,152
Mvaa 200,232,136
s_cbranch_scc1 L_nw_nl
s_waitcnt vmcnt(8)
L_nw_nl:
Ra 196,2,17408
Ra 200,2,18432
Mvaa 200,236,140
s_waitcnt lgkmcnt(3)
Ra 204,2,19456
Ra 208,2,20480
Cvaa 204,240,128,32
Ve 13,153
Mvaa 204,244,132
s_barrier
Ra 212,2,21504
Vc 76,12,13
Mvaa 204,248,136
s_waitcnt lgkmcnt(2)
Ve 14,154
Ve 15,155
Ve 8,140
Ve 9,141
Ve 10,142
Ve 11,143
Ve 12,156
Ve 13,157
Vc 77,14,15
Ve 14,158
Ve 15,159
Vc 70,8,9
Vc 71,10,11
Vc 78,12,13
Vc 79,14,15
v_or3_b32 v7, v7, v76, v77
v_or3_b32 v7, v7, v70, v71
v_or3_b32 v7, v7, v78, v79
v_and_b32 v1, 0x40004000, v7
v_cmp_ne_u32 vcc, 0, v1
Mvaa 204,252,140
s_cbranch_vccnz L_k2_fb_nl
L_k2_fbr_nl:
Ra 216,2,22528
Ra 220,2,23552
s_lshr_b32 s3, s42, 4
s_mul_i32 s3, s3, 33792
s_and_b32 s47, s42, 15
s_lshl_b32 s47, s47, 4
s_add_u32 s3, s3, s47
v_mov_b32 v28, s3
s_lshr_b32 s3, s43, 4
s_mul_i32 s3, s3, 33792
s_and_b32 s47, s43, 15
s_lshl_b32 s47, s47, 4
s_add_u32 s3, s3, s47
v_mov_b32 v29, s3
v_lshrrev_b32 v24, 4, v0
v_and_b32 v25, 15, v0
v_cmp_eq_u32 vcc, 1, v25
s_lshl_b32 s3, s32, 4
v_add_u32 v26, s3, v24
v_cndmask_b32 v28, v28, v29, vcc
v_lshl_add_u32 v28, v24, 8, v28
v_mul_u32_u24 v26, 7168, v26
v_lshlrev_b32 v24, 1, v24
v_xor_b32 v24, v24, v25
v_xor_b32_e64 v25, 8, v24
v_lshl_add_u32 v24, v24, 4, v26
v_lshl_add_u32 v25, v25, 4, v26
s_lshl_b32 s3, s92, 12
buffer_load_dwordx4 a[160:163], v28, s[20:23], s3 offen offset:0 sc1
buffer_load_dwordx4 a[164:167], v28, s[20:23], s3 offen offset:1024 sc1
buffer_load_dwordx4 a[168:171], v28, s[20:23], s3 offen offset:2048 sc1
buffer_load_dwordx4 a[172:175], v28, s[20:23], s3 offen offset:3072 sc1
Maav 0,192,64
s_branch L_k2_mk_nl
L_k2_mkr_nl:
VE 8,192
Maav 0,196,68
s_add_u32 m0, s54, 0
s_add_u32 s3, s5, 0
VE 9,193
Maav 32,192,72
buffer_load_dwordx4 v24, s[24:27], s3 offen offset:0 lds
Maav 32,196,76
s_add_u32 s3, s5, 27648
Ra 224,2,24576
Vc 96,8,9
Maav 4,200,64
buffer_load_dwordx4 v24, s[24:27], s3 offen offset:1024 lds
Maav 4,204,68
s_add_u32 s3, s5, 55296
VE 10,194
Maav 36,200,72
buffer_load_dwordx4 v25, s[24:27], s3 offen offset:2048 lds
Maav 36,204,76
s_add_u32 s3, s5, 82944
Ra 228,2,25600
Ra 232,2,26624
Mvvv 48,16,64
buffer_load_dwordx4 v25, s[24:27], s3 offen offset:3072 lds
Mvvv 48,16,68
s_waitcnt lgkmcnt(3)
s_add_u32 m0, s54, 16384
s_add_u32 s3, s5, 458752
Ra 236,2,27648
Ra 240,2,28672
Maav 8,208,64
buffer_load_dwordx4 v24, s[24:27], s3 offen offset:0 lds
Maav 8,212,68
s_add_u32 s3, s5, 486400
Ve 11,195
Maav 40,208,72
buffer_load_dwordx4 v24, s[24:27], s3 offen offset:1024 lds
Maav 40,212,76
s_add_u32 s3, s5, 514048
Ra 244,2,29696
Vc 97,10,11
Maav 12,216,64
buffer_load_dwordx4 v25, s[24:27], s3 offen offset:2048 lds
Maav 12,220,68
s_add_u32 s3, s5, 541696
Ra 248,2,30720
v_or_b32_e64 v7, v96, v97
Maav 44,216,72
buffer_load_dwordx4 v25, s[24:27], s3 offen offset:3072 lds
Maav 44,220,76
s_add_u32 m0, s54, 32768
s_add_u32 s3, s5, 0
Ve 12,196
Mvvv 52,16,72
buffer_load_dwordx4 v24, s[68:71], s3 offen offset:0 lds
Mvvv 52,16,76
s_waitcnt lgkmcnt(3)
s_add_u32 s3, s5, 27648
Ra 252,2,31744
Ra 192,2,49152
Maav 16,224,64
buffer_load_dwordx4 v24, s[68:71], s3 offen offset:1024 lds
Maav 16,228,68
s_add_u32 s3, s5, 55296
Ve 13,197
Maav 48,224,72
buffer_load_dwordx4 v25, s[68:71], s3 offen offset:2048 lds
Maav 48,228,76
s_add_u32 s3, s5, 82944
Ra 196,2,50176
Vc 98,12,13
Maav 20,232,64
buffer_load_dwordx4 v25, s[68:71], s3 offen offset:3072 lds
Maav 20,236,68
s_add_u32 m0, s54, 49152
s_add_u32 s3, s5, 458752
Ra 200,2,51200
Ra 204,2,52224
Maav 52,232,72
buffer_load_dwordx4 v24, s[68:71], s3 offen offset:0 lds
Maav 52,236,76
s_waitcnt lgkmcnt(4)
s_add_u32 s3, s5, 486400
Ve 14,198
Maav 24,240,64
buffer_load_dwordx4 v24, s[68:71], s3 offen offset:1024 lds
Maav 24,244,68
s_add_u32 s3, s5, 514048
VE 15,199
Maav 56,240,72
buffer_load_dwordx4 v25, s[68:71], s3 offen offset:2048 lds
Maav 56,244,76
s_add_u32 s3, s5, 541696
Ra 208,2,53248
Vc 99,14,15
Maav 28,248,64
buffer_load_dwordx4 v25, s[68:71], s3 offen offset:3072 lds
Maav 28,252,68
Ra 212,2,54272
v_or3_b32 v7, v7, v98, v99
Maav 60,248,72
s_waitcnt lgkmcnt(2)
Ra 216,2,55296
Ra 220,2,56320
Ve 8,200
Ve 9,201
Ve 10,202
Ve 11,203
Ve 12,204
Ve 13,205
Ve 14,206
VE 15,207
Vc 100,8,9
Vc 101,10,11
Vc 102,12,13
Vc 103,14,15
v_or3_b32 v7, v7, v100, v101
v_or3_b32 v7, v7, v102, v103
Maav 60,252,76
v_and_b32 v1, 0x40004000, v7
v_cmp_ne_u32 vcc, 0, v1
s_cbranch_vccnz L_k2_fb_fi
L_k2_fbr_fi:
Maav 0,192,96
Ra 224,2,57344
Ra 228,2,58368
Maav 0,196,100
Ra 232,2,59392
Ra 236,2,60416
Maav 4,200,96
Ra 240,2,61440
Ra 244,2,62464
Maav 4,204,100
Ra 248,2,63488
Ra 252,2,64512
Mvvv 48,16,96
s_mov_b32 s60, s8
s_and_b32 s61, s9, 0xffff
s_mov_b32 s62, 7340032
Mvvv 48,16,100
s_waitcnt lgkmcnt(8)
Maav 8,208,96
s_mov_b32 s63, 0x20000
s_mov_b32 s68, s10
s_and_b32 s69, s11, 0xffff
Maav 8,212,100
s_mov_b32 s70, 4194304
s_mov_b32 s71, 0x20000
s_mov_b32 s56, s40
Maav 12,216,96
s_and_b32 s57, s41, 0xffff
s_mov_b32 s58, 4194304
s_mov_b32 s59, 0x20000
Maav 12,220,100
s_waitcnt lgkmcnt(4)
Maav 16,224,96
s_bfe_u32 s6, s2, 0x20001
s_lshr_b32 s7, s34, 1
s_lshl_b32 s45, s7, 2
Maav 16,228,100
s_add_u32 s46, s45, s6
s_sub_u32 s46, 15, s46
s_sub_u32 s45, 12, s45
Maav 20,232,96
s_add_u32 s45, s45, s6
s_cmp_lt_u32 s7, 2
s_cselect_b32 s45, s46, s45
Maav 20,236,100
s_waitcnt lgkmcnt(0)
Maav 24,240,96
s_and_b32 s46, s2, 1
s_bfe_u32 s6, s2, 0x30003
s_lshl_b32 s6, s6, 1
Maav 24,244,100
s_add_u32 s46, s46, s6
s_mov_b32 s48, 0
s_mov_b32 s49, 15360
Maav 28,248,96
s_mov_b32 s50, 30720
s_mov_b32 s51, 46080
s_lshl_b32 s35, s32, 13
Maav 28,252,100
s_add_u32 s35, s35, 131072
s_and_b32 s52, s46, 1
s_lshl_b32 s6, s45, 20
s_lshl_b32 s7, s52, 19
s_add_u32 s6, s6, s7
s_add_u32 s6, s6, 46137344
s_add_u32 s8, s66, s6
s_addc_u32 s9, s67, 0
s_and_b32 s9, s9, 0xffff
s_mov_b32 s10, 524288
s_mov_b32 s11, 0x20000
s_lshr_b32 s7, s46, 1
s_lshl_b32 s7, s7, 8
s_lshl_b32 s6, s52, 22
s_add_u32 s6, s6, s7
s_add_u32 s12, s94, s6
s_addc_u32 s13, s95, 0
s_and_b32 s13, s13, 0xffff
s_mov_b32 s14, 0
s_mov_b32 s15, 0x20000
s_sub_u32 s14, 4194304, s7
s_mov_b32 s28, s94
s_and_b32 s29, s95, 0xffff
s_mov_b32 s30, 8388608
s_mov_b32 s31, 0x20000
s_lshl_b32 s7, s46, 7
s_lshl_b32 s36, s45, 18
s_add_u32 s36, s36, s7
s_and_b32 s94, s7, 128
s_lshl_b32 s38, s45, 7
s_lshl_b32 s6, s52, 6
s_add_u32 s38, s38, s6
s_add_u32 s38, s38, 5300224
s_lshl_b32 s52, s32, 11
v_lshlrev_b32 v112, 4, v0
v_lshrrev_b32 v121, 4, v0
v_and_b32 v122, 7, v0
v_lshrrev_b32 v123, 3, v0
v_lshlrev_b32 v124, 1, v121
v_xor_b32 v124, v124, v122
v_lshlrev_b32_e64 v124, 4, v124
v_lshl_add_u32 v113, v123, 11, v124
s_and_b32 s6, s32, 1
s_lshl_b32 s6, s6, 16
s_lshr_b32 s7, s32, 1
s_lshl_b32 s7, s7, 7
s_xor_b32 s7, s7, s94
s_xor_b32 s7, s7, 128
s_add_u32 s6, s6, s7
v_add_u32 v114, s6, v113
v_lshrrev_b32 v124, 2, v0
v_bfe_u32 v126, v0, 3, 2
v_lshlrev_b32 v124, 7, v124
v_and_b32 v125, 3, v0
v_lshl_add_u32 v124, v125, 3, v124
v_lshl_add_u32 v115, v126, 5, v124
v_xor_b32 v116, 32, v115
v_xor_b32 v117, 64, v115
v_xor_b32 v118, 96, v115
s_lshl_b32 s6, s32, 5
v_add_u32 v120, s6, v123
v_lshlrev_b32_e64 v119, 11, v120
v_lshl_add_u32 v119, v122, 4, v119
v_mov_b32 v126, 0
v_lshlrev_b32 v127, 2, v122
s_nop 7
s_lshl_b32 s3, s55, 20
s_lshl_b32 s47, s33, 15
s_add_u32 s3, s3, s47
s_lshl_b32 s47, s32, 10
v_lshlrev_b32 v248, 4, v0
v_add_u32_e64 v249, s47, v248
s_sub_u32 s47, 7168, s47
v_add_u32 v248, s47, v248
v_rcp_f32 v250, v48
v_rcp_f32 v252, v52
v_mov_b32 v251, v250
v_mov_b32_e64 v253, v252
Ar 240,32
Ar 241,33
Ar 242,34
Ar 243,35
Ar 244,36
Ar 245,37
Ar 246,38
Ar 247,39
v_pk_mul_f32 v[240:241], v[240:241], v[252:253]
v_pk_mul_f32 v[242:243], v[242:243], v[252:253]
v_pk_mul_f32 v[244:245], v[244:245], v[252:253]
v_pk_mul_f32 v[246:247], v[246:247], v[252:253]
Vc 28,240,241
Vc 29,242,243
Vc 30,244,245
Vc 31,246,247
buffer_store_dwordx4 v[28:31], v249, s[16:19], s3 offen sc1
Ar 240,0
Ar 241,1
Ar 242,2
Ar 243,3
Ar 244,4
Ar 245,5
Ar 246,6
Ar 247,7
v_pk_mul_f32 v[240:241], v[240:241], v[250:251]
v_pk_mul_f32 v[242:243], v[242:243], v[250:251]
v_pk_mul_f32 v[244:245], v[244:245], v[250:251]
v_pk_mul_f32 v[246:247], v[246:247], v[250:251]
Vc 24,240,241
Vc 25,242,243
Vc 26,244,245
Vc 27,246,247
buffer_store_dwordx4 v[24:27], v248, s[16:19], s3 offen sc1
s_add_u32 s3, s3, 8192
Ar 240,40
Ar 241,41
Ar 242,42
Ar 243,43
Ar 244,44
Ar 245,45
Ar 246,46
Ar 247,47
v_pk_mul_f32 v[240:241], v[240:241], v[252:253]
v_pk_mul_f32 v[242:243], v[242:243], v[252:253]
v_pk_mul_f32 v[244:245], v[244:245], v[252:253]
v_pk_mul_f32 v[246:247], v[246:247], v[252:253]
Vc 28,240,241
Vc 29,242,243
Vc 30,244,245
Vc 31,246,247
buffer_store_dwordx4 v[28:31], v249, s[16:19], s3 offen sc1
Ar 240,8
Ar 241,9
Ar 242,10
Ar 243,11
Ar 244,12
Ar 245,13
Ar 246,14
Ar 247,15
v_pk_mul_f32 v[240:241], v[240:241], v[250:251]
v_pk_mul_f32 v[242:243], v[242:243], v[250:251]
v_pk_mul_f32 v[244:245], v[244:245], v[250:251]
v_pk_mul_f32 v[246:247], v[246:247], v[250:251]
Vc 24,240,241
Vc 25,242,243
Vc 26,244,245
Vc 27,246,247
buffer_store_dwordx4 v[24:27], v248, s[16:19], s3 offen sc1
s_add_u32 s3, s3, 8192
Ar 240,48
Ar 241,49
Ar 242,50
Ar 243,51
Ar 244,52
Ar 245,53
Ar 246,54
Ar 247,55
v_pk_mul_f32 v[240:241], v[240:241], v[252:253]
v_pk_mul_f32 v[242:243], v[242:243], v[252:253]
v_pk_mul_f32 v[244:245], v[244:245], v[252:253]
v_pk_mul_f32 v[246:247], v[246:247], v[252:253]
Vc 28,240,241
Vc 29,242,243
Vc 30,244,245
Vc 31,246,247
buffer_store_dwordx4 v[28:31], v249, s[16:19], s3 offen sc1
Ar 240,16
Ar 241,17
Ar 242,18
Ar 243,19
Ar 244,20
Ar 245,21
Ar 246,22
Ar 247,23
v_pk_mul_f32 v[240:241], v[240:241], v[250:251]
v_pk_mul_f32 v[242:243], v[242:243], v[250:251]
v_pk_mul_f32 v[244:245], v[244:245], v[250:251]
v_pk_mul_f32 v[246:247], v[246:247], v[250:251]
Vc 24,240,241
Vc 25,242,243
Vc 26,244,245
Vc 27,246,247
buffer_store_dwordx4 v[24:27], v248, s[16:19], s3 offen sc1
s_add_u32 s3, s3, 8192
Ar 240,56
Ar 241,57
Ar 242,58
Ar 243,59
Ar 244,60
Ar 245,61
Ar 246,62
Ar 247,63
v_pk_mul_f32 v[240:241], v[240:241], v[252:253]
v_pk_mul_f32 v[242:243], v[242:243], v[252:253]
v_pk_mul_f32 v[244:245], v[244:245], v[252:253]
v_pk_mul_f32 v[246:247], v[246:247], v[252:253]
Vc 28,240,241
Vc 29,242,243
Vc 30,244,245
Vc 31,246,247
buffer_store_dwordx4 v[28:31], v249, s[16:19], s3 offen sc1
Ar 240,24
Ar 241,25
Ar 242,26
Ar 243,27
Ar 244,28
Ar 245,29
Ar 246,30
Ar 247,31
v_pk_mul_f32 v[240:241], v[240:241], v[250:251]
v_pk_mul_f32 v[242:243], v[242:243], v[250:251]
v_pk_mul_f32 v[244:245], v[244:245], v[250:251]
v_pk_mul_f32 v[246:247], v[246:247], v[250:251]
Vc 24,240,241
Vc 25,242,243
Vc 26,244,245
Vc 27,246,247
buffer_store_dwordx4 v[24:27], v248, s[16:19], s3 offen sc1
s_cmp_ge_u32 s93, 224
s_cbranch_scc1 L_noffn
v_lshrrev_b32 v24, 4, v0
v_bfe_u32 v25, v0, 2, 2
v_lshl_add_u32 v26, v24, 3, v25
v_lshlrev_b32 v26, 8, v26
v_and_b32 v27, 3, v0
v_lshl_add_u32 v26, v27, 3, v26
v_and_b32_e64 v27, 1, v24
v_lshl_add_u32 v25, v27, 2, v25
s_lshl_b32 s3, s32, 1
v_xor_b32 v25, s3, v25
v_lshl_add_u32 v26, v25, 5, v26
s_sub_u32 s3, s54, s44
v_add_u32 v26, s3, v26
v_xor_b32 v27, 32, v26
s_waitcnt vmcnt(8) lgkmcnt(0)
s_barrier
s_nop 0
ds_read_b64_tr_b16 v[128:129], v26 offset:0
ds_read_b64_tr_b16 v[130:131], v26 offset:1024
ds_read_b64_tr_b16 v[132:133], v27 offset:0
ds_read_b64_tr_b16 v[134:135], v27 offset:1024
ds_read_b64_tr_b16 v[136:137], v26 offset:8192
ds_read_b64_tr_b16 v[138:139], v26 offset:9216
ds_read_b64_tr_b16 v[140:141], v27 offset:8192
ds_read_b64_tr_b16 v[142:143], v27 offset:9216
ds_read_b64_tr_b16 v[144:145], v26 offset:16384
ds_read_b64_tr_b16 v[146:147], v26 offset:17408
ds_read_b64_tr_b16 v[148:149], v27 offset:16384
ds_read_b64_tr_b16 v[150:151], v27 offset:17408
ds_read_b64_tr_b16 v[152:153], v26 offset:24576
ds_read_b64_tr_b16 v[154:155], v26 offset:25600
ds_read_b64_tr_b16 v[156:157], v27 offset:24576
s_waitcnt lgkmcnt(9)
s_nop 0
ds_read_b64_tr_b16 v[158:159], v27 offset:25600
ds_read_b64_tr_b16 v[160:161], v26 offset:32768
ds_read_b64_tr_b16 v[162:163], v26 offset:33792
ds_read_b64_tr_b16 v[164:165], v27 offset:32768
ds_read_b64_tr_b16 v[166:167], v27 offset:33792
ds_read_b64_tr_b16 v[168:169], v26 offset:40960
s_waitcnt lgkmcnt(9)
s_nop 0
ds_read_b64_tr_b16 v[170:171], v26 offset:41984
ds_read_b64_tr_b16 v[172:173], v27 offset:40960
ds_read_b64_tr_b16 v[174:175], v27 offset:41984
ds_read_b64_tr_b16 v[176:177], v26 offset:49152
ds_read_b64_tr_b16 v[178:179], v26 offset:50176
ds_read_b64_tr_b16 v[180:181], v27 offset:49152
s_waitcnt lgkmcnt(9)
ds_read_b64_tr_b16 v[182:183], v27 offset:50176
ds_read_b64_tr_b16 v[184:185], v26 offset:57344
ds_read_b64_tr_b16 v[186:187], v26 offset:58368
ds_read_b64_tr_b16 v[188:189], v27 offset:57344
ds_read_b64_tr_b16 v[190:191], v27 offset:58368
v_and_b32 v25, 15, v0
v_mul_u32_u24 v28, 14336, v25
v_lshl_add_u32 v28, v24, 4, v28
v_mov_b32 v29, 2146435072
v_cmp_gt_u32 vcc, 2, v25
s_mul_i32 s3, s92, 57344
s_lshl_b32 s47, s4, 9
s_add_u32 s3, s3, s47
v_cndmask_b32 v28, v29, v28, vcc
s_lshl_b32 s47, s32, 7
s_add_u32 s3, s3, s47
s_add_u32 s3, s3, 6291456
Zvva 224,128,160
Zvva 228,132,160
Mvva 224,136,164
Mvva 228,140,164
Mvva 224,144,168
Mvva 228,148,168
Mvva 224,152,172
Mvva 228,156,172
s_waitcnt lgkmcnt(0)
Zvva 232,160,160
Zvva 236,164,160
Mvva 232,168,164
Mvva 236,172,164
Mvva 232,176,168
Mvva 236,180,168
Mvva 232,184,172
Mvva 236,188,172
L_noffn:
v_mov_b32 v24, 1
v_mul_u32_u24 v25, s65, v0
s_waitcnt vmcnt(0)
s_barrier
s_mov_b64 exec, 3
buffer_store_dword v24, v25, s[20:23], s64 offen sc1
s_mov_b64 exec, -1
s_nop 0
s_cmp_lt_u32 s93, 224
s_cselect_b32 s3, s3, 8388608
s_add_u32 s7, s3, 28672
buffer_store_dwordx4 v[224:227], v28, s[20:23], s3 offen offset:0 sc1
buffer_store_dwordx4 v[228:231], v28, s[20:23], s3 offen offset:64 sc1
buffer_store_dwordx4 v[232:235], v28, s[20:23], s7 offen offset:0 sc1
buffer_store_dwordx4 v[236:239], v28, s[20:23], s7 offen offset:64 sc1
s_mov_b32 s3, s36
s_nop 0
buffer_load_dwordx4 v[18:21], v119, s[56:59], s3 offen
s_add_u32 s3, s3, 16384
buffer_load_dwordx4 v[22:25], v119, s[56:59], s3 offen
s_add_u32 s3, s3, 16384
buffer_load_dwordx4 v[26:29], v119, s[56:59], s3 offen
s_add_u32 s3, s3, 16384
buffer_load_dwordx4 v[30:33], v119, s[56:59], s3 offen
s_lshl_b32 s3, s45, 10
s_add_u32 s3, s3, 5259264
v_lshlrev_b32 v124, 3, v120
buffer_load_dwordx2 v[34:35], v124, s[20:23], s3 offen offset:0 sc1
buffer_load_dwordx2 v[36:37], v124, s[20:23], s3 offen offset:64 sc1
buffer_load_dwordx2 v[38:39], v124, s[20:23], s3 offen offset:128 sc1
buffer_load_dwordx2 v[40:41], v124, s[20:23], s3 offen offset:192 sc1
v_and_b32 v10, 15, v0
v_lshlrev_b32 v10, 2, v10
s_add_u32 s95, s32, 32
s_lshl_b32 s95, s95, 16
s_add_u32 s95, s95, s94
s_xor_b32 s95, s95, 128
s_add_u32 m0, s44, 0
s_nop 0
s_nop 0
buffer_load_dwordx4 v114, s[12:15], s48 offen offset:0 lds
buffer_load_dwordx4 v114, s[12:15], s49 offen offset:1024 lds
buffer_load_dwordx4 v114, s[12:15], s50 offen offset:2048 lds
buffer_load_dwordx4 v114, s[12:15], s51 offen offset:3072 lds
v_add_u32 v114, 131072, v114
s_add_u32 m0, s44, 16384
s_nop 0
s_nop 0
buffer_load_dwordx4 v114, s[12:15], s48 offen offset:0 lds
buffer_load_dwordx4 v114, s[12:15], s49 offen offset:1024 lds
buffer_load_dwordx4 v114, s[12:15], s50 offen offset:2048 lds
buffer_load_dwordx4 v114, s[12:15], s51 offen offset:3072 lds
v_add_u32 v114, 131072, v114
buffer_load_dword v124, v10, s[20:23], s38 offen sc1
v_add_u32 v12, 65536, v115
v_add_u32 v13, 65536, v116
v_add_u32 v14, 65536, v117
v_add_u32 v15, 65536, v118
s_and_b32 s39, s93, 15
s_lshr_b32 s37, s93, 4
s_lshl_b32 s54, s37, 2
s_add_u32 s54, s54, s32
s_lshl_b32 s3, s54, 17
s_lshl_b32 s7, s39, 7
s_add_u32 s3, s3, s7
s_cmp_lt_u32 s93, 224
s_cselect_b32 s3, s3, 2146435072
v_add_u32 v125, s3, v113
s_mov_b32 s40, 0
s_waitcnt vmcnt(9)
v_lshlrev_b32_e64 v42, 16, v18
v_and_b32 v43, 0xffff0000, v18
v_lshlrev_b32_e64 v44, 16, v19
v_and_b32 v45, 0xffff0000, v19
v_lshlrev_b32_e64 v46, 16, v20
v_and_b32 v47, 0xffff0000, v20
v_lshlrev_b32_e64 v48, 16, v21
v_and_b32 v49, 0xffff0000, v21
v_pk_add_f32 v[42:43], v[42:43], v[34:35] op_sel_hi:[1,0] neg_lo:[0,1] neg_hi:[0,1]
v_pk_add_f32 v[44:45], v[44:45], v[34:35] op_sel_hi:[1,0] neg_lo:[0,1] neg_hi:[0,1]
v_pk_add_f32 v[46:47], v[46:47], v[34:35] op_sel_hi:[1,0] neg_lo:[0,1] neg_hi:[0,1]
v_pk_add_f32 v[48:49], v[48:49], v[34:35] op_sel_hi:[1,0] neg_lo:[0,1] neg_hi:[0,1]
Vc 2,42,43
v_lshlrev_b32_e64 v42, 16, v2
v_and_b32 v43, 0xffff0000, v2
Vc 3,44,45
v_lshlrev_b32_e64 v44, 16, v3
v_and_b32 v45, 0xffff0000, v3
Vc 4,46,47
v_lshlrev_b32_e64 v46, 16, v4
v_and_b32 v47, 0xffff0000, v4
Vc 5,48,49
v_lshlrev_b32_e64 v48, 16, v5
v_and_b32 v49, 0xffff0000, v5
v_pk_mul_f32 v[42:43], v[42:43], v[34:35] op_sel:[0,1] op_sel_hi:[1,1]
v_pk_mul_f32 v[44:45], v[44:45], v[34:35] op_sel:[0,1] op_sel_hi:[1,1]
v_pk_mul_f32 v[46:47], v[46:47], v[34:35] op_sel:[0,1] op_sel_hi:[1,1]
v_pk_mul_f32 v[48:49], v[48:49], v[34:35] op_sel:[0,1] op_sel_hi:[1,1]
Vc 2,42,43
v_lshlrev_b32_e64 v42, 16, v2
v_and_b32 v43, 0xffff0000, v2
Vc 3,44,45
v_lshlrev_b32_e64 v44, 16, v3
v_and_b32 v45, 0xffff0000, v3
Vc 4,46,47
v_lshlrev_b32_e64 v46, 16, v4
v_and_b32 v47, 0xffff0000, v4
Vc 5,48,49
v_lshlrev_b32_e64 v48, 16, v5
v_and_b32 v49, 0xffff0000, v5
v_mul_f32 v2, 0xbfb8aa3b, v42
v_mul_f32 v3, 0xbfb8aa3b, v43
v_mul_f32 v4, 0xbfb8aa3b, v44
v_mul_f32 v5, 0xbfb8aa3b, v45
v_mul_f32 v6, 0xbfb8aa3b, v46
v_mul_f32 v7, 0xbfb8aa3b, v47
v_mul_f32 v8, 0xbfb8aa3b, v48
v_mul_f32 v9, 0xbfb8aa3b, v49
Ve 2,2
Ve 3,3
Ve 4,4
Ve 5,5
Ve 6,6
Ve 7,7
Ve 8,8
Ve 9,9
v_add_f32 v2, 1.0, v2
v_add_f32 v3, 1.0, v3
v_add_f32 v4, 1.0, v4
v_add_f32 v5, 1.0, v5
v_add_f32 v6, 1.0, v6
v_add_f32 v7, 1.0, v7
v_add_f32 v8, 1.0, v8
v_add_f32 v9, 1.0, v9
v_rcp_f32 v2, v2
v_rcp_f32 v3, v3
v_rcp_f32 v4, v4
v_rcp_f32 v5, v5
v_rcp_f32 v6, v6
v_rcp_f32 v7, v7
v_rcp_f32 v8, v8
v_rcp_f32 v9, v9
v_pk_mul_f32 v[42:43], v[42:43], v[2:3]
v_pk_mul_f32 v[44:45], v[44:45], v[4:5]
v_pk_mul_f32 v[46:47], v[46:47], v[6:7]
v_pk_mul_f32 v[48:49], v[48:49], v[8:9]
Vc 2,42,43
v_lshlrev_b32_e64 v42, 16, v2
v_and_b32 v43, 0xffff0000, v2
Vc 3,44,45
v_lshlrev_b32_e64 v44, 16, v3
v_and_b32 v45, 0xffff0000, v3
Vc 4,46,47
v_lshlrev_b32_e64 v46, 16, v4
v_and_b32 v47, 0xffff0000, v4
Vc 5,48,49
v_lshlrev_b32_e64 v48, 16, v5
v_and_b32 v49, 0xffff0000, v5
s_waitcnt vmcnt(0)
v_cmp_ne_u32 vcc, 1, v124
s_cbranch_vccnz L_spinC
s_nop 0
L_spinCr:
buffer_load_dwordx4 a[0:3], v112, s[8:11], s52 offen offset:0 sc1
buffer_load_dwordx4 a[4:7], v112, s[8:11], s52 offen offset:1024 sc1
s_add_u32 s52, s52, 8192
buffer_load_dwordx4 a[8:11], v112, s[8:11], s52 offen offset:0 sc1
buffer_load_dwordx4 a[12:15], v112, s[8:11], s52 offen offset:1024 sc1
s_add_u32 s52, s52, 8192
buffer_load_dwordx4 a[16:19], v112, s[8:11], s52 offen offset:0 sc1
buffer_load_dwordx4 a[20:23], v112, s[8:11], s52 offen offset:1024 sc1
s_add_u32 s52, s52, 8192
buffer_load_dwordx4 a[24:27], v112, s[8:11], s52 offen offset:0 sc1
buffer_load_dwordx4 a[28:31], v112, s[8:11], s52 offen offset:1024 sc1
s_add_u32 s52, s52, 8192
v_lshlrev_b32_e64 v50, 16, v22
v_and_b32 v51, 0xffff0000, v22
v_lshlrev_b32_e64 v52, 16, v23
v_and_b32 v53, 0xffff0000, v23
v_lshlrev_b32_e64 v54, 16, v24
v_and_b32 v55, 0xffff0000, v24
v_lshlrev_b32_e64 v56, 16, v25
v_and_b32 v57, 0xffff0000, v25
v_pk_add_f32 v[50:51], v[50:51], v[36:37] op_sel_hi:[1,0] neg_lo:[0,1] neg_hi:[0,1]
v_pk_add_f32 v[52:53], v[52:53], v[36:37] op_sel_hi:[1,0] neg_lo:[0,1] neg_hi:[0,1]
v_pk_add_f32 v[54:55], v[54:55], v[36:37] op_sel_hi:[1,0] neg_lo:[0,1] neg_hi:[0,1]
v_pk_add_f32 v[56:57], v[56:57], v[36:37] op_sel_hi:[1,0] neg_lo:[0,1] neg_hi:[0,1]
Vc 2,50,51
v_lshlrev_b32_e64 v50, 16, v2
v_and_b32 v51, 0xffff0000, v2
Vc 3,52,53
v_lshlrev_b32_e64 v52, 16, v3
v_and_b32 v53, 0xffff0000, v3
Vc 4,54,55
v_lshlrev_b32_e64 v54, 16, v4
v_and_b32 v55, 0xffff0000, v4
Vc 5,56,57
v_lshlrev_b32_e64 v56, 16, v5
v_and_b32 v57, 0xffff0000, v5
v_pk_mul_f32 v[50:51], v[50:51], v[36:37] op_sel:[0,1] op_sel_hi:[1,1]
v_pk_mul_f32 v[52:53], v[52:53], v[36:37] op_sel:[0,1] op_sel_hi:[1,1]
v_pk_mul_f32 v[54:55], v[54:55], v[36:37] op_sel:[0,1] op_sel_hi:[1,1]
v_pk_mul_f32 v[56:57], v[56:57], v[36:37] op_sel:[0,1] op_sel_hi:[1,1]
Vc 2,50,51
v_lshlrev_b32_e64 v50, 16, v2
v_and_b32 v51, 0xffff0000, v2
Vc 3,52,53
v_lshlrev_b32_e64 v52, 16, v3
v_and_b32 v53, 0xffff0000, v3
Vc 4,54,55
v_lshlrev_b32_e64 v54, 16, v4
v_and_b32 v55, 0xffff0000, v4
Vc 5,56,57
v_lshlrev_b32_e64 v56, 16, v5
v_and_b32 v57, 0xffff0000, v5
v_mul_f32 v2, 0xbfb8aa3b, v50
v_mul_f32 v3, 0xbfb8aa3b, v51
v_mul_f32 v4, 0xbfb8aa3b, v52
v_mul_f32 v5, 0xbfb8aa3b, v53
v_mul_f32 v6, 0xbfb8aa3b, v54
v_mul_f32 v7, 0xbfb8aa3b, v55
v_mul_f32 v8, 0xbfb8aa3b, v56
v_mul_f32 v9, 0xbfb8aa3b, v57
Ve 2,2
Ve 3,3
Ve 4,4
Ve 5,5
Ve 6,6
Ve 7,7
Ve 8,8
Ve 9,9
v_add_f32 v2, 1.0, v2
v_add_f32 v3, 1.0, v3
v_add_f32 v4, 1.0, v4
v_add_f32 v5, 1.0, v5
v_add_f32 v6, 1.0, v6
v_add_f32 v7, 1.0, v7
v_add_f32 v8, 1.0, v8
v_add_f32 v9, 1.0, v9
v_rcp_f32 v2, v2
v_rcp_f32 v3, v3
v_rcp_f32 v4, v4
v_rcp_f32 v5, v5
v_rcp_f32 v6, v6
v_rcp_f32 v7, v7
v_rcp_f32 v8, v8
v_rcp_f32 v9, v9
v_pk_mul_f32 v[50:51], v[50:51], v[2:3]
v_pk_mul_f32 v[52:53], v[52:53], v[4:5]
v_pk_mul_f32 v[54:55], v[54:55], v[6:7]
v_pk_mul_f32 v[56:57], v[56:57], v[8:9]
Vc 2,50,51
v_lshlrev_b32_e64 v50, 16, v2
v_and_b32 v51, 0xffff0000, v2
Vc 3,52,53
v_lshlrev_b32_e64 v52, 16, v3
v_and_b32 v53, 0xffff0000, v3
Vc 4,54,55
v_lshlrev_b32_e64 v54, 16, v4
v_and_b32 v55, 0xffff0000, v4
Vc 5,56,57
v_lshlrev_b32_e64 v56, 16, v5
v_and_b32 v57, 0xffff0000, v5
buffer_load_dwordx4 a[32:35], v112, s[8:11], s52 offen offset:0 sc1
buffer_load_dwordx4 a[36:39], v112, s[8:11], s52 offen offset:1024 sc1
s_add_u32 s52, s52, 8192
buffer_load_dwordx4 a[40:43], v112, s[8:11], s52 offen offset:0 sc1
buffer_load_dwordx4 a[44:47], v112, s[8:11], s52 offen offset:1024 sc1
s_add_u32 s52, s52, 8192
s_add_u32 m0, s44, 32768
s_nop 0
buffer_load_dwordx4 v114, s[12:15], s48 offen offset:0 lds
buffer_load_dwordx4 v114, s[12:15], s49 offen offset:1024 lds
buffer_load_dwordx4 v114, s[12:15], s50 offen offset:2048 lds
buffer_load_dwordx4 v114, s[12:15], s51 offen offset:3072 lds
v_add_u32 v114, 131072, v114
s_cmp_lg_u32 s40, 0
s_cbranch_scc1 L_nowd
s_add_u32 m0, s35, 0
s_nop 0
s_nop 0
buffer_load_dwordx4 v125, s[60:63], s48 offen offset:0 lds
buffer_load_dwordx4 v125, s[60:63], s49 offen offset:1024 lds
buffer_load_dwordx4 v125, s[60:63], s50 offen offset:2048 lds
buffer_load_dwordx4 v125, s[60:63], s51 offen offset:3072 lds
v_add_u32 v125, 65536, v125
s_add_u32 m0, s35, 4096
s_nop 0
buffer_load_dwordx4 v125, s[60:63], s48 offen offset:0 lds
buffer_load_dwordx4 v125, s[60:63], s49 offen offset:1024 lds
buffer_load_dwordx4 v125, s[60:63], s50 offen offset:2048 lds
buffer_load_dwordx4 v125, s[60:63], s51 offen offset:3072 lds
L_nowd:
s_cmp_lt_u32 s2, 128
s_cbranch_scc1 L_noc3
s_bfe_u32 s3, s2, 0x40003
s_lshl_b32 s3, s3, 2
s_add_u32 s3, s3, s32
s_lshl_b32 s3, s3, 15
s_and_b32 s7, s2, 1
s_lshl_b32 s7, s7, 22
s_add_u32 s3, s3, s7
s_add_u32 s3, s3, 384
v_and_b32 v1, 15, v0
v_lshlrev_b32 v1, 11, v1
v_lshrrev_b32_e64 v11, 5, v0
v_lshl_add_u32 v1, v11, 10, v1
buffer_load_dword v11, v1, s[28:31], s3 offen
L_noc3:
s_barrier
s_nop 0
ds_read_b64_tr_b16 v[192:193], v115 offset:0
ds_read_b64_tr_b16 v[194:195], v115 offset:2048
ds_read_b64_tr_b16 v[196:197], v116 offset:0
ds_read_b64_tr_b16 v[198:199], v116 offset:2048
ds_read_b64_tr_b16 v[200:201], v117 offset:0
ds_read_b64_tr_b16 v[202:203], v117 offset:2048
ds_read_b64_tr_b16 v[204:205], v118 offset:0
ds_read_b64_tr_b16 v[206:207], v118 offset:2048
ds_read_b64_tr_b16 v[208:209], v115 offset:4096
ds_read_b64_tr_b16 v[210:211], v115 offset:6144
ds_read_b64_tr_b16 v[212:213], v116 offset:4096
ds_read_b64_tr_b16 v[214:215], v116 offset:6144
ds_read_b64_tr_b16 v[216:217], v117 offset:4096
ds_read_b64_tr_b16 v[218:219], v117 offset:6144
ds_read_b64_tr_b16 v[220:221], v118 offset:4096
s_waitcnt lgkmcnt(9)
ds_read_b64_tr_b16 v[222:223], v118 offset:6144
s_waitcnt vmcnt(12)
Zvva 160,192,0
ds_read_b64_tr_b16 v[224:225], v115 offset:8192
ds_read_b64_tr_b16 v[226:227], v115 offset:10240
v_mov_b32 v125, 1
s_waitcnt lgkmcnt(8)
Mvva 160,208,8
s_lshl_b32 s6, s4, 3
s_add_u32 s6, s6, s92
s_lshl_b32 s6, s6, 2
Zvva 176,192,4
s_waitcnt lgkmcnt(6)
s_add_u32 m0, s44, 49152
ds_read_b64_tr_b16 v[240:241], v115 offset:12288
ds_read_b64_tr_b16 v[242:243], v115 offset:14336
Mvva 176,208,12
buffer_load_dwordx4 v114, s[12:15], s48 offen offset:0 lds
Zvva 164,196,0
ds_read_b64_tr_b16 v[228:229], v116 offset:8192
ds_read_b64_tr_b16 v[230:231], v116 offset:10240
Mvva 164,212,8
s_add_u32 s6, s6, 5447680
s_cmp_eq_u32 s32, 0
s_cselect_b32 s6, s6, s64
s_cmp_lt_u32 s93, 224
s_cselect_b32 s6, s6, 2146435072
Zvva 180,196,4
s_waitcnt lgkmcnt(8)
ds_read_b64_tr_b16 v[244:245], v116 offset:12288
ds_read_b64_tr_b16 v[246:247], v116 offset:14336
Mvva 180,212,12
buffer_load_dwordx4 v114, s[12:15], s49 offen offset:1024 lds
Zvva 168,200,0
ds_read_b64_tr_b16 v[232:233], v117 offset:8192
ds_read_b64_tr_b16 v[234:235], v117 offset:10240
Mvva 168,216,8
s_mov_b64 exec, 1
buffer_store_dword v125, v126, s[20:23], s6 offen sc1
s_mov_b64 exec, -1
Zvva 184,200,4
s_waitcnt lgkmcnt(10)
ds_read_b64_tr_b16 v[248:249], v117 offset:12288
ds_read_b64_tr_b16 v[250:251], v117 offset:14336
Mvva 184,216,12
buffer_load_dwordx4 v114, s[12:15], s50 offen offset:2048 lds
Zvva 172,204,0
ds_read_b64_tr_b16 v[236:237], v118 offset:8192
ds_read_b64_tr_b16 v[238:239], v118 offset:10240
Mvva 172,220,8
s_waitcnt lgkmcnt(10)
s_lshl_b32 s40, s45, 2
s_add_u32 s40, s40, s32
s_lshr_b32 s3, s42, 5
s_lshr_b32 s47, s43, 5
s_cmp_eq_u32 s3, s40
s_cselect_b32 s53, 1, 0
s_cmp_eq_u32 s47, s40
s_cselect_b32 s53, 1, s53
s_mov_b32 s40, 0
Zvva 188,204,4
s_barrier
ds_read_b64_tr_b16 v[252:253], v118 offset:12288
ds_read_b64_tr_b16 v[254:255], v118 offset:14336
Mvva 188,220,12
buffer_load_dwordx4 v114, s[12:15], s51 offen offset:3072 lds
v_add_u32 v114, 131072, v114
Zvva 128,224,0
ds_read_b64_tr_b16 v[192:193], v115 offset:16384
ds_read_b64_tr_b16 v[194:195], v115 offset:18432
Mvva 128,240,8
s_lshl_b32 s41, s46, 7
s_add_u32 s41, s41, 5449728
s_lshl_b32 s55, s46, 13
Zvva 144,224,4
s_waitcnt lgkmcnt(10)
ds_read_b64_tr_b16 v[208:209], v115 offset:20480
ds_read_b64_tr_b16 v[210:211], v115 offset:22528
Mvva 144,240,12
buffer_load_dwordx4 a[48:51], v112, s[8:11], s52 offen offset:0 sc1
Zvva 132,228,0
ds_read_b64_tr_b16 v[196:197], v116 offset:16384
ds_read_b64_tr_b16 v[198:199], v116 offset:18432
Mvva 132,244,8
s_add_u32 s55, s55, 5308416
s_add_u32 s16, s66, 88080384
s_addc_u32 s17, s67, 0
s_and_b32 s17, s17, 0xffff
Zvva 148,228,4
s_waitcnt lgkmcnt(10)
ds_read_b64_tr_b16 v[212:213], v116 offset:20480
ds_read_b64_tr_b16 v[214:215], v116 offset:22528
Mvva 148,244,12
buffer_load_dwordx4 a[52:55], v112, s[8:11], s52 offen offset:1024 sc1
s_add_u32 s52, s52, 8192
Zvva 136,232,0
ds_read_b64_tr_b16 v[200:201], v117 offset:16384
ds_read_b64_tr_b16 v[202:203], v117 offset:18432
Mvva 136,248,8
s_mov_b32 s18, 8388608
s_mov_b32 s19, 0x20000
s_lshl_b32 s24, s2, 2
Zvva 152,232,4
s_waitcnt lgkmcnt(10)
ds_read_b64_tr_b16 v[216:217], v117 offset:20480
ds_read_b64_tr_b16 v[218:219], v117 offset:22528
Mvva 152,248,12
buffer_load_dwordx4 a[56:59], v112, s[8:11], s52 offen offset:0 sc1
Zvva 140,236,0
ds_read_b64_tr_b16 v[204:205], v118 offset:16384
ds_read_b64_tr_b16 v[206:207], v118 offset:18432
Mvva 140,252,8
s_add_u32 s24, s24, s32
s_lshl_b32 s25, s24, 13
s_xor_b32 s26, s25, 32768
Zvva 156,236,4
s_waitcnt lgkmcnt(10)
ds_read_b64_tr_b16 v[220:221], v118 offset:20480
ds_read_b64_tr_b16 v[222:223], v118 offset:22528
Mvva 156,252,12
buffer_load_dwordx4 a[60:63], v112, s[8:11], s52 offen offset:1024 sc1
s_add_u32 s52, s52, 8192
s_waitcnt vmcnt(17)
Mvva 160,192,16
ds_read_b64_tr_b16 v[224:225], v115 offset:24576
ds_read_b64_tr_b16 v[226:227], v115 offset:26624
Mvva 160,208,24
s_lshl_b32 s24, s24, 2
s_xor_b32 s27, s24, 16
s_add_u32 s24, s24, 5452800
Mvva 176,192,20
s_waitcnt lgkmcnt(10)
s_add_u32 m0, s44, 65536
ds_read_b64_tr_b16 v[240:241], v115 offset:28672
ds_read_b64_tr_b16 v[242:243], v115 offset:30720
Mvva 176,208,28
buffer_load_dwordx4 v114, s[12:15], s48 offen offset:0 lds
Mvva 164,196,16
ds_read_b64_tr_b16 v[228:229], v116 offset:24576
ds_read_b64_tr_b16 v[230:231], v116 offset:26624
Mvva 164,212,24
s_add_u32 s27, s27, 5452800
v_lshlrev_b32 v58, 16, v26
v_and_b32 v59, 0xffff0000, v26
v_lshlrev_b32_e64 v60, 16, v27
v_and_b32 v61, 0xffff0000, v27
v_lshlrev_b32_e64 v62, 16, v28
Mvva 180,196,20
s_waitcnt lgkmcnt(10)
ds_read_b64_tr_b16 v[244:245], v116 offset:28672
ds_read_b64_tr_b16 v[246:247], v116 offset:30720
v_and_b32 v63, 0xffff0000, v28
Mvva 180,212,28
buffer_load_dwordx4 v114, s[12:15], s49 offen offset:1024 lds
Mvva 168,200,16
ds_read_b64_tr_b16 v[232:233], v117 offset:24576
ds_read_b64_tr_b16 v[234:235], v117 offset:26624
v_lshlrev_b32 v64, 16, v29
Mvva 168,216,24
v_and_b32 v65, 0xffff0000, v29
Vs 58,58,38
Vs 59,59,38
Vs 60,60,38
Vs 61,61,38
Mvva 184,200,20
s_waitcnt lgkmcnt(10)
ds_read_b64_tr_b16 v[248:249], v117 offset:28672
ds_read_b64_tr_b16 v[250:251], v117 offset:30720
Vs 62,62,38
Mvva 184,216,28
buffer_load_dwordx4 v114, s[12:15], s50 offen offset:2048 lds
Mvva 172,204,16
s_waitcnt vmcnt(12)
ds_read_b64_tr_b16 v[236:237], v118 offset:24576
ds_read_b64_tr_b16 v[238:239], v118 offset:26624
Vs 63,63,38
Mvva 172,220,24
s_waitcnt lgkmcnt(10)
Vs 64,64,38
v_sub_f32_e64 v65, v65, v38
Vc 2,58,59
v_lshlrev_b32_e64 v58, 16, v2
v_and_b32 v59, 0xffff0000, v2
Mvva 188,204,20
s_barrier
ds_read_b64_tr_b16 v[252:253], v118 offset:28672
ds_read_b64_tr_b16 v[254:255], v118 offset:30720
Vc 3,60,61
Mvva 188,220,28
buffer_load_dwordx4 v114, s[12:15], s51 offen offset:3072 lds
v_add_u32 v114, 131072, v114
Mvva 128,224,16
ds_read_b64_tr_b16 v[192:193], v115 offset:32768
ds_read_b64_tr_b16 v[194:195], v115 offset:34816
v_lshlrev_b32 v60, 16, v3
Mvva 128,240,24
v_and_b32 v61, 0xffff0000, v3
Vc 4,62,63
v_lshlrev_b32_e64 v62, 16, v4
v_and_b32 v63, 0xffff0000, v4
Vc 5,64,65
Mvva 144,224,20
s_waitcnt lgkmcnt(10)
ds_read_b64_tr_b16 v[208:209], v115 offset:36864
ds_read_b64_tr_b16 v[210:211], v115 offset:38912
v_lshlrev_b32 v64, 16, v5
Mvva 144,240,28
buffer_load_dwordx4 a[64:67], v112, s[8:11], s52 offen offset:0 sc1
Mvva 132,228,16
ds_read_b64_tr_b16 v[196:197], v116 offset:32768
ds_read_b64_tr_b16 v[198:199], v116 offset:34816
v_and_b32 v65, 0xffff0000, v5
Mvva 132,244,24
Vm 58,58,39
Vm 59,59,39
Vm 60,60,39
Vm 61,61,39
v_mul_f32_e64 v62, v62, v39
Mvva 148,228,20
s_waitcnt lgkmcnt(10)
ds_read_b64_tr_b16 v[212:213], v116 offset:36864
ds_read_b64_tr_b16 v[214:215], v116 offset:38912
Vm 63,63,39
Mvva 148,244,28
buffer_load_dwordx4 a[68:71], v112, s[8:11], s52 offen offset:1024 sc1
s_add_u32 s52, s52, 8192
Mvva 136,232,16
ds_read_b64_tr_b16 v[200:201], v117 offset:32768
ds_read_b64_tr_b16 v[202:203], v117 offset:34816
v_mul_f32_e64 v64, v64, v39
Mvva 136,248,24
v_mul_f32_e64 v65, v65, v39
Vc 2,58,59
v_lshlrev_b32_e64 v58, 16, v2
v_and_b32 v59, 0xffff0000, v2
Vc 3,60,61
Mvva 152,232,20
s_waitcnt lgkmcnt(10)
ds_read_b64_tr_b16 v[216:217], v117 offset:36864
ds_read_b64_tr_b16 v[218:219], v117 offset:38912
v_lshlrev_b32 v60, 16, v3
Mvva 152,248,28
buffer_load_dwordx4 a[72:75], v112, s[8:11], s52 offen offset:0 sc1
Mvva 140,236,16
ds_read_b64_tr_b16 v[204:205], v118 offset:32768
ds_read_b64_tr_b16 v[206:207], v118 offset:34816
v_and_b32 v61, 0xffff0000, v3
Mvva 140,252,24
Vc 4,62,63
v_lshlrev_b32_e64 v62, 16, v4
v_and_b32 v63, 0xffff0000, v4
Vc 5,64,65
v_lshlrev_b32_e64 v64, 16, v5
Mvva 156,236,20
s_waitcnt lgkmcnt(10)
ds_read_b64_tr_b16 v[220:221], v118 offset:36864
ds_read_b64_tr_b16 v[222:223], v118 offset:38912
v_and_b32 v65, 0xffff0000, v5
Mvva 156,252,28
buffer_load_dwordx4 a[76:79], v112, s[8:11], s52 offen offset:1024 sc1
s_add_u32 s52, s52, 8192
Mvva 160,192,32
ds_read_b64_tr_b16 v[224:225], v115 offset:40960
ds_read_b64_tr_b16 v[226:227], v115 offset:43008
v_mul_f32 v2, 0xbfb8aa3b, v58
Mvva 160,208,40
v_mul_f32 v3, 0xbfb8aa3b, v59
v_mul_f32 v4, 0xbfb8aa3b, v60
v_mul_f32 v5, 0xbfb8aa3b, v61
v_mul_f32 v6, 0xbfb8aa3b, v62
v_mul_f32 v7, 0xbfb8aa3b, v63
Mvva 176,192,36
s_waitcnt lgkmcnt(10)
s_add_u32 m0, s44, 81920
ds_read_b64_tr_b16 v[240:241], v115 offset:45056
ds_read_b64_tr_b16 v[242:243], v115 offset:47104
v_mul_f32 v8, 0xbfb8aa3b, v64
Mvva 176,208,44
buffer_load_dwordx4 v114, s[12:15], s48 offen offset:0 lds
Mvva 164,196,32
ds_read_b64_tr_b16 v[228:229], v116 offset:40960
ds_read_b64_tr_b16 v[230:231], v116 offset:43008
v_mul_f32 v9, 0xbfb8aa3b, v65
Mvva 164,212,40
Ve 2,2
Ve 3,3
Mvva 180,196,36
s_waitcnt lgkmcnt(10)
ds_read_b64_tr_b16 v[244:245], v116 offset:45056
ds_read_b64_tr_b16 v[246:247], v116 offset:47104
Mvva 180,212,44
buffer_load_dwordx4 v114, s[12:15], s49 offen offset:1024 lds
Mvva 168,200,32
ds_read_b64_tr_b16 v[232:233], v117 offset:40960
ds_read_b64_tr_b16 v[234:235], v117 offset:43008
Mvva 168,216,40
Ve 4,4
VE 5,5
Mvva 184,200,36
s_waitcnt lgkmcnt(10)
ds_read_b64_tr_b16 v[248:249], v117 offset:45056
ds_read_b64_tr_b16 v[250:251], v117 offset:47104
Mvva 184,216,44
buffer_load_dwordx4 v114, s[12:15], s50 offen offset:2048 lds
Mvva 172,204,32
s_waitcnt vmcnt(15)
ds_read_b64_tr_b16 v[236:237], v118 offset:40960
ds_read_b64_tr_b16 v[238:239], v118 offset:43008
Mvva 172,220,40
s_waitcnt lgkmcnt(10)
Ve 6,6
VE 7,7
Mvva 188,204,36
s_barrier
ds_read_b64_tr_b16 v[252:253], v118 offset:45056
ds_read_b64_tr_b16 v[254:255], v118 offset:47104
Mvva 188,220,44
buffer_load_dwordx4 v114, s[12:15], s51 offen offset:3072 lds
v_add_u32 v114, 131072, v114
Mvva 128,224,32
ds_read_b64_tr_b16 v[192:193], v115 offset:49152
ds_read_b64_tr_b16 v[194:195], v115 offset:51200
Mvva 128,240,40
Ve 8,8
Ve 9,9
v_add_f32 v2, 1.0, v2
Mvva 144,224,36
s_waitcnt lgkmcnt(10)
ds_read_b64_tr_b16 v[208:209], v115 offset:53248
ds_read_b64_tr_b16 v[210:211], v115 offset:55296
v_add_f32 v3, 1.0, v3
Mvva 144,240,44
buffer_load_dwordx4 a[80:83], v112, s[8:11], s52 offen offset:0 sc1
Mvva 132,228,32
ds_read_b64_tr_b16 v[196:197], v116 offset:49152
ds_read_b64_tr_b16 v[198:199], v116 offset:51200
v_add_f32_e64 v4, 1.0, v4
Mvva 132,244,40
v_add_f32 v5, 1.0, v5
v_add_f32 v6, 1.0, v6
v_add_f32 v7, 1.0, v7
v_add_f32 v8, 1.0, v8
v_add_f32_e64 v9, 1.0, v9
Mvva 148,228,36
s_waitcnt lgkmcnt(10)
ds_read_b64_tr_b16 v[212:213], v116 offset:53248
ds_read_b64_tr_b16 v[214:215], v116 offset:55296
Mvva 148,244,44
buffer_load_dwordx4 a[84:87], v112, s[8:11], s52 offen offset:1024 sc1
s_add_u32 s52, s52, 8192
Mvva 136,232,32
ds_read_b64_tr_b16 v[200:201], v117 offset:49152
ds_read_b64_tr_b16 v[202:203], v117 offset:51200
Mvva 136,248,40
v_rcp_f32 v2, v2
v_rcp_f32_e64 v3, v3
Mvva 152,232,36
s_waitcnt lgkmcnt(10)
ds_read_b64_tr_b16 v[216:217], v117 offset:53248
ds_read_b64_tr_b16 v[218:219], v117 offset:55296
Mvva 152,248,44
buffer_load_dwordx4 a[88:91], v112, s[8:11], s52 offen offset:0 sc1
Mvva 140,236,32
ds_read_b64_tr_b16 v[204:205], v118 offset:49152
ds_read_b64_tr_b16 v[206:207], v118 offset:51200
Mvva 140,252,40
v_rcp_f32 v4, v4
v_rcp_f32_e64 v5, v5
Mvva 156,236,36
s_waitcnt lgkmcnt(10)
ds_read_b64_tr_b16 v[220:221], v118 offset:53248
ds_read_b64_tr_b16 v[222:223], v118 offset:55296
Mvva 156,252,44
buffer_load_dwordx4 a[92:95], v112, s[8:11], s52 offen offset:1024 sc1
s_add_u32 s52, s52, 8192
s_waitcnt vmcnt(16)
Mvva 160,192,48
ds_read_b64_tr_b16 v[224:225], v115 offset:57344
ds_read_b64_tr_b16 v[226:227], v115 offset:59392
Mvva 160,208,56
v_rcp_f32 v6, v6
v_rcp_f32 v7, v7
Mvva 176,192,52
s_waitcnt lgkmcnt(10)
s_add_u32 m0, s44, 98304
ds_read_b64_tr_b16 v[240:241], v115 offset:61440
ds_read_b64_tr_b16 v[242:243], v115 offset:63488
Mvva 176,208,60
buffer_load_dwordx4 v114, s[12:15], s48 offen offset:0 lds
Mvva 164,196,48
ds_read_b64_tr_b16 v[228:229], v116 offset:57344
ds_read_b64_tr_b16 v[230:231], v116 offset:59392
Mvva 164,212,56
v_rcp_f32 v8, v8
v_rcp_f32 v9, v9
Vm 58,58,2
Mvva 180,196,52
s_waitcnt lgkmcnt(10)
ds_read_b64_tr_b16 v[244:245], v116 offset:61440
ds_read_b64_tr_b16 v[246:247], v116 offset:63488
Vm 59,59,3
Mvva 180,212,60
buffer_load_dwordx4 v114, s[12:15], s49 offen offset:1024 lds
Mvva 168,200,48
ds_read_b64_tr_b16 v[232:233], v117 offset:57344
ds_read_b64_tr_b16 v[234:235], v117 offset:59392
v_mul_f32_e64 v60, v60, v4
Mvva 168,216,56
Vm 61,61,5
Vm 62,62,6
Vm 63,63,7
Vm 64,64,8
v_mul_f32_e64 v65, v65, v9
Mvva 184,200,52
s_waitcnt lgkmcnt(10)
ds_read_b64_tr_b16 v[248:249], v117 offset:61440
ds_read_b64_tr_b16 v[250:251], v117 offset:63488
Vc 2,58,59
Mvva 184,216,60
buffer_load_dwordx4 v114, s[12:15], s50 offen offset:2048 lds
Mvva 172,204,48
s_waitcnt vmcnt(15)
ds_read_b64_tr_b16 v[236:237], v118 offset:57344
ds_read_b64_tr_b16 v[238:239], v118 offset:59392
v_lshlrev_b32_e64 v58, 16, v2
Mvva 172,220,56
s_waitcnt lgkmcnt(10)
v_and_b32 v59, 0xffff0000, v2
Vc 3,60,61
v_lshlrev_b32 v60, 16, v3
v_and_b32 v61, 0xffff0000, v3
Vc 4,62,63
Mvva 188,204,52
s_barrier
ds_read_b64_tr_b16 v[252:253], v118 offset:61440
ds_read_b64_tr_b16 v[254:255], v118 offset:63488
v_lshlrev_b32 v62, 16, v4
Mvva 188,220,60
buffer_load_dwordx4 v114, s[12:15], s51 offen offset:3072 lds
v_add_u32 v114, 131072, v114
Mvva 128,224,48
ds_read_b64_tr_b16 v[192:193], v12 offset:0
ds_read_b64_tr_b16 v[194:195], v12 offset:2048
v_and_b32 v63, 0xffff0000, v4
Mvva 128,240,56
Vc 5,64,65
v_lshlrev_b32_e64 v64, 16, v5
v_and_b32 v65, 0xffff0000, v5
v_lshlrev_b32_e64 v66, 16, v30
v_and_b32 v67, 0xffff0000, v30
Mvva 144,224,52
s_waitcnt lgkmcnt(10)
ds_read_b64_tr_b16 v[208:209], v12 offset:4096
ds_read_b64_tr_b16 v[210:211], v12 offset:6144
v_lshlrev_b32 v68, 16, v31
Mvva 144,240,60
buffer_load_dwordx4 a[96:99], v112, s[8:11], s52 offen offset:0 sc1
Mvva 132,228,48
ds_read_b64_tr_b16 v[196:197], v13 offset:0
ds_read_b64_tr_b16 v[198:199], v13 offset:2048
v_and_b32 v69, 0xffff0000, v31
Mvva 132,244,56
v_lshlrev_b32_e64 v70, 16, v32
v_and_b32 v71, 0xffff0000, v32
v_lshlrev_b32_e64 v72, 16, v33
v_and_b32 v73, 0xffff0000, v33
v_sub_f32_e64 v66, v66, v40
Mvva 148,228,52
s_waitcnt lgkmcnt(10)
ds_read_b64_tr_b16 v[212:213], v13 offset:4096
ds_read_b64_tr_b16 v[214:215], v13 offset:6144
Vs 67,67,40
Mvva 148,244,60
buffer_load_dwordx4 a[100:103], v112, s[8:11], s52 offen offset:1024 sc1
s_add_u32 s52, s52, 8192
Mvva 136,232,48
ds_read_b64_tr_b16 v[200:201], v14 offset:0
ds_read_b64_tr_b16 v[202:203], v14 offset:2048
v_sub_f32_e64 v68, v68, v40
Mvva 136,248,56
Vs 69,69,40
Vs 70,70,40
Vs 71,71,40
Vs 72,72,40
v_sub_f32_e64 v73, v73, v40
Mvva 152,232,52
s_waitcnt lgkmcnt(10)
ds_read_b64_tr_b16 v[216:217], v14 offset:4096
ds_read_b64_tr_b16 v[218:219], v14 offset:6144
Vc 2,66,67
Mvva 152,248,60
buffer_load_dwordx4 a[104:107], v112, s[8:11], s52 offen offset:0 sc1
Mvva 140,236,48
ds_read_b64_tr_b16 v[204:205], v15 offset:0
ds_read_b64_tr_b16 v[206:207], v15 offset:2048
v_lshlrev_b32 v66, 16, v2
Mvva 140,252,56
v_and_b32 v67, 0xffff0000, v2
Vc 3,68,69
v_lshlrev_b32_e64 v68, 16, v3
v_and_b32 v69, 0xffff0000, v3
Vc 4,70,71
Mvva 156,236,52
s_waitcnt lgkmcnt(10)
ds_read_b64_tr_b16 v[220:221], v15 offset:4096
ds_read_b64_tr_b16 v[222:223], v15 offset:6144
v_lshlrev_b32 v70, 16, v4
Mvva 156,252,60
buffer_load_dwordx4 a[108:111], v112, s[8:11], s52 offen offset:1024 sc1
s_add_u32 s52, s52, 8192
s_waitcnt vmcnt(16)
Mvva 160,192,64
ds_read_b64_tr_b16 v[224:225], v12 offset:8192
ds_read_b64_tr_b16 v[226:227], v12 offset:10240
v_and_b32 v71, 0xffff0000, v4
Mvva 160,208,72
s_cmp_lt_u32 s93, 224
s_cbranch_scc1 L_f2A
L_f2Ar:
Mvva 176,192,68
s_waitcnt lgkmcnt(10)
s_add_u32 m0, s44, 114688
ds_read_b64_tr_b16 v[240:241], v12 offset:12288
ds_read_b64_tr_b16 v[242:243], v12 offset:14336
Vc 5,72,73
Mvva 176,208,76
buffer_load_dwordx4 v114, s[12:15], s48 offen offset:0 lds
Mvva 164,196,64
ds_read_b64_tr_b16 v[228:229], v13 offset:8192
ds_read_b64_tr_b16 v[230:231], v13 offset:10240
v_lshlrev_b32 v72, 16, v5
Mvva 164,212,72
v_and_b32 v73, 0xffff0000, v5
Vm 66,66,41
Vm 67,67,41
Vm 68,68,41
Vm 69,69,41
Mvva 180,196,68
s_waitcnt lgkmcnt(10)
ds_read_b64_tr_b16 v[244:245], v13 offset:12288
ds_read_b64_tr_b16 v[246:247], v13 offset:14336
Vm 70,70,41
Mvva 180,212,76
buffer_load_dwordx4 v114, s[12:15], s49 offen offset:1024 lds
Mvva 168,200,64
ds_read_b64_tr_b16 v[232:233], v14 offset:8192
ds_read_b64_tr_b16 v[234:235], v14 offset:10240
v_mul_f32_e64 v71, v71, v41
Mvva 168,216,72
Vm 72,72,41
Vm 73,73,41
Vc 2,66,67
v_lshlrev_b32_e64 v66, 16, v2
v_and_b32 v67, 0xffff0000, v2
Mvva 184,200,68
s_waitcnt lgkmcnt(10)
ds_read_b64_tr_b16 v[248:249], v14 offset:12288
ds_read_b64_tr_b16 v[250:251], v14 offset:14336
Vc 3,68,69
Mvva 184,216,76
buffer_load_dwordx4 v114, s[12:15], s50 offen offset:2048 lds
Mvva 172,204,64
s_waitcnt vmcnt(15)
ds_read_b64_tr_b16 v[236:237], v15 offset:8192
ds_read_b64_tr_b16 v[238:239], v15 offset:10240
v_lshlrev_b32_e64 v68, 16, v3
Mvva 172,220,72
s_waitcnt lgkmcnt(10)
v_and_b32 v69, 0xffff0000, v3
Vc 4,70,71
v_lshlrev_b32 v70, 16, v4
v_and_b32 v71, 0xffff0000, v4
Vc 5,72,73
Mvva 188,204,68
s_barrier
ds_read_b64_tr_b16 v[252:253], v15 offset:12288
ds_read_b64_tr_b16 v[254:255], v15 offset:14336
v_lshlrev_b32 v72, 16, v5
Mvva 188,220,76
buffer_load_dwordx4 v114, s[12:15], s51 offen offset:3072 lds
v_add_u32 v114, 131072, v114
Mvva 128,224,64
ds_read_b64_tr_b16 v[192:193], v12 offset:16384
ds_read_b64_tr_b16 v[194:195], v12 offset:18432
v_and_b32 v73, 0xffff0000, v5
Mvva 128,240,72
v_mul_f32 v2, 0xbfb8aa3b, v66
v_mul_f32 v3, 0xbfb8aa3b, v67
v_mul_f32 v4, 0xbfb8aa3b, v68
v_mul_f32 v5, 0xbfb8aa3b, v69
v_mul_f32 v6, 0xbfb8aa3b, v70
Mvva 144,224,68
s_waitcnt lgkmcnt(10)
ds_read_b64_tr_b16 v[208:209], v12 offset:20480
ds_read_b64_tr_b16 v[210:211], v12 offset:22528
v_mul_f32 v7, 0xbfb8aa3b, v71
Mvva 144,240,76
buffer_load_dwordx4 a[112:115], v112, s[8:11], s52 offen offset:0 sc1
Mvva 132,228,64
ds_read_b64_tr_b16 v[196:197], v13 offset:16384
ds_read_b64_tr_b16 v[198:199], v13 offset:18432
v_mul_f32 v8, 0xbfb8aa3b, v72
Mvva 132,244,72
v_mul_f32 v9, 0xbfb8aa3b, v73
Ve 2,2
VE 3,3
Mvva 148,228,68
s_waitcnt lgkmcnt(10)
ds_read_b64_tr_b16 v[212:213], v13 offset:20480
ds_read_b64_tr_b16 v[214:215], v13 offset:22528
Mvva 148,244,76
buffer_load_dwordx4 a[116:119], v112, s[8:11], s52 offen offset:1024 sc1
s_add_u32 s52, s52, 8192
Mvva 136,232,64
ds_read_b64_tr_b16 v[200:201], v14 offset:16384
ds_read_b64_tr_b16 v[202:203], v14 offset:18432
Mvva 136,248,72
Ve 4,4
VE 5,5
Mvva 152,232,68
s_waitcnt lgkmcnt(10)
ds_read_b64_tr_b16 v[216:217], v14 offset:20480
ds_read_b64_tr_b16 v[218:219], v14 offset:22528
Mvva 152,248,76
buffer_load_dwordx4 a[120:123], v112, s[8:11], s52 offen offset:0 sc1
Mvva 140,236,64
ds_read_b64_tr_b16 v[204:205], v15 offset:16384
ds_read_b64_tr_b16 v[206:207], v15 offset:18432
Mvva 140,252,72
Ve 6,6
VE 7,7
Mvva 156,236,68
s_waitcnt lgkmcnt(10)
ds_read_b64_tr_b16 v[220:221], v15 offset:20480
ds_read_b64_tr_b16 v[222:223], v15 offset:22528
Mvva 156,252,76
buffer_load_dwordx4 a[124:127], v112, s[8:11], s52 offen offset:1024 sc1
s_add_u32 s52, s52, 8192
s_waitcnt vmcnt(16)
Mvva 160,192,80
ds_read_b64_tr_b16 v[224:225], v12 offset:24576
ds_read_b64_tr_b16 v[226:227], v12 offset:26624
Mvva 160,208,88
Ve 8,8
Ve 9,9
v_add_f32_e64 v2, 1.0, v2
Mvva 176,192,84
s_waitcnt lgkmcnt(10)
s_add_u32 m0, s44, 0
ds_read_b64_tr_b16 v[240:241], v12 offset:28672
ds_read_b64_tr_b16 v[242:243], v12 offset:30720
v_add_f32_e64 v3, 1.0, v3
Mvva 176,208,92
buffer_load_dwordx4 v114, s[12:15], s48 offen offset:0 lds
Mvva 164,196,80
ds_read_b64_tr_b16 v[228:229], v13 offset:24576
ds_read_b64_tr_b16 v[230:231], v13 offset:26624
v_add_f32_e64 v4, 1.0, v4
Mvva 164,212,88
v_add_f32 v5, 1.0, v5
v_add_f32 v6, 1.0, v6
v_add_f32 v7, 1.0, v7
v_add_f32 v8, 1.0, v8
v_add_f32_e64 v9, 1.0, v9
Mvva 180,196,84
s_waitcnt lgkmcnt(10)
ds_read_b64_tr_b16 v[244:245], v13 offset:28672
ds_read_b64_tr_b16 v[246:247], v13 offset:30720
Mvva 180,212,92
buffer_load_dwordx4 v114, s[12:15], s49 offen offset:1024 lds
Mvva 168,200,80
ds_read_b64_tr_b16 v[232:233], v14 offset:24576
ds_read_b64_tr_b16 v[234:235], v14 offset:26624
Mvva 168,216,88
v_rcp_f32 v2, v2
v_rcp_f32_e64 v3, v3
Mvva 184,200,84
s_waitcnt lgkmcnt(10)
ds_read_b64_tr_b16 v[248:249], v14 offset:28672
ds_read_b64_tr_b16 v[250:251], v14 offset:30720
Mvva 184,216,92
buffer_load_dwordx4 v114, s[12:15], s50 offen offset:2048 lds
Mvva 172,204,80
s_waitcnt vmcnt(15)
ds_read_b64_tr_b16 v[236:237], v15 offset:24576
ds_read_b64_tr_b16 v[238:239], v15 offset:26624
Mvva 172,220,88
s_waitcnt lgkmcnt(10)
v_rcp_f32 v4, v4
v_rcp_f32_e64 v5, v5
Mvva 188,204,84
s_barrier
ds_read_b64_tr_b16 v[252:253], v15 offset:28672
ds_read_b64_tr_b16 v[254:255], v15 offset:30720
Mvva 188,220,92
buffer_load_dwordx4 v114, s[12:15], s51 offen offset:3072 lds
v_add_u32 v114, 131072, v114
Mvva 128,224,80
ds_read_b64_tr_b16 v[192:193], v12 offset:32768
ds_read_b64_tr_b16 v[194:195], v12 offset:34816
Mvva 128,240,88
v_rcp_f32 v6, v6
v_rcp_f32_e64 v7, v7
Mvva 144,224,84
s_waitcnt lgkmcnt(10)
ds_read_b64_tr_b16 v[208:209], v12 offset:36864
ds_read_b64_tr_b16 v[210:211], v12 offset:38912
Mvva 144,240,92
buffer_load_dwordx4 a[128:131], v112, s[8:11], s52 offen offset:0 sc1
Mvva 132,228,80
ds_read_b64_tr_b16 v[196:197], v13 offset:32768
ds_read_b64_tr_b16 v[198:199], v13 offset:34816
Mvva 132,244,88
v_rcp_f32 v8, v8
v_rcp_f32 v9, v9
Vm 66,66,2
Mvva 148,228,84
s_waitcnt lgkmcnt(10)
ds_read_b64_tr_b16 v[212:213], v13 offset:36864
ds_read_b64_tr_b16 v[214:215], v13 offset:38912
Vm 67,67,3
Mvva 148,244,92
buffer_load_dwordx4 a[132:135], v112, s[8:11], s52 offen offset:1024 sc1
s_add_u32 s52, s52, 8192
Mvva 136,232,80
ds_read_b64_tr_b16 v[200:201], v14 offset:32768
ds_read_b64_tr_b16 v[202:203], v14 offset:34816
v_mul_f32_e64 v68, v68, v4
Mvva 136,248,88
Vm 69,69,5
Vm 70,70,6
Vm 71,71,7
Vm 72,72,8
v_mul_f32_e64 v73, v73, v9
Mvva 152,232,84
s_waitcnt lgkmcnt(10)
ds_read_b64_tr_b16 v[216:217], v14 offset:36864
ds_read_b64_tr_b16 v[218:219], v14 offset:38912
Vc 2,66,67
Mvva 152,248,92
buffer_load_dwordx4 a[136:139], v112, s[8:11], s52 offen offset:0 sc1
Mvva 140,236,80
ds_read_b64_tr_b16 v[204:205], v15 offset:32768
ds_read_b64_tr_b16 v[206:207], v15 offset:34816
v_lshlrev_b32 v66, 16, v2
Mvva 140,252,88
v_and_b32 v67, 0xffff0000, v2
Vc 3,68,69
v_lshlrev_b32_e64 v68, 16, v3
v_and_b32 v69, 0xffff0000, v3
Vc 4,70,71
Mvva 156,236,84
s_waitcnt lgkmcnt(10)
ds_read_b64_tr_b16 v[220:221], v15 offset:36864
ds_read_b64_tr_b16 v[222:223], v15 offset:38912
v_lshlrev_b32 v70, 16, v4
Mvva 156,252,92
buffer_load_dwordx4 a[140:143], v112, s[8:11], s52 offen offset:1024 sc1
s_add_u32 s52, s52, 8192
s_waitcnt vmcnt(16)
Mvva 160,192,96
ds_read_b64_tr_b16 v[224:225], v12 offset:40960
ds_read_b64_tr_b16 v[226:227], v12 offset:43008
v_and_b32 v71, 0xffff0000, v4
Mvva 160,208,104
Vc 5,72,73
v_lshlrev_b32 v72, 16, v5
v_and_b32 v73, 0xffff0000, v5
Mvva 176,192,100
s_waitcnt lgkmcnt(10)
s_add_u32 m0, s44, 16384
ds_read_b64_tr_b16 v[240:241], v12 offset:45056
ds_read_b64_tr_b16 v[242:243], v12 offset:47104
Mvva 176,208,108
buffer_load_dwordx4 v114, s[12:15], s48 offen offset:0 lds
Mvva 164,196,96
ds_read_b64_tr_b16 v[228:229], v13 offset:40960
ds_read_b64_tr_b16 v[230:231], v13 offset:43008
Mvva 164,212,104
Mvva 180,196,100
s_waitcnt lgkmcnt(10)
ds_read_b64_tr_b16 v[244:245], v13 offset:45056
ds_read_b64_tr_b16 v[246:247], v13 offset:47104
Mvva 180,212,108
buffer_load_dwordx4 v114, s[12:15], s49 offen offset:1024 lds
Mvva 168,200,96
ds_read_b64_tr_b16 v[232:233], v14 offset:40960
ds_read_b64_tr_b16 v[234:235], v14 offset:43008
Mvva 168,216,104
Mvva 184,200,100
s_waitcnt lgkmcnt(10)
ds_read_b64_tr_b16 v[248:249], v14 offset:45056
ds_read_b64_tr_b16 v[250:251], v14 offset:47104
Mvva 184,216,108
buffer_load_dwordx4 v114, s[12:15], s50 offen offset:2048 lds
Mvva 172,204,96
s_waitcnt vmcnt(15)
ds_read_b64_tr_b16 v[236:237], v15 offset:40960
ds_read_b64_tr_b16 v[238:239], v15 offset:43008
Mvva 172,220,104
s_waitcnt lgkmcnt(10)
s_cmp_lt_u32 s93, 224
s_cbranch_scc1 L_f2B
L_f2Br:
Mvva 188,204,100
s_barrier
ds_read_b64_tr_b16 v[252:253], v15 offset:45056
ds_read_b64_tr_b16 v[254:255], v15 offset:47104
Mvva 188,220,108
buffer_load_dwordx4 v114, s[12:15], s51 offen offset:3072 lds
v_add_u32 v114, 131072, v114
Mvva 128,224,96
ds_read_b64_tr_b16 v[192:193], v12 offset:49152
ds_read_b64_tr_b16 v[194:195], v12 offset:51200
Mvva 128,240,104
Mvva 144,224,100
s_waitcnt lgkmcnt(10)
ds_read_b64_tr_b16 v[208:209], v12 offset:53248
ds_read_b64_tr_b16 v[210:211], v12 offset:55296
Mvva 144,240,108
buffer_load_dwordx4 a[144:147], v112, s[8:11], s52 offen offset:0 sc1
Mvva 132,228,96
ds_read_b64_tr_b16 v[196:197], v13 offset:49152
ds_read_b64_tr_b16 v[198:199], v13 offset:51200
Mvva 132,244,104
Mvva 148,228,100
s_waitcnt lgkmcnt(10)
ds_read_b64_tr_b16 v[212:213], v13 offset:53248
ds_read_b64_tr_b16 v[214:215], v13 offset:55296
Mvva 148,244,108
buffer_load_dwordx4 a[148:151], v112, s[8:11], s52 offen offset:1024 sc1
s_add_u32 s52, s52, 8192
Mvva 136,232,96
ds_read_b64_tr_b16 v[200:201], v14 offset:49152
ds_read_b64_tr_b16 v[202:203], v14 offset:51200
Mvva 136,248,104
Mvva 152,232,100
s_waitcnt lgkmcnt(10)
ds_read_b64_tr_b16 v[216:217], v14 offset:53248
ds_read_b64_tr_b16 v[218:219], v14 offset:55296
Mvva 152,248,108
buffer_load_dwordx4 a[152:155], v112, s[8:11], s52 offen offset:0 sc1
Mvva 140,236,96
ds_read_b64_tr_b16 v[204:205], v15 offset:49152
ds_read_b64_tr_b16 v[206:207], v15 offset:51200
Mvva 140,252,104
Mvva 156,236,100
s_waitcnt lgkmcnt(10)
ds_read_b64_tr_b16 v[220:221], v15 offset:53248
ds_read_b64_tr_b16 v[222:223], v15 offset:55296
Mvva 156,252,108
buffer_load_dwordx4 a[156:159], v112, s[8:11], s52 offen offset:1024 sc1
s_add_u32 s52, s52, 8192
s_waitcnt vmcnt(16)
Mvva 160,192,112
ds_read_b64_tr_b16 v[224:225], v12 offset:57344
ds_read_b64_tr_b16 v[226:227], v12 offset:59392
Mvva 160,208,120
Mvva 176,192,116
s_waitcnt lgkmcnt(10)
s_add_u32 m0, s44, 32768
ds_read_b64_tr_b16 v[240:241], v12 offset:61440
ds_read_b64_tr_b16 v[242:243], v12 offset:63488
Mvva 176,208,124
buffer_load_dwordx4 v114, s[12:15], s48 offen offset:0 lds
Mvva 164,196,112
ds_read_b64_tr_b16 v[228:229], v13 offset:57344
ds_read_b64_tr_b16 v[230:231], v13 offset:59392
Mvva 164,212,120
Mvva 180,196,116
s_waitcnt lgkmcnt(10)
ds_read_b64_tr_b16 v[244:245], v13 offset:61440
ds_read_b64_tr_b16 v[246:247], v13 offset:63488
Mvva 180,212,124
buffer_load_dwordx4 v114, s[12:15], s49 offen offset:1024 lds
Mvva 168,200,112
ds_read_b64_tr_b16 v[232:233], v14 offset:57344
ds_read_b64_tr_b16 v[234:235], v14 offset:59392
Mvva 168,216,120
Mvva 184,200,116
s_waitcnt lgkmcnt(10)
ds_read_b64_tr_b16 v[248:249], v14 offset:61440
ds_read_b64_tr_b16 v[250:251], v14 offset:63488
Mvva 184,216,124
buffer_load_dwordx4 v114, s[12:15], s50 offen offset:2048 lds
Mvva 172,204,112
s_waitcnt vmcnt(15)
ds_read_b64_tr_b16 v[236:237], v15 offset:57344
ds_read_b64_tr_b16 v[238:239], v15 offset:59392
Mvva 172,220,120
s_waitcnt lgkmcnt(10)
Mvva 188,204,116
s_barrier
ds_read_b64_tr_b16 v[252:253], v15 offset:61440
ds_read_b64_tr_b16 v[254:255], v15 offset:63488
Mvva 188,220,124
buffer_load_dwordx4 v114, s[12:15], s51 offen offset:3072 lds
v_add_u32 v114, 131072, v114
Mvva 128,224,112
ds_read_b64_tr_b16 v[192:193], v115 offset:0
ds_read_b64_tr_b16 v[194:195], v115 offset:2048
Mvva 128,240,120
Mvva 144,224,116
s_waitcnt lgkmcnt(10)
ds_read_b64_tr_b16 v[208:209], v115 offset:4096
ds_read_b64_tr_b16 v[210:211], v115 offset:6144
Mvva 144,240,124
buffer_load_dwordx4 a[160:163], v112, s[8:11], s52 offen offset:0 sc1
Mvva 132,228,112
ds_read_b64_tr_b16 v[196:197], v116 offset:0
ds_read_b64_tr_b16 v[198:199], v116 offset:2048
Mvva 132,244,120
Mvva 148,228,116
s_waitcnt lgkmcnt(10)
ds_read_b64_tr_b16 v[212:213], v116 offset:4096
ds_read_b64_tr_b16 v[214:215], v116 offset:6144
Mvva 148,244,124
buffer_load_dwordx4 a[164:167], v112, s[8:11], s52 offen offset:1024 sc1
s_add_u32 s52, s52, 8192
Mvva 136,232,112
ds_read_b64_tr_b16 v[200:201], v117 offset:0
ds_read_b64_tr_b16 v[202:203], v117 offset:2048
Mvva 136,248,120
Mvva 152,232,116
s_waitcnt lgkmcnt(10)
ds_read_b64_tr_b16 v[216:217], v117 offset:4096
ds_read_b64_tr_b16 v[218:219], v117 offset:6144
Mvva 152,248,124
buffer_load_dwordx4 a[168:171], v112, s[8:11], s52 offen offset:0 sc1
Mvva 140,236,112
ds_read_b64_tr_b16 v[204:205], v118 offset:0
ds_read_b64_tr_b16 v[206:207], v118 offset:2048
Mvva 140,252,120
Mvva 156,236,116
s_waitcnt lgkmcnt(10)
ds_read_b64_tr_b16 v[220:221], v118 offset:4096
ds_read_b64_tr_b16 v[222:223], v118 offset:6144
Mvva 156,252,124
buffer_load_dwordx4 a[172:175], v112, s[8:11], s52 offen offset:1024 sc1
s_add_u32 s52, s52, 8192
s_waitcnt vmcnt(16)
Mvva 160,192,128
ds_read_b64_tr_b16 v[224:225], v115 offset:8192
ds_read_b64_tr_b16 v[226:227], v115 offset:10240
Mvva 160,208,136
Mvva 176,192,132
s_waitcnt lgkmcnt(10)
s_add_u32 m0, s44, 49152
ds_read_b64_tr_b16 v[240:241], v115 offset:12288
ds_read_b64_tr_b16 v[242:243], v115 offset:14336
Mvva 176,208,140
buffer_load_dwordx4 v114, s[12:15], s48 offen offset:0 lds
Mvva 164,196,128
ds_read_b64_tr_b16 v[228:229], v116 offset:8192
ds_read_b64_tr_b16 v[230:231], v116 offset:10240
Mvva 164,212,136
Mvva 180,196,132
s_waitcnt lgkmcnt(10)
ds_read_b64_tr_b16 v[244:245], v116 offset:12288
ds_read_b64_tr_b16 v[246:247], v116 offset:14336
Mvva 180,212,140
buffer_load_dwordx4 v114, s[12:15], s49 offen offset:1024 lds
Mvva 168,200,128
ds_read_b64_tr_b16 v[232:233], v117 offset:8192
ds_read_b64_tr_b16 v[234:235], v117 offset:10240
Mvva 168,216,136
Mvva 184,200,132
s_waitcnt lgkmcnt(10)
ds_read_b64_tr_b16 v[248:249], v117 offset:12288
ds_read_b64_tr_b16 v[250:251], v117 offset:14336
Mvva 184,216,140
buffer_load_dwordx4 v114, s[12:15], s50 offen offset:2048 lds
Mvva 172,204,128
s_waitcnt vmcnt(15)
ds_read_b64_tr_b16 v[236:237], v118 offset:8192
ds_read_b64_tr_b16 v[238:239], v118 offset:10240
Mvva 172,220,136
s_waitcnt lgkmcnt(10)
Mvva 188,204,132
s_barrier
ds_read_b64_tr_b16 v[252:253], v118 offset:12288
ds_read_b64_tr_b16 v[254:255], v118 offset:14336
Mvva 188,220,140
buffer_load_dwordx4 v114, s[12:15], s51 offen offset:3072 lds
v_add_u32 v114, 131072, v114
Mvva 128,224,128
ds_read_b64_tr_b16 v[192:193], v115 offset:16384
ds_read_b64_tr_b16 v[194:195], v115 offset:18432
Mvva 128,240,136
Mvva 144,224,132
s_waitcnt lgkmcnt(10)
ds_read_b64_tr_b16 v[208:209], v115 offset:20480
ds_read_b64_tr_b16 v[210:211], v115 offset:22528
Mvva 144,240,140
buffer_load_dwordx4 a[176:179], v112, s[8:11], s52 offen offset:0 sc1
Mvva 132,228,128
ds_read_b64_tr_b16 v[196:197], v116 offset:16384
ds_read_b64_tr_b16 v[198:199], v116 offset:18432
Mvva 132,244,136
Mvva 148,228,132
s_waitcnt lgkmcnt(10)
ds_read_b64_tr_b16 v[212:213], v116 offset:20480
ds_read_b64_tr_b16 v[214:215], v116 offset:22528
Mvva 148,244,140
buffer_load_dwordx4 a[180:183], v112, s[8:11], s52 offen offset:1024 sc1
s_add_u32 s52, s52, 8192
Mvva 136,232,128
ds_read_b64_tr_b16 v[200:201], v117 offset:16384
ds_read_b64_tr_b16 v[202:203], v117 offset:18432
Mvva 136,248,136
Mvva 152,232,132
s_waitcnt lgkmcnt(10)
ds_read_b64_tr_b16 v[216:217], v117 offset:20480
ds_read_b64_tr_b16 v[218:219], v117 offset:22528
Mvva 152,248,140
buffer_load_dwordx4 a[184:187], v112, s[8:11], s52 offen offset:0 sc1
Mvva 140,236,128
ds_read_b64_tr_b16 v[204:205], v118 offset:16384
ds_read_b64_tr_b16 v[206:207], v118 offset:18432
Mvva 140,252,136
s_cmp_lt_u32 s93, 224
s_cbranch_scc1 L_f2C
L_f2Cr:
Mvva 156,236,132
s_waitcnt lgkmcnt(10)
ds_read_b64_tr_b16 v[220:221], v118 offset:20480
ds_read_b64_tr_b16 v[222:223], v118 offset:22528
Mvva 156,252,140
buffer_load_dwordx4 a[188:191], v112, s[8:11], s52 offen offset:1024 sc1
s_add_u32 s52, s52, 8192
s_waitcnt vmcnt(16)
Mvva 160,192,144
ds_read_b64_tr_b16 v[224:225], v115 offset:24576
ds_read_b64_tr_b16 v[226:227], v115 offset:26624
Mvva 160,208,152
Mvva 176,192,148
s_waitcnt lgkmcnt(10)
s_add_u32 m0, s44, 65536
ds_read_b64_tr_b16 v[240:241], v115 offset:28672
ds_read_b64_tr_b16 v[242:243], v115 offset:30720
Mvva 176,208,156
buffer_load_dwordx4 v114, s[12:15], s48 offen offset:0 lds
Mvva 164,196,144
ds_read_b64_tr_b16 v[228:229], v116 offset:24576
ds_read_b64_tr_b16 v[230:231], v116 offset:26624
Mvva 164,212,152
Mvva 180,196,148
s_waitcnt lgkmcnt(10)
ds_read_b64_tr_b16 v[244:245], v116 offset:28672
ds_read_b64_tr_b16 v[246:247], v116 offset:30720
Mvva 180,212,156
buffer_load_dwordx4 v114, s[12:15], s49 offen offset:1024 lds
Mvva 168,200,144
ds_read_b64_tr_b16 v[232:233], v117 offset:24576
ds_read_b64_tr_b16 v[234:235], v117 offset:26624
Mvva 168,216,152
Mvva 184,200,148
s_waitcnt lgkmcnt(10)
ds_read_b64_tr_b16 v[248:249], v117 offset:28672
ds_read_b64_tr_b16 v[250:251], v117 offset:30720
Mvva 184,216,156
buffer_load_dwordx4 v114, s[12:15], s50 offen offset:2048 lds
Mvva 172,204,144
s_waitcnt vmcnt(15)
ds_read_b64_tr_b16 v[236:237], v118 offset:24576
ds_read_b64_tr_b16 v[238:239], v118 offset:26624
Mvva 172,220,152
s_waitcnt lgkmcnt(10)
Mvva 188,204,148
s_barrier
ds_read_b64_tr_b16 v[252:253], v118 offset:28672
ds_read_b64_tr_b16 v[254:255], v118 offset:30720
Mvva 188,220,156
buffer_load_dwordx4 v114, s[12:15], s51 offen offset:3072 lds
v_add_u32 v114, 131072, v114
Mvva 128,224,144
ds_read_b64_tr_b16 v[192:193], v115 offset:32768
ds_read_b64_tr_b16 v[194:195], v115 offset:34816
Mvva 128,240,152
s_cmp_ge_u32 s2, 128
s_cbranch_scc1 L_c31
L_c31r:
Mvva 144,224,148
s_waitcnt lgkmcnt(10)
ds_read_b64_tr_b16 v[208:209], v115 offset:36864
ds_read_b64_tr_b16 v[210:211], v115 offset:38912
Mvva 144,240,156
buffer_load_dwordx4 a[192:195], v112, s[8:11], s52 offen offset:0 sc1
Mvva 132,228,144
ds_read_b64_tr_b16 v[196:197], v116 offset:32768
ds_read_b64_tr_b16 v[198:199], v116 offset:34816
Mvva 132,244,152
Mvva 148,228,148
s_waitcnt lgkmcnt(10)
ds_read_b64_tr_b16 v[212:213], v116 offset:36864
ds_read_b64_tr_b16 v[214:215], v116 offset:38912
Mvva 148,244,156
buffer_load_dwordx4 a[196:199], v112, s[8:11], s52 offen offset:1024 sc1
s_add_u32 s52, s52, 8192
Mvva 136,232,144
ds_read_b64_tr_b16 v[200:201], v117 offset:32768
ds_read_b64_tr_b16 v[202:203], v117 offset:34816
Mvva 136,248,152
Mvva 152,232,148
s_waitcnt lgkmcnt(10)
ds_read_b64_tr_b16 v[216:217], v117 offset:36864
ds_read_b64_tr_b16 v[218:219], v117 offset:38912
Mvva 152,248,156
buffer_load_dwordx4 a[200:203], v112, s[8:11], s52 offen offset:0 sc1
Mvva 140,236,144
ds_read_b64_tr_b16 v[204:205], v118 offset:32768
ds_read_b64_tr_b16 v[206:207], v118 offset:34816
Mvva 140,252,152
Mvva 156,236,148
s_waitcnt lgkmcnt(10)
ds_read_b64_tr_b16 v[220:221], v118 offset:36864
ds_read_b64_tr_b16 v[222:223], v118 offset:38912
Mvva 156,252,156
buffer_load_dwordx4 a[204:207], v112, s[8:11], s52 offen offset:1024 sc1
s_add_u32 s52, s52, 8192
s_waitcnt vmcnt(16)
Mvva 160,192,160
ds_read_b64_tr_b16 v[224:225], v115 offset:40960
ds_read_b64_tr_b16 v[226:227], v115 offset:43008
Mvva 160,208,168
Mvva 176,192,164
s_waitcnt lgkmcnt(10)
s_add_u32 m0, s44, 81920
ds_read_b64_tr_b16 v[240:241], v115 offset:45056
ds_read_b64_tr_b16 v[242:243], v115 offset:47104
Mvva 176,208,172
buffer_load_dwordx4 v114, s[12:15], s48 offen offset:0 lds
Mvva 164,196,160
ds_read_b64_tr_b16 v[228:229], v116 offset:40960
ds_read_b64_tr_b16 v[230:231], v116 offset:43008
Mvva 164,212,168
Mvva 180,196,164
s_waitcnt lgkmcnt(10)
ds_read_b64_tr_b16 v[244:245], v116 offset:45056
ds_read_b64_tr_b16 v[246:247], v116 offset:47104
Mvva 180,212,172
buffer_load_dwordx4 v114, s[12:15], s49 offen offset:1024 lds
Mvva 168,200,160
ds_read_b64_tr_b16 v[232:233], v117 offset:40960
ds_read_b64_tr_b16 v[234:235], v117 offset:43008
Mvva 168,216,168
Mvva 184,200,164
s_waitcnt lgkmcnt(10)
ds_read_b64_tr_b16 v[248:249], v117 offset:45056
ds_read_b64_tr_b16 v[250:251], v117 offset:47104
Mvva 184,216,172
buffer_load_dwordx4 v114, s[12:15], s50 offen offset:2048 lds
Mvva 172,204,160
s_waitcnt vmcnt(15)
ds_read_b64_tr_b16 v[236:237], v118 offset:40960
ds_read_b64_tr_b16 v[238:239], v118 offset:43008
Mvva 172,220,168
s_waitcnt lgkmcnt(10)
Mvva 188,204,164
s_barrier
ds_read_b64_tr_b16 v[252:253], v118 offset:45056
ds_read_b64_tr_b16 v[254:255], v118 offset:47104
Mvva 188,220,172
buffer_load_dwordx4 v114, s[12:15], s51 offen offset:3072 lds
v_add_u32 v114, 131072, v114
Mvva 128,224,160
ds_read_b64_tr_b16 v[192:193], v115 offset:49152
ds_read_b64_tr_b16 v[194:195], v115 offset:51200
Mvva 128,240,168
Mvva 144,224,164
s_waitcnt lgkmcnt(10)
ds_read_b64_tr_b16 v[208:209], v115 offset:53248
ds_read_b64_tr_b16 v[210:211], v115 offset:55296
Mvva 144,240,172
buffer_load_dwordx4 a[208:211], v112, s[8:11], s52 offen offset:0 sc1
Mvva 132,228,160
ds_read_b64_tr_b16 v[196:197], v116 offset:49152
ds_read_b64_tr_b16 v[198:199], v116 offset:51200
Mvva 132,244,168
Mvva 148,228,164
s_waitcnt lgkmcnt(10)
ds_read_b64_tr_b16 v[212:213], v116 offset:53248
ds_read_b64_tr_b16 v[214:215], v116 offset:55296
Mvva 148,244,172
buffer_load_dwordx4 a[212:215], v112, s[8:11], s52 offen offset:1024 sc1
s_add_u32 s52, s52, 8192
Mvva 136,232,160
ds_read_b64_tr_b16 v[200:201], v117 offset:49152
ds_read_b64_tr_b16 v[202:203], v117 offset:51200
Mvva 136,248,168
Mvva 152,232,164
s_waitcnt lgkmcnt(10)
ds_read_b64_tr_b16 v[216:217], v117 offset:53248
ds_read_b64_tr_b16 v[218:219], v117 offset:55296
Mvva 152,248,172
buffer_load_dwordx4 a[216:219], v112, s[8:11], s52 offen offset:0 sc1
Mvva 140,236,160
ds_read_b64_tr_b16 v[204:205], v118 offset:49152
ds_read_b64_tr_b16 v[206:207], v118 offset:51200
Mvva 140,252,168
Mvva 156,236,164
s_waitcnt lgkmcnt(10)
ds_read_b64_tr_b16 v[220:221], v118 offset:53248
ds_read_b64_tr_b16 v[222:223], v118 offset:55296
Mvva 156,252,172
buffer_load_dwordx4 a[220:223], v112, s[8:11], s52 offen offset:1024 sc1
s_add_u32 s52, s52, 8192
s_waitcnt vmcnt(16)
Mvva 160,192,176
ds_read_b64_tr_b16 v[224:225], v115 offset:57344
ds_read_b64_tr_b16 v[226:227], v115 offset:59392
Mvva 160,208,184
Mvva 176,192,180
s_waitcnt lgkmcnt(10)
s_add_u32 m0, s44, 98304
ds_read_b64_tr_b16 v[240:241], v115 offset:61440
ds_read_b64_tr_b16 v[242:243], v115 offset:63488
Mvva 176,208,188
buffer_load_dwordx4 v114, s[12:15], s48 offen offset:0 lds
Mvva 164,196,176
ds_read_b64_tr_b16 v[228:229], v116 offset:57344
ds_read_b64_tr_b16 v[230:231], v116 offset:59392
Mvva 164,212,184
Mvva 180,196,180
s_waitcnt lgkmcnt(10)
ds_read_b64_tr_b16 v[244:245], v116 offset:61440
ds_read_b64_tr_b16 v[246:247], v116 offset:63488
Mvva 180,212,188
buffer_load_dwordx4 v114, s[12:15], s49 offen offset:1024 lds
Mvva 168,200,176
ds_read_b64_tr_b16 v[232:233], v117 offset:57344
ds_read_b64_tr_b16 v[234:235], v117 offset:59392
Mvva 168,216,184
s_cmp_lt_u32 s93, 224
s_cbranch_scc1 L_f2E
L_f2Er:
Mvva 184,200,180
s_waitcnt lgkmcnt(10)
ds_read_b64_tr_b16 v[248:249], v117 offset:61440
ds_read_b64_tr_b16 v[250:251], v117 offset:63488
Mvva 184,216,188
buffer_load_dwordx4 v114, s[12:15], s50 offen offset:2048 lds
Mvva 172,204,176
s_waitcnt vmcnt(15)
ds_read_b64_tr_b16 v[236:237], v118 offset:57344
ds_read_b64_tr_b16 v[238:239], v118 offset:59392
Mvva 172,220,184
s_waitcnt lgkmcnt(10)
Mvva 188,204,180
s_barrier
ds_read_b64_tr_b16 v[252:253], v118 offset:61440
ds_read_b64_tr_b16 v[254:255], v118 offset:63488
Mvva 188,220,188
buffer_load_dwordx4 v114, s[12:15], s51 offen offset:3072 lds
v_add_u32 v114, 131072, v114
Mvva 128,224,176
ds_read_b64_tr_b16 v[192:193], v12 offset:0
ds_read_b64_tr_b16 v[194:195], v12 offset:2048
Mvva 128,240,184
Mvva 144,224,180
s_waitcnt lgkmcnt(10)
ds_read_b64_tr_b16 v[208:209], v12 offset:4096
ds_read_b64_tr_b16 v[210:211], v12 offset:6144
Mvva 144,240,188
buffer_load_dwordx4 a[224:227], v112, s[8:11], s52 offen offset:0 sc1
Mvva 132,228,176
ds_read_b64_tr_b16 v[196:197], v13 offset:0
ds_read_b64_tr_b16 v[198:199], v13 offset:2048
Mvva 132,244,184
Mvva 148,228,180
s_waitcnt lgkmcnt(10)
ds_read_b64_tr_b16 v[212:213], v13 offset:4096
ds_read_b64_tr_b16 v[214:215], v13 offset:6144
Mvva 148,244,188
buffer_load_dwordx4 a[228:231], v112, s[8:11], s52 offen offset:1024 sc1
s_add_u32 s52, s52, 8192
Mvva 136,232,176
ds_read_b64_tr_b16 v[200:201], v14 offset:0
ds_read_b64_tr_b16 v[202:203], v14 offset:2048
Mvva 136,248,184
Mvva 152,232,180
s_waitcnt lgkmcnt(10)
ds_read_b64_tr_b16 v[216:217], v14 offset:4096
ds_read_b64_tr_b16 v[218:219], v14 offset:6144
Mvva 152,248,188
buffer_load_dwordx4 a[232:235], v112, s[8:11], s52 offen offset:0 sc1
Mvva 140,236,176
ds_read_b64_tr_b16 v[204:205], v15 offset:0
ds_read_b64_tr_b16 v[206:207], v15 offset:2048
Mvva 140,252,184
Mvva 156,236,180
s_waitcnt lgkmcnt(10)
ds_read_b64_tr_b16 v[220:221], v15 offset:4096
ds_read_b64_tr_b16 v[222:223], v15 offset:6144
Mvva 156,252,188
buffer_load_dwordx4 a[236:239], v112, s[8:11], s52 offen offset:1024 sc1
s_add_u32 s52, s52, 8192
s_waitcnt vmcnt(16)
Mvva 160,192,192
ds_read_b64_tr_b16 v[224:225], v12 offset:8192
ds_read_b64_tr_b16 v[226:227], v12 offset:10240
Mvva 160,208,200
Mvva 176,192,196
s_waitcnt lgkmcnt(10)
s_add_u32 m0, s44, 114688
ds_read_b64_tr_b16 v[240:241], v12 offset:12288
ds_read_b64_tr_b16 v[242:243], v12 offset:14336
Mvva 176,208,204
buffer_load_dwordx4 v114, s[12:15], s48 offen offset:0 lds
Mvva 164,196,192
ds_read_b64_tr_b16 v[228:229], v13 offset:8192
ds_read_b64_tr_b16 v[230:231], v13 offset:10240
Mvva 164,212,200
Mvva 180,196,196
s_waitcnt lgkmcnt(10)
ds_read_b64_tr_b16 v[244:245], v13 offset:12288
ds_read_b64_tr_b16 v[246:247], v13 offset:14336
Mvva 180,212,204
buffer_load_dwordx4 v114, s[12:15], s49 offen offset:1024 lds
Mvva 168,200,192
ds_read_b64_tr_b16 v[232:233], v14 offset:8192
ds_read_b64_tr_b16 v[234:235], v14 offset:10240
Mvva 168,216,200
Mvva 184,200,196
s_waitcnt lgkmcnt(10)
ds_read_b64_tr_b16 v[248:249], v14 offset:12288
ds_read_b64_tr_b16 v[250:251], v14 offset:14336
Mvva 184,216,204
buffer_load_dwordx4 v114, s[12:15], s50 offen offset:2048 lds
Mvva 172,204,192
s_waitcnt vmcnt(15)
ds_read_b64_tr_b16 v[236:237], v15 offset:8192
ds_read_b64_tr_b16 v[238:239], v15 offset:10240
Mvva 172,220,200
s_waitcnt lgkmcnt(10)
Mvva 188,204,196
s_barrier
ds_read_b64_tr_b16 v[252:253], v15 offset:12288
ds_read_b64_tr_b16 v[254:255], v15 offset:14336
Mvva 188,220,204
buffer_load_dwordx4 v114, s[12:15], s51 offen offset:3072 lds
v_add_u32_e64 v114, s95, v113
Mvva 128,224,192
ds_read_b64_tr_b16 v[192:193], v12 offset:16384
ds_read_b64_tr_b16 v[194:195], v12 offset:18432
Mvva 128,240,200
Mvva 144,224,196
s_waitcnt lgkmcnt(10)
ds_read_b64_tr_b16 v[208:209], v12 offset:20480
ds_read_b64_tr_b16 v[210:211], v12 offset:22528
Mvva 144,240,204
buffer_load_dwordx4 a[240:243], v112, s[8:11], s52 offen offset:0 sc1
Mvva 132,228,192
ds_read_b64_tr_b16 v[196:197], v13 offset:16384
ds_read_b64_tr_b16 v[198:199], v13 offset:18432
Mvva 132,244,200
Mvva 148,228,196
s_waitcnt lgkmcnt(10)
ds_read_b64_tr_b16 v[212:213], v13 offset:20480
ds_read_b64_tr_b16 v[214:215], v13 offset:22528
Mvva 148,244,204
buffer_load_dwordx4 a[244:247], v112, s[8:11], s52 offen offset:1024 sc1
s_add_u32 s52, s52, 8192
Mvva 136,232,192
ds_read_b64_tr_b16 v[200:201], v14 offset:16384
ds_read_b64_tr_b16 v[202:203], v14 offset:18432
Mvva 136,248,200
Mvva 152,232,196
s_waitcnt lgkmcnt(10)
ds_read_b64_tr_b16 v[216:217], v14 offset:20480
ds_read_b64_tr_b16 v[218:219], v14 offset:22528
Mvva 152,248,204
buffer_load_dwordx4 a[248:251], v112, s[8:11], s52 offen offset:0 sc1
Mvva 140,236,192
ds_read_b64_tr_b16 v[204:205], v15 offset:16384
ds_read_b64_tr_b16 v[206:207], v15 offset:18432
Mvva 140,252,200
Mvva 156,236,196
s_waitcnt lgkmcnt(10)
ds_read_b64_tr_b16 v[220:221], v15 offset:20480
ds_read_b64_tr_b16 v[222:223], v15 offset:22528
Mvva 156,252,204
buffer_load_dwordx4 a[252:255], v112, s[8:11], s52 offen offset:1024 sc1
s_add_u32 s52, s52, 8192
s_waitcnt vmcnt(16)
Mvva 160,192,208
s_add_u32 m0, s44, 0
ds_read_b64_tr_b16 v[224:225], v12 offset:24576
ds_read_b64_tr_b16 v[226:227], v12 offset:26624
Mvva 160,208,216
buffer_load_dwordx4 v114, s[12:15], s48 offen offset:0 lds
Mvva 176,192,212
s_waitcnt lgkmcnt(10)
ds_read_b64_tr_b16 v[240:241], v12 offset:28672
ds_read_b64_tr_b16 v[242:243], v12 offset:30720
Mvva 176,208,220
Mvva 164,196,208
ds_read_b64_tr_b16 v[228:229], v13 offset:24576
ds_read_b64_tr_b16 v[230:231], v13 offset:26624
Mvva 164,212,216
buffer_load_dwordx4 v114, s[12:15], s49 offen offset:1024 lds
Mvva 180,196,212
s_waitcnt lgkmcnt(10)
ds_read_b64_tr_b16 v[244:245], v13 offset:28672
ds_read_b64_tr_b16 v[246:247], v13 offset:30720
Mvva 180,212,220
buffer_load_dwordx4 v114, s[12:15], s50 offen offset:2048 lds
Mvva 168,200,208
ds_read_b64_tr_b16 v[232:233], v14 offset:24576
ds_read_b64_tr_b16 v[234:235], v14 offset:26624
Mvva 168,216,216
buffer_load_dwordx4 v114, s[12:15], s51 offen offset:3072 lds
v_add_u32 v114, 262144, v114
Mvva 184,200,212
s_waitcnt lgkmcnt(10)
ds_read_b64_tr_b16 v[248:249], v14 offset:28672
ds_read_b64_tr_b16 v[250:251], v14 offset:30720
Mvva 184,216,220
Mvva 172,204,208
s_waitcnt vmcnt(16)
ds_read_b64_tr_b16 v[236:237], v15 offset:24576
ds_read_b64_tr_b16 v[238:239], v15 offset:26624
Mvva 172,220,216
s_waitcnt lgkmcnt(10)
buffer_load_dwordx4 a[0:3], v112, s[8:11], s52 offen offset:0 sc1
Mvva 188,204,212
s_barrier
ds_read_b64_tr_b16 v[252:253], v15 offset:28672
ds_read_b64_tr_b16 v[254:255], v15 offset:30720
Mvva 188,220,220
buffer_load_dwordx4 a[4:7], v112, s[8:11], s52 offen offset:1024 sc1
s_add_u32 s52, s52, 8192
Mvva 128,224,208
ds_read_b64_tr_b16 v[192:193], v12 offset:32768
ds_read_b64_tr_b16 v[194:195], v12 offset:34816
Mvva 128,240,216
buffer_load_dwordx4 a[8:11], v112, s[8:11], s52 offen offset:0 sc1
Mvva 144,224,212
s_waitcnt lgkmcnt(10)
ds_read_b64_tr_b16 v[208:209], v12 offset:36864
ds_read_b64_tr_b16 v[210:211], v12 offset:38912
Mvva 144,240,220
Mvva 132,228,208
ds_read_b64_tr_b16 v[196:197], v13 offset:32768
ds_read_b64_tr_b16 v[198:199], v13 offset:34816
Mvva 132,244,216
buffer_load_dwordx4 a[12:15], v112, s[8:11], s52 offen offset:1024 sc1
s_add_u32 s52, s52, 8192
Mvva 148,228,212
s_waitcnt lgkmcnt(10)
ds_read_b64_tr_b16 v[212:213], v13 offset:36864
ds_read_b64_tr_b16 v[214:215], v13 offset:38912
Mvva 148,244,220
buffer_load_dwordx4 a[16:19], v112, s[8:11], s52 offen offset:0 sc1
Mvva 136,232,208
ds_read_b64_tr_b16 v[200:201], v14 offset:32768
ds_read_b64_tr_b16 v[202:203], v14 offset:34816
Mvva 136,248,216
buffer_load_dwordx4 a[20:23], v112, s[8:11], s52 offen offset:1024 sc1
s_add_u32 s52, s52, 8192
Mvva 152,232,212
s_waitcnt lgkmcnt(10)
ds_read_b64_tr_b16 v[216:217], v14 offset:36864
ds_read_b64_tr_b16 v[218:219], v14 offset:38912
Mvva 152,248,220
Mvva 140,236,208
ds_read_b64_tr_b16 v[204:205], v15 offset:32768
ds_read_b64_tr_b16 v[206:207], v15 offset:34816
Mvva 140,252,216
buffer_load_dwordx4 a[24:27], v112, s[8:11], s52 offen offset:0 sc1
Mvva 156,236,212
s_waitcnt lgkmcnt(10)
ds_read_b64_tr_b16 v[220:221], v15 offset:36864
ds_read_b64_tr_b16 v[222:223], v15 offset:38912
Mvva 156,252,220
buffer_load_dwordx4 a[28:31], v112, s[8:11], s52 offen offset:1024 sc1
s_add_u32 s52, s52, 8192
s_waitcnt vmcnt(20)
Mvva 160,192,224
s_add_u32 m0, s44, 16384
ds_read_b64_tr_b16 v[224:225], v12 offset:40960
ds_read_b64_tr_b16 v[226:227], v12 offset:43008
Mvva 160,208,232
buffer_load_dwordx4 v114, s[12:15], s48 offen offset:0 lds
Mvva 176,192,228
s_waitcnt lgkmcnt(10)
ds_read_b64_tr_b16 v[240:241], v12 offset:45056
ds_read_b64_tr_b16 v[242:243], v12 offset:47104
Mvva 176,208,236
Mvva 164,196,224
ds_read_b64_tr_b16 v[228:229], v13 offset:40960
ds_read_b64_tr_b16 v[230:231], v13 offset:43008
Mvva 164,212,232
buffer_load_dwordx4 v114, s[12:15], s49 offen offset:1024 lds
Mvva 180,196,228
s_waitcnt lgkmcnt(10)
ds_read_b64_tr_b16 v[244:245], v13 offset:45056
ds_read_b64_tr_b16 v[246:247], v13 offset:47104
Mvva 180,212,236
buffer_load_dwordx4 v114, s[12:15], s50 offen offset:2048 lds
Mvva 168,200,224
ds_read_b64_tr_b16 v[232:233], v14 offset:40960
ds_read_b64_tr_b16 v[234:235], v14 offset:43008
Mvva 168,216,232
buffer_load_dwordx4 v114, s[12:15], s51 offen offset:3072 lds
v_add_u32 v114, 262144, v114
Mvva 184,200,228
s_waitcnt lgkmcnt(10)
ds_read_b64_tr_b16 v[248:249], v14 offset:45056
ds_read_b64_tr_b16 v[250:251], v14 offset:47104
Mvva 184,216,236
Mvva 172,204,224
s_waitcnt vmcnt(20)
ds_read_b64_tr_b16 v[236:237], v15 offset:40960
ds_read_b64_tr_b16 v[238:239], v15 offset:43008
Mvva 172,220,232
s_waitcnt lgkmcnt(10)
buffer_load_dwordx4 a[32:35], v112, s[8:11], s52 offen offset:0 sc1
Mvva 188,204,228
s_barrier
ds_read_b64_tr_b16 v[252:253], v15 offset:45056
ds_read_b64_tr_b16 v[254:255], v15 offset:47104
Mvva 188,220,236
buffer_load_dwordx4 a[36:39], v112, s[8:11], s52 offen offset:1024 sc1
s_add_u32 s52, s52, 8192
Mvva 128,224,224
ds_read_b64_tr_b16 v[192:193], v12 offset:49152
ds_read_b64_tr_b16 v[194:195], v12 offset:51200
Mvva 128,240,232
buffer_load_dwordx4 a[40:43], v112, s[8:11], s52 offen offset:0 sc1
Mvva 144,224,228
s_waitcnt lgkmcnt(10)
ds_read_b64_tr_b16 v[208:209], v12 offset:53248
ds_read_b64_tr_b16 v[210:211], v12 offset:55296
Mvva 144,240,236
Mvva 132,228,224
ds_read_b64_tr_b16 v[196:197], v13 offset:49152
ds_read_b64_tr_b16 v[198:199], v13 offset:51200
Mvva 132,244,232
buffer_load_dwordx4 a[44:47], v112, s[8:11], s52 offen offset:1024 sc1
s_add_u32 s52, s52, 8192
Mvva 148,228,228
s_waitcnt lgkmcnt(10)
ds_read_b64_tr_b16 v[212:213], v13 offset:53248
ds_read_b64_tr_b16 v[214:215], v13 offset:55296
Mvva 148,244,236
buffer_load_dwordx4 a[48:51], v112, s[8:11], s52 offen offset:0 sc1
Mvva 136,232,224
ds_read_b64_tr_b16 v[200:201], v14 offset:49152
ds_read_b64_tr_b16 v[202:203], v14 offset:51200
Mvva 136,248,232
buffer_load_dwordx4 a[52:55], v112, s[8:11], s52 offen offset:1024 sc1
s_add_u32 s52, s52, 8192
Mvva 152,232,228
s_waitcnt lgkmcnt(10)
ds_read_b64_tr_b16 v[216:217], v14 offset:53248
ds_read_b64_tr_b16 v[218:219], v14 offset:55296
Mvva 152,248,236
Mvva 140,236,224
ds_read_b64_tr_b16 v[204:205], v15 offset:49152
ds_read_b64_tr_b16 v[206:207], v15 offset:51200
Mvva 140,252,232
buffer_load_dwordx4 a[56:59], v112, s[8:11], s52 offen offset:0 sc1
Mvva 156,236,228
s_waitcnt lgkmcnt(10)
ds_read_b64_tr_b16 v[220:221], v15 offset:53248
ds_read_b64_tr_b16 v[222:223], v15 offset:55296
Mvva 156,252,236
buffer_load_dwordx4 a[60:63], v112, s[8:11], s52 offen offset:1024 sc1
s_add_u32 s52, s52, 8192
s_waitcnt vmcnt(24)
Mvva 160,192,240
s_add_u32 m0, s44, 32768
ds_read_b64_tr_b16 v[224:225], v12 offset:57344
ds_read_b64_tr_b16 v[226:227], v12 offset:59392
Mvva 160,208,248
buffer_load_dwordx4 v114, s[12:15], s48 offen offset:0 lds
Mvva 176,192,244
s_waitcnt lgkmcnt(10)
ds_read_b64_tr_b16 v[240:241], v12 offset:61440
ds_read_b64_tr_b16 v[242:243], v12 offset:63488
Mvva 176,208,252
Mvva 164,196,240
ds_read_b64_tr_b16 v[228:229], v13 offset:57344
ds_read_b64_tr_b16 v[230:231], v13 offset:59392
Mvva 164,212,248
buffer_load_dwordx4 v114, s[12:15], s49 offen offset:1024 lds
Mvva 180,196,244
s_waitcnt lgkmcnt(10)
ds_read_b64_tr_b16 v[244:245], v13 offset:61440
ds_read_b64_tr_b16 v[246:247], v13 offset:63488
Mvva 180,212,252
buffer_load_dwordx4 v114, s[12:15], s50 offen offset:2048 lds
Mvva 168,200,240
ds_read_b64_tr_b16 v[232:233], v14 offset:57344
ds_read_b64_tr_b16 v[234:235], v14 offset:59392
Mvva 168,216,248
buffer_load_dwordx4 v114, s[12:15], s51 offen offset:3072 lds
v_add_u32 v114, 262144, v114
Mvva 184,200,244
s_waitcnt lgkmcnt(10)
ds_read_b64_tr_b16 v[248:249], v14 offset:61440
ds_read_b64_tr_b16 v[250:251], v14 offset:63488
Mvva 184,216,252
Mvva 172,204,240
s_waitcnt vmcnt(24)
ds_read_b64_tr_b16 v[236:237], v15 offset:57344
ds_read_b64_tr_b16 v[238:239], v15 offset:59392
Mvva 172,220,248
s_waitcnt lgkmcnt(10)
buffer_load_dwordx4 a[64:67], v112, s[8:11], s52 offen offset:0 sc1
Mvva 188,204,244
s_barrier
ds_read_b64_tr_b16 v[252:253], v15 offset:61440
ds_read_b64_tr_b16 v[254:255], v15 offset:63488
Mvva 188,220,252
buffer_load_dwordx4 a[68:71], v112, s[8:11], s52 offen offset:1024 sc1
s_add_u32 s52, s52, 8192
Mvva 128,224,240
ds_read_b64_tr_b16 v[192:193], v115 offset:0
ds_read_b64_tr_b16 v[194:195], v115 offset:2048
Mvva 128,240,248
buffer_load_dwordx4 a[72:75], v112, s[8:11], s52 offen offset:0 sc1
Mvva 144,224,244
s_waitcnt lgkmcnt(10)
ds_read_b64_tr_b16 v[208:209], v115 offset:4096
ds_read_b64_tr_b16 v[210:211], v115 offset:6144
Mvva 144,240,252
Mvva 132,228,240
ds_read_b64_tr_b16 v[196:197], v116 offset:0
ds_read_b64_tr_b16 v[198:199], v116 offset:2048
Mvva 132,244,248
buffer_load_dwordx4 a[76:79], v112, s[8:11], s52 offen offset:1024 sc1
s_add_u32 s52, s52, 8192
Mvva 148,228,244
s_waitcnt lgkmcnt(10)
ds_read_b64_tr_b16 v[212:213], v116 offset:4096
ds_read_b64_tr_b16 v[214:215], v116 offset:6144
Mvva 148,244,252
buffer_load_dwordx4 a[80:83], v112, s[8:11], s52 offen offset:0 sc1
Mvva 136,232,240
ds_read_b64_tr_b16 v[200:201], v117 offset:0
ds_read_b64_tr_b16 v[202:203], v117 offset:2048
Mvva 136,248,248
buffer_load_dwordx4 a[84:87], v112, s[8:11], s52 offen offset:1024 sc1
s_add_u32 s52, s52, 8192
Mvva 152,232,244
s_waitcnt lgkmcnt(10)
ds_read_b64_tr_b16 v[216:217], v117 offset:4096
ds_read_b64_tr_b16 v[218:219], v117 offset:6144
Mvva 152,248,252
Mvva 140,236,240
ds_read_b64_tr_b16 v[204:205], v118 offset:0
ds_read_b64_tr_b16 v[206:207], v118 offset:2048
Mvva 140,252,248
buffer_load_dwordx4 a[88:91], v112, s[8:11], s52 offen offset:0 sc1
Mvva 156,236,244
s_waitcnt lgkmcnt(10)
ds_read_b64_tr_b16 v[220:221], v118 offset:4096
ds_read_b64_tr_b16 v[222:223], v118 offset:6144
Mvva 156,252,252
buffer_load_dwordx4 a[92:95], v112, s[8:11], s52 offen offset:1024 sc1
s_add_u32 s52, s52, 8192
s_waitcnt vmcnt(28)
Mvva 160,192,0
s_add_u32 m0, s44, 49152
ds_read_b64_tr_b16 v[224:225], v115 offset:8192
ds_read_b64_tr_b16 v[226:227], v115 offset:10240
Mvva 160,208,8
buffer_load_dwordx4 v114, s[12:15], s48 offen offset:0 lds
Mvva 176,192,4
s_waitcnt lgkmcnt(10)
ds_read_b64_tr_b16 v[240:241], v115 offset:12288
ds_read_b64_tr_b16 v[242:243], v115 offset:14336
Mvva 176,208,12
Mvva 164,196,0
ds_read_b64_tr_b16 v[228:229], v116 offset:8192
ds_read_b64_tr_b16 v[230:231], v116 offset:10240
Mvva 164,212,8
buffer_load_dwordx4 v114, s[12:15], s49 offen offset:1024 lds
Mvva 180,196,4
s_waitcnt lgkmcnt(10)
ds_read_b64_tr_b16 v[244:245], v116 offset:12288
ds_read_b64_tr_b16 v[246:247], v116 offset:14336
Mvva 180,212,12
buffer_load_dwordx4 v114, s[12:15], s50 offen offset:2048 lds
Mvva 168,200,0
ds_read_b64_tr_b16 v[232:233], v117 offset:8192
ds_read_b64_tr_b16 v[234:235], v117 offset:10240
Mvva 168,216,8
buffer_load_dwordx4 v114, s[12:15], s51 offen offset:3072 lds
v_add_u32 v114, 262144, v114
Mvva 184,200,4
s_waitcnt lgkmcnt(10)
ds_read_b64_tr_b16 v[248:249], v117 offset:12288
ds_read_b64_tr_b16 v[250:251], v117 offset:14336
Mvva 184,216,12
Mvva 172,204,0
s_waitcnt vmcnt(24)
ds_read_b64_tr_b16 v[236:237], v118 offset:8192
ds_read_b64_tr_b16 v[238:239], v118 offset:10240
Mvva 172,220,8
s_waitcnt lgkmcnt(10)
buffer_load_dwordx4 a[96:99], v112, s[8:11], s52 offen offset:0 sc1
Mvva 188,204,4
s_barrier
ds_read_b64_tr_b16 v[252:253], v118 offset:12288
ds_read_b64_tr_b16 v[254:255], v118 offset:14336
Mvva 188,220,12
buffer_load_dwordx4 a[100:103], v112, s[8:11], s52 offen offset:1024 sc1
s_add_u32 s52, s52, 8192
Mvva 160,224,16
ds_read_b64_tr_b16 v[192:193], v115 offset:16384
ds_read_b64_tr_b16 v[194:195], v115 offset:18432
Mvva 160,240,24
buffer_load_dwordx4 a[104:107], v112, s[8:11], s52 offen offset:0 sc1
Mvva 176,224,20
s_waitcnt lgkmcnt(10)
ds_read_b64_tr_b16 v[208:209], v115 offset:20480
ds_read_b64_tr_b16 v[210:211], v115 offset:22528
Mvva 176,240,28
Mvva 164,228,16
ds_read_b64_tr_b16 v[196:197], v116 offset:16384
ds_read_b64_tr_b16 v[198:199], v116 offset:18432
Mvva 164,244,24
buffer_load_dwordx4 a[108:111], v112, s[8:11], s52 offen offset:1024 sc1
s_add_u32 s52, s52, 8192
Mvva 180,228,20
s_waitcnt lgkmcnt(10)
ds_read_b64_tr_b16 v[212:213], v116 offset:20480
ds_read_b64_tr_b16 v[214:215], v116 offset:22528
Mvva 180,244,28
buffer_load_dwordx4 a[112:115], v112, s[8:11], s52 offen offset:0 sc1
Mvva 168,232,16
ds_read_b64_tr_b16 v[200:201], v117 offset:16384
ds_read_b64_tr_b16 v[202:203], v117 offset:18432
Mvva 168,248,24
buffer_load_dwordx4 a[116:119], v112, s[8:11], s52 offen offset:1024 sc1
s_add_u32 s52, s52, 8192
Mvva 184,232,20
s_waitcnt lgkmcnt(10)
ds_read_b64_tr_b16 v[216:217], v117 offset:20480
ds_read_b64_tr_b16 v[218:219], v117 offset:22528
Mvva 184,248,28
Mvva 172,236,16
ds_read_b64_tr_b16 v[204:205], v118 offset:16384
ds_read_b64_tr_b16 v[206:207], v118 offset:18432
Mvva 172,252,24
buffer_load_dwordx4 a[120:123], v112, s[8:11], s52 offen offset:0 sc1
Mvva 188,236,20
s_waitcnt lgkmcnt(10)
ds_read_b64_tr_b16 v[220:221], v118 offset:20480
ds_read_b64_tr_b16 v[222:223], v118 offset:22528
Mvva 188,252,28
buffer_load_dwordx4 a[124:127], v112, s[8:11], s52 offen offset:1024 sc1
s_add_u32 s52, s52, 8192
s_waitcnt vmcnt(28)
Mvva 160,192,32
s_add_u32 m0, s44, 65536
ds_read_b64_tr_b16 v[224:225], v115 offset:24576
ds_read_b64_tr_b16 v[226:227], v115 offset:26624
Mvva 160,208,40
buffer_load_dwordx4 v114, s[12:15], s48 offen offset:0 lds
Mvva 176,192,36
s_waitcnt lgkmcnt(10)
ds_read_b64_tr_b16 v[240:241], v115 offset:28672
ds_read_b64_tr_b16 v[242:243], v115 offset:30720
Mvva 176,208,44
Mvva 164,196,32
ds_read_b64_tr_b16 v[228:229], v116 offset:24576
ds_read_b64_tr_b16 v[230:231], v116 offset:26624
Mvva 164,212,40
buffer_load_dwordx4 v114, s[12:15], s49 offen offset:1024 lds
Mvva 180,196,36
s_waitcnt lgkmcnt(10)
ds_read_b64_tr_b16 v[244:245], v116 offset:28672
ds_read_b64_tr_b16 v[246:247], v116 offset:30720
Mvva 180,212,44
buffer_load_dwordx4 v114, s[12:15], s50 offen offset:2048 lds
Mvva 168,200,32
ds_read_b64_tr_b16 v[232:233], v117 offset:24576
ds_read_b64_tr_b16 v[234:235], v117 offset:26624
Mvva 168,216,40
buffer_load_dwordx4 v114, s[12:15], s51 offen offset:3072 lds
v_add_u32 v114, 262144, v114
Mvva 184,200,36
s_waitcnt lgkmcnt(10)
ds_read_b64_tr_b16 v[248:249], v117 offset:28672
ds_read_b64_tr_b16 v[250:251], v117 offset:30720
Mvva 184,216,44
Mvva 172,204,32
s_waitcnt vmcnt(24)
ds_read_b64_tr_b16 v[236:237], v118 offset:24576
ds_read_b64_tr_b16 v[238:239], v118 offset:26624
Mvva 172,220,40
s_waitcnt lgkmcnt(10)
buffer_load_dwordx4 a[128:131], v112, s[8:11], s52 offen offset:0 sc1
Mvva 188,204,36
s_barrier
ds_read_b64_tr_b16 v[252:253], v118 offset:28672
ds_read_b64_tr_b16 v[254:255], v118 offset:30720
Mvva 188,220,44
buffer_load_dwordx4 a[132:135], v112, s[8:11], s52 offen offset:1024 sc1
s_add_u32 s52, s52, 8192
Mvva 160,224,48
ds_read_b64_tr_b16 v[192:193], v115 offset:32768
ds_read_b64_tr_b16 v[194:195], v115 offset:34816
Mvva 160,240,56
buffer_load_dwordx4 a[136:139], v112, s[8:11], s52 offen offset:0 sc1
Mvva 176,224,52
s_waitcnt lgkmcnt(10)
ds_read_b64_tr_b16 v[208:209], v115 offset:36864
ds_read_b64_tr_b16 v[210:211], v115 offset:38912
Mvva 176,240,60
Mvva 164,228,48
ds_read_b64_tr_b16 v[196:197], v116 offset:32768
ds_read_b64_tr_b16 v[198:199], v116 offset:34816
Mvva 164,244,56
buffer_load_dwordx4 a[140:143], v112, s[8:11], s52 offen offset:1024 sc1
s_add_u32 s52, s52, 8192
Mvva 180,228,52
s_waitcnt lgkmcnt(10)
ds_read_b64_tr_b16 v[212:213], v116 offset:36864
ds_read_b64_tr_b16 v[214:215], v116 offset:38912
Mvva 180,244,60
buffer_load_dwordx4 a[144:147], v112, s[8:11], s52 offen offset:0 sc1
Mvva 168,232,48
ds_read_b64_tr_b16 v[200:201], v117 offset:32768
ds_read_b64_tr_b16 v[202:203], v117 offset:34816
Mvva 168,248,56
buffer_load_dwordx4 a[148:151], v112, s[8:11], s52 offen offset:1024 sc1
s_add_u32 s52, s52, 8192
Mvva 184,232,52
s_waitcnt lgkmcnt(10)
ds_read_b64_tr_b16 v[216:217], v117 offset:36864
ds_read_b64_tr_b16 v[218:219], v117 offset:38912
Mvva 184,248,60
Mvva 172,236,48
ds_read_b64_tr_b16 v[204:205], v118 offset:32768
ds_read_b64_tr_b16 v[206:207], v118 offset:34816
Mvva 172,252,56
buffer_load_dwordx4 a[152:155], v112, s[8:11], s52 offen offset:0 sc1
Mvva 188,236,52
s_waitcnt lgkmcnt(10)
ds_read_b64_tr_b16 v[220:221], v118 offset:36864
ds_read_b64_tr_b16 v[222:223], v118 offset:38912
Mvva 188,252,60
buffer_load_dwordx4 a[156:159], v112, s[8:11], s52 offen offset:1024 sc1
s_add_u32 s52, s52, 8192
s_waitcnt vmcnt(28)
Mvva 160,192,64
s_add_u32 m0, s44, 81920
ds_read_b64_tr_b16 v[224:225], v115 offset:40960
ds_read_b64_tr_b16 v[226:227], v115 offset:43008
Mvva 160,208,72
buffer_load_dwordx4 v114, s[12:15], s48 offen offset:0 lds
Mvva 176,192,68
s_waitcnt lgkmcnt(10)
ds_read_b64_tr_b16 v[240:241], v115 offset:45056
ds_read_b64_tr_b16 v[242:243], v115 offset:47104
Mvva 176,208,76
Mvva 164,196,64
ds_read_b64_tr_b16 v[228:229], v116 offset:40960
ds_read_b64_tr_b16 v[230:231], v116 offset:43008
Mvva 164,212,72
buffer_load_dwordx4 v114, s[12:15], s49 offen offset:1024 lds
Mvva 180,196,68
s_waitcnt lgkmcnt(10)
ds_read_b64_tr_b16 v[244:245], v116 offset:45056
ds_read_b64_tr_b16 v[246:247], v116 offset:47104
Mvva 180,212,76
buffer_load_dwordx4 v114, s[12:15], s50 offen offset:2048 lds
Mvva 168,200,64
ds_read_b64_tr_b16 v[232:233], v117 offset:40960
ds_read_b64_tr_b16 v[234:235], v117 offset:43008
Mvva 168,216,72
buffer_load_dwordx4 v114, s[12:15], s51 offen offset:3072 lds
v_add_u32 v114, 262144, v114
Mvva 184,200,68
s_waitcnt lgkmcnt(10)
ds_read_b64_tr_b16 v[248:249], v117 offset:45056
ds_read_b64_tr_b16 v[250:251], v117 offset:47104
Mvva 184,216,76
Mvva 172,204,64
s_waitcnt vmcnt(24)
ds_read_b64_tr_b16 v[236:237], v118 offset:40960
ds_read_b64_tr_b16 v[238:239], v118 offset:43008
Mvva 172,220,72
s_waitcnt lgkmcnt(10)
buffer_load_dwordx4 a[160:163], v112, s[8:11], s52 offen offset:0 sc1
Mvva 188,204,68
s_barrier
ds_read_b64_tr_b16 v[252:253], v118 offset:45056
ds_read_b64_tr_b16 v[254:255], v118 offset:47104
Mvva 188,220,76
buffer_load_dwordx4 a[164:167], v112, s[8:11], s52 offen offset:1024 sc1
s_add_u32 s52, s52, 8192
Mvva 160,224,80
ds_read_b64_tr_b16 v[192:193], v115 offset:49152
ds_read_b64_tr_b16 v[194:195], v115 offset:51200
Mvva 160,240,88
buffer_load_dwordx4 a[168:171], v112, s[8:11], s52 offen offset:0 sc1
Mvva 176,224,84
s_waitcnt lgkmcnt(10)
ds_read_b64_tr_b16 v[208:209], v115 offset:53248
ds_read_b64_tr_b16 v[210:211], v115 offset:55296
Mvva 176,240,92
Mvva 164,228,80
ds_read_b64_tr_b16 v[196:197], v116 offset:49152
ds_read_b64_tr_b16 v[198:199], v116 offset:51200
Mvva 164,244,88
buffer_load_dwordx4 a[172:175], v112, s[8:11], s52 offen offset:1024 sc1
s_add_u32 s52, s52, 8192
Mvva 180,228,84
s_waitcnt lgkmcnt(10)
ds_read_b64_tr_b16 v[212:213], v116 offset:53248
ds_read_b64_tr_b16 v[214:215], v116 offset:55296
Mvva 180,244,92
buffer_load_dwordx4 a[176:179], v112, s[8:11], s52 offen offset:0 sc1
Mvva 168,232,80
ds_read_b64_tr_b16 v[200:201], v117 offset:49152
ds_read_b64_tr_b16 v[202:203], v117 offset:51200
Mvva 168,248,88
buffer_load_dwordx4 a[180:183], v112, s[8:11], s52 offen offset:1024 sc1
s_add_u32 s52, s52, 8192
Mvva 184,232,84
s_waitcnt lgkmcnt(10)
ds_read_b64_tr_b16 v[216:217], v117 offset:53248
ds_read_b64_tr_b16 v[218:219], v117 offset:55296
Mvva 184,248,92
Mvva 172,236,80
ds_read_b64_tr_b16 v[204:205], v118 offset:49152
ds_read_b64_tr_b16 v[206:207], v118 offset:51200
Mvva 172,252,88
buffer_load_dwordx4 a[184:187], v112, s[8:11], s52 offen offset:0 sc1
Mvva 188,236,84
s_waitcnt lgkmcnt(10)
ds_read_b64_tr_b16 v[220:221], v118 offset:53248
ds_read_b64_tr_b16 v[222:223], v118 offset:55296
Mvva 188,252,92
buffer_load_dwordx4 a[188:191], v112, s[8:11], s52 offen offset:1024 sc1
s_add_u32 s52, s52, 8192
s_waitcnt vmcnt(28)
Mvva 160,192,96
s_add_u32 m0, s44, 98304
ds_read_b64_tr_b16 v[224:225], v115 offset:57344
ds_read_b64_tr_b16 v[226:227], v115 offset:59392
Mvva 160,208,104
buffer_load_dwordx4 v114, s[12:15], s48 offen offset:0 lds
Mvva 176,192,100
s_waitcnt lgkmcnt(10)
ds_read_b64_tr_b16 v[240:241], v115 offset:61440
ds_read_b64_tr_b16 v[242:243], v115 offset:63488
Mvva 176,208,108
s_cmp_lg_u32 s53, 0
s_cbranch_scc1 L_yA
L_yAr:
Mvva 164,196,96
ds_read_b64_tr_b16 v[228:229], v116 offset:57344
ds_read_b64_tr_b16 v[230:231], v116 offset:59392
Mvva 164,212,104
buffer_load_dwordx4 v114, s[12:15], s49 offen offset:1024 lds
Mvva 180,196,100
s_waitcnt lgkmcnt(10)
ds_read_b64_tr_b16 v[244:245], v116 offset:61440
ds_read_b64_tr_b16 v[246:247], v116 offset:63488
Mvva 180,212,108
buffer_load_dwordx4 v114, s[12:15], s50 offen offset:2048 lds
Mvva 168,200,96
ds_read_b64_tr_b16 v[232:233], v117 offset:57344
ds_read_b64_tr_b16 v[234:235], v117 offset:59392
Mvva 168,216,104
buffer_load_dwordx4 v114, s[12:15], s51 offen offset:3072 lds
v_add_u32 v114, 262144, v114
Mvva 184,200,100
s_waitcnt lgkmcnt(10)
ds_read_b64_tr_b16 v[248:249], v117 offset:61440
ds_read_b64_tr_b16 v[250:251], v117 offset:63488
Mvva 184,216,108
Mvva 172,204,96
s_waitcnt vmcnt(24)
ds_read_b64_tr_b16 v[236:237], v118 offset:57344
ds_read_b64_tr_b16 v[238:239], v118 offset:59392
Mvva 172,220,104
s_waitcnt lgkmcnt(10)
buffer_load_dwordx4 a[192:195], v112, s[8:11], s52 offen offset:0 sc1
Mvva 188,204,100
s_barrier
ds_read_b64_tr_b16 v[252:253], v118 offset:61440
ds_read_b64_tr_b16 v[254:255], v118 offset:63488
Mvva 188,220,108
buffer_load_dwordx4 a[196:199], v112, s[8:11], s52 offen offset:1024 sc1
s_add_u32 s52, s52, 8192
Mvva 160,224,112
ds_read_b64_tr_b16 v[192:193], v12 offset:0
ds_read_b64_tr_b16 v[194:195], v12 offset:2048
Mvva 160,240,120
buffer_load_dwordx4 a[200:203], v112, s[8:11], s52 offen offset:0 sc1
Mvva 176,224,116
s_waitcnt lgkmcnt(10)
ds_read_b64_tr_b16 v[208:209], v12 offset:4096
ds_read_b64_tr_b16 v[210:211], v12 offset:6144
Mvva 176,240,124
Mvva 164,228,112
ds_read_b64_tr_b16 v[196:197], v13 offset:0
ds_read_b64_tr_b16 v[198:199], v13 offset:2048
Mvva 164,244,120
buffer_load_dwordx4 a[204:207], v112, s[8:11], s52 offen offset:1024 sc1
s_add_u32 s52, s52, 8192
Mvva 180,228,116
s_waitcnt lgkmcnt(10)
ds_read_b64_tr_b16 v[212:213], v13 offset:4096
ds_read_b64_tr_b16 v[214:215], v13 offset:6144
Mvva 180,244,124
buffer_load_dwordx4 a[208:211], v112, s[8:11], s52 offen offset:0 sc1
Mvva 168,232,112
ds_read_b64_tr_b16 v[200:201], v14 offset:0
ds_read_b64_tr_b16 v[202:203], v14 offset:2048
Mvva 168,248,120
buffer_load_dwordx4 a[212:215], v112, s[8:11], s52 offen offset:1024 sc1
s_add_u32 s52, s52, 8192
Mvva 184,232,116
s_waitcnt lgkmcnt(10)
ds_read_b64_tr_b16 v[216:217], v14 offset:4096
ds_read_b64_tr_b16 v[218:219], v14 offset:6144
Mvva 184,248,124
Mvva 172,236,112
ds_read_b64_tr_b16 v[204:205], v15 offset:0
ds_read_b64_tr_b16 v[206:207], v15 offset:2048
Mvva 172,252,120
buffer_load_dwordx4 a[216:219], v112, s[8:11], s52 offen offset:0 sc1
Mvva 188,236,116
s_waitcnt lgkmcnt(10)
ds_read_b64_tr_b16 v[220:221], v15 offset:4096
ds_read_b64_tr_b16 v[222:223], v15 offset:6144
Mvva 188,252,124
buffer_load_dwordx4 a[220:223], v112, s[8:11], s52 offen offset:1024 sc1
s_add_u32 s52, s52, 8192
s_waitcnt vmcnt(28)
Mvva 160,192,128
s_add_u32 m0, s44, 114688
ds_read_b64_tr_b16 v[224:225], v12 offset:8192
ds_read_b64_tr_b16 v[226:227], v12 offset:10240
Mvva 160,208,136
buffer_load_dwordx4 v114, s[12:15], s48 offen offset:0 lds
Mvva 176,192,132
s_waitcnt lgkmcnt(10)
ds_read_b64_tr_b16 v[240:241], v12 offset:12288
ds_read_b64_tr_b16 v[242:243], v12 offset:14336
Mvva 176,208,140
Mvva 164,196,128
ds_read_b64_tr_b16 v[228:229], v13 offset:8192
ds_read_b64_tr_b16 v[230:231], v13 offset:10240
Mvva 164,212,136
buffer_load_dwordx4 v114, s[12:15], s49 offen offset:1024 lds
Mvva 180,196,132
s_waitcnt lgkmcnt(10)
ds_read_b64_tr_b16 v[244:245], v13 offset:12288
ds_read_b64_tr_b16 v[246:247], v13 offset:14336
Mvva 180,212,140
buffer_load_dwordx4 v114, s[12:15], s50 offen offset:2048 lds
Mvva 168,200,128
ds_read_b64_tr_b16 v[232:233], v14 offset:8192
ds_read_b64_tr_b16 v[234:235], v14 offset:10240
Mvva 168,216,136
buffer_load_dwordx4 v114, s[12:15], s51 offen offset:3072 lds
s_xor_b32 s95, s95, 128
v_add_u32 v114, s95, v113
Mvva 184,200,132
s_waitcnt lgkmcnt(10)
ds_read_b64_tr_b16 v[248:249], v14 offset:12288
ds_read_b64_tr_b16 v[250:251], v14 offset:14336
Mvva 184,216,140
Mvva 172,204,128
s_waitcnt vmcnt(24)
ds_read_b64_tr_b16 v[236:237], v15 offset:8192
ds_read_b64_tr_b16 v[238:239], v15 offset:10240
Mvva 172,220,136
s_waitcnt lgkmcnt(10)
buffer_load_dwordx4 a[224:227], v112, s[8:11], s52 offen offset:0 sc1
Mvva 188,204,132
s_barrier
ds_read_b64_tr_b16 v[252:253], v15 offset:12288
ds_read_b64_tr_b16 v[254:255], v15 offset:14336
Mvva 188,220,140
buffer_load_dwordx4 a[228:231], v112, s[8:11], s52 offen offset:1024 sc1
s_add_u32 s52, s52, 8192
Mvva 160,224,144
ds_read_b64_tr_b16 v[192:193], v12 offset:16384
ds_read_b64_tr_b16 v[194:195], v12 offset:18432
Mvva 160,240,152
buffer_load_dwordx4 a[232:235], v112, s[8:11], s52 offen offset:0 sc1
Mvva 176,224,148
s_waitcnt lgkmcnt(10)
ds_read_b64_tr_b16 v[208:209], v12 offset:20480
ds_read_b64_tr_b16 v[210:211], v12 offset:22528
Mvva 176,240,156
Mvva 164,228,144
ds_read_b64_tr_b16 v[196:197], v13 offset:16384
ds_read_b64_tr_b16 v[198:199], v13 offset:18432
Mvva 164,244,152
buffer_load_dwordx4 a[236:239], v112, s[8:11], s52 offen offset:1024 sc1
s_add_u32 s52, s52, 8192
Mvva 180,228,148
s_waitcnt lgkmcnt(10)
ds_read_b64_tr_b16 v[212:213], v13 offset:20480
ds_read_b64_tr_b16 v[214:215], v13 offset:22528
Mvva 180,244,156
buffer_load_dwordx4 a[240:243], v112, s[8:11], s52 offen offset:0 sc1
Mvva 168,232,144
ds_read_b64_tr_b16 v[200:201], v14 offset:16384
ds_read_b64_tr_b16 v[202:203], v14 offset:18432
Mvva 168,248,152
buffer_load_dwordx4 a[244:247], v112, s[8:11], s52 offen offset:1024 sc1
s_add_u32 s52, s52, 8192
Mvva 184,232,148
s_waitcnt lgkmcnt(10)
ds_read_b64_tr_b16 v[216:217], v14 offset:20480
ds_read_b64_tr_b16 v[218:219], v14 offset:22528
Mvva 184,248,156
Mvva 172,236,144
ds_read_b64_tr_b16 v[204:205], v15 offset:16384
ds_read_b64_tr_b16 v[206:207], v15 offset:18432
Mvva 172,252,152
buffer_load_dwordx4 a[248:251], v112, s[8:11], s52 offen offset:0 sc1
Mvva 188,236,148
s_waitcnt lgkmcnt(10)
ds_read_b64_tr_b16 v[220:221], v15 offset:20480
ds_read_b64_tr_b16 v[222:223], v15 offset:22528
Mvva 188,252,156
buffer_load_dwordx4 a[252:255], v112, s[8:11], s52 offen offset:1024 sc1
s_add_u32 s52, s52, 8192
s_waitcnt vmcnt(28)
Mvva 160,192,160
s_add_u32 m0, s44, 0
ds_read_b64_tr_b16 v[224:225], v12 offset:24576
ds_read_b64_tr_b16 v[226:227], v12 offset:26624
Mvva 160,208,168
buffer_load_dwordx4 v114, s[12:15], s48 offen offset:0 lds
Mvva 176,192,164
s_waitcnt lgkmcnt(10)
ds_read_b64_tr_b16 v[240:241], v12 offset:28672
ds_read_b64_tr_b16 v[242:243], v12 offset:30720
Mvva 176,208,172
Mvva 164,196,160
ds_read_b64_tr_b16 v[228:229], v13 offset:24576
ds_read_b64_tr_b16 v[230:231], v13 offset:26624
Mvva 164,212,168
buffer_load_dwordx4 v114, s[12:15], s49 offen offset:1024 lds
Mvva 180,196,164
s_waitcnt lgkmcnt(10)
ds_read_b64_tr_b16 v[244:245], v13 offset:28672
ds_read_b64_tr_b16 v[246:247], v13 offset:30720
Mvva 180,212,172
buffer_load_dwordx4 v114, s[12:15], s50 offen offset:2048 lds
Mvva 168,200,160
ds_read_b64_tr_b16 v[232:233], v14 offset:24576
ds_read_b64_tr_b16 v[234:235], v14 offset:26624
Mvva 168,216,168
buffer_load_dwordx4 v114, s[12:15], s51 offen offset:3072 lds
v_add_u32 v114, 262144, v114
Mvva 184,200,164
s_waitcnt lgkmcnt(10)
ds_read_b64_tr_b16 v[248:249], v14 offset:28672
ds_read_b64_tr_b16 v[250:251], v14 offset:30720
Mvva 184,216,172
Mvva 172,204,160
s_waitcnt vmcnt(24)
s_add_u32 m0, s44, 16384
ds_read_b64_tr_b16 v[236:237], v15 offset:24576
ds_read_b64_tr_b16 v[238:239], v15 offset:26624
Mvva 172,220,168
s_waitcnt lgkmcnt(10)
buffer_load_dwordx4 v114, s[12:15], s48 offen offset:0 lds
Mvva 188,204,164
s_barrier
ds_read_b64_tr_b16 v[252:253], v15 offset:28672
ds_read_b64_tr_b16 v[254:255], v15 offset:30720
Mvva 188,220,172
buffer_load_dwordx4 v114, s[12:15], s49 offen offset:1024 lds
Mvva 160,224,176
ds_read_b64_tr_b16 v[192:193], v12 offset:32768
ds_read_b64_tr_b16 v[194:195], v12 offset:34816
Mvva 160,240,184
buffer_load_dwordx4 v114, s[12:15], s50 offen offset:2048 lds
Mvva 176,224,180
s_waitcnt lgkmcnt(10)
ds_read_b64_tr_b16 v[208:209], v12 offset:36864
ds_read_b64_tr_b16 v[210:211], v12 offset:38912
Mvva 176,240,188
s_cmp_lg_u32 s53, 0
s_cbranch_scc1 L_yB
L_yBr:
Mvva 164,228,176
ds_read_b64_tr_b16 v[196:197], v13 offset:32768
ds_read_b64_tr_b16 v[198:199], v13 offset:34816
Mvva 164,244,184
buffer_load_dwordx4 v114, s[12:15], s51 offen offset:3072 lds
v_add_u32 v114, 262144, v114
Mvva 180,228,180
s_waitcnt lgkmcnt(10)
s_add_u32 m0, s44, 32768
ds_read_b64_tr_b16 v[212:213], v13 offset:36864
ds_read_b64_tr_b16 v[214:215], v13 offset:38912
Mvva 180,244,188
buffer_load_dwordx4 v114, s[12:15], s48 offen offset:0 lds
Mvva 168,232,176
ds_read_b64_tr_b16 v[200:201], v14 offset:32768
ds_read_b64_tr_b16 v[202:203], v14 offset:34816
Mvva 168,248,184
buffer_load_dwordx4 v114, s[12:15], s49 offen offset:1024 lds
Mvva 184,232,180
s_waitcnt lgkmcnt(10)
ds_read_b64_tr_b16 v[216:217], v14 offset:36864
ds_read_b64_tr_b16 v[218:219], v14 offset:38912
Mvva 184,248,188
Mvva 172,236,176
ds_read_b64_tr_b16 v[204:205], v15 offset:32768
ds_read_b64_tr_b16 v[206:207], v15 offset:34816
Mvva 172,252,184
buffer_load_dwordx4 v114, s[12:15], s50 offen offset:2048 lds
Mvva 188,236,180
s_waitcnt lgkmcnt(10)
ds_read_b64_tr_b16 v[220:221], v15 offset:36864
ds_read_b64_tr_b16 v[222:223], v15 offset:38912
Mvva 188,252,188
buffer_load_dwordx4 v114, s[12:15], s51 offen offset:3072 lds
v_add_u32 v114, 262144, v114
s_waitcnt vmcnt(28)
Mvva 160,192,192
ds_read_b64_tr_b16 v[224:225], v12 offset:40960
ds_read_b64_tr_b16 v[226:227], v12 offset:43008
Mvva 160,208,200
Mvva 176,192,196
s_waitcnt lgkmcnt(10)
s_add_u32 m0, s44, 49152
ds_read_b64_tr_b16 v[240:241], v12 offset:45056
ds_read_b64_tr_b16 v[242:243], v12 offset:47104
Mvva 176,208,204
buffer_load_dwordx4 v114, s[12:15], s48 offen offset:0 lds
Mvva 164,196,192
ds_read_b64_tr_b16 v[228:229], v13 offset:40960
ds_read_b64_tr_b16 v[230:231], v13 offset:43008
Mvva 164,212,200
Mvva 180,196,196
s_waitcnt lgkmcnt(10)
ds_read_b64_tr_b16 v[244:245], v13 offset:45056
ds_read_b64_tr_b16 v[246:247], v13 offset:47104
Mvva 180,212,204
buffer_load_dwordx4 v114, s[12:15], s49 offen offset:1024 lds
Mvva 168,200,192
ds_read_b64_tr_b16 v[232:233], v14 offset:40960
ds_read_b64_tr_b16 v[234:235], v14 offset:43008
Mvva 168,216,200
Mvva 184,200,196
s_waitcnt lgkmcnt(10)
ds_read_b64_tr_b16 v[248:249], v14 offset:45056
ds_read_b64_tr_b16 v[250:251], v14 offset:47104
Mvva 184,216,204
buffer_load_dwordx4 v114, s[12:15], s50 offen offset:2048 lds
Mvva 172,204,192
s_waitcnt vmcnt(23)
ds_read_b64_tr_b16 v[236:237], v15 offset:40960
ds_read_b64_tr_b16 v[238:239], v15 offset:43008
Mvva 172,220,200
s_waitcnt lgkmcnt(10)
Mvva 188,204,196
s_barrier
ds_read_b64_tr_b16 v[252:253], v15 offset:45056
ds_read_b64_tr_b16 v[254:255], v15 offset:47104
Mvva 188,220,204
buffer_load_dwordx4 v114, s[12:15], s51 offen offset:3072 lds
v_add_u32 v114, 262144, v114
Mvva 160,224,208
ds_read_b64_tr_b16 v[192:193], v12 offset:49152
ds_read_b64_tr_b16 v[194:195], v12 offset:51200
Mvva 160,240,216
Mvva 176,224,212
s_waitcnt lgkmcnt(10)
s_add_u32 m0, s44, 65536
ds_read_b64_tr_b16 v[208:209], v12 offset:53248
ds_read_b64_tr_b16 v[210:211], v12 offset:55296
Mvva 176,240,220
buffer_load_dwordx4 v114, s[12:15], s48 offen offset:0 lds
Mvva 164,228,208
ds_read_b64_tr_b16 v[196:197], v13 offset:49152
ds_read_b64_tr_b16 v[198:199], v13 offset:51200
Mvva 164,244,216
Mvva 180,228,212
s_waitcnt lgkmcnt(10)
ds_read_b64_tr_b16 v[212:213], v13 offset:53248
ds_read_b64_tr_b16 v[214:215], v13 offset:55296
Mvva 180,244,220
buffer_load_dwordx4 v114, s[12:15], s49 offen offset:1024 lds
Mvva 168,232,208
ds_read_b64_tr_b16 v[200:201], v14 offset:49152
ds_read_b64_tr_b16 v[202:203], v14 offset:51200
Mvva 168,248,216
Mvva 184,232,212
s_waitcnt lgkmcnt(10)
ds_read_b64_tr_b16 v[216:217], v14 offset:53248
ds_read_b64_tr_b16 v[218:219], v14 offset:55296
Mvva 184,248,220
buffer_load_dwordx4 v114, s[12:15], s50 offen offset:2048 lds
Mvva 172,236,208
ds_read_b64_tr_b16 v[204:205], v15 offset:49152
ds_read_b64_tr_b16 v[206:207], v15 offset:51200
Mvva 172,252,216
Mvva 188,236,212
s_waitcnt lgkmcnt(10)
ds_read_b64_tr_b16 v[220:221], v15 offset:53248
ds_read_b64_tr_b16 v[222:223], v15 offset:55296
Mvva 188,252,220
buffer_load_dwordx4 v114, s[12:15], s51 offen offset:3072 lds
v_add_u32 v114, 262144, v114
s_waitcnt vmcnt(24)
Mvva 160,192,224
ds_read_b64_tr_b16 v[224:225], v12 offset:57344
ds_read_b64_tr_b16 v[226:227], v12 offset:59392
Mvva 160,208,232
Mvva 176,192,228
s_waitcnt lgkmcnt(10)
ds_read_b64_tr_b16 v[240:241], v12 offset:61440
ds_read_b64_tr_b16 v[242:243], v12 offset:63488
Mvva 176,208,236
Mvva 164,196,224
s_add_u32 m0, s44, 81920
ds_read_b64_tr_b16 v[228:229], v13 offset:57344
ds_read_b64_tr_b16 v[230:231], v13 offset:59392
Mvva 164,212,232
buffer_load_dwordx4 v114, s[12:15], s48 offen offset:0 lds
Mvva 180,196,228
s_waitcnt lgkmcnt(10)
ds_read_b64_tr_b16 v[244:245], v13 offset:61440
ds_read_b64_tr_b16 v[246:247], v13 offset:63488
Mvva 180,212,236
Mvva 168,200,224
ds_read_b64_tr_b16 v[232:233], v14 offset:57344
ds_read_b64_tr_b16 v[234:235], v14 offset:59392
Mvva 168,216,232
Mvva 184,200,228
s_waitcnt lgkmcnt(10)
ds_read_b64_tr_b16 v[248:249], v14 offset:61440
ds_read_b64_tr_b16 v[250:251], v14 offset:63488
Mvva 184,216,236
Mvva 172,204,224
s_waitcnt vmcnt(17)
ds_read_b64_tr_b16 v[236:237], v15 offset:57344
ds_read_b64_tr_b16 v[238:239], v15 offset:59392
Mvva 172,220,232
s_waitcnt lgkmcnt(10)
buffer_load_dwordx4 v114, s[12:15], s49 offen offset:1024 lds
Mvva 188,204,228
s_barrier
ds_read_b64_tr_b16 v[252:253], v15 offset:61440
ds_read_b64_tr_b16 v[254:255], v15 offset:63488
Mvva 188,220,236
Mvva 160,224,240
ds_read_b64_tr_b16 v[192:193], v115 offset:0
ds_read_b64_tr_b16 v[194:195], v115 offset:2048
Mvva 160,240,248
s_cmp_lg_u32 s40, 0
s_cbranch_scc1 L_yC
L_yCr:
Mvva 176,224,244
s_waitcnt lgkmcnt(10)
ds_read_b64_tr_b16 v[208:209], v115 offset:4096
ds_read_b64_tr_b16 v[210:211], v115 offset:6144
Mvva 176,240,252
Mvva 164,228,240
ds_read_b64_tr_b16 v[196:197], v116 offset:0
ds_read_b64_tr_b16 v[198:199], v116 offset:2048
Mvva 164,244,248
buffer_load_dwordx4 v114, s[12:15], s50 offen offset:2048 lds
Mvva 180,228,244
s_waitcnt lgkmcnt(10)
ds_read_b64_tr_b16 v[212:213], v116 offset:4096
ds_read_b64_tr_b16 v[214:215], v116 offset:6144
Mvva 180,244,252
Mvva 168,232,240
ds_read_b64_tr_b16 v[200:201], v117 offset:0
ds_read_b64_tr_b16 v[202:203], v117 offset:2048
Mvva 168,248,248
Mvva 184,232,244
s_waitcnt lgkmcnt(10)
ds_read_b64_tr_b16 v[216:217], v117 offset:4096
ds_read_b64_tr_b16 v[218:219], v117 offset:6144
Mvva 184,248,252
Mvva 172,236,240
ds_read_b64_tr_b16 v[204:205], v118 offset:0
ds_read_b64_tr_b16 v[206:207], v118 offset:2048
Mvva 172,252,248
buffer_load_dwordx4 v114, s[12:15], s51 offen offset:3072 lds
v_add_u32 v114, 262144, v114
Mvva 188,236,244
s_waitcnt lgkmcnt(10)
ds_read_b64_tr_b16 v[220:221], v118 offset:4096
ds_read_b64_tr_b16 v[222:223], v118 offset:6144
Mvva 188,252,252
Mvva 128,192,0
ds_read_b64_tr_b16 v[224:225], v115 offset:8192
ds_read_b64_tr_b16 v[226:227], v115 offset:10240
Mvva 128,208,8
Mvva 144,192,4
s_waitcnt lgkmcnt(10)
ds_read_b64_tr_b16 v[240:241], v115 offset:12288
ds_read_b64_tr_b16 v[242:243], v115 offset:14336
Mvva 144,208,12
Mvva 132,196,0
s_add_u32 m0, s44, 98304
ds_read_b64_tr_b16 v[228:229], v116 offset:8192
ds_read_b64_tr_b16 v[230:231], v116 offset:10240
Mvva 132,212,8
buffer_load_dwordx4 v114, s[12:15], s48 offen offset:0 lds
Mvva 148,196,4
s_waitcnt lgkmcnt(10)
ds_read_b64_tr_b16 v[244:245], v116 offset:12288
ds_read_b64_tr_b16 v[246:247], v116 offset:14336
Mvva 148,212,12
v_add_u32 v10, 4096, v112
Mvva 136,200,0
ds_read_b64_tr_b16 v[232:233], v117 offset:8192
ds_read_b64_tr_b16 v[234:235], v117 offset:10240
Mvva 136,216,8
buffer_store_dwordx4 v[160:163], v112, s[16:19], s26 offen offset:0 sc1
Mvva 152,200,4
s_waitcnt lgkmcnt(10)
ds_read_b64_tr_b16 v[248:249], v117 offset:12288
ds_read_b64_tr_b16 v[250:251], v117 offset:14336
Mvva 152,216,12
buffer_store_dwordx4 v[164:167], v112, s[16:19], s26 offen offset:1024 sc1
Mvva 140,204,0
s_waitcnt vmcnt(19)
ds_read_b64_tr_b16 v[236:237], v118 offset:8192
ds_read_b64_tr_b16 v[238:239], v118 offset:10240
Mvva 140,220,8
s_waitcnt lgkmcnt(10)
buffer_load_dwordx4 v114, s[12:15], s49 offen offset:1024 lds
Mvva 156,204,4
s_barrier
ds_read_b64_tr_b16 v[252:253], v118 offset:12288
ds_read_b64_tr_b16 v[254:255], v118 offset:14336
Mvva 156,220,12
buffer_store_dwordx4 v[168:171], v112, s[16:19], s26 offen offset:2048 sc1
Mvva 128,224,16
ds_read_b64_tr_b16 v[192:193], v115 offset:16384
ds_read_b64_tr_b16 v[194:195], v115 offset:18432
Mvva 128,240,24
buffer_store_dwordx4 v[172:175], v112, s[16:19], s26 offen offset:3072 sc1
Mvva 144,224,20
s_waitcnt lgkmcnt(10)
ds_read_b64_tr_b16 v[208:209], v115 offset:20480
ds_read_b64_tr_b16 v[210:211], v115 offset:22528
Mvva 144,240,28
buffer_store_dwordx4 v[176:179], v10, s[16:19], s26 offen offset:0 sc1
Mvva 132,228,16
ds_read_b64_tr_b16 v[196:197], v116 offset:16384
ds_read_b64_tr_b16 v[198:199], v116 offset:18432
Mvva 132,244,24
buffer_load_dwordx4 v114, s[12:15], s50 offen offset:2048 lds
Mvva 148,228,20
s_waitcnt lgkmcnt(10)
ds_read_b64_tr_b16 v[212:213], v116 offset:20480
ds_read_b64_tr_b16 v[214:215], v116 offset:22528
Mvva 148,244,28
buffer_store_dwordx4 v[180:183], v10, s[16:19], s26 offen offset:1024 sc1
Mvva 136,232,16
ds_read_b64_tr_b16 v[200:201], v117 offset:16384
ds_read_b64_tr_b16 v[202:203], v117 offset:18432
Mvva 136,248,24
buffer_store_dwordx4 v[184:187], v10, s[16:19], s26 offen offset:2048 sc1
Mvva 152,232,20
s_waitcnt lgkmcnt(10)
ds_read_b64_tr_b16 v[216:217], v117 offset:20480
ds_read_b64_tr_b16 v[218:219], v117 offset:22528
Mvva 152,248,28
buffer_store_dwordx4 v[188:191], v10, s[16:19], s26 offen offset:3072 sc1
Mvva 140,236,16
ds_read_b64_tr_b16 v[204:205], v118 offset:16384
ds_read_b64_tr_b16 v[206:207], v118 offset:18432
Mvva 140,252,24
buffer_load_dwordx4 v114, s[12:15], s51 offen offset:3072 lds
v_add_u32 v114, 262144, v114
Mvva 156,236,20
s_waitcnt lgkmcnt(10)
ds_read_b64_tr_b16 v[220:221], v118 offset:20480
ds_read_b64_tr_b16 v[222:223], v118 offset:22528
Mvva 156,252,28
v_mov_b32_e64 v16, 1
Mvva 128,192,32
ds_read_b64_tr_b16 v[224:225], v115 offset:24576
ds_read_b64_tr_b16 v[226:227], v115 offset:26624
Mvva 128,208,40
Mvva 144,192,36
s_waitcnt lgkmcnt(10)
ds_read_b64_tr_b16 v[240:241], v115 offset:28672
ds_read_b64_tr_b16 v[242:243], v115 offset:30720
Mvva 144,208,44
Mvva 132,196,32
s_add_u32 m0, s44, 114688
ds_read_b64_tr_b16 v[228:229], v116 offset:24576
ds_read_b64_tr_b16 v[230:231], v116 offset:26624
Mvva 132,212,40
buffer_load_dwordx4 v114, s[12:15], s48 offen offset:0 lds
Mvva 148,196,36
s_waitcnt lgkmcnt(10)
ds_read_b64_tr_b16 v[244:245], v116 offset:28672
ds_read_b64_tr_b16 v[246:247], v116 offset:30720
Mvva 148,212,44
Mvva 136,200,32
ds_read_b64_tr_b16 v[232:233], v117 offset:24576
ds_read_b64_tr_b16 v[234:235], v117 offset:26624
Mvva 136,216,40
Mvva 152,200,36
s_waitcnt lgkmcnt(10)
ds_read_b64_tr_b16 v[248:249], v117 offset:28672
ds_read_b64_tr_b16 v[250:251], v117 offset:30720
Mvva 152,216,44
Mvva 140,204,32
s_waitcnt vmcnt(25)
ds_read_b64_tr_b16 v[236:237], v118 offset:24576
ds_read_b64_tr_b16 v[238:239], v118 offset:26624
Mvva 140,220,40
s_waitcnt lgkmcnt(10)
buffer_load_dwordx4 v114, s[12:15], s49 offen offset:1024 lds
Mvva 156,204,36
s_barrier
ds_read_b64_tr_b16 v[252:253], v118 offset:28672
ds_read_b64_tr_b16 v[254:255], v118 offset:30720
Mvva 156,220,44
Mvva 128,224,48
ds_read_b64_tr_b16 v[192:193], v115 offset:32768
ds_read_b64_tr_b16 v[194:195], v115 offset:34816
Mvva 128,240,56
Mvva 144,224,52
s_waitcnt lgkmcnt(10)
ds_read_b64_tr_b16 v[208:209], v115 offset:36864
ds_read_b64_tr_b16 v[210:211], v115 offset:38912
Mvva 144,240,60
Mvva 132,228,48
ds_read_b64_tr_b16 v[196:197], v116 offset:32768
ds_read_b64_tr_b16 v[198:199], v116 offset:34816
Mvva 132,244,56
buffer_load_dwordx4 v114, s[12:15], s50 offen offset:2048 lds
Mvva 148,228,52
s_waitcnt lgkmcnt(10)
ds_read_b64_tr_b16 v[212:213], v116 offset:36864
ds_read_b64_tr_b16 v[214:215], v116 offset:38912
Mvva 148,244,60
Mvva 136,232,48
ds_read_b64_tr_b16 v[200:201], v117 offset:32768
ds_read_b64_tr_b16 v[202:203], v117 offset:34816
Mvva 136,248,56
Mvva 152,232,52
s_waitcnt lgkmcnt(10)
ds_read_b64_tr_b16 v[216:217], v117 offset:36864
ds_read_b64_tr_b16 v[218:219], v117 offset:38912
Mvva 152,248,60
Mvva 140,236,48
ds_read_b64_tr_b16 v[204:205], v118 offset:32768
ds_read_b64_tr_b16 v[206:207], v118 offset:34816
Mvva 140,252,56
buffer_load_dwordx4 v114, s[12:15], s51 offen offset:3072 lds
v_add_u32 v114, 262144, v114
Mvva 156,236,52
s_waitcnt lgkmcnt(10)
ds_read_b64_tr_b16 v[220:221], v118 offset:36864
ds_read_b64_tr_b16 v[222:223], v118 offset:38912
Mvva 156,252,60
Mvva 128,192,64
ds_read_b64_tr_b16 v[224:225], v115 offset:40960
ds_read_b64_tr_b16 v[226:227], v115 offset:43008
Mvva 128,208,72
Mvva 144,192,68
s_waitcnt lgkmcnt(10)
ds_read_b64_tr_b16 v[240:241], v115 offset:45056
ds_read_b64_tr_b16 v[242:243], v115 offset:47104
Mvva 144,208,76
Mvva 132,196,64
ds_read_b64_tr_b16 v[228:229], v116 offset:40960
ds_read_b64_tr_b16 v[230:231], v116 offset:43008
Mvva 132,212,72
Mvva 148,196,68
s_waitcnt lgkmcnt(10)
ds_read_b64_tr_b16 v[244:245], v116 offset:45056
ds_read_b64_tr_b16 v[246:247], v116 offset:47104
Mvva 148,212,76
Mvva 136,200,64
ds_read_b64_tr_b16 v[232:233], v117 offset:40960
ds_read_b64_tr_b16 v[234:235], v117 offset:43008
Mvva 136,216,72
Mvva 152,200,68
s_waitcnt lgkmcnt(10)
ds_read_b64_tr_b16 v[248:249], v117 offset:45056
ds_read_b64_tr_b16 v[250:251], v117 offset:47104
Mvva 152,216,76
Mvva 140,204,64
s_waitcnt vmcnt(24)
ds_read_b64_tr_b16 v[236:237], v118 offset:40960
ds_read_b64_tr_b16 v[238:239], v118 offset:43008
Mvva 140,220,72
s_waitcnt lgkmcnt(10)
Mvva 156,204,68
s_barrier
ds_read_b64_tr_b16 v[252:253], v118 offset:45056
ds_read_b64_tr_b16 v[254:255], v118 offset:47104
Mvva 156,220,76
Mvva 128,224,80
ds_read_b64_tr_b16 v[192:193], v115 offset:49152
ds_read_b64_tr_b16 v[194:195], v115 offset:51200
Mvva 128,240,88
Mvva 144,224,84
s_waitcnt lgkmcnt(10)
ds_read_b64_tr_b16 v[208:209], v115 offset:53248
ds_read_b64_tr_b16 v[210:211], v115 offset:55296
Mvva 144,240,92
Mvva 132,228,80
ds_read_b64_tr_b16 v[196:197], v116 offset:49152
ds_read_b64_tr_b16 v[198:199], v116 offset:51200
Mvva 132,244,88
Mvva 148,228,84
s_waitcnt lgkmcnt(10)
ds_read_b64_tr_b16 v[212:213], v116 offset:53248
ds_read_b64_tr_b16 v[214:215], v116 offset:55296
Mvva 148,244,92
Mvva 136,232,80
ds_read_b64_tr_b16 v[200:201], v117 offset:49152
ds_read_b64_tr_b16 v[202:203], v117 offset:51200
Mvva 136,248,88
Mvva 152,232,84
s_waitcnt lgkmcnt(10)
ds_read_b64_tr_b16 v[216:217], v117 offset:53248
ds_read_b64_tr_b16 v[218:219], v117 offset:55296
Mvva 152,248,92
Mvva 140,236,80
ds_read_b64_tr_b16 v[204:205], v118 offset:49152
ds_read_b64_tr_b16 v[206:207], v118 offset:51200
Mvva 140,252,88
Mvva 156,236,84
s_waitcnt lgkmcnt(10)
ds_read_b64_tr_b16 v[220:221], v118 offset:53248
ds_read_b64_tr_b16 v[222:223], v118 offset:55296
Mvva 156,252,92
Mvva 128,192,96
ds_read_b64_tr_b16 v[224:225], v115 offset:57344
ds_read_b64_tr_b16 v[226:227], v115 offset:59392
Mvva 128,208,104
Mvva 144,192,100
s_waitcnt lgkmcnt(10)
ds_read_b64_tr_b16 v[240:241], v115 offset:61440
ds_read_b64_tr_b16 v[242:243], v115 offset:63488
Mvva 144,208,108
Mvva 132,196,96
ds_read_b64_tr_b16 v[228:229], v116 offset:57344
ds_read_b64_tr_b16 v[230:231], v116 offset:59392
Mvva 132,212,104
Mvva 148,196,100
s_waitcnt lgkmcnt(10)
ds_read_b64_tr_b16 v[244:245], v116 offset:61440
ds_read_b64_tr_b16 v[246:247], v116 offset:63488
Mvva 148,212,108
s_waitcnt vmcnt(5)
s_mov_b64 exec, 1
buffer_store_dword v16, v126, s[20:23], s27 offen sc1
s_mov_b64 exec, -1
Mvva 136,200,96
ds_read_b64_tr_b16 v[232:233], v117 offset:57344
ds_read_b64_tr_b16 v[234:235], v117 offset:59392
Mvva 136,216,104
Mvva 152,200,100
s_waitcnt lgkmcnt(10)
ds_read_b64_tr_b16 v[248:249], v117 offset:61440
ds_read_b64_tr_b16 v[250:251], v117 offset:63488
Mvva 152,216,108
Mvva 140,204,96
ds_read_b64_tr_b16 v[236:237], v118 offset:57344
ds_read_b64_tr_b16 v[238:239], v118 offset:59392
Mvva 140,220,104
s_waitcnt lgkmcnt(10)
Mvva 156,204,100
s_barrier
ds_read_b64_tr_b16 v[252:253], v118 offset:61440
ds_read_b64_tr_b16 v[254:255], v118 offset:63488
Mvva 156,220,108
Mvva 128,224,112
ds_read_b64_tr_b16 v[192:193], v12 offset:0
ds_read_b64_tr_b16 v[194:195], v12 offset:2048
Mvva 128,240,120
Mvva 144,224,116
s_waitcnt lgkmcnt(10)
ds_read_b64_tr_b16 v[208:209], v12 offset:4096
ds_read_b64_tr_b16 v[210:211], v12 offset:6144
Mvva 144,240,124
Mvva 132,228,112
ds_read_b64_tr_b16 v[196:197], v13 offset:0
ds_read_b64_tr_b16 v[198:199], v13 offset:2048
Mvva 132,244,120
Mvva 148,228,116
s_waitcnt lgkmcnt(10)
ds_read_b64_tr_b16 v[212:213], v13 offset:4096
ds_read_b64_tr_b16 v[214:215], v13 offset:6144
Mvva 148,244,124
Mvva 136,232,112
ds_read_b64_tr_b16 v[200:201], v14 offset:0
ds_read_b64_tr_b16 v[202:203], v14 offset:2048
Mvva 136,248,120
Mvva 152,232,116
s_waitcnt lgkmcnt(10)
ds_read_b64_tr_b16 v[216:217], v14 offset:4096
ds_read_b64_tr_b16 v[218:219], v14 offset:6144
Mvva 152,248,124
Mvva 140,236,112
ds_read_b64_tr_b16 v[204:205], v15 offset:0
ds_read_b64_tr_b16 v[206:207], v15 offset:2048
Mvva 140,252,120
Mvva 156,236,116
s_waitcnt lgkmcnt(10)
ds_read_b64_tr_b16 v[220:221], v15 offset:4096
ds_read_b64_tr_b16 v[222:223], v15 offset:6144
Mvva 156,252,124
Mvva 128,192,128
ds_read_b64_tr_b16 v[224:225], v12 offset:8192
ds_read_b64_tr_b16 v[226:227], v12 offset:10240
Mvva 128,208,136
Mvva 144,192,132
s_waitcnt lgkmcnt(10)
ds_read_b64_tr_b16 v[240:241], v12 offset:12288
ds_read_b64_tr_b16 v[242:243], v12 offset:14336
Mvva 144,208,140
Mvva 132,196,128
ds_read_b64_tr_b16 v[228:229], v13 offset:8192
ds_read_b64_tr_b16 v[230:231], v13 offset:10240
Mvva 132,212,136
Mvva 148,196,132
s_waitcnt lgkmcnt(10)
ds_read_b64_tr_b16 v[244:245], v13 offset:12288
ds_read_b64_tr_b16 v[246:247], v13 offset:14336
Mvva 148,212,140
Mvva 136,200,128
ds_read_b64_tr_b16 v[232:233], v14 offset:8192
ds_read_b64_tr_b16 v[234:235], v14 offset:10240
Mvva 136,216,136
Mvva 152,200,132
s_waitcnt lgkmcnt(10)
ds_read_b64_tr_b16 v[248:249], v14 offset:12288
ds_read_b64_tr_b16 v[250:251], v14 offset:14336
Mvva 152,216,140
Mvva 140,204,128
ds_read_b64_tr_b16 v[236:237], v15 offset:8192
ds_read_b64_tr_b16 v[238:239], v15 offset:10240
Mvva 140,220,136
s_waitcnt lgkmcnt(10)
Mvva 156,204,132
s_barrier
ds_read_b64_tr_b16 v[252:253], v15 offset:12288
ds_read_b64_tr_b16 v[254:255], v15 offset:14336
Mvva 156,220,140
Mvva 128,224,144
ds_read_b64_tr_b16 v[192:193], v12 offset:16384
ds_read_b64_tr_b16 v[194:195], v12 offset:18432
Mvva 128,240,152
Mvva 144,224,148
s_waitcnt lgkmcnt(10)
ds_read_b64_tr_b16 v[208:209], v12 offset:20480
ds_read_b64_tr_b16 v[210:211], v12 offset:22528
Mvva 144,240,156
Mvva 132,228,144
ds_read_b64_tr_b16 v[196:197], v13 offset:16384
ds_read_b64_tr_b16 v[198:199], v13 offset:18432
Mvva 132,244,152
buffer_load_dword v17, v126, s[20:23], s24 offen sc1
Mvva 148,228,148
s_waitcnt lgkmcnt(10)
ds_read_b64_tr_b16 v[212:213], v13 offset:20480
ds_read_b64_tr_b16 v[214:215], v13 offset:22528
Mvva 148,244,156
Mvva 136,232,144
ds_read_b64_tr_b16 v[200:201], v14 offset:16384
ds_read_b64_tr_b16 v[202:203], v14 offset:18432
Mvva 136,248,152
Mvva 152,232,148
s_waitcnt lgkmcnt(10)
ds_read_b64_tr_b16 v[216:217], v14 offset:20480
ds_read_b64_tr_b16 v[218:219], v14 offset:22528
Mvva 152,248,156
Mvva 140,236,144
ds_read_b64_tr_b16 v[204:205], v15 offset:16384
ds_read_b64_tr_b16 v[206:207], v15 offset:18432
Mvva 140,252,152
Mvva 156,236,148
s_waitcnt lgkmcnt(10)
ds_read_b64_tr_b16 v[220:221], v15 offset:20480
ds_read_b64_tr_b16 v[222:223], v15 offset:22528
Mvva 156,252,156
Mvva 128,192,160
ds_read_b64_tr_b16 v[224:225], v12 offset:24576
ds_read_b64_tr_b16 v[226:227], v12 offset:26624
Mvva 128,208,168
Mvva 144,192,164
s_waitcnt lgkmcnt(10)
ds_read_b64_tr_b16 v[240:241], v12 offset:28672
ds_read_b64_tr_b16 v[242:243], v12 offset:30720
Mvva 144,208,172
Mvva 132,196,160
ds_read_b64_tr_b16 v[228:229], v13 offset:24576
ds_read_b64_tr_b16 v[230:231], v13 offset:26624
Mvva 132,212,168
Mvva 148,196,164
s_waitcnt lgkmcnt(10)
ds_read_b64_tr_b16 v[244:245], v13 offset:28672
ds_read_b64_tr_b16 v[246:247], v13 offset:30720
Mvva 148,212,172
Mvva 136,200,160
ds_read_b64_tr_b16 v[232:233], v14 offset:24576
ds_read_b64_tr_b16 v[234:235], v14 offset:26624
Mvva 136,216,168
Mvva 152,200,164
s_waitcnt lgkmcnt(10)
ds_read_b64_tr_b16 v[248:249], v14 offset:28672
ds_read_b64_tr_b16 v[250:251], v14 offset:30720
Mvva 152,216,172
Mvva 140,204,160
s_waitcnt vmcnt(6)
ds_read_b64_tr_b16 v[236:237], v15 offset:24576
ds_read_b64_tr_b16 v[238:239], v15 offset:26624
Mvva 140,220,168
s_waitcnt lgkmcnt(10)
Mvva 156,204,164
s_barrier
ds_read_b64_tr_b16 v[252:253], v15 offset:28672
ds_read_b64_tr_b16 v[254:255], v15 offset:30720
Mvva 156,220,172
Mvva 128,224,176
ds_read_b64_tr_b16 v[192:193], v12 offset:32768
ds_read_b64_tr_b16 v[194:195], v12 offset:34816
Mvva 128,240,184
Mvva 144,224,180
s_waitcnt lgkmcnt(10)
ds_read_b64_tr_b16 v[208:209], v12 offset:36864
ds_read_b64_tr_b16 v[210:211], v12 offset:38912
Mvva 144,240,188
Mvva 132,228,176
ds_read_b64_tr_b16 v[196:197], v13 offset:32768
ds_read_b64_tr_b16 v[198:199], v13 offset:34816
Mvva 132,244,184
Mvva 148,228,180
s_waitcnt lgkmcnt(10)
ds_read_b64_tr_b16 v[212:213], v13 offset:36864
ds_read_b64_tr_b16 v[214:215], v13 offset:38912
Mvva 148,244,188
Mvva 136,232,176
ds_read_b64_tr_b16 v[200:201], v14 offset:32768
ds_read_b64_tr_b16 v[202:203], v14 offset:34816
Mvva 136,248,184
Mvva 152,232,180
s_waitcnt lgkmcnt(10)
ds_read_b64_tr_b16 v[216:217], v14 offset:36864
ds_read_b64_tr_b16 v[218:219], v14 offset:38912
Mvva 152,248,188
s_waitcnt vmcnt(0)
v_cmp_ne_u32 vcc, 1, v17
s_mov_b32 s33, 0
s_cbranch_vccnz L_xno
buffer_load_dwordx4 v[160:163], v112, s[16:19], s25 offen offset:0 sc1
buffer_load_dwordx4 v[164:167], v112, s[16:19], s25 offen offset:1024 sc1
buffer_load_dwordx4 v[168:171], v112, s[16:19], s25 offen offset:2048 sc1
buffer_load_dwordx4 v[172:175], v112, s[16:19], s25 offen offset:3072 sc1
buffer_load_dwordx4 v[176:179], v10, s[16:19], s25 offen offset:0 sc1
buffer_load_dwordx4 v[180:183], v10, s[16:19], s25 offen offset:1024 sc1
buffer_load_dwordx4 v[184:187], v10, s[16:19], s25 offen offset:2048 sc1
buffer_load_dwordx4 v[188:191], v10, s[16:19], s25 offen offset:3072 sc1
s_mov_b32 s33, 1
L_xno:
Mvva 140,236,176
ds_read_b64_tr_b16 v[204:205], v15 offset:32768
ds_read_b64_tr_b16 v[206:207], v15 offset:34816
Mvva 140,252,184
Mvva 156,236,180
s_waitcnt lgkmcnt(10)
ds_read_b64_tr_b16 v[220:221], v15 offset:36864
ds_read_b64_tr_b16 v[222:223], v15 offset:38912
Mvva 156,252,188
Mvva 128,192,192
ds_read_b64_tr_b16 v[224:225], v12 offset:40960
ds_read_b64_tr_b16 v[226:227], v12 offset:43008
Mvva 128,208,200
Mvva 144,192,196
s_waitcnt lgkmcnt(10)
ds_read_b64_tr_b16 v[240:241], v12 offset:45056
ds_read_b64_tr_b16 v[242:243], v12 offset:47104
Mvva 144,208,204
Mvva 132,196,192
ds_read_b64_tr_b16 v[228:229], v13 offset:40960
ds_read_b64_tr_b16 v[230:231], v13 offset:43008
Mvva 132,212,200
Mvva 148,196,196
s_waitcnt lgkmcnt(10)
ds_read_b64_tr_b16 v[244:245], v13 offset:45056
ds_read_b64_tr_b16 v[246:247], v13 offset:47104
Mvva 148,212,204
Mvva 136,200,192
ds_read_b64_tr_b16 v[232:233], v14 offset:40960
ds_read_b64_tr_b16 v[234:235], v14 offset:43008
Mvva 136,216,200
Mvva 152,200,196
s_waitcnt lgkmcnt(10)
ds_read_b64_tr_b16 v[248:249], v14 offset:45056
ds_read_b64_tr_b16 v[250:251], v14 offset:47104
Mvva 152,216,204
Mvva 140,204,192
ds_read_b64_tr_b16 v[236:237], v15 offset:40960
ds_read_b64_tr_b16 v[238:239], v15 offset:43008
Mvva 140,220,200
s_waitcnt lgkmcnt(10)
Mvva 156,204,196
s_barrier
ds_read_b64_tr_b16 v[252:253], v15 offset:45056
ds_read_b64_tr_b16 v[254:255], v15 offset:47104
Mvva 156,220,204
Mvva 128,224,208
ds_read_b64_tr_b16 v[192:193], v12 offset:49152
ds_read_b64_tr_b16 v[194:195], v12 offset:51200
Mvva 128,240,216
Mvva 144,224,212
s_waitcnt lgkmcnt(10)
ds_read_b64_tr_b16 v[208:209], v12 offset:53248
ds_read_b64_tr_b16 v[210:211], v12 offset:55296
Mvva 144,240,220
Mvva 132,228,208
ds_read_b64_tr_b16 v[196:197], v13 offset:49152
ds_read_b64_tr_b16 v[198:199], v13 offset:51200
Mvva 132,244,216
Mvva 148,228,212
s_waitcnt lgkmcnt(10)
ds_read_b64_tr_b16 v[212:213], v13 offset:53248
ds_read_b64_tr_b16 v[214:215], v13 offset:55296
Mvva 148,244,220
Mvva 136,232,208
ds_read_b64_tr_b16 v[200:201], v14 offset:49152
ds_read_b64_tr_b16 v[202:203], v14 offset:51200
Mvva 136,248,216
Mvva 152,232,212
s_waitcnt lgkmcnt(10)
ds_read_b64_tr_b16 v[216:217], v14 offset:53248
ds_read_b64_tr_b16 v[218:219], v14 offset:55296
Mvva 152,248,220
Mvva 140,236,208
ds_read_b64_tr_b16 v[204:205], v15 offset:49152
ds_read_b64_tr_b16 v[206:207], v15 offset:51200
Mvva 140,252,216
Mvva 156,236,212
s_waitcnt lgkmcnt(10)
ds_read_b64_tr_b16 v[220:221], v15 offset:53248
ds_read_b64_tr_b16 v[222:223], v15 offset:55296
Mvva 156,252,220
Mvva 128,192,224
ds_read_b64_tr_b16 v[224:225], v12 offset:57344
ds_read_b64_tr_b16 v[226:227], v12 offset:59392
Mvva 128,208,232
Mvva 144,192,228
s_waitcnt lgkmcnt(10)
ds_read_b64_tr_b16 v[240:241], v12 offset:61440
ds_read_b64_tr_b16 v[242:243], v12 offset:63488
Mvva 144,208,236
Mvva 132,196,224
ds_read_b64_tr_b16 v[228:229], v13 offset:57344
ds_read_b64_tr_b16 v[230:231], v13 offset:59392
Mvva 132,212,232
Mvva 148,196,228
s_waitcnt lgkmcnt(10)
ds_read_b64_tr_b16 v[244:245], v13 offset:61440
ds_read_b64_tr_b16 v[246:247], v13 offset:63488
Mvva 148,212,236
Mvva 136,200,224
ds_read_b64_tr_b16 v[232:233], v14 offset:57344
ds_read_b64_tr_b16 v[234:235], v14 offset:59392
Mvva 136,216,232
Mvva 152,200,228
s_waitcnt lgkmcnt(10)
ds_read_b64_tr_b16 v[248:249], v14 offset:61440
ds_read_b64_tr_b16 v[250:251], v14 offset:63488
Mvva 152,216,236
Mvva 140,204,224
ds_read_b64_tr_b16 v[236:237], v15 offset:57344
ds_read_b64_tr_b16 v[238:239], v15 offset:59392
Mvva 140,220,232
s_waitcnt lgkmcnt(10)
Mvva 156,204,228
ds_read_b64_tr_b16 v[252:253], v15 offset:61440
ds_read_b64_tr_b16 v[254:255], v15 offset:63488
Mvva 156,220,236
Mvva 128,224,240
Mvva 128,240,248
Mvva 144,224,244
s_waitcnt lgkmcnt(8)
Mvva 144,240,252
Mvva 132,228,240
Mvva 132,244,248
Mvva 148,228,244
s_waitcnt lgkmcnt(4)
Mvva 148,244,252
Mvva 136,232,240
Mvva 136,248,248
Mvva 152,232,244
s_waitcnt lgkmcnt(0)
Mvva 152,248,252
Mvva 140,236,240
Mvva 140,252,248
Mvva 156,236,244
Mvva 156,252,252
s_cmp_lg_u32 s53, s40
s_cbranch_scc1 L_ysl
L_yslr:
v_and_b32 v124, 15, v0
v_lshlrev_b32 v74, 8, v124
v_add_u32 v74, s35, v74
v_xor_b32 v124, v124, v121
v_lshl_add_u32 v74, v124, 4, v74
v_xor_b32_e64 v75, 64, v74
v_xor_b32 v76, 128, v74
v_xor_b32 v77, 192, v74
v_lshlrev_b32 v125, 1, v122
v_xor_b32 v124, v123, v125
v_lshlrev_b32 v12, 8, v123
v_add_u32 v12, s35, v12
v_lshl_add_u32 v12, v124, 4, v12
v_xor_b32_e64 v13, 16, v12
v_xor_b32 v14, 128, v12
v_xor_b32 v15, 144, v12
s_cmp_eq_u32 s33, 0
s_cbranch_scc1 L_spinX
L_spinXr:
v_lshlrev_b32_e64 v80, 16, v18
v_and_b32 v81, 0xffff0000, v18
v_lshlrev_b32_e64 v82, 16, v19
v_and_b32 v83, 0xffff0000, v19
v_lshlrev_b32_e64 v84, 16, v20
v_and_b32 v85, 0xffff0000, v20
v_lshlrev_b32_e64 v86, 16, v21
v_and_b32 v87, 0xffff0000, v21
v_lshlrev_b32_e64 v88, 16, v22
v_and_b32 v89, 0xffff0000, v22
v_lshlrev_b32_e64 v90, 16, v23
v_and_b32 v91, 0xffff0000, v23
v_lshlrev_b32_e64 v92, 16, v24
v_and_b32 v93, 0xffff0000, v24
v_lshlrev_b32_e64 v94, 16, v25
v_and_b32 v95, 0xffff0000, v25
v_lshlrev_b32_e64 v96, 16, v26
v_and_b32 v97, 0xffff0000, v26
v_lshlrev_b32_e64 v98, 16, v27
v_and_b32 v99, 0xffff0000, v27
v_lshlrev_b32_e64 v100, 16, v28
v_and_b32 v101, 0xffff0000, v28
v_lshlrev_b32_e64 v102, 16, v29
v_and_b32 v103, 0xffff0000, v29
v_lshlrev_b32_e64 v104, 16, v30
v_and_b32 v105, 0xffff0000, v30
v_lshlrev_b32_e64 v106, 16, v31
v_and_b32 v107, 0xffff0000, v31
v_lshlrev_b32_e64 v108, 16, v32
v_and_b32 v109, 0xffff0000, v32
v_lshlrev_b32_e64 v110, 16, v33
v_and_b32 v111, 0xffff0000, v33
s_waitcnt vmcnt(0)
s_nop 0
v_pk_add_f32 v[128:129], v[128:129], v[160:161]
v_pk_add_f32 v[130:131], v[130:131], v[162:163]
ds_write_b128 v74, v[128:131] offset:0
v_pk_add_f32 v[132:133], v[132:133], v[164:165]
v_pk_add_f32 v[134:135], v[134:135], v[166:167]
ds_write_b128 v75, v[132:135] offset:0
v_pk_add_f32 v[136:137], v[136:137], v[168:169]
v_pk_add_f32 v[138:139], v[138:139], v[170:171]
ds_write_b128 v76, v[136:139] offset:0
v_pk_add_f32 v[140:141], v[140:141], v[172:173]
v_pk_add_f32 v[142:143], v[142:143], v[174:175]
ds_write_b128 v77, v[140:143] offset:0
v_pk_add_f32 v[144:145], v[144:145], v[176:177]
v_pk_add_f32 v[146:147], v[146:147], v[178:179]
ds_write_b128 v74, v[144:147] offset:4096
v_pk_add_f32 v[148:149], v[148:149], v[180:181]
v_pk_add_f32 v[150:151], v[150:151], v[182:183]
ds_write_b128 v75, v[148:151] offset:4096
v_pk_add_f32 v[152:153], v[152:153], v[184:185]
v_pk_add_f32 v[154:155], v[154:155], v[186:187]
ds_write_b128 v76, v[152:155] offset:4096
v_pk_add_f32 v[156:157], v[156:157], v[188:189]
v_pk_add_f32 v[158:159], v[158:159], v[190:191]
ds_write_b128 v77, v[156:159] offset:4096
Rv 192,12,0
Rv 196,13,0
Rv 200,14,2048
Rv 204,15,2048
Rv 208,12,4096
Rv 212,13,4096
Rv 216,14,6144
s_waitcnt lgkmcnt(9)
Rv 220,15,6144
s_waitcnt lgkmcnt(6)
Vc 224,192,193
v_lshlrev_b32_e64 v192, 16, v224
v_and_b32 v193, 0xffff0000, v224
Vc 225,194,195
v_lshlrev_b32_e64 v194, 16, v225
v_and_b32 v195, 0xffff0000, v225
Vc 226,196,197
v_lshlrev_b32_e64 v196, 16, v226
v_and_b32 v197, 0xffff0000, v226
Vc 227,198,199
v_lshlrev_b32_e64 v198, 16, v227
v_and_b32 v199, 0xffff0000, v227
v_pk_mul_f32 v[192:193], v[192:193], v[42:43]
v_pk_mul_f32 v[194:195], v[194:195], v[44:45]
v_pk_mul_f32 v[196:197], v[196:197], v[46:47]
v_pk_mul_f32 v[198:199], v[198:199], v[48:49]
Vc 224,192,193
v_lshlrev_b32_e64 v192, 16, v224
v_and_b32 v193, 0xffff0000, v224
Vc 225,194,195
v_lshlrev_b32_e64 v194, 16, v225
v_and_b32 v195, 0xffff0000, v225
Vc 226,196,197
v_lshlrev_b32_e64 v196, 16, v226
v_and_b32 v197, 0xffff0000, v226
Vc 227,198,199
v_lshlrev_b32_e64 v198, 16, v227
v_and_b32 v199, 0xffff0000, v227
v_pk_add_f32 v[192:193], v[192:193], v[80:81]
v_pk_add_f32 v[194:195], v[194:195], v[82:83]
v_pk_add_f32 v[196:197], v[196:197], v[84:85]
v_pk_add_f32 v[198:199], v[198:199], v[86:87]
Vc 224,192,193
Vc 225,194,195
Vc 226,196,197
Vc 227,198,199
buffer_store_dwordx4 v[224:227], v119, s[68:71], s36 offen sc1
s_add_u32 s36, s36, 16384
s_waitcnt lgkmcnt(4)
Vc 228,200,201
v_lshlrev_b32 v200, 16, v228
v_and_b32 v201, 0xffff0000, v228
Vc 229,202,203
v_lshlrev_b32_e64 v202, 16, v229
v_and_b32 v203, 0xffff0000, v229
Vc 230,204,205
v_lshlrev_b32_e64 v204, 16, v230
v_and_b32 v205, 0xffff0000, v230
Vc 231,206,207
v_lshlrev_b32_e64 v206, 16, v231
v_and_b32 v207, 0xffff0000, v231
v_pk_mul_f32 v[200:201], v[200:201], v[50:51]
v_pk_mul_f32 v[202:203], v[202:203], v[52:53]
v_pk_mul_f32 v[204:205], v[204:205], v[54:55]
v_pk_mul_f32 v[206:207], v[206:207], v[56:57]
Vc 228,200,201
v_lshlrev_b32_e64 v200, 16, v228
v_and_b32 v201, 0xffff0000, v228
Vc 229,202,203
v_lshlrev_b32_e64 v202, 16, v229
v_and_b32 v203, 0xffff0000, v229
Vc 230,204,205
v_lshlrev_b32_e64 v204, 16, v230
v_and_b32 v205, 0xffff0000, v230
Vc 231,206,207
v_lshlrev_b32_e64 v206, 16, v231
v_and_b32 v207, 0xffff0000, v231
v_pk_add_f32 v[200:201], v[200:201], v[88:89]
v_pk_add_f32 v[202:203], v[202:203], v[90:91]
v_pk_add_f32 v[204:205], v[204:205], v[92:93]
v_pk_add_f32 v[206:207], v[206:207], v[94:95]
Vc 228,200,201
Vc 229,202,203
Vc 230,204,205
Vc 231,206,207
buffer_store_dwordx4 v[228:231], v119, s[68:71], s36 offen sc1
s_add_u32 s36, s36, 16384
s_waitcnt lgkmcnt(2)
Vc 232,208,209
v_lshlrev_b32 v208, 16, v232
v_and_b32 v209, 0xffff0000, v232
Vc 233,210,211
v_lshlrev_b32_e64 v210, 16, v233
v_and_b32 v211, 0xffff0000, v233
Vc 234,212,213
v_lshlrev_b32_e64 v212, 16, v234
v_and_b32 v213, 0xffff0000, v234
Vc 235,214,215
v_lshlrev_b32_e64 v214, 16, v235
v_and_b32 v215, 0xffff0000, v235
v_pk_mul_f32 v[208:209], v[208:209], v[58:59]
v_pk_mul_f32 v[210:211], v[210:211], v[60:61]
v_pk_mul_f32 v[212:213], v[212:213], v[62:63]
v_pk_mul_f32 v[214:215], v[214:215], v[64:65]
Vc 232,208,209
v_lshlrev_b32_e64 v208, 16, v232
v_and_b32 v209, 0xffff0000, v232
Vc 233,210,211
v_lshlrev_b32_e64 v210, 16, v233
v_and_b32 v211, 0xffff0000, v233
Vc 234,212,213
v_lshlrev_b32_e64 v212, 16, v234
v_and_b32 v213, 0xffff0000, v234
Vc 235,214,215
v_lshlrev_b32_e64 v214, 16, v235
v_and_b32 v215, 0xffff0000, v235
v_pk_add_f32 v[208:209], v[208:209], v[96:97]
v_pk_add_f32 v[210:211], v[210:211], v[98:99]
v_pk_add_f32 v[212:213], v[212:213], v[100:101]
v_pk_add_f32 v[214:215], v[214:215], v[102:103]
Vc 232,208,209
Vc 233,210,211
Vc 234,212,213
Vc 235,214,215
buffer_store_dwordx4 v[232:235], v119, s[68:71], s36 offen sc1
s_add_u32 s36, s36, 16384
s_waitcnt lgkmcnt(0)
Vc 236,216,217
v_lshlrev_b32 v216, 16, v236
v_and_b32 v217, 0xffff0000, v236
Vc 237,218,219
v_lshlrev_b32_e64 v218, 16, v237
v_and_b32 v219, 0xffff0000, v237
Vc 238,220,221
v_lshlrev_b32_e64 v220, 16, v238
v_and_b32 v221, 0xffff0000, v238
Vc 239,222,223
v_lshlrev_b32_e64 v222, 16, v239
v_and_b32 v223, 0xffff0000, v239
v_pk_mul_f32 v[216:217], v[216:217], v[66:67]
v_pk_mul_f32 v[218:219], v[218:219], v[68:69]
v_pk_mul_f32 v[220:221], v[220:221], v[70:71]
v_pk_mul_f32 v[222:223], v[222:223], v[72:73]
Vc 236,216,217
v_lshlrev_b32_e64 v216, 16, v236
v_and_b32 v217, 0xffff0000, v236
Vc 237,218,219
v_lshlrev_b32_e64 v218, 16, v237
v_and_b32 v219, 0xffff0000, v237
Vc 238,220,221
v_lshlrev_b32_e64 v220, 16, v238
v_and_b32 v221, 0xffff0000, v238
Vc 239,222,223
v_lshlrev_b32_e64 v222, 16, v239
v_and_b32 v223, 0xffff0000, v239
v_pk_add_f32 v[216:217], v[216:217], v[104:105]
v_pk_add_f32 v[218:219], v[218:219], v[106:107]
v_pk_add_f32 v[220:221], v[220:221], v[108:109]
v_pk_add_f32 v[222:223], v[222:223], v[110:111]
Vc 236,216,217
Vc 237,218,219
Vc 238,220,221
Vc 239,222,223
buffer_store_dwordx4 v[236:239], v119, s[68:71], s36 offen sc1
L_k2_end:
s_endpgm
L_spinC:
s_add_u32 m0, s35, 0
s_nop 0
s_nop 0
buffer_load_dwordx4 v125, s[60:63], s48 offen offset:0 lds
buffer_load_dwordx4 v125, s[60:63], s49 offen offset:1024 lds
buffer_load_dwordx4 v125, s[60:63], s50 offen offset:2048 lds
buffer_load_dwordx4 v125, s[60:63], s51 offen offset:3072 lds
v_add_u32 v125, 65536, v125
s_add_u32 m0, s35, 4096
s_nop 0
buffer_load_dwordx4 v125, s[60:63], s48 offen offset:0 lds
buffer_load_dwordx4 v125, s[60:63], s49 offen offset:1024 lds
buffer_load_dwordx4 v125, s[60:63], s50 offen offset:2048 lds
buffer_load_dwordx4 v125, s[60:63], s51 offen offset:3072 lds
s_mov_b32 s40, 1
s_mov_b32 s47, 0x400000
L_spinC_l:
buffer_load_dword v124, v10, s[20:23], s38 offen sc1
s_sub_u32 s47, s47, 1
s_waitcnt vmcnt(0)
s_cmp_eq_u32 s47, 0
s_cbranch_scc1 L_spinC_lx
v_cmp_ne_u32 vcc, 1, v124
s_cbranch_vccz L_spinC_lx
s_sleep 4
s_branch L_spinC_l
L_spinC_lx:
s_branch L_spinCr
L_c31:
s_bfe_u32 s3, s2, 0x40003
s_lshl_b32 s3, s3, 2
s_add_u32 s3, s3, s32
s_lshl_b32 s3, s3, 15
s_and_b32 s7, s2, 1
s_lshl_b32 s7, s7, 22
s_add_u32 s3, s3, s7
s_add_u32 s3, s3, 2097536
v_and_b32 v1, 15, v0
v_lshlrev_b32 v1, 11, v1
v_lshrrev_b32 v11, 5, v0
v_lshl_add_u32 v1, v11, 10, v1
buffer_load_dword v11, v1, s[28:31], s3 offen
s_branch L_c31r
L_f2A:
s_lshr_b32 s5, s54, 1
s_lshl_b32 s5, s5, 5
s_add_u32 s5, s5, 5447680
buffer_load_dword v125, v127, s[20:23], s5 offen sc1
s_branch L_f2Ar
L_f2B:
s_waitcnt vmcnt(16)
v_cmp_ne_u32 vcc, 1, v125
s_cbranch_vccz L_f2lx
s_mov_b32 s47, 0x400000
L_f2l:
buffer_load_dword v125, v127, s[20:23], s5 offen sc1
s_sub_u32 s47, s47, 1
s_waitcnt vmcnt(0)
s_cmp_eq_u32 s47, 0
s_cbranch_scc1 L_f2lx
v_cmp_ne_u32 vcc, 1, v125
s_cbranch_vccz L_f2lx
s_sleep 8
s_branch L_f2l
L_f2lx:
s_lshl_b32 s3, s54, 8
s_add_u32 s3, s3, 6291456
v_mul_u32_u24 v124, 14336, v121
v_and_b32_e64 v125, 15, v0
v_lshl_add_u32 v124, v125, 4, v124
buffer_load_dwordx4 v[74:77], v124, s[20:23], s3 offen sc1
s_add_u32 s3, s3, 57344
buffer_load_dwordx4 v[78:81], v124, s[20:23], s3 offen sc1
s_add_u32 s3, s3, 57344
buffer_load_dwordx4 v[82:85], v124, s[20:23], s3 offen sc1
s_add_u32 s3, s3, 57344
buffer_load_dwordx4 v[86:89], v124, s[20:23], s3 offen sc1
s_add_u32 s3, s3, 57344
buffer_load_dwordx4 v[90:93], v124, s[20:23], s3 offen sc1
s_add_u32 s3, s3, 57344
buffer_load_dwordx4 v[94:97], v124, s[20:23], s3 offen sc1
s_add_u32 s3, s3, 57344
buffer_load_dwordx4 v[98:101], v124, s[20:23], s3 offen sc1
s_add_u32 s3, s3, 57344
buffer_load_dwordx4 v[102:105], v124, s[20:23], s3 offen sc1
s_branch L_f2Br
L_f2C:
v_add_u32 v106, s35, v115
v_add_u32 v107, s35, v116
v_add_u32 v108, s35, v117
v_add_u32 v109, s35, v118
s_waitcnt vmcnt(16) lgkmcnt(0)
v_pk_add_f32 v[74:75], v[74:75], v[78:79]
v_pk_add_f32 v[76:77], v[76:77], v[80:81]
v_pk_add_f32 v[74:75], v[74:75], v[82:83]
v_pk_add_f32 v[76:77], v[76:77], v[84:85]
v_pk_add_f32 v[74:75], v[74:75], v[86:87]
v_pk_add_f32 v[76:77], v[76:77], v[88:89]
v_pk_add_f32 v[74:75], v[74:75], v[90:91]
v_pk_add_f32 v[76:77], v[76:77], v[92:93]
v_pk_add_f32 v[74:75], v[74:75], v[94:95]
v_pk_add_f32 v[76:77], v[76:77], v[96:97]
v_pk_add_f32 v[74:75], v[74:75], v[98:99]
v_pk_add_f32 v[76:77], v[76:77], v[100:101]
v_pk_add_f32 v[74:75], v[74:75], v[102:103]
v_pk_add_f32 v[76:77], v[76:77], v[104:105]
Vc 125,74,75
v_lshlrev_b32_e64 v74, 16, v125
v_and_b32 v75, 0xffff0000, v125
Vc 125,76,77
v_lshlrev_b32_e64 v76, 16, v125
v_and_b32 v77, 0xffff0000, v125
v_mov_b32 v82, v74
v_mov_b32 v83, v75
v_mov_b32 v84, v76
v_mov_b32 v85, v77
v_permlane32_swap_b32 v82, v74
v_permlane32_swap_b32 v83, v75
v_permlane32_swap_b32 v84, v76
v_permlane32_swap_b32 v85, v77
v_mul_f32 v90, 0xbfb8aa3b, v82
v_mul_f32 v91, 0xbfb8aa3b, v83
v_mul_f32 v92, 0xbfb8aa3b, v84
v_mul_f32 v93, 0xbfb8aa3b, v85
Ve 90,90
Ve 91,91
Ve 92,92
Ve 93,93
v_add_f32 v90, 1.0, v90
v_add_f32 v91, 1.0, v91
v_add_f32 v92, 1.0, v92
v_add_f32 v93, 1.0, v93
v_rcp_f32 v90, v90
v_rcp_f32 v91, v91
v_rcp_f32 v92, v92
v_rcp_f32 v93, v93
Vm 82,82,90
Vm 83,83,91
Vm 84,84,92
Vm 85,85,93
Vc 125,82,83
v_lshlrev_b32_e64 v82, 16, v125
v_and_b32 v83, 0xffff0000, v125
Vc 125,84,85
v_lshlrev_b32_e64 v84, 16, v125
v_and_b32 v85, 0xffff0000, v125
Vm 74,74,82
Vm 75,75,83
Vm 76,76,84
Vm 77,77,85
Vc 90,74,75
Vc 91,76,77
v_and_b32 v124, 1, v121
v_lshlrev_b32 v124, 8, v124
v_and_b32_e64 v125, 15, v0
v_lshl_add_u32 v124, v125, 3, v124
v_add_u32_e64 v124, s35, v124
ds_read_b64_tr_b16 v[74:75], v106 offset:0
ds_read_b64_tr_b16 v[76:77], v106 offset:2048
ds_read_b64_tr_b16 v[78:79], v107 offset:0
ds_read_b64_tr_b16 v[80:81], v107 offset:2048
ds_read_b64_tr_b16 v[82:83], v108 offset:0
ds_read_b64_tr_b16 v[84:85], v108 offset:2048
ds_read_b64_tr_b16 v[86:87], v109 offset:0
ds_read_b64_tr_b16 v[88:89], v109 offset:2048
ds_write_b64 v124, v[90:91]
v_and_b32 v124, 1, v0
v_lshlrev_b32 v124, 8, v124
v_lshl_add_u32 v125, v121, 3, v124
v_add_u32_e64 v125, s35, v125
ds_read_b64 v[90:91], v125 offset:0
ds_read_b64 v[92:93], v125 offset:32
ds_read_b64 v[94:95], v125 offset:64
ds_read_b64 v[96:97], v125 offset:96
v_lshl_add_u32 v124, v121, 4, v124
v_add_u32 v124, s35, v124
s_waitcnt lgkmcnt(0)
Zvvv 98,74,90
ds_read_b64_tr_b16 v[74:75], v106 offset:4096
ds_read_b64_tr_b16 v[76:77], v106 offset:6144
Zvvv 102,78,90
ds_read_b64_tr_b16 v[78:79], v107 offset:4096
ds_read_b64_tr_b16 v[80:81], v107 offset:6144
s_waitcnt lgkmcnt(0)
Mvvv 98,74,94
Mvvv 102,78,94
s_nop 6
ds_write_b128 v124, v[98:101] offset:2048
ds_write_b128 v124, v[102:105] offset:2112
s_waitcnt lgkmcnt(0)
Zvvv 98,82,90
ds_read_b64_tr_b16 v[82:83], v108 offset:4096
ds_read_b64_tr_b16 v[84:85], v108 offset:6144
Zvvv 102,86,90
ds_read_b64_tr_b16 v[86:87], v109 offset:4096
ds_read_b64_tr_b16 v[88:89], v109 offset:6144
s_waitcnt lgkmcnt(0)
Mvvv 98,82,94
Mvvv 102,86,94
s_nop 6
ds_write_b128 v124, v[98:101] offset:2176
ds_write_b128 v124, v[102:105] offset:2240
s_waitcnt lgkmcnt(0)
s_barrier
s_cmp_lg_u32 s32, 0
s_cbranch_scc1 L_f2Cr
v_lshlrev_b32 v124, 3, v0
v_add_u32 v125, 133120, v124
ds_read_b64 v[74:75], v125 offset:0
ds_read_b64 v[76:77], v125 offset:8192
ds_read_b64 v[78:79], v125 offset:16384
ds_read_b64 v[80:81], v125 offset:24576
s_lshl_b32 s3, s39, 4
s_add_u32 s3, s3, s37
s_lshl_b32 s3, s3, 9
s_add_u32 s3, s3, 5308416
s_waitcnt lgkmcnt(0)
v_pk_add_f32 v[74:75], v[74:75], v[76:77]
v_pk_add_f32 v[78:79], v[78:79], v[80:81]
v_pk_add_f32 v[74:75], v[74:75], v[78:79]
buffer_store_dwordx2 v[74:75], v124, s[20:23], s3 offen sc1
s_branch L_f2Cr
L_f2E:
s_cmp_lg_u32 s32, 0
s_cbranch_scc1 L_f2Er
v_mov_b32 v125, 1
s_lshl_b32 s3, s39, 5
s_add_u32 s3, s3, s37
s_lshl_b32 s3, s3, 2
s_add_u32 s3, s3, 5449728
s_waitcnt vmcnt(16)
s_mov_b64 exec, 1
buffer_store_dword v125, v126, s[20:23], s3 offen sc1
s_mov_b64 exec, -1
s_branch L_f2Er
L_yA:
v_min_u32 v127, 13, v0
v_lshlrev_b32_e64 v127, 2, v127
buffer_load_dword v74, v127, s[20:23], s41 offen sc1
s_branch L_yAr
L_yB:
s_waitcnt vmcnt(6)
v_cmp_ne_u32 vcc, 1, v74
s_cbranch_vccnz L_yBr
s_mov_b32 s40, 1
v_lshlrev_b32 v124, 2, v0
v_lshlrev_b32 v125, 1, v0
s_lshl_b32 s7, s45, 2
s_add_u32 s7, s7, s32
s_lshr_b32 s3, s42, 5
s_cmp_lg_u32 s3, s7
s_cbranch_scc1 L_f_yl1
s_add_u32 s3, s55, 0
s_nop 0
s_add_u32 s7, s3, 4096
buffer_load_dword v76, v124, s[20:23], s3 offen offset:0 sc1
buffer_load_dword v77, v124, s[20:23], s3 offen offset:512 sc1
buffer_load_dword v78, v124, s[20:23], s3 offen offset:1024 sc1
buffer_load_dword v79, v124, s[20:23], s3 offen offset:1536 sc1
buffer_load_dword v80, v124, s[20:23], s3 offen offset:2048 sc1
buffer_load_dword v81, v124, s[20:23], s3 offen offset:2560 sc1
buffer_load_dword v82, v124, s[20:23], s3 offen offset:3072 sc1
buffer_load_dword v83, v124, s[20:23], s3 offen offset:3584 sc1
buffer_load_dword v84, v124, s[20:23], s7 offen offset:0 sc1
buffer_load_dword v85, v124, s[20:23], s7 offen offset:512 sc1
buffer_load_dword v86, v124, s[20:23], s7 offen offset:1024 sc1
buffer_load_dword v87, v124, s[20:23], s7 offen offset:1536 sc1
buffer_load_dword v88, v124, s[20:23], s7 offen offset:2048 sc1
buffer_load_dword v89, v124, s[20:23], s7 offen offset:2560 sc1
s_lshl_b32 s3, s42, 11
s_lshl_b32 s7, s46, 7
s_add_u32 s3, s3, s7
buffer_load_ushort v90, v125, s[56:59], s3 offen
s_lshl_b32 s3, s42, 3
s_add_u32 s3, s3, 5259264
buffer_load_dwordx2 v[92:93], v126, s[20:23], s3 offen sc1
L_f_yl1:
s_lshl_b32 s7, s45, 2
s_add_u32 s7, s7, s32
s_lshr_b32 s3, s43, 5
s_cmp_lg_u32 s3, s7
s_cbranch_scc1 L_f_yl2
s_nop 0
s_add_u32 s3, s55, 256
s_add_u32 s7, s3, 4096
buffer_load_dword v94, v124, s[20:23], s3 offen offset:0 sc1
buffer_load_dword v95, v124, s[20:23], s3 offen offset:512 sc1
buffer_load_dword v96, v124, s[20:23], s3 offen offset:1024 sc1
buffer_load_dword v97, v124, s[20:23], s3 offen offset:1536 sc1
buffer_load_dword v98, v124, s[20:23], s3 offen offset:2048 sc1
buffer_load_dword v99, v124, s[20:23], s3 offen offset:2560 sc1
buffer_load_dword v100, v124, s[20:23], s3 offen offset:3072 sc1
buffer_load_dword v101, v124, s[20:23], s3 offen offset:3584 sc1
buffer_load_dword v102, v124, s[20:23], s7 offen offset:0 sc1
buffer_load_dword v103, v124, s[20:23], s7 offen offset:512 sc1
buffer_load_dword v104, v124, s[20:23], s7 offen offset:1024 sc1
buffer_load_dword v105, v124, s[20:23], s7 offen offset:1536 sc1
buffer_load_dword v106, v124, s[20:23], s7 offen offset:2048 sc1
buffer_load_dword v107, v124, s[20:23], s7 offen offset:2560 sc1
s_lshl_b32 s3, s43, 11
s_lshl_b32 s7, s46, 7
s_add_u32 s3, s3, s7
buffer_load_ushort v108, v125, s[56:59], s3 offen
s_lshl_b32 s3, s43, 3
s_add_u32 s3, s3, 5259264
buffer_load_dwordx2 v[110:111], v126, s[20:23], s3 offen sc1
L_f_yl2:
s_branch L_yBr
L_yC:
s_waitcnt vmcnt(4)
s_lshl_b32 s7, s45, 2
s_add_u32 s7, s7, s32
s_lshr_b32 s3, s42, 5
s_cmp_lg_u32 s3, s7
s_cbranch_scc1 L_f_ys3
s_nop 0
v_pk_add_f32 v[76:77], v[76:77], v[78:79]
v_pk_add_f32 v[76:77], v[76:77], v[80:81]
v_pk_add_f32 v[76:77], v[76:77], v[82:83]
v_pk_add_f32 v[76:77], v[76:77], v[84:85]
v_pk_add_f32 v[76:77], v[76:77], v[86:87]
v_pk_add_f32 v[76:77], v[76:77], v[88:89]
Va 76,76,77
v_lshlrev_b32 v90, 16, v90
v_sub_f32_e64 v90, v90, v92
Vc 76,76,76
v_lshlrev_b32_e64 v76, 16, v76
Vc 90,90,90
v_lshlrev_b32 v90, 16, v90
v_mul_f32 v76, s100, v76
v_mul_f32_e64 v90, v90, v93
Vc 76,76,76
v_lshlrev_b32_e64 v76, 16, v76
Vc 90,90,90
v_lshlrev_b32 v90, 16, v90
Va 90,90,76
Vc 90,90,90
v_lshlrev_b32_e64 v90, 16, v90
v_mul_f32 v76, 0xbfb8aa3b, v90
Ve 76,76
s_nop 0
v_add_f32 v76, 1.0, v76
v_rcp_f32 v76, v76
s_nop 0
Vm 90,90,76
Vc 90,90,90
v_lshlrev_b32 v90, 16, v90
v_lshlrev_b32 v124, 2, v0
v_add_u32 v124, s35, v124
v_lshlrev_b32 v125, 5, v122
v_add_u32 v125, s35, v125
s_waitcnt lgkmcnt(0)
ds_write_b32 v124, v90
s_and_b32 s3, s42, 7
s_lshl_b32 s3, s3, 3
s_lshl_b64 s[4:5], 0xff, s3
s_bfe_u32 s3, s42, 0x20003
s_mov_b64 exec, s[4:5]
s_cmp_lg_u32 s3, 0
s_cbranch_scc1 L_f_yp4
ds_read_b64 v[42:43], v125
ds_read_b64 v[44:45], v125 offset:8
ds_read_b64 v[46:47], v125 offset:16
ds_read_b64 v[48:49], v125 offset:24
L_f_yp4:
s_cmp_lg_u32 s3, 1
s_cbranch_scc1 L_f_yp5
ds_read_b64 v[50:51], v125
ds_read_b64 v[52:53], v125 offset:8
ds_read_b64 v[54:55], v125 offset:16
ds_read_b64 v[56:57], v125 offset:24
L_f_yp5:
s_cmp_lg_u32 s3, 2
s_cbranch_scc1 L_f_yp6
ds_read_b64 v[58:59], v125
ds_read_b64 v[60:61], v125 offset:8
ds_read_b64 v[62:63], v125 offset:16
ds_read_b64 v[64:65], v125 offset:24
L_f_yp6:
s_cmp_lg_u32 s3, 3
s_cbranch_scc1 L_f_yp7
ds_read_b64 v[66:67], v125
ds_read_b64 v[68:69], v125 offset:8
s_waitcnt lgkmcnt(9)
ds_read_b64 v[70:71], v125 offset:16
ds_read_b64 v[72:73], v125 offset:24
L_f_yp7:
s_mov_b64 exec, -1
s_waitcnt lgkmcnt(0)
L_f_ys3:
s_lshl_b32 s7, s45, 2
s_add_u32 s7, s7, s32
s_lshr_b32 s3, s43, 5
s_cmp_lg_u32 s3, s7
s_cbranch_scc1 L_f_ys8
s_nop 0
v_pk_add_f32 v[94:95], v[94:95], v[96:97]
v_pk_add_f32 v[94:95], v[94:95], v[98:99]
v_pk_add_f32 v[94:95], v[94:95], v[100:101]
v_pk_add_f32 v[94:95], v[94:95], v[102:103]
v_pk_add_f32 v[94:95], v[94:95], v[104:105]
v_pk_add_f32 v[94:95], v[94:95], v[106:107]
Va 94,94,95
v_lshlrev_b32 v108, 16, v108
v_sub_f32_e64 v108, v108, v110
Vc 94,94,94
v_lshlrev_b32_e64 v94, 16, v94
Vc 108,108,108
v_lshlrev_b32 v108, 16, v108
v_mul_f32 v94, s101, v94
v_mul_f32_e64 v108, v108, v111
Vc 94,94,94
v_lshlrev_b32_e64 v94, 16, v94
Vc 108,108,108
v_lshlrev_b32 v108, 16, v108
Va 108,108,94
Vc 108,108,108
v_lshlrev_b32_e64 v108, 16, v108
v_mul_f32 v94, 0xbfb8aa3b, v108
Ve 94,94
s_nop 0
v_add_f32 v94, 1.0, v94
v_rcp_f32 v94, v94
s_nop 0
Vm 108,108,94
Vc 108,108,108
v_lshlrev_b32 v108, 16, v108
v_lshlrev_b32 v124, 2, v0
v_add_u32 v124, s35, v124
v_lshlrev_b32 v125, 5, v122
v_add_u32 v125, s35, v125
s_waitcnt lgkmcnt(0)
ds_write_b32 v124, v108
s_and_b32 s3, s43, 7
s_lshl_b32 s3, s3, 3
s_lshl_b64 s[4:5], 0xff, s3
s_bfe_u32 s3, s43, 0x20003
s_mov_b64 exec, s[4:5]
s_cmp_lg_u32 s3, 0
s_cbranch_scc1 L_f_yp9
ds_read_b64 v[42:43], v125
ds_read_b64 v[44:45], v125 offset:8
ds_read_b64 v[46:47], v125 offset:16
ds_read_b64 v[48:49], v125 offset:24
L_f_yp9:
s_cmp_lg_u32 s3, 1
s_cbranch_scc1 L_f_yp10
ds_read_b64 v[50:51], v125
ds_read_b64 v[52:53], v125 offset:8
ds_read_b64 v[54:55], v125 offset:16
ds_read_b64 v[56:57], v125 offset:24
L_f_yp10:
s_cmp_lg_u32 s3, 2
s_cbranch_scc1 L_f_yp11
ds_read_b64 v[58:59], v125
ds_read_b64 v[60:61], v125 offset:8
ds_read_b64 v[62:63], v125 offset:16
ds_read_b64 v[64:65], v125 offset:24
L_f_yp11:
s_cmp_lg_u32 s3, 3
s_cbranch_scc1 L_f_yp12
ds_read_b64 v[66:67], v125
ds_read_b64 v[68:69], v125 offset:8
s_waitcnt lgkmcnt(9)
ds_read_b64 v[70:71], v125 offset:16
ds_read_b64 v[72:73], v125 offset:24
L_f_yp12:
s_mov_b64 exec, -1
s_waitcnt lgkmcnt(0)
L_f_ys8:
s_branch L_yCr
L_p4_end:
L_spinAk:
s_mov_b32 s47, 0x400000
L_spinAk_l:
s_sleep 8
buffer_load_dword v30, v31, s[28:31], 0 offen sc1
s_waitcnt vmcnt(0)
v_readfirstlane_b32 s3, v30
s_sub_u32 s47, s47, 1
s_cmp_eq_u32 s47, 0
s_cbranch_scc1 L_spinArk
s_cmp_lt_u32 s3, 256
s_cbranch_scc1 L_spinAk_l
s_branch L_spinArk
L_spinAv:
s_mov_b32 s47, 0x400000
L_spinAv_l:
s_sleep 8
buffer_load_dword v30, v31, s[28:31], 0 offen sc1
s_waitcnt vmcnt(0)
v_readfirstlane_b32 s3, v30
s_sub_u32 s47, s47, 1
s_cmp_eq_u32 s47, 0
s_cbranch_scc1 L_spinArv
s_cmp_lt_u32 s3, 256
s_cbranch_scc1 L_spinAv_l
s_branch L_spinArv
L_spinB:
s_mov_b32 s59, 0x400000
L_spinB_l:
s_sleep 4
buffer_load_dword v12, v1, s[20:23], s6 offen sc1
s_sub_u32 s59, s59, 1
s_cmp_eq_u32 s59, 0
s_cbranch_scc1 L_spinBx
s_waitcnt vmcnt(0)
v_cmp_ne_u32 vcc, 1, v12
s_cbranch_vccnz L_spinB_l
L_spinBx:
s_waitcnt vmcnt(0)
s_branch L_spinBr
L_k2_fb_we:
s_nop 7
s_nop 0
v_max3_f32 v21, v128, v129, v130
v_max3_f32 v21, v21, v131, v132
v_max3_f32 v21, v21, v133, v134
v_max3_f32 v21, v21, v135, v136
v_max3_f32 v21, v21, v137, v138
v_max3_f32 v21, v21, v139, v140
v_max3_f32 v21, v21, v141, v142
v_max_f32 v21, v21, v143
v_mov_b32 v1, v21
s_nop 1
v_permlane16_swap_b32 v1, v21
v_max_f32 v21, v21, v1
v_mov_b32 v1, v21
s_nop 1
v_permlane32_swap_b32 v1, v21
v_max_f32_e64 v21, v21, v1
v_add_f32 v21, 0x41f80000, v21
v_max_f32 v21, 0, v21
Vs 128,128,21
Vs 129,129,21
Vs 130,130,21
Vs 131,131,21
Vs 132,132,21
Vs 133,133,21
Vs 134,134,21
Vs 135,135,21
Vs 136,136,21
Vs 137,137,21
Vs 138,138,21
Vs 139,139,21
Vs 140,140,21
Vs 141,141,21
Vs 142,142,21
Vs 143,143,21
Vs 192,192,21
Vs 193,193,21
Vs 194,194,21
Vs 195,195,21
Vs 196,196,21
Vs 197,197,21
Vs 198,198,21
Vs 199,199,21
Vs 200,200,21
Vs 201,201,21
Vs 202,202,21
Vs 203,203,21
Vs 204,204,21
Vs 205,205,21
Vs 206,206,21
Vs 207,207,21
Vs 32,32,21
Vs 33,33,21
Vs 34,34,21
v_sub_f32_e64 v35, v35, v21
v_exp_f32 v22, -v21
s_nop 0
Vm 48,48,22
Vm 49,49,22
Vm 50,50,22
v_mul_f32_e64 v51, v51, v22
Ar 8,0
Ar 9,1
Ar 10,2
Ar 11,3
Ar 12,4
Ar 13,5
Ar 14,6
Ar 15,7
Vm 8,8,22
Vm 9,9,22
Vm 10,10,22
Vm 11,11,22
Vm 12,12,22
Vm 13,13,22
Vm 14,14,22
Vm 15,15,22
Aw 0,8
Aw 1,9
Aw 2,10
Aw 3,11
Aw 4,12
Aw 5,13
Aw 6,14
Aw 7,15
Ar 8,8
Ar 9,9
Ar 10,10
Ar 11,11
Ar 12,12
Ar 13,13
Ar 14,14
Ar 15,15
Vm 8,8,22
Vm 9,9,22
Vm 10,10,22
Vm 11,11,22
Vm 12,12,22
Vm 13,13,22
Vm 14,14,22
Vm 15,15,22
Aw 8,8
Aw 9,9
Aw 10,10
Aw 11,11
Aw 12,12
Aw 13,13
Aw 14,14
Aw 15,15
Ar 8,16
Ar 9,17
Ar 10,18
Ar 11,19
Ar 12,20
Ar 13,21
Ar 14,22
Ar 15,23
Vm 8,8,22
Vm 9,9,22
Vm 10,10,22
Vm 11,11,22
Vm 12,12,22
Vm 13,13,22
Vm 14,14,22
Vm 15,15,22
Aw 16,8
Aw 17,9
Aw 18,10
Aw 19,11
Aw 20,12
Aw 21,13
Aw 22,14
Aw 23,15
Ar 8,24
Ar 9,25
Ar 10,26
Ar 11,27
Ar 12,28
Ar 13,29
Ar 14,30
Ar 15,31
Vm 8,8,22
Vm 9,9,22
Vm 10,10,22
Vm 11,11,22
Vm 12,12,22
Vm 13,13,22
Vm 14,14,22
Vm 15,15,22
Aw 24,8
Aw 25,9
Aw 26,10
Aw 27,11
Aw 28,12
Aw 29,13
Aw 30,14
Aw 31,15
v_max3_f32 v21, v144, v145, v146
v_max3_f32 v21, v21, v147, v148
v_max3_f32 v21, v21, v149, v150
v_max3_f32 v21, v21, v151, v152
v_max3_f32 v21, v21, v153, v154
v_max3_f32 v21, v21, v155, v156
v_max3_f32 v21, v21, v157, v158
v_max_f32 v21, v21, v159
v_mov_b32 v1, v21
s_nop 1
v_permlane16_swap_b32 v1, v21
v_max_f32 v21, v21, v1
v_mov_b32 v1, v21
s_nop 1
v_permlane32_swap_b32 v1, v21
v_max_f32_e64 v21, v21, v1
v_add_f32 v21, 0x41f80000, v21
v_max_f32 v21, 0, v21
Vs 144,144,21
Vs 145,145,21
Vs 146,146,21
Vs 147,147,21
Vs 148,148,21
Vs 149,149,21
Vs 150,150,21
Vs 151,151,21
Vs 152,152,21
Vs 153,153,21
Vs 154,154,21
Vs 155,155,21
Vs 156,156,21
Vs 157,157,21
Vs 158,158,21
Vs 159,159,21
Vs 208,208,21
Vs 209,209,21
Vs 210,210,21
Vs 211,211,21
Vs 212,212,21
Vs 213,213,21
Vs 214,214,21
Vs 215,215,21
Vs 216,216,21
Vs 217,217,21
Vs 218,218,21
Vs 219,219,21
Vs 220,220,21
Vs 221,221,21
Vs 222,222,21
Vs 223,223,21
Vs 36,36,21
Vs 37,37,21
Vs 38,38,21
v_sub_f32_e64 v39, v39, v21
v_exp_f32 v22, -v21
s_nop 0
Vm 52,52,22
Vm 53,53,22
Vm 54,54,22
v_mul_f32_e64 v55, v55, v22
Ar 8,32
Ar 9,33
Ar 10,34
Ar 11,35
Ar 12,36
Ar 13,37
Ar 14,38
Ar 15,39
Vm 8,8,22
Vm 9,9,22
Vm 10,10,22
Vm 11,11,22
Vm 12,12,22
Vm 13,13,22
Vm 14,14,22
Vm 15,15,22
Aw 32,8
Aw 33,9
Aw 34,10
Aw 35,11
Aw 36,12
Aw 37,13
Aw 38,14
Aw 39,15
Ar 8,40
Ar 9,41
Ar 10,42
Ar 11,43
Ar 12,44
Ar 13,45
Ar 14,46
Ar 15,47
Vm 8,8,22
Vm 9,9,22
Vm 10,10,22
Vm 11,11,22
Vm 12,12,22
Vm 13,13,22
Vm 14,14,22
Vm 15,15,22
Aw 40,8
Aw 41,9
Aw 42,10
Aw 43,11
Aw 44,12
Aw 45,13
Aw 46,14
Aw 47,15
Ar 8,48
Ar 9,49
Ar 10,50
Ar 11,51
Ar 12,52
Ar 13,53
Ar 14,54
Ar 15,55
Vm 8,8,22
Vm 9,9,22
Vm 10,10,22
Vm 11,11,22
Vm 12,12,22
Vm 13,13,22
Vm 14,14,22
Vm 15,15,22
Aw 48,8
Aw 49,9
Aw 50,10
Aw 51,11
Aw 52,12
Aw 53,13
Aw 54,14
Aw 55,15
Ar 8,56
Ar 9,57
Ar 10,58
Ar 11,59
Ar 12,60
Ar 13,61
Ar 14,62
Ar 15,63
Vm 8,8,22
Vm 9,9,22
Vm 10,10,22
Vm 11,11,22
Vm 12,12,22
Vm 13,13,22
Vm 14,14,22
Vm 15,15,22
Aw 56,8
Aw 57,9
Aw 58,10
Aw 59,11
Aw 60,12
Aw 61,13
Aw 62,14
Aw 63,15
v_max3_f32 v21, v160, v161, v162
v_max3_f32 v21, v21, v163, v164
v_max3_f32 v21, v21, v165, v166
v_max3_f32 v21, v21, v167, v168
v_max3_f32 v21, v21, v169, v170
v_max3_f32 v21, v21, v171, v172
v_max3_f32 v21, v21, v173, v174
v_max_f32 v21, v21, v175
v_mov_b32 v1, v21
s_nop 1
v_permlane16_swap_b32 v1, v21
v_max_f32 v21, v21, v1
v_mov_b32 v1, v21
s_nop 1
v_permlane32_swap_b32 v1, v21
v_max_f32_e64 v21, v21, v1
v_add_f32 v21, 0x41f80000, v21
v_max_f32 v21, 0, v21
Vs 160,160,21
Vs 161,161,21
Vs 162,162,21
Vs 163,163,21
Vs 164,164,21
Vs 165,165,21
Vs 166,166,21
Vs 167,167,21
Vs 168,168,21
Vs 169,169,21
Vs 170,170,21
Vs 171,171,21
Vs 172,172,21
Vs 173,173,21
Vs 174,174,21
Vs 175,175,21
Vs 224,224,21
Vs 225,225,21
Vs 226,226,21
Vs 227,227,21
Vs 228,228,21
Vs 229,229,21
Vs 230,230,21
Vs 231,231,21
Vs 232,232,21
Vs 233,233,21
Vs 234,234,21
Vs 235,235,21
Vs 236,236,21
Vs 237,237,21
Vs 238,238,21
Vs 239,239,21
Vs 40,40,21
Vs 41,41,21
Vs 42,42,21
v_sub_f32_e64 v43, v43, v21
v_exp_f32 v22, -v21
s_nop 0
Vm 56,56,22
Vm 57,57,22
Vm 58,58,22
v_mul_f32_e64 v59, v59, v22
Ar 8,64
Ar 9,65
Ar 10,66
Ar 11,67
Ar 12,68
Ar 13,69
Ar 14,70
Ar 15,71
Vm 8,8,22
Vm 9,9,22
Vm 10,10,22
Vm 11,11,22
Vm 12,12,22
Vm 13,13,22
Vm 14,14,22
Vm 15,15,22
Aw 64,8
Aw 65,9
Aw 66,10
Aw 67,11
Aw 68,12
Aw 69,13
Aw 70,14
Aw 71,15
Ar 8,72
Ar 9,73
Ar 10,74
Ar 11,75
Ar 12,76
Ar 13,77
Ar 14,78
Ar 15,79
Vm 8,8,22
Vm 9,9,22
Vm 10,10,22
Vm 11,11,22
Vm 12,12,22
Vm 13,13,22
Vm 14,14,22
Vm 15,15,22
Aw 72,8
Aw 73,9
Aw 74,10
Aw 75,11
Aw 76,12
Aw 77,13
Aw 78,14
Aw 79,15
Ar 8,80
Ar 9,81
Ar 10,82
Ar 11,83
Ar 12,84
Ar 13,85
Ar 14,86
Ar 15,87
Vm 8,8,22
Vm 9,9,22
Vm 10,10,22
Vm 11,11,22
Vm 12,12,22
Vm 13,13,22
Vm 14,14,22
Vm 15,15,22
Aw 80,8
Aw 81,9
Aw 82,10
Aw 83,11
Aw 84,12
Aw 85,13
Aw 86,14
Aw 87,15
Ar 8,88
Ar 9,89
Ar 10,90
Ar 11,91
Ar 12,92
Ar 13,93
Ar 14,94
Ar 15,95
Vm 8,8,22
Vm 9,9,22
Vm 10,10,22
Vm 11,11,22
Vm 12,12,22
Vm 13,13,22
Vm 14,14,22
Vm 15,15,22
Aw 88,8
Aw 89,9
Aw 90,10
Aw 91,11
Aw 92,12
Aw 93,13
Aw 94,14
Aw 95,15
v_max3_f32 v21, v176, v177, v178
v_max3_f32 v21, v21, v179, v180
v_max3_f32 v21, v21, v181, v182
v_max3_f32 v21, v21, v183, v184
v_max3_f32 v21, v21, v185, v186
v_max3_f32 v21, v21, v187, v188
v_max3_f32 v21, v21, v189, v190
v_max_f32 v21, v21, v191
v_mov_b32 v1, v21
s_nop 1
v_permlane16_swap_b32 v1, v21
v_max_f32 v21, v21, v1
v_mov_b32 v1, v21
s_nop 1
v_permlane32_swap_b32 v1, v21
v_max_f32_e64 v21, v21, v1
v_add_f32 v21, 0x41f80000, v21
v_max_f32 v21, 0, v21
Vs 176,176,21
Vs 177,177,21
Vs 178,178,21
Vs 179,179,21
Vs 180,180,21
Vs 181,181,21
Vs 182,182,21
Vs 183,183,21
Vs 184,184,21
Vs 185,185,21
Vs 186,186,21
Vs 187,187,21
Vs 188,188,21
Vs 189,189,21
Vs 190,190,21
Vs 191,191,21
Vs 240,240,21
Vs 241,241,21
Vs 242,242,21
Vs 243,243,21
Vs 244,244,21
Vs 245,245,21
Vs 246,246,21
Vs 247,247,21
Vs 248,248,21
Vs 249,249,21
Vs 250,250,21
Vs 251,251,21
Vs 252,252,21
Vs 253,253,21
Vs 254,254,21
Vs 255,255,21
Vs 44,44,21
Vs 45,45,21
Vs 46,46,21
v_sub_f32_e64 v47, v47, v21
v_exp_f32 v22, -v21
s_nop 0
Vm 60,60,22
Vm 61,61,22
Vm 62,62,22
v_mul_f32_e64 v63, v63, v22
Ar 8,96
Ar 9,97
Ar 10,98
Ar 11,99
Ar 12,100
Ar 13,101
Ar 14,102
Ar 15,103
Vm 8,8,22
Vm 9,9,22
Vm 10,10,22
Vm 11,11,22
Vm 12,12,22
Vm 13,13,22
Vm 14,14,22
Vm 15,15,22
Aw 96,8
Aw 97,9
Aw 98,10
Aw 99,11
Aw 100,12
Aw 101,13
Aw 102,14
Aw 103,15
Ar 8,104
Ar 9,105
Ar 10,106
Ar 11,107
Ar 12,108
Ar 13,109
Ar 14,110
Ar 15,111
Vm 8,8,22
Vm 9,9,22
Vm 10,10,22
Vm 11,11,22
Vm 12,12,22
Vm 13,13,22
Vm 14,14,22
Vm 15,15,22
Aw 104,8
Aw 105,9
Aw 106,10
Aw 107,11
Aw 108,12
Aw 109,13
Aw 110,14
Aw 111,15
Ar 8,112
Ar 9,113
Ar 10,114
Ar 11,115
Ar 12,116
Ar 13,117
Ar 14,118
Ar 15,119
Vm 8,8,22
Vm 9,9,22
Vm 10,10,22
Vm 11,11,22
Vm 12,12,22
Vm 13,13,22
Vm 14,14,22
Vm 15,15,22
Aw 112,8
Aw 113,9
Aw 114,10
Aw 115,11
Aw 116,12
Aw 117,13
Aw 118,14
Aw 119,15
Ar 8,120
Ar 9,121
Ar 10,122
Ar 11,123
Ar 12,124
Ar 13,125
Ar 14,126
Ar 15,127
Vm 8,8,22
Vm 9,9,22
Vm 10,10,22
Vm 11,11,22
Vm 12,12,22
Vm 13,13,22
Vm 14,14,22
Vm 15,15,22
Aw 120,8
Aw 121,9
Aw 122,10
Aw 123,11
Aw 124,12
Aw 125,13
Aw 126,14
Aw 127,15
Ve 8,128
Ve 9,129
s_nop 0
Vc 64,8,9
Ve 8,130
Ve 9,131
s_nop 0
Vc 65,8,9
Ve 8,144
Ve 9,145
s_nop 0
Vc 72,8,9
Ve 8,146
Ve 9,147
s_nop 0
Vc 73,8,9
Ve 8,160
Ve 9,161
s_nop 0
Vc 80,8,9
Ve 8,162
Ve 9,163
s_nop 0
Vc 81,8,9
Ve 8,176
Ve 9,177
s_nop 0
Vc 88,8,9
Ve 8,178
Ve 9,179
s_nop 0
Vc 89,8,9
Ve 8,132
Ve 9,133
s_nop 0
Vc 66,8,9
Ve 8,134
Ve 9,135
s_nop 0
Vc 67,8,9
Ve 8,148
Ve 9,149
s_nop 0
Vc 74,8,9
Ve 8,150
Ve 9,151
s_nop 0
Vc 75,8,9
Ve 8,164
Ve 9,165
s_nop 0
Vc 82,8,9
Ve 8,166
Ve 9,167
s_nop 0
Vc 83,8,9
Ve 8,180
Ve 9,181
s_nop 0
Vc 90,8,9
Ve 8,182
Ve 9,183
s_nop 0
Vc 91,8,9
Ve 8,136
Ve 9,137
s_nop 0
Vc 68,8,9
Ve 8,138
Ve 9,139
s_nop 0
Vc 69,8,9
Ve 8,152
Ve 9,153
s_nop 0
Vc 76,8,9
Ve 8,154
Ve 9,155
s_nop 0
Vc 77,8,9
Ve 8,168
Ve 9,169
s_nop 0
Vc 84,8,9
Ve 8,170
Ve 9,171
s_nop 0
Vc 85,8,9
Ve 8,184
Ve 9,185
s_nop 0
Vc 92,8,9
Ve 8,186
Ve 9,187
s_nop 0
Vc 93,8,9
Ve 8,140
Ve 9,141
s_nop 0
Vc 70,8,9
Ve 8,142
Ve 9,143
s_nop 0
Vc 71,8,9
Ve 8,156
Ve 9,157
s_nop 0
Vc 78,8,9
Ve 8,158
Ve 9,159
s_nop 0
Vc 79,8,9
Ve 8,172
Ve 9,173
s_nop 0
Vc 86,8,9
Ve 8,174
Ve 9,175
s_nop 0
Vc 87,8,9
Ve 8,188
Ve 9,189
s_nop 0
Vc 94,8,9
Ve 8,190
Ve 9,191
s_nop 0
Vc 95,8,9
s_nop 1
s_branch L_k2_fbr_we
L_k2_fb_wo:
s_nop 7
s_nop 0
v_max3_f32 v21, v192, v193, v194
v_max3_f32 v21, v21, v195, v196
v_max3_f32 v21, v21, v197, v198
v_max3_f32 v21, v21, v199, v200
v_max3_f32 v21, v21, v201, v202
v_max3_f32 v21, v21, v203, v204
v_max3_f32 v21, v21, v205, v206
v_max_f32 v21, v21, v207
v_mov_b32 v1, v21
s_nop 1
v_permlane16_swap_b32 v1, v21
v_max_f32 v21, v21, v1
v_mov_b32 v1, v21
s_nop 1
v_permlane32_swap_b32 v1, v21
v_max_f32_e64 v21, v21, v1
v_add_f32 v21, 0x41f80000, v21
v_max_f32 v21, 0, v21
Vs 192,192,21
Vs 193,193,21
Vs 194,194,21
Vs 195,195,21
Vs 196,196,21
Vs 197,197,21
Vs 198,198,21
Vs 199,199,21
Vs 200,200,21
Vs 201,201,21
Vs 202,202,21
Vs 203,203,21
Vs 204,204,21
Vs 205,205,21
Vs 206,206,21
Vs 207,207,21
Vs 128,128,21
Vs 129,129,21
Vs 130,130,21
Vs 131,131,21
Vs 132,132,21
Vs 133,133,21
Vs 134,134,21
Vs 135,135,21
Vs 136,136,21
Vs 137,137,21
Vs 138,138,21
Vs 139,139,21
Vs 140,140,21
Vs 141,141,21
Vs 142,142,21
Vs 143,143,21
Vs 32,32,21
Vs 33,33,21
Vs 34,34,21
v_sub_f32_e64 v35, v35, v21
v_exp_f32 v22, -v21
s_nop 0
Vm 48,48,22
Vm 49,49,22
Vm 50,50,22
v_mul_f32_e64 v51, v51, v22
Ar 8,0
Ar 9,1
Ar 10,2
Ar 11,3
Ar 12,4
Ar 13,5
Ar 14,6
Ar 15,7
Vm 8,8,22
Vm 9,9,22
Vm 10,10,22
Vm 11,11,22
Vm 12,12,22
Vm 13,13,22
Vm 14,14,22
Vm 15,15,22
Aw 0,8
Aw 1,9
Aw 2,10
Aw 3,11
Aw 4,12
Aw 5,13
Aw 6,14
Aw 7,15
Ar 8,8
Ar 9,9
Ar 10,10
Ar 11,11
Ar 12,12
Ar 13,13
Ar 14,14
Ar 15,15
Vm 8,8,22
Vm 9,9,22
Vm 10,10,22
Vm 11,11,22
Vm 12,12,22
Vm 13,13,22
Vm 14,14,22
Vm 15,15,22
Aw 8,8
Aw 9,9
Aw 10,10
Aw 11,11
Aw 12,12
Aw 13,13
Aw 14,14
Aw 15,15
Ar 8,16
Ar 9,17
Ar 10,18
Ar 11,19
Ar 12,20
Ar 13,21
Ar 14,22
Ar 15,23
Vm 8,8,22
Vm 9,9,22
Vm 10,10,22
Vm 11,11,22
Vm 12,12,22
Vm 13,13,22
Vm 14,14,22
Vm 15,15,22
Aw 16,8
Aw 17,9
Aw 18,10
Aw 19,11
Aw 20,12
Aw 21,13
Aw 22,14
Aw 23,15
Ar 8,24
Ar 9,25
Ar 10,26
Ar 11,27
Ar 12,28
Ar 13,29
Ar 14,30
Ar 15,31
Vm 8,8,22
Vm 9,9,22
Vm 10,10,22
Vm 11,11,22
Vm 12,12,22
Vm 13,13,22
Vm 14,14,22
Vm 15,15,22
Aw 24,8
Aw 25,9
Aw 26,10
Aw 27,11
Aw 28,12
Aw 29,13
Aw 30,14
Aw 31,15
v_max3_f32 v21, v208, v209, v210
v_max3_f32 v21, v21, v211, v212
v_max3_f32 v21, v21, v213, v214
v_max3_f32 v21, v21, v215, v216
v_max3_f32 v21, v21, v217, v218
v_max3_f32 v21, v21, v219, v220
v_max3_f32 v21, v21, v221, v222
v_max_f32 v21, v21, v223
v_mov_b32 v1, v21
s_nop 1
v_permlane16_swap_b32 v1, v21
v_max_f32 v21, v21, v1
v_mov_b32 v1, v21
s_nop 1
v_permlane32_swap_b32 v1, v21
v_max_f32_e64 v21, v21, v1
v_add_f32 v21, 0x41f80000, v21
v_max_f32 v21, 0, v21
Vs 208,208,21
Vs 209,209,21
Vs 210,210,21
Vs 211,211,21
Vs 212,212,21
Vs 213,213,21
Vs 214,214,21
Vs 215,215,21
Vs 216,216,21
Vs 217,217,21
Vs 218,218,21
Vs 219,219,21
Vs 220,220,21
Vs 221,221,21
Vs 222,222,21
Vs 223,223,21
Vs 144,144,21
Vs 145,145,21
Vs 146,146,21
Vs 147,147,21
Vs 148,148,21
Vs 149,149,21
Vs 150,150,21
Vs 151,151,21
Vs 152,152,21
Vs 153,153,21
Vs 154,154,21
Vs 155,155,21
Vs 156,156,21
Vs 157,157,21
Vs 158,158,21
Vs 159,159,21
Vs 36,36,21
Vs 37,37,21
Vs 38,38,21
v_sub_f32_e64 v39, v39, v21
v_exp_f32 v22, -v21
s_nop 0
Vm 52,52,22
Vm 53,53,22
Vm 54,54,22
v_mul_f32_e64 v55, v55, v22
Ar 8,32
Ar 9,33
Ar 10,34
Ar 11,35
Ar 12,36
Ar 13,37
Ar 14,38
Ar 15,39
Vm 8,8,22
Vm 9,9,22
Vm 10,10,22
Vm 11,11,22
Vm 12,12,22
Vm 13,13,22
Vm 14,14,22
Vm 15,15,22
Aw 32,8
Aw 33,9
Aw 34,10
Aw 35,11
Aw 36,12
Aw 37,13
Aw 38,14
Aw 39,15
Ar 8,40
Ar 9,41
Ar 10,42
Ar 11,43
Ar 12,44
Ar 13,45
Ar 14,46
Ar 15,47
Vm 8,8,22
Vm 9,9,22
Vm 10,10,22
Vm 11,11,22
Vm 12,12,22
Vm 13,13,22
Vm 14,14,22
Vm 15,15,22
Aw 40,8
Aw 41,9
Aw 42,10
Aw 43,11
Aw 44,12
Aw 45,13
Aw 46,14
Aw 47,15
Ar 8,48
Ar 9,49
Ar 10,50
Ar 11,51
Ar 12,52
Ar 13,53
Ar 14,54
Ar 15,55
Vm 8,8,22
Vm 9,9,22
Vm 10,10,22
Vm 11,11,22
Vm 12,12,22
Vm 13,13,22
Vm 14,14,22
Vm 15,15,22
Aw 48,8
Aw 49,9
Aw 50,10
Aw 51,11
Aw 52,12
Aw 53,13
Aw 54,14
Aw 55,15
Ar 8,56
Ar 9,57
Ar 10,58
Ar 11,59
Ar 12,60
Ar 13,61
Ar 14,62
Ar 15,63
Vm 8,8,22
Vm 9,9,22
Vm 10,10,22
Vm 11,11,22
Vm 12,12,22
Vm 13,13,22
Vm 14,14,22
Vm 15,15,22
Aw 56,8
Aw 57,9
Aw 58,10
Aw 59,11
Aw 60,12
Aw 61,13
Aw 62,14
Aw 63,15
v_max3_f32 v21, v224, v225, v226
v_max3_f32 v21, v21, v227, v228
v_max3_f32 v21, v21, v229, v230
v_max3_f32 v21, v21, v231, v232
v_max3_f32 v21, v21, v233, v234
v_max3_f32 v21, v21, v235, v236
v_max3_f32 v21, v21, v237, v238
v_max_f32 v21, v21, v239
v_mov_b32 v1, v21
s_nop 1
v_permlane16_swap_b32 v1, v21
v_max_f32 v21, v21, v1
v_mov_b32 v1, v21
s_nop 1
v_permlane32_swap_b32 v1, v21
v_max_f32_e64 v21, v21, v1
v_add_f32 v21, 0x41f80000, v21
v_max_f32 v21, 0, v21
Vs 224,224,21
Vs 225,225,21
Vs 226,226,21
Vs 227,227,21
Vs 228,228,21
Vs 229,229,21
Vs 230,230,21
Vs 231,231,21
Vs 232,232,21
Vs 233,233,21
Vs 234,234,21
Vs 235,235,21
Vs 236,236,21
Vs 237,237,21
Vs 238,238,21
Vs 239,239,21
Vs 160,160,21
Vs 161,161,21
Vs 162,162,21
Vs 163,163,21
Vs 164,164,21
Vs 165,165,21
Vs 166,166,21
Vs 167,167,21
Vs 168,168,21
Vs 169,169,21
Vs 170,170,21
Vs 171,171,21
Vs 172,172,21
Vs 173,173,21
Vs 174,174,21
Vs 175,175,21
Vs 40,40,21
Vs 41,41,21
Vs 42,42,21
v_sub_f32_e64 v43, v43, v21
v_exp_f32 v22, -v21
s_nop 0
Vm 56,56,22
Vm 57,57,22
Vm 58,58,22
v_mul_f32_e64 v59, v59, v22
Ar 8,64
Ar 9,65
Ar 10,66
Ar 11,67
Ar 12,68
Ar 13,69
Ar 14,70
Ar 15,71
Vm 8,8,22
Vm 9,9,22
Vm 10,10,22
Vm 11,11,22
Vm 12,12,22
Vm 13,13,22
Vm 14,14,22
Vm 15,15,22
Aw 64,8
Aw 65,9
Aw 66,10
Aw 67,11
Aw 68,12
Aw 69,13
Aw 70,14
Aw 71,15
Ar 8,72
Ar 9,73
Ar 10,74
Ar 11,75
Ar 12,76
Ar 13,77
Ar 14,78
Ar 15,79
Vm 8,8,22
Vm 9,9,22
Vm 10,10,22
Vm 11,11,22
Vm 12,12,22
Vm 13,13,22
Vm 14,14,22
Vm 15,15,22
Aw 72,8
Aw 73,9
Aw 74,10
Aw 75,11
Aw 76,12
Aw 77,13
Aw 78,14
Aw 79,15
Ar 8,80
Ar 9,81
Ar 10,82
Ar 11,83
Ar 12,84
Ar 13,85
Ar 14,86
Ar 15,87
Vm 8,8,22
Vm 9,9,22
Vm 10,10,22
Vm 11,11,22
Vm 12,12,22
Vm 13,13,22
Vm 14,14,22
Vm 15,15,22
Aw 80,8
Aw 81,9
Aw 82,10
Aw 83,11
Aw 84,12
Aw 85,13
Aw 86,14
Aw 87,15
Ar 8,88
Ar 9,89
Ar 10,90
Ar 11,91
Ar 12,92
Ar 13,93
Ar 14,94
Ar 15,95
Vm 8,8,22
Vm 9,9,22
Vm 10,10,22
Vm 11,11,22
Vm 12,12,22
Vm 13,13,22
Vm 14,14,22
Vm 15,15,22
Aw 88,8
Aw 89,9
Aw 90,10
Aw 91,11
Aw 92,12
Aw 93,13
Aw 94,14
Aw 95,15
v_max3_f32 v21, v240, v241, v242
v_max3_f32 v21, v21, v243, v244
v_max3_f32 v21, v21, v245, v246
v_max3_f32 v21, v21, v247, v248
v_max3_f32 v21, v21, v249, v250
v_max3_f32 v21, v21, v251, v252
v_max3_f32 v21, v21, v253, v254
v_max_f32 v21, v21, v255
v_mov_b32 v1, v21
s_nop 1
v_permlane16_swap_b32 v1, v21
v_max_f32 v21, v21, v1
v_mov_b32 v1, v21
s_nop 1
v_permlane32_swap_b32 v1, v21
v_max_f32_e64 v21, v21, v1
v_add_f32 v21, 0x41f80000, v21
v_max_f32 v21, 0, v21
Vs 240,240,21
Vs 241,241,21
Vs 242,242,21
Vs 243,243,21
Vs 244,244,21
Vs 245,245,21
Vs 246,246,21
Vs 247,247,21
Vs 248,248,21
Vs 249,249,21
Vs 250,250,21
Vs 251,251,21
Vs 252,252,21
Vs 253,253,21
Vs 254,254,21
Vs 255,255,21
Vs 176,176,21
Vs 177,177,21
Vs 178,178,21
Vs 179,179,21
Vs 180,180,21
Vs 181,181,21
Vs 182,182,21
Vs 183,183,21
Vs 184,184,21
Vs 185,185,21
Vs 186,186,21
Vs 187,187,21
Vs 188,188,21
Vs 189,189,21
Vs 190,190,21
Vs 191,191,21
Vs 44,44,21
Vs 45,45,21
Vs 46,46,21
v_sub_f32_e64 v47, v47, v21
v_exp_f32 v22, -v21
s_nop 0
Vm 60,60,22
Vm 61,61,22
Vm 62,62,22
v_mul_f32_e64 v63, v63, v22
Ar 8,96
Ar 9,97
Ar 10,98
Ar 11,99
Ar 12,100
Ar 13,101
Ar 14,102
Ar 15,103
Vm 8,8,22
Vm 9,9,22
Vm 10,10,22
Vm 11,11,22
Vm 12,12,22
Vm 13,13,22
Vm 14,14,22
Vm 15,15,22
Aw 96,8
Aw 97,9
Aw 98,10
Aw 99,11
Aw 100,12
Aw 101,13
Aw 102,14
Aw 103,15
Ar 8,104
Ar 9,105
Ar 10,106
Ar 11,107
Ar 12,108
Ar 13,109
Ar 14,110
Ar 15,111
Vm 8,8,22
Vm 9,9,22
Vm 10,10,22
Vm 11,11,22
Vm 12,12,22
Vm 13,13,22
Vm 14,14,22
Vm 15,15,22
Aw 104,8
Aw 105,9
Aw 106,10
Aw 107,11
Aw 108,12
Aw 109,13
Aw 110,14
Aw 111,15
Ar 8,112
Ar 9,113
Ar 10,114
Ar 11,115
Ar 12,116
Ar 13,117
Ar 14,118
Ar 15,119
Vm 8,8,22
Vm 9,9,22
Vm 10,10,22
Vm 11,11,22
Vm 12,12,22
Vm 13,13,22
Vm 14,14,22
Vm 15,15,22
Aw 112,8
Aw 113,9
Aw 114,10
Aw 115,11
Aw 116,12
Aw 117,13
Aw 118,14
Aw 119,15
Ar 8,120
Ar 9,121
Ar 10,122
Ar 11,123
Ar 12,124
Ar 13,125
Ar 14,126
Ar 15,127
Vm 8,8,22
Vm 9,9,22
Vm 10,10,22
Vm 11,11,22
Vm 12,12,22
Vm 13,13,22
Vm 14,14,22
Vm 15,15,22
Aw 120,8
Aw 121,9
Aw 122,10
Aw 123,11
Aw 124,12
Aw 125,13
Aw 126,14
Aw 127,15
Ve 8,192
Ve 9,193
s_nop 0
Vc 96,8,9
Ve 8,194
Ve 9,195
s_nop 0
Vc 97,8,9
Ve 8,208
Ve 9,209
s_nop 0
Vc 104,8,9
Ve 8,210
Ve 9,211
s_nop 0
Vc 105,8,9
Ve 8,224
Ve 9,225
s_nop 0
Vc 112,8,9
Ve 8,226
Ve 9,227
s_nop 0
Vc 113,8,9
Ve 8,240
Ve 9,241
s_nop 0
Vc 120,8,9
Ve 8,242
Ve 9,243
s_nop 0
Vc 121,8,9
Ve 8,196
Ve 9,197
s_nop 0
Vc 98,8,9
Ve 8,198
Ve 9,199
s_nop 0
Vc 99,8,9
Ve 8,212
Ve 9,213
s_nop 0
Vc 106,8,9
Ve 8,214
Ve 9,215
s_nop 0
Vc 107,8,9
Ve 8,228
Ve 9,229
s_nop 0
Vc 114,8,9
Ve 8,230
Ve 9,231
s_nop 0
Vc 115,8,9
Ve 8,244
Ve 9,245
s_nop 0
Vc 122,8,9
Ve 8,246
Ve 9,247
s_nop 0
Vc 123,8,9
Ve 8,200
Ve 9,201
s_nop 0
Vc 100,8,9
Ve 8,202
Ve 9,203
s_nop 0
Vc 101,8,9
Ve 8,216
Ve 9,217
s_nop 0
Vc 108,8,9
Ve 8,218
Ve 9,219
s_nop 0
Vc 109,8,9
Ve 8,232
Ve 9,233
s_nop 0
Vc 116,8,9
Ve 8,234
Ve 9,235
s_nop 0
Vc 117,8,9
Ve 8,248
Ve 9,249
s_nop 0
Vc 124,8,9
Ve 8,250
Ve 9,251
s_nop 0
Vc 125,8,9
Ve 8,204
Ve 9,205
s_nop 0
Vc 102,8,9
Ve 8,206
Ve 9,207
s_nop 0
Vc 103,8,9
Ve 8,220
Ve 9,221
s_nop 0
Vc 110,8,9
Ve 8,222
Ve 9,223
s_nop 0
Vc 111,8,9
Ve 8,236
Ve 9,237
s_nop 0
Vc 118,8,9
Ve 8,238
Ve 9,239
s_nop 0
Vc 119,8,9
Ve 8,252
Ve 9,253
s_nop 0
Vc 126,8,9
Ve 8,254
Ve 9,255
s_nop 0
Vc 127,8,9
s_nop 1
s_branch L_k2_fbr_wo
L_k2_mk_wo:
v_cmp_gt_i32 s[56:57], 0, v5
v_cmp_gt_i32 s[58:59], 1, v5
v_cmp_gt_i32 s[60:61], 2, v5
v_cmp_gt_i32 s[62:63], 3, v5
s_nop 3
s_nop 0
v_cndmask_b32 v176, v176, v20, s[56:57]
v_cndmask_b32 v177, v177, v20, s[58:59]
v_cndmask_b32 v178, v178, v20, s[60:61]
v_cndmask_b32 v179, v179, v20, s[62:63]
v_cmp_gt_i32 s[56:57], 16, v5
v_cmp_gt_i32 s[58:59], 17, v5
v_cmp_gt_i32 s[60:61], 18, v5
v_cmp_gt_i32 s[62:63], 19, v5
v_cndmask_b32 v180, v180, v20, s[56:57]
v_cndmask_b32 v181, v181, v20, s[58:59]
v_cndmask_b32 v182, v182, v20, s[60:61]
v_cndmask_b32 v183, v183, v20, s[62:63]
v_cmp_gt_i32 s[56:57], 32, v5
v_cmp_gt_i32 s[58:59], 33, v5
v_cmp_gt_i32 s[60:61], 34, v5
v_cmp_gt_i32 s[62:63], 35, v5
v_cndmask_b32 v184, v184, v20, s[56:57]
v_cndmask_b32 v185, v185, v20, s[58:59]
v_cndmask_b32 v186, v186, v20, s[60:61]
v_cndmask_b32 v187, v187, v20, s[62:63]
v_cmp_gt_i32 s[56:57], 48, v5
v_cmp_gt_i32 s[58:59], 49, v5
v_cmp_gt_i32 s[60:61], 50, v5
v_cmp_gt_i32 s[62:63], 51, v5
v_cndmask_b32 v188, v188, v20, s[56:57]
v_cndmask_b32 v189, v189, v20, s[58:59]
v_cndmask_b32 v190, v190, v20, s[60:61]
v_cndmask_b32 v191, v191, v20, s[62:63]
s_branch L_k2_mkr_wo
L_k2_fb_wl:
s_nop 7
v_max3_f32 v21, v128, v129, v130
v_max3_f32 v21, v21, v131, v132
v_max3_f32 v21, v21, v133, v134
v_max3_f32 v21, v21, v135, v136
v_max3_f32 v21, v21, v137, v138
v_max3_f32 v21, v21, v139, v140
v_max3_f32 v21, v21, v141, v142
v_max_f32 v21, v21, v143
v_mov_b32 v1, v21
s_nop 1
v_permlane16_swap_b32 v1, v21
v_max_f32 v21, v21, v1
v_mov_b32 v1, v21
s_nop 1
v_permlane32_swap_b32 v1, v21
v_max_f32_e64 v21, v21, v1
v_add_f32 v21, 0x41f80000, v21
v_max_f32 v21, 0, v21
Vs 128,128,21
Vs 129,129,21
Vs 130,130,21
Vs 131,131,21
Vs 132,132,21
Vs 133,133,21
Vs 134,134,21
Vs 135,135,21
Vs 136,136,21
Vs 137,137,21
Vs 138,138,21
Vs 139,139,21
Vs 140,140,21
Vs 141,141,21
Vs 142,142,21
Vs 143,143,21
Vs 192,192,21
Vs 193,193,21
Vs 194,194,21
Vs 195,195,21
Vs 196,196,21
Vs 197,197,21
Vs 198,198,21
Vs 199,199,21
Vs 200,200,21
Vs 201,201,21
Vs 202,202,21
Vs 203,203,21
Vs 204,204,21
Vs 205,205,21
Vs 206,206,21
Vs 207,207,21
Vs 32,32,21
Vs 33,33,21
Vs 34,34,21
v_sub_f32_e64 v35, v35, v21
v_exp_f32 v22, -v21
s_nop 0
Vm 48,48,22
Vm 49,49,22
Vm 50,50,22
v_mul_f32_e64 v51, v51, v22
Ar 8,0
Ar 9,1
Ar 10,2
Ar 11,3
Ar 12,4
Ar 13,5
Ar 14,6
Ar 15,7
Vm 8,8,22
Vm 9,9,22
Vm 10,10,22
Vm 11,11,22
Vm 12,12,22
Vm 13,13,22
Vm 14,14,22
Vm 15,15,22
Aw 0,8
Aw 1,9
Aw 2,10
Aw 3,11
Aw 4,12
Aw 5,13
Aw 6,14
Aw 7,15
Ar 8,8
Ar 9,9
Ar 10,10
Ar 11,11
Ar 12,12
Ar 13,13
Ar 14,14
Ar 15,15
Vm 8,8,22
Vm 9,9,22
Vm 10,10,22
Vm 11,11,22
Vm 12,12,22
Vm 13,13,22
Vm 14,14,22
Vm 15,15,22
Aw 8,8
Aw 9,9
Aw 10,10
Aw 11,11
Aw 12,12
Aw 13,13
Aw 14,14
Aw 15,15
Ar 8,16
Ar 9,17
Ar 10,18
Ar 11,19
Ar 12,20
Ar 13,21
Ar 14,22
Ar 15,23
Vm 8,8,22
Vm 9,9,22
Vm 10,10,22
Vm 11,11,22
Vm 12,12,22
Vm 13,13,22
Vm 14,14,22
Vm 15,15,22
Aw 16,8
Aw 17,9
Aw 18,10
Aw 19,11
Aw 20,12
Aw 21,13
Aw 22,14
Aw 23,15
Ar 8,24
Ar 9,25
Ar 10,26
Ar 11,27
Ar 12,28
Ar 13,29
Ar 14,30
Ar 15,31
Vm 8,8,22
Vm 9,9,22
Vm 10,10,22
Vm 11,11,22
Vm 12,12,22
Vm 13,13,22
Vm 14,14,22
Vm 15,15,22
Aw 24,8
Aw 25,9
Aw 26,10
Aw 27,11
Aw 28,12
Aw 29,13
Aw 30,14
Aw 31,15
v_max3_f32 v21, v144, v145, v146
v_max3_f32 v21, v21, v147, v148
v_max3_f32 v21, v21, v149, v150
v_max3_f32 v21, v21, v151, v152
v_max3_f32 v21, v21, v153, v154
v_max3_f32 v21, v21, v155, v156
v_max3_f32 v21, v21, v157, v158
v_max_f32 v21, v21, v159
v_mov_b32 v1, v21
s_nop 1
v_permlane16_swap_b32 v1, v21
v_max_f32 v21, v21, v1
v_mov_b32 v1, v21
s_nop 1
v_permlane32_swap_b32 v1, v21
v_max_f32_e64 v21, v21, v1
v_add_f32 v21, 0x41f80000, v21
v_max_f32 v21, 0, v21
Vs 144,144,21
Vs 145,145,21
Vs 146,146,21
Vs 147,147,21
Vs 148,148,21
Vs 149,149,21
Vs 150,150,21
Vs 151,151,21
Vs 152,152,21
Vs 153,153,21
Vs 154,154,21
Vs 155,155,21
Vs 156,156,21
Vs 157,157,21
Vs 158,158,21
Vs 159,159,21
Vs 208,208,21
Vs 209,209,21
Vs 210,210,21
Vs 211,211,21
Vs 212,212,21
Vs 213,213,21
Vs 214,214,21
Vs 215,215,21
Vs 216,216,21
Vs 217,217,21
Vs 218,218,21
Vs 219,219,21
Vs 220,220,21
Vs 221,221,21
Vs 222,222,21
Vs 223,223,21
Vs 36,36,21
Vs 37,37,21
Vs 38,38,21
v_sub_f32_e64 v39, v39, v21
v_exp_f32 v22, -v21
s_nop 0
Vm 52,52,22
Vm 53,53,22
Vm 54,54,22
v_mul_f32_e64 v55, v55, v22
Ar 8,32
Ar 9,33
Ar 10,34
Ar 11,35
Ar 12,36
Ar 13,37
Ar 14,38
Ar 15,39
Vm 8,8,22
Vm 9,9,22
Vm 10,10,22
Vm 11,11,22
Vm 12,12,22
Vm 13,13,22
Vm 14,14,22
Vm 15,15,22
Aw 32,8
Aw 33,9
Aw 34,10
Aw 35,11
Aw 36,12
Aw 37,13
Aw 38,14
Aw 39,15
Ar 8,40
Ar 9,41
Ar 10,42
Ar 11,43
Ar 12,44
Ar 13,45
Ar 14,46
Ar 15,47
Vm 8,8,22
Vm 9,9,22
Vm 10,10,22
Vm 11,11,22
Vm 12,12,22
Vm 13,13,22
Vm 14,14,22
Vm 15,15,22
Aw 40,8
Aw 41,9
Aw 42,10
Aw 43,11
Aw 44,12
Aw 45,13
Aw 46,14
Aw 47,15
Ar 8,48
Ar 9,49
Ar 10,50
Ar 11,51
Ar 12,52
Ar 13,53
Ar 14,54
Ar 15,55
Vm 8,8,22
Vm 9,9,22
Vm 10,10,22
Vm 11,11,22
Vm 12,12,22
Vm 13,13,22
Vm 14,14,22
Vm 15,15,22
Aw 48,8
Aw 49,9
Aw 50,10
Aw 51,11
Aw 52,12
Aw 53,13
Aw 54,14
Aw 55,15
Ar 8,56
Ar 9,57
Ar 10,58
Ar 11,59
Ar 12,60
Ar 13,61
Ar 14,62
Ar 15,63
Vm 8,8,22
Vm 9,9,22
Vm 10,10,22
Vm 11,11,22
Vm 12,12,22
Vm 13,13,22
Vm 14,14,22
Vm 15,15,22
Aw 56,8
Aw 57,9
Aw 58,10
Aw 59,11
Aw 60,12
Aw 61,13
Aw 62,14
Aw 63,15
v_max3_f32 v21, v160, v161, v162
v_max3_f32 v21, v21, v163, v164
v_max3_f32 v21, v21, v165, v166
v_max3_f32 v21, v21, v167, v168
v_max3_f32 v21, v21, v169, v170
v_max3_f32 v21, v21, v171, v172
v_max3_f32 v21, v21, v173, v174
v_max_f32 v21, v21, v175
v_mov_b32 v1, v21
s_nop 1
v_permlane16_swap_b32 v1, v21
v_max_f32 v21, v21, v1
v_mov_b32 v1, v21
s_nop 1
v_permlane32_swap_b32 v1, v21
v_max_f32_e64 v21, v21, v1
v_add_f32 v21, 0x41f80000, v21
v_max_f32 v21, 0, v21
Vs 160,160,21
Vs 161,161,21
Vs 162,162,21
Vs 163,163,21
Vs 164,164,21
Vs 165,165,21
Vs 166,166,21
Vs 167,167,21
Vs 168,168,21
Vs 169,169,21
Vs 170,170,21
Vs 171,171,21
Vs 172,172,21
Vs 173,173,21
Vs 174,174,21
Vs 175,175,21
Vs 224,224,21
Vs 225,225,21
Vs 226,226,21
Vs 227,227,21
Vs 228,228,21
Vs 229,229,21
Vs 230,230,21
Vs 231,231,21
Vs 232,232,21
Vs 233,233,21
Vs 234,234,21
Vs 235,235,21
Vs 236,236,21
Vs 237,237,21
Vs 238,238,21
Vs 239,239,21
Vs 40,40,21
Vs 41,41,21
Vs 42,42,21
v_sub_f32_e64 v43, v43, v21
v_exp_f32 v22, -v21
s_nop 0
Vm 56,56,22
Vm 57,57,22
Vm 58,58,22
v_mul_f32_e64 v59, v59, v22
Ar 8,64
Ar 9,65
Ar 10,66
Ar 11,67
Ar 12,68
Ar 13,69
Ar 14,70
Ar 15,71
Vm 8,8,22
Vm 9,9,22
Vm 10,10,22
Vm 11,11,22
Vm 12,12,22
Vm 13,13,22
Vm 14,14,22
Vm 15,15,22
Aw 64,8
Aw 65,9
Aw 66,10
Aw 67,11
Aw 68,12
Aw 69,13
Aw 70,14
Aw 71,15
Ar 8,72
Ar 9,73
Ar 10,74
Ar 11,75
Ar 12,76
Ar 13,77
Ar 14,78
Ar 15,79
Vm 8,8,22
Vm 9,9,22
Vm 10,10,22
Vm 11,11,22
Vm 12,12,22
Vm 13,13,22
Vm 14,14,22
Vm 15,15,22
Aw 72,8
Aw 73,9
Aw 74,10
Aw 75,11
Aw 76,12
Aw 77,13
Aw 78,14
Aw 79,15
Ar 8,80
Ar 9,81
Ar 10,82
Ar 11,83
Ar 12,84
Ar 13,85
Ar 14,86
Ar 15,87
Vm 8,8,22
Vm 9,9,22
Vm 10,10,22
Vm 11,11,22
Vm 12,12,22
Vm 13,13,22
Vm 14,14,22
Vm 15,15,22
Aw 80,8
Aw 81,9
Aw 82,10
Aw 83,11
Aw 84,12
Aw 85,13
Aw 86,14
Aw 87,15
Ar 8,88
Ar 9,89
Ar 10,90
Ar 11,91
Ar 12,92
Ar 13,93
Ar 14,94
Ar 15,95
Vm 8,8,22
Vm 9,9,22
Vm 10,10,22
Vm 11,11,22
Vm 12,12,22
Vm 13,13,22
Vm 14,14,22
Vm 15,15,22
Aw 88,8
Aw 89,9
Aw 90,10
Aw 91,11
Aw 92,12
Aw 93,13
Aw 94,14
Aw 95,15
v_max3_f32 v21, v176, v177, v178
v_max3_f32 v21, v21, v179, v180
v_max3_f32 v21, v21, v181, v182
v_max3_f32 v21, v21, v183, v184
v_max3_f32 v21, v21, v185, v186
v_max3_f32 v21, v21, v187, v188
v_max3_f32 v21, v21, v189, v190
v_max_f32 v21, v21, v191
v_mov_b32 v1, v21
s_nop 1
v_permlane16_swap_b32 v1, v21
v_max_f32 v21, v21, v1
v_mov_b32 v1, v21
s_nop 1
v_permlane32_swap_b32 v1, v21
v_max_f32_e64 v21, v21, v1
v_add_f32 v21, 0x41f80000, v21
v_max_f32 v21, 0, v21
Vs 176,176,21
Vs 177,177,21
Vs 178,178,21
Vs 179,179,21
Vs 180,180,21
Vs 181,181,21
Vs 182,182,21
Vs 183,183,21
Vs 184,184,21
Vs 185,185,21
Vs 186,186,21
Vs 187,187,21
Vs 188,188,21
Vs 189,189,21
Vs 190,190,21
Vs 191,191,21
Vs 44,44,21
Vs 45,45,21
Vs 46,46,21
v_sub_f32_e64 v47, v47, v21
v_exp_f32 v22, -v21
s_nop 0
Vm 60,60,22
Vm 61,61,22
Vm 62,62,22
v_mul_f32_e64 v63, v63, v22
Ar 8,96
Ar 9,97
Ar 10,98
Ar 11,99
Ar 12,100
Ar 13,101
Ar 14,102
Ar 15,103
Vm 8,8,22
Vm 9,9,22
Vm 10,10,22
Vm 11,11,22
Vm 12,12,22
Vm 13,13,22
Vm 14,14,22
Vm 15,15,22
Aw 96,8
Aw 97,9
Aw 98,10
Aw 99,11
Aw 100,12
Aw 101,13
Aw 102,14
Aw 103,15
Ar 8,104
Ar 9,105
Ar 10,106
Ar 11,107
Ar 12,108
Ar 13,109
Ar 14,110
Ar 15,111
Vm 8,8,22
Vm 9,9,22
Vm 10,10,22
Vm 11,11,22
Vm 12,12,22
Vm 13,13,22
Vm 14,14,22
Vm 15,15,22
Aw 104,8
Aw 105,9
Aw 106,10
Aw 107,11
Aw 108,12
Aw 109,13
Aw 110,14
Aw 111,15
Ar 8,112
Ar 9,113
Ar 10,114
Ar 11,115
Ar 12,116
Ar 13,117
Ar 14,118
Ar 15,119
Vm 8,8,22
Vm 9,9,22
Vm 10,10,22
Vm 11,11,22
Vm 12,12,22
Vm 13,13,22
Vm 14,14,22
Vm 15,15,22
Aw 112,8
Aw 113,9
Aw 114,10
Aw 115,11
Aw 116,12
Aw 117,13
Aw 118,14
Aw 119,15
Ar 8,120
Ar 9,121
Ar 10,122
Ar 11,123
Ar 12,124
Ar 13,125
Ar 14,126
Ar 15,127
Vm 8,8,22
Vm 9,9,22
Vm 10,10,22
Vm 11,11,22
Vm 12,12,22
Vm 13,13,22
Vm 14,14,22
Vm 15,15,22
Aw 120,8
Aw 121,9
Aw 122,10
Aw 123,11
Aw 124,12
Aw 125,13
Aw 126,14
Aw 127,15
Ve 8,128
Ve 9,129
s_nop 0
Vc 64,8,9
Ve 8,130
Ve 9,131
s_nop 0
Vc 65,8,9
Ve 8,144
Ve 9,145
s_nop 0
Vc 72,8,9
Ve 8,146
Ve 9,147
s_nop 0
Vc 73,8,9
Ve 8,160
Ve 9,161
s_nop 0
Vc 80,8,9
Ve 8,162
Ve 9,163
s_nop 0
Vc 81,8,9
Ve 8,176
Ve 9,177
s_nop 0
Vc 88,8,9
Ve 8,178
Ve 9,179
s_nop 0
Vc 89,8,9
Ve 8,132
Ve 9,133
s_nop 0
Vc 66,8,9
Ve 8,134
Ve 9,135
s_nop 0
Vc 67,8,9
Ve 8,148
Ve 9,149
s_nop 0
Vc 74,8,9
Ve 8,150
Ve 9,151
s_nop 0
Vc 75,8,9
Ve 8,164
Ve 9,165
s_nop 0
Vc 82,8,9
Ve 8,166
Ve 9,167
s_nop 0
Vc 83,8,9
Ve 8,180
Ve 9,181
s_nop 0
Vc 90,8,9
Ve 8,182
Ve 9,183
s_nop 0
Vc 91,8,9
Ve 8,136
Ve 9,137
s_nop 0
Vc 68,8,9
Ve 8,138
Ve 9,139
s_nop 0
Vc 69,8,9
Ve 8,152
Ve 9,153
s_nop 0
Vc 76,8,9
Ve 8,154
Ve 9,155
s_nop 0
Vc 77,8,9
Ve 8,168
Ve 9,169
s_nop 0
Vc 84,8,9
Ve 8,170
Ve 9,171
s_nop 0
Vc 85,8,9
Ve 8,184
Ve 9,185
s_nop 0
Vc 92,8,9
Ve 8,186
Ve 9,187
s_nop 0
Vc 93,8,9
Ve 8,140
Ve 9,141
s_nop 0
Vc 70,8,9
Ve 8,142
Ve 9,143
s_nop 0
Vc 71,8,9
Ve 8,156
Ve 9,157
s_nop 0
Vc 78,8,9
Ve 8,158
Ve 9,159
s_nop 0
Vc 79,8,9
Ve 8,172
Ve 9,173
s_nop 0
Vc 86,8,9
Ve 8,174
Ve 9,175
s_nop 0
Vc 87,8,9
Ve 8,188
Ve 9,189
s_nop 0
Vc 94,8,9
Ve 8,190
Ve 9,191
s_nop 0
Vc 95,8,9
s_nop 1
s_branch L_k2_fbr_wl
L_k2_mk_wl:
v_cmp_gt_i32 s[56:57], 0, v6
v_cmp_gt_i32 s[58:59], 1, v6
v_cmp_gt_i32 s[60:61], 2, v6
v_cmp_gt_i32 s[62:63], 3, v6
s_nop 3
s_nop 0
v_cndmask_b32 v224, v224, v20, s[56:57]
v_cndmask_b32 v225, v225, v20, s[58:59]
v_cndmask_b32 v226, v226, v20, s[60:61]
v_cndmask_b32 v227, v227, v20, s[62:63]
v_cmp_gt_i32 s[56:57], 16, v6
v_cmp_gt_i32 s[58:59], 17, v6
v_cmp_gt_i32 s[60:61], 18, v6
v_cmp_gt_i32 s[62:63], 19, v6
v_cndmask_b32 v228, v228, v20, s[56:57]
v_cndmask_b32 v229, v229, v20, s[58:59]
v_cndmask_b32 v230, v230, v20, s[60:61]
v_cndmask_b32 v231, v231, v20, s[62:63]
v_cmp_gt_i32 s[56:57], 32, v6
v_cmp_gt_i32 s[58:59], 33, v6
v_cmp_gt_i32 s[60:61], 34, v6
v_cmp_gt_i32 s[62:63], 35, v6
v_cndmask_b32 v232, v232, v20, s[56:57]
v_cndmask_b32 v233, v233, v20, s[58:59]
v_cndmask_b32 v234, v234, v20, s[60:61]
v_cndmask_b32 v235, v235, v20, s[62:63]
v_cmp_gt_i32 s[56:57], 48, v6
v_cmp_gt_i32 s[58:59], 49, v6
v_cmp_gt_i32 s[60:61], 50, v6
v_cmp_gt_i32 s[62:63], 51, v6
v_cndmask_b32 v236, v236, v20, s[56:57]
v_cndmask_b32 v237, v237, v20, s[58:59]
v_cndmask_b32 v238, v238, v20, s[60:61]
v_cndmask_b32 v239, v239, v20, s[62:63]
s_branch L_k2_mkr_wl
L_k2_fb_tr:
s_nop 7
v_max3_f32 v21, v192, v193, v194
v_max3_f32 v21, v21, v195, v196
v_max3_f32 v21, v21, v197, v198
v_max3_f32 v21, v21, v199, v200
v_max3_f32 v21, v21, v201, v202
v_max3_f32 v21, v21, v203, v204
v_max3_f32 v21, v21, v205, v206
v_max_f32 v21, v21, v207
v_mov_b32 v1, v21
s_nop 1
v_permlane16_swap_b32 v1, v21
v_max_f32 v21, v21, v1
v_mov_b32 v1, v21
s_nop 1
v_permlane32_swap_b32 v1, v21
v_max_f32_e64 v21, v21, v1
v_add_f32 v21, 0x41f80000, v21
v_max_f32 v21, 0, v21
Vs 192,192,21
Vs 193,193,21
Vs 194,194,21
Vs 195,195,21
Vs 196,196,21
Vs 197,197,21
Vs 198,198,21
Vs 199,199,21
Vs 200,200,21
Vs 201,201,21
Vs 202,202,21
Vs 203,203,21
Vs 204,204,21
Vs 205,205,21
Vs 206,206,21
Vs 207,207,21
Vs 128,128,21
Vs 129,129,21
Vs 130,130,21
Vs 131,131,21
Vs 132,132,21
Vs 133,133,21
Vs 134,134,21
Vs 135,135,21
Vs 136,136,21
Vs 137,137,21
Vs 138,138,21
Vs 139,139,21
Vs 140,140,21
Vs 141,141,21
Vs 142,142,21
Vs 143,143,21
Vs 32,32,21
Vs 33,33,21
Vs 34,34,21
v_sub_f32_e64 v35, v35, v21
v_exp_f32 v22, -v21
s_nop 0
Vm 48,48,22
Vm 49,49,22
Vm 50,50,22
v_mul_f32_e64 v51, v51, v22
Ar 8,0
Ar 9,1
Ar 10,2
Ar 11,3
Ar 12,4
Ar 13,5
Ar 14,6
Ar 15,7
Vm 8,8,22
Vm 9,9,22
Vm 10,10,22
Vm 11,11,22
Vm 12,12,22
Vm 13,13,22
Vm 14,14,22
Vm 15,15,22
Aw 0,8
Aw 1,9
Aw 2,10
Aw 3,11
Aw 4,12
Aw 5,13
Aw 6,14
Aw 7,15
Ar 8,8
Ar 9,9
Ar 10,10
Ar 11,11
Ar 12,12
Ar 13,13
Ar 14,14
Ar 15,15
Vm 8,8,22
Vm 9,9,22
Vm 10,10,22
Vm 11,11,22
Vm 12,12,22
Vm 13,13,22
Vm 14,14,22
Vm 15,15,22
Aw 8,8
Aw 9,9
Aw 10,10
Aw 11,11
Aw 12,12
Aw 13,13
Aw 14,14
Aw 15,15
Ar 8,16
Ar 9,17
Ar 10,18
Ar 11,19
Ar 12,20
Ar 13,21
Ar 14,22
Ar 15,23
Vm 8,8,22
Vm 9,9,22
Vm 10,10,22
Vm 11,11,22
Vm 12,12,22
Vm 13,13,22
Vm 14,14,22
Vm 15,15,22
Aw 16,8
Aw 17,9
Aw 18,10
Aw 19,11
Aw 20,12
Aw 21,13
Aw 22,14
Aw 23,15
Ar 8,24
Ar 9,25
Ar 10,26
Ar 11,27
Ar 12,28
Ar 13,29
Ar 14,30
Ar 15,31
Vm 8,8,22
Vm 9,9,22
Vm 10,10,22
Vm 11,11,22
Vm 12,12,22
Vm 13,13,22
Vm 14,14,22
Vm 15,15,22
Aw 24,8
Aw 25,9
Aw 26,10
Aw 27,11
Aw 28,12
Aw 29,13
Aw 30,14
Aw 31,15
v_max3_f32 v21, v208, v209, v210
v_max3_f32 v21, v21, v211, v212
v_max3_f32 v21, v21, v213, v214
v_max3_f32 v21, v21, v215, v216
v_max3_f32 v21, v21, v217, v218
v_max3_f32 v21, v21, v219, v220
v_max3_f32 v21, v21, v221, v222
v_max_f32 v21, v21, v223
v_mov_b32 v1, v21
s_nop 1
v_permlane16_swap_b32 v1, v21
v_max_f32 v21, v21, v1
v_mov_b32 v1, v21
s_nop 1
v_permlane32_swap_b32 v1, v21
v_max_f32_e64 v21, v21, v1
v_add_f32 v21, 0x41f80000, v21
v_max_f32 v21, 0, v21
Vs 208,208,21
Vs 209,209,21
Vs 210,210,21
Vs 211,211,21
Vs 212,212,21
Vs 213,213,21
Vs 214,214,21
Vs 215,215,21
Vs 216,216,21
Vs 217,217,21
Vs 218,218,21
Vs 219,219,21
Vs 220,220,21
Vs 221,221,21
Vs 222,222,21
Vs 223,223,21
Vs 144,144,21
Vs 145,145,21
Vs 146,146,21
Vs 147,147,21
Vs 148,148,21
Vs 149,149,21
Vs 150,150,21
Vs 151,151,21
Vs 152,152,21
Vs 153,153,21
Vs 154,154,21
Vs 155,155,21
Vs 156,156,21
Vs 157,157,21
Vs 158,158,21
Vs 159,159,21
Vs 36,36,21
Vs 37,37,21
Vs 38,38,21
v_sub_f32_e64 v39, v39, v21
v_exp_f32 v22, -v21
s_nop 0
Vm 52,52,22
Vm 53,53,22
Vm 54,54,22
v_mul_f32_e64 v55, v55, v22
Ar 8,32
Ar 9,33
Ar 10,34
Ar 11,35
Ar 12,36
Ar 13,37
Ar 14,38
Ar 15,39
Vm 8,8,22
Vm 9,9,22
Vm 10,10,22
Vm 11,11,22
Vm 12,12,22
Vm 13,13,22
Vm 14,14,22
Vm 15,15,22
Aw 32,8
Aw 33,9
Aw 34,10
Aw 35,11
Aw 36,12
Aw 37,13
Aw 38,14
Aw 39,15
Ar 8,40
Ar 9,41
Ar 10,42
Ar 11,43
Ar 12,44
Ar 13,45
Ar 14,46
Ar 15,47
Vm 8,8,22
Vm 9,9,22
Vm 10,10,22
Vm 11,11,22
Vm 12,12,22
Vm 13,13,22
Vm 14,14,22
Vm 15,15,22
Aw 40,8
Aw 41,9
Aw 42,10
Aw 43,11
Aw 44,12
Aw 45,13
Aw 46,14
Aw 47,15
Ar 8,48
Ar 9,49
Ar 10,50
Ar 11,51
Ar 12,52
Ar 13,53
Ar 14,54
Ar 15,55
Vm 8,8,22
Vm 9,9,22
Vm 10,10,22
Vm 11,11,22
Vm 12,12,22
Vm 13,13,22
Vm 14,14,22
Vm 15,15,22
Aw 48,8
Aw 49,9
Aw 50,10
Aw 51,11
Aw 52,12
Aw 53,13
Aw 54,14
Aw 55,15
Ar 8,56
Ar 9,57
Ar 10,58
Ar 11,59
Ar 12,60
Ar 13,61
Ar 14,62
Ar 15,63
Vm 8,8,22
Vm 9,9,22
Vm 10,10,22
Vm 11,11,22
Vm 12,12,22
Vm 13,13,22
Vm 14,14,22
Vm 15,15,22
Aw 56,8
Aw 57,9
Aw 58,10
Aw 59,11
Aw 60,12
Aw 61,13
Aw 62,14
Aw 63,15
v_max3_f32 v21, v224, v225, v226
v_max3_f32 v21, v21, v227, v228
v_max3_f32 v21, v21, v229, v230
v_max3_f32 v21, v21, v231, v232
v_max3_f32 v21, v21, v233, v234
v_max3_f32 v21, v21, v235, v236
v_max3_f32 v21, v21, v237, v238
v_max_f32 v21, v21, v239
v_mov_b32 v1, v21
s_nop 1
v_permlane16_swap_b32 v1, v21
v_max_f32 v21, v21, v1
v_mov_b32 v1, v21
s_nop 1
v_permlane32_swap_b32 v1, v21
v_max_f32_e64 v21, v21, v1
v_add_f32 v21, 0x41f80000, v21
v_max_f32 v21, 0, v21
Vs 224,224,21
Vs 225,225,21
Vs 226,226,21
Vs 227,227,21
Vs 228,228,21
Vs 229,229,21
Vs 230,230,21
Vs 231,231,21
Vs 232,232,21
Vs 233,233,21
Vs 234,234,21
Vs 235,235,21
Vs 236,236,21
Vs 237,237,21
Vs 238,238,21
Vs 239,239,21
Vs 40,40,21
Vs 41,41,21
Vs 42,42,21
v_sub_f32_e64 v43, v43, v21
v_exp_f32 v22, -v21
s_nop 0
Vm 56,56,22
Vm 57,57,22
Vm 58,58,22
v_mul_f32_e64 v59, v59, v22
Ar 8,64
Ar 9,65
Ar 10,66
Ar 11,67
Ar 12,68
Ar 13,69
Ar 14,70
Ar 15,71
Vm 8,8,22
Vm 9,9,22
Vm 10,10,22
Vm 11,11,22
Vm 12,12,22
Vm 13,13,22
Vm 14,14,22
Vm 15,15,22
Aw 64,8
Aw 65,9
Aw 66,10
Aw 67,11
Aw 68,12
Aw 69,13
Aw 70,14
Aw 71,15
Ar 8,72
Ar 9,73
Ar 10,74
Ar 11,75
Ar 12,76
Ar 13,77
Ar 14,78
Ar 15,79
Vm 8,8,22
Vm 9,9,22
Vm 10,10,22
Vm 11,11,22
Vm 12,12,22
Vm 13,13,22
Vm 14,14,22
Vm 15,15,22
Aw 72,8
Aw 73,9
Aw 74,10
Aw 75,11
Aw 76,12
Aw 77,13
Aw 78,14
Aw 79,15
Ar 8,80
Ar 9,81
Ar 10,82
Ar 11,83
Ar 12,84
Ar 13,85
Ar 14,86
Ar 15,87
Vm 8,8,22
Vm 9,9,22
Vm 10,10,22
Vm 11,11,22
Vm 12,12,22
Vm 13,13,22
Vm 14,14,22
Vm 15,15,22
Aw 80,8
Aw 81,9
Aw 82,10
Aw 83,11
Aw 84,12
Aw 85,13
Aw 86,14
Aw 87,15
Ar 8,88
Ar 9,89
Ar 10,90
Ar 11,91
Ar 12,92
Ar 13,93
Ar 14,94
Ar 15,95
Vm 8,8,22
Vm 9,9,22
Vm 10,10,22
Vm 11,11,22
Vm 12,12,22
Vm 13,13,22
Vm 14,14,22
Vm 15,15,22
Aw 88,8
Aw 89,9
Aw 90,10
Aw 91,11
Aw 92,12
Aw 93,13
Aw 94,14
Aw 95,15
Ve 8,192
Ve 9,193
s_nop 0
Vc 96,8,9
Ve 8,194
Ve 9,195
s_nop 0
Vc 97,8,9
Ve 8,208
Ve 9,209
s_nop 0
Vc 104,8,9
Ve 8,210
Ve 9,211
s_nop 0
Vc 105,8,9
Ve 8,224
Ve 9,225
s_nop 0
Vc 112,8,9
Ve 8,226
Ve 9,227
s_nop 0
Vc 113,8,9
Ve 8,196
Ve 9,197
s_nop 0
Vc 98,8,9
Ve 8,198
Ve 9,199
s_nop 0
Vc 99,8,9
Ve 8,212
Ve 9,213
s_nop 0
Vc 106,8,9
Ve 8,214
Ve 9,215
s_nop 0
Vc 107,8,9
Ve 8,228
Ve 9,229
s_nop 0
Vc 114,8,9
Ve 8,230
Ve 9,231
s_nop 0
Vc 115,8,9
Ve 8,200
Ve 9,201
s_nop 0
Vc 100,8,9
Ve 8,202
Ve 9,203
s_nop 0
Vc 101,8,9
Ve 8,216
Ve 9,217
s_nop 0
Vc 108,8,9
Ve 8,218
Ve 9,219
s_nop 0
Vc 109,8,9
Ve 8,232
Ve 9,233
s_nop 0
Vc 116,8,9
Ve 8,234
Ve 9,235
s_nop 0
Vc 117,8,9
Ve 8,204
Ve 9,205
s_nop 0
Vc 102,8,9
Ve 8,206
Ve 9,207
s_nop 0
Vc 103,8,9
Ve 8,220
Ve 9,221
s_nop 0
Vc 110,8,9
Ve 8,222
Ve 9,223
s_nop 0
Vc 111,8,9
Ve 8,236
Ve 9,237
s_nop 0
Vc 118,8,9
Ve 8,238
Ve 9,239
s_nop 0
Vc 119,8,9
s_nop 1
s_branch L_k2_fbr_tr
L_k2_mk_tr:
v_cmp_gt_i32 s[56:57], 0, v5
v_cmp_gt_i32 s[58:59], 1, v5
v_cmp_gt_i32 s[60:61], 2, v5
v_cmp_gt_i32 s[62:63], 3, v5
s_nop 3
s_nop 0
v_cndmask_b32 v144, v144, v20, s[56:57]
v_cndmask_b32 v145, v145, v20, s[58:59]
v_cndmask_b32 v146, v146, v20, s[60:61]
v_cndmask_b32 v147, v147, v20, s[62:63]
v_cmp_gt_i32 s[56:57], 16, v5
v_cmp_gt_i32 s[58:59], 17, v5
v_cmp_gt_i32 s[60:61], 18, v5
v_cmp_gt_i32 s[62:63], 19, v5
v_cndmask_b32 v148, v148, v20, s[56:57]
v_cndmask_b32 v149, v149, v20, s[58:59]
v_cndmask_b32 v150, v150, v20, s[60:61]
v_cndmask_b32 v151, v151, v20, s[62:63]
v_cmp_gt_i32 s[56:57], 32, v5
v_cmp_gt_i32 s[58:59], 33, v5
v_cmp_gt_i32 s[60:61], 34, v5
v_cmp_gt_i32 s[62:63], 35, v5
v_cndmask_b32 v152, v152, v20, s[56:57]
v_cndmask_b32 v153, v153, v20, s[58:59]
v_cndmask_b32 v154, v154, v20, s[60:61]
v_cndmask_b32 v155, v155, v20, s[62:63]
v_cmp_gt_i32 s[56:57], 48, v5
v_cmp_gt_i32 s[58:59], 49, v5
v_cmp_gt_i32 s[60:61], 50, v5
v_cmp_gt_i32 s[62:63], 51, v5
v_cndmask_b32 v156, v156, v20, s[56:57]
v_cndmask_b32 v157, v157, v20, s[58:59]
v_cndmask_b32 v158, v158, v20, s[60:61]
v_cndmask_b32 v159, v159, v20, s[62:63]
s_branch L_k2_mkr_tr
L_k2_fb_ne:
s_nop 7
v_max3_f32 v21, v128, v129, v130
v_max3_f32 v21, v21, v131, v132
v_max3_f32 v21, v21, v133, v134
v_max3_f32 v21, v21, v135, v136
v_max3_f32 v21, v21, v137, v138
v_max3_f32 v21, v21, v139, v140
v_max3_f32 v21, v21, v141, v142
v_max_f32 v21, v21, v143
v_mov_b32 v1, v21
s_nop 1
v_permlane16_swap_b32 v1, v21
v_max_f32 v21, v21, v1
v_mov_b32 v1, v21
s_nop 1
v_permlane32_swap_b32 v1, v21
v_max_f32_e64 v21, v21, v1
v_add_f32 v21, 0x41f80000, v21
v_max_f32 v21, 0, v21
Vs 128,128,21
Vs 129,129,21
Vs 130,130,21
Vs 131,131,21
Vs 132,132,21
Vs 133,133,21
Vs 134,134,21
Vs 135,135,21
Vs 136,136,21
Vs 137,137,21
Vs 138,138,21
Vs 139,139,21
Vs 140,140,21
Vs 141,141,21
Vs 142,142,21
Vs 143,143,21
Vs 192,192,21
Vs 193,193,21
Vs 194,194,21
Vs 195,195,21
Vs 196,196,21
Vs 197,197,21
Vs 198,198,21
Vs 199,199,21
Vs 200,200,21
Vs 201,201,21
Vs 202,202,21
Vs 203,203,21
Vs 204,204,21
Vs 205,205,21
Vs 206,206,21
Vs 207,207,21
Vs 32,32,21
Vs 33,33,21
Vs 34,34,21
v_sub_f32_e64 v35, v35, v21
v_exp_f32 v22, -v21
s_nop 0
Vm 48,48,22
Vm 49,49,22
Vm 50,50,22
v_mul_f32_e64 v51, v51, v22
Ar 8,0
Ar 9,1
Ar 10,2
Ar 11,3
Ar 12,4
Ar 13,5
Ar 14,6
Ar 15,7
Vm 8,8,22
Vm 9,9,22
Vm 10,10,22
Vm 11,11,22
Vm 12,12,22
Vm 13,13,22
Vm 14,14,22
Vm 15,15,22
Aw 0,8
Aw 1,9
Aw 2,10
Aw 3,11
Aw 4,12
Aw 5,13
Aw 6,14
Aw 7,15
Ar 8,8
Ar 9,9
Ar 10,10
Ar 11,11
Ar 12,12
Ar 13,13
Ar 14,14
Ar 15,15
Vm 8,8,22
Vm 9,9,22
Vm 10,10,22
Vm 11,11,22
Vm 12,12,22
Vm 13,13,22
Vm 14,14,22
Vm 15,15,22
Aw 8,8
Aw 9,9
Aw 10,10
Aw 11,11
Aw 12,12
Aw 13,13
Aw 14,14
Aw 15,15
Ar 8,16
Ar 9,17
Ar 10,18
Ar 11,19
Ar 12,20
Ar 13,21
Ar 14,22
Ar 15,23
Vm 8,8,22
Vm 9,9,22
Vm 10,10,22
Vm 11,11,22
Vm 12,12,22
Vm 13,13,22
Vm 14,14,22
Vm 15,15,22
Aw 16,8
Aw 17,9
Aw 18,10
Aw 19,11
Aw 20,12
Aw 21,13
Aw 22,14
Aw 23,15
Ar 8,24
Ar 9,25
Ar 10,26
Ar 11,27
Ar 12,28
Ar 13,29
Ar 14,30
Ar 15,31
Vm 8,8,22
Vm 9,9,22
Vm 10,10,22
Vm 11,11,22
Vm 12,12,22
Vm 13,13,22
Vm 14,14,22
Vm 15,15,22
Aw 24,8
Aw 25,9
Aw 26,10
Aw 27,11
Aw 28,12
Aw 29,13
Aw 30,14
Aw 31,15
v_max3_f32 v21, v144, v145, v146
v_max3_f32 v21, v21, v147, v148
v_max3_f32 v21, v21, v149, v150
v_max3_f32 v21, v21, v151, v152
v_max3_f32 v21, v21, v153, v154
v_max3_f32 v21, v21, v155, v156
v_max3_f32 v21, v21, v157, v158
v_max_f32 v21, v21, v159
v_mov_b32 v1, v21
s_nop 1
v_permlane16_swap_b32 v1, v21
v_max_f32 v21, v21, v1
v_mov_b32 v1, v21
s_nop 1
v_permlane32_swap_b32 v1, v21
v_max_f32_e64 v21, v21, v1
v_add_f32 v21, 0x41f80000, v21
v_max_f32 v21, 0, v21
Vs 144,144,21
Vs 145,145,21
Vs 146,146,21
Vs 147,147,21
Vs 148,148,21
Vs 149,149,21
Vs 150,150,21
Vs 151,151,21
Vs 152,152,21
Vs 153,153,21
Vs 154,154,21
Vs 155,155,21
Vs 156,156,21
Vs 157,157,21
Vs 158,158,21
Vs 159,159,21
Vs 208,208,21
Vs 209,209,21
Vs 210,210,21
Vs 211,211,21
Vs 212,212,21
Vs 213,213,21
Vs 214,214,21
Vs 215,215,21
Vs 216,216,21
Vs 217,217,21
Vs 218,218,21
Vs 219,219,21
Vs 220,220,21
Vs 221,221,21
Vs 222,222,21
Vs 223,223,21
Vs 36,36,21
Vs 37,37,21
Vs 38,38,21
v_sub_f32_e64 v39, v39, v21
v_exp_f32 v22, -v21
s_nop 0
Vm 52,52,22
Vm 53,53,22
Vm 54,54,22
v_mul_f32_e64 v55, v55, v22
Ar 8,32
Ar 9,33
Ar 10,34
Ar 11,35
Ar 12,36
Ar 13,37
Ar 14,38
Ar 15,39
Vm 8,8,22
Vm 9,9,22
Vm 10,10,22
Vm 11,11,22
Vm 12,12,22
Vm 13,13,22
Vm 14,14,22
Vm 15,15,22
Aw 32,8
Aw 33,9
Aw 34,10
Aw 35,11
Aw 36,12
Aw 37,13
Aw 38,14
Aw 39,15
Ar 8,40
Ar 9,41
Ar 10,42
Ar 11,43
Ar 12,44
Ar 13,45
Ar 14,46
Ar 15,47
Vm 8,8,22
Vm 9,9,22
Vm 10,10,22
Vm 11,11,22
Vm 12,12,22
Vm 13,13,22
Vm 14,14,22
Vm 15,15,22
Aw 40,8
Aw 41,9
Aw 42,10
Aw 43,11
Aw 44,12
Aw 45,13
Aw 46,14
Aw 47,15
Ar 8,48
Ar 9,49
Ar 10,50
Ar 11,51
Ar 12,52
Ar 13,53
Ar 14,54
Ar 15,55
Vm 8,8,22
Vm 9,9,22
Vm 10,10,22
Vm 11,11,22
Vm 12,12,22
Vm 13,13,22
Vm 14,14,22
Vm 15,15,22
Aw 48,8
Aw 49,9
Aw 50,10
Aw 51,11
Aw 52,12
Aw 53,13
Aw 54,14
Aw 55,15
Ar 8,56
Ar 9,57
Ar 10,58
Ar 11,59
Ar 12,60
Ar 13,61
Ar 14,62
Ar 15,63
Vm 8,8,22
Vm 9,9,22
Vm 10,10,22
Vm 11,11,22
Vm 12,12,22
Vm 13,13,22
Vm 14,14,22
Vm 15,15,22
Aw 56,8
Aw 57,9
Aw 58,10
Aw 59,11
Aw 60,12
Aw 61,13
Aw 62,14
Aw 63,15
Ve 8,128
Ve 9,129
s_nop 0
Vc 64,8,9
Ve 8,130
Ve 9,131
s_nop 0
Vc 65,8,9
Ve 8,144
Ve 9,145
s_nop 0
Vc 72,8,9
Ve 8,146
Ve 9,147
s_nop 0
Vc 73,8,9
Ve 8,132
Ve 9,133
s_nop 0
Vc 66,8,9
Ve 8,134
Ve 9,135
s_nop 0
Vc 67,8,9
Ve 8,148
Ve 9,149
s_nop 0
Vc 74,8,9
Ve 8,150
Ve 9,151
s_nop 0
Vc 75,8,9
Ve 8,136
Ve 9,137
s_nop 0
Vc 68,8,9
Ve 8,138
Ve 9,139
s_nop 0
Vc 69,8,9
Ve 8,152
Ve 9,153
s_nop 0
Vc 76,8,9
Ve 8,154
Ve 9,155
s_nop 0
Vc 77,8,9
Ve 8,140
Ve 9,141
s_nop 0
Vc 70,8,9
Ve 8,142
Ve 9,143
s_nop 0
Vc 71,8,9
Ve 8,156
Ve 9,157
s_nop 0
Vc 78,8,9
Ve 8,158
Ve 9,159
s_nop 0
Vc 79,8,9
s_nop 1
s_branch L_k2_fbr_ne
L_pubB:
v_mov_b32 v24, 1
v_mov_b32 v25, 0
s_mov_b64 exec, 1
buffer_store_dword v24, v25, s[20:23], s64 offen sc1
s_mov_b64 exec, -1
s_branch L_pubBr
L_k2_fb_no:
s_nop 7
v_max3_f32 v21, v192, v193, v194
v_max3_f32 v21, v21, v195, v196
v_max3_f32 v21, v21, v197, v198
v_max3_f32 v21, v21, v199, v200
v_max3_f32 v21, v21, v201, v202
v_max3_f32 v21, v21, v203, v204
v_max3_f32 v21, v21, v205, v206
v_max_f32 v21, v21, v207
v_mov_b32 v1, v21
s_nop 1
v_permlane16_swap_b32 v1, v21
v_max_f32 v21, v21, v1
v_mov_b32 v1, v21
s_nop 1
v_permlane32_swap_b32 v1, v21
v_max_f32_e64 v21, v21, v1
v_add_f32 v21, 0x41f80000, v21
v_max_f32 v21, 0, v21
Vs 192,192,21
Vs 193,193,21
Vs 194,194,21
Vs 195,195,21
Vs 196,196,21
Vs 197,197,21
Vs 198,198,21
Vs 199,199,21
Vs 200,200,21
Vs 201,201,21
Vs 202,202,21
Vs 203,203,21
Vs 204,204,21
Vs 205,205,21
Vs 206,206,21
Vs 207,207,21
Vs 128,128,21
Vs 129,129,21
Vs 130,130,21
Vs 131,131,21
Vs 132,132,21
Vs 133,133,21
Vs 134,134,21
Vs 135,135,21
Vs 136,136,21
Vs 137,137,21
Vs 138,138,21
Vs 139,139,21
Vs 140,140,21
Vs 141,141,21
Vs 142,142,21
Vs 143,143,21
Vs 32,32,21
Vs 33,33,21
Vs 34,34,21
v_sub_f32_e64 v35, v35, v21
v_exp_f32 v22, -v21
s_nop 0
Vm 48,48,22
Vm 49,49,22
Vm 50,50,22
v_mul_f32_e64 v51, v51, v22
Ar 8,0
Ar 9,1
Ar 10,2
Ar 11,3
Ar 12,4
Ar 13,5
Ar 14,6
Ar 15,7
Vm 8,8,22
Vm 9,9,22
Vm 10,10,22
Vm 11,11,22
Vm 12,12,22
Vm 13,13,22
Vm 14,14,22
Vm 15,15,22
Aw 0,8
Aw 1,9
Aw 2,10
Aw 3,11
Aw 4,12
Aw 5,13
Aw 6,14
Aw 7,15
Ar 8,8
Ar 9,9
Ar 10,10
Ar 11,11
Ar 12,12
Ar 13,13
Ar 14,14
Ar 15,15
Vm 8,8,22
Vm 9,9,22
Vm 10,10,22
Vm 11,11,22
Vm 12,12,22
Vm 13,13,22
Vm 14,14,22
Vm 15,15,22
Aw 8,8
Aw 9,9
Aw 10,10
Aw 11,11
Aw 12,12
Aw 13,13
Aw 14,14
Aw 15,15
Ar 8,16
Ar 9,17
Ar 10,18
Ar 11,19
Ar 12,20
Ar 13,21
Ar 14,22
Ar 15,23
Vm 8,8,22
Vm 9,9,22
Vm 10,10,22
Vm 11,11,22
Vm 12,12,22
Vm 13,13,22
Vm 14,14,22
Vm 15,15,22
Aw 16,8
Aw 17,9
Aw 18,10
Aw 19,11
Aw 20,12
Aw 21,13
Aw 22,14
Aw 23,15
Ar 8,24
Ar 9,25
Ar 10,26
Ar 11,27
Ar 12,28
Ar 13,29
Ar 14,30
Ar 15,31
Vm 8,8,22
Vm 9,9,22
Vm 10,10,22
Vm 11,11,22
Vm 12,12,22
Vm 13,13,22
Vm 14,14,22
Vm 15,15,22
Aw 24,8
Aw 25,9
Aw 26,10
Aw 27,11
Aw 28,12
Aw 29,13
Aw 30,14
Aw 31,15
v_max3_f32 v21, v208, v209, v210
v_max3_f32 v21, v21, v211, v212
v_max3_f32 v21, v21, v213, v214
v_max3_f32 v21, v21, v215, v216
v_max3_f32 v21, v21, v217, v218
v_max3_f32 v21, v21, v219, v220
v_max3_f32 v21, v21, v221, v222
v_max_f32 v21, v21, v223
v_mov_b32 v1, v21
s_nop 1
v_permlane16_swap_b32 v1, v21
v_max_f32 v21, v21, v1
v_mov_b32 v1, v21
s_nop 1
v_permlane32_swap_b32 v1, v21
v_max_f32_e64 v21, v21, v1
v_add_f32 v21, 0x41f80000, v21
v_max_f32 v21, 0, v21
Vs 208,208,21
Vs 209,209,21
Vs 210,210,21
Vs 211,211,21
Vs 212,212,21
Vs 213,213,21
Vs 214,214,21
Vs 215,215,21
Vs 216,216,21
Vs 217,217,21
Vs 218,218,21
Vs 219,219,21
Vs 220,220,21
Vs 221,221,21
Vs 222,222,21
Vs 223,223,21
Vs 144,144,21
Vs 145,145,21
Vs 146,146,21
Vs 147,147,21
Vs 148,148,21
Vs 149,149,21
Vs 150,150,21
Vs 151,151,21
Vs 152,152,21
Vs 153,153,21
Vs 154,154,21
Vs 155,155,21
Vs 156,156,21
Vs 157,157,21
Vs 158,158,21
Vs 159,159,21
Vs 36,36,21
Vs 37,37,21
Vs 38,38,21
v_sub_f32_e64 v39, v39, v21
v_exp_f32 v22, -v21
s_nop 0
Vm 52,52,22
Vm 53,53,22
Vm 54,54,22
v_mul_f32_e64 v55, v55, v22
Ar 8,32
Ar 9,33
Ar 10,34
Ar 11,35
Ar 12,36
Ar 13,37
Ar 14,38
Ar 15,39
Vm 8,8,22
Vm 9,9,22
Vm 10,10,22
Vm 11,11,22
Vm 12,12,22
Vm 13,13,22
Vm 14,14,22
Vm 15,15,22
Aw 32,8
Aw 33,9
Aw 34,10
Aw 35,11
Aw 36,12
Aw 37,13
Aw 38,14
Aw 39,15
Ar 8,40
Ar 9,41
Ar 10,42
Ar 11,43
Ar 12,44
Ar 13,45
Ar 14,46
Ar 15,47
Vm 8,8,22
Vm 9,9,22
Vm 10,10,22
Vm 11,11,22
Vm 12,12,22
Vm 13,13,22
Vm 14,14,22
Vm 15,15,22
Aw 40,8
Aw 41,9
Aw 42,10
Aw 43,11
Aw 44,12
Aw 45,13
Aw 46,14
Aw 47,15
Ar 8,48
Ar 9,49
Ar 10,50
Ar 11,51
Ar 12,52
Ar 13,53
Ar 14,54
Ar 15,55
Vm 8,8,22
Vm 9,9,22
Vm 10,10,22
Vm 11,11,22
Vm 12,12,22
Vm 13,13,22
Vm 14,14,22
Vm 15,15,22
Aw 48,8
Aw 49,9
Aw 50,10
Aw 51,11
Aw 52,12
Aw 53,13
Aw 54,14
Aw 55,15
Ar 8,56
Ar 9,57
Ar 10,58
Ar 11,59
Ar 12,60
Ar 13,61
Ar 14,62
Ar 15,63
Vm 8,8,22
Vm 9,9,22
Vm 10,10,22
Vm 11,11,22
Vm 12,12,22
Vm 13,13,22
Vm 14,14,22
Vm 15,15,22
Aw 56,8
Aw 57,9
Aw 58,10
Aw 59,11
Aw 60,12
Aw 61,13
Aw 62,14
Aw 63,15
Ve 8,192
Ve 9,193
s_nop 0
Vc 96,8,9
Ve 8,194
Ve 9,195
s_nop 0
Vc 97,8,9
Ve 8,208
Ve 9,209
s_nop 0
Vc 104,8,9
Ve 8,210
Ve 9,211
s_nop 0
Vc 105,8,9
Ve 8,196
Ve 9,197
s_nop 0
Vc 98,8,9
Ve 8,198
Ve 9,199
s_nop 0
Vc 99,8,9
Ve 8,212
Ve 9,213
s_nop 0
Vc 106,8,9
Ve 8,214
Ve 9,215
s_nop 0
Vc 107,8,9
Ve 8,200
Ve 9,201
s_nop 0
Vc 100,8,9
Ve 8,202
Ve 9,203
s_nop 0
Vc 101,8,9
Ve 8,216
Ve 9,217
s_nop 0
Vc 108,8,9
Ve 8,218
Ve 9,219
s_nop 0
Vc 109,8,9
Ve 8,204
Ve 9,205
s_nop 0
Vc 102,8,9
Ve 8,206
Ve 9,207
s_nop 0
Vc 103,8,9
Ve 8,220
Ve 9,221
s_nop 0
Vc 110,8,9
Ve 8,222
Ve 9,223
s_nop 0
Vc 111,8,9
s_nop 1
s_branch L_k2_fbr_no
L_k2_mk_no:
v_cmp_gt_i32 s[56:57], 0, v5
v_cmp_gt_i32 s[58:59], 1, v5
v_cmp_gt_i32 s[60:61], 2, v5
v_cmp_gt_i32 s[62:63], 3, v5
s_nop 3
s_nop 0
v_cndmask_b32 v144, v144, v20, s[56:57]
v_cndmask_b32 v145, v145, v20, s[58:59]
v_cndmask_b32 v146, v146, v20, s[60:61]
v_cndmask_b32 v147, v147, v20, s[62:63]
v_cmp_gt_i32 s[56:57], 16, v5
v_cmp_gt_i32 s[58:59], 17, v5
v_cmp_gt_i32 s[60:61], 18, v5
v_cmp_gt_i32 s[62:63], 19, v5
v_cndmask_b32 v148, v148, v20, s[56:57]
v_cndmask_b32 v149, v149, v20, s[58:59]
v_cndmask_b32 v150, v150, v20, s[60:61]
v_cndmask_b32 v151, v151, v20, s[62:63]
v_cmp_gt_i32 s[56:57], 32, v5
v_cmp_gt_i32 s[58:59], 33, v5
v_cmp_gt_i32 s[60:61], 34, v5
v_cmp_gt_i32 s[62:63], 35, v5
v_cndmask_b32 v152, v152, v20, s[56:57]
v_cndmask_b32 v153, v153, v20, s[58:59]
v_cndmask_b32 v154, v154, v20, s[60:61]
v_cndmask_b32 v155, v155, v20, s[62:63]
v_cmp_gt_i32 s[56:57], 48, v5
v_cmp_gt_i32 s[58:59], 49, v5
v_cmp_gt_i32 s[60:61], 50, v5
v_cmp_gt_i32 s[62:63], 51, v5
v_cndmask_b32 v156, v156, v20, s[56:57]
v_cndmask_b32 v157, v157, v20, s[58:59]
v_cndmask_b32 v158, v158, v20, s[60:61]
v_cndmask_b32 v159, v159, v20, s[62:63]
s_branch L_k2_mkr_no
L_k2_fb_nl:
s_nop 7
v_max3_f32 v21, v128, v129, v130
v_max3_f32 v21, v21, v131, v132
v_max3_f32 v21, v21, v133, v134
v_max3_f32 v21, v21, v135, v136
v_max3_f32 v21, v21, v137, v138
v_max3_f32 v21, v21, v139, v140
v_max3_f32 v21, v21, v141, v142
v_max_f32 v21, v21, v143
v_mov_b32 v1, v21
s_nop 1
v_permlane16_swap_b32 v1, v21
v_max_f32 v21, v21, v1
v_mov_b32 v1, v21
s_nop 1
v_permlane32_swap_b32 v1, v21
v_max_f32_e64 v21, v21, v1
v_add_f32 v21, 0x41f80000, v21
v_max_f32 v21, 0, v21
Vs 128,128,21
Vs 129,129,21
Vs 130,130,21
Vs 131,131,21
Vs 132,132,21
Vs 133,133,21
Vs 134,134,21
Vs 135,135,21
Vs 136,136,21
Vs 137,137,21
Vs 138,138,21
Vs 139,139,21
Vs 140,140,21
Vs 141,141,21
Vs 142,142,21
Vs 143,143,21
Vs 192,192,21
Vs 193,193,21
Vs 194,194,21
Vs 195,195,21
Vs 196,196,21
Vs 197,197,21
Vs 198,198,21
Vs 199,199,21
Vs 200,200,21
Vs 201,201,21
Vs 202,202,21
Vs 203,203,21
Vs 204,204,21
Vs 205,205,21
Vs 206,206,21
Vs 207,207,21
Vs 32,32,21
Vs 33,33,21
Vs 34,34,21
v_sub_f32_e64 v35, v35, v21
v_exp_f32 v22, -v21
s_nop 0
Vm 48,48,22
Vm 49,49,22
Vm 50,50,22
v_mul_f32_e64 v51, v51, v22
Ar 8,0
Ar 9,1
Ar 10,2
Ar 11,3
Ar 12,4
Ar 13,5
Ar 14,6
Ar 15,7
Vm 8,8,22
Vm 9,9,22
Vm 10,10,22
Vm 11,11,22
Vm 12,12,22
Vm 13,13,22
Vm 14,14,22
Vm 15,15,22
Aw 0,8
Aw 1,9
Aw 2,10
Aw 3,11
Aw 4,12
Aw 5,13
Aw 6,14
Aw 7,15
Ar 8,8
Ar 9,9
Ar 10,10
Ar 11,11
Ar 12,12
Ar 13,13
Ar 14,14
Ar 15,15
Vm 8,8,22
Vm 9,9,22
Vm 10,10,22
Vm 11,11,22
Vm 12,12,22
Vm 13,13,22
Vm 14,14,22
Vm 15,15,22
Aw 8,8
Aw 9,9
Aw 10,10
Aw 11,11
Aw 12,12
Aw 13,13
Aw 14,14
Aw 15,15
Ar 8,16
Ar 9,17
Ar 10,18
Ar 11,19
Ar 12,20
Ar 13,21
Ar 14,22
Ar 15,23
Vm 8,8,22
Vm 9,9,22
Vm 10,10,22
Vm 11,11,22
Vm 12,12,22
Vm 13,13,22
Vm 14,14,22
Vm 15,15,22
Aw 16,8
Aw 17,9
Aw 18,10
Aw 19,11
Aw 20,12
Aw 21,13
Aw 22,14
Aw 23,15
Ar 8,24
Ar 9,25
Ar 10,26
Ar 11,27
Ar 12,28
Ar 13,29
Ar 14,30
Ar 15,31
Vm 8,8,22
Vm 9,9,22
Vm 10,10,22
Vm 11,11,22
Vm 12,12,22
Vm 13,13,22
Vm 14,14,22
Vm 15,15,22
Aw 24,8
Aw 25,9
Aw 26,10
Aw 27,11
Aw 28,12
Aw 29,13
Aw 30,14
Aw 31,15
v_max3_f32 v21, v144, v145, v146
v_max3_f32 v21, v21, v147, v148
v_max3_f32 v21, v21, v149, v150
v_max3_f32 v21, v21, v151, v152
v_max3_f32 v21, v21, v153, v154
v_max3_f32 v21, v21, v155, v156
v_max3_f32 v21, v21, v157, v158
v_max_f32 v21, v21, v159
v_mov_b32 v1, v21
s_nop 1
v_permlane16_swap_b32 v1, v21
v_max_f32 v21, v21, v1
v_mov_b32 v1, v21
s_nop 1
v_permlane32_swap_b32 v1, v21
v_max_f32_e64 v21, v21, v1
v_add_f32 v21, 0x41f80000, v21
v_max_f32 v21, 0, v21
Vs 144,144,21
Vs 145,145,21
Vs 146,146,21
Vs 147,147,21
Vs 148,148,21
Vs 149,149,21
Vs 150,150,21
Vs 151,151,21
Vs 152,152,21
Vs 153,153,21
Vs 154,154,21
Vs 155,155,21
Vs 156,156,21
Vs 157,157,21
Vs 158,158,21
Vs 159,159,21
Vs 36,36,21
Vs 37,37,21
Vs 38,38,21
v_sub_f32_e64 v39, v39, v21
v_exp_f32 v22, -v21
s_nop 0
Vm 52,52,22
Vm 53,53,22
Vm 54,54,22
v_mul_f32_e64 v55, v55, v22
Ar 8,32
Ar 9,33
Ar 10,34
Ar 11,35
Ar 12,36
Ar 13,37
Ar 14,38
Ar 15,39
Vm 8,8,22
Vm 9,9,22
Vm 10,10,22
Vm 11,11,22
Vm 12,12,22
Vm 13,13,22
Vm 14,14,22
Vm 15,15,22
Aw 32,8
Aw 33,9
Aw 34,10
Aw 35,11
Aw 36,12
Aw 37,13
Aw 38,14
Aw 39,15
Ar 8,40
Ar 9,41
Ar 10,42
Ar 11,43
Ar 12,44
Ar 13,45
Ar 14,46
Ar 15,47
Vm 8,8,22
Vm 9,9,22
Vm 10,10,22
Vm 11,11,22
Vm 12,12,22
Vm 13,13,22
Vm 14,14,22
Vm 15,15,22
Aw 40,8
Aw 41,9
Aw 42,10
Aw 43,11
Aw 44,12
Aw 45,13
Aw 46,14
Aw 47,15
Ar 8,48
Ar 9,49
Ar 10,50
Ar 11,51
Ar 12,52
Ar 13,53
Ar 14,54
Ar 15,55
Vm 8,8,22
Vm 9,9,22
Vm 10,10,22
Vm 11,11,22
Vm 12,12,22
Vm 13,13,22
Vm 14,14,22
Vm 15,15,22
Aw 48,8
Aw 49,9
Aw 50,10
Aw 51,11
Aw 52,12
Aw 53,13
Aw 54,14
Aw 55,15
Ar 8,56
Ar 9,57
Ar 10,58
Ar 11,59
Ar 12,60
Ar 13,61
Ar 14,62
Ar 15,63
Vm 8,8,22
Vm 9,9,22
Vm 10,10,22
Vm 11,11,22
Vm 12,12,22
Vm 13,13,22
Vm 14,14,22
Vm 15,15,22
Aw 56,8
Aw 57,9
Aw 58,10
Aw 59,11
Aw 60,12
Aw 61,13
Aw 62,14
Aw 63,15
Ve 8,128
Ve 9,129
s_nop 0
Vc 64,8,9
Ve 8,130
Ve 9,131
s_nop 0
Vc 65,8,9
Ve 8,144
Ve 9,145
s_nop 0
Vc 72,8,9
Ve 8,146
Ve 9,147
s_nop 0
Vc 73,8,9
Ve 8,132
Ve 9,133
s_nop 0
Vc 66,8,9
Ve 8,134
Ve 9,135
s_nop 0
Vc 67,8,9
Ve 8,148
Ve 9,149
s_nop 0
Vc 74,8,9
Ve 8,150
Ve 9,151
s_nop 0
Vc 75,8,9
Ve 8,136
Ve 9,137
s_nop 0
Vc 68,8,9
Ve 8,138
Ve 9,139
s_nop 0
Vc 69,8,9
Ve 8,152
Ve 9,153
s_nop 0
Vc 76,8,9
Ve 8,154
Ve 9,155
s_nop 0
Vc 77,8,9
Ve 8,140
Ve 9,141
s_nop 0
Vc 70,8,9
Ve 8,142
Ve 9,143
s_nop 0
Vc 71,8,9
Ve 8,156
Ve 9,157
s_nop 0
Vc 78,8,9
Ve 8,158
Ve 9,159
s_nop 0
Vc 79,8,9
s_nop 1
s_branch L_k2_fbr_nl
L_k2_mk_nl:
v_cmp_gt_i32 s[56:57], 0, v6
v_cmp_gt_i32 s[58:59], 1, v6
v_cmp_gt_i32 s[60:61], 2, v6
v_cmp_gt_i32 s[62:63], 3, v6
s_nop 3
s_nop 0
v_cndmask_b32 v192, v192, v20, s[56:57]
v_cndmask_b32 v193, v193, v20, s[58:59]
v_cndmask_b32 v194, v194, v20, s[60:61]
v_cndmask_b32 v195, v195, v20, s[62:63]
v_cmp_gt_i32 s[56:57], 16, v6
v_cmp_gt_i32 s[58:59], 17, v6
v_cmp_gt_i32 s[60:61], 18, v6
v_cmp_gt_i32 s[62:63], 19, v6
v_cndmask_b32 v196, v196, v20, s[56:57]
v_cndmask_b32 v197, v197, v20, s[58:59]
v_cndmask_b32 v198, v198, v20, s[60:61]
v_cndmask_b32 v199, v199, v20, s[62:63]
v_cmp_gt_i32 s[56:57], 32, v6
v_cmp_gt_i32 s[58:59], 33, v6
v_cmp_gt_i32 s[60:61], 34, v6
v_cmp_gt_i32 s[62:63], 35, v6
v_cndmask_b32 v200, v200, v20, s[56:57]
v_cndmask_b32 v201, v201, v20, s[58:59]
v_cndmask_b32 v202, v202, v20, s[60:61]
v_cndmask_b32 v203, v203, v20, s[62:63]
v_cmp_gt_i32 s[56:57], 48, v6
v_cmp_gt_i32 s[58:59], 49, v6
v_cmp_gt_i32 s[60:61], 50, v6
v_cmp_gt_i32 s[62:63], 51, v6
v_cndmask_b32 v204, v204, v20, s[56:57]
v_cndmask_b32 v205, v205, v20, s[58:59]
v_cndmask_b32 v206, v206, v20, s[60:61]
v_cndmask_b32 v207, v207, v20, s[62:63]
s_branch L_k2_mkr_nl
L_k2_fb_fi:
s_nop 7
v_max3_f32 v21, v192, v193, v194
v_max3_f32 v21, v21, v195, v196
v_max3_f32 v21, v21, v197, v198
v_max3_f32 v21, v21, v199, v200
v_max3_f32 v21, v21, v201, v202
v_max3_f32 v21, v21, v203, v204
v_max3_f32 v21, v21, v205, v206
v_max_f32 v21, v21, v207
v_mov_b32 v1, v21
s_nop 1
v_permlane16_swap_b32 v1, v21
v_max_f32 v21, v21, v1
v_mov_b32 v1, v21
s_nop 1
v_permlane32_swap_b32 v1, v21
v_max_f32_e64 v21, v21, v1
v_add_f32 v21, 0x41f80000, v21
v_max_f32 v21, 0, v21
Vs 192,192,21
Vs 193,193,21
Vs 194,194,21
Vs 195,195,21
Vs 196,196,21
Vs 197,197,21
Vs 198,198,21
Vs 199,199,21
Vs 200,200,21
Vs 201,201,21
Vs 202,202,21
Vs 203,203,21
Vs 204,204,21
Vs 205,205,21
Vs 206,206,21
Vs 207,207,21
Vs 32,32,21
Vs 33,33,21
Vs 34,34,21
v_sub_f32_e64 v35, v35, v21
v_exp_f32 v22, -v21
s_nop 0
Vm 48,48,22
Vm 49,49,22
Vm 50,50,22
v_mul_f32_e64 v51, v51, v22
Ar 8,0
Ar 9,1
Ar 10,2
Ar 11,3
Ar 12,4
Ar 13,5
Ar 14,6
Ar 15,7
Vm 8,8,22
Vm 9,9,22
Vm 10,10,22
Vm 11,11,22
Vm 12,12,22
Vm 13,13,22
Vm 14,14,22
Vm 15,15,22
Aw 0,8
Aw 1,9
Aw 2,10
Aw 3,11
Aw 4,12
Aw 5,13
Aw 6,14
Aw 7,15
Ar 8,8
Ar 9,9
Ar 10,10
Ar 11,11
Ar 12,12
Ar 13,13
Ar 14,14
Ar 15,15
Vm 8,8,22
Vm 9,9,22
Vm 10,10,22
Vm 11,11,22
Vm 12,12,22
Vm 13,13,22
Vm 14,14,22
Vm 15,15,22
Aw 8,8
Aw 9,9
Aw 10,10
Aw 11,11
Aw 12,12
Aw 13,13
Aw 14,14
Aw 15,15
Ar 8,16
Ar 9,17
Ar 10,18
Ar 11,19
Ar 12,20
Ar 13,21
Ar 14,22
Ar 15,23
Vm 8,8,22
Vm 9,9,22
Vm 10,10,22
Vm 11,11,22
Vm 12,12,22
Vm 13,13,22
Vm 14,14,22
Vm 15,15,22
Aw 16,8
Aw 17,9
Aw 18,10
Aw 19,11
Aw 20,12
Aw 21,13
Aw 22,14
Aw 23,15
Ar 8,24
Ar 9,25
Ar 10,26
Ar 11,27
Ar 12,28
Ar 13,29
Ar 14,30
Ar 15,31
Vm 8,8,22
Vm 9,9,22
Vm 10,10,22
Vm 11,11,22
Vm 12,12,22
Vm 13,13,22
Vm 14,14,22
Vm 15,15,22
Aw 24,8
Aw 25,9
Aw 26,10
Aw 27,11
Aw 28,12
Aw 29,13
Aw 30,14
Aw 31,15
Ve 8,192
Ve 9,193
s_nop 0
Vc 96,8,9
Ve 8,194
Ve 9,195
s_nop 0
Vc 97,8,9
Ve 8,196
Ve 9,197
s_nop 0
Vc 98,8,9
Ve 8,198
Ve 9,199
s_nop 0
Vc 99,8,9
Ve 8,200
Ve 9,201
s_nop 0
Vc 100,8,9
Ve 8,202
Ve 9,203
s_nop 0
Vc 101,8,9
Ve 8,204
Ve 9,205
s_nop 0
Vc 102,8,9
Ve 8,206
Ve 9,207
s_nop 0
Vc 103,8,9
s_nop 1
s_branch L_k2_fbr_fi
L_spinX:
s_mov_b32 s47, 0x400000
L_spinXl:
buffer_load_dword v17, v126, s[20:23], s24 offen sc1
s_sub_u32 s47, s47, 1
s_waitcnt vmcnt(0)
s_cmp_eq_u32 s47, 0
s_cbranch_scc1 L_spinXlx
v_cmp_ne_u32 vcc, 1, v17
s_cbranch_vccz L_spinXlx
s_sleep 1
s_branch L_spinXl
L_spinXlx:
buffer_load_dwordx4 v[160:163], v112, s[16:19], s25 offen offset:0 sc1
buffer_load_dwordx4 v[164:167], v112, s[16:19], s25 offen offset:1024 sc1
buffer_load_dwordx4 v[168:171], v112, s[16:19], s25 offen offset:2048 sc1
buffer_load_dwordx4 v[172:175], v112, s[16:19], s25 offen offset:3072 sc1
buffer_load_dwordx4 v[176:179], v10, s[16:19], s25 offen offset:0 sc1
buffer_load_dwordx4 v[180:183], v10, s[16:19], s25 offen offset:1024 sc1
buffer_load_dwordx4 v[184:187], v10, s[16:19], s25 offen offset:2048 sc1
buffer_load_dwordx4 v[188:191], v10, s[16:19], s25 offen offset:3072 sc1
s_branch L_spinXr
L_ysl:
s_mov_b32 s47, 0x400000
L_ysll:
buffer_load_dword v124, v127, s[20:23], s41 offen sc1
s_sub_u32 s47, s47, 1
s_waitcnt vmcnt(0)
s_cmp_eq_u32 s47, 0
s_cbranch_scc1 L_ysllx
v_cmp_ne_u32 vcc, 1, v124
s_cbranch_vccz L_ysllx
s_sleep 8
s_branch L_ysll
L_ysllx:
v_lshlrev_b32 v124, 2, v0
v_lshlrev_b32 v125, 1, v0
s_lshl_b32 s7, s45, 2
s_add_u32 s7, s7, s32
s_lshr_b32 s3, s42, 5
s_cmp_lg_u32 s3, s7
s_cbranch_scc1 L_f_yl13
s_add_u32 s3, s55, 0
s_nop 0
s_add_u32 s7, s3, 4096
buffer_load_dword v76, v124, s[20:23], s3 offen offset:0 sc1
buffer_load_dword v77, v124, s[20:23], s3 offen offset:512 sc1
buffer_load_dword v78, v124, s[20:23], s3 offen offset:1024 sc1
buffer_load_dword v79, v124, s[20:23], s3 offen offset:1536 sc1
buffer_load_dword v80, v124, s[20:23], s3 offen offset:2048 sc1
buffer_load_dword v81, v124, s[20:23], s3 offen offset:2560 sc1
buffer_load_dword v82, v124, s[20:23], s3 offen offset:3072 sc1
buffer_load_dword v83, v124, s[20:23], s3 offen offset:3584 sc1
buffer_load_dword v84, v124, s[20:23], s7 offen offset:0 sc1
buffer_load_dword v85, v124, s[20:23], s7 offen offset:512 sc1
buffer_load_dword v86, v124, s[20:23], s7 offen offset:1024 sc1
buffer_load_dword v87, v124, s[20:23], s7 offen offset:1536 sc1
buffer_load_dword v88, v124, s[20:23], s7 offen offset:2048 sc1
buffer_load_dword v89, v124, s[20:23], s7 offen offset:2560 sc1
s_lshl_b32 s3, s42, 11
s_lshl_b32 s7, s46, 7
s_add_u32 s3, s3, s7
buffer_load_ushort v90, v125, s[56:59], s3 offen
s_lshl_b32 s3, s42, 3
s_add_u32 s3, s3, 5259264
buffer_load_dwordx2 v[92:93], v126, s[20:23], s3 offen sc1
L_f_yl13:
s_lshl_b32 s7, s45, 2
s_add_u32 s7, s7, s32
s_lshr_b32 s3, s43, 5
s_cmp_lg_u32 s3, s7
s_cbranch_scc1 L_f_yl14
s_nop 0
s_add_u32 s3, s55, 256
s_add_u32 s7, s3, 4096
buffer_load_dword v94, v124, s[20:23], s3 offen offset:0 sc1
buffer_load_dword v95, v124, s[20:23], s3 offen offset:512 sc1
buffer_load_dword v96, v124, s[20:23], s3 offen offset:1024 sc1
buffer_load_dword v97, v124, s[20:23], s3 offen offset:1536 sc1
buffer_load_dword v98, v124, s[20:23], s3 offen offset:2048 sc1
buffer_load_dword v99, v124, s[20:23], s3 offen offset:2560 sc1
buffer_load_dword v100, v124, s[20:23], s3 offen offset:3072 sc1
buffer_load_dword v101, v124, s[20:23], s3 offen offset:3584 sc1
buffer_load_dword v102, v124, s[20:23], s7 offen offset:0 sc1
buffer_load_dword v103, v124, s[20:23], s7 offen offset:512 sc1
buffer_load_dword v104, v124, s[20:23], s7 offen offset:1024 sc1
buffer_load_dword v105, v124, s[20:23], s7 offen offset:1536 sc1
buffer_load_dword v106, v124, s[20:23], s7 offen offset:2048 sc1
buffer_load_dword v107, v124, s[20:23], s7 offen offset:2560 sc1
s_lshl_b32 s3, s43, 11
s_lshl_b32 s7, s46, 7
s_add_u32 s3, s3, s7
buffer_load_ushort v108, v125, s[56:59], s3 offen
s_lshl_b32 s3, s43, 3
s_add_u32 s3, s3, 5259264
buffer_load_dwordx2 v[110:111], v126, s[20:23], s3 offen sc1
L_f_yl14:
s_waitcnt vmcnt(0)
s_lshl_b32 s7, s45, 2
s_add_u32 s7, s7, s32
s_lshr_b32 s3, s42, 5
s_cmp_lg_u32 s3, s7
s_cbranch_scc1 L_f_ys15
v_pk_add_f32 v[76:77], v[76:77], v[78:79]
v_pk_add_f32 v[76:77], v[76:77], v[80:81]
v_pk_add_f32 v[76:77], v[76:77], v[82:83]
v_pk_add_f32 v[76:77], v[76:77], v[84:85]
v_pk_add_f32 v[76:77], v[76:77], v[86:87]
v_pk_add_f32 v[76:77], v[76:77], v[88:89]
Va 76,76,77
v_lshlrev_b32 v90, 16, v90
v_sub_f32_e64 v90, v90, v92
Vc 76,76,76
v_lshlrev_b32_e64 v76, 16, v76
Vc 90,90,90
v_lshlrev_b32 v90, 16, v90
v_mul_f32 v76, s100, v76
v_mul_f32_e64 v90, v90, v93
Vc 76,76,76
v_lshlrev_b32_e64 v76, 16, v76
Vc 90,90,90
v_lshlrev_b32 v90, 16, v90
Va 90,90,76
Vc 90,90,90
v_lshlrev_b32_e64 v90, 16, v90
v_mul_f32 v76, 0xbfb8aa3b, v90
Ve 76,76
s_nop 0
v_add_f32 v76, 1.0, v76
v_rcp_f32 v76, v76
s_nop 0
Vm 90,90,76
Vc 90,90,90
v_lshlrev_b32 v90, 16, v90
v_lshlrev_b32 v124, 2, v0
v_add_u32 v124, s35, v124
v_lshlrev_b32 v125, 5, v122
v_add_u32 v125, s35, v125
s_waitcnt lgkmcnt(0)
ds_write_b32 v124, v90
s_and_b32 s3, s42, 7
s_lshl_b32 s3, s3, 3
s_lshl_b64 s[4:5], 0xff, s3
s_bfe_u32 s3, s42, 0x20003
s_mov_b64 exec, s[4:5]
s_cmp_lg_u32 s3, 0
s_cbranch_scc1 L_f_yp16
ds_read_b64 v[42:43], v125
ds_read_b64 v[44:45], v125 offset:8
ds_read_b64 v[46:47], v125 offset:16
ds_read_b64 v[48:49], v125 offset:24
L_f_yp16:
s_cmp_lg_u32 s3, 1
s_cbranch_scc1 L_f_yp17
ds_read_b64 v[50:51], v125
ds_read_b64 v[52:53], v125 offset:8
ds_read_b64 v[54:55], v125 offset:16
ds_read_b64 v[56:57], v125 offset:24
L_f_yp17:
s_cmp_lg_u32 s3, 2
s_cbranch_scc1 L_f_yp18
ds_read_b64 v[58:59], v125
ds_read_b64 v[60:61], v125 offset:8
ds_read_b64 v[62:63], v125 offset:16
ds_read_b64 v[64:65], v125 offset:24
L_f_yp18:
s_cmp_lg_u32 s3, 3
s_cbranch_scc1 L_f_yp19
ds_read_b64 v[66:67], v125
ds_read_b64 v[68:69], v125 offset:8
s_waitcnt lgkmcnt(9)
ds_read_b64 v[70:71], v125 offset:16
ds_read_b64 v[72:73], v125 offset:24
L_f_yp19:
s_mov_b64 exec, -1
s_waitcnt lgkmcnt(0)
L_f_ys15:
s_lshl_b32 s7, s45, 2
s_add_u32 s7, s7, s32
s_lshr_b32 s3, s43, 5
s_cmp_lg_u32 s3, s7
s_cbranch_scc1 L_f_ys20
s_nop 0
v_pk_add_f32 v[94:95], v[94:95], v[96:97]
v_pk_add_f32 v[94:95], v[94:95], v[98:99]
v_pk_add_f32 v[94:95], v[94:95], v[100:101]
v_pk_add_f32 v[94:95], v[94:95], v[102:103]
v_pk_add_f32 v[94:95], v[94:95], v[104:105]
v_pk_add_f32 v[94:95], v[94:95], v[106:107]
Va 94,94,95
v_lshlrev_b32 v108, 16, v108
v_sub_f32_e64 v108, v108, v110
Vc 94,94,94
v_lshlrev_b32_e64 v94, 16, v94
Vc 108,108,108
v_lshlrev_b32 v108, 16, v108
v_mul_f32 v94, s101, v94
v_mul_f32_e64 v108, v108, v111
Vc 94,94,94
v_lshlrev_b32_e64 v94, 16, v94
Vc 108,108,108
v_lshlrev_b32 v108, 16, v108
Va 108,108,94
Vc 108,108,108
v_lshlrev_b32_e64 v108, 16, v108
v_mul_f32 v94, 0xbfb8aa3b, v108
Ve 94,94
s_nop 0
v_add_f32 v94, 1.0, v94
v_rcp_f32 v94, v94
s_nop 0
Vm 108,108,94
Vc 108,108,108
v_lshlrev_b32 v108, 16, v108
v_lshlrev_b32 v124, 2, v0
v_add_u32 v124, s35, v124
v_lshlrev_b32 v125, 5, v122
v_add_u32 v125, s35, v125
s_waitcnt lgkmcnt(0)
ds_write_b32 v124, v108
s_and_b32 s3, s43, 7
s_lshl_b32 s3, s3, 3
s_lshl_b64 s[4:5], 0xff, s3
s_bfe_u32 s3, s43, 0x20003
s_mov_b64 exec, s[4:5]
s_cmp_lg_u32 s3, 0
s_cbranch_scc1 L_f_yp21
ds_read_b64 v[42:43], v125
ds_read_b64 v[44:45], v125 offset:8
ds_read_b64 v[46:47], v125 offset:16
ds_read_b64 v[48:49], v125 offset:24
L_f_yp21:
s_cmp_lg_u32 s3, 1
s_cbranch_scc1 L_f_yp22
ds_read_b64 v[50:51], v125
ds_read_b64 v[52:53], v125 offset:8
ds_read_b64 v[54:55], v125 offset:16
ds_read_b64 v[56:57], v125 offset:24
L_f_yp22:
s_cmp_lg_u32 s3, 2
s_cbranch_scc1 L_f_yp23
ds_read_b64 v[58:59], v125
ds_read_b64 v[60:61], v125 offset:8
ds_read_b64 v[62:63], v125 offset:16
ds_read_b64 v[64:65], v125 offset:24
L_f_yp23:
s_cmp_lg_u32 s3, 3
s_cbranch_scc1 L_f_yp24
ds_read_b64 v[66:67], v125
ds_read_b64 v[68:69], v125 offset:8
s_waitcnt lgkmcnt(9)
ds_read_b64 v[70:71], v125 offset:16
ds_read_b64 v[72:73], v125 offset:24
L_f_yp24:
s_mov_b64 exec, -1
s_waitcnt lgkmcnt(0)
L_f_ys20:
s_branch L_yslr
.section .rodata,"a"
.p2align 6
.amdhsa_kernel recurrent_scan__compressed_kv_cla__moe_arch_mod__prompt_kernel
  .amdhsa_next_free_vgpr 512
  .amdhsa_next_free_sgpr 102
  .amdhsa_accum_offset 256
  .amdhsa_group_segment_fixed_size 0
  .amdhsa_kernarg_size 112
  .amdhsa_user_sgpr_count 2
  .amdhsa_user_sgpr_kernarg_segment_ptr 1
  .amdhsa_system_sgpr_workgroup_id_x 1
.end_amdhsa_kernel
```

```asm
; @launch grid=(256,1,1) block=(256,1,1) lds=163840
.amdgcn_target "amdgcn-amd-amdhsa--gfx950"
.macro Va d,x,y
v_add_f32 v\d, v\x, v\y
.endm
.macro Vc d,x,y
v_cvt_pk_bf16_f32 v\d, v\x, v\y
.endm
.macro Ta d,x,o
ds_read_b64_tr_b16 a[\d:\d+1], v\x offset:\o
.endm
.macro Ra d,x,o
ds_read_b128 a[\d:\d+3], v\x offset:\o
.endm
.macro Zvaa d,x,y
v_mfma_f32_16x16x32_bf16 v[\d:\d+3], a[\x:\x+3], a[\y:\y+3], 0
.endm
.macro Rv d,x,o
ds_read_b128 v[\d:\d+3], v\x offset:\o
.endm
.macro Zaaa d,x,y
v_mfma_f32_16x16x32_bf16 a[\d:\d+3], a[\x:\x+3], a[\y:\y+3], 0
.endm
.macro Mvaa d,x,y
v_mfma_f32_16x16x32_bf16 v[\d:\d+3], a[\x:\x+3], a[\y:\y+3], v[\d:\d+3]
.endm
.macro Maaa d,x,y
v_mfma_f32_16x16x32_bf16 a[\d:\d+3], a[\x:\x+3], a[\y:\y+3], a[\d:\d+3]
.endm
.macro Ar d,x
v_accvgpr_read_b32 v\d, a\x
.endm
.macro VE d,x
v_exp_f32_e64 v\d, v\x
.endm
.macro Aw d,x
v_accvgpr_write_b32 a\d, v\x
.endm
.macro Vs d,x,y
v_sub_f32 v\d, v\x, v\y
.endm
.macro Ve d,x
v_exp_f32 v\d, v\x
.endm
.macro Cvaa d,x,y,c
v_mfma_f32_16x16x32_bf16 v[\d:\d+3], a[\x:\x+3], a[\y:\y+3], v[\c:\c+3]
.endm
.macro Maav d,x,y
v_mfma_f32_16x16x32_bf16 a[\d:\d+3], a[\x:\x+3], v[\y:\y+3], a[\d:\d+3]
.endm
.macro Mvvv d,x,y
v_mfma_f32_16x16x32_bf16 v[\d:\d+3], v[\x:\x+3], v[\y:\y+3], v[\d:\d+3]
.endm
.macro Zvva d,x,y
v_mfma_f32_16x16x32_bf16 v[\d:\d+3], v[\x:\x+3], a[\y:\y+3], 0
.endm
.macro Mvva d,x,y
v_mfma_f32_16x16x32_bf16 v[\d:\d+3], v[\x:\x+3], a[\y:\y+3], v[\d:\d+3]
.endm
.macro Vm d,x,y
v_mul_f32 v\d, v\x, v\y
.endm
.macro Zvvv d,x,y
v_mfma_f32_16x16x32_bf16 v[\d:\d+3], v[\x:\x+3], v[\y:\y+3], 0
.endm
.text
.globl recurrent_scan__compressed_kv_cla__moe_arch_mod__prompt_kernel
.p2align 8
.type recurrent_scan__compressed_kv_cla__moe_arch_mod__prompt_kernel,@function
recurrent_scan__compressed_kv_cla__moe_arch_mod__prompt_kernel:
s_cmp_ge_u32 s2, 256
s_cbranch_scc1 L_k2_end
s_load_dwordx4 s[4:7], s[0:1], 0
s_load_dwordx2 s[44:45], s[0:1], 56
s_load_dwordx4 s[40:43], s[0:1], 24
s_load_dwordx4 s[64:67], s[0:1], 96
v_lshrrev_b32 v1, 6, v0
v_and_b32 v0, 63, v0
v_readfirstlane_b32 s32, v1
s_getpc_b64 s[68:69]
L_cpf1:
s_add_u32 s68, s68, (recurrent_scan__compressed_kv_cla__moe_arch_mod__prompt_kernel-L_cpf1)&0xffffffff
s_addc_u32 s69, s69, ((recurrent_scan__compressed_kv_cla__moe_arch_mod__prompt_kernel-L_cpf1)>>32)&0xffffffff
s_lshr_b32 s70, s2, 3
s_lshl_b32 s70, s70, 2
s_add_u32 s70, s70, s32
s_lshl_b32 s70, s70, 10
v_and_b32 v122, 7, v0
v_lshlrev_b32 v122, 7, v122
v_add_u32 v122, s70, v122
v_min_u32 v122, L_k2_fin-recurrent_scan__compressed_kv_cla__moe_arch_mod__prompt_kernel-4, v122
v_mov_b32 v121, s69
v_add_co_u32 v120, vcc, s68, v122
s_nop 1
v_addc_co_u32 v121, vcc, 0, v121, vcc
global_load_dword v124, v[120:121], off
v_lshrrev_b32 v33, 5, v0
v_and_b32 v31, 31, v0
v_lshlrev_b32_e64 v36, 4, v31
v_lshl_add_u32 v35, v33, 11, v36
s_lshl_b32 s36, s2, 14
s_lshl_b32 s37, s32, 12
s_add_u32 s36, s36, s37
s_mov_b32 s18, 4194304
s_mov_b32 s19, 0x20000
s_bfe_u32 s33, s2, 0x30003
s_lshr_b32 s35, s2, 7
s_bfe_u32 s3, s2, 0x10006
s_and_b32 s34, s2, 7
s_lshl_b32 s34, s34, 1
s_add_u32 s34, s34, s3
s_waitcnt lgkmcnt(0)
s_mov_b32 s16, s4
s_and_b32 s17, s5, 0xffff
buffer_load_dwordx4 v[48:51], v35, s[16:19], s36 offen offset:0 nt
buffer_load_dwordx4 v[52:55], v35, s[16:19], s36 offen offset:512 nt
buffer_load_dwordx4 v[56:59], v35, s[16:19], s36 offen offset:1024 nt
buffer_load_dwordx4 v[60:63], v35, s[16:19], s36 offen offset:1536 nt
s_cmp_eq_u32 s35, 0
s_cselect_b32 s40, s40, s42
s_cselect_b32 s41, s41, s43
s_lshl_b32 s3, s34, 9
s_add_u32 s12, s40, s3
s_addc_u32 s13, s41, 0
s_and_b32 s13, s13, 0xffff
s_mov_b32 s14, 0
s_mov_b32 s15, 0x20000
s_sub_u32 s14, 4194304, s3
s_lshl_b32 s3, s33, 18
s_add_u32 s8, s6, s3
s_addc_u32 s9, s7, 0
s_and_b32 s9, s9, 0xffff
s_mov_b32 s10, 262144
s_mov_b32 s11, 0x20000
s_and_b32 s58, s2, 7
s_mov_b32 s52, 0
s_mov_b32 s53, 15360
s_mov_b32 s54, 30720
s_mov_b32 s55, 46080
s_lshl_b32 s56, s32, 13
s_add_u32 s57, s56, 32768
s_lshl_b32 s3, s58, 2
s_add_u32 s3, s3, s32
s_lshl_b32 s3, s3, 4
v_add_u32 v30, s3, v33
v_lshlrev_b32 v30, 13, v30
v_lshlrev_b32 v34, 5, v33
v_xor_b32 v34, v34, v36
v_add_u32 v6, v34, v30
v_xor_b32_e64 v7, 64, v6
v_xor_b32 v8, 65664, v6
v_xor_b32 v9, 65728, v6
s_add_u32 m0, s57, 0
s_nop 0
buffer_load_dwordx4 v6, s[12:15], s52 offen offset:0 nt lds
buffer_load_dwordx4 v7, s[12:15], s53 offen offset:1024 nt lds
buffer_load_dwordx4 v6, s[12:15], s54 offen offset:2048 nt lds
buffer_load_dwordx4 v7, s[12:15], s55 offen offset:3072 nt lds
s_add_u32 m0, s57, 4096
s_nop 0
s_nop 0
buffer_load_dwordx4 v8, s[12:15], s52 offen offset:0 nt lds
buffer_load_dwordx4 v9, s[12:15], s53 offen offset:1024 nt lds
buffer_load_dwordx4 v8, s[12:15], s54 offen offset:2048 nt lds
buffer_load_dwordx4 v9, s[12:15], s55 offen offset:3072 nt lds
v_xor_b32 v6, 524288, v6
v_xor_b32 v7, 524288, v7
v_xor_b32 v8, 524288, v8
v_xor_b32 v9, 524288, v9
s_mov_b32 s48, 0
s_mov_b32 s49, 7168
s_mov_b32 s50, 14336
s_mov_b32 s51, 21504
v_lshrrev_b32 v30, 3, v0
v_lshlrev_b32 v30, 10, v30
s_lshl_b32 s3, s32, 16
s_lshl_b32 s39, s58, 7
s_add_u32 s3, s3, s39
v_and_b32 v31, 7, v0
v_lshrrev_b32 v32, 4, v0
v_xor_b32_e64 v31, v31, v32
v_lshl_add_u32 v30, v31, 4, v30
v_add_u32 v2, s3, v30
v_xor_b32 v3, 64, v2
v_xor_b32 v4, 32768, v2
v_xor_b32 v5, 32832, v2
s_cmp_lt_u32 s32, 2
s_cselect_b32 s60, s8, s12
s_cselect_b32 s61, s9, s13
s_cselect_b32 s62, s10, s14
s_mov_b32 s63, 0x20000
s_mov_b32 s59, 524288
s_cselect_b32 s59, 128, s59
s_cselect_b64 vcc, -1, 0
s_cselect_b32 s38, 32, 16
s_lshr_b32 s3, s2, 6
s_cmp_lt_u32 s32, 2
s_cselect_b32 s3, s3, s33
s_lshl_b32 s3, s3, 1
s_and_b32 s39, s32, 1
s_add_u32 s3, s3, s39
s_lshl_b32 s3, s3, 15
s_xor_b32 s39, s58, 1
s_mul_i32 s39, s39, s59
s_add_u32 s3, s3, s39
v_lshlrev_b32 v37, 10, v0
v_lshrrev_b32 v38, 2, v0
v_lshlrev_b32 v38, 13, v38
v_and_b32 v39, 3, v0
v_lshl_add_u32 v38, v39, 7, v38
v_cndmask_b32 v47, v38, v37, vcc
v_add_u32 v47, s3, v47
v_cmp_gt_u32 vcc, s38, v0
v_mov_b32 v37, 2146435072
s_nop 0
v_cndmask_b32 v47, v37, v47, vcc
s_mov_b32 s20, s66
s_and_b32 s21, s67, 0xffff
s_mov_b32 s22, 8388608
s_mov_b32 s23, 0x20000
s_add_u32 s24, s66, 8388608
s_addc_u32 s25, s67, 0
s_and_b32 s25, s25, 0xffff
s_mov_b32 s26, 35717120
s_mov_b32 s27, 0x20000
v_lshrrev_b32 v32, 4, v0
v_and_b32 v30, 15, v0
s_lshr_b32 s3, s32, 1
s_lshl_b32 s3, s3, 14
v_lshlrev_b32 v31, 7, v30
v_add_u32 v31, s3, v31
v_lshrrev_b32 v34, 1, v30
v_xor_b32_e64 v34, v34, v32
v_lshl_add_u32 v10, v34, 4, v31
v_xor_b32 v11, 64, v10
v_lshrrev_b32 v30, 2, v30
v_lshl_add_u32 v31, v32, 3, v30
v_lshlrev_b32 v31, 9, v31
v_and_b32 v34, 3, v0
v_lshl_add_u32 v31, v34, 3, v31
s_and_b32 s3, s32, 1
s_lshl_b32 s3, s3, 8
s_add_u32 s3, s3, 32768
v_add_u32 v31, s3, v31
v_and_b32 v34, 1, v32
v_lshl_add_u32 v30, v34, 2, v30
v_lshl_add_u32 v12, v30, 5, v31
v_xor_b32 v13, 32, v12
v_xor_b32 v14, 64, v12
v_xor_b32 v15, 96, v12
v_xor_b32 v16, 128, v12
v_xor_b32 v17, 160, v12
v_xor_b32 v18, 192, v12
v_xor_b32 v19, 224, v12
v_add_u32 v20, 65536, v10
v_add_u32 v21, 65536, v11
v_add_u32 v22, 65536, v12
v_add_u32 v23, 65536, v13
v_add_u32 v24, 65536, v14
v_add_u32 v25, 65536, v15
v_add_u32 v26, 65536, v16
v_add_u32 v27, 65536, v17
v_add_u32 v28, 65536, v18
v_add_u32 v29, 65536, v19
s_mov_b32 s28, s44
s_nop 0
s_and_b32 s29, s45, 0xffff
s_mov_b32 s30, 2048
s_mov_b32 s31, 0x20000
buffer_load_dwordx4 v[64:67], v36, s[28:31], 0 offen offset:0
buffer_load_dwordx4 v[68:71], v36, s[28:31], 0 offen offset:512
buffer_load_dwordx4 v[72:75], v36, s[28:31], 0 offen offset:1024
buffer_load_dwordx4 v[76:79], v36, s[28:31], 0 offen offset:1536
s_waitcnt vmcnt(12)
v_lshlrev_b32 v80, 16, v48
v_and_b32 v81, 0xffff0000, v48
v_lshlrev_b32_e64 v82, 16, v49
v_and_b32 v83, 0xffff0000, v49
v_lshlrev_b32_e64 v84, 16, v50
v_and_b32 v85, 0xffff0000, v50
v_lshlrev_b32_e64 v86, 16, v51
v_and_b32 v87, 0xffff0000, v51
v_lshlrev_b32_e64 v88, 16, v52
v_and_b32 v89, 0xffff0000, v52
v_lshlrev_b32_e64 v90, 16, v53
v_and_b32 v91, 0xffff0000, v53
v_lshlrev_b32_e64 v92, 16, v54
v_and_b32 v93, 0xffff0000, v54
v_lshlrev_b32_e64 v94, 16, v55
v_and_b32 v95, 0xffff0000, v55
v_lshlrev_b32_e64 v96, 16, v56
v_and_b32 v97, 0xffff0000, v56
v_lshlrev_b32_e64 v98, 16, v57
v_and_b32 v99, 0xffff0000, v57
v_lshlrev_b32_e64 v100, 16, v58
v_and_b32 v101, 0xffff0000, v58
v_lshlrev_b32_e64 v102, 16, v59
v_and_b32 v103, 0xffff0000, v59
v_lshlrev_b32_e64 v104, 16, v60
v_and_b32 v105, 0xffff0000, v60
v_lshlrev_b32_e64 v106, 16, v61
v_and_b32 v107, 0xffff0000, v61
v_lshlrev_b32_e64 v108, 16, v62
v_and_b32 v109, 0xffff0000, v62
v_lshlrev_b32_e64 v110, 16, v63
v_and_b32 v111, 0xffff0000, v63
v_pk_add_f32 v[40:41], v[80:81], v[82:83]
v_pk_add_f32 v[42:43], v[84:85], v[86:87]
v_pk_add_f32 v[40:41], v[40:41], v[88:89]
v_pk_add_f32 v[42:43], v[42:43], v[90:91]
v_pk_add_f32 v[40:41], v[40:41], v[92:93]
v_pk_add_f32 v[42:43], v[42:43], v[94:95]
v_pk_add_f32 v[40:41], v[40:41], v[96:97]
v_pk_add_f32 v[42:43], v[42:43], v[98:99]
v_pk_add_f32 v[40:41], v[40:41], v[100:101]
v_pk_add_f32 v[42:43], v[42:43], v[102:103]
v_pk_add_f32 v[40:41], v[40:41], v[104:105]
v_pk_add_f32 v[42:43], v[42:43], v[106:107]
v_pk_add_f32 v[40:41], v[40:41], v[108:109]
v_pk_add_f32 v[42:43], v[42:43], v[110:111]
v_pk_add_f32 v[40:41], v[40:41], v[42:43]
Va 38,40,41
s_nop 1
v_add_f32_dpp v38, v38, v38 quad_perm:[1,0,3,2] row_mask:0xf bank_mask:0xf
s_nop 1
v_add_f32_dpp v38, v38, v38 quad_perm:[2,3,0,1] row_mask:0xf bank_mask:0xf
s_nop 1
v_add_f32_dpp v38, v38, v38 row_half_mirror row_mask:0xf bank_mask:0xf
s_nop 1
v_add_f32_dpp v38, v38, v38 row_mirror row_mask:0xf bank_mask:0xf
v_mov_b32 v37, v38
s_nop 1
v_permlane16_swap_b32 v37, v38
Va 38,38,37
s_add_u32 m0, s56, 0
s_nop 0
buffer_load_dwordx4 v2, s[8:11], s48 offen offset:0 lds
buffer_load_dwordx4 v3, s[8:11], s49 offen offset:1024 lds
buffer_load_dwordx4 v2, s[8:11], s50 offen offset:2048 lds
buffer_load_dwordx4 v3, s[8:11], s51 offen offset:3072 lds
s_add_u32 m0, s56, 4096
s_nop 0
buffer_load_dwordx4 v4, s[8:11], s48 offen offset:0 lds
buffer_load_dwordx4 v5, s[8:11], s49 offen offset:1024 lds
buffer_load_dwordx4 v4, s[8:11], s50 offen offset:2048 lds
buffer_load_dwordx4 v5, s[8:11], s51 offen offset:3072 lds
v_xor_b32 v2, 128, v2
v_xor_b32 v3, 128, v3
v_xor_b32 v4, 128, v4
v_xor_b32 v5, 128, v5
buffer_load_dword v1, v47, s[60:63], 0 offen
s_mul_i32 vcc_lo, s59, 3
v_xor_b32 v47, vcc_lo, v47
v_mul_f32 v38, 0xba800000, v38
v_mov_b32_e64 v39, v38
v_pk_add_f32 v[112:113], v[80:81], v[38:39]
v_pk_mul_f32 v[40:41], v[112:113], v[112:113]
v_pk_add_f32 v[114:115], v[82:83], v[38:39]
v_pk_mul_f32 v[42:43], v[114:115], v[114:115]
v_pk_add_f32 v[116:117], v[84:85], v[38:39]
v_pk_fma_f32 v[40:41], v[116:117], v[116:117], v[40:41]
v_pk_add_f32 v[118:119], v[86:87], v[38:39]
v_pk_fma_f32 v[42:43], v[118:119], v[118:119], v[42:43]
v_pk_add_f32 v[112:113], v[88:89], v[38:39]
v_pk_fma_f32 v[40:41], v[112:113], v[112:113], v[40:41]
v_pk_add_f32 v[114:115], v[90:91], v[38:39]
v_pk_fma_f32 v[42:43], v[114:115], v[114:115], v[42:43]
v_pk_add_f32 v[116:117], v[92:93], v[38:39]
v_pk_fma_f32 v[40:41], v[116:117], v[116:117], v[40:41]
v_pk_add_f32 v[118:119], v[94:95], v[38:39]
v_pk_fma_f32 v[42:43], v[118:119], v[118:119], v[42:43]
v_pk_add_f32 v[112:113], v[96:97], v[38:39]
v_pk_fma_f32 v[40:41], v[112:113], v[112:113], v[40:41]
v_pk_add_f32 v[114:115], v[98:99], v[38:39]
v_pk_fma_f32 v[42:43], v[114:115], v[114:115], v[42:43]
v_pk_add_f32 v[116:117], v[100:101], v[38:39]
v_pk_fma_f32 v[40:41], v[116:117], v[116:117], v[40:41]
v_pk_add_f32 v[118:119], v[102:103], v[38:39]
v_pk_fma_f32 v[42:43], v[118:119], v[118:119], v[42:43]
v_pk_add_f32 v[112:113], v[104:105], v[38:39]
v_pk_fma_f32 v[40:41], v[112:113], v[112:113], v[40:41]
v_pk_add_f32 v[114:115], v[106:107], v[38:39]
v_pk_fma_f32 v[42:43], v[114:115], v[114:115], v[42:43]
v_pk_add_f32 v[116:117], v[108:109], v[38:39]
v_pk_fma_f32 v[40:41], v[116:117], v[116:117], v[40:41]
v_pk_add_f32 v[118:119], v[110:111], v[38:39]
v_pk_fma_f32 v[42:43], v[118:119], v[118:119], v[42:43]
v_pk_add_f32 v[40:41], v[40:41], v[42:43]
Va 40,40,41
s_nop 1
v_add_f32_dpp v40, v40, v40 quad_perm:[1,0,3,2] row_mask:0xf bank_mask:0xf
s_nop 1
v_add_f32_dpp v40, v40, v40 quad_perm:[2,3,0,1] row_mask:0xf bank_mask:0xf
s_nop 1
v_add_f32_dpp v40, v40, v40 row_half_mirror row_mask:0xf bank_mask:0xf
s_nop 1
v_add_f32_dpp v40, v40, v40 row_mirror row_mask:0xf bank_mask:0xf
v_mov_b32 v37, v40
s_nop 1
v_permlane16_swap_b32 v37, v40
v_add_f32_e64 v40, v40, v37
buffer_load_dword v1, v47, s[60:63], 0 offen
s_mul_i32 vcc_lo, s59, 1
v_xor_b32 v47, vcc_lo, v47
v_mul_f32 v40, 0x3a800000, v40
Vc 44,38,40
v_lshlrev_b32_e64 v38, 16, v44
v_and_b32 v40, 0xffff0000, v44
v_add_f32 v40, 0x3727c5ac, v40
Vc 44,40,40
v_lshlrev_b32 v40, 16, v44
v_sqrt_f32 v40, v40
v_mov_b32_e64 v39, v38
Vc 44,40,40
v_lshlrev_b32 v44, 16, v44
v_rcp_f32 v40, v44
v_pk_add_f32 v[80:81], v[80:81], v[38:39]
v_pk_add_f32 v[82:83], v[82:83], v[38:39]
v_pk_add_f32 v[84:85], v[84:85], v[38:39]
v_pk_add_f32 v[86:87], v[86:87], v[38:39]
v_pk_add_f32 v[88:89], v[88:89], v[38:39]
v_pk_add_f32 v[90:91], v[90:91], v[38:39]
v_pk_add_f32 v[92:93], v[92:93], v[38:39]
v_pk_add_f32 v[94:95], v[94:95], v[38:39]
v_pk_add_f32 v[96:97], v[96:97], v[38:39]
v_pk_add_f32 v[98:99], v[98:99], v[38:39]
v_pk_add_f32 v[100:101], v[100:101], v[38:39]
v_pk_add_f32 v[102:103], v[102:103], v[38:39]
v_pk_add_f32 v[104:105], v[104:105], v[38:39]
v_pk_add_f32 v[106:107], v[106:107], v[38:39]
v_pk_add_f32 v[108:109], v[108:109], v[38:39]
v_pk_add_f32 v[110:111], v[110:111], v[38:39]
v_fma_f32 v45, -v44, v40, 1.0
v_fma_f32 v40, v45, v40, v40
v_mov_b32_e64 v41, v40
Vc 48,80,81
Vc 49,82,83
Vc 50,84,85
Vc 51,86,87
Vc 52,88,89
Vc 53,90,91
Vc 54,92,93
Vc 55,94,95
Vc 56,96,97
Vc 57,98,99
Vc 58,100,101
Vc 59,102,103
Vc 60,104,105
Vc 61,106,107
Vc 62,108,109
Vc 63,110,111
v_lshlrev_b32_e64 v80, 16, v48
v_and_b32 v81, 0xffff0000, v48
v_lshlrev_b32_e64 v82, 16, v49
v_and_b32 v83, 0xffff0000, v49
v_lshlrev_b32_e64 v84, 16, v50
v_and_b32 v85, 0xffff0000, v50
v_lshlrev_b32_e64 v86, 16, v51
v_and_b32 v87, 0xffff0000, v51
v_lshlrev_b32_e64 v88, 16, v52
v_and_b32 v89, 0xffff0000, v52
v_lshlrev_b32_e64 v90, 16, v53
v_and_b32 v91, 0xffff0000, v53
v_lshlrev_b32_e64 v92, 16, v54
v_and_b32 v93, 0xffff0000, v54
v_lshlrev_b32_e64 v94, 16, v55
v_and_b32 v95, 0xffff0000, v55
v_lshlrev_b32_e64 v96, 16, v56
v_and_b32 v97, 0xffff0000, v56
v_lshlrev_b32_e64 v98, 16, v57
v_and_b32 v99, 0xffff0000, v57
v_lshlrev_b32_e64 v100, 16, v58
v_and_b32 v101, 0xffff0000, v58
v_lshlrev_b32_e64 v102, 16, v59
v_and_b32 v103, 0xffff0000, v59
v_lshlrev_b32_e64 v104, 16, v60
v_and_b32 v105, 0xffff0000, v60
v_lshlrev_b32_e64 v106, 16, v61
v_and_b32 v107, 0xffff0000, v61
v_lshlrev_b32_e64 v108, 16, v62
v_and_b32 v109, 0xffff0000, v62
v_lshlrev_b32_e64 v110, 16, v63
v_and_b32 v111, 0xffff0000, v63
v_pk_mul_f32 v[80:81], v[80:81], v[40:41]
v_pk_mul_f32 v[82:83], v[82:83], v[40:41]
v_pk_mul_f32 v[84:85], v[84:85], v[40:41]
v_pk_mul_f32 v[86:87], v[86:87], v[40:41]
v_pk_mul_f32 v[88:89], v[88:89], v[40:41]
v_pk_mul_f32 v[90:91], v[90:91], v[40:41]
v_pk_mul_f32 v[92:93], v[92:93], v[40:41]
v_pk_mul_f32 v[94:95], v[94:95], v[40:41]
v_pk_mul_f32 v[96:97], v[96:97], v[40:41]
v_pk_mul_f32 v[98:99], v[98:99], v[40:41]
v_pk_mul_f32 v[100:101], v[100:101], v[40:41]
v_pk_mul_f32 v[102:103], v[102:103], v[40:41]
v_pk_mul_f32 v[104:105], v[104:105], v[40:41]
v_pk_mul_f32 v[106:107], v[106:107], v[40:41]
v_pk_mul_f32 v[108:109], v[108:109], v[40:41]
v_pk_mul_f32 v[110:111], v[110:111], v[40:41]
Vc 48,80,81
Vc 49,82,83
Vc 50,84,85
Vc 51,86,87
Vc 52,88,89
Vc 53,90,91
Vc 54,92,93
Vc 55,94,95
Vc 56,96,97
Vc 57,98,99
Vc 58,100,101
Vc 59,102,103
Vc 60,104,105
Vc 61,106,107
Vc 62,108,109
Vc 63,110,111
s_mul_i32 s3, s32, 4128
s_add_u32 s3, s3, 131072
v_mul_u32_u24 v42, 2064, v33
v_add3_u32 v42, v42, v36, s3
ds_write_b128 v42, v[48:51] offset:0
ds_write_b128 v42, v[52:55] offset:512
ds_write_b128 v42, v[56:59] offset:1024
ds_write_b128 v42, v[60:63] offset:1536
s_waitcnt vmcnt(10)
v_lshlrev_b32 v80, 16, v48
v_and_b32 v81, 0xffff0000, v48
v_lshlrev_b32_e64 v112, 16, v64
v_and_b32 v113, 0xffff0000, v64
v_pk_mul_f32 v[42:43], v[80:81], v[112:113]
v_lshlrev_b32_e64 v82, 16, v49
v_and_b32 v83, 0xffff0000, v49
v_lshlrev_b32_e64 v114, 16, v65
v_and_b32 v115, 0xffff0000, v65
v_pk_mul_f32 v[44:45], v[82:83], v[114:115]
v_lshlrev_b32_e64 v84, 16, v50
v_and_b32 v85, 0xffff0000, v50
v_lshlrev_b32_e64 v116, 16, v66
v_and_b32 v117, 0xffff0000, v66
v_pk_fma_f32 v[42:43], v[84:85], v[116:117], v[42:43]
v_lshlrev_b32_e64 v86, 16, v51
v_and_b32 v87, 0xffff0000, v51
v_lshlrev_b32_e64 v118, 16, v67
v_and_b32 v119, 0xffff0000, v67
v_pk_fma_f32 v[44:45], v[86:87], v[118:119], v[44:45]
v_lshlrev_b32_e64 v88, 16, v52
v_and_b32 v89, 0xffff0000, v52
v_lshlrev_b32_e64 v112, 16, v68
v_and_b32 v113, 0xffff0000, v68
v_pk_fma_f32 v[42:43], v[88:89], v[112:113], v[42:43]
v_lshlrev_b32_e64 v90, 16, v53
v_and_b32 v91, 0xffff0000, v53
v_lshlrev_b32_e64 v114, 16, v69
v_and_b32 v115, 0xffff0000, v69
v_pk_fma_f32 v[44:45], v[90:91], v[114:115], v[44:45]
v_lshlrev_b32_e64 v92, 16, v54
v_and_b32 v93, 0xffff0000, v54
v_lshlrev_b32_e64 v116, 16, v70
v_and_b32 v117, 0xffff0000, v70
v_pk_fma_f32 v[42:43], v[92:93], v[116:117], v[42:43]
v_lshlrev_b32_e64 v94, 16, v55
v_and_b32 v95, 0xffff0000, v55
v_lshlrev_b32_e64 v118, 16, v71
v_and_b32 v119, 0xffff0000, v71
v_pk_fma_f32 v[44:45], v[94:95], v[118:119], v[44:45]
v_lshlrev_b32_e64 v96, 16, v56
v_and_b32 v97, 0xffff0000, v56
v_lshlrev_b32_e64 v112, 16, v72
v_and_b32 v113, 0xffff0000, v72
v_pk_fma_f32 v[42:43], v[96:97], v[112:113], v[42:43]
v_lshlrev_b32_e64 v98, 16, v57
v_and_b32 v99, 0xffff0000, v57
v_lshlrev_b32_e64 v114, 16, v73
v_and_b32 v115, 0xffff0000, v73
v_pk_fma_f32 v[44:45], v[98:99], v[114:115], v[44:45]
v_lshlrev_b32_e64 v100, 16, v58
v_and_b32 v101, 0xffff0000, v58
v_lshlrev_b32_e64 v116, 16, v74
v_and_b32 v117, 0xffff0000, v74
v_pk_fma_f32 v[42:43], v[100:101], v[116:117], v[42:43]
v_lshlrev_b32_e64 v102, 16, v59
v_and_b32 v103, 0xffff0000, v59
v_lshlrev_b32_e64 v118, 16, v75
v_and_b32 v119, 0xffff0000, v75
v_pk_fma_f32 v[44:45], v[102:103], v[118:119], v[44:45]
v_lshlrev_b32_e64 v104, 16, v60
v_and_b32 v105, 0xffff0000, v60
v_lshlrev_b32_e64 v112, 16, v76
v_and_b32 v113, 0xffff0000, v76
v_pk_fma_f32 v[42:43], v[104:105], v[112:113], v[42:43]
v_lshlrev_b32_e64 v106, 16, v61
v_and_b32 v107, 0xffff0000, v61
v_lshlrev_b32_e64 v114, 16, v77
v_and_b32 v115, 0xffff0000, v77
v_pk_fma_f32 v[44:45], v[106:107], v[114:115], v[44:45]
v_lshlrev_b32_e64 v108, 16, v62
v_and_b32 v109, 0xffff0000, v62
v_lshlrev_b32_e64 v116, 16, v78
v_and_b32 v117, 0xffff0000, v78
v_pk_fma_f32 v[42:43], v[108:109], v[116:117], v[42:43]
v_lshlrev_b32_e64 v110, 16, v63
v_and_b32 v111, 0xffff0000, v63
v_lshlrev_b32_e64 v118, 16, v79
v_and_b32 v119, 0xffff0000, v79
v_pk_fma_f32 v[44:45], v[110:111], v[118:119], v[44:45]
v_pk_add_f32 v[42:43], v[42:43], v[44:45]
Va 45,42,43
s_nop 1
v_add_f32_dpp v45, v45, v45 quad_perm:[1,0,3,2] row_mask:0xf bank_mask:0xf
s_nop 1
v_add_f32_dpp v45, v45, v45 quad_perm:[2,3,0,1] row_mask:0xf bank_mask:0xf
s_nop 1
v_add_f32_dpp v45, v45, v45 row_half_mirror row_mask:0xf bank_mask:0xf
s_nop 1
v_add_f32_dpp v45, v45, v45 row_mirror row_mask:0xf bank_mask:0xf
v_mov_b32 v37, v45
s_nop 1
v_permlane16_swap_b32 v37, v45
v_add_f32_e64 v45, v45, v37
Vc 45,45,45
v_ashrrev_i32_e64 v46, 31, v45
v_or_b32 v46, 0x80000000, v46
v_xor_b32_e64 v45, v45, v46
v_and_b32 v45, 0xffff0000, v45
s_lshr_b32 s3, s36, 11
v_add_u32 v46, s3, v33
v_sub_u32 v44, 0xffff, v46
v_or_b32 v45, v45, v44
v_lshlrev_b32 v44, 2, v46
v_lshlrev_b32_e64 v46, 3, v46
v_xor_b32 v38, 0x80000000, v38
v_mov_b32_e64 v39, v40
s_mov_b32 s3, 5242880
s_mov_b32 s39, 5259264
s_mov_b32 exec_lo, 1
s_mov_b32 exec_hi, 1
buffer_store_dword v45, v44, s[20:23], s3 offen sc1
buffer_store_dwordx2 v[38:39], v46, s[20:23], s39 offen sc1
s_mov_b64 exec, -1
s_load_dwordx2 s[4:5], s[0:1], 16
s_load_dwordx4 s[40:43], s[0:1], 64
s_load_dwordx2 s[92:93], s[0:1], 40
s_load_dwordx2 s[94:95], s[0:1], 80
s_load_dwordx2 s[100:101], s[0:1], 0
s_mov_b32 s28, s64
s_and_b32 s29, s65, 0xffff
s_mov_b32 s30, 256
s_mov_b32 s31, 0x20000
s_waitcnt vmcnt(4)
s_waitcnt lgkmcnt(0)
s_barrier
s_nop 0
Ta 32,12,0
Ta 34,12,2048
Ra 0,10,0
Ta 36,13,0
Ta 38,13,2048
Ra 4,10,2048
Ta 40,14,0
Ta 42,14,2048
Ra 8,10,4096
Ta 44,15,0
Ta 46,15,2048
Ra 12,10,6144
s_waitcnt lgkmcnt(2)
s_nop 0
Ta 48,16,0
Ta 50,16,2048
Ra 16,10,8192
Ta 52,17,0
Ta 54,17,2048
Ra 20,10,10240
Ta 56,18,0
Ta 58,18,2048
Ra 24,10,12288
Ta 60,19,0
Ta 62,19,2048
Ra 28,10,14336
s_cmp_lg_u32 s35, 0
s_cbranch_scc1 L_k1_vpath
s_waitcnt lgkmcnt(0)
s_add_u32 m0, s57, 65536
Zvaa 48,32,0
buffer_load_dwordx4 v6, s[12:15], s52 offen offset:0 nt lds
Zvaa 52,36,0
Ta 96,12,16384
Ta 98,12,18432
Zvaa 56,40,0
buffer_load_dwordx4 v7, s[12:15], s53 offen offset:1024 nt lds
Zvaa 60,44,0
Ra 64,11,0
Zvaa 64,48,0
buffer_load_dwordx4 v6, s[12:15], s54 offen offset:2048 nt lds
Zvaa 68,52,0
Ta 100,13,16384
Ta 102,13,18432
Zvaa 72,56,0
buffer_load_dwordx4 v7, s[12:15], s55 offen offset:3072 nt lds
Zvaa 76,60,0
s_add_u32 m0, s57, 69632
s_waitcnt lgkmcnt(6)
Ra 68,11,2048
Zvaa 80,32,4
buffer_load_dwordx4 v8, s[12:15], s52 offen offset:0 nt lds
Zvaa 84,36,4
Ta 104,14,16384
Ta 106,14,18432
Zvaa 88,40,4
buffer_load_dwordx4 v9, s[12:15], s53 offen offset:1024 nt lds
Zvaa 92,44,4
Ra 72,11,4096
Zvaa 96,48,4
buffer_load_dwordx4 v8, s[12:15], s54 offen offset:2048 nt lds
Zvaa 100,52,4
Ta 108,15,16384
Ta 110,15,18432
Zvaa 104,56,4
buffer_load_dwordx4 v9, s[12:15], s55 offen offset:3072 nt lds
Zvaa 108,60,4
s_add_u32 m0, s56, 65536
s_waitcnt lgkmcnt(6)
Ra 76,11,6144
Zvaa 112,32,8
buffer_load_dwordx4 v2, s[8:11], s48 offen offset:0 lds
Zvaa 116,36,8
Ta 112,16,16384
Ta 114,16,18432
Zvaa 120,40,8
buffer_load_dwordx4 v3, s[8:11], s49 offen offset:1024 lds
Zvaa 124,44,8
Ra 80,11,8192
v_xor_b32 v6, 1572864, v6
Zvaa 128,48,8
buffer_load_dwordx4 v2, s[8:11], s50 offen offset:2048 lds
Zvaa 132,52,8
Ta 116,17,16384
Ta 118,17,18432
Zvaa 136,56,8
buffer_load_dwordx4 v3, s[8:11], s51 offen offset:3072 lds
Zvaa 140,60,8
s_add_u32 m0, s56, 69632
s_waitcnt lgkmcnt(6)
Ra 84,11,10240
Zvaa 144,32,12
buffer_load_dwordx4 v4, s[8:11], s48 offen offset:0 lds
Zvaa 148,36,12
Ta 120,18,16384
Ta 122,18,18432
Zvaa 152,40,12
buffer_load_dwordx4 v5, s[8:11], s49 offen offset:1024 lds
Zvaa 156,44,12
Ra 88,11,12288
v_xor_b32 v7, 1572864, v7
Zvaa 160,48,12
buffer_load_dwordx4 v4, s[8:11], s50 offen offset:2048 lds
Zvaa 164,52,12
Ta 124,19,16384
Ta 126,19,18432
Zvaa 168,56,12
buffer_load_dwordx4 v5, s[8:11], s51 offen offset:3072 lds
Zvaa 172,60,12
s_waitcnt lgkmcnt(6)
Ra 92,11,14336
Zvaa 176,32,16
v_and_b32 v46, 7, v0
v_mul_u32_u24 v30, 2064, v46
Zvaa 180,36,16
v_xor_b32 v8, 1572864, v8
v_xor_b32 v9, 1572864, v9
Zvaa 184,40,16
v_lshrrev_b32_e64 v31, 3, v0
Zvaa 188,44,16
v_xor_b32 v2, 384, v2
v_xor_b32 v3, 384, v3
Zvaa 192,48,16
s_lshl_b32 s3, s32, 9
s_add_u32 s3, s3, 131072
v_lshl_add_u32 v30, v31, 4, v30
Zvaa 196,52,16
v_xor_b32 v4, 384, v4
v_xor_b32 v5, 384, v5
Zvaa 200,56,16
v_add_u32 v30, s3, v30
v_lshlrev_b32_e64 v31, 8, v31
Zvaa 204,60,16
v_lshl_add_u32 v46, v46, 4, v31
Zvaa 208,32,20
buffer_load_dword v1, v47, s[60:63], 0 offen
Zvaa 212,36,20
s_mul_i32 vcc_lo, s59, 7
v_xor_b32 v47, vcc_lo, v47
Zvaa 216,40,20
Rv 34,30,128
Rv 38,30,256
Zvaa 220,44,20
Rv 42,30,384
Rv 30,30,0
Zvaa 224,48,20
buffer_load_dword v1, v47, s[60:63], 0 offen
Zvaa 228,52,20
s_mul_i32 vcc_lo, s59, 1
v_xor_b32 v47, vcc_lo, v47
Zvaa 232,56,20
s_lshr_b32 s3, s2, 1
s_mul_i32 s3, s3, 33792
s_add_u32 s3, s3, s56
Zvaa 236,60,20
s_and_b32 s39, s2, 1
s_lshl_b32 s39, s39, 7
s_add_u32 s3, s3, s39
Zvaa 240,32,24
s_add_u32 s39, s3, 4096
Zvaa 244,36,24
Zvaa 248,40,24
Zvaa 252,44,24
Zaaa 128,48,24
Zaaa 132,52,24
Zaaa 136,56,24
Zaaa 140,60,24
Zaaa 144,32,28
Zaaa 148,36,28
Zaaa 152,40,28
Zaaa 156,44,28
Zaaa 160,48,28
Zaaa 164,52,28
Zaaa 168,56,28
Zaaa 172,60,28
s_waitcnt vmcnt(2) lgkmcnt(0)
s_add_u32 m0, s57, 0
s_barrier
Mvaa 48,96,64
buffer_load_dwordx4 v6, s[12:15], s52 offen offset:0 nt lds
Mvaa 52,100,64
Ta 32,22,0
Ta 34,22,2048
Mvaa 56,104,64
Mvaa 60,108,64
Ra 0,20,0
Mvaa 64,112,64
buffer_load_dwordx4 v7, s[12:15], s53 offen offset:1024 nt lds
Mvaa 68,116,64
s_waitcnt lgkmcnt(6)
Ta 36,23,0
Ta 38,23,2048
Mvaa 72,120,64
Mvaa 76,124,64
Ra 4,20,2048
Mvaa 80,96,68
buffer_load_dwordx4 v6, s[12:15], s54 offen offset:2048 nt lds
Mvaa 84,100,68
Ta 40,24,0
Ta 42,24,2048
Mvaa 88,104,68
Mvaa 92,108,68
Ra 8,20,4096
Mvaa 96,112,68
buffer_load_dwordx4 v7, s[12:15], s55 offen offset:3072 nt lds
Mvaa 100,116,68
s_waitcnt lgkmcnt(6)
Ta 44,25,0
Ta 46,25,2048
Mvaa 104,120,68
Mvaa 108,124,68
s_add_u32 m0, s57, 4096
Ra 12,20,6144
Mvaa 112,96,72
buffer_load_dwordx4 v8, s[12:15], s52 offen offset:0 nt lds
Mvaa 116,100,72
Ta 48,26,0
Ta 50,26,2048
Mvaa 120,104,72
Mvaa 124,108,72
Ra 16,20,8192
Mvaa 128,112,72
buffer_load_dwordx4 v9, s[12:15], s53 offen offset:1024 nt lds
Mvaa 132,116,72
s_waitcnt lgkmcnt(6)
Ta 52,27,0
Ta 54,27,2048
Mvaa 136,120,72
Mvaa 140,124,72
Ra 20,20,10240
Mvaa 144,96,76
buffer_load_dwordx4 v8, s[12:15], s54 offen offset:2048 nt lds
Mvaa 148,100,76
Ta 56,28,0
Ta 58,28,2048
Mvaa 152,104,76
Mvaa 156,108,76
Ra 24,20,12288
Mvaa 160,112,76
buffer_load_dwordx4 v9, s[12:15], s55 offen offset:3072 nt lds
Mvaa 164,116,76
s_waitcnt lgkmcnt(6)
Ta 60,29,0
Ta 62,29,2048
Mvaa 168,120,76
v_xor_b32 v6, 524288, v6
v_xor_b32 v7, 524288, v7
Mvaa 172,124,76
s_add_u32 m0, s56, 0
Ra 28,20,14336
v_xor_b32 v8, 524288, v8
Mvaa 176,96,80
buffer_load_dwordx4 v2, s[8:11], s48 offen offset:0 lds
Mvaa 180,100,80
v_xor_b32 v9, 524288, v9
Mvaa 184,104,80
Mvaa 188,108,80
Mvaa 192,112,80
buffer_load_dwordx4 v3, s[8:11], s49 offen offset:1024 lds
Mvaa 196,116,80
Mvaa 200,120,80
Mvaa 204,124,80
Mvaa 208,96,84
buffer_load_dwordx4 v2, s[8:11], s50 offen offset:2048 lds
Mvaa 212,100,84
Mvaa 216,104,84
Mvaa 220,108,84
Mvaa 224,112,84
buffer_load_dwordx4 v3, s[8:11], s51 offen offset:3072 lds
Mvaa 228,116,84
Mvaa 232,120,84
Mvaa 236,124,84
s_add_u32 m0, s56, 4096
Mvaa 240,96,88
buffer_load_dwordx4 v4, s[8:11], s48 offen offset:0 lds
Mvaa 244,100,88
Mvaa 248,104,88
Mvaa 252,108,88
Maaa 128,112,88
buffer_load_dwordx4 v5, s[8:11], s49 offen offset:1024 lds
Maaa 132,116,88
Maaa 136,120,88
Maaa 140,124,88
Maaa 144,96,92
buffer_load_dwordx4 v4, s[8:11], s50 offen offset:2048 lds
Maaa 148,100,92
Maaa 152,104,92
Maaa 156,108,92
Maaa 160,112,92
buffer_load_dwordx4 v5, s[8:11], s51 offen offset:3072 lds
Maaa 164,116,92
v_xor_b32 v2, 128, v2
v_xor_b32 v3, 128, v3
Maaa 168,120,92
buffer_load_dword v1, v47, s[60:63], 0 offen
v_xor_b32 v4, 128, v4
v_xor_b32 v5, 128, v5
Maaa 172,124,92
s_mul_i32 vcc_lo, s59, 3
v_xor_b32 v47, vcc_lo, v47
s_waitcnt lgkmcnt(0)
Mvaa 48,32,0
buffer_store_dwordx4 v[30:33], v46, s[20:23], s3 offen offset:0 sc1
Mvaa 52,36,0
Ta 96,22,16384
Ta 98,22,18432
Mvaa 56,40,0
buffer_store_dwordx4 v[34:37], v46, s[20:23], s3 offen offset:2048 sc1
Mvaa 60,44,0
Ra 64,21,0
Mvaa 64,48,0
buffer_store_dwordx4 v[38:41], v46, s[20:23], s39 offen offset:0 sc1
Mvaa 68,52,0
Ta 100,23,16384
Ta 102,23,18432
Mvaa 72,56,0
buffer_store_dwordx4 v[42:45], v46, s[20:23], s39 offen offset:2048 sc1
Mvaa 76,60,0
s_waitcnt lgkmcnt(6)
Ra 68,21,2048
Mvaa 80,32,4
s_lshl_b32 s3, s34, 1
s_and_b32 s36, s32, 1
s_add_u32 s3, s3, s36
Mvaa 84,36,4
Ta 104,24,16384
Ta 106,24,18432
Mvaa 88,40,4
s_mul_i32 s3, s3, 1116160
s_mul_i32 s36, s33, 139264
s_add_u32 s3, s3, s36
Mvaa 92,44,4
Ra 72,21,4096
Mvaa 96,48,4
s_lshr_b32 s36, s32, 1
s_mul_i32 s36, s36, 69632
s_add_u32 s3, s3, s36
Mvaa 100,52,4
Ta 108,25,16384
Ta 110,25,18432
Mvaa 104,56,4
s_add_u32 s38, s3, 0
s_lshl_b32 s39, s34, 7
s_lshl_b32 s36, s33, 2
Mvaa 108,60,4
s_waitcnt lgkmcnt(6)
Ra 76,21,6144
Mvaa 112,32,8
s_add_u32 s39, s39, s36
s_add_u32 s39, s39, 5296128
v_mov_b32_e64 v30, 1
Mvaa 116,36,8
Ta 112,26,16384
Ta 114,26,18432
Mvaa 120,40,8
v_mov_b32_e64 v31, 0
Mvaa 124,44,8
Ra 80,21,8192
Mvaa 128,48,8
s_cmp_eq_u32 s32, 0
s_cselect_b32 s39, s39, 2146435072
Mvaa 132,52,8
Ta 116,27,16384
Ta 118,27,18432
Mvaa 136,56,8
s_mov_b64 exec, 1
buffer_store_dword v31, v31, s[20:23], s39 offen sc1
s_mov_b64 exec, -1
Mvaa 140,60,8
s_waitcnt lgkmcnt(6)
Ra 84,21,10240
Mvaa 144,32,12
s_and_b32 s33, s2, 7
s_lshl_b32 s33, s33, 2
s_bfe_u32 s3, s2, 0x20003
Mvaa 148,36,12
Ta 120,28,16384
Ta 122,28,18432
Mvaa 152,40,12
s_add_u32 s33, s33, s3
s_lshr_b32 s34, s2, 5
s_lshl_b32 s64, s34, 7
Mvaa 156,44,12
Ra 88,21,12288
Mvaa 160,48,12
s_lshl_b32 s3, s33, 2
s_add_u32 s64, s64, s3
s_add_u32 s64, s64, 5300224
Mvaa 164,52,12
Ta 124,29,16384
Ta 126,29,18432
Mvaa 168,56,12
s_lshl_b32 s65, s34, 8
s_sub_u32 s65, 1920, s65
v_mul_u32_u24_e64 v32, s65, v0
Mvaa 172,60,12
s_waitcnt lgkmcnt(6)
Ra 92,21,14336
Mvaa 176,32,16
s_cmp_eq_u32 s32, 0
s_cselect_b32 s64, s64, 2146435072
Mvaa 180,36,16
s_mov_b64 exec, 3
buffer_store_dword v31, v32, s[20:23], s64 offen sc1
s_mov_b64 exec, -1
Mvaa 184,40,16
s_lshl_b32 s3, s2, 2
s_add_u32 s3, s3, 5447680
v_lshlrev_b32 v32, 10, v0
Mvaa 188,44,16
s_cmp_eq_u32 s32, 0
s_cselect_b32 s3, s3, 2146435072
Mvaa 192,48,16
s_mov_b64 exec, 0x1ff
buffer_store_dword v31, v32, s[20:23], s3 offen sc1
s_mov_b64 exec, -1
Mvaa 196,52,16
s_lshl_b32 s35, s34, 1
s_sub_u32 s36, 32, s35
s_add_u32 s35, s35, 2
Mvaa 200,56,16
s_lshl_b32 s44, s32, 12
s_lshl_b32 s58, s32, 1
s_sub_u32 s58, 7, s58
Mvaa 204,60,16
s_mul_i32 s58, s58, 33792
s_sub_u32 s3, 15, s34
s_lshl_b32 s45, s3, 3
Mvaa 208,32,20
s_add_u32 s45, s45, s32
s_lshl_b32 s46, s34, 3
s_add_u32 s46, s46, s32
Mvaa 212,36,20
s_mov_b32 s68, s42
s_and_b32 s69, s43, 0xffff
s_mov_b32 s70, 7340032
Mvaa 216,40,20
s_mov_b32 s71, 0x20000
s_cmp_eq_u32 s32, 0
s_cselect_b32 s37, 0, 2146435072
Mvaa 220,44,20
s_lshl_b32 s3, s33, 8
s_add_u32 s16, s4, s3
s_addc_u32 s17, s5, 0
s_and_b32 s17, s17, 0xffff
Mvaa 224,48,20
s_mov_b32 s18, 0
s_mov_b32 s19, 0x20000
s_sub_u32 s18, 8388608, s3
Mvaa 228,52,20
v_and_b32 v33, 15, v0
v_lshrrev_b32_e64 v32, 1, v33
Mvaa 232,56,20
v_and_b32 v33, 1, v0
v_lshlrev_b32 v32, 13, v32
Mvaa 236,60,20
v_lshl_add_u32 v45, v33, 7, v32
Mvaa 240,32,24
s_lshl_b32 s3, s32, 3
s_add_u32 s3, s3, s34
s_mul_i32 s47, s3, 65536
Mvaa 244,36,24
s_bfe_u32 s6, s2, 131075
s_lshl_b32 s3, s32, 8
s_or_b32 s6, s6, s3
Mvaa 248,40,24
Mvaa 252,44,24
Maaa 128,48,24
Maaa 132,52,24
Maaa 136,56,24
Maaa 140,60,24
Maaa 144,32,28
Maaa 148,36,28
Maaa 152,40,28
Maaa 156,44,28
Maaa 160,48,28
Maaa 164,52,28
Maaa 168,56,28
Maaa 172,60,28
s_waitcnt vmcnt(8) lgkmcnt(0)
s_add_u32 m0, s57, 65536
s_barrier
Mvaa 48,96,64
buffer_load_dwordx4 v6, s[12:15], s52 offen offset:0 nt lds
Mvaa 52,100,64
Ta 32,12,0
Ta 34,12,2048
Mvaa 56,104,64
Mvaa 60,108,64
Ra 0,10,0
Mvaa 64,112,64
buffer_load_dwordx4 v7, s[12:15], s53 offen offset:1024 nt lds
Mvaa 68,116,64
s_waitcnt lgkmcnt(6)
Ta 36,13,0
Ta 38,13,2048
Mvaa 72,120,64
Mvaa 76,124,64
Ra 4,10,2048
Mvaa 80,96,68
buffer_load_dwordx4 v6, s[12:15], s54 offen offset:2048 nt lds
Mvaa 84,100,68
Ta 40,14,0
Ta 42,14,2048
Mvaa 88,104,68
Mvaa 92,108,68
Ra 8,10,4096
Mvaa 96,112,68
buffer_load_dwordx4 v7, s[12:15], s55 offen offset:3072 nt lds
Mvaa 100,116,68
s_waitcnt lgkmcnt(6)
Ta 44,15,0
Ta 46,15,2048
Mvaa 104,120,68
Mvaa 108,124,68
s_add_u32 m0, s57, 69632
Ra 12,10,6144
Mvaa 112,96,72
buffer_load_dwordx4 v8, s[12:15], s52 offen offset:0 nt lds
Mvaa 116,100,72
Ta 48,16,0
Ta 50,16,2048
Mvaa 120,104,72
Mvaa 124,108,72
Ra 16,10,8192
Mvaa 128,112,72
buffer_load_dwordx4 v9, s[12:15], s53 offen offset:1024 nt lds
Mvaa 132,116,72
s_waitcnt lgkmcnt(6)
Ta 52,17,0
Ta 54,17,2048
Mvaa 136,120,72
Mvaa 140,124,72
Ra 20,10,10240
Mvaa 144,96,76
buffer_load_dwordx4 v8, s[12:15], s54 offen offset:2048 nt lds
Mvaa 148,100,76
Ta 56,18,0
Ta 58,18,2048
Mvaa 152,104,76
Mvaa 156,108,76
Ra 24,10,12288
Mvaa 160,112,76
buffer_load_dwordx4 v9, s[12:15], s55 offen offset:3072 nt lds
Mvaa 164,116,76
s_waitcnt lgkmcnt(6)
Ta 60,19,0
Ta 62,19,2048
Mvaa 168,120,76
v_xor_b32 v6, 3670016, v6
v_xor_b32 v7, 3670016, v7
Mvaa 172,124,76
s_add_u32 m0, s56, 65536
Ra 28,10,14336
v_xor_b32 v8, 3670016, v8
Mvaa 176,96,80
buffer_load_dwordx4 v2, s[8:11], s48 offen offset:0 lds
Mvaa 180,100,80
v_xor_b32 v9, 3670016, v9
Mvaa 184,104,80
Mvaa 188,108,80
Mvaa 192,112,80
buffer_load_dwordx4 v3, s[8:11], s49 offen offset:1024 lds
Mvaa 196,116,80
Mvaa 200,120,80
Mvaa 204,124,80
Mvaa 208,96,84
buffer_load_dwordx4 v2, s[8:11], s50 offen offset:2048 lds
Mvaa 212,100,84
Mvaa 216,104,84
Mvaa 220,108,84
Mvaa 224,112,84
buffer_load_dwordx4 v3, s[8:11], s51 offen offset:3072 lds
Mvaa 228,116,84
Mvaa 232,120,84
Mvaa 236,124,84
s_add_u32 m0, s56, 69632
Mvaa 240,96,88
buffer_load_dwordx4 v4, s[8:11], s48 offen offset:0 lds
Mvaa 244,100,88
Mvaa 248,104,88
Mvaa 252,108,88
Maaa 128,112,88
buffer_load_dwordx4 v5, s[8:11], s49 offen offset:1024 lds
Maaa 132,116,88
Maaa 136,120,88
Maaa 140,124,88
Maaa 144,96,92
buffer_load_dwordx4 v4, s[8:11], s50 offen offset:2048 lds
Maaa 148,100,92
Maaa 152,104,92
Maaa 156,108,92
Maaa 160,112,92
buffer_load_dwordx4 v5, s[8:11], s51 offen offset:3072 lds
Maaa 164,116,92
v_xor_b32 v2, 896, v2
v_xor_b32 v3, 896, v3
Maaa 168,120,92
buffer_load_dword v1, v47, s[60:63], 0 offen
v_xor_b32 v4, 896, v4
v_xor_b32 v5, 896, v5
Maaa 172,124,92
s_mul_i32 vcc_lo, s59, 1
v_xor_b32 v47, vcc_lo, v47
s_waitcnt lgkmcnt(0)
Mvaa 48,32,0
Mvaa 52,36,0
Ta 96,12,16384
Ta 98,12,18432
Mvaa 56,40,0
Mvaa 60,44,0
Ra 64,11,0
Mvaa 64,48,0
Mvaa 68,52,0
Ta 100,13,16384
Ta 102,13,18432
Mvaa 72,56,0
Mvaa 76,60,0
s_waitcnt lgkmcnt(6)
Ra 68,11,2048
Mvaa 80,32,4
Mvaa 84,36,4
Ta 104,14,16384
Ta 106,14,18432
Mvaa 88,40,4
Mvaa 92,44,4
Ra 72,11,4096
Mvaa 96,48,4
Mvaa 100,52,4
Ta 108,15,16384
Ta 110,15,18432
Mvaa 104,56,4
Mvaa 108,60,4
s_waitcnt lgkmcnt(6)
Ra 76,11,6144
Mvaa 112,32,8
Mvaa 116,36,8
Ta 112,16,16384
Ta 114,16,18432
Mvaa 120,40,8
Mvaa 124,44,8
Ra 80,11,8192
Mvaa 128,48,8
Mvaa 132,52,8
Ta 116,17,16384
Ta 118,17,18432
Mvaa 136,56,8
Mvaa 140,60,8
s_waitcnt lgkmcnt(6)
Ra 84,11,10240
Mvaa 144,32,12
Mvaa 148,36,12
Ta 120,18,16384
Ta 122,18,18432
Mvaa 152,40,12
Mvaa 156,44,12
Ra 88,11,12288
Mvaa 160,48,12
Mvaa 164,52,12
Ta 124,19,16384
Ta 126,19,18432
Mvaa 168,56,12
Mvaa 172,60,12
s_waitcnt lgkmcnt(6)
Ra 92,11,14336
Mvaa 176,32,16
Mvaa 180,36,16
Mvaa 184,40,16
Mvaa 188,44,16
Mvaa 192,48,16
Mvaa 196,52,16
Mvaa 200,56,16
Mvaa 204,60,16
Mvaa 208,32,20
Mvaa 212,36,20
Mvaa 216,40,20
Mvaa 220,44,20
Mvaa 224,48,20
Mvaa 228,52,20
Mvaa 232,56,20
Mvaa 236,60,20
Mvaa 240,32,24
Mvaa 244,36,24
Mvaa 248,40,24
Mvaa 252,44,24
Maaa 128,48,24
Maaa 132,52,24
Maaa 136,56,24
Maaa 140,60,24
Maaa 144,32,28
Maaa 148,36,28
Maaa 152,40,28
Maaa 156,44,28
Maaa 160,48,28
Maaa 164,52,28
Maaa 168,56,28
Maaa 172,60,28
s_waitcnt vmcnt(1) lgkmcnt(0)
s_add_u32 m0, s57, 0
s_barrier
Mvaa 48,96,64
buffer_load_dwordx4 v6, s[12:15], s52 offen offset:0 nt lds
Mvaa 52,100,64
Ta 32,22,0
Ta 34,22,2048
Mvaa 56,104,64
Mvaa 60,108,64
Ra 0,20,0
Mvaa 64,112,64
buffer_load_dwordx4 v7, s[12:15], s53 offen offset:1024 nt lds
Mvaa 68,116,64
s_waitcnt lgkmcnt(6)
Ta 36,23,0
Ta 38,23,2048
Mvaa 72,120,64
Mvaa 76,124,64
Ra 4,20,2048
Mvaa 80,96,68
buffer_load_dwordx4 v6, s[12:15], s54 offen offset:2048 nt lds
Mvaa 84,100,68
Ta 40,24,0
Ta 42,24,2048
Mvaa 88,104,68
Mvaa 92,108,68
Ra 8,20,4096
Mvaa 96,112,68
buffer_load_dwordx4 v7, s[12:15], s55 offen offset:3072 nt lds
Mvaa 100,116,68
s_waitcnt lgkmcnt(6)
Ta 44,25,0
Ta 46,25,2048
Mvaa 104,120,68
s_cmp_eq_u32 s6, 0
s_cselect_b32 s3, 0, 2146435072
Mvaa 108,124,68
s_add_u32 m0, s57, 4096
Ra 12,20,6144
Mvaa 112,96,72
buffer_load_dwordx4 v8, s[12:15], s52 offen offset:0 nt lds
Mvaa 116,100,72
Ta 48,26,0
Ta 50,26,2048
Mvaa 120,104,72
s_mov_b64 exec, 1
buffer_atomic_add v30, v31, s[28:31], s3 offen sc1
s_mov_b64 exec, -1
Mvaa 124,108,72
Ra 16,20,8192
Mvaa 128,112,72
buffer_load_dwordx4 v9, s[12:15], s53 offen offset:1024 nt lds
Mvaa 132,116,72
s_waitcnt lgkmcnt(6)
Ta 52,27,0
Ta 54,27,2048
Mvaa 136,120,72
Mvaa 140,124,72
Ra 20,20,10240
Mvaa 144,96,76
buffer_load_dwordx4 v8, s[12:15], s54 offen offset:2048 nt lds
Mvaa 148,100,76
Ta 56,28,0
Ta 58,28,2048
Mvaa 152,104,76
Mvaa 156,108,76
Ra 24,20,12288
Mvaa 160,112,76
buffer_load_dwordx4 v9, s[12:15], s55 offen offset:3072 nt lds
Mvaa 164,116,76
s_waitcnt lgkmcnt(6)
Ta 60,29,0
Ta 62,29,2048
Mvaa 168,120,76
v_xor_b32 v6, 524288, v6
v_xor_b32 v7, 524288, v7
Mvaa 172,124,76
s_add_u32 m0, s56, 0
Ra 28,20,14336
v_xor_b32 v8, 524288, v8
Mvaa 176,96,80
buffer_load_dwordx4 v2, s[8:11], s48 offen offset:0 lds
Mvaa 180,100,80
v_xor_b32 v9, 524288, v9
Mvaa 184,104,80
Mvaa 188,108,80
Mvaa 192,112,80
buffer_load_dwordx4 v3, s[8:11], s49 offen offset:1024 lds
Mvaa 196,116,80
Mvaa 200,120,80
Mvaa 204,124,80
Mvaa 208,96,84
buffer_load_dwordx4 v2, s[8:11], s50 offen offset:2048 lds
Mvaa 212,100,84
Mvaa 216,104,84
Mvaa 220,108,84
Mvaa 224,112,84
buffer_load_dwordx4 v3, s[8:11], s51 offen offset:3072 lds
Mvaa 228,116,84
Mvaa 232,120,84
Mvaa 236,124,84
s_add_u32 m0, s56, 4096
Mvaa 240,96,88
buffer_load_dwordx4 v4, s[8:11], s48 offen offset:0 lds
Mvaa 244,100,88
Mvaa 248,104,88
Mvaa 252,108,88
Maaa 128,112,88
buffer_load_dwordx4 v5, s[8:11], s49 offen offset:1024 lds
Maaa 132,116,88
Maaa 136,120,88
Maaa 140,124,88
Maaa 144,96,92
buffer_load_dwordx4 v4, s[8:11], s50 offen offset:2048 lds
Maaa 148,100,92
Maaa 152,104,92
Maaa 156,108,92
Maaa 160,112,92
buffer_load_dwordx4 v5, s[8:11], s51 offen offset:3072 lds
Maaa 164,116,92
v_xor_b32 v2, 128, v2
v_xor_b32 v3, 128, v3
Maaa 168,120,92
buffer_load_dword v1, v47, s[60:63], 0 offen
v_xor_b32 v4, 128, v4
v_xor_b32 v5, 128, v5
Maaa 172,124,92
s_mul_i32 vcc_lo, s59, 7
v_xor_b32 v47, vcc_lo, v47
s_waitcnt lgkmcnt(0)
Mvaa 48,32,0
buffer_load_dword v44, v45, s[16:19], s47 offen
Mvaa 52,36,0
Ta 96,22,16384
Ta 98,22,18432
Mvaa 56,40,0
s_add_u32 s47, s47, 2097152
Mvaa 60,44,0
Ra 64,21,0
Mvaa 64,48,0
Mvaa 68,52,0
Ta 100,23,16384
Ta 102,23,18432
Mvaa 72,56,0
Mvaa 76,60,0
s_waitcnt lgkmcnt(6)
Ra 68,21,2048
Mvaa 80,32,4
Mvaa 84,36,4
Ta 104,24,16384
Ta 106,24,18432
Mvaa 88,40,4
Mvaa 92,44,4
Ra 72,21,4096
Mvaa 96,48,4
Mvaa 100,52,4
Ta 108,25,16384
Ta 110,25,18432
Mvaa 104,56,4
Mvaa 108,60,4
s_waitcnt lgkmcnt(6)
Ra 76,21,6144
Mvaa 112,32,8
Mvaa 116,36,8
Ta 112,26,16384
Ta 114,26,18432
Mvaa 120,40,8
Mvaa 124,44,8
Ra 80,21,8192
Mvaa 128,48,8
Mvaa 132,52,8
Ta 116,27,16384
Ta 118,27,18432
Mvaa 136,56,8
Mvaa 140,60,8
s_waitcnt lgkmcnt(6)
Ra 84,21,10240
Mvaa 144,32,12
Mvaa 148,36,12
Ta 120,28,16384
Ta 122,28,18432
Mvaa 152,40,12
s_cmp_eq_u32 s6, 1
s_cselect_b32 s3, 0, 2146435072
Mvaa 156,44,12
Ra 88,21,12288
Mvaa 160,48,12
s_mov_b64 exec, 1
buffer_atomic_add v30, v31, s[28:31], s3 offen sc1
s_mov_b64 exec, -1
Mvaa 164,52,12
Ta 124,29,16384
Ta 126,29,18432
Mvaa 168,56,12
Mvaa 172,60,12
s_waitcnt lgkmcnt(6)
Ra 92,21,14336
Mvaa 176,32,16
Mvaa 180,36,16
Mvaa 184,40,16
Mvaa 188,44,16
Mvaa 192,48,16
Mvaa 196,52,16
Mvaa 200,56,16
Mvaa 204,60,16
Mvaa 208,32,20
Mvaa 212,36,20
Mvaa 216,40,20
Mvaa 220,44,20
Mvaa 224,48,20
Mvaa 228,52,20
Mvaa 232,56,20
Mvaa 236,60,20
Mvaa 240,32,24
Mvaa 244,36,24
Mvaa 248,40,24
Mvaa 252,44,24
Maaa 128,48,24
Maaa 132,52,24
Maaa 136,56,24
Maaa 140,60,24
Maaa 144,32,28
Maaa 148,36,28
Maaa 152,40,28
Maaa 156,44,28
Maaa 160,48,28
Maaa 164,52,28
Maaa 168,56,28
Maaa 172,60,28
s_waitcnt vmcnt(3) lgkmcnt(0)
s_add_u32 m0, s57, 65536
s_barrier
Mvaa 48,96,64
buffer_load_dwordx4 v6, s[12:15], s52 offen offset:0 nt lds
Mvaa 52,100,64
Ta 32,12,0
Ta 34,12,2048
Mvaa 56,104,64
Mvaa 60,108,64
Ra 0,10,0
Mvaa 64,112,64
buffer_load_dwordx4 v7, s[12:15], s53 offen offset:1024 nt lds
Mvaa 68,116,64
s_waitcnt lgkmcnt(6)
Ta 36,13,0
Ta 38,13,2048
Mvaa 72,120,64
Mvaa 76,124,64
Ra 4,10,2048
Mvaa 80,96,68
buffer_load_dwordx4 v6, s[12:15], s54 offen offset:2048 nt lds
Mvaa 84,100,68
Ta 40,14,0
Ta 42,14,2048
Mvaa 88,104,68
Mvaa 92,108,68
Ra 8,10,4096
Mvaa 96,112,68
buffer_load_dwordx4 v7, s[12:15], s55 offen offset:3072 nt lds
Mvaa 100,116,68
s_waitcnt lgkmcnt(6)
Ta 44,15,0
Ta 46,15,2048
Mvaa 104,120,68
Mvaa 108,124,68
s_add_u32 m0, s57, 69632
Ra 12,10,6144
Mvaa 112,96,72
buffer_load_dwordx4 v8, s[12:15], s52 offen offset:0 nt lds
Mvaa 116,100,72
Ta 48,16,0
Ta 50,16,2048
Mvaa 120,104,72
Mvaa 124,108,72
Ra 16,10,8192
Mvaa 128,112,72
buffer_load_dwordx4 v9, s[12:15], s53 offen offset:1024 nt lds
Mvaa 132,116,72
s_waitcnt lgkmcnt(6)
Ta 52,17,0
Ta 54,17,2048
Mvaa 136,120,72
Mvaa 140,124,72
Ra 20,10,10240
Mvaa 144,96,76
buffer_load_dwordx4 v8, s[12:15], s54 offen offset:2048 nt lds
Mvaa 148,100,76
Ta 56,18,0
Ta 58,18,2048
Mvaa 152,104,76
Mvaa 156,108,76
Ra 24,10,12288
Mvaa 160,112,76
buffer_load_dwordx4 v9, s[12:15], s55 offen offset:3072 nt lds
Mvaa 164,116,76
s_waitcnt lgkmcnt(6)
Ta 60,19,0
Ta 62,19,2048
Mvaa 168,120,76
v_xor_b32 v6, 1572864, v6
v_xor_b32 v7, 1572864, v7
Mvaa 172,124,76
s_add_u32 m0, s56, 65536
Ra 28,10,14336
v_xor_b32 v8, 1572864, v8
Mvaa 176,96,80
buffer_load_dwordx4 v2, s[8:11], s48 offen offset:0 lds
Mvaa 180,100,80
v_xor_b32 v9, 1572864, v9
Mvaa 184,104,80
Mvaa 188,108,80
Mvaa 192,112,80
buffer_load_dwordx4 v3, s[8:11], s49 offen offset:1024 lds
Mvaa 196,116,80
Mvaa 200,120,80
Mvaa 204,124,80
s_cmp_eq_u32 s6, 2
s_cselect_b32 s3, 0, 2146435072
Mvaa 208,96,84
buffer_load_dwordx4 v2, s[8:11], s50 offen offset:2048 lds
Mvaa 212,100,84
s_mov_b64 exec, 1
buffer_atomic_add v30, v31, s[28:31], s3 offen sc1
s_mov_b64 exec, -1
Mvaa 216,104,84
Mvaa 220,108,84
Mvaa 224,112,84
buffer_load_dwordx4 v3, s[8:11], s51 offen offset:3072 lds
Mvaa 228,116,84
Mvaa 232,120,84
Mvaa 236,124,84
s_add_u32 m0, s56, 69632
Mvaa 240,96,88
buffer_load_dwordx4 v4, s[8:11], s48 offen offset:0 lds
Mvaa 244,100,88
Mvaa 248,104,88
Mvaa 252,108,88
Maaa 128,112,88
buffer_load_dwordx4 v5, s[8:11], s49 offen offset:1024 lds
Maaa 132,116,88
Maaa 136,120,88
Maaa 140,124,88
Maaa 144,96,92
buffer_load_dwordx4 v4, s[8:11], s50 offen offset:2048 lds
Maaa 148,100,92
Maaa 152,104,92
Maaa 156,108,92
Maaa 160,112,92
buffer_load_dwordx4 v5, s[8:11], s51 offen offset:3072 lds
Maaa 164,116,92
v_xor_b32 v2, 384, v2
v_xor_b32 v3, 384, v3
Maaa 168,120,92
v_xor_b32 v4, 384, v4
v_xor_b32 v5, 384, v5
Maaa 172,124,92
s_waitcnt lgkmcnt(0)
Mvaa 48,32,0
buffer_load_dword v44, v45, s[16:19], s47 offen
Mvaa 52,36,0
Ta 96,12,16384
Ta 98,12,18432
Mvaa 56,40,0
s_add_u32 s47, s47, 2097152
Mvaa 60,44,0
Ra 64,11,0
Mvaa 64,48,0
Mvaa 68,52,0
Ta 100,13,16384
Ta 102,13,18432
Mvaa 72,56,0
Mvaa 76,60,0
s_waitcnt lgkmcnt(6)
Ra 68,11,2048
Mvaa 80,32,4
Mvaa 84,36,4
Ta 104,14,16384
Ta 106,14,18432
Mvaa 88,40,4
Mvaa 92,44,4
Ra 72,11,4096
Mvaa 96,48,4
Mvaa 100,52,4
Ta 108,15,16384
Ta 110,15,18432
Mvaa 104,56,4
Mvaa 108,60,4
s_waitcnt lgkmcnt(6)
Ra 76,11,6144
Mvaa 112,32,8
Mvaa 116,36,8
Ta 112,16,16384
Ta 114,16,18432
Mvaa 120,40,8
Mvaa 124,44,8
Ra 80,11,8192
Mvaa 128,48,8
Mvaa 132,52,8
Ta 116,17,16384
Ta 118,17,18432
Mvaa 136,56,8
Mvaa 140,60,8
s_waitcnt lgkmcnt(6)
Ra 84,11,10240
Mvaa 144,32,12
Mvaa 148,36,12
Ta 120,18,16384
Ta 122,18,18432
Mvaa 152,40,12
Mvaa 156,44,12
Ra 88,11,12288
Mvaa 160,48,12
Mvaa 164,52,12
Ta 124,19,16384
Ta 126,19,18432
Mvaa 168,56,12
Mvaa 172,60,12
s_waitcnt lgkmcnt(6)
Ra 92,11,14336
Mvaa 176,32,16
Mvaa 180,36,16
Mvaa 184,40,16
Mvaa 188,44,16
Mvaa 192,48,16
Mvaa 196,52,16
Mvaa 200,56,16
Mvaa 204,60,16
Mvaa 208,32,20
Mvaa 212,36,20
Mvaa 216,40,20
Mvaa 220,44,20
Mvaa 224,48,20
Mvaa 228,52,20
Mvaa 232,56,20
Mvaa 236,60,20
Mvaa 240,32,24
Mvaa 244,36,24
Mvaa 248,40,24
Mvaa 252,44,24
Maaa 128,48,24
s_cmp_eq_u32 s6, 3
s_cselect_b32 s3, 0, 2146435072
Maaa 132,52,24
s_mov_b64 exec, 1
buffer_atomic_add v30, v31, s[28:31], s3 offen sc1
s_mov_b64 exec, -1
Maaa 136,56,24
Maaa 140,60,24
Maaa 144,32,28
Maaa 148,36,28
Maaa 152,40,28
Maaa 156,44,28
Maaa 160,48,28
Maaa 164,52,28
Maaa 168,56,28
Maaa 172,60,28
s_waitcnt vmcnt(2) lgkmcnt(0)
s_add_u32 m0, s57, 0
s_barrier
Mvaa 48,96,64
buffer_load_dwordx4 v6, s[12:15], s52 offen offset:0 nt lds
Mvaa 52,100,64
Ta 32,22,0
Ta 34,22,2048
Mvaa 56,104,64
Mvaa 60,108,64
Ra 0,20,0
Mvaa 64,112,64
buffer_load_dwordx4 v7, s[12:15], s53 offen offset:1024 nt lds
Mvaa 68,116,64
s_waitcnt lgkmcnt(6)
Ta 36,23,0
Ta 38,23,2048
Mvaa 72,120,64
Mvaa 76,124,64
Ra 4,20,2048
Mvaa 80,96,68
buffer_load_dwordx4 v6, s[12:15], s54 offen offset:2048 nt lds
Mvaa 84,100,68
Ta 40,24,0
Ta 42,24,2048
Mvaa 88,104,68
Mvaa 92,108,68
Ra 8,20,4096
Mvaa 96,112,68
buffer_load_dwordx4 v7, s[12:15], s55 offen offset:3072 nt lds
Mvaa 100,116,68
s_waitcnt lgkmcnt(6)
Ta 44,25,0
Ta 46,25,2048
Mvaa 104,120,68
Mvaa 108,124,68
s_add_u32 m0, s57, 4096
Ra 12,20,6144
Mvaa 112,96,72
buffer_load_dwordx4 v8, s[12:15], s52 offen offset:0 nt lds
Mvaa 116,100,72
Ta 48,26,0
Ta 50,26,2048
Mvaa 120,104,72
Mvaa 124,108,72
Ra 16,20,8192
Mvaa 128,112,72
buffer_load_dwordx4 v9, s[12:15], s53 offen offset:1024 nt lds
Mvaa 132,116,72
s_waitcnt lgkmcnt(6)
Ta 52,27,0
Ta 54,27,2048
Mvaa 136,120,72
Mvaa 140,124,72
Ra 20,20,10240
Mvaa 144,96,76
buffer_load_dwordx4 v8, s[12:15], s54 offen offset:2048 nt lds
Mvaa 148,100,76
Ta 56,28,0
Ta 58,28,2048
Mvaa 152,104,76
Mvaa 156,108,76
Ra 24,20,12288
Mvaa 160,112,76
buffer_load_dwordx4 v9, s[12:15], s55 offen offset:3072 nt lds
Mvaa 164,116,76
s_waitcnt lgkmcnt(6)
Ta 60,29,0
Ta 62,29,2048
Mvaa 168,120,76
v_xor_b32 v6, 524288, v6
v_xor_b32 v7, 524288, v7
Mvaa 172,124,76
s_add_u32 m0, s56, 0
Ra 28,20,14336
v_xor_b32 v8, 524288, v8
Mvaa 176,96,80
buffer_load_dwordx4 v2, s[8:11], s48 offen offset:0 lds
Mvaa 180,100,80
v_xor_b32 v9, 524288, v9
Mvaa 184,104,80
Mvaa 188,108,80
Mvaa 192,112,80
buffer_load_dwordx4 v3, s[8:11], s49 offen offset:1024 lds
Mvaa 196,116,80
Mvaa 200,120,80
Mvaa 204,124,80
Mvaa 208,96,84
buffer_load_dwordx4 v2, s[8:11], s50 offen offset:2048 lds
Mvaa 212,100,84
Mvaa 216,104,84
Mvaa 220,108,84
Mvaa 224,112,84
buffer_load_dwordx4 v3, s[8:11], s51 offen offset:3072 lds
Mvaa 228,116,84
Mvaa 232,120,84
Mvaa 236,124,84
s_add_u32 m0, s56, 4096
Mvaa 240,96,88
buffer_load_dwordx4 v4, s[8:11], s48 offen offset:0 lds
Mvaa 244,100,88
Mvaa 248,104,88
Mvaa 252,108,88
Maaa 128,112,88
buffer_load_dwordx4 v5, s[8:11], s49 offen offset:1024 lds
Maaa 132,116,88
Maaa 136,120,88
Maaa 140,124,88
Maaa 144,96,92
buffer_load_dwordx4 v4, s[8:11], s50 offen offset:2048 lds
Maaa 148,100,92
Maaa 152,104,92
Maaa 156,108,92
Maaa 160,112,92
buffer_load_dwordx4 v5, s[8:11], s51 offen offset:3072 lds
Maaa 164,116,92
v_xor_b32 v2, 128, v2
v_xor_b32 v3, 128, v3
Maaa 168,120,92
v_xor_b32 v4, 128, v4
v_xor_b32 v5, 128, v5
Maaa 172,124,92
s_waitcnt lgkmcnt(0)
Mvaa 48,32,0
buffer_load_dword v44, v45, s[16:19], s47 offen
Mvaa 52,36,0
Ta 96,22,16384
Ta 98,22,18432
Mvaa 56,40,0
s_add_u32 s47, s47, 2097152
v_lshrrev_b32 v32, 4, v0
v_and_b32 v33, 15, v0
Mvaa 60,44,0
Ra 64,21,0
Mvaa 64,48,0
s_lshl_b32 s3, s32, 4
v_add_u32 v34, s3, v32
v_lshlrev_b32_e64 v36, 1, v32
Mvaa 68,52,0
Ta 100,23,16384
Ta 102,23,18432
Mvaa 72,56,0
v_xor_b32 v36, v36, v33
v_xor_b32 v37, 8, v36
Mvaa 76,60,0
s_waitcnt lgkmcnt(6)
Ra 68,21,2048
Mvaa 80,32,4
s_getpc_b64 s[6:7]
L_cpf2:
s_add_u32 s6, s6, (L_phase2-L_cpf2)&0xffffffff
s_addc_u32 s7, s7, ((L_phase2-L_cpf2)>>32)&0xffffffff
Mvaa 84,36,4
Ta 104,24,16384
Ta 106,24,18432
Mvaa 88,40,4
s_lshr_b32 s3, s2, 3
s_lshl_b32 s3, s3, 2
s_add_u32 s3, s3, s32
Mvaa 92,44,4
Ra 72,21,4096
Mvaa 96,48,4
s_lshl_b32 s3, s3, 10
v_and_b32 v42, 7, v0
v_lshlrev_b32 v42, 7, v42
Mvaa 100,52,4
Ta 108,25,16384
Ta 110,25,18432
Mvaa 104,56,4
v_add_u32_e64 v42, s3, v42
v_min_u32 v42, L_k2_fin-L_phase2-4, v42
Mvaa 108,60,4
s_waitcnt lgkmcnt(6)
Ra 76,21,6144
Mvaa 112,32,8
v_mov_b32 v41, s7
Mvaa 116,36,8
Ta 112,26,16384
Ta 114,26,18432
Mvaa 120,40,8
v_add_co_u32 v40, vcc, s6, v42
s_nop 1
v_addc_co_u32 v41, vcc, 0, v41, vcc
Mvaa 124,44,8
Ra 80,21,8192
Mvaa 128,48,8
global_load_dword v38, v[40:41], off
Mvaa 132,52,8
Ta 116,27,16384
Ta 118,27,18432
Mvaa 136,56,8
Mvaa 140,60,8
s_waitcnt lgkmcnt(6)
Ra 84,21,10240
Mvaa 144,32,12
Mvaa 148,36,12
Ta 120,28,16384
Ta 122,28,18432
Mvaa 152,40,12
Mvaa 156,44,12
Ra 88,21,12288
Mvaa 160,48,12
Mvaa 164,52,12
Ta 124,29,16384
Ta 126,29,18432
Mvaa 168,56,12
Mvaa 172,60,12
s_waitcnt lgkmcnt(6)
Ra 92,21,14336
Mvaa 176,32,16
Mvaa 180,36,16
Mvaa 184,40,16
Mvaa 188,44,16
Mvaa 192,48,16
Mvaa 196,52,16
Mvaa 200,56,16
Mvaa 204,60,16
Mvaa 208,32,20
Mvaa 212,36,20
Mvaa 216,40,20
Mvaa 220,44,20
Mvaa 224,48,20
Mvaa 228,52,20
Mvaa 232,56,20
Mvaa 236,60,20
Mvaa 240,32,24
Mvaa 244,36,24
Mvaa 248,40,24
Mvaa 252,44,24
Maaa 128,48,24
Maaa 132,52,24
Maaa 136,56,24
Maaa 140,60,24
Maaa 144,32,28
Maaa 148,36,28
Maaa 152,40,28
Maaa 156,44,28
Maaa 160,48,28
Maaa 164,52,28
Maaa 168,56,28
Maaa 172,60,28
s_waitcnt vmcnt(2) lgkmcnt(0)
s_add_u32 m0, s57, 65536
s_barrier
Mvaa 48,96,64
buffer_load_dwordx4 v6, s[12:15], s52 offen offset:0 nt lds
Mvaa 52,100,64
Ta 32,12,0
Ta 34,12,2048
Mvaa 56,104,64
Mvaa 60,108,64
Ra 0,10,0
Mvaa 64,112,64
buffer_load_dwordx4 v7, s[12:15], s53 offen offset:1024 nt lds
Mvaa 68,116,64
s_waitcnt lgkmcnt(6)
Ta 36,13,0
Ta 38,13,2048
Mvaa 72,120,64
Mvaa 76,124,64
Ra 4,10,2048
Mvaa 80,96,68
buffer_load_dwordx4 v6, s[12:15], s54 offen offset:2048 nt lds
Mvaa 84,100,68
Ta 40,14,0
Ta 42,14,2048
Mvaa 88,104,68
Mvaa 92,108,68
Ra 8,10,4096
Mvaa 96,112,68
buffer_load_dwordx4 v7, s[12:15], s55 offen offset:3072 nt lds
Mvaa 100,116,68
s_waitcnt lgkmcnt(6)
Ta 44,15,0
Ta 46,15,2048
Mvaa 104,120,68
Mvaa 108,124,68
s_add_u32 m0, s57, 69632
Ra 12,10,6144
Mvaa 112,96,72
buffer_load_dwordx4 v8, s[12:15], s52 offen offset:0 nt lds
Mvaa 116,100,72
Ta 48,16,0
Ta 50,16,2048
Mvaa 120,104,72
Mvaa 124,108,72
Ra 16,10,8192
Mvaa 128,112,72
buffer_load_dwordx4 v9, s[12:15], s53 offen offset:1024 nt lds
Mvaa 132,116,72
s_waitcnt lgkmcnt(6)
Ta 52,17,0
Ta 54,17,2048
Mvaa 136,120,72
Mvaa 140,124,72
Ra 20,10,10240
Mvaa 144,96,76
buffer_load_dwordx4 v8, s[12:15], s54 offen offset:2048 nt lds
Mvaa 148,100,76
Ta 56,18,0
Ta 58,18,2048
Mvaa 152,104,76
Mvaa 156,108,76
Ra 24,10,12288
Mvaa 160,112,76
buffer_load_dwordx4 v9, s[12:15], s55 offen offset:3072 nt lds
Mvaa 164,116,76
s_waitcnt lgkmcnt(6)
Ta 60,19,0
Ta 62,19,2048
Mvaa 168,120,76
Mvaa 172,124,76
s_add_u32 m0, s56, 65536
Ra 28,10,14336
Mvaa 176,96,80
buffer_load_dwordx4 v2, s[8:11], s48 offen offset:0 lds
Mvaa 180,100,80
Mvaa 184,104,80
Mvaa 188,108,80
Mvaa 192,112,80
buffer_load_dwordx4 v3, s[8:11], s49 offen offset:1024 lds
Mvaa 196,116,80
Mvaa 200,120,80
Mvaa 204,124,80
Mvaa 208,96,84
buffer_load_dwordx4 v2, s[8:11], s50 offen offset:2048 lds
Mvaa 212,100,84
Mvaa 216,104,84
Mvaa 220,108,84
Mvaa 224,112,84
buffer_load_dwordx4 v3, s[8:11], s51 offen offset:3072 lds
Mvaa 228,116,84
Mvaa 232,120,84
Mvaa 236,124,84
s_add_u32 m0, s56, 69632
Mvaa 240,96,88
buffer_load_dwordx4 v4, s[8:11], s48 offen offset:0 lds
Mvaa 244,100,88
Mvaa 248,104,88
Mvaa 252,108,88
Maaa 128,112,88
buffer_load_dwordx4 v5, s[8:11], s49 offen offset:1024 lds
Maaa 132,116,88
Maaa 136,120,88
Maaa 140,124,88
Maaa 144,96,92
buffer_load_dwordx4 v4, s[8:11], s50 offen offset:2048 lds
Maaa 148,100,92
Maaa 152,104,92
Maaa 156,108,92
Maaa 160,112,92
buffer_load_dwordx4 v5, s[8:11], s51 offen offset:3072 lds
Maaa 164,116,92
Maaa 168,120,92
Maaa 172,124,92
s_waitcnt lgkmcnt(0)
Mvaa 48,32,0
buffer_load_dword v30, v31, s[28:31], s37 offen sc1
Mvaa 52,36,0
Ta 96,12,16384
Ta 98,12,18432
Mvaa 56,40,0
s_mov_b32 s8, s16
s_mov_b32 s9, s17
s_mov_b32 s10, s18
Mvaa 60,44,0
Ra 64,11,0
Mvaa 64,48,0
s_add_u32 s16, s66, 46137344
s_addc_u32 s17, s67, 0
s_and_b32 s17, s17, 0xffff
Mvaa 68,52,0
Ta 100,13,16384
Ta 102,13,18432
Mvaa 72,56,0
s_mov_b32 s18, 16777216
s_mov_b32 s19, 0x20000
s_mov_b32 s48, 0
Mvaa 76,60,0
s_waitcnt lgkmcnt(6)
Ra 68,11,2048
Mvaa 80,32,4
s_mov_b32 s49, 31744
s_mov_b32 s50, 63488
s_mov_b32 s51, 95232
Mvaa 84,36,4
Ta 104,14,16384
Ta 106,14,18432
Mvaa 88,40,4
v_lshlrev_b32_e64 v35, 13, v34
v_lshl_add_u32 v8, v36, 4, v35
Mvaa 92,44,4
Ra 72,11,4096
Mvaa 96,48,4
v_lshl_add_u32 v9, v37, 4, v35
v_lshlrev_b32_e64 v2, 4, v0
Mvaa 100,52,4
Ta 108,15,16384
Ta 110,15,18432
Mvaa 104,56,4
v_add_u32 v3, 65536, v2
v_add_u32_e64 v4, s44, v2
Mvaa 108,60,4
s_waitcnt lgkmcnt(6)
Ra 76,11,6144
Mvaa 112,32,8
v_mov_b32 v7, 0
v_lshlrev_b32_e64 v35, 2, v32
Mvaa 116,36,8
Ta 112,16,16384
Ta 114,16,18432
Mvaa 120,40,8
v_sub_u32_e64 v35, v33, v35
Mvaa 124,44,8
Ra 80,11,8192
Mvaa 128,48,8
s_lshl_b32 s3, s32, 4
v_add_u32 v5, s3, v35
Mvaa 132,52,8
Ta 116,17,16384
Ta 118,17,18432
Mvaa 136,56,8
s_sub_u32 s3, 48, s3
v_add_u32 v6, s3, v35
Mvaa 140,60,8
s_waitcnt lgkmcnt(6)
Ra 84,11,10240
Mvaa 144,32,12
s_mul_i32 s3, s33, 1116160
s_add_u32 s3, s3, 8388608
s_add_u32 s12, s66, s3
s_addc_u32 s13, s67, 0
s_and_b32 s13, s13, 0xffff
Mvaa 148,36,12
Ta 120,18,16384
Ta 122,18,18432
Mvaa 152,40,12
s_mov_b32 s14, 0
s_mov_b32 s15, 0x20000
s_mul_i32 s14, s36, 34816
Mvaa 156,44,12
Ra 88,11,12288
Mvaa 160,48,12
buffer_load_dword v44, v45, s[8:11], s47 offen
Mvaa 164,52,12
Ta 124,19,16384
Ta 126,19,18432
Mvaa 168,56,12
s_add_u32 s47, s47, 2097152
Mvaa 172,60,12
s_waitcnt lgkmcnt(6)
Ra 92,11,14336
Mvaa 176,32,16
Mvaa 180,36,16
Mvaa 184,40,16
Mvaa 188,44,16
Mvaa 192,48,16
Mvaa 196,52,16
Mvaa 200,56,16
Mvaa 204,60,16
Mvaa 208,32,20
Mvaa 212,36,20
Mvaa 216,40,20
Mvaa 220,44,20
Mvaa 224,48,20
Mvaa 228,52,20
Mvaa 232,56,20
Mvaa 236,60,20
Mvaa 240,32,24
Mvaa 244,36,24
Mvaa 248,40,24
Mvaa 252,44,24
Maaa 128,48,24
Maaa 132,52,24
Maaa 136,56,24
Maaa 140,60,24
Maaa 144,32,28
Maaa 148,36,28
Maaa 152,40,28
Maaa 156,44,28
Maaa 160,48,28
Maaa 164,52,28
Maaa 168,56,28
Maaa 172,60,28
s_waitcnt vmcnt(2) lgkmcnt(0)
s_add_u32 m0, s44, 0
s_barrier
Mvaa 48,96,64
buffer_load_dwordx4 v8, s[8:11], s48 offen offset:0 lds
Mvaa 52,100,64
Ta 32,22,0
Ta 34,22,2048
Mvaa 56,104,64
s_mul_i32 s3, s45, 33792
v_add_u32_e64 v10, s3, v2
Mvaa 60,108,64
Ra 0,20,0
Mvaa 64,112,64
buffer_load_dwordx4 v8, s[8:11], s49 offen offset:1024 lds
Mvaa 68,116,64
s_waitcnt lgkmcnt(6)
Ta 36,23,0
Ta 38,23,2048
Mvaa 72,120,64
s_mul_i32 s3, s46, 33792
v_add_u32 v11, s3, v2
v_mov_b32_e64 v14, v40
Mvaa 76,124,64
Ra 4,20,2048
Mvaa 80,96,68
buffer_load_dwordx4 v9, s[8:11], s50 offen offset:2048 lds
Mvaa 84,100,68
Ta 40,24,0
Ta 42,24,2048
Mvaa 88,104,68
v_mov_b32_e64 v15, v41
Mvaa 92,108,68
Ra 8,20,4096
Mvaa 96,112,68
buffer_load_dwordx4 v9, s[8:11], s51 offen offset:3072 lds
Mvaa 100,116,68
s_waitcnt lgkmcnt(6)
Ta 44,25,0
Ta 46,25,2048
Mvaa 104,120,68
v_add_u32 v8, 524288, v8
v_add_u32 v9, 524288, v9
Mvaa 108,124,68
s_add_u32 m0, s44, 16384
Ra 12,20,6144
Mvaa 112,96,72
buffer_load_dwordx4 v8, s[8:11], s48 offen offset:0 lds
Mvaa 116,100,72
Ta 48,26,0
Ta 50,26,2048
Mvaa 120,104,72
Mvaa 124,108,72
Ra 16,20,8192
Mvaa 128,112,72
buffer_load_dwordx4 v8, s[8:11], s49 offen offset:1024 lds
Mvaa 132,116,72
s_waitcnt lgkmcnt(6)
Ta 52,27,0
Ta 54,27,2048
Mvaa 136,120,72
Mvaa 140,124,72
Ra 20,20,10240
Mvaa 144,96,76
buffer_load_dwordx4 v9, s[8:11], s50 offen offset:2048 lds
Mvaa 148,100,76
Ta 56,28,0
Ta 58,28,2048
Mvaa 152,104,76
Mvaa 156,108,76
Ra 24,20,12288
Mvaa 160,112,76
buffer_load_dwordx4 v9, s[8:11], s51 offen offset:3072 lds
Mvaa 164,116,76
s_waitcnt lgkmcnt(6)
Ta 60,29,0
Ta 62,29,2048
Mvaa 168,120,76
v_add_u32 v8, 524288, v8
v_add_u32 v9, 524288, v9
Mvaa 172,124,76
s_add_u32 m0, s44, 32768
Ra 28,20,14336
Mvaa 176,96,80
buffer_load_dwordx4 v8, s[8:11], s48 offen offset:0 lds
Mvaa 180,100,80
Mvaa 184,104,80
Mvaa 188,108,80
Mvaa 192,112,80
buffer_load_dwordx4 v8, s[8:11], s49 offen offset:1024 lds
Mvaa 196,116,80
Mvaa 200,120,80
Mvaa 204,124,80
Mvaa 208,96,84
buffer_load_dwordx4 v9, s[8:11], s50 offen offset:2048 lds
Mvaa 212,100,84
Mvaa 216,104,84
Mvaa 220,108,84
Mvaa 224,112,84
buffer_load_dwordx4 v9, s[8:11], s51 offen offset:3072 lds
Mvaa 228,116,84
v_add_u32 v8, 524288, v8
v_add_u32 v9, 524288, v9
Mvaa 232,120,84
Mvaa 236,124,84
s_add_u32 m0, s44, 49152
Mvaa 240,96,88
buffer_load_dwordx4 v8, s[8:11], s48 offen offset:0 lds
Mvaa 244,100,88
Mvaa 248,104,88
Mvaa 252,108,88
Maaa 128,112,88
buffer_load_dwordx4 v8, s[8:11], s49 offen offset:1024 lds
Maaa 132,116,88
Maaa 136,120,88
Maaa 140,124,88
Maaa 144,96,92
buffer_load_dwordx4 v9, s[8:11], s50 offen offset:2048 lds
Maaa 148,100,92
Maaa 152,104,92
Maaa 156,108,92
Maaa 160,112,92
buffer_load_dwordx4 v9, s[8:11], s51 offen offset:3072 lds
Maaa 164,116,92
v_add_u32 v8, 524288, v8
v_add_u32 v9, 524288, v9
Maaa 168,120,92
Maaa 172,124,92
s_waitcnt lgkmcnt(0)
Mvaa 48,32,0
Mvaa 52,36,0
Ta 96,22,16384
Ta 98,22,18432
Mvaa 56,40,0
Mvaa 60,44,0
Ra 64,21,0
Mvaa 64,48,0
Mvaa 68,52,0
Ta 100,23,16384
Ta 102,23,18432
Mvaa 72,56,0
Mvaa 76,60,0
s_waitcnt lgkmcnt(6)
Ra 68,21,2048
Mvaa 80,32,4
Mvaa 84,36,4
Ta 104,24,16384
Ta 106,24,18432
Mvaa 88,40,4
Mvaa 92,44,4
Ra 72,21,4096
Mvaa 96,48,4
Mvaa 100,52,4
Ta 108,25,16384
Ta 110,25,18432
Mvaa 104,56,4
Mvaa 108,60,4
s_waitcnt lgkmcnt(6)
Ra 76,21,6144
Mvaa 112,32,8
Mvaa 116,36,8
Ta 112,26,16384
Ta 114,26,18432
Mvaa 120,40,8
Mvaa 124,44,8
Ra 80,21,8192
Mvaa 128,48,8
Mvaa 132,52,8
Ta 116,27,16384
Ta 118,27,18432
Mvaa 136,56,8
Mvaa 140,60,8
s_waitcnt lgkmcnt(6)
Ra 84,21,10240
Mvaa 144,32,12
Mvaa 148,36,12
Ta 120,28,16384
Ta 122,28,18432
Mvaa 152,40,12
Mvaa 156,44,12
Ra 88,21,12288
Mvaa 160,48,12
Mvaa 164,52,12
Ta 124,29,16384
Ta 126,29,18432
Mvaa 168,56,12
Mvaa 172,60,12
s_waitcnt lgkmcnt(6)
Ra 92,21,14336
Mvaa 176,32,16
Mvaa 180,36,16
Mvaa 184,40,16
Mvaa 188,44,16
Mvaa 192,48,16
Mvaa 196,52,16
Mvaa 200,56,16
Mvaa 204,60,16
Mvaa 208,32,20
Mvaa 212,36,20
Mvaa 216,40,20
Mvaa 220,44,20
Mvaa 224,48,20
Mvaa 228,52,20
Mvaa 232,56,20
Mvaa 236,60,20
Mvaa 240,32,24
Mvaa 244,36,24
Mvaa 248,40,24
Mvaa 252,44,24
Maaa 128,48,24
Maaa 132,52,24
Maaa 136,56,24
Maaa 140,60,24
Maaa 144,32,28
Maaa 148,36,28
Maaa 152,40,28
Maaa 156,44,28
Maaa 160,48,28
Maaa 164,52,28
Maaa 168,56,28
Maaa 172,60,28
s_waitcnt vmcnt(12) lgkmcnt(0)
v_readfirstlane_b32 s3, v30
s_nop 0
s_or_b32 s3, s3, s37
s_cmp_lt_u32 s3, 256
s_cbranch_scc1 L_spinAk
L_spinArk:
s_barrier
Mvaa 48,96,64
buffer_load_dwordx4 a[0:3], v10, s[20:23], s58 offen offset:0 sc1
Mvaa 52,100,64
v_lshrrev_b32_e64 v42, 2, v33
v_lshl_add_u32 v43, v32, 3, v42
Mvaa 56,104,64
v_lshlrev_b32 v43, 8, v43
v_and_b32 v44, 3, v0
Mvaa 60,108,64
v_lshl_add_u32 v43, v44, 3, v43
v_and_b32_e64 v44, 1, v32
Mvaa 64,112,64
buffer_load_dwordx4 a[4:7], v10, s[20:23], 0 offen offset:0 sc1
Mvaa 68,116,64
v_lshl_add_u32 v42, v44, 2, v42
v_xor_b32_e64 v44, 0, v42
Mvaa 72,120,64
v_lshl_add_u32 v16, v44, 5, v43
v_xor_b32_e64 v44, 1, v42
Mvaa 76,124,64
v_lshl_add_u32 v17, v44, 5, v43
v_xor_b32_e64 v44, 2, v42
Mvaa 80,96,68
buffer_load_dwordx4 a[8:11], v11, s[20:23], s58 offen offset:0 sc1
Mvaa 84,100,68
v_lshl_add_u32 v18, v44, 5, v43
v_xor_b32_e64 v44, 3, v42
Mvaa 88,104,68
v_lshl_add_u32 v19, v44, 5, v43
v_xor_b32_e64 v44, 4, v42
Mvaa 92,108,68
v_lshl_add_u32 v20, v44, 5, v43
v_xor_b32_e64 v44, 5, v42
Mvaa 96,112,68
buffer_load_dwordx4 a[12:15], v11, s[20:23], 0 offen offset:0 sc1
Mvaa 100,116,68
v_lshl_add_u32 v21, v44, 5, v43
v_xor_b32_e64 v44, 6, v42
Mvaa 104,120,68
v_lshl_add_u32 v22, v44, 5, v43
v_xor_b32_e64 v44, 7, v42
Mvaa 108,124,68
v_lshl_add_u32 v23, v44, 5, v43
Mvaa 112,96,72
buffer_load_dwordx4 a[16:19], v10, s[20:23], s58 offen offset:1024 sc1
Mvaa 116,100,72
Mvaa 120,104,72
Mvaa 124,108,72
Mvaa 128,112,72
buffer_load_dwordx4 a[20:23], v10, s[20:23], 0 offen offset:1024 sc1
Mvaa 132,116,72
Ta 192,16,0
Ta 194,16,1024
Mvaa 136,120,72
Ta 196,17,0
Ta 198,17,1024
Mvaa 140,124,72
Ta 200,18,0
Ta 202,18,1024
Mvaa 144,96,76
buffer_load_dwordx4 a[24:27], v11, s[20:23], s58 offen offset:1024 sc1
Mvaa 148,100,76
Ta 204,19,0
Ta 206,19,1024
Mvaa 152,104,76
Ta 208,20,0
Ta 210,20,1024
Mvaa 156,108,76
Ta 212,21,0
Ta 214,21,1024
Mvaa 160,112,76
buffer_load_dwordx4 a[28:31], v11, s[20:23], 0 offen offset:1024 sc1
Mvaa 164,116,76
Ta 216,22,0
Ta 218,22,1024
Mvaa 168,120,76
Ta 220,23,0
s_waitcnt lgkmcnt(9)
Ta 222,23,1024
Mvaa 172,124,76
s_waitcnt lgkmcnt(8)
Vc 24,48,49
Vc 25,50,51
Mvaa 176,96,80
buffer_load_dwordx4 a[32:35], v10, s[20:23], s58 offen offset:2048 sc1
Mvaa 180,100,80
Vc 26,52,53
Vc 27,54,55
Mvaa 184,104,80
Vc 28,56,57
Vc 29,58,59
Mvaa 188,108,80
Vc 30,60,61
Vc 31,62,63
Mvaa 192,112,80
buffer_load_dwordx4 a[36:39], v10, s[20:23], 0 offen offset:2048 sc1
Mvaa 196,116,80
Vc 32,64,65
Vc 33,66,67
Mvaa 200,120,80
Vc 34,68,69
Vc 35,70,71
Mvaa 204,124,80
Vc 36,72,73
Vc 37,74,75
Mvaa 208,96,84
buffer_load_dwordx4 a[40:43], v11, s[20:23], s58 offen offset:2048 sc1
Mvaa 212,100,84
Vc 38,76,77
Vc 39,78,79
Mvaa 216,104,84
Vc 40,80,81
Vc 41,82,83
Mvaa 220,108,84
Vc 42,84,85
Vc 43,86,87
Mvaa 224,112,84
buffer_load_dwordx4 a[44:47], v11, s[20:23], 0 offen offset:2048 sc1
Mvaa 228,116,84
Vc 44,88,89
Vc 45,90,91
Mvaa 232,120,84
Vc 46,92,93
Vc 47,94,95
Mvaa 236,124,84
Vc 48,96,97
Vc 49,98,99
Mvaa 240,96,88
buffer_load_dwordx4 a[48:51], v10, s[20:23], s58 offen offset:3072 sc1
Mvaa 244,100,88
Vc 50,100,101
Vc 51,102,103
Mvaa 248,104,88
Vc 52,104,105
Vc 53,106,107
Mvaa 252,108,88
Vc 54,108,109
Vc 55,110,111
Maaa 128,112,88
buffer_load_dwordx4 a[52:55], v10, s[20:23], 0 offen offset:3072 sc1
Maaa 132,116,88
Vc 56,112,113
Vc 57,114,115
Maaa 136,120,88
Vc 58,116,117
Vc 59,118,119
Maaa 140,124,88
Vc 60,120,121
Vc 61,122,123
Maaa 144,96,92
buffer_load_dwordx4 a[56:59], v11, s[20:23], s58 offen offset:3072 sc1
Maaa 148,100,92
Vc 62,124,125
Vc 63,126,127
Maaa 152,104,92
Vc 64,128,129
Vc 65,130,131
Maaa 156,108,92
Vc 66,132,133
Vc 67,134,135
Maaa 160,112,92
buffer_load_dwordx4 a[60:63], v11, s[20:23], 0 offen offset:3072 sc1
Maaa 164,116,92
v_add_u32 v10, 4096, v10
v_add_u32 v11, 4096, v11
Maaa 168,120,92
Vc 68,136,137
Vc 69,138,139
Maaa 172,124,92
Vc 70,140,141
Vc 71,142,143
Vc 72,144,145
Vc 73,146,147
Vc 74,148,149
Vc 75,150,151
Vc 76,152,153
Vc 77,154,155
Vc 78,156,157
Vc 79,158,159
Vc 80,160,161
Vc 81,162,163
Vc 82,164,165
Vc 83,166,167
Vc 84,168,169
Vc 85,170,171
Vc 86,172,173
Vc 87,174,175
Vc 88,176,177
Vc 89,178,179
Vc 90,180,181
Vc 91,182,183
Vc 92,184,185
Vc 93,186,187
Vc 94,188,189
Vc 95,190,191
Vc 96,192,193
Vc 97,194,195
Vc 98,196,197
Vc 99,198,199
Vc 100,200,201
Vc 101,202,203
Vc 102,204,205
Vc 103,206,207
Vc 104,208,209
Vc 105,210,211
Vc 106,212,213
Vc 107,214,215
Vc 108,216,217
Vc 109,218,219
Vc 110,220,221
Vc 111,222,223
Vc 112,224,225
Vc 113,226,227
Vc 114,228,229
Vc 115,230,231
Vc 116,232,233
Vc 117,234,235
Vc 118,236,237
Vc 119,238,239
Vc 120,240,241
Vc 121,242,243
Vc 122,244,245
Vc 123,246,247
Vc 124,248,249
Vc 125,250,251
Vc 126,252,253
Vc 127,254,255
s_branch L_phase2
L_k1_vpath:
s_waitcnt lgkmcnt(0)
s_add_u32 m0, s57, 65536
Zvaa 48,0,32
buffer_load_dwordx4 v6, s[12:15], s52 offen offset:0 nt lds
Zvaa 64,0,36
Ta 96,12,16384
Ta 98,12,18432
Zvaa 80,0,40
buffer_load_dwordx4 v7, s[12:15], s53 offen offset:1024 nt lds
Zvaa 96,0,44
Ra 64,11,0
Zvaa 112,0,48
buffer_load_dwordx4 v6, s[12:15], s54 offen offset:2048 nt lds
Zvaa 128,0,52
Ta 100,13,16384
Ta 102,13,18432
Zvaa 144,0,56
buffer_load_dwordx4 v7, s[12:15], s55 offen offset:3072 nt lds
Zvaa 160,0,60
s_add_u32 m0, s57, 69632
s_waitcnt lgkmcnt(6)
Ra 68,11,2048
Zvaa 52,4,32
buffer_load_dwordx4 v8, s[12:15], s52 offen offset:0 nt lds
Zvaa 68,4,36
Ta 104,14,16384
Ta 106,14,18432
Zvaa 84,4,40
buffer_load_dwordx4 v9, s[12:15], s53 offen offset:1024 nt lds
Zvaa 100,4,44
Ra 72,11,4096
Zvaa 116,4,48
buffer_load_dwordx4 v8, s[12:15], s54 offen offset:2048 nt lds
Zvaa 132,4,52
Ta 108,15,16384
Ta 110,15,18432
Zvaa 148,4,56
buffer_load_dwordx4 v9, s[12:15], s55 offen offset:3072 nt lds
Zvaa 164,4,60
s_add_u32 m0, s56, 65536
s_waitcnt lgkmcnt(6)
Ra 76,11,6144
Zvaa 56,8,32
buffer_load_dwordx4 v2, s[8:11], s48 offen offset:0 lds
Zvaa 72,8,36
Ta 112,16,16384
Ta 114,16,18432
Zvaa 88,8,40
buffer_load_dwordx4 v3, s[8:11], s49 offen offset:1024 lds
Zvaa 104,8,44
Ra 80,11,8192
v_xor_b32 v6, 1572864, v6
Zvaa 120,8,48
buffer_load_dwordx4 v2, s[8:11], s50 offen offset:2048 lds
Zvaa 136,8,52
Ta 116,17,16384
Ta 118,17,18432
Zvaa 152,8,56
buffer_load_dwordx4 v3, s[8:11], s51 offen offset:3072 lds
Zvaa 168,8,60
s_add_u32 m0, s56, 69632
s_waitcnt lgkmcnt(6)
Ra 84,11,10240
Zvaa 60,12,32
buffer_load_dwordx4 v4, s[8:11], s48 offen offset:0 lds
Zvaa 76,12,36
Ta 120,18,16384
Ta 122,18,18432
Zvaa 92,12,40
buffer_load_dwordx4 v5, s[8:11], s49 offen offset:1024 lds
Zvaa 108,12,44
Ra 88,11,12288
v_xor_b32 v7, 1572864, v7
Zvaa 124,12,48
buffer_load_dwordx4 v4, s[8:11], s50 offen offset:2048 lds
Zvaa 140,12,52
Ta 124,19,16384
Ta 126,19,18432
Zvaa 156,12,56
buffer_load_dwordx4 v5, s[8:11], s51 offen offset:3072 lds
Zvaa 172,12,60
s_waitcnt lgkmcnt(6)
Ra 92,11,14336
Zvaa 176,16,32
v_and_b32_e64 v46, 7, v0
v_mul_u32_u24 v30, 2064, v46
Zvaa 192,16,36
v_xor_b32 v8, 1572864, v8
v_xor_b32 v9, 1572864, v9
Zvaa 208,16,40
v_lshrrev_b32_e64 v31, 3, v0
Zvaa 224,16,44
v_xor_b32 v2, 384, v2
v_xor_b32 v3, 384, v3
Zvaa 240,16,48
s_lshl_b32 s3, s32, 9
s_add_u32 s3, s3, 131072
v_lshl_add_u32 v30, v31, 4, v30
Zaaa 128,16,52
v_xor_b32 v4, 384, v4
v_xor_b32 v5, 384, v5
Zaaa 144,16,56
v_add_u32 v30, s3, v30
v_lshlrev_b32_e64 v31, 8, v31
Zaaa 160,16,60
v_lshl_add_u32 v46, v46, 4, v31
Zvaa 180,20,32
buffer_load_dword v1, v47, s[60:63], 0 offen
Zvaa 196,20,36
s_mul_i32 vcc_lo, s59, 7
v_xor_b32 v47, vcc_lo, v47
Zvaa 212,20,40
Rv 34,30,128
Rv 38,30,256
Zvaa 228,20,44
Rv 42,30,384
Rv 30,30,0
Zvaa 244,20,48
buffer_load_dword v1, v47, s[60:63], 0 offen
Zaaa 132,20,52
s_mul_i32 vcc_lo, s59, 1
v_xor_b32 v47, vcc_lo, v47
Zaaa 148,20,56
s_lshr_b32 s3, s2, 1
s_mul_i32 s3, s3, 33792
s_add_u32 s3, s3, s56
Zaaa 164,20,60
s_and_b32 s39, s2, 1
s_lshl_b32 s39, s39, 7
s_add_u32 s3, s3, s39
Zvaa 184,24,32
s_add_u32 s39, s3, 4096
Zvaa 200,24,36
Zvaa 216,24,40
Zvaa 232,24,44
Zvaa 248,24,48
Zaaa 136,24,52
Zaaa 152,24,56
Zaaa 168,24,60
Zvaa 188,28,32
Zvaa 204,28,36
Zvaa 220,28,40
Zvaa 236,28,44
Zvaa 252,28,48
Zaaa 140,28,52
Zaaa 156,28,56
Zaaa 172,28,60
s_waitcnt vmcnt(2) lgkmcnt(0)
s_add_u32 m0, s57, 0
s_barrier
Mvaa 48,64,96
buffer_load_dwordx4 v6, s[12:15], s52 offen offset:0 nt lds
Mvaa 64,64,100
Ta 32,22,0
Ta 34,22,2048
Mvaa 80,64,104
Mvaa 96,64,108
Ra 0,20,0
Mvaa 112,64,112
buffer_load_dwordx4 v7, s[12:15], s53 offen offset:1024 nt lds
Mvaa 128,64,116
s_waitcnt lgkmcnt(6)
Ta 36,23,0
Ta 38,23,2048
Mvaa 144,64,120
Mvaa 160,64,124
Ra 4,20,2048
Mvaa 52,68,96
buffer_load_dwordx4 v6, s[12:15], s54 offen offset:2048 nt lds
Mvaa 68,68,100
Ta 40,24,0
Ta 42,24,2048
Mvaa 84,68,104
Mvaa 100,68,108
Ra 8,20,4096
Mvaa 116,68,112
buffer_load_dwordx4 v7, s[12:15], s55 offen offset:3072 nt lds
Mvaa 132,68,116
s_waitcnt lgkmcnt(6)
Ta 44,25,0
Ta 46,25,2048
Mvaa 148,68,120
Mvaa 164,68,124
s_add_u32 m0, s57, 4096
Ra 12,20,6144
Mvaa 56,72,96
buffer_load_dwordx4 v8, s[12:15], s52 offen offset:0 nt lds
Mvaa 72,72,100
Ta 48,26,0
Ta 50,26,2048
Mvaa 88,72,104
Mvaa 104,72,108
Ra 16,20,8192
Mvaa 120,72,112
buffer_load_dwordx4 v9, s[12:15], s53 offen offset:1024 nt lds
Mvaa 136,72,116
s_waitcnt lgkmcnt(6)
Ta 52,27,0
Ta 54,27,2048
Mvaa 152,72,120
Mvaa 168,72,124
Ra 20,20,10240
Mvaa 60,76,96
buffer_load_dwordx4 v8, s[12:15], s54 offen offset:2048 nt lds
Mvaa 76,76,100
Ta 56,28,0
Ta 58,28,2048
Mvaa 92,76,104
Mvaa 108,76,108
Ra 24,20,12288
Mvaa 124,76,112
buffer_load_dwordx4 v9, s[12:15], s55 offen offset:3072 nt lds
Mvaa 140,76,116
s_waitcnt lgkmcnt(6)
Ta 60,29,0
Ta 62,29,2048
Mvaa 156,76,120
v_xor_b32 v6, 524288, v6
v_xor_b32 v7, 524288, v7
Mvaa 172,76,124
s_add_u32 m0, s56, 0
Ra 28,20,14336
v_xor_b32 v8, 524288, v8
Mvaa 176,80,96
buffer_load_dwordx4 v2, s[8:11], s48 offen offset:0 lds
Mvaa 192,80,100
v_xor_b32 v9, 524288, v9
Mvaa 208,80,104
Mvaa 224,80,108
Mvaa 240,80,112
buffer_load_dwordx4 v3, s[8:11], s49 offen offset:1024 lds
Maaa 128,80,116
Maaa 144,80,120
Maaa 160,80,124
Mvaa 180,84,96
buffer_load_dwordx4 v2, s[8:11], s50 offen offset:2048 lds
Mvaa 196,84,100
Mvaa 212,84,104
Mvaa 228,84,108
Mvaa 244,84,112
buffer_load_dwordx4 v3, s[8:11], s51 offen offset:3072 lds
Maaa 132,84,116
Maaa 148,84,120
Maaa 164,84,124
s_add_u32 m0, s56, 4096
Mvaa 184,88,96
buffer_load_dwordx4 v4, s[8:11], s48 offen offset:0 lds
Mvaa 200,88,100
Mvaa 216,88,104
Mvaa 232,88,108
Mvaa 248,88,112
buffer_load_dwordx4 v5, s[8:11], s49 offen offset:1024 lds
Maaa 136,88,116
Maaa 152,88,120
Maaa 168,88,124
Mvaa 188,92,96
buffer_load_dwordx4 v4, s[8:11], s50 offen offset:2048 lds
Mvaa 204,92,100
Mvaa 220,92,104
Mvaa 236,92,108
Mvaa 252,92,112
buffer_load_dwordx4 v5, s[8:11], s51 offen offset:3072 lds
Maaa 140,92,116
v_xor_b32 v2, 128, v2
v_xor_b32 v3, 128, v3
Maaa 156,92,120
buffer_load_dword v1, v47, s[60:63], 0 offen
v_xor_b32 v4, 128, v4
v_xor_b32 v5, 128, v5
Maaa 172,92,124
s_mul_i32 vcc_lo, s59, 3
v_xor_b32 v47, vcc_lo, v47
s_waitcnt lgkmcnt(0)
Mvaa 48,0,32
buffer_store_dwordx4 v[30:33], v46, s[20:23], s3 offen offset:0 sc1
Mvaa 64,0,36
Ta 96,22,16384
Ta 98,22,18432
Mvaa 80,0,40
buffer_store_dwordx4 v[34:37], v46, s[20:23], s3 offen offset:2048 sc1
Mvaa 96,0,44
Ra 64,21,0
Mvaa 112,0,48
buffer_store_dwordx4 v[38:41], v46, s[20:23], s39 offen offset:0 sc1
Mvaa 128,0,52
Ta 100,23,16384
Ta 102,23,18432
Mvaa 144,0,56
buffer_store_dwordx4 v[42:45], v46, s[20:23], s39 offen offset:2048 sc1
Mvaa 160,0,60
s_waitcnt lgkmcnt(6)
Ra 68,21,2048
Mvaa 52,4,32
s_lshl_b32 s3, s34, 1
s_and_b32 s36, s32, 1
s_add_u32 s3, s3, s36
Mvaa 68,4,36
Ta 104,24,16384
Ta 106,24,18432
Mvaa 84,4,40
s_mul_i32 s3, s3, 1116160
s_mul_i32 s36, s33, 139264
s_add_u32 s3, s3, s36
Mvaa 100,4,44
Ra 72,21,4096
Mvaa 116,4,48
s_lshr_b32 s36, s32, 1
s_mul_i32 s36, s36, 69632
s_add_u32 s3, s3, s36
Mvaa 132,4,52
Ta 108,25,16384
Ta 110,25,18432
Mvaa 148,4,56
s_add_u32 s38, s3, 17408
s_lshl_b32 s39, s34, 7
s_lshl_b32 s36, s33, 2
Mvaa 164,4,60
s_waitcnt lgkmcnt(6)
Ra 76,21,6144
Mvaa 56,8,32
s_add_u32 s39, s39, s36
s_add_u32 s39, s39, 5296160
v_mov_b32 v30, 1
Mvaa 72,8,36
Ta 112,26,16384
Ta 114,26,18432
Mvaa 88,8,40
v_mov_b32_e64 v31, 0
Mvaa 104,8,44
Ra 80,21,8192
Mvaa 120,8,48
s_cmp_eq_u32 s32, 0
s_cselect_b32 s39, s39, 2146435072
Mvaa 136,8,52
Ta 116,27,16384
Ta 118,27,18432
Mvaa 152,8,56
s_mov_b64 exec, 1
buffer_store_dword v31, v31, s[20:23], s39 offen sc1
s_mov_b64 exec, -1
Mvaa 168,8,60
s_waitcnt lgkmcnt(6)
Ra 84,21,10240
Mvaa 60,12,32
s_and_b32 s33, s2, 7
s_lshl_b32 s33, s33, 2
s_bfe_u32 s3, s2, 0x20003
Mvaa 76,12,36
Ta 120,28,16384
Ta 122,28,18432
Mvaa 92,12,40
s_add_u32 s33, s33, s3
s_lshr_b32 s34, s2, 5
s_lshl_b32 s64, s34, 7
Mvaa 108,12,44
Ra 88,21,12288
Mvaa 124,12,48
s_lshl_b32 s3, s33, 2
s_add_u32 s64, s64, s3
s_add_u32 s64, s64, 5300224
Mvaa 140,12,52
Ta 124,29,16384
Ta 126,29,18432
Mvaa 156,12,56
s_lshl_b32 s65, s34, 8
s_sub_u32 s65, 1920, s65
v_mul_u32_u24_e64 v32, s65, v0
Mvaa 172,12,60
s_waitcnt lgkmcnt(6)
Ra 92,21,14336
Mvaa 176,16,32
s_cmp_eq_u32 s32, 0
s_cselect_b32 s64, s64, 2146435072
Mvaa 192,16,36
s_mov_b64 exec, 3
buffer_store_dword v31, v32, s[20:23], s64 offen sc1
s_mov_b64 exec, -1
Mvaa 208,16,40
s_lshl_b32 s3, s2, 2
s_add_u32 s3, s3, 5447680
v_lshlrev_b32 v32, 10, v0
Mvaa 224,16,44
s_cmp_eq_u32 s32, 0
s_cselect_b32 s3, s3, 2146435072
Mvaa 240,16,48
s_mov_b64 exec, 0x1ff
buffer_store_dword v31, v32, s[20:23], s3 offen sc1
s_mov_b64 exec, -1
Maaa 128,16,52
s_lshl_b32 s35, s34, 1
s_sub_u32 s36, 32, s35
s_add_u32 s35, s35, 2
Maaa 144,16,56
s_lshl_b32 s44, s32, 12
s_lshl_b32 s58, s32, 1
s_sub_u32 s58, 7, s58
Maaa 160,16,60
s_mul_i32 s58, s58, 33792
s_sub_u32 s3, 15, s34
s_lshl_b32 s45, s3, 3
Mvaa 180,20,32
s_add_u32 s45, s45, s32
s_lshl_b32 s46, s34, 3
s_add_u32 s46, s46, s32
Mvaa 196,20,36
s_mov_b32 s68, s42
s_and_b32 s69, s43, 0xffff
s_mov_b32 s70, 7340032
Mvaa 212,20,40
s_mov_b32 s71, 0x20000
s_cmp_eq_u32 s32, 0
s_cselect_b32 s37, 0, 2146435072
Mvaa 228,20,44
s_lshl_b32 s3, s33, 8
s_add_u32 s16, s4, s3
s_addc_u32 s17, s5, 0
s_and_b32 s17, s17, 0xffff
Mvaa 244,20,48
s_mov_b32 s18, 0
s_mov_b32 s19, 0x20000
s_sub_u32 s18, 8388608, s3
Maaa 132,20,52
v_and_b32 v33, 15, v0
v_lshrrev_b32_e64 v32, 1, v33
Maaa 148,20,56
v_and_b32 v33, 1, v0
v_lshlrev_b32 v32, 13, v32
Maaa 164,20,60
v_lshl_add_u32 v45, v33, 7, v32
Mvaa 184,24,32
s_lshl_b32 s3, s32, 3
s_add_u32 s3, s3, s34
s_mul_i32 s47, s3, 65536
Mvaa 200,24,36
s_bfe_u32 s6, s2, 131075
s_lshl_b32 s3, s32, 8
s_or_b32 s6, s6, s3
Mvaa 216,24,40
Mvaa 232,24,44
Mvaa 248,24,48
Maaa 136,24,52
Maaa 152,24,56
Maaa 168,24,60
Mvaa 188,28,32
Mvaa 204,28,36
Mvaa 220,28,40
Mvaa 236,28,44
Mvaa 252,28,48
Maaa 140,28,52
Maaa 156,28,56
Maaa 172,28,60
s_waitcnt vmcnt(8) lgkmcnt(0)
s_add_u32 m0, s57, 65536
s_barrier
Mvaa 48,64,96
buffer_load_dwordx4 v6, s[12:15], s52 offen offset:0 nt lds
Mvaa 64,64,100
Ta 32,12,0
Ta 34,12,2048
Mvaa 80,64,104
Mvaa 96,64,108
Ra 0,10,0
Mvaa 112,64,112
buffer_load_dwordx4 v7, s[12:15], s53 offen offset:1024 nt lds
Mvaa 128,64,116
s_waitcnt lgkmcnt(6)
Ta 36,13,0
Ta 38,13,2048
Mvaa 144,64,120
Mvaa 160,64,124
Ra 4,10,2048
Mvaa 52,68,96
buffer_load_dwordx4 v6, s[12:15], s54 offen offset:2048 nt lds
Mvaa 68,68,100
Ta 40,14,0
Ta 42,14,2048
Mvaa 84,68,104
Mvaa 100,68,108
Ra 8,10,4096
Mvaa 116,68,112
buffer_load_dwordx4 v7, s[12:15], s55 offen offset:3072 nt lds
Mvaa 132,68,116
s_waitcnt lgkmcnt(6)
Ta 44,15,0
Ta 46,15,2048
Mvaa 148,68,120
Mvaa 164,68,124
s_add_u32 m0, s57, 69632
Ra 12,10,6144
Mvaa 56,72,96
buffer_load_dwordx4 v8, s[12:15], s52 offen offset:0 nt lds
Mvaa 72,72,100
Ta 48,16,0
Ta 50,16,2048
Mvaa 88,72,104
Mvaa 104,72,108
Ra 16,10,8192
Mvaa 120,72,112
buffer_load_dwordx4 v9, s[12:15], s53 offen offset:1024 nt lds
Mvaa 136,72,116
s_waitcnt lgkmcnt(6)
Ta 52,17,0
Ta 54,17,2048
Mvaa 152,72,120
Mvaa 168,72,124
Ra 20,10,10240
Mvaa 60,76,96
buffer_load_dwordx4 v8, s[12:15], s54 offen offset:2048 nt lds
Mvaa 76,76,100
Ta 56,18,0
Ta 58,18,2048
Mvaa 92,76,104
Mvaa 108,76,108
Ra 24,10,12288
Mvaa 124,76,112
buffer_load_dwordx4 v9, s[12:15], s55 offen offset:3072 nt lds
Mvaa 140,76,116
s_waitcnt lgkmcnt(6)
Ta 60,19,0
Ta 62,19,2048
Mvaa 156,76,120
v_xor_b32 v6, 3670016, v6
v_xor_b32 v7, 3670016, v7
Mvaa 172,76,124
s_add_u32 m0, s56, 65536
Ra 28,10,14336
v_xor_b32 v8, 3670016, v8
Mvaa 176,80,96
buffer_load_dwordx4 v2, s[8:11], s48 offen offset:0 lds
Mvaa 192,80,100
v_xor_b32 v9, 3670016, v9
Mvaa 208,80,104
Mvaa 224,80,108
Mvaa 240,80,112
buffer_load_dwordx4 v3, s[8:11], s49 offen offset:1024 lds
Maaa 128,80,116
Maaa 144,80,120
Maaa 160,80,124
Mvaa 180,84,96
buffer_load_dwordx4 v2, s[8:11], s50 offen offset:2048 lds
Mvaa 196,84,100
Mvaa 212,84,104
Mvaa 228,84,108
Mvaa 244,84,112
buffer_load_dwordx4 v3, s[8:11], s51 offen offset:3072 lds
Maaa 132,84,116
Maaa 148,84,120
Maaa 164,84,124
s_add_u32 m0, s56, 69632
Mvaa 184,88,96
buffer_load_dwordx4 v4, s[8:11], s48 offen offset:0 lds
Mvaa 200,88,100
Mvaa 216,88,104
Mvaa 232,88,108
Mvaa 248,88,112
buffer_load_dwordx4 v5, s[8:11], s49 offen offset:1024 lds
Maaa 136,88,116
Maaa 152,88,120
Maaa 168,88,124
Mvaa 188,92,96
buffer_load_dwordx4 v4, s[8:11], s50 offen offset:2048 lds
Mvaa 204,92,100
Mvaa 220,92,104
Mvaa 236,92,108
Mvaa 252,92,112
buffer_load_dwordx4 v5, s[8:11], s51 offen offset:3072 lds
Maaa 140,92,116
v_xor_b32 v2, 896, v2
v_xor_b32 v3, 896, v3
Maaa 156,92,120
buffer_load_dword v1, v47, s[60:63], 0 offen
v_xor_b32 v4, 896, v4
v_xor_b32 v5, 896, v5
Maaa 172,92,124
s_mul_i32 vcc_lo, s59, 1
v_xor_b32 v47, vcc_lo, v47
s_waitcnt lgkmcnt(0)
Mvaa 48,0,32
Mvaa 64,0,36
Ta 96,12,16384
Ta 98,12,18432
Mvaa 80,0,40
Mvaa 96,0,44
Ra 64,11,0
Mvaa 112,0,48
Mvaa 128,0,52
Ta 100,13,16384
Ta 102,13,18432
Mvaa 144,0,56
Mvaa 160,0,60
s_waitcnt lgkmcnt(6)
Ra 68,11,2048
Mvaa 52,4,32
Mvaa 68,4,36
Ta 104,14,16384
Ta 106,14,18432
Mvaa 84,4,40
Mvaa 100,4,44
Ra 72,11,4096
Mvaa 116,4,48
Mvaa 132,4,52
Ta 108,15,16384
Ta 110,15,18432
Mvaa 148,4,56
Mvaa 164,4,60
s_waitcnt lgkmcnt(6)
Ra 76,11,6144
Mvaa 56,8,32
Mvaa 72,8,36
Ta 112,16,16384
Ta 114,16,18432
Mvaa 88,8,40
Mvaa 104,8,44
Ra 80,11,8192
Mvaa 120,8,48
Mvaa 136,8,52
Ta 116,17,16384
Ta 118,17,18432
Mvaa 152,8,56
Mvaa 168,8,60
s_waitcnt lgkmcnt(6)
Ra 84,11,10240
Mvaa 60,12,32
Mvaa 76,12,36
Ta 120,18,16384
Ta 122,18,18432
Mvaa 92,12,40
Mvaa 108,12,44
Ra 88,11,12288
Mvaa 124,12,48
Mvaa 140,12,52
Ta 124,19,16384
Ta 126,19,18432
Mvaa 156,12,56
Mvaa 172,12,60
s_waitcnt lgkmcnt(6)
Ra 92,11,14336
Mvaa 176,16,32
Mvaa 192,16,36
Mvaa 208,16,40
Mvaa 224,16,44
Mvaa 240,16,48
Maaa 128,16,52
Maaa 144,16,56
Maaa 160,16,60
Mvaa 180,20,32
Mvaa 196,20,36
Mvaa 212,20,40
Mvaa 228,20,44
Mvaa 244,20,48
Maaa 132,20,52
Maaa 148,20,56
Maaa 164,20,60
Mvaa 184,24,32
Mvaa 200,24,36
Mvaa 216,24,40
Mvaa 232,24,44
Mvaa 248,24,48
Maaa 136,24,52
Maaa 152,24,56
Maaa 168,24,60
Mvaa 188,28,32
Mvaa 204,28,36
Mvaa 220,28,40
Mvaa 236,28,44
Mvaa 252,28,48
Maaa 140,28,52
Maaa 156,28,56
Maaa 172,28,60
s_waitcnt vmcnt(1) lgkmcnt(0)
s_add_u32 m0, s57, 0
s_barrier
Mvaa 48,64,96
buffer_load_dwordx4 v6, s[12:15], s52 offen offset:0 nt lds
Mvaa 64,64,100
Ta 32,22,0
Ta 34,22,2048
Mvaa 80,64,104
Mvaa 96,64,108
Ra 0,20,0
Mvaa 112,64,112
buffer_load_dwordx4 v7, s[12:15], s53 offen offset:1024 nt lds
Mvaa 128,64,116
s_waitcnt lgkmcnt(6)
Ta 36,23,0
Ta 38,23,2048
Mvaa 144,64,120
Mvaa 160,64,124
Ra 4,20,2048
Mvaa 52,68,96
buffer_load_dwordx4 v6, s[12:15], s54 offen offset:2048 nt lds
Mvaa 68,68,100
Ta 40,24,0
Ta 42,24,2048
Mvaa 84,68,104
Mvaa 100,68,108
Ra 8,20,4096
Mvaa 116,68,112
buffer_load_dwordx4 v7, s[12:15], s55 offen offset:3072 nt lds
Mvaa 132,68,116
s_waitcnt lgkmcnt(6)
Ta 44,25,0
Ta 46,25,2048
Mvaa 148,68,120
s_cmp_eq_u32 s6, 0
s_cselect_b32 s3, 0, 2146435072
Mvaa 164,68,124
s_add_u32 m0, s57, 4096
Ra 12,20,6144
Mvaa 56,72,96
buffer_load_dwordx4 v8, s[12:15], s52 offen offset:0 nt lds
Mvaa 72,72,100
Ta 48,26,0
Ta 50,26,2048
Mvaa 88,72,104
s_mov_b64 exec, 1
buffer_atomic_add v30, v31, s[28:31], s3 offen sc1
s_mov_b64 exec, -1
Mvaa 104,72,108
Ra 16,20,8192
Mvaa 120,72,112
buffer_load_dwordx4 v9, s[12:15], s53 offen offset:1024 nt lds
Mvaa 136,72,116
s_waitcnt lgkmcnt(6)
Ta 52,27,0
Ta 54,27,2048
Mvaa 152,72,120
Mvaa 168,72,124
Ra 20,20,10240
Mvaa 60,76,96
buffer_load_dwordx4 v8, s[12:15], s54 offen offset:2048 nt lds
Mvaa 76,76,100
Ta 56,28,0
Ta 58,28,2048
Mvaa 92,76,104
Mvaa 108,76,108
Ra 24,20,12288
Mvaa 124,76,112
buffer_load_dwordx4 v9, s[12:15], s55 offen offset:3072 nt lds
Mvaa 140,76,116
s_waitcnt lgkmcnt(6)
Ta 60,29,0
Ta 62,29,2048
Mvaa 156,76,120
v_xor_b32 v6, 524288, v6
v_xor_b32 v7, 524288, v7
Mvaa 172,76,124
s_add_u32 m0, s56, 0
Ra 28,20,14336
v_xor_b32 v8, 524288, v8
Mvaa 176,80,96
buffer_load_dwordx4 v2, s[8:11], s48 offen offset:0 lds
Mvaa 192,80,100
v_xor_b32 v9, 524288, v9
Mvaa 208,80,104
Mvaa 224,80,108
Mvaa 240,80,112
buffer_load_dwordx4 v3, s[8:11], s49 offen offset:1024 lds
Maaa 128,80,116
Maaa 144,80,120
Maaa 160,80,124
Mvaa 180,84,96
buffer_load_dwordx4 v2, s[8:11], s50 offen offset:2048 lds
Mvaa 196,84,100
Mvaa 212,84,104
Mvaa 228,84,108
Mvaa 244,84,112
buffer_load_dwordx4 v3, s[8:11], s51 offen offset:3072 lds
Maaa 132,84,116
Maaa 148,84,120
Maaa 164,84,124
s_add_u32 m0, s56, 4096
Mvaa 184,88,96
buffer_load_dwordx4 v4, s[8:11], s48 offen offset:0 lds
Mvaa 200,88,100
Mvaa 216,88,104
Mvaa 232,88,108
Mvaa 248,88,112
buffer_load_dwordx4 v5, s[8:11], s49 offen offset:1024 lds
Maaa 136,88,116
Maaa 152,88,120
Maaa 168,88,124
Mvaa 188,92,96
buffer_load_dwordx4 v4, s[8:11], s50 offen offset:2048 lds
Mvaa 204,92,100
Mvaa 220,92,104
Mvaa 236,92,108
Mvaa 252,92,112
buffer_load_dwordx4 v5, s[8:11], s51 offen offset:3072 lds
Maaa 140,92,116
v_xor_b32 v2, 128, v2
v_xor_b32 v3, 128, v3
Maaa 156,92,120
buffer_load_dword v1, v47, s[60:63], 0 offen
v_xor_b32 v4, 128, v4
v_xor_b32 v5, 128, v5
Maaa 172,92,124
s_mul_i32 vcc_lo, s59, 7
v_xor_b32 v47, vcc_lo, v47
s_waitcnt lgkmcnt(0)
Mvaa 48,0,32
buffer_load_dword v44, v45, s[16:19], s47 offen
Mvaa 64,0,36
Ta 96,22,16384
Ta 98,22,18432
Mvaa 80,0,40
s_add_u32 s47, s47, 2097152
Mvaa 96,0,44
Ra 64,21,0
Mvaa 112,0,48
Mvaa 128,0,52
Ta 100,23,16384
Ta 102,23,18432
Mvaa 144,0,56
Mvaa 160,0,60
s_waitcnt lgkmcnt(6)
Ra 68,21,2048
Mvaa 52,4,32
Mvaa 68,4,36
Ta 104,24,16384
Ta 106,24,18432
Mvaa 84,4,40
Mvaa 100,4,44
Ra 72,21,4096
Mvaa 116,4,48
Mvaa 132,4,52
Ta 108,25,16384
Ta 110,25,18432
Mvaa 148,4,56
Mvaa 164,4,60
s_waitcnt lgkmcnt(6)
Ra 76,21,6144
Mvaa 56,8,32
Mvaa 72,8,36
Ta 112,26,16384
Ta 114,26,18432
Mvaa 88,8,40
Mvaa 104,8,44
Ra 80,21,8192
Mvaa 120,8,48
Mvaa 136,8,52
Ta 116,27,16384
Ta 118,27,18432
Mvaa 152,8,56
Mvaa 168,8,60
s_waitcnt lgkmcnt(6)
Ra 84,21,10240
Mvaa 60,12,32
Mvaa 76,12,36
Ta 120,28,16384
Ta 122,28,18432
Mvaa 92,12,40
s_cmp_eq_u32 s6, 1
s_cselect_b32 s3, 0, 2146435072
Mvaa 108,12,44
Ra 88,21,12288
Mvaa 124,12,48
s_mov_b64 exec, 1
buffer_atomic_add v30, v31, s[28:31], s3 offen sc1
s_mov_b64 exec, -1
Mvaa 140,12,52
Ta 124,29,16384
Ta 126,29,18432
Mvaa 156,12,56
Mvaa 172,12,60
s_waitcnt lgkmcnt(6)
Ra 92,21,14336
Mvaa 176,16,32
Mvaa 192,16,36
Mvaa 208,16,40
Mvaa 224,16,44
Mvaa 240,16,48
Maaa 128,16,52
Maaa 144,16,56
Maaa 160,16,60
Mvaa 180,20,32
Mvaa 196,20,36
Mvaa 212,20,40
Mvaa 228,20,44
Mvaa 244,20,48
Maaa 132,20,52
Maaa 148,20,56
Maaa 164,20,60
Mvaa 184,24,32
Mvaa 200,24,36
Mvaa 216,24,40
Mvaa 232,24,44
Mvaa 248,24,48
Maaa 136,24,52
Maaa 152,24,56
Maaa 168,24,60
Mvaa 188,28,32
Mvaa 204,28,36
Mvaa 220,28,40
Mvaa 236,28,44
Mvaa 252,28,48
Maaa 140,28,52
Maaa 156,28,56
Maaa 172,28,60
s_waitcnt vmcnt(3) lgkmcnt(0)
s_add_u32 m0, s57, 65536
s_barrier
Mvaa 48,64,96
buffer_load_dwordx4 v6, s[12:15], s52 offen offset:0 nt lds
Mvaa 64,64,100
Ta 32,12,0
Ta 34,12,2048
Mvaa 80,64,104
Mvaa 96,64,108
Ra 0,10,0
Mvaa 112,64,112
buffer_load_dwordx4 v7, s[12:15], s53 offen offset:1024 nt lds
Mvaa 128,64,116
s_waitcnt lgkmcnt(6)
Ta 36,13,0
Ta 38,13,2048
Mvaa 144,64,120
Mvaa 160,64,124
Ra 4,10,2048
Mvaa 52,68,96
buffer_load_dwordx4 v6, s[12:15], s54 offen offset:2048 nt lds
Mvaa 68,68,100
Ta 40,14,0
Ta 42,14,2048
Mvaa 84,68,104
Mvaa 100,68,108
Ra 8,10,4096
Mvaa 116,68,112
buffer_load_dwordx4 v7, s[12:15], s55 offen offset:3072 nt lds
Mvaa 132,68,116
s_waitcnt lgkmcnt(6)
Ta 44,15,0
Ta 46,15,2048
Mvaa 148,68,120
Mvaa 164,68,124
s_add_u32 m0, s57, 69632
Ra 12,10,6144
Mvaa 56,72,96
buffer_load_dwordx4 v8, s[12:15], s52 offen offset:0 nt lds
Mvaa 72,72,100
Ta 48,16,0
Ta 50,16,2048
Mvaa 88,72,104
Mvaa 104,72,108
Ra 16,10,8192
Mvaa 120,72,112
buffer_load_dwordx4 v9, s[12:15], s53 offen offset:1024 nt lds
Mvaa 136,72,116
s_waitcnt lgkmcnt(6)
Ta 52,17,0
Ta 54,17,2048
Mvaa 152,72,120
Mvaa 168,72,124
Ra 20,10,10240
Mvaa 60,76,96
buffer_load_dwordx4 v8, s[12:15], s54 offen offset:2048 nt lds
Mvaa 76,76,100
Ta 56,18,0
Ta 58,18,2048
Mvaa 92,76,104
Mvaa 108,76,108
Ra 24,10,12288
Mvaa 124,76,112
buffer_load_dwordx4 v9, s[12:15], s55 offen offset:3072 nt lds
Mvaa 140,76,116
s_waitcnt lgkmcnt(6)
Ta 60,19,0
Ta 62,19,2048
Mvaa 156,76,120
v_xor_b32 v6, 1572864, v6
v_xor_b32 v7, 1572864, v7
Mvaa 172,76,124
s_add_u32 m0, s56, 65536
Ra 28,10,14336
v_xor_b32 v8, 1572864, v8
Mvaa 176,80,96
buffer_load_dwordx4 v2, s[8:11], s48 offen offset:0 lds
Mvaa 192,80,100
v_xor_b32 v9, 1572864, v9
Mvaa 208,80,104
Mvaa 224,80,108
Mvaa 240,80,112
buffer_load_dwordx4 v3, s[8:11], s49 offen offset:1024 lds
Maaa 128,80,116
Maaa 144,80,120
Maaa 160,80,124
s_cmp_eq_u32 s6, 2
s_cselect_b32 s3, 0, 2146435072
Mvaa 180,84,96
buffer_load_dwordx4 v2, s[8:11], s50 offen offset:2048 lds
Mvaa 196,84,100
s_mov_b64 exec, 1
buffer_atomic_add v30, v31, s[28:31], s3 offen sc1
s_mov_b64 exec, -1
Mvaa 212,84,104
Mvaa 228,84,108
Mvaa 244,84,112
buffer_load_dwordx4 v3, s[8:11], s51 offen offset:3072 lds
Maaa 132,84,116
Maaa 148,84,120
Maaa 164,84,124
s_add_u32 m0, s56, 69632
Mvaa 184,88,96
buffer_load_dwordx4 v4, s[8:11], s48 offen offset:0 lds
Mvaa 200,88,100
Mvaa 216,88,104
Mvaa 232,88,108
Mvaa 248,88,112
buffer_load_dwordx4 v5, s[8:11], s49 offen offset:1024 lds
Maaa 136,88,116
Maaa 152,88,120
Maaa 168,88,124
Mvaa 188,92,96
buffer_load_dwordx4 v4, s[8:11], s50 offen offset:2048 lds
Mvaa 204,92,100
Mvaa 220,92,104
Mvaa 236,92,108
Mvaa 252,92,112
buffer_load_dwordx4 v5, s[8:11], s51 offen offset:3072 lds
Maaa 140,92,116
v_xor_b32 v2, 384, v2
v_xor_b32 v3, 384, v3
Maaa 156,92,120
v_xor_b32 v4, 384, v4
v_xor_b32 v5, 384, v5
Maaa 172,92,124
s_waitcnt lgkmcnt(0)
Mvaa 48,0,32
buffer_load_dword v44, v45, s[16:19], s47 offen
Mvaa 64,0,36
Ta 96,12,16384
Ta 98,12,18432
Mvaa 80,0,40
s_add_u32 s47, s47, 2097152
Mvaa 96,0,44
Ra 64,11,0
Mvaa 112,0,48
Mvaa 128,0,52
Ta 100,13,16384
Ta 102,13,18432
Mvaa 144,0,56
Mvaa 160,0,60
s_waitcnt lgkmcnt(6)
Ra 68,11,2048
Mvaa 52,4,32
Mvaa 68,4,36
Ta 104,14,16384
Ta 106,14,18432
Mvaa 84,4,40
Mvaa 100,4,44
Ra 72,11,4096
Mvaa 116,4,48
Mvaa 132,4,52
Ta 108,15,16384
Ta 110,15,18432
Mvaa 148,4,56
Mvaa 164,4,60
s_waitcnt lgkmcnt(6)
Ra 76,11,6144
Mvaa 56,8,32
Mvaa 72,8,36
Ta 112,16,16384
Ta 114,16,18432
Mvaa 88,8,40
Mvaa 104,8,44
Ra 80,11,8192
Mvaa 120,8,48
Mvaa 136,8,52
Ta 116,17,16384
Ta 118,17,18432
Mvaa 152,8,56
Mvaa 168,8,60
s_waitcnt lgkmcnt(6)
Ra 84,11,10240
Mvaa 60,12,32
Mvaa 76,12,36
Ta 120,18,16384
Ta 122,18,18432
Mvaa 92,12,40
Mvaa 108,12,44
Ra 88,11,12288
Mvaa 124,12,48
Mvaa 140,12,52
Ta 124,19,16384
Ta 126,19,18432
Mvaa 156,12,56
Mvaa 172,12,60
s_waitcnt lgkmcnt(6)
Ra 92,11,14336
Mvaa 176,16,32
Mvaa 192,16,36
Mvaa 208,16,40
Mvaa 224,16,44
Mvaa 240,16,48
Maaa 128,16,52
Maaa 144,16,56
Maaa 160,16,60
Mvaa 180,20,32
Mvaa 196,20,36
Mvaa 212,20,40
Mvaa 228,20,44
Mvaa 244,20,48
Maaa 132,20,52
Maaa 148,20,56
Maaa 164,20,60
Mvaa 184,24,32
Mvaa 200,24,36
Mvaa 216,24,40
Mvaa 232,24,44
Mvaa 248,24,48
s_cmp_eq_u32 s6, 3
s_cselect_b32 s3, 0, 2146435072
Maaa 136,24,52
s_mov_b64 exec, 1
buffer_atomic_add v30, v31, s[28:31], s3 offen sc1
s_mov_b64 exec, -1
Maaa 152,24,56
Maaa 168,24,60
Mvaa 188,28,32
Mvaa 204,28,36
Mvaa 220,28,40
Mvaa 236,28,44
Mvaa 252,28,48
Maaa 140,28,52
Maaa 156,28,56
Maaa 172,28,60
s_waitcnt vmcnt(2) lgkmcnt(0)
s_add_u32 m0, s57, 0
s_barrier
Mvaa 48,64,96
buffer_load_dwordx4 v6, s[12:15], s52 offen offset:0 nt lds
Mvaa 64,64,100
Ta 32,22,0
Ta 34,22,2048
Mvaa 80,64,104
Mvaa 96,64,108
Ra 0,20,0
Mvaa 112,64,112
buffer_load_dwordx4 v7, s[12:15], s53 offen offset:1024 nt lds
Mvaa 128,64,116
s_waitcnt lgkmcnt(6)
Ta 36,23,0
Ta 38,23,2048
Mvaa 144,64,120
Mvaa 160,64,124
Ra 4,20,2048
Mvaa 52,68,96
buffer_load_dwordx4 v6, s[12:15], s54 offen offset:2048 nt lds
Mvaa 68,68,100
Ta 40,24,0
Ta 42,24,2048
Mvaa 84,68,104
Mvaa 100,68,108
Ra 8,20,4096
Mvaa 116,68,112
buffer_load_dwordx4 v7, s[12:15], s55 offen offset:3072 nt lds
Mvaa 132,68,116
s_waitcnt lgkmcnt(6)
Ta 44,25,0
Ta 46,25,2048
Mvaa 148,68,120
Mvaa 164,68,124
s_add_u32 m0, s57, 4096
Ra 12,20,6144
Mvaa 56,72,96
buffer_load_dwordx4 v8, s[12:15], s52 offen offset:0 nt lds
Mvaa 72,72,100
Ta 48,26,0
Ta 50,26,2048
Mvaa 88,72,104
Mvaa 104,72,108
Ra 16,20,8192
Mvaa 120,72,112
buffer_load_dwordx4 v9, s[12:15], s53 offen offset:1024 nt lds
Mvaa 136,72,116
s_waitcnt lgkmcnt(6)
Ta 52,27,0
Ta 54,27,2048
Mvaa 152,72,120
Mvaa 168,72,124
Ra 20,20,10240
Mvaa 60,76,96
buffer_load_dwordx4 v8, s[12:15], s54 offen offset:2048 nt lds
Mvaa 76,76,100
Ta 56,28,0
Ta 58,28,2048
Mvaa 92,76,104
Mvaa 108,76,108
Ra 24,20,12288
Mvaa 124,76,112
buffer_load_dwordx4 v9, s[12:15], s55 offen offset:3072 nt lds
Mvaa 140,76,116
s_waitcnt lgkmcnt(6)
Ta 60,29,0
Ta 62,29,2048
Mvaa 156,76,120
v_xor_b32 v6, 524288, v6
v_xor_b32 v7, 524288, v7
Mvaa 172,76,124
s_add_u32 m0, s56, 0
Ra 28,20,14336
v_xor_b32 v8, 524288, v8
Mvaa 176,80,96
buffer_load_dwordx4 v2, s[8:11], s48 offen offset:0 lds
Mvaa 192,80,100
v_xor_b32 v9, 524288, v9
Mvaa 208,80,104
Mvaa 224,80,108
Mvaa 240,80,112
buffer_load_dwordx4 v3, s[8:11], s49 offen offset:1024 lds
Maaa 128,80,116
Maaa 144,80,120
Maaa 160,80,124
Mvaa 180,84,96
buffer_load_dwordx4 v2, s[8:11], s50 offen offset:2048 lds
Mvaa 196,84,100
Mvaa 212,84,104
Mvaa 228,84,108
Mvaa 244,84,112
buffer_load_dwordx4 v3, s[8:11], s51 offen offset:3072 lds
Maaa 132,84,116
Maaa 148,84,120
Maaa 164,84,124
s_add_u32 m0, s56, 4096
Mvaa 184,88,96
buffer_load_dwordx4 v4, s[8:11], s48 offen offset:0 lds
Mvaa 200,88,100
Mvaa 216,88,104
Mvaa 232,88,108
Mvaa 248,88,112
buffer_load_dwordx4 v5, s[8:11], s49 offen offset:1024 lds
Maaa 136,88,116
Maaa 152,88,120
Maaa 168,88,124
Mvaa 188,92,96
buffer_load_dwordx4 v4, s[8:11], s50 offen offset:2048 lds
Mvaa 204,92,100
Mvaa 220,92,104
Mvaa 236,92,108
Mvaa 252,92,112
buffer_load_dwordx4 v5, s[8:11], s51 offen offset:3072 lds
Maaa 140,92,116
v_xor_b32 v2, 128, v2
v_xor_b32 v3, 128, v3
Maaa 156,92,120
v_xor_b32 v4, 128, v4
v_xor_b32 v5, 128, v5
Maaa 172,92,124
s_waitcnt lgkmcnt(0)
Mvaa 48,0,32
buffer_load_dword v44, v45, s[16:19], s47 offen
Mvaa 64,0,36
Ta 96,22,16384
Ta 98,22,18432
Mvaa 80,0,40
s_add_u32 s47, s47, 2097152
v_lshrrev_b32 v32, 4, v0
v_and_b32 v33, 15, v0
Mvaa 96,0,44
Ra 64,21,0
Mvaa 112,0,48
s_lshl_b32 s3, s32, 4
v_add_u32 v34, s3, v32
v_lshlrev_b32_e64 v36, 1, v32
Mvaa 128,0,52
Ta 100,23,16384
Ta 102,23,18432
Mvaa 144,0,56
v_xor_b32 v36, v36, v33
v_xor_b32 v37, 8, v36
Mvaa 160,0,60
s_waitcnt lgkmcnt(6)
Ra 68,21,2048
Mvaa 52,4,32
s_getpc_b64 s[6:7]
L_cpf3:
s_add_u32 s6, s6, (L_phase2-L_cpf3)&0xffffffff
s_addc_u32 s7, s7, ((L_phase2-L_cpf3)>>32)&0xffffffff
Mvaa 68,4,36
Ta 104,24,16384
Ta 106,24,18432
Mvaa 84,4,40
s_lshr_b32 s3, s2, 3
s_lshl_b32 s3, s3, 2
s_add_u32 s3, s3, s32
Mvaa 100,4,44
Ra 72,21,4096
Mvaa 116,4,48
s_lshl_b32 s3, s3, 10
v_and_b32 v42, 7, v0
v_lshlrev_b32 v42, 7, v42
Mvaa 132,4,52
Ta 108,25,16384
Ta 110,25,18432
Mvaa 148,4,56
v_add_u32_e64 v42, s3, v42
v_min_u32 v42, L_k2_fin-L_phase2-4, v42
Mvaa 164,4,60
s_waitcnt lgkmcnt(6)
Ra 76,21,6144
Mvaa 56,8,32
v_mov_b32 v41, s7
Mvaa 72,8,36
Ta 112,26,16384
Ta 114,26,18432
Mvaa 88,8,40
v_add_co_u32 v40, vcc, s6, v42
s_nop 1
v_addc_co_u32 v41, vcc, 0, v41, vcc
Mvaa 104,8,44
Ra 80,21,8192
Mvaa 120,8,48
global_load_dword v38, v[40:41], off
Mvaa 136,8,52
Ta 116,27,16384
Ta 118,27,18432
Mvaa 152,8,56
Mvaa 168,8,60
s_waitcnt lgkmcnt(6)
Ra 84,21,10240
Mvaa 60,12,32
Mvaa 76,12,36
Ta 120,28,16384
Ta 122,28,18432
Mvaa 92,12,40
Mvaa 108,12,44
Ra 88,21,12288
Mvaa 124,12,48
Mvaa 140,12,52
Ta 124,29,16384
Ta 126,29,18432
Mvaa 156,12,56
Mvaa 172,12,60
s_waitcnt lgkmcnt(6)
Ra 92,21,14336
Mvaa 176,16,32
Mvaa 192,16,36
Mvaa 208,16,40
Mvaa 224,16,44
Mvaa 240,16,48
Maaa 128,16,52
Maaa 144,16,56
Maaa 160,16,60
Mvaa 180,20,32
Mvaa 196,20,36
Mvaa 212,20,40
Mvaa 228,20,44
Mvaa 244,20,48
Maaa 132,20,52
Maaa 148,20,56
Maaa 164,20,60
Mvaa 184,24,32
Mvaa 200,24,36
Mvaa 216,24,40
Mvaa 232,24,44
Mvaa 248,24,48
Maaa 136,24,52
Maaa 152,24,56
Maaa 168,24,60
Mvaa 188,28,32
Mvaa 204,28,36
Mvaa 220,28,40
Mvaa 236,28,44
Mvaa 252,28,48
Maaa 140,28,52
Maaa 156,28,56
Maaa 172,28,60
s_waitcnt vmcnt(2) lgkmcnt(0)
s_add_u32 m0, s57, 65536
s_barrier
Mvaa 48,64,96
buffer_load_dwordx4 v6, s[12:15], s52 offen offset:0 nt lds
Mvaa 64,64,100
Ta 32,12,0
Ta 34,12,2048
Mvaa 80,64,104
Mvaa 96,64,108
Ra 0,10,0
Mvaa 112,64,112
buffer_load_dwordx4 v7, s[12:15], s53 offen offset:1024 nt lds
Mvaa 128,64,116
s_waitcnt lgkmcnt(6)
Ta 36,13,0
Ta 38,13,2048
Mvaa 144,64,120
Mvaa 160,64,124
Ra 4,10,2048
Mvaa 52,68,96
buffer_load_dwordx4 v6, s[12:15], s54 offen offset:2048 nt lds
Mvaa 68,68,100
Ta 40,14,0
Ta 42,14,2048
Mvaa 84,68,104
Mvaa 100,68,108
Ra 8,10,4096
Mvaa 116,68,112
buffer_load_dwordx4 v7, s[12:15], s55 offen offset:3072 nt lds
Mvaa 132,68,116
s_waitcnt lgkmcnt(6)
Ta 44,15,0
Ta 46,15,2048
Mvaa 148,68,120
Mvaa 164,68,124
s_add_u32 m0, s57, 69632
Ra 12,10,6144
Mvaa 56,72,96
buffer_load_dwordx4 v8, s[12:15], s52 offen offset:0 nt lds
Mvaa 72,72,100
Ta 48,16,0
Ta 50,16,2048
Mvaa 88,72,104
Mvaa 104,72,108
Ra 16,10,8192
Mvaa 120,72,112
buffer_load_dwordx4 v9, s[12:15], s53 offen offset:1024 nt lds
Mvaa 136,72,116
s_waitcnt lgkmcnt(6)
Ta 52,17,0
Ta 54,17,2048
Mvaa 152,72,120
Mvaa 168,72,124
Ra 20,10,10240
Mvaa 60,76,96
buffer_load_dwordx4 v8, s[12:15], s54 offen offset:2048 nt lds
Mvaa 76,76,100
Ta 56,18,0
Ta 58,18,2048
Mvaa 92,76,104
Mvaa 108,76,108
Ra 24,10,12288
Mvaa 124,76,112
buffer_load_dwordx4 v9, s[12:15], s55 offen offset:3072 nt lds
Mvaa 140,76,116
s_waitcnt lgkmcnt(6)
Ta 60,19,0
Ta 62,19,2048
Mvaa 156,76,120
Mvaa 172,76,124
s_add_u32 m0, s56, 65536
Ra 28,10,14336
Mvaa 176,80,96
buffer_load_dwordx4 v2, s[8:11], s48 offen offset:0 lds
Mvaa 192,80,100
Mvaa 208,80,104
Mvaa 224,80,108
Mvaa 240,80,112
buffer_load_dwordx4 v3, s[8:11], s49 offen offset:1024 lds
Maaa 128,80,116
Maaa 144,80,120
Maaa 160,80,124
Mvaa 180,84,96
buffer_load_dwordx4 v2, s[8:11], s50 offen offset:2048 lds
Mvaa 196,84,100
Mvaa 212,84,104
Mvaa 228,84,108
Mvaa 244,84,112
buffer_load_dwordx4 v3, s[8:11], s51 offen offset:3072 lds
Maaa 132,84,116
Maaa 148,84,120
Maaa 164,84,124
s_add_u32 m0, s56, 69632
Mvaa 184,88,96
buffer_load_dwordx4 v4, s[8:11], s48 offen offset:0 lds
Mvaa 200,88,100
Mvaa 216,88,104
Mvaa 232,88,108
Mvaa 248,88,112
buffer_load_dwordx4 v5, s[8:11], s49 offen offset:1024 lds
Maaa 136,88,116
Maaa 152,88,120
Maaa 168,88,124
Mvaa 188,92,96
buffer_load_dwordx4 v4, s[8:11], s50 offen offset:2048 lds
Mvaa 204,92,100
Mvaa 220,92,104
Mvaa 236,92,108
Mvaa 252,92,112
buffer_load_dwordx4 v5, s[8:11], s51 offen offset:3072 lds
Maaa 140,92,116
Maaa 156,92,120
Maaa 172,92,124
s_waitcnt lgkmcnt(0)
Mvaa 48,0,32
buffer_load_dword v30, v31, s[28:31], s37 offen sc1
Mvaa 64,0,36
Ta 96,12,16384
Ta 98,12,18432
Mvaa 80,0,40
s_mov_b32 s8, s16
s_mov_b32 s9, s17
s_mov_b32 s10, s18
Mvaa 96,0,44
Ra 64,11,0
Mvaa 112,0,48
s_add_u32 s16, s66, 46137344
s_addc_u32 s17, s67, 0
s_and_b32 s17, s17, 0xffff
Mvaa 128,0,52
Ta 100,13,16384
Ta 102,13,18432
Mvaa 144,0,56
s_mov_b32 s18, 16777216
s_mov_b32 s19, 0x20000
s_mov_b32 s48, 0
Mvaa 160,0,60
s_waitcnt lgkmcnt(6)
Ra 68,11,2048
Mvaa 52,4,32
s_mov_b32 s49, 31744
s_mov_b32 s50, 63488
s_mov_b32 s51, 95232
Mvaa 68,4,36
Ta 104,14,16384
Ta 106,14,18432
Mvaa 84,4,40
v_lshlrev_b32_e64 v35, 13, v34
v_lshl_add_u32 v8, v36, 4, v35
Mvaa 100,4,44
Ra 72,11,4096
Mvaa 116,4,48
v_lshl_add_u32 v9, v37, 4, v35
v_lshlrev_b32_e64 v2, 4, v0
Mvaa 132,4,52
Ta 108,15,16384
Ta 110,15,18432
Mvaa 148,4,56
v_add_u32 v3, 65536, v2
v_add_u32_e64 v4, s44, v2
Mvaa 164,4,60
s_waitcnt lgkmcnt(6)
Ra 76,11,6144
Mvaa 56,8,32
v_mov_b32 v7, 0
v_lshlrev_b32_e64 v35, 2, v32
Mvaa 72,8,36
Ta 112,16,16384
Ta 114,16,18432
Mvaa 88,8,40
v_sub_u32_e64 v35, v33, v35
Mvaa 104,8,44
Ra 80,11,8192
Mvaa 120,8,48
s_lshl_b32 s3, s32, 4
v_add_u32 v5, s3, v35
Mvaa 136,8,52
Ta 116,17,16384
Ta 118,17,18432
Mvaa 152,8,56
s_sub_u32 s3, 48, s3
v_add_u32 v6, s3, v35
Mvaa 168,8,60
s_waitcnt lgkmcnt(6)
Ra 84,11,10240
Mvaa 60,12,32
s_mul_i32 s3, s33, 1116160
s_add_u32 s3, s3, 8388608
s_add_u32 s12, s66, s3
s_addc_u32 s13, s67, 0
s_and_b32 s13, s13, 0xffff
Mvaa 76,12,36
Ta 120,18,16384
Ta 122,18,18432
Mvaa 92,12,40
s_mov_b32 s14, 0
s_mov_b32 s15, 0x20000
s_mul_i32 s14, s36, 34816
Mvaa 108,12,44
Ra 88,11,12288
Mvaa 124,12,48
buffer_load_dword v44, v45, s[8:11], s47 offen
Mvaa 140,12,52
Ta 124,19,16384
Ta 126,19,18432
Mvaa 156,12,56
s_add_u32 s47, s47, 2097152
Mvaa 172,12,60
s_waitcnt lgkmcnt(6)
Ra 92,11,14336
Mvaa 176,16,32
Mvaa 192,16,36
Mvaa 208,16,40
Mvaa 224,16,44
Mvaa 240,16,48
Maaa 128,16,52
Maaa 144,16,56
Maaa 160,16,60
Mvaa 180,20,32
Mvaa 196,20,36
Mvaa 212,20,40
Mvaa 228,20,44
Mvaa 244,20,48
Maaa 132,20,52
Maaa 148,20,56
Maaa 164,20,60
Mvaa 184,24,32
Mvaa 200,24,36
Mvaa 216,24,40
Mvaa 232,24,44
Mvaa 248,24,48
Maaa 136,24,52
Maaa 152,24,56
Maaa 168,24,60
Mvaa 188,28,32
Mvaa 204,28,36
Mvaa 220,28,40
Mvaa 236,28,44
Mvaa 252,28,48
Maaa 140,28,52
Maaa 156,28,56
Maaa 172,28,60
s_waitcnt vmcnt(2) lgkmcnt(0)
s_add_u32 m0, s44, 0
s_barrier
Mvaa 48,64,96
buffer_load_dwordx4 v8, s[8:11], s48 offen offset:0 lds
Mvaa 64,64,100
Ta 32,22,0
Ta 34,22,2048
Mvaa 80,64,104
s_mul_i32 s3, s45, 33792
v_add_u32_e64 v10, s3, v2
Mvaa 96,64,108
Ra 0,20,0
Mvaa 112,64,112
buffer_load_dwordx4 v8, s[8:11], s49 offen offset:1024 lds
Mvaa 128,64,116
s_waitcnt lgkmcnt(6)
Ta 36,23,0
Ta 38,23,2048
Mvaa 144,64,120
s_mul_i32 s3, s46, 33792
v_add_u32 v11, s3, v2
v_mov_b32_e64 v14, v40
Mvaa 160,64,124
Ra 4,20,2048
Mvaa 52,68,96
buffer_load_dwordx4 v9, s[8:11], s50 offen offset:2048 lds
Mvaa 68,68,100
Ta 40,24,0
Ta 42,24,2048
Mvaa 84,68,104
v_mov_b32_e64 v15, v41
Mvaa 100,68,108
Ra 8,20,4096
Mvaa 116,68,112
buffer_load_dwordx4 v9, s[8:11], s51 offen offset:3072 lds
Mvaa 132,68,116
s_waitcnt lgkmcnt(6)
Ta 44,25,0
Ta 46,25,2048
Mvaa 148,68,120
v_add_u32 v8, 524288, v8
v_add_u32 v9, 524288, v9
Mvaa 164,68,124
s_add_u32 m0, s44, 16384
Ra 12,20,6144
Mvaa 56,72,96
buffer_load_dwordx4 v8, s[8:11], s48 offen offset:0 lds
Mvaa 72,72,100
Ta 48,26,0
Ta 50,26,2048
Mvaa 88,72,104
Mvaa 104,72,108
Ra 16,20,8192
Mvaa 120,72,112
buffer_load_dwordx4 v8, s[8:11], s49 offen offset:1024 lds
Mvaa 136,72,116
s_waitcnt lgkmcnt(6)
Ta 52,27,0
Ta 54,27,2048
Mvaa 152,72,120
Mvaa 168,72,124
Ra 20,20,10240
Mvaa 60,76,96
buffer_load_dwordx4 v9, s[8:11], s50 offen offset:2048 lds
Mvaa 76,76,100
Ta 56,28,0
Ta 58,28,2048
Mvaa 92,76,104
Mvaa 108,76,108
Ra 24,20,12288
Mvaa 124,76,112
buffer_load_dwordx4 v9, s[8:11], s51 offen offset:3072 lds
Mvaa 140,76,116
s_waitcnt lgkmcnt(6)
Ta 60,29,0
Ta 62,29,2048
Mvaa 156,76,120
v_add_u32 v8, 524288, v8
v_add_u32 v9, 524288, v9
Mvaa 172,76,124
s_add_u32 m0, s44, 32768
Ra 28,20,14336
Mvaa 176,80,96
buffer_load_dwordx4 v8, s[8:11], s48 offen offset:0 lds
Mvaa 192,80,100
Mvaa 208,80,104
Mvaa 224,80,108
Mvaa 240,80,112
buffer_load_dwordx4 v8, s[8:11], s49 offen offset:1024 lds
Maaa 128,80,116
Maaa 144,80,120
Maaa 160,80,124
Mvaa 180,84,96
buffer_load_dwordx4 v9, s[8:11], s50 offen offset:2048 lds
Mvaa 196,84,100
Mvaa 212,84,104
Mvaa 228,84,108
Mvaa 244,84,112
buffer_load_dwordx4 v9, s[8:11], s51 offen offset:3072 lds
Maaa 132,84,116
v_add_u32 v8, 524288, v8
v_add_u32 v9, 524288, v9
Maaa 148,84,120
Maaa 164,84,124
s_add_u32 m0, s44, 49152
Mvaa 184,88,96
buffer_load_dwordx4 v8, s[8:11], s48 offen offset:0 lds
Mvaa 200,88,100
Mvaa 216,88,104
Mvaa 232,88,108
Mvaa 248,88,112
buffer_load_dwordx4 v8, s[8:11], s49 offen offset:1024 lds
Maaa 136,88,116
Maaa 152,88,120
Maaa 168,88,124
Mvaa 188,92,96
buffer_load_dwordx4 v9, s[8:11], s50 offen offset:2048 lds
Mvaa 204,92,100
Mvaa 220,92,104
Mvaa 236,92,108
Mvaa 252,92,112
buffer_load_dwordx4 v9, s[8:11], s51 offen offset:3072 lds
Maaa 140,92,116
v_add_u32 v8, 524288, v8
v_add_u32 v9, 524288, v9
Maaa 156,92,120
Maaa 172,92,124
s_waitcnt lgkmcnt(0)
Mvaa 48,0,32
Mvaa 64,0,36
Ta 96,22,16384
Ta 98,22,18432
Mvaa 80,0,40
Mvaa 96,0,44
Ra 64,21,0
Mvaa 112,0,48
Mvaa 128,0,52
Ta 100,23,16384
Ta 102,23,18432
Mvaa 144,0,56
Mvaa 160,0,60
s_waitcnt lgkmcnt(6)
Ra 68,21,2048
Mvaa 52,4,32
Mvaa 68,4,36
Ta 104,24,16384
Ta 106,24,18432
Mvaa 84,4,40
Mvaa 100,4,44
Ra 72,21,4096
Mvaa 116,4,48
Mvaa 132,4,52
Ta 108,25,16384
Ta 110,25,18432
Mvaa 148,4,56
Mvaa 164,4,60
s_waitcnt lgkmcnt(6)
Ra 76,21,6144
Mvaa 56,8,32
Mvaa 72,8,36
Ta 112,26,16384
Ta 114,26,18432
Mvaa 88,8,40
Mvaa 104,8,44
Ra 80,21,8192
Mvaa 120,8,48
Mvaa 136,8,52
Ta 116,27,16384
Ta 118,27,18432
Mvaa 152,8,56
Mvaa 168,8,60
s_waitcnt lgkmcnt(6)
Ra 84,21,10240
Mvaa 60,12,32
Mvaa 76,12,36
Ta 120,28,16384
Ta 122,28,18432
Mvaa 92,12,40
Mvaa 108,12,44
Ra 88,21,12288
Mvaa 124,12,48
Mvaa 140,12,52
Ta 124,29,16384
Ta 126,29,18432
Mvaa 156,12,56
Mvaa 172,12,60
s_waitcnt lgkmcnt(6)
Ra 92,21,14336
Mvaa 176,16,32
Mvaa 192,16,36
Mvaa 208,16,40
Mvaa 224,16,44
Mvaa 240,16,48
Maaa 128,16,52
Maaa 144,16,56
Maaa 160,16,60
Mvaa 180,20,32
Mvaa 196,20,36
Mvaa 212,20,40
Mvaa 228,20,44
Mvaa 244,20,48
Maaa 132,20,52
Maaa 148,20,56
Maaa 164,20,60
Mvaa 184,24,32
Mvaa 200,24,36
Mvaa 216,24,40
Mvaa 232,24,44
Mvaa 248,24,48
Maaa 136,24,52
Maaa 152,24,56
Maaa 168,24,60
Mvaa 188,28,32
Mvaa 204,28,36
Mvaa 220,28,40
Mvaa 236,28,44
Mvaa 252,28,48
Maaa 140,28,52
Maaa 156,28,56
Maaa 172,28,60
s_waitcnt vmcnt(12) lgkmcnt(0)
v_readfirstlane_b32 s3, v30
s_nop 0
s_or_b32 s3, s3, s37
s_cmp_lt_u32 s3, 256
s_cbranch_scc1 L_spinAv
L_spinArv:
s_barrier
Mvaa 48,64,96
buffer_load_dwordx4 a[0:3], v10, s[20:23], s58 offen offset:0 sc1
Mvaa 52,68,96
v_lshrrev_b32_e64 v42, 2, v33
v_lshl_add_u32 v43, v32, 3, v42
Mvaa 56,72,96
v_lshlrev_b32 v43, 8, v43
v_and_b32 v44, 3, v0
Mvaa 60,76,96
v_lshl_add_u32 v43, v44, 3, v43
v_and_b32_e64 v44, 1, v32
Mvaa 64,64,100
buffer_load_dwordx4 a[4:7], v10, s[20:23], 0 offen offset:0 sc1
Mvaa 68,68,100
v_lshl_add_u32 v42, v44, 2, v42
v_xor_b32_e64 v44, 0, v42
Mvaa 72,72,100
v_lshl_add_u32 v16, v44, 5, v43
v_xor_b32_e64 v44, 1, v42
Mvaa 76,76,100
v_lshl_add_u32 v17, v44, 5, v43
v_xor_b32_e64 v44, 2, v42
Mvaa 80,64,104
buffer_load_dwordx4 a[8:11], v11, s[20:23], s58 offen offset:0 sc1
Mvaa 84,68,104
v_lshl_add_u32 v18, v44, 5, v43
v_xor_b32_e64 v44, 3, v42
Mvaa 88,72,104
v_lshl_add_u32 v19, v44, 5, v43
v_xor_b32_e64 v44, 4, v42
Mvaa 92,76,104
v_lshl_add_u32 v20, v44, 5, v43
v_xor_b32_e64 v44, 5, v42
Mvaa 96,64,108
buffer_load_dwordx4 a[12:15], v11, s[20:23], 0 offen offset:0 sc1
Mvaa 100,68,108
v_lshl_add_u32 v21, v44, 5, v43
v_xor_b32_e64 v44, 6, v42
Mvaa 104,72,108
v_lshl_add_u32 v22, v44, 5, v43
v_xor_b32_e64 v44, 7, v42
Mvaa 108,76,108
v_lshl_add_u32 v23, v44, 5, v43
Mvaa 112,64,112
buffer_load_dwordx4 a[16:19], v10, s[20:23], s58 offen offset:1024 sc1
Mvaa 116,68,112
Mvaa 120,72,112
Mvaa 124,76,112
Mvaa 128,64,116
buffer_load_dwordx4 a[20:23], v10, s[20:23], 0 offen offset:1024 sc1
Mvaa 132,68,116
Ta 192,16,0
Ta 194,16,1024
Mvaa 136,72,116
Ta 196,17,0
Ta 198,17,1024
Mvaa 140,76,116
Ta 200,18,0
Ta 202,18,1024
Mvaa 144,64,120
buffer_load_dwordx4 a[24:27], v11, s[20:23], s58 offen offset:1024 sc1
Mvaa 148,68,120
Ta 204,19,0
Ta 206,19,1024
Mvaa 152,72,120
Ta 208,20,0
Ta 210,20,1024
Mvaa 156,76,120
Ta 212,21,0
Ta 214,21,1024
Mvaa 160,64,124
buffer_load_dwordx4 a[28:31], v11, s[20:23], 0 offen offset:1024 sc1
Mvaa 164,68,124
Ta 216,22,0
Ta 218,22,1024
Mvaa 168,72,124
Ta 220,23,0
s_waitcnt lgkmcnt(9)
Ta 222,23,1024
Mvaa 172,76,124
s_waitcnt lgkmcnt(8)
Vc 24,48,49
Vc 25,50,51
Mvaa 176,80,96
buffer_load_dwordx4 a[32:35], v10, s[20:23], s58 offen offset:2048 sc1
Mvaa 180,84,96
Vc 26,52,53
Vc 27,54,55
Mvaa 184,88,96
Vc 28,56,57
Vc 29,58,59
Mvaa 188,92,96
Vc 30,60,61
Vc 31,62,63
Mvaa 192,80,100
buffer_load_dwordx4 a[36:39], v10, s[20:23], 0 offen offset:2048 sc1
Mvaa 196,84,100
Vc 32,64,65
Vc 33,66,67
Mvaa 200,88,100
Vc 34,68,69
Vc 35,70,71
Mvaa 204,92,100
Vc 36,72,73
Vc 37,74,75
Mvaa 208,80,104
buffer_load_dwordx4 a[40:43], v11, s[20:23], s58 offen offset:2048 sc1
Mvaa 212,84,104
Vc 38,76,77
Vc 39,78,79
Mvaa 216,88,104
Vc 40,80,81
Vc 41,82,83
Mvaa 220,92,104
Vc 42,84,85
Vc 43,86,87
Mvaa 224,80,108
buffer_load_dwordx4 a[44:47], v11, s[20:23], 0 offen offset:2048 sc1
Mvaa 228,84,108
Vc 44,88,89
Vc 45,90,91
Mvaa 232,88,108
Vc 46,92,93
Vc 47,94,95
Mvaa 236,92,108
Vc 48,96,97
Vc 49,98,99
Mvaa 240,80,112
buffer_load_dwordx4 a[48:51], v10, s[20:23], s58 offen offset:3072 sc1
Mvaa 244,84,112
Vc 50,100,101
Vc 51,102,103
Mvaa 248,88,112
Vc 52,104,105
Vc 53,106,107
Mvaa 252,92,112
Vc 54,108,109
Vc 55,110,111
Maaa 128,80,116
buffer_load_dwordx4 a[52:55], v10, s[20:23], 0 offen offset:3072 sc1
Maaa 132,84,116
Vc 56,112,113
Vc 57,114,115
Maaa 136,88,116
Vc 58,116,117
Vc 59,118,119
Maaa 140,92,116
Vc 60,120,121
Vc 61,122,123
Maaa 144,80,120
buffer_load_dwordx4 a[56:59], v11, s[20:23], s58 offen offset:3072 sc1
Maaa 148,84,120
Vc 62,124,125
Vc 63,126,127
Maaa 152,88,120
Vc 64,128,129
Vc 65,130,131
Maaa 156,92,120
Vc 66,132,133
Vc 67,134,135
Maaa 160,80,124
buffer_load_dwordx4 a[60:63], v11, s[20:23], 0 offen offset:3072 sc1
Maaa 164,84,124
v_add_u32 v10, 4096, v10
v_add_u32 v11, 4096, v11
Maaa 168,88,124
Vc 68,136,137
Vc 69,138,139
Maaa 172,92,124
Vc 70,140,141
Vc 71,142,143
Vc 72,144,145
Vc 73,146,147
Vc 74,148,149
Vc 75,150,151
Vc 76,152,153
Vc 77,154,155
Vc 78,156,157
Vc 79,158,159
Vc 80,160,161
Vc 81,162,163
Vc 82,164,165
Vc 83,166,167
Vc 84,168,169
Vc 85,170,171
Vc 86,172,173
Vc 87,174,175
Vc 88,176,177
Vc 89,178,179
Vc 90,180,181
Vc 91,182,183
Vc 92,184,185
Vc 93,186,187
Vc 94,188,189
Vc 95,190,191
Vc 96,192,193
Vc 97,194,195
Vc 98,196,197
Vc 99,198,199
Vc 100,200,201
Vc 101,202,203
Vc 102,204,205
Vc 103,206,207
Vc 104,208,209
Vc 105,210,211
Vc 106,212,213
Vc 107,214,215
Vc 108,216,217
Vc 109,218,219
Vc 110,220,221
Vc 111,222,223
Vc 112,224,225
Vc 113,226,227
Vc 114,228,229
Vc 115,230,231
Vc 116,232,233
Vc 117,234,235
Vc 118,236,237
Vc 119,238,239
Vc 120,240,241
Vc 121,242,243
Vc 122,244,245
Vc 123,246,247
Vc 124,248,249
Vc 125,250,251
Vc 126,252,253
Vc 127,254,255
L_phase2:
s_nop 7
s_waitcnt vmcnt(12) lgkmcnt(0)
Zvaa 128,192,0
s_add_u32 s37, s38, 0
Zvaa 160,192,4
Ta 224,16,8192
Ta 226,16,9216
Zvaa 192,192,8
buffer_load_dwordx4 a[64:67], v10, s[20:23], s58 offen offset:0 sc1
Zvaa 224,192,12
buffer_store_dwordx4 v[24:27], v2, s[24:27], s37 offen offset:0 sc1
Zvaa 132,196,0
Ta 228,17,8192
Ta 230,17,9216
Zvaa 164,196,4
buffer_load_dwordx4 a[68:71], v10, s[20:23], 0 offen offset:0 sc1
Zvaa 196,196,8
s_mov_b32 s60, s40
s_and_b32 s61, s41, 0xffff
s_mov_b32 s62, 7340032
Zvaa 228,196,12
Ta 232,18,8192
Ta 234,18,9216
Zvaa 136,200,0
s_mov_b32 s63, 0x20000
Zvaa 168,200,4
buffer_load_dwordx4 a[72:75], v11, s[20:23], s58 offen offset:0 sc1
Zvaa 200,200,8
Ta 236,19,8192
Ta 238,19,9216
Zvaa 232,200,12
global_load_dword v13, v[14:15], off
Zvaa 140,204,0
Zvaa 172,204,4
Ta 240,20,8192
Ta 242,20,9216
Zvaa 204,204,8
buffer_load_dwordx4 a[76:79], v11, s[20:23], 0 offen offset:0 sc1
Zvaa 236,204,12
Zvaa 144,208,0
s_waitcnt lgkmcnt(6)
Ta 244,21,8192
Ta 246,21,9216
Zvaa 176,208,4
buffer_store_dwordx4 v[28:31], v2, s[24:27], s37 offen offset:1024 sc1
Zvaa 208,208,8
buffer_load_dwordx4 a[80:83], v10, s[20:23], s58 offen offset:1024 sc1
Zvaa 240,208,12
Ta 248,22,8192
Ta 250,22,9216
Zvaa 148,212,0
Zvaa 180,212,4
Zvaa 212,212,8
Ta 252,23,8192
Ta 254,23,9216
Zvaa 244,212,12
buffer_load_dwordx4 a[84:87], v10, s[20:23], 0 offen offset:1024 sc1
Zvaa 152,216,0
Zvaa 184,216,4
Zvaa 216,216,8
buffer_load_dwordx4 a[88:91], v11, s[20:23], s58 offen offset:1024 sc1
Zvaa 248,216,12
Zvaa 156,220,0
Zvaa 188,220,4
buffer_load_dwordx4 a[92:95], v11, s[20:23], 0 offen offset:1024 sc1
Zvaa 220,220,8
Zvaa 252,220,12
s_waitcnt vmcnt(19) lgkmcnt(0)
s_barrier
Mvaa 128,224,16
buffer_store_dwordx4 v[32:35], v2, s[24:27], s37 offen offset:2048 sc1
Mvaa 160,224,20
s_add_u32 m0, s44, 0
Ta 192,16,16384
Ta 194,16,17408
Mvaa 192,224,24
buffer_load_dwordx4 v8, s[8:11], s48 offen offset:0 lds
Mvaa 224,224,28
Mvaa 132,228,16
Ta 196,17,16384
Ta 198,17,17408
Mvaa 164,228,20
buffer_load_dwordx4 v8, s[8:11], s49 offen offset:1024 lds
Mvaa 196,228,24
Mvaa 228,228,28
Ta 200,18,16384
Ta 202,18,17408
Mvaa 136,232,16
Mvaa 168,232,20
buffer_load_dwordx4 v9, s[8:11], s50 offen offset:2048 lds
Mvaa 200,232,24
Ta 204,19,16384
Ta 206,19,17408
Mvaa 232,232,28
Mvaa 140,236,16
Mvaa 172,236,20
Ta 208,20,16384
Ta 210,20,17408
Mvaa 204,236,24
buffer_load_dwordx4 v9, s[8:11], s51 offen offset:3072 lds
v_add_u32 v8, 524288, v8
v_add_u32 v9, 524288, v9
Mvaa 236,236,28
Mvaa 144,240,16
s_waitcnt lgkmcnt(6)
Ta 212,21,16384
Ta 214,21,17408
Mvaa 176,240,20
buffer_store_dwordx4 v[36:39], v2, s[24:27], s37 offen offset:3072 sc1
Mvaa 208,240,24
buffer_load_dwordx4 a[96:99], v10, s[20:23], s58 offen offset:2048 sc1
Mvaa 240,240,28
Ta 216,22,16384
Ta 218,22,17408
Mvaa 148,244,16
Mvaa 180,244,20
Mvaa 212,244,24
Ta 220,23,16384
Ta 222,23,17408
Mvaa 244,244,28
buffer_load_dwordx4 a[100:103], v10, s[20:23], 0 offen offset:2048 sc1
Mvaa 152,248,16
Mvaa 184,248,20
Mvaa 216,248,24
buffer_load_dwordx4 a[104:107], v11, s[20:23], s58 offen offset:2048 sc1
Mvaa 248,248,28
Mvaa 156,252,16
Mvaa 188,252,20
buffer_load_dwordx4 a[108:111], v11, s[20:23], 0 offen offset:2048 sc1
Mvaa 220,252,24
Mvaa 252,252,28
s_waitcnt vmcnt(25) lgkmcnt(0)
Mvaa 128,192,32
s_add_u32 s37, s38, 4096
Mvaa 160,192,36
Ta 224,16,24576
Ta 226,16,25600
Mvaa 192,192,40
buffer_load_dwordx4 a[112:115], v10, s[20:23], s58 offen offset:3072 sc1
Mvaa 224,192,44
buffer_store_dwordx4 v[40:43], v2, s[24:27], s37 offen offset:0 sc1
Mvaa 132,196,32
Ta 228,17,24576
Ta 230,17,25600
Mvaa 164,196,36
Mvaa 196,196,40
Mvaa 228,196,44
Ta 232,18,24576
Ta 234,18,25600
Mvaa 136,200,32
Mvaa 168,200,36
buffer_load_dwordx4 a[116:119], v10, s[20:23], 0 offen offset:3072 sc1
Mvaa 200,200,40
Ta 236,19,24576
Ta 238,19,25600
Mvaa 232,200,44
Mvaa 140,204,32
Mvaa 172,204,36
Ta 240,20,24576
Ta 242,20,25600
Mvaa 204,204,40
Mvaa 236,204,44
Mvaa 144,208,32
s_waitcnt lgkmcnt(6)
Ta 244,21,24576
Ta 246,21,25600
Mvaa 176,208,36
buffer_store_dwordx4 v[44:47], v2, s[24:27], s37 offen offset:1024 sc1
Mvaa 208,208,40
buffer_load_dwordx4 a[120:123], v11, s[20:23], s58 offen offset:3072 sc1
Mvaa 240,208,44
Ta 248,22,24576
Ta 250,22,25600
Mvaa 148,212,32
Mvaa 180,212,36
Mvaa 212,212,40
Ta 252,23,24576
Ta 254,23,25600
Mvaa 244,212,44
Mvaa 152,216,32
Mvaa 184,216,36
Mvaa 216,216,40
buffer_load_dwordx4 a[124:127], v11, s[20:23], 0 offen offset:3072 sc1
v_add_u32 v10, 4096, v10
v_add_u32 v11, 4096, v11
Mvaa 248,216,44
Mvaa 156,220,32
Mvaa 188,220,36
Mvaa 220,220,40
Mvaa 252,220,44
s_waitcnt vmcnt(27) lgkmcnt(0)
s_barrier
Mvaa 128,224,48
buffer_store_dwordx4 v[48:51], v2, s[24:27], s37 offen offset:2048 sc1
Mvaa 160,224,52
s_add_u32 m0, s44, 16384
Ta 192,16,32768
Ta 194,16,33792
Mvaa 192,224,56
buffer_load_dwordx4 v8, s[8:11], s48 offen offset:0 lds
Mvaa 224,224,60
Mvaa 132,228,48
Ta 196,17,32768
Ta 198,17,33792
Mvaa 164,228,52
buffer_load_dwordx4 v8, s[8:11], s49 offen offset:1024 lds
Mvaa 196,228,56
Mvaa 228,228,60
Ta 200,18,32768
Ta 202,18,33792
Mvaa 136,232,48
Mvaa 168,232,52
buffer_load_dwordx4 v9, s[8:11], s50 offen offset:2048 lds
Mvaa 200,232,56
Ta 204,19,32768
Ta 206,19,33792
Mvaa 232,232,60
Mvaa 140,236,48
Mvaa 172,236,52
Ta 208,20,32768
Ta 210,20,33792
Mvaa 204,236,56
buffer_load_dwordx4 v9, s[8:11], s51 offen offset:3072 lds
v_add_u32 v8, 524288, v8
v_add_u32 v9, 524288, v9
Mvaa 236,236,60
Mvaa 144,240,48
s_waitcnt lgkmcnt(6)
Ta 212,21,32768
Ta 214,21,33792
Mvaa 176,240,52
buffer_store_dwordx4 v[52:55], v2, s[24:27], s37 offen offset:3072 sc1
Mvaa 208,240,56
buffer_load_dwordx4 a[0:3], v10, s[20:23], s58 offen offset:0 sc1
Mvaa 240,240,60
Ta 216,22,32768
Ta 218,22,33792
Mvaa 148,244,48
Mvaa 180,244,52
Mvaa 212,244,56
Ta 220,23,32768
Ta 222,23,33792
Mvaa 244,244,60
buffer_load_dwordx4 a[4:7], v10, s[20:23], 0 offen offset:0 sc1
Mvaa 152,248,48
Mvaa 184,248,52
Mvaa 216,248,56
buffer_load_dwordx4 a[8:11], v11, s[20:23], s58 offen offset:0 sc1
Mvaa 248,248,60
Mvaa 156,252,48
Mvaa 188,252,52
buffer_load_dwordx4 a[12:15], v11, s[20:23], 0 offen offset:0 sc1
Mvaa 220,252,56
Mvaa 252,252,60
s_waitcnt vmcnt(31) lgkmcnt(0)
Mvaa 128,192,64
s_add_u32 s37, s38, 8192
Mvaa 160,192,68
Ta 224,16,40960
Ta 226,16,41984
Mvaa 192,192,72
buffer_load_dwordx4 a[16:19], v10, s[20:23], s58 offen offset:1024 sc1
Mvaa 224,192,76
buffer_store_dwordx4 v[56:59], v2, s[24:27], s37 offen offset:0 sc1
Mvaa 132,196,64
Ta 228,17,40960
Ta 230,17,41984
Mvaa 164,196,68
Ar 48,128
Ar 49,129
Mvaa 196,196,72
Ar 50,130
Ar 51,131
Mvaa 228,196,76
Ta 232,18,40960
Ta 234,18,41984
Mvaa 136,200,64
Ar 52,132
Ar 53,133
Mvaa 168,200,68
buffer_load_dwordx4 a[20:23], v10, s[20:23], 0 offen offset:1024 sc1
Mvaa 200,200,72
Ta 236,19,40960
Ta 238,19,41984
Mvaa 232,200,76
Ar 54,134
Ar 55,135
Mvaa 140,204,64
Vc 24,48,49
Vc 25,50,51
Mvaa 172,204,68
Ta 240,20,40960
Ta 242,20,41984
Mvaa 204,204,72
Vc 26,52,53
Vc 27,54,55
Mvaa 236,204,76
Mvaa 144,208,64
s_waitcnt lgkmcnt(6)
Ta 244,21,40960
Ta 246,21,41984
Mvaa 176,208,68
buffer_store_dwordx4 v[60:63], v2, s[24:27], s37 offen offset:1024 sc1
Mvaa 208,208,72
buffer_load_dwordx4 a[24:27], v11, s[20:23], s58 offen offset:1024 sc1
Mvaa 240,208,76
Ta 248,22,40960
Ta 250,22,41984
Mvaa 148,212,64
Ar 48,136
Ar 49,137
Mvaa 180,212,68
Ar 50,138
Ar 51,139
Mvaa 212,212,72
Ta 252,23,40960
Ta 254,23,41984
Mvaa 244,212,76
Ar 52,140
Ar 53,141
Mvaa 152,216,64
Ar 54,142
Ar 55,143
Mvaa 184,216,68
Vc 28,48,49
Vc 29,50,51
Mvaa 216,216,72
buffer_load_dwordx4 a[28:31], v11, s[20:23], 0 offen offset:1024 sc1
Mvaa 248,216,76
Vc 30,52,53
Vc 31,54,55
Mvaa 156,220,64
Mvaa 188,220,68
Mvaa 220,220,72
Mvaa 252,220,76
s_waitcnt vmcnt(32) lgkmcnt(0)
s_barrier
Mvaa 128,224,80
buffer_store_dwordx4 v[64:67], v2, s[24:27], s37 offen offset:2048 sc1
Mvaa 160,224,84
s_add_u32 m0, s44, 32768
Ta 192,16,49152
Ta 194,16,50176
Mvaa 192,224,88
buffer_load_dwordx4 v8, s[8:11], s48 offen offset:0 lds
Mvaa 224,224,92
Ar 48,144
Ar 49,145
Mvaa 132,228,80
Ta 196,17,49152
Ta 198,17,50176
Mvaa 164,228,84
buffer_load_dwordx4 v8, s[8:11], s49 offen offset:1024 lds
Mvaa 196,228,88
Ar 50,146
Ar 51,147
Mvaa 228,228,92
Ta 200,18,49152
Ta 202,18,50176
Mvaa 136,232,80
Ar 52,148
Ar 53,149
Mvaa 168,232,84
buffer_load_dwordx4 v9, s[8:11], s50 offen offset:2048 lds
Mvaa 200,232,88
Ta 204,19,49152
Ta 206,19,50176
Mvaa 232,232,92
Ar 54,150
Ar 55,151
Mvaa 140,236,80
Vc 32,48,49
Vc 33,50,51
Mvaa 172,236,84
Ta 208,20,49152
Ta 210,20,50176
Mvaa 204,236,88
buffer_load_dwordx4 v9, s[8:11], s51 offen offset:3072 lds
v_add_u32 v8, 524288, v8
v_add_u32 v9, 524288, v9
Mvaa 236,236,92
Vc 34,52,53
Vc 35,54,55
Mvaa 144,240,80
s_waitcnt lgkmcnt(6)
Ta 212,21,49152
Ta 214,21,50176
Mvaa 176,240,84
buffer_store_dwordx4 v[68:71], v2, s[24:27], s37 offen offset:3072 sc1
Mvaa 208,240,88
buffer_load_dwordx4 a[32:35], v10, s[20:23], s58 offen offset:2048 sc1
Mvaa 240,240,92
Ta 216,22,49152
Ta 218,22,50176
Mvaa 148,244,80
Ar 48,152
Ar 49,153
Mvaa 180,244,84
Ar 50,154
Ar 51,155
Mvaa 212,244,88
Ta 220,23,49152
Ta 222,23,50176
Mvaa 244,244,92
buffer_load_dwordx4 a[36:39], v10, s[20:23], 0 offen offset:2048 sc1
Mvaa 152,248,80
Ar 52,156
Ar 53,157
Mvaa 184,248,84
Ar 54,158
Ar 55,159
Mvaa 216,248,88
buffer_load_dwordx4 a[40:43], v11, s[20:23], s58 offen offset:2048 sc1
Mvaa 248,248,92
Vc 36,48,49
Vc 37,50,51
Mvaa 156,252,80
Vc 38,52,53
Vc 39,54,55
Mvaa 188,252,84
buffer_load_dwordx4 a[44:47], v11, s[20:23], 0 offen offset:2048 sc1
Mvaa 220,252,88
global_load_dword v13, v[14:15], off
Mvaa 252,252,92
s_waitcnt vmcnt(33) lgkmcnt(0)
Mvaa 128,192,96
s_add_u32 s37, s38, 12288
Mvaa 160,192,100
Ta 224,16,57344
Ta 226,16,58368
Mvaa 192,192,104
buffer_load_dwordx4 a[48:51], v10, s[20:23], s58 offen offset:3072 sc1
Mvaa 224,192,108
buffer_store_dwordx4 v[72:75], v2, s[24:27], s37 offen offset:0 sc1
Mvaa 132,196,96
Ta 228,17,57344
Ta 230,17,58368
Mvaa 164,196,100
Ar 48,160
Ar 49,161
Mvaa 196,196,104
Ar 50,162
Ar 51,163
Mvaa 228,196,108
Ta 232,18,57344
Ta 234,18,58368
Mvaa 136,200,96
Ar 52,164
Ar 53,165
Mvaa 168,200,100
buffer_load_dwordx4 a[52:55], v10, s[20:23], 0 offen offset:3072 sc1
Mvaa 200,200,104
Ta 236,19,57344
Ta 238,19,58368
Mvaa 232,200,108
Ar 54,166
Ar 55,167
Mvaa 140,204,96
Vc 40,48,49
Vc 41,50,51
Mvaa 172,204,100
Ta 240,20,57344
Ta 242,20,58368
Mvaa 204,204,104
Vc 42,52,53
Vc 43,54,55
Mvaa 236,204,108
Mvaa 144,208,96
s_waitcnt lgkmcnt(6)
Ta 244,21,57344
Ta 246,21,58368
Mvaa 176,208,100
buffer_store_dwordx4 v[76:79], v2, s[24:27], s37 offen offset:1024 sc1
Mvaa 208,208,104
buffer_load_dwordx4 a[56:59], v11, s[20:23], s58 offen offset:3072 sc1
Mvaa 240,208,108
Ta 248,22,57344
Ta 250,22,58368
Mvaa 148,212,96
Ar 48,168
Ar 49,169
Mvaa 180,212,100
Ar 50,170
Ar 51,171
Mvaa 212,212,104
Ta 252,23,57344
Ta 254,23,58368
Mvaa 244,212,108
Ar 52,172
Ar 53,173
Mvaa 152,216,96
Ar 54,174
Ar 55,175
Mvaa 184,216,100
Vc 44,48,49
Vc 45,50,51
Mvaa 216,216,104
buffer_load_dwordx4 a[60:63], v11, s[20:23], 0 offen offset:3072 sc1
v_add_u32 v10, 4096, v10
v_add_u32 v11, 4096, v11
Mvaa 248,216,108
Vc 46,52,53
Vc 47,54,55
Mvaa 156,220,96
Mvaa 188,220,100
Mvaa 220,220,104
Mvaa 252,220,108
s_waitcnt vmcnt(33) lgkmcnt(0)
s_barrier
Mvaa 128,224,112
buffer_store_dwordx4 v[80:83], v2, s[24:27], s37 offen offset:2048 sc1
Mvaa 160,224,116
s_add_u32 m0, s44, 49152
Ta 192,16,0
Ta 194,16,1024
Mvaa 192,224,120
buffer_load_dwordx4 v8, s[8:11], s48 offen offset:0 lds
Mvaa 224,224,124
Mvaa 132,228,112
Ta 196,17,0
Ta 198,17,1024
Mvaa 164,228,116
buffer_load_dwordx4 v8, s[8:11], s49 offen offset:1024 lds
Mvaa 196,228,120
Mvaa 228,228,124
Ta 200,18,0
Ta 202,18,1024
Mvaa 136,232,112
Mvaa 168,232,116
buffer_load_dwordx4 v9, s[8:11], s50 offen offset:2048 lds
Mvaa 200,232,120
Ta 204,19,0
Ta 206,19,1024
Mvaa 232,232,124
Mvaa 140,236,112
Mvaa 172,236,116
Ta 208,20,0
Ta 210,20,1024
Mvaa 204,236,120
buffer_load_dwordx4 v9, s[8:11], s51 offen offset:3072 lds
v_add_u32 v8, 524288, v8
v_add_u32 v9, 524288, v9
Mvaa 236,236,124
Mvaa 144,240,112
s_waitcnt lgkmcnt(6)
Ta 212,21,0
Ta 214,21,1024
Mvaa 176,240,116
buffer_store_dwordx4 v[84:87], v2, s[24:27], s37 offen offset:3072 sc1
Mvaa 208,240,120
buffer_load_dwordx4 a[64:67], v10, s[20:23], s58 offen offset:0 sc1
Mvaa 240,240,124
Ta 216,22,0
Ta 218,22,1024
Mvaa 148,244,112
Mvaa 180,244,116
Mvaa 212,244,120
Ta 220,23,0
Ta 222,23,1024
Mvaa 244,244,124
buffer_load_dwordx4 a[68:71], v10, s[20:23], 0 offen offset:0 sc1
Mvaa 152,248,112
Mvaa 184,248,116
Mvaa 216,248,120
buffer_load_dwordx4 a[72:75], v11, s[20:23], s58 offen offset:0 sc1
Mvaa 248,248,124
Mvaa 156,252,112
Mvaa 188,252,116
buffer_load_dwordx4 a[76:79], v11, s[20:23], 0 offen offset:0 sc1
Mvaa 220,252,120
Mvaa 252,252,124
s_waitcnt vmcnt(33) lgkmcnt(0)
Mvaa 128,192,0
s_add_u32 s37, s38, 34816
Mvaa 160,192,4
Ta 224,16,8192
Ta 226,16,9216
Mvaa 192,192,8
buffer_load_dwordx4 a[80:83], v10, s[20:23], s58 offen offset:1024 sc1
Mvaa 224,192,12
buffer_store_dwordx4 v[88:91], v2, s[24:27], s37 offen offset:0 sc1
Mvaa 132,196,0
Ta 228,17,8192
Ta 230,17,9216
Mvaa 164,196,4
Mvaa 196,196,8
Mvaa 228,196,12
Ta 232,18,8192
Ta 234,18,9216
Mvaa 136,200,0
Mvaa 168,200,4
buffer_load_dwordx4 a[84:87], v10, s[20:23], 0 offen offset:1024 sc1
Mvaa 200,200,8
Ta 236,19,8192
Ta 238,19,9216
Mvaa 232,200,12
Mvaa 140,204,0
Mvaa 172,204,4
Ta 240,20,8192
Ta 242,20,9216
Mvaa 204,204,8
Mvaa 236,204,12
Mvaa 144,208,0
s_waitcnt lgkmcnt(6)
Ta 244,21,8192
Ta 246,21,9216
Mvaa 176,208,4
buffer_store_dwordx4 v[92:95], v2, s[24:27], s37 offen offset:1024 sc1
Mvaa 208,208,8
buffer_load_dwordx4 a[88:91], v11, s[20:23], s58 offen offset:1024 sc1
Mvaa 240,208,12
Ta 248,22,8192
Ta 250,22,9216
Mvaa 148,212,0
s_mov_b32 s3, 5242880
s_mov_b32 s47, 5246976
Mvaa 180,212,4
buffer_load_dwordx4 v[56:59], v2, s[20:23], s3 offen offset:0 sc1
Mvaa 212,212,8
Ta 252,23,8192
Ta 254,23,9216
Mvaa 244,212,12
buffer_load_dwordx4 v[60:63], v2, s[20:23], s3 offen offset:1024 sc1
Mvaa 152,216,0
buffer_load_dwordx4 v[64:67], v2, s[20:23], s3 offen offset:2048 sc1
Mvaa 184,216,4
buffer_load_dwordx4 v[68:71], v2, s[20:23], s3 offen offset:3072 sc1
Mvaa 216,216,8
buffer_load_dwordx4 a[92:95], v11, s[20:23], 0 offen offset:1024 sc1
Mvaa 248,216,12
buffer_load_dwordx4 v[72:75], v2, s[20:23], s47 offen offset:0 sc1
Mvaa 156,220,0
buffer_load_dwordx4 v[76:79], v2, s[20:23], s47 offen offset:1024 sc1
Mvaa 188,220,4
buffer_load_dwordx4 v[80:83], v2, s[20:23], s47 offen offset:2048 sc1
Mvaa 220,220,8
buffer_load_dwordx4 v[84:87], v2, s[20:23], s47 offen offset:3072 sc1
Mvaa 252,220,12
s_waitcnt vmcnt(41) lgkmcnt(0)
s_barrier
Mvaa 128,224,16
buffer_store_dwordx4 v[96:99], v2, s[24:27], s37 offen offset:2048 sc1
Mvaa 160,224,20
s_add_u32 m0, s44, 0
Ta 192,16,16384
Ta 194,16,17408
Mvaa 192,224,24
buffer_load_dwordx4 v8, s[8:11], s48 offen offset:0 lds
Mvaa 224,224,28
Mvaa 132,228,16
Ta 196,17,16384
Ta 198,17,17408
Mvaa 164,228,20
buffer_load_dwordx4 v8, s[8:11], s49 offen offset:1024 lds
Mvaa 196,228,24
Mvaa 228,228,28
Ta 200,18,16384
Ta 202,18,17408
Mvaa 136,232,16
Mvaa 168,232,20
buffer_load_dwordx4 v9, s[8:11], s50 offen offset:2048 lds
Mvaa 200,232,24
Ta 204,19,16384
Ta 206,19,17408
Mvaa 232,232,28
Mvaa 140,236,16
Mvaa 172,236,20
Ta 208,20,16384
Ta 210,20,17408
Mvaa 204,236,24
buffer_load_dwordx4 v9, s[8:11], s51 offen offset:3072 lds
v_add_u32 v8, 524288, v8
v_add_u32 v9, 524288, v9
Mvaa 236,236,28
Mvaa 144,240,16
s_waitcnt lgkmcnt(6)
Ta 212,21,16384
Ta 214,21,17408
Mvaa 176,240,20
buffer_store_dwordx4 v[100:103], v2, s[24:27], s37 offen offset:3072 sc1
Mvaa 208,240,24
buffer_load_dwordx4 a[96:99], v10, s[20:23], s58 offen offset:2048 sc1
Mvaa 240,240,28
Ta 216,22,16384
Ta 218,22,17408
Mvaa 148,244,16
Mvaa 180,244,20
Mvaa 212,244,24
Ta 220,23,16384
Ta 222,23,17408
Mvaa 244,244,28
buffer_load_dwordx4 a[100:103], v10, s[20:23], 0 offen offset:2048 sc1
Mvaa 152,248,16
Mvaa 184,248,20
Mvaa 216,248,24
buffer_load_dwordx4 a[104:107], v11, s[20:23], s58 offen offset:2048 sc1
Mvaa 248,248,28
Mvaa 156,252,16
Mvaa 188,252,20
buffer_load_dwordx4 a[108:111], v11, s[20:23], 0 offen offset:2048 sc1
Mvaa 220,252,24
Mvaa 252,252,28
s_waitcnt vmcnt(41) lgkmcnt(0)
Mvaa 128,192,32
s_add_u32 s37, s38, 38912
Mvaa 160,192,36
Ta 224,16,24576
Ta 226,16,25600
Mvaa 192,192,40
buffer_load_dwordx4 a[112:115], v10, s[20:23], s58 offen offset:3072 sc1
Mvaa 224,192,44
buffer_store_dwordx4 v[104:107], v2, s[24:27], s37 offen offset:0 sc1
Mvaa 132,196,32
Ta 228,17,24576
Ta 230,17,25600
Mvaa 164,196,36
Mvaa 196,196,40
Mvaa 228,196,44
Ta 232,18,24576
Ta 234,18,25600
Mvaa 136,200,32
Mvaa 168,200,36
buffer_load_dwordx4 a[116:119], v10, s[20:23], 0 offen offset:3072 sc1
Mvaa 200,200,40
Ta 236,19,24576
Ta 238,19,25600
Mvaa 232,200,44
Mvaa 140,204,32
Mvaa 172,204,36
Ta 240,20,24576
Ta 242,20,25600
Mvaa 204,204,40
Mvaa 236,204,44
Mvaa 144,208,32
s_waitcnt lgkmcnt(6)
Ta 244,21,24576
Ta 246,21,25600
Mvaa 176,208,36
buffer_store_dwordx4 v[108:111], v2, s[24:27], s37 offen offset:1024 sc1
Mvaa 208,208,40
buffer_load_dwordx4 a[120:123], v11, s[20:23], s58 offen offset:3072 sc1
Mvaa 240,208,44
Ta 248,22,24576
Ta 250,22,25600
Mvaa 148,212,32
Mvaa 180,212,36
Mvaa 212,212,40
Ta 252,23,24576
Ta 254,23,25600
Mvaa 244,212,44
Mvaa 152,216,32
Mvaa 184,216,36
Mvaa 216,216,40
buffer_load_dwordx4 a[124:127], v11, s[20:23], 0 offen offset:3072 sc1
v_add_u32 v10, 4096, v10
v_add_u32 v11, 4096, v11
Mvaa 248,216,44
Mvaa 156,220,32
Mvaa 188,220,36
Mvaa 220,220,40
Mvaa 252,220,44
s_waitcnt vmcnt(40) lgkmcnt(0)
s_barrier
Mvaa 128,224,48
buffer_store_dwordx4 v[112:115], v2, s[24:27], s37 offen offset:2048 sc1
Mvaa 160,224,52
s_add_u32 m0, s44, 16384
Ta 192,16,32768
Ta 194,16,33792
Mvaa 192,224,56
buffer_load_dwordx4 v8, s[8:11], s48 offen offset:0 lds
Mvaa 224,224,60
Mvaa 132,228,48
Ta 196,17,32768
Ta 198,17,33792
Mvaa 164,228,52
buffer_load_dwordx4 v8, s[8:11], s49 offen offset:1024 lds
Mvaa 196,228,56
Mvaa 228,228,60
Ta 200,18,32768
Ta 202,18,33792
Mvaa 136,232,48
Mvaa 168,232,52
buffer_load_dwordx4 v9, s[8:11], s50 offen offset:2048 lds
Mvaa 200,232,56
Ta 204,19,32768
Ta 206,19,33792
Mvaa 232,232,60
Mvaa 140,236,48
Mvaa 172,236,52
Ta 208,20,32768
Ta 210,20,33792
Mvaa 204,236,56
buffer_load_dwordx4 v9, s[8:11], s51 offen offset:3072 lds
v_add_u32 v8, 524288, v8
v_add_u32 v9, 524288, v9
Mvaa 236,236,60
Mvaa 144,240,48
s_waitcnt lgkmcnt(6)
Ta 212,21,32768
Ta 214,21,33792
Mvaa 176,240,52
buffer_store_dwordx4 v[116:119], v2, s[24:27], s37 offen offset:3072 sc1
Mvaa 208,240,56
buffer_load_dwordx4 a[0:3], v10, s[20:23], s58 offen offset:0 sc1
Mvaa 240,240,60
Ta 216,22,32768
Ta 218,22,33792
Mvaa 148,244,48
Mvaa 180,244,52
Mvaa 212,244,56
Ta 220,23,32768
Ta 222,23,33792
Mvaa 244,244,60
buffer_load_dwordx4 a[4:7], v10, s[20:23], 0 offen offset:0 sc1
Mvaa 152,248,48
Mvaa 184,248,52
Mvaa 216,248,56
buffer_load_dwordx4 a[8:11], v11, s[20:23], s58 offen offset:0 sc1
Mvaa 248,248,60
Mvaa 156,252,48
Mvaa 188,252,52
buffer_load_dwordx4 a[12:15], v11, s[20:23], 0 offen offset:0 sc1
Mvaa 220,252,56
Mvaa 252,252,60
s_waitcnt vmcnt(40) lgkmcnt(0)
Mvaa 128,192,64
s_add_u32 s37, s38, 43008
Mvaa 160,192,68
Ta 224,16,40960
Ta 226,16,41984
Mvaa 192,192,72
buffer_load_dwordx4 a[16:19], v10, s[20:23], s58 offen offset:1024 sc1
Mvaa 224,192,76
buffer_store_dwordx4 v[120:123], v2, s[24:27], s37 offen offset:0 sc1
Mvaa 132,196,64
Ta 228,17,40960
Ta 230,17,41984
Mvaa 164,196,68
Mvaa 196,196,72
Mvaa 228,196,76
Ta 232,18,40960
Ta 234,18,41984
Mvaa 136,200,64
Mvaa 168,200,68
buffer_load_dwordx4 a[20:23], v10, s[20:23], 0 offen offset:1024 sc1
Mvaa 200,200,72
Ta 236,19,40960
Ta 238,19,41984
Mvaa 232,200,76
Mvaa 140,204,64
Mvaa 172,204,68
Ta 240,20,40960
Ta 242,20,41984
Mvaa 204,204,72
Mvaa 236,204,76
Mvaa 144,208,64
s_waitcnt lgkmcnt(6)
Ta 244,21,40960
Ta 246,21,41984
Mvaa 176,208,68
buffer_store_dwordx4 v[124:127], v2, s[24:27], s37 offen offset:1024 sc1
Mvaa 208,208,72
buffer_load_dwordx4 a[24:27], v11, s[20:23], s58 offen offset:1024 sc1
Mvaa 240,208,76
Ta 248,22,40960
Ta 250,22,41984
Mvaa 148,212,64
Mvaa 180,212,68
Mvaa 212,212,72
Ta 252,23,40960
Ta 254,23,41984
Mvaa 244,212,76
Mvaa 152,216,64
Mvaa 184,216,68
Mvaa 216,216,72
buffer_load_dwordx4 a[28:31], v11, s[20:23], 0 offen offset:1024 sc1
Mvaa 248,216,76
Mvaa 156,220,64
Mvaa 188,220,68
Mvaa 220,220,72
Mvaa 252,220,76
s_waitcnt vmcnt(36) lgkmcnt(0)
s_barrier
Mvaa 128,224,80
buffer_store_dwordx4 v[24:27], v2, s[24:27], s37 offen offset:2048 sc1
Mvaa 160,224,84
s_add_u32 m0, s44, 32768
Ta 192,16,49152
Ta 194,16,50176
Mvaa 192,224,88
buffer_load_dwordx4 v8, s[8:11], s48 offen offset:0 lds
Mvaa 224,224,92
Mvaa 132,228,80
Ta 196,17,49152
Ta 198,17,50176
Mvaa 164,228,84
buffer_load_dwordx4 v8, s[8:11], s49 offen offset:1024 lds
Mvaa 196,228,88
Mvaa 228,228,92
Ta 200,18,49152
Ta 202,18,50176
Mvaa 136,232,80
Mvaa 168,232,84
buffer_load_dwordx4 v9, s[8:11], s50 offen offset:2048 lds
Mvaa 200,232,88
Ta 204,19,49152
Ta 206,19,50176
Mvaa 232,232,92
Mvaa 140,236,80
Mvaa 172,236,84
Ta 208,20,49152
Ta 210,20,50176
Mvaa 204,236,88
buffer_load_dwordx4 v9, s[8:11], s51 offen offset:3072 lds
v_add_u32 v8, 524288, v8
v_add_u32 v9, 524288, v9
Mvaa 236,236,92
Mvaa 144,240,80
s_waitcnt lgkmcnt(6)
Ta 212,21,49152
Ta 214,21,50176
Mvaa 176,240,84
buffer_store_dwordx4 v[28:31], v2, s[24:27], s37 offen offset:3072 sc1
Mvaa 208,240,88
buffer_load_dwordx4 a[32:35], v10, s[20:23], s58 offen offset:2048 sc1
Mvaa 240,240,92
Ta 216,22,49152
Ta 218,22,50176
Mvaa 148,244,80
Mvaa 180,244,84
Mvaa 212,244,88
Ta 220,23,49152
Ta 222,23,50176
Mvaa 244,244,92
buffer_load_dwordx4 a[36:39], v10, s[20:23], 0 offen offset:2048 sc1
Mvaa 152,248,80
Mvaa 184,248,84
Mvaa 216,248,88
buffer_load_dwordx4 a[40:43], v11, s[20:23], s58 offen offset:2048 sc1
Mvaa 248,248,92
Mvaa 156,252,80
Mvaa 188,252,84
buffer_load_dwordx4 a[44:47], v11, s[20:23], 0 offen offset:2048 sc1
Mvaa 220,252,88
Mvaa 252,252,92
s_waitcnt vmcnt(32) lgkmcnt(0)
Mvaa 128,192,96
s_add_u32 s37, s38, 47104
Mvaa 160,192,100
Ta 224,16,57344
Ta 226,16,58368
Mvaa 192,192,104
buffer_load_dwordx4 a[48:51], v10, s[20:23], s58 offen offset:3072 sc1
Mvaa 224,192,108
buffer_store_dwordx4 v[32:35], v2, s[24:27], s37 offen offset:0 sc1
Mvaa 132,196,96
Ta 228,17,57344
Ta 230,17,58368
Mvaa 164,196,100
Mvaa 196,196,104
Mvaa 228,196,108
Ta 232,18,57344
Ta 234,18,58368
Mvaa 136,200,96
Mvaa 168,200,100
buffer_load_dwordx4 a[52:55], v10, s[20:23], 0 offen offset:3072 sc1
Mvaa 200,200,104
Ta 236,19,57344
Ta 238,19,58368
Mvaa 232,200,108
Mvaa 140,204,96
Mvaa 172,204,100
Ta 240,20,57344
Ta 242,20,58368
Mvaa 204,204,104
Mvaa 236,204,108
Mvaa 144,208,96
s_waitcnt lgkmcnt(6)
Ta 244,21,57344
Ta 246,21,58368
Mvaa 176,208,100
buffer_store_dwordx4 v[36:39], v2, s[24:27], s37 offen offset:1024 sc1
Mvaa 208,208,104
buffer_load_dwordx4 a[56:59], v11, s[20:23], s58 offen offset:3072 sc1
Mvaa 240,208,108
Ta 248,22,57344
Ta 250,22,58368
Mvaa 148,212,96
Mvaa 180,212,100
Mvaa 212,212,104
Ta 252,23,57344
Ta 254,23,58368
Mvaa 244,212,108
Mvaa 152,216,96
Mvaa 184,216,100
Mvaa 216,216,104
buffer_load_dwordx4 a[60:63], v11, s[20:23], 0 offen offset:3072 sc1
v_add_u32 v10, 4096, v10
v_add_u32 v11, 4096, v11
Mvaa 248,216,108
Mvaa 156,220,96
Mvaa 188,220,100
Mvaa 220,220,104
Mvaa 252,220,108
s_waitcnt vmcnt(32) lgkmcnt(0)
s_barrier
Mvaa 128,224,112
buffer_store_dwordx4 v[40:43], v2, s[24:27], s37 offen offset:2048 sc1
Mvaa 160,224,116
s_add_u32 m0, s44, 49152
Ta 192,16,0
Ta 194,16,1024
Mvaa 192,224,120
buffer_load_dwordx4 v8, s[8:11], s48 offen offset:0 lds
Mvaa 224,224,124
Mvaa 132,228,112
Ta 196,17,0
Ta 198,17,1024
Mvaa 164,228,116
buffer_load_dwordx4 v8, s[8:11], s49 offen offset:1024 lds
Mvaa 196,228,120
Mvaa 228,228,124
Ta 200,18,0
Ta 202,18,1024
Mvaa 136,232,112
Mvaa 168,232,116
buffer_load_dwordx4 v9, s[8:11], s50 offen offset:2048 lds
Mvaa 200,232,120
Ta 204,19,0
Ta 206,19,1024
Mvaa 232,232,124
Mvaa 140,236,112
Mvaa 172,236,116
Ta 208,20,0
Ta 210,20,1024
Mvaa 204,236,120
buffer_load_dwordx4 v9, s[8:11], s51 offen offset:3072 lds
v_add_u32 v8, 524288, v8
v_add_u32 v9, 524288, v9
Mvaa 236,236,124
Mvaa 144,240,112
s_waitcnt lgkmcnt(6)
Ta 212,21,0
Ta 214,21,1024
Mvaa 176,240,116
buffer_store_dwordx4 v[44:47], v2, s[24:27], s37 offen offset:3072 sc1
Mvaa 208,240,120
buffer_load_dwordx4 a[64:67], v10, s[20:23], s58 offen offset:0 sc1
Mvaa 240,240,124
Ta 216,22,0
Ta 218,22,1024
Mvaa 148,244,112
v_mov_b32 v12, 1
v_and_b32_e64 v1, 15, v0
Mvaa 180,244,116
v_lshlrev_b32_e64 v1, 2, v1
Mvaa 212,244,120
Ta 220,23,0
Ta 222,23,1024
Mvaa 244,244,124
buffer_load_dwordx4 a[68:71], v10, s[20:23], 0 offen offset:0 sc1
Mvaa 152,248,112
s_lshr_b32 s6, s33, 1
s_lshl_b32 s6, s6, 7
s_add_u32 s6, s6, 5296128
Mvaa 184,248,116
s_cmp_eq_u32 s32, 0
s_cselect_b32 s6, s6, 2146435072
Mvaa 216,248,120
buffer_load_dwordx4 a[72:75], v11, s[20:23], s58 offen offset:0 sc1
Mvaa 248,248,124
Mvaa 156,252,112
Mvaa 188,252,116
buffer_load_dwordx4 a[76:79], v11, s[20:23], 0 offen offset:0 sc1
Mvaa 220,252,120
Mvaa 252,252,124
s_waitcnt vmcnt(32) lgkmcnt(0)
Mvaa 128,192,0
Mvaa 160,192,4
Ta 224,16,8192
Ta 226,16,9216
Mvaa 192,192,8
buffer_load_dwordx4 a[80:83], v10, s[20:23], s58 offen offset:1024 sc1
Mvaa 224,192,12
Mvaa 132,196,0
Ta 228,17,8192
Ta 230,17,9216
Mvaa 164,196,4
Mvaa 196,196,8
Mvaa 228,196,12
Ta 232,18,8192
Ta 234,18,9216
Mvaa 136,200,0
Mvaa 168,200,4
buffer_load_dwordx4 a[84:87], v10, s[20:23], 0 offen offset:1024 sc1
Mvaa 200,200,8
Ta 236,19,8192
Ta 238,19,9216
Mvaa 232,200,12
Mvaa 140,204,0
Mvaa 172,204,4
Ta 240,20,8192
Ta 242,20,9216
Mvaa 204,204,8
Mvaa 236,204,12
Mvaa 144,208,0
s_waitcnt lgkmcnt(6)
Ta 244,21,8192
Ta 246,21,9216
Mvaa 176,208,4
v_max_u32 v14, v56, v57
v_min_u32_e64 v15, v56, v57
Mvaa 208,208,8
buffer_load_dwordx4 a[88:91], v11, s[20:23], s58 offen offset:1024 sc1
Mvaa 240,208,12
Ta 248,22,8192
Ta 250,22,9216
Mvaa 148,212,0
v_med3_u32 v15, v14, v15, v58
v_max_u32_e64 v14, v14, v58
Mvaa 180,212,4
v_med3_u32 v15, v14, v15, v59
v_max_u32_e64 v14, v14, v59
Mvaa 212,212,8
Ta 252,23,8192
Ta 254,23,9216
Mvaa 244,212,12
v_med3_u32 v15, v14, v15, v60
v_max_u32_e64 v14, v14, v60
Mvaa 152,216,0
v_med3_u32 v15, v14, v15, v61
v_max_u32_e64 v14, v14, v61
Mvaa 184,216,4
v_med3_u32 v15, v14, v15, v62
v_max_u32_e64 v14, v14, v62
Mvaa 216,216,8
buffer_load_dwordx4 a[92:95], v11, s[20:23], 0 offen offset:1024 sc1
Mvaa 248,216,12
v_med3_u32 v15, v14, v15, v63
v_max_u32_e64 v14, v14, v63
Mvaa 156,220,0
v_med3_u32 v15, v14, v15, v64
v_max_u32_e64 v14, v14, v64
Mvaa 188,220,4
v_med3_u32 v15, v14, v15, v65
v_max_u32_e64 v14, v14, v65
Mvaa 220,220,8
v_med3_u32 v15, v14, v15, v66
v_max_u32_e64 v14, v14, v66
Mvaa 252,220,12
v_med3_u32 v15, v14, v15, v67
v_max_u32 v14, v14, v67
s_waitcnt vmcnt(30) lgkmcnt(0)
s_barrier
Mvaa 128,224,16
v_med3_u32 v15, v14, v15, v68
v_max_u32 v14, v14, v68
Mvaa 160,224,20
s_add_u32 m0, s44, 0
Ta 192,16,16384
Ta 194,16,17408
Mvaa 192,224,24
buffer_load_dwordx4 v8, s[8:11], s48 offen offset:0 lds
Mvaa 224,224,28
v_med3_u32 v15, v14, v15, v69
v_max_u32 v14, v14, v69
Mvaa 132,228,16
Ta 196,17,16384
Ta 198,17,17408
Mvaa 164,228,20
buffer_load_dwordx4 v8, s[8:11], s49 offen offset:1024 lds
Mvaa 196,228,24
v_med3_u32 v15, v14, v15, v70
v_max_u32_e64 v14, v14, v70
Mvaa 228,228,28
Ta 200,18,16384
Ta 202,18,17408
Mvaa 136,232,16
v_med3_u32 v15, v14, v15, v71
v_max_u32_e64 v14, v14, v71
Mvaa 168,232,20
buffer_load_dwordx4 v9, s[8:11], s50 offen offset:2048 lds
Mvaa 200,232,24
Ta 204,19,16384
Ta 206,19,17408
Mvaa 232,232,28
v_med3_u32 v15, v14, v15, v72
v_max_u32_e64 v14, v14, v72
Mvaa 140,236,16
v_med3_u32 v15, v14, v15, v73
v_max_u32_e64 v14, v14, v73
Mvaa 172,236,20
Ta 208,20,16384
Ta 210,20,17408
Mvaa 204,236,24
buffer_load_dwordx4 v9, s[8:11], s51 offen offset:3072 lds
v_add_u32 v8, 524288, v8
v_add_u32 v9, 524288, v9
Mvaa 236,236,28
v_med3_u32 v15, v14, v15, v74
v_max_u32_e64 v14, v14, v74
Mvaa 144,240,16
s_waitcnt lgkmcnt(6)
Ta 212,21,16384
Ta 214,21,17408
Mvaa 176,240,20
v_med3_u32 v15, v14, v15, v75
v_max_u32 v14, v14, v75
Mvaa 208,240,24
buffer_load_dwordx4 a[96:99], v10, s[20:23], s58 offen offset:2048 sc1
Mvaa 240,240,28
Ta 216,22,16384
Ta 218,22,17408
Mvaa 148,244,16
v_med3_u32 v15, v14, v15, v76
v_max_u32_e64 v14, v14, v76
Mvaa 180,244,20
v_med3_u32 v15, v14, v15, v77
v_max_u32_e64 v14, v14, v77
Mvaa 212,244,24
Ta 220,23,16384
Ta 222,23,17408
Mvaa 244,244,28
buffer_load_dwordx4 a[100:103], v10, s[20:23], 0 offen offset:2048 sc1
Mvaa 152,248,16
v_med3_u32 v15, v14, v15, v78
v_max_u32_e64 v14, v14, v78
Mvaa 184,248,20
v_med3_u32 v15, v14, v15, v79
v_max_u32_e64 v14, v14, v79
Mvaa 216,248,24
buffer_load_dwordx4 a[104:107], v11, s[20:23], s58 offen offset:2048 sc1
Mvaa 248,248,28
v_med3_u32 v15, v14, v15, v80
v_max_u32_e64 v14, v14, v80
Mvaa 156,252,16
v_med3_u32 v15, v14, v15, v81
v_max_u32_e64 v14, v14, v81
Mvaa 188,252,20
buffer_load_dwordx4 a[108:111], v11, s[20:23], 0 offen offset:2048 sc1
Mvaa 220,252,24
v_med3_u32 v15, v14, v15, v82
v_max_u32_e64 v14, v14, v82
Mvaa 252,252,28
v_med3_u32 v15, v14, v15, v83
v_max_u32 v14, v14, v83
s_waitcnt vmcnt(28) lgkmcnt(0)
Mvaa 128,192,32
v_med3_u32 v15, v14, v15, v84
v_max_u32_e64 v14, v14, v84
Mvaa 160,192,36
Ta 224,16,24576
Ta 226,16,25600
Mvaa 192,192,40
buffer_load_dwordx4 a[112:115], v10, s[20:23], s58 offen offset:3072 sc1
Mvaa 224,192,44
v_med3_u32 v15, v14, v15, v85
v_max_u32_e64 v14, v14, v85
Mvaa 132,196,32
Ta 228,17,24576
Ta 230,17,25600
Mvaa 164,196,36
v_med3_u32 v15, v14, v15, v86
v_max_u32_e64 v14, v14, v86
Mvaa 196,196,40
v_med3_u32 v15, v14, v15, v87
v_max_u32_e64 v14, v14, v87
Mvaa 228,196,44
Ta 232,18,24576
Ta 234,18,25600
Mvaa 136,200,32
v_mov_b32_e64 v13, v14
Mvaa 168,200,36
buffer_load_dwordx4 a[116:119], v10, s[20:23], 0 offen offset:3072 sc1
Mvaa 200,200,40
Ta 236,19,24576
Ta 238,19,25600
Mvaa 232,200,44
v_max_u32_dpp v13, v13, v13 quad_perm:[1,0,3,2] row_mask:0xf bank_mask:0xf
Mvaa 140,204,32
s_nop 0
v_max_u32_dpp v13, v13, v13 quad_perm:[2,3,0,1] row_mask:0xf bank_mask:0xf
Mvaa 172,204,36
Ta 240,20,24576
Ta 242,20,25600
Mvaa 204,204,40
v_max_u32_dpp v13, v13, v13 row_half_mirror row_mask:0xf bank_mask:0xf
Mvaa 236,204,44
s_nop 0
v_max_u32_dpp v13, v13, v13 row_mirror row_mask:0xf bank_mask:0xf
Mvaa 144,208,32
s_waitcnt lgkmcnt(6)
Ta 244,21,24576
Ta 246,21,25600
Mvaa 176,208,36
v_readlane_b32 s3, v13, 0
v_readlane_b32 s47, v13, 16
Mvaa 208,208,40
buffer_load_dwordx4 a[120:123], v11, s[20:23], s58 offen offset:3072 sc1
Mvaa 240,208,44
Ta 248,22,24576
Ta 250,22,25600
Mvaa 148,212,32
v_readlane_b32 s4, v13, 32
v_readlane_b32 s5, v13, 48
Mvaa 180,212,36
s_max_u32 s3, s3, s47
s_max_u32 s4, s4, s5
s_max_u32 s40, s3, s4
Mvaa 212,212,40
Ta 252,23,24576
Ta 254,23,25600
Mvaa 244,212,44
v_cmp_eq_u32 vcc, s40, v14
Mvaa 152,216,32
s_nop 0
v_cndmask_b32 v13, v14, v15, vcc
Mvaa 184,216,36
s_nop 0
v_max_u32_dpp v13, v13, v13 quad_perm:[1,0,3,2] row_mask:0xf bank_mask:0xf
Mvaa 216,216,40
buffer_load_dwordx4 a[124:127], v11, s[20:23], 0 offen offset:3072 sc1
v_add_u32 v10, 4096, v10
v_add_u32 v11, 4096, v11
Mvaa 248,216,44
v_max_u32_dpp v13, v13, v13 quad_perm:[2,3,0,1] row_mask:0xf bank_mask:0xf
Mvaa 156,220,32
s_nop 0
v_max_u32_dpp v13, v13, v13 row_half_mirror row_mask:0xf bank_mask:0xf
Mvaa 188,220,36
s_nop 0
v_max_u32_dpp v13, v13, v13 row_mirror row_mask:0xf bank_mask:0xf
Mvaa 220,220,40
v_readlane_b32 s3, v13, 0
v_readlane_b32 s47, v13, 16
Mvaa 252,220,44
v_readlane_b32 s4, v13, 32
v_readlane_b32 s5, v13, 48
s_waitcnt vmcnt(26) lgkmcnt(0)
s_barrier
Mvaa 128,224,48
s_max_u32 s3, s3, s47
s_max_u32 s4, s4, s5
s_max_u32 s41, s3, s4
Mvaa 160,224,52
s_add_u32 m0, s44, 16384
Ta 192,16,32768
Ta 194,16,33792
Mvaa 192,224,56
buffer_load_dwordx4 v8, s[8:11], s48 offen offset:0 lds
Mvaa 224,224,60
s_and_b32 s3, s40, 0xffff
s_sub_u32 s42, 0xffff, s3
s_and_b32 s3, s41, 0xffff
Mvaa 132,228,48
Ta 196,17,32768
Ta 198,17,33792
Mvaa 164,228,52
buffer_load_dwordx4 v8, s[8:11], s49 offen offset:1024 lds
Mvaa 196,228,56
s_sub_u32 s43, 0xffff, s3
v_mov_b32 v60, s40
v_not_b32_e64 v61, v60
Mvaa 228,228,60
Ta 200,18,32768
Ta 202,18,33792
Mvaa 136,232,48
v_ashrrev_i32_e64 v61, 31, v61
v_or_b32 v61, 0x80000000, v61
Mvaa 168,232,52
buffer_load_dwordx4 v9, s[8:11], s50 offen offset:2048 lds
Mvaa 200,232,56
Ta 204,19,32768
Ta 206,19,33792
Mvaa 232,232,60
v_xor_b32_e64 v60, v60, v61
v_and_b32 v60, 0xffff0000, v60
Mvaa 140,236,48
v_mul_f32 v60, 0xbfb8aa3b, v60
Mvaa 172,236,52
Ta 208,20,32768
Ta 210,20,33792
Mvaa 204,236,56
buffer_load_dwordx4 v9, s[8:11], s51 offen offset:3072 lds
v_add_u32 v8, 524288, v8
v_add_u32 v9, 524288, v9
Mvaa 236,236,60
VE 60,60
Mvaa 144,240,48
s_waitcnt lgkmcnt(6)
Ta 212,21,32768
Ta 214,21,33792
Mvaa 176,240,52
v_add_f32 v60, 1.0, v60
Mvaa 208,240,56
buffer_load_dwordx4 a[0:3], v10, s[20:23], s58 offen offset:0 sc1
Mvaa 240,240,60
Ta 216,22,32768
Ta 218,22,33792
Mvaa 148,244,48
v_rcp_f32_e64 v60, v60
Mvaa 180,244,52
Vc 60,60,60
v_and_b32 v64, 0xffff0000, v60
Mvaa 212,244,56
Ta 220,23,32768
Ta 222,23,33792
Mvaa 244,244,60
buffer_load_dwordx4 a[4:7], v10, s[20:23], 0 offen offset:0 sc1
Mvaa 152,248,48
v_mov_b32 v60, s41
v_not_b32 v61, v60
Mvaa 184,248,52
v_ashrrev_i32_e64 v61, 31, v61
v_or_b32 v61, 0x80000000, v61
Mvaa 216,248,56
buffer_load_dwordx4 a[8:11], v11, s[20:23], s58 offen offset:0 sc1
Mvaa 248,248,60
v_xor_b32_e64 v60, v60, v61
v_and_b32 v60, 0xffff0000, v60
Mvaa 156,252,48
v_mul_f32 v60, 0xbfb8aa3b, v60
Mvaa 188,252,52
buffer_load_dwordx4 a[12:15], v11, s[20:23], 0 offen offset:0 sc1
Mvaa 220,252,56
VE 60,60
Mvaa 252,252,60
v_add_f32 v60, 1.0, v60
s_waitcnt vmcnt(24) lgkmcnt(0)
Mvaa 128,192,64
v_rcp_f32_e64 v60, v60
Mvaa 160,192,68
Ta 224,16,40960
Ta 226,16,41984
Mvaa 192,192,72
buffer_load_dwordx4 a[16:19], v10, s[20:23], s58 offen offset:1024 sc1
Mvaa 224,192,76
Vc 60,60,60
v_and_b32 v65, 0xffff0000, v60
Mvaa 132,196,64
Ta 228,17,40960
Ta 230,17,41984
Mvaa 164,196,68
v_mov_b32 v48, 0
v_mov_b32 v49, 0
Mvaa 196,196,72
v_mov_b32 v50, 0
v_mov_b32 v51, 0
Mvaa 228,196,76
Ta 232,18,40960
Ta 234,18,41984
Mvaa 136,200,64
v_mov_b32 v52, 0
v_mov_b32 v53, 0
Mvaa 168,200,68
buffer_load_dwordx4 a[20:23], v10, s[20:23], 0 offen offset:1024 sc1
Mvaa 200,200,72
Ta 236,19,40960
Ta 238,19,41984
Mvaa 232,200,76
v_mov_b32 v54, 0
v_mov_b32 v55, 0
Mvaa 140,204,64
v_mov_b32 v56, 0
v_mov_b32 v57, 0
Mvaa 172,204,68
Ta 240,20,40960
Ta 242,20,41984
Mvaa 204,204,72
v_mov_b32 v58, 0
v_mov_b32 v59, 0
Mvaa 236,204,76
v_mov_b32 v60, 0
v_mov_b32 v61, 0
Mvaa 144,208,64
s_waitcnt lgkmcnt(6)
Ta 244,21,40960
Ta 246,21,41984
Mvaa 176,208,68
v_mov_b32 v62, 0
v_mov_b32_e64 v63, 0
Mvaa 208,208,72
buffer_load_dwordx4 a[24:27], v11, s[20:23], s58 offen offset:1024 sc1
Mvaa 240,208,76
Ta 248,22,40960
Ta 250,22,41984
Mvaa 148,212,64
s_mul_i32 s3, s34, s34
s_mul_i32 s47, s33, 48
s_add_u32 s3, s3, s47
Mvaa 180,212,68
s_lshl_b32 s3, s3, 2
s_add_u32 s3, s3, s32
s_lshl_b32 s3, s3, 7
Mvaa 212,212,72
Ta 252,23,40960
Ta 254,23,41984
Mvaa 244,212,76
s_sub_u32 s3, s3, 8704
s_cmp_ge_u32 s34, 4
s_cselect_b32 s3, s3, 0
s_cselect_b32 s40, 512, 0
s_cselect_b32 s47, 786432, 0
Mvaa 152,216,64
v_subrev_u32_e64 v31, 0, v0
v_mul_lo_u32 v31, v31, s47
Mvaa 184,216,68
v_min_u32 v31, 6553600, v31
v_mov_b32_e64 v28, s94
Mvaa 216,216,72
buffer_load_dwordx4 a[28:31], v11, s[20:23], 0 offen offset:1024 sc1
Mvaa 248,216,76
v_mov_b32 v29, s95
v_mov_b32 v30, v31
Mvaa 156,220,64
v_subrev_u32_e64 v31, 10, v0
v_mul_lo_u32 v31, v31, s47
Mvaa 188,220,68
v_min_u32 v31, 3407872, v31
v_mov_b32_e64 v14, s100
Mvaa 220,220,72
v_mov_b32_e64 v15, s101
Mvaa 252,220,76
v_cmp_le_u32 vcc, 10, v0
s_waitcnt vmcnt(24) lgkmcnt(0)
s_barrier
Mvaa 128,224,80
s_mov_b64 exec, 1
buffer_store_dword v12, v7, s[20:23], s39 offen sc1
s_mov_b64 exec, -1
Mvaa 160,224,84
s_add_u32 m0, s44, 32768
Ta 192,16,49152
Ta 194,16,50176
Mvaa 192,224,88
buffer_load_dwordx4 v8, s[8:11], s48 offen offset:0 lds
Mvaa 224,224,92
v_cndmask_b32 v28, v28, v14, vcc
v_cndmask_b32 v29, v29, v15, vcc
Mvaa 132,228,80
Ta 196,17,49152
Ta 198,17,50176
Mvaa 164,228,84
buffer_load_dwordx4 v8, s[8:11], s49 offen offset:1024 lds
Mvaa 196,228,88
v_cndmask_b32 v30, v30, v31, vcc
Mvaa 228,228,92
Ta 200,18,49152
Ta 202,18,50176
Mvaa 136,232,80
v_subrev_u32_e64 v31, 16, v0
v_mul_lo_u32 v31, v31, s47
Mvaa 168,232,84
buffer_load_dwordx4 v9, s[8:11], s50 offen offset:2048 lds
Mvaa 200,232,88
Ta 204,19,49152
Ta 206,19,50176
Mvaa 232,232,92
v_min_u32 v31, 6553600, v31
v_mov_b32_e64 v14, s60
Mvaa 140,236,80
v_mov_b32_e64 v15, s61
Mvaa 172,236,84
Ta 208,20,49152
Ta 210,20,50176
Mvaa 204,236,88
buffer_load_dwordx4 v9, s[8:11], s51 offen offset:3072 lds
v_add_u32 v8, 524288, v8
v_add_u32 v9, 524288, v9
Mvaa 236,236,92
v_cmp_le_u32 vcc, 16, v0
Mvaa 144,240,80
s_waitcnt lgkmcnt(6)
Ta 212,21,49152
Ta 214,21,50176
Mvaa 176,240,84
v_cndmask_b32 v28, v28, v14, vcc
v_cndmask_b32 v29, v29, v15, vcc
Mvaa 208,240,88
buffer_load_dwordx4 a[32:35], v10, s[20:23], s58 offen offset:2048 sc1
Mvaa 240,240,92
Ta 216,22,49152
Ta 218,22,50176
Mvaa 148,244,80
v_cndmask_b32 v30, v30, v31, vcc
Mvaa 180,244,84
v_subrev_u32 v31, 26, v0
v_mul_lo_u32 v31, v31, s47
Mvaa 212,244,88
Ta 220,23,49152
Ta 222,23,50176
Mvaa 244,244,92
buffer_load_dwordx4 a[36:39], v10, s[20:23], 0 offen offset:2048 sc1
Mvaa 152,248,80
v_min_u32 v31, 6553600, v31
v_mov_b32_e64 v14, s68
Mvaa 184,248,84
v_mov_b32_e64 v15, s69
Mvaa 216,248,88
buffer_load_dwordx4 a[40:43], v11, s[20:23], s58 offen offset:2048 sc1
Mvaa 248,248,92
v_cmp_le_u32 vcc, 26, v0
Mvaa 156,252,80
s_nop 0
v_cndmask_b32 v28, v28, v14, vcc
v_cndmask_b32 v29, v29, v15, vcc
Mvaa 188,252,84
buffer_load_dwordx4 a[44:47], v11, s[20:23], 0 offen offset:2048 sc1
Mvaa 220,252,88
v_cndmask_b32 v30, v30, v31, vcc
Mvaa 252,252,92
v_subrev_u32 v31, 36, v0
v_mul_lo_u32 v31, v31, s47
s_waitcnt vmcnt(25) lgkmcnt(0)
Mvaa 128,192,96
v_min_u32 v31, 7602176, v31
v_mov_b32 v14, s92
Mvaa 160,192,100
Ta 224,16,57344
Ta 226,16,58368
Mvaa 192,192,104
buffer_load_dwordx4 a[48:51], v10, s[20:23], s58 offen offset:3072 sc1
Mvaa 224,192,108
v_mov_b32_e64 v15, s93
Mvaa 132,196,96
Ta 228,17,57344
Ta 230,17,58368
Mvaa 164,196,100
v_cmp_le_u32 vcc, 36, v0
Mvaa 196,196,104
s_nop 0
v_cndmask_b32 v28, v28, v14, vcc
v_cndmask_b32 v29, v29, v15, vcc
Mvaa 228,196,108
Ta 232,18,57344
Ta 234,18,58368
Mvaa 136,200,96
v_cndmask_b32 v30, v30, v31, vcc
Mvaa 168,200,100
buffer_load_dwordx4 a[52:55], v10, s[20:23], 0 offen offset:3072 sc1
Mvaa 200,200,104
Ta 236,19,57344
Ta 238,19,58368
Mvaa 232,200,108
v_add_u32 v30, s3, v30
v_ashrrev_i32_e64 v31, 31, v30
Mvaa 140,204,96
v_lshl_add_u64 v[28:29], v[30:31], 0, v[28:29]
Mvaa 172,204,100
Ta 240,20,57344
Ta 242,20,58368
Mvaa 204,204,104
s_mov_b32 s41, 0
v_readfirstlane_b32 s100, v64
v_readfirstlane_b32 s101, v65
Mvaa 236,204,108
s_mov_b32 s24, s60
s_mov_b32 s25, s61
s_mov_b32 s26, s62
Mvaa 144,208,96
s_waitcnt lgkmcnt(6)
Ta 244,21,57344
Ta 246,21,58368
Mvaa 176,208,100
s_mov_b32 s94, 1040356334
s_mov_b32 s95, 1040356334
s_sub_u32 s55, 15, s34
Mvaa 208,208,104
buffer_load_dwordx4 a[56:59], v11, s[20:23], s58 offen offset:3072 sc1
Mvaa 240,208,108
Ta 248,22,57344
Ta 250,22,58368
Mvaa 148,212,96
s_sub_u32 s45, s36, 3
s_sub_u32 s46, s35, 3
s_mov_b32 s54, s44
Mvaa 180,212,100
s_sub_u32 s35, s35, 2
s_sub_u32 s36, s36, 2
Mvaa 212,212,104
Ta 252,23,57344
Ta 254,23,58368
Mvaa 244,212,108
Mvaa 152,216,96
Mvaa 184,216,100
Mvaa 216,216,104
buffer_load_dwordx4 a[60:63], v11, s[20:23], 0 offen offset:3072 sc1
v_add_u32 v10, 4096, v10
v_add_u32 v11, 4096, v11
Mvaa 248,216,108
Mvaa 156,220,96
Mvaa 188,220,100
Mvaa 220,220,104
Mvaa 252,220,108
s_waitcnt vmcnt(25) lgkmcnt(0)
s_barrier
Mvaa 128,224,112
Mvaa 160,224,116
s_add_u32 m0, s44, 49152
Ta 192,16,0
Ta 194,16,1024
Mvaa 192,224,120
buffer_load_dwordx4 v8, s[8:11], s48 offen offset:0 lds
Mvaa 224,224,124
Mvaa 132,228,112
Ta 196,17,0
Ta 198,17,1024
Mvaa 164,228,116
buffer_load_dwordx4 v8, s[8:11], s49 offen offset:1024 lds
Mvaa 196,228,120
Mvaa 228,228,124
Ta 200,18,0
Ta 202,18,1024
Mvaa 136,232,112
Mvaa 168,232,116
buffer_load_dwordx4 v9, s[8:11], s50 offen offset:2048 lds
Mvaa 200,232,120
Ta 204,19,0
Ta 206,19,1024
Mvaa 232,232,124
Mvaa 140,236,112
Mvaa 172,236,116
Ta 208,20,0
Ta 210,20,1024
Mvaa 204,236,120
buffer_load_dwordx4 v9, s[8:11], s51 offen offset:3072 lds
v_add_u32 v8, 524288, v8
v_add_u32 v9, 524288, v9
Mvaa 236,236,124
Mvaa 144,240,112
s_waitcnt lgkmcnt(6)
Ta 212,21,0
Ta 214,21,1024
Mvaa 176,240,116
Mvaa 208,240,120
buffer_load_dwordx4 a[64:67], v10, s[20:23], s58 offen offset:0 sc1
Mvaa 240,240,124
Ta 216,22,0
Ta 218,22,1024
Mvaa 148,244,112
Mvaa 180,244,116
Mvaa 212,244,120
Ta 220,23,0
Ta 222,23,1024
Mvaa 244,244,124
buffer_load_dwordx4 a[68:71], v10, s[20:23], 0 offen offset:0 sc1
Mvaa 152,248,112
Mvaa 184,248,116
Mvaa 216,248,120
buffer_load_dwordx4 a[72:75], v11, s[20:23], s58 offen offset:0 sc1
Mvaa 248,248,124
Mvaa 156,252,112
Mvaa 188,252,116
buffer_load_dwordx4 a[76:79], v11, s[20:23], 0 offen offset:0 sc1
Mvaa 220,252,120
Mvaa 252,252,124
s_waitcnt vmcnt(25) lgkmcnt(0)
Mvaa 128,192,0
Mvaa 160,192,4
Ta 224,16,8192
Ta 226,16,9216
Mvaa 192,192,8
buffer_load_dwordx4 a[80:83], v10, s[20:23], s58 offen offset:1024 sc1
Mvaa 224,192,12
Mvaa 132,196,0
Ta 228,17,8192
Ta 230,17,9216
Mvaa 164,196,4
Mvaa 196,196,8
Mvaa 228,196,12
Ta 232,18,8192
Ta 234,18,9216
Mvaa 136,200,0
Mvaa 168,200,4
buffer_load_dwordx4 a[84:87], v10, s[20:23], 0 offen offset:1024 sc1
Mvaa 200,200,8
Ta 236,19,8192
Ta 238,19,9216
Mvaa 232,200,12
Mvaa 140,204,0
Mvaa 172,204,4
Ta 240,20,8192
Ta 242,20,9216
Mvaa 204,204,8
Mvaa 236,204,12
Mvaa 144,208,0
s_waitcnt lgkmcnt(6)
Ta 244,21,8192
Ta 246,21,9216
Mvaa 176,208,4
Mvaa 208,208,8
buffer_load_dwordx4 a[88:91], v11, s[20:23], s58 offen offset:1024 sc1
Mvaa 240,208,12
Ta 248,22,8192
Ta 250,22,9216
Mvaa 148,212,0
Mvaa 180,212,4
Mvaa 212,212,8
Ta 252,23,8192
Ta 254,23,9216
Mvaa 244,212,12
Mvaa 152,216,0
Mvaa 184,216,4
Mvaa 216,216,8
buffer_load_dwordx4 a[92:95], v11, s[20:23], 0 offen offset:1024 sc1
Mvaa 248,216,12
Mvaa 156,220,0
Mvaa 188,220,4
Mvaa 220,220,8
Mvaa 252,220,12
s_waitcnt vmcnt(25) lgkmcnt(0)
s_barrier
Mvaa 128,224,16
v_accvgpr_write_b32 a0, 0
v_accvgpr_write_b32 a1, 0
Mvaa 160,224,20
Ta 192,16,16384
Ta 194,16,17408
Mvaa 192,224,24
buffer_load_dwordx4 a[96:99], v10, s[20:23], s58 offen offset:2048 sc1
Mvaa 224,224,28
v_accvgpr_write_b32 a2, 0
v_accvgpr_write_b32 a3, 0
Mvaa 132,228,16
Ta 196,17,16384
Ta 198,17,17408
Mvaa 164,228,20
v_accvgpr_write_b32 a4, 0
v_accvgpr_write_b32 a5, 0
Mvaa 196,228,24
v_accvgpr_write_b32 a6, 0
v_accvgpr_write_b32 a7, 0
Mvaa 228,228,28
Ta 200,18,16384
Ta 202,18,17408
Mvaa 136,232,16
v_accvgpr_write_b32 a8, 0
v_accvgpr_write_b32 a9, 0
Mvaa 168,232,20
buffer_load_dwordx4 a[100:103], v10, s[20:23], 0 offen offset:2048 sc1
Mvaa 200,232,24
Ta 204,19,16384
Ta 206,19,17408
Mvaa 232,232,28
v_accvgpr_write_b32 a10, 0
v_accvgpr_write_b32 a11, 0
Mvaa 140,236,16
v_accvgpr_write_b32 a12, 0
v_accvgpr_write_b32 a13, 0
Mvaa 172,236,20
Ta 208,20,16384
Ta 210,20,17408
Mvaa 204,236,24
v_accvgpr_write_b32 a14, 0
v_accvgpr_write_b32 a15, 0
Mvaa 236,236,28
Mvaa 144,240,16
s_waitcnt lgkmcnt(6)
Ta 212,21,16384
Ta 214,21,17408
Mvaa 176,240,20
Mvaa 208,240,24
buffer_load_dwordx4 a[104:107], v11, s[20:23], s58 offen offset:2048 sc1
Mvaa 240,240,28
Ta 216,22,16384
Ta 218,22,17408
Mvaa 148,244,16
Mvaa 180,244,20
Mvaa 212,244,24
Ta 220,23,16384
Ta 222,23,17408
Mvaa 244,244,28
Mvaa 152,248,16
Mvaa 184,248,20
Mvaa 216,248,24
buffer_load_dwordx4 a[108:111], v11, s[20:23], 0 offen offset:2048 sc1
Mvaa 248,248,28
Mvaa 156,252,16
Mvaa 188,252,20
Mvaa 220,252,24
Mvaa 252,252,28
s_waitcnt vmcnt(20) lgkmcnt(0)
Mvaa 128,192,32
v_accvgpr_write_b32 a16, 0
v_accvgpr_write_b32 a17, 0
Mvaa 160,192,36
Ta 224,16,24576
Ta 226,16,25600
Mvaa 192,192,40
buffer_load_dwordx4 a[112:115], v10, s[20:23], s58 offen offset:3072 sc1
Mvaa 224,192,44
v_accvgpr_write_b32 a18, 0
v_accvgpr_write_b32 a19, 0
Mvaa 132,196,32
Ta 228,17,24576
Ta 230,17,25600
Mvaa 164,196,36
v_accvgpr_write_b32 a20, 0
v_accvgpr_write_b32 a21, 0
Mvaa 196,196,40
v_accvgpr_write_b32 a22, 0
v_accvgpr_write_b32 a23, 0
Mvaa 228,196,44
Ta 232,18,24576
Ta 234,18,25600
Mvaa 136,200,32
v_accvgpr_write_b32 a24, 0
v_accvgpr_write_b32 a25, 0
Mvaa 168,200,36
buffer_load_dwordx4 a[116:119], v10, s[20:23], 0 offen offset:3072 sc1
Mvaa 200,200,40
Ta 236,19,24576
Ta 238,19,25600
Mvaa 232,200,44
v_accvgpr_write_b32 a26, 0
v_accvgpr_write_b32 a27, 0
Mvaa 140,204,32
v_accvgpr_write_b32 a28, 0
v_accvgpr_write_b32 a29, 0
Mvaa 172,204,36
Ta 240,20,24576
Ta 242,20,25600
Mvaa 204,204,40
v_accvgpr_write_b32 a30, 0
v_accvgpr_write_b32 a31, 0
Mvaa 236,204,44
Mvaa 144,208,32
s_waitcnt lgkmcnt(6)
Ta 244,21,24576
Ta 246,21,25600
Mvaa 176,208,36
buffer_load_dword v12, v1, s[20:23], s6 offen sc1
Mvaa 208,208,40
buffer_load_dwordx4 a[120:123], v11, s[20:23], s58 offen offset:3072 sc1
Mvaa 240,208,44
Ta 248,22,24576
Ta 250,22,25600
Mvaa 148,212,32
s_add_u32 m0, s44, 65536
s_mov_b32 s7, 0
Mvaa 180,212,36
Mvaa 212,212,40
Ta 252,23,24576
Ta 254,23,25600
Mvaa 244,212,44
Mvaa 152,216,32
Mvaa 184,216,36
Mvaa 216,216,40
buffer_load_dwordx4 a[124:127], v11, s[20:23], 0 offen offset:3072 sc1
v_add_u32 v10, 4096, v10
v_add_u32 v11, 4096, v11
Mvaa 248,216,44
Mvaa 156,220,32
Mvaa 188,220,36
Mvaa 220,220,40
Mvaa 252,220,44
s_waitcnt vmcnt(21) lgkmcnt(0)
s_barrier
Mvaa 128,224,48
v_accvgpr_write_b32 a32, 0
v_accvgpr_write_b32 a33, 0
Mvaa 160,224,52
Ta 192,16,32768
Ta 194,16,33792
Mvaa 192,224,56
v_accvgpr_write_b32 a34, 0
v_accvgpr_write_b32 a35, 0
Mvaa 224,224,60
v_accvgpr_write_b32 a36, 0
v_accvgpr_write_b32 a37, 0
Mvaa 132,228,48
Ta 196,17,32768
Ta 198,17,33792
Mvaa 164,228,52
v_accvgpr_write_b32 a38, 0
v_accvgpr_write_b32 a39, 0
Mvaa 196,228,56
v_accvgpr_write_b32 a40, 0
v_accvgpr_write_b32 a41, 0
Mvaa 228,228,60
Ta 200,18,32768
Ta 202,18,33792
Mvaa 136,232,48
v_accvgpr_write_b32 a42, 0
v_accvgpr_write_b32 a43, 0
Mvaa 168,232,52
v_accvgpr_write_b32 a44, 0
v_accvgpr_write_b32 a45, 0
Mvaa 200,232,56
Ta 204,19,32768
Ta 206,19,33792
Mvaa 232,232,60
v_accvgpr_write_b32 a46, 0
v_accvgpr_write_b32 a47, 0
Mvaa 140,236,48
Mvaa 172,236,52
Ta 208,20,32768
Ta 210,20,33792
Mvaa 204,236,56
Mvaa 236,236,60
Mvaa 144,240,48
s_waitcnt lgkmcnt(6)
Ta 212,21,32768
Ta 214,21,33792
Mvaa 176,240,52
Mvaa 208,240,56
Mvaa 240,240,60
Ta 216,22,32768
Ta 218,22,33792
Mvaa 148,244,48
Mvaa 180,244,52
Mvaa 212,244,56
Ta 220,23,32768
Ta 222,23,33792
Mvaa 244,244,60
Mvaa 152,248,48
Mvaa 184,248,52
Mvaa 216,248,56
Mvaa 248,248,60
Mvaa 156,252,48
Mvaa 188,252,52
Mvaa 220,252,56
Mvaa 252,252,60
s_waitcnt vmcnt(13) lgkmcnt(0)
Mvaa 128,192,64
v_accvgpr_write_b32 a48, 0
v_accvgpr_write_b32 a49, 0
Mvaa 160,192,68
Ta 224,16,40960
Ta 226,16,41984
Mvaa 192,192,72
v_accvgpr_write_b32 a50, 0
v_accvgpr_write_b32 a51, 0
Mvaa 224,192,76
v_accvgpr_write_b32 a52, 0
v_accvgpr_write_b32 a53, 0
Mvaa 132,196,64
Ta 228,17,40960
Ta 230,17,41984
Mvaa 164,196,68
v_accvgpr_write_b32 a54, 0
v_accvgpr_write_b32 a55, 0
Mvaa 196,196,72
v_accvgpr_write_b32 a56, 0
v_accvgpr_write_b32 a57, 0
Mvaa 228,196,76
Ta 232,18,40960
Ta 234,18,41984
Mvaa 136,200,64
v_accvgpr_write_b32 a58, 0
v_accvgpr_write_b32 a59, 0
Mvaa 168,200,68
v_accvgpr_write_b32 a60, 0
v_accvgpr_write_b32 a61, 0
Mvaa 200,200,72
Ta 236,19,40960
Ta 238,19,41984
Mvaa 232,200,76
v_accvgpr_write_b32 a62, 0
v_accvgpr_write_b32 a63, 0
Mvaa 140,204,64
Mvaa 172,204,68
Ta 240,20,40960
Ta 242,20,41984
Mvaa 204,204,72
Mvaa 236,204,76
Mvaa 144,208,64
s_waitcnt lgkmcnt(6)
Ta 244,21,40960
Ta 246,21,41984
Mvaa 176,208,68
Mvaa 208,208,72
Mvaa 240,208,76
Ta 248,22,40960
Ta 250,22,41984
Mvaa 148,212,64
Mvaa 180,212,68
Mvaa 212,212,72
Ta 252,23,40960
Ta 254,23,41984
Mvaa 244,212,76
Mvaa 152,216,64
Mvaa 184,216,68
Mvaa 216,216,72
Mvaa 248,216,76
Mvaa 156,220,64
Mvaa 188,220,68
Mvaa 220,220,72
Mvaa 252,220,76
s_waitcnt vmcnt(2) lgkmcnt(0)
s_cmp_lg_u32 s32, 0
s_cbranch_scc1 L_spinBr
v_cmp_ne_u32 vcc, 1, v12
s_cbranch_vccnz L_spinB
L_spinBr:
s_barrier
Mvaa 128,224,80
buffer_load_dwordx4 v4, s[12:15], s7 offen offset:0 sc1 lds
Mvaa 160,224,84
Ta 192,16,49152
Ta 194,16,50176
Mvaa 192,224,88
v_accvgpr_write_b32 a64, 0
v_accvgpr_write_b32 a65, 0
Mvaa 224,224,92
buffer_load_dwordx4 v4, s[12:15], s7 offen offset:1024 sc1 lds
Mvaa 132,228,80
Ta 196,17,49152
Ta 198,17,50176
Mvaa 164,228,84
v_accvgpr_write_b32 a66, 0
v_accvgpr_write_b32 a67, 0
Mvaa 196,228,88
buffer_load_dwordx4 v4, s[12:15], s7 offen offset:2048 sc1 lds
Mvaa 228,228,92
Ta 200,18,49152
Ta 202,18,50176
Mvaa 136,232,80
v_accvgpr_write_b32 a68, 0
v_accvgpr_write_b32 a69, 0
Mvaa 168,232,84
buffer_load_dwordx4 v4, s[12:15], s7 offen offset:3072 sc1 lds
Mvaa 200,232,88
Ta 204,19,49152
Ta 206,19,50176
Mvaa 232,232,92
s_add_u32 m0, s44, 98304
s_mov_b32 s7, 34816
Mvaa 140,236,80
buffer_load_dwordx4 v4, s[12:15], s7 offen offset:0 sc1 lds
Mvaa 172,236,84
Ta 208,20,49152
Ta 210,20,50176
Mvaa 204,236,88
v_accvgpr_write_b32 a70, 0
v_accvgpr_write_b32 a71, 0
Mvaa 236,236,92
buffer_load_dwordx4 v4, s[12:15], s7 offen offset:1024 sc1 lds
Mvaa 144,240,80
s_waitcnt lgkmcnt(6)
Ta 212,21,49152
Ta 214,21,50176
Mvaa 176,240,84
v_accvgpr_write_b32 a72, 0
v_accvgpr_write_b32 a73, 0
Mvaa 208,240,88
buffer_load_dwordx4 v4, s[12:15], s7 offen offset:2048 sc1 lds
Mvaa 240,240,92
Ta 216,22,49152
Ta 218,22,50176
Mvaa 148,244,80
v_accvgpr_write_b32 a74, 0
v_accvgpr_write_b32 a75, 0
Mvaa 180,244,84
buffer_load_dwordx4 v4, s[12:15], s7 offen offset:3072 sc1 lds
Mvaa 212,244,88
Ta 220,23,49152
Ta 222,23,50176
Mvaa 244,244,92
s_add_u32 m0, s44, 81920
s_mov_b32 s7, 17408
Mvaa 152,248,80
buffer_load_dwordx4 v4, s[12:15], s7 offen offset:0 sc1 lds
Mvaa 184,248,84
v_accvgpr_write_b32 a76, 0
v_accvgpr_write_b32 a77, 0
Mvaa 216,248,88
buffer_load_dwordx4 v4, s[12:15], s7 offen offset:1024 sc1 lds
Mvaa 248,248,92
v_accvgpr_write_b32 a78, 0
v_accvgpr_write_b32 a79, 0
Mvaa 156,252,80
Mvaa 188,252,84
buffer_load_dwordx4 v4, s[12:15], s7 offen offset:2048 sc1 lds
Mvaa 220,252,88
Mvaa 252,252,92
s_waitcnt lgkmcnt(0)
Mvaa 128,192,96
buffer_load_dwordx4 v4, s[12:15], s7 offen offset:3072 sc1 lds
Mvaa 160,192,100
Ta 224,16,57344
Ta 226,16,58368
Mvaa 192,192,104
s_add_u32 m0, s44, 114688
s_mov_b32 s7, 52224
Mvaa 224,192,108
buffer_load_dwordx4 v4, s[12:15], s7 offen offset:0 sc1 lds
Mvaa 132,196,96
Ta 228,17,57344
Ta 230,17,58368
Mvaa 164,196,100
v_accvgpr_write_b32 a80, 0
v_accvgpr_write_b32 a81, 0
Mvaa 196,196,104
buffer_load_dwordx4 v4, s[12:15], s7 offen offset:1024 sc1 lds
Mvaa 228,196,108
Ta 232,18,57344
Ta 234,18,58368
Mvaa 136,200,96
v_accvgpr_write_b32 a82, 0
v_accvgpr_write_b32 a83, 0
Mvaa 168,200,100
buffer_load_dwordx4 v4, s[12:15], s7 offen offset:2048 sc1 lds
Mvaa 200,200,104
Ta 236,19,57344
Ta 238,19,58368
Mvaa 232,200,108
v_accvgpr_write_b32 a84, 0
v_accvgpr_write_b32 a85, 0
Mvaa 140,204,96
buffer_load_dwordx4 v4, s[12:15], s7 offen offset:3072 sc1 lds
Mvaa 172,204,100
Ta 240,20,57344
Ta 242,20,58368
Mvaa 204,204,104
s_add_u32 m0, s44, 0
s_mov_b32 s7, 69632
Mvaa 236,204,108
buffer_load_dwordx4 v4, s[12:15], s7 offen offset:0 sc1 lds
Mvaa 144,208,96
s_waitcnt lgkmcnt(6)
Ta 244,21,57344
Ta 246,21,58368
Mvaa 176,208,100
buffer_load_dwordx4 v4, s[12:15], s7 offen offset:1024 sc1 lds
Mvaa 208,208,104
v_accvgpr_write_b32 a86, 0
v_accvgpr_write_b32 a87, 0
Mvaa 240,208,108
Ta 248,22,57344
Ta 250,22,58368
Mvaa 148,212,96
buffer_load_dwordx4 v4, s[12:15], s7 offen offset:2048 sc1 lds
Mvaa 180,212,100
v_accvgpr_write_b32 a88, 0
v_accvgpr_write_b32 a89, 0
Mvaa 212,212,104
Ta 252,23,57344
Ta 254,23,58368
Mvaa 244,212,108
buffer_load_dwordx4 v4, s[12:15], s7 offen offset:3072 sc1 lds
Mvaa 152,216,96
s_add_u32 m0, s44, 16384
s_mov_b32 s7, 87040
Mvaa 184,216,100
v_accvgpr_write_b32 a90, 0
v_accvgpr_write_b32 a91, 0
Mvaa 216,216,104
buffer_load_dwordx4 v4, s[12:15], s7 offen offset:0 sc1 lds
Mvaa 248,216,108
v_accvgpr_write_b32 a92, 0
v_accvgpr_write_b32 a93, 0
Mvaa 156,220,96
v_accvgpr_write_b32 a94, 0
v_accvgpr_write_b32 a95, 0
Mvaa 188,220,100
buffer_load_dwordx4 v4, s[12:15], s7 offen offset:1024 sc1 lds
Mvaa 220,220,104
Mvaa 252,220,108
s_waitcnt vmcnt(18) lgkmcnt(0)
s_barrier
Mvaa 128,224,112
buffer_load_dwordx4 v4, s[12:15], s7 offen offset:2048 sc1 lds
Mvaa 132,228,112
Ra 192,3,0
Ra 196,3,1024
Mvaa 136,232,112
Ra 200,3,2048
Ra 204,3,3072
Mvaa 140,236,112
buffer_load_dwordx4 v4, s[12:15], s7 offen offset:3072 sc1 lds
Mvaa 144,240,112
s_add_u32 m0, s44, 32768
s_mov_b32 s7, 104448
Mvaa 148,244,112
Ra 208,3,4096
Ra 212,3,5120
Mvaa 152,248,112
buffer_load_dwordx4 v4, s[12:15], s7 offen offset:0 sc1 lds
Mvaa 156,252,112
Ra 216,3,6144
Ra 220,3,7168
Mvaa 160,224,116
buffer_load_dwordx4 v4, s[12:15], s7 offen offset:1024 sc1 lds
Mvaa 164,228,116
Mvaa 168,232,116
Mvaa 172,236,116
buffer_load_dwordx4 v4, s[12:15], s7 offen offset:2048 sc1 lds
Mvaa 176,240,116
v_mul_f32 v128, s94, v128
v_mul_f32_e64 v129, s94, v129
Mvaa 180,244,116
v_mul_f32 v130, s94, v130
v_mul_f32 v131, s94, v131
Mvaa 184,248,116
buffer_load_dwordx4 v4, s[12:15], s7 offen offset:3072 sc1 lds
Mvaa 188,252,116
v_mul_f32 v132, s94, v132
v_mul_f32 v133, s94, v133
Mvaa 192,224,120
v_mul_f32 v134, s94, v134
v_mul_f32 v135, s94, v135
Mvaa 196,228,120
Vc 128,128,129
Vc 129,130,131
Mvaa 200,232,120
Vc 130,132,133
Vc 131,134,135
Mvaa 204,236,120
Aw 128,128
Aw 129,129
Mvaa 208,240,120
Aw 130,130
Aw 131,131
Mvaa 212,244,120
v_mul_f32 v136, s94, v136
v_mul_f32 v137, s94, v137
Mvaa 216,248,120
v_mul_f32 v138, s94, v138
v_mul_f32 v139, s94, v139
Mvaa 220,252,120
v_mul_f32 v140, s94, v140
v_mul_f32 v141, s94, v141
Mvaa 224,224,124
v_mul_f32 v142, s94, v142
v_mul_f32 v143, s94, v143
Mvaa 228,228,124
Vc 136,136,137
Vc 137,138,139
Mvaa 232,232,124
Vc 138,140,141
Vc 139,142,143
Mvaa 236,236,124
Aw 132,136
Aw 133,137
Mvaa 240,240,124
Aw 134,138
Aw 135,139
Mvaa 244,244,124
v_mul_f32 v144, s94, v144
v_mul_f32 v145, s94, v145
Mvaa 248,248,124
v_mul_f32 v146, s94, v146
v_mul_f32 v147, s94, v147
Mvaa 252,252,124
v_mul_f32 v148, s94, v148
v_mul_f32 v149, s94, v149
Ra 224,3,8192
Ra 228,3,9216
Ra 232,3,10240
Ra 236,3,11264
Ra 240,3,12288
Ra 244,3,13312
Ra 248,3,14336
s_waitcnt lgkmcnt(9)
Ra 252,3,15360
v_mul_f32 v150, s94, v150
v_mul_f32_e64 v151, s94, v151
Vc 144,144,145
Vc 145,146,147
Vc 146,148,149
Vc 147,150,151
Aw 136,144
Aw 137,145
Aw 138,146
Aw 139,147
v_mul_f32 v152, s94, v152
v_mul_f32 v153, s94, v153
v_mul_f32 v154, s94, v154
v_mul_f32 v155, s94, v155
v_mul_f32 v156, s94, v156
v_mul_f32 v157, s94, v157
v_mul_f32 v158, s94, v158
v_mul_f32 v159, s94, v159
Vc 152,152,153
Vc 153,154,155
Vc 154,156,157
Vc 155,158,159
Aw 140,152
Aw 141,153
Aw 142,154
Aw 143,155
Zvaa 128,192,128
v_mul_f32 v160, s94, v160
v_mul_f32 v161, s94, v161
v_mul_f32 v162, s94, v162
v_mul_f32 v163, s94, v163
Mvaa 128,196,132
v_mul_f32 v164, s94, v164
v_mul_f32 v165, s94, v165
v_mul_f32 v166, s94, v166
v_mul_f32 v167, s94, v167
Mvaa 128,200,136
Vc 160,160,161
Vc 161,162,163
Vc 162,164,165
Vc 163,166,167
Mvaa 128,204,140
Aw 144,160
Aw 145,161
Aw 146,162
Aw 147,163
s_waitcnt lgkmcnt(8)
Zvaa 132,208,128
v_mul_f32 v168, s94, v168
v_mul_f32 v169, s94, v169
v_mul_f32 v170, s94, v170
v_mul_f32_e64 v171, s94, v171
Mvaa 132,212,132
v_mul_f32 v172, s94, v172
v_mul_f32 v173, s94, v173
v_mul_f32 v174, s94, v174
v_mul_f32 v175, s94, v175
Mvaa 132,216,136
Vc 168,168,169
Vc 169,170,171
Vc 170,172,173
Vc 171,174,175
Mvaa 132,220,140
Aw 148,168
Aw 149,169
Aw 150,170
Aw 151,171
s_waitcnt lgkmcnt(4)
Zvaa 136,224,128
v_mul_f32 v176, s94, v176
v_mul_f32 v177, s94, v177
v_mul_f32 v178, s94, v178
v_mul_f32_e64 v179, s94, v179
Mvaa 136,228,132
v_mul_f32 v180, s94, v180
v_mul_f32 v181, s94, v181
v_mul_f32 v182, s94, v182
v_mul_f32 v183, s94, v183
Mvaa 136,232,136
Vc 176,176,177
Vc 177,178,179
Vc 178,180,181
Vc 179,182,183
Mvaa 136,236,140
Aw 152,176
Aw 153,177
Aw 154,178
Aw 155,179
s_waitcnt lgkmcnt(0)
Zvaa 140,240,128
v_mul_f32 v184, s94, v184
v_mul_f32 v185, s94, v185
v_mul_f32 v186, s94, v186
v_mul_f32_e64 v187, s94, v187
Mvaa 140,244,132
v_mul_f32 v188, s94, v188
v_mul_f32 v189, s94, v189
v_mul_f32 v190, s94, v190
v_mul_f32 v191, s94, v191
Mvaa 140,248,136
Vc 184,184,185
Vc 185,186,187
Vc 186,188,189
Vc 187,190,191
Mvaa 140,252,140
Aw 156,184
Aw 157,185
Aw 158,186
Aw 159,187
Zvaa 144,192,144
v_mul_f32 v192, s94, v192
v_mul_f32 v193, s94, v193
v_mul_f32 v194, s94, v194
v_mul_f32 v195, s94, v195
Mvaa 144,196,148
v_mul_f32 v196, s94, v196
v_mul_f32 v197, s94, v197
v_mul_f32 v198, s94, v198
v_mul_f32 v199, s94, v199
Mvaa 144,200,152
Vc 192,192,193
Vc 193,194,195
Vc 194,196,197
Vc 195,198,199
Mvaa 144,204,156
Aw 160,192
Aw 161,193
Aw 162,194
Aw 163,195
Zvaa 148,208,144
v_mul_f32 v200, s94, v200
v_mul_f32 v201, s94, v201
v_mul_f32 v202, s94, v202
v_mul_f32 v203, s94, v203
Mvaa 148,212,148
v_mul_f32 v204, s94, v204
v_mul_f32 v205, s94, v205
v_mul_f32 v206, s94, v206
v_mul_f32 v207, s94, v207
Mvaa 148,216,152
Vc 200,200,201
Vc 201,202,203
Vc 202,204,205
Vc 203,206,207
Mvaa 148,220,156
Aw 164,200
Aw 165,201
Aw 166,202
Aw 167,203
Zvaa 152,224,144
v_mul_f32 v208, s94, v208
v_mul_f32 v209, s94, v209
v_mul_f32 v210, s94, v210
v_mul_f32 v211, s94, v211
Mvaa 152,228,148
v_mul_f32 v212, s94, v212
v_mul_f32 v213, s94, v213
v_mul_f32 v214, s94, v214
v_mul_f32 v215, s94, v215
Mvaa 152,232,152
Vc 208,208,209
Vc 209,210,211
Vc 210,212,213
Vc 211,214,215
Mvaa 152,236,156
Aw 168,208
Aw 169,209
Aw 170,210
Aw 171,211
Zvaa 156,240,144
v_mul_f32 v216, s94, v216
v_mul_f32 v217, s94, v217
v_mul_f32 v218, s94, v218
v_mul_f32 v219, s94, v219
Mvaa 156,244,148
v_mul_f32 v220, s94, v220
v_mul_f32 v221, s94, v221
v_mul_f32 v222, s94, v222
v_mul_f32 v223, s94, v223
Mvaa 156,248,152
Vc 216,216,217
Vc 217,218,219
Vc 218,220,221
Vc 219,222,223
Mvaa 156,252,156
Aw 172,216
Aw 173,217
Aw 174,218
Aw 175,219
Zvaa 160,192,160
v_mul_f32 v224, s94, v224
v_mul_f32 v225, s94, v225
v_mul_f32 v226, s94, v226
v_mul_f32 v227, s94, v227
Mvaa 160,196,164
v_mul_f32 v228, s94, v228
v_mul_f32 v229, s94, v229
v_mul_f32 v230, s94, v230
v_mul_f32 v231, s94, v231
Mvaa 160,200,168
Vc 224,224,225
Vc 225,226,227
Vc 226,228,229
Vc 227,230,231
Mvaa 160,204,172
Aw 176,224
Aw 177,225
Aw 178,226
Aw 179,227
Zvaa 164,208,160
v_mul_f32 v232, s94, v232
v_mul_f32 v233, s94, v233
v_mul_f32 v234, s94, v234
v_mul_f32 v235, s94, v235
Mvaa 164,212,164
v_mul_f32 v236, s94, v236
v_mul_f32 v237, s94, v237
v_mul_f32 v238, s94, v238
v_mul_f32 v239, s94, v239
Mvaa 164,216,168
Vc 232,232,233
Vc 233,234,235
Vc 234,236,237
Vc 235,238,239
Mvaa 164,220,172
Aw 180,232
Aw 181,233
Aw 182,234
Aw 183,235
Zvaa 168,224,160
v_mul_f32 v240, s94, v240
v_mul_f32 v241, s94, v241
v_mul_f32 v242, s94, v242
v_mul_f32 v243, s94, v243
Mvaa 168,228,164
v_mul_f32 v244, s94, v244
v_mul_f32 v245, s94, v245
v_mul_f32 v246, s94, v246
v_mul_f32 v247, s94, v247
Mvaa 168,232,168
Vc 240,240,241
Vc 241,242,243
Vc 242,244,245
Vc 243,246,247
Mvaa 168,236,172
Aw 184,240
Aw 185,241
Aw 186,242
Aw 187,243
Zvaa 172,240,160
v_mul_f32 v248, s94, v248
v_mul_f32 v249, s94, v249
v_mul_f32 v250, s94, v250
v_mul_f32 v251, s94, v251
Mvaa 172,244,164
v_mul_f32 v252, s94, v252
v_mul_f32 v253, s94, v253
v_mul_f32 v254, s94, v254
v_mul_f32 v255, s94, v255
Mvaa 172,248,168
Vc 248,248,249
Vc 249,250,251
Vc 250,252,253
Vc 251,254,255
Mvaa 172,252,172
Aw 188,248
Aw 189,249
Aw 190,250
Aw 191,251
Zvaa 176,192,176
v_accvgpr_write_b32 a96, 0
v_accvgpr_write_b32 a97, 0
v_accvgpr_write_b32 a98, 0
v_accvgpr_write_b32 a99, 0
Mvaa 176,196,180
v_accvgpr_write_b32 a100, 0
v_accvgpr_write_b32 a101, 0
v_accvgpr_write_b32 a102, 0
v_accvgpr_write_b32 a103, 0
Mvaa 176,200,184
v_accvgpr_write_b32 a104, 0
v_accvgpr_write_b32 a105, 0
v_accvgpr_write_b32 a106, 0
v_accvgpr_write_b32 a107, 0
Mvaa 176,204,188
v_accvgpr_write_b32 a108, 0
v_accvgpr_write_b32 a109, 0
v_accvgpr_write_b32 a110, 0
v_accvgpr_write_b32 a111, 0
Zvaa 180,208,176
v_accvgpr_write_b32 a112, 0
v_accvgpr_write_b32 a113, 0
v_accvgpr_write_b32 a114, 0
v_accvgpr_write_b32 a115, 0
Mvaa 180,212,180
v_accvgpr_write_b32 a116, 0
v_accvgpr_write_b32 a117, 0
v_accvgpr_write_b32 a118, 0
v_accvgpr_write_b32 a119, 0
Mvaa 180,216,184
v_accvgpr_write_b32 a120, 0
v_accvgpr_write_b32 a121, 0
v_accvgpr_write_b32 a122, 0
v_accvgpr_write_b32 a123, 0
Mvaa 180,220,188
v_accvgpr_write_b32 a124, 0
v_accvgpr_write_b32 a125, 0
v_accvgpr_write_b32 a126, 0
v_accvgpr_write_b32 a127, 0
s_waitcnt vmcnt(16)
s_barrier
s_add_u32 s53, s44, 65536
Zvaa 184,224,176
Ra 192,3,32768
v_mov_b32 v16, 0x3f803f80
v_mov_b32 v17, 0x3f803f80
v_mov_b32 v18, 0x3f803f80
v_mov_b32 v19, 0x3f803f80
Mvaa 184,228,180
Ra 196,3,33792
v_mov_b32 v20, 0xff800000
v_max3_f32 v22, v128, v129, v130
v_max3_f32 v22, v22, v131, v132
v_max3_f32 v22, v22, v133, v134
Mvaa 184,232,184
Ra 200,3,34816
v_max3_f32 v22, v22, v135, v136
v_max3_f32 v22, v22, v137, v138
v_max3_f32 v22, v22, v139, v140
v_max3_f32 v22, v22, v141, v142
Mvaa 184,236,188
Ra 204,3,35840
v_max_f32 v22, v22, v143
v_mov_b32 v1, v22
s_nop 1
v_permlane16_swap_b32 v1, v22
v_max_f32_e64 v22, v22, v1
Zvaa 188,240,176
Ra 208,3,36864
v_mov_b32 v1, v22
s_nop 1
v_permlane32_swap_b32 v1, v22
v_max_f32 v22, v22, v1
v_add_f32 v22, 0x41f80000, v22
Mvaa 188,244,180
Ra 212,3,37888
Vs 128,128,22
Vs 129,129,22
Vs 130,130,22
Vs 131,131,22
Mvaa 188,248,184
Ra 216,3,38912
Vs 132,132,22
Vs 133,133,22
Vs 134,134,22
Vs 135,135,22
Mvaa 188,252,188
Ra 220,3,39936
Vs 136,136,22
Vs 137,137,22
Vs 138,138,22
Vs 139,139,22
Vs 140,140,22
Vs 141,141,22
Vs 142,142,22
Vs 143,143,22
v_sub_f32 v32, 0, v22
v_sub_f32 v33, 0, v22
v_sub_f32 v34, 0, v22
v_sub_f32 v35, 0, v22
v_max3_f32 v22, v144, v145, v146
v_max3_f32 v22, v22, v147, v148
v_max3_f32 v22, v22, v149, v150
v_max3_f32 v22, v22, v151, v152
v_max3_f32 v22, v22, v153, v154
v_max3_f32 v22, v22, v155, v156
v_max3_f32 v22, v22, v157, v158
v_max_f32 v22, v22, v159
v_mov_b32 v1, v22
s_nop 1
v_permlane16_swap_b32 v1, v22
v_max_f32 v22, v22, v1
v_mov_b32 v1, v22
s_nop 1
v_permlane32_swap_b32 v1, v22
v_max_f32_e64 v22, v22, v1
v_add_f32 v22, 0x41f80000, v22
Vs 144,144,22
Vs 145,145,22
Vs 146,146,22
Vs 147,147,22
Vs 148,148,22
Vs 149,149,22
Vs 150,150,22
Vs 151,151,22
Vs 152,152,22
Vs 153,153,22
Vs 154,154,22
Vs 155,155,22
Vs 156,156,22
Vs 157,157,22
Vs 158,158,22
Vs 159,159,22
v_sub_f32 v36, 0, v22
v_sub_f32 v37, 0, v22
v_sub_f32 v38, 0, v22
v_sub_f32 v39, 0, v22
s_mov_b32 s38, 139264
s_mov_b32 s39, 121856
s_cmp_lg_u32 s34, 0
s_cbranch_scc1 L_k2_nomask0
v_cmp_gt_i32 s[56:57], 0, v5
v_cmp_gt_i32 s[58:59], 1, v5
v_cmp_gt_i32 s[60:61], 2, v5
v_cmp_gt_i32 s[62:63], 3, v5
s_nop 3
s_nop 0
v_cndmask_b32 v176, v176, v20, s[56:57]
v_cndmask_b32 v177, v177, v20, s[58:59]
v_cndmask_b32 v178, v178, v20, s[60:61]
v_cndmask_b32 v179, v179, v20, s[62:63]
v_cmp_gt_i32 s[56:57], 16, v5
v_cmp_gt_i32 s[58:59], 17, v5
v_cmp_gt_i32 s[60:61], 18, v5
v_cmp_gt_i32 s[62:63], 19, v5
v_cndmask_b32 v180, v180, v20, s[56:57]
v_cndmask_b32 v181, v181, v20, s[58:59]
v_cndmask_b32 v182, v182, v20, s[60:61]
v_cndmask_b32 v183, v183, v20, s[62:63]
v_cmp_gt_i32 s[56:57], 32, v5
v_cmp_gt_i32 s[58:59], 33, v5
v_cmp_gt_i32 s[60:61], 34, v5
v_cmp_gt_i32 s[62:63], 35, v5
v_cndmask_b32 v184, v184, v20, s[56:57]
v_cndmask_b32 v185, v185, v20, s[58:59]
v_cndmask_b32 v186, v186, v20, s[60:61]
v_cndmask_b32 v187, v187, v20, s[62:63]
v_cmp_gt_i32 s[56:57], 48, v5
v_cmp_gt_i32 s[58:59], 49, v5
v_cmp_gt_i32 s[60:61], 50, v5
v_cmp_gt_i32 s[62:63], 51, v5
v_cndmask_b32 v188, v188, v20, s[56:57]
v_cndmask_b32 v189, v189, v20, s[58:59]
v_cndmask_b32 v190, v190, v20, s[60:61]
v_cndmask_b32 v191, v191, v20, s[62:63]
L_k2_nomask0:
s_mov_b32 s37, 0
s_nop 0
v_max3_f32 v22, v160, v161, v162
v_max3_f32 v22, v22, v163, v164
v_max3_f32 v22, v22, v165, v166
v_max3_f32 v22, v22, v167, v168
v_max3_f32 v22, v22, v169, v170
v_max3_f32 v22, v22, v171, v172
v_max3_f32 v22, v22, v173, v174
v_max_f32 v22, v22, v175
v_mov_b32 v1, v22
s_nop 1
v_permlane16_swap_b32 v1, v22
v_max_f32 v22, v22, v1
v_mov_b32 v1, v22
s_nop 1
v_permlane32_swap_b32 v1, v22
v_max_f32_e64 v22, v22, v1
v_add_f32 v22, 0x41f80000, v22
Vs 160,160,22
Vs 161,161,22
Vs 162,162,22
Vs 163,163,22
Vs 164,164,22
Vs 165,165,22
Vs 166,166,22
Vs 167,167,22
Vs 168,168,22
Vs 169,169,22
Vs 170,170,22
Vs 171,171,22
Vs 172,172,22
Vs 173,173,22
Vs 174,174,22
Vs 175,175,22
v_sub_f32 v40, 0, v22
v_sub_f32 v41, 0, v22
v_sub_f32 v42, 0, v22
v_sub_f32 v43, 0, v22
v_max3_f32 v22, v176, v177, v178
v_max3_f32 v22, v22, v179, v180
v_max3_f32 v22, v22, v181, v182
v_max3_f32 v22, v22, v183, v184
v_max3_f32 v22, v22, v185, v186
v_max3_f32 v22, v22, v187, v188
v_max3_f32 v22, v22, v189, v190
v_max_f32 v22, v22, v191
v_mov_b32 v1, v22
s_nop 1
v_permlane16_swap_b32 v1, v22
v_max_f32 v22, v22, v1
v_mov_b32 v1, v22
s_nop 1
v_permlane32_swap_b32 v1, v22
v_max_f32_e64 v22, v22, v1
v_add_f32 v22, 0x41f80000, v22
Vs 176,176,22
Vs 177,177,22
Vs 178,178,22
Vs 179,179,22
Vs 180,180,22
Vs 181,181,22
Vs 182,182,22
Vs 183,183,22
Vs 184,184,22
Vs 185,185,22
Vs 186,186,22
Vs 187,187,22
Vs 188,188,22
Vs 189,189,22
Vs 190,190,22
Vs 191,191,22
v_sub_f32 v44, 0, v22
v_sub_f32 v45, 0, v22
v_sub_f32 v46, 0, v22
v_sub_f32 v47, 0, v22
Ve 8,128
Ve 9,129
Ve 10,130
Ve 11,131
Vc 64,8,9
Ve 12,144
Ve 13,145
Vc 65,10,11
Ve 14,146
Ve 15,147
Vc 72,12,13
Ve 8,160
Ve 9,161
Vc 73,14,15
Ve 10,162
Ve 11,163
Vc 80,8,9
Ve 12,176
Ve 13,177
Vc 81,10,11
Ve 14,178
Ve 15,179
Vc 88,12,13
Ve 8,132
Ve 9,133
Vc 89,14,15
Ve 10,134
Ve 11,135
Vc 66,8,9
Ve 12,148
Ve 13,149
Vc 67,10,11
Ve 14,150
Ve 15,151
Vc 74,12,13
Ve 8,164
Ve 9,165
Vc 75,14,15
Ve 10,166
Ve 11,167
Vc 82,8,9
Ve 12,180
Ve 13,181
Vc 83,10,11
Ve 14,182
Ve 15,183
Vc 90,12,13
Vc 91,14,15
v_or_b32_e64 v7, v64, v65
v_or3_b32 v7, v7, v72, v73
v_or3_b32 v7, v7, v80, v81
v_or3_b32 v7, v7, v88, v89
v_or3_b32 v7, v7, v66, v67
v_or3_b32 v7, v7, v74, v75
v_or3_b32 v7, v7, v82, v83
v_or3_b32 v7, v7, v90, v91
s_waitcnt lgkmcnt(4)
s_cmp_eq_u32 s34, 0
s_cbranch_scc1 L_k2_wlast
s_branch L_k2_wloop
L_k2_mk_wo:
v_cmp_gt_i32 s[56:57], 0, v5
v_cmp_gt_i32 s[58:59], 1, v5
v_cmp_gt_i32 s[60:61], 2, v5
v_cmp_gt_i32 s[62:63], 3, v5
s_nop 3
s_nop 0
v_cndmask_b32 v176, v176, v20, s[56:57]
v_cndmask_b32 v177, v177, v20, s[58:59]
v_cndmask_b32 v178, v178, v20, s[60:61]
v_cndmask_b32 v179, v179, v20, s[62:63]
v_cmp_gt_i32 s[56:57], 16, v5
v_cmp_gt_i32 s[58:59], 17, v5
v_cmp_gt_i32 s[60:61], 18, v5
v_cmp_gt_i32 s[62:63], 19, v5
v_cndmask_b32 v180, v180, v20, s[56:57]
v_cndmask_b32 v181, v181, v20, s[58:59]
v_cndmask_b32 v182, v182, v20, s[60:61]
v_cndmask_b32 v183, v183, v20, s[62:63]
v_cmp_gt_i32 s[56:57], 32, v5
v_cmp_gt_i32 s[58:59], 33, v5
v_cmp_gt_i32 s[60:61], 34, v5
v_cmp_gt_i32 s[62:63], 35, v5
v_cndmask_b32 v184, v184, v20, s[56:57]
v_cndmask_b32 v185, v185, v20, s[58:59]
v_cndmask_b32 v186, v186, v20, s[60:61]
v_cndmask_b32 v187, v187, v20, s[62:63]
v_cmp_gt_i32 s[56:57], 48, v5
v_cmp_gt_i32 s[58:59], 49, v5
v_cmp_gt_i32 s[60:61], 50, v5
v_cmp_gt_i32 s[62:63], 51, v5
v_cndmask_b32 v188, v188, v20, s[56:57]
v_cndmask_b32 v189, v189, v20, s[58:59]
v_cndmask_b32 v190, v190, v20, s[60:61]
v_cndmask_b32 v191, v191, v20, s[62:63]
s_branch L_k2_mkr_wo
L_k2_mk_tr:
v_cmp_gt_i32 s[56:57], 0, v5
v_cmp_gt_i32 s[58:59], 1, v5
v_cmp_gt_i32 s[60:61], 2, v5
v_cmp_gt_i32 s[62:63], 3, v5
s_nop 3
v_cndmask_b32 v144, v144, v20, s[56:57]
v_cndmask_b32 v145, v145, v20, s[58:59]
v_cndmask_b32 v146, v146, v20, s[60:61]
v_cndmask_b32 v147, v147, v20, s[62:63]
v_cmp_gt_i32 s[56:57], 16, v5
v_cmp_gt_i32 s[58:59], 17, v5
v_cmp_gt_i32 s[60:61], 18, v5
v_cmp_gt_i32 s[62:63], 19, v5
v_cndmask_b32 v148, v148, v20, s[56:57]
v_cndmask_b32 v149, v149, v20, s[58:59]
v_cndmask_b32 v150, v150, v20, s[60:61]
v_cndmask_b32 v151, v151, v20, s[62:63]
v_cmp_gt_i32 s[56:57], 32, v5
v_cmp_gt_i32 s[58:59], 33, v5
v_cmp_gt_i32 s[60:61], 34, v5
v_cmp_gt_i32 s[62:63], 35, v5
v_cndmask_b32 v152, v152, v20, s[56:57]
v_cndmask_b32 v153, v153, v20, s[58:59]
v_cndmask_b32 v154, v154, v20, s[60:61]
v_cndmask_b32 v155, v155, v20, s[62:63]
v_cmp_gt_i32 s[56:57], 48, v5
v_cmp_gt_i32 s[58:59], 49, v5
v_cmp_gt_i32 s[60:61], 50, v5
v_cmp_gt_i32 s[62:63], 51, v5
v_cndmask_b32 v156, v156, v20, s[56:57]
v_cndmask_b32 v157, v157, v20, s[58:59]
v_cndmask_b32 v158, v158, v20, s[60:61]
v_cndmask_b32 v159, v159, v20, s[62:63]
s_branch L_k2_mkr_tr
L_k2_mk_no:
v_cmp_gt_i32 s[56:57], 0, v5
v_cmp_gt_i32 s[58:59], 1, v5
v_cmp_gt_i32 s[60:61], 2, v5
v_cmp_gt_i32 s[62:63], 3, v5
s_nop 3
v_cndmask_b32 v144, v144, v20, s[56:57]
v_cndmask_b32 v145, v145, v20, s[58:59]
v_cndmask_b32 v146, v146, v20, s[60:61]
v_cndmask_b32 v147, v147, v20, s[62:63]
v_cmp_gt_i32 s[56:57], 16, v5
v_cmp_gt_i32 s[58:59], 17, v5
v_cmp_gt_i32 s[60:61], 18, v5
v_cmp_gt_i32 s[62:63], 19, v5
v_cndmask_b32 v148, v148, v20, s[56:57]
v_cndmask_b32 v149, v149, v20, s[58:59]
v_cndmask_b32 v150, v150, v20, s[60:61]
v_cndmask_b32 v151, v151, v20, s[62:63]
v_cmp_gt_i32 s[56:57], 32, v5
v_cmp_gt_i32 s[58:59], 33, v5
v_cmp_gt_i32 s[60:61], 34, v5
v_cmp_gt_i32 s[62:63], 35, v5
v_cndmask_b32 v152, v152, v20, s[56:57]
v_cndmask_b32 v153, v153, v20, s[58:59]
v_cndmask_b32 v154, v154, v20, s[60:61]
v_cndmask_b32 v155, v155, v20, s[62:63]
v_cmp_gt_i32 s[56:57], 48, v5
v_cmp_gt_i32 s[58:59], 49, v5
v_cmp_gt_i32 s[60:61], 50, v5
v_cmp_gt_i32 s[62:63], 51, v5
v_cndmask_b32 v156, v156, v20, s[56:57]
v_cndmask_b32 v157, v157, v20, s[58:59]
v_cndmask_b32 v158, v158, v20, s[60:61]
v_cndmask_b32 v159, v159, v20, s[62:63]
s_branch L_k2_mkr_no
L_pubB:
v_mov_b32 v24, 1
v_mov_b32 v25, 0
s_mov_b64 exec, 1
buffer_store_dword v24, v25, s[20:23], s64 offen sc1
s_mov_b64 exec, -1
s_branch L_pubBr
L_k2_wloop:
v_xor_b32 v2, 65536, v2
v_xor_b32 v3, 65536, v3
Cvaa 192,192,128,32
s_mov_b32 m0, s53
Ra 224,2,40960
v_lshl_add_u64 v[28:29], s[40:41], 0, v[28:29]
Mvaa 192,196,132
buffer_load_dwordx4 v4, s[12:15], s38 offen offset:0 sc1 lds
Mvaa 192,200,136
Ve 8,136
Mvaa 192,204,140
VE 9,137
Cvaa 208,192,144,36
Ra 228,2,41984
Vc 68,8,9
Mvaa 208,196,148
VE 10,138
Mvaa 208,200,152
VE 11,139
Mvaa 208,204,156
Ra 232,2,43008
Vc 69,10,11
Cvaa 224,192,160,40
Ra 236,2,44032
v_or3_b32 v7, v7, v68, v69
Mvaa 224,196,164
VE 12,152
Mvaa 224,200,168
VE 13,153
Mvaa 224,204,172
Ra 240,2,45056
Vc 76,12,13
Cvaa 240,192,176,44
VE 14,154
Mvaa 240,196,180
VE 15,155
Mvaa 240,200,184
Ra 244,2,46080
Vc 77,14,15
Mvaa 240,204,188
s_waitcnt lgkmcnt(6)
Ra 248,2,47104
v_or3_b32 v7, v7, v76, v77
Cvaa 196,208,128,32
buffer_load_dwordx4 v4, s[12:15], s38 offen offset:1024 sc1 lds
Mvaa 196,212,132
Ve 8,168
Mvaa 196,216,136
VE 9,169
Mvaa 196,220,140
Ra 252,2,48128
Vc 84,8,9
Cvaa 212,208,144,36
VE 10,170
Mvaa 212,212,148
VE 11,171
Mvaa 212,216,152
Ra 192,2,16384
Vc 85,10,11
Mvaa 212,220,156
Ra 196,2,17408
v_or3_b32 v7, v7, v84, v85
Cvaa 228,208,160,40
VE 12,184
Mvaa 228,212,164
VE 13,185
Mvaa 228,216,168
Ra 200,2,18432
Vc 92,12,13
Mvaa 228,220,172
VE 14,186
Cvaa 244,208,176,44
VE 15,187
Mvaa 244,212,180
buffer_load_dwordx4 v4, s[12:15], s38 offen offset:2048 sc1 lds
Mvaa 244,216,184
Ra 204,2,19456
Vc 93,14,15
Mvaa 244,220,188
s_waitcnt lgkmcnt(8)
Ve 8,140
Cvaa 200,224,128,32
Ra 208,2,20480
v_or3_b32 v7, v7, v92, v93
Mvaa 200,228,132
VE 9,141
Mvaa 200,232,136
Ra 212,2,21504
Vc 70,8,9
Mvaa 200,236,140
VE 10,142
Cvaa 216,224,144,36
VE 11,143
Mvaa 216,228,148
Ra 216,2,22528
Vc 71,10,11
Mvaa 216,232,152
Ra 220,2,23552
v_or3_b32 v7, v7, v70, v71
Mvaa 216,236,156
VE 12,156
Cvaa 232,224,160,40
VE 13,157
Mvaa 232,228,164
VE 14,158
Mvaa 232,232,168
VE 15,159
Mvaa 232,236,172
buffer_load_dwordx4 v4, s[12:15], s38 offen offset:3072 sc1 lds
Cvaa 248,224,176,44
VE 8,172
Mvaa 248,228,180
VE 9,173
Mvaa 248,232,184
Vc 78,12,13
Vc 79,14,15
Mvaa 248,236,188
s_waitcnt lgkmcnt(8)
Ve 10,174
Cvaa 204,240,128,32
VE 11,175
Mvaa 204,244,132
Vc 86,8,9
Vc 87,10,11
Mvaa 204,248,136
VE 12,188
Mvaa 204,252,140
VE 13,189
Cvaa 220,240,144,36
Vc 94,12,13
v_or3_b32 v7, v7, v78, v79
Mvaa 220,244,148
VE 14,190
Mvaa 220,248,152
VE 15,191
Mvaa 220,252,156
Vc 95,14,15
v_or3_b32 v7, v7, v86, v87
Cvaa 236,240,160,40
v_or3_b32 v7, v7, v94, v95
v_and_b32 v1, 0x40004000, v7
Mvaa 236,244,164
v_cmp_ne_u32 vcc, 0, v1
Mvaa 236,248,168
Mvaa 236,252,172
s_waitcnt vmcnt(12)
Cvaa 252,240,176,44
Mvaa 252,244,180
s_barrier
Mvaa 252,248,184
s_waitcnt lgkmcnt(4)
Mvaa 252,252,188
s_cbranch_vccnz L_k2_fb_we
L_k2_fbr_we:
Maav 0,192,64
Ve 8,192
Maav 0,196,68
s_add_u32 m0, s54, 49152
VE 9,193
Maav 32,192,72
buffer_load_dwordx4 v4, s[12:15], s39 offen offset:0 sc1 lds
Maav 32,196,76
s_add_u32 s37, s37, 1
Ra 224,2,24576
Vc 96,8,9
Maav 64,192,80
s_add_u32 s38, s38, 34816
Ve 10,194
Maav 64,196,84
VE 11,195
Maav 96,192,88
Ra 228,2,25600
Vc 97,10,11
Maav 96,196,92
Ra 232,2,26624
v_or_b32_e64 v7, v96, v97
Maav 4,200,64
VE 12,208
Maav 4,204,68
VE 13,209
Maav 36,200,72
Ra 236,2,27648
Vc 104,12,13
Maav 36,204,76
VE 14,210
Maav 68,200,80
VE 15,211
Maav 68,204,84
Ra 240,2,28672
Vc 105,14,15
Maav 100,200,88
Ra 244,2,29696
v_or3_b32 v7, v7, v104, v105
Maav 100,204,92
buffer_load_dwordx4 v4, s[12:15], s39 offen offset:1024 sc1 lds
Mvvv 48,16,64
VE 8,224
Mvvv 48,16,68
s_waitcnt lgkmcnt(6)
Ve 9,225
Maav 8,208,64
Ra 248,2,30720
Vc 112,8,9
Maav 8,212,68
VE 10,226
Maav 40,208,72
VE 11,227
Maav 40,212,76
Ra 252,2,31744
Vc 113,10,11
Maav 72,208,80
Ra 192,3,0
v_or3_b32 v7, v7, v112, v113
Maav 72,212,84
VE 12,240
Maav 104,208,88
VE 13,241
Maav 104,212,92
Ra 196,3,1024
Vc 120,12,13
Maav 12,216,64
VE 14,242
Maav 12,220,68
VE 15,243
Maav 44,216,72
Ra 200,3,2048
Vc 121,14,15
Maav 44,220,76
buffer_load_dwordx4 v4, s[12:15], s39 offen offset:2048 sc1 lds
Maav 76,216,80
Ra 204,3,3072
v_or3_b32 v7, v7, v120, v121
Maav 76,220,84
VE 8,196
Maav 108,216,88
VE 9,197
Maav 108,220,92
VE 10,198
Mvvv 52,16,72
VE 11,199
Mvvv 52,16,76
s_waitcnt lgkmcnt(8)
Ve 12,212
Maav 16,224,64
Ra 208,3,4096
Vc 98,8,9
Maav 16,228,68
Ra 212,3,5120
Vc 99,10,11
Maav 48,224,72
Ra 216,3,6144
v_or3_b32 v7, v7, v98, v99
Maav 48,228,76
VE 13,213
Maav 80,224,80
Ra 220,3,7168
Vc 106,12,13
Maav 80,228,84
VE 14,214
Maav 112,224,88
buffer_load_dwordx4 v4, s[12:15], s39 offen offset:3072 sc1 lds
Maav 112,228,92
s_add_u32 s39, s39, 34816
VE 15,215
Maav 20,232,64
VE 8,228
Maav 20,236,68
VE 9,229
Maav 52,232,72
VE 10,230
Maav 52,236,76
VE 11,231
Maav 84,232,80
Vc 107,14,15
Vc 114,8,9
Maav 84,236,84
VE 12,244
Maav 116,232,88
VE 13,245
Maav 116,236,92
Vc 115,10,11
Vc 122,12,13
Mvvv 56,16,80
VE 14,246
Mvvv 56,16,84
s_waitcnt lgkmcnt(8)
Ve 15,247
Maav 24,240,64
Vc 123,14,15
v_or3_b32 v7, v7, v106, v107
Maav 24,244,68
v_or3_b32 v7, v7, v114, v115
v_or3_b32 v7, v7, v122, v123
Maav 56,240,72
global_load_dword v30, v[28:29], off
Maav 56,244,76
Maav 88,240,80
Maav 88,244,84
Maav 120,240,88
Maav 120,244,92
Maav 28,248,64
Maav 28,252,68
Maav 60,248,72
Maav 60,252,76
Maav 92,248,80
Maav 92,252,84
Maav 124,248,88
Maav 124,252,92
Mvvv 60,16,88
s_waitcnt lgkmcnt(4)
Mvvv 60,16,92
Ve 8,200
Cvaa 128,192,128,32
s_add_u32 m0, s53, 32768
Ra 224,3,8192
v_lshl_add_u64 v[28:29], s[40:41], 0, v[28:29]
Mvaa 128,196,132
buffer_load_dwordx4 v4, s[12:15], s38 offen offset:0 sc1 lds
Mvaa 128,200,136
VE 9,201
Mvaa 128,204,140
Ra 228,3,9216
Vc 100,8,9
Cvaa 144,192,144,36
VE 10,202
Mvaa 144,196,148
VE 11,203
Mvaa 144,200,152
Ra 232,3,10240
Vc 101,10,11
Mvaa 144,204,156
Ra 236,3,11264
v_or3_b32 v7, v7, v100, v101
Cvaa 160,192,160,40
VE 12,216
Mvaa 160,196,164
VE 13,217
Mvaa 160,200,168
Ra 240,3,12288
Vc 108,12,13
Mvaa 160,204,172
VE 14,218
Cvaa 176,192,176,44
VE 15,219
Mvaa 176,196,180
Ra 244,3,13312
Vc 109,14,15
Mvaa 176,200,184
Ra 248,3,14336
v_or3_b32 v7, v7, v108, v109
Mvaa 176,204,188
s_waitcnt lgkmcnt(7)
Ve 8,232
Cvaa 132,208,128,32
buffer_load_dwordx4 v4, s[12:15], s38 offen offset:1024 sc1 lds
Mvaa 132,212,132
VE 9,233
Mvaa 132,216,136
Ra 252,3,15360
Vc 116,8,9
Mvaa 132,220,140
VE 10,234
Cvaa 148,208,144,36
VE 11,235
Mvaa 148,212,148
Ra 192,2,49152
Vc 117,10,11
Mvaa 148,216,152
Ra 196,2,50176
v_or3_b32 v7, v7, v116, v117
Mvaa 148,220,156
VE 12,248
Cvaa 164,208,160,40
VE 13,249
Mvaa 164,212,164
Ra 200,2,51200
Vc 124,12,13
Mvaa 164,216,168
VE 14,250
Mvaa 164,220,172
VE 15,251
Cvaa 180,208,176,44
Ra 204,2,52224
Vc 125,14,15
Mvaa 180,212,180
buffer_load_dwordx4 v4, s[12:15], s38 offen offset:2048 sc1 lds
Mvaa 180,216,184
VE 8,204
Mvaa 180,220,188
s_waitcnt lgkmcnt(8)
Ve 9,205
Cvaa 136,224,128,32
Ra 208,2,53248
Vc 102,8,9
Mvaa 136,228,132
Ra 212,2,54272
v_or3_b32 v7, v7, v124, v125
Mvaa 136,232,136
VE 10,206
Mvaa 136,236,140
VE 11,207
Cvaa 152,224,144,36
Ra 216,2,55296
Vc 103,10,11
Mvaa 152,228,148
Ra 220,2,56320
v_or3_b32 v7, v7, v102, v103
Mvaa 152,232,152
VE 12,220
Mvaa 152,236,156
VE 13,221
Cvaa 168,224,160,40
VE 14,222
Mvaa 168,228,164
VE 15,223
Mvaa 168,232,168
VE 8,236
Mvaa 168,236,172
buffer_load_dwordx4 v4, s[12:15], s38 offen offset:3072 sc1 lds
Cvaa 184,224,176,44
VE 9,237
Mvaa 184,228,180
Vc 110,12,13
Vc 111,14,15
Mvaa 184,232,184
VE 10,238
Mvaa 184,236,188
s_waitcnt lgkmcnt(8)
Ve 11,239
Cvaa 140,240,128,32
Vc 118,8,9
Vc 119,10,11
Mvaa 140,244,132
VE 12,252
Mvaa 140,248,136
VE 13,253
Mvaa 140,252,140
Vc 126,12,13
v_or3_b32 v7, v7, v110, v111
Cvaa 156,240,144,36
VE 14,254
Mvaa 156,244,148
VE 15,255
Mvaa 156,248,152
Vc 127,14,15
v_or3_b32 v7, v7, v118, v119
Mvaa 156,252,156
v_or3_b32 v7, v7, v126, v127
v_and_b32 v1, 0x40004000, v7
Cvaa 172,240,160,40
v_cmp_ne_u32 vcc, 0, v1
Mvaa 172,244,164
Mvaa 172,248,168
Mvaa 172,252,172
s_waitcnt vmcnt(12)
Cvaa 188,240,176,44
s_cmp_eq_u32 s37, s46
Mvaa 188,244,180
s_barrier
Mvaa 188,248,184
s_waitcnt lgkmcnt(4)
Mvaa 188,252,188
s_cbranch_vccnz L_k2_fb_wo
L_k2_fbr_wo:
Maav 0,192,96
s_cbranch_scc1 L_k2_mk_wo
L_k2_mkr_wo:
Ve 8,128
Maav 0,196,100
s_add_u32 m0, s53, 16384
VE 9,129
Maav 32,192,104
buffer_load_dwordx4 v4, s[12:15], s39 offen offset:0 sc1 lds
Maav 32,196,108
s_add_u32 s37, s37, 1
Ra 224,2,57344
Vc 64,8,9
Maav 64,192,112
s_add_u32 s38, s38, 34816
Ve 10,130
Maav 64,196,116
s_xor_b32 s53, s53, 65536
VE 11,131
Maav 96,192,120
s_xor_b32 s54, s54, 65536
Ra 228,2,58368
Vc 65,10,11
Maav 96,196,124
Ra 232,2,59392
v_or_b32_e64 v7, v64, v65
Maav 4,200,96
VE 12,144
Maav 4,204,100
VE 13,145
Maav 36,200,104
Ra 236,2,60416
Vc 72,12,13
Maav 36,204,108
VE 14,146
Maav 68,200,112
VE 15,147
Maav 68,204,116
Ra 240,2,61440
Vc 73,14,15
Maav 100,200,120
Ra 244,2,62464
v_or3_b32 v7, v7, v72, v73
Maav 100,204,124
buffer_load_dwordx4 v4, s[12:15], s39 offen offset:1024 sc1 lds
Mvvv 48,16,96
VE 8,160
Mvvv 48,16,100
s_waitcnt lgkmcnt(6)
Ve 9,161
Maav 8,208,96
Ra 248,2,63488
Vc 80,8,9
Maav 8,212,100
VE 10,162
Maav 40,208,104
VE 11,163
Maav 40,212,108
Ra 252,2,64512
Vc 81,10,11
Maav 72,208,112
Ra 192,3,32768
v_or3_b32 v7, v7, v80, v81
Maav 72,212,116
VE 12,176
Maav 104,208,120
VE 13,177
Maav 104,212,124
Ra 196,3,33792
Vc 88,12,13
Maav 12,216,96
VE 14,178
Maav 12,220,100
VE 15,179
Maav 44,216,104
Ra 200,3,34816
Vc 89,14,15
Maav 44,220,108
buffer_load_dwordx4 v4, s[12:15], s39 offen offset:2048 sc1 lds
Maav 76,216,112
Ra 204,3,35840
v_or3_b32 v7, v7, v88, v89
Maav 76,220,116
VE 8,132
Maav 108,216,120
VE 9,133
Maav 108,220,124
VE 10,134
Mvvv 52,16,104
VE 11,135
Mvvv 52,16,108
s_waitcnt lgkmcnt(8)
Ve 12,148
Maav 16,224,96
Ra 208,3,36864
Vc 66,8,9
Maav 16,228,100
Ra 212,3,37888
Vc 67,10,11
Maav 48,224,104
Ra 216,3,38912
v_or3_b32 v7, v7, v66, v67
Maav 48,228,108
VE 13,149
Maav 80,224,112
Ra 220,3,39936
Vc 74,12,13
Maav 80,228,116
VE 14,150
Maav 112,224,120
buffer_load_dwordx4 v4, s[12:15], s39 offen offset:3072 sc1 lds
Maav 112,228,124
s_add_u32 s39, s39, 34816
VE 15,151
Maav 20,232,96
VE 8,164
Maav 20,236,100
VE 9,165
Maav 52,232,104
VE 10,166
Maav 52,236,108
VE 11,167
Maav 84,232,112
Vc 75,14,15
Vc 82,8,9
Maav 84,236,116
VE 12,180
Maav 116,232,120
VE 13,181
Maav 116,236,124
Vc 83,10,11
Vc 90,12,13
Mvvv 56,16,112
VE 14,182
Mvvv 56,16,116
s_waitcnt lgkmcnt(8)
Ve 15,183
Maav 24,240,96
Vc 91,14,15
v_or3_b32 v7, v7, v74, v75
Maav 24,244,100
v_or3_b32 v7, v7, v82, v83
v_or3_b32 v7, v7, v90, v91
Maav 56,240,104
global_load_dword v30, v[28:29], off
Maav 56,244,108
Maav 88,240,112
Maav 88,244,116
Maav 120,240,120
Maav 120,244,124
Maav 28,248,96
Maav 28,252,100
Maav 60,248,104
Maav 60,252,108
Maav 92,248,112
Maav 92,252,116
Maav 124,248,120
Maav 124,252,124
s_cmp_lg_u32 s37, s35
Mvvv 60,16,120
s_waitcnt lgkmcnt(4)
Mvvv 60,16,124
s_cbranch_scc1 L_k2_wloop
L_k2_wlast:
v_xor_b32 v2, 65536, v2
v_xor_b32 v3, 65536, v3
Cvaa 192,192,128,32
s_mov_b32 m0, s53
Ra 224,2,40960
v_lshl_add_u64 v[28:29], s[40:41], 0, v[28:29]
Mvaa 192,196,132
buffer_load_dwordx4 v4, s[12:15], s38 offen offset:0 sc1 lds
Mvaa 192,200,136
VE 8,136
Mvaa 192,204,140
VE 9,137
Cvaa 208,192,144,36
Ra 228,2,41984
Vc 68,8,9
Mvaa 208,196,148
VE 10,138
Mvaa 208,200,152
VE 11,139
Mvaa 208,204,156
Ra 232,2,43008
Vc 69,10,11
Cvaa 224,192,160,40
Ra 236,2,44032
v_or3_b32 v7, v7, v68, v69
Mvaa 224,196,164
VE 12,152
Mvaa 224,200,168
VE 13,153
Mvaa 224,204,172
s_waitcnt lgkmcnt(4)
Ra 240,2,45056
Vc 76,12,13
Cvaa 196,208,128,32
buffer_load_dwordx4 v4, s[12:15], s38 offen offset:1024 sc1 lds
Mvaa 196,212,132
Ve 14,154
Mvaa 196,216,136
VE 15,155
Mvaa 196,220,140
Ra 244,2,46080
Vc 77,14,15
Cvaa 212,208,144,36
Ra 248,2,47104
v_or3_b32 v7, v7, v76, v77
Mvaa 212,212,148
VE 8,168
Mvaa 212,216,152
VE 9,169
Mvaa 212,220,156
Ra 252,2,48128
Vc 84,8,9
Cvaa 228,208,160,40
VE 10,170
Mvaa 228,212,164
buffer_load_dwordx4 v4, s[12:15], s38 offen offset:2048 sc1 lds
Mvaa 228,216,168
VE 11,171
Mvaa 228,220,172
s_waitcnt lgkmcnt(4)
Ra 192,2,16384
Vc 85,10,11
Cvaa 200,224,128,32
Ra 196,2,17408
v_or3_b32 v7, v7, v84, v85
Mvaa 200,228,132
Ve 12,184
Mvaa 200,232,136
VE 13,185
Mvaa 200,236,140
Ra 200,2,18432
Vc 92,12,13
Cvaa 216,224,144,36
VE 14,186
Mvaa 216,228,148
VE 15,187
Mvaa 216,232,152
Ra 204,2,19456
Vc 93,14,15
Mvaa 216,236,156
buffer_load_dwordx4 v4, s[12:15], s38 offen offset:3072 sc1 lds
Cvaa 232,224,160,40
Ra 208,2,20480
v_or3_b32 v7, v7, v92, v93
Mvaa 232,228,164
VE 8,140
Mvaa 232,232,168
VE 9,141
Mvaa 232,236,172
s_waitcnt lgkmcnt(5)
Ra 212,2,21504
Vc 70,8,9
Cvaa 204,240,128,32
Ve 10,142
Mvaa 204,244,132
VE 11,143
Mvaa 204,248,136
Ra 216,2,22528
Vc 71,10,11
Mvaa 204,252,140
Ra 220,2,23552
v_or3_b32 v7, v7, v70, v71
Cvaa 220,240,144,36
VE 12,156
Mvaa 220,244,148
VE 13,157
Mvaa 220,248,152
VE 14,158
Mvaa 220,252,156
s_waitcnt vmcnt(12)
Ve 15,159
Cvaa 236,240,160,40
VE 8,172
Mvaa 236,244,164
s_barrier
Ve 9,173
Mvaa 236,248,168
s_waitcnt lgkmcnt(4)
Vc 78,12,13
Vc 79,14,15
Ve 10,174
Ve 11,175
Ve 12,188
Ve 13,189
Ve 14,190
VE 15,191
Vc 86,8,9
Vc 87,10,11
Vc 94,12,13
Vc 95,14,15
v_or3_b32 v7, v7, v78, v79
v_or3_b32 v7, v7, v86, v87
v_or3_b32 v7, v7, v94, v95
v_and_b32 v1, 0x40004000, v7
v_cmp_ne_u32 vcc, 0, v1
Mvaa 236,252,172
s_cbranch_vccnz L_k2_fb_wl
L_k2_fbr_wl:
Maav 0,192,64
v_cmp_gt_i32 s[56:57], 0, v6
v_cmp_gt_i32 s[58:59], 1, v6
v_cmp_gt_i32 s[60:61], 2, v6
v_cmp_gt_i32 s[62:63], 3, v6
s_nop 3
s_nop 0
v_cndmask_b32 v224, v224, v20, s[56:57]
v_cndmask_b32 v225, v225, v20, s[58:59]
v_cndmask_b32 v226, v226, v20, s[60:61]
v_cndmask_b32 v227, v227, v20, s[62:63]
v_cmp_gt_i32 s[56:57], 16, v6
v_cmp_gt_i32 s[58:59], 17, v6
v_cmp_gt_i32 s[60:61], 18, v6
v_cmp_gt_i32 s[62:63], 19, v6
v_cndmask_b32 v228, v228, v20, s[56:57]
v_cndmask_b32 v229, v229, v20, s[58:59]
v_cndmask_b32 v230, v230, v20, s[60:61]
v_cndmask_b32 v231, v231, v20, s[62:63]
v_cmp_gt_i32 s[56:57], 32, v6
v_cmp_gt_i32 s[58:59], 33, v6
v_cmp_gt_i32 s[60:61], 34, v6
v_cmp_gt_i32 s[62:63], 35, v6
v_cndmask_b32 v232, v232, v20, s[56:57]
v_cndmask_b32 v233, v233, v20, s[58:59]
v_cndmask_b32 v234, v234, v20, s[60:61]
v_cndmask_b32 v235, v235, v20, s[62:63]
v_cmp_gt_i32 s[56:57], 48, v6
v_cmp_gt_i32 s[58:59], 49, v6
v_cmp_gt_i32 s[60:61], 50, v6
v_cmp_gt_i32 s[62:63], 51, v6
v_cndmask_b32 v236, v236, v20, s[56:57]
v_cndmask_b32 v237, v237, v20, s[58:59]
v_cndmask_b32 v238, v238, v20, s[60:61]
v_cndmask_b32 v239, v239, v20, s[62:63]
VE 8,192
Maav 0,196,68
s_add_u32 m0, s54, 49152
VE 9,193
Maav 32,192,72
buffer_load_dwordx4 v4, s[12:15], s39 offen offset:0 sc1 lds
Maav 32,196,76
s_add_u32 s37, s37, 1
Ra 224,2,24576
Vc 96,8,9
Maav 64,192,80
s_add_u32 s38, s38, 34816
Ve 10,194
Maav 64,196,84
VE 11,195
Maav 96,192,88
Ra 228,2,25600
Vc 97,10,11
Maav 96,196,92
Ra 232,2,26624
v_or_b32_e64 v7, v96, v97
Maav 4,200,64
VE 12,208
Maav 4,204,68
VE 13,209
Maav 36,200,72
Ra 236,2,27648
Vc 104,12,13
Maav 36,204,76
VE 14,210
Maav 68,200,80
VE 15,211
Maav 68,204,84
Ra 240,2,28672
Vc 105,14,15
Maav 100,200,88
Ra 244,2,29696
v_or3_b32 v7, v7, v104, v105
Maav 100,204,92
buffer_load_dwordx4 v4, s[12:15], s39 offen offset:1024 sc1 lds
Mvvv 48,16,64
VE 8,224
Mvvv 48,16,68
s_waitcnt lgkmcnt(6)
Ve 9,225
Maav 8,208,64
Ra 248,2,30720
Vc 112,8,9
Maav 8,212,68
VE 10,226
Maav 40,208,72
VE 11,227
Maav 40,212,76
Ra 252,2,31744
Vc 113,10,11
Maav 72,208,80
Ra 192,3,0
v_or3_b32 v7, v7, v112, v113
Maav 72,212,84
VE 12,196
Maav 104,208,88
VE 13,197
Maav 104,212,92
Ra 196,3,1024
Vc 98,12,13
Maav 12,216,64
VE 14,198
Maav 12,220,68
VE 15,199
Maav 44,216,72
Ra 200,3,2048
Vc 99,14,15
Maav 44,220,76
buffer_load_dwordx4 v4, s[12:15], s39 offen offset:2048 sc1 lds
Maav 76,216,80
Ra 204,3,3072
v_or3_b32 v7, v7, v98, v99
Maav 76,220,84
VE 8,212
Maav 108,216,88
VE 9,213
Maav 108,220,92
VE 10,214
Mvvv 52,16,72
VE 11,215
Mvvv 52,16,76
s_waitcnt lgkmcnt(8)
Ve 12,228
Maav 16,224,64
Ra 208,3,4096
Vc 106,8,9
Maav 16,228,68
Ra 212,3,5120
Vc 107,10,11
Maav 48,224,72
Ra 216,3,6144
v_or3_b32 v7, v7, v106, v107
Maav 48,228,76
VE 13,229
Maav 80,224,80
Ra 220,3,7168
Vc 114,12,13
Maav 80,228,84
VE 14,230
Maav 112,224,88
buffer_load_dwordx4 v4, s[12:15], s39 offen offset:3072 sc1 lds
Maav 112,228,92
s_add_u32 s39, s39, 34816
VE 15,231
Maav 20,232,64
VE 8,200
Maav 20,236,68
VE 9,201
Maav 52,232,72
VE 10,202
Maav 52,236,76
VE 11,203
Maav 84,232,80
Vc 115,14,15
Vc 100,8,9
Maav 84,236,84
VE 12,216
Maav 116,232,88
VE 13,217
Maav 116,236,92
Vc 101,10,11
Vc 108,12,13
Mvvv 56,16,80
VE 14,218
Mvvv 56,16,84
s_waitcnt lgkmcnt(8)
Ve 15,219
Maav 24,240,64
Vc 109,14,15
v_or3_b32 v7, v7, v114, v115
Maav 24,244,68
VE 8,232
Maav 56,240,72
global_load_dword v30, v[28:29], off
Maav 56,244,76
VE 9,233
Maav 88,240,80
Vc 116,8,9
v_or3_b32 v7, v7, v100, v101
Maav 88,244,84
VE 10,234
Maav 120,240,88
VE 11,235
Maav 120,244,92
Vc 117,10,11
v_or3_b32 v7, v7, v108, v109
Maav 28,248,64
v_or3_b32 v7, v7, v116, v117
Maav 28,252,68
Maav 60,248,72
Maav 60,252,76
Maav 92,248,80
Maav 92,252,84
Maav 124,248,88
Maav 124,252,92
Mvvv 60,16,88
s_waitcnt lgkmcnt(4)
Mvvv 60,16,92
Ve 12,204
Cvaa 128,192,128,32
s_add_u32 m0, s53, 32768
VE 13,205
Mvaa 128,196,132
buffer_load_dwordx4 v4, s[12:15], s38 offen offset:0 sc1 lds
Mvaa 128,200,136
Ra 224,3,8192
Vc 102,12,13
Mvaa 128,204,140
VE 14,206
Cvaa 144,192,144,36
VE 15,207
Mvaa 144,196,148
Ra 228,3,9216
Vc 103,14,15
Mvaa 144,200,152
Ra 232,3,10240
v_or3_b32 v7, v7, v102, v103
Mvaa 144,204,156
s_waitcnt lgkmcnt(3)
Ra 236,3,11264
Ra 240,3,12288
Cvaa 132,208,128,32
buffer_load_dwordx4 v4, s[12:15], s38 offen offset:1024 sc1 lds
Mvaa 132,212,132
Ve 8,220
Mvaa 132,216,136
VE 9,221
Mvaa 132,220,140
Ra 244,3,13312
Vc 110,8,9
Cvaa 148,208,144,36
VE 10,222
Mvaa 148,212,148
buffer_load_dwordx4 v4, s[12:15], s38 offen offset:2048 sc1 lds
Mvaa 148,216,152
VE 11,223
Mvaa 148,220,156
s_waitcnt lgkmcnt(2)
Ra 248,3,14336
Ra 252,3,15360
Cvaa 136,224,128,32
Ra 192,2,49152
Vc 111,10,11
Mvaa 136,228,132
Ra 196,2,50176
v_or3_b32 v7, v7, v110, v111
Mvaa 136,232,136
Ve 12,236
Mvaa 136,236,140
buffer_load_dwordx4 v4, s[12:15], s38 offen offset:3072 sc1 lds
Cvaa 152,224,144,36
VE 13,237
Mvaa 152,228,148
Ra 200,2,51200
Vc 118,12,13
Mvaa 152,232,152
VE 14,238
Mvaa 152,236,156
s_waitcnt lgkmcnt(3)
Ra 204,2,52224
Ra 208,2,53248
Cvaa 140,240,128,32
Ve 15,239
Mvaa 140,244,132
Ra 212,2,54272
Vc 119,14,15
Mvaa 140,248,136
Ra 216,2,55296
v_or3_b32 v7, v7, v118, v119
Mvaa 140,252,140
s_waitcnt vmcnt(12)
Ra 220,2,56320
v_and_b32 v1, 0x40004000, v7
Cvaa 156,240,144,36
s_cmp_eq_u32 s37, s45
v_cmp_ne_u32 vcc, 0, v1
Mvaa 156,244,148
s_barrier
Mvaa 156,248,152
s_waitcnt lgkmcnt(4)
Mvaa 156,252,156
s_cbranch_vccnz L_k2_fb_tr
L_k2_fbr_tr:
Maav 0,192,96
s_cbranch_scc1 L_k2_mk_tr
L_k2_mkr_tr:
Ve 8,128
Maav 0,196,100
s_add_u32 m0, s53, 16384
VE 9,129
Maav 32,192,104
buffer_load_dwordx4 v4, s[12:15], s39 offen offset:0 sc1 lds
Maav 32,196,108
s_add_u32 s37, s37, 1
Ra 224,2,57344
Vc 64,8,9
Maav 64,192,112
s_add_u32 s38, s38, 34816
Ve 10,130
Maav 64,196,116
s_xor_b32 s53, s53, 65536
VE 11,131
Maav 4,200,96
s_xor_b32 s54, s54, 65536
Ra 228,2,58368
Vc 65,10,11
Maav 4,204,100
Ra 232,2,59392
v_or_b32_e64 v7, v64, v65
Maav 36,200,104
VE 12,144
Maav 36,204,108
VE 13,145
Maav 68,200,112
Ra 236,2,60416
Vc 72,12,13
Maav 68,204,116
VE 14,146
Mvvv 48,16,96
VE 15,147
Mvvv 48,16,100
s_waitcnt lgkmcnt(4)
Ra 240,2,61440
Vc 73,14,15
Maav 8,208,96
buffer_load_dwordx4 v4, s[12:15], s39 offen offset:1024 sc1 lds
Maav 8,212,100
Ra 244,2,62464
v_or3_b32 v7, v7, v72, v73
Maav 40,208,104
Ve 8,132
Maav 40,212,108
VE 9,133
Maav 72,208,112
Ra 248,2,63488
Vc 66,8,9
Maav 72,212,116
VE 10,134
Maav 12,216,96
VE 11,135
Maav 12,220,100
Ra 252,2,64512
Vc 67,10,11
Maav 44,216,104
Ra 192,3,32768
v_or3_b32 v7, v7, v66, v67
Maav 44,220,108
VE 12,148
Maav 76,216,112
VE 13,149
Maav 76,220,116
Ra 196,3,33792
Vc 74,12,13
Mvvv 52,16,104
VE 14,150
Mvvv 52,16,108
s_waitcnt lgkmcnt(6)
Ve 15,151
Maav 16,224,96
buffer_load_dwordx4 v4, s[12:15], s39 offen offset:2048 sc1 lds
Maav 16,228,100
Ra 200,3,34816
Vc 75,14,15
Maav 48,224,104
Ra 204,3,35840
v_or3_b32 v7, v7, v74, v75
Maav 48,228,108
VE 8,136
Maav 80,224,112
Ra 208,3,36864
Ra 212,3,37888
Maav 80,228,116
Ra 216,3,38912
Ra 220,3,39936
Maav 20,232,96
Maav 20,236,100
Maav 52,232,104
Maav 52,236,108
Maav 84,232,112
Maav 84,236,116
buffer_load_dwordx4 v4, s[12:15], s39 offen offset:3072 sc1 lds
Mvvv 56,16,112
s_add_u32 s39, s39, 34816
Mvvv 56,16,116
s_waitcnt lgkmcnt(8)
Maav 24,240,96
Maav 24,244,100
Maav 56,240,104
Maav 56,244,108
Maav 88,240,112
Maav 88,244,116
Maav 28,248,96
Maav 28,252,100
Maav 60,248,104
Maav 60,252,108
Maav 92,248,112
s_waitcnt lgkmcnt(4)
Maav 92,252,116
s_getpc_b64 s[56:57]
L_cpf4:
s_add_u32 s56, s56, (L_k2_fin-L_cpf4)&0xffffffff
s_addc_u32 s57, s57, ((L_k2_fin-L_cpf4)>>32)&0xffffffff
s_lshr_b32 s58, s2, 3
s_lshl_b32 s58, s58, 2
s_add_u32 s58, s58, s32
s_lshl_b32 s58, s58, 10
v_and_b32 v162, 7, v0
v_lshlrev_b32 v162, 7, v162
v_add_u32 v162, s58, v162
v_min_u32 v162, L_p4_end-L_k2_fin-4, v162
v_mov_b32 v161, s57
v_add_co_u32 v160, vcc, s56, v162
s_nop 1
v_addc_co_u32 v161, vcc, 0, v161, vcc
global_load_dword v164, v[160:161], off
s_waitcnt vmcnt(9)
s_lshl_b32 s3, s34, 20
s_lshl_b32 s47, s33, 15
s_add_u32 s3, s3, s47
s_lshl_b32 s47, s32, 10
v_lshlrev_b32 v248, 4, v0
v_add_u32_e64 v249, s47, v248
s_sub_u32 s47, 7168, s47
v_add_u32 v248, s47, v248
v_rcp_f32 v250, v56
v_rcp_f32 v252, v60
v_mov_b32 v251, v250
v_mov_b32_e64 v253, v252
Ar 240,96
Ar 241,97
Ar 242,98
Ar 243,99
Ar 244,100
Ar 245,101
Ar 246,102
Ar 247,103
v_pk_mul_f32 v[240:241], v[240:241], v[252:253]
v_pk_mul_f32 v[242:243], v[242:243], v[252:253]
v_pk_mul_f32 v[244:245], v[244:245], v[252:253]
v_pk_mul_f32 v[246:247], v[246:247], v[252:253]
Vc 28,240,241
Vc 29,242,243
Vc 30,244,245
Vc 31,246,247
buffer_store_dwordx4 v[28:31], v249, s[16:19], s3 offen sc1
Ar 240,64
Ar 241,65
Ar 242,66
Ar 243,67
Ar 244,68
Ar 245,69
Ar 246,70
Ar 247,71
v_pk_mul_f32 v[240:241], v[240:241], v[250:251]
v_pk_mul_f32 v[242:243], v[242:243], v[250:251]
v_pk_mul_f32 v[244:245], v[244:245], v[250:251]
v_pk_mul_f32 v[246:247], v[246:247], v[250:251]
Vc 24,240,241
Vc 25,242,243
Vc 26,244,245
Vc 27,246,247
buffer_store_dwordx4 v[24:27], v248, s[16:19], s3 offen sc1
s_add_u32 s3, s3, 8192
Ar 240,104
Ar 241,105
Ar 242,106
Ar 243,107
Ar 244,108
Ar 245,109
Ar 246,110
Ar 247,111
v_pk_mul_f32 v[240:241], v[240:241], v[252:253]
v_pk_mul_f32 v[242:243], v[242:243], v[252:253]
v_pk_mul_f32 v[244:245], v[244:245], v[252:253]
v_pk_mul_f32 v[246:247], v[246:247], v[252:253]
Vc 28,240,241
Vc 29,242,243
Vc 30,244,245
Vc 31,246,247
buffer_store_dwordx4 v[28:31], v249, s[16:19], s3 offen sc1
Ar 240,72
Ar 241,73
Ar 242,74
Ar 243,75
Ar 244,76
Ar 245,77
Ar 246,78
Ar 247,79
v_pk_mul_f32 v[240:241], v[240:241], v[250:251]
v_pk_mul_f32 v[242:243], v[242:243], v[250:251]
v_pk_mul_f32 v[244:245], v[244:245], v[250:251]
v_pk_mul_f32 v[246:247], v[246:247], v[250:251]
Vc 24,240,241
Vc 25,242,243
Vc 26,244,245
Vc 27,246,247
buffer_store_dwordx4 v[24:27], v248, s[16:19], s3 offen sc1
s_add_u32 s3, s3, 8192
Ar 240,112
Ar 241,113
Ar 242,114
Ar 243,115
Ar 244,116
Ar 245,117
Ar 246,118
Ar 247,119
v_pk_mul_f32 v[240:241], v[240:241], v[252:253]
v_pk_mul_f32 v[242:243], v[242:243], v[252:253]
v_pk_mul_f32 v[244:245], v[244:245], v[252:253]
v_pk_mul_f32 v[246:247], v[246:247], v[252:253]
Vc 28,240,241
Vc 29,242,243
Vc 30,244,245
Vc 31,246,247
buffer_store_dwordx4 v[28:31], v249, s[16:19], s3 offen sc1
Ar 240,80
Ar 241,81
Ar 242,82
Ar 243,83
Ar 244,84
Ar 245,85
Ar 246,86
Ar 247,87
v_pk_mul_f32 v[240:241], v[240:241], v[250:251]
v_pk_mul_f32 v[242:243], v[242:243], v[250:251]
v_pk_mul_f32 v[244:245], v[244:245], v[250:251]
v_pk_mul_f32 v[246:247], v[246:247], v[250:251]
Vc 24,240,241
Vc 25,242,243
Vc 26,244,245
Vc 27,246,247
buffer_store_dwordx4 v[24:27], v248, s[16:19], s3 offen sc1
s_add_u32 s3, s3, 8192
Ar 240,120
Ar 241,121
Ar 242,122
Ar 243,123
Ar 244,124
Ar 245,125
Ar 246,126
Ar 247,127
v_pk_mul_f32 v[240:241], v[240:241], v[252:253]
v_pk_mul_f32 v[242:243], v[242:243], v[252:253]
v_pk_mul_f32 v[244:245], v[244:245], v[252:253]
v_pk_mul_f32 v[246:247], v[246:247], v[252:253]
Vc 28,240,241
Vc 29,242,243
Vc 30,244,245
Vc 31,246,247
buffer_store_dwordx4 v[28:31], v249, s[16:19], s3 offen sc1
Ar 240,88
Ar 241,89
Ar 242,90
Ar 243,91
Ar 244,92
Ar 245,93
Ar 246,94
Ar 247,95
v_pk_mul_f32 v[240:241], v[240:241], v[250:251]
v_pk_mul_f32 v[242:243], v[242:243], v[250:251]
v_pk_mul_f32 v[244:245], v[244:245], v[250:251]
v_pk_mul_f32 v[246:247], v[246:247], v[250:251]
Vc 24,240,241
Vc 25,242,243
Vc 26,244,245
Vc 27,246,247
buffer_store_dwordx4 v[24:27], v248, s[16:19], s3 offen sc1
s_add_u32 s52, s37, 2
s_load_dwordx2 s[94:95], s[0:1], 40
s_load_dwordx2 s[40:41], s[0:1], 0
s_load_dwordx4 s[8:11], s[0:1], 80
s_waitcnt vmcnt(8) lgkmcnt(0)
s_add_u32 s93, s2, 224
s_and_b32 s93, s93, 255
s_nop 0
s_mul_i32 s92, s93, 2341
s_lshr_b32 s92, s92, 16
s_mul_i32 s47, s92, 28
s_sub_u32 s4, s93, s47
s_mul_i32 s5, s92, 917504
s_lshl_b32 s47, s4, 8
s_add_u32 s5, s5, s47
s_cmp_eq_u32 s34, 7
s_cbranch_scc1 L_k2_fin
L_k2_nloop:
v_xor_b32 v2, 65536, v2
v_xor_b32 v3, 65536, v3
Cvaa 192,192,128,32
s_mov_b32 m0, s53
Ve 9,137
Mvaa 192,196,132
buffer_load_dwordx4 v4, s[12:15], s38 offen offset:0 sc1 lds
Mvaa 192,200,136
Ra 224,2,40960
Vc 68,8,9
Mvaa 192,204,140
VE 10,138
Cvaa 208,192,144,36
VE 11,139
Mvaa 208,196,148
Ra 228,2,41984
Vc 69,10,11
Mvaa 208,200,152
Ra 232,2,43008
v_or3_b32 v7, v7, v68, v69
Mvaa 208,204,156
s_waitcnt lgkmcnt(3)
Ra 236,2,44032
Ra 240,2,45056
Cvaa 196,208,128,32
buffer_load_dwordx4 v4, s[12:15], s38 offen offset:1024 sc1 lds
Mvaa 196,212,132
Ve 12,152
Mvaa 196,216,136
VE 13,153
Mvaa 196,220,140
Ra 244,2,46080
Vc 76,12,13
Cvaa 212,208,144,36
VE 14,154
Mvaa 212,212,148
buffer_load_dwordx4 v4, s[12:15], s38 offen offset:2048 sc1 lds
Mvaa 212,216,152
VE 15,155
Mvaa 212,220,156
s_waitcnt lgkmcnt(2)
Ra 248,2,47104
Ra 252,2,48128
Cvaa 200,224,128,32
Ra 192,2,16384
Vc 77,14,15
Mvaa 200,228,132
Ra 196,2,17408
v_or3_b32 v7, v7, v76, v77
Mvaa 200,232,136
Ve 8,140
Mvaa 200,236,140
buffer_load_dwordx4 v4, s[12:15], s38 offen offset:3072 sc1 lds
Cvaa 216,224,144,36
VE 9,141
Mvaa 216,228,148
Ra 200,2,18432
Vc 70,8,9
Mvaa 216,232,152
VE 10,142
Mvaa 216,236,156
s_waitcnt lgkmcnt(3)
Ra 204,2,19456
Ra 208,2,20480
Cvaa 204,240,128,32
Ve 11,143
Mvaa 204,244,132
s_cmp_lt_u32 s37, s52
Ra 212,2,21504
Vc 71,10,11
Mvaa 204,248,136
s_cbranch_scc1 L_nw_ne
s_waitcnt vmcnt(12)
L_nw_ne:
Ra 216,2,22528
v_or3_b32 v7, v7, v70, v71
Mvaa 204,252,140
Ve 12,156
Cvaa 220,240,144,36
VE 13,157
Mvaa 220,244,148
s_barrier
Ra 220,2,23552
Vc 78,12,13
Mvaa 220,248,152
s_waitcnt lgkmcnt(4)
Ve 14,158
Ve 15,159
s_nop 0
Vc 79,14,15
v_or3_b32 v7, v7, v78, v79
v_and_b32 v1, 0x40004000, v7
v_cmp_ne_u32 vcc, 0, v1
Mvaa 220,252,156
s_cbranch_vccnz L_k2_fb_ne
L_k2_fbr_ne:
Maav 0,192,64
Ve 8,192
Maav 0,196,68
s_add_u32 m0, s54, 49152
VE 9,193
Maav 32,192,72
buffer_load_dwordx4 v4, s[12:15], s39 offen offset:0 sc1 lds
Maav 32,196,76
s_cmp_eq_u32 s37, s52
Ra 224,2,24576
Vc 96,8,9
Maav 4,200,64
s_cbranch_scc1 L_pubB
L_pubBr:
VE 10,194
Maav 4,204,68
s_add_u32 s37, s37, 1
Ve 11,195
Maav 36,200,72
s_add_u32 s38, s38, 34816
Ra 228,2,25600
Vc 97,10,11
Maav 36,204,76
Ra 232,2,26624
v_or_b32_e64 v7, v96, v97
Mvvv 48,16,64
VE 12,208
Mvvv 48,16,68
s_waitcnt lgkmcnt(3)
Ra 236,2,27648
Ra 240,2,28672
Maav 8,208,64
buffer_load_dwordx4 v4, s[12:15], s39 offen offset:1024 sc1 lds
Maav 8,212,68
Ve 13,209
Maav 40,208,72
Ra 244,2,29696
Vc 104,12,13
Maav 40,212,76
VE 14,210
Maav 12,216,64
VE 15,211
Maav 12,220,68
Ra 248,2,30720
Vc 105,14,15
Maav 44,216,72
Ra 252,2,31744
v_or3_b32 v7, v7, v104, v105
Maav 44,220,76
VE 8,196
Mvvv 52,16,72
buffer_load_dwordx4 v4, s[12:15], s39 offen offset:2048 sc1 lds
Mvvv 52,16,76
s_waitcnt lgkmcnt(4)
Ve 9,197
Maav 16,224,64
Ra 192,3,0
Vc 98,8,9
Maav 16,228,68
VE 10,198
Maav 48,224,72
VE 11,199
Maav 48,228,76
Ra 196,3,1024
Vc 99,10,11
Maav 20,232,64
Ra 200,3,2048
v_or3_b32 v7, v7, v98, v99
Maav 20,236,68
Ra 204,3,3072
Ra 208,3,4096
Maav 52,232,72
buffer_load_dwordx4 v4, s[12:15], s39 offen offset:3072 sc1 lds
Maav 52,236,76
s_waitcnt lgkmcnt(5)
Ve 12,212
Maav 24,240,64
s_add_u32 s39, s39, 34816
VE 13,213
Maav 24,244,68
Ra 212,3,5120
Vc 106,12,13
Maav 56,240,72
VE 14,214
Maav 56,244,76
VE 15,215
Maav 28,248,64
Ra 216,3,6144
Vc 107,14,15
Maav 28,252,68
Ra 220,3,7168
v_or3_b32 v7, v7, v106, v107
Maav 60,248,72
s_waitcnt lgkmcnt(4)
Ve 8,200
Maav 60,252,76
VE 9,201
Cvaa 128,192,128,32
s_add_u32 m0, s53, 32768
Ra 224,3,8192
Vc 100,8,9
Mvaa 128,196,132
buffer_load_dwordx4 v4, s[12:15], s38 offen offset:0 sc1 lds
Mvaa 128,200,136
VE 10,202
Mvaa 128,204,140
VE 11,203
Cvaa 144,192,144,36
Ra 228,3,9216
Vc 101,10,11
Mvaa 144,196,148
Ra 232,3,10240
v_or3_b32 v7, v7, v100, v101
Mvaa 144,200,152
VE 12,216
Mvaa 144,204,156
s_waitcnt lgkmcnt(3)
Ra 236,3,11264
Ra 240,3,12288
Cvaa 132,208,128,32
buffer_load_dwordx4 v4, s[12:15], s38 offen offset:1024 sc1 lds
Mvaa 132,212,132
Ve 13,217
Mvaa 132,216,136
Ra 244,3,13312
Vc 108,12,13
Mvaa 132,220,140
VE 14,218
Cvaa 148,208,144,36
VE 15,219
Mvaa 148,212,148
buffer_load_dwordx4 v4, s[12:15], s38 offen offset:2048 sc1 lds
Mvaa 148,216,152
Ra 248,3,14336
Vc 109,14,15
Mvaa 148,220,156
s_waitcnt lgkmcnt(3)
Ra 252,3,15360
v_or3_b32 v7, v7, v108, v109
Cvaa 136,224,128,32
Ve 8,204
Mvaa 136,228,132
VE 9,205
Mvaa 136,232,136
Ra 192,2,49152
Vc 102,8,9
Mvaa 136,236,140
buffer_load_dwordx4 v4, s[12:15], s38 offen offset:3072 sc1 lds
Cvaa 152,224,144,36
VE 10,206
Mvaa 152,228,148
VE 11,207
Mvaa 152,232,152
Ra 196,2,50176
Vc 103,10,11
Mvaa 152,236,156
s_waitcnt lgkmcnt(2)
Ra 200,2,51200
Ra 204,2,52224
Cvaa 140,240,128,32
Ra 208,2,53248
v_or3_b32 v7, v7, v102, v103
Mvaa 140,244,132
s_cmp_lt_u32 s37, s52
VE 12,220
Mvaa 140,248,136
s_cbranch_scc1 L_nw_no
s_waitcnt vmcnt(12)
L_nw_no:
VE 13,221
Mvaa 140,252,140
Ra 212,2,54272
Vc 110,12,13
Cvaa 156,240,144,36
s_cmp_eq_u32 s37, s45
Ve 14,222
Mvaa 156,244,148
s_barrier
Ve 15,223
Mvaa 156,248,152
s_waitcnt lgkmcnt(2)
Ra 216,2,55296
Vc 111,14,15
v_or3_b32 v7, v7, v110, v111
v_and_b32 v1, 0x40004000, v7
v_cmp_ne_u32 vcc, 0, v1
Mvaa 156,252,156
s_cbranch_vccnz L_k2_fb_no
L_k2_fbr_no:
Ra 220,2,56320
Maav 0,192,96
s_cbranch_scc1 L_k2_mk_no
L_k2_mkr_no:
VE 8,128
Maav 0,196,100
s_add_u32 m0, s53, 16384
VE 9,129
Maav 32,192,104
buffer_load_dwordx4 v4, s[12:15], s39 offen offset:0 sc1 lds
Maav 32,196,108
s_add_u32 s37, s37, 1
Ra 224,2,57344
Vc 64,8,9
Maav 4,200,96
s_add_u32 s38, s38, 34816
Ve 10,130
Maav 4,204,100
s_xor_b32 s53, s53, 65536
VE 11,131
Maav 36,200,104
s_xor_b32 s54, s54, 65536
Ra 228,2,58368
Vc 65,10,11
Maav 36,204,108
Ra 232,2,59392
v_or_b32_e64 v7, v64, v65
Mvvv 48,16,96
VE 12,144
Mvvv 48,16,100
s_waitcnt lgkmcnt(3)
Ra 236,2,60416
Ra 240,2,61440
Maav 8,208,96
buffer_load_dwordx4 v4, s[12:15], s39 offen offset:1024 sc1 lds
Maav 8,212,100
Ve 13,145
Maav 40,208,104
Ra 244,2,62464
Vc 72,12,13
Maav 40,212,108
VE 14,146
Maav 12,216,96
VE 15,147
Maav 12,220,100
Ra 248,2,63488
Vc 73,14,15
Maav 44,216,104
Ra 252,2,64512
v_or3_b32 v7, v7, v72, v73
Maav 44,220,108
VE 8,132
Mvvv 52,16,104
buffer_load_dwordx4 v4, s[12:15], s39 offen offset:2048 sc1 lds
Mvvv 52,16,108
s_waitcnt lgkmcnt(4)
Ve 9,133
Maav 16,224,96
Ra 192,3,32768
Vc 66,8,9
Maav 16,228,100
VE 10,134
Maav 48,224,104
VE 11,135
Maav 48,228,108
Ra 196,3,33792
Vc 67,10,11
Maav 20,232,96
Ra 200,3,34816
v_or3_b32 v7, v7, v66, v67
Maav 20,236,100
Ra 204,3,35840
Ra 208,3,36864
Maav 52,232,104
buffer_load_dwordx4 v4, s[12:15], s39 offen offset:3072 sc1 lds
Maav 52,236,108
s_waitcnt lgkmcnt(5)
Ve 12,148
Maav 24,240,96
s_add_u32 s39, s39, 34816
VE 13,149
Maav 24,244,100
Ra 212,3,37888
Vc 74,12,13
Maav 56,240,104
VE 14,150
Maav 56,244,108
VE 15,151
Maav 28,248,96
Ra 216,3,38912
Vc 75,14,15
Maav 28,252,100
s_cmp_lg_u32 s37, s36
Ra 220,3,39936
v_or3_b32 v7, v7, v74, v75
Maav 60,248,104
s_waitcnt lgkmcnt(4)
VE 8,136
Maav 60,252,108
s_cbranch_scc1 L_k2_nloop
L_k2_fin:
v_xor_b32 v2, 65536, v2
v_xor_b32 v3, 65536, v3
s_lshr_b32 s3, s42, 4
s_mul_i32 s3, s3, 33792
s_and_b32 s47, s42, 15
s_lshl_b32 s47, s47, 4
s_add_u32 s3, s3, s47
v_mov_b32 v28, s3
s_lshr_b32 s3, s43, 4
s_mul_i32 s3, s3, 33792
s_and_b32 s47, s43, 15
s_lshl_b32 s47, s47, 4
s_add_u32 s3, s3, s47
v_mov_b32 v29, s3
v_lshrrev_b32 v24, 4, v0
v_and_b32 v25, 15, v0
v_cmp_eq_u32 vcc, 1, v25
s_lshl_b32 s3, s32, 4
v_add_u32 v26, s3, v24
v_cndmask_b32 v28, v28, v29, vcc
v_lshl_add_u32 v28, v24, 8, v28
v_mul_u32_u24 v26, 7168, v26
v_lshlrev_b32 v24, 1, v24
v_xor_b32 v24, v24, v25
v_xor_b32 v25, 8, v24
v_lshl_add_u32 v24, v24, 4, v26
v_lshl_add_u32 v25, v25, 4, v26
s_lshl_b32 s3, s92, 12
buffer_load_dwordx4 a[160:163], v28, s[20:23], s3 offen offset:0 sc1
buffer_load_dwordx4 a[164:167], v28, s[20:23], s3 offen offset:1024 sc1
buffer_load_dwordx4 a[168:171], v28, s[20:23], s3 offen offset:2048 sc1
buffer_load_dwordx4 a[172:175], v28, s[20:23], s3 offen offset:3072 sc1
Cvaa 192,192,128,32
s_add_u32 m0, s54, 0
s_add_u32 s3, s5, 0
Ve 9,137
Mvaa 192,196,132
buffer_load_dwordx4 v24, s[24:27], s3 offen offset:0 lds
Mvaa 192,200,136
Ra 224,2,40960
Ra 228,2,41984
Mvaa 192,204,140
s_waitcnt lgkmcnt(2)
Ra 232,2,43008
Ra 236,2,44032
Cvaa 196,208,128,32
s_add_u32 s3, s5, 27648
Ra 240,2,45056
Vc 68,8,9
Mvaa 196,212,132
buffer_load_dwordx4 v24, s[24:27], s3 offen offset:1024 lds
Mvaa 196,216,136
Ra 244,2,46080
Ra 248,2,47104
Mvaa 196,220,140
s_waitcnt lgkmcnt(3)
s_add_u32 s3, s5, 55296
Ra 252,2,48128
Ra 192,2,16384
Cvaa 200,224,128,32
buffer_load_dwordx4 v25, s[24:27], s3 offen offset:2048 lds
Mvaa 200,228,132
s_cmp_lt_u32 s37, s52
Ve 10,138
Mvaa 200,232,136
s_cbranch_scc1 L_nw_nl
s_waitcnt vmcnt(15)
L_nw_nl:
Ra 196,2,17408
Ra 200,2,18432
Mvaa 200,236,140
s_waitcnt lgkmcnt(3)
s_add_u32 s3, s5, 82944
Ra 204,2,19456
Ra 208,2,20480
Cvaa 204,240,128,32
buffer_load_dwordx4 v25, s[24:27], s3 offen offset:3072 lds
Mvaa 204,244,132
s_barrier
VE 11,139
Mvaa 204,248,136
s_waitcnt lgkmcnt(1)
Ra 212,2,21504
Vc 69,10,11
Ve 12,152
Ve 13,153
Ve 14,154
Ve 15,155
Ve 8,140
Ve 9,141
Ve 10,142
VE 11,143
Vc 76,12,13
Ve 12,156
Ve 13,157
Vc 77,14,15
Ve 14,158
Ve 15,159
Vc 70,8,9
Vc 71,10,11
Vc 78,12,13
Vc 79,14,15
v_or3_b32 v7, v7, v68, v69
v_or3_b32 v7, v7, v76, v77
v_or3_b32 v7, v7, v70, v71
v_or3_b32 v7, v7, v78, v79
v_and_b32 v1, 0x40004000, v7
v_cmp_ne_u32 vcc, 0, v1
Mvaa 204,252,140
s_cbranch_vccnz L_k2_fb_nl
L_k2_fbr_nl:
Ra 216,2,22528
Ra 220,2,23552
Maav 0,192,64
v_cmp_gt_i32 s[56:57], 0, v6
v_cmp_gt_i32 s[58:59], 1, v6
v_cmp_gt_i32 s[60:61], 2, v6
v_cmp_gt_i32 s[62:63], 3, v6
s_nop 3
s_nop 0
v_cndmask_b32 v192, v192, v20, s[56:57]
v_cndmask_b32 v193, v193, v20, s[58:59]
v_cndmask_b32 v194, v194, v20, s[60:61]
v_cndmask_b32 v195, v195, v20, s[62:63]
v_cmp_gt_i32 s[56:57], 16, v6
v_cmp_gt_i32 s[58:59], 17, v6
v_cmp_gt_i32 s[60:61], 18, v6
v_cmp_gt_i32 s[62:63], 19, v6
v_cndmask_b32 v196, v196, v20, s[56:57]
v_cndmask_b32 v197, v197, v20, s[58:59]
v_cndmask_b32 v198, v198, v20, s[60:61]
v_cndmask_b32 v199, v199, v20, s[62:63]
v_cmp_gt_i32 s[56:57], 32, v6
v_cmp_gt_i32 s[58:59], 33, v6
v_cmp_gt_i32 s[60:61], 34, v6
v_cmp_gt_i32 s[62:63], 35, v6
v_cndmask_b32 v200, v200, v20, s[56:57]
v_cndmask_b32 v201, v201, v20, s[58:59]
v_cndmask_b32 v202, v202, v20, s[60:61]
v_cndmask_b32 v203, v203, v20, s[62:63]
v_cmp_gt_i32 s[56:57], 48, v6
v_cmp_gt_i32 s[58:59], 49, v6
v_cmp_gt_i32 s[60:61], 50, v6
v_cmp_gt_i32 s[62:63], 51, v6
v_cndmask_b32 v204, v204, v20, s[56:57]
v_cndmask_b32 v205, v205, v20, s[58:59]
v_cndmask_b32 v206, v206, v20, s[60:61]
v_cndmask_b32 v207, v207, v20, s[62:63]
VE 8,192
Maav 0,196,68
s_add_u32 m0, s54, 16384
s_add_u32 s3, s5, 458752
VE 9,193
Maav 32,192,72
buffer_load_dwordx4 v24, s[24:27], s3 offen offset:0 lds
Maav 32,196,76
s_add_u32 s3, s5, 486400
Ra 224,2,24576
Vc 96,8,9
Maav 4,200,64
buffer_load_dwordx4 v24, s[24:27], s3 offen offset:1024 lds
Maav 4,204,68
s_mov_b32 s60, s8
s_and_b32 s61, s9, 0xffff
Ve 10,194
Maav 36,200,72
s_add_u32 s3, s5, 514048
VE 11,195
Maav 36,204,76
buffer_load_dwordx4 v25, s[24:27], s3 offen offset:2048 lds
Mvvv 48,16,64
s_mov_b32 s62, 7340032
Ra 228,2,25600
Vc 97,10,11
Mvvv 48,16,68
s_waitcnt lgkmcnt(2)
s_add_u32 s3, s5, 541696
Ra 232,2,26624
Ra 236,2,27648
Maav 8,208,64
buffer_load_dwordx4 v25, s[24:27], s3 offen offset:3072 lds
Maav 8,212,68
s_add_u32 m0, s54, 32768
s_add_u32 s3, s5, 0
Ra 240,2,28672
v_or_b32_e64 v7, v96, v97
Maav 40,208,72
buffer_load_dwordx4 v24, s[68:71], s3 offen offset:0 lds
Maav 40,212,76
s_mov_b32 s63, 0x20000
s_mov_b32 s56, s40
Ve 12,196
Maav 12,216,64
s_add_u32 s3, s5, 27648
VE 13,197
Maav 12,220,68
buffer_load_dwordx4 v24, s[68:71], s3 offen offset:1024 lds
Maav 44,216,72
s_and_b32 s57, s41, 0xffff
Ra 244,2,29696
Vc 98,12,13
Maav 44,220,76
s_add_u32 s3, s5, 55296
VE 14,198
Mvvv 52,16,72
buffer_load_dwordx4 v25, s[68:71], s3 offen offset:2048 lds
Mvvv 52,16,76
s_waitcnt lgkmcnt(2)
s_add_u32 s3, s5, 82944
Ra 248,2,30720
Ra 252,2,31744
Maav 16,224,64
buffer_load_dwordx4 v25, s[68:71], s3 offen offset:3072 lds
Maav 16,228,68
s_mov_b32 s58, 4194304
s_mov_b32 s59, 0x20000
Ve 15,199
Maav 48,224,72
s_add_u32 m0, s54, 49152
s_add_u32 s3, s5, 458752
Ra 192,2,49152
Vc 99,14,15
Maav 48,228,76
buffer_load_dwordx4 v24, s[68:71], s3 offen offset:0 lds
Maav 20,232,64
s_bfe_u32 s6, s2, 0x20001
Ra 196,2,50176
v_or3_b32 v7, v7, v98, v99
Maav 20,236,68
s_add_u32 s3, s5, 486400
Ra 200,2,51200
Ra 204,2,52224
Maav 52,232,72
buffer_load_dwordx4 v24, s[68:71], s3 offen offset:1024 lds
Maav 52,236,76
s_waitcnt lgkmcnt(4)
s_add_u32 s3, s5, 514048
Ve 8,200
Maav 24,240,64
buffer_load_dwordx4 v25, s[68:71], s3 offen offset:2048 lds
Maav 24,244,68
s_lshr_b32 s7, s34, 1
s_lshl_b32 s45, s7, 2
VE 9,201
Maav 56,240,72
s_add_u32 s3, s5, 541696
Ra 208,2,53248
Vc 100,8,9
Maav 56,244,76
buffer_load_dwordx4 v25, s[68:71], s3 offen offset:3072 lds
Maav 28,248,64
s_add_u32 s46, s45, s6
s_sub_u32 s46, 15, s46
VE 10,202
Maav 28,252,68
s_sub_u32 s45, 12, s45
Ra 212,2,54272
Ra 216,2,55296
Maav 60,248,72
s_waitcnt lgkmcnt(3)
Ra 220,2,56320
Ve 11,203
Ve 12,204
Ve 13,205
Ve 14,206
VE 15,207
Vc 101,10,11
Vc 102,12,13
Vc 103,14,15
v_or3_b32 v7, v7, v100, v101
v_or3_b32 v7, v7, v102, v103
Maav 60,252,76
s_add_u32 s45, s45, s6
v_and_b32 v1, 0x40004000, v7
v_cmp_ne_u32 vcc, 0, v1
s_cbranch_vccnz L_k2_fb_fi
L_k2_fbr_fi:
Maav 0,192,96
Ra 224,2,57344
Ra 228,2,58368
Maav 0,196,100
Ra 232,2,59392
Ra 236,2,60416
Maav 4,200,96
Ra 240,2,61440
Ra 244,2,62464
Maav 4,204,100
Ra 248,2,63488
Ra 252,2,64512
Mvvv 48,16,96
s_cmp_lt_u32 s7, 2
s_cselect_b32 s45, s46, s45
Mvvv 48,16,100
s_waitcnt lgkmcnt(8)
Maav 8,208,96
s_and_b32 s46, s2, 1
s_bfe_u32 s6, s2, 0x30003
s_lshl_b32 s6, s6, 1
Maav 8,212,100
s_add_u32 s46, s46, s6
s_mov_b32 s48, 0
s_mov_b32 s49, 15360
Maav 12,216,96
s_mov_b32 s50, 30720
s_mov_b32 s51, 46080
s_lshl_b32 s35, s32, 13
Maav 12,220,100
s_waitcnt lgkmcnt(4)
Maav 16,224,96
s_add_u32 s35, s35, 131072
s_and_b32 s52, s46, 1
s_lshl_b32 s37, s45, 20
Maav 16,228,100
s_lshl_b32 s7, s52, 19
s_add_u32 s37, s37, s7
s_add_u32 s37, s37, 46137344
Maav 20,232,96
s_lshr_b32 s7, s46, 1
s_lshl_b32 s7, s7, 8
s_lshl_b32 s6, s52, 22
Maav 20,236,100
s_waitcnt lgkmcnt(0)
Maav 24,240,96
s_add_u32 s6, s6, s7
s_add_u32 s12, s94, s6
s_addc_u32 s13, s95, 0
s_and_b32 s13, s13, 0xffff
Maav 24,244,100
s_mov_b32 s14, 0
s_mov_b32 s15, 0x20000
s_sub_u32 s14, 4194304, s7
Maav 28,248,96
s_mov_b32 s28, s94
s_and_b32 s29, s95, 0xffff
s_mov_b32 s30, 8388608
Maav 28,252,100
s_mov_b32 s31, 0x20000
s_lshl_b32 s7, s46, 7
s_lshl_b32 s36, s45, 18
s_nop 7
s_lshl_b32 s3, s55, 20
s_lshl_b32 s47, s33, 15
s_add_u32 s3, s3, s47
s_lshl_b32 s47, s32, 10
v_lshlrev_b32 v248, 4, v0
v_add_u32 v249, s47, v248
s_sub_u32 s47, 7168, s47
v_add_u32 v248, s47, v248
v_rcp_f32 v250, v48
v_rcp_f32 v252, v52
v_mov_b32 v251, v250
v_mov_b32_e64 v253, v252
Ar 240,32
Ar 241,33
Ar 242,34
Ar 243,35
Ar 244,36
Ar 245,37
Ar 246,38
Ar 247,39
v_pk_mul_f32 v[240:241], v[240:241], v[252:253]
v_pk_mul_f32 v[242:243], v[242:243], v[252:253]
v_pk_mul_f32 v[244:245], v[244:245], v[252:253]
v_pk_mul_f32 v[246:247], v[246:247], v[252:253]
Vc 28,240,241
Vc 29,242,243
Vc 30,244,245
Vc 31,246,247
buffer_store_dwordx4 v[28:31], v249, s[16:19], s3 offen sc1
Ar 240,0
Ar 241,1
Ar 242,2
Ar 243,3
Ar 244,4
Ar 245,5
Ar 246,6
Ar 247,7
v_pk_mul_f32 v[240:241], v[240:241], v[250:251]
v_pk_mul_f32 v[242:243], v[242:243], v[250:251]
v_pk_mul_f32 v[244:245], v[244:245], v[250:251]
v_pk_mul_f32 v[246:247], v[246:247], v[250:251]
Vc 24,240,241
Vc 25,242,243
Vc 26,244,245
Vc 27,246,247
buffer_store_dwordx4 v[24:27], v248, s[16:19], s3 offen sc1
s_add_u32 s3, s3, 8192
Ar 240,40
Ar 241,41
Ar 242,42
Ar 243,43
Ar 244,44
Ar 245,45
Ar 246,46
Ar 247,47
v_pk_mul_f32 v[240:241], v[240:241], v[252:253]
v_pk_mul_f32 v[242:243], v[242:243], v[252:253]
v_pk_mul_f32 v[244:245], v[244:245], v[252:253]
v_pk_mul_f32 v[246:247], v[246:247], v[252:253]
Vc 28,240,241
Vc 29,242,243
Vc 30,244,245
Vc 31,246,247
buffer_store_dwordx4 v[28:31], v249, s[16:19], s3 offen sc1
Ar 240,8
Ar 241,9
Ar 242,10
Ar 243,11
Ar 244,12
Ar 245,13
Ar 246,14
Ar 247,15
v_pk_mul_f32 v[240:241], v[240:241], v[250:251]
v_pk_mul_f32 v[242:243], v[242:243], v[250:251]
v_pk_mul_f32 v[244:245], v[244:245], v[250:251]
v_pk_mul_f32 v[246:247], v[246:247], v[250:251]
Vc 24,240,241
Vc 25,242,243
Vc 26,244,245
Vc 27,246,247
buffer_store_dwordx4 v[24:27], v248, s[16:19], s3 offen sc1
s_add_u32 s3, s3, 8192
Ar 240,48
Ar 241,49
Ar 242,50
Ar 243,51
Ar 244,52
Ar 245,53
Ar 246,54
Ar 247,55
v_pk_mul_f32 v[240:241], v[240:241], v[252:253]
v_pk_mul_f32 v[242:243], v[242:243], v[252:253]
v_pk_mul_f32 v[244:245], v[244:245], v[252:253]
v_pk_mul_f32 v[246:247], v[246:247], v[252:253]
Vc 28,240,241
Vc 29,242,243
Vc 30,244,245
Vc 31,246,247
buffer_store_dwordx4 v[28:31], v249, s[16:19], s3 offen sc1
Ar 240,16
Ar 241,17
Ar 242,18
Ar 243,19
Ar 244,20
Ar 245,21
Ar 246,22
Ar 247,23
v_pk_mul_f32 v[240:241], v[240:241], v[250:251]
v_pk_mul_f32 v[242:243], v[242:243], v[250:251]
v_pk_mul_f32 v[244:245], v[244:245], v[250:251]
v_pk_mul_f32 v[246:247], v[246:247], v[250:251]
Vc 24,240,241
Vc 25,242,243
Vc 26,244,245
Vc 27,246,247
buffer_store_dwordx4 v[24:27], v248, s[16:19], s3 offen sc1
s_add_u32 s3, s3, 8192
Ar 240,56
Ar 241,57
Ar 242,58
Ar 243,59
Ar 244,60
Ar 245,61
Ar 246,62
Ar 247,63
v_pk_mul_f32 v[240:241], v[240:241], v[252:253]
v_pk_mul_f32 v[242:243], v[242:243], v[252:253]
v_pk_mul_f32 v[244:245], v[244:245], v[252:253]
v_pk_mul_f32 v[246:247], v[246:247], v[252:253]
Vc 28,240,241
Vc 29,242,243
Vc 30,244,245
Vc 31,246,247
buffer_store_dwordx4 v[28:31], v249, s[16:19], s3 offen sc1
Ar 240,24
Ar 241,25
Ar 242,26
Ar 243,27
Ar 244,28
Ar 245,29
Ar 246,30
Ar 247,31
v_pk_mul_f32 v[240:241], v[240:241], v[250:251]
v_pk_mul_f32 v[242:243], v[242:243], v[250:251]
v_pk_mul_f32 v[244:245], v[244:245], v[250:251]
v_pk_mul_f32 v[246:247], v[246:247], v[250:251]
Vc 24,240,241
Vc 25,242,243
Vc 26,244,245
Vc 27,246,247
buffer_store_dwordx4 v[24:27], v248, s[16:19], s3 offen sc1
s_cmp_ge_u32 s93, 224
s_cbranch_scc1 L_noffn
v_lshrrev_b32 v24, 4, v0
v_bfe_u32 v25, v0, 2, 2
v_lshl_add_u32 v26, v24, 3, v25
v_lshlrev_b32 v26, 8, v26
v_and_b32 v27, 3, v0
v_lshl_add_u32 v26, v27, 3, v26
v_and_b32_e64 v27, 1, v24
v_lshl_add_u32 v25, v27, 2, v25
s_lshl_b32 s3, s32, 1
v_xor_b32 v25, s3, v25
v_lshl_add_u32 v26, v25, 5, v26
s_sub_u32 s3, s54, s44
v_add_u32 v26, s3, v26
v_xor_b32 v27, 32, v26
s_waitcnt vmcnt(8) lgkmcnt(0)
s_barrier
s_nop 0
ds_read_b64_tr_b16 v[128:129], v26 offset:0
ds_read_b64_tr_b16 v[130:131], v26 offset:1024
ds_read_b64_tr_b16 v[132:133], v27 offset:0
ds_read_b64_tr_b16 v[134:135], v27 offset:1024
ds_read_b64_tr_b16 v[136:137], v26 offset:8192
ds_read_b64_tr_b16 v[138:139], v26 offset:9216
ds_read_b64_tr_b16 v[140:141], v27 offset:8192
ds_read_b64_tr_b16 v[142:143], v27 offset:9216
ds_read_b64_tr_b16 v[144:145], v26 offset:16384
ds_read_b64_tr_b16 v[146:147], v26 offset:17408
ds_read_b64_tr_b16 v[148:149], v27 offset:16384
ds_read_b64_tr_b16 v[150:151], v27 offset:17408
ds_read_b64_tr_b16 v[152:153], v26 offset:24576
ds_read_b64_tr_b16 v[154:155], v26 offset:25600
ds_read_b64_tr_b16 v[156:157], v27 offset:24576
s_waitcnt lgkmcnt(9)
s_nop 0
ds_read_b64_tr_b16 v[158:159], v27 offset:25600
ds_read_b64_tr_b16 v[160:161], v26 offset:32768
ds_read_b64_tr_b16 v[162:163], v26 offset:33792
ds_read_b64_tr_b16 v[164:165], v27 offset:32768
ds_read_b64_tr_b16 v[166:167], v27 offset:33792
ds_read_b64_tr_b16 v[168:169], v26 offset:40960
s_waitcnt lgkmcnt(9)
s_nop 0
ds_read_b64_tr_b16 v[170:171], v26 offset:41984
ds_read_b64_tr_b16 v[172:173], v27 offset:40960
ds_read_b64_tr_b16 v[174:175], v27 offset:41984
ds_read_b64_tr_b16 v[176:177], v26 offset:49152
ds_read_b64_tr_b16 v[178:179], v26 offset:50176
ds_read_b64_tr_b16 v[180:181], v27 offset:49152
s_waitcnt lgkmcnt(9)
ds_read_b64_tr_b16 v[182:183], v27 offset:50176
ds_read_b64_tr_b16 v[184:185], v26 offset:57344
ds_read_b64_tr_b16 v[186:187], v26 offset:58368
ds_read_b64_tr_b16 v[188:189], v27 offset:57344
ds_read_b64_tr_b16 v[190:191], v27 offset:58368
v_and_b32 v25, 15, v0
v_mul_u32_u24 v28, 14336, v25
v_lshl_add_u32 v28, v24, 4, v28
v_mov_b32 v29, 2146435072
v_cmp_gt_u32 vcc, 2, v25
s_mul_i32 s3, s92, 57344
s_lshl_b32 s47, s4, 9
s_add_u32 s3, s3, s47
v_cndmask_b32 v28, v29, v28, vcc
s_lshl_b32 s47, s32, 7
s_add_u32 s3, s3, s47
s_add_u32 s3, s3, 6291456
Zvva 224,128,160
Zvva 228,132,160
Mvva 224,136,164
Mvva 228,140,164
Mvva 224,144,168
Mvva 228,148,168
Mvva 224,152,172
Mvva 228,156,172
s_waitcnt lgkmcnt(0)
Zvva 232,160,160
Zvva 236,164,160
Mvva 232,168,164
Mvva 236,172,164
Mvva 232,176,168
Mvva 236,180,168
Mvva 232,184,172
Mvva 236,188,172
L_noffn:
s_add_u32 s36, s36, s7
s_and_b32 s94, s7, 128
s_lshl_b32 s38, s45, 7
s_lshl_b32 s6, s52, 6
s_add_u32 s38, s38, s6
s_add_u32 s38, s38, 5300224
s_lshl_b32 s52, s32, 11
s_and_b32 s6, s32, 1
s_lshl_b32 s6, s6, 16
s_lshr_b32 s7, s32, 1
s_lshl_b32 s7, s7, 7
s_xor_b32 s7, s7, s94
s_xor_b32 s7, s7, 128
s_add_u32 s6, s6, s7
s_lshl_b32 s7, s32, 5
s_mov_b32 s68, s10
s_and_b32 s69, s11, 0xffff
s_mov_b32 s70, 4194304
s_mov_b32 s71, 0x20000
s_add_u32 s8, s66, s37
s_addc_u32 s9, s67, 0
s_and_b32 s9, s9, 0xffff
s_mov_b32 s10, 524288
s_mov_b32 s11, 0x20000
v_lshlrev_b32 v112, 4, v0
v_lshrrev_b32 v121, 4, v0
v_and_b32 v122, 7, v0
v_lshrrev_b32 v123, 3, v0
v_lshlrev_b32 v124, 1, v121
v_xor_b32 v124, v124, v122
v_lshlrev_b32_e64 v124, 4, v124
v_lshl_add_u32 v113, v123, 11, v124
v_add_u32 v114, s6, v113
v_lshrrev_b32 v124, 2, v0
v_bfe_u32 v126, v0, 3, 2
v_lshlrev_b32 v124, 7, v124
v_and_b32 v125, 3, v0
v_lshl_add_u32 v124, v125, 3, v124
v_lshl_add_u32 v115, v126, 5, v124
v_xor_b32 v116, 32, v115
v_xor_b32 v117, 64, v115
v_xor_b32 v118, 96, v115
v_add_u32 v120, s7, v123
v_lshlrev_b32 v119, 11, v120
v_lshl_add_u32 v119, v122, 4, v119
v_mov_b32 v126, 0
v_lshlrev_b32 v127, 2, v122
v_mov_b32 v24, 1
v_mul_u32_u24 v25, s65, v0
s_waitcnt vmcnt(0)
s_barrier
s_mov_b64 exec, 3
buffer_store_dword v24, v25, s[20:23], s64 offen sc1
s_mov_b64 exec, -1
s_cmp_lt_u32 s93, 224
s_cselect_b32 s3, s3, 8388608
s_add_u32 s7, s3, 28672
buffer_store_dwordx4 v[224:227], v28, s[20:23], s3 offen offset:0 sc1
buffer_store_dwordx4 v[228:231], v28, s[20:23], s3 offen offset:64 sc1
buffer_store_dwordx4 v[232:235], v28, s[20:23], s7 offen offset:0 sc1
buffer_store_dwordx4 v[236:239], v28, s[20:23], s7 offen offset:64 sc1
s_mov_b32 s3, s36
s_nop 0
buffer_load_dwordx4 v[18:21], v119, s[56:59], s3 offen
s_add_u32 s3, s3, 16384
buffer_load_dwordx4 v[22:25], v119, s[56:59], s3 offen
s_add_u32 s3, s3, 16384
buffer_load_dwordx4 v[26:29], v119, s[56:59], s3 offen
s_add_u32 s3, s3, 16384
buffer_load_dwordx4 v[30:33], v119, s[56:59], s3 offen
s_lshl_b32 s3, s45, 10
s_add_u32 s3, s3, 5259264
v_lshlrev_b32 v124, 3, v120
buffer_load_dwordx2 v[34:35], v124, s[20:23], s3 offen offset:0 sc1
buffer_load_dwordx2 v[36:37], v124, s[20:23], s3 offen offset:64 sc1
buffer_load_dwordx2 v[38:39], v124, s[20:23], s3 offen offset:128 sc1
buffer_load_dwordx2 v[40:41], v124, s[20:23], s3 offen offset:192 sc1
v_and_b32 v10, 15, v0
v_lshlrev_b32 v10, 2, v10
s_add_u32 s95, s32, 32
s_lshl_b32 s95, s95, 16
s_add_u32 s95, s95, s94
s_xor_b32 s95, s95, 128
s_add_u32 m0, s44, 0
s_nop 0
s_nop 0
buffer_load_dwordx4 v114, s[12:15], s48 offen offset:0 lds
buffer_load_dwordx4 v114, s[12:15], s49 offen offset:1024 lds
buffer_load_dwordx4 v114, s[12:15], s50 offen offset:2048 lds
buffer_load_dwordx4 v114, s[12:15], s51 offen offset:3072 lds
v_add_u32 v114, 131072, v114
s_add_u32 m0, s44, 16384
s_nop 0
s_nop 0
buffer_load_dwordx4 v114, s[12:15], s48 offen offset:0 lds
buffer_load_dwordx4 v114, s[12:15], s49 offen offset:1024 lds
buffer_load_dwordx4 v114, s[12:15], s50 offen offset:2048 lds
buffer_load_dwordx4 v114, s[12:15], s51 offen offset:3072 lds
v_add_u32 v114, 131072, v114
buffer_load_dword v124, v10, s[20:23], s38 offen sc1
v_add_u32 v12, 65536, v115
v_add_u32 v13, 65536, v116
v_add_u32 v14, 65536, v117
v_add_u32 v15, 65536, v118
s_and_b32 s39, s93, 15
s_lshr_b32 s37, s93, 4
s_lshl_b32 s54, s37, 2
s_add_u32 s54, s54, s32
s_lshl_b32 s3, s54, 17
s_lshl_b32 s7, s39, 7
s_add_u32 s3, s3, s7
s_cmp_lt_u32 s93, 224
s_cselect_b32 s3, s3, 2146435072
v_add_u32 v125, s3, v113
s_mov_b32 s40, 0
s_waitcnt vmcnt(9)
v_lshlrev_b32_e64 v42, 16, v18
v_and_b32 v43, 0xffff0000, v18
v_lshlrev_b32_e64 v44, 16, v19
v_and_b32 v45, 0xffff0000, v19
v_lshlrev_b32_e64 v46, 16, v20
v_and_b32 v47, 0xffff0000, v20
v_lshlrev_b32_e64 v48, 16, v21
v_and_b32 v49, 0xffff0000, v21
v_pk_add_f32 v[42:43], v[42:43], v[34:35] op_sel_hi:[1,0] neg_lo:[0,1] neg_hi:[0,1]
v_pk_add_f32 v[44:45], v[44:45], v[34:35] op_sel_hi:[1,0] neg_lo:[0,1] neg_hi:[0,1]
v_pk_add_f32 v[46:47], v[46:47], v[34:35] op_sel_hi:[1,0] neg_lo:[0,1] neg_hi:[0,1]
v_pk_add_f32 v[48:49], v[48:49], v[34:35] op_sel_hi:[1,0] neg_lo:[0,1] neg_hi:[0,1]
Vc 2,42,43
v_lshlrev_b32_e64 v42, 16, v2
v_and_b32 v43, 0xffff0000, v2
Vc 3,44,45
v_lshlrev_b32_e64 v44, 16, v3
v_and_b32 v45, 0xffff0000, v3
Vc 4,46,47
v_lshlrev_b32_e64 v46, 16, v4
v_and_b32 v47, 0xffff0000, v4
Vc 5,48,49
v_lshlrev_b32_e64 v48, 16, v5
v_and_b32 v49, 0xffff0000, v5
v_pk_mul_f32 v[42:43], v[42:43], v[34:35] op_sel:[0,1] op_sel_hi:[1,1]
v_pk_mul_f32 v[44:45], v[44:45], v[34:35] op_sel:[0,1] op_sel_hi:[1,1]
v_pk_mul_f32 v[46:47], v[46:47], v[34:35] op_sel:[0,1] op_sel_hi:[1,1]
v_pk_mul_f32 v[48:49], v[48:49], v[34:35] op_sel:[0,1] op_sel_hi:[1,1]
Vc 2,42,43
v_lshlrev_b32_e64 v42, 16, v2
v_and_b32 v43, 0xffff0000, v2
Vc 3,44,45
v_lshlrev_b32_e64 v44, 16, v3
v_and_b32 v45, 0xffff0000, v3
Vc 4,46,47
v_lshlrev_b32_e64 v46, 16, v4
v_and_b32 v47, 0xffff0000, v4
Vc 5,48,49
v_lshlrev_b32_e64 v48, 16, v5
v_and_b32 v49, 0xffff0000, v5
v_mul_f32 v2, 0xbfb8aa3b, v42
v_mul_f32 v3, 0xbfb8aa3b, v43
v_mul_f32 v4, 0xbfb8aa3b, v44
v_mul_f32 v5, 0xbfb8aa3b, v45
v_mul_f32 v6, 0xbfb8aa3b, v46
v_mul_f32 v7, 0xbfb8aa3b, v47
v_mul_f32 v8, 0xbfb8aa3b, v48
v_mul_f32 v9, 0xbfb8aa3b, v49
Ve 2,2
Ve 3,3
Ve 4,4
Ve 5,5
Ve 6,6
Ve 7,7
Ve 8,8
Ve 9,9
v_add_f32 v2, 1.0, v2
v_add_f32 v3, 1.0, v3
v_add_f32 v4, 1.0, v4
v_add_f32 v5, 1.0, v5
v_add_f32 v6, 1.0, v6
v_add_f32 v7, 1.0, v7
v_add_f32 v8, 1.0, v8
v_add_f32 v9, 1.0, v9
v_rcp_f32 v2, v2
v_rcp_f32 v3, v3
v_rcp_f32 v4, v4
v_rcp_f32 v5, v5
v_rcp_f32 v6, v6
v_rcp_f32 v7, v7
v_rcp_f32 v8, v8
v_rcp_f32 v9, v9
v_pk_mul_f32 v[42:43], v[42:43], v[2:3]
v_pk_mul_f32 v[44:45], v[44:45], v[4:5]
v_pk_mul_f32 v[46:47], v[46:47], v[6:7]
v_pk_mul_f32 v[48:49], v[48:49], v[8:9]
Vc 2,42,43
v_lshlrev_b32_e64 v42, 16, v2
v_and_b32 v43, 0xffff0000, v2
Vc 3,44,45
v_lshlrev_b32_e64 v44, 16, v3
v_and_b32 v45, 0xffff0000, v3
Vc 4,46,47
v_lshlrev_b32_e64 v46, 16, v4
v_and_b32 v47, 0xffff0000, v4
Vc 5,48,49
v_lshlrev_b32_e64 v48, 16, v5
v_and_b32 v49, 0xffff0000, v5
s_waitcnt vmcnt(0)
v_cmp_ne_u32 vcc, 1, v124
s_cbranch_vccnz L_spinC
s_nop 0
L_spinCr:
buffer_load_dwordx4 a[0:3], v112, s[8:11], s52 offen offset:0 sc1
buffer_load_dwordx4 a[4:7], v112, s[8:11], s52 offen offset:1024 sc1
s_add_u32 s52, s52, 8192
buffer_load_dwordx4 a[8:11], v112, s[8:11], s52 offen offset:0 sc1
buffer_load_dwordx4 a[12:15], v112, s[8:11], s52 offen offset:1024 sc1
s_add_u32 s52, s52, 8192
buffer_load_dwordx4 a[16:19], v112, s[8:11], s52 offen offset:0 sc1
buffer_load_dwordx4 a[20:23], v112, s[8:11], s52 offen offset:1024 sc1
s_add_u32 s52, s52, 8192
buffer_load_dwordx4 a[24:27], v112, s[8:11], s52 offen offset:0 sc1
buffer_load_dwordx4 a[28:31], v112, s[8:11], s52 offen offset:1024 sc1
s_add_u32 s52, s52, 8192
v_lshlrev_b32_e64 v50, 16, v22
v_and_b32 v51, 0xffff0000, v22
v_lshlrev_b32_e64 v52, 16, v23
v_and_b32 v53, 0xffff0000, v23
v_lshlrev_b32_e64 v54, 16, v24
v_and_b32 v55, 0xffff0000, v24
v_lshlrev_b32_e64 v56, 16, v25
v_and_b32 v57, 0xffff0000, v25
v_pk_add_f32 v[50:51], v[50:51], v[36:37] op_sel_hi:[1,0] neg_lo:[0,1] neg_hi:[0,1]
v_pk_add_f32 v[52:53], v[52:53], v[36:37] op_sel_hi:[1,0] neg_lo:[0,1] neg_hi:[0,1]
v_pk_add_f32 v[54:55], v[54:55], v[36:37] op_sel_hi:[1,0] neg_lo:[0,1] neg_hi:[0,1]
v_pk_add_f32 v[56:57], v[56:57], v[36:37] op_sel_hi:[1,0] neg_lo:[0,1] neg_hi:[0,1]
Vc 2,50,51
v_lshlrev_b32_e64 v50, 16, v2
v_and_b32 v51, 0xffff0000, v2
Vc 3,52,53
v_lshlrev_b32_e64 v52, 16, v3
v_and_b32 v53, 0xffff0000, v3
Vc 4,54,55
v_lshlrev_b32_e64 v54, 16, v4
v_and_b32 v55, 0xffff0000, v4
Vc 5,56,57
v_lshlrev_b32_e64 v56, 16, v5
v_and_b32 v57, 0xffff0000, v5
v_pk_mul_f32 v[50:51], v[50:51], v[36:37] op_sel:[0,1] op_sel_hi:[1,1]
v_pk_mul_f32 v[52:53], v[52:53], v[36:37] op_sel:[0,1] op_sel_hi:[1,1]
v_pk_mul_f32 v[54:55], v[54:55], v[36:37] op_sel:[0,1] op_sel_hi:[1,1]
v_pk_mul_f32 v[56:57], v[56:57], v[36:37] op_sel:[0,1] op_sel_hi:[1,1]
Vc 2,50,51
v_lshlrev_b32_e64 v50, 16, v2
v_and_b32 v51, 0xffff0000, v2
Vc 3,52,53
v_lshlrev_b32_e64 v52, 16, v3
v_and_b32 v53, 0xffff0000, v3
Vc 4,54,55
v_lshlrev_b32_e64 v54, 16, v4
v_and_b32 v55, 0xffff0000, v4
Vc 5,56,57
v_lshlrev_b32_e64 v56, 16, v5
v_and_b32 v57, 0xffff0000, v5
v_mul_f32 v2, 0xbfb8aa3b, v50
v_mul_f32 v3, 0xbfb8aa3b, v51
v_mul_f32 v4, 0xbfb8aa3b, v52
v_mul_f32 v5, 0xbfb8aa3b, v53
v_mul_f32 v6, 0xbfb8aa3b, v54
v_mul_f32 v7, 0xbfb8aa3b, v55
v_mul_f32 v8, 0xbfb8aa3b, v56
v_mul_f32 v9, 0xbfb8aa3b, v57
Ve 2,2
Ve 3,3
Ve 4,4
Ve 5,5
Ve 6,6
Ve 7,7
Ve 8,8
Ve 9,9
v_add_f32 v2, 1.0, v2
v_add_f32 v3, 1.0, v3
v_add_f32 v4, 1.0, v4
v_add_f32 v5, 1.0, v5
v_add_f32 v6, 1.0, v6
v_add_f32 v7, 1.0, v7
v_add_f32 v8, 1.0, v8
v_add_f32 v9, 1.0, v9
v_rcp_f32 v2, v2
v_rcp_f32 v3, v3
v_rcp_f32 v4, v4
v_rcp_f32 v5, v5
v_rcp_f32 v6, v6
v_rcp_f32 v7, v7
v_rcp_f32 v8, v8
v_rcp_f32 v9, v9
v_pk_mul_f32 v[50:51], v[50:51], v[2:3]
v_pk_mul_f32 v[52:53], v[52:53], v[4:5]
v_pk_mul_f32 v[54:55], v[54:55], v[6:7]
v_pk_mul_f32 v[56:57], v[56:57], v[8:9]
Vc 2,50,51
v_lshlrev_b32_e64 v50, 16, v2
v_and_b32 v51, 0xffff0000, v2
Vc 3,52,53
v_lshlrev_b32_e64 v52, 16, v3
v_and_b32 v53, 0xffff0000, v3
Vc 4,54,55
v_lshlrev_b32_e64 v54, 16, v4
v_and_b32 v55, 0xffff0000, v4
Vc 5,56,57
v_lshlrev_b32_e64 v56, 16, v5
v_and_b32 v57, 0xffff0000, v5
buffer_load_dwordx4 a[32:35], v112, s[8:11], s52 offen offset:0 sc1
buffer_load_dwordx4 a[36:39], v112, s[8:11], s52 offen offset:1024 sc1
s_add_u32 s52, s52, 8192
buffer_load_dwordx4 a[40:43], v112, s[8:11], s52 offen offset:0 sc1
buffer_load_dwordx4 a[44:47], v112, s[8:11], s52 offen offset:1024 sc1
s_add_u32 s52, s52, 8192
s_add_u32 m0, s44, 32768
s_nop 0
buffer_load_dwordx4 v114, s[12:15], s48 offen offset:0 lds
buffer_load_dwordx4 v114, s[12:15], s49 offen offset:1024 lds
buffer_load_dwordx4 v114, s[12:15], s50 offen offset:2048 lds
buffer_load_dwordx4 v114, s[12:15], s51 offen offset:3072 lds
v_add_u32 v114, 131072, v114
s_cmp_lg_u32 s40, 0
s_cbranch_scc1 L_nowd
s_add_u32 m0, s35, 0
s_nop 0
s_nop 0
buffer_load_dwordx4 v125, s[60:63], s48 offen offset:0 lds
buffer_load_dwordx4 v125, s[60:63], s49 offen offset:1024 lds
buffer_load_dwordx4 v125, s[60:63], s50 offen offset:2048 lds
buffer_load_dwordx4 v125, s[60:63], s51 offen offset:3072 lds
v_add_u32 v125, 65536, v125
s_add_u32 m0, s35, 4096
s_nop 0
buffer_load_dwordx4 v125, s[60:63], s48 offen offset:0 lds
buffer_load_dwordx4 v125, s[60:63], s49 offen offset:1024 lds
buffer_load_dwordx4 v125, s[60:63], s50 offen offset:2048 lds
buffer_load_dwordx4 v125, s[60:63], s51 offen offset:3072 lds
L_nowd:
s_cmp_lt_u32 s2, 128
s_cbranch_scc1 L_noc3
s_bfe_u32 s3, s2, 0x40003
s_lshl_b32 s3, s3, 2
s_add_u32 s3, s3, s32
s_lshl_b32 s3, s3, 15
s_and_b32 s7, s2, 1
s_lshl_b32 s7, s7, 22
s_add_u32 s3, s3, s7
s_add_u32 s3, s3, 384
v_and_b32 v1, 15, v0
v_lshlrev_b32 v1, 11, v1
v_lshrrev_b32_e64 v11, 5, v0
v_lshl_add_u32 v1, v11, 10, v1
buffer_load_dword v11, v1, s[28:31], s3 offen
L_noc3:
s_barrier
s_nop 0
ds_read_b64_tr_b16 v[192:193], v115 offset:0
ds_read_b64_tr_b16 v[194:195], v115 offset:2048
ds_read_b64_tr_b16 v[196:197], v116 offset:0
ds_read_b64_tr_b16 v[198:199], v116 offset:2048
ds_read_b64_tr_b16 v[200:201], v117 offset:0
ds_read_b64_tr_b16 v[202:203], v117 offset:2048
ds_read_b64_tr_b16 v[204:205], v118 offset:0
ds_read_b64_tr_b16 v[206:207], v118 offset:2048
ds_read_b64_tr_b16 v[208:209], v115 offset:4096
ds_read_b64_tr_b16 v[210:211], v115 offset:6144
ds_read_b64_tr_b16 v[212:213], v116 offset:4096
ds_read_b64_tr_b16 v[214:215], v116 offset:6144
ds_read_b64_tr_b16 v[216:217], v117 offset:4096
ds_read_b64_tr_b16 v[218:219], v117 offset:6144
ds_read_b64_tr_b16 v[220:221], v118 offset:4096
s_waitcnt lgkmcnt(9)
ds_read_b64_tr_b16 v[222:223], v118 offset:6144
s_waitcnt vmcnt(12)
Zvva 160,192,0
ds_read_b64_tr_b16 v[224:225], v115 offset:8192
ds_read_b64_tr_b16 v[226:227], v115 offset:10240
v_mov_b32 v125, 1
s_waitcnt lgkmcnt(8)
Mvva 160,208,8
s_lshl_b32 s6, s4, 3
s_add_u32 s6, s6, s92
s_lshl_b32 s6, s6, 2
Zvva 176,192,4
s_waitcnt lgkmcnt(6)
s_add_u32 m0, s44, 49152
ds_read_b64_tr_b16 v[240:241], v115 offset:12288
ds_read_b64_tr_b16 v[242:243], v115 offset:14336
Mvva 176,208,12
buffer_load_dwordx4 v114, s[12:15], s48 offen offset:0 lds
Zvva 164,196,0
ds_read_b64_tr_b16 v[228:229], v116 offset:8192
ds_read_b64_tr_b16 v[230:231], v116 offset:10240
Mvva 164,212,8
s_add_u32 s6, s6, 5447680
s_cmp_eq_u32 s32, 0
s_cselect_b32 s6, s6, s64
s_cmp_lt_u32 s93, 224
s_cselect_b32 s6, s6, 2146435072
Zvva 180,196,4
s_waitcnt lgkmcnt(8)
ds_read_b64_tr_b16 v[244:245], v116 offset:12288
ds_read_b64_tr_b16 v[246:247], v116 offset:14336
Mvva 180,212,12
buffer_load_dwordx4 v114, s[12:15], s49 offen offset:1024 lds
Zvva 168,200,0
ds_read_b64_tr_b16 v[232:233], v117 offset:8192
ds_read_b64_tr_b16 v[234:235], v117 offset:10240
Mvva 168,216,8
s_mov_b64 exec, 1
buffer_store_dword v125, v126, s[20:23], s6 offen sc1
s_mov_b64 exec, -1
Zvva 184,200,4
s_waitcnt lgkmcnt(10)
ds_read_b64_tr_b16 v[248:249], v117 offset:12288
ds_read_b64_tr_b16 v[250:251], v117 offset:14336
Mvva 184,216,12
buffer_load_dwordx4 v114, s[12:15], s50 offen offset:2048 lds
Zvva 172,204,0
ds_read_b64_tr_b16 v[236:237], v118 offset:8192
ds_read_b64_tr_b16 v[238:239], v118 offset:10240
Mvva 172,220,8
s_waitcnt lgkmcnt(10)
s_lshl_b32 s40, s45, 2
s_add_u32 s40, s40, s32
s_lshr_b32 s3, s42, 5
s_lshr_b32 s47, s43, 5
s_cmp_eq_u32 s3, s40
s_cselect_b32 s53, 1, 0
s_cmp_eq_u32 s47, s40
s_cselect_b32 s53, 1, s53
s_mov_b32 s40, 0
Zvva 188,204,4
s_barrier
ds_read_b64_tr_b16 v[252:253], v118 offset:12288
ds_read_b64_tr_b16 v[254:255], v118 offset:14336
Mvva 188,220,12
buffer_load_dwordx4 v114, s[12:15], s51 offen offset:3072 lds
v_add_u32 v114, 131072, v114
Zvva 128,224,0
ds_read_b64_tr_b16 v[192:193], v115 offset:16384
ds_read_b64_tr_b16 v[194:195], v115 offset:18432
Mvva 128,240,8
s_lshl_b32 s41, s46, 7
s_add_u32 s41, s41, 5449728
s_lshl_b32 s55, s46, 13
Zvva 144,224,4
s_waitcnt lgkmcnt(10)
ds_read_b64_tr_b16 v[208:209], v115 offset:20480
ds_read_b64_tr_b16 v[210:211], v115 offset:22528
Mvva 144,240,12
buffer_load_dwordx4 a[48:51], v112, s[8:11], s52 offen offset:0 sc1
Zvva 132,228,0
ds_read_b64_tr_b16 v[196:197], v116 offset:16384
ds_read_b64_tr_b16 v[198:199], v116 offset:18432
Mvva 132,244,8
s_add_u32 s55, s55, 5308416
s_add_u32 s16, s66, 88080384
s_addc_u32 s17, s67, 0
s_and_b32 s17, s17, 0xffff
Zvva 148,228,4
s_waitcnt lgkmcnt(10)
ds_read_b64_tr_b16 v[212:213], v116 offset:20480
ds_read_b64_tr_b16 v[214:215], v116 offset:22528
Mvva 148,244,12
buffer_load_dwordx4 a[52:55], v112, s[8:11], s52 offen offset:1024 sc1
s_add_u32 s52, s52, 8192
Zvva 136,232,0
ds_read_b64_tr_b16 v[200:201], v117 offset:16384
ds_read_b64_tr_b16 v[202:203], v117 offset:18432
Mvva 136,248,8
s_mov_b32 s18, 8388608
s_mov_b32 s19, 0x20000
s_lshl_b32 s24, s2, 2
Zvva 152,232,4
s_waitcnt lgkmcnt(10)
ds_read_b64_tr_b16 v[216:217], v117 offset:20480
ds_read_b64_tr_b16 v[218:219], v117 offset:22528
Mvva 152,248,12
buffer_load_dwordx4 a[56:59], v112, s[8:11], s52 offen offset:0 sc1
Zvva 140,236,0
ds_read_b64_tr_b16 v[204:205], v118 offset:16384
ds_read_b64_tr_b16 v[206:207], v118 offset:18432
Mvva 140,252,8
s_add_u32 s24, s24, s32
s_lshl_b32 s25, s24, 13
s_xor_b32 s26, s25, 32768
Zvva 156,236,4
s_waitcnt lgkmcnt(10)
ds_read_b64_tr_b16 v[220:221], v118 offset:20480
ds_read_b64_tr_b16 v[222:223], v118 offset:22528
Mvva 156,252,12
buffer_load_dwordx4 a[60:63], v112, s[8:11], s52 offen offset:1024 sc1
s_add_u32 s52, s52, 8192
s_waitcnt vmcnt(17)
Mvva 160,192,16
ds_read_b64_tr_b16 v[224:225], v115 offset:24576
ds_read_b64_tr_b16 v[226:227], v115 offset:26624
Mvva 160,208,24
s_lshl_b32 s24, s24, 2
s_xor_b32 s27, s24, 16
s_add_u32 s24, s24, 5452800
Mvva 176,192,20
s_waitcnt lgkmcnt(10)
s_add_u32 m0, s44, 65536
ds_read_b64_tr_b16 v[240:241], v115 offset:28672
ds_read_b64_tr_b16 v[242:243], v115 offset:30720
Mvva 176,208,28
buffer_load_dwordx4 v114, s[12:15], s48 offen offset:0 lds
Mvva 164,196,16
ds_read_b64_tr_b16 v[228:229], v116 offset:24576
ds_read_b64_tr_b16 v[230:231], v116 offset:26624
Mvva 164,212,24
s_add_u32 s27, s27, 5452800
v_lshlrev_b32 v58, 16, v26
v_and_b32 v59, 0xffff0000, v26
v_lshlrev_b32_e64 v60, 16, v27
v_and_b32 v61, 0xffff0000, v27
v_lshlrev_b32_e64 v62, 16, v28
Mvva 180,196,20
s_waitcnt lgkmcnt(10)
ds_read_b64_tr_b16 v[244:245], v116 offset:28672
ds_read_b64_tr_b16 v[246:247], v116 offset:30720
v_and_b32 v63, 0xffff0000, v28
Mvva 180,212,28
buffer_load_dwordx4 v114, s[12:15], s49 offen offset:1024 lds
Mvva 168,200,16
ds_read_b64_tr_b16 v[232:233], v117 offset:24576
ds_read_b64_tr_b16 v[234:235], v117 offset:26624
v_lshlrev_b32 v64, 16, v29
Mvva 168,216,24
v_and_b32 v65, 0xffff0000, v29
Vs 58,58,38
Vs 59,59,38
Vs 60,60,38
Vs 61,61,38
Mvva 184,200,20
s_waitcnt lgkmcnt(10)
ds_read_b64_tr_b16 v[248:249], v117 offset:28672
ds_read_b64_tr_b16 v[250:251], v117 offset:30720
Vs 62,62,38
Mvva 184,216,28
buffer_load_dwordx4 v114, s[12:15], s50 offen offset:2048 lds
Mvva 172,204,16
s_waitcnt vmcnt(12)
ds_read_b64_tr_b16 v[236:237], v118 offset:24576
ds_read_b64_tr_b16 v[238:239], v118 offset:26624
Vs 63,63,38
Mvva 172,220,24
s_waitcnt lgkmcnt(10)
Vs 64,64,38
v_sub_f32_e64 v65, v65, v38
Vc 2,58,59
v_lshlrev_b32_e64 v58, 16, v2
v_and_b32 v59, 0xffff0000, v2
Mvva 188,204,20
s_barrier
ds_read_b64_tr_b16 v[252:253], v118 offset:28672
ds_read_b64_tr_b16 v[254:255], v118 offset:30720
Vc 3,60,61
Mvva 188,220,28
buffer_load_dwordx4 v114, s[12:15], s51 offen offset:3072 lds
v_add_u32 v114, 131072, v114
Mvva 128,224,16
ds_read_b64_tr_b16 v[192:193], v115 offset:32768
ds_read_b64_tr_b16 v[194:195], v115 offset:34816
v_lshlrev_b32 v60, 16, v3
Mvva 128,240,24
v_and_b32 v61, 0xffff0000, v3
Vc 4,62,63
v_lshlrev_b32_e64 v62, 16, v4
v_and_b32 v63, 0xffff0000, v4
Vc 5,64,65
Mvva 144,224,20
s_waitcnt lgkmcnt(10)
ds_read_b64_tr_b16 v[208:209], v115 offset:36864
ds_read_b64_tr_b16 v[210:211], v115 offset:38912
v_lshlrev_b32 v64, 16, v5
Mvva 144,240,28
buffer_load_dwordx4 a[64:67], v112, s[8:11], s52 offen offset:0 sc1
Mvva 132,228,16
ds_read_b64_tr_b16 v[196:197], v116 offset:32768
ds_read_b64_tr_b16 v[198:199], v116 offset:34816
v_and_b32 v65, 0xffff0000, v5
Mvva 132,244,24
Vm 58,58,39
Vm 59,59,39
Vm 60,60,39
Vm 61,61,39
v_mul_f32_e64 v62, v62, v39
Mvva 148,228,20
s_waitcnt lgkmcnt(10)
ds_read_b64_tr_b16 v[212:213], v116 offset:36864
ds_read_b64_tr_b16 v[214:215], v116 offset:38912
Vm 63,63,39
Mvva 148,244,28
buffer_load_dwordx4 a[68:71], v112, s[8:11], s52 offen offset:1024 sc1
s_add_u32 s52, s52, 8192
Mvva 136,232,16
ds_read_b64_tr_b16 v[200:201], v117 offset:32768
ds_read_b64_tr_b16 v[202:203], v117 offset:34816
v_mul_f32_e64 v64, v64, v39
Mvva 136,248,24
v_mul_f32_e64 v65, v65, v39
Vc 2,58,59
v_lshlrev_b32_e64 v58, 16, v2
v_and_b32 v59, 0xffff0000, v2
Vc 3,60,61
Mvva 152,232,20
s_waitcnt lgkmcnt(10)
ds_read_b64_tr_b16 v[216:217], v117 offset:36864
ds_read_b64_tr_b16 v[218:219], v117 offset:38912
v_lshlrev_b32 v60, 16, v3
Mvva 152,248,28
buffer_load_dwordx4 a[72:75], v112, s[8:11], s52 offen offset:0 sc1
Mvva 140,236,16
ds_read_b64_tr_b16 v[204:205], v118 offset:32768
ds_read_b64_tr_b16 v[206:207], v118 offset:34816
v_and_b32 v61, 0xffff0000, v3
Mvva 140,252,24
Vc 4,62,63
v_lshlrev_b32_e64 v62, 16, v4
v_and_b32 v63, 0xffff0000, v4
Vc 5,64,65
v_lshlrev_b32_e64 v64, 16, v5
Mvva 156,236,20
s_waitcnt lgkmcnt(10)
ds_read_b64_tr_b16 v[220:221], v118 offset:36864
ds_read_b64_tr_b16 v[222:223], v118 offset:38912
v_and_b32 v65, 0xffff0000, v5
Mvva 156,252,28
buffer_load_dwordx4 a[76:79], v112, s[8:11], s52 offen offset:1024 sc1
s_add_u32 s52, s52, 8192
Mvva 160,192,32
ds_read_b64_tr_b16 v[224:225], v115 offset:40960
ds_read_b64_tr_b16 v[226:227], v115 offset:43008
v_mul_f32 v2, 0xbfb8aa3b, v58
Mvva 160,208,40
v_mul_f32 v3, 0xbfb8aa3b, v59
v_mul_f32 v4, 0xbfb8aa3b, v60
v_mul_f32 v5, 0xbfb8aa3b, v61
v_mul_f32 v6, 0xbfb8aa3b, v62
v_mul_f32 v7, 0xbfb8aa3b, v63
Mvva 176,192,36
s_waitcnt lgkmcnt(10)
s_add_u32 m0, s44, 81920
ds_read_b64_tr_b16 v[240:241], v115 offset:45056
ds_read_b64_tr_b16 v[242:243], v115 offset:47104
v_mul_f32 v8, 0xbfb8aa3b, v64
Mvva 176,208,44
buffer_load_dwordx4 v114, s[12:15], s48 offen offset:0 lds
Mvva 164,196,32
ds_read_b64_tr_b16 v[228:229], v116 offset:40960
ds_read_b64_tr_b16 v[230:231], v116 offset:43008
v_mul_f32 v9, 0xbfb8aa3b, v65
Mvva 164,212,40
Ve 2,2
Ve 3,3
Mvva 180,196,36
s_waitcnt lgkmcnt(10)
ds_read_b64_tr_b16 v[244:245], v116 offset:45056
ds_read_b64_tr_b16 v[246:247], v116 offset:47104
Mvva 180,212,44
buffer_load_dwordx4 v114, s[12:15], s49 offen offset:1024 lds
Mvva 168,200,32
ds_read_b64_tr_b16 v[232:233], v117 offset:40960
ds_read_b64_tr_b16 v[234:235], v117 offset:43008
Mvva 168,216,40
Ve 4,4
VE 5,5
Mvva 184,200,36
s_waitcnt lgkmcnt(10)
ds_read_b64_tr_b16 v[248:249], v117 offset:45056
ds_read_b64_tr_b16 v[250:251], v117 offset:47104
Mvva 184,216,44
buffer_load_dwordx4 v114, s[12:15], s50 offen offset:2048 lds
Mvva 172,204,32
s_waitcnt vmcnt(15)
ds_read_b64_tr_b16 v[236:237], v118 offset:40960
ds_read_b64_tr_b16 v[238:239], v118 offset:43008
Mvva 172,220,40
s_waitcnt lgkmcnt(10)
Ve 6,6
VE 7,7
Mvva 188,204,36
s_barrier
ds_read_b64_tr_b16 v[252:253], v118 offset:45056
ds_read_b64_tr_b16 v[254:255], v118 offset:47104
Mvva 188,220,44
buffer_load_dwordx4 v114, s[12:15], s51 offen offset:3072 lds
v_add_u32 v114, 131072, v114
Mvva 128,224,32
ds_read_b64_tr_b16 v[192:193], v115 offset:49152
ds_read_b64_tr_b16 v[194:195], v115 offset:51200
Mvva 128,240,40
Ve 8,8
Ve 9,9
v_add_f32 v2, 1.0, v2
Mvva 144,224,36
s_waitcnt lgkmcnt(10)
ds_read_b64_tr_b16 v[208:209], v115 offset:53248
ds_read_b64_tr_b16 v[210:211], v115 offset:55296
v_add_f32 v3, 1.0, v3
Mvva 144,240,44
buffer_load_dwordx4 a[80:83], v112, s[8:11], s52 offen offset:0 sc1
Mvva 132,228,32
ds_read_b64_tr_b16 v[196:197], v116 offset:49152
ds_read_b64_tr_b16 v[198:199], v116 offset:51200
v_add_f32_e64 v4, 1.0, v4
Mvva 132,244,40
v_add_f32 v5, 1.0, v5
v_add_f32 v6, 1.0, v6
v_add_f32 v7, 1.0, v7
v_add_f32 v8, 1.0, v8
v_add_f32_e64 v9, 1.0, v9
Mvva 148,228,36
s_waitcnt lgkmcnt(10)
ds_read_b64_tr_b16 v[212:213], v116 offset:53248
ds_read_b64_tr_b16 v[214:215], v116 offset:55296
Mvva 148,244,44
buffer_load_dwordx4 a[84:87], v112, s[8:11], s52 offen offset:1024 sc1
s_add_u32 s52, s52, 8192
Mvva 136,232,32
ds_read_b64_tr_b16 v[200:201], v117 offset:49152
ds_read_b64_tr_b16 v[202:203], v117 offset:51200
Mvva 136,248,40
v_rcp_f32 v2, v2
v_rcp_f32_e64 v3, v3
Mvva 152,232,36
s_waitcnt lgkmcnt(10)
ds_read_b64_tr_b16 v[216:217], v117 offset:53248
ds_read_b64_tr_b16 v[218:219], v117 offset:55296
Mvva 152,248,44
buffer_load_dwordx4 a[88:91], v112, s[8:11], s52 offen offset:0 sc1
Mvva 140,236,32
ds_read_b64_tr_b16 v[204:205], v118 offset:49152
ds_read_b64_tr_b16 v[206:207], v118 offset:51200
Mvva 140,252,40
v_rcp_f32 v4, v4
v_rcp_f32_e64 v5, v5
Mvva 156,236,36
s_waitcnt lgkmcnt(10)
ds_read_b64_tr_b16 v[220:221], v118 offset:53248
ds_read_b64_tr_b16 v[222:223], v118 offset:55296
Mvva 156,252,44
buffer_load_dwordx4 a[92:95], v112, s[8:11], s52 offen offset:1024 sc1
s_add_u32 s52, s52, 8192
s_waitcnt vmcnt(16)
Mvva 160,192,48
ds_read_b64_tr_b16 v[224:225], v115 offset:57344
ds_read_b64_tr_b16 v[226:227], v115 offset:59392
Mvva 160,208,56
v_rcp_f32 v6, v6
v_rcp_f32 v7, v7
Mvva 176,192,52
s_waitcnt lgkmcnt(10)
s_add_u32 m0, s44, 98304
ds_read_b64_tr_b16 v[240:241], v115 offset:61440
ds_read_b64_tr_b16 v[242:243], v115 offset:63488
Mvva 176,208,60
buffer_load_dwordx4 v114, s[12:15], s48 offen offset:0 lds
Mvva 164,196,48
ds_read_b64_tr_b16 v[228:229], v116 offset:57344
ds_read_b64_tr_b16 v[230:231], v116 offset:59392
Mvva 164,212,56
v_rcp_f32 v8, v8
v_rcp_f32 v9, v9
Vm 58,58,2
Mvva 180,196,52
s_waitcnt lgkmcnt(10)
ds_read_b64_tr_b16 v[244:245], v116 offset:61440
ds_read_b64_tr_b16 v[246:247], v116 offset:63488
Vm 59,59,3
Mvva 180,212,60
buffer_load_dwordx4 v114, s[12:15], s49 offen offset:1024 lds
Mvva 168,200,48
ds_read_b64_tr_b16 v[232:233], v117 offset:57344
ds_read_b64_tr_b16 v[234:235], v117 offset:59392
v_mul_f32_e64 v60, v60, v4
Mvva 168,216,56
Vm 61,61,5
Vm 62,62,6
Vm 63,63,7
Vm 64,64,8
v_mul_f32_e64 v65, v65, v9
Mvva 184,200,52
s_waitcnt lgkmcnt(10)
ds_read_b64_tr_b16 v[248:249], v117 offset:61440
ds_read_b64_tr_b16 v[250:251], v117 offset:63488
Vc 2,58,59
Mvva 184,216,60
buffer_load_dwordx4 v114, s[12:15], s50 offen offset:2048 lds
Mvva 172,204,48
s_waitcnt vmcnt(15)
ds_read_b64_tr_b16 v[236:237], v118 offset:57344
ds_read_b64_tr_b16 v[238:239], v118 offset:59392
v_lshlrev_b32_e64 v58, 16, v2
Mvva 172,220,56
s_waitcnt lgkmcnt(10)
v_and_b32 v59, 0xffff0000, v2
Vc 3,60,61
v_lshlrev_b32 v60, 16, v3
v_and_b32 v61, 0xffff0000, v3
Vc 4,62,63
Mvva 188,204,52
s_barrier
ds_read_b64_tr_b16 v[252:253], v118 offset:61440
ds_read_b64_tr_b16 v[254:255], v118 offset:63488
v_lshlrev_b32 v62, 16, v4
Mvva 188,220,60
buffer_load_dwordx4 v114, s[12:15], s51 offen offset:3072 lds
v_add_u32 v114, 131072, v114
Mvva 128,224,48
ds_read_b64_tr_b16 v[192:193], v12 offset:0
ds_read_b64_tr_b16 v[194:195], v12 offset:2048
v_and_b32 v63, 0xffff0000, v4
Mvva 128,240,56
Vc 5,64,65
v_lshlrev_b32_e64 v64, 16, v5
v_and_b32 v65, 0xffff0000, v5
v_lshlrev_b32_e64 v66, 16, v30
v_and_b32 v67, 0xffff0000, v30
Mvva 144,224,52
s_waitcnt lgkmcnt(10)
ds_read_b64_tr_b16 v[208:209], v12 offset:4096
ds_read_b64_tr_b16 v[210:211], v12 offset:6144
v_lshlrev_b32 v68, 16, v31
Mvva 144,240,60
buffer_load_dwordx4 a[96:99], v112, s[8:11], s52 offen offset:0 sc1
Mvva 132,228,48
ds_read_b64_tr_b16 v[196:197], v13 offset:0
ds_read_b64_tr_b16 v[198:199], v13 offset:2048
v_and_b32 v69, 0xffff0000, v31
Mvva 132,244,56
v_lshlrev_b32_e64 v70, 16, v32
v_and_b32 v71, 0xffff0000, v32
v_lshlrev_b32_e64 v72, 16, v33
v_and_b32 v73, 0xffff0000, v33
v_sub_f32_e64 v66, v66, v40
Mvva 148,228,52
s_waitcnt lgkmcnt(10)
ds_read_b64_tr_b16 v[212:213], v13 offset:4096
ds_read_b64_tr_b16 v[214:215], v13 offset:6144
Vs 67,67,40
Mvva 148,244,60
buffer_load_dwordx4 a[100:103], v112, s[8:11], s52 offen offset:1024 sc1
s_add_u32 s52, s52, 8192
Mvva 136,232,48
ds_read_b64_tr_b16 v[200:201], v14 offset:0
ds_read_b64_tr_b16 v[202:203], v14 offset:2048
v_sub_f32_e64 v68, v68, v40
Mvva 136,248,56
Vs 69,69,40
Vs 70,70,40
Vs 71,71,40
Vs 72,72,40
v_sub_f32_e64 v73, v73, v40
Mvva 152,232,52
s_waitcnt lgkmcnt(10)
ds_read_b64_tr_b16 v[216:217], v14 offset:4096
ds_read_b64_tr_b16 v[218:219], v14 offset:6144
Vc 2,66,67
Mvva 152,248,60
buffer_load_dwordx4 a[104:107], v112, s[8:11], s52 offen offset:0 sc1
Mvva 140,236,48
ds_read_b64_tr_b16 v[204:205], v15 offset:0
ds_read_b64_tr_b16 v[206:207], v15 offset:2048
v_lshlrev_b32 v66, 16, v2
Mvva 140,252,56
v_and_b32 v67, 0xffff0000, v2
Vc 3,68,69
v_lshlrev_b32_e64 v68, 16, v3
v_and_b32 v69, 0xffff0000, v3
Vc 4,70,71
Mvva 156,236,52
s_waitcnt lgkmcnt(10)
ds_read_b64_tr_b16 v[220:221], v15 offset:4096
ds_read_b64_tr_b16 v[222:223], v15 offset:6144
v_lshlrev_b32 v70, 16, v4
Mvva 156,252,60
buffer_load_dwordx4 a[108:111], v112, s[8:11], s52 offen offset:1024 sc1
s_add_u32 s52, s52, 8192
s_waitcnt vmcnt(16)
Mvva 160,192,64
ds_read_b64_tr_b16 v[224:225], v12 offset:8192
ds_read_b64_tr_b16 v[226:227], v12 offset:10240
v_and_b32 v71, 0xffff0000, v4
Mvva 160,208,72
s_cmp_lt_u32 s93, 224
s_cbranch_scc1 L_f2A
L_f2Ar:
Mvva 176,192,68
s_waitcnt lgkmcnt(10)
s_add_u32 m0, s44, 114688
ds_read_b64_tr_b16 v[240:241], v12 offset:12288
ds_read_b64_tr_b16 v[242:243], v12 offset:14336
Vc 5,72,73
Mvva 176,208,76
buffer_load_dwordx4 v114, s[12:15], s48 offen offset:0 lds
Mvva 164,196,64
ds_read_b64_tr_b16 v[228:229], v13 offset:8192
ds_read_b64_tr_b16 v[230:231], v13 offset:10240
v_lshlrev_b32 v72, 16, v5
Mvva 164,212,72
v_and_b32 v73, 0xffff0000, v5
Vm 66,66,41
Vm 67,67,41
Vm 68,68,41
Vm 69,69,41
Mvva 180,196,68
s_waitcnt lgkmcnt(10)
ds_read_b64_tr_b16 v[244:245], v13 offset:12288
ds_read_b64_tr_b16 v[246:247], v13 offset:14336
Vm 70,70,41
Mvva 180,212,76
buffer_load_dwordx4 v114, s[12:15], s49 offen offset:1024 lds
Mvva 168,200,64
ds_read_b64_tr_b16 v[232:233], v14 offset:8192
ds_read_b64_tr_b16 v[234:235], v14 offset:10240
v_mul_f32_e64 v71, v71, v41
Mvva 168,216,72
Vm 72,72,41
Vm 73,73,41
Vc 2,66,67
v_lshlrev_b32_e64 v66, 16, v2
v_and_b32 v67, 0xffff0000, v2
Mvva 184,200,68
s_waitcnt lgkmcnt(10)
ds_read_b64_tr_b16 v[248:249], v14 offset:12288
ds_read_b64_tr_b16 v[250:251], v14 offset:14336
Vc 3,68,69
Mvva 184,216,76
buffer_load_dwordx4 v114, s[12:15], s50 offen offset:2048 lds
Mvva 172,204,64
s_waitcnt vmcnt(15)
ds_read_b64_tr_b16 v[236:237], v15 offset:8192
ds_read_b64_tr_b16 v[238:239], v15 offset:10240
v_lshlrev_b32_e64 v68, 16, v3
Mvva 172,220,72
s_waitcnt lgkmcnt(10)
v_and_b32 v69, 0xffff0000, v3
Vc 4,70,71
v_lshlrev_b32 v70, 16, v4
v_and_b32 v71, 0xffff0000, v4
Vc 5,72,73
Mvva 188,204,68
s_barrier
ds_read_b64_tr_b16 v[252:253], v15 offset:12288
ds_read_b64_tr_b16 v[254:255], v15 offset:14336
v_lshlrev_b32 v72, 16, v5
Mvva 188,220,76
buffer_load_dwordx4 v114, s[12:15], s51 offen offset:3072 lds
v_add_u32 v114, 131072, v114
Mvva 128,224,64
ds_read_b64_tr_b16 v[192:193], v12 offset:16384
ds_read_b64_tr_b16 v[194:195], v12 offset:18432
v_and_b32 v73, 0xffff0000, v5
Mvva 128,240,72
v_mul_f32 v2, 0xbfb8aa3b, v66
v_mul_f32 v3, 0xbfb8aa3b, v67
v_mul_f32 v4, 0xbfb8aa3b, v68
v_mul_f32 v5, 0xbfb8aa3b, v69
v_mul_f32 v6, 0xbfb8aa3b, v70
Mvva 144,224,68
s_waitcnt lgkmcnt(10)
ds_read_b64_tr_b16 v[208:209], v12 offset:20480
ds_read_b64_tr_b16 v[210:211], v12 offset:22528
v_mul_f32 v7, 0xbfb8aa3b, v71
Mvva 144,240,76
buffer_load_dwordx4 a[112:115], v112, s[8:11], s52 offen offset:0 sc1
Mvva 132,228,64
ds_read_b64_tr_b16 v[196:197], v13 offset:16384
ds_read_b64_tr_b16 v[198:199], v13 offset:18432
v_mul_f32 v8, 0xbfb8aa3b, v72
Mvva 132,244,72
v_mul_f32 v9, 0xbfb8aa3b, v73
Ve 2,2
VE 3,3
Mvva 148,228,68
s_waitcnt lgkmcnt(10)
ds_read_b64_tr_b16 v[212:213], v13 offset:20480
ds_read_b64_tr_b16 v[214:215], v13 offset:22528
Mvva 148,244,76
buffer_load_dwordx4 a[116:119], v112, s[8:11], s52 offen offset:1024 sc1
s_add_u32 s52, s52, 8192
Mvva 136,232,64
ds_read_b64_tr_b16 v[200:201], v14 offset:16384
ds_read_b64_tr_b16 v[202:203], v14 offset:18432
Mvva 136,248,72
Ve 4,4
VE 5,5
Mvva 152,232,68
s_waitcnt lgkmcnt(10)
ds_read_b64_tr_b16 v[216:217], v14 offset:20480
ds_read_b64_tr_b16 v[218:219], v14 offset:22528
Mvva 152,248,76
buffer_load_dwordx4 a[120:123], v112, s[8:11], s52 offen offset:0 sc1
Mvva 140,236,64
ds_read_b64_tr_b16 v[204:205], v15 offset:16384
ds_read_b64_tr_b16 v[206:207], v15 offset:18432
Mvva 140,252,72
Ve 6,6
VE 7,7
Mvva 156,236,68
s_waitcnt lgkmcnt(10)
ds_read_b64_tr_b16 v[220:221], v15 offset:20480
ds_read_b64_tr_b16 v[222:223], v15 offset:22528
Mvva 156,252,76
buffer_load_dwordx4 a[124:127], v112, s[8:11], s52 offen offset:1024 sc1
s_add_u32 s52, s52, 8192
s_waitcnt vmcnt(16)
Mvva 160,192,80
ds_read_b64_tr_b16 v[224:225], v12 offset:24576
ds_read_b64_tr_b16 v[226:227], v12 offset:26624
Mvva 160,208,88
Ve 8,8
Ve 9,9
v_add_f32_e64 v2, 1.0, v2
Mvva 176,192,84
s_waitcnt lgkmcnt(10)
s_add_u32 m0, s44, 0
ds_read_b64_tr_b16 v[240:241], v12 offset:28672
ds_read_b64_tr_b16 v[242:243], v12 offset:30720
v_add_f32_e64 v3, 1.0, v3
Mvva 176,208,92
buffer_load_dwordx4 v114, s[12:15], s48 offen offset:0 lds
Mvva 164,196,80
ds_read_b64_tr_b16 v[228:229], v13 offset:24576
ds_read_b64_tr_b16 v[230:231], v13 offset:26624
v_add_f32_e64 v4, 1.0, v4
Mvva 164,212,88
v_add_f32 v5, 1.0, v5
v_add_f32 v6, 1.0, v6
v_add_f32 v7, 1.0, v7
v_add_f32 v8, 1.0, v8
v_add_f32_e64 v9, 1.0, v9
Mvva 180,196,84
s_waitcnt lgkmcnt(10)
ds_read_b64_tr_b16 v[244:245], v13 offset:28672
ds_read_b64_tr_b16 v[246:247], v13 offset:30720
Mvva 180,212,92
buffer_load_dwordx4 v114, s[12:15], s49 offen offset:1024 lds
Mvva 168,200,80
ds_read_b64_tr_b16 v[232:233], v14 offset:24576
ds_read_b64_tr_b16 v[234:235], v14 offset:26624
Mvva 168,216,88
v_rcp_f32 v2, v2
v_rcp_f32_e64 v3, v3
Mvva 184,200,84
s_waitcnt lgkmcnt(10)
ds_read_b64_tr_b16 v[248:249], v14 offset:28672
ds_read_b64_tr_b16 v[250:251], v14 offset:30720
Mvva 184,216,92
buffer_load_dwordx4 v114, s[12:15], s50 offen offset:2048 lds
Mvva 172,204,80
s_waitcnt vmcnt(15)
ds_read_b64_tr_b16 v[236:237], v15 offset:24576
ds_read_b64_tr_b16 v[238:239], v15 offset:26624
Mvva 172,220,88
s_waitcnt lgkmcnt(10)
v_rcp_f32 v4, v4
v_rcp_f32_e64 v5, v5
Mvva 188,204,84
s_barrier
ds_read_b64_tr_b16 v[252:253], v15 offset:28672
ds_read_b64_tr_b16 v[254:255], v15 offset:30720
Mvva 188,220,92
buffer_load_dwordx4 v114, s[12:15], s51 offen offset:3072 lds
v_add_u32 v114, 131072, v114
Mvva 128,224,80
ds_read_b64_tr_b16 v[192:193], v12 offset:32768
ds_read_b64_tr_b16 v[194:195], v12 offset:34816
Mvva 128,240,88
v_rcp_f32 v6, v6
v_rcp_f32_e64 v7, v7
Mvva 144,224,84
s_waitcnt lgkmcnt(10)
ds_read_b64_tr_b16 v[208:209], v12 offset:36864
ds_read_b64_tr_b16 v[210:211], v12 offset:38912
Mvva 144,240,92
buffer_load_dwordx4 a[128:131], v112, s[8:11], s52 offen offset:0 sc1
Mvva 132,228,80
ds_read_b64_tr_b16 v[196:197], v13 offset:32768
ds_read_b64_tr_b16 v[198:199], v13 offset:34816
Mvva 132,244,88
v_rcp_f32 v8, v8
v_rcp_f32 v9, v9
Vm 66,66,2
Mvva 148,228,84
s_waitcnt lgkmcnt(10)
ds_read_b64_tr_b16 v[212:213], v13 offset:36864
ds_read_b64_tr_b16 v[214:215], v13 offset:38912
Vm 67,67,3
Mvva 148,244,92
buffer_load_dwordx4 a[132:135], v112, s[8:11], s52 offen offset:1024 sc1
s_add_u32 s52, s52, 8192
Mvva 136,232,80
ds_read_b64_tr_b16 v[200:201], v14 offset:32768
ds_read_b64_tr_b16 v[202:203], v14 offset:34816
v_mul_f32_e64 v68, v68, v4
Mvva 136,248,88
Vm 69,69,5
Vm 70,70,6
Vm 71,71,7
Vm 72,72,8
v_mul_f32_e64 v73, v73, v9
Mvva 152,232,84
s_waitcnt lgkmcnt(10)
ds_read_b64_tr_b16 v[216:217], v14 offset:36864
ds_read_b64_tr_b16 v[218:219], v14 offset:38912
Vc 2,66,67
Mvva 152,248,92
buffer_load_dwordx4 a[136:139], v112, s[8:11], s52 offen offset:0 sc1
Mvva 140,236,80
ds_read_b64_tr_b16 v[204:205], v15 offset:32768
ds_read_b64_tr_b16 v[206:207], v15 offset:34816
v_lshlrev_b32 v66, 16, v2
Mvva 140,252,88
v_and_b32 v67, 0xffff0000, v2
Vc 3,68,69
v_lshlrev_b32_e64 v68, 16, v3
v_and_b32 v69, 0xffff0000, v3
Vc 4,70,71
Mvva 156,236,84
s_waitcnt lgkmcnt(10)
ds_read_b64_tr_b16 v[220:221], v15 offset:36864
ds_read_b64_tr_b16 v[222:223], v15 offset:38912
v_lshlrev_b32 v70, 16, v4
Mvva 156,252,92
buffer_load_dwordx4 a[140:143], v112, s[8:11], s52 offen offset:1024 sc1
s_add_u32 s52, s52, 8192
s_waitcnt vmcnt(16)
Mvva 160,192,96
ds_read_b64_tr_b16 v[224:225], v12 offset:40960
ds_read_b64_tr_b16 v[226:227], v12 offset:43008
v_and_b32 v71, 0xffff0000, v4
Mvva 160,208,104
Vc 5,72,73
v_lshlrev_b32 v72, 16, v5
v_and_b32 v73, 0xffff0000, v5
Mvva 176,192,100
s_waitcnt lgkmcnt(10)
s_add_u32 m0, s44, 16384
ds_read_b64_tr_b16 v[240:241], v12 offset:45056
ds_read_b64_tr_b16 v[242:243], v12 offset:47104
Mvva 176,208,108
buffer_load_dwordx4 v114, s[12:15], s48 offen offset:0 lds
Mvva 164,196,96
ds_read_b64_tr_b16 v[228:229], v13 offset:40960
ds_read_b64_tr_b16 v[230:231], v13 offset:43008
Mvva 164,212,104
Mvva 180,196,100
s_waitcnt lgkmcnt(10)
ds_read_b64_tr_b16 v[244:245], v13 offset:45056
ds_read_b64_tr_b16 v[246:247], v13 offset:47104
Mvva 180,212,108
buffer_load_dwordx4 v114, s[12:15], s49 offen offset:1024 lds
Mvva 168,200,96
ds_read_b64_tr_b16 v[232:233], v14 offset:40960
ds_read_b64_tr_b16 v[234:235], v14 offset:43008
Mvva 168,216,104
Mvva 184,200,100
s_waitcnt lgkmcnt(10)
ds_read_b64_tr_b16 v[248:249], v14 offset:45056
ds_read_b64_tr_b16 v[250:251], v14 offset:47104
Mvva 184,216,108
buffer_load_dwordx4 v114, s[12:15], s50 offen offset:2048 lds
Mvva 172,204,96
s_waitcnt vmcnt(15)
ds_read_b64_tr_b16 v[236:237], v15 offset:40960
ds_read_b64_tr_b16 v[238:239], v15 offset:43008
Mvva 172,220,104
s_waitcnt lgkmcnt(10)
s_cmp_lt_u32 s93, 224
s_cbranch_scc1 L_f2B
L_f2Br:
Mvva 188,204,100
s_barrier
ds_read_b64_tr_b16 v[252:253], v15 offset:45056
ds_read_b64_tr_b16 v[254:255], v15 offset:47104
Mvva 188,220,108
buffer_load_dwordx4 v114, s[12:15], s51 offen offset:3072 lds
v_add_u32 v114, 131072, v114
Mvva 128,224,96
ds_read_b64_tr_b16 v[192:193], v12 offset:49152
ds_read_b64_tr_b16 v[194:195], v12 offset:51200
Mvva 128,240,104
Mvva 144,224,100
s_waitcnt lgkmcnt(10)
ds_read_b64_tr_b16 v[208:209], v12 offset:53248
ds_read_b64_tr_b16 v[210:211], v12 offset:55296
Mvva 144,240,108
buffer_load_dwordx4 a[144:147], v112, s[8:11], s52 offen offset:0 sc1
Mvva 132,228,96
ds_read_b64_tr_b16 v[196:197], v13 offset:49152
ds_read_b64_tr_b16 v[198:199], v13 offset:51200
Mvva 132,244,104
Mvva 148,228,100
s_waitcnt lgkmcnt(10)
ds_read_b64_tr_b16 v[212:213], v13 offset:53248
ds_read_b64_tr_b16 v[214:215], v13 offset:55296
Mvva 148,244,108
buffer_load_dwordx4 a[148:151], v112, s[8:11], s52 offen offset:1024 sc1
s_add_u32 s52, s52, 8192
Mvva 136,232,96
ds_read_b64_tr_b16 v[200:201], v14 offset:49152
ds_read_b64_tr_b16 v[202:203], v14 offset:51200
Mvva 136,248,104
Mvva 152,232,100
s_waitcnt lgkmcnt(10)
ds_read_b64_tr_b16 v[216:217], v14 offset:53248
ds_read_b64_tr_b16 v[218:219], v14 offset:55296
Mvva 152,248,108
buffer_load_dwordx4 a[152:155], v112, s[8:11], s52 offen offset:0 sc1
Mvva 140,236,96
ds_read_b64_tr_b16 v[204:205], v15 offset:49152
ds_read_b64_tr_b16 v[206:207], v15 offset:51200
Mvva 140,252,104
Mvva 156,236,100
s_waitcnt lgkmcnt(10)
ds_read_b64_tr_b16 v[220:221], v15 offset:53248
ds_read_b64_tr_b16 v[222:223], v15 offset:55296
Mvva 156,252,108
buffer_load_dwordx4 a[156:159], v112, s[8:11], s52 offen offset:1024 sc1
s_add_u32 s52, s52, 8192
s_waitcnt vmcnt(16)
Mvva 160,192,112
ds_read_b64_tr_b16 v[224:225], v12 offset:57344
ds_read_b64_tr_b16 v[226:227], v12 offset:59392
Mvva 160,208,120
Mvva 176,192,116
s_waitcnt lgkmcnt(10)
s_add_u32 m0, s44, 32768
ds_read_b64_tr_b16 v[240:241], v12 offset:61440
ds_read_b64_tr_b16 v[242:243], v12 offset:63488
Mvva 176,208,124
buffer_load_dwordx4 v114, s[12:15], s48 offen offset:0 lds
Mvva 164,196,112
ds_read_b64_tr_b16 v[228:229], v13 offset:57344
ds_read_b64_tr_b16 v[230:231], v13 offset:59392
Mvva 164,212,120
Mvva 180,196,116
s_waitcnt lgkmcnt(10)
ds_read_b64_tr_b16 v[244:245], v13 offset:61440
ds_read_b64_tr_b16 v[246:247], v13 offset:63488
Mvva 180,212,124
buffer_load_dwordx4 v114, s[12:15], s49 offen offset:1024 lds
Mvva 168,200,112
ds_read_b64_tr_b16 v[232:233], v14 offset:57344
ds_read_b64_tr_b16 v[234:235], v14 offset:59392
Mvva 168,216,120
Mvva 184,200,116
s_waitcnt lgkmcnt(10)
ds_read_b64_tr_b16 v[248:249], v14 offset:61440
ds_read_b64_tr_b16 v[250:251], v14 offset:63488
Mvva 184,216,124
buffer_load_dwordx4 v114, s[12:15], s50 offen offset:2048 lds
Mvva 172,204,112
s_waitcnt vmcnt(15)
ds_read_b64_tr_b16 v[236:237], v15 offset:57344
ds_read_b64_tr_b16 v[238:239], v15 offset:59392
Mvva 172,220,120
s_waitcnt lgkmcnt(10)
Mvva 188,204,116
s_barrier
ds_read_b64_tr_b16 v[252:253], v15 offset:61440
ds_read_b64_tr_b16 v[254:255], v15 offset:63488
Mvva 188,220,124
buffer_load_dwordx4 v114, s[12:15], s51 offen offset:3072 lds
v_add_u32 v114, 131072, v114
Mvva 128,224,112
ds_read_b64_tr_b16 v[192:193], v115 offset:0
ds_read_b64_tr_b16 v[194:195], v115 offset:2048
Mvva 128,240,120
Mvva 144,224,116
s_waitcnt lgkmcnt(10)
ds_read_b64_tr_b16 v[208:209], v115 offset:4096
ds_read_b64_tr_b16 v[210:211], v115 offset:6144
Mvva 144,240,124
buffer_load_dwordx4 a[160:163], v112, s[8:11], s52 offen offset:0 sc1
Mvva 132,228,112
ds_read_b64_tr_b16 v[196:197], v116 offset:0
ds_read_b64_tr_b16 v[198:199], v116 offset:2048
Mvva 132,244,120
Mvva 148,228,116
s_waitcnt lgkmcnt(10)
ds_read_b64_tr_b16 v[212:213], v116 offset:4096
ds_read_b64_tr_b16 v[214:215], v116 offset:6144
Mvva 148,244,124
buffer_load_dwordx4 a[164:167], v112, s[8:11], s52 offen offset:1024 sc1
s_add_u32 s52, s52, 8192
Mvva 136,232,112
ds_read_b64_tr_b16 v[200:201], v117 offset:0
ds_read_b64_tr_b16 v[202:203], v117 offset:2048
Mvva 136,248,120
Mvva 152,232,116
s_waitcnt lgkmcnt(10)
ds_read_b64_tr_b16 v[216:217], v117 offset:4096
ds_read_b64_tr_b16 v[218:219], v117 offset:6144
Mvva 152,248,124
buffer_load_dwordx4 a[168:171], v112, s[8:11], s52 offen offset:0 sc1
Mvva 140,236,112
ds_read_b64_tr_b16 v[204:205], v118 offset:0
ds_read_b64_tr_b16 v[206:207], v118 offset:2048
Mvva 140,252,120
Mvva 156,236,116
s_waitcnt lgkmcnt(10)
ds_read_b64_tr_b16 v[220:221], v118 offset:4096
ds_read_b64_tr_b16 v[222:223], v118 offset:6144
Mvva 156,252,124
buffer_load_dwordx4 a[172:175], v112, s[8:11], s52 offen offset:1024 sc1
s_add_u32 s52, s52, 8192
s_waitcnt vmcnt(16)
Mvva 160,192,128
ds_read_b64_tr_b16 v[224:225], v115 offset:8192
ds_read_b64_tr_b16 v[226:227], v115 offset:10240
Mvva 160,208,136
Mvva 176,192,132
s_waitcnt lgkmcnt(10)
s_add_u32 m0, s44, 49152
ds_read_b64_tr_b16 v[240:241], v115 offset:12288
ds_read_b64_tr_b16 v[242:243], v115 offset:14336
Mvva 176,208,140
buffer_load_dwordx4 v114, s[12:15], s48 offen offset:0 lds
Mvva 164,196,128
ds_read_b64_tr_b16 v[228:229], v116 offset:8192
ds_read_b64_tr_b16 v[230:231], v116 offset:10240
Mvva 164,212,136
Mvva 180,196,132
s_waitcnt lgkmcnt(10)
ds_read_b64_tr_b16 v[244:245], v116 offset:12288
ds_read_b64_tr_b16 v[246:247], v116 offset:14336
Mvva 180,212,140
buffer_load_dwordx4 v114, s[12:15], s49 offen offset:1024 lds
Mvva 168,200,128
ds_read_b64_tr_b16 v[232:233], v117 offset:8192
ds_read_b64_tr_b16 v[234:235], v117 offset:10240
Mvva 168,216,136
Mvva 184,200,132
s_waitcnt lgkmcnt(10)
ds_read_b64_tr_b16 v[248:249], v117 offset:12288
ds_read_b64_tr_b16 v[250:251], v117 offset:14336
Mvva 184,216,140
buffer_load_dwordx4 v114, s[12:15], s50 offen offset:2048 lds
Mvva 172,204,128
s_waitcnt vmcnt(15)
ds_read_b64_tr_b16 v[236:237], v118 offset:8192
ds_read_b64_tr_b16 v[238:239], v118 offset:10240
Mvva 172,220,136
s_waitcnt lgkmcnt(10)
Mvva 188,204,132
s_barrier
ds_read_b64_tr_b16 v[252:253], v118 offset:12288
ds_read_b64_tr_b16 v[254:255], v118 offset:14336
Mvva 188,220,140
buffer_load_dwordx4 v114, s[12:15], s51 offen offset:3072 lds
v_add_u32 v114, 131072, v114
Mvva 128,224,128
ds_read_b64_tr_b16 v[192:193], v115 offset:16384
ds_read_b64_tr_b16 v[194:195], v115 offset:18432
Mvva 128,240,136
Mvva 144,224,132
s_waitcnt lgkmcnt(10)
ds_read_b64_tr_b16 v[208:209], v115 offset:20480
ds_read_b64_tr_b16 v[210:211], v115 offset:22528
Mvva 144,240,140
buffer_load_dwordx4 a[176:179], v112, s[8:11], s52 offen offset:0 sc1
Mvva 132,228,128
ds_read_b64_tr_b16 v[196:197], v116 offset:16384
ds_read_b64_tr_b16 v[198:199], v116 offset:18432
Mvva 132,244,136
Mvva 148,228,132
s_waitcnt lgkmcnt(10)
ds_read_b64_tr_b16 v[212:213], v116 offset:20480
ds_read_b64_tr_b16 v[214:215], v116 offset:22528
Mvva 148,244,140
buffer_load_dwordx4 a[180:183], v112, s[8:11], s52 offen offset:1024 sc1
s_add_u32 s52, s52, 8192
Mvva 136,232,128
ds_read_b64_tr_b16 v[200:201], v117 offset:16384
ds_read_b64_tr_b16 v[202:203], v117 offset:18432
Mvva 136,248,136
Mvva 152,232,132
s_waitcnt lgkmcnt(10)
ds_read_b64_tr_b16 v[216:217], v117 offset:20480
ds_read_b64_tr_b16 v[218:219], v117 offset:22528
Mvva 152,248,140
buffer_load_dwordx4 a[184:187], v112, s[8:11], s52 offen offset:0 sc1
Mvva 140,236,128
ds_read_b64_tr_b16 v[204:205], v118 offset:16384
ds_read_b64_tr_b16 v[206:207], v118 offset:18432
Mvva 140,252,136
s_cmp_lt_u32 s93, 224
s_cbranch_scc1 L_f2C
L_f2Cr:
Mvva 156,236,132
s_waitcnt lgkmcnt(10)
ds_read_b64_tr_b16 v[220:221], v118 offset:20480
ds_read_b64_tr_b16 v[222:223], v118 offset:22528
Mvva 156,252,140
buffer_load_dwordx4 a[188:191], v112, s[8:11], s52 offen offset:1024 sc1
s_add_u32 s52, s52, 8192
s_waitcnt vmcnt(16)
Mvva 160,192,144
ds_read_b64_tr_b16 v[224:225], v115 offset:24576
ds_read_b64_tr_b16 v[226:227], v115 offset:26624
Mvva 160,208,152
Mvva 176,192,148
s_waitcnt lgkmcnt(10)
s_add_u32 m0, s44, 65536
ds_read_b64_tr_b16 v[240:241], v115 offset:28672
ds_read_b64_tr_b16 v[242:243], v115 offset:30720
Mvva 176,208,156
buffer_load_dwordx4 v114, s[12:15], s48 offen offset:0 lds
Mvva 164,196,144
ds_read_b64_tr_b16 v[228:229], v116 offset:24576
ds_read_b64_tr_b16 v[230:231], v116 offset:26624
Mvva 164,212,152
Mvva 180,196,148
s_waitcnt lgkmcnt(10)
ds_read_b64_tr_b16 v[244:245], v116 offset:28672
ds_read_b64_tr_b16 v[246:247], v116 offset:30720
Mvva 180,212,156
buffer_load_dwordx4 v114, s[12:15], s49 offen offset:1024 lds
Mvva 168,200,144
ds_read_b64_tr_b16 v[232:233], v117 offset:24576
ds_read_b64_tr_b16 v[234:235], v117 offset:26624
Mvva 168,216,152
Mvva 184,200,148
s_waitcnt lgkmcnt(10)
ds_read_b64_tr_b16 v[248:249], v117 offset:28672
ds_read_b64_tr_b16 v[250:251], v117 offset:30720
Mvva 184,216,156
buffer_load_dwordx4 v114, s[12:15], s50 offen offset:2048 lds
Mvva 172,204,144
s_waitcnt vmcnt(15)
ds_read_b64_tr_b16 v[236:237], v118 offset:24576
ds_read_b64_tr_b16 v[238:239], v118 offset:26624
Mvva 172,220,152
s_waitcnt lgkmcnt(10)
Mvva 188,204,148
s_barrier
ds_read_b64_tr_b16 v[252:253], v118 offset:28672
ds_read_b64_tr_b16 v[254:255], v118 offset:30720
Mvva 188,220,156
buffer_load_dwordx4 v114, s[12:15], s51 offen offset:3072 lds
v_add_u32 v114, 131072, v114
Mvva 128,224,144
ds_read_b64_tr_b16 v[192:193], v115 offset:32768
ds_read_b64_tr_b16 v[194:195], v115 offset:34816
Mvva 128,240,152
s_cmp_ge_u32 s2, 128
s_cbranch_scc1 L_c31
L_c31r:
Mvva 144,224,148
s_waitcnt lgkmcnt(10)
ds_read_b64_tr_b16 v[208:209], v115 offset:36864
ds_read_b64_tr_b16 v[210:211], v115 offset:38912
Mvva 144,240,156
buffer_load_dwordx4 a[192:195], v112, s[8:11], s52 offen offset:0 sc1
Mvva 132,228,144
ds_read_b64_tr_b16 v[196:197], v116 offset:32768
ds_read_b64_tr_b16 v[198:199], v116 offset:34816
Mvva 132,244,152
Mvva 148,228,148
s_waitcnt lgkmcnt(10)
ds_read_b64_tr_b16 v[212:213], v116 offset:36864
ds_read_b64_tr_b16 v[214:215], v116 offset:38912
Mvva 148,244,156
buffer_load_dwordx4 a[196:199], v112, s[8:11], s52 offen offset:1024 sc1
s_add_u32 s52, s52, 8192
Mvva 136,232,144
ds_read_b64_tr_b16 v[200:201], v117 offset:32768
ds_read_b64_tr_b16 v[202:203], v117 offset:34816
Mvva 136,248,152
Mvva 152,232,148
s_waitcnt lgkmcnt(10)
ds_read_b64_tr_b16 v[216:217], v117 offset:36864
ds_read_b64_tr_b16 v[218:219], v117 offset:38912
Mvva 152,248,156
buffer_load_dwordx4 a[200:203], v112, s[8:11], s52 offen offset:0 sc1
Mvva 140,236,144
ds_read_b64_tr_b16 v[204:205], v118 offset:32768
ds_read_b64_tr_b16 v[206:207], v118 offset:34816
Mvva 140,252,152
Mvva 156,236,148
s_waitcnt lgkmcnt(10)
ds_read_b64_tr_b16 v[220:221], v118 offset:36864
ds_read_b64_tr_b16 v[222:223], v118 offset:38912
Mvva 156,252,156
buffer_load_dwordx4 a[204:207], v112, s[8:11], s52 offen offset:1024 sc1
s_add_u32 s52, s52, 8192
s_waitcnt vmcnt(16)
Mvva 160,192,160
ds_read_b64_tr_b16 v[224:225], v115 offset:40960
ds_read_b64_tr_b16 v[226:227], v115 offset:43008
Mvva 160,208,168
Mvva 176,192,164
s_waitcnt lgkmcnt(10)
s_add_u32 m0, s44, 81920
ds_read_b64_tr_b16 v[240:241], v115 offset:45056
ds_read_b64_tr_b16 v[242:243], v115 offset:47104
Mvva 176,208,172
buffer_load_dwordx4 v114, s[12:15], s48 offen offset:0 lds
Mvva 164,196,160
ds_read_b64_tr_b16 v[228:229], v116 offset:40960
ds_read_b64_tr_b16 v[230:231], v116 offset:43008
Mvva 164,212,168
Mvva 180,196,164
s_waitcnt lgkmcnt(10)
ds_read_b64_tr_b16 v[244:245], v116 offset:45056
ds_read_b64_tr_b16 v[246:247], v116 offset:47104
Mvva 180,212,172
buffer_load_dwordx4 v114, s[12:15], s49 offen offset:1024 lds
Mvva 168,200,160
ds_read_b64_tr_b16 v[232:233], v117 offset:40960
ds_read_b64_tr_b16 v[234:235], v117 offset:43008
Mvva 168,216,168
Mvva 184,200,164
s_waitcnt lgkmcnt(10)
ds_read_b64_tr_b16 v[248:249], v117 offset:45056
ds_read_b64_tr_b16 v[250:251], v117 offset:47104
Mvva 184,216,172
buffer_load_dwordx4 v114, s[12:15], s50 offen offset:2048 lds
Mvva 172,204,160
s_waitcnt vmcnt(15)
ds_read_b64_tr_b16 v[236:237], v118 offset:40960
ds_read_b64_tr_b16 v[238:239], v118 offset:43008
Mvva 172,220,168
s_waitcnt lgkmcnt(10)
Mvva 188,204,164
s_barrier
ds_read_b64_tr_b16 v[252:253], v118 offset:45056
ds_read_b64_tr_b16 v[254:255], v118 offset:47104
Mvva 188,220,172
buffer_load_dwordx4 v114, s[12:15], s51 offen offset:3072 lds
v_add_u32 v114, 131072, v114
Mvva 128,224,160
ds_read_b64_tr_b16 v[192:193], v115 offset:49152
ds_read_b64_tr_b16 v[194:195], v115 offset:51200
Mvva 128,240,168
Mvva 144,224,164
s_waitcnt lgkmcnt(10)
ds_read_b64_tr_b16 v[208:209], v115 offset:53248
ds_read_b64_tr_b16 v[210:211], v115 offset:55296
Mvva 144,240,172
buffer_load_dwordx4 a[208:211], v112, s[8:11], s52 offen offset:0 sc1
Mvva 132,228,160
ds_read_b64_tr_b16 v[196:197], v116 offset:49152
ds_read_b64_tr_b16 v[198:199], v116 offset:51200
Mvva 132,244,168
Mvva 148,228,164
s_waitcnt lgkmcnt(10)
ds_read_b64_tr_b16 v[212:213], v116 offset:53248
ds_read_b64_tr_b16 v[214:215], v116 offset:55296
Mvva 148,244,172
buffer_load_dwordx4 a[212:215], v112, s[8:11], s52 offen offset:1024 sc1
s_add_u32 s52, s52, 8192
Mvva 136,232,160
ds_read_b64_tr_b16 v[200:201], v117 offset:49152
ds_read_b64_tr_b16 v[202:203], v117 offset:51200
Mvva 136,248,168
Mvva 152,232,164
s_waitcnt lgkmcnt(10)
ds_read_b64_tr_b16 v[216:217], v117 offset:53248
ds_read_b64_tr_b16 v[218:219], v117 offset:55296
Mvva 152,248,172
buffer_load_dwordx4 a[216:219], v112, s[8:11], s52 offen offset:0 sc1
Mvva 140,236,160
ds_read_b64_tr_b16 v[204:205], v118 offset:49152
ds_read_b64_tr_b16 v[206:207], v118 offset:51200
Mvva 140,252,168
Mvva 156,236,164
s_waitcnt lgkmcnt(10)
ds_read_b64_tr_b16 v[220:221], v118 offset:53248
ds_read_b64_tr_b16 v[222:223], v118 offset:55296
Mvva 156,252,172
buffer_load_dwordx4 a[220:223], v112, s[8:11], s52 offen offset:1024 sc1
s_add_u32 s52, s52, 8192
s_waitcnt vmcnt(16)
Mvva 160,192,176
ds_read_b64_tr_b16 v[224:225], v115 offset:57344
ds_read_b64_tr_b16 v[226:227], v115 offset:59392
Mvva 160,208,184
Mvva 176,192,180
s_waitcnt lgkmcnt(10)
s_add_u32 m0, s44, 98304
ds_read_b64_tr_b16 v[240:241], v115 offset:61440
ds_read_b64_tr_b16 v[242:243], v115 offset:63488
Mvva 176,208,188
buffer_load_dwordx4 v114, s[12:15], s48 offen offset:0 lds
Mvva 164,196,176
ds_read_b64_tr_b16 v[228:229], v116 offset:57344
ds_read_b64_tr_b16 v[230:231], v116 offset:59392
Mvva 164,212,184
Mvva 180,196,180
s_waitcnt lgkmcnt(10)
ds_read_b64_tr_b16 v[244:245], v116 offset:61440
ds_read_b64_tr_b16 v[246:247], v116 offset:63488
Mvva 180,212,188
buffer_load_dwordx4 v114, s[12:15], s49 offen offset:1024 lds
Mvva 168,200,176
ds_read_b64_tr_b16 v[232:233], v117 offset:57344
ds_read_b64_tr_b16 v[234:235], v117 offset:59392
Mvva 168,216,184
s_cmp_lt_u32 s93, 224
s_cbranch_scc1 L_f2E
L_f2Er:
Mvva 184,200,180
s_waitcnt lgkmcnt(10)
ds_read_b64_tr_b16 v[248:249], v117 offset:61440
ds_read_b64_tr_b16 v[250:251], v117 offset:63488
Mvva 184,216,188
buffer_load_dwordx4 v114, s[12:15], s50 offen offset:2048 lds
Mvva 172,204,176
s_waitcnt vmcnt(15)
ds_read_b64_tr_b16 v[236:237], v118 offset:57344
ds_read_b64_tr_b16 v[238:239], v118 offset:59392
Mvva 172,220,184
s_waitcnt lgkmcnt(10)
Mvva 188,204,180
s_barrier
ds_read_b64_tr_b16 v[252:253], v118 offset:61440
ds_read_b64_tr_b16 v[254:255], v118 offset:63488
Mvva 188,220,188
buffer_load_dwordx4 v114, s[12:15], s51 offen offset:3072 lds
v_add_u32 v114, 131072, v114
Mvva 128,224,176
ds_read_b64_tr_b16 v[192:193], v12 offset:0
ds_read_b64_tr_b16 v[194:195], v12 offset:2048
Mvva 128,240,184
Mvva 144,224,180
s_waitcnt lgkmcnt(10)
ds_read_b64_tr_b16 v[208:209], v12 offset:4096
ds_read_b64_tr_b16 v[210:211], v12 offset:6144
Mvva 144,240,188
buffer_load_dwordx4 a[224:227], v112, s[8:11], s52 offen offset:0 sc1
Mvva 132,228,176
ds_read_b64_tr_b16 v[196:197], v13 offset:0
ds_read_b64_tr_b16 v[198:199], v13 offset:2048
Mvva 132,244,184
Mvva 148,228,180
s_waitcnt lgkmcnt(10)
ds_read_b64_tr_b16 v[212:213], v13 offset:4096
ds_read_b64_tr_b16 v[214:215], v13 offset:6144
Mvva 148,244,188
buffer_load_dwordx4 a[228:231], v112, s[8:11], s52 offen offset:1024 sc1
s_add_u32 s52, s52, 8192
Mvva 136,232,176
ds_read_b64_tr_b16 v[200:201], v14 offset:0
ds_read_b64_tr_b16 v[202:203], v14 offset:2048
Mvva 136,248,184
Mvva 152,232,180
s_waitcnt lgkmcnt(10)
ds_read_b64_tr_b16 v[216:217], v14 offset:4096
ds_read_b64_tr_b16 v[218:219], v14 offset:6144
Mvva 152,248,188
buffer_load_dwordx4 a[232:235], v112, s[8:11], s52 offen offset:0 sc1
Mvva 140,236,176
ds_read_b64_tr_b16 v[204:205], v15 offset:0
ds_read_b64_tr_b16 v[206:207], v15 offset:2048
Mvva 140,252,184
Mvva 156,236,180
s_waitcnt lgkmcnt(10)
ds_read_b64_tr_b16 v[220:221], v15 offset:4096
ds_read_b64_tr_b16 v[222:223], v15 offset:6144
Mvva 156,252,188
buffer_load_dwordx4 a[236:239], v112, s[8:11], s52 offen offset:1024 sc1
s_add_u32 s52, s52, 8192
s_waitcnt vmcnt(16)
Mvva 160,192,192
ds_read_b64_tr_b16 v[224:225], v12 offset:8192
ds_read_b64_tr_b16 v[226:227], v12 offset:10240
Mvva 160,208,200
Mvva 176,192,196
s_waitcnt lgkmcnt(10)
s_add_u32 m0, s44, 114688
ds_read_b64_tr_b16 v[240:241], v12 offset:12288
ds_read_b64_tr_b16 v[242:243], v12 offset:14336
Mvva 176,208,204
buffer_load_dwordx4 v114, s[12:15], s48 offen offset:0 lds
Mvva 164,196,192
ds_read_b64_tr_b16 v[228:229], v13 offset:8192
ds_read_b64_tr_b16 v[230:231], v13 offset:10240
Mvva 164,212,200
Mvva 180,196,196
s_waitcnt lgkmcnt(10)
ds_read_b64_tr_b16 v[244:245], v13 offset:12288
ds_read_b64_tr_b16 v[246:247], v13 offset:14336
Mvva 180,212,204
buffer_load_dwordx4 v114, s[12:15], s49 offen offset:1024 lds
Mvva 168,200,192
ds_read_b64_tr_b16 v[232:233], v14 offset:8192
ds_read_b64_tr_b16 v[234:235], v14 offset:10240
Mvva 168,216,200
Mvva 184,200,196
s_waitcnt lgkmcnt(10)
ds_read_b64_tr_b16 v[248:249], v14 offset:12288
ds_read_b64_tr_b16 v[250:251], v14 offset:14336
Mvva 184,216,204
buffer_load_dwordx4 v114, s[12:15], s50 offen offset:2048 lds
Mvva 172,204,192
s_waitcnt vmcnt(15)
ds_read_b64_tr_b16 v[236:237], v15 offset:8192
ds_read_b64_tr_b16 v[238:239], v15 offset:10240
Mvva 172,220,200
s_waitcnt lgkmcnt(10)
Mvva 188,204,196
s_barrier
ds_read_b64_tr_b16 v[252:253], v15 offset:12288
ds_read_b64_tr_b16 v[254:255], v15 offset:14336
Mvva 188,220,204
buffer_load_dwordx4 v114, s[12:15], s51 offen offset:3072 lds
v_add_u32_e64 v114, s95, v113
Mvva 128,224,192
ds_read_b64_tr_b16 v[192:193], v12 offset:16384
ds_read_b64_tr_b16 v[194:195], v12 offset:18432
Mvva 128,240,200
Mvva 144,224,196
s_waitcnt lgkmcnt(10)
ds_read_b64_tr_b16 v[208:209], v12 offset:20480
ds_read_b64_tr_b16 v[210:211], v12 offset:22528
Mvva 144,240,204
buffer_load_dwordx4 a[240:243], v112, s[8:11], s52 offen offset:0 sc1
Mvva 132,228,192
ds_read_b64_tr_b16 v[196:197], v13 offset:16384
ds_read_b64_tr_b16 v[198:199], v13 offset:18432
Mvva 132,244,200
Mvva 148,228,196
s_waitcnt lgkmcnt(10)
ds_read_b64_tr_b16 v[212:213], v13 offset:20480
ds_read_b64_tr_b16 v[214:215], v13 offset:22528
Mvva 148,244,204
buffer_load_dwordx4 a[244:247], v112, s[8:11], s52 offen offset:1024 sc1
s_add_u32 s52, s52, 8192
Mvva 136,232,192
ds_read_b64_tr_b16 v[200:201], v14 offset:16384
ds_read_b64_tr_b16 v[202:203], v14 offset:18432
Mvva 136,248,200
Mvva 152,232,196
s_waitcnt lgkmcnt(10)
ds_read_b64_tr_b16 v[216:217], v14 offset:20480
ds_read_b64_tr_b16 v[218:219], v14 offset:22528
Mvva 152,248,204
buffer_load_dwordx4 a[248:251], v112, s[8:11], s52 offen offset:0 sc1
Mvva 140,236,192
ds_read_b64_tr_b16 v[204:205], v15 offset:16384
ds_read_b64_tr_b16 v[206:207], v15 offset:18432
Mvva 140,252,200
Mvva 156,236,196
s_waitcnt lgkmcnt(10)
ds_read_b64_tr_b16 v[220:221], v15 offset:20480
ds_read_b64_tr_b16 v[222:223], v15 offset:22528
Mvva 156,252,204
buffer_load_dwordx4 a[252:255], v112, s[8:11], s52 offen offset:1024 sc1
s_add_u32 s52, s52, 8192
s_waitcnt vmcnt(16)
Mvva 160,192,208
s_add_u32 m0, s44, 0
ds_read_b64_tr_b16 v[224:225], v12 offset:24576
ds_read_b64_tr_b16 v[226:227], v12 offset:26624
Mvva 160,208,216
buffer_load_dwordx4 v114, s[12:15], s48 offen offset:0 lds
Mvva 176,192,212
s_waitcnt lgkmcnt(10)
ds_read_b64_tr_b16 v[240:241], v12 offset:28672
ds_read_b64_tr_b16 v[242:243], v12 offset:30720
Mvva 176,208,220
Mvva 164,196,208
ds_read_b64_tr_b16 v[228:229], v13 offset:24576
ds_read_b64_tr_b16 v[230:231], v13 offset:26624
Mvva 164,212,216
buffer_load_dwordx4 v114, s[12:15], s49 offen offset:1024 lds
Mvva 180,196,212
s_waitcnt lgkmcnt(10)
ds_read_b64_tr_b16 v[244:245], v13 offset:28672
ds_read_b64_tr_b16 v[246:247], v13 offset:30720
Mvva 180,212,220
buffer_load_dwordx4 v114, s[12:15], s50 offen offset:2048 lds
Mvva 168,200,208
ds_read_b64_tr_b16 v[232:233], v14 offset:24576
ds_read_b64_tr_b16 v[234:235], v14 offset:26624
Mvva 168,216,216
buffer_load_dwordx4 v114, s[12:15], s51 offen offset:3072 lds
v_add_u32 v114, 262144, v114
Mvva 184,200,212
s_waitcnt lgkmcnt(10)
ds_read_b64_tr_b16 v[248:249], v14 offset:28672
ds_read_b64_tr_b16 v[250:251], v14 offset:30720
Mvva 184,216,220
Mvva 172,204,208
s_waitcnt vmcnt(16)
ds_read_b64_tr_b16 v[236:237], v15 offset:24576
ds_read_b64_tr_b16 v[238:239], v15 offset:26624
Mvva 172,220,216
s_waitcnt lgkmcnt(10)
buffer_load_dwordx4 a[0:3], v112, s[8:11], s52 offen offset:0 sc1
Mvva 188,204,212
s_barrier
ds_read_b64_tr_b16 v[252:253], v15 offset:28672
ds_read_b64_tr_b16 v[254:255], v15 offset:30720
Mvva 188,220,220
buffer_load_dwordx4 a[4:7], v112, s[8:11], s52 offen offset:1024 sc1
s_add_u32 s52, s52, 8192
Mvva 128,224,208
ds_read_b64_tr_b16 v[192:193], v12 offset:32768
ds_read_b64_tr_b16 v[194:195], v12 offset:34816
Mvva 128,240,216
buffer_load_dwordx4 a[8:11], v112, s[8:11], s52 offen offset:0 sc1
Mvva 144,224,212
s_waitcnt lgkmcnt(10)
ds_read_b64_tr_b16 v[208:209], v12 offset:36864
ds_read_b64_tr_b16 v[210:211], v12 offset:38912
Mvva 144,240,220
Mvva 132,228,208
ds_read_b64_tr_b16 v[196:197], v13 offset:32768
ds_read_b64_tr_b16 v[198:199], v13 offset:34816
Mvva 132,244,216
buffer_load_dwordx4 a[12:15], v112, s[8:11], s52 offen offset:1024 sc1
s_add_u32 s52, s52, 8192
Mvva 148,228,212
s_waitcnt lgkmcnt(10)
ds_read_b64_tr_b16 v[212:213], v13 offset:36864
ds_read_b64_tr_b16 v[214:215], v13 offset:38912
Mvva 148,244,220
buffer_load_dwordx4 a[16:19], v112, s[8:11], s52 offen offset:0 sc1
Mvva 136,232,208
ds_read_b64_tr_b16 v[200:201], v14 offset:32768
ds_read_b64_tr_b16 v[202:203], v14 offset:34816
Mvva 136,248,216
buffer_load_dwordx4 a[20:23], v112, s[8:11], s52 offen offset:1024 sc1
s_add_u32 s52, s52, 8192
Mvva 152,232,212
s_waitcnt lgkmcnt(10)
ds_read_b64_tr_b16 v[216:217], v14 offset:36864
ds_read_b64_tr_b16 v[218:219], v14 offset:38912
Mvva 152,248,220
Mvva 140,236,208
ds_read_b64_tr_b16 v[204:205], v15 offset:32768
ds_read_b64_tr_b16 v[206:207], v15 offset:34816
Mvva 140,252,216
buffer_load_dwordx4 a[24:27], v112, s[8:11], s52 offen offset:0 sc1
Mvva 156,236,212
s_waitcnt lgkmcnt(10)
ds_read_b64_tr_b16 v[220:221], v15 offset:36864
ds_read_b64_tr_b16 v[222:223], v15 offset:38912
Mvva 156,252,220
buffer_load_dwordx4 a[28:31], v112, s[8:11], s52 offen offset:1024 sc1
s_add_u32 s52, s52, 8192
s_waitcnt vmcnt(20)
Mvva 160,192,224
s_add_u32 m0, s44, 16384
ds_read_b64_tr_b16 v[224:225], v12 offset:40960
ds_read_b64_tr_b16 v[226:227], v12 offset:43008
Mvva 160,208,232
buffer_load_dwordx4 v114, s[12:15], s48 offen offset:0 lds
Mvva 176,192,228
s_waitcnt lgkmcnt(10)
ds_read_b64_tr_b16 v[240:241], v12 offset:45056
ds_read_b64_tr_b16 v[242:243], v12 offset:47104
Mvva 176,208,236
Mvva 164,196,224
ds_read_b64_tr_b16 v[228:229], v13 offset:40960
ds_read_b64_tr_b16 v[230:231], v13 offset:43008
Mvva 164,212,232
buffer_load_dwordx4 v114, s[12:15], s49 offen offset:1024 lds
Mvva 180,196,228
s_waitcnt lgkmcnt(10)
ds_read_b64_tr_b16 v[244:245], v13 offset:45056
ds_read_b64_tr_b16 v[246:247], v13 offset:47104
Mvva 180,212,236
buffer_load_dwordx4 v114, s[12:15], s50 offen offset:2048 lds
Mvva 168,200,224
ds_read_b64_tr_b16 v[232:233], v14 offset:40960
ds_read_b64_tr_b16 v[234:235], v14 offset:43008
Mvva 168,216,232
buffer_load_dwordx4 v114, s[12:15], s51 offen offset:3072 lds
v_add_u32 v114, 262144, v114
Mvva 184,200,228
s_waitcnt lgkmcnt(10)
ds_read_b64_tr_b16 v[248:249], v14 offset:45056
ds_read_b64_tr_b16 v[250:251], v14 offset:47104
Mvva 184,216,236
Mvva 172,204,224
s_waitcnt vmcnt(20)
ds_read_b64_tr_b16 v[236:237], v15 offset:40960
ds_read_b64_tr_b16 v[238:239], v15 offset:43008
Mvva 172,220,232
s_waitcnt lgkmcnt(10)
buffer_load_dwordx4 a[32:35], v112, s[8:11], s52 offen offset:0 sc1
Mvva 188,204,228
s_barrier
ds_read_b64_tr_b16 v[252:253], v15 offset:45056
ds_read_b64_tr_b16 v[254:255], v15 offset:47104
Mvva 188,220,236
buffer_load_dwordx4 a[36:39], v112, s[8:11], s52 offen offset:1024 sc1
s_add_u32 s52, s52, 8192
Mvva 128,224,224
ds_read_b64_tr_b16 v[192:193], v12 offset:49152
ds_read_b64_tr_b16 v[194:195], v12 offset:51200
Mvva 128,240,232
buffer_load_dwordx4 a[40:43], v112, s[8:11], s52 offen offset:0 sc1
Mvva 144,224,228
s_waitcnt lgkmcnt(10)
ds_read_b64_tr_b16 v[208:209], v12 offset:53248
ds_read_b64_tr_b16 v[210:211], v12 offset:55296
Mvva 144,240,236
Mvva 132,228,224
ds_read_b64_tr_b16 v[196:197], v13 offset:49152
ds_read_b64_tr_b16 v[198:199], v13 offset:51200
Mvva 132,244,232
buffer_load_dwordx4 a[44:47], v112, s[8:11], s52 offen offset:1024 sc1
s_add_u32 s52, s52, 8192
Mvva 148,228,228
s_waitcnt lgkmcnt(10)
ds_read_b64_tr_b16 v[212:213], v13 offset:53248
ds_read_b64_tr_b16 v[214:215], v13 offset:55296
Mvva 148,244,236
buffer_load_dwordx4 a[48:51], v112, s[8:11], s52 offen offset:0 sc1
Mvva 136,232,224
ds_read_b64_tr_b16 v[200:201], v14 offset:49152
ds_read_b64_tr_b16 v[202:203], v14 offset:51200
Mvva 136,248,232
buffer_load_dwordx4 a[52:55], v112, s[8:11], s52 offen offset:1024 sc1
s_add_u32 s52, s52, 8192
Mvva 152,232,228
s_waitcnt lgkmcnt(10)
ds_read_b64_tr_b16 v[216:217], v14 offset:53248
ds_read_b64_tr_b16 v[218:219], v14 offset:55296
Mvva 152,248,236
Mvva 140,236,224
ds_read_b64_tr_b16 v[204:205], v15 offset:49152
ds_read_b64_tr_b16 v[206:207], v15 offset:51200
Mvva 140,252,232
buffer_load_dwordx4 a[56:59], v112, s[8:11], s52 offen offset:0 sc1
Mvva 156,236,228
s_waitcnt lgkmcnt(10)
ds_read_b64_tr_b16 v[220:221], v15 offset:53248
ds_read_b64_tr_b16 v[222:223], v15 offset:55296
Mvva 156,252,236
buffer_load_dwordx4 a[60:63], v112, s[8:11], s52 offen offset:1024 sc1
s_add_u32 s52, s52, 8192
s_waitcnt vmcnt(24)
Mvva 160,192,240
s_add_u32 m0, s44, 32768
ds_read_b64_tr_b16 v[224:225], v12 offset:57344
ds_read_b64_tr_b16 v[226:227], v12 offset:59392
Mvva 160,208,248
buffer_load_dwordx4 v114, s[12:15], s48 offen offset:0 lds
Mvva 176,192,244
s_waitcnt lgkmcnt(10)
ds_read_b64_tr_b16 v[240:241], v12 offset:61440
ds_read_b64_tr_b16 v[242:243], v12 offset:63488
Mvva 176,208,252
Mvva 164,196,240
ds_read_b64_tr_b16 v[228:229], v13 offset:57344
ds_read_b64_tr_b16 v[230:231], v13 offset:59392
Mvva 164,212,248
buffer_load_dwordx4 v114, s[12:15], s49 offen offset:1024 lds
Mvva 180,196,244
s_waitcnt lgkmcnt(10)
ds_read_b64_tr_b16 v[244:245], v13 offset:61440
ds_read_b64_tr_b16 v[246:247], v13 offset:63488
Mvva 180,212,252
buffer_load_dwordx4 v114, s[12:15], s50 offen offset:2048 lds
Mvva 168,200,240
ds_read_b64_tr_b16 v[232:233], v14 offset:57344
ds_read_b64_tr_b16 v[234:235], v14 offset:59392
Mvva 168,216,248
buffer_load_dwordx4 v114, s[12:15], s51 offen offset:3072 lds
v_add_u32 v114, 262144, v114
Mvva 184,200,244
s_waitcnt lgkmcnt(10)
ds_read_b64_tr_b16 v[248:249], v14 offset:61440
ds_read_b64_tr_b16 v[250:251], v14 offset:63488
Mvva 184,216,252
Mvva 172,204,240
s_waitcnt vmcnt(24)
ds_read_b64_tr_b16 v[236:237], v15 offset:57344
ds_read_b64_tr_b16 v[238:239], v15 offset:59392
Mvva 172,220,248
s_waitcnt lgkmcnt(10)
buffer_load_dwordx4 a[64:67], v112, s[8:11], s52 offen offset:0 sc1
Mvva 188,204,244
s_barrier
ds_read_b64_tr_b16 v[252:253], v15 offset:61440
ds_read_b64_tr_b16 v[254:255], v15 offset:63488
Mvva 188,220,252
buffer_load_dwordx4 a[68:71], v112, s[8:11], s52 offen offset:1024 sc1
s_add_u32 s52, s52, 8192
Mvva 128,224,240
ds_read_b64_tr_b16 v[192:193], v115 offset:0
ds_read_b64_tr_b16 v[194:195], v115 offset:2048
Mvva 128,240,248
buffer_load_dwordx4 a[72:75], v112, s[8:11], s52 offen offset:0 sc1
Mvva 144,224,244
s_waitcnt lgkmcnt(10)
ds_read_b64_tr_b16 v[208:209], v115 offset:4096
ds_read_b64_tr_b16 v[210:211], v115 offset:6144
Mvva 144,240,252
Mvva 132,228,240
ds_read_b64_tr_b16 v[196:197], v116 offset:0
ds_read_b64_tr_b16 v[198:199], v116 offset:2048
Mvva 132,244,248
buffer_load_dwordx4 a[76:79], v112, s[8:11], s52 offen offset:1024 sc1
s_add_u32 s52, s52, 8192
Mvva 148,228,244
s_waitcnt lgkmcnt(10)
ds_read_b64_tr_b16 v[212:213], v116 offset:4096
ds_read_b64_tr_b16 v[214:215], v116 offset:6144
Mvva 148,244,252
buffer_load_dwordx4 a[80:83], v112, s[8:11], s52 offen offset:0 sc1
Mvva 136,232,240
ds_read_b64_tr_b16 v[200:201], v117 offset:0
ds_read_b64_tr_b16 v[202:203], v117 offset:2048
Mvva 136,248,248
buffer_load_dwordx4 a[84:87], v112, s[8:11], s52 offen offset:1024 sc1
s_add_u32 s52, s52, 8192
Mvva 152,232,244
s_waitcnt lgkmcnt(10)
ds_read_b64_tr_b16 v[216:217], v117 offset:4096
ds_read_b64_tr_b16 v[218:219], v117 offset:6144
Mvva 152,248,252
Mvva 140,236,240
ds_read_b64_tr_b16 v[204:205], v118 offset:0
ds_read_b64_tr_b16 v[206:207], v118 offset:2048
Mvva 140,252,248
buffer_load_dwordx4 a[88:91], v112, s[8:11], s52 offen offset:0 sc1
Mvva 156,236,244
s_waitcnt lgkmcnt(10)
ds_read_b64_tr_b16 v[220:221], v118 offset:4096
ds_read_b64_tr_b16 v[222:223], v118 offset:6144
Mvva 156,252,252
buffer_load_dwordx4 a[92:95], v112, s[8:11], s52 offen offset:1024 sc1
s_add_u32 s52, s52, 8192
s_waitcnt vmcnt(28)
Mvva 160,192,0
s_add_u32 m0, s44, 49152
ds_read_b64_tr_b16 v[224:225], v115 offset:8192
ds_read_b64_tr_b16 v[226:227], v115 offset:10240
Mvva 160,208,8
buffer_load_dwordx4 v114, s[12:15], s48 offen offset:0 lds
Mvva 176,192,4
s_waitcnt lgkmcnt(10)
ds_read_b64_tr_b16 v[240:241], v115 offset:12288
ds_read_b64_tr_b16 v[242:243], v115 offset:14336
Mvva 176,208,12
Mvva 164,196,0
ds_read_b64_tr_b16 v[228:229], v116 offset:8192
ds_read_b64_tr_b16 v[230:231], v116 offset:10240
Mvva 164,212,8
buffer_load_dwordx4 v114, s[12:15], s49 offen offset:1024 lds
Mvva 180,196,4
s_waitcnt lgkmcnt(10)
ds_read_b64_tr_b16 v[244:245], v116 offset:12288
ds_read_b64_tr_b16 v[246:247], v116 offset:14336
Mvva 180,212,12
buffer_load_dwordx4 v114, s[12:15], s50 offen offset:2048 lds
Mvva 168,200,0
ds_read_b64_tr_b16 v[232:233], v117 offset:8192
ds_read_b64_tr_b16 v[234:235], v117 offset:10240
Mvva 168,216,8
buffer_load_dwordx4 v114, s[12:15], s51 offen offset:3072 lds
v_add_u32 v114, 262144, v114
Mvva 184,200,4
s_waitcnt lgkmcnt(10)
ds_read_b64_tr_b16 v[248:249], v117 offset:12288
ds_read_b64_tr_b16 v[250:251], v117 offset:14336
Mvva 184,216,12
Mvva 172,204,0
s_waitcnt vmcnt(24)
ds_read_b64_tr_b16 v[236:237], v118 offset:8192
ds_read_b64_tr_b16 v[238:239], v118 offset:10240
Mvva 172,220,8
s_waitcnt lgkmcnt(10)
buffer_load_dwordx4 a[96:99], v112, s[8:11], s52 offen offset:0 sc1
Mvva 188,204,4
s_barrier
ds_read_b64_tr_b16 v[252:253], v118 offset:12288
ds_read_b64_tr_b16 v[254:255], v118 offset:14336
Mvva 188,220,12
buffer_load_dwordx4 a[100:103], v112, s[8:11], s52 offen offset:1024 sc1
s_add_u32 s52, s52, 8192
Mvva 160,224,16
ds_read_b64_tr_b16 v[192:193], v115 offset:16384
ds_read_b64_tr_b16 v[194:195], v115 offset:18432
Mvva 160,240,24
buffer_load_dwordx4 a[104:107], v112, s[8:11], s52 offen offset:0 sc1
Mvva 176,224,20
s_waitcnt lgkmcnt(10)
ds_read_b64_tr_b16 v[208:209], v115 offset:20480
ds_read_b64_tr_b16 v[210:211], v115 offset:22528
Mvva 176,240,28
Mvva 164,228,16
ds_read_b64_tr_b16 v[196:197], v116 offset:16384
ds_read_b64_tr_b16 v[198:199], v116 offset:18432
Mvva 164,244,24
buffer_load_dwordx4 a[108:111], v112, s[8:11], s52 offen offset:1024 sc1
s_add_u32 s52, s52, 8192
Mvva 180,228,20
s_waitcnt lgkmcnt(10)
ds_read_b64_tr_b16 v[212:213], v116 offset:20480
ds_read_b64_tr_b16 v[214:215], v116 offset:22528
Mvva 180,244,28
buffer_load_dwordx4 a[112:115], v112, s[8:11], s52 offen offset:0 sc1
Mvva 168,232,16
ds_read_b64_tr_b16 v[200:201], v117 offset:16384
ds_read_b64_tr_b16 v[202:203], v117 offset:18432
Mvva 168,248,24
buffer_load_dwordx4 a[116:119], v112, s[8:11], s52 offen offset:1024 sc1
s_add_u32 s52, s52, 8192
Mvva 184,232,20
s_waitcnt lgkmcnt(10)
ds_read_b64_tr_b16 v[216:217], v117 offset:20480
ds_read_b64_tr_b16 v[218:219], v117 offset:22528
Mvva 184,248,28
Mvva 172,236,16
ds_read_b64_tr_b16 v[204:205], v118 offset:16384
ds_read_b64_tr_b16 v[206:207], v118 offset:18432
Mvva 172,252,24
buffer_load_dwordx4 a[120:123], v112, s[8:11], s52 offen offset:0 sc1
Mvva 188,236,20
s_waitcnt lgkmcnt(10)
ds_read_b64_tr_b16 v[220:221], v118 offset:20480
ds_read_b64_tr_b16 v[222:223], v118 offset:22528
Mvva 188,252,28
buffer_load_dwordx4 a[124:127], v112, s[8:11], s52 offen offset:1024 sc1
s_add_u32 s52, s52, 8192
s_waitcnt vmcnt(28)
Mvva 160,192,32
s_add_u32 m0, s44, 65536
ds_read_b64_tr_b16 v[224:225], v115 offset:24576
ds_read_b64_tr_b16 v[226:227], v115 offset:26624
Mvva 160,208,40
buffer_load_dwordx4 v114, s[12:15], s48 offen offset:0 lds
Mvva 176,192,36
s_waitcnt lgkmcnt(10)
ds_read_b64_tr_b16 v[240:241], v115 offset:28672
ds_read_b64_tr_b16 v[242:243], v115 offset:30720
Mvva 176,208,44
Mvva 164,196,32
ds_read_b64_tr_b16 v[228:229], v116 offset:24576
ds_read_b64_tr_b16 v[230:231], v116 offset:26624
Mvva 164,212,40
buffer_load_dwordx4 v114, s[12:15], s49 offen offset:1024 lds
Mvva 180,196,36
s_waitcnt lgkmcnt(10)
ds_read_b64_tr_b16 v[244:245], v116 offset:28672
ds_read_b64_tr_b16 v[246:247], v116 offset:30720
Mvva 180,212,44
buffer_load_dwordx4 v114, s[12:15], s50 offen offset:2048 lds
Mvva 168,200,32
ds_read_b64_tr_b16 v[232:233], v117 offset:24576
ds_read_b64_tr_b16 v[234:235], v117 offset:26624
Mvva 168,216,40
buffer_load_dwordx4 v114, s[12:15], s51 offen offset:3072 lds
v_add_u32 v114, 262144, v114
Mvva 184,200,36
s_waitcnt lgkmcnt(10)
ds_read_b64_tr_b16 v[248:249], v117 offset:28672
ds_read_b64_tr_b16 v[250:251], v117 offset:30720
Mvva 184,216,44
Mvva 172,204,32
s_waitcnt vmcnt(24)
ds_read_b64_tr_b16 v[236:237], v118 offset:24576
ds_read_b64_tr_b16 v[238:239], v118 offset:26624
Mvva 172,220,40
s_waitcnt lgkmcnt(10)
buffer_load_dwordx4 a[128:131], v112, s[8:11], s52 offen offset:0 sc1
Mvva 188,204,36
s_barrier
ds_read_b64_tr_b16 v[252:253], v118 offset:28672
ds_read_b64_tr_b16 v[254:255], v118 offset:30720
Mvva 188,220,44
buffer_load_dwordx4 a[132:135], v112, s[8:11], s52 offen offset:1024 sc1
s_add_u32 s52, s52, 8192
Mvva 160,224,48
ds_read_b64_tr_b16 v[192:193], v115 offset:32768
ds_read_b64_tr_b16 v[194:195], v115 offset:34816
Mvva 160,240,56
buffer_load_dwordx4 a[136:139], v112, s[8:11], s52 offen offset:0 sc1
Mvva 176,224,52
s_waitcnt lgkmcnt(10)
ds_read_b64_tr_b16 v[208:209], v115 offset:36864
ds_read_b64_tr_b16 v[210:211], v115 offset:38912
Mvva 176,240,60
Mvva 164,228,48
ds_read_b64_tr_b16 v[196:197], v116 offset:32768
ds_read_b64_tr_b16 v[198:199], v116 offset:34816
Mvva 164,244,56
buffer_load_dwordx4 a[140:143], v112, s[8:11], s52 offen offset:1024 sc1
s_add_u32 s52, s52, 8192
Mvva 180,228,52
s_waitcnt lgkmcnt(10)
ds_read_b64_tr_b16 v[212:213], v116 offset:36864
ds_read_b64_tr_b16 v[214:215], v116 offset:38912
Mvva 180,244,60
buffer_load_dwordx4 a[144:147], v112, s[8:11], s52 offen offset:0 sc1
Mvva 168,232,48
ds_read_b64_tr_b16 v[200:201], v117 offset:32768
ds_read_b64_tr_b16 v[202:203], v117 offset:34816
Mvva 168,248,56
buffer_load_dwordx4 a[148:151], v112, s[8:11], s52 offen offset:1024 sc1
s_add_u32 s52, s52, 8192
Mvva 184,232,52
s_waitcnt lgkmcnt(10)
ds_read_b64_tr_b16 v[216:217], v117 offset:36864
ds_read_b64_tr_b16 v[218:219], v117 offset:38912
Mvva 184,248,60
Mvva 172,236,48
ds_read_b64_tr_b16 v[204:205], v118 offset:32768
ds_read_b64_tr_b16 v[206:207], v118 offset:34816
Mvva 172,252,56
buffer_load_dwordx4 a[152:155], v112, s[8:11], s52 offen offset:0 sc1
Mvva 188,236,52
s_waitcnt lgkmcnt(10)
ds_read_b64_tr_b16 v[220:221], v118 offset:36864
ds_read_b64_tr_b16 v[222:223], v118 offset:38912
Mvva 188,252,60
buffer_load_dwordx4 a[156:159], v112, s[8:11], s52 offen offset:1024 sc1
s_add_u32 s52, s52, 8192
s_waitcnt vmcnt(28)
Mvva 160,192,64
s_add_u32 m0, s44, 81920
ds_read_b64_tr_b16 v[224:225], v115 offset:40960
ds_read_b64_tr_b16 v[226:227], v115 offset:43008
Mvva 160,208,72
buffer_load_dwordx4 v114, s[12:15], s48 offen offset:0 lds
Mvva 176,192,68
s_waitcnt lgkmcnt(10)
ds_read_b64_tr_b16 v[240:241], v115 offset:45056
ds_read_b64_tr_b16 v[242:243], v115 offset:47104
Mvva 176,208,76
Mvva 164,196,64
ds_read_b64_tr_b16 v[228:229], v116 offset:40960
ds_read_b64_tr_b16 v[230:231], v116 offset:43008
Mvva 164,212,72
buffer_load_dwordx4 v114, s[12:15], s49 offen offset:1024 lds
Mvva 180,196,68
s_waitcnt lgkmcnt(10)
ds_read_b64_tr_b16 v[244:245], v116 offset:45056
ds_read_b64_tr_b16 v[246:247], v116 offset:47104
Mvva 180,212,76
buffer_load_dwordx4 v114, s[12:15], s50 offen offset:2048 lds
Mvva 168,200,64
ds_read_b64_tr_b16 v[232:233], v117 offset:40960
ds_read_b64_tr_b16 v[234:235], v117 offset:43008
Mvva 168,216,72
buffer_load_dwordx4 v114, s[12:15], s51 offen offset:3072 lds
v_add_u32 v114, 262144, v114
Mvva 184,200,68
s_waitcnt lgkmcnt(10)
ds_read_b64_tr_b16 v[248:249], v117 offset:45056
ds_read_b64_tr_b16 v[250:251], v117 offset:47104
Mvva 184,216,76
Mvva 172,204,64
s_waitcnt vmcnt(24)
ds_read_b64_tr_b16 v[236:237], v118 offset:40960
ds_read_b64_tr_b16 v[238:239], v118 offset:43008
Mvva 172,220,72
s_waitcnt lgkmcnt(10)
buffer_load_dwordx4 a[160:163], v112, s[8:11], s52 offen offset:0 sc1
Mvva 188,204,68
s_barrier
ds_read_b64_tr_b16 v[252:253], v118 offset:45056
ds_read_b64_tr_b16 v[254:255], v118 offset:47104
Mvva 188,220,76
buffer_load_dwordx4 a[164:167], v112, s[8:11], s52 offen offset:1024 sc1
s_add_u32 s52, s52, 8192
Mvva 160,224,80
ds_read_b64_tr_b16 v[192:193], v115 offset:49152
ds_read_b64_tr_b16 v[194:195], v115 offset:51200
Mvva 160,240,88
buffer_load_dwordx4 a[168:171], v112, s[8:11], s52 offen offset:0 sc1
Mvva 176,224,84
s_waitcnt lgkmcnt(10)
ds_read_b64_tr_b16 v[208:209], v115 offset:53248
ds_read_b64_tr_b16 v[210:211], v115 offset:55296
Mvva 176,240,92
Mvva 164,228,80
ds_read_b64_tr_b16 v[196:197], v116 offset:49152
ds_read_b64_tr_b16 v[198:199], v116 offset:51200
Mvva 164,244,88
buffer_load_dwordx4 a[172:175], v112, s[8:11], s52 offen offset:1024 sc1
s_add_u32 s52, s52, 8192
Mvva 180,228,84
s_waitcnt lgkmcnt(10)
ds_read_b64_tr_b16 v[212:213], v116 offset:53248
ds_read_b64_tr_b16 v[214:215], v116 offset:55296
Mvva 180,244,92
buffer_load_dwordx4 a[176:179], v112, s[8:11], s52 offen offset:0 sc1
Mvva 168,232,80
ds_read_b64_tr_b16 v[200:201], v117 offset:49152
ds_read_b64_tr_b16 v[202:203], v117 offset:51200
Mvva 168,248,88
buffer_load_dwordx4 a[180:183], v112, s[8:11], s52 offen offset:1024 sc1
s_add_u32 s52, s52, 8192
Mvva 184,232,84
s_waitcnt lgkmcnt(10)
ds_read_b64_tr_b16 v[216:217], v117 offset:53248
ds_read_b64_tr_b16 v[218:219], v117 offset:55296
Mvva 184,248,92
Mvva 172,236,80
ds_read_b64_tr_b16 v[204:205], v118 offset:49152
ds_read_b64_tr_b16 v[206:207], v118 offset:51200
Mvva 172,252,88
buffer_load_dwordx4 a[184:187], v112, s[8:11], s52 offen offset:0 sc1
Mvva 188,236,84
s_waitcnt lgkmcnt(10)
ds_read_b64_tr_b16 v[220:221], v118 offset:53248
ds_read_b64_tr_b16 v[222:223], v118 offset:55296
Mvva 188,252,92
buffer_load_dwordx4 a[188:191], v112, s[8:11], s52 offen offset:1024 sc1
s_add_u32 s52, s52, 8192
s_waitcnt vmcnt(28)
Mvva 160,192,96
s_add_u32 m0, s44, 98304
ds_read_b64_tr_b16 v[224:225], v115 offset:57344
ds_read_b64_tr_b16 v[226:227], v115 offset:59392
Mvva 160,208,104
buffer_load_dwordx4 v114, s[12:15], s48 offen offset:0 lds
Mvva 176,192,100
s_waitcnt lgkmcnt(10)
ds_read_b64_tr_b16 v[240:241], v115 offset:61440
ds_read_b64_tr_b16 v[242:243], v115 offset:63488
Mvva 176,208,108
s_cmp_lg_u32 s53, 0
s_cbranch_scc1 L_yA
L_yAr:
Mvva 164,196,96
ds_read_b64_tr_b16 v[228:229], v116 offset:57344
ds_read_b64_tr_b16 v[230:231], v116 offset:59392
Mvva 164,212,104
buffer_load_dwordx4 v114, s[12:15], s49 offen offset:1024 lds
Mvva 180,196,100
s_waitcnt lgkmcnt(10)
ds_read_b64_tr_b16 v[244:245], v116 offset:61440
ds_read_b64_tr_b16 v[246:247], v116 offset:63488
Mvva 180,212,108
buffer_load_dwordx4 v114, s[12:15], s50 offen offset:2048 lds
Mvva 168,200,96
ds_read_b64_tr_b16 v[232:233], v117 offset:57344
ds_read_b64_tr_b16 v[234:235], v117 offset:59392
Mvva 168,216,104
buffer_load_dwordx4 v114, s[12:15], s51 offen offset:3072 lds
v_add_u32 v114, 262144, v114
Mvva 184,200,100
s_waitcnt lgkmcnt(10)
ds_read_b64_tr_b16 v[248:249], v117 offset:61440
ds_read_b64_tr_b16 v[250:251], v117 offset:63488
Mvva 184,216,108
Mvva 172,204,96
s_waitcnt vmcnt(24)
ds_read_b64_tr_b16 v[236:237], v118 offset:57344
ds_read_b64_tr_b16 v[238:239], v118 offset:59392
Mvva 172,220,104
s_waitcnt lgkmcnt(10)
buffer_load_dwordx4 a[192:195], v112, s[8:11], s52 offen offset:0 sc1
Mvva 188,204,100
s_barrier
ds_read_b64_tr_b16 v[252:253], v118 offset:61440
ds_read_b64_tr_b16 v[254:255], v118 offset:63488
Mvva 188,220,108
buffer_load_dwordx4 a[196:199], v112, s[8:11], s52 offen offset:1024 sc1
s_add_u32 s52, s52, 8192
Mvva 160,224,112
ds_read_b64_tr_b16 v[192:193], v12 offset:0
ds_read_b64_tr_b16 v[194:195], v12 offset:2048
Mvva 160,240,120
buffer_load_dwordx4 a[200:203], v112, s[8:11], s52 offen offset:0 sc1
Mvva 176,224,116
s_waitcnt lgkmcnt(10)
ds_read_b64_tr_b16 v[208:209], v12 offset:4096
ds_read_b64_tr_b16 v[210:211], v12 offset:6144
Mvva 176,240,124
Mvva 164,228,112
ds_read_b64_tr_b16 v[196:197], v13 offset:0
ds_read_b64_tr_b16 v[198:199], v13 offset:2048
Mvva 164,244,120
buffer_load_dwordx4 a[204:207], v112, s[8:11], s52 offen offset:1024 sc1
s_add_u32 s52, s52, 8192
Mvva 180,228,116
s_waitcnt lgkmcnt(10)
ds_read_b64_tr_b16 v[212:213], v13 offset:4096
ds_read_b64_tr_b16 v[214:215], v13 offset:6144
Mvva 180,244,124
buffer_load_dwordx4 a[208:211], v112, s[8:11], s52 offen offset:0 sc1
Mvva 168,232,112
ds_read_b64_tr_b16 v[200:201], v14 offset:0
ds_read_b64_tr_b16 v[202:203], v14 offset:2048
Mvva 168,248,120
buffer_load_dwordx4 a[212:215], v112, s[8:11], s52 offen offset:1024 sc1
s_add_u32 s52, s52, 8192
Mvva 184,232,116
s_waitcnt lgkmcnt(10)
ds_read_b64_tr_b16 v[216:217], v14 offset:4096
ds_read_b64_tr_b16 v[218:219], v14 offset:6144
Mvva 184,248,124
Mvva 172,236,112
ds_read_b64_tr_b16 v[204:205], v15 offset:0
ds_read_b64_tr_b16 v[206:207], v15 offset:2048
Mvva 172,252,120
buffer_load_dwordx4 a[216:219], v112, s[8:11], s52 offen offset:0 sc1
Mvva 188,236,116
s_waitcnt lgkmcnt(10)
ds_read_b64_tr_b16 v[220:221], v15 offset:4096
ds_read_b64_tr_b16 v[222:223], v15 offset:6144
Mvva 188,252,124
buffer_load_dwordx4 a[220:223], v112, s[8:11], s52 offen offset:1024 sc1
s_add_u32 s52, s52, 8192
s_waitcnt vmcnt(28)
Mvva 160,192,128
s_add_u32 m0, s44, 114688
ds_read_b64_tr_b16 v[224:225], v12 offset:8192
ds_read_b64_tr_b16 v[226:227], v12 offset:10240
Mvva 160,208,136
buffer_load_dwordx4 v114, s[12:15], s48 offen offset:0 lds
Mvva 176,192,132
s_waitcnt lgkmcnt(10)
ds_read_b64_tr_b16 v[240:241], v12 offset:12288
ds_read_b64_tr_b16 v[242:243], v12 offset:14336
Mvva 176,208,140
Mvva 164,196,128
ds_read_b64_tr_b16 v[228:229], v13 offset:8192
ds_read_b64_tr_b16 v[230:231], v13 offset:10240
Mvva 164,212,136
buffer_load_dwordx4 v114, s[12:15], s49 offen offset:1024 lds
Mvva 180,196,132
s_waitcnt lgkmcnt(10)
ds_read_b64_tr_b16 v[244:245], v13 offset:12288
ds_read_b64_tr_b16 v[246:247], v13 offset:14336
Mvva 180,212,140
buffer_load_dwordx4 v114, s[12:15], s50 offen offset:2048 lds
Mvva 168,200,128
ds_read_b64_tr_b16 v[232:233], v14 offset:8192
ds_read_b64_tr_b16 v[234:235], v14 offset:10240
Mvva 168,216,136
buffer_load_dwordx4 v114, s[12:15], s51 offen offset:3072 lds
s_xor_b32 s95, s95, 128
v_add_u32 v114, s95, v113
Mvva 184,200,132
s_waitcnt lgkmcnt(10)
ds_read_b64_tr_b16 v[248:249], v14 offset:12288
ds_read_b64_tr_b16 v[250:251], v14 offset:14336
Mvva 184,216,140
Mvva 172,204,128
s_waitcnt vmcnt(24)
ds_read_b64_tr_b16 v[236:237], v15 offset:8192
ds_read_b64_tr_b16 v[238:239], v15 offset:10240
Mvva 172,220,136
s_waitcnt lgkmcnt(10)
buffer_load_dwordx4 a[224:227], v112, s[8:11], s52 offen offset:0 sc1
Mvva 188,204,132
s_barrier
ds_read_b64_tr_b16 v[252:253], v15 offset:12288
ds_read_b64_tr_b16 v[254:255], v15 offset:14336
Mvva 188,220,140
buffer_load_dwordx4 a[228:231], v112, s[8:11], s52 offen offset:1024 sc1
s_add_u32 s52, s52, 8192
Mvva 160,224,144
ds_read_b64_tr_b16 v[192:193], v12 offset:16384
ds_read_b64_tr_b16 v[194:195], v12 offset:18432
Mvva 160,240,152
buffer_load_dwordx4 a[232:235], v112, s[8:11], s52 offen offset:0 sc1
Mvva 176,224,148
s_waitcnt lgkmcnt(10)
ds_read_b64_tr_b16 v[208:209], v12 offset:20480
ds_read_b64_tr_b16 v[210:211], v12 offset:22528
Mvva 176,240,156
Mvva 164,228,144
ds_read_b64_tr_b16 v[196:197], v13 offset:16384
ds_read_b64_tr_b16 v[198:199], v13 offset:18432
Mvva 164,244,152
buffer_load_dwordx4 a[236:239], v112, s[8:11], s52 offen offset:1024 sc1
s_add_u32 s52, s52, 8192
Mvva 180,228,148
s_waitcnt lgkmcnt(10)
ds_read_b64_tr_b16 v[212:213], v13 offset:20480
ds_read_b64_tr_b16 v[214:215], v13 offset:22528
Mvva 180,244,156
buffer_load_dwordx4 a[240:243], v112, s[8:11], s52 offen offset:0 sc1
Mvva 168,232,144
ds_read_b64_tr_b16 v[200:201], v14 offset:16384
ds_read_b64_tr_b16 v[202:203], v14 offset:18432
Mvva 168,248,152
buffer_load_dwordx4 a[244:247], v112, s[8:11], s52 offen offset:1024 sc1
s_add_u32 s52, s52, 8192
Mvva 184,232,148
s_waitcnt lgkmcnt(10)
ds_read_b64_tr_b16 v[216:217], v14 offset:20480
ds_read_b64_tr_b16 v[218:219], v14 offset:22528
Mvva 184,248,156
Mvva 172,236,144
ds_read_b64_tr_b16 v[204:205], v15 offset:16384
ds_read_b64_tr_b16 v[206:207], v15 offset:18432
Mvva 172,252,152
buffer_load_dwordx4 a[248:251], v112, s[8:11], s52 offen offset:0 sc1
Mvva 188,236,148
s_waitcnt lgkmcnt(10)
ds_read_b64_tr_b16 v[220:221], v15 offset:20480
ds_read_b64_tr_b16 v[222:223], v15 offset:22528
Mvva 188,252,156
buffer_load_dwordx4 a[252:255], v112, s[8:11], s52 offen offset:1024 sc1
s_add_u32 s52, s52, 8192
s_waitcnt vmcnt(28)
Mvva 160,192,160
s_add_u32 m0, s44, 0
ds_read_b64_tr_b16 v[224:225], v12 offset:24576
ds_read_b64_tr_b16 v[226:227], v12 offset:26624
Mvva 160,208,168
buffer_load_dwordx4 v114, s[12:15], s48 offen offset:0 lds
Mvva 176,192,164
s_waitcnt lgkmcnt(10)
ds_read_b64_tr_b16 v[240:241], v12 offset:28672
ds_read_b64_tr_b16 v[242:243], v12 offset:30720
Mvva 176,208,172
Mvva 164,196,160
ds_read_b64_tr_b16 v[228:229], v13 offset:24576
ds_read_b64_tr_b16 v[230:231], v13 offset:26624
Mvva 164,212,168
buffer_load_dwordx4 v114, s[12:15], s49 offen offset:1024 lds
Mvva 180,196,164
s_waitcnt lgkmcnt(10)
ds_read_b64_tr_b16 v[244:245], v13 offset:28672
ds_read_b64_tr_b16 v[246:247], v13 offset:30720
Mvva 180,212,172
buffer_load_dwordx4 v114, s[12:15], s50 offen offset:2048 lds
Mvva 168,200,160
ds_read_b64_tr_b16 v[232:233], v14 offset:24576
ds_read_b64_tr_b16 v[234:235], v14 offset:26624
Mvva 168,216,168
buffer_load_dwordx4 v114, s[12:15], s51 offen offset:3072 lds
v_add_u32 v114, 262144, v114
Mvva 184,200,164
s_waitcnt lgkmcnt(10)
ds_read_b64_tr_b16 v[248:249], v14 offset:28672
ds_read_b64_tr_b16 v[250:251], v14 offset:30720
Mvva 184,216,172
Mvva 172,204,160
s_waitcnt vmcnt(24)
s_add_u32 m0, s44, 16384
ds_read_b64_tr_b16 v[236:237], v15 offset:24576
ds_read_b64_tr_b16 v[238:239], v15 offset:26624
Mvva 172,220,168
s_waitcnt lgkmcnt(10)
buffer_load_dwordx4 v114, s[12:15], s48 offen offset:0 lds
Mvva 188,204,164
s_barrier
ds_read_b64_tr_b16 v[252:253], v15 offset:28672
ds_read_b64_tr_b16 v[254:255], v15 offset:30720
Mvva 188,220,172
buffer_load_dwordx4 v114, s[12:15], s49 offen offset:1024 lds
Mvva 160,224,176
ds_read_b64_tr_b16 v[192:193], v12 offset:32768
ds_read_b64_tr_b16 v[194:195], v12 offset:34816
Mvva 160,240,184
buffer_load_dwordx4 v114, s[12:15], s50 offen offset:2048 lds
Mvva 176,224,180
s_waitcnt lgkmcnt(10)
ds_read_b64_tr_b16 v[208:209], v12 offset:36864
ds_read_b64_tr_b16 v[210:211], v12 offset:38912
Mvva 176,240,188
s_cmp_lg_u32 s53, 0
s_cbranch_scc1 L_yB
L_yBr:
Mvva 164,228,176
ds_read_b64_tr_b16 v[196:197], v13 offset:32768
ds_read_b64_tr_b16 v[198:199], v13 offset:34816
Mvva 164,244,184
buffer_load_dwordx4 v114, s[12:15], s51 offen offset:3072 lds
v_add_u32 v114, 262144, v114
Mvva 180,228,180
s_waitcnt lgkmcnt(10)
s_add_u32 m0, s44, 32768
ds_read_b64_tr_b16 v[212:213], v13 offset:36864
ds_read_b64_tr_b16 v[214:215], v13 offset:38912
Mvva 180,244,188
buffer_load_dwordx4 v114, s[12:15], s48 offen offset:0 lds
Mvva 168,232,176
ds_read_b64_tr_b16 v[200:201], v14 offset:32768
ds_read_b64_tr_b16 v[202:203], v14 offset:34816
Mvva 168,248,184
buffer_load_dwordx4 v114, s[12:15], s49 offen offset:1024 lds
Mvva 184,232,180
s_waitcnt lgkmcnt(10)
ds_read_b64_tr_b16 v[216:217], v14 offset:36864
ds_read_b64_tr_b16 v[218:219], v14 offset:38912
Mvva 184,248,188
Mvva 172,236,176
ds_read_b64_tr_b16 v[204:205], v15 offset:32768
ds_read_b64_tr_b16 v[206:207], v15 offset:34816
Mvva 172,252,184
buffer_load_dwordx4 v114, s[12:15], s50 offen offset:2048 lds
Mvva 188,236,180
s_waitcnt lgkmcnt(10)
ds_read_b64_tr_b16 v[220:221], v15 offset:36864
ds_read_b64_tr_b16 v[222:223], v15 offset:38912
Mvva 188,252,188
buffer_load_dwordx4 v114, s[12:15], s51 offen offset:3072 lds
v_add_u32 v114, 262144, v114
s_waitcnt vmcnt(28)
Mvva 160,192,192
ds_read_b64_tr_b16 v[224:225], v12 offset:40960
ds_read_b64_tr_b16 v[226:227], v12 offset:43008
Mvva 160,208,200
Mvva 176,192,196
s_waitcnt lgkmcnt(10)
s_add_u32 m0, s44, 49152
ds_read_b64_tr_b16 v[240:241], v12 offset:45056
ds_read_b64_tr_b16 v[242:243], v12 offset:47104
Mvva 176,208,204
buffer_load_dwordx4 v114, s[12:15], s48 offen offset:0 lds
Mvva 164,196,192
ds_read_b64_tr_b16 v[228:229], v13 offset:40960
ds_read_b64_tr_b16 v[230:231], v13 offset:43008
Mvva 164,212,200
Mvva 180,196,196
s_waitcnt lgkmcnt(10)
ds_read_b64_tr_b16 v[244:245], v13 offset:45056
ds_read_b64_tr_b16 v[246:247], v13 offset:47104
Mvva 180,212,204
buffer_load_dwordx4 v114, s[12:15], s49 offen offset:1024 lds
Mvva 168,200,192
ds_read_b64_tr_b16 v[232:233], v14 offset:40960
ds_read_b64_tr_b16 v[234:235], v14 offset:43008
Mvva 168,216,200
Mvva 184,200,196
s_waitcnt lgkmcnt(10)
ds_read_b64_tr_b16 v[248:249], v14 offset:45056
ds_read_b64_tr_b16 v[250:251], v14 offset:47104
Mvva 184,216,204
buffer_load_dwordx4 v114, s[12:15], s50 offen offset:2048 lds
Mvva 172,204,192
s_waitcnt vmcnt(23)
ds_read_b64_tr_b16 v[236:237], v15 offset:40960
ds_read_b64_tr_b16 v[238:239], v15 offset:43008
Mvva 172,220,200
s_waitcnt lgkmcnt(10)
Mvva 188,204,196
s_barrier
ds_read_b64_tr_b16 v[252:253], v15 offset:45056
ds_read_b64_tr_b16 v[254:255], v15 offset:47104
Mvva 188,220,204
buffer_load_dwordx4 v114, s[12:15], s51 offen offset:3072 lds
v_add_u32 v114, 262144, v114
Mvva 160,224,208
ds_read_b64_tr_b16 v[192:193], v12 offset:49152
ds_read_b64_tr_b16 v[194:195], v12 offset:51200
Mvva 160,240,216
Mvva 176,224,212
s_waitcnt lgkmcnt(10)
s_add_u32 m0, s44, 65536
ds_read_b64_tr_b16 v[208:209], v12 offset:53248
ds_read_b64_tr_b16 v[210:211], v12 offset:55296
Mvva 176,240,220
buffer_load_dwordx4 v114, s[12:15], s48 offen offset:0 lds
Mvva 164,228,208
ds_read_b64_tr_b16 v[196:197], v13 offset:49152
ds_read_b64_tr_b16 v[198:199], v13 offset:51200
Mvva 164,244,216
Mvva 180,228,212
s_waitcnt lgkmcnt(10)
ds_read_b64_tr_b16 v[212:213], v13 offset:53248
ds_read_b64_tr_b16 v[214:215], v13 offset:55296
Mvva 180,244,220
buffer_load_dwordx4 v114, s[12:15], s49 offen offset:1024 lds
Mvva 168,232,208
ds_read_b64_tr_b16 v[200:201], v14 offset:49152
ds_read_b64_tr_b16 v[202:203], v14 offset:51200
Mvva 168,248,216
Mvva 184,232,212
s_waitcnt lgkmcnt(10)
ds_read_b64_tr_b16 v[216:217], v14 offset:53248
ds_read_b64_tr_b16 v[218:219], v14 offset:55296
Mvva 184,248,220
buffer_load_dwordx4 v114, s[12:15], s50 offen offset:2048 lds
Mvva 172,236,208
ds_read_b64_tr_b16 v[204:205], v15 offset:49152
ds_read_b64_tr_b16 v[206:207], v15 offset:51200
Mvva 172,252,216
Mvva 188,236,212
s_waitcnt lgkmcnt(10)
ds_read_b64_tr_b16 v[220:221], v15 offset:53248
ds_read_b64_tr_b16 v[222:223], v15 offset:55296
Mvva 188,252,220
buffer_load_dwordx4 v114, s[12:15], s51 offen offset:3072 lds
v_add_u32 v114, 262144, v114
s_waitcnt vmcnt(24)
Mvva 160,192,224
ds_read_b64_tr_b16 v[224:225], v12 offset:57344
ds_read_b64_tr_b16 v[226:227], v12 offset:59392
Mvva 160,208,232
Mvva 176,192,228
s_waitcnt lgkmcnt(10)
ds_read_b64_tr_b16 v[240:241], v12 offset:61440
ds_read_b64_tr_b16 v[242:243], v12 offset:63488
Mvva 176,208,236
Mvva 164,196,224
s_add_u32 m0, s44, 81920
ds_read_b64_tr_b16 v[228:229], v13 offset:57344
ds_read_b64_tr_b16 v[230:231], v13 offset:59392
Mvva 164,212,232
buffer_load_dwordx4 v114, s[12:15], s48 offen offset:0 lds
Mvva 180,196,228
s_waitcnt lgkmcnt(10)
ds_read_b64_tr_b16 v[244:245], v13 offset:61440
ds_read_b64_tr_b16 v[246:247], v13 offset:63488
Mvva 180,212,236
Mvva 168,200,224
ds_read_b64_tr_b16 v[232:233], v14 offset:57344
ds_read_b64_tr_b16 v[234:235], v14 offset:59392
Mvva 168,216,232
Mvva 184,200,228
s_waitcnt lgkmcnt(10)
ds_read_b64_tr_b16 v[248:249], v14 offset:61440
ds_read_b64_tr_b16 v[250:251], v14 offset:63488
Mvva 184,216,236
Mvva 172,204,224
s_waitcnt vmcnt(17)
ds_read_b64_tr_b16 v[236:237], v15 offset:57344
ds_read_b64_tr_b16 v[238:239], v15 offset:59392
Mvva 172,220,232
s_waitcnt lgkmcnt(10)
buffer_load_dwordx4 v114, s[12:15], s49 offen offset:1024 lds
Mvva 188,204,228
s_barrier
ds_read_b64_tr_b16 v[252:253], v15 offset:61440
ds_read_b64_tr_b16 v[254:255], v15 offset:63488
Mvva 188,220,236
Mvva 160,224,240
ds_read_b64_tr_b16 v[192:193], v115 offset:0
ds_read_b64_tr_b16 v[194:195], v115 offset:2048
Mvva 160,240,248
s_cmp_lg_u32 s40, 0
s_cbranch_scc1 L_yC
L_yCr:
Mvva 176,224,244
s_waitcnt lgkmcnt(10)
ds_read_b64_tr_b16 v[208:209], v115 offset:4096
ds_read_b64_tr_b16 v[210:211], v115 offset:6144
Mvva 176,240,252
Mvva 164,228,240
ds_read_b64_tr_b16 v[196:197], v116 offset:0
ds_read_b64_tr_b16 v[198:199], v116 offset:2048
Mvva 164,244,248
buffer_load_dwordx4 v114, s[12:15], s50 offen offset:2048 lds
Mvva 180,228,244
s_waitcnt lgkmcnt(10)
ds_read_b64_tr_b16 v[212:213], v116 offset:4096
ds_read_b64_tr_b16 v[214:215], v116 offset:6144
Mvva 180,244,252
Mvva 168,232,240
ds_read_b64_tr_b16 v[200:201], v117 offset:0
ds_read_b64_tr_b16 v[202:203], v117 offset:2048
Mvva 168,248,248
Mvva 184,232,244
s_waitcnt lgkmcnt(10)
ds_read_b64_tr_b16 v[216:217], v117 offset:4096
ds_read_b64_tr_b16 v[218:219], v117 offset:6144
Mvva 184,248,252
Mvva 172,236,240
ds_read_b64_tr_b16 v[204:205], v118 offset:0
ds_read_b64_tr_b16 v[206:207], v118 offset:2048
Mvva 172,252,248
buffer_load_dwordx4 v114, s[12:15], s51 offen offset:3072 lds
v_add_u32 v114, 262144, v114
Mvva 188,236,244
s_waitcnt lgkmcnt(10)
ds_read_b64_tr_b16 v[220:221], v118 offset:4096
ds_read_b64_tr_b16 v[222:223], v118 offset:6144
Mvva 188,252,252
Mvva 128,192,0
ds_read_b64_tr_b16 v[224:225], v115 offset:8192
ds_read_b64_tr_b16 v[226:227], v115 offset:10240
Mvva 128,208,8
Mvva 144,192,4
s_waitcnt lgkmcnt(10)
ds_read_b64_tr_b16 v[240:241], v115 offset:12288
ds_read_b64_tr_b16 v[242:243], v115 offset:14336
Mvva 144,208,12
Mvva 132,196,0
s_add_u32 m0, s44, 98304
ds_read_b64_tr_b16 v[228:229], v116 offset:8192
ds_read_b64_tr_b16 v[230:231], v116 offset:10240
Mvva 132,212,8
buffer_load_dwordx4 v114, s[12:15], s48 offen offset:0 lds
Mvva 148,196,4
s_waitcnt lgkmcnt(10)
ds_read_b64_tr_b16 v[244:245], v116 offset:12288
ds_read_b64_tr_b16 v[246:247], v116 offset:14336
Mvva 148,212,12
v_add_u32 v10, 4096, v112
Mvva 136,200,0
ds_read_b64_tr_b16 v[232:233], v117 offset:8192
ds_read_b64_tr_b16 v[234:235], v117 offset:10240
Mvva 136,216,8
buffer_store_dwordx4 v[160:163], v112, s[16:19], s26 offen offset:0 sc1
Mvva 152,200,4
s_waitcnt lgkmcnt(10)
ds_read_b64_tr_b16 v[248:249], v117 offset:12288
ds_read_b64_tr_b16 v[250:251], v117 offset:14336
Mvva 152,216,12
buffer_store_dwordx4 v[164:167], v112, s[16:19], s26 offen offset:1024 sc1
Mvva 140,204,0
s_waitcnt vmcnt(19)
ds_read_b64_tr_b16 v[236:237], v118 offset:8192
ds_read_b64_tr_b16 v[238:239], v118 offset:10240
Mvva 140,220,8
s_waitcnt lgkmcnt(10)
buffer_load_dwordx4 v114, s[12:15], s49 offen offset:1024 lds
Mvva 156,204,4
s_barrier
ds_read_b64_tr_b16 v[252:253], v118 offset:12288
ds_read_b64_tr_b16 v[254:255], v118 offset:14336
Mvva 156,220,12
buffer_store_dwordx4 v[168:171], v112, s[16:19], s26 offen offset:2048 sc1
Mvva 128,224,16
ds_read_b64_tr_b16 v[192:193], v115 offset:16384
ds_read_b64_tr_b16 v[194:195], v115 offset:18432
Mvva 128,240,24
buffer_store_dwordx4 v[172:175], v112, s[16:19], s26 offen offset:3072 sc1
Mvva 144,224,20
s_waitcnt lgkmcnt(10)
ds_read_b64_tr_b16 v[208:209], v115 offset:20480
ds_read_b64_tr_b16 v[210:211], v115 offset:22528
Mvva 144,240,28
buffer_store_dwordx4 v[176:179], v10, s[16:19], s26 offen offset:0 sc1
Mvva 132,228,16
ds_read_b64_tr_b16 v[196:197], v116 offset:16384
ds_read_b64_tr_b16 v[198:199], v116 offset:18432
Mvva 132,244,24
buffer_load_dwordx4 v114, s[12:15], s50 offen offset:2048 lds
Mvva 148,228,20
s_waitcnt lgkmcnt(10)
ds_read_b64_tr_b16 v[212:213], v116 offset:20480
ds_read_b64_tr_b16 v[214:215], v116 offset:22528
Mvva 148,244,28
buffer_store_dwordx4 v[180:183], v10, s[16:19], s26 offen offset:1024 sc1
Mvva 136,232,16
ds_read_b64_tr_b16 v[200:201], v117 offset:16384
ds_read_b64_tr_b16 v[202:203], v117 offset:18432
Mvva 136,248,24
buffer_store_dwordx4 v[184:187], v10, s[16:19], s26 offen offset:2048 sc1
Mvva 152,232,20
s_waitcnt lgkmcnt(10)
ds_read_b64_tr_b16 v[216:217], v117 offset:20480
ds_read_b64_tr_b16 v[218:219], v117 offset:22528
Mvva 152,248,28
buffer_store_dwordx4 v[188:191], v10, s[16:19], s26 offen offset:3072 sc1
Mvva 140,236,16
ds_read_b64_tr_b16 v[204:205], v118 offset:16384
ds_read_b64_tr_b16 v[206:207], v118 offset:18432
Mvva 140,252,24
buffer_load_dwordx4 v114, s[12:15], s51 offen offset:3072 lds
v_add_u32 v114, 262144, v114
Mvva 156,236,20
s_waitcnt lgkmcnt(10)
ds_read_b64_tr_b16 v[220:221], v118 offset:20480
ds_read_b64_tr_b16 v[222:223], v118 offset:22528
Mvva 156,252,28
v_mov_b32_e64 v16, 1
Mvva 128,192,32
ds_read_b64_tr_b16 v[224:225], v115 offset:24576
ds_read_b64_tr_b16 v[226:227], v115 offset:26624
Mvva 128,208,40
Mvva 144,192,36
s_waitcnt lgkmcnt(10)
ds_read_b64_tr_b16 v[240:241], v115 offset:28672
ds_read_b64_tr_b16 v[242:243], v115 offset:30720
Mvva 144,208,44
Mvva 132,196,32
s_add_u32 m0, s44, 114688
ds_read_b64_tr_b16 v[228:229], v116 offset:24576
ds_read_b64_tr_b16 v[230:231], v116 offset:26624
Mvva 132,212,40
buffer_load_dwordx4 v114, s[12:15], s48 offen offset:0 lds
Mvva 148,196,36
s_waitcnt lgkmcnt(10)
ds_read_b64_tr_b16 v[244:245], v116 offset:28672
ds_read_b64_tr_b16 v[246:247], v116 offset:30720
Mvva 148,212,44
Mvva 136,200,32
ds_read_b64_tr_b16 v[232:233], v117 offset:24576
ds_read_b64_tr_b16 v[234:235], v117 offset:26624
Mvva 136,216,40
Mvva 152,200,36
s_waitcnt lgkmcnt(10)
ds_read_b64_tr_b16 v[248:249], v117 offset:28672
ds_read_b64_tr_b16 v[250:251], v117 offset:30720
Mvva 152,216,44
Mvva 140,204,32
s_waitcnt vmcnt(25)
ds_read_b64_tr_b16 v[236:237], v118 offset:24576
ds_read_b64_tr_b16 v[238:239], v118 offset:26624
Mvva 140,220,40
s_waitcnt lgkmcnt(10)
buffer_load_dwordx4 v114, s[12:15], s49 offen offset:1024 lds
Mvva 156,204,36
s_barrier
ds_read_b64_tr_b16 v[252:253], v118 offset:28672
ds_read_b64_tr_b16 v[254:255], v118 offset:30720
Mvva 156,220,44
Mvva 128,224,48
ds_read_b64_tr_b16 v[192:193], v115 offset:32768
ds_read_b64_tr_b16 v[194:195], v115 offset:34816
Mvva 128,240,56
Mvva 144,224,52
s_waitcnt lgkmcnt(10)
ds_read_b64_tr_b16 v[208:209], v115 offset:36864
ds_read_b64_tr_b16 v[210:211], v115 offset:38912
Mvva 144,240,60
Mvva 132,228,48
ds_read_b64_tr_b16 v[196:197], v116 offset:32768
ds_read_b64_tr_b16 v[198:199], v116 offset:34816
Mvva 132,244,56
buffer_load_dwordx4 v114, s[12:15], s50 offen offset:2048 lds
Mvva 148,228,52
s_waitcnt lgkmcnt(10)
ds_read_b64_tr_b16 v[212:213], v116 offset:36864
ds_read_b64_tr_b16 v[214:215], v116 offset:38912
Mvva 148,244,60
Mvva 136,232,48
ds_read_b64_tr_b16 v[200:201], v117 offset:32768
ds_read_b64_tr_b16 v[202:203], v117 offset:34816
Mvva 136,248,56
Mvva 152,232,52
s_waitcnt lgkmcnt(10)
ds_read_b64_tr_b16 v[216:217], v117 offset:36864
ds_read_b64_tr_b16 v[218:219], v117 offset:38912
Mvva 152,248,60
Mvva 140,236,48
ds_read_b64_tr_b16 v[204:205], v118 offset:32768
ds_read_b64_tr_b16 v[206:207], v118 offset:34816
Mvva 140,252,56
buffer_load_dwordx4 v114, s[12:15], s51 offen offset:3072 lds
v_add_u32 v114, 262144, v114
Mvva 156,236,52
s_waitcnt lgkmcnt(10)
ds_read_b64_tr_b16 v[220:221], v118 offset:36864
ds_read_b64_tr_b16 v[222:223], v118 offset:38912
Mvva 156,252,60
Mvva 128,192,64
ds_read_b64_tr_b16 v[224:225], v115 offset:40960
ds_read_b64_tr_b16 v[226:227], v115 offset:43008
Mvva 128,208,72
Mvva 144,192,68
s_waitcnt lgkmcnt(10)
ds_read_b64_tr_b16 v[240:241], v115 offset:45056
ds_read_b64_tr_b16 v[242:243], v115 offset:47104
Mvva 144,208,76
Mvva 132,196,64
ds_read_b64_tr_b16 v[228:229], v116 offset:40960
ds_read_b64_tr_b16 v[230:231], v116 offset:43008
Mvva 132,212,72
Mvva 148,196,68
s_waitcnt lgkmcnt(10)
ds_read_b64_tr_b16 v[244:245], v116 offset:45056
ds_read_b64_tr_b16 v[246:247], v116 offset:47104
Mvva 148,212,76
Mvva 136,200,64
ds_read_b64_tr_b16 v[232:233], v117 offset:40960
ds_read_b64_tr_b16 v[234:235], v117 offset:43008
Mvva 136,216,72
Mvva 152,200,68
s_waitcnt lgkmcnt(10)
ds_read_b64_tr_b16 v[248:249], v117 offset:45056
ds_read_b64_tr_b16 v[250:251], v117 offset:47104
Mvva 152,216,76
Mvva 140,204,64
s_waitcnt vmcnt(24)
ds_read_b64_tr_b16 v[236:237], v118 offset:40960
ds_read_b64_tr_b16 v[238:239], v118 offset:43008
Mvva 140,220,72
s_waitcnt lgkmcnt(10)
Mvva 156,204,68
s_barrier
ds_read_b64_tr_b16 v[252:253], v118 offset:45056
ds_read_b64_tr_b16 v[254:255], v118 offset:47104
Mvva 156,220,76
Mvva 128,224,80
ds_read_b64_tr_b16 v[192:193], v115 offset:49152
ds_read_b64_tr_b16 v[194:195], v115 offset:51200
Mvva 128,240,88
Mvva 144,224,84
s_waitcnt lgkmcnt(10)
ds_read_b64_tr_b16 v[208:209], v115 offset:53248
ds_read_b64_tr_b16 v[210:211], v115 offset:55296
Mvva 144,240,92
Mvva 132,228,80
ds_read_b64_tr_b16 v[196:197], v116 offset:49152
ds_read_b64_tr_b16 v[198:199], v116 offset:51200
Mvva 132,244,88
Mvva 148,228,84
s_waitcnt lgkmcnt(10)
ds_read_b64_tr_b16 v[212:213], v116 offset:53248
ds_read_b64_tr_b16 v[214:215], v116 offset:55296
Mvva 148,244,92
Mvva 136,232,80
ds_read_b64_tr_b16 v[200:201], v117 offset:49152
ds_read_b64_tr_b16 v[202:203], v117 offset:51200
Mvva 136,248,88
Mvva 152,232,84
s_waitcnt lgkmcnt(10)
ds_read_b64_tr_b16 v[216:217], v117 offset:53248
ds_read_b64_tr_b16 v[218:219], v117 offset:55296
Mvva 152,248,92
Mvva 140,236,80
ds_read_b64_tr_b16 v[204:205], v118 offset:49152
ds_read_b64_tr_b16 v[206:207], v118 offset:51200
Mvva 140,252,88
Mvva 156,236,84
s_waitcnt lgkmcnt(10)
ds_read_b64_tr_b16 v[220:221], v118 offset:53248
ds_read_b64_tr_b16 v[222:223], v118 offset:55296
Mvva 156,252,92
Mvva 128,192,96
ds_read_b64_tr_b16 v[224:225], v115 offset:57344
ds_read_b64_tr_b16 v[226:227], v115 offset:59392
Mvva 128,208,104
Mvva 144,192,100
s_waitcnt lgkmcnt(10)
ds_read_b64_tr_b16 v[240:241], v115 offset:61440
ds_read_b64_tr_b16 v[242:243], v115 offset:63488
Mvva 144,208,108
Mvva 132,196,96
ds_read_b64_tr_b16 v[228:229], v116 offset:57344
ds_read_b64_tr_b16 v[230:231], v116 offset:59392
Mvva 132,212,104
Mvva 148,196,100
s_waitcnt lgkmcnt(10)
ds_read_b64_tr_b16 v[244:245], v116 offset:61440
ds_read_b64_tr_b16 v[246:247], v116 offset:63488
Mvva 148,212,108
s_waitcnt vmcnt(5)
s_mov_b64 exec, 1
buffer_store_dword v16, v126, s[20:23], s27 offen sc1
s_mov_b64 exec, -1
Mvva 136,200,96
ds_read_b64_tr_b16 v[232:233], v117 offset:57344
ds_read_b64_tr_b16 v[234:235], v117 offset:59392
Mvva 136,216,104
Mvva 152,200,100
s_waitcnt lgkmcnt(10)
ds_read_b64_tr_b16 v[248:249], v117 offset:61440
ds_read_b64_tr_b16 v[250:251], v117 offset:63488
Mvva 152,216,108
Mvva 140,204,96
ds_read_b64_tr_b16 v[236:237], v118 offset:57344
ds_read_b64_tr_b16 v[238:239], v118 offset:59392
Mvva 140,220,104
s_waitcnt lgkmcnt(10)
Mvva 156,204,100
s_barrier
ds_read_b64_tr_b16 v[252:253], v118 offset:61440
ds_read_b64_tr_b16 v[254:255], v118 offset:63488
Mvva 156,220,108
Mvva 128,224,112
ds_read_b64_tr_b16 v[192:193], v12 offset:0
ds_read_b64_tr_b16 v[194:195], v12 offset:2048
Mvva 128,240,120
Mvva 144,224,116
s_waitcnt lgkmcnt(10)
ds_read_b64_tr_b16 v[208:209], v12 offset:4096
ds_read_b64_tr_b16 v[210:211], v12 offset:6144
Mvva 144,240,124
Mvva 132,228,112
ds_read_b64_tr_b16 v[196:197], v13 offset:0
ds_read_b64_tr_b16 v[198:199], v13 offset:2048
Mvva 132,244,120
Mvva 148,228,116
s_waitcnt lgkmcnt(10)
ds_read_b64_tr_b16 v[212:213], v13 offset:4096
ds_read_b64_tr_b16 v[214:215], v13 offset:6144
Mvva 148,244,124
Mvva 136,232,112
ds_read_b64_tr_b16 v[200:201], v14 offset:0
ds_read_b64_tr_b16 v[202:203], v14 offset:2048
Mvva 136,248,120
Mvva 152,232,116
s_waitcnt lgkmcnt(10)
ds_read_b64_tr_b16 v[216:217], v14 offset:4096
ds_read_b64_tr_b16 v[218:219], v14 offset:6144
Mvva 152,248,124
Mvva 140,236,112
ds_read_b64_tr_b16 v[204:205], v15 offset:0
ds_read_b64_tr_b16 v[206:207], v15 offset:2048
Mvva 140,252,120
Mvva 156,236,116
s_waitcnt lgkmcnt(10)
ds_read_b64_tr_b16 v[220:221], v15 offset:4096
ds_read_b64_tr_b16 v[222:223], v15 offset:6144
Mvva 156,252,124
Mvva 128,192,128
ds_read_b64_tr_b16 v[224:225], v12 offset:8192
ds_read_b64_tr_b16 v[226:227], v12 offset:10240
Mvva 128,208,136
Mvva 144,192,132
s_waitcnt lgkmcnt(10)
ds_read_b64_tr_b16 v[240:241], v12 offset:12288
ds_read_b64_tr_b16 v[242:243], v12 offset:14336
Mvva 144,208,140
Mvva 132,196,128
ds_read_b64_tr_b16 v[228:229], v13 offset:8192
ds_read_b64_tr_b16 v[230:231], v13 offset:10240
Mvva 132,212,136
Mvva 148,196,132
s_waitcnt lgkmcnt(10)
ds_read_b64_tr_b16 v[244:245], v13 offset:12288
ds_read_b64_tr_b16 v[246:247], v13 offset:14336
Mvva 148,212,140
Mvva 136,200,128
ds_read_b64_tr_b16 v[232:233], v14 offset:8192
ds_read_b64_tr_b16 v[234:235], v14 offset:10240
Mvva 136,216,136
Mvva 152,200,132
s_waitcnt lgkmcnt(10)
ds_read_b64_tr_b16 v[248:249], v14 offset:12288
ds_read_b64_tr_b16 v[250:251], v14 offset:14336
Mvva 152,216,140
Mvva 140,204,128
ds_read_b64_tr_b16 v[236:237], v15 offset:8192
ds_read_b64_tr_b16 v[238:239], v15 offset:10240
Mvva 140,220,136
s_waitcnt lgkmcnt(10)
Mvva 156,204,132
s_barrier
ds_read_b64_tr_b16 v[252:253], v15 offset:12288
ds_read_b64_tr_b16 v[254:255], v15 offset:14336
Mvva 156,220,140
Mvva 128,224,144
ds_read_b64_tr_b16 v[192:193], v12 offset:16384
ds_read_b64_tr_b16 v[194:195], v12 offset:18432
Mvva 128,240,152
Mvva 144,224,148
s_waitcnt lgkmcnt(10)
ds_read_b64_tr_b16 v[208:209], v12 offset:20480
ds_read_b64_tr_b16 v[210:211], v12 offset:22528
Mvva 144,240,156
Mvva 132,228,144
ds_read_b64_tr_b16 v[196:197], v13 offset:16384
ds_read_b64_tr_b16 v[198:199], v13 offset:18432
Mvva 132,244,152
buffer_load_dword v17, v126, s[20:23], s24 offen sc1
Mvva 148,228,148
s_waitcnt lgkmcnt(10)
ds_read_b64_tr_b16 v[212:213], v13 offset:20480
ds_read_b64_tr_b16 v[214:215], v13 offset:22528
Mvva 148,244,156
Mvva 136,232,144
ds_read_b64_tr_b16 v[200:201], v14 offset:16384
ds_read_b64_tr_b16 v[202:203], v14 offset:18432
Mvva 136,248,152
Mvva 152,232,148
s_waitcnt lgkmcnt(10)
ds_read_b64_tr_b16 v[216:217], v14 offset:20480
ds_read_b64_tr_b16 v[218:219], v14 offset:22528
Mvva 152,248,156
Mvva 140,236,144
ds_read_b64_tr_b16 v[204:205], v15 offset:16384
ds_read_b64_tr_b16 v[206:207], v15 offset:18432
Mvva 140,252,152
Mvva 156,236,148
s_waitcnt lgkmcnt(10)
ds_read_b64_tr_b16 v[220:221], v15 offset:20480
ds_read_b64_tr_b16 v[222:223], v15 offset:22528
Mvva 156,252,156
Mvva 128,192,160
ds_read_b64_tr_b16 v[224:225], v12 offset:24576
ds_read_b64_tr_b16 v[226:227], v12 offset:26624
Mvva 128,208,168
Mvva 144,192,164
s_waitcnt lgkmcnt(10)
ds_read_b64_tr_b16 v[240:241], v12 offset:28672
ds_read_b64_tr_b16 v[242:243], v12 offset:30720
Mvva 144,208,172
Mvva 132,196,160
ds_read_b64_tr_b16 v[228:229], v13 offset:24576
ds_read_b64_tr_b16 v[230:231], v13 offset:26624
Mvva 132,212,168
Mvva 148,196,164
s_waitcnt lgkmcnt(10)
ds_read_b64_tr_b16 v[244:245], v13 offset:28672
ds_read_b64_tr_b16 v[246:247], v13 offset:30720
Mvva 148,212,172
Mvva 136,200,160
ds_read_b64_tr_b16 v[232:233], v14 offset:24576
ds_read_b64_tr_b16 v[234:235], v14 offset:26624
Mvva 136,216,168
Mvva 152,200,164
s_waitcnt lgkmcnt(10)
ds_read_b64_tr_b16 v[248:249], v14 offset:28672
ds_read_b64_tr_b16 v[250:251], v14 offset:30720
Mvva 152,216,172
Mvva 140,204,160
s_waitcnt vmcnt(6)
ds_read_b64_tr_b16 v[236:237], v15 offset:24576
ds_read_b64_tr_b16 v[238:239], v15 offset:26624
Mvva 140,220,168
s_waitcnt lgkmcnt(10)
Mvva 156,204,164
s_barrier
ds_read_b64_tr_b16 v[252:253], v15 offset:28672
ds_read_b64_tr_b16 v[254:255], v15 offset:30720
Mvva 156,220,172
Mvva 128,224,176
ds_read_b64_tr_b16 v[192:193], v12 offset:32768
ds_read_b64_tr_b16 v[194:195], v12 offset:34816
Mvva 128,240,184
Mvva 144,224,180
s_waitcnt lgkmcnt(10)
ds_read_b64_tr_b16 v[208:209], v12 offset:36864
ds_read_b64_tr_b16 v[210:211], v12 offset:38912
Mvva 144,240,188
Mvva 132,228,176
ds_read_b64_tr_b16 v[196:197], v13 offset:32768
ds_read_b64_tr_b16 v[198:199], v13 offset:34816
Mvva 132,244,184
Mvva 148,228,180
s_waitcnt lgkmcnt(10)
ds_read_b64_tr_b16 v[212:213], v13 offset:36864
ds_read_b64_tr_b16 v[214:215], v13 offset:38912
Mvva 148,244,188
Mvva 136,232,176
ds_read_b64_tr_b16 v[200:201], v14 offset:32768
ds_read_b64_tr_b16 v[202:203], v14 offset:34816
Mvva 136,248,184
Mvva 152,232,180
s_waitcnt lgkmcnt(10)
ds_read_b64_tr_b16 v[216:217], v14 offset:36864
ds_read_b64_tr_b16 v[218:219], v14 offset:38912
Mvva 152,248,188
s_waitcnt vmcnt(0)
v_cmp_ne_u32 vcc, 1, v17
s_mov_b32 s33, 0
s_cbranch_vccnz L_xno
buffer_load_dwordx4 v[160:163], v112, s[16:19], s25 offen offset:0 sc1
buffer_load_dwordx4 v[164:167], v112, s[16:19], s25 offen offset:1024 sc1
buffer_load_dwordx4 v[168:171], v112, s[16:19], s25 offen offset:2048 sc1
buffer_load_dwordx4 v[172:175], v112, s[16:19], s25 offen offset:3072 sc1
buffer_load_dwordx4 v[176:179], v10, s[16:19], s25 offen offset:0 sc1
buffer_load_dwordx4 v[180:183], v10, s[16:19], s25 offen offset:1024 sc1
buffer_load_dwordx4 v[184:187], v10, s[16:19], s25 offen offset:2048 sc1
buffer_load_dwordx4 v[188:191], v10, s[16:19], s25 offen offset:3072 sc1
s_mov_b32 s33, 1
L_xno:
Mvva 140,236,176
ds_read_b64_tr_b16 v[204:205], v15 offset:32768
ds_read_b64_tr_b16 v[206:207], v15 offset:34816
Mvva 140,252,184
Mvva 156,236,180
s_waitcnt lgkmcnt(10)
ds_read_b64_tr_b16 v[220:221], v15 offset:36864
ds_read_b64_tr_b16 v[222:223], v15 offset:38912
Mvva 156,252,188
Mvva 128,192,192
ds_read_b64_tr_b16 v[224:225], v12 offset:40960
ds_read_b64_tr_b16 v[226:227], v12 offset:43008
Mvva 128,208,200
Mvva 144,192,196
s_waitcnt lgkmcnt(10)
ds_read_b64_tr_b16 v[240:241], v12 offset:45056
ds_read_b64_tr_b16 v[242:243], v12 offset:47104
Mvva 144,208,204
Mvva 132,196,192
ds_read_b64_tr_b16 v[228:229], v13 offset:40960
ds_read_b64_tr_b16 v[230:231], v13 offset:43008
Mvva 132,212,200
Mvva 148,196,196
s_waitcnt lgkmcnt(10)
ds_read_b64_tr_b16 v[244:245], v13 offset:45056
ds_read_b64_tr_b16 v[246:247], v13 offset:47104
Mvva 148,212,204
Mvva 136,200,192
ds_read_b64_tr_b16 v[232:233], v14 offset:40960
ds_read_b64_tr_b16 v[234:235], v14 offset:43008
Mvva 136,216,200
Mvva 152,200,196
s_waitcnt lgkmcnt(10)
ds_read_b64_tr_b16 v[248:249], v14 offset:45056
ds_read_b64_tr_b16 v[250:251], v14 offset:47104
Mvva 152,216,204
Mvva 140,204,192
ds_read_b64_tr_b16 v[236:237], v15 offset:40960
ds_read_b64_tr_b16 v[238:239], v15 offset:43008
Mvva 140,220,200
s_waitcnt lgkmcnt(10)
Mvva 156,204,196
s_barrier
ds_read_b64_tr_b16 v[252:253], v15 offset:45056
ds_read_b64_tr_b16 v[254:255], v15 offset:47104
Mvva 156,220,204
Mvva 128,224,208
ds_read_b64_tr_b16 v[192:193], v12 offset:49152
ds_read_b64_tr_b16 v[194:195], v12 offset:51200
Mvva 128,240,216
Mvva 144,224,212
s_waitcnt lgkmcnt(10)
ds_read_b64_tr_b16 v[208:209], v12 offset:53248
ds_read_b64_tr_b16 v[210:211], v12 offset:55296
Mvva 144,240,220
Mvva 132,228,208
ds_read_b64_tr_b16 v[196:197], v13 offset:49152
ds_read_b64_tr_b16 v[198:199], v13 offset:51200
Mvva 132,244,216
Mvva 148,228,212
s_waitcnt lgkmcnt(10)
ds_read_b64_tr_b16 v[212:213], v13 offset:53248
ds_read_b64_tr_b16 v[214:215], v13 offset:55296
Mvva 148,244,220
Mvva 136,232,208
ds_read_b64_tr_b16 v[200:201], v14 offset:49152
ds_read_b64_tr_b16 v[202:203], v14 offset:51200
Mvva 136,248,216
Mvva 152,232,212
s_waitcnt lgkmcnt(10)
ds_read_b64_tr_b16 v[216:217], v14 offset:53248
ds_read_b64_tr_b16 v[218:219], v14 offset:55296
Mvva 152,248,220
Mvva 140,236,208
ds_read_b64_tr_b16 v[204:205], v15 offset:49152
ds_read_b64_tr_b16 v[206:207], v15 offset:51200
Mvva 140,252,216
Mvva 156,236,212
s_waitcnt lgkmcnt(10)
ds_read_b64_tr_b16 v[220:221], v15 offset:53248
ds_read_b64_tr_b16 v[222:223], v15 offset:55296
Mvva 156,252,220
Mvva 128,192,224
ds_read_b64_tr_b16 v[224:225], v12 offset:57344
ds_read_b64_tr_b16 v[226:227], v12 offset:59392
Mvva 128,208,232
Mvva 144,192,228
s_waitcnt lgkmcnt(10)
ds_read_b64_tr_b16 v[240:241], v12 offset:61440
ds_read_b64_tr_b16 v[242:243], v12 offset:63488
Mvva 144,208,236
Mvva 132,196,224
ds_read_b64_tr_b16 v[228:229], v13 offset:57344
ds_read_b64_tr_b16 v[230:231], v13 offset:59392
Mvva 132,212,232
Mvva 148,196,228
s_waitcnt lgkmcnt(10)
ds_read_b64_tr_b16 v[244:245], v13 offset:61440
ds_read_b64_tr_b16 v[246:247], v13 offset:63488
Mvva 148,212,236
Mvva 136,200,224
ds_read_b64_tr_b16 v[232:233], v14 offset:57344
ds_read_b64_tr_b16 v[234:235], v14 offset:59392
Mvva 136,216,232
Mvva 152,200,228
s_waitcnt lgkmcnt(10)
ds_read_b64_tr_b16 v[248:249], v14 offset:61440
ds_read_b64_tr_b16 v[250:251], v14 offset:63488
Mvva 152,216,236
Mvva 140,204,224
ds_read_b64_tr_b16 v[236:237], v15 offset:57344
ds_read_b64_tr_b16 v[238:239], v15 offset:59392
Mvva 140,220,232
s_waitcnt lgkmcnt(10)
Mvva 156,204,228
ds_read_b64_tr_b16 v[252:253], v15 offset:61440
ds_read_b64_tr_b16 v[254:255], v15 offset:63488
Mvva 156,220,236
Mvva 128,224,240
Mvva 128,240,248
Mvva 144,224,244
s_waitcnt lgkmcnt(8)
Mvva 144,240,252
Mvva 132,228,240
Mvva 132,244,248
Mvva 148,228,244
s_waitcnt lgkmcnt(4)
Mvva 148,244,252
Mvva 136,232,240
Mvva 136,248,248
Mvva 152,232,244
s_waitcnt lgkmcnt(0)
Mvva 152,248,252
Mvva 140,236,240
Mvva 140,252,248
Mvva 156,236,244
Mvva 156,252,252
s_cmp_lg_u32 s53, s40
s_cbranch_scc1 L_ysl
L_yslr:
v_and_b32 v124, 15, v0
v_lshlrev_b32 v74, 8, v124
v_add_u32 v74, s35, v74
v_xor_b32 v124, v124, v121
v_lshl_add_u32 v74, v124, 4, v74
v_xor_b32_e64 v75, 64, v74
v_xor_b32 v76, 128, v74
v_xor_b32 v77, 192, v74
v_lshlrev_b32 v125, 1, v122
v_xor_b32 v124, v123, v125
v_lshlrev_b32 v12, 8, v123
v_add_u32 v12, s35, v12
v_lshl_add_u32 v12, v124, 4, v12
v_xor_b32_e64 v13, 16, v12
v_xor_b32 v14, 128, v12
v_xor_b32 v15, 144, v12
s_cmp_eq_u32 s33, 0
s_cbranch_scc1 L_spinX
L_spinXr:
v_lshlrev_b32_e64 v80, 16, v18
v_and_b32 v81, 0xffff0000, v18
v_lshlrev_b32_e64 v82, 16, v19
v_and_b32 v83, 0xffff0000, v19
v_lshlrev_b32_e64 v84, 16, v20
v_and_b32 v85, 0xffff0000, v20
v_lshlrev_b32_e64 v86, 16, v21
v_and_b32 v87, 0xffff0000, v21
v_lshlrev_b32_e64 v88, 16, v22
v_and_b32 v89, 0xffff0000, v22
v_lshlrev_b32_e64 v90, 16, v23
v_and_b32 v91, 0xffff0000, v23
v_lshlrev_b32_e64 v92, 16, v24
v_and_b32 v93, 0xffff0000, v24
v_lshlrev_b32_e64 v94, 16, v25
v_and_b32 v95, 0xffff0000, v25
v_lshlrev_b32_e64 v96, 16, v26
v_and_b32 v97, 0xffff0000, v26
v_lshlrev_b32_e64 v98, 16, v27
v_and_b32 v99, 0xffff0000, v27
v_lshlrev_b32_e64 v100, 16, v28
v_and_b32 v101, 0xffff0000, v28
v_lshlrev_b32_e64 v102, 16, v29
v_and_b32 v103, 0xffff0000, v29
v_lshlrev_b32_e64 v104, 16, v30
v_and_b32 v105, 0xffff0000, v30
v_lshlrev_b32_e64 v106, 16, v31
v_and_b32 v107, 0xffff0000, v31
v_lshlrev_b32_e64 v108, 16, v32
v_and_b32 v109, 0xffff0000, v32
v_lshlrev_b32_e64 v110, 16, v33
v_and_b32 v111, 0xffff0000, v33
s_waitcnt vmcnt(0)
s_nop 0
v_pk_add_f32 v[128:129], v[128:129], v[160:161]
v_pk_add_f32 v[130:131], v[130:131], v[162:163]
ds_write_b128 v74, v[128:131] offset:0
v_pk_add_f32 v[132:133], v[132:133], v[164:165]
v_pk_add_f32 v[134:135], v[134:135], v[166:167]
ds_write_b128 v75, v[132:135] offset:0
v_pk_add_f32 v[136:137], v[136:137], v[168:169]
v_pk_add_f32 v[138:139], v[138:139], v[170:171]
ds_write_b128 v76, v[136:139] offset:0
v_pk_add_f32 v[140:141], v[140:141], v[172:173]
v_pk_add_f32 v[142:143], v[142:143], v[174:175]
ds_write_b128 v77, v[140:143] offset:0
v_pk_add_f32 v[144:145], v[144:145], v[176:177]
v_pk_add_f32 v[146:147], v[146:147], v[178:179]
ds_write_b128 v74, v[144:147] offset:4096
v_pk_add_f32 v[148:149], v[148:149], v[180:181]
v_pk_add_f32 v[150:151], v[150:151], v[182:183]
ds_write_b128 v75, v[148:151] offset:4096
v_pk_add_f32 v[152:153], v[152:153], v[184:185]
v_pk_add_f32 v[154:155], v[154:155], v[186:187]
ds_write_b128 v76, v[152:155] offset:4096
v_pk_add_f32 v[156:157], v[156:157], v[188:189]
v_pk_add_f32 v[158:159], v[158:159], v[190:191]
ds_write_b128 v77, v[156:159] offset:4096
Rv 192,12,0
Rv 196,13,0
Rv 200,14,2048
Rv 204,15,2048
Rv 208,12,4096
Rv 212,13,4096
Rv 216,14,6144
s_waitcnt lgkmcnt(9)
Rv 220,15,6144
s_waitcnt lgkmcnt(6)
Vc 224,192,193
v_lshlrev_b32_e64 v192, 16, v224
v_and_b32 v193, 0xffff0000, v224
Vc 225,194,195
v_lshlrev_b32_e64 v194, 16, v225
v_and_b32 v195, 0xffff0000, v225
Vc 226,196,197
v_lshlrev_b32_e64 v196, 16, v226
v_and_b32 v197, 0xffff0000, v226
Vc 227,198,199
v_lshlrev_b32_e64 v198, 16, v227
v_and_b32 v199, 0xffff0000, v227
v_pk_mul_f32 v[192:193], v[192:193], v[42:43]
v_pk_mul_f32 v[194:195], v[194:195], v[44:45]
v_pk_mul_f32 v[196:197], v[196:197], v[46:47]
v_pk_mul_f32 v[198:199], v[198:199], v[48:49]
Vc 224,192,193
v_lshlrev_b32_e64 v192, 16, v224
v_and_b32 v193, 0xffff0000, v224
Vc 225,194,195
v_lshlrev_b32_e64 v194, 16, v225
v_and_b32 v195, 0xffff0000, v225
Vc 226,196,197
v_lshlrev_b32_e64 v196, 16, v226
v_and_b32 v197, 0xffff0000, v226
Vc 227,198,199
v_lshlrev_b32_e64 v198, 16, v227
v_and_b32 v199, 0xffff0000, v227
v_pk_add_f32 v[192:193], v[192:193], v[80:81]
v_pk_add_f32 v[194:195], v[194:195], v[82:83]
v_pk_add_f32 v[196:197], v[196:197], v[84:85]
v_pk_add_f32 v[198:199], v[198:199], v[86:87]
Vc 224,192,193
Vc 225,194,195
Vc 226,196,197
Vc 227,198,199
buffer_store_dwordx4 v[224:227], v119, s[68:71], s36 offen sc1
s_add_u32 s36, s36, 16384
s_waitcnt lgkmcnt(4)
Vc 228,200,201
v_lshlrev_b32 v200, 16, v228
v_and_b32 v201, 0xffff0000, v228
Vc 229,202,203
v_lshlrev_b32_e64 v202, 16, v229
v_and_b32 v203, 0xffff0000, v229
Vc 230,204,205
v_lshlrev_b32_e64 v204, 16, v230
v_and_b32 v205, 0xffff0000, v230
Vc 231,206,207
v_lshlrev_b32_e64 v206, 16, v231
v_and_b32 v207, 0xffff0000, v231
v_pk_mul_f32 v[200:201], v[200:201], v[50:51]
v_pk_mul_f32 v[202:203], v[202:203], v[52:53]
v_pk_mul_f32 v[204:205], v[204:205], v[54:55]
v_pk_mul_f32 v[206:207], v[206:207], v[56:57]
Vc 228,200,201
v_lshlrev_b32_e64 v200, 16, v228
v_and_b32 v201, 0xffff0000, v228
Vc 229,202,203
v_lshlrev_b32_e64 v202, 16, v229
v_and_b32 v203, 0xffff0000, v229
Vc 230,204,205
v_lshlrev_b32_e64 v204, 16, v230
v_and_b32 v205, 0xffff0000, v230
Vc 231,206,207
v_lshlrev_b32_e64 v206, 16, v231
v_and_b32 v207, 0xffff0000, v231
v_pk_add_f32 v[200:201], v[200:201], v[88:89]
v_pk_add_f32 v[202:203], v[202:203], v[90:91]
v_pk_add_f32 v[204:205], v[204:205], v[92:93]
v_pk_add_f32 v[206:207], v[206:207], v[94:95]
Vc 228,200,201
Vc 229,202,203
Vc 230,204,205
Vc 231,206,207
buffer_store_dwordx4 v[228:231], v119, s[68:71], s36 offen sc1
s_add_u32 s36, s36, 16384
s_waitcnt lgkmcnt(2)
Vc 232,208,209
v_lshlrev_b32 v208, 16, v232
v_and_b32 v209, 0xffff0000, v232
Vc 233,210,211
v_lshlrev_b32_e64 v210, 16, v233
v_and_b32 v211, 0xffff0000, v233
Vc 234,212,213
v_lshlrev_b32_e64 v212, 16, v234
v_and_b32 v213, 0xffff0000, v234
Vc 235,214,215
v_lshlrev_b32_e64 v214, 16, v235
v_and_b32 v215, 0xffff0000, v235
v_pk_mul_f32 v[208:209], v[208:209], v[58:59]
v_pk_mul_f32 v[210:211], v[210:211], v[60:61]
v_pk_mul_f32 v[212:213], v[212:213], v[62:63]
v_pk_mul_f32 v[214:215], v[214:215], v[64:65]
Vc 232,208,209
v_lshlrev_b32_e64 v208, 16, v232
v_and_b32 v209, 0xffff0000, v232
Vc 233,210,211
v_lshlrev_b32_e64 v210, 16, v233
v_and_b32 v211, 0xffff0000, v233
Vc 234,212,213
v_lshlrev_b32_e64 v212, 16, v234
v_and_b32 v213, 0xffff0000, v234
Vc 235,214,215
v_lshlrev_b32_e64 v214, 16, v235
v_and_b32 v215, 0xffff0000, v235
v_pk_add_f32 v[208:209], v[208:209], v[96:97]
v_pk_add_f32 v[210:211], v[210:211], v[98:99]
v_pk_add_f32 v[212:213], v[212:213], v[100:101]
v_pk_add_f32 v[214:215], v[214:215], v[102:103]
Vc 232,208,209
Vc 233,210,211
Vc 234,212,213
Vc 235,214,215
buffer_store_dwordx4 v[232:235], v119, s[68:71], s36 offen sc1
s_add_u32 s36, s36, 16384
s_waitcnt lgkmcnt(0)
Vc 236,216,217
v_lshlrev_b32 v216, 16, v236
v_and_b32 v217, 0xffff0000, v236
Vc 237,218,219
v_lshlrev_b32_e64 v218, 16, v237
v_and_b32 v219, 0xffff0000, v237
Vc 238,220,221
v_lshlrev_b32_e64 v220, 16, v238
v_and_b32 v221, 0xffff0000, v238
Vc 239,222,223
v_lshlrev_b32_e64 v222, 16, v239
v_and_b32 v223, 0xffff0000, v239
v_pk_mul_f32 v[216:217], v[216:217], v[66:67]
v_pk_mul_f32 v[218:219], v[218:219], v[68:69]
v_pk_mul_f32 v[220:221], v[220:221], v[70:71]
v_pk_mul_f32 v[222:223], v[222:223], v[72:73]
Vc 236,216,217
v_lshlrev_b32_e64 v216, 16, v236
v_and_b32 v217, 0xffff0000, v236
Vc 237,218,219
v_lshlrev_b32_e64 v218, 16, v237
v_and_b32 v219, 0xffff0000, v237
Vc 238,220,221
v_lshlrev_b32_e64 v220, 16, v238
v_and_b32 v221, 0xffff0000, v238
Vc 239,222,223
v_lshlrev_b32_e64 v222, 16, v239
v_and_b32 v223, 0xffff0000, v239
v_pk_add_f32 v[216:217], v[216:217], v[104:105]
v_pk_add_f32 v[218:219], v[218:219], v[106:107]
v_pk_add_f32 v[220:221], v[220:221], v[108:109]
v_pk_add_f32 v[222:223], v[222:223], v[110:111]
Vc 236,216,217
Vc 237,218,219
Vc 238,220,221
Vc 239,222,223
buffer_store_dwordx4 v[236:239], v119, s[68:71], s36 offen sc1
L_k2_end:
s_endpgm
L_spinC:
s_add_u32 m0, s35, 0
s_nop 0
s_nop 0
buffer_load_dwordx4 v125, s[60:63], s48 offen offset:0 lds
buffer_load_dwordx4 v125, s[60:63], s49 offen offset:1024 lds
buffer_load_dwordx4 v125, s[60:63], s50 offen offset:2048 lds
buffer_load_dwordx4 v125, s[60:63], s51 offen offset:3072 lds
v_add_u32 v125, 65536, v125
s_add_u32 m0, s35, 4096
s_nop 0
buffer_load_dwordx4 v125, s[60:63], s48 offen offset:0 lds
buffer_load_dwordx4 v125, s[60:63], s49 offen offset:1024 lds
buffer_load_dwordx4 v125, s[60:63], s50 offen offset:2048 lds
buffer_load_dwordx4 v125, s[60:63], s51 offen offset:3072 lds
s_mov_b32 s40, 1
s_mov_b32 s47, 0x400000
L_spinC_l:
buffer_load_dword v124, v10, s[20:23], s38 offen sc1
s_sub_u32 s47, s47, 1
s_waitcnt vmcnt(0)
s_cmp_eq_u32 s47, 0
s_cbranch_scc1 L_spinC_lx
v_cmp_ne_u32 vcc, 1, v124
s_cbranch_vccz L_spinC_lx
s_sleep 4
s_branch L_spinC_l
L_spinC_lx:
s_branch L_spinCr
L_c31:
s_bfe_u32 s3, s2, 0x40003
s_lshl_b32 s3, s3, 2
s_add_u32 s3, s3, s32
s_lshl_b32 s3, s3, 15
s_and_b32 s7, s2, 1
s_lshl_b32 s7, s7, 22
s_add_u32 s3, s3, s7
s_add_u32 s3, s3, 2097536
v_and_b32 v1, 15, v0
v_lshlrev_b32 v1, 11, v1
v_lshrrev_b32 v11, 5, v0
v_lshl_add_u32 v1, v11, 10, v1
buffer_load_dword v11, v1, s[28:31], s3 offen
s_branch L_c31r
L_f2A:
s_lshr_b32 s5, s54, 1
s_lshl_b32 s5, s5, 5
s_add_u32 s5, s5, 5447680
buffer_load_dword v125, v127, s[20:23], s5 offen sc1
s_branch L_f2Ar
L_f2B:
s_waitcnt vmcnt(16)
v_cmp_ne_u32 vcc, 1, v125
s_cbranch_vccz L_f2lx
s_mov_b32 s47, 0x400000
L_f2l:
buffer_load_dword v125, v127, s[20:23], s5 offen sc1
s_sub_u32 s47, s47, 1
s_waitcnt vmcnt(0)
s_cmp_eq_u32 s47, 0
s_cbranch_scc1 L_f2lx
v_cmp_ne_u32 vcc, 1, v125
s_cbranch_vccz L_f2lx
s_sleep 8
s_branch L_f2l
L_f2lx:
s_lshl_b32 s3, s54, 8
s_add_u32 s3, s3, 6291456
v_mul_u32_u24 v124, 14336, v121
v_and_b32_e64 v125, 15, v0
v_lshl_add_u32 v124, v125, 4, v124
buffer_load_dwordx4 v[74:77], v124, s[20:23], s3 offen sc1
s_add_u32 s3, s3, 57344
buffer_load_dwordx4 v[78:81], v124, s[20:23], s3 offen sc1
s_add_u32 s3, s3, 57344
buffer_load_dwordx4 v[82:85], v124, s[20:23], s3 offen sc1
s_add_u32 s3, s3, 57344
buffer_load_dwordx4 v[86:89], v124, s[20:23], s3 offen sc1
s_add_u32 s3, s3, 57344
buffer_load_dwordx4 v[90:93], v124, s[20:23], s3 offen sc1
s_add_u32 s3, s3, 57344
buffer_load_dwordx4 v[94:97], v124, s[20:23], s3 offen sc1
s_add_u32 s3, s3, 57344
buffer_load_dwordx4 v[98:101], v124, s[20:23], s3 offen sc1
s_add_u32 s3, s3, 57344
buffer_load_dwordx4 v[102:105], v124, s[20:23], s3 offen sc1
s_branch L_f2Br
L_f2C:
v_add_u32 v106, s35, v115
v_add_u32 v107, s35, v116
v_add_u32 v108, s35, v117
v_add_u32 v109, s35, v118
s_waitcnt vmcnt(16) lgkmcnt(0)
v_pk_add_f32 v[74:75], v[74:75], v[78:79]
v_pk_add_f32 v[76:77], v[76:77], v[80:81]
v_pk_add_f32 v[74:75], v[74:75], v[82:83]
v_pk_add_f32 v[76:77], v[76:77], v[84:85]
v_pk_add_f32 v[74:75], v[74:75], v[86:87]
v_pk_add_f32 v[76:77], v[76:77], v[88:89]
v_pk_add_f32 v[74:75], v[74:75], v[90:91]
v_pk_add_f32 v[76:77], v[76:77], v[92:93]
v_pk_add_f32 v[74:75], v[74:75], v[94:95]
v_pk_add_f32 v[76:77], v[76:77], v[96:97]
v_pk_add_f32 v[74:75], v[74:75], v[98:99]
v_pk_add_f32 v[76:77], v[76:77], v[100:101]
v_pk_add_f32 v[74:75], v[74:75], v[102:103]
v_pk_add_f32 v[76:77], v[76:77], v[104:105]
Vc 125,74,75
v_lshlrev_b32_e64 v74, 16, v125
v_and_b32 v75, 0xffff0000, v125
Vc 125,76,77
v_lshlrev_b32_e64 v76, 16, v125
v_and_b32 v77, 0xffff0000, v125
v_mov_b32 v82, v74
v_mov_b32 v83, v75
v_mov_b32 v84, v76
v_mov_b32 v85, v77
v_permlane32_swap_b32 v82, v74
v_permlane32_swap_b32 v83, v75
v_permlane32_swap_b32 v84, v76
v_permlane32_swap_b32 v85, v77
v_mul_f32 v90, 0xbfb8aa3b, v82
v_mul_f32 v91, 0xbfb8aa3b, v83
v_mul_f32 v92, 0xbfb8aa3b, v84
v_mul_f32 v93, 0xbfb8aa3b, v85
Ve 90,90
Ve 91,91
Ve 92,92
Ve 93,93
v_add_f32 v90, 1.0, v90
v_add_f32 v91, 1.0, v91
v_add_f32 v92, 1.0, v92
v_add_f32 v93, 1.0, v93
v_rcp_f32 v90, v90
v_rcp_f32 v91, v91
v_rcp_f32 v92, v92
v_rcp_f32 v93, v93
Vm 82,82,90
Vm 83,83,91
Vm 84,84,92
Vm 85,85,93
Vc 125,82,83
v_lshlrev_b32_e64 v82, 16, v125
v_and_b32 v83, 0xffff0000, v125
Vc 125,84,85
v_lshlrev_b32_e64 v84, 16, v125
v_and_b32 v85, 0xffff0000, v125
Vm 74,74,82
Vm 75,75,83
Vm 76,76,84
Vm 77,77,85
Vc 90,74,75
Vc 91,76,77
v_and_b32 v124, 1, v121
v_lshlrev_b32 v124, 8, v124
v_and_b32_e64 v125, 15, v0
v_lshl_add_u32 v124, v125, 3, v124
v_add_u32_e64 v124, s35, v124
ds_read_b64_tr_b16 v[74:75], v106 offset:0
ds_read_b64_tr_b16 v[76:77], v106 offset:2048
ds_read_b64_tr_b16 v[78:79], v107 offset:0
ds_read_b64_tr_b16 v[80:81], v107 offset:2048
ds_read_b64_tr_b16 v[82:83], v108 offset:0
ds_read_b64_tr_b16 v[84:85], v108 offset:2048
ds_read_b64_tr_b16 v[86:87], v109 offset:0
ds_read_b64_tr_b16 v[88:89], v109 offset:2048
ds_write_b64 v124, v[90:91]
v_and_b32 v124, 1, v0
v_lshlrev_b32 v124, 8, v124
v_lshl_add_u32 v125, v121, 3, v124
v_add_u32_e64 v125, s35, v125
ds_read_b64 v[90:91], v125 offset:0
ds_read_b64 v[92:93], v125 offset:32
ds_read_b64 v[94:95], v125 offset:64
ds_read_b64 v[96:97], v125 offset:96
v_lshl_add_u32 v124, v121, 4, v124
v_add_u32 v124, s35, v124
s_waitcnt lgkmcnt(0)
Zvvv 98,74,90
ds_read_b64_tr_b16 v[74:75], v106 offset:4096
ds_read_b64_tr_b16 v[76:77], v106 offset:6144
Zvvv 102,78,90
ds_read_b64_tr_b16 v[78:79], v107 offset:4096
ds_read_b64_tr_b16 v[80:81], v107 offset:6144
s_waitcnt lgkmcnt(0)
Mvvv 98,74,94
Mvvv 102,78,94
s_nop 6
ds_write_b128 v124, v[98:101] offset:2048
ds_write_b128 v124, v[102:105] offset:2112
s_waitcnt lgkmcnt(0)
Zvvv 98,82,90
ds_read_b64_tr_b16 v[82:83], v108 offset:4096
ds_read_b64_tr_b16 v[84:85], v108 offset:6144
Zvvv 102,86,90
ds_read_b64_tr_b16 v[86:87], v109 offset:4096
ds_read_b64_tr_b16 v[88:89], v109 offset:6144
s_waitcnt lgkmcnt(0)
Mvvv 98,82,94
Mvvv 102,86,94
s_nop 6
ds_write_b128 v124, v[98:101] offset:2176
ds_write_b128 v124, v[102:105] offset:2240
s_waitcnt lgkmcnt(0)
s_barrier
s_cmp_lg_u32 s32, 0
s_cbranch_scc1 L_f2Cr
v_lshlrev_b32 v124, 3, v0
v_add_u32 v125, 133120, v124
ds_read_b64 v[74:75], v125 offset:0
ds_read_b64 v[76:77], v125 offset:8192
ds_read_b64 v[78:79], v125 offset:16384
ds_read_b64 v[80:81], v125 offset:24576
s_lshl_b32 s3, s39, 4
s_add_u32 s3, s3, s37
s_lshl_b32 s3, s3, 9
s_add_u32 s3, s3, 5308416
s_waitcnt lgkmcnt(0)
v_pk_add_f32 v[74:75], v[74:75], v[76:77]
v_pk_add_f32 v[78:79], v[78:79], v[80:81]
v_pk_add_f32 v[74:75], v[74:75], v[78:79]
buffer_store_dwordx2 v[74:75], v124, s[20:23], s3 offen sc1
s_branch L_f2Cr
L_f2E:
s_cmp_lg_u32 s32, 0
s_cbranch_scc1 L_f2Er
v_mov_b32 v125, 1
s_lshl_b32 s3, s39, 5
s_add_u32 s3, s3, s37
s_lshl_b32 s3, s3, 2
s_add_u32 s3, s3, 5449728
s_waitcnt vmcnt(16)
s_mov_b64 exec, 1
buffer_store_dword v125, v126, s[20:23], s3 offen sc1
s_mov_b64 exec, -1
s_branch L_f2Er
L_yA:
v_min_u32 v127, 13, v0
v_lshlrev_b32_e64 v127, 2, v127
buffer_load_dword v74, v127, s[20:23], s41 offen sc1
s_branch L_yAr
L_yB:
s_waitcnt vmcnt(6)
v_cmp_ne_u32 vcc, 1, v74
s_cbranch_vccnz L_yBr
s_mov_b32 s40, 1
v_lshlrev_b32 v124, 2, v0
v_lshlrev_b32 v125, 1, v0
s_lshl_b32 s7, s45, 2
s_add_u32 s7, s7, s32
s_lshr_b32 s3, s42, 5
s_cmp_lg_u32 s3, s7
s_cbranch_scc1 L_f_yl1
s_add_u32 s3, s55, 0
s_nop 0
s_add_u32 s7, s3, 4096
buffer_load_dword v76, v124, s[20:23], s3 offen offset:0 sc1
buffer_load_dword v77, v124, s[20:23], s3 offen offset:512 sc1
buffer_load_dword v78, v124, s[20:23], s3 offen offset:1024 sc1
buffer_load_dword v79, v124, s[20:23], s3 offen offset:1536 sc1
buffer_load_dword v80, v124, s[20:23], s3 offen offset:2048 sc1
buffer_load_dword v81, v124, s[20:23], s3 offen offset:2560 sc1
buffer_load_dword v82, v124, s[20:23], s3 offen offset:3072 sc1
buffer_load_dword v83, v124, s[20:23], s3 offen offset:3584 sc1
buffer_load_dword v84, v124, s[20:23], s7 offen offset:0 sc1
buffer_load_dword v85, v124, s[20:23], s7 offen offset:512 sc1
buffer_load_dword v86, v124, s[20:23], s7 offen offset:1024 sc1
buffer_load_dword v87, v124, s[20:23], s7 offen offset:1536 sc1
buffer_load_dword v88, v124, s[20:23], s7 offen offset:2048 sc1
buffer_load_dword v89, v124, s[20:23], s7 offen offset:2560 sc1
s_lshl_b32 s3, s42, 11
s_lshl_b32 s7, s46, 7
s_add_u32 s3, s3, s7
buffer_load_ushort v90, v125, s[56:59], s3 offen
s_lshl_b32 s3, s42, 3
s_add_u32 s3, s3, 5259264
buffer_load_dwordx2 v[92:93], v126, s[20:23], s3 offen sc1
L_f_yl1:
s_lshl_b32 s7, s45, 2
s_add_u32 s7, s7, s32
s_lshr_b32 s3, s43, 5
s_cmp_lg_u32 s3, s7
s_cbranch_scc1 L_f_yl2
s_nop 0
s_add_u32 s3, s55, 256
s_add_u32 s7, s3, 4096
buffer_load_dword v94, v124, s[20:23], s3 offen offset:0 sc1
buffer_load_dword v95, v124, s[20:23], s3 offen offset:512 sc1
buffer_load_dword v96, v124, s[20:23], s3 offen offset:1024 sc1
buffer_load_dword v97, v124, s[20:23], s3 offen offset:1536 sc1
buffer_load_dword v98, v124, s[20:23], s3 offen offset:2048 sc1
buffer_load_dword v99, v124, s[20:23], s3 offen offset:2560 sc1
buffer_load_dword v100, v124, s[20:23], s3 offen offset:3072 sc1
buffer_load_dword v101, v124, s[20:23], s3 offen offset:3584 sc1
buffer_load_dword v102, v124, s[20:23], s7 offen offset:0 sc1
buffer_load_dword v103, v124, s[20:23], s7 offen offset:512 sc1
buffer_load_dword v104, v124, s[20:23], s7 offen offset:1024 sc1
buffer_load_dword v105, v124, s[20:23], s7 offen offset:1536 sc1
buffer_load_dword v106, v124, s[20:23], s7 offen offset:2048 sc1
buffer_load_dword v107, v124, s[20:23], s7 offen offset:2560 sc1
s_lshl_b32 s3, s43, 11
s_lshl_b32 s7, s46, 7
s_add_u32 s3, s3, s7
buffer_load_ushort v108, v125, s[56:59], s3 offen
s_lshl_b32 s3, s43, 3
s_add_u32 s3, s3, 5259264
buffer_load_dwordx2 v[110:111], v126, s[20:23], s3 offen sc1
L_f_yl2:
s_branch L_yBr
L_yC:
s_waitcnt vmcnt(4)
s_lshl_b32 s7, s45, 2
s_add_u32 s7, s7, s32
s_lshr_b32 s3, s42, 5
s_cmp_lg_u32 s3, s7
s_cbranch_scc1 L_f_ys3
s_nop 0
v_pk_add_f32 v[76:77], v[76:77], v[78:79]
v_pk_add_f32 v[76:77], v[76:77], v[80:81]
v_pk_add_f32 v[76:77], v[76:77], v[82:83]
v_pk_add_f32 v[76:77], v[76:77], v[84:85]
v_pk_add_f32 v[76:77], v[76:77], v[86:87]
v_pk_add_f32 v[76:77], v[76:77], v[88:89]
Va 76,76,77
v_lshlrev_b32 v90, 16, v90
v_sub_f32_e64 v90, v90, v92
Vc 76,76,76
v_lshlrev_b32_e64 v76, 16, v76
Vc 90,90,90
v_lshlrev_b32 v90, 16, v90
v_mul_f32 v76, s100, v76
v_mul_f32_e64 v90, v90, v93
Vc 76,76,76
v_lshlrev_b32_e64 v76, 16, v76
Vc 90,90,90
v_lshlrev_b32 v90, 16, v90
Va 90,90,76
Vc 90,90,90
v_lshlrev_b32_e64 v90, 16, v90
v_mul_f32 v76, 0xbfb8aa3b, v90
Ve 76,76
s_nop 0
v_add_f32 v76, 1.0, v76
v_rcp_f32 v76, v76
s_nop 0
Vm 90,90,76
Vc 90,90,90
v_lshlrev_b32 v90, 16, v90
v_lshlrev_b32 v124, 2, v0
v_add_u32 v124, s35, v124
v_lshlrev_b32 v125, 5, v122
v_add_u32 v125, s35, v125
s_waitcnt lgkmcnt(0)
ds_write_b32 v124, v90
s_and_b32 s3, s42, 7
s_lshl_b32 s3, s3, 3
s_lshl_b64 s[4:5], 0xff, s3
s_bfe_u32 s3, s42, 0x20003
s_mov_b64 exec, s[4:5]
s_cmp_lg_u32 s3, 0
s_cbranch_scc1 L_f_yp4
ds_read_b64 v[42:43], v125
ds_read_b64 v[44:45], v125 offset:8
ds_read_b64 v[46:47], v125 offset:16
ds_read_b64 v[48:49], v125 offset:24
L_f_yp4:
s_cmp_lg_u32 s3, 1
s_cbranch_scc1 L_f_yp5
ds_read_b64 v[50:51], v125
ds_read_b64 v[52:53], v125 offset:8
ds_read_b64 v[54:55], v125 offset:16
ds_read_b64 v[56:57], v125 offset:24
L_f_yp5:
s_cmp_lg_u32 s3, 2
s_cbranch_scc1 L_f_yp6
ds_read_b64 v[58:59], v125
ds_read_b64 v[60:61], v125 offset:8
ds_read_b64 v[62:63], v125 offset:16
ds_read_b64 v[64:65], v125 offset:24
L_f_yp6:
s_cmp_lg_u32 s3, 3
s_cbranch_scc1 L_f_yp7
ds_read_b64 v[66:67], v125
ds_read_b64 v[68:69], v125 offset:8
s_waitcnt lgkmcnt(9)
ds_read_b64 v[70:71], v125 offset:16
ds_read_b64 v[72:73], v125 offset:24
L_f_yp7:
s_mov_b64 exec, -1
s_waitcnt lgkmcnt(0)
L_f_ys3:
s_lshl_b32 s7, s45, 2
s_add_u32 s7, s7, s32
s_lshr_b32 s3, s43, 5
s_cmp_lg_u32 s3, s7
s_cbranch_scc1 L_f_ys8
s_nop 0
v_pk_add_f32 v[94:95], v[94:95], v[96:97]
v_pk_add_f32 v[94:95], v[94:95], v[98:99]
v_pk_add_f32 v[94:95], v[94:95], v[100:101]
v_pk_add_f32 v[94:95], v[94:95], v[102:103]
v_pk_add_f32 v[94:95], v[94:95], v[104:105]
v_pk_add_f32 v[94:95], v[94:95], v[106:107]
Va 94,94,95
v_lshlrev_b32 v108, 16, v108
v_sub_f32_e64 v108, v108, v110
Vc 94,94,94
v_lshlrev_b32_e64 v94, 16, v94
Vc 108,108,108
v_lshlrev_b32 v108, 16, v108
v_mul_f32 v94, s101, v94
v_mul_f32_e64 v108, v108, v111
Vc 94,94,94
v_lshlrev_b32_e64 v94, 16, v94
Vc 108,108,108
v_lshlrev_b32 v108, 16, v108
Va 108,108,94
Vc 108,108,108
v_lshlrev_b32_e64 v108, 16, v108
v_mul_f32 v94, 0xbfb8aa3b, v108
Ve 94,94
s_nop 0
v_add_f32 v94, 1.0, v94
v_rcp_f32 v94, v94
s_nop 0
Vm 108,108,94
Vc 108,108,108
v_lshlrev_b32 v108, 16, v108
v_lshlrev_b32 v124, 2, v0
v_add_u32 v124, s35, v124
v_lshlrev_b32 v125, 5, v122
v_add_u32 v125, s35, v125
s_waitcnt lgkmcnt(0)
ds_write_b32 v124, v108
s_and_b32 s3, s43, 7
s_lshl_b32 s3, s3, 3
s_lshl_b64 s[4:5], 0xff, s3
s_bfe_u32 s3, s43, 0x20003
s_mov_b64 exec, s[4:5]
s_cmp_lg_u32 s3, 0
s_cbranch_scc1 L_f_yp9
ds_read_b64 v[42:43], v125
ds_read_b64 v[44:45], v125 offset:8
ds_read_b64 v[46:47], v125 offset:16
ds_read_b64 v[48:49], v125 offset:24
L_f_yp9:
s_cmp_lg_u32 s3, 1
s_cbranch_scc1 L_f_yp10
ds_read_b64 v[50:51], v125
ds_read_b64 v[52:53], v125 offset:8
ds_read_b64 v[54:55], v125 offset:16
ds_read_b64 v[56:57], v125 offset:24
L_f_yp10:
s_cmp_lg_u32 s3, 2
s_cbranch_scc1 L_f_yp11
ds_read_b64 v[58:59], v125
ds_read_b64 v[60:61], v125 offset:8
ds_read_b64 v[62:63], v125 offset:16
ds_read_b64 v[64:65], v125 offset:24
L_f_yp11:
s_cmp_lg_u32 s3, 3
s_cbranch_scc1 L_f_yp12
ds_read_b64 v[66:67], v125
ds_read_b64 v[68:69], v125 offset:8
s_waitcnt lgkmcnt(9)
ds_read_b64 v[70:71], v125 offset:16
ds_read_b64 v[72:73], v125 offset:24
L_f_yp12:
s_mov_b64 exec, -1
s_waitcnt lgkmcnt(0)
L_f_ys8:
s_branch L_yCr
L_p4_end:
L_spinAk:
s_mov_b32 s47, 0x400000
L_spinAk_l:
s_sleep 8
buffer_load_dword v30, v31, s[28:31], 0 offen sc1
s_waitcnt vmcnt(0)
v_readfirstlane_b32 s3, v30
s_sub_u32 s47, s47, 1
s_cmp_eq_u32 s47, 0
s_cbranch_scc1 L_spinArk
s_cmp_lt_u32 s3, 256
s_cbranch_scc1 L_spinAk_l
s_branch L_spinArk
L_spinAv:
s_mov_b32 s47, 0x400000
L_spinAv_l:
s_sleep 8
buffer_load_dword v30, v31, s[28:31], 0 offen sc1
s_waitcnt vmcnt(0)
v_readfirstlane_b32 s3, v30
s_sub_u32 s47, s47, 1
s_cmp_eq_u32 s47, 0
s_cbranch_scc1 L_spinArv
s_cmp_lt_u32 s3, 256
s_cbranch_scc1 L_spinAv_l
s_branch L_spinArv
L_spinB:
s_mov_b32 s59, 0x400000
L_spinB_l:
s_sleep 4
buffer_load_dword v12, v1, s[20:23], s6 offen sc1
s_sub_u32 s59, s59, 1
s_cmp_eq_u32 s59, 0
s_cbranch_scc1 L_spinBx
s_waitcnt vmcnt(0)
v_cmp_ne_u32 vcc, 1, v12
s_cbranch_vccnz L_spinB_l
L_spinBx:
s_waitcnt vmcnt(0)
s_branch L_spinBr
L_k2_fb_we:
s_nop 7
s_nop 0
v_max3_f32 v21, v128, v129, v130
v_max3_f32 v21, v21, v131, v132
v_max3_f32 v21, v21, v133, v134
v_max3_f32 v21, v21, v135, v136
v_max3_f32 v21, v21, v137, v138
v_max3_f32 v21, v21, v139, v140
v_max3_f32 v21, v21, v141, v142
v_max_f32 v21, v21, v143
v_mov_b32 v1, v21
s_nop 1
v_permlane16_swap_b32 v1, v21
v_max_f32 v21, v21, v1
v_mov_b32 v1, v21
s_nop 1
v_permlane32_swap_b32 v1, v21
v_max_f32_e64 v21, v21, v1
v_add_f32 v21, 0x41f80000, v21
v_max_f32 v21, 0, v21
Vs 128,128,21
Vs 129,129,21
Vs 130,130,21
Vs 131,131,21
Vs 132,132,21
Vs 133,133,21
Vs 134,134,21
Vs 135,135,21
Vs 136,136,21
Vs 137,137,21
Vs 138,138,21
Vs 139,139,21
Vs 140,140,21
Vs 141,141,21
Vs 142,142,21
Vs 143,143,21
Vs 192,192,21
Vs 193,193,21
Vs 194,194,21
Vs 195,195,21
Vs 196,196,21
Vs 197,197,21
Vs 198,198,21
Vs 199,199,21
Vs 200,200,21
Vs 201,201,21
Vs 202,202,21
Vs 203,203,21
Vs 204,204,21
Vs 205,205,21
Vs 206,206,21
Vs 207,207,21
Vs 32,32,21
Vs 33,33,21
Vs 34,34,21
v_sub_f32_e64 v35, v35, v21
v_exp_f32 v22, -v21
s_nop 0
Vm 48,48,22
Vm 49,49,22
Vm 50,50,22
v_mul_f32_e64 v51, v51, v22
Ar 8,0
Ar 9,1
Ar 10,2
Ar 11,3
Ar 12,4
Ar 13,5
Ar 14,6
Ar 15,7
Vm 8,8,22
Vm 9,9,22
Vm 10,10,22
Vm 11,11,22
Vm 12,12,22
Vm 13,13,22
Vm 14,14,22
Vm 15,15,22
Aw 0,8
Aw 1,9
Aw 2,10
Aw 3,11
Aw 4,12
Aw 5,13
Aw 6,14
Aw 7,15
Ar 8,8
Ar 9,9
Ar 10,10
Ar 11,11
Ar 12,12
Ar 13,13
Ar 14,14
Ar 15,15
Vm 8,8,22
Vm 9,9,22
Vm 10,10,22
Vm 11,11,22
Vm 12,12,22
Vm 13,13,22
Vm 14,14,22
Vm 15,15,22
Aw 8,8
Aw 9,9
Aw 10,10
Aw 11,11
Aw 12,12
Aw 13,13
Aw 14,14
Aw 15,15
Ar 8,16
Ar 9,17
Ar 10,18
Ar 11,19
Ar 12,20
Ar 13,21
Ar 14,22
Ar 15,23
Vm 8,8,22
Vm 9,9,22
Vm 10,10,22
Vm 11,11,22
Vm 12,12,22
Vm 13,13,22
Vm 14,14,22
Vm 15,15,22
Aw 16,8
Aw 17,9
Aw 18,10
Aw 19,11
Aw 20,12
Aw 21,13
Aw 22,14
Aw 23,15
Ar 8,24
Ar 9,25
Ar 10,26
Ar 11,27
Ar 12,28
Ar 13,29
Ar 14,30
Ar 15,31
Vm 8,8,22
Vm 9,9,22
Vm 10,10,22
Vm 11,11,22
Vm 12,12,22
Vm 13,13,22
Vm 14,14,22
Vm 15,15,22
Aw 24,8
Aw 25,9
Aw 26,10
Aw 27,11
Aw 28,12
Aw 29,13
Aw 30,14
Aw 31,15
v_max3_f32 v21, v144, v145, v146
v_max3_f32 v21, v21, v147, v148
v_max3_f32 v21, v21, v149, v150
v_max3_f32 v21, v21, v151, v152
v_max3_f32 v21, v21, v153, v154
v_max3_f32 v21, v21, v155, v156
v_max3_f32 v21, v21, v157, v158
v_max_f32 v21, v21, v159
v_mov_b32 v1, v21
s_nop 1
v_permlane16_swap_b32 v1, v21
v_max_f32 v21, v21, v1
v_mov_b32 v1, v21
s_nop 1
v_permlane32_swap_b32 v1, v21
v_max_f32_e64 v21, v21, v1
v_add_f32 v21, 0x41f80000, v21
v_max_f32 v21, 0, v21
Vs 144,144,21
Vs 145,145,21
Vs 146,146,21
Vs 147,147,21
Vs 148,148,21
Vs 149,149,21
Vs 150,150,21
Vs 151,151,21
Vs 152,152,21
Vs 153,153,21
Vs 154,154,21
Vs 155,155,21
Vs 156,156,21
Vs 157,157,21
Vs 158,158,21
Vs 159,159,21
Vs 208,208,21
Vs 209,209,21
Vs 210,210,21
Vs 211,211,21
Vs 212,212,21
Vs 213,213,21
Vs 214,214,21
Vs 215,215,21
Vs 216,216,21
Vs 217,217,21
Vs 218,218,21
Vs 219,219,21
Vs 220,220,21
Vs 221,221,21
Vs 222,222,21
Vs 223,223,21
Vs 36,36,21
Vs 37,37,21
Vs 38,38,21
v_sub_f32_e64 v39, v39, v21
v_exp_f32 v22, -v21
s_nop 0
Vm 52,52,22
Vm 53,53,22
Vm 54,54,22
v_mul_f32_e64 v55, v55, v22
Ar 8,32
Ar 9,33
Ar 10,34
Ar 11,35
Ar 12,36
Ar 13,37
Ar 14,38
Ar 15,39
Vm 8,8,22
Vm 9,9,22
Vm 10,10,22
Vm 11,11,22
Vm 12,12,22
Vm 13,13,22
Vm 14,14,22
Vm 15,15,22
Aw 32,8
Aw 33,9
Aw 34,10
Aw 35,11
Aw 36,12
Aw 37,13
Aw 38,14
Aw 39,15
Ar 8,40
Ar 9,41
Ar 10,42
Ar 11,43
Ar 12,44
Ar 13,45
Ar 14,46
Ar 15,47
Vm 8,8,22
Vm 9,9,22
Vm 10,10,22
Vm 11,11,22
Vm 12,12,22
Vm 13,13,22
Vm 14,14,22
Vm 15,15,22
Aw 40,8
Aw 41,9
Aw 42,10
Aw 43,11
Aw 44,12
Aw 45,13
Aw 46,14
Aw 47,15
Ar 8,48
Ar 9,49
Ar 10,50
Ar 11,51
Ar 12,52
Ar 13,53
Ar 14,54
Ar 15,55
Vm 8,8,22
Vm 9,9,22
Vm 10,10,22
Vm 11,11,22
Vm 12,12,22
Vm 13,13,22
Vm 14,14,22
Vm 15,15,22
Aw 48,8
Aw 49,9
Aw 50,10
Aw 51,11
Aw 52,12
Aw 53,13
Aw 54,14
Aw 55,15
Ar 8,56
Ar 9,57
Ar 10,58
Ar 11,59
Ar 12,60
Ar 13,61
Ar 14,62
Ar 15,63
Vm 8,8,22
Vm 9,9,22
Vm 10,10,22
Vm 11,11,22
Vm 12,12,22
Vm 13,13,22
Vm 14,14,22
Vm 15,15,22
Aw 56,8
Aw 57,9
Aw 58,10
Aw 59,11
Aw 60,12
Aw 61,13
Aw 62,14
Aw 63,15
v_max3_f32 v21, v160, v161, v162
v_max3_f32 v21, v21, v163, v164
v_max3_f32 v21, v21, v165, v166
v_max3_f32 v21, v21, v167, v168
v_max3_f32 v21, v21, v169, v170
v_max3_f32 v21, v21, v171, v172
v_max3_f32 v21, v21, v173, v174
v_max_f32 v21, v21, v175
v_mov_b32 v1, v21
s_nop 1
v_permlane16_swap_b32 v1, v21
v_max_f32 v21, v21, v1
v_mov_b32 v1, v21
s_nop 1
v_permlane32_swap_b32 v1, v21
v_max_f32_e64 v21, v21, v1
v_add_f32 v21, 0x41f80000, v21
v_max_f32 v21, 0, v21
Vs 160,160,21
Vs 161,161,21
Vs 162,162,21
Vs 163,163,21
Vs 164,164,21
Vs 165,165,21
Vs 166,166,21
Vs 167,167,21
Vs 168,168,21
Vs 169,169,21
Vs 170,170,21
Vs 171,171,21
Vs 172,172,21
Vs 173,173,21
Vs 174,174,21
Vs 175,175,21
Vs 224,224,21
Vs 225,225,21
Vs 226,226,21
Vs 227,227,21
Vs 228,228,21
Vs 229,229,21
Vs 230,230,21
Vs 231,231,21
Vs 232,232,21
Vs 233,233,21
Vs 234,234,21
Vs 235,235,21
Vs 236,236,21
Vs 237,237,21
Vs 238,238,21
Vs 239,239,21
Vs 40,40,21
Vs 41,41,21
Vs 42,42,21
v_sub_f32_e64 v43, v43, v21
v_exp_f32 v22, -v21
s_nop 0
Vm 56,56,22
Vm 57,57,22
Vm 58,58,22
v_mul_f32_e64 v59, v59, v22
Ar 8,64
Ar 9,65
Ar 10,66
Ar 11,67
Ar 12,68
Ar 13,69
Ar 14,70
Ar 15,71
Vm 8,8,22
Vm 9,9,22
Vm 10,10,22
Vm 11,11,22
Vm 12,12,22
Vm 13,13,22
Vm 14,14,22
Vm 15,15,22
Aw 64,8
Aw 65,9
Aw 66,10
Aw 67,11
Aw 68,12
Aw 69,13
Aw 70,14
Aw 71,15
Ar 8,72
Ar 9,73
Ar 10,74
Ar 11,75
Ar 12,76
Ar 13,77
Ar 14,78
Ar 15,79
Vm 8,8,22
Vm 9,9,22
Vm 10,10,22
Vm 11,11,22
Vm 12,12,22
Vm 13,13,22
Vm 14,14,22
Vm 15,15,22
Aw 72,8
Aw 73,9
Aw 74,10
Aw 75,11
Aw 76,12
Aw 77,13
Aw 78,14
Aw 79,15
Ar 8,80
Ar 9,81
Ar 10,82
Ar 11,83
Ar 12,84
Ar 13,85
Ar 14,86
Ar 15,87
Vm 8,8,22
Vm 9,9,22
Vm 10,10,22
Vm 11,11,22
Vm 12,12,22
Vm 13,13,22
Vm 14,14,22
Vm 15,15,22
Aw 80,8
Aw 81,9
Aw 82,10
Aw 83,11
Aw 84,12
Aw 85,13
Aw 86,14
Aw 87,15
Ar 8,88
Ar 9,89
Ar 10,90
Ar 11,91
Ar 12,92
Ar 13,93
Ar 14,94
Ar 15,95
Vm 8,8,22
Vm 9,9,22
Vm 10,10,22
Vm 11,11,22
Vm 12,12,22
Vm 13,13,22
Vm 14,14,22
Vm 15,15,22
Aw 88,8
Aw 89,9
Aw 90,10
Aw 91,11
Aw 92,12
Aw 93,13
Aw 94,14
Aw 95,15
v_max3_f32 v21, v176, v177, v178
v_max3_f32 v21, v21, v179, v180
v_max3_f32 v21, v21, v181, v182
v_max3_f32 v21, v21, v183, v184
v_max3_f32 v21, v21, v185, v186
v_max3_f32 v21, v21, v187, v188
v_max3_f32 v21, v21, v189, v190
v_max_f32 v21, v21, v191
v_mov_b32 v1, v21
s_nop 1
v_permlane16_swap_b32 v1, v21
v_max_f32 v21, v21, v1
v_mov_b32 v1, v21
s_nop 1
v_permlane32_swap_b32 v1, v21
v_max_f32_e64 v21, v21, v1
v_add_f32 v21, 0x41f80000, v21
v_max_f32 v21, 0, v21
Vs 176,176,21
Vs 177,177,21
Vs 178,178,21
Vs 179,179,21
Vs 180,180,21
Vs 181,181,21
Vs 182,182,21
Vs 183,183,21
Vs 184,184,21
Vs 185,185,21
Vs 186,186,21
Vs 187,187,21
Vs 188,188,21
Vs 189,189,21
Vs 190,190,21
Vs 191,191,21
Vs 240,240,21
Vs 241,241,21
Vs 242,242,21
Vs 243,243,21
Vs 244,244,21
Vs 245,245,21
Vs 246,246,21
Vs 247,247,21
Vs 248,248,21
Vs 249,249,21
Vs 250,250,21
Vs 251,251,21
Vs 252,252,21
Vs 253,253,21
Vs 254,254,21
Vs 255,255,21
Vs 44,44,21
Vs 45,45,21
Vs 46,46,21
v_sub_f32_e64 v47, v47, v21
v_exp_f32 v22, -v21
s_nop 0
Vm 60,60,22
Vm 61,61,22
Vm 62,62,22
v_mul_f32_e64 v63, v63, v22
Ar 8,96
Ar 9,97
Ar 10,98
Ar 11,99
Ar 12,100
Ar 13,101
Ar 14,102
Ar 15,103
Vm 8,8,22
Vm 9,9,22
Vm 10,10,22
Vm 11,11,22
Vm 12,12,22
Vm 13,13,22
Vm 14,14,22
Vm 15,15,22
Aw 96,8
Aw 97,9
Aw 98,10
Aw 99,11
Aw 100,12
Aw 101,13
Aw 102,14
Aw 103,15
Ar 8,104
Ar 9,105
Ar 10,106
Ar 11,107
Ar 12,108
Ar 13,109
Ar 14,110
Ar 15,111
Vm 8,8,22
Vm 9,9,22
Vm 10,10,22
Vm 11,11,22
Vm 12,12,22
Vm 13,13,22
Vm 14,14,22
Vm 15,15,22
Aw 104,8
Aw 105,9
Aw 106,10
Aw 107,11
Aw 108,12
Aw 109,13
Aw 110,14
Aw 111,15
Ar 8,112
Ar 9,113
Ar 10,114
Ar 11,115
Ar 12,116
Ar 13,117
Ar 14,118
Ar 15,119
Vm 8,8,22
Vm 9,9,22
Vm 10,10,22
Vm 11,11,22
Vm 12,12,22
Vm 13,13,22
Vm 14,14,22
Vm 15,15,22
Aw 112,8
Aw 113,9
Aw 114,10
Aw 115,11
Aw 116,12
Aw 117,13
Aw 118,14
Aw 119,15
Ar 8,120
Ar 9,121
Ar 10,122
Ar 11,123
Ar 12,124
Ar 13,125
Ar 14,126
Ar 15,127
Vm 8,8,22
Vm 9,9,22
Vm 10,10,22
Vm 11,11,22
Vm 12,12,22
Vm 13,13,22
Vm 14,14,22
Vm 15,15,22
Aw 120,8
Aw 121,9
Aw 122,10
Aw 123,11
Aw 124,12
Aw 125,13
Aw 126,14
Aw 127,15
Ve 8,128
Ve 9,129
s_nop 0
Vc 64,8,9
Ve 8,130
Ve 9,131
s_nop 0
Vc 65,8,9
Ve 8,144
Ve 9,145
s_nop 0
Vc 72,8,9
Ve 8,146
Ve 9,147
s_nop 0
Vc 73,8,9
Ve 8,160
Ve 9,161
s_nop 0
Vc 80,8,9
Ve 8,162
Ve 9,163
s_nop 0
Vc 81,8,9
Ve 8,176
Ve 9,177
s_nop 0
Vc 88,8,9
Ve 8,178
Ve 9,179
s_nop 0
Vc 89,8,9
Ve 8,132
Ve 9,133
s_nop 0
Vc 66,8,9
Ve 8,134
Ve 9,135
s_nop 0
Vc 67,8,9
Ve 8,148
Ve 9,149
s_nop 0
Vc 74,8,9
Ve 8,150
Ve 9,151
s_nop 0
Vc 75,8,9
Ve 8,164
Ve 9,165
s_nop 0
Vc 82,8,9
Ve 8,166
Ve 9,167
s_nop 0
Vc 83,8,9
Ve 8,180
Ve 9,181
s_nop 0
Vc 90,8,9
Ve 8,182
Ve 9,183
s_nop 0
Vc 91,8,9
Ve 8,136
Ve 9,137
s_nop 0
Vc 68,8,9
Ve 8,138
Ve 9,139
s_nop 0
Vc 69,8,9
Ve 8,152
Ve 9,153
s_nop 0
Vc 76,8,9
Ve 8,154
Ve 9,155
s_nop 0
Vc 77,8,9
Ve 8,168
Ve 9,169
s_nop 0
Vc 84,8,9
Ve 8,170
Ve 9,171
s_nop 0
Vc 85,8,9
Ve 8,184
Ve 9,185
s_nop 0
Vc 92,8,9
Ve 8,186
Ve 9,187
s_nop 0
Vc 93,8,9
Ve 8,140
Ve 9,141
s_nop 0
Vc 70,8,9
Ve 8,142
Ve 9,143
s_nop 0
Vc 71,8,9
Ve 8,156
Ve 9,157
s_nop 0
Vc 78,8,9
Ve 8,158
Ve 9,159
s_nop 0
Vc 79,8,9
Ve 8,172
Ve 9,173
s_nop 0
Vc 86,8,9
Ve 8,174
Ve 9,175
s_nop 0
Vc 87,8,9
Ve 8,188
Ve 9,189
s_nop 0
Vc 94,8,9
Ve 8,190
Ve 9,191
s_nop 0
Vc 95,8,9
s_nop 1
s_branch L_k2_fbr_we
L_k2_fb_wo:
s_nop 7
s_nop 0
v_max3_f32 v21, v192, v193, v194
v_max3_f32 v21, v21, v195, v196
v_max3_f32 v21, v21, v197, v198
v_max3_f32 v21, v21, v199, v200
v_max3_f32 v21, v21, v201, v202
v_max3_f32 v21, v21, v203, v204
v_max3_f32 v21, v21, v205, v206
v_max_f32 v21, v21, v207
v_mov_b32 v1, v21
s_nop 1
v_permlane16_swap_b32 v1, v21
v_max_f32 v21, v21, v1
v_mov_b32 v1, v21
s_nop 1
v_permlane32_swap_b32 v1, v21
v_max_f32_e64 v21, v21, v1
v_add_f32 v21, 0x41f80000, v21
v_max_f32 v21, 0, v21
Vs 192,192,21
Vs 193,193,21
Vs 194,194,21
Vs 195,195,21
Vs 196,196,21
Vs 197,197,21
Vs 198,198,21
Vs 199,199,21
Vs 200,200,21
Vs 201,201,21
Vs 202,202,21
Vs 203,203,21
Vs 204,204,21
Vs 205,205,21
Vs 206,206,21
Vs 207,207,21
Vs 128,128,21
Vs 129,129,21
Vs 130,130,21
Vs 131,131,21
Vs 132,132,21
Vs 133,133,21
Vs 134,134,21
Vs 135,135,21
Vs 136,136,21
Vs 137,137,21
Vs 138,138,21
Vs 139,139,21
Vs 140,140,21
Vs 141,141,21
Vs 142,142,21
Vs 143,143,21
Vs 32,32,21
Vs 33,33,21
Vs 34,34,21
v_sub_f32_e64 v35, v35, v21
v_exp_f32 v22, -v21
s_nop 0
Vm 48,48,22
Vm 49,49,22
Vm 50,50,22
v_mul_f32_e64 v51, v51, v22
Ar 8,0
Ar 9,1
Ar 10,2
Ar 11,3
Ar 12,4
Ar 13,5
Ar 14,6
Ar 15,7
Vm 8,8,22
Vm 9,9,22
Vm 10,10,22
Vm 11,11,22
Vm 12,12,22
Vm 13,13,22
Vm 14,14,22
Vm 15,15,22
Aw 0,8
Aw 1,9
Aw 2,10
Aw 3,11
Aw 4,12
Aw 5,13
Aw 6,14
Aw 7,15
Ar 8,8
Ar 9,9
Ar 10,10
Ar 11,11
Ar 12,12
Ar 13,13
Ar 14,14
Ar 15,15
Vm 8,8,22
Vm 9,9,22
Vm 10,10,22
Vm 11,11,22
Vm 12,12,22
Vm 13,13,22
Vm 14,14,22
Vm 15,15,22
Aw 8,8
Aw 9,9
Aw 10,10
Aw 11,11
Aw 12,12
Aw 13,13
Aw 14,14
Aw 15,15
Ar 8,16
Ar 9,17
Ar 10,18
Ar 11,19
Ar 12,20
Ar 13,21
Ar 14,22
Ar 15,23
Vm 8,8,22
Vm 9,9,22
Vm 10,10,22
Vm 11,11,22
Vm 12,12,22
Vm 13,13,22
Vm 14,14,22
Vm 15,15,22
Aw 16,8
Aw 17,9
Aw 18,10
Aw 19,11
Aw 20,12
Aw 21,13
Aw 22,14
Aw 23,15
Ar 8,24
Ar 9,25
Ar 10,26
Ar 11,27
Ar 12,28
Ar 13,29
Ar 14,30
Ar 15,31
Vm 8,8,22
Vm 9,9,22
Vm 10,10,22
Vm 11,11,22
Vm 12,12,22
Vm 13,13,22
Vm 14,14,22
Vm 15,15,22
Aw 24,8
Aw 25,9
Aw 26,10
Aw 27,11
Aw 28,12
Aw 29,13
Aw 30,14
Aw 31,15
v_max3_f32 v21, v208, v209, v210
v_max3_f32 v21, v21, v211, v212
v_max3_f32 v21, v21, v213, v214
v_max3_f32 v21, v21, v215, v216
v_max3_f32 v21, v21, v217, v218
v_max3_f32 v21, v21, v219, v220
v_max3_f32 v21, v21, v221, v222
v_max_f32 v21, v21, v223
v_mov_b32 v1, v21
s_nop 1
v_permlane16_swap_b32 v1, v21
v_max_f32 v21, v21, v1
v_mov_b32 v1, v21
s_nop 1
v_permlane32_swap_b32 v1, v21
v_max_f32_e64 v21, v21, v1
v_add_f32 v21, 0x41f80000, v21
v_max_f32 v21, 0, v21
Vs 208,208,21
Vs 209,209,21
Vs 210,210,21
Vs 211,211,21
Vs 212,212,21
Vs 213,213,21
Vs 214,214,21
Vs 215,215,21
Vs 216,216,21
Vs 217,217,21
Vs 218,218,21
Vs 219,219,21
Vs 220,220,21
Vs 221,221,21
Vs 222,222,21
Vs 223,223,21
Vs 144,144,21
Vs 145,145,21
Vs 146,146,21
Vs 147,147,21
Vs 148,148,21
Vs 149,149,21
Vs 150,150,21
Vs 151,151,21
Vs 152,152,21
Vs 153,153,21
Vs 154,154,21
Vs 155,155,21
Vs 156,156,21
Vs 157,157,21
Vs 158,158,21
Vs 159,159,21
Vs 36,36,21
Vs 37,37,21
Vs 38,38,21
v_sub_f32_e64 v39, v39, v21
v_exp_f32 v22, -v21
s_nop 0
Vm 52,52,22
Vm 53,53,22
Vm 54,54,22
v_mul_f32_e64 v55, v55, v22
Ar 8,32
Ar 9,33
Ar 10,34
Ar 11,35
Ar 12,36
Ar 13,37
Ar 14,38
Ar 15,39
Vm 8,8,22
Vm 9,9,22
Vm 10,10,22
Vm 11,11,22
Vm 12,12,22
Vm 13,13,22
Vm 14,14,22
Vm 15,15,22
Aw 32,8
Aw 33,9
Aw 34,10
Aw 35,11
Aw 36,12
Aw 37,13
Aw 38,14
Aw 39,15
Ar 8,40
Ar 9,41
Ar 10,42
Ar 11,43
Ar 12,44
Ar 13,45
Ar 14,46
Ar 15,47
Vm 8,8,22
Vm 9,9,22
Vm 10,10,22
Vm 11,11,22
Vm 12,12,22
Vm 13,13,22
Vm 14,14,22
Vm 15,15,22
Aw 40,8
Aw 41,9
Aw 42,10
Aw 43,11
Aw 44,12
Aw 45,13
Aw 46,14
Aw 47,15
Ar 8,48
Ar 9,49
Ar 10,50
Ar 11,51
Ar 12,52
Ar 13,53
Ar 14,54
Ar 15,55
Vm 8,8,22
Vm 9,9,22
Vm 10,10,22
Vm 11,11,22
Vm 12,12,22
Vm 13,13,22
Vm 14,14,22
Vm 15,15,22
Aw 48,8
Aw 49,9
Aw 50,10
Aw 51,11
Aw 52,12
Aw 53,13
Aw 54,14
Aw 55,15
Ar 8,56
Ar 9,57
Ar 10,58
Ar 11,59
Ar 12,60
Ar 13,61
Ar 14,62
Ar 15,63
Vm 8,8,22
Vm 9,9,22
Vm 10,10,22
Vm 11,11,22
Vm 12,12,22
Vm 13,13,22
Vm 14,14,22
Vm 15,15,22
Aw 56,8
Aw 57,9
Aw 58,10
Aw 59,11
Aw 60,12
Aw 61,13
Aw 62,14
Aw 63,15
v_max3_f32 v21, v224, v225, v226
v_max3_f32 v21, v21, v227, v228
v_max3_f32 v21, v21, v229, v230
v_max3_f32 v21, v21, v231, v232
v_max3_f32 v21, v21, v233, v234
v_max3_f32 v21, v21, v235, v236
v_max3_f32 v21, v21, v237, v238
v_max_f32 v21, v21, v239
v_mov_b32 v1, v21
s_nop 1
v_permlane16_swap_b32 v1, v21
v_max_f32 v21, v21, v1
v_mov_b32 v1, v21
s_nop 1
v_permlane32_swap_b32 v1, v21
v_max_f32_e64 v21, v21, v1
v_add_f32 v21, 0x41f80000, v21
v_max_f32 v21, 0, v21
Vs 224,224,21
Vs 225,225,21
Vs 226,226,21
Vs 227,227,21
Vs 228,228,21
Vs 229,229,21
Vs 230,230,21
Vs 231,231,21
Vs 232,232,21
Vs 233,233,21
Vs 234,234,21
Vs 235,235,21
Vs 236,236,21
Vs 237,237,21
Vs 238,238,21
Vs 239,239,21
Vs 160,160,21
Vs 161,161,21
Vs 162,162,21
Vs 163,163,21
Vs 164,164,21
Vs 165,165,21
Vs 166,166,21
Vs 167,167,21
Vs 168,168,21
Vs 169,169,21
Vs 170,170,21
Vs 171,171,21
Vs 172,172,21
Vs 173,173,21
Vs 174,174,21
Vs 175,175,21
Vs 40,40,21
Vs 41,41,21
Vs 42,42,21
v_sub_f32_e64 v43, v43, v21
v_exp_f32 v22, -v21
s_nop 0
Vm 56,56,22
Vm 57,57,22
Vm 58,58,22
v_mul_f32_e64 v59, v59, v22
Ar 8,64
Ar 9,65
Ar 10,66
Ar 11,67
Ar 12,68
Ar 13,69
Ar 14,70
Ar 15,71
Vm 8,8,22
Vm 9,9,22
Vm 10,10,22
Vm 11,11,22
Vm 12,12,22
Vm 13,13,22
Vm 14,14,22
Vm 15,15,22
Aw 64,8
Aw 65,9
Aw 66,10
Aw 67,11
Aw 68,12
Aw 69,13
Aw 70,14
Aw 71,15
Ar 8,72
Ar 9,73
Ar 10,74
Ar 11,75
Ar 12,76
Ar 13,77
Ar 14,78
Ar 15,79
Vm 8,8,22
Vm 9,9,22
Vm 10,10,22
Vm 11,11,22
Vm 12,12,22
Vm 13,13,22
Vm 14,14,22
Vm 15,15,22
Aw 72,8
Aw 73,9
Aw 74,10
Aw 75,11
Aw 76,12
Aw 77,13
Aw 78,14
Aw 79,15
Ar 8,80
Ar 9,81
Ar 10,82
Ar 11,83
Ar 12,84
Ar 13,85
Ar 14,86
Ar 15,87
Vm 8,8,22
Vm 9,9,22
Vm 10,10,22
Vm 11,11,22
Vm 12,12,22
Vm 13,13,22
Vm 14,14,22
Vm 15,15,22
Aw 80,8
Aw 81,9
Aw 82,10
Aw 83,11
Aw 84,12
Aw 85,13
Aw 86,14
Aw 87,15
Ar 8,88
Ar 9,89
Ar 10,90
Ar 11,91
Ar 12,92
Ar 13,93
Ar 14,94
Ar 15,95
Vm 8,8,22
Vm 9,9,22
Vm 10,10,22
Vm 11,11,22
Vm 12,12,22
Vm 13,13,22
Vm 14,14,22
Vm 15,15,22
Aw 88,8
Aw 89,9
Aw 90,10
Aw 91,11
Aw 92,12
Aw 93,13
Aw 94,14
Aw 95,15
v_max3_f32 v21, v240, v241, v242
v_max3_f32 v21, v21, v243, v244
v_max3_f32 v21, v21, v245, v246
v_max3_f32 v21, v21, v247, v248
v_max3_f32 v21, v21, v249, v250
v_max3_f32 v21, v21, v251, v252
v_max3_f32 v21, v21, v253, v254
v_max_f32 v21, v21, v255
v_mov_b32 v1, v21
s_nop 1
v_permlane16_swap_b32 v1, v21
v_max_f32 v21, v21, v1
v_mov_b32 v1, v21
s_nop 1
v_permlane32_swap_b32 v1, v21
v_max_f32_e64 v21, v21, v1
v_add_f32 v21, 0x41f80000, v21
v_max_f32 v21, 0, v21
Vs 240,240,21
Vs 241,241,21
Vs 242,242,21
Vs 243,243,21
Vs 244,244,21
Vs 245,245,21
Vs 246,246,21
Vs 247,247,21
Vs 248,248,21
Vs 249,249,21
Vs 250,250,21
Vs 251,251,21
Vs 252,252,21
Vs 253,253,21
Vs 254,254,21
Vs 255,255,21
Vs 176,176,21
Vs 177,177,21
Vs 178,178,21
Vs 179,179,21
Vs 180,180,21
Vs 181,181,21
Vs 182,182,21
Vs 183,183,21
Vs 184,184,21
Vs 185,185,21
Vs 186,186,21
Vs 187,187,21
Vs 188,188,21
Vs 189,189,21
Vs 190,190,21
Vs 191,191,21
Vs 44,44,21
Vs 45,45,21
Vs 46,46,21
v_sub_f32_e64 v47, v47, v21
v_exp_f32 v22, -v21
s_nop 0
Vm 60,60,22
Vm 61,61,22
Vm 62,62,22
v_mul_f32_e64 v63, v63, v22
Ar 8,96
Ar 9,97
Ar 10,98
Ar 11,99
Ar 12,100
Ar 13,101
Ar 14,102
Ar 15,103
Vm 8,8,22
Vm 9,9,22
Vm 10,10,22
Vm 11,11,22
Vm 12,12,22
Vm 13,13,22
Vm 14,14,22
Vm 15,15,22
Aw 96,8
Aw 97,9
Aw 98,10
Aw 99,11
Aw 100,12
Aw 101,13
Aw 102,14
Aw 103,15
Ar 8,104
Ar 9,105
Ar 10,106
Ar 11,107
Ar 12,108
Ar 13,109
Ar 14,110
Ar 15,111
Vm 8,8,22
Vm 9,9,22
Vm 10,10,22
Vm 11,11,22
Vm 12,12,22
Vm 13,13,22
Vm 14,14,22
Vm 15,15,22
Aw 104,8
Aw 105,9
Aw 106,10
Aw 107,11
Aw 108,12
Aw 109,13
Aw 110,14
Aw 111,15
Ar 8,112
Ar 9,113
Ar 10,114
Ar 11,115
Ar 12,116
Ar 13,117
Ar 14,118
Ar 15,119
Vm 8,8,22
Vm 9,9,22
Vm 10,10,22
Vm 11,11,22
Vm 12,12,22
Vm 13,13,22
Vm 14,14,22
Vm 15,15,22
Aw 112,8
Aw 113,9
Aw 114,10
Aw 115,11
Aw 116,12
Aw 117,13
Aw 118,14
Aw 119,15
Ar 8,120
Ar 9,121
Ar 10,122
Ar 11,123
Ar 12,124
Ar 13,125
Ar 14,126
Ar 15,127
Vm 8,8,22
Vm 9,9,22
Vm 10,10,22
Vm 11,11,22
Vm 12,12,22
Vm 13,13,22
Vm 14,14,22
Vm 15,15,22
Aw 120,8
Aw 121,9
Aw 122,10
Aw 123,11
Aw 124,12
Aw 125,13
Aw 126,14
Aw 127,15
Ve 8,192
Ve 9,193
s_nop 0
Vc 96,8,9
Ve 8,194
Ve 9,195
s_nop 0
Vc 97,8,9
Ve 8,208
Ve 9,209
s_nop 0
Vc 104,8,9
Ve 8,210
Ve 9,211
s_nop 0
Vc 105,8,9
Ve 8,224
Ve 9,225
s_nop 0
Vc 112,8,9
Ve 8,226
Ve 9,227
s_nop 0
Vc 113,8,9
Ve 8,240
Ve 9,241
s_nop 0
Vc 120,8,9
Ve 8,242
Ve 9,243
s_nop 0
Vc 121,8,9
Ve 8,196
Ve 9,197
s_nop 0
Vc 98,8,9
Ve 8,198
Ve 9,199
s_nop 0
Vc 99,8,9
Ve 8,212
Ve 9,213
s_nop 0
Vc 106,8,9
Ve 8,214
Ve 9,215
s_nop 0
Vc 107,8,9
Ve 8,228
Ve 9,229
s_nop 0
Vc 114,8,9
Ve 8,230
Ve 9,231
s_nop 0
Vc 115,8,9
Ve 8,244
Ve 9,245
s_nop 0
Vc 122,8,9
Ve 8,246
Ve 9,247
s_nop 0
Vc 123,8,9
Ve 8,200
Ve 9,201
s_nop 0
Vc 100,8,9
Ve 8,202
Ve 9,203
s_nop 0
Vc 101,8,9
Ve 8,216
Ve 9,217
s_nop 0
Vc 108,8,9
Ve 8,218
Ve 9,219
s_nop 0
Vc 109,8,9
Ve 8,232
Ve 9,233
s_nop 0
Vc 116,8,9
Ve 8,234
Ve 9,235
s_nop 0
Vc 117,8,9
Ve 8,248
Ve 9,249
s_nop 0
Vc 124,8,9
Ve 8,250
Ve 9,251
s_nop 0
Vc 125,8,9
Ve 8,204
Ve 9,205
s_nop 0
Vc 102,8,9
Ve 8,206
Ve 9,207
s_nop 0
Vc 103,8,9
Ve 8,220
Ve 9,221
s_nop 0
Vc 110,8,9
Ve 8,222
Ve 9,223
s_nop 0
Vc 111,8,9
Ve 8,236
Ve 9,237
s_nop 0
Vc 118,8,9
Ve 8,238
Ve 9,239
s_nop 0
Vc 119,8,9
Ve 8,252
Ve 9,253
s_nop 0
Vc 126,8,9
Ve 8,254
Ve 9,255
s_nop 0
Vc 127,8,9
s_nop 1
s_branch L_k2_fbr_wo
L_k2_fb_wl:
s_nop 7
s_nop 0
v_max3_f32 v21, v128, v129, v130
v_max3_f32 v21, v21, v131, v132
v_max3_f32 v21, v21, v133, v134
v_max3_f32 v21, v21, v135, v136
v_max3_f32 v21, v21, v137, v138
v_max3_f32 v21, v21, v139, v140
v_max3_f32 v21, v21, v141, v142
v_max_f32 v21, v21, v143
v_mov_b32 v1, v21
s_nop 1
v_permlane16_swap_b32 v1, v21
v_max_f32 v21, v21, v1
v_mov_b32 v1, v21
s_nop 1
v_permlane32_swap_b32 v1, v21
v_max_f32_e64 v21, v21, v1
v_add_f32 v21, 0x41f80000, v21
v_max_f32 v21, 0, v21
Vs 128,128,21
Vs 129,129,21
Vs 130,130,21
Vs 131,131,21
Vs 132,132,21
Vs 133,133,21
Vs 134,134,21
Vs 135,135,21
Vs 136,136,21
Vs 137,137,21
Vs 138,138,21
Vs 139,139,21
Vs 140,140,21
Vs 141,141,21
Vs 142,142,21
Vs 143,143,21
Vs 192,192,21
Vs 193,193,21
Vs 194,194,21
Vs 195,195,21
Vs 196,196,21
Vs 197,197,21
Vs 198,198,21
Vs 199,199,21
Vs 200,200,21
Vs 201,201,21
Vs 202,202,21
Vs 203,203,21
Vs 204,204,21
Vs 205,205,21
Vs 206,206,21
Vs 207,207,21
Vs 32,32,21
Vs 33,33,21
Vs 34,34,21
v_sub_f32_e64 v35, v35, v21
v_exp_f32 v22, -v21
s_nop 0
Vm 48,48,22
Vm 49,49,22
Vm 50,50,22
v_mul_f32_e64 v51, v51, v22
Ar 8,0
Ar 9,1
Ar 10,2
Ar 11,3
Ar 12,4
Ar 13,5
Ar 14,6
Ar 15,7
Vm 8,8,22
Vm 9,9,22
Vm 10,10,22
Vm 11,11,22
Vm 12,12,22
Vm 13,13,22
Vm 14,14,22
Vm 15,15,22
Aw 0,8
Aw 1,9
Aw 2,10
Aw 3,11
Aw 4,12
Aw 5,13
Aw 6,14
Aw 7,15
Ar 8,8
Ar 9,9
Ar 10,10
Ar 11,11
Ar 12,12
Ar 13,13
Ar 14,14
Ar 15,15
Vm 8,8,22
Vm 9,9,22
Vm 10,10,22
Vm 11,11,22
Vm 12,12,22
Vm 13,13,22
Vm 14,14,22
Vm 15,15,22
Aw 8,8
Aw 9,9
Aw 10,10
Aw 11,11
Aw 12,12
Aw 13,13
Aw 14,14
Aw 15,15
Ar 8,16
Ar 9,17
Ar 10,18
Ar 11,19
Ar 12,20
Ar 13,21
Ar 14,22
Ar 15,23
Vm 8,8,22
Vm 9,9,22
Vm 10,10,22
Vm 11,11,22
Vm 12,12,22
Vm 13,13,22
Vm 14,14,22
Vm 15,15,22
Aw 16,8
Aw 17,9
Aw 18,10
Aw 19,11
Aw 20,12
Aw 21,13
Aw 22,14
Aw 23,15
Ar 8,24
Ar 9,25
Ar 10,26
Ar 11,27
Ar 12,28
Ar 13,29
Ar 14,30
Ar 15,31
Vm 8,8,22
Vm 9,9,22
Vm 10,10,22
Vm 11,11,22
Vm 12,12,22
Vm 13,13,22
Vm 14,14,22
Vm 15,15,22
Aw 24,8
Aw 25,9
Aw 26,10
Aw 27,11
Aw 28,12
Aw 29,13
Aw 30,14
Aw 31,15
v_max3_f32 v21, v144, v145, v146
v_max3_f32 v21, v21, v147, v148
v_max3_f32 v21, v21, v149, v150
v_max3_f32 v21, v21, v151, v152
v_max3_f32 v21, v21, v153, v154
v_max3_f32 v21, v21, v155, v156
v_max3_f32 v21, v21, v157, v158
v_max_f32 v21, v21, v159
v_mov_b32 v1, v21
s_nop 1
v_permlane16_swap_b32 v1, v21
v_max_f32 v21, v21, v1
v_mov_b32 v1, v21
s_nop 1
v_permlane32_swap_b32 v1, v21
v_max_f32_e64 v21, v21, v1
v_add_f32 v21, 0x41f80000, v21
v_max_f32 v21, 0, v21
Vs 144,144,21
Vs 145,145,21
Vs 146,146,21
Vs 147,147,21
Vs 148,148,21
Vs 149,149,21
Vs 150,150,21
Vs 151,151,21
Vs 152,152,21
Vs 153,153,21
Vs 154,154,21
Vs 155,155,21
Vs 156,156,21
Vs 157,157,21
Vs 158,158,21
Vs 159,159,21
Vs 208,208,21
Vs 209,209,21
Vs 210,210,21
Vs 211,211,21
Vs 212,212,21
Vs 213,213,21
Vs 214,214,21
Vs 215,215,21
Vs 216,216,21
Vs 217,217,21
Vs 218,218,21
Vs 219,219,21
Vs 220,220,21
Vs 221,221,21
Vs 222,222,21
Vs 223,223,21
Vs 36,36,21
Vs 37,37,21
Vs 38,38,21
v_sub_f32_e64 v39, v39, v21
v_exp_f32 v22, -v21
s_nop 0
Vm 52,52,22
Vm 53,53,22
Vm 54,54,22
v_mul_f32_e64 v55, v55, v22
Ar 8,32
Ar 9,33
Ar 10,34
Ar 11,35
Ar 12,36
Ar 13,37
Ar 14,38
Ar 15,39
Vm 8,8,22
Vm 9,9,22
Vm 10,10,22
Vm 11,11,22
Vm 12,12,22
Vm 13,13,22
Vm 14,14,22
Vm 15,15,22
Aw 32,8
Aw 33,9
Aw 34,10
Aw 35,11
Aw 36,12
Aw 37,13
Aw 38,14
Aw 39,15
Ar 8,40
Ar 9,41
Ar 10,42
Ar 11,43
Ar 12,44
Ar 13,45
Ar 14,46
Ar 15,47
Vm 8,8,22
Vm 9,9,22
Vm 10,10,22
Vm 11,11,22
Vm 12,12,22
Vm 13,13,22
Vm 14,14,22
Vm 15,15,22
Aw 40,8
Aw 41,9
Aw 42,10
Aw 43,11
Aw 44,12
Aw 45,13
Aw 46,14
Aw 47,15
Ar 8,48
Ar 9,49
Ar 10,50
Ar 11,51
Ar 12,52
Ar 13,53
Ar 14,54
Ar 15,55
Vm 8,8,22
Vm 9,9,22
Vm 10,10,22
Vm 11,11,22
Vm 12,12,22
Vm 13,13,22
Vm 14,14,22
Vm 15,15,22
Aw 48,8
Aw 49,9
Aw 50,10
Aw 51,11
Aw 52,12
Aw 53,13
Aw 54,14
Aw 55,15
Ar 8,56
Ar 9,57
Ar 10,58
Ar 11,59
Ar 12,60
Ar 13,61
Ar 14,62
Ar 15,63
Vm 8,8,22
Vm 9,9,22
Vm 10,10,22
Vm 11,11,22
Vm 12,12,22
Vm 13,13,22
Vm 14,14,22
Vm 15,15,22
Aw 56,8
Aw 57,9
Aw 58,10
Aw 59,11
Aw 60,12
Aw 61,13
Aw 62,14
Aw 63,15
v_max3_f32 v21, v160, v161, v162
v_max3_f32 v21, v21, v163, v164
v_max3_f32 v21, v21, v165, v166
v_max3_f32 v21, v21, v167, v168
v_max3_f32 v21, v21, v169, v170
v_max3_f32 v21, v21, v171, v172
v_max3_f32 v21, v21, v173, v174
v_max_f32 v21, v21, v175
v_mov_b32 v1, v21
s_nop 1
v_permlane16_swap_b32 v1, v21
v_max_f32 v21, v21, v1
v_mov_b32 v1, v21
s_nop 1
v_permlane32_swap_b32 v1, v21
v_max_f32_e64 v21, v21, v1
v_add_f32 v21, 0x41f80000, v21
v_max_f32 v21, 0, v21
Vs 160,160,21
Vs 161,161,21
Vs 162,162,21
Vs 163,163,21
Vs 164,164,21
Vs 165,165,21
Vs 166,166,21
Vs 167,167,21
Vs 168,168,21
Vs 169,169,21
Vs 170,170,21
Vs 171,171,21
Vs 172,172,21
Vs 173,173,21
Vs 174,174,21
Vs 175,175,21
Vs 224,224,21
Vs 225,225,21
Vs 226,226,21
Vs 227,227,21
Vs 228,228,21
Vs 229,229,21
Vs 230,230,21
Vs 231,231,21
Vs 232,232,21
Vs 233,233,21
Vs 234,234,21
Vs 235,235,21
Vs 236,236,21
Vs 237,237,21
Vs 238,238,21
Vs 239,239,21
Vs 40,40,21
Vs 41,41,21
Vs 42,42,21
v_sub_f32_e64 v43, v43, v21
v_exp_f32 v22, -v21
s_nop 0
Vm 56,56,22
Vm 57,57,22
Vm 58,58,22
v_mul_f32_e64 v59, v59, v22
Ar 8,64
Ar 9,65
Ar 10,66
Ar 11,67
Ar 12,68
Ar 13,69
Ar 14,70
Ar 15,71
Vm 8,8,22
Vm 9,9,22
Vm 10,10,22
Vm 11,11,22
Vm 12,12,22
Vm 13,13,22
Vm 14,14,22
Vm 15,15,22
Aw 64,8
Aw 65,9
Aw 66,10
Aw 67,11
Aw 68,12
Aw 69,13
Aw 70,14
Aw 71,15
Ar 8,72
Ar 9,73
Ar 10,74
Ar 11,75
Ar 12,76
Ar 13,77
Ar 14,78
Ar 15,79
Vm 8,8,22
Vm 9,9,22
Vm 10,10,22
Vm 11,11,22
Vm 12,12,22
Vm 13,13,22
Vm 14,14,22
Vm 15,15,22
Aw 72,8
Aw 73,9
Aw 74,10
Aw 75,11
Aw 76,12
Aw 77,13
Aw 78,14
Aw 79,15
Ar 8,80
Ar 9,81
Ar 10,82
Ar 11,83
Ar 12,84
Ar 13,85
Ar 14,86
Ar 15,87
Vm 8,8,22
Vm 9,9,22
Vm 10,10,22
Vm 11,11,22
Vm 12,12,22
Vm 13,13,22
Vm 14,14,22
Vm 15,15,22
Aw 80,8
Aw 81,9
Aw 82,10
Aw 83,11
Aw 84,12
Aw 85,13
Aw 86,14
Aw 87,15
Ar 8,88
Ar 9,89
Ar 10,90
Ar 11,91
Ar 12,92
Ar 13,93
Ar 14,94
Ar 15,95
Vm 8,8,22
Vm 9,9,22
Vm 10,10,22
Vm 11,11,22
Vm 12,12,22
Vm 13,13,22
Vm 14,14,22
Vm 15,15,22
Aw 88,8
Aw 89,9
Aw 90,10
Aw 91,11
Aw 92,12
Aw 93,13
Aw 94,14
Aw 95,15
v_max3_f32 v21, v176, v177, v178
v_max3_f32 v21, v21, v179, v180
v_max3_f32 v21, v21, v181, v182
v_max3_f32 v21, v21, v183, v184
v_max3_f32 v21, v21, v185, v186
v_max3_f32 v21, v21, v187, v188
v_max3_f32 v21, v21, v189, v190
v_max_f32 v21, v21, v191
v_mov_b32 v1, v21
s_nop 1
v_permlane16_swap_b32 v1, v21
v_max_f32 v21, v21, v1
v_mov_b32 v1, v21
s_nop 1
v_permlane32_swap_b32 v1, v21
v_max_f32_e64 v21, v21, v1
v_add_f32 v21, 0x41f80000, v21
v_max_f32 v21, 0, v21
Vs 176,176,21
Vs 177,177,21
Vs 178,178,21
Vs 179,179,21
Vs 180,180,21
Vs 181,181,21
Vs 182,182,21
Vs 183,183,21
Vs 184,184,21
Vs 185,185,21
Vs 186,186,21
Vs 187,187,21
Vs 188,188,21
Vs 189,189,21
Vs 190,190,21
Vs 191,191,21
Vs 44,44,21
Vs 45,45,21
Vs 46,46,21
v_sub_f32_e64 v47, v47, v21
v_exp_f32 v22, -v21
s_nop 0
Vm 60,60,22
Vm 61,61,22
Vm 62,62,22
v_mul_f32_e64 v63, v63, v22
Ar 8,96
Ar 9,97
Ar 10,98
Ar 11,99
Ar 12,100
Ar 13,101
Ar 14,102
Ar 15,103
Vm 8,8,22
Vm 9,9,22
Vm 10,10,22
Vm 11,11,22
Vm 12,12,22
Vm 13,13,22
Vm 14,14,22
Vm 15,15,22
Aw 96,8
Aw 97,9
Aw 98,10
Aw 99,11
Aw 100,12
Aw 101,13
Aw 102,14
Aw 103,15
Ar 8,104
Ar 9,105
Ar 10,106
Ar 11,107
Ar 12,108
Ar 13,109
Ar 14,110
Ar 15,111
Vm 8,8,22
Vm 9,9,22
Vm 10,10,22
Vm 11,11,22
Vm 12,12,22
Vm 13,13,22
Vm 14,14,22
Vm 15,15,22
Aw 104,8
Aw 105,9
Aw 106,10
Aw 107,11
Aw 108,12
Aw 109,13
Aw 110,14
Aw 111,15
Ar 8,112
Ar 9,113
Ar 10,114
Ar 11,115
Ar 12,116
Ar 13,117
Ar 14,118
Ar 15,119
Vm 8,8,22
Vm 9,9,22
Vm 10,10,22
Vm 11,11,22
Vm 12,12,22
Vm 13,13,22
Vm 14,14,22
Vm 15,15,22
Aw 112,8
Aw 113,9
Aw 114,10
Aw 115,11
Aw 116,12
Aw 117,13
Aw 118,14
Aw 119,15
Ar 8,120
Ar 9,121
Ar 10,122
Ar 11,123
Ar 12,124
Ar 13,125
Ar 14,126
Ar 15,127
Vm 8,8,22
Vm 9,9,22
Vm 10,10,22
Vm 11,11,22
Vm 12,12,22
Vm 13,13,22
Vm 14,14,22
Vm 15,15,22
Aw 120,8
Aw 121,9
Aw 122,10
Aw 123,11
Aw 124,12
Aw 125,13
Aw 126,14
Aw 127,15
Ve 8,128
Ve 9,129
s_nop 0
Vc 64,8,9
Ve 8,130
Ve 9,131
s_nop 0
Vc 65,8,9
Ve 8,144
Ve 9,145
s_nop 0
Vc 72,8,9
Ve 8,146
Ve 9,147
s_nop 0
Vc 73,8,9
Ve 8,160
Ve 9,161
s_nop 0
Vc 80,8,9
Ve 8,162
Ve 9,163
s_nop 0
Vc 81,8,9
Ve 8,176
Ve 9,177
s_nop 0
Vc 88,8,9
Ve 8,178
Ve 9,179
s_nop 0
Vc 89,8,9
Ve 8,132
Ve 9,133
s_nop 0
Vc 66,8,9
Ve 8,134
Ve 9,135
s_nop 0
Vc 67,8,9
Ve 8,148
Ve 9,149
s_nop 0
Vc 74,8,9
Ve 8,150
Ve 9,151
s_nop 0
Vc 75,8,9
Ve 8,164
Ve 9,165
s_nop 0
Vc 82,8,9
Ve 8,166
Ve 9,167
s_nop 0
Vc 83,8,9
Ve 8,180
Ve 9,181
s_nop 0
Vc 90,8,9
Ve 8,182
Ve 9,183
s_nop 0
Vc 91,8,9
Ve 8,136
Ve 9,137
s_nop 0
Vc 68,8,9
Ve 8,138
Ve 9,139
s_nop 0
Vc 69,8,9
Ve 8,152
Ve 9,153
s_nop 0
Vc 76,8,9
Ve 8,154
Ve 9,155
s_nop 0
Vc 77,8,9
Ve 8,168
Ve 9,169
s_nop 0
Vc 84,8,9
Ve 8,170
Ve 9,171
s_nop 0
Vc 85,8,9
Ve 8,184
Ve 9,185
s_nop 0
Vc 92,8,9
Ve 8,186
Ve 9,187
s_nop 0
Vc 93,8,9
Ve 8,140
Ve 9,141
s_nop 0
Vc 70,8,9
Ve 8,142
Ve 9,143
s_nop 0
Vc 71,8,9
Ve 8,156
Ve 9,157
s_nop 0
Vc 78,8,9
Ve 8,158
Ve 9,159
s_nop 0
Vc 79,8,9
Ve 8,172
Ve 9,173
s_nop 0
Vc 86,8,9
Ve 8,174
Ve 9,175
s_nop 0
Vc 87,8,9
Ve 8,188
Ve 9,189
s_nop 0
Vc 94,8,9
Ve 8,190
Ve 9,191
s_nop 0
Vc 95,8,9
s_nop 1
s_branch L_k2_fbr_wl
L_k2_fb_tr:
s_nop 7
s_nop 0
v_max3_f32 v21, v192, v193, v194
v_max3_f32 v21, v21, v195, v196
v_max3_f32 v21, v21, v197, v198
v_max3_f32 v21, v21, v199, v200
v_max3_f32 v21, v21, v201, v202
v_max3_f32 v21, v21, v203, v204
v_max3_f32 v21, v21, v205, v206
v_max_f32 v21, v21, v207
v_mov_b32 v1, v21
s_nop 1
v_permlane16_swap_b32 v1, v21
v_max_f32 v21, v21, v1
v_mov_b32 v1, v21
s_nop 1
v_permlane32_swap_b32 v1, v21
v_max_f32_e64 v21, v21, v1
v_add_f32 v21, 0x41f80000, v21
v_max_f32 v21, 0, v21
Vs 192,192,21
Vs 193,193,21
Vs 194,194,21
Vs 195,195,21
Vs 196,196,21
Vs 197,197,21
Vs 198,198,21
Vs 199,199,21
Vs 200,200,21
Vs 201,201,21
Vs 202,202,21
Vs 203,203,21
Vs 204,204,21
Vs 205,205,21
Vs 206,206,21
Vs 207,207,21
Vs 128,128,21
Vs 129,129,21
Vs 130,130,21
Vs 131,131,21
Vs 132,132,21
Vs 133,133,21
Vs 134,134,21
Vs 135,135,21
Vs 136,136,21
Vs 137,137,21
Vs 138,138,21
Vs 139,139,21
Vs 140,140,21
Vs 141,141,21
Vs 142,142,21
Vs 143,143,21
Vs 32,32,21
Vs 33,33,21
Vs 34,34,21
v_sub_f32_e64 v35, v35, v21
v_exp_f32 v22, -v21
s_nop 0
Vm 48,48,22
Vm 49,49,22
Vm 50,50,22
v_mul_f32_e64 v51, v51, v22
Ar 8,0
Ar 9,1
Ar 10,2
Ar 11,3
Ar 12,4
Ar 13,5
Ar 14,6
Ar 15,7
Vm 8,8,22
Vm 9,9,22
Vm 10,10,22
Vm 11,11,22
Vm 12,12,22
Vm 13,13,22
Vm 14,14,22
Vm 15,15,22
Aw 0,8
Aw 1,9
Aw 2,10
Aw 3,11
Aw 4,12
Aw 5,13
Aw 6,14
Aw 7,15
Ar 8,8
Ar 9,9
Ar 10,10
Ar 11,11
Ar 12,12
Ar 13,13
Ar 14,14
Ar 15,15
Vm 8,8,22
Vm 9,9,22
Vm 10,10,22
Vm 11,11,22
Vm 12,12,22
Vm 13,13,22
Vm 14,14,22
Vm 15,15,22
Aw 8,8
Aw 9,9
Aw 10,10
Aw 11,11
Aw 12,12
Aw 13,13
Aw 14,14
Aw 15,15
Ar 8,16
Ar 9,17
Ar 10,18
Ar 11,19
Ar 12,20
Ar 13,21
Ar 14,22
Ar 15,23
Vm 8,8,22
Vm 9,9,22
Vm 10,10,22
Vm 11,11,22
Vm 12,12,22
Vm 13,13,22
Vm 14,14,22
Vm 15,15,22
Aw 16,8
Aw 17,9
Aw 18,10
Aw 19,11
Aw 20,12
Aw 21,13
Aw 22,14
Aw 23,15
Ar 8,24
Ar 9,25
Ar 10,26
Ar 11,27
Ar 12,28
Ar 13,29
Ar 14,30
Ar 15,31
Vm 8,8,22
Vm 9,9,22
Vm 10,10,22
Vm 11,11,22
Vm 12,12,22
Vm 13,13,22
Vm 14,14,22
Vm 15,15,22
Aw 24,8
Aw 25,9
Aw 26,10
Aw 27,11
Aw 28,12
Aw 29,13
Aw 30,14
Aw 31,15
v_max3_f32 v21, v208, v209, v210
v_max3_f32 v21, v21, v211, v212
v_max3_f32 v21, v21, v213, v214
v_max3_f32 v21, v21, v215, v216
v_max3_f32 v21, v21, v217, v218
v_max3_f32 v21, v21, v219, v220
v_max3_f32 v21, v21, v221, v222
v_max_f32 v21, v21, v223
v_mov_b32 v1, v21
s_nop 1
v_permlane16_swap_b32 v1, v21
v_max_f32 v21, v21, v1
v_mov_b32 v1, v21
s_nop 1
v_permlane32_swap_b32 v1, v21
v_max_f32_e64 v21, v21, v1
v_add_f32 v21, 0x41f80000, v21
v_max_f32 v21, 0, v21
Vs 208,208,21
Vs 209,209,21
Vs 210,210,21
Vs 211,211,21
Vs 212,212,21
Vs 213,213,21
Vs 214,214,21
Vs 215,215,21
Vs 216,216,21
Vs 217,217,21
Vs 218,218,21
Vs 219,219,21
Vs 220,220,21
Vs 221,221,21
Vs 222,222,21
Vs 223,223,21
Vs 144,144,21
Vs 145,145,21
Vs 146,146,21
Vs 147,147,21
Vs 148,148,21
Vs 149,149,21
Vs 150,150,21
Vs 151,151,21
Vs 152,152,21
Vs 153,153,21
Vs 154,154,21
Vs 155,155,21
Vs 156,156,21
Vs 157,157,21
Vs 158,158,21
Vs 159,159,21
Vs 36,36,21
Vs 37,37,21
Vs 38,38,21
v_sub_f32_e64 v39, v39, v21
v_exp_f32 v22, -v21
s_nop 0
Vm 52,52,22
Vm 53,53,22
Vm 54,54,22
v_mul_f32_e64 v55, v55, v22
Ar 8,32
Ar 9,33
Ar 10,34
Ar 11,35
Ar 12,36
Ar 13,37
Ar 14,38
Ar 15,39
Vm 8,8,22
Vm 9,9,22
Vm 10,10,22
Vm 11,11,22
Vm 12,12,22
Vm 13,13,22
Vm 14,14,22
Vm 15,15,22
Aw 32,8
Aw 33,9
Aw 34,10
Aw 35,11
Aw 36,12
Aw 37,13
Aw 38,14
Aw 39,15
Ar 8,40
Ar 9,41
Ar 10,42
Ar 11,43
Ar 12,44
Ar 13,45
Ar 14,46
Ar 15,47
Vm 8,8,22
Vm 9,9,22
Vm 10,10,22
Vm 11,11,22
Vm 12,12,22
Vm 13,13,22
Vm 14,14,22
Vm 15,15,22
Aw 40,8
Aw 41,9
Aw 42,10
Aw 43,11
Aw 44,12
Aw 45,13
Aw 46,14
Aw 47,15
Ar 8,48
Ar 9,49
Ar 10,50
Ar 11,51
Ar 12,52
Ar 13,53
Ar 14,54
Ar 15,55
Vm 8,8,22
Vm 9,9,22
Vm 10,10,22
Vm 11,11,22
Vm 12,12,22
Vm 13,13,22
Vm 14,14,22
Vm 15,15,22
Aw 48,8
Aw 49,9
Aw 50,10
Aw 51,11
Aw 52,12
Aw 53,13
Aw 54,14
Aw 55,15
Ar 8,56
Ar 9,57
Ar 10,58
Ar 11,59
Ar 12,60
Ar 13,61
Ar 14,62
Ar 15,63
Vm 8,8,22
Vm 9,9,22
Vm 10,10,22
Vm 11,11,22
Vm 12,12,22
Vm 13,13,22
Vm 14,14,22
Vm 15,15,22
Aw 56,8
Aw 57,9
Aw 58,10
Aw 59,11
Aw 60,12
Aw 61,13
Aw 62,14
Aw 63,15
v_max3_f32 v21, v224, v225, v226
v_max3_f32 v21, v21, v227, v228
v_max3_f32 v21, v21, v229, v230
v_max3_f32 v21, v21, v231, v232
v_max3_f32 v21, v21, v233, v234
v_max3_f32 v21, v21, v235, v236
v_max3_f32 v21, v21, v237, v238
v_max_f32 v21, v21, v239
v_mov_b32 v1, v21
s_nop 1
v_permlane16_swap_b32 v1, v21
v_max_f32 v21, v21, v1
v_mov_b32 v1, v21
s_nop 1
v_permlane32_swap_b32 v1, v21
v_max_f32_e64 v21, v21, v1
v_add_f32 v21, 0x41f80000, v21
v_max_f32 v21, 0, v21
Vs 224,224,21
Vs 225,225,21
Vs 226,226,21
Vs 227,227,21
Vs 228,228,21
Vs 229,229,21
Vs 230,230,21
Vs 231,231,21
Vs 232,232,21
Vs 233,233,21
Vs 234,234,21
Vs 235,235,21
Vs 236,236,21
Vs 237,237,21
Vs 238,238,21
Vs 239,239,21
Vs 40,40,21
Vs 41,41,21
Vs 42,42,21
v_sub_f32_e64 v43, v43, v21
v_exp_f32 v22, -v21
s_nop 0
Vm 56,56,22
Vm 57,57,22
Vm 58,58,22
v_mul_f32_e64 v59, v59, v22
Ar 8,64
Ar 9,65
Ar 10,66
Ar 11,67
Ar 12,68
Ar 13,69
Ar 14,70
Ar 15,71
Vm 8,8,22
Vm 9,9,22
Vm 10,10,22
Vm 11,11,22
Vm 12,12,22
Vm 13,13,22
Vm 14,14,22
Vm 15,15,22
Aw 64,8
Aw 65,9
Aw 66,10
Aw 67,11
Aw 68,12
Aw 69,13
Aw 70,14
Aw 71,15
Ar 8,72
Ar 9,73
Ar 10,74
Ar 11,75
Ar 12,76
Ar 13,77
Ar 14,78
Ar 15,79
Vm 8,8,22
Vm 9,9,22
Vm 10,10,22
Vm 11,11,22
Vm 12,12,22
Vm 13,13,22
Vm 14,14,22
Vm 15,15,22
Aw 72,8
Aw 73,9
Aw 74,10
Aw 75,11
Aw 76,12
Aw 77,13
Aw 78,14
Aw 79,15
Ar 8,80
Ar 9,81
Ar 10,82
Ar 11,83
Ar 12,84
Ar 13,85
Ar 14,86
Ar 15,87
Vm 8,8,22
Vm 9,9,22
Vm 10,10,22
Vm 11,11,22
Vm 12,12,22
Vm 13,13,22
Vm 14,14,22
Vm 15,15,22
Aw 80,8
Aw 81,9
Aw 82,10
Aw 83,11
Aw 84,12
Aw 85,13
Aw 86,14
Aw 87,15
Ar 8,88
Ar 9,89
Ar 10,90
Ar 11,91
Ar 12,92
Ar 13,93
Ar 14,94
Ar 15,95
Vm 8,8,22
Vm 9,9,22
Vm 10,10,22
Vm 11,11,22
Vm 12,12,22
Vm 13,13,22
Vm 14,14,22
Vm 15,15,22
Aw 88,8
Aw 89,9
Aw 90,10
Aw 91,11
Aw 92,12
Aw 93,13
Aw 94,14
Aw 95,15
Ve 8,192
Ve 9,193
s_nop 0
Vc 96,8,9
Ve 8,194
Ve 9,195
s_nop 0
Vc 97,8,9
Ve 8,208
Ve 9,209
s_nop 0
Vc 104,8,9
Ve 8,210
Ve 9,211
s_nop 0
Vc 105,8,9
Ve 8,224
Ve 9,225
s_nop 0
Vc 112,8,9
Ve 8,226
Ve 9,227
s_nop 0
Vc 113,8,9
Ve 8,196
Ve 9,197
s_nop 0
Vc 98,8,9
Ve 8,198
Ve 9,199
s_nop 0
Vc 99,8,9
Ve 8,212
Ve 9,213
s_nop 0
Vc 106,8,9
Ve 8,214
Ve 9,215
s_nop 0
Vc 107,8,9
Ve 8,228
Ve 9,229
s_nop 0
Vc 114,8,9
Ve 8,230
Ve 9,231
s_nop 0
Vc 115,8,9
Ve 8,200
Ve 9,201
s_nop 0
Vc 100,8,9
Ve 8,202
Ve 9,203
s_nop 0
Vc 101,8,9
Ve 8,216
Ve 9,217
s_nop 0
Vc 108,8,9
Ve 8,218
Ve 9,219
s_nop 0
Vc 109,8,9
Ve 8,232
Ve 9,233
s_nop 0
Vc 116,8,9
Ve 8,234
Ve 9,235
s_nop 0
Vc 117,8,9
Ve 8,204
Ve 9,205
s_nop 0
Vc 102,8,9
Ve 8,206
Ve 9,207
s_nop 0
Vc 103,8,9
Ve 8,220
Ve 9,221
s_nop 0
Vc 110,8,9
Ve 8,222
Ve 9,223
s_nop 0
Vc 111,8,9
Ve 8,236
Ve 9,237
s_nop 0
Vc 118,8,9
Ve 8,238
Ve 9,239
s_nop 0
Vc 119,8,9
s_nop 1
s_branch L_k2_fbr_tr
L_k2_fb_ne:
s_nop 7
s_nop 0
v_max3_f32 v21, v128, v129, v130
v_max3_f32 v21, v21, v131, v132
v_max3_f32 v21, v21, v133, v134
v_max3_f32 v21, v21, v135, v136
v_max3_f32 v21, v21, v137, v138
v_max3_f32 v21, v21, v139, v140
v_max3_f32 v21, v21, v141, v142
v_max_f32 v21, v21, v143
v_mov_b32 v1, v21
s_nop 1
v_permlane16_swap_b32 v1, v21
v_max_f32 v21, v21, v1
v_mov_b32 v1, v21
s_nop 1
v_permlane32_swap_b32 v1, v21
v_max_f32_e64 v21, v21, v1
v_add_f32 v21, 0x41f80000, v21
v_max_f32 v21, 0, v21
Vs 128,128,21
Vs 129,129,21
Vs 130,130,21
Vs 131,131,21
Vs 132,132,21
Vs 133,133,21
Vs 134,134,21
Vs 135,135,21
Vs 136,136,21
Vs 137,137,21
Vs 138,138,21
Vs 139,139,21
Vs 140,140,21
Vs 141,141,21
Vs 142,142,21
Vs 143,143,21
Vs 192,192,21
Vs 193,193,21
Vs 194,194,21
Vs 195,195,21
Vs 196,196,21
Vs 197,197,21
Vs 198,198,21
Vs 199,199,21
Vs 200,200,21
Vs 201,201,21
Vs 202,202,21
Vs 203,203,21
Vs 204,204,21
Vs 205,205,21
Vs 206,206,21
Vs 207,207,21
Vs 32,32,21
Vs 33,33,21
Vs 34,34,21
v_sub_f32_e64 v35, v35, v21
v_exp_f32 v22, -v21
s_nop 0
Vm 48,48,22
Vm 49,49,22
Vm 50,50,22
v_mul_f32_e64 v51, v51, v22
Ar 8,0
Ar 9,1
Ar 10,2
Ar 11,3
Ar 12,4
Ar 13,5
Ar 14,6
Ar 15,7
Vm 8,8,22
Vm 9,9,22
Vm 10,10,22
Vm 11,11,22
Vm 12,12,22
Vm 13,13,22
Vm 14,14,22
Vm 15,15,22
Aw 0,8
Aw 1,9
Aw 2,10
Aw 3,11
Aw 4,12
Aw 5,13
Aw 6,14
Aw 7,15
Ar 8,8
Ar 9,9
Ar 10,10
Ar 11,11
Ar 12,12
Ar 13,13
Ar 14,14
Ar 15,15
Vm 8,8,22
Vm 9,9,22
Vm 10,10,22
Vm 11,11,22
Vm 12,12,22
Vm 13,13,22
Vm 14,14,22
Vm 15,15,22
Aw 8,8
Aw 9,9
Aw 10,10
Aw 11,11
Aw 12,12
Aw 13,13
Aw 14,14
Aw 15,15
Ar 8,16
Ar 9,17
Ar 10,18
Ar 11,19
Ar 12,20
Ar 13,21
Ar 14,22
Ar 15,23
Vm 8,8,22
Vm 9,9,22
Vm 10,10,22
Vm 11,11,22
Vm 12,12,22
Vm 13,13,22
Vm 14,14,22
Vm 15,15,22
Aw 16,8
Aw 17,9
Aw 18,10
Aw 19,11
Aw 20,12
Aw 21,13
Aw 22,14
Aw 23,15
Ar 8,24
Ar 9,25
Ar 10,26
Ar 11,27
Ar 12,28
Ar 13,29
Ar 14,30
Ar 15,31
Vm 8,8,22
Vm 9,9,22
Vm 10,10,22
Vm 11,11,22
Vm 12,12,22
Vm 13,13,22
Vm 14,14,22
Vm 15,15,22
Aw 24,8
Aw 25,9
Aw 26,10
Aw 27,11
Aw 28,12
Aw 29,13
Aw 30,14
Aw 31,15
v_max3_f32 v21, v144, v145, v146
v_max3_f32 v21, v21, v147, v148
v_max3_f32 v21, v21, v149, v150
v_max3_f32 v21, v21, v151, v152
v_max3_f32 v21, v21, v153, v154
v_max3_f32 v21, v21, v155, v156
v_max3_f32 v21, v21, v157, v158
v_max_f32 v21, v21, v159
v_mov_b32 v1, v21
s_nop 1
v_permlane16_swap_b32 v1, v21
v_max_f32 v21, v21, v1
v_mov_b32 v1, v21
s_nop 1
v_permlane32_swap_b32 v1, v21
v_max_f32_e64 v21, v21, v1
v_add_f32 v21, 0x41f80000, v21
v_max_f32 v21, 0, v21
Vs 144,144,21
Vs 145,145,21
Vs 146,146,21
Vs 147,147,21
Vs 148,148,21
Vs 149,149,21
Vs 150,150,21
Vs 151,151,21
Vs 152,152,21
Vs 153,153,21
Vs 154,154,21
Vs 155,155,21
Vs 156,156,21
Vs 157,157,21
Vs 158,158,21
Vs 159,159,21
Vs 208,208,21
Vs 209,209,21
Vs 210,210,21
Vs 211,211,21
Vs 212,212,21
Vs 213,213,21
Vs 214,214,21
Vs 215,215,21
Vs 216,216,21
Vs 217,217,21
Vs 218,218,21
Vs 219,219,21
Vs 220,220,21
Vs 221,221,21
Vs 222,222,21
Vs 223,223,21
Vs 36,36,21
Vs 37,37,21
Vs 38,38,21
v_sub_f32_e64 v39, v39, v21
v_exp_f32 v22, -v21
s_nop 0
Vm 52,52,22
Vm 53,53,22
Vm 54,54,22
v_mul_f32_e64 v55, v55, v22
Ar 8,32
Ar 9,33
Ar 10,34
Ar 11,35
Ar 12,36
Ar 13,37
Ar 14,38
Ar 15,39
Vm 8,8,22
Vm 9,9,22
Vm 10,10,22
Vm 11,11,22
Vm 12,12,22
Vm 13,13,22
Vm 14,14,22
Vm 15,15,22
Aw 32,8
Aw 33,9
Aw 34,10
Aw 35,11
Aw 36,12
Aw 37,13
Aw 38,14
Aw 39,15
Ar 8,40
Ar 9,41
Ar 10,42
Ar 11,43
Ar 12,44
Ar 13,45
Ar 14,46
Ar 15,47
Vm 8,8,22
Vm 9,9,22
Vm 10,10,22
Vm 11,11,22
Vm 12,12,22
Vm 13,13,22
Vm 14,14,22
Vm 15,15,22
Aw 40,8
Aw 41,9
Aw 42,10
Aw 43,11
Aw 44,12
Aw 45,13
Aw 46,14
Aw 47,15
Ar 8,48
Ar 9,49
Ar 10,50
Ar 11,51
Ar 12,52
Ar 13,53
Ar 14,54
Ar 15,55
Vm 8,8,22
Vm 9,9,22
Vm 10,10,22
Vm 11,11,22
Vm 12,12,22
Vm 13,13,22
Vm 14,14,22
Vm 15,15,22
Aw 48,8
Aw 49,9
Aw 50,10
Aw 51,11
Aw 52,12
Aw 53,13
Aw 54,14
Aw 55,15
Ar 8,56
Ar 9,57
Ar 10,58
Ar 11,59
Ar 12,60
Ar 13,61
Ar 14,62
Ar 15,63
Vm 8,8,22
Vm 9,9,22
Vm 10,10,22
Vm 11,11,22
Vm 12,12,22
Vm 13,13,22
Vm 14,14,22
Vm 15,15,22
Aw 56,8
Aw 57,9
Aw 58,10
Aw 59,11
Aw 60,12
Aw 61,13
Aw 62,14
Aw 63,15
Ve 8,128
Ve 9,129
s_nop 0
Vc 64,8,9
Ve 8,130
Ve 9,131
s_nop 0
Vc 65,8,9
Ve 8,144
Ve 9,145
s_nop 0
Vc 72,8,9
Ve 8,146
Ve 9,147
s_nop 0
Vc 73,8,9
Ve 8,132
Ve 9,133
s_nop 0
Vc 66,8,9
Ve 8,134
Ve 9,135
s_nop 0
Vc 67,8,9
Ve 8,148
Ve 9,149
s_nop 0
Vc 74,8,9
Ve 8,150
Ve 9,151
s_nop 0
Vc 75,8,9
Ve 8,136
Ve 9,137
s_nop 0
Vc 68,8,9
Ve 8,138
Ve 9,139
s_nop 0
Vc 69,8,9
Ve 8,152
Ve 9,153
s_nop 0
Vc 76,8,9
Ve 8,154
Ve 9,155
s_nop 0
Vc 77,8,9
Ve 8,140
Ve 9,141
s_nop 0
Vc 70,8,9
Ve 8,142
Ve 9,143
s_nop 0
Vc 71,8,9
Ve 8,156
Ve 9,157
s_nop 0
Vc 78,8,9
Ve 8,158
Ve 9,159
s_nop 0
Vc 79,8,9
s_nop 1
s_branch L_k2_fbr_ne
L_k2_fb_no:
s_nop 7
s_nop 0
v_max3_f32 v21, v192, v193, v194
v_max3_f32 v21, v21, v195, v196
v_max3_f32 v21, v21, v197, v198
v_max3_f32 v21, v21, v199, v200
v_max3_f32 v21, v21, v201, v202
v_max3_f32 v21, v21, v203, v204
v_max3_f32 v21, v21, v205, v206
v_max_f32 v21, v21, v207
v_mov_b32 v1, v21
s_nop 1
v_permlane16_swap_b32 v1, v21
v_max_f32 v21, v21, v1
v_mov_b32 v1, v21
s_nop 1
v_permlane32_swap_b32 v1, v21
v_max_f32_e64 v21, v21, v1
v_add_f32 v21, 0x41f80000, v21
v_max_f32 v21, 0, v21
Vs 192,192,21
Vs 193,193,21
Vs 194,194,21
Vs 195,195,21
Vs 196,196,21
Vs 197,197,21
Vs 198,198,21
Vs 199,199,21
Vs 200,200,21
Vs 201,201,21
Vs 202,202,21
Vs 203,203,21
Vs 204,204,21
Vs 205,205,21
Vs 206,206,21
Vs 207,207,21
Vs 128,128,21
Vs 129,129,21
Vs 130,130,21
Vs 131,131,21
Vs 132,132,21
Vs 133,133,21
Vs 134,134,21
Vs 135,135,21
Vs 136,136,21
Vs 137,137,21
Vs 138,138,21
Vs 139,139,21
Vs 140,140,21
Vs 141,141,21
Vs 142,142,21
Vs 143,143,21
Vs 32,32,21
Vs 33,33,21
Vs 34,34,21
v_sub_f32_e64 v35, v35, v21
v_exp_f32 v22, -v21
s_nop 0
Vm 48,48,22
Vm 49,49,22
Vm 50,50,22
v_mul_f32_e64 v51, v51, v22
Ar 8,0
Ar 9,1
Ar 10,2
Ar 11,3
Ar 12,4
Ar 13,5
Ar 14,6
Ar 15,7
Vm 8,8,22
Vm 9,9,22
Vm 10,10,22
Vm 11,11,22
Vm 12,12,22
Vm 13,13,22
Vm 14,14,22
Vm 15,15,22
Aw 0,8
Aw 1,9
Aw 2,10
Aw 3,11
Aw 4,12
Aw 5,13
Aw 6,14
Aw 7,15
Ar 8,8
Ar 9,9
Ar 10,10
Ar 11,11
Ar 12,12
Ar 13,13
Ar 14,14
Ar 15,15
Vm 8,8,22
Vm 9,9,22
Vm 10,10,22
Vm 11,11,22
Vm 12,12,22
Vm 13,13,22
Vm 14,14,22
Vm 15,15,22
Aw 8,8
Aw 9,9
Aw 10,10
Aw 11,11
Aw 12,12
Aw 13,13
Aw 14,14
Aw 15,15
Ar 8,16
Ar 9,17
Ar 10,18
Ar 11,19
Ar 12,20
Ar 13,21
Ar 14,22
Ar 15,23
Vm 8,8,22
Vm 9,9,22
Vm 10,10,22
Vm 11,11,22
Vm 12,12,22
Vm 13,13,22
Vm 14,14,22
Vm 15,15,22
Aw 16,8
Aw 17,9
Aw 18,10
Aw 19,11
Aw 20,12
Aw 21,13
Aw 22,14
Aw 23,15
Ar 8,24
Ar 9,25
Ar 10,26
Ar 11,27
Ar 12,28
Ar 13,29
Ar 14,30
Ar 15,31
Vm 8,8,22
Vm 9,9,22
Vm 10,10,22
Vm 11,11,22
Vm 12,12,22
Vm 13,13,22
Vm 14,14,22
Vm 15,15,22
Aw 24,8
Aw 25,9
Aw 26,10
Aw 27,11
Aw 28,12
Aw 29,13
Aw 30,14
Aw 31,15
v_max3_f32 v21, v208, v209, v210
v_max3_f32 v21, v21, v211, v212
v_max3_f32 v21, v21, v213, v214
v_max3_f32 v21, v21, v215, v216
v_max3_f32 v21, v21, v217, v218
v_max3_f32 v21, v21, v219, v220
v_max3_f32 v21, v21, v221, v222
v_max_f32 v21, v21, v223
v_mov_b32 v1, v21
s_nop 1
v_permlane16_swap_b32 v1, v21
v_max_f32 v21, v21, v1
v_mov_b32 v1, v21
s_nop 1
v_permlane32_swap_b32 v1, v21
v_max_f32_e64 v21, v21, v1
v_add_f32 v21, 0x41f80000, v21
v_max_f32 v21, 0, v21
Vs 208,208,21
Vs 209,209,21
Vs 210,210,21
Vs 211,211,21
Vs 212,212,21
Vs 213,213,21
Vs 214,214,21
Vs 215,215,21
Vs 216,216,21
Vs 217,217,21
Vs 218,218,21
Vs 219,219,21
Vs 220,220,21
Vs 221,221,21
Vs 222,222,21
Vs 223,223,21
Vs 144,144,21
Vs 145,145,21
Vs 146,146,21
Vs 147,147,21
Vs 148,148,21
Vs 149,149,21
Vs 150,150,21
Vs 151,151,21
Vs 152,152,21
Vs 153,153,21
Vs 154,154,21
Vs 155,155,21
Vs 156,156,21
Vs 157,157,21
Vs 158,158,21
Vs 159,159,21
Vs 36,36,21
Vs 37,37,21
Vs 38,38,21
v_sub_f32_e64 v39, v39, v21
v_exp_f32 v22, -v21
s_nop 0
Vm 52,52,22
Vm 53,53,22
Vm 54,54,22
v_mul_f32_e64 v55, v55, v22
Ar 8,32
Ar 9,33
Ar 10,34
Ar 11,35
Ar 12,36
Ar 13,37
Ar 14,38
Ar 15,39
Vm 8,8,22
Vm 9,9,22
Vm 10,10,22
Vm 11,11,22
Vm 12,12,22
Vm 13,13,22
Vm 14,14,22
Vm 15,15,22
Aw 32,8
Aw 33,9
Aw 34,10
Aw 35,11
Aw 36,12
Aw 37,13
Aw 38,14
Aw 39,15
Ar 8,40
Ar 9,41
Ar 10,42
Ar 11,43
Ar 12,44
Ar 13,45
Ar 14,46
Ar 15,47
Vm 8,8,22
Vm 9,9,22
Vm 10,10,22
Vm 11,11,22
Vm 12,12,22
Vm 13,13,22
Vm 14,14,22
Vm 15,15,22
Aw 40,8
Aw 41,9
Aw 42,10
Aw 43,11
Aw 44,12
Aw 45,13
Aw 46,14
Aw 47,15
Ar 8,48
Ar 9,49
Ar 10,50
Ar 11,51
Ar 12,52
Ar 13,53
Ar 14,54
Ar 15,55
Vm 8,8,22
Vm 9,9,22
Vm 10,10,22
Vm 11,11,22
Vm 12,12,22
Vm 13,13,22
Vm 14,14,22
Vm 15,15,22
Aw 48,8
Aw 49,9
Aw 50,10
Aw 51,11
Aw 52,12
Aw 53,13
Aw 54,14
Aw 55,15
Ar 8,56
Ar 9,57
Ar 10,58
Ar 11,59
Ar 12,60
Ar 13,61
Ar 14,62
Ar 15,63
Vm 8,8,22
Vm 9,9,22
Vm 10,10,22
Vm 11,11,22
Vm 12,12,22
Vm 13,13,22
Vm 14,14,22
Vm 15,15,22
Aw 56,8
Aw 57,9
Aw 58,10
Aw 59,11
Aw 60,12
Aw 61,13
Aw 62,14
Aw 63,15
Ve 8,192
Ve 9,193
s_nop 0
Vc 96,8,9
Ve 8,194
Ve 9,195
s_nop 0
Vc 97,8,9
Ve 8,208
Ve 9,209
s_nop 0
Vc 104,8,9
Ve 8,210
Ve 9,211
s_nop 0
Vc 105,8,9
Ve 8,196
Ve 9,197
s_nop 0
Vc 98,8,9
Ve 8,198
Ve 9,199
s_nop 0
Vc 99,8,9
Ve 8,212
Ve 9,213
s_nop 0
Vc 106,8,9
Ve 8,214
Ve 9,215
s_nop 0
Vc 107,8,9
Ve 8,200
Ve 9,201
s_nop 0
Vc 100,8,9
Ve 8,202
Ve 9,203
s_nop 0
Vc 101,8,9
Ve 8,216
Ve 9,217
s_nop 0
Vc 108,8,9
Ve 8,218
Ve 9,219
s_nop 0
Vc 109,8,9
Ve 8,204
Ve 9,205
s_nop 0
Vc 102,8,9
Ve 8,206
Ve 9,207
s_nop 0
Vc 103,8,9
Ve 8,220
Ve 9,221
s_nop 0
Vc 110,8,9
Ve 8,222
Ve 9,223
s_nop 0
Vc 111,8,9
s_nop 1
s_branch L_k2_fbr_no
L_k2_fb_nl:
s_nop 7
s_nop 0
v_max3_f32 v21, v128, v129, v130
v_max3_f32 v21, v21, v131, v132
v_max3_f32 v21, v21, v133, v134
v_max3_f32 v21, v21, v135, v136
v_max3_f32 v21, v21, v137, v138
v_max3_f32 v21, v21, v139, v140
v_max3_f32 v21, v21, v141, v142
v_max_f32 v21, v21, v143
v_mov_b32 v1, v21
s_nop 1
v_permlane16_swap_b32 v1, v21
v_max_f32 v21, v21, v1
v_mov_b32 v1, v21
s_nop 1
v_permlane32_swap_b32 v1, v21
v_max_f32_e64 v21, v21, v1
v_add_f32 v21, 0x41f80000, v21
v_max_f32 v21, 0, v21
Vs 128,128,21
Vs 129,129,21
Vs 130,130,21
Vs 131,131,21
Vs 132,132,21
Vs 133,133,21
Vs 134,134,21
Vs 135,135,21
Vs 136,136,21
Vs 137,137,21
Vs 138,138,21
Vs 139,139,21
Vs 140,140,21
Vs 141,141,21
Vs 142,142,21
Vs 143,143,21
Vs 192,192,21
Vs 193,193,21
Vs 194,194,21
Vs 195,195,21
Vs 196,196,21
Vs 197,197,21
Vs 198,198,21
Vs 199,199,21
Vs 200,200,21
Vs 201,201,21
Vs 202,202,21
Vs 203,203,21
Vs 204,204,21
Vs 205,205,21
Vs 206,206,21
Vs 207,207,21
Vs 32,32,21
Vs 33,33,21
Vs 34,34,21
v_sub_f32_e64 v35, v35, v21
v_exp_f32 v22, -v21
s_nop 0
Vm 48,48,22
Vm 49,49,22
Vm 50,50,22
v_mul_f32_e64 v51, v51, v22
Ar 8,0
Ar 9,1
Ar 10,2
Ar 11,3
Ar 12,4
Ar 13,5
Ar 14,6
Ar 15,7
Vm 8,8,22
Vm 9,9,22
Vm 10,10,22
Vm 11,11,22
Vm 12,12,22
Vm 13,13,22
Vm 14,14,22
Vm 15,15,22
Aw 0,8
Aw 1,9
Aw 2,10
Aw 3,11
Aw 4,12
Aw 5,13
Aw 6,14
Aw 7,15
Ar 8,8
Ar 9,9
Ar 10,10
Ar 11,11
Ar 12,12
Ar 13,13
Ar 14,14
Ar 15,15
Vm 8,8,22
Vm 9,9,22
Vm 10,10,22
Vm 11,11,22
Vm 12,12,22
Vm 13,13,22
Vm 14,14,22
Vm 15,15,22
Aw 8,8
Aw 9,9
Aw 10,10
Aw 11,11
Aw 12,12
Aw 13,13
Aw 14,14
Aw 15,15
Ar 8,16
Ar 9,17
Ar 10,18
Ar 11,19
Ar 12,20
Ar 13,21
Ar 14,22
Ar 15,23
Vm 8,8,22
Vm 9,9,22
Vm 10,10,22
Vm 11,11,22
Vm 12,12,22
Vm 13,13,22
Vm 14,14,22
Vm 15,15,22
Aw 16,8
Aw 17,9
Aw 18,10
Aw 19,11
Aw 20,12
Aw 21,13
Aw 22,14
Aw 23,15
Ar 8,24
Ar 9,25
Ar 10,26
Ar 11,27
Ar 12,28
Ar 13,29
Ar 14,30
Ar 15,31
Vm 8,8,22
Vm 9,9,22
Vm 10,10,22
Vm 11,11,22
Vm 12,12,22
Vm 13,13,22
Vm 14,14,22
Vm 15,15,22
Aw 24,8
Aw 25,9
Aw 26,10
Aw 27,11
Aw 28,12
Aw 29,13
Aw 30,14
Aw 31,15
v_max3_f32 v21, v144, v145, v146
v_max3_f32 v21, v21, v147, v148
v_max3_f32 v21, v21, v149, v150
v_max3_f32 v21, v21, v151, v152
v_max3_f32 v21, v21, v153, v154
v_max3_f32 v21, v21, v155, v156
v_max3_f32 v21, v21, v157, v158
v_max_f32 v21, v21, v159
v_mov_b32 v1, v21
s_nop 1
v_permlane16_swap_b32 v1, v21
v_max_f32 v21, v21, v1
v_mov_b32 v1, v21
s_nop 1
v_permlane32_swap_b32 v1, v21
v_max_f32_e64 v21, v21, v1
v_add_f32 v21, 0x41f80000, v21
v_max_f32 v21, 0, v21
Vs 144,144,21
Vs 145,145,21
Vs 146,146,21
Vs 147,147,21
Vs 148,148,21
Vs 149,149,21
Vs 150,150,21
Vs 151,151,21
Vs 152,152,21
Vs 153,153,21
Vs 154,154,21
Vs 155,155,21
Vs 156,156,21
Vs 157,157,21
Vs 158,158,21
Vs 159,159,21
Vs 36,36,21
Vs 37,37,21
Vs 38,38,21
v_sub_f32_e64 v39, v39, v21
v_exp_f32 v22, -v21
s_nop 0
Vm 52,52,22
Vm 53,53,22
Vm 54,54,22
v_mul_f32_e64 v55, v55, v22
Ar 8,32
Ar 9,33
Ar 10,34
Ar 11,35
Ar 12,36
Ar 13,37
Ar 14,38
Ar 15,39
Vm 8,8,22
Vm 9,9,22
Vm 10,10,22
Vm 11,11,22
Vm 12,12,22
Vm 13,13,22
Vm 14,14,22
Vm 15,15,22
Aw 32,8
Aw 33,9
Aw 34,10
Aw 35,11
Aw 36,12
Aw 37,13
Aw 38,14
Aw 39,15
Ar 8,40
Ar 9,41
Ar 10,42
Ar 11,43
Ar 12,44
Ar 13,45
Ar 14,46
Ar 15,47
Vm 8,8,22
Vm 9,9,22
Vm 10,10,22
Vm 11,11,22
Vm 12,12,22
Vm 13,13,22
Vm 14,14,22
Vm 15,15,22
Aw 40,8
Aw 41,9
Aw 42,10
Aw 43,11
Aw 44,12
Aw 45,13
Aw 46,14
Aw 47,15
Ar 8,48
Ar 9,49
Ar 10,50
Ar 11,51
Ar 12,52
Ar 13,53
Ar 14,54
Ar 15,55
Vm 8,8,22
Vm 9,9,22
Vm 10,10,22
Vm 11,11,22
Vm 12,12,22
Vm 13,13,22
Vm 14,14,22
Vm 15,15,22
Aw 48,8
Aw 49,9
Aw 50,10
Aw 51,11
Aw 52,12
Aw 53,13
Aw 54,14
Aw 55,15
Ar 8,56
Ar 9,57
Ar 10,58
Ar 11,59
Ar 12,60
Ar 13,61
Ar 14,62
Ar 15,63
Vm 8,8,22
Vm 9,9,22
Vm 10,10,22
Vm 11,11,22
Vm 12,12,22
Vm 13,13,22
Vm 14,14,22
Vm 15,15,22
Aw 56,8
Aw 57,9
Aw 58,10
Aw 59,11
Aw 60,12
Aw 61,13
Aw 62,14
Aw 63,15
Ve 8,128
Ve 9,129
s_nop 0
Vc 64,8,9
Ve 8,130
Ve 9,131
s_nop 0
Vc 65,8,9
Ve 8,144
Ve 9,145
s_nop 0
Vc 72,8,9
Ve 8,146
Ve 9,147
s_nop 0
Vc 73,8,9
Ve 8,132
Ve 9,133
s_nop 0
Vc 66,8,9
Ve 8,134
Ve 9,135
s_nop 0
Vc 67,8,9
Ve 8,148
Ve 9,149
s_nop 0
Vc 74,8,9
Ve 8,150
Ve 9,151
s_nop 0
Vc 75,8,9
Ve 8,136
Ve 9,137
s_nop 0
Vc 68,8,9
Ve 8,138
Ve 9,139
s_nop 0
Vc 69,8,9
Ve 8,152
Ve 9,153
s_nop 0
Vc 76,8,9
Ve 8,154
Ve 9,155
s_nop 0
Vc 77,8,9
Ve 8,140
Ve 9,141
s_nop 0
Vc 70,8,9
Ve 8,142
Ve 9,143
s_nop 0
Vc 71,8,9
Ve 8,156
Ve 9,157
s_nop 0
Vc 78,8,9
Ve 8,158
Ve 9,159
s_nop 0
Vc 79,8,9
s_nop 1
s_branch L_k2_fbr_nl
L_k2_fb_fi:
s_nop 7
s_nop 0
v_max3_f32 v21, v192, v193, v194
v_max3_f32 v21, v21, v195, v196
v_max3_f32 v21, v21, v197, v198
v_max3_f32 v21, v21, v199, v200
v_max3_f32 v21, v21, v201, v202
v_max3_f32 v21, v21, v203, v204
v_max3_f32 v21, v21, v205, v206
v_max_f32 v21, v21, v207
v_mov_b32 v1, v21
s_nop 1
v_permlane16_swap_b32 v1, v21
v_max_f32 v21, v21, v1
v_mov_b32 v1, v21
s_nop 1
v_permlane32_swap_b32 v1, v21
v_max_f32_e64 v21, v21, v1
v_add_f32 v21, 0x41f80000, v21
v_max_f32 v21, 0, v21
Vs 192,192,21
Vs 193,193,21
Vs 194,194,21
Vs 195,195,21
Vs 196,196,21
Vs 197,197,21
Vs 198,198,21
Vs 199,199,21
Vs 200,200,21
Vs 201,201,21
Vs 202,202,21
Vs 203,203,21
Vs 204,204,21
Vs 205,205,21
Vs 206,206,21
Vs 207,207,21
Vs 32,32,21
Vs 33,33,21
Vs 34,34,21
v_sub_f32_e64 v35, v35, v21
v_exp_f32 v22, -v21
s_nop 0
Vm 48,48,22
Vm 49,49,22
Vm 50,50,22
v_mul_f32_e64 v51, v51, v22
Ar 8,0
Ar 9,1
Ar 10,2
Ar 11,3
Ar 12,4
Ar 13,5
Ar 14,6
Ar 15,7
Vm 8,8,22
Vm 9,9,22
Vm 10,10,22
Vm 11,11,22
Vm 12,12,22
Vm 13,13,22
Vm 14,14,22
Vm 15,15,22
Aw 0,8
Aw 1,9
Aw 2,10
Aw 3,11
Aw 4,12
Aw 5,13
Aw 6,14
Aw 7,15
Ar 8,8
Ar 9,9
Ar 10,10
Ar 11,11
Ar 12,12
Ar 13,13
Ar 14,14
Ar 15,15
Vm 8,8,22
Vm 9,9,22
Vm 10,10,22
Vm 11,11,22
Vm 12,12,22
Vm 13,13,22
Vm 14,14,22
Vm 15,15,22
Aw 8,8
Aw 9,9
Aw 10,10
Aw 11,11
Aw 12,12
Aw 13,13
Aw 14,14
Aw 15,15
Ar 8,16
Ar 9,17
Ar 10,18
Ar 11,19
Ar 12,20
Ar 13,21
Ar 14,22
Ar 15,23
Vm 8,8,22
Vm 9,9,22
Vm 10,10,22
Vm 11,11,22
Vm 12,12,22
Vm 13,13,22
Vm 14,14,22
Vm 15,15,22
Aw 16,8
Aw 17,9
Aw 18,10
Aw 19,11
Aw 20,12
Aw 21,13
Aw 22,14
Aw 23,15
Ar 8,24
Ar 9,25
Ar 10,26
Ar 11,27
Ar 12,28
Ar 13,29
Ar 14,30
Ar 15,31
Vm 8,8,22
Vm 9,9,22
Vm 10,10,22
Vm 11,11,22
Vm 12,12,22
Vm 13,13,22
Vm 14,14,22
Vm 15,15,22
Aw 24,8
Aw 25,9
Aw 26,10
Aw 27,11
Aw 28,12
Aw 29,13
Aw 30,14
Aw 31,15
Ve 8,192
Ve 9,193
s_nop 0
Vc 96,8,9
Ve 8,194
Ve 9,195
s_nop 0
Vc 97,8,9
Ve 8,196
Ve 9,197
s_nop 0
Vc 98,8,9
Ve 8,198
Ve 9,199
s_nop 0
Vc 99,8,9
Ve 8,200
Ve 9,201
s_nop 0
Vc 100,8,9
Ve 8,202
Ve 9,203
s_nop 0
Vc 101,8,9
Ve 8,204
Ve 9,205
s_nop 0
Vc 102,8,9
Ve 8,206
Ve 9,207
s_nop 0
Vc 103,8,9
s_nop 1
s_branch L_k2_fbr_fi
L_spinX:
s_mov_b32 s47, 0x400000
L_spinXl:
buffer_load_dword v17, v126, s[20:23], s24 offen sc1
s_sub_u32 s47, s47, 1
s_waitcnt vmcnt(0)
s_cmp_eq_u32 s47, 0
s_cbranch_scc1 L_spinXlx
v_cmp_ne_u32 vcc, 1, v17
s_cbranch_vccz L_spinXlx
s_sleep 1
s_branch L_spinXl
L_spinXlx:
buffer_load_dwordx4 v[160:163], v112, s[16:19], s25 offen offset:0 sc1
buffer_load_dwordx4 v[164:167], v112, s[16:19], s25 offen offset:1024 sc1
buffer_load_dwordx4 v[168:171], v112, s[16:19], s25 offen offset:2048 sc1
buffer_load_dwordx4 v[172:175], v112, s[16:19], s25 offen offset:3072 sc1
buffer_load_dwordx4 v[176:179], v10, s[16:19], s25 offen offset:0 sc1
buffer_load_dwordx4 v[180:183], v10, s[16:19], s25 offen offset:1024 sc1
buffer_load_dwordx4 v[184:187], v10, s[16:19], s25 offen offset:2048 sc1
buffer_load_dwordx4 v[188:191], v10, s[16:19], s25 offen offset:3072 sc1
s_branch L_spinXr
L_ysl:
s_mov_b32 s47, 0x400000
L_ysll:
buffer_load_dword v124, v127, s[20:23], s41 offen sc1
s_sub_u32 s47, s47, 1
s_waitcnt vmcnt(0)
s_cmp_eq_u32 s47, 0
s_cbranch_scc1 L_ysllx
v_cmp_ne_u32 vcc, 1, v124
s_cbranch_vccz L_ysllx
s_sleep 8
s_branch L_ysll
L_ysllx:
v_lshlrev_b32 v124, 2, v0
v_lshlrev_b32 v125, 1, v0
s_lshl_b32 s7, s45, 2
s_add_u32 s7, s7, s32
s_lshr_b32 s3, s42, 5
s_cmp_lg_u32 s3, s7
s_cbranch_scc1 L_f_yl13
s_add_u32 s3, s55, 0
s_nop 0
s_add_u32 s7, s3, 4096
buffer_load_dword v76, v124, s[20:23], s3 offen offset:0 sc1
buffer_load_dword v77, v124, s[20:23], s3 offen offset:512 sc1
buffer_load_dword v78, v124, s[20:23], s3 offen offset:1024 sc1
buffer_load_dword v79, v124, s[20:23], s3 offen offset:1536 sc1
buffer_load_dword v80, v124, s[20:23], s3 offen offset:2048 sc1
buffer_load_dword v81, v124, s[20:23], s3 offen offset:2560 sc1
buffer_load_dword v82, v124, s[20:23], s3 offen offset:3072 sc1
buffer_load_dword v83, v124, s[20:23], s3 offen offset:3584 sc1
buffer_load_dword v84, v124, s[20:23], s7 offen offset:0 sc1
buffer_load_dword v85, v124, s[20:23], s7 offen offset:512 sc1
buffer_load_dword v86, v124, s[20:23], s7 offen offset:1024 sc1
buffer_load_dword v87, v124, s[20:23], s7 offen offset:1536 sc1
buffer_load_dword v88, v124, s[20:23], s7 offen offset:2048 sc1
buffer_load_dword v89, v124, s[20:23], s7 offen offset:2560 sc1
s_lshl_b32 s3, s42, 11
s_lshl_b32 s7, s46, 7
s_add_u32 s3, s3, s7
buffer_load_ushort v90, v125, s[56:59], s3 offen
s_lshl_b32 s3, s42, 3
s_add_u32 s3, s3, 5259264
buffer_load_dwordx2 v[92:93], v126, s[20:23], s3 offen sc1
L_f_yl13:
s_lshl_b32 s7, s45, 2
s_add_u32 s7, s7, s32
s_lshr_b32 s3, s43, 5
s_cmp_lg_u32 s3, s7
s_cbranch_scc1 L_f_yl14
s_nop 0
s_add_u32 s3, s55, 256
s_add_u32 s7, s3, 4096
buffer_load_dword v94, v124, s[20:23], s3 offen offset:0 sc1
buffer_load_dword v95, v124, s[20:23], s3 offen offset:512 sc1
buffer_load_dword v96, v124, s[20:23], s3 offen offset:1024 sc1
buffer_load_dword v97, v124, s[20:23], s3 offen offset:1536 sc1
buffer_load_dword v98, v124, s[20:23], s3 offen offset:2048 sc1
buffer_load_dword v99, v124, s[20:23], s3 offen offset:2560 sc1
buffer_load_dword v100, v124, s[20:23], s3 offen offset:3072 sc1
buffer_load_dword v101, v124, s[20:23], s3 offen offset:3584 sc1
buffer_load_dword v102, v124, s[20:23], s7 offen offset:0 sc1
buffer_load_dword v103, v124, s[20:23], s7 offen offset:512 sc1
buffer_load_dword v104, v124, s[20:23], s7 offen offset:1024 sc1
buffer_load_dword v105, v124, s[20:23], s7 offen offset:1536 sc1
buffer_load_dword v106, v124, s[20:23], s7 offen offset:2048 sc1
buffer_load_dword v107, v124, s[20:23], s7 offen offset:2560 sc1
s_lshl_b32 s3, s43, 11
s_lshl_b32 s7, s46, 7
s_add_u32 s3, s3, s7
buffer_load_ushort v108, v125, s[56:59], s3 offen
s_lshl_b32 s3, s43, 3
s_add_u32 s3, s3, 5259264
buffer_load_dwordx2 v[110:111], v126, s[20:23], s3 offen sc1
L_f_yl14:
s_waitcnt vmcnt(0)
s_lshl_b32 s7, s45, 2
s_add_u32 s7, s7, s32
s_lshr_b32 s3, s42, 5
s_cmp_lg_u32 s3, s7
s_cbranch_scc1 L_f_ys15
v_pk_add_f32 v[76:77], v[76:77], v[78:79]
v_pk_add_f32 v[76:77], v[76:77], v[80:81]
v_pk_add_f32 v[76:77], v[76:77], v[82:83]
v_pk_add_f32 v[76:77], v[76:77], v[84:85]
v_pk_add_f32 v[76:77], v[76:77], v[86:87]
v_pk_add_f32 v[76:77], v[76:77], v[88:89]
Va 76,76,77
v_lshlrev_b32 v90, 16, v90
v_sub_f32_e64 v90, v90, v92
Vc 76,76,76
v_lshlrev_b32_e64 v76, 16, v76
Vc 90,90,90
v_lshlrev_b32 v90, 16, v90
v_mul_f32 v76, s100, v76
v_mul_f32_e64 v90, v90, v93
Vc 76,76,76
v_lshlrev_b32_e64 v76, 16, v76
Vc 90,90,90
v_lshlrev_b32 v90, 16, v90
Va 90,90,76
Vc 90,90,90
v_lshlrev_b32_e64 v90, 16, v90
v_mul_f32 v76, 0xbfb8aa3b, v90
Ve 76,76
s_nop 0
v_add_f32 v76, 1.0, v76
v_rcp_f32 v76, v76
s_nop 0
Vm 90,90,76
Vc 90,90,90
v_lshlrev_b32 v90, 16, v90
v_lshlrev_b32 v124, 2, v0
v_add_u32 v124, s35, v124
v_lshlrev_b32 v125, 5, v122
v_add_u32 v125, s35, v125
s_waitcnt lgkmcnt(0)
ds_write_b32 v124, v90
s_and_b32 s3, s42, 7
s_lshl_b32 s3, s3, 3
s_lshl_b64 s[4:5], 0xff, s3
s_bfe_u32 s3, s42, 0x20003
s_mov_b64 exec, s[4:5]
s_cmp_lg_u32 s3, 0
s_cbranch_scc1 L_f_yp16
ds_read_b64 v[42:43], v125
ds_read_b64 v[44:45], v125 offset:8
ds_read_b64 v[46:47], v125 offset:16
ds_read_b64 v[48:49], v125 offset:24
L_f_yp16:
s_cmp_lg_u32 s3, 1
s_cbranch_scc1 L_f_yp17
ds_read_b64 v[50:51], v125
ds_read_b64 v[52:53], v125 offset:8
ds_read_b64 v[54:55], v125 offset:16
ds_read_b64 v[56:57], v125 offset:24
L_f_yp17:
s_cmp_lg_u32 s3, 2
s_cbranch_scc1 L_f_yp18
ds_read_b64 v[58:59], v125
ds_read_b64 v[60:61], v125 offset:8
ds_read_b64 v[62:63], v125 offset:16
ds_read_b64 v[64:65], v125 offset:24
L_f_yp18:
s_cmp_lg_u32 s3, 3
s_cbranch_scc1 L_f_yp19
ds_read_b64 v[66:67], v125
ds_read_b64 v[68:69], v125 offset:8
s_waitcnt lgkmcnt(9)
ds_read_b64 v[70:71], v125 offset:16
ds_read_b64 v[72:73], v125 offset:24
L_f_yp19:
s_mov_b64 exec, -1
s_waitcnt lgkmcnt(0)
L_f_ys15:
s_lshl_b32 s7, s45, 2
s_add_u32 s7, s7, s32
s_lshr_b32 s3, s43, 5
s_cmp_lg_u32 s3, s7
s_cbranch_scc1 L_f_ys20
s_nop 0
v_pk_add_f32 v[94:95], v[94:95], v[96:97]
v_pk_add_f32 v[94:95], v[94:95], v[98:99]
v_pk_add_f32 v[94:95], v[94:95], v[100:101]
v_pk_add_f32 v[94:95], v[94:95], v[102:103]
v_pk_add_f32 v[94:95], v[94:95], v[104:105]
v_pk_add_f32 v[94:95], v[94:95], v[106:107]
Va 94,94,95
v_lshlrev_b32 v108, 16, v108
v_sub_f32_e64 v108, v108, v110
Vc 94,94,94
v_lshlrev_b32_e64 v94, 16, v94
Vc 108,108,108
v_lshlrev_b32 v108, 16, v108
v_mul_f32 v94, s101, v94
v_mul_f32_e64 v108, v108, v111
Vc 94,94,94
v_lshlrev_b32_e64 v94, 16, v94
Vc 108,108,108
v_lshlrev_b32 v108, 16, v108
Va 108,108,94
Vc 108,108,108
v_lshlrev_b32_e64 v108, 16, v108
v_mul_f32 v94, 0xbfb8aa3b, v108
Ve 94,94
s_nop 0
v_add_f32 v94, 1.0, v94
v_rcp_f32 v94, v94
s_nop 0
Vm 108,108,94
Vc 108,108,108
v_lshlrev_b32 v108, 16, v108
v_lshlrev_b32 v124, 2, v0
v_add_u32 v124, s35, v124
v_lshlrev_b32 v125, 5, v122
v_add_u32 v125, s35, v125
s_waitcnt lgkmcnt(0)
ds_write_b32 v124, v108
s_and_b32 s3, s43, 7
s_lshl_b32 s3, s3, 3
s_lshl_b64 s[4:5], 0xff, s3
s_bfe_u32 s3, s43, 0x20003
s_mov_b64 exec, s[4:5]
s_cmp_lg_u32 s3, 0
s_cbranch_scc1 L_f_yp21
ds_read_b64 v[42:43], v125
ds_read_b64 v[44:45], v125 offset:8
ds_read_b64 v[46:47], v125 offset:16
ds_read_b64 v[48:49], v125 offset:24
L_f_yp21:
s_cmp_lg_u32 s3, 1
s_cbranch_scc1 L_f_yp22
ds_read_b64 v[50:51], v125
ds_read_b64 v[52:53], v125 offset:8
ds_read_b64 v[54:55], v125 offset:16
ds_read_b64 v[56:57], v125 offset:24
L_f_yp22:
s_cmp_lg_u32 s3, 2
s_cbranch_scc1 L_f_yp23
ds_read_b64 v[58:59], v125
ds_read_b64 v[60:61], v125 offset:8
ds_read_b64 v[62:63], v125 offset:16
ds_read_b64 v[64:65], v125 offset:24
L_f_yp23:
s_cmp_lg_u32 s3, 3
s_cbranch_scc1 L_f_yp24
ds_read_b64 v[66:67], v125
ds_read_b64 v[68:69], v125 offset:8
s_waitcnt lgkmcnt(9)
ds_read_b64 v[70:71], v125 offset:16
ds_read_b64 v[72:73], v125 offset:24
L_f_yp24:
s_mov_b64 exec, -1
s_waitcnt lgkmcnt(0)
L_f_ys20:
s_branch L_yslr
.section .rodata,"a"
.p2align 6
.amdhsa_kernel recurrent_scan__compressed_kv_cla__moe_arch_mod__prompt_kernel
  .amdhsa_next_free_vgpr 512
  .amdhsa_next_free_sgpr 102
  .amdhsa_accum_offset 256
  .amdhsa_group_segment_fixed_size 0
  .amdhsa_kernarg_size 112
  .amdhsa_user_sgpr_count 2
  .amdhsa_user_sgpr_kernarg_segment_ptr 1
  .amdhsa_system_sgpr_workgroup_id_x 1
.end_amdhsa_kernel
```

```asm
; @launch grid=(256,1,1) block=(256,1,1) lds=163840
.amdgcn_target "amdgcn-amd-amdhsa--gfx950"
.macro Va d,x,y
v_add_f32 v\d, v\x, v\y
.endm
.macro Vc d,x,y
v_cvt_pk_bf16_f32 v\d, v\x, v\y
.endm
.macro Ra d,x,o
ds_read_b128 a[\d:\d+3], v\x offset:\o
.endm
.macro Ta d,x,o
ds_read_b64_tr_b16 a[\d:\d+1], v\x offset:\o
.endm
.macro Zvaa d,x,y
v_mfma_f32_16x16x32_bf16 v[\d:\d+3], a[\x:\x+3], a[\y:\y+3], 0
.endm
.macro Mvaa d,x,y
v_mfma_f32_16x16x32_bf16 v[\d:\d+3], a[\x:\x+3], a[\y:\y+3], v[\d:\d+3]
.endm
.macro Rv d,x,o
ds_read_b128 v[\d:\d+3], v\x offset:\o
.endm
.macro Zaaa d,x,y
v_mfma_f32_16x16x32_bf16 a[\d:\d+3], a[\x:\x+3], a[\y:\y+3], 0
.endm
.macro Maaa d,x,y
v_mfma_f32_16x16x32_bf16 a[\d:\d+3], a[\x:\x+3], a[\y:\y+3], a[\d:\d+3]
.endm
.macro Ar d,x
v_accvgpr_read_b32 v\d, a\x
.endm
.macro VE d,x
v_exp_f32_e64 v\d, v\x
.endm
.macro Aw d,x
v_accvgpr_write_b32 a\d, v\x
.endm
.macro Vs d,x,y
v_sub_f32 v\d, v\x, v\y
.endm
.macro Ve d,x
v_exp_f32 v\d, v\x
.endm
.macro Cvaa d,x,y,c
v_mfma_f32_16x16x32_bf16 v[\d:\d+3], a[\x:\x+3], a[\y:\y+3], v[\c:\c+3]
.endm
.macro Maav d,x,y
v_mfma_f32_16x16x32_bf16 a[\d:\d+3], a[\x:\x+3], v[\y:\y+3], a[\d:\d+3]
.endm
.macro Mvvv d,x,y
v_mfma_f32_16x16x32_bf16 v[\d:\d+3], v[\x:\x+3], v[\y:\y+3], v[\d:\d+3]
.endm
.macro Zvva d,x,y
v_mfma_f32_16x16x32_bf16 v[\d:\d+3], v[\x:\x+3], a[\y:\y+3], 0
.endm
.macro Mvva d,x,y
v_mfma_f32_16x16x32_bf16 v[\d:\d+3], v[\x:\x+3], a[\y:\y+3], v[\d:\d+3]
.endm
.macro Vm d,x,y
v_mul_f32 v\d, v\x, v\y
.endm
.macro Zvvv d,x,y
v_mfma_f32_16x16x32_bf16 v[\d:\d+3], v[\x:\x+3], v[\y:\y+3], 0
.endm
.text
.globl recurrent_scan__compressed_kv_cla__moe_arch_mod__prompt_kernel
.p2align 8
.type recurrent_scan__compressed_kv_cla__moe_arch_mod__prompt_kernel,@function
recurrent_scan__compressed_kv_cla__moe_arch_mod__prompt_kernel:
s_cmp_ge_u32 s2, 256
s_cbranch_scc1 L_k2_end
s_load_dwordx4 s[4:7], s[0:1], 0
s_load_dwordx2 s[44:45], s[0:1], 56
s_load_dwordx4 s[40:43], s[0:1], 24
s_load_dwordx4 s[64:67], s[0:1], 96
v_lshrrev_b32 v1, 6, v0
v_and_b32 v0, 63, v0
v_readfirstlane_b32 s32, v1
s_getpc_b64 s[68:69]
L_cpf1:
s_add_u32 s68, s68, (recurrent_scan__compressed_kv_cla__moe_arch_mod__prompt_kernel-L_cpf1)&0xffffffff
s_addc_u32 s69, s69, ((recurrent_scan__compressed_kv_cla__moe_arch_mod__prompt_kernel-L_cpf1)>>32)&0xffffffff
s_lshr_b32 s70, s2, 3
s_lshl_b32 s70, s70, 2
s_add_u32 s70, s70, s32
s_lshl_b32 s70, s70, 10
v_and_b32 v122, 7, v0
v_lshlrev_b32 v122, 7, v122
v_add_u32 v122, s70, v122
v_min_u32 v122, L_k2_fin-recurrent_scan__compressed_kv_cla__moe_arch_mod__prompt_kernel-4, v122
v_mov_b32 v121, s69
v_add_co_u32 v120, vcc, s68, v122
s_nop 1
v_addc_co_u32 v121, vcc, 0, v121, vcc
global_load_dword v124, v[120:121], off
v_lshrrev_b32 v33, 5, v0
v_and_b32 v31, 31, v0
v_lshlrev_b32_e64 v36, 4, v31
v_lshl_add_u32 v35, v33, 11, v36
s_lshl_b32 s36, s2, 14
s_lshl_b32 s37, s32, 12
s_add_u32 s36, s36, s37
s_mov_b32 s18, 4194304
s_mov_b32 s19, 0x20000
s_bfe_u32 s33, s2, 0x30003
s_lshr_b32 s35, s2, 7
s_bfe_u32 s3, s2, 0x10006
s_and_b32 s34, s2, 7
s_lshl_b32 s34, s34, 1
s_add_u32 s34, s34, s3
s_waitcnt lgkmcnt(0)
s_mov_b32 s16, s4
s_and_b32 s17, s5, 0xffff
buffer_load_dwordx4 v[48:51], v35, s[16:19], s36 offen offset:0
buffer_load_dwordx4 v[52:55], v35, s[16:19], s36 offen offset:512
buffer_load_dwordx4 v[56:59], v35, s[16:19], s36 offen offset:1024
buffer_load_dwordx4 v[60:63], v35, s[16:19], s36 offen offset:1536
s_cmp_eq_u32 s35, 0
s_cselect_b32 s40, s40, s42
s_cselect_b32 s41, s41, s43
s_lshl_b32 s3, s34, 9
s_add_u32 s12, s40, s3
s_addc_u32 s13, s41, 0
s_and_b32 s13, s13, 0xffff
s_mov_b32 s14, 0
s_mov_b32 s15, 0x20000
s_sub_u32 s14, 4194304, s3
s_lshl_b32 s3, s33, 18
s_add_u32 s8, s6, s3
s_addc_u32 s9, s7, 0
s_and_b32 s9, s9, 0xffff
s_mov_b32 s10, 262144
s_mov_b32 s11, 0x20000
s_and_b32 s58, s2, 7
s_mov_b32 s52, 0
s_mov_b32 s53, 15360
s_mov_b32 s54, 30720
s_mov_b32 s55, 46080
s_lshl_b32 s57, s32, 13
s_add_u32 s56, s57, 32768
s_lshl_b32 s3, s58, 2
s_add_u32 s3, s3, s32
s_lshl_b32 s3, s3, 4
v_add_u32 v30, s3, v33
v_lshlrev_b32 v30, 13, v30
v_lshlrev_b32 v34, 5, v33
v_xor_b32 v34, v34, v36
v_add_u32 v6, v34, v30
v_xor_b32_e64 v7, 64, v6
v_xor_b32 v8, 65664, v6
v_xor_b32 v9, 65728, v6
s_add_u32 m0, s57, 0
s_nop 0
buffer_load_dwordx4 v6, s[12:15], s52 offen offset:0 lds
buffer_load_dwordx4 v7, s[12:15], s53 offen offset:1024 lds
buffer_load_dwordx4 v6, s[12:15], s54 offen offset:2048 lds
buffer_load_dwordx4 v7, s[12:15], s55 offen offset:3072 lds
s_add_u32 m0, s57, 4096
s_nop 0
s_nop 0
buffer_load_dwordx4 v8, s[12:15], s52 offen offset:0 lds
buffer_load_dwordx4 v9, s[12:15], s53 offen offset:1024 lds
buffer_load_dwordx4 v8, s[12:15], s54 offen offset:2048 lds
buffer_load_dwordx4 v9, s[12:15], s55 offen offset:3072 lds
v_xor_b32 v6, 524288, v6
v_xor_b32 v7, 524288, v7
v_xor_b32 v8, 524288, v8
v_xor_b32 v9, 524288, v9
s_mov_b32 s48, 0
s_mov_b32 s49, 7168
s_mov_b32 s50, 14336
s_mov_b32 s51, 21504
v_lshrrev_b32 v30, 3, v0
v_lshlrev_b32 v30, 10, v30
s_lshl_b32 s3, s32, 16
s_lshl_b32 s39, s58, 7
s_add_u32 s3, s3, s39
v_and_b32 v31, 7, v0
v_lshrrev_b32 v32, 4, v0
v_xor_b32_e64 v31, v31, v32
v_lshl_add_u32 v30, v31, 4, v30
v_add_u32 v2, s3, v30
v_xor_b32 v3, 64, v2
v_xor_b32 v4, 32768, v2
v_xor_b32 v5, 32832, v2
s_cmp_lt_u32 s32, 2
s_cselect_b32 s60, s8, s12
s_cselect_b32 s61, s9, s13
s_cselect_b32 s62, s10, s14
s_mov_b32 s63, 0x20000
s_mov_b32 s59, 524288
s_cselect_b32 s59, 128, s59
s_cselect_b64 vcc, -1, 0
s_cselect_b32 s38, 32, 16
s_lshr_b32 s3, s2, 6
s_cmp_lt_u32 s32, 2
s_cselect_b32 s3, s3, s33
s_lshl_b32 s3, s3, 1
s_and_b32 s39, s32, 1
s_add_u32 s3, s3, s39
s_lshl_b32 s3, s3, 15
s_xor_b32 s39, s58, 2
s_mul_i32 s39, s39, s59
s_add_u32 s3, s3, s39
v_lshlrev_b32 v37, 10, v0
v_lshrrev_b32 v38, 2, v0
v_lshlrev_b32 v38, 13, v38
v_and_b32 v39, 3, v0
v_lshl_add_u32 v38, v39, 7, v38
v_cndmask_b32 v47, v38, v37, vcc
v_add_u32 v47, s3, v47
v_cmp_gt_u32 vcc, s38, v0
v_mov_b32 v37, 2146435072
s_nop 0
v_cndmask_b32 v47, v37, v47, vcc
s_mov_b32 s20, s66
s_and_b32 s21, s67, 0xffff
s_mov_b32 s22, 8388608
s_mov_b32 s23, 0x20000
s_add_u32 s24, s66, 8388608
s_addc_u32 s25, s67, 0
s_and_b32 s25, s25, 0xffff
s_mov_b32 s26, 35717120
s_mov_b32 s27, 0x20000
v_lshrrev_b32 v32, 4, v0
v_and_b32 v30, 15, v0
s_lshr_b32 s3, s32, 1
s_lshl_b32 s3, s3, 14
s_add_u32 s3, s3, 32768
v_lshlrev_b32 v31, 7, v30
v_add_u32 v31, s3, v31
v_lshrrev_b32 v34, 1, v30
v_xor_b32_e64 v34, v34, v32
v_lshl_add_u32 v10, v34, 4, v31
v_xor_b32 v11, 64, v10
v_lshrrev_b32 v30, 2, v30
v_lshl_add_u32 v31, v32, 3, v30
v_lshlrev_b32 v31, 9, v31
v_and_b32 v34, 3, v0
v_lshl_add_u32 v31, v34, 3, v31
s_and_b32 s3, s32, 1
s_lshl_b32 s3, s3, 8
v_add_u32 v31, s3, v31
v_and_b32 v34, 1, v32
v_lshl_add_u32 v30, v34, 2, v30
v_lshl_add_u32 v16, v30, 5, v31
v_xor_b32 v17, 32, v16
v_xor_b32 v18, 64, v16
v_xor_b32 v19, 96, v16
v_xor_b32 v20, 128, v16
v_xor_b32 v21, 160, v16
v_xor_b32 v22, 192, v16
v_xor_b32 v23, 224, v16
v_add_u32 v12, 65536, v10
v_add_u32 v13, 65536, v11
v_add_u32 v14, 65536, v16
v_add_u32 v15, 65536, v17
v_add_u32 v24, 65536, v18
v_add_u32 v25, 65536, v19
v_add_u32 v26, 65536, v20
v_add_u32 v27, 65536, v21
v_add_u32 v28, 65536, v22
v_add_u32 v29, 65536, v23
s_mov_b32 s28, s44
s_nop 0
s_and_b32 s29, s45, 0xffff
s_mov_b32 s30, 2048
s_mov_b32 s31, 0x20000
buffer_load_dwordx4 v[64:67], v36, s[28:31], 0 offen offset:0
buffer_load_dwordx4 v[68:71], v36, s[28:31], 0 offen offset:512
buffer_load_dwordx4 v[72:75], v36, s[28:31], 0 offen offset:1024
buffer_load_dwordx4 v[76:79], v36, s[28:31], 0 offen offset:1536
s_waitcnt vmcnt(12)
v_lshlrev_b32 v80, 16, v48
v_and_b32 v81, 0xffff0000, v48
v_lshlrev_b32_e64 v82, 16, v49
v_and_b32 v83, 0xffff0000, v49
v_lshlrev_b32_e64 v84, 16, v50
v_and_b32 v85, 0xffff0000, v50
v_lshlrev_b32_e64 v86, 16, v51
v_and_b32 v87, 0xffff0000, v51
v_lshlrev_b32_e64 v88, 16, v52
v_and_b32 v89, 0xffff0000, v52
v_lshlrev_b32_e64 v90, 16, v53
v_and_b32 v91, 0xffff0000, v53
v_lshlrev_b32_e64 v92, 16, v54
v_and_b32 v93, 0xffff0000, v54
v_lshlrev_b32_e64 v94, 16, v55
v_and_b32 v95, 0xffff0000, v55
v_lshlrev_b32_e64 v96, 16, v56
v_and_b32 v97, 0xffff0000, v56
v_lshlrev_b32_e64 v98, 16, v57
v_and_b32 v99, 0xffff0000, v57
v_lshlrev_b32_e64 v100, 16, v58
v_and_b32 v101, 0xffff0000, v58
v_lshlrev_b32_e64 v102, 16, v59
v_and_b32 v103, 0xffff0000, v59
v_lshlrev_b32_e64 v104, 16, v60
v_and_b32 v105, 0xffff0000, v60
v_lshlrev_b32_e64 v106, 16, v61
v_and_b32 v107, 0xffff0000, v61
v_lshlrev_b32_e64 v108, 16, v62
v_and_b32 v109, 0xffff0000, v62
v_lshlrev_b32_e64 v110, 16, v63
v_and_b32 v111, 0xffff0000, v63
v_pk_add_f32 v[40:41], v[80:81], v[82:83]
v_pk_add_f32 v[42:43], v[84:85], v[86:87]
v_pk_add_f32 v[40:41], v[40:41], v[88:89]
v_pk_add_f32 v[42:43], v[42:43], v[90:91]
v_pk_add_f32 v[40:41], v[40:41], v[92:93]
v_pk_add_f32 v[42:43], v[42:43], v[94:95]
v_pk_add_f32 v[40:41], v[40:41], v[96:97]
v_pk_add_f32 v[42:43], v[42:43], v[98:99]
v_pk_add_f32 v[40:41], v[40:41], v[100:101]
v_pk_add_f32 v[42:43], v[42:43], v[102:103]
v_pk_add_f32 v[40:41], v[40:41], v[104:105]
v_pk_add_f32 v[42:43], v[42:43], v[106:107]
v_pk_add_f32 v[40:41], v[40:41], v[108:109]
v_pk_add_f32 v[42:43], v[42:43], v[110:111]
v_pk_add_f32 v[40:41], v[40:41], v[42:43]
Va 38,40,41
s_nop 1
v_add_f32_dpp v38, v38, v38 quad_perm:[1,0,3,2] row_mask:0xf bank_mask:0xf
s_nop 1
v_add_f32_dpp v38, v38, v38 quad_perm:[2,3,0,1] row_mask:0xf bank_mask:0xf
s_nop 1
v_add_f32_dpp v38, v38, v38 row_half_mirror row_mask:0xf bank_mask:0xf
s_nop 1
v_add_f32_dpp v38, v38, v38 row_mirror row_mask:0xf bank_mask:0xf
v_mov_b32 v37, v38
s_nop 1
v_permlane16_swap_b32 v37, v38
Va 38,38,37
s_add_u32 m0, s56, 0
s_nop 0
buffer_load_dwordx4 v2, s[8:11], s48 offen offset:0 lds
buffer_load_dwordx4 v3, s[8:11], s49 offen offset:1024 lds
buffer_load_dwordx4 v2, s[8:11], s50 offen offset:2048 lds
buffer_load_dwordx4 v3, s[8:11], s51 offen offset:3072 lds
s_add_u32 m0, s56, 4096
s_nop 0
buffer_load_dwordx4 v4, s[8:11], s48 offen offset:0 lds
buffer_load_dwordx4 v5, s[8:11], s49 offen offset:1024 lds
buffer_load_dwordx4 v4, s[8:11], s50 offen offset:2048 lds
buffer_load_dwordx4 v5, s[8:11], s51 offen offset:3072 lds
v_xor_b32 v2, 128, v2
v_xor_b32 v3, 128, v3
v_xor_b32 v4, 128, v4
v_xor_b32 v5, 128, v5
v_mul_f32 v38, 0xba800000, v38
v_mov_b32_e64 v39, v38
v_pk_add_f32 v[112:113], v[80:81], v[38:39]
v_pk_mul_f32 v[40:41], v[112:113], v[112:113]
v_pk_add_f32 v[114:115], v[82:83], v[38:39]
v_pk_mul_f32 v[42:43], v[114:115], v[114:115]
v_pk_add_f32 v[116:117], v[84:85], v[38:39]
v_pk_fma_f32 v[40:41], v[116:117], v[116:117], v[40:41]
v_pk_add_f32 v[118:119], v[86:87], v[38:39]
v_pk_fma_f32 v[42:43], v[118:119], v[118:119], v[42:43]
v_pk_add_f32 v[112:113], v[88:89], v[38:39]
v_pk_fma_f32 v[40:41], v[112:113], v[112:113], v[40:41]
v_pk_add_f32 v[114:115], v[90:91], v[38:39]
v_pk_fma_f32 v[42:43], v[114:115], v[114:115], v[42:43]
v_pk_add_f32 v[116:117], v[92:93], v[38:39]
v_pk_fma_f32 v[40:41], v[116:117], v[116:117], v[40:41]
v_pk_add_f32 v[118:119], v[94:95], v[38:39]
v_pk_fma_f32 v[42:43], v[118:119], v[118:119], v[42:43]
v_pk_add_f32 v[112:113], v[96:97], v[38:39]
v_pk_fma_f32 v[40:41], v[112:113], v[112:113], v[40:41]
v_pk_add_f32 v[114:115], v[98:99], v[38:39]
v_pk_fma_f32 v[42:43], v[114:115], v[114:115], v[42:43]
v_pk_add_f32 v[116:117], v[100:101], v[38:39]
v_pk_fma_f32 v[40:41], v[116:117], v[116:117], v[40:41]
v_pk_add_f32 v[118:119], v[102:103], v[38:39]
v_pk_fma_f32 v[42:43], v[118:119], v[118:119], v[42:43]
v_pk_add_f32 v[112:113], v[104:105], v[38:39]
v_pk_fma_f32 v[40:41], v[112:113], v[112:113], v[40:41]
v_pk_add_f32 v[114:115], v[106:107], v[38:39]
v_pk_fma_f32 v[42:43], v[114:115], v[114:115], v[42:43]
v_pk_add_f32 v[116:117], v[108:109], v[38:39]
v_pk_fma_f32 v[40:41], v[116:117], v[116:117], v[40:41]
v_pk_add_f32 v[118:119], v[110:111], v[38:39]
v_pk_fma_f32 v[42:43], v[118:119], v[118:119], v[42:43]
v_pk_add_f32 v[40:41], v[40:41], v[42:43]
Va 40,40,41
s_nop 1
v_add_f32_dpp v40, v40, v40 quad_perm:[1,0,3,2] row_mask:0xf bank_mask:0xf
s_nop 1
v_add_f32_dpp v40, v40, v40 quad_perm:[2,3,0,1] row_mask:0xf bank_mask:0xf
s_nop 1
v_add_f32_dpp v40, v40, v40 row_half_mirror row_mask:0xf bank_mask:0xf
s_nop 1
v_add_f32_dpp v40, v40, v40 row_mirror row_mask:0xf bank_mask:0xf
v_mov_b32 v37, v40
s_nop 1
v_permlane16_swap_b32 v37, v40
v_add_f32_e64 v40, v40, v37
v_mul_f32 v40, 0x3a800000, v40
Vc 44,38,40
v_lshlrev_b32_e64 v38, 16, v44
v_and_b32 v40, 0xffff0000, v44
v_add_f32 v40, 0x3727c5ac, v40
Vc 44,40,40
v_lshlrev_b32 v40, 16, v44
v_sqrt_f32 v40, v40
v_mov_b32_e64 v39, v38
Vc 44,40,40
v_lshlrev_b32 v44, 16, v44
v_rcp_f32 v40, v44
v_pk_add_f32 v[80:81], v[80:81], v[38:39]
v_pk_add_f32 v[82:83], v[82:83], v[38:39]
v_pk_add_f32 v[84:85], v[84:85], v[38:39]
v_pk_add_f32 v[86:87], v[86:87], v[38:39]
v_pk_add_f32 v[88:89], v[88:89], v[38:39]
v_pk_add_f32 v[90:91], v[90:91], v[38:39]
v_pk_add_f32 v[92:93], v[92:93], v[38:39]
v_pk_add_f32 v[94:95], v[94:95], v[38:39]
v_pk_add_f32 v[96:97], v[96:97], v[38:39]
v_pk_add_f32 v[98:99], v[98:99], v[38:39]
v_pk_add_f32 v[100:101], v[100:101], v[38:39]
v_pk_add_f32 v[102:103], v[102:103], v[38:39]
v_pk_add_f32 v[104:105], v[104:105], v[38:39]
v_pk_add_f32 v[106:107], v[106:107], v[38:39]
v_pk_add_f32 v[108:109], v[108:109], v[38:39]
v_pk_add_f32 v[110:111], v[110:111], v[38:39]
v_fma_f32 v45, -v44, v40, 1.0
v_fma_f32 v40, v45, v40, v40
v_mov_b32_e64 v41, v40
Vc 48,80,81
Vc 49,82,83
Vc 50,84,85
Vc 51,86,87
Vc 52,88,89
Vc 53,90,91
Vc 54,92,93
Vc 55,94,95
Vc 56,96,97
Vc 57,98,99
Vc 58,100,101
Vc 59,102,103
Vc 60,104,105
Vc 61,106,107
Vc 62,108,109
Vc 63,110,111
v_lshlrev_b32_e64 v80, 16, v48
v_and_b32 v81, 0xffff0000, v48
v_lshlrev_b32_e64 v82, 16, v49
v_and_b32 v83, 0xffff0000, v49
v_lshlrev_b32_e64 v84, 16, v50
v_and_b32 v85, 0xffff0000, v50
v_lshlrev_b32_e64 v86, 16, v51
v_and_b32 v87, 0xffff0000, v51
v_lshlrev_b32_e64 v88, 16, v52
v_and_b32 v89, 0xffff0000, v52
v_lshlrev_b32_e64 v90, 16, v53
v_and_b32 v91, 0xffff0000, v53
v_lshlrev_b32_e64 v92, 16, v54
v_and_b32 v93, 0xffff0000, v54
v_lshlrev_b32_e64 v94, 16, v55
v_and_b32 v95, 0xffff0000, v55
v_lshlrev_b32_e64 v96, 16, v56
v_and_b32 v97, 0xffff0000, v56
v_lshlrev_b32_e64 v98, 16, v57
v_and_b32 v99, 0xffff0000, v57
v_lshlrev_b32_e64 v100, 16, v58
v_and_b32 v101, 0xffff0000, v58
v_lshlrev_b32_e64 v102, 16, v59
v_and_b32 v103, 0xffff0000, v59
v_lshlrev_b32_e64 v104, 16, v60
v_and_b32 v105, 0xffff0000, v60
v_lshlrev_b32_e64 v106, 16, v61
v_and_b32 v107, 0xffff0000, v61
v_lshlrev_b32_e64 v108, 16, v62
v_and_b32 v109, 0xffff0000, v62
v_lshlrev_b32_e64 v110, 16, v63
v_and_b32 v111, 0xffff0000, v63
v_pk_mul_f32 v[80:81], v[80:81], v[40:41]
v_pk_mul_f32 v[82:83], v[82:83], v[40:41]
v_pk_mul_f32 v[84:85], v[84:85], v[40:41]
v_pk_mul_f32 v[86:87], v[86:87], v[40:41]
v_pk_mul_f32 v[88:89], v[88:89], v[40:41]
v_pk_mul_f32 v[90:91], v[90:91], v[40:41]
v_pk_mul_f32 v[92:93], v[92:93], v[40:41]
v_pk_mul_f32 v[94:95], v[94:95], v[40:41]
v_pk_mul_f32 v[96:97], v[96:97], v[40:41]
v_pk_mul_f32 v[98:99], v[98:99], v[40:41]
v_pk_mul_f32 v[100:101], v[100:101], v[40:41]
v_pk_mul_f32 v[102:103], v[102:103], v[40:41]
v_pk_mul_f32 v[104:105], v[104:105], v[40:41]
v_pk_mul_f32 v[106:107], v[106:107], v[40:41]
v_pk_mul_f32 v[108:109], v[108:109], v[40:41]
v_pk_mul_f32 v[110:111], v[110:111], v[40:41]
Vc 48,80,81
Vc 49,82,83
Vc 50,84,85
Vc 51,86,87
Vc 52,88,89
Vc 53,90,91
Vc 54,92,93
Vc 55,94,95
Vc 56,96,97
Vc 57,98,99
Vc 58,100,101
Vc 59,102,103
Vc 60,104,105
Vc 61,106,107
Vc 62,108,109
Vc 63,110,111
s_mul_i32 s3, s32, 4128
s_add_u32 s3, s3, 131072
v_mul_u32_u24 v42, 2064, v33
v_add3_u32 v42, v42, v36, s3
ds_write_b128 v42, v[48:51] offset:0
ds_write_b128 v42, v[52:55] offset:512
ds_write_b128 v42, v[56:59] offset:1024
ds_write_b128 v42, v[60:63] offset:1536
s_waitcnt vmcnt(8)
v_lshlrev_b32 v80, 16, v48
v_and_b32 v81, 0xffff0000, v48
v_lshlrev_b32_e64 v112, 16, v64
v_and_b32 v113, 0xffff0000, v64
v_pk_mul_f32 v[42:43], v[80:81], v[112:113]
v_lshlrev_b32_e64 v82, 16, v49
v_and_b32 v83, 0xffff0000, v49
v_lshlrev_b32_e64 v114, 16, v65
v_and_b32 v115, 0xffff0000, v65
v_pk_mul_f32 v[44:45], v[82:83], v[114:115]
v_lshlrev_b32_e64 v84, 16, v50
v_and_b32 v85, 0xffff0000, v50
v_lshlrev_b32_e64 v116, 16, v66
v_and_b32 v117, 0xffff0000, v66
v_pk_fma_f32 v[42:43], v[84:85], v[116:117], v[42:43]
v_lshlrev_b32_e64 v86, 16, v51
v_and_b32 v87, 0xffff0000, v51
v_lshlrev_b32_e64 v118, 16, v67
v_and_b32 v119, 0xffff0000, v67
v_pk_fma_f32 v[44:45], v[86:87], v[118:119], v[44:45]
v_lshlrev_b32_e64 v88, 16, v52
v_and_b32 v89, 0xffff0000, v52
v_lshlrev_b32_e64 v112, 16, v68
v_and_b32 v113, 0xffff0000, v68
v_pk_fma_f32 v[42:43], v[88:89], v[112:113], v[42:43]
v_lshlrev_b32_e64 v90, 16, v53
v_and_b32 v91, 0xffff0000, v53
v_lshlrev_b32_e64 v114, 16, v69
v_and_b32 v115, 0xffff0000, v69
v_pk_fma_f32 v[44:45], v[90:91], v[114:115], v[44:45]
v_lshlrev_b32_e64 v92, 16, v54
v_and_b32 v93, 0xffff0000, v54
v_lshlrev_b32_e64 v116, 16, v70
v_and_b32 v117, 0xffff0000, v70
v_pk_fma_f32 v[42:43], v[92:93], v[116:117], v[42:43]
v_lshlrev_b32_e64 v94, 16, v55
v_and_b32 v95, 0xffff0000, v55
v_lshlrev_b32_e64 v118, 16, v71
v_and_b32 v119, 0xffff0000, v71
v_pk_fma_f32 v[44:45], v[94:95], v[118:119], v[44:45]
v_lshlrev_b32_e64 v96, 16, v56
v_and_b32 v97, 0xffff0000, v56
v_lshlrev_b32_e64 v112, 16, v72
v_and_b32 v113, 0xffff0000, v72
v_pk_fma_f32 v[42:43], v[96:97], v[112:113], v[42:43]
v_lshlrev_b32_e64 v98, 16, v57
v_and_b32 v99, 0xffff0000, v57
v_lshlrev_b32_e64 v114, 16, v73
v_and_b32 v115, 0xffff0000, v73
v_pk_fma_f32 v[44:45], v[98:99], v[114:115], v[44:45]
v_lshlrev_b32_e64 v100, 16, v58
v_and_b32 v101, 0xffff0000, v58
v_lshlrev_b32_e64 v116, 16, v74
v_and_b32 v117, 0xffff0000, v74
v_pk_fma_f32 v[42:43], v[100:101], v[116:117], v[42:43]
v_lshlrev_b32_e64 v102, 16, v59
v_and_b32 v103, 0xffff0000, v59
v_lshlrev_b32_e64 v118, 16, v75
v_and_b32 v119, 0xffff0000, v75
v_pk_fma_f32 v[44:45], v[102:103], v[118:119], v[44:45]
v_lshlrev_b32_e64 v104, 16, v60
v_and_b32 v105, 0xffff0000, v60
v_lshlrev_b32_e64 v112, 16, v76
v_and_b32 v113, 0xffff0000, v76
v_pk_fma_f32 v[42:43], v[104:105], v[112:113], v[42:43]
v_lshlrev_b32_e64 v106, 16, v61
v_and_b32 v107, 0xffff0000, v61
v_lshlrev_b32_e64 v114, 16, v77
v_and_b32 v115, 0xffff0000, v77
v_pk_fma_f32 v[44:45], v[106:107], v[114:115], v[44:45]
v_lshlrev_b32_e64 v108, 16, v62
v_and_b32 v109, 0xffff0000, v62
v_lshlrev_b32_e64 v116, 16, v78
v_and_b32 v117, 0xffff0000, v78
v_pk_fma_f32 v[42:43], v[108:109], v[116:117], v[42:43]
v_lshlrev_b32_e64 v110, 16, v63
v_and_b32 v111, 0xffff0000, v63
v_lshlrev_b32_e64 v118, 16, v79
v_and_b32 v119, 0xffff0000, v79
v_pk_fma_f32 v[44:45], v[110:111], v[118:119], v[44:45]
v_pk_add_f32 v[42:43], v[42:43], v[44:45]
Va 45,42,43
s_nop 1
v_add_f32_dpp v45, v45, v45 quad_perm:[1,0,3,2] row_mask:0xf bank_mask:0xf
s_nop 1
v_add_f32_dpp v45, v45, v45 quad_perm:[2,3,0,1] row_mask:0xf bank_mask:0xf
s_nop 1
v_add_f32_dpp v45, v45, v45 row_half_mirror row_mask:0xf bank_mask:0xf
s_nop 1
v_add_f32_dpp v45, v45, v45 row_mirror row_mask:0xf bank_mask:0xf
v_mov_b32 v37, v45
s_nop 1
v_permlane16_swap_b32 v37, v45
v_add_f32_e64 v45, v45, v37
Vc 45,45,45
v_ashrrev_i32_e64 v46, 31, v45
v_or_b32 v46, 0x80000000, v46
v_xor_b32_e64 v45, v45, v46
v_and_b32 v45, 0xffff0000, v45
s_lshr_b32 s3, s36, 11
v_add_u32 v46, s3, v33
v_sub_u32 v44, 0xffff, v46
v_or_b32 v45, v45, v44
v_lshlrev_b32 v44, 2, v46
v_lshlrev_b32_e64 v46, 3, v46
v_xor_b32 v38, 0x80000000, v38
v_mov_b32_e64 v39, v40
s_mov_b32 s3, 5242880
s_mov_b32 s39, 5259264
s_mov_b32 exec_lo, 1
s_mov_b32 exec_hi, 1
buffer_store_dword v45, v44, s[20:23], s3 offen sc1
buffer_store_dwordx2 v[38:39], v46, s[20:23], s39 offen sc1
s_mov_b64 exec, -1
s_load_dwordx2 s[4:5], s[0:1], 16
s_load_dwordx4 s[40:43], s[0:1], 64
s_load_dwordx2 s[92:93], s[0:1], 40
s_load_dwordx2 s[94:95], s[0:1], 80
s_load_dwordx2 s[100:101], s[0:1], 0
s_mov_b32 s28, s64
s_and_b32 s29, s65, 0xffff
s_mov_b32 s30, 256
s_mov_b32 s31, 0x20000
s_waitcnt vmcnt(2)
s_waitcnt lgkmcnt(0)
s_barrier
s_nop 0
Ra 224,10,0
Ra 228,11,0
Ra 232,10,2048
Ra 236,11,2048
Ta 0,16,0
Ta 2,16,2048
Ta 4,16,16384
Ta 6,16,18432
Ta 8,17,0
Ta 10,17,2048
Ta 12,17,16384
Ta 14,17,18432
Ta 16,18,0
Ta 18,18,2048
Ta 20,18,16384
s_waitcnt lgkmcnt(9)
s_nop 0
Ta 22,18,18432
Ta 24,19,0
Ta 26,19,2048
Ta 28,19,16384
Ta 30,19,18432
Ta 32,20,0
s_waitcnt lgkmcnt(9)
s_nop 0
Ta 34,20,2048
Ta 36,20,16384
Ta 38,20,18432
Ta 40,21,0
Ta 42,21,2048
Ta 44,21,16384
s_waitcnt lgkmcnt(9)
s_nop 0
Ta 46,21,18432
Ta 48,22,0
Ta 50,22,2048
Ta 52,22,16384
Ta 54,22,18432
Ta 56,23,0
s_waitcnt lgkmcnt(9)
Ta 58,23,2048
Ta 60,23,16384
Ta 62,23,18432
s_cmp_lg_u32 s35, 0
s_cbranch_scc1 L_k1_vpath
Zvaa 48,0,224
v_and_b32 v46, 7, v0
v_mul_u32_u24 v30, 2064, v46
Mvaa 48,4,228
s_add_u32 m0, s57, 65536
Zvaa 52,8,224
buffer_load_dwordx4 v6, s[12:15], s52 offen offset:0 lds
Mvaa 52,12,228
Ra 240,10,4096
Zvaa 56,16,224
buffer_load_dwordx4 v7, s[12:15], s53 offen offset:1024 lds
Mvaa 56,20,228
v_lshrrev_b32_e64 v31, 3, v0
Zvaa 60,24,224
buffer_load_dwordx4 v6, s[12:15], s54 offen offset:2048 lds
Mvaa 60,28,228
Ra 244,11,4096
Zvaa 64,32,224
buffer_load_dwordx4 v7, s[12:15], s55 offen offset:3072 lds
Mvaa 64,36,228
s_add_u32 m0, s57, 69632
s_waitcnt lgkmcnt(10)
Zvaa 68,40,224
buffer_load_dwordx4 v8, s[12:15], s52 offen offset:0 lds
Mvaa 68,44,228
Ra 248,10,6144
s_waitcnt lgkmcnt(7)
Zvaa 72,48,224
buffer_load_dwordx4 v9, s[12:15], s53 offen offset:1024 lds
Mvaa 72,52,228
s_lshl_b32 s3, s32, 9
s_add_u32 s3, s3, 131072
v_lshl_add_u32 v30, v31, 4, v30
s_waitcnt lgkmcnt(3)
Zvaa 76,56,224
buffer_load_dwordx4 v8, s[12:15], s54 offen offset:2048 lds
Mvaa 76,60,228
Ra 252,11,6144
Zvaa 80,0,232
buffer_load_dwordx4 v9, s[12:15], s55 offen offset:3072 lds
Mvaa 80,4,236
s_add_u32 m0, s56, 65536
v_xor_b32 v6, 1572864, v6
v_xor_b32 v7, 1572864, v7
Zvaa 84,8,232
buffer_load_dwordx4 v2, s[8:11], s48 offen offset:0 lds
Mvaa 84,12,236
v_xor_b32 v8, 1572864, v8
v_xor_b32 v9, 1572864, v9
Zvaa 88,16,232
buffer_load_dwordx4 v3, s[8:11], s49 offen offset:1024 lds
Mvaa 88,20,236
v_add_u32 v30, s3, v30
v_lshlrev_b32 v31, 8, v31
Zvaa 92,24,232
buffer_load_dwordx4 v2, s[8:11], s50 offen offset:2048 lds
Mvaa 92,28,236
v_lshl_add_u32 v46, v46, 4, v31
Zvaa 96,32,232
buffer_load_dwordx4 v3, s[8:11], s51 offen offset:3072 lds
Mvaa 96,36,236
s_add_u32 m0, s56, 69632
Zvaa 100,40,232
buffer_load_dwordx4 v4, s[8:11], s48 offen offset:0 lds
Mvaa 100,44,236
Rv 34,30,128
Rv 38,30,256
Zvaa 104,48,232
buffer_load_dwordx4 v5, s[8:11], s49 offen offset:1024 lds
Mvaa 104,52,236
Rv 42,30,384
Rv 30,30,0
Zvaa 108,56,232
s_waitcnt lgkmcnt(4)
buffer_load_dwordx4 v4, s[8:11], s50 offen offset:2048 lds
Mvaa 108,60,236
s_lshr_b32 s3, s2, 1
s_mul_i32 s3, s3, 33792
s_add_u32 s3, s3, s57
Zvaa 112,0,240
buffer_load_dwordx4 v5, s[8:11], s51 offen offset:3072 lds
Mvaa 112,4,244
v_xor_b32 v2, 384, v2
v_xor_b32 v3, 384, v3
Zvaa 116,8,240
s_and_b32 s39, s2, 1
s_lshl_b32 s39, s39, 7
s_add_u32 s3, s3, s39
Mvaa 116,12,244
Ra 224,10,8192
v_xor_b32 v4, 384, v4
Zvaa 120,16,240
s_add_u32 s39, s3, 4096
Mvaa 120,20,244
v_xor_b32 v5, 384, v5
Zvaa 124,24,240
Mvaa 124,28,244
Ra 228,11,8192
Zvaa 128,32,240
Mvaa 128,36,244
Zvaa 132,40,240
Mvaa 132,44,244
Ra 232,10,10240
Zvaa 136,48,240
buffer_load_dword v1, v47, s[60:63], 0 offen
Mvaa 136,52,244
s_mul_i32 vcc_lo, s59, 1
v_xor_b32 v47, vcc_lo, v47
Zvaa 140,56,240
Mvaa 140,60,244
Ra 236,11,10240
Zvaa 144,0,248
Mvaa 144,4,252
Zvaa 148,8,248
Mvaa 148,12,252
Zvaa 152,16,248
Mvaa 152,20,252
Zvaa 156,24,248
Mvaa 156,28,252
Zvaa 160,32,248
Mvaa 160,36,252
Zvaa 164,40,248
Mvaa 164,44,252
Zvaa 168,48,248
Mvaa 168,52,252
s_waitcnt vmcnt(9)
Zvaa 172,56,248
s_waitcnt lgkmcnt(0)
s_barrier
Mvaa 172,60,252
s_add_u32 m0, s57, 0
Zvaa 176,0,224
buffer_load_dwordx4 v6, s[12:15], s52 offen offset:0 lds
Mvaa 176,4,228
Ta 64,14,0
Ta 66,14,2048
Zvaa 180,8,224
Mvaa 180,12,228
Ra 240,10,12288
Zvaa 184,16,224
buffer_load_dwordx4 v7, s[12:15], s53 offen offset:1024 lds
Mvaa 184,20,228
Ta 68,14,16384
Ta 70,14,18432
Zvaa 188,24,224
Mvaa 188,28,228
Ra 244,11,12288
Zvaa 192,32,224
buffer_load_dwordx4 v6, s[12:15], s54 offen offset:2048 lds
Mvaa 192,36,228
Ta 72,15,0
Ta 74,15,2048
Zvaa 196,40,224
Mvaa 196,44,228
Ra 248,10,14336
Zvaa 200,48,224
buffer_load_dwordx4 v7, s[12:15], s55 offen offset:3072 lds
Mvaa 200,52,228
Ta 76,15,16384
Ta 78,15,18432
Zvaa 204,56,224
Mvaa 204,60,228
s_add_u32 m0, s57, 4096
Ra 252,11,14336
Zvaa 208,0,232
buffer_load_dwordx4 v8, s[12:15], s52 offen offset:0 lds
Mvaa 208,4,236
Zvaa 212,8,232
Mvaa 212,12,236
Ta 80,24,0
Ta 82,24,2048
Zvaa 216,16,232
buffer_load_dwordx4 v9, s[12:15], s53 offen offset:1024 lds
Mvaa 216,20,236
Ta 84,24,16384
s_waitcnt lgkmcnt(9)
Ta 86,24,18432
Zvaa 220,24,232
Mvaa 220,28,236
Ta 88,25,0
Ta 90,25,2048
Zvaa 224,32,232
buffer_load_dwordx4 v8, s[12:15], s54 offen offset:2048 lds
Mvaa 224,36,236
Zvaa 228,40,232
Mvaa 228,44,236
Ta 92,25,16384
Ta 94,25,18432
Zvaa 232,48,232
buffer_load_dwordx4 v9, s[12:15], s55 offen offset:3072 lds
Mvaa 232,52,236
s_waitcnt vmcnt(9)
Ta 96,26,0
s_waitcnt lgkmcnt(9)
Ta 98,26,2048
Zvaa 236,56,232
s_barrier
v_xor_b32 v6, 524288, v6
v_xor_b32 v7, 524288, v7
Mvaa 236,60,236
s_add_u32 m0, s56, 0
Ta 100,26,16384
Ta 102,26,18432
Zvaa 240,0,240
buffer_load_dwordx4 v2, s[8:11], s48 offen offset:0 lds
Mvaa 240,4,244
v_xor_b32 v8, 524288, v8
v_xor_b32 v9, 524288, v9
Zvaa 244,8,240
Mvaa 244,12,244
Ra 224,12,0
Zvaa 248,16,240
buffer_load_dwordx4 v3, s[8:11], s49 offen offset:1024 lds
Mvaa 248,20,244
Ta 104,27,0
Ta 106,27,2048
Zvaa 252,24,240
Mvaa 252,28,244
s_waitcnt lgkmcnt(9)
Ra 228,13,0
Zaaa 128,32,240
buffer_load_dwordx4 v2, s[8:11], s50 offen offset:2048 lds
Maaa 128,36,244
Ta 108,27,16384
Ta 110,27,18432
Zaaa 132,40,240
Maaa 132,44,244
Ra 232,12,2048
Zaaa 136,48,240
buffer_load_dwordx4 v3, s[8:11], s51 offen offset:3072 lds
Maaa 136,52,244
Ta 112,28,0
Ta 114,28,2048
Zaaa 140,56,240
Maaa 140,60,244
s_add_u32 m0, s56, 4096
s_waitcnt lgkmcnt(9)
Ra 236,13,2048
Zaaa 144,0,248
buffer_load_dwordx4 v4, s[8:11], s48 offen offset:0 lds
Maaa 144,4,252
Zaaa 148,8,248
Maaa 148,12,252
Ta 116,28,16384
Ta 118,28,18432
Zaaa 152,16,248
buffer_load_dwordx4 v5, s[8:11], s49 offen offset:1024 lds
Maaa 152,20,252
Ta 120,29,0
Ta 122,29,2048
Zaaa 156,24,248
Maaa 156,28,252
Ta 124,29,16384
s_waitcnt lgkmcnt(9)
Ta 126,29,18432
Zaaa 160,32,248
buffer_load_dwordx4 v4, s[8:11], s50 offen offset:2048 lds
Maaa 160,36,252
Zaaa 164,40,248
Maaa 164,44,252
Zaaa 168,48,248
buffer_load_dwordx4 v5, s[8:11], s51 offen offset:3072 lds
Maaa 168,52,252
v_xor_b32 v2, 128, v2
v_xor_b32 v3, 128, v3
Zaaa 172,56,248
s_waitcnt lgkmcnt(6)
buffer_load_dword v1, v47, s[60:63], 0 offen
v_xor_b32 v4, 128, v4
v_xor_b32 v5, 128, v5
Maaa 172,60,252
s_waitcnt lgkmcnt(0)
s_mul_i32 vcc_lo, s59, 7
v_xor_b32 v47, vcc_lo, v47
Mvaa 48,64,224
buffer_store_dwordx4 v[30:33], v46, s[20:23], s3 offen offset:0 sc1
Mvaa 48,68,228
buffer_store_dwordx4 v[34:37], v46, s[20:23], s3 offen offset:2048 sc1
Mvaa 52,72,224
buffer_store_dwordx4 v[38:41], v46, s[20:23], s39 offen offset:0 sc1
Mvaa 52,76,228
Ra 240,12,4096
Mvaa 56,80,224
buffer_store_dwordx4 v[42:45], v46, s[20:23], s39 offen offset:2048 sc1
Mvaa 56,84,228
s_lshl_b32 s3, s34, 1
s_and_b32 s36, s32, 1
s_add_u32 s3, s3, s36
Mvaa 60,88,224
s_mul_i32 s3, s3, 1116160
s_mul_i32 s36, s33, 139264
s_add_u32 s3, s3, s36
Mvaa 60,92,228
Ra 244,13,4096
Mvaa 64,96,224
s_lshr_b32 s36, s32, 1
s_mul_i32 s36, s36, 69632
s_add_u32 s3, s3, s36
Mvaa 64,100,228
s_add_u32 s38, s3, 0
s_lshl_b32 s39, s34, 7
s_lshl_b32 s36, s33, 2
Mvaa 68,104,224
s_add_u32 s39, s39, s36
s_add_u32 s39, s39, 5296128
v_mov_b32_e64 v30, 1
Mvaa 68,108,228
Ra 248,12,6144
Mvaa 72,112,224
v_mov_b32_e64 v31, 0
Mvaa 72,116,228
s_cmp_eq_u32 s32, 0
s_cselect_b32 s39, s39, 2146435072
Mvaa 76,120,224
s_mov_b64 exec, 1
buffer_store_dword v31, v31, s[20:23], s39 offen sc1
s_mov_b64 exec, -1
Mvaa 76,124,228
Ra 252,13,6144
Mvaa 80,64,232
s_and_b32 s33, s2, 7
s_lshl_b32 s33, s33, 2
s_bfe_u32 s3, s2, 0x20003
Mvaa 80,68,236
s_add_u32 s33, s33, s3
s_lshr_b32 s34, s2, 5
s_lshl_b32 s64, s34, 7
Mvaa 84,72,232
s_lshl_b32 s3, s33, 2
s_add_u32 s64, s64, s3
s_add_u32 s64, s64, 5300224
Mvaa 84,76,236
s_lshl_b32 s65, s34, 8
s_sub_u32 s65, 1920, s65
v_mul_u32_u24 v32, s65, v0
Mvaa 88,80,232
s_cmp_eq_u32 s32, 0
s_cselect_b32 s64, s64, 2146435072
Mvaa 88,84,236
s_mov_b64 exec, 3
buffer_store_dword v31, v32, s[20:23], s64 offen sc1
s_mov_b64 exec, -1
Mvaa 92,88,232
s_lshl_b32 s3, s2, 2
s_add_u32 s3, s3, 5447680
v_lshlrev_b32_e64 v32, 10, v0
Mvaa 92,92,236
s_cmp_eq_u32 s32, 0
s_cselect_b32 s3, s3, 2146435072
Mvaa 96,96,232
s_mov_b64 exec, 0x1ff
buffer_store_dword v31, v32, s[20:23], s3 offen sc1
s_mov_b64 exec, -1
Mvaa 96,100,236
s_lshl_b32 s35, s34, 1
s_sub_u32 s36, 32, s35
s_add_u32 s35, s35, 2
Mvaa 100,104,232
s_lshl_b32 s44, s32, 12
s_lshl_b32 s58, s32, 1
s_sub_u32 s58, 7, s58
Mvaa 100,108,236
s_mul_i32 s58, s58, 33792
s_sub_u32 s3, 15, s34
s_lshl_b32 s45, s3, 3
Mvaa 104,112,232
s_add_u32 s45, s45, s32
s_lshl_b32 s46, s34, 3
s_add_u32 s46, s46, s32
Mvaa 104,116,236
s_mov_b32 s68, s42
s_and_b32 s69, s43, 0xffff
s_mov_b32 s70, 7340032
Mvaa 108,120,232
s_waitcnt lgkmcnt(0)
Mvaa 108,124,236
s_mov_b32 s71, 0x20000
s_cmp_eq_u32 s32, 0
s_cselect_b32 s37, 0, 2146435072
Mvaa 112,64,240
s_lshl_b32 s3, s33, 8
s_add_u32 s16, s4, s3
s_addc_u32 s17, s5, 0
s_and_b32 s17, s17, 0xffff
Mvaa 112,68,244
s_mov_b32 s18, 0
s_mov_b32 s19, 0x20000
s_sub_u32 s18, 8388608, s3
Mvaa 116,72,240
v_and_b32 v33, 15, v0
v_lshrrev_b32 v32, 1, v33
Mvaa 116,76,244
Ra 224,12,8192
Mvaa 120,80,240
v_and_b32 v33, 1, v0
v_lshlrev_b32 v32, 13, v32
Mvaa 120,84,244
v_lshl_add_u32 v45, v33, 7, v32
Mvaa 124,88,240
s_lshl_b32 s3, s32, 3
s_add_u32 s3, s3, s34
s_mul_i32 s47, s3, 65536
Mvaa 124,92,244
Ra 228,13,8192
Mvaa 128,96,240
s_bfe_u32 s6, s2, 131075
s_lshl_b32 s3, s32, 8
s_or_b32 s6, s6, s3
Mvaa 128,100,244
Mvaa 132,104,240
Mvaa 132,108,244
Ra 232,12,10240
Mvaa 136,112,240
Mvaa 136,116,244
Mvaa 140,120,240
Mvaa 140,124,244
Ra 236,13,10240
Mvaa 144,64,248
Mvaa 144,68,252
Mvaa 148,72,248
Mvaa 148,76,252
Mvaa 152,80,248
Mvaa 152,84,252
Mvaa 156,88,248
Mvaa 156,92,252
Mvaa 160,96,248
Mvaa 160,100,252
Mvaa 164,104,248
Mvaa 164,108,252
Mvaa 168,112,248
Mvaa 168,116,252
s_waitcnt vmcnt(16)
Mvaa 172,120,248
s_waitcnt lgkmcnt(0)
s_barrier
Mvaa 172,124,252
s_add_u32 m0, s57, 65536
Mvaa 176,64,224
buffer_load_dwordx4 v6, s[12:15], s52 offen offset:0 lds
Mvaa 176,68,228
Ta 0,16,0
Ta 2,16,2048
Mvaa 180,72,224
Mvaa 180,76,228
Ra 240,12,12288
Mvaa 184,80,224
buffer_load_dwordx4 v7, s[12:15], s53 offen offset:1024 lds
Mvaa 184,84,228
Ta 4,16,16384
Ta 6,16,18432
Mvaa 188,88,224
Mvaa 188,92,228
Ra 244,13,12288
Mvaa 192,96,224
buffer_load_dwordx4 v6, s[12:15], s54 offen offset:2048 lds
Mvaa 192,100,228
Ta 8,17,0
Ta 10,17,2048
Mvaa 196,104,224
Mvaa 196,108,228
Ra 248,12,14336
Mvaa 200,112,224
buffer_load_dwordx4 v7, s[12:15], s55 offen offset:3072 lds
Mvaa 200,116,228
Ta 12,17,16384
Ta 14,17,18432
Mvaa 204,120,224
Mvaa 204,124,228
s_add_u32 m0, s57, 69632
Ra 252,13,14336
Mvaa 208,64,232
buffer_load_dwordx4 v8, s[12:15], s52 offen offset:0 lds
Mvaa 208,68,236
Mvaa 212,72,232
Mvaa 212,76,236
Ta 16,18,0
Ta 18,18,2048
Mvaa 216,80,232
buffer_load_dwordx4 v9, s[12:15], s53 offen offset:1024 lds
Mvaa 216,84,236
Ta 20,18,16384
s_waitcnt lgkmcnt(9)
Ta 22,18,18432
Mvaa 220,88,232
Mvaa 220,92,236
Ta 24,19,0
Ta 26,19,2048
Mvaa 224,96,232
buffer_load_dwordx4 v8, s[12:15], s54 offen offset:2048 lds
Mvaa 224,100,236
Mvaa 228,104,232
Mvaa 228,108,236
Ta 28,19,16384
Ta 30,19,18432
Mvaa 232,112,232
buffer_load_dwordx4 v9, s[12:15], s55 offen offset:3072 lds
Mvaa 232,116,236
s_waitcnt vmcnt(16)
Ta 32,20,0
s_waitcnt lgkmcnt(9)
Ta 34,20,2048
Mvaa 236,120,232
s_barrier
v_xor_b32 v6, 3670016, v6
v_xor_b32 v7, 3670016, v7
Mvaa 236,124,236
s_add_u32 m0, s56, 65536
Ta 36,20,16384
Ta 38,20,18432
Mvaa 240,64,240
buffer_load_dwordx4 v2, s[8:11], s48 offen offset:0 lds
Mvaa 240,68,244
v_xor_b32 v8, 3670016, v8
v_xor_b32 v9, 3670016, v9
Mvaa 244,72,240
Mvaa 244,76,244
Ra 224,10,0
Mvaa 248,80,240
buffer_load_dwordx4 v3, s[8:11], s49 offen offset:1024 lds
Mvaa 248,84,244
Ta 40,21,0
Ta 42,21,2048
Mvaa 252,88,240
Mvaa 252,92,244
s_waitcnt lgkmcnt(9)
Ra 228,11,0
Maaa 128,96,240
buffer_load_dwordx4 v2, s[8:11], s50 offen offset:2048 lds
Maaa 128,100,244
Ta 44,21,16384
Ta 46,21,18432
Maaa 132,104,240
Maaa 132,108,244
Ra 232,10,2048
Maaa 136,112,240
buffer_load_dwordx4 v3, s[8:11], s51 offen offset:3072 lds
Maaa 136,116,244
Ta 48,22,0
Ta 50,22,2048
Maaa 140,120,240
Maaa 140,124,244
s_add_u32 m0, s56, 69632
s_waitcnt lgkmcnt(9)
Ra 236,11,2048
Maaa 144,64,248
buffer_load_dwordx4 v4, s[8:11], s48 offen offset:0 lds
Maaa 144,68,252
Maaa 148,72,248
Maaa 148,76,252
Ta 52,22,16384
Ta 54,22,18432
Maaa 152,80,248
buffer_load_dwordx4 v5, s[8:11], s49 offen offset:1024 lds
Maaa 152,84,252
Ta 56,23,0
Ta 58,23,2048
Maaa 156,88,248
Maaa 156,92,252
Ta 60,23,16384
s_waitcnt lgkmcnt(9)
Ta 62,23,18432
Maaa 160,96,248
buffer_load_dwordx4 v4, s[8:11], s50 offen offset:2048 lds
Maaa 160,100,252
Maaa 164,104,248
Maaa 164,108,252
Maaa 168,112,248
buffer_load_dwordx4 v5, s[8:11], s51 offen offset:3072 lds
Maaa 168,116,252
v_xor_b32 v2, 896, v2
v_xor_b32 v3, 896, v3
Maaa 172,120,248
s_waitcnt lgkmcnt(6)
buffer_load_dword v1, v47, s[60:63], 0 offen
v_xor_b32 v4, 896, v4
v_xor_b32 v5, 896, v5
Maaa 172,124,252
s_waitcnt lgkmcnt(0)
s_mul_i32 vcc_lo, s59, 1
v_xor_b32 v47, vcc_lo, v47
Mvaa 48,0,224
Mvaa 48,4,228
Mvaa 52,8,224
Mvaa 52,12,228
Ra 240,10,4096
Mvaa 56,16,224
Mvaa 56,20,228
Mvaa 60,24,224
Mvaa 60,28,228
Ra 244,11,4096
Mvaa 64,32,224
Mvaa 64,36,228
Mvaa 68,40,224
Mvaa 68,44,228
Ra 248,10,6144
Mvaa 72,48,224
Mvaa 72,52,228
Mvaa 76,56,224
Mvaa 76,60,228
Ra 252,11,6144
Mvaa 80,0,232
Mvaa 80,4,236
Mvaa 84,8,232
Mvaa 84,12,236
Mvaa 88,16,232
Mvaa 88,20,236
Mvaa 92,24,232
Mvaa 92,28,236
Mvaa 96,32,232
Mvaa 96,36,236
Mvaa 100,40,232
Mvaa 100,44,236
Mvaa 104,48,232
Mvaa 104,52,236
Mvaa 108,56,232
s_waitcnt lgkmcnt(0)
Mvaa 108,60,236
Mvaa 112,0,240
Mvaa 112,4,244
Mvaa 116,8,240
Mvaa 116,12,244
Ra 224,10,8192
Mvaa 120,16,240
Mvaa 120,20,244
Mvaa 124,24,240
Mvaa 124,28,244
Ra 228,11,8192
Mvaa 128,32,240
Mvaa 128,36,244
Mvaa 132,40,240
Mvaa 132,44,244
Ra 232,10,10240
Mvaa 136,48,240
Mvaa 136,52,244
Mvaa 140,56,240
Mvaa 140,60,244
Ra 236,11,10240
Mvaa 144,0,248
Mvaa 144,4,252
Mvaa 148,8,248
Mvaa 148,12,252
Mvaa 152,16,248
Mvaa 152,20,252
Mvaa 156,24,248
Mvaa 156,28,252
Mvaa 160,32,248
Mvaa 160,36,252
Mvaa 164,40,248
Mvaa 164,44,252
Mvaa 168,48,248
Mvaa 168,52,252
s_waitcnt vmcnt(9)
Mvaa 172,56,248
s_waitcnt lgkmcnt(0)
s_barrier
Mvaa 172,60,252
s_add_u32 m0, s57, 0
Mvaa 176,0,224
buffer_load_dwordx4 v6, s[12:15], s52 offen offset:0 lds
Mvaa 176,4,228
Ta 64,14,0
Ta 66,14,2048
Mvaa 180,8,224
Mvaa 180,12,228
Ra 240,10,12288
Mvaa 184,16,224
buffer_load_dwordx4 v7, s[12:15], s53 offen offset:1024 lds
Mvaa 184,20,228
Ta 68,14,16384
Ta 70,14,18432
Mvaa 188,24,224
Mvaa 188,28,228
Ra 244,11,12288
Mvaa 192,32,224
buffer_load_dwordx4 v6, s[12:15], s54 offen offset:2048 lds
Mvaa 192,36,228
Ta 72,15,0
Ta 74,15,2048
Mvaa 196,40,224
Mvaa 196,44,228
Ra 248,10,14336
Mvaa 200,48,224
buffer_load_dwordx4 v7, s[12:15], s55 offen offset:3072 lds
Mvaa 200,52,228
Ta 76,15,16384
Ta 78,15,18432
Mvaa 204,56,224
s_cmp_eq_u32 s6, 0
s_cselect_b32 s3, 0, 2146435072
Mvaa 204,60,228
s_add_u32 m0, s57, 4096
Ra 252,11,14336
Mvaa 208,0,232
buffer_load_dwordx4 v8, s[12:15], s52 offen offset:0 lds
Mvaa 208,4,236
s_mov_b64 exec, 1
buffer_atomic_add v30, v31, s[28:31], s3 offen sc1
s_mov_b64 exec, -1
Mvaa 212,8,232
Mvaa 212,12,236
Ta 80,24,0
Ta 82,24,2048
Mvaa 216,16,232
buffer_load_dwordx4 v9, s[12:15], s53 offen offset:1024 lds
Mvaa 216,20,236
Ta 84,24,16384
s_waitcnt lgkmcnt(9)
Ta 86,24,18432
Mvaa 220,24,232
Mvaa 220,28,236
Ta 88,25,0
Ta 90,25,2048
Mvaa 224,32,232
buffer_load_dwordx4 v8, s[12:15], s54 offen offset:2048 lds
Mvaa 224,36,236
Mvaa 228,40,232
Mvaa 228,44,236
Ta 92,25,16384
Ta 94,25,18432
Mvaa 232,48,232
buffer_load_dwordx4 v9, s[12:15], s55 offen offset:3072 lds
Mvaa 232,52,236
s_waitcnt vmcnt(10)
Ta 96,26,0
s_waitcnt lgkmcnt(9)
Ta 98,26,2048
Mvaa 236,56,232
s_barrier
v_xor_b32 v6, 524288, v6
v_xor_b32 v7, 524288, v7
Mvaa 236,60,236
s_add_u32 m0, s56, 0
Ta 100,26,16384
Ta 102,26,18432
Mvaa 240,0,240
buffer_load_dwordx4 v2, s[8:11], s48 offen offset:0 lds
Mvaa 240,4,244
v_xor_b32 v8, 524288, v8
v_xor_b32 v9, 524288, v9
Mvaa 244,8,240
Mvaa 244,12,244
Ra 224,12,0
Mvaa 248,16,240
buffer_load_dwordx4 v3, s[8:11], s49 offen offset:1024 lds
Mvaa 248,20,244
Ta 104,27,0
Ta 106,27,2048
Mvaa 252,24,240
Mvaa 252,28,244
s_waitcnt lgkmcnt(9)
Ra 228,13,0
Maaa 128,32,240
buffer_load_dwordx4 v2, s[8:11], s50 offen offset:2048 lds
Maaa 128,36,244
Ta 108,27,16384
Ta 110,27,18432
Maaa 132,40,240
Maaa 132,44,244
Ra 232,12,2048
Maaa 136,48,240
buffer_load_dwordx4 v3, s[8:11], s51 offen offset:3072 lds
Maaa 136,52,244
Ta 112,28,0
Ta 114,28,2048
Maaa 140,56,240
Maaa 140,60,244
s_add_u32 m0, s56, 4096
s_waitcnt lgkmcnt(9)
Ra 236,13,2048
Maaa 144,0,248
buffer_load_dwordx4 v4, s[8:11], s48 offen offset:0 lds
Maaa 144,4,252
Maaa 148,8,248
Maaa 148,12,252
Ta 116,28,16384
Ta 118,28,18432
Maaa 152,16,248
buffer_load_dwordx4 v5, s[8:11], s49 offen offset:1024 lds
Maaa 152,20,252
Ta 120,29,0
Ta 122,29,2048
Maaa 156,24,248
Maaa 156,28,252
Ta 124,29,16384
s_waitcnt lgkmcnt(9)
Ta 126,29,18432
Maaa 160,32,248
buffer_load_dwordx4 v4, s[8:11], s50 offen offset:2048 lds
Maaa 160,36,252
Maaa 164,40,248
Maaa 164,44,252
Maaa 168,48,248
buffer_load_dwordx4 v5, s[8:11], s51 offen offset:3072 lds
Maaa 168,52,252
v_xor_b32 v2, 128, v2
v_xor_b32 v3, 128, v3
Maaa 172,56,248
s_waitcnt lgkmcnt(6)
buffer_load_dword v1, v47, s[60:63], 0 offen
v_xor_b32 v4, 128, v4
v_xor_b32 v5, 128, v5
Maaa 172,60,252
s_waitcnt lgkmcnt(0)
s_mul_i32 vcc_lo, s59, 3
v_xor_b32 v47, vcc_lo, v47
Mvaa 48,64,224
buffer_load_dword v44, v45, s[16:19], s47 offen
Mvaa 48,68,228
s_add_u32 s47, s47, 2097152
Mvaa 52,72,224
Mvaa 52,76,228
Ra 240,12,4096
Mvaa 56,80,224
Mvaa 56,84,228
Mvaa 60,88,224
Mvaa 60,92,228
Ra 244,13,4096
Mvaa 64,96,224
Mvaa 64,100,228
Mvaa 68,104,224
Mvaa 68,108,228
Ra 248,12,6144
Mvaa 72,112,224
Mvaa 72,116,228
Mvaa 76,120,224
Mvaa 76,124,228
Ra 252,13,6144
Mvaa 80,64,232
Mvaa 80,68,236
Mvaa 84,72,232
Mvaa 84,76,236
Mvaa 88,80,232
Mvaa 88,84,236
Mvaa 92,88,232
Mvaa 92,92,236
Mvaa 96,96,232
Mvaa 96,100,236
Mvaa 100,104,232
s_cmp_eq_u32 s6, 1
s_cselect_b32 s3, 0, 2146435072
Mvaa 100,108,236
s_mov_b64 exec, 1
buffer_atomic_add v30, v31, s[28:31], s3 offen sc1
s_mov_b64 exec, -1
Mvaa 104,112,232
Mvaa 104,116,236
Mvaa 108,120,232
s_waitcnt lgkmcnt(0)
Mvaa 108,124,236
Mvaa 112,64,240
Mvaa 112,68,244
Mvaa 116,72,240
Mvaa 116,76,244
Ra 224,12,8192
Mvaa 120,80,240
Mvaa 120,84,244
Mvaa 124,88,240
Mvaa 124,92,244
Ra 228,13,8192
Mvaa 128,96,240
Mvaa 128,100,244
Mvaa 132,104,240
Mvaa 132,108,244
Ra 232,12,10240
Mvaa 136,112,240
Mvaa 136,116,244
Mvaa 140,120,240
Mvaa 140,124,244
Ra 236,13,10240
Mvaa 144,64,248
Mvaa 144,68,252
Mvaa 148,72,248
Mvaa 148,76,252
Mvaa 152,80,248
Mvaa 152,84,252
Mvaa 156,88,248
Mvaa 156,92,252
Mvaa 160,96,248
Mvaa 160,100,252
Mvaa 164,104,248
Mvaa 164,108,252
Mvaa 168,112,248
Mvaa 168,116,252
s_waitcnt vmcnt(11)
Mvaa 172,120,248
s_waitcnt lgkmcnt(0)
s_barrier
Mvaa 172,124,252
s_add_u32 m0, s57, 65536
Mvaa 176,64,224
buffer_load_dwordx4 v6, s[12:15], s52 offen offset:0 lds
Mvaa 176,68,228
Ta 0,16,0
Ta 2,16,2048
Mvaa 180,72,224
Mvaa 180,76,228
Ra 240,12,12288
Mvaa 184,80,224
buffer_load_dwordx4 v7, s[12:15], s53 offen offset:1024 lds
Mvaa 184,84,228
Ta 4,16,16384
Ta 6,16,18432
Mvaa 188,88,224
Mvaa 188,92,228
Ra 244,13,12288
Mvaa 192,96,224
buffer_load_dwordx4 v6, s[12:15], s54 offen offset:2048 lds
Mvaa 192,100,228
Ta 8,17,0
Ta 10,17,2048
Mvaa 196,104,224
Mvaa 196,108,228
Ra 248,12,14336
Mvaa 200,112,224
buffer_load_dwordx4 v7, s[12:15], s55 offen offset:3072 lds
Mvaa 200,116,228
Ta 12,17,16384
Ta 14,17,18432
Mvaa 204,120,224
Mvaa 204,124,228
s_add_u32 m0, s57, 69632
Ra 252,13,14336
Mvaa 208,64,232
buffer_load_dwordx4 v8, s[12:15], s52 offen offset:0 lds
Mvaa 208,68,236
Mvaa 212,72,232
Mvaa 212,76,236
Ta 16,18,0
Ta 18,18,2048
Mvaa 216,80,232
buffer_load_dwordx4 v9, s[12:15], s53 offen offset:1024 lds
Mvaa 216,84,236
Ta 20,18,16384
s_waitcnt lgkmcnt(9)
Ta 22,18,18432
Mvaa 220,88,232
Mvaa 220,92,236
Ta 24,19,0
Ta 26,19,2048
Mvaa 224,96,232
buffer_load_dwordx4 v8, s[12:15], s54 offen offset:2048 lds
Mvaa 224,100,236
Mvaa 228,104,232
Mvaa 228,108,236
Ta 28,19,16384
Ta 30,19,18432
Mvaa 232,112,232
buffer_load_dwordx4 v9, s[12:15], s55 offen offset:3072 lds
Mvaa 232,116,236
s_waitcnt vmcnt(11)
Ta 32,20,0
s_waitcnt lgkmcnt(9)
Ta 34,20,2048
Mvaa 236,120,232
s_barrier
v_xor_b32 v6, 1572864, v6
v_xor_b32 v7, 1572864, v7
Mvaa 236,124,236
s_add_u32 m0, s56, 65536
Ta 36,20,16384
Ta 38,20,18432
Mvaa 240,64,240
buffer_load_dwordx4 v2, s[8:11], s48 offen offset:0 lds
Mvaa 240,68,244
v_xor_b32 v8, 1572864, v8
v_xor_b32 v9, 1572864, v9
Mvaa 244,72,240
Mvaa 244,76,244
Ra 224,10,0
Mvaa 248,80,240
buffer_load_dwordx4 v3, s[8:11], s49 offen offset:1024 lds
Mvaa 248,84,244
Ta 40,21,0
Ta 42,21,2048
Mvaa 252,88,240
Mvaa 252,92,244
s_waitcnt lgkmcnt(9)
Ra 228,11,0
Maaa 128,96,240
buffer_load_dwordx4 v2, s[8:11], s50 offen offset:2048 lds
Maaa 128,100,244
Ta 44,21,16384
Ta 46,21,18432
Maaa 132,104,240
s_cmp_eq_u32 s6, 2
s_cselect_b32 s3, 0, 2146435072
Maaa 132,108,244
Ra 232,10,2048
Maaa 136,112,240
buffer_load_dwordx4 v3, s[8:11], s51 offen offset:3072 lds
Maaa 136,116,244
Ta 48,22,0
Ta 50,22,2048
Maaa 140,120,240
s_mov_b64 exec, 1
buffer_atomic_add v30, v31, s[28:31], s3 offen sc1
s_mov_b64 exec, -1
Maaa 140,124,244
s_add_u32 m0, s56, 69632
s_waitcnt lgkmcnt(9)
Ra 236,11,2048
Maaa 144,64,248
buffer_load_dwordx4 v4, s[8:11], s48 offen offset:0 lds
Maaa 144,68,252
Maaa 148,72,248
Maaa 148,76,252
Ta 52,22,16384
Ta 54,22,18432
Maaa 152,80,248
buffer_load_dwordx4 v5, s[8:11], s49 offen offset:1024 lds
Maaa 152,84,252
Ta 56,23,0
Ta 58,23,2048
Maaa 156,88,248
Maaa 156,92,252
Ta 60,23,16384
s_waitcnt lgkmcnt(9)
Ta 62,23,18432
Maaa 160,96,248
buffer_load_dwordx4 v4, s[8:11], s50 offen offset:2048 lds
Maaa 160,100,252
Maaa 164,104,248
Maaa 164,108,252
Maaa 168,112,248
buffer_load_dwordx4 v5, s[8:11], s51 offen offset:3072 lds
Maaa 168,116,252
v_xor_b32 v2, 384, v2
v_xor_b32 v3, 384, v3
Maaa 172,120,248
s_waitcnt lgkmcnt(6)
buffer_load_dword v1, v47, s[60:63], 0 offen
v_xor_b32 v4, 384, v4
v_xor_b32 v5, 384, v5
Maaa 172,124,252
s_waitcnt lgkmcnt(0)
s_mul_i32 vcc_lo, s59, 1
v_xor_b32_e64 v47, vcc_lo, v47
Mvaa 48,0,224
buffer_load_dword v44, v45, s[16:19], s47 offen
Mvaa 48,4,228
s_add_u32 s47, s47, 2097152
Mvaa 52,8,224
Mvaa 52,12,228
Ra 240,10,4096
Mvaa 56,16,224
Mvaa 56,20,228
Mvaa 60,24,224
Mvaa 60,28,228
Ra 244,11,4096
Mvaa 64,32,224
Mvaa 64,36,228
Mvaa 68,40,224
Mvaa 68,44,228
Ra 248,10,6144
Mvaa 72,48,224
Mvaa 72,52,228
Mvaa 76,56,224
Mvaa 76,60,228
Ra 252,11,6144
Mvaa 80,0,232
Mvaa 80,4,236
Mvaa 84,8,232
Mvaa 84,12,236
Mvaa 88,16,232
Mvaa 88,20,236
Mvaa 92,24,232
Mvaa 92,28,236
Mvaa 96,32,232
Mvaa 96,36,236
Mvaa 100,40,232
Mvaa 100,44,236
Mvaa 104,48,232
Mvaa 104,52,236
Mvaa 108,56,232
s_waitcnt lgkmcnt(0)
Mvaa 108,60,236
Mvaa 112,0,240
Mvaa 112,4,244
Mvaa 116,8,240
Mvaa 116,12,244
Ra 224,10,8192
Mvaa 120,16,240
Mvaa 120,20,244
Mvaa 124,24,240
Mvaa 124,28,244
Ra 228,11,8192
Mvaa 128,32,240
Mvaa 128,36,244
Mvaa 132,40,240
Mvaa 132,44,244
Ra 232,10,10240
Mvaa 136,48,240
Mvaa 136,52,244
Mvaa 140,56,240
Mvaa 140,60,244
Ra 236,11,10240
Mvaa 144,0,248
Mvaa 144,4,252
Mvaa 148,8,248
Mvaa 148,12,252
Mvaa 152,16,248
s_cmp_eq_u32 s6, 3
s_cselect_b32 s3, 0, 2146435072
Mvaa 152,20,252
s_mov_b64 exec, 1
buffer_atomic_add v30, v31, s[28:31], s3 offen sc1
s_mov_b64 exec, -1
Mvaa 156,24,248
Mvaa 156,28,252
Mvaa 160,32,248
Mvaa 160,36,252
Mvaa 164,40,248
Mvaa 164,44,252
Mvaa 168,48,248
Mvaa 168,52,252
s_waitcnt vmcnt(12)
Mvaa 172,56,248
s_waitcnt lgkmcnt(0)
s_barrier
Mvaa 172,60,252
s_add_u32 m0, s57, 0
Mvaa 176,0,224
buffer_load_dwordx4 v6, s[12:15], s52 offen offset:0 lds
Mvaa 176,4,228
Ta 64,14,0
Ta 66,14,2048
Mvaa 180,8,224
Mvaa 180,12,228
Ra 240,10,12288
Mvaa 184,16,224
buffer_load_dwordx4 v7, s[12:15], s53 offen offset:1024 lds
Mvaa 184,20,228
Ta 68,14,16384
Ta 70,14,18432
Mvaa 188,24,224
Mvaa 188,28,228
Ra 244,11,12288
Mvaa 192,32,224
buffer_load_dwordx4 v6, s[12:15], s54 offen offset:2048 lds
Mvaa 192,36,228
Ta 72,15,0
Ta 74,15,2048
Mvaa 196,40,224
Mvaa 196,44,228
Ra 248,10,14336
Mvaa 200,48,224
buffer_load_dwordx4 v7, s[12:15], s55 offen offset:3072 lds
Mvaa 200,52,228
Ta 76,15,16384
Ta 78,15,18432
Mvaa 204,56,224
Mvaa 204,60,228
s_add_u32 m0, s57, 4096
Ra 252,11,14336
Mvaa 208,0,232
buffer_load_dwordx4 v8, s[12:15], s52 offen offset:0 lds
Mvaa 208,4,236
Mvaa 212,8,232
Mvaa 212,12,236
Ta 80,24,0
Ta 82,24,2048
Mvaa 216,16,232
buffer_load_dwordx4 v9, s[12:15], s53 offen offset:1024 lds
Mvaa 216,20,236
Ta 84,24,16384
s_waitcnt lgkmcnt(9)
Ta 86,24,18432
Mvaa 220,24,232
Mvaa 220,28,236
Ta 88,25,0
Ta 90,25,2048
Mvaa 224,32,232
buffer_load_dwordx4 v8, s[12:15], s54 offen offset:2048 lds
Mvaa 224,36,236
Mvaa 228,40,232
Mvaa 228,44,236
Ta 92,25,16384
Ta 94,25,18432
Mvaa 232,48,232
buffer_load_dwordx4 v9, s[12:15], s55 offen offset:3072 lds
Mvaa 232,52,236
s_waitcnt vmcnt(11)
Ta 96,26,0
s_waitcnt lgkmcnt(9)
Ta 98,26,2048
Mvaa 236,56,232
s_barrier
v_xor_b32 v6, 524288, v6
v_xor_b32 v7, 524288, v7
Mvaa 236,60,236
s_add_u32 m0, s56, 0
Ta 100,26,16384
Ta 102,26,18432
Mvaa 240,0,240
buffer_load_dwordx4 v2, s[8:11], s48 offen offset:0 lds
Mvaa 240,4,244
v_xor_b32 v8, 524288, v8
v_xor_b32 v9, 524288, v9
Mvaa 244,8,240
Mvaa 244,12,244
Ra 224,12,0
Mvaa 248,16,240
buffer_load_dwordx4 v3, s[8:11], s49 offen offset:1024 lds
Mvaa 248,20,244
Ta 104,27,0
Ta 106,27,2048
Mvaa 252,24,240
Mvaa 252,28,244
s_waitcnt lgkmcnt(9)
Ra 228,13,0
Maaa 128,32,240
buffer_load_dwordx4 v2, s[8:11], s50 offen offset:2048 lds
Maaa 128,36,244
Ta 108,27,16384
Ta 110,27,18432
Maaa 132,40,240
Maaa 132,44,244
Ra 232,12,2048
Maaa 136,48,240
buffer_load_dwordx4 v3, s[8:11], s51 offen offset:3072 lds
Maaa 136,52,244
Ta 112,28,0
Ta 114,28,2048
Maaa 140,56,240
Maaa 140,60,244
s_add_u32 m0, s56, 4096
s_waitcnt lgkmcnt(9)
Ra 236,13,2048
Maaa 144,0,248
buffer_load_dwordx4 v4, s[8:11], s48 offen offset:0 lds
Maaa 144,4,252
Maaa 148,8,248
Maaa 148,12,252
Ta 116,28,16384
Ta 118,28,18432
Maaa 152,16,248
buffer_load_dwordx4 v5, s[8:11], s49 offen offset:1024 lds
Maaa 152,20,252
Ta 120,29,0
Ta 122,29,2048
Maaa 156,24,248
Maaa 156,28,252
Ta 124,29,16384
s_waitcnt lgkmcnt(9)
Ta 126,29,18432
Maaa 160,32,248
buffer_load_dwordx4 v4, s[8:11], s50 offen offset:2048 lds
Maaa 160,36,252
Maaa 164,40,248
Maaa 164,44,252
Maaa 168,48,248
buffer_load_dwordx4 v5, s[8:11], s51 offen offset:3072 lds
Maaa 168,52,252
v_xor_b32 v2, 128, v2
v_xor_b32 v3, 128, v3
Maaa 172,56,248
s_waitcnt lgkmcnt(6)
buffer_load_dword v1, v47, s[60:63], 0 offen
v_xor_b32 v4, 128, v4
v_xor_b32 v5, 128, v5
Maaa 172,60,252
s_waitcnt lgkmcnt(0)
s_mul_i32 vcc_lo, s59, 7
v_xor_b32 v47, vcc_lo, v47
Mvaa 48,64,224
buffer_load_dword v44, v45, s[16:19], s47 offen
Mvaa 48,68,228
s_add_u32 s47, s47, 2097152
v_lshrrev_b32 v32, 4, v0
v_and_b32 v33, 15, v0
Mvaa 52,72,224
s_lshl_b32 s3, s32, 4
v_add_u32 v34, s3, v32
v_lshlrev_b32_e64 v36, 1, v32
Mvaa 52,76,228
Ra 240,12,4096
Mvaa 56,80,224
v_xor_b32 v36, v36, v33
v_xor_b32 v37, 8, v36
Mvaa 56,84,228
Mvaa 60,88,224
Mvaa 60,92,228
Ra 244,13,4096
Mvaa 64,96,224
s_getpc_b64 s[6:7]
L_cpf2:
s_add_u32 s6, s6, (L_phase2-L_cpf2)&0xffffffff
s_addc_u32 s7, s7, ((L_phase2-L_cpf2)>>32)&0xffffffff
Mvaa 64,100,228
s_lshr_b32 s3, s2, 3
s_lshl_b32 s3, s3, 2
s_add_u32 s3, s3, s32
Mvaa 68,104,224
s_lshl_b32 s3, s3, 10
v_and_b32 v42, 7, v0
v_lshlrev_b32_e64 v42, 7, v42
Mvaa 68,108,228
Ra 248,12,6144
Mvaa 72,112,224
v_add_u32_e64 v42, s3, v42
v_min_u32 v42, L_k2_fin-L_phase2-4, v42
Mvaa 72,116,228
v_mov_b32_e64 v41, s7
Mvaa 76,120,224
v_add_co_u32 v40, vcc, s6, v42
s_nop 1
v_addc_co_u32 v41, vcc, 0, v41, vcc
Mvaa 76,124,228
Ra 252,13,6144
Mvaa 80,64,232
global_load_dword v38, v[40:41], off
Mvaa 80,68,236
Mvaa 84,72,232
Mvaa 84,76,236
Mvaa 88,80,232
Mvaa 88,84,236
Mvaa 92,88,232
Mvaa 92,92,236
Mvaa 96,96,232
Mvaa 96,100,236
Mvaa 100,104,232
Mvaa 100,108,236
Mvaa 104,112,232
Mvaa 104,116,236
Mvaa 108,120,232
s_waitcnt lgkmcnt(0)
Mvaa 108,124,236
Mvaa 112,64,240
Mvaa 112,68,244
Mvaa 116,72,240
Mvaa 116,76,244
Ra 224,12,8192
Mvaa 120,80,240
Mvaa 120,84,244
Mvaa 124,88,240
Mvaa 124,92,244
Ra 228,13,8192
Mvaa 128,96,240
Mvaa 128,100,244
Mvaa 132,104,240
Mvaa 132,108,244
Ra 232,12,10240
Mvaa 136,112,240
Mvaa 136,116,244
Mvaa 140,120,240
Mvaa 140,124,244
Ra 236,13,10240
Mvaa 144,64,248
Mvaa 144,68,252
Mvaa 148,72,248
Mvaa 148,76,252
Mvaa 152,80,248
Mvaa 152,84,252
Mvaa 156,88,248
Mvaa 156,92,252
Mvaa 160,96,248
Mvaa 160,100,252
Mvaa 164,104,248
Mvaa 164,108,252
Mvaa 168,112,248
Mvaa 168,116,252
s_waitcnt vmcnt(11)
Mvaa 172,120,248
s_waitcnt lgkmcnt(0)
s_barrier
Mvaa 172,124,252
s_add_u32 m0, s57, 65536
Mvaa 176,64,224
buffer_load_dwordx4 v6, s[12:15], s52 offen offset:0 lds
Mvaa 176,68,228
Ta 0,16,0
Ta 2,16,2048
Mvaa 180,72,224
Mvaa 180,76,228
Ra 240,12,12288
Mvaa 184,80,224
buffer_load_dwordx4 v7, s[12:15], s53 offen offset:1024 lds
Mvaa 184,84,228
Ta 4,16,16384
Ta 6,16,18432
Mvaa 188,88,224
Mvaa 188,92,228
Ra 244,13,12288
Mvaa 192,96,224
buffer_load_dwordx4 v6, s[12:15], s54 offen offset:2048 lds
Mvaa 192,100,228
Ta 8,17,0
Ta 10,17,2048
Mvaa 196,104,224
Mvaa 196,108,228
Ra 248,12,14336
Mvaa 200,112,224
buffer_load_dwordx4 v7, s[12:15], s55 offen offset:3072 lds
Mvaa 200,116,228
Ta 12,17,16384
Ta 14,17,18432
Mvaa 204,120,224
Mvaa 204,124,228
s_add_u32 m0, s57, 69632
Ra 252,13,14336
Mvaa 208,64,232
buffer_load_dwordx4 v8, s[12:15], s52 offen offset:0 lds
Mvaa 208,68,236
Mvaa 212,72,232
Mvaa 212,76,236
Ta 16,18,0
Ta 18,18,2048
Mvaa 216,80,232
buffer_load_dwordx4 v9, s[12:15], s53 offen offset:1024 lds
Mvaa 216,84,236
Ta 20,18,16384
s_waitcnt lgkmcnt(9)
Ta 22,18,18432
Mvaa 220,88,232
Mvaa 220,92,236
Ta 24,19,0
Ta 26,19,2048
Mvaa 224,96,232
buffer_load_dwordx4 v8, s[12:15], s54 offen offset:2048 lds
Mvaa 224,100,236
Mvaa 228,104,232
Mvaa 228,108,236
Ta 28,19,16384
Ta 30,19,18432
Mvaa 232,112,232
buffer_load_dwordx4 v9, s[12:15], s55 offen offset:3072 lds
Mvaa 232,116,236
s_waitcnt vmcnt(11)
Ta 32,20,0
s_waitcnt lgkmcnt(9)
Ta 34,20,2048
Mvaa 236,120,232
s_barrier
Mvaa 236,124,236
s_add_u32 m0, s56, 65536
Ta 36,20,16384
Ta 38,20,18432
Mvaa 240,64,240
buffer_load_dwordx4 v2, s[8:11], s48 offen offset:0 lds
Mvaa 240,68,244
Mvaa 244,72,240
Mvaa 244,76,244
Ra 224,10,0
Mvaa 248,80,240
buffer_load_dwordx4 v3, s[8:11], s49 offen offset:1024 lds
Mvaa 248,84,244
Ta 40,21,0
Ta 42,21,2048
Mvaa 252,88,240
Mvaa 252,92,244
s_waitcnt lgkmcnt(9)
Ra 228,11,0
Maaa 128,96,240
buffer_load_dwordx4 v2, s[8:11], s50 offen offset:2048 lds
Maaa 128,100,244
Ta 44,21,16384
Ta 46,21,18432
Maaa 132,104,240
Maaa 132,108,244
Ra 232,10,2048
Maaa 136,112,240
buffer_load_dwordx4 v3, s[8:11], s51 offen offset:3072 lds
Maaa 136,116,244
Ta 48,22,0
Ta 50,22,2048
Maaa 140,120,240
Maaa 140,124,244
s_add_u32 m0, s56, 69632
s_waitcnt lgkmcnt(9)
Ra 236,11,2048
Maaa 144,64,248
buffer_load_dwordx4 v4, s[8:11], s48 offen offset:0 lds
Maaa 144,68,252
Maaa 148,72,248
Maaa 148,76,252
Ta 52,22,16384
Ta 54,22,18432
Maaa 152,80,248
buffer_load_dwordx4 v5, s[8:11], s49 offen offset:1024 lds
Maaa 152,84,252
Ta 56,23,0
Ta 58,23,2048
Maaa 156,88,248
Maaa 156,92,252
Ta 60,23,16384
s_waitcnt lgkmcnt(9)
Ta 62,23,18432
Maaa 160,96,248
buffer_load_dwordx4 v4, s[8:11], s50 offen offset:2048 lds
Maaa 160,100,252
Maaa 164,104,248
Maaa 164,108,252
Maaa 168,112,248
buffer_load_dwordx4 v5, s[8:11], s51 offen offset:3072 lds
Maaa 168,116,252
Maaa 172,120,248
s_waitcnt lgkmcnt(6)
Maaa 172,124,252
s_waitcnt lgkmcnt(0)
Mvaa 48,0,224
buffer_load_dword v1, v31, s[28:31], s37 offen sc1
Mvaa 48,4,228
s_mov_b32 s8, s16
s_mov_b32 s9, s17
s_mov_b32 s10, s18
Mvaa 52,8,224
s_add_u32 s16, s66, 46137344
s_addc_u32 s17, s67, 0
s_and_b32 s17, s17, 0xffff
Mvaa 52,12,228
Ra 240,10,4096
Mvaa 56,16,224
s_mov_b32 s18, 16777216
s_mov_b32 s19, 0x20000
s_mov_b32 s48, 0
Mvaa 56,20,228
s_mov_b32 s49, 31744
s_mov_b32 s50, 63488
s_mov_b32 s51, 95232
Mvaa 60,24,224
v_lshlrev_b32 v35, 13, v34
v_lshl_add_u32 v8, v36, 4, v35
Mvaa 60,28,228
Ra 244,11,4096
Mvaa 64,32,224
v_lshl_add_u32 v9, v37, 4, v35
v_lshlrev_b32_e64 v2, 4, v0
Mvaa 64,36,228
v_add_u32 v3, 65536, v2
v_add_u32_e64 v4, s44, v2
Mvaa 68,40,224
v_mov_b32 v7, 0
v_lshlrev_b32 v35, 2, v32
Mvaa 68,44,228
Ra 248,10,6144
Mvaa 72,48,224
v_sub_u32_e64 v35, v33, v35
Mvaa 72,52,228
s_lshl_b32 s3, s32, 4
v_add_u32 v5, s3, v35
Mvaa 76,56,224
s_sub_u32 s3, 48, s3
v_add_u32 v6, s3, v35
Mvaa 76,60,228
Ra 252,11,6144
Mvaa 80,0,232
s_mul_i32 s3, s33, 1116160
s_add_u32 s3, s3, 8388608
s_add_u32 s12, s66, s3
s_addc_u32 s13, s67, 0
s_and_b32 s13, s13, 0xffff
Mvaa 80,4,236
s_mov_b32 s14, 0
s_mov_b32 s15, 0x20000
s_mul_i32 s14, s36, 34816
Mvaa 84,8,232
buffer_load_dword v44, v45, s[8:11], s47 offen
Mvaa 84,12,236
s_add_u32 s47, s47, 2097152
v_lshrrev_b32 v42, 2, v33
v_lshl_add_u32 v43, v32, 3, v42
Mvaa 88,16,232
v_lshlrev_b32 v43, 8, v43
v_and_b32 v46, 3, v0
Mvaa 88,20,236
v_lshl_add_u32 v43, v46, 3, v43
v_and_b32_e64 v46, 1, v32
Mvaa 92,24,232
v_lshl_add_u32 v42, v46, 2, v42
v_lshl_add_u32 v16, v42, 5, v43
Mvaa 92,28,236
v_xor_b32 v17, 32, v16
v_xor_b32 v18, 64, v16
Mvaa 96,32,232
v_xor_b32 v19, 96, v16
v_xor_b32 v20, 128, v16
Mvaa 96,36,236
v_xor_b32 v21, 160, v16
v_xor_b32 v22, 192, v16
Mvaa 100,40,232
v_xor_b32 v23, 224, v16
Mvaa 100,44,236
Mvaa 104,48,232
Mvaa 104,52,236
Mvaa 108,56,232
s_waitcnt lgkmcnt(0)
Mvaa 108,60,236
Mvaa 112,0,240
Mvaa 112,4,244
Mvaa 116,8,240
Mvaa 116,12,244
Ra 224,10,8192
Mvaa 120,16,240
Mvaa 120,20,244
Mvaa 124,24,240
Mvaa 124,28,244
Ra 228,11,8192
Mvaa 128,32,240
Mvaa 128,36,244
Mvaa 132,40,240
Mvaa 132,44,244
Ra 232,10,10240
Mvaa 136,48,240
Mvaa 136,52,244
Mvaa 140,56,240
Mvaa 140,60,244
Ra 236,11,10240
Mvaa 144,0,248
Mvaa 144,4,252
Mvaa 148,8,248
Mvaa 148,12,252
Mvaa 152,16,248
Mvaa 152,20,252
Mvaa 156,24,248
Mvaa 156,28,252
Mvaa 160,32,248
Mvaa 160,36,252
Mvaa 164,40,248
Mvaa 164,44,252
Mvaa 168,48,248
Mvaa 168,52,252
s_waitcnt vmcnt(10)
Mvaa 172,56,248
s_waitcnt lgkmcnt(0)
s_barrier
Mvaa 172,60,252
s_add_u32 m0, s44, 0
Mvaa 176,0,224
buffer_load_dwordx4 v8, s[8:11], s48 offen offset:0 lds
Mvaa 176,4,228
Ta 64,14,0
Ta 66,14,2048
Mvaa 180,8,224
Mvaa 180,12,228
Ra 240,10,12288
Mvaa 184,16,224
buffer_load_dwordx4 v8, s[8:11], s49 offen offset:1024 lds
Mvaa 184,20,228
Ta 68,14,16384
Ta 70,14,18432
Mvaa 188,24,224
Mvaa 188,28,228
Ra 244,11,12288
Mvaa 192,32,224
buffer_load_dwordx4 v9, s[8:11], s50 offen offset:2048 lds
Mvaa 192,36,228
Ta 72,15,0
Ta 74,15,2048
Mvaa 196,40,224
Mvaa 196,44,228
Ra 248,10,14336
Mvaa 200,48,224
buffer_load_dwordx4 v9, s[8:11], s51 offen offset:3072 lds
Mvaa 200,52,228
Ta 76,15,16384
Ta 78,15,18432
Mvaa 204,56,224
v_add_u32 v8, 524288, v8
v_add_u32 v9, 524288, v9
Mvaa 204,60,228
s_add_u32 m0, s44, 16384
Ra 252,11,14336
Mvaa 208,0,232
buffer_load_dwordx4 v8, s[8:11], s48 offen offset:0 lds
Mvaa 208,4,236
Mvaa 212,8,232
Mvaa 212,12,236
Ta 80,24,0
Ta 82,24,2048
Mvaa 216,16,232
buffer_load_dwordx4 v8, s[8:11], s49 offen offset:1024 lds
Mvaa 216,20,236
Ta 84,24,16384
s_waitcnt lgkmcnt(9)
Ta 86,24,18432
Mvaa 220,24,232
Mvaa 220,28,236
Ta 88,25,0
Ta 90,25,2048
Mvaa 224,32,232
buffer_load_dwordx4 v9, s[8:11], s50 offen offset:2048 lds
Mvaa 224,36,236
Mvaa 228,40,232
s_mul_i32 s3, s45, 33792
v_add_u32_e64 v10, s3, v2
Mvaa 228,44,236
Ta 92,25,16384
Ta 94,25,18432
Mvaa 232,48,232
buffer_load_dwordx4 v9, s[8:11], s51 offen offset:3072 lds
Mvaa 232,52,236
s_waitcnt vmcnt(10)
Ta 96,26,0
s_waitcnt lgkmcnt(9)
Ta 98,26,2048
Mvaa 236,56,232
s_barrier
v_add_u32 v8, 524288, v8
v_add_u32 v9, 524288, v9
Mvaa 236,60,236
s_add_u32 m0, s44, 32768
Ta 100,26,16384
Ta 102,26,18432
Mvaa 240,0,240
buffer_load_dwordx4 v8, s[8:11], s48 offen offset:0 lds
Mvaa 240,4,244
s_mul_i32 s3, s46, 33792
v_add_u32 v11, s3, v2
Mvaa 244,8,240
Mvaa 244,12,244
Ra 224,12,0
Mvaa 248,16,240
buffer_load_dwordx4 v8, s[8:11], s49 offen offset:1024 lds
Mvaa 248,20,244
Ta 104,27,0
Ta 106,27,2048
Mvaa 252,24,240
Mvaa 252,28,244
s_waitcnt lgkmcnt(9)
Ra 228,13,0
Maaa 128,32,240
buffer_load_dwordx4 v9, s[8:11], s50 offen offset:2048 lds
Maaa 128,36,244
Ta 108,27,16384
Ta 110,27,18432
Maaa 132,40,240
Maaa 132,44,244
Ra 232,12,2048
Maaa 136,48,240
buffer_load_dwordx4 v9, s[8:11], s51 offen offset:3072 lds
Maaa 136,52,244
Ta 112,28,0
Ta 114,28,2048
Maaa 140,56,240
v_add_u32 v8, 524288, v8
v_add_u32 v9, 524288, v9
Maaa 140,60,244
s_add_u32 m0, s44, 49152
s_waitcnt lgkmcnt(9)
Ra 236,13,2048
Maaa 144,0,248
buffer_load_dwordx4 v8, s[8:11], s48 offen offset:0 lds
Maaa 144,4,252
Maaa 148,8,248
Maaa 148,12,252
Ta 116,28,16384
Ta 118,28,18432
Maaa 152,16,248
buffer_load_dwordx4 v8, s[8:11], s49 offen offset:1024 lds
Maaa 152,20,252
Ta 120,29,0
Ta 122,29,2048
Maaa 156,24,248
Maaa 156,28,252
Ta 124,29,16384
s_waitcnt lgkmcnt(9)
Ta 126,29,18432
Maaa 160,32,248
buffer_load_dwordx4 v9, s[8:11], s50 offen offset:2048 lds
Maaa 160,36,252
Maaa 164,40,248
Maaa 164,44,252
Maaa 168,48,248
buffer_load_dwordx4 v9, s[8:11], s51 offen offset:3072 lds
Maaa 168,52,252
v_add_u32 v8, 524288, v8
v_add_u32 v9, 524288, v9
Maaa 172,56,248
s_waitcnt lgkmcnt(6)
Maaa 172,60,252
s_waitcnt lgkmcnt(0)
Mvaa 48,64,224
v_mov_b32 v14, v40
v_mov_b32_e64 v15, v41
Mvaa 48,68,228
Mvaa 52,72,224
Mvaa 52,76,228
Ra 240,12,4096
Mvaa 56,80,224
Mvaa 56,84,228
Mvaa 60,88,224
Mvaa 60,92,228
Ra 244,13,4096
Mvaa 64,96,224
Vc 24,48,49
Vc 25,50,51
Mvaa 64,100,228
Vc 26,52,53
Vc 27,54,55
Mvaa 68,104,224
Mvaa 68,108,228
Ra 248,12,6144
Mvaa 72,112,224
Vc 28,56,57
Vc 29,58,59
Mvaa 72,116,228
Vc 30,60,61
Vc 31,62,63
Mvaa 76,120,224
Mvaa 76,124,228
Ra 252,13,6144
Mvaa 80,64,232
Vc 32,64,65
Vc 33,66,67
Mvaa 80,68,236
Vc 34,68,69
Vc 35,70,71
Mvaa 84,72,232
Mvaa 84,76,236
Mvaa 88,80,232
Vc 36,72,73
Vc 37,74,75
Mvaa 88,84,236
Vc 38,76,77
Vc 39,78,79
Mvaa 92,88,232
Mvaa 92,92,236
Mvaa 96,96,232
Vc 40,80,81
Vc 41,82,83
Mvaa 96,100,236
Vc 42,84,85
Vc 43,86,87
Mvaa 100,104,232
s_waitcnt vmcnt(12)
Mvaa 100,108,236
Mvaa 104,112,232
v_readfirstlane_b32 s3, v1
s_nop 0
s_or_b32 s3, s3, s37
s_cmp_lt_u32 s3, 256
s_cbranch_scc1 L_spinAk
L_spinArk:
s_barrier
Mvaa 104,116,236
Vc 44,88,89
Vc 45,90,91
Mvaa 108,120,232
s_waitcnt lgkmcnt(0)
Mvaa 108,124,236
Vc 46,92,93
Vc 47,94,95
Mvaa 112,64,240
buffer_load_dwordx4 a[0:3], v10, s[20:23], s58 offen offset:0 sc1
Mvaa 112,68,244
Vc 48,96,97
Vc 49,98,99
Mvaa 116,72,240
Vc 50,100,101
Vc 51,102,103
Mvaa 116,76,244
Ra 224,12,8192
Mvaa 120,80,240
Vc 52,104,105
Vc 53,106,107
Mvaa 120,84,244
Vc 54,108,109
Vc 55,110,111
Mvaa 124,88,240
buffer_load_dwordx4 a[4:7], v10, s[20:23], 0 offen offset:0 sc1
Mvaa 124,92,244
Ra 228,13,8192
Mvaa 128,96,240
Vc 56,112,113
Vc 57,114,115
Mvaa 128,100,244
Vc 58,116,117
Vc 59,118,119
Mvaa 132,104,240
Mvaa 132,108,244
Ra 232,12,10240
Mvaa 136,112,240
buffer_load_dwordx4 a[8:11], v11, s[20:23], s58 offen offset:0 sc1
Mvaa 136,116,244
Vc 60,120,121
Vc 61,122,123
Mvaa 140,120,240
Vc 62,124,125
Vc 63,126,127
Mvaa 140,124,244
Ra 236,13,10240
Mvaa 144,64,248
Vc 64,128,129
Vc 65,130,131
Mvaa 144,68,252
Vc 66,132,133
Vc 67,134,135
Mvaa 148,72,248
buffer_load_dwordx4 a[12:15], v11, s[20:23], 0 offen offset:0 sc1
Mvaa 148,76,252
Mvaa 152,80,248
Vc 68,136,137
Vc 69,138,139
Mvaa 152,84,252
Vc 70,140,141
Vc 71,142,143
Mvaa 156,88,248
Mvaa 156,92,252
Mvaa 160,96,248
buffer_load_dwordx4 a[16:19], v10, s[20:23], s58 offen offset:1024 sc1
Mvaa 160,100,252
Vc 72,144,145
Vc 73,146,147
Mvaa 164,104,248
Vc 74,148,149
Vc 75,150,151
Mvaa 164,108,252
Mvaa 168,112,248
Vc 76,152,153
Vc 77,154,155
Mvaa 168,116,252
Vc 78,156,157
Vc 79,158,159
Mvaa 172,120,248
s_waitcnt lgkmcnt(0)
buffer_load_dwordx4 a[20:23], v10, s[20:23], 0 offen offset:1024 sc1
Mvaa 172,124,252
Mvaa 176,64,224
Vc 80,160,161
Vc 81,162,163
Mvaa 176,68,228
Vc 82,164,165
Vc 83,166,167
Mvaa 180,72,224
Mvaa 180,76,228
Ra 240,12,12288
Mvaa 184,80,224
buffer_load_dwordx4 a[24:27], v11, s[20:23], s58 offen offset:1024 sc1
Mvaa 184,84,228
Vc 84,168,169
Vc 85,170,171
Mvaa 188,88,224
Vc 86,172,173
Vc 87,174,175
Mvaa 188,92,228
Ra 244,13,12288
Mvaa 192,96,224
Vc 88,176,177
Vc 89,178,179
Mvaa 192,100,228
Vc 90,180,181
Vc 91,182,183
Mvaa 196,104,224
buffer_load_dwordx4 a[28:31], v11, s[20:23], 0 offen offset:1024 sc1
Mvaa 196,108,228
Ra 248,12,14336
Mvaa 200,112,224
Vc 92,184,185
Vc 93,186,187
Mvaa 200,116,228
Vc 94,188,189
Vc 95,190,191
Mvaa 204,120,224
Mvaa 204,124,228
Ra 252,13,14336
Mvaa 208,64,232
buffer_load_dwordx4 a[32:35], v10, s[20:23], s58 offen offset:2048 sc1
Mvaa 208,68,236
Vc 96,192,193
Vc 97,194,195
Mvaa 212,72,232
Vc 98,196,197
Vc 99,198,199
Mvaa 212,76,236
Mvaa 216,80,232
Vc 100,200,201
Vc 101,202,203
Mvaa 216,84,236
Vc 102,204,205
Vc 103,206,207
Mvaa 220,88,232
buffer_load_dwordx4 a[36:39], v10, s[20:23], 0 offen offset:2048 sc1
Mvaa 220,92,236
Mvaa 224,96,232
Vc 104,208,209
Vc 105,210,211
Mvaa 224,100,236
Vc 106,212,213
Vc 107,214,215
Mvaa 228,104,232
Mvaa 228,108,236
Mvaa 232,112,232
buffer_load_dwordx4 a[40:43], v11, s[20:23], s58 offen offset:2048 sc1
Mvaa 232,116,236
Vc 108,216,217
Vc 109,218,219
Mvaa 236,120,232
s_waitcnt lgkmcnt(0)
Mvaa 236,124,236
Vc 110,220,221
Vc 111,222,223
Mvaa 240,64,240
Vc 112,224,225
Vc 113,226,227
Mvaa 240,68,244
Vc 114,228,229
Vc 115,230,231
Mvaa 244,72,240
buffer_load_dwordx4 a[44:47], v11, s[20:23], 0 offen offset:2048 sc1
Mvaa 244,76,244
Mvaa 248,80,240
Vc 116,232,233
Vc 117,234,235
Mvaa 248,84,244
Vc 118,236,237
Vc 119,238,239
Mvaa 252,88,240
Mvaa 252,92,244
Maaa 128,96,240
buffer_load_dwordx4 a[48:51], v10, s[20:23], s58 offen offset:3072 sc1
Maaa 128,100,244
Ta 192,16,0
Ta 194,16,1024
Maaa 132,104,240
Vc 120,240,241
Vc 121,242,243
Maaa 132,108,244
Ta 196,17,0
Ta 198,17,1024
Maaa 136,112,240
Vc 122,244,245
Vc 123,246,247
Maaa 136,116,244
Ta 200,18,0
Ta 202,18,1024
Maaa 140,120,240
buffer_load_dwordx4 a[52:55], v10, s[20:23], 0 offen offset:3072 sc1
Maaa 140,124,244
Ta 204,19,0
Ta 206,19,1024
Maaa 144,64,248
Vc 124,248,249
Vc 125,250,251
Maaa 144,68,252
Ta 208,20,0
Ta 210,20,1024
Maaa 148,72,248
Vc 126,252,253
Vc 127,254,255
Maaa 148,76,252
Ta 212,21,0
Ta 214,21,1024
Maaa 152,80,248
buffer_load_dwordx4 a[56:59], v11, s[20:23], s58 offen offset:3072 sc1
Maaa 152,84,252
Ta 216,22,0
Ta 218,22,1024
Maaa 156,88,248
Maaa 156,92,252
Ta 220,23,0
s_waitcnt lgkmcnt(9)
Ta 222,23,1024
Maaa 160,96,248
Maaa 160,100,252
Maaa 164,104,248
buffer_load_dwordx4 a[60:63], v11, s[20:23], 0 offen offset:3072 sc1
Maaa 164,108,252
v_add_u32 v10, 4096, v10
v_add_u32 v11, 4096, v11
Maaa 168,112,248
Maaa 168,116,252
Maaa 172,120,248
Maaa 172,124,252
s_branch L_phase2
L_k1_vpath:
Zvaa 48,224,0
v_and_b32 v46, 7, v0
v_mul_u32_u24 v30, 2064, v46
Mvaa 48,228,4
s_add_u32 m0, s57, 65536
Zvaa 52,232,0
buffer_load_dwordx4 v6, s[12:15], s52 offen offset:0 lds
Mvaa 52,236,4
Ra 240,10,4096
Zvaa 56,224,8
buffer_load_dwordx4 v7, s[12:15], s53 offen offset:1024 lds
Mvaa 56,228,12
v_lshrrev_b32_e64 v31, 3, v0
Zvaa 60,232,8
buffer_load_dwordx4 v6, s[12:15], s54 offen offset:2048 lds
Mvaa 60,236,12
Ra 244,11,4096
Zvaa 64,224,16
buffer_load_dwordx4 v7, s[12:15], s55 offen offset:3072 lds
Mvaa 64,228,20
s_add_u32 m0, s57, 69632
Zvaa 68,232,16
buffer_load_dwordx4 v8, s[12:15], s52 offen offset:0 lds
Mvaa 68,236,20
Ra 248,10,6144
Zvaa 72,224,24
buffer_load_dwordx4 v9, s[12:15], s53 offen offset:1024 lds
Mvaa 72,228,28
s_lshl_b32 s3, s32, 9
s_add_u32 s3, s3, 131072
v_lshl_add_u32 v30, v31, 4, v30
Zvaa 76,232,24
buffer_load_dwordx4 v8, s[12:15], s54 offen offset:2048 lds
Mvaa 76,236,28
s_waitcnt lgkmcnt(9)
Ra 252,11,6144
Zvaa 80,224,32
buffer_load_dwordx4 v9, s[12:15], s55 offen offset:3072 lds
Mvaa 80,228,36
s_add_u32 m0, s56, 65536
v_xor_b32 v6, 1572864, v6
v_xor_b32 v7, 1572864, v7
Zvaa 84,232,32
buffer_load_dwordx4 v2, s[8:11], s48 offen offset:0 lds
Mvaa 84,236,36
v_xor_b32 v8, 1572864, v8
v_xor_b32 v9, 1572864, v9
Zvaa 88,224,40
buffer_load_dwordx4 v3, s[8:11], s49 offen offset:1024 lds
Mvaa 88,228,44
v_add_u32 v30, s3, v30
v_lshlrev_b32 v31, 8, v31
Zvaa 92,232,40
buffer_load_dwordx4 v2, s[8:11], s50 offen offset:2048 lds
Mvaa 92,236,44
v_lshl_add_u32 v46, v46, 4, v31
s_waitcnt lgkmcnt(8)
Zvaa 96,224,48
buffer_load_dwordx4 v3, s[8:11], s51 offen offset:3072 lds
Mvaa 96,228,52
s_add_u32 m0, s56, 69632
Zvaa 100,232,48
buffer_load_dwordx4 v4, s[8:11], s48 offen offset:0 lds
Mvaa 100,236,52
Rv 34,30,128
Rv 38,30,256
s_waitcnt lgkmcnt(6)
Zvaa 104,224,56
buffer_load_dwordx4 v5, s[8:11], s49 offen offset:1024 lds
Mvaa 104,228,60
Rv 42,30,384
Rv 30,30,0
Zvaa 108,232,56
s_waitcnt lgkmcnt(4)
buffer_load_dwordx4 v4, s[8:11], s50 offen offset:2048 lds
Mvaa 108,236,60
s_lshr_b32 s3, s2, 1
s_mul_i32 s3, s3, 33792
s_add_u32 s3, s3, s57
Zvaa 112,240,0
buffer_load_dwordx4 v5, s[8:11], s51 offen offset:3072 lds
Mvaa 112,244,4
v_xor_b32 v2, 384, v2
v_xor_b32 v3, 384, v3
Zvaa 116,248,0
s_and_b32 s39, s2, 1
s_lshl_b32 s39, s39, 7
s_add_u32 s3, s3, s39
Mvaa 116,252,4
Ra 224,10,8192
v_xor_b32 v4, 384, v4
Zvaa 120,240,8
s_add_u32 s39, s3, 4096
Mvaa 120,244,12
v_xor_b32 v5, 384, v5
Zvaa 124,248,8
Mvaa 124,252,12
Ra 228,11,8192
Zvaa 128,240,16
Mvaa 128,244,20
Zvaa 132,248,16
Mvaa 132,252,20
Ra 232,10,10240
Zvaa 136,240,24
buffer_load_dword v1, v47, s[60:63], 0 offen
Mvaa 136,244,28
s_mul_i32 vcc_lo, s59, 1
v_xor_b32 v47, vcc_lo, v47
Zvaa 140,248,24
Mvaa 140,252,28
Ra 236,11,10240
Zvaa 144,240,32
Mvaa 144,244,36
Zvaa 148,248,32
Mvaa 148,252,36
Zvaa 152,240,40
Mvaa 152,244,44
Zvaa 156,248,40
Mvaa 156,252,44
Zvaa 160,240,48
Mvaa 160,244,52
Zvaa 164,248,48
Mvaa 164,252,52
Zvaa 168,240,56
Mvaa 168,244,60
s_waitcnt vmcnt(9)
Zvaa 172,248,56
s_waitcnt lgkmcnt(0)
s_barrier
Mvaa 172,252,60
s_add_u32 m0, s57, 0
Zvaa 176,224,0
buffer_load_dwordx4 v6, s[12:15], s52 offen offset:0 lds
Mvaa 176,228,4
Ta 64,14,0
Ta 66,14,2048
Zvaa 180,232,0
Mvaa 180,236,4
Ra 240,10,12288
Zvaa 184,224,8
buffer_load_dwordx4 v7, s[12:15], s53 offen offset:1024 lds
Mvaa 184,228,12
Ta 68,14,16384
Ta 70,14,18432
Zvaa 188,232,8
Mvaa 188,236,12
Ra 244,11,12288
Zvaa 192,224,16
buffer_load_dwordx4 v6, s[12:15], s54 offen offset:2048 lds
Mvaa 192,228,20
Ta 72,15,0
Ta 74,15,2048
Zvaa 196,232,16
Mvaa 196,236,20
Ra 248,10,14336
Zvaa 200,224,24
buffer_load_dwordx4 v7, s[12:15], s55 offen offset:3072 lds
Mvaa 200,228,28
Ta 76,15,16384
Ta 78,15,18432
Zvaa 204,232,24
Mvaa 204,236,28
s_add_u32 m0, s57, 4096
Ra 252,11,14336
Zvaa 208,224,32
buffer_load_dwordx4 v8, s[12:15], s52 offen offset:0 lds
Mvaa 208,228,36
Zvaa 212,232,32
Mvaa 212,236,36
Ta 80,24,0
Ta 82,24,2048
Zvaa 216,224,40
buffer_load_dwordx4 v9, s[12:15], s53 offen offset:1024 lds
Mvaa 216,228,44
Ta 84,24,16384
s_waitcnt lgkmcnt(9)
Ta 86,24,18432
Zvaa 220,232,40
Mvaa 220,236,44
Ta 88,25,0
Ta 90,25,2048
Zvaa 224,224,48
buffer_load_dwordx4 v8, s[12:15], s54 offen offset:2048 lds
Mvaa 224,228,52
Zvaa 228,232,48
Mvaa 228,236,52
Ta 92,25,16384
Ta 94,25,18432
Zvaa 232,224,56
buffer_load_dwordx4 v9, s[12:15], s55 offen offset:3072 lds
Mvaa 232,228,60
s_waitcnt vmcnt(9)
Ta 96,26,0
s_waitcnt lgkmcnt(9)
Ta 98,26,2048
Zvaa 236,232,56
s_barrier
v_xor_b32 v6, 524288, v6
v_xor_b32 v7, 524288, v7
Mvaa 236,236,60
s_add_u32 m0, s56, 0
Ta 100,26,16384
Ta 102,26,18432
Zvaa 240,240,0
buffer_load_dwordx4 v2, s[8:11], s48 offen offset:0 lds
Mvaa 240,244,4
v_xor_b32 v8, 524288, v8
v_xor_b32 v9, 524288, v9
Zvaa 244,248,0
Mvaa 244,252,4
Ra 224,12,0
Zvaa 248,240,8
buffer_load_dwordx4 v3, s[8:11], s49 offen offset:1024 lds
Mvaa 248,244,12
Ta 104,27,0
Ta 106,27,2048
Zvaa 252,248,8
Mvaa 252,252,12
s_waitcnt lgkmcnt(9)
Ra 228,13,0
Zaaa 128,240,16
buffer_load_dwordx4 v2, s[8:11], s50 offen offset:2048 lds
Maaa 128,244,20
Ta 108,27,16384
Ta 110,27,18432
Zaaa 132,248,16
Maaa 132,252,20
Ra 232,12,2048
Zaaa 136,240,24
buffer_load_dwordx4 v3, s[8:11], s51 offen offset:3072 lds
Maaa 136,244,28
Ta 112,28,0
Ta 114,28,2048
Zaaa 140,248,24
Maaa 140,252,28
s_add_u32 m0, s56, 4096
s_waitcnt lgkmcnt(9)
Ra 236,13,2048
Zaaa 144,240,32
buffer_load_dwordx4 v4, s[8:11], s48 offen offset:0 lds
Maaa 144,244,36
Zaaa 148,248,32
Maaa 148,252,36
Ta 116,28,16384
Ta 118,28,18432
Zaaa 152,240,40
buffer_load_dwordx4 v5, s[8:11], s49 offen offset:1024 lds
Maaa 152,244,44
Ta 120,29,0
Ta 122,29,2048
Zaaa 156,248,40
Maaa 156,252,44
Ta 124,29,16384
s_waitcnt lgkmcnt(9)
Ta 126,29,18432
Zaaa 160,240,48
buffer_load_dwordx4 v4, s[8:11], s50 offen offset:2048 lds
Maaa 160,244,52
Zaaa 164,248,48
Maaa 164,252,52
Zaaa 168,240,56
buffer_load_dwordx4 v5, s[8:11], s51 offen offset:3072 lds
Maaa 168,244,60
v_xor_b32 v2, 128, v2
v_xor_b32 v3, 128, v3
Zaaa 172,248,56
s_waitcnt lgkmcnt(6)
buffer_load_dword v1, v47, s[60:63], 0 offen
v_xor_b32 v4, 128, v4
v_xor_b32 v5, 128, v5
Maaa 172,252,60
s_waitcnt lgkmcnt(0)
s_mul_i32 vcc_lo, s59, 7
v_xor_b32 v47, vcc_lo, v47
Mvaa 48,224,64
buffer_store_dwordx4 v[30:33], v46, s[20:23], s3 offen offset:0 sc1
Mvaa 48,228,68
buffer_store_dwordx4 v[34:37], v46, s[20:23], s3 offen offset:2048 sc1
Mvaa 52,232,64
buffer_store_dwordx4 v[38:41], v46, s[20:23], s39 offen offset:0 sc1
Mvaa 52,236,68
Ra 240,12,4096
Mvaa 56,224,72
buffer_store_dwordx4 v[42:45], v46, s[20:23], s39 offen offset:2048 sc1
Mvaa 56,228,76
s_lshl_b32 s3, s34, 1
s_and_b32 s36, s32, 1
s_add_u32 s3, s3, s36
Mvaa 60,232,72
s_mul_i32 s3, s3, 1116160
s_mul_i32 s36, s33, 139264
s_add_u32 s3, s3, s36
Mvaa 60,236,76
Ra 244,13,4096
Mvaa 64,224,80
s_lshr_b32 s36, s32, 1
s_mul_i32 s36, s36, 69632
s_add_u32 s3, s3, s36
Mvaa 64,228,84
s_add_u32 s38, s3, 17408
s_lshl_b32 s39, s34, 7
s_lshl_b32 s36, s33, 2
Mvaa 68,232,80
s_add_u32 s39, s39, s36
s_add_u32 s39, s39, 5296160
v_mov_b32 v30, 1
Mvaa 68,236,84
Ra 248,12,6144
Mvaa 72,224,88
v_mov_b32_e64 v31, 0
Mvaa 72,228,92
s_cmp_eq_u32 s32, 0
s_cselect_b32 s39, s39, 2146435072
Mvaa 76,232,88
s_mov_b64 exec, 1
buffer_store_dword v31, v31, s[20:23], s39 offen sc1
s_mov_b64 exec, -1
Mvaa 76,236,92
Ra 252,13,6144
Mvaa 80,224,96
s_and_b32 s33, s2, 7
s_lshl_b32 s33, s33, 2
s_bfe_u32 s3, s2, 0x20003
Mvaa 80,228,100
s_add_u32 s33, s33, s3
s_lshr_b32 s34, s2, 5
s_lshl_b32 s64, s34, 7
Mvaa 84,232,96
s_lshl_b32 s3, s33, 2
s_add_u32 s64, s64, s3
s_add_u32 s64, s64, 5300224
Mvaa 84,236,100
s_lshl_b32 s65, s34, 8
s_sub_u32 s65, 1920, s65
v_mul_u32_u24 v32, s65, v0
Mvaa 88,224,104
s_cmp_eq_u32 s32, 0
s_cselect_b32 s64, s64, 2146435072
Mvaa 88,228,108
s_mov_b64 exec, 3
buffer_store_dword v31, v32, s[20:23], s64 offen sc1
s_mov_b64 exec, -1
Mvaa 92,232,104
s_lshl_b32 s3, s2, 2
s_add_u32 s3, s3, 5447680
v_lshlrev_b32_e64 v32, 10, v0
Mvaa 92,236,108
s_cmp_eq_u32 s32, 0
s_cselect_b32 s3, s3, 2146435072
Mvaa 96,224,112
s_mov_b64 exec, 0x1ff
buffer_store_dword v31, v32, s[20:23], s3 offen sc1
s_mov_b64 exec, -1
Mvaa 96,228,116
s_lshl_b32 s35, s34, 1
s_sub_u32 s36, 32, s35
s_add_u32 s35, s35, 2
Mvaa 100,232,112
s_lshl_b32 s44, s32, 12
s_lshl_b32 s58, s32, 1
s_sub_u32 s58, 7, s58
Mvaa 100,236,116
s_mul_i32 s58, s58, 33792
s_sub_u32 s3, 15, s34
s_lshl_b32 s45, s3, 3
Mvaa 104,224,120
s_add_u32 s45, s45, s32
s_lshl_b32 s46, s34, 3
s_add_u32 s46, s46, s32
Mvaa 104,228,124
s_mov_b32 s68, s42
s_and_b32 s69, s43, 0xffff
s_mov_b32 s70, 7340032
Mvaa 108,232,120
s_waitcnt lgkmcnt(0)
Mvaa 108,236,124
s_mov_b32 s71, 0x20000
s_cmp_eq_u32 s32, 0
s_cselect_b32 s37, 0, 2146435072
Mvaa 112,240,64
s_lshl_b32 s3, s33, 8
s_add_u32 s16, s4, s3
s_addc_u32 s17, s5, 0
s_and_b32 s17, s17, 0xffff
Mvaa 112,244,68
s_mov_b32 s18, 0
s_mov_b32 s19, 0x20000
s_sub_u32 s18, 8388608, s3
Mvaa 116,248,64
v_and_b32 v33, 15, v0
v_lshrrev_b32 v32, 1, v33
Mvaa 116,252,68
Ra 224,12,8192
Mvaa 120,240,72
v_and_b32 v33, 1, v0
v_lshlrev_b32 v32, 13, v32
Mvaa 120,244,76
v_lshl_add_u32 v45, v33, 7, v32
Mvaa 124,248,72
s_lshl_b32 s3, s32, 3
s_add_u32 s3, s3, s34
s_mul_i32 s47, s3, 65536
Mvaa 124,252,76
Ra 228,13,8192
Mvaa 128,240,80
s_bfe_u32 s6, s2, 131075
s_lshl_b32 s3, s32, 8
s_or_b32 s6, s6, s3
Mvaa 128,244,84
Mvaa 132,248,80
Mvaa 132,252,84
Ra 232,12,10240
Mvaa 136,240,88
Mvaa 136,244,92
Mvaa 140,248,88
Mvaa 140,252,92
Ra 236,13,10240
Mvaa 144,240,96
Mvaa 144,244,100
Mvaa 148,248,96
Mvaa 148,252,100
Mvaa 152,240,104
Mvaa 152,244,108
Mvaa 156,248,104
Mvaa 156,252,108
Mvaa 160,240,112
Mvaa 160,244,116
Mvaa 164,248,112
Mvaa 164,252,116
Mvaa 168,240,120
Mvaa 168,244,124
s_waitcnt vmcnt(16)
Mvaa 172,248,120
s_waitcnt lgkmcnt(0)
s_barrier
Mvaa 172,252,124
s_add_u32 m0, s57, 65536
Mvaa 176,224,64
buffer_load_dwordx4 v6, s[12:15], s52 offen offset:0 lds
Mvaa 176,228,68
Ta 0,16,0
Ta 2,16,2048
Mvaa 180,232,64
Mvaa 180,236,68
Ra 240,12,12288
Mvaa 184,224,72
buffer_load_dwordx4 v7, s[12:15], s53 offen offset:1024 lds
Mvaa 184,228,76
Ta 4,16,16384
Ta 6,16,18432
Mvaa 188,232,72
Mvaa 188,236,76
Ra 244,13,12288
Mvaa 192,224,80
buffer_load_dwordx4 v6, s[12:15], s54 offen offset:2048 lds
Mvaa 192,228,84
Ta 8,17,0
Ta 10,17,2048
Mvaa 196,232,80
Mvaa 196,236,84
Ra 248,12,14336
Mvaa 200,224,88
buffer_load_dwordx4 v7, s[12:15], s55 offen offset:3072 lds
Mvaa 200,228,92
Ta 12,17,16384
Ta 14,17,18432
Mvaa 204,232,88
Mvaa 204,236,92
s_add_u32 m0, s57, 69632
Ra 252,13,14336
Mvaa 208,224,96
buffer_load_dwordx4 v8, s[12:15], s52 offen offset:0 lds
Mvaa 208,228,100
Mvaa 212,232,96
Mvaa 212,236,100
Ta 16,18,0
Ta 18,18,2048
Mvaa 216,224,104
buffer_load_dwordx4 v9, s[12:15], s53 offen offset:1024 lds
Mvaa 216,228,108
Ta 20,18,16384
s_waitcnt lgkmcnt(9)
Ta 22,18,18432
Mvaa 220,232,104
Mvaa 220,236,108
Ta 24,19,0
Ta 26,19,2048
Mvaa 224,224,112
buffer_load_dwordx4 v8, s[12:15], s54 offen offset:2048 lds
Mvaa 224,228,116
Mvaa 228,232,112
Mvaa 228,236,116
Ta 28,19,16384
Ta 30,19,18432
Mvaa 232,224,120
buffer_load_dwordx4 v9, s[12:15], s55 offen offset:3072 lds
Mvaa 232,228,124
s_waitcnt vmcnt(16)
Ta 32,20,0
s_waitcnt lgkmcnt(9)
Ta 34,20,2048
Mvaa 236,232,120
s_barrier
v_xor_b32 v6, 3670016, v6
v_xor_b32 v7, 3670016, v7
Mvaa 236,236,124
s_add_u32 m0, s56, 65536
Ta 36,20,16384
Ta 38,20,18432
Mvaa 240,240,64
buffer_load_dwordx4 v2, s[8:11], s48 offen offset:0 lds
Mvaa 240,244,68
v_xor_b32 v8, 3670016, v8
v_xor_b32 v9, 3670016, v9
Mvaa 244,248,64
Mvaa 244,252,68
Ra 224,10,0
Mvaa 248,240,72
buffer_load_dwordx4 v3, s[8:11], s49 offen offset:1024 lds
Mvaa 248,244,76
Ta 40,21,0
Ta 42,21,2048
Mvaa 252,248,72
Mvaa 252,252,76
s_waitcnt lgkmcnt(9)
Ra 228,11,0
Maaa 128,240,80
buffer_load_dwordx4 v2, s[8:11], s50 offen offset:2048 lds
Maaa 128,244,84
Ta 44,21,16384
Ta 46,21,18432
Maaa 132,248,80
Maaa 132,252,84
Ra 232,10,2048
Maaa 136,240,88
buffer_load_dwordx4 v3, s[8:11], s51 offen offset:3072 lds
Maaa 136,244,92
Ta 48,22,0
Ta 50,22,2048
Maaa 140,248,88
Maaa 140,252,92
s_add_u32 m0, s56, 69632
s_waitcnt lgkmcnt(9)
Ra 236,11,2048
Maaa 144,240,96
buffer_load_dwordx4 v4, s[8:11], s48 offen offset:0 lds
Maaa 144,244,100
Maaa 148,248,96
Maaa 148,252,100
Ta 52,22,16384
Ta 54,22,18432
Maaa 152,240,104
buffer_load_dwordx4 v5, s[8:11], s49 offen offset:1024 lds
Maaa 152,244,108
Ta 56,23,0
Ta 58,23,2048
Maaa 156,248,104
Maaa 156,252,108
Ta 60,23,16384
s_waitcnt lgkmcnt(9)
Ta 62,23,18432
Maaa 160,240,112
buffer_load_dwordx4 v4, s[8:11], s50 offen offset:2048 lds
Maaa 160,244,116
Maaa 164,248,112
Maaa 164,252,116
Maaa 168,240,120
buffer_load_dwordx4 v5, s[8:11], s51 offen offset:3072 lds
Maaa 168,244,124
v_xor_b32 v2, 896, v2
v_xor_b32 v3, 896, v3
Maaa 172,248,120
s_waitcnt lgkmcnt(6)
buffer_load_dword v1, v47, s[60:63], 0 offen
v_xor_b32 v4, 896, v4
v_xor_b32 v5, 896, v5
Maaa 172,252,124
s_waitcnt lgkmcnt(0)
s_mul_i32 vcc_lo, s59, 1
v_xor_b32 v47, vcc_lo, v47
Mvaa 48,224,0
Mvaa 48,228,4
Mvaa 52,232,0
Mvaa 52,236,4
Ra 240,10,4096
Mvaa 56,224,8
Mvaa 56,228,12
Mvaa 60,232,8
Mvaa 60,236,12
Ra 244,11,4096
Mvaa 64,224,16
Mvaa 64,228,20
Mvaa 68,232,16
Mvaa 68,236,20
Ra 248,10,6144
Mvaa 72,224,24
Mvaa 72,228,28
Mvaa 76,232,24
Mvaa 76,236,28
Ra 252,11,6144
Mvaa 80,224,32
Mvaa 80,228,36
Mvaa 84,232,32
Mvaa 84,236,36
Mvaa 88,224,40
Mvaa 88,228,44
Mvaa 92,232,40
Mvaa 92,236,44
Mvaa 96,224,48
Mvaa 96,228,52
Mvaa 100,232,48
Mvaa 100,236,52
Mvaa 104,224,56
Mvaa 104,228,60
Mvaa 108,232,56
s_waitcnt lgkmcnt(0)
Mvaa 108,236,60
Mvaa 112,240,0
Mvaa 112,244,4
Mvaa 116,248,0
Mvaa 116,252,4
Ra 224,10,8192
Mvaa 120,240,8
Mvaa 120,244,12
Mvaa 124,248,8
Mvaa 124,252,12
Ra 228,11,8192
Mvaa 128,240,16
Mvaa 128,244,20
Mvaa 132,248,16
Mvaa 132,252,20
Ra 232,10,10240
Mvaa 136,240,24
Mvaa 136,244,28
Mvaa 140,248,24
Mvaa 140,252,28
Ra 236,11,10240
Mvaa 144,240,32
Mvaa 144,244,36
Mvaa 148,248,32
Mvaa 148,252,36
Mvaa 152,240,40
Mvaa 152,244,44
Mvaa 156,248,40
Mvaa 156,252,44
Mvaa 160,240,48
Mvaa 160,244,52
Mvaa 164,248,48
Mvaa 164,252,52
Mvaa 168,240,56
Mvaa 168,244,60
s_waitcnt vmcnt(9)
Mvaa 172,248,56
s_waitcnt lgkmcnt(0)
s_barrier
Mvaa 172,252,60
s_add_u32 m0, s57, 0
Mvaa 176,224,0
buffer_load_dwordx4 v6, s[12:15], s52 offen offset:0 lds
Mvaa 176,228,4
Ta 64,14,0
Ta 66,14,2048
Mvaa 180,232,0
Mvaa 180,236,4
Ra 240,10,12288
Mvaa 184,224,8
buffer_load_dwordx4 v7, s[12:15], s53 offen offset:1024 lds
Mvaa 184,228,12
Ta 68,14,16384
Ta 70,14,18432
Mvaa 188,232,8
Mvaa 188,236,12
Ra 244,11,12288
Mvaa 192,224,16
buffer_load_dwordx4 v6, s[12:15], s54 offen offset:2048 lds
Mvaa 192,228,20
Ta 72,15,0
Ta 74,15,2048
Mvaa 196,232,16
Mvaa 196,236,20
Ra 248,10,14336
Mvaa 200,224,24
buffer_load_dwordx4 v7, s[12:15], s55 offen offset:3072 lds
Mvaa 200,228,28
Ta 76,15,16384
Ta 78,15,18432
Mvaa 204,232,24
s_cmp_eq_u32 s6, 0
s_cselect_b32 s3, 0, 2146435072
Mvaa 204,236,28
s_add_u32 m0, s57, 4096
Ra 252,11,14336
Mvaa 208,224,32
buffer_load_dwordx4 v8, s[12:15], s52 offen offset:0 lds
Mvaa 208,228,36
s_mov_b64 exec, 1
buffer_atomic_add v30, v31, s[28:31], s3 offen sc1
s_mov_b64 exec, -1
Mvaa 212,232,32
Mvaa 212,236,36
Ta 80,24,0
Ta 82,24,2048
Mvaa 216,224,40
buffer_load_dwordx4 v9, s[12:15], s53 offen offset:1024 lds
Mvaa 216,228,44
Ta 84,24,16384
s_waitcnt lgkmcnt(9)
Ta 86,24,18432
Mvaa 220,232,40
Mvaa 220,236,44
Ta 88,25,0
Ta 90,25,2048
Mvaa 224,224,48
buffer_load_dwordx4 v8, s[12:15], s54 offen offset:2048 lds
Mvaa 224,228,52
Mvaa 228,232,48
Mvaa 228,236,52
Ta 92,25,16384
Ta 94,25,18432
Mvaa 232,224,56
buffer_load_dwordx4 v9, s[12:15], s55 offen offset:3072 lds
Mvaa 232,228,60
s_waitcnt vmcnt(10)
Ta 96,26,0
s_waitcnt lgkmcnt(9)
Ta 98,26,2048
Mvaa 236,232,56
s_barrier
v_xor_b32 v6, 524288, v6
v_xor_b32 v7, 524288, v7
Mvaa 236,236,60
s_add_u32 m0, s56, 0
Ta 100,26,16384
Ta 102,26,18432
Mvaa 240,240,0
buffer_load_dwordx4 v2, s[8:11], s48 offen offset:0 lds
Mvaa 240,244,4
v_xor_b32 v8, 524288, v8
v_xor_b32 v9, 524288, v9
Mvaa 244,248,0
Mvaa 244,252,4
Ra 224,12,0
Mvaa 248,240,8
buffer_load_dwordx4 v3, s[8:11], s49 offen offset:1024 lds
Mvaa 248,244,12
Ta 104,27,0
Ta 106,27,2048
Mvaa 252,248,8
Mvaa 252,252,12
s_waitcnt lgkmcnt(9)
Ra 228,13,0
Maaa 128,240,16
buffer_load_dwordx4 v2, s[8:11], s50 offen offset:2048 lds
Maaa 128,244,20
Ta 108,27,16384
Ta 110,27,18432
Maaa 132,248,16
Maaa 132,252,20
Ra 232,12,2048
Maaa 136,240,24
buffer_load_dwordx4 v3, s[8:11], s51 offen offset:3072 lds
Maaa 136,244,28
Ta 112,28,0
Ta 114,28,2048
Maaa 140,248,24
Maaa 140,252,28
s_add_u32 m0, s56, 4096
s_waitcnt lgkmcnt(9)
Ra 236,13,2048
Maaa 144,240,32
buffer_load_dwordx4 v4, s[8:11], s48 offen offset:0 lds
Maaa 144,244,36
Maaa 148,248,32
Maaa 148,252,36
Ta 116,28,16384
Ta 118,28,18432
Maaa 152,240,40
buffer_load_dwordx4 v5, s[8:11], s49 offen offset:1024 lds
Maaa 152,244,44
Ta 120,29,0
Ta 122,29,2048
Maaa 156,248,40
Maaa 156,252,44
Ta 124,29,16384
s_waitcnt lgkmcnt(9)
Ta 126,29,18432
Maaa 160,240,48
buffer_load_dwordx4 v4, s[8:11], s50 offen offset:2048 lds
Maaa 160,244,52
Maaa 164,248,48
Maaa 164,252,52
Maaa 168,240,56
buffer_load_dwordx4 v5, s[8:11], s51 offen offset:3072 lds
Maaa 168,244,60
v_xor_b32 v2, 128, v2
v_xor_b32 v3, 128, v3
Maaa 172,248,56
s_waitcnt lgkmcnt(6)
buffer_load_dword v1, v47, s[60:63], 0 offen
v_xor_b32 v4, 128, v4
v_xor_b32 v5, 128, v5
Maaa 172,252,60
s_waitcnt lgkmcnt(0)
s_mul_i32 vcc_lo, s59, 3
v_xor_b32 v47, vcc_lo, v47
Mvaa 48,224,64
buffer_load_dword v44, v45, s[16:19], s47 offen
Mvaa 48,228,68
s_add_u32 s47, s47, 2097152
Mvaa 52,232,64
Mvaa 52,236,68
Ra 240,12,4096
Mvaa 56,224,72
Mvaa 56,228,76
Mvaa 60,232,72
Mvaa 60,236,76
Ra 244,13,4096
Mvaa 64,224,80
Mvaa 64,228,84
Mvaa 68,232,80
Mvaa 68,236,84
Ra 248,12,6144
Mvaa 72,224,88
Mvaa 72,228,92
Mvaa 76,232,88
Mvaa 76,236,92
Ra 252,13,6144
Mvaa 80,224,96
Mvaa 80,228,100
Mvaa 84,232,96
Mvaa 84,236,100
Mvaa 88,224,104
Mvaa 88,228,108
Mvaa 92,232,104
Mvaa 92,236,108
Mvaa 96,224,112
Mvaa 96,228,116
Mvaa 100,232,112
s_cmp_eq_u32 s6, 1
s_cselect_b32 s3, 0, 2146435072
Mvaa 100,236,116
s_mov_b64 exec, 1
buffer_atomic_add v30, v31, s[28:31], s3 offen sc1
s_mov_b64 exec, -1
Mvaa 104,224,120
Mvaa 104,228,124
Mvaa 108,232,120
s_waitcnt lgkmcnt(0)
Mvaa 108,236,124
Mvaa 112,240,64
Mvaa 112,244,68
Mvaa 116,248,64
Mvaa 116,252,68
Ra 224,12,8192
Mvaa 120,240,72
Mvaa 120,244,76
Mvaa 124,248,72
Mvaa 124,252,76
Ra 228,13,8192
Mvaa 128,240,80
Mvaa 128,244,84
Mvaa 132,248,80
Mvaa 132,252,84
Ra 232,12,10240
Mvaa 136,240,88
Mvaa 136,244,92
Mvaa 140,248,88
Mvaa 140,252,92
Ra 236,13,10240
Mvaa 144,240,96
Mvaa 144,244,100
Mvaa 148,248,96
Mvaa 148,252,100
Mvaa 152,240,104
Mvaa 152,244,108
Mvaa 156,248,104
Mvaa 156,252,108
Mvaa 160,240,112
Mvaa 160,244,116
Mvaa 164,248,112
Mvaa 164,252,116
Mvaa 168,240,120
Mvaa 168,244,124
s_waitcnt vmcnt(11)
Mvaa 172,248,120
s_waitcnt lgkmcnt(0)
s_barrier
Mvaa 172,252,124
s_add_u32 m0, s57, 65536
Mvaa 176,224,64
buffer_load_dwordx4 v6, s[12:15], s52 offen offset:0 lds
Mvaa 176,228,68
Ta 0,16,0
Ta 2,16,2048
Mvaa 180,232,64
Mvaa 180,236,68
Ra 240,12,12288
Mvaa 184,224,72
buffer_load_dwordx4 v7, s[12:15], s53 offen offset:1024 lds
Mvaa 184,228,76
Ta 4,16,16384
Ta 6,16,18432
Mvaa 188,232,72
Mvaa 188,236,76
Ra 244,13,12288
Mvaa 192,224,80
buffer_load_dwordx4 v6, s[12:15], s54 offen offset:2048 lds
Mvaa 192,228,84
Ta 8,17,0
Ta 10,17,2048
Mvaa 196,232,80
Mvaa 196,236,84
Ra 248,12,14336
Mvaa 200,224,88
buffer_load_dwordx4 v7, s[12:15], s55 offen offset:3072 lds
Mvaa 200,228,92
Ta 12,17,16384
Ta 14,17,18432
Mvaa 204,232,88
Mvaa 204,236,92
s_add_u32 m0, s57, 69632
Ra 252,13,14336
Mvaa 208,224,96
buffer_load_dwordx4 v8, s[12:15], s52 offen offset:0 lds
Mvaa 208,228,100
Mvaa 212,232,96
Mvaa 212,236,100
Ta 16,18,0
Ta 18,18,2048
Mvaa 216,224,104
buffer_load_dwordx4 v9, s[12:15], s53 offen offset:1024 lds
Mvaa 216,228,108
Ta 20,18,16384
s_waitcnt lgkmcnt(9)
Ta 22,18,18432
Mvaa 220,232,104
Mvaa 220,236,108
Ta 24,19,0
Ta 26,19,2048
Mvaa 224,224,112
buffer_load_dwordx4 v8, s[12:15], s54 offen offset:2048 lds
Mvaa 224,228,116
Mvaa 228,232,112
Mvaa 228,236,116
Ta 28,19,16384
Ta 30,19,18432
Mvaa 232,224,120
buffer_load_dwordx4 v9, s[12:15], s55 offen offset:3072 lds
Mvaa 232,228,124
s_waitcnt vmcnt(11)
Ta 32,20,0
s_waitcnt lgkmcnt(9)
Ta 34,20,2048
Mvaa 236,232,120
s_barrier
v_xor_b32 v6, 1572864, v6
v_xor_b32 v7, 1572864, v7
Mvaa 236,236,124
s_add_u32 m0, s56, 65536
Ta 36,20,16384
Ta 38,20,18432
Mvaa 240,240,64
buffer_load_dwordx4 v2, s[8:11], s48 offen offset:0 lds
Mvaa 240,244,68
v_xor_b32 v8, 1572864, v8
v_xor_b32 v9, 1572864, v9
Mvaa 244,248,64
Mvaa 244,252,68
Ra 224,10,0
Mvaa 248,240,72
buffer_load_dwordx4 v3, s[8:11], s49 offen offset:1024 lds
Mvaa 248,244,76
Ta 40,21,0
Ta 42,21,2048
Mvaa 252,248,72
Mvaa 252,252,76
s_waitcnt lgkmcnt(9)
Ra 228,11,0
Maaa 128,240,80
buffer_load_dwordx4 v2, s[8:11], s50 offen offset:2048 lds
Maaa 128,244,84
Ta 44,21,16384
Ta 46,21,18432
Maaa 132,248,80
s_cmp_eq_u32 s6, 2
s_cselect_b32 s3, 0, 2146435072
Maaa 132,252,84
Ra 232,10,2048
Maaa 136,240,88
buffer_load_dwordx4 v3, s[8:11], s51 offen offset:3072 lds
Maaa 136,244,92
Ta 48,22,0
Ta 50,22,2048
Maaa 140,248,88
s_mov_b64 exec, 1
buffer_atomic_add v30, v31, s[28:31], s3 offen sc1
s_mov_b64 exec, -1
Maaa 140,252,92
s_add_u32 m0, s56, 69632
s_waitcnt lgkmcnt(9)
Ra 236,11,2048
Maaa 144,240,96
buffer_load_dwordx4 v4, s[8:11], s48 offen offset:0 lds
Maaa 144,244,100
Maaa 148,248,96
Maaa 148,252,100
Ta 52,22,16384
Ta 54,22,18432
Maaa 152,240,104
buffer_load_dwordx4 v5, s[8:11], s49 offen offset:1024 lds
Maaa 152,244,108
Ta 56,23,0
Ta 58,23,2048
Maaa 156,248,104
Maaa 156,252,108
Ta 60,23,16384
s_waitcnt lgkmcnt(9)
Ta 62,23,18432
Maaa 160,240,112
buffer_load_dwordx4 v4, s[8:11], s50 offen offset:2048 lds
Maaa 160,244,116
Maaa 164,248,112
Maaa 164,252,116
Maaa 168,240,120
buffer_load_dwordx4 v5, s[8:11], s51 offen offset:3072 lds
Maaa 168,244,124
v_xor_b32 v2, 384, v2
v_xor_b32 v3, 384, v3
Maaa 172,248,120
s_waitcnt lgkmcnt(6)
buffer_load_dword v1, v47, s[60:63], 0 offen
v_xor_b32 v4, 384, v4
v_xor_b32 v5, 384, v5
Maaa 172,252,124
s_waitcnt lgkmcnt(0)
s_mul_i32 vcc_lo, s59, 1
v_xor_b32_e64 v47, vcc_lo, v47
Mvaa 48,224,0
buffer_load_dword v44, v45, s[16:19], s47 offen
Mvaa 48,228,4
s_add_u32 s47, s47, 2097152
Mvaa 52,232,0
Mvaa 52,236,4
Ra 240,10,4096
Mvaa 56,224,8
Mvaa 56,228,12
Mvaa 60,232,8
Mvaa 60,236,12
Ra 244,11,4096
Mvaa 64,224,16
Mvaa 64,228,20
Mvaa 68,232,16
Mvaa 68,236,20
Ra 248,10,6144
Mvaa 72,224,24
Mvaa 72,228,28
Mvaa 76,232,24
Mvaa 76,236,28
Ra 252,11,6144
Mvaa 80,224,32
Mvaa 80,228,36
Mvaa 84,232,32
Mvaa 84,236,36
Mvaa 88,224,40
Mvaa 88,228,44
Mvaa 92,232,40
Mvaa 92,236,44
Mvaa 96,224,48
Mvaa 96,228,52
Mvaa 100,232,48
Mvaa 100,236,52
Mvaa 104,224,56
Mvaa 104,228,60
Mvaa 108,232,56
s_waitcnt lgkmcnt(0)
Mvaa 108,236,60
Mvaa 112,240,0
Mvaa 112,244,4
Mvaa 116,248,0
Mvaa 116,252,4
Ra 224,10,8192
Mvaa 120,240,8
Mvaa 120,244,12
Mvaa 124,248,8
Mvaa 124,252,12
Ra 228,11,8192
Mvaa 128,240,16
Mvaa 128,244,20
Mvaa 132,248,16
Mvaa 132,252,20
Ra 232,10,10240
Mvaa 136,240,24
Mvaa 136,244,28
Mvaa 140,248,24
Mvaa 140,252,28
Ra 236,11,10240
Mvaa 144,240,32
Mvaa 144,244,36
Mvaa 148,248,32
Mvaa 148,252,36
Mvaa 152,240,40
s_cmp_eq_u32 s6, 3
s_cselect_b32 s3, 0, 2146435072
Mvaa 152,244,44
s_mov_b64 exec, 1
buffer_atomic_add v30, v31, s[28:31], s3 offen sc1
s_mov_b64 exec, -1
Mvaa 156,248,40
Mvaa 156,252,44
Mvaa 160,240,48
Mvaa 160,244,52
Mvaa 164,248,48
Mvaa 164,252,52
Mvaa 168,240,56
Mvaa 168,244,60
s_waitcnt vmcnt(12)
Mvaa 172,248,56
s_waitcnt lgkmcnt(0)
s_barrier
Mvaa 172,252,60
s_add_u32 m0, s57, 0
Mvaa 176,224,0
buffer_load_dwordx4 v6, s[12:15], s52 offen offset:0 lds
Mvaa 176,228,4
Ta 64,14,0
Ta 66,14,2048
Mvaa 180,232,0
Mvaa 180,236,4
Ra 240,10,12288
Mvaa 184,224,8
buffer_load_dwordx4 v7, s[12:15], s53 offen offset:1024 lds
Mvaa 184,228,12
Ta 68,14,16384
Ta 70,14,18432
Mvaa 188,232,8
Mvaa 188,236,12
Ra 244,11,12288
Mvaa 192,224,16
buffer_load_dwordx4 v6, s[12:15], s54 offen offset:2048 lds
Mvaa 192,228,20
Ta 72,15,0
Ta 74,15,2048
Mvaa 196,232,16
Mvaa 196,236,20
Ra 248,10,14336
Mvaa 200,224,24
buffer_load_dwordx4 v7, s[12:15], s55 offen offset:3072 lds
Mvaa 200,228,28
Ta 76,15,16384
Ta 78,15,18432
Mvaa 204,232,24
Mvaa 204,236,28
s_add_u32 m0, s57, 4096
Ra 252,11,14336
Mvaa 208,224,32
buffer_load_dwordx4 v8, s[12:15], s52 offen offset:0 lds
Mvaa 208,228,36
Mvaa 212,232,32
Mvaa 212,236,36
Ta 80,24,0
Ta 82,24,2048
Mvaa 216,224,40
buffer_load_dwordx4 v9, s[12:15], s53 offen offset:1024 lds
Mvaa 216,228,44
Ta 84,24,16384
s_waitcnt lgkmcnt(9)
Ta 86,24,18432
Mvaa 220,232,40
Mvaa 220,236,44
Ta 88,25,0
Ta 90,25,2048
Mvaa 224,224,48
buffer_load_dwordx4 v8, s[12:15], s54 offen offset:2048 lds
Mvaa 224,228,52
Mvaa 228,232,48
Mvaa 228,236,52
Ta 92,25,16384
Ta 94,25,18432
Mvaa 232,224,56
buffer_load_dwordx4 v9, s[12:15], s55 offen offset:3072 lds
Mvaa 232,228,60
s_waitcnt vmcnt(11)
Ta 96,26,0
s_waitcnt lgkmcnt(9)
Ta 98,26,2048
Mvaa 236,232,56
s_barrier
v_xor_b32 v6, 524288, v6
v_xor_b32 v7, 524288, v7
Mvaa 236,236,60
s_add_u32 m0, s56, 0
Ta 100,26,16384
Ta 102,26,18432
Mvaa 240,240,0
buffer_load_dwordx4 v2, s[8:11], s48 offen offset:0 lds
Mvaa 240,244,4
v_xor_b32 v8, 524288, v8
v_xor_b32 v9, 524288, v9
Mvaa 244,248,0
Mvaa 244,252,4
Ra 224,12,0
Mvaa 248,240,8
buffer_load_dwordx4 v3, s[8:11], s49 offen offset:1024 lds
Mvaa 248,244,12
Ta 104,27,0
Ta 106,27,2048
Mvaa 252,248,8
Mvaa 252,252,12
s_waitcnt lgkmcnt(9)
Ra 228,13,0
Maaa 128,240,16
buffer_load_dwordx4 v2, s[8:11], s50 offen offset:2048 lds
Maaa 128,244,20
Ta 108,27,16384
Ta 110,27,18432
Maaa 132,248,16
Maaa 132,252,20
Ra 232,12,2048
Maaa 136,240,24
buffer_load_dwordx4 v3, s[8:11], s51 offen offset:3072 lds
Maaa 136,244,28
Ta 112,28,0
Ta 114,28,2048
Maaa 140,248,24
Maaa 140,252,28
s_add_u32 m0, s56, 4096
s_waitcnt lgkmcnt(9)
Ra 236,13,2048
Maaa 144,240,32
buffer_load_dwordx4 v4, s[8:11], s48 offen offset:0 lds
Maaa 144,244,36
Maaa 148,248,32
Maaa 148,252,36
Ta 116,28,16384
Ta 118,28,18432
Maaa 152,240,40
buffer_load_dwordx4 v5, s[8:11], s49 offen offset:1024 lds
Maaa 152,244,44
Ta 120,29,0
Ta 122,29,2048
Maaa 156,248,40
Maaa 156,252,44
Ta 124,29,16384
s_waitcnt lgkmcnt(9)
Ta 126,29,18432
Maaa 160,240,48
buffer_load_dwordx4 v4, s[8:11], s50 offen offset:2048 lds
Maaa 160,244,52
Maaa 164,248,48
Maaa 164,252,52
Maaa 168,240,56
buffer_load_dwordx4 v5, s[8:11], s51 offen offset:3072 lds
Maaa 168,244,60
v_xor_b32 v2, 128, v2
v_xor_b32 v3, 128, v3
Maaa 172,248,56
s_waitcnt lgkmcnt(6)
buffer_load_dword v1, v47, s[60:63], 0 offen
v_xor_b32 v4, 128, v4
v_xor_b32 v5, 128, v5
Maaa 172,252,60
s_waitcnt lgkmcnt(0)
s_mul_i32 vcc_lo, s59, 7
v_xor_b32 v47, vcc_lo, v47
Mvaa 48,224,64
buffer_load_dword v44, v45, s[16:19], s47 offen
Mvaa 48,228,68
s_add_u32 s47, s47, 2097152
v_lshrrev_b32 v32, 4, v0
v_and_b32 v33, 15, v0
Mvaa 52,232,64
s_lshl_b32 s3, s32, 4
v_add_u32 v34, s3, v32
v_lshlrev_b32_e64 v36, 1, v32
Mvaa 52,236,68
Ra 240,12,4096
Mvaa 56,224,72
v_xor_b32 v36, v36, v33
v_xor_b32 v37, 8, v36
Mvaa 56,228,76
Mvaa 60,232,72
Mvaa 60,236,76
Ra 244,13,4096
Mvaa 64,224,80
s_getpc_b64 s[6:7]
L_cpf3:
s_add_u32 s6, s6, (L_phase2-L_cpf3)&0xffffffff
s_addc_u32 s7, s7, ((L_phase2-L_cpf3)>>32)&0xffffffff
Mvaa 64,228,84
s_lshr_b32 s3, s2, 3
s_lshl_b32 s3, s3, 2
s_add_u32 s3, s3, s32
Mvaa 68,232,80
s_lshl_b32 s3, s3, 10
v_and_b32 v42, 7, v0
v_lshlrev_b32_e64 v42, 7, v42
Mvaa 68,236,84
Ra 248,12,6144
Mvaa 72,224,88
v_add_u32_e64 v42, s3, v42
v_min_u32 v42, L_k2_fin-L_phase2-4, v42
Mvaa 72,228,92
v_mov_b32_e64 v41, s7
Mvaa 76,232,88
v_add_co_u32 v40, vcc, s6, v42
s_nop 1
v_addc_co_u32 v41, vcc, 0, v41, vcc
Mvaa 76,236,92
Ra 252,13,6144
Mvaa 80,224,96
global_load_dword v38, v[40:41], off
Mvaa 80,228,100
Mvaa 84,232,96
Mvaa 84,236,100
Mvaa 88,224,104
Mvaa 88,228,108
Mvaa 92,232,104
Mvaa 92,236,108
Mvaa 96,224,112
Mvaa 96,228,116
Mvaa 100,232,112
Mvaa 100,236,116
Mvaa 104,224,120
Mvaa 104,228,124
Mvaa 108,232,120
s_waitcnt lgkmcnt(0)
Mvaa 108,236,124
Mvaa 112,240,64
Mvaa 112,244,68
Mvaa 116,248,64
Mvaa 116,252,68
Ra 224,12,8192
Mvaa 120,240,72
Mvaa 120,244,76
Mvaa 124,248,72
Mvaa 124,252,76
Ra 228,13,8192
Mvaa 128,240,80
Mvaa 128,244,84
Mvaa 132,248,80
Mvaa 132,252,84
Ra 232,12,10240
Mvaa 136,240,88
Mvaa 136,244,92
Mvaa 140,248,88
Mvaa 140,252,92
Ra 236,13,10240
Mvaa 144,240,96
Mvaa 144,244,100
Mvaa 148,248,96
Mvaa 148,252,100
Mvaa 152,240,104
Mvaa 152,244,108
Mvaa 156,248,104
Mvaa 156,252,108
Mvaa 160,240,112
Mvaa 160,244,116
Mvaa 164,248,112
Mvaa 164,252,116
Mvaa 168,240,120
Mvaa 168,244,124
s_waitcnt vmcnt(11)
Mvaa 172,248,120
s_waitcnt lgkmcnt(0)
s_barrier
Mvaa 172,252,124
s_add_u32 m0, s57, 65536
Mvaa 176,224,64
buffer_load_dwordx4 v6, s[12:15], s52 offen offset:0 lds
Mvaa 176,228,68
Ta 0,16,0
Ta 2,16,2048
Mvaa 180,232,64
Mvaa 180,236,68
Ra 240,12,12288
Mvaa 184,224,72
buffer_load_dwordx4 v7, s[12:15], s53 offen offset:1024 lds
Mvaa 184,228,76
Ta 4,16,16384
Ta 6,16,18432
Mvaa 188,232,72
Mvaa 188,236,76
Ra 244,13,12288
Mvaa 192,224,80
buffer_load_dwordx4 v6, s[12:15], s54 offen offset:2048 lds
Mvaa 192,228,84
Ta 8,17,0
Ta 10,17,2048
Mvaa 196,232,80
Mvaa 196,236,84
Ra 248,12,14336
Mvaa 200,224,88
buffer_load_dwordx4 v7, s[12:15], s55 offen offset:3072 lds
Mvaa 200,228,92
Ta 12,17,16384
Ta 14,17,18432
Mvaa 204,232,88
Mvaa 204,236,92
s_add_u32 m0, s57, 69632
Ra 252,13,14336
Mvaa 208,224,96
buffer_load_dwordx4 v8, s[12:15], s52 offen offset:0 lds
Mvaa 208,228,100
Mvaa 212,232,96
Mvaa 212,236,100
Ta 16,18,0
Ta 18,18,2048
Mvaa 216,224,104
buffer_load_dwordx4 v9, s[12:15], s53 offen offset:1024 lds
Mvaa 216,228,108
Ta 20,18,16384
s_waitcnt lgkmcnt(9)
Ta 22,18,18432
Mvaa 220,232,104
Mvaa 220,236,108
Ta 24,19,0
Ta 26,19,2048
Mvaa 224,224,112
buffer_load_dwordx4 v8, s[12:15], s54 offen offset:2048 lds
Mvaa 224,228,116
Mvaa 228,232,112
Mvaa 228,236,116
Ta 28,19,16384
Ta 30,19,18432
Mvaa 232,224,120
buffer_load_dwordx4 v9, s[12:15], s55 offen offset:3072 lds
Mvaa 232,228,124
s_waitcnt vmcnt(11)
Ta 32,20,0
s_waitcnt lgkmcnt(9)
Ta 34,20,2048
Mvaa 236,232,120
s_barrier
Mvaa 236,236,124
s_add_u32 m0, s56, 65536
Ta 36,20,16384
Ta 38,20,18432
Mvaa 240,240,64
buffer_load_dwordx4 v2, s[8:11], s48 offen offset:0 lds
Mvaa 240,244,68
Mvaa 244,248,64
Mvaa 244,252,68
Ra 224,10,0
Mvaa 248,240,72
buffer_load_dwordx4 v3, s[8:11], s49 offen offset:1024 lds
Mvaa 248,244,76
Ta 40,21,0
Ta 42,21,2048
Mvaa 252,248,72
Mvaa 252,252,76
s_waitcnt lgkmcnt(9)
Ra 228,11,0
Maaa 128,240,80
buffer_load_dwordx4 v2, s[8:11], s50 offen offset:2048 lds
Maaa 128,244,84
Ta 44,21,16384
Ta 46,21,18432
Maaa 132,248,80
Maaa 132,252,84
Ra 232,10,2048
Maaa 136,240,88
buffer_load_dwordx4 v3, s[8:11], s51 offen offset:3072 lds
Maaa 136,244,92
Ta 48,22,0
Ta 50,22,2048
Maaa 140,248,88
Maaa 140,252,92
s_add_u32 m0, s56, 69632
s_waitcnt lgkmcnt(9)
Ra 236,11,2048
Maaa 144,240,96
buffer_load_dwordx4 v4, s[8:11], s48 offen offset:0 lds
Maaa 144,244,100
Maaa 148,248,96
Maaa 148,252,100
Ta 52,22,16384
Ta 54,22,18432
Maaa 152,240,104
buffer_load_dwordx4 v5, s[8:11], s49 offen offset:1024 lds
Maaa 152,244,108
Ta 56,23,0
Ta 58,23,2048
Maaa 156,248,104
Maaa 156,252,108
Ta 60,23,16384
s_waitcnt lgkmcnt(9)
Ta 62,23,18432
Maaa 160,240,112
buffer_load_dwordx4 v4, s[8:11], s50 offen offset:2048 lds
Maaa 160,244,116
Maaa 164,248,112
Maaa 164,252,116
Maaa 168,240,120
buffer_load_dwordx4 v5, s[8:11], s51 offen offset:3072 lds
Maaa 168,244,124
Maaa 172,248,120
s_waitcnt lgkmcnt(6)
Maaa 172,252,124
s_waitcnt lgkmcnt(0)
Mvaa 48,224,0
buffer_load_dword v1, v31, s[28:31], s37 offen sc1
Mvaa 48,228,4
s_mov_b32 s8, s16
s_mov_b32 s9, s17
s_mov_b32 s10, s18
Mvaa 52,232,0
s_add_u32 s16, s66, 46137344
s_addc_u32 s17, s67, 0
s_and_b32 s17, s17, 0xffff
Mvaa 52,236,4
Ra 240,10,4096
Mvaa 56,224,8
s_mov_b32 s18, 16777216
s_mov_b32 s19, 0x20000
s_mov_b32 s48, 0
Mvaa 56,228,12
s_mov_b32 s49, 31744
s_mov_b32 s50, 63488
s_mov_b32 s51, 95232
Mvaa 60,232,8
v_lshlrev_b32 v35, 13, v34
v_lshl_add_u32 v8, v36, 4, v35
Mvaa 60,236,12
Ra 244,11,4096
Mvaa 64,224,16
v_lshl_add_u32 v9, v37, 4, v35
v_lshlrev_b32_e64 v2, 4, v0
Mvaa 64,228,20
v_add_u32 v3, 65536, v2
v_add_u32_e64 v4, s44, v2
Mvaa 68,232,16
v_mov_b32 v7, 0
v_lshlrev_b32 v35, 2, v32
Mvaa 68,236,20
Ra 248,10,6144
Mvaa 72,224,24
v_sub_u32_e64 v35, v33, v35
Mvaa 72,228,28
s_lshl_b32 s3, s32, 4
v_add_u32 v5, s3, v35
Mvaa 76,232,24
s_sub_u32 s3, 48, s3
v_add_u32 v6, s3, v35
Mvaa 76,236,28
Ra 252,11,6144
Mvaa 80,224,32
s_mul_i32 s3, s33, 1116160
s_add_u32 s3, s3, 8388608
s_add_u32 s12, s66, s3
s_addc_u32 s13, s67, 0
s_and_b32 s13, s13, 0xffff
Mvaa 80,228,36
s_mov_b32 s14, 0
s_mov_b32 s15, 0x20000
s_mul_i32 s14, s36, 34816
Mvaa 84,232,32
buffer_load_dword v44, v45, s[8:11], s47 offen
Mvaa 84,236,36
s_add_u32 s47, s47, 2097152
v_lshrrev_b32 v42, 2, v33
v_lshl_add_u32 v43, v32, 3, v42
Mvaa 88,224,40
v_lshlrev_b32 v43, 8, v43
v_and_b32 v46, 3, v0
Mvaa 88,228,44
v_lshl_add_u32 v43, v46, 3, v43
v_and_b32_e64 v46, 1, v32
Mvaa 92,232,40
v_lshl_add_u32 v42, v46, 2, v42
v_lshl_add_u32 v16, v42, 5, v43
Mvaa 92,236,44
v_xor_b32 v17, 32, v16
v_xor_b32 v18, 64, v16
Mvaa 96,224,48
v_xor_b32 v19, 96, v16
v_xor_b32 v20, 128, v16
Mvaa 96,228,52
v_xor_b32 v21, 160, v16
v_xor_b32 v22, 192, v16
Mvaa 100,232,48
v_xor_b32 v23, 224, v16
Mvaa 100,236,52
Mvaa 104,224,56
Mvaa 104,228,60
Mvaa 108,232,56
s_waitcnt lgkmcnt(0)
Mvaa 108,236,60
Mvaa 112,240,0
Mvaa 112,244,4
Mvaa 116,248,0
Mvaa 116,252,4
Ra 224,10,8192
Mvaa 120,240,8
Mvaa 120,244,12
Mvaa 124,248,8
Mvaa 124,252,12
Ra 228,11,8192
Mvaa 128,240,16
Mvaa 128,244,20
Mvaa 132,248,16
Mvaa 132,252,20
Ra 232,10,10240
Mvaa 136,240,24
Mvaa 136,244,28
Mvaa 140,248,24
Mvaa 140,252,28
Ra 236,11,10240
Mvaa 144,240,32
Mvaa 144,244,36
Mvaa 148,248,32
Mvaa 148,252,36
Mvaa 152,240,40
Mvaa 152,244,44
Mvaa 156,248,40
Mvaa 156,252,44
Mvaa 160,240,48
Mvaa 160,244,52
Mvaa 164,248,48
Mvaa 164,252,52
Mvaa 168,240,56
Mvaa 168,244,60
s_waitcnt vmcnt(10)
Mvaa 172,248,56
s_waitcnt lgkmcnt(0)
s_barrier
Mvaa 172,252,60
s_add_u32 m0, s44, 0
Mvaa 176,224,0
buffer_load_dwordx4 v8, s[8:11], s48 offen offset:0 lds
Mvaa 176,228,4
Ta 64,14,0
Ta 66,14,2048
Mvaa 180,232,0
Mvaa 180,236,4
Ra 240,10,12288
Mvaa 184,224,8
buffer_load_dwordx4 v8, s[8:11], s49 offen offset:1024 lds
Mvaa 184,228,12
Ta 68,14,16384
Ta 70,14,18432
Mvaa 188,232,8
Mvaa 188,236,12
Ra 244,11,12288
Mvaa 192,224,16
buffer_load_dwordx4 v9, s[8:11], s50 offen offset:2048 lds
Mvaa 192,228,20
Ta 72,15,0
Ta 74,15,2048
Mvaa 196,232,16
Mvaa 196,236,20
Ra 248,10,14336
Mvaa 200,224,24
buffer_load_dwordx4 v9, s[8:11], s51 offen offset:3072 lds
Mvaa 200,228,28
Ta 76,15,16384
Ta 78,15,18432
Mvaa 204,232,24
v_add_u32 v8, 524288, v8
v_add_u32 v9, 524288, v9
Mvaa 204,236,28
s_add_u32 m0, s44, 16384
Ra 252,11,14336
Mvaa 208,224,32
buffer_load_dwordx4 v8, s[8:11], s48 offen offset:0 lds
Mvaa 208,228,36
Mvaa 212,232,32
Mvaa 212,236,36
Ta 80,24,0
Ta 82,24,2048
Mvaa 216,224,40
buffer_load_dwordx4 v8, s[8:11], s49 offen offset:1024 lds
Mvaa 216,228,44
Ta 84,24,16384
s_waitcnt lgkmcnt(9)
Ta 86,24,18432
Mvaa 220,232,40
Mvaa 220,236,44
Ta 88,25,0
Ta 90,25,2048
Mvaa 224,224,48
buffer_load_dwordx4 v9, s[8:11], s50 offen offset:2048 lds
Mvaa 224,228,52
Mvaa 228,232,48
s_mul_i32 s3, s45, 33792
v_add_u32_e64 v10, s3, v2
Mvaa 228,236,52
Ta 92,25,16384
Ta 94,25,18432
Mvaa 232,224,56
buffer_load_dwordx4 v9, s[8:11], s51 offen offset:3072 lds
Mvaa 232,228,60
s_waitcnt vmcnt(10)
Ta 96,26,0
s_waitcnt lgkmcnt(9)
Ta 98,26,2048
Mvaa 236,232,56
s_barrier
v_add_u32 v8, 524288, v8
v_add_u32 v9, 524288, v9
Mvaa 236,236,60
s_add_u32 m0, s44, 32768
Ta 100,26,16384
Ta 102,26,18432
Mvaa 240,240,0
buffer_load_dwordx4 v8, s[8:11], s48 offen offset:0 lds
Mvaa 240,244,4
s_mul_i32 s3, s46, 33792
v_add_u32 v11, s3, v2
Mvaa 244,248,0
Mvaa 244,252,4
Ra 224,12,0
Mvaa 248,240,8
buffer_load_dwordx4 v8, s[8:11], s49 offen offset:1024 lds
Mvaa 248,244,12
Ta 104,27,0
Ta 106,27,2048
Mvaa 252,248,8
Mvaa 252,252,12
s_waitcnt lgkmcnt(9)
Ra 228,13,0
Maaa 128,240,16
buffer_load_dwordx4 v9, s[8:11], s50 offen offset:2048 lds
Maaa 128,244,20
Ta 108,27,16384
Ta 110,27,18432
Maaa 132,248,16
Maaa 132,252,20
Ra 232,12,2048
Maaa 136,240,24
buffer_load_dwordx4 v9, s[8:11], s51 offen offset:3072 lds
Maaa 136,244,28
Ta 112,28,0
Ta 114,28,2048
Maaa 140,248,24
v_add_u32 v8, 524288, v8
v_add_u32 v9, 524288, v9
Maaa 140,252,28
s_add_u32 m0, s44, 49152
s_waitcnt lgkmcnt(9)
Ra 236,13,2048
Maaa 144,240,32
buffer_load_dwordx4 v8, s[8:11], s48 offen offset:0 lds
Maaa 144,244,36
Maaa 148,248,32
Maaa 148,252,36
Ta 116,28,16384
Ta 118,28,18432
Maaa 152,240,40
buffer_load_dwordx4 v8, s[8:11], s49 offen offset:1024 lds
Maaa 152,244,44
Ta 120,29,0
Ta 122,29,2048
Maaa 156,248,40
Maaa 156,252,44
Ta 124,29,16384
s_waitcnt lgkmcnt(9)
Ta 126,29,18432
Maaa 160,240,48
buffer_load_dwordx4 v9, s[8:11], s50 offen offset:2048 lds
Maaa 160,244,52
Maaa 164,248,48
Maaa 164,252,52
Maaa 168,240,56
buffer_load_dwordx4 v9, s[8:11], s51 offen offset:3072 lds
Maaa 168,244,60
v_add_u32 v8, 524288, v8
v_add_u32 v9, 524288, v9
Maaa 172,248,56
s_waitcnt lgkmcnt(6)
Maaa 172,252,60
s_waitcnt lgkmcnt(0)
Mvaa 48,224,64
v_mov_b32 v14, v40
v_mov_b32_e64 v15, v41
Mvaa 48,228,68
Mvaa 52,232,64
Mvaa 52,236,68
Ra 240,12,4096
Mvaa 56,224,72
Mvaa 56,228,76
Mvaa 60,232,72
Mvaa 60,236,76
Ra 244,13,4096
Mvaa 64,224,80
Vc 24,48,49
Vc 25,50,51
Mvaa 64,228,84
Vc 26,52,53
Vc 27,54,55
Mvaa 68,232,80
Mvaa 68,236,84
Ra 248,12,6144
Mvaa 72,224,88
Vc 28,56,57
Vc 29,58,59
Mvaa 72,228,92
Vc 30,60,61
Vc 31,62,63
Mvaa 76,232,88
Mvaa 76,236,92
Ra 252,13,6144
Mvaa 80,224,96
Vc 32,64,65
Vc 33,66,67
Mvaa 80,228,100
Vc 34,68,69
Vc 35,70,71
Mvaa 84,232,96
Mvaa 84,236,100
Mvaa 88,224,104
Vc 36,72,73
Vc 37,74,75
Mvaa 88,228,108
Vc 38,76,77
Vc 39,78,79
Mvaa 92,232,104
Mvaa 92,236,108
Mvaa 96,224,112
Vc 40,80,81
Vc 41,82,83
Mvaa 96,228,116
Vc 42,84,85
Vc 43,86,87
Mvaa 100,232,112
s_waitcnt vmcnt(12)
Mvaa 100,236,116
Mvaa 104,224,120
v_readfirstlane_b32 s3, v1
s_nop 0
s_or_b32 s3, s3, s37
s_cmp_lt_u32 s3, 256
s_cbranch_scc1 L_spinAv
L_spinArv:
s_barrier
Mvaa 104,228,124
Vc 44,88,89
Vc 45,90,91
Mvaa 108,232,120
s_waitcnt lgkmcnt(0)
Mvaa 108,236,124
Vc 46,92,93
Vc 47,94,95
Mvaa 112,240,64
buffer_load_dwordx4 a[0:3], v10, s[20:23], s58 offen offset:0 sc1
Mvaa 112,244,68
Vc 48,96,97
Vc 49,98,99
Mvaa 116,248,64
Vc 50,100,101
Vc 51,102,103
Mvaa 116,252,68
Ra 224,12,8192
Mvaa 120,240,72
Vc 52,104,105
Vc 53,106,107
Mvaa 120,244,76
Vc 54,108,109
Vc 55,110,111
Mvaa 124,248,72
buffer_load_dwordx4 a[4:7], v10, s[20:23], 0 offen offset:0 sc1
Mvaa 124,252,76
Ra 228,13,8192
Mvaa 128,240,80
Vc 56,112,113
Vc 57,114,115
Mvaa 128,244,84
Vc 58,116,117
Vc 59,118,119
Mvaa 132,248,80
Mvaa 132,252,84
Ra 232,12,10240
Mvaa 136,240,88
buffer_load_dwordx4 a[8:11], v11, s[20:23], s58 offen offset:0 sc1
Mvaa 136,244,92
Vc 60,120,121
Vc 61,122,123
Mvaa 140,248,88
Vc 62,124,125
Vc 63,126,127
Mvaa 140,252,92
Ra 236,13,10240
Mvaa 144,240,96
Vc 64,128,129
Vc 65,130,131
Mvaa 144,244,100
Vc 66,132,133
Vc 67,134,135
Mvaa 148,248,96
buffer_load_dwordx4 a[12:15], v11, s[20:23], 0 offen offset:0 sc1
Mvaa 148,252,100
Mvaa 152,240,104
Vc 68,136,137
Vc 69,138,139
Mvaa 152,244,108
Vc 70,140,141
Vc 71,142,143
Mvaa 156,248,104
Mvaa 156,252,108
Mvaa 160,240,112
buffer_load_dwordx4 a[16:19], v10, s[20:23], s58 offen offset:1024 sc1
Mvaa 160,244,116
Vc 72,144,145
Vc 73,146,147
Mvaa 164,248,112
Vc 74,148,149
Vc 75,150,151
Mvaa 164,252,116
Mvaa 168,240,120
Vc 76,152,153
Vc 77,154,155
Mvaa 168,244,124
Vc 78,156,157
Vc 79,158,159
Mvaa 172,248,120
s_waitcnt lgkmcnt(0)
buffer_load_dwordx4 a[20:23], v10, s[20:23], 0 offen offset:1024 sc1
Mvaa 172,252,124
Mvaa 176,224,64
Vc 80,160,161
Vc 81,162,163
Mvaa 176,228,68
Vc 82,164,165
Vc 83,166,167
Mvaa 180,232,64
Mvaa 180,236,68
Ra 240,12,12288
Mvaa 184,224,72
buffer_load_dwordx4 a[24:27], v11, s[20:23], s58 offen offset:1024 sc1
Mvaa 184,228,76
Vc 84,168,169
Vc 85,170,171
Mvaa 188,232,72
Vc 86,172,173
Vc 87,174,175
Mvaa 188,236,76
Ra 244,13,12288
Mvaa 192,224,80
Vc 88,176,177
Vc 89,178,179
Mvaa 192,228,84
Vc 90,180,181
Vc 91,182,183
Mvaa 196,232,80
buffer_load_dwordx4 a[28:31], v11, s[20:23], 0 offen offset:1024 sc1
Mvaa 196,236,84
Ra 248,12,14336
Mvaa 200,224,88
Vc 92,184,185
Vc 93,186,187
Mvaa 200,228,92
Vc 94,188,189
Vc 95,190,191
Mvaa 204,232,88
Mvaa 204,236,92
Ra 252,13,14336
Mvaa 208,224,96
buffer_load_dwordx4 a[32:35], v10, s[20:23], s58 offen offset:2048 sc1
Mvaa 208,228,100
Vc 96,192,193
Vc 97,194,195
Mvaa 212,232,96
Vc 98,196,197
Vc 99,198,199
Mvaa 212,236,100
Mvaa 216,224,104
Vc 100,200,201
Vc 101,202,203
Mvaa 216,228,108
Vc 102,204,205
Vc 103,206,207
Mvaa 220,232,104
buffer_load_dwordx4 a[36:39], v10, s[20:23], 0 offen offset:2048 sc1
Mvaa 220,236,108
Mvaa 224,224,112
Vc 104,208,209
Vc 105,210,211
Mvaa 224,228,116
Vc 106,212,213
Vc 107,214,215
Mvaa 228,232,112
Mvaa 228,236,116
Mvaa 232,224,120
buffer_load_dwordx4 a[40:43], v11, s[20:23], s58 offen offset:2048 sc1
Mvaa 232,228,124
Vc 108,216,217
Vc 109,218,219
Mvaa 236,232,120
s_waitcnt lgkmcnt(0)
Mvaa 236,236,124
Vc 110,220,221
Vc 111,222,223
Mvaa 240,240,64
Vc 112,224,225
Vc 113,226,227
Mvaa 240,244,68
Vc 114,228,229
Vc 115,230,231
Mvaa 244,248,64
buffer_load_dwordx4 a[44:47], v11, s[20:23], 0 offen offset:2048 sc1
Mvaa 244,252,68
Mvaa 248,240,72
Vc 116,232,233
Vc 117,234,235
Mvaa 248,244,76
Vc 118,236,237
Vc 119,238,239
Mvaa 252,248,72
Mvaa 252,252,76
Maaa 128,240,80
buffer_load_dwordx4 a[48:51], v10, s[20:23], s58 offen offset:3072 sc1
Maaa 128,244,84
Ta 192,16,0
Ta 194,16,1024
Maaa 132,248,80
Vc 120,240,241
Vc 121,242,243
Maaa 132,252,84
Ta 196,17,0
Ta 198,17,1024
Maaa 136,240,88
Vc 122,244,245
Vc 123,246,247
Maaa 136,244,92
Ta 200,18,0
Ta 202,18,1024
Maaa 140,248,88
buffer_load_dwordx4 a[52:55], v10, s[20:23], 0 offen offset:3072 sc1
Maaa 140,252,92
Ta 204,19,0
Ta 206,19,1024
Maaa 144,240,96
Vc 124,248,249
Vc 125,250,251
Maaa 144,244,100
Ta 208,20,0
Ta 210,20,1024
Maaa 148,248,96
Vc 126,252,253
Vc 127,254,255
Maaa 148,252,100
Ta 212,21,0
Ta 214,21,1024
Maaa 152,240,104
buffer_load_dwordx4 a[56:59], v11, s[20:23], s58 offen offset:3072 sc1
Maaa 152,244,108
Ta 216,22,0
Ta 218,22,1024
Maaa 156,248,104
Maaa 156,252,108
Ta 220,23,0
s_waitcnt lgkmcnt(9)
Ta 222,23,1024
Maaa 160,240,112
Maaa 160,244,116
Maaa 164,248,112
buffer_load_dwordx4 a[60:63], v11, s[20:23], 0 offen offset:3072 sc1
Maaa 164,252,116
v_add_u32 v10, 4096, v10
v_add_u32 v11, 4096, v11
Maaa 168,240,120
Maaa 168,244,124
Maaa 172,248,120
Maaa 172,252,124
L_phase2:
s_nop 7
s_waitcnt vmcnt(12) lgkmcnt(0)
Zvaa 128,192,0
s_add_u32 s59, s38, 0
Zvaa 160,192,4
Ta 224,16,8192
Ta 226,16,9216
Zvaa 192,192,8
buffer_load_dwordx4 a[64:67], v10, s[20:23], s58 offen offset:0 sc1
Zvaa 224,192,12
buffer_store_dwordx4 v[24:27], v2, s[24:27], s59 offen offset:0 sc1
Zvaa 132,196,0
Ta 228,17,8192
Ta 230,17,9216
Zvaa 164,196,4
buffer_load_dwordx4 a[68:71], v10, s[20:23], 0 offen offset:0 sc1
Zvaa 196,196,8
s_mov_b32 s60, s40
s_and_b32 s61, s41, 0xffff
s_mov_b32 s62, 7340032
Zvaa 228,196,12
Ta 232,18,8192
Ta 234,18,9216
Zvaa 136,200,0
s_mov_b32 s63, 0x20000
Zvaa 168,200,4
buffer_load_dwordx4 a[72:75], v11, s[20:23], s58 offen offset:0 sc1
Zvaa 200,200,8
Ta 236,19,8192
Ta 238,19,9216
Zvaa 232,200,12
global_load_dword v13, v[14:15], off
Zvaa 140,204,0
Zvaa 172,204,4
Ta 240,20,8192
Ta 242,20,9216
Zvaa 204,204,8
buffer_load_dwordx4 a[76:79], v11, s[20:23], 0 offen offset:0 sc1
Zvaa 236,204,12
Zvaa 144,208,0
s_waitcnt lgkmcnt(6)
Ta 244,21,8192
Ta 246,21,9216
Zvaa 176,208,4
buffer_store_dwordx4 v[28:31], v2, s[24:27], s59 offen offset:1024 sc1
Zvaa 208,208,8
buffer_load_dwordx4 a[80:83], v10, s[20:23], s58 offen offset:1024 sc1
Zvaa 240,208,12
Ta 248,22,8192
Ta 250,22,9216
Zvaa 148,212,0
Zvaa 180,212,4
Zvaa 212,212,8
Ta 252,23,8192
Ta 254,23,9216
Zvaa 244,212,12
buffer_load_dwordx4 a[84:87], v10, s[20:23], 0 offen offset:1024 sc1
Zvaa 152,216,0
Zvaa 184,216,4
Zvaa 216,216,8
buffer_load_dwordx4 a[88:91], v11, s[20:23], s58 offen offset:1024 sc1
Zvaa 248,216,12
Zvaa 156,220,0
Zvaa 188,220,4
buffer_load_dwordx4 a[92:95], v11, s[20:23], 0 offen offset:1024 sc1
Zvaa 220,220,8
Zvaa 252,220,12
s_waitcnt vmcnt(19) lgkmcnt(0)
s_barrier
Mvaa 128,224,16
buffer_store_dwordx4 v[32:35], v2, s[24:27], s59 offen offset:2048 sc1
Mvaa 160,224,20
s_add_u32 m0, s44, 0
Ta 192,16,16384
Ta 194,16,17408
Mvaa 192,224,24
buffer_load_dwordx4 v8, s[8:11], s48 offen offset:0 lds
Mvaa 224,224,28
Mvaa 132,228,16
Ta 196,17,16384
Ta 198,17,17408
Mvaa 164,228,20
buffer_load_dwordx4 v8, s[8:11], s49 offen offset:1024 lds
Mvaa 196,228,24
Mvaa 228,228,28
Ta 200,18,16384
Ta 202,18,17408
Mvaa 136,232,16
Mvaa 168,232,20
buffer_load_dwordx4 v9, s[8:11], s50 offen offset:2048 lds
Mvaa 200,232,24
Ta 204,19,16384
Ta 206,19,17408
Mvaa 232,232,28
Mvaa 140,236,16
Mvaa 172,236,20
Ta 208,20,16384
Ta 210,20,17408
Mvaa 204,236,24
buffer_load_dwordx4 v9, s[8:11], s51 offen offset:3072 lds
v_add_u32 v8, 524288, v8
v_add_u32 v9, 524288, v9
Mvaa 236,236,28
Mvaa 144,240,16
s_waitcnt lgkmcnt(6)
Ta 212,21,16384
Ta 214,21,17408
Mvaa 176,240,20
buffer_store_dwordx4 v[36:39], v2, s[24:27], s59 offen offset:3072 sc1
Mvaa 208,240,24
buffer_load_dwordx4 a[96:99], v10, s[20:23], s58 offen offset:2048 sc1
Mvaa 240,240,28
Ta 216,22,16384
Ta 218,22,17408
Mvaa 148,244,16
Mvaa 180,244,20
Mvaa 212,244,24
Ta 220,23,16384
Ta 222,23,17408
Mvaa 244,244,28
buffer_load_dwordx4 a[100:103], v10, s[20:23], 0 offen offset:2048 sc1
Mvaa 152,248,16
Mvaa 184,248,20
Mvaa 216,248,24
buffer_load_dwordx4 a[104:107], v11, s[20:23], s58 offen offset:2048 sc1
Mvaa 248,248,28
Mvaa 156,252,16
Mvaa 188,252,20
buffer_load_dwordx4 a[108:111], v11, s[20:23], 0 offen offset:2048 sc1
Mvaa 220,252,24
Mvaa 252,252,28
s_waitcnt vmcnt(25) lgkmcnt(0)
Mvaa 128,192,32
s_add_u32 s59, s38, 4096
Mvaa 160,192,36
Ta 224,16,24576
Ta 226,16,25600
Mvaa 192,192,40
buffer_load_dwordx4 a[112:115], v10, s[20:23], s58 offen offset:3072 sc1
Mvaa 224,192,44
buffer_store_dwordx4 v[40:43], v2, s[24:27], s59 offen offset:0 sc1
Mvaa 132,196,32
Ta 228,17,24576
Ta 230,17,25600
Mvaa 164,196,36
Mvaa 196,196,40
Mvaa 228,196,44
Ta 232,18,24576
Ta 234,18,25600
Mvaa 136,200,32
Mvaa 168,200,36
buffer_load_dwordx4 a[116:119], v10, s[20:23], 0 offen offset:3072 sc1
Mvaa 200,200,40
Ta 236,19,24576
Ta 238,19,25600
Mvaa 232,200,44
Mvaa 140,204,32
Mvaa 172,204,36
Ta 240,20,24576
Ta 242,20,25600
Mvaa 204,204,40
Mvaa 236,204,44
Mvaa 144,208,32
s_waitcnt lgkmcnt(6)
Ta 244,21,24576
Ta 246,21,25600
Mvaa 176,208,36
buffer_store_dwordx4 v[44:47], v2, s[24:27], s59 offen offset:1024 sc1
Mvaa 208,208,40
buffer_load_dwordx4 a[120:123], v11, s[20:23], s58 offen offset:3072 sc1
Mvaa 240,208,44
Ta 248,22,24576
Ta 250,22,25600
Mvaa 148,212,32
Mvaa 180,212,36
Mvaa 212,212,40
Ta 252,23,24576
Ta 254,23,25600
Mvaa 244,212,44
Mvaa 152,216,32
Mvaa 184,216,36
Mvaa 216,216,40
buffer_load_dwordx4 a[124:127], v11, s[20:23], 0 offen offset:3072 sc1
v_add_u32 v10, 4096, v10
v_add_u32 v11, 4096, v11
Mvaa 248,216,44
Mvaa 156,220,32
Mvaa 188,220,36
Mvaa 220,220,40
Mvaa 252,220,44
s_waitcnt vmcnt(27) lgkmcnt(0)
s_barrier
Mvaa 128,224,48
buffer_store_dwordx4 v[48:51], v2, s[24:27], s59 offen offset:2048 sc1
Mvaa 160,224,52
s_add_u32 m0, s44, 16384
Ta 192,16,32768
Ta 194,16,33792
Mvaa 192,224,56
buffer_load_dwordx4 v8, s[8:11], s48 offen offset:0 lds
Mvaa 224,224,60
Mvaa 132,228,48
Ta 196,17,32768
Ta 198,17,33792
Mvaa 164,228,52
buffer_load_dwordx4 v8, s[8:11], s49 offen offset:1024 lds
Mvaa 196,228,56
Mvaa 228,228,60
Ta 200,18,32768
Ta 202,18,33792
Mvaa 136,232,48
Mvaa 168,232,52
buffer_load_dwordx4 v9, s[8:11], s50 offen offset:2048 lds
Mvaa 200,232,56
Ta 204,19,32768
Ta 206,19,33792
Mvaa 232,232,60
Mvaa 140,236,48
Mvaa 172,236,52
Ta 208,20,32768
Ta 210,20,33792
Mvaa 204,236,56
buffer_load_dwordx4 v9, s[8:11], s51 offen offset:3072 lds
v_add_u32 v8, 524288, v8
v_add_u32 v9, 524288, v9
Mvaa 236,236,60
Mvaa 144,240,48
s_waitcnt lgkmcnt(6)
Ta 212,21,32768
Ta 214,21,33792
Mvaa 176,240,52
buffer_store_dwordx4 v[52:55], v2, s[24:27], s59 offen offset:3072 sc1
Mvaa 208,240,56
buffer_load_dwordx4 a[0:3], v10, s[20:23], s58 offen offset:0 sc1
Mvaa 240,240,60
Ta 216,22,32768
Ta 218,22,33792
Mvaa 148,244,48
Mvaa 180,244,52
Mvaa 212,244,56
Ta 220,23,32768
Ta 222,23,33792
Mvaa 244,244,60
buffer_load_dwordx4 a[4:7], v10, s[20:23], 0 offen offset:0 sc1
Mvaa 152,248,48
Mvaa 184,248,52
Mvaa 216,248,56
buffer_load_dwordx4 a[8:11], v11, s[20:23], s58 offen offset:0 sc1
Mvaa 248,248,60
Mvaa 156,252,48
Mvaa 188,252,52
buffer_load_dwordx4 a[12:15], v11, s[20:23], 0 offen offset:0 sc1
Mvaa 220,252,56
Mvaa 252,252,60
s_waitcnt vmcnt(31) lgkmcnt(0)
Mvaa 128,192,64
s_add_u32 s59, s38, 8192
Mvaa 160,192,68
Ta 224,16,40960
Ta 226,16,41984
Mvaa 192,192,72
buffer_load_dwordx4 a[16:19], v10, s[20:23], s58 offen offset:1024 sc1
Mvaa 224,192,76
buffer_store_dwordx4 v[56:59], v2, s[24:27], s59 offen offset:0 sc1
Mvaa 132,196,64
Ta 228,17,40960
Ta 230,17,41984
Mvaa 164,196,68
Ar 48,128
Ar 49,129
Mvaa 196,196,72
Ar 50,130
Ar 51,131
Mvaa 228,196,76
Ta 232,18,40960
Ta 234,18,41984
Mvaa 136,200,64
Ar 52,132
Ar 53,133
Mvaa 168,200,68
buffer_load_dwordx4 a[20:23], v10, s[20:23], 0 offen offset:1024 sc1
Mvaa 200,200,72
Ta 236,19,40960
Ta 238,19,41984
Mvaa 232,200,76
Ar 54,134
Ar 55,135
Mvaa 140,204,64
Vc 24,48,49
Vc 25,50,51
Mvaa 172,204,68
Ta 240,20,40960
Ta 242,20,41984
Mvaa 204,204,72
Vc 26,52,53
Vc 27,54,55
Mvaa 236,204,76
Mvaa 144,208,64
s_waitcnt lgkmcnt(6)
Ta 244,21,40960
Ta 246,21,41984
Mvaa 176,208,68
buffer_store_dwordx4 v[60:63], v2, s[24:27], s59 offen offset:1024 sc1
Mvaa 208,208,72
buffer_load_dwordx4 a[24:27], v11, s[20:23], s58 offen offset:1024 sc1
Mvaa 240,208,76
Ta 248,22,40960
Ta 250,22,41984
Mvaa 148,212,64
Ar 48,136
Ar 49,137
Mvaa 180,212,68
Ar 50,138
Ar 51,139
Mvaa 212,212,72
Ta 252,23,40960
Ta 254,23,41984
Mvaa 244,212,76
Ar 52,140
Ar 53,141
Mvaa 152,216,64
Ar 54,142
Ar 55,143
Mvaa 184,216,68
Vc 28,48,49
Vc 29,50,51
Mvaa 216,216,72
buffer_load_dwordx4 a[28:31], v11, s[20:23], 0 offen offset:1024 sc1
Mvaa 248,216,76
Vc 30,52,53
Vc 31,54,55
Mvaa 156,220,64
Mvaa 188,220,68
Mvaa 220,220,72
Mvaa 252,220,76
s_waitcnt vmcnt(32) lgkmcnt(0)
s_barrier
Mvaa 128,224,80
buffer_store_dwordx4 v[64:67], v2, s[24:27], s59 offen offset:2048 sc1
Mvaa 160,224,84
s_add_u32 m0, s44, 32768
Ta 192,16,49152
Ta 194,16,50176
Mvaa 192,224,88
buffer_load_dwordx4 v8, s[8:11], s48 offen offset:0 lds
Mvaa 224,224,92
Ar 48,144
Ar 49,145
Mvaa 132,228,80
Ta 196,17,49152
Ta 198,17,50176
Mvaa 164,228,84
buffer_load_dwordx4 v8, s[8:11], s49 offen offset:1024 lds
Mvaa 196,228,88
Ar 50,146
Ar 51,147
Mvaa 228,228,92
Ta 200,18,49152
Ta 202,18,50176
Mvaa 136,232,80
Ar 52,148
Ar 53,149
Mvaa 168,232,84
buffer_load_dwordx4 v9, s[8:11], s50 offen offset:2048 lds
Mvaa 200,232,88
Ta 204,19,49152
Ta 206,19,50176
Mvaa 232,232,92
Ar 54,150
Ar 55,151
Mvaa 140,236,80
Vc 32,48,49
Vc 33,50,51
Mvaa 172,236,84
Ta 208,20,49152
Ta 210,20,50176
Mvaa 204,236,88
buffer_load_dwordx4 v9, s[8:11], s51 offen offset:3072 lds
v_add_u32 v8, 524288, v8
v_add_u32 v9, 524288, v9
Mvaa 236,236,92
Vc 34,52,53
Vc 35,54,55
Mvaa 144,240,80
s_waitcnt lgkmcnt(6)
Ta 212,21,49152
Ta 214,21,50176
Mvaa 176,240,84
buffer_store_dwordx4 v[68:71], v2, s[24:27], s59 offen offset:3072 sc1
Mvaa 208,240,88
buffer_load_dwordx4 a[32:35], v10, s[20:23], s58 offen offset:2048 sc1
Mvaa 240,240,92
Ta 216,22,49152
Ta 218,22,50176
Mvaa 148,244,80
Ar 48,152
Ar 49,153
Mvaa 180,244,84
Ar 50,154
Ar 51,155
Mvaa 212,244,88
Ta 220,23,49152
Ta 222,23,50176
Mvaa 244,244,92
buffer_load_dwordx4 a[36:39], v10, s[20:23], 0 offen offset:2048 sc1
Mvaa 152,248,80
Ar 52,156
Ar 53,157
Mvaa 184,248,84
Ar 54,158
Ar 55,159
Mvaa 216,248,88
buffer_load_dwordx4 a[40:43], v11, s[20:23], s58 offen offset:2048 sc1
Mvaa 248,248,92
Vc 36,48,49
Vc 37,50,51
Mvaa 156,252,80
Vc 38,52,53
Vc 39,54,55
Mvaa 188,252,84
buffer_load_dwordx4 a[44:47], v11, s[20:23], 0 offen offset:2048 sc1
Mvaa 220,252,88
global_load_dword v13, v[14:15], off
Mvaa 252,252,92
s_waitcnt vmcnt(33) lgkmcnt(0)
Mvaa 128,192,96
s_add_u32 s59, s38, 12288
Mvaa 160,192,100
Ta 224,16,57344
Ta 226,16,58368
Mvaa 192,192,104
buffer_load_dwordx4 a[48:51], v10, s[20:23], s58 offen offset:3072 sc1
Mvaa 224,192,108
buffer_store_dwordx4 v[72:75], v2, s[24:27], s59 offen offset:0 sc1
Mvaa 132,196,96
Ta 228,17,57344
Ta 230,17,58368
Mvaa 164,196,100
Ar 48,160
Ar 49,161
Mvaa 196,196,104
Ar 50,162
Ar 51,163
Mvaa 228,196,108
Ta 232,18,57344
Ta 234,18,58368
Mvaa 136,200,96
Ar 52,164
Ar 53,165
Mvaa 168,200,100
buffer_load_dwordx4 a[52:55], v10, s[20:23], 0 offen offset:3072 sc1
Mvaa 200,200,104
Ta 236,19,57344
Ta 238,19,58368
Mvaa 232,200,108
Ar 54,166
Ar 55,167
Mvaa 140,204,96
Vc 40,48,49
Vc 41,50,51
Mvaa 172,204,100
Ta 240,20,57344
Ta 242,20,58368
Mvaa 204,204,104
Vc 42,52,53
Vc 43,54,55
Mvaa 236,204,108
Mvaa 144,208,96
s_waitcnt lgkmcnt(6)
Ta 244,21,57344
Ta 246,21,58368
Mvaa 176,208,100
buffer_store_dwordx4 v[76:79], v2, s[24:27], s59 offen offset:1024 sc1
Mvaa 208,208,104
buffer_load_dwordx4 a[56:59], v11, s[20:23], s58 offen offset:3072 sc1
Mvaa 240,208,108
Ta 248,22,57344
Ta 250,22,58368
Mvaa 148,212,96
Ar 48,168
Ar 49,169
Mvaa 180,212,100
Ar 50,170
Ar 51,171
Mvaa 212,212,104
Ta 252,23,57344
Ta 254,23,58368
Mvaa 244,212,108
Ar 52,172
Ar 53,173
Mvaa 152,216,96
Ar 54,174
Ar 55,175
Mvaa 184,216,100
Vc 44,48,49
Vc 45,50,51
Mvaa 216,216,104
buffer_load_dwordx4 a[60:63], v11, s[20:23], 0 offen offset:3072 sc1
v_add_u32 v10, 4096, v10
v_add_u32 v11, 4096, v11
Mvaa 248,216,108
Vc 46,52,53
Vc 47,54,55
Mvaa 156,220,96
Mvaa 188,220,100
Mvaa 220,220,104
Mvaa 252,220,108
s_waitcnt vmcnt(33) lgkmcnt(0)
s_barrier
Mvaa 128,224,112
buffer_store_dwordx4 v[80:83], v2, s[24:27], s59 offen offset:2048 sc1
Mvaa 160,224,116
s_add_u32 m0, s44, 49152
Ta 192,16,0
Ta 194,16,1024
Mvaa 192,224,120
buffer_load_dwordx4 v8, s[8:11], s48 offen offset:0 lds
Mvaa 224,224,124
Mvaa 132,228,112
Ta 196,17,0
Ta 198,17,1024
Mvaa 164,228,116
buffer_load_dwordx4 v8, s[8:11], s49 offen offset:1024 lds
Mvaa 196,228,120
Mvaa 228,228,124
Ta 200,18,0
Ta 202,18,1024
Mvaa 136,232,112
Mvaa 168,232,116
buffer_load_dwordx4 v9, s[8:11], s50 offen offset:2048 lds
Mvaa 200,232,120
Ta 204,19,0
Ta 206,19,1024
Mvaa 232,232,124
Mvaa 140,236,112
Mvaa 172,236,116
Ta 208,20,0
Ta 210,20,1024
Mvaa 204,236,120
buffer_load_dwordx4 v9, s[8:11], s51 offen offset:3072 lds
v_add_u32 v8, 524288, v8
v_add_u32 v9, 524288, v9
Mvaa 236,236,124
Mvaa 144,240,112
s_waitcnt lgkmcnt(6)
Ta 212,21,0
Ta 214,21,1024
Mvaa 176,240,116
buffer_store_dwordx4 v[84:87], v2, s[24:27], s59 offen offset:3072 sc1
Mvaa 208,240,120
buffer_load_dwordx4 a[64:67], v10, s[20:23], s58 offen offset:0 sc1
Mvaa 240,240,124
Ta 216,22,0
Ta 218,22,1024
Mvaa 148,244,112
Mvaa 180,244,116
Mvaa 212,244,120
Ta 220,23,0
Ta 222,23,1024
Mvaa 244,244,124
buffer_load_dwordx4 a[68:71], v10, s[20:23], 0 offen offset:0 sc1
Mvaa 152,248,112
Mvaa 184,248,116
Mvaa 216,248,120
buffer_load_dwordx4 a[72:75], v11, s[20:23], s58 offen offset:0 sc1
Mvaa 248,248,124
Mvaa 156,252,112
Mvaa 188,252,116
buffer_load_dwordx4 a[76:79], v11, s[20:23], 0 offen offset:0 sc1
Mvaa 220,252,120
Mvaa 252,252,124
s_waitcnt vmcnt(33) lgkmcnt(0)
Mvaa 128,192,0
s_add_u32 s59, s38, 34816
Mvaa 160,192,4
Ta 224,16,8192
Ta 226,16,9216
Mvaa 192,192,8
buffer_load_dwordx4 a[80:83], v10, s[20:23], s58 offen offset:1024 sc1
Mvaa 224,192,12
buffer_store_dwordx4 v[88:91], v2, s[24:27], s59 offen offset:0 sc1
Mvaa 132,196,0
Ta 228,17,8192
Ta 230,17,9216
Mvaa 164,196,4
Mvaa 196,196,8
Mvaa 228,196,12
Ta 232,18,8192
Ta 234,18,9216
Mvaa 136,200,0
Mvaa 168,200,4
buffer_load_dwordx4 a[84:87], v10, s[20:23], 0 offen offset:1024 sc1
Mvaa 200,200,8
Ta 236,19,8192
Ta 238,19,9216
Mvaa 232,200,12
Mvaa 140,204,0
Mvaa 172,204,4
Ta 240,20,8192
Ta 242,20,9216
Mvaa 204,204,8
Mvaa 236,204,12
Mvaa 144,208,0
s_waitcnt lgkmcnt(6)
Ta 244,21,8192
Ta 246,21,9216
Mvaa 176,208,4
buffer_store_dwordx4 v[92:95], v2, s[24:27], s59 offen offset:1024 sc1
Mvaa 208,208,8
buffer_load_dwordx4 a[88:91], v11, s[20:23], s58 offen offset:1024 sc1
Mvaa 240,208,12
Ta 248,22,8192
Ta 250,22,9216
Mvaa 148,212,0
Mvaa 180,212,4
Mvaa 212,212,8
Ta 252,23,8192
Ta 254,23,9216
Mvaa 244,212,12
Mvaa 152,216,0
Mvaa 184,216,4
Mvaa 216,216,8
buffer_load_dwordx4 a[92:95], v11, s[20:23], 0 offen offset:1024 sc1
Mvaa 248,216,12
Mvaa 156,220,0
Mvaa 188,220,4
Mvaa 220,220,8
Mvaa 252,220,12
s_waitcnt vmcnt(33) lgkmcnt(0)
s_barrier
Mvaa 128,224,16
buffer_store_dwordx4 v[96:99], v2, s[24:27], s59 offen offset:2048 sc1
Mvaa 160,224,20
s_add_u32 m0, s44, 0
Ta 192,16,16384
Ta 194,16,17408
Mvaa 192,224,24
buffer_load_dwordx4 v8, s[8:11], s48 offen offset:0 lds
Mvaa 224,224,28
Mvaa 132,228,16
Ta 196,17,16384
Ta 198,17,17408
Mvaa 164,228,20
buffer_load_dwordx4 v8, s[8:11], s49 offen offset:1024 lds
Mvaa 196,228,24
Mvaa 228,228,28
Ta 200,18,16384
Ta 202,18,17408
Mvaa 136,232,16
Mvaa 168,232,20
buffer_load_dwordx4 v9, s[8:11], s50 offen offset:2048 lds
Mvaa 200,232,24
Ta 204,19,16384
Ta 206,19,17408
Mvaa 232,232,28
Mvaa 140,236,16
Mvaa 172,236,20
Ta 208,20,16384
Ta 210,20,17408
Mvaa 204,236,24
buffer_load_dwordx4 v9, s[8:11], s51 offen offset:3072 lds
v_add_u32 v8, 524288, v8
v_add_u32 v9, 524288, v9
Mvaa 236,236,28
Mvaa 144,240,16
s_waitcnt lgkmcnt(6)
Ta 212,21,16384
Ta 214,21,17408
Mvaa 176,240,20
buffer_store_dwordx4 v[100:103], v2, s[24:27], s59 offen offset:3072 sc1
Mvaa 208,240,24
buffer_load_dwordx4 a[96:99], v10, s[20:23], s58 offen offset:2048 sc1
Mvaa 240,240,28
Ta 216,22,16384
Ta 218,22,17408
Mvaa 148,244,16
s_mov_b32 s3, 5242880
s_mov_b32 s47, 5246976
Mvaa 180,244,20
buffer_load_dwordx4 v[56:59], v2, s[20:23], s3 offen offset:0 sc1
Mvaa 212,244,24
Ta 220,23,16384
Ta 222,23,17408
Mvaa 244,244,28
buffer_load_dwordx4 a[100:103], v10, s[20:23], 0 offen offset:2048 sc1
Mvaa 152,248,16
buffer_load_dwordx4 v[60:63], v2, s[20:23], s3 offen offset:1024 sc1
Mvaa 184,248,20
buffer_load_dwordx4 v[64:67], v2, s[20:23], s3 offen offset:2048 sc1
Mvaa 216,248,24
buffer_load_dwordx4 a[104:107], v11, s[20:23], s58 offen offset:2048 sc1
Mvaa 248,248,28
buffer_load_dwordx4 v[68:71], v2, s[20:23], s3 offen offset:3072 sc1
Mvaa 156,252,16
buffer_load_dwordx4 v[72:75], v2, s[20:23], s47 offen offset:0 sc1
Mvaa 188,252,20
buffer_load_dwordx4 a[108:111], v11, s[20:23], 0 offen offset:2048 sc1
Mvaa 220,252,24
buffer_load_dwordx4 v[76:79], v2, s[20:23], s47 offen offset:1024 sc1
Mvaa 252,252,28
buffer_load_dwordx4 v[80:83], v2, s[20:23], s47 offen offset:2048 sc1
s_waitcnt vmcnt(40) lgkmcnt(0)
Mvaa 128,192,32
s_add_u32 s59, s38, 38912
Mvaa 160,192,36
Ta 224,16,24576
Ta 226,16,25600
Mvaa 192,192,40
buffer_load_dwordx4 a[112:115], v10, s[20:23], s58 offen offset:3072 sc1
Mvaa 224,192,44
buffer_store_dwordx4 v[104:107], v2, s[24:27], s59 offen offset:0 sc1
Mvaa 132,196,32
Ta 228,17,24576
Ta 230,17,25600
Mvaa 164,196,36
buffer_load_dwordx4 v[84:87], v2, s[20:23], s47 offen offset:3072 sc1
Mvaa 196,196,40
Mvaa 228,196,44
Ta 232,18,24576
Ta 234,18,25600
Mvaa 136,200,32
Mvaa 168,200,36
buffer_load_dwordx4 a[116:119], v10, s[20:23], 0 offen offset:3072 sc1
Mvaa 200,200,40
Ta 236,19,24576
Ta 238,19,25600
Mvaa 232,200,44
Mvaa 140,204,32
Mvaa 172,204,36
Ta 240,20,24576
Ta 242,20,25600
Mvaa 204,204,40
Mvaa 236,204,44
Mvaa 144,208,32
s_waitcnt lgkmcnt(6)
Ta 244,21,24576
Ta 246,21,25600
Mvaa 176,208,36
buffer_store_dwordx4 v[108:111], v2, s[24:27], s59 offen offset:1024 sc1
Mvaa 208,208,40
buffer_load_dwordx4 a[120:123], v11, s[20:23], s58 offen offset:3072 sc1
Mvaa 240,208,44
Ta 248,22,24576
Ta 250,22,25600
Mvaa 148,212,32
Mvaa 180,212,36
Mvaa 212,212,40
Ta 252,23,24576
Ta 254,23,25600
Mvaa 244,212,44
Mvaa 152,216,32
Mvaa 184,216,36
Mvaa 216,216,40
buffer_load_dwordx4 a[124:127], v11, s[20:23], 0 offen offset:3072 sc1
v_add_u32 v10, 4096, v10
v_add_u32 v11, 4096, v11
Mvaa 248,216,44
Mvaa 156,220,32
Mvaa 188,220,36
Mvaa 220,220,40
Mvaa 252,220,44
s_waitcnt vmcnt(40) lgkmcnt(0)
s_barrier
Mvaa 128,224,48
buffer_store_dwordx4 v[112:115], v2, s[24:27], s59 offen offset:2048 sc1
Mvaa 160,224,52
s_add_u32 m0, s44, 16384
Ta 192,16,32768
Ta 194,16,33792
Mvaa 192,224,56
buffer_load_dwordx4 v8, s[8:11], s48 offen offset:0 lds
Mvaa 224,224,60
Mvaa 132,228,48
Ta 196,17,32768
Ta 198,17,33792
Mvaa 164,228,52
buffer_load_dwordx4 v8, s[8:11], s49 offen offset:1024 lds
Mvaa 196,228,56
Mvaa 228,228,60
Ta 200,18,32768
Ta 202,18,33792
Mvaa 136,232,48
Mvaa 168,232,52
buffer_load_dwordx4 v9, s[8:11], s50 offen offset:2048 lds
Mvaa 200,232,56
Ta 204,19,32768
Ta 206,19,33792
Mvaa 232,232,60
Mvaa 140,236,48
Mvaa 172,236,52
Ta 208,20,32768
Ta 210,20,33792
Mvaa 204,236,56
buffer_load_dwordx4 v9, s[8:11], s51 offen offset:3072 lds
v_add_u32 v8, 524288, v8
v_add_u32 v9, 524288, v9
Mvaa 236,236,60
Mvaa 144,240,48
s_waitcnt lgkmcnt(6)
Ta 212,21,32768
Ta 214,21,33792
Mvaa 176,240,52
buffer_store_dwordx4 v[116:119], v2, s[24:27], s59 offen offset:3072 sc1
Mvaa 208,240,56
buffer_load_dwordx4 a[0:3], v10, s[20:23], s58 offen offset:0 sc1
Mvaa 240,240,60
Ta 216,22,32768
Ta 218,22,33792
Mvaa 148,244,48
Mvaa 180,244,52
Mvaa 212,244,56
Ta 220,23,32768
Ta 222,23,33792
Mvaa 244,244,60
buffer_load_dwordx4 a[4:7], v10, s[20:23], 0 offen offset:0 sc1
Mvaa 152,248,48
Mvaa 184,248,52
Mvaa 216,248,56
buffer_load_dwordx4 a[8:11], v11, s[20:23], s58 offen offset:0 sc1
Mvaa 248,248,60
Mvaa 156,252,48
Mvaa 188,252,52
buffer_load_dwordx4 a[12:15], v11, s[20:23], 0 offen offset:0 sc1
Mvaa 220,252,56
Mvaa 252,252,60
s_waitcnt vmcnt(40) lgkmcnt(0)
Mvaa 128,192,64
s_add_u32 s59, s38, 43008
Mvaa 160,192,68
Ta 224,16,40960
Ta 226,16,41984
Mvaa 192,192,72
buffer_load_dwordx4 a[16:19], v10, s[20:23], s58 offen offset:1024 sc1
Mvaa 224,192,76
buffer_store_dwordx4 v[120:123], v2, s[24:27], s59 offen offset:0 sc1
Mvaa 132,196,64
Ta 228,17,40960
Ta 230,17,41984
Mvaa 164,196,68
Mvaa 196,196,72
Mvaa 228,196,76
Ta 232,18,40960
Ta 234,18,41984
Mvaa 136,200,64
Mvaa 168,200,68
buffer_load_dwordx4 a[20:23], v10, s[20:23], 0 offen offset:1024 sc1
Mvaa 200,200,72
Ta 236,19,40960
Ta 238,19,41984
Mvaa 232,200,76
Mvaa 140,204,64
Mvaa 172,204,68
Ta 240,20,40960
Ta 242,20,41984
Mvaa 204,204,72
Mvaa 236,204,76
Mvaa 144,208,64
s_waitcnt lgkmcnt(6)
Ta 244,21,40960
Ta 246,21,41984
Mvaa 176,208,68
buffer_store_dwordx4 v[124:127], v2, s[24:27], s59 offen offset:1024 sc1
Mvaa 208,208,72
buffer_load_dwordx4 a[24:27], v11, s[20:23], s58 offen offset:1024 sc1
Mvaa 240,208,76
Ta 248,22,40960
Ta 250,22,41984
Mvaa 148,212,64
Mvaa 180,212,68
Mvaa 212,212,72
Ta 252,23,40960
Ta 254,23,41984
Mvaa 244,212,76
Mvaa 152,216,64
Mvaa 184,216,68
Mvaa 216,216,72
buffer_load_dwordx4 a[28:31], v11, s[20:23], 0 offen offset:1024 sc1
Mvaa 248,216,76
Mvaa 156,220,64
Mvaa 188,220,68
Mvaa 220,220,72
Mvaa 252,220,76
s_waitcnt vmcnt(40) lgkmcnt(0)
s_barrier
Mvaa 128,224,80
buffer_store_dwordx4 v[24:27], v2, s[24:27], s59 offen offset:2048 sc1
Mvaa 160,224,84
s_add_u32 m0, s44, 32768
Ta 192,16,49152
Ta 194,16,50176
Mvaa 192,224,88
buffer_load_dwordx4 v8, s[8:11], s48 offen offset:0 lds
Mvaa 224,224,92
Mvaa 132,228,80
Ta 196,17,49152
Ta 198,17,50176
Mvaa 164,228,84
buffer_load_dwordx4 v8, s[8:11], s49 offen offset:1024 lds
Mvaa 196,228,88
Mvaa 228,228,92
Ta 200,18,49152
Ta 202,18,50176
Mvaa 136,232,80
Mvaa 168,232,84
buffer_load_dwordx4 v9, s[8:11], s50 offen offset:2048 lds
Mvaa 200,232,88
Ta 204,19,49152
Ta 206,19,50176
Mvaa 232,232,92
Mvaa 140,236,80
Mvaa 172,236,84
Ta 208,20,49152
Ta 210,20,50176
Mvaa 204,236,88
buffer_load_dwordx4 v9, s[8:11], s51 offen offset:3072 lds
v_add_u32 v8, 524288, v8
v_add_u32 v9, 524288, v9
Mvaa 236,236,92
Mvaa 144,240,80
s_waitcnt lgkmcnt(6)
Ta 212,21,49152
Ta 214,21,50176
Mvaa 176,240,84
buffer_store_dwordx4 v[28:31], v2, s[24:27], s59 offen offset:3072 sc1
Mvaa 208,240,88
buffer_load_dwordx4 a[32:35], v10, s[20:23], s58 offen offset:2048 sc1
Mvaa 240,240,92
Ta 216,22,49152
Ta 218,22,50176
Mvaa 148,244,80
Mvaa 180,244,84
Mvaa 212,244,88
Ta 220,23,49152
Ta 222,23,50176
Mvaa 244,244,92
buffer_load_dwordx4 a[36:39], v10, s[20:23], 0 offen offset:2048 sc1
Mvaa 152,248,80
Mvaa 184,248,84
Mvaa 216,248,88
buffer_load_dwordx4 a[40:43], v11, s[20:23], s58 offen offset:2048 sc1
Mvaa 248,248,92
Mvaa 156,252,80
Mvaa 188,252,84
buffer_load_dwordx4 a[44:47], v11, s[20:23], 0 offen offset:2048 sc1
Mvaa 220,252,88
Mvaa 252,252,92
s_waitcnt vmcnt(35) lgkmcnt(0)
Mvaa 128,192,96
s_add_u32 s59, s38, 47104
Mvaa 160,192,100
Ta 224,16,57344
Ta 226,16,58368
Mvaa 192,192,104
buffer_load_dwordx4 a[48:51], v10, s[20:23], s58 offen offset:3072 sc1
Mvaa 224,192,108
buffer_store_dwordx4 v[32:35], v2, s[24:27], s59 offen offset:0 sc1
Mvaa 132,196,96
Ta 228,17,57344
Ta 230,17,58368
Mvaa 164,196,100
Mvaa 196,196,104
Mvaa 228,196,108
Ta 232,18,57344
Ta 234,18,58368
Mvaa 136,200,96
Mvaa 168,200,100
buffer_load_dwordx4 a[52:55], v10, s[20:23], 0 offen offset:3072 sc1
Mvaa 200,200,104
Ta 236,19,57344
Ta 238,19,58368
Mvaa 232,200,108
Mvaa 140,204,96
Mvaa 172,204,100
Ta 240,20,57344
Ta 242,20,58368
Mvaa 204,204,104
Mvaa 236,204,108
Mvaa 144,208,96
s_waitcnt lgkmcnt(6)
Ta 244,21,57344
Ta 246,21,58368
Mvaa 176,208,100
buffer_store_dwordx4 v[36:39], v2, s[24:27], s59 offen offset:1024 sc1
Mvaa 208,208,104
buffer_load_dwordx4 a[56:59], v11, s[20:23], s58 offen offset:3072 sc1
Mvaa 240,208,108
Ta 248,22,57344
Ta 250,22,58368
Mvaa 148,212,96
Mvaa 180,212,100
Mvaa 212,212,104
Ta 252,23,57344
Ta 254,23,58368
Mvaa 244,212,108
Mvaa 152,216,96
Mvaa 184,216,100
Mvaa 216,216,104
buffer_load_dwordx4 a[60:63], v11, s[20:23], 0 offen offset:3072 sc1
v_add_u32 v10, 4096, v10
v_add_u32 v11, 4096, v11
Mvaa 248,216,108
Mvaa 156,220,96
Mvaa 188,220,100
Mvaa 220,220,104
Mvaa 252,220,108
s_waitcnt vmcnt(32) lgkmcnt(0)
s_barrier
Mvaa 128,224,112
buffer_store_dwordx4 v[40:43], v2, s[24:27], s59 offen offset:2048 sc1
Mvaa 160,224,116
s_add_u32 m0, s44, 49152
Ta 192,16,0
Ta 194,16,1024
Mvaa 192,224,120
buffer_load_dwordx4 v8, s[8:11], s48 offen offset:0 lds
Mvaa 224,224,124
Mvaa 132,228,112
Ta 196,17,0
Ta 198,17,1024
Mvaa 164,228,116
buffer_load_dwordx4 v8, s[8:11], s49 offen offset:1024 lds
Mvaa 196,228,120
Mvaa 228,228,124
Ta 200,18,0
Ta 202,18,1024
Mvaa 136,232,112
Mvaa 168,232,116
buffer_load_dwordx4 v9, s[8:11], s50 offen offset:2048 lds
Mvaa 200,232,120
Ta 204,19,0
Ta 206,19,1024
Mvaa 232,232,124
Mvaa 140,236,112
Mvaa 172,236,116
Ta 208,20,0
Ta 210,20,1024
Mvaa 204,236,120
buffer_load_dwordx4 v9, s[8:11], s51 offen offset:3072 lds
v_add_u32 v8, 524288, v8
v_add_u32 v9, 524288, v9
Mvaa 236,236,124
Mvaa 144,240,112
s_waitcnt lgkmcnt(6)
Ta 212,21,0
Ta 214,21,1024
Mvaa 176,240,116
buffer_store_dwordx4 v[44:47], v2, s[24:27], s59 offen offset:3072 sc1
Mvaa 208,240,120
buffer_load_dwordx4 a[64:67], v10, s[20:23], s58 offen offset:0 sc1
Mvaa 240,240,124
Ta 216,22,0
Ta 218,22,1024
Mvaa 148,244,112
v_mov_b32 v12, 1
v_and_b32_e64 v1, 15, v0
Mvaa 180,244,116
v_lshlrev_b32_e64 v1, 2, v1
Mvaa 212,244,120
Ta 220,23,0
Ta 222,23,1024
Mvaa 244,244,124
buffer_load_dwordx4 a[68:71], v10, s[20:23], 0 offen offset:0 sc1
Mvaa 152,248,112
s_lshr_b32 s6, s33, 1
s_lshl_b32 s6, s6, 7
s_add_u32 s6, s6, 5296128
Mvaa 184,248,116
s_cmp_eq_u32 s32, 0
s_cselect_b32 s6, s6, 2146435072
Mvaa 216,248,120
buffer_load_dwordx4 a[72:75], v11, s[20:23], s58 offen offset:0 sc1
Mvaa 248,248,124
Mvaa 156,252,112
Mvaa 188,252,116
buffer_load_dwordx4 a[76:79], v11, s[20:23], 0 offen offset:0 sc1
Mvaa 220,252,120
Mvaa 252,252,124
s_waitcnt vmcnt(32) lgkmcnt(0)
Mvaa 128,192,0
Mvaa 160,192,4
Ta 224,16,8192
Ta 226,16,9216
Mvaa 192,192,8
buffer_load_dwordx4 a[80:83], v10, s[20:23], s58 offen offset:1024 sc1
Mvaa 224,192,12
Mvaa 132,196,0
Ta 228,17,8192
Ta 230,17,9216
Mvaa 164,196,4
Mvaa 196,196,8
Mvaa 228,196,12
Ta 232,18,8192
Ta 234,18,9216
Mvaa 136,200,0
Mvaa 168,200,4
buffer_load_dwordx4 a[84:87], v10, s[20:23], 0 offen offset:1024 sc1
Mvaa 200,200,8
Ta 236,19,8192
Ta 238,19,9216
Mvaa 232,200,12
Mvaa 140,204,0
Mvaa 172,204,4
Ta 240,20,8192
Ta 242,20,9216
Mvaa 204,204,8
Mvaa 236,204,12
Mvaa 144,208,0
s_waitcnt lgkmcnt(6)
Ta 244,21,8192
Ta 246,21,9216
Mvaa 176,208,4
v_max_u32 v14, v56, v57
v_min_u32_e64 v15, v56, v57
Mvaa 208,208,8
buffer_load_dwordx4 a[88:91], v11, s[20:23], s58 offen offset:1024 sc1
Mvaa 240,208,12
Ta 248,22,8192
Ta 250,22,9216
Mvaa 148,212,0
v_med3_u32 v15, v14, v15, v58
v_max_u32_e64 v14, v14, v58
Mvaa 180,212,4
v_med3_u32 v15, v14, v15, v59
v_max_u32_e64 v14, v14, v59
Mvaa 212,212,8
Ta 252,23,8192
Ta 254,23,9216
Mvaa 244,212,12
v_med3_u32 v15, v14, v15, v60
v_max_u32_e64 v14, v14, v60
Mvaa 152,216,0
v_med3_u32 v15, v14, v15, v61
v_max_u32_e64 v14, v14, v61
Mvaa 184,216,4
v_med3_u32 v15, v14, v15, v62
v_max_u32_e64 v14, v14, v62
Mvaa 216,216,8
buffer_load_dwordx4 a[92:95], v11, s[20:23], 0 offen offset:1024 sc1
Mvaa 248,216,12
v_med3_u32 v15, v14, v15, v63
v_max_u32_e64 v14, v14, v63
Mvaa 156,220,0
v_med3_u32 v15, v14, v15, v64
v_max_u32_e64 v14, v14, v64
Mvaa 188,220,4
v_med3_u32 v15, v14, v15, v65
v_max_u32_e64 v14, v14, v65
Mvaa 220,220,8
v_med3_u32 v15, v14, v15, v66
v_max_u32_e64 v14, v14, v66
Mvaa 252,220,12
v_med3_u32 v15, v14, v15, v67
v_max_u32 v14, v14, v67
s_waitcnt vmcnt(30) lgkmcnt(0)
s_barrier
Mvaa 128,224,16
v_med3_u32 v15, v14, v15, v68
v_max_u32 v14, v14, v68
Mvaa 160,224,20
s_add_u32 m0, s44, 0
Ta 192,16,16384
Ta 194,16,17408
Mvaa 192,224,24
buffer_load_dwordx4 v8, s[8:11], s48 offen offset:0 lds
Mvaa 224,224,28
v_med3_u32 v15, v14, v15, v69
v_max_u32 v14, v14, v69
Mvaa 132,228,16
Ta 196,17,16384
Ta 198,17,17408
Mvaa 164,228,20
buffer_load_dwordx4 v8, s[8:11], s49 offen offset:1024 lds
Mvaa 196,228,24
v_med3_u32 v15, v14, v15, v70
v_max_u32_e64 v14, v14, v70
Mvaa 228,228,28
Ta 200,18,16384
Ta 202,18,17408
Mvaa 136,232,16
v_med3_u32 v15, v14, v15, v71
v_max_u32_e64 v14, v14, v71
Mvaa 168,232,20
buffer_load_dwordx4 v9, s[8:11], s50 offen offset:2048 lds
Mvaa 200,232,24
Ta 204,19,16384
Ta 206,19,17408
Mvaa 232,232,28
v_med3_u32 v15, v14, v15, v72
v_max_u32_e64 v14, v14, v72
Mvaa 140,236,16
v_med3_u32 v15, v14, v15, v73
v_max_u32_e64 v14, v14, v73
Mvaa 172,236,20
Ta 208,20,16384
Ta 210,20,17408
Mvaa 204,236,24
buffer_load_dwordx4 v9, s[8:11], s51 offen offset:3072 lds
v_add_u32 v8, 524288, v8
v_add_u32 v9, 524288, v9
Mvaa 236,236,28
v_med3_u32 v15, v14, v15, v74
v_max_u32_e64 v14, v14, v74
Mvaa 144,240,16
s_waitcnt lgkmcnt(6)
Ta 212,21,16384
Ta 214,21,17408
Mvaa 176,240,20
v_med3_u32 v15, v14, v15, v75
v_max_u32 v14, v14, v75
Mvaa 208,240,24
buffer_load_dwordx4 a[96:99], v10, s[20:23], s58 offen offset:2048 sc1
Mvaa 240,240,28
Ta 216,22,16384
Ta 218,22,17408
Mvaa 148,244,16
v_med3_u32 v15, v14, v15, v76
v_max_u32_e64 v14, v14, v76
Mvaa 180,244,20
v_med3_u32 v15, v14, v15, v77
v_max_u32_e64 v14, v14, v77
Mvaa 212,244,24
Ta 220,23,16384
Ta 222,23,17408
Mvaa 244,244,28
buffer_load_dwordx4 a[100:103], v10, s[20:23], 0 offen offset:2048 sc1
Mvaa 152,248,16
v_med3_u32 v15, v14, v15, v78
v_max_u32_e64 v14, v14, v78
Mvaa 184,248,20
v_med3_u32 v15, v14, v15, v79
v_max_u32_e64 v14, v14, v79
Mvaa 216,248,24
buffer_load_dwordx4 a[104:107], v11, s[20:23], s58 offen offset:2048 sc1
Mvaa 248,248,28
v_med3_u32 v15, v14, v15, v80
v_max_u32_e64 v14, v14, v80
Mvaa 156,252,16
v_med3_u32 v15, v14, v15, v81
v_max_u32_e64 v14, v14, v81
Mvaa 188,252,20
buffer_load_dwordx4 a[108:111], v11, s[20:23], 0 offen offset:2048 sc1
Mvaa 220,252,24
v_med3_u32 v15, v14, v15, v82
v_max_u32_e64 v14, v14, v82
Mvaa 252,252,28
v_med3_u32 v15, v14, v15, v83
v_max_u32 v14, v14, v83
s_waitcnt vmcnt(28) lgkmcnt(0)
Mvaa 128,192,32
v_med3_u32 v15, v14, v15, v84
v_max_u32_e64 v14, v14, v84
Mvaa 160,192,36
Ta 224,16,24576
Ta 226,16,25600
Mvaa 192,192,40
buffer_load_dwordx4 a[112:115], v10, s[20:23], s58 offen offset:3072 sc1
Mvaa 224,192,44
v_med3_u32 v15, v14, v15, v85
v_max_u32_e64 v14, v14, v85
Mvaa 132,196,32
Ta 228,17,24576
Ta 230,17,25600
Mvaa 164,196,36
v_med3_u32 v15, v14, v15, v86
v_max_u32_e64 v14, v14, v86
Mvaa 196,196,40
v_med3_u32 v15, v14, v15, v87
v_max_u32_e64 v14, v14, v87
Mvaa 228,196,44
Ta 232,18,24576
Ta 234,18,25600
Mvaa 136,200,32
v_mov_b32_e64 v13, v14
Mvaa 168,200,36
buffer_load_dwordx4 a[116:119], v10, s[20:23], 0 offen offset:3072 sc1
Mvaa 200,200,40
Ta 236,19,24576
Ta 238,19,25600
Mvaa 232,200,44
v_max_u32_dpp v13, v13, v13 quad_perm:[1,0,3,2] row_mask:0xf bank_mask:0xf
Mvaa 140,204,32
s_nop 0
v_max_u32_dpp v13, v13, v13 quad_perm:[2,3,0,1] row_mask:0xf bank_mask:0xf
Mvaa 172,204,36
Ta 240,20,24576
Ta 242,20,25600
Mvaa 204,204,40
v_max_u32_dpp v13, v13, v13 row_half_mirror row_mask:0xf bank_mask:0xf
Mvaa 236,204,44
s_nop 0
v_max_u32_dpp v13, v13, v13 row_mirror row_mask:0xf bank_mask:0xf
Mvaa 144,208,32
s_waitcnt lgkmcnt(6)
Ta 244,21,24576
Ta 246,21,25600
Mvaa 176,208,36
v_readlane_b32 s3, v13, 0
v_readlane_b32 s47, v13, 16
Mvaa 208,208,40
buffer_load_dwordx4 a[120:123], v11, s[20:23], s58 offen offset:3072 sc1
Mvaa 240,208,44
Ta 248,22,24576
Ta 250,22,25600
Mvaa 148,212,32
v_readlane_b32 s4, v13, 32
v_readlane_b32 s5, v13, 48
Mvaa 180,212,36
s_max_u32 s3, s3, s47
s_max_u32 s4, s4, s5
s_max_u32 s40, s3, s4
Mvaa 212,212,40
Ta 252,23,24576
Ta 254,23,25600
Mvaa 244,212,44
v_cmp_eq_u32 vcc, s40, v14
Mvaa 152,216,32
s_nop 0
v_cndmask_b32 v13, v14, v15, vcc
Mvaa 184,216,36
s_nop 0
v_max_u32_dpp v13, v13, v13 quad_perm:[1,0,3,2] row_mask:0xf bank_mask:0xf
Mvaa 216,216,40
buffer_load_dwordx4 a[124:127], v11, s[20:23], 0 offen offset:3072 sc1
v_add_u32 v10, 4096, v10
v_add_u32 v11, 4096, v11
Mvaa 248,216,44
v_max_u32_dpp v13, v13, v13 quad_perm:[2,3,0,1] row_mask:0xf bank_mask:0xf
Mvaa 156,220,32
s_nop 0
v_max_u32_dpp v13, v13, v13 row_half_mirror row_mask:0xf bank_mask:0xf
Mvaa 188,220,36
s_nop 0
v_max_u32_dpp v13, v13, v13 row_mirror row_mask:0xf bank_mask:0xf
Mvaa 220,220,40
v_readlane_b32 s3, v13, 0
v_readlane_b32 s47, v13, 16
Mvaa 252,220,44
v_readlane_b32 s4, v13, 32
v_readlane_b32 s5, v13, 48
s_waitcnt vmcnt(26) lgkmcnt(0)
s_barrier
Mvaa 128,224,48
s_max_u32 s3, s3, s47
s_max_u32 s4, s4, s5
s_max_u32 s41, s3, s4
Mvaa 160,224,52
s_add_u32 m0, s44, 16384
Ta 192,16,32768
Ta 194,16,33792
Mvaa 192,224,56
buffer_load_dwordx4 v8, s[8:11], s48 offen offset:0 lds
Mvaa 224,224,60
s_and_b32 s3, s40, 0xffff
s_sub_u32 s42, 0xffff, s3
s_and_b32 s3, s41, 0xffff
Mvaa 132,228,48
Ta 196,17,32768
Ta 198,17,33792
Mvaa 164,228,52
buffer_load_dwordx4 v8, s[8:11], s49 offen offset:1024 lds
Mvaa 196,228,56
s_sub_u32 s43, 0xffff, s3
v_mov_b32 v60, s40
v_not_b32_e64 v61, v60
Mvaa 228,228,60
Ta 200,18,32768
Ta 202,18,33792
Mvaa 136,232,48
v_ashrrev_i32_e64 v61, 31, v61
v_or_b32 v61, 0x80000000, v61
Mvaa 168,232,52
buffer_load_dwordx4 v9, s[8:11], s50 offen offset:2048 lds
Mvaa 200,232,56
Ta 204,19,32768
Ta 206,19,33792
Mvaa 232,232,60
v_xor_b32_e64 v60, v60, v61
v_and_b32 v60, 0xffff0000, v60
Mvaa 140,236,48
v_mul_f32 v60, 0xbfb8aa3b, v60
Mvaa 172,236,52
Ta 208,20,32768
Ta 210,20,33792
Mvaa 204,236,56
buffer_load_dwordx4 v9, s[8:11], s51 offen offset:3072 lds
v_add_u32 v8, 524288, v8
v_add_u32 v9, 524288, v9
Mvaa 236,236,60
VE 60,60
Mvaa 144,240,48
s_waitcnt lgkmcnt(6)
Ta 212,21,32768
Ta 214,21,33792
Mvaa 176,240,52
v_add_f32 v60, 1.0, v60
Mvaa 208,240,56
buffer_load_dwordx4 a[0:3], v10, s[20:23], s58 offen offset:0 sc1
Mvaa 240,240,60
Ta 216,22,32768
Ta 218,22,33792
Mvaa 148,244,48
v_rcp_f32_e64 v60, v60
Mvaa 180,244,52
Vc 60,60,60
v_and_b32 v64, 0xffff0000, v60
Mvaa 212,244,56
Ta 220,23,32768
Ta 222,23,33792
Mvaa 244,244,60
buffer_load_dwordx4 a[4:7], v10, s[20:23], 0 offen offset:0 sc1
Mvaa 152,248,48
v_mov_b32 v60, s41
v_not_b32 v61, v60
Mvaa 184,248,52
v_ashrrev_i32_e64 v61, 31, v61
v_or_b32 v61, 0x80000000, v61
Mvaa 216,248,56
buffer_load_dwordx4 a[8:11], v11, s[20:23], s58 offen offset:0 sc1
Mvaa 248,248,60
v_xor_b32_e64 v60, v60, v61
v_and_b32 v60, 0xffff0000, v60
Mvaa 156,252,48
v_mul_f32 v60, 0xbfb8aa3b, v60
Mvaa 188,252,52
buffer_load_dwordx4 a[12:15], v11, s[20:23], 0 offen offset:0 sc1
Mvaa 220,252,56
VE 60,60
Mvaa 252,252,60
v_add_f32 v60, 1.0, v60
s_waitcnt vmcnt(24) lgkmcnt(0)
Mvaa 128,192,64
v_rcp_f32_e64 v60, v60
Mvaa 160,192,68
Ta 224,16,40960
Ta 226,16,41984
Mvaa 192,192,72
buffer_load_dwordx4 a[16:19], v10, s[20:23], s58 offen offset:1024 sc1
Mvaa 224,192,76
Vc 60,60,60
v_and_b32 v65, 0xffff0000, v60
Mvaa 132,196,64
Ta 228,17,40960
Ta 230,17,41984
Mvaa 164,196,68
v_mov_b32 v48, 0
v_mov_b32 v49, 0
Mvaa 196,196,72
v_mov_b32 v50, 0
v_mov_b32 v51, 0
Mvaa 228,196,76
Ta 232,18,40960
Ta 234,18,41984
Mvaa 136,200,64
v_mov_b32 v52, 0
v_mov_b32 v53, 0
Mvaa 168,200,68
buffer_load_dwordx4 a[20:23], v10, s[20:23], 0 offen offset:1024 sc1
Mvaa 200,200,72
Ta 236,19,40960
Ta 238,19,41984
Mvaa 232,200,76
v_mov_b32 v54, 0
v_mov_b32 v55, 0
Mvaa 140,204,64
v_mov_b32 v56, 0
v_mov_b32 v57, 0
Mvaa 172,204,68
Ta 240,20,40960
Ta 242,20,41984
Mvaa 204,204,72
v_mov_b32 v58, 0
v_mov_b32 v59, 0
Mvaa 236,204,76
v_mov_b32 v60, 0
v_mov_b32 v61, 0
Mvaa 144,208,64
s_waitcnt lgkmcnt(6)
Ta 244,21,40960
Ta 246,21,41984
Mvaa 176,208,68
v_mov_b32 v62, 0
v_mov_b32_e64 v63, 0
Mvaa 208,208,72
buffer_load_dwordx4 a[24:27], v11, s[20:23], s58 offen offset:1024 sc1
Mvaa 240,208,76
Ta 248,22,40960
Ta 250,22,41984
Mvaa 148,212,64
s_mul_i32 s3, s34, s34
s_mul_i32 s47, s33, 48
s_add_u32 s3, s3, s47
Mvaa 180,212,68
s_lshl_b32 s3, s3, 2
s_add_u32 s3, s3, s32
s_lshl_b32 s3, s3, 7
Mvaa 212,212,72
Ta 252,23,40960
Ta 254,23,41984
Mvaa 244,212,76
s_sub_u32 s3, s3, 8704
s_cmp_ge_u32 s34, 4
s_cselect_b32 s3, s3, 0
s_cselect_b32 s40, 512, 0
s_cselect_b32 s47, 786432, 0
Mvaa 152,216,64
v_subrev_u32_e64 v31, 0, v0
v_mul_lo_u32 v31, v31, s47
Mvaa 184,216,68
v_min_u32 v31, 6553600, v31
v_mov_b32_e64 v28, s94
Mvaa 216,216,72
buffer_load_dwordx4 a[28:31], v11, s[20:23], 0 offen offset:1024 sc1
Mvaa 248,216,76
v_mov_b32 v29, s95
v_mov_b32 v30, v31
Mvaa 156,220,64
v_subrev_u32_e64 v31, 10, v0
v_mul_lo_u32 v31, v31, s47
Mvaa 188,220,68
v_min_u32 v31, 6553600, v31
v_mov_b32_e64 v14, s60
Mvaa 220,220,72
v_mov_b32_e64 v15, s61
Mvaa 252,220,76
v_cmp_le_u32 vcc, 10, v0
s_waitcnt vmcnt(24) lgkmcnt(0)
s_barrier
Mvaa 128,224,80
s_mov_b64 exec, 1
buffer_store_dword v12, v7, s[20:23], s39 offen sc1
s_mov_b64 exec, -1
Mvaa 160,224,84
s_add_u32 m0, s44, 32768
Ta 192,16,49152
Ta 194,16,50176
Mvaa 192,224,88
buffer_load_dwordx4 v8, s[8:11], s48 offen offset:0 lds
Mvaa 224,224,92
v_cndmask_b32 v28, v28, v14, vcc
v_cndmask_b32 v29, v29, v15, vcc
Mvaa 132,228,80
Ta 196,17,49152
Ta 198,17,50176
Mvaa 164,228,84
buffer_load_dwordx4 v8, s[8:11], s49 offen offset:1024 lds
Mvaa 196,228,88
v_cndmask_b32 v30, v30, v31, vcc
Mvaa 228,228,92
Ta 200,18,49152
Ta 202,18,50176
Mvaa 136,232,80
v_subrev_u32_e64 v31, 20, v0
v_mul_lo_u32 v31, v31, s47
Mvaa 168,232,84
buffer_load_dwordx4 v9, s[8:11], s50 offen offset:2048 lds
Mvaa 200,232,88
Ta 204,19,49152
Ta 206,19,50176
Mvaa 232,232,92
v_min_u32 v31, 6553600, v31
v_mov_b32_e64 v14, s68
Mvaa 140,236,80
v_mov_b32_e64 v15, s69
Mvaa 172,236,84
Ta 208,20,49152
Ta 210,20,50176
Mvaa 204,236,88
buffer_load_dwordx4 v9, s[8:11], s51 offen offset:3072 lds
v_add_u32 v8, 524288, v8
v_add_u32 v9, 524288, v9
Mvaa 236,236,92
v_cmp_le_u32 vcc, 20, v0
Mvaa 144,240,80
s_waitcnt lgkmcnt(6)
Ta 212,21,49152
Ta 214,21,50176
Mvaa 176,240,84
v_cndmask_b32 v28, v28, v14, vcc
v_cndmask_b32 v29, v29, v15, vcc
Mvaa 208,240,88
buffer_load_dwordx4 a[32:35], v10, s[20:23], s58 offen offset:2048 sc1
Mvaa 240,240,92
Ta 216,22,49152
Ta 218,22,50176
Mvaa 148,244,80
v_cndmask_b32 v30, v30, v31, vcc
Mvaa 180,244,84
v_subrev_u32 v31, 30, v0
v_mul_lo_u32 v31, v31, s47
Mvaa 212,244,88
Ta 220,23,49152
Ta 222,23,50176
Mvaa 244,244,92
buffer_load_dwordx4 a[36:39], v10, s[20:23], 0 offen offset:2048 sc1
Mvaa 152,248,80
v_min_u32 v31, 7602176, v31
v_mov_b32_e64 v14, s92
Mvaa 184,248,84
v_mov_b32_e64 v15, s93
Mvaa 216,248,88
buffer_load_dwordx4 a[40:43], v11, s[20:23], s58 offen offset:2048 sc1
Mvaa 248,248,92
v_cmp_le_u32 vcc, 30, v0
Mvaa 156,252,80
s_nop 0
v_cndmask_b32 v28, v28, v14, vcc
v_cndmask_b32 v29, v29, v15, vcc
Mvaa 188,252,84
buffer_load_dwordx4 a[44:47], v11, s[20:23], 0 offen offset:2048 sc1
Mvaa 220,252,88
v_cndmask_b32 v30, v30, v31, vcc
Mvaa 252,252,92
v_add_u32 v30, s3, v30
v_ashrrev_i32 v31, 31, v30
s_waitcnt vmcnt(25) lgkmcnt(0)
Mvaa 128,192,96
v_lshl_add_u64 v[28:29], v[30:31], 0, v[28:29]
Mvaa 160,192,100
Ta 224,16,57344
Ta 226,16,58368
Mvaa 192,192,104
buffer_load_dwordx4 a[48:51], v10, s[20:23], s58 offen offset:3072 sc1
Mvaa 224,192,108
s_mov_b32 s41, 0
v_readfirstlane_b32 s100, v64
v_readfirstlane_b32 s101, v65
Mvaa 132,196,96
Ta 228,17,57344
Ta 230,17,58368
Mvaa 164,196,100
s_mov_b32 s24, s60
s_mov_b32 s25, s61
s_mov_b32 s26, s62
Mvaa 196,196,104
s_mov_b32 s94, 1040356334
s_mov_b32 s95, 1040356334
s_sub_u32 s55, 15, s34
Mvaa 228,196,108
Ta 232,18,57344
Ta 234,18,58368
Mvaa 136,200,96
s_sub_u32 s45, s36, 3
s_sub_u32 s46, s35, 3
s_mov_b32 s54, s44
Mvaa 168,200,100
buffer_load_dwordx4 a[52:55], v10, s[20:23], 0 offen offset:3072 sc1
Mvaa 200,200,104
Ta 236,19,57344
Ta 238,19,58368
Mvaa 232,200,108
s_sub_u32 s35, s35, 2
s_sub_u32 s36, s36, 2
Mvaa 140,204,96
Mvaa 172,204,100
Ta 240,20,57344
Ta 242,20,58368
Mvaa 204,204,104
Mvaa 236,204,108
Mvaa 144,208,96
s_waitcnt lgkmcnt(6)
Ta 244,21,57344
Ta 246,21,58368
Mvaa 176,208,100
Mvaa 208,208,104
buffer_load_dwordx4 a[56:59], v11, s[20:23], s58 offen offset:3072 sc1
Mvaa 240,208,108
Ta 248,22,57344
Ta 250,22,58368
Mvaa 148,212,96
Mvaa 180,212,100
Mvaa 212,212,104
Ta 252,23,57344
Ta 254,23,58368
Mvaa 244,212,108
Mvaa 152,216,96
Mvaa 184,216,100
Mvaa 216,216,104
buffer_load_dwordx4 a[60:63], v11, s[20:23], 0 offen offset:3072 sc1
v_add_u32 v10, 4096, v10
v_add_u32 v11, 4096, v11
Mvaa 248,216,108
Mvaa 156,220,96
Mvaa 188,220,100
Mvaa 220,220,104
Mvaa 252,220,108
s_waitcnt vmcnt(25) lgkmcnt(0)
s_barrier
Mvaa 128,224,112
Mvaa 160,224,116
s_add_u32 m0, s44, 49152
Ta 192,16,0
Ta 194,16,1024
Mvaa 192,224,120
buffer_load_dwordx4 v8, s[8:11], s48 offen offset:0 lds
Mvaa 224,224,124
Mvaa 132,228,112
Ta 196,17,0
Ta 198,17,1024
Mvaa 164,228,116
buffer_load_dwordx4 v8, s[8:11], s49 offen offset:1024 lds
Mvaa 196,228,120
Mvaa 228,228,124
Ta 200,18,0
Ta 202,18,1024
Mvaa 136,232,112
Mvaa 168,232,116
buffer_load_dwordx4 v9, s[8:11], s50 offen offset:2048 lds
Mvaa 200,232,120
Ta 204,19,0
Ta 206,19,1024
Mvaa 232,232,124
Mvaa 140,236,112
Mvaa 172,236,116
Ta 208,20,0
Ta 210,20,1024
Mvaa 204,236,120
buffer_load_dwordx4 v9, s[8:11], s51 offen offset:3072 lds
v_add_u32 v8, 524288, v8
v_add_u32 v9, 524288, v9
Mvaa 236,236,124
Mvaa 144,240,112
s_waitcnt lgkmcnt(6)
Ta 212,21,0
Ta 214,21,1024
Mvaa 176,240,116
Mvaa 208,240,120
buffer_load_dwordx4 a[64:67], v10, s[20:23], s58 offen offset:0 sc1
Mvaa 240,240,124
Ta 216,22,0
Ta 218,22,1024
Mvaa 148,244,112
Mvaa 180,244,116
Mvaa 212,244,120
Ta 220,23,0
Ta 222,23,1024
Mvaa 244,244,124
buffer_load_dwordx4 a[68:71], v10, s[20:23], 0 offen offset:0 sc1
Mvaa 152,248,112
Mvaa 184,248,116
Mvaa 216,248,120
buffer_load_dwordx4 a[72:75], v11, s[20:23], s58 offen offset:0 sc1
Mvaa 248,248,124
Mvaa 156,252,112
Mvaa 188,252,116
buffer_load_dwordx4 a[76:79], v11, s[20:23], 0 offen offset:0 sc1
Mvaa 220,252,120
Mvaa 252,252,124
s_waitcnt vmcnt(25) lgkmcnt(0)
Mvaa 128,192,0
Mvaa 160,192,4
Ta 224,16,8192
Ta 226,16,9216
Mvaa 192,192,8
buffer_load_dwordx4 a[80:83], v10, s[20:23], s58 offen offset:1024 sc1
Mvaa 224,192,12
Mvaa 132,196,0
Ta 228,17,8192
Ta 230,17,9216
Mvaa 164,196,4
Mvaa 196,196,8
Mvaa 228,196,12
Ta 232,18,8192
Ta 234,18,9216
Mvaa 136,200,0
Mvaa 168,200,4
buffer_load_dwordx4 a[84:87], v10, s[20:23], 0 offen offset:1024 sc1
Mvaa 200,200,8
Ta 236,19,8192
Ta 238,19,9216
Mvaa 232,200,12
Mvaa 140,204,0
Mvaa 172,204,4
Ta 240,20,8192
Ta 242,20,9216
Mvaa 204,204,8
Mvaa 236,204,12
Mvaa 144,208,0
s_waitcnt lgkmcnt(6)
Ta 244,21,8192
Ta 246,21,9216
Mvaa 176,208,4
Mvaa 208,208,8
buffer_load_dwordx4 a[88:91], v11, s[20:23], s58 offen offset:1024 sc1
Mvaa 240,208,12
Ta 248,22,8192
Ta 250,22,9216
Mvaa 148,212,0
Mvaa 180,212,4
Mvaa 212,212,8
Ta 252,23,8192
Ta 254,23,9216
Mvaa 244,212,12
Mvaa 152,216,0
Mvaa 184,216,4
Mvaa 216,216,8
buffer_load_dwordx4 a[92:95], v11, s[20:23], 0 offen offset:1024 sc1
Mvaa 248,216,12
Mvaa 156,220,0
Mvaa 188,220,4
Mvaa 220,220,8
Mvaa 252,220,12
s_waitcnt vmcnt(25) lgkmcnt(0)
s_barrier
Mvaa 128,224,16
v_accvgpr_write_b32 a0, 0
v_accvgpr_write_b32 a1, 0
Mvaa 160,224,20
Ta 192,16,16384
Ta 194,16,17408
Mvaa 192,224,24
buffer_load_dwordx4 a[96:99], v10, s[20:23], s58 offen offset:2048 sc1
Mvaa 224,224,28
v_accvgpr_write_b32 a2, 0
v_accvgpr_write_b32 a3, 0
Mvaa 132,228,16
Ta 196,17,16384
Ta 198,17,17408
Mvaa 164,228,20
v_accvgpr_write_b32 a4, 0
v_accvgpr_write_b32 a5, 0
Mvaa 196,228,24
v_accvgpr_write_b32 a6, 0
v_accvgpr_write_b32 a7, 0
Mvaa 228,228,28
Ta 200,18,16384
Ta 202,18,17408
Mvaa 136,232,16
v_accvgpr_write_b32 a8, 0
v_accvgpr_write_b32 a9, 0
Mvaa 168,232,20
buffer_load_dwordx4 a[100:103], v10, s[20:23], 0 offen offset:2048 sc1
Mvaa 200,232,24
Ta 204,19,16384
Ta 206,19,17408
Mvaa 232,232,28
v_accvgpr_write_b32 a10, 0
v_accvgpr_write_b32 a11, 0
Mvaa 140,236,16
v_accvgpr_write_b32 a12, 0
v_accvgpr_write_b32 a13, 0
Mvaa 172,236,20
Ta 208,20,16384
Ta 210,20,17408
Mvaa 204,236,24
v_accvgpr_write_b32 a14, 0
v_accvgpr_write_b32 a15, 0
Mvaa 236,236,28
Mvaa 144,240,16
s_waitcnt lgkmcnt(6)
Ta 212,21,16384
Ta 214,21,17408
Mvaa 176,240,20
Mvaa 208,240,24
buffer_load_dwordx4 a[104:107], v11, s[20:23], s58 offen offset:2048 sc1
Mvaa 240,240,28
Ta 216,22,16384
Ta 218,22,17408
Mvaa 148,244,16
Mvaa 180,244,20
Mvaa 212,244,24
Ta 220,23,16384
Ta 222,23,17408
Mvaa 244,244,28
Mvaa 152,248,16
Mvaa 184,248,20
Mvaa 216,248,24
buffer_load_dwordx4 a[108:111], v11, s[20:23], 0 offen offset:2048 sc1
Mvaa 248,248,28
Mvaa 156,252,16
Mvaa 188,252,20
Mvaa 220,252,24
Mvaa 252,252,28
s_waitcnt vmcnt(20) lgkmcnt(0)
Mvaa 128,192,32
v_accvgpr_write_b32 a16, 0
v_accvgpr_write_b32 a17, 0
Mvaa 160,192,36
Ta 224,16,24576
Ta 226,16,25600
Mvaa 192,192,40
buffer_load_dwordx4 a[112:115], v10, s[20:23], s58 offen offset:3072 sc1
Mvaa 224,192,44
v_accvgpr_write_b32 a18, 0
v_accvgpr_write_b32 a19, 0
Mvaa 132,196,32
Ta 228,17,24576
Ta 230,17,25600
Mvaa 164,196,36
v_accvgpr_write_b32 a20, 0
v_accvgpr_write_b32 a21, 0
Mvaa 196,196,40
v_accvgpr_write_b32 a22, 0
v_accvgpr_write_b32 a23, 0
Mvaa 228,196,44
Ta 232,18,24576
Ta 234,18,25600
Mvaa 136,200,32
v_accvgpr_write_b32 a24, 0
v_accvgpr_write_b32 a25, 0
Mvaa 168,200,36
buffer_load_dwordx4 a[116:119], v10, s[20:23], 0 offen offset:3072 sc1
Mvaa 200,200,40
Ta 236,19,24576
Ta 238,19,25600
Mvaa 232,200,44
v_accvgpr_write_b32 a26, 0
v_accvgpr_write_b32 a27, 0
Mvaa 140,204,32
v_accvgpr_write_b32 a28, 0
v_accvgpr_write_b32 a29, 0
Mvaa 172,204,36
Ta 240,20,24576
Ta 242,20,25600
Mvaa 204,204,40
v_accvgpr_write_b32 a30, 0
v_accvgpr_write_b32 a31, 0
Mvaa 236,204,44
Mvaa 144,208,32
s_waitcnt lgkmcnt(6)
Ta 244,21,24576
Ta 246,21,25600
Mvaa 176,208,36
buffer_load_dword v12, v1, s[20:23], s6 offen sc1
Mvaa 208,208,40
buffer_load_dwordx4 a[120:123], v11, s[20:23], s58 offen offset:3072 sc1
Mvaa 240,208,44
Ta 248,22,24576
Ta 250,22,25600
Mvaa 148,212,32
s_add_u32 m0, s44, 65536
s_mov_b32 s7, 0
Mvaa 180,212,36
Mvaa 212,212,40
Ta 252,23,24576
Ta 254,23,25600
Mvaa 244,212,44
Mvaa 152,216,32
Mvaa 184,216,36
Mvaa 216,216,40
buffer_load_dwordx4 a[124:127], v11, s[20:23], 0 offen offset:3072 sc1
v_add_u32 v10, 4096, v10
v_add_u32 v11, 4096, v11
Mvaa 248,216,44
Mvaa 156,220,32
Mvaa 188,220,36
Mvaa 220,220,40
Mvaa 252,220,44
s_waitcnt vmcnt(21) lgkmcnt(0)
s_barrier
Mvaa 128,224,48
v_accvgpr_write_b32 a32, 0
v_accvgpr_write_b32 a33, 0
Mvaa 160,224,52
Ta 192,16,32768
Ta 194,16,33792
Mvaa 192,224,56
v_accvgpr_write_b32 a34, 0
v_accvgpr_write_b32 a35, 0
Mvaa 224,224,60
v_accvgpr_write_b32 a36, 0
v_accvgpr_write_b32 a37, 0
Mvaa 132,228,48
Ta 196,17,32768
Ta 198,17,33792
Mvaa 164,228,52
v_accvgpr_write_b32 a38, 0
v_accvgpr_write_b32 a39, 0
Mvaa 196,228,56
v_accvgpr_write_b32 a40, 0
v_accvgpr_write_b32 a41, 0
Mvaa 228,228,60
Ta 200,18,32768
Ta 202,18,33792
Mvaa 136,232,48
v_accvgpr_write_b32 a42, 0
v_accvgpr_write_b32 a43, 0
Mvaa 168,232,52
v_accvgpr_write_b32 a44, 0
v_accvgpr_write_b32 a45, 0
Mvaa 200,232,56
Ta 204,19,32768
Ta 206,19,33792
Mvaa 232,232,60
v_accvgpr_write_b32 a46, 0
v_accvgpr_write_b32 a47, 0
Mvaa 140,236,48
Mvaa 172,236,52
Ta 208,20,32768
Ta 210,20,33792
Mvaa 204,236,56
Mvaa 236,236,60
Mvaa 144,240,48
s_waitcnt lgkmcnt(6)
Ta 212,21,32768
Ta 214,21,33792
Mvaa 176,240,52
Mvaa 208,240,56
Mvaa 240,240,60
Ta 216,22,32768
Ta 218,22,33792
Mvaa 148,244,48
Mvaa 180,244,52
Mvaa 212,244,56
Ta 220,23,32768
Ta 222,23,33792
Mvaa 244,244,60
Mvaa 152,248,48
Mvaa 184,248,52
Mvaa 216,248,56
Mvaa 248,248,60
Mvaa 156,252,48
Mvaa 188,252,52
Mvaa 220,252,56
Mvaa 252,252,60
s_waitcnt vmcnt(13) lgkmcnt(0)
Mvaa 128,192,64
v_accvgpr_write_b32 a48, 0
v_accvgpr_write_b32 a49, 0
Mvaa 160,192,68
Ta 224,16,40960
Ta 226,16,41984
Mvaa 192,192,72
v_accvgpr_write_b32 a50, 0
v_accvgpr_write_b32 a51, 0
Mvaa 224,192,76
v_accvgpr_write_b32 a52, 0
v_accvgpr_write_b32 a53, 0
Mvaa 132,196,64
Ta 228,17,40960
Ta 230,17,41984
Mvaa 164,196,68
v_accvgpr_write_b32 a54, 0
v_accvgpr_write_b32 a55, 0
Mvaa 196,196,72
v_accvgpr_write_b32 a56, 0
v_accvgpr_write_b32 a57, 0
Mvaa 228,196,76
Ta 232,18,40960
Ta 234,18,41984
Mvaa 136,200,64
v_accvgpr_write_b32 a58, 0
v_accvgpr_write_b32 a59, 0
Mvaa 168,200,68
v_accvgpr_write_b32 a60, 0
v_accvgpr_write_b32 a61, 0
Mvaa 200,200,72
Ta 236,19,40960
Ta 238,19,41984
Mvaa 232,200,76
v_accvgpr_write_b32 a62, 0
v_accvgpr_write_b32 a63, 0
Mvaa 140,204,64
Mvaa 172,204,68
Ta 240,20,40960
Ta 242,20,41984
Mvaa 204,204,72
Mvaa 236,204,76
Mvaa 144,208,64
s_waitcnt lgkmcnt(6)
Ta 244,21,40960
Ta 246,21,41984
Mvaa 176,208,68
Mvaa 208,208,72
Mvaa 240,208,76
Ta 248,22,40960
Ta 250,22,41984
Mvaa 148,212,64
Mvaa 180,212,68
Mvaa 212,212,72
Ta 252,23,40960
Ta 254,23,41984
Mvaa 244,212,76
Mvaa 152,216,64
Mvaa 184,216,68
Mvaa 216,216,72
Mvaa 248,216,76
Mvaa 156,220,64
Mvaa 188,220,68
Mvaa 220,220,72
Mvaa 252,220,76
s_waitcnt vmcnt(2) lgkmcnt(0)
s_cmp_lg_u32 s32, 0
s_cbranch_scc1 L_spinBr
v_cmp_ne_u32 vcc, 1, v12
s_cbranch_vccnz L_spinB
L_spinBr:
s_barrier
Mvaa 128,224,80
buffer_load_dwordx4 v4, s[12:15], s7 offen offset:0 sc1 lds
Mvaa 160,224,84
Ta 192,16,49152
Ta 194,16,50176
Mvaa 192,224,88
v_accvgpr_write_b32 a64, 0
v_accvgpr_write_b32 a65, 0
Mvaa 224,224,92
buffer_load_dwordx4 v4, s[12:15], s7 offen offset:1024 sc1 lds
Mvaa 132,228,80
Ta 196,17,49152
Ta 198,17,50176
Mvaa 164,228,84
v_accvgpr_write_b32 a66, 0
v_accvgpr_write_b32 a67, 0
Mvaa 196,228,88
buffer_load_dwordx4 v4, s[12:15], s7 offen offset:2048 sc1 lds
Mvaa 228,228,92
Ta 200,18,49152
Ta 202,18,50176
Mvaa 136,232,80
v_accvgpr_write_b32 a68, 0
v_accvgpr_write_b32 a69, 0
Mvaa 168,232,84
buffer_load_dwordx4 v4, s[12:15], s7 offen offset:3072 sc1 lds
Mvaa 200,232,88
Ta 204,19,49152
Ta 206,19,50176
Mvaa 232,232,92
s_add_u32 m0, s44, 98304
s_mov_b32 s7, 34816
Mvaa 140,236,80
buffer_load_dwordx4 v4, s[12:15], s7 offen offset:0 sc1 lds
Mvaa 172,236,84
Ta 208,20,49152
Ta 210,20,50176
Mvaa 204,236,88
v_accvgpr_write_b32 a70, 0
v_accvgpr_write_b32 a71, 0
Mvaa 236,236,92
buffer_load_dwordx4 v4, s[12:15], s7 offen offset:1024 sc1 lds
Mvaa 144,240,80
s_waitcnt lgkmcnt(6)
Ta 212,21,49152
Ta 214,21,50176
Mvaa 176,240,84
v_accvgpr_write_b32 a72, 0
v_accvgpr_write_b32 a73, 0
Mvaa 208,240,88
buffer_load_dwordx4 v4, s[12:15], s7 offen offset:2048 sc1 lds
Mvaa 240,240,92
Ta 216,22,49152
Ta 218,22,50176
Mvaa 148,244,80
v_accvgpr_write_b32 a74, 0
v_accvgpr_write_b32 a75, 0
Mvaa 180,244,84
buffer_load_dwordx4 v4, s[12:15], s7 offen offset:3072 sc1 lds
Mvaa 212,244,88
Ta 220,23,49152
Ta 222,23,50176
Mvaa 244,244,92
s_add_u32 m0, s44, 81920
s_mov_b32 s7, 17408
Mvaa 152,248,80
buffer_load_dwordx4 v4, s[12:15], s7 offen offset:0 sc1 lds
Mvaa 184,248,84
v_accvgpr_write_b32 a76, 0
v_accvgpr_write_b32 a77, 0
Mvaa 216,248,88
buffer_load_dwordx4 v4, s[12:15], s7 offen offset:1024 sc1 lds
Mvaa 248,248,92
v_accvgpr_write_b32 a78, 0
v_accvgpr_write_b32 a79, 0
Mvaa 156,252,80
Mvaa 188,252,84
buffer_load_dwordx4 v4, s[12:15], s7 offen offset:2048 sc1 lds
Mvaa 220,252,88
Mvaa 252,252,92
s_waitcnt lgkmcnt(0)
Mvaa 128,192,96
buffer_load_dwordx4 v4, s[12:15], s7 offen offset:3072 sc1 lds
Mvaa 160,192,100
Ta 224,16,57344
Ta 226,16,58368
Mvaa 192,192,104
s_add_u32 m0, s44, 114688
s_mov_b32 s7, 52224
Mvaa 224,192,108
buffer_load_dwordx4 v4, s[12:15], s7 offen offset:0 sc1 lds
Mvaa 132,196,96
Ta 228,17,57344
Ta 230,17,58368
Mvaa 164,196,100
v_accvgpr_write_b32 a80, 0
v_accvgpr_write_b32 a81, 0
Mvaa 196,196,104
buffer_load_dwordx4 v4, s[12:15], s7 offen offset:1024 sc1 lds
Mvaa 228,196,108
Ta 232,18,57344
Ta 234,18,58368
Mvaa 136,200,96
v_accvgpr_write_b32 a82, 0
v_accvgpr_write_b32 a83, 0
Mvaa 168,200,100
buffer_load_dwordx4 v4, s[12:15], s7 offen offset:2048 sc1 lds
Mvaa 200,200,104
Ta 236,19,57344
Ta 238,19,58368
Mvaa 232,200,108
v_accvgpr_write_b32 a84, 0
v_accvgpr_write_b32 a85, 0
Mvaa 140,204,96
buffer_load_dwordx4 v4, s[12:15], s7 offen offset:3072 sc1 lds
Mvaa 172,204,100
Ta 240,20,57344
Ta 242,20,58368
Mvaa 204,204,104
s_add_u32 m0, s44, 0
s_mov_b32 s7, 69632
Mvaa 236,204,108
buffer_load_dwordx4 v4, s[12:15], s7 offen offset:0 sc1 lds
Mvaa 144,208,96
s_waitcnt lgkmcnt(6)
Ta 244,21,57344
Ta 246,21,58368
Mvaa 176,208,100
buffer_load_dwordx4 v4, s[12:15], s7 offen offset:1024 sc1 lds
Mvaa 208,208,104
v_accvgpr_write_b32 a86, 0
v_accvgpr_write_b32 a87, 0
Mvaa 240,208,108
Ta 248,22,57344
Ta 250,22,58368
Mvaa 148,212,96
buffer_load_dwordx4 v4, s[12:15], s7 offen offset:2048 sc1 lds
Mvaa 180,212,100
v_accvgpr_write_b32 a88, 0
v_accvgpr_write_b32 a89, 0
Mvaa 212,212,104
Ta 252,23,57344
Ta 254,23,58368
Mvaa 244,212,108
buffer_load_dwordx4 v4, s[12:15], s7 offen offset:3072 sc1 lds
Mvaa 152,216,96
s_add_u32 m0, s44, 16384
s_mov_b32 s7, 87040
Mvaa 184,216,100
v_accvgpr_write_b32 a90, 0
v_accvgpr_write_b32 a91, 0
Mvaa 216,216,104
buffer_load_dwordx4 v4, s[12:15], s7 offen offset:0 sc1 lds
Mvaa 248,216,108
v_accvgpr_write_b32 a92, 0
v_accvgpr_write_b32 a93, 0
Mvaa 156,220,96
v_accvgpr_write_b32 a94, 0
v_accvgpr_write_b32 a95, 0
Mvaa 188,220,100
buffer_load_dwordx4 v4, s[12:15], s7 offen offset:1024 sc1 lds
Mvaa 220,220,104
Mvaa 252,220,108
s_waitcnt vmcnt(18) lgkmcnt(0)
s_barrier
Mvaa 128,224,112
buffer_load_dwordx4 v4, s[12:15], s7 offen offset:2048 sc1 lds
Mvaa 132,228,112
Ra 192,3,0
Ra 196,3,1024
Mvaa 136,232,112
Ra 200,3,2048
Ra 204,3,3072
Mvaa 140,236,112
buffer_load_dwordx4 v4, s[12:15], s7 offen offset:3072 sc1 lds
Mvaa 144,240,112
s_add_u32 m0, s44, 32768
s_mov_b32 s7, 104448
Mvaa 148,244,112
Ra 208,3,4096
Ra 212,3,5120
Mvaa 152,248,112
buffer_load_dwordx4 v4, s[12:15], s7 offen offset:0 sc1 lds
Mvaa 156,252,112
Ra 216,3,6144
Ra 220,3,7168
Mvaa 160,224,116
buffer_load_dwordx4 v4, s[12:15], s7 offen offset:1024 sc1 lds
Mvaa 164,228,116
Mvaa 168,232,116
Mvaa 172,236,116
buffer_load_dwordx4 v4, s[12:15], s7 offen offset:2048 sc1 lds
Mvaa 176,240,116
v_mul_f32 v128, s94, v128
v_mul_f32_e64 v129, s94, v129
Mvaa 180,244,116
v_mul_f32 v130, s94, v130
v_mul_f32 v131, s94, v131
Mvaa 184,248,116
buffer_load_dwordx4 v4, s[12:15], s7 offen offset:3072 sc1 lds
Mvaa 188,252,116
v_mul_f32 v132, s94, v132
v_mul_f32 v133, s94, v133
Mvaa 192,224,120
v_mul_f32 v134, s94, v134
v_mul_f32 v135, s94, v135
Mvaa 196,228,120
Vc 128,128,129
Vc 129,130,131
Mvaa 200,232,120
Vc 130,132,133
Vc 131,134,135
Mvaa 204,236,120
Aw 128,128
Aw 129,129
Mvaa 208,240,120
Aw 130,130
Aw 131,131
Mvaa 212,244,120
v_mul_f32 v136, s94, v136
v_mul_f32 v137, s94, v137
Mvaa 216,248,120
v_mul_f32 v138, s94, v138
v_mul_f32 v139, s94, v139
Mvaa 220,252,120
v_mul_f32 v140, s94, v140
v_mul_f32 v141, s94, v141
Mvaa 224,224,124
v_mul_f32 v142, s94, v142
v_mul_f32 v143, s94, v143
Mvaa 228,228,124
Vc 136,136,137
Vc 137,138,139
Mvaa 232,232,124
Vc 138,140,141
Vc 139,142,143
Mvaa 236,236,124
Aw 132,136
Aw 133,137
Mvaa 240,240,124
Aw 134,138
Aw 135,139
Mvaa 244,244,124
v_mul_f32 v144, s94, v144
v_mul_f32 v145, s94, v145
Mvaa 248,248,124
v_mul_f32 v146, s94, v146
v_mul_f32 v147, s94, v147
Mvaa 252,252,124
v_mul_f32 v148, s94, v148
v_mul_f32 v149, s94, v149
Ra 224,3,8192
Ra 228,3,9216
Ra 232,3,10240
Ra 236,3,11264
Ra 240,3,12288
Ra 244,3,13312
Ra 248,3,14336
s_waitcnt lgkmcnt(9)
Ra 252,3,15360
v_mul_f32 v150, s94, v150
v_mul_f32_e64 v151, s94, v151
Vc 144,144,145
Vc 145,146,147
Vc 146,148,149
Vc 147,150,151
Aw 136,144
Aw 137,145
Aw 138,146
Aw 139,147
v_mul_f32 v152, s94, v152
v_mul_f32 v153, s94, v153
v_mul_f32 v154, s94, v154
v_mul_f32 v155, s94, v155
v_mul_f32 v156, s94, v156
v_mul_f32 v157, s94, v157
v_mul_f32 v158, s94, v158
v_mul_f32 v159, s94, v159
Vc 152,152,153
Vc 153,154,155
Vc 154,156,157
Vc 155,158,159
Aw 140,152
Aw 141,153
Aw 142,154
Aw 143,155
Zvaa 128,192,128
v_mul_f32 v160, s94, v160
v_mul_f32 v161, s94, v161
v_mul_f32 v162, s94, v162
v_mul_f32 v163, s94, v163
Mvaa 128,196,132
v_mul_f32 v164, s94, v164
v_mul_f32 v165, s94, v165
v_mul_f32 v166, s94, v166
v_mul_f32 v167, s94, v167
Mvaa 128,200,136
Vc 160,160,161
Vc 161,162,163
Vc 162,164,165
Vc 163,166,167
Mvaa 128,204,140
Aw 144,160
Aw 145,161
Aw 146,162
Aw 147,163
s_waitcnt lgkmcnt(8)
Zvaa 132,208,128
v_mul_f32 v168, s94, v168
v_mul_f32 v169, s94, v169
v_mul_f32 v170, s94, v170
v_mul_f32_e64 v171, s94, v171
Mvaa 132,212,132
v_mul_f32 v172, s94, v172
v_mul_f32 v173, s94, v173
v_mul_f32 v174, s94, v174
v_mul_f32 v175, s94, v175
Mvaa 132,216,136
Vc 168,168,169
Vc 169,170,171
Vc 170,172,173
Vc 171,174,175
Mvaa 132,220,140
Aw 148,168
Aw 149,169
Aw 150,170
Aw 151,171
s_waitcnt lgkmcnt(4)
Zvaa 136,224,128
v_mul_f32 v176, s94, v176
v_mul_f32 v177, s94, v177
v_mul_f32 v178, s94, v178
v_mul_f32_e64 v179, s94, v179
Mvaa 136,228,132
v_mul_f32 v180, s94, v180
v_mul_f32 v181, s94, v181
v_mul_f32 v182, s94, v182
v_mul_f32 v183, s94, v183
Mvaa 136,232,136
Vc 176,176,177
Vc 177,178,179
Vc 178,180,181
Vc 179,182,183
Mvaa 136,236,140
Aw 152,176
Aw 153,177
Aw 154,178
Aw 155,179
s_waitcnt lgkmcnt(0)
Zvaa 140,240,128
v_mul_f32 v184, s94, v184
v_mul_f32 v185, s94, v185
v_mul_f32 v186, s94, v186
v_mul_f32_e64 v187, s94, v187
Mvaa 140,244,132
v_mul_f32 v188, s94, v188
v_mul_f32 v189, s94, v189
v_mul_f32 v190, s94, v190
v_mul_f32 v191, s94, v191
Mvaa 140,248,136
Vc 184,184,185
Vc 185,186,187
Vc 186,188,189
Vc 187,190,191
Mvaa 140,252,140
Aw 156,184
Aw 157,185
Aw 158,186
Aw 159,187
Zvaa 144,192,144
v_mul_f32 v192, s94, v192
v_mul_f32 v193, s94, v193
v_mul_f32 v194, s94, v194
v_mul_f32 v195, s94, v195
Mvaa 144,196,148
v_mul_f32 v196, s94, v196
v_mul_f32 v197, s94, v197
v_mul_f32 v198, s94, v198
v_mul_f32 v199, s94, v199
Mvaa 144,200,152
Vc 192,192,193
Vc 193,194,195
Vc 194,196,197
Vc 195,198,199
Mvaa 144,204,156
Aw 160,192
Aw 161,193
Aw 162,194
Aw 163,195
Zvaa 148,208,144
v_mul_f32 v200, s94, v200
v_mul_f32 v201, s94, v201
v_mul_f32 v202, s94, v202
v_mul_f32 v203, s94, v203
Mvaa 148,212,148
v_mul_f32 v204, s94, v204
v_mul_f32 v205, s94, v205
v_mul_f32 v206, s94, v206
v_mul_f32 v207, s94, v207
Mvaa 148,216,152
Vc 200,200,201
Vc 201,202,203
Vc 202,204,205
Vc 203,206,207
Mvaa 148,220,156
Aw 164,200
Aw 165,201
Aw 166,202
Aw 167,203
Zvaa 152,224,144
v_mul_f32 v208, s94, v208
v_mul_f32 v209, s94, v209
v_mul_f32 v210, s94, v210
v_mul_f32 v211, s94, v211
Mvaa 152,228,148
v_mul_f32 v212, s94, v212
v_mul_f32 v213, s94, v213
v_mul_f32 v214, s94, v214
v_mul_f32 v215, s94, v215
Mvaa 152,232,152
Vc 208,208,209
Vc 209,210,211
Vc 210,212,213
Vc 211,214,215
Mvaa 152,236,156
Aw 168,208
Aw 169,209
Aw 170,210
Aw 171,211
Zvaa 156,240,144
v_mul_f32 v216, s94, v216
v_mul_f32 v217, s94, v217
v_mul_f32 v218, s94, v218
v_mul_f32 v219, s94, v219
Mvaa 156,244,148
v_mul_f32 v220, s94, v220
v_mul_f32 v221, s94, v221
v_mul_f32 v222, s94, v222
v_mul_f32 v223, s94, v223
Mvaa 156,248,152
Vc 216,216,217
Vc 217,218,219
Vc 218,220,221
Vc 219,222,223
Mvaa 156,252,156
Aw 172,216
Aw 173,217
Aw 174,218
Aw 175,219
Zvaa 160,192,160
v_mul_f32 v224, s94, v224
v_mul_f32 v225, s94, v225
v_mul_f32 v226, s94, v226
v_mul_f32 v227, s94, v227
Mvaa 160,196,164
v_mul_f32 v228, s94, v228
v_mul_f32 v229, s94, v229
v_mul_f32 v230, s94, v230
v_mul_f32 v231, s94, v231
Mvaa 160,200,168
Vc 224,224,225
Vc 225,226,227
Vc 226,228,229
Vc 227,230,231
Mvaa 160,204,172
Aw 176,224
Aw 177,225
Aw 178,226
Aw 179,227
Zvaa 164,208,160
v_mul_f32 v232, s94, v232
v_mul_f32 v233, s94, v233
v_mul_f32 v234, s94, v234
v_mul_f32 v235, s94, v235
Mvaa 164,212,164
v_mul_f32 v236, s94, v236
v_mul_f32 v237, s94, v237
v_mul_f32 v238, s94, v238
v_mul_f32 v239, s94, v239
Mvaa 164,216,168
Vc 232,232,233
Vc 233,234,235
Vc 234,236,237
Vc 235,238,239
Mvaa 164,220,172
Aw 180,232
Aw 181,233
Aw 182,234
Aw 183,235
Zvaa 168,224,160
v_mul_f32 v240, s94, v240
v_mul_f32 v241, s94, v241
v_mul_f32 v242, s94, v242
v_mul_f32 v243, s94, v243
Mvaa 168,228,164
v_mul_f32 v244, s94, v244
v_mul_f32 v245, s94, v245
v_mul_f32 v246, s94, v246
v_mul_f32 v247, s94, v247
Mvaa 168,232,168
Vc 240,240,241
Vc 241,242,243
Vc 242,244,245
Vc 243,246,247
Mvaa 168,236,172
Aw 184,240
Aw 185,241
Aw 186,242
Aw 187,243
Zvaa 172,240,160
v_mul_f32 v248, s94, v248
v_mul_f32 v249, s94, v249
v_mul_f32 v250, s94, v250
v_mul_f32 v251, s94, v251
Mvaa 172,244,164
v_mul_f32 v252, s94, v252
v_mul_f32 v253, s94, v253
v_mul_f32 v254, s94, v254
v_mul_f32 v255, s94, v255
Mvaa 172,248,168
Vc 248,248,249
Vc 249,250,251
Vc 250,252,253
Vc 251,254,255
Mvaa 172,252,172
Aw 188,248
Aw 189,249
Aw 190,250
Aw 191,251
Zvaa 176,192,176
v_accvgpr_write_b32 a96, 0
v_accvgpr_write_b32 a97, 0
v_accvgpr_write_b32 a98, 0
v_accvgpr_write_b32 a99, 0
Mvaa 176,196,180
v_accvgpr_write_b32 a100, 0
v_accvgpr_write_b32 a101, 0
v_accvgpr_write_b32 a102, 0
v_accvgpr_write_b32 a103, 0
Mvaa 176,200,184
v_accvgpr_write_b32 a104, 0
v_accvgpr_write_b32 a105, 0
v_accvgpr_write_b32 a106, 0
v_accvgpr_write_b32 a107, 0
Mvaa 176,204,188
v_accvgpr_write_b32 a108, 0
v_accvgpr_write_b32 a109, 0
v_accvgpr_write_b32 a110, 0
v_accvgpr_write_b32 a111, 0
Zvaa 180,208,176
v_accvgpr_write_b32 a112, 0
v_accvgpr_write_b32 a113, 0
v_accvgpr_write_b32 a114, 0
v_accvgpr_write_b32 a115, 0
Mvaa 180,212,180
v_accvgpr_write_b32 a116, 0
v_accvgpr_write_b32 a117, 0
v_accvgpr_write_b32 a118, 0
v_accvgpr_write_b32 a119, 0
Mvaa 180,216,184
v_accvgpr_write_b32 a120, 0
v_accvgpr_write_b32 a121, 0
v_accvgpr_write_b32 a122, 0
v_accvgpr_write_b32 a123, 0
Mvaa 180,220,188
v_accvgpr_write_b32 a124, 0
v_accvgpr_write_b32 a125, 0
v_accvgpr_write_b32 a126, 0
v_accvgpr_write_b32 a127, 0
s_waitcnt vmcnt(16)
s_barrier
s_add_u32 s53, s44, 65536
Zvaa 184,224,176
Ra 192,3,32768
v_mov_b32 v16, 0x3f803f80
v_mov_b32 v17, 0x3f803f80
v_mov_b32 v18, 0x3f803f80
v_mov_b32 v19, 0x3f803f80
Mvaa 184,228,180
Ra 196,3,33792
v_mov_b32 v20, 0xff800000
v_max3_f32 v22, v128, v129, v130
v_max3_f32 v22, v22, v131, v132
v_max3_f32 v22, v22, v133, v134
Mvaa 184,232,184
Ra 200,3,34816
v_max3_f32 v22, v22, v135, v136
v_max3_f32 v22, v22, v137, v138
v_max3_f32 v22, v22, v139, v140
v_max3_f32 v22, v22, v141, v142
Mvaa 184,236,188
Ra 204,3,35840
v_max_f32 v22, v22, v143
v_mov_b32 v1, v22
s_nop 1
v_permlane16_swap_b32 v1, v22
v_max_f32_e64 v22, v22, v1
Zvaa 188,240,176
Ra 208,3,36864
v_mov_b32 v1, v22
s_nop 1
v_permlane32_swap_b32 v1, v22
v_max_f32 v22, v22, v1
v_add_f32 v22, 0x41f80000, v22
Mvaa 188,244,180
Ra 212,3,37888
Vs 128,128,22
Vs 129,129,22
Vs 130,130,22
Vs 131,131,22
Mvaa 188,248,184
Ra 216,3,38912
Vs 132,132,22
Vs 133,133,22
Vs 134,134,22
Vs 135,135,22
Mvaa 188,252,188
Ra 220,3,39936
Vs 136,136,22
Vs 137,137,22
Vs 138,138,22
Vs 139,139,22
Vs 140,140,22
Vs 141,141,22
Vs 142,142,22
Vs 143,143,22
v_sub_f32 v32, 0, v22
v_sub_f32 v33, 0, v22
v_sub_f32 v34, 0, v22
v_sub_f32 v35, 0, v22
v_max3_f32 v22, v144, v145, v146
v_max3_f32 v22, v22, v147, v148
v_max3_f32 v22, v22, v149, v150
v_max3_f32 v22, v22, v151, v152
v_max3_f32 v22, v22, v153, v154
v_max3_f32 v22, v22, v155, v156
v_max3_f32 v22, v22, v157, v158
v_max_f32 v22, v22, v159
v_mov_b32 v1, v22
s_nop 1
v_permlane16_swap_b32 v1, v22
v_max_f32 v22, v22, v1
v_mov_b32 v1, v22
s_nop 1
v_permlane32_swap_b32 v1, v22
v_max_f32_e64 v22, v22, v1
v_add_f32 v22, 0x41f80000, v22
Vs 144,144,22
Vs 145,145,22
Vs 146,146,22
Vs 147,147,22
Vs 148,148,22
Vs 149,149,22
Vs 150,150,22
Vs 151,151,22
Vs 152,152,22
Vs 153,153,22
Vs 154,154,22
Vs 155,155,22
Vs 156,156,22
Vs 157,157,22
Vs 158,158,22
Vs 159,159,22
v_sub_f32 v36, 0, v22
v_sub_f32 v37, 0, v22
v_sub_f32 v38, 0, v22
v_sub_f32 v39, 0, v22
s_mov_b32 s38, 139264
s_mov_b32 s39, 121856
s_cmp_lg_u32 s34, 0
s_cbranch_scc1 L_k2_nomask0
v_cmp_gt_i32 s[56:57], 0, v5
v_cmp_gt_i32 s[58:59], 1, v5
v_cmp_gt_i32 s[60:61], 2, v5
v_cmp_gt_i32 s[62:63], 3, v5
s_nop 3
s_nop 0
v_cndmask_b32 v176, v176, v20, s[56:57]
v_cndmask_b32 v177, v177, v20, s[58:59]
v_cndmask_b32 v178, v178, v20, s[60:61]
v_cndmask_b32 v179, v179, v20, s[62:63]
v_cmp_gt_i32 s[56:57], 16, v5
v_cmp_gt_i32 s[58:59], 17, v5
v_cmp_gt_i32 s[60:61], 18, v5
v_cmp_gt_i32 s[62:63], 19, v5
v_cndmask_b32 v180, v180, v20, s[56:57]
v_cndmask_b32 v181, v181, v20, s[58:59]
v_cndmask_b32 v182, v182, v20, s[60:61]
v_cndmask_b32 v183, v183, v20, s[62:63]
v_cmp_gt_i32 s[56:57], 32, v5
v_cmp_gt_i32 s[58:59], 33, v5
v_cmp_gt_i32 s[60:61], 34, v5
v_cmp_gt_i32 s[62:63], 35, v5
v_cndmask_b32 v184, v184, v20, s[56:57]
v_cndmask_b32 v185, v185, v20, s[58:59]
v_cndmask_b32 v186, v186, v20, s[60:61]
v_cndmask_b32 v187, v187, v20, s[62:63]
v_cmp_gt_i32 s[56:57], 48, v5
v_cmp_gt_i32 s[58:59], 49, v5
v_cmp_gt_i32 s[60:61], 50, v5
v_cmp_gt_i32 s[62:63], 51, v5
v_cndmask_b32 v188, v188, v20, s[56:57]
v_cndmask_b32 v189, v189, v20, s[58:59]
v_cndmask_b32 v190, v190, v20, s[60:61]
v_cndmask_b32 v191, v191, v20, s[62:63]
L_k2_nomask0:
s_mov_b32 s37, 0
s_nop 0
v_max3_f32 v22, v160, v161, v162
v_max3_f32 v22, v22, v163, v164
v_max3_f32 v22, v22, v165, v166
v_max3_f32 v22, v22, v167, v168
v_max3_f32 v22, v22, v169, v170
v_max3_f32 v22, v22, v171, v172
v_max3_f32 v22, v22, v173, v174
v_max_f32 v22, v22, v175
v_mov_b32 v1, v22
s_nop 1
v_permlane16_swap_b32 v1, v22
v_max_f32 v22, v22, v1
v_mov_b32 v1, v22
s_nop 1
v_permlane32_swap_b32 v1, v22
v_max_f32_e64 v22, v22, v1
v_add_f32 v22, 0x41f80000, v22
Vs 160,160,22
Vs 161,161,22
Vs 162,162,22
Vs 163,163,22
Vs 164,164,22
Vs 165,165,22
Vs 166,166,22
Vs 167,167,22
Vs 168,168,22
Vs 169,169,22
Vs 170,170,22
Vs 171,171,22
Vs 172,172,22
Vs 173,173,22
Vs 174,174,22
Vs 175,175,22
v_sub_f32 v40, 0, v22
v_sub_f32 v41, 0, v22
v_sub_f32 v42, 0, v22
v_sub_f32 v43, 0, v22
v_max3_f32 v22, v176, v177, v178
v_max3_f32 v22, v22, v179, v180
v_max3_f32 v22, v22, v181, v182
v_max3_f32 v22, v22, v183, v184
v_max3_f32 v22, v22, v185, v186
v_max3_f32 v22, v22, v187, v188
v_max3_f32 v22, v22, v189, v190
v_max_f32 v22, v22, v191
v_mov_b32 v1, v22
s_nop 1
v_permlane16_swap_b32 v1, v22
v_max_f32 v22, v22, v1
v_mov_b32 v1, v22
s_nop 1
v_permlane32_swap_b32 v1, v22
v_max_f32_e64 v22, v22, v1
v_add_f32 v22, 0x41f80000, v22
Vs 176,176,22
Vs 177,177,22
Vs 178,178,22
Vs 179,179,22
Vs 180,180,22
Vs 181,181,22
Vs 182,182,22
Vs 183,183,22
Vs 184,184,22
Vs 185,185,22
Vs 186,186,22
Vs 187,187,22
Vs 188,188,22
Vs 189,189,22
Vs 190,190,22
Vs 191,191,22
v_sub_f32 v44, 0, v22
v_sub_f32 v45, 0, v22
v_sub_f32 v46, 0, v22
v_sub_f32 v47, 0, v22
Ve 8,128
Ve 9,129
Ve 10,130
Ve 11,131
Vc 64,8,9
Ve 12,144
Ve 13,145
Vc 65,10,11
Ve 14,146
Ve 15,147
Vc 72,12,13
Ve 8,160
Ve 9,161
Vc 73,14,15
Ve 10,162
Ve 11,163
Vc 80,8,9
Ve 12,176
Ve 13,177
Vc 81,10,11
Ve 14,178
Ve 15,179
Vc 88,12,13
Ve 8,132
Ve 9,133
Vc 89,14,15
Ve 10,134
Ve 11,135
Vc 66,8,9
Ve 12,148
Ve 13,149
Vc 67,10,11
Ve 14,150
Ve 15,151
Vc 74,12,13
Ve 8,164
Ve 9,165
Vc 75,14,15
Ve 10,166
Ve 11,167
Vc 82,8,9
Ve 12,180
Ve 13,181
Vc 83,10,11
Ve 14,182
Ve 15,183
Vc 90,12,13
Vc 91,14,15
v_or_b32_e64 v7, v64, v65
v_or3_b32 v7, v7, v72, v73
v_or3_b32 v7, v7, v80, v81
v_or3_b32 v7, v7, v88, v89
v_or3_b32 v7, v7, v66, v67
v_or3_b32 v7, v7, v74, v75
v_or3_b32 v7, v7, v82, v83
v_or3_b32 v7, v7, v90, v91
s_waitcnt lgkmcnt(4)
s_cmp_eq_u32 s34, 0
s_cbranch_scc1 L_k2_wlast
s_branch L_k2_wloop
L_k2_mk_wo:
v_cmp_gt_i32 s[56:57], 0, v5
v_cmp_gt_i32 s[58:59], 1, v5
v_cmp_gt_i32 s[60:61], 2, v5
v_cmp_gt_i32 s[62:63], 3, v5
s_nop 3
s_nop 0
v_cndmask_b32 v176, v176, v20, s[56:57]
v_cndmask_b32 v177, v177, v20, s[58:59]
v_cndmask_b32 v178, v178, v20, s[60:61]
v_cndmask_b32 v179, v179, v20, s[62:63]
v_cmp_gt_i32 s[56:57], 16, v5
v_cmp_gt_i32 s[58:59], 17, v5
v_cmp_gt_i32 s[60:61], 18, v5
v_cmp_gt_i32 s[62:63], 19, v5
v_cndmask_b32 v180, v180, v20, s[56:57]
v_cndmask_b32 v181, v181, v20, s[58:59]
v_cndmask_b32 v182, v182, v20, s[60:61]
v_cndmask_b32 v183, v183, v20, s[62:63]
v_cmp_gt_i32 s[56:57], 32, v5
v_cmp_gt_i32 s[58:59], 33, v5
v_cmp_gt_i32 s[60:61], 34, v5
v_cmp_gt_i32 s[62:63], 35, v5
v_cndmask_b32 v184, v184, v20, s[56:57]
v_cndmask_b32 v185, v185, v20, s[58:59]
v_cndmask_b32 v186, v186, v20, s[60:61]
v_cndmask_b32 v187, v187, v20, s[62:63]
v_cmp_gt_i32 s[56:57], 48, v5
v_cmp_gt_i32 s[58:59], 49, v5
v_cmp_gt_i32 s[60:61], 50, v5
v_cmp_gt_i32 s[62:63], 51, v5
v_cndmask_b32 v188, v188, v20, s[56:57]
v_cndmask_b32 v189, v189, v20, s[58:59]
v_cndmask_b32 v190, v190, v20, s[60:61]
v_cndmask_b32 v191, v191, v20, s[62:63]
s_branch L_k2_mkr_wo
L_k2_mk_tr:
v_cmp_gt_i32 s[56:57], 0, v5
v_cmp_gt_i32 s[58:59], 1, v5
v_cmp_gt_i32 s[60:61], 2, v5
v_cmp_gt_i32 s[62:63], 3, v5
s_nop 3
v_cndmask_b32 v144, v144, v20, s[56:57]
v_cndmask_b32 v145, v145, v20, s[58:59]
v_cndmask_b32 v146, v146, v20, s[60:61]
v_cndmask_b32 v147, v147, v20, s[62:63]
v_cmp_gt_i32 s[56:57], 16, v5
v_cmp_gt_i32 s[58:59], 17, v5
v_cmp_gt_i32 s[60:61], 18, v5
v_cmp_gt_i32 s[62:63], 19, v5
v_cndmask_b32 v148, v148, v20, s[56:57]
v_cndmask_b32 v149, v149, v20, s[58:59]
v_cndmask_b32 v150, v150, v20, s[60:61]
v_cndmask_b32 v151, v151, v20, s[62:63]
v_cmp_gt_i32 s[56:57], 32, v5
v_cmp_gt_i32 s[58:59], 33, v5
v_cmp_gt_i32 s[60:61], 34, v5
v_cmp_gt_i32 s[62:63], 35, v5
v_cndmask_b32 v152, v152, v20, s[56:57]
v_cndmask_b32 v153, v153, v20, s[58:59]
v_cndmask_b32 v154, v154, v20, s[60:61]
v_cndmask_b32 v155, v155, v20, s[62:63]
v_cmp_gt_i32 s[56:57], 48, v5
v_cmp_gt_i32 s[58:59], 49, v5
v_cmp_gt_i32 s[60:61], 50, v5
v_cmp_gt_i32 s[62:63], 51, v5
v_cndmask_b32 v156, v156, v20, s[56:57]
v_cndmask_b32 v157, v157, v20, s[58:59]
v_cndmask_b32 v158, v158, v20, s[60:61]
v_cndmask_b32 v159, v159, v20, s[62:63]
s_branch L_k2_mkr_tr
L_k2_mk_no:
v_cmp_gt_i32 s[56:57], 0, v5
v_cmp_gt_i32 s[58:59], 1, v5
v_cmp_gt_i32 s[60:61], 2, v5
v_cmp_gt_i32 s[62:63], 3, v5
s_nop 3
v_cndmask_b32 v144, v144, v20, s[56:57]
v_cndmask_b32 v145, v145, v20, s[58:59]
v_cndmask_b32 v146, v146, v20, s[60:61]
v_cndmask_b32 v147, v147, v20, s[62:63]
v_cmp_gt_i32 s[56:57], 16, v5
v_cmp_gt_i32 s[58:59], 17, v5
v_cmp_gt_i32 s[60:61], 18, v5
v_cmp_gt_i32 s[62:63], 19, v5
v_cndmask_b32 v148, v148, v20, s[56:57]
v_cndmask_b32 v149, v149, v20, s[58:59]
v_cndmask_b32 v150, v150, v20, s[60:61]
v_cndmask_b32 v151, v151, v20, s[62:63]
v_cmp_gt_i32 s[56:57], 32, v5
v_cmp_gt_i32 s[58:59], 33, v5
v_cmp_gt_i32 s[60:61], 34, v5
v_cmp_gt_i32 s[62:63], 35, v5
v_cndmask_b32 v152, v152, v20, s[56:57]
v_cndmask_b32 v153, v153, v20, s[58:59]
v_cndmask_b32 v154, v154, v20, s[60:61]
v_cndmask_b32 v155, v155, v20, s[62:63]
v_cmp_gt_i32 s[56:57], 48, v5
v_cmp_gt_i32 s[58:59], 49, v5
v_cmp_gt_i32 s[60:61], 50, v5
v_cmp_gt_i32 s[62:63], 51, v5
v_cndmask_b32 v156, v156, v20, s[56:57]
v_cndmask_b32 v157, v157, v20, s[58:59]
v_cndmask_b32 v158, v158, v20, s[60:61]
v_cndmask_b32 v159, v159, v20, s[62:63]
s_branch L_k2_mkr_no
L_pubB:
v_mov_b32 v24, 1
v_mov_b32 v25, 0
s_mov_b64 exec, 1
buffer_store_dword v24, v25, s[20:23], s64 offen sc1
s_mov_b64 exec, -1
s_branch L_pubBr
L_k2_wloop:
v_xor_b32 v2, 65536, v2
v_xor_b32 v3, 65536, v3
Cvaa 192,192,128,32
s_mov_b32 m0, s53
Ra 224,2,40960
v_lshl_add_u64 v[28:29], s[40:41], 0, v[28:29]
Mvaa 192,196,132
buffer_load_dwordx4 v4, s[12:15], s38 offen offset:0 sc1 lds
Mvaa 192,200,136
Ve 8,136
Mvaa 192,204,140
VE 9,137
Cvaa 208,192,144,36
Ra 228,2,41984
Vc 68,8,9
Mvaa 208,196,148
VE 10,138
Mvaa 208,200,152
VE 11,139
Mvaa 208,204,156
Ra 232,2,43008
Vc 69,10,11
Cvaa 224,192,160,40
Ra 236,2,44032
v_or3_b32 v7, v7, v68, v69
Mvaa 224,196,164
VE 12,152
Mvaa 224,200,168
VE 13,153
Mvaa 224,204,172
Ra 240,2,45056
Vc 76,12,13
Cvaa 240,192,176,44
VE 14,154
Mvaa 240,196,180
VE 15,155
Mvaa 240,200,184
Ra 244,2,46080
Vc 77,14,15
Mvaa 240,204,188
s_waitcnt lgkmcnt(6)
Ra 248,2,47104
v_or3_b32 v7, v7, v76, v77
Cvaa 196,208,128,32
buffer_load_dwordx4 v4, s[12:15], s38 offen offset:1024 sc1 lds
Mvaa 196,212,132
Ve 8,168
Mvaa 196,216,136
VE 9,169
Mvaa 196,220,140
Ra 252,2,48128
Vc 84,8,9
Cvaa 212,208,144,36
VE 10,170
Mvaa 212,212,148
VE 11,171
Mvaa 212,216,152
Ra 192,2,16384
Vc 85,10,11
Mvaa 212,220,156
Ra 196,2,24576
v_or3_b32 v7, v7, v84, v85
Cvaa 228,208,160,40
VE 12,184
Mvaa 228,212,164
VE 13,185
Mvaa 228,216,168
Ra 200,2,17408
Vc 92,12,13
Mvaa 228,220,172
VE 14,186
Cvaa 244,208,176,44
VE 15,187
Mvaa 244,212,180
buffer_load_dwordx4 v4, s[12:15], s38 offen offset:2048 sc1 lds
Mvaa 244,216,184
Ra 204,2,25600
Vc 93,14,15
Mvaa 244,220,188
s_waitcnt lgkmcnt(8)
Ve 8,140
Cvaa 200,224,128,32
Ra 208,2,18432
v_or3_b32 v7, v7, v92, v93
Mvaa 200,228,132
VE 9,141
Mvaa 200,232,136
Ra 212,2,26624
Vc 70,8,9
Mvaa 200,236,140
VE 10,142
Cvaa 216,224,144,36
VE 11,143
Mvaa 216,228,148
Ra 216,2,19456
Vc 71,10,11
Mvaa 216,232,152
Ra 220,2,27648
v_or3_b32 v7, v7, v70, v71
Mvaa 216,236,156
VE 12,156
Cvaa 232,224,160,40
VE 13,157
Mvaa 232,228,164
VE 14,158
Mvaa 232,232,168
VE 15,159
Mvaa 232,236,172
buffer_load_dwordx4 v4, s[12:15], s38 offen offset:3072 sc1 lds
Cvaa 248,224,176,44
VE 8,172
Mvaa 248,228,180
VE 9,173
Mvaa 248,232,184
Vc 78,12,13
Vc 79,14,15
Mvaa 248,236,188
s_waitcnt lgkmcnt(8)
Ve 10,174
Cvaa 204,240,128,32
VE 11,175
Mvaa 204,244,132
Vc 86,8,9
Vc 87,10,11
Mvaa 204,248,136
VE 12,188
Mvaa 204,252,140
VE 13,189
Cvaa 220,240,144,36
Vc 94,12,13
v_or3_b32 v7, v7, v78, v79
Mvaa 220,244,148
VE 14,190
Mvaa 220,248,152
VE 15,191
Mvaa 220,252,156
Vc 95,14,15
v_or3_b32 v7, v7, v86, v87
Cvaa 236,240,160,40
v_or3_b32 v7, v7, v94, v95
v_and_b32 v1, 0x40004000, v7
Mvaa 236,244,164
v_cmp_ne_u32 vcc, 0, v1
Mvaa 236,248,168
Mvaa 236,252,172
s_waitcnt vmcnt(12)
Cvaa 252,240,176,44
Mvaa 252,244,180
s_barrier
Mvaa 252,248,184
s_waitcnt lgkmcnt(4)
Mvaa 252,252,188
s_cbranch_vccnz L_k2_fb_we
L_k2_fbr_we:
Maav 0,192,64
Ve 8,192
Maav 0,196,68
s_add_u32 m0, s54, 49152
VE 9,193
Maav 32,192,72
buffer_load_dwordx4 v4, s[12:15], s39 offen offset:0 sc1 lds
Maav 32,196,76
s_add_u32 s37, s37, 1
Ra 224,2,20480
Vc 96,8,9
Maav 64,192,80
s_add_u32 s38, s38, 34816
Ve 10,194
Maav 64,196,84
VE 11,195
Maav 96,192,88
Ra 228,2,28672
Vc 97,10,11
Maav 96,196,92
Ra 232,2,21504
v_or_b32_e64 v7, v96, v97
Maav 4,200,64
VE 12,208
Maav 4,204,68
VE 13,209
Maav 36,200,72
Ra 236,2,29696
Vc 104,12,13
Maav 36,204,76
VE 14,210
Maav 68,200,80
VE 15,211
Maav 68,204,84
Ra 240,2,22528
Vc 105,14,15
Maav 100,200,88
Ra 244,2,30720
v_or3_b32 v7, v7, v104, v105
Maav 100,204,92
buffer_load_dwordx4 v4, s[12:15], s39 offen offset:1024 sc1 lds
Mvvv 48,16,64
VE 8,224
Mvvv 48,16,68
s_waitcnt lgkmcnt(6)
Ve 9,225
Maav 8,208,64
Ra 248,2,23552
Vc 112,8,9
Maav 8,212,68
VE 10,226
Maav 40,208,72
VE 11,227
Maav 40,212,76
Ra 252,2,31744
Vc 113,10,11
Maav 72,208,80
Ra 192,3,0
v_or3_b32 v7, v7, v112, v113
Maav 72,212,84
VE 12,240
Maav 104,208,88
VE 13,241
Maav 104,212,92
Ra 196,3,1024
Vc 120,12,13
Maav 12,216,64
VE 14,242
Maav 12,220,68
VE 15,243
Maav 44,216,72
Ra 200,3,2048
Vc 121,14,15
Maav 44,220,76
buffer_load_dwordx4 v4, s[12:15], s39 offen offset:2048 sc1 lds
Maav 76,216,80
Ra 204,3,3072
v_or3_b32 v7, v7, v120, v121
Maav 76,220,84
VE 8,196
Maav 108,216,88
VE 9,197
Maav 108,220,92
VE 10,198
Mvvv 52,16,72
VE 11,199
Mvvv 52,16,76
s_waitcnt lgkmcnt(8)
Ve 12,212
Maav 16,224,64
Ra 208,3,4096
Vc 98,8,9
Maav 16,228,68
Ra 212,3,5120
Vc 99,10,11
Maav 48,224,72
Ra 216,3,6144
v_or3_b32 v7, v7, v98, v99
Maav 48,228,76
VE 13,213
Maav 80,224,80
Ra 220,3,7168
Vc 106,12,13
Maav 80,228,84
VE 14,214
Maav 112,224,88
buffer_load_dwordx4 v4, s[12:15], s39 offen offset:3072 sc1 lds
Maav 112,228,92
s_add_u32 s39, s39, 34816
VE 15,215
Maav 20,232,64
VE 8,228
Maav 20,236,68
VE 9,229
Maav 52,232,72
VE 10,230
Maav 52,236,76
VE 11,231
Maav 84,232,80
Vc 107,14,15
Vc 114,8,9
Maav 84,236,84
VE 12,244
Maav 116,232,88
VE 13,245
Maav 116,236,92
Vc 115,10,11
Vc 122,12,13
Mvvv 56,16,80
VE 14,246
Mvvv 56,16,84
s_waitcnt lgkmcnt(8)
Ve 15,247
Maav 24,240,64
Vc 123,14,15
v_or3_b32 v7, v7, v106, v107
Maav 24,244,68
v_or3_b32 v7, v7, v114, v115
v_or3_b32 v7, v7, v122, v123
Maav 56,240,72
global_load_dword v30, v[28:29], off
Maav 56,244,76
Maav 88,240,80
Maav 88,244,84
Maav 120,240,88
Maav 120,244,92
Maav 28,248,64
Maav 28,252,68
Maav 60,248,72
Maav 60,252,76
Maav 92,248,80
Maav 92,252,84
Maav 124,248,88
Maav 124,252,92
Mvvv 60,16,88
s_waitcnt lgkmcnt(4)
Mvvv 60,16,92
Ve 8,200
Cvaa 128,192,128,32
s_add_u32 m0, s53, 32768
Ra 224,3,8192
v_lshl_add_u64 v[28:29], s[40:41], 0, v[28:29]
Mvaa 128,196,132
buffer_load_dwordx4 v4, s[12:15], s38 offen offset:0 sc1 lds
Mvaa 128,200,136
VE 9,201
Mvaa 128,204,140
Ra 228,3,9216
Vc 100,8,9
Cvaa 144,192,144,36
VE 10,202
Mvaa 144,196,148
VE 11,203
Mvaa 144,200,152
Ra 232,3,10240
Vc 101,10,11
Mvaa 144,204,156
Ra 236,3,11264
v_or3_b32 v7, v7, v100, v101
Cvaa 160,192,160,40
VE 12,216
Mvaa 160,196,164
VE 13,217
Mvaa 160,200,168
Ra 240,3,12288
Vc 108,12,13
Mvaa 160,204,172
VE 14,218
Cvaa 176,192,176,44
VE 15,219
Mvaa 176,196,180
Ra 244,3,13312
Vc 109,14,15
Mvaa 176,200,184
Ra 248,3,14336
v_or3_b32 v7, v7, v108, v109
Mvaa 176,204,188
s_waitcnt lgkmcnt(7)
Ve 8,232
Cvaa 132,208,128,32
buffer_load_dwordx4 v4, s[12:15], s38 offen offset:1024 sc1 lds
Mvaa 132,212,132
VE 9,233
Mvaa 132,216,136
Ra 252,3,15360
Vc 116,8,9
Mvaa 132,220,140
VE 10,234
Cvaa 148,208,144,36
VE 11,235
Mvaa 148,212,148
Ra 192,2,49152
Vc 117,10,11
Mvaa 148,216,152
Ra 196,2,57344
v_or3_b32 v7, v7, v116, v117
Mvaa 148,220,156
VE 12,248
Cvaa 164,208,160,40
VE 13,249
Mvaa 164,212,164
Ra 200,2,50176
Vc 124,12,13
Mvaa 164,216,168
VE 14,250
Mvaa 164,220,172
VE 15,251
Cvaa 180,208,176,44
Ra 204,2,58368
Vc 125,14,15
Mvaa 180,212,180
buffer_load_dwordx4 v4, s[12:15], s38 offen offset:2048 sc1 lds
Mvaa 180,216,184
VE 8,204
Mvaa 180,220,188
s_waitcnt lgkmcnt(8)
Ve 9,205
Cvaa 136,224,128,32
Ra 208,2,51200
Vc 102,8,9
Mvaa 136,228,132
Ra 212,2,59392
v_or3_b32 v7, v7, v124, v125
Mvaa 136,232,136
VE 10,206
Mvaa 136,236,140
VE 11,207
Cvaa 152,224,144,36
Ra 216,2,52224
Vc 103,10,11
Mvaa 152,228,148
Ra 220,2,60416
v_or3_b32 v7, v7, v102, v103
Mvaa 152,232,152
VE 12,220
Mvaa 152,236,156
VE 13,221
Cvaa 168,224,160,40
VE 14,222
Mvaa 168,228,164
VE 15,223
Mvaa 168,232,168
VE 8,236
Mvaa 168,236,172
buffer_load_dwordx4 v4, s[12:15], s38 offen offset:3072 sc1 lds
Cvaa 184,224,176,44
VE 9,237
Mvaa 184,228,180
Vc 110,12,13
Vc 111,14,15
Mvaa 184,232,184
VE 10,238
Mvaa 184,236,188
s_waitcnt lgkmcnt(8)
Ve 11,239
Cvaa 140,240,128,32
Vc 118,8,9
Vc 119,10,11
Mvaa 140,244,132
VE 12,252
Mvaa 140,248,136
VE 13,253
Mvaa 140,252,140
Vc 126,12,13
v_or3_b32 v7, v7, v110, v111
Cvaa 156,240,144,36
VE 14,254
Mvaa 156,244,148
VE 15,255
Mvaa 156,248,152
Vc 127,14,15
v_or3_b32 v7, v7, v118, v119
Mvaa 156,252,156
v_or3_b32 v7, v7, v126, v127
v_and_b32 v1, 0x40004000, v7
Cvaa 172,240,160,40
v_cmp_ne_u32 vcc, 0, v1
Mvaa 172,244,164
Mvaa 172,248,168
Mvaa 172,252,172
s_waitcnt vmcnt(12)
Cvaa 188,240,176,44
s_cmp_eq_u32 s37, s46
Mvaa 188,244,180
s_barrier
Mvaa 188,248,184
s_waitcnt lgkmcnt(4)
Mvaa 188,252,188
s_cbranch_vccnz L_k2_fb_wo
L_k2_fbr_wo:
Maav 0,192,96
s_cbranch_scc1 L_k2_mk_wo
L_k2_mkr_wo:
Ve 8,128
Maav 0,196,100
s_add_u32 m0, s53, 16384
VE 9,129
Maav 32,192,104
buffer_load_dwordx4 v4, s[12:15], s39 offen offset:0 sc1 lds
Maav 32,196,108
s_add_u32 s37, s37, 1
Ra 224,2,53248
Vc 64,8,9
Maav 64,192,112
s_add_u32 s38, s38, 34816
Ve 10,130
Maav 64,196,116
s_xor_b32 s53, s53, 65536
VE 11,131
Maav 96,192,120
s_xor_b32 s54, s54, 65536
Ra 228,2,61440
Vc 65,10,11
Maav 96,196,124
Ra 232,2,54272
v_or_b32_e64 v7, v64, v65
Maav 4,200,96
VE 12,144
Maav 4,204,100
VE 13,145
Maav 36,200,104
Ra 236,2,62464
Vc 72,12,13
Maav 36,204,108
VE 14,146
Maav 68,200,112
VE 15,147
Maav 68,204,116
Ra 240,2,55296
Vc 73,14,15
Maav 100,200,120
Ra 244,2,63488
v_or3_b32 v7, v7, v72, v73
Maav 100,204,124
buffer_load_dwordx4 v4, s[12:15], s39 offen offset:1024 sc1 lds
Mvvv 48,16,96
VE 8,160
Mvvv 48,16,100
s_waitcnt lgkmcnt(6)
Ve 9,161
Maav 8,208,96
Ra 248,2,56320
Vc 80,8,9
Maav 8,212,100
VE 10,162
Maav 40,208,104
VE 11,163
Maav 40,212,108
Ra 252,2,64512
Vc 81,10,11
Maav 72,208,112
Ra 192,3,32768
v_or3_b32 v7, v7, v80, v81
Maav 72,212,116
VE 12,176
Maav 104,208,120
VE 13,177
Maav 104,212,124
Ra 196,3,33792
Vc 88,12,13
Maav 12,216,96
VE 14,178
Maav 12,220,100
VE 15,179
Maav 44,216,104
Ra 200,3,34816
Vc 89,14,15
Maav 44,220,108
buffer_load_dwordx4 v4, s[12:15], s39 offen offset:2048 sc1 lds
Maav 76,216,112
Ra 204,3,35840
v_or3_b32 v7, v7, v88, v89
Maav 76,220,116
VE 8,132
Maav 108,216,120
VE 9,133
Maav 108,220,124
VE 10,134
Mvvv 52,16,104
VE 11,135
Mvvv 52,16,108
s_waitcnt lgkmcnt(8)
Ve 12,148
Maav 16,224,96
Ra 208,3,36864
Vc 66,8,9
Maav 16,228,100
Ra 212,3,37888
Vc 67,10,11
Maav 48,224,104
Ra 216,3,38912
v_or3_b32 v7, v7, v66, v67
Maav 48,228,108
VE 13,149
Maav 80,224,112
Ra 220,3,39936
Vc 74,12,13
Maav 80,228,116
VE 14,150
Maav 112,224,120
buffer_load_dwordx4 v4, s[12:15], s39 offen offset:3072 sc1 lds
Maav 112,228,124
s_add_u32 s39, s39, 34816
VE 15,151
Maav 20,232,96
VE 8,164
Maav 20,236,100
VE 9,165
Maav 52,232,104
VE 10,166
Maav 52,236,108
VE 11,167
Maav 84,232,112
Vc 75,14,15
Vc 82,8,9
Maav 84,236,116
VE 12,180
Maav 116,232,120
VE 13,181
Maav 116,236,124
Vc 83,10,11
Vc 90,12,13
Mvvv 56,16,112
VE 14,182
Mvvv 56,16,116
s_waitcnt lgkmcnt(8)
Ve 15,183
Maav 24,240,96
Vc 91,14,15
v_or3_b32 v7, v7, v74, v75
Maav 24,244,100
v_or3_b32 v7, v7, v82, v83
v_or3_b32 v7, v7, v90, v91
Maav 56,240,104
global_load_dword v30, v[28:29], off
Maav 56,244,108
Maav 88,240,112
Maav 88,244,116
Maav 120,240,120
Maav 120,244,124
Maav 28,248,96
Maav 28,252,100
Maav 60,248,104
Maav 60,252,108
Maav 92,248,112
Maav 92,252,116
Maav 124,248,120
Maav 124,252,124
s_cmp_lg_u32 s37, s35
Mvvv 60,16,120
s_waitcnt lgkmcnt(4)
Mvvv 60,16,124
s_cbranch_scc1 L_k2_wloop
L_k2_wlast:
v_xor_b32 v2, 65536, v2
v_xor_b32 v3, 65536, v3
Cvaa 192,192,128,32
s_mov_b32 m0, s53
Ra 224,2,40960
v_lshl_add_u64 v[28:29], s[40:41], 0, v[28:29]
Mvaa 192,196,132
buffer_load_dwordx4 v4, s[12:15], s38 offen offset:0 sc1 lds
Mvaa 192,200,136
VE 8,136
Mvaa 192,204,140
VE 9,137
Cvaa 208,192,144,36
Ra 228,2,41984
Vc 68,8,9
Mvaa 208,196,148
VE 10,138
Mvaa 208,200,152
VE 11,139
Mvaa 208,204,156
Ra 232,2,43008
Vc 69,10,11
Cvaa 224,192,160,40
Ra 236,2,44032
v_or3_b32 v7, v7, v68, v69
Mvaa 224,196,164
VE 12,152
Mvaa 224,200,168
VE 13,153
Mvaa 224,204,172
s_waitcnt lgkmcnt(4)
Ra 240,2,45056
Vc 76,12,13
Cvaa 196,208,128,32
buffer_load_dwordx4 v4, s[12:15], s38 offen offset:1024 sc1 lds
Mvaa 196,212,132
Ve 14,154
Mvaa 196,216,136
VE 15,155
Mvaa 196,220,140
Ra 244,2,46080
Vc 77,14,15
Cvaa 212,208,144,36
Ra 248,2,47104
v_or3_b32 v7, v7, v76, v77
Mvaa 212,212,148
VE 8,168
Mvaa 212,216,152
VE 9,169
Mvaa 212,220,156
Ra 252,2,48128
Vc 84,8,9
Cvaa 228,208,160,40
VE 10,170
Mvaa 228,212,164
buffer_load_dwordx4 v4, s[12:15], s38 offen offset:2048 sc1 lds
Mvaa 228,216,168
VE 11,171
Mvaa 228,220,172
s_waitcnt lgkmcnt(4)
Ra 192,2,16384
Vc 85,10,11
Cvaa 200,224,128,32
Ra 196,2,24576
v_or3_b32 v7, v7, v84, v85
Mvaa 200,228,132
Ve 12,184
Mvaa 200,232,136
VE 13,185
Mvaa 200,236,140
Ra 200,2,17408
Vc 92,12,13
Cvaa 216,224,144,36
VE 14,186
Mvaa 216,228,148
VE 15,187
Mvaa 216,232,152
Ra 204,2,25600
Vc 93,14,15
Mvaa 216,236,156
buffer_load_dwordx4 v4, s[12:15], s38 offen offset:3072 sc1 lds
Cvaa 232,224,160,40
Ra 208,2,18432
v_or3_b32 v7, v7, v92, v93
Mvaa 232,228,164
VE 8,140
Mvaa 232,232,168
VE 9,141
Mvaa 232,236,172
s_waitcnt lgkmcnt(5)
Ra 212,2,26624
Vc 70,8,9
Cvaa 204,240,128,32
Ve 10,142
Mvaa 204,244,132
VE 11,143
Mvaa 204,248,136
Ra 216,2,19456
Vc 71,10,11
Mvaa 204,252,140
Ra 220,2,27648
v_or3_b32 v7, v7, v70, v71
Cvaa 220,240,144,36
VE 12,156
Mvaa 220,244,148
VE 13,157
Mvaa 220,248,152
VE 14,158
Mvaa 220,252,156
s_waitcnt vmcnt(12)
Ve 15,159
Cvaa 236,240,160,40
VE 8,172
Mvaa 236,244,164
s_barrier
Ve 9,173
Mvaa 236,248,168
s_waitcnt lgkmcnt(4)
Vc 78,12,13
Vc 79,14,15
Ve 10,174
Ve 11,175
Ve 12,188
Ve 13,189
Ve 14,190
VE 15,191
Vc 86,8,9
Vc 87,10,11
Vc 94,12,13
Vc 95,14,15
v_or3_b32 v7, v7, v78, v79
v_or3_b32 v7, v7, v86, v87
v_or3_b32 v7, v7, v94, v95
v_and_b32 v1, 0x40004000, v7
v_cmp_ne_u32 vcc, 0, v1
Mvaa 236,252,172
s_cbranch_vccnz L_k2_fb_wl
L_k2_fbr_wl:
Maav 0,192,64
v_cmp_gt_i32 s[56:57], 0, v6
v_cmp_gt_i32 s[58:59], 1, v6
v_cmp_gt_i32 s[60:61], 2, v6
v_cmp_gt_i32 s[62:63], 3, v6
s_nop 3
s_nop 0
v_cndmask_b32 v224, v224, v20, s[56:57]
v_cndmask_b32 v225, v225, v20, s[58:59]
v_cndmask_b32 v226, v226, v20, s[60:61]
v_cndmask_b32 v227, v227, v20, s[62:63]
v_cmp_gt_i32 s[56:57], 16, v6
v_cmp_gt_i32 s[58:59], 17, v6
v_cmp_gt_i32 s[60:61], 18, v6
v_cmp_gt_i32 s[62:63], 19, v6
v_cndmask_b32 v228, v228, v20, s[56:57]
v_cndmask_b32 v229, v229, v20, s[58:59]
v_cndmask_b32 v230, v230, v20, s[60:61]
v_cndmask_b32 v231, v231, v20, s[62:63]
v_cmp_gt_i32 s[56:57], 32, v6
v_cmp_gt_i32 s[58:59], 33, v6
v_cmp_gt_i32 s[60:61], 34, v6
v_cmp_gt_i32 s[62:63], 35, v6
v_cndmask_b32 v232, v232, v20, s[56:57]
v_cndmask_b32 v233, v233, v20, s[58:59]
v_cndmask_b32 v234, v234, v20, s[60:61]
v_cndmask_b32 v235, v235, v20, s[62:63]
v_cmp_gt_i32 s[56:57], 48, v6
v_cmp_gt_i32 s[58:59], 49, v6
v_cmp_gt_i32 s[60:61], 50, v6
v_cmp_gt_i32 s[62:63], 51, v6
v_cndmask_b32 v236, v236, v20, s[56:57]
v_cndmask_b32 v237, v237, v20, s[58:59]
v_cndmask_b32 v238, v238, v20, s[60:61]
v_cndmask_b32 v239, v239, v20, s[62:63]
VE 8,192
Maav 0,196,68
s_add_u32 m0, s54, 49152
VE 9,193
Maav 32,192,72
buffer_load_dwordx4 v4, s[12:15], s39 offen offset:0 sc1 lds
Maav 32,196,76
s_add_u32 s37, s37, 1
Ra 224,2,20480
Vc 96,8,9
Maav 64,192,80
s_add_u32 s38, s38, 34816
Ve 10,194
Maav 64,196,84
VE 11,195
Maav 96,192,88
Ra 228,2,28672
Vc 97,10,11
Maav 96,196,92
Ra 232,2,21504
v_or_b32_e64 v7, v96, v97
Maav 4,200,64
VE 12,208
Maav 4,204,68
VE 13,209
Maav 36,200,72
Ra 236,2,29696
Vc 104,12,13
Maav 36,204,76
VE 14,210
Maav 68,200,80
VE 15,211
Maav 68,204,84
Ra 240,2,22528
Vc 105,14,15
Maav 100,200,88
Ra 244,2,30720
v_or3_b32 v7, v7, v104, v105
Maav 100,204,92
buffer_load_dwordx4 v4, s[12:15], s39 offen offset:1024 sc1 lds
Mvvv 48,16,64
VE 8,224
Mvvv 48,16,68
s_waitcnt lgkmcnt(6)
Ve 9,225
Maav 8,208,64
Ra 248,2,23552
Vc 112,8,9
Maav 8,212,68
VE 10,226
Maav 40,208,72
VE 11,227
Maav 40,212,76
Ra 252,2,31744
Vc 113,10,11
Maav 72,208,80
Ra 192,3,0
v_or3_b32 v7, v7, v112, v113
Maav 72,212,84
VE 12,196
Maav 104,208,88
VE 13,197
Maav 104,212,92
Ra 196,3,1024
Vc 98,12,13
Maav 12,216,64
VE 14,198
Maav 12,220,68
VE 15,199
Maav 44,216,72
Ra 200,3,2048
Vc 99,14,15
Maav 44,220,76
buffer_load_dwordx4 v4, s[12:15], s39 offen offset:2048 sc1 lds
Maav 76,216,80
Ra 204,3,3072
v_or3_b32 v7, v7, v98, v99
Maav 76,220,84
VE 8,212
Maav 108,216,88
VE 9,213
Maav 108,220,92
VE 10,214
Mvvv 52,16,72
VE 11,215
Mvvv 52,16,76
s_waitcnt lgkmcnt(8)
Ve 12,228
Maav 16,224,64
Ra 208,3,4096
Vc 106,8,9
Maav 16,228,68
Ra 212,3,5120
Vc 107,10,11
Maav 48,224,72
Ra 216,3,6144
v_or3_b32 v7, v7, v106, v107
Maav 48,228,76
VE 13,229
Maav 80,224,80
Ra 220,3,7168
Vc 114,12,13
Maav 80,228,84
VE 14,230
Maav 112,224,88
buffer_load_dwordx4 v4, s[12:15], s39 offen offset:3072 sc1 lds
Maav 112,228,92
s_add_u32 s39, s39, 34816
VE 15,231
Maav 20,232,64
VE 8,200
Maav 20,236,68
VE 9,201
Maav 52,232,72
VE 10,202
Maav 52,236,76
VE 11,203
Maav 84,232,80
Vc 115,14,15
Vc 100,8,9
Maav 84,236,84
VE 12,216
Maav 116,232,88
VE 13,217
Maav 116,236,92
Vc 101,10,11
Vc 108,12,13
Mvvv 56,16,80
VE 14,218
Mvvv 56,16,84
s_waitcnt lgkmcnt(8)
Ve 15,219
Maav 24,240,64
Vc 109,14,15
v_or3_b32 v7, v7, v114, v115
Maav 24,244,68
VE 8,232
Maav 56,240,72
global_load_dword v30, v[28:29], off
Maav 56,244,76
VE 9,233
Maav 88,240,80
Vc 116,8,9
v_or3_b32 v7, v7, v100, v101
Maav 88,244,84
VE 10,234
Maav 120,240,88
VE 11,235
Maav 120,244,92
Vc 117,10,11
v_or3_b32 v7, v7, v108, v109
Maav 28,248,64
v_or3_b32 v7, v7, v116, v117
Maav 28,252,68
Maav 60,248,72
Maav 60,252,76
Maav 92,248,80
Maav 92,252,84
Maav 124,248,88
Maav 124,252,92
Mvvv 60,16,88
s_waitcnt lgkmcnt(4)
Mvvv 60,16,92
Ve 12,204
Cvaa 128,192,128,32
s_add_u32 m0, s53, 32768
VE 13,205
Mvaa 128,196,132
buffer_load_dwordx4 v4, s[12:15], s38 offen offset:0 sc1 lds
Mvaa 128,200,136
Ra 224,3,8192
Vc 102,12,13
Mvaa 128,204,140
VE 14,206
Cvaa 144,192,144,36
VE 15,207
Mvaa 144,196,148
Ra 228,3,9216
Vc 103,14,15
Mvaa 144,200,152
Ra 232,3,10240
v_or3_b32 v7, v7, v102, v103
Mvaa 144,204,156
s_waitcnt lgkmcnt(3)
Ra 236,3,11264
Ra 240,3,12288
Cvaa 132,208,128,32
buffer_load_dwordx4 v4, s[12:15], s38 offen offset:1024 sc1 lds
Mvaa 132,212,132
Ve 8,220
Mvaa 132,216,136
VE 9,221
Mvaa 132,220,140
Ra 244,3,13312
Vc 110,8,9
Cvaa 148,208,144,36
VE 10,222
Mvaa 148,212,148
buffer_load_dwordx4 v4, s[12:15], s38 offen offset:2048 sc1 lds
Mvaa 148,216,152
VE 11,223
Mvaa 148,220,156
s_waitcnt lgkmcnt(2)
Ra 248,3,14336
Ra 252,3,15360
Cvaa 136,224,128,32
Ra 192,2,49152
Vc 111,10,11
Mvaa 136,228,132
Ra 196,2,57344
v_or3_b32 v7, v7, v110, v111
Mvaa 136,232,136
Ve 12,236
Mvaa 136,236,140
buffer_load_dwordx4 v4, s[12:15], s38 offen offset:3072 sc1 lds
Cvaa 152,224,144,36
VE 13,237
Mvaa 152,228,148
Ra 200,2,50176
Vc 118,12,13
Mvaa 152,232,152
VE 14,238
Mvaa 152,236,156
s_waitcnt lgkmcnt(3)
Ra 204,2,58368
Ra 208,2,51200
Cvaa 140,240,128,32
Ve 15,239
Mvaa 140,244,132
Ra 212,2,59392
Vc 119,14,15
Mvaa 140,248,136
Ra 216,2,52224
v_or3_b32 v7, v7, v118, v119
Mvaa 140,252,140
s_waitcnt vmcnt(12)
Ra 220,2,60416
v_and_b32 v1, 0x40004000, v7
Cvaa 156,240,144,36
s_cmp_eq_u32 s37, s45
v_cmp_ne_u32 vcc, 0, v1
Mvaa 156,244,148
s_barrier
Mvaa 156,248,152
s_waitcnt lgkmcnt(4)
Mvaa 156,252,156
s_cbranch_vccnz L_k2_fb_tr
L_k2_fbr_tr:
Maav 0,192,96
s_cbranch_scc1 L_k2_mk_tr
L_k2_mkr_tr:
Ve 8,128
Maav 0,196,100
s_add_u32 m0, s53, 16384
VE 9,129
Maav 32,192,104
buffer_load_dwordx4 v4, s[12:15], s39 offen offset:0 sc1 lds
Maav 32,196,108
s_add_u32 s37, s37, 1
Ra 224,2,53248
Vc 64,8,9
Maav 64,192,112
s_add_u32 s38, s38, 34816
Ve 10,130
Maav 64,196,116
s_xor_b32 s53, s53, 65536
VE 11,131
Maav 4,200,96
s_xor_b32 s54, s54, 65536
Ra 228,2,61440
Vc 65,10,11
Maav 4,204,100
Ra 232,2,54272
v_or_b32_e64 v7, v64, v65
Maav 36,200,104
VE 12,144
Maav 36,204,108
VE 13,145
Maav 68,200,112
Ra 236,2,62464
Vc 72,12,13
Maav 68,204,116
VE 14,146
Mvvv 48,16,96
VE 15,147
Mvvv 48,16,100
s_waitcnt lgkmcnt(4)
Ra 240,2,55296
Vc 73,14,15
Maav 8,208,96
buffer_load_dwordx4 v4, s[12:15], s39 offen offset:1024 sc1 lds
Maav 8,212,100
Ra 244,2,63488
v_or3_b32 v7, v7, v72, v73
Maav 40,208,104
Ve 8,132
Maav 40,212,108
VE 9,133
Maav 72,208,112
Ra 248,2,56320
Vc 66,8,9
Maav 72,212,116
VE 10,134
Maav 12,216,96
VE 11,135
Maav 12,220,100
Ra 252,2,64512
Vc 67,10,11
Maav 44,216,104
Ra 192,3,32768
v_or3_b32 v7, v7, v66, v67
Maav 44,220,108
VE 12,148
Maav 76,216,112
VE 13,149
Maav 76,220,116
Ra 196,3,33792
Vc 74,12,13
Mvvv 52,16,104
VE 14,150
Mvvv 52,16,108
s_waitcnt lgkmcnt(6)
Ve 15,151
Maav 16,224,96
buffer_load_dwordx4 v4, s[12:15], s39 offen offset:2048 sc1 lds
Maav 16,228,100
Ra 200,3,34816
Vc 75,14,15
Maav 48,224,104
Ra 204,3,35840
v_or3_b32 v7, v7, v74, v75
Maav 48,228,108
VE 8,136
Maav 80,224,112
Ra 208,3,36864
Ra 212,3,37888
Maav 80,228,116
Ra 216,3,38912
Ra 220,3,39936
Maav 20,232,96
Maav 20,236,100
Maav 52,232,104
Maav 52,236,108
Maav 84,232,112
Maav 84,236,116
buffer_load_dwordx4 v4, s[12:15], s39 offen offset:3072 sc1 lds
Mvvv 56,16,112
s_add_u32 s39, s39, 34816
Mvvv 56,16,116
s_waitcnt lgkmcnt(8)
Maav 24,240,96
Maav 24,244,100
Maav 56,240,104
Maav 56,244,108
Maav 88,240,112
Maav 88,244,116
Maav 28,248,96
Maav 28,252,100
Maav 60,248,104
Maav 60,252,108
Maav 92,248,112
s_waitcnt lgkmcnt(4)
Maav 92,252,116
s_getpc_b64 s[56:57]
L_cpf4:
s_add_u32 s56, s56, (L_k2_fin-L_cpf4)&0xffffffff
s_addc_u32 s57, s57, ((L_k2_fin-L_cpf4)>>32)&0xffffffff
s_lshr_b32 s58, s2, 3
s_lshl_b32 s58, s58, 2
s_add_u32 s58, s58, s32
s_lshl_b32 s58, s58, 10
v_and_b32 v162, 7, v0
v_lshlrev_b32 v162, 7, v162
v_add_u32 v162, s58, v162
v_min_u32 v162, L_p4_end-L_k2_fin-4, v162
v_mov_b32 v161, s57
v_add_co_u32 v160, vcc, s56, v162
s_nop 1
v_addc_co_u32 v161, vcc, 0, v161, vcc
global_load_dword v164, v[160:161], off
s_waitcnt vmcnt(9)
s_lshl_b32 s3, s34, 20
s_lshl_b32 s47, s33, 15
s_add_u32 s3, s3, s47
s_lshl_b32 s47, s32, 10
v_lshlrev_b32 v248, 4, v0
v_add_u32_e64 v249, s47, v248
s_sub_u32 s47, 7168, s47
v_add_u32 v248, s47, v248
v_rcp_f32 v250, v56
v_rcp_f32 v252, v60
v_mov_b32 v251, v250
v_mov_b32_e64 v253, v252
Ar 240,96
Ar 241,97
Ar 242,98
Ar 243,99
Ar 244,100
Ar 245,101
Ar 246,102
Ar 247,103
v_pk_mul_f32 v[240:241], v[240:241], v[252:253]
v_pk_mul_f32 v[242:243], v[242:243], v[252:253]
v_pk_mul_f32 v[244:245], v[244:245], v[252:253]
v_pk_mul_f32 v[246:247], v[246:247], v[252:253]
Vc 28,240,241
Vc 29,242,243
Vc 30,244,245
Vc 31,246,247
buffer_store_dwordx4 v[28:31], v249, s[16:19], s3 offen sc1
Ar 240,64
Ar 241,65
Ar 242,66
Ar 243,67
Ar 244,68
Ar 245,69
Ar 246,70
Ar 247,71
v_pk_mul_f32 v[240:241], v[240:241], v[250:251]
v_pk_mul_f32 v[242:243], v[242:243], v[250:251]
v_pk_mul_f32 v[244:245], v[244:245], v[250:251]
v_pk_mul_f32 v[246:247], v[246:247], v[250:251]
Vc 24,240,241
Vc 25,242,243
Vc 26,244,245
Vc 27,246,247
buffer_store_dwordx4 v[24:27], v248, s[16:19], s3 offen sc1
s_add_u32 s3, s3, 8192
Ar 240,104
Ar 241,105
Ar 242,106
Ar 243,107
Ar 244,108
Ar 245,109
Ar 246,110
Ar 247,111
v_pk_mul_f32 v[240:241], v[240:241], v[252:253]
v_pk_mul_f32 v[242:243], v[242:243], v[252:253]
v_pk_mul_f32 v[244:245], v[244:245], v[252:253]
v_pk_mul_f32 v[246:247], v[246:247], v[252:253]
Vc 28,240,241
Vc 29,242,243
Vc 30,244,245
Vc 31,246,247
buffer_store_dwordx4 v[28:31], v249, s[16:19], s3 offen sc1
Ar 240,72
Ar 241,73
Ar 242,74
Ar 243,75
Ar 244,76
Ar 245,77
Ar 246,78
Ar 247,79
v_pk_mul_f32 v[240:241], v[240:241], v[250:251]
v_pk_mul_f32 v[242:243], v[242:243], v[250:251]
v_pk_mul_f32 v[244:245], v[244:245], v[250:251]
v_pk_mul_f32 v[246:247], v[246:247], v[250:251]
Vc 24,240,241
Vc 25,242,243
Vc 26,244,245
Vc 27,246,247
buffer_store_dwordx4 v[24:27], v248, s[16:19], s3 offen sc1
s_add_u32 s3, s3, 8192
Ar 240,112
Ar 241,113
Ar 242,114
Ar 243,115
Ar 244,116
Ar 245,117
Ar 246,118
Ar 247,119
v_pk_mul_f32 v[240:241], v[240:241], v[252:253]
v_pk_mul_f32 v[242:243], v[242:243], v[252:253]
v_pk_mul_f32 v[244:245], v[244:245], v[252:253]
v_pk_mul_f32 v[246:247], v[246:247], v[252:253]
Vc 28,240,241
Vc 29,242,243
Vc 30,244,245
Vc 31,246,247
buffer_store_dwordx4 v[28:31], v249, s[16:19], s3 offen sc1
Ar 240,80
Ar 241,81
Ar 242,82
Ar 243,83
Ar 244,84
Ar 245,85
Ar 246,86
Ar 247,87
v_pk_mul_f32 v[240:241], v[240:241], v[250:251]
v_pk_mul_f32 v[242:243], v[242:243], v[250:251]
v_pk_mul_f32 v[244:245], v[244:245], v[250:251]
v_pk_mul_f32 v[246:247], v[246:247], v[250:251]
Vc 24,240,241
Vc 25,242,243
Vc 26,244,245
Vc 27,246,247
buffer_store_dwordx4 v[24:27], v248, s[16:19], s3 offen sc1
s_add_u32 s3, s3, 8192
Ar 240,120
Ar 241,121
Ar 242,122
Ar 243,123
Ar 244,124
Ar 245,125
Ar 246,126
Ar 247,127
v_pk_mul_f32 v[240:241], v[240:241], v[252:253]
v_pk_mul_f32 v[242:243], v[242:243], v[252:253]
v_pk_mul_f32 v[244:245], v[244:245], v[252:253]
v_pk_mul_f32 v[246:247], v[246:247], v[252:253]
Vc 28,240,241
Vc 29,242,243
Vc 30,244,245
Vc 31,246,247
buffer_store_dwordx4 v[28:31], v249, s[16:19], s3 offen sc1
Ar 240,88
Ar 241,89
Ar 242,90
Ar 243,91
Ar 244,92
Ar 245,93
Ar 246,94
Ar 247,95
v_pk_mul_f32 v[240:241], v[240:241], v[250:251]
v_pk_mul_f32 v[242:243], v[242:243], v[250:251]
v_pk_mul_f32 v[244:245], v[244:245], v[250:251]
v_pk_mul_f32 v[246:247], v[246:247], v[250:251]
Vc 24,240,241
Vc 25,242,243
Vc 26,244,245
Vc 27,246,247
buffer_store_dwordx4 v[24:27], v248, s[16:19], s3 offen sc1
s_add_u32 s52, s37, 2
s_load_dwordx2 s[94:95], s[0:1], 40
s_load_dwordx2 s[40:41], s[0:1], 0
s_load_dwordx4 s[8:11], s[0:1], 80
s_waitcnt vmcnt(8) lgkmcnt(0)
s_add_u32 s93, s2, 224
s_and_b32 s93, s93, 255
s_nop 0
s_mul_i32 s92, s93, 2341
s_lshr_b32 s92, s92, 16
s_mul_i32 s47, s92, 28
s_sub_u32 s4, s93, s47
s_mul_i32 s5, s92, 917504
s_lshl_b32 s47, s4, 8
s_add_u32 s5, s5, s47
s_cmp_eq_u32 s34, 7
s_cbranch_scc1 L_k2_fin
L_k2_nloop:
v_xor_b32 v2, 65536, v2
v_xor_b32 v3, 65536, v3
Cvaa 192,192,128,32
s_mov_b32 m0, s53
Ve 9,137
Mvaa 192,196,132
buffer_load_dwordx4 v4, s[12:15], s38 offen offset:0 sc1 lds
Mvaa 192,200,136
Ra 224,2,40960
Vc 68,8,9
Mvaa 192,204,140
VE 10,138
Cvaa 208,192,144,36
VE 11,139
Mvaa 208,196,148
Ra 228,2,41984
Vc 69,10,11
Mvaa 208,200,152
Ra 232,2,43008
v_or3_b32 v7, v7, v68, v69
Mvaa 208,204,156
s_waitcnt lgkmcnt(3)
Ra 236,2,44032
Ra 240,2,45056
Cvaa 196,208,128,32
buffer_load_dwordx4 v4, s[12:15], s38 offen offset:1024 sc1 lds
Mvaa 196,212,132
Ve 12,152
Mvaa 196,216,136
VE 13,153
Mvaa 196,220,140
Ra 244,2,46080
Vc 76,12,13
Cvaa 212,208,144,36
VE 14,154
Mvaa 212,212,148
buffer_load_dwordx4 v4, s[12:15], s38 offen offset:2048 sc1 lds
Mvaa 212,216,152
VE 15,155
Mvaa 212,220,156
s_waitcnt lgkmcnt(2)
Ra 248,2,47104
Ra 252,2,48128
Cvaa 200,224,128,32
Ra 192,2,16384
Vc 77,14,15
Mvaa 200,228,132
Ra 196,2,24576
v_or3_b32 v7, v7, v76, v77
Mvaa 200,232,136
Ve 8,140
Mvaa 200,236,140
buffer_load_dwordx4 v4, s[12:15], s38 offen offset:3072 sc1 lds
Cvaa 216,224,144,36
VE 9,141
Mvaa 216,228,148
Ra 200,2,17408
Vc 70,8,9
Mvaa 216,232,152
VE 10,142
Mvaa 216,236,156
s_waitcnt lgkmcnt(3)
Ra 204,2,25600
Ra 208,2,18432
Cvaa 204,240,128,32
Ve 11,143
Mvaa 204,244,132
s_cmp_lt_u32 s37, s52
Ra 212,2,26624
Vc 71,10,11
Mvaa 204,248,136
s_cbranch_scc1 L_nw_ne
s_waitcnt vmcnt(12)
L_nw_ne:
Ra 216,2,19456
v_or3_b32 v7, v7, v70, v71
Mvaa 204,252,140
Ve 12,156
Cvaa 220,240,144,36
VE 13,157
Mvaa 220,244,148
s_barrier
Ra 220,2,27648
Vc 78,12,13
Mvaa 220,248,152
s_waitcnt lgkmcnt(4)
Ve 14,158
Ve 15,159
s_nop 0
Vc 79,14,15
v_or3_b32 v7, v7, v78, v79
v_and_b32 v1, 0x40004000, v7
v_cmp_ne_u32 vcc, 0, v1
Mvaa 220,252,156
s_cbranch_vccnz L_k2_fb_ne
L_k2_fbr_ne:
Maav 0,192,64
Ve 8,192
Maav 0,196,68
s_add_u32 m0, s54, 49152
VE 9,193
Maav 32,192,72
buffer_load_dwordx4 v4, s[12:15], s39 offen offset:0 sc1 lds
Maav 32,196,76
s_cmp_eq_u32 s37, s52
Ra 224,2,20480
Vc 96,8,9
Maav 4,200,64
s_cbranch_scc1 L_pubB
L_pubBr:
VE 10,194
Maav 4,204,68
s_add_u32 s37, s37, 1
Ve 11,195
Maav 36,200,72
s_add_u32 s38, s38, 34816
Ra 228,2,28672
Vc 97,10,11
Maav 36,204,76
Ra 232,2,21504
v_or_b32_e64 v7, v96, v97
Mvvv 48,16,64
VE 12,208
Mvvv 48,16,68
s_waitcnt lgkmcnt(3)
Ra 236,2,29696
Ra 240,2,22528
Maav 8,208,64
buffer_load_dwordx4 v4, s[12:15], s39 offen offset:1024 sc1 lds
Maav 8,212,68
Ve 13,209
Maav 40,208,72
Ra 244,2,30720
Vc 104,12,13
Maav 40,212,76
VE 14,210
Maav 12,216,64
VE 15,211
Maav 12,220,68
Ra 248,2,23552
Vc 105,14,15
Maav 44,216,72
Ra 252,2,31744
v_or3_b32 v7, v7, v104, v105
Maav 44,220,76
VE 8,196
Mvvv 52,16,72
buffer_load_dwordx4 v4, s[12:15], s39 offen offset:2048 sc1 lds
Mvvv 52,16,76
s_waitcnt lgkmcnt(4)
Ve 9,197
Maav 16,224,64
Ra 192,3,0
Vc 98,8,9
Maav 16,228,68
VE 10,198
Maav 48,224,72
VE 11,199
Maav 48,228,76
Ra 196,3,1024
Vc 99,10,11
Maav 20,232,64
Ra 200,3,2048
v_or3_b32 v7, v7, v98, v99
Maav 20,236,68
Ra 204,3,3072
Ra 208,3,4096
Maav 52,232,72
buffer_load_dwordx4 v4, s[12:15], s39 offen offset:3072 sc1 lds
Maav 52,236,76
s_waitcnt lgkmcnt(5)
Ve 12,212
Maav 24,240,64
s_add_u32 s39, s39, 34816
VE 13,213
Maav 24,244,68
Ra 212,3,5120
Vc 106,12,13
Maav 56,240,72
VE 14,214
Maav 56,244,76
VE 15,215
Maav 28,248,64
Ra 216,3,6144
Vc 107,14,15
Maav 28,252,68
Ra 220,3,7168
v_or3_b32 v7, v7, v106, v107
Maav 60,248,72
s_waitcnt lgkmcnt(4)
Ve 8,200
Maav 60,252,76
VE 9,201
Cvaa 128,192,128,32
s_add_u32 m0, s53, 32768
Ra 224,3,8192
Vc 100,8,9
Mvaa 128,196,132
buffer_load_dwordx4 v4, s[12:15], s38 offen offset:0 sc1 lds
Mvaa 128,200,136
VE 10,202
Mvaa 128,204,140
VE 11,203
Cvaa 144,192,144,36
Ra 228,3,9216
Vc 101,10,11
Mvaa 144,196,148
Ra 232,3,10240
v_or3_b32 v7, v7, v100, v101
Mvaa 144,200,152
VE 12,216
Mvaa 144,204,156
s_waitcnt lgkmcnt(3)
Ra 236,3,11264
Ra 240,3,12288
Cvaa 132,208,128,32
buffer_load_dwordx4 v4, s[12:15], s38 offen offset:1024 sc1 lds
Mvaa 132,212,132
Ve 13,217
Mvaa 132,216,136
Ra 244,3,13312
Vc 108,12,13
Mvaa 132,220,140
VE 14,218
Cvaa 148,208,144,36
VE 15,219
Mvaa 148,212,148
buffer_load_dwordx4 v4, s[12:15], s38 offen offset:2048 sc1 lds
Mvaa 148,216,152
Ra 248,3,14336
Vc 109,14,15
Mvaa 148,220,156
s_waitcnt lgkmcnt(3)
Ra 252,3,15360
v_or3_b32 v7, v7, v108, v109
Cvaa 136,224,128,32
Ve 8,204
Mvaa 136,228,132
VE 9,205
Mvaa 136,232,136
Ra 192,2,49152
Vc 102,8,9
Mvaa 136,236,140
buffer_load_dwordx4 v4, s[12:15], s38 offen offset:3072 sc1 lds
Cvaa 152,224,144,36
VE 10,206
Mvaa 152,228,148
VE 11,207
Mvaa 152,232,152
Ra 196,2,57344
Vc 103,10,11
Mvaa 152,236,156
s_waitcnt lgkmcnt(2)
Ra 200,2,50176
Ra 204,2,58368
Cvaa 140,240,128,32
Ra 208,2,51200
v_or3_b32 v7, v7, v102, v103
Mvaa 140,244,132
s_cmp_lt_u32 s37, s52
VE 12,220
Mvaa 140,248,136
s_cbranch_scc1 L_nw_no
s_waitcnt vmcnt(12)
L_nw_no:
VE 13,221
Mvaa 140,252,140
Ra 212,2,59392
Vc 110,12,13
Cvaa 156,240,144,36
s_cmp_eq_u32 s37, s45
Ve 14,222
Mvaa 156,244,148
s_barrier
Ve 15,223
Mvaa 156,248,152
s_waitcnt lgkmcnt(2)
Ra 216,2,52224
Vc 111,14,15
v_or3_b32 v7, v7, v110, v111
v_and_b32 v1, 0x40004000, v7
v_cmp_ne_u32 vcc, 0, v1
Mvaa 156,252,156
s_cbranch_vccnz L_k2_fb_no
L_k2_fbr_no:
Ra 220,2,60416
Maav 0,192,96
s_cbranch_scc1 L_k2_mk_no
L_k2_mkr_no:
VE 8,128
Maav 0,196,100
s_add_u32 m0, s53, 16384
VE 9,129
Maav 32,192,104
buffer_load_dwordx4 v4, s[12:15], s39 offen offset:0 sc1 lds
Maav 32,196,108
s_add_u32 s37, s37, 1
Ra 224,2,53248
Vc 64,8,9
Maav 4,200,96
s_add_u32 s38, s38, 34816
Ve 10,130
Maav 4,204,100
s_xor_b32 s53, s53, 65536
VE 11,131
Maav 36,200,104
s_xor_b32 s54, s54, 65536
Ra 228,2,61440
Vc 65,10,11
Maav 36,204,108
Ra 232,2,54272
v_or_b32_e64 v7, v64, v65
Mvvv 48,16,96
VE 12,144
Mvvv 48,16,100
s_waitcnt lgkmcnt(3)
Ra 236,2,62464
Ra 240,2,55296
Maav 8,208,96
buffer_load_dwordx4 v4, s[12:15], s39 offen offset:1024 sc1 lds
Maav 8,212,100
Ve 13,145
Maav 40,208,104
Ra 244,2,63488
Vc 72,12,13
Maav 40,212,108
VE 14,146
Maav 12,216,96
VE 15,147
Maav 12,220,100
Ra 248,2,56320
Vc 73,14,15
Maav 44,216,104
Ra 252,2,64512
v_or3_b32 v7, v7, v72, v73
Maav 44,220,108
VE 8,132
Mvvv 52,16,104
buffer_load_dwordx4 v4, s[12:15], s39 offen offset:2048 sc1 lds
Mvvv 52,16,108
s_waitcnt lgkmcnt(4)
Ve 9,133
Maav 16,224,96
Ra 192,3,32768
Vc 66,8,9
Maav 16,228,100
VE 10,134
Maav 48,224,104
VE 11,135
Maav 48,228,108
Ra 196,3,33792
Vc 67,10,11
Maav 20,232,96
Ra 200,3,34816
v_or3_b32 v7, v7, v66, v67
Maav 20,236,100
Ra 204,3,35840
Ra 208,3,36864
Maav 52,232,104
buffer_load_dwordx4 v4, s[12:15], s39 offen offset:3072 sc1 lds
Maav 52,236,108
s_waitcnt lgkmcnt(5)
Ve 12,148
Maav 24,240,96
s_add_u32 s39, s39, 34816
VE 13,149
Maav 24,244,100
Ra 212,3,37888
Vc 74,12,13
Maav 56,240,104
VE 14,150
Maav 56,244,108
VE 15,151
Maav 28,248,96
Ra 216,3,38912
Vc 75,14,15
Maav 28,252,100
s_cmp_lg_u32 s37, s36
Ra 220,3,39936
v_or3_b32 v7, v7, v74, v75
Maav 60,248,104
s_waitcnt lgkmcnt(4)
VE 8,136
Maav 60,252,108
s_cbranch_scc1 L_k2_nloop
L_k2_fin:
v_xor_b32 v2, 65536, v2
v_xor_b32 v3, 65536, v3
s_lshr_b32 s3, s42, 4
s_mul_i32 s3, s3, 33792
s_and_b32 s47, s42, 15
s_lshl_b32 s47, s47, 4
s_add_u32 s3, s3, s47
v_mov_b32 v28, s3
s_lshr_b32 s3, s43, 4
s_mul_i32 s3, s3, 33792
s_and_b32 s47, s43, 15
s_lshl_b32 s47, s47, 4
s_add_u32 s3, s3, s47
v_mov_b32 v29, s3
v_lshrrev_b32 v24, 4, v0
v_and_b32 v25, 15, v0
v_cmp_eq_u32 vcc, 1, v25
s_lshl_b32 s3, s32, 4
v_add_u32 v26, s3, v24
v_cndmask_b32 v28, v28, v29, vcc
v_lshl_add_u32 v28, v24, 8, v28
v_mul_u32_u24 v26, 7168, v26
v_lshlrev_b32 v24, 1, v24
v_xor_b32 v24, v24, v25
v_xor_b32 v25, 8, v24
v_lshl_add_u32 v24, v24, 4, v26
v_lshl_add_u32 v25, v25, 4, v26
s_lshl_b32 s3, s92, 12
buffer_load_dwordx4 a[160:163], v28, s[20:23], s3 offen offset:0 sc1
buffer_load_dwordx4 a[164:167], v28, s[20:23], s3 offen offset:1024 sc1
buffer_load_dwordx4 a[168:171], v28, s[20:23], s3 offen offset:2048 sc1
buffer_load_dwordx4 a[172:175], v28, s[20:23], s3 offen offset:3072 sc1
Cvaa 192,192,128,32
s_add_u32 m0, s54, 0
s_add_u32 s3, s5, 0
Ve 9,137
Mvaa 192,196,132
buffer_load_dwordx4 v24, s[24:27], s3 offen offset:0 lds
Mvaa 192,200,136
Ra 224,2,40960
Ra 228,2,41984
Mvaa 192,204,140
s_waitcnt lgkmcnt(2)
Ra 232,2,43008
Ra 236,2,44032
Cvaa 196,208,128,32
s_add_u32 s3, s5, 27648
Ra 240,2,45056
Vc 68,8,9
Mvaa 196,212,132
buffer_load_dwordx4 v24, s[24:27], s3 offen offset:1024 lds
Mvaa 196,216,136
Ra 244,2,46080
Ra 248,2,47104
Mvaa 196,220,140
s_waitcnt lgkmcnt(3)
s_add_u32 s3, s5, 55296
Ra 252,2,48128
Ra 192,2,16384
Cvaa 200,224,128,32
buffer_load_dwordx4 v25, s[24:27], s3 offen offset:2048 lds
Mvaa 200,228,132
s_cmp_lt_u32 s37, s52
Ve 10,138
Mvaa 200,232,136
s_cbranch_scc1 L_nw_nl
s_waitcnt vmcnt(15)
L_nw_nl:
Ra 196,2,24576
Ra 200,2,17408
Mvaa 200,236,140
s_waitcnt lgkmcnt(3)
s_add_u32 s3, s5, 82944
Ra 204,2,25600
Ra 208,2,18432
Cvaa 204,240,128,32
buffer_load_dwordx4 v25, s[24:27], s3 offen offset:3072 lds
Mvaa 204,244,132
s_barrier
VE 11,139
Mvaa 204,248,136
s_waitcnt lgkmcnt(1)
Ra 212,2,26624
Vc 69,10,11
Ve 12,152
Ve 13,153
Ve 14,154
Ve 15,155
Ve 8,140
Ve 9,141
Ve 10,142
VE 11,143
Vc 76,12,13
Ve 12,156
Ve 13,157
Vc 77,14,15
Ve 14,158
Ve 15,159
Vc 70,8,9
Vc 71,10,11
Vc 78,12,13
Vc 79,14,15
v_or3_b32 v7, v7, v68, v69
v_or3_b32 v7, v7, v76, v77
v_or3_b32 v7, v7, v70, v71
v_or3_b32 v7, v7, v78, v79
v_and_b32 v1, 0x40004000, v7
v_cmp_ne_u32 vcc, 0, v1
Mvaa 204,252,140
s_cbranch_vccnz L_k2_fb_nl
L_k2_fbr_nl:
Ra 216,2,19456
Ra 220,2,27648
Maav 0,192,64
v_cmp_gt_i32 s[56:57], 0, v6
v_cmp_gt_i32 s[58:59], 1, v6
v_cmp_gt_i32 s[60:61], 2, v6
v_cmp_gt_i32 s[62:63], 3, v6
s_nop 3
s_nop 0
v_cndmask_b32 v192, v192, v20, s[56:57]
v_cndmask_b32 v193, v193, v20, s[58:59]
v_cndmask_b32 v194, v194, v20, s[60:61]
v_cndmask_b32 v195, v195, v20, s[62:63]
v_cmp_gt_i32 s[56:57], 16, v6
v_cmp_gt_i32 s[58:59], 17, v6
v_cmp_gt_i32 s[60:61], 18, v6
v_cmp_gt_i32 s[62:63], 19, v6
v_cndmask_b32 v196, v196, v20, s[56:57]
v_cndmask_b32 v197, v197, v20, s[58:59]
v_cndmask_b32 v198, v198, v20, s[60:61]
v_cndmask_b32 v199, v199, v20, s[62:63]
v_cmp_gt_i32 s[56:57], 32, v6
v_cmp_gt_i32 s[58:59], 33, v6
v_cmp_gt_i32 s[60:61], 34, v6
v_cmp_gt_i32 s[62:63], 35, v6
v_cndmask_b32 v200, v200, v20, s[56:57]
v_cndmask_b32 v201, v201, v20, s[58:59]
v_cndmask_b32 v202, v202, v20, s[60:61]
v_cndmask_b32 v203, v203, v20, s[62:63]
v_cmp_gt_i32 s[56:57], 48, v6
v_cmp_gt_i32 s[58:59], 49, v6
v_cmp_gt_i32 s[60:61], 50, v6
v_cmp_gt_i32 s[62:63], 51, v6
v_cndmask_b32 v204, v204, v20, s[56:57]
v_cndmask_b32 v205, v205, v20, s[58:59]
v_cndmask_b32 v206, v206, v20, s[60:61]
v_cndmask_b32 v207, v207, v20, s[62:63]
VE 8,192
Maav 0,196,68
s_add_u32 m0, s54, 16384
s_add_u32 s3, s5, 458752
VE 9,193
Maav 32,192,72
buffer_load_dwordx4 v24, s[24:27], s3 offen offset:0 lds
Maav 32,196,76
s_add_u32 s3, s5, 486400
Ra 224,2,20480
Vc 96,8,9
Maav 4,200,64
buffer_load_dwordx4 v24, s[24:27], s3 offen offset:1024 lds
Maav 4,204,68
s_mov_b32 s60, s8
s_and_b32 s61, s9, 0xffff
Ve 10,194
Maav 36,200,72
s_add_u32 s3, s5, 514048
VE 11,195
Maav 36,204,76
buffer_load_dwordx4 v25, s[24:27], s3 offen offset:2048 lds
Mvvv 48,16,64
s_mov_b32 s62, 7340032
Ra 228,2,28672
Vc 97,10,11
Mvvv 48,16,68
s_waitcnt lgkmcnt(2)
s_add_u32 s3, s5, 541696
Ra 232,2,21504
Ra 236,2,29696
Maav 8,208,64
buffer_load_dwordx4 v25, s[24:27], s3 offen offset:3072 lds
Maav 8,212,68
s_add_u32 m0, s54, 32768
s_add_u32 s3, s5, 0
Ra 240,2,22528
v_or_b32_e64 v7, v96, v97
Maav 40,208,72
buffer_load_dwordx4 v24, s[68:71], s3 offen offset:0 lds
Maav 40,212,76
s_mov_b32 s63, 0x20000
s_mov_b32 s56, s40
Ve 12,196
Maav 12,216,64
s_add_u32 s3, s5, 27648
VE 13,197
Maav 12,220,68
buffer_load_dwordx4 v24, s[68:71], s3 offen offset:1024 lds
Maav 44,216,72
s_and_b32 s57, s41, 0xffff
Ra 244,2,30720
Vc 98,12,13
Maav 44,220,76
s_add_u32 s3, s5, 55296
VE 14,198
Mvvv 52,16,72
buffer_load_dwordx4 v25, s[68:71], s3 offen offset:2048 lds
Mvvv 52,16,76
s_waitcnt lgkmcnt(2)
s_add_u32 s3, s5, 82944
Ra 248,2,23552
Ra 252,2,31744
Maav 16,224,64
buffer_load_dwordx4 v25, s[68:71], s3 offen offset:3072 lds
Maav 16,228,68
s_mov_b32 s58, 4194304
s_mov_b32 s59, 0x20000
Ve 15,199
Maav 48,224,72
s_add_u32 m0, s54, 49152
s_add_u32 s3, s5, 458752
Ra 192,2,49152
Vc 99,14,15
Maav 48,228,76
buffer_load_dwordx4 v24, s[68:71], s3 offen offset:0 lds
Maav 20,232,64
s_bfe_u32 s6, s2, 0x20001
Ra 196,2,57344
v_or3_b32 v7, v7, v98, v99
Maav 20,236,68
s_add_u32 s3, s5, 486400
Ra 200,2,50176
Ra 204,2,58368
Maav 52,232,72
buffer_load_dwordx4 v24, s[68:71], s3 offen offset:1024 lds
Maav 52,236,76
s_waitcnt lgkmcnt(4)
s_add_u32 s3, s5, 514048
Ve 8,200
Maav 24,240,64
buffer_load_dwordx4 v25, s[68:71], s3 offen offset:2048 lds
Maav 24,244,68
s_lshr_b32 s7, s34, 1
s_lshl_b32 s45, s7, 2
VE 9,201
Maav 56,240,72
s_add_u32 s3, s5, 541696
Ra 208,2,51200
Vc 100,8,9
Maav 56,244,76
buffer_load_dwordx4 v25, s[68:71], s3 offen offset:3072 lds
Maav 28,248,64
s_add_u32 s46, s45, s6
s_sub_u32 s46, 15, s46
VE 10,202
Maav 28,252,68
s_sub_u32 s45, 12, s45
Ra 212,2,59392
Ra 216,2,52224
Maav 60,248,72
s_waitcnt lgkmcnt(3)
Ra 220,2,60416
Ve 11,203
Ve 12,204
Ve 13,205
Ve 14,206
VE 15,207
Vc 101,10,11
Vc 102,12,13
Vc 103,14,15
v_or3_b32 v7, v7, v100, v101
v_or3_b32 v7, v7, v102, v103
Maav 60,252,76
s_add_u32 s45, s45, s6
v_and_b32 v1, 0x40004000, v7
v_cmp_ne_u32 vcc, 0, v1
s_cbranch_vccnz L_k2_fb_fi
L_k2_fbr_fi:
Maav 0,192,96
Ra 224,2,53248
Ra 228,2,61440
Maav 0,196,100
Ra 232,2,54272
Ra 236,2,62464
Maav 4,200,96
Ra 240,2,55296
Ra 244,2,63488
Maav 4,204,100
Ra 248,2,56320
Ra 252,2,64512
Mvvv 48,16,96
s_cmp_lt_u32 s7, 2
s_cselect_b32 s45, s46, s45
Mvvv 48,16,100
s_waitcnt lgkmcnt(8)
Maav 8,208,96
s_and_b32 s46, s2, 1
s_bfe_u32 s6, s2, 0x30003
s_lshl_b32 s6, s6, 1
Maav 8,212,100
s_add_u32 s46, s46, s6
s_mov_b32 s48, 0
s_mov_b32 s49, 15360
Maav 12,216,96
s_mov_b32 s50, 30720
s_mov_b32 s51, 46080
s_lshl_b32 s35, s32, 13
Maav 12,220,100
s_waitcnt lgkmcnt(4)
Maav 16,224,96
s_add_u32 s35, s35, 131072
s_and_b32 s52, s46, 1
s_lshl_b32 s37, s45, 20
Maav 16,228,100
s_lshl_b32 s7, s52, 19
s_add_u32 s37, s37, s7
s_add_u32 s37, s37, 46137344
Maav 20,232,96
s_lshr_b32 s7, s46, 1
s_lshl_b32 s7, s7, 8
s_lshl_b32 s6, s52, 22
Maav 20,236,100
s_waitcnt lgkmcnt(0)
Maav 24,240,96
s_add_u32 s6, s6, s7
s_add_u32 s12, s94, s6
s_addc_u32 s13, s95, 0
s_and_b32 s13, s13, 0xffff
Maav 24,244,100
s_mov_b32 s14, 0
s_mov_b32 s15, 0x20000
s_sub_u32 s14, 4194304, s7
Maav 28,248,96
s_mov_b32 s28, s94
s_and_b32 s29, s95, 0xffff
s_mov_b32 s30, 8388608
Maav 28,252,100
s_mov_b32 s31, 0x20000
s_lshl_b32 s7, s46, 7
s_lshl_b32 s36, s45, 18
s_nop 7
s_lshl_b32 s3, s55, 20
s_lshl_b32 s47, s33, 15
s_add_u32 s3, s3, s47
s_lshl_b32 s47, s32, 10
v_lshlrev_b32 v248, 4, v0
v_add_u32 v249, s47, v248
s_sub_u32 s47, 7168, s47
v_add_u32 v248, s47, v248
v_rcp_f32 v250, v48
v_rcp_f32 v252, v52
v_mov_b32 v251, v250
v_mov_b32_e64 v253, v252
Ar 240,32
Ar 241,33
Ar 242,34
Ar 243,35
Ar 244,36
Ar 245,37
Ar 246,38
Ar 247,39
v_pk_mul_f32 v[240:241], v[240:241], v[252:253]
v_pk_mul_f32 v[242:243], v[242:243], v[252:253]
v_pk_mul_f32 v[244:245], v[244:245], v[252:253]
v_pk_mul_f32 v[246:247], v[246:247], v[252:253]
Vc 28,240,241
Vc 29,242,243
Vc 30,244,245
Vc 31,246,247
buffer_store_dwordx4 v[28:31], v249, s[16:19], s3 offen sc1
Ar 240,0
Ar 241,1
Ar 242,2
Ar 243,3
Ar 244,4
Ar 245,5
Ar 246,6
Ar 247,7
v_pk_mul_f32 v[240:241], v[240:241], v[250:251]
v_pk_mul_f32 v[242:243], v[242:243], v[250:251]
v_pk_mul_f32 v[244:245], v[244:245], v[250:251]
v_pk_mul_f32 v[246:247], v[246:247], v[250:251]
Vc 24,240,241
Vc 25,242,243
Vc 26,244,245
Vc 27,246,247
buffer_store_dwordx4 v[24:27], v248, s[16:19], s3 offen sc1
s_add_u32 s3, s3, 8192
Ar 240,40
Ar 241,41
Ar 242,42
Ar 243,43
Ar 244,44
Ar 245,45
Ar 246,46
Ar 247,47
v_pk_mul_f32 v[240:241], v[240:241], v[252:253]
v_pk_mul_f32 v[242:243], v[242:243], v[252:253]
v_pk_mul_f32 v[244:245], v[244:245], v[252:253]
v_pk_mul_f32 v[246:247], v[246:247], v[252:253]
Vc 28,240,241
Vc 29,242,243
Vc 30,244,245
Vc 31,246,247
buffer_store_dwordx4 v[28:31], v249, s[16:19], s3 offen sc1
Ar 240,8
Ar 241,9
Ar 242,10
Ar 243,11
Ar 244,12
Ar 245,13
Ar 246,14
Ar 247,15
v_pk_mul_f32 v[240:241], v[240:241], v[250:251]
v_pk_mul_f32 v[242:243], v[242:243], v[250:251]
v_pk_mul_f32 v[244:245], v[244:245], v[250:251]
v_pk_mul_f32 v[246:247], v[246:247], v[250:251]
Vc 24,240,241
Vc 25,242,243
Vc 26,244,245
Vc 27,246,247
buffer_store_dwordx4 v[24:27], v248, s[16:19], s3 offen sc1
s_add_u32 s3, s3, 8192
Ar 240,48
Ar 241,49
Ar 242,50
Ar 243,51
Ar 244,52
Ar 245,53
Ar 246,54
Ar 247,55
v_pk_mul_f32 v[240:241], v[240:241], v[252:253]
v_pk_mul_f32 v[242:243], v[242:243], v[252:253]
v_pk_mul_f32 v[244:245], v[244:245], v[252:253]
v_pk_mul_f32 v[246:247], v[246:247], v[252:253]
Vc 28,240,241
Vc 29,242,243
Vc 30,244,245
Vc 31,246,247
buffer_store_dwordx4 v[28:31], v249, s[16:19], s3 offen sc1
Ar 240,16
Ar 241,17
Ar 242,18
Ar 243,19
Ar 244,20
Ar 245,21
Ar 246,22
Ar 247,23
v_pk_mul_f32 v[240:241], v[240:241], v[250:251]
v_pk_mul_f32 v[242:243], v[242:243], v[250:251]
v_pk_mul_f32 v[244:245], v[244:245], v[250:251]
v_pk_mul_f32 v[246:247], v[246:247], v[250:251]
Vc 24,240,241
Vc 25,242,243
Vc 26,244,245
Vc 27,246,247
buffer_store_dwordx4 v[24:27], v248, s[16:19], s3 offen sc1
s_add_u32 s3, s3, 8192
Ar 240,56
Ar 241,57
Ar 242,58
Ar 243,59
Ar 244,60
Ar 245,61
Ar 246,62
Ar 247,63
v_pk_mul_f32 v[240:241], v[240:241], v[252:253]
v_pk_mul_f32 v[242:243], v[242:243], v[252:253]
v_pk_mul_f32 v[244:245], v[244:245], v[252:253]
v_pk_mul_f32 v[246:247], v[246:247], v[252:253]
Vc 28,240,241
Vc 29,242,243
Vc 30,244,245
Vc 31,246,247
buffer_store_dwordx4 v[28:31], v249, s[16:19], s3 offen sc1
Ar 240,24
Ar 241,25
Ar 242,26
Ar 243,27
Ar 244,28
Ar 245,29
Ar 246,30
Ar 247,31
v_pk_mul_f32 v[240:241], v[240:241], v[250:251]
v_pk_mul_f32 v[242:243], v[242:243], v[250:251]
v_pk_mul_f32 v[244:245], v[244:245], v[250:251]
v_pk_mul_f32 v[246:247], v[246:247], v[250:251]
Vc 24,240,241
Vc 25,242,243
Vc 26,244,245
Vc 27,246,247
buffer_store_dwordx4 v[24:27], v248, s[16:19], s3 offen sc1
s_cmp_ge_u32 s93, 224
s_cbranch_scc1 L_noffn
v_lshrrev_b32 v24, 4, v0
v_bfe_u32 v25, v0, 2, 2
v_lshl_add_u32 v26, v24, 3, v25
v_lshlrev_b32 v26, 8, v26
v_and_b32 v27, 3, v0
v_lshl_add_u32 v26, v27, 3, v26
v_and_b32_e64 v27, 1, v24
v_lshl_add_u32 v25, v27, 2, v25
s_lshl_b32 s3, s32, 1
v_xor_b32 v25, s3, v25
v_lshl_add_u32 v26, v25, 5, v26
s_sub_u32 s3, s54, s44
v_add_u32 v26, s3, v26
v_xor_b32 v27, 32, v26
s_waitcnt vmcnt(8) lgkmcnt(0)
s_barrier
s_nop 0
ds_read_b64_tr_b16 v[128:129], v26 offset:0
ds_read_b64_tr_b16 v[130:131], v26 offset:1024
ds_read_b64_tr_b16 v[132:133], v27 offset:0
ds_read_b64_tr_b16 v[134:135], v27 offset:1024
ds_read_b64_tr_b16 v[136:137], v26 offset:8192
ds_read_b64_tr_b16 v[138:139], v26 offset:9216
ds_read_b64_tr_b16 v[140:141], v27 offset:8192
ds_read_b64_tr_b16 v[142:143], v27 offset:9216
ds_read_b64_tr_b16 v[144:145], v26 offset:16384
ds_read_b64_tr_b16 v[146:147], v26 offset:17408
ds_read_b64_tr_b16 v[148:149], v27 offset:16384
ds_read_b64_tr_b16 v[150:151], v27 offset:17408
ds_read_b64_tr_b16 v[152:153], v26 offset:24576
ds_read_b64_tr_b16 v[154:155], v26 offset:25600
ds_read_b64_tr_b16 v[156:157], v27 offset:24576
s_waitcnt lgkmcnt(9)
s_nop 0
ds_read_b64_tr_b16 v[158:159], v27 offset:25600
ds_read_b64_tr_b16 v[160:161], v26 offset:32768
ds_read_b64_tr_b16 v[162:163], v26 offset:33792
ds_read_b64_tr_b16 v[164:165], v27 offset:32768
ds_read_b64_tr_b16 v[166:167], v27 offset:33792
ds_read_b64_tr_b16 v[168:169], v26 offset:40960
s_waitcnt lgkmcnt(9)
s_nop 0
ds_read_b64_tr_b16 v[170:171], v26 offset:41984
ds_read_b64_tr_b16 v[172:173], v27 offset:40960
ds_read_b64_tr_b16 v[174:175], v27 offset:41984
ds_read_b64_tr_b16 v[176:177], v26 offset:49152
ds_read_b64_tr_b16 v[178:179], v26 offset:50176
ds_read_b64_tr_b16 v[180:181], v27 offset:49152
s_waitcnt lgkmcnt(9)
ds_read_b64_tr_b16 v[182:183], v27 offset:50176
ds_read_b64_tr_b16 v[184:185], v26 offset:57344
ds_read_b64_tr_b16 v[186:187], v26 offset:58368
ds_read_b64_tr_b16 v[188:189], v27 offset:57344
ds_read_b64_tr_b16 v[190:191], v27 offset:58368
v_and_b32 v25, 15, v0
v_mul_u32_u24 v28, 14336, v25
v_lshl_add_u32 v28, v24, 4, v28
v_mov_b32 v29, 2146435072
v_cmp_gt_u32 vcc, 2, v25
s_mul_i32 s3, s92, 57344
s_lshl_b32 s47, s4, 9
s_add_u32 s3, s3, s47
v_cndmask_b32 v28, v29, v28, vcc
s_lshl_b32 s47, s32, 7
s_add_u32 s3, s3, s47
s_add_u32 s3, s3, 6291456
Zvva 224,128,160
Zvva 228,132,160
Mvva 224,136,164
Mvva 228,140,164
Mvva 224,144,168
Mvva 228,148,168
Mvva 224,152,172
Mvva 228,156,172
s_waitcnt lgkmcnt(0)
Zvva 232,160,160
Zvva 236,164,160
Mvva 232,168,164
Mvva 236,172,164
Mvva 232,176,168
Mvva 236,180,168
Mvva 232,184,172
Mvva 236,188,172
L_noffn:
s_add_u32 s36, s36, s7
s_and_b32 s94, s7, 128
s_lshl_b32 s38, s45, 7
s_lshl_b32 s6, s52, 6
s_add_u32 s38, s38, s6
s_add_u32 s38, s38, 5300224
s_lshl_b32 s52, s32, 11
s_and_b32 s6, s32, 1
s_lshl_b32 s6, s6, 16
s_lshr_b32 s7, s32, 1
s_lshl_b32 s7, s7, 7
s_xor_b32 s7, s7, s94
s_xor_b32 s7, s7, 128
s_add_u32 s6, s6, s7
s_lshl_b32 s7, s32, 5
s_mov_b32 s68, s10
s_and_b32 s69, s11, 0xffff
s_mov_b32 s70, 4194304
s_mov_b32 s71, 0x20000
s_add_u32 s8, s66, s37
s_addc_u32 s9, s67, 0
s_and_b32 s9, s9, 0xffff
s_mov_b32 s10, 524288
s_mov_b32 s11, 0x20000
v_lshlrev_b32 v112, 4, v0
v_lshrrev_b32 v121, 4, v0
v_and_b32 v122, 7, v0
v_lshrrev_b32 v123, 3, v0
v_lshlrev_b32 v124, 1, v121
v_xor_b32 v124, v124, v122
v_lshlrev_b32_e64 v124, 4, v124
v_lshl_add_u32 v113, v123, 11, v124
v_add_u32 v114, s6, v113
v_lshrrev_b32 v124, 2, v0
v_bfe_u32 v126, v0, 3, 2
v_lshlrev_b32 v124, 7, v124
v_and_b32 v125, 3, v0
v_lshl_add_u32 v124, v125, 3, v124
v_lshl_add_u32 v115, v126, 5, v124
v_xor_b32 v116, 32, v115
v_xor_b32 v117, 64, v115
v_xor_b32 v118, 96, v115
v_add_u32 v120, s7, v123
v_lshlrev_b32 v119, 11, v120
v_lshl_add_u32 v119, v122, 4, v119
v_mov_b32 v126, 0
v_lshlrev_b32 v127, 2, v122
v_mov_b32 v24, 1
v_mul_u32_u24 v25, s65, v0
s_waitcnt vmcnt(0)
s_barrier
s_mov_b64 exec, 3
buffer_store_dword v24, v25, s[20:23], s64 offen sc1
s_mov_b64 exec, -1
s_cmp_lt_u32 s93, 224
s_cselect_b32 s3, s3, 8388608
s_add_u32 s7, s3, 28672
buffer_store_dwordx4 v[224:227], v28, s[20:23], s3 offen offset:0 sc1
buffer_store_dwordx4 v[228:231], v28, s[20:23], s3 offen offset:64 sc1
buffer_store_dwordx4 v[232:235], v28, s[20:23], s7 offen offset:0 sc1
buffer_store_dwordx4 v[236:239], v28, s[20:23], s7 offen offset:64 sc1
s_mov_b32 s3, s36
s_nop 0
buffer_load_dwordx4 v[18:21], v119, s[56:59], s3 offen
s_add_u32 s3, s3, 16384
buffer_load_dwordx4 v[22:25], v119, s[56:59], s3 offen
s_add_u32 s3, s3, 16384
buffer_load_dwordx4 v[26:29], v119, s[56:59], s3 offen
s_add_u32 s3, s3, 16384
buffer_load_dwordx4 v[30:33], v119, s[56:59], s3 offen
s_lshl_b32 s3, s45, 10
s_add_u32 s3, s3, 5259264
v_lshlrev_b32 v124, 3, v120
buffer_load_dwordx2 v[34:35], v124, s[20:23], s3 offen offset:0 sc1
buffer_load_dwordx2 v[36:37], v124, s[20:23], s3 offen offset:64 sc1
buffer_load_dwordx2 v[38:39], v124, s[20:23], s3 offen offset:128 sc1
buffer_load_dwordx2 v[40:41], v124, s[20:23], s3 offen offset:192 sc1
v_and_b32 v10, 15, v0
v_lshlrev_b32 v10, 2, v10
s_add_u32 s95, s32, 32
s_lshl_b32 s95, s95, 16
s_add_u32 s95, s95, s94
s_xor_b32 s95, s95, 128
s_add_u32 m0, s44, 0
s_nop 0
s_nop 0
buffer_load_dwordx4 v114, s[12:15], s48 offen offset:0 lds
buffer_load_dwordx4 v114, s[12:15], s49 offen offset:1024 lds
buffer_load_dwordx4 v114, s[12:15], s50 offen offset:2048 lds
buffer_load_dwordx4 v114, s[12:15], s51 offen offset:3072 lds
v_add_u32 v114, 131072, v114
s_add_u32 m0, s44, 16384
s_nop 0
s_nop 0
buffer_load_dwordx4 v114, s[12:15], s48 offen offset:0 lds
buffer_load_dwordx4 v114, s[12:15], s49 offen offset:1024 lds
buffer_load_dwordx4 v114, s[12:15], s50 offen offset:2048 lds
buffer_load_dwordx4 v114, s[12:15], s51 offen offset:3072 lds
v_add_u32 v114, 131072, v114
buffer_load_dword v124, v10, s[20:23], s38 offen sc1
v_add_u32 v12, 65536, v115
v_add_u32 v13, 65536, v116
v_add_u32 v14, 65536, v117
v_add_u32 v15, 65536, v118
s_and_b32 s39, s93, 15
s_lshr_b32 s37, s93, 4
s_lshl_b32 s54, s37, 2
s_add_u32 s54, s54, s32
s_lshl_b32 s3, s54, 17
s_lshl_b32 s7, s39, 7
s_add_u32 s3, s3, s7
s_cmp_lt_u32 s93, 224
s_cselect_b32 s3, s3, 2146435072
v_add_u32 v125, s3, v113
s_mov_b32 s40, 0
s_waitcnt vmcnt(9)
v_lshlrev_b32_e64 v42, 16, v18
v_and_b32 v43, 0xffff0000, v18
v_lshlrev_b32_e64 v44, 16, v19
v_and_b32 v45, 0xffff0000, v19
v_lshlrev_b32_e64 v46, 16, v20
v_and_b32 v47, 0xffff0000, v20
v_lshlrev_b32_e64 v48, 16, v21
v_and_b32 v49, 0xffff0000, v21
v_pk_add_f32 v[42:43], v[42:43], v[34:35] op_sel_hi:[1,0] neg_lo:[0,1] neg_hi:[0,1]
v_pk_add_f32 v[44:45], v[44:45], v[34:35] op_sel_hi:[1,0] neg_lo:[0,1] neg_hi:[0,1]
v_pk_add_f32 v[46:47], v[46:47], v[34:35] op_sel_hi:[1,0] neg_lo:[0,1] neg_hi:[0,1]
v_pk_add_f32 v[48:49], v[48:49], v[34:35] op_sel_hi:[1,0] neg_lo:[0,1] neg_hi:[0,1]
Vc 2,42,43
v_lshlrev_b32_e64 v42, 16, v2
v_and_b32 v43, 0xffff0000, v2
Vc 3,44,45
v_lshlrev_b32_e64 v44, 16, v3
v_and_b32 v45, 0xffff0000, v3
Vc 4,46,47
v_lshlrev_b32_e64 v46, 16, v4
v_and_b32 v47, 0xffff0000, v4
Vc 5,48,49
v_lshlrev_b32_e64 v48, 16, v5
v_and_b32 v49, 0xffff0000, v5
v_pk_mul_f32 v[42:43], v[42:43], v[34:35] op_sel:[0,1] op_sel_hi:[1,1]
v_pk_mul_f32 v[44:45], v[44:45], v[34:35] op_sel:[0,1] op_sel_hi:[1,1]
v_pk_mul_f32 v[46:47], v[46:47], v[34:35] op_sel:[0,1] op_sel_hi:[1,1]
v_pk_mul_f32 v[48:49], v[48:49], v[34:35] op_sel:[0,1] op_sel_hi:[1,1]
Vc 2,42,43
v_lshlrev_b32_e64 v42, 16, v2
v_and_b32 v43, 0xffff0000, v2
Vc 3,44,45
v_lshlrev_b32_e64 v44, 16, v3
v_and_b32 v45, 0xffff0000, v3
Vc 4,46,47
v_lshlrev_b32_e64 v46, 16, v4
v_and_b32 v47, 0xffff0000, v4
Vc 5,48,49
v_lshlrev_b32_e64 v48, 16, v5
v_and_b32 v49, 0xffff0000, v5
v_mul_f32 v2, 0xbfb8aa3b, v42
v_mul_f32 v3, 0xbfb8aa3b, v43
v_mul_f32 v4, 0xbfb8aa3b, v44
v_mul_f32 v5, 0xbfb8aa3b, v45
v_mul_f32 v6, 0xbfb8aa3b, v46
v_mul_f32 v7, 0xbfb8aa3b, v47
v_mul_f32 v8, 0xbfb8aa3b, v48
v_mul_f32 v9, 0xbfb8aa3b, v49
Ve 2,2
Ve 3,3
Ve 4,4
Ve 5,5
Ve 6,6
Ve 7,7
Ve 8,8
Ve 9,9
v_add_f32 v2, 1.0, v2
v_add_f32 v3, 1.0, v3
v_add_f32 v4, 1.0, v4
v_add_f32 v5, 1.0, v5
v_add_f32 v6, 1.0, v6
v_add_f32 v7, 1.0, v7
v_add_f32 v8, 1.0, v8
v_add_f32 v9, 1.0, v9
v_rcp_f32 v2, v2
v_rcp_f32 v3, v3
v_rcp_f32 v4, v4
v_rcp_f32 v5, v5
v_rcp_f32 v6, v6
v_rcp_f32 v7, v7
v_rcp_f32 v8, v8
v_rcp_f32 v9, v9
v_pk_mul_f32 v[42:43], v[42:43], v[2:3]
v_pk_mul_f32 v[44:45], v[44:45], v[4:5]
v_pk_mul_f32 v[46:47], v[46:47], v[6:7]
v_pk_mul_f32 v[48:49], v[48:49], v[8:9]
Vc 2,42,43
v_lshlrev_b32_e64 v42, 16, v2
v_and_b32 v43, 0xffff0000, v2
Vc 3,44,45
v_lshlrev_b32_e64 v44, 16, v3
v_and_b32 v45, 0xffff0000, v3
Vc 4,46,47
v_lshlrev_b32_e64 v46, 16, v4
v_and_b32 v47, 0xffff0000, v4
Vc 5,48,49
v_lshlrev_b32_e64 v48, 16, v5
v_and_b32 v49, 0xffff0000, v5
s_waitcnt vmcnt(0)
v_cmp_ne_u32 vcc, 1, v124
s_cbranch_vccnz L_spinC
s_nop 0
L_spinCr:
buffer_load_dwordx4 a[0:3], v112, s[8:11], s52 offen offset:0 sc1
buffer_load_dwordx4 a[4:7], v112, s[8:11], s52 offen offset:1024 sc1
s_add_u32 s52, s52, 8192
buffer_load_dwordx4 a[8:11], v112, s[8:11], s52 offen offset:0 sc1
buffer_load_dwordx4 a[12:15], v112, s[8:11], s52 offen offset:1024 sc1
s_add_u32 s52, s52, 8192
buffer_load_dwordx4 a[16:19], v112, s[8:11], s52 offen offset:0 sc1
buffer_load_dwordx4 a[20:23], v112, s[8:11], s52 offen offset:1024 sc1
s_add_u32 s52, s52, 8192
buffer_load_dwordx4 a[24:27], v112, s[8:11], s52 offen offset:0 sc1
buffer_load_dwordx4 a[28:31], v112, s[8:11], s52 offen offset:1024 sc1
s_add_u32 s52, s52, 8192
v_lshlrev_b32_e64 v50, 16, v22
v_and_b32 v51, 0xffff0000, v22
v_lshlrev_b32_e64 v52, 16, v23
v_and_b32 v53, 0xffff0000, v23
v_lshlrev_b32_e64 v54, 16, v24
v_and_b32 v55, 0xffff0000, v24
v_lshlrev_b32_e64 v56, 16, v25
v_and_b32 v57, 0xffff0000, v25
v_pk_add_f32 v[50:51], v[50:51], v[36:37] op_sel_hi:[1,0] neg_lo:[0,1] neg_hi:[0,1]
v_pk_add_f32 v[52:53], v[52:53], v[36:37] op_sel_hi:[1,0] neg_lo:[0,1] neg_hi:[0,1]
v_pk_add_f32 v[54:55], v[54:55], v[36:37] op_sel_hi:[1,0] neg_lo:[0,1] neg_hi:[0,1]
v_pk_add_f32 v[56:57], v[56:57], v[36:37] op_sel_hi:[1,0] neg_lo:[0,1] neg_hi:[0,1]
Vc 2,50,51
v_lshlrev_b32_e64 v50, 16, v2
v_and_b32 v51, 0xffff0000, v2
Vc 3,52,53
v_lshlrev_b32_e64 v52, 16, v3
v_and_b32 v53, 0xffff0000, v3
Vc 4,54,55
v_lshlrev_b32_e64 v54, 16, v4
v_and_b32 v55, 0xffff0000, v4
Vc 5,56,57
v_lshlrev_b32_e64 v56, 16, v5
v_and_b32 v57, 0xffff0000, v5
v_pk_mul_f32 v[50:51], v[50:51], v[36:37] op_sel:[0,1] op_sel_hi:[1,1]
v_pk_mul_f32 v[52:53], v[52:53], v[36:37] op_sel:[0,1] op_sel_hi:[1,1]
v_pk_mul_f32 v[54:55], v[54:55], v[36:37] op_sel:[0,1] op_sel_hi:[1,1]
v_pk_mul_f32 v[56:57], v[56:57], v[36:37] op_sel:[0,1] op_sel_hi:[1,1]
Vc 2,50,51
v_lshlrev_b32_e64 v50, 16, v2
v_and_b32 v51, 0xffff0000, v2
Vc 3,52,53
v_lshlrev_b32_e64 v52, 16, v3
v_and_b32 v53, 0xffff0000, v3
Vc 4,54,55
v_lshlrev_b32_e64 v54, 16, v4
v_and_b32 v55, 0xffff0000, v4
Vc 5,56,57
v_lshlrev_b32_e64 v56, 16, v5
v_and_b32 v57, 0xffff0000, v5
v_mul_f32 v2, 0xbfb8aa3b, v50
v_mul_f32 v3, 0xbfb8aa3b, v51
v_mul_f32 v4, 0xbfb8aa3b, v52
v_mul_f32 v5, 0xbfb8aa3b, v53
v_mul_f32 v6, 0xbfb8aa3b, v54
v_mul_f32 v7, 0xbfb8aa3b, v55
v_mul_f32 v8, 0xbfb8aa3b, v56
v_mul_f32 v9, 0xbfb8aa3b, v57
Ve 2,2
Ve 3,3
Ve 4,4
Ve 5,5
Ve 6,6
Ve 7,7
Ve 8,8
Ve 9,9
v_add_f32 v2, 1.0, v2
v_add_f32 v3, 1.0, v3
v_add_f32 v4, 1.0, v4
v_add_f32 v5, 1.0, v5
v_add_f32 v6, 1.0, v6
v_add_f32 v7, 1.0, v7
v_add_f32 v8, 1.0, v8
v_add_f32 v9, 1.0, v9
v_rcp_f32 v2, v2
v_rcp_f32 v3, v3
v_rcp_f32 v4, v4
v_rcp_f32 v5, v5
v_rcp_f32 v6, v6
v_rcp_f32 v7, v7
v_rcp_f32 v8, v8
v_rcp_f32 v9, v9
v_pk_mul_f32 v[50:51], v[50:51], v[2:3]
v_pk_mul_f32 v[52:53], v[52:53], v[4:5]
v_pk_mul_f32 v[54:55], v[54:55], v[6:7]
v_pk_mul_f32 v[56:57], v[56:57], v[8:9]
Vc 2,50,51
v_lshlrev_b32_e64 v50, 16, v2
v_and_b32 v51, 0xffff0000, v2
Vc 3,52,53
v_lshlrev_b32_e64 v52, 16, v3
v_and_b32 v53, 0xffff0000, v3
Vc 4,54,55
v_lshlrev_b32_e64 v54, 16, v4
v_and_b32 v55, 0xffff0000, v4
Vc 5,56,57
v_lshlrev_b32_e64 v56, 16, v5
v_and_b32 v57, 0xffff0000, v5
buffer_load_dwordx4 a[32:35], v112, s[8:11], s52 offen offset:0 sc1
buffer_load_dwordx4 a[36:39], v112, s[8:11], s52 offen offset:1024 sc1
s_add_u32 s52, s52, 8192
buffer_load_dwordx4 a[40:43], v112, s[8:11], s52 offen offset:0 sc1
buffer_load_dwordx4 a[44:47], v112, s[8:11], s52 offen offset:1024 sc1
s_add_u32 s52, s52, 8192
s_add_u32 m0, s44, 32768
s_nop 0
buffer_load_dwordx4 v114, s[12:15], s48 offen offset:0 lds
buffer_load_dwordx4 v114, s[12:15], s49 offen offset:1024 lds
buffer_load_dwordx4 v114, s[12:15], s50 offen offset:2048 lds
buffer_load_dwordx4 v114, s[12:15], s51 offen offset:3072 lds
v_add_u32 v114, 131072, v114
s_cmp_lg_u32 s40, 0
s_cbranch_scc1 L_nowd
s_add_u32 m0, s35, 0
s_nop 0
s_nop 0
buffer_load_dwordx4 v125, s[60:63], s48 offen offset:0 lds
buffer_load_dwordx4 v125, s[60:63], s49 offen offset:1024 lds
buffer_load_dwordx4 v125, s[60:63], s50 offen offset:2048 lds
buffer_load_dwordx4 v125, s[60:63], s51 offen offset:3072 lds
v_add_u32 v125, 65536, v125
s_add_u32 m0, s35, 4096
s_nop 0
buffer_load_dwordx4 v125, s[60:63], s48 offen offset:0 lds
buffer_load_dwordx4 v125, s[60:63], s49 offen offset:1024 lds
buffer_load_dwordx4 v125, s[60:63], s50 offen offset:2048 lds
buffer_load_dwordx4 v125, s[60:63], s51 offen offset:3072 lds
L_nowd:
s_cmp_lt_u32 s2, 128
s_cbranch_scc1 L_noc3
s_bfe_u32 s3, s2, 0x40003
s_lshl_b32 s3, s3, 2
s_add_u32 s3, s3, s32
s_lshl_b32 s3, s3, 15
s_and_b32 s7, s2, 1
s_lshl_b32 s7, s7, 22
s_add_u32 s3, s3, s7
s_add_u32 s3, s3, 384
v_and_b32 v1, 15, v0
v_lshlrev_b32 v1, 11, v1
v_lshrrev_b32_e64 v11, 5, v0
v_lshl_add_u32 v1, v11, 10, v1
buffer_load_dword v11, v1, s[28:31], s3 offen
L_noc3:
s_barrier
s_nop 0
ds_read_b64_tr_b16 v[192:193], v115 offset:0
ds_read_b64_tr_b16 v[194:195], v115 offset:2048
ds_read_b64_tr_b16 v[196:197], v116 offset:0
ds_read_b64_tr_b16 v[198:199], v116 offset:2048
ds_read_b64_tr_b16 v[200:201], v117 offset:0
ds_read_b64_tr_b16 v[202:203], v117 offset:2048
ds_read_b64_tr_b16 v[204:205], v118 offset:0
ds_read_b64_tr_b16 v[206:207], v118 offset:2048
ds_read_b64_tr_b16 v[208:209], v115 offset:4096
ds_read_b64_tr_b16 v[210:211], v115 offset:6144
ds_read_b64_tr_b16 v[212:213], v116 offset:4096
ds_read_b64_tr_b16 v[214:215], v116 offset:6144
ds_read_b64_tr_b16 v[216:217], v117 offset:4096
ds_read_b64_tr_b16 v[218:219], v117 offset:6144
ds_read_b64_tr_b16 v[220:221], v118 offset:4096
s_waitcnt lgkmcnt(9)
ds_read_b64_tr_b16 v[222:223], v118 offset:6144
s_waitcnt vmcnt(12)
Zvva 160,192,0
ds_read_b64_tr_b16 v[224:225], v115 offset:8192
ds_read_b64_tr_b16 v[226:227], v115 offset:10240
v_mov_b32 v125, 1
s_waitcnt lgkmcnt(8)
Mvva 160,208,8
s_lshl_b32 s6, s4, 3
s_add_u32 s6, s6, s92
s_lshl_b32 s6, s6, 2
Zvva 176,192,4
s_waitcnt lgkmcnt(6)
s_add_u32 m0, s44, 49152
ds_read_b64_tr_b16 v[240:241], v115 offset:12288
ds_read_b64_tr_b16 v[242:243], v115 offset:14336
Mvva 176,208,12
buffer_load_dwordx4 v114, s[12:15], s48 offen offset:0 lds
Zvva 164,196,0
ds_read_b64_tr_b16 v[228:229], v116 offset:8192
ds_read_b64_tr_b16 v[230:231], v116 offset:10240
Mvva 164,212,8
s_add_u32 s6, s6, 5447680
s_cmp_eq_u32 s32, 0
s_cselect_b32 s6, s6, s64
s_cmp_lt_u32 s93, 224
s_cselect_b32 s6, s6, 2146435072
Zvva 180,196,4
s_waitcnt lgkmcnt(8)
ds_read_b64_tr_b16 v[244:245], v116 offset:12288
ds_read_b64_tr_b16 v[246:247], v116 offset:14336
Mvva 180,212,12
buffer_load_dwordx4 v114, s[12:15], s49 offen offset:1024 lds
Zvva 168,200,0
ds_read_b64_tr_b16 v[232:233], v117 offset:8192
ds_read_b64_tr_b16 v[234:235], v117 offset:10240
Mvva 168,216,8
s_mov_b64 exec, 1
buffer_store_dword v125, v126, s[20:23], s6 offen sc1
s_mov_b64 exec, -1
Zvva 184,200,4
s_waitcnt lgkmcnt(10)
ds_read_b64_tr_b16 v[248:249], v117 offset:12288
ds_read_b64_tr_b16 v[250:251], v117 offset:14336
Mvva 184,216,12
buffer_load_dwordx4 v114, s[12:15], s50 offen offset:2048 lds
Zvva 172,204,0
ds_read_b64_tr_b16 v[236:237], v118 offset:8192
ds_read_b64_tr_b16 v[238:239], v118 offset:10240
Mvva 172,220,8
s_waitcnt lgkmcnt(10)
s_lshl_b32 s40, s45, 2
s_add_u32 s40, s40, s32
s_lshr_b32 s3, s42, 5
s_lshr_b32 s47, s43, 5
s_cmp_eq_u32 s3, s40
s_cselect_b32 s53, 1, 0
s_cmp_eq_u32 s47, s40
s_cselect_b32 s53, 1, s53
s_mov_b32 s40, 0
Zvva 188,204,4
s_barrier
ds_read_b64_tr_b16 v[252:253], v118 offset:12288
ds_read_b64_tr_b16 v[254:255], v118 offset:14336
Mvva 188,220,12
buffer_load_dwordx4 v114, s[12:15], s51 offen offset:3072 lds
v_add_u32 v114, 131072, v114
Zvva 128,224,0
ds_read_b64_tr_b16 v[192:193], v115 offset:16384
ds_read_b64_tr_b16 v[194:195], v115 offset:18432
Mvva 128,240,8
s_lshl_b32 s41, s46, 7
s_add_u32 s41, s41, 5449728
s_lshl_b32 s55, s46, 13
Zvva 144,224,4
s_waitcnt lgkmcnt(10)
ds_read_b64_tr_b16 v[208:209], v115 offset:20480
ds_read_b64_tr_b16 v[210:211], v115 offset:22528
Mvva 144,240,12
buffer_load_dwordx4 a[48:51], v112, s[8:11], s52 offen offset:0 sc1
Zvva 132,228,0
ds_read_b64_tr_b16 v[196:197], v116 offset:16384
ds_read_b64_tr_b16 v[198:199], v116 offset:18432
Mvva 132,244,8
s_add_u32 s55, s55, 5308416
s_add_u32 s16, s66, 88080384
s_addc_u32 s17, s67, 0
s_and_b32 s17, s17, 0xffff
Zvva 148,228,4
s_waitcnt lgkmcnt(10)
ds_read_b64_tr_b16 v[212:213], v116 offset:20480
ds_read_b64_tr_b16 v[214:215], v116 offset:22528
Mvva 148,244,12
buffer_load_dwordx4 a[52:55], v112, s[8:11], s52 offen offset:1024 sc1
s_add_u32 s52, s52, 8192
Zvva 136,232,0
ds_read_b64_tr_b16 v[200:201], v117 offset:16384
ds_read_b64_tr_b16 v[202:203], v117 offset:18432
Mvva 136,248,8
s_mov_b32 s18, 8388608
s_mov_b32 s19, 0x20000
s_lshl_b32 s24, s2, 2
Zvva 152,232,4
s_waitcnt lgkmcnt(10)
ds_read_b64_tr_b16 v[216:217], v117 offset:20480
ds_read_b64_tr_b16 v[218:219], v117 offset:22528
Mvva 152,248,12
buffer_load_dwordx4 a[56:59], v112, s[8:11], s52 offen offset:0 sc1
Zvva 140,236,0
ds_read_b64_tr_b16 v[204:205], v118 offset:16384
ds_read_b64_tr_b16 v[206:207], v118 offset:18432
Mvva 140,252,8
s_add_u32 s24, s24, s32
s_lshl_b32 s25, s24, 13
s_xor_b32 s26, s25, 32768
Zvva 156,236,4
s_waitcnt lgkmcnt(10)
ds_read_b64_tr_b16 v[220:221], v118 offset:20480
ds_read_b64_tr_b16 v[222:223], v118 offset:22528
Mvva 156,252,12
buffer_load_dwordx4 a[60:63], v112, s[8:11], s52 offen offset:1024 sc1
s_add_u32 s52, s52, 8192
s_waitcnt vmcnt(17)
Mvva 160,192,16
ds_read_b64_tr_b16 v[224:225], v115 offset:24576
ds_read_b64_tr_b16 v[226:227], v115 offset:26624
Mvva 160,208,24
s_lshl_b32 s24, s24, 2
s_xor_b32 s27, s24, 16
s_add_u32 s24, s24, 5452800
Mvva 176,192,20
s_waitcnt lgkmcnt(10)
s_add_u32 m0, s44, 65536
ds_read_b64_tr_b16 v[240:241], v115 offset:28672
ds_read_b64_tr_b16 v[242:243], v115 offset:30720
Mvva 176,208,28
buffer_load_dwordx4 v114, s[12:15], s48 offen offset:0 lds
Mvva 164,196,16
ds_read_b64_tr_b16 v[228:229], v116 offset:24576
ds_read_b64_tr_b16 v[230:231], v116 offset:26624
Mvva 164,212,24
s_add_u32 s27, s27, 5452800
v_lshlrev_b32 v58, 16, v26
v_and_b32 v59, 0xffff0000, v26
v_lshlrev_b32_e64 v60, 16, v27
v_and_b32 v61, 0xffff0000, v27
v_lshlrev_b32_e64 v62, 16, v28
Mvva 180,196,20
s_waitcnt lgkmcnt(10)
ds_read_b64_tr_b16 v[244:245], v116 offset:28672
ds_read_b64_tr_b16 v[246:247], v116 offset:30720
v_and_b32 v63, 0xffff0000, v28
Mvva 180,212,28
buffer_load_dwordx4 v114, s[12:15], s49 offen offset:1024 lds
Mvva 168,200,16
ds_read_b64_tr_b16 v[232:233], v117 offset:24576
ds_read_b64_tr_b16 v[234:235], v117 offset:26624
v_lshlrev_b32 v64, 16, v29
Mvva 168,216,24
v_and_b32 v65, 0xffff0000, v29
Vs 58,58,38
Vs 59,59,38
Vs 60,60,38
Vs 61,61,38
Mvva 184,200,20
s_waitcnt lgkmcnt(10)
ds_read_b64_tr_b16 v[248:249], v117 offset:28672
ds_read_b64_tr_b16 v[250:251], v117 offset:30720
Vs 62,62,38
Mvva 184,216,28
buffer_load_dwordx4 v114, s[12:15], s50 offen offset:2048 lds
Mvva 172,204,16
s_waitcnt vmcnt(12)
ds_read_b64_tr_b16 v[236:237], v118 offset:24576
ds_read_b64_tr_b16 v[238:239], v118 offset:26624
Vs 63,63,38
Mvva 172,220,24
s_waitcnt lgkmcnt(10)
Vs 64,64,38
v_sub_f32_e64 v65, v65, v38
Vc 2,58,59
v_lshlrev_b32_e64 v58, 16, v2
v_and_b32 v59, 0xffff0000, v2
Mvva 188,204,20
s_barrier
ds_read_b64_tr_b16 v[252:253], v118 offset:28672
ds_read_b64_tr_b16 v[254:255], v118 offset:30720
Vc 3,60,61
Mvva 188,220,28
buffer_load_dwordx4 v114, s[12:15], s51 offen offset:3072 lds
v_add_u32 v114, 131072, v114
Mvva 128,224,16
ds_read_b64_tr_b16 v[192:193], v115 offset:32768
ds_read_b64_tr_b16 v[194:195], v115 offset:34816
v_lshlrev_b32 v60, 16, v3
Mvva 128,240,24
v_and_b32 v61, 0xffff0000, v3
Vc 4,62,63
v_lshlrev_b32_e64 v62, 16, v4
v_and_b32 v63, 0xffff0000, v4
Vc 5,64,65
Mvva 144,224,20
s_waitcnt lgkmcnt(10)
ds_read_b64_tr_b16 v[208:209], v115 offset:36864
ds_read_b64_tr_b16 v[210:211], v115 offset:38912
v_lshlrev_b32 v64, 16, v5
Mvva 144,240,28
buffer_load_dwordx4 a[64:67], v112, s[8:11], s52 offen offset:0 sc1
Mvva 132,228,16
ds_read_b64_tr_b16 v[196:197], v116 offset:32768
ds_read_b64_tr_b16 v[198:199], v116 offset:34816
v_and_b32 v65, 0xffff0000, v5
Mvva 132,244,24
Vm 58,58,39
Vm 59,59,39
Vm 60,60,39
Vm 61,61,39
v_mul_f32_e64 v62, v62, v39
Mvva 148,228,20
s_waitcnt lgkmcnt(10)
ds_read_b64_tr_b16 v[212:213], v116 offset:36864
ds_read_b64_tr_b16 v[214:215], v116 offset:38912
Vm 63,63,39
Mvva 148,244,28
buffer_load_dwordx4 a[68:71], v112, s[8:11], s52 offen offset:1024 sc1
s_add_u32 s52, s52, 8192
Mvva 136,232,16
ds_read_b64_tr_b16 v[200:201], v117 offset:32768
ds_read_b64_tr_b16 v[202:203], v117 offset:34816
v_mul_f32_e64 v64, v64, v39
Mvva 136,248,24
v_mul_f32_e64 v65, v65, v39
Vc 2,58,59
v_lshlrev_b32_e64 v58, 16, v2
v_and_b32 v59, 0xffff0000, v2
Vc 3,60,61
Mvva 152,232,20
s_waitcnt lgkmcnt(10)
ds_read_b64_tr_b16 v[216:217], v117 offset:36864
ds_read_b64_tr_b16 v[218:219], v117 offset:38912
v_lshlrev_b32 v60, 16, v3
Mvva 152,248,28
buffer_load_dwordx4 a[72:75], v112, s[8:11], s52 offen offset:0 sc1
Mvva 140,236,16
ds_read_b64_tr_b16 v[204:205], v118 offset:32768
ds_read_b64_tr_b16 v[206:207], v118 offset:34816
v_and_b32 v61, 0xffff0000, v3
Mvva 140,252,24
Vc 4,62,63
v_lshlrev_b32_e64 v62, 16, v4
v_and_b32 v63, 0xffff0000, v4
Vc 5,64,65
v_lshlrev_b32_e64 v64, 16, v5
Mvva 156,236,20
s_waitcnt lgkmcnt(10)
ds_read_b64_tr_b16 v[220:221], v118 offset:36864
ds_read_b64_tr_b16 v[222:223], v118 offset:38912
v_and_b32 v65, 0xffff0000, v5
Mvva 156,252,28
buffer_load_dwordx4 a[76:79], v112, s[8:11], s52 offen offset:1024 sc1
s_add_u32 s52, s52, 8192
Mvva 160,192,32
ds_read_b64_tr_b16 v[224:225], v115 offset:40960
ds_read_b64_tr_b16 v[226:227], v115 offset:43008
v_mul_f32 v2, 0xbfb8aa3b, v58
Mvva 160,208,40
v_mul_f32 v3, 0xbfb8aa3b, v59
v_mul_f32 v4, 0xbfb8aa3b, v60
v_mul_f32 v5, 0xbfb8aa3b, v61
v_mul_f32 v6, 0xbfb8aa3b, v62
v_mul_f32 v7, 0xbfb8aa3b, v63
Mvva 176,192,36
s_waitcnt lgkmcnt(10)
s_add_u32 m0, s44, 81920
ds_read_b64_tr_b16 v[240:241], v115 offset:45056
ds_read_b64_tr_b16 v[242:243], v115 offset:47104
v_mul_f32 v8, 0xbfb8aa3b, v64
Mvva 176,208,44
buffer_load_dwordx4 v114, s[12:15], s48 offen offset:0 lds
Mvva 164,196,32
ds_read_b64_tr_b16 v[228:229], v116 offset:40960
ds_read_b64_tr_b16 v[230:231], v116 offset:43008
v_mul_f32 v9, 0xbfb8aa3b, v65
Mvva 164,212,40
Ve 2,2
Ve 3,3
Mvva 180,196,36
s_waitcnt lgkmcnt(10)
ds_read_b64_tr_b16 v[244:245], v116 offset:45056
ds_read_b64_tr_b16 v[246:247], v116 offset:47104
Mvva 180,212,44
buffer_load_dwordx4 v114, s[12:15], s49 offen offset:1024 lds
Mvva 168,200,32
ds_read_b64_tr_b16 v[232:233], v117 offset:40960
ds_read_b64_tr_b16 v[234:235], v117 offset:43008
Mvva 168,216,40
Ve 4,4
VE 5,5
Mvva 184,200,36
s_waitcnt lgkmcnt(10)
ds_read_b64_tr_b16 v[248:249], v117 offset:45056
ds_read_b64_tr_b16 v[250:251], v117 offset:47104
Mvva 184,216,44
buffer_load_dwordx4 v114, s[12:15], s50 offen offset:2048 lds
Mvva 172,204,32
s_waitcnt vmcnt(15)
ds_read_b64_tr_b16 v[236:237], v118 offset:40960
ds_read_b64_tr_b16 v[238:239], v118 offset:43008
Mvva 172,220,40
s_waitcnt lgkmcnt(10)
Ve 6,6
VE 7,7
Mvva 188,204,36
s_barrier
ds_read_b64_tr_b16 v[252:253], v118 offset:45056
ds_read_b64_tr_b16 v[254:255], v118 offset:47104
Mvva 188,220,44
buffer_load_dwordx4 v114, s[12:15], s51 offen offset:3072 lds
v_add_u32 v114, 131072, v114
Mvva 128,224,32
ds_read_b64_tr_b16 v[192:193], v115 offset:49152
ds_read_b64_tr_b16 v[194:195], v115 offset:51200
Mvva 128,240,40
Ve 8,8
Ve 9,9
v_add_f32 v2, 1.0, v2
Mvva 144,224,36
s_waitcnt lgkmcnt(10)
ds_read_b64_tr_b16 v[208:209], v115 offset:53248
ds_read_b64_tr_b16 v[210:211], v115 offset:55296
v_add_f32 v3, 1.0, v3
Mvva 144,240,44
buffer_load_dwordx4 a[80:83], v112, s[8:11], s52 offen offset:0 sc1
Mvva 132,228,32
ds_read_b64_tr_b16 v[196:197], v116 offset:49152
ds_read_b64_tr_b16 v[198:199], v116 offset:51200
v_add_f32_e64 v4, 1.0, v4
Mvva 132,244,40
v_add_f32 v5, 1.0, v5
v_add_f32 v6, 1.0, v6
v_add_f32 v7, 1.0, v7
v_add_f32 v8, 1.0, v8
v_add_f32_e64 v9, 1.0, v9
Mvva 148,228,36
s_waitcnt lgkmcnt(10)
ds_read_b64_tr_b16 v[212:213], v116 offset:53248
ds_read_b64_tr_b16 v[214:215], v116 offset:55296
Mvva 148,244,44
buffer_load_dwordx4 a[84:87], v112, s[8:11], s52 offen offset:1024 sc1
s_add_u32 s52, s52, 8192
Mvva 136,232,32
ds_read_b64_tr_b16 v[200:201], v117 offset:49152
ds_read_b64_tr_b16 v[202:203], v117 offset:51200
Mvva 136,248,40
v_rcp_f32 v2, v2
v_rcp_f32_e64 v3, v3
Mvva 152,232,36
s_waitcnt lgkmcnt(10)
ds_read_b64_tr_b16 v[216:217], v117 offset:53248
ds_read_b64_tr_b16 v[218:219], v117 offset:55296
Mvva 152,248,44
buffer_load_dwordx4 a[88:91], v112, s[8:11], s52 offen offset:0 sc1
Mvva 140,236,32
ds_read_b64_tr_b16 v[204:205], v118 offset:49152
ds_read_b64_tr_b16 v[206:207], v118 offset:51200
Mvva 140,252,40
v_rcp_f32 v4, v4
v_rcp_f32_e64 v5, v5
Mvva 156,236,36
s_waitcnt lgkmcnt(10)
ds_read_b64_tr_b16 v[220:221], v118 offset:53248
ds_read_b64_tr_b16 v[222:223], v118 offset:55296
Mvva 156,252,44
buffer_load_dwordx4 a[92:95], v112, s[8:11], s52 offen offset:1024 sc1
s_add_u32 s52, s52, 8192
s_waitcnt vmcnt(16)
Mvva 160,192,48
ds_read_b64_tr_b16 v[224:225], v115 offset:57344
ds_read_b64_tr_b16 v[226:227], v115 offset:59392
Mvva 160,208,56
v_rcp_f32 v6, v6
v_rcp_f32 v7, v7
Mvva 176,192,52
s_waitcnt lgkmcnt(10)
s_add_u32 m0, s44, 98304
ds_read_b64_tr_b16 v[240:241], v115 offset:61440
ds_read_b64_tr_b16 v[242:243], v115 offset:63488
Mvva 176,208,60
buffer_load_dwordx4 v114, s[12:15], s48 offen offset:0 lds
Mvva 164,196,48
ds_read_b64_tr_b16 v[228:229], v116 offset:57344
ds_read_b64_tr_b16 v[230:231], v116 offset:59392
Mvva 164,212,56
v_rcp_f32 v8, v8
v_rcp_f32 v9, v9
Vm 58,58,2
Mvva 180,196,52
s_waitcnt lgkmcnt(10)
ds_read_b64_tr_b16 v[244:245], v116 offset:61440
ds_read_b64_tr_b16 v[246:247], v116 offset:63488
Vm 59,59,3
Mvva 180,212,60
buffer_load_dwordx4 v114, s[12:15], s49 offen offset:1024 lds
Mvva 168,200,48
ds_read_b64_tr_b16 v[232:233], v117 offset:57344
ds_read_b64_tr_b16 v[234:235], v117 offset:59392
v_mul_f32_e64 v60, v60, v4
Mvva 168,216,56
Vm 61,61,5
Vm 62,62,6
Vm 63,63,7
Vm 64,64,8
v_mul_f32_e64 v65, v65, v9
Mvva 184,200,52
s_waitcnt lgkmcnt(10)
ds_read_b64_tr_b16 v[248:249], v117 offset:61440
ds_read_b64_tr_b16 v[250:251], v117 offset:63488
Vc 2,58,59
Mvva 184,216,60
buffer_load_dwordx4 v114, s[12:15], s50 offen offset:2048 lds
Mvva 172,204,48
s_waitcnt vmcnt(15)
ds_read_b64_tr_b16 v[236:237], v118 offset:57344
ds_read_b64_tr_b16 v[238:239], v118 offset:59392
v_lshlrev_b32_e64 v58, 16, v2
Mvva 172,220,56
s_waitcnt lgkmcnt(10)
v_and_b32 v59, 0xffff0000, v2
Vc 3,60,61
v_lshlrev_b32 v60, 16, v3
v_and_b32 v61, 0xffff0000, v3
Vc 4,62,63
Mvva 188,204,52
s_barrier
ds_read_b64_tr_b16 v[252:253], v118 offset:61440
ds_read_b64_tr_b16 v[254:255], v118 offset:63488
v_lshlrev_b32 v62, 16, v4
Mvva 188,220,60
buffer_load_dwordx4 v114, s[12:15], s51 offen offset:3072 lds
v_add_u32 v114, 131072, v114
Mvva 128,224,48
ds_read_b64_tr_b16 v[192:193], v12 offset:0
ds_read_b64_tr_b16 v[194:195], v12 offset:2048
v_and_b32 v63, 0xffff0000, v4
Mvva 128,240,56
Vc 5,64,65
v_lshlrev_b32_e64 v64, 16, v5
v_and_b32 v65, 0xffff0000, v5
v_lshlrev_b32_e64 v66, 16, v30
v_and_b32 v67, 0xffff0000, v30
Mvva 144,224,52
s_waitcnt lgkmcnt(10)
ds_read_b64_tr_b16 v[208:209], v12 offset:4096
ds_read_b64_tr_b16 v[210:211], v12 offset:6144
v_lshlrev_b32 v68, 16, v31
Mvva 144,240,60
buffer_load_dwordx4 a[96:99], v112, s[8:11], s52 offen offset:0 sc1
Mvva 132,228,48
ds_read_b64_tr_b16 v[196:197], v13 offset:0
ds_read_b64_tr_b16 v[198:199], v13 offset:2048
v_and_b32 v69, 0xffff0000, v31
Mvva 132,244,56
v_lshlrev_b32_e64 v70, 16, v32
v_and_b32 v71, 0xffff0000, v32
v_lshlrev_b32_e64 v72, 16, v33
v_and_b32 v73, 0xffff0000, v33
v_sub_f32_e64 v66, v66, v40
Mvva 148,228,52
s_waitcnt lgkmcnt(10)
ds_read_b64_tr_b16 v[212:213], v13 offset:4096
ds_read_b64_tr_b16 v[214:215], v13 offset:6144
Vs 67,67,40
Mvva 148,244,60
buffer_load_dwordx4 a[100:103], v112, s[8:11], s52 offen offset:1024 sc1
s_add_u32 s52, s52, 8192
Mvva 136,232,48
ds_read_b64_tr_b16 v[200:201], v14 offset:0
ds_read_b64_tr_b16 v[202:203], v14 offset:2048
v_sub_f32_e64 v68, v68, v40
Mvva 136,248,56
Vs 69,69,40
Vs 70,70,40
Vs 71,71,40
Vs 72,72,40
v_sub_f32_e64 v73, v73, v40
Mvva 152,232,52
s_waitcnt lgkmcnt(10)
ds_read_b64_tr_b16 v[216:217], v14 offset:4096
ds_read_b64_tr_b16 v[218:219], v14 offset:6144
Vc 2,66,67
Mvva 152,248,60
buffer_load_dwordx4 a[104:107], v112, s[8:11], s52 offen offset:0 sc1
Mvva 140,236,48
ds_read_b64_tr_b16 v[204:205], v15 offset:0
ds_read_b64_tr_b16 v[206:207], v15 offset:2048
v_lshlrev_b32 v66, 16, v2
Mvva 140,252,56
v_and_b32 v67, 0xffff0000, v2
Vc 3,68,69
v_lshlrev_b32_e64 v68, 16, v3
v_and_b32 v69, 0xffff0000, v3
Vc 4,70,71
Mvva 156,236,52
s_waitcnt lgkmcnt(10)
ds_read_b64_tr_b16 v[220:221], v15 offset:4096
ds_read_b64_tr_b16 v[222:223], v15 offset:6144
v_lshlrev_b32 v70, 16, v4
Mvva 156,252,60
buffer_load_dwordx4 a[108:111], v112, s[8:11], s52 offen offset:1024 sc1
s_add_u32 s52, s52, 8192
s_waitcnt vmcnt(16)
Mvva 160,192,64
ds_read_b64_tr_b16 v[224:225], v12 offset:8192
ds_read_b64_tr_b16 v[226:227], v12 offset:10240
v_and_b32 v71, 0xffff0000, v4
Mvva 160,208,72
s_cmp_lt_u32 s93, 224
s_cbranch_scc1 L_f2A
L_f2Ar:
Mvva 176,192,68
s_waitcnt lgkmcnt(10)
s_add_u32 m0, s44, 114688
ds_read_b64_tr_b16 v[240:241], v12 offset:12288
ds_read_b64_tr_b16 v[242:243], v12 offset:14336
Vc 5,72,73
Mvva 176,208,76
buffer_load_dwordx4 v114, s[12:15], s48 offen offset:0 lds
Mvva 164,196,64
ds_read_b64_tr_b16 v[228:229], v13 offset:8192
ds_read_b64_tr_b16 v[230:231], v13 offset:10240
v_lshlrev_b32 v72, 16, v5
Mvva 164,212,72
v_and_b32 v73, 0xffff0000, v5
Vm 66,66,41
Vm 67,67,41
Vm 68,68,41
Vm 69,69,41
Mvva 180,196,68
s_waitcnt lgkmcnt(10)
ds_read_b64_tr_b16 v[244:245], v13 offset:12288
ds_read_b64_tr_b16 v[246:247], v13 offset:14336
Vm 70,70,41
Mvva 180,212,76
buffer_load_dwordx4 v114, s[12:15], s49 offen offset:1024 lds
Mvva 168,200,64
ds_read_b64_tr_b16 v[232:233], v14 offset:8192
ds_read_b64_tr_b16 v[234:235], v14 offset:10240
v_mul_f32_e64 v71, v71, v41
Mvva 168,216,72
Vm 72,72,41
Vm 73,73,41
Vc 2,66,67
v_lshlrev_b32_e64 v66, 16, v2
v_and_b32 v67, 0xffff0000, v2
Mvva 184,200,68
s_waitcnt lgkmcnt(10)
ds_read_b64_tr_b16 v[248:249], v14 offset:12288
ds_read_b64_tr_b16 v[250:251], v14 offset:14336
Vc 3,68,69
Mvva 184,216,76
buffer_load_dwordx4 v114, s[12:15], s50 offen offset:2048 lds
Mvva 172,204,64
s_waitcnt vmcnt(15)
ds_read_b64_tr_b16 v[236:237], v15 offset:8192
ds_read_b64_tr_b16 v[238:239], v15 offset:10240
v_lshlrev_b32_e64 v68, 16, v3
Mvva 172,220,72
s_waitcnt lgkmcnt(10)
v_and_b32 v69, 0xffff0000, v3
Vc 4,70,71
v_lshlrev_b32 v70, 16, v4
v_and_b32 v71, 0xffff0000, v4
Vc 5,72,73
Mvva 188,204,68
s_barrier
ds_read_b64_tr_b16 v[252:253], v15 offset:12288
ds_read_b64_tr_b16 v[254:255], v15 offset:14336
v_lshlrev_b32 v72, 16, v5
Mvva 188,220,76
buffer_load_dwordx4 v114, s[12:15], s51 offen offset:3072 lds
v_add_u32 v114, 131072, v114
Mvva 128,224,64
ds_read_b64_tr_b16 v[192:193], v12 offset:16384
ds_read_b64_tr_b16 v[194:195], v12 offset:18432
v_and_b32 v73, 0xffff0000, v5
Mvva 128,240,72
v_mul_f32 v2, 0xbfb8aa3b, v66
v_mul_f32 v3, 0xbfb8aa3b, v67
v_mul_f32 v4, 0xbfb8aa3b, v68
v_mul_f32 v5, 0xbfb8aa3b, v69
v_mul_f32 v6, 0xbfb8aa3b, v70
Mvva 144,224,68
s_waitcnt lgkmcnt(10)
ds_read_b64_tr_b16 v[208:209], v12 offset:20480
ds_read_b64_tr_b16 v[210:211], v12 offset:22528
v_mul_f32 v7, 0xbfb8aa3b, v71
Mvva 144,240,76
buffer_load_dwordx4 a[112:115], v112, s[8:11], s52 offen offset:0 sc1
Mvva 132,228,64
ds_read_b64_tr_b16 v[196:197], v13 offset:16384
ds_read_b64_tr_b16 v[198:199], v13 offset:18432
v_mul_f32 v8, 0xbfb8aa3b, v72
Mvva 132,244,72
v_mul_f32 v9, 0xbfb8aa3b, v73
Ve 2,2
VE 3,3
Mvva 148,228,68
s_waitcnt lgkmcnt(10)
ds_read_b64_tr_b16 v[212:213], v13 offset:20480
ds_read_b64_tr_b16 v[214:215], v13 offset:22528
Mvva 148,244,76
buffer_load_dwordx4 a[116:119], v112, s[8:11], s52 offen offset:1024 sc1
s_add_u32 s52, s52, 8192
Mvva 136,232,64
ds_read_b64_tr_b16 v[200:201], v14 offset:16384
ds_read_b64_tr_b16 v[202:203], v14 offset:18432
Mvva 136,248,72
Ve 4,4
VE 5,5
Mvva 152,232,68
s_waitcnt lgkmcnt(10)
ds_read_b64_tr_b16 v[216:217], v14 offset:20480
ds_read_b64_tr_b16 v[218:219], v14 offset:22528
Mvva 152,248,76
buffer_load_dwordx4 a[120:123], v112, s[8:11], s52 offen offset:0 sc1
Mvva 140,236,64
ds_read_b64_tr_b16 v[204:205], v15 offset:16384
ds_read_b64_tr_b16 v[206:207], v15 offset:18432
Mvva 140,252,72
Ve 6,6
VE 7,7
Mvva 156,236,68
s_waitcnt lgkmcnt(10)
ds_read_b64_tr_b16 v[220:221], v15 offset:20480
ds_read_b64_tr_b16 v[222:223], v15 offset:22528
Mvva 156,252,76
buffer_load_dwordx4 a[124:127], v112, s[8:11], s52 offen offset:1024 sc1
s_add_u32 s52, s52, 8192
s_waitcnt vmcnt(16)
Mvva 160,192,80
ds_read_b64_tr_b16 v[224:225], v12 offset:24576
ds_read_b64_tr_b16 v[226:227], v12 offset:26624
Mvva 160,208,88
Ve 8,8
Ve 9,9
v_add_f32_e64 v2, 1.0, v2
Mvva 176,192,84
s_waitcnt lgkmcnt(10)
s_add_u32 m0, s44, 0
ds_read_b64_tr_b16 v[240:241], v12 offset:28672
ds_read_b64_tr_b16 v[242:243], v12 offset:30720
v_add_f32_e64 v3, 1.0, v3
Mvva 176,208,92
buffer_load_dwordx4 v114, s[12:15], s48 offen offset:0 lds
Mvva 164,196,80
ds_read_b64_tr_b16 v[228:229], v13 offset:24576
ds_read_b64_tr_b16 v[230:231], v13 offset:26624
v_add_f32_e64 v4, 1.0, v4
Mvva 164,212,88
v_add_f32 v5, 1.0, v5
v_add_f32 v6, 1.0, v6
v_add_f32 v7, 1.0, v7
v_add_f32 v8, 1.0, v8
v_add_f32_e64 v9, 1.0, v9
Mvva 180,196,84
s_waitcnt lgkmcnt(10)
ds_read_b64_tr_b16 v[244:245], v13 offset:28672
ds_read_b64_tr_b16 v[246:247], v13 offset:30720
Mvva 180,212,92
buffer_load_dwordx4 v114, s[12:15], s49 offen offset:1024 lds
Mvva 168,200,80
ds_read_b64_tr_b16 v[232:233], v14 offset:24576
ds_read_b64_tr_b16 v[234:235], v14 offset:26624
Mvva 168,216,88
v_rcp_f32 v2, v2
v_rcp_f32_e64 v3, v3
Mvva 184,200,84
s_waitcnt lgkmcnt(10)
ds_read_b64_tr_b16 v[248:249], v14 offset:28672
ds_read_b64_tr_b16 v[250:251], v14 offset:30720
Mvva 184,216,92
buffer_load_dwordx4 v114, s[12:15], s50 offen offset:2048 lds
Mvva 172,204,80
s_waitcnt vmcnt(15)
ds_read_b64_tr_b16 v[236:237], v15 offset:24576
ds_read_b64_tr_b16 v[238:239], v15 offset:26624
Mvva 172,220,88
s_waitcnt lgkmcnt(10)
v_rcp_f32 v4, v4
v_rcp_f32_e64 v5, v5
Mvva 188,204,84
s_barrier
ds_read_b64_tr_b16 v[252:253], v15 offset:28672
ds_read_b64_tr_b16 v[254:255], v15 offset:30720
Mvva 188,220,92
buffer_load_dwordx4 v114, s[12:15], s51 offen offset:3072 lds
v_add_u32 v114, 131072, v114
Mvva 128,224,80
ds_read_b64_tr_b16 v[192:193], v12 offset:32768
ds_read_b64_tr_b16 v[194:195], v12 offset:34816
Mvva 128,240,88
v_rcp_f32 v6, v6
v_rcp_f32_e64 v7, v7
Mvva 144,224,84
s_waitcnt lgkmcnt(10)
ds_read_b64_tr_b16 v[208:209], v12 offset:36864
ds_read_b64_tr_b16 v[210:211], v12 offset:38912
Mvva 144,240,92
buffer_load_dwordx4 a[128:131], v112, s[8:11], s52 offen offset:0 sc1
Mvva 132,228,80
ds_read_b64_tr_b16 v[196:197], v13 offset:32768
ds_read_b64_tr_b16 v[198:199], v13 offset:34816
Mvva 132,244,88
v_rcp_f32 v8, v8
v_rcp_f32 v9, v9
Vm 66,66,2
Mvva 148,228,84
s_waitcnt lgkmcnt(10)
ds_read_b64_tr_b16 v[212:213], v13 offset:36864
ds_read_b64_tr_b16 v[214:215], v13 offset:38912
Vm 67,67,3
Mvva 148,244,92
buffer_load_dwordx4 a[132:135], v112, s[8:11], s52 offen offset:1024 sc1
s_add_u32 s52, s52, 8192
Mvva 136,232,80
ds_read_b64_tr_b16 v[200:201], v14 offset:32768
ds_read_b64_tr_b16 v[202:203], v14 offset:34816
v_mul_f32_e64 v68, v68, v4
Mvva 136,248,88
Vm 69,69,5
Vm 70,70,6
Vm 71,71,7
Vm 72,72,8
v_mul_f32_e64 v73, v73, v9
Mvva 152,232,84
s_waitcnt lgkmcnt(10)
ds_read_b64_tr_b16 v[216:217], v14 offset:36864
ds_read_b64_tr_b16 v[218:219], v14 offset:38912
Vc 2,66,67
Mvva 152,248,92
buffer_load_dwordx4 a[136:139], v112, s[8:11], s52 offen offset:0 sc1
Mvva 140,236,80
ds_read_b64_tr_b16 v[204:205], v15 offset:32768
ds_read_b64_tr_b16 v[206:207], v15 offset:34816
v_lshlrev_b32 v66, 16, v2
Mvva 140,252,88
v_and_b32 v67, 0xffff0000, v2
Vc 3,68,69
v_lshlrev_b32_e64 v68, 16, v3
v_and_b32 v69, 0xffff0000, v3
Vc 4,70,71
Mvva 156,236,84
s_waitcnt lgkmcnt(10)
ds_read_b64_tr_b16 v[220:221], v15 offset:36864
ds_read_b64_tr_b16 v[222:223], v15 offset:38912
v_lshlrev_b32 v70, 16, v4
Mvva 156,252,92
buffer_load_dwordx4 a[140:143], v112, s[8:11], s52 offen offset:1024 sc1
s_add_u32 s52, s52, 8192
s_waitcnt vmcnt(16)
Mvva 160,192,96
ds_read_b64_tr_b16 v[224:225], v12 offset:40960
ds_read_b64_tr_b16 v[226:227], v12 offset:43008
v_and_b32 v71, 0xffff0000, v4
Mvva 160,208,104
Vc 5,72,73
v_lshlrev_b32 v72, 16, v5
v_and_b32 v73, 0xffff0000, v5
Mvva 176,192,100
s_waitcnt lgkmcnt(10)
s_add_u32 m0, s44, 16384
ds_read_b64_tr_b16 v[240:241], v12 offset:45056
ds_read_b64_tr_b16 v[242:243], v12 offset:47104
Mvva 176,208,108
buffer_load_dwordx4 v114, s[12:15], s48 offen offset:0 lds
Mvva 164,196,96
ds_read_b64_tr_b16 v[228:229], v13 offset:40960
ds_read_b64_tr_b16 v[230:231], v13 offset:43008
Mvva 164,212,104
Mvva 180,196,100
s_waitcnt lgkmcnt(10)
ds_read_b64_tr_b16 v[244:245], v13 offset:45056
ds_read_b64_tr_b16 v[246:247], v13 offset:47104
Mvva 180,212,108
buffer_load_dwordx4 v114, s[12:15], s49 offen offset:1024 lds
Mvva 168,200,96
ds_read_b64_tr_b16 v[232:233], v14 offset:40960
ds_read_b64_tr_b16 v[234:235], v14 offset:43008
Mvva 168,216,104
Mvva 184,200,100
s_waitcnt lgkmcnt(10)
ds_read_b64_tr_b16 v[248:249], v14 offset:45056
ds_read_b64_tr_b16 v[250:251], v14 offset:47104
Mvva 184,216,108
buffer_load_dwordx4 v114, s[12:15], s50 offen offset:2048 lds
Mvva 172,204,96
s_waitcnt vmcnt(15)
ds_read_b64_tr_b16 v[236:237], v15 offset:40960
ds_read_b64_tr_b16 v[238:239], v15 offset:43008
Mvva 172,220,104
s_waitcnt lgkmcnt(10)
s_cmp_lt_u32 s93, 224
s_cbranch_scc1 L_f2B
L_f2Br:
Mvva 188,204,100
s_barrier
ds_read_b64_tr_b16 v[252:253], v15 offset:45056
ds_read_b64_tr_b16 v[254:255], v15 offset:47104
Mvva 188,220,108
buffer_load_dwordx4 v114, s[12:15], s51 offen offset:3072 lds
v_add_u32 v114, 131072, v114
Mvva 128,224,96
ds_read_b64_tr_b16 v[192:193], v12 offset:49152
ds_read_b64_tr_b16 v[194:195], v12 offset:51200
Mvva 128,240,104
Mvva 144,224,100
s_waitcnt lgkmcnt(10)
ds_read_b64_tr_b16 v[208:209], v12 offset:53248
ds_read_b64_tr_b16 v[210:211], v12 offset:55296
Mvva 144,240,108
buffer_load_dwordx4 a[144:147], v112, s[8:11], s52 offen offset:0 sc1
Mvva 132,228,96
ds_read_b64_tr_b16 v[196:197], v13 offset:49152
ds_read_b64_tr_b16 v[198:199], v13 offset:51200
Mvva 132,244,104
Mvva 148,228,100
s_waitcnt lgkmcnt(10)
ds_read_b64_tr_b16 v[212:213], v13 offset:53248
ds_read_b64_tr_b16 v[214:215], v13 offset:55296
Mvva 148,244,108
buffer_load_dwordx4 a[148:151], v112, s[8:11], s52 offen offset:1024 sc1
s_add_u32 s52, s52, 8192
Mvva 136,232,96
ds_read_b64_tr_b16 v[200:201], v14 offset:49152
ds_read_b64_tr_b16 v[202:203], v14 offset:51200
Mvva 136,248,104
Mvva 152,232,100
s_waitcnt lgkmcnt(10)
ds_read_b64_tr_b16 v[216:217], v14 offset:53248
ds_read_b64_tr_b16 v[218:219], v14 offset:55296
Mvva 152,248,108
buffer_load_dwordx4 a[152:155], v112, s[8:11], s52 offen offset:0 sc1
Mvva 140,236,96
ds_read_b64_tr_b16 v[204:205], v15 offset:49152
ds_read_b64_tr_b16 v[206:207], v15 offset:51200
Mvva 140,252,104
Mvva 156,236,100
s_waitcnt lgkmcnt(10)
ds_read_b64_tr_b16 v[220:221], v15 offset:53248
ds_read_b64_tr_b16 v[222:223], v15 offset:55296
Mvva 156,252,108
buffer_load_dwordx4 a[156:159], v112, s[8:11], s52 offen offset:1024 sc1
s_add_u32 s52, s52, 8192
s_waitcnt vmcnt(16)
Mvva 160,192,112
ds_read_b64_tr_b16 v[224:225], v12 offset:57344
ds_read_b64_tr_b16 v[226:227], v12 offset:59392
Mvva 160,208,120
Mvva 176,192,116
s_waitcnt lgkmcnt(10)
s_add_u32 m0, s44, 32768
ds_read_b64_tr_b16 v[240:241], v12 offset:61440
ds_read_b64_tr_b16 v[242:243], v12 offset:63488
Mvva 176,208,124
buffer_load_dwordx4 v114, s[12:15], s48 offen offset:0 lds
Mvva 164,196,112
ds_read_b64_tr_b16 v[228:229], v13 offset:57344
ds_read_b64_tr_b16 v[230:231], v13 offset:59392
Mvva 164,212,120
Mvva 180,196,116
s_waitcnt lgkmcnt(10)
ds_read_b64_tr_b16 v[244:245], v13 offset:61440
ds_read_b64_tr_b16 v[246:247], v13 offset:63488
Mvva 180,212,124
buffer_load_dwordx4 v114, s[12:15], s49 offen offset:1024 lds
Mvva 168,200,112
ds_read_b64_tr_b16 v[232:233], v14 offset:57344
ds_read_b64_tr_b16 v[234:235], v14 offset:59392
Mvva 168,216,120
Mvva 184,200,116
s_waitcnt lgkmcnt(10)
ds_read_b64_tr_b16 v[248:249], v14 offset:61440
ds_read_b64_tr_b16 v[250:251], v14 offset:63488
Mvva 184,216,124
buffer_load_dwordx4 v114, s[12:15], s50 offen offset:2048 lds
Mvva 172,204,112
s_waitcnt vmcnt(15)
ds_read_b64_tr_b16 v[236:237], v15 offset:57344
ds_read_b64_tr_b16 v[238:239], v15 offset:59392
Mvva 172,220,120
s_waitcnt lgkmcnt(10)
Mvva 188,204,116
s_barrier
ds_read_b64_tr_b16 v[252:253], v15 offset:61440
ds_read_b64_tr_b16 v[254:255], v15 offset:63488
Mvva 188,220,124
buffer_load_dwordx4 v114, s[12:15], s51 offen offset:3072 lds
v_add_u32 v114, 131072, v114
Mvva 128,224,112
ds_read_b64_tr_b16 v[192:193], v115 offset:0
ds_read_b64_tr_b16 v[194:195], v115 offset:2048
Mvva 128,240,120
Mvva 144,224,116
s_waitcnt lgkmcnt(10)
ds_read_b64_tr_b16 v[208:209], v115 offset:4096
ds_read_b64_tr_b16 v[210:211], v115 offset:6144
Mvva 144,240,124
buffer_load_dwordx4 a[160:163], v112, s[8:11], s52 offen offset:0 sc1
Mvva 132,228,112
ds_read_b64_tr_b16 v[196:197], v116 offset:0
ds_read_b64_tr_b16 v[198:199], v116 offset:2048
Mvva 132,244,120
Mvva 148,228,116
s_waitcnt lgkmcnt(10)
ds_read_b64_tr_b16 v[212:213], v116 offset:4096
ds_read_b64_tr_b16 v[214:215], v116 offset:6144
Mvva 148,244,124
buffer_load_dwordx4 a[164:167], v112, s[8:11], s52 offen offset:1024 sc1
s_add_u32 s52, s52, 8192
Mvva 136,232,112
ds_read_b64_tr_b16 v[200:201], v117 offset:0
ds_read_b64_tr_b16 v[202:203], v117 offset:2048
Mvva 136,248,120
Mvva 152,232,116
s_waitcnt lgkmcnt(10)
ds_read_b64_tr_b16 v[216:217], v117 offset:4096
ds_read_b64_tr_b16 v[218:219], v117 offset:6144
Mvva 152,248,124
buffer_load_dwordx4 a[168:171], v112, s[8:11], s52 offen offset:0 sc1
Mvva 140,236,112
ds_read_b64_tr_b16 v[204:205], v118 offset:0
ds_read_b64_tr_b16 v[206:207], v118 offset:2048
Mvva 140,252,120
Mvva 156,236,116
s_waitcnt lgkmcnt(10)
ds_read_b64_tr_b16 v[220:221], v118 offset:4096
ds_read_b64_tr_b16 v[222:223], v118 offset:6144
Mvva 156,252,124
buffer_load_dwordx4 a[172:175], v112, s[8:11], s52 offen offset:1024 sc1
s_add_u32 s52, s52, 8192
s_waitcnt vmcnt(16)
Mvva 160,192,128
ds_read_b64_tr_b16 v[224:225], v115 offset:8192
ds_read_b64_tr_b16 v[226:227], v115 offset:10240
Mvva 160,208,136
Mvva 176,192,132
s_waitcnt lgkmcnt(10)
s_add_u32 m0, s44, 49152
ds_read_b64_tr_b16 v[240:241], v115 offset:12288
ds_read_b64_tr_b16 v[242:243], v115 offset:14336
Mvva 176,208,140
buffer_load_dwordx4 v114, s[12:15], s48 offen offset:0 lds
Mvva 164,196,128
ds_read_b64_tr_b16 v[228:229], v116 offset:8192
ds_read_b64_tr_b16 v[230:231], v116 offset:10240
Mvva 164,212,136
Mvva 180,196,132
s_waitcnt lgkmcnt(10)
ds_read_b64_tr_b16 v[244:245], v116 offset:12288
ds_read_b64_tr_b16 v[246:247], v116 offset:14336
Mvva 180,212,140
buffer_load_dwordx4 v114, s[12:15], s49 offen offset:1024 lds
Mvva 168,200,128
ds_read_b64_tr_b16 v[232:233], v117 offset:8192
ds_read_b64_tr_b16 v[234:235], v117 offset:10240
Mvva 168,216,136
Mvva 184,200,132
s_waitcnt lgkmcnt(10)
ds_read_b64_tr_b16 v[248:249], v117 offset:12288
ds_read_b64_tr_b16 v[250:251], v117 offset:14336
Mvva 184,216,140
buffer_load_dwordx4 v114, s[12:15], s50 offen offset:2048 lds
Mvva 172,204,128
s_waitcnt vmcnt(15)
ds_read_b64_tr_b16 v[236:237], v118 offset:8192
ds_read_b64_tr_b16 v[238:239], v118 offset:10240
Mvva 172,220,136
s_waitcnt lgkmcnt(10)
Mvva 188,204,132
s_barrier
ds_read_b64_tr_b16 v[252:253], v118 offset:12288
ds_read_b64_tr_b16 v[254:255], v118 offset:14336
Mvva 188,220,140
buffer_load_dwordx4 v114, s[12:15], s51 offen offset:3072 lds
v_add_u32 v114, 131072, v114
Mvva 128,224,128
ds_read_b64_tr_b16 v[192:193], v115 offset:16384
ds_read_b64_tr_b16 v[194:195], v115 offset:18432
Mvva 128,240,136
Mvva 144,224,132
s_waitcnt lgkmcnt(10)
ds_read_b64_tr_b16 v[208:209], v115 offset:20480
ds_read_b64_tr_b16 v[210:211], v115 offset:22528
Mvva 144,240,140
buffer_load_dwordx4 a[176:179], v112, s[8:11], s52 offen offset:0 sc1
Mvva 132,228,128
ds_read_b64_tr_b16 v[196:197], v116 offset:16384
ds_read_b64_tr_b16 v[198:199], v116 offset:18432
Mvva 132,244,136
Mvva 148,228,132
s_waitcnt lgkmcnt(10)
ds_read_b64_tr_b16 v[212:213], v116 offset:20480
ds_read_b64_tr_b16 v[214:215], v116 offset:22528
Mvva 148,244,140
buffer_load_dwordx4 a[180:183], v112, s[8:11], s52 offen offset:1024 sc1
s_add_u32 s52, s52, 8192
Mvva 136,232,128
ds_read_b64_tr_b16 v[200:201], v117 offset:16384
ds_read_b64_tr_b16 v[202:203], v117 offset:18432
Mvva 136,248,136
Mvva 152,232,132
s_waitcnt lgkmcnt(10)
ds_read_b64_tr_b16 v[216:217], v117 offset:20480
ds_read_b64_tr_b16 v[218:219], v117 offset:22528
Mvva 152,248,140
buffer_load_dwordx4 a[184:187], v112, s[8:11], s52 offen offset:0 sc1
Mvva 140,236,128
ds_read_b64_tr_b16 v[204:205], v118 offset:16384
ds_read_b64_tr_b16 v[206:207], v118 offset:18432
Mvva 140,252,136
s_cmp_lt_u32 s93, 224
s_cbranch_scc1 L_f2C
L_f2Cr:
Mvva 156,236,132
s_waitcnt lgkmcnt(10)
ds_read_b64_tr_b16 v[220:221], v118 offset:20480
ds_read_b64_tr_b16 v[222:223], v118 offset:22528
Mvva 156,252,140
buffer_load_dwordx4 a[188:191], v112, s[8:11], s52 offen offset:1024 sc1
s_add_u32 s52, s52, 8192
s_waitcnt vmcnt(16)
Mvva 160,192,144
ds_read_b64_tr_b16 v[224:225], v115 offset:24576
ds_read_b64_tr_b16 v[226:227], v115 offset:26624
Mvva 160,208,152
Mvva 176,192,148
s_waitcnt lgkmcnt(10)
s_add_u32 m0, s44, 65536
ds_read_b64_tr_b16 v[240:241], v115 offset:28672
ds_read_b64_tr_b16 v[242:243], v115 offset:30720
Mvva 176,208,156
buffer_load_dwordx4 v114, s[12:15], s48 offen offset:0 lds
Mvva 164,196,144
ds_read_b64_tr_b16 v[228:229], v116 offset:24576
ds_read_b64_tr_b16 v[230:231], v116 offset:26624
Mvva 164,212,152
Mvva 180,196,148
s_waitcnt lgkmcnt(10)
ds_read_b64_tr_b16 v[244:245], v116 offset:28672
ds_read_b64_tr_b16 v[246:247], v116 offset:30720
Mvva 180,212,156
buffer_load_dwordx4 v114, s[12:15], s49 offen offset:1024 lds
Mvva 168,200,144
ds_read_b64_tr_b16 v[232:233], v117 offset:24576
ds_read_b64_tr_b16 v[234:235], v117 offset:26624
Mvva 168,216,152
Mvva 184,200,148
s_waitcnt lgkmcnt(10)
ds_read_b64_tr_b16 v[248:249], v117 offset:28672
ds_read_b64_tr_b16 v[250:251], v117 offset:30720
Mvva 184,216,156
buffer_load_dwordx4 v114, s[12:15], s50 offen offset:2048 lds
Mvva 172,204,144
s_waitcnt vmcnt(15)
ds_read_b64_tr_b16 v[236:237], v118 offset:24576
ds_read_b64_tr_b16 v[238:239], v118 offset:26624
Mvva 172,220,152
s_waitcnt lgkmcnt(10)
Mvva 188,204,148
s_barrier
ds_read_b64_tr_b16 v[252:253], v118 offset:28672
ds_read_b64_tr_b16 v[254:255], v118 offset:30720
Mvva 188,220,156
buffer_load_dwordx4 v114, s[12:15], s51 offen offset:3072 lds
v_add_u32 v114, 131072, v114
Mvva 128,224,144
ds_read_b64_tr_b16 v[192:193], v115 offset:32768
ds_read_b64_tr_b16 v[194:195], v115 offset:34816
Mvva 128,240,152
s_cmp_ge_u32 s2, 128
s_cbranch_scc1 L_c31
L_c31r:
Mvva 144,224,148
s_waitcnt lgkmcnt(10)
ds_read_b64_tr_b16 v[208:209], v115 offset:36864
ds_read_b64_tr_b16 v[210:211], v115 offset:38912
Mvva 144,240,156
buffer_load_dwordx4 a[192:195], v112, s[8:11], s52 offen offset:0 sc1
Mvva 132,228,144
ds_read_b64_tr_b16 v[196:197], v116 offset:32768
ds_read_b64_tr_b16 v[198:199], v116 offset:34816
Mvva 132,244,152
Mvva 148,228,148
s_waitcnt lgkmcnt(10)
ds_read_b64_tr_b16 v[212:213], v116 offset:36864
ds_read_b64_tr_b16 v[214:215], v116 offset:38912
Mvva 148,244,156
buffer_load_dwordx4 a[196:199], v112, s[8:11], s52 offen offset:1024 sc1
s_add_u32 s52, s52, 8192
Mvva 136,232,144
ds_read_b64_tr_b16 v[200:201], v117 offset:32768
ds_read_b64_tr_b16 v[202:203], v117 offset:34816
Mvva 136,248,152
Mvva 152,232,148
s_waitcnt lgkmcnt(10)
ds_read_b64_tr_b16 v[216:217], v117 offset:36864
ds_read_b64_tr_b16 v[218:219], v117 offset:38912
Mvva 152,248,156
buffer_load_dwordx4 a[200:203], v112, s[8:11], s52 offen offset:0 sc1
Mvva 140,236,144
ds_read_b64_tr_b16 v[204:205], v118 offset:32768
ds_read_b64_tr_b16 v[206:207], v118 offset:34816
Mvva 140,252,152
Mvva 156,236,148
s_waitcnt lgkmcnt(10)
ds_read_b64_tr_b16 v[220:221], v118 offset:36864
ds_read_b64_tr_b16 v[222:223], v118 offset:38912
Mvva 156,252,156
buffer_load_dwordx4 a[204:207], v112, s[8:11], s52 offen offset:1024 sc1
s_add_u32 s52, s52, 8192
s_waitcnt vmcnt(16)
Mvva 160,192,160
ds_read_b64_tr_b16 v[224:225], v115 offset:40960
ds_read_b64_tr_b16 v[226:227], v115 offset:43008
Mvva 160,208,168
Mvva 176,192,164
s_waitcnt lgkmcnt(10)
s_add_u32 m0, s44, 81920
ds_read_b64_tr_b16 v[240:241], v115 offset:45056
ds_read_b64_tr_b16 v[242:243], v115 offset:47104
Mvva 176,208,172
buffer_load_dwordx4 v114, s[12:15], s48 offen offset:0 lds
Mvva 164,196,160
ds_read_b64_tr_b16 v[228:229], v116 offset:40960
ds_read_b64_tr_b16 v[230:231], v116 offset:43008
Mvva 164,212,168
Mvva 180,196,164
s_waitcnt lgkmcnt(10)
ds_read_b64_tr_b16 v[244:245], v116 offset:45056
ds_read_b64_tr_b16 v[246:247], v116 offset:47104
Mvva 180,212,172
buffer_load_dwordx4 v114, s[12:15], s49 offen offset:1024 lds
Mvva 168,200,160
ds_read_b64_tr_b16 v[232:233], v117 offset:40960
ds_read_b64_tr_b16 v[234:235], v117 offset:43008
Mvva 168,216,168
Mvva 184,200,164
s_waitcnt lgkmcnt(10)
ds_read_b64_tr_b16 v[248:249], v117 offset:45056
ds_read_b64_tr_b16 v[250:251], v117 offset:47104
Mvva 184,216,172
buffer_load_dwordx4 v114, s[12:15], s50 offen offset:2048 lds
Mvva 172,204,160
s_waitcnt vmcnt(15)
ds_read_b64_tr_b16 v[236:237], v118 offset:40960
ds_read_b64_tr_b16 v[238:239], v118 offset:43008
Mvva 172,220,168
s_waitcnt lgkmcnt(10)
Mvva 188,204,164
s_barrier
ds_read_b64_tr_b16 v[252:253], v118 offset:45056
ds_read_b64_tr_b16 v[254:255], v118 offset:47104
Mvva 188,220,172
buffer_load_dwordx4 v114, s[12:15], s51 offen offset:3072 lds
v_add_u32 v114, 131072, v114
Mvva 128,224,160
ds_read_b64_tr_b16 v[192:193], v115 offset:49152
ds_read_b64_tr_b16 v[194:195], v115 offset:51200
Mvva 128,240,168
Mvva 144,224,164
s_waitcnt lgkmcnt(10)
ds_read_b64_tr_b16 v[208:209], v115 offset:53248
ds_read_b64_tr_b16 v[210:211], v115 offset:55296
Mvva 144,240,172
buffer_load_dwordx4 a[208:211], v112, s[8:11], s52 offen offset:0 sc1
Mvva 132,228,160
ds_read_b64_tr_b16 v[196:197], v116 offset:49152
ds_read_b64_tr_b16 v[198:199], v116 offset:51200
Mvva 132,244,168
Mvva 148,228,164
s_waitcnt lgkmcnt(10)
ds_read_b64_tr_b16 v[212:213], v116 offset:53248
ds_read_b64_tr_b16 v[214:215], v116 offset:55296
Mvva 148,244,172
buffer_load_dwordx4 a[212:215], v112, s[8:11], s52 offen offset:1024 sc1
s_add_u32 s52, s52, 8192
Mvva 136,232,160
ds_read_b64_tr_b16 v[200:201], v117 offset:49152
ds_read_b64_tr_b16 v[202:203], v117 offset:51200
Mvva 136,248,168
Mvva 152,232,164
s_waitcnt lgkmcnt(10)
ds_read_b64_tr_b16 v[216:217], v117 offset:53248
ds_read_b64_tr_b16 v[218:219], v117 offset:55296
Mvva 152,248,172
buffer_load_dwordx4 a[216:219], v112, s[8:11], s52 offen offset:0 sc1
Mvva 140,236,160
ds_read_b64_tr_b16 v[204:205], v118 offset:49152
ds_read_b64_tr_b16 v[206:207], v118 offset:51200
Mvva 140,252,168
Mvva 156,236,164
s_waitcnt lgkmcnt(10)
ds_read_b64_tr_b16 v[220:221], v118 offset:53248
ds_read_b64_tr_b16 v[222:223], v118 offset:55296
Mvva 156,252,172
buffer_load_dwordx4 a[220:223], v112, s[8:11], s52 offen offset:1024 sc1
s_add_u32 s52, s52, 8192
s_waitcnt vmcnt(16)
Mvva 160,192,176
ds_read_b64_tr_b16 v[224:225], v115 offset:57344
ds_read_b64_tr_b16 v[226:227], v115 offset:59392
Mvva 160,208,184
Mvva 176,192,180
s_waitcnt lgkmcnt(10)
s_add_u32 m0, s44, 98304
ds_read_b64_tr_b16 v[240:241], v115 offset:61440
ds_read_b64_tr_b16 v[242:243], v115 offset:63488
Mvva 176,208,188
buffer_load_dwordx4 v114, s[12:15], s48 offen offset:0 lds
Mvva 164,196,176
ds_read_b64_tr_b16 v[228:229], v116 offset:57344
ds_read_b64_tr_b16 v[230:231], v116 offset:59392
Mvva 164,212,184
Mvva 180,196,180
s_waitcnt lgkmcnt(10)
ds_read_b64_tr_b16 v[244:245], v116 offset:61440
ds_read_b64_tr_b16 v[246:247], v116 offset:63488
Mvva 180,212,188
buffer_load_dwordx4 v114, s[12:15], s49 offen offset:1024 lds
Mvva 168,200,176
ds_read_b64_tr_b16 v[232:233], v117 offset:57344
ds_read_b64_tr_b16 v[234:235], v117 offset:59392
Mvva 168,216,184
s_cmp_lt_u32 s93, 224
s_cbranch_scc1 L_f2E
L_f2Er:
Mvva 184,200,180
s_waitcnt lgkmcnt(10)
ds_read_b64_tr_b16 v[248:249], v117 offset:61440
ds_read_b64_tr_b16 v[250:251], v117 offset:63488
Mvva 184,216,188
buffer_load_dwordx4 v114, s[12:15], s50 offen offset:2048 lds
Mvva 172,204,176
s_waitcnt vmcnt(15)
ds_read_b64_tr_b16 v[236:237], v118 offset:57344
ds_read_b64_tr_b16 v[238:239], v118 offset:59392
Mvva 172,220,184
s_waitcnt lgkmcnt(10)
Mvva 188,204,180
s_barrier
ds_read_b64_tr_b16 v[252:253], v118 offset:61440
ds_read_b64_tr_b16 v[254:255], v118 offset:63488
Mvva 188,220,188
buffer_load_dwordx4 v114, s[12:15], s51 offen offset:3072 lds
v_add_u32 v114, 131072, v114
Mvva 128,224,176
ds_read_b64_tr_b16 v[192:193], v12 offset:0
ds_read_b64_tr_b16 v[194:195], v12 offset:2048
Mvva 128,240,184
Mvva 144,224,180
s_waitcnt lgkmcnt(10)
ds_read_b64_tr_b16 v[208:209], v12 offset:4096
ds_read_b64_tr_b16 v[210:211], v12 offset:6144
Mvva 144,240,188
buffer_load_dwordx4 a[224:227], v112, s[8:11], s52 offen offset:0 sc1
Mvva 132,228,176
ds_read_b64_tr_b16 v[196:197], v13 offset:0
ds_read_b64_tr_b16 v[198:199], v13 offset:2048
Mvva 132,244,184
Mvva 148,228,180
s_waitcnt lgkmcnt(10)
ds_read_b64_tr_b16 v[212:213], v13 offset:4096
ds_read_b64_tr_b16 v[214:215], v13 offset:6144
Mvva 148,244,188
buffer_load_dwordx4 a[228:231], v112, s[8:11], s52 offen offset:1024 sc1
s_add_u32 s52, s52, 8192
Mvva 136,232,176
ds_read_b64_tr_b16 v[200:201], v14 offset:0
ds_read_b64_tr_b16 v[202:203], v14 offset:2048
Mvva 136,248,184
Mvva 152,232,180
s_waitcnt lgkmcnt(10)
ds_read_b64_tr_b16 v[216:217], v14 offset:4096
ds_read_b64_tr_b16 v[218:219], v14 offset:6144
Mvva 152,248,188
buffer_load_dwordx4 a[232:235], v112, s[8:11], s52 offen offset:0 sc1
Mvva 140,236,176
ds_read_b64_tr_b16 v[204:205], v15 offset:0
ds_read_b64_tr_b16 v[206:207], v15 offset:2048
Mvva 140,252,184
Mvva 156,236,180
s_waitcnt lgkmcnt(10)
ds_read_b64_tr_b16 v[220:221], v15 offset:4096
ds_read_b64_tr_b16 v[222:223], v15 offset:6144
Mvva 156,252,188
buffer_load_dwordx4 a[236:239], v112, s[8:11], s52 offen offset:1024 sc1
s_add_u32 s52, s52, 8192
s_waitcnt vmcnt(16)
Mvva 160,192,192
ds_read_b64_tr_b16 v[224:225], v12 offset:8192
ds_read_b64_tr_b16 v[226:227], v12 offset:10240
Mvva 160,208,200
Mvva 176,192,196
s_waitcnt lgkmcnt(10)
s_add_u32 m0, s44, 114688
ds_read_b64_tr_b16 v[240:241], v12 offset:12288
ds_read_b64_tr_b16 v[242:243], v12 offset:14336
Mvva 176,208,204
buffer_load_dwordx4 v114, s[12:15], s48 offen offset:0 lds
Mvva 164,196,192
ds_read_b64_tr_b16 v[228:229], v13 offset:8192
ds_read_b64_tr_b16 v[230:231], v13 offset:10240
Mvva 164,212,200
Mvva 180,196,196
s_waitcnt lgkmcnt(10)
ds_read_b64_tr_b16 v[244:245], v13 offset:12288
ds_read_b64_tr_b16 v[246:247], v13 offset:14336
Mvva 180,212,204
buffer_load_dwordx4 v114, s[12:15], s49 offen offset:1024 lds
Mvva 168,200,192
ds_read_b64_tr_b16 v[232:233], v14 offset:8192
ds_read_b64_tr_b16 v[234:235], v14 offset:10240
Mvva 168,216,200
Mvva 184,200,196
s_waitcnt lgkmcnt(10)
ds_read_b64_tr_b16 v[248:249], v14 offset:12288
ds_read_b64_tr_b16 v[250:251], v14 offset:14336
Mvva 184,216,204
buffer_load_dwordx4 v114, s[12:15], s50 offen offset:2048 lds
Mvva 172,204,192
s_waitcnt vmcnt(15)
ds_read_b64_tr_b16 v[236:237], v15 offset:8192
ds_read_b64_tr_b16 v[238:239], v15 offset:10240
Mvva 172,220,200
s_waitcnt lgkmcnt(10)
Mvva 188,204,196
s_barrier
ds_read_b64_tr_b16 v[252:253], v15 offset:12288
ds_read_b64_tr_b16 v[254:255], v15 offset:14336
Mvva 188,220,204
buffer_load_dwordx4 v114, s[12:15], s51 offen offset:3072 lds
v_add_u32_e64 v114, s95, v113
Mvva 128,224,192
ds_read_b64_tr_b16 v[192:193], v12 offset:16384
ds_read_b64_tr_b16 v[194:195], v12 offset:18432
Mvva 128,240,200
Mvva 144,224,196
s_waitcnt lgkmcnt(10)
ds_read_b64_tr_b16 v[208:209], v12 offset:20480
ds_read_b64_tr_b16 v[210:211], v12 offset:22528
Mvva 144,240,204
buffer_load_dwordx4 a[240:243], v112, s[8:11], s52 offen offset:0 sc1
Mvva 132,228,192
ds_read_b64_tr_b16 v[196:197], v13 offset:16384
ds_read_b64_tr_b16 v[198:199], v13 offset:18432
Mvva 132,244,200
Mvva 148,228,196
s_waitcnt lgkmcnt(10)
ds_read_b64_tr_b16 v[212:213], v13 offset:20480
ds_read_b64_tr_b16 v[214:215], v13 offset:22528
Mvva 148,244,204
buffer_load_dwordx4 a[244:247], v112, s[8:11], s52 offen offset:1024 sc1
s_add_u32 s52, s52, 8192
Mvva 136,232,192
ds_read_b64_tr_b16 v[200:201], v14 offset:16384
ds_read_b64_tr_b16 v[202:203], v14 offset:18432
Mvva 136,248,200
Mvva 152,232,196
s_waitcnt lgkmcnt(10)
ds_read_b64_tr_b16 v[216:217], v14 offset:20480
ds_read_b64_tr_b16 v[218:219], v14 offset:22528
Mvva 152,248,204
buffer_load_dwordx4 a[248:251], v112, s[8:11], s52 offen offset:0 sc1
Mvva 140,236,192
ds_read_b64_tr_b16 v[204:205], v15 offset:16384
ds_read_b64_tr_b16 v[206:207], v15 offset:18432
Mvva 140,252,200
Mvva 156,236,196
s_waitcnt lgkmcnt(10)
ds_read_b64_tr_b16 v[220:221], v15 offset:20480
ds_read_b64_tr_b16 v[222:223], v15 offset:22528
Mvva 156,252,204
buffer_load_dwordx4 a[252:255], v112, s[8:11], s52 offen offset:1024 sc1
s_add_u32 s52, s52, 8192
s_waitcnt vmcnt(16)
Mvva 160,192,208
s_add_u32 m0, s44, 0
ds_read_b64_tr_b16 v[224:225], v12 offset:24576
ds_read_b64_tr_b16 v[226:227], v12 offset:26624
Mvva 160,208,216
buffer_load_dwordx4 v114, s[12:15], s48 offen offset:0 lds
Mvva 176,192,212
s_waitcnt lgkmcnt(10)
ds_read_b64_tr_b16 v[240:241], v12 offset:28672
ds_read_b64_tr_b16 v[242:243], v12 offset:30720
Mvva 176,208,220
Mvva 164,196,208
ds_read_b64_tr_b16 v[228:229], v13 offset:24576
ds_read_b64_tr_b16 v[230:231], v13 offset:26624
Mvva 164,212,216
buffer_load_dwordx4 v114, s[12:15], s49 offen offset:1024 lds
Mvva 180,196,212
s_waitcnt lgkmcnt(10)
ds_read_b64_tr_b16 v[244:245], v13 offset:28672
ds_read_b64_tr_b16 v[246:247], v13 offset:30720
Mvva 180,212,220
buffer_load_dwordx4 v114, s[12:15], s50 offen offset:2048 lds
Mvva 168,200,208
ds_read_b64_tr_b16 v[232:233], v14 offset:24576
ds_read_b64_tr_b16 v[234:235], v14 offset:26624
Mvva 168,216,216
buffer_load_dwordx4 v114, s[12:15], s51 offen offset:3072 lds
v_add_u32 v114, 262144, v114
Mvva 184,200,212
s_waitcnt lgkmcnt(10)
ds_read_b64_tr_b16 v[248:249], v14 offset:28672
ds_read_b64_tr_b16 v[250:251], v14 offset:30720
Mvva 184,216,220
Mvva 172,204,208
s_waitcnt vmcnt(16)
ds_read_b64_tr_b16 v[236:237], v15 offset:24576
ds_read_b64_tr_b16 v[238:239], v15 offset:26624
Mvva 172,220,216
s_waitcnt lgkmcnt(10)
buffer_load_dwordx4 a[0:3], v112, s[8:11], s52 offen offset:0 sc1
Mvva 188,204,212
s_barrier
ds_read_b64_tr_b16 v[252:253], v15 offset:28672
ds_read_b64_tr_b16 v[254:255], v15 offset:30720
Mvva 188,220,220
buffer_load_dwordx4 a[4:7], v112, s[8:11], s52 offen offset:1024 sc1
s_add_u32 s52, s52, 8192
Mvva 128,224,208
ds_read_b64_tr_b16 v[192:193], v12 offset:32768
ds_read_b64_tr_b16 v[194:195], v12 offset:34816
Mvva 128,240,216
buffer_load_dwordx4 a[8:11], v112, s[8:11], s52 offen offset:0 sc1
Mvva 144,224,212
s_waitcnt lgkmcnt(10)
ds_read_b64_tr_b16 v[208:209], v12 offset:36864
ds_read_b64_tr_b16 v[210:211], v12 offset:38912
Mvva 144,240,220
Mvva 132,228,208
ds_read_b64_tr_b16 v[196:197], v13 offset:32768
ds_read_b64_tr_b16 v[198:199], v13 offset:34816
Mvva 132,244,216
buffer_load_dwordx4 a[12:15], v112, s[8:11], s52 offen offset:1024 sc1
s_add_u32 s52, s52, 8192
Mvva 148,228,212
s_waitcnt lgkmcnt(10)
ds_read_b64_tr_b16 v[212:213], v13 offset:36864
ds_read_b64_tr_b16 v[214:215], v13 offset:38912
Mvva 148,244,220
buffer_load_dwordx4 a[16:19], v112, s[8:11], s52 offen offset:0 sc1
Mvva 136,232,208
ds_read_b64_tr_b16 v[200:201], v14 offset:32768
ds_read_b64_tr_b16 v[202:203], v14 offset:34816
Mvva 136,248,216
buffer_load_dwordx4 a[20:23], v112, s[8:11], s52 offen offset:1024 sc1
s_add_u32 s52, s52, 8192
Mvva 152,232,212
s_waitcnt lgkmcnt(10)
ds_read_b64_tr_b16 v[216:217], v14 offset:36864
ds_read_b64_tr_b16 v[218:219], v14 offset:38912
Mvva 152,248,220
Mvva 140,236,208
ds_read_b64_tr_b16 v[204:205], v15 offset:32768
ds_read_b64_tr_b16 v[206:207], v15 offset:34816
Mvva 140,252,216
buffer_load_dwordx4 a[24:27], v112, s[8:11], s52 offen offset:0 sc1
Mvva 156,236,212
s_waitcnt lgkmcnt(10)
ds_read_b64_tr_b16 v[220:221], v15 offset:36864
ds_read_b64_tr_b16 v[222:223], v15 offset:38912
Mvva 156,252,220
buffer_load_dwordx4 a[28:31], v112, s[8:11], s52 offen offset:1024 sc1
s_add_u32 s52, s52, 8192
s_waitcnt vmcnt(20)
Mvva 160,192,224
s_add_u32 m0, s44, 16384
ds_read_b64_tr_b16 v[224:225], v12 offset:40960
ds_read_b64_tr_b16 v[226:227], v12 offset:43008
Mvva 160,208,232
buffer_load_dwordx4 v114, s[12:15], s48 offen offset:0 lds
Mvva 176,192,228
s_waitcnt lgkmcnt(10)
ds_read_b64_tr_b16 v[240:241], v12 offset:45056
ds_read_b64_tr_b16 v[242:243], v12 offset:47104
Mvva 176,208,236
Mvva 164,196,224
ds_read_b64_tr_b16 v[228:229], v13 offset:40960
ds_read_b64_tr_b16 v[230:231], v13 offset:43008
Mvva 164,212,232
buffer_load_dwordx4 v114, s[12:15], s49 offen offset:1024 lds
Mvva 180,196,228
s_waitcnt lgkmcnt(10)
ds_read_b64_tr_b16 v[244:245], v13 offset:45056
ds_read_b64_tr_b16 v[246:247], v13 offset:47104
Mvva 180,212,236
buffer_load_dwordx4 v114, s[12:15], s50 offen offset:2048 lds
Mvva 168,200,224
ds_read_b64_tr_b16 v[232:233], v14 offset:40960
ds_read_b64_tr_b16 v[234:235], v14 offset:43008
Mvva 168,216,232
buffer_load_dwordx4 v114, s[12:15], s51 offen offset:3072 lds
v_add_u32 v114, 262144, v114
Mvva 184,200,228
s_waitcnt lgkmcnt(10)
ds_read_b64_tr_b16 v[248:249], v14 offset:45056
ds_read_b64_tr_b16 v[250:251], v14 offset:47104
Mvva 184,216,236
Mvva 172,204,224
s_waitcnt vmcnt(20)
ds_read_b64_tr_b16 v[236:237], v15 offset:40960
ds_read_b64_tr_b16 v[238:239], v15 offset:43008
Mvva 172,220,232
s_waitcnt lgkmcnt(10)
buffer_load_dwordx4 a[32:35], v112, s[8:11], s52 offen offset:0 sc1
Mvva 188,204,228
s_barrier
ds_read_b64_tr_b16 v[252:253], v15 offset:45056
ds_read_b64_tr_b16 v[254:255], v15 offset:47104
Mvva 188,220,236
buffer_load_dwordx4 a[36:39], v112, s[8:11], s52 offen offset:1024 sc1
s_add_u32 s52, s52, 8192
Mvva 128,224,224
ds_read_b64_tr_b16 v[192:193], v12 offset:49152
ds_read_b64_tr_b16 v[194:195], v12 offset:51200
Mvva 128,240,232
buffer_load_dwordx4 a[40:43], v112, s[8:11], s52 offen offset:0 sc1
Mvva 144,224,228
s_waitcnt lgkmcnt(10)
ds_read_b64_tr_b16 v[208:209], v12 offset:53248
ds_read_b64_tr_b16 v[210:211], v12 offset:55296
Mvva 144,240,236
Mvva 132,228,224
ds_read_b64_tr_b16 v[196:197], v13 offset:49152
ds_read_b64_tr_b16 v[198:199], v13 offset:51200
Mvva 132,244,232
buffer_load_dwordx4 a[44:47], v112, s[8:11], s52 offen offset:1024 sc1
s_add_u32 s52, s52, 8192
Mvva 148,228,228
s_waitcnt lgkmcnt(10)
ds_read_b64_tr_b16 v[212:213], v13 offset:53248
ds_read_b64_tr_b16 v[214:215], v13 offset:55296
Mvva 148,244,236
buffer_load_dwordx4 a[48:51], v112, s[8:11], s52 offen offset:0 sc1
Mvva 136,232,224
ds_read_b64_tr_b16 v[200:201], v14 offset:49152
ds_read_b64_tr_b16 v[202:203], v14 offset:51200
Mvva 136,248,232
buffer_load_dwordx4 a[52:55], v112, s[8:11], s52 offen offset:1024 sc1
s_add_u32 s52, s52, 8192
Mvva 152,232,228
s_waitcnt lgkmcnt(10)
ds_read_b64_tr_b16 v[216:217], v14 offset:53248
ds_read_b64_tr_b16 v[218:219], v14 offset:55296
Mvva 152,248,236
Mvva 140,236,224
ds_read_b64_tr_b16 v[204:205], v15 offset:49152
ds_read_b64_tr_b16 v[206:207], v15 offset:51200
Mvva 140,252,232
buffer_load_dwordx4 a[56:59], v112, s[8:11], s52 offen offset:0 sc1
Mvva 156,236,228
s_waitcnt lgkmcnt(10)
ds_read_b64_tr_b16 v[220:221], v15 offset:53248
ds_read_b64_tr_b16 v[222:223], v15 offset:55296
Mvva 156,252,236
buffer_load_dwordx4 a[60:63], v112, s[8:11], s52 offen offset:1024 sc1
s_add_u32 s52, s52, 8192
s_waitcnt vmcnt(24)
Mvva 160,192,240
s_add_u32 m0, s44, 32768
ds_read_b64_tr_b16 v[224:225], v12 offset:57344
ds_read_b64_tr_b16 v[226:227], v12 offset:59392
Mvva 160,208,248
buffer_load_dwordx4 v114, s[12:15], s48 offen offset:0 lds
Mvva 176,192,244
s_waitcnt lgkmcnt(10)
ds_read_b64_tr_b16 v[240:241], v12 offset:61440
ds_read_b64_tr_b16 v[242:243], v12 offset:63488
Mvva 176,208,252
Mvva 164,196,240
ds_read_b64_tr_b16 v[228:229], v13 offset:57344
ds_read_b64_tr_b16 v[230:231], v13 offset:59392
Mvva 164,212,248
buffer_load_dwordx4 v114, s[12:15], s49 offen offset:1024 lds
Mvva 180,196,244
s_waitcnt lgkmcnt(10)
ds_read_b64_tr_b16 v[244:245], v13 offset:61440
ds_read_b64_tr_b16 v[246:247], v13 offset:63488
Mvva 180,212,252
buffer_load_dwordx4 v114, s[12:15], s50 offen offset:2048 lds
Mvva 168,200,240
ds_read_b64_tr_b16 v[232:233], v14 offset:57344
ds_read_b64_tr_b16 v[234:235], v14 offset:59392
Mvva 168,216,248
buffer_load_dwordx4 v114, s[12:15], s51 offen offset:3072 lds
v_add_u32 v114, 262144, v114
Mvva 184,200,244
s_waitcnt lgkmcnt(10)
ds_read_b64_tr_b16 v[248:249], v14 offset:61440
ds_read_b64_tr_b16 v[250:251], v14 offset:63488
Mvva 184,216,252
Mvva 172,204,240
s_waitcnt vmcnt(24)
ds_read_b64_tr_b16 v[236:237], v15 offset:57344
ds_read_b64_tr_b16 v[238:239], v15 offset:59392
Mvva 172,220,248
s_waitcnt lgkmcnt(10)
buffer_load_dwordx4 a[64:67], v112, s[8:11], s52 offen offset:0 sc1
Mvva 188,204,244
s_barrier
ds_read_b64_tr_b16 v[252:253], v15 offset:61440
ds_read_b64_tr_b16 v[254:255], v15 offset:63488
Mvva 188,220,252
buffer_load_dwordx4 a[68:71], v112, s[8:11], s52 offen offset:1024 sc1
s_add_u32 s52, s52, 8192
Mvva 128,224,240
ds_read_b64_tr_b16 v[192:193], v115 offset:0
ds_read_b64_tr_b16 v[194:195], v115 offset:2048
Mvva 128,240,248
buffer_load_dwordx4 a[72:75], v112, s[8:11], s52 offen offset:0 sc1
Mvva 144,224,244
s_waitcnt lgkmcnt(10)
ds_read_b64_tr_b16 v[208:209], v115 offset:4096
ds_read_b64_tr_b16 v[210:211], v115 offset:6144
Mvva 144,240,252
Mvva 132,228,240
ds_read_b64_tr_b16 v[196:197], v116 offset:0
ds_read_b64_tr_b16 v[198:199], v116 offset:2048
Mvva 132,244,248
buffer_load_dwordx4 a[76:79], v112, s[8:11], s52 offen offset:1024 sc1
s_add_u32 s52, s52, 8192
Mvva 148,228,244
s_waitcnt lgkmcnt(10)
ds_read_b64_tr_b16 v[212:213], v116 offset:4096
ds_read_b64_tr_b16 v[214:215], v116 offset:6144
Mvva 148,244,252
buffer_load_dwordx4 a[80:83], v112, s[8:11], s52 offen offset:0 sc1
Mvva 136,232,240
ds_read_b64_tr_b16 v[200:201], v117 offset:0
ds_read_b64_tr_b16 v[202:203], v117 offset:2048
Mvva 136,248,248
buffer_load_dwordx4 a[84:87], v112, s[8:11], s52 offen offset:1024 sc1
s_add_u32 s52, s52, 8192
Mvva 152,232,244
s_waitcnt lgkmcnt(10)
ds_read_b64_tr_b16 v[216:217], v117 offset:4096
ds_read_b64_tr_b16 v[218:219], v117 offset:6144
Mvva 152,248,252
Mvva 140,236,240
ds_read_b64_tr_b16 v[204:205], v118 offset:0
ds_read_b64_tr_b16 v[206:207], v118 offset:2048
Mvva 140,252,248
buffer_load_dwordx4 a[88:91], v112, s[8:11], s52 offen offset:0 sc1
Mvva 156,236,244
s_waitcnt lgkmcnt(10)
ds_read_b64_tr_b16 v[220:221], v118 offset:4096
ds_read_b64_tr_b16 v[222:223], v118 offset:6144
Mvva 156,252,252
buffer_load_dwordx4 a[92:95], v112, s[8:11], s52 offen offset:1024 sc1
s_add_u32 s52, s52, 8192
s_waitcnt vmcnt(28)
Mvva 160,192,0
s_add_u32 m0, s44, 49152
ds_read_b64_tr_b16 v[224:225], v115 offset:8192
ds_read_b64_tr_b16 v[226:227], v115 offset:10240
Mvva 160,208,8
buffer_load_dwordx4 v114, s[12:15], s48 offen offset:0 lds
Mvva 176,192,4
s_waitcnt lgkmcnt(10)
ds_read_b64_tr_b16 v[240:241], v115 offset:12288
ds_read_b64_tr_b16 v[242:243], v115 offset:14336
Mvva 176,208,12
Mvva 164,196,0
ds_read_b64_tr_b16 v[228:229], v116 offset:8192
ds_read_b64_tr_b16 v[230:231], v116 offset:10240
Mvva 164,212,8
buffer_load_dwordx4 v114, s[12:15], s49 offen offset:1024 lds
Mvva 180,196,4
s_waitcnt lgkmcnt(10)
ds_read_b64_tr_b16 v[244:245], v116 offset:12288
ds_read_b64_tr_b16 v[246:247], v116 offset:14336
Mvva 180,212,12
buffer_load_dwordx4 v114, s[12:15], s50 offen offset:2048 lds
Mvva 168,200,0
ds_read_b64_tr_b16 v[232:233], v117 offset:8192
ds_read_b64_tr_b16 v[234:235], v117 offset:10240
Mvva 168,216,8
buffer_load_dwordx4 v114, s[12:15], s51 offen offset:3072 lds
v_add_u32 v114, 262144, v114
Mvva 184,200,4
s_waitcnt lgkmcnt(10)
ds_read_b64_tr_b16 v[248:249], v117 offset:12288
ds_read_b64_tr_b16 v[250:251], v117 offset:14336
Mvva 184,216,12
Mvva 172,204,0
s_waitcnt vmcnt(24)
ds_read_b64_tr_b16 v[236:237], v118 offset:8192
ds_read_b64_tr_b16 v[238:239], v118 offset:10240
Mvva 172,220,8
s_waitcnt lgkmcnt(10)
buffer_load_dwordx4 a[96:99], v112, s[8:11], s52 offen offset:0 sc1
Mvva 188,204,4
s_barrier
ds_read_b64_tr_b16 v[252:253], v118 offset:12288
ds_read_b64_tr_b16 v[254:255], v118 offset:14336
Mvva 188,220,12
buffer_load_dwordx4 a[100:103], v112, s[8:11], s52 offen offset:1024 sc1
s_add_u32 s52, s52, 8192
Mvva 160,224,16
ds_read_b64_tr_b16 v[192:193], v115 offset:16384
ds_read_b64_tr_b16 v[194:195], v115 offset:18432
Mvva 160,240,24
buffer_load_dwordx4 a[104:107], v112, s[8:11], s52 offen offset:0 sc1
Mvva 176,224,20
s_waitcnt lgkmcnt(10)
ds_read_b64_tr_b16 v[208:209], v115 offset:20480
ds_read_b64_tr_b16 v[210:211], v115 offset:22528
Mvva 176,240,28
Mvva 164,228,16
ds_read_b64_tr_b16 v[196:197], v116 offset:16384
ds_read_b64_tr_b16 v[198:199], v116 offset:18432
Mvva 164,244,24
buffer_load_dwordx4 a[108:111], v112, s[8:11], s52 offen offset:1024 sc1
s_add_u32 s52, s52, 8192
Mvva 180,228,20
s_waitcnt lgkmcnt(10)
ds_read_b64_tr_b16 v[212:213], v116 offset:20480
ds_read_b64_tr_b16 v[214:215], v116 offset:22528
Mvva 180,244,28
buffer_load_dwordx4 a[112:115], v112, s[8:11], s52 offen offset:0 sc1
Mvva 168,232,16
ds_read_b64_tr_b16 v[200:201], v117 offset:16384
ds_read_b64_tr_b16 v[202:203], v117 offset:18432
Mvva 168,248,24
buffer_load_dwordx4 a[116:119], v112, s[8:11], s52 offen offset:1024 sc1
s_add_u32 s52, s52, 8192
Mvva 184,232,20
s_waitcnt lgkmcnt(10)
ds_read_b64_tr_b16 v[216:217], v117 offset:20480
ds_read_b64_tr_b16 v[218:219], v117 offset:22528
Mvva 184,248,28
Mvva 172,236,16
ds_read_b64_tr_b16 v[204:205], v118 offset:16384
ds_read_b64_tr_b16 v[206:207], v118 offset:18432
Mvva 172,252,24
buffer_load_dwordx4 a[120:123], v112, s[8:11], s52 offen offset:0 sc1
Mvva 188,236,20
s_waitcnt lgkmcnt(10)
ds_read_b64_tr_b16 v[220:221], v118 offset:20480
ds_read_b64_tr_b16 v[222:223], v118 offset:22528
Mvva 188,252,28
buffer_load_dwordx4 a[124:127], v112, s[8:11], s52 offen offset:1024 sc1
s_add_u32 s52, s52, 8192
s_waitcnt vmcnt(28)
Mvva 160,192,32
s_add_u32 m0, s44, 65536
ds_read_b64_tr_b16 v[224:225], v115 offset:24576
ds_read_b64_tr_b16 v[226:227], v115 offset:26624
Mvva 160,208,40
buffer_load_dwordx4 v114, s[12:15], s48 offen offset:0 lds
Mvva 176,192,36
s_waitcnt lgkmcnt(10)
ds_read_b64_tr_b16 v[240:241], v115 offset:28672
ds_read_b64_tr_b16 v[242:243], v115 offset:30720
Mvva 176,208,44
Mvva 164,196,32
ds_read_b64_tr_b16 v[228:229], v116 offset:24576
ds_read_b64_tr_b16 v[230:231], v116 offset:26624
Mvva 164,212,40
buffer_load_dwordx4 v114, s[12:15], s49 offen offset:1024 lds
Mvva 180,196,36
s_waitcnt lgkmcnt(10)
ds_read_b64_tr_b16 v[244:245], v116 offset:28672
ds_read_b64_tr_b16 v[246:247], v116 offset:30720
Mvva 180,212,44
buffer_load_dwordx4 v114, s[12:15], s50 offen offset:2048 lds
Mvva 168,200,32
ds_read_b64_tr_b16 v[232:233], v117 offset:24576
ds_read_b64_tr_b16 v[234:235], v117 offset:26624
Mvva 168,216,40
buffer_load_dwordx4 v114, s[12:15], s51 offen offset:3072 lds
v_add_u32 v114, 262144, v114
Mvva 184,200,36
s_waitcnt lgkmcnt(10)
ds_read_b64_tr_b16 v[248:249], v117 offset:28672
ds_read_b64_tr_b16 v[250:251], v117 offset:30720
Mvva 184,216,44
Mvva 172,204,32
s_waitcnt vmcnt(24)
ds_read_b64_tr_b16 v[236:237], v118 offset:24576
ds_read_b64_tr_b16 v[238:239], v118 offset:26624
Mvva 172,220,40
s_waitcnt lgkmcnt(10)
buffer_load_dwordx4 a[128:131], v112, s[8:11], s52 offen offset:0 sc1
Mvva 188,204,36
s_barrier
ds_read_b64_tr_b16 v[252:253], v118 offset:28672
ds_read_b64_tr_b16 v[254:255], v118 offset:30720
Mvva 188,220,44
buffer_load_dwordx4 a[132:135], v112, s[8:11], s52 offen offset:1024 sc1
s_add_u32 s52, s52, 8192
Mvva 160,224,48
ds_read_b64_tr_b16 v[192:193], v115 offset:32768
ds_read_b64_tr_b16 v[194:195], v115 offset:34816
Mvva 160,240,56
buffer_load_dwordx4 a[136:139], v112, s[8:11], s52 offen offset:0 sc1
Mvva 176,224,52
s_waitcnt lgkmcnt(10)
ds_read_b64_tr_b16 v[208:209], v115 offset:36864
ds_read_b64_tr_b16 v[210:211], v115 offset:38912
Mvva 176,240,60
Mvva 164,228,48
ds_read_b64_tr_b16 v[196:197], v116 offset:32768
ds_read_b64_tr_b16 v[198:199], v116 offset:34816
Mvva 164,244,56
buffer_load_dwordx4 a[140:143], v112, s[8:11], s52 offen offset:1024 sc1
s_add_u32 s52, s52, 8192
Mvva 180,228,52
s_waitcnt lgkmcnt(10)
ds_read_b64_tr_b16 v[212:213], v116 offset:36864
ds_read_b64_tr_b16 v[214:215], v116 offset:38912
Mvva 180,244,60
buffer_load_dwordx4 a[144:147], v112, s[8:11], s52 offen offset:0 sc1
Mvva 168,232,48
ds_read_b64_tr_b16 v[200:201], v117 offset:32768
ds_read_b64_tr_b16 v[202:203], v117 offset:34816
Mvva 168,248,56
buffer_load_dwordx4 a[148:151], v112, s[8:11], s52 offen offset:1024 sc1
s_add_u32 s52, s52, 8192
Mvva 184,232,52
s_waitcnt lgkmcnt(10)
ds_read_b64_tr_b16 v[216:217], v117 offset:36864
ds_read_b64_tr_b16 v[218:219], v117 offset:38912
Mvva 184,248,60
Mvva 172,236,48
ds_read_b64_tr_b16 v[204:205], v118 offset:32768
ds_read_b64_tr_b16 v[206:207], v118 offset:34816
Mvva 172,252,56
buffer_load_dwordx4 a[152:155], v112, s[8:11], s52 offen offset:0 sc1
Mvva 188,236,52
s_waitcnt lgkmcnt(10)
ds_read_b64_tr_b16 v[220:221], v118 offset:36864
ds_read_b64_tr_b16 v[222:223], v118 offset:38912
Mvva 188,252,60
buffer_load_dwordx4 a[156:159], v112, s[8:11], s52 offen offset:1024 sc1
s_add_u32 s52, s52, 8192
s_waitcnt vmcnt(28)
Mvva 160,192,64
s_add_u32 m0, s44, 81920
ds_read_b64_tr_b16 v[224:225], v115 offset:40960
ds_read_b64_tr_b16 v[226:227], v115 offset:43008
Mvva 160,208,72
buffer_load_dwordx4 v114, s[12:15], s48 offen offset:0 lds
Mvva 176,192,68
s_waitcnt lgkmcnt(10)
ds_read_b64_tr_b16 v[240:241], v115 offset:45056
ds_read_b64_tr_b16 v[242:243], v115 offset:47104
Mvva 176,208,76
Mvva 164,196,64
ds_read_b64_tr_b16 v[228:229], v116 offset:40960
ds_read_b64_tr_b16 v[230:231], v116 offset:43008
Mvva 164,212,72
buffer_load_dwordx4 v114, s[12:15], s49 offen offset:1024 lds
Mvva 180,196,68
s_waitcnt lgkmcnt(10)
ds_read_b64_tr_b16 v[244:245], v116 offset:45056
ds_read_b64_tr_b16 v[246:247], v116 offset:47104
Mvva 180,212,76
buffer_load_dwordx4 v114, s[12:15], s50 offen offset:2048 lds
Mvva 168,200,64
ds_read_b64_tr_b16 v[232:233], v117 offset:40960
ds_read_b64_tr_b16 v[234:235], v117 offset:43008
Mvva 168,216,72
buffer_load_dwordx4 v114, s[12:15], s51 offen offset:3072 lds
v_add_u32 v114, 262144, v114
Mvva 184,200,68
s_waitcnt lgkmcnt(10)
ds_read_b64_tr_b16 v[248:249], v117 offset:45056
ds_read_b64_tr_b16 v[250:251], v117 offset:47104
Mvva 184,216,76
Mvva 172,204,64
s_waitcnt vmcnt(24)
ds_read_b64_tr_b16 v[236:237], v118 offset:40960
ds_read_b64_tr_b16 v[238:239], v118 offset:43008
Mvva 172,220,72
s_waitcnt lgkmcnt(10)
buffer_load_dwordx4 a[160:163], v112, s[8:11], s52 offen offset:0 sc1
Mvva 188,204,68
s_barrier
ds_read_b64_tr_b16 v[252:253], v118 offset:45056
ds_read_b64_tr_b16 v[254:255], v118 offset:47104
Mvva 188,220,76
buffer_load_dwordx4 a[164:167], v112, s[8:11], s52 offen offset:1024 sc1
s_add_u32 s52, s52, 8192
Mvva 160,224,80
ds_read_b64_tr_b16 v[192:193], v115 offset:49152
ds_read_b64_tr_b16 v[194:195], v115 offset:51200
Mvva 160,240,88
buffer_load_dwordx4 a[168:171], v112, s[8:11], s52 offen offset:0 sc1
Mvva 176,224,84
s_waitcnt lgkmcnt(10)
ds_read_b64_tr_b16 v[208:209], v115 offset:53248
ds_read_b64_tr_b16 v[210:211], v115 offset:55296
Mvva 176,240,92
Mvva 164,228,80
ds_read_b64_tr_b16 v[196:197], v116 offset:49152
ds_read_b64_tr_b16 v[198:199], v116 offset:51200
Mvva 164,244,88
buffer_load_dwordx4 a[172:175], v112, s[8:11], s52 offen offset:1024 sc1
s_add_u32 s52, s52, 8192
Mvva 180,228,84
s_waitcnt lgkmcnt(10)
ds_read_b64_tr_b16 v[212:213], v116 offset:53248
ds_read_b64_tr_b16 v[214:215], v116 offset:55296
Mvva 180,244,92
buffer_load_dwordx4 a[176:179], v112, s[8:11], s52 offen offset:0 sc1
Mvva 168,232,80
ds_read_b64_tr_b16 v[200:201], v117 offset:49152
ds_read_b64_tr_b16 v[202:203], v117 offset:51200
Mvva 168,248,88
buffer_load_dwordx4 a[180:183], v112, s[8:11], s52 offen offset:1024 sc1
s_add_u32 s52, s52, 8192
Mvva 184,232,84
s_waitcnt lgkmcnt(10)
ds_read_b64_tr_b16 v[216:217], v117 offset:53248
ds_read_b64_tr_b16 v[218:219], v117 offset:55296
Mvva 184,248,92
Mvva 172,236,80
ds_read_b64_tr_b16 v[204:205], v118 offset:49152
ds_read_b64_tr_b16 v[206:207], v118 offset:51200
Mvva 172,252,88
buffer_load_dwordx4 a[184:187], v112, s[8:11], s52 offen offset:0 sc1
Mvva 188,236,84
s_waitcnt lgkmcnt(10)
ds_read_b64_tr_b16 v[220:221], v118 offset:53248
ds_read_b64_tr_b16 v[222:223], v118 offset:55296
Mvva 188,252,92
buffer_load_dwordx4 a[188:191], v112, s[8:11], s52 offen offset:1024 sc1
s_add_u32 s52, s52, 8192
s_waitcnt vmcnt(28)
Mvva 160,192,96
s_add_u32 m0, s44, 98304
ds_read_b64_tr_b16 v[224:225], v115 offset:57344
ds_read_b64_tr_b16 v[226:227], v115 offset:59392
Mvva 160,208,104
buffer_load_dwordx4 v114, s[12:15], s48 offen offset:0 lds
Mvva 176,192,100
s_waitcnt lgkmcnt(10)
ds_read_b64_tr_b16 v[240:241], v115 offset:61440
ds_read_b64_tr_b16 v[242:243], v115 offset:63488
Mvva 176,208,108
s_cmp_lg_u32 s53, 0
s_cbranch_scc1 L_yA
L_yAr:
Mvva 164,196,96
ds_read_b64_tr_b16 v[228:229], v116 offset:57344
ds_read_b64_tr_b16 v[230:231], v116 offset:59392
Mvva 164,212,104
buffer_load_dwordx4 v114, s[12:15], s49 offen offset:1024 lds
Mvva 180,196,100
s_waitcnt lgkmcnt(10)
ds_read_b64_tr_b16 v[244:245], v116 offset:61440
ds_read_b64_tr_b16 v[246:247], v116 offset:63488
Mvva 180,212,108
buffer_load_dwordx4 v114, s[12:15], s50 offen offset:2048 lds
Mvva 168,200,96
ds_read_b64_tr_b16 v[232:233], v117 offset:57344
ds_read_b64_tr_b16 v[234:235], v117 offset:59392
Mvva 168,216,104
buffer_load_dwordx4 v114, s[12:15], s51 offen offset:3072 lds
v_add_u32 v114, 262144, v114
Mvva 184,200,100
s_waitcnt lgkmcnt(10)
ds_read_b64_tr_b16 v[248:249], v117 offset:61440
ds_read_b64_tr_b16 v[250:251], v117 offset:63488
Mvva 184,216,108
Mvva 172,204,96
s_waitcnt vmcnt(24)
ds_read_b64_tr_b16 v[236:237], v118 offset:57344
ds_read_b64_tr_b16 v[238:239], v118 offset:59392
Mvva 172,220,104
s_waitcnt lgkmcnt(10)
buffer_load_dwordx4 a[192:195], v112, s[8:11], s52 offen offset:0 sc1
Mvva 188,204,100
s_barrier
ds_read_b64_tr_b16 v[252:253], v118 offset:61440
ds_read_b64_tr_b16 v[254:255], v118 offset:63488
Mvva 188,220,108
buffer_load_dwordx4 a[196:199], v112, s[8:11], s52 offen offset:1024 sc1
s_add_u32 s52, s52, 8192
Mvva 160,224,112
ds_read_b64_tr_b16 v[192:193], v12 offset:0
ds_read_b64_tr_b16 v[194:195], v12 offset:2048
Mvva 160,240,120
buffer_load_dwordx4 a[200:203], v112, s[8:11], s52 offen offset:0 sc1
Mvva 176,224,116
s_waitcnt lgkmcnt(10)
ds_read_b64_tr_b16 v[208:209], v12 offset:4096
ds_read_b64_tr_b16 v[210:211], v12 offset:6144
Mvva 176,240,124
Mvva 164,228,112
ds_read_b64_tr_b16 v[196:197], v13 offset:0
ds_read_b64_tr_b16 v[198:199], v13 offset:2048
Mvva 164,244,120
buffer_load_dwordx4 a[204:207], v112, s[8:11], s52 offen offset:1024 sc1
s_add_u32 s52, s52, 8192
Mvva 180,228,116
s_waitcnt lgkmcnt(10)
ds_read_b64_tr_b16 v[212:213], v13 offset:4096
ds_read_b64_tr_b16 v[214:215], v13 offset:6144
Mvva 180,244,124
buffer_load_dwordx4 a[208:211], v112, s[8:11], s52 offen offset:0 sc1
Mvva 168,232,112
ds_read_b64_tr_b16 v[200:201], v14 offset:0
ds_read_b64_tr_b16 v[202:203], v14 offset:2048
Mvva 168,248,120
buffer_load_dwordx4 a[212:215], v112, s[8:11], s52 offen offset:1024 sc1
s_add_u32 s52, s52, 8192
Mvva 184,232,116
s_waitcnt lgkmcnt(10)
ds_read_b64_tr_b16 v[216:217], v14 offset:4096
ds_read_b64_tr_b16 v[218:219], v14 offset:6144
Mvva 184,248,124
Mvva 172,236,112
ds_read_b64_tr_b16 v[204:205], v15 offset:0
ds_read_b64_tr_b16 v[206:207], v15 offset:2048
Mvva 172,252,120
buffer_load_dwordx4 a[216:219], v112, s[8:11], s52 offen offset:0 sc1
Mvva 188,236,116
s_waitcnt lgkmcnt(10)
ds_read_b64_tr_b16 v[220:221], v15 offset:4096
ds_read_b64_tr_b16 v[222:223], v15 offset:6144
Mvva 188,252,124
buffer_load_dwordx4 a[220:223], v112, s[8:11], s52 offen offset:1024 sc1
s_add_u32 s52, s52, 8192
s_waitcnt vmcnt(28)
Mvva 160,192,128
s_add_u32 m0, s44, 114688
ds_read_b64_tr_b16 v[224:225], v12 offset:8192
ds_read_b64_tr_b16 v[226:227], v12 offset:10240
Mvva 160,208,136
buffer_load_dwordx4 v114, s[12:15], s48 offen offset:0 lds
Mvva 176,192,132
s_waitcnt lgkmcnt(10)
ds_read_b64_tr_b16 v[240:241], v12 offset:12288
ds_read_b64_tr_b16 v[242:243], v12 offset:14336
Mvva 176,208,140
Mvva 164,196,128
ds_read_b64_tr_b16 v[228:229], v13 offset:8192
ds_read_b64_tr_b16 v[230:231], v13 offset:10240
Mvva 164,212,136
buffer_load_dwordx4 v114, s[12:15], s49 offen offset:1024 lds
Mvva 180,196,132
s_waitcnt lgkmcnt(10)
ds_read_b64_tr_b16 v[244:245], v13 offset:12288
ds_read_b64_tr_b16 v[246:247], v13 offset:14336
Mvva 180,212,140
buffer_load_dwordx4 v114, s[12:15], s50 offen offset:2048 lds
Mvva 168,200,128
ds_read_b64_tr_b16 v[232:233], v14 offset:8192
ds_read_b64_tr_b16 v[234:235], v14 offset:10240
Mvva 168,216,136
buffer_load_dwordx4 v114, s[12:15], s51 offen offset:3072 lds
s_xor_b32 s95, s95, 128
v_add_u32 v114, s95, v113
Mvva 184,200,132
s_waitcnt lgkmcnt(10)
ds_read_b64_tr_b16 v[248:249], v14 offset:12288
ds_read_b64_tr_b16 v[250:251], v14 offset:14336
Mvva 184,216,140
Mvva 172,204,128
s_waitcnt vmcnt(24)
ds_read_b64_tr_b16 v[236:237], v15 offset:8192
ds_read_b64_tr_b16 v[238:239], v15 offset:10240
Mvva 172,220,136
s_waitcnt lgkmcnt(10)
buffer_load_dwordx4 a[224:227], v112, s[8:11], s52 offen offset:0 sc1
Mvva 188,204,132
s_barrier
ds_read_b64_tr_b16 v[252:253], v15 offset:12288
ds_read_b64_tr_b16 v[254:255], v15 offset:14336
Mvva 188,220,140
buffer_load_dwordx4 a[228:231], v112, s[8:11], s52 offen offset:1024 sc1
s_add_u32 s52, s52, 8192
Mvva 160,224,144
ds_read_b64_tr_b16 v[192:193], v12 offset:16384
ds_read_b64_tr_b16 v[194:195], v12 offset:18432
Mvva 160,240,152
buffer_load_dwordx4 a[232:235], v112, s[8:11], s52 offen offset:0 sc1
Mvva 176,224,148
s_waitcnt lgkmcnt(10)
ds_read_b64_tr_b16 v[208:209], v12 offset:20480
ds_read_b64_tr_b16 v[210:211], v12 offset:22528
Mvva 176,240,156
Mvva 164,228,144
ds_read_b64_tr_b16 v[196:197], v13 offset:16384
ds_read_b64_tr_b16 v[198:199], v13 offset:18432
Mvva 164,244,152
buffer_load_dwordx4 a[236:239], v112, s[8:11], s52 offen offset:1024 sc1
s_add_u32 s52, s52, 8192
Mvva 180,228,148
s_waitcnt lgkmcnt(10)
ds_read_b64_tr_b16 v[212:213], v13 offset:20480
ds_read_b64_tr_b16 v[214:215], v13 offset:22528
Mvva 180,244,156
buffer_load_dwordx4 a[240:243], v112, s[8:11], s52 offen offset:0 sc1
Mvva 168,232,144
ds_read_b64_tr_b16 v[200:201], v14 offset:16384
ds_read_b64_tr_b16 v[202:203], v14 offset:18432
Mvva 168,248,152
buffer_load_dwordx4 a[244:247], v112, s[8:11], s52 offen offset:1024 sc1
s_add_u32 s52, s52, 8192
Mvva 184,232,148
s_waitcnt lgkmcnt(10)
ds_read_b64_tr_b16 v[216:217], v14 offset:20480
ds_read_b64_tr_b16 v[218:219], v14 offset:22528
Mvva 184,248,156
Mvva 172,236,144
ds_read_b64_tr_b16 v[204:205], v15 offset:16384
ds_read_b64_tr_b16 v[206:207], v15 offset:18432
Mvva 172,252,152
buffer_load_dwordx4 a[248:251], v112, s[8:11], s52 offen offset:0 sc1
Mvva 188,236,148
s_waitcnt lgkmcnt(10)
ds_read_b64_tr_b16 v[220:221], v15 offset:20480
ds_read_b64_tr_b16 v[222:223], v15 offset:22528
Mvva 188,252,156
buffer_load_dwordx4 a[252:255], v112, s[8:11], s52 offen offset:1024 sc1
s_add_u32 s52, s52, 8192
s_waitcnt vmcnt(28)
Mvva 160,192,160
s_add_u32 m0, s44, 0
ds_read_b64_tr_b16 v[224:225], v12 offset:24576
ds_read_b64_tr_b16 v[226:227], v12 offset:26624
Mvva 160,208,168
buffer_load_dwordx4 v114, s[12:15], s48 offen offset:0 lds
Mvva 176,192,164
s_waitcnt lgkmcnt(10)
ds_read_b64_tr_b16 v[240:241], v12 offset:28672
ds_read_b64_tr_b16 v[242:243], v12 offset:30720
Mvva 176,208,172
Mvva 164,196,160
ds_read_b64_tr_b16 v[228:229], v13 offset:24576
ds_read_b64_tr_b16 v[230:231], v13 offset:26624
Mvva 164,212,168
buffer_load_dwordx4 v114, s[12:15], s49 offen offset:1024 lds
Mvva 180,196,164
s_waitcnt lgkmcnt(10)
ds_read_b64_tr_b16 v[244:245], v13 offset:28672
ds_read_b64_tr_b16 v[246:247], v13 offset:30720
Mvva 180,212,172
buffer_load_dwordx4 v114, s[12:15], s50 offen offset:2048 lds
Mvva 168,200,160
ds_read_b64_tr_b16 v[232:233], v14 offset:24576
ds_read_b64_tr_b16 v[234:235], v14 offset:26624
Mvva 168,216,168
buffer_load_dwordx4 v114, s[12:15], s51 offen offset:3072 lds
v_add_u32 v114, 262144, v114
Mvva 184,200,164
s_waitcnt lgkmcnt(10)
ds_read_b64_tr_b16 v[248:249], v14 offset:28672
ds_read_b64_tr_b16 v[250:251], v14 offset:30720
Mvva 184,216,172
Mvva 172,204,160
s_waitcnt vmcnt(24)
s_add_u32 m0, s44, 16384
ds_read_b64_tr_b16 v[236:237], v15 offset:24576
ds_read_b64_tr_b16 v[238:239], v15 offset:26624
Mvva 172,220,168
s_waitcnt lgkmcnt(10)
buffer_load_dwordx4 v114, s[12:15], s48 offen offset:0 lds
Mvva 188,204,164
s_barrier
ds_read_b64_tr_b16 v[252:253], v15 offset:28672
ds_read_b64_tr_b16 v[254:255], v15 offset:30720
Mvva 188,220,172
buffer_load_dwordx4 v114, s[12:15], s49 offen offset:1024 lds
Mvva 160,224,176
ds_read_b64_tr_b16 v[192:193], v12 offset:32768
ds_read_b64_tr_b16 v[194:195], v12 offset:34816
Mvva 160,240,184
buffer_load_dwordx4 v114, s[12:15], s50 offen offset:2048 lds
Mvva 176,224,180
s_waitcnt lgkmcnt(10)
ds_read_b64_tr_b16 v[208:209], v12 offset:36864
ds_read_b64_tr_b16 v[210:211], v12 offset:38912
Mvva 176,240,188
s_cmp_lg_u32 s53, 0
s_cbranch_scc1 L_yB
L_yBr:
Mvva 164,228,176
ds_read_b64_tr_b16 v[196:197], v13 offset:32768
ds_read_b64_tr_b16 v[198:199], v13 offset:34816
Mvva 164,244,184
buffer_load_dwordx4 v114, s[12:15], s51 offen offset:3072 lds
v_add_u32 v114, 262144, v114
Mvva 180,228,180
s_waitcnt lgkmcnt(10)
s_add_u32 m0, s44, 32768
ds_read_b64_tr_b16 v[212:213], v13 offset:36864
ds_read_b64_tr_b16 v[214:215], v13 offset:38912
Mvva 180,244,188
buffer_load_dwordx4 v114, s[12:15], s48 offen offset:0 lds
Mvva 168,232,176
ds_read_b64_tr_b16 v[200:201], v14 offset:32768
ds_read_b64_tr_b16 v[202:203], v14 offset:34816
Mvva 168,248,184
buffer_load_dwordx4 v114, s[12:15], s49 offen offset:1024 lds
Mvva 184,232,180
s_waitcnt lgkmcnt(10)
ds_read_b64_tr_b16 v[216:217], v14 offset:36864
ds_read_b64_tr_b16 v[218:219], v14 offset:38912
Mvva 184,248,188
Mvva 172,236,176
ds_read_b64_tr_b16 v[204:205], v15 offset:32768
ds_read_b64_tr_b16 v[206:207], v15 offset:34816
Mvva 172,252,184
buffer_load_dwordx4 v114, s[12:15], s50 offen offset:2048 lds
Mvva 188,236,180
s_waitcnt lgkmcnt(10)
ds_read_b64_tr_b16 v[220:221], v15 offset:36864
ds_read_b64_tr_b16 v[222:223], v15 offset:38912
Mvva 188,252,188
buffer_load_dwordx4 v114, s[12:15], s51 offen offset:3072 lds
v_add_u32 v114, 262144, v114
s_waitcnt vmcnt(28)
Mvva 160,192,192
ds_read_b64_tr_b16 v[224:225], v12 offset:40960
ds_read_b64_tr_b16 v[226:227], v12 offset:43008
Mvva 160,208,200
Mvva 176,192,196
s_waitcnt lgkmcnt(10)
s_add_u32 m0, s44, 49152
ds_read_b64_tr_b16 v[240:241], v12 offset:45056
ds_read_b64_tr_b16 v[242:243], v12 offset:47104
Mvva 176,208,204
buffer_load_dwordx4 v114, s[12:15], s48 offen offset:0 lds
Mvva 164,196,192
ds_read_b64_tr_b16 v[228:229], v13 offset:40960
ds_read_b64_tr_b16 v[230:231], v13 offset:43008
Mvva 164,212,200
Mvva 180,196,196
s_waitcnt lgkmcnt(10)
ds_read_b64_tr_b16 v[244:245], v13 offset:45056
ds_read_b64_tr_b16 v[246:247], v13 offset:47104
Mvva 180,212,204
buffer_load_dwordx4 v114, s[12:15], s49 offen offset:1024 lds
Mvva 168,200,192
ds_read_b64_tr_b16 v[232:233], v14 offset:40960
ds_read_b64_tr_b16 v[234:235], v14 offset:43008
Mvva 168,216,200
Mvva 184,200,196
s_waitcnt lgkmcnt(10)
ds_read_b64_tr_b16 v[248:249], v14 offset:45056
ds_read_b64_tr_b16 v[250:251], v14 offset:47104
Mvva 184,216,204
buffer_load_dwordx4 v114, s[12:15], s50 offen offset:2048 lds
Mvva 172,204,192
s_waitcnt vmcnt(23)
ds_read_b64_tr_b16 v[236:237], v15 offset:40960
ds_read_b64_tr_b16 v[238:239], v15 offset:43008
Mvva 172,220,200
s_waitcnt lgkmcnt(10)
Mvva 188,204,196
s_barrier
ds_read_b64_tr_b16 v[252:253], v15 offset:45056
ds_read_b64_tr_b16 v[254:255], v15 offset:47104
Mvva 188,220,204
buffer_load_dwordx4 v114, s[12:15], s51 offen offset:3072 lds
v_add_u32 v114, 262144, v114
Mvva 160,224,208
ds_read_b64_tr_b16 v[192:193], v12 offset:49152
ds_read_b64_tr_b16 v[194:195], v12 offset:51200
Mvva 160,240,216
Mvva 176,224,212
s_waitcnt lgkmcnt(10)
s_add_u32 m0, s44, 65536
ds_read_b64_tr_b16 v[208:209], v12 offset:53248
ds_read_b64_tr_b16 v[210:211], v12 offset:55296
Mvva 176,240,220
buffer_load_dwordx4 v114, s[12:15], s48 offen offset:0 lds
Mvva 164,228,208
ds_read_b64_tr_b16 v[196:197], v13 offset:49152
ds_read_b64_tr_b16 v[198:199], v13 offset:51200
Mvva 164,244,216
Mvva 180,228,212
s_waitcnt lgkmcnt(10)
ds_read_b64_tr_b16 v[212:213], v13 offset:53248
ds_read_b64_tr_b16 v[214:215], v13 offset:55296
Mvva 180,244,220
buffer_load_dwordx4 v114, s[12:15], s49 offen offset:1024 lds
Mvva 168,232,208
ds_read_b64_tr_b16 v[200:201], v14 offset:49152
ds_read_b64_tr_b16 v[202:203], v14 offset:51200
Mvva 168,248,216
Mvva 184,232,212
s_waitcnt lgkmcnt(10)
ds_read_b64_tr_b16 v[216:217], v14 offset:53248
ds_read_b64_tr_b16 v[218:219], v14 offset:55296
Mvva 184,248,220
buffer_load_dwordx4 v114, s[12:15], s50 offen offset:2048 lds
Mvva 172,236,208
ds_read_b64_tr_b16 v[204:205], v15 offset:49152
ds_read_b64_tr_b16 v[206:207], v15 offset:51200
Mvva 172,252,216
Mvva 188,236,212
s_waitcnt lgkmcnt(10)
ds_read_b64_tr_b16 v[220:221], v15 offset:53248
ds_read_b64_tr_b16 v[222:223], v15 offset:55296
Mvva 188,252,220
buffer_load_dwordx4 v114, s[12:15], s51 offen offset:3072 lds
v_add_u32 v114, 262144, v114
s_waitcnt vmcnt(24)
Mvva 160,192,224
ds_read_b64_tr_b16 v[224:225], v12 offset:57344
ds_read_b64_tr_b16 v[226:227], v12 offset:59392
Mvva 160,208,232
Mvva 176,192,228
s_waitcnt lgkmcnt(10)
ds_read_b64_tr_b16 v[240:241], v12 offset:61440
ds_read_b64_tr_b16 v[242:243], v12 offset:63488
Mvva 176,208,236
Mvva 164,196,224
s_add_u32 m0, s44, 81920
ds_read_b64_tr_b16 v[228:229], v13 offset:57344
ds_read_b64_tr_b16 v[230:231], v13 offset:59392
Mvva 164,212,232
buffer_load_dwordx4 v114, s[12:15], s48 offen offset:0 lds
Mvva 180,196,228
s_waitcnt lgkmcnt(10)
ds_read_b64_tr_b16 v[244:245], v13 offset:61440
ds_read_b64_tr_b16 v[246:247], v13 offset:63488
Mvva 180,212,236
Mvva 168,200,224
ds_read_b64_tr_b16 v[232:233], v14 offset:57344
ds_read_b64_tr_b16 v[234:235], v14 offset:59392
Mvva 168,216,232
Mvva 184,200,228
s_waitcnt lgkmcnt(10)
ds_read_b64_tr_b16 v[248:249], v14 offset:61440
ds_read_b64_tr_b16 v[250:251], v14 offset:63488
Mvva 184,216,236
Mvva 172,204,224
s_waitcnt vmcnt(17)
ds_read_b64_tr_b16 v[236:237], v15 offset:57344
ds_read_b64_tr_b16 v[238:239], v15 offset:59392
Mvva 172,220,232
s_waitcnt lgkmcnt(10)
buffer_load_dwordx4 v114, s[12:15], s49 offen offset:1024 lds
Mvva 188,204,228
s_barrier
ds_read_b64_tr_b16 v[252:253], v15 offset:61440
ds_read_b64_tr_b16 v[254:255], v15 offset:63488
Mvva 188,220,236
Mvva 160,224,240
ds_read_b64_tr_b16 v[192:193], v115 offset:0
ds_read_b64_tr_b16 v[194:195], v115 offset:2048
Mvva 160,240,248
s_cmp_lg_u32 s40, 0
s_cbranch_scc1 L_yC
L_yCr:
Mvva 176,224,244
s_waitcnt lgkmcnt(10)
ds_read_b64_tr_b16 v[208:209], v115 offset:4096
ds_read_b64_tr_b16 v[210:211], v115 offset:6144
Mvva 176,240,252
Mvva 164,228,240
ds_read_b64_tr_b16 v[196:197], v116 offset:0
ds_read_b64_tr_b16 v[198:199], v116 offset:2048
Mvva 164,244,248
buffer_load_dwordx4 v114, s[12:15], s50 offen offset:2048 lds
Mvva 180,228,244
s_waitcnt lgkmcnt(10)
ds_read_b64_tr_b16 v[212:213], v116 offset:4096
ds_read_b64_tr_b16 v[214:215], v116 offset:6144
Mvva 180,244,252
Mvva 168,232,240
ds_read_b64_tr_b16 v[200:201], v117 offset:0
ds_read_b64_tr_b16 v[202:203], v117 offset:2048
Mvva 168,248,248
Mvva 184,232,244
s_waitcnt lgkmcnt(10)
ds_read_b64_tr_b16 v[216:217], v117 offset:4096
ds_read_b64_tr_b16 v[218:219], v117 offset:6144
Mvva 184,248,252
Mvva 172,236,240
ds_read_b64_tr_b16 v[204:205], v118 offset:0
ds_read_b64_tr_b16 v[206:207], v118 offset:2048
Mvva 172,252,248
buffer_load_dwordx4 v114, s[12:15], s51 offen offset:3072 lds
v_add_u32 v114, 262144, v114
Mvva 188,236,244
s_waitcnt lgkmcnt(10)
ds_read_b64_tr_b16 v[220:221], v118 offset:4096
ds_read_b64_tr_b16 v[222:223], v118 offset:6144
Mvva 188,252,252
Mvva 128,192,0
ds_read_b64_tr_b16 v[224:225], v115 offset:8192
ds_read_b64_tr_b16 v[226:227], v115 offset:10240
Mvva 128,208,8
Mvva 144,192,4
s_waitcnt lgkmcnt(10)
ds_read_b64_tr_b16 v[240:241], v115 offset:12288
ds_read_b64_tr_b16 v[242:243], v115 offset:14336
Mvva 144,208,12
Mvva 132,196,0
s_add_u32 m0, s44, 98304
ds_read_b64_tr_b16 v[228:229], v116 offset:8192
ds_read_b64_tr_b16 v[230:231], v116 offset:10240
Mvva 132,212,8
buffer_load_dwordx4 v114, s[12:15], s48 offen offset:0 lds
Mvva 148,196,4
s_waitcnt lgkmcnt(10)
ds_read_b64_tr_b16 v[244:245], v116 offset:12288
ds_read_b64_tr_b16 v[246:247], v116 offset:14336
Mvva 148,212,12
v_add_u32 v10, 4096, v112
Mvva 136,200,0
ds_read_b64_tr_b16 v[232:233], v117 offset:8192
ds_read_b64_tr_b16 v[234:235], v117 offset:10240
Mvva 136,216,8
buffer_store_dwordx4 v[160:163], v112, s[16:19], s26 offen offset:0 sc1
Mvva 152,200,4
s_waitcnt lgkmcnt(10)
ds_read_b64_tr_b16 v[248:249], v117 offset:12288
ds_read_b64_tr_b16 v[250:251], v117 offset:14336
Mvva 152,216,12
buffer_store_dwordx4 v[164:167], v112, s[16:19], s26 offen offset:1024 sc1
Mvva 140,204,0
s_waitcnt vmcnt(19)
ds_read_b64_tr_b16 v[236:237], v118 offset:8192
ds_read_b64_tr_b16 v[238:239], v118 offset:10240
Mvva 140,220,8
s_waitcnt lgkmcnt(10)
buffer_load_dwordx4 v114, s[12:15], s49 offen offset:1024 lds
Mvva 156,204,4
s_barrier
ds_read_b64_tr_b16 v[252:253], v118 offset:12288
ds_read_b64_tr_b16 v[254:255], v118 offset:14336
Mvva 156,220,12
buffer_store_dwordx4 v[168:171], v112, s[16:19], s26 offen offset:2048 sc1
Mvva 128,224,16
ds_read_b64_tr_b16 v[192:193], v115 offset:16384
ds_read_b64_tr_b16 v[194:195], v115 offset:18432
Mvva 128,240,24
buffer_store_dwordx4 v[172:175], v112, s[16:19], s26 offen offset:3072 sc1
Mvva 144,224,20
s_waitcnt lgkmcnt(10)
ds_read_b64_tr_b16 v[208:209], v115 offset:20480
ds_read_b64_tr_b16 v[210:211], v115 offset:22528
Mvva 144,240,28
buffer_store_dwordx4 v[176:179], v10, s[16:19], s26 offen offset:0 sc1
Mvva 132,228,16
ds_read_b64_tr_b16 v[196:197], v116 offset:16384
ds_read_b64_tr_b16 v[198:199], v116 offset:18432
Mvva 132,244,24
buffer_load_dwordx4 v114, s[12:15], s50 offen offset:2048 lds
Mvva 148,228,20
s_waitcnt lgkmcnt(10)
ds_read_b64_tr_b16 v[212:213], v116 offset:20480
ds_read_b64_tr_b16 v[214:215], v116 offset:22528
Mvva 148,244,28
buffer_store_dwordx4 v[180:183], v10, s[16:19], s26 offen offset:1024 sc1
Mvva 136,232,16
ds_read_b64_tr_b16 v[200:201], v117 offset:16384
ds_read_b64_tr_b16 v[202:203], v117 offset:18432
Mvva 136,248,24
buffer_store_dwordx4 v[184:187], v10, s[16:19], s26 offen offset:2048 sc1
Mvva 152,232,20
s_waitcnt lgkmcnt(10)
ds_read_b64_tr_b16 v[216:217], v117 offset:20480
ds_read_b64_tr_b16 v[218:219], v117 offset:22528
Mvva 152,248,28
buffer_store_dwordx4 v[188:191], v10, s[16:19], s26 offen offset:3072 sc1
Mvva 140,236,16
ds_read_b64_tr_b16 v[204:205], v118 offset:16384
ds_read_b64_tr_b16 v[206:207], v118 offset:18432
Mvva 140,252,24
buffer_load_dwordx4 v114, s[12:15], s51 offen offset:3072 lds
v_add_u32 v114, 262144, v114
Mvva 156,236,20
s_waitcnt lgkmcnt(10)
ds_read_b64_tr_b16 v[220:221], v118 offset:20480
ds_read_b64_tr_b16 v[222:223], v118 offset:22528
Mvva 156,252,28
v_mov_b32_e64 v16, 1
Mvva 128,192,32
ds_read_b64_tr_b16 v[224:225], v115 offset:24576
ds_read_b64_tr_b16 v[226:227], v115 offset:26624
Mvva 128,208,40
Mvva 144,192,36
s_waitcnt lgkmcnt(10)
ds_read_b64_tr_b16 v[240:241], v115 offset:28672
ds_read_b64_tr_b16 v[242:243], v115 offset:30720
Mvva 144,208,44
Mvva 132,196,32
s_add_u32 m0, s44, 114688
ds_read_b64_tr_b16 v[228:229], v116 offset:24576
ds_read_b64_tr_b16 v[230:231], v116 offset:26624
Mvva 132,212,40
buffer_load_dwordx4 v114, s[12:15], s48 offen offset:0 lds
Mvva 148,196,36
s_waitcnt lgkmcnt(10)
ds_read_b64_tr_b16 v[244:245], v116 offset:28672
ds_read_b64_tr_b16 v[246:247], v116 offset:30720
Mvva 148,212,44
Mvva 136,200,32
ds_read_b64_tr_b16 v[232:233], v117 offset:24576
ds_read_b64_tr_b16 v[234:235], v117 offset:26624
Mvva 136,216,40
Mvva 152,200,36
s_waitcnt lgkmcnt(10)
ds_read_b64_tr_b16 v[248:249], v117 offset:28672
ds_read_b64_tr_b16 v[250:251], v117 offset:30720
Mvva 152,216,44
Mvva 140,204,32
s_waitcnt vmcnt(25)
ds_read_b64_tr_b16 v[236:237], v118 offset:24576
ds_read_b64_tr_b16 v[238:239], v118 offset:26624
Mvva 140,220,40
s_waitcnt lgkmcnt(10)
buffer_load_dwordx4 v114, s[12:15], s49 offen offset:1024 lds
Mvva 156,204,36
s_barrier
ds_read_b64_tr_b16 v[252:253], v118 offset:28672
ds_read_b64_tr_b16 v[254:255], v118 offset:30720
Mvva 156,220,44
Mvva 128,224,48
ds_read_b64_tr_b16 v[192:193], v115 offset:32768
ds_read_b64_tr_b16 v[194:195], v115 offset:34816
Mvva 128,240,56
Mvva 144,224,52
s_waitcnt lgkmcnt(10)
ds_read_b64_tr_b16 v[208:209], v115 offset:36864
ds_read_b64_tr_b16 v[210:211], v115 offset:38912
Mvva 144,240,60
Mvva 132,228,48
ds_read_b64_tr_b16 v[196:197], v116 offset:32768
ds_read_b64_tr_b16 v[198:199], v116 offset:34816
Mvva 132,244,56
buffer_load_dwordx4 v114, s[12:15], s50 offen offset:2048 lds
Mvva 148,228,52
s_waitcnt lgkmcnt(10)
ds_read_b64_tr_b16 v[212:213], v116 offset:36864
ds_read_b64_tr_b16 v[214:215], v116 offset:38912
Mvva 148,244,60
Mvva 136,232,48
ds_read_b64_tr_b16 v[200:201], v117 offset:32768
ds_read_b64_tr_b16 v[202:203], v117 offset:34816
Mvva 136,248,56
Mvva 152,232,52
s_waitcnt lgkmcnt(10)
ds_read_b64_tr_b16 v[216:217], v117 offset:36864
ds_read_b64_tr_b16 v[218:219], v117 offset:38912
Mvva 152,248,60
Mvva 140,236,48
ds_read_b64_tr_b16 v[204:205], v118 offset:32768
ds_read_b64_tr_b16 v[206:207], v118 offset:34816
Mvva 140,252,56
buffer_load_dwordx4 v114, s[12:15], s51 offen offset:3072 lds
v_add_u32 v114, 262144, v114
Mvva 156,236,52
s_waitcnt lgkmcnt(10)
ds_read_b64_tr_b16 v[220:221], v118 offset:36864
ds_read_b64_tr_b16 v[222:223], v118 offset:38912
Mvva 156,252,60
Mvva 128,192,64
ds_read_b64_tr_b16 v[224:225], v115 offset:40960
ds_read_b64_tr_b16 v[226:227], v115 offset:43008
Mvva 128,208,72
Mvva 144,192,68
s_waitcnt lgkmcnt(10)
ds_read_b64_tr_b16 v[240:241], v115 offset:45056
ds_read_b64_tr_b16 v[242:243], v115 offset:47104
Mvva 144,208,76
Mvva 132,196,64
ds_read_b64_tr_b16 v[228:229], v116 offset:40960
ds_read_b64_tr_b16 v[230:231], v116 offset:43008
Mvva 132,212,72
Mvva 148,196,68
s_waitcnt lgkmcnt(10)
ds_read_b64_tr_b16 v[244:245], v116 offset:45056
ds_read_b64_tr_b16 v[246:247], v116 offset:47104
Mvva 148,212,76
Mvva 136,200,64
ds_read_b64_tr_b16 v[232:233], v117 offset:40960
ds_read_b64_tr_b16 v[234:235], v117 offset:43008
Mvva 136,216,72
Mvva 152,200,68
s_waitcnt lgkmcnt(10)
ds_read_b64_tr_b16 v[248:249], v117 offset:45056
ds_read_b64_tr_b16 v[250:251], v117 offset:47104
Mvva 152,216,76
Mvva 140,204,64
s_waitcnt vmcnt(24)
ds_read_b64_tr_b16 v[236:237], v118 offset:40960
ds_read_b64_tr_b16 v[238:239], v118 offset:43008
Mvva 140,220,72
s_waitcnt lgkmcnt(10)
Mvva 156,204,68
s_barrier
ds_read_b64_tr_b16 v[252:253], v118 offset:45056
ds_read_b64_tr_b16 v[254:255], v118 offset:47104
Mvva 156,220,76
Mvva 128,224,80
ds_read_b64_tr_b16 v[192:193], v115 offset:49152
ds_read_b64_tr_b16 v[194:195], v115 offset:51200
Mvva 128,240,88
Mvva 144,224,84
s_waitcnt lgkmcnt(10)
ds_read_b64_tr_b16 v[208:209], v115 offset:53248
ds_read_b64_tr_b16 v[210:211], v115 offset:55296
Mvva 144,240,92
Mvva 132,228,80
ds_read_b64_tr_b16 v[196:197], v116 offset:49152
ds_read_b64_tr_b16 v[198:199], v116 offset:51200
Mvva 132,244,88
Mvva 148,228,84
s_waitcnt lgkmcnt(10)
ds_read_b64_tr_b16 v[212:213], v116 offset:53248
ds_read_b64_tr_b16 v[214:215], v116 offset:55296
Mvva 148,244,92
Mvva 136,232,80
ds_read_b64_tr_b16 v[200:201], v117 offset:49152
ds_read_b64_tr_b16 v[202:203], v117 offset:51200
Mvva 136,248,88
Mvva 152,232,84
s_waitcnt lgkmcnt(10)
ds_read_b64_tr_b16 v[216:217], v117 offset:53248
ds_read_b64_tr_b16 v[218:219], v117 offset:55296
Mvva 152,248,92
Mvva 140,236,80
ds_read_b64_tr_b16 v[204:205], v118 offset:49152
ds_read_b64_tr_b16 v[206:207], v118 offset:51200
Mvva 140,252,88
Mvva 156,236,84
s_waitcnt lgkmcnt(10)
ds_read_b64_tr_b16 v[220:221], v118 offset:53248
ds_read_b64_tr_b16 v[222:223], v118 offset:55296
Mvva 156,252,92
Mvva 128,192,96
ds_read_b64_tr_b16 v[224:225], v115 offset:57344
ds_read_b64_tr_b16 v[226:227], v115 offset:59392
Mvva 128,208,104
Mvva 144,192,100
s_waitcnt lgkmcnt(10)
ds_read_b64_tr_b16 v[240:241], v115 offset:61440
ds_read_b64_tr_b16 v[242:243], v115 offset:63488
Mvva 144,208,108
Mvva 132,196,96
ds_read_b64_tr_b16 v[228:229], v116 offset:57344
ds_read_b64_tr_b16 v[230:231], v116 offset:59392
Mvva 132,212,104
Mvva 148,196,100
s_waitcnt lgkmcnt(10)
ds_read_b64_tr_b16 v[244:245], v116 offset:61440
ds_read_b64_tr_b16 v[246:247], v116 offset:63488
Mvva 148,212,108
s_waitcnt vmcnt(5)
s_mov_b64 exec, 1
buffer_store_dword v16, v126, s[20:23], s27 offen sc1
s_mov_b64 exec, -1
Mvva 136,200,96
ds_read_b64_tr_b16 v[232:233], v117 offset:57344
ds_read_b64_tr_b16 v[234:235], v117 offset:59392
Mvva 136,216,104
Mvva 152,200,100
s_waitcnt lgkmcnt(10)
ds_read_b64_tr_b16 v[248:249], v117 offset:61440
ds_read_b64_tr_b16 v[250:251], v117 offset:63488
Mvva 152,216,108
Mvva 140,204,96
ds_read_b64_tr_b16 v[236:237], v118 offset:57344
ds_read_b64_tr_b16 v[238:239], v118 offset:59392
Mvva 140,220,104
s_waitcnt lgkmcnt(10)
Mvva 156,204,100
s_barrier
ds_read_b64_tr_b16 v[252:253], v118 offset:61440
ds_read_b64_tr_b16 v[254:255], v118 offset:63488
Mvva 156,220,108
Mvva 128,224,112
ds_read_b64_tr_b16 v[192:193], v12 offset:0
ds_read_b64_tr_b16 v[194:195], v12 offset:2048
Mvva 128,240,120
Mvva 144,224,116
s_waitcnt lgkmcnt(10)
ds_read_b64_tr_b16 v[208:209], v12 offset:4096
ds_read_b64_tr_b16 v[210:211], v12 offset:6144
Mvva 144,240,124
Mvva 132,228,112
ds_read_b64_tr_b16 v[196:197], v13 offset:0
ds_read_b64_tr_b16 v[198:199], v13 offset:2048
Mvva 132,244,120
Mvva 148,228,116
s_waitcnt lgkmcnt(10)
ds_read_b64_tr_b16 v[212:213], v13 offset:4096
ds_read_b64_tr_b16 v[214:215], v13 offset:6144
Mvva 148,244,124
Mvva 136,232,112
ds_read_b64_tr_b16 v[200:201], v14 offset:0
ds_read_b64_tr_b16 v[202:203], v14 offset:2048
Mvva 136,248,120
Mvva 152,232,116
s_waitcnt lgkmcnt(10)
ds_read_b64_tr_b16 v[216:217], v14 offset:4096
ds_read_b64_tr_b16 v[218:219], v14 offset:6144
Mvva 152,248,124
Mvva 140,236,112
ds_read_b64_tr_b16 v[204:205], v15 offset:0
ds_read_b64_tr_b16 v[206:207], v15 offset:2048
Mvva 140,252,120
Mvva 156,236,116
s_waitcnt lgkmcnt(10)
ds_read_b64_tr_b16 v[220:221], v15 offset:4096
ds_read_b64_tr_b16 v[222:223], v15 offset:6144
Mvva 156,252,124
Mvva 128,192,128
ds_read_b64_tr_b16 v[224:225], v12 offset:8192
ds_read_b64_tr_b16 v[226:227], v12 offset:10240
Mvva 128,208,136
Mvva 144,192,132
s_waitcnt lgkmcnt(10)
ds_read_b64_tr_b16 v[240:241], v12 offset:12288
ds_read_b64_tr_b16 v[242:243], v12 offset:14336
Mvva 144,208,140
Mvva 132,196,128
ds_read_b64_tr_b16 v[228:229], v13 offset:8192
ds_read_b64_tr_b16 v[230:231], v13 offset:10240
Mvva 132,212,136
Mvva 148,196,132
s_waitcnt lgkmcnt(10)
ds_read_b64_tr_b16 v[244:245], v13 offset:12288
ds_read_b64_tr_b16 v[246:247], v13 offset:14336
Mvva 148,212,140
Mvva 136,200,128
ds_read_b64_tr_b16 v[232:233], v14 offset:8192
ds_read_b64_tr_b16 v[234:235], v14 offset:10240
Mvva 136,216,136
Mvva 152,200,132
s_waitcnt lgkmcnt(10)
ds_read_b64_tr_b16 v[248:249], v14 offset:12288
ds_read_b64_tr_b16 v[250:251], v14 offset:14336
Mvva 152,216,140
Mvva 140,204,128
ds_read_b64_tr_b16 v[236:237], v15 offset:8192
ds_read_b64_tr_b16 v[238:239], v15 offset:10240
Mvva 140,220,136
s_waitcnt lgkmcnt(10)
Mvva 156,204,132
s_barrier
ds_read_b64_tr_b16 v[252:253], v15 offset:12288
ds_read_b64_tr_b16 v[254:255], v15 offset:14336
Mvva 156,220,140
Mvva 128,224,144
ds_read_b64_tr_b16 v[192:193], v12 offset:16384
ds_read_b64_tr_b16 v[194:195], v12 offset:18432
Mvva 128,240,152
Mvva 144,224,148
s_waitcnt lgkmcnt(10)
ds_read_b64_tr_b16 v[208:209], v12 offset:20480
ds_read_b64_tr_b16 v[210:211], v12 offset:22528
Mvva 144,240,156
Mvva 132,228,144
ds_read_b64_tr_b16 v[196:197], v13 offset:16384
ds_read_b64_tr_b16 v[198:199], v13 offset:18432
Mvva 132,244,152
buffer_load_dword v17, v126, s[20:23], s24 offen sc1
Mvva 148,228,148
s_waitcnt lgkmcnt(10)
ds_read_b64_tr_b16 v[212:213], v13 offset:20480
ds_read_b64_tr_b16 v[214:215], v13 offset:22528
Mvva 148,244,156
Mvva 136,232,144
ds_read_b64_tr_b16 v[200:201], v14 offset:16384
ds_read_b64_tr_b16 v[202:203], v14 offset:18432
Mvva 136,248,152
Mvva 152,232,148
s_waitcnt lgkmcnt(10)
ds_read_b64_tr_b16 v[216:217], v14 offset:20480
ds_read_b64_tr_b16 v[218:219], v14 offset:22528
Mvva 152,248,156
Mvva 140,236,144
ds_read_b64_tr_b16 v[204:205], v15 offset:16384
ds_read_b64_tr_b16 v[206:207], v15 offset:18432
Mvva 140,252,152
Mvva 156,236,148
s_waitcnt lgkmcnt(10)
ds_read_b64_tr_b16 v[220:221], v15 offset:20480
ds_read_b64_tr_b16 v[222:223], v15 offset:22528
Mvva 156,252,156
Mvva 128,192,160
ds_read_b64_tr_b16 v[224:225], v12 offset:24576
ds_read_b64_tr_b16 v[226:227], v12 offset:26624
Mvva 128,208,168
Mvva 144,192,164
s_waitcnt lgkmcnt(10)
ds_read_b64_tr_b16 v[240:241], v12 offset:28672
ds_read_b64_tr_b16 v[242:243], v12 offset:30720
Mvva 144,208,172
Mvva 132,196,160
ds_read_b64_tr_b16 v[228:229], v13 offset:24576
ds_read_b64_tr_b16 v[230:231], v13 offset:26624
Mvva 132,212,168
Mvva 148,196,164
s_waitcnt lgkmcnt(10)
ds_read_b64_tr_b16 v[244:245], v13 offset:28672
ds_read_b64_tr_b16 v[246:247], v13 offset:30720
Mvva 148,212,172
Mvva 136,200,160
ds_read_b64_tr_b16 v[232:233], v14 offset:24576
ds_read_b64_tr_b16 v[234:235], v14 offset:26624
Mvva 136,216,168
Mvva 152,200,164
s_waitcnt lgkmcnt(10)
ds_read_b64_tr_b16 v[248:249], v14 offset:28672
ds_read_b64_tr_b16 v[250:251], v14 offset:30720
Mvva 152,216,172
Mvva 140,204,160
s_waitcnt vmcnt(6)
ds_read_b64_tr_b16 v[236:237], v15 offset:24576
ds_read_b64_tr_b16 v[238:239], v15 offset:26624
Mvva 140,220,168
s_waitcnt lgkmcnt(10)
Mvva 156,204,164
s_barrier
ds_read_b64_tr_b16 v[252:253], v15 offset:28672
ds_read_b64_tr_b16 v[254:255], v15 offset:30720
Mvva 156,220,172
Mvva 128,224,176
ds_read_b64_tr_b16 v[192:193], v12 offset:32768
ds_read_b64_tr_b16 v[194:195], v12 offset:34816
Mvva 128,240,184
Mvva 144,224,180
s_waitcnt lgkmcnt(10)
ds_read_b64_tr_b16 v[208:209], v12 offset:36864
ds_read_b64_tr_b16 v[210:211], v12 offset:38912
Mvva 144,240,188
Mvva 132,228,176
ds_read_b64_tr_b16 v[196:197], v13 offset:32768
ds_read_b64_tr_b16 v[198:199], v13 offset:34816
Mvva 132,244,184
Mvva 148,228,180
s_waitcnt lgkmcnt(10)
ds_read_b64_tr_b16 v[212:213], v13 offset:36864
ds_read_b64_tr_b16 v[214:215], v13 offset:38912
Mvva 148,244,188
Mvva 136,232,176
ds_read_b64_tr_b16 v[200:201], v14 offset:32768
ds_read_b64_tr_b16 v[202:203], v14 offset:34816
Mvva 136,248,184
Mvva 152,232,180
s_waitcnt lgkmcnt(10)
ds_read_b64_tr_b16 v[216:217], v14 offset:36864
ds_read_b64_tr_b16 v[218:219], v14 offset:38912
Mvva 152,248,188
s_waitcnt vmcnt(0)
v_cmp_ne_u32 vcc, 1, v17
s_mov_b32 s33, 0
s_cbranch_vccnz L_xno
buffer_load_dwordx4 v[160:163], v112, s[16:19], s25 offen offset:0 sc1
buffer_load_dwordx4 v[164:167], v112, s[16:19], s25 offen offset:1024 sc1
buffer_load_dwordx4 v[168:171], v112, s[16:19], s25 offen offset:2048 sc1
buffer_load_dwordx4 v[172:175], v112, s[16:19], s25 offen offset:3072 sc1
buffer_load_dwordx4 v[176:179], v10, s[16:19], s25 offen offset:0 sc1
buffer_load_dwordx4 v[180:183], v10, s[16:19], s25 offen offset:1024 sc1
buffer_load_dwordx4 v[184:187], v10, s[16:19], s25 offen offset:2048 sc1
buffer_load_dwordx4 v[188:191], v10, s[16:19], s25 offen offset:3072 sc1
s_mov_b32 s33, 1
L_xno:
Mvva 140,236,176
ds_read_b64_tr_b16 v[204:205], v15 offset:32768
ds_read_b64_tr_b16 v[206:207], v15 offset:34816
Mvva 140,252,184
Mvva 156,236,180
s_waitcnt lgkmcnt(10)
ds_read_b64_tr_b16 v[220:221], v15 offset:36864
ds_read_b64_tr_b16 v[222:223], v15 offset:38912
Mvva 156,252,188
Mvva 128,192,192
ds_read_b64_tr_b16 v[224:225], v12 offset:40960
ds_read_b64_tr_b16 v[226:227], v12 offset:43008
Mvva 128,208,200
Mvva 144,192,196
s_waitcnt lgkmcnt(10)
ds_read_b64_tr_b16 v[240:241], v12 offset:45056
ds_read_b64_tr_b16 v[242:243], v12 offset:47104
Mvva 144,208,204
Mvva 132,196,192
ds_read_b64_tr_b16 v[228:229], v13 offset:40960
ds_read_b64_tr_b16 v[230:231], v13 offset:43008
Mvva 132,212,200
Mvva 148,196,196
s_waitcnt lgkmcnt(10)
ds_read_b64_tr_b16 v[244:245], v13 offset:45056
ds_read_b64_tr_b16 v[246:247], v13 offset:47104
Mvva 148,212,204
Mvva 136,200,192
ds_read_b64_tr_b16 v[232:233], v14 offset:40960
ds_read_b64_tr_b16 v[234:235], v14 offset:43008
Mvva 136,216,200
Mvva 152,200,196
s_waitcnt lgkmcnt(10)
ds_read_b64_tr_b16 v[248:249], v14 offset:45056
ds_read_b64_tr_b16 v[250:251], v14 offset:47104
Mvva 152,216,204
Mvva 140,204,192
ds_read_b64_tr_b16 v[236:237], v15 offset:40960
ds_read_b64_tr_b16 v[238:239], v15 offset:43008
Mvva 140,220,200
s_waitcnt lgkmcnt(10)
Mvva 156,204,196
s_barrier
ds_read_b64_tr_b16 v[252:253], v15 offset:45056
ds_read_b64_tr_b16 v[254:255], v15 offset:47104
Mvva 156,220,204
Mvva 128,224,208
ds_read_b64_tr_b16 v[192:193], v12 offset:49152
ds_read_b64_tr_b16 v[194:195], v12 offset:51200
Mvva 128,240,216
Mvva 144,224,212
s_waitcnt lgkmcnt(10)
ds_read_b64_tr_b16 v[208:209], v12 offset:53248
ds_read_b64_tr_b16 v[210:211], v12 offset:55296
Mvva 144,240,220
Mvva 132,228,208
ds_read_b64_tr_b16 v[196:197], v13 offset:49152
ds_read_b64_tr_b16 v[198:199], v13 offset:51200
Mvva 132,244,216
Mvva 148,228,212
s_waitcnt lgkmcnt(10)
ds_read_b64_tr_b16 v[212:213], v13 offset:53248
ds_read_b64_tr_b16 v[214:215], v13 offset:55296
Mvva 148,244,220
Mvva 136,232,208
ds_read_b64_tr_b16 v[200:201], v14 offset:49152
ds_read_b64_tr_b16 v[202:203], v14 offset:51200
Mvva 136,248,216
Mvva 152,232,212
s_waitcnt lgkmcnt(10)
ds_read_b64_tr_b16 v[216:217], v14 offset:53248
ds_read_b64_tr_b16 v[218:219], v14 offset:55296
Mvva 152,248,220
Mvva 140,236,208
ds_read_b64_tr_b16 v[204:205], v15 offset:49152
ds_read_b64_tr_b16 v[206:207], v15 offset:51200
Mvva 140,252,216
Mvva 156,236,212
s_waitcnt lgkmcnt(10)
ds_read_b64_tr_b16 v[220:221], v15 offset:53248
ds_read_b64_tr_b16 v[222:223], v15 offset:55296
Mvva 156,252,220
Mvva 128,192,224
ds_read_b64_tr_b16 v[224:225], v12 offset:57344
ds_read_b64_tr_b16 v[226:227], v12 offset:59392
Mvva 128,208,232
Mvva 144,192,228
s_waitcnt lgkmcnt(10)
ds_read_b64_tr_b16 v[240:241], v12 offset:61440
ds_read_b64_tr_b16 v[242:243], v12 offset:63488
Mvva 144,208,236
Mvva 132,196,224
ds_read_b64_tr_b16 v[228:229], v13 offset:57344
ds_read_b64_tr_b16 v[230:231], v13 offset:59392
Mvva 132,212,232
Mvva 148,196,228
s_waitcnt lgkmcnt(10)
ds_read_b64_tr_b16 v[244:245], v13 offset:61440
ds_read_b64_tr_b16 v[246:247], v13 offset:63488
Mvva 148,212,236
Mvva 136,200,224
ds_read_b64_tr_b16 v[232:233], v14 offset:57344
ds_read_b64_tr_b16 v[234:235], v14 offset:59392
Mvva 136,216,232
Mvva 152,200,228
s_waitcnt lgkmcnt(10)
ds_read_b64_tr_b16 v[248:249], v14 offset:61440
ds_read_b64_tr_b16 v[250:251], v14 offset:63488
Mvva 152,216,236
Mvva 140,204,224
ds_read_b64_tr_b16 v[236:237], v15 offset:57344
ds_read_b64_tr_b16 v[238:239], v15 offset:59392
Mvva 140,220,232
s_waitcnt lgkmcnt(10)
Mvva 156,204,228
ds_read_b64_tr_b16 v[252:253], v15 offset:61440
ds_read_b64_tr_b16 v[254:255], v15 offset:63488
Mvva 156,220,236
Mvva 128,224,240
Mvva 128,240,248
Mvva 144,224,244
s_waitcnt lgkmcnt(8)
Mvva 144,240,252
Mvva 132,228,240
Mvva 132,244,248
Mvva 148,228,244
s_waitcnt lgkmcnt(4)
Mvva 148,244,252
Mvva 136,232,240
Mvva 136,248,248
Mvva 152,232,244
s_waitcnt lgkmcnt(0)
Mvva 152,248,252
Mvva 140,236,240
Mvva 140,252,248
Mvva 156,236,244
Mvva 156,252,252
s_cmp_lg_u32 s53, s40
s_cbranch_scc1 L_ysl
L_yslr:
v_and_b32 v124, 15, v0
v_lshlrev_b32 v74, 8, v124
v_add_u32 v74, s35, v74
v_xor_b32 v124, v124, v121
v_lshl_add_u32 v74, v124, 4, v74
v_xor_b32_e64 v75, 64, v74
v_xor_b32 v76, 128, v74
v_xor_b32 v77, 192, v74
v_lshlrev_b32 v125, 1, v122
v_xor_b32 v124, v123, v125
v_lshlrev_b32 v12, 8, v123
v_add_u32 v12, s35, v12
v_lshl_add_u32 v12, v124, 4, v12
v_xor_b32_e64 v13, 16, v12
v_xor_b32 v14, 128, v12
v_xor_b32 v15, 144, v12
s_cmp_eq_u32 s33, 0
s_cbranch_scc1 L_spinX
L_spinXr:
v_lshlrev_b32_e64 v80, 16, v18
v_and_b32 v81, 0xffff0000, v18
v_lshlrev_b32_e64 v82, 16, v19
v_and_b32 v83, 0xffff0000, v19
v_lshlrev_b32_e64 v84, 16, v20
v_and_b32 v85, 0xffff0000, v20
v_lshlrev_b32_e64 v86, 16, v21
v_and_b32 v87, 0xffff0000, v21
v_lshlrev_b32_e64 v88, 16, v22
v_and_b32 v89, 0xffff0000, v22
v_lshlrev_b32_e64 v90, 16, v23
v_and_b32 v91, 0xffff0000, v23
v_lshlrev_b32_e64 v92, 16, v24
v_and_b32 v93, 0xffff0000, v24
v_lshlrev_b32_e64 v94, 16, v25
v_and_b32 v95, 0xffff0000, v25
v_lshlrev_b32_e64 v96, 16, v26
v_and_b32 v97, 0xffff0000, v26
v_lshlrev_b32_e64 v98, 16, v27
v_and_b32 v99, 0xffff0000, v27
v_lshlrev_b32_e64 v100, 16, v28
v_and_b32 v101, 0xffff0000, v28
v_lshlrev_b32_e64 v102, 16, v29
v_and_b32 v103, 0xffff0000, v29
v_lshlrev_b32_e64 v104, 16, v30
v_and_b32 v105, 0xffff0000, v30
v_lshlrev_b32_e64 v106, 16, v31
v_and_b32 v107, 0xffff0000, v31
v_lshlrev_b32_e64 v108, 16, v32
v_and_b32 v109, 0xffff0000, v32
v_lshlrev_b32_e64 v110, 16, v33
v_and_b32 v111, 0xffff0000, v33
s_waitcnt vmcnt(0)
s_nop 0
v_pk_add_f32 v[128:129], v[128:129], v[160:161]
v_pk_add_f32 v[130:131], v[130:131], v[162:163]
ds_write_b128 v74, v[128:131] offset:0
v_pk_add_f32 v[132:133], v[132:133], v[164:165]
v_pk_add_f32 v[134:135], v[134:135], v[166:167]
ds_write_b128 v75, v[132:135] offset:0
v_pk_add_f32 v[136:137], v[136:137], v[168:169]
v_pk_add_f32 v[138:139], v[138:139], v[170:171]
ds_write_b128 v76, v[136:139] offset:0
v_pk_add_f32 v[140:141], v[140:141], v[172:173]
v_pk_add_f32 v[142:143], v[142:143], v[174:175]
ds_write_b128 v77, v[140:143] offset:0
v_pk_add_f32 v[144:145], v[144:145], v[176:177]
v_pk_add_f32 v[146:147], v[146:147], v[178:179]
ds_write_b128 v74, v[144:147] offset:4096
v_pk_add_f32 v[148:149], v[148:149], v[180:181]
v_pk_add_f32 v[150:151], v[150:151], v[182:183]
ds_write_b128 v75, v[148:151] offset:4096
v_pk_add_f32 v[152:153], v[152:153], v[184:185]
v_pk_add_f32 v[154:155], v[154:155], v[186:187]
ds_write_b128 v76, v[152:155] offset:4096
v_pk_add_f32 v[156:157], v[156:157], v[188:189]
v_pk_add_f32 v[158:159], v[158:159], v[190:191]
ds_write_b128 v77, v[156:159] offset:4096
Rv 192,12,0
Rv 196,13,0
Rv 200,14,2048
Rv 204,15,2048
Rv 208,12,4096
Rv 212,13,4096
Rv 216,14,6144
s_waitcnt lgkmcnt(9)
Rv 220,15,6144
s_waitcnt lgkmcnt(6)
Vc 224,192,193
v_lshlrev_b32_e64 v192, 16, v224
v_and_b32 v193, 0xffff0000, v224
Vc 225,194,195
v_lshlrev_b32_e64 v194, 16, v225
v_and_b32 v195, 0xffff0000, v225
Vc 226,196,197
v_lshlrev_b32_e64 v196, 16, v226
v_and_b32 v197, 0xffff0000, v226
Vc 227,198,199
v_lshlrev_b32_e64 v198, 16, v227
v_and_b32 v199, 0xffff0000, v227
v_pk_mul_f32 v[192:193], v[192:193], v[42:43]
v_pk_mul_f32 v[194:195], v[194:195], v[44:45]
v_pk_mul_f32 v[196:197], v[196:197], v[46:47]
v_pk_mul_f32 v[198:199], v[198:199], v[48:49]
Vc 224,192,193
v_lshlrev_b32_e64 v192, 16, v224
v_and_b32 v193, 0xffff0000, v224
Vc 225,194,195
v_lshlrev_b32_e64 v194, 16, v225
v_and_b32 v195, 0xffff0000, v225
Vc 226,196,197
v_lshlrev_b32_e64 v196, 16, v226
v_and_b32 v197, 0xffff0000, v226
Vc 227,198,199
v_lshlrev_b32_e64 v198, 16, v227
v_and_b32 v199, 0xffff0000, v227
v_pk_add_f32 v[192:193], v[192:193], v[80:81]
v_pk_add_f32 v[194:195], v[194:195], v[82:83]
v_pk_add_f32 v[196:197], v[196:197], v[84:85]
v_pk_add_f32 v[198:199], v[198:199], v[86:87]
Vc 224,192,193
Vc 225,194,195
Vc 226,196,197
Vc 227,198,199
buffer_store_dwordx4 v[224:227], v119, s[68:71], s36 offen sc1
s_add_u32 s36, s36, 16384
s_waitcnt lgkmcnt(4)
Vc 228,200,201
v_lshlrev_b32 v200, 16, v228
v_and_b32 v201, 0xffff0000, v228
Vc 229,202,203
v_lshlrev_b32_e64 v202, 16, v229
v_and_b32 v203, 0xffff0000, v229
Vc 230,204,205
v_lshlrev_b32_e64 v204, 16, v230
v_and_b32 v205, 0xffff0000, v230
Vc 231,206,207
v_lshlrev_b32_e64 v206, 16, v231
v_and_b32 v207, 0xffff0000, v231
v_pk_mul_f32 v[200:201], v[200:201], v[50:51]
v_pk_mul_f32 v[202:203], v[202:203], v[52:53]
v_pk_mul_f32 v[204:205], v[204:205], v[54:55]
v_pk_mul_f32 v[206:207], v[206:207], v[56:57]
Vc 228,200,201
v_lshlrev_b32_e64 v200, 16, v228
v_and_b32 v201, 0xffff0000, v228
Vc 229,202,203
v_lshlrev_b32_e64 v202, 16, v229
v_and_b32 v203, 0xffff0000, v229
Vc 230,204,205
v_lshlrev_b32_e64 v204, 16, v230
v_and_b32 v205, 0xffff0000, v230
Vc 231,206,207
v_lshlrev_b32_e64 v206, 16, v231
v_and_b32 v207, 0xffff0000, v231
v_pk_add_f32 v[200:201], v[200:201], v[88:89]
v_pk_add_f32 v[202:203], v[202:203], v[90:91]
v_pk_add_f32 v[204:205], v[204:205], v[92:93]
v_pk_add_f32 v[206:207], v[206:207], v[94:95]
Vc 228,200,201
Vc 229,202,203
Vc 230,204,205
Vc 231,206,207
buffer_store_dwordx4 v[228:231], v119, s[68:71], s36 offen sc1
s_add_u32 s36, s36, 16384
s_waitcnt lgkmcnt(2)
Vc 232,208,209
v_lshlrev_b32 v208, 16, v232
v_and_b32 v209, 0xffff0000, v232
Vc 233,210,211
v_lshlrev_b32_e64 v210, 16, v233
v_and_b32 v211, 0xffff0000, v233
Vc 234,212,213
v_lshlrev_b32_e64 v212, 16, v234
v_and_b32 v213, 0xffff0000, v234
Vc 235,214,215
v_lshlrev_b32_e64 v214, 16, v235
v_and_b32 v215, 0xffff0000, v235
v_pk_mul_f32 v[208:209], v[208:209], v[58:59]
v_pk_mul_f32 v[210:211], v[210:211], v[60:61]
v_pk_mul_f32 v[212:213], v[212:213], v[62:63]
v_pk_mul_f32 v[214:215], v[214:215], v[64:65]
Vc 232,208,209
v_lshlrev_b32_e64 v208, 16, v232
v_and_b32 v209, 0xffff0000, v232
Vc 233,210,211
v_lshlrev_b32_e64 v210, 16, v233
v_and_b32 v211, 0xffff0000, v233
Vc 234,212,213
v_lshlrev_b32_e64 v212, 16, v234
v_and_b32 v213, 0xffff0000, v234
Vc 235,214,215
v_lshlrev_b32_e64 v214, 16, v235
v_and_b32 v215, 0xffff0000, v235
v_pk_add_f32 v[208:209], v[208:209], v[96:97]
v_pk_add_f32 v[210:211], v[210:211], v[98:99]
v_pk_add_f32 v[212:213], v[212:213], v[100:101]
v_pk_add_f32 v[214:215], v[214:215], v[102:103]
Vc 232,208,209
Vc 233,210,211
Vc 234,212,213
Vc 235,214,215
buffer_store_dwordx4 v[232:235], v119, s[68:71], s36 offen sc1
s_add_u32 s36, s36, 16384
s_waitcnt lgkmcnt(0)
Vc 236,216,217
v_lshlrev_b32 v216, 16, v236
v_and_b32 v217, 0xffff0000, v236
Vc 237,218,219
v_lshlrev_b32_e64 v218, 16, v237
v_and_b32 v219, 0xffff0000, v237
Vc 238,220,221
v_lshlrev_b32_e64 v220, 16, v238
v_and_b32 v221, 0xffff0000, v238
Vc 239,222,223
v_lshlrev_b32_e64 v222, 16, v239
v_and_b32 v223, 0xffff0000, v239
v_pk_mul_f32 v[216:217], v[216:217], v[66:67]
v_pk_mul_f32 v[218:219], v[218:219], v[68:69]
v_pk_mul_f32 v[220:221], v[220:221], v[70:71]
v_pk_mul_f32 v[222:223], v[222:223], v[72:73]
Vc 236,216,217
v_lshlrev_b32_e64 v216, 16, v236
v_and_b32 v217, 0xffff0000, v236
Vc 237,218,219
v_lshlrev_b32_e64 v218, 16, v237
v_and_b32 v219, 0xffff0000, v237
Vc 238,220,221
v_lshlrev_b32_e64 v220, 16, v238
v_and_b32 v221, 0xffff0000, v238
Vc 239,222,223
v_lshlrev_b32_e64 v222, 16, v239
v_and_b32 v223, 0xffff0000, v239
v_pk_add_f32 v[216:217], v[216:217], v[104:105]
v_pk_add_f32 v[218:219], v[218:219], v[106:107]
v_pk_add_f32 v[220:221], v[220:221], v[108:109]
v_pk_add_f32 v[222:223], v[222:223], v[110:111]
Vc 236,216,217
Vc 237,218,219
Vc 238,220,221
Vc 239,222,223
buffer_store_dwordx4 v[236:239], v119, s[68:71], s36 offen sc1
L_k2_end:
s_endpgm
L_spinC:
s_add_u32 m0, s35, 0
s_nop 0
s_nop 0
buffer_load_dwordx4 v125, s[60:63], s48 offen offset:0 lds
buffer_load_dwordx4 v125, s[60:63], s49 offen offset:1024 lds
buffer_load_dwordx4 v125, s[60:63], s50 offen offset:2048 lds
buffer_load_dwordx4 v125, s[60:63], s51 offen offset:3072 lds
v_add_u32 v125, 65536, v125
s_add_u32 m0, s35, 4096
s_nop 0
buffer_load_dwordx4 v125, s[60:63], s48 offen offset:0 lds
buffer_load_dwordx4 v125, s[60:63], s49 offen offset:1024 lds
buffer_load_dwordx4 v125, s[60:63], s50 offen offset:2048 lds
buffer_load_dwordx4 v125, s[60:63], s51 offen offset:3072 lds
s_mov_b32 s40, 1
s_mov_b32 s47, 0x400000
L_spinC_l:
buffer_load_dword v124, v10, s[20:23], s38 offen sc1
s_sub_u32 s47, s47, 1
s_waitcnt vmcnt(0)
s_cmp_eq_u32 s47, 0
s_cbranch_scc1 L_spinC_lx
v_cmp_ne_u32 vcc, 1, v124
s_cbranch_vccz L_spinC_lx
s_sleep 4
s_branch L_spinC_l
L_spinC_lx:
s_branch L_spinCr
L_c31:
s_bfe_u32 s3, s2, 0x40003
s_lshl_b32 s3, s3, 2
s_add_u32 s3, s3, s32
s_lshl_b32 s3, s3, 15
s_and_b32 s7, s2, 1
s_lshl_b32 s7, s7, 22
s_add_u32 s3, s3, s7
s_add_u32 s3, s3, 2097536
v_and_b32 v1, 15, v0
v_lshlrev_b32 v1, 11, v1
v_lshrrev_b32 v11, 5, v0
v_lshl_add_u32 v1, v11, 10, v1
buffer_load_dword v11, v1, s[28:31], s3 offen
s_branch L_c31r
L_f2A:
s_lshr_b32 s5, s54, 1
s_lshl_b32 s5, s5, 5
s_add_u32 s5, s5, 5447680
buffer_load_dword v125, v127, s[20:23], s5 offen sc1
s_branch L_f2Ar
L_f2B:
s_waitcnt vmcnt(16)
v_cmp_ne_u32 vcc, 1, v125
s_cbranch_vccz L_f2lx
s_mov_b32 s47, 0x400000
L_f2l:
buffer_load_dword v125, v127, s[20:23], s5 offen sc1
s_sub_u32 s47, s47, 1
s_waitcnt vmcnt(0)
s_cmp_eq_u32 s47, 0
s_cbranch_scc1 L_f2lx
v_cmp_ne_u32 vcc, 1, v125
s_cbranch_vccz L_f2lx
s_sleep 8
s_branch L_f2l
L_f2lx:
s_lshl_b32 s3, s54, 8
s_add_u32 s3, s3, 6291456
v_mul_u32_u24 v124, 14336, v121
v_and_b32_e64 v125, 15, v0
v_lshl_add_u32 v124, v125, 4, v124
buffer_load_dwordx4 v[74:77], v124, s[20:23], s3 offen sc1
s_add_u32 s3, s3, 57344
buffer_load_dwordx4 v[78:81], v124, s[20:23], s3 offen sc1
s_add_u32 s3, s3, 57344
buffer_load_dwordx4 v[82:85], v124, s[20:23], s3 offen sc1
s_add_u32 s3, s3, 57344
buffer_load_dwordx4 v[86:89], v124, s[20:23], s3 offen sc1
s_add_u32 s3, s3, 57344
buffer_load_dwordx4 v[90:93], v124, s[20:23], s3 offen sc1
s_add_u32 s3, s3, 57344
buffer_load_dwordx4 v[94:97], v124, s[20:23], s3 offen sc1
s_add_u32 s3, s3, 57344
buffer_load_dwordx4 v[98:101], v124, s[20:23], s3 offen sc1
s_add_u32 s3, s3, 57344
buffer_load_dwordx4 v[102:105], v124, s[20:23], s3 offen sc1
s_branch L_f2Br
L_f2C:
v_add_u32 v106, s35, v115
v_add_u32 v107, s35, v116
v_add_u32 v108, s35, v117
v_add_u32 v109, s35, v118
s_waitcnt vmcnt(16) lgkmcnt(0)
v_pk_add_f32 v[74:75], v[74:75], v[78:79]
v_pk_add_f32 v[76:77], v[76:77], v[80:81]
v_pk_add_f32 v[74:75], v[74:75], v[82:83]
v_pk_add_f32 v[76:77], v[76:77], v[84:85]
v_pk_add_f32 v[74:75], v[74:75], v[86:87]
v_pk_add_f32 v[76:77], v[76:77], v[88:89]
v_pk_add_f32 v[74:75], v[74:75], v[90:91]
v_pk_add_f32 v[76:77], v[76:77], v[92:93]
v_pk_add_f32 v[74:75], v[74:75], v[94:95]
v_pk_add_f32 v[76:77], v[76:77], v[96:97]
v_pk_add_f32 v[74:75], v[74:75], v[98:99]
v_pk_add_f32 v[76:77], v[76:77], v[100:101]
v_pk_add_f32 v[74:75], v[74:75], v[102:103]
v_pk_add_f32 v[76:77], v[76:77], v[104:105]
Vc 125,74,75
v_lshlrev_b32_e64 v74, 16, v125
v_and_b32 v75, 0xffff0000, v125
Vc 125,76,77
v_lshlrev_b32_e64 v76, 16, v125
v_and_b32 v77, 0xffff0000, v125
v_mov_b32 v82, v74
v_mov_b32 v83, v75
v_mov_b32 v84, v76
v_mov_b32 v85, v77
v_permlane32_swap_b32 v82, v74
v_permlane32_swap_b32 v83, v75
v_permlane32_swap_b32 v84, v76
v_permlane32_swap_b32 v85, v77
v_mul_f32 v90, 0xbfb8aa3b, v82
v_mul_f32 v91, 0xbfb8aa3b, v83
v_mul_f32 v92, 0xbfb8aa3b, v84
v_mul_f32 v93, 0xbfb8aa3b, v85
Ve 90,90
Ve 91,91
Ve 92,92
Ve 93,93
v_add_f32 v90, 1.0, v90
v_add_f32 v91, 1.0, v91
v_add_f32 v92, 1.0, v92
v_add_f32 v93, 1.0, v93
v_rcp_f32 v90, v90
v_rcp_f32 v91, v91
v_rcp_f32 v92, v92
v_rcp_f32 v93, v93
Vm 82,82,90
Vm 83,83,91
Vm 84,84,92
Vm 85,85,93
Vc 125,82,83
v_lshlrev_b32_e64 v82, 16, v125
v_and_b32 v83, 0xffff0000, v125
Vc 125,84,85
v_lshlrev_b32_e64 v84, 16, v125
v_and_b32 v85, 0xffff0000, v125
Vm 74,74,82
Vm 75,75,83
Vm 76,76,84
Vm 77,77,85
Vc 90,74,75
Vc 91,76,77
v_and_b32 v124, 1, v121
v_lshlrev_b32 v124, 8, v124
v_and_b32_e64 v125, 15, v0
v_lshl_add_u32 v124, v125, 3, v124
v_add_u32_e64 v124, s35, v124
ds_read_b64_tr_b16 v[74:75], v106 offset:0
ds_read_b64_tr_b16 v[76:77], v106 offset:2048
ds_read_b64_tr_b16 v[78:79], v107 offset:0
ds_read_b64_tr_b16 v[80:81], v107 offset:2048
ds_read_b64_tr_b16 v[82:83], v108 offset:0
ds_read_b64_tr_b16 v[84:85], v108 offset:2048
ds_read_b64_tr_b16 v[86:87], v109 offset:0
ds_read_b64_tr_b16 v[88:89], v109 offset:2048
ds_write_b64 v124, v[90:91]
v_and_b32 v124, 1, v0
v_lshlrev_b32 v124, 8, v124
v_lshl_add_u32 v125, v121, 3, v124
v_add_u32_e64 v125, s35, v125
ds_read_b64 v[90:91], v125 offset:0
ds_read_b64 v[92:93], v125 offset:32
ds_read_b64 v[94:95], v125 offset:64
ds_read_b64 v[96:97], v125 offset:96
v_lshl_add_u32 v124, v121, 4, v124
v_add_u32 v124, s35, v124
s_waitcnt lgkmcnt(0)
Zvvv 98,74,90
ds_read_b64_tr_b16 v[74:75], v106 offset:4096
ds_read_b64_tr_b16 v[76:77], v106 offset:6144
Zvvv 102,78,90
ds_read_b64_tr_b16 v[78:79], v107 offset:4096
ds_read_b64_tr_b16 v[80:81], v107 offset:6144
s_waitcnt lgkmcnt(0)
Mvvv 98,74,94
Mvvv 102,78,94
s_nop 6
ds_write_b128 v124, v[98:101] offset:2048
ds_write_b128 v124, v[102:105] offset:2112
s_waitcnt lgkmcnt(0)
Zvvv 98,82,90
ds_read_b64_tr_b16 v[82:83], v108 offset:4096
ds_read_b64_tr_b16 v[84:85], v108 offset:6144
Zvvv 102,86,90
ds_read_b64_tr_b16 v[86:87], v109 offset:4096
ds_read_b64_tr_b16 v[88:89], v109 offset:6144
s_waitcnt lgkmcnt(0)
Mvvv 98,82,94
Mvvv 102,86,94
s_nop 6
ds_write_b128 v124, v[98:101] offset:2176
ds_write_b128 v124, v[102:105] offset:2240
s_waitcnt lgkmcnt(0)
s_barrier
s_cmp_lg_u32 s32, 0
s_cbranch_scc1 L_f2Cr
v_lshlrev_b32 v124, 3, v0
v_add_u32 v125, 133120, v124
ds_read_b64 v[74:75], v125 offset:0
ds_read_b64 v[76:77], v125 offset:8192
ds_read_b64 v[78:79], v125 offset:16384
ds_read_b64 v[80:81], v125 offset:24576
s_lshl_b32 s3, s39, 4
s_add_u32 s3, s3, s37
s_lshl_b32 s3, s3, 9
s_add_u32 s3, s3, 5308416
s_waitcnt lgkmcnt(0)
v_pk_add_f32 v[74:75], v[74:75], v[76:77]
v_pk_add_f32 v[78:79], v[78:79], v[80:81]
v_pk_add_f32 v[74:75], v[74:75], v[78:79]
buffer_store_dwordx2 v[74:75], v124, s[20:23], s3 offen sc1
s_branch L_f2Cr
L_f2E:
s_cmp_lg_u32 s32, 0
s_cbranch_scc1 L_f2Er
v_mov_b32 v125, 1
s_lshl_b32 s3, s39, 5
s_add_u32 s3, s3, s37
s_lshl_b32 s3, s3, 2
s_add_u32 s3, s3, 5449728
s_waitcnt vmcnt(16)
s_mov_b64 exec, 1
buffer_store_dword v125, v126, s[20:23], s3 offen sc1
s_mov_b64 exec, -1
s_branch L_f2Er
L_yA:
v_min_u32 v127, 13, v0
v_lshlrev_b32_e64 v127, 2, v127
buffer_load_dword v74, v127, s[20:23], s41 offen sc1
s_branch L_yAr
L_yB:
s_waitcnt vmcnt(6)
v_cmp_ne_u32 vcc, 1, v74
s_cbranch_vccnz L_yBr
s_mov_b32 s40, 1
v_lshlrev_b32 v124, 2, v0
v_lshlrev_b32 v125, 1, v0
s_lshl_b32 s7, s45, 2
s_add_u32 s7, s7, s32
s_lshr_b32 s3, s42, 5
s_cmp_lg_u32 s3, s7
s_cbranch_scc1 L_f_yl1
s_add_u32 s3, s55, 0
s_nop 0
s_add_u32 s7, s3, 4096
buffer_load_dword v76, v124, s[20:23], s3 offen offset:0 sc1
buffer_load_dword v77, v124, s[20:23], s3 offen offset:512 sc1
buffer_load_dword v78, v124, s[20:23], s3 offen offset:1024 sc1
buffer_load_dword v79, v124, s[20:23], s3 offen offset:1536 sc1
buffer_load_dword v80, v124, s[20:23], s3 offen offset:2048 sc1
buffer_load_dword v81, v124, s[20:23], s3 offen offset:2560 sc1
buffer_load_dword v82, v124, s[20:23], s3 offen offset:3072 sc1
buffer_load_dword v83, v124, s[20:23], s3 offen offset:3584 sc1
buffer_load_dword v84, v124, s[20:23], s7 offen offset:0 sc1
buffer_load_dword v85, v124, s[20:23], s7 offen offset:512 sc1
buffer_load_dword v86, v124, s[20:23], s7 offen offset:1024 sc1
buffer_load_dword v87, v124, s[20:23], s7 offen offset:1536 sc1
buffer_load_dword v88, v124, s[20:23], s7 offen offset:2048 sc1
buffer_load_dword v89, v124, s[20:23], s7 offen offset:2560 sc1
s_lshl_b32 s3, s42, 11
s_lshl_b32 s7, s46, 7
s_add_u32 s3, s3, s7
buffer_load_ushort v90, v125, s[56:59], s3 offen
s_lshl_b32 s3, s42, 3
s_add_u32 s3, s3, 5259264
buffer_load_dwordx2 v[92:93], v126, s[20:23], s3 offen sc1
L_f_yl1:
s_lshl_b32 s7, s45, 2
s_add_u32 s7, s7, s32
s_lshr_b32 s3, s43, 5
s_cmp_lg_u32 s3, s7
s_cbranch_scc1 L_f_yl2
s_nop 0
s_add_u32 s3, s55, 256
s_add_u32 s7, s3, 4096
buffer_load_dword v94, v124, s[20:23], s3 offen offset:0 sc1
buffer_load_dword v95, v124, s[20:23], s3 offen offset:512 sc1
buffer_load_dword v96, v124, s[20:23], s3 offen offset:1024 sc1
buffer_load_dword v97, v124, s[20:23], s3 offen offset:1536 sc1
buffer_load_dword v98, v124, s[20:23], s3 offen offset:2048 sc1
buffer_load_dword v99, v124, s[20:23], s3 offen offset:2560 sc1
buffer_load_dword v100, v124, s[20:23], s3 offen offset:3072 sc1
buffer_load_dword v101, v124, s[20:23], s3 offen offset:3584 sc1
buffer_load_dword v102, v124, s[20:23], s7 offen offset:0 sc1
buffer_load_dword v103, v124, s[20:23], s7 offen offset:512 sc1
buffer_load_dword v104, v124, s[20:23], s7 offen offset:1024 sc1
buffer_load_dword v105, v124, s[20:23], s7 offen offset:1536 sc1
buffer_load_dword v106, v124, s[20:23], s7 offen offset:2048 sc1
buffer_load_dword v107, v124, s[20:23], s7 offen offset:2560 sc1
s_lshl_b32 s3, s43, 11
s_lshl_b32 s7, s46, 7
s_add_u32 s3, s3, s7
buffer_load_ushort v108, v125, s[56:59], s3 offen
s_lshl_b32 s3, s43, 3
s_add_u32 s3, s3, 5259264
buffer_load_dwordx2 v[110:111], v126, s[20:23], s3 offen sc1
L_f_yl2:
s_branch L_yBr
L_yC:
s_waitcnt vmcnt(4)
s_lshl_b32 s7, s45, 2
s_add_u32 s7, s7, s32
s_lshr_b32 s3, s42, 5
s_cmp_lg_u32 s3, s7
s_cbranch_scc1 L_f_ys3
s_nop 0
v_pk_add_f32 v[76:77], v[76:77], v[78:79]
v_pk_add_f32 v[76:77], v[76:77], v[80:81]
v_pk_add_f32 v[76:77], v[76:77], v[82:83]
v_pk_add_f32 v[76:77], v[76:77], v[84:85]
v_pk_add_f32 v[76:77], v[76:77], v[86:87]
v_pk_add_f32 v[76:77], v[76:77], v[88:89]
Va 76,76,77
v_lshlrev_b32 v90, 16, v90
v_sub_f32_e64 v90, v90, v92
Vc 76,76,76
v_lshlrev_b32_e64 v76, 16, v76
Vc 90,90,90
v_lshlrev_b32 v90, 16, v90
v_mul_f32 v76, s100, v76
v_mul_f32_e64 v90, v90, v93
Vc 76,76,76
v_lshlrev_b32_e64 v76, 16, v76
Vc 90,90,90
v_lshlrev_b32 v90, 16, v90
Va 90,90,76
Vc 90,90,90
v_lshlrev_b32_e64 v90, 16, v90
v_mul_f32 v76, 0xbfb8aa3b, v90
Ve 76,76
s_nop 0
v_add_f32 v76, 1.0, v76
v_rcp_f32 v76, v76
s_nop 0
Vm 90,90,76
Vc 90,90,90
v_lshlrev_b32 v90, 16, v90
v_lshlrev_b32 v124, 2, v0
v_add_u32 v124, s35, v124
v_lshlrev_b32 v125, 5, v122
v_add_u32 v125, s35, v125
s_waitcnt lgkmcnt(0)
ds_write_b32 v124, v90
s_and_b32 s3, s42, 7
s_lshl_b32 s3, s3, 3
s_lshl_b64 s[4:5], 0xff, s3
s_bfe_u32 s3, s42, 0x20003
s_mov_b64 exec, s[4:5]
s_cmp_lg_u32 s3, 0
s_cbranch_scc1 L_f_yp4
ds_read_b64 v[42:43], v125
ds_read_b64 v[44:45], v125 offset:8
ds_read_b64 v[46:47], v125 offset:16
ds_read_b64 v[48:49], v125 offset:24
L_f_yp4:
s_cmp_lg_u32 s3, 1
s_cbranch_scc1 L_f_yp5
ds_read_b64 v[50:51], v125
ds_read_b64 v[52:53], v125 offset:8
ds_read_b64 v[54:55], v125 offset:16
ds_read_b64 v[56:57], v125 offset:24
L_f_yp5:
s_cmp_lg_u32 s3, 2
s_cbranch_scc1 L_f_yp6
ds_read_b64 v[58:59], v125
ds_read_b64 v[60:61], v125 offset:8
ds_read_b64 v[62:63], v125 offset:16
ds_read_b64 v[64:65], v125 offset:24
L_f_yp6:
s_cmp_lg_u32 s3, 3
s_cbranch_scc1 L_f_yp7
ds_read_b64 v[66:67], v125
ds_read_b64 v[68:69], v125 offset:8
s_waitcnt lgkmcnt(9)
ds_read_b64 v[70:71], v125 offset:16
ds_read_b64 v[72:73], v125 offset:24
L_f_yp7:
s_mov_b64 exec, -1
s_waitcnt lgkmcnt(0)
L_f_ys3:
s_lshl_b32 s7, s45, 2
s_add_u32 s7, s7, s32
s_lshr_b32 s3, s43, 5
s_cmp_lg_u32 s3, s7
s_cbranch_scc1 L_f_ys8
s_nop 0
v_pk_add_f32 v[94:95], v[94:95], v[96:97]
v_pk_add_f32 v[94:95], v[94:95], v[98:99]
v_pk_add_f32 v[94:95], v[94:95], v[100:101]
v_pk_add_f32 v[94:95], v[94:95], v[102:103]
v_pk_add_f32 v[94:95], v[94:95], v[104:105]
v_pk_add_f32 v[94:95], v[94:95], v[106:107]
Va 94,94,95
v_lshlrev_b32 v108, 16, v108
v_sub_f32_e64 v108, v108, v110
Vc 94,94,94
v_lshlrev_b32_e64 v94, 16, v94
Vc 108,108,108
v_lshlrev_b32 v108, 16, v108
v_mul_f32 v94, s101, v94
v_mul_f32_e64 v108, v108, v111
Vc 94,94,94
v_lshlrev_b32_e64 v94, 16, v94
Vc 108,108,108
v_lshlrev_b32 v108, 16, v108
Va 108,108,94
Vc 108,108,108
v_lshlrev_b32_e64 v108, 16, v108
v_mul_f32 v94, 0xbfb8aa3b, v108
Ve 94,94
s_nop 0
v_add_f32 v94, 1.0, v94
v_rcp_f32 v94, v94
s_nop 0
Vm 108,108,94
Vc 108,108,108
v_lshlrev_b32 v108, 16, v108
v_lshlrev_b32 v124, 2, v0
v_add_u32 v124, s35, v124
v_lshlrev_b32 v125, 5, v122
v_add_u32 v125, s35, v125
s_waitcnt lgkmcnt(0)
ds_write_b32 v124, v108
s_and_b32 s3, s43, 7
s_lshl_b32 s3, s3, 3
s_lshl_b64 s[4:5], 0xff, s3
s_bfe_u32 s3, s43, 0x20003
s_mov_b64 exec, s[4:5]
s_cmp_lg_u32 s3, 0
s_cbranch_scc1 L_f_yp9
ds_read_b64 v[42:43], v125
ds_read_b64 v[44:45], v125 offset:8
ds_read_b64 v[46:47], v125 offset:16
ds_read_b64 v[48:49], v125 offset:24
L_f_yp9:
s_cmp_lg_u32 s3, 1
s_cbranch_scc1 L_f_yp10
ds_read_b64 v[50:51], v125
ds_read_b64 v[52:53], v125 offset:8
ds_read_b64 v[54:55], v125 offset:16
ds_read_b64 v[56:57], v125 offset:24
L_f_yp10:
s_cmp_lg_u32 s3, 2
s_cbranch_scc1 L_f_yp11
ds_read_b64 v[58:59], v125
ds_read_b64 v[60:61], v125 offset:8
ds_read_b64 v[62:63], v125 offset:16
ds_read_b64 v[64:65], v125 offset:24
L_f_yp11:
s_cmp_lg_u32 s3, 3
s_cbranch_scc1 L_f_yp12
ds_read_b64 v[66:67], v125
ds_read_b64 v[68:69], v125 offset:8
s_waitcnt lgkmcnt(9)
ds_read_b64 v[70:71], v125 offset:16
ds_read_b64 v[72:73], v125 offset:24
L_f_yp12:
s_mov_b64 exec, -1
s_waitcnt lgkmcnt(0)
L_f_ys8:
s_branch L_yCr
L_p4_end:
L_spinAk:
s_mov_b32 s47, 0x400000
L_spinAk_l:
s_sleep 8
buffer_load_dword v1, v7, s[28:31], 0 offen sc1
s_waitcnt vmcnt(0)
v_readfirstlane_b32 s3, v1
s_sub_u32 s47, s47, 1
s_cmp_eq_u32 s47, 0
s_cbranch_scc1 L_spinArk
s_cmp_lt_u32 s3, 256
s_cbranch_scc1 L_spinAk_l
s_branch L_spinArk
L_spinAv:
s_mov_b32 s47, 0x400000
L_spinAv_l:
s_sleep 8
buffer_load_dword v1, v7, s[28:31], 0 offen sc1
s_waitcnt vmcnt(0)
v_readfirstlane_b32 s3, v1
s_sub_u32 s47, s47, 1
s_cmp_eq_u32 s47, 0
s_cbranch_scc1 L_spinArv
s_cmp_lt_u32 s3, 256
s_cbranch_scc1 L_spinAv_l
s_branch L_spinArv
L_spinB:
s_mov_b32 s59, 0x400000
L_spinB_l:
s_sleep 4
buffer_load_dword v12, v1, s[20:23], s6 offen sc1
s_sub_u32 s59, s59, 1
s_cmp_eq_u32 s59, 0
s_cbranch_scc1 L_spinBx
s_waitcnt vmcnt(0)
v_cmp_ne_u32 vcc, 1, v12
s_cbranch_vccnz L_spinB_l
L_spinBx:
s_waitcnt vmcnt(0)
s_branch L_spinBr
L_k2_fb_we:
s_nop 7
s_nop 0
v_max3_f32 v21, v128, v129, v130
v_max3_f32 v21, v21, v131, v132
v_max3_f32 v21, v21, v133, v134
v_max3_f32 v21, v21, v135, v136
v_max3_f32 v21, v21, v137, v138
v_max3_f32 v21, v21, v139, v140
v_max3_f32 v21, v21, v141, v142
v_max_f32 v21, v21, v143
v_mov_b32 v1, v21
s_nop 1
v_permlane16_swap_b32 v1, v21
v_max_f32 v21, v21, v1
v_mov_b32 v1, v21
s_nop 1
v_permlane32_swap_b32 v1, v21
v_max_f32_e64 v21, v21, v1
v_add_f32 v21, 0x41f80000, v21
v_max_f32 v21, 0, v21
Vs 128,128,21
Vs 129,129,21
Vs 130,130,21
Vs 131,131,21
Vs 132,132,21
Vs 133,133,21
Vs 134,134,21
Vs 135,135,21
Vs 136,136,21
Vs 137,137,21
Vs 138,138,21
Vs 139,139,21
Vs 140,140,21
Vs 141,141,21
Vs 142,142,21
Vs 143,143,21
Vs 192,192,21
Vs 193,193,21
Vs 194,194,21
Vs 195,195,21
Vs 196,196,21
Vs 197,197,21
Vs 198,198,21
Vs 199,199,21
Vs 200,200,21
Vs 201,201,21
Vs 202,202,21
Vs 203,203,21
Vs 204,204,21
Vs 205,205,21
Vs 206,206,21
Vs 207,207,21
Vs 32,32,21
Vs 33,33,21
Vs 34,34,21
v_sub_f32_e64 v35, v35, v21
v_exp_f32 v22, -v21
s_nop 0
Vm 48,48,22
Vm 49,49,22
Vm 50,50,22
v_mul_f32_e64 v51, v51, v22
Ar 8,0
Ar 9,1
Ar 10,2
Ar 11,3
Ar 12,4
Ar 13,5
Ar 14,6
Ar 15,7
Vm 8,8,22
Vm 9,9,22
Vm 10,10,22
Vm 11,11,22
Vm 12,12,22
Vm 13,13,22
Vm 14,14,22
Vm 15,15,22
Aw 0,8
Aw 1,9
Aw 2,10
Aw 3,11
Aw 4,12
Aw 5,13
Aw 6,14
Aw 7,15
Ar 8,8
Ar 9,9
Ar 10,10
Ar 11,11
Ar 12,12
Ar 13,13
Ar 14,14
Ar 15,15
Vm 8,8,22
Vm 9,9,22
Vm 10,10,22
Vm 11,11,22
Vm 12,12,22
Vm 13,13,22
Vm 14,14,22
Vm 15,15,22
Aw 8,8
Aw 9,9
Aw 10,10
Aw 11,11
Aw 12,12
Aw 13,13
Aw 14,14
Aw 15,15
Ar 8,16
Ar 9,17
Ar 10,18
Ar 11,19
Ar 12,20
Ar 13,21
Ar 14,22
Ar 15,23
Vm 8,8,22
Vm 9,9,22
Vm 10,10,22
Vm 11,11,22
Vm 12,12,22
Vm 13,13,22
Vm 14,14,22
Vm 15,15,22
Aw 16,8
Aw 17,9
Aw 18,10
Aw 19,11
Aw 20,12
Aw 21,13
Aw 22,14
Aw 23,15
Ar 8,24
Ar 9,25
Ar 10,26
Ar 11,27
Ar 12,28
Ar 13,29
Ar 14,30
Ar 15,31
Vm 8,8,22
Vm 9,9,22
Vm 10,10,22
Vm 11,11,22
Vm 12,12,22
Vm 13,13,22
Vm 14,14,22
Vm 15,15,22
Aw 24,8
Aw 25,9
Aw 26,10
Aw 27,11
Aw 28,12
Aw 29,13
Aw 30,14
Aw 31,15
v_max3_f32 v21, v144, v145, v146
v_max3_f32 v21, v21, v147, v148
v_max3_f32 v21, v21, v149, v150
v_max3_f32 v21, v21, v151, v152
v_max3_f32 v21, v21, v153, v154
v_max3_f32 v21, v21, v155, v156
v_max3_f32 v21, v21, v157, v158
v_max_f32 v21, v21, v159
v_mov_b32 v1, v21
s_nop 1
v_permlane16_swap_b32 v1, v21
v_max_f32 v21, v21, v1
v_mov_b32 v1, v21
s_nop 1
v_permlane32_swap_b32 v1, v21
v_max_f32_e64 v21, v21, v1
v_add_f32 v21, 0x41f80000, v21
v_max_f32 v21, 0, v21
Vs 144,144,21
Vs 145,145,21
Vs 146,146,21
Vs 147,147,21
Vs 148,148,21
Vs 149,149,21
Vs 150,150,21
Vs 151,151,21
Vs 152,152,21
Vs 153,153,21
Vs 154,154,21
Vs 155,155,21
Vs 156,156,21
Vs 157,157,21
Vs 158,158,21
Vs 159,159,21
Vs 208,208,21
Vs 209,209,21
Vs 210,210,21
Vs 211,211,21
Vs 212,212,21
Vs 213,213,21
Vs 214,214,21
Vs 215,215,21
Vs 216,216,21
Vs 217,217,21
Vs 218,218,21
Vs 219,219,21
Vs 220,220,21
Vs 221,221,21
Vs 222,222,21
Vs 223,223,21
Vs 36,36,21
Vs 37,37,21
Vs 38,38,21
v_sub_f32_e64 v39, v39, v21
v_exp_f32 v22, -v21
s_nop 0
Vm 52,52,22
Vm 53,53,22
Vm 54,54,22
v_mul_f32_e64 v55, v55, v22
Ar 8,32
Ar 9,33
Ar 10,34
Ar 11,35
Ar 12,36
Ar 13,37
Ar 14,38
Ar 15,39
Vm 8,8,22
Vm 9,9,22
Vm 10,10,22
Vm 11,11,22
Vm 12,12,22
Vm 13,13,22
Vm 14,14,22
Vm 15,15,22
Aw 32,8
Aw 33,9
Aw 34,10
Aw 35,11
Aw 36,12
Aw 37,13
Aw 38,14
Aw 39,15
Ar 8,40
Ar 9,41
Ar 10,42
Ar 11,43
Ar 12,44
Ar 13,45
Ar 14,46
Ar 15,47
Vm 8,8,22
Vm 9,9,22
Vm 10,10,22
Vm 11,11,22
Vm 12,12,22
Vm 13,13,22
Vm 14,14,22
Vm 15,15,22
Aw 40,8
Aw 41,9
Aw 42,10
Aw 43,11
Aw 44,12
Aw 45,13
Aw 46,14
Aw 47,15
Ar 8,48
Ar 9,49
Ar 10,50
Ar 11,51
Ar 12,52
Ar 13,53
Ar 14,54
Ar 15,55
Vm 8,8,22
Vm 9,9,22
Vm 10,10,22
Vm 11,11,22
Vm 12,12,22
Vm 13,13,22
Vm 14,14,22
Vm 15,15,22
Aw 48,8
Aw 49,9
Aw 50,10
Aw 51,11
Aw 52,12
Aw 53,13
Aw 54,14
Aw 55,15
Ar 8,56
Ar 9,57
Ar 10,58
Ar 11,59
Ar 12,60
Ar 13,61
Ar 14,62
Ar 15,63
Vm 8,8,22
Vm 9,9,22
Vm 10,10,22
Vm 11,11,22
Vm 12,12,22
Vm 13,13,22
Vm 14,14,22
Vm 15,15,22
Aw 56,8
Aw 57,9
Aw 58,10
Aw 59,11
Aw 60,12
Aw 61,13
Aw 62,14
Aw 63,15
v_max3_f32 v21, v160, v161, v162
v_max3_f32 v21, v21, v163, v164
v_max3_f32 v21, v21, v165, v166
v_max3_f32 v21, v21, v167, v168
v_max3_f32 v21, v21, v169, v170
v_max3_f32 v21, v21, v171, v172
v_max3_f32 v21, v21, v173, v174
v_max_f32 v21, v21, v175
v_mov_b32 v1, v21
s_nop 1
v_permlane16_swap_b32 v1, v21
v_max_f32 v21, v21, v1
v_mov_b32 v1, v21
s_nop 1
v_permlane32_swap_b32 v1, v21
v_max_f32_e64 v21, v21, v1
v_add_f32 v21, 0x41f80000, v21
v_max_f32 v21, 0, v21
Vs 160,160,21
Vs 161,161,21
Vs 162,162,21
Vs 163,163,21
Vs 164,164,21
Vs 165,165,21
Vs 166,166,21
Vs 167,167,21
Vs 168,168,21
Vs 169,169,21
Vs 170,170,21
Vs 171,171,21
Vs 172,172,21
Vs 173,173,21
Vs 174,174,21
Vs 175,175,21
Vs 224,224,21
Vs 225,225,21
Vs 226,226,21
Vs 227,227,21
Vs 228,228,21
Vs 229,229,21
Vs 230,230,21
Vs 231,231,21
Vs 232,232,21
Vs 233,233,21
Vs 234,234,21
Vs 235,235,21
Vs 236,236,21
Vs 237,237,21
Vs 238,238,21
Vs 239,239,21
Vs 40,40,21
Vs 41,41,21
Vs 42,42,21
v_sub_f32_e64 v43, v43, v21
v_exp_f32 v22, -v21
s_nop 0
Vm 56,56,22
Vm 57,57,22
Vm 58,58,22
v_mul_f32_e64 v59, v59, v22
Ar 8,64
Ar 9,65
Ar 10,66
Ar 11,67
Ar 12,68
Ar 13,69
Ar 14,70
Ar 15,71
Vm 8,8,22
Vm 9,9,22
Vm 10,10,22
Vm 11,11,22
Vm 12,12,22
Vm 13,13,22
Vm 14,14,22
Vm 15,15,22
Aw 64,8
Aw 65,9
Aw 66,10
Aw 67,11
Aw 68,12
Aw 69,13
Aw 70,14
Aw 71,15
Ar 8,72
Ar 9,73
Ar 10,74
Ar 11,75
Ar 12,76
Ar 13,77
Ar 14,78
Ar 15,79
Vm 8,8,22
Vm 9,9,22
Vm 10,10,22
Vm 11,11,22
Vm 12,12,22
Vm 13,13,22
Vm 14,14,22
Vm 15,15,22
Aw 72,8
Aw 73,9
Aw 74,10
Aw 75,11
Aw 76,12
Aw 77,13
Aw 78,14
Aw 79,15
Ar 8,80
Ar 9,81
Ar 10,82
Ar 11,83
Ar 12,84
Ar 13,85
Ar 14,86
Ar 15,87
Vm 8,8,22
Vm 9,9,22
Vm 10,10,22
Vm 11,11,22
Vm 12,12,22
Vm 13,13,22
Vm 14,14,22
Vm 15,15,22
Aw 80,8
Aw 81,9
Aw 82,10
Aw 83,11
Aw 84,12
Aw 85,13
Aw 86,14
Aw 87,15
Ar 8,88
Ar 9,89
Ar 10,90
Ar 11,91
Ar 12,92
Ar 13,93
Ar 14,94
Ar 15,95
Vm 8,8,22
Vm 9,9,22
Vm 10,10,22
Vm 11,11,22
Vm 12,12,22
Vm 13,13,22
Vm 14,14,22
Vm 15,15,22
Aw 88,8
Aw 89,9
Aw 90,10
Aw 91,11
Aw 92,12
Aw 93,13
Aw 94,14
Aw 95,15
v_max3_f32 v21, v176, v177, v178
v_max3_f32 v21, v21, v179, v180
v_max3_f32 v21, v21, v181, v182
v_max3_f32 v21, v21, v183, v184
v_max3_f32 v21, v21, v185, v186
v_max3_f32 v21, v21, v187, v188
v_max3_f32 v21, v21, v189, v190
v_max_f32 v21, v21, v191
v_mov_b32 v1, v21
s_nop 1
v_permlane16_swap_b32 v1, v21
v_max_f32 v21, v21, v1
v_mov_b32 v1, v21
s_nop 1
v_permlane32_swap_b32 v1, v21
v_max_f32_e64 v21, v21, v1
v_add_f32 v21, 0x41f80000, v21
v_max_f32 v21, 0, v21
Vs 176,176,21
Vs 177,177,21
Vs 178,178,21
Vs 179,179,21
Vs 180,180,21
Vs 181,181,21
Vs 182,182,21
Vs 183,183,21
Vs 184,184,21
Vs 185,185,21
Vs 186,186,21
Vs 187,187,21
Vs 188,188,21
Vs 189,189,21
Vs 190,190,21
Vs 191,191,21
Vs 240,240,21
Vs 241,241,21
Vs 242,242,21
Vs 243,243,21
Vs 244,244,21
Vs 245,245,21
Vs 246,246,21
Vs 247,247,21
Vs 248,248,21
Vs 249,249,21
Vs 250,250,21
Vs 251,251,21
Vs 252,252,21
Vs 253,253,21
Vs 254,254,21
Vs 255,255,21
Vs 44,44,21
Vs 45,45,21
Vs 46,46,21
v_sub_f32_e64 v47, v47, v21
v_exp_f32 v22, -v21
s_nop 0
Vm 60,60,22
Vm 61,61,22
Vm 62,62,22
v_mul_f32_e64 v63, v63, v22
Ar 8,96
Ar 9,97
Ar 10,98
Ar 11,99
Ar 12,100
Ar 13,101
Ar 14,102
Ar 15,103
Vm 8,8,22
Vm 9,9,22
Vm 10,10,22
Vm 11,11,22
Vm 12,12,22
Vm 13,13,22
Vm 14,14,22
Vm 15,15,22
Aw 96,8
Aw 97,9
Aw 98,10
Aw 99,11
Aw 100,12
Aw 101,13
Aw 102,14
Aw 103,15
Ar 8,104
Ar 9,105
Ar 10,106
Ar 11,107
Ar 12,108
Ar 13,109
Ar 14,110
Ar 15,111
Vm 8,8,22
Vm 9,9,22
Vm 10,10,22
Vm 11,11,22
Vm 12,12,22
Vm 13,13,22
Vm 14,14,22
Vm 15,15,22
Aw 104,8
Aw 105,9
Aw 106,10
Aw 107,11
Aw 108,12
Aw 109,13
Aw 110,14
Aw 111,15
Ar 8,112
Ar 9,113
Ar 10,114
Ar 11,115
Ar 12,116
Ar 13,117
Ar 14,118
Ar 15,119
Vm 8,8,22
Vm 9,9,22
Vm 10,10,22
Vm 11,11,22
Vm 12,12,22
Vm 13,13,22
Vm 14,14,22
Vm 15,15,22
Aw 112,8
Aw 113,9
Aw 114,10
Aw 115,11
Aw 116,12
Aw 117,13
Aw 118,14
Aw 119,15
Ar 8,120
Ar 9,121
Ar 10,122
Ar 11,123
Ar 12,124
Ar 13,125
Ar 14,126
Ar 15,127
Vm 8,8,22
Vm 9,9,22
Vm 10,10,22
Vm 11,11,22
Vm 12,12,22
Vm 13,13,22
Vm 14,14,22
Vm 15,15,22
Aw 120,8
Aw 121,9
Aw 122,10
Aw 123,11
Aw 124,12
Aw 125,13
Aw 126,14
Aw 127,15
Ve 8,128
Ve 9,129
s_nop 0
Vc 64,8,9
Ve 8,130
Ve 9,131
s_nop 0
Vc 65,8,9
Ve 8,144
Ve 9,145
s_nop 0
Vc 72,8,9
Ve 8,146
Ve 9,147
s_nop 0
Vc 73,8,9
Ve 8,160
Ve 9,161
s_nop 0
Vc 80,8,9
Ve 8,162
Ve 9,163
s_nop 0
Vc 81,8,9
Ve 8,176
Ve 9,177
s_nop 0
Vc 88,8,9
Ve 8,178
Ve 9,179
s_nop 0
Vc 89,8,9
Ve 8,132
Ve 9,133
s_nop 0
Vc 66,8,9
Ve 8,134
Ve 9,135
s_nop 0
Vc 67,8,9
Ve 8,148
Ve 9,149
s_nop 0
Vc 74,8,9
Ve 8,150
Ve 9,151
s_nop 0
Vc 75,8,9
Ve 8,164
Ve 9,165
s_nop 0
Vc 82,8,9
Ve 8,166
Ve 9,167
s_nop 0
Vc 83,8,9
Ve 8,180
Ve 9,181
s_nop 0
Vc 90,8,9
Ve 8,182
Ve 9,183
s_nop 0
Vc 91,8,9
Ve 8,136
Ve 9,137
s_nop 0
Vc 68,8,9
Ve 8,138
Ve 9,139
s_nop 0
Vc 69,8,9
Ve 8,152
Ve 9,153
s_nop 0
Vc 76,8,9
Ve 8,154
Ve 9,155
s_nop 0
Vc 77,8,9
Ve 8,168
Ve 9,169
s_nop 0
Vc 84,8,9
Ve 8,170
Ve 9,171
s_nop 0
Vc 85,8,9
Ve 8,184
Ve 9,185
s_nop 0
Vc 92,8,9
Ve 8,186
Ve 9,187
s_nop 0
Vc 93,8,9
Ve 8,140
Ve 9,141
s_nop 0
Vc 70,8,9
Ve 8,142
Ve 9,143
s_nop 0
Vc 71,8,9
Ve 8,156
Ve 9,157
s_nop 0
Vc 78,8,9
Ve 8,158
Ve 9,159
s_nop 0
Vc 79,8,9
Ve 8,172
Ve 9,173
s_nop 0
Vc 86,8,9
Ve 8,174
Ve 9,175
s_nop 0
Vc 87,8,9
Ve 8,188
Ve 9,189
s_nop 0
Vc 94,8,9
Ve 8,190
Ve 9,191
s_nop 0
Vc 95,8,9
s_nop 1
s_branch L_k2_fbr_we
L_k2_fb_wo:
s_nop 7
s_nop 0
v_max3_f32 v21, v192, v193, v194
v_max3_f32 v21, v21, v195, v196
v_max3_f32 v21, v21, v197, v198
v_max3_f32 v21, v21, v199, v200
v_max3_f32 v21, v21, v201, v202
v_max3_f32 v21, v21, v203, v204
v_max3_f32 v21, v21, v205, v206
v_max_f32 v21, v21, v207
v_mov_b32 v1, v21
s_nop 1
v_permlane16_swap_b32 v1, v21
v_max_f32 v21, v21, v1
v_mov_b32 v1, v21
s_nop 1
v_permlane32_swap_b32 v1, v21
v_max_f32_e64 v21, v21, v1
v_add_f32 v21, 0x41f80000, v21
v_max_f32 v21, 0, v21
Vs 192,192,21
Vs 193,193,21
Vs 194,194,21
Vs 195,195,21
Vs 196,196,21
Vs 197,197,21
Vs 198,198,21
Vs 199,199,21
Vs 200,200,21
Vs 201,201,21
Vs 202,202,21
Vs 203,203,21
Vs 204,204,21
Vs 205,205,21
Vs 206,206,21
Vs 207,207,21
Vs 128,128,21
Vs 129,129,21
Vs 130,130,21
Vs 131,131,21
Vs 132,132,21
Vs 133,133,21
Vs 134,134,21
Vs 135,135,21
Vs 136,136,21
Vs 137,137,21
Vs 138,138,21
Vs 139,139,21
Vs 140,140,21
Vs 141,141,21
Vs 142,142,21
Vs 143,143,21
Vs 32,32,21
Vs 33,33,21
Vs 34,34,21
v_sub_f32_e64 v35, v35, v21
v_exp_f32 v22, -v21
s_nop 0
Vm 48,48,22
Vm 49,49,22
Vm 50,50,22
v_mul_f32_e64 v51, v51, v22
Ar 8,0
Ar 9,1
Ar 10,2
Ar 11,3
Ar 12,4
Ar 13,5
Ar 14,6
Ar 15,7
Vm 8,8,22
Vm 9,9,22
Vm 10,10,22
Vm 11,11,22
Vm 12,12,22
Vm 13,13,22
Vm 14,14,22
Vm 15,15,22
Aw 0,8
Aw 1,9
Aw 2,10
Aw 3,11
Aw 4,12
Aw 5,13
Aw 6,14
Aw 7,15
Ar 8,8
Ar 9,9
Ar 10,10
Ar 11,11
Ar 12,12
Ar 13,13
Ar 14,14
Ar 15,15
Vm 8,8,22
Vm 9,9,22
Vm 10,10,22
Vm 11,11,22
Vm 12,12,22
Vm 13,13,22
Vm 14,14,22
Vm 15,15,22
Aw 8,8
Aw 9,9
Aw 10,10
Aw 11,11
Aw 12,12
Aw 13,13
Aw 14,14
Aw 15,15
Ar 8,16
Ar 9,17
Ar 10,18
Ar 11,19
Ar 12,20
Ar 13,21
Ar 14,22
Ar 15,23
Vm 8,8,22
Vm 9,9,22
Vm 10,10,22
Vm 11,11,22
Vm 12,12,22
Vm 13,13,22
Vm 14,14,22
Vm 15,15,22
Aw 16,8
Aw 17,9
Aw 18,10
Aw 19,11
Aw 20,12
Aw 21,13
Aw 22,14
Aw 23,15
Ar 8,24
Ar 9,25
Ar 10,26
Ar 11,27
Ar 12,28
Ar 13,29
Ar 14,30
Ar 15,31
Vm 8,8,22
Vm 9,9,22
Vm 10,10,22
Vm 11,11,22
Vm 12,12,22
Vm 13,13,22
Vm 14,14,22
Vm 15,15,22
Aw 24,8
Aw 25,9
Aw 26,10
Aw 27,11
Aw 28,12
Aw 29,13
Aw 30,14
Aw 31,15
v_max3_f32 v21, v208, v209, v210
v_max3_f32 v21, v21, v211, v212
v_max3_f32 v21, v21, v213, v214
v_max3_f32 v21, v21, v215, v216
v_max3_f32 v21, v21, v217, v218
v_max3_f32 v21, v21, v219, v220
v_max3_f32 v21, v21, v221, v222
v_max_f32 v21, v21, v223
v_mov_b32 v1, v21
s_nop 1
v_permlane16_swap_b32 v1, v21
v_max_f32 v21, v21, v1
v_mov_b32 v1, v21
s_nop 1
v_permlane32_swap_b32 v1, v21
v_max_f32_e64 v21, v21, v1
v_add_f32 v21, 0x41f80000, v21
v_max_f32 v21, 0, v21
Vs 208,208,21
Vs 209,209,21
Vs 210,210,21
Vs 211,211,21
Vs 212,212,21
Vs 213,213,21
Vs 214,214,21
Vs 215,215,21
Vs 216,216,21
Vs 217,217,21
Vs 218,218,21
Vs 219,219,21
Vs 220,220,21
Vs 221,221,21
Vs 222,222,21
Vs 223,223,21
Vs 144,144,21
Vs 145,145,21
Vs 146,146,21
Vs 147,147,21
Vs 148,148,21
Vs 149,149,21
Vs 150,150,21
Vs 151,151,21
Vs 152,152,21
Vs 153,153,21
Vs 154,154,21
Vs 155,155,21
Vs 156,156,21
Vs 157,157,21
Vs 158,158,21
Vs 159,159,21
Vs 36,36,21
Vs 37,37,21
Vs 38,38,21
v_sub_f32_e64 v39, v39, v21
v_exp_f32 v22, -v21
s_nop 0
Vm 52,52,22
Vm 53,53,22
Vm 54,54,22
v_mul_f32_e64 v55, v55, v22
Ar 8,32
Ar 9,33
Ar 10,34
Ar 11,35
Ar 12,36
Ar 13,37
Ar 14,38
Ar 15,39
Vm 8,8,22
Vm 9,9,22
Vm 10,10,22
Vm 11,11,22
Vm 12,12,22
Vm 13,13,22
Vm 14,14,22
Vm 15,15,22
Aw 32,8
Aw 33,9
Aw 34,10
Aw 35,11
Aw 36,12
Aw 37,13
Aw 38,14
Aw 39,15
Ar 8,40
Ar 9,41
Ar 10,42
Ar 11,43
Ar 12,44
Ar 13,45
Ar 14,46
Ar 15,47
Vm 8,8,22
Vm 9,9,22
Vm 10,10,22
Vm 11,11,22
Vm 12,12,22
Vm 13,13,22
Vm 14,14,22
Vm 15,15,22
Aw 40,8
Aw 41,9
Aw 42,10
Aw 43,11
Aw 44,12
Aw 45,13
Aw 46,14
Aw 47,15
Ar 8,48
Ar 9,49
Ar 10,50
Ar 11,51
Ar 12,52
Ar 13,53
Ar 14,54
Ar 15,55
Vm 8,8,22
Vm 9,9,22
Vm 10,10,22
Vm 11,11,22
Vm 12,12,22
Vm 13,13,22
Vm 14,14,22
Vm 15,15,22
Aw 48,8
Aw 49,9
Aw 50,10
Aw 51,11
Aw 52,12
Aw 53,13
Aw 54,14
Aw 55,15
Ar 8,56
Ar 9,57
Ar 10,58
Ar 11,59
Ar 12,60
Ar 13,61
Ar 14,62
Ar 15,63
Vm 8,8,22
Vm 9,9,22
Vm 10,10,22
Vm 11,11,22
Vm 12,12,22
Vm 13,13,22
Vm 14,14,22
Vm 15,15,22
Aw 56,8
Aw 57,9
Aw 58,10
Aw 59,11
Aw 60,12
Aw 61,13
Aw 62,14
Aw 63,15
v_max3_f32 v21, v224, v225, v226
v_max3_f32 v21, v21, v227, v228
v_max3_f32 v21, v21, v229, v230
v_max3_f32 v21, v21, v231, v232
v_max3_f32 v21, v21, v233, v234
v_max3_f32 v21, v21, v235, v236
v_max3_f32 v21, v21, v237, v238
v_max_f32 v21, v21, v239
v_mov_b32 v1, v21
s_nop 1
v_permlane16_swap_b32 v1, v21
v_max_f32 v21, v21, v1
v_mov_b32 v1, v21
s_nop 1
v_permlane32_swap_b32 v1, v21
v_max_f32_e64 v21, v21, v1
v_add_f32 v21, 0x41f80000, v21
v_max_f32 v21, 0, v21
Vs 224,224,21
Vs 225,225,21
Vs 226,226,21
Vs 227,227,21
Vs 228,228,21
Vs 229,229,21
Vs 230,230,21
Vs 231,231,21
Vs 232,232,21
Vs 233,233,21
Vs 234,234,21
Vs 235,235,21
Vs 236,236,21
Vs 237,237,21
Vs 238,238,21
Vs 239,239,21
Vs 160,160,21
Vs 161,161,21
Vs 162,162,21
Vs 163,163,21
Vs 164,164,21
Vs 165,165,21
Vs 166,166,21
Vs 167,167,21
Vs 168,168,21
Vs 169,169,21
Vs 170,170,21
Vs 171,171,21
Vs 172,172,21
Vs 173,173,21
Vs 174,174,21
Vs 175,175,21
Vs 40,40,21
Vs 41,41,21
Vs 42,42,21
v_sub_f32_e64 v43, v43, v21
v_exp_f32 v22, -v21
s_nop 0
Vm 56,56,22
Vm 57,57,22
Vm 58,58,22
v_mul_f32_e64 v59, v59, v22
Ar 8,64
Ar 9,65
Ar 10,66
Ar 11,67
Ar 12,68
Ar 13,69
Ar 14,70
Ar 15,71
Vm 8,8,22
Vm 9,9,22
Vm 10,10,22
Vm 11,11,22
Vm 12,12,22
Vm 13,13,22
Vm 14,14,22
Vm 15,15,22
Aw 64,8
Aw 65,9
Aw 66,10
Aw 67,11
Aw 68,12
Aw 69,13
Aw 70,14
Aw 71,15
Ar 8,72
Ar 9,73
Ar 10,74
Ar 11,75
Ar 12,76
Ar 13,77
Ar 14,78
Ar 15,79
Vm 8,8,22
Vm 9,9,22
Vm 10,10,22
Vm 11,11,22
Vm 12,12,22
Vm 13,13,22
Vm 14,14,22
Vm 15,15,22
Aw 72,8
Aw 73,9
Aw 74,10
Aw 75,11
Aw 76,12
Aw 77,13
Aw 78,14
Aw 79,15
Ar 8,80
Ar 9,81
Ar 10,82
Ar 11,83
Ar 12,84
Ar 13,85
Ar 14,86
Ar 15,87
Vm 8,8,22
Vm 9,9,22
Vm 10,10,22
Vm 11,11,22
Vm 12,12,22
Vm 13,13,22
Vm 14,14,22
Vm 15,15,22
Aw 80,8
Aw 81,9
Aw 82,10
Aw 83,11
Aw 84,12
Aw 85,13
Aw 86,14
Aw 87,15
Ar 8,88
Ar 9,89
Ar 10,90
Ar 11,91
Ar 12,92
Ar 13,93
Ar 14,94
Ar 15,95
Vm 8,8,22
Vm 9,9,22
Vm 10,10,22
Vm 11,11,22
Vm 12,12,22
Vm 13,13,22
Vm 14,14,22
Vm 15,15,22
Aw 88,8
Aw 89,9
Aw 90,10
Aw 91,11
Aw 92,12
Aw 93,13
Aw 94,14
Aw 95,15
v_max3_f32 v21, v240, v241, v242
v_max3_f32 v21, v21, v243, v244
v_max3_f32 v21, v21, v245, v246
v_max3_f32 v21, v21, v247, v248
v_max3_f32 v21, v21, v249, v250
v_max3_f32 v21, v21, v251, v252
v_max3_f32 v21, v21, v253, v254
v_max_f32 v21, v21, v255
v_mov_b32 v1, v21
s_nop 1
v_permlane16_swap_b32 v1, v21
v_max_f32 v21, v21, v1
v_mov_b32 v1, v21
s_nop 1
v_permlane32_swap_b32 v1, v21
v_max_f32_e64 v21, v21, v1
v_add_f32 v21, 0x41f80000, v21
v_max_f32 v21, 0, v21
Vs 240,240,21
Vs 241,241,21
Vs 242,242,21
Vs 243,243,21
Vs 244,244,21
Vs 245,245,21
Vs 246,246,21
Vs 247,247,21
Vs 248,248,21
Vs 249,249,21
Vs 250,250,21
Vs 251,251,21
Vs 252,252,21
Vs 253,253,21
Vs 254,254,21
Vs 255,255,21
Vs 176,176,21
Vs 177,177,21
Vs 178,178,21
Vs 179,179,21
Vs 180,180,21
Vs 181,181,21
Vs 182,182,21
Vs 183,183,21
Vs 184,184,21
Vs 185,185,21
Vs 186,186,21
Vs 187,187,21
Vs 188,188,21
Vs 189,189,21
Vs 190,190,21
Vs 191,191,21
Vs 44,44,21
Vs 45,45,21
Vs 46,46,21
v_sub_f32_e64 v47, v47, v21
v_exp_f32 v22, -v21
s_nop 0
Vm 60,60,22
Vm 61,61,22
Vm 62,62,22
v_mul_f32_e64 v63, v63, v22
Ar 8,96
Ar 9,97
Ar 10,98
Ar 11,99
Ar 12,100
Ar 13,101
Ar 14,102
Ar 15,103
Vm 8,8,22
Vm 9,9,22
Vm 10,10,22
Vm 11,11,22
Vm 12,12,22
Vm 13,13,22
Vm 14,14,22
Vm 15,15,22
Aw 96,8
Aw 97,9
Aw 98,10
Aw 99,11
Aw 100,12
Aw 101,13
Aw 102,14
Aw 103,15
Ar 8,104
Ar 9,105
Ar 10,106
Ar 11,107
Ar 12,108
Ar 13,109
Ar 14,110
Ar 15,111
Vm 8,8,22
Vm 9,9,22
Vm 10,10,22
Vm 11,11,22
Vm 12,12,22
Vm 13,13,22
Vm 14,14,22
Vm 15,15,22
Aw 104,8
Aw 105,9
Aw 106,10
Aw 107,11
Aw 108,12
Aw 109,13
Aw 110,14
Aw 111,15
Ar 8,112
Ar 9,113
Ar 10,114
Ar 11,115
Ar 12,116
Ar 13,117
Ar 14,118
Ar 15,119
Vm 8,8,22
Vm 9,9,22
Vm 10,10,22
Vm 11,11,22
Vm 12,12,22
Vm 13,13,22
Vm 14,14,22
Vm 15,15,22
Aw 112,8
Aw 113,9
Aw 114,10
Aw 115,11
Aw 116,12
Aw 117,13
Aw 118,14
Aw 119,15
Ar 8,120
Ar 9,121
Ar 10,122
Ar 11,123
Ar 12,124
Ar 13,125
Ar 14,126
Ar 15,127
Vm 8,8,22
Vm 9,9,22
Vm 10,10,22
Vm 11,11,22
Vm 12,12,22
Vm 13,13,22
Vm 14,14,22
Vm 15,15,22
Aw 120,8
Aw 121,9
Aw 122,10
Aw 123,11
Aw 124,12
Aw 125,13
Aw 126,14
Aw 127,15
Ve 8,192
Ve 9,193
s_nop 0
Vc 96,8,9
Ve 8,194
Ve 9,195
s_nop 0
Vc 97,8,9
Ve 8,208
Ve 9,209
s_nop 0
Vc 104,8,9
Ve 8,210
Ve 9,211
s_nop 0
Vc 105,8,9
Ve 8,224
Ve 9,225
s_nop 0
Vc 112,8,9
Ve 8,226
Ve 9,227
s_nop 0
Vc 113,8,9
Ve 8,240
Ve 9,241
s_nop 0
Vc 120,8,9
Ve 8,242
Ve 9,243
s_nop 0
Vc 121,8,9
Ve 8,196
Ve 9,197
s_nop 0
Vc 98,8,9
Ve 8,198
Ve 9,199
s_nop 0
Vc 99,8,9
Ve 8,212
Ve 9,213
s_nop 0
Vc 106,8,9
Ve 8,214
Ve 9,215
s_nop 0
Vc 107,8,9
Ve 8,228
Ve 9,229
s_nop 0
Vc 114,8,9
Ve 8,230
Ve 9,231
s_nop 0
Vc 115,8,9
Ve 8,244
Ve 9,245
s_nop 0
Vc 122,8,9
Ve 8,246
Ve 9,247
s_nop 0
Vc 123,8,9
Ve 8,200
Ve 9,201
s_nop 0
Vc 100,8,9
Ve 8,202
Ve 9,203
s_nop 0
Vc 101,8,9
Ve 8,216
Ve 9,217
s_nop 0
Vc 108,8,9
Ve 8,218
Ve 9,219
s_nop 0
Vc 109,8,9
Ve 8,232
Ve 9,233
s_nop 0
Vc 116,8,9
Ve 8,234
Ve 9,235
s_nop 0
Vc 117,8,9
Ve 8,248
Ve 9,249
s_nop 0
Vc 124,8,9
Ve 8,250
Ve 9,251
s_nop 0
Vc 125,8,9
Ve 8,204
Ve 9,205
s_nop 0
Vc 102,8,9
Ve 8,206
Ve 9,207
s_nop 0
Vc 103,8,9
Ve 8,220
Ve 9,221
s_nop 0
Vc 110,8,9
Ve 8,222
Ve 9,223
s_nop 0
Vc 111,8,9
Ve 8,236
Ve 9,237
s_nop 0
Vc 118,8,9
Ve 8,238
Ve 9,239
s_nop 0
Vc 119,8,9
Ve 8,252
Ve 9,253
s_nop 0
Vc 126,8,9
Ve 8,254
Ve 9,255
s_nop 0
Vc 127,8,9
s_nop 1
s_branch L_k2_fbr_wo
L_k2_fb_wl:
s_nop 7
s_nop 0
v_max3_f32 v21, v128, v129, v130
v_max3_f32 v21, v21, v131, v132
v_max3_f32 v21, v21, v133, v134
v_max3_f32 v21, v21, v135, v136
v_max3_f32 v21, v21, v137, v138
v_max3_f32 v21, v21, v139, v140
v_max3_f32 v21, v21, v141, v142
v_max_f32 v21, v21, v143
v_mov_b32 v1, v21
s_nop 1
v_permlane16_swap_b32 v1, v21
v_max_f32 v21, v21, v1
v_mov_b32 v1, v21
s_nop 1
v_permlane32_swap_b32 v1, v21
v_max_f32_e64 v21, v21, v1
v_add_f32 v21, 0x41f80000, v21
v_max_f32 v21, 0, v21
Vs 128,128,21
Vs 129,129,21
Vs 130,130,21
Vs 131,131,21
Vs 132,132,21
Vs 133,133,21
Vs 134,134,21
Vs 135,135,21
Vs 136,136,21
Vs 137,137,21
Vs 138,138,21
Vs 139,139,21
Vs 140,140,21
Vs 141,141,21
Vs 142,142,21
Vs 143,143,21
Vs 192,192,21
Vs 193,193,21
Vs 194,194,21
Vs 195,195,21
Vs 196,196,21
Vs 197,197,21
Vs 198,198,21
Vs 199,199,21
Vs 200,200,21
Vs 201,201,21
Vs 202,202,21
Vs 203,203,21
Vs 204,204,21
Vs 205,205,21
Vs 206,206,21
Vs 207,207,21
Vs 32,32,21
Vs 33,33,21
Vs 34,34,21
v_sub_f32_e64 v35, v35, v21
v_exp_f32 v22, -v21
s_nop 0
Vm 48,48,22
Vm 49,49,22
Vm 50,50,22
v_mul_f32_e64 v51, v51, v22
Ar 8,0
Ar 9,1
Ar 10,2
Ar 11,3
Ar 12,4
Ar 13,5
Ar 14,6
Ar 15,7
Vm 8,8,22
Vm 9,9,22
Vm 10,10,22
Vm 11,11,22
Vm 12,12,22
Vm 13,13,22
Vm 14,14,22
Vm 15,15,22
Aw 0,8
Aw 1,9
Aw 2,10
Aw 3,11
Aw 4,12
Aw 5,13
Aw 6,14
Aw 7,15
Ar 8,8
Ar 9,9
Ar 10,10
Ar 11,11
Ar 12,12
Ar 13,13
Ar 14,14
Ar 15,15
Vm 8,8,22
Vm 9,9,22
Vm 10,10,22
Vm 11,11,22
Vm 12,12,22
Vm 13,13,22
Vm 14,14,22
Vm 15,15,22
Aw 8,8
Aw 9,9
Aw 10,10
Aw 11,11
Aw 12,12
Aw 13,13
Aw 14,14
Aw 15,15
Ar 8,16
Ar 9,17
Ar 10,18
Ar 11,19
Ar 12,20
Ar 13,21
Ar 14,22
Ar 15,23
Vm 8,8,22
Vm 9,9,22
Vm 10,10,22
Vm 11,11,22
Vm 12,12,22
Vm 13,13,22
Vm 14,14,22
Vm 15,15,22
Aw 16,8
Aw 17,9
Aw 18,10
Aw 19,11
Aw 20,12
Aw 21,13
Aw 22,14
Aw 23,15
Ar 8,24
Ar 9,25
Ar 10,26
Ar 11,27
Ar 12,28
Ar 13,29
Ar 14,30
Ar 15,31
Vm 8,8,22
Vm 9,9,22
Vm 10,10,22
Vm 11,11,22
Vm 12,12,22
Vm 13,13,22
Vm 14,14,22
Vm 15,15,22
Aw 24,8
Aw 25,9
Aw 26,10
Aw 27,11
Aw 28,12
Aw 29,13
Aw 30,14
Aw 31,15
v_max3_f32 v21, v144, v145, v146
v_max3_f32 v21, v21, v147, v148
v_max3_f32 v21, v21, v149, v150
v_max3_f32 v21, v21, v151, v152
v_max3_f32 v21, v21, v153, v154
v_max3_f32 v21, v21, v155, v156
v_max3_f32 v21, v21, v157, v158
v_max_f32 v21, v21, v159
v_mov_b32 v1, v21
s_nop 1
v_permlane16_swap_b32 v1, v21
v_max_f32 v21, v21, v1
v_mov_b32 v1, v21
s_nop 1
v_permlane32_swap_b32 v1, v21
v_max_f32_e64 v21, v21, v1
v_add_f32 v21, 0x41f80000, v21
v_max_f32 v21, 0, v21
Vs 144,144,21
Vs 145,145,21
Vs 146,146,21
Vs 147,147,21
Vs 148,148,21
Vs 149,149,21
Vs 150,150,21
Vs 151,151,21
Vs 152,152,21
Vs 153,153,21
Vs 154,154,21
Vs 155,155,21
Vs 156,156,21
Vs 157,157,21
Vs 158,158,21
Vs 159,159,21
Vs 208,208,21
Vs 209,209,21
Vs 210,210,21
Vs 211,211,21
Vs 212,212,21
Vs 213,213,21
Vs 214,214,21
Vs 215,215,21
Vs 216,216,21
Vs 217,217,21
Vs 218,218,21
Vs 219,219,21
Vs 220,220,21
Vs 221,221,21
Vs 222,222,21
Vs 223,223,21
Vs 36,36,21
Vs 37,37,21
Vs 38,38,21
v_sub_f32_e64 v39, v39, v21
v_exp_f32 v22, -v21
s_nop 0
Vm 52,52,22
Vm 53,53,22
Vm 54,54,22
v_mul_f32_e64 v55, v55, v22
Ar 8,32
Ar 9,33
Ar 10,34
Ar 11,35
Ar 12,36
Ar 13,37
Ar 14,38
Ar 15,39
Vm 8,8,22
Vm 9,9,22
Vm 10,10,22
Vm 11,11,22
Vm 12,12,22
Vm 13,13,22
Vm 14,14,22
Vm 15,15,22
Aw 32,8
Aw 33,9
Aw 34,10
Aw 35,11
Aw 36,12
Aw 37,13
Aw 38,14
Aw 39,15
Ar 8,40
Ar 9,41
Ar 10,42
Ar 11,43
Ar 12,44
Ar 13,45
Ar 14,46
Ar 15,47
Vm 8,8,22
Vm 9,9,22
Vm 10,10,22
Vm 11,11,22
Vm 12,12,22
Vm 13,13,22
Vm 14,14,22
Vm 15,15,22
Aw 40,8
Aw 41,9
Aw 42,10
Aw 43,11
Aw 44,12
Aw 45,13
Aw 46,14
Aw 47,15
Ar 8,48
Ar 9,49
Ar 10,50
Ar 11,51
Ar 12,52
Ar 13,53
Ar 14,54
Ar 15,55
Vm 8,8,22
Vm 9,9,22
Vm 10,10,22
Vm 11,11,22
Vm 12,12,22
Vm 13,13,22
Vm 14,14,22
Vm 15,15,22
Aw 48,8
Aw 49,9
Aw 50,10
Aw 51,11
Aw 52,12
Aw 53,13
Aw 54,14
Aw 55,15
Ar 8,56
Ar 9,57
Ar 10,58
Ar 11,59
Ar 12,60
Ar 13,61
Ar 14,62
Ar 15,63
Vm 8,8,22
Vm 9,9,22
Vm 10,10,22
Vm 11,11,22
Vm 12,12,22
Vm 13,13,22
Vm 14,14,22
Vm 15,15,22
Aw 56,8
Aw 57,9
Aw 58,10
Aw 59,11
Aw 60,12
Aw 61,13
Aw 62,14
Aw 63,15
v_max3_f32 v21, v160, v161, v162
v_max3_f32 v21, v21, v163, v164
v_max3_f32 v21, v21, v165, v166
v_max3_f32 v21, v21, v167, v168
v_max3_f32 v21, v21, v169, v170
v_max3_f32 v21, v21, v171, v172
v_max3_f32 v21, v21, v173, v174
v_max_f32 v21, v21, v175
v_mov_b32 v1, v21
s_nop 1
v_permlane16_swap_b32 v1, v21
v_max_f32 v21, v21, v1
v_mov_b32 v1, v21
s_nop 1
v_permlane32_swap_b32 v1, v21
v_max_f32_e64 v21, v21, v1
v_add_f32 v21, 0x41f80000, v21
v_max_f32 v21, 0, v21
Vs 160,160,21
Vs 161,161,21
Vs 162,162,21
Vs 163,163,21
Vs 164,164,21
Vs 165,165,21
Vs 166,166,21
Vs 167,167,21
Vs 168,168,21
Vs 169,169,21
Vs 170,170,21
Vs 171,171,21
Vs 172,172,21
Vs 173,173,21
Vs 174,174,21
Vs 175,175,21
Vs 224,224,21
Vs 225,225,21
Vs 226,226,21
Vs 227,227,21
Vs 228,228,21
Vs 229,229,21
Vs 230,230,21
Vs 231,231,21
Vs 232,232,21
Vs 233,233,21
Vs 234,234,21
Vs 235,235,21
Vs 236,236,21
Vs 237,237,21
Vs 238,238,21
Vs 239,239,21
Vs 40,40,21
Vs 41,41,21
Vs 42,42,21
v_sub_f32_e64 v43, v43, v21
v_exp_f32 v22, -v21
s_nop 0
Vm 56,56,22
Vm 57,57,22
Vm 58,58,22
v_mul_f32_e64 v59, v59, v22
Ar 8,64
Ar 9,65
Ar 10,66
Ar 11,67
Ar 12,68
Ar 13,69
Ar 14,70
Ar 15,71
Vm 8,8,22
Vm 9,9,22
Vm 10,10,22
Vm 11,11,22
Vm 12,12,22
Vm 13,13,22
Vm 14,14,22
Vm 15,15,22
Aw 64,8
Aw 65,9
Aw 66,10
Aw 67,11
Aw 68,12
Aw 69,13
Aw 70,14
Aw 71,15
Ar 8,72
Ar 9,73
Ar 10,74
Ar 11,75
Ar 12,76
Ar 13,77
Ar 14,78
Ar 15,79
Vm 8,8,22
Vm 9,9,22
Vm 10,10,22
Vm 11,11,22
Vm 12,12,22
Vm 13,13,22
Vm 14,14,22
Vm 15,15,22
Aw 72,8
Aw 73,9
Aw 74,10
Aw 75,11
Aw 76,12
Aw 77,13
Aw 78,14
Aw 79,15
Ar 8,80
Ar 9,81
Ar 10,82
Ar 11,83
Ar 12,84
Ar 13,85
Ar 14,86
Ar 15,87
Vm 8,8,22
Vm 9,9,22
Vm 10,10,22
Vm 11,11,22
Vm 12,12,22
Vm 13,13,22
Vm 14,14,22
Vm 15,15,22
Aw 80,8
Aw 81,9
Aw 82,10
Aw 83,11
Aw 84,12
Aw 85,13
Aw 86,14
Aw 87,15
Ar 8,88
Ar 9,89
Ar 10,90
Ar 11,91
Ar 12,92
Ar 13,93
Ar 14,94
Ar 15,95
Vm 8,8,22
Vm 9,9,22
Vm 10,10,22
Vm 11,11,22
Vm 12,12,22
Vm 13,13,22
Vm 14,14,22
Vm 15,15,22
Aw 88,8
Aw 89,9
Aw 90,10
Aw 91,11
Aw 92,12
Aw 93,13
Aw 94,14
Aw 95,15
v_max3_f32 v21, v176, v177, v178
v_max3_f32 v21, v21, v179, v180
v_max3_f32 v21, v21, v181, v182
v_max3_f32 v21, v21, v183, v184
v_max3_f32 v21, v21, v185, v186
v_max3_f32 v21, v21, v187, v188
v_max3_f32 v21, v21, v189, v190
v_max_f32 v21, v21, v191
v_mov_b32 v1, v21
s_nop 1
v_permlane16_swap_b32 v1, v21
v_max_f32 v21, v21, v1
v_mov_b32 v1, v21
s_nop 1
v_permlane32_swap_b32 v1, v21
v_max_f32_e64 v21, v21, v1
v_add_f32 v21, 0x41f80000, v21
v_max_f32 v21, 0, v21
Vs 176,176,21
Vs 177,177,21
Vs 178,178,21
Vs 179,179,21
Vs 180,180,21
Vs 181,181,21
Vs 182,182,21
Vs 183,183,21
Vs 184,184,21
Vs 185,185,21
Vs 186,186,21
Vs 187,187,21
Vs 188,188,21
Vs 189,189,21
Vs 190,190,21
Vs 191,191,21
Vs 44,44,21
Vs 45,45,21
Vs 46,46,21
v_sub_f32_e64 v47, v47, v21
v_exp_f32 v22, -v21
s_nop 0
Vm 60,60,22
Vm 61,61,22
Vm 62,62,22
v_mul_f32_e64 v63, v63, v22
Ar 8,96
Ar 9,97
Ar 10,98
Ar 11,99
Ar 12,100
Ar 13,101
Ar 14,102
Ar 15,103
Vm 8,8,22
Vm 9,9,22
Vm 10,10,22
Vm 11,11,22
Vm 12,12,22
Vm 13,13,22
Vm 14,14,22
Vm 15,15,22
Aw 96,8
Aw 97,9
Aw 98,10
Aw 99,11
Aw 100,12
Aw 101,13
Aw 102,14
Aw 103,15
Ar 8,104
Ar 9,105
Ar 10,106
Ar 11,107
Ar 12,108
Ar 13,109
Ar 14,110
Ar 15,111
Vm 8,8,22
Vm 9,9,22
Vm 10,10,22
Vm 11,11,22
Vm 12,12,22
Vm 13,13,22
Vm 14,14,22
Vm 15,15,22
Aw 104,8
Aw 105,9
Aw 106,10
Aw 107,11
Aw 108,12
Aw 109,13
Aw 110,14
Aw 111,15
Ar 8,112
Ar 9,113
Ar 10,114
Ar 11,115
Ar 12,116
Ar 13,117
Ar 14,118
Ar 15,119
Vm 8,8,22
Vm 9,9,22
Vm 10,10,22
Vm 11,11,22
Vm 12,12,22
Vm 13,13,22
Vm 14,14,22
Vm 15,15,22
Aw 112,8
Aw 113,9
Aw 114,10
Aw 115,11
Aw 116,12
Aw 117,13
Aw 118,14
Aw 119,15
Ar 8,120
Ar 9,121
Ar 10,122
Ar 11,123
Ar 12,124
Ar 13,125
Ar 14,126
Ar 15,127
Vm 8,8,22
Vm 9,9,22
Vm 10,10,22
Vm 11,11,22
Vm 12,12,22
Vm 13,13,22
Vm 14,14,22
Vm 15,15,22
Aw 120,8
Aw 121,9
Aw 122,10
Aw 123,11
Aw 124,12
Aw 125,13
Aw 126,14
Aw 127,15
Ve 8,128
Ve 9,129
s_nop 0
Vc 64,8,9
Ve 8,130
Ve 9,131
s_nop 0
Vc 65,8,9
Ve 8,144
Ve 9,145
s_nop 0
Vc 72,8,9
Ve 8,146
Ve 9,147
s_nop 0
Vc 73,8,9
Ve 8,160
Ve 9,161
s_nop 0
Vc 80,8,9
Ve 8,162
Ve 9,163
s_nop 0
Vc 81,8,9
Ve 8,176
Ve 9,177
s_nop 0
Vc 88,8,9
Ve 8,178
Ve 9,179
s_nop 0
Vc 89,8,9
Ve 8,132
Ve 9,133
s_nop 0
Vc 66,8,9
Ve 8,134
Ve 9,135
s_nop 0
Vc 67,8,9
Ve 8,148
Ve 9,149
s_nop 0
Vc 74,8,9
Ve 8,150
Ve 9,151
s_nop 0
Vc 75,8,9
Ve 8,164
Ve 9,165
s_nop 0
Vc 82,8,9
Ve 8,166
Ve 9,167
s_nop 0
Vc 83,8,9
Ve 8,180
Ve 9,181
s_nop 0
Vc 90,8,9
Ve 8,182
Ve 9,183
s_nop 0
Vc 91,8,9
Ve 8,136
Ve 9,137
s_nop 0
Vc 68,8,9
Ve 8,138
Ve 9,139
s_nop 0
Vc 69,8,9
Ve 8,152
Ve 9,153
s_nop 0
Vc 76,8,9
Ve 8,154
Ve 9,155
s_nop 0
Vc 77,8,9
Ve 8,168
Ve 9,169
s_nop 0
Vc 84,8,9
Ve 8,170
Ve 9,171
s_nop 0
Vc 85,8,9
Ve 8,184
Ve 9,185
s_nop 0
Vc 92,8,9
Ve 8,186
Ve 9,187
s_nop 0
Vc 93,8,9
Ve 8,140
Ve 9,141
s_nop 0
Vc 70,8,9
Ve 8,142
Ve 9,143
s_nop 0
Vc 71,8,9
Ve 8,156
Ve 9,157
s_nop 0
Vc 78,8,9
Ve 8,158
Ve 9,159
s_nop 0
Vc 79,8,9
Ve 8,172
Ve 9,173
s_nop 0
Vc 86,8,9
Ve 8,174
Ve 9,175
s_nop 0
Vc 87,8,9
Ve 8,188
Ve 9,189
s_nop 0
Vc 94,8,9
Ve 8,190
Ve 9,191
s_nop 0
Vc 95,8,9
s_nop 1
s_branch L_k2_fbr_wl
L_k2_fb_tr:
s_nop 7
s_nop 0
v_max3_f32 v21, v192, v193, v194
v_max3_f32 v21, v21, v195, v196
v_max3_f32 v21, v21, v197, v198
v_max3_f32 v21, v21, v199, v200
v_max3_f32 v21, v21, v201, v202
v_max3_f32 v21, v21, v203, v204
v_max3_f32 v21, v21, v205, v206
v_max_f32 v21, v21, v207
v_mov_b32 v1, v21
s_nop 1
v_permlane16_swap_b32 v1, v21
v_max_f32 v21, v21, v1
v_mov_b32 v1, v21
s_nop 1
v_permlane32_swap_b32 v1, v21
v_max_f32_e64 v21, v21, v1
v_add_f32 v21, 0x41f80000, v21
v_max_f32 v21, 0, v21
Vs 192,192,21
Vs 193,193,21
Vs 194,194,21
Vs 195,195,21
Vs 196,196,21
Vs 197,197,21
Vs 198,198,21
Vs 199,199,21
Vs 200,200,21
Vs 201,201,21
Vs 202,202,21
Vs 203,203,21
Vs 204,204,21
Vs 205,205,21
Vs 206,206,21
Vs 207,207,21
Vs 128,128,21
Vs 129,129,21
Vs 130,130,21
Vs 131,131,21
Vs 132,132,21
Vs 133,133,21
Vs 134,134,21
Vs 135,135,21
Vs 136,136,21
Vs 137,137,21
Vs 138,138,21
Vs 139,139,21
Vs 140,140,21
Vs 141,141,21
Vs 142,142,21
Vs 143,143,21
Vs 32,32,21
Vs 33,33,21
Vs 34,34,21
v_sub_f32_e64 v35, v35, v21
v_exp_f32 v22, -v21
s_nop 0
Vm 48,48,22
Vm 49,49,22
Vm 50,50,22
v_mul_f32_e64 v51, v51, v22
Ar 8,0
Ar 9,1
Ar 10,2
Ar 11,3
Ar 12,4
Ar 13,5
Ar 14,6
Ar 15,7
Vm 8,8,22
Vm 9,9,22
Vm 10,10,22
Vm 11,11,22
Vm 12,12,22
Vm 13,13,22
Vm 14,14,22
Vm 15,15,22
Aw 0,8
Aw 1,9
Aw 2,10
Aw 3,11
Aw 4,12
Aw 5,13
Aw 6,14
Aw 7,15
Ar 8,8
Ar 9,9
Ar 10,10
Ar 11,11
Ar 12,12
Ar 13,13
Ar 14,14
Ar 15,15
Vm 8,8,22
Vm 9,9,22
Vm 10,10,22
Vm 11,11,22
Vm 12,12,22
Vm 13,13,22
Vm 14,14,22
Vm 15,15,22
Aw 8,8
Aw 9,9
Aw 10,10
Aw 11,11
Aw 12,12
Aw 13,13
Aw 14,14
Aw 15,15
Ar 8,16
Ar 9,17
Ar 10,18
Ar 11,19
Ar 12,20
Ar 13,21
Ar 14,22
Ar 15,23
Vm 8,8,22
Vm 9,9,22
Vm 10,10,22
Vm 11,11,22
Vm 12,12,22
Vm 13,13,22
Vm 14,14,22
Vm 15,15,22
Aw 16,8
Aw 17,9
Aw 18,10
Aw 19,11
Aw 20,12
Aw 21,13
Aw 22,14
Aw 23,15
Ar 8,24
Ar 9,25
Ar 10,26
Ar 11,27
Ar 12,28
Ar 13,29
Ar 14,30
Ar 15,31
Vm 8,8,22
Vm 9,9,22
Vm 10,10,22
Vm 11,11,22
Vm 12,12,22
Vm 13,13,22
Vm 14,14,22
Vm 15,15,22
Aw 24,8
Aw 25,9
Aw 26,10
Aw 27,11
Aw 28,12
Aw 29,13
Aw 30,14
Aw 31,15
v_max3_f32 v21, v208, v209, v210
v_max3_f32 v21, v21, v211, v212
v_max3_f32 v21, v21, v213, v214
v_max3_f32 v21, v21, v215, v216
v_max3_f32 v21, v21, v217, v218
v_max3_f32 v21, v21, v219, v220
v_max3_f32 v21, v21, v221, v222
v_max_f32 v21, v21, v223
v_mov_b32 v1, v21
s_nop 1
v_permlane16_swap_b32 v1, v21
v_max_f32 v21, v21, v1
v_mov_b32 v1, v21
s_nop 1
v_permlane32_swap_b32 v1, v21
v_max_f32_e64 v21, v21, v1
v_add_f32 v21, 0x41f80000, v21
v_max_f32 v21, 0, v21
Vs 208,208,21
Vs 209,209,21
Vs 210,210,21
Vs 211,211,21
Vs 212,212,21
Vs 213,213,21
Vs 214,214,21
Vs 215,215,21
Vs 216,216,21
Vs 217,217,21
Vs 218,218,21
Vs 219,219,21
Vs 220,220,21
Vs 221,221,21
Vs 222,222,21
Vs 223,223,21
Vs 144,144,21
Vs 145,145,21
Vs 146,146,21
Vs 147,147,21
Vs 148,148,21
Vs 149,149,21
Vs 150,150,21
Vs 151,151,21
Vs 152,152,21
Vs 153,153,21
Vs 154,154,21
Vs 155,155,21
Vs 156,156,21
Vs 157,157,21
Vs 158,158,21
Vs 159,159,21
Vs 36,36,21
Vs 37,37,21
Vs 38,38,21
v_sub_f32_e64 v39, v39, v21
v_exp_f32 v22, -v21
s_nop 0
Vm 52,52,22
Vm 53,53,22
Vm 54,54,22
v_mul_f32_e64 v55, v55, v22
Ar 8,32
Ar 9,33
Ar 10,34
Ar 11,35
Ar 12,36
Ar 13,37
Ar 14,38
Ar 15,39
Vm 8,8,22
Vm 9,9,22
Vm 10,10,22
Vm 11,11,22
Vm 12,12,22
Vm 13,13,22
Vm 14,14,22
Vm 15,15,22
Aw 32,8
Aw 33,9
Aw 34,10
Aw 35,11
Aw 36,12
Aw 37,13
Aw 38,14
Aw 39,15
Ar 8,40
Ar 9,41
Ar 10,42
Ar 11,43
Ar 12,44
Ar 13,45
Ar 14,46
Ar 15,47
Vm 8,8,22
Vm 9,9,22
Vm 10,10,22
Vm 11,11,22
Vm 12,12,22
Vm 13,13,22
Vm 14,14,22
Vm 15,15,22
Aw 40,8
Aw 41,9
Aw 42,10
Aw 43,11
Aw 44,12
Aw 45,13
Aw 46,14
Aw 47,15
Ar 8,48
Ar 9,49
Ar 10,50
Ar 11,51
Ar 12,52
Ar 13,53
Ar 14,54
Ar 15,55
Vm 8,8,22
Vm 9,9,22
Vm 10,10,22
Vm 11,11,22
Vm 12,12,22
Vm 13,13,22
Vm 14,14,22
Vm 15,15,22
Aw 48,8
Aw 49,9
Aw 50,10
Aw 51,11
Aw 52,12
Aw 53,13
Aw 54,14
Aw 55,15
Ar 8,56
Ar 9,57
Ar 10,58
Ar 11,59
Ar 12,60
Ar 13,61
Ar 14,62
Ar 15,63
Vm 8,8,22
Vm 9,9,22
Vm 10,10,22
Vm 11,11,22
Vm 12,12,22
Vm 13,13,22
Vm 14,14,22
Vm 15,15,22
Aw 56,8
Aw 57,9
Aw 58,10
Aw 59,11
Aw 60,12
Aw 61,13
Aw 62,14
Aw 63,15
v_max3_f32 v21, v224, v225, v226
v_max3_f32 v21, v21, v227, v228
v_max3_f32 v21, v21, v229, v230
v_max3_f32 v21, v21, v231, v232
v_max3_f32 v21, v21, v233, v234
v_max3_f32 v21, v21, v235, v236
v_max3_f32 v21, v21, v237, v238
v_max_f32 v21, v21, v239
v_mov_b32 v1, v21
s_nop 1
v_permlane16_swap_b32 v1, v21
v_max_f32 v21, v21, v1
v_mov_b32 v1, v21
s_nop 1
v_permlane32_swap_b32 v1, v21
v_max_f32_e64 v21, v21, v1
v_add_f32 v21, 0x41f80000, v21
v_max_f32 v21, 0, v21
Vs 224,224,21
Vs 225,225,21
Vs 226,226,21
Vs 227,227,21
Vs 228,228,21
Vs 229,229,21
Vs 230,230,21
Vs 231,231,21
Vs 232,232,21
Vs 233,233,21
Vs 234,234,21
Vs 235,235,21
Vs 236,236,21
Vs 237,237,21
Vs 238,238,21
Vs 239,239,21
Vs 40,40,21
Vs 41,41,21
Vs 42,42,21
v_sub_f32_e64 v43, v43, v21
v_exp_f32 v22, -v21
s_nop 0
Vm 56,56,22
Vm 57,57,22
Vm 58,58,22
v_mul_f32_e64 v59, v59, v22
Ar 8,64
Ar 9,65
Ar 10,66
Ar 11,67
Ar 12,68
Ar 13,69
Ar 14,70
Ar 15,71
Vm 8,8,22
Vm 9,9,22
Vm 10,10,22
Vm 11,11,22
Vm 12,12,22
Vm 13,13,22
Vm 14,14,22
Vm 15,15,22
Aw 64,8
Aw 65,9
Aw 66,10
Aw 67,11
Aw 68,12
Aw 69,13
Aw 70,14
Aw 71,15
Ar 8,72
Ar 9,73
Ar 10,74
Ar 11,75
Ar 12,76
Ar 13,77
Ar 14,78
Ar 15,79
Vm 8,8,22
Vm 9,9,22
Vm 10,10,22
Vm 11,11,22
Vm 12,12,22
Vm 13,13,22
Vm 14,14,22
Vm 15,15,22
Aw 72,8
Aw 73,9
Aw 74,10
Aw 75,11
Aw 76,12
Aw 77,13
Aw 78,14
Aw 79,15
Ar 8,80
Ar 9,81
Ar 10,82
Ar 11,83
Ar 12,84
Ar 13,85
Ar 14,86
Ar 15,87
Vm 8,8,22
Vm 9,9,22
Vm 10,10,22
Vm 11,11,22
Vm 12,12,22
Vm 13,13,22
Vm 14,14,22
Vm 15,15,22
Aw 80,8
Aw 81,9
Aw 82,10
Aw 83,11
Aw 84,12
Aw 85,13
Aw 86,14
Aw 87,15
Ar 8,88
Ar 9,89
Ar 10,90
Ar 11,91
Ar 12,92
Ar 13,93
Ar 14,94
Ar 15,95
Vm 8,8,22
Vm 9,9,22
Vm 10,10,22
Vm 11,11,22
Vm 12,12,22
Vm 13,13,22
Vm 14,14,22
Vm 15,15,22
Aw 88,8
Aw 89,9
Aw 90,10
Aw 91,11
Aw 92,12
Aw 93,13
Aw 94,14
Aw 95,15
Ve 8,192
Ve 9,193
s_nop 0
Vc 96,8,9
Ve 8,194
Ve 9,195
s_nop 0
Vc 97,8,9
Ve 8,208
Ve 9,209
s_nop 0
Vc 104,8,9
Ve 8,210
Ve 9,211
s_nop 0
Vc 105,8,9
Ve 8,224
Ve 9,225
s_nop 0
Vc 112,8,9
Ve 8,226
Ve 9,227
s_nop 0
Vc 113,8,9
Ve 8,196
Ve 9,197
s_nop 0
Vc 98,8,9
Ve 8,198
Ve 9,199
s_nop 0
Vc 99,8,9
Ve 8,212
Ve 9,213
s_nop 0
Vc 106,8,9
Ve 8,214
Ve 9,215
s_nop 0
Vc 107,8,9
Ve 8,228
Ve 9,229
s_nop 0
Vc 114,8,9
Ve 8,230
Ve 9,231
s_nop 0
Vc 115,8,9
Ve 8,200
Ve 9,201
s_nop 0
Vc 100,8,9
Ve 8,202
Ve 9,203
s_nop 0
Vc 101,8,9
Ve 8,216
Ve 9,217
s_nop 0
Vc 108,8,9
Ve 8,218
Ve 9,219
s_nop 0
Vc 109,8,9
Ve 8,232
Ve 9,233
s_nop 0
Vc 116,8,9
Ve 8,234
Ve 9,235
s_nop 0
Vc 117,8,9
Ve 8,204
Ve 9,205
s_nop 0
Vc 102,8,9
Ve 8,206
Ve 9,207
s_nop 0
Vc 103,8,9
Ve 8,220
Ve 9,221
s_nop 0
Vc 110,8,9
Ve 8,222
Ve 9,223
s_nop 0
Vc 111,8,9
Ve 8,236
Ve 9,237
s_nop 0
Vc 118,8,9
Ve 8,238
Ve 9,239
s_nop 0
Vc 119,8,9
s_nop 1
s_branch L_k2_fbr_tr
L_k2_fb_ne:
s_nop 7
s_nop 0
v_max3_f32 v21, v128, v129, v130
v_max3_f32 v21, v21, v131, v132
v_max3_f32 v21, v21, v133, v134
v_max3_f32 v21, v21, v135, v136
v_max3_f32 v21, v21, v137, v138
v_max3_f32 v21, v21, v139, v140
v_max3_f32 v21, v21, v141, v142
v_max_f32 v21, v21, v143
v_mov_b32 v1, v21
s_nop 1
v_permlane16_swap_b32 v1, v21
v_max_f32 v21, v21, v1
v_mov_b32 v1, v21
s_nop 1
v_permlane32_swap_b32 v1, v21
v_max_f32_e64 v21, v21, v1
v_add_f32 v21, 0x41f80000, v21
v_max_f32 v21, 0, v21
Vs 128,128,21
Vs 129,129,21
Vs 130,130,21
Vs 131,131,21
Vs 132,132,21
Vs 133,133,21
Vs 134,134,21
Vs 135,135,21
Vs 136,136,21
Vs 137,137,21
Vs 138,138,21
Vs 139,139,21
Vs 140,140,21
Vs 141,141,21
Vs 142,142,21
Vs 143,143,21
Vs 192,192,21
Vs 193,193,21
Vs 194,194,21
Vs 195,195,21
Vs 196,196,21
Vs 197,197,21
Vs 198,198,21
Vs 199,199,21
Vs 200,200,21
Vs 201,201,21
Vs 202,202,21
Vs 203,203,21
Vs 204,204,21
Vs 205,205,21
Vs 206,206,21
Vs 207,207,21
Vs 32,32,21
Vs 33,33,21
Vs 34,34,21
v_sub_f32_e64 v35, v35, v21
v_exp_f32 v22, -v21
s_nop 0
Vm 48,48,22
Vm 49,49,22
Vm 50,50,22
v_mul_f32_e64 v51, v51, v22
Ar 8,0
Ar 9,1
Ar 10,2
Ar 11,3
Ar 12,4
Ar 13,5
Ar 14,6
Ar 15,7
Vm 8,8,22
Vm 9,9,22
Vm 10,10,22
Vm 11,11,22
Vm 12,12,22
Vm 13,13,22
Vm 14,14,22
Vm 15,15,22
Aw 0,8
Aw 1,9
Aw 2,10
Aw 3,11
Aw 4,12
Aw 5,13
Aw 6,14
Aw 7,15
Ar 8,8
Ar 9,9
Ar 10,10
Ar 11,11
Ar 12,12
Ar 13,13
Ar 14,14
Ar 15,15
Vm 8,8,22
Vm 9,9,22
Vm 10,10,22
Vm 11,11,22
Vm 12,12,22
Vm 13,13,22
Vm 14,14,22
Vm 15,15,22
Aw 8,8
Aw 9,9
Aw 10,10
Aw 11,11
Aw 12,12
Aw 13,13
Aw 14,14
Aw 15,15
Ar 8,16
Ar 9,17
Ar 10,18
Ar 11,19
Ar 12,20
Ar 13,21
Ar 14,22
Ar 15,23
Vm 8,8,22
Vm 9,9,22
Vm 10,10,22
Vm 11,11,22
Vm 12,12,22
Vm 13,13,22
Vm 14,14,22
Vm 15,15,22
Aw 16,8
Aw 17,9
Aw 18,10
Aw 19,11
Aw 20,12
Aw 21,13
Aw 22,14
Aw 23,15
Ar 8,24
Ar 9,25
Ar 10,26
Ar 11,27
Ar 12,28
Ar 13,29
Ar 14,30
Ar 15,31
Vm 8,8,22
Vm 9,9,22
Vm 10,10,22
Vm 11,11,22
Vm 12,12,22
Vm 13,13,22
Vm 14,14,22
Vm 15,15,22
Aw 24,8
Aw 25,9
Aw 26,10
Aw 27,11
Aw 28,12
Aw 29,13
Aw 30,14
Aw 31,15
v_max3_f32 v21, v144, v145, v146
v_max3_f32 v21, v21, v147, v148
v_max3_f32 v21, v21, v149, v150
v_max3_f32 v21, v21, v151, v152
v_max3_f32 v21, v21, v153, v154
v_max3_f32 v21, v21, v155, v156
v_max3_f32 v21, v21, v157, v158
v_max_f32 v21, v21, v159
v_mov_b32 v1, v21
s_nop 1
v_permlane16_swap_b32 v1, v21
v_max_f32 v21, v21, v1
v_mov_b32 v1, v21
s_nop 1
v_permlane32_swap_b32 v1, v21
v_max_f32_e64 v21, v21, v1
v_add_f32 v21, 0x41f80000, v21
v_max_f32 v21, 0, v21
Vs 144,144,21
Vs 145,145,21
Vs 146,146,21
Vs 147,147,21
Vs 148,148,21
Vs 149,149,21
Vs 150,150,21
Vs 151,151,21
Vs 152,152,21
Vs 153,153,21
Vs 154,154,21
Vs 155,155,21
Vs 156,156,21
Vs 157,157,21
Vs 158,158,21
Vs 159,159,21
Vs 208,208,21
Vs 209,209,21
Vs 210,210,21
Vs 211,211,21
Vs 212,212,21
Vs 213,213,21
Vs 214,214,21
Vs 215,215,21
Vs 216,216,21
Vs 217,217,21
Vs 218,218,21
Vs 219,219,21
Vs 220,220,21
Vs 221,221,21
Vs 222,222,21
Vs 223,223,21
Vs 36,36,21
Vs 37,37,21
Vs 38,38,21
v_sub_f32_e64 v39, v39, v21
v_exp_f32 v22, -v21
s_nop 0
Vm 52,52,22
Vm 53,53,22
Vm 54,54,22
v_mul_f32_e64 v55, v55, v22
Ar 8,32
Ar 9,33
Ar 10,34
Ar 11,35
Ar 12,36
Ar 13,37
Ar 14,38
Ar 15,39
Vm 8,8,22
Vm 9,9,22
Vm 10,10,22
Vm 11,11,22
Vm 12,12,22
Vm 13,13,22
Vm 14,14,22
Vm 15,15,22
Aw 32,8
Aw 33,9
Aw 34,10
Aw 35,11
Aw 36,12
Aw 37,13
Aw 38,14
Aw 39,15
Ar 8,40
Ar 9,41
Ar 10,42
Ar 11,43
Ar 12,44
Ar 13,45
Ar 14,46
Ar 15,47
Vm 8,8,22
Vm 9,9,22
Vm 10,10,22
Vm 11,11,22
Vm 12,12,22
Vm 13,13,22
Vm 14,14,22
Vm 15,15,22
Aw 40,8
Aw 41,9
Aw 42,10
Aw 43,11
Aw 44,12
Aw 45,13
Aw 46,14
Aw 47,15
Ar 8,48
Ar 9,49
Ar 10,50
Ar 11,51
Ar 12,52
Ar 13,53
Ar 14,54
Ar 15,55
Vm 8,8,22
Vm 9,9,22
Vm 10,10,22
Vm 11,11,22
Vm 12,12,22
Vm 13,13,22
Vm 14,14,22
Vm 15,15,22
Aw 48,8
Aw 49,9
Aw 50,10
Aw 51,11
Aw 52,12
Aw 53,13
Aw 54,14
Aw 55,15
Ar 8,56
Ar 9,57
Ar 10,58
Ar 11,59
Ar 12,60
Ar 13,61
Ar 14,62
Ar 15,63
Vm 8,8,22
Vm 9,9,22
Vm 10,10,22
Vm 11,11,22
Vm 12,12,22
Vm 13,13,22
Vm 14,14,22
Vm 15,15,22
Aw 56,8
Aw 57,9
Aw 58,10
Aw 59,11
Aw 60,12
Aw 61,13
Aw 62,14
Aw 63,15
Ve 8,128
Ve 9,129
s_nop 0
Vc 64,8,9
Ve 8,130
Ve 9,131
s_nop 0
Vc 65,8,9
Ve 8,144
Ve 9,145
s_nop 0
Vc 72,8,9
Ve 8,146
Ve 9,147
s_nop 0
Vc 73,8,9
Ve 8,132
Ve 9,133
s_nop 0
Vc 66,8,9
Ve 8,134
Ve 9,135
s_nop 0
Vc 67,8,9
Ve 8,148
Ve 9,149
s_nop 0
Vc 74,8,9
Ve 8,150
Ve 9,151
s_nop 0
Vc 75,8,9
Ve 8,136
Ve 9,137
s_nop 0
Vc 68,8,9
Ve 8,138
Ve 9,139
s_nop 0
Vc 69,8,9
Ve 8,152
Ve 9,153
s_nop 0
Vc 76,8,9
Ve 8,154
Ve 9,155
s_nop 0
Vc 77,8,9
Ve 8,140
Ve 9,141
s_nop 0
Vc 70,8,9
Ve 8,142
Ve 9,143
s_nop 0
Vc 71,8,9
Ve 8,156
Ve 9,157
s_nop 0
Vc 78,8,9
Ve 8,158
Ve 9,159
s_nop 0
Vc 79,8,9
s_nop 1
s_branch L_k2_fbr_ne
L_k2_fb_no:
s_nop 7
s_nop 0
v_max3_f32 v21, v192, v193, v194
v_max3_f32 v21, v21, v195, v196
v_max3_f32 v21, v21, v197, v198
v_max3_f32 v21, v21, v199, v200
v_max3_f32 v21, v21, v201, v202
v_max3_f32 v21, v21, v203, v204
v_max3_f32 v21, v21, v205, v206
v_max_f32 v21, v21, v207
v_mov_b32 v1, v21
s_nop 1
v_permlane16_swap_b32 v1, v21
v_max_f32 v21, v21, v1
v_mov_b32 v1, v21
s_nop 1
v_permlane32_swap_b32 v1, v21
v_max_f32_e64 v21, v21, v1
v_add_f32 v21, 0x41f80000, v21
v_max_f32 v21, 0, v21
Vs 192,192,21
Vs 193,193,21
Vs 194,194,21
Vs 195,195,21
Vs 196,196,21
Vs 197,197,21
Vs 198,198,21
Vs 199,199,21
Vs 200,200,21
Vs 201,201,21
Vs 202,202,21
Vs 203,203,21
Vs 204,204,21
Vs 205,205,21
Vs 206,206,21
Vs 207,207,21
Vs 128,128,21
Vs 129,129,21
Vs 130,130,21
Vs 131,131,21
Vs 132,132,21
Vs 133,133,21
Vs 134,134,21
Vs 135,135,21
Vs 136,136,21
Vs 137,137,21
Vs 138,138,21
Vs 139,139,21
Vs 140,140,21
Vs 141,141,21
Vs 142,142,21
Vs 143,143,21
Vs 32,32,21
Vs 33,33,21
Vs 34,34,21
v_sub_f32_e64 v35, v35, v21
v_exp_f32 v22, -v21
s_nop 0
Vm 48,48,22
Vm 49,49,22
Vm 50,50,22
v_mul_f32_e64 v51, v51, v22
Ar 8,0
Ar 9,1
Ar 10,2
Ar 11,3
Ar 12,4
Ar 13,5
Ar 14,6
Ar 15,7
Vm 8,8,22
Vm 9,9,22
Vm 10,10,22
Vm 11,11,22
Vm 12,12,22
Vm 13,13,22
Vm 14,14,22
Vm 15,15,22
Aw 0,8
Aw 1,9
Aw 2,10
Aw 3,11
Aw 4,12
Aw 5,13
Aw 6,14
Aw 7,15
Ar 8,8
Ar 9,9
Ar 10,10
Ar 11,11
Ar 12,12
Ar 13,13
Ar 14,14
Ar 15,15
Vm 8,8,22
Vm 9,9,22
Vm 10,10,22
Vm 11,11,22
Vm 12,12,22
Vm 13,13,22
Vm 14,14,22
Vm 15,15,22
Aw 8,8
Aw 9,9
Aw 10,10
Aw 11,11
Aw 12,12
Aw 13,13
Aw 14,14
Aw 15,15
Ar 8,16
Ar 9,17
Ar 10,18
Ar 11,19
Ar 12,20
Ar 13,21
Ar 14,22
Ar 15,23
Vm 8,8,22
Vm 9,9,22
Vm 10,10,22
Vm 11,11,22
Vm 12,12,22
Vm 13,13,22
Vm 14,14,22
Vm 15,15,22
Aw 16,8
Aw 17,9
Aw 18,10
Aw 19,11
Aw 20,12
Aw 21,13
Aw 22,14
Aw 23,15
Ar 8,24
Ar 9,25
Ar 10,26
Ar 11,27
Ar 12,28
Ar 13,29
Ar 14,30
Ar 15,31
Vm 8,8,22
Vm 9,9,22
Vm 10,10,22
Vm 11,11,22
Vm 12,12,22
Vm 13,13,22
Vm 14,14,22
Vm 15,15,22
Aw 24,8
Aw 25,9
Aw 26,10
Aw 27,11
Aw 28,12
Aw 29,13
Aw 30,14
Aw 31,15
v_max3_f32 v21, v208, v209, v210
v_max3_f32 v21, v21, v211, v212
v_max3_f32 v21, v21, v213, v214
v_max3_f32 v21, v21, v215, v216
v_max3_f32 v21, v21, v217, v218
v_max3_f32 v21, v21, v219, v220
v_max3_f32 v21, v21, v221, v222
v_max_f32 v21, v21, v223
v_mov_b32 v1, v21
s_nop 1
v_permlane16_swap_b32 v1, v21
v_max_f32 v21, v21, v1
v_mov_b32 v1, v21
s_nop 1
v_permlane32_swap_b32 v1, v21
v_max_f32_e64 v21, v21, v1
v_add_f32 v21, 0x41f80000, v21
v_max_f32 v21, 0, v21
Vs 208,208,21
Vs 209,209,21
Vs 210,210,21
Vs 211,211,21
Vs 212,212,21
Vs 213,213,21
Vs 214,214,21
Vs 215,215,21
Vs 216,216,21
Vs 217,217,21
Vs 218,218,21
Vs 219,219,21
Vs 220,220,21
Vs 221,221,21
Vs 222,222,21
Vs 223,223,21
Vs 144,144,21
Vs 145,145,21
Vs 146,146,21
Vs 147,147,21
Vs 148,148,21
Vs 149,149,21
Vs 150,150,21
Vs 151,151,21
Vs 152,152,21
Vs 153,153,21
Vs 154,154,21
Vs 155,155,21
Vs 156,156,21
Vs 157,157,21
Vs 158,158,21
Vs 159,159,21
Vs 36,36,21
Vs 37,37,21
Vs 38,38,21
v_sub_f32_e64 v39, v39, v21
v_exp_f32 v22, -v21
s_nop 0
Vm 52,52,22
Vm 53,53,22
Vm 54,54,22
v_mul_f32_e64 v55, v55, v22
Ar 8,32
Ar 9,33
Ar 10,34
Ar 11,35
Ar 12,36
Ar 13,37
Ar 14,38
Ar 15,39
Vm 8,8,22
Vm 9,9,22
Vm 10,10,22
Vm 11,11,22
Vm 12,12,22
Vm 13,13,22
Vm 14,14,22
Vm 15,15,22
Aw 32,8
Aw 33,9
Aw 34,10
Aw 35,11
Aw 36,12
Aw 37,13
Aw 38,14
Aw 39,15
Ar 8,40
Ar 9,41
Ar 10,42
Ar 11,43
Ar 12,44
Ar 13,45
Ar 14,46
Ar 15,47
Vm 8,8,22
Vm 9,9,22
Vm 10,10,22
Vm 11,11,22
Vm 12,12,22
Vm 13,13,22
Vm 14,14,22
Vm 15,15,22
Aw 40,8
Aw 41,9
Aw 42,10
Aw 43,11
Aw 44,12
Aw 45,13
Aw 46,14
Aw 47,15
Ar 8,48
Ar 9,49
Ar 10,50
Ar 11,51
Ar 12,52
Ar 13,53
Ar 14,54
Ar 15,55
Vm 8,8,22
Vm 9,9,22
Vm 10,10,22
Vm 11,11,22
Vm 12,12,22
Vm 13,13,22
Vm 14,14,22
Vm 15,15,22
Aw 48,8
Aw 49,9
Aw 50,10
Aw 51,11
Aw 52,12
Aw 53,13
Aw 54,14
Aw 55,15
Ar 8,56
Ar 9,57
Ar 10,58
Ar 11,59
Ar 12,60
Ar 13,61
Ar 14,62
Ar 15,63
Vm 8,8,22
Vm 9,9,22
Vm 10,10,22
Vm 11,11,22
Vm 12,12,22
Vm 13,13,22
Vm 14,14,22
Vm 15,15,22
Aw 56,8
Aw 57,9
Aw 58,10
Aw 59,11
Aw 60,12
Aw 61,13
Aw 62,14
Aw 63,15
Ve 8,192
Ve 9,193
s_nop 0
Vc 96,8,9
Ve 8,194
Ve 9,195
s_nop 0
Vc 97,8,9
Ve 8,208
Ve 9,209
s_nop 0
Vc 104,8,9
Ve 8,210
Ve 9,211
s_nop 0
Vc 105,8,9
Ve 8,196
Ve 9,197
s_nop 0
Vc 98,8,9
Ve 8,198
Ve 9,199
s_nop 0
Vc 99,8,9
Ve 8,212
Ve 9,213
s_nop 0
Vc 106,8,9
Ve 8,214
Ve 9,215
s_nop 0
Vc 107,8,9
Ve 8,200
Ve 9,201
s_nop 0
Vc 100,8,9
Ve 8,202
Ve 9,203
s_nop 0
Vc 101,8,9
Ve 8,216
Ve 9,217
s_nop 0
Vc 108,8,9
Ve 8,218
Ve 9,219
s_nop 0
Vc 109,8,9
Ve 8,204
Ve 9,205
s_nop 0
Vc 102,8,9
Ve 8,206
Ve 9,207
s_nop 0
Vc 103,8,9
Ve 8,220
Ve 9,221
s_nop 0
Vc 110,8,9
Ve 8,222
Ve 9,223
s_nop 0
Vc 111,8,9
s_nop 1
s_branch L_k2_fbr_no
L_k2_fb_nl:
s_nop 7
s_nop 0
v_max3_f32 v21, v128, v129, v130
v_max3_f32 v21, v21, v131, v132
v_max3_f32 v21, v21, v133, v134
v_max3_f32 v21, v21, v135, v136
v_max3_f32 v21, v21, v137, v138
v_max3_f32 v21, v21, v139, v140
v_max3_f32 v21, v21, v141, v142
v_max_f32 v21, v21, v143
v_mov_b32 v1, v21
s_nop 1
v_permlane16_swap_b32 v1, v21
v_max_f32 v21, v21, v1
v_mov_b32 v1, v21
s_nop 1
v_permlane32_swap_b32 v1, v21
v_max_f32_e64 v21, v21, v1
v_add_f32 v21, 0x41f80000, v21
v_max_f32 v21, 0, v21
Vs 128,128,21
Vs 129,129,21
Vs 130,130,21
Vs 131,131,21
Vs 132,132,21
Vs 133,133,21
Vs 134,134,21
Vs 135,135,21
Vs 136,136,21
Vs 137,137,21
Vs 138,138,21
Vs 139,139,21
Vs 140,140,21
Vs 141,141,21
Vs 142,142,21
Vs 143,143,21
Vs 192,192,21
Vs 193,193,21
Vs 194,194,21
Vs 195,195,21
Vs 196,196,21
Vs 197,197,21
Vs 198,198,21
Vs 199,199,21
Vs 200,200,21
Vs 201,201,21
Vs 202,202,21
Vs 203,203,21
Vs 204,204,21
Vs 205,205,21
Vs 206,206,21
Vs 207,207,21
Vs 32,32,21
Vs 33,33,21
Vs 34,34,21
v_sub_f32_e64 v35, v35, v21
v_exp_f32 v22, -v21
s_nop 0
Vm 48,48,22
Vm 49,49,22
Vm 50,50,22
v_mul_f32_e64 v51, v51, v22
Ar 8,0
Ar 9,1
Ar 10,2
Ar 11,3
Ar 12,4
Ar 13,5
Ar 14,6
Ar 15,7
Vm 8,8,22
Vm 9,9,22
Vm 10,10,22
Vm 11,11,22
Vm 12,12,22
Vm 13,13,22
Vm 14,14,22
Vm 15,15,22
Aw 0,8
Aw 1,9
Aw 2,10
Aw 3,11
Aw 4,12
Aw 5,13
Aw 6,14
Aw 7,15
Ar 8,8
Ar 9,9
Ar 10,10
Ar 11,11
Ar 12,12
Ar 13,13
Ar 14,14
Ar 15,15
Vm 8,8,22
Vm 9,9,22
Vm 10,10,22
Vm 11,11,22
Vm 12,12,22
Vm 13,13,22
Vm 14,14,22
Vm 15,15,22
Aw 8,8
Aw 9,9
Aw 10,10
Aw 11,11
Aw 12,12
Aw 13,13
Aw 14,14
Aw 15,15
Ar 8,16
Ar 9,17
Ar 10,18
Ar 11,19
Ar 12,20
Ar 13,21
Ar 14,22
Ar 15,23
Vm 8,8,22
Vm 9,9,22
Vm 10,10,22
Vm 11,11,22
Vm 12,12,22
Vm 13,13,22
Vm 14,14,22
Vm 15,15,22
Aw 16,8
Aw 17,9
Aw 18,10
Aw 19,11
Aw 20,12
Aw 21,13
Aw 22,14
Aw 23,15
Ar 8,24
Ar 9,25
Ar 10,26
Ar 11,27
Ar 12,28
Ar 13,29
Ar 14,30
Ar 15,31
Vm 8,8,22
Vm 9,9,22
Vm 10,10,22
Vm 11,11,22
Vm 12,12,22
Vm 13,13,22
Vm 14,14,22
Vm 15,15,22
Aw 24,8
Aw 25,9
Aw 26,10
Aw 27,11
Aw 28,12
Aw 29,13
Aw 30,14
Aw 31,15
v_max3_f32 v21, v144, v145, v146
v_max3_f32 v21, v21, v147, v148
v_max3_f32 v21, v21, v149, v150
v_max3_f32 v21, v21, v151, v152
v_max3_f32 v21, v21, v153, v154
v_max3_f32 v21, v21, v155, v156
v_max3_f32 v21, v21, v157, v158
v_max_f32 v21, v21, v159
v_mov_b32 v1, v21
s_nop 1
v_permlane16_swap_b32 v1, v21
v_max_f32 v21, v21, v1
v_mov_b32 v1, v21
s_nop 1
v_permlane32_swap_b32 v1, v21
v_max_f32_e64 v21, v21, v1
v_add_f32 v21, 0x41f80000, v21
v_max_f32 v21, 0, v21
Vs 144,144,21
Vs 145,145,21
Vs 146,146,21
Vs 147,147,21
Vs 148,148,21
Vs 149,149,21
Vs 150,150,21
Vs 151,151,21
Vs 152,152,21
Vs 153,153,21
Vs 154,154,21
Vs 155,155,21
Vs 156,156,21
Vs 157,157,21
Vs 158,158,21
Vs 159,159,21
Vs 36,36,21
Vs 37,37,21
Vs 38,38,21
v_sub_f32_e64 v39, v39, v21
v_exp_f32 v22, -v21
s_nop 0
Vm 52,52,22
Vm 53,53,22
Vm 54,54,22
v_mul_f32_e64 v55, v55, v22
Ar 8,32
Ar 9,33
Ar 10,34
Ar 11,35
Ar 12,36
Ar 13,37
Ar 14,38
Ar 15,39
Vm 8,8,22
Vm 9,9,22
Vm 10,10,22
Vm 11,11,22
Vm 12,12,22
Vm 13,13,22
Vm 14,14,22
Vm 15,15,22
Aw 32,8
Aw 33,9
Aw 34,10
Aw 35,11
Aw 36,12
Aw 37,13
Aw 38,14
Aw 39,15
Ar 8,40
Ar 9,41
Ar 10,42
Ar 11,43
Ar 12,44
Ar 13,45
Ar 14,46
Ar 15,47
Vm 8,8,22
Vm 9,9,22
Vm 10,10,22
Vm 11,11,22
Vm 12,12,22
Vm 13,13,22
Vm 14,14,22
Vm 15,15,22
Aw 40,8
Aw 41,9
Aw 42,10
Aw 43,11
Aw 44,12
Aw 45,13
Aw 46,14
Aw 47,15
Ar 8,48
Ar 9,49
Ar 10,50
Ar 11,51
Ar 12,52
Ar 13,53
Ar 14,54
Ar 15,55
Vm 8,8,22
Vm 9,9,22
Vm 10,10,22
Vm 11,11,22
Vm 12,12,22
Vm 13,13,22
Vm 14,14,22
Vm 15,15,22
Aw 48,8
Aw 49,9
Aw 50,10
Aw 51,11
Aw 52,12
Aw 53,13
Aw 54,14
Aw 55,15
Ar 8,56
Ar 9,57
Ar 10,58
Ar 11,59
Ar 12,60
Ar 13,61
Ar 14,62
Ar 15,63
Vm 8,8,22
Vm 9,9,22
Vm 10,10,22
Vm 11,11,22
Vm 12,12,22
Vm 13,13,22
Vm 14,14,22
Vm 15,15,22
Aw 56,8
Aw 57,9
Aw 58,10
Aw 59,11
Aw 60,12
Aw 61,13
Aw 62,14
Aw 63,15
Ve 8,128
Ve 9,129
s_nop 0
Vc 64,8,9
Ve 8,130
Ve 9,131
s_nop 0
Vc 65,8,9
Ve 8,144
Ve 9,145
s_nop 0
Vc 72,8,9
Ve 8,146
Ve 9,147
s_nop 0
Vc 73,8,9
Ve 8,132
Ve 9,133
s_nop 0
Vc 66,8,9
Ve 8,134
Ve 9,135
s_nop 0
Vc 67,8,9
Ve 8,148
Ve 9,149
s_nop 0
Vc 74,8,9
Ve 8,150
Ve 9,151
s_nop 0
Vc 75,8,9
Ve 8,136
Ve 9,137
s_nop 0
Vc 68,8,9
Ve 8,138
Ve 9,139
s_nop 0
Vc 69,8,9
Ve 8,152
Ve 9,153
s_nop 0
Vc 76,8,9
Ve 8,154
Ve 9,155
s_nop 0
Vc 77,8,9
Ve 8,140
Ve 9,141
s_nop 0
Vc 70,8,9
Ve 8,142
Ve 9,143
s_nop 0
Vc 71,8,9
Ve 8,156
Ve 9,157
s_nop 0
Vc 78,8,9
Ve 8,158
Ve 9,159
s_nop 0
Vc 79,8,9
s_nop 1
s_branch L_k2_fbr_nl
L_k2_fb_fi:
s_nop 7
s_nop 0
v_max3_f32 v21, v192, v193, v194
v_max3_f32 v21, v21, v195, v196
v_max3_f32 v21, v21, v197, v198
v_max3_f32 v21, v21, v199, v200
v_max3_f32 v21, v21, v201, v202
v_max3_f32 v21, v21, v203, v204
v_max3_f32 v21, v21, v205, v206
v_max_f32 v21, v21, v207
v_mov_b32 v1, v21
s_nop 1
v_permlane16_swap_b32 v1, v21
v_max_f32 v21, v21, v1
v_mov_b32 v1, v21
s_nop 1
v_permlane32_swap_b32 v1, v21
v_max_f32_e64 v21, v21, v1
v_add_f32 v21, 0x41f80000, v21
v_max_f32 v21, 0, v21
Vs 192,192,21
Vs 193,193,21
Vs 194,194,21
Vs 195,195,21
Vs 196,196,21
Vs 197,197,21
Vs 198,198,21
Vs 199,199,21
Vs 200,200,21
Vs 201,201,21
Vs 202,202,21
Vs 203,203,21
Vs 204,204,21
Vs 205,205,21
Vs 206,206,21
Vs 207,207,21
Vs 32,32,21
Vs 33,33,21
Vs 34,34,21
v_sub_f32_e64 v35, v35, v21
v_exp_f32 v22, -v21
s_nop 0
Vm 48,48,22
Vm 49,49,22
Vm 50,50,22
v_mul_f32_e64 v51, v51, v22
Ar 8,0
Ar 9,1
Ar 10,2
Ar 11,3
Ar 12,4
Ar 13,5
Ar 14,6
Ar 15,7
Vm 8,8,22
Vm 9,9,22
Vm 10,10,22
Vm 11,11,22
Vm 12,12,22
Vm 13,13,22
Vm 14,14,22
Vm 15,15,22
Aw 0,8
Aw 1,9
Aw 2,10
Aw 3,11
Aw 4,12
Aw 5,13
Aw 6,14
Aw 7,15
Ar 8,8
Ar 9,9
Ar 10,10
Ar 11,11
Ar 12,12
Ar 13,13
Ar 14,14
Ar 15,15
Vm 8,8,22
Vm 9,9,22
Vm 10,10,22
Vm 11,11,22
Vm 12,12,22
Vm 13,13,22
Vm 14,14,22
Vm 15,15,22
Aw 8,8
Aw 9,9
Aw 10,10
Aw 11,11
Aw 12,12
Aw 13,13
Aw 14,14
Aw 15,15
Ar 8,16
Ar 9,17
Ar 10,18
Ar 11,19
Ar 12,20
Ar 13,21
Ar 14,22
Ar 15,23
Vm 8,8,22
Vm 9,9,22
Vm 10,10,22
Vm 11,11,22
Vm 12,12,22
Vm 13,13,22
Vm 14,14,22
Vm 15,15,22
Aw 16,8
Aw 17,9
Aw 18,10
Aw 19,11
Aw 20,12
Aw 21,13
Aw 22,14
Aw 23,15
Ar 8,24
Ar 9,25
Ar 10,26
Ar 11,27
Ar 12,28
Ar 13,29
Ar 14,30
Ar 15,31
Vm 8,8,22
Vm 9,9,22
Vm 10,10,22
Vm 11,11,22
Vm 12,12,22
Vm 13,13,22
Vm 14,14,22
Vm 15,15,22
Aw 24,8
Aw 25,9
Aw 26,10
Aw 27,11
Aw 28,12
Aw 29,13
Aw 30,14
Aw 31,15
Ve 8,192
Ve 9,193
s_nop 0
Vc 96,8,9
Ve 8,194
Ve 9,195
s_nop 0
Vc 97,8,9
Ve 8,196
Ve 9,197
s_nop 0
Vc 98,8,9
Ve 8,198
Ve 9,199
s_nop 0
Vc 99,8,9
Ve 8,200
Ve 9,201
s_nop 0
Vc 100,8,9
Ve 8,202
Ve 9,203
s_nop 0
Vc 101,8,9
Ve 8,204
Ve 9,205
s_nop 0
Vc 102,8,9
Ve 8,206
Ve 9,207
s_nop 0
Vc 103,8,9
s_nop 1
s_branch L_k2_fbr_fi
L_spinX:
s_mov_b32 s47, 0x400000
L_spinXl:
buffer_load_dword v17, v126, s[20:23], s24 offen sc1
s_sub_u32 s47, s47, 1
s_waitcnt vmcnt(0)
s_cmp_eq_u32 s47, 0
s_cbranch_scc1 L_spinXlx
v_cmp_ne_u32 vcc, 1, v17
s_cbranch_vccz L_spinXlx
s_sleep 1
s_branch L_spinXl
L_spinXlx:
buffer_load_dwordx4 v[160:163], v112, s[16:19], s25 offen offset:0 sc1
buffer_load_dwordx4 v[164:167], v112, s[16:19], s25 offen offset:1024 sc1
buffer_load_dwordx4 v[168:171], v112, s[16:19], s25 offen offset:2048 sc1
buffer_load_dwordx4 v[172:175], v112, s[16:19], s25 offen offset:3072 sc1
buffer_load_dwordx4 v[176:179], v10, s[16:19], s25 offen offset:0 sc1
buffer_load_dwordx4 v[180:183], v10, s[16:19], s25 offen offset:1024 sc1
buffer_load_dwordx4 v[184:187], v10, s[16:19], s25 offen offset:2048 sc1
buffer_load_dwordx4 v[188:191], v10, s[16:19], s25 offen offset:3072 sc1
s_branch L_spinXr
L_ysl:
s_mov_b32 s47, 0x400000
L_ysll:
buffer_load_dword v124, v127, s[20:23], s41 offen sc1
s_sub_u32 s47, s47, 1
s_waitcnt vmcnt(0)
s_cmp_eq_u32 s47, 0
s_cbranch_scc1 L_ysllx
v_cmp_ne_u32 vcc, 1, v124
s_cbranch_vccz L_ysllx
s_sleep 8
s_branch L_ysll
L_ysllx:
v_lshlrev_b32 v124, 2, v0
v_lshlrev_b32 v125, 1, v0
s_lshl_b32 s7, s45, 2
s_add_u32 s7, s7, s32
s_lshr_b32 s3, s42, 5
s_cmp_lg_u32 s3, s7
s_cbranch_scc1 L_f_yl13
s_add_u32 s3, s55, 0
s_nop 0
s_add_u32 s7, s3, 4096
buffer_load_dword v76, v124, s[20:23], s3 offen offset:0 sc1
buffer_load_dword v77, v124, s[20:23], s3 offen offset:512 sc1
buffer_load_dword v78, v124, s[20:23], s3 offen offset:1024 sc1
buffer_load_dword v79, v124, s[20:23], s3 offen offset:1536 sc1
buffer_load_dword v80, v124, s[20:23], s3 offen offset:2048 sc1
buffer_load_dword v81, v124, s[20:23], s3 offen offset:2560 sc1
buffer_load_dword v82, v124, s[20:23], s3 offen offset:3072 sc1
buffer_load_dword v83, v124, s[20:23], s3 offen offset:3584 sc1
buffer_load_dword v84, v124, s[20:23], s7 offen offset:0 sc1
buffer_load_dword v85, v124, s[20:23], s7 offen offset:512 sc1
buffer_load_dword v86, v124, s[20:23], s7 offen offset:1024 sc1
buffer_load_dword v87, v124, s[20:23], s7 offen offset:1536 sc1
buffer_load_dword v88, v124, s[20:23], s7 offen offset:2048 sc1
buffer_load_dword v89, v124, s[20:23], s7 offen offset:2560 sc1
s_lshl_b32 s3, s42, 11
s_lshl_b32 s7, s46, 7
s_add_u32 s3, s3, s7
buffer_load_ushort v90, v125, s[56:59], s3 offen
s_lshl_b32 s3, s42, 3
s_add_u32 s3, s3, 5259264
buffer_load_dwordx2 v[92:93], v126, s[20:23], s3 offen sc1
L_f_yl13:
s_lshl_b32 s7, s45, 2
s_add_u32 s7, s7, s32
s_lshr_b32 s3, s43, 5
s_cmp_lg_u32 s3, s7
s_cbranch_scc1 L_f_yl14
s_nop 0
s_add_u32 s3, s55, 256
s_add_u32 s7, s3, 4096
buffer_load_dword v94, v124, s[20:23], s3 offen offset:0 sc1
buffer_load_dword v95, v124, s[20:23], s3 offen offset:512 sc1
buffer_load_dword v96, v124, s[20:23], s3 offen offset:1024 sc1
buffer_load_dword v97, v124, s[20:23], s3 offen offset:1536 sc1
buffer_load_dword v98, v124, s[20:23], s3 offen offset:2048 sc1
buffer_load_dword v99, v124, s[20:23], s3 offen offset:2560 sc1
buffer_load_dword v100, v124, s[20:23], s3 offen offset:3072 sc1
buffer_load_dword v101, v124, s[20:23], s3 offen offset:3584 sc1
buffer_load_dword v102, v124, s[20:23], s7 offen offset:0 sc1
buffer_load_dword v103, v124, s[20:23], s7 offen offset:512 sc1
buffer_load_dword v104, v124, s[20:23], s7 offen offset:1024 sc1
buffer_load_dword v105, v124, s[20:23], s7 offen offset:1536 sc1
buffer_load_dword v106, v124, s[20:23], s7 offen offset:2048 sc1
buffer_load_dword v107, v124, s[20:23], s7 offen offset:2560 sc1
s_lshl_b32 s3, s43, 11
s_lshl_b32 s7, s46, 7
s_add_u32 s3, s3, s7
buffer_load_ushort v108, v125, s[56:59], s3 offen
s_lshl_b32 s3, s43, 3
s_add_u32 s3, s3, 5259264
buffer_load_dwordx2 v[110:111], v126, s[20:23], s3 offen sc1
L_f_yl14:
s_waitcnt vmcnt(0)
s_lshl_b32 s7, s45, 2
s_add_u32 s7, s7, s32
s_lshr_b32 s3, s42, 5
s_cmp_lg_u32 s3, s7
s_cbranch_scc1 L_f_ys15
v_pk_add_f32 v[76:77], v[76:77], v[78:79]
v_pk_add_f32 v[76:77], v[76:77], v[80:81]
v_pk_add_f32 v[76:77], v[76:77], v[82:83]
v_pk_add_f32 v[76:77], v[76:77], v[84:85]
v_pk_add_f32 v[76:77], v[76:77], v[86:87]
v_pk_add_f32 v[76:77], v[76:77], v[88:89]
Va 76,76,77
v_lshlrev_b32 v90, 16, v90
v_sub_f32_e64 v90, v90, v92
Vc 76,76,76
v_lshlrev_b32_e64 v76, 16, v76
Vc 90,90,90
v_lshlrev_b32 v90, 16, v90
v_mul_f32 v76, s100, v76
v_mul_f32_e64 v90, v90, v93
Vc 76,76,76
v_lshlrev_b32_e64 v76, 16, v76
Vc 90,90,90
v_lshlrev_b32 v90, 16, v90
Va 90,90,76
Vc 90,90,90
v_lshlrev_b32_e64 v90, 16, v90
v_mul_f32 v76, 0xbfb8aa3b, v90
Ve 76,76
s_nop 0
v_add_f32 v76, 1.0, v76
v_rcp_f32 v76, v76
s_nop 0
Vm 90,90,76
Vc 90,90,90
v_lshlrev_b32 v90, 16, v90
v_lshlrev_b32 v124, 2, v0
v_add_u32 v124, s35, v124
v_lshlrev_b32 v125, 5, v122
v_add_u32 v125, s35, v125
s_waitcnt lgkmcnt(0)
ds_write_b32 v124, v90
s_and_b32 s3, s42, 7
s_lshl_b32 s3, s3, 3
s_lshl_b64 s[4:5], 0xff, s3
s_bfe_u32 s3, s42, 0x20003
s_mov_b64 exec, s[4:5]
s_cmp_lg_u32 s3, 0
s_cbranch_scc1 L_f_yp16
ds_read_b64 v[42:43], v125
ds_read_b64 v[44:45], v125 offset:8
ds_read_b64 v[46:47], v125 offset:16
ds_read_b64 v[48:49], v125 offset:24
L_f_yp16:
s_cmp_lg_u32 s3, 1
s_cbranch_scc1 L_f_yp17
ds_read_b64 v[50:51], v125
ds_read_b64 v[52:53], v125 offset:8
ds_read_b64 v[54:55], v125 offset:16
ds_read_b64 v[56:57], v125 offset:24
L_f_yp17:
s_cmp_lg_u32 s3, 2
s_cbranch_scc1 L_f_yp18
ds_read_b64 v[58:59], v125
ds_read_b64 v[60:61], v125 offset:8
ds_read_b64 v[62:63], v125 offset:16
ds_read_b64 v[64:65], v125 offset:24
L_f_yp18:
s_cmp_lg_u32 s3, 3
s_cbranch_scc1 L_f_yp19
ds_read_b64 v[66:67], v125
ds_read_b64 v[68:69], v125 offset:8
s_waitcnt lgkmcnt(9)
ds_read_b64 v[70:71], v125 offset:16
ds_read_b64 v[72:73], v125 offset:24
L_f_yp19:
s_mov_b64 exec, -1
s_waitcnt lgkmcnt(0)
L_f_ys15:
s_lshl_b32 s7, s45, 2
s_add_u32 s7, s7, s32
s_lshr_b32 s3, s43, 5
s_cmp_lg_u32 s3, s7
s_cbranch_scc1 L_f_ys20
s_nop 0
v_pk_add_f32 v[94:95], v[94:95], v[96:97]
v_pk_add_f32 v[94:95], v[94:95], v[98:99]
v_pk_add_f32 v[94:95], v[94:95], v[100:101]
v_pk_add_f32 v[94:95], v[94:95], v[102:103]
v_pk_add_f32 v[94:95], v[94:95], v[104:105]
v_pk_add_f32 v[94:95], v[94:95], v[106:107]
Va 94,94,95
v_lshlrev_b32 v108, 16, v108
v_sub_f32_e64 v108, v108, v110
Vc 94,94,94
v_lshlrev_b32_e64 v94, 16, v94
Vc 108,108,108
v_lshlrev_b32 v108, 16, v108
v_mul_f32 v94, s101, v94
v_mul_f32_e64 v108, v108, v111
Vc 94,94,94
v_lshlrev_b32_e64 v94, 16, v94
Vc 108,108,108
v_lshlrev_b32 v108, 16, v108
Va 108,108,94
Vc 108,108,108
v_lshlrev_b32_e64 v108, 16, v108
v_mul_f32 v94, 0xbfb8aa3b, v108
Ve 94,94
s_nop 0
v_add_f32 v94, 1.0, v94
v_rcp_f32 v94, v94
s_nop 0
Vm 108,108,94
Vc 108,108,108
v_lshlrev_b32 v108, 16, v108
v_lshlrev_b32 v124, 2, v0
v_add_u32 v124, s35, v124
v_lshlrev_b32 v125, 5, v122
v_add_u32 v125, s35, v125
s_waitcnt lgkmcnt(0)
ds_write_b32 v124, v108
s_and_b32 s3, s43, 7
s_lshl_b32 s3, s3, 3
s_lshl_b64 s[4:5], 0xff, s3
s_bfe_u32 s3, s43, 0x20003
s_mov_b64 exec, s[4:5]
s_cmp_lg_u32 s3, 0
s_cbranch_scc1 L_f_yp21
ds_read_b64 v[42:43], v125
ds_read_b64 v[44:45], v125 offset:8
ds_read_b64 v[46:47], v125 offset:16
ds_read_b64 v[48:49], v125 offset:24
L_f_yp21:
s_cmp_lg_u32 s3, 1
s_cbranch_scc1 L_f_yp22
ds_read_b64 v[50:51], v125
ds_read_b64 v[52:53], v125 offset:8
ds_read_b64 v[54:55], v125 offset:16
ds_read_b64 v[56:57], v125 offset:24
L_f_yp22:
s_cmp_lg_u32 s3, 2
s_cbranch_scc1 L_f_yp23
ds_read_b64 v[58:59], v125
ds_read_b64 v[60:61], v125 offset:8
ds_read_b64 v[62:63], v125 offset:16
ds_read_b64 v[64:65], v125 offset:24
L_f_yp23:
s_cmp_lg_u32 s3, 3
s_cbranch_scc1 L_f_yp24
ds_read_b64 v[66:67], v125
ds_read_b64 v[68:69], v125 offset:8
s_waitcnt lgkmcnt(9)
ds_read_b64 v[70:71], v125 offset:16
ds_read_b64 v[72:73], v125 offset:24
L_f_yp24:
s_mov_b64 exec, -1
s_waitcnt lgkmcnt(0)
L_f_ys20:
s_branch L_yslr
.section .rodata,"a"
.p2align 6
.amdhsa_kernel recurrent_scan__compressed_kv_cla__moe_arch_mod__prompt_kernel
  .amdhsa_next_free_vgpr 512
  .amdhsa_next_free_sgpr 102
  .amdhsa_accum_offset 256
  .amdhsa_group_segment_fixed_size 0
  .amdhsa_kernarg_size 112
  .amdhsa_user_sgpr_count 2
  .amdhsa_user_sgpr_kernarg_segment_ptr 1
  .amdhsa_system_sgpr_workgroup_id_x 1
.end_amdhsa_kernel
```

```asm
; @launch grid=(256,1,1) block=(256,1,1) lds=163840
.amdgcn_target "amdgcn-amd-amdhsa--gfx950"
.macro Va d,x,y
v_add_f32 v\d, v\x, v\y
.endm
.macro Vc d,x,y
v_cvt_pk_bf16_f32 v\d, v\x, v\y
.endm
.macro Ra d,x,o
ds_read_b128 a[\d:\d+3], v\x offset:\o
.endm
.macro Ta d,x,o
ds_read_b64_tr_b16 a[\d:\d+1], v\x offset:\o
.endm
.macro Zvaa d,x,y
v_mfma_f32_16x16x32_bf16 v[\d:\d+3], a[\x:\x+3], a[\y:\y+3], 0
.endm
.macro Mvaa d,x,y
v_mfma_f32_16x16x32_bf16 v[\d:\d+3], a[\x:\x+3], a[\y:\y+3], v[\d:\d+3]
.endm
.macro Rv d,x,o
ds_read_b128 v[\d:\d+3], v\x offset:\o
.endm
.macro Zaaa d,x,y
v_mfma_f32_16x16x32_bf16 a[\d:\d+3], a[\x:\x+3], a[\y:\y+3], 0
.endm
.macro Maaa d,x,y
v_mfma_f32_16x16x32_bf16 a[\d:\d+3], a[\x:\x+3], a[\y:\y+3], a[\d:\d+3]
.endm
.macro Ar d,x
v_accvgpr_read_b32 v\d, a\x
.endm
.macro VE d,x
v_exp_f32_e64 v\d, v\x
.endm
.macro Ve d,x
v_exp_f32 v\d, v\x
.endm
.macro Aw d,x
v_accvgpr_write_b32 a\d, v\x
.endm
.macro Vs d,x,y
v_sub_f32 v\d, v\x, v\y
.endm
.macro Cvaa d,x,y,c
v_mfma_f32_16x16x32_bf16 v[\d:\d+3], a[\x:\x+3], a[\y:\y+3], v[\c:\c+3]
.endm
.macro Maav d,x,y
v_mfma_f32_16x16x32_bf16 a[\d:\d+3], a[\x:\x+3], v[\y:\y+3], a[\d:\d+3]
.endm
.macro Mvvv d,x,y
v_mfma_f32_16x16x32_bf16 v[\d:\d+3], v[\x:\x+3], v[\y:\y+3], v[\d:\d+3]
.endm
.macro Zvva d,x,y
v_mfma_f32_16x16x32_bf16 v[\d:\d+3], v[\x:\x+3], a[\y:\y+3], 0
.endm
.macro Mvva d,x,y
v_mfma_f32_16x16x32_bf16 v[\d:\d+3], v[\x:\x+3], a[\y:\y+3], v[\d:\d+3]
.endm
.macro Vm d,x,y
v_mul_f32 v\d, v\x, v\y
.endm
.macro Zvvv d,x,y
v_mfma_f32_16x16x32_bf16 v[\d:\d+3], v[\x:\x+3], v[\y:\y+3], 0
.endm
.text
.globl recurrent_scan__compressed_kv_cla__moe_arch_mod__prompt_kernel
.p2align 8
.type recurrent_scan__compressed_kv_cla__moe_arch_mod__prompt_kernel,@function
recurrent_scan__compressed_kv_cla__moe_arch_mod__prompt_kernel:
s_cmp_ge_u32 s2, 256
s_cbranch_scc1 L_k2_end
s_load_dwordx4 s[4:7], s[0:1], 0
s_load_dwordx2 s[44:45], s[0:1], 56
s_load_dwordx4 s[40:43], s[0:1], 24
s_load_dwordx4 s[64:67], s[0:1], 96
v_lshrrev_b32 v1, 6, v0
v_and_b32 v0, 63, v0
v_readfirstlane_b32 s32, v1
s_getpc_b64 s[68:69]
L_cpf1:
s_add_u32 s68, s68, (recurrent_scan__compressed_kv_cla__moe_arch_mod__prompt_kernel-L_cpf1)&0xffffffff
s_addc_u32 s69, s69, ((recurrent_scan__compressed_kv_cla__moe_arch_mod__prompt_kernel-L_cpf1)>>32)&0xffffffff
s_lshr_b32 s70, s2, 3
s_lshl_b32 s70, s70, 2
s_add_u32 s70, s70, s32
s_lshl_b32 s70, s70, 10
v_and_b32 v122, 7, v0
v_lshlrev_b32 v122, 7, v122
v_add_u32 v122, s70, v122
v_min_u32 v122, L_k2_fin-recurrent_scan__compressed_kv_cla__moe_arch_mod__prompt_kernel-4, v122
v_mov_b32 v121, s69
v_add_co_u32 v120, vcc, s68, v122
s_nop 1
v_addc_co_u32 v121, vcc, 0, v121, vcc
global_load_dword v124, v[120:121], off
v_lshrrev_b32 v33, 5, v0
v_and_b32 v31, 31, v0
v_lshlrev_b32_e64 v36, 4, v31
v_lshl_add_u32 v35, v33, 11, v36
s_lshl_b32 s36, s2, 14
s_lshl_b32 s37, s32, 12
s_add_u32 s36, s36, s37
s_mov_b32 s18, 4194304
s_mov_b32 s19, 0x20000
s_bfe_u32 s33, s2, 0x30003
s_lshr_b32 s35, s2, 7
s_bfe_u32 s3, s2, 0x10006
s_and_b32 s34, s2, 7
s_lshl_b32 s34, s34, 1
s_add_u32 s34, s34, s3
s_waitcnt lgkmcnt(0)
s_mov_b32 s16, s4
s_and_b32 s17, s5, 0xffff
buffer_load_dwordx4 v[48:51], v35, s[16:19], s36 offen offset:0
buffer_load_dwordx4 v[52:55], v35, s[16:19], s36 offen offset:512
buffer_load_dwordx4 v[56:59], v35, s[16:19], s36 offen offset:1024
buffer_load_dwordx4 v[60:63], v35, s[16:19], s36 offen offset:1536
s_cmp_eq_u32 s35, 0
s_cselect_b32 s40, s40, s42
s_cselect_b32 s41, s41, s43
s_lshl_b32 s3, s34, 9
s_add_u32 s12, s40, s3
s_addc_u32 s13, s41, 0
s_and_b32 s13, s13, 0xffff
s_mov_b32 s14, 0
s_mov_b32 s15, 0x20000
s_sub_u32 s14, 4194304, s3
s_lshl_b32 s3, s33, 18
s_add_u32 s8, s6, s3
s_addc_u32 s9, s7, 0
s_and_b32 s9, s9, 0xffff
s_mov_b32 s10, 262144
s_mov_b32 s11, 0x20000
s_and_b32 s58, s2, 7
s_mov_b32 s52, 0
s_mov_b32 s53, 15360
s_mov_b32 s54, 30720
s_mov_b32 s55, 46080
s_lshl_b32 s57, s32, 13
s_add_u32 s56, s57, 32768
s_lshl_b32 s3, s58, 2
s_add_u32 s3, s3, s32
s_lshl_b32 s3, s3, 4
v_add_u32 v30, s3, v33
v_lshlrev_b32 v30, 13, v30
v_lshlrev_b32 v34, 5, v33
v_xor_b32 v34, v34, v36
v_add_u32 v6, v34, v30
v_xor_b32_e64 v7, 64, v6
v_xor_b32 v8, 65664, v6
v_xor_b32 v9, 65728, v6
s_add_u32 m0, s57, 0
s_nop 0
buffer_load_dwordx4 v6, s[12:15], s52 offen offset:0 lds
buffer_load_dwordx4 v7, s[12:15], s53 offen offset:1024 lds
buffer_load_dwordx4 v6, s[12:15], s54 offen offset:2048 lds
buffer_load_dwordx4 v7, s[12:15], s55 offen offset:3072 lds
s_add_u32 m0, s57, 4096
s_nop 0
s_nop 0
buffer_load_dwordx4 v8, s[12:15], s52 offen offset:0 lds
buffer_load_dwordx4 v9, s[12:15], s53 offen offset:1024 lds
buffer_load_dwordx4 v8, s[12:15], s54 offen offset:2048 lds
buffer_load_dwordx4 v9, s[12:15], s55 offen offset:3072 lds
v_xor_b32 v6, 524288, v6
v_xor_b32 v7, 524288, v7
v_xor_b32 v8, 524288, v8
v_xor_b32 v9, 524288, v9
s_mov_b32 s48, 0
s_mov_b32 s49, 7168
s_mov_b32 s50, 14336
s_mov_b32 s51, 21504
v_lshrrev_b32 v30, 3, v0
v_lshlrev_b32 v30, 10, v30
s_lshl_b32 s3, s32, 16
s_lshl_b32 s39, s58, 7
s_add_u32 s3, s3, s39
v_and_b32 v31, 7, v0
v_lshrrev_b32 v32, 4, v0
v_xor_b32_e64 v31, v31, v32
v_lshl_add_u32 v30, v31, 4, v30
v_add_u32 v2, s3, v30
v_xor_b32 v3, 64, v2
v_xor_b32 v4, 32768, v2
v_xor_b32 v5, 32832, v2
s_cmp_lt_u32 s32, 2
s_cselect_b32 s60, s8, s12
s_cselect_b32 s61, s9, s13
s_cselect_b32 s62, s10, s14
s_mov_b32 s63, 0x20000
s_mov_b32 s59, 524288
s_cselect_b32 s59, 128, s59
s_cselect_b64 vcc, -1, 0
s_cselect_b32 s38, 32, 16
s_lshr_b32 s3, s2, 6
s_cmp_lt_u32 s32, 2
s_cselect_b32 s3, s3, s33
s_lshl_b32 s3, s3, 1
s_and_b32 s39, s32, 1
s_add_u32 s3, s3, s39
s_lshl_b32 s3, s3, 15
s_xor_b32 s39, s58, 2
s_mul_i32 s39, s39, s59
s_add_u32 s3, s3, s39
v_lshlrev_b32 v37, 10, v0
v_lshrrev_b32 v38, 2, v0
v_lshlrev_b32 v38, 13, v38
v_and_b32 v39, 3, v0
v_lshl_add_u32 v38, v39, 7, v38
v_cndmask_b32 v47, v38, v37, vcc
v_add_u32 v47, s3, v47
v_cmp_gt_u32 vcc, s38, v0
v_mov_b32 v37, 2146435072
s_nop 0
v_cndmask_b32 v47, v37, v47, vcc
s_mov_b32 s20, s66
s_and_b32 s21, s67, 0xffff
s_mov_b32 s22, 8388608
s_mov_b32 s23, 0x20000
s_add_u32 s24, s66, 8388608
s_addc_u32 s25, s67, 0
s_and_b32 s25, s25, 0xffff
s_mov_b32 s26, 35717120
s_mov_b32 s27, 0x20000
v_lshrrev_b32 v32, 4, v0
v_and_b32 v30, 15, v0
s_lshr_b32 s3, s32, 1
s_lshl_b32 s3, s3, 14
s_add_u32 s3, s3, 32768
v_lshlrev_b32 v31, 7, v30
v_add_u32 v31, s3, v31
v_lshrrev_b32 v34, 1, v30
v_xor_b32_e64 v34, v34, v32
v_lshl_add_u32 v10, v34, 4, v31
v_xor_b32 v11, 64, v10
v_lshrrev_b32 v30, 2, v30
v_lshl_add_u32 v31, v32, 3, v30
v_lshlrev_b32 v31, 9, v31
v_and_b32 v34, 3, v0
v_lshl_add_u32 v31, v34, 3, v31
s_and_b32 s3, s32, 1
s_lshl_b32 s3, s3, 8
v_add_u32 v31, s3, v31
v_and_b32 v34, 1, v32
v_lshl_add_u32 v30, v34, 2, v30
v_lshl_add_u32 v16, v30, 5, v31
v_xor_b32 v17, 32, v16
v_xor_b32 v18, 64, v16
v_xor_b32 v19, 96, v16
v_xor_b32 v20, 128, v16
v_xor_b32 v21, 160, v16
v_xor_b32 v22, 192, v16
v_xor_b32 v23, 224, v16
v_add_u32 v12, 65536, v10
v_add_u32 v13, 65536, v11
v_add_u32 v14, 65536, v16
v_add_u32 v15, 65536, v17
v_add_u32 v24, 65536, v18
v_add_u32 v25, 65536, v19
v_add_u32 v26, 65536, v20
v_add_u32 v27, 65536, v21
v_add_u32 v28, 65536, v22
v_add_u32 v29, 65536, v23
s_mov_b32 s28, s44
s_nop 0
s_and_b32 s29, s45, 0xffff
s_mov_b32 s30, 2048
s_mov_b32 s31, 0x20000
buffer_load_dwordx4 v[64:67], v36, s[28:31], 0 offen offset:0
buffer_load_dwordx4 v[68:71], v36, s[28:31], 0 offen offset:512
buffer_load_dwordx4 v[72:75], v36, s[28:31], 0 offen offset:1024
buffer_load_dwordx4 v[76:79], v36, s[28:31], 0 offen offset:1536
s_waitcnt vmcnt(12)
v_lshlrev_b32 v80, 16, v48
v_and_b32 v81, 0xffff0000, v48
v_lshlrev_b32_e64 v82, 16, v49
v_and_b32 v83, 0xffff0000, v49
v_lshlrev_b32_e64 v84, 16, v50
v_and_b32 v85, 0xffff0000, v50
v_lshlrev_b32_e64 v86, 16, v51
v_and_b32 v87, 0xffff0000, v51
v_lshlrev_b32_e64 v88, 16, v52
v_and_b32 v89, 0xffff0000, v52
v_lshlrev_b32_e64 v90, 16, v53
v_and_b32 v91, 0xffff0000, v53
v_lshlrev_b32_e64 v92, 16, v54
v_and_b32 v93, 0xffff0000, v54
v_lshlrev_b32_e64 v94, 16, v55
v_and_b32 v95, 0xffff0000, v55
v_lshlrev_b32_e64 v96, 16, v56
v_and_b32 v97, 0xffff0000, v56
v_lshlrev_b32_e64 v98, 16, v57
v_and_b32 v99, 0xffff0000, v57
v_lshlrev_b32_e64 v100, 16, v58
v_and_b32 v101, 0xffff0000, v58
v_lshlrev_b32_e64 v102, 16, v59
v_and_b32 v103, 0xffff0000, v59
v_lshlrev_b32_e64 v104, 16, v60
v_and_b32 v105, 0xffff0000, v60
v_lshlrev_b32_e64 v106, 16, v61
v_and_b32 v107, 0xffff0000, v61
v_lshlrev_b32_e64 v108, 16, v62
v_and_b32 v109, 0xffff0000, v62
v_lshlrev_b32_e64 v110, 16, v63
v_and_b32 v111, 0xffff0000, v63
v_pk_add_f32 v[40:41], v[80:81], v[82:83]
v_pk_add_f32 v[42:43], v[84:85], v[86:87]
v_pk_add_f32 v[40:41], v[40:41], v[88:89]
v_pk_add_f32 v[42:43], v[42:43], v[90:91]
v_pk_add_f32 v[40:41], v[40:41], v[92:93]
v_pk_add_f32 v[42:43], v[42:43], v[94:95]
v_pk_add_f32 v[40:41], v[40:41], v[96:97]
v_pk_add_f32 v[42:43], v[42:43], v[98:99]
v_pk_add_f32 v[40:41], v[40:41], v[100:101]
v_pk_add_f32 v[42:43], v[42:43], v[102:103]
v_pk_add_f32 v[40:41], v[40:41], v[104:105]
v_pk_add_f32 v[42:43], v[42:43], v[106:107]
v_pk_add_f32 v[40:41], v[40:41], v[108:109]
v_pk_add_f32 v[42:43], v[42:43], v[110:111]
v_pk_add_f32 v[40:41], v[40:41], v[42:43]
Va 38,40,41
s_nop 1
v_add_f32_dpp v38, v38, v38 quad_perm:[1,0,3,2] row_mask:0xf bank_mask:0xf
s_nop 1
v_add_f32_dpp v38, v38, v38 quad_perm:[2,3,0,1] row_mask:0xf bank_mask:0xf
s_nop 1
v_add_f32_dpp v38, v38, v38 row_half_mirror row_mask:0xf bank_mask:0xf
s_nop 1
v_add_f32_dpp v38, v38, v38 row_mirror row_mask:0xf bank_mask:0xf
v_mov_b32 v37, v38
s_nop 1
v_permlane16_swap_b32 v37, v38
Va 38,38,37
s_add_u32 m0, s56, 0
s_nop 0
buffer_load_dwordx4 v2, s[8:11], s48 offen offset:0 lds
buffer_load_dwordx4 v3, s[8:11], s49 offen offset:1024 lds
buffer_load_dwordx4 v2, s[8:11], s50 offen offset:2048 lds
buffer_load_dwordx4 v3, s[8:11], s51 offen offset:3072 lds
s_add_u32 m0, s56, 4096
s_nop 0
buffer_load_dwordx4 v4, s[8:11], s48 offen offset:0 lds
buffer_load_dwordx4 v5, s[8:11], s49 offen offset:1024 lds
buffer_load_dwordx4 v4, s[8:11], s50 offen offset:2048 lds
buffer_load_dwordx4 v5, s[8:11], s51 offen offset:3072 lds
v_xor_b32 v2, 128, v2
v_xor_b32 v3, 128, v3
v_xor_b32 v4, 128, v4
v_xor_b32 v5, 128, v5
v_mul_f32 v38, 0xba800000, v38
v_mov_b32_e64 v39, v38
v_pk_add_f32 v[112:113], v[80:81], v[38:39]
v_pk_mul_f32 v[40:41], v[112:113], v[112:113]
v_pk_add_f32 v[114:115], v[82:83], v[38:39]
v_pk_mul_f32 v[42:43], v[114:115], v[114:115]
v_pk_add_f32 v[116:117], v[84:85], v[38:39]
v_pk_fma_f32 v[40:41], v[116:117], v[116:117], v[40:41]
v_pk_add_f32 v[118:119], v[86:87], v[38:39]
v_pk_fma_f32 v[42:43], v[118:119], v[118:119], v[42:43]
v_pk_add_f32 v[112:113], v[88:89], v[38:39]
v_pk_fma_f32 v[40:41], v[112:113], v[112:113], v[40:41]
v_pk_add_f32 v[114:115], v[90:91], v[38:39]
v_pk_fma_f32 v[42:43], v[114:115], v[114:115], v[42:43]
v_pk_add_f32 v[116:117], v[92:93], v[38:39]
v_pk_fma_f32 v[40:41], v[116:117], v[116:117], v[40:41]
v_pk_add_f32 v[118:119], v[94:95], v[38:39]
v_pk_fma_f32 v[42:43], v[118:119], v[118:119], v[42:43]
v_pk_add_f32 v[112:113], v[96:97], v[38:39]
v_pk_fma_f32 v[40:41], v[112:113], v[112:113], v[40:41]
v_pk_add_f32 v[114:115], v[98:99], v[38:39]
v_pk_fma_f32 v[42:43], v[114:115], v[114:115], v[42:43]
v_pk_add_f32 v[116:117], v[100:101], v[38:39]
v_pk_fma_f32 v[40:41], v[116:117], v[116:117], v[40:41]
v_pk_add_f32 v[118:119], v[102:103], v[38:39]
v_pk_fma_f32 v[42:43], v[118:119], v[118:119], v[42:43]
v_pk_add_f32 v[112:113], v[104:105], v[38:39]
v_pk_fma_f32 v[40:41], v[112:113], v[112:113], v[40:41]
v_pk_add_f32 v[114:115], v[106:107], v[38:39]
v_pk_fma_f32 v[42:43], v[114:115], v[114:115], v[42:43]
v_pk_add_f32 v[116:117], v[108:109], v[38:39]
v_pk_fma_f32 v[40:41], v[116:117], v[116:117], v[40:41]
v_pk_add_f32 v[118:119], v[110:111], v[38:39]
v_pk_fma_f32 v[42:43], v[118:119], v[118:119], v[42:43]
v_pk_add_f32 v[40:41], v[40:41], v[42:43]
Va 40,40,41
s_nop 1
v_add_f32_dpp v40, v40, v40 quad_perm:[1,0,3,2] row_mask:0xf bank_mask:0xf
s_nop 1
v_add_f32_dpp v40, v40, v40 quad_perm:[2,3,0,1] row_mask:0xf bank_mask:0xf
s_nop 1
v_add_f32_dpp v40, v40, v40 row_half_mirror row_mask:0xf bank_mask:0xf
s_nop 1
v_add_f32_dpp v40, v40, v40 row_mirror row_mask:0xf bank_mask:0xf
v_mov_b32 v37, v40
s_nop 1
v_permlane16_swap_b32 v37, v40
v_add_f32_e64 v40, v40, v37
v_mul_f32 v40, 0x3a800000, v40
Vc 44,38,40
v_lshlrev_b32_e64 v38, 16, v44
v_and_b32 v40, 0xffff0000, v44
v_add_f32 v40, 0x3727c5ac, v40
Vc 44,40,40
v_lshlrev_b32 v40, 16, v44
v_sqrt_f32 v40, v40
v_mov_b32_e64 v39, v38
Vc 44,40,40
v_lshlrev_b32 v44, 16, v44
v_rcp_f32 v40, v44
v_pk_add_f32 v[80:81], v[80:81], v[38:39]
v_pk_add_f32 v[82:83], v[82:83], v[38:39]
v_pk_add_f32 v[84:85], v[84:85], v[38:39]
v_pk_add_f32 v[86:87], v[86:87], v[38:39]
v_pk_add_f32 v[88:89], v[88:89], v[38:39]
v_pk_add_f32 v[90:91], v[90:91], v[38:39]
v_pk_add_f32 v[92:93], v[92:93], v[38:39]
v_pk_add_f32 v[94:95], v[94:95], v[38:39]
v_pk_add_f32 v[96:97], v[96:97], v[38:39]
v_pk_add_f32 v[98:99], v[98:99], v[38:39]
v_pk_add_f32 v[100:101], v[100:101], v[38:39]
v_pk_add_f32 v[102:103], v[102:103], v[38:39]
v_pk_add_f32 v[104:105], v[104:105], v[38:39]
v_pk_add_f32 v[106:107], v[106:107], v[38:39]
v_pk_add_f32 v[108:109], v[108:109], v[38:39]
v_pk_add_f32 v[110:111], v[110:111], v[38:39]
v_fma_f32 v45, -v44, v40, 1.0
v_fma_f32 v40, v45, v40, v40
v_mov_b32_e64 v41, v40
Vc 48,80,81
Vc 49,82,83
Vc 50,84,85
Vc 51,86,87
Vc 52,88,89
Vc 53,90,91
Vc 54,92,93
Vc 55,94,95
Vc 56,96,97
Vc 57,98,99
Vc 58,100,101
Vc 59,102,103
Vc 60,104,105
Vc 61,106,107
Vc 62,108,109
Vc 63,110,111
v_lshlrev_b32_e64 v80, 16, v48
v_and_b32 v81, 0xffff0000, v48
v_lshlrev_b32_e64 v82, 16, v49
v_and_b32 v83, 0xffff0000, v49
v_lshlrev_b32_e64 v84, 16, v50
v_and_b32 v85, 0xffff0000, v50
v_lshlrev_b32_e64 v86, 16, v51
v_and_b32 v87, 0xffff0000, v51
v_lshlrev_b32_e64 v88, 16, v52
v_and_b32 v89, 0xffff0000, v52
v_lshlrev_b32_e64 v90, 16, v53
v_and_b32 v91, 0xffff0000, v53
v_lshlrev_b32_e64 v92, 16, v54
v_and_b32 v93, 0xffff0000, v54
v_lshlrev_b32_e64 v94, 16, v55
v_and_b32 v95, 0xffff0000, v55
v_lshlrev_b32_e64 v96, 16, v56
v_and_b32 v97, 0xffff0000, v56
v_lshlrev_b32_e64 v98, 16, v57
v_and_b32 v99, 0xffff0000, v57
v_lshlrev_b32_e64 v100, 16, v58
v_and_b32 v101, 0xffff0000, v58
v_lshlrev_b32_e64 v102, 16, v59
v_and_b32 v103, 0xffff0000, v59
v_lshlrev_b32_e64 v104, 16, v60
v_and_b32 v105, 0xffff0000, v60
v_lshlrev_b32_e64 v106, 16, v61
v_and_b32 v107, 0xffff0000, v61
v_lshlrev_b32_e64 v108, 16, v62
v_and_b32 v109, 0xffff0000, v62
v_lshlrev_b32_e64 v110, 16, v63
v_and_b32 v111, 0xffff0000, v63
v_pk_mul_f32 v[80:81], v[80:81], v[40:41]
v_pk_mul_f32 v[82:83], v[82:83], v[40:41]
v_pk_mul_f32 v[84:85], v[84:85], v[40:41]
v_pk_mul_f32 v[86:87], v[86:87], v[40:41]
v_pk_mul_f32 v[88:89], v[88:89], v[40:41]
v_pk_mul_f32 v[90:91], v[90:91], v[40:41]
v_pk_mul_f32 v[92:93], v[92:93], v[40:41]
v_pk_mul_f32 v[94:95], v[94:95], v[40:41]
v_pk_mul_f32 v[96:97], v[96:97], v[40:41]
v_pk_mul_f32 v[98:99], v[98:99], v[40:41]
v_pk_mul_f32 v[100:101], v[100:101], v[40:41]
v_pk_mul_f32 v[102:103], v[102:103], v[40:41]
v_pk_mul_f32 v[104:105], v[104:105], v[40:41]
v_pk_mul_f32 v[106:107], v[106:107], v[40:41]
v_pk_mul_f32 v[108:109], v[108:109], v[40:41]
v_pk_mul_f32 v[110:111], v[110:111], v[40:41]
Vc 48,80,81
Vc 49,82,83
Vc 50,84,85
Vc 51,86,87
Vc 52,88,89
Vc 53,90,91
Vc 54,92,93
Vc 55,94,95
Vc 56,96,97
Vc 57,98,99
Vc 58,100,101
Vc 59,102,103
Vc 60,104,105
Vc 61,106,107
Vc 62,108,109
Vc 63,110,111
s_mul_i32 s3, s32, 4128
s_add_u32 s3, s3, 131072
v_mul_u32_u24 v42, 2064, v33
v_add3_u32 v42, v42, v36, s3
ds_write_b128 v42, v[48:51] offset:0
ds_write_b128 v42, v[52:55] offset:512
ds_write_b128 v42, v[56:59] offset:1024
ds_write_b128 v42, v[60:63] offset:1536
s_waitcnt vmcnt(8)
v_lshlrev_b32 v80, 16, v48
v_and_b32 v81, 0xffff0000, v48
v_lshlrev_b32_e64 v112, 16, v64
v_and_b32 v113, 0xffff0000, v64
v_pk_mul_f32 v[42:43], v[80:81], v[112:113]
v_lshlrev_b32_e64 v82, 16, v49
v_and_b32 v83, 0xffff0000, v49
v_lshlrev_b32_e64 v114, 16, v65
v_and_b32 v115, 0xffff0000, v65
v_pk_mul_f32 v[44:45], v[82:83], v[114:115]
v_lshlrev_b32_e64 v84, 16, v50
v_and_b32 v85, 0xffff0000, v50
v_lshlrev_b32_e64 v116, 16, v66
v_and_b32 v117, 0xffff0000, v66
v_pk_fma_f32 v[42:43], v[84:85], v[116:117], v[42:43]
v_lshlrev_b32_e64 v86, 16, v51
v_and_b32 v87, 0xffff0000, v51
v_lshlrev_b32_e64 v118, 16, v67
v_and_b32 v119, 0xffff0000, v67
v_pk_fma_f32 v[44:45], v[86:87], v[118:119], v[44:45]
v_lshlrev_b32_e64 v88, 16, v52
v_and_b32 v89, 0xffff0000, v52
v_lshlrev_b32_e64 v112, 16, v68
v_and_b32 v113, 0xffff0000, v68
v_pk_fma_f32 v[42:43], v[88:89], v[112:113], v[42:43]
v_lshlrev_b32_e64 v90, 16, v53
v_and_b32 v91, 0xffff0000, v53
v_lshlrev_b32_e64 v114, 16, v69
v_and_b32 v115, 0xffff0000, v69
v_pk_fma_f32 v[44:45], v[90:91], v[114:115], v[44:45]
v_lshlrev_b32_e64 v92, 16, v54
v_and_b32 v93, 0xffff0000, v54
v_lshlrev_b32_e64 v116, 16, v70
v_and_b32 v117, 0xffff0000, v70
v_pk_fma_f32 v[42:43], v[92:93], v[116:117], v[42:43]
v_lshlrev_b32_e64 v94, 16, v55
v_and_b32 v95, 0xffff0000, v55
v_lshlrev_b32_e64 v118, 16, v71
v_and_b32 v119, 0xffff0000, v71
v_pk_fma_f32 v[44:45], v[94:95], v[118:119], v[44:45]
v_lshlrev_b32_e64 v96, 16, v56
v_and_b32 v97, 0xffff0000, v56
v_lshlrev_b32_e64 v112, 16, v72
v_and_b32 v113, 0xffff0000, v72
v_pk_fma_f32 v[42:43], v[96:97], v[112:113], v[42:43]
v_lshlrev_b32_e64 v98, 16, v57
v_and_b32 v99, 0xffff0000, v57
v_lshlrev_b32_e64 v114, 16, v73
v_and_b32 v115, 0xffff0000, v73
v_pk_fma_f32 v[44:45], v[98:99], v[114:115], v[44:45]
v_lshlrev_b32_e64 v100, 16, v58
v_and_b32 v101, 0xffff0000, v58
v_lshlrev_b32_e64 v116, 16, v74
v_and_b32 v117, 0xffff0000, v74
v_pk_fma_f32 v[42:43], v[100:101], v[116:117], v[42:43]
v_lshlrev_b32_e64 v102, 16, v59
v_and_b32 v103, 0xffff0000, v59
v_lshlrev_b32_e64 v118, 16, v75
v_and_b32 v119, 0xffff0000, v75
v_pk_fma_f32 v[44:45], v[102:103], v[118:119], v[44:45]
v_lshlrev_b32_e64 v104, 16, v60
v_and_b32 v105, 0xffff0000, v60
v_lshlrev_b32_e64 v112, 16, v76
v_and_b32 v113, 0xffff0000, v76
v_pk_fma_f32 v[42:43], v[104:105], v[112:113], v[42:43]
v_lshlrev_b32_e64 v106, 16, v61
v_and_b32 v107, 0xffff0000, v61
v_lshlrev_b32_e64 v114, 16, v77
v_and_b32 v115, 0xffff0000, v77
v_pk_fma_f32 v[44:45], v[106:107], v[114:115], v[44:45]
v_lshlrev_b32_e64 v108, 16, v62
v_and_b32 v109, 0xffff0000, v62
v_lshlrev_b32_e64 v116, 16, v78
v_and_b32 v117, 0xffff0000, v78
v_pk_fma_f32 v[42:43], v[108:109], v[116:117], v[42:43]
v_lshlrev_b32_e64 v110, 16, v63
v_and_b32 v111, 0xffff0000, v63
v_lshlrev_b32_e64 v118, 16, v79
v_and_b32 v119, 0xffff0000, v79
v_pk_fma_f32 v[44:45], v[110:111], v[118:119], v[44:45]
v_pk_add_f32 v[42:43], v[42:43], v[44:45]
Va 45,42,43
s_nop 1
v_add_f32_dpp v45, v45, v45 quad_perm:[1,0,3,2] row_mask:0xf bank_mask:0xf
s_nop 1
v_add_f32_dpp v45, v45, v45 quad_perm:[2,3,0,1] row_mask:0xf bank_mask:0xf
s_nop 1
v_add_f32_dpp v45, v45, v45 row_half_mirror row_mask:0xf bank_mask:0xf
s_nop 1
v_add_f32_dpp v45, v45, v45 row_mirror row_mask:0xf bank_mask:0xf
v_mov_b32 v37, v45
s_nop 1
v_permlane16_swap_b32 v37, v45
v_add_f32_e64 v45, v45, v37
Vc 45,45,45
v_ashrrev_i32_e64 v46, 31, v45
v_or_b32 v46, 0x80000000, v46
v_xor_b32_e64 v45, v45, v46
v_and_b32 v45, 0xffff0000, v45
s_lshr_b32 s3, s36, 11
v_add_u32 v46, s3, v33
v_sub_u32 v44, 0xffff, v46
v_or_b32 v45, v45, v44
v_lshlrev_b32 v44, 2, v46
v_lshlrev_b32_e64 v46, 3, v46
v_xor_b32 v38, 0x80000000, v38
v_mov_b32_e64 v39, v40
s_mov_b32 s3, 5242880
s_mov_b32 s39, 5259264
s_mov_b32 exec_lo, 1
s_mov_b32 exec_hi, 1
buffer_store_dword v45, v44, s[20:23], s3 offen sc1
buffer_store_dwordx2 v[38:39], v46, s[20:23], s39 offen sc1
s_mov_b64 exec, -1
s_load_dwordx2 s[4:5], s[0:1], 16
s_load_dwordx4 s[40:43], s[0:1], 64
s_load_dwordx2 s[92:93], s[0:1], 40
s_load_dwordx2 s[94:95], s[0:1], 80
s_load_dwordx2 s[100:101], s[0:1], 0
s_mov_b32 s28, s64
s_and_b32 s29, s65, 0xffff
s_mov_b32 s30, 256
s_mov_b32 s31, 0x20000
s_waitcnt vmcnt(2)
s_waitcnt lgkmcnt(0)
s_barrier
s_nop 0
Ra 224,10,0
Ra 228,11,0
Ra 232,10,2048
Ra 236,11,2048
Ta 0,16,0
Ta 2,16,2048
Ta 4,16,16384
Ta 6,16,18432
Ta 8,17,0
Ta 10,17,2048
Ta 12,17,16384
Ta 14,17,18432
Ta 16,18,0
Ta 18,18,2048
Ta 20,18,16384
s_waitcnt lgkmcnt(9)
s_nop 0
Ta 22,18,18432
Ta 24,19,0
Ta 26,19,2048
Ta 28,19,16384
Ta 30,19,18432
Ta 32,20,0
s_waitcnt lgkmcnt(9)
s_nop 0
Ta 34,20,2048
Ta 36,20,16384
Ta 38,20,18432
Ta 40,21,0
Ta 42,21,2048
Ta 44,21,16384
s_waitcnt lgkmcnt(9)
s_nop 0
Ta 46,21,18432
Ta 48,22,0
Ta 50,22,2048
Ta 52,22,16384
Ta 54,22,18432
Ta 56,23,0
s_waitcnt lgkmcnt(9)
Ta 58,23,2048
Ta 60,23,16384
Ta 62,23,18432
s_cmp_lg_u32 s35, 0
s_cbranch_scc1 L_k1_vpath
Zvaa 48,0,224
v_and_b32 v46, 7, v0
v_mul_u32_u24 v30, 2064, v46
Mvaa 48,4,228
s_add_u32 m0, s57, 65536
Zvaa 52,8,224
buffer_load_dwordx4 v6, s[12:15], s52 offen offset:0 lds
Mvaa 52,12,228
Ra 240,10,4096
Zvaa 56,16,224
buffer_load_dwordx4 v7, s[12:15], s53 offen offset:1024 lds
Mvaa 56,20,228
v_lshrrev_b32_e64 v31, 3, v0
Zvaa 60,24,224
buffer_load_dwordx4 v6, s[12:15], s54 offen offset:2048 lds
Mvaa 60,28,228
Ra 244,11,4096
Zvaa 64,32,224
buffer_load_dwordx4 v7, s[12:15], s55 offen offset:3072 lds
Mvaa 64,36,228
s_add_u32 m0, s57, 69632
s_waitcnt lgkmcnt(10)
Zvaa 68,40,224
buffer_load_dwordx4 v8, s[12:15], s52 offen offset:0 lds
Mvaa 68,44,228
Ra 248,10,6144
s_waitcnt lgkmcnt(7)
Zvaa 72,48,224
buffer_load_dwordx4 v9, s[12:15], s53 offen offset:1024 lds
Mvaa 72,52,228
s_lshl_b32 s3, s32, 9
s_add_u32 s3, s3, 131072
v_lshl_add_u32 v30, v31, 4, v30
s_waitcnt lgkmcnt(3)
Zvaa 76,56,224
buffer_load_dwordx4 v8, s[12:15], s54 offen offset:2048 lds
Mvaa 76,60,228
Ra 252,11,6144
Zvaa 80,0,232
buffer_load_dwordx4 v9, s[12:15], s55 offen offset:3072 lds
Mvaa 80,4,236
s_add_u32 m0, s56, 65536
v_xor_b32 v6, 1572864, v6
v_xor_b32 v7, 1572864, v7
Zvaa 84,8,232
buffer_load_dwordx4 v2, s[8:11], s48 offen offset:0 lds
Mvaa 84,12,236
v_xor_b32 v8, 1572864, v8
v_xor_b32 v9, 1572864, v9
Zvaa 88,16,232
buffer_load_dwordx4 v3, s[8:11], s49 offen offset:1024 lds
Mvaa 88,20,236
v_add_u32 v30, s3, v30
v_lshlrev_b32 v31, 8, v31
Zvaa 92,24,232
buffer_load_dwordx4 v2, s[8:11], s50 offen offset:2048 lds
Mvaa 92,28,236
v_lshl_add_u32 v46, v46, 4, v31
Zvaa 96,32,232
buffer_load_dwordx4 v3, s[8:11], s51 offen offset:3072 lds
Mvaa 96,36,236
s_add_u32 m0, s56, 69632
Zvaa 100,40,232
buffer_load_dwordx4 v4, s[8:11], s48 offen offset:0 lds
Mvaa 100,44,236
Rv 34,30,128
Rv 38,30,256
Zvaa 104,48,232
buffer_load_dwordx4 v5, s[8:11], s49 offen offset:1024 lds
Mvaa 104,52,236
Rv 42,30,384
Rv 30,30,0
Zvaa 108,56,232
s_waitcnt lgkmcnt(4)
buffer_load_dwordx4 v4, s[8:11], s50 offen offset:2048 lds
Mvaa 108,60,236
s_lshr_b32 s3, s2, 1
s_mul_i32 s3, s3, 33792
s_add_u32 s3, s3, s57
Zvaa 112,0,240
buffer_load_dwordx4 v5, s[8:11], s51 offen offset:3072 lds
Mvaa 112,4,244
v_xor_b32 v2, 384, v2
v_xor_b32 v3, 384, v3
Zvaa 116,8,240
s_and_b32 s39, s2, 1
s_lshl_b32 s39, s39, 7
s_add_u32 s3, s3, s39
Mvaa 116,12,244
Ra 224,10,8192
v_xor_b32 v4, 384, v4
Zvaa 120,16,240
s_add_u32 s39, s3, 4096
Mvaa 120,20,244
v_xor_b32 v5, 384, v5
Zvaa 124,24,240
Mvaa 124,28,244
Ra 228,11,8192
Zvaa 128,32,240
Mvaa 128,36,244
Zvaa 132,40,240
Mvaa 132,44,244
Ra 232,10,10240
Zvaa 136,48,240
buffer_load_dword v1, v47, s[60:63], 0 offen
Mvaa 136,52,244
s_mul_i32 vcc_lo, s59, 1
v_xor_b32 v47, vcc_lo, v47
Zvaa 140,56,240
Mvaa 140,60,244
Ra 236,11,10240
Zvaa 144,0,248
Mvaa 144,4,252
Zvaa 148,8,248
Mvaa 148,12,252
Zvaa 152,16,248
Mvaa 152,20,252
Zvaa 156,24,248
Mvaa 156,28,252
Zvaa 160,32,248
Mvaa 160,36,252
Zvaa 164,40,248
Mvaa 164,44,252
Zvaa 168,48,248
Mvaa 168,52,252
s_waitcnt vmcnt(9)
Zvaa 172,56,248
s_waitcnt lgkmcnt(0)
s_barrier
Mvaa 172,60,252
s_add_u32 m0, s57, 0
Zvaa 176,0,224
buffer_load_dwordx4 v6, s[12:15], s52 offen offset:0 lds
Mvaa 176,4,228
Ta 64,14,0
Ta 66,14,2048
Zvaa 180,8,224
Mvaa 180,12,228
Ra 240,10,12288
Zvaa 184,16,224
buffer_load_dwordx4 v7, s[12:15], s53 offen offset:1024 lds
Mvaa 184,20,228
Ta 68,14,16384
Ta 70,14,18432
Zvaa 188,24,224
Mvaa 188,28,228
Ra 244,11,12288
Zvaa 192,32,224
buffer_load_dwordx4 v6, s[12:15], s54 offen offset:2048 lds
Mvaa 192,36,228
Ta 72,15,0
Ta 74,15,2048
Zvaa 196,40,224
Mvaa 196,44,228
Ra 248,10,14336
Zvaa 200,48,224
buffer_load_dwordx4 v7, s[12:15], s55 offen offset:3072 lds
Mvaa 200,52,228
Ta 76,15,16384
Ta 78,15,18432
Zvaa 204,56,224
Mvaa 204,60,228
s_add_u32 m0, s57, 4096
Ra 252,11,14336
Zvaa 208,0,232
buffer_load_dwordx4 v8, s[12:15], s52 offen offset:0 lds
Mvaa 208,4,236
Zvaa 212,8,232
Mvaa 212,12,236
Ta 80,24,0
Ta 82,24,2048
Zvaa 216,16,232
buffer_load_dwordx4 v9, s[12:15], s53 offen offset:1024 lds
Mvaa 216,20,236
Ta 84,24,16384
s_waitcnt lgkmcnt(9)
Ta 86,24,18432
Zvaa 220,24,232
Mvaa 220,28,236
Ta 88,25,0
Ta 90,25,2048
Zvaa 224,32,232
buffer_load_dwordx4 v8, s[12:15], s54 offen offset:2048 lds
Mvaa 224,36,236
Zvaa 228,40,232
Mvaa 228,44,236
Ta 92,25,16384
Ta 94,25,18432
Zvaa 232,48,232
buffer_load_dwordx4 v9, s[12:15], s55 offen offset:3072 lds
Mvaa 232,52,236
s_waitcnt vmcnt(9)
Ta 96,26,0
s_waitcnt lgkmcnt(9)
Ta 98,26,2048
Zvaa 236,56,232
s_barrier
v_xor_b32 v6, 524288, v6
v_xor_b32 v7, 524288, v7
Mvaa 236,60,236
s_add_u32 m0, s56, 0
Ta 100,26,16384
Ta 102,26,18432
Zvaa 240,0,240
buffer_load_dwordx4 v2, s[8:11], s48 offen offset:0 lds
Mvaa 240,4,244
v_xor_b32 v8, 524288, v8
v_xor_b32 v9, 524288, v9
Zvaa 244,8,240
Mvaa 244,12,244
Ra 224,12,0
Zvaa 248,16,240
buffer_load_dwordx4 v3, s[8:11], s49 offen offset:1024 lds
Mvaa 248,20,244
Ta 104,27,0
Ta 106,27,2048
Zvaa 252,24,240
Mvaa 252,28,244
s_waitcnt lgkmcnt(9)
Ra 228,13,0
Zaaa 128,32,240
buffer_load_dwordx4 v2, s[8:11], s50 offen offset:2048 lds
Maaa 128,36,244
Ta 108,27,16384
Ta 110,27,18432
Zaaa 132,40,240
Maaa 132,44,244
Ra 232,12,2048
Zaaa 136,48,240
buffer_load_dwordx4 v3, s[8:11], s51 offen offset:3072 lds
Maaa 136,52,244
Ta 112,28,0
Ta 114,28,2048
Zaaa 140,56,240
Maaa 140,60,244
s_add_u32 m0, s56, 4096
s_waitcnt lgkmcnt(9)
Ra 236,13,2048
Zaaa 144,0,248
buffer_load_dwordx4 v4, s[8:11], s48 offen offset:0 lds
Maaa 144,4,252
Zaaa 148,8,248
Maaa 148,12,252
Ta 116,28,16384
Ta 118,28,18432
Zaaa 152,16,248
buffer_load_dwordx4 v5, s[8:11], s49 offen offset:1024 lds
Maaa 152,20,252
Ta 120,29,0
Ta 122,29,2048
Zaaa 156,24,248
Maaa 156,28,252
Ta 124,29,16384
s_waitcnt lgkmcnt(9)
Ta 126,29,18432
Zaaa 160,32,248
buffer_load_dwordx4 v4, s[8:11], s50 offen offset:2048 lds
Maaa 160,36,252
Zaaa 164,40,248
Maaa 164,44,252
Zaaa 168,48,248
buffer_load_dwordx4 v5, s[8:11], s51 offen offset:3072 lds
Maaa 168,52,252
v_xor_b32 v2, 128, v2
v_xor_b32 v3, 128, v3
Zaaa 172,56,248
s_waitcnt lgkmcnt(6)
buffer_load_dword v1, v47, s[60:63], 0 offen
v_xor_b32 v4, 128, v4
v_xor_b32 v5, 128, v5
Maaa 172,60,252
s_waitcnt lgkmcnt(0)
s_mul_i32 vcc_lo, s59, 7
v_xor_b32 v47, vcc_lo, v47
Mvaa 48,64,224
buffer_store_dwordx4 v[30:33], v46, s[20:23], s3 offen offset:0 sc1
Mvaa 48,68,228
buffer_store_dwordx4 v[34:37], v46, s[20:23], s3 offen offset:2048 sc1
Mvaa 52,72,224
buffer_store_dwordx4 v[38:41], v46, s[20:23], s39 offen offset:0 sc1
Mvaa 52,76,228
Ra 240,12,4096
Mvaa 56,80,224
buffer_store_dwordx4 v[42:45], v46, s[20:23], s39 offen offset:2048 sc1
Mvaa 56,84,228
s_lshl_b32 s3, s34, 1
s_and_b32 s36, s32, 1
s_add_u32 s3, s3, s36
Mvaa 60,88,224
s_mul_i32 s3, s3, 1116160
s_mul_i32 s36, s33, 139264
s_add_u32 s3, s3, s36
Mvaa 60,92,228
Ra 244,13,4096
Mvaa 64,96,224
s_lshr_b32 s36, s32, 1
s_mul_i32 s36, s36, 69632
s_add_u32 s3, s3, s36
Mvaa 64,100,228
s_add_u32 s38, s3, 0
s_lshl_b32 s39, s34, 7
s_lshl_b32 s36, s33, 2
Mvaa 68,104,224
s_add_u32 s39, s39, s36
s_add_u32 s39, s39, 5296128
v_mov_b32_e64 v30, 1
Mvaa 68,108,228
Ra 248,12,6144
Mvaa 72,112,224
v_mov_b32_e64 v31, 0
Mvaa 72,116,228
s_cmp_eq_u32 s32, 0
s_cselect_b32 s39, s39, 2146435072
Mvaa 76,120,224
s_mov_b64 exec, 1
buffer_store_dword v31, v31, s[20:23], s39 offen sc1
s_mov_b64 exec, -1
Mvaa 76,124,228
Ra 252,13,6144
Mvaa 80,64,232
s_and_b32 s33, s2, 7
s_lshl_b32 s33, s33, 2
s_bfe_u32 s3, s2, 0x20003
Mvaa 80,68,236
s_add_u32 s33, s33, s3
s_lshr_b32 s34, s2, 5
s_lshl_b32 s64, s34, 7
Mvaa 84,72,232
s_lshl_b32 s3, s33, 2
s_add_u32 s64, s64, s3
s_add_u32 s64, s64, 5300224
Mvaa 84,76,236
s_lshl_b32 s65, s34, 8
s_sub_u32 s65, 1920, s65
v_mul_u32_u24 v32, s65, v0
Mvaa 88,80,232
s_cmp_eq_u32 s32, 0
s_cselect_b32 s64, s64, 2146435072
Mvaa 88,84,236
s_mov_b64 exec, 3
buffer_store_dword v31, v32, s[20:23], s64 offen sc1
s_mov_b64 exec, -1
Mvaa 92,88,232
s_lshl_b32 s3, s2, 2
s_add_u32 s3, s3, 5447680
v_lshlrev_b32_e64 v32, 10, v0
Mvaa 92,92,236
s_cmp_eq_u32 s32, 0
s_cselect_b32 s3, s3, 2146435072
Mvaa 96,96,232
s_mov_b64 exec, 0x1ff
buffer_store_dword v31, v32, s[20:23], s3 offen sc1
s_mov_b64 exec, -1
Mvaa 96,100,236
s_lshl_b32 s35, s34, 1
s_sub_u32 s36, 32, s35
s_add_u32 s35, s35, 2
Mvaa 100,104,232
s_lshl_b32 s44, s32, 12
s_lshl_b32 s58, s32, 1
s_sub_u32 s58, 7, s58
Mvaa 100,108,236
s_mul_i32 s58, s58, 33792
s_sub_u32 s3, 15, s34
s_lshl_b32 s45, s3, 3
Mvaa 104,112,232
s_add_u32 s45, s45, s32
s_lshl_b32 s46, s34, 3
s_add_u32 s46, s46, s32
Mvaa 104,116,236
s_mov_b32 s68, s42
s_and_b32 s69, s43, 0xffff
s_mov_b32 s70, 7340032
Mvaa 108,120,232
s_waitcnt lgkmcnt(0)
Mvaa 108,124,236
s_mov_b32 s71, 0x20000
s_cmp_eq_u32 s32, 0
s_cselect_b32 s37, 0, 2146435072
Mvaa 112,64,240
s_lshl_b32 s3, s33, 8
s_add_u32 s16, s4, s3
s_addc_u32 s17, s5, 0
s_and_b32 s17, s17, 0xffff
Mvaa 112,68,244
s_mov_b32 s18, 0
s_mov_b32 s19, 0x20000
s_sub_u32 s18, 8388608, s3
Mvaa 116,72,240
v_and_b32 v33, 15, v0
v_lshrrev_b32 v32, 1, v33
Mvaa 116,76,244
Ra 224,12,8192
Mvaa 120,80,240
v_and_b32 v33, 1, v0
v_lshlrev_b32 v32, 13, v32
Mvaa 120,84,244
v_lshl_add_u32 v45, v33, 7, v32
Mvaa 124,88,240
s_lshl_b32 s3, s32, 3
s_add_u32 s3, s3, s34
s_mul_i32 s47, s3, 65536
Mvaa 124,92,244
Ra 228,13,8192
Mvaa 128,96,240
s_bfe_u32 s6, s2, 131075
s_lshl_b32 s3, s32, 8
s_or_b32 s6, s6, s3
Mvaa 128,100,244
Mvaa 132,104,240
Mvaa 132,108,244
Ra 232,12,10240
Mvaa 136,112,240
Mvaa 136,116,244
Mvaa 140,120,240
Mvaa 140,124,244
Ra 236,13,10240
Mvaa 144,64,248
Mvaa 144,68,252
Mvaa 148,72,248
Mvaa 148,76,252
Mvaa 152,80,248
Mvaa 152,84,252
Mvaa 156,88,248
Mvaa 156,92,252
Mvaa 160,96,248
Mvaa 160,100,252
Mvaa 164,104,248
Mvaa 164,108,252
Mvaa 168,112,248
Mvaa 168,116,252
s_waitcnt vmcnt(16)
Mvaa 172,120,248
s_waitcnt lgkmcnt(0)
s_barrier
Mvaa 172,124,252
s_add_u32 m0, s57, 65536
Mvaa 176,64,224
buffer_load_dwordx4 v6, s[12:15], s52 offen offset:0 lds
Mvaa 176,68,228
Ta 0,16,0
Ta 2,16,2048
Mvaa 180,72,224
Mvaa 180,76,228
Ra 240,12,12288
Mvaa 184,80,224
buffer_load_dwordx4 v7, s[12:15], s53 offen offset:1024 lds
Mvaa 184,84,228
Ta 4,16,16384
Ta 6,16,18432
Mvaa 188,88,224
Mvaa 188,92,228
Ra 244,13,12288
Mvaa 192,96,224
buffer_load_dwordx4 v6, s[12:15], s54 offen offset:2048 lds
Mvaa 192,100,228
Ta 8,17,0
Ta 10,17,2048
Mvaa 196,104,224
Mvaa 196,108,228
Ra 248,12,14336
Mvaa 200,112,224
buffer_load_dwordx4 v7, s[12:15], s55 offen offset:3072 lds
Mvaa 200,116,228
Ta 12,17,16384
Ta 14,17,18432
Mvaa 204,120,224
Mvaa 204,124,228
s_add_u32 m0, s57, 69632
Ra 252,13,14336
Mvaa 208,64,232
buffer_load_dwordx4 v8, s[12:15], s52 offen offset:0 lds
Mvaa 208,68,236
Mvaa 212,72,232
Mvaa 212,76,236
Ta 16,18,0
Ta 18,18,2048
Mvaa 216,80,232
buffer_load_dwordx4 v9, s[12:15], s53 offen offset:1024 lds
Mvaa 216,84,236
Ta 20,18,16384
s_waitcnt lgkmcnt(9)
Ta 22,18,18432
Mvaa 220,88,232
Mvaa 220,92,236
Ta 24,19,0
Ta 26,19,2048
Mvaa 224,96,232
buffer_load_dwordx4 v8, s[12:15], s54 offen offset:2048 lds
Mvaa 224,100,236
Mvaa 228,104,232
Mvaa 228,108,236
Ta 28,19,16384
Ta 30,19,18432
Mvaa 232,112,232
buffer_load_dwordx4 v9, s[12:15], s55 offen offset:3072 lds
Mvaa 232,116,236
s_waitcnt vmcnt(16)
Ta 32,20,0
s_waitcnt lgkmcnt(9)
Ta 34,20,2048
Mvaa 236,120,232
s_barrier
v_xor_b32 v6, 3670016, v6
v_xor_b32 v7, 3670016, v7
Mvaa 236,124,236
s_add_u32 m0, s56, 65536
Ta 36,20,16384
Ta 38,20,18432
Mvaa 240,64,240
buffer_load_dwordx4 v2, s[8:11], s48 offen offset:0 lds
Mvaa 240,68,244
v_xor_b32 v8, 3670016, v8
v_xor_b32 v9, 3670016, v9
Mvaa 244,72,240
Mvaa 244,76,244
Ra 224,10,0
Mvaa 248,80,240
buffer_load_dwordx4 v3, s[8:11], s49 offen offset:1024 lds
Mvaa 248,84,244
Ta 40,21,0
Ta 42,21,2048
Mvaa 252,88,240
Mvaa 252,92,244
s_waitcnt lgkmcnt(9)
Ra 228,11,0
Maaa 128,96,240
buffer_load_dwordx4 v2, s[8:11], s50 offen offset:2048 lds
Maaa 128,100,244
Ta 44,21,16384
Ta 46,21,18432
Maaa 132,104,240
Maaa 132,108,244
Ra 232,10,2048
Maaa 136,112,240
buffer_load_dwordx4 v3, s[8:11], s51 offen offset:3072 lds
Maaa 136,116,244
Ta 48,22,0
Ta 50,22,2048
Maaa 140,120,240
Maaa 140,124,244
s_add_u32 m0, s56, 69632
s_waitcnt lgkmcnt(9)
Ra 236,11,2048
Maaa 144,64,248
buffer_load_dwordx4 v4, s[8:11], s48 offen offset:0 lds
Maaa 144,68,252
Maaa 148,72,248
Maaa 148,76,252
Ta 52,22,16384
Ta 54,22,18432
Maaa 152,80,248
buffer_load_dwordx4 v5, s[8:11], s49 offen offset:1024 lds
Maaa 152,84,252
Ta 56,23,0
Ta 58,23,2048
Maaa 156,88,248
Maaa 156,92,252
Ta 60,23,16384
s_waitcnt lgkmcnt(9)
Ta 62,23,18432
Maaa 160,96,248
buffer_load_dwordx4 v4, s[8:11], s50 offen offset:2048 lds
Maaa 160,100,252
Maaa 164,104,248
Maaa 164,108,252
Maaa 168,112,248
buffer_load_dwordx4 v5, s[8:11], s51 offen offset:3072 lds
Maaa 168,116,252
v_xor_b32 v2, 896, v2
v_xor_b32 v3, 896, v3
Maaa 172,120,248
s_waitcnt lgkmcnt(6)
buffer_load_dword v1, v47, s[60:63], 0 offen
v_xor_b32 v4, 896, v4
v_xor_b32 v5, 896, v5
Maaa 172,124,252
s_waitcnt lgkmcnt(0)
s_mul_i32 vcc_lo, s59, 1
v_xor_b32 v47, vcc_lo, v47
Mvaa 48,0,224
Mvaa 48,4,228
Mvaa 52,8,224
Mvaa 52,12,228
Ra 240,10,4096
Mvaa 56,16,224
Mvaa 56,20,228
Mvaa 60,24,224
Mvaa 60,28,228
Ra 244,11,4096
Mvaa 64,32,224
Mvaa 64,36,228
Mvaa 68,40,224
Mvaa 68,44,228
Ra 248,10,6144
Mvaa 72,48,224
Mvaa 72,52,228
Mvaa 76,56,224
Mvaa 76,60,228
Ra 252,11,6144
Mvaa 80,0,232
Mvaa 80,4,236
Mvaa 84,8,232
Mvaa 84,12,236
Mvaa 88,16,232
Mvaa 88,20,236
Mvaa 92,24,232
Mvaa 92,28,236
Mvaa 96,32,232
Mvaa 96,36,236
Mvaa 100,40,232
Mvaa 100,44,236
Mvaa 104,48,232
Mvaa 104,52,236
Mvaa 108,56,232
s_waitcnt lgkmcnt(0)
Mvaa 108,60,236
Mvaa 112,0,240
Mvaa 112,4,244
Mvaa 116,8,240
Mvaa 116,12,244
Ra 224,10,8192
Mvaa 120,16,240
Mvaa 120,20,244
Mvaa 124,24,240
Mvaa 124,28,244
Ra 228,11,8192
Mvaa 128,32,240
Mvaa 128,36,244
Mvaa 132,40,240
Mvaa 132,44,244
Ra 232,10,10240
Mvaa 136,48,240
Mvaa 136,52,244
Mvaa 140,56,240
Mvaa 140,60,244
Ra 236,11,10240
Mvaa 144,0,248
Mvaa 144,4,252
Mvaa 148,8,248
Mvaa 148,12,252
Mvaa 152,16,248
Mvaa 152,20,252
Mvaa 156,24,248
Mvaa 156,28,252
Mvaa 160,32,248
Mvaa 160,36,252
Mvaa 164,40,248
Mvaa 164,44,252
Mvaa 168,48,248
Mvaa 168,52,252
s_waitcnt vmcnt(9)
Mvaa 172,56,248
s_waitcnt lgkmcnt(0)
s_barrier
Mvaa 172,60,252
s_add_u32 m0, s57, 0
Mvaa 176,0,224
buffer_load_dwordx4 v6, s[12:15], s52 offen offset:0 lds
Mvaa 176,4,228
Ta 64,14,0
Ta 66,14,2048
Mvaa 180,8,224
Mvaa 180,12,228
Ra 240,10,12288
Mvaa 184,16,224
buffer_load_dwordx4 v7, s[12:15], s53 offen offset:1024 lds
Mvaa 184,20,228
Ta 68,14,16384
Ta 70,14,18432
Mvaa 188,24,224
Mvaa 188,28,228
Ra 244,11,12288
Mvaa 192,32,224
buffer_load_dwordx4 v6, s[12:15], s54 offen offset:2048 lds
Mvaa 192,36,228
Ta 72,15,0
Ta 74,15,2048
Mvaa 196,40,224
Mvaa 196,44,228
Ra 248,10,14336
Mvaa 200,48,224
buffer_load_dwordx4 v7, s[12:15], s55 offen offset:3072 lds
Mvaa 200,52,228
Ta 76,15,16384
Ta 78,15,18432
Mvaa 204,56,224
s_cmp_eq_u32 s6, 0
s_cselect_b32 s3, 0, 2146435072
Mvaa 204,60,228
s_add_u32 m0, s57, 4096
Ra 252,11,14336
Mvaa 208,0,232
buffer_load_dwordx4 v8, s[12:15], s52 offen offset:0 lds
Mvaa 208,4,236
s_mov_b64 exec, 1
buffer_atomic_add v30, v31, s[28:31], s3 offen sc1
s_mov_b64 exec, -1
Mvaa 212,8,232
Mvaa 212,12,236
Ta 80,24,0
Ta 82,24,2048
Mvaa 216,16,232
buffer_load_dwordx4 v9, s[12:15], s53 offen offset:1024 lds
Mvaa 216,20,236
Ta 84,24,16384
s_waitcnt lgkmcnt(9)
Ta 86,24,18432
Mvaa 220,24,232
Mvaa 220,28,236
Ta 88,25,0
Ta 90,25,2048
Mvaa 224,32,232
buffer_load_dwordx4 v8, s[12:15], s54 offen offset:2048 lds
Mvaa 224,36,236
Mvaa 228,40,232
Mvaa 228,44,236
Ta 92,25,16384
Ta 94,25,18432
Mvaa 232,48,232
buffer_load_dwordx4 v9, s[12:15], s55 offen offset:3072 lds
Mvaa 232,52,236
s_waitcnt vmcnt(10)
Ta 96,26,0
s_waitcnt lgkmcnt(9)
Ta 98,26,2048
Mvaa 236,56,232
s_barrier
v_xor_b32 v6, 524288, v6
v_xor_b32 v7, 524288, v7
Mvaa 236,60,236
s_add_u32 m0, s56, 0
Ta 100,26,16384
Ta 102,26,18432
Mvaa 240,0,240
buffer_load_dwordx4 v2, s[8:11], s48 offen offset:0 lds
Mvaa 240,4,244
v_xor_b32 v8, 524288, v8
v_xor_b32 v9, 524288, v9
Mvaa 244,8,240
Mvaa 244,12,244
Ra 224,12,0
Mvaa 248,16,240
buffer_load_dwordx4 v3, s[8:11], s49 offen offset:1024 lds
Mvaa 248,20,244
Ta 104,27,0
Ta 106,27,2048
Mvaa 252,24,240
Mvaa 252,28,244
s_waitcnt lgkmcnt(9)
Ra 228,13,0
Maaa 128,32,240
buffer_load_dwordx4 v2, s[8:11], s50 offen offset:2048 lds
Maaa 128,36,244
Ta 108,27,16384
Ta 110,27,18432
Maaa 132,40,240
Maaa 132,44,244
Ra 232,12,2048
Maaa 136,48,240
buffer_load_dwordx4 v3, s[8:11], s51 offen offset:3072 lds
Maaa 136,52,244
Ta 112,28,0
Ta 114,28,2048
Maaa 140,56,240
Maaa 140,60,244
s_add_u32 m0, s56, 4096
s_waitcnt lgkmcnt(9)
Ra 236,13,2048
Maaa 144,0,248
buffer_load_dwordx4 v4, s[8:11], s48 offen offset:0 lds
Maaa 144,4,252
Maaa 148,8,248
Maaa 148,12,252
Ta 116,28,16384
Ta 118,28,18432
Maaa 152,16,248
buffer_load_dwordx4 v5, s[8:11], s49 offen offset:1024 lds
Maaa 152,20,252
Ta 120,29,0
Ta 122,29,2048
Maaa 156,24,248
Maaa 156,28,252
Ta 124,29,16384
s_waitcnt lgkmcnt(9)
Ta 126,29,18432
Maaa 160,32,248
buffer_load_dwordx4 v4, s[8:11], s50 offen offset:2048 lds
Maaa 160,36,252
Maaa 164,40,248
Maaa 164,44,252
Maaa 168,48,248
buffer_load_dwordx4 v5, s[8:11], s51 offen offset:3072 lds
Maaa 168,52,252
v_xor_b32 v2, 128, v2
v_xor_b32 v3, 128, v3
Maaa 172,56,248
s_waitcnt lgkmcnt(6)
buffer_load_dword v1, v47, s[60:63], 0 offen
v_xor_b32 v4, 128, v4
v_xor_b32 v5, 128, v5
Maaa 172,60,252
s_waitcnt lgkmcnt(0)
s_mul_i32 vcc_lo, s59, 3
v_xor_b32 v47, vcc_lo, v47
Mvaa 48,64,224
buffer_load_dword v44, v45, s[16:19], s47 offen
Mvaa 48,68,228
s_add_u32 s47, s47, 2097152
Mvaa 52,72,224
Mvaa 52,76,228
Ra 240,12,4096
Mvaa 56,80,224
Mvaa 56,84,228
Mvaa 60,88,224
Mvaa 60,92,228
Ra 244,13,4096
Mvaa 64,96,224
Mvaa 64,100,228
Mvaa 68,104,224
Mvaa 68,108,228
Ra 248,12,6144
Mvaa 72,112,224
Mvaa 72,116,228
Mvaa 76,120,224
Mvaa 76,124,228
Ra 252,13,6144
Mvaa 80,64,232
Mvaa 80,68,236
Mvaa 84,72,232
Mvaa 84,76,236
Mvaa 88,80,232
Mvaa 88,84,236
Mvaa 92,88,232
Mvaa 92,92,236
Mvaa 96,96,232
Mvaa 96,100,236
Mvaa 100,104,232
s_cmp_eq_u32 s6, 1
s_cselect_b32 s3, 0, 2146435072
Mvaa 100,108,236
s_mov_b64 exec, 1
buffer_atomic_add v30, v31, s[28:31], s3 offen sc1
s_mov_b64 exec, -1
Mvaa 104,112,232
Mvaa 104,116,236
Mvaa 108,120,232
s_waitcnt lgkmcnt(0)
Mvaa 108,124,236
Mvaa 112,64,240
Mvaa 112,68,244
Mvaa 116,72,240
Mvaa 116,76,244
Ra 224,12,8192
Mvaa 120,80,240
Mvaa 120,84,244
Mvaa 124,88,240
Mvaa 124,92,244
Ra 228,13,8192
Mvaa 128,96,240
Mvaa 128,100,244
Mvaa 132,104,240
Mvaa 132,108,244
Ra 232,12,10240
Mvaa 136,112,240
Mvaa 136,116,244
Mvaa 140,120,240
Mvaa 140,124,244
Ra 236,13,10240
Mvaa 144,64,248
Mvaa 144,68,252
Mvaa 148,72,248
Mvaa 148,76,252
Mvaa 152,80,248
Mvaa 152,84,252
Mvaa 156,88,248
Mvaa 156,92,252
Mvaa 160,96,248
Mvaa 160,100,252
Mvaa 164,104,248
Mvaa 164,108,252
Mvaa 168,112,248
Mvaa 168,116,252
s_waitcnt vmcnt(11)
Mvaa 172,120,248
s_waitcnt lgkmcnt(0)
s_barrier
Mvaa 172,124,252
s_add_u32 m0, s57, 65536
Mvaa 176,64,224
buffer_load_dwordx4 v6, s[12:15], s52 offen offset:0 lds
Mvaa 176,68,228
Ta 0,16,0
Ta 2,16,2048
Mvaa 180,72,224
Mvaa 180,76,228
Ra 240,12,12288
Mvaa 184,80,224
buffer_load_dwordx4 v7, s[12:15], s53 offen offset:1024 lds
Mvaa 184,84,228
Ta 4,16,16384
Ta 6,16,18432
Mvaa 188,88,224
Mvaa 188,92,228
Ra 244,13,12288
Mvaa 192,96,224
buffer_load_dwordx4 v6, s[12:15], s54 offen offset:2048 lds
Mvaa 192,100,228
Ta 8,17,0
Ta 10,17,2048
Mvaa 196,104,224
Mvaa 196,108,228
Ra 248,12,14336
Mvaa 200,112,224
buffer_load_dwordx4 v7, s[12:15], s55 offen offset:3072 lds
Mvaa 200,116,228
Ta 12,17,16384
Ta 14,17,18432
Mvaa 204,120,224
Mvaa 204,124,228
s_add_u32 m0, s57, 69632
Ra 252,13,14336
Mvaa 208,64,232
buffer_load_dwordx4 v8, s[12:15], s52 offen offset:0 lds
Mvaa 208,68,236
Mvaa 212,72,232
Mvaa 212,76,236
Ta 16,18,0
Ta 18,18,2048
Mvaa 216,80,232
buffer_load_dwordx4 v9, s[12:15], s53 offen offset:1024 lds
Mvaa 216,84,236
Ta 20,18,16384
s_waitcnt lgkmcnt(9)
Ta 22,18,18432
Mvaa 220,88,232
Mvaa 220,92,236
Ta 24,19,0
Ta 26,19,2048
Mvaa 224,96,232
buffer_load_dwordx4 v8, s[12:15], s54 offen offset:2048 lds
Mvaa 224,100,236
Mvaa 228,104,232
Mvaa 228,108,236
Ta 28,19,16384
Ta 30,19,18432
Mvaa 232,112,232
buffer_load_dwordx4 v9, s[12:15], s55 offen offset:3072 lds
Mvaa 232,116,236
s_waitcnt vmcnt(11)
Ta 32,20,0
s_waitcnt lgkmcnt(9)
Ta 34,20,2048
Mvaa 236,120,232
s_barrier
v_xor_b32 v6, 1572864, v6
v_xor_b32 v7, 1572864, v7
Mvaa 236,124,236
s_add_u32 m0, s56, 65536
Ta 36,20,16384
Ta 38,20,18432
Mvaa 240,64,240
buffer_load_dwordx4 v2, s[8:11], s48 offen offset:0 lds
Mvaa 240,68,244
v_xor_b32 v8, 1572864, v8
v_xor_b32 v9, 1572864, v9
Mvaa 244,72,240
Mvaa 244,76,244
Ra 224,10,0
Mvaa 248,80,240
buffer_load_dwordx4 v3, s[8:11], s49 offen offset:1024 lds
Mvaa 248,84,244
Ta 40,21,0
Ta 42,21,2048
Mvaa 252,88,240
Mvaa 252,92,244
s_waitcnt lgkmcnt(9)
Ra 228,11,0
Maaa 128,96,240
buffer_load_dwordx4 v2, s[8:11], s50 offen offset:2048 lds
Maaa 128,100,244
Ta 44,21,16384
Ta 46,21,18432
Maaa 132,104,240
s_cmp_eq_u32 s6, 2
s_cselect_b32 s3, 0, 2146435072
Maaa 132,108,244
Ra 232,10,2048
Maaa 136,112,240
buffer_load_dwordx4 v3, s[8:11], s51 offen offset:3072 lds
Maaa 136,116,244
Ta 48,22,0
Ta 50,22,2048
Maaa 140,120,240
s_mov_b64 exec, 1
buffer_atomic_add v30, v31, s[28:31], s3 offen sc1
s_mov_b64 exec, -1
Maaa 140,124,244
s_add_u32 m0, s56, 69632
s_waitcnt lgkmcnt(9)
Ra 236,11,2048
Maaa 144,64,248
buffer_load_dwordx4 v4, s[8:11], s48 offen offset:0 lds
Maaa 144,68,252
Maaa 148,72,248
Maaa 148,76,252
Ta 52,22,16384
Ta 54,22,18432
Maaa 152,80,248
buffer_load_dwordx4 v5, s[8:11], s49 offen offset:1024 lds
Maaa 152,84,252
Ta 56,23,0
Ta 58,23,2048
Maaa 156,88,248
Maaa 156,92,252
Ta 60,23,16384
s_waitcnt lgkmcnt(9)
Ta 62,23,18432
Maaa 160,96,248
buffer_load_dwordx4 v4, s[8:11], s50 offen offset:2048 lds
Maaa 160,100,252
Maaa 164,104,248
Maaa 164,108,252
Maaa 168,112,248
buffer_load_dwordx4 v5, s[8:11], s51 offen offset:3072 lds
Maaa 168,116,252
v_xor_b32 v2, 384, v2
v_xor_b32 v3, 384, v3
Maaa 172,120,248
s_waitcnt lgkmcnt(6)
buffer_load_dword v1, v47, s[60:63], 0 offen
v_xor_b32 v4, 384, v4
v_xor_b32 v5, 384, v5
Maaa 172,124,252
s_waitcnt lgkmcnt(0)
s_mul_i32 vcc_lo, s59, 1
v_xor_b32_e64 v47, vcc_lo, v47
Mvaa 48,0,224
buffer_load_dword v44, v45, s[16:19], s47 offen
Mvaa 48,4,228
s_add_u32 s47, s47, 2097152
Mvaa 52,8,224
Mvaa 52,12,228
Ra 240,10,4096
Mvaa 56,16,224
Mvaa 56,20,228
Mvaa 60,24,224
Mvaa 60,28,228
Ra 244,11,4096
Mvaa 64,32,224
Mvaa 64,36,228
Mvaa 68,40,224
Mvaa 68,44,228
Ra 248,10,6144
Mvaa 72,48,224
Mvaa 72,52,228
Mvaa 76,56,224
Mvaa 76,60,228
Ra 252,11,6144
Mvaa 80,0,232
Mvaa 80,4,236
Mvaa 84,8,232
Mvaa 84,12,236
Mvaa 88,16,232
Mvaa 88,20,236
Mvaa 92,24,232
Mvaa 92,28,236
Mvaa 96,32,232
Mvaa 96,36,236
Mvaa 100,40,232
Mvaa 100,44,236
Mvaa 104,48,232
Mvaa 104,52,236
Mvaa 108,56,232
s_waitcnt lgkmcnt(0)
Mvaa 108,60,236
Mvaa 112,0,240
Mvaa 112,4,244
Mvaa 116,8,240
Mvaa 116,12,244
Ra 224,10,8192
Mvaa 120,16,240
Mvaa 120,20,244
Mvaa 124,24,240
Mvaa 124,28,244
Ra 228,11,8192
Mvaa 128,32,240
Mvaa 128,36,244
Mvaa 132,40,240
Mvaa 132,44,244
Ra 232,10,10240
Mvaa 136,48,240
Mvaa 136,52,244
Mvaa 140,56,240
Mvaa 140,60,244
Ra 236,11,10240
Mvaa 144,0,248
Mvaa 144,4,252
Mvaa 148,8,248
Mvaa 148,12,252
Mvaa 152,16,248
s_cmp_eq_u32 s6, 3
s_cselect_b32 s3, 0, 2146435072
Mvaa 152,20,252
s_mov_b64 exec, 1
buffer_atomic_add v30, v31, s[28:31], s3 offen sc1
s_mov_b64 exec, -1
Mvaa 156,24,248
Mvaa 156,28,252
Mvaa 160,32,248
Mvaa 160,36,252
Mvaa 164,40,248
Mvaa 164,44,252
Mvaa 168,48,248
Mvaa 168,52,252
s_waitcnt vmcnt(12)
Mvaa 172,56,248
s_waitcnt lgkmcnt(0)
s_barrier
Mvaa 172,60,252
s_add_u32 m0, s57, 0
Mvaa 176,0,224
buffer_load_dwordx4 v6, s[12:15], s52 offen offset:0 lds
Mvaa 176,4,228
Ta 64,14,0
Ta 66,14,2048
Mvaa 180,8,224
Mvaa 180,12,228
Ra 240,10,12288
Mvaa 184,16,224
buffer_load_dwordx4 v7, s[12:15], s53 offen offset:1024 lds
Mvaa 184,20,228
Ta 68,14,16384
Ta 70,14,18432
Mvaa 188,24,224
Mvaa 188,28,228
Ra 244,11,12288
Mvaa 192,32,224
buffer_load_dwordx4 v6, s[12:15], s54 offen offset:2048 lds
Mvaa 192,36,228
Ta 72,15,0
Ta 74,15,2048
Mvaa 196,40,224
Mvaa 196,44,228
Ra 248,10,14336
Mvaa 200,48,224
buffer_load_dwordx4 v7, s[12:15], s55 offen offset:3072 lds
Mvaa 200,52,228
Ta 76,15,16384
Ta 78,15,18432
Mvaa 204,56,224
Mvaa 204,60,228
s_add_u32 m0, s57, 4096
Ra 252,11,14336
Mvaa 208,0,232
buffer_load_dwordx4 v8, s[12:15], s52 offen offset:0 lds
Mvaa 208,4,236
Mvaa 212,8,232
Mvaa 212,12,236
Ta 80,24,0
Ta 82,24,2048
Mvaa 216,16,232
buffer_load_dwordx4 v9, s[12:15], s53 offen offset:1024 lds
Mvaa 216,20,236
Ta 84,24,16384
s_waitcnt lgkmcnt(9)
Ta 86,24,18432
Mvaa 220,24,232
Mvaa 220,28,236
Ta 88,25,0
Ta 90,25,2048
Mvaa 224,32,232
buffer_load_dwordx4 v8, s[12:15], s54 offen offset:2048 lds
Mvaa 224,36,236
Mvaa 228,40,232
Mvaa 228,44,236
Ta 92,25,16384
Ta 94,25,18432
Mvaa 232,48,232
buffer_load_dwordx4 v9, s[12:15], s55 offen offset:3072 lds
Mvaa 232,52,236
s_waitcnt vmcnt(11)
Ta 96,26,0
s_waitcnt lgkmcnt(9)
Ta 98,26,2048
Mvaa 236,56,232
s_barrier
v_xor_b32 v6, 524288, v6
v_xor_b32 v7, 524288, v7
Mvaa 236,60,236
s_add_u32 m0, s56, 0
Ta 100,26,16384
Ta 102,26,18432
Mvaa 240,0,240
buffer_load_dwordx4 v2, s[8:11], s48 offen offset:0 lds
Mvaa 240,4,244
v_xor_b32 v8, 524288, v8
v_xor_b32 v9, 524288, v9
Mvaa 244,8,240
Mvaa 244,12,244
Ra 224,12,0
Mvaa 248,16,240
buffer_load_dwordx4 v3, s[8:11], s49 offen offset:1024 lds
Mvaa 248,20,244
Ta 104,27,0
Ta 106,27,2048
Mvaa 252,24,240
Mvaa 252,28,244
s_waitcnt lgkmcnt(9)
Ra 228,13,0
Maaa 128,32,240
buffer_load_dwordx4 v2, s[8:11], s50 offen offset:2048 lds
Maaa 128,36,244
Ta 108,27,16384
Ta 110,27,18432
Maaa 132,40,240
Maaa 132,44,244
Ra 232,12,2048
Maaa 136,48,240
buffer_load_dwordx4 v3, s[8:11], s51 offen offset:3072 lds
Maaa 136,52,244
Ta 112,28,0
Ta 114,28,2048
Maaa 140,56,240
Maaa 140,60,244
s_add_u32 m0, s56, 4096
s_waitcnt lgkmcnt(9)
Ra 236,13,2048
Maaa 144,0,248
buffer_load_dwordx4 v4, s[8:11], s48 offen offset:0 lds
Maaa 144,4,252
Maaa 148,8,248
Maaa 148,12,252
Ta 116,28,16384
Ta 118,28,18432
Maaa 152,16,248
buffer_load_dwordx4 v5, s[8:11], s49 offen offset:1024 lds
Maaa 152,20,252
Ta 120,29,0
Ta 122,29,2048
Maaa 156,24,248
Maaa 156,28,252
Ta 124,29,16384
s_waitcnt lgkmcnt(9)
Ta 126,29,18432
Maaa 160,32,248
buffer_load_dwordx4 v4, s[8:11], s50 offen offset:2048 lds
Maaa 160,36,252
Maaa 164,40,248
Maaa 164,44,252
Maaa 168,48,248
buffer_load_dwordx4 v5, s[8:11], s51 offen offset:3072 lds
Maaa 168,52,252
v_xor_b32 v2, 128, v2
v_xor_b32 v3, 128, v3
Maaa 172,56,248
s_waitcnt lgkmcnt(6)
buffer_load_dword v1, v47, s[60:63], 0 offen
v_xor_b32 v4, 128, v4
v_xor_b32 v5, 128, v5
Maaa 172,60,252
s_waitcnt lgkmcnt(0)
s_mul_i32 vcc_lo, s59, 7
v_xor_b32 v47, vcc_lo, v47
Mvaa 48,64,224
buffer_load_dword v44, v45, s[16:19], s47 offen
Mvaa 48,68,228
s_add_u32 s47, s47, 2097152
v_lshrrev_b32 v32, 4, v0
v_and_b32 v33, 15, v0
Mvaa 52,72,224
s_lshl_b32 s3, s32, 4
v_add_u32 v34, s3, v32
v_lshlrev_b32_e64 v36, 1, v32
Mvaa 52,76,228
Ra 240,12,4096
Mvaa 56,80,224
v_xor_b32 v36, v36, v33
v_xor_b32 v37, 8, v36
Mvaa 56,84,228
Mvaa 60,88,224
Mvaa 60,92,228
Ra 244,13,4096
Mvaa 64,96,224
s_getpc_b64 s[6:7]
L_cpf2:
s_add_u32 s6, s6, (L_phase2-L_cpf2)&0xffffffff
s_addc_u32 s7, s7, ((L_phase2-L_cpf2)>>32)&0xffffffff
Mvaa 64,100,228
s_lshr_b32 s3, s2, 3
s_lshl_b32 s3, s3, 2
s_add_u32 s3, s3, s32
Mvaa 68,104,224
s_lshl_b32 s3, s3, 10
v_and_b32 v42, 7, v0
v_lshlrev_b32_e64 v42, 7, v42
Mvaa 68,108,228
Ra 248,12,6144
Mvaa 72,112,224
v_add_u32_e64 v42, s3, v42
v_min_u32 v42, L_k2_fin-L_phase2-4, v42
Mvaa 72,116,228
v_mov_b32_e64 v41, s7
Mvaa 76,120,224
v_add_co_u32 v40, vcc, s6, v42
s_nop 1
v_addc_co_u32 v41, vcc, 0, v41, vcc
Mvaa 76,124,228
Ra 252,13,6144
Mvaa 80,64,232
global_load_dword v38, v[40:41], off
Mvaa 80,68,236
Mvaa 84,72,232
Mvaa 84,76,236
Mvaa 88,80,232
Mvaa 88,84,236
Mvaa 92,88,232
Mvaa 92,92,236
Mvaa 96,96,232
Mvaa 96,100,236
Mvaa 100,104,232
Mvaa 100,108,236
Mvaa 104,112,232
Mvaa 104,116,236
Mvaa 108,120,232
s_waitcnt lgkmcnt(0)
Mvaa 108,124,236
Mvaa 112,64,240
Mvaa 112,68,244
Mvaa 116,72,240
Mvaa 116,76,244
Ra 224,12,8192
Mvaa 120,80,240
Mvaa 120,84,244
Mvaa 124,88,240
Mvaa 124,92,244
Ra 228,13,8192
Mvaa 128,96,240
Mvaa 128,100,244
Mvaa 132,104,240
Mvaa 132,108,244
Ra 232,12,10240
Mvaa 136,112,240
Mvaa 136,116,244
Mvaa 140,120,240
Mvaa 140,124,244
Ra 236,13,10240
Mvaa 144,64,248
Mvaa 144,68,252
Mvaa 148,72,248
Mvaa 148,76,252
Mvaa 152,80,248
Mvaa 152,84,252
Mvaa 156,88,248
Mvaa 156,92,252
Mvaa 160,96,248
Mvaa 160,100,252
Mvaa 164,104,248
Mvaa 164,108,252
Mvaa 168,112,248
Mvaa 168,116,252
s_waitcnt vmcnt(11)
Mvaa 172,120,248
s_waitcnt lgkmcnt(0)
s_barrier
Mvaa 172,124,252
s_add_u32 m0, s57, 65536
Mvaa 176,64,224
buffer_load_dwordx4 v6, s[12:15], s52 offen offset:0 lds
Mvaa 176,68,228
Ta 0,16,0
Ta 2,16,2048
Mvaa 180,72,224
Mvaa 180,76,228
Ra 240,12,12288
Mvaa 184,80,224
buffer_load_dwordx4 v7, s[12:15], s53 offen offset:1024 lds
Mvaa 184,84,228
Ta 4,16,16384
Ta 6,16,18432
Mvaa 188,88,224
Mvaa 188,92,228
Ra 244,13,12288
Mvaa 192,96,224
buffer_load_dwordx4 v6, s[12:15], s54 offen offset:2048 lds
Mvaa 192,100,228
Ta 8,17,0
Ta 10,17,2048
Mvaa 196,104,224
Mvaa 196,108,228
Ra 248,12,14336
Mvaa 200,112,224
buffer_load_dwordx4 v7, s[12:15], s55 offen offset:3072 lds
Mvaa 200,116,228
Ta 12,17,16384
Ta 14,17,18432
Mvaa 204,120,224
Mvaa 204,124,228
s_add_u32 m0, s57, 69632
Ra 252,13,14336
Mvaa 208,64,232
buffer_load_dwordx4 v8, s[12:15], s52 offen offset:0 lds
Mvaa 208,68,236
Mvaa 212,72,232
Mvaa 212,76,236
Ta 16,18,0
Ta 18,18,2048
Mvaa 216,80,232
buffer_load_dwordx4 v9, s[12:15], s53 offen offset:1024 lds
Mvaa 216,84,236
Ta 20,18,16384
s_waitcnt lgkmcnt(9)
Ta 22,18,18432
Mvaa 220,88,232
Mvaa 220,92,236
Ta 24,19,0
Ta 26,19,2048
Mvaa 224,96,232
buffer_load_dwordx4 v8, s[12:15], s54 offen offset:2048 lds
Mvaa 224,100,236
Mvaa 228,104,232
Mvaa 228,108,236
Ta 28,19,16384
Ta 30,19,18432
Mvaa 232,112,232
buffer_load_dwordx4 v9, s[12:15], s55 offen offset:3072 lds
Mvaa 232,116,236
s_waitcnt vmcnt(11)
Ta 32,20,0
s_waitcnt lgkmcnt(9)
Ta 34,20,2048
Mvaa 236,120,232
s_barrier
Mvaa 236,124,236
s_add_u32 m0, s56, 65536
Ta 36,20,16384
Ta 38,20,18432
Mvaa 240,64,240
buffer_load_dwordx4 v2, s[8:11], s48 offen offset:0 lds
Mvaa 240,68,244
Mvaa 244,72,240
Mvaa 244,76,244
Ra 224,10,0
Mvaa 248,80,240
buffer_load_dwordx4 v3, s[8:11], s49 offen offset:1024 lds
Mvaa 248,84,244
Ta 40,21,0
Ta 42,21,2048
Mvaa 252,88,240
Mvaa 252,92,244
s_waitcnt lgkmcnt(9)
Ra 228,11,0
Maaa 128,96,240
buffer_load_dwordx4 v2, s[8:11], s50 offen offset:2048 lds
Maaa 128,100,244
Ta 44,21,16384
Ta 46,21,18432
Maaa 132,104,240
Maaa 132,108,244
Ra 232,10,2048
Maaa 136,112,240
buffer_load_dwordx4 v3, s[8:11], s51 offen offset:3072 lds
Maaa 136,116,244
Ta 48,22,0
Ta 50,22,2048
Maaa 140,120,240
Maaa 140,124,244
s_add_u32 m0, s56, 69632
s_waitcnt lgkmcnt(9)
Ra 236,11,2048
Maaa 144,64,248
buffer_load_dwordx4 v4, s[8:11], s48 offen offset:0 lds
Maaa 144,68,252
Maaa 148,72,248
Maaa 148,76,252
Ta 52,22,16384
Ta 54,22,18432
Maaa 152,80,248
buffer_load_dwordx4 v5, s[8:11], s49 offen offset:1024 lds
Maaa 152,84,252
Ta 56,23,0
Ta 58,23,2048
Maaa 156,88,248
Maaa 156,92,252
Ta 60,23,16384
s_waitcnt lgkmcnt(9)
Ta 62,23,18432
Maaa 160,96,248
buffer_load_dwordx4 v4, s[8:11], s50 offen offset:2048 lds
Maaa 160,100,252
Maaa 164,104,248
Maaa 164,108,252
Maaa 168,112,248
buffer_load_dwordx4 v5, s[8:11], s51 offen offset:3072 lds
Maaa 168,116,252
Maaa 172,120,248
s_waitcnt lgkmcnt(6)
Maaa 172,124,252
s_waitcnt lgkmcnt(0)
Mvaa 48,0,224
buffer_load_dword v1, v31, s[28:31], s37 offen sc1
Mvaa 48,4,228
s_mov_b32 s8, s16
s_mov_b32 s9, s17
s_mov_b32 s10, s18
Mvaa 52,8,224
s_add_u32 s16, s66, 46137344
s_addc_u32 s17, s67, 0
s_and_b32 s17, s17, 0xffff
Mvaa 52,12,228
Ra 240,10,4096
Mvaa 56,16,224
s_mov_b32 s18, 16777216
s_mov_b32 s19, 0x20000
s_mov_b32 s48, 0
Mvaa 56,20,228
s_mov_b32 s49, 31744
s_mov_b32 s50, 63488
s_mov_b32 s51, 95232
Mvaa 60,24,224
v_lshlrev_b32 v35, 13, v34
v_lshl_add_u32 v8, v36, 4, v35
Mvaa 60,28,228
Ra 244,11,4096
Mvaa 64,32,224
v_lshl_add_u32 v9, v37, 4, v35
v_lshlrev_b32_e64 v2, 4, v0
Mvaa 64,36,228
v_add_u32 v3, 65536, v2
v_add_u32_e64 v4, s44, v2
Mvaa 68,40,224
v_mov_b32 v7, 0
v_lshlrev_b32 v35, 2, v32
Mvaa 68,44,228
Ra 248,10,6144
Mvaa 72,48,224
v_sub_u32_e64 v35, v33, v35
Mvaa 72,52,228
s_lshl_b32 s3, s32, 4
v_add_u32 v5, s3, v35
Mvaa 76,56,224
s_sub_u32 s3, 48, s3
v_add_u32 v6, s3, v35
Mvaa 76,60,228
Ra 252,11,6144
Mvaa 80,0,232
s_mul_i32 s3, s33, 1116160
s_add_u32 s3, s3, 8388608
s_add_u32 s12, s66, s3
s_addc_u32 s13, s67, 0
s_and_b32 s13, s13, 0xffff
Mvaa 80,4,236
s_mov_b32 s14, 0
s_mov_b32 s15, 0x20000
s_mul_i32 s14, s36, 34816
Mvaa 84,8,232
buffer_load_dword v44, v45, s[8:11], s47 offen
Mvaa 84,12,236
s_add_u32 s47, s47, 2097152
v_lshrrev_b32 v42, 2, v33
v_lshl_add_u32 v43, v32, 3, v42
Mvaa 88,16,232
v_lshlrev_b32 v43, 8, v43
v_and_b32 v46, 3, v0
Mvaa 88,20,236
v_lshl_add_u32 v43, v46, 3, v43
v_and_b32_e64 v46, 1, v32
Mvaa 92,24,232
v_lshl_add_u32 v42, v46, 2, v42
v_lshl_add_u32 v16, v42, 5, v43
Mvaa 92,28,236
v_xor_b32 v17, 32, v16
v_xor_b32 v18, 64, v16
Mvaa 96,32,232
v_xor_b32 v19, 96, v16
v_xor_b32 v20, 128, v16
Mvaa 96,36,236
v_xor_b32 v21, 160, v16
v_xor_b32 v22, 192, v16
Mvaa 100,40,232
v_xor_b32 v23, 224, v16
Mvaa 100,44,236
Mvaa 104,48,232
Mvaa 104,52,236
Mvaa 108,56,232
s_waitcnt lgkmcnt(0)
Mvaa 108,60,236
Mvaa 112,0,240
Mvaa 112,4,244
Mvaa 116,8,240
Mvaa 116,12,244
Ra 224,10,8192
Mvaa 120,16,240
Mvaa 120,20,244
Mvaa 124,24,240
Mvaa 124,28,244
Ra 228,11,8192
Mvaa 128,32,240
Mvaa 128,36,244
Mvaa 132,40,240
Mvaa 132,44,244
Ra 232,10,10240
Mvaa 136,48,240
Mvaa 136,52,244
Mvaa 140,56,240
Mvaa 140,60,244
Ra 236,11,10240
Mvaa 144,0,248
Mvaa 144,4,252
Mvaa 148,8,248
Mvaa 148,12,252
Mvaa 152,16,248
Mvaa 152,20,252
Mvaa 156,24,248
Mvaa 156,28,252
Mvaa 160,32,248
Mvaa 160,36,252
Mvaa 164,40,248
Mvaa 164,44,252
Mvaa 168,48,248
Mvaa 168,52,252
s_waitcnt vmcnt(10)
Mvaa 172,56,248
s_waitcnt lgkmcnt(0)
s_barrier
Mvaa 172,60,252
s_add_u32 m0, s44, 0
Mvaa 176,0,224
buffer_load_dwordx4 v8, s[8:11], s48 offen offset:0 lds
Mvaa 176,4,228
Ta 64,14,0
Ta 66,14,2048
Mvaa 180,8,224
Mvaa 180,12,228
Ra 240,10,12288
Mvaa 184,16,224
buffer_load_dwordx4 v8, s[8:11], s49 offen offset:1024 lds
Mvaa 184,20,228
Ta 68,14,16384
Ta 70,14,18432
Mvaa 188,24,224
Mvaa 188,28,228
Ra 244,11,12288
Mvaa 192,32,224
buffer_load_dwordx4 v9, s[8:11], s50 offen offset:2048 lds
Mvaa 192,36,228
Ta 72,15,0
Ta 74,15,2048
Mvaa 196,40,224
Mvaa 196,44,228
Ra 248,10,14336
Mvaa 200,48,224
buffer_load_dwordx4 v9, s[8:11], s51 offen offset:3072 lds
Mvaa 200,52,228
Ta 76,15,16384
Ta 78,15,18432
Mvaa 204,56,224
v_add_u32 v8, 524288, v8
v_add_u32 v9, 524288, v9
Mvaa 204,60,228
s_add_u32 m0, s44, 16384
Ra 252,11,14336
Mvaa 208,0,232
buffer_load_dwordx4 v8, s[8:11], s48 offen offset:0 lds
Mvaa 208,4,236
Mvaa 212,8,232
Mvaa 212,12,236
Ta 80,24,0
Ta 82,24,2048
Mvaa 216,16,232
buffer_load_dwordx4 v8, s[8:11], s49 offen offset:1024 lds
Mvaa 216,20,236
Ta 84,24,16384
s_waitcnt lgkmcnt(9)
Ta 86,24,18432
Mvaa 220,24,232
Mvaa 220,28,236
Ta 88,25,0
Ta 90,25,2048
Mvaa 224,32,232
buffer_load_dwordx4 v9, s[8:11], s50 offen offset:2048 lds
Mvaa 224,36,236
Mvaa 228,40,232
s_mul_i32 s3, s45, 33792
v_add_u32_e64 v10, s3, v2
Mvaa 228,44,236
Ta 92,25,16384
Ta 94,25,18432
Mvaa 232,48,232
buffer_load_dwordx4 v9, s[8:11], s51 offen offset:3072 lds
Mvaa 232,52,236
s_waitcnt vmcnt(10)
Ta 96,26,0
s_waitcnt lgkmcnt(9)
Ta 98,26,2048
Mvaa 236,56,232
s_barrier
v_add_u32 v8, 524288, v8
v_add_u32 v9, 524288, v9
Mvaa 236,60,236
s_add_u32 m0, s44, 32768
Ta 100,26,16384
Ta 102,26,18432
Mvaa 240,0,240
buffer_load_dwordx4 v8, s[8:11], s48 offen offset:0 lds
Mvaa 240,4,244
s_mul_i32 s3, s46, 33792
v_add_u32 v11, s3, v2
Mvaa 244,8,240
Mvaa 244,12,244
Ra 224,12,0
Mvaa 248,16,240
buffer_load_dwordx4 v8, s[8:11], s49 offen offset:1024 lds
Mvaa 248,20,244
Ta 104,27,0
Ta 106,27,2048
Mvaa 252,24,240
Mvaa 252,28,244
s_waitcnt lgkmcnt(9)
Ra 228,13,0
Maaa 128,32,240
buffer_load_dwordx4 v9, s[8:11], s50 offen offset:2048 lds
Maaa 128,36,244
Ta 108,27,16384
Ta 110,27,18432
Maaa 132,40,240
Maaa 132,44,244
Ra 232,12,2048
Maaa 136,48,240
buffer_load_dwordx4 v9, s[8:11], s51 offen offset:3072 lds
Maaa 136,52,244
Ta 112,28,0
Ta 114,28,2048
Maaa 140,56,240
v_add_u32 v8, 524288, v8
v_add_u32 v9, 524288, v9
Maaa 140,60,244
s_add_u32 m0, s44, 49152
s_waitcnt lgkmcnt(9)
Ra 236,13,2048
Maaa 144,0,248
buffer_load_dwordx4 v8, s[8:11], s48 offen offset:0 lds
Maaa 144,4,252
Maaa 148,8,248
Maaa 148,12,252
Ta 116,28,16384
Ta 118,28,18432
Maaa 152,16,248
buffer_load_dwordx4 v8, s[8:11], s49 offen offset:1024 lds
Maaa 152,20,252
Ta 120,29,0
Ta 122,29,2048
Maaa 156,24,248
Maaa 156,28,252
Ta 124,29,16384
s_waitcnt lgkmcnt(9)
Ta 126,29,18432
Maaa 160,32,248
buffer_load_dwordx4 v9, s[8:11], s50 offen offset:2048 lds
Maaa 160,36,252
Maaa 164,40,248
Maaa 164,44,252
Maaa 168,48,248
buffer_load_dwordx4 v9, s[8:11], s51 offen offset:3072 lds
Maaa 168,52,252
v_add_u32 v8, 524288, v8
v_add_u32 v9, 524288, v9
Maaa 172,56,248
s_waitcnt lgkmcnt(6)
Maaa 172,60,252
s_waitcnt lgkmcnt(0)
Mvaa 48,64,224
v_mov_b32 v14, v40
v_mov_b32_e64 v15, v41
Mvaa 48,68,228
Mvaa 52,72,224
Mvaa 52,76,228
Ra 240,12,4096
Mvaa 56,80,224
Mvaa 56,84,228
Mvaa 60,88,224
Mvaa 60,92,228
Ra 244,13,4096
Mvaa 64,96,224
Vc 24,48,49
Vc 25,50,51
Mvaa 64,100,228
Vc 26,52,53
Vc 27,54,55
Mvaa 68,104,224
Mvaa 68,108,228
Ra 248,12,6144
Mvaa 72,112,224
Vc 28,56,57
Vc 29,58,59
Mvaa 72,116,228
Vc 30,60,61
Vc 31,62,63
Mvaa 76,120,224
Mvaa 76,124,228
Ra 252,13,6144
Mvaa 80,64,232
Vc 32,64,65
Vc 33,66,67
Mvaa 80,68,236
Vc 34,68,69
Vc 35,70,71
Mvaa 84,72,232
Mvaa 84,76,236
Mvaa 88,80,232
Vc 36,72,73
Vc 37,74,75
Mvaa 88,84,236
Vc 38,76,77
Vc 39,78,79
Mvaa 92,88,232
Mvaa 92,92,236
Mvaa 96,96,232
Vc 40,80,81
Vc 41,82,83
Mvaa 96,100,236
Vc 42,84,85
Vc 43,86,87
Mvaa 100,104,232
s_waitcnt vmcnt(12)
Mvaa 100,108,236
s_add_u32 s59, s38, 0
Mvaa 104,112,232
v_readfirstlane_b32 s3, v1
s_nop 0
s_or_b32 s3, s3, s37
s_cmp_lt_u32 s3, 256
s_cbranch_scc1 L_spinAk
L_spinArk:
s_barrier
Mvaa 104,116,236
buffer_store_dwordx4 v[24:27], v2, s[24:27], s59 offen offset:0 sc1
Mvaa 108,120,232
s_waitcnt lgkmcnt(0)
Mvaa 108,124,236
Vc 44,88,89
Vc 45,90,91
Mvaa 112,64,240
buffer_load_dwordx4 a[0:3], v10, s[20:23], s58 offen offset:0 sc1
Mvaa 112,68,244
Vc 46,92,93
Vc 47,94,95
Mvaa 116,72,240
Vc 48,96,97
Vc 49,98,99
Mvaa 116,76,244
Ra 224,12,8192
Mvaa 120,80,240
Vc 50,100,101
Vc 51,102,103
Mvaa 120,84,244
Vc 52,104,105
Vc 53,106,107
Mvaa 124,88,240
buffer_load_dwordx4 a[4:7], v10, s[20:23], 0 offen offset:0 sc1
Mvaa 124,92,244
Ra 228,13,8192
Mvaa 128,96,240
Vc 54,108,109
Vc 55,110,111
Mvaa 128,100,244
Vc 56,112,113
Vc 57,114,115
Mvaa 132,104,240
Vc 58,116,117
Vc 59,118,119
Mvaa 132,108,244
Ra 232,12,10240
Mvaa 136,112,240
buffer_load_dwordx4 a[8:11], v11, s[20:23], s58 offen offset:0 sc1
Mvaa 136,116,244
buffer_store_dwordx4 v[28:31], v2, s[24:27], s59 offen offset:1024 sc1
Mvaa 140,120,240
Vc 60,120,121
Vc 61,122,123
Mvaa 140,124,244
Ra 236,13,10240
Mvaa 144,64,248
Vc 62,124,125
Vc 63,126,127
Mvaa 144,68,252
Vc 64,128,129
Vc 65,130,131
Mvaa 148,72,248
buffer_load_dwordx4 a[12:15], v11, s[20:23], 0 offen offset:0 sc1
Mvaa 148,76,252
Vc 66,132,133
Vc 67,134,135
Mvaa 152,80,248
Vc 68,136,137
Vc 69,138,139
Mvaa 152,84,252
Vc 70,140,141
Vc 71,142,143
Mvaa 156,88,248
Mvaa 156,92,252
Mvaa 160,96,248
buffer_load_dwordx4 a[16:19], v10, s[20:23], s58 offen offset:1024 sc1
Mvaa 160,100,252
Vc 72,144,145
Vc 73,146,147
Mvaa 164,104,248
Vc 74,148,149
Vc 75,150,151
Mvaa 164,108,252
buffer_store_dwordx4 v[32:35], v2, s[24:27], s59 offen offset:2048 sc1
Mvaa 168,112,248
Vc 76,152,153
Vc 77,154,155
Mvaa 168,116,252
Vc 78,156,157
Vc 79,158,159
Mvaa 172,120,248
s_waitcnt lgkmcnt(0)
buffer_load_dwordx4 a[20:23], v10, s[20:23], 0 offen offset:1024 sc1
Mvaa 172,124,252
Mvaa 176,64,224
Vc 80,160,161
Vc 81,162,163
Mvaa 176,68,228
Vc 82,164,165
Vc 83,166,167
Mvaa 180,72,224
Mvaa 180,76,228
Ra 240,12,12288
Mvaa 184,80,224
buffer_load_dwordx4 a[24:27], v11, s[20:23], s58 offen offset:1024 sc1
Mvaa 184,84,228
Vc 84,168,169
Vc 85,170,171
Mvaa 188,88,224
Vc 86,172,173
Vc 87,174,175
Mvaa 188,92,228
Ra 244,13,12288
Mvaa 192,96,224
Vc 88,176,177
Vc 89,178,179
Mvaa 192,100,228
Vc 90,180,181
Vc 91,182,183
Mvaa 196,104,224
buffer_load_dwordx4 a[28:31], v11, s[20:23], 0 offen offset:1024 sc1
Mvaa 196,108,228
Ra 248,12,14336
Mvaa 200,112,224
Vc 92,184,185
Vc 93,186,187
Mvaa 200,116,228
Vc 94,188,189
Vc 95,190,191
Mvaa 204,120,224
buffer_store_dwordx4 v[36:39], v2, s[24:27], s59 offen offset:3072 sc1
Mvaa 204,124,228
Ra 252,13,14336
Mvaa 208,64,232
buffer_load_dwordx4 a[32:35], v10, s[20:23], s58 offen offset:2048 sc1
Mvaa 208,68,236
Vc 96,192,193
Vc 97,194,195
Mvaa 212,72,232
Vc 98,196,197
Vc 99,198,199
Mvaa 212,76,236
Mvaa 216,80,232
Vc 100,200,201
Vc 101,202,203
Mvaa 216,84,236
Vc 102,204,205
Vc 103,206,207
Mvaa 220,88,232
buffer_load_dwordx4 a[36:39], v10, s[20:23], 0 offen offset:2048 sc1
Mvaa 220,92,236
Mvaa 224,96,232
Vc 104,208,209
Vc 105,210,211
Mvaa 224,100,236
Vc 106,212,213
Vc 107,214,215
Mvaa 228,104,232
Mvaa 228,108,236
Mvaa 232,112,232
buffer_load_dwordx4 a[40:43], v11, s[20:23], s58 offen offset:2048 sc1
Mvaa 232,116,236
Vc 108,216,217
Vc 109,218,219
Mvaa 236,120,232
s_waitcnt lgkmcnt(0)
Mvaa 236,124,236
Vc 110,220,221
Vc 111,222,223
Mvaa 240,64,240
s_add_u32 s59, s38, 4096
Mvaa 240,68,244
buffer_store_dwordx4 v[40:43], v2, s[24:27], s59 offen offset:0 sc1
Mvaa 244,72,240
buffer_load_dwordx4 a[44:47], v11, s[20:23], 0 offen offset:2048 sc1
Mvaa 244,76,244
Vc 112,224,225
Vc 113,226,227
Mvaa 248,80,240
Vc 114,228,229
Vc 115,230,231
Mvaa 248,84,244
Vc 116,232,233
Vc 117,234,235
Mvaa 252,88,240
Vc 118,236,237
Vc 119,238,239
Mvaa 252,92,244
Maaa 128,96,240
buffer_load_dwordx4 a[48:51], v10, s[20:23], s58 offen offset:3072 sc1
Maaa 128,100,244
Ta 192,16,0
Ta 194,16,1024
Maaa 132,104,240
Vc 120,240,241
Vc 121,242,243
Maaa 132,108,244
Ta 196,17,0
Ta 198,17,1024
Maaa 136,112,240
Vc 122,244,245
Vc 123,246,247
Maaa 136,116,244
Ta 200,18,0
Ta 202,18,1024
Maaa 140,120,240
buffer_load_dwordx4 a[52:55], v10, s[20:23], 0 offen offset:3072 sc1
Maaa 140,124,244
Ta 204,19,0
Ta 206,19,1024
Maaa 144,64,248
Vc 124,248,249
Vc 125,250,251
Maaa 144,68,252
Ta 208,20,0
Ta 210,20,1024
Maaa 148,72,248
Vc 126,252,253
Vc 127,254,255
Maaa 148,76,252
Ta 212,21,0
Ta 214,21,1024
Maaa 152,80,248
buffer_load_dwordx4 a[56:59], v11, s[20:23], s58 offen offset:3072 sc1
Maaa 152,84,252
Ta 216,22,0
Ta 218,22,1024
Maaa 156,88,248
buffer_store_dwordx4 v[44:47], v2, s[24:27], s59 offen offset:1024 sc1
Maaa 156,92,252
Ta 220,23,0
s_waitcnt lgkmcnt(9)
Ta 222,23,1024
Maaa 160,96,248
Maaa 160,100,252
Maaa 164,104,248
buffer_load_dwordx4 a[60:63], v11, s[20:23], 0 offen offset:3072 sc1
Maaa 164,108,252
v_add_u32 v10, 4096, v10
v_add_u32 v11, 4096, v11
Maaa 168,112,248
Maaa 168,116,252
Maaa 172,120,248
Maaa 172,124,252
s_branch L_phase2
L_k1_vpath:
Zvaa 48,224,0
v_and_b32_e64 v46, 7, v0
v_mul_u32_u24 v30, 2064, v46
Mvaa 48,228,4
s_add_u32 m0, s57, 65536
Zvaa 52,232,0
buffer_load_dwordx4 v6, s[12:15], s52 offen offset:0 lds
Mvaa 52,236,4
Ra 240,10,4096
Zvaa 56,224,8
buffer_load_dwordx4 v7, s[12:15], s53 offen offset:1024 lds
Mvaa 56,228,12
v_lshrrev_b32_e64 v31, 3, v0
Zvaa 60,232,8
buffer_load_dwordx4 v6, s[12:15], s54 offen offset:2048 lds
Mvaa 60,236,12
Ra 244,11,4096
Zvaa 64,224,16
buffer_load_dwordx4 v7, s[12:15], s55 offen offset:3072 lds
Mvaa 64,228,20
s_add_u32 m0, s57, 69632
Zvaa 68,232,16
buffer_load_dwordx4 v8, s[12:15], s52 offen offset:0 lds
Mvaa 68,236,20
Ra 248,10,6144
Zvaa 72,224,24
buffer_load_dwordx4 v9, s[12:15], s53 offen offset:1024 lds
Mvaa 72,228,28
s_lshl_b32 s3, s32, 9
s_add_u32 s3, s3, 131072
v_lshl_add_u32 v30, v31, 4, v30
Zvaa 76,232,24
buffer_load_dwordx4 v8, s[12:15], s54 offen offset:2048 lds
Mvaa 76,236,28
s_waitcnt lgkmcnt(9)
Ra 252,11,6144
Zvaa 80,224,32
buffer_load_dwordx4 v9, s[12:15], s55 offen offset:3072 lds
Mvaa 80,228,36
s_add_u32 m0, s56, 65536
v_xor_b32 v6, 1572864, v6
v_xor_b32 v7, 1572864, v7
Zvaa 84,232,32
buffer_load_dwordx4 v2, s[8:11], s48 offen offset:0 lds
Mvaa 84,236,36
v_xor_b32 v8, 1572864, v8
v_xor_b32 v9, 1572864, v9
Zvaa 88,224,40
buffer_load_dwordx4 v3, s[8:11], s49 offen offset:1024 lds
Mvaa 88,228,44
v_add_u32 v30, s3, v30
v_lshlrev_b32 v31, 8, v31
Zvaa 92,232,40
buffer_load_dwordx4 v2, s[8:11], s50 offen offset:2048 lds
Mvaa 92,236,44
v_lshl_add_u32 v46, v46, 4, v31
s_waitcnt lgkmcnt(8)
Zvaa 96,224,48
buffer_load_dwordx4 v3, s[8:11], s51 offen offset:3072 lds
Mvaa 96,228,52
s_add_u32 m0, s56, 69632
Zvaa 100,232,48
buffer_load_dwordx4 v4, s[8:11], s48 offen offset:0 lds
Mvaa 100,236,52
Rv 34,30,128
Rv 38,30,256
s_waitcnt lgkmcnt(6)
Zvaa 104,224,56
buffer_load_dwordx4 v5, s[8:11], s49 offen offset:1024 lds
Mvaa 104,228,60
Rv 42,30,384
Rv 30,30,0
Zvaa 108,232,56
s_waitcnt lgkmcnt(4)
buffer_load_dwordx4 v4, s[8:11], s50 offen offset:2048 lds
Mvaa 108,236,60
s_lshr_b32 s3, s2, 1
s_mul_i32 s3, s3, 33792
s_add_u32 s3, s3, s57
Zvaa 112,240,0
buffer_load_dwordx4 v5, s[8:11], s51 offen offset:3072 lds
Mvaa 112,244,4
v_xor_b32 v2, 384, v2
v_xor_b32 v3, 384, v3
Zvaa 116,248,0
s_and_b32 s39, s2, 1
s_lshl_b32 s39, s39, 7
s_add_u32 s3, s3, s39
Mvaa 116,252,4
Ra 224,10,8192
v_xor_b32 v4, 384, v4
Zvaa 120,240,8
s_add_u32 s39, s3, 4096
Mvaa 120,244,12
v_xor_b32 v5, 384, v5
Zvaa 124,248,8
Mvaa 124,252,12
Ra 228,11,8192
Zvaa 128,240,16
Mvaa 128,244,20
Zvaa 132,248,16
Mvaa 132,252,20
Ra 232,10,10240
Zvaa 136,240,24
buffer_load_dword v1, v47, s[60:63], 0 offen
Mvaa 136,244,28
s_mul_i32 vcc_lo, s59, 1
v_xor_b32 v47, vcc_lo, v47
Zvaa 140,248,24
Mvaa 140,252,28
Ra 236,11,10240
Zvaa 144,240,32
Mvaa 144,244,36
Zvaa 148,248,32
Mvaa 148,252,36
Zvaa 152,240,40
Mvaa 152,244,44
Zvaa 156,248,40
Mvaa 156,252,44
Zvaa 160,240,48
Mvaa 160,244,52
Zvaa 164,248,48
Mvaa 164,252,52
Zvaa 168,240,56
Mvaa 168,244,60
s_waitcnt vmcnt(9)
Zvaa 172,248,56
s_waitcnt lgkmcnt(0)
s_barrier
Mvaa 172,252,60
s_add_u32 m0, s57, 0
Zvaa 176,224,0
buffer_load_dwordx4 v6, s[12:15], s52 offen offset:0 lds
Mvaa 176,228,4
Ta 64,14,0
Ta 66,14,2048
Zvaa 180,232,0
Mvaa 180,236,4
Ra 240,10,12288
Zvaa 184,224,8
buffer_load_dwordx4 v7, s[12:15], s53 offen offset:1024 lds
Mvaa 184,228,12
Ta 68,14,16384
Ta 70,14,18432
Zvaa 188,232,8
Mvaa 188,236,12
Ra 244,11,12288
Zvaa 192,224,16
buffer_load_dwordx4 v6, s[12:15], s54 offen offset:2048 lds
Mvaa 192,228,20
Ta 72,15,0
Ta 74,15,2048
Zvaa 196,232,16
Mvaa 196,236,20
Ra 248,10,14336
Zvaa 200,224,24
buffer_load_dwordx4 v7, s[12:15], s55 offen offset:3072 lds
Mvaa 200,228,28
Ta 76,15,16384
Ta 78,15,18432
Zvaa 204,232,24
Mvaa 204,236,28
s_add_u32 m0, s57, 4096
Ra 252,11,14336
Zvaa 208,224,32
buffer_load_dwordx4 v8, s[12:15], s52 offen offset:0 lds
Mvaa 208,228,36
Zvaa 212,232,32
Mvaa 212,236,36
Ta 80,24,0
Ta 82,24,2048
Zvaa 216,224,40
buffer_load_dwordx4 v9, s[12:15], s53 offen offset:1024 lds
Mvaa 216,228,44
Ta 84,24,16384
s_waitcnt lgkmcnt(9)
Ta 86,24,18432
Zvaa 220,232,40
Mvaa 220,236,44
Ta 88,25,0
Ta 90,25,2048
Zvaa 224,224,48
buffer_load_dwordx4 v8, s[12:15], s54 offen offset:2048 lds
Mvaa 224,228,52
Zvaa 228,232,48
Mvaa 228,236,52
Ta 92,25,16384
Ta 94,25,18432
Zvaa 232,224,56
buffer_load_dwordx4 v9, s[12:15], s55 offen offset:3072 lds
Mvaa 232,228,60
s_waitcnt vmcnt(9)
Ta 96,26,0
s_waitcnt lgkmcnt(9)
Ta 98,26,2048
Zvaa 236,232,56
s_barrier
v_xor_b32 v6, 524288, v6
v_xor_b32 v7, 524288, v7
Mvaa 236,236,60
s_add_u32 m0, s56, 0
Ta 100,26,16384
Ta 102,26,18432
Zvaa 240,240,0
buffer_load_dwordx4 v2, s[8:11], s48 offen offset:0 lds
Mvaa 240,244,4
v_xor_b32 v8, 524288, v8
v_xor_b32 v9, 524288, v9
Zvaa 244,248,0
Mvaa 244,252,4
Ra 224,12,0
Zvaa 248,240,8
buffer_load_dwordx4 v3, s[8:11], s49 offen offset:1024 lds
Mvaa 248,244,12
Ta 104,27,0
Ta 106,27,2048
Zvaa 252,248,8
Mvaa 252,252,12
s_waitcnt lgkmcnt(9)
Ra 228,13,0
Zaaa 128,240,16
buffer_load_dwordx4 v2, s[8:11], s50 offen offset:2048 lds
Maaa 128,244,20
Ta 108,27,16384
Ta 110,27,18432
Zaaa 132,248,16
Maaa 132,252,20
Ra 232,12,2048
Zaaa 136,240,24
buffer_load_dwordx4 v3, s[8:11], s51 offen offset:3072 lds
Maaa 136,244,28
Ta 112,28,0
Ta 114,28,2048
Zaaa 140,248,24
Maaa 140,252,28
s_add_u32 m0, s56, 4096
s_waitcnt lgkmcnt(9)
Ra 236,13,2048
Zaaa 144,240,32
buffer_load_dwordx4 v4, s[8:11], s48 offen offset:0 lds
Maaa 144,244,36
Zaaa 148,248,32
Maaa 148,252,36
Ta 116,28,16384
Ta 118,28,18432
Zaaa 152,240,40
buffer_load_dwordx4 v5, s[8:11], s49 offen offset:1024 lds
Maaa 152,244,44
Ta 120,29,0
Ta 122,29,2048
Zaaa 156,248,40
Maaa 156,252,44
Ta 124,29,16384
s_waitcnt lgkmcnt(9)
Ta 126,29,18432
Zaaa 160,240,48
buffer_load_dwordx4 v4, s[8:11], s50 offen offset:2048 lds
Maaa 160,244,52
Zaaa 164,248,48
Maaa 164,252,52
Zaaa 168,240,56
buffer_load_dwordx4 v5, s[8:11], s51 offen offset:3072 lds
Maaa 168,244,60
v_xor_b32 v2, 128, v2
v_xor_b32 v3, 128, v3
Zaaa 172,248,56
s_waitcnt lgkmcnt(6)
buffer_load_dword v1, v47, s[60:63], 0 offen
v_xor_b32 v4, 128, v4
v_xor_b32 v5, 128, v5
Maaa 172,252,60
s_waitcnt lgkmcnt(0)
s_mul_i32 vcc_lo, s59, 7
v_xor_b32 v47, vcc_lo, v47
Mvaa 48,224,64
buffer_store_dwordx4 v[30:33], v46, s[20:23], s3 offen offset:0 sc1
Mvaa 48,228,68
buffer_store_dwordx4 v[34:37], v46, s[20:23], s3 offen offset:2048 sc1
Mvaa 52,232,64
buffer_store_dwordx4 v[38:41], v46, s[20:23], s39 offen offset:0 sc1
Mvaa 52,236,68
Ra 240,12,4096
Mvaa 56,224,72
buffer_store_dwordx4 v[42:45], v46, s[20:23], s39 offen offset:2048 sc1
Mvaa 56,228,76
s_lshl_b32 s3, s34, 1
s_and_b32 s36, s32, 1
s_add_u32 s3, s3, s36
Mvaa 60,232,72
s_mul_i32 s3, s3, 1116160
s_mul_i32 s36, s33, 139264
s_add_u32 s3, s3, s36
Mvaa 60,236,76
Ra 244,13,4096
Mvaa 64,224,80
s_lshr_b32 s36, s32, 1
s_mul_i32 s36, s36, 69632
s_add_u32 s3, s3, s36
Mvaa 64,228,84
s_add_u32 s38, s3, 17408
s_lshl_b32 s39, s34, 7
s_lshl_b32 s36, s33, 2
Mvaa 68,232,80
s_add_u32 s39, s39, s36
s_add_u32 s39, s39, 5296160
v_mov_b32 v30, 1
Mvaa 68,236,84
Ra 248,12,6144
Mvaa 72,224,88
v_mov_b32_e64 v31, 0
Mvaa 72,228,92
s_cmp_eq_u32 s32, 0
s_cselect_b32 s39, s39, 2146435072
Mvaa 76,232,88
s_mov_b64 exec, 1
buffer_store_dword v31, v31, s[20:23], s39 offen sc1
s_mov_b64 exec, -1
Mvaa 76,236,92
Ra 252,13,6144
Mvaa 80,224,96
s_and_b32 s33, s2, 7
s_lshl_b32 s33, s33, 2
s_bfe_u32 s3, s2, 0x20003
Mvaa 80,228,100
s_add_u32 s33, s33, s3
s_lshr_b32 s34, s2, 5
s_lshl_b32 s64, s34, 7
Mvaa 84,232,96
s_lshl_b32 s3, s33, 2
s_add_u32 s64, s64, s3
s_add_u32 s64, s64, 5300224
Mvaa 84,236,100
s_lshl_b32 s65, s34, 8
s_sub_u32 s65, 1920, s65
v_mul_u32_u24 v32, s65, v0
Mvaa 88,224,104
s_cmp_eq_u32 s32, 0
s_cselect_b32 s64, s64, 2146435072
Mvaa 88,228,108
s_mov_b64 exec, 3
buffer_store_dword v31, v32, s[20:23], s64 offen sc1
s_mov_b64 exec, -1
Mvaa 92,232,104
s_lshl_b32 s3, s2, 2
s_add_u32 s3, s3, 5447680
v_lshlrev_b32_e64 v32, 10, v0
Mvaa 92,236,108
s_cmp_eq_u32 s32, 0
s_cselect_b32 s3, s3, 2146435072
Mvaa 96,224,112
s_mov_b64 exec, 0x1ff
buffer_store_dword v31, v32, s[20:23], s3 offen sc1
s_mov_b64 exec, -1
Mvaa 96,228,116
s_lshl_b32 s35, s34, 1
s_sub_u32 s36, 32, s35
s_add_u32 s35, s35, 2
Mvaa 100,232,112
s_lshl_b32 s44, s32, 12
s_lshl_b32 s58, s32, 1
s_sub_u32 s58, 7, s58
Mvaa 100,236,116
s_mul_i32 s58, s58, 33792
s_sub_u32 s3, 15, s34
s_lshl_b32 s45, s3, 3
Mvaa 104,224,120
s_add_u32 s45, s45, s32
s_lshl_b32 s46, s34, 3
s_add_u32 s46, s46, s32
Mvaa 104,228,124
s_mov_b32 s68, s42
s_and_b32 s69, s43, 0xffff
s_mov_b32 s70, 7340032
Mvaa 108,232,120
s_waitcnt lgkmcnt(0)
Mvaa 108,236,124
s_mov_b32 s71, 0x20000
s_cmp_eq_u32 s32, 0
s_cselect_b32 s37, 0, 2146435072
Mvaa 112,240,64
s_lshl_b32 s3, s33, 8
s_add_u32 s16, s4, s3
s_addc_u32 s17, s5, 0
s_and_b32 s17, s17, 0xffff
Mvaa 112,244,68
s_mov_b32 s18, 0
s_mov_b32 s19, 0x20000
s_sub_u32 s18, 8388608, s3
Mvaa 116,248,64
v_and_b32 v33, 15, v0
v_lshrrev_b32 v32, 1, v33
Mvaa 116,252,68
Ra 224,12,8192
Mvaa 120,240,72
v_and_b32 v33, 1, v0
v_lshlrev_b32 v32, 13, v32
Mvaa 120,244,76
v_lshl_add_u32 v45, v33, 7, v32
Mvaa 124,248,72
s_lshl_b32 s3, s32, 3
s_add_u32 s3, s3, s34
s_mul_i32 s47, s3, 65536
Mvaa 124,252,76
Ra 228,13,8192
Mvaa 128,240,80
s_bfe_u32 s6, s2, 131075
s_lshl_b32 s3, s32, 8
s_or_b32 s6, s6, s3
Mvaa 128,244,84
Mvaa 132,248,80
Mvaa 132,252,84
Ra 232,12,10240
Mvaa 136,240,88
Mvaa 136,244,92
Mvaa 140,248,88
Mvaa 140,252,92
Ra 236,13,10240
Mvaa 144,240,96
Mvaa 144,244,100
Mvaa 148,248,96
Mvaa 148,252,100
Mvaa 152,240,104
Mvaa 152,244,108
Mvaa 156,248,104
Mvaa 156,252,108
Mvaa 160,240,112
Mvaa 160,244,116
Mvaa 164,248,112
Mvaa 164,252,116
Mvaa 168,240,120
Mvaa 168,244,124
s_waitcnt vmcnt(16)
Mvaa 172,248,120
s_waitcnt lgkmcnt(0)
s_barrier
Mvaa 172,252,124
s_add_u32 m0, s57, 65536
Mvaa 176,224,64
buffer_load_dwordx4 v6, s[12:15], s52 offen offset:0 lds
Mvaa 176,228,68
Ta 0,16,0
Ta 2,16,2048
Mvaa 180,232,64
Mvaa 180,236,68
Ra 240,12,12288
Mvaa 184,224,72
buffer_load_dwordx4 v7, s[12:15], s53 offen offset:1024 lds
Mvaa 184,228,76
Ta 4,16,16384
Ta 6,16,18432
Mvaa 188,232,72
Mvaa 188,236,76
Ra 244,13,12288
Mvaa 192,224,80
buffer_load_dwordx4 v6, s[12:15], s54 offen offset:2048 lds
Mvaa 192,228,84
Ta 8,17,0
Ta 10,17,2048
Mvaa 196,232,80
Mvaa 196,236,84
Ra 248,12,14336
Mvaa 200,224,88
buffer_load_dwordx4 v7, s[12:15], s55 offen offset:3072 lds
Mvaa 200,228,92
Ta 12,17,16384
Ta 14,17,18432
Mvaa 204,232,88
Mvaa 204,236,92
s_add_u32 m0, s57, 69632
Ra 252,13,14336
Mvaa 208,224,96
buffer_load_dwordx4 v8, s[12:15], s52 offen offset:0 lds
Mvaa 208,228,100
Mvaa 212,232,96
Mvaa 212,236,100
Ta 16,18,0
Ta 18,18,2048
Mvaa 216,224,104
buffer_load_dwordx4 v9, s[12:15], s53 offen offset:1024 lds
Mvaa 216,228,108
Ta 20,18,16384
s_waitcnt lgkmcnt(9)
Ta 22,18,18432
Mvaa 220,232,104
Mvaa 220,236,108
Ta 24,19,0
Ta 26,19,2048
Mvaa 224,224,112
buffer_load_dwordx4 v8, s[12:15], s54 offen offset:2048 lds
Mvaa 224,228,116
Mvaa 228,232,112
Mvaa 228,236,116
Ta 28,19,16384
Ta 30,19,18432
Mvaa 232,224,120
buffer_load_dwordx4 v9, s[12:15], s55 offen offset:3072 lds
Mvaa 232,228,124
s_waitcnt vmcnt(16)
Ta 32,20,0
s_waitcnt lgkmcnt(9)
Ta 34,20,2048
Mvaa 236,232,120
s_barrier
v_xor_b32 v6, 3670016, v6
v_xor_b32 v7, 3670016, v7
Mvaa 236,236,124
s_add_u32 m0, s56, 65536
Ta 36,20,16384
Ta 38,20,18432
Mvaa 240,240,64
buffer_load_dwordx4 v2, s[8:11], s48 offen offset:0 lds
Mvaa 240,244,68
v_xor_b32 v8, 3670016, v8
v_xor_b32 v9, 3670016, v9
Mvaa 244,248,64
Mvaa 244,252,68
Ra 224,10,0
Mvaa 248,240,72
buffer_load_dwordx4 v3, s[8:11], s49 offen offset:1024 lds
Mvaa 248,244,76
Ta 40,21,0
Ta 42,21,2048
Mvaa 252,248,72
Mvaa 252,252,76
s_waitcnt lgkmcnt(9)
Ra 228,11,0
Maaa 128,240,80
buffer_load_dwordx4 v2, s[8:11], s50 offen offset:2048 lds
Maaa 128,244,84
Ta 44,21,16384
Ta 46,21,18432
Maaa 132,248,80
Maaa 132,252,84
Ra 232,10,2048
Maaa 136,240,88
buffer_load_dwordx4 v3, s[8:11], s51 offen offset:3072 lds
Maaa 136,244,92
Ta 48,22,0
Ta 50,22,2048
Maaa 140,248,88
Maaa 140,252,92
s_add_u32 m0, s56, 69632
s_waitcnt lgkmcnt(9)
Ra 236,11,2048
Maaa 144,240,96
buffer_load_dwordx4 v4, s[8:11], s48 offen offset:0 lds
Maaa 144,244,100
Maaa 148,248,96
Maaa 148,252,100
Ta 52,22,16384
Ta 54,22,18432
Maaa 152,240,104
buffer_load_dwordx4 v5, s[8:11], s49 offen offset:1024 lds
Maaa 152,244,108
Ta 56,23,0
Ta 58,23,2048
Maaa 156,248,104
Maaa 156,252,108
Ta 60,23,16384
s_waitcnt lgkmcnt(9)
Ta 62,23,18432
Maaa 160,240,112
buffer_load_dwordx4 v4, s[8:11], s50 offen offset:2048 lds
Maaa 160,244,116
Maaa 164,248,112
Maaa 164,252,116
Maaa 168,240,120
buffer_load_dwordx4 v5, s[8:11], s51 offen offset:3072 lds
Maaa 168,244,124
v_xor_b32 v2, 896, v2
v_xor_b32 v3, 896, v3
Maaa 172,248,120
s_waitcnt lgkmcnt(6)
buffer_load_dword v1, v47, s[60:63], 0 offen
v_xor_b32 v4, 896, v4
v_xor_b32 v5, 896, v5
Maaa 172,252,124
s_waitcnt lgkmcnt(0)
s_mul_i32 vcc_lo, s59, 1
v_xor_b32 v47, vcc_lo, v47
Mvaa 48,224,0
Mvaa 48,228,4
Mvaa 52,232,0
Mvaa 52,236,4
Ra 240,10,4096
Mvaa 56,224,8
Mvaa 56,228,12
Mvaa 60,232,8
Mvaa 60,236,12
Ra 244,11,4096
Mvaa 64,224,16
Mvaa 64,228,20
Mvaa 68,232,16
Mvaa 68,236,20
Ra 248,10,6144
Mvaa 72,224,24
Mvaa 72,228,28
Mvaa 76,232,24
Mvaa 76,236,28
Ra 252,11,6144
Mvaa 80,224,32
Mvaa 80,228,36
Mvaa 84,232,32
Mvaa 84,236,36
Mvaa 88,224,40
Mvaa 88,228,44
Mvaa 92,232,40
Mvaa 92,236,44
Mvaa 96,224,48
Mvaa 96,228,52
Mvaa 100,232,48
Mvaa 100,236,52
Mvaa 104,224,56
Mvaa 104,228,60
Mvaa 108,232,56
s_waitcnt lgkmcnt(0)
Mvaa 108,236,60
Mvaa 112,240,0
Mvaa 112,244,4
Mvaa 116,248,0
Mvaa 116,252,4
Ra 224,10,8192
Mvaa 120,240,8
Mvaa 120,244,12
Mvaa 124,248,8
Mvaa 124,252,12
Ra 228,11,8192
Mvaa 128,240,16
Mvaa 128,244,20
Mvaa 132,248,16
Mvaa 132,252,20
Ra 232,10,10240
Mvaa 136,240,24
Mvaa 136,244,28
Mvaa 140,248,24
Mvaa 140,252,28
Ra 236,11,10240
Mvaa 144,240,32
Mvaa 144,244,36
Mvaa 148,248,32
Mvaa 148,252,36
Mvaa 152,240,40
Mvaa 152,244,44
Mvaa 156,248,40
Mvaa 156,252,44
Mvaa 160,240,48
Mvaa 160,244,52
Mvaa 164,248,48
Mvaa 164,252,52
Mvaa 168,240,56
Mvaa 168,244,60
s_waitcnt vmcnt(9)
Mvaa 172,248,56
s_waitcnt lgkmcnt(0)
s_barrier
Mvaa 172,252,60
s_add_u32 m0, s57, 0
Mvaa 176,224,0
buffer_load_dwordx4 v6, s[12:15], s52 offen offset:0 lds
Mvaa 176,228,4
Ta 64,14,0
Ta 66,14,2048
Mvaa 180,232,0
Mvaa 180,236,4
Ra 240,10,12288
Mvaa 184,224,8
buffer_load_dwordx4 v7, s[12:15], s53 offen offset:1024 lds
Mvaa 184,228,12
Ta 68,14,16384
Ta 70,14,18432
Mvaa 188,232,8
Mvaa 188,236,12
Ra 244,11,12288
Mvaa 192,224,16
buffer_load_dwordx4 v6, s[12:15], s54 offen offset:2048 lds
Mvaa 192,228,20
Ta 72,15,0
Ta 74,15,2048
Mvaa 196,232,16
Mvaa 196,236,20
Ra 248,10,14336
Mvaa 200,224,24
buffer_load_dwordx4 v7, s[12:15], s55 offen offset:3072 lds
Mvaa 200,228,28
Ta 76,15,16384
Ta 78,15,18432
Mvaa 204,232,24
s_cmp_eq_u32 s6, 0
s_cselect_b32 s3, 0, 2146435072
Mvaa 204,236,28
s_add_u32 m0, s57, 4096
Ra 252,11,14336
Mvaa 208,224,32
buffer_load_dwordx4 v8, s[12:15], s52 offen offset:0 lds
Mvaa 208,228,36
s_mov_b64 exec, 1
buffer_atomic_add v30, v31, s[28:31], s3 offen sc1
s_mov_b64 exec, -1
Mvaa 212,232,32
Mvaa 212,236,36
Ta 80,24,0
Ta 82,24,2048
Mvaa 216,224,40
buffer_load_dwordx4 v9, s[12:15], s53 offen offset:1024 lds
Mvaa 216,228,44
Ta 84,24,16384
s_waitcnt lgkmcnt(9)
Ta 86,24,18432
Mvaa 220,232,40
Mvaa 220,236,44
Ta 88,25,0
Ta 90,25,2048
Mvaa 224,224,48
buffer_load_dwordx4 v8, s[12:15], s54 offen offset:2048 lds
Mvaa 224,228,52
Mvaa 228,232,48
Mvaa 228,236,52
Ta 92,25,16384
Ta 94,25,18432
Mvaa 232,224,56
buffer_load_dwordx4 v9, s[12:15], s55 offen offset:3072 lds
Mvaa 232,228,60
s_waitcnt vmcnt(10)
Ta 96,26,0
s_waitcnt lgkmcnt(9)
Ta 98,26,2048
Mvaa 236,232,56
s_barrier
v_xor_b32 v6, 524288, v6
v_xor_b32 v7, 524288, v7
Mvaa 236,236,60
s_add_u32 m0, s56, 0
Ta 100,26,16384
Ta 102,26,18432
Mvaa 240,240,0
buffer_load_dwordx4 v2, s[8:11], s48 offen offset:0 lds
Mvaa 240,244,4
v_xor_b32 v8, 524288, v8
v_xor_b32 v9, 524288, v9
Mvaa 244,248,0
Mvaa 244,252,4
Ra 224,12,0
Mvaa 248,240,8
buffer_load_dwordx4 v3, s[8:11], s49 offen offset:1024 lds
Mvaa 248,244,12
Ta 104,27,0
Ta 106,27,2048
Mvaa 252,248,8
Mvaa 252,252,12
s_waitcnt lgkmcnt(9)
Ra 228,13,0
Maaa 128,240,16
buffer_load_dwordx4 v2, s[8:11], s50 offen offset:2048 lds
Maaa 128,244,20
Ta 108,27,16384
Ta 110,27,18432
Maaa 132,248,16
Maaa 132,252,20
Ra 232,12,2048
Maaa 136,240,24
buffer_load_dwordx4 v3, s[8:11], s51 offen offset:3072 lds
Maaa 136,244,28
Ta 112,28,0
Ta 114,28,2048
Maaa 140,248,24
Maaa 140,252,28
s_add_u32 m0, s56, 4096
s_waitcnt lgkmcnt(9)
Ra 236,13,2048
Maaa 144,240,32
buffer_load_dwordx4 v4, s[8:11], s48 offen offset:0 lds
Maaa 144,244,36
Maaa 148,248,32
Maaa 148,252,36
Ta 116,28,16384
Ta 118,28,18432
Maaa 152,240,40
buffer_load_dwordx4 v5, s[8:11], s49 offen offset:1024 lds
Maaa 152,244,44
Ta 120,29,0
Ta 122,29,2048
Maaa 156,248,40
Maaa 156,252,44
Ta 124,29,16384
s_waitcnt lgkmcnt(9)
Ta 126,29,18432
Maaa 160,240,48
buffer_load_dwordx4 v4, s[8:11], s50 offen offset:2048 lds
Maaa 160,244,52
Maaa 164,248,48
Maaa 164,252,52
Maaa 168,240,56
buffer_load_dwordx4 v5, s[8:11], s51 offen offset:3072 lds
Maaa 168,244,60
v_xor_b32 v2, 128, v2
v_xor_b32 v3, 128, v3
Maaa 172,248,56
s_waitcnt lgkmcnt(6)
buffer_load_dword v1, v47, s[60:63], 0 offen
v_xor_b32 v4, 128, v4
v_xor_b32 v5, 128, v5
Maaa 172,252,60
s_waitcnt lgkmcnt(0)
s_mul_i32 vcc_lo, s59, 3
v_xor_b32 v47, vcc_lo, v47
Mvaa 48,224,64
buffer_load_dword v44, v45, s[16:19], s47 offen
Mvaa 48,228,68
s_add_u32 s47, s47, 2097152
Mvaa 52,232,64
Mvaa 52,236,68
Ra 240,12,4096
Mvaa 56,224,72
Mvaa 56,228,76
Mvaa 60,232,72
Mvaa 60,236,76
Ra 244,13,4096
Mvaa 64,224,80
Mvaa 64,228,84
Mvaa 68,232,80
Mvaa 68,236,84
Ra 248,12,6144
Mvaa 72,224,88
Mvaa 72,228,92
Mvaa 76,232,88
Mvaa 76,236,92
Ra 252,13,6144
Mvaa 80,224,96
Mvaa 80,228,100
Mvaa 84,232,96
Mvaa 84,236,100
Mvaa 88,224,104
Mvaa 88,228,108
Mvaa 92,232,104
Mvaa 92,236,108
Mvaa 96,224,112
Mvaa 96,228,116
Mvaa 100,232,112
s_cmp_eq_u32 s6, 1
s_cselect_b32 s3, 0, 2146435072
Mvaa 100,236,116
s_mov_b64 exec, 1
buffer_atomic_add v30, v31, s[28:31], s3 offen sc1
s_mov_b64 exec, -1
Mvaa 104,224,120
Mvaa 104,228,124
Mvaa 108,232,120
s_waitcnt lgkmcnt(0)
Mvaa 108,236,124
Mvaa 112,240,64
Mvaa 112,244,68
Mvaa 116,248,64
Mvaa 116,252,68
Ra 224,12,8192
Mvaa 120,240,72
Mvaa 120,244,76
Mvaa 124,248,72
Mvaa 124,252,76
Ra 228,13,8192
Mvaa 128,240,80
Mvaa 128,244,84
Mvaa 132,248,80
Mvaa 132,252,84
Ra 232,12,10240
Mvaa 136,240,88
Mvaa 136,244,92
Mvaa 140,248,88
Mvaa 140,252,92
Ra 236,13,10240
Mvaa 144,240,96
Mvaa 144,244,100
Mvaa 148,248,96
Mvaa 148,252,100
Mvaa 152,240,104
Mvaa 152,244,108
Mvaa 156,248,104
Mvaa 156,252,108
Mvaa 160,240,112
Mvaa 160,244,116
Mvaa 164,248,112
Mvaa 164,252,116
Mvaa 168,240,120
Mvaa 168,244,124
s_waitcnt vmcnt(11)
Mvaa 172,248,120
s_waitcnt lgkmcnt(0)
s_barrier
Mvaa 172,252,124
s_add_u32 m0, s57, 65536
Mvaa 176,224,64
buffer_load_dwordx4 v6, s[12:15], s52 offen offset:0 lds
Mvaa 176,228,68
Ta 0,16,0
Ta 2,16,2048
Mvaa 180,232,64
Mvaa 180,236,68
Ra 240,12,12288
Mvaa 184,224,72
buffer_load_dwordx4 v7, s[12:15], s53 offen offset:1024 lds
Mvaa 184,228,76
Ta 4,16,16384
Ta 6,16,18432
Mvaa 188,232,72
Mvaa 188,236,76
Ra 244,13,12288
Mvaa 192,224,80
buffer_load_dwordx4 v6, s[12:15], s54 offen offset:2048 lds
Mvaa 192,228,84
Ta 8,17,0
Ta 10,17,2048
Mvaa 196,232,80
Mvaa 196,236,84
Ra 248,12,14336
Mvaa 200,224,88
buffer_load_dwordx4 v7, s[12:15], s55 offen offset:3072 lds
Mvaa 200,228,92
Ta 12,17,16384
Ta 14,17,18432
Mvaa 204,232,88
Mvaa 204,236,92
s_add_u32 m0, s57, 69632
Ra 252,13,14336
Mvaa 208,224,96
buffer_load_dwordx4 v8, s[12:15], s52 offen offset:0 lds
Mvaa 208,228,100
Mvaa 212,232,96
Mvaa 212,236,100
Ta 16,18,0
Ta 18,18,2048
Mvaa 216,224,104
buffer_load_dwordx4 v9, s[12:15], s53 offen offset:1024 lds
Mvaa 216,228,108
Ta 20,18,16384
s_waitcnt lgkmcnt(9)
Ta 22,18,18432
Mvaa 220,232,104
Mvaa 220,236,108
Ta 24,19,0
Ta 26,19,2048
Mvaa 224,224,112
buffer_load_dwordx4 v8, s[12:15], s54 offen offset:2048 lds
Mvaa 224,228,116
Mvaa 228,232,112
Mvaa 228,236,116
Ta 28,19,16384
Ta 30,19,18432
Mvaa 232,224,120
buffer_load_dwordx4 v9, s[12:15], s55 offen offset:3072 lds
Mvaa 232,228,124
s_waitcnt vmcnt(11)
Ta 32,20,0
s_waitcnt lgkmcnt(9)
Ta 34,20,2048
Mvaa 236,232,120
s_barrier
v_xor_b32 v6, 1572864, v6
v_xor_b32 v7, 1572864, v7
Mvaa 236,236,124
s_add_u32 m0, s56, 65536
Ta 36,20,16384
Ta 38,20,18432
Mvaa 240,240,64
buffer_load_dwordx4 v2, s[8:11], s48 offen offset:0 lds
Mvaa 240,244,68
v_xor_b32 v8, 1572864, v8
v_xor_b32 v9, 1572864, v9
Mvaa 244,248,64
Mvaa 244,252,68
Ra 224,10,0
Mvaa 248,240,72
buffer_load_dwordx4 v3, s[8:11], s49 offen offset:1024 lds
Mvaa 248,244,76
Ta 40,21,0
Ta 42,21,2048
Mvaa 252,248,72
Mvaa 252,252,76
s_waitcnt lgkmcnt(9)
Ra 228,11,0
Maaa 128,240,80
buffer_load_dwordx4 v2, s[8:11], s50 offen offset:2048 lds
Maaa 128,244,84
Ta 44,21,16384
Ta 46,21,18432
Maaa 132,248,80
s_cmp_eq_u32 s6, 2
s_cselect_b32 s3, 0, 2146435072
Maaa 132,252,84
Ra 232,10,2048
Maaa 136,240,88
buffer_load_dwordx4 v3, s[8:11], s51 offen offset:3072 lds
Maaa 136,244,92
Ta 48,22,0
Ta 50,22,2048
Maaa 140,248,88
s_mov_b64 exec, 1
buffer_atomic_add v30, v31, s[28:31], s3 offen sc1
s_mov_b64 exec, -1
Maaa 140,252,92
s_add_u32 m0, s56, 69632
s_waitcnt lgkmcnt(9)
Ra 236,11,2048
Maaa 144,240,96
buffer_load_dwordx4 v4, s[8:11], s48 offen offset:0 lds
Maaa 144,244,100
Maaa 148,248,96
Maaa 148,252,100
Ta 52,22,16384
Ta 54,22,18432
Maaa 152,240,104
buffer_load_dwordx4 v5, s[8:11], s49 offen offset:1024 lds
Maaa 152,244,108
Ta 56,23,0
Ta 58,23,2048
Maaa 156,248,104
Maaa 156,252,108
Ta 60,23,16384
s_waitcnt lgkmcnt(9)
Ta 62,23,18432
Maaa 160,240,112
buffer_load_dwordx4 v4, s[8:11], s50 offen offset:2048 lds
Maaa 160,244,116
Maaa 164,248,112
Maaa 164,252,116
Maaa 168,240,120
buffer_load_dwordx4 v5, s[8:11], s51 offen offset:3072 lds
Maaa 168,244,124
v_xor_b32 v2, 384, v2
v_xor_b32 v3, 384, v3
Maaa 172,248,120
s_waitcnt lgkmcnt(6)
buffer_load_dword v1, v47, s[60:63], 0 offen
v_xor_b32 v4, 384, v4
v_xor_b32 v5, 384, v5
Maaa 172,252,124
s_waitcnt lgkmcnt(0)
s_mul_i32 vcc_lo, s59, 1
v_xor_b32_e64 v47, vcc_lo, v47
Mvaa 48,224,0
buffer_load_dword v44, v45, s[16:19], s47 offen
Mvaa 48,228,4
s_add_u32 s47, s47, 2097152
Mvaa 52,232,0
Mvaa 52,236,4
Ra 240,10,4096
Mvaa 56,224,8
Mvaa 56,228,12
Mvaa 60,232,8
Mvaa 60,236,12
Ra 244,11,4096
Mvaa 64,224,16
Mvaa 64,228,20
Mvaa 68,232,16
Mvaa 68,236,20
Ra 248,10,6144
Mvaa 72,224,24
Mvaa 72,228,28
Mvaa 76,232,24
Mvaa 76,236,28
Ra 252,11,6144
Mvaa 80,224,32
Mvaa 80,228,36
Mvaa 84,232,32
Mvaa 84,236,36
Mvaa 88,224,40
Mvaa 88,228,44
Mvaa 92,232,40
Mvaa 92,236,44
Mvaa 96,224,48
Mvaa 96,228,52
Mvaa 100,232,48
Mvaa 100,236,52
Mvaa 104,224,56
Mvaa 104,228,60
Mvaa 108,232,56
s_waitcnt lgkmcnt(0)
Mvaa 108,236,60
Mvaa 112,240,0
Mvaa 112,244,4
Mvaa 116,248,0
Mvaa 116,252,4
Ra 224,10,8192
Mvaa 120,240,8
Mvaa 120,244,12
Mvaa 124,248,8
Mvaa 124,252,12
Ra 228,11,8192
Mvaa 128,240,16
Mvaa 128,244,20
Mvaa 132,248,16
Mvaa 132,252,20
Ra 232,10,10240
Mvaa 136,240,24
Mvaa 136,244,28
Mvaa 140,248,24
Mvaa 140,252,28
Ra 236,11,10240
Mvaa 144,240,32
Mvaa 144,244,36
Mvaa 148,248,32
Mvaa 148,252,36
Mvaa 152,240,40
s_cmp_eq_u32 s6, 3
s_cselect_b32 s3, 0, 2146435072
Mvaa 152,244,44
s_mov_b64 exec, 1
buffer_atomic_add v30, v31, s[28:31], s3 offen sc1
s_mov_b64 exec, -1
Mvaa 156,248,40
Mvaa 156,252,44
Mvaa 160,240,48
Mvaa 160,244,52
Mvaa 164,248,48
Mvaa 164,252,52
Mvaa 168,240,56
Mvaa 168,244,60
s_waitcnt vmcnt(12)
Mvaa 172,248,56
s_waitcnt lgkmcnt(0)
s_barrier
Mvaa 172,252,60
s_add_u32 m0, s57, 0
Mvaa 176,224,0
buffer_load_dwordx4 v6, s[12:15], s52 offen offset:0 lds
Mvaa 176,228,4
Ta 64,14,0
Ta 66,14,2048
Mvaa 180,232,0
Mvaa 180,236,4
Ra 240,10,12288
Mvaa 184,224,8
buffer_load_dwordx4 v7, s[12:15], s53 offen offset:1024 lds
Mvaa 184,228,12
Ta 68,14,16384
Ta 70,14,18432
Mvaa 188,232,8
Mvaa 188,236,12
Ra 244,11,12288
Mvaa 192,224,16
buffer_load_dwordx4 v6, s[12:15], s54 offen offset:2048 lds
Mvaa 192,228,20
Ta 72,15,0
Ta 74,15,2048
Mvaa 196,232,16
Mvaa 196,236,20
Ra 248,10,14336
Mvaa 200,224,24
buffer_load_dwordx4 v7, s[12:15], s55 offen offset:3072 lds
Mvaa 200,228,28
Ta 76,15,16384
Ta 78,15,18432
Mvaa 204,232,24
Mvaa 204,236,28
s_add_u32 m0, s57, 4096
Ra 252,11,14336
Mvaa 208,224,32
buffer_load_dwordx4 v8, s[12:15], s52 offen offset:0 lds
Mvaa 208,228,36
Mvaa 212,232,32
Mvaa 212,236,36
Ta 80,24,0
Ta 82,24,2048
Mvaa 216,224,40
buffer_load_dwordx4 v9, s[12:15], s53 offen offset:1024 lds
Mvaa 216,228,44
Ta 84,24,16384
s_waitcnt lgkmcnt(9)
Ta 86,24,18432
Mvaa 220,232,40
Mvaa 220,236,44
Ta 88,25,0
Ta 90,25,2048
Mvaa 224,224,48
buffer_load_dwordx4 v8, s[12:15], s54 offen offset:2048 lds
Mvaa 224,228,52
Mvaa 228,232,48
Mvaa 228,236,52
Ta 92,25,16384
Ta 94,25,18432
Mvaa 232,224,56
buffer_load_dwordx4 v9, s[12:15], s55 offen offset:3072 lds
Mvaa 232,228,60
s_waitcnt vmcnt(11)
Ta 96,26,0
s_waitcnt lgkmcnt(9)
Ta 98,26,2048
Mvaa 236,232,56
s_barrier
v_xor_b32 v6, 524288, v6
v_xor_b32 v7, 524288, v7
Mvaa 236,236,60
s_add_u32 m0, s56, 0
Ta 100,26,16384
Ta 102,26,18432
Mvaa 240,240,0
buffer_load_dwordx4 v2, s[8:11], s48 offen offset:0 lds
Mvaa 240,244,4
v_xor_b32 v8, 524288, v8
v_xor_b32 v9, 524288, v9
Mvaa 244,248,0
Mvaa 244,252,4
Ra 224,12,0
Mvaa 248,240,8
buffer_load_dwordx4 v3, s[8:11], s49 offen offset:1024 lds
Mvaa 248,244,12
Ta 104,27,0
Ta 106,27,2048
Mvaa 252,248,8
Mvaa 252,252,12
s_waitcnt lgkmcnt(9)
Ra 228,13,0
Maaa 128,240,16
buffer_load_dwordx4 v2, s[8:11], s50 offen offset:2048 lds
Maaa 128,244,20
Ta 108,27,16384
Ta 110,27,18432
Maaa 132,248,16
Maaa 132,252,20
Ra 232,12,2048
Maaa 136,240,24
buffer_load_dwordx4 v3, s[8:11], s51 offen offset:3072 lds
Maaa 136,244,28
Ta 112,28,0
Ta 114,28,2048
Maaa 140,248,24
Maaa 140,252,28
s_add_u32 m0, s56, 4096
s_waitcnt lgkmcnt(9)
Ra 236,13,2048
Maaa 144,240,32
buffer_load_dwordx4 v4, s[8:11], s48 offen offset:0 lds
Maaa 144,244,36
Maaa 148,248,32
Maaa 148,252,36
Ta 116,28,16384
Ta 118,28,18432
Maaa 152,240,40
buffer_load_dwordx4 v5, s[8:11], s49 offen offset:1024 lds
Maaa 152,244,44
Ta 120,29,0
Ta 122,29,2048
Maaa 156,248,40
Maaa 156,252,44
Ta 124,29,16384
s_waitcnt lgkmcnt(9)
Ta 126,29,18432
Maaa 160,240,48
buffer_load_dwordx4 v4, s[8:11], s50 offen offset:2048 lds
Maaa 160,244,52
Maaa 164,248,48
Maaa 164,252,52
Maaa 168,240,56
buffer_load_dwordx4 v5, s[8:11], s51 offen offset:3072 lds
Maaa 168,244,60
v_xor_b32 v2, 128, v2
v_xor_b32 v3, 128, v3
Maaa 172,248,56
s_waitcnt lgkmcnt(6)
buffer_load_dword v1, v47, s[60:63], 0 offen
v_xor_b32 v4, 128, v4
v_xor_b32 v5, 128, v5
Maaa 172,252,60
s_waitcnt lgkmcnt(0)
s_mul_i32 vcc_lo, s59, 7
v_xor_b32 v47, vcc_lo, v47
Mvaa 48,224,64
buffer_load_dword v44, v45, s[16:19], s47 offen
Mvaa 48,228,68
s_add_u32 s47, s47, 2097152
v_lshrrev_b32 v32, 4, v0
v_and_b32 v33, 15, v0
Mvaa 52,232,64
s_lshl_b32 s3, s32, 4
v_add_u32 v34, s3, v32
v_lshlrev_b32_e64 v36, 1, v32
Mvaa 52,236,68
Ra 240,12,4096
Mvaa 56,224,72
v_xor_b32 v36, v36, v33
v_xor_b32 v37, 8, v36
Mvaa 56,228,76
Mvaa 60,232,72
Mvaa 60,236,76
Ra 244,13,4096
Mvaa 64,224,80
s_getpc_b64 s[6:7]
L_cpf3:
s_add_u32 s6, s6, (L_phase2-L_cpf3)&0xffffffff
s_addc_u32 s7, s7, ((L_phase2-L_cpf3)>>32)&0xffffffff
Mvaa 64,228,84
s_lshr_b32 s3, s2, 3
s_lshl_b32 s3, s3, 2
s_add_u32 s3, s3, s32
Mvaa 68,232,80
s_lshl_b32 s3, s3, 10
v_and_b32 v42, 7, v0
v_lshlrev_b32_e64 v42, 7, v42
Mvaa 68,236,84
Ra 248,12,6144
Mvaa 72,224,88
v_add_u32_e64 v42, s3, v42
v_min_u32 v42, L_k2_fin-L_phase2-4, v42
Mvaa 72,228,92
v_mov_b32_e64 v41, s7
Mvaa 76,232,88
v_add_co_u32 v40, vcc, s6, v42
s_nop 1
v_addc_co_u32 v41, vcc, 0, v41, vcc
Mvaa 76,236,92
Ra 252,13,6144
Mvaa 80,224,96
global_load_dword v38, v[40:41], off
Mvaa 80,228,100
Mvaa 84,232,96
Mvaa 84,236,100
Mvaa 88,224,104
Mvaa 88,228,108
Mvaa 92,232,104
Mvaa 92,236,108
Mvaa 96,224,112
Mvaa 96,228,116
Mvaa 100,232,112
Mvaa 100,236,116
Mvaa 104,224,120
Mvaa 104,228,124
Mvaa 108,232,120
s_waitcnt lgkmcnt(0)
Mvaa 108,236,124
Mvaa 112,240,64
Mvaa 112,244,68
Mvaa 116,248,64
Mvaa 116,252,68
Ra 224,12,8192
Mvaa 120,240,72
Mvaa 120,244,76
Mvaa 124,248,72
Mvaa 124,252,76
Ra 228,13,8192
Mvaa 128,240,80
Mvaa 128,244,84
Mvaa 132,248,80
Mvaa 132,252,84
Ra 232,12,10240
Mvaa 136,240,88
Mvaa 136,244,92
Mvaa 140,248,88
Mvaa 140,252,92
Ra 236,13,10240
Mvaa 144,240,96
Mvaa 144,244,100
Mvaa 148,248,96
Mvaa 148,252,100
Mvaa 152,240,104
Mvaa 152,244,108
Mvaa 156,248,104
Mvaa 156,252,108
Mvaa 160,240,112
Mvaa 160,244,116
Mvaa 164,248,112
Mvaa 164,252,116
Mvaa 168,240,120
Mvaa 168,244,124
s_waitcnt vmcnt(11)
Mvaa 172,248,120
s_waitcnt lgkmcnt(0)
s_barrier
Mvaa 172,252,124
s_add_u32 m0, s57, 65536
Mvaa 176,224,64
buffer_load_dwordx4 v6, s[12:15], s52 offen offset:0 lds
Mvaa 176,228,68
Ta 0,16,0
Ta 2,16,2048
Mvaa 180,232,64
Mvaa 180,236,68
Ra 240,12,12288
Mvaa 184,224,72
buffer_load_dwordx4 v7, s[12:15], s53 offen offset:1024 lds
Mvaa 184,228,76
Ta 4,16,16384
Ta 6,16,18432
Mvaa 188,232,72
Mvaa 188,236,76
Ra 244,13,12288
Mvaa 192,224,80
buffer_load_dwordx4 v6, s[12:15], s54 offen offset:2048 lds
Mvaa 192,228,84
Ta 8,17,0
Ta 10,17,2048
Mvaa 196,232,80
Mvaa 196,236,84
Ra 248,12,14336
Mvaa 200,224,88
buffer_load_dwordx4 v7, s[12:15], s55 offen offset:3072 lds
Mvaa 200,228,92
Ta 12,17,16384
Ta 14,17,18432
Mvaa 204,232,88
Mvaa 204,236,92
s_add_u32 m0, s57, 69632
Ra 252,13,14336
Mvaa 208,224,96
buffer_load_dwordx4 v8, s[12:15], s52 offen offset:0 lds
Mvaa 208,228,100
Mvaa 212,232,96
Mvaa 212,236,100
Ta 16,18,0
Ta 18,18,2048
Mvaa 216,224,104
buffer_load_dwordx4 v9, s[12:15], s53 offen offset:1024 lds
Mvaa 216,228,108
Ta 20,18,16384
s_waitcnt lgkmcnt(9)
Ta 22,18,18432
Mvaa 220,232,104
Mvaa 220,236,108
Ta 24,19,0
Ta 26,19,2048
Mvaa 224,224,112
buffer_load_dwordx4 v8, s[12:15], s54 offen offset:2048 lds
Mvaa 224,228,116
Mvaa 228,232,112
Mvaa 228,236,116
Ta 28,19,16384
Ta 30,19,18432
Mvaa 232,224,120
buffer_load_dwordx4 v9, s[12:15], s55 offen offset:3072 lds
Mvaa 232,228,124
s_waitcnt vmcnt(11)
Ta 32,20,0
s_waitcnt lgkmcnt(9)
Ta 34,20,2048
Mvaa 236,232,120
s_barrier
Mvaa 236,236,124
s_add_u32 m0, s56, 65536
Ta 36,20,16384
Ta 38,20,18432
Mvaa 240,240,64
buffer_load_dwordx4 v2, s[8:11], s48 offen offset:0 lds
Mvaa 240,244,68
Mvaa 244,248,64
Mvaa 244,252,68
Ra 224,10,0
Mvaa 248,240,72
buffer_load_dwordx4 v3, s[8:11], s49 offen offset:1024 lds
Mvaa 248,244,76
Ta 40,21,0
Ta 42,21,2048
Mvaa 252,248,72
Mvaa 252,252,76
s_waitcnt lgkmcnt(9)
Ra 228,11,0
Maaa 128,240,80
buffer_load_dwordx4 v2, s[8:11], s50 offen offset:2048 lds
Maaa 128,244,84
Ta 44,21,16384
Ta 46,21,18432
Maaa 132,248,80
Maaa 132,252,84
Ra 232,10,2048
Maaa 136,240,88
buffer_load_dwordx4 v3, s[8:11], s51 offen offset:3072 lds
Maaa 136,244,92
Ta 48,22,0
Ta 50,22,2048
Maaa 140,248,88
Maaa 140,252,92
s_add_u32 m0, s56, 69632
s_waitcnt lgkmcnt(9)
Ra 236,11,2048
Maaa 144,240,96
buffer_load_dwordx4 v4, s[8:11], s48 offen offset:0 lds
Maaa 144,244,100
Maaa 148,248,96
Maaa 148,252,100
Ta 52,22,16384
Ta 54,22,18432
Maaa 152,240,104
buffer_load_dwordx4 v5, s[8:11], s49 offen offset:1024 lds
Maaa 152,244,108
Ta 56,23,0
Ta 58,23,2048
Maaa 156,248,104
Maaa 156,252,108
Ta 60,23,16384
s_waitcnt lgkmcnt(9)
Ta 62,23,18432
Maaa 160,240,112
buffer_load_dwordx4 v4, s[8:11], s50 offen offset:2048 lds
Maaa 160,244,116
Maaa 164,248,112
Maaa 164,252,116
Maaa 168,240,120
buffer_load_dwordx4 v5, s[8:11], s51 offen offset:3072 lds
Maaa 168,244,124
Maaa 172,248,120
s_waitcnt lgkmcnt(6)
Maaa 172,252,124
s_waitcnt lgkmcnt(0)
Mvaa 48,224,0
buffer_load_dword v1, v31, s[28:31], s37 offen sc1
Mvaa 48,228,4
s_mov_b32 s8, s16
s_mov_b32 s9, s17
s_mov_b32 s10, s18
Mvaa 52,232,0
s_add_u32 s16, s66, 46137344
s_addc_u32 s17, s67, 0
s_and_b32 s17, s17, 0xffff
Mvaa 52,236,4
Ra 240,10,4096
Mvaa 56,224,8
s_mov_b32 s18, 16777216
s_mov_b32 s19, 0x20000
s_mov_b32 s48, 0
Mvaa 56,228,12
s_mov_b32 s49, 31744
s_mov_b32 s50, 63488
s_mov_b32 s51, 95232
Mvaa 60,232,8
v_lshlrev_b32 v35, 13, v34
v_lshl_add_u32 v8, v36, 4, v35
Mvaa 60,236,12
Ra 244,11,4096
Mvaa 64,224,16
v_lshl_add_u32 v9, v37, 4, v35
v_lshlrev_b32_e64 v2, 4, v0
Mvaa 64,228,20
v_add_u32 v3, 65536, v2
v_add_u32_e64 v4, s44, v2
Mvaa 68,232,16
v_mov_b32 v7, 0
v_lshlrev_b32 v35, 2, v32
Mvaa 68,236,20
Ra 248,10,6144
Mvaa 72,224,24
v_sub_u32_e64 v35, v33, v35
Mvaa 72,228,28
s_lshl_b32 s3, s32, 4
v_add_u32 v5, s3, v35
Mvaa 76,232,24
s_sub_u32 s3, 48, s3
v_add_u32 v6, s3, v35
Mvaa 76,236,28
Ra 252,11,6144
Mvaa 80,224,32
s_mul_i32 s3, s33, 1116160
s_add_u32 s3, s3, 8388608
s_add_u32 s12, s66, s3
s_addc_u32 s13, s67, 0
s_and_b32 s13, s13, 0xffff
Mvaa 80,228,36
s_mov_b32 s14, 0
s_mov_b32 s15, 0x20000
s_mul_i32 s14, s36, 34816
Mvaa 84,232,32
buffer_load_dword v44, v45, s[8:11], s47 offen
Mvaa 84,236,36
s_add_u32 s47, s47, 2097152
v_lshrrev_b32 v42, 2, v33
v_lshl_add_u32 v43, v32, 3, v42
Mvaa 88,224,40
v_lshlrev_b32 v43, 8, v43
v_and_b32 v46, 3, v0
Mvaa 88,228,44
v_lshl_add_u32 v43, v46, 3, v43
v_and_b32_e64 v46, 1, v32
Mvaa 92,232,40
v_lshl_add_u32 v42, v46, 2, v42
v_lshl_add_u32 v16, v42, 5, v43
Mvaa 92,236,44
v_xor_b32 v17, 32, v16
v_xor_b32 v18, 64, v16
Mvaa 96,224,48
v_xor_b32 v19, 96, v16
v_xor_b32 v20, 128, v16
Mvaa 96,228,52
v_xor_b32 v21, 160, v16
v_xor_b32 v22, 192, v16
Mvaa 100,232,48
v_xor_b32 v23, 224, v16
Mvaa 100,236,52
Mvaa 104,224,56
Mvaa 104,228,60
Mvaa 108,232,56
s_waitcnt lgkmcnt(0)
Mvaa 108,236,60
Mvaa 112,240,0
Mvaa 112,244,4
Mvaa 116,248,0
Mvaa 116,252,4
Ra 224,10,8192
Mvaa 120,240,8
Mvaa 120,244,12
Mvaa 124,248,8
Mvaa 124,252,12
Ra 228,11,8192
Mvaa 128,240,16
Mvaa 128,244,20
Mvaa 132,248,16
Mvaa 132,252,20
Ra 232,10,10240
Mvaa 136,240,24
Mvaa 136,244,28
Mvaa 140,248,24
Mvaa 140,252,28
Ra 236,11,10240
Mvaa 144,240,32
Mvaa 144,244,36
Mvaa 148,248,32
Mvaa 148,252,36
Mvaa 152,240,40
Mvaa 152,244,44
Mvaa 156,248,40
Mvaa 156,252,44
Mvaa 160,240,48
Mvaa 160,244,52
Mvaa 164,248,48
Mvaa 164,252,52
Mvaa 168,240,56
Mvaa 168,244,60
s_waitcnt vmcnt(10)
Mvaa 172,248,56
s_waitcnt lgkmcnt(0)
s_barrier
Mvaa 172,252,60
s_add_u32 m0, s44, 0
Mvaa 176,224,0
buffer_load_dwordx4 v8, s[8:11], s48 offen offset:0 lds
Mvaa 176,228,4
Ta 64,14,0
Ta 66,14,2048
Mvaa 180,232,0
Mvaa 180,236,4
Ra 240,10,12288
Mvaa 184,224,8
buffer_load_dwordx4 v8, s[8:11], s49 offen offset:1024 lds
Mvaa 184,228,12
Ta 68,14,16384
Ta 70,14,18432
Mvaa 188,232,8
Mvaa 188,236,12
Ra 244,11,12288
Mvaa 192,224,16
buffer_load_dwordx4 v9, s[8:11], s50 offen offset:2048 lds
Mvaa 192,228,20
Ta 72,15,0
Ta 74,15,2048
Mvaa 196,232,16
Mvaa 196,236,20
Ra 248,10,14336
Mvaa 200,224,24
buffer_load_dwordx4 v9, s[8:11], s51 offen offset:3072 lds
Mvaa 200,228,28
Ta 76,15,16384
Ta 78,15,18432
Mvaa 204,232,24
v_add_u32 v8, 524288, v8
v_add_u32 v9, 524288, v9
Mvaa 204,236,28
s_add_u32 m0, s44, 16384
Ra 252,11,14336
Mvaa 208,224,32
buffer_load_dwordx4 v8, s[8:11], s48 offen offset:0 lds
Mvaa 208,228,36
Mvaa 212,232,32
Mvaa 212,236,36
Ta 80,24,0
Ta 82,24,2048
Mvaa 216,224,40
buffer_load_dwordx4 v8, s[8:11], s49 offen offset:1024 lds
Mvaa 216,228,44
Ta 84,24,16384
s_waitcnt lgkmcnt(9)
Ta 86,24,18432
Mvaa 220,232,40
Mvaa 220,236,44
Ta 88,25,0
Ta 90,25,2048
Mvaa 224,224,48
buffer_load_dwordx4 v9, s[8:11], s50 offen offset:2048 lds
Mvaa 224,228,52
Mvaa 228,232,48
s_mul_i32 s3, s45, 33792
v_add_u32_e64 v10, s3, v2
Mvaa 228,236,52
Ta 92,25,16384
Ta 94,25,18432
Mvaa 232,224,56
buffer_load_dwordx4 v9, s[8:11], s51 offen offset:3072 lds
Mvaa 232,228,60
s_waitcnt vmcnt(10)
Ta 96,26,0
s_waitcnt lgkmcnt(9)
Ta 98,26,2048
Mvaa 236,232,56
s_barrier
v_add_u32 v8, 524288, v8
v_add_u32 v9, 524288, v9
Mvaa 236,236,60
s_add_u32 m0, s44, 32768
Ta 100,26,16384
Ta 102,26,18432
Mvaa 240,240,0
buffer_load_dwordx4 v8, s[8:11], s48 offen offset:0 lds
Mvaa 240,244,4
s_mul_i32 s3, s46, 33792
v_add_u32 v11, s3, v2
Mvaa 244,248,0
Mvaa 244,252,4
Ra 224,12,0
Mvaa 248,240,8
buffer_load_dwordx4 v8, s[8:11], s49 offen offset:1024 lds
Mvaa 248,244,12
Ta 104,27,0
Ta 106,27,2048
Mvaa 252,248,8
Mvaa 252,252,12
s_waitcnt lgkmcnt(9)
Ra 228,13,0
Maaa 128,240,16
buffer_load_dwordx4 v9, s[8:11], s50 offen offset:2048 lds
Maaa 128,244,20
Ta 108,27,16384
Ta 110,27,18432
Maaa 132,248,16
Maaa 132,252,20
Ra 232,12,2048
Maaa 136,240,24
buffer_load_dwordx4 v9, s[8:11], s51 offen offset:3072 lds
Maaa 136,244,28
Ta 112,28,0
Ta 114,28,2048
Maaa 140,248,24
v_add_u32 v8, 524288, v8
v_add_u32 v9, 524288, v9
Maaa 140,252,28
s_add_u32 m0, s44, 49152
s_waitcnt lgkmcnt(9)
Ra 236,13,2048
Maaa 144,240,32
buffer_load_dwordx4 v8, s[8:11], s48 offen offset:0 lds
Maaa 144,244,36
Maaa 148,248,32
Maaa 148,252,36
Ta 116,28,16384
Ta 118,28,18432
Maaa 152,240,40
buffer_load_dwordx4 v8, s[8:11], s49 offen offset:1024 lds
Maaa 152,244,44
Ta 120,29,0
Ta 122,29,2048
Maaa 156,248,40
Maaa 156,252,44
Ta 124,29,16384
s_waitcnt lgkmcnt(9)
Ta 126,29,18432
Maaa 160,240,48
buffer_load_dwordx4 v9, s[8:11], s50 offen offset:2048 lds
Maaa 160,244,52
Maaa 164,248,48
Maaa 164,252,52
Maaa 168,240,56
buffer_load_dwordx4 v9, s[8:11], s51 offen offset:3072 lds
Maaa 168,244,60
v_add_u32 v8, 524288, v8
v_add_u32 v9, 524288, v9
Maaa 172,248,56
s_waitcnt lgkmcnt(6)
Maaa 172,252,60
s_waitcnt lgkmcnt(0)
Mvaa 48,224,64
v_mov_b32 v14, v40
v_mov_b32_e64 v15, v41
Mvaa 48,228,68
Mvaa 52,232,64
Mvaa 52,236,68
Ra 240,12,4096
Mvaa 56,224,72
Mvaa 56,228,76
Mvaa 60,232,72
Mvaa 60,236,76
Ra 244,13,4096
Mvaa 64,224,80
Vc 24,48,49
Vc 25,50,51
Mvaa 64,228,84
Vc 26,52,53
Vc 27,54,55
Mvaa 68,232,80
Mvaa 68,236,84
Ra 248,12,6144
Mvaa 72,224,88
Vc 28,56,57
Vc 29,58,59
Mvaa 72,228,92
Vc 30,60,61
Vc 31,62,63
Mvaa 76,232,88
Mvaa 76,236,92
Ra 252,13,6144
Mvaa 80,224,96
Vc 32,64,65
Vc 33,66,67
Mvaa 80,228,100
Vc 34,68,69
Vc 35,70,71
Mvaa 84,232,96
Mvaa 84,236,100
Mvaa 88,224,104
Vc 36,72,73
Vc 37,74,75
Mvaa 88,228,108
Vc 38,76,77
Vc 39,78,79
Mvaa 92,232,104
Mvaa 92,236,108
Mvaa 96,224,112
Vc 40,80,81
Vc 41,82,83
Mvaa 96,228,116
Vc 42,84,85
Vc 43,86,87
Mvaa 100,232,112
s_waitcnt vmcnt(12)
Mvaa 100,236,116
s_add_u32 s59, s38, 0
Mvaa 104,224,120
v_readfirstlane_b32 s3, v1
s_nop 0
s_or_b32 s3, s3, s37
s_cmp_lt_u32 s3, 256
s_cbranch_scc1 L_spinAv
L_spinArv:
s_barrier
Mvaa 104,228,124
buffer_store_dwordx4 v[24:27], v2, s[24:27], s59 offen offset:0 sc1
Mvaa 108,232,120
s_waitcnt lgkmcnt(0)
Mvaa 108,236,124
Vc 44,88,89
Vc 45,90,91
Mvaa 112,240,64
buffer_load_dwordx4 a[0:3], v10, s[20:23], s58 offen offset:0 sc1
Mvaa 112,244,68
Vc 46,92,93
Vc 47,94,95
Mvaa 116,248,64
Vc 48,96,97
Vc 49,98,99
Mvaa 116,252,68
Ra 224,12,8192
Mvaa 120,240,72
Vc 50,100,101
Vc 51,102,103
Mvaa 120,244,76
Vc 52,104,105
Vc 53,106,107
Mvaa 124,248,72
buffer_load_dwordx4 a[4:7], v10, s[20:23], 0 offen offset:0 sc1
Mvaa 124,252,76
Ra 228,13,8192
Mvaa 128,240,80
Vc 54,108,109
Vc 55,110,111
Mvaa 128,244,84
Vc 56,112,113
Vc 57,114,115
Mvaa 132,248,80
Vc 58,116,117
Vc 59,118,119
Mvaa 132,252,84
Ra 232,12,10240
Mvaa 136,240,88
buffer_load_dwordx4 a[8:11], v11, s[20:23], s58 offen offset:0 sc1
Mvaa 136,244,92
buffer_store_dwordx4 v[28:31], v2, s[24:27], s59 offen offset:1024 sc1
Mvaa 140,248,88
Vc 60,120,121
Vc 61,122,123
Mvaa 140,252,92
Ra 236,13,10240
Mvaa 144,240,96
Vc 62,124,125
Vc 63,126,127
Mvaa 144,244,100
Vc 64,128,129
Vc 65,130,131
Mvaa 148,248,96
buffer_load_dwordx4 a[12:15], v11, s[20:23], 0 offen offset:0 sc1
Mvaa 148,252,100
Vc 66,132,133
Vc 67,134,135
Mvaa 152,240,104
Vc 68,136,137
Vc 69,138,139
Mvaa 152,244,108
Vc 70,140,141
Vc 71,142,143
Mvaa 156,248,104
Mvaa 156,252,108
Mvaa 160,240,112
buffer_load_dwordx4 a[16:19], v10, s[20:23], s58 offen offset:1024 sc1
Mvaa 160,244,116
Vc 72,144,145
Vc 73,146,147
Mvaa 164,248,112
Vc 74,148,149
Vc 75,150,151
Mvaa 164,252,116
buffer_store_dwordx4 v[32:35], v2, s[24:27], s59 offen offset:2048 sc1
Mvaa 168,240,120
Vc 76,152,153
Vc 77,154,155
Mvaa 168,244,124
Vc 78,156,157
Vc 79,158,159
Mvaa 172,248,120
s_waitcnt lgkmcnt(0)
buffer_load_dwordx4 a[20:23], v10, s[20:23], 0 offen offset:1024 sc1
Mvaa 172,252,124
Mvaa 176,224,64
Vc 80,160,161
Vc 81,162,163
Mvaa 176,228,68
Vc 82,164,165
Vc 83,166,167
Mvaa 180,232,64
Mvaa 180,236,68
Ra 240,12,12288
Mvaa 184,224,72
buffer_load_dwordx4 a[24:27], v11, s[20:23], s58 offen offset:1024 sc1
Mvaa 184,228,76
Vc 84,168,169
Vc 85,170,171
Mvaa 188,232,72
Vc 86,172,173
Vc 87,174,175
Mvaa 188,236,76
Ra 244,13,12288
Mvaa 192,224,80
Vc 88,176,177
Vc 89,178,179
Mvaa 192,228,84
Vc 90,180,181
Vc 91,182,183
Mvaa 196,232,80
buffer_load_dwordx4 a[28:31], v11, s[20:23], 0 offen offset:1024 sc1
Mvaa 196,236,84
Ra 248,12,14336
Mvaa 200,224,88
Vc 92,184,185
Vc 93,186,187
Mvaa 200,228,92
Vc 94,188,189
Vc 95,190,191
Mvaa 204,232,88
buffer_store_dwordx4 v[36:39], v2, s[24:27], s59 offen offset:3072 sc1
Mvaa 204,236,92
Ra 252,13,14336
Mvaa 208,224,96
buffer_load_dwordx4 a[32:35], v10, s[20:23], s58 offen offset:2048 sc1
Mvaa 208,228,100
Vc 96,192,193
Vc 97,194,195
Mvaa 212,232,96
Vc 98,196,197
Vc 99,198,199
Mvaa 212,236,100
Mvaa 216,224,104
Vc 100,200,201
Vc 101,202,203
Mvaa 216,228,108
Vc 102,204,205
Vc 103,206,207
Mvaa 220,232,104
buffer_load_dwordx4 a[36:39], v10, s[20:23], 0 offen offset:2048 sc1
Mvaa 220,236,108
Mvaa 224,224,112
Vc 104,208,209
Vc 105,210,211
Mvaa 224,228,116
Vc 106,212,213
Vc 107,214,215
Mvaa 228,232,112
Mvaa 228,236,116
Mvaa 232,224,120
buffer_load_dwordx4 a[40:43], v11, s[20:23], s58 offen offset:2048 sc1
Mvaa 232,228,124
Vc 108,216,217
Vc 109,218,219
Mvaa 236,232,120
s_waitcnt lgkmcnt(0)
Mvaa 236,236,124
Vc 110,220,221
Vc 111,222,223
Mvaa 240,240,64
s_add_u32 s59, s38, 4096
Mvaa 240,244,68
buffer_store_dwordx4 v[40:43], v2, s[24:27], s59 offen offset:0 sc1
Mvaa 244,248,64
buffer_load_dwordx4 a[44:47], v11, s[20:23], 0 offen offset:2048 sc1
Mvaa 244,252,68
Vc 112,224,225
Vc 113,226,227
Mvaa 248,240,72
Vc 114,228,229
Vc 115,230,231
Mvaa 248,244,76
Vc 116,232,233
Vc 117,234,235
Mvaa 252,248,72
Vc 118,236,237
Vc 119,238,239
Mvaa 252,252,76
Maaa 128,240,80
buffer_load_dwordx4 a[48:51], v10, s[20:23], s58 offen offset:3072 sc1
Maaa 128,244,84
Ta 192,16,0
Ta 194,16,1024
Maaa 132,248,80
Vc 120,240,241
Vc 121,242,243
Maaa 132,252,84
Ta 196,17,0
Ta 198,17,1024
Maaa 136,240,88
Vc 122,244,245
Vc 123,246,247
Maaa 136,244,92
Ta 200,18,0
Ta 202,18,1024
Maaa 140,248,88
buffer_load_dwordx4 a[52:55], v10, s[20:23], 0 offen offset:3072 sc1
Maaa 140,252,92
Ta 204,19,0
Ta 206,19,1024
Maaa 144,240,96
Vc 124,248,249
Vc 125,250,251
Maaa 144,244,100
Ta 208,20,0
Ta 210,20,1024
Maaa 148,248,96
Vc 126,252,253
Vc 127,254,255
Maaa 148,252,100
Ta 212,21,0
Ta 214,21,1024
Maaa 152,240,104
buffer_load_dwordx4 a[56:59], v11, s[20:23], s58 offen offset:3072 sc1
Maaa 152,244,108
Ta 216,22,0
Ta 218,22,1024
Maaa 156,248,104
buffer_store_dwordx4 v[44:47], v2, s[24:27], s59 offen offset:1024 sc1
Maaa 156,252,108
Ta 220,23,0
s_waitcnt lgkmcnt(9)
Ta 222,23,1024
Maaa 160,240,112
Maaa 160,244,116
Maaa 164,248,112
buffer_load_dwordx4 a[60:63], v11, s[20:23], 0 offen offset:3072 sc1
Maaa 164,252,116
v_add_u32 v10, 4096, v10
v_add_u32 v11, 4096, v11
Maaa 168,240,120
Maaa 168,244,124
Maaa 172,248,120
Maaa 172,252,124
L_phase2:
s_nop 7
s_waitcnt vmcnt(16) lgkmcnt(0)
Zvaa 128,192,0
buffer_store_dwordx4 v[48:51], v2, s[24:27], s59 offen offset:2048 sc1
Zvaa 160,192,4
Ta 224,16,8192
Ta 226,16,9216
Zvaa 192,192,8
buffer_load_dwordx4 a[64:67], v10, s[20:23], s58 offen offset:0 sc1
Zvaa 224,192,12
s_mov_b32 s60, s40
s_and_b32 s61, s41, 0xffff
s_mov_b32 s62, 7340032
Zvaa 132,196,0
Ta 228,17,8192
Ta 230,17,9216
Zvaa 164,196,4
buffer_load_dwordx4 a[68:71], v10, s[20:23], 0 offen offset:0 sc1
Zvaa 196,196,8
s_mov_b32 s63, 0x20000
Zvaa 228,196,12
Ta 232,18,8192
Ta 234,18,9216
Zvaa 136,200,0
global_load_dword v13, v[14:15], off
Zvaa 168,200,4
buffer_load_dwordx4 a[72:75], v11, s[20:23], s58 offen offset:0 sc1
Zvaa 200,200,8
Ta 236,19,8192
Ta 238,19,9216
Zvaa 232,200,12
Zvaa 140,204,0
Zvaa 172,204,4
Ta 240,20,8192
Ta 242,20,9216
Zvaa 204,204,8
buffer_load_dwordx4 a[76:79], v11, s[20:23], 0 offen offset:0 sc1
Zvaa 236,204,12
Zvaa 144,208,0
s_waitcnt lgkmcnt(6)
Ta 244,21,8192
Ta 246,21,9216
Zvaa 176,208,4
Zvaa 208,208,8
buffer_load_dwordx4 a[80:83], v10, s[20:23], s58 offen offset:1024 sc1
Zvaa 240,208,12
Ta 248,22,8192
Ta 250,22,9216
Zvaa 148,212,0
Zvaa 180,212,4
Zvaa 212,212,8
Ta 252,23,8192
Ta 254,23,9216
Zvaa 244,212,12
buffer_load_dwordx4 a[84:87], v10, s[20:23], 0 offen offset:1024 sc1
Zvaa 152,216,0
Zvaa 184,216,4
Zvaa 216,216,8
buffer_load_dwordx4 a[88:91], v11, s[20:23], s58 offen offset:1024 sc1
Zvaa 248,216,12
buffer_store_dwordx4 v[52:55], v2, s[24:27], s59 offen offset:3072 sc1
Zvaa 156,220,0
Zvaa 188,220,4
buffer_load_dwordx4 a[92:95], v11, s[20:23], 0 offen offset:1024 sc1
Zvaa 220,220,8
Zvaa 252,220,12
s_waitcnt vmcnt(22) lgkmcnt(0)
s_barrier
Mvaa 128,224,16
Mvaa 160,224,20
s_add_u32 m0, s44, 0
Ta 192,16,16384
Ta 194,16,17408
Mvaa 192,224,24
buffer_load_dwordx4 v8, s[8:11], s48 offen offset:0 lds
Mvaa 224,224,28
Mvaa 132,228,16
Ta 196,17,16384
Ta 198,17,17408
Mvaa 164,228,20
buffer_load_dwordx4 v8, s[8:11], s49 offen offset:1024 lds
Mvaa 196,228,24
Mvaa 228,228,28
Ta 200,18,16384
Ta 202,18,17408
Mvaa 136,232,16
Mvaa 168,232,20
buffer_load_dwordx4 v9, s[8:11], s50 offen offset:2048 lds
Mvaa 200,232,24
Ta 204,19,16384
Ta 206,19,17408
Mvaa 232,232,28
Mvaa 140,236,16
Mvaa 172,236,20
Ta 208,20,16384
Ta 210,20,17408
Mvaa 204,236,24
buffer_load_dwordx4 v9, s[8:11], s51 offen offset:3072 lds
v_add_u32 v8, 524288, v8
v_add_u32 v9, 524288, v9
Mvaa 236,236,28
Mvaa 144,240,16
s_waitcnt lgkmcnt(6)
Ta 212,21,16384
Ta 214,21,17408
Mvaa 176,240,20
Mvaa 208,240,24
buffer_load_dwordx4 a[96:99], v10, s[20:23], s58 offen offset:2048 sc1
Mvaa 240,240,28
Ta 216,22,16384
Ta 218,22,17408
Mvaa 148,244,16
Mvaa 180,244,20
Mvaa 212,244,24
Ta 220,23,16384
Ta 222,23,17408
Mvaa 244,244,28
buffer_load_dwordx4 a[100:103], v10, s[20:23], 0 offen offset:2048 sc1
Mvaa 152,248,16
s_add_u32 s59, s38, 8192
Mvaa 184,248,20
buffer_store_dwordx4 v[56:59], v2, s[24:27], s59 offen offset:0 sc1
Mvaa 216,248,24
buffer_load_dwordx4 a[104:107], v11, s[20:23], s58 offen offset:2048 sc1
Mvaa 248,248,28
Ar 48,128
Ar 49,129
Mvaa 156,252,16
Ar 50,130
Ar 51,131
Mvaa 188,252,20
buffer_load_dwordx4 a[108:111], v11, s[20:23], 0 offen offset:2048 sc1
Mvaa 220,252,24
Ar 52,132
Ar 53,133
Mvaa 252,252,28
Ar 54,134
Ar 55,135
s_waitcnt vmcnt(25) lgkmcnt(0)
Mvaa 128,192,32
Vc 24,48,49
Vc 25,50,51
Mvaa 160,192,36
Ta 224,16,24576
Ta 226,16,25600
Mvaa 192,192,40
buffer_load_dwordx4 a[112:115], v10, s[20:23], s58 offen offset:3072 sc1
Mvaa 224,192,44
Vc 26,52,53
Vc 27,54,55
Mvaa 132,196,32
Ta 228,17,24576
Ta 230,17,25600
Mvaa 164,196,36
Mvaa 196,196,40
Mvaa 228,196,44
Ta 232,18,24576
Ta 234,18,25600
Mvaa 136,200,32
Mvaa 168,200,36
buffer_load_dwordx4 a[116:119], v10, s[20:23], 0 offen offset:3072 sc1
Mvaa 200,200,40
Ta 236,19,24576
Ta 238,19,25600
Mvaa 232,200,44
Mvaa 140,204,32
Mvaa 172,204,36
Ta 240,20,24576
Ta 242,20,25600
Mvaa 204,204,40
Mvaa 236,204,44
Mvaa 144,208,32
s_waitcnt lgkmcnt(6)
Ta 244,21,24576
Ta 246,21,25600
Mvaa 176,208,36
buffer_store_dwordx4 v[60:63], v2, s[24:27], s59 offen offset:1024 sc1
Mvaa 208,208,40
buffer_load_dwordx4 a[120:123], v11, s[20:23], s58 offen offset:3072 sc1
Mvaa 240,208,44
Ta 248,22,24576
Ta 250,22,25600
Mvaa 148,212,32
Ar 48,136
Ar 49,137
Mvaa 180,212,36
Ar 50,138
Ar 51,139
Mvaa 212,212,40
Ta 252,23,24576
Ta 254,23,25600
Mvaa 244,212,44
Ar 52,140
Ar 53,141
Mvaa 152,216,32
Ar 54,142
Ar 55,143
Mvaa 184,216,36
Vc 28,48,49
Vc 29,50,51
Mvaa 216,216,40
buffer_load_dwordx4 a[124:127], v11, s[20:23], 0 offen offset:3072 sc1
v_add_u32 v10, 4096, v10
v_add_u32 v11, 4096, v11
Mvaa 248,216,44
Vc 30,52,53
Vc 31,54,55
Mvaa 156,220,32
Mvaa 188,220,36
Mvaa 220,220,40
Mvaa 252,220,44
s_waitcnt vmcnt(25) lgkmcnt(0)
s_barrier
Mvaa 128,224,48
Mvaa 160,224,52
s_add_u32 m0, s44, 16384
Ta 192,16,32768
Ta 194,16,33792
Mvaa 192,224,56
buffer_load_dwordx4 v8, s[8:11], s48 offen offset:0 lds
Mvaa 224,224,60
Mvaa 132,228,48
Ta 196,17,32768
Ta 198,17,33792
Mvaa 164,228,52
buffer_load_dwordx4 v8, s[8:11], s49 offen offset:1024 lds
Mvaa 196,228,56
Mvaa 228,228,60
Ta 200,18,32768
Ta 202,18,33792
Mvaa 136,232,48
Mvaa 168,232,52
buffer_load_dwordx4 v9, s[8:11], s50 offen offset:2048 lds
Mvaa 200,232,56
Ta 204,19,32768
Ta 206,19,33792
Mvaa 232,232,60
buffer_store_dwordx4 v[64:67], v2, s[24:27], s59 offen offset:2048 sc1
Mvaa 140,236,48
Ar 48,144
Ar 49,145
Mvaa 172,236,52
Ta 208,20,32768
Ta 210,20,33792
Mvaa 204,236,56
buffer_load_dwordx4 v9, s[8:11], s51 offen offset:3072 lds
v_add_u32 v8, 524288, v8
v_add_u32 v9, 524288, v9
Mvaa 236,236,60
Ar 50,146
Ar 51,147
Mvaa 144,240,48
s_waitcnt lgkmcnt(6)
Ta 212,21,32768
Ta 214,21,33792
Mvaa 176,240,52
Ar 52,148
Ar 53,149
Mvaa 208,240,56
buffer_load_dwordx4 a[0:3], v10, s[20:23], s58 offen offset:0 sc1
Mvaa 240,240,60
Ta 216,22,32768
Ta 218,22,33792
Mvaa 148,244,48
Ar 54,150
Ar 55,151
Mvaa 180,244,52
Vc 32,48,49
Vc 33,50,51
Mvaa 212,244,56
Ta 220,23,32768
Ta 222,23,33792
Mvaa 244,244,60
buffer_load_dwordx4 a[4:7], v10, s[20:23], 0 offen offset:0 sc1
Mvaa 152,248,48
Vc 34,52,53
Vc 35,54,55
Mvaa 184,248,52
Mvaa 216,248,56
buffer_load_dwordx4 a[8:11], v11, s[20:23], s58 offen offset:0 sc1
Mvaa 248,248,60
Mvaa 156,252,48
Mvaa 188,252,52
buffer_load_dwordx4 a[12:15], v11, s[20:23], 0 offen offset:0 sc1
Mvaa 220,252,56
Mvaa 252,252,60
s_waitcnt vmcnt(28) lgkmcnt(0)
Mvaa 128,192,64
Mvaa 160,192,68
Ta 224,16,40960
Ta 226,16,41984
Mvaa 192,192,72
buffer_load_dwordx4 a[16:19], v10, s[20:23], s58 offen offset:1024 sc1
Mvaa 224,192,76
Mvaa 132,196,64
Ta 228,17,40960
Ta 230,17,41984
Mvaa 164,196,68
Mvaa 196,196,72
buffer_store_dwordx4 v[68:71], v2, s[24:27], s59 offen offset:3072 sc1
Mvaa 228,196,76
Ta 232,18,40960
Ta 234,18,41984
Mvaa 136,200,64
Ar 48,152
Ar 49,153
Mvaa 168,200,68
buffer_load_dwordx4 a[20:23], v10, s[20:23], 0 offen offset:1024 sc1
Mvaa 200,200,72
Ta 236,19,40960
Ta 238,19,41984
Mvaa 232,200,76
Ar 50,154
Ar 51,155
Mvaa 140,204,64
Ar 52,156
Ar 53,157
Mvaa 172,204,68
Ta 240,20,40960
Ta 242,20,41984
Mvaa 204,204,72
Ar 54,158
Ar 55,159
Mvaa 236,204,76
Vc 36,48,49
Vc 37,50,51
Mvaa 144,208,64
s_waitcnt lgkmcnt(6)
Ta 244,21,40960
Ta 246,21,41984
Mvaa 176,208,68
Vc 38,52,53
Vc 39,54,55
Mvaa 208,208,72
buffer_load_dwordx4 a[24:27], v11, s[20:23], s58 offen offset:1024 sc1
Mvaa 240,208,76
Ta 248,22,40960
Ta 250,22,41984
Mvaa 148,212,64
Mvaa 180,212,68
Mvaa 212,212,72
Ta 252,23,40960
Ta 254,23,41984
Mvaa 244,212,76
Mvaa 152,216,64
Mvaa 184,216,68
Mvaa 216,216,72
buffer_load_dwordx4 a[28:31], v11, s[20:23], 0 offen offset:1024 sc1
Mvaa 248,216,76
Mvaa 156,220,64
Mvaa 188,220,68
Mvaa 220,220,72
Mvaa 252,220,76
s_waitcnt vmcnt(28) lgkmcnt(0)
s_barrier
Mvaa 128,224,80
s_add_u32 s59, s38, 12288
Mvaa 160,224,84
s_add_u32 m0, s44, 32768
Ta 192,16,49152
Ta 194,16,50176
Mvaa 192,224,88
buffer_load_dwordx4 v8, s[8:11], s48 offen offset:0 lds
Mvaa 224,224,92
buffer_store_dwordx4 v[72:75], v2, s[24:27], s59 offen offset:0 sc1
Mvaa 132,228,80
Ta 196,17,49152
Ta 198,17,50176
Mvaa 164,228,84
buffer_load_dwordx4 v8, s[8:11], s49 offen offset:1024 lds
Mvaa 196,228,88
Ar 48,160
Ar 49,161
Mvaa 228,228,92
Ta 200,18,49152
Ta 202,18,50176
Mvaa 136,232,80
Ar 50,162
Ar 51,163
Mvaa 168,232,84
buffer_load_dwordx4 v9, s[8:11], s50 offen offset:2048 lds
Mvaa 200,232,88
Ta 204,19,49152
Ta 206,19,50176
Mvaa 232,232,92
Ar 52,164
Ar 53,165
Mvaa 140,236,80
Ar 54,166
Ar 55,167
Mvaa 172,236,84
Ta 208,20,49152
Ta 210,20,50176
Mvaa 204,236,88
buffer_load_dwordx4 v9, s[8:11], s51 offen offset:3072 lds
v_add_u32 v8, 524288, v8
v_add_u32 v9, 524288, v9
Mvaa 236,236,92
Vc 40,48,49
Vc 41,50,51
Mvaa 144,240,80
s_waitcnt lgkmcnt(6)
Ta 212,21,49152
Ta 214,21,50176
Mvaa 176,240,84
Vc 42,52,53
Vc 43,54,55
Mvaa 208,240,88
buffer_load_dwordx4 a[32:35], v10, s[20:23], s58 offen offset:2048 sc1
Mvaa 240,240,92
Ta 216,22,49152
Ta 218,22,50176
Mvaa 148,244,80
global_load_dword v13, v[14:15], off
Mvaa 180,244,84
Mvaa 212,244,88
Ta 220,23,49152
Ta 222,23,50176
Mvaa 244,244,92
buffer_load_dwordx4 a[36:39], v10, s[20:23], 0 offen offset:2048 sc1
Mvaa 152,248,80
Mvaa 184,248,84
Mvaa 216,248,88
buffer_load_dwordx4 a[40:43], v11, s[20:23], s58 offen offset:2048 sc1
Mvaa 248,248,92
buffer_store_dwordx4 v[76:79], v2, s[24:27], s59 offen offset:1024 sc1
Mvaa 156,252,80
Ar 48,168
Ar 49,169
Mvaa 188,252,84
buffer_load_dwordx4 a[44:47], v11, s[20:23], 0 offen offset:2048 sc1
Mvaa 220,252,88
Ar 50,170
Ar 51,171
Mvaa 252,252,92
Ar 52,172
Ar 53,173
s_waitcnt vmcnt(30) lgkmcnt(0)
Mvaa 128,192,96
Ar 54,174
Ar 55,175
Mvaa 160,192,100
Ta 224,16,57344
Ta 226,16,58368
Mvaa 192,192,104
buffer_load_dwordx4 a[48:51], v10, s[20:23], s58 offen offset:3072 sc1
Mvaa 224,192,108
Vc 44,48,49
Vc 45,50,51
Mvaa 132,196,96
Ta 228,17,57344
Ta 230,17,58368
Mvaa 164,196,100
Vc 46,52,53
Vc 47,54,55
Mvaa 196,196,104
Mvaa 228,196,108
Ta 232,18,57344
Ta 234,18,58368
Mvaa 136,200,96
Mvaa 168,200,100
buffer_load_dwordx4 a[52:55], v10, s[20:23], 0 offen offset:3072 sc1
Mvaa 200,200,104
Ta 236,19,57344
Ta 238,19,58368
Mvaa 232,200,108
Mvaa 140,204,96
Mvaa 172,204,100
Ta 240,20,57344
Ta 242,20,58368
Mvaa 204,204,104
Mvaa 236,204,108
Mvaa 144,208,96
s_waitcnt lgkmcnt(6)
Ta 244,21,57344
Ta 246,21,58368
Mvaa 176,208,100
Mvaa 208,208,104
buffer_load_dwordx4 a[56:59], v11, s[20:23], s58 offen offset:3072 sc1
Mvaa 240,208,108
Ta 248,22,57344
Ta 250,22,58368
Mvaa 148,212,96
Mvaa 180,212,100
Mvaa 212,212,104
Ta 252,23,57344
Ta 254,23,58368
Mvaa 244,212,108
buffer_store_dwordx4 v[80:83], v2, s[24:27], s59 offen offset:2048 sc1
Mvaa 152,216,96
Mvaa 184,216,100
Mvaa 216,216,104
buffer_load_dwordx4 a[60:63], v11, s[20:23], 0 offen offset:3072 sc1
v_add_u32 v10, 4096, v10
v_add_u32 v11, 4096, v11
Mvaa 248,216,108
Mvaa 156,220,96
Mvaa 188,220,100
Mvaa 220,220,104
Mvaa 252,220,108
s_waitcnt vmcnt(30) lgkmcnt(0)
s_barrier
Mvaa 128,224,112
Mvaa 160,224,116
s_add_u32 m0, s44, 49152
Ta 192,16,0
Ta 194,16,1024
Mvaa 192,224,120
buffer_load_dwordx4 v8, s[8:11], s48 offen offset:0 lds
Mvaa 224,224,124
Mvaa 132,228,112
Ta 196,17,0
Ta 198,17,1024
Mvaa 164,228,116
buffer_load_dwordx4 v8, s[8:11], s49 offen offset:1024 lds
Mvaa 196,228,120
Mvaa 228,228,124
Ta 200,18,0
Ta 202,18,1024
Mvaa 136,232,112
Mvaa 168,232,116
buffer_load_dwordx4 v9, s[8:11], s50 offen offset:2048 lds
Mvaa 200,232,120
Ta 204,19,0
Ta 206,19,1024
Mvaa 232,232,124
Mvaa 140,236,112
Mvaa 172,236,116
Ta 208,20,0
Ta 210,20,1024
Mvaa 204,236,120
buffer_load_dwordx4 v9, s[8:11], s51 offen offset:3072 lds
v_add_u32 v8, 524288, v8
v_add_u32 v9, 524288, v9
Mvaa 236,236,124
Mvaa 144,240,112
s_waitcnt lgkmcnt(6)
Ta 212,21,0
Ta 214,21,1024
Mvaa 176,240,116
buffer_store_dwordx4 v[84:87], v2, s[24:27], s59 offen offset:3072 sc1
Mvaa 208,240,120
buffer_load_dwordx4 a[64:67], v10, s[20:23], s58 offen offset:0 sc1
Mvaa 240,240,124
Ta 216,22,0
Ta 218,22,1024
Mvaa 148,244,112
Mvaa 180,244,116
Mvaa 212,244,120
Ta 220,23,0
Ta 222,23,1024
Mvaa 244,244,124
buffer_load_dwordx4 a[68:71], v10, s[20:23], 0 offen offset:0 sc1
Mvaa 152,248,112
Mvaa 184,248,116
Mvaa 216,248,120
buffer_load_dwordx4 a[72:75], v11, s[20:23], s58 offen offset:0 sc1
Mvaa 248,248,124
Mvaa 156,252,112
Mvaa 188,252,116
buffer_load_dwordx4 a[76:79], v11, s[20:23], 0 offen offset:0 sc1
Mvaa 220,252,120
Mvaa 252,252,124
s_waitcnt vmcnt(30) lgkmcnt(0)
Mvaa 128,192,0
Mvaa 160,192,4
Ta 224,16,8192
Ta 226,16,9216
Mvaa 192,192,8
buffer_load_dwordx4 a[80:83], v10, s[20:23], s58 offen offset:1024 sc1
Mvaa 224,192,12
Mvaa 132,196,0
Ta 228,17,8192
Ta 230,17,9216
Mvaa 164,196,4
Mvaa 196,196,8
Mvaa 228,196,12
Ta 232,18,8192
Ta 234,18,9216
Mvaa 136,200,0
Mvaa 168,200,4
buffer_load_dwordx4 a[84:87], v10, s[20:23], 0 offen offset:1024 sc1
Mvaa 200,200,8
Ta 236,19,8192
Ta 238,19,9216
Mvaa 232,200,12
s_add_u32 s59, s38, 34816
Mvaa 140,204,0
buffer_store_dwordx4 v[88:91], v2, s[24:27], s59 offen offset:0 sc1
Mvaa 172,204,4
Ta 240,20,8192
Ta 242,20,9216
Mvaa 204,204,8
Mvaa 236,204,12
Mvaa 144,208,0
s_waitcnt lgkmcnt(6)
Ta 244,21,8192
Ta 246,21,9216
Mvaa 176,208,4
Mvaa 208,208,8
buffer_load_dwordx4 a[88:91], v11, s[20:23], s58 offen offset:1024 sc1
Mvaa 240,208,12
Ta 248,22,8192
Ta 250,22,9216
Mvaa 148,212,0
Mvaa 180,212,4
Mvaa 212,212,8
Ta 252,23,8192
Ta 254,23,9216
Mvaa 244,212,12
Mvaa 152,216,0
Mvaa 184,216,4
Mvaa 216,216,8
buffer_load_dwordx4 a[92:95], v11, s[20:23], 0 offen offset:1024 sc1
Mvaa 248,216,12
Mvaa 156,220,0
Mvaa 188,220,4
Mvaa 220,220,8
Mvaa 252,220,12
s_waitcnt vmcnt(30) lgkmcnt(0)
s_barrier
Mvaa 128,224,16
Mvaa 160,224,20
s_add_u32 m0, s44, 0
Ta 192,16,16384
Ta 194,16,17408
Mvaa 192,224,24
buffer_load_dwordx4 v8, s[8:11], s48 offen offset:0 lds
Mvaa 224,224,28
Mvaa 132,228,16
Ta 196,17,16384
Ta 198,17,17408
Mvaa 164,228,20
buffer_load_dwordx4 v8, s[8:11], s49 offen offset:1024 lds
Mvaa 196,228,24
buffer_store_dwordx4 v[92:95], v2, s[24:27], s59 offen offset:1024 sc1
Mvaa 228,228,28
Ta 200,18,16384
Ta 202,18,17408
Mvaa 136,232,16
Mvaa 168,232,20
buffer_load_dwordx4 v9, s[8:11], s50 offen offset:2048 lds
Mvaa 200,232,24
Ta 204,19,16384
Ta 206,19,17408
Mvaa 232,232,28
Mvaa 140,236,16
Mvaa 172,236,20
Ta 208,20,16384
Ta 210,20,17408
Mvaa 204,236,24
buffer_load_dwordx4 v9, s[8:11], s51 offen offset:3072 lds
v_add_u32 v8, 524288, v8
v_add_u32 v9, 524288, v9
Mvaa 236,236,28
Mvaa 144,240,16
s_waitcnt lgkmcnt(6)
Ta 212,21,16384
Ta 214,21,17408
Mvaa 176,240,20
Mvaa 208,240,24
buffer_load_dwordx4 a[96:99], v10, s[20:23], s58 offen offset:2048 sc1
Mvaa 240,240,28
Ta 216,22,16384
Ta 218,22,17408
Mvaa 148,244,16
Mvaa 180,244,20
Mvaa 212,244,24
Ta 220,23,16384
Ta 222,23,17408
Mvaa 244,244,28
buffer_load_dwordx4 a[100:103], v10, s[20:23], 0 offen offset:2048 sc1
Mvaa 152,248,16
Mvaa 184,248,20
Mvaa 216,248,24
buffer_load_dwordx4 a[104:107], v11, s[20:23], s58 offen offset:2048 sc1
Mvaa 248,248,28
Mvaa 156,252,16
Mvaa 188,252,20
buffer_load_dwordx4 a[108:111], v11, s[20:23], 0 offen offset:2048 sc1
Mvaa 220,252,24
Mvaa 252,252,28
s_waitcnt vmcnt(28) lgkmcnt(0)
Mvaa 128,192,32
buffer_store_dwordx4 v[96:99], v2, s[24:27], s59 offen offset:2048 sc1
Mvaa 160,192,36
Ta 224,16,24576
Ta 226,16,25600
Mvaa 192,192,40
buffer_load_dwordx4 a[112:115], v10, s[20:23], s58 offen offset:3072 sc1
Mvaa 224,192,44
Mvaa 132,196,32
Ta 228,17,24576
Ta 230,17,25600
Mvaa 164,196,36
Mvaa 196,196,40
s_mov_b32 s3, 5242880
s_mov_b32 s47, 5246976
Mvaa 228,196,44
Ta 232,18,24576
Ta 234,18,25600
Mvaa 136,200,32
buffer_load_dwordx4 v[56:59], v2, s[20:23], s3 offen offset:0 sc1
Mvaa 168,200,36
buffer_load_dwordx4 a[116:119], v10, s[20:23], 0 offen offset:3072 sc1
Mvaa 200,200,40
Ta 236,19,24576
Ta 238,19,25600
Mvaa 232,200,44
buffer_load_dwordx4 v[60:63], v2, s[20:23], s3 offen offset:1024 sc1
Mvaa 140,204,32
buffer_load_dwordx4 v[64:67], v2, s[20:23], s3 offen offset:2048 sc1
Mvaa 172,204,36
Ta 240,20,24576
Ta 242,20,25600
Mvaa 204,204,40
buffer_load_dwordx4 v[68:71], v2, s[20:23], s3 offen offset:3072 sc1
Mvaa 236,204,44
buffer_load_dwordx4 v[72:75], v2, s[20:23], s47 offen offset:0 sc1
Mvaa 144,208,32
s_waitcnt lgkmcnt(6)
Ta 244,21,24576
Ta 246,21,25600
Mvaa 176,208,36
buffer_load_dwordx4 v[76:79], v2, s[20:23], s47 offen offset:1024 sc1
Mvaa 208,208,40
buffer_load_dwordx4 a[120:123], v11, s[20:23], s58 offen offset:3072 sc1
Mvaa 240,208,44
Ta 248,22,24576
Ta 250,22,25600
Mvaa 148,212,32
buffer_load_dwordx4 v[80:83], v2, s[20:23], s47 offen offset:2048 sc1
Mvaa 180,212,36
buffer_load_dwordx4 v[84:87], v2, s[20:23], s47 offen offset:3072 sc1
Mvaa 212,212,40
Ta 252,23,24576
Ta 254,23,25600
Mvaa 244,212,44
Mvaa 152,216,32
Mvaa 184,216,36
Mvaa 216,216,40
buffer_load_dwordx4 a[124:127], v11, s[20:23], 0 offen offset:3072 sc1
v_add_u32 v10, 4096, v10
v_add_u32 v11, 4096, v11
Mvaa 248,216,44
buffer_store_dwordx4 v[100:103], v2, s[24:27], s59 offen offset:3072 sc1
Mvaa 156,220,32
Mvaa 188,220,36
Mvaa 220,220,40
Mvaa 252,220,44
s_waitcnt vmcnt(37) lgkmcnt(0)
s_barrier
Mvaa 128,224,48
Mvaa 160,224,52
s_add_u32 m0, s44, 16384
Ta 192,16,32768
Ta 194,16,33792
Mvaa 192,224,56
buffer_load_dwordx4 v8, s[8:11], s48 offen offset:0 lds
Mvaa 224,224,60
Mvaa 132,228,48
Ta 196,17,32768
Ta 198,17,33792
Mvaa 164,228,52
buffer_load_dwordx4 v8, s[8:11], s49 offen offset:1024 lds
Mvaa 196,228,56
Mvaa 228,228,60
Ta 200,18,32768
Ta 202,18,33792
Mvaa 136,232,48
Mvaa 168,232,52
buffer_load_dwordx4 v9, s[8:11], s50 offen offset:2048 lds
Mvaa 200,232,56
Ta 204,19,32768
Ta 206,19,33792
Mvaa 232,232,60
Mvaa 140,236,48
Mvaa 172,236,52
Ta 208,20,32768
Ta 210,20,33792
Mvaa 204,236,56
buffer_load_dwordx4 v9, s[8:11], s51 offen offset:3072 lds
v_add_u32 v8, 524288, v8
v_add_u32 v9, 524288, v9
Mvaa 236,236,60
Mvaa 144,240,48
s_waitcnt lgkmcnt(6)
Ta 212,21,32768
Ta 214,21,33792
Mvaa 176,240,52
Mvaa 208,240,56
buffer_load_dwordx4 a[0:3], v10, s[20:23], s58 offen offset:0 sc1
Mvaa 240,240,60
Ta 216,22,32768
Ta 218,22,33792
Mvaa 148,244,48
Mvaa 180,244,52
Mvaa 212,244,56
Ta 220,23,32768
Ta 222,23,33792
Mvaa 244,244,60
buffer_load_dwordx4 a[4:7], v10, s[20:23], 0 offen offset:0 sc1
Mvaa 152,248,48
s_add_u32 s59, s38, 38912
Mvaa 184,248,52
buffer_store_dwordx4 v[104:107], v2, s[24:27], s59 offen offset:0 sc1
Mvaa 216,248,56
buffer_load_dwordx4 a[8:11], v11, s[20:23], s58 offen offset:0 sc1
Mvaa 248,248,60
Mvaa 156,252,48
Mvaa 188,252,52
buffer_load_dwordx4 a[12:15], v11, s[20:23], 0 offen offset:0 sc1
Mvaa 220,252,56
Mvaa 252,252,60
s_waitcnt vmcnt(37) lgkmcnt(0)
Mvaa 128,192,64
Mvaa 160,192,68
Ta 224,16,40960
Ta 226,16,41984
Mvaa 192,192,72
buffer_load_dwordx4 a[16:19], v10, s[20:23], s58 offen offset:1024 sc1
Mvaa 224,192,76
Mvaa 132,196,64
Ta 228,17,40960
Ta 230,17,41984
Mvaa 164,196,68
Mvaa 196,196,72
Mvaa 228,196,76
Ta 232,18,40960
Ta 234,18,41984
Mvaa 136,200,64
Mvaa 168,200,68
buffer_load_dwordx4 a[20:23], v10, s[20:23], 0 offen offset:1024 sc1
Mvaa 200,200,72
Ta 236,19,40960
Ta 238,19,41984
Mvaa 232,200,76
Mvaa 140,204,64
Mvaa 172,204,68
Ta 240,20,40960
Ta 242,20,41984
Mvaa 204,204,72
Mvaa 236,204,76
Mvaa 144,208,64
s_waitcnt lgkmcnt(6)
Ta 244,21,40960
Ta 246,21,41984
Mvaa 176,208,68
buffer_store_dwordx4 v[108:111], v2, s[24:27], s59 offen offset:1024 sc1
Mvaa 208,208,72
buffer_load_dwordx4 a[24:27], v11, s[20:23], s58 offen offset:1024 sc1
Mvaa 240,208,76
Ta 248,22,40960
Ta 250,22,41984
Mvaa 148,212,64
Mvaa 180,212,68
Mvaa 212,212,72
Ta 252,23,40960
Ta 254,23,41984
Mvaa 244,212,76
Mvaa 152,216,64
Mvaa 184,216,68
Mvaa 216,216,72
buffer_load_dwordx4 a[28:31], v11, s[20:23], 0 offen offset:1024 sc1
Mvaa 248,216,76
Mvaa 156,220,64
Mvaa 188,220,68
Mvaa 220,220,72
Mvaa 252,220,76
s_waitcnt vmcnt(37) lgkmcnt(0)
s_barrier
Mvaa 128,224,80
Mvaa 160,224,84
s_add_u32 m0, s44, 32768
Ta 192,16,49152
Ta 194,16,50176
Mvaa 192,224,88
buffer_load_dwordx4 v8, s[8:11], s48 offen offset:0 lds
Mvaa 224,224,92
Mvaa 132,228,80
Ta 196,17,49152
Ta 198,17,50176
Mvaa 164,228,84
buffer_load_dwordx4 v8, s[8:11], s49 offen offset:1024 lds
Mvaa 196,228,88
Mvaa 228,228,92
Ta 200,18,49152
Ta 202,18,50176
Mvaa 136,232,80
Mvaa 168,232,84
buffer_load_dwordx4 v9, s[8:11], s50 offen offset:2048 lds
Mvaa 200,232,88
Ta 204,19,49152
Ta 206,19,50176
Mvaa 232,232,92
buffer_store_dwordx4 v[112:115], v2, s[24:27], s59 offen offset:2048 sc1
Mvaa 140,236,80
Mvaa 172,236,84
Ta 208,20,49152
Ta 210,20,50176
Mvaa 204,236,88
buffer_load_dwordx4 v9, s[8:11], s51 offen offset:3072 lds
v_add_u32 v8, 524288, v8
v_add_u32 v9, 524288, v9
Mvaa 236,236,92
Mvaa 144,240,80
s_waitcnt lgkmcnt(6)
Ta 212,21,49152
Ta 214,21,50176
Mvaa 176,240,84
Mvaa 208,240,88
buffer_load_dwordx4 a[32:35], v10, s[20:23], s58 offen offset:2048 sc1
Mvaa 240,240,92
Ta 216,22,49152
Ta 218,22,50176
Mvaa 148,244,80
Mvaa 180,244,84
Mvaa 212,244,88
Ta 220,23,49152
Ta 222,23,50176
Mvaa 244,244,92
buffer_load_dwordx4 a[36:39], v10, s[20:23], 0 offen offset:2048 sc1
Mvaa 152,248,80
Mvaa 184,248,84
Mvaa 216,248,88
buffer_load_dwordx4 a[40:43], v11, s[20:23], s58 offen offset:2048 sc1
Mvaa 248,248,92
Mvaa 156,252,80
Mvaa 188,252,84
buffer_load_dwordx4 a[44:47], v11, s[20:23], 0 offen offset:2048 sc1
Mvaa 220,252,88
Mvaa 252,252,92
s_waitcnt vmcnt(37) lgkmcnt(0)
Mvaa 128,192,96
Mvaa 160,192,100
Ta 224,16,57344
Ta 226,16,58368
Mvaa 192,192,104
buffer_load_dwordx4 a[48:51], v10, s[20:23], s58 offen offset:3072 sc1
Mvaa 224,192,108
Mvaa 132,196,96
Ta 228,17,57344
Ta 230,17,58368
Mvaa 164,196,100
Mvaa 196,196,104
buffer_store_dwordx4 v[116:119], v2, s[24:27], s59 offen offset:3072 sc1
Mvaa 228,196,108
Ta 232,18,57344
Ta 234,18,58368
Mvaa 136,200,96
Mvaa 168,200,100
buffer_load_dwordx4 a[52:55], v10, s[20:23], 0 offen offset:3072 sc1
Mvaa 200,200,104
Ta 236,19,57344
Ta 238,19,58368
Mvaa 232,200,108
Mvaa 140,204,96
Mvaa 172,204,100
Ta 240,20,57344
Ta 242,20,58368
Mvaa 204,204,104
Mvaa 236,204,108
Mvaa 144,208,96
s_waitcnt lgkmcnt(6)
Ta 244,21,57344
Ta 246,21,58368
Mvaa 176,208,100
Mvaa 208,208,104
buffer_load_dwordx4 a[56:59], v11, s[20:23], s58 offen offset:3072 sc1
Mvaa 240,208,108
Ta 248,22,57344
Ta 250,22,58368
Mvaa 148,212,96
Mvaa 180,212,100
Mvaa 212,212,104
Ta 252,23,57344
Ta 254,23,58368
Mvaa 244,212,108
Mvaa 152,216,96
Mvaa 184,216,100
Mvaa 216,216,104
buffer_load_dwordx4 a[60:63], v11, s[20:23], 0 offen offset:3072 sc1
v_add_u32 v10, 4096, v10
v_add_u32 v11, 4096, v11
Mvaa 248,216,108
Mvaa 156,220,96
Mvaa 188,220,100
Mvaa 220,220,104
Mvaa 252,220,108
s_waitcnt vmcnt(29) lgkmcnt(0)
s_barrier
Mvaa 128,224,112
s_add_u32 s59, s38, 43008
Mvaa 160,224,116
s_add_u32 m0, s44, 49152
Ta 192,16,0
Ta 194,16,1024
Mvaa 192,224,120
buffer_load_dwordx4 v8, s[8:11], s48 offen offset:0 lds
Mvaa 224,224,124
buffer_store_dwordx4 v[120:123], v2, s[24:27], s59 offen offset:0 sc1
Mvaa 132,228,112
Ta 196,17,0
Ta 198,17,1024
Mvaa 164,228,116
buffer_load_dwordx4 v8, s[8:11], s49 offen offset:1024 lds
Mvaa 196,228,120
Mvaa 228,228,124
Ta 200,18,0
Ta 202,18,1024
Mvaa 136,232,112
Mvaa 168,232,116
buffer_load_dwordx4 v9, s[8:11], s50 offen offset:2048 lds
Mvaa 200,232,120
Ta 204,19,0
Ta 206,19,1024
Mvaa 232,232,124
Mvaa 140,236,112
Mvaa 172,236,116
Ta 208,20,0
Ta 210,20,1024
Mvaa 204,236,120
buffer_load_dwordx4 v9, s[8:11], s51 offen offset:3072 lds
v_add_u32 v8, 524288, v8
v_add_u32 v9, 524288, v9
Mvaa 236,236,124
Mvaa 144,240,112
s_waitcnt lgkmcnt(6)
Ta 212,21,0
Ta 214,21,1024
Mvaa 176,240,116
Mvaa 208,240,120
buffer_load_dwordx4 a[64:67], v10, s[20:23], s58 offen offset:0 sc1
Mvaa 240,240,124
Ta 216,22,0
Ta 218,22,1024
Mvaa 148,244,112
Mvaa 180,244,116
Mvaa 212,244,120
Ta 220,23,0
Ta 222,23,1024
Mvaa 244,244,124
buffer_load_dwordx4 a[68:71], v10, s[20:23], 0 offen offset:0 sc1
Mvaa 152,248,112
Mvaa 184,248,116
Mvaa 216,248,120
buffer_load_dwordx4 a[72:75], v11, s[20:23], s58 offen offset:0 sc1
Mvaa 248,248,124
buffer_store_dwordx4 v[124:127], v2, s[24:27], s59 offen offset:1024 sc1
Mvaa 156,252,112
Mvaa 188,252,116
buffer_load_dwordx4 a[76:79], v11, s[20:23], 0 offen offset:0 sc1
Mvaa 220,252,120
Mvaa 252,252,124
s_waitcnt vmcnt(29) lgkmcnt(0)
Mvaa 128,192,0
Mvaa 160,192,4
Ta 224,16,8192
Ta 226,16,9216
Mvaa 192,192,8
buffer_load_dwordx4 a[80:83], v10, s[20:23], s58 offen offset:1024 sc1
Mvaa 224,192,12
Mvaa 132,196,0
Ta 228,17,8192
Ta 230,17,9216
Mvaa 164,196,4
Mvaa 196,196,8
Mvaa 228,196,12
Ta 232,18,8192
Ta 234,18,9216
Mvaa 136,200,0
Mvaa 168,200,4
buffer_load_dwordx4 a[84:87], v10, s[20:23], 0 offen offset:1024 sc1
Mvaa 200,200,8
Ta 236,19,8192
Ta 238,19,9216
Mvaa 232,200,12
Mvaa 140,204,0
Mvaa 172,204,4
Ta 240,20,8192
Ta 242,20,9216
Mvaa 204,204,8
Mvaa 236,204,12
Mvaa 144,208,0
s_waitcnt lgkmcnt(6)
Ta 244,21,8192
Ta 246,21,9216
Mvaa 176,208,4
Mvaa 208,208,8
buffer_load_dwordx4 a[88:91], v11, s[20:23], s58 offen offset:1024 sc1
Mvaa 240,208,12
Ta 248,22,8192
Ta 250,22,9216
Mvaa 148,212,0
Mvaa 180,212,4
Mvaa 212,212,8
Ta 252,23,8192
Ta 254,23,9216
Mvaa 244,212,12
buffer_store_dwordx4 v[24:27], v2, s[24:27], s59 offen offset:2048 sc1
Mvaa 152,216,0
Mvaa 184,216,4
Mvaa 216,216,8
buffer_load_dwordx4 a[92:95], v11, s[20:23], 0 offen offset:1024 sc1
Mvaa 248,216,12
Mvaa 156,220,0
Mvaa 188,220,4
Mvaa 220,220,8
Mvaa 252,220,12
s_waitcnt vmcnt(29) lgkmcnt(0)
s_barrier
Mvaa 128,224,16
Mvaa 160,224,20
s_add_u32 m0, s44, 0
Ta 192,16,16384
Ta 194,16,17408
Mvaa 192,224,24
buffer_load_dwordx4 v8, s[8:11], s48 offen offset:0 lds
Mvaa 224,224,28
Mvaa 132,228,16
Ta 196,17,16384
Ta 198,17,17408
Mvaa 164,228,20
buffer_load_dwordx4 v8, s[8:11], s49 offen offset:1024 lds
Mvaa 196,228,24
v_max_u32 v14, v56, v57
v_min_u32 v15, v56, v57
Mvaa 228,228,28
Ta 200,18,16384
Ta 202,18,17408
Mvaa 136,232,16
v_med3_u32 v15, v14, v15, v58
v_max_u32_e64 v14, v14, v58
Mvaa 168,232,20
buffer_load_dwordx4 v9, s[8:11], s50 offen offset:2048 lds
Mvaa 200,232,24
Ta 204,19,16384
Ta 206,19,17408
Mvaa 232,232,28
v_med3_u32 v15, v14, v15, v59
v_max_u32_e64 v14, v14, v59
Mvaa 140,236,16
v_med3_u32 v15, v14, v15, v60
v_max_u32_e64 v14, v14, v60
Mvaa 172,236,20
Ta 208,20,16384
Ta 210,20,17408
Mvaa 204,236,24
buffer_load_dwordx4 v9, s[8:11], s51 offen offset:3072 lds
v_add_u32 v8, 524288, v8
v_add_u32 v9, 524288, v9
Mvaa 236,236,28
v_med3_u32 v15, v14, v15, v61
v_max_u32_e64 v14, v14, v61
Mvaa 144,240,16
s_waitcnt lgkmcnt(6)
Ta 212,21,16384
Ta 214,21,17408
Mvaa 176,240,20
buffer_store_dwordx4 v[28:31], v2, s[24:27], s59 offen offset:3072 sc1
Mvaa 208,240,24
buffer_load_dwordx4 a[96:99], v10, s[20:23], s58 offen offset:2048 sc1
Mvaa 240,240,28
Ta 216,22,16384
Ta 218,22,17408
Mvaa 148,244,16
v_med3_u32 v15, v14, v15, v62
v_max_u32 v14, v14, v62
Mvaa 180,244,20
v_med3_u32 v15, v14, v15, v63
v_max_u32_e64 v14, v14, v63
Mvaa 212,244,24
Ta 220,23,16384
Ta 222,23,17408
Mvaa 244,244,28
buffer_load_dwordx4 a[100:103], v10, s[20:23], 0 offen offset:2048 sc1
Mvaa 152,248,16
v_med3_u32 v15, v14, v15, v64
v_max_u32_e64 v14, v14, v64
Mvaa 184,248,20
v_med3_u32 v15, v14, v15, v65
v_max_u32_e64 v14, v14, v65
Mvaa 216,248,24
buffer_load_dwordx4 a[104:107], v11, s[20:23], s58 offen offset:2048 sc1
Mvaa 248,248,28
v_med3_u32 v15, v14, v15, v66
v_max_u32_e64 v14, v14, v66
Mvaa 156,252,16
v_med3_u32 v15, v14, v15, v67
v_max_u32_e64 v14, v14, v67
Mvaa 188,252,20
buffer_load_dwordx4 a[108:111], v11, s[20:23], 0 offen offset:2048 sc1
Mvaa 220,252,24
v_med3_u32 v15, v14, v15, v68
v_max_u32_e64 v14, v14, v68
Mvaa 252,252,28
v_med3_u32 v15, v14, v15, v69
v_max_u32 v14, v14, v69
s_waitcnt vmcnt(29) lgkmcnt(0)
Mvaa 128,192,32
v_med3_u32 v15, v14, v15, v70
v_max_u32_e64 v14, v14, v70
Mvaa 160,192,36
Ta 224,16,24576
Ta 226,16,25600
Mvaa 192,192,40
buffer_load_dwordx4 a[112:115], v10, s[20:23], s58 offen offset:3072 sc1
Mvaa 224,192,44
v_med3_u32 v15, v14, v15, v71
v_max_u32_e64 v14, v14, v71
Mvaa 132,196,32
Ta 228,17,24576
Ta 230,17,25600
Mvaa 164,196,36
v_med3_u32 v15, v14, v15, v72
v_max_u32_e64 v14, v14, v72
Mvaa 196,196,40
v_med3_u32 v15, v14, v15, v73
v_max_u32_e64 v14, v14, v73
Mvaa 228,196,44
Ta 232,18,24576
Ta 234,18,25600
Mvaa 136,200,32
v_med3_u32 v15, v14, v15, v74
v_max_u32_e64 v14, v14, v74
Mvaa 168,200,36
buffer_load_dwordx4 a[116:119], v10, s[20:23], 0 offen offset:3072 sc1
Mvaa 200,200,40
Ta 236,19,24576
Ta 238,19,25600
Mvaa 232,200,44
s_add_u32 s59, s38, 47104
Mvaa 140,204,32
buffer_store_dwordx4 v[32:35], v2, s[24:27], s59 offen offset:0 sc1
Mvaa 172,204,36
Ta 240,20,24576
Ta 242,20,25600
Mvaa 204,204,40
v_med3_u32 v15, v14, v15, v75
v_max_u32_e64 v14, v14, v75
Mvaa 236,204,44
v_med3_u32 v15, v14, v15, v76
v_max_u32_e64 v14, v14, v76
Mvaa 144,208,32
s_waitcnt lgkmcnt(6)
Ta 244,21,24576
Ta 246,21,25600
Mvaa 176,208,36
v_med3_u32 v15, v14, v15, v77
v_max_u32 v14, v14, v77
Mvaa 208,208,40
buffer_load_dwordx4 a[120:123], v11, s[20:23], s58 offen offset:3072 sc1
Mvaa 240,208,44
Ta 248,22,24576
Ta 250,22,25600
Mvaa 148,212,32
v_med3_u32 v15, v14, v15, v78
v_max_u32_e64 v14, v14, v78
Mvaa 180,212,36
v_med3_u32 v15, v14, v15, v79
v_max_u32_e64 v14, v14, v79
Mvaa 212,212,40
Ta 252,23,24576
Ta 254,23,25600
Mvaa 244,212,44
v_med3_u32 v15, v14, v15, v80
v_max_u32_e64 v14, v14, v80
Mvaa 152,216,32
v_med3_u32 v15, v14, v15, v81
v_max_u32_e64 v14, v14, v81
Mvaa 184,216,36
v_med3_u32 v15, v14, v15, v82
v_max_u32_e64 v14, v14, v82
Mvaa 216,216,40
buffer_load_dwordx4 a[124:127], v11, s[20:23], 0 offen offset:3072 sc1
v_add_u32 v10, 4096, v10
v_add_u32 v11, 4096, v11
Mvaa 248,216,44
v_med3_u32 v15, v14, v15, v83
v_max_u32_e64 v14, v14, v83
Mvaa 156,220,32
v_med3_u32 v15, v14, v15, v84
v_max_u32_e64 v14, v14, v84
Mvaa 188,220,36
v_med3_u32 v15, v14, v15, v85
v_max_u32_e64 v14, v14, v85
Mvaa 220,220,40
v_med3_u32 v15, v14, v15, v86
v_max_u32_e64 v14, v14, v86
Mvaa 252,220,44
v_med3_u32 v15, v14, v15, v87
v_max_u32 v14, v14, v87
s_waitcnt vmcnt(29) lgkmcnt(0)
s_barrier
Mvaa 128,224,48
v_mov_b32 v13, v14
Mvaa 160,224,52
s_add_u32 m0, s44, 16384
Ta 192,16,32768
Ta 194,16,33792
Mvaa 192,224,56
buffer_load_dwordx4 v8, s[8:11], s48 offen offset:0 lds
Mvaa 224,224,60
v_max_u32_dpp v13, v13, v13 quad_perm:[1,0,3,2] row_mask:0xf bank_mask:0xf
Mvaa 132,228,48
Ta 196,17,32768
Ta 198,17,33792
Mvaa 164,228,52
buffer_load_dwordx4 v8, s[8:11], s49 offen offset:1024 lds
Mvaa 196,228,56
buffer_store_dwordx4 v[36:39], v2, s[24:27], s59 offen offset:1024 sc1
Mvaa 228,228,60
Ta 200,18,32768
Ta 202,18,33792
Mvaa 136,232,48
v_max_u32_dpp v13, v13, v13 quad_perm:[2,3,0,1] row_mask:0xf bank_mask:0xf
Mvaa 168,232,52
buffer_load_dwordx4 v9, s[8:11], s50 offen offset:2048 lds
Mvaa 200,232,56
Ta 204,19,32768
Ta 206,19,33792
Mvaa 232,232,60
v_max_u32_dpp v13, v13, v13 row_half_mirror row_mask:0xf bank_mask:0xf
Mvaa 140,236,48
s_nop 0
v_max_u32_dpp v13, v13, v13 row_mirror row_mask:0xf bank_mask:0xf
Mvaa 172,236,52
Ta 208,20,32768
Ta 210,20,33792
Mvaa 204,236,56
buffer_load_dwordx4 v9, s[8:11], s51 offen offset:3072 lds
v_add_u32 v8, 524288, v8
v_add_u32 v9, 524288, v9
Mvaa 236,236,60
v_readlane_b32 s3, v13, 0
v_readlane_b32 s47, v13, 16
Mvaa 144,240,48
s_waitcnt lgkmcnt(6)
Ta 212,21,32768
Ta 214,21,33792
Mvaa 176,240,52
v_readlane_b32 s4, v13, 32
v_readlane_b32 s5, v13, 48
Mvaa 208,240,56
buffer_load_dwordx4 a[0:3], v10, s[20:23], s58 offen offset:0 sc1
Mvaa 240,240,60
Ta 216,22,32768
Ta 218,22,33792
Mvaa 148,244,48
s_max_u32 s3, s3, s47
s_max_u32 s4, s4, s5
s_max_u32 s40, s3, s4
Mvaa 180,244,52
v_cmp_eq_u32 vcc, s40, v14
Mvaa 212,244,56
Ta 220,23,32768
Ta 222,23,33792
Mvaa 244,244,60
buffer_load_dwordx4 a[4:7], v10, s[20:23], 0 offen offset:0 sc1
Mvaa 152,248,48
v_cndmask_b32 v13, v14, v15, vcc
Mvaa 184,248,52
s_nop 0
v_max_u32_dpp v13, v13, v13 quad_perm:[1,0,3,2] row_mask:0xf bank_mask:0xf
Mvaa 216,248,56
buffer_load_dwordx4 a[8:11], v11, s[20:23], s58 offen offset:0 sc1
Mvaa 248,248,60
v_max_u32_dpp v13, v13, v13 quad_perm:[2,3,0,1] row_mask:0xf bank_mask:0xf
Mvaa 156,252,48
s_nop 0
v_max_u32_dpp v13, v13, v13 row_half_mirror row_mask:0xf bank_mask:0xf
Mvaa 188,252,52
buffer_load_dwordx4 a[12:15], v11, s[20:23], 0 offen offset:0 sc1
Mvaa 220,252,56
v_max_u32_dpp v13, v13, v13 row_mirror row_mask:0xf bank_mask:0xf
Mvaa 252,252,60
v_readlane_b32 s3, v13, 0
v_readlane_b32 s47, v13, 16
s_waitcnt vmcnt(28) lgkmcnt(0)
Mvaa 128,192,64
buffer_store_dwordx4 v[40:43], v2, s[24:27], s59 offen offset:2048 sc1
Mvaa 160,192,68
Ta 224,16,40960
Ta 226,16,41984
Mvaa 192,192,72
buffer_load_dwordx4 a[16:19], v10, s[20:23], s58 offen offset:1024 sc1
Mvaa 224,192,76
v_readlane_b32 s4, v13, 32
v_readlane_b32 s5, v13, 48
Mvaa 132,196,64
Ta 228,17,40960
Ta 230,17,41984
Mvaa 164,196,68
s_max_u32 s3, s3, s47
s_max_u32 s4, s4, s5
s_max_u32 s41, s3, s4
Mvaa 196,196,72
s_and_b32 s3, s40, 0xffff
s_sub_u32 s42, 0xffff, s3
s_and_b32 s3, s41, 0xffff
Mvaa 228,196,76
Ta 232,18,40960
Ta 234,18,41984
Mvaa 136,200,64
s_sub_u32 s43, 0xffff, s3
v_mov_b32 v60, s40
v_not_b32_e64 v61, v60
Mvaa 168,200,68
buffer_load_dwordx4 a[20:23], v10, s[20:23], 0 offen offset:1024 sc1
Mvaa 200,200,72
Ta 236,19,40960
Ta 238,19,41984
Mvaa 232,200,76
v_ashrrev_i32_e64 v61, 31, v61
v_or_b32 v61, 0x80000000, v61
Mvaa 140,204,64
v_xor_b32_e64 v60, v60, v61
v_and_b32 v60, 0xffff0000, v60
Mvaa 172,204,68
Ta 240,20,40960
Ta 242,20,41984
Mvaa 204,204,72
v_mul_f32 v60, 0xbfb8aa3b, v60
Mvaa 236,204,76
VE 60,60
Mvaa 144,208,64
s_waitcnt lgkmcnt(6)
Ta 244,21,40960
Ta 246,21,41984
Mvaa 176,208,68
v_add_f32 v60, 1.0, v60
Mvaa 208,208,72
buffer_load_dwordx4 a[24:27], v11, s[20:23], s58 offen offset:1024 sc1
Mvaa 240,208,76
Ta 248,22,40960
Ta 250,22,41984
Mvaa 148,212,64
v_rcp_f32_e64 v60, v60
Mvaa 180,212,68
Vc 60,60,60
v_and_b32 v64, 0xffff0000, v60
Mvaa 212,212,72
Ta 252,23,40960
Ta 254,23,41984
Mvaa 244,212,76
v_mov_b32 v60, s41
v_not_b32 v61, v60
Mvaa 152,216,64
v_ashrrev_i32_e64 v61, 31, v61
v_or_b32 v61, 0x80000000, v61
Mvaa 184,216,68
v_xor_b32_e64 v60, v60, v61
v_and_b32 v60, 0xffff0000, v60
Mvaa 216,216,72
buffer_load_dwordx4 a[28:31], v11, s[20:23], 0 offen offset:1024 sc1
Mvaa 248,216,76
buffer_store_dwordx4 v[44:47], v2, s[24:27], s59 offen offset:3072 sc1
Mvaa 156,220,64
v_mov_b32 v12, 1
v_and_b32 v1, 15, v0
Mvaa 188,220,68
v_lshlrev_b32_e64 v1, 2, v1
Mvaa 220,220,72
s_lshr_b32 s6, s33, 1
s_lshl_b32 s6, s6, 7
s_add_u32 s6, s6, 5296128
Mvaa 252,220,76
s_cmp_eq_u32 s32, 0
s_cselect_b32 s6, s6, 2146435072
s_waitcnt vmcnt(29) lgkmcnt(0)
s_barrier
Mvaa 128,224,80
v_mul_f32 v60, 0xbfb8aa3b, v60
Mvaa 160,224,84
s_add_u32 m0, s44, 32768
Ta 192,16,49152
Ta 194,16,50176
Mvaa 192,224,88
buffer_load_dwordx4 v8, s[8:11], s48 offen offset:0 lds
Mvaa 224,224,92
Ve 60,60
Mvaa 132,228,80
Ta 196,17,49152
Ta 198,17,50176
Mvaa 164,228,84
buffer_load_dwordx4 v8, s[8:11], s49 offen offset:1024 lds
Mvaa 196,228,88
v_add_f32_e64 v60, 1.0, v60
Mvaa 228,228,92
Ta 200,18,49152
Ta 202,18,50176
Mvaa 136,232,80
v_rcp_f32_e64 v60, v60
Mvaa 168,232,84
buffer_load_dwordx4 v9, s[8:11], s50 offen offset:2048 lds
Mvaa 200,232,88
Ta 204,19,49152
Ta 206,19,50176
Mvaa 232,232,92
Vc 60,60,60
v_and_b32 v65, 0xffff0000, v60
Mvaa 140,236,80
v_mov_b32 v48, 0
v_mov_b32 v49, 0
Mvaa 172,236,84
Ta 208,20,49152
Ta 210,20,50176
Mvaa 204,236,88
buffer_load_dwordx4 v9, s[8:11], s51 offen offset:3072 lds
v_add_u32 v8, 524288, v8
v_add_u32 v9, 524288, v9
Mvaa 236,236,92
v_mov_b32 v50, 0
v_mov_b32 v51, 0
Mvaa 144,240,80
s_waitcnt lgkmcnt(6)
Ta 212,21,49152
Ta 214,21,50176
Mvaa 176,240,84
v_mov_b32 v52, 0
v_mov_b32_e64 v53, 0
Mvaa 208,240,88
buffer_load_dwordx4 a[32:35], v10, s[20:23], s58 offen offset:2048 sc1
Mvaa 240,240,92
Ta 216,22,49152
Ta 218,22,50176
Mvaa 148,244,80
v_mov_b32 v54, 0
v_mov_b32 v55, 0
Mvaa 180,244,84
v_mov_b32 v56, 0
v_mov_b32 v57, 0
Mvaa 212,244,88
Ta 220,23,49152
Ta 222,23,50176
Mvaa 244,244,92
buffer_load_dwordx4 a[36:39], v10, s[20:23], 0 offen offset:2048 sc1
Mvaa 152,248,80
v_mov_b32 v58, 0
v_mov_b32 v59, 0
Mvaa 184,248,84
v_mov_b32 v60, 0
v_mov_b32 v61, 0
Mvaa 216,248,88
buffer_load_dwordx4 a[40:43], v11, s[20:23], s58 offen offset:2048 sc1
Mvaa 248,248,92
v_mov_b32 v62, 0
v_mov_b32 v63, 0
Mvaa 156,252,80
s_mul_i32 s3, s34, s34
s_mul_i32 s47, s33, 48
s_add_u32 s3, s3, s47
Mvaa 188,252,84
buffer_load_dwordx4 a[44:47], v11, s[20:23], 0 offen offset:2048 sc1
Mvaa 220,252,88
s_lshl_b32 s3, s3, 2
s_add_u32 s3, s3, s32
s_lshl_b32 s3, s3, 7
Mvaa 252,252,92
s_sub_u32 s3, s3, 8704
s_cmp_ge_u32 s34, 4
s_cselect_b32 s3, s3, 0
s_cselect_b32 s40, 512, 0
s_cselect_b32 s47, 786432, 0
s_waitcnt vmcnt(28) lgkmcnt(0)
Mvaa 128,192,96
v_subrev_u32 v31, 0, v0
v_mul_lo_u32 v31, v31, s47
Mvaa 160,192,100
Ta 224,16,57344
Ta 226,16,58368
Mvaa 192,192,104
buffer_load_dwordx4 a[48:51], v10, s[20:23], s58 offen offset:3072 sc1
Mvaa 224,192,108
v_min_u32 v31, 6553600, v31
v_mov_b32_e64 v28, s94
Mvaa 132,196,96
Ta 228,17,57344
Ta 230,17,58368
Mvaa 164,196,100
v_mov_b32 v29, s95
v_mov_b32 v30, v31
Mvaa 196,196,104
v_subrev_u32_e64 v31, 10, v0
v_mul_lo_u32 v31, v31, s47
Mvaa 228,196,108
Ta 232,18,57344
Ta 234,18,58368
Mvaa 136,200,96
v_min_u32 v31, 6553600, v31
v_mov_b32_e64 v14, s60
Mvaa 168,200,100
buffer_load_dwordx4 a[52:55], v10, s[20:23], 0 offen offset:3072 sc1
Mvaa 200,200,104
Ta 236,19,57344
Ta 238,19,58368
Mvaa 232,200,108
v_mov_b32_e64 v15, s61
Mvaa 140,204,96
v_cmp_le_u32 vcc, 10, v0
Mvaa 172,204,100
Ta 240,20,57344
Ta 242,20,58368
Mvaa 204,204,104
v_cndmask_b32 v28, v28, v14, vcc
v_cndmask_b32 v29, v29, v15, vcc
Mvaa 236,204,108
v_cndmask_b32 v30, v30, v31, vcc
Mvaa 144,208,96
s_waitcnt lgkmcnt(6)
Ta 244,21,57344
Ta 246,21,58368
Mvaa 176,208,100
v_subrev_u32 v31, 20, v0
v_mul_lo_u32 v31, v31, s47
Mvaa 208,208,104
buffer_load_dwordx4 a[56:59], v11, s[20:23], s58 offen offset:3072 sc1
Mvaa 240,208,108
Ta 248,22,57344
Ta 250,22,58368
Mvaa 148,212,96
v_min_u32 v31, 6553600, v31
v_mov_b32_e64 v14, s68
Mvaa 180,212,100
v_mov_b32_e64 v15, s69
Mvaa 212,212,104
Ta 252,23,57344
Ta 254,23,58368
Mvaa 244,212,108
v_cmp_le_u32 vcc, 20, v0
Mvaa 152,216,96
s_nop 0
v_cndmask_b32 v28, v28, v14, vcc
v_cndmask_b32 v29, v29, v15, vcc
Mvaa 184,216,100
v_cndmask_b32 v30, v30, v31, vcc
Mvaa 216,216,104
buffer_load_dwordx4 a[60:63], v11, s[20:23], 0 offen offset:3072 sc1
v_add_u32 v10, 4096, v10
v_add_u32 v11, 4096, v11
Mvaa 248,216,108
v_subrev_u32 v31, 30, v0
v_mul_lo_u32 v31, v31, s47
Mvaa 156,220,96
v_min_u32 v31, 7602176, v31
v_mov_b32_e64 v14, s92
Mvaa 188,220,100
v_mov_b32_e64 v15, s93
Mvaa 220,220,104
v_cmp_le_u32 vcc, 30, v0
Mvaa 252,220,108
s_nop 0
v_cndmask_b32 v28, v28, v14, vcc
v_cndmask_b32 v29, v29, v15, vcc
s_waitcnt vmcnt(27) lgkmcnt(0)
s_barrier
Mvaa 128,224,112
v_cndmask_b32 v30, v30, v31, vcc
Mvaa 160,224,116
s_add_u32 m0, s44, 49152
Ta 192,16,0
Ta 194,16,1024
Mvaa 192,224,120
buffer_load_dwordx4 v8, s[8:11], s48 offen offset:0 lds
Mvaa 224,224,124
v_add_u32 v30, s3, v30
v_ashrrev_i32_e64 v31, 31, v30
Mvaa 132,228,112
Ta 196,17,0
Ta 198,17,1024
Mvaa 164,228,116
buffer_load_dwordx4 v8, s[8:11], s49 offen offset:1024 lds
Mvaa 196,228,120
v_lshl_add_u64 v[28:29], v[30:31], 0, v[28:29]
Mvaa 228,228,124
Ta 200,18,0
Ta 202,18,1024
Mvaa 136,232,112
s_mov_b32 s41, 0
v_readfirstlane_b32 s100, v64
v_readfirstlane_b32 s101, v65
Mvaa 168,232,116
buffer_load_dwordx4 v9, s[8:11], s50 offen offset:2048 lds
Mvaa 200,232,120
Ta 204,19,0
Ta 206,19,1024
Mvaa 232,232,124
Mvaa 140,236,112
Mvaa 172,236,116
Ta 208,20,0
Ta 210,20,1024
Mvaa 204,236,120
buffer_load_dwordx4 v9, s[8:11], s51 offen offset:3072 lds
v_add_u32 v8, 524288, v8
v_add_u32 v9, 524288, v9
Mvaa 236,236,124
Mvaa 144,240,112
s_waitcnt lgkmcnt(6)
Ta 212,21,0
Ta 214,21,1024
Mvaa 176,240,116
Mvaa 208,240,120
buffer_load_dwordx4 a[64:67], v10, s[20:23], s58 offen offset:0 sc1
Mvaa 240,240,124
Ta 216,22,0
Ta 218,22,1024
Mvaa 148,244,112
Mvaa 180,244,116
Mvaa 212,244,120
Ta 220,23,0
Ta 222,23,1024
Mvaa 244,244,124
buffer_load_dwordx4 a[68:71], v10, s[20:23], 0 offen offset:0 sc1
Mvaa 152,248,112
Mvaa 184,248,116
Mvaa 216,248,120
buffer_load_dwordx4 a[72:75], v11, s[20:23], s58 offen offset:0 sc1
Mvaa 248,248,124
Mvaa 156,252,112
Mvaa 188,252,116
buffer_load_dwordx4 a[76:79], v11, s[20:23], 0 offen offset:0 sc1
Mvaa 220,252,120
Mvaa 252,252,124
s_waitcnt vmcnt(26) lgkmcnt(0)
Mvaa 128,192,0
Mvaa 160,192,4
Ta 224,16,8192
Ta 226,16,9216
Mvaa 192,192,8
buffer_load_dwordx4 a[80:83], v10, s[20:23], s58 offen offset:1024 sc1
Mvaa 224,192,12
Mvaa 132,196,0
Ta 228,17,8192
Ta 230,17,9216
Mvaa 164,196,4
Mvaa 196,196,8
Mvaa 228,196,12
Ta 232,18,8192
Ta 234,18,9216
Mvaa 136,200,0
Mvaa 168,200,4
buffer_load_dwordx4 a[84:87], v10, s[20:23], 0 offen offset:1024 sc1
Mvaa 200,200,8
Ta 236,19,8192
Ta 238,19,9216
Mvaa 232,200,12
Mvaa 140,204,0
Mvaa 172,204,4
Ta 240,20,8192
Ta 242,20,9216
Mvaa 204,204,8
Mvaa 236,204,12
Mvaa 144,208,0
s_waitcnt lgkmcnt(6)
Ta 244,21,8192
Ta 246,21,9216
Mvaa 176,208,4
Mvaa 208,208,8
buffer_load_dwordx4 a[88:91], v11, s[20:23], s58 offen offset:1024 sc1
Mvaa 240,208,12
Ta 248,22,8192
Ta 250,22,9216
Mvaa 148,212,0
Mvaa 180,212,4
Mvaa 212,212,8
Ta 252,23,8192
Ta 254,23,9216
Mvaa 244,212,12
Mvaa 152,216,0
Mvaa 184,216,4
Mvaa 216,216,8
buffer_load_dwordx4 a[92:95], v11, s[20:23], 0 offen offset:1024 sc1
Mvaa 248,216,12
Mvaa 156,220,0
Mvaa 188,220,4
Mvaa 220,220,8
Mvaa 252,220,12
s_waitcnt vmcnt(24) lgkmcnt(0)
s_barrier
Mvaa 128,224,16
s_mov_b64 exec, 1
buffer_store_dword v12, v7, s[20:23], s39 offen sc1
s_mov_b64 exec, -1
Mvaa 160,224,20
Ta 192,16,16384
Ta 194,16,17408
Mvaa 192,224,24
buffer_load_dwordx4 a[96:99], v10, s[20:23], s58 offen offset:2048 sc1
Mvaa 224,224,28
s_mov_b32 s24, s60
s_mov_b32 s25, s61
s_mov_b32 s26, s62
Mvaa 132,228,16
Ta 196,17,16384
Ta 198,17,17408
Mvaa 164,228,20
s_mov_b32 s94, 1040356334
s_mov_b32 s95, 1040356334
s_sub_u32 s55, 15, s34
Mvaa 196,228,24
s_sub_u32 s45, s36, 3
s_sub_u32 s46, s35, 3
s_mov_b32 s54, s44
Mvaa 228,228,28
Ta 200,18,16384
Ta 202,18,17408
Mvaa 136,232,16
s_sub_u32 s35, s35, 2
s_sub_u32 s36, s36, 2
v_accvgpr_write_b32 a0, 0
Mvaa 168,232,20
buffer_load_dwordx4 a[100:103], v10, s[20:23], 0 offen offset:2048 sc1
Mvaa 200,232,24
Ta 204,19,16384
Ta 206,19,17408
Mvaa 232,232,28
v_accvgpr_write_b32 a1, 0
v_accvgpr_write_b32 a2, 0
Mvaa 140,236,16
v_accvgpr_write_b32 a3, 0
v_accvgpr_write_b32 a4, 0
Mvaa 172,236,20
Ta 208,20,16384
Ta 210,20,17408
Mvaa 204,236,24
v_accvgpr_write_b32 a5, 0
v_accvgpr_write_b32 a6, 0
Mvaa 236,236,28
v_accvgpr_write_b32 a7, 0
v_accvgpr_write_b32 a8, 0
Mvaa 144,240,16
s_waitcnt lgkmcnt(6)
Ta 212,21,16384
Ta 214,21,17408
Mvaa 176,240,20
v_accvgpr_write_b32 a9, 0
v_accvgpr_write_b32 a10, 0
Mvaa 208,240,24
buffer_load_dwordx4 a[104:107], v11, s[20:23], s58 offen offset:2048 sc1
Mvaa 240,240,28
Ta 216,22,16384
Ta 218,22,17408
Mvaa 148,244,16
v_accvgpr_write_b32 a11, 0
v_accvgpr_write_b32 a12, 0
Mvaa 180,244,20
v_accvgpr_write_b32 a13, 0
v_accvgpr_write_b32 a14, 0
Mvaa 212,244,24
Ta 220,23,16384
Ta 222,23,17408
Mvaa 244,244,28
v_accvgpr_write_b32 a15, 0
Mvaa 152,248,16
Mvaa 184,248,20
Mvaa 216,248,24
buffer_load_dwordx4 a[108:111], v11, s[20:23], 0 offen offset:2048 sc1
Mvaa 248,248,28
Mvaa 156,252,16
Mvaa 188,252,20
Mvaa 220,252,24
Mvaa 252,252,28
s_waitcnt vmcnt(21) lgkmcnt(0)
Mvaa 128,192,32
v_accvgpr_write_b32 a16, 0
v_accvgpr_write_b32 a17, 0
Mvaa 160,192,36
Ta 224,16,24576
Ta 226,16,25600
Mvaa 192,192,40
buffer_load_dwordx4 a[112:115], v10, s[20:23], s58 offen offset:3072 sc1
Mvaa 224,192,44
v_accvgpr_write_b32 a18, 0
v_accvgpr_write_b32 a19, 0
Mvaa 132,196,32
Ta 228,17,24576
Ta 230,17,25600
Mvaa 164,196,36
v_accvgpr_write_b32 a20, 0
v_accvgpr_write_b32 a21, 0
Mvaa 196,196,40
v_accvgpr_write_b32 a22, 0
v_accvgpr_write_b32 a23, 0
Mvaa 228,196,44
Ta 232,18,24576
Ta 234,18,25600
Mvaa 136,200,32
v_accvgpr_write_b32 a24, 0
v_accvgpr_write_b32 a25, 0
Mvaa 168,200,36
buffer_load_dwordx4 a[116:119], v10, s[20:23], 0 offen offset:3072 sc1
Mvaa 200,200,40
Ta 236,19,24576
Ta 238,19,25600
Mvaa 232,200,44
v_accvgpr_write_b32 a26, 0
v_accvgpr_write_b32 a27, 0
Mvaa 140,204,32
v_accvgpr_write_b32 a28, 0
v_accvgpr_write_b32 a29, 0
Mvaa 172,204,36
Ta 240,20,24576
Ta 242,20,25600
Mvaa 204,204,40
v_accvgpr_write_b32 a30, 0
v_accvgpr_write_b32 a31, 0
Mvaa 236,204,44
Mvaa 144,208,32
s_waitcnt lgkmcnt(6)
Ta 244,21,24576
Ta 246,21,25600
Mvaa 176,208,36
Mvaa 208,208,40
buffer_load_dwordx4 a[120:123], v11, s[20:23], s58 offen offset:3072 sc1
Mvaa 240,208,44
Ta 248,22,24576
Ta 250,22,25600
Mvaa 148,212,32
Mvaa 180,212,36
Mvaa 212,212,40
Ta 252,23,24576
Ta 254,23,25600
Mvaa 244,212,44
Mvaa 152,216,32
Mvaa 184,216,36
Mvaa 216,216,40
buffer_load_dwordx4 a[124:127], v11, s[20:23], 0 offen offset:3072 sc1
v_add_u32 v10, 4096, v10
v_add_u32 v11, 4096, v11
Mvaa 248,216,44
Mvaa 156,220,32
Mvaa 188,220,36
Mvaa 220,220,40
Mvaa 252,220,44
s_waitcnt vmcnt(21) lgkmcnt(0)
s_barrier
Mvaa 128,224,48
v_accvgpr_write_b32 a32, 0
v_accvgpr_write_b32 a33, 0
Mvaa 160,224,52
Ta 192,16,32768
Ta 194,16,33792
Mvaa 192,224,56
v_accvgpr_write_b32 a34, 0
v_accvgpr_write_b32 a35, 0
Mvaa 224,224,60
v_accvgpr_write_b32 a36, 0
v_accvgpr_write_b32 a37, 0
Mvaa 132,228,48
Ta 196,17,32768
Ta 198,17,33792
Mvaa 164,228,52
v_accvgpr_write_b32 a38, 0
v_accvgpr_write_b32 a39, 0
Mvaa 196,228,56
v_accvgpr_write_b32 a40, 0
v_accvgpr_write_b32 a41, 0
Mvaa 228,228,60
Ta 200,18,32768
Ta 202,18,33792
Mvaa 136,232,48
v_accvgpr_write_b32 a42, 0
v_accvgpr_write_b32 a43, 0
Mvaa 168,232,52
v_accvgpr_write_b32 a44, 0
v_accvgpr_write_b32 a45, 0
Mvaa 200,232,56
Ta 204,19,32768
Ta 206,19,33792
Mvaa 232,232,60
buffer_load_dword v12, v1, s[20:23], s6 offen sc1
Mvaa 140,236,48
s_add_u32 m0, s44, 65536
s_mov_b32 s7, 0
Mvaa 172,236,52
Ta 208,20,32768
Ta 210,20,33792
Mvaa 204,236,56
v_accvgpr_write_b32 a46, 0
v_accvgpr_write_b32 a47, 0
Mvaa 236,236,60
Mvaa 144,240,48
s_waitcnt lgkmcnt(6)
Ta 212,21,32768
Ta 214,21,33792
Mvaa 176,240,52
Mvaa 208,240,56
Mvaa 240,240,60
Ta 216,22,32768
Ta 218,22,33792
Mvaa 148,244,48
Mvaa 180,244,52
Mvaa 212,244,56
Ta 220,23,32768
Ta 222,23,33792
Mvaa 244,244,60
Mvaa 152,248,48
Mvaa 184,248,52
Mvaa 216,248,56
Mvaa 248,248,60
Mvaa 156,252,48
Mvaa 188,252,52
Mvaa 220,252,56
Mvaa 252,252,60
s_waitcnt vmcnt(14) lgkmcnt(0)
Mvaa 128,192,64
v_accvgpr_write_b32 a48, 0
v_accvgpr_write_b32 a49, 0
Mvaa 160,192,68
Ta 224,16,40960
Ta 226,16,41984
Mvaa 192,192,72
v_accvgpr_write_b32 a50, 0
v_accvgpr_write_b32 a51, 0
Mvaa 224,192,76
v_accvgpr_write_b32 a52, 0
v_accvgpr_write_b32 a53, 0
Mvaa 132,196,64
Ta 228,17,40960
Ta 230,17,41984
Mvaa 164,196,68
v_accvgpr_write_b32 a54, 0
v_accvgpr_write_b32 a55, 0
Mvaa 196,196,72
v_accvgpr_write_b32 a56, 0
v_accvgpr_write_b32 a57, 0
Mvaa 228,196,76
Ta 232,18,40960
Ta 234,18,41984
Mvaa 136,200,64
v_accvgpr_write_b32 a58, 0
v_accvgpr_write_b32 a59, 0
Mvaa 168,200,68
v_accvgpr_write_b32 a60, 0
v_accvgpr_write_b32 a61, 0
Mvaa 200,200,72
Ta 236,19,40960
Ta 238,19,41984
Mvaa 232,200,76
v_accvgpr_write_b32 a62, 0
v_accvgpr_write_b32 a63, 0
Mvaa 140,204,64
Mvaa 172,204,68
Ta 240,20,40960
Ta 242,20,41984
Mvaa 204,204,72
Mvaa 236,204,76
Mvaa 144,208,64
s_waitcnt lgkmcnt(6)
Ta 244,21,40960
Ta 246,21,41984
Mvaa 176,208,68
Mvaa 208,208,72
Mvaa 240,208,76
Ta 248,22,40960
Ta 250,22,41984
Mvaa 148,212,64
Mvaa 180,212,68
Mvaa 212,212,72
Ta 252,23,40960
Ta 254,23,41984
Mvaa 244,212,76
Mvaa 152,216,64
Mvaa 184,216,68
Mvaa 216,216,72
Mvaa 248,216,76
Mvaa 156,220,64
Mvaa 188,220,68
Mvaa 220,220,72
Mvaa 252,220,76
s_waitcnt vmcnt(0) lgkmcnt(0)
s_cmp_lg_u32 s32, 0
s_cbranch_scc1 L_spinBr
v_cmp_ne_u32 vcc, 1, v12
s_cbranch_vccnz L_spinB
L_spinBr:
s_barrier
Mvaa 128,224,80
buffer_load_dwordx4 v4, s[12:15], s7 offen offset:0 sc1 lds
Mvaa 160,224,84
Ta 192,16,49152
Ta 194,16,50176
Mvaa 192,224,88
v_accvgpr_write_b32 a64, 0
v_accvgpr_write_b32 a65, 0
Mvaa 224,224,92
buffer_load_dwordx4 v4, s[12:15], s7 offen offset:1024 sc1 lds
Mvaa 132,228,80
Ta 196,17,49152
Ta 198,17,50176
Mvaa 164,228,84
v_accvgpr_write_b32 a66, 0
v_accvgpr_write_b32 a67, 0
Mvaa 196,228,88
buffer_load_dwordx4 v4, s[12:15], s7 offen offset:2048 sc1 lds
Mvaa 228,228,92
Ta 200,18,49152
Ta 202,18,50176
Mvaa 136,232,80
v_accvgpr_write_b32 a68, 0
v_accvgpr_write_b32 a69, 0
Mvaa 168,232,84
buffer_load_dwordx4 v4, s[12:15], s7 offen offset:3072 sc1 lds
Mvaa 200,232,88
Ta 204,19,49152
Ta 206,19,50176
Mvaa 232,232,92
s_add_u32 m0, s44, 98304
s_mov_b32 s7, 34816
Mvaa 140,236,80
buffer_load_dwordx4 v4, s[12:15], s7 offen offset:0 sc1 lds
Mvaa 172,236,84
Ta 208,20,49152
Ta 210,20,50176
Mvaa 204,236,88
v_accvgpr_write_b32 a70, 0
v_accvgpr_write_b32 a71, 0
Mvaa 236,236,92
buffer_load_dwordx4 v4, s[12:15], s7 offen offset:1024 sc1 lds
Mvaa 144,240,80
s_waitcnt lgkmcnt(6)
Ta 212,21,49152
Ta 214,21,50176
Mvaa 176,240,84
v_accvgpr_write_b32 a72, 0
v_accvgpr_write_b32 a73, 0
Mvaa 208,240,88
buffer_load_dwordx4 v4, s[12:15], s7 offen offset:2048 sc1 lds
Mvaa 240,240,92
Ta 216,22,49152
Ta 218,22,50176
Mvaa 148,244,80
v_accvgpr_write_b32 a74, 0
v_accvgpr_write_b32 a75, 0
Mvaa 180,244,84
buffer_load_dwordx4 v4, s[12:15], s7 offen offset:3072 sc1 lds
Mvaa 212,244,88
Ta 220,23,49152
Ta 222,23,50176
Mvaa 244,244,92
s_add_u32 m0, s44, 81920
s_mov_b32 s7, 17408
Mvaa 152,248,80
buffer_load_dwordx4 v4, s[12:15], s7 offen offset:0 sc1 lds
Mvaa 184,248,84
v_accvgpr_write_b32 a76, 0
v_accvgpr_write_b32 a77, 0
Mvaa 216,248,88
buffer_load_dwordx4 v4, s[12:15], s7 offen offset:1024 sc1 lds
Mvaa 248,248,92
v_accvgpr_write_b32 a78, 0
v_accvgpr_write_b32 a79, 0
Mvaa 156,252,80
Mvaa 188,252,84
buffer_load_dwordx4 v4, s[12:15], s7 offen offset:2048 sc1 lds
Mvaa 220,252,88
Mvaa 252,252,92
s_waitcnt lgkmcnt(0)
Mvaa 128,192,96
buffer_load_dwordx4 v4, s[12:15], s7 offen offset:3072 sc1 lds
Mvaa 160,192,100
Ta 224,16,57344
Ta 226,16,58368
Mvaa 192,192,104
s_add_u32 m0, s44, 114688
s_mov_b32 s7, 52224
Mvaa 224,192,108
buffer_load_dwordx4 v4, s[12:15], s7 offen offset:0 sc1 lds
Mvaa 132,196,96
Ta 228,17,57344
Ta 230,17,58368
Mvaa 164,196,100
v_accvgpr_write_b32 a80, 0
v_accvgpr_write_b32 a81, 0
Mvaa 196,196,104
buffer_load_dwordx4 v4, s[12:15], s7 offen offset:1024 sc1 lds
Mvaa 228,196,108
Ta 232,18,57344
Ta 234,18,58368
Mvaa 136,200,96
v_accvgpr_write_b32 a82, 0
v_accvgpr_write_b32 a83, 0
Mvaa 168,200,100
buffer_load_dwordx4 v4, s[12:15], s7 offen offset:2048 sc1 lds
Mvaa 200,200,104
Ta 236,19,57344
Ta 238,19,58368
Mvaa 232,200,108
v_accvgpr_write_b32 a84, 0
v_accvgpr_write_b32 a85, 0
Mvaa 140,204,96
buffer_load_dwordx4 v4, s[12:15], s7 offen offset:3072 sc1 lds
Mvaa 172,204,100
Ta 240,20,57344
Ta 242,20,58368
Mvaa 204,204,104
s_add_u32 m0, s44, 0
s_mov_b32 s7, 69632
Mvaa 236,204,108
buffer_load_dwordx4 v4, s[12:15], s7 offen offset:0 sc1 lds
Mvaa 144,208,96
s_waitcnt lgkmcnt(6)
Ta 244,21,57344
Ta 246,21,58368
Mvaa 176,208,100
buffer_load_dwordx4 v4, s[12:15], s7 offen offset:1024 sc1 lds
Mvaa 208,208,104
v_accvgpr_write_b32 a86, 0
v_accvgpr_write_b32 a87, 0
Mvaa 240,208,108
Ta 248,22,57344
Ta 250,22,58368
Mvaa 148,212,96
buffer_load_dwordx4 v4, s[12:15], s7 offen offset:2048 sc1 lds
Mvaa 180,212,100
v_accvgpr_write_b32 a88, 0
v_accvgpr_write_b32 a89, 0
Mvaa 212,212,104
Ta 252,23,57344
Ta 254,23,58368
Mvaa 244,212,108
buffer_load_dwordx4 v4, s[12:15], s7 offen offset:3072 sc1 lds
Mvaa 152,216,96
s_add_u32 m0, s44, 16384
s_mov_b32 s7, 87040
Mvaa 184,216,100
v_accvgpr_write_b32 a90, 0
v_accvgpr_write_b32 a91, 0
Mvaa 216,216,104
buffer_load_dwordx4 v4, s[12:15], s7 offen offset:0 sc1 lds
Mvaa 248,216,108
v_accvgpr_write_b32 a92, 0
v_accvgpr_write_b32 a93, 0
Mvaa 156,220,96
v_accvgpr_write_b32 a94, 0
v_accvgpr_write_b32 a95, 0
Mvaa 188,220,100
buffer_load_dwordx4 v4, s[12:15], s7 offen offset:1024 sc1 lds
Mvaa 220,220,104
Mvaa 252,220,108
s_waitcnt vmcnt(18) lgkmcnt(0)
s_barrier
Mvaa 128,224,112
buffer_load_dwordx4 v4, s[12:15], s7 offen offset:2048 sc1 lds
Mvaa 132,228,112
Ra 192,3,0
Ra 196,3,1024
Mvaa 136,232,112
Ra 200,3,2048
Ra 204,3,3072
Mvaa 140,236,112
buffer_load_dwordx4 v4, s[12:15], s7 offen offset:3072 sc1 lds
Mvaa 144,240,112
s_add_u32 m0, s44, 32768
s_mov_b32 s7, 104448
Mvaa 148,244,112
Ra 208,3,4096
Ra 212,3,5120
Mvaa 152,248,112
buffer_load_dwordx4 v4, s[12:15], s7 offen offset:0 sc1 lds
Mvaa 156,252,112
Ra 216,3,6144
Ra 220,3,7168
Mvaa 160,224,116
buffer_load_dwordx4 v4, s[12:15], s7 offen offset:1024 sc1 lds
Mvaa 164,228,116
Mvaa 168,232,116
Mvaa 172,236,116
buffer_load_dwordx4 v4, s[12:15], s7 offen offset:2048 sc1 lds
Mvaa 176,240,116
v_mul_f32 v128, s94, v128
v_mul_f32 v129, s94, v129
Mvaa 180,244,116
v_mul_f32 v130, s94, v130
v_mul_f32 v131, s94, v131
Mvaa 184,248,116
buffer_load_dwordx4 v4, s[12:15], s7 offen offset:3072 sc1 lds
Mvaa 188,252,116
v_mul_f32 v132, s94, v132
v_mul_f32 v133, s94, v133
Mvaa 192,224,120
v_mul_f32 v134, s94, v134
v_mul_f32 v135, s94, v135
Mvaa 196,228,120
Vc 128,128,129
Vc 129,130,131
Mvaa 200,232,120
Vc 130,132,133
Vc 131,134,135
Mvaa 204,236,120
Aw 128,128
Aw 129,129
Mvaa 208,240,120
Aw 130,130
Aw 131,131
Mvaa 212,244,120
v_mul_f32 v136, s94, v136
v_mul_f32 v137, s94, v137
Mvaa 216,248,120
v_mul_f32 v138, s94, v138
v_mul_f32 v139, s94, v139
Mvaa 220,252,120
v_mul_f32 v140, s94, v140
v_mul_f32 v141, s94, v141
Mvaa 224,224,124
v_mul_f32 v142, s94, v142
v_mul_f32 v143, s94, v143
Mvaa 228,228,124
Vc 136,136,137
Vc 137,138,139
Mvaa 232,232,124
Vc 138,140,141
Vc 139,142,143
Mvaa 236,236,124
Aw 132,136
Aw 133,137
Mvaa 240,240,124
Aw 134,138
Aw 135,139
Mvaa 244,244,124
v_mul_f32 v144, s94, v144
v_mul_f32 v145, s94, v145
Mvaa 248,248,124
v_mul_f32 v146, s94, v146
v_mul_f32 v147, s94, v147
Mvaa 252,252,124
v_mul_f32 v148, s94, v148
v_mul_f32 v149, s94, v149
Ra 224,3,8192
Ra 228,3,9216
Ra 232,3,10240
Ra 236,3,11264
Ra 240,3,12288
Ra 244,3,13312
Ra 248,3,14336
s_waitcnt lgkmcnt(9)
Ra 252,3,15360
v_mul_f32 v150, s94, v150
v_mul_f32_e64 v151, s94, v151
Vc 144,144,145
Vc 145,146,147
Vc 146,148,149
Vc 147,150,151
Aw 136,144
Aw 137,145
Aw 138,146
Aw 139,147
v_mul_f32 v152, s94, v152
v_mul_f32 v153, s94, v153
v_mul_f32 v154, s94, v154
v_mul_f32 v155, s94, v155
v_mul_f32 v156, s94, v156
v_mul_f32 v157, s94, v157
v_mul_f32 v158, s94, v158
v_mul_f32 v159, s94, v159
Vc 152,152,153
Vc 153,154,155
Vc 154,156,157
Vc 155,158,159
Aw 140,152
Aw 141,153
Aw 142,154
Aw 143,155
Zvaa 128,192,128
v_mul_f32 v160, s94, v160
v_mul_f32 v161, s94, v161
v_mul_f32 v162, s94, v162
v_mul_f32 v163, s94, v163
Mvaa 128,196,132
v_mul_f32 v164, s94, v164
v_mul_f32 v165, s94, v165
v_mul_f32 v166, s94, v166
v_mul_f32 v167, s94, v167
Mvaa 128,200,136
Vc 160,160,161
Vc 161,162,163
Vc 162,164,165
Vc 163,166,167
Mvaa 128,204,140
Aw 144,160
Aw 145,161
Aw 146,162
Aw 147,163
s_waitcnt lgkmcnt(8)
Zvaa 132,208,128
v_mul_f32 v168, s94, v168
v_mul_f32 v169, s94, v169
v_mul_f32 v170, s94, v170
v_mul_f32_e64 v171, s94, v171
Mvaa 132,212,132
v_mul_f32 v172, s94, v172
v_mul_f32 v173, s94, v173
v_mul_f32 v174, s94, v174
v_mul_f32 v175, s94, v175
Mvaa 132,216,136
Vc 168,168,169
Vc 169,170,171
Vc 170,172,173
Vc 171,174,175
Mvaa 132,220,140
Aw 148,168
Aw 149,169
Aw 150,170
Aw 151,171
s_waitcnt lgkmcnt(4)
Zvaa 136,224,128
v_mul_f32 v176, s94, v176
v_mul_f32 v177, s94, v177
v_mul_f32 v178, s94, v178
v_mul_f32_e64 v179, s94, v179
Mvaa 136,228,132
v_mul_f32 v180, s94, v180
v_mul_f32 v181, s94, v181
v_mul_f32 v182, s94, v182
v_mul_f32 v183, s94, v183
Mvaa 136,232,136
Vc 176,176,177
Vc 177,178,179
Vc 178,180,181
Vc 179,182,183
Mvaa 136,236,140
Aw 152,176
Aw 153,177
Aw 154,178
Aw 155,179
s_waitcnt lgkmcnt(0)
Zvaa 140,240,128
v_mul_f32 v184, s94, v184
v_mul_f32 v185, s94, v185
v_mul_f32 v186, s94, v186
v_mul_f32_e64 v187, s94, v187
Mvaa 140,244,132
v_mul_f32 v188, s94, v188
v_mul_f32 v189, s94, v189
v_mul_f32 v190, s94, v190
v_mul_f32 v191, s94, v191
Mvaa 140,248,136
Vc 184,184,185
Vc 185,186,187
Vc 186,188,189
Vc 187,190,191
Mvaa 140,252,140
Aw 156,184
Aw 157,185
Aw 158,186
Aw 159,187
Zvaa 144,192,144
v_mul_f32 v192, s94, v192
v_mul_f32 v193, s94, v193
v_mul_f32 v194, s94, v194
v_mul_f32 v195, s94, v195
Mvaa 144,196,148
v_mul_f32 v196, s94, v196
v_mul_f32 v197, s94, v197
v_mul_f32 v198, s94, v198
v_mul_f32 v199, s94, v199
Mvaa 144,200,152
Vc 192,192,193
Vc 193,194,195
Vc 194,196,197
Vc 195,198,199
Mvaa 144,204,156
Aw 160,192
Aw 161,193
Aw 162,194
Aw 163,195
Zvaa 148,208,144
v_mul_f32 v200, s94, v200
v_mul_f32 v201, s94, v201
v_mul_f32 v202, s94, v202
v_mul_f32 v203, s94, v203
Mvaa 148,212,148
v_mul_f32 v204, s94, v204
v_mul_f32 v205, s94, v205
v_mul_f32 v206, s94, v206
v_mul_f32 v207, s94, v207
Mvaa 148,216,152
Vc 200,200,201
Vc 201,202,203
Vc 202,204,205
Vc 203,206,207
Mvaa 148,220,156
Aw 164,200
Aw 165,201
Aw 166,202
Aw 167,203
Zvaa 152,224,144
v_mul_f32 v208, s94, v208
v_mul_f32 v209, s94, v209
v_mul_f32 v210, s94, v210
v_mul_f32 v211, s94, v211
Mvaa 152,228,148
v_mul_f32 v212, s94, v212
v_mul_f32 v213, s94, v213
v_mul_f32 v214, s94, v214
v_mul_f32 v215, s94, v215
Mvaa 152,232,152
Vc 208,208,209
Vc 209,210,211
Vc 210,212,213
Vc 211,214,215
Mvaa 152,236,156
Aw 168,208
Aw 169,209
Aw 170,210
Aw 171,211
Zvaa 156,240,144
v_mul_f32 v216, s94, v216
v_mul_f32 v217, s94, v217
v_mul_f32 v218, s94, v218
v_mul_f32 v219, s94, v219
Mvaa 156,244,148
v_mul_f32 v220, s94, v220
v_mul_f32 v221, s94, v221
v_mul_f32 v222, s94, v222
v_mul_f32 v223, s94, v223
Mvaa 156,248,152
Vc 216,216,217
Vc 217,218,219
Vc 218,220,221
Vc 219,222,223
Mvaa 156,252,156
Aw 172,216
Aw 173,217
Aw 174,218
Aw 175,219
Zvaa 160,192,160
v_mul_f32 v224, s94, v224
v_mul_f32 v225, s94, v225
v_mul_f32 v226, s94, v226
v_mul_f32 v227, s94, v227
Mvaa 160,196,164
v_mul_f32 v228, s94, v228
v_mul_f32 v229, s94, v229
v_mul_f32 v230, s94, v230
v_mul_f32 v231, s94, v231
Mvaa 160,200,168
Vc 224,224,225
Vc 225,226,227
Vc 226,228,229
Vc 227,230,231
Mvaa 160,204,172
Aw 176,224
Aw 177,225
Aw 178,226
Aw 179,227
Zvaa 164,208,160
v_mul_f32 v232, s94, v232
v_mul_f32 v233, s94, v233
v_mul_f32 v234, s94, v234
v_mul_f32 v235, s94, v235
Mvaa 164,212,164
v_mul_f32 v236, s94, v236
v_mul_f32 v237, s94, v237
v_mul_f32 v238, s94, v238
v_mul_f32 v239, s94, v239
Mvaa 164,216,168
Vc 232,232,233
Vc 233,234,235
Vc 234,236,237
Vc 235,238,239
Mvaa 164,220,172
Aw 180,232
Aw 181,233
Aw 182,234
Aw 183,235
Zvaa 168,224,160
v_mul_f32 v240, s94, v240
v_mul_f32 v241, s94, v241
v_mul_f32 v242, s94, v242
v_mul_f32 v243, s94, v243
Mvaa 168,228,164
v_mul_f32 v244, s94, v244
v_mul_f32 v245, s94, v245
v_mul_f32 v246, s94, v246
v_mul_f32 v247, s94, v247
Mvaa 168,232,168
Vc 240,240,241
Vc 241,242,243
Vc 242,244,245
Vc 243,246,247
Mvaa 168,236,172
Aw 184,240
Aw 185,241
Aw 186,242
Aw 187,243
Zvaa 172,240,160
v_mul_f32 v248, s94, v248
v_mul_f32 v249, s94, v249
v_mul_f32 v250, s94, v250
v_mul_f32 v251, s94, v251
Mvaa 172,244,164
v_mul_f32 v252, s94, v252
v_mul_f32 v253, s94, v253
v_mul_f32 v254, s94, v254
v_mul_f32 v255, s94, v255
Mvaa 172,248,168
Vc 248,248,249
Vc 249,250,251
Vc 250,252,253
Vc 251,254,255
Mvaa 172,252,172
Aw 188,248
Aw 189,249
Aw 190,250
Aw 191,251
Zvaa 176,192,176
v_accvgpr_write_b32 a96, 0
v_accvgpr_write_b32 a97, 0
v_accvgpr_write_b32 a98, 0
v_accvgpr_write_b32 a99, 0
Mvaa 176,196,180
v_accvgpr_write_b32 a100, 0
v_accvgpr_write_b32 a101, 0
v_accvgpr_write_b32 a102, 0
v_accvgpr_write_b32 a103, 0
Mvaa 176,200,184
v_accvgpr_write_b32 a104, 0
v_accvgpr_write_b32 a105, 0
v_accvgpr_write_b32 a106, 0
v_accvgpr_write_b32 a107, 0
Mvaa 176,204,188
v_accvgpr_write_b32 a108, 0
v_accvgpr_write_b32 a109, 0
v_accvgpr_write_b32 a110, 0
v_accvgpr_write_b32 a111, 0
Zvaa 180,208,176
v_accvgpr_write_b32 a112, 0
v_accvgpr_write_b32 a113, 0
v_accvgpr_write_b32 a114, 0
v_accvgpr_write_b32 a115, 0
Mvaa 180,212,180
v_accvgpr_write_b32 a116, 0
v_accvgpr_write_b32 a117, 0
v_accvgpr_write_b32 a118, 0
v_accvgpr_write_b32 a119, 0
Mvaa 180,216,184
v_accvgpr_write_b32 a120, 0
v_accvgpr_write_b32 a121, 0
v_accvgpr_write_b32 a122, 0
v_accvgpr_write_b32 a123, 0
Mvaa 180,220,188
v_accvgpr_write_b32 a124, 0
v_accvgpr_write_b32 a125, 0
v_accvgpr_write_b32 a126, 0
v_accvgpr_write_b32 a127, 0
s_waitcnt vmcnt(16)
s_barrier
s_add_u32 s53, s44, 65536
Zvaa 184,224,176
Ra 192,3,32768
v_mov_b32 v16, 0x3f803f80
v_mov_b32 v17, 0x3f803f80
v_mov_b32 v18, 0x3f803f80
v_mov_b32 v19, 0x3f803f80
Mvaa 184,228,180
Ra 196,3,33792
v_mov_b32 v20, 0xff800000
v_max3_f32 v22, v128, v129, v130
v_max3_f32 v22, v22, v131, v132
v_max3_f32 v22, v22, v133, v134
Mvaa 184,232,184
Ra 200,3,34816
v_max3_f32 v22, v22, v135, v136
v_max3_f32 v22, v22, v137, v138
v_max3_f32 v22, v22, v139, v140
v_max3_f32 v22, v22, v141, v142
Mvaa 184,236,188
Ra 204,3,35840
v_max_f32 v22, v22, v143
v_mov_b32 v1, v22
s_nop 1
v_permlane16_swap_b32 v1, v22
v_max_f32_e64 v22, v22, v1
Zvaa 188,240,176
Ra 208,3,36864
v_mov_b32 v1, v22
s_nop 1
v_permlane32_swap_b32 v1, v22
v_max_f32 v22, v22, v1
v_add_f32 v22, 0x41f80000, v22
Mvaa 188,244,180
Ra 212,3,37888
Vs 128,128,22
Vs 129,129,22
Vs 130,130,22
Vs 131,131,22
Mvaa 188,248,184
Ra 216,3,38912
Vs 132,132,22
Vs 133,133,22
Vs 134,134,22
Vs 135,135,22
Mvaa 188,252,188
Ra 220,3,39936
Vs 136,136,22
Vs 137,137,22
Vs 138,138,22
Vs 139,139,22
Vs 140,140,22
Vs 141,141,22
Vs 142,142,22
Vs 143,143,22
v_sub_f32 v32, 0, v22
v_sub_f32 v33, 0, v22
v_sub_f32 v34, 0, v22
v_sub_f32 v35, 0, v22
v_max3_f32 v22, v144, v145, v146
v_max3_f32 v22, v22, v147, v148
v_max3_f32 v22, v22, v149, v150
v_max3_f32 v22, v22, v151, v152
v_max3_f32 v22, v22, v153, v154
v_max3_f32 v22, v22, v155, v156
v_max3_f32 v22, v22, v157, v158
v_max_f32 v22, v22, v159
v_mov_b32 v1, v22
s_nop 1
v_permlane16_swap_b32 v1, v22
v_max_f32 v22, v22, v1
v_mov_b32 v1, v22
s_nop 1
v_permlane32_swap_b32 v1, v22
v_max_f32_e64 v22, v22, v1
v_add_f32 v22, 0x41f80000, v22
Vs 144,144,22
Vs 145,145,22
Vs 146,146,22
Vs 147,147,22
Vs 148,148,22
Vs 149,149,22
Vs 150,150,22
Vs 151,151,22
Vs 152,152,22
Vs 153,153,22
Vs 154,154,22
Vs 155,155,22
Vs 156,156,22
Vs 157,157,22
Vs 158,158,22
Vs 159,159,22
v_sub_f32 v36, 0, v22
v_sub_f32 v37, 0, v22
v_sub_f32 v38, 0, v22
v_sub_f32 v39, 0, v22
s_mov_b32 s38, 139264
s_mov_b32 s39, 121856
s_cmp_lg_u32 s34, 0
s_cbranch_scc1 L_k2_nomask0
v_cmp_gt_i32 s[56:57], 0, v5
v_cmp_gt_i32 s[58:59], 1, v5
v_cmp_gt_i32 s[60:61], 2, v5
v_cmp_gt_i32 s[62:63], 3, v5
s_nop 3
s_nop 0
v_cndmask_b32 v176, v176, v20, s[56:57]
v_cndmask_b32 v177, v177, v20, s[58:59]
v_cndmask_b32 v178, v178, v20, s[60:61]
v_cndmask_b32 v179, v179, v20, s[62:63]
v_cmp_gt_i32 s[56:57], 16, v5
v_cmp_gt_i32 s[58:59], 17, v5
v_cmp_gt_i32 s[60:61], 18, v5
v_cmp_gt_i32 s[62:63], 19, v5
v_cndmask_b32 v180, v180, v20, s[56:57]
v_cndmask_b32 v181, v181, v20, s[58:59]
v_cndmask_b32 v182, v182, v20, s[60:61]
v_cndmask_b32 v183, v183, v20, s[62:63]
v_cmp_gt_i32 s[56:57], 32, v5
v_cmp_gt_i32 s[58:59], 33, v5
v_cmp_gt_i32 s[60:61], 34, v5
v_cmp_gt_i32 s[62:63], 35, v5
v_cndmask_b32 v184, v184, v20, s[56:57]
v_cndmask_b32 v185, v185, v20, s[58:59]
v_cndmask_b32 v186, v186, v20, s[60:61]
v_cndmask_b32 v187, v187, v20, s[62:63]
v_cmp_gt_i32 s[56:57], 48, v5
v_cmp_gt_i32 s[58:59], 49, v5
v_cmp_gt_i32 s[60:61], 50, v5
v_cmp_gt_i32 s[62:63], 51, v5
v_cndmask_b32 v188, v188, v20, s[56:57]
v_cndmask_b32 v189, v189, v20, s[58:59]
v_cndmask_b32 v190, v190, v20, s[60:61]
v_cndmask_b32 v191, v191, v20, s[62:63]
L_k2_nomask0:
s_mov_b32 s37, 0
s_nop 0
v_max3_f32 v22, v160, v161, v162
v_max3_f32 v22, v22, v163, v164
v_max3_f32 v22, v22, v165, v166
v_max3_f32 v22, v22, v167, v168
v_max3_f32 v22, v22, v169, v170
v_max3_f32 v22, v22, v171, v172
v_max3_f32 v22, v22, v173, v174
v_max_f32 v22, v22, v175
v_mov_b32 v1, v22
s_nop 1
v_permlane16_swap_b32 v1, v22
v_max_f32 v22, v22, v1
v_mov_b32 v1, v22
s_nop 1
v_permlane32_swap_b32 v1, v22
v_max_f32_e64 v22, v22, v1
v_add_f32 v22, 0x41f80000, v22
Vs 160,160,22
Vs 161,161,22
Vs 162,162,22
Vs 163,163,22
Vs 164,164,22
Vs 165,165,22
Vs 166,166,22
Vs 167,167,22
Vs 168,168,22
Vs 169,169,22
Vs 170,170,22
Vs 171,171,22
Vs 172,172,22
Vs 173,173,22
Vs 174,174,22
Vs 175,175,22
v_sub_f32 v40, 0, v22
v_sub_f32 v41, 0, v22
v_sub_f32 v42, 0, v22
v_sub_f32 v43, 0, v22
v_max3_f32 v22, v176, v177, v178
v_max3_f32 v22, v22, v179, v180
v_max3_f32 v22, v22, v181, v182
v_max3_f32 v22, v22, v183, v184
v_max3_f32 v22, v22, v185, v186
v_max3_f32 v22, v22, v187, v188
v_max3_f32 v22, v22, v189, v190
v_max_f32 v22, v22, v191
v_mov_b32 v1, v22
s_nop 1
v_permlane16_swap_b32 v1, v22
v_max_f32 v22, v22, v1
v_mov_b32 v1, v22
s_nop 1
v_permlane32_swap_b32 v1, v22
v_max_f32_e64 v22, v22, v1
v_add_f32 v22, 0x41f80000, v22
Vs 176,176,22
Vs 177,177,22
Vs 178,178,22
Vs 179,179,22
Vs 180,180,22
Vs 181,181,22
Vs 182,182,22
Vs 183,183,22
Vs 184,184,22
Vs 185,185,22
Vs 186,186,22
Vs 187,187,22
Vs 188,188,22
Vs 189,189,22
Vs 190,190,22
Vs 191,191,22
v_sub_f32 v44, 0, v22
v_sub_f32 v45, 0, v22
v_sub_f32 v46, 0, v22
v_sub_f32 v47, 0, v22
Ve 8,128
Ve 9,129
Ve 10,130
Ve 11,131
Vc 64,8,9
Ve 12,144
Ve 13,145
Vc 65,10,11
Ve 14,146
Ve 15,147
Vc 72,12,13
Ve 8,160
Ve 9,161
Vc 73,14,15
Ve 10,162
Ve 11,163
Vc 80,8,9
Ve 12,176
Ve 13,177
Vc 81,10,11
Ve 14,178
Ve 15,179
Vc 88,12,13
Ve 8,132
Ve 9,133
Vc 89,14,15
Ve 10,134
Ve 11,135
Vc 66,8,9
Ve 12,148
Ve 13,149
Vc 67,10,11
Ve 14,150
Ve 15,151
Vc 74,12,13
Ve 8,164
Ve 9,165
Vc 75,14,15
Ve 10,166
Ve 11,167
Vc 82,8,9
Ve 12,180
Ve 13,181
Vc 83,10,11
Ve 14,182
Ve 15,183
Vc 90,12,13
Vc 91,14,15
v_or_b32_e64 v7, v64, v65
v_or3_b32 v7, v7, v72, v73
v_or3_b32 v7, v7, v80, v81
v_or3_b32 v7, v7, v88, v89
v_or3_b32 v7, v7, v66, v67
v_or3_b32 v7, v7, v74, v75
v_or3_b32 v7, v7, v82, v83
v_or3_b32 v7, v7, v90, v91
s_waitcnt lgkmcnt(4)
s_cmp_eq_u32 s34, 0
s_cbranch_scc1 L_k2_wlast
s_branch L_k2_wloop
L_k2_mk_wo:
v_cmp_gt_i32 s[56:57], 0, v5
v_cmp_gt_i32 s[58:59], 1, v5
v_cmp_gt_i32 s[60:61], 2, v5
v_cmp_gt_i32 s[62:63], 3, v5
s_nop 3
s_nop 0
v_cndmask_b32 v176, v176, v20, s[56:57]
v_cndmask_b32 v177, v177, v20, s[58:59]
v_cndmask_b32 v178, v178, v20, s[60:61]
v_cndmask_b32 v179, v179, v20, s[62:63]
v_cmp_gt_i32 s[56:57], 16, v5
v_cmp_gt_i32 s[58:59], 17, v5
v_cmp_gt_i32 s[60:61], 18, v5
v_cmp_gt_i32 s[62:63], 19, v5
v_cndmask_b32 v180, v180, v20, s[56:57]
v_cndmask_b32 v181, v181, v20, s[58:59]
v_cndmask_b32 v182, v182, v20, s[60:61]
v_cndmask_b32 v183, v183, v20, s[62:63]
v_cmp_gt_i32 s[56:57], 32, v5
v_cmp_gt_i32 s[58:59], 33, v5
v_cmp_gt_i32 s[60:61], 34, v5
v_cmp_gt_i32 s[62:63], 35, v5
v_cndmask_b32 v184, v184, v20, s[56:57]
v_cndmask_b32 v185, v185, v20, s[58:59]
v_cndmask_b32 v186, v186, v20, s[60:61]
v_cndmask_b32 v187, v187, v20, s[62:63]
v_cmp_gt_i32 s[56:57], 48, v5
v_cmp_gt_i32 s[58:59], 49, v5
v_cmp_gt_i32 s[60:61], 50, v5
v_cmp_gt_i32 s[62:63], 51, v5
v_cndmask_b32 v188, v188, v20, s[56:57]
v_cndmask_b32 v189, v189, v20, s[58:59]
v_cndmask_b32 v190, v190, v20, s[60:61]
v_cndmask_b32 v191, v191, v20, s[62:63]
s_branch L_k2_mkr_wo
L_k2_mk_tr:
v_cmp_gt_i32 s[56:57], 0, v5
v_cmp_gt_i32 s[58:59], 1, v5
v_cmp_gt_i32 s[60:61], 2, v5
v_cmp_gt_i32 s[62:63], 3, v5
s_nop 3
v_cndmask_b32 v144, v144, v20, s[56:57]
v_cndmask_b32 v145, v145, v20, s[58:59]
v_cndmask_b32 v146, v146, v20, s[60:61]
v_cndmask_b32 v147, v147, v20, s[62:63]
v_cmp_gt_i32 s[56:57], 16, v5
v_cmp_gt_i32 s[58:59], 17, v5
v_cmp_gt_i32 s[60:61], 18, v5
v_cmp_gt_i32 s[62:63], 19, v5
v_cndmask_b32 v148, v148, v20, s[56:57]
v_cndmask_b32 v149, v149, v20, s[58:59]
v_cndmask_b32 v150, v150, v20, s[60:61]
v_cndmask_b32 v151, v151, v20, s[62:63]
v_cmp_gt_i32 s[56:57], 32, v5
v_cmp_gt_i32 s[58:59], 33, v5
v_cmp_gt_i32 s[60:61], 34, v5
v_cmp_gt_i32 s[62:63], 35, v5
v_cndmask_b32 v152, v152, v20, s[56:57]
v_cndmask_b32 v153, v153, v20, s[58:59]
v_cndmask_b32 v154, v154, v20, s[60:61]
v_cndmask_b32 v155, v155, v20, s[62:63]
v_cmp_gt_i32 s[56:57], 48, v5
v_cmp_gt_i32 s[58:59], 49, v5
v_cmp_gt_i32 s[60:61], 50, v5
v_cmp_gt_i32 s[62:63], 51, v5
v_cndmask_b32 v156, v156, v20, s[56:57]
v_cndmask_b32 v157, v157, v20, s[58:59]
v_cndmask_b32 v158, v158, v20, s[60:61]
v_cndmask_b32 v159, v159, v20, s[62:63]
s_branch L_k2_mkr_tr
L_k2_mk_no:
v_cmp_gt_i32 s[56:57], 0, v5
v_cmp_gt_i32 s[58:59], 1, v5
v_cmp_gt_i32 s[60:61], 2, v5
v_cmp_gt_i32 s[62:63], 3, v5
s_nop 3
v_cndmask_b32 v144, v144, v20, s[56:57]
v_cndmask_b32 v145, v145, v20, s[58:59]
v_cndmask_b32 v146, v146, v20, s[60:61]
v_cndmask_b32 v147, v147, v20, s[62:63]
v_cmp_gt_i32 s[56:57], 16, v5
v_cmp_gt_i32 s[58:59], 17, v5
v_cmp_gt_i32 s[60:61], 18, v5
v_cmp_gt_i32 s[62:63], 19, v5
v_cndmask_b32 v148, v148, v20, s[56:57]
v_cndmask_b32 v149, v149, v20, s[58:59]
v_cndmask_b32 v150, v150, v20, s[60:61]
v_cndmask_b32 v151, v151, v20, s[62:63]
v_cmp_gt_i32 s[56:57], 32, v5
v_cmp_gt_i32 s[58:59], 33, v5
v_cmp_gt_i32 s[60:61], 34, v5
v_cmp_gt_i32 s[62:63], 35, v5
v_cndmask_b32 v152, v152, v20, s[56:57]
v_cndmask_b32 v153, v153, v20, s[58:59]
v_cndmask_b32 v154, v154, v20, s[60:61]
v_cndmask_b32 v155, v155, v20, s[62:63]
v_cmp_gt_i32 s[56:57], 48, v5
v_cmp_gt_i32 s[58:59], 49, v5
v_cmp_gt_i32 s[60:61], 50, v5
v_cmp_gt_i32 s[62:63], 51, v5
v_cndmask_b32 v156, v156, v20, s[56:57]
v_cndmask_b32 v157, v157, v20, s[58:59]
v_cndmask_b32 v158, v158, v20, s[60:61]
v_cndmask_b32 v159, v159, v20, s[62:63]
s_branch L_k2_mkr_no
L_pubB:
v_mov_b32 v24, 1
v_mov_b32 v25, 0
s_mov_b64 exec, 1
buffer_store_dword v24, v25, s[20:23], s64 offen sc1
s_mov_b64 exec, -1
s_branch L_pubBr
L_k2_wloop:
v_xor_b32 v2, 65536, v2
v_xor_b32 v3, 65536, v3
Cvaa 192,192,128,32
s_mov_b32 m0, s53
Ra 224,2,40960
v_lshl_add_u64 v[28:29], s[40:41], 0, v[28:29]
Mvaa 192,196,132
buffer_load_dwordx4 v4, s[12:15], s38 offen offset:0 sc1 lds
Mvaa 192,200,136
Ve 8,136
Mvaa 192,204,140
VE 9,137
Cvaa 208,192,144,36
Ra 228,2,41984
Vc 68,8,9
Mvaa 208,196,148
VE 10,138
Mvaa 208,200,152
VE 11,139
Mvaa 208,204,156
Ra 232,2,43008
Vc 69,10,11
Cvaa 224,192,160,40
Ra 236,2,44032
v_or3_b32 v7, v7, v68, v69
Mvaa 224,196,164
VE 12,152
Mvaa 224,200,168
VE 13,153
Mvaa 224,204,172
Ra 240,2,45056
Vc 76,12,13
Cvaa 240,192,176,44
VE 14,154
Mvaa 240,196,180
VE 15,155
Mvaa 240,200,184
Ra 244,2,46080
Vc 77,14,15
Mvaa 240,204,188
s_waitcnt lgkmcnt(6)
Ra 248,2,47104
v_or3_b32 v7, v7, v76, v77
Cvaa 196,208,128,32
buffer_load_dwordx4 v4, s[12:15], s38 offen offset:1024 sc1 lds
Mvaa 196,212,132
Ve 8,168
Mvaa 196,216,136
VE 9,169
Mvaa 196,220,140
Ra 252,2,48128
Vc 84,8,9
Cvaa 212,208,144,36
VE 10,170
Mvaa 212,212,148
VE 11,171
Mvaa 212,216,152
Ra 192,2,16384
Vc 85,10,11
Mvaa 212,220,156
Ra 196,2,24576
v_or3_b32 v7, v7, v84, v85
Cvaa 228,208,160,40
VE 12,184
Mvaa 228,212,164
VE 13,185
Mvaa 228,216,168
Ra 200,2,17408
Vc 92,12,13
Mvaa 228,220,172
VE 14,186
Cvaa 244,208,176,44
VE 15,187
Mvaa 244,212,180
buffer_load_dwordx4 v4, s[12:15], s38 offen offset:2048 sc1 lds
Mvaa 244,216,184
Ra 204,2,25600
Vc 93,14,15
Mvaa 244,220,188
s_waitcnt lgkmcnt(8)
Ve 8,140
Cvaa 200,224,128,32
Ra 208,2,18432
v_or3_b32 v7, v7, v92, v93
Mvaa 200,228,132
VE 9,141
Mvaa 200,232,136
Ra 212,2,26624
Vc 70,8,9
Mvaa 200,236,140
VE 10,142
Cvaa 216,224,144,36
VE 11,143
Mvaa 216,228,148
Ra 216,2,19456
Vc 71,10,11
Mvaa 216,232,152
Ra 220,2,27648
v_or3_b32 v7, v7, v70, v71
Mvaa 216,236,156
VE 12,156
Cvaa 232,224,160,40
VE 13,157
Mvaa 232,228,164
VE 14,158
Mvaa 232,232,168
VE 15,159
Mvaa 232,236,172
buffer_load_dwordx4 v4, s[12:15], s38 offen offset:3072 sc1 lds
Cvaa 248,224,176,44
VE 8,172
Mvaa 248,228,180
VE 9,173
Mvaa 248,232,184
Vc 78,12,13
Vc 79,14,15
Mvaa 248,236,188
s_waitcnt lgkmcnt(8)
Ve 10,174
Cvaa 204,240,128,32
VE 11,175
Mvaa 204,244,132
Vc 86,8,9
Vc 87,10,11
Mvaa 204,248,136
VE 12,188
Mvaa 204,252,140
VE 13,189
Cvaa 220,240,144,36
Vc 94,12,13
v_or3_b32 v7, v7, v78, v79
Mvaa 220,244,148
VE 14,190
Mvaa 220,248,152
VE 15,191
Mvaa 220,252,156
Vc 95,14,15
v_or3_b32 v7, v7, v86, v87
Cvaa 236,240,160,40
v_or3_b32 v7, v7, v94, v95
v_and_b32 v1, 0x40004000, v7
Mvaa 236,244,164
v_cmp_ne_u32 vcc, 0, v1
Mvaa 236,248,168
Mvaa 236,252,172
s_waitcnt vmcnt(12)
Cvaa 252,240,176,44
Mvaa 252,244,180
s_barrier
Mvaa 252,248,184
s_waitcnt lgkmcnt(4)
Mvaa 252,252,188
s_cbranch_vccnz L_k2_fb_we
L_k2_fbr_we:
Maav 0,192,64
Ve 8,192
Maav 0,196,68
s_add_u32 m0, s54, 49152
VE 9,193
Maav 32,192,72
buffer_load_dwordx4 v4, s[12:15], s39 offen offset:0 sc1 lds
Maav 32,196,76
s_add_u32 s37, s37, 1
Ra 224,2,20480
Vc 96,8,9
Maav 64,192,80
s_add_u32 s38, s38, 34816
Ve 10,194
Maav 64,196,84
VE 11,195
Maav 96,192,88
Ra 228,2,28672
Vc 97,10,11
Maav 96,196,92
Ra 232,2,21504
v_or_b32_e64 v7, v96, v97
Maav 4,200,64
VE 12,208
Maav 4,204,68
VE 13,209
Maav 36,200,72
Ra 236,2,29696
Vc 104,12,13
Maav 36,204,76
VE 14,210
Maav 68,200,80
VE 15,211
Maav 68,204,84
Ra 240,2,22528
Vc 105,14,15
Maav 100,200,88
Ra 244,2,30720
v_or3_b32 v7, v7, v104, v105
Maav 100,204,92
buffer_load_dwordx4 v4, s[12:15], s39 offen offset:1024 sc1 lds
Mvvv 48,16,64
VE 8,224
Mvvv 48,16,68
s_waitcnt lgkmcnt(6)
Ve 9,225
Maav 8,208,64
Ra 248,2,23552
Vc 112,8,9
Maav 8,212,68
VE 10,226
Maav 40,208,72
VE 11,227
Maav 40,212,76
Ra 252,2,31744
Vc 113,10,11
Maav 72,208,80
Ra 192,3,0
v_or3_b32 v7, v7, v112, v113
Maav 72,212,84
VE 12,240
Maav 104,208,88
VE 13,241
Maav 104,212,92
Ra 196,3,1024
Vc 120,12,13
Maav 12,216,64
VE 14,242
Maav 12,220,68
VE 15,243
Maav 44,216,72
Ra 200,3,2048
Vc 121,14,15
Maav 44,220,76
buffer_load_dwordx4 v4, s[12:15], s39 offen offset:2048 sc1 lds
Maav 76,216,80
Ra 204,3,3072
v_or3_b32 v7, v7, v120, v121
Maav 76,220,84
VE 8,196
Maav 108,216,88
VE 9,197
Maav 108,220,92
VE 10,198
Mvvv 52,16,72
VE 11,199
Mvvv 52,16,76
s_waitcnt lgkmcnt(8)
Ve 12,212
Maav 16,224,64
Ra 208,3,4096
Vc 98,8,9
Maav 16,228,68
Ra 212,3,5120
Vc 99,10,11
Maav 48,224,72
Ra 216,3,6144
v_or3_b32 v7, v7, v98, v99
Maav 48,228,76
VE 13,213
Maav 80,224,80
Ra 220,3,7168
Vc 106,12,13
Maav 80,228,84
VE 14,214
Maav 112,224,88
buffer_load_dwordx4 v4, s[12:15], s39 offen offset:3072 sc1 lds
Maav 112,228,92
s_add_u32 s39, s39, 34816
VE 15,215
Maav 20,232,64
VE 8,228
Maav 20,236,68
VE 9,229
Maav 52,232,72
VE 10,230
Maav 52,236,76
VE 11,231
Maav 84,232,80
Vc 107,14,15
Vc 114,8,9
Maav 84,236,84
VE 12,244
Maav 116,232,88
VE 13,245
Maav 116,236,92
Vc 115,10,11
Vc 122,12,13
Mvvv 56,16,80
VE 14,246
Mvvv 56,16,84
s_waitcnt lgkmcnt(8)
Ve 15,247
Maav 24,240,64
Vc 123,14,15
v_or3_b32 v7, v7, v106, v107
Maav 24,244,68
v_or3_b32 v7, v7, v114, v115
v_or3_b32 v7, v7, v122, v123
Maav 56,240,72
global_load_dword v30, v[28:29], off
Maav 56,244,76
Maav 88,240,80
Maav 88,244,84
Maav 120,240,88
Maav 120,244,92
Maav 28,248,64
Maav 28,252,68
Maav 60,248,72
Maav 60,252,76
Maav 92,248,80
Maav 92,252,84
Maav 124,248,88
Maav 124,252,92
Mvvv 60,16,88
s_waitcnt lgkmcnt(4)
Mvvv 60,16,92
Ve 8,200
Cvaa 128,192,128,32
s_add_u32 m0, s53, 32768
Ra 224,3,8192
v_lshl_add_u64 v[28:29], s[40:41], 0, v[28:29]
Mvaa 128,196,132
buffer_load_dwordx4 v4, s[12:15], s38 offen offset:0 sc1 lds
Mvaa 128,200,136
VE 9,201
Mvaa 128,204,140
Ra 228,3,9216
Vc 100,8,9
Cvaa 144,192,144,36
VE 10,202
Mvaa 144,196,148
VE 11,203
Mvaa 144,200,152
Ra 232,3,10240
Vc 101,10,11
Mvaa 144,204,156
Ra 236,3,11264
v_or3_b32 v7, v7, v100, v101
Cvaa 160,192,160,40
VE 12,216
Mvaa 160,196,164
VE 13,217
Mvaa 160,200,168
Ra 240,3,12288
Vc 108,12,13
Mvaa 160,204,172
VE 14,218
Cvaa 176,192,176,44
VE 15,219
Mvaa 176,196,180
Ra 244,3,13312
Vc 109,14,15
Mvaa 176,200,184
Ra 248,3,14336
v_or3_b32 v7, v7, v108, v109
Mvaa 176,204,188
s_waitcnt lgkmcnt(7)
Ve 8,232
Cvaa 132,208,128,32
buffer_load_dwordx4 v4, s[12:15], s38 offen offset:1024 sc1 lds
Mvaa 132,212,132
VE 9,233
Mvaa 132,216,136
Ra 252,3,15360
Vc 116,8,9
Mvaa 132,220,140
VE 10,234
Cvaa 148,208,144,36
VE 11,235
Mvaa 148,212,148
Ra 192,2,49152
Vc 117,10,11
Mvaa 148,216,152
Ra 196,2,57344
v_or3_b32 v7, v7, v116, v117
Mvaa 148,220,156
VE 12,248
Cvaa 164,208,160,40
VE 13,249
Mvaa 164,212,164
Ra 200,2,50176
Vc 124,12,13
Mvaa 164,216,168
VE 14,250
Mvaa 164,220,172
VE 15,251
Cvaa 180,208,176,44
Ra 204,2,58368
Vc 125,14,15
Mvaa 180,212,180
buffer_load_dwordx4 v4, s[12:15], s38 offen offset:2048 sc1 lds
Mvaa 180,216,184
VE 8,204
Mvaa 180,220,188
s_waitcnt lgkmcnt(8)
Ve 9,205
Cvaa 136,224,128,32
Ra 208,2,51200
Vc 102,8,9
Mvaa 136,228,132
Ra 212,2,59392
v_or3_b32 v7, v7, v124, v125
Mvaa 136,232,136
VE 10,206
Mvaa 136,236,140
VE 11,207
Cvaa 152,224,144,36
Ra 216,2,52224
Vc 103,10,11
Mvaa 152,228,148
Ra 220,2,60416
v_or3_b32 v7, v7, v102, v103
Mvaa 152,232,152
VE 12,220
Mvaa 152,236,156
VE 13,221
Cvaa 168,224,160,40
VE 14,222
Mvaa 168,228,164
VE 15,223
Mvaa 168,232,168
VE 8,236
Mvaa 168,236,172
buffer_load_dwordx4 v4, s[12:15], s38 offen offset:3072 sc1 lds
Cvaa 184,224,176,44
VE 9,237
Mvaa 184,228,180
Vc 110,12,13
Vc 111,14,15
Mvaa 184,232,184
VE 10,238
Mvaa 184,236,188
s_waitcnt lgkmcnt(8)
Ve 11,239
Cvaa 140,240,128,32
Vc 118,8,9
Vc 119,10,11
Mvaa 140,244,132
VE 12,252
Mvaa 140,248,136
VE 13,253
Mvaa 140,252,140
Vc 126,12,13
v_or3_b32 v7, v7, v110, v111
Cvaa 156,240,144,36
VE 14,254
Mvaa 156,244,148
VE 15,255
Mvaa 156,248,152
Vc 127,14,15
v_or3_b32 v7, v7, v118, v119
Mvaa 156,252,156
v_or3_b32 v7, v7, v126, v127
v_and_b32 v1, 0x40004000, v7
Cvaa 172,240,160,40
v_cmp_ne_u32 vcc, 0, v1
Mvaa 172,244,164
Mvaa 172,248,168
Mvaa 172,252,172
s_waitcnt vmcnt(12)
Cvaa 188,240,176,44
s_cmp_eq_u32 s37, s46
Mvaa 188,244,180
s_barrier
Mvaa 188,248,184
s_waitcnt lgkmcnt(4)
Mvaa 188,252,188
s_cbranch_vccnz L_k2_fb_wo
L_k2_fbr_wo:
Maav 0,192,96
s_cbranch_scc1 L_k2_mk_wo
L_k2_mkr_wo:
Ve 8,128
Maav 0,196,100
s_add_u32 m0, s53, 16384
VE 9,129
Maav 32,192,104
buffer_load_dwordx4 v4, s[12:15], s39 offen offset:0 sc1 lds
Maav 32,196,108
s_add_u32 s37, s37, 1
Ra 224,2,53248
Vc 64,8,9
Maav 64,192,112
s_add_u32 s38, s38, 34816
Ve 10,130
Maav 64,196,116
s_xor_b32 s53, s53, 65536
VE 11,131
Maav 96,192,120
s_xor_b32 s54, s54, 65536
Ra 228,2,61440
Vc 65,10,11
Maav 96,196,124
Ra 232,2,54272
v_or_b32_e64 v7, v64, v65
Maav 4,200,96
VE 12,144
Maav 4,204,100
VE 13,145
Maav 36,200,104
Ra 236,2,62464
Vc 72,12,13
Maav 36,204,108
VE 14,146
Maav 68,200,112
VE 15,147
Maav 68,204,116
Ra 240,2,55296
Vc 73,14,15
Maav 100,200,120
Ra 244,2,63488
v_or3_b32 v7, v7, v72, v73
Maav 100,204,124
buffer_load_dwordx4 v4, s[12:15], s39 offen offset:1024 sc1 lds
Mvvv 48,16,96
VE 8,160
Mvvv 48,16,100
s_waitcnt lgkmcnt(6)
Ve 9,161
Maav 8,208,96
Ra 248,2,56320
Vc 80,8,9
Maav 8,212,100
VE 10,162
Maav 40,208,104
VE 11,163
Maav 40,212,108
Ra 252,2,64512
Vc 81,10,11
Maav 72,208,112
Ra 192,3,32768
v_or3_b32 v7, v7, v80, v81
Maav 72,212,116
VE 12,176
Maav 104,208,120
VE 13,177
Maav 104,212,124
Ra 196,3,33792
Vc 88,12,13
Maav 12,216,96
VE 14,178
Maav 12,220,100
VE 15,179
Maav 44,216,104
Ra 200,3,34816
Vc 89,14,15
Maav 44,220,108
buffer_load_dwordx4 v4, s[12:15], s39 offen offset:2048 sc1 lds
Maav 76,216,112
Ra 204,3,35840
v_or3_b32 v7, v7, v88, v89
Maav 76,220,116
VE 8,132
Maav 108,216,120
VE 9,133
Maav 108,220,124
VE 10,134
Mvvv 52,16,104
VE 11,135
Mvvv 52,16,108
s_waitcnt lgkmcnt(8)
Ve 12,148
Maav 16,224,96
Ra 208,3,36864
Vc 66,8,9
Maav 16,228,100
Ra 212,3,37888
Vc 67,10,11
Maav 48,224,104
Ra 216,3,38912
v_or3_b32 v7, v7, v66, v67
Maav 48,228,108
VE 13,149
Maav 80,224,112
Ra 220,3,39936
Vc 74,12,13
Maav 80,228,116
VE 14,150
Maav 112,224,120
buffer_load_dwordx4 v4, s[12:15], s39 offen offset:3072 sc1 lds
Maav 112,228,124
s_add_u32 s39, s39, 34816
VE 15,151
Maav 20,232,96
VE 8,164
Maav 20,236,100
VE 9,165
Maav 52,232,104
VE 10,166
Maav 52,236,108
VE 11,167
Maav 84,232,112
Vc 75,14,15
Vc 82,8,9
Maav 84,236,116
VE 12,180
Maav 116,232,120
VE 13,181
Maav 116,236,124
Vc 83,10,11
Vc 90,12,13
Mvvv 56,16,112
VE 14,182
Mvvv 56,16,116
s_waitcnt lgkmcnt(8)
Ve 15,183
Maav 24,240,96
Vc 91,14,15
v_or3_b32 v7, v7, v74, v75
Maav 24,244,100
v_or3_b32 v7, v7, v82, v83
v_or3_b32 v7, v7, v90, v91
Maav 56,240,104
global_load_dword v30, v[28:29], off
Maav 56,244,108
Maav 88,240,112
Maav 88,244,116
Maav 120,240,120
Maav 120,244,124
Maav 28,248,96
Maav 28,252,100
Maav 60,248,104
Maav 60,252,108
Maav 92,248,112
Maav 92,252,116
Maav 124,248,120
Maav 124,252,124
s_cmp_lg_u32 s37, s35
Mvvv 60,16,120
s_waitcnt lgkmcnt(4)
Mvvv 60,16,124
s_cbranch_scc1 L_k2_wloop
L_k2_wlast:
v_xor_b32 v2, 65536, v2
v_xor_b32 v3, 65536, v3
Cvaa 192,192,128,32
s_mov_b32 m0, s53
Ra 224,2,40960
v_lshl_add_u64 v[28:29], s[40:41], 0, v[28:29]
Mvaa 192,196,132
buffer_load_dwordx4 v4, s[12:15], s38 offen offset:0 sc1 lds
Mvaa 192,200,136
VE 8,136
Mvaa 192,204,140
VE 9,137
Cvaa 208,192,144,36
Ra 228,2,41984
Vc 68,8,9
Mvaa 208,196,148
VE 10,138
Mvaa 208,200,152
VE 11,139
Mvaa 208,204,156
Ra 232,2,43008
Vc 69,10,11
Cvaa 224,192,160,40
Ra 236,2,44032
v_or3_b32 v7, v7, v68, v69
Mvaa 224,196,164
VE 12,152
Mvaa 224,200,168
VE 13,153
Mvaa 224,204,172
s_waitcnt lgkmcnt(4)
Ra 240,2,45056
Vc 76,12,13
Cvaa 196,208,128,32
buffer_load_dwordx4 v4, s[12:15], s38 offen offset:1024 sc1 lds
Mvaa 196,212,132
Ve 14,154
Mvaa 196,216,136
VE 15,155
Mvaa 196,220,140
Ra 244,2,46080
Vc 77,14,15
Cvaa 212,208,144,36
Ra 248,2,47104
v_or3_b32 v7, v7, v76, v77
Mvaa 212,212,148
VE 8,168
Mvaa 212,216,152
VE 9,169
Mvaa 212,220,156
Ra 252,2,48128
Vc 84,8,9
Cvaa 228,208,160,40
VE 10,170
Mvaa 228,212,164
buffer_load_dwordx4 v4, s[12:15], s38 offen offset:2048 sc1 lds
Mvaa 228,216,168
VE 11,171
Mvaa 228,220,172
s_waitcnt lgkmcnt(4)
Ra 192,2,16384
Vc 85,10,11
Cvaa 200,224,128,32
Ra 196,2,24576
v_or3_b32 v7, v7, v84, v85
Mvaa 200,228,132
Ve 12,184
Mvaa 200,232,136
VE 13,185
Mvaa 200,236,140
Ra 200,2,17408
Vc 92,12,13
Cvaa 216,224,144,36
VE 14,186
Mvaa 216,228,148
VE 15,187
Mvaa 216,232,152
Ra 204,2,25600
Vc 93,14,15
Mvaa 216,236,156
buffer_load_dwordx4 v4, s[12:15], s38 offen offset:3072 sc1 lds
Cvaa 232,224,160,40
Ra 208,2,18432
v_or3_b32 v7, v7, v92, v93
Mvaa 232,228,164
VE 8,140
Mvaa 232,232,168
VE 9,141
Mvaa 232,236,172
s_waitcnt lgkmcnt(5)
Ra 212,2,26624
Vc 70,8,9
Cvaa 204,240,128,32
Ve 10,142
Mvaa 204,244,132
VE 11,143
Mvaa 204,248,136
Ra 216,2,19456
Vc 71,10,11
Mvaa 204,252,140
Ra 220,2,27648
v_or3_b32 v7, v7, v70, v71
Cvaa 220,240,144,36
VE 12,156
Mvaa 220,244,148
VE 13,157
Mvaa 220,248,152
VE 14,158
Mvaa 220,252,156
s_waitcnt vmcnt(12)
Ve 15,159
Cvaa 236,240,160,40
VE 8,172
Mvaa 236,244,164
s_barrier
Ve 9,173
Mvaa 236,248,168
s_waitcnt lgkmcnt(4)
Vc 78,12,13
Vc 79,14,15
Ve 10,174
Ve 11,175
Ve 12,188
Ve 13,189
Ve 14,190
VE 15,191
Vc 86,8,9
Vc 87,10,11
Vc 94,12,13
Vc 95,14,15
v_or3_b32 v7, v7, v78, v79
v_or3_b32 v7, v7, v86, v87
v_or3_b32 v7, v7, v94, v95
v_and_b32 v1, 0x40004000, v7
v_cmp_ne_u32 vcc, 0, v1
Mvaa 236,252,172
s_cbranch_vccnz L_k2_fb_wl
L_k2_fbr_wl:
Maav 0,192,64
v_cmp_gt_i32 s[56:57], 0, v6
v_cmp_gt_i32 s[58:59], 1, v6
v_cmp_gt_i32 s[60:61], 2, v6
v_cmp_gt_i32 s[62:63], 3, v6
s_nop 3
s_nop 0
v_cndmask_b32 v224, v224, v20, s[56:57]
v_cndmask_b32 v225, v225, v20, s[58:59]
v_cndmask_b32 v226, v226, v20, s[60:61]
v_cndmask_b32 v227, v227, v20, s[62:63]
v_cmp_gt_i32 s[56:57], 16, v6
v_cmp_gt_i32 s[58:59], 17, v6
v_cmp_gt_i32 s[60:61], 18, v6
v_cmp_gt_i32 s[62:63], 19, v6
v_cndmask_b32 v228, v228, v20, s[56:57]
v_cndmask_b32 v229, v229, v20, s[58:59]
v_cndmask_b32 v230, v230, v20, s[60:61]
v_cndmask_b32 v231, v231, v20, s[62:63]
v_cmp_gt_i32 s[56:57], 32, v6
v_cmp_gt_i32 s[58:59], 33, v6
v_cmp_gt_i32 s[60:61], 34, v6
v_cmp_gt_i32 s[62:63], 35, v6
v_cndmask_b32 v232, v232, v20, s[56:57]
v_cndmask_b32 v233, v233, v20, s[58:59]
v_cndmask_b32 v234, v234, v20, s[60:61]
v_cndmask_b32 v235, v235, v20, s[62:63]
v_cmp_gt_i32 s[56:57], 48, v6
v_cmp_gt_i32 s[58:59], 49, v6
v_cmp_gt_i32 s[60:61], 50, v6
v_cmp_gt_i32 s[62:63], 51, v6
v_cndmask_b32 v236, v236, v20, s[56:57]
v_cndmask_b32 v237, v237, v20, s[58:59]
v_cndmask_b32 v238, v238, v20, s[60:61]
v_cndmask_b32 v239, v239, v20, s[62:63]
VE 8,192
Maav 0,196,68
s_add_u32 m0, s54, 49152
VE 9,193
Maav 32,192,72
buffer_load_dwordx4 v4, s[12:15], s39 offen offset:0 sc1 lds
Maav 32,196,76
s_add_u32 s37, s37, 1
Ra 224,2,20480
Vc 96,8,9
Maav 64,192,80
s_add_u32 s38, s38, 34816
Ve 10,194
Maav 64,196,84
VE 11,195
Maav 96,192,88
Ra 228,2,28672
Vc 97,10,11
Maav 96,196,92
Ra 232,2,21504
v_or_b32_e64 v7, v96, v97
Maav 4,200,64
VE 12,208
Maav 4,204,68
VE 13,209
Maav 36,200,72
Ra 236,2,29696
Vc 104,12,13
Maav 36,204,76
VE 14,210
Maav 68,200,80
VE 15,211
Maav 68,204,84
Ra 240,2,22528
Vc 105,14,15
Maav 100,200,88
Ra 244,2,30720
v_or3_b32 v7, v7, v104, v105
Maav 100,204,92
buffer_load_dwordx4 v4, s[12:15], s39 offen offset:1024 sc1 lds
Mvvv 48,16,64
VE 8,224
Mvvv 48,16,68
s_waitcnt lgkmcnt(6)
Ve 9,225
Maav 8,208,64
Ra 248,2,23552
Vc 112,8,9
Maav 8,212,68
VE 10,226
Maav 40,208,72
VE 11,227
Maav 40,212,76
Ra 252,2,31744
Vc 113,10,11
Maav 72,208,80
Ra 192,3,0
v_or3_b32 v7, v7, v112, v113
Maav 72,212,84
VE 12,196
Maav 104,208,88
VE 13,197
Maav 104,212,92
Ra 196,3,1024
Vc 98,12,13
Maav 12,216,64
VE 14,198
Maav 12,220,68
VE 15,199
Maav 44,216,72
Ra 200,3,2048
Vc 99,14,15
Maav 44,220,76
buffer_load_dwordx4 v4, s[12:15], s39 offen offset:2048 sc1 lds
Maav 76,216,80
Ra 204,3,3072
v_or3_b32 v7, v7, v98, v99
Maav 76,220,84
VE 8,212
Maav 108,216,88
VE 9,213
Maav 108,220,92
VE 10,214
Mvvv 52,16,72
VE 11,215
Mvvv 52,16,76
s_waitcnt lgkmcnt(8)
Ve 12,228
Maav 16,224,64
Ra 208,3,4096
Vc 106,8,9
Maav 16,228,68
Ra 212,3,5120
Vc 107,10,11
Maav 48,224,72
Ra 216,3,6144
v_or3_b32 v7, v7, v106, v107
Maav 48,228,76
VE 13,229
Maav 80,224,80
Ra 220,3,7168
Vc 114,12,13
Maav 80,228,84
VE 14,230
Maav 112,224,88
buffer_load_dwordx4 v4, s[12:15], s39 offen offset:3072 sc1 lds
Maav 112,228,92
s_add_u32 s39, s39, 34816
VE 15,231
Maav 20,232,64
VE 8,200
Maav 20,236,68
VE 9,201
Maav 52,232,72
VE 10,202
Maav 52,236,76
VE 11,203
Maav 84,232,80
Vc 115,14,15
Vc 100,8,9
Maav 84,236,84
VE 12,216
Maav 116,232,88
VE 13,217
Maav 116,236,92
Vc 101,10,11
Vc 108,12,13
Mvvv 56,16,80
VE 14,218
Mvvv 56,16,84
s_waitcnt lgkmcnt(8)
Ve 15,219
Maav 24,240,64
Vc 109,14,15
v_or3_b32 v7, v7, v114, v115
Maav 24,244,68
VE 8,232
Maav 56,240,72
global_load_dword v30, v[28:29], off
Maav 56,244,76
VE 9,233
Maav 88,240,80
Vc 116,8,9
v_or3_b32 v7, v7, v100, v101
Maav 88,244,84
VE 10,234
Maav 120,240,88
VE 11,235
Maav 120,244,92
Vc 117,10,11
v_or3_b32 v7, v7, v108, v109
Maav 28,248,64
v_or3_b32 v7, v7, v116, v117
Maav 28,252,68
Maav 60,248,72
Maav 60,252,76
Maav 92,248,80
Maav 92,252,84
Maav 124,248,88
Maav 124,252,92
Mvvv 60,16,88
s_waitcnt lgkmcnt(4)
Mvvv 60,16,92
Ve 12,204
Cvaa 128,192,128,32
s_add_u32 m0, s53, 32768
VE 13,205
Mvaa 128,196,132
buffer_load_dwordx4 v4, s[12:15], s38 offen offset:0 sc1 lds
Mvaa 128,200,136
Ra 224,3,8192
Vc 102,12,13
Mvaa 128,204,140
VE 14,206
Cvaa 144,192,144,36
VE 15,207
Mvaa 144,196,148
Ra 228,3,9216
Vc 103,14,15
Mvaa 144,200,152
Ra 232,3,10240
v_or3_b32 v7, v7, v102, v103
Mvaa 144,204,156
s_waitcnt lgkmcnt(3)
Ra 236,3,11264
Ra 240,3,12288
Cvaa 132,208,128,32
buffer_load_dwordx4 v4, s[12:15], s38 offen offset:1024 sc1 lds
Mvaa 132,212,132
Ve 8,220
Mvaa 132,216,136
VE 9,221
Mvaa 132,220,140
Ra 244,3,13312
Vc 110,8,9
Cvaa 148,208,144,36
VE 10,222
Mvaa 148,212,148
buffer_load_dwordx4 v4, s[12:15], s38 offen offset:2048 sc1 lds
Mvaa 148,216,152
VE 11,223
Mvaa 148,220,156
s_waitcnt lgkmcnt(2)
Ra 248,3,14336
Ra 252,3,15360
Cvaa 136,224,128,32
Ra 192,2,49152
Vc 111,10,11
Mvaa 136,228,132
Ra 196,2,57344
v_or3_b32 v7, v7, v110, v111
Mvaa 136,232,136
Ve 12,236
Mvaa 136,236,140
buffer_load_dwordx4 v4, s[12:15], s38 offen offset:3072 sc1 lds
Cvaa 152,224,144,36
VE 13,237
Mvaa 152,228,148
Ra 200,2,50176
Vc 118,12,13
Mvaa 152,232,152
VE 14,238
Mvaa 152,236,156
s_waitcnt lgkmcnt(3)
Ra 204,2,58368
Ra 208,2,51200
Cvaa 140,240,128,32
Ve 15,239
Mvaa 140,244,132
Ra 212,2,59392
Vc 119,14,15
Mvaa 140,248,136
Ra 216,2,52224
v_or3_b32 v7, v7, v118, v119
Mvaa 140,252,140
s_waitcnt vmcnt(12)
Ra 220,2,60416
v_and_b32 v1, 0x40004000, v7
Cvaa 156,240,144,36
s_cmp_eq_u32 s37, s45
v_cmp_ne_u32 vcc, 0, v1
Mvaa 156,244,148
s_barrier
Mvaa 156,248,152
s_waitcnt lgkmcnt(4)
Mvaa 156,252,156
s_cbranch_vccnz L_k2_fb_tr
L_k2_fbr_tr:
Maav 0,192,96
s_cbranch_scc1 L_k2_mk_tr
L_k2_mkr_tr:
Ve 8,128
Maav 0,196,100
s_add_u32 m0, s53, 16384
VE 9,129
Maav 32,192,104
buffer_load_dwordx4 v4, s[12:15], s39 offen offset:0 sc1 lds
Maav 32,196,108
s_add_u32 s37, s37, 1
Ra 224,2,53248
Vc 64,8,9
Maav 64,192,112
s_add_u32 s38, s38, 34816
Ve 10,130
Maav 64,196,116
s_xor_b32 s53, s53, 65536
VE 11,131
Maav 4,200,96
s_xor_b32 s54, s54, 65536
Ra 228,2,61440
Vc 65,10,11
Maav 4,204,100
Ra 232,2,54272
v_or_b32_e64 v7, v64, v65
Maav 36,200,104
VE 12,144
Maav 36,204,108
VE 13,145
Maav 68,200,112
Ra 236,2,62464
Vc 72,12,13
Maav 68,204,116
VE 14,146
Mvvv 48,16,96
VE 15,147
Mvvv 48,16,100
s_waitcnt lgkmcnt(4)
Ra 240,2,55296
Vc 73,14,15
Maav 8,208,96
buffer_load_dwordx4 v4, s[12:15], s39 offen offset:1024 sc1 lds
Maav 8,212,100
Ra 244,2,63488
v_or3_b32 v7, v7, v72, v73
Maav 40,208,104
Ve 8,132
Maav 40,212,108
VE 9,133
Maav 72,208,112
Ra 248,2,56320
Vc 66,8,9
Maav 72,212,116
VE 10,134
Maav 12,216,96
VE 11,135
Maav 12,220,100
Ra 252,2,64512
Vc 67,10,11
Maav 44,216,104
Ra 192,3,32768
v_or3_b32 v7, v7, v66, v67
Maav 44,220,108
VE 12,148
Maav 76,216,112
VE 13,149
Maav 76,220,116
Ra 196,3,33792
Vc 74,12,13
Mvvv 52,16,104
VE 14,150
Mvvv 52,16,108
s_waitcnt lgkmcnt(6)
Ve 15,151
Maav 16,224,96
buffer_load_dwordx4 v4, s[12:15], s39 offen offset:2048 sc1 lds
Maav 16,228,100
Ra 200,3,34816
Vc 75,14,15
Maav 48,224,104
Ra 204,3,35840
v_or3_b32 v7, v7, v74, v75
Maav 48,228,108
VE 8,136
Maav 80,224,112
Ra 208,3,36864
Ra 212,3,37888
Maav 80,228,116
Ra 216,3,38912
Ra 220,3,39936
Maav 20,232,96
Maav 20,236,100
Maav 52,232,104
Maav 52,236,108
Maav 84,232,112
Maav 84,236,116
buffer_load_dwordx4 v4, s[12:15], s39 offen offset:3072 sc1 lds
Mvvv 56,16,112
s_add_u32 s39, s39, 34816
Mvvv 56,16,116
s_waitcnt lgkmcnt(8)
Maav 24,240,96
Maav 24,244,100
Maav 56,240,104
Maav 56,244,108
Maav 88,240,112
Maav 88,244,116
Maav 28,248,96
Maav 28,252,100
Maav 60,248,104
Maav 60,252,108
Maav 92,248,112
s_waitcnt lgkmcnt(4)
Maav 92,252,116
s_getpc_b64 s[56:57]
L_cpf4:
s_add_u32 s56, s56, (L_k2_fin-L_cpf4)&0xffffffff
s_addc_u32 s57, s57, ((L_k2_fin-L_cpf4)>>32)&0xffffffff
s_lshr_b32 s58, s2, 3
s_lshl_b32 s58, s58, 2
s_add_u32 s58, s58, s32
s_lshl_b32 s58, s58, 10
v_and_b32 v162, 7, v0
v_lshlrev_b32 v162, 7, v162
v_add_u32 v162, s58, v162
v_min_u32 v162, L_p4_end-L_k2_fin-4, v162
v_mov_b32 v161, s57
v_add_co_u32 v160, vcc, s56, v162
s_nop 1
v_addc_co_u32 v161, vcc, 0, v161, vcc
global_load_dword v164, v[160:161], off
s_waitcnt vmcnt(9)
s_lshl_b32 s3, s34, 20
s_lshl_b32 s47, s33, 15
s_add_u32 s3, s3, s47
s_lshl_b32 s47, s32, 10
v_lshlrev_b32 v248, 4, v0
v_add_u32_e64 v249, s47, v248
s_sub_u32 s47, 7168, s47
v_add_u32 v248, s47, v248
v_rcp_f32 v250, v56
v_rcp_f32 v252, v60
v_mov_b32 v251, v250
v_mov_b32_e64 v253, v252
Ar 240,96
Ar 241,97
Ar 242,98
Ar 243,99
Ar 244,100
Ar 245,101
Ar 246,102
Ar 247,103
v_pk_mul_f32 v[240:241], v[240:241], v[252:253]
v_pk_mul_f32 v[242:243], v[242:243], v[252:253]
v_pk_mul_f32 v[244:245], v[244:245], v[252:253]
v_pk_mul_f32 v[246:247], v[246:247], v[252:253]
Vc 28,240,241
Vc 29,242,243
Vc 30,244,245
Vc 31,246,247
buffer_store_dwordx4 v[28:31], v249, s[16:19], s3 offen sc1
Ar 240,64
Ar 241,65
Ar 242,66
Ar 243,67
Ar 244,68
Ar 245,69
Ar 246,70
Ar 247,71
v_pk_mul_f32 v[240:241], v[240:241], v[250:251]
v_pk_mul_f32 v[242:243], v[242:243], v[250:251]
v_pk_mul_f32 v[244:245], v[244:245], v[250:251]
v_pk_mul_f32 v[246:247], v[246:247], v[250:251]
Vc 24,240,241
Vc 25,242,243
Vc 26,244,245
Vc 27,246,247
buffer_store_dwordx4 v[24:27], v248, s[16:19], s3 offen sc1
s_add_u32 s3, s3, 8192
Ar 240,104
Ar 241,105
Ar 242,106
Ar 243,107
Ar 244,108
Ar 245,109
Ar 246,110
Ar 247,111
v_pk_mul_f32 v[240:241], v[240:241], v[252:253]
v_pk_mul_f32 v[242:243], v[242:243], v[252:253]
v_pk_mul_f32 v[244:245], v[244:245], v[252:253]
v_pk_mul_f32 v[246:247], v[246:247], v[252:253]
Vc 28,240,241
Vc 29,242,243
Vc 30,244,245
Vc 31,246,247
buffer_store_dwordx4 v[28:31], v249, s[16:19], s3 offen sc1
Ar 240,72
Ar 241,73
Ar 242,74
Ar 243,75
Ar 244,76
Ar 245,77
Ar 246,78
Ar 247,79
v_pk_mul_f32 v[240:241], v[240:241], v[250:251]
v_pk_mul_f32 v[242:243], v[242:243], v[250:251]
v_pk_mul_f32 v[244:245], v[244:245], v[250:251]
v_pk_mul_f32 v[246:247], v[246:247], v[250:251]
Vc 24,240,241
Vc 25,242,243
Vc 26,244,245
Vc 27,246,247
buffer_store_dwordx4 v[24:27], v248, s[16:19], s3 offen sc1
s_add_u32 s3, s3, 8192
Ar 240,112
Ar 241,113
Ar 242,114
Ar 243,115
Ar 244,116
Ar 245,117
Ar 246,118
Ar 247,119
v_pk_mul_f32 v[240:241], v[240:241], v[252:253]
v_pk_mul_f32 v[242:243], v[242:243], v[252:253]
v_pk_mul_f32 v[244:245], v[244:245], v[252:253]
v_pk_mul_f32 v[246:247], v[246:247], v[252:253]
Vc 28,240,241
Vc 29,242,243
Vc 30,244,245
Vc 31,246,247
buffer_store_dwordx4 v[28:31], v249, s[16:19], s3 offen sc1
Ar 240,80
Ar 241,81
Ar 242,82
Ar 243,83
Ar 244,84
Ar 245,85
Ar 246,86
Ar 247,87
v_pk_mul_f32 v[240:241], v[240:241], v[250:251]
v_pk_mul_f32 v[242:243], v[242:243], v[250:251]
v_pk_mul_f32 v[244:245], v[244:245], v[250:251]
v_pk_mul_f32 v[246:247], v[246:247], v[250:251]
Vc 24,240,241
Vc 25,242,243
Vc 26,244,245
Vc 27,246,247
buffer_store_dwordx4 v[24:27], v248, s[16:19], s3 offen sc1
s_add_u32 s3, s3, 8192
Ar 240,120
Ar 241,121
Ar 242,122
Ar 243,123
Ar 244,124
Ar 245,125
Ar 246,126
Ar 247,127
v_pk_mul_f32 v[240:241], v[240:241], v[252:253]
v_pk_mul_f32 v[242:243], v[242:243], v[252:253]
v_pk_mul_f32 v[244:245], v[244:245], v[252:253]
v_pk_mul_f32 v[246:247], v[246:247], v[252:253]
Vc 28,240,241
Vc 29,242,243
Vc 30,244,245
Vc 31,246,247
buffer_store_dwordx4 v[28:31], v249, s[16:19], s3 offen sc1
Ar 240,88
Ar 241,89
Ar 242,90
Ar 243,91
Ar 244,92
Ar 245,93
Ar 246,94
Ar 247,95
v_pk_mul_f32 v[240:241], v[240:241], v[250:251]
v_pk_mul_f32 v[242:243], v[242:243], v[250:251]
v_pk_mul_f32 v[244:245], v[244:245], v[250:251]
v_pk_mul_f32 v[246:247], v[246:247], v[250:251]
Vc 24,240,241
Vc 25,242,243
Vc 26,244,245
Vc 27,246,247
buffer_store_dwordx4 v[24:27], v248, s[16:19], s3 offen sc1
s_add_u32 s52, s37, 2
s_load_dwordx2 s[94:95], s[0:1], 40
s_load_dwordx2 s[40:41], s[0:1], 0
s_load_dwordx4 s[8:11], s[0:1], 80
s_waitcnt vmcnt(8) lgkmcnt(0)
s_add_u32 s93, s2, 224
s_and_b32 s93, s93, 255
s_nop 0
s_mul_i32 s92, s93, 2341
s_lshr_b32 s92, s92, 16
s_mul_i32 s47, s92, 28
s_sub_u32 s4, s93, s47
s_mul_i32 s5, s92, 917504
s_lshl_b32 s47, s4, 8
s_add_u32 s5, s5, s47
s_cmp_eq_u32 s34, 7
s_cbranch_scc1 L_k2_fin
L_k2_nloop:
v_xor_b32 v2, 65536, v2
v_xor_b32 v3, 65536, v3
Cvaa 192,192,128,32
s_mov_b32 m0, s53
Ve 9,137
Mvaa 192,196,132
buffer_load_dwordx4 v4, s[12:15], s38 offen offset:0 sc1 lds
Mvaa 192,200,136
Ra 224,2,40960
Vc 68,8,9
Mvaa 192,204,140
VE 10,138
Cvaa 208,192,144,36
VE 11,139
Mvaa 208,196,148
Ra 228,2,41984
Vc 69,10,11
Mvaa 208,200,152
Ra 232,2,43008
v_or3_b32 v7, v7, v68, v69
Mvaa 208,204,156
s_waitcnt lgkmcnt(3)
Ra 236,2,44032
Ra 240,2,45056
Cvaa 196,208,128,32
buffer_load_dwordx4 v4, s[12:15], s38 offen offset:1024 sc1 lds
Mvaa 196,212,132
Ve 12,152
Mvaa 196,216,136
VE 13,153
Mvaa 196,220,140
Ra 244,2,46080
Vc 76,12,13
Cvaa 212,208,144,36
VE 14,154
Mvaa 212,212,148
buffer_load_dwordx4 v4, s[12:15], s38 offen offset:2048 sc1 lds
Mvaa 212,216,152
VE 15,155
Mvaa 212,220,156
s_waitcnt lgkmcnt(2)
Ra 248,2,47104
Ra 252,2,48128
Cvaa 200,224,128,32
Ra 192,2,16384
Vc 77,14,15
Mvaa 200,228,132
Ra 196,2,24576
v_or3_b32 v7, v7, v76, v77
Mvaa 200,232,136
Ve 8,140
Mvaa 200,236,140
buffer_load_dwordx4 v4, s[12:15], s38 offen offset:3072 sc1 lds
Cvaa 216,224,144,36
VE 9,141
Mvaa 216,228,148
Ra 200,2,17408
Vc 70,8,9
Mvaa 216,232,152
VE 10,142
Mvaa 216,236,156
s_waitcnt lgkmcnt(3)
Ra 204,2,25600
Ra 208,2,18432
Cvaa 204,240,128,32
Ve 11,143
Mvaa 204,244,132
s_cmp_lt_u32 s37, s52
Ra 212,2,26624
Vc 71,10,11
Mvaa 204,248,136
s_cbranch_scc1 L_nw_ne
s_waitcnt vmcnt(12)
L_nw_ne:
Ra 216,2,19456
v_or3_b32 v7, v7, v70, v71
Mvaa 204,252,140
Ve 12,156
Cvaa 220,240,144,36
VE 13,157
Mvaa 220,244,148
s_barrier
Ra 220,2,27648
Vc 78,12,13
Mvaa 220,248,152
s_waitcnt lgkmcnt(4)
Ve 14,158
Ve 15,159
s_nop 0
Vc 79,14,15
v_or3_b32 v7, v7, v78, v79
v_and_b32 v1, 0x40004000, v7
v_cmp_ne_u32 vcc, 0, v1
Mvaa 220,252,156
s_cbranch_vccnz L_k2_fb_ne
L_k2_fbr_ne:
Maav 0,192,64
Ve 8,192
Maav 0,196,68
s_add_u32 m0, s54, 49152
VE 9,193
Maav 32,192,72
buffer_load_dwordx4 v4, s[12:15], s39 offen offset:0 sc1 lds
Maav 32,196,76
s_cmp_eq_u32 s37, s52
Ra 224,2,20480
Vc 96,8,9
Maav 4,200,64
s_cbranch_scc1 L_pubB
L_pubBr:
VE 10,194
Maav 4,204,68
s_add_u32 s37, s37, 1
Ve 11,195
Maav 36,200,72
s_add_u32 s38, s38, 34816
Ra 228,2,28672
Vc 97,10,11
Maav 36,204,76
Ra 232,2,21504
v_or_b32_e64 v7, v96, v97
Mvvv 48,16,64
VE 12,208
Mvvv 48,16,68
s_waitcnt lgkmcnt(3)
Ra 236,2,29696
Ra 240,2,22528
Maav 8,208,64
buffer_load_dwordx4 v4, s[12:15], s39 offen offset:1024 sc1 lds
Maav 8,212,68
Ve 13,209
Maav 40,208,72
Ra 244,2,30720
Vc 104,12,13
Maav 40,212,76
VE 14,210
Maav 12,216,64
VE 15,211
Maav 12,220,68
Ra 248,2,23552
Vc 105,14,15
Maav 44,216,72
Ra 252,2,31744
v_or3_b32 v7, v7, v104, v105
Maav 44,220,76
VE 8,196
Mvvv 52,16,72
buffer_load_dwordx4 v4, s[12:15], s39 offen offset:2048 sc1 lds
Mvvv 52,16,76
s_waitcnt lgkmcnt(4)
Ve 9,197
Maav 16,224,64
Ra 192,3,0
Vc 98,8,9
Maav 16,228,68
VE 10,198
Maav 48,224,72
VE 11,199
Maav 48,228,76
Ra 196,3,1024
Vc 99,10,11
Maav 20,232,64
Ra 200,3,2048
v_or3_b32 v7, v7, v98, v99
Maav 20,236,68
Ra 204,3,3072
Ra 208,3,4096
Maav 52,232,72
buffer_load_dwordx4 v4, s[12:15], s39 offen offset:3072 sc1 lds
Maav 52,236,76
s_waitcnt lgkmcnt(5)
Ve 12,212
Maav 24,240,64
s_add_u32 s39, s39, 34816
VE 13,213
Maav 24,244,68
Ra 212,3,5120
Vc 106,12,13
Maav 56,240,72
VE 14,214
Maav 56,244,76
VE 15,215
Maav 28,248,64
Ra 216,3,6144
Vc 107,14,15
Maav 28,252,68
Ra 220,3,7168
v_or3_b32 v7, v7, v106, v107
Maav 60,248,72
s_waitcnt lgkmcnt(4)
Ve 8,200
Maav 60,252,76
VE 9,201
Cvaa 128,192,128,32
s_add_u32 m0, s53, 32768
Ra 224,3,8192
Vc 100,8,9
Mvaa 128,196,132
buffer_load_dwordx4 v4, s[12:15], s38 offen offset:0 sc1 lds
Mvaa 128,200,136
VE 10,202
Mvaa 128,204,140
VE 11,203
Cvaa 144,192,144,36
Ra 228,3,9216
Vc 101,10,11
Mvaa 144,196,148
Ra 232,3,10240
v_or3_b32 v7, v7, v100, v101
Mvaa 144,200,152
VE 12,216
Mvaa 144,204,156
s_waitcnt lgkmcnt(3)
Ra 236,3,11264
Ra 240,3,12288
Cvaa 132,208,128,32
buffer_load_dwordx4 v4, s[12:15], s38 offen offset:1024 sc1 lds
Mvaa 132,212,132
Ve 13,217
Mvaa 132,216,136
Ra 244,3,13312
Vc 108,12,13
Mvaa 132,220,140
VE 14,218
Cvaa 148,208,144,36
VE 15,219
Mvaa 148,212,148
buffer_load_dwordx4 v4, s[12:15], s38 offen offset:2048 sc1 lds
Mvaa 148,216,152
Ra 248,3,14336
Vc 109,14,15
Mvaa 148,220,156
s_waitcnt lgkmcnt(3)
Ra 252,3,15360
v_or3_b32 v7, v7, v108, v109
Cvaa 136,224,128,32
Ve 8,204
Mvaa 136,228,132
VE 9,205
Mvaa 136,232,136
Ra 192,2,49152
Vc 102,8,9
Mvaa 136,236,140
buffer_load_dwordx4 v4, s[12:15], s38 offen offset:3072 sc1 lds
Cvaa 152,224,144,36
VE 10,206
Mvaa 152,228,148
VE 11,207
Mvaa 152,232,152
Ra 196,2,57344
Vc 103,10,11
Mvaa 152,236,156
s_waitcnt lgkmcnt(2)
Ra 200,2,50176
Ra 204,2,58368
Cvaa 140,240,128,32
Ra 208,2,51200
v_or3_b32 v7, v7, v102, v103
Mvaa 140,244,132
s_cmp_lt_u32 s37, s52
VE 12,220
Mvaa 140,248,136
s_cbranch_scc1 L_nw_no
s_waitcnt vmcnt(12)
L_nw_no:
VE 13,221
Mvaa 140,252,140
Ra 212,2,59392
Vc 110,12,13
Cvaa 156,240,144,36
s_cmp_eq_u32 s37, s45
Ve 14,222
Mvaa 156,244,148
s_barrier
Ve 15,223
Mvaa 156,248,152
s_waitcnt lgkmcnt(2)
Ra 216,2,52224
Vc 111,14,15
v_or3_b32 v7, v7, v110, v111
v_and_b32 v1, 0x40004000, v7
v_cmp_ne_u32 vcc, 0, v1
Mvaa 156,252,156
s_cbranch_vccnz L_k2_fb_no
L_k2_fbr_no:
Ra 220,2,60416
Maav 0,192,96
s_cbranch_scc1 L_k2_mk_no
L_k2_mkr_no:
VE 8,128
Maav 0,196,100
s_add_u32 m0, s53, 16384
VE 9,129
Maav 32,192,104
buffer_load_dwordx4 v4, s[12:15], s39 offen offset:0 sc1 lds
Maav 32,196,108
s_add_u32 s37, s37, 1
Ra 224,2,53248
Vc 64,8,9
Maav 4,200,96
s_add_u32 s38, s38, 34816
Ve 10,130
Maav 4,204,100
s_xor_b32 s53, s53, 65536
VE 11,131
Maav 36,200,104
s_xor_b32 s54, s54, 65536
Ra 228,2,61440
Vc 65,10,11
Maav 36,204,108
Ra 232,2,54272
v_or_b32_e64 v7, v64, v65
Mvvv 48,16,96
VE 12,144
Mvvv 48,16,100
s_waitcnt lgkmcnt(3)
Ra 236,2,62464
Ra 240,2,55296
Maav 8,208,96
buffer_load_dwordx4 v4, s[12:15], s39 offen offset:1024 sc1 lds
Maav 8,212,100
Ve 13,145
Maav 40,208,104
Ra 244,2,63488
Vc 72,12,13
Maav 40,212,108
VE 14,146
Maav 12,216,96
VE 15,147
Maav 12,220,100
Ra 248,2,56320
Vc 73,14,15
Maav 44,216,104
Ra 252,2,64512
v_or3_b32 v7, v7, v72, v73
Maav 44,220,108
VE 8,132
Mvvv 52,16,104
buffer_load_dwordx4 v4, s[12:15], s39 offen offset:2048 sc1 lds
Mvvv 52,16,108
s_waitcnt lgkmcnt(4)
Ve 9,133
Maav 16,224,96
Ra 192,3,32768
Vc 66,8,9
Maav 16,228,100
VE 10,134
Maav 48,224,104
VE 11,135
Maav 48,228,108
Ra 196,3,33792
Vc 67,10,11
Maav 20,232,96
Ra 200,3,34816
v_or3_b32 v7, v7, v66, v67
Maav 20,236,100
Ra 204,3,35840
Ra 208,3,36864
Maav 52,232,104
buffer_load_dwordx4 v4, s[12:15], s39 offen offset:3072 sc1 lds
Maav 52,236,108
s_waitcnt lgkmcnt(5)
Ve 12,148
Maav 24,240,96
s_add_u32 s39, s39, 34816
VE 13,149
Maav 24,244,100
Ra 212,3,37888
Vc 74,12,13
Maav 56,240,104
VE 14,150
Maav 56,244,108
VE 15,151
Maav 28,248,96
Ra 216,3,38912
Vc 75,14,15
Maav 28,252,100
s_cmp_lg_u32 s37, s36
Ra 220,3,39936
v_or3_b32 v7, v7, v74, v75
Maav 60,248,104
s_waitcnt lgkmcnt(4)
VE 8,136
Maav 60,252,108
s_cbranch_scc1 L_k2_nloop
L_k2_fin:
v_xor_b32 v2, 65536, v2
v_xor_b32 v3, 65536, v3
s_lshr_b32 s3, s42, 4
s_mul_i32 s3, s3, 33792
s_and_b32 s47, s42, 15
s_lshl_b32 s47, s47, 4
s_add_u32 s3, s3, s47
v_mov_b32 v28, s3
s_lshr_b32 s3, s43, 4
s_mul_i32 s3, s3, 33792
s_and_b32 s47, s43, 15
s_lshl_b32 s47, s47, 4
s_add_u32 s3, s3, s47
v_mov_b32 v29, s3
v_lshrrev_b32 v24, 4, v0
v_and_b32 v25, 15, v0
v_cmp_eq_u32 vcc, 1, v25
s_lshl_b32 s3, s32, 4
v_add_u32 v26, s3, v24
v_cndmask_b32 v28, v28, v29, vcc
v_lshl_add_u32 v28, v24, 8, v28
v_mul_u32_u24 v26, 7168, v26
v_lshlrev_b32 v24, 1, v24
v_xor_b32 v24, v24, v25
v_xor_b32 v25, 8, v24
v_lshl_add_u32 v24, v24, 4, v26
v_lshl_add_u32 v25, v25, 4, v26
s_lshl_b32 s3, s92, 12
buffer_load_dwordx4 a[160:163], v28, s[20:23], s3 offen offset:0 sc1
buffer_load_dwordx4 a[164:167], v28, s[20:23], s3 offen offset:1024 sc1
buffer_load_dwordx4 a[168:171], v28, s[20:23], s3 offen offset:2048 sc1
buffer_load_dwordx4 a[172:175], v28, s[20:23], s3 offen offset:3072 sc1
Cvaa 192,192,128,32
s_add_u32 m0, s54, 0
s_add_u32 s3, s5, 0
Ve 9,137
Mvaa 192,196,132
buffer_load_dwordx4 v24, s[24:27], s3 offen offset:0 lds
Mvaa 192,200,136
Ra 224,2,40960
Ra 228,2,41984
Mvaa 192,204,140
s_waitcnt lgkmcnt(2)
Ra 232,2,43008
Ra 236,2,44032
Cvaa 196,208,128,32
s_add_u32 s3, s5, 27648
Ra 240,2,45056
Vc 68,8,9
Mvaa 196,212,132
buffer_load_dwordx4 v24, s[24:27], s3 offen offset:1024 lds
Mvaa 196,216,136
Ra 244,2,46080
Ra 248,2,47104
Mvaa 196,220,140
s_waitcnt lgkmcnt(3)
s_add_u32 s3, s5, 55296
Ra 252,2,48128
Ra 192,2,16384
Cvaa 200,224,128,32
buffer_load_dwordx4 v25, s[24:27], s3 offen offset:2048 lds
Mvaa 200,228,132
s_cmp_lt_u32 s37, s52
Ve 10,138
Mvaa 200,232,136
s_cbranch_scc1 L_nw_nl
s_waitcnt vmcnt(15)
L_nw_nl:
Ra 196,2,24576
Ra 200,2,17408
Mvaa 200,236,140
s_waitcnt lgkmcnt(3)
s_add_u32 s3, s5, 82944
Ra 204,2,25600
Ra 208,2,18432
Cvaa 204,240,128,32
buffer_load_dwordx4 v25, s[24:27], s3 offen offset:3072 lds
Mvaa 204,244,132
s_barrier
VE 11,139
Mvaa 204,248,136
s_waitcnt lgkmcnt(1)
Ra 212,2,26624
Vc 69,10,11
Ve 12,152
Ve 13,153
Ve 14,154
Ve 15,155
Ve 8,140
Ve 9,141
Ve 10,142
VE 11,143
Vc 76,12,13
Ve 12,156
Ve 13,157
Vc 77,14,15
Ve 14,158
Ve 15,159
Vc 70,8,9
Vc 71,10,11
Vc 78,12,13
Vc 79,14,15
v_or3_b32 v7, v7, v68, v69
v_or3_b32 v7, v7, v76, v77
v_or3_b32 v7, v7, v70, v71
v_or3_b32 v7, v7, v78, v79
v_and_b32 v1, 0x40004000, v7
v_cmp_ne_u32 vcc, 0, v1
Mvaa 204,252,140
s_cbranch_vccnz L_k2_fb_nl
L_k2_fbr_nl:
Ra 216,2,19456
Ra 220,2,27648
Maav 0,192,64
v_cmp_gt_i32 s[56:57], 0, v6
v_cmp_gt_i32 s[58:59], 1, v6
v_cmp_gt_i32 s[60:61], 2, v6
v_cmp_gt_i32 s[62:63], 3, v6
s_nop 3
s_nop 0
v_cndmask_b32 v192, v192, v20, s[56:57]
v_cndmask_b32 v193, v193, v20, s[58:59]
v_cndmask_b32 v194, v194, v20, s[60:61]
v_cndmask_b32 v195, v195, v20, s[62:63]
v_cmp_gt_i32 s[56:57], 16, v6
v_cmp_gt_i32 s[58:59], 17, v6
v_cmp_gt_i32 s[60:61], 18, v6
v_cmp_gt_i32 s[62:63], 19, v6
v_cndmask_b32 v196, v196, v20, s[56:57]
v_cndmask_b32 v197, v197, v20, s[58:59]
v_cndmask_b32 v198, v198, v20, s[60:61]
v_cndmask_b32 v199, v199, v20, s[62:63]
v_cmp_gt_i32 s[56:57], 32, v6
v_cmp_gt_i32 s[58:59], 33, v6
v_cmp_gt_i32 s[60:61], 34, v6
v_cmp_gt_i32 s[62:63], 35, v6
v_cndmask_b32 v200, v200, v20, s[56:57]
v_cndmask_b32 v201, v201, v20, s[58:59]
v_cndmask_b32 v202, v202, v20, s[60:61]
v_cndmask_b32 v203, v203, v20, s[62:63]
v_cmp_gt_i32 s[56:57], 48, v6
v_cmp_gt_i32 s[58:59], 49, v6
v_cmp_gt_i32 s[60:61], 50, v6
v_cmp_gt_i32 s[62:63], 51, v6
v_cndmask_b32 v204, v204, v20, s[56:57]
v_cndmask_b32 v205, v205, v20, s[58:59]
v_cndmask_b32 v206, v206, v20, s[60:61]
v_cndmask_b32 v207, v207, v20, s[62:63]
VE 8,192
Maav 0,196,68
s_add_u32 m0, s54, 16384
s_add_u32 s3, s5, 458752
VE 9,193
Maav 32,192,72
buffer_load_dwordx4 v24, s[24:27], s3 offen offset:0 lds
Maav 32,196,76
s_add_u32 s3, s5, 486400
Ra 224,2,20480
Vc 96,8,9
Maav 4,200,64
buffer_load_dwordx4 v24, s[24:27], s3 offen offset:1024 lds
Maav 4,204,68
s_mov_b32 s60, s8
s_and_b32 s61, s9, 0xffff
Ve 10,194
Maav 36,200,72
s_add_u32 s3, s5, 514048
VE 11,195
Maav 36,204,76
buffer_load_dwordx4 v25, s[24:27], s3 offen offset:2048 lds
Mvvv 48,16,64
s_mov_b32 s62, 7340032
Ra 228,2,28672
Vc 97,10,11
Mvvv 48,16,68
s_waitcnt lgkmcnt(2)
s_add_u32 s3, s5, 541696
Ra 232,2,21504
Ra 236,2,29696
Maav 8,208,64
buffer_load_dwordx4 v25, s[24:27], s3 offen offset:3072 lds
Maav 8,212,68
s_add_u32 m0, s54, 32768
s_add_u32 s3, s5, 0
Ra 240,2,22528
v_or_b32_e64 v7, v96, v97
Maav 40,208,72
buffer_load_dwordx4 v24, s[68:71], s3 offen offset:0 lds
Maav 40,212,76
s_mov_b32 s63, 0x20000
s_mov_b32 s56, s40
Ve 12,196
Maav 12,216,64
s_add_u32 s3, s5, 27648
VE 13,197
Maav 12,220,68
buffer_load_dwordx4 v24, s[68:71], s3 offen offset:1024 lds
Maav 44,216,72
s_and_b32 s57, s41, 0xffff
Ra 244,2,30720
Vc 98,12,13
Maav 44,220,76
s_add_u32 s3, s5, 55296
VE 14,198
Mvvv 52,16,72
buffer_load_dwordx4 v25, s[68:71], s3 offen offset:2048 lds
Mvvv 52,16,76
s_waitcnt lgkmcnt(2)
s_add_u32 s3, s5, 82944
Ra 248,2,23552
Ra 252,2,31744
Maav 16,224,64
buffer_load_dwordx4 v25, s[68:71], s3 offen offset:3072 lds
Maav 16,228,68
s_mov_b32 s58, 4194304
s_mov_b32 s59, 0x20000
Ve 15,199
Maav 48,224,72
s_add_u32 m0, s54, 49152
s_add_u32 s3, s5, 458752
Ra 192,2,49152
Vc 99,14,15
Maav 48,228,76
buffer_load_dwordx4 v24, s[68:71], s3 offen offset:0 lds
Maav 20,232,64
s_bfe_u32 s6, s2, 0x20001
Ra 196,2,57344
v_or3_b32 v7, v7, v98, v99
Maav 20,236,68
s_add_u32 s3, s5, 486400
Ra 200,2,50176
Ra 204,2,58368
Maav 52,232,72
buffer_load_dwordx4 v24, s[68:71], s3 offen offset:1024 lds
Maav 52,236,76
s_waitcnt lgkmcnt(4)
s_add_u32 s3, s5, 514048
Ve 8,200
Maav 24,240,64
buffer_load_dwordx4 v25, s[68:71], s3 offen offset:2048 lds
Maav 24,244,68
s_lshr_b32 s7, s34, 1
s_lshl_b32 s45, s7, 2
VE 9,201
Maav 56,240,72
s_add_u32 s3, s5, 541696
Ra 208,2,51200
Vc 100,8,9
Maav 56,244,76
buffer_load_dwordx4 v25, s[68:71], s3 offen offset:3072 lds
Maav 28,248,64
s_add_u32 s46, s45, s6
s_sub_u32 s46, 15, s46
VE 10,202
Maav 28,252,68
s_sub_u32 s45, 12, s45
Ra 212,2,59392
Ra 216,2,52224
Maav 60,248,72
s_waitcnt lgkmcnt(3)
Ra 220,2,60416
Ve 11,203
Ve 12,204
Ve 13,205
Ve 14,206
VE 15,207
Vc 101,10,11
Vc 102,12,13
Vc 103,14,15
v_or3_b32 v7, v7, v100, v101
v_or3_b32 v7, v7, v102, v103
Maav 60,252,76
s_add_u32 s45, s45, s6
v_and_b32 v1, 0x40004000, v7
v_cmp_ne_u32 vcc, 0, v1
s_cbranch_vccnz L_k2_fb_fi
L_k2_fbr_fi:
Maav 0,192,96
Ra 224,2,53248
Ra 228,2,61440
Maav 0,196,100
Ra 232,2,54272
Ra 236,2,62464
Maav 4,200,96
Ra 240,2,55296
Ra 244,2,63488
Maav 4,204,100
Ra 248,2,56320
Ra 252,2,64512
Mvvv 48,16,96
s_cmp_lt_u32 s7, 2
s_cselect_b32 s45, s46, s45
Mvvv 48,16,100
s_waitcnt lgkmcnt(8)
Maav 8,208,96
s_and_b32 s46, s2, 1
s_bfe_u32 s6, s2, 0x30003
s_lshl_b32 s6, s6, 1
Maav 8,212,100
s_add_u32 s46, s46, s6
s_mov_b32 s48, 0
s_mov_b32 s49, 15360
Maav 12,216,96
s_mov_b32 s50, 30720
s_mov_b32 s51, 46080
s_lshl_b32 s35, s32, 13
Maav 12,220,100
s_waitcnt lgkmcnt(4)
Maav 16,224,96
s_add_u32 s35, s35, 131072
s_and_b32 s52, s46, 1
s_lshl_b32 s37, s45, 20
Maav 16,228,100
s_lshl_b32 s7, s52, 19
s_add_u32 s37, s37, s7
s_add_u32 s37, s37, 46137344
Maav 20,232,96
s_lshr_b32 s7, s46, 1
s_lshl_b32 s7, s7, 8
s_lshl_b32 s6, s52, 22
Maav 20,236,100
s_waitcnt lgkmcnt(0)
Maav 24,240,96
s_add_u32 s6, s6, s7
s_add_u32 s12, s94, s6
s_addc_u32 s13, s95, 0
s_and_b32 s13, s13, 0xffff
Maav 24,244,100
s_mov_b32 s14, 0
s_mov_b32 s15, 0x20000
s_sub_u32 s14, 4194304, s7
Maav 28,248,96
s_mov_b32 s28, s94
s_and_b32 s29, s95, 0xffff
s_mov_b32 s30, 8388608
Maav 28,252,100
s_mov_b32 s31, 0x20000
s_lshl_b32 s7, s46, 7
s_lshl_b32 s36, s45, 18
s_nop 7
s_lshl_b32 s3, s55, 20
s_lshl_b32 s47, s33, 15
s_add_u32 s3, s3, s47
s_lshl_b32 s47, s32, 10
v_lshlrev_b32 v248, 4, v0
v_add_u32 v249, s47, v248
s_sub_u32 s47, 7168, s47
v_add_u32 v248, s47, v248
v_rcp_f32 v250, v48
v_rcp_f32 v252, v52
v_mov_b32 v251, v250
v_mov_b32_e64 v253, v252
Ar 240,32
Ar 241,33
Ar 242,34
Ar 243,35
Ar 244,36
Ar 245,37
Ar 246,38
Ar 247,39
v_pk_mul_f32 v[240:241], v[240:241], v[252:253]
v_pk_mul_f32 v[242:243], v[242:243], v[252:253]
v_pk_mul_f32 v[244:245], v[244:245], v[252:253]
v_pk_mul_f32 v[246:247], v[246:247], v[252:253]
Vc 28,240,241
Vc 29,242,243
Vc 30,244,245
Vc 31,246,247
buffer_store_dwordx4 v[28:31], v249, s[16:19], s3 offen sc1
Ar 240,0
Ar 241,1
Ar 242,2
Ar 243,3
Ar 244,4
Ar 245,5
Ar 246,6
Ar 247,7
v_pk_mul_f32 v[240:241], v[240:241], v[250:251]
v_pk_mul_f32 v[242:243], v[242:243], v[250:251]
v_pk_mul_f32 v[244:245], v[244:245], v[250:251]
v_pk_mul_f32 v[246:247], v[246:247], v[250:251]
Vc 24,240,241
Vc 25,242,243
Vc 26,244,245
Vc 27,246,247
buffer_store_dwordx4 v[24:27], v248, s[16:19], s3 offen sc1
s_add_u32 s3, s3, 8192
Ar 240,40
Ar 241,41
Ar 242,42
Ar 243,43
Ar 244,44
Ar 245,45
Ar 246,46
Ar 247,47
v_pk_mul_f32 v[240:241], v[240:241], v[252:253]
v_pk_mul_f32 v[242:243], v[242:243], v[252:253]
v_pk_mul_f32 v[244:245], v[244:245], v[252:253]
v_pk_mul_f32 v[246:247], v[246:247], v[252:253]
Vc 28,240,241
Vc 29,242,243
Vc 30,244,245
Vc 31,246,247
buffer_store_dwordx4 v[28:31], v249, s[16:19], s3 offen sc1
Ar 240,8
Ar 241,9
Ar 242,10
Ar 243,11
Ar 244,12
Ar 245,13
Ar 246,14
Ar 247,15
v_pk_mul_f32 v[240:241], v[240:241], v[250:251]
v_pk_mul_f32 v[242:243], v[242:243], v[250:251]
v_pk_mul_f32 v[244:245], v[244:245], v[250:251]
v_pk_mul_f32 v[246:247], v[246:247], v[250:251]
Vc 24,240,241
Vc 25,242,243
Vc 26,244,245
Vc 27,246,247
buffer_store_dwordx4 v[24:27], v248, s[16:19], s3 offen sc1
s_add_u32 s3, s3, 8192
Ar 240,48
Ar 241,49
Ar 242,50
Ar 243,51
Ar 244,52
Ar 245,53
Ar 246,54
Ar 247,55
v_pk_mul_f32 v[240:241], v[240:241], v[252:253]
v_pk_mul_f32 v[242:243], v[242:243], v[252:253]
v_pk_mul_f32 v[244:245], v[244:245], v[252:253]
v_pk_mul_f32 v[246:247], v[246:247], v[252:253]
Vc 28,240,241
Vc 29,242,243
Vc 30,244,245
Vc 31,246,247
buffer_store_dwordx4 v[28:31], v249, s[16:19], s3 offen sc1
Ar 240,16
Ar 241,17
Ar 242,18
Ar 243,19
Ar 244,20
Ar 245,21
Ar 246,22
Ar 247,23
v_pk_mul_f32 v[240:241], v[240:241], v[250:251]
v_pk_mul_f32 v[242:243], v[242:243], v[250:251]
v_pk_mul_f32 v[244:245], v[244:245], v[250:251]
v_pk_mul_f32 v[246:247], v[246:247], v[250:251]
Vc 24,240,241
Vc 25,242,243
Vc 26,244,245
Vc 27,246,247
buffer_store_dwordx4 v[24:27], v248, s[16:19], s3 offen sc1
s_add_u32 s3, s3, 8192
Ar 240,56
Ar 241,57
Ar 242,58
Ar 243,59
Ar 244,60
Ar 245,61
Ar 246,62
Ar 247,63
v_pk_mul_f32 v[240:241], v[240:241], v[252:253]
v_pk_mul_f32 v[242:243], v[242:243], v[252:253]
v_pk_mul_f32 v[244:245], v[244:245], v[252:253]
v_pk_mul_f32 v[246:247], v[246:247], v[252:253]
Vc 28,240,241
Vc 29,242,243
Vc 30,244,245
Vc 31,246,247
buffer_store_dwordx4 v[28:31], v249, s[16:19], s3 offen sc1
Ar 240,24
Ar 241,25
Ar 242,26
Ar 243,27
Ar 244,28
Ar 245,29
Ar 246,30
Ar 247,31
v_pk_mul_f32 v[240:241], v[240:241], v[250:251]
v_pk_mul_f32 v[242:243], v[242:243], v[250:251]
v_pk_mul_f32 v[244:245], v[244:245], v[250:251]
v_pk_mul_f32 v[246:247], v[246:247], v[250:251]
Vc 24,240,241
Vc 25,242,243
Vc 26,244,245
Vc 27,246,247
buffer_store_dwordx4 v[24:27], v248, s[16:19], s3 offen sc1
s_cmp_ge_u32 s93, 224
s_cbranch_scc1 L_noffn
v_lshrrev_b32 v24, 4, v0
v_bfe_u32 v25, v0, 2, 2
v_lshl_add_u32 v26, v24, 3, v25
v_lshlrev_b32 v26, 8, v26
v_and_b32 v27, 3, v0
v_lshl_add_u32 v26, v27, 3, v26
v_and_b32_e64 v27, 1, v24
v_lshl_add_u32 v25, v27, 2, v25
s_lshl_b32 s3, s32, 1
v_xor_b32 v25, s3, v25
v_lshl_add_u32 v26, v25, 5, v26
s_sub_u32 s3, s54, s44
v_add_u32 v26, s3, v26
v_xor_b32 v27, 32, v26
s_waitcnt vmcnt(8) lgkmcnt(0)
s_barrier
s_nop 0
ds_read_b64_tr_b16 v[128:129], v26 offset:0
ds_read_b64_tr_b16 v[130:131], v26 offset:1024
ds_read_b64_tr_b16 v[132:133], v27 offset:0
ds_read_b64_tr_b16 v[134:135], v27 offset:1024
ds_read_b64_tr_b16 v[136:137], v26 offset:8192
ds_read_b64_tr_b16 v[138:139], v26 offset:9216
ds_read_b64_tr_b16 v[140:141], v27 offset:8192
ds_read_b64_tr_b16 v[142:143], v27 offset:9216
ds_read_b64_tr_b16 v[144:145], v26 offset:16384
ds_read_b64_tr_b16 v[146:147], v26 offset:17408
ds_read_b64_tr_b16 v[148:149], v27 offset:16384
ds_read_b64_tr_b16 v[150:151], v27 offset:17408
ds_read_b64_tr_b16 v[152:153], v26 offset:24576
ds_read_b64_tr_b16 v[154:155], v26 offset:25600
ds_read_b64_tr_b16 v[156:157], v27 offset:24576
s_waitcnt lgkmcnt(9)
s_nop 0
ds_read_b64_tr_b16 v[158:159], v27 offset:25600
ds_read_b64_tr_b16 v[160:161], v26 offset:32768
ds_read_b64_tr_b16 v[162:163], v26 offset:33792
ds_read_b64_tr_b16 v[164:165], v27 offset:32768
ds_read_b64_tr_b16 v[166:167], v27 offset:33792
ds_read_b64_tr_b16 v[168:169], v26 offset:40960
s_waitcnt lgkmcnt(9)
s_nop 0
ds_read_b64_tr_b16 v[170:171], v26 offset:41984
ds_read_b64_tr_b16 v[172:173], v27 offset:40960
ds_read_b64_tr_b16 v[174:175], v27 offset:41984
ds_read_b64_tr_b16 v[176:177], v26 offset:49152
ds_read_b64_tr_b16 v[178:179], v26 offset:50176
ds_read_b64_tr_b16 v[180:181], v27 offset:49152
s_waitcnt lgkmcnt(9)
ds_read_b64_tr_b16 v[182:183], v27 offset:50176
ds_read_b64_tr_b16 v[184:185], v26 offset:57344
ds_read_b64_tr_b16 v[186:187], v26 offset:58368
ds_read_b64_tr_b16 v[188:189], v27 offset:57344
ds_read_b64_tr_b16 v[190:191], v27 offset:58368
v_and_b32 v25, 15, v0
v_mul_u32_u24 v28, 14336, v25
v_lshl_add_u32 v28, v24, 4, v28
v_mov_b32 v29, 2146435072
v_cmp_gt_u32 vcc, 2, v25
s_mul_i32 s3, s92, 57344
s_lshl_b32 s47, s4, 9
s_add_u32 s3, s3, s47
v_cndmask_b32 v28, v29, v28, vcc
s_lshl_b32 s47, s32, 7
s_add_u32 s3, s3, s47
s_add_u32 s3, s3, 6291456
Zvva 224,128,160
Zvva 228,132,160
Mvva 224,136,164
Mvva 228,140,164
Mvva 224,144,168
Mvva 228,148,168
Mvva 224,152,172
Mvva 228,156,172
s_waitcnt lgkmcnt(0)
Zvva 232,160,160
Zvva 236,164,160
Mvva 232,168,164
Mvva 236,172,164
Mvva 232,176,168
Mvva 236,180,168
Mvva 232,184,172
Mvva 236,188,172
L_noffn:
s_add_u32 s36, s36, s7
s_and_b32 s94, s7, 128
s_lshl_b32 s38, s45, 7
s_lshl_b32 s6, s52, 6
s_add_u32 s38, s38, s6
s_add_u32 s38, s38, 5300224
s_lshl_b32 s52, s32, 11
s_and_b32 s6, s32, 1
s_lshl_b32 s6, s6, 16
s_lshr_b32 s7, s32, 1
s_lshl_b32 s7, s7, 7
s_xor_b32 s7, s7, s94
s_xor_b32 s7, s7, 128
s_add_u32 s6, s6, s7
s_lshl_b32 s7, s32, 5
s_mov_b32 s68, s10
s_and_b32 s69, s11, 0xffff
s_mov_b32 s70, 4194304
s_mov_b32 s71, 0x20000
s_add_u32 s8, s66, s37
s_addc_u32 s9, s67, 0
s_and_b32 s9, s9, 0xffff
s_mov_b32 s10, 524288
s_mov_b32 s11, 0x20000
v_lshlrev_b32 v112, 4, v0
v_lshrrev_b32 v121, 4, v0
v_and_b32 v122, 7, v0
v_lshrrev_b32 v123, 3, v0
v_lshlrev_b32 v124, 1, v121
v_xor_b32 v124, v124, v122
v_lshlrev_b32_e64 v124, 4, v124
v_lshl_add_u32 v113, v123, 11, v124
v_add_u32 v114, s6, v113
v_lshrrev_b32 v124, 2, v0
v_bfe_u32 v126, v0, 3, 2
v_lshlrev_b32 v124, 7, v124
v_and_b32 v125, 3, v0
v_lshl_add_u32 v124, v125, 3, v124
v_lshl_add_u32 v115, v126, 5, v124
v_xor_b32 v116, 32, v115
v_xor_b32 v117, 64, v115
v_xor_b32 v118, 96, v115
v_add_u32 v120, s7, v123
v_lshlrev_b32 v119, 11, v120
v_lshl_add_u32 v119, v122, 4, v119
v_mov_b32 v126, 0
v_lshlrev_b32 v127, 2, v122
v_mov_b32 v24, 1
v_mul_u32_u24 v25, s65, v0
s_waitcnt vmcnt(0)
s_barrier
s_mov_b64 exec, 3
buffer_store_dword v24, v25, s[20:23], s64 offen sc1
s_mov_b64 exec, -1
s_cmp_lt_u32 s93, 224
s_cselect_b32 s3, s3, 8388608
s_add_u32 s7, s3, 28672
buffer_store_dwordx4 v[224:227], v28, s[20:23], s3 offen offset:0 sc1
buffer_store_dwordx4 v[228:231], v28, s[20:23], s3 offen offset:64 sc1
buffer_store_dwordx4 v[232:235], v28, s[20:23], s7 offen offset:0 sc1
buffer_store_dwordx4 v[236:239], v28, s[20:23], s7 offen offset:64 sc1
s_mov_b32 s3, s36
s_nop 0
buffer_load_dwordx4 v[18:21], v119, s[56:59], s3 offen
s_add_u32 s3, s3, 16384
buffer_load_dwordx4 v[22:25], v119, s[56:59], s3 offen
s_add_u32 s3, s3, 16384
buffer_load_dwordx4 v[26:29], v119, s[56:59], s3 offen
s_add_u32 s3, s3, 16384
buffer_load_dwordx4 v[30:33], v119, s[56:59], s3 offen
s_lshl_b32 s3, s45, 10
s_add_u32 s3, s3, 5259264
v_lshlrev_b32 v124, 3, v120
buffer_load_dwordx2 v[34:35], v124, s[20:23], s3 offen offset:0 sc1
buffer_load_dwordx2 v[36:37], v124, s[20:23], s3 offen offset:64 sc1
buffer_load_dwordx2 v[38:39], v124, s[20:23], s3 offen offset:128 sc1
buffer_load_dwordx2 v[40:41], v124, s[20:23], s3 offen offset:192 sc1
v_and_b32 v10, 15, v0
v_lshlrev_b32 v10, 2, v10
s_add_u32 s95, s32, 32
s_lshl_b32 s95, s95, 16
s_add_u32 s95, s95, s94
s_xor_b32 s95, s95, 128
s_add_u32 m0, s44, 0
s_nop 0
s_nop 0
buffer_load_dwordx4 v114, s[12:15], s48 offen offset:0 lds
buffer_load_dwordx4 v114, s[12:15], s49 offen offset:1024 lds
buffer_load_dwordx4 v114, s[12:15], s50 offen offset:2048 lds
buffer_load_dwordx4 v114, s[12:15], s51 offen offset:3072 lds
v_add_u32 v114, 131072, v114
s_add_u32 m0, s44, 16384
s_nop 0
s_nop 0
buffer_load_dwordx4 v114, s[12:15], s48 offen offset:0 lds
buffer_load_dwordx4 v114, s[12:15], s49 offen offset:1024 lds
buffer_load_dwordx4 v114, s[12:15], s50 offen offset:2048 lds
buffer_load_dwordx4 v114, s[12:15], s51 offen offset:3072 lds
v_add_u32 v114, 131072, v114
buffer_load_dword v124, v10, s[20:23], s38 offen sc1
v_add_u32 v12, 65536, v115
v_add_u32 v13, 65536, v116
v_add_u32 v14, 65536, v117
v_add_u32 v15, 65536, v118
s_and_b32 s39, s93, 15
s_lshr_b32 s37, s93, 4
s_lshl_b32 s54, s37, 2
s_add_u32 s54, s54, s32
s_lshl_b32 s3, s54, 17
s_lshl_b32 s7, s39, 7
s_add_u32 s3, s3, s7
s_cmp_lt_u32 s93, 224
s_cselect_b32 s3, s3, 2146435072
v_add_u32 v125, s3, v113
s_mov_b32 s40, 0
s_waitcnt vmcnt(9)
v_lshlrev_b32_e64 v42, 16, v18
v_and_b32 v43, 0xffff0000, v18
v_lshlrev_b32_e64 v44, 16, v19
v_and_b32 v45, 0xffff0000, v19
v_lshlrev_b32_e64 v46, 16, v20
v_and_b32 v47, 0xffff0000, v20
v_lshlrev_b32_e64 v48, 16, v21
v_and_b32 v49, 0xffff0000, v21
v_pk_add_f32 v[42:43], v[42:43], v[34:35] op_sel_hi:[1,0] neg_lo:[0,1] neg_hi:[0,1]
v_pk_add_f32 v[44:45], v[44:45], v[34:35] op_sel_hi:[1,0] neg_lo:[0,1] neg_hi:[0,1]
v_pk_add_f32 v[46:47], v[46:47], v[34:35] op_sel_hi:[1,0] neg_lo:[0,1] neg_hi:[0,1]
v_pk_add_f32 v[48:49], v[48:49], v[34:35] op_sel_hi:[1,0] neg_lo:[0,1] neg_hi:[0,1]
Vc 2,42,43
v_lshlrev_b32_e64 v42, 16, v2
v_and_b32 v43, 0xffff0000, v2
Vc 3,44,45
v_lshlrev_b32_e64 v44, 16, v3
v_and_b32 v45, 0xffff0000, v3
Vc 4,46,47
v_lshlrev_b32_e64 v46, 16, v4
v_and_b32 v47, 0xffff0000, v4
Vc 5,48,49
v_lshlrev_b32_e64 v48, 16, v5
v_and_b32 v49, 0xffff0000, v5
v_pk_mul_f32 v[42:43], v[42:43], v[34:35] op_sel:[0,1] op_sel_hi:[1,1]
v_pk_mul_f32 v[44:45], v[44:45], v[34:35] op_sel:[0,1] op_sel_hi:[1,1]
v_pk_mul_f32 v[46:47], v[46:47], v[34:35] op_sel:[0,1] op_sel_hi:[1,1]
v_pk_mul_f32 v[48:49], v[48:49], v[34:35] op_sel:[0,1] op_sel_hi:[1,1]
Vc 2,42,43
v_lshlrev_b32_e64 v42, 16, v2
v_and_b32 v43, 0xffff0000, v2
Vc 3,44,45
v_lshlrev_b32_e64 v44, 16, v3
v_and_b32 v45, 0xffff0000, v3
Vc 4,46,47
v_lshlrev_b32_e64 v46, 16, v4
v_and_b32 v47, 0xffff0000, v4
Vc 5,48,49
v_lshlrev_b32_e64 v48, 16, v5
v_and_b32 v49, 0xffff0000, v5
v_mul_f32 v2, 0xbfb8aa3b, v42
v_mul_f32 v3, 0xbfb8aa3b, v43
v_mul_f32 v4, 0xbfb8aa3b, v44
v_mul_f32 v5, 0xbfb8aa3b, v45
v_mul_f32 v6, 0xbfb8aa3b, v46
v_mul_f32 v7, 0xbfb8aa3b, v47
v_mul_f32 v8, 0xbfb8aa3b, v48
v_mul_f32 v9, 0xbfb8aa3b, v49
Ve 2,2
Ve 3,3
Ve 4,4
Ve 5,5
Ve 6,6
Ve 7,7
Ve 8,8
Ve 9,9
v_add_f32 v2, 1.0, v2
v_add_f32 v3, 1.0, v3
v_add_f32 v4, 1.0, v4
v_add_f32 v5, 1.0, v5
v_add_f32 v6, 1.0, v6
v_add_f32 v7, 1.0, v7
v_add_f32 v8, 1.0, v8
v_add_f32 v9, 1.0, v9
v_rcp_f32 v2, v2
v_rcp_f32 v3, v3
v_rcp_f32 v4, v4
v_rcp_f32 v5, v5
v_rcp_f32 v6, v6
v_rcp_f32 v7, v7
v_rcp_f32 v8, v8
v_rcp_f32 v9, v9
v_pk_mul_f32 v[42:43], v[42:43], v[2:3]
v_pk_mul_f32 v[44:45], v[44:45], v[4:5]
v_pk_mul_f32 v[46:47], v[46:47], v[6:7]
v_pk_mul_f32 v[48:49], v[48:49], v[8:9]
Vc 2,42,43
v_lshlrev_b32_e64 v42, 16, v2
v_and_b32 v43, 0xffff0000, v2
Vc 3,44,45
v_lshlrev_b32_e64 v44, 16, v3
v_and_b32 v45, 0xffff0000, v3
Vc 4,46,47
v_lshlrev_b32_e64 v46, 16, v4
v_and_b32 v47, 0xffff0000, v4
Vc 5,48,49
v_lshlrev_b32_e64 v48, 16, v5
v_and_b32 v49, 0xffff0000, v5
s_waitcnt vmcnt(0)
v_cmp_ne_u32 vcc, 1, v124
s_cbranch_vccnz L_spinC
s_nop 0
L_spinCr:
buffer_load_dwordx4 a[0:3], v112, s[8:11], s52 offen offset:0 sc1
buffer_load_dwordx4 a[4:7], v112, s[8:11], s52 offen offset:1024 sc1
s_add_u32 s52, s52, 8192
buffer_load_dwordx4 a[8:11], v112, s[8:11], s52 offen offset:0 sc1
buffer_load_dwordx4 a[12:15], v112, s[8:11], s52 offen offset:1024 sc1
s_add_u32 s52, s52, 8192
buffer_load_dwordx4 a[16:19], v112, s[8:11], s52 offen offset:0 sc1
buffer_load_dwordx4 a[20:23], v112, s[8:11], s52 offen offset:1024 sc1
s_add_u32 s52, s52, 8192
buffer_load_dwordx4 a[24:27], v112, s[8:11], s52 offen offset:0 sc1
buffer_load_dwordx4 a[28:31], v112, s[8:11], s52 offen offset:1024 sc1
s_add_u32 s52, s52, 8192
v_lshlrev_b32_e64 v50, 16, v22
v_and_b32 v51, 0xffff0000, v22
v_lshlrev_b32_e64 v52, 16, v23
v_and_b32 v53, 0xffff0000, v23
v_lshlrev_b32_e64 v54, 16, v24
v_and_b32 v55, 0xffff0000, v24
v_lshlrev_b32_e64 v56, 16, v25
v_and_b32 v57, 0xffff0000, v25
v_pk_add_f32 v[50:51], v[50:51], v[36:37] op_sel_hi:[1,0] neg_lo:[0,1] neg_hi:[0,1]
v_pk_add_f32 v[52:53], v[52:53], v[36:37] op_sel_hi:[1,0] neg_lo:[0,1] neg_hi:[0,1]
v_pk_add_f32 v[54:55], v[54:55], v[36:37] op_sel_hi:[1,0] neg_lo:[0,1] neg_hi:[0,1]
v_pk_add_f32 v[56:57], v[56:57], v[36:37] op_sel_hi:[1,0] neg_lo:[0,1] neg_hi:[0,1]
Vc 2,50,51
v_lshlrev_b32_e64 v50, 16, v2
v_and_b32 v51, 0xffff0000, v2
Vc 3,52,53
v_lshlrev_b32_e64 v52, 16, v3
v_and_b32 v53, 0xffff0000, v3
Vc 4,54,55
v_lshlrev_b32_e64 v54, 16, v4
v_and_b32 v55, 0xffff0000, v4
Vc 5,56,57
v_lshlrev_b32_e64 v56, 16, v5
v_and_b32 v57, 0xffff0000, v5
v_pk_mul_f32 v[50:51], v[50:51], v[36:37] op_sel:[0,1] op_sel_hi:[1,1]
v_pk_mul_f32 v[52:53], v[52:53], v[36:37] op_sel:[0,1] op_sel_hi:[1,1]
v_pk_mul_f32 v[54:55], v[54:55], v[36:37] op_sel:[0,1] op_sel_hi:[1,1]
v_pk_mul_f32 v[56:57], v[56:57], v[36:37] op_sel:[0,1] op_sel_hi:[1,1]
Vc 2,50,51
v_lshlrev_b32_e64 v50, 16, v2
v_and_b32 v51, 0xffff0000, v2
Vc 3,52,53
v_lshlrev_b32_e64 v52, 16, v3
v_and_b32 v53, 0xffff0000, v3
Vc 4,54,55
v_lshlrev_b32_e64 v54, 16, v4
v_and_b32 v55, 0xffff0000, v4
Vc 5,56,57
v_lshlrev_b32_e64 v56, 16, v5
v_and_b32 v57, 0xffff0000, v5
v_mul_f32 v2, 0xbfb8aa3b, v50
v_mul_f32 v3, 0xbfb8aa3b, v51
v_mul_f32 v4, 0xbfb8aa3b, v52
v_mul_f32 v5, 0xbfb8aa3b, v53
v_mul_f32 v6, 0xbfb8aa3b, v54
v_mul_f32 v7, 0xbfb8aa3b, v55
v_mul_f32 v8, 0xbfb8aa3b, v56
v_mul_f32 v9, 0xbfb8aa3b, v57
Ve 2,2
Ve 3,3
Ve 4,4
Ve 5,5
Ve 6,6
Ve 7,7
Ve 8,8
Ve 9,9
v_add_f32 v2, 1.0, v2
v_add_f32 v3, 1.0, v3
v_add_f32 v4, 1.0, v4
v_add_f32 v5, 1.0, v5
v_add_f32 v6, 1.0, v6
v_add_f32 v7, 1.0, v7
v_add_f32 v8, 1.0, v8
v_add_f32 v9, 1.0, v9
v_rcp_f32 v2, v2
v_rcp_f32 v3, v3
v_rcp_f32 v4, v4
v_rcp_f32 v5, v5
v_rcp_f32 v6, v6
v_rcp_f32 v7, v7
v_rcp_f32 v8, v8
v_rcp_f32 v9, v9
v_pk_mul_f32 v[50:51], v[50:51], v[2:3]
v_pk_mul_f32 v[52:53], v[52:53], v[4:5]
v_pk_mul_f32 v[54:55], v[54:55], v[6:7]
v_pk_mul_f32 v[56:57], v[56:57], v[8:9]
Vc 2,50,51
v_lshlrev_b32_e64 v50, 16, v2
v_and_b32 v51, 0xffff0000, v2
Vc 3,52,53
v_lshlrev_b32_e64 v52, 16, v3
v_and_b32 v53, 0xffff0000, v3
Vc 4,54,55
v_lshlrev_b32_e64 v54, 16, v4
v_and_b32 v55, 0xffff0000, v4
Vc 5,56,57
v_lshlrev_b32_e64 v56, 16, v5
v_and_b32 v57, 0xffff0000, v5
buffer_load_dwordx4 a[32:35], v112, s[8:11], s52 offen offset:0 sc1
buffer_load_dwordx4 a[36:39], v112, s[8:11], s52 offen offset:1024 sc1
s_add_u32 s52, s52, 8192
buffer_load_dwordx4 a[40:43], v112, s[8:11], s52 offen offset:0 sc1
buffer_load_dwordx4 a[44:47], v112, s[8:11], s52 offen offset:1024 sc1
s_add_u32 s52, s52, 8192
s_add_u32 m0, s44, 32768
s_nop 0
buffer_load_dwordx4 v114, s[12:15], s48 offen offset:0 lds
buffer_load_dwordx4 v114, s[12:15], s49 offen offset:1024 lds
buffer_load_dwordx4 v114, s[12:15], s50 offen offset:2048 lds
buffer_load_dwordx4 v114, s[12:15], s51 offen offset:3072 lds
v_add_u32 v114, 131072, v114
s_cmp_lg_u32 s40, 0
s_cbranch_scc1 L_nowd
s_add_u32 m0, s35, 0
s_nop 0
s_nop 0
buffer_load_dwordx4 v125, s[60:63], s48 offen offset:0 lds
buffer_load_dwordx4 v125, s[60:63], s49 offen offset:1024 lds
buffer_load_dwordx4 v125, s[60:63], s50 offen offset:2048 lds
buffer_load_dwordx4 v125, s[60:63], s51 offen offset:3072 lds
v_add_u32 v125, 65536, v125
s_add_u32 m0, s35, 4096
s_nop 0
buffer_load_dwordx4 v125, s[60:63], s48 offen offset:0 lds
buffer_load_dwordx4 v125, s[60:63], s49 offen offset:1024 lds
buffer_load_dwordx4 v125, s[60:63], s50 offen offset:2048 lds
buffer_load_dwordx4 v125, s[60:63], s51 offen offset:3072 lds
L_nowd:
s_cmp_lt_u32 s2, 128
s_cbranch_scc1 L_noc3
s_bfe_u32 s3, s2, 0x40003
s_lshl_b32 s3, s3, 2
s_add_u32 s3, s3, s32
s_lshl_b32 s3, s3, 15
s_and_b32 s7, s2, 1
s_lshl_b32 s7, s7, 22
s_add_u32 s3, s3, s7
s_add_u32 s3, s3, 384
v_and_b32 v1, 15, v0
v_lshlrev_b32 v1, 11, v1
v_lshrrev_b32_e64 v11, 5, v0
v_lshl_add_u32 v1, v11, 10, v1
buffer_load_dword v11, v1, s[28:31], s3 offen
L_noc3:
s_barrier
s_nop 0
ds_read_b64_tr_b16 v[192:193], v115 offset:0
ds_read_b64_tr_b16 v[194:195], v115 offset:2048
ds_read_b64_tr_b16 v[196:197], v116 offset:0
ds_read_b64_tr_b16 v[198:199], v116 offset:2048
ds_read_b64_tr_b16 v[200:201], v117 offset:0
ds_read_b64_tr_b16 v[202:203], v117 offset:2048
ds_read_b64_tr_b16 v[204:205], v118 offset:0
ds_read_b64_tr_b16 v[206:207], v118 offset:2048
ds_read_b64_tr_b16 v[208:209], v115 offset:4096
ds_read_b64_tr_b16 v[210:211], v115 offset:6144
ds_read_b64_tr_b16 v[212:213], v116 offset:4096
ds_read_b64_tr_b16 v[214:215], v116 offset:6144
ds_read_b64_tr_b16 v[216:217], v117 offset:4096
ds_read_b64_tr_b16 v[218:219], v117 offset:6144
ds_read_b64_tr_b16 v[220:221], v118 offset:4096
s_waitcnt lgkmcnt(9)
ds_read_b64_tr_b16 v[222:223], v118 offset:6144
s_waitcnt vmcnt(12)
Zvva 160,192,0
ds_read_b64_tr_b16 v[224:225], v115 offset:8192
ds_read_b64_tr_b16 v[226:227], v115 offset:10240
v_mov_b32 v125, 1
s_waitcnt lgkmcnt(8)
Mvva 160,208,8
s_lshl_b32 s6, s4, 3
s_add_u32 s6, s6, s92
s_lshl_b32 s6, s6, 2
Zvva 176,192,4
s_waitcnt lgkmcnt(6)
s_add_u32 m0, s44, 49152
ds_read_b64_tr_b16 v[240:241], v115 offset:12288
ds_read_b64_tr_b16 v[242:243], v115 offset:14336
Mvva 176,208,12
buffer_load_dwordx4 v114, s[12:15], s48 offen offset:0 lds
Zvva 164,196,0
ds_read_b64_tr_b16 v[228:229], v116 offset:8192
ds_read_b64_tr_b16 v[230:231], v116 offset:10240
Mvva 164,212,8
s_add_u32 s6, s6, 5447680
s_cmp_eq_u32 s32, 0
s_cselect_b32 s6, s6, s64
s_cmp_lt_u32 s93, 224
s_cselect_b32 s6, s6, 2146435072
Zvva 180,196,4
s_waitcnt lgkmcnt(8)
ds_read_b64_tr_b16 v[244:245], v116 offset:12288
ds_read_b64_tr_b16 v[246:247], v116 offset:14336
Mvva 180,212,12
buffer_load_dwordx4 v114, s[12:15], s49 offen offset:1024 lds
Zvva 168,200,0
ds_read_b64_tr_b16 v[232:233], v117 offset:8192
ds_read_b64_tr_b16 v[234:235], v117 offset:10240
Mvva 168,216,8
s_mov_b64 exec, 1
buffer_store_dword v125, v126, s[20:23], s6 offen sc1
s_mov_b64 exec, -1
Zvva 184,200,4
s_waitcnt lgkmcnt(10)
ds_read_b64_tr_b16 v[248:249], v117 offset:12288
ds_read_b64_tr_b16 v[250:251], v117 offset:14336
Mvva 184,216,12
buffer_load_dwordx4 v114, s[12:15], s50 offen offset:2048 lds
Zvva 172,204,0
ds_read_b64_tr_b16 v[236:237], v118 offset:8192
ds_read_b64_tr_b16 v[238:239], v118 offset:10240
Mvva 172,220,8
s_waitcnt lgkmcnt(10)
s_lshl_b32 s40, s45, 2
s_add_u32 s40, s40, s32
s_lshr_b32 s3, s42, 5
s_lshr_b32 s47, s43, 5
s_cmp_eq_u32 s3, s40
s_cselect_b32 s53, 1, 0
s_cmp_eq_u32 s47, s40
s_cselect_b32 s53, 1, s53
s_mov_b32 s40, 0
Zvva 188,204,4
s_barrier
ds_read_b64_tr_b16 v[252:253], v118 offset:12288
ds_read_b64_tr_b16 v[254:255], v118 offset:14336
Mvva 188,220,12
buffer_load_dwordx4 v114, s[12:15], s51 offen offset:3072 lds
v_add_u32 v114, 131072, v114
Zvva 128,224,0
ds_read_b64_tr_b16 v[192:193], v115 offset:16384
ds_read_b64_tr_b16 v[194:195], v115 offset:18432
Mvva 128,240,8
s_lshl_b32 s41, s46, 7
s_add_u32 s41, s41, 5449728
s_lshl_b32 s55, s46, 13
Zvva 144,224,4
s_waitcnt lgkmcnt(10)
ds_read_b64_tr_b16 v[208:209], v115 offset:20480
ds_read_b64_tr_b16 v[210:211], v115 offset:22528
Mvva 144,240,12
buffer_load_dwordx4 a[48:51], v112, s[8:11], s52 offen offset:0 sc1
Zvva 132,228,0
ds_read_b64_tr_b16 v[196:197], v116 offset:16384
ds_read_b64_tr_b16 v[198:199], v116 offset:18432
Mvva 132,244,8
s_add_u32 s55, s55, 5308416
s_add_u32 s16, s66, 88080384
s_addc_u32 s17, s67, 0
s_and_b32 s17, s17, 0xffff
Zvva 148,228,4
s_waitcnt lgkmcnt(10)
ds_read_b64_tr_b16 v[212:213], v116 offset:20480
ds_read_b64_tr_b16 v[214:215], v116 offset:22528
Mvva 148,244,12
buffer_load_dwordx4 a[52:55], v112, s[8:11], s52 offen offset:1024 sc1
s_add_u32 s52, s52, 8192
Zvva 136,232,0
ds_read_b64_tr_b16 v[200:201], v117 offset:16384
ds_read_b64_tr_b16 v[202:203], v117 offset:18432
Mvva 136,248,8
s_mov_b32 s18, 8388608
s_mov_b32 s19, 0x20000
s_lshl_b32 s24, s2, 2
Zvva 152,232,4
s_waitcnt lgkmcnt(10)
ds_read_b64_tr_b16 v[216:217], v117 offset:20480
ds_read_b64_tr_b16 v[218:219], v117 offset:22528
Mvva 152,248,12
buffer_load_dwordx4 a[56:59], v112, s[8:11], s52 offen offset:0 sc1
Zvva 140,236,0
ds_read_b64_tr_b16 v[204:205], v118 offset:16384
ds_read_b64_tr_b16 v[206:207], v118 offset:18432
Mvva 140,252,8
s_add_u32 s24, s24, s32
s_lshl_b32 s25, s24, 13
s_xor_b32 s26, s25, 32768
Zvva 156,236,4
s_waitcnt lgkmcnt(10)
ds_read_b64_tr_b16 v[220:221], v118 offset:20480
ds_read_b64_tr_b16 v[222:223], v118 offset:22528
Mvva 156,252,12
buffer_load_dwordx4 a[60:63], v112, s[8:11], s52 offen offset:1024 sc1
s_add_u32 s52, s52, 8192
s_waitcnt vmcnt(17)
Mvva 160,192,16
ds_read_b64_tr_b16 v[224:225], v115 offset:24576
ds_read_b64_tr_b16 v[226:227], v115 offset:26624
Mvva 160,208,24
s_lshl_b32 s24, s24, 2
s_xor_b32 s27, s24, 16
s_add_u32 s24, s24, 5452800
Mvva 176,192,20
s_waitcnt lgkmcnt(10)
s_add_u32 m0, s44, 65536
ds_read_b64_tr_b16 v[240:241], v115 offset:28672
ds_read_b64_tr_b16 v[242:243], v115 offset:30720
Mvva 176,208,28
buffer_load_dwordx4 v114, s[12:15], s48 offen offset:0 lds
Mvva 164,196,16
ds_read_b64_tr_b16 v[228:229], v116 offset:24576
ds_read_b64_tr_b16 v[230:231], v116 offset:26624
Mvva 164,212,24
s_add_u32 s27, s27, 5452800
v_lshlrev_b32 v58, 16, v26
v_and_b32 v59, 0xffff0000, v26
v_lshlrev_b32_e64 v60, 16, v27
v_and_b32 v61, 0xffff0000, v27
v_lshlrev_b32_e64 v62, 16, v28
Mvva 180,196,20
s_waitcnt lgkmcnt(10)
ds_read_b64_tr_b16 v[244:245], v116 offset:28672
ds_read_b64_tr_b16 v[246:247], v116 offset:30720
v_and_b32 v63, 0xffff0000, v28
Mvva 180,212,28
buffer_load_dwordx4 v114, s[12:15], s49 offen offset:1024 lds
Mvva 168,200,16
ds_read_b64_tr_b16 v[232:233], v117 offset:24576
ds_read_b64_tr_b16 v[234:235], v117 offset:26624
v_lshlrev_b32 v64, 16, v29
Mvva 168,216,24
v_and_b32 v65, 0xffff0000, v29
Vs 58,58,38
Vs 59,59,38
Vs 60,60,38
Vs 61,61,38
Mvva 184,200,20
s_waitcnt lgkmcnt(10)
ds_read_b64_tr_b16 v[248:249], v117 offset:28672
ds_read_b64_tr_b16 v[250:251], v117 offset:30720
Vs 62,62,38
Mvva 184,216,28
buffer_load_dwordx4 v114, s[12:15], s50 offen offset:2048 lds
Mvva 172,204,16
s_waitcnt vmcnt(12)
ds_read_b64_tr_b16 v[236:237], v118 offset:24576
ds_read_b64_tr_b16 v[238:239], v118 offset:26624
Vs 63,63,38
Mvva 172,220,24
s_waitcnt lgkmcnt(10)
Vs 64,64,38
v_sub_f32_e64 v65, v65, v38
Vc 2,58,59
v_lshlrev_b32_e64 v58, 16, v2
v_and_b32 v59, 0xffff0000, v2
Mvva 188,204,20
s_barrier
ds_read_b64_tr_b16 v[252:253], v118 offset:28672
ds_read_b64_tr_b16 v[254:255], v118 offset:30720
Vc 3,60,61
Mvva 188,220,28
buffer_load_dwordx4 v114, s[12:15], s51 offen offset:3072 lds
v_add_u32 v114, 131072, v114
Mvva 128,224,16
ds_read_b64_tr_b16 v[192:193], v115 offset:32768
ds_read_b64_tr_b16 v[194:195], v115 offset:34816
v_lshlrev_b32 v60, 16, v3
Mvva 128,240,24
v_and_b32 v61, 0xffff0000, v3
Vc 4,62,63
v_lshlrev_b32_e64 v62, 16, v4
v_and_b32 v63, 0xffff0000, v4
Vc 5,64,65
Mvva 144,224,20
s_waitcnt lgkmcnt(10)
ds_read_b64_tr_b16 v[208:209], v115 offset:36864
ds_read_b64_tr_b16 v[210:211], v115 offset:38912
v_lshlrev_b32 v64, 16, v5
Mvva 144,240,28
buffer_load_dwordx4 a[64:67], v112, s[8:11], s52 offen offset:0 sc1
Mvva 132,228,16
ds_read_b64_tr_b16 v[196:197], v116 offset:32768
ds_read_b64_tr_b16 v[198:199], v116 offset:34816
v_and_b32 v65, 0xffff0000, v5
Mvva 132,244,24
Vm 58,58,39
Vm 59,59,39
Vm 60,60,39
Vm 61,61,39
v_mul_f32_e64 v62, v62, v39
Mvva 148,228,20
s_waitcnt lgkmcnt(10)
ds_read_b64_tr_b16 v[212:213], v116 offset:36864
ds_read_b64_tr_b16 v[214:215], v116 offset:38912
Vm 63,63,39
Mvva 148,244,28
buffer_load_dwordx4 a[68:71], v112, s[8:11], s52 offen offset:1024 sc1
s_add_u32 s52, s52, 8192
Mvva 136,232,16
ds_read_b64_tr_b16 v[200:201], v117 offset:32768
ds_read_b64_tr_b16 v[202:203], v117 offset:34816
v_mul_f32_e64 v64, v64, v39
Mvva 136,248,24
v_mul_f32_e64 v65, v65, v39
Vc 2,58,59
v_lshlrev_b32_e64 v58, 16, v2
v_and_b32 v59, 0xffff0000, v2
Vc 3,60,61
Mvva 152,232,20
s_waitcnt lgkmcnt(10)
ds_read_b64_tr_b16 v[216:217], v117 offset:36864
ds_read_b64_tr_b16 v[218:219], v117 offset:38912
v_lshlrev_b32 v60, 16, v3
Mvva 152,248,28
buffer_load_dwordx4 a[72:75], v112, s[8:11], s52 offen offset:0 sc1
Mvva 140,236,16
ds_read_b64_tr_b16 v[204:205], v118 offset:32768
ds_read_b64_tr_b16 v[206:207], v118 offset:34816
v_and_b32 v61, 0xffff0000, v3
Mvva 140,252,24
Vc 4,62,63
v_lshlrev_b32_e64 v62, 16, v4
v_and_b32 v63, 0xffff0000, v4
Vc 5,64,65
v_lshlrev_b32_e64 v64, 16, v5
Mvva 156,236,20
s_waitcnt lgkmcnt(10)
ds_read_b64_tr_b16 v[220:221], v118 offset:36864
ds_read_b64_tr_b16 v[222:223], v118 offset:38912
v_and_b32 v65, 0xffff0000, v5
Mvva 156,252,28
buffer_load_dwordx4 a[76:79], v112, s[8:11], s52 offen offset:1024 sc1
s_add_u32 s52, s52, 8192
Mvva 160,192,32
ds_read_b64_tr_b16 v[224:225], v115 offset:40960
ds_read_b64_tr_b16 v[226:227], v115 offset:43008
v_mul_f32 v2, 0xbfb8aa3b, v58
Mvva 160,208,40
v_mul_f32 v3, 0xbfb8aa3b, v59
v_mul_f32 v4, 0xbfb8aa3b, v60
v_mul_f32 v5, 0xbfb8aa3b, v61
v_mul_f32 v6, 0xbfb8aa3b, v62
v_mul_f32 v7, 0xbfb8aa3b, v63
Mvva 176,192,36
s_waitcnt lgkmcnt(10)
s_add_u32 m0, s44, 81920
ds_read_b64_tr_b16 v[240:241], v115 offset:45056
ds_read_b64_tr_b16 v[242:243], v115 offset:47104
v_mul_f32 v8, 0xbfb8aa3b, v64
Mvva 176,208,44
buffer_load_dwordx4 v114, s[12:15], s48 offen offset:0 lds
Mvva 164,196,32
ds_read_b64_tr_b16 v[228:229], v116 offset:40960
ds_read_b64_tr_b16 v[230:231], v116 offset:43008
v_mul_f32 v9, 0xbfb8aa3b, v65
Mvva 164,212,40
Ve 2,2
Ve 3,3
Mvva 180,196,36
s_waitcnt lgkmcnt(10)
ds_read_b64_tr_b16 v[244:245], v116 offset:45056
ds_read_b64_tr_b16 v[246:247], v116 offset:47104
Mvva 180,212,44
buffer_load_dwordx4 v114, s[12:15], s49 offen offset:1024 lds
Mvva 168,200,32
ds_read_b64_tr_b16 v[232:233], v117 offset:40960
ds_read_b64_tr_b16 v[234:235], v117 offset:43008
Mvva 168,216,40
Ve 4,4
VE 5,5
Mvva 184,200,36
s_waitcnt lgkmcnt(10)
ds_read_b64_tr_b16 v[248:249], v117 offset:45056
ds_read_b64_tr_b16 v[250:251], v117 offset:47104
Mvva 184,216,44
buffer_load_dwordx4 v114, s[12:15], s50 offen offset:2048 lds
Mvva 172,204,32
s_waitcnt vmcnt(15)
ds_read_b64_tr_b16 v[236:237], v118 offset:40960
ds_read_b64_tr_b16 v[238:239], v118 offset:43008
Mvva 172,220,40
s_waitcnt lgkmcnt(10)
Ve 6,6
VE 7,7
Mvva 188,204,36
s_barrier
ds_read_b64_tr_b16 v[252:253], v118 offset:45056
ds_read_b64_tr_b16 v[254:255], v118 offset:47104
Mvva 188,220,44
buffer_load_dwordx4 v114, s[12:15], s51 offen offset:3072 lds
v_add_u32 v114, 131072, v114
Mvva 128,224,32
ds_read_b64_tr_b16 v[192:193], v115 offset:49152
ds_read_b64_tr_b16 v[194:195], v115 offset:51200
Mvva 128,240,40
Ve 8,8
Ve 9,9
v_add_f32 v2, 1.0, v2
Mvva 144,224,36
s_waitcnt lgkmcnt(10)
ds_read_b64_tr_b16 v[208:209], v115 offset:53248
ds_read_b64_tr_b16 v[210:211], v115 offset:55296
v_add_f32 v3, 1.0, v3
Mvva 144,240,44
buffer_load_dwordx4 a[80:83], v112, s[8:11], s52 offen offset:0 sc1
Mvva 132,228,32
ds_read_b64_tr_b16 v[196:197], v116 offset:49152
ds_read_b64_tr_b16 v[198:199], v116 offset:51200
v_add_f32_e64 v4, 1.0, v4
Mvva 132,244,40
v_add_f32 v5, 1.0, v5
v_add_f32 v6, 1.0, v6
v_add_f32 v7, 1.0, v7
v_add_f32 v8, 1.0, v8
v_add_f32_e64 v9, 1.0, v9
Mvva 148,228,36
s_waitcnt lgkmcnt(10)
ds_read_b64_tr_b16 v[212:213], v116 offset:53248
ds_read_b64_tr_b16 v[214:215], v116 offset:55296
Mvva 148,244,44
buffer_load_dwordx4 a[84:87], v112, s[8:11], s52 offen offset:1024 sc1
s_add_u32 s52, s52, 8192
Mvva 136,232,32
ds_read_b64_tr_b16 v[200:201], v117 offset:49152
ds_read_b64_tr_b16 v[202:203], v117 offset:51200
Mvva 136,248,40
v_rcp_f32 v2, v2
v_rcp_f32_e64 v3, v3
Mvva 152,232,36
s_waitcnt lgkmcnt(10)
ds_read_b64_tr_b16 v[216:217], v117 offset:53248
ds_read_b64_tr_b16 v[218:219], v117 offset:55296
Mvva 152,248,44
buffer_load_dwordx4 a[88:91], v112, s[8:11], s52 offen offset:0 sc1
Mvva 140,236,32
ds_read_b64_tr_b16 v[204:205], v118 offset:49152
ds_read_b64_tr_b16 v[206:207], v118 offset:51200
Mvva 140,252,40
v_rcp_f32 v4, v4
v_rcp_f32_e64 v5, v5
Mvva 156,236,36
s_waitcnt lgkmcnt(10)
ds_read_b64_tr_b16 v[220:221], v118 offset:53248
ds_read_b64_tr_b16 v[222:223], v118 offset:55296
Mvva 156,252,44
buffer_load_dwordx4 a[92:95], v112, s[8:11], s52 offen offset:1024 sc1
s_add_u32 s52, s52, 8192
s_waitcnt vmcnt(16)
Mvva 160,192,48
ds_read_b64_tr_b16 v[224:225], v115 offset:57344
ds_read_b64_tr_b16 v[226:227], v115 offset:59392
Mvva 160,208,56
v_rcp_f32 v6, v6
v_rcp_f32 v7, v7
Mvva 176,192,52
s_waitcnt lgkmcnt(10)
s_add_u32 m0, s44, 98304
ds_read_b64_tr_b16 v[240:241], v115 offset:61440
ds_read_b64_tr_b16 v[242:243], v115 offset:63488
Mvva 176,208,60
buffer_load_dwordx4 v114, s[12:15], s48 offen offset:0 lds
Mvva 164,196,48
ds_read_b64_tr_b16 v[228:229], v116 offset:57344
ds_read_b64_tr_b16 v[230:231], v116 offset:59392
Mvva 164,212,56
v_rcp_f32 v8, v8
v_rcp_f32 v9, v9
Vm 58,58,2
Mvva 180,196,52
s_waitcnt lgkmcnt(10)
ds_read_b64_tr_b16 v[244:245], v116 offset:61440
ds_read_b64_tr_b16 v[246:247], v116 offset:63488
Vm 59,59,3
Mvva 180,212,60
buffer_load_dwordx4 v114, s[12:15], s49 offen offset:1024 lds
Mvva 168,200,48
ds_read_b64_tr_b16 v[232:233], v117 offset:57344
ds_read_b64_tr_b16 v[234:235], v117 offset:59392
v_mul_f32_e64 v60, v60, v4
Mvva 168,216,56
Vm 61,61,5
Vm 62,62,6
Vm 63,63,7
Vm 64,64,8
v_mul_f32_e64 v65, v65, v9
Mvva 184,200,52
s_waitcnt lgkmcnt(10)
ds_read_b64_tr_b16 v[248:249], v117 offset:61440
ds_read_b64_tr_b16 v[250:251], v117 offset:63488
Vc 2,58,59
Mvva 184,216,60
buffer_load_dwordx4 v114, s[12:15], s50 offen offset:2048 lds
Mvva 172,204,48
s_waitcnt vmcnt(15)
ds_read_b64_tr_b16 v[236:237], v118 offset:57344
ds_read_b64_tr_b16 v[238:239], v118 offset:59392
v_lshlrev_b32_e64 v58, 16, v2
Mvva 172,220,56
s_waitcnt lgkmcnt(10)
v_and_b32 v59, 0xffff0000, v2
Vc 3,60,61
v_lshlrev_b32 v60, 16, v3
v_and_b32 v61, 0xffff0000, v3
Vc 4,62,63
Mvva 188,204,52
s_barrier
ds_read_b64_tr_b16 v[252:253], v118 offset:61440
ds_read_b64_tr_b16 v[254:255], v118 offset:63488
v_lshlrev_b32 v62, 16, v4
Mvva 188,220,60
buffer_load_dwordx4 v114, s[12:15], s51 offen offset:3072 lds
v_add_u32 v114, 131072, v114
Mvva 128,224,48
ds_read_b64_tr_b16 v[192:193], v12 offset:0
ds_read_b64_tr_b16 v[194:195], v12 offset:2048
v_and_b32 v63, 0xffff0000, v4
Mvva 128,240,56
Vc 5,64,65
v_lshlrev_b32_e64 v64, 16, v5
v_and_b32 v65, 0xffff0000, v5
v_lshlrev_b32_e64 v66, 16, v30
v_and_b32 v67, 0xffff0000, v30
Mvva 144,224,52
s_waitcnt lgkmcnt(10)
ds_read_b64_tr_b16 v[208:209], v12 offset:4096
ds_read_b64_tr_b16 v[210:211], v12 offset:6144
v_lshlrev_b32 v68, 16, v31
Mvva 144,240,60
buffer_load_dwordx4 a[96:99], v112, s[8:11], s52 offen offset:0 sc1
Mvva 132,228,48
ds_read_b64_tr_b16 v[196:197], v13 offset:0
ds_read_b64_tr_b16 v[198:199], v13 offset:2048
v_and_b32 v69, 0xffff0000, v31
Mvva 132,244,56
v_lshlrev_b32_e64 v70, 16, v32
v_and_b32 v71, 0xffff0000, v32
v_lshlrev_b32_e64 v72, 16, v33
v_and_b32 v73, 0xffff0000, v33
v_sub_f32_e64 v66, v66, v40
Mvva 148,228,52
s_waitcnt lgkmcnt(10)
ds_read_b64_tr_b16 v[212:213], v13 offset:4096
ds_read_b64_tr_b16 v[214:215], v13 offset:6144
Vs 67,67,40
Mvva 148,244,60
buffer_load_dwordx4 a[100:103], v112, s[8:11], s52 offen offset:1024 sc1
s_add_u32 s52, s52, 8192
Mvva 136,232,48
ds_read_b64_tr_b16 v[200:201], v14 offset:0
ds_read_b64_tr_b16 v[202:203], v14 offset:2048
v_sub_f32_e64 v68, v68, v40
Mvva 136,248,56
Vs 69,69,40
Vs 70,70,40
Vs 71,71,40
Vs 72,72,40
v_sub_f32_e64 v73, v73, v40
Mvva 152,232,52
s_waitcnt lgkmcnt(10)
ds_read_b64_tr_b16 v[216:217], v14 offset:4096
ds_read_b64_tr_b16 v[218:219], v14 offset:6144
Vc 2,66,67
Mvva 152,248,60
buffer_load_dwordx4 a[104:107], v112, s[8:11], s52 offen offset:0 sc1
Mvva 140,236,48
ds_read_b64_tr_b16 v[204:205], v15 offset:0
ds_read_b64_tr_b16 v[206:207], v15 offset:2048
v_lshlrev_b32 v66, 16, v2
Mvva 140,252,56
v_and_b32 v67, 0xffff0000, v2
Vc 3,68,69
v_lshlrev_b32_e64 v68, 16, v3
v_and_b32 v69, 0xffff0000, v3
Vc 4,70,71
Mvva 156,236,52
s_waitcnt lgkmcnt(10)
ds_read_b64_tr_b16 v[220:221], v15 offset:4096
ds_read_b64_tr_b16 v[222:223], v15 offset:6144
v_lshlrev_b32 v70, 16, v4
Mvva 156,252,60
buffer_load_dwordx4 a[108:111], v112, s[8:11], s52 offen offset:1024 sc1
s_add_u32 s52, s52, 8192
s_waitcnt vmcnt(16)
Mvva 160,192,64
ds_read_b64_tr_b16 v[224:225], v12 offset:8192
ds_read_b64_tr_b16 v[226:227], v12 offset:10240
v_and_b32 v71, 0xffff0000, v4
Mvva 160,208,72
s_cmp_lt_u32 s93, 224
s_cbranch_scc1 L_f2A
L_f2Ar:
Mvva 176,192,68
s_waitcnt lgkmcnt(10)
s_add_u32 m0, s44, 114688
ds_read_b64_tr_b16 v[240:241], v12 offset:12288
ds_read_b64_tr_b16 v[242:243], v12 offset:14336
Vc 5,72,73
Mvva 176,208,76
buffer_load_dwordx4 v114, s[12:15], s48 offen offset:0 lds
Mvva 164,196,64
ds_read_b64_tr_b16 v[228:229], v13 offset:8192
ds_read_b64_tr_b16 v[230:231], v13 offset:10240
v_lshlrev_b32 v72, 16, v5
Mvva 164,212,72
v_and_b32 v73, 0xffff0000, v5
Vm 66,66,41
Vm 67,67,41
Vm 68,68,41
Vm 69,69,41
Mvva 180,196,68
s_waitcnt lgkmcnt(10)
ds_read_b64_tr_b16 v[244:245], v13 offset:12288
ds_read_b64_tr_b16 v[246:247], v13 offset:14336
Vm 70,70,41
Mvva 180,212,76
buffer_load_dwordx4 v114, s[12:15], s49 offen offset:1024 lds
Mvva 168,200,64
ds_read_b64_tr_b16 v[232:233], v14 offset:8192
ds_read_b64_tr_b16 v[234:235], v14 offset:10240
v_mul_f32_e64 v71, v71, v41
Mvva 168,216,72
Vm 72,72,41
Vm 73,73,41
Vc 2,66,67
v_lshlrev_b32_e64 v66, 16, v2
v_and_b32 v67, 0xffff0000, v2
Mvva 184,200,68
s_waitcnt lgkmcnt(10)
ds_read_b64_tr_b16 v[248:249], v14 offset:12288
ds_read_b64_tr_b16 v[250:251], v14 offset:14336
Vc 3,68,69
Mvva 184,216,76
buffer_load_dwordx4 v114, s[12:15], s50 offen offset:2048 lds
Mvva 172,204,64
s_waitcnt vmcnt(15)
ds_read_b64_tr_b16 v[236:237], v15 offset:8192
ds_read_b64_tr_b16 v[238:239], v15 offset:10240
v_lshlrev_b32_e64 v68, 16, v3
Mvva 172,220,72
s_waitcnt lgkmcnt(10)
v_and_b32 v69, 0xffff0000, v3
Vc 4,70,71
v_lshlrev_b32 v70, 16, v4
v_and_b32 v71, 0xffff0000, v4
Vc 5,72,73
Mvva 188,204,68
s_barrier
ds_read_b64_tr_b16 v[252:253], v15 offset:12288
ds_read_b64_tr_b16 v[254:255], v15 offset:14336
v_lshlrev_b32 v72, 16, v5
Mvva 188,220,76
buffer_load_dwordx4 v114, s[12:15], s51 offen offset:3072 lds
v_add_u32 v114, 131072, v114
Mvva 128,224,64
ds_read_b64_tr_b16 v[192:193], v12 offset:16384
ds_read_b64_tr_b16 v[194:195], v12 offset:18432
v_and_b32 v73, 0xffff0000, v5
Mvva 128,240,72
v_mul_f32 v2, 0xbfb8aa3b, v66
v_mul_f32 v3, 0xbfb8aa3b, v67
v_mul_f32 v4, 0xbfb8aa3b, v68
v_mul_f32 v5, 0xbfb8aa3b, v69
v_mul_f32 v6, 0xbfb8aa3b, v70
Mvva 144,224,68
s_waitcnt lgkmcnt(10)
ds_read_b64_tr_b16 v[208:209], v12 offset:20480
ds_read_b64_tr_b16 v[210:211], v12 offset:22528
v_mul_f32 v7, 0xbfb8aa3b, v71
Mvva 144,240,76
buffer_load_dwordx4 a[112:115], v112, s[8:11], s52 offen offset:0 sc1
Mvva 132,228,64
ds_read_b64_tr_b16 v[196:197], v13 offset:16384
ds_read_b64_tr_b16 v[198:199], v13 offset:18432
v_mul_f32 v8, 0xbfb8aa3b, v72
Mvva 132,244,72
v_mul_f32 v9, 0xbfb8aa3b, v73
Ve 2,2
VE 3,3
Mvva 148,228,68
s_waitcnt lgkmcnt(10)
ds_read_b64_tr_b16 v[212:213], v13 offset:20480
ds_read_b64_tr_b16 v[214:215], v13 offset:22528
Mvva 148,244,76
buffer_load_dwordx4 a[116:119], v112, s[8:11], s52 offen offset:1024 sc1
s_add_u32 s52, s52, 8192
Mvva 136,232,64
ds_read_b64_tr_b16 v[200:201], v14 offset:16384
ds_read_b64_tr_b16 v[202:203], v14 offset:18432
Mvva 136,248,72
Ve 4,4
VE 5,5
Mvva 152,232,68
s_waitcnt lgkmcnt(10)
ds_read_b64_tr_b16 v[216:217], v14 offset:20480
ds_read_b64_tr_b16 v[218:219], v14 offset:22528
Mvva 152,248,76
buffer_load_dwordx4 a[120:123], v112, s[8:11], s52 offen offset:0 sc1
Mvva 140,236,64
ds_read_b64_tr_b16 v[204:205], v15 offset:16384
ds_read_b64_tr_b16 v[206:207], v15 offset:18432
Mvva 140,252,72
Ve 6,6
VE 7,7
Mvva 156,236,68
s_waitcnt lgkmcnt(10)
ds_read_b64_tr_b16 v[220:221], v15 offset:20480
ds_read_b64_tr_b16 v[222:223], v15 offset:22528
Mvva 156,252,76
buffer_load_dwordx4 a[124:127], v112, s[8:11], s52 offen offset:1024 sc1
s_add_u32 s52, s52, 8192
s_waitcnt vmcnt(16)
Mvva 160,192,80
ds_read_b64_tr_b16 v[224:225], v12 offset:24576
ds_read_b64_tr_b16 v[226:227], v12 offset:26624
Mvva 160,208,88
Ve 8,8
Ve 9,9
v_add_f32_e64 v2, 1.0, v2
Mvva 176,192,84
s_waitcnt lgkmcnt(10)
s_add_u32 m0, s44, 0
ds_read_b64_tr_b16 v[240:241], v12 offset:28672
ds_read_b64_tr_b16 v[242:243], v12 offset:30720
v_add_f32_e64 v3, 1.0, v3
Mvva 176,208,92
buffer_load_dwordx4 v114, s[12:15], s48 offen offset:0 lds
Mvva 164,196,80
ds_read_b64_tr_b16 v[228:229], v13 offset:24576
ds_read_b64_tr_b16 v[230:231], v13 offset:26624
v_add_f32_e64 v4, 1.0, v4
Mvva 164,212,88
v_add_f32 v5, 1.0, v5
v_add_f32 v6, 1.0, v6
v_add_f32 v7, 1.0, v7
v_add_f32 v8, 1.0, v8
v_add_f32_e64 v9, 1.0, v9
Mvva 180,196,84
s_waitcnt lgkmcnt(10)
ds_read_b64_tr_b16 v[244:245], v13 offset:28672
ds_read_b64_tr_b16 v[246:247], v13 offset:30720
Mvva 180,212,92
buffer_load_dwordx4 v114, s[12:15], s49 offen offset:1024 lds
Mvva 168,200,80
ds_read_b64_tr_b16 v[232:233], v14 offset:24576
ds_read_b64_tr_b16 v[234:235], v14 offset:26624
Mvva 168,216,88
v_rcp_f32 v2, v2
v_rcp_f32_e64 v3, v3
Mvva 184,200,84
s_waitcnt lgkmcnt(10)
ds_read_b64_tr_b16 v[248:249], v14 offset:28672
ds_read_b64_tr_b16 v[250:251], v14 offset:30720
Mvva 184,216,92
buffer_load_dwordx4 v114, s[12:15], s50 offen offset:2048 lds
Mvva 172,204,80
s_waitcnt vmcnt(15)
ds_read_b64_tr_b16 v[236:237], v15 offset:24576
ds_read_b64_tr_b16 v[238:239], v15 offset:26624
Mvva 172,220,88
s_waitcnt lgkmcnt(10)
v_rcp_f32 v4, v4
v_rcp_f32_e64 v5, v5
Mvva 188,204,84
s_barrier
ds_read_b64_tr_b16 v[252:253], v15 offset:28672
ds_read_b64_tr_b16 v[254:255], v15 offset:30720
Mvva 188,220,92
buffer_load_dwordx4 v114, s[12:15], s51 offen offset:3072 lds
v_add_u32 v114, 131072, v114
Mvva 128,224,80
ds_read_b64_tr_b16 v[192:193], v12 offset:32768
ds_read_b64_tr_b16 v[194:195], v12 offset:34816
Mvva 128,240,88
v_rcp_f32 v6, v6
v_rcp_f32_e64 v7, v7
Mvva 144,224,84
s_waitcnt lgkmcnt(10)
ds_read_b64_tr_b16 v[208:209], v12 offset:36864
ds_read_b64_tr_b16 v[210:211], v12 offset:38912
Mvva 144,240,92
buffer_load_dwordx4 a[128:131], v112, s[8:11], s52 offen offset:0 sc1
Mvva 132,228,80
ds_read_b64_tr_b16 v[196:197], v13 offset:32768
ds_read_b64_tr_b16 v[198:199], v13 offset:34816
Mvva 132,244,88
v_rcp_f32 v8, v8
v_rcp_f32 v9, v9
Vm 66,66,2
Mvva 148,228,84
s_waitcnt lgkmcnt(10)
ds_read_b64_tr_b16 v[212:213], v13 offset:36864
ds_read_b64_tr_b16 v[214:215], v13 offset:38912
Vm 67,67,3
Mvva 148,244,92
buffer_load_dwordx4 a[132:135], v112, s[8:11], s52 offen offset:1024 sc1
s_add_u32 s52, s52, 8192
Mvva 136,232,80
ds_read_b64_tr_b16 v[200:201], v14 offset:32768
ds_read_b64_tr_b16 v[202:203], v14 offset:34816
v_mul_f32_e64 v68, v68, v4
Mvva 136,248,88
Vm 69,69,5
Vm 70,70,6
Vm 71,71,7
Vm 72,72,8
v_mul_f32_e64 v73, v73, v9
Mvva 152,232,84
s_waitcnt lgkmcnt(10)
ds_read_b64_tr_b16 v[216:217], v14 offset:36864
ds_read_b64_tr_b16 v[218:219], v14 offset:38912
Vc 2,66,67
Mvva 152,248,92
buffer_load_dwordx4 a[136:139], v112, s[8:11], s52 offen offset:0 sc1
Mvva 140,236,80
ds_read_b64_tr_b16 v[204:205], v15 offset:32768
ds_read_b64_tr_b16 v[206:207], v15 offset:34816
v_lshlrev_b32 v66, 16, v2
Mvva 140,252,88
v_and_b32 v67, 0xffff0000, v2
Vc 3,68,69
v_lshlrev_b32_e64 v68, 16, v3
v_and_b32 v69, 0xffff0000, v3
Vc 4,70,71
Mvva 156,236,84
s_waitcnt lgkmcnt(10)
ds_read_b64_tr_b16 v[220:221], v15 offset:36864
ds_read_b64_tr_b16 v[222:223], v15 offset:38912
v_lshlrev_b32 v70, 16, v4
Mvva 156,252,92
buffer_load_dwordx4 a[140:143], v112, s[8:11], s52 offen offset:1024 sc1
s_add_u32 s52, s52, 8192
s_waitcnt vmcnt(16)
Mvva 160,192,96
ds_read_b64_tr_b16 v[224:225], v12 offset:40960
ds_read_b64_tr_b16 v[226:227], v12 offset:43008
v_and_b32 v71, 0xffff0000, v4
Mvva 160,208,104
Vc 5,72,73
v_lshlrev_b32 v72, 16, v5
v_and_b32 v73, 0xffff0000, v5
Mvva 176,192,100
s_waitcnt lgkmcnt(10)
s_add_u32 m0, s44, 16384
ds_read_b64_tr_b16 v[240:241], v12 offset:45056
ds_read_b64_tr_b16 v[242:243], v12 offset:47104
Mvva 176,208,108
buffer_load_dwordx4 v114, s[12:15], s48 offen offset:0 lds
Mvva 164,196,96
ds_read_b64_tr_b16 v[228:229], v13 offset:40960
ds_read_b64_tr_b16 v[230:231], v13 offset:43008
Mvva 164,212,104
Mvva 180,196,100
s_waitcnt lgkmcnt(10)
ds_read_b64_tr_b16 v[244:245], v13 offset:45056
ds_read_b64_tr_b16 v[246:247], v13 offset:47104
Mvva 180,212,108
buffer_load_dwordx4 v114, s[12:15], s49 offen offset:1024 lds
Mvva 168,200,96
ds_read_b64_tr_b16 v[232:233], v14 offset:40960
ds_read_b64_tr_b16 v[234:235], v14 offset:43008
Mvva 168,216,104
Mvva 184,200,100
s_waitcnt lgkmcnt(10)
ds_read_b64_tr_b16 v[248:249], v14 offset:45056
ds_read_b64_tr_b16 v[250:251], v14 offset:47104
Mvva 184,216,108
buffer_load_dwordx4 v114, s[12:15], s50 offen offset:2048 lds
Mvva 172,204,96
s_waitcnt vmcnt(15)
ds_read_b64_tr_b16 v[236:237], v15 offset:40960
ds_read_b64_tr_b16 v[238:239], v15 offset:43008
Mvva 172,220,104
s_waitcnt lgkmcnt(10)
s_cmp_lt_u32 s93, 224
s_cbranch_scc1 L_f2B
L_f2Br:
Mvva 188,204,100
s_barrier
ds_read_b64_tr_b16 v[252:253], v15 offset:45056
ds_read_b64_tr_b16 v[254:255], v15 offset:47104
Mvva 188,220,108
buffer_load_dwordx4 v114, s[12:15], s51 offen offset:3072 lds
v_add_u32 v114, 131072, v114
Mvva 128,224,96
ds_read_b64_tr_b16 v[192:193], v12 offset:49152
ds_read_b64_tr_b16 v[194:195], v12 offset:51200
Mvva 128,240,104
Mvva 144,224,100
s_waitcnt lgkmcnt(10)
ds_read_b64_tr_b16 v[208:209], v12 offset:53248
ds_read_b64_tr_b16 v[210:211], v12 offset:55296
Mvva 144,240,108
buffer_load_dwordx4 a[144:147], v112, s[8:11], s52 offen offset:0 sc1
Mvva 132,228,96
ds_read_b64_tr_b16 v[196:197], v13 offset:49152
ds_read_b64_tr_b16 v[198:199], v13 offset:51200
Mvva 132,244,104
Mvva 148,228,100
s_waitcnt lgkmcnt(10)
ds_read_b64_tr_b16 v[212:213], v13 offset:53248
ds_read_b64_tr_b16 v[214:215], v13 offset:55296
Mvva 148,244,108
buffer_load_dwordx4 a[148:151], v112, s[8:11], s52 offen offset:1024 sc1
s_add_u32 s52, s52, 8192
Mvva 136,232,96
ds_read_b64_tr_b16 v[200:201], v14 offset:49152
ds_read_b64_tr_b16 v[202:203], v14 offset:51200
Mvva 136,248,104
Mvva 152,232,100
s_waitcnt lgkmcnt(10)
ds_read_b64_tr_b16 v[216:217], v14 offset:53248
ds_read_b64_tr_b16 v[218:219], v14 offset:55296
Mvva 152,248,108
buffer_load_dwordx4 a[152:155], v112, s[8:11], s52 offen offset:0 sc1
Mvva 140,236,96
ds_read_b64_tr_b16 v[204:205], v15 offset:49152
ds_read_b64_tr_b16 v[206:207], v15 offset:51200
Mvva 140,252,104
Mvva 156,236,100
s_waitcnt lgkmcnt(10)
ds_read_b64_tr_b16 v[220:221], v15 offset:53248
ds_read_b64_tr_b16 v[222:223], v15 offset:55296
Mvva 156,252,108
buffer_load_dwordx4 a[156:159], v112, s[8:11], s52 offen offset:1024 sc1
s_add_u32 s52, s52, 8192
s_waitcnt vmcnt(16)
Mvva 160,192,112
ds_read_b64_tr_b16 v[224:225], v12 offset:57344
ds_read_b64_tr_b16 v[226:227], v12 offset:59392
Mvva 160,208,120
Mvva 176,192,116
s_waitcnt lgkmcnt(10)
s_add_u32 m0, s44, 32768
ds_read_b64_tr_b16 v[240:241], v12 offset:61440
ds_read_b64_tr_b16 v[242:243], v12 offset:63488
Mvva 176,208,124
buffer_load_dwordx4 v114, s[12:15], s48 offen offset:0 lds
Mvva 164,196,112
ds_read_b64_tr_b16 v[228:229], v13 offset:57344
ds_read_b64_tr_b16 v[230:231], v13 offset:59392
Mvva 164,212,120
Mvva 180,196,116
s_waitcnt lgkmcnt(10)
ds_read_b64_tr_b16 v[244:245], v13 offset:61440
ds_read_b64_tr_b16 v[246:247], v13 offset:63488
Mvva 180,212,124
buffer_load_dwordx4 v114, s[12:15], s49 offen offset:1024 lds
Mvva 168,200,112
ds_read_b64_tr_b16 v[232:233], v14 offset:57344
ds_read_b64_tr_b16 v[234:235], v14 offset:59392
Mvva 168,216,120
Mvva 184,200,116
s_waitcnt lgkmcnt(10)
ds_read_b64_tr_b16 v[248:249], v14 offset:61440
ds_read_b64_tr_b16 v[250:251], v14 offset:63488
Mvva 184,216,124
buffer_load_dwordx4 v114, s[12:15], s50 offen offset:2048 lds
Mvva 172,204,112
s_waitcnt vmcnt(15)
ds_read_b64_tr_b16 v[236:237], v15 offset:57344
ds_read_b64_tr_b16 v[238:239], v15 offset:59392
Mvva 172,220,120
s_waitcnt lgkmcnt(10)
Mvva 188,204,116
s_barrier
ds_read_b64_tr_b16 v[252:253], v15 offset:61440
ds_read_b64_tr_b16 v[254:255], v15 offset:63488
Mvva 188,220,124
buffer_load_dwordx4 v114, s[12:15], s51 offen offset:3072 lds
v_add_u32 v114, 131072, v114
Mvva 128,224,112
ds_read_b64_tr_b16 v[192:193], v115 offset:0
ds_read_b64_tr_b16 v[194:195], v115 offset:2048
Mvva 128,240,120
Mvva 144,224,116
s_waitcnt lgkmcnt(10)
ds_read_b64_tr_b16 v[208:209], v115 offset:4096
ds_read_b64_tr_b16 v[210:211], v115 offset:6144
Mvva 144,240,124
buffer_load_dwordx4 a[160:163], v112, s[8:11], s52 offen offset:0 sc1
Mvva 132,228,112
ds_read_b64_tr_b16 v[196:197], v116 offset:0
ds_read_b64_tr_b16 v[198:199], v116 offset:2048
Mvva 132,244,120
Mvva 148,228,116
s_waitcnt lgkmcnt(10)
ds_read_b64_tr_b16 v[212:213], v116 offset:4096
ds_read_b64_tr_b16 v[214:215], v116 offset:6144
Mvva 148,244,124
buffer_load_dwordx4 a[164:167], v112, s[8:11], s52 offen offset:1024 sc1
s_add_u32 s52, s52, 8192
Mvva 136,232,112
ds_read_b64_tr_b16 v[200:201], v117 offset:0
ds_read_b64_tr_b16 v[202:203], v117 offset:2048
Mvva 136,248,120
Mvva 152,232,116
s_waitcnt lgkmcnt(10)
ds_read_b64_tr_b16 v[216:217], v117 offset:4096
ds_read_b64_tr_b16 v[218:219], v117 offset:6144
Mvva 152,248,124
buffer_load_dwordx4 a[168:171], v112, s[8:11], s52 offen offset:0 sc1
Mvva 140,236,112
ds_read_b64_tr_b16 v[204:205], v118 offset:0
ds_read_b64_tr_b16 v[206:207], v118 offset:2048
Mvva 140,252,120
Mvva 156,236,116
s_waitcnt lgkmcnt(10)
ds_read_b64_tr_b16 v[220:221], v118 offset:4096
ds_read_b64_tr_b16 v[222:223], v118 offset:6144
Mvva 156,252,124
buffer_load_dwordx4 a[172:175], v112, s[8:11], s52 offen offset:1024 sc1
s_add_u32 s52, s52, 8192
s_waitcnt vmcnt(16)
Mvva 160,192,128
ds_read_b64_tr_b16 v[224:225], v115 offset:8192
ds_read_b64_tr_b16 v[226:227], v115 offset:10240
Mvva 160,208,136
Mvva 176,192,132
s_waitcnt lgkmcnt(10)
s_add_u32 m0, s44, 49152
ds_read_b64_tr_b16 v[240:241], v115 offset:12288
ds_read_b64_tr_b16 v[242:243], v115 offset:14336
Mvva 176,208,140
buffer_load_dwordx4 v114, s[12:15], s48 offen offset:0 lds
Mvva 164,196,128
ds_read_b64_tr_b16 v[228:229], v116 offset:8192
ds_read_b64_tr_b16 v[230:231], v116 offset:10240
Mvva 164,212,136
Mvva 180,196,132
s_waitcnt lgkmcnt(10)
ds_read_b64_tr_b16 v[244:245], v116 offset:12288
ds_read_b64_tr_b16 v[246:247], v116 offset:14336
Mvva 180,212,140
buffer_load_dwordx4 v114, s[12:15], s49 offen offset:1024 lds
Mvva 168,200,128
ds_read_b64_tr_b16 v[232:233], v117 offset:8192
ds_read_b64_tr_b16 v[234:235], v117 offset:10240
Mvva 168,216,136
Mvva 184,200,132
s_waitcnt lgkmcnt(10)
ds_read_b64_tr_b16 v[248:249], v117 offset:12288
ds_read_b64_tr_b16 v[250:251], v117 offset:14336
Mvva 184,216,140
buffer_load_dwordx4 v114, s[12:15], s50 offen offset:2048 lds
Mvva 172,204,128
s_waitcnt vmcnt(15)
ds_read_b64_tr_b16 v[236:237], v118 offset:8192
ds_read_b64_tr_b16 v[238:239], v118 offset:10240
Mvva 172,220,136
s_waitcnt lgkmcnt(10)
Mvva 188,204,132
s_barrier
ds_read_b64_tr_b16 v[252:253], v118 offset:12288
ds_read_b64_tr_b16 v[254:255], v118 offset:14336
Mvva 188,220,140
buffer_load_dwordx4 v114, s[12:15], s51 offen offset:3072 lds
v_add_u32 v114, 131072, v114
Mvva 128,224,128
ds_read_b64_tr_b16 v[192:193], v115 offset:16384
ds_read_b64_tr_b16 v[194:195], v115 offset:18432
Mvva 128,240,136
Mvva 144,224,132
s_waitcnt lgkmcnt(10)
ds_read_b64_tr_b16 v[208:209], v115 offset:20480
ds_read_b64_tr_b16 v[210:211], v115 offset:22528
Mvva 144,240,140
buffer_load_dwordx4 a[176:179], v112, s[8:11], s52 offen offset:0 sc1
Mvva 132,228,128
ds_read_b64_tr_b16 v[196:197], v116 offset:16384
ds_read_b64_tr_b16 v[198:199], v116 offset:18432
Mvva 132,244,136
Mvva 148,228,132
s_waitcnt lgkmcnt(10)
ds_read_b64_tr_b16 v[212:213], v116 offset:20480
ds_read_b64_tr_b16 v[214:215], v116 offset:22528
Mvva 148,244,140
buffer_load_dwordx4 a[180:183], v112, s[8:11], s52 offen offset:1024 sc1
s_add_u32 s52, s52, 8192
Mvva 136,232,128
ds_read_b64_tr_b16 v[200:201], v117 offset:16384
ds_read_b64_tr_b16 v[202:203], v117 offset:18432
Mvva 136,248,136
Mvva 152,232,132
s_waitcnt lgkmcnt(10)
ds_read_b64_tr_b16 v[216:217], v117 offset:20480
ds_read_b64_tr_b16 v[218:219], v117 offset:22528
Mvva 152,248,140
buffer_load_dwordx4 a[184:187], v112, s[8:11], s52 offen offset:0 sc1
Mvva 140,236,128
ds_read_b64_tr_b16 v[204:205], v118 offset:16384
ds_read_b64_tr_b16 v[206:207], v118 offset:18432
Mvva 140,252,136
s_cmp_lt_u32 s93, 224
s_cbranch_scc1 L_f2C
L_f2Cr:
Mvva 156,236,132
s_waitcnt lgkmcnt(10)
ds_read_b64_tr_b16 v[220:221], v118 offset:20480
ds_read_b64_tr_b16 v[222:223], v118 offset:22528
Mvva 156,252,140
buffer_load_dwordx4 a[188:191], v112, s[8:11], s52 offen offset:1024 sc1
s_add_u32 s52, s52, 8192
s_waitcnt vmcnt(16)
Mvva 160,192,144
ds_read_b64_tr_b16 v[224:225], v115 offset:24576
ds_read_b64_tr_b16 v[226:227], v115 offset:26624
Mvva 160,208,152
Mvva 176,192,148
s_waitcnt lgkmcnt(10)
s_add_u32 m0, s44, 65536
ds_read_b64_tr_b16 v[240:241], v115 offset:28672
ds_read_b64_tr_b16 v[242:243], v115 offset:30720
Mvva 176,208,156
buffer_load_dwordx4 v114, s[12:15], s48 offen offset:0 lds
Mvva 164,196,144
ds_read_b64_tr_b16 v[228:229], v116 offset:24576
ds_read_b64_tr_b16 v[230:231], v116 offset:26624
Mvva 164,212,152
Mvva 180,196,148
s_waitcnt lgkmcnt(10)
ds_read_b64_tr_b16 v[244:245], v116 offset:28672
ds_read_b64_tr_b16 v[246:247], v116 offset:30720
Mvva 180,212,156
buffer_load_dwordx4 v114, s[12:15], s49 offen offset:1024 lds
Mvva 168,200,144
ds_read_b64_tr_b16 v[232:233], v117 offset:24576
ds_read_b64_tr_b16 v[234:235], v117 offset:26624
Mvva 168,216,152
Mvva 184,200,148
s_waitcnt lgkmcnt(10)
ds_read_b64_tr_b16 v[248:249], v117 offset:28672
ds_read_b64_tr_b16 v[250:251], v117 offset:30720
Mvva 184,216,156
buffer_load_dwordx4 v114, s[12:15], s50 offen offset:2048 lds
Mvva 172,204,144
s_waitcnt vmcnt(15)
ds_read_b64_tr_b16 v[236:237], v118 offset:24576
ds_read_b64_tr_b16 v[238:239], v118 offset:26624
Mvva 172,220,152
s_waitcnt lgkmcnt(10)
Mvva 188,204,148
s_barrier
ds_read_b64_tr_b16 v[252:253], v118 offset:28672
ds_read_b64_tr_b16 v[254:255], v118 offset:30720
Mvva 188,220,156
buffer_load_dwordx4 v114, s[12:15], s51 offen offset:3072 lds
v_add_u32 v114, 131072, v114
Mvva 128,224,144
ds_read_b64_tr_b16 v[192:193], v115 offset:32768
ds_read_b64_tr_b16 v[194:195], v115 offset:34816
Mvva 128,240,152
s_cmp_ge_u32 s2, 128
s_cbranch_scc1 L_c31
L_c31r:
Mvva 144,224,148
s_waitcnt lgkmcnt(10)
ds_read_b64_tr_b16 v[208:209], v115 offset:36864
ds_read_b64_tr_b16 v[210:211], v115 offset:38912
Mvva 144,240,156
buffer_load_dwordx4 a[192:195], v112, s[8:11], s52 offen offset:0 sc1
Mvva 132,228,144
ds_read_b64_tr_b16 v[196:197], v116 offset:32768
ds_read_b64_tr_b16 v[198:199], v116 offset:34816
Mvva 132,244,152
Mvva 148,228,148
s_waitcnt lgkmcnt(10)
ds_read_b64_tr_b16 v[212:213], v116 offset:36864
ds_read_b64_tr_b16 v[214:215], v116 offset:38912
Mvva 148,244,156
buffer_load_dwordx4 a[196:199], v112, s[8:11], s52 offen offset:1024 sc1
s_add_u32 s52, s52, 8192
Mvva 136,232,144
ds_read_b64_tr_b16 v[200:201], v117 offset:32768
ds_read_b64_tr_b16 v[202:203], v117 offset:34816
Mvva 136,248,152
Mvva 152,232,148
s_waitcnt lgkmcnt(10)
ds_read_b64_tr_b16 v[216:217], v117 offset:36864
ds_read_b64_tr_b16 v[218:219], v117 offset:38912
Mvva 152,248,156
buffer_load_dwordx4 a[200:203], v112, s[8:11], s52 offen offset:0 sc1
Mvva 140,236,144
ds_read_b64_tr_b16 v[204:205], v118 offset:32768
ds_read_b64_tr_b16 v[206:207], v118 offset:34816
Mvva 140,252,152
Mvva 156,236,148
s_waitcnt lgkmcnt(10)
ds_read_b64_tr_b16 v[220:221], v118 offset:36864
ds_read_b64_tr_b16 v[222:223], v118 offset:38912
Mvva 156,252,156
buffer_load_dwordx4 a[204:207], v112, s[8:11], s52 offen offset:1024 sc1
s_add_u32 s52, s52, 8192
s_waitcnt vmcnt(16)
Mvva 160,192,160
ds_read_b64_tr_b16 v[224:225], v115 offset:40960
ds_read_b64_tr_b16 v[226:227], v115 offset:43008
Mvva 160,208,168
Mvva 176,192,164
s_waitcnt lgkmcnt(10)
s_add_u32 m0, s44, 81920
ds_read_b64_tr_b16 v[240:241], v115 offset:45056
ds_read_b64_tr_b16 v[242:243], v115 offset:47104
Mvva 176,208,172
buffer_load_dwordx4 v114, s[12:15], s48 offen offset:0 lds
Mvva 164,196,160
ds_read_b64_tr_b16 v[228:229], v116 offset:40960
ds_read_b64_tr_b16 v[230:231], v116 offset:43008
Mvva 164,212,168
Mvva 180,196,164
s_waitcnt lgkmcnt(10)
ds_read_b64_tr_b16 v[244:245], v116 offset:45056
ds_read_b64_tr_b16 v[246:247], v116 offset:47104
Mvva 180,212,172
buffer_load_dwordx4 v114, s[12:15], s49 offen offset:1024 lds
Mvva 168,200,160
ds_read_b64_tr_b16 v[232:233], v117 offset:40960
ds_read_b64_tr_b16 v[234:235], v117 offset:43008
Mvva 168,216,168
Mvva 184,200,164
s_waitcnt lgkmcnt(10)
ds_read_b64_tr_b16 v[248:249], v117 offset:45056
ds_read_b64_tr_b16 v[250:251], v117 offset:47104
Mvva 184,216,172
buffer_load_dwordx4 v114, s[12:15], s50 offen offset:2048 lds
Mvva 172,204,160
s_waitcnt vmcnt(15)
ds_read_b64_tr_b16 v[236:237], v118 offset:40960
ds_read_b64_tr_b16 v[238:239], v118 offset:43008
Mvva 172,220,168
s_waitcnt lgkmcnt(10)
Mvva 188,204,164
s_barrier
ds_read_b64_tr_b16 v[252:253], v118 offset:45056
ds_read_b64_tr_b16 v[254:255], v118 offset:47104
Mvva 188,220,172
buffer_load_dwordx4 v114, s[12:15], s51 offen offset:3072 lds
v_add_u32 v114, 131072, v114
Mvva 128,224,160
ds_read_b64_tr_b16 v[192:193], v115 offset:49152
ds_read_b64_tr_b16 v[194:195], v115 offset:51200
Mvva 128,240,168
Mvva 144,224,164
s_waitcnt lgkmcnt(10)
ds_read_b64_tr_b16 v[208:209], v115 offset:53248
ds_read_b64_tr_b16 v[210:211], v115 offset:55296
Mvva 144,240,172
buffer_load_dwordx4 a[208:211], v112, s[8:11], s52 offen offset:0 sc1
Mvva 132,228,160
ds_read_b64_tr_b16 v[196:197], v116 offset:49152
ds_read_b64_tr_b16 v[198:199], v116 offset:51200
Mvva 132,244,168
Mvva 148,228,164
s_waitcnt lgkmcnt(10)
ds_read_b64_tr_b16 v[212:213], v116 offset:53248
ds_read_b64_tr_b16 v[214:215], v116 offset:55296
Mvva 148,244,172
buffer_load_dwordx4 a[212:215], v112, s[8:11], s52 offen offset:1024 sc1
s_add_u32 s52, s52, 8192
Mvva 136,232,160
ds_read_b64_tr_b16 v[200:201], v117 offset:49152
ds_read_b64_tr_b16 v[202:203], v117 offset:51200
Mvva 136,248,168
Mvva 152,232,164
s_waitcnt lgkmcnt(10)
ds_read_b64_tr_b16 v[216:217], v117 offset:53248
ds_read_b64_tr_b16 v[218:219], v117 offset:55296
Mvva 152,248,172
buffer_load_dwordx4 a[216:219], v112, s[8:11], s52 offen offset:0 sc1
Mvva 140,236,160
ds_read_b64_tr_b16 v[204:205], v118 offset:49152
ds_read_b64_tr_b16 v[206:207], v118 offset:51200
Mvva 140,252,168
Mvva 156,236,164
s_waitcnt lgkmcnt(10)
ds_read_b64_tr_b16 v[220:221], v118 offset:53248
ds_read_b64_tr_b16 v[222:223], v118 offset:55296
Mvva 156,252,172
buffer_load_dwordx4 a[220:223], v112, s[8:11], s52 offen offset:1024 sc1
s_add_u32 s52, s52, 8192
s_waitcnt vmcnt(16)
Mvva 160,192,176
ds_read_b64_tr_b16 v[224:225], v115 offset:57344
ds_read_b64_tr_b16 v[226:227], v115 offset:59392
Mvva 160,208,184
Mvva 176,192,180
s_waitcnt lgkmcnt(10)
s_add_u32 m0, s44, 98304
ds_read_b64_tr_b16 v[240:241], v115 offset:61440
ds_read_b64_tr_b16 v[242:243], v115 offset:63488
Mvva 176,208,188
buffer_load_dwordx4 v114, s[12:15], s48 offen offset:0 lds
Mvva 164,196,176
ds_read_b64_tr_b16 v[228:229], v116 offset:57344
ds_read_b64_tr_b16 v[230:231], v116 offset:59392
Mvva 164,212,184
Mvva 180,196,180
s_waitcnt lgkmcnt(10)
ds_read_b64_tr_b16 v[244:245], v116 offset:61440
ds_read_b64_tr_b16 v[246:247], v116 offset:63488
Mvva 180,212,188
buffer_load_dwordx4 v114, s[12:15], s49 offen offset:1024 lds
Mvva 168,200,176
ds_read_b64_tr_b16 v[232:233], v117 offset:57344
ds_read_b64_tr_b16 v[234:235], v117 offset:59392
Mvva 168,216,184
s_cmp_lt_u32 s93, 224
s_cbranch_scc1 L_f2E
L_f2Er:
Mvva 184,200,180
s_waitcnt lgkmcnt(10)
ds_read_b64_tr_b16 v[248:249], v117 offset:61440
ds_read_b64_tr_b16 v[250:251], v117 offset:63488
Mvva 184,216,188
buffer_load_dwordx4 v114, s[12:15], s50 offen offset:2048 lds
Mvva 172,204,176
s_waitcnt vmcnt(15)
ds_read_b64_tr_b16 v[236:237], v118 offset:57344
ds_read_b64_tr_b16 v[238:239], v118 offset:59392
Mvva 172,220,184
s_waitcnt lgkmcnt(10)
Mvva 188,204,180
s_barrier
ds_read_b64_tr_b16 v[252:253], v118 offset:61440
ds_read_b64_tr_b16 v[254:255], v118 offset:63488
Mvva 188,220,188
buffer_load_dwordx4 v114, s[12:15], s51 offen offset:3072 lds
v_add_u32 v114, 131072, v114
Mvva 128,224,176
ds_read_b64_tr_b16 v[192:193], v12 offset:0
ds_read_b64_tr_b16 v[194:195], v12 offset:2048
Mvva 128,240,184
Mvva 144,224,180
s_waitcnt lgkmcnt(10)
ds_read_b64_tr_b16 v[208:209], v12 offset:4096
ds_read_b64_tr_b16 v[210:211], v12 offset:6144
Mvva 144,240,188
buffer_load_dwordx4 a[224:227], v112, s[8:11], s52 offen offset:0 sc1
Mvva 132,228,176
ds_read_b64_tr_b16 v[196:197], v13 offset:0
ds_read_b64_tr_b16 v[198:199], v13 offset:2048
Mvva 132,244,184
Mvva 148,228,180
s_waitcnt lgkmcnt(10)
ds_read_b64_tr_b16 v[212:213], v13 offset:4096
ds_read_b64_tr_b16 v[214:215], v13 offset:6144
Mvva 148,244,188
buffer_load_dwordx4 a[228:231], v112, s[8:11], s52 offen offset:1024 sc1
s_add_u32 s52, s52, 8192
Mvva 136,232,176
ds_read_b64_tr_b16 v[200:201], v14 offset:0
ds_read_b64_tr_b16 v[202:203], v14 offset:2048
Mvva 136,248,184
Mvva 152,232,180
s_waitcnt lgkmcnt(10)
ds_read_b64_tr_b16 v[216:217], v14 offset:4096
ds_read_b64_tr_b16 v[218:219], v14 offset:6144
Mvva 152,248,188
buffer_load_dwordx4 a[232:235], v112, s[8:11], s52 offen offset:0 sc1
Mvva 140,236,176
ds_read_b64_tr_b16 v[204:205], v15 offset:0
ds_read_b64_tr_b16 v[206:207], v15 offset:2048
Mvva 140,252,184
Mvva 156,236,180
s_waitcnt lgkmcnt(10)
ds_read_b64_tr_b16 v[220:221], v15 offset:4096
ds_read_b64_tr_b16 v[222:223], v15 offset:6144
Mvva 156,252,188
buffer_load_dwordx4 a[236:239], v112, s[8:11], s52 offen offset:1024 sc1
s_add_u32 s52, s52, 8192
s_waitcnt vmcnt(16)
Mvva 160,192,192
ds_read_b64_tr_b16 v[224:225], v12 offset:8192
ds_read_b64_tr_b16 v[226:227], v12 offset:10240
Mvva 160,208,200
Mvva 176,192,196
s_waitcnt lgkmcnt(10)
s_add_u32 m0, s44, 114688
ds_read_b64_tr_b16 v[240:241], v12 offset:12288
ds_read_b64_tr_b16 v[242:243], v12 offset:14336
Mvva 176,208,204
buffer_load_dwordx4 v114, s[12:15], s48 offen offset:0 lds
Mvva 164,196,192
ds_read_b64_tr_b16 v[228:229], v13 offset:8192
ds_read_b64_tr_b16 v[230:231], v13 offset:10240
Mvva 164,212,200
Mvva 180,196,196
s_waitcnt lgkmcnt(10)
ds_read_b64_tr_b16 v[244:245], v13 offset:12288
ds_read_b64_tr_b16 v[246:247], v13 offset:14336
Mvva 180,212,204
buffer_load_dwordx4 v114, s[12:15], s49 offen offset:1024 lds
Mvva 168,200,192
ds_read_b64_tr_b16 v[232:233], v14 offset:8192
ds_read_b64_tr_b16 v[234:235], v14 offset:10240
Mvva 168,216,200
Mvva 184,200,196
s_waitcnt lgkmcnt(10)
ds_read_b64_tr_b16 v[248:249], v14 offset:12288
ds_read_b64_tr_b16 v[250:251], v14 offset:14336
Mvva 184,216,204
buffer_load_dwordx4 v114, s[12:15], s50 offen offset:2048 lds
Mvva 172,204,192
s_waitcnt vmcnt(15)
ds_read_b64_tr_b16 v[236:237], v15 offset:8192
ds_read_b64_tr_b16 v[238:239], v15 offset:10240
Mvva 172,220,200
s_waitcnt lgkmcnt(10)
Mvva 188,204,196
s_barrier
ds_read_b64_tr_b16 v[252:253], v15 offset:12288
ds_read_b64_tr_b16 v[254:255], v15 offset:14336
Mvva 188,220,204
buffer_load_dwordx4 v114, s[12:15], s51 offen offset:3072 lds
v_add_u32_e64 v114, s95, v113
Mvva 128,224,192
ds_read_b64_tr_b16 v[192:193], v12 offset:16384
ds_read_b64_tr_b16 v[194:195], v12 offset:18432
Mvva 128,240,200
Mvva 144,224,196
s_waitcnt lgkmcnt(10)
ds_read_b64_tr_b16 v[208:209], v12 offset:20480
ds_read_b64_tr_b16 v[210:211], v12 offset:22528
Mvva 144,240,204
buffer_load_dwordx4 a[240:243], v112, s[8:11], s52 offen offset:0 sc1
Mvva 132,228,192
ds_read_b64_tr_b16 v[196:197], v13 offset:16384
ds_read_b64_tr_b16 v[198:199], v13 offset:18432
Mvva 132,244,200
Mvva 148,228,196
s_waitcnt lgkmcnt(10)
ds_read_b64_tr_b16 v[212:213], v13 offset:20480
ds_read_b64_tr_b16 v[214:215], v13 offset:22528
Mvva 148,244,204
buffer_load_dwordx4 a[244:247], v112, s[8:11], s52 offen offset:1024 sc1
s_add_u32 s52, s52, 8192
Mvva 136,232,192
ds_read_b64_tr_b16 v[200:201], v14 offset:16384
ds_read_b64_tr_b16 v[202:203], v14 offset:18432
Mvva 136,248,200
Mvva 152,232,196
s_waitcnt lgkmcnt(10)
ds_read_b64_tr_b16 v[216:217], v14 offset:20480
ds_read_b64_tr_b16 v[218:219], v14 offset:22528
Mvva 152,248,204
buffer_load_dwordx4 a[248:251], v112, s[8:11], s52 offen offset:0 sc1
Mvva 140,236,192
ds_read_b64_tr_b16 v[204:205], v15 offset:16384
ds_read_b64_tr_b16 v[206:207], v15 offset:18432
Mvva 140,252,200
Mvva 156,236,196
s_waitcnt lgkmcnt(10)
ds_read_b64_tr_b16 v[220:221], v15 offset:20480
ds_read_b64_tr_b16 v[222:223], v15 offset:22528
Mvva 156,252,204
buffer_load_dwordx4 a[252:255], v112, s[8:11], s52 offen offset:1024 sc1
s_add_u32 s52, s52, 8192
s_waitcnt vmcnt(16)
Mvva 160,192,208
s_add_u32 m0, s44, 0
ds_read_b64_tr_b16 v[224:225], v12 offset:24576
ds_read_b64_tr_b16 v[226:227], v12 offset:26624
Mvva 160,208,216
buffer_load_dwordx4 v114, s[12:15], s48 offen offset:0 lds
Mvva 176,192,212
s_waitcnt lgkmcnt(10)
ds_read_b64_tr_b16 v[240:241], v12 offset:28672
ds_read_b64_tr_b16 v[242:243], v12 offset:30720
Mvva 176,208,220
Mvva 164,196,208
ds_read_b64_tr_b16 v[228:229], v13 offset:24576
ds_read_b64_tr_b16 v[230:231], v13 offset:26624
Mvva 164,212,216
buffer_load_dwordx4 v114, s[12:15], s49 offen offset:1024 lds
Mvva 180,196,212
s_waitcnt lgkmcnt(10)
ds_read_b64_tr_b16 v[244:245], v13 offset:28672
ds_read_b64_tr_b16 v[246:247], v13 offset:30720
Mvva 180,212,220
buffer_load_dwordx4 v114, s[12:15], s50 offen offset:2048 lds
Mvva 168,200,208
ds_read_b64_tr_b16 v[232:233], v14 offset:24576
ds_read_b64_tr_b16 v[234:235], v14 offset:26624
Mvva 168,216,216
buffer_load_dwordx4 v114, s[12:15], s51 offen offset:3072 lds
v_add_u32 v114, 262144, v114
Mvva 184,200,212
s_waitcnt lgkmcnt(10)
ds_read_b64_tr_b16 v[248:249], v14 offset:28672
ds_read_b64_tr_b16 v[250:251], v14 offset:30720
Mvva 184,216,220
Mvva 172,204,208
s_waitcnt vmcnt(16)
ds_read_b64_tr_b16 v[236:237], v15 offset:24576
ds_read_b64_tr_b16 v[238:239], v15 offset:26624
Mvva 172,220,216
s_waitcnt lgkmcnt(10)
buffer_load_dwordx4 a[0:3], v112, s[8:11], s52 offen offset:0 sc1
Mvva 188,204,212
s_barrier
ds_read_b64_tr_b16 v[252:253], v15 offset:28672
ds_read_b64_tr_b16 v[254:255], v15 offset:30720
Mvva 188,220,220
buffer_load_dwordx4 a[4:7], v112, s[8:11], s52 offen offset:1024 sc1
s_add_u32 s52, s52, 8192
Mvva 128,224,208
ds_read_b64_tr_b16 v[192:193], v12 offset:32768
ds_read_b64_tr_b16 v[194:195], v12 offset:34816
Mvva 128,240,216
buffer_load_dwordx4 a[8:11], v112, s[8:11], s52 offen offset:0 sc1
Mvva 144,224,212
s_waitcnt lgkmcnt(10)
ds_read_b64_tr_b16 v[208:209], v12 offset:36864
ds_read_b64_tr_b16 v[210:211], v12 offset:38912
Mvva 144,240,220
Mvva 132,228,208
ds_read_b64_tr_b16 v[196:197], v13 offset:32768
ds_read_b64_tr_b16 v[198:199], v13 offset:34816
Mvva 132,244,216
buffer_load_dwordx4 a[12:15], v112, s[8:11], s52 offen offset:1024 sc1
s_add_u32 s52, s52, 8192
Mvva 148,228,212
s_waitcnt lgkmcnt(10)
ds_read_b64_tr_b16 v[212:213], v13 offset:36864
ds_read_b64_tr_b16 v[214:215], v13 offset:38912
Mvva 148,244,220
buffer_load_dwordx4 a[16:19], v112, s[8:11], s52 offen offset:0 sc1
Mvva 136,232,208
ds_read_b64_tr_b16 v[200:201], v14 offset:32768
ds_read_b64_tr_b16 v[202:203], v14 offset:34816
Mvva 136,248,216
buffer_load_dwordx4 a[20:23], v112, s[8:11], s52 offen offset:1024 sc1
s_add_u32 s52, s52, 8192
Mvva 152,232,212
s_waitcnt lgkmcnt(10)
ds_read_b64_tr_b16 v[216:217], v14 offset:36864
ds_read_b64_tr_b16 v[218:219], v14 offset:38912
Mvva 152,248,220
Mvva 140,236,208
ds_read_b64_tr_b16 v[204:205], v15 offset:32768
ds_read_b64_tr_b16 v[206:207], v15 offset:34816
Mvva 140,252,216
buffer_load_dwordx4 a[24:27], v112, s[8:11], s52 offen offset:0 sc1
Mvva 156,236,212
s_waitcnt lgkmcnt(10)
ds_read_b64_tr_b16 v[220:221], v15 offset:36864
ds_read_b64_tr_b16 v[222:223], v15 offset:38912
Mvva 156,252,220
buffer_load_dwordx4 a[28:31], v112, s[8:11], s52 offen offset:1024 sc1
s_add_u32 s52, s52, 8192
s_waitcnt vmcnt(20)
Mvva 160,192,224
s_add_u32 m0, s44, 16384
ds_read_b64_tr_b16 v[224:225], v12 offset:40960
ds_read_b64_tr_b16 v[226:227], v12 offset:43008
Mvva 160,208,232
buffer_load_dwordx4 v114, s[12:15], s48 offen offset:0 lds
Mvva 176,192,228
s_waitcnt lgkmcnt(10)
ds_read_b64_tr_b16 v[240:241], v12 offset:45056
ds_read_b64_tr_b16 v[242:243], v12 offset:47104
Mvva 176,208,236
Mvva 164,196,224
ds_read_b64_tr_b16 v[228:229], v13 offset:40960
ds_read_b64_tr_b16 v[230:231], v13 offset:43008
Mvva 164,212,232
buffer_load_dwordx4 v114, s[12:15], s49 offen offset:1024 lds
Mvva 180,196,228
s_waitcnt lgkmcnt(10)
ds_read_b64_tr_b16 v[244:245], v13 offset:45056
ds_read_b64_tr_b16 v[246:247], v13 offset:47104
Mvva 180,212,236
buffer_load_dwordx4 v114, s[12:15], s50 offen offset:2048 lds
Mvva 168,200,224
ds_read_b64_tr_b16 v[232:233], v14 offset:40960
ds_read_b64_tr_b16 v[234:235], v14 offset:43008
Mvva 168,216,232
buffer_load_dwordx4 v114, s[12:15], s51 offen offset:3072 lds
v_add_u32 v114, 262144, v114
Mvva 184,200,228
s_waitcnt lgkmcnt(10)
ds_read_b64_tr_b16 v[248:249], v14 offset:45056
ds_read_b64_tr_b16 v[250:251], v14 offset:47104
Mvva 184,216,236
Mvva 172,204,224
s_waitcnt vmcnt(20)
ds_read_b64_tr_b16 v[236:237], v15 offset:40960
ds_read_b64_tr_b16 v[238:239], v15 offset:43008
Mvva 172,220,232
s_waitcnt lgkmcnt(10)
buffer_load_dwordx4 a[32:35], v112, s[8:11], s52 offen offset:0 sc1
Mvva 188,204,228
s_barrier
ds_read_b64_tr_b16 v[252:253], v15 offset:45056
ds_read_b64_tr_b16 v[254:255], v15 offset:47104
Mvva 188,220,236
buffer_load_dwordx4 a[36:39], v112, s[8:11], s52 offen offset:1024 sc1
s_add_u32 s52, s52, 8192
Mvva 128,224,224
ds_read_b64_tr_b16 v[192:193], v12 offset:49152
ds_read_b64_tr_b16 v[194:195], v12 offset:51200
Mvva 128,240,232
buffer_load_dwordx4 a[40:43], v112, s[8:11], s52 offen offset:0 sc1
Mvva 144,224,228
s_waitcnt lgkmcnt(10)
ds_read_b64_tr_b16 v[208:209], v12 offset:53248
ds_read_b64_tr_b16 v[210:211], v12 offset:55296
Mvva 144,240,236
Mvva 132,228,224
ds_read_b64_tr_b16 v[196:197], v13 offset:49152
ds_read_b64_tr_b16 v[198:199], v13 offset:51200
Mvva 132,244,232
buffer_load_dwordx4 a[44:47], v112, s[8:11], s52 offen offset:1024 sc1
s_add_u32 s52, s52, 8192
Mvva 148,228,228
s_waitcnt lgkmcnt(10)
ds_read_b64_tr_b16 v[212:213], v13 offset:53248
ds_read_b64_tr_b16 v[214:215], v13 offset:55296
Mvva 148,244,236
buffer_load_dwordx4 a[48:51], v112, s[8:11], s52 offen offset:0 sc1
Mvva 136,232,224
ds_read_b64_tr_b16 v[200:201], v14 offset:49152
ds_read_b64_tr_b16 v[202:203], v14 offset:51200
Mvva 136,248,232
buffer_load_dwordx4 a[52:55], v112, s[8:11], s52 offen offset:1024 sc1
s_add_u32 s52, s52, 8192
Mvva 152,232,228
s_waitcnt lgkmcnt(10)
ds_read_b64_tr_b16 v[216:217], v14 offset:53248
ds_read_b64_tr_b16 v[218:219], v14 offset:55296
Mvva 152,248,236
Mvva 140,236,224
ds_read_b64_tr_b16 v[204:205], v15 offset:49152
ds_read_b64_tr_b16 v[206:207], v15 offset:51200
Mvva 140,252,232
buffer_load_dwordx4 a[56:59], v112, s[8:11], s52 offen offset:0 sc1
Mvva 156,236,228
s_waitcnt lgkmcnt(10)
ds_read_b64_tr_b16 v[220:221], v15 offset:53248
ds_read_b64_tr_b16 v[222:223], v15 offset:55296
Mvva 156,252,236
buffer_load_dwordx4 a[60:63], v112, s[8:11], s52 offen offset:1024 sc1
s_add_u32 s52, s52, 8192
s_waitcnt vmcnt(24)
Mvva 160,192,240
s_add_u32 m0, s44, 32768
ds_read_b64_tr_b16 v[224:225], v12 offset:57344
ds_read_b64_tr_b16 v[226:227], v12 offset:59392
Mvva 160,208,248
buffer_load_dwordx4 v114, s[12:15], s48 offen offset:0 lds
Mvva 176,192,244
s_waitcnt lgkmcnt(10)
ds_read_b64_tr_b16 v[240:241], v12 offset:61440
ds_read_b64_tr_b16 v[242:243], v12 offset:63488
Mvva 176,208,252
Mvva 164,196,240
ds_read_b64_tr_b16 v[228:229], v13 offset:57344
ds_read_b64_tr_b16 v[230:231], v13 offset:59392
Mvva 164,212,248
buffer_load_dwordx4 v114, s[12:15], s49 offen offset:1024 lds
Mvva 180,196,244
s_waitcnt lgkmcnt(10)
ds_read_b64_tr_b16 v[244:245], v13 offset:61440
ds_read_b64_tr_b16 v[246:247], v13 offset:63488
Mvva 180,212,252
buffer_load_dwordx4 v114, s[12:15], s50 offen offset:2048 lds
Mvva 168,200,240
ds_read_b64_tr_b16 v[232:233], v14 offset:57344
ds_read_b64_tr_b16 v[234:235], v14 offset:59392
Mvva 168,216,248
buffer_load_dwordx4 v114, s[12:15], s51 offen offset:3072 lds
v_add_u32 v114, 262144, v114
Mvva 184,200,244
s_waitcnt lgkmcnt(10)
ds_read_b64_tr_b16 v[248:249], v14 offset:61440
ds_read_b64_tr_b16 v[250:251], v14 offset:63488
Mvva 184,216,252
Mvva 172,204,240
s_waitcnt vmcnt(24)
ds_read_b64_tr_b16 v[236:237], v15 offset:57344
ds_read_b64_tr_b16 v[238:239], v15 offset:59392
Mvva 172,220,248
s_waitcnt lgkmcnt(10)
buffer_load_dwordx4 a[64:67], v112, s[8:11], s52 offen offset:0 sc1
Mvva 188,204,244
s_barrier
ds_read_b64_tr_b16 v[252:253], v15 offset:61440
ds_read_b64_tr_b16 v[254:255], v15 offset:63488
Mvva 188,220,252
buffer_load_dwordx4 a[68:71], v112, s[8:11], s52 offen offset:1024 sc1
s_add_u32 s52, s52, 8192
Mvva 128,224,240
ds_read_b64_tr_b16 v[192:193], v115 offset:0
ds_read_b64_tr_b16 v[194:195], v115 offset:2048
Mvva 128,240,248
buffer_load_dwordx4 a[72:75], v112, s[8:11], s52 offen offset:0 sc1
Mvva 144,224,244
s_waitcnt lgkmcnt(10)
ds_read_b64_tr_b16 v[208:209], v115 offset:4096
ds_read_b64_tr_b16 v[210:211], v115 offset:6144
Mvva 144,240,252
Mvva 132,228,240
ds_read_b64_tr_b16 v[196:197], v116 offset:0
ds_read_b64_tr_b16 v[198:199], v116 offset:2048
Mvva 132,244,248
buffer_load_dwordx4 a[76:79], v112, s[8:11], s52 offen offset:1024 sc1
s_add_u32 s52, s52, 8192
Mvva 148,228,244
s_waitcnt lgkmcnt(10)
ds_read_b64_tr_b16 v[212:213], v116 offset:4096
ds_read_b64_tr_b16 v[214:215], v116 offset:6144
Mvva 148,244,252
buffer_load_dwordx4 a[80:83], v112, s[8:11], s52 offen offset:0 sc1
Mvva 136,232,240
ds_read_b64_tr_b16 v[200:201], v117 offset:0
ds_read_b64_tr_b16 v[202:203], v117 offset:2048
Mvva 136,248,248
buffer_load_dwordx4 a[84:87], v112, s[8:11], s52 offen offset:1024 sc1
s_add_u32 s52, s52, 8192
Mvva 152,232,244
s_waitcnt lgkmcnt(10)
ds_read_b64_tr_b16 v[216:217], v117 offset:4096
ds_read_b64_tr_b16 v[218:219], v117 offset:6144
Mvva 152,248,252
Mvva 140,236,240
ds_read_b64_tr_b16 v[204:205], v118 offset:0
ds_read_b64_tr_b16 v[206:207], v118 offset:2048
Mvva 140,252,248
buffer_load_dwordx4 a[88:91], v112, s[8:11], s52 offen offset:0 sc1
Mvva 156,236,244
s_waitcnt lgkmcnt(10)
ds_read_b64_tr_b16 v[220:221], v118 offset:4096
ds_read_b64_tr_b16 v[222:223], v118 offset:6144
Mvva 156,252,252
buffer_load_dwordx4 a[92:95], v112, s[8:11], s52 offen offset:1024 sc1
s_add_u32 s52, s52, 8192
s_waitcnt vmcnt(28)
Mvva 160,192,0
s_add_u32 m0, s44, 49152
ds_read_b64_tr_b16 v[224:225], v115 offset:8192
ds_read_b64_tr_b16 v[226:227], v115 offset:10240
Mvva 160,208,8
buffer_load_dwordx4 v114, s[12:15], s48 offen offset:0 lds
Mvva 176,192,4
s_waitcnt lgkmcnt(10)
ds_read_b64_tr_b16 v[240:241], v115 offset:12288
ds_read_b64_tr_b16 v[242:243], v115 offset:14336
Mvva 176,208,12
Mvva 164,196,0
ds_read_b64_tr_b16 v[228:229], v116 offset:8192
ds_read_b64_tr_b16 v[230:231], v116 offset:10240
Mvva 164,212,8
buffer_load_dwordx4 v114, s[12:15], s49 offen offset:1024 lds
Mvva 180,196,4
s_waitcnt lgkmcnt(10)
ds_read_b64_tr_b16 v[244:245], v116 offset:12288
ds_read_b64_tr_b16 v[246:247], v116 offset:14336
Mvva 180,212,12
buffer_load_dwordx4 v114, s[12:15], s50 offen offset:2048 lds
Mvva 168,200,0
ds_read_b64_tr_b16 v[232:233], v117 offset:8192
ds_read_b64_tr_b16 v[234:235], v117 offset:10240
Mvva 168,216,8
buffer_load_dwordx4 v114, s[12:15], s51 offen offset:3072 lds
v_add_u32 v114, 262144, v114
Mvva 184,200,4
s_waitcnt lgkmcnt(10)
ds_read_b64_tr_b16 v[248:249], v117 offset:12288
ds_read_b64_tr_b16 v[250:251], v117 offset:14336
Mvva 184,216,12
Mvva 172,204,0
s_waitcnt vmcnt(24)
ds_read_b64_tr_b16 v[236:237], v118 offset:8192
ds_read_b64_tr_b16 v[238:239], v118 offset:10240
Mvva 172,220,8
s_waitcnt lgkmcnt(10)
buffer_load_dwordx4 a[96:99], v112, s[8:11], s52 offen offset:0 sc1
Mvva 188,204,4
s_barrier
ds_read_b64_tr_b16 v[252:253], v118 offset:12288
ds_read_b64_tr_b16 v[254:255], v118 offset:14336
Mvva 188,220,12
buffer_load_dwordx4 a[100:103], v112, s[8:11], s52 offen offset:1024 sc1
s_add_u32 s52, s52, 8192
Mvva 160,224,16
ds_read_b64_tr_b16 v[192:193], v115 offset:16384
ds_read_b64_tr_b16 v[194:195], v115 offset:18432
Mvva 160,240,24
buffer_load_dwordx4 a[104:107], v112, s[8:11], s52 offen offset:0 sc1
Mvva 176,224,20
s_waitcnt lgkmcnt(10)
ds_read_b64_tr_b16 v[208:209], v115 offset:20480
ds_read_b64_tr_b16 v[210:211], v115 offset:22528
Mvva 176,240,28
Mvva 164,228,16
ds_read_b64_tr_b16 v[196:197], v116 offset:16384
ds_read_b64_tr_b16 v[198:199], v116 offset:18432
Mvva 164,244,24
buffer_load_dwordx4 a[108:111], v112, s[8:11], s52 offen offset:1024 sc1
s_add_u32 s52, s52, 8192
Mvva 180,228,20
s_waitcnt lgkmcnt(10)
ds_read_b64_tr_b16 v[212:213], v116 offset:20480
ds_read_b64_tr_b16 v[214:215], v116 offset:22528
Mvva 180,244,28
buffer_load_dwordx4 a[112:115], v112, s[8:11], s52 offen offset:0 sc1
Mvva 168,232,16
ds_read_b64_tr_b16 v[200:201], v117 offset:16384
ds_read_b64_tr_b16 v[202:203], v117 offset:18432
Mvva 168,248,24
buffer_load_dwordx4 a[116:119], v112, s[8:11], s52 offen offset:1024 sc1
s_add_u32 s52, s52, 8192
Mvva 184,232,20
s_waitcnt lgkmcnt(10)
ds_read_b64_tr_b16 v[216:217], v117 offset:20480
ds_read_b64_tr_b16 v[218:219], v117 offset:22528
Mvva 184,248,28
Mvva 172,236,16
ds_read_b64_tr_b16 v[204:205], v118 offset:16384
ds_read_b64_tr_b16 v[206:207], v118 offset:18432
Mvva 172,252,24
buffer_load_dwordx4 a[120:123], v112, s[8:11], s52 offen offset:0 sc1
Mvva 188,236,20
s_waitcnt lgkmcnt(10)
ds_read_b64_tr_b16 v[220:221], v118 offset:20480
ds_read_b64_tr_b16 v[222:223], v118 offset:22528
Mvva 188,252,28
buffer_load_dwordx4 a[124:127], v112, s[8:11], s52 offen offset:1024 sc1
s_add_u32 s52, s52, 8192
s_waitcnt vmcnt(28)
Mvva 160,192,32
s_add_u32 m0, s44, 65536
ds_read_b64_tr_b16 v[224:225], v115 offset:24576
ds_read_b64_tr_b16 v[226:227], v115 offset:26624
Mvva 160,208,40
buffer_load_dwordx4 v114, s[12:15], s48 offen offset:0 lds
Mvva 176,192,36
s_waitcnt lgkmcnt(10)
ds_read_b64_tr_b16 v[240:241], v115 offset:28672
ds_read_b64_tr_b16 v[242:243], v115 offset:30720
Mvva 176,208,44
Mvva 164,196,32
ds_read_b64_tr_b16 v[228:229], v116 offset:24576
ds_read_b64_tr_b16 v[230:231], v116 offset:26624
Mvva 164,212,40
buffer_load_dwordx4 v114, s[12:15], s49 offen offset:1024 lds
Mvva 180,196,36
s_waitcnt lgkmcnt(10)
ds_read_b64_tr_b16 v[244:245], v116 offset:28672
ds_read_b64_tr_b16 v[246:247], v116 offset:30720
Mvva 180,212,44
buffer_load_dwordx4 v114, s[12:15], s50 offen offset:2048 lds
Mvva 168,200,32
ds_read_b64_tr_b16 v[232:233], v117 offset:24576
ds_read_b64_tr_b16 v[234:235], v117 offset:26624
Mvva 168,216,40
buffer_load_dwordx4 v114, s[12:15], s51 offen offset:3072 lds
v_add_u32 v114, 262144, v114
Mvva 184,200,36
s_waitcnt lgkmcnt(10)
ds_read_b64_tr_b16 v[248:249], v117 offset:28672
ds_read_b64_tr_b16 v[250:251], v117 offset:30720
Mvva 184,216,44
Mvva 172,204,32
s_waitcnt vmcnt(24)
ds_read_b64_tr_b16 v[236:237], v118 offset:24576
ds_read_b64_tr_b16 v[238:239], v118 offset:26624
Mvva 172,220,40
s_waitcnt lgkmcnt(10)
buffer_load_dwordx4 a[128:131], v112, s[8:11], s52 offen offset:0 sc1
Mvva 188,204,36
s_barrier
ds_read_b64_tr_b16 v[252:253], v118 offset:28672
ds_read_b64_tr_b16 v[254:255], v118 offset:30720
Mvva 188,220,44
buffer_load_dwordx4 a[132:135], v112, s[8:11], s52 offen offset:1024 sc1
s_add_u32 s52, s52, 8192
Mvva 160,224,48
ds_read_b64_tr_b16 v[192:193], v115 offset:32768
ds_read_b64_tr_b16 v[194:195], v115 offset:34816
Mvva 160,240,56
buffer_load_dwordx4 a[136:139], v112, s[8:11], s52 offen offset:0 sc1
Mvva 176,224,52
s_waitcnt lgkmcnt(10)
ds_read_b64_tr_b16 v[208:209], v115 offset:36864
ds_read_b64_tr_b16 v[210:211], v115 offset:38912
Mvva 176,240,60
Mvva 164,228,48
ds_read_b64_tr_b16 v[196:197], v116 offset:32768
ds_read_b64_tr_b16 v[198:199], v116 offset:34816
Mvva 164,244,56
buffer_load_dwordx4 a[140:143], v112, s[8:11], s52 offen offset:1024 sc1
s_add_u32 s52, s52, 8192
Mvva 180,228,52
s_waitcnt lgkmcnt(10)
ds_read_b64_tr_b16 v[212:213], v116 offset:36864
ds_read_b64_tr_b16 v[214:215], v116 offset:38912
Mvva 180,244,60
buffer_load_dwordx4 a[144:147], v112, s[8:11], s52 offen offset:0 sc1
Mvva 168,232,48
ds_read_b64_tr_b16 v[200:201], v117 offset:32768
ds_read_b64_tr_b16 v[202:203], v117 offset:34816
Mvva 168,248,56
buffer_load_dwordx4 a[148:151], v112, s[8:11], s52 offen offset:1024 sc1
s_add_u32 s52, s52, 8192
Mvva 184,232,52
s_waitcnt lgkmcnt(10)
ds_read_b64_tr_b16 v[216:217], v117 offset:36864
ds_read_b64_tr_b16 v[218:219], v117 offset:38912
Mvva 184,248,60
Mvva 172,236,48
ds_read_b64_tr_b16 v[204:205], v118 offset:32768
ds_read_b64_tr_b16 v[206:207], v118 offset:34816
Mvva 172,252,56
buffer_load_dwordx4 a[152:155], v112, s[8:11], s52 offen offset:0 sc1
Mvva 188,236,52
s_waitcnt lgkmcnt(10)
ds_read_b64_tr_b16 v[220:221], v118 offset:36864
ds_read_b64_tr_b16 v[222:223], v118 offset:38912
Mvva 188,252,60
buffer_load_dwordx4 a[156:159], v112, s[8:11], s52 offen offset:1024 sc1
s_add_u32 s52, s52, 8192
s_waitcnt vmcnt(28)
Mvva 160,192,64
s_add_u32 m0, s44, 81920
ds_read_b64_tr_b16 v[224:225], v115 offset:40960
ds_read_b64_tr_b16 v[226:227], v115 offset:43008
Mvva 160,208,72
buffer_load_dwordx4 v114, s[12:15], s48 offen offset:0 lds
Mvva 176,192,68
s_waitcnt lgkmcnt(10)
ds_read_b64_tr_b16 v[240:241], v115 offset:45056
ds_read_b64_tr_b16 v[242:243], v115 offset:47104
Mvva 176,208,76
Mvva 164,196,64
ds_read_b64_tr_b16 v[228:229], v116 offset:40960
ds_read_b64_tr_b16 v[230:231], v116 offset:43008
Mvva 164,212,72
buffer_load_dwordx4 v114, s[12:15], s49 offen offset:1024 lds
Mvva 180,196,68
s_waitcnt lgkmcnt(10)
ds_read_b64_tr_b16 v[244:245], v116 offset:45056
ds_read_b64_tr_b16 v[246:247], v116 offset:47104
Mvva 180,212,76
buffer_load_dwordx4 v114, s[12:15], s50 offen offset:2048 lds
Mvva 168,200,64
ds_read_b64_tr_b16 v[232:233], v117 offset:40960
ds_read_b64_tr_b16 v[234:235], v117 offset:43008
Mvva 168,216,72
buffer_load_dwordx4 v114, s[12:15], s51 offen offset:3072 lds
v_add_u32 v114, 262144, v114
Mvva 184,200,68
s_waitcnt lgkmcnt(10)
ds_read_b64_tr_b16 v[248:249], v117 offset:45056
ds_read_b64_tr_b16 v[250:251], v117 offset:47104
Mvva 184,216,76
Mvva 172,204,64
s_waitcnt vmcnt(24)
ds_read_b64_tr_b16 v[236:237], v118 offset:40960
ds_read_b64_tr_b16 v[238:239], v118 offset:43008
Mvva 172,220,72
s_waitcnt lgkmcnt(10)
buffer_load_dwordx4 a[160:163], v112, s[8:11], s52 offen offset:0 sc1
Mvva 188,204,68
s_barrier
ds_read_b64_tr_b16 v[252:253], v118 offset:45056
ds_read_b64_tr_b16 v[254:255], v118 offset:47104
Mvva 188,220,76
buffer_load_dwordx4 a[164:167], v112, s[8:11], s52 offen offset:1024 sc1
s_add_u32 s52, s52, 8192
Mvva 160,224,80
ds_read_b64_tr_b16 v[192:193], v115 offset:49152
ds_read_b64_tr_b16 v[194:195], v115 offset:51200
Mvva 160,240,88
buffer_load_dwordx4 a[168:171], v112, s[8:11], s52 offen offset:0 sc1
Mvva 176,224,84
s_waitcnt lgkmcnt(10)
ds_read_b64_tr_b16 v[208:209], v115 offset:53248
ds_read_b64_tr_b16 v[210:211], v115 offset:55296
Mvva 176,240,92
Mvva 164,228,80
ds_read_b64_tr_b16 v[196:197], v116 offset:49152
ds_read_b64_tr_b16 v[198:199], v116 offset:51200
Mvva 164,244,88
buffer_load_dwordx4 a[172:175], v112, s[8:11], s52 offen offset:1024 sc1
s_add_u32 s52, s52, 8192
Mvva 180,228,84
s_waitcnt lgkmcnt(10)
ds_read_b64_tr_b16 v[212:213], v116 offset:53248
ds_read_b64_tr_b16 v[214:215], v116 offset:55296
Mvva 180,244,92
buffer_load_dwordx4 a[176:179], v112, s[8:11], s52 offen offset:0 sc1
Mvva 168,232,80
ds_read_b64_tr_b16 v[200:201], v117 offset:49152
ds_read_b64_tr_b16 v[202:203], v117 offset:51200
Mvva 168,248,88
buffer_load_dwordx4 a[180:183], v112, s[8:11], s52 offen offset:1024 sc1
s_add_u32 s52, s52, 8192
Mvva 184,232,84
s_waitcnt lgkmcnt(10)
ds_read_b64_tr_b16 v[216:217], v117 offset:53248
ds_read_b64_tr_b16 v[218:219], v117 offset:55296
Mvva 184,248,92
Mvva 172,236,80
ds_read_b64_tr_b16 v[204:205], v118 offset:49152
ds_read_b64_tr_b16 v[206:207], v118 offset:51200
Mvva 172,252,88
buffer_load_dwordx4 a[184:187], v112, s[8:11], s52 offen offset:0 sc1
Mvva 188,236,84
s_waitcnt lgkmcnt(10)
ds_read_b64_tr_b16 v[220:221], v118 offset:53248
ds_read_b64_tr_b16 v[222:223], v118 offset:55296
Mvva 188,252,92
buffer_load_dwordx4 a[188:191], v112, s[8:11], s52 offen offset:1024 sc1
s_add_u32 s52, s52, 8192
s_waitcnt vmcnt(28)
Mvva 160,192,96
s_add_u32 m0, s44, 98304
ds_read_b64_tr_b16 v[224:225], v115 offset:57344
ds_read_b64_tr_b16 v[226:227], v115 offset:59392
Mvva 160,208,104
buffer_load_dwordx4 v114, s[12:15], s48 offen offset:0 lds
Mvva 176,192,100
s_waitcnt lgkmcnt(10)
ds_read_b64_tr_b16 v[240:241], v115 offset:61440
ds_read_b64_tr_b16 v[242:243], v115 offset:63488
Mvva 176,208,108
s_cmp_lg_u32 s53, 0
s_cbranch_scc1 L_yA
L_yAr:
Mvva 164,196,96
ds_read_b64_tr_b16 v[228:229], v116 offset:57344
ds_read_b64_tr_b16 v[230:231], v116 offset:59392
Mvva 164,212,104
buffer_load_dwordx4 v114, s[12:15], s49 offen offset:1024 lds
Mvva 180,196,100
s_waitcnt lgkmcnt(10)
ds_read_b64_tr_b16 v[244:245], v116 offset:61440
ds_read_b64_tr_b16 v[246:247], v116 offset:63488
Mvva 180,212,108
buffer_load_dwordx4 v114, s[12:15], s50 offen offset:2048 lds
Mvva 168,200,96
ds_read_b64_tr_b16 v[232:233], v117 offset:57344
ds_read_b64_tr_b16 v[234:235], v117 offset:59392
Mvva 168,216,104
buffer_load_dwordx4 v114, s[12:15], s51 offen offset:3072 lds
v_add_u32 v114, 262144, v114
Mvva 184,200,100
s_waitcnt lgkmcnt(10)
ds_read_b64_tr_b16 v[248:249], v117 offset:61440
ds_read_b64_tr_b16 v[250:251], v117 offset:63488
Mvva 184,216,108
Mvva 172,204,96
s_waitcnt vmcnt(24)
ds_read_b64_tr_b16 v[236:237], v118 offset:57344
ds_read_b64_tr_b16 v[238:239], v118 offset:59392
Mvva 172,220,104
s_waitcnt lgkmcnt(10)
buffer_load_dwordx4 a[192:195], v112, s[8:11], s52 offen offset:0 sc1
Mvva 188,204,100
s_barrier
ds_read_b64_tr_b16 v[252:253], v118 offset:61440
ds_read_b64_tr_b16 v[254:255], v118 offset:63488
Mvva 188,220,108
buffer_load_dwordx4 a[196:199], v112, s[8:11], s52 offen offset:1024 sc1
s_add_u32 s52, s52, 8192
Mvva 160,224,112
ds_read_b64_tr_b16 v[192:193], v12 offset:0
ds_read_b64_tr_b16 v[194:195], v12 offset:2048
Mvva 160,240,120
buffer_load_dwordx4 a[200:203], v112, s[8:11], s52 offen offset:0 sc1
Mvva 176,224,116
s_waitcnt lgkmcnt(10)
ds_read_b64_tr_b16 v[208:209], v12 offset:4096
ds_read_b64_tr_b16 v[210:211], v12 offset:6144
Mvva 176,240,124
Mvva 164,228,112
ds_read_b64_tr_b16 v[196:197], v13 offset:0
ds_read_b64_tr_b16 v[198:199], v13 offset:2048
Mvva 164,244,120
buffer_load_dwordx4 a[204:207], v112, s[8:11], s52 offen offset:1024 sc1
s_add_u32 s52, s52, 8192
Mvva 180,228,116
s_waitcnt lgkmcnt(10)
ds_read_b64_tr_b16 v[212:213], v13 offset:4096
ds_read_b64_tr_b16 v[214:215], v13 offset:6144
Mvva 180,244,124
buffer_load_dwordx4 a[208:211], v112, s[8:11], s52 offen offset:0 sc1
Mvva 168,232,112
ds_read_b64_tr_b16 v[200:201], v14 offset:0
ds_read_b64_tr_b16 v[202:203], v14 offset:2048
Mvva 168,248,120
buffer_load_dwordx4 a[212:215], v112, s[8:11], s52 offen offset:1024 sc1
s_add_u32 s52, s52, 8192
Mvva 184,232,116
s_waitcnt lgkmcnt(10)
ds_read_b64_tr_b16 v[216:217], v14 offset:4096
ds_read_b64_tr_b16 v[218:219], v14 offset:6144
Mvva 184,248,124
Mvva 172,236,112
ds_read_b64_tr_b16 v[204:205], v15 offset:0
ds_read_b64_tr_b16 v[206:207], v15 offset:2048
Mvva 172,252,120
buffer_load_dwordx4 a[216:219], v112, s[8:11], s52 offen offset:0 sc1
Mvva 188,236,116
s_waitcnt lgkmcnt(10)
ds_read_b64_tr_b16 v[220:221], v15 offset:4096
ds_read_b64_tr_b16 v[222:223], v15 offset:6144
Mvva 188,252,124
buffer_load_dwordx4 a[220:223], v112, s[8:11], s52 offen offset:1024 sc1
s_add_u32 s52, s52, 8192
s_waitcnt vmcnt(28)
Mvva 160,192,128
s_add_u32 m0, s44, 114688
ds_read_b64_tr_b16 v[224:225], v12 offset:8192
ds_read_b64_tr_b16 v[226:227], v12 offset:10240
Mvva 160,208,136
buffer_load_dwordx4 v114, s[12:15], s48 offen offset:0 lds
Mvva 176,192,132
s_waitcnt lgkmcnt(10)
ds_read_b64_tr_b16 v[240:241], v12 offset:12288
ds_read_b64_tr_b16 v[242:243], v12 offset:14336
Mvva 176,208,140
Mvva 164,196,128
ds_read_b64_tr_b16 v[228:229], v13 offset:8192
ds_read_b64_tr_b16 v[230:231], v13 offset:10240
Mvva 164,212,136
buffer_load_dwordx4 v114, s[12:15], s49 offen offset:1024 lds
Mvva 180,196,132
s_waitcnt lgkmcnt(10)
ds_read_b64_tr_b16 v[244:245], v13 offset:12288
ds_read_b64_tr_b16 v[246:247], v13 offset:14336
Mvva 180,212,140
buffer_load_dwordx4 v114, s[12:15], s50 offen offset:2048 lds
Mvva 168,200,128
ds_read_b64_tr_b16 v[232:233], v14 offset:8192
ds_read_b64_tr_b16 v[234:235], v14 offset:10240
Mvva 168,216,136
buffer_load_dwordx4 v114, s[12:15], s51 offen offset:3072 lds
s_xor_b32 s95, s95, 128
v_add_u32 v114, s95, v113
Mvva 184,200,132
s_waitcnt lgkmcnt(10)
ds_read_b64_tr_b16 v[248:249], v14 offset:12288
ds_read_b64_tr_b16 v[250:251], v14 offset:14336
Mvva 184,216,140
Mvva 172,204,128
s_waitcnt vmcnt(24)
ds_read_b64_tr_b16 v[236:237], v15 offset:8192
ds_read_b64_tr_b16 v[238:239], v15 offset:10240
Mvva 172,220,136
s_waitcnt lgkmcnt(10)
buffer_load_dwordx4 a[224:227], v112, s[8:11], s52 offen offset:0 sc1
Mvva 188,204,132
s_barrier
ds_read_b64_tr_b16 v[252:253], v15 offset:12288
ds_read_b64_tr_b16 v[254:255], v15 offset:14336
Mvva 188,220,140
buffer_load_dwordx4 a[228:231], v112, s[8:11], s52 offen offset:1024 sc1
s_add_u32 s52, s52, 8192
Mvva 160,224,144
ds_read_b64_tr_b16 v[192:193], v12 offset:16384
ds_read_b64_tr_b16 v[194:195], v12 offset:18432
Mvva 160,240,152
buffer_load_dwordx4 a[232:235], v112, s[8:11], s52 offen offset:0 sc1
Mvva 176,224,148
s_waitcnt lgkmcnt(10)
ds_read_b64_tr_b16 v[208:209], v12 offset:20480
ds_read_b64_tr_b16 v[210:211], v12 offset:22528
Mvva 176,240,156
Mvva 164,228,144
ds_read_b64_tr_b16 v[196:197], v13 offset:16384
ds_read_b64_tr_b16 v[198:199], v13 offset:18432
Mvva 164,244,152
buffer_load_dwordx4 a[236:239], v112, s[8:11], s52 offen offset:1024 sc1
s_add_u32 s52, s52, 8192
Mvva 180,228,148
s_waitcnt lgkmcnt(10)
ds_read_b64_tr_b16 v[212:213], v13 offset:20480
ds_read_b64_tr_b16 v[214:215], v13 offset:22528
Mvva 180,244,156
buffer_load_dwordx4 a[240:243], v112, s[8:11], s52 offen offset:0 sc1
Mvva 168,232,144
ds_read_b64_tr_b16 v[200:201], v14 offset:16384
ds_read_b64_tr_b16 v[202:203], v14 offset:18432
Mvva 168,248,152
buffer_load_dwordx4 a[244:247], v112, s[8:11], s52 offen offset:1024 sc1
s_add_u32 s52, s52, 8192
Mvva 184,232,148
s_waitcnt lgkmcnt(10)
ds_read_b64_tr_b16 v[216:217], v14 offset:20480
ds_read_b64_tr_b16 v[218:219], v14 offset:22528
Mvva 184,248,156
Mvva 172,236,144
ds_read_b64_tr_b16 v[204:205], v15 offset:16384
ds_read_b64_tr_b16 v[206:207], v15 offset:18432
Mvva 172,252,152
buffer_load_dwordx4 a[248:251], v112, s[8:11], s52 offen offset:0 sc1
Mvva 188,236,148
s_waitcnt lgkmcnt(10)
ds_read_b64_tr_b16 v[220:221], v15 offset:20480
ds_read_b64_tr_b16 v[222:223], v15 offset:22528
Mvva 188,252,156
buffer_load_dwordx4 a[252:255], v112, s[8:11], s52 offen offset:1024 sc1
s_add_u32 s52, s52, 8192
s_waitcnt vmcnt(28)
Mvva 160,192,160
s_add_u32 m0, s44, 0
ds_read_b64_tr_b16 v[224:225], v12 offset:24576
ds_read_b64_tr_b16 v[226:227], v12 offset:26624
Mvva 160,208,168
buffer_load_dwordx4 v114, s[12:15], s48 offen offset:0 lds
Mvva 176,192,164
s_waitcnt lgkmcnt(10)
ds_read_b64_tr_b16 v[240:241], v12 offset:28672
ds_read_b64_tr_b16 v[242:243], v12 offset:30720
Mvva 176,208,172
Mvva 164,196,160
ds_read_b64_tr_b16 v[228:229], v13 offset:24576
ds_read_b64_tr_b16 v[230:231], v13 offset:26624
Mvva 164,212,168
buffer_load_dwordx4 v114, s[12:15], s49 offen offset:1024 lds
Mvva 180,196,164
s_waitcnt lgkmcnt(10)
ds_read_b64_tr_b16 v[244:245], v13 offset:28672
ds_read_b64_tr_b16 v[246:247], v13 offset:30720
Mvva 180,212,172
buffer_load_dwordx4 v114, s[12:15], s50 offen offset:2048 lds
Mvva 168,200,160
ds_read_b64_tr_b16 v[232:233], v14 offset:24576
ds_read_b64_tr_b16 v[234:235], v14 offset:26624
Mvva 168,216,168
buffer_load_dwordx4 v114, s[12:15], s51 offen offset:3072 lds
v_add_u32 v114, 262144, v114
Mvva 184,200,164
s_waitcnt lgkmcnt(10)
ds_read_b64_tr_b16 v[248:249], v14 offset:28672
ds_read_b64_tr_b16 v[250:251], v14 offset:30720
Mvva 184,216,172
Mvva 172,204,160
s_waitcnt vmcnt(24)
s_add_u32 m0, s44, 16384
ds_read_b64_tr_b16 v[236:237], v15 offset:24576
ds_read_b64_tr_b16 v[238:239], v15 offset:26624
Mvva 172,220,168
s_waitcnt lgkmcnt(10)
buffer_load_dwordx4 v114, s[12:15], s48 offen offset:0 lds
Mvva 188,204,164
s_barrier
ds_read_b64_tr_b16 v[252:253], v15 offset:28672
ds_read_b64_tr_b16 v[254:255], v15 offset:30720
Mvva 188,220,172
buffer_load_dwordx4 v114, s[12:15], s49 offen offset:1024 lds
Mvva 160,224,176
ds_read_b64_tr_b16 v[192:193], v12 offset:32768
ds_read_b64_tr_b16 v[194:195], v12 offset:34816
Mvva 160,240,184
buffer_load_dwordx4 v114, s[12:15], s50 offen offset:2048 lds
Mvva 176,224,180
s_waitcnt lgkmcnt(10)
ds_read_b64_tr_b16 v[208:209], v12 offset:36864
ds_read_b64_tr_b16 v[210:211], v12 offset:38912
Mvva 176,240,188
s_cmp_lg_u32 s53, 0
s_cbranch_scc1 L_yB
L_yBr:
Mvva 164,228,176
ds_read_b64_tr_b16 v[196:197], v13 offset:32768
ds_read_b64_tr_b16 v[198:199], v13 offset:34816
Mvva 164,244,184
buffer_load_dwordx4 v114, s[12:15], s51 offen offset:3072 lds
v_add_u32 v114, 262144, v114
Mvva 180,228,180
s_waitcnt lgkmcnt(10)
s_add_u32 m0, s44, 32768
ds_read_b64_tr_b16 v[212:213], v13 offset:36864
ds_read_b64_tr_b16 v[214:215], v13 offset:38912
Mvva 180,244,188
buffer_load_dwordx4 v114, s[12:15], s48 offen offset:0 lds
Mvva 168,232,176
ds_read_b64_tr_b16 v[200:201], v14 offset:32768
ds_read_b64_tr_b16 v[202:203], v14 offset:34816
Mvva 168,248,184
buffer_load_dwordx4 v114, s[12:15], s49 offen offset:1024 lds
Mvva 184,232,180
s_waitcnt lgkmcnt(10)
ds_read_b64_tr_b16 v[216:217], v14 offset:36864
ds_read_b64_tr_b16 v[218:219], v14 offset:38912
Mvva 184,248,188
Mvva 172,236,176
ds_read_b64_tr_b16 v[204:205], v15 offset:32768
ds_read_b64_tr_b16 v[206:207], v15 offset:34816
Mvva 172,252,184
buffer_load_dwordx4 v114, s[12:15], s50 offen offset:2048 lds
Mvva 188,236,180
s_waitcnt lgkmcnt(10)
ds_read_b64_tr_b16 v[220:221], v15 offset:36864
ds_read_b64_tr_b16 v[222:223], v15 offset:38912
Mvva 188,252,188
buffer_load_dwordx4 v114, s[12:15], s51 offen offset:3072 lds
v_add_u32 v114, 262144, v114
s_waitcnt vmcnt(28)
Mvva 160,192,192
ds_read_b64_tr_b16 v[224:225], v12 offset:40960
ds_read_b64_tr_b16 v[226:227], v12 offset:43008
Mvva 160,208,200
Mvva 176,192,196
s_waitcnt lgkmcnt(10)
s_add_u32 m0, s44, 49152
ds_read_b64_tr_b16 v[240:241], v12 offset:45056
ds_read_b64_tr_b16 v[242:243], v12 offset:47104
Mvva 176,208,204
buffer_load_dwordx4 v114, s[12:15], s48 offen offset:0 lds
Mvva 164,196,192
ds_read_b64_tr_b16 v[228:229], v13 offset:40960
ds_read_b64_tr_b16 v[230:231], v13 offset:43008
Mvva 164,212,200
Mvva 180,196,196
s_waitcnt lgkmcnt(10)
ds_read_b64_tr_b16 v[244:245], v13 offset:45056
ds_read_b64_tr_b16 v[246:247], v13 offset:47104
Mvva 180,212,204
buffer_load_dwordx4 v114, s[12:15], s49 offen offset:1024 lds
Mvva 168,200,192
ds_read_b64_tr_b16 v[232:233], v14 offset:40960
ds_read_b64_tr_b16 v[234:235], v14 offset:43008
Mvva 168,216,200
Mvva 184,200,196
s_waitcnt lgkmcnt(10)
ds_read_b64_tr_b16 v[248:249], v14 offset:45056
ds_read_b64_tr_b16 v[250:251], v14 offset:47104
Mvva 184,216,204
buffer_load_dwordx4 v114, s[12:15], s50 offen offset:2048 lds
Mvva 172,204,192
s_waitcnt vmcnt(23)
ds_read_b64_tr_b16 v[236:237], v15 offset:40960
ds_read_b64_tr_b16 v[238:239], v15 offset:43008
Mvva 172,220,200
s_waitcnt lgkmcnt(10)
Mvva 188,204,196
s_barrier
ds_read_b64_tr_b16 v[252:253], v15 offset:45056
ds_read_b64_tr_b16 v[254:255], v15 offset:47104
Mvva 188,220,204
buffer_load_dwordx4 v114, s[12:15], s51 offen offset:3072 lds
v_add_u32 v114, 262144, v114
Mvva 160,224,208
ds_read_b64_tr_b16 v[192:193], v12 offset:49152
ds_read_b64_tr_b16 v[194:195], v12 offset:51200
Mvva 160,240,216
Mvva 176,224,212
s_waitcnt lgkmcnt(10)
s_add_u32 m0, s44, 65536
ds_read_b64_tr_b16 v[208:209], v12 offset:53248
ds_read_b64_tr_b16 v[210:211], v12 offset:55296
Mvva 176,240,220
buffer_load_dwordx4 v114, s[12:15], s48 offen offset:0 lds
Mvva 164,228,208
ds_read_b64_tr_b16 v[196:197], v13 offset:49152
ds_read_b64_tr_b16 v[198:199], v13 offset:51200
Mvva 164,244,216
Mvva 180,228,212
s_waitcnt lgkmcnt(10)
ds_read_b64_tr_b16 v[212:213], v13 offset:53248
ds_read_b64_tr_b16 v[214:215], v13 offset:55296
Mvva 180,244,220
buffer_load_dwordx4 v114, s[12:15], s49 offen offset:1024 lds
Mvva 168,232,208
ds_read_b64_tr_b16 v[200:201], v14 offset:49152
ds_read_b64_tr_b16 v[202:203], v14 offset:51200
Mvva 168,248,216
Mvva 184,232,212
s_waitcnt lgkmcnt(10)
ds_read_b64_tr_b16 v[216:217], v14 offset:53248
ds_read_b64_tr_b16 v[218:219], v14 offset:55296
Mvva 184,248,220
buffer_load_dwordx4 v114, s[12:15], s50 offen offset:2048 lds
Mvva 172,236,208
ds_read_b64_tr_b16 v[204:205], v15 offset:49152
ds_read_b64_tr_b16 v[206:207], v15 offset:51200
Mvva 172,252,216
Mvva 188,236,212
s_waitcnt lgkmcnt(10)
ds_read_b64_tr_b16 v[220:221], v15 offset:53248
ds_read_b64_tr_b16 v[222:223], v15 offset:55296
Mvva 188,252,220
buffer_load_dwordx4 v114, s[12:15], s51 offen offset:3072 lds
v_add_u32 v114, 262144, v114
s_waitcnt vmcnt(24)
Mvva 160,192,224
ds_read_b64_tr_b16 v[224:225], v12 offset:57344
ds_read_b64_tr_b16 v[226:227], v12 offset:59392
Mvva 160,208,232
Mvva 176,192,228
s_waitcnt lgkmcnt(10)
ds_read_b64_tr_b16 v[240:241], v12 offset:61440
ds_read_b64_tr_b16 v[242:243], v12 offset:63488
Mvva 176,208,236
Mvva 164,196,224
s_add_u32 m0, s44, 81920
ds_read_b64_tr_b16 v[228:229], v13 offset:57344
ds_read_b64_tr_b16 v[230:231], v13 offset:59392
Mvva 164,212,232
buffer_load_dwordx4 v114, s[12:15], s48 offen offset:0 lds
Mvva 180,196,228
s_waitcnt lgkmcnt(10)
ds_read_b64_tr_b16 v[244:245], v13 offset:61440
ds_read_b64_tr_b16 v[246:247], v13 offset:63488
Mvva 180,212,236
Mvva 168,200,224
ds_read_b64_tr_b16 v[232:233], v14 offset:57344
ds_read_b64_tr_b16 v[234:235], v14 offset:59392
Mvva 168,216,232
Mvva 184,200,228
s_waitcnt lgkmcnt(10)
ds_read_b64_tr_b16 v[248:249], v14 offset:61440
ds_read_b64_tr_b16 v[250:251], v14 offset:63488
Mvva 184,216,236
Mvva 172,204,224
s_waitcnt vmcnt(17)
ds_read_b64_tr_b16 v[236:237], v15 offset:57344
ds_read_b64_tr_b16 v[238:239], v15 offset:59392
Mvva 172,220,232
s_waitcnt lgkmcnt(10)
buffer_load_dwordx4 v114, s[12:15], s49 offen offset:1024 lds
Mvva 188,204,228
s_barrier
ds_read_b64_tr_b16 v[252:253], v15 offset:61440
ds_read_b64_tr_b16 v[254:255], v15 offset:63488
Mvva 188,220,236
Mvva 160,224,240
ds_read_b64_tr_b16 v[192:193], v115 offset:0
ds_read_b64_tr_b16 v[194:195], v115 offset:2048
Mvva 160,240,248
s_cmp_lg_u32 s40, 0
s_cbranch_scc1 L_yC
L_yCr:
Mvva 176,224,244
s_waitcnt lgkmcnt(10)
ds_read_b64_tr_b16 v[208:209], v115 offset:4096
ds_read_b64_tr_b16 v[210:211], v115 offset:6144
Mvva 176,240,252
Mvva 164,228,240
ds_read_b64_tr_b16 v[196:197], v116 offset:0
ds_read_b64_tr_b16 v[198:199], v116 offset:2048
Mvva 164,244,248
buffer_load_dwordx4 v114, s[12:15], s50 offen offset:2048 lds
Mvva 180,228,244
s_waitcnt lgkmcnt(10)
ds_read_b64_tr_b16 v[212:213], v116 offset:4096
ds_read_b64_tr_b16 v[214:215], v116 offset:6144
Mvva 180,244,252
Mvva 168,232,240
ds_read_b64_tr_b16 v[200:201], v117 offset:0
ds_read_b64_tr_b16 v[202:203], v117 offset:2048
Mvva 168,248,248
Mvva 184,232,244
s_waitcnt lgkmcnt(10)
ds_read_b64_tr_b16 v[216:217], v117 offset:4096
ds_read_b64_tr_b16 v[218:219], v117 offset:6144
Mvva 184,248,252
Mvva 172,236,240
ds_read_b64_tr_b16 v[204:205], v118 offset:0
ds_read_b64_tr_b16 v[206:207], v118 offset:2048
Mvva 172,252,248
buffer_load_dwordx4 v114, s[12:15], s51 offen offset:3072 lds
v_add_u32 v114, 262144, v114
Mvva 188,236,244
s_waitcnt lgkmcnt(10)
ds_read_b64_tr_b16 v[220:221], v118 offset:4096
ds_read_b64_tr_b16 v[222:223], v118 offset:6144
Mvva 188,252,252
Mvva 128,192,0
ds_read_b64_tr_b16 v[224:225], v115 offset:8192
ds_read_b64_tr_b16 v[226:227], v115 offset:10240
Mvva 128,208,8
Mvva 144,192,4
s_waitcnt lgkmcnt(10)
ds_read_b64_tr_b16 v[240:241], v115 offset:12288
ds_read_b64_tr_b16 v[242:243], v115 offset:14336
Mvva 144,208,12
Mvva 132,196,0
s_add_u32 m0, s44, 98304
ds_read_b64_tr_b16 v[228:229], v116 offset:8192
ds_read_b64_tr_b16 v[230:231], v116 offset:10240
Mvva 132,212,8
buffer_load_dwordx4 v114, s[12:15], s48 offen offset:0 lds
Mvva 148,196,4
s_waitcnt lgkmcnt(10)
ds_read_b64_tr_b16 v[244:245], v116 offset:12288
ds_read_b64_tr_b16 v[246:247], v116 offset:14336
Mvva 148,212,12
v_add_u32 v10, 4096, v112
Mvva 136,200,0
ds_read_b64_tr_b16 v[232:233], v117 offset:8192
ds_read_b64_tr_b16 v[234:235], v117 offset:10240
Mvva 136,216,8
buffer_store_dwordx4 v[160:163], v112, s[16:19], s26 offen offset:0 sc1
Mvva 152,200,4
s_waitcnt lgkmcnt(10)
ds_read_b64_tr_b16 v[248:249], v117 offset:12288
ds_read_b64_tr_b16 v[250:251], v117 offset:14336
Mvva 152,216,12
buffer_store_dwordx4 v[164:167], v112, s[16:19], s26 offen offset:1024 sc1
Mvva 140,204,0
s_waitcnt vmcnt(19)
ds_read_b64_tr_b16 v[236:237], v118 offset:8192
ds_read_b64_tr_b16 v[238:239], v118 offset:10240
Mvva 140,220,8
s_waitcnt lgkmcnt(10)
buffer_load_dwordx4 v114, s[12:15], s49 offen offset:1024 lds
Mvva 156,204,4
s_barrier
ds_read_b64_tr_b16 v[252:253], v118 offset:12288
ds_read_b64_tr_b16 v[254:255], v118 offset:14336
Mvva 156,220,12
buffer_store_dwordx4 v[168:171], v112, s[16:19], s26 offen offset:2048 sc1
Mvva 128,224,16
ds_read_b64_tr_b16 v[192:193], v115 offset:16384
ds_read_b64_tr_b16 v[194:195], v115 offset:18432
Mvva 128,240,24
buffer_store_dwordx4 v[172:175], v112, s[16:19], s26 offen offset:3072 sc1
Mvva 144,224,20
s_waitcnt lgkmcnt(10)
ds_read_b64_tr_b16 v[208:209], v115 offset:20480
ds_read_b64_tr_b16 v[210:211], v115 offset:22528
Mvva 144,240,28
buffer_store_dwordx4 v[176:179], v10, s[16:19], s26 offen offset:0 sc1
Mvva 132,228,16
ds_read_b64_tr_b16 v[196:197], v116 offset:16384
ds_read_b64_tr_b16 v[198:199], v116 offset:18432
Mvva 132,244,24
buffer_load_dwordx4 v114, s[12:15], s50 offen offset:2048 lds
Mvva 148,228,20
s_waitcnt lgkmcnt(10)
ds_read_b64_tr_b16 v[212:213], v116 offset:20480
ds_read_b64_tr_b16 v[214:215], v116 offset:22528
Mvva 148,244,28
buffer_store_dwordx4 v[180:183], v10, s[16:19], s26 offen offset:1024 sc1
Mvva 136,232,16
ds_read_b64_tr_b16 v[200:201], v117 offset:16384
ds_read_b64_tr_b16 v[202:203], v117 offset:18432
Mvva 136,248,24
buffer_store_dwordx4 v[184:187], v10, s[16:19], s26 offen offset:2048 sc1
Mvva 152,232,20
s_waitcnt lgkmcnt(10)
ds_read_b64_tr_b16 v[216:217], v117 offset:20480
ds_read_b64_tr_b16 v[218:219], v117 offset:22528
Mvva 152,248,28
buffer_store_dwordx4 v[188:191], v10, s[16:19], s26 offen offset:3072 sc1
Mvva 140,236,16
ds_read_b64_tr_b16 v[204:205], v118 offset:16384
ds_read_b64_tr_b16 v[206:207], v118 offset:18432
Mvva 140,252,24
buffer_load_dwordx4 v114, s[12:15], s51 offen offset:3072 lds
v_add_u32 v114, 262144, v114
Mvva 156,236,20
s_waitcnt lgkmcnt(10)
ds_read_b64_tr_b16 v[220:221], v118 offset:20480
ds_read_b64_tr_b16 v[222:223], v118 offset:22528
Mvva 156,252,28
v_mov_b32_e64 v16, 1
Mvva 128,192,32
ds_read_b64_tr_b16 v[224:225], v115 offset:24576
ds_read_b64_tr_b16 v[226:227], v115 offset:26624
Mvva 128,208,40
Mvva 144,192,36
s_waitcnt lgkmcnt(10)
ds_read_b64_tr_b16 v[240:241], v115 offset:28672
ds_read_b64_tr_b16 v[242:243], v115 offset:30720
Mvva 144,208,44
Mvva 132,196,32
s_add_u32 m0, s44, 114688
ds_read_b64_tr_b16 v[228:229], v116 offset:24576
ds_read_b64_tr_b16 v[230:231], v116 offset:26624
Mvva 132,212,40
buffer_load_dwordx4 v114, s[12:15], s48 offen offset:0 lds
Mvva 148,196,36
s_waitcnt lgkmcnt(10)
ds_read_b64_tr_b16 v[244:245], v116 offset:28672
ds_read_b64_tr_b16 v[246:247], v116 offset:30720
Mvva 148,212,44
Mvva 136,200,32
ds_read_b64_tr_b16 v[232:233], v117 offset:24576
ds_read_b64_tr_b16 v[234:235], v117 offset:26624
Mvva 136,216,40
Mvva 152,200,36
s_waitcnt lgkmcnt(10)
ds_read_b64_tr_b16 v[248:249], v117 offset:28672
ds_read_b64_tr_b16 v[250:251], v117 offset:30720
Mvva 152,216,44
Mvva 140,204,32
s_waitcnt vmcnt(25)
ds_read_b64_tr_b16 v[236:237], v118 offset:24576
ds_read_b64_tr_b16 v[238:239], v118 offset:26624
Mvva 140,220,40
s_waitcnt lgkmcnt(10)
buffer_load_dwordx4 v114, s[12:15], s49 offen offset:1024 lds
Mvva 156,204,36
s_barrier
ds_read_b64_tr_b16 v[252:253], v118 offset:28672
ds_read_b64_tr_b16 v[254:255], v118 offset:30720
Mvva 156,220,44
Mvva 128,224,48
ds_read_b64_tr_b16 v[192:193], v115 offset:32768
ds_read_b64_tr_b16 v[194:195], v115 offset:34816
Mvva 128,240,56
Mvva 144,224,52
s_waitcnt lgkmcnt(10)
ds_read_b64_tr_b16 v[208:209], v115 offset:36864
ds_read_b64_tr_b16 v[210:211], v115 offset:38912
Mvva 144,240,60
Mvva 132,228,48
ds_read_b64_tr_b16 v[196:197], v116 offset:32768
ds_read_b64_tr_b16 v[198:199], v116 offset:34816
Mvva 132,244,56
buffer_load_dwordx4 v114, s[12:15], s50 offen offset:2048 lds
Mvva 148,228,52
s_waitcnt lgkmcnt(10)
ds_read_b64_tr_b16 v[212:213], v116 offset:36864
ds_read_b64_tr_b16 v[214:215], v116 offset:38912
Mvva 148,244,60
Mvva 136,232,48
ds_read_b64_tr_b16 v[200:201], v117 offset:32768
ds_read_b64_tr_b16 v[202:203], v117 offset:34816
Mvva 136,248,56
Mvva 152,232,52
s_waitcnt lgkmcnt(10)
ds_read_b64_tr_b16 v[216:217], v117 offset:36864
ds_read_b64_tr_b16 v[218:219], v117 offset:38912
Mvva 152,248,60
Mvva 140,236,48
ds_read_b64_tr_b16 v[204:205], v118 offset:32768
ds_read_b64_tr_b16 v[206:207], v118 offset:34816
Mvva 140,252,56
buffer_load_dwordx4 v114, s[12:15], s51 offen offset:3072 lds
v_add_u32 v114, 262144, v114
Mvva 156,236,52
s_waitcnt lgkmcnt(10)
ds_read_b64_tr_b16 v[220:221], v118 offset:36864
ds_read_b64_tr_b16 v[222:223], v118 offset:38912
Mvva 156,252,60
Mvva 128,192,64
ds_read_b64_tr_b16 v[224:225], v115 offset:40960
ds_read_b64_tr_b16 v[226:227], v115 offset:43008
Mvva 128,208,72
Mvva 144,192,68
s_waitcnt lgkmcnt(10)
ds_read_b64_tr_b16 v[240:241], v115 offset:45056
ds_read_b64_tr_b16 v[242:243], v115 offset:47104
Mvva 144,208,76
Mvva 132,196,64
ds_read_b64_tr_b16 v[228:229], v116 offset:40960
ds_read_b64_tr_b16 v[230:231], v116 offset:43008
Mvva 132,212,72
Mvva 148,196,68
s_waitcnt lgkmcnt(10)
ds_read_b64_tr_b16 v[244:245], v116 offset:45056
ds_read_b64_tr_b16 v[246:247], v116 offset:47104
Mvva 148,212,76
Mvva 136,200,64
ds_read_b64_tr_b16 v[232:233], v117 offset:40960
ds_read_b64_tr_b16 v[234:235], v117 offset:43008
Mvva 136,216,72
Mvva 152,200,68
s_waitcnt lgkmcnt(10)
ds_read_b64_tr_b16 v[248:249], v117 offset:45056
ds_read_b64_tr_b16 v[250:251], v117 offset:47104
Mvva 152,216,76
Mvva 140,204,64
s_waitcnt vmcnt(24)
ds_read_b64_tr_b16 v[236:237], v118 offset:40960
ds_read_b64_tr_b16 v[238:239], v118 offset:43008
Mvva 140,220,72
s_waitcnt lgkmcnt(10)
Mvva 156,204,68
s_barrier
ds_read_b64_tr_b16 v[252:253], v118 offset:45056
ds_read_b64_tr_b16 v[254:255], v118 offset:47104
Mvva 156,220,76
Mvva 128,224,80
ds_read_b64_tr_b16 v[192:193], v115 offset:49152
ds_read_b64_tr_b16 v[194:195], v115 offset:51200
Mvva 128,240,88
Mvva 144,224,84
s_waitcnt lgkmcnt(10)
ds_read_b64_tr_b16 v[208:209], v115 offset:53248
ds_read_b64_tr_b16 v[210:211], v115 offset:55296
Mvva 144,240,92
Mvva 132,228,80
ds_read_b64_tr_b16 v[196:197], v116 offset:49152
ds_read_b64_tr_b16 v[198:199], v116 offset:51200
Mvva 132,244,88
Mvva 148,228,84
s_waitcnt lgkmcnt(10)
ds_read_b64_tr_b16 v[212:213], v116 offset:53248
ds_read_b64_tr_b16 v[214:215], v116 offset:55296
Mvva 148,244,92
Mvva 136,232,80
ds_read_b64_tr_b16 v[200:201], v117 offset:49152
ds_read_b64_tr_b16 v[202:203], v117 offset:51200
Mvva 136,248,88
Mvva 152,232,84
s_waitcnt lgkmcnt(10)
ds_read_b64_tr_b16 v[216:217], v117 offset:53248
ds_read_b64_tr_b16 v[218:219], v117 offset:55296
Mvva 152,248,92
Mvva 140,236,80
ds_read_b64_tr_b16 v[204:205], v118 offset:49152
ds_read_b64_tr_b16 v[206:207], v118 offset:51200
Mvva 140,252,88
Mvva 156,236,84
s_waitcnt lgkmcnt(10)
ds_read_b64_tr_b16 v[220:221], v118 offset:53248
ds_read_b64_tr_b16 v[222:223], v118 offset:55296
Mvva 156,252,92
Mvva 128,192,96
ds_read_b64_tr_b16 v[224:225], v115 offset:57344
ds_read_b64_tr_b16 v[226:227], v115 offset:59392
Mvva 128,208,104
Mvva 144,192,100
s_waitcnt lgkmcnt(10)
ds_read_b64_tr_b16 v[240:241], v115 offset:61440
ds_read_b64_tr_b16 v[242:243], v115 offset:63488
Mvva 144,208,108
Mvva 132,196,96
ds_read_b64_tr_b16 v[228:229], v116 offset:57344
ds_read_b64_tr_b16 v[230:231], v116 offset:59392
Mvva 132,212,104
Mvva 148,196,100
s_waitcnt lgkmcnt(10)
ds_read_b64_tr_b16 v[244:245], v116 offset:61440
ds_read_b64_tr_b16 v[246:247], v116 offset:63488
Mvva 148,212,108
s_waitcnt vmcnt(5)
s_mov_b64 exec, 1
buffer_store_dword v16, v126, s[20:23], s27 offen sc1
s_mov_b64 exec, -1
Mvva 136,200,96
ds_read_b64_tr_b16 v[232:233], v117 offset:57344
ds_read_b64_tr_b16 v[234:235], v117 offset:59392
Mvva 136,216,104
Mvva 152,200,100
s_waitcnt lgkmcnt(10)
ds_read_b64_tr_b16 v[248:249], v117 offset:61440
ds_read_b64_tr_b16 v[250:251], v117 offset:63488
Mvva 152,216,108
Mvva 140,204,96
ds_read_b64_tr_b16 v[236:237], v118 offset:57344
ds_read_b64_tr_b16 v[238:239], v118 offset:59392
Mvva 140,220,104
s_waitcnt lgkmcnt(10)
Mvva 156,204,100
s_barrier
ds_read_b64_tr_b16 v[252:253], v118 offset:61440
ds_read_b64_tr_b16 v[254:255], v118 offset:63488
Mvva 156,220,108
Mvva 128,224,112
ds_read_b64_tr_b16 v[192:193], v12 offset:0
ds_read_b64_tr_b16 v[194:195], v12 offset:2048
Mvva 128,240,120
Mvva 144,224,116
s_waitcnt lgkmcnt(10)
ds_read_b64_tr_b16 v[208:209], v12 offset:4096
ds_read_b64_tr_b16 v[210:211], v12 offset:6144
Mvva 144,240,124
Mvva 132,228,112
ds_read_b64_tr_b16 v[196:197], v13 offset:0
ds_read_b64_tr_b16 v[198:199], v13 offset:2048
Mvva 132,244,120
Mvva 148,228,116
s_waitcnt lgkmcnt(10)
ds_read_b64_tr_b16 v[212:213], v13 offset:4096
ds_read_b64_tr_b16 v[214:215], v13 offset:6144
Mvva 148,244,124
Mvva 136,232,112
ds_read_b64_tr_b16 v[200:201], v14 offset:0
ds_read_b64_tr_b16 v[202:203], v14 offset:2048
Mvva 136,248,120
Mvva 152,232,116
s_waitcnt lgkmcnt(10)
ds_read_b64_tr_b16 v[216:217], v14 offset:4096
ds_read_b64_tr_b16 v[218:219], v14 offset:6144
Mvva 152,248,124
Mvva 140,236,112
ds_read_b64_tr_b16 v[204:205], v15 offset:0
ds_read_b64_tr_b16 v[206:207], v15 offset:2048
Mvva 140,252,120
Mvva 156,236,116
s_waitcnt lgkmcnt(10)
ds_read_b64_tr_b16 v[220:221], v15 offset:4096
ds_read_b64_tr_b16 v[222:223], v15 offset:6144
Mvva 156,252,124
Mvva 128,192,128
ds_read_b64_tr_b16 v[224:225], v12 offset:8192
ds_read_b64_tr_b16 v[226:227], v12 offset:10240
Mvva 128,208,136
Mvva 144,192,132
s_waitcnt lgkmcnt(10)
ds_read_b64_tr_b16 v[240:241], v12 offset:12288
ds_read_b64_tr_b16 v[242:243], v12 offset:14336
Mvva 144,208,140
Mvva 132,196,128
ds_read_b64_tr_b16 v[228:229], v13 offset:8192
ds_read_b64_tr_b16 v[230:231], v13 offset:10240
Mvva 132,212,136
Mvva 148,196,132
s_waitcnt lgkmcnt(10)
ds_read_b64_tr_b16 v[244:245], v13 offset:12288
ds_read_b64_tr_b16 v[246:247], v13 offset:14336
Mvva 148,212,140
Mvva 136,200,128
ds_read_b64_tr_b16 v[232:233], v14 offset:8192
ds_read_b64_tr_b16 v[234:235], v14 offset:10240
Mvva 136,216,136
Mvva 152,200,132
s_waitcnt lgkmcnt(10)
ds_read_b64_tr_b16 v[248:249], v14 offset:12288
ds_read_b64_tr_b16 v[250:251], v14 offset:14336
Mvva 152,216,140
Mvva 140,204,128
ds_read_b64_tr_b16 v[236:237], v15 offset:8192
ds_read_b64_tr_b16 v[238:239], v15 offset:10240
Mvva 140,220,136
s_waitcnt lgkmcnt(10)
Mvva 156,204,132
s_barrier
ds_read_b64_tr_b16 v[252:253], v15 offset:12288
ds_read_b64_tr_b16 v[254:255], v15 offset:14336
Mvva 156,220,140
Mvva 128,224,144
ds_read_b64_tr_b16 v[192:193], v12 offset:16384
ds_read_b64_tr_b16 v[194:195], v12 offset:18432
Mvva 128,240,152
Mvva 144,224,148
s_waitcnt lgkmcnt(10)
ds_read_b64_tr_b16 v[208:209], v12 offset:20480
ds_read_b64_tr_b16 v[210:211], v12 offset:22528
Mvva 144,240,156
Mvva 132,228,144
ds_read_b64_tr_b16 v[196:197], v13 offset:16384
ds_read_b64_tr_b16 v[198:199], v13 offset:18432
Mvva 132,244,152
buffer_load_dword v17, v126, s[20:23], s24 offen sc1
Mvva 148,228,148
s_waitcnt lgkmcnt(10)
ds_read_b64_tr_b16 v[212:213], v13 offset:20480
ds_read_b64_tr_b16 v[214:215], v13 offset:22528
Mvva 148,244,156
Mvva 136,232,144
ds_read_b64_tr_b16 v[200:201], v14 offset:16384
ds_read_b64_tr_b16 v[202:203], v14 offset:18432
Mvva 136,248,152
Mvva 152,232,148
s_waitcnt lgkmcnt(10)
ds_read_b64_tr_b16 v[216:217], v14 offset:20480
ds_read_b64_tr_b16 v[218:219], v14 offset:22528
Mvva 152,248,156
Mvva 140,236,144
ds_read_b64_tr_b16 v[204:205], v15 offset:16384
ds_read_b64_tr_b16 v[206:207], v15 offset:18432
Mvva 140,252,152
Mvva 156,236,148
s_waitcnt lgkmcnt(10)
ds_read_b64_tr_b16 v[220:221], v15 offset:20480
ds_read_b64_tr_b16 v[222:223], v15 offset:22528
Mvva 156,252,156
Mvva 128,192,160
ds_read_b64_tr_b16 v[224:225], v12 offset:24576
ds_read_b64_tr_b16 v[226:227], v12 offset:26624
Mvva 128,208,168
Mvva 144,192,164
s_waitcnt lgkmcnt(10)
ds_read_b64_tr_b16 v[240:241], v12 offset:28672
ds_read_b64_tr_b16 v[242:243], v12 offset:30720
Mvva 144,208,172
Mvva 132,196,160
ds_read_b64_tr_b16 v[228:229], v13 offset:24576
ds_read_b64_tr_b16 v[230:231], v13 offset:26624
Mvva 132,212,168
Mvva 148,196,164
s_waitcnt lgkmcnt(10)
ds_read_b64_tr_b16 v[244:245], v13 offset:28672
ds_read_b64_tr_b16 v[246:247], v13 offset:30720
Mvva 148,212,172
Mvva 136,200,160
ds_read_b64_tr_b16 v[232:233], v14 offset:24576
ds_read_b64_tr_b16 v[234:235], v14 offset:26624
Mvva 136,216,168
Mvva 152,200,164
s_waitcnt lgkmcnt(10)
ds_read_b64_tr_b16 v[248:249], v14 offset:28672
ds_read_b64_tr_b16 v[250:251], v14 offset:30720
Mvva 152,216,172
Mvva 140,204,160
s_waitcnt vmcnt(6)
ds_read_b64_tr_b16 v[236:237], v15 offset:24576
ds_read_b64_tr_b16 v[238:239], v15 offset:26624
Mvva 140,220,168
s_waitcnt lgkmcnt(10)
Mvva 156,204,164
s_barrier
ds_read_b64_tr_b16 v[252:253], v15 offset:28672
ds_read_b64_tr_b16 v[254:255], v15 offset:30720
Mvva 156,220,172
Mvva 128,224,176
ds_read_b64_tr_b16 v[192:193], v12 offset:32768
ds_read_b64_tr_b16 v[194:195], v12 offset:34816
Mvva 128,240,184
Mvva 144,224,180
s_waitcnt lgkmcnt(10)
ds_read_b64_tr_b16 v[208:209], v12 offset:36864
ds_read_b64_tr_b16 v[210:211], v12 offset:38912
Mvva 144,240,188
Mvva 132,228,176
ds_read_b64_tr_b16 v[196:197], v13 offset:32768
ds_read_b64_tr_b16 v[198:199], v13 offset:34816
Mvva 132,244,184
Mvva 148,228,180
s_waitcnt lgkmcnt(10)
ds_read_b64_tr_b16 v[212:213], v13 offset:36864
ds_read_b64_tr_b16 v[214:215], v13 offset:38912
Mvva 148,244,188
Mvva 136,232,176
ds_read_b64_tr_b16 v[200:201], v14 offset:32768
ds_read_b64_tr_b16 v[202:203], v14 offset:34816
Mvva 136,248,184
Mvva 152,232,180
s_waitcnt lgkmcnt(10)
ds_read_b64_tr_b16 v[216:217], v14 offset:36864
ds_read_b64_tr_b16 v[218:219], v14 offset:38912
Mvva 152,248,188
s_waitcnt vmcnt(0)
v_cmp_ne_u32 vcc, 1, v17
s_mov_b32 s33, 0
s_cbranch_vccnz L_xno
buffer_load_dwordx4 v[160:163], v112, s[16:19], s25 offen offset:0 sc1
buffer_load_dwordx4 v[164:167], v112, s[16:19], s25 offen offset:1024 sc1
buffer_load_dwordx4 v[168:171], v112, s[16:19], s25 offen offset:2048 sc1
buffer_load_dwordx4 v[172:175], v112, s[16:19], s25 offen offset:3072 sc1
buffer_load_dwordx4 v[176:179], v10, s[16:19], s25 offen offset:0 sc1
buffer_load_dwordx4 v[180:183], v10, s[16:19], s25 offen offset:1024 sc1
buffer_load_dwordx4 v[184:187], v10, s[16:19], s25 offen offset:2048 sc1
buffer_load_dwordx4 v[188:191], v10, s[16:19], s25 offen offset:3072 sc1
s_mov_b32 s33, 1
L_xno:
Mvva 140,236,176
ds_read_b64_tr_b16 v[204:205], v15 offset:32768
ds_read_b64_tr_b16 v[206:207], v15 offset:34816
Mvva 140,252,184
Mvva 156,236,180
s_waitcnt lgkmcnt(10)
ds_read_b64_tr_b16 v[220:221], v15 offset:36864
ds_read_b64_tr_b16 v[222:223], v15 offset:38912
Mvva 156,252,188
Mvva 128,192,192
ds_read_b64_tr_b16 v[224:225], v12 offset:40960
ds_read_b64_tr_b16 v[226:227], v12 offset:43008
Mvva 128,208,200
Mvva 144,192,196
s_waitcnt lgkmcnt(10)
ds_read_b64_tr_b16 v[240:241], v12 offset:45056
ds_read_b64_tr_b16 v[242:243], v12 offset:47104
Mvva 144,208,204
Mvva 132,196,192
ds_read_b64_tr_b16 v[228:229], v13 offset:40960
ds_read_b64_tr_b16 v[230:231], v13 offset:43008
Mvva 132,212,200
Mvva 148,196,196
s_waitcnt lgkmcnt(10)
ds_read_b64_tr_b16 v[244:245], v13 offset:45056
ds_read_b64_tr_b16 v[246:247], v13 offset:47104
Mvva 148,212,204
Mvva 136,200,192
ds_read_b64_tr_b16 v[232:233], v14 offset:40960
ds_read_b64_tr_b16 v[234:235], v14 offset:43008
Mvva 136,216,200
Mvva 152,200,196
s_waitcnt lgkmcnt(10)
ds_read_b64_tr_b16 v[248:249], v14 offset:45056
ds_read_b64_tr_b16 v[250:251], v14 offset:47104
Mvva 152,216,204
Mvva 140,204,192
ds_read_b64_tr_b16 v[236:237], v15 offset:40960
ds_read_b64_tr_b16 v[238:239], v15 offset:43008
Mvva 140,220,200
s_waitcnt lgkmcnt(10)
Mvva 156,204,196
s_barrier
ds_read_b64_tr_b16 v[252:253], v15 offset:45056
ds_read_b64_tr_b16 v[254:255], v15 offset:47104
Mvva 156,220,204
Mvva 128,224,208
ds_read_b64_tr_b16 v[192:193], v12 offset:49152
ds_read_b64_tr_b16 v[194:195], v12 offset:51200
Mvva 128,240,216
Mvva 144,224,212
s_waitcnt lgkmcnt(10)
ds_read_b64_tr_b16 v[208:209], v12 offset:53248
ds_read_b64_tr_b16 v[210:211], v12 offset:55296
Mvva 144,240,220
Mvva 132,228,208
ds_read_b64_tr_b16 v[196:197], v13 offset:49152
ds_read_b64_tr_b16 v[198:199], v13 offset:51200
Mvva 132,244,216
Mvva 148,228,212
s_waitcnt lgkmcnt(10)
ds_read_b64_tr_b16 v[212:213], v13 offset:53248
ds_read_b64_tr_b16 v[214:215], v13 offset:55296
Mvva 148,244,220
Mvva 136,232,208
ds_read_b64_tr_b16 v[200:201], v14 offset:49152
ds_read_b64_tr_b16 v[202:203], v14 offset:51200
Mvva 136,248,216
Mvva 152,232,212
s_waitcnt lgkmcnt(10)
ds_read_b64_tr_b16 v[216:217], v14 offset:53248
ds_read_b64_tr_b16 v[218:219], v14 offset:55296
Mvva 152,248,220
Mvva 140,236,208
ds_read_b64_tr_b16 v[204:205], v15 offset:49152
ds_read_b64_tr_b16 v[206:207], v15 offset:51200
Mvva 140,252,216
Mvva 156,236,212
s_waitcnt lgkmcnt(10)
ds_read_b64_tr_b16 v[220:221], v15 offset:53248
ds_read_b64_tr_b16 v[222:223], v15 offset:55296
Mvva 156,252,220
Mvva 128,192,224
ds_read_b64_tr_b16 v[224:225], v12 offset:57344
ds_read_b64_tr_b16 v[226:227], v12 offset:59392
Mvva 128,208,232
Mvva 144,192,228
s_waitcnt lgkmcnt(10)
ds_read_b64_tr_b16 v[240:241], v12 offset:61440
ds_read_b64_tr_b16 v[242:243], v12 offset:63488
Mvva 144,208,236
Mvva 132,196,224
ds_read_b64_tr_b16 v[228:229], v13 offset:57344
ds_read_b64_tr_b16 v[230:231], v13 offset:59392
Mvva 132,212,232
Mvva 148,196,228
s_waitcnt lgkmcnt(10)
ds_read_b64_tr_b16 v[244:245], v13 offset:61440
ds_read_b64_tr_b16 v[246:247], v13 offset:63488
Mvva 148,212,236
Mvva 136,200,224
ds_read_b64_tr_b16 v[232:233], v14 offset:57344
ds_read_b64_tr_b16 v[234:235], v14 offset:59392
Mvva 136,216,232
Mvva 152,200,228
s_waitcnt lgkmcnt(10)
ds_read_b64_tr_b16 v[248:249], v14 offset:61440
ds_read_b64_tr_b16 v[250:251], v14 offset:63488
Mvva 152,216,236
Mvva 140,204,224
ds_read_b64_tr_b16 v[236:237], v15 offset:57344
ds_read_b64_tr_b16 v[238:239], v15 offset:59392
Mvva 140,220,232
s_waitcnt lgkmcnt(10)
Mvva 156,204,228
ds_read_b64_tr_b16 v[252:253], v15 offset:61440
ds_read_b64_tr_b16 v[254:255], v15 offset:63488
Mvva 156,220,236
Mvva 128,224,240
Mvva 128,240,248
Mvva 144,224,244
s_waitcnt lgkmcnt(8)
Mvva 144,240,252
Mvva 132,228,240
Mvva 132,244,248
Mvva 148,228,244
s_waitcnt lgkmcnt(4)
Mvva 148,244,252
Mvva 136,232,240
Mvva 136,248,248
Mvva 152,232,244
s_waitcnt lgkmcnt(0)
Mvva 152,248,252
Mvva 140,236,240
Mvva 140,252,248
Mvva 156,236,244
Mvva 156,252,252
s_cmp_lg_u32 s53, s40
s_cbranch_scc1 L_ysl
L_yslr:
v_and_b32 v124, 15, v0
v_lshlrev_b32 v74, 8, v124
v_add_u32 v74, s35, v74
v_xor_b32 v124, v124, v121
v_lshl_add_u32 v74, v124, 4, v74
v_xor_b32_e64 v75, 64, v74
v_xor_b32 v76, 128, v74
v_xor_b32 v77, 192, v74
v_lshlrev_b32 v125, 1, v122
v_xor_b32 v124, v123, v125
v_lshlrev_b32 v12, 8, v123
v_add_u32 v12, s35, v12
v_lshl_add_u32 v12, v124, 4, v12
v_xor_b32_e64 v13, 16, v12
v_xor_b32 v14, 128, v12
v_xor_b32 v15, 144, v12
s_cmp_eq_u32 s33, 0
s_cbranch_scc1 L_spinX
L_spinXr:
v_lshlrev_b32_e64 v80, 16, v18
v_and_b32 v81, 0xffff0000, v18
v_lshlrev_b32_e64 v82, 16, v19
v_and_b32 v83, 0xffff0000, v19
v_lshlrev_b32_e64 v84, 16, v20
v_and_b32 v85, 0xffff0000, v20
v_lshlrev_b32_e64 v86, 16, v21
v_and_b32 v87, 0xffff0000, v21
v_lshlrev_b32_e64 v88, 16, v22
v_and_b32 v89, 0xffff0000, v22
v_lshlrev_b32_e64 v90, 16, v23
v_and_b32 v91, 0xffff0000, v23
v_lshlrev_b32_e64 v92, 16, v24
v_and_b32 v93, 0xffff0000, v24
v_lshlrev_b32_e64 v94, 16, v25
v_and_b32 v95, 0xffff0000, v25
v_lshlrev_b32_e64 v96, 16, v26
v_and_b32 v97, 0xffff0000, v26
v_lshlrev_b32_e64 v98, 16, v27
v_and_b32 v99, 0xffff0000, v27
v_lshlrev_b32_e64 v100, 16, v28
v_and_b32 v101, 0xffff0000, v28
v_lshlrev_b32_e64 v102, 16, v29
v_and_b32 v103, 0xffff0000, v29
v_lshlrev_b32_e64 v104, 16, v30
v_and_b32 v105, 0xffff0000, v30
v_lshlrev_b32_e64 v106, 16, v31
v_and_b32 v107, 0xffff0000, v31
v_lshlrev_b32_e64 v108, 16, v32
v_and_b32 v109, 0xffff0000, v32
v_lshlrev_b32_e64 v110, 16, v33
v_and_b32 v111, 0xffff0000, v33
s_waitcnt vmcnt(0)
s_nop 0
v_pk_add_f32 v[128:129], v[128:129], v[160:161]
v_pk_add_f32 v[130:131], v[130:131], v[162:163]
ds_write_b128 v74, v[128:131] offset:0
v_pk_add_f32 v[132:133], v[132:133], v[164:165]
v_pk_add_f32 v[134:135], v[134:135], v[166:167]
ds_write_b128 v75, v[132:135] offset:0
v_pk_add_f32 v[136:137], v[136:137], v[168:169]
v_pk_add_f32 v[138:139], v[138:139], v[170:171]
ds_write_b128 v76, v[136:139] offset:0
v_pk_add_f32 v[140:141], v[140:141], v[172:173]
v_pk_add_f32 v[142:143], v[142:143], v[174:175]
ds_write_b128 v77, v[140:143] offset:0
v_pk_add_f32 v[144:145], v[144:145], v[176:177]
v_pk_add_f32 v[146:147], v[146:147], v[178:179]
ds_write_b128 v74, v[144:147] offset:4096
v_pk_add_f32 v[148:149], v[148:149], v[180:181]
v_pk_add_f32 v[150:151], v[150:151], v[182:183]
ds_write_b128 v75, v[148:151] offset:4096
v_pk_add_f32 v[152:153], v[152:153], v[184:185]
v_pk_add_f32 v[154:155], v[154:155], v[186:187]
ds_write_b128 v76, v[152:155] offset:4096
v_pk_add_f32 v[156:157], v[156:157], v[188:189]
v_pk_add_f32 v[158:159], v[158:159], v[190:191]
ds_write_b128 v77, v[156:159] offset:4096
Rv 192,12,0
Rv 196,13,0
Rv 200,14,2048
Rv 204,15,2048
Rv 208,12,4096
Rv 212,13,4096
Rv 216,14,6144
s_waitcnt lgkmcnt(9)
Rv 220,15,6144
s_waitcnt lgkmcnt(6)
Vc 224,192,193
v_lshlrev_b32_e64 v192, 16, v224
v_and_b32 v193, 0xffff0000, v224
Vc 225,194,195
v_lshlrev_b32_e64 v194, 16, v225
v_and_b32 v195, 0xffff0000, v225
Vc 226,196,197
v_lshlrev_b32_e64 v196, 16, v226
v_and_b32 v197, 0xffff0000, v226
Vc 227,198,199
v_lshlrev_b32_e64 v198, 16, v227
v_and_b32 v199, 0xffff0000, v227
v_pk_mul_f32 v[192:193], v[192:193], v[42:43]
v_pk_mul_f32 v[194:195], v[194:195], v[44:45]
v_pk_mul_f32 v[196:197], v[196:197], v[46:47]
v_pk_mul_f32 v[198:199], v[198:199], v[48:49]
Vc 224,192,193
v_lshlrev_b32_e64 v192, 16, v224
v_and_b32 v193, 0xffff0000, v224
Vc 225,194,195
v_lshlrev_b32_e64 v194, 16, v225
v_and_b32 v195, 0xffff0000, v225
Vc 226,196,197
v_lshlrev_b32_e64 v196, 16, v226
v_and_b32 v197, 0xffff0000, v226
Vc 227,198,199
v_lshlrev_b32_e64 v198, 16, v227
v_and_b32 v199, 0xffff0000, v227
v_pk_add_f32 v[192:193], v[192:193], v[80:81]
v_pk_add_f32 v[194:195], v[194:195], v[82:83]
v_pk_add_f32 v[196:197], v[196:197], v[84:85]
v_pk_add_f32 v[198:199], v[198:199], v[86:87]
Vc 224,192,193
Vc 225,194,195
Vc 226,196,197
Vc 227,198,199
buffer_store_dwordx4 v[224:227], v119, s[68:71], s36 offen sc1
s_add_u32 s36, s36, 16384
s_waitcnt lgkmcnt(4)
Vc 228,200,201
v_lshlrev_b32 v200, 16, v228
v_and_b32 v201, 0xffff0000, v228
Vc 229,202,203
v_lshlrev_b32_e64 v202, 16, v229
v_and_b32 v203, 0xffff0000, v229
Vc 230,204,205
v_lshlrev_b32_e64 v204, 16, v230
v_and_b32 v205, 0xffff0000, v230
Vc 231,206,207
v_lshlrev_b32_e64 v206, 16, v231
v_and_b32 v207, 0xffff0000, v231
v_pk_mul_f32 v[200:201], v[200:201], v[50:51]
v_pk_mul_f32 v[202:203], v[202:203], v[52:53]
v_pk_mul_f32 v[204:205], v[204:205], v[54:55]
v_pk_mul_f32 v[206:207], v[206:207], v[56:57]
Vc 228,200,201
v_lshlrev_b32_e64 v200, 16, v228
v_and_b32 v201, 0xffff0000, v228
Vc 229,202,203
v_lshlrev_b32_e64 v202, 16, v229
v_and_b32 v203, 0xffff0000, v229
Vc 230,204,205
v_lshlrev_b32_e64 v204, 16, v230
v_and_b32 v205, 0xffff0000, v230
Vc 231,206,207
v_lshlrev_b32_e64 v206, 16, v231
v_and_b32 v207, 0xffff0000, v231
v_pk_add_f32 v[200:201], v[200:201], v[88:89]
v_pk_add_f32 v[202:203], v[202:203], v[90:91]
v_pk_add_f32 v[204:205], v[204:205], v[92:93]
v_pk_add_f32 v[206:207], v[206:207], v[94:95]
Vc 228,200,201
Vc 229,202,203
Vc 230,204,205
Vc 231,206,207
buffer_store_dwordx4 v[228:231], v119, s[68:71], s36 offen sc1
s_add_u32 s36, s36, 16384
s_waitcnt lgkmcnt(2)
Vc 232,208,209
v_lshlrev_b32 v208, 16, v232
v_and_b32 v209, 0xffff0000, v232
Vc 233,210,211
v_lshlrev_b32_e64 v210, 16, v233
v_and_b32 v211, 0xffff0000, v233
Vc 234,212,213
v_lshlrev_b32_e64 v212, 16, v234
v_and_b32 v213, 0xffff0000, v234
Vc 235,214,215
v_lshlrev_b32_e64 v214, 16, v235
v_and_b32 v215, 0xffff0000, v235
v_pk_mul_f32 v[208:209], v[208:209], v[58:59]
v_pk_mul_f32 v[210:211], v[210:211], v[60:61]
v_pk_mul_f32 v[212:213], v[212:213], v[62:63]
v_pk_mul_f32 v[214:215], v[214:215], v[64:65]
Vc 232,208,209
v_lshlrev_b32_e64 v208, 16, v232
v_and_b32 v209, 0xffff0000, v232
Vc 233,210,211
v_lshlrev_b32_e64 v210, 16, v233
v_and_b32 v211, 0xffff0000, v233
Vc 234,212,213
v_lshlrev_b32_e64 v212, 16, v234
v_and_b32 v213, 0xffff0000, v234
Vc 235,214,215
v_lshlrev_b32_e64 v214, 16, v235
v_and_b32 v215, 0xffff0000, v235
v_pk_add_f32 v[208:209], v[208:209], v[96:97]
v_pk_add_f32 v[210:211], v[210:211], v[98:99]
v_pk_add_f32 v[212:213], v[212:213], v[100:101]
v_pk_add_f32 v[214:215], v[214:215], v[102:103]
Vc 232,208,209
Vc 233,210,211
Vc 234,212,213
Vc 235,214,215
buffer_store_dwordx4 v[232:235], v119, s[68:71], s36 offen sc1
s_add_u32 s36, s36, 16384
s_waitcnt lgkmcnt(0)
Vc 236,216,217
v_lshlrev_b32 v216, 16, v236
v_and_b32 v217, 0xffff0000, v236
Vc 237,218,219
v_lshlrev_b32_e64 v218, 16, v237
v_and_b32 v219, 0xffff0000, v237
Vc 238,220,221
v_lshlrev_b32_e64 v220, 16, v238
v_and_b32 v221, 0xffff0000, v238
Vc 239,222,223
v_lshlrev_b32_e64 v222, 16, v239
v_and_b32 v223, 0xffff0000, v239
v_pk_mul_f32 v[216:217], v[216:217], v[66:67]
v_pk_mul_f32 v[218:219], v[218:219], v[68:69]
v_pk_mul_f32 v[220:221], v[220:221], v[70:71]
v_pk_mul_f32 v[222:223], v[222:223], v[72:73]
Vc 236,216,217
v_lshlrev_b32_e64 v216, 16, v236
v_and_b32 v217, 0xffff0000, v236
Vc 237,218,219
v_lshlrev_b32_e64 v218, 16, v237
v_and_b32 v219, 0xffff0000, v237
Vc 238,220,221
v_lshlrev_b32_e64 v220, 16, v238
v_and_b32 v221, 0xffff0000, v238
Vc 239,222,223
v_lshlrev_b32_e64 v222, 16, v239
v_and_b32 v223, 0xffff0000, v239
v_pk_add_f32 v[216:217], v[216:217], v[104:105]
v_pk_add_f32 v[218:219], v[218:219], v[106:107]
v_pk_add_f32 v[220:221], v[220:221], v[108:109]
v_pk_add_f32 v[222:223], v[222:223], v[110:111]
Vc 236,216,217
Vc 237,218,219
Vc 238,220,221
Vc 239,222,223
buffer_store_dwordx4 v[236:239], v119, s[68:71], s36 offen sc1
L_k2_end:
s_endpgm
L_spinC:
s_add_u32 m0, s35, 0
s_nop 0
s_nop 0
buffer_load_dwordx4 v125, s[60:63], s48 offen offset:0 lds
buffer_load_dwordx4 v125, s[60:63], s49 offen offset:1024 lds
buffer_load_dwordx4 v125, s[60:63], s50 offen offset:2048 lds
buffer_load_dwordx4 v125, s[60:63], s51 offen offset:3072 lds
v_add_u32 v125, 65536, v125
s_add_u32 m0, s35, 4096
s_nop 0
buffer_load_dwordx4 v125, s[60:63], s48 offen offset:0 lds
buffer_load_dwordx4 v125, s[60:63], s49 offen offset:1024 lds
buffer_load_dwordx4 v125, s[60:63], s50 offen offset:2048 lds
buffer_load_dwordx4 v125, s[60:63], s51 offen offset:3072 lds
s_mov_b32 s40, 1
s_mov_b32 s47, 0x400000
L_spinC_l:
buffer_load_dword v124, v10, s[20:23], s38 offen sc1
s_sub_u32 s47, s47, 1
s_waitcnt vmcnt(0)
s_cmp_eq_u32 s47, 0
s_cbranch_scc1 L_spinC_lx
v_cmp_ne_u32 vcc, 1, v124
s_cbranch_vccz L_spinC_lx
s_sleep 4
s_branch L_spinC_l
L_spinC_lx:
s_branch L_spinCr
L_c31:
s_bfe_u32 s3, s2, 0x40003
s_lshl_b32 s3, s3, 2
s_add_u32 s3, s3, s32
s_lshl_b32 s3, s3, 15
s_and_b32 s7, s2, 1
s_lshl_b32 s7, s7, 22
s_add_u32 s3, s3, s7
s_add_u32 s3, s3, 2097536
v_and_b32 v1, 15, v0
v_lshlrev_b32 v1, 11, v1
v_lshrrev_b32 v11, 5, v0
v_lshl_add_u32 v1, v11, 10, v1
buffer_load_dword v11, v1, s[28:31], s3 offen
s_branch L_c31r
L_f2A:
s_lshr_b32 s5, s54, 1
s_lshl_b32 s5, s5, 5
s_add_u32 s5, s5, 5447680
buffer_load_dword v125, v127, s[20:23], s5 offen sc1
s_branch L_f2Ar
L_f2B:
s_waitcnt vmcnt(16)
v_cmp_ne_u32 vcc, 1, v125
s_cbranch_vccz L_f2lx
s_mov_b32 s47, 0x400000
L_f2l:
buffer_load_dword v125, v127, s[20:23], s5 offen sc1
s_sub_u32 s47, s47, 1
s_waitcnt vmcnt(0)
s_cmp_eq_u32 s47, 0
s_cbranch_scc1 L_f2lx
v_cmp_ne_u32 vcc, 1, v125
s_cbranch_vccz L_f2lx
s_sleep 8
s_branch L_f2l
L_f2lx:
s_lshl_b32 s3, s54, 8
s_add_u32 s3, s3, 6291456
v_mul_u32_u24 v124, 14336, v121
v_and_b32_e64 v125, 15, v0
v_lshl_add_u32 v124, v125, 4, v124
buffer_load_dwordx4 v[74:77], v124, s[20:23], s3 offen sc1
s_add_u32 s3, s3, 57344
buffer_load_dwordx4 v[78:81], v124, s[20:23], s3 offen sc1
s_add_u32 s3, s3, 57344
buffer_load_dwordx4 v[82:85], v124, s[20:23], s3 offen sc1
s_add_u32 s3, s3, 57344
buffer_load_dwordx4 v[86:89], v124, s[20:23], s3 offen sc1
s_add_u32 s3, s3, 57344
buffer_load_dwordx4 v[90:93], v124, s[20:23], s3 offen sc1
s_add_u32 s3, s3, 57344
buffer_load_dwordx4 v[94:97], v124, s[20:23], s3 offen sc1
s_add_u32 s3, s3, 57344
buffer_load_dwordx4 v[98:101], v124, s[20:23], s3 offen sc1
s_add_u32 s3, s3, 57344
buffer_load_dwordx4 v[102:105], v124, s[20:23], s3 offen sc1
s_branch L_f2Br
L_f2C:
v_add_u32 v106, s35, v115
v_add_u32 v107, s35, v116
v_add_u32 v108, s35, v117
v_add_u32 v109, s35, v118
s_waitcnt vmcnt(16) lgkmcnt(0)
v_pk_add_f32 v[74:75], v[74:75], v[78:79]
v_pk_add_f32 v[76:77], v[76:77], v[80:81]
v_pk_add_f32 v[74:75], v[74:75], v[82:83]
v_pk_add_f32 v[76:77], v[76:77], v[84:85]
v_pk_add_f32 v[74:75], v[74:75], v[86:87]
v_pk_add_f32 v[76:77], v[76:77], v[88:89]
v_pk_add_f32 v[74:75], v[74:75], v[90:91]
v_pk_add_f32 v[76:77], v[76:77], v[92:93]
v_pk_add_f32 v[74:75], v[74:75], v[94:95]
v_pk_add_f32 v[76:77], v[76:77], v[96:97]
v_pk_add_f32 v[74:75], v[74:75], v[98:99]
v_pk_add_f32 v[76:77], v[76:77], v[100:101]
v_pk_add_f32 v[74:75], v[74:75], v[102:103]
v_pk_add_f32 v[76:77], v[76:77], v[104:105]
Vc 125,74,75
v_lshlrev_b32_e64 v74, 16, v125
v_and_b32 v75, 0xffff0000, v125
Vc 125,76,77
v_lshlrev_b32_e64 v76, 16, v125
v_and_b32 v77, 0xffff0000, v125
v_mov_b32 v82, v74
v_mov_b32 v83, v75
v_mov_b32 v84, v76
v_mov_b32 v85, v77
v_permlane32_swap_b32 v82, v74
v_permlane32_swap_b32 v83, v75
v_permlane32_swap_b32 v84, v76
v_permlane32_swap_b32 v85, v77
v_mul_f32 v90, 0xbfb8aa3b, v82
v_mul_f32 v91, 0xbfb8aa3b, v83
v_mul_f32 v92, 0xbfb8aa3b, v84
v_mul_f32 v93, 0xbfb8aa3b, v85
Ve 90,90
Ve 91,91
Ve 92,92
Ve 93,93
v_add_f32 v90, 1.0, v90
v_add_f32 v91, 1.0, v91
v_add_f32 v92, 1.0, v92
v_add_f32 v93, 1.0, v93
v_rcp_f32 v90, v90
v_rcp_f32 v91, v91
v_rcp_f32 v92, v92
v_rcp_f32 v93, v93
Vm 82,82,90
Vm 83,83,91
Vm 84,84,92
Vm 85,85,93
Vc 125,82,83
v_lshlrev_b32_e64 v82, 16, v125
v_and_b32 v83, 0xffff0000, v125
Vc 125,84,85
v_lshlrev_b32_e64 v84, 16, v125
v_and_b32 v85, 0xffff0000, v125
Vm 74,74,82
Vm 75,75,83
Vm 76,76,84
Vm 77,77,85
Vc 90,74,75
Vc 91,76,77
v_and_b32 v124, 1, v121
v_lshlrev_b32 v124, 8, v124
v_and_b32_e64 v125, 15, v0
v_lshl_add_u32 v124, v125, 3, v124
v_add_u32_e64 v124, s35, v124
ds_read_b64_tr_b16 v[74:75], v106 offset:0
ds_read_b64_tr_b16 v[76:77], v106 offset:2048
ds_read_b64_tr_b16 v[78:79], v107 offset:0
ds_read_b64_tr_b16 v[80:81], v107 offset:2048
ds_read_b64_tr_b16 v[82:83], v108 offset:0
ds_read_b64_tr_b16 v[84:85], v108 offset:2048
ds_read_b64_tr_b16 v[86:87], v109 offset:0
ds_read_b64_tr_b16 v[88:89], v109 offset:2048
ds_write_b64 v124, v[90:91]
v_and_b32 v124, 1, v0
v_lshlrev_b32 v124, 8, v124
v_lshl_add_u32 v125, v121, 3, v124
v_add_u32_e64 v125, s35, v125
ds_read_b64 v[90:91], v125 offset:0
ds_read_b64 v[92:93], v125 offset:32
ds_read_b64 v[94:95], v125 offset:64
ds_read_b64 v[96:97], v125 offset:96
v_lshl_add_u32 v124, v121, 4, v124
v_add_u32 v124, s35, v124
s_waitcnt lgkmcnt(0)
Zvvv 98,74,90
ds_read_b64_tr_b16 v[74:75], v106 offset:4096
ds_read_b64_tr_b16 v[76:77], v106 offset:6144
Zvvv 102,78,90
ds_read_b64_tr_b16 v[78:79], v107 offset:4096
ds_read_b64_tr_b16 v[80:81], v107 offset:6144
s_waitcnt lgkmcnt(0)
Mvvv 98,74,94
Mvvv 102,78,94
s_nop 6
ds_write_b128 v124, v[98:101] offset:2048
ds_write_b128 v124, v[102:105] offset:2112
s_waitcnt lgkmcnt(0)
Zvvv 98,82,90
ds_read_b64_tr_b16 v[82:83], v108 offset:4096
ds_read_b64_tr_b16 v[84:85], v108 offset:6144
Zvvv 102,86,90
ds_read_b64_tr_b16 v[86:87], v109 offset:4096
ds_read_b64_tr_b16 v[88:89], v109 offset:6144
s_waitcnt lgkmcnt(0)
Mvvv 98,82,94
Mvvv 102,86,94
s_nop 6
ds_write_b128 v124, v[98:101] offset:2176
ds_write_b128 v124, v[102:105] offset:2240
s_waitcnt lgkmcnt(0)
s_barrier
s_cmp_lg_u32 s32, 0
s_cbranch_scc1 L_f2Cr
v_lshlrev_b32 v124, 3, v0
v_add_u32 v125, 133120, v124
ds_read_b64 v[74:75], v125 offset:0
ds_read_b64 v[76:77], v125 offset:8192
ds_read_b64 v[78:79], v125 offset:16384
ds_read_b64 v[80:81], v125 offset:24576
s_lshl_b32 s3, s39, 4
s_add_u32 s3, s3, s37
s_lshl_b32 s3, s3, 9
s_add_u32 s3, s3, 5308416
s_waitcnt lgkmcnt(0)
v_pk_add_f32 v[74:75], v[74:75], v[76:77]
v_pk_add_f32 v[78:79], v[78:79], v[80:81]
v_pk_add_f32 v[74:75], v[74:75], v[78:79]
buffer_store_dwordx2 v[74:75], v124, s[20:23], s3 offen sc1
s_branch L_f2Cr
L_f2E:
s_cmp_lg_u32 s32, 0
s_cbranch_scc1 L_f2Er
v_mov_b32 v125, 1
s_lshl_b32 s3, s39, 5
s_add_u32 s3, s3, s37
s_lshl_b32 s3, s3, 2
s_add_u32 s3, s3, 5449728
s_waitcnt vmcnt(16)
s_mov_b64 exec, 1
buffer_store_dword v125, v126, s[20:23], s3 offen sc1
s_mov_b64 exec, -1
s_branch L_f2Er
L_yA:
v_min_u32 v127, 13, v0
v_lshlrev_b32_e64 v127, 2, v127
buffer_load_dword v74, v127, s[20:23], s41 offen sc1
s_branch L_yAr
L_yB:
s_waitcnt vmcnt(6)
v_cmp_ne_u32 vcc, 1, v74
s_cbranch_vccnz L_yBr
s_mov_b32 s40, 1
v_lshlrev_b32 v124, 2, v0
v_lshlrev_b32 v125, 1, v0
s_lshl_b32 s7, s45, 2
s_add_u32 s7, s7, s32
s_lshr_b32 s3, s42, 5
s_cmp_lg_u32 s3, s7
s_cbranch_scc1 L_f_yl1
s_add_u32 s3, s55, 0
s_nop 0
s_add_u32 s7, s3, 4096
buffer_load_dword v76, v124, s[20:23], s3 offen offset:0 sc1
buffer_load_dword v77, v124, s[20:23], s3 offen offset:512 sc1
buffer_load_dword v78, v124, s[20:23], s3 offen offset:1024 sc1
buffer_load_dword v79, v124, s[20:23], s3 offen offset:1536 sc1
buffer_load_dword v80, v124, s[20:23], s3 offen offset:2048 sc1
buffer_load_dword v81, v124, s[20:23], s3 offen offset:2560 sc1
buffer_load_dword v82, v124, s[20:23], s3 offen offset:3072 sc1
buffer_load_dword v83, v124, s[20:23], s3 offen offset:3584 sc1
buffer_load_dword v84, v124, s[20:23], s7 offen offset:0 sc1
buffer_load_dword v85, v124, s[20:23], s7 offen offset:512 sc1
buffer_load_dword v86, v124, s[20:23], s7 offen offset:1024 sc1
buffer_load_dword v87, v124, s[20:23], s7 offen offset:1536 sc1
buffer_load_dword v88, v124, s[20:23], s7 offen offset:2048 sc1
buffer_load_dword v89, v124, s[20:23], s7 offen offset:2560 sc1
s_lshl_b32 s3, s42, 11
s_lshl_b32 s7, s46, 7
s_add_u32 s3, s3, s7
buffer_load_ushort v90, v125, s[56:59], s3 offen
s_lshl_b32 s3, s42, 3
s_add_u32 s3, s3, 5259264
buffer_load_dwordx2 v[92:93], v126, s[20:23], s3 offen sc1
L_f_yl1:
s_lshl_b32 s7, s45, 2
s_add_u32 s7, s7, s32
s_lshr_b32 s3, s43, 5
s_cmp_lg_u32 s3, s7
s_cbranch_scc1 L_f_yl2
s_nop 0
s_add_u32 s3, s55, 256
s_add_u32 s7, s3, 4096
buffer_load_dword v94, v124, s[20:23], s3 offen offset:0 sc1
buffer_load_dword v95, v124, s[20:23], s3 offen offset:512 sc1
buffer_load_dword v96, v124, s[20:23], s3 offen offset:1024 sc1
buffer_load_dword v97, v124, s[20:23], s3 offen offset:1536 sc1
buffer_load_dword v98, v124, s[20:23], s3 offen offset:2048 sc1
buffer_load_dword v99, v124, s[20:23], s3 offen offset:2560 sc1
buffer_load_dword v100, v124, s[20:23], s3 offen offset:3072 sc1
buffer_load_dword v101, v124, s[20:23], s3 offen offset:3584 sc1
buffer_load_dword v102, v124, s[20:23], s7 offen offset:0 sc1
buffer_load_dword v103, v124, s[20:23], s7 offen offset:512 sc1
buffer_load_dword v104, v124, s[20:23], s7 offen offset:1024 sc1
buffer_load_dword v105, v124, s[20:23], s7 offen offset:1536 sc1
buffer_load_dword v106, v124, s[20:23], s7 offen offset:2048 sc1
buffer_load_dword v107, v124, s[20:23], s7 offen offset:2560 sc1
s_lshl_b32 s3, s43, 11
s_lshl_b32 s7, s46, 7
s_add_u32 s3, s3, s7
buffer_load_ushort v108, v125, s[56:59], s3 offen
s_lshl_b32 s3, s43, 3
s_add_u32 s3, s3, 5259264
buffer_load_dwordx2 v[110:111], v126, s[20:23], s3 offen sc1
L_f_yl2:
s_branch L_yBr
L_yC:
s_waitcnt vmcnt(4)
s_lshl_b32 s7, s45, 2
s_add_u32 s7, s7, s32
s_lshr_b32 s3, s42, 5
s_cmp_lg_u32 s3, s7
s_cbranch_scc1 L_f_ys3
s_nop 0
v_pk_add_f32 v[76:77], v[76:77], v[78:79]
v_pk_add_f32 v[76:77], v[76:77], v[80:81]
v_pk_add_f32 v[76:77], v[76:77], v[82:83]
v_pk_add_f32 v[76:77], v[76:77], v[84:85]
v_pk_add_f32 v[76:77], v[76:77], v[86:87]
v_pk_add_f32 v[76:77], v[76:77], v[88:89]
Va 76,76,77
v_lshlrev_b32 v90, 16, v90
v_sub_f32_e64 v90, v90, v92
Vc 76,76,76
v_lshlrev_b32_e64 v76, 16, v76
Vc 90,90,90
v_lshlrev_b32 v90, 16, v90
v_mul_f32 v76, s100, v76
v_mul_f32_e64 v90, v90, v93
Vc 76,76,76
v_lshlrev_b32_e64 v76, 16, v76
Vc 90,90,90
v_lshlrev_b32 v90, 16, v90
Va 90,90,76
Vc 90,90,90
v_lshlrev_b32_e64 v90, 16, v90
v_mul_f32 v76, 0xbfb8aa3b, v90
Ve 76,76
s_nop 0
v_add_f32 v76, 1.0, v76
v_rcp_f32 v76, v76
s_nop 0
Vm 90,90,76
Vc 90,90,90
v_lshlrev_b32 v90, 16, v90
v_lshlrev_b32 v124, 2, v0
v_add_u32 v124, s35, v124
v_lshlrev_b32 v125, 5, v122
v_add_u32 v125, s35, v125
s_waitcnt lgkmcnt(0)
ds_write_b32 v124, v90
s_and_b32 s3, s42, 7
s_lshl_b32 s3, s3, 3
s_lshl_b64 s[4:5], 0xff, s3
s_bfe_u32 s3, s42, 0x20003
s_mov_b64 exec, s[4:5]
s_cmp_lg_u32 s3, 0
s_cbranch_scc1 L_f_yp4
ds_read_b64 v[42:43], v125
ds_read_b64 v[44:45], v125 offset:8
ds_read_b64 v[46:47], v125 offset:16
ds_read_b64 v[48:49], v125 offset:24
L_f_yp4:
s_cmp_lg_u32 s3, 1
s_cbranch_scc1 L_f_yp5
ds_read_b64 v[50:51], v125
ds_read_b64 v[52:53], v125 offset:8
ds_read_b64 v[54:55], v125 offset:16
ds_read_b64 v[56:57], v125 offset:24
L_f_yp5:
s_cmp_lg_u32 s3, 2
s_cbranch_scc1 L_f_yp6
ds_read_b64 v[58:59], v125
ds_read_b64 v[60:61], v125 offset:8
ds_read_b64 v[62:63], v125 offset:16
ds_read_b64 v[64:65], v125 offset:24
L_f_yp6:
s_cmp_lg_u32 s3, 3
s_cbranch_scc1 L_f_yp7
ds_read_b64 v[66:67], v125
ds_read_b64 v[68:69], v125 offset:8
s_waitcnt lgkmcnt(9)
ds_read_b64 v[70:71], v125 offset:16
ds_read_b64 v[72:73], v125 offset:24
L_f_yp7:
s_mov_b64 exec, -1
s_waitcnt lgkmcnt(0)
L_f_ys3:
s_lshl_b32 s7, s45, 2
s_add_u32 s7, s7, s32
s_lshr_b32 s3, s43, 5
s_cmp_lg_u32 s3, s7
s_cbranch_scc1 L_f_ys8
s_nop 0
v_pk_add_f32 v[94:95], v[94:95], v[96:97]
v_pk_add_f32 v[94:95], v[94:95], v[98:99]
v_pk_add_f32 v[94:95], v[94:95], v[100:101]
v_pk_add_f32 v[94:95], v[94:95], v[102:103]
v_pk_add_f32 v[94:95], v[94:95], v[104:105]
v_pk_add_f32 v[94:95], v[94:95], v[106:107]
Va 94,94,95
v_lshlrev_b32 v108, 16, v108
v_sub_f32_e64 v108, v108, v110
Vc 94,94,94
v_lshlrev_b32_e64 v94, 16, v94
Vc 108,108,108
v_lshlrev_b32 v108, 16, v108
v_mul_f32 v94, s101, v94
v_mul_f32_e64 v108, v108, v111
Vc 94,94,94
v_lshlrev_b32_e64 v94, 16, v94
Vc 108,108,108
v_lshlrev_b32 v108, 16, v108
Va 108,108,94
Vc 108,108,108
v_lshlrev_b32_e64 v108, 16, v108
v_mul_f32 v94, 0xbfb8aa3b, v108
Ve 94,94
s_nop 0
v_add_f32 v94, 1.0, v94
v_rcp_f32 v94, v94
s_nop 0
Vm 108,108,94
Vc 108,108,108
v_lshlrev_b32 v108, 16, v108
v_lshlrev_b32 v124, 2, v0
v_add_u32 v124, s35, v124
v_lshlrev_b32 v125, 5, v122
v_add_u32 v125, s35, v125
s_waitcnt lgkmcnt(0)
ds_write_b32 v124, v108
s_and_b32 s3, s43, 7
s_lshl_b32 s3, s3, 3
s_lshl_b64 s[4:5], 0xff, s3
s_bfe_u32 s3, s43, 0x20003
s_mov_b64 exec, s[4:5]
s_cmp_lg_u32 s3, 0
s_cbranch_scc1 L_f_yp9
ds_read_b64 v[42:43], v125
ds_read_b64 v[44:45], v125 offset:8
ds_read_b64 v[46:47], v125 offset:16
ds_read_b64 v[48:49], v125 offset:24
L_f_yp9:
s_cmp_lg_u32 s3, 1
s_cbranch_scc1 L_f_yp10
ds_read_b64 v[50:51], v125
ds_read_b64 v[52:53], v125 offset:8
ds_read_b64 v[54:55], v125 offset:16
ds_read_b64 v[56:57], v125 offset:24
L_f_yp10:
s_cmp_lg_u32 s3, 2
s_cbranch_scc1 L_f_yp11
ds_read_b64 v[58:59], v125
ds_read_b64 v[60:61], v125 offset:8
ds_read_b64 v[62:63], v125 offset:16
ds_read_b64 v[64:65], v125 offset:24
L_f_yp11:
s_cmp_lg_u32 s3, 3
s_cbranch_scc1 L_f_yp12
ds_read_b64 v[66:67], v125
ds_read_b64 v[68:69], v125 offset:8
s_waitcnt lgkmcnt(9)
ds_read_b64 v[70:71], v125 offset:16
ds_read_b64 v[72:73], v125 offset:24
L_f_yp12:
s_mov_b64 exec, -1
s_waitcnt lgkmcnt(0)
L_f_ys8:
s_branch L_yCr
L_p4_end:
L_spinAk:
s_mov_b32 s47, 0x400000
L_spinAk_l:
s_sleep 8
buffer_load_dword v1, v7, s[28:31], 0 offen sc1
s_waitcnt vmcnt(0)
v_readfirstlane_b32 s3, v1
s_sub_u32 s47, s47, 1
s_cmp_eq_u32 s47, 0
s_cbranch_scc1 L_spinArk
s_cmp_lt_u32 s3, 256
s_cbranch_scc1 L_spinAk_l
s_branch L_spinArk
L_spinAv:
s_mov_b32 s47, 0x400000
L_spinAv_l:
s_sleep 8
buffer_load_dword v1, v7, s[28:31], 0 offen sc1
s_waitcnt vmcnt(0)
v_readfirstlane_b32 s3, v1
s_sub_u32 s47, s47, 1
s_cmp_eq_u32 s47, 0
s_cbranch_scc1 L_spinArv
s_cmp_lt_u32 s3, 256
s_cbranch_scc1 L_spinAv_l
s_branch L_spinArv
L_spinB:
s_mov_b32 s59, 0x400000
L_spinB_l:
s_sleep 4
buffer_load_dword v12, v1, s[20:23], s6 offen sc1
s_sub_u32 s59, s59, 1
s_cmp_eq_u32 s59, 0
s_cbranch_scc1 L_spinBx
s_waitcnt vmcnt(0)
v_cmp_ne_u32 vcc, 1, v12
s_cbranch_vccnz L_spinB_l
L_spinBx:
s_waitcnt vmcnt(0)
s_branch L_spinBr
L_k2_fb_we:
s_nop 7
s_nop 0
v_max3_f32 v21, v128, v129, v130
v_max3_f32 v21, v21, v131, v132
v_max3_f32 v21, v21, v133, v134
v_max3_f32 v21, v21, v135, v136
v_max3_f32 v21, v21, v137, v138
v_max3_f32 v21, v21, v139, v140
v_max3_f32 v21, v21, v141, v142
v_max_f32 v21, v21, v143
v_mov_b32 v1, v21
s_nop 1
v_permlane16_swap_b32 v1, v21
v_max_f32 v21, v21, v1
v_mov_b32 v1, v21
s_nop 1
v_permlane32_swap_b32 v1, v21
v_max_f32_e64 v21, v21, v1
v_add_f32 v21, 0x41f80000, v21
v_max_f32 v21, 0, v21
Vs 128,128,21
Vs 129,129,21
Vs 130,130,21
Vs 131,131,21
Vs 132,132,21
Vs 133,133,21
Vs 134,134,21
Vs 135,135,21
Vs 136,136,21
Vs 137,137,21
Vs 138,138,21
Vs 139,139,21
Vs 140,140,21
Vs 141,141,21
Vs 142,142,21
Vs 143,143,21
Vs 192,192,21
Vs 193,193,21
Vs 194,194,21
Vs 195,195,21
Vs 196,196,21
Vs 197,197,21
Vs 198,198,21
Vs 199,199,21
Vs 200,200,21
Vs 201,201,21
Vs 202,202,21
Vs 203,203,21
Vs 204,204,21
Vs 205,205,21
Vs 206,206,21
Vs 207,207,21
Vs 32,32,21
Vs 33,33,21
Vs 34,34,21
v_sub_f32_e64 v35, v35, v21
v_exp_f32 v22, -v21
s_nop 0
Vm 48,48,22
Vm 49,49,22
Vm 50,50,22
v_mul_f32_e64 v51, v51, v22
Ar 8,0
Ar 9,1
Ar 10,2
Ar 11,3
Ar 12,4
Ar 13,5
Ar 14,6
Ar 15,7
Vm 8,8,22
Vm 9,9,22
Vm 10,10,22
Vm 11,11,22
Vm 12,12,22
Vm 13,13,22
Vm 14,14,22
Vm 15,15,22
Aw 0,8
Aw 1,9
Aw 2,10
Aw 3,11
Aw 4,12
Aw 5,13
Aw 6,14
Aw 7,15
Ar 8,8
Ar 9,9
Ar 10,10
Ar 11,11
Ar 12,12
Ar 13,13
Ar 14,14
Ar 15,15
Vm 8,8,22
Vm 9,9,22
Vm 10,10,22
Vm 11,11,22
Vm 12,12,22
Vm 13,13,22
Vm 14,14,22
Vm 15,15,22
Aw 8,8
Aw 9,9
Aw 10,10
Aw 11,11
Aw 12,12
Aw 13,13
Aw 14,14
Aw 15,15
Ar 8,16
Ar 9,17
Ar 10,18
Ar 11,19
Ar 12,20
Ar 13,21
Ar 14,22
Ar 15,23
Vm 8,8,22
Vm 9,9,22
Vm 10,10,22
Vm 11,11,22
Vm 12,12,22
Vm 13,13,22
Vm 14,14,22
Vm 15,15,22
Aw 16,8
Aw 17,9
Aw 18,10
Aw 19,11
Aw 20,12
Aw 21,13
Aw 22,14
Aw 23,15
Ar 8,24
Ar 9,25
Ar 10,26
Ar 11,27
Ar 12,28
Ar 13,29
Ar 14,30
Ar 15,31
Vm 8,8,22
Vm 9,9,22
Vm 10,10,22
Vm 11,11,22
Vm 12,12,22
Vm 13,13,22
Vm 14,14,22
Vm 15,15,22
Aw 24,8
Aw 25,9
Aw 26,10
Aw 27,11
Aw 28,12
Aw 29,13
Aw 30,14
Aw 31,15
v_max3_f32 v21, v144, v145, v146
v_max3_f32 v21, v21, v147, v148
v_max3_f32 v21, v21, v149, v150
v_max3_f32 v21, v21, v151, v152
v_max3_f32 v21, v21, v153, v154
v_max3_f32 v21, v21, v155, v156
v_max3_f32 v21, v21, v157, v158
v_max_f32 v21, v21, v159
v_mov_b32 v1, v21
s_nop 1
v_permlane16_swap_b32 v1, v21
v_max_f32 v21, v21, v1
v_mov_b32 v1, v21
s_nop 1
v_permlane32_swap_b32 v1, v21
v_max_f32_e64 v21, v21, v1
v_add_f32 v21, 0x41f80000, v21
v_max_f32 v21, 0, v21
Vs 144,144,21
Vs 145,145,21
Vs 146,146,21
Vs 147,147,21
Vs 148,148,21
Vs 149,149,21
Vs 150,150,21
Vs 151,151,21
Vs 152,152,21
Vs 153,153,21
Vs 154,154,21
Vs 155,155,21
Vs 156,156,21
Vs 157,157,21
Vs 158,158,21
Vs 159,159,21
Vs 208,208,21
Vs 209,209,21
Vs 210,210,21
Vs 211,211,21
Vs 212,212,21
Vs 213,213,21
Vs 214,214,21
Vs 215,215,21
Vs 216,216,21
Vs 217,217,21
Vs 218,218,21
Vs 219,219,21
Vs 220,220,21
Vs 221,221,21
Vs 222,222,21
Vs 223,223,21
Vs 36,36,21
Vs 37,37,21
Vs 38,38,21
v_sub_f32_e64 v39, v39, v21
v_exp_f32 v22, -v21
s_nop 0
Vm 52,52,22
Vm 53,53,22
Vm 54,54,22
v_mul_f32_e64 v55, v55, v22
Ar 8,32
Ar 9,33
Ar 10,34
Ar 11,35
Ar 12,36
Ar 13,37
Ar 14,38
Ar 15,39
Vm 8,8,22
Vm 9,9,22
Vm 10,10,22
Vm 11,11,22
Vm 12,12,22
Vm 13,13,22
Vm 14,14,22
Vm 15,15,22
Aw 32,8
Aw 33,9
Aw 34,10
Aw 35,11
Aw 36,12
Aw 37,13
Aw 38,14
Aw 39,15
Ar 8,40
Ar 9,41
Ar 10,42
Ar 11,43
Ar 12,44
Ar 13,45
Ar 14,46
Ar 15,47
Vm 8,8,22
Vm 9,9,22
Vm 10,10,22
Vm 11,11,22
Vm 12,12,22
Vm 13,13,22
Vm 14,14,22
Vm 15,15,22
Aw 40,8
Aw 41,9
Aw 42,10
Aw 43,11
Aw 44,12
Aw 45,13
Aw 46,14
Aw 47,15
Ar 8,48
Ar 9,49
Ar 10,50
Ar 11,51
Ar 12,52
Ar 13,53
Ar 14,54
Ar 15,55
Vm 8,8,22
Vm 9,9,22
Vm 10,10,22
Vm 11,11,22
Vm 12,12,22
Vm 13,13,22
Vm 14,14,22
Vm 15,15,22
Aw 48,8
Aw 49,9
Aw 50,10
Aw 51,11
Aw 52,12
Aw 53,13
Aw 54,14
Aw 55,15
Ar 8,56
Ar 9,57
Ar 10,58
Ar 11,59
Ar 12,60
Ar 13,61
Ar 14,62
Ar 15,63
Vm 8,8,22
Vm 9,9,22
Vm 10,10,22
Vm 11,11,22
Vm 12,12,22
Vm 13,13,22
Vm 14,14,22
Vm 15,15,22
Aw 56,8
Aw 57,9
Aw 58,10
Aw 59,11
Aw 60,12
Aw 61,13
Aw 62,14
Aw 63,15
v_max3_f32 v21, v160, v161, v162
v_max3_f32 v21, v21, v163, v164
v_max3_f32 v21, v21, v165, v166
v_max3_f32 v21, v21, v167, v168
v_max3_f32 v21, v21, v169, v170
v_max3_f32 v21, v21, v171, v172
v_max3_f32 v21, v21, v173, v174
v_max_f32 v21, v21, v175
v_mov_b32 v1, v21
s_nop 1
v_permlane16_swap_b32 v1, v21
v_max_f32 v21, v21, v1
v_mov_b32 v1, v21
s_nop 1
v_permlane32_swap_b32 v1, v21
v_max_f32_e64 v21, v21, v1
v_add_f32 v21, 0x41f80000, v21
v_max_f32 v21, 0, v21
Vs 160,160,21
Vs 161,161,21
Vs 162,162,21
Vs 163,163,21
Vs 164,164,21
Vs 165,165,21
Vs 166,166,21
Vs 167,167,21
Vs 168,168,21
Vs 169,169,21
Vs 170,170,21
Vs 171,171,21
Vs 172,172,21
Vs 173,173,21
Vs 174,174,21
Vs 175,175,21
Vs 224,224,21
Vs 225,225,21
Vs 226,226,21
Vs 227,227,21
Vs 228,228,21
Vs 229,229,21
Vs 230,230,21
Vs 231,231,21
Vs 232,232,21
Vs 233,233,21
Vs 234,234,21
Vs 235,235,21
Vs 236,236,21
Vs 237,237,21
Vs 238,238,21
Vs 239,239,21
Vs 40,40,21
Vs 41,41,21
Vs 42,42,21
v_sub_f32_e64 v43, v43, v21
v_exp_f32 v22, -v21
s_nop 0
Vm 56,56,22
Vm 57,57,22
Vm 58,58,22
v_mul_f32_e64 v59, v59, v22
Ar 8,64
Ar 9,65
Ar 10,66
Ar 11,67
Ar 12,68
Ar 13,69
Ar 14,70
Ar 15,71
Vm 8,8,22
Vm 9,9,22
Vm 10,10,22
Vm 11,11,22
Vm 12,12,22
Vm 13,13,22
Vm 14,14,22
Vm 15,15,22
Aw 64,8
Aw 65,9
Aw 66,10
Aw 67,11
Aw 68,12
Aw 69,13
Aw 70,14
Aw 71,15
Ar 8,72
Ar 9,73
Ar 10,74
Ar 11,75
Ar 12,76
Ar 13,77
Ar 14,78
Ar 15,79
Vm 8,8,22
Vm 9,9,22
Vm 10,10,22
Vm 11,11,22
Vm 12,12,22
Vm 13,13,22
Vm 14,14,22
Vm 15,15,22
Aw 72,8
Aw 73,9
Aw 74,10
Aw 75,11
Aw 76,12
Aw 77,13
Aw 78,14
Aw 79,15
Ar 8,80
Ar 9,81
Ar 10,82
Ar 11,83
Ar 12,84
Ar 13,85
Ar 14,86
Ar 15,87
Vm 8,8,22
Vm 9,9,22
Vm 10,10,22
Vm 11,11,22
Vm 12,12,22
Vm 13,13,22
Vm 14,14,22
Vm 15,15,22
Aw 80,8
Aw 81,9
Aw 82,10
Aw 83,11
Aw 84,12
Aw 85,13
Aw 86,14
Aw 87,15
Ar 8,88
Ar 9,89
Ar 10,90
Ar 11,91
Ar 12,92
Ar 13,93
Ar 14,94
Ar 15,95
Vm 8,8,22
Vm 9,9,22
Vm 10,10,22
Vm 11,11,22
Vm 12,12,22
Vm 13,13,22
Vm 14,14,22
Vm 15,15,22
Aw 88,8
Aw 89,9
Aw 90,10
Aw 91,11
Aw 92,12
Aw 93,13
Aw 94,14
Aw 95,15
v_max3_f32 v21, v176, v177, v178
v_max3_f32 v21, v21, v179, v180
v_max3_f32 v21, v21, v181, v182
v_max3_f32 v21, v21, v183, v184
v_max3_f32 v21, v21, v185, v186
v_max3_f32 v21, v21, v187, v188
v_max3_f32 v21, v21, v189, v190
v_max_f32 v21, v21, v191
v_mov_b32 v1, v21
s_nop 1
v_permlane16_swap_b32 v1, v21
v_max_f32 v21, v21, v1
v_mov_b32 v1, v21
s_nop 1
v_permlane32_swap_b32 v1, v21
v_max_f32_e64 v21, v21, v1
v_add_f32 v21, 0x41f80000, v21
v_max_f32 v21, 0, v21
Vs 176,176,21
Vs 177,177,21
Vs 178,178,21
Vs 179,179,21
Vs 180,180,21
Vs 181,181,21
Vs 182,182,21
Vs 183,183,21
Vs 184,184,21
Vs 185,185,21
Vs 186,186,21
Vs 187,187,21
Vs 188,188,21
Vs 189,189,21
Vs 190,190,21
Vs 191,191,21
Vs 240,240,21
Vs 241,241,21
Vs 242,242,21
Vs 243,243,21
Vs 244,244,21
Vs 245,245,21
Vs 246,246,21
Vs 247,247,21
Vs 248,248,21
Vs 249,249,21
Vs 250,250,21
Vs 251,251,21
Vs 252,252,21
Vs 253,253,21
Vs 254,254,21
Vs 255,255,21
Vs 44,44,21
Vs 45,45,21
Vs 46,46,21
v_sub_f32_e64 v47, v47, v21
v_exp_f32 v22, -v21
s_nop 0
Vm 60,60,22
Vm 61,61,22
Vm 62,62,22
v_mul_f32_e64 v63, v63, v22
Ar 8,96
Ar 9,97
Ar 10,98
Ar 11,99
Ar 12,100
Ar 13,101
Ar 14,102
Ar 15,103
Vm 8,8,22
Vm 9,9,22
Vm 10,10,22
Vm 11,11,22
Vm 12,12,22
Vm 13,13,22
Vm 14,14,22
Vm 15,15,22
Aw 96,8
Aw 97,9
Aw 98,10
Aw 99,11
Aw 100,12
Aw 101,13
Aw 102,14
Aw 103,15
Ar 8,104
Ar 9,105
Ar 10,106
Ar 11,107
Ar 12,108
Ar 13,109
Ar 14,110
Ar 15,111
Vm 8,8,22
Vm 9,9,22
Vm 10,10,22
Vm 11,11,22
Vm 12,12,22
Vm 13,13,22
Vm 14,14,22
Vm 15,15,22
Aw 104,8
Aw 105,9
Aw 106,10
Aw 107,11
Aw 108,12
Aw 109,13
Aw 110,14
Aw 111,15
Ar 8,112
Ar 9,113
Ar 10,114
Ar 11,115
Ar 12,116
Ar 13,117
Ar 14,118
Ar 15,119
Vm 8,8,22
Vm 9,9,22
Vm 10,10,22
Vm 11,11,22
Vm 12,12,22
Vm 13,13,22
Vm 14,14,22
Vm 15,15,22
Aw 112,8
Aw 113,9
Aw 114,10
Aw 115,11
Aw 116,12
Aw 117,13
Aw 118,14
Aw 119,15
Ar 8,120
Ar 9,121
Ar 10,122
Ar 11,123
Ar 12,124
Ar 13,125
Ar 14,126
Ar 15,127
Vm 8,8,22
Vm 9,9,22
Vm 10,10,22
Vm 11,11,22
Vm 12,12,22
Vm 13,13,22
Vm 14,14,22
Vm 15,15,22
Aw 120,8
Aw 121,9
Aw 122,10
Aw 123,11
Aw 124,12
Aw 125,13
Aw 126,14
Aw 127,15
Ve 8,128
Ve 9,129
s_nop 0
Vc 64,8,9
Ve 8,130
Ve 9,131
s_nop 0
Vc 65,8,9
Ve 8,144
Ve 9,145
s_nop 0
Vc 72,8,9
Ve 8,146
Ve 9,147
s_nop 0
Vc 73,8,9
Ve 8,160
Ve 9,161
s_nop 0
Vc 80,8,9
Ve 8,162
Ve 9,163
s_nop 0
Vc 81,8,9
Ve 8,176
Ve 9,177
s_nop 0
Vc 88,8,9
Ve 8,178
Ve 9,179
s_nop 0
Vc 89,8,9
Ve 8,132
Ve 9,133
s_nop 0
Vc 66,8,9
Ve 8,134
Ve 9,135
s_nop 0
Vc 67,8,9
Ve 8,148
Ve 9,149
s_nop 0
Vc 74,8,9
Ve 8,150
Ve 9,151
s_nop 0
Vc 75,8,9
Ve 8,164
Ve 9,165
s_nop 0
Vc 82,8,9
Ve 8,166
Ve 9,167
s_nop 0
Vc 83,8,9
Ve 8,180
Ve 9,181
s_nop 0
Vc 90,8,9
Ve 8,182
Ve 9,183
s_nop 0
Vc 91,8,9
Ve 8,136
Ve 9,137
s_nop 0
Vc 68,8,9
Ve 8,138
Ve 9,139
s_nop 0
Vc 69,8,9
Ve 8,152
Ve 9,153
s_nop 0
Vc 76,8,9
Ve 8,154
Ve 9,155
s_nop 0
Vc 77,8,9
Ve 8,168
Ve 9,169
s_nop 0
Vc 84,8,9
Ve 8,170
Ve 9,171
s_nop 0
Vc 85,8,9
Ve 8,184
Ve 9,185
s_nop 0
Vc 92,8,9
Ve 8,186
Ve 9,187
s_nop 0
Vc 93,8,9
Ve 8,140
Ve 9,141
s_nop 0
Vc 70,8,9
Ve 8,142
Ve 9,143
s_nop 0
Vc 71,8,9
Ve 8,156
Ve 9,157
s_nop 0
Vc 78,8,9
Ve 8,158
Ve 9,159
s_nop 0
Vc 79,8,9
Ve 8,172
Ve 9,173
s_nop 0
Vc 86,8,9
Ve 8,174
Ve 9,175
s_nop 0
Vc 87,8,9
Ve 8,188
Ve 9,189
s_nop 0
Vc 94,8,9
Ve 8,190
Ve 9,191
s_nop 0
Vc 95,8,9
s_nop 1
s_branch L_k2_fbr_we
L_k2_fb_wo:
s_nop 7
s_nop 0
v_max3_f32 v21, v192, v193, v194
v_max3_f32 v21, v21, v195, v196
v_max3_f32 v21, v21, v197, v198
v_max3_f32 v21, v21, v199, v200
v_max3_f32 v21, v21, v201, v202
v_max3_f32 v21, v21, v203, v204
v_max3_f32 v21, v21, v205, v206
v_max_f32 v21, v21, v207
v_mov_b32 v1, v21
s_nop 1
v_permlane16_swap_b32 v1, v21
v_max_f32 v21, v21, v1
v_mov_b32 v1, v21
s_nop 1
v_permlane32_swap_b32 v1, v21
v_max_f32_e64 v21, v21, v1
v_add_f32 v21, 0x41f80000, v21
v_max_f32 v21, 0, v21
Vs 192,192,21
Vs 193,193,21
Vs 194,194,21
Vs 195,195,21
Vs 196,196,21
Vs 197,197,21
Vs 198,198,21
Vs 199,199,21
Vs 200,200,21
Vs 201,201,21
Vs 202,202,21
Vs 203,203,21
Vs 204,204,21
Vs 205,205,21
Vs 206,206,21
Vs 207,207,21
Vs 128,128,21
Vs 129,129,21
Vs 130,130,21
Vs 131,131,21
Vs 132,132,21
Vs 133,133,21
Vs 134,134,21
Vs 135,135,21
Vs 136,136,21
Vs 137,137,21
Vs 138,138,21
Vs 139,139,21
Vs 140,140,21
Vs 141,141,21
Vs 142,142,21
Vs 143,143,21
Vs 32,32,21
Vs 33,33,21
Vs 34,34,21
v_sub_f32_e64 v35, v35, v21
v_exp_f32 v22, -v21
s_nop 0
Vm 48,48,22
Vm 49,49,22
Vm 50,50,22
v_mul_f32_e64 v51, v51, v22
Ar 8,0
Ar 9,1
Ar 10,2
Ar 11,3
Ar 12,4
Ar 13,5
Ar 14,6
Ar 15,7
Vm 8,8,22
Vm 9,9,22
Vm 10,10,22
Vm 11,11,22
Vm 12,12,22
Vm 13,13,22
Vm 14,14,22
Vm 15,15,22
Aw 0,8
Aw 1,9
Aw 2,10
Aw 3,11
Aw 4,12
Aw 5,13
Aw 6,14
Aw 7,15
Ar 8,8
Ar 9,9
Ar 10,10
Ar 11,11
Ar 12,12
Ar 13,13
Ar 14,14
Ar 15,15
Vm 8,8,22
Vm 9,9,22
Vm 10,10,22
Vm 11,11,22
Vm 12,12,22
Vm 13,13,22
Vm 14,14,22
Vm 15,15,22
Aw 8,8
Aw 9,9
Aw 10,10
Aw 11,11
Aw 12,12
Aw 13,13
Aw 14,14
Aw 15,15
Ar 8,16
Ar 9,17
Ar 10,18
Ar 11,19
Ar 12,20
Ar 13,21
Ar 14,22
Ar 15,23
Vm 8,8,22
Vm 9,9,22
Vm 10,10,22
Vm 11,11,22
Vm 12,12,22
Vm 13,13,22
Vm 14,14,22
Vm 15,15,22
Aw 16,8
Aw 17,9
Aw 18,10
Aw 19,11
Aw 20,12
Aw 21,13
Aw 22,14
Aw 23,15
Ar 8,24
Ar 9,25
Ar 10,26
Ar 11,27
Ar 12,28
Ar 13,29
Ar 14,30
Ar 15,31
Vm 8,8,22
Vm 9,9,22
Vm 10,10,22
Vm 11,11,22
Vm 12,12,22
Vm 13,13,22
Vm 14,14,22
Vm 15,15,22
Aw 24,8
Aw 25,9
Aw 26,10
Aw 27,11
Aw 28,12
Aw 29,13
Aw 30,14
Aw 31,15
v_max3_f32 v21, v208, v209, v210
v_max3_f32 v21, v21, v211, v212
v_max3_f32 v21, v21, v213, v214
v_max3_f32 v21, v21, v215, v216
v_max3_f32 v21, v21, v217, v218
v_max3_f32 v21, v21, v219, v220
v_max3_f32 v21, v21, v221, v222
v_max_f32 v21, v21, v223
v_mov_b32 v1, v21
s_nop 1
v_permlane16_swap_b32 v1, v21
v_max_f32 v21, v21, v1
v_mov_b32 v1, v21
s_nop 1
v_permlane32_swap_b32 v1, v21
v_max_f32_e64 v21, v21, v1
v_add_f32 v21, 0x41f80000, v21
v_max_f32 v21, 0, v21
Vs 208,208,21
Vs 209,209,21
Vs 210,210,21
Vs 211,211,21
Vs 212,212,21
Vs 213,213,21
Vs 214,214,21
Vs 215,215,21
Vs 216,216,21
Vs 217,217,21
Vs 218,218,21
Vs 219,219,21
Vs 220,220,21
Vs 221,221,21
Vs 222,222,21
Vs 223,223,21
Vs 144,144,21
Vs 145,145,21
Vs 146,146,21
Vs 147,147,21
Vs 148,148,21
Vs 149,149,21
Vs 150,150,21
Vs 151,151,21
Vs 152,152,21
Vs 153,153,21
Vs 154,154,21
Vs 155,155,21
Vs 156,156,21
Vs 157,157,21
Vs 158,158,21
Vs 159,159,21
Vs 36,36,21
Vs 37,37,21
Vs 38,38,21
v_sub_f32_e64 v39, v39, v21
v_exp_f32 v22, -v21
s_nop 0
Vm 52,52,22
Vm 53,53,22
Vm 54,54,22
v_mul_f32_e64 v55, v55, v22
Ar 8,32
Ar 9,33
Ar 10,34
Ar 11,35
Ar 12,36
Ar 13,37
Ar 14,38
Ar 15,39
Vm 8,8,22
Vm 9,9,22
Vm 10,10,22
Vm 11,11,22
Vm 12,12,22
Vm 13,13,22
Vm 14,14,22
Vm 15,15,22
Aw 32,8
Aw 33,9
Aw 34,10
Aw 35,11
Aw 36,12
Aw 37,13
Aw 38,14
Aw 39,15
Ar 8,40
Ar 9,41
Ar 10,42
Ar 11,43
Ar 12,44
Ar 13,45
Ar 14,46
Ar 15,47
Vm 8,8,22
Vm 9,9,22
Vm 10,10,22
Vm 11,11,22
Vm 12,12,22
Vm 13,13,22
Vm 14,14,22
Vm 15,15,22
Aw 40,8
Aw 41,9
Aw 42,10
Aw 43,11
Aw 44,12
Aw 45,13
Aw 46,14
Aw 47,15
Ar 8,48
Ar 9,49
Ar 10,50
Ar 11,51
Ar 12,52
Ar 13,53
Ar 14,54
Ar 15,55
Vm 8,8,22
Vm 9,9,22
Vm 10,10,22
Vm 11,11,22
Vm 12,12,22
Vm 13,13,22
Vm 14,14,22
Vm 15,15,22
Aw 48,8
Aw 49,9
Aw 50,10
Aw 51,11
Aw 52,12
Aw 53,13
Aw 54,14
Aw 55,15
Ar 8,56
Ar 9,57
Ar 10,58
Ar 11,59
Ar 12,60
Ar 13,61
Ar 14,62
Ar 15,63
Vm 8,8,22
Vm 9,9,22
Vm 10,10,22
Vm 11,11,22
Vm 12,12,22
Vm 13,13,22
Vm 14,14,22
Vm 15,15,22
Aw 56,8
Aw 57,9
Aw 58,10
Aw 59,11
Aw 60,12
Aw 61,13
Aw 62,14
Aw 63,15
v_max3_f32 v21, v224, v225, v226
v_max3_f32 v21, v21, v227, v228
v_max3_f32 v21, v21, v229, v230
v_max3_f32 v21, v21, v231, v232
v_max3_f32 v21, v21, v233, v234
v_max3_f32 v21, v21, v235, v236
v_max3_f32 v21, v21, v237, v238
v_max_f32 v21, v21, v239
v_mov_b32 v1, v21
s_nop 1
v_permlane16_swap_b32 v1, v21
v_max_f32 v21, v21, v1
v_mov_b32 v1, v21
s_nop 1
v_permlane32_swap_b32 v1, v21
v_max_f32_e64 v21, v21, v1
v_add_f32 v21, 0x41f80000, v21
v_max_f32 v21, 0, v21
Vs 224,224,21
Vs 225,225,21
Vs 226,226,21
Vs 227,227,21
Vs 228,228,21
Vs 229,229,21
Vs 230,230,21
Vs 231,231,21
Vs 232,232,21
Vs 233,233,21
Vs 234,234,21
Vs 235,235,21
Vs 236,236,21
Vs 237,237,21
Vs 238,238,21
Vs 239,239,21
Vs 160,160,21
Vs 161,161,21
Vs 162,162,21
Vs 163,163,21
Vs 164,164,21
Vs 165,165,21
Vs 166,166,21
Vs 167,167,21
Vs 168,168,21
Vs 169,169,21
Vs 170,170,21
Vs 171,171,21
Vs 172,172,21
Vs 173,173,21
Vs 174,174,21
Vs 175,175,21
Vs 40,40,21
Vs 41,41,21
Vs 42,42,21
v_sub_f32_e64 v43, v43, v21
v_exp_f32 v22, -v21
s_nop 0
Vm 56,56,22
Vm 57,57,22
Vm 58,58,22
v_mul_f32_e64 v59, v59, v22
Ar 8,64
Ar 9,65
Ar 10,66
Ar 11,67
Ar 12,68
Ar 13,69
Ar 14,70
Ar 15,71
Vm 8,8,22
Vm 9,9,22
Vm 10,10,22
Vm 11,11,22
Vm 12,12,22
Vm 13,13,22
Vm 14,14,22
Vm 15,15,22
Aw 64,8
Aw 65,9
Aw 66,10
Aw 67,11
Aw 68,12
Aw 69,13
Aw 70,14
Aw 71,15
Ar 8,72
Ar 9,73
Ar 10,74
Ar 11,75
Ar 12,76
Ar 13,77
Ar 14,78
Ar 15,79
Vm 8,8,22
Vm 9,9,22
Vm 10,10,22
Vm 11,11,22
Vm 12,12,22
Vm 13,13,22
Vm 14,14,22
Vm 15,15,22
Aw 72,8
Aw 73,9
Aw 74,10
Aw 75,11
Aw 76,12
Aw 77,13
Aw 78,14
Aw 79,15
Ar 8,80
Ar 9,81
Ar 10,82
Ar 11,83
Ar 12,84
Ar 13,85
Ar 14,86
Ar 15,87
Vm 8,8,22
Vm 9,9,22
Vm 10,10,22
Vm 11,11,22
Vm 12,12,22
Vm 13,13,22
Vm 14,14,22
Vm 15,15,22
Aw 80,8
Aw 81,9
Aw 82,10
Aw 83,11
Aw 84,12
Aw 85,13
Aw 86,14
Aw 87,15
Ar 8,88
Ar 9,89
Ar 10,90
Ar 11,91
Ar 12,92
Ar 13,93
Ar 14,94
Ar 15,95
Vm 8,8,22
Vm 9,9,22
Vm 10,10,22
Vm 11,11,22
Vm 12,12,22
Vm 13,13,22
Vm 14,14,22
Vm 15,15,22
Aw 88,8
Aw 89,9
Aw 90,10
Aw 91,11
Aw 92,12
Aw 93,13
Aw 94,14
Aw 95,15
v_max3_f32 v21, v240, v241, v242
v_max3_f32 v21, v21, v243, v244
v_max3_f32 v21, v21, v245, v246
v_max3_f32 v21, v21, v247, v248
v_max3_f32 v21, v21, v249, v250
v_max3_f32 v21, v21, v251, v252
v_max3_f32 v21, v21, v253, v254
v_max_f32 v21, v21, v255
v_mov_b32 v1, v21
s_nop 1
v_permlane16_swap_b32 v1, v21
v_max_f32 v21, v21, v1
v_mov_b32 v1, v21
s_nop 1
v_permlane32_swap_b32 v1, v21
v_max_f32_e64 v21, v21, v1
v_add_f32 v21, 0x41f80000, v21
v_max_f32 v21, 0, v21
Vs 240,240,21
Vs 241,241,21
Vs 242,242,21
Vs 243,243,21
Vs 244,244,21
Vs 245,245,21
Vs 246,246,21
Vs 247,247,21
Vs 248,248,21
Vs 249,249,21
Vs 250,250,21
Vs 251,251,21
Vs 252,252,21
Vs 253,253,21
Vs 254,254,21
Vs 255,255,21
Vs 176,176,21
Vs 177,177,21
Vs 178,178,21
Vs 179,179,21
Vs 180,180,21
Vs 181,181,21
Vs 182,182,21
Vs 183,183,21
Vs 184,184,21
Vs 185,185,21
Vs 186,186,21
Vs 187,187,21
Vs 188,188,21
Vs 189,189,21
Vs 190,190,21
Vs 191,191,21
Vs 44,44,21
Vs 45,45,21
Vs 46,46,21
v_sub_f32_e64 v47, v47, v21
v_exp_f32 v22, -v21
s_nop 0
Vm 60,60,22
Vm 61,61,22
Vm 62,62,22
v_mul_f32_e64 v63, v63, v22
Ar 8,96
Ar 9,97
Ar 10,98
Ar 11,99
Ar 12,100
Ar 13,101
Ar 14,102
Ar 15,103
Vm 8,8,22
Vm 9,9,22
Vm 10,10,22
Vm 11,11,22
Vm 12,12,22
Vm 13,13,22
Vm 14,14,22
Vm 15,15,22
Aw 96,8
Aw 97,9
Aw 98,10
Aw 99,11
Aw 100,12
Aw 101,13
Aw 102,14
Aw 103,15
Ar 8,104
Ar 9,105
Ar 10,106
Ar 11,107
Ar 12,108
Ar 13,109
Ar 14,110
Ar 15,111
Vm 8,8,22
Vm 9,9,22
Vm 10,10,22
Vm 11,11,22
Vm 12,12,22
Vm 13,13,22
Vm 14,14,22
Vm 15,15,22
Aw 104,8
Aw 105,9
Aw 106,10
Aw 107,11
Aw 108,12
Aw 109,13
Aw 110,14
Aw 111,15
Ar 8,112
Ar 9,113
Ar 10,114
Ar 11,115
Ar 12,116
Ar 13,117
Ar 14,118
Ar 15,119
Vm 8,8,22
Vm 9,9,22
Vm 10,10,22
Vm 11,11,22
Vm 12,12,22
Vm 13,13,22
Vm 14,14,22
Vm 15,15,22
Aw 112,8
Aw 113,9
Aw 114,10
Aw 115,11
Aw 116,12
Aw 117,13
Aw 118,14
Aw 119,15
Ar 8,120
Ar 9,121
Ar 10,122
Ar 11,123
Ar 12,124
Ar 13,125
Ar 14,126
Ar 15,127
Vm 8,8,22
Vm 9,9,22
Vm 10,10,22
Vm 11,11,22
Vm 12,12,22
Vm 13,13,22
Vm 14,14,22
Vm 15,15,22
Aw 120,8
Aw 121,9
Aw 122,10
Aw 123,11
Aw 124,12
Aw 125,13
Aw 126,14
Aw 127,15
Ve 8,192
Ve 9,193
s_nop 0
Vc 96,8,9
Ve 8,194
Ve 9,195
s_nop 0
Vc 97,8,9
Ve 8,208
Ve 9,209
s_nop 0
Vc 104,8,9
Ve 8,210
Ve 9,211
s_nop 0
Vc 105,8,9
Ve 8,224
Ve 9,225
s_nop 0
Vc 112,8,9
Ve 8,226
Ve 9,227
s_nop 0
Vc 113,8,9
Ve 8,240
Ve 9,241
s_nop 0
Vc 120,8,9
Ve 8,242
Ve 9,243
s_nop 0
Vc 121,8,9
Ve 8,196
Ve 9,197
s_nop 0
Vc 98,8,9
Ve 8,198
Ve 9,199
s_nop 0
Vc 99,8,9
Ve 8,212
Ve 9,213
s_nop 0
Vc 106,8,9
Ve 8,214
Ve 9,215
s_nop 0
Vc 107,8,9
Ve 8,228
Ve 9,229
s_nop 0
Vc 114,8,9
Ve 8,230
Ve 9,231
s_nop 0
Vc 115,8,9
Ve 8,244
Ve 9,245
s_nop 0
Vc 122,8,9
Ve 8,246
Ve 9,247
s_nop 0
Vc 123,8,9
Ve 8,200
Ve 9,201
s_nop 0
Vc 100,8,9
Ve 8,202
Ve 9,203
s_nop 0
Vc 101,8,9
Ve 8,216
Ve 9,217
s_nop 0
Vc 108,8,9
Ve 8,218
Ve 9,219
s_nop 0
Vc 109,8,9
Ve 8,232
Ve 9,233
s_nop 0
Vc 116,8,9
Ve 8,234
Ve 9,235
s_nop 0
Vc 117,8,9
Ve 8,248
Ve 9,249
s_nop 0
Vc 124,8,9
Ve 8,250
Ve 9,251
s_nop 0
Vc 125,8,9
Ve 8,204
Ve 9,205
s_nop 0
Vc 102,8,9
Ve 8,206
Ve 9,207
s_nop 0
Vc 103,8,9
Ve 8,220
Ve 9,221
s_nop 0
Vc 110,8,9
Ve 8,222
Ve 9,223
s_nop 0
Vc 111,8,9
Ve 8,236
Ve 9,237
s_nop 0
Vc 118,8,9
Ve 8,238
Ve 9,239
s_nop 0
Vc 119,8,9
Ve 8,252
Ve 9,253
s_nop 0
Vc 126,8,9
Ve 8,254
Ve 9,255
s_nop 0
Vc 127,8,9
s_nop 1
s_branch L_k2_fbr_wo
L_k2_fb_wl:
s_nop 7
s_nop 0
v_max3_f32 v21, v128, v129, v130
v_max3_f32 v21, v21, v131, v132
v_max3_f32 v21, v21, v133, v134
v_max3_f32 v21, v21, v135, v136
v_max3_f32 v21, v21, v137, v138
v_max3_f32 v21, v21, v139, v140
v_max3_f32 v21, v21, v141, v142
v_max_f32 v21, v21, v143
v_mov_b32 v1, v21
s_nop 1
v_permlane16_swap_b32 v1, v21
v_max_f32 v21, v21, v1
v_mov_b32 v1, v21
s_nop 1
v_permlane32_swap_b32 v1, v21
v_max_f32_e64 v21, v21, v1
v_add_f32 v21, 0x41f80000, v21
v_max_f32 v21, 0, v21
Vs 128,128,21
Vs 129,129,21
Vs 130,130,21
Vs 131,131,21
Vs 132,132,21
Vs 133,133,21
Vs 134,134,21
Vs 135,135,21
Vs 136,136,21
Vs 137,137,21
Vs 138,138,21
Vs 139,139,21
Vs 140,140,21
Vs 141,141,21
Vs 142,142,21
Vs 143,143,21
Vs 192,192,21
Vs 193,193,21
Vs 194,194,21
Vs 195,195,21
Vs 196,196,21
Vs 197,197,21
Vs 198,198,21
Vs 199,199,21
Vs 200,200,21
Vs 201,201,21
Vs 202,202,21
Vs 203,203,21
Vs 204,204,21
Vs 205,205,21
Vs 206,206,21
Vs 207,207,21
Vs 32,32,21
Vs 33,33,21
Vs 34,34,21
v_sub_f32_e64 v35, v35, v21
v_exp_f32 v22, -v21
s_nop 0
Vm 48,48,22
Vm 49,49,22
Vm 50,50,22
v_mul_f32_e64 v51, v51, v22
Ar 8,0
Ar 9,1
Ar 10,2
Ar 11,3
Ar 12,4
Ar 13,5
Ar 14,6
Ar 15,7
Vm 8,8,22
Vm 9,9,22
Vm 10,10,22
Vm 11,11,22
Vm 12,12,22
Vm 13,13,22
Vm 14,14,22
Vm 15,15,22
Aw 0,8
Aw 1,9
Aw 2,10
Aw 3,11
Aw 4,12
Aw 5,13
Aw 6,14
Aw 7,15
Ar 8,8
Ar 9,9
Ar 10,10
Ar 11,11
Ar 12,12
Ar 13,13
Ar 14,14
Ar 15,15
Vm 8,8,22
Vm 9,9,22
Vm 10,10,22
Vm 11,11,22
Vm 12,12,22
Vm 13,13,22
Vm 14,14,22
Vm 15,15,22
Aw 8,8
Aw 9,9
Aw 10,10
Aw 11,11
Aw 12,12
Aw 13,13
Aw 14,14
Aw 15,15
Ar 8,16
Ar 9,17
Ar 10,18
Ar 11,19
Ar 12,20
Ar 13,21
Ar 14,22
Ar 15,23
Vm 8,8,22
Vm 9,9,22
Vm 10,10,22
Vm 11,11,22
Vm 12,12,22
Vm 13,13,22
Vm 14,14,22
Vm 15,15,22
Aw 16,8
Aw 17,9
Aw 18,10
Aw 19,11
Aw 20,12
Aw 21,13
Aw 22,14
Aw 23,15
Ar 8,24
Ar 9,25
Ar 10,26
Ar 11,27
Ar 12,28
Ar 13,29
Ar 14,30
Ar 15,31
Vm 8,8,22
Vm 9,9,22
Vm 10,10,22
Vm 11,11,22
Vm 12,12,22
Vm 13,13,22
Vm 14,14,22
Vm 15,15,22
Aw 24,8
Aw 25,9
Aw 26,10
Aw 27,11
Aw 28,12
Aw 29,13
Aw 30,14
Aw 31,15
v_max3_f32 v21, v144, v145, v146
v_max3_f32 v21, v21, v147, v148
v_max3_f32 v21, v21, v149, v150
v_max3_f32 v21, v21, v151, v152
v_max3_f32 v21, v21, v153, v154
v_max3_f32 v21, v21, v155, v156
v_max3_f32 v21, v21, v157, v158
v_max_f32 v21, v21, v159
v_mov_b32 v1, v21
s_nop 1
v_permlane16_swap_b32 v1, v21
v_max_f32 v21, v21, v1
v_mov_b32 v1, v21
s_nop 1
v_permlane32_swap_b32 v1, v21
v_max_f32_e64 v21, v21, v1
v_add_f32 v21, 0x41f80000, v21
v_max_f32 v21, 0, v21
Vs 144,144,21
Vs 145,145,21
Vs 146,146,21
Vs 147,147,21
Vs 148,148,21
Vs 149,149,21
Vs 150,150,21
Vs 151,151,21
Vs 152,152,21
Vs 153,153,21
Vs 154,154,21
Vs 155,155,21
Vs 156,156,21
Vs 157,157,21
Vs 158,158,21
Vs 159,159,21
Vs 208,208,21
Vs 209,209,21
Vs 210,210,21
Vs 211,211,21
Vs 212,212,21
Vs 213,213,21
Vs 214,214,21
Vs 215,215,21
Vs 216,216,21
Vs 217,217,21
Vs 218,218,21
Vs 219,219,21
Vs 220,220,21
Vs 221,221,21
Vs 222,222,21
Vs 223,223,21
Vs 36,36,21
Vs 37,37,21
Vs 38,38,21
v_sub_f32_e64 v39, v39, v21
v_exp_f32 v22, -v21
s_nop 0
Vm 52,52,22
Vm 53,53,22
Vm 54,54,22
v_mul_f32_e64 v55, v55, v22
Ar 8,32
Ar 9,33
Ar 10,34
Ar 11,35
Ar 12,36
Ar 13,37
Ar 14,38
Ar 15,39
Vm 8,8,22
Vm 9,9,22
Vm 10,10,22
Vm 11,11,22
Vm 12,12,22
Vm 13,13,22
Vm 14,14,22
Vm 15,15,22
Aw 32,8
Aw 33,9
Aw 34,10
Aw 35,11
Aw 36,12
Aw 37,13
Aw 38,14
Aw 39,15
Ar 8,40
Ar 9,41
Ar 10,42
Ar 11,43
Ar 12,44
Ar 13,45
Ar 14,46
Ar 15,47
Vm 8,8,22
Vm 9,9,22
Vm 10,10,22
Vm 11,11,22
Vm 12,12,22
Vm 13,13,22
Vm 14,14,22
Vm 15,15,22
Aw 40,8
Aw 41,9
Aw 42,10
Aw 43,11
Aw 44,12
Aw 45,13
Aw 46,14
Aw 47,15
Ar 8,48
Ar 9,49
Ar 10,50
Ar 11,51
Ar 12,52
Ar 13,53
Ar 14,54
Ar 15,55
Vm 8,8,22
Vm 9,9,22
Vm 10,10,22
Vm 11,11,22
Vm 12,12,22
Vm 13,13,22
Vm 14,14,22
Vm 15,15,22
Aw 48,8
Aw 49,9
Aw 50,10
Aw 51,11
Aw 52,12
Aw 53,13
Aw 54,14
Aw 55,15
Ar 8,56
Ar 9,57
Ar 10,58
Ar 11,59
Ar 12,60
Ar 13,61
Ar 14,62
Ar 15,63
Vm 8,8,22
Vm 9,9,22
Vm 10,10,22
Vm 11,11,22
Vm 12,12,22
Vm 13,13,22
Vm 14,14,22
Vm 15,15,22
Aw 56,8
Aw 57,9
Aw 58,10
Aw 59,11
Aw 60,12
Aw 61,13
Aw 62,14
Aw 63,15
v_max3_f32 v21, v160, v161, v162
v_max3_f32 v21, v21, v163, v164
v_max3_f32 v21, v21, v165, v166
v_max3_f32 v21, v21, v167, v168
v_max3_f32 v21, v21, v169, v170
v_max3_f32 v21, v21, v171, v172
v_max3_f32 v21, v21, v173, v174
v_max_f32 v21, v21, v175
v_mov_b32 v1, v21
s_nop 1
v_permlane16_swap_b32 v1, v21
v_max_f32 v21, v21, v1
v_mov_b32 v1, v21
s_nop 1
v_permlane32_swap_b32 v1, v21
v_max_f32_e64 v21, v21, v1
v_add_f32 v21, 0x41f80000, v21
v_max_f32 v21, 0, v21
Vs 160,160,21
Vs 161,161,21
Vs 162,162,21
Vs 163,163,21
Vs 164,164,21
Vs 165,165,21
Vs 166,166,21
Vs 167,167,21
Vs 168,168,21
Vs 169,169,21
Vs 170,170,21
Vs 171,171,21
Vs 172,172,21
Vs 173,173,21
Vs 174,174,21
Vs 175,175,21
Vs 224,224,21
Vs 225,225,21
Vs 226,226,21
Vs 227,227,21
Vs 228,228,21
Vs 229,229,21
Vs 230,230,21
Vs 231,231,21
Vs 232,232,21
Vs 233,233,21
Vs 234,234,21
Vs 235,235,21
Vs 236,236,21
Vs 237,237,21
Vs 238,238,21
Vs 239,239,21
Vs 40,40,21
Vs 41,41,21
Vs 42,42,21
v_sub_f32_e64 v43, v43, v21
v_exp_f32 v22, -v21
s_nop 0
Vm 56,56,22
Vm 57,57,22
Vm 58,58,22
v_mul_f32_e64 v59, v59, v22
Ar 8,64
Ar 9,65
Ar 10,66
Ar 11,67
Ar 12,68
Ar 13,69
Ar 14,70
Ar 15,71
Vm 8,8,22
Vm 9,9,22
Vm 10,10,22
Vm 11,11,22
Vm 12,12,22
Vm 13,13,22
Vm 14,14,22
Vm 15,15,22
Aw 64,8
Aw 65,9
Aw 66,10
Aw 67,11
Aw 68,12
Aw 69,13
Aw 70,14
Aw 71,15
Ar 8,72
Ar 9,73
Ar 10,74
Ar 11,75
Ar 12,76
Ar 13,77
Ar 14,78
Ar 15,79
Vm 8,8,22
Vm 9,9,22
Vm 10,10,22
Vm 11,11,22
Vm 12,12,22
Vm 13,13,22
Vm 14,14,22
Vm 15,15,22
Aw 72,8
Aw 73,9
Aw 74,10
Aw 75,11
Aw 76,12
Aw 77,13
Aw 78,14
Aw 79,15
Ar 8,80
Ar 9,81
Ar 10,82
Ar 11,83
Ar 12,84
Ar 13,85
Ar 14,86
Ar 15,87
Vm 8,8,22
Vm 9,9,22
Vm 10,10,22
Vm 11,11,22
Vm 12,12,22
Vm 13,13,22
Vm 14,14,22
Vm 15,15,22
Aw 80,8
Aw 81,9
Aw 82,10
Aw 83,11
Aw 84,12
Aw 85,13
Aw 86,14
Aw 87,15
Ar 8,88
Ar 9,89
Ar 10,90
Ar 11,91
Ar 12,92
Ar 13,93
Ar 14,94
Ar 15,95
Vm 8,8,22
Vm 9,9,22
Vm 10,10,22
Vm 11,11,22
Vm 12,12,22
Vm 13,13,22
Vm 14,14,22
Vm 15,15,22
Aw 88,8
Aw 89,9
Aw 90,10
Aw 91,11
Aw 92,12
Aw 93,13
Aw 94,14
Aw 95,15
v_max3_f32 v21, v176, v177, v178
v_max3_f32 v21, v21, v179, v180
v_max3_f32 v21, v21, v181, v182
v_max3_f32 v21, v21, v183, v184
v_max3_f32 v21, v21, v185, v186
v_max3_f32 v21, v21, v187, v188
v_max3_f32 v21, v21, v189, v190
v_max_f32 v21, v21, v191
v_mov_b32 v1, v21
s_nop 1
v_permlane16_swap_b32 v1, v21
v_max_f32 v21, v21, v1
v_mov_b32 v1, v21
s_nop 1
v_permlane32_swap_b32 v1, v21
v_max_f32_e64 v21, v21, v1
v_add_f32 v21, 0x41f80000, v21
v_max_f32 v21, 0, v21
Vs 176,176,21
Vs 177,177,21
Vs 178,178,21
Vs 179,179,21
Vs 180,180,21
Vs 181,181,21
Vs 182,182,21
Vs 183,183,21
Vs 184,184,21
Vs 185,185,21
Vs 186,186,21
Vs 187,187,21
Vs 188,188,21
Vs 189,189,21
Vs 190,190,21
Vs 191,191,21
Vs 44,44,21
Vs 45,45,21
Vs 46,46,21
v_sub_f32_e64 v47, v47, v21
v_exp_f32 v22, -v21
s_nop 0
Vm 60,60,22
Vm 61,61,22
Vm 62,62,22
v_mul_f32_e64 v63, v63, v22
Ar 8,96
Ar 9,97
Ar 10,98
Ar 11,99
Ar 12,100
Ar 13,101
Ar 14,102
Ar 15,103
Vm 8,8,22
Vm 9,9,22
Vm 10,10,22
Vm 11,11,22
Vm 12,12,22
Vm 13,13,22
Vm 14,14,22
Vm 15,15,22
Aw 96,8
Aw 97,9
Aw 98,10
Aw 99,11
Aw 100,12
Aw 101,13
Aw 102,14
Aw 103,15
Ar 8,104
Ar 9,105
Ar 10,106
Ar 11,107
Ar 12,108
Ar 13,109
Ar 14,110
Ar 15,111
Vm 8,8,22
Vm 9,9,22
Vm 10,10,22
Vm 11,11,22
Vm 12,12,22
Vm 13,13,22
Vm 14,14,22
Vm 15,15,22
Aw 104,8
Aw 105,9
Aw 106,10
Aw 107,11
Aw 108,12
Aw 109,13
Aw 110,14
Aw 111,15
Ar 8,112
Ar 9,113
Ar 10,114
Ar 11,115
Ar 12,116
Ar 13,117
Ar 14,118
Ar 15,119
Vm 8,8,22
Vm 9,9,22
Vm 10,10,22
Vm 11,11,22
Vm 12,12,22
Vm 13,13,22
Vm 14,14,22
Vm 15,15,22
Aw 112,8
Aw 113,9
Aw 114,10
Aw 115,11
Aw 116,12
Aw 117,13
Aw 118,14
Aw 119,15
Ar 8,120
Ar 9,121
Ar 10,122
Ar 11,123
Ar 12,124
Ar 13,125
Ar 14,126
Ar 15,127
Vm 8,8,22
Vm 9,9,22
Vm 10,10,22
Vm 11,11,22
Vm 12,12,22
Vm 13,13,22
Vm 14,14,22
Vm 15,15,22
Aw 120,8
Aw 121,9
Aw 122,10
Aw 123,11
Aw 124,12
Aw 125,13
Aw 126,14
Aw 127,15
Ve 8,128
Ve 9,129
s_nop 0
Vc 64,8,9
Ve 8,130
Ve 9,131
s_nop 0
Vc 65,8,9
Ve 8,144
Ve 9,145
s_nop 0
Vc 72,8,9
Ve 8,146
Ve 9,147
s_nop 0
Vc 73,8,9
Ve 8,160
Ve 9,161
s_nop 0
Vc 80,8,9
Ve 8,162
Ve 9,163
s_nop 0
Vc 81,8,9
Ve 8,176
Ve 9,177
s_nop 0
Vc 88,8,9
Ve 8,178
Ve 9,179
s_nop 0
Vc 89,8,9
Ve 8,132
Ve 9,133
s_nop 0
Vc 66,8,9
Ve 8,134
Ve 9,135
s_nop 0
Vc 67,8,9
Ve 8,148
Ve 9,149
s_nop 0
Vc 74,8,9
Ve 8,150
Ve 9,151
s_nop 0
Vc 75,8,9
Ve 8,164
Ve 9,165
s_nop 0
Vc 82,8,9
Ve 8,166
Ve 9,167
s_nop 0
Vc 83,8,9
Ve 8,180
Ve 9,181
s_nop 0
Vc 90,8,9
Ve 8,182
Ve 9,183
s_nop 0
Vc 91,8,9
Ve 8,136
Ve 9,137
s_nop 0
Vc 68,8,9
Ve 8,138
Ve 9,139
s_nop 0
Vc 69,8,9
Ve 8,152
Ve 9,153
s_nop 0
Vc 76,8,9
Ve 8,154
Ve 9,155
s_nop 0
Vc 77,8,9
Ve 8,168
Ve 9,169
s_nop 0
Vc 84,8,9
Ve 8,170
Ve 9,171
s_nop 0
Vc 85,8,9
Ve 8,184
Ve 9,185
s_nop 0
Vc 92,8,9
Ve 8,186
Ve 9,187
s_nop 0
Vc 93,8,9
Ve 8,140
Ve 9,141
s_nop 0
Vc 70,8,9
Ve 8,142
Ve 9,143
s_nop 0
Vc 71,8,9
Ve 8,156
Ve 9,157
s_nop 0
Vc 78,8,9
Ve 8,158
Ve 9,159
s_nop 0
Vc 79,8,9
Ve 8,172
Ve 9,173
s_nop 0
Vc 86,8,9
Ve 8,174
Ve 9,175
s_nop 0
Vc 87,8,9
Ve 8,188
Ve 9,189
s_nop 0
Vc 94,8,9
Ve 8,190
Ve 9,191
s_nop 0
Vc 95,8,9
s_nop 1
s_branch L_k2_fbr_wl
L_k2_fb_tr:
s_nop 7
s_nop 0
v_max3_f32 v21, v192, v193, v194
v_max3_f32 v21, v21, v195, v196
v_max3_f32 v21, v21, v197, v198
v_max3_f32 v21, v21, v199, v200
v_max3_f32 v21, v21, v201, v202
v_max3_f32 v21, v21, v203, v204
v_max3_f32 v21, v21, v205, v206
v_max_f32 v21, v21, v207
v_mov_b32 v1, v21
s_nop 1
v_permlane16_swap_b32 v1, v21
v_max_f32 v21, v21, v1
v_mov_b32 v1, v21
s_nop 1
v_permlane32_swap_b32 v1, v21
v_max_f32_e64 v21, v21, v1
v_add_f32 v21, 0x41f80000, v21
v_max_f32 v21, 0, v21
Vs 192,192,21
Vs 193,193,21
Vs 194,194,21
Vs 195,195,21
Vs 196,196,21
Vs 197,197,21
Vs 198,198,21
Vs 199,199,21
Vs 200,200,21
Vs 201,201,21
Vs 202,202,21
Vs 203,203,21
Vs 204,204,21
Vs 205,205,21
Vs 206,206,21
Vs 207,207,21
Vs 128,128,21
Vs 129,129,21
Vs 130,130,21
Vs 131,131,21
Vs 132,132,21
Vs 133,133,21
Vs 134,134,21
Vs 135,135,21
Vs 136,136,21
Vs 137,137,21
Vs 138,138,21
Vs 139,139,21
Vs 140,140,21
Vs 141,141,21
Vs 142,142,21
Vs 143,143,21
Vs 32,32,21
Vs 33,33,21
Vs 34,34,21
v_sub_f32_e64 v35, v35, v21
v_exp_f32 v22, -v21
s_nop 0
Vm 48,48,22
Vm 49,49,22
Vm 50,50,22
v_mul_f32_e64 v51, v51, v22
Ar 8,0
Ar 9,1
Ar 10,2
Ar 11,3
Ar 12,4
Ar 13,5
Ar 14,6
Ar 15,7
Vm 8,8,22
Vm 9,9,22
Vm 10,10,22
Vm 11,11,22
Vm 12,12,22
Vm 13,13,22
Vm 14,14,22
Vm 15,15,22
Aw 0,8
Aw 1,9
Aw 2,10
Aw 3,11
Aw 4,12
Aw 5,13
Aw 6,14
Aw 7,15
Ar 8,8
Ar 9,9
Ar 10,10
Ar 11,11
Ar 12,12
Ar 13,13
Ar 14,14
Ar 15,15
Vm 8,8,22
Vm 9,9,22
Vm 10,10,22
Vm 11,11,22
Vm 12,12,22
Vm 13,13,22
Vm 14,14,22
Vm 15,15,22
Aw 8,8
Aw 9,9
Aw 10,10
Aw 11,11
Aw 12,12
Aw 13,13
Aw 14,14
Aw 15,15
Ar 8,16
Ar 9,17
Ar 10,18
Ar 11,19
Ar 12,20
Ar 13,21
Ar 14,22
Ar 15,23
Vm 8,8,22
Vm 9,9,22
Vm 10,10,22
Vm 11,11,22
Vm 12,12,22
Vm 13,13,22
Vm 14,14,22
Vm 15,15,22
Aw 16,8
Aw 17,9
Aw 18,10
Aw 19,11
Aw 20,12
Aw 21,13
Aw 22,14
Aw 23,15
Ar 8,24
Ar 9,25
Ar 10,26
Ar 11,27
Ar 12,28
Ar 13,29
Ar 14,30
Ar 15,31
Vm 8,8,22
Vm 9,9,22
Vm 10,10,22
Vm 11,11,22
Vm 12,12,22
Vm 13,13,22
Vm 14,14,22
Vm 15,15,22
Aw 24,8
Aw 25,9
Aw 26,10
Aw 27,11
Aw 28,12
Aw 29,13
Aw 30,14
Aw 31,15
v_max3_f32 v21, v208, v209, v210
v_max3_f32 v21, v21, v211, v212
v_max3_f32 v21, v21, v213, v214
v_max3_f32 v21, v21, v215, v216
v_max3_f32 v21, v21, v217, v218
v_max3_f32 v21, v21, v219, v220
v_max3_f32 v21, v21, v221, v222
v_max_f32 v21, v21, v223
v_mov_b32 v1, v21
s_nop 1
v_permlane16_swap_b32 v1, v21
v_max_f32 v21, v21, v1
v_mov_b32 v1, v21
s_nop 1
v_permlane32_swap_b32 v1, v21
v_max_f32_e64 v21, v21, v1
v_add_f32 v21, 0x41f80000, v21
v_max_f32 v21, 0, v21
Vs 208,208,21
Vs 209,209,21
Vs 210,210,21
Vs 211,211,21
Vs 212,212,21
Vs 213,213,21
Vs 214,214,21
Vs 215,215,21
Vs 216,216,21
Vs 217,217,21
Vs 218,218,21
Vs 219,219,21
Vs 220,220,21
Vs 221,221,21
Vs 222,222,21
Vs 223,223,21
Vs 144,144,21
Vs 145,145,21
Vs 146,146,21
Vs 147,147,21
Vs 148,148,21
Vs 149,149,21
Vs 150,150,21
Vs 151,151,21
Vs 152,152,21
Vs 153,153,21
Vs 154,154,21
Vs 155,155,21
Vs 156,156,21
Vs 157,157,21
Vs 158,158,21
Vs 159,159,21
Vs 36,36,21
Vs 37,37,21
Vs 38,38,21
v_sub_f32_e64 v39, v39, v21
v_exp_f32 v22, -v21
s_nop 0
Vm 52,52,22
Vm 53,53,22
Vm 54,54,22
v_mul_f32_e64 v55, v55, v22
Ar 8,32
Ar 9,33
Ar 10,34
Ar 11,35
Ar 12,36
Ar 13,37
Ar 14,38
Ar 15,39
Vm 8,8,22
Vm 9,9,22
Vm 10,10,22
Vm 11,11,22
Vm 12,12,22
Vm 13,13,22
Vm 14,14,22
Vm 15,15,22
Aw 32,8
Aw 33,9
Aw 34,10
Aw 35,11
Aw 36,12
Aw 37,13
Aw 38,14
Aw 39,15
Ar 8,40
Ar 9,41
Ar 10,42
Ar 11,43
Ar 12,44
Ar 13,45
Ar 14,46
Ar 15,47
Vm 8,8,22
Vm 9,9,22
Vm 10,10,22
Vm 11,11,22
Vm 12,12,22
Vm 13,13,22
Vm 14,14,22
Vm 15,15,22
Aw 40,8
Aw 41,9
Aw 42,10
Aw 43,11
Aw 44,12
Aw 45,13
Aw 46,14
Aw 47,15
Ar 8,48
Ar 9,49
Ar 10,50
Ar 11,51
Ar 12,52
Ar 13,53
Ar 14,54
Ar 15,55
Vm 8,8,22
Vm 9,9,22
Vm 10,10,22
Vm 11,11,22
Vm 12,12,22
Vm 13,13,22
Vm 14,14,22
Vm 15,15,22
Aw 48,8
Aw 49,9
Aw 50,10
Aw 51,11
Aw 52,12
Aw 53,13
Aw 54,14
Aw 55,15
Ar 8,56
Ar 9,57
Ar 10,58
Ar 11,59
Ar 12,60
Ar 13,61
Ar 14,62
Ar 15,63
Vm 8,8,22
Vm 9,9,22
Vm 10,10,22
Vm 11,11,22
Vm 12,12,22
Vm 13,13,22
Vm 14,14,22
Vm 15,15,22
Aw 56,8
Aw 57,9
Aw 58,10
Aw 59,11
Aw 60,12
Aw 61,13
Aw 62,14
Aw 63,15
v_max3_f32 v21, v224, v225, v226
v_max3_f32 v21, v21, v227, v228
v_max3_f32 v21, v21, v229, v230
v_max3_f32 v21, v21, v231, v232
v_max3_f32 v21, v21, v233, v234
v_max3_f32 v21, v21, v235, v236
v_max3_f32 v21, v21, v237, v238
v_max_f32 v21, v21, v239
v_mov_b32 v1, v21
s_nop 1
v_permlane16_swap_b32 v1, v21
v_max_f32 v21, v21, v1
v_mov_b32 v1, v21
s_nop 1
v_permlane32_swap_b32 v1, v21
v_max_f32_e64 v21, v21, v1
v_add_f32 v21, 0x41f80000, v21
v_max_f32 v21, 0, v21
Vs 224,224,21
Vs 225,225,21
Vs 226,226,21
Vs 227,227,21
Vs 228,228,21
Vs 229,229,21
Vs 230,230,21
Vs 231,231,21
Vs 232,232,21
Vs 233,233,21
Vs 234,234,21
Vs 235,235,21
Vs 236,236,21
Vs 237,237,21
Vs 238,238,21
Vs 239,239,21
Vs 40,40,21
Vs 41,41,21
Vs 42,42,21
v_sub_f32_e64 v43, v43, v21
v_exp_f32 v22, -v21
s_nop 0
Vm 56,56,22
Vm 57,57,22
Vm 58,58,22
v_mul_f32_e64 v59, v59, v22
Ar 8,64
Ar 9,65
Ar 10,66
Ar 11,67
Ar 12,68
Ar 13,69
Ar 14,70
Ar 15,71
Vm 8,8,22
Vm 9,9,22
Vm 10,10,22
Vm 11,11,22
Vm 12,12,22
Vm 13,13,22
Vm 14,14,22
Vm 15,15,22
Aw 64,8
Aw 65,9
Aw 66,10
Aw 67,11
Aw 68,12
Aw 69,13
Aw 70,14
Aw 71,15
Ar 8,72
Ar 9,73
Ar 10,74
Ar 11,75
Ar 12,76
Ar 13,77
Ar 14,78
Ar 15,79
Vm 8,8,22
Vm 9,9,22
Vm 10,10,22
Vm 11,11,22
Vm 12,12,22
Vm 13,13,22
Vm 14,14,22
Vm 15,15,22
Aw 72,8
Aw 73,9
Aw 74,10
Aw 75,11
Aw 76,12
Aw 77,13
Aw 78,14
Aw 79,15
Ar 8,80
Ar 9,81
Ar 10,82
Ar 11,83
Ar 12,84
Ar 13,85
Ar 14,86
Ar 15,87
Vm 8,8,22
Vm 9,9,22
Vm 10,10,22
Vm 11,11,22
Vm 12,12,22
Vm 13,13,22
Vm 14,14,22
Vm 15,15,22
Aw 80,8
Aw 81,9
Aw 82,10
Aw 83,11
Aw 84,12
Aw 85,13
Aw 86,14
Aw 87,15
Ar 8,88
Ar 9,89
Ar 10,90
Ar 11,91
Ar 12,92
Ar 13,93
Ar 14,94
Ar 15,95
Vm 8,8,22
Vm 9,9,22
Vm 10,10,22
Vm 11,11,22
Vm 12,12,22
Vm 13,13,22
Vm 14,14,22
Vm 15,15,22
Aw 88,8
Aw 89,9
Aw 90,10
Aw 91,11
Aw 92,12
Aw 93,13
Aw 94,14
Aw 95,15
Ve 8,192
Ve 9,193
s_nop 0
Vc 96,8,9
Ve 8,194
Ve 9,195
s_nop 0
Vc 97,8,9
Ve 8,208
Ve 9,209
s_nop 0
Vc 104,8,9
Ve 8,210
Ve 9,211
s_nop 0
Vc 105,8,9
Ve 8,224
Ve 9,225
s_nop 0
Vc 112,8,9
Ve 8,226
Ve 9,227
s_nop 0
Vc 113,8,9
Ve 8,196
Ve 9,197
s_nop 0
Vc 98,8,9
Ve 8,198
Ve 9,199
s_nop 0
Vc 99,8,9
Ve 8,212
Ve 9,213
s_nop 0
Vc 106,8,9
Ve 8,214
Ve 9,215
s_nop 0
Vc 107,8,9
Ve 8,228
Ve 9,229
s_nop 0
Vc 114,8,9
Ve 8,230
Ve 9,231
s_nop 0
Vc 115,8,9
Ve 8,200
Ve 9,201
s_nop 0
Vc 100,8,9
Ve 8,202
Ve 9,203
s_nop 0
Vc 101,8,9
Ve 8,216
Ve 9,217
s_nop 0
Vc 108,8,9
Ve 8,218
Ve 9,219
s_nop 0
Vc 109,8,9
Ve 8,232
Ve 9,233
s_nop 0
Vc 116,8,9
Ve 8,234
Ve 9,235
s_nop 0
Vc 117,8,9
Ve 8,204
Ve 9,205
s_nop 0
Vc 102,8,9
Ve 8,206
Ve 9,207
s_nop 0
Vc 103,8,9
Ve 8,220
Ve 9,221
s_nop 0
Vc 110,8,9
Ve 8,222
Ve 9,223
s_nop 0
Vc 111,8,9
Ve 8,236
Ve 9,237
s_nop 0
Vc 118,8,9
Ve 8,238
Ve 9,239
s_nop 0
Vc 119,8,9
s_nop 1
s_branch L_k2_fbr_tr
L_k2_fb_ne:
s_nop 7
s_nop 0
v_max3_f32 v21, v128, v129, v130
v_max3_f32 v21, v21, v131, v132
v_max3_f32 v21, v21, v133, v134
v_max3_f32 v21, v21, v135, v136
v_max3_f32 v21, v21, v137, v138
v_max3_f32 v21, v21, v139, v140
v_max3_f32 v21, v21, v141, v142
v_max_f32 v21, v21, v143
v_mov_b32 v1, v21
s_nop 1
v_permlane16_swap_b32 v1, v21
v_max_f32 v21, v21, v1
v_mov_b32 v1, v21
s_nop 1
v_permlane32_swap_b32 v1, v21
v_max_f32_e64 v21, v21, v1
v_add_f32 v21, 0x41f80000, v21
v_max_f32 v21, 0, v21
Vs 128,128,21
Vs 129,129,21
Vs 130,130,21
Vs 131,131,21
Vs 132,132,21
Vs 133,133,21
Vs 134,134,21
Vs 135,135,21
Vs 136,136,21
Vs 137,137,21
Vs 138,138,21
Vs 139,139,21
Vs 140,140,21
Vs 141,141,21
Vs 142,142,21
Vs 143,143,21
Vs 192,192,21
Vs 193,193,21
Vs 194,194,21
Vs 195,195,21
Vs 196,196,21
Vs 197,197,21
Vs 198,198,21
Vs 199,199,21
Vs 200,200,21
Vs 201,201,21
Vs 202,202,21
Vs 203,203,21
Vs 204,204,21
Vs 205,205,21
Vs 206,206,21
Vs 207,207,21
Vs 32,32,21
Vs 33,33,21
Vs 34,34,21
v_sub_f32_e64 v35, v35, v21
v_exp_f32 v22, -v21
s_nop 0
Vm 48,48,22
Vm 49,49,22
Vm 50,50,22
v_mul_f32_e64 v51, v51, v22
Ar 8,0
Ar 9,1
Ar 10,2
Ar 11,3
Ar 12,4
Ar 13,5
Ar 14,6
Ar 15,7
Vm 8,8,22
Vm 9,9,22
Vm 10,10,22
Vm 11,11,22
Vm 12,12,22
Vm 13,13,22
Vm 14,14,22
Vm 15,15,22
Aw 0,8
Aw 1,9
Aw 2,10
Aw 3,11
Aw 4,12
Aw 5,13
Aw 6,14
Aw 7,15
Ar 8,8
Ar 9,9
Ar 10,10
Ar 11,11
Ar 12,12
Ar 13,13
Ar 14,14
Ar 15,15
Vm 8,8,22
Vm 9,9,22
Vm 10,10,22
Vm 11,11,22
Vm 12,12,22
Vm 13,13,22
Vm 14,14,22
Vm 15,15,22
Aw 8,8
Aw 9,9
Aw 10,10
Aw 11,11
Aw 12,12
Aw 13,13
Aw 14,14
Aw 15,15
Ar 8,16
Ar 9,17
Ar 10,18
Ar 11,19
Ar 12,20
Ar 13,21
Ar 14,22
Ar 15,23
Vm 8,8,22
Vm 9,9,22
Vm 10,10,22
Vm 11,11,22
Vm 12,12,22
Vm 13,13,22
Vm 14,14,22
Vm 15,15,22
Aw 16,8
Aw 17,9
Aw 18,10
Aw 19,11
Aw 20,12
Aw 21,13
Aw 22,14
Aw 23,15
Ar 8,24
Ar 9,25
Ar 10,26
Ar 11,27
Ar 12,28
Ar 13,29
Ar 14,30
Ar 15,31
Vm 8,8,22
Vm 9,9,22
Vm 10,10,22
Vm 11,11,22
Vm 12,12,22
Vm 13,13,22
Vm 14,14,22
Vm 15,15,22
Aw 24,8
Aw 25,9
Aw 26,10
Aw 27,11
Aw 28,12
Aw 29,13
Aw 30,14
Aw 31,15
v_max3_f32 v21, v144, v145, v146
v_max3_f32 v21, v21, v147, v148
v_max3_f32 v21, v21, v149, v150
v_max3_f32 v21, v21, v151, v152
v_max3_f32 v21, v21, v153, v154
v_max3_f32 v21, v21, v155, v156
v_max3_f32 v21, v21, v157, v158
v_max_f32 v21, v21, v159
v_mov_b32 v1, v21
s_nop 1
v_permlane16_swap_b32 v1, v21
v_max_f32 v21, v21, v1
v_mov_b32 v1, v21
s_nop 1
v_permlane32_swap_b32 v1, v21
v_max_f32_e64 v21, v21, v1
v_add_f32 v21, 0x41f80000, v21
v_max_f32 v21, 0, v21
Vs 144,144,21
Vs 145,145,21
Vs 146,146,21
Vs 147,147,21
Vs 148,148,21
Vs 149,149,21
Vs 150,150,21
Vs 151,151,21
Vs 152,152,21
Vs 153,153,21
Vs 154,154,21
Vs 155,155,21
Vs 156,156,21
Vs 157,157,21
Vs 158,158,21
Vs 159,159,21
Vs 208,208,21
Vs 209,209,21
Vs 210,210,21
Vs 211,211,21
Vs 212,212,21
Vs 213,213,21
Vs 214,214,21
Vs 215,215,21
Vs 216,216,21
Vs 217,217,21
Vs 218,218,21
Vs 219,219,21
Vs 220,220,21
Vs 221,221,21
Vs 222,222,21
Vs 223,223,21
Vs 36,36,21
Vs 37,37,21
Vs 38,38,21
v_sub_f32_e64 v39, v39, v21
v_exp_f32 v22, -v21
s_nop 0
Vm 52,52,22
Vm 53,53,22
Vm 54,54,22
v_mul_f32_e64 v55, v55, v22
Ar 8,32
Ar 9,33
Ar 10,34
Ar 11,35
Ar 12,36
Ar 13,37
Ar 14,38
Ar 15,39
Vm 8,8,22
Vm 9,9,22
Vm 10,10,22
Vm 11,11,22
Vm 12,12,22
Vm 13,13,22
Vm 14,14,22
Vm 15,15,22
Aw 32,8
Aw 33,9
Aw 34,10
Aw 35,11
Aw 36,12
Aw 37,13
Aw 38,14
Aw 39,15
Ar 8,40
Ar 9,41
Ar 10,42
Ar 11,43
Ar 12,44
Ar 13,45
Ar 14,46
Ar 15,47
Vm 8,8,22
Vm 9,9,22
Vm 10,10,22
Vm 11,11,22
Vm 12,12,22
Vm 13,13,22
Vm 14,14,22
Vm 15,15,22
Aw 40,8
Aw 41,9
Aw 42,10
Aw 43,11
Aw 44,12
Aw 45,13
Aw 46,14
Aw 47,15
Ar 8,48
Ar 9,49
Ar 10,50
Ar 11,51
Ar 12,52
Ar 13,53
Ar 14,54
Ar 15,55
Vm 8,8,22
Vm 9,9,22
Vm 10,10,22
Vm 11,11,22
Vm 12,12,22
Vm 13,13,22
Vm 14,14,22
Vm 15,15,22
Aw 48,8
Aw 49,9
Aw 50,10
Aw 51,11
Aw 52,12
Aw 53,13
Aw 54,14
Aw 55,15
Ar 8,56
Ar 9,57
Ar 10,58
Ar 11,59
Ar 12,60
Ar 13,61
Ar 14,62
Ar 15,63
Vm 8,8,22
Vm 9,9,22
Vm 10,10,22
Vm 11,11,22
Vm 12,12,22
Vm 13,13,22
Vm 14,14,22
Vm 15,15,22
Aw 56,8
Aw 57,9
Aw 58,10
Aw 59,11
Aw 60,12
Aw 61,13
Aw 62,14
Aw 63,15
Ve 8,128
Ve 9,129
s_nop 0
Vc 64,8,9
Ve 8,130
Ve 9,131
s_nop 0
Vc 65,8,9
Ve 8,144
Ve 9,145
s_nop 0
Vc 72,8,9
Ve 8,146
Ve 9,147
s_nop 0
Vc 73,8,9
Ve 8,132
Ve 9,133
s_nop 0
Vc 66,8,9
Ve 8,134
Ve 9,135
s_nop 0
Vc 67,8,9
Ve 8,148
Ve 9,149
s_nop 0
Vc 74,8,9
Ve 8,150
Ve 9,151
s_nop 0
Vc 75,8,9
Ve 8,136
Ve 9,137
s_nop 0
Vc 68,8,9
Ve 8,138
Ve 9,139
s_nop 0
Vc 69,8,9
Ve 8,152
Ve 9,153
s_nop 0
Vc 76,8,9
Ve 8,154
Ve 9,155
s_nop 0
Vc 77,8,9
Ve 8,140
Ve 9,141
s_nop 0
Vc 70,8,9
Ve 8,142
Ve 9,143
s_nop 0
Vc 71,8,9
Ve 8,156
Ve 9,157
s_nop 0
Vc 78,8,9
Ve 8,158
Ve 9,159
s_nop 0
Vc 79,8,9
s_nop 1
s_branch L_k2_fbr_ne
L_k2_fb_no:
s_nop 7
s_nop 0
v_max3_f32 v21, v192, v193, v194
v_max3_f32 v21, v21, v195, v196
v_max3_f32 v21, v21, v197, v198
v_max3_f32 v21, v21, v199, v200
v_max3_f32 v21, v21, v201, v202
v_max3_f32 v21, v21, v203, v204
v_max3_f32 v21, v21, v205, v206
v_max_f32 v21, v21, v207
v_mov_b32 v1, v21
s_nop 1
v_permlane16_swap_b32 v1, v21
v_max_f32 v21, v21, v1
v_mov_b32 v1, v21
s_nop 1
v_permlane32_swap_b32 v1, v21
v_max_f32_e64 v21, v21, v1
v_add_f32 v21, 0x41f80000, v21
v_max_f32 v21, 0, v21
Vs 192,192,21
Vs 193,193,21
Vs 194,194,21
Vs 195,195,21
Vs 196,196,21
Vs 197,197,21
Vs 198,198,21
Vs 199,199,21
Vs 200,200,21
Vs 201,201,21
Vs 202,202,21
Vs 203,203,21
Vs 204,204,21
Vs 205,205,21
Vs 206,206,21
Vs 207,207,21
Vs 128,128,21
Vs 129,129,21
Vs 130,130,21
Vs 131,131,21
Vs 132,132,21
Vs 133,133,21
Vs 134,134,21
Vs 135,135,21
Vs 136,136,21
Vs 137,137,21
Vs 138,138,21
Vs 139,139,21
Vs 140,140,21
Vs 141,141,21
Vs 142,142,21
Vs 143,143,21
Vs 32,32,21
Vs 33,33,21
Vs 34,34,21
v_sub_f32_e64 v35, v35, v21
v_exp_f32 v22, -v21
s_nop 0
Vm 48,48,22
Vm 49,49,22
Vm 50,50,22
v_mul_f32_e64 v51, v51, v22
Ar 8,0
Ar 9,1
Ar 10,2
Ar 11,3
Ar 12,4
Ar 13,5
Ar 14,6
Ar 15,7
Vm 8,8,22
Vm 9,9,22
Vm 10,10,22
Vm 11,11,22
Vm 12,12,22
Vm 13,13,22
Vm 14,14,22
Vm 15,15,22
Aw 0,8
Aw 1,9
Aw 2,10
Aw 3,11
Aw 4,12
Aw 5,13
Aw 6,14
Aw 7,15
Ar 8,8
Ar 9,9
Ar 10,10
Ar 11,11
Ar 12,12
Ar 13,13
Ar 14,14
Ar 15,15
Vm 8,8,22
Vm 9,9,22
Vm 10,10,22
Vm 11,11,22
Vm 12,12,22
Vm 13,13,22
Vm 14,14,22
Vm 15,15,22
Aw 8,8
Aw 9,9
Aw 10,10
Aw 11,11
Aw 12,12
Aw 13,13
Aw 14,14
Aw 15,15
Ar 8,16
Ar 9,17
Ar 10,18
Ar 11,19
Ar 12,20
Ar 13,21
Ar 14,22
Ar 15,23
Vm 8,8,22
Vm 9,9,22
Vm 10,10,22
Vm 11,11,22
Vm 12,12,22
Vm 13,13,22
Vm 14,14,22
Vm 15,15,22
Aw 16,8
Aw 17,9
Aw 18,10
Aw 19,11
Aw 20,12
Aw 21,13
Aw 22,14
Aw 23,15
Ar 8,24
Ar 9,25
Ar 10,26
Ar 11,27
Ar 12,28
Ar 13,29
Ar 14,30
Ar 15,31
Vm 8,8,22
Vm 9,9,22
Vm 10,10,22
Vm 11,11,22
Vm 12,12,22
Vm 13,13,22
Vm 14,14,22
Vm 15,15,22
Aw 24,8
Aw 25,9
Aw 26,10
Aw 27,11
Aw 28,12
Aw 29,13
Aw 30,14
Aw 31,15
v_max3_f32 v21, v208, v209, v210
v_max3_f32 v21, v21, v211, v212
v_max3_f32 v21, v21, v213, v214
v_max3_f32 v21, v21, v215, v216
v_max3_f32 v21, v21, v217, v218
v_max3_f32 v21, v21, v219, v220
v_max3_f32 v21, v21, v221, v222
v_max_f32 v21, v21, v223
v_mov_b32 v1, v21
s_nop 1
v_permlane16_swap_b32 v1, v21
v_max_f32 v21, v21, v1
v_mov_b32 v1, v21
s_nop 1
v_permlane32_swap_b32 v1, v21
v_max_f32_e64 v21, v21, v1
v_add_f32 v21, 0x41f80000, v21
v_max_f32 v21, 0, v21
Vs 208,208,21
Vs 209,209,21
Vs 210,210,21
Vs 211,211,21
Vs 212,212,21
Vs 213,213,21
Vs 214,214,21
Vs 215,215,21
Vs 216,216,21
Vs 217,217,21
Vs 218,218,21
Vs 219,219,21
Vs 220,220,21
Vs 221,221,21
Vs 222,222,21
Vs 223,223,21
Vs 144,144,21
Vs 145,145,21
Vs 146,146,21
Vs 147,147,21
Vs 148,148,21
Vs 149,149,21
Vs 150,150,21
Vs 151,151,21
Vs 152,152,21
Vs 153,153,21
Vs 154,154,21
Vs 155,155,21
Vs 156,156,21
Vs 157,157,21
Vs 158,158,21
Vs 159,159,21
Vs 36,36,21
Vs 37,37,21
Vs 38,38,21
v_sub_f32_e64 v39, v39, v21
v_exp_f32 v22, -v21
s_nop 0
Vm 52,52,22
Vm 53,53,22
Vm 54,54,22
v_mul_f32_e64 v55, v55, v22
Ar 8,32
Ar 9,33
Ar 10,34
Ar 11,35
Ar 12,36
Ar 13,37
Ar 14,38
Ar 15,39
Vm 8,8,22
Vm 9,9,22
Vm 10,10,22
Vm 11,11,22
Vm 12,12,22
Vm 13,13,22
Vm 14,14,22
Vm 15,15,22
Aw 32,8
Aw 33,9
Aw 34,10
Aw 35,11
Aw 36,12
Aw 37,13
Aw 38,14
Aw 39,15
Ar 8,40
Ar 9,41
Ar 10,42
Ar 11,43
Ar 12,44
Ar 13,45
Ar 14,46
Ar 15,47
Vm 8,8,22
Vm 9,9,22
Vm 10,10,22
Vm 11,11,22
Vm 12,12,22
Vm 13,13,22
Vm 14,14,22
Vm 15,15,22
Aw 40,8
Aw 41,9
Aw 42,10
Aw 43,11
Aw 44,12
Aw 45,13
Aw 46,14
Aw 47,15
Ar 8,48
Ar 9,49
Ar 10,50
Ar 11,51
Ar 12,52
Ar 13,53
Ar 14,54
Ar 15,55
Vm 8,8,22
Vm 9,9,22
Vm 10,10,22
Vm 11,11,22
Vm 12,12,22
Vm 13,13,22
Vm 14,14,22
Vm 15,15,22
Aw 48,8
Aw 49,9
Aw 50,10
Aw 51,11
Aw 52,12
Aw 53,13
Aw 54,14
Aw 55,15
Ar 8,56
Ar 9,57
Ar 10,58
Ar 11,59
Ar 12,60
Ar 13,61
Ar 14,62
Ar 15,63
Vm 8,8,22
Vm 9,9,22
Vm 10,10,22
Vm 11,11,22
Vm 12,12,22
Vm 13,13,22
Vm 14,14,22
Vm 15,15,22
Aw 56,8
Aw 57,9
Aw 58,10
Aw 59,11
Aw 60,12
Aw 61,13
Aw 62,14
Aw 63,15
Ve 8,192
Ve 9,193
s_nop 0
Vc 96,8,9
Ve 8,194
Ve 9,195
s_nop 0
Vc 97,8,9
Ve 8,208
Ve 9,209
s_nop 0
Vc 104,8,9
Ve 8,210
Ve 9,211
s_nop 0
Vc 105,8,9
Ve 8,196
Ve 9,197
s_nop 0
Vc 98,8,9
Ve 8,198
Ve 9,199
s_nop 0
Vc 99,8,9
Ve 8,212
Ve 9,213
s_nop 0
Vc 106,8,9
Ve 8,214
Ve 9,215
s_nop 0
Vc 107,8,9
Ve 8,200
Ve 9,201
s_nop 0
Vc 100,8,9
Ve 8,202
Ve 9,203
s_nop 0
Vc 101,8,9
Ve 8,216
Ve 9,217
s_nop 0
Vc 108,8,9
Ve 8,218
Ve 9,219
s_nop 0
Vc 109,8,9
Ve 8,204
Ve 9,205
s_nop 0
Vc 102,8,9
Ve 8,206
Ve 9,207
s_nop 0
Vc 103,8,9
Ve 8,220
Ve 9,221
s_nop 0
Vc 110,8,9
Ve 8,222
Ve 9,223
s_nop 0
Vc 111,8,9
s_nop 1
s_branch L_k2_fbr_no
L_k2_fb_nl:
s_nop 7
s_nop 0
v_max3_f32 v21, v128, v129, v130
v_max3_f32 v21, v21, v131, v132
v_max3_f32 v21, v21, v133, v134
v_max3_f32 v21, v21, v135, v136
v_max3_f32 v21, v21, v137, v138
v_max3_f32 v21, v21, v139, v140
v_max3_f32 v21, v21, v141, v142
v_max_f32 v21, v21, v143
v_mov_b32 v1, v21
s_nop 1
v_permlane16_swap_b32 v1, v21
v_max_f32 v21, v21, v1
v_mov_b32 v1, v21
s_nop 1
v_permlane32_swap_b32 v1, v21
v_max_f32_e64 v21, v21, v1
v_add_f32 v21, 0x41f80000, v21
v_max_f32 v21, 0, v21
Vs 128,128,21
Vs 129,129,21
Vs 130,130,21
Vs 131,131,21
Vs 132,132,21
Vs 133,133,21
Vs 134,134,21
Vs 135,135,21
Vs 136,136,21
Vs 137,137,21
Vs 138,138,21
Vs 139,139,21
Vs 140,140,21
Vs 141,141,21
Vs 142,142,21
Vs 143,143,21
Vs 192,192,21
Vs 193,193,21
Vs 194,194,21
Vs 195,195,21
Vs 196,196,21
Vs 197,197,21
Vs 198,198,21
Vs 199,199,21
Vs 200,200,21
Vs 201,201,21
Vs 202,202,21
Vs 203,203,21
Vs 204,204,21
Vs 205,205,21
Vs 206,206,21
Vs 207,207,21
Vs 32,32,21
Vs 33,33,21
Vs 34,34,21
v_sub_f32_e64 v35, v35, v21
v_exp_f32 v22, -v21
s_nop 0
Vm 48,48,22
Vm 49,49,22
Vm 50,50,22
v_mul_f32_e64 v51, v51, v22
Ar 8,0
Ar 9,1
Ar 10,2
Ar 11,3
Ar 12,4
Ar 13,5
Ar 14,6
Ar 15,7
Vm 8,8,22
Vm 9,9,22
Vm 10,10,22
Vm 11,11,22
Vm 12,12,22
Vm 13,13,22
Vm 14,14,22
Vm 15,15,22
Aw 0,8
Aw 1,9
Aw 2,10
Aw 3,11
Aw 4,12
Aw 5,13
Aw 6,14
Aw 7,15
Ar 8,8
Ar 9,9
Ar 10,10
Ar 11,11
Ar 12,12
Ar 13,13
Ar 14,14
Ar 15,15
Vm 8,8,22
Vm 9,9,22
Vm 10,10,22
Vm 11,11,22
Vm 12,12,22
Vm 13,13,22
Vm 14,14,22
Vm 15,15,22
Aw 8,8
Aw 9,9
Aw 10,10
Aw 11,11
Aw 12,12
Aw 13,13
Aw 14,14
Aw 15,15
Ar 8,16
Ar 9,17
Ar 10,18
Ar 11,19
Ar 12,20
Ar 13,21
Ar 14,22
Ar 15,23
Vm 8,8,22
Vm 9,9,22
Vm 10,10,22
Vm 11,11,22
Vm 12,12,22
Vm 13,13,22
Vm 14,14,22
Vm 15,15,22
Aw 16,8
Aw 17,9
Aw 18,10
Aw 19,11
Aw 20,12
Aw 21,13
Aw 22,14
Aw 23,15
Ar 8,24
Ar 9,25
Ar 10,26
Ar 11,27
Ar 12,28
Ar 13,29
Ar 14,30
Ar 15,31
Vm 8,8,22
Vm 9,9,22
Vm 10,10,22
Vm 11,11,22
Vm 12,12,22
Vm 13,13,22
Vm 14,14,22
Vm 15,15,22
Aw 24,8
Aw 25,9
Aw 26,10
Aw 27,11
Aw 28,12
Aw 29,13
Aw 30,14
Aw 31,15
v_max3_f32 v21, v144, v145, v146
v_max3_f32 v21, v21, v147, v148
v_max3_f32 v21, v21, v149, v150
v_max3_f32 v21, v21, v151, v152
v_max3_f32 v21, v21, v153, v154
v_max3_f32 v21, v21, v155, v156
v_max3_f32 v21, v21, v157, v158
v_max_f32 v21, v21, v159
v_mov_b32 v1, v21
s_nop 1
v_permlane16_swap_b32 v1, v21
v_max_f32 v21, v21, v1
v_mov_b32 v1, v21
s_nop 1
v_permlane32_swap_b32 v1, v21
v_max_f32_e64 v21, v21, v1
v_add_f32 v21, 0x41f80000, v21
v_max_f32 v21, 0, v21
Vs 144,144,21
Vs 145,145,21
Vs 146,146,21
Vs 147,147,21
Vs 148,148,21
Vs 149,149,21
Vs 150,150,21
Vs 151,151,21
Vs 152,152,21
Vs 153,153,21
Vs 154,154,21
Vs 155,155,21
Vs 156,156,21
Vs 157,157,21
Vs 158,158,21
Vs 159,159,21
Vs 36,36,21
Vs 37,37,21
Vs 38,38,21
v_sub_f32_e64 v39, v39, v21
v_exp_f32 v22, -v21
s_nop 0
Vm 52,52,22
Vm 53,53,22
Vm 54,54,22
v_mul_f32_e64 v55, v55, v22
Ar 8,32
Ar 9,33
Ar 10,34
Ar 11,35
Ar 12,36
Ar 13,37
Ar 14,38
Ar 15,39
Vm 8,8,22
Vm 9,9,22
Vm 10,10,22
Vm 11,11,22
Vm 12,12,22
Vm 13,13,22
Vm 14,14,22
Vm 15,15,22
Aw 32,8
Aw 33,9
Aw 34,10
Aw 35,11
Aw 36,12
Aw 37,13
Aw 38,14
Aw 39,15
Ar 8,40
Ar 9,41
Ar 10,42
Ar 11,43
Ar 12,44
Ar 13,45
Ar 14,46
Ar 15,47
Vm 8,8,22
Vm 9,9,22
Vm 10,10,22
Vm 11,11,22
Vm 12,12,22
Vm 13,13,22
Vm 14,14,22
Vm 15,15,22
Aw 40,8
Aw 41,9
Aw 42,10
Aw 43,11
Aw 44,12
Aw 45,13
Aw 46,14
Aw 47,15
Ar 8,48
Ar 9,49
Ar 10,50
Ar 11,51
Ar 12,52
Ar 13,53
Ar 14,54
Ar 15,55
Vm 8,8,22
Vm 9,9,22
Vm 10,10,22
Vm 11,11,22
Vm 12,12,22
Vm 13,13,22
Vm 14,14,22
Vm 15,15,22
Aw 48,8
Aw 49,9
Aw 50,10
Aw 51,11
Aw 52,12
Aw 53,13
Aw 54,14
Aw 55,15
Ar 8,56
Ar 9,57
Ar 10,58
Ar 11,59
Ar 12,60
Ar 13,61
Ar 14,62
Ar 15,63
Vm 8,8,22
Vm 9,9,22
Vm 10,10,22
Vm 11,11,22
Vm 12,12,22
Vm 13,13,22
Vm 14,14,22
Vm 15,15,22
Aw 56,8
Aw 57,9
Aw 58,10
Aw 59,11
Aw 60,12
Aw 61,13
Aw 62,14
Aw 63,15
Ve 8,128
Ve 9,129
s_nop 0
Vc 64,8,9
Ve 8,130
Ve 9,131
s_nop 0
Vc 65,8,9
Ve 8,144
Ve 9,145
s_nop 0
Vc 72,8,9
Ve 8,146
Ve 9,147
s_nop 0
Vc 73,8,9
Ve 8,132
Ve 9,133
s_nop 0
Vc 66,8,9
Ve 8,134
Ve 9,135
s_nop 0
Vc 67,8,9
Ve 8,148
Ve 9,149
s_nop 0
Vc 74,8,9
Ve 8,150
Ve 9,151
s_nop 0
Vc 75,8,9
Ve 8,136
Ve 9,137
s_nop 0
Vc 68,8,9
Ve 8,138
Ve 9,139
s_nop 0
Vc 69,8,9
Ve 8,152
Ve 9,153
s_nop 0
Vc 76,8,9
Ve 8,154
Ve 9,155
s_nop 0
Vc 77,8,9
Ve 8,140
Ve 9,141
s_nop 0
Vc 70,8,9
Ve 8,142
Ve 9,143
s_nop 0
Vc 71,8,9
Ve 8,156
Ve 9,157
s_nop 0
Vc 78,8,9
Ve 8,158
Ve 9,159
s_nop 0
Vc 79,8,9
s_nop 1
s_branch L_k2_fbr_nl
L_k2_fb_fi:
s_nop 7
s_nop 0
v_max3_f32 v21, v192, v193, v194
v_max3_f32 v21, v21, v195, v196
v_max3_f32 v21, v21, v197, v198
v_max3_f32 v21, v21, v199, v200
v_max3_f32 v21, v21, v201, v202
v_max3_f32 v21, v21, v203, v204
v_max3_f32 v21, v21, v205, v206
v_max_f32 v21, v21, v207
v_mov_b32 v1, v21
s_nop 1
v_permlane16_swap_b32 v1, v21
v_max_f32 v21, v21, v1
v_mov_b32 v1, v21
s_nop 1
v_permlane32_swap_b32 v1, v21
v_max_f32_e64 v21, v21, v1
v_add_f32 v21, 0x41f80000, v21
v_max_f32 v21, 0, v21
Vs 192,192,21
Vs 193,193,21
Vs 194,194,21
Vs 195,195,21
Vs 196,196,21
Vs 197,197,21
Vs 198,198,21
Vs 199,199,21
Vs 200,200,21
Vs 201,201,21
Vs 202,202,21
Vs 203,203,21
Vs 204,204,21
Vs 205,205,21
Vs 206,206,21
Vs 207,207,21
Vs 32,32,21
Vs 33,33,21
Vs 34,34,21
v_sub_f32_e64 v35, v35, v21
v_exp_f32 v22, -v21
s_nop 0
Vm 48,48,22
Vm 49,49,22
Vm 50,50,22
v_mul_f32_e64 v51, v51, v22
Ar 8,0
Ar 9,1
Ar 10,2
Ar 11,3
Ar 12,4
Ar 13,5
Ar 14,6
Ar 15,7
Vm 8,8,22
Vm 9,9,22
Vm 10,10,22
Vm 11,11,22
Vm 12,12,22
Vm 13,13,22
Vm 14,14,22
Vm 15,15,22
Aw 0,8
Aw 1,9
Aw 2,10
Aw 3,11
Aw 4,12
Aw 5,13
Aw 6,14
Aw 7,15
Ar 8,8
Ar 9,9
Ar 10,10
Ar 11,11
Ar 12,12
Ar 13,13
Ar 14,14
Ar 15,15
Vm 8,8,22
Vm 9,9,22
Vm 10,10,22
Vm 11,11,22
Vm 12,12,22
Vm 13,13,22
Vm 14,14,22
Vm 15,15,22
Aw 8,8
Aw 9,9
Aw 10,10
Aw 11,11
Aw 12,12
Aw 13,13
Aw 14,14
Aw 15,15
Ar 8,16
Ar 9,17
Ar 10,18
Ar 11,19
Ar 12,20
Ar 13,21
Ar 14,22
Ar 15,23
Vm 8,8,22
Vm 9,9,22
Vm 10,10,22
Vm 11,11,22
Vm 12,12,22
Vm 13,13,22
Vm 14,14,22
Vm 15,15,22
Aw 16,8
Aw 17,9
Aw 18,10
Aw 19,11
Aw 20,12
Aw 21,13
Aw 22,14
Aw 23,15
Ar 8,24
Ar 9,25
Ar 10,26
Ar 11,27
Ar 12,28
Ar 13,29
Ar 14,30
Ar 15,31
Vm 8,8,22
Vm 9,9,22
Vm 10,10,22
Vm 11,11,22
Vm 12,12,22
Vm 13,13,22
Vm 14,14,22
Vm 15,15,22
Aw 24,8
Aw 25,9
Aw 26,10
Aw 27,11
Aw 28,12
Aw 29,13
Aw 30,14
Aw 31,15
Ve 8,192
Ve 9,193
s_nop 0
Vc 96,8,9
Ve 8,194
Ve 9,195
s_nop 0
Vc 97,8,9
Ve 8,196
Ve 9,197
s_nop 0
Vc 98,8,9
Ve 8,198
Ve 9,199
s_nop 0
Vc 99,8,9
Ve 8,200
Ve 9,201
s_nop 0
Vc 100,8,9
Ve 8,202
Ve 9,203
s_nop 0
Vc 101,8,9
Ve 8,204
Ve 9,205
s_nop 0
Vc 102,8,9
Ve 8,206
Ve 9,207
s_nop 0
Vc 103,8,9
s_nop 1
s_branch L_k2_fbr_fi
L_spinX:
s_mov_b32 s47, 0x400000
L_spinXl:
buffer_load_dword v17, v126, s[20:23], s24 offen sc1
s_sub_u32 s47, s47, 1
s_waitcnt vmcnt(0)
s_cmp_eq_u32 s47, 0
s_cbranch_scc1 L_spinXlx
v_cmp_ne_u32 vcc, 1, v17
s_cbranch_vccz L_spinXlx
s_sleep 1
s_branch L_spinXl
L_spinXlx:
buffer_load_dwordx4 v[160:163], v112, s[16:19], s25 offen offset:0 sc1
buffer_load_dwordx4 v[164:167], v112, s[16:19], s25 offen offset:1024 sc1
buffer_load_dwordx4 v[168:171], v112, s[16:19], s25 offen offset:2048 sc1
buffer_load_dwordx4 v[172:175], v112, s[16:19], s25 offen offset:3072 sc1
buffer_load_dwordx4 v[176:179], v10, s[16:19], s25 offen offset:0 sc1
buffer_load_dwordx4 v[180:183], v10, s[16:19], s25 offen offset:1024 sc1
buffer_load_dwordx4 v[184:187], v10, s[16:19], s25 offen offset:2048 sc1
buffer_load_dwordx4 v[188:191], v10, s[16:19], s25 offen offset:3072 sc1
s_branch L_spinXr
L_ysl:
s_mov_b32 s47, 0x400000
L_ysll:
buffer_load_dword v124, v127, s[20:23], s41 offen sc1
s_sub_u32 s47, s47, 1
s_waitcnt vmcnt(0)
s_cmp_eq_u32 s47, 0
s_cbranch_scc1 L_ysllx
v_cmp_ne_u32 vcc, 1, v124
s_cbranch_vccz L_ysllx
s_sleep 8
s_branch L_ysll
L_ysllx:
v_lshlrev_b32 v124, 2, v0
v_lshlrev_b32 v125, 1, v0
s_lshl_b32 s7, s45, 2
s_add_u32 s7, s7, s32
s_lshr_b32 s3, s42, 5
s_cmp_lg_u32 s3, s7
s_cbranch_scc1 L_f_yl13
s_add_u32 s3, s55, 0
s_nop 0
s_add_u32 s7, s3, 4096
buffer_load_dword v76, v124, s[20:23], s3 offen offset:0 sc1
buffer_load_dword v77, v124, s[20:23], s3 offen offset:512 sc1
buffer_load_dword v78, v124, s[20:23], s3 offen offset:1024 sc1
buffer_load_dword v79, v124, s[20:23], s3 offen offset:1536 sc1
buffer_load_dword v80, v124, s[20:23], s3 offen offset:2048 sc1
buffer_load_dword v81, v124, s[20:23], s3 offen offset:2560 sc1
buffer_load_dword v82, v124, s[20:23], s3 offen offset:3072 sc1
buffer_load_dword v83, v124, s[20:23], s3 offen offset:3584 sc1
buffer_load_dword v84, v124, s[20:23], s7 offen offset:0 sc1
buffer_load_dword v85, v124, s[20:23], s7 offen offset:512 sc1
buffer_load_dword v86, v124, s[20:23], s7 offen offset:1024 sc1
buffer_load_dword v87, v124, s[20:23], s7 offen offset:1536 sc1
buffer_load_dword v88, v124, s[20:23], s7 offen offset:2048 sc1
buffer_load_dword v89, v124, s[20:23], s7 offen offset:2560 sc1
s_lshl_b32 s3, s42, 11
s_lshl_b32 s7, s46, 7
s_add_u32 s3, s3, s7
buffer_load_ushort v90, v125, s[56:59], s3 offen
s_lshl_b32 s3, s42, 3
s_add_u32 s3, s3, 5259264
buffer_load_dwordx2 v[92:93], v126, s[20:23], s3 offen sc1
L_f_yl13:
s_lshl_b32 s7, s45, 2
s_add_u32 s7, s7, s32
s_lshr_b32 s3, s43, 5
s_cmp_lg_u32 s3, s7
s_cbranch_scc1 L_f_yl14
s_nop 0
s_add_u32 s3, s55, 256
s_add_u32 s7, s3, 4096
buffer_load_dword v94, v124, s[20:23], s3 offen offset:0 sc1
buffer_load_dword v95, v124, s[20:23], s3 offen offset:512 sc1
buffer_load_dword v96, v124, s[20:23], s3 offen offset:1024 sc1
buffer_load_dword v97, v124, s[20:23], s3 offen offset:1536 sc1
buffer_load_dword v98, v124, s[20:23], s3 offen offset:2048 sc1
buffer_load_dword v99, v124, s[20:23], s3 offen offset:2560 sc1
buffer_load_dword v100, v124, s[20:23], s3 offen offset:3072 sc1
buffer_load_dword v101, v124, s[20:23], s3 offen offset:3584 sc1
buffer_load_dword v102, v124, s[20:23], s7 offen offset:0 sc1
buffer_load_dword v103, v124, s[20:23], s7 offen offset:512 sc1
buffer_load_dword v104, v124, s[20:23], s7 offen offset:1024 sc1
buffer_load_dword v105, v124, s[20:23], s7 offen offset:1536 sc1
buffer_load_dword v106, v124, s[20:23], s7 offen offset:2048 sc1
buffer_load_dword v107, v124, s[20:23], s7 offen offset:2560 sc1
s_lshl_b32 s3, s43, 11
s_lshl_b32 s7, s46, 7
s_add_u32 s3, s3, s7
buffer_load_ushort v108, v125, s[56:59], s3 offen
s_lshl_b32 s3, s43, 3
s_add_u32 s3, s3, 5259264
buffer_load_dwordx2 v[110:111], v126, s[20:23], s3 offen sc1
L_f_yl14:
s_waitcnt vmcnt(0)
s_lshl_b32 s7, s45, 2
s_add_u32 s7, s7, s32
s_lshr_b32 s3, s42, 5
s_cmp_lg_u32 s3, s7
s_cbranch_scc1 L_f_ys15
v_pk_add_f32 v[76:77], v[76:77], v[78:79]
v_pk_add_f32 v[76:77], v[76:77], v[80:81]
v_pk_add_f32 v[76:77], v[76:77], v[82:83]
v_pk_add_f32 v[76:77], v[76:77], v[84:85]
v_pk_add_f32 v[76:77], v[76:77], v[86:87]
v_pk_add_f32 v[76:77], v[76:77], v[88:89]
Va 76,76,77
v_lshlrev_b32 v90, 16, v90
v_sub_f32_e64 v90, v90, v92
Vc 76,76,76
v_lshlrev_b32_e64 v76, 16, v76
Vc 90,90,90
v_lshlrev_b32 v90, 16, v90
v_mul_f32 v76, s100, v76
v_mul_f32_e64 v90, v90, v93
Vc 76,76,76
v_lshlrev_b32_e64 v76, 16, v76
Vc 90,90,90
v_lshlrev_b32 v90, 16, v90
Va 90,90,76
Vc 90,90,90
v_lshlrev_b32_e64 v90, 16, v90
v_mul_f32 v76, 0xbfb8aa3b, v90
Ve 76,76
s_nop 0
v_add_f32 v76, 1.0, v76
v_rcp_f32 v76, v76
s_nop 0
Vm 90,90,76
Vc 90,90,90
v_lshlrev_b32 v90, 16, v90
v_lshlrev_b32 v124, 2, v0
v_add_u32 v124, s35, v124
v_lshlrev_b32 v125, 5, v122
v_add_u32 v125, s35, v125
s_waitcnt lgkmcnt(0)
ds_write_b32 v124, v90
s_and_b32 s3, s42, 7
s_lshl_b32 s3, s3, 3
s_lshl_b64 s[4:5], 0xff, s3
s_bfe_u32 s3, s42, 0x20003
s_mov_b64 exec, s[4:5]
s_cmp_lg_u32 s3, 0
s_cbranch_scc1 L_f_yp16
ds_read_b64 v[42:43], v125
ds_read_b64 v[44:45], v125 offset:8
ds_read_b64 v[46:47], v125 offset:16
ds_read_b64 v[48:49], v125 offset:24
L_f_yp16:
s_cmp_lg_u32 s3, 1
s_cbranch_scc1 L_f_yp17
ds_read_b64 v[50:51], v125
ds_read_b64 v[52:53], v125 offset:8
ds_read_b64 v[54:55], v125 offset:16
ds_read_b64 v[56:57], v125 offset:24
L_f_yp17:
s_cmp_lg_u32 s3, 2
s_cbranch_scc1 L_f_yp18
ds_read_b64 v[58:59], v125
ds_read_b64 v[60:61], v125 offset:8
ds_read_b64 v[62:63], v125 offset:16
ds_read_b64 v[64:65], v125 offset:24
L_f_yp18:
s_cmp_lg_u32 s3, 3
s_cbranch_scc1 L_f_yp19
ds_read_b64 v[66:67], v125
ds_read_b64 v[68:69], v125 offset:8
s_waitcnt lgkmcnt(9)
ds_read_b64 v[70:71], v125 offset:16
ds_read_b64 v[72:73], v125 offset:24
L_f_yp19:
s_mov_b64 exec, -1
s_waitcnt lgkmcnt(0)
L_f_ys15:
s_lshl_b32 s7, s45, 2
s_add_u32 s7, s7, s32
s_lshr_b32 s3, s43, 5
s_cmp_lg_u32 s3, s7
s_cbranch_scc1 L_f_ys20
s_nop 0
v_pk_add_f32 v[94:95], v[94:95], v[96:97]
v_pk_add_f32 v[94:95], v[94:95], v[98:99]
v_pk_add_f32 v[94:95], v[94:95], v[100:101]
v_pk_add_f32 v[94:95], v[94:95], v[102:103]
v_pk_add_f32 v[94:95], v[94:95], v[104:105]
v_pk_add_f32 v[94:95], v[94:95], v[106:107]
Va 94,94,95
v_lshlrev_b32 v108, 16, v108
v_sub_f32_e64 v108, v108, v110
Vc 94,94,94
v_lshlrev_b32_e64 v94, 16, v94
Vc 108,108,108
v_lshlrev_b32 v108, 16, v108
v_mul_f32 v94, s101, v94
v_mul_f32_e64 v108, v108, v111
Vc 94,94,94
v_lshlrev_b32_e64 v94, 16, v94
Vc 108,108,108
v_lshlrev_b32 v108, 16, v108
Va 108,108,94
Vc 108,108,108
v_lshlrev_b32_e64 v108, 16, v108
v_mul_f32 v94, 0xbfb8aa3b, v108
Ve 94,94
s_nop 0
v_add_f32 v94, 1.0, v94
v_rcp_f32 v94, v94
s_nop 0
Vm 108,108,94
Vc 108,108,108
v_lshlrev_b32 v108, 16, v108
v_lshlrev_b32 v124, 2, v0
v_add_u32 v124, s35, v124
v_lshlrev_b32 v125, 5, v122
v_add_u32 v125, s35, v125
s_waitcnt lgkmcnt(0)
ds_write_b32 v124, v108
s_and_b32 s3, s43, 7
s_lshl_b32 s3, s3, 3
s_lshl_b64 s[4:5], 0xff, s3
s_bfe_u32 s3, s43, 0x20003
s_mov_b64 exec, s[4:5]
s_cmp_lg_u32 s3, 0
s_cbranch_scc1 L_f_yp21
ds_read_b64 v[42:43], v125
ds_read_b64 v[44:45], v125 offset:8
ds_read_b64 v[46:47], v125 offset:16
ds_read_b64 v[48:49], v125 offset:24
L_f_yp21:
s_cmp_lg_u32 s3, 1
s_cbranch_scc1 L_f_yp22
ds_read_b64 v[50:51], v125
ds_read_b64 v[52:53], v125 offset:8
ds_read_b64 v[54:55], v125 offset:16
ds_read_b64 v[56:57], v125 offset:24
L_f_yp22:
s_cmp_lg_u32 s3, 2
s_cbranch_scc1 L_f_yp23
ds_read_b64 v[58:59], v125
ds_read_b64 v[60:61], v125 offset:8
ds_read_b64 v[62:63], v125 offset:16
ds_read_b64 v[64:65], v125 offset:24
L_f_yp23:
s_cmp_lg_u32 s3, 3
s_cbranch_scc1 L_f_yp24
ds_read_b64 v[66:67], v125
ds_read_b64 v[68:69], v125 offset:8
s_waitcnt lgkmcnt(9)
ds_read_b64 v[70:71], v125 offset:16
ds_read_b64 v[72:73], v125 offset:24
L_f_yp24:
s_mov_b64 exec, -1
s_waitcnt lgkmcnt(0)
L_f_ys20:
s_branch L_yslr
.section .rodata,"a"
.p2align 6
.amdhsa_kernel recurrent_scan__compressed_kv_cla__moe_arch_mod__prompt_kernel
  .amdhsa_next_free_vgpr 512
  .amdhsa_next_free_sgpr 102
  .amdhsa_accum_offset 256
  .amdhsa_group_segment_fixed_size 0
  .amdhsa_kernarg_size 112
  .amdhsa_user_sgpr_count 2
  .amdhsa_user_sgpr_kernarg_segment_ptr 1
  .amdhsa_system_sgpr_workgroup_id_x 1
.end_amdhsa_kernel
```

```asm
; @launch grid=(256,1,1) block=(256,1,1) lds=163840
.amdgcn_target "amdgcn-amd-amdhsa--gfx950"
.macro Va d,x,y
v_add_f32 v\d, v\x, v\y
.endm
.macro Vc d,x,y
v_cvt_pk_bf16_f32 v\d, v\x, v\y
.endm
.macro Ra d,x,o
ds_read_b128 a[\d:\d+3], v\x offset:\o
.endm
.macro Ta d,x,o
ds_read_b64_tr_b16 a[\d:\d+1], v\x offset:\o
.endm
.macro Zvaa d,x,y
v_mfma_f32_16x16x32_bf16 v[\d:\d+3], a[\x:\x+3], a[\y:\y+3], 0
.endm
.macro Mvaa d,x,y
v_mfma_f32_16x16x32_bf16 v[\d:\d+3], a[\x:\x+3], a[\y:\y+3], v[\d:\d+3]
.endm
.macro Rv d,x,o
ds_read_b128 v[\d:\d+3], v\x offset:\o
.endm
.macro Zaaa d,x,y
v_mfma_f32_16x16x32_bf16 a[\d:\d+3], a[\x:\x+3], a[\y:\y+3], 0
.endm
.macro Maaa d,x,y
v_mfma_f32_16x16x32_bf16 a[\d:\d+3], a[\x:\x+3], a[\y:\y+3], a[\d:\d+3]
.endm
.macro Ar d,x
v_accvgpr_read_b32 v\d, a\x
.endm
.macro Ve d,x
v_exp_f32 v\d, v\x
.endm
.macro Aw d,x
v_accvgpr_write_b32 a\d, v\x
.endm
.macro Vs d,x,y
v_sub_f32 v\d, v\x, v\y
.endm
.macro Cvaa d,x,y,c
v_mfma_f32_16x16x32_bf16 v[\d:\d+3], a[\x:\x+3], a[\y:\y+3], v[\c:\c+3]
.endm
.macro VE d,x
v_exp_f32_e64 v\d, v\x
.endm
.macro Maav d,x,y
v_mfma_f32_16x16x32_bf16 a[\d:\d+3], a[\x:\x+3], v[\y:\y+3], a[\d:\d+3]
.endm
.macro Mvvv d,x,y
v_mfma_f32_16x16x32_bf16 v[\d:\d+3], v[\x:\x+3], v[\y:\y+3], v[\d:\d+3]
.endm
.macro Zvva d,x,y
v_mfma_f32_16x16x32_bf16 v[\d:\d+3], v[\x:\x+3], a[\y:\y+3], 0
.endm
.macro Mvva d,x,y
v_mfma_f32_16x16x32_bf16 v[\d:\d+3], v[\x:\x+3], a[\y:\y+3], v[\d:\d+3]
.endm
.macro Vm d,x,y
v_mul_f32 v\d, v\x, v\y
.endm
.macro Zvvv d,x,y
v_mfma_f32_16x16x32_bf16 v[\d:\d+3], v[\x:\x+3], v[\y:\y+3], 0
.endm
.text
.globl recurrent_scan__compressed_kv_cla__moe_arch_mod__prompt_kernel
.p2align 8
.type recurrent_scan__compressed_kv_cla__moe_arch_mod__prompt_kernel,@function
recurrent_scan__compressed_kv_cla__moe_arch_mod__prompt_kernel:
s_cmp_ge_u32 s2, 256
s_cbranch_scc1 L_k2_end
s_load_dwordx4 s[4:7], s[0:1], 0
s_load_dwordx2 s[44:45], s[0:1], 56
s_load_dwordx4 s[40:43], s[0:1], 24
s_load_dwordx4 s[64:67], s[0:1], 96
v_lshrrev_b32 v1, 6, v0
v_and_b32 v0, 63, v0
v_readfirstlane_b32 s32, v1
s_getpc_b64 s[68:69]
L_cpf1:
s_add_u32 s68, s68, (recurrent_scan__compressed_kv_cla__moe_arch_mod__prompt_kernel-L_cpf1)&0xffffffff
s_addc_u32 s69, s69, ((recurrent_scan__compressed_kv_cla__moe_arch_mod__prompt_kernel-L_cpf1)>>32)&0xffffffff
s_lshr_b32 s70, s2, 3
s_lshl_b32 s70, s70, 2
s_add_u32 s70, s70, s32
s_lshl_b32 s70, s70, 10
v_and_b32 v122, 7, v0
v_lshlrev_b32 v122, 7, v122
v_add_u32 v122, s70, v122
v_min_u32 v122, L_k2_fin-recurrent_scan__compressed_kv_cla__moe_arch_mod__prompt_kernel-4, v122
v_mov_b32 v121, s69
v_add_co_u32 v120, vcc, s68, v122
s_nop 1
v_addc_co_u32 v121, vcc, 0, v121, vcc
global_load_dword v124, v[120:121], off
v_lshrrev_b32 v33, 5, v0
v_and_b32 v31, 31, v0
v_lshlrev_b32_e64 v36, 4, v31
v_lshl_add_u32 v35, v33, 11, v36
s_lshl_b32 s36, s2, 14
s_lshl_b32 s37, s32, 12
s_add_u32 s36, s36, s37
s_mov_b32 s18, 4194304
s_mov_b32 s19, 0x20000
s_bfe_u32 s33, s2, 0x30003
s_lshr_b32 s35, s2, 7
s_bfe_u32 s3, s2, 0x10006
s_and_b32 s34, s2, 7
s_lshl_b32 s34, s34, 1
s_add_u32 s34, s34, s3
s_waitcnt lgkmcnt(0)
s_mov_b32 s16, s4
s_and_b32 s17, s5, 0xffff
buffer_load_dwordx4 v[48:51], v35, s[16:19], s36 offen offset:0
buffer_load_dwordx4 v[52:55], v35, s[16:19], s36 offen offset:512
buffer_load_dwordx4 v[56:59], v35, s[16:19], s36 offen offset:1024
buffer_load_dwordx4 v[60:63], v35, s[16:19], s36 offen offset:1536
s_cmp_eq_u32 s35, 0
s_cselect_b32 s40, s40, s42
s_cselect_b32 s41, s41, s43
s_lshl_b32 s3, s34, 9
s_add_u32 s12, s40, s3
s_addc_u32 s13, s41, 0
s_and_b32 s13, s13, 0xffff
s_mov_b32 s14, 0
s_mov_b32 s15, 0x20000
s_sub_u32 s14, 4194304, s3
s_lshl_b32 s3, s33, 18
s_add_u32 s8, s6, s3
s_addc_u32 s9, s7, 0
s_and_b32 s9, s9, 0xffff
s_mov_b32 s10, 262144
s_mov_b32 s11, 0x20000
s_and_b32 s58, s2, 7
s_mov_b32 s52, 0
s_mov_b32 s53, 15360
s_mov_b32 s54, 30720
s_mov_b32 s55, 46080
s_lshl_b32 s57, s32, 13
s_add_u32 s56, s57, 32768
s_lshl_b32 s3, s58, 2
s_add_u32 s3, s3, s32
s_lshl_b32 s3, s3, 4
v_add_u32 v30, s3, v33
v_lshlrev_b32 v30, 13, v30
v_lshlrev_b32 v34, 5, v33
v_xor_b32 v34, v34, v36
v_add_u32 v6, v34, v30
v_xor_b32_e64 v7, 64, v6
v_xor_b32 v8, 65664, v6
v_xor_b32 v9, 65728, v6
s_add_u32 m0, s57, 0
s_nop 0
buffer_load_dwordx4 v6, s[12:15], s52 offen offset:0 lds
buffer_load_dwordx4 v7, s[12:15], s53 offen offset:1024 lds
buffer_load_dwordx4 v6, s[12:15], s54 offen offset:2048 lds
buffer_load_dwordx4 v7, s[12:15], s55 offen offset:3072 lds
s_add_u32 m0, s57, 4096
s_nop 0
s_nop 0
buffer_load_dwordx4 v8, s[12:15], s52 offen offset:0 lds
buffer_load_dwordx4 v9, s[12:15], s53 offen offset:1024 lds
buffer_load_dwordx4 v8, s[12:15], s54 offen offset:2048 lds
buffer_load_dwordx4 v9, s[12:15], s55 offen offset:3072 lds
v_xor_b32 v6, 524288, v6
v_xor_b32 v7, 524288, v7
v_xor_b32 v8, 524288, v8
v_xor_b32 v9, 524288, v9
s_mov_b32 s48, 0
s_mov_b32 s49, 7168
s_mov_b32 s50, 14336
s_mov_b32 s51, 21504
v_lshrrev_b32 v30, 3, v0
v_lshlrev_b32 v30, 10, v30
s_lshl_b32 s3, s32, 16
s_lshl_b32 s39, s58, 7
s_add_u32 s3, s3, s39
v_and_b32 v31, 7, v0
v_lshrrev_b32 v32, 4, v0
v_xor_b32_e64 v31, v31, v32
v_lshl_add_u32 v30, v31, 4, v30
v_add_u32 v2, s3, v30
v_xor_b32 v3, 64, v2
v_xor_b32 v4, 32768, v2
v_xor_b32 v5, 32832, v2
s_cmp_lt_u32 s32, 2
s_cselect_b32 s60, s8, s12
s_cselect_b32 s61, s9, s13
s_cselect_b32 s62, s10, s14
s_mov_b32 s63, 0x20000
s_mov_b32 s59, 524288
s_cselect_b32 s59, 128, s59
s_cselect_b64 vcc, -1, 0
s_cselect_b32 s38, 32, 16
s_lshr_b32 s3, s2, 6
s_cmp_lt_u32 s32, 2
s_cselect_b32 s3, s3, s33
s_lshl_b32 s3, s3, 1
s_and_b32 s39, s32, 1
s_add_u32 s3, s3, s39
s_lshl_b32 s3, s3, 15
s_xor_b32 s39, s58, 2
s_mul_i32 s39, s39, s59
s_add_u32 s3, s3, s39
v_lshlrev_b32 v37, 10, v0
v_lshrrev_b32 v38, 2, v0
v_lshlrev_b32 v38, 13, v38
v_and_b32 v39, 3, v0
v_lshl_add_u32 v38, v39, 7, v38
v_cndmask_b32 v47, v38, v37, vcc
v_add_u32 v47, s3, v47
v_cmp_gt_u32 vcc, s38, v0
v_mov_b32 v37, 2146435072
s_nop 0
v_cndmask_b32 v47, v37, v47, vcc
s_mov_b32 s20, s66
s_and_b32 s21, s67, 0xffff
s_mov_b32 s22, 8388608
s_mov_b32 s23, 0x20000
s_add_u32 s24, s66, 8388608
s_addc_u32 s25, s67, 0
s_and_b32 s25, s25, 0xffff
s_mov_b32 s26, 35717120
s_mov_b32 s27, 0x20000
v_lshrrev_b32 v32, 4, v0
v_and_b32 v30, 15, v0
s_lshr_b32 s3, s32, 1
s_lshl_b32 s3, s3, 14
s_add_u32 s3, s3, 32768
v_lshlrev_b32 v31, 7, v30
v_add_u32 v31, s3, v31
v_lshrrev_b32 v34, 1, v30
v_xor_b32_e64 v34, v34, v32
v_lshl_add_u32 v10, v34, 4, v31
v_xor_b32 v11, 64, v10
v_lshrrev_b32 v30, 2, v30
v_lshl_add_u32 v31, v32, 3, v30
v_lshlrev_b32 v31, 9, v31
v_and_b32 v34, 3, v0
v_lshl_add_u32 v31, v34, 3, v31
s_and_b32 s3, s32, 1
s_lshl_b32 s3, s3, 8
v_add_u32 v31, s3, v31
v_and_b32 v34, 1, v32
v_lshl_add_u32 v30, v34, 2, v30
v_lshl_add_u32 v16, v30, 5, v31
v_xor_b32 v17, 32, v16
v_xor_b32 v18, 64, v16
v_xor_b32 v19, 96, v16
v_xor_b32 v20, 128, v16
v_xor_b32 v21, 160, v16
v_xor_b32 v22, 192, v16
v_xor_b32 v23, 224, v16
v_add_u32 v12, 65536, v10
v_add_u32 v13, 65536, v11
v_add_u32 v14, 65536, v16
v_add_u32 v15, 65536, v17
v_add_u32 v24, 65536, v18
v_add_u32 v25, 65536, v19
v_add_u32 v26, 65536, v20
v_add_u32 v27, 65536, v21
v_add_u32 v28, 65536, v22
v_add_u32 v29, 65536, v23
s_mov_b32 s28, s44
s_nop 0
s_and_b32 s29, s45, 0xffff
s_mov_b32 s30, 2048
s_mov_b32 s31, 0x20000
buffer_load_dwordx4 v[64:67], v36, s[28:31], 0 offen offset:0
buffer_load_dwordx4 v[68:71], v36, s[28:31], 0 offen offset:512
buffer_load_dwordx4 v[72:75], v36, s[28:31], 0 offen offset:1024
buffer_load_dwordx4 v[76:79], v36, s[28:31], 0 offen offset:1536
s_waitcnt vmcnt(12)
v_lshlrev_b32 v80, 16, v48
v_and_b32 v81, 0xffff0000, v48
v_lshlrev_b32_e64 v82, 16, v49
v_and_b32 v83, 0xffff0000, v49
v_lshlrev_b32_e64 v84, 16, v50
v_and_b32 v85, 0xffff0000, v50
v_lshlrev_b32_e64 v86, 16, v51
v_and_b32 v87, 0xffff0000, v51
v_lshlrev_b32_e64 v88, 16, v52
v_and_b32 v89, 0xffff0000, v52
v_lshlrev_b32_e64 v90, 16, v53
v_and_b32 v91, 0xffff0000, v53
v_lshlrev_b32_e64 v92, 16, v54
v_and_b32 v93, 0xffff0000, v54
v_lshlrev_b32_e64 v94, 16, v55
v_and_b32 v95, 0xffff0000, v55
v_lshlrev_b32_e64 v96, 16, v56
v_and_b32 v97, 0xffff0000, v56
v_lshlrev_b32_e64 v98, 16, v57
v_and_b32 v99, 0xffff0000, v57
v_lshlrev_b32_e64 v100, 16, v58
v_and_b32 v101, 0xffff0000, v58
v_lshlrev_b32_e64 v102, 16, v59
v_and_b32 v103, 0xffff0000, v59
v_lshlrev_b32_e64 v104, 16, v60
v_and_b32 v105, 0xffff0000, v60
v_lshlrev_b32_e64 v106, 16, v61
v_and_b32 v107, 0xffff0000, v61
v_lshlrev_b32_e64 v108, 16, v62
v_and_b32 v109, 0xffff0000, v62
v_lshlrev_b32_e64 v110, 16, v63
v_and_b32 v111, 0xffff0000, v63
v_pk_add_f32 v[40:41], v[80:81], v[82:83]
v_pk_add_f32 v[42:43], v[84:85], v[86:87]
v_pk_add_f32 v[40:41], v[40:41], v[88:89]
v_pk_add_f32 v[42:43], v[42:43], v[90:91]
v_pk_add_f32 v[40:41], v[40:41], v[92:93]
v_pk_add_f32 v[42:43], v[42:43], v[94:95]
v_pk_add_f32 v[40:41], v[40:41], v[96:97]
v_pk_add_f32 v[42:43], v[42:43], v[98:99]
v_pk_add_f32 v[40:41], v[40:41], v[100:101]
v_pk_add_f32 v[42:43], v[42:43], v[102:103]
v_pk_add_f32 v[40:41], v[40:41], v[104:105]
v_pk_add_f32 v[42:43], v[42:43], v[106:107]
v_pk_add_f32 v[40:41], v[40:41], v[108:109]
v_pk_add_f32 v[42:43], v[42:43], v[110:111]
v_pk_add_f32 v[40:41], v[40:41], v[42:43]
Va 38,40,41
s_nop 1
v_add_f32_dpp v38, v38, v38 quad_perm:[1,0,3,2] row_mask:0xf bank_mask:0xf
s_nop 1
v_add_f32_dpp v38, v38, v38 quad_perm:[2,3,0,1] row_mask:0xf bank_mask:0xf
s_nop 1
v_add_f32_dpp v38, v38, v38 row_half_mirror row_mask:0xf bank_mask:0xf
s_nop 1
v_add_f32_dpp v38, v38, v38 row_mirror row_mask:0xf bank_mask:0xf
v_mov_b32 v37, v38
s_nop 1
v_permlane16_swap_b32 v37, v38
Va 38,38,37
s_add_u32 m0, s56, 0
s_nop 0
buffer_load_dwordx4 v2, s[8:11], s48 offen offset:0 lds
buffer_load_dwordx4 v3, s[8:11], s49 offen offset:1024 lds
buffer_load_dwordx4 v2, s[8:11], s50 offen offset:2048 lds
buffer_load_dwordx4 v3, s[8:11], s51 offen offset:3072 lds
s_add_u32 m0, s56, 4096
s_nop 0
buffer_load_dwordx4 v4, s[8:11], s48 offen offset:0 lds
buffer_load_dwordx4 v5, s[8:11], s49 offen offset:1024 lds
buffer_load_dwordx4 v4, s[8:11], s50 offen offset:2048 lds
buffer_load_dwordx4 v5, s[8:11], s51 offen offset:3072 lds
v_xor_b32 v2, 128, v2
v_xor_b32 v3, 128, v3
v_xor_b32 v4, 128, v4
v_xor_b32 v5, 128, v5
v_mul_f32 v38, 0xba800000, v38
v_mov_b32_e64 v39, v38
v_pk_add_f32 v[112:113], v[80:81], v[38:39]
v_pk_mul_f32 v[40:41], v[112:113], v[112:113]
v_pk_add_f32 v[114:115], v[82:83], v[38:39]
v_pk_mul_f32 v[42:43], v[114:115], v[114:115]
v_pk_add_f32 v[116:117], v[84:85], v[38:39]
v_pk_fma_f32 v[40:41], v[116:117], v[116:117], v[40:41]
v_pk_add_f32 v[118:119], v[86:87], v[38:39]
v_pk_fma_f32 v[42:43], v[118:119], v[118:119], v[42:43]
v_pk_add_f32 v[112:113], v[88:89], v[38:39]
v_pk_fma_f32 v[40:41], v[112:113], v[112:113], v[40:41]
v_pk_add_f32 v[114:115], v[90:91], v[38:39]
v_pk_fma_f32 v[42:43], v[114:115], v[114:115], v[42:43]
v_pk_add_f32 v[116:117], v[92:93], v[38:39]
v_pk_fma_f32 v[40:41], v[116:117], v[116:117], v[40:41]
v_pk_add_f32 v[118:119], v[94:95], v[38:39]
v_pk_fma_f32 v[42:43], v[118:119], v[118:119], v[42:43]
v_pk_add_f32 v[112:113], v[96:97], v[38:39]
v_pk_fma_f32 v[40:41], v[112:113], v[112:113], v[40:41]
v_pk_add_f32 v[114:115], v[98:99], v[38:39]
v_pk_fma_f32 v[42:43], v[114:115], v[114:115], v[42:43]
v_pk_add_f32 v[116:117], v[100:101], v[38:39]
v_pk_fma_f32 v[40:41], v[116:117], v[116:117], v[40:41]
v_pk_add_f32 v[118:119], v[102:103], v[38:39]
v_pk_fma_f32 v[42:43], v[118:119], v[118:119], v[42:43]
v_pk_add_f32 v[112:113], v[104:105], v[38:39]
v_pk_fma_f32 v[40:41], v[112:113], v[112:113], v[40:41]
v_pk_add_f32 v[114:115], v[106:107], v[38:39]
v_pk_fma_f32 v[42:43], v[114:115], v[114:115], v[42:43]
v_pk_add_f32 v[116:117], v[108:109], v[38:39]
v_pk_fma_f32 v[40:41], v[116:117], v[116:117], v[40:41]
v_pk_add_f32 v[118:119], v[110:111], v[38:39]
v_pk_fma_f32 v[42:43], v[118:119], v[118:119], v[42:43]
v_pk_add_f32 v[40:41], v[40:41], v[42:43]
Va 40,40,41
s_nop 1
v_add_f32_dpp v40, v40, v40 quad_perm:[1,0,3,2] row_mask:0xf bank_mask:0xf
s_nop 1
v_add_f32_dpp v40, v40, v40 quad_perm:[2,3,0,1] row_mask:0xf bank_mask:0xf
s_nop 1
v_add_f32_dpp v40, v40, v40 row_half_mirror row_mask:0xf bank_mask:0xf
s_nop 1
v_add_f32_dpp v40, v40, v40 row_mirror row_mask:0xf bank_mask:0xf
v_mov_b32 v37, v40
s_nop 1
v_permlane16_swap_b32 v37, v40
v_add_f32_e64 v40, v40, v37
v_mul_f32 v40, 0x3a800000, v40
Vc 44,38,40
v_lshlrev_b32_e64 v38, 16, v44
v_and_b32 v40, 0xffff0000, v44
v_add_f32 v40, 0x3727c5ac, v40
Vc 44,40,40
v_lshlrev_b32 v40, 16, v44
v_sqrt_f32 v40, v40
v_mov_b32_e64 v39, v38
Vc 44,40,40
v_lshlrev_b32 v44, 16, v44
v_rcp_f32 v40, v44
v_pk_add_f32 v[80:81], v[80:81], v[38:39]
v_pk_add_f32 v[82:83], v[82:83], v[38:39]
v_pk_add_f32 v[84:85], v[84:85], v[38:39]
v_pk_add_f32 v[86:87], v[86:87], v[38:39]
v_pk_add_f32 v[88:89], v[88:89], v[38:39]
v_pk_add_f32 v[90:91], v[90:91], v[38:39]
v_pk_add_f32 v[92:93], v[92:93], v[38:39]
v_pk_add_f32 v[94:95], v[94:95], v[38:39]
v_pk_add_f32 v[96:97], v[96:97], v[38:39]
v_pk_add_f32 v[98:99], v[98:99], v[38:39]
v_pk_add_f32 v[100:101], v[100:101], v[38:39]
v_pk_add_f32 v[102:103], v[102:103], v[38:39]
v_pk_add_f32 v[104:105], v[104:105], v[38:39]
v_pk_add_f32 v[106:107], v[106:107], v[38:39]
v_pk_add_f32 v[108:109], v[108:109], v[38:39]
v_pk_add_f32 v[110:111], v[110:111], v[38:39]
v_fma_f32 v45, -v44, v40, 1.0
v_fma_f32 v40, v45, v40, v40
v_mov_b32_e64 v41, v40
Vc 48,80,81
Vc 49,82,83
Vc 50,84,85
Vc 51,86,87
Vc 52,88,89
Vc 53,90,91
Vc 54,92,93
Vc 55,94,95
Vc 56,96,97
Vc 57,98,99
Vc 58,100,101
Vc 59,102,103
Vc 60,104,105
Vc 61,106,107
Vc 62,108,109
Vc 63,110,111
v_lshlrev_b32_e64 v80, 16, v48
v_and_b32 v81, 0xffff0000, v48
v_lshlrev_b32_e64 v82, 16, v49
v_and_b32 v83, 0xffff0000, v49
v_lshlrev_b32_e64 v84, 16, v50
v_and_b32 v85, 0xffff0000, v50
v_lshlrev_b32_e64 v86, 16, v51
v_and_b32 v87, 0xffff0000, v51
v_lshlrev_b32_e64 v88, 16, v52
v_and_b32 v89, 0xffff0000, v52
v_lshlrev_b32_e64 v90, 16, v53
v_and_b32 v91, 0xffff0000, v53
v_lshlrev_b32_e64 v92, 16, v54
v_and_b32 v93, 0xffff0000, v54
v_lshlrev_b32_e64 v94, 16, v55
v_and_b32 v95, 0xffff0000, v55
v_lshlrev_b32_e64 v96, 16, v56
v_and_b32 v97, 0xffff0000, v56
v_lshlrev_b32_e64 v98, 16, v57
v_and_b32 v99, 0xffff0000, v57
v_lshlrev_b32_e64 v100, 16, v58
v_and_b32 v101, 0xffff0000, v58
v_lshlrev_b32_e64 v102, 16, v59
v_and_b32 v103, 0xffff0000, v59
v_lshlrev_b32_e64 v104, 16, v60
v_and_b32 v105, 0xffff0000, v60
v_lshlrev_b32_e64 v106, 16, v61
v_and_b32 v107, 0xffff0000, v61
v_lshlrev_b32_e64 v108, 16, v62
v_and_b32 v109, 0xffff0000, v62
v_lshlrev_b32_e64 v110, 16, v63
v_and_b32 v111, 0xffff0000, v63
v_pk_mul_f32 v[80:81], v[80:81], v[40:41]
v_pk_mul_f32 v[82:83], v[82:83], v[40:41]
v_pk_mul_f32 v[84:85], v[84:85], v[40:41]
v_pk_mul_f32 v[86:87], v[86:87], v[40:41]
v_pk_mul_f32 v[88:89], v[88:89], v[40:41]
v_pk_mul_f32 v[90:91], v[90:91], v[40:41]
v_pk_mul_f32 v[92:93], v[92:93], v[40:41]
v_pk_mul_f32 v[94:95], v[94:95], v[40:41]
v_pk_mul_f32 v[96:97], v[96:97], v[40:41]
v_pk_mul_f32 v[98:99], v[98:99], v[40:41]
v_pk_mul_f32 v[100:101], v[100:101], v[40:41]
v_pk_mul_f32 v[102:103], v[102:103], v[40:41]
v_pk_mul_f32 v[104:105], v[104:105], v[40:41]
v_pk_mul_f32 v[106:107], v[106:107], v[40:41]
v_pk_mul_f32 v[108:109], v[108:109], v[40:41]
v_pk_mul_f32 v[110:111], v[110:111], v[40:41]
Vc 48,80,81
Vc 49,82,83
Vc 50,84,85
Vc 51,86,87
Vc 52,88,89
Vc 53,90,91
Vc 54,92,93
Vc 55,94,95
Vc 56,96,97
Vc 57,98,99
Vc 58,100,101
Vc 59,102,103
Vc 60,104,105
Vc 61,106,107
Vc 62,108,109
Vc 63,110,111
s_mul_i32 s3, s32, 4128
s_add_u32 s3, s3, 131072
v_mul_u32_u24 v42, 2064, v33
v_add3_u32 v42, v42, v36, s3
ds_write_b128 v42, v[48:51] offset:0
ds_write_b128 v42, v[52:55] offset:512
ds_write_b128 v42, v[56:59] offset:1024
ds_write_b128 v42, v[60:63] offset:1536
s_waitcnt vmcnt(8)
v_lshlrev_b32 v80, 16, v48
v_and_b32 v81, 0xffff0000, v48
v_lshlrev_b32_e64 v112, 16, v64
v_and_b32 v113, 0xffff0000, v64
v_pk_mul_f32 v[42:43], v[80:81], v[112:113]
v_lshlrev_b32_e64 v82, 16, v49
v_and_b32 v83, 0xffff0000, v49
v_lshlrev_b32_e64 v114, 16, v65
v_and_b32 v115, 0xffff0000, v65
v_pk_mul_f32 v[44:45], v[82:83], v[114:115]
v_lshlrev_b32_e64 v84, 16, v50
v_and_b32 v85, 0xffff0000, v50
v_lshlrev_b32_e64 v116, 16, v66
v_and_b32 v117, 0xffff0000, v66
v_pk_fma_f32 v[42:43], v[84:85], v[116:117], v[42:43]
v_lshlrev_b32_e64 v86, 16, v51
v_and_b32 v87, 0xffff0000, v51
v_lshlrev_b32_e64 v118, 16, v67
v_and_b32 v119, 0xffff0000, v67
v_pk_fma_f32 v[44:45], v[86:87], v[118:119], v[44:45]
v_lshlrev_b32_e64 v88, 16, v52
v_and_b32 v89, 0xffff0000, v52
v_lshlrev_b32_e64 v112, 16, v68
v_and_b32 v113, 0xffff0000, v68
v_pk_fma_f32 v[42:43], v[88:89], v[112:113], v[42:43]
v_lshlrev_b32_e64 v90, 16, v53
v_and_b32 v91, 0xffff0000, v53
v_lshlrev_b32_e64 v114, 16, v69
v_and_b32 v115, 0xffff0000, v69
v_pk_fma_f32 v[44:45], v[90:91], v[114:115], v[44:45]
v_lshlrev_b32_e64 v92, 16, v54
v_and_b32 v93, 0xffff0000, v54
v_lshlrev_b32_e64 v116, 16, v70
v_and_b32 v117, 0xffff0000, v70
v_pk_fma_f32 v[42:43], v[92:93], v[116:117], v[42:43]
v_lshlrev_b32_e64 v94, 16, v55
v_and_b32 v95, 0xffff0000, v55
v_lshlrev_b32_e64 v118, 16, v71
v_and_b32 v119, 0xffff0000, v71
v_pk_fma_f32 v[44:45], v[94:95], v[118:119], v[44:45]
v_lshlrev_b32_e64 v96, 16, v56
v_and_b32 v97, 0xffff0000, v56
v_lshlrev_b32_e64 v112, 16, v72
v_and_b32 v113, 0xffff0000, v72
v_pk_fma_f32 v[42:43], v[96:97], v[112:113], v[42:43]
v_lshlrev_b32_e64 v98, 16, v57
v_and_b32 v99, 0xffff0000, v57
v_lshlrev_b32_e64 v114, 16, v73
v_and_b32 v115, 0xffff0000, v73
v_pk_fma_f32 v[44:45], v[98:99], v[114:115], v[44:45]
v_lshlrev_b32_e64 v100, 16, v58
v_and_b32 v101, 0xffff0000, v58
v_lshlrev_b32_e64 v116, 16, v74
v_and_b32 v117, 0xffff0000, v74
v_pk_fma_f32 v[42:43], v[100:101], v[116:117], v[42:43]
v_lshlrev_b32_e64 v102, 16, v59
v_and_b32 v103, 0xffff0000, v59
v_lshlrev_b32_e64 v118, 16, v75
v_and_b32 v119, 0xffff0000, v75
v_pk_fma_f32 v[44:45], v[102:103], v[118:119], v[44:45]
v_lshlrev_b32_e64 v104, 16, v60
v_and_b32 v105, 0xffff0000, v60
v_lshlrev_b32_e64 v112, 16, v76
v_and_b32 v113, 0xffff0000, v76
v_pk_fma_f32 v[42:43], v[104:105], v[112:113], v[42:43]
v_lshlrev_b32_e64 v106, 16, v61
v_and_b32 v107, 0xffff0000, v61
v_lshlrev_b32_e64 v114, 16, v77
v_and_b32 v115, 0xffff0000, v77
v_pk_fma_f32 v[44:45], v[106:107], v[114:115], v[44:45]
v_lshlrev_b32_e64 v108, 16, v62
v_and_b32 v109, 0xffff0000, v62
v_lshlrev_b32_e64 v116, 16, v78
v_and_b32 v117, 0xffff0000, v78
v_pk_fma_f32 v[42:43], v[108:109], v[116:117], v[42:43]
v_lshlrev_b32_e64 v110, 16, v63
v_and_b32 v111, 0xffff0000, v63
v_lshlrev_b32_e64 v118, 16, v79
v_and_b32 v119, 0xffff0000, v79
v_pk_fma_f32 v[44:45], v[110:111], v[118:119], v[44:45]
v_pk_add_f32 v[42:43], v[42:43], v[44:45]
Va 45,42,43
s_nop 1
v_add_f32_dpp v45, v45, v45 quad_perm:[1,0,3,2] row_mask:0xf bank_mask:0xf
s_nop 1
v_add_f32_dpp v45, v45, v45 quad_perm:[2,3,0,1] row_mask:0xf bank_mask:0xf
s_nop 1
v_add_f32_dpp v45, v45, v45 row_half_mirror row_mask:0xf bank_mask:0xf
s_nop 1
v_add_f32_dpp v45, v45, v45 row_mirror row_mask:0xf bank_mask:0xf
v_mov_b32 v37, v45
s_nop 1
v_permlane16_swap_b32 v37, v45
v_add_f32_e64 v45, v45, v37
Vc 45,45,45
v_ashrrev_i32_e64 v46, 31, v45
v_or_b32 v46, 0x80000000, v46
v_xor_b32_e64 v45, v45, v46
v_and_b32 v45, 0xffff0000, v45
s_lshr_b32 s3, s36, 11
v_add_u32 v46, s3, v33
v_sub_u32 v44, 0xffff, v46
v_or_b32 v45, v45, v44
v_lshlrev_b32 v44, 2, v46
v_lshlrev_b32_e64 v46, 3, v46
v_xor_b32 v38, 0x80000000, v38
v_mov_b32_e64 v39, v40
s_mov_b32 s3, 5242880
s_mov_b32 s39, 5259264
s_mov_b32 exec_lo, 1
s_mov_b32 exec_hi, 1
buffer_store_dword v45, v44, s[20:23], s3 offen sc1
buffer_store_dwordx2 v[38:39], v46, s[20:23], s39 offen sc1
s_mov_b64 exec, -1
s_load_dwordx2 s[4:5], s[0:1], 16
s_load_dwordx4 s[40:43], s[0:1], 64
s_load_dwordx2 s[92:93], s[0:1], 40
s_load_dwordx2 s[94:95], s[0:1], 80
s_load_dwordx2 s[100:101], s[0:1], 0
s_mov_b32 s28, s64
s_and_b32 s29, s65, 0xffff
s_mov_b32 s30, 256
s_mov_b32 s31, 0x20000
s_waitcnt vmcnt(2)
s_waitcnt lgkmcnt(0)
s_barrier
s_nop 0
Ra 224,10,0
Ra 228,11,0
Ra 232,10,2048
Ra 236,11,2048
Ta 0,16,0
Ta 2,16,2048
Ta 4,16,16384
Ta 6,16,18432
Ta 8,17,0
Ta 10,17,2048
Ta 12,17,16384
Ta 14,17,18432
Ta 16,18,0
Ta 18,18,2048
Ta 20,18,16384
s_waitcnt lgkmcnt(9)
s_nop 0
Ta 22,18,18432
Ta 24,19,0
Ta 26,19,2048
Ta 28,19,16384
Ta 30,19,18432
Ta 32,20,0
s_waitcnt lgkmcnt(9)
s_nop 0
Ta 34,20,2048
Ta 36,20,16384
Ta 38,20,18432
Ta 40,21,0
Ta 42,21,2048
Ta 44,21,16384
s_waitcnt lgkmcnt(9)
s_nop 0
Ta 46,21,18432
Ta 48,22,0
Ta 50,22,2048
Ta 52,22,16384
Ta 54,22,18432
Ta 56,23,0
s_waitcnt lgkmcnt(9)
Ta 58,23,2048
Ta 60,23,16384
Ta 62,23,18432
s_cmp_lg_u32 s35, 0
s_cbranch_scc1 L_k1_vpath
Zvaa 48,0,224
v_and_b32 v46, 7, v0
v_mul_u32_u24 v30, 2064, v46
Mvaa 48,4,228
s_add_u32 m0, s57, 65536
Zvaa 52,8,224
buffer_load_dwordx4 v6, s[12:15], s52 offen offset:0 lds
Mvaa 52,12,228
Ra 240,10,4096
Zvaa 56,16,224
buffer_load_dwordx4 v7, s[12:15], s53 offen offset:1024 lds
Mvaa 56,20,228
v_lshrrev_b32_e64 v31, 3, v0
Zvaa 60,24,224
buffer_load_dwordx4 v6, s[12:15], s54 offen offset:2048 lds
Mvaa 60,28,228
Ra 244,11,4096
Zvaa 64,32,224
buffer_load_dwordx4 v7, s[12:15], s55 offen offset:3072 lds
Mvaa 64,36,228
s_add_u32 m0, s57, 69632
s_waitcnt lgkmcnt(10)
Zvaa 68,40,224
buffer_load_dwordx4 v8, s[12:15], s52 offen offset:0 lds
Mvaa 68,44,228
Ra 248,10,6144
s_waitcnt lgkmcnt(7)
Zvaa 72,48,224
buffer_load_dwordx4 v9, s[12:15], s53 offen offset:1024 lds
Mvaa 72,52,228
s_lshl_b32 s3, s32, 9
s_add_u32 s3, s3, 131072
v_lshl_add_u32 v30, v31, 4, v30
s_waitcnt lgkmcnt(3)
Zvaa 76,56,224
buffer_load_dwordx4 v8, s[12:15], s54 offen offset:2048 lds
Mvaa 76,60,228
Ra 252,11,6144
Zvaa 80,0,232
buffer_load_dwordx4 v9, s[12:15], s55 offen offset:3072 lds
Mvaa 80,4,236
s_add_u32 m0, s56, 65536
v_xor_b32 v6, 1572864, v6
v_xor_b32 v7, 1572864, v7
Zvaa 84,8,232
buffer_load_dwordx4 v2, s[8:11], s48 offen offset:0 lds
Mvaa 84,12,236
v_xor_b32 v8, 1572864, v8
v_xor_b32 v9, 1572864, v9
Zvaa 88,16,232
buffer_load_dwordx4 v3, s[8:11], s49 offen offset:1024 lds
Mvaa 88,20,236
v_add_u32 v30, s3, v30
v_lshlrev_b32 v31, 8, v31
Zvaa 92,24,232
buffer_load_dwordx4 v2, s[8:11], s50 offen offset:2048 lds
Mvaa 92,28,236
v_lshl_add_u32 v46, v46, 4, v31
Zvaa 96,32,232
buffer_load_dwordx4 v3, s[8:11], s51 offen offset:3072 lds
Mvaa 96,36,236
s_add_u32 m0, s56, 69632
Zvaa 100,40,232
buffer_load_dwordx4 v4, s[8:11], s48 offen offset:0 lds
Mvaa 100,44,236
Rv 34,30,128
Rv 38,30,256
Zvaa 104,48,232
buffer_load_dwordx4 v5, s[8:11], s49 offen offset:1024 lds
Mvaa 104,52,236
Rv 42,30,384
Rv 30,30,0
Zvaa 108,56,232
s_waitcnt lgkmcnt(4)
buffer_load_dwordx4 v4, s[8:11], s50 offen offset:2048 lds
Mvaa 108,60,236
s_lshr_b32 s3, s2, 1
s_mul_i32 s3, s3, 33792
s_add_u32 s3, s3, s57
Zvaa 112,0,240
buffer_load_dwordx4 v5, s[8:11], s51 offen offset:3072 lds
Mvaa 112,4,244
v_xor_b32 v2, 384, v2
v_xor_b32 v3, 384, v3
Zvaa 116,8,240
s_and_b32 s39, s2, 1
s_lshl_b32 s39, s39, 7
s_add_u32 s3, s3, s39
Mvaa 116,12,244
Ra 224,10,8192
v_xor_b32 v4, 384, v4
Zvaa 120,16,240
s_add_u32 s39, s3, 4096
Mvaa 120,20,244
v_xor_b32 v5, 384, v5
Zvaa 124,24,240
Mvaa 124,28,244
Ra 228,11,8192
Zvaa 128,32,240
Mvaa 128,36,244
Zvaa 132,40,240
Mvaa 132,44,244
Ra 232,10,10240
Zvaa 136,48,240
buffer_load_dword v1, v47, s[60:63], 0 offen
Mvaa 136,52,244
s_mul_i32 vcc_lo, s59, 1
v_xor_b32 v47, vcc_lo, v47
Zvaa 140,56,240
Mvaa 140,60,244
Ra 236,11,10240
Zvaa 144,0,248
Mvaa 144,4,252
Zvaa 148,8,248
Mvaa 148,12,252
Zvaa 152,16,248
Mvaa 152,20,252
Zvaa 156,24,248
Mvaa 156,28,252
Zvaa 160,32,248
Mvaa 160,36,252
Zvaa 164,40,248
Mvaa 164,44,252
Zvaa 168,48,248
Mvaa 168,52,252
s_waitcnt vmcnt(9)
Zvaa 172,56,248
s_waitcnt lgkmcnt(0)
s_barrier
Mvaa 172,60,252
s_add_u32 m0, s57, 0
Zvaa 176,0,224
buffer_load_dwordx4 v6, s[12:15], s52 offen offset:0 lds
Mvaa 176,4,228
Ta 64,14,0
Ta 66,14,2048
Zvaa 180,8,224
Mvaa 180,12,228
Ra 240,10,12288
Zvaa 184,16,224
buffer_load_dwordx4 v7, s[12:15], s53 offen offset:1024 lds
Mvaa 184,20,228
Ta 68,14,16384
Ta 70,14,18432
Zvaa 188,24,224
Mvaa 188,28,228
Ra 244,11,12288
Zvaa 192,32,224
buffer_load_dwordx4 v6, s[12:15], s54 offen offset:2048 lds
Mvaa 192,36,228
Ta 72,15,0
Ta 74,15,2048
Zvaa 196,40,224
Mvaa 196,44,228
Ra 248,10,14336
Zvaa 200,48,224
buffer_load_dwordx4 v7, s[12:15], s55 offen offset:3072 lds
Mvaa 200,52,228
Ta 76,15,16384
Ta 78,15,18432
Zvaa 204,56,224
Mvaa 204,60,228
s_add_u32 m0, s57, 4096
Ra 252,11,14336
Zvaa 208,0,232
buffer_load_dwordx4 v8, s[12:15], s52 offen offset:0 lds
Mvaa 208,4,236
Zvaa 212,8,232
Mvaa 212,12,236
Ta 80,24,0
Ta 82,24,2048
Zvaa 216,16,232
buffer_load_dwordx4 v9, s[12:15], s53 offen offset:1024 lds
Mvaa 216,20,236
Ta 84,24,16384
s_waitcnt lgkmcnt(9)
Ta 86,24,18432
Zvaa 220,24,232
Mvaa 220,28,236
Ta 88,25,0
Ta 90,25,2048
Zvaa 224,32,232
buffer_load_dwordx4 v8, s[12:15], s54 offen offset:2048 lds
Mvaa 224,36,236
Zvaa 228,40,232
Mvaa 228,44,236
Ta 92,25,16384
Ta 94,25,18432
Zvaa 232,48,232
buffer_load_dwordx4 v9, s[12:15], s55 offen offset:3072 lds
Mvaa 232,52,236
s_waitcnt vmcnt(9)
Ta 96,26,0
s_waitcnt lgkmcnt(9)
Ta 98,26,2048
Zvaa 236,56,232
s_barrier
v_xor_b32 v6, 524288, v6
v_xor_b32 v7, 524288, v7
Mvaa 236,60,236
s_add_u32 m0, s56, 0
Ta 100,26,16384
Ta 102,26,18432
Zvaa 240,0,240
buffer_load_dwordx4 v2, s[8:11], s48 offen offset:0 lds
Mvaa 240,4,244
v_xor_b32 v8, 524288, v8
v_xor_b32 v9, 524288, v9
Zvaa 244,8,240
Mvaa 244,12,244
Ra 224,12,0
Zvaa 248,16,240
buffer_load_dwordx4 v3, s[8:11], s49 offen offset:1024 lds
Mvaa 248,20,244
Ta 104,27,0
Ta 106,27,2048
Zvaa 252,24,240
Mvaa 252,28,244
s_waitcnt lgkmcnt(9)
Ra 228,13,0
Zaaa 128,32,240
buffer_load_dwordx4 v2, s[8:11], s50 offen offset:2048 lds
Maaa 128,36,244
Ta 108,27,16384
Ta 110,27,18432
Zaaa 132,40,240
Maaa 132,44,244
Ra 232,12,2048
Zaaa 136,48,240
buffer_load_dwordx4 v3, s[8:11], s51 offen offset:3072 lds
Maaa 136,52,244
Ta 112,28,0
Ta 114,28,2048
Zaaa 140,56,240
Maaa 140,60,244
s_add_u32 m0, s56, 4096
s_waitcnt lgkmcnt(9)
Ra 236,13,2048
Zaaa 144,0,248
buffer_load_dwordx4 v4, s[8:11], s48 offen offset:0 lds
Maaa 144,4,252
Zaaa 148,8,248
Maaa 148,12,252
Ta 116,28,16384
Ta 118,28,18432
Zaaa 152,16,248
buffer_load_dwordx4 v5, s[8:11], s49 offen offset:1024 lds
Maaa 152,20,252
Ta 120,29,0
Ta 122,29,2048
Zaaa 156,24,248
Maaa 156,28,252
Ta 124,29,16384
s_waitcnt lgkmcnt(9)
Ta 126,29,18432
Zaaa 160,32,248
buffer_load_dwordx4 v4, s[8:11], s50 offen offset:2048 lds
Maaa 160,36,252
Zaaa 164,40,248
Maaa 164,44,252
Zaaa 168,48,248
buffer_load_dwordx4 v5, s[8:11], s51 offen offset:3072 lds
Maaa 168,52,252
v_xor_b32 v2, 128, v2
v_xor_b32 v3, 128, v3
Zaaa 172,56,248
s_waitcnt lgkmcnt(6)
buffer_load_dword v1, v47, s[60:63], 0 offen
v_xor_b32 v4, 128, v4
v_xor_b32 v5, 128, v5
Maaa 172,60,252
s_waitcnt lgkmcnt(0)
s_mul_i32 vcc_lo, s59, 7
v_xor_b32 v47, vcc_lo, v47
Mvaa 48,64,224
buffer_store_dwordx4 v[30:33], v46, s[20:23], s3 offen offset:0 sc1
Mvaa 48,68,228
buffer_store_dwordx4 v[34:37], v46, s[20:23], s3 offen offset:2048 sc1
Mvaa 52,72,224
buffer_store_dwordx4 v[38:41], v46, s[20:23], s39 offen offset:0 sc1
Mvaa 52,76,228
Ra 240,12,4096
Mvaa 56,80,224
buffer_store_dwordx4 v[42:45], v46, s[20:23], s39 offen offset:2048 sc1
Mvaa 56,84,228
s_lshl_b32 s3, s34, 1
s_and_b32 s36, s32, 1
s_add_u32 s3, s3, s36
Mvaa 60,88,224
s_mul_i32 s3, s3, 1116160
s_mul_i32 s36, s33, 139264
s_add_u32 s3, s3, s36
Mvaa 60,92,228
Ra 244,13,4096
Mvaa 64,96,224
s_lshr_b32 s36, s32, 1
s_mul_i32 s36, s36, 69632
s_add_u32 s3, s3, s36
Mvaa 64,100,228
s_add_u32 s38, s3, 0
s_lshl_b32 s39, s34, 7
s_lshl_b32 s36, s33, 2
Mvaa 68,104,224
s_add_u32 s39, s39, s36
s_add_u32 s39, s39, 5296128
v_mov_b32_e64 v30, 1
Mvaa 68,108,228
Ra 248,12,6144
Mvaa 72,112,224
v_mov_b32_e64 v31, 0
Mvaa 72,116,228
s_cmp_eq_u32 s32, 0
s_cselect_b32 s39, s39, 2146435072
Mvaa 76,120,224
s_mov_b64 exec, 1
buffer_store_dword v31, v31, s[20:23], s39 offen sc1
s_mov_b64 exec, -1
Mvaa 76,124,228
Ra 252,13,6144
Mvaa 80,64,232
s_and_b32 s33, s2, 7
s_lshl_b32 s33, s33, 2
s_bfe_u32 s3, s2, 0x20003
Mvaa 80,68,236
s_add_u32 s33, s33, s3
s_lshr_b32 s34, s2, 5
s_lshl_b32 s64, s34, 7
Mvaa 84,72,232
s_lshl_b32 s3, s33, 2
s_add_u32 s64, s64, s3
s_add_u32 s64, s64, 5300224
Mvaa 84,76,236
s_lshl_b32 s65, s34, 8
s_sub_u32 s65, 1920, s65
v_mul_u32_u24 v32, s65, v0
Mvaa 88,80,232
s_cmp_eq_u32 s32, 0
s_cselect_b32 s64, s64, 2146435072
Mvaa 88,84,236
s_mov_b64 exec, 3
buffer_store_dword v31, v32, s[20:23], s64 offen sc1
s_mov_b64 exec, -1
Mvaa 92,88,232
s_lshl_b32 s3, s2, 2
s_add_u32 s3, s3, 5447680
v_lshlrev_b32_e64 v32, 10, v0
Mvaa 92,92,236
s_cmp_eq_u32 s32, 0
s_cselect_b32 s3, s3, 2146435072
Mvaa 96,96,232
s_mov_b64 exec, 0x1ff
buffer_store_dword v31, v32, s[20:23], s3 offen sc1
s_mov_b64 exec, -1
Mvaa 96,100,236
s_lshl_b32 s35, s34, 1
s_sub_u32 s36, 32, s35
s_add_u32 s35, s35, 2
Mvaa 100,104,232
s_lshl_b32 s44, s32, 12
s_lshl_b32 s58, s32, 1
s_sub_u32 s58, 7, s58
Mvaa 100,108,236
s_mul_i32 s58, s58, 33792
s_sub_u32 s3, 15, s34
s_lshl_b32 s45, s3, 3
Mvaa 104,112,232
s_add_u32 s45, s45, s32
s_lshl_b32 s46, s34, 3
s_add_u32 s46, s46, s32
Mvaa 104,116,236
s_mov_b32 s68, s42
s_and_b32 s69, s43, 0xffff
s_mov_b32 s70, 7340032
Mvaa 108,120,232
s_waitcnt lgkmcnt(0)
Mvaa 108,124,236
s_mov_b32 s71, 0x20000
s_cmp_eq_u32 s32, 0
s_cselect_b32 s37, 0, 2146435072
Mvaa 112,64,240
s_lshl_b32 s3, s33, 8
s_add_u32 s16, s4, s3
s_addc_u32 s17, s5, 0
s_and_b32 s17, s17, 0xffff
Mvaa 112,68,244
s_mov_b32 s18, 0
s_mov_b32 s19, 0x20000
s_sub_u32 s18, 8388608, s3
Mvaa 116,72,240
v_and_b32 v33, 15, v0
v_lshrrev_b32 v32, 1, v33
Mvaa 116,76,244
Ra 224,12,8192
Mvaa 120,80,240
v_and_b32 v33, 1, v0
v_lshlrev_b32 v32, 13, v32
Mvaa 120,84,244
v_lshl_add_u32 v45, v33, 7, v32
Mvaa 124,88,240
s_lshl_b32 s3, s32, 3
s_add_u32 s3, s3, s34
s_mul_i32 s47, s3, 65536
Mvaa 124,92,244
Ra 228,13,8192
Mvaa 128,96,240
s_bfe_u32 s6, s2, 131075
s_lshl_b32 s3, s32, 8
s_or_b32 s6, s6, s3
Mvaa 128,100,244
Mvaa 132,104,240
Mvaa 132,108,244
Ra 232,12,10240
Mvaa 136,112,240
Mvaa 136,116,244
Mvaa 140,120,240
Mvaa 140,124,244
Ra 236,13,10240
Mvaa 144,64,248
Mvaa 144,68,252
Mvaa 148,72,248
Mvaa 148,76,252
Mvaa 152,80,248
Mvaa 152,84,252
Mvaa 156,88,248
Mvaa 156,92,252
Mvaa 160,96,248
Mvaa 160,100,252
Mvaa 164,104,248
Mvaa 164,108,252
Mvaa 168,112,248
Mvaa 168,116,252
s_waitcnt vmcnt(16)
Mvaa 172,120,248
s_waitcnt lgkmcnt(0)
s_barrier
Mvaa 172,124,252
s_add_u32 m0, s57, 65536
Mvaa 176,64,224
buffer_load_dwordx4 v6, s[12:15], s52 offen offset:0 lds
Mvaa 176,68,228
Ta 0,16,0
Ta 2,16,2048
Mvaa 180,72,224
Mvaa 180,76,228
Ra 240,12,12288
Mvaa 184,80,224
buffer_load_dwordx4 v7, s[12:15], s53 offen offset:1024 lds
Mvaa 184,84,228
Ta 4,16,16384
Ta 6,16,18432
Mvaa 188,88,224
Mvaa 188,92,228
Ra 244,13,12288
Mvaa 192,96,224
buffer_load_dwordx4 v6, s[12:15], s54 offen offset:2048 lds
Mvaa 192,100,228
Ta 8,17,0
Ta 10,17,2048
Mvaa 196,104,224
Mvaa 196,108,228
Ra 248,12,14336
Mvaa 200,112,224
buffer_load_dwordx4 v7, s[12:15], s55 offen offset:3072 lds
Mvaa 200,116,228
Ta 12,17,16384
Ta 14,17,18432
Mvaa 204,120,224
Mvaa 204,124,228
s_add_u32 m0, s57, 69632
Ra 252,13,14336
Mvaa 208,64,232
buffer_load_dwordx4 v8, s[12:15], s52 offen offset:0 lds
Mvaa 208,68,236
Mvaa 212,72,232
Mvaa 212,76,236
Ta 16,18,0
Ta 18,18,2048
Mvaa 216,80,232
buffer_load_dwordx4 v9, s[12:15], s53 offen offset:1024 lds
Mvaa 216,84,236
Ta 20,18,16384
s_waitcnt lgkmcnt(9)
Ta 22,18,18432
Mvaa 220,88,232
Mvaa 220,92,236
Ta 24,19,0
Ta 26,19,2048
Mvaa 224,96,232
buffer_load_dwordx4 v8, s[12:15], s54 offen offset:2048 lds
Mvaa 224,100,236
Mvaa 228,104,232
Mvaa 228,108,236
Ta 28,19,16384
Ta 30,19,18432
Mvaa 232,112,232
buffer_load_dwordx4 v9, s[12:15], s55 offen offset:3072 lds
Mvaa 232,116,236
s_waitcnt vmcnt(16)
Ta 32,20,0
s_waitcnt lgkmcnt(9)
Ta 34,20,2048
Mvaa 236,120,232
s_barrier
v_xor_b32 v6, 3670016, v6
v_xor_b32 v7, 3670016, v7
Mvaa 236,124,236
s_add_u32 m0, s56, 65536
Ta 36,20,16384
Ta 38,20,18432
Mvaa 240,64,240
buffer_load_dwordx4 v2, s[8:11], s48 offen offset:0 lds
Mvaa 240,68,244
v_xor_b32 v8, 3670016, v8
v_xor_b32 v9, 3670016, v9
Mvaa 244,72,240
Mvaa 244,76,244
Ra 224,10,0
Mvaa 248,80,240
buffer_load_dwordx4 v3, s[8:11], s49 offen offset:1024 lds
Mvaa 248,84,244
Ta 40,21,0
Ta 42,21,2048
Mvaa 252,88,240
Mvaa 252,92,244
s_waitcnt lgkmcnt(9)
Ra 228,11,0
Maaa 128,96,240
buffer_load_dwordx4 v2, s[8:11], s50 offen offset:2048 lds
Maaa 128,100,244
Ta 44,21,16384
Ta 46,21,18432
Maaa 132,104,240
Maaa 132,108,244
Ra 232,10,2048
Maaa 136,112,240
buffer_load_dwordx4 v3, s[8:11], s51 offen offset:3072 lds
Maaa 136,116,244
Ta 48,22,0
Ta 50,22,2048
Maaa 140,120,240
Maaa 140,124,244
s_add_u32 m0, s56, 69632
s_waitcnt lgkmcnt(9)
Ra 236,11,2048
Maaa 144,64,248
buffer_load_dwordx4 v4, s[8:11], s48 offen offset:0 lds
Maaa 144,68,252
Maaa 148,72,248
Maaa 148,76,252
Ta 52,22,16384
Ta 54,22,18432
Maaa 152,80,248
buffer_load_dwordx4 v5, s[8:11], s49 offen offset:1024 lds
Maaa 152,84,252
Ta 56,23,0
Ta 58,23,2048
Maaa 156,88,248
Maaa 156,92,252
Ta 60,23,16384
s_waitcnt lgkmcnt(9)
Ta 62,23,18432
Maaa 160,96,248
buffer_load_dwordx4 v4, s[8:11], s50 offen offset:2048 lds
Maaa 160,100,252
Maaa 164,104,248
Maaa 164,108,252
Maaa 168,112,248
buffer_load_dwordx4 v5, s[8:11], s51 offen offset:3072 lds
Maaa 168,116,252
v_xor_b32 v2, 896, v2
v_xor_b32 v3, 896, v3
Maaa 172,120,248
s_waitcnt lgkmcnt(6)
buffer_load_dword v1, v47, s[60:63], 0 offen
v_xor_b32 v4, 896, v4
v_xor_b32 v5, 896, v5
Maaa 172,124,252
s_waitcnt lgkmcnt(0)
s_mul_i32 vcc_lo, s59, 1
v_xor_b32 v47, vcc_lo, v47
Mvaa 48,0,224
Mvaa 48,4,228
Mvaa 52,8,224
Mvaa 52,12,228
Ra 240,10,4096
Mvaa 56,16,224
Mvaa 56,20,228
Mvaa 60,24,224
Mvaa 60,28,228
Ra 244,11,4096
Mvaa 64,32,224
Mvaa 64,36,228
Mvaa 68,40,224
Mvaa 68,44,228
Ra 248,10,6144
Mvaa 72,48,224
Mvaa 72,52,228
Mvaa 76,56,224
Mvaa 76,60,228
Ra 252,11,6144
Mvaa 80,0,232
Mvaa 80,4,236
Mvaa 84,8,232
Mvaa 84,12,236
Mvaa 88,16,232
Mvaa 88,20,236
Mvaa 92,24,232
Mvaa 92,28,236
Mvaa 96,32,232
Mvaa 96,36,236
Mvaa 100,40,232
Mvaa 100,44,236
Mvaa 104,48,232
Mvaa 104,52,236
Mvaa 108,56,232
s_waitcnt lgkmcnt(0)
Mvaa 108,60,236
Mvaa 112,0,240
Mvaa 112,4,244
Mvaa 116,8,240
Mvaa 116,12,244
Ra 224,10,8192
Mvaa 120,16,240
Mvaa 120,20,244
Mvaa 124,24,240
Mvaa 124,28,244
Ra 228,11,8192
Mvaa 128,32,240
Mvaa 128,36,244
Mvaa 132,40,240
Mvaa 132,44,244
Ra 232,10,10240
Mvaa 136,48,240
Mvaa 136,52,244
Mvaa 140,56,240
Mvaa 140,60,244
Ra 236,11,10240
Mvaa 144,0,248
Mvaa 144,4,252
Mvaa 148,8,248
Mvaa 148,12,252
Mvaa 152,16,248
Mvaa 152,20,252
Mvaa 156,24,248
Mvaa 156,28,252
Mvaa 160,32,248
Mvaa 160,36,252
Mvaa 164,40,248
Mvaa 164,44,252
Mvaa 168,48,248
Mvaa 168,52,252
s_waitcnt vmcnt(9)
Mvaa 172,56,248
s_waitcnt lgkmcnt(0)
s_barrier
Mvaa 172,60,252
s_add_u32 m0, s57, 0
Mvaa 176,0,224
buffer_load_dwordx4 v6, s[12:15], s52 offen offset:0 lds
Mvaa 176,4,228
Ta 64,14,0
Ta 66,14,2048
Mvaa 180,8,224
Mvaa 180,12,228
Ra 240,10,12288
Mvaa 184,16,224
buffer_load_dwordx4 v7, s[12:15], s53 offen offset:1024 lds
Mvaa 184,20,228
Ta 68,14,16384
Ta 70,14,18432
Mvaa 188,24,224
Mvaa 188,28,228
Ra 244,11,12288
Mvaa 192,32,224
buffer_load_dwordx4 v6, s[12:15], s54 offen offset:2048 lds
Mvaa 192,36,228
Ta 72,15,0
Ta 74,15,2048
Mvaa 196,40,224
Mvaa 196,44,228
Ra 248,10,14336
Mvaa 200,48,224
buffer_load_dwordx4 v7, s[12:15], s55 offen offset:3072 lds
Mvaa 200,52,228
Ta 76,15,16384
Ta 78,15,18432
Mvaa 204,56,224
s_cmp_eq_u32 s6, 0
s_cselect_b32 s3, 0, 2146435072
Mvaa 204,60,228
s_add_u32 m0, s57, 4096
Ra 252,11,14336
Mvaa 208,0,232
buffer_load_dwordx4 v8, s[12:15], s52 offen offset:0 lds
Mvaa 208,4,236
s_mov_b64 exec, 1
buffer_atomic_add v30, v31, s[28:31], s3 offen sc1
s_mov_b64 exec, -1
Mvaa 212,8,232
Mvaa 212,12,236
Ta 80,24,0
Ta 82,24,2048
Mvaa 216,16,232
buffer_load_dwordx4 v9, s[12:15], s53 offen offset:1024 lds
Mvaa 216,20,236
Ta 84,24,16384
s_waitcnt lgkmcnt(9)
Ta 86,24,18432
Mvaa 220,24,232
Mvaa 220,28,236
Ta 88,25,0
Ta 90,25,2048
Mvaa 224,32,232
buffer_load_dwordx4 v8, s[12:15], s54 offen offset:2048 lds
Mvaa 224,36,236
Mvaa 228,40,232
Mvaa 228,44,236
Ta 92,25,16384
Ta 94,25,18432
Mvaa 232,48,232
buffer_load_dwordx4 v9, s[12:15], s55 offen offset:3072 lds
Mvaa 232,52,236
s_waitcnt vmcnt(10)
Ta 96,26,0
s_waitcnt lgkmcnt(9)
Ta 98,26,2048
Mvaa 236,56,232
s_barrier
v_xor_b32 v6, 524288, v6
v_xor_b32 v7, 524288, v7
Mvaa 236,60,236
s_add_u32 m0, s56, 0
Ta 100,26,16384
Ta 102,26,18432
Mvaa 240,0,240
buffer_load_dwordx4 v2, s[8:11], s48 offen offset:0 lds
Mvaa 240,4,244
v_xor_b32 v8, 524288, v8
v_xor_b32 v9, 524288, v9
Mvaa 244,8,240
Mvaa 244,12,244
Ra 224,12,0
Mvaa 248,16,240
buffer_load_dwordx4 v3, s[8:11], s49 offen offset:1024 lds
Mvaa 248,20,244
Ta 104,27,0
Ta 106,27,2048
Mvaa 252,24,240
Mvaa 252,28,244
s_waitcnt lgkmcnt(9)
Ra 228,13,0
Maaa 128,32,240
buffer_load_dwordx4 v2, s[8:11], s50 offen offset:2048 lds
Maaa 128,36,244
Ta 108,27,16384
Ta 110,27,18432
Maaa 132,40,240
Maaa 132,44,244
Ra 232,12,2048
Maaa 136,48,240
buffer_load_dwordx4 v3, s[8:11], s51 offen offset:3072 lds
Maaa 136,52,244
Ta 112,28,0
Ta 114,28,2048
Maaa 140,56,240
Maaa 140,60,244
s_add_u32 m0, s56, 4096
s_waitcnt lgkmcnt(9)
Ra 236,13,2048
Maaa 144,0,248
buffer_load_dwordx4 v4, s[8:11], s48 offen offset:0 lds
Maaa 144,4,252
Maaa 148,8,248
Maaa 148,12,252
Ta 116,28,16384
Ta 118,28,18432
Maaa 152,16,248
buffer_load_dwordx4 v5, s[8:11], s49 offen offset:1024 lds
Maaa 152,20,252
Ta 120,29,0
Ta 122,29,2048
Maaa 156,24,248
Maaa 156,28,252
Ta 124,29,16384
s_waitcnt lgkmcnt(9)
Ta 126,29,18432
Maaa 160,32,248
buffer_load_dwordx4 v4, s[8:11], s50 offen offset:2048 lds
Maaa 160,36,252
Maaa 164,40,248
Maaa 164,44,252
Maaa 168,48,248
buffer_load_dwordx4 v5, s[8:11], s51 offen offset:3072 lds
Maaa 168,52,252
v_xor_b32 v2, 128, v2
v_xor_b32 v3, 128, v3
Maaa 172,56,248
s_waitcnt lgkmcnt(6)
buffer_load_dword v1, v47, s[60:63], 0 offen
v_xor_b32 v4, 128, v4
v_xor_b32 v5, 128, v5
Maaa 172,60,252
s_waitcnt lgkmcnt(0)
s_mul_i32 vcc_lo, s59, 3
v_xor_b32 v47, vcc_lo, v47
Mvaa 48,64,224
buffer_load_dword v44, v45, s[16:19], s47 offen
Mvaa 48,68,228
s_add_u32 s47, s47, 2097152
Mvaa 52,72,224
Mvaa 52,76,228
Ra 240,12,4096
Mvaa 56,80,224
Mvaa 56,84,228
Mvaa 60,88,224
Mvaa 60,92,228
Ra 244,13,4096
Mvaa 64,96,224
Mvaa 64,100,228
Mvaa 68,104,224
Mvaa 68,108,228
Ra 248,12,6144
Mvaa 72,112,224
Mvaa 72,116,228
Mvaa 76,120,224
Mvaa 76,124,228
Ra 252,13,6144
Mvaa 80,64,232
Mvaa 80,68,236
Mvaa 84,72,232
Mvaa 84,76,236
Mvaa 88,80,232
Mvaa 88,84,236
Mvaa 92,88,232
Mvaa 92,92,236
Mvaa 96,96,232
Mvaa 96,100,236
Mvaa 100,104,232
s_cmp_eq_u32 s6, 1
s_cselect_b32 s3, 0, 2146435072
Mvaa 100,108,236
s_mov_b64 exec, 1
buffer_atomic_add v30, v31, s[28:31], s3 offen sc1
s_mov_b64 exec, -1
Mvaa 104,112,232
Mvaa 104,116,236
Mvaa 108,120,232
s_waitcnt lgkmcnt(0)
Mvaa 108,124,236
Mvaa 112,64,240
Mvaa 112,68,244
Mvaa 116,72,240
Mvaa 116,76,244
Ra 224,12,8192
Mvaa 120,80,240
Mvaa 120,84,244
Mvaa 124,88,240
Mvaa 124,92,244
Ra 228,13,8192
Mvaa 128,96,240
Mvaa 128,100,244
Mvaa 132,104,240
Mvaa 132,108,244
Ra 232,12,10240
Mvaa 136,112,240
Mvaa 136,116,244
Mvaa 140,120,240
Mvaa 140,124,244
Ra 236,13,10240
Mvaa 144,64,248
Mvaa 144,68,252
Mvaa 148,72,248
Mvaa 148,76,252
Mvaa 152,80,248
Mvaa 152,84,252
Mvaa 156,88,248
Mvaa 156,92,252
Mvaa 160,96,248
Mvaa 160,100,252
Mvaa 164,104,248
Mvaa 164,108,252
Mvaa 168,112,248
Mvaa 168,116,252
s_waitcnt vmcnt(11)
Mvaa 172,120,248
s_waitcnt lgkmcnt(0)
s_barrier
Mvaa 172,124,252
s_add_u32 m0, s57, 65536
Mvaa 176,64,224
buffer_load_dwordx4 v6, s[12:15], s52 offen offset:0 lds
Mvaa 176,68,228
Ta 0,16,0
Ta 2,16,2048
Mvaa 180,72,224
Mvaa 180,76,228
Ra 240,12,12288
Mvaa 184,80,224
buffer_load_dwordx4 v7, s[12:15], s53 offen offset:1024 lds
Mvaa 184,84,228
Ta 4,16,16384
Ta 6,16,18432
Mvaa 188,88,224
Mvaa 188,92,228
Ra 244,13,12288
Mvaa 192,96,224
buffer_load_dwordx4 v6, s[12:15], s54 offen offset:2048 lds
Mvaa 192,100,228
Ta 8,17,0
Ta 10,17,2048
Mvaa 196,104,224
Mvaa 196,108,228
Ra 248,12,14336
Mvaa 200,112,224
buffer_load_dwordx4 v7, s[12:15], s55 offen offset:3072 lds
Mvaa 200,116,228
Ta 12,17,16384
Ta 14,17,18432
Mvaa 204,120,224
Mvaa 204,124,228
s_add_u32 m0, s57, 69632
Ra 252,13,14336
Mvaa 208,64,232
buffer_load_dwordx4 v8, s[12:15], s52 offen offset:0 lds
Mvaa 208,68,236
Mvaa 212,72,232
Mvaa 212,76,236
Ta 16,18,0
Ta 18,18,2048
Mvaa 216,80,232
buffer_load_dwordx4 v9, s[12:15], s53 offen offset:1024 lds
Mvaa 216,84,236
Ta 20,18,16384
s_waitcnt lgkmcnt(9)
Ta 22,18,18432
Mvaa 220,88,232
Mvaa 220,92,236
Ta 24,19,0
Ta 26,19,2048
Mvaa 224,96,232
buffer_load_dwordx4 v8, s[12:15], s54 offen offset:2048 lds
Mvaa 224,100,236
Mvaa 228,104,232
Mvaa 228,108,236
Ta 28,19,16384
Ta 30,19,18432
Mvaa 232,112,232
buffer_load_dwordx4 v9, s[12:15], s55 offen offset:3072 lds
Mvaa 232,116,236
s_waitcnt vmcnt(11)
Ta 32,20,0
s_waitcnt lgkmcnt(9)
Ta 34,20,2048
Mvaa 236,120,232
s_barrier
v_xor_b32 v6, 1572864, v6
v_xor_b32 v7, 1572864, v7
Mvaa 236,124,236
s_add_u32 m0, s56, 65536
Ta 36,20,16384
Ta 38,20,18432
Mvaa 240,64,240
buffer_load_dwordx4 v2, s[8:11], s48 offen offset:0 lds
Mvaa 240,68,244
v_xor_b32 v8, 1572864, v8
v_xor_b32 v9, 1572864, v9
Mvaa 244,72,240
Mvaa 244,76,244
Ra 224,10,0
Mvaa 248,80,240
buffer_load_dwordx4 v3, s[8:11], s49 offen offset:1024 lds
Mvaa 248,84,244
Ta 40,21,0
Ta 42,21,2048
Mvaa 252,88,240
Mvaa 252,92,244
s_waitcnt lgkmcnt(9)
Ra 228,11,0
Maaa 128,96,240
buffer_load_dwordx4 v2, s[8:11], s50 offen offset:2048 lds
Maaa 128,100,244
Ta 44,21,16384
Ta 46,21,18432
Maaa 132,104,240
s_cmp_eq_u32 s6, 2
s_cselect_b32 s3, 0, 2146435072
Maaa 132,108,244
Ra 232,10,2048
Maaa 136,112,240
buffer_load_dwordx4 v3, s[8:11], s51 offen offset:3072 lds
Maaa 136,116,244
Ta 48,22,0
Ta 50,22,2048
Maaa 140,120,240
s_mov_b64 exec, 1
buffer_atomic_add v30, v31, s[28:31], s3 offen sc1
s_mov_b64 exec, -1
Maaa 140,124,244
s_add_u32 m0, s56, 69632
s_waitcnt lgkmcnt(9)
Ra 236,11,2048
Maaa 144,64,248
buffer_load_dwordx4 v4, s[8:11], s48 offen offset:0 lds
Maaa 144,68,252
Maaa 148,72,248
Maaa 148,76,252
Ta 52,22,16384
Ta 54,22,18432
Maaa 152,80,248
buffer_load_dwordx4 v5, s[8:11], s49 offen offset:1024 lds
Maaa 152,84,252
Ta 56,23,0
Ta 58,23,2048
Maaa 156,88,248
Maaa 156,92,252
Ta 60,23,16384
s_waitcnt lgkmcnt(9)
Ta 62,23,18432
Maaa 160,96,248
buffer_load_dwordx4 v4, s[8:11], s50 offen offset:2048 lds
Maaa 160,100,252
Maaa 164,104,248
Maaa 164,108,252
Maaa 168,112,248
buffer_load_dwordx4 v5, s[8:11], s51 offen offset:3072 lds
Maaa 168,116,252
v_xor_b32 v2, 384, v2
v_xor_b32 v3, 384, v3
Maaa 172,120,248
s_waitcnt lgkmcnt(6)
buffer_load_dword v1, v47, s[60:63], 0 offen
v_xor_b32 v4, 384, v4
v_xor_b32 v5, 384, v5
Maaa 172,124,252
s_waitcnt lgkmcnt(0)
s_mul_i32 vcc_lo, s59, 1
v_xor_b32_e64 v47, vcc_lo, v47
Mvaa 48,0,224
buffer_load_dword v44, v45, s[16:19], s47 offen
Mvaa 48,4,228
s_add_u32 s47, s47, 2097152
Mvaa 52,8,224
Mvaa 52,12,228
Ra 240,10,4096
Mvaa 56,16,224
Mvaa 56,20,228
Mvaa 60,24,224
Mvaa 60,28,228
Ra 244,11,4096
Mvaa 64,32,224
Mvaa 64,36,228
Mvaa 68,40,224
Mvaa 68,44,228
Ra 248,10,6144
Mvaa 72,48,224
Mvaa 72,52,228
Mvaa 76,56,224
Mvaa 76,60,228
Ra 252,11,6144
Mvaa 80,0,232
Mvaa 80,4,236
Mvaa 84,8,232
Mvaa 84,12,236
Mvaa 88,16,232
Mvaa 88,20,236
Mvaa 92,24,232
Mvaa 92,28,236
Mvaa 96,32,232
Mvaa 96,36,236
Mvaa 100,40,232
Mvaa 100,44,236
Mvaa 104,48,232
Mvaa 104,52,236
Mvaa 108,56,232
s_waitcnt lgkmcnt(0)
Mvaa 108,60,236
Mvaa 112,0,240
Mvaa 112,4,244
Mvaa 116,8,240
Mvaa 116,12,244
Ra 224,10,8192
Mvaa 120,16,240
Mvaa 120,20,244
Mvaa 124,24,240
Mvaa 124,28,244
Ra 228,11,8192
Mvaa 128,32,240
Mvaa 128,36,244
Mvaa 132,40,240
Mvaa 132,44,244
Ra 232,10,10240
Mvaa 136,48,240
Mvaa 136,52,244
Mvaa 140,56,240
Mvaa 140,60,244
Ra 236,11,10240
Mvaa 144,0,248
Mvaa 144,4,252
Mvaa 148,8,248
Mvaa 148,12,252
Mvaa 152,16,248
s_cmp_eq_u32 s6, 3
s_cselect_b32 s3, 0, 2146435072
Mvaa 152,20,252
s_mov_b64 exec, 1
buffer_atomic_add v30, v31, s[28:31], s3 offen sc1
s_mov_b64 exec, -1
Mvaa 156,24,248
Mvaa 156,28,252
Mvaa 160,32,248
Mvaa 160,36,252
Mvaa 164,40,248
Mvaa 164,44,252
Mvaa 168,48,248
Mvaa 168,52,252
s_waitcnt vmcnt(12)
Mvaa 172,56,248
s_waitcnt lgkmcnt(0)
s_barrier
Mvaa 172,60,252
s_add_u32 m0, s57, 0
Mvaa 176,0,224
buffer_load_dwordx4 v6, s[12:15], s52 offen offset:0 lds
Mvaa 176,4,228
Ta 64,14,0
Ta 66,14,2048
Mvaa 180,8,224
Mvaa 180,12,228
Ra 240,10,12288
Mvaa 184,16,224
buffer_load_dwordx4 v7, s[12:15], s53 offen offset:1024 lds
Mvaa 184,20,228
Ta 68,14,16384
Ta 70,14,18432
Mvaa 188,24,224
Mvaa 188,28,228
Ra 244,11,12288
Mvaa 192,32,224
buffer_load_dwordx4 v6, s[12:15], s54 offen offset:2048 lds
Mvaa 192,36,228
Ta 72,15,0
Ta 74,15,2048
Mvaa 196,40,224
Mvaa 196,44,228
Ra 248,10,14336
Mvaa 200,48,224
buffer_load_dwordx4 v7, s[12:15], s55 offen offset:3072 lds
Mvaa 200,52,228
Ta 76,15,16384
Ta 78,15,18432
Mvaa 204,56,224
Mvaa 204,60,228
s_add_u32 m0, s57, 4096
Ra 252,11,14336
Mvaa 208,0,232
buffer_load_dwordx4 v8, s[12:15], s52 offen offset:0 lds
Mvaa 208,4,236
Mvaa 212,8,232
Mvaa 212,12,236
Ta 80,24,0
Ta 82,24,2048
Mvaa 216,16,232
buffer_load_dwordx4 v9, s[12:15], s53 offen offset:1024 lds
Mvaa 216,20,236
Ta 84,24,16384
s_waitcnt lgkmcnt(9)
Ta 86,24,18432
Mvaa 220,24,232
Mvaa 220,28,236
Ta 88,25,0
Ta 90,25,2048
Mvaa 224,32,232
buffer_load_dwordx4 v8, s[12:15], s54 offen offset:2048 lds
Mvaa 224,36,236
Mvaa 228,40,232
Mvaa 228,44,236
Ta 92,25,16384
Ta 94,25,18432
Mvaa 232,48,232
buffer_load_dwordx4 v9, s[12:15], s55 offen offset:3072 lds
Mvaa 232,52,236
s_waitcnt vmcnt(11)
Ta 96,26,0
s_waitcnt lgkmcnt(9)
Ta 98,26,2048
Mvaa 236,56,232
s_barrier
v_xor_b32 v6, 524288, v6
v_xor_b32 v7, 524288, v7
Mvaa 236,60,236
s_add_u32 m0, s56, 0
Ta 100,26,16384
Ta 102,26,18432
Mvaa 240,0,240
buffer_load_dwordx4 v2, s[8:11], s48 offen offset:0 lds
Mvaa 240,4,244
v_xor_b32 v8, 524288, v8
v_xor_b32 v9, 524288, v9
Mvaa 244,8,240
Mvaa 244,12,244
Ra 224,12,0
Mvaa 248,16,240
buffer_load_dwordx4 v3, s[8:11], s49 offen offset:1024 lds
Mvaa 248,20,244
Ta 104,27,0
Ta 106,27,2048
Mvaa 252,24,240
Mvaa 252,28,244
s_waitcnt lgkmcnt(9)
Ra 228,13,0
Maaa 128,32,240
buffer_load_dwordx4 v2, s[8:11], s50 offen offset:2048 lds
Maaa 128,36,244
Ta 108,27,16384
Ta 110,27,18432
Maaa 132,40,240
Maaa 132,44,244
Ra 232,12,2048
Maaa 136,48,240
buffer_load_dwordx4 v3, s[8:11], s51 offen offset:3072 lds
Maaa 136,52,244
Ta 112,28,0
Ta 114,28,2048
Maaa 140,56,240
Maaa 140,60,244
s_add_u32 m0, s56, 4096
s_waitcnt lgkmcnt(9)
Ra 236,13,2048
Maaa 144,0,248
buffer_load_dwordx4 v4, s[8:11], s48 offen offset:0 lds
Maaa 144,4,252
Maaa 148,8,248
Maaa 148,12,252
Ta 116,28,16384
Ta 118,28,18432
Maaa 152,16,248
buffer_load_dwordx4 v5, s[8:11], s49 offen offset:1024 lds
Maaa 152,20,252
Ta 120,29,0
Ta 122,29,2048
Maaa 156,24,248
Maaa 156,28,252
Ta 124,29,16384
s_waitcnt lgkmcnt(9)
Ta 126,29,18432
Maaa 160,32,248
buffer_load_dwordx4 v4, s[8:11], s50 offen offset:2048 lds
Maaa 160,36,252
Maaa 164,40,248
Maaa 164,44,252
Maaa 168,48,248
buffer_load_dwordx4 v5, s[8:11], s51 offen offset:3072 lds
Maaa 168,52,252
v_xor_b32 v2, 128, v2
v_xor_b32 v3, 128, v3
Maaa 172,56,248
s_waitcnt lgkmcnt(6)
buffer_load_dword v1, v47, s[60:63], 0 offen
v_xor_b32 v4, 128, v4
v_xor_b32 v5, 128, v5
Maaa 172,60,252
s_waitcnt lgkmcnt(0)
s_mul_i32 vcc_lo, s59, 7
v_xor_b32 v47, vcc_lo, v47
Mvaa 48,64,224
buffer_load_dword v44, v45, s[16:19], s47 offen
Mvaa 48,68,228
s_add_u32 s47, s47, 2097152
v_lshrrev_b32 v32, 4, v0
v_and_b32 v33, 15, v0
Mvaa 52,72,224
s_lshl_b32 s3, s32, 4
v_add_u32 v34, s3, v32
v_lshlrev_b32_e64 v36, 1, v32
Mvaa 52,76,228
Ra 240,12,4096
Mvaa 56,80,224
v_xor_b32 v36, v36, v33
v_xor_b32 v37, 8, v36
Mvaa 56,84,228
Mvaa 60,88,224
Mvaa 60,92,228
Ra 244,13,4096
Mvaa 64,96,224
s_getpc_b64 s[6:7]
L_cpf2:
s_add_u32 s6, s6, (L_phase2-L_cpf2)&0xffffffff
s_addc_u32 s7, s7, ((L_phase2-L_cpf2)>>32)&0xffffffff
Mvaa 64,100,228
s_lshr_b32 s3, s2, 3
s_lshl_b32 s3, s3, 2
s_add_u32 s3, s3, s32
Mvaa 68,104,224
s_lshl_b32 s3, s3, 10
v_and_b32 v42, 7, v0
v_lshlrev_b32_e64 v42, 7, v42
Mvaa 68,108,228
Ra 248,12,6144
Mvaa 72,112,224
v_add_u32_e64 v42, s3, v42
v_min_u32 v42, L_k2_fin-L_phase2-4, v42
Mvaa 72,116,228
v_mov_b32_e64 v41, s7
Mvaa 76,120,224
v_add_co_u32 v40, vcc, s6, v42
s_nop 1
v_addc_co_u32 v41, vcc, 0, v41, vcc
Mvaa 76,124,228
Ra 252,13,6144
Mvaa 80,64,232
global_load_dword v38, v[40:41], off
Mvaa 80,68,236
Mvaa 84,72,232
Mvaa 84,76,236
Mvaa 88,80,232
Mvaa 88,84,236
Mvaa 92,88,232
Mvaa 92,92,236
Mvaa 96,96,232
Mvaa 96,100,236
Mvaa 100,104,232
Mvaa 100,108,236
Mvaa 104,112,232
Mvaa 104,116,236
Mvaa 108,120,232
s_waitcnt lgkmcnt(0)
Mvaa 108,124,236
Mvaa 112,64,240
Mvaa 112,68,244
Mvaa 116,72,240
Mvaa 116,76,244
Ra 224,12,8192
Mvaa 120,80,240
Mvaa 120,84,244
Mvaa 124,88,240
Mvaa 124,92,244
Ra 228,13,8192
Mvaa 128,96,240
Mvaa 128,100,244
Mvaa 132,104,240
Mvaa 132,108,244
Ra 232,12,10240
Mvaa 136,112,240
Mvaa 136,116,244
Mvaa 140,120,240
Mvaa 140,124,244
Ra 236,13,10240
Mvaa 144,64,248
Mvaa 144,68,252
Mvaa 148,72,248
Mvaa 148,76,252
Mvaa 152,80,248
Mvaa 152,84,252
Mvaa 156,88,248
Mvaa 156,92,252
Mvaa 160,96,248
Mvaa 160,100,252
Mvaa 164,104,248
Mvaa 164,108,252
Mvaa 168,112,248
Mvaa 168,116,252
s_waitcnt vmcnt(11)
Mvaa 172,120,248
s_waitcnt lgkmcnt(0)
s_barrier
Mvaa 172,124,252
s_add_u32 m0, s57, 65536
Mvaa 176,64,224
buffer_load_dwordx4 v6, s[12:15], s52 offen offset:0 lds
Mvaa 176,68,228
Ta 0,16,0
Ta 2,16,2048
Mvaa 180,72,224
Mvaa 180,76,228
Ra 240,12,12288
Mvaa 184,80,224
buffer_load_dwordx4 v7, s[12:15], s53 offen offset:1024 lds
Mvaa 184,84,228
Ta 4,16,16384
Ta 6,16,18432
Mvaa 188,88,224
Mvaa 188,92,228
Ra 244,13,12288
Mvaa 192,96,224
buffer_load_dwordx4 v6, s[12:15], s54 offen offset:2048 lds
Mvaa 192,100,228
Ta 8,17,0
Ta 10,17,2048
Mvaa 196,104,224
Mvaa 196,108,228
Ra 248,12,14336
Mvaa 200,112,224
buffer_load_dwordx4 v7, s[12:15], s55 offen offset:3072 lds
Mvaa 200,116,228
Ta 12,17,16384
Ta 14,17,18432
Mvaa 204,120,224
Mvaa 204,124,228
s_add_u32 m0, s57, 69632
Ra 252,13,14336
Mvaa 208,64,232
buffer_load_dwordx4 v8, s[12:15], s52 offen offset:0 lds
Mvaa 208,68,236
Mvaa 212,72,232
Mvaa 212,76,236
Ta 16,18,0
Ta 18,18,2048
Mvaa 216,80,232
buffer_load_dwordx4 v9, s[12:15], s53 offen offset:1024 lds
Mvaa 216,84,236
Ta 20,18,16384
s_waitcnt lgkmcnt(9)
Ta 22,18,18432
Mvaa 220,88,232
Mvaa 220,92,236
Ta 24,19,0
Ta 26,19,2048
Mvaa 224,96,232
buffer_load_dwordx4 v8, s[12:15], s54 offen offset:2048 lds
Mvaa 224,100,236
Mvaa 228,104,232
Mvaa 228,108,236
Ta 28,19,16384
Ta 30,19,18432
Mvaa 232,112,232
buffer_load_dwordx4 v9, s[12:15], s55 offen offset:3072 lds
Mvaa 232,116,236
s_waitcnt vmcnt(11)
Ta 32,20,0
s_waitcnt lgkmcnt(9)
Ta 34,20,2048
Mvaa 236,120,232
s_barrier
Mvaa 236,124,236
s_add_u32 m0, s56, 65536
Ta 36,20,16384
Ta 38,20,18432
Mvaa 240,64,240
buffer_load_dwordx4 v2, s[8:11], s48 offen offset:0 lds
Mvaa 240,68,244
Mvaa 244,72,240
Mvaa 244,76,244
Ra 224,10,0
Mvaa 248,80,240
buffer_load_dwordx4 v3, s[8:11], s49 offen offset:1024 lds
Mvaa 248,84,244
Ta 40,21,0
Ta 42,21,2048
Mvaa 252,88,240
Mvaa 252,92,244
s_waitcnt lgkmcnt(9)
Ra 228,11,0
Maaa 128,96,240
buffer_load_dwordx4 v2, s[8:11], s50 offen offset:2048 lds
Maaa 128,100,244
Ta 44,21,16384
Ta 46,21,18432
Maaa 132,104,240
Maaa 132,108,244
Ra 232,10,2048
Maaa 136,112,240
buffer_load_dwordx4 v3, s[8:11], s51 offen offset:3072 lds
Maaa 136,116,244
Ta 48,22,0
Ta 50,22,2048
Maaa 140,120,240
Maaa 140,124,244
s_add_u32 m0, s56, 69632
s_waitcnt lgkmcnt(9)
Ra 236,11,2048
Maaa 144,64,248
buffer_load_dwordx4 v4, s[8:11], s48 offen offset:0 lds
Maaa 144,68,252
Maaa 148,72,248
Maaa 148,76,252
Ta 52,22,16384
Ta 54,22,18432
Maaa 152,80,248
buffer_load_dwordx4 v5, s[8:11], s49 offen offset:1024 lds
Maaa 152,84,252
Ta 56,23,0
Ta 58,23,2048
Maaa 156,88,248
Maaa 156,92,252
Ta 60,23,16384
s_waitcnt lgkmcnt(9)
Ta 62,23,18432
Maaa 160,96,248
buffer_load_dwordx4 v4, s[8:11], s50 offen offset:2048 lds
Maaa 160,100,252
Maaa 164,104,248
Maaa 164,108,252
Maaa 168,112,248
buffer_load_dwordx4 v5, s[8:11], s51 offen offset:3072 lds
Maaa 168,116,252
Maaa 172,120,248
s_waitcnt lgkmcnt(6)
Maaa 172,124,252
s_waitcnt lgkmcnt(0)
Mvaa 48,0,224
buffer_load_dword v1, v31, s[28:31], s37 offen sc1
Mvaa 48,4,228
s_mov_b32 s8, s16
s_mov_b32 s9, s17
s_mov_b32 s10, s18
Mvaa 52,8,224
s_add_u32 s16, s66, 46137344
s_addc_u32 s17, s67, 0
s_and_b32 s17, s17, 0xffff
Mvaa 52,12,228
Ra 240,10,4096
Mvaa 56,16,224
s_mov_b32 s18, 16777216
s_mov_b32 s19, 0x20000
s_mov_b32 s48, 0
Mvaa 56,20,228
s_mov_b32 s49, 31744
s_mov_b32 s50, 63488
s_mov_b32 s51, 95232
Mvaa 60,24,224
v_lshlrev_b32 v35, 13, v34
Mvaa 60,28,228
Ra 244,11,4096
Mvaa 64,32,224
s_and_b32 s52, s33, 0
s_lshl_b32 s3, s52, 19
s_lshl_b32 s52, s52, 11
Mvaa 64,36,228
s_add_u32 s53, s52, s58
v_add_u32_e64 v35, s3, v35
v_lshl_add_u32 v8, v36, 4, v35
Mvaa 68,40,224
v_lshl_add_u32 v9, v37, 4, v35
v_lshlrev_b32_e64 v2, 4, v0
Mvaa 68,44,228
Ra 248,10,6144
Mvaa 72,48,224
v_add_u32 v3, 65536, v2
v_add_u32_e64 v4, s44, v2
Mvaa 72,52,228
v_mov_b32 v7, 0
v_lshlrev_b32 v35, 2, v32
Mvaa 76,56,224
v_sub_u32_e64 v35, v33, v35
Mvaa 76,60,228
Ra 252,11,6144
Mvaa 80,0,232
s_lshl_b32 s3, s32, 4
v_add_u32 v5, s3, v35
Mvaa 80,4,236
s_sub_u32 s3, 48, s3
v_add_u32 v6, s3, v35
Mvaa 84,8,232
s_mul_i32 s3, s33, 1116160
s_add_u32 s3, s3, 8388608
s_add_u32 s12, s66, s3
s_addc_u32 s13, s67, 0
s_and_b32 s13, s13, 0xffff
Mvaa 84,12,236
s_mov_b32 s14, 0
s_mov_b32 s15, 0x20000
s_mul_i32 s14, s36, 34816
Mvaa 88,16,232
buffer_load_dword v44, v45, s[8:11], s47 offen
Mvaa 88,20,236
s_add_u32 s47, s47, 2097152
v_lshrrev_b32 v42, 2, v33
v_lshl_add_u32 v43, v32, 3, v42
Mvaa 92,24,232
v_lshlrev_b32 v43, 8, v43
v_and_b32 v46, 3, v0
Mvaa 92,28,236
v_lshl_add_u32 v43, v46, 3, v43
v_and_b32_e64 v46, 1, v32
Mvaa 96,32,232
v_lshl_add_u32 v42, v46, 2, v42
v_lshl_add_u32 v16, v42, 5, v43
Mvaa 96,36,236
v_xor_b32 v17, 32, v16
v_xor_b32 v18, 64, v16
Mvaa 100,40,232
v_xor_b32 v19, 96, v16
v_xor_b32 v20, 128, v16
Mvaa 100,44,236
v_xor_b32 v21, 160, v16
v_xor_b32 v22, 192, v16
Mvaa 104,48,232
v_xor_b32 v23, 224, v16
Mvaa 104,52,236
Mvaa 108,56,232
s_waitcnt lgkmcnt(0)
Mvaa 108,60,236
Mvaa 112,0,240
Mvaa 112,4,244
Mvaa 116,8,240
Mvaa 116,12,244
Ra 224,10,8192
Mvaa 120,16,240
Mvaa 120,20,244
Mvaa 124,24,240
Mvaa 124,28,244
Ra 228,11,8192
Mvaa 128,32,240
Mvaa 128,36,244
Mvaa 132,40,240
Mvaa 132,44,244
Ra 232,10,10240
Mvaa 136,48,240
Mvaa 136,52,244
Mvaa 140,56,240
Mvaa 140,60,244
Ra 236,11,10240
Mvaa 144,0,248
Mvaa 144,4,252
Mvaa 148,8,248
Mvaa 148,12,252
Mvaa 152,16,248
Mvaa 152,20,252
Mvaa 156,24,248
Mvaa 156,28,252
Mvaa 160,32,248
Mvaa 160,36,252
Mvaa 164,40,248
Mvaa 164,44,252
Mvaa 168,48,248
Mvaa 168,52,252
s_waitcnt vmcnt(10)
Mvaa 172,56,248
s_waitcnt lgkmcnt(0)
s_barrier
Mvaa 172,60,252
s_add_u32 m0, s44, 0
Mvaa 176,0,224
buffer_load_dwordx4 v8, s[8:11], s48 offen offset:0 lds
Mvaa 176,4,228
Ta 64,14,0
Ta 66,14,2048
Mvaa 180,8,224
Mvaa 180,12,228
Ra 240,10,12288
Mvaa 184,16,224
buffer_load_dwordx4 v8, s[8:11], s49 offen offset:1024 lds
Mvaa 184,20,228
Ta 68,14,16384
Ta 70,14,18432
Mvaa 188,24,224
Mvaa 188,28,228
Ra 244,11,12288
Mvaa 192,32,224
buffer_load_dwordx4 v9, s[8:11], s50 offen offset:2048 lds
Mvaa 192,36,228
Ta 72,15,0
Ta 74,15,2048
Mvaa 196,40,224
Mvaa 196,44,228
Ra 248,10,14336
Mvaa 200,48,224
buffer_load_dwordx4 v9, s[8:11], s51 offen offset:3072 lds
Mvaa 200,52,228
Ta 76,15,16384
Ta 78,15,18432
Mvaa 204,56,224
v_xor_b32 v8, 524288, v8
v_xor_b32 v9, 524288, v9
Mvaa 204,60,228
s_add_u32 m0, s44, 16384
Ra 252,11,14336
Mvaa 208,0,232
buffer_load_dwordx4 v8, s[8:11], s48 offen offset:0 lds
Mvaa 208,4,236
Mvaa 212,8,232
Mvaa 212,12,236
Ta 80,24,0
Ta 82,24,2048
Mvaa 216,16,232
buffer_load_dwordx4 v8, s[8:11], s49 offen offset:1024 lds
Mvaa 216,20,236
Ta 84,24,16384
s_waitcnt lgkmcnt(9)
Ta 86,24,18432
Mvaa 220,24,232
Mvaa 220,28,236
Ta 88,25,0
Ta 90,25,2048
Mvaa 224,32,232
buffer_load_dwordx4 v9, s[8:11], s50 offen offset:2048 lds
Mvaa 224,36,236
Mvaa 228,40,232
s_mul_i32 s3, s45, 33792
v_add_u32_e64 v10, s3, v2
Mvaa 228,44,236
Ta 92,25,16384
Ta 94,25,18432
Mvaa 232,48,232
buffer_load_dwordx4 v9, s[8:11], s51 offen offset:3072 lds
Mvaa 232,52,236
s_waitcnt vmcnt(10)
Ta 96,26,0
s_waitcnt lgkmcnt(9)
Ta 98,26,2048
Mvaa 236,56,232
s_barrier
v_xor_b32 v8, 1572864, v8
v_xor_b32 v9, 1572864, v9
Mvaa 236,60,236
s_add_u32 m0, s44, 32768
Ta 100,26,16384
Ta 102,26,18432
Mvaa 240,0,240
buffer_load_dwordx4 v8, s[8:11], s48 offen offset:0 lds
Mvaa 240,4,244
s_mul_i32 s3, s46, 33792
v_add_u32 v11, s3, v2
Mvaa 244,8,240
Mvaa 244,12,244
Ra 224,12,0
Mvaa 248,16,240
buffer_load_dwordx4 v8, s[8:11], s49 offen offset:1024 lds
Mvaa 248,20,244
Ta 104,27,0
Ta 106,27,2048
Mvaa 252,24,240
Mvaa 252,28,244
s_waitcnt lgkmcnt(9)
Ra 228,13,0
Maaa 128,32,240
buffer_load_dwordx4 v9, s[8:11], s50 offen offset:2048 lds
Maaa 128,36,244
Ta 108,27,16384
Ta 110,27,18432
Maaa 132,40,240
Maaa 132,44,244
Ra 232,12,2048
Maaa 136,48,240
buffer_load_dwordx4 v9, s[8:11], s51 offen offset:3072 lds
Maaa 136,52,244
Ta 112,28,0
Ta 114,28,2048
Maaa 140,56,240
v_xor_b32 v8, 524288, v8
v_xor_b32 v9, 524288, v9
Maaa 140,60,244
s_add_u32 m0, s44, 49152
s_waitcnt lgkmcnt(9)
Ra 236,13,2048
Maaa 144,0,248
buffer_load_dwordx4 v8, s[8:11], s48 offen offset:0 lds
Maaa 144,4,252
Maaa 148,8,248
Maaa 148,12,252
Ta 116,28,16384
Ta 118,28,18432
Maaa 152,16,248
buffer_load_dwordx4 v8, s[8:11], s49 offen offset:1024 lds
Maaa 152,20,252
Ta 120,29,0
Ta 122,29,2048
Maaa 156,24,248
Maaa 156,28,252
Ta 124,29,16384
s_waitcnt lgkmcnt(9)
Ta 126,29,18432
Maaa 160,32,248
buffer_load_dwordx4 v9, s[8:11], s50 offen offset:2048 lds
Maaa 160,36,252
Maaa 164,40,248
Maaa 164,44,252
Maaa 168,48,248
buffer_load_dwordx4 v9, s[8:11], s51 offen offset:3072 lds
Maaa 168,52,252
v_xor_b32 v8, 3670016, v8
v_xor_b32 v9, 3670016, v9
Maaa 172,56,248
s_waitcnt lgkmcnt(6)
Maaa 172,60,252
s_waitcnt lgkmcnt(0)
Mvaa 48,64,224
v_mov_b32 v14, v40
v_mov_b32_e64 v15, v41
Mvaa 48,68,228
Mvaa 52,72,224
Mvaa 52,76,228
Ra 240,12,4096
Mvaa 56,80,224
Mvaa 56,84,228
Mvaa 60,88,224
Mvaa 60,92,228
Ra 244,13,4096
Mvaa 64,96,224
Vc 24,48,49
Vc 25,50,51
Mvaa 64,100,228
Vc 26,52,53
Vc 27,54,55
Mvaa 68,104,224
Mvaa 68,108,228
Ra 248,12,6144
Mvaa 72,112,224
Vc 28,56,57
Vc 29,58,59
Mvaa 72,116,228
Vc 30,60,61
Vc 31,62,63
Mvaa 76,120,224
Mvaa 76,124,228
Ra 252,13,6144
Mvaa 80,64,232
Vc 32,64,65
Vc 33,66,67
Mvaa 80,68,236
Vc 34,68,69
Vc 35,70,71
Mvaa 84,72,232
Mvaa 84,76,236
Mvaa 88,80,232
Vc 36,72,73
Vc 37,74,75
Mvaa 88,84,236
Vc 38,76,77
Vc 39,78,79
Mvaa 92,88,232
Mvaa 92,92,236
Mvaa 96,96,232
Vc 40,80,81
Vc 41,82,83
Mvaa 96,100,236
Vc 42,84,85
Vc 43,86,87
Mvaa 100,104,232
s_waitcnt vmcnt(12)
Mvaa 100,108,236
s_add_u32 s59, s38, 0
Mvaa 104,112,232
v_readfirstlane_b32 s3, v1
s_nop 0
s_or_b32 s3, s3, s37
s_cmp_lt_u32 s3, 256
s_cbranch_scc1 L_spinAk
L_spinArk:
s_barrier
Mvaa 104,116,236
buffer_store_dwordx4 v[24:27], v2, s[24:27], s59 offen offset:0 sc1
Mvaa 108,120,232
s_waitcnt lgkmcnt(0)
Mvaa 108,124,236
Vc 44,88,89
Vc 45,90,91
Mvaa 112,64,240
buffer_load_dwordx4 a[0:3], v10, s[20:23], s53 offen offset:0 sc1
Mvaa 112,68,244
Vc 46,92,93
Vc 47,94,95
Mvaa 116,72,240
Vc 48,96,97
Vc 49,98,99
Mvaa 116,76,244
Ra 224,12,8192
Mvaa 120,80,240
Vc 50,100,101
Vc 51,102,103
Mvaa 120,84,244
Vc 52,104,105
Vc 53,106,107
Mvaa 124,88,240
buffer_load_dwordx4 a[4:7], v10, s[20:23], s52 offen offset:0 sc1
Mvaa 124,92,244
Ra 228,13,8192
Mvaa 128,96,240
Vc 54,108,109
Vc 55,110,111
Mvaa 128,100,244
Vc 56,112,113
Vc 57,114,115
Mvaa 132,104,240
Vc 58,116,117
Vc 59,118,119
Mvaa 132,108,244
Ra 232,12,10240
Mvaa 136,112,240
buffer_load_dwordx4 a[8:11], v11, s[20:23], s53 offen offset:0 sc1
Mvaa 136,116,244
buffer_store_dwordx4 v[28:31], v2, s[24:27], s59 offen offset:1024 sc1
Mvaa 140,120,240
Vc 60,120,121
Vc 61,122,123
Mvaa 140,124,244
Ra 236,13,10240
Mvaa 144,64,248
Vc 62,124,125
Vc 63,126,127
Mvaa 144,68,252
Vc 64,128,129
Vc 65,130,131
Mvaa 148,72,248
buffer_load_dwordx4 a[12:15], v11, s[20:23], s52 offen offset:0 sc1
Mvaa 148,76,252
Vc 66,132,133
Vc 67,134,135
Mvaa 152,80,248
Vc 68,136,137
Vc 69,138,139
Mvaa 152,84,252
Vc 70,140,141
Vc 71,142,143
Mvaa 156,88,248
Mvaa 156,92,252
Mvaa 160,96,248
buffer_load_dwordx4 a[16:19], v10, s[20:23], s53 offen offset:1024 sc1
Mvaa 160,100,252
Vc 72,144,145
Vc 73,146,147
Mvaa 164,104,248
Vc 74,148,149
Vc 75,150,151
Mvaa 164,108,252
buffer_store_dwordx4 v[32:35], v2, s[24:27], s59 offen offset:2048 sc1
Mvaa 168,112,248
Vc 76,152,153
Vc 77,154,155
Mvaa 168,116,252
Vc 78,156,157
Vc 79,158,159
Mvaa 172,120,248
s_waitcnt lgkmcnt(0)
buffer_load_dwordx4 a[20:23], v10, s[20:23], s52 offen offset:1024 sc1
Mvaa 172,124,252
Mvaa 176,64,224
Vc 80,160,161
Vc 81,162,163
Mvaa 176,68,228
Vc 82,164,165
Vc 83,166,167
Mvaa 180,72,224
Mvaa 180,76,228
Ra 240,12,12288
Mvaa 184,80,224
buffer_load_dwordx4 a[24:27], v11, s[20:23], s53 offen offset:1024 sc1
Mvaa 184,84,228
Vc 84,168,169
Vc 85,170,171
Mvaa 188,88,224
Vc 86,172,173
Vc 87,174,175
Mvaa 188,92,228
Ra 244,13,12288
Mvaa 192,96,224
Vc 88,176,177
Vc 89,178,179
Mvaa 192,100,228
Vc 90,180,181
Vc 91,182,183
Mvaa 196,104,224
buffer_load_dwordx4 a[28:31], v11, s[20:23], s52 offen offset:1024 sc1
Mvaa 196,108,228
Ra 248,12,14336
s_xor_b32 s52, s52, 2048
Mvaa 200,112,224
s_add_u32 s53, s52, s58
Mvaa 200,116,228
Vc 92,184,185
Vc 93,186,187
Mvaa 204,120,224
Vc 94,188,189
Vc 95,190,191
Mvaa 204,124,228
Ra 252,13,14336
Mvaa 208,64,232
buffer_load_dwordx4 a[32:35], v10, s[20:23], s53 offen offset:0 sc1
Mvaa 208,68,236
buffer_store_dwordx4 v[36:39], v2, s[24:27], s59 offen offset:3072 sc1
Mvaa 212,72,232
Vc 96,192,193
Vc 97,194,195
Mvaa 212,76,236
Vc 98,196,197
Vc 99,198,199
Mvaa 216,80,232
Vc 100,200,201
Vc 101,202,203
Mvaa 216,84,236
Vc 102,204,205
Vc 103,206,207
Mvaa 220,88,232
buffer_load_dwordx4 a[36:39], v10, s[20:23], s52 offen offset:0 sc1
Mvaa 220,92,236
Mvaa 224,96,232
Vc 104,208,209
Vc 105,210,211
Mvaa 224,100,236
Vc 106,212,213
Vc 107,214,215
Mvaa 228,104,232
Mvaa 228,108,236
Mvaa 232,112,232
buffer_load_dwordx4 a[40:43], v11, s[20:23], s53 offen offset:0 sc1
Mvaa 232,116,236
Vc 108,216,217
Vc 109,218,219
Mvaa 236,120,232
s_waitcnt lgkmcnt(0)
Mvaa 236,124,236
Vc 110,220,221
Vc 111,222,223
Mvaa 240,64,240
s_add_u32 s59, s38, 4096
Mvaa 240,68,244
buffer_store_dwordx4 v[40:43], v2, s[24:27], s59 offen offset:0 sc1
Mvaa 244,72,240
buffer_load_dwordx4 a[44:47], v11, s[20:23], s52 offen offset:0 sc1
Mvaa 244,76,244
Vc 112,224,225
Vc 113,226,227
Mvaa 248,80,240
Vc 114,228,229
Vc 115,230,231
Mvaa 248,84,244
Vc 116,232,233
Vc 117,234,235
Mvaa 252,88,240
Vc 118,236,237
Vc 119,238,239
Mvaa 252,92,244
Maaa 128,96,240
buffer_load_dwordx4 a[48:51], v10, s[20:23], s53 offen offset:1024 sc1
Maaa 128,100,244
Ta 192,16,0
Ta 194,16,1024
Maaa 132,104,240
Vc 120,240,241
Vc 121,242,243
Maaa 132,108,244
Ta 196,17,0
Ta 198,17,1024
Maaa 136,112,240
Vc 122,244,245
Vc 123,246,247
Maaa 136,116,244
Ta 200,18,0
Ta 202,18,1024
Maaa 140,120,240
buffer_load_dwordx4 a[52:55], v10, s[20:23], s52 offen offset:1024 sc1
Maaa 140,124,244
Ta 204,19,0
Ta 206,19,1024
Maaa 144,64,248
Vc 124,248,249
Vc 125,250,251
Maaa 144,68,252
Ta 208,20,0
Ta 210,20,1024
Maaa 148,72,248
Vc 126,252,253
Vc 127,254,255
Maaa 148,76,252
Ta 212,21,0
Ta 214,21,1024
Maaa 152,80,248
buffer_load_dwordx4 a[56:59], v11, s[20:23], s53 offen offset:1024 sc1
Maaa 152,84,252
Ta 216,22,0
Ta 218,22,1024
Maaa 156,88,248
buffer_store_dwordx4 v[44:47], v2, s[24:27], s59 offen offset:1024 sc1
Maaa 156,92,252
Ta 220,23,0
s_waitcnt lgkmcnt(9)
Ta 222,23,1024
Maaa 160,96,248
Maaa 160,100,252
Maaa 164,104,248
buffer_load_dwordx4 a[60:63], v11, s[20:23], s52 offen offset:1024 sc1
Maaa 164,108,252
s_xor_b32 s52, s52, 6144
s_add_u32 s53, s52, s58
Maaa 168,112,248
Maaa 168,116,252
Maaa 172,120,248
Maaa 172,124,252
s_branch L_phase2
L_k1_vpath:
Zvaa 48,224,0
v_and_b32_e64 v46, 7, v0
v_mul_u32_u24 v30, 2064, v46
Mvaa 48,228,4
s_add_u32 m0, s57, 65536
Zvaa 52,232,0
buffer_load_dwordx4 v6, s[12:15], s52 offen offset:0 lds
Mvaa 52,236,4
Ra 240,10,4096
Zvaa 56,224,8
buffer_load_dwordx4 v7, s[12:15], s53 offen offset:1024 lds
Mvaa 56,228,12
v_lshrrev_b32_e64 v31, 3, v0
Zvaa 60,232,8
buffer_load_dwordx4 v6, s[12:15], s54 offen offset:2048 lds
Mvaa 60,236,12
Ra 244,11,4096
Zvaa 64,224,16
buffer_load_dwordx4 v7, s[12:15], s55 offen offset:3072 lds
Mvaa 64,228,20
s_add_u32 m0, s57, 69632
Zvaa 68,232,16
buffer_load_dwordx4 v8, s[12:15], s52 offen offset:0 lds
Mvaa 68,236,20
Ra 248,10,6144
Zvaa 72,224,24
buffer_load_dwordx4 v9, s[12:15], s53 offen offset:1024 lds
Mvaa 72,228,28
s_lshl_b32 s3, s32, 9
s_add_u32 s3, s3, 131072
v_lshl_add_u32 v30, v31, 4, v30
Zvaa 76,232,24
buffer_load_dwordx4 v8, s[12:15], s54 offen offset:2048 lds
Mvaa 76,236,28
s_waitcnt lgkmcnt(9)
Ra 252,11,6144
Zvaa 80,224,32
buffer_load_dwordx4 v9, s[12:15], s55 offen offset:3072 lds
Mvaa 80,228,36
s_add_u32 m0, s56, 65536
v_xor_b32 v6, 1572864, v6
v_xor_b32 v7, 1572864, v7
Zvaa 84,232,32
buffer_load_dwordx4 v2, s[8:11], s48 offen offset:0 lds
Mvaa 84,236,36
v_xor_b32 v8, 1572864, v8
v_xor_b32 v9, 1572864, v9
Zvaa 88,224,40
buffer_load_dwordx4 v3, s[8:11], s49 offen offset:1024 lds
Mvaa 88,228,44
v_add_u32 v30, s3, v30
v_lshlrev_b32 v31, 8, v31
Zvaa 92,232,40
buffer_load_dwordx4 v2, s[8:11], s50 offen offset:2048 lds
Mvaa 92,236,44
v_lshl_add_u32 v46, v46, 4, v31
s_waitcnt lgkmcnt(8)
Zvaa 96,224,48
buffer_load_dwordx4 v3, s[8:11], s51 offen offset:3072 lds
Mvaa 96,228,52
s_add_u32 m0, s56, 69632
Zvaa 100,232,48
buffer_load_dwordx4 v4, s[8:11], s48 offen offset:0 lds
Mvaa 100,236,52
Rv 34,30,128
Rv 38,30,256
s_waitcnt lgkmcnt(6)
Zvaa 104,224,56
buffer_load_dwordx4 v5, s[8:11], s49 offen offset:1024 lds
Mvaa 104,228,60
Rv 42,30,384
Rv 30,30,0
Zvaa 108,232,56
s_waitcnt lgkmcnt(4)
buffer_load_dwordx4 v4, s[8:11], s50 offen offset:2048 lds
Mvaa 108,236,60
s_lshr_b32 s3, s2, 1
s_mul_i32 s3, s3, 33792
s_add_u32 s3, s3, s57
Zvaa 112,240,0
buffer_load_dwordx4 v5, s[8:11], s51 offen offset:3072 lds
Mvaa 112,244,4
v_xor_b32 v2, 384, v2
v_xor_b32 v3, 384, v3
Zvaa 116,248,0
s_and_b32 s39, s2, 1
s_lshl_b32 s39, s39, 7
s_add_u32 s3, s3, s39
Mvaa 116,252,4
Ra 224,10,8192
v_xor_b32 v4, 384, v4
Zvaa 120,240,8
s_add_u32 s39, s3, 4096
Mvaa 120,244,12
v_xor_b32 v5, 384, v5
Zvaa 124,248,8
Mvaa 124,252,12
Ra 228,11,8192
Zvaa 128,240,16
Mvaa 128,244,20
Zvaa 132,248,16
Mvaa 132,252,20
Ra 232,10,10240
Zvaa 136,240,24
buffer_load_dword v1, v47, s[60:63], 0 offen
Mvaa 136,244,28
s_mul_i32 vcc_lo, s59, 1
v_xor_b32 v47, vcc_lo, v47
Zvaa 140,248,24
Mvaa 140,252,28
Ra 236,11,10240
Zvaa 144,240,32
Mvaa 144,244,36
Zvaa 148,248,32
Mvaa 148,252,36
Zvaa 152,240,40
Mvaa 152,244,44
Zvaa 156,248,40
Mvaa 156,252,44
Zvaa 160,240,48
Mvaa 160,244,52
Zvaa 164,248,48
Mvaa 164,252,52
Zvaa 168,240,56
Mvaa 168,244,60
s_waitcnt vmcnt(9)
Zvaa 172,248,56
s_waitcnt lgkmcnt(0)
s_barrier
Mvaa 172,252,60
s_add_u32 m0, s57, 0
Zvaa 176,224,0
buffer_load_dwordx4 v6, s[12:15], s52 offen offset:0 lds
Mvaa 176,228,4
Ta 64,14,0
Ta 66,14,2048
Zvaa 180,232,0
Mvaa 180,236,4
Ra 240,10,12288
Zvaa 184,224,8
buffer_load_dwordx4 v7, s[12:15], s53 offen offset:1024 lds
Mvaa 184,228,12
Ta 68,14,16384
Ta 70,14,18432
Zvaa 188,232,8
Mvaa 188,236,12
Ra 244,11,12288
Zvaa 192,224,16
buffer_load_dwordx4 v6, s[12:15], s54 offen offset:2048 lds
Mvaa 192,228,20
Ta 72,15,0
Ta 74,15,2048
Zvaa 196,232,16
Mvaa 196,236,20
Ra 248,10,14336
Zvaa 200,224,24
buffer_load_dwordx4 v7, s[12:15], s55 offen offset:3072 lds
Mvaa 200,228,28
Ta 76,15,16384
Ta 78,15,18432
Zvaa 204,232,24
Mvaa 204,236,28
s_add_u32 m0, s57, 4096
Ra 252,11,14336
Zvaa 208,224,32
buffer_load_dwordx4 v8, s[12:15], s52 offen offset:0 lds
Mvaa 208,228,36
Zvaa 212,232,32
Mvaa 212,236,36
Ta 80,24,0
Ta 82,24,2048
Zvaa 216,224,40
buffer_load_dwordx4 v9, s[12:15], s53 offen offset:1024 lds
Mvaa 216,228,44
Ta 84,24,16384
s_waitcnt lgkmcnt(9)
Ta 86,24,18432
Zvaa 220,232,40
Mvaa 220,236,44
Ta 88,25,0
Ta 90,25,2048
Zvaa 224,224,48
buffer_load_dwordx4 v8, s[12:15], s54 offen offset:2048 lds
Mvaa 224,228,52
Zvaa 228,232,48
Mvaa 228,236,52
Ta 92,25,16384
Ta 94,25,18432
Zvaa 232,224,56
buffer_load_dwordx4 v9, s[12:15], s55 offen offset:3072 lds
Mvaa 232,228,60
s_waitcnt vmcnt(9)
Ta 96,26,0
s_waitcnt lgkmcnt(9)
Ta 98,26,2048
Zvaa 236,232,56
s_barrier
v_xor_b32 v6, 524288, v6
v_xor_b32 v7, 524288, v7
Mvaa 236,236,60
s_add_u32 m0, s56, 0
Ta 100,26,16384
Ta 102,26,18432
Zvaa 240,240,0
buffer_load_dwordx4 v2, s[8:11], s48 offen offset:0 lds
Mvaa 240,244,4
v_xor_b32 v8, 524288, v8
v_xor_b32 v9, 524288, v9
Zvaa 244,248,0
Mvaa 244,252,4
Ra 224,12,0
Zvaa 248,240,8
buffer_load_dwordx4 v3, s[8:11], s49 offen offset:1024 lds
Mvaa 248,244,12
Ta 104,27,0
Ta 106,27,2048
Zvaa 252,248,8
Mvaa 252,252,12
s_waitcnt lgkmcnt(9)
Ra 228,13,0
Zaaa 128,240,16
buffer_load_dwordx4 v2, s[8:11], s50 offen offset:2048 lds
Maaa 128,244,20
Ta 108,27,16384
Ta 110,27,18432
Zaaa 132,248,16
Maaa 132,252,20
Ra 232,12,2048
Zaaa 136,240,24
buffer_load_dwordx4 v3, s[8:11], s51 offen offset:3072 lds
Maaa 136,244,28
Ta 112,28,0
Ta 114,28,2048
Zaaa 140,248,24
Maaa 140,252,28
s_add_u32 m0, s56, 4096
s_waitcnt lgkmcnt(9)
Ra 236,13,2048
Zaaa 144,240,32
buffer_load_dwordx4 v4, s[8:11], s48 offen offset:0 lds
Maaa 144,244,36
Zaaa 148,248,32
Maaa 148,252,36
Ta 116,28,16384
Ta 118,28,18432
Zaaa 152,240,40
buffer_load_dwordx4 v5, s[8:11], s49 offen offset:1024 lds
Maaa 152,244,44
Ta 120,29,0
Ta 122,29,2048
Zaaa 156,248,40
Maaa 156,252,44
Ta 124,29,16384
s_waitcnt lgkmcnt(9)
Ta 126,29,18432
Zaaa 160,240,48
buffer_load_dwordx4 v4, s[8:11], s50 offen offset:2048 lds
Maaa 160,244,52
Zaaa 164,248,48
Maaa 164,252,52
Zaaa 168,240,56
buffer_load_dwordx4 v5, s[8:11], s51 offen offset:3072 lds
Maaa 168,244,60
v_xor_b32 v2, 128, v2
v_xor_b32 v3, 128, v3
Zaaa 172,248,56
s_waitcnt lgkmcnt(6)
buffer_load_dword v1, v47, s[60:63], 0 offen
v_xor_b32 v4, 128, v4
v_xor_b32 v5, 128, v5
Maaa 172,252,60
s_waitcnt lgkmcnt(0)
s_mul_i32 vcc_lo, s59, 7
v_xor_b32 v47, vcc_lo, v47
Mvaa 48,224,64
buffer_store_dwordx4 v[30:33], v46, s[20:23], s3 offen offset:0 sc1
Mvaa 48,228,68
buffer_store_dwordx4 v[34:37], v46, s[20:23], s3 offen offset:2048 sc1
Mvaa 52,232,64
buffer_store_dwordx4 v[38:41], v46, s[20:23], s39 offen offset:0 sc1
Mvaa 52,236,68
Ra 240,12,4096
Mvaa 56,224,72
buffer_store_dwordx4 v[42:45], v46, s[20:23], s39 offen offset:2048 sc1
Mvaa 56,228,76
s_lshl_b32 s3, s34, 1
s_and_b32 s36, s32, 1
s_add_u32 s3, s3, s36
Mvaa 60,232,72
s_mul_i32 s3, s3, 1116160
s_mul_i32 s36, s33, 139264
s_add_u32 s3, s3, s36
Mvaa 60,236,76
Ra 244,13,4096
Mvaa 64,224,80
s_lshr_b32 s36, s32, 1
s_mul_i32 s36, s36, 69632
s_add_u32 s3, s3, s36
Mvaa 64,228,84
s_add_u32 s38, s3, 17408
s_lshl_b32 s39, s34, 7
s_lshl_b32 s36, s33, 2
Mvaa 68,232,80
s_add_u32 s39, s39, s36
s_add_u32 s39, s39, 5296160
v_mov_b32 v30, 1
Mvaa 68,236,84
Ra 248,12,6144
Mvaa 72,224,88
v_mov_b32_e64 v31, 0
Mvaa 72,228,92
s_cmp_eq_u32 s32, 0
s_cselect_b32 s39, s39, 2146435072
Mvaa 76,232,88
s_mov_b64 exec, 1
buffer_store_dword v31, v31, s[20:23], s39 offen sc1
s_mov_b64 exec, -1
Mvaa 76,236,92
Ra 252,13,6144
Mvaa 80,224,96
s_and_b32 s33, s2, 7
s_lshl_b32 s33, s33, 2
s_bfe_u32 s3, s2, 0x20003
Mvaa 80,228,100
s_add_u32 s33, s33, s3
s_lshr_b32 s34, s2, 5
s_lshl_b32 s64, s34, 7
Mvaa 84,232,96
s_lshl_b32 s3, s33, 2
s_add_u32 s64, s64, s3
s_add_u32 s64, s64, 5300224
Mvaa 84,236,100
s_lshl_b32 s65, s34, 8
s_sub_u32 s65, 1920, s65
v_mul_u32_u24 v32, s65, v0
Mvaa 88,224,104
s_cmp_eq_u32 s32, 0
s_cselect_b32 s64, s64, 2146435072
Mvaa 88,228,108
s_mov_b64 exec, 3
buffer_store_dword v31, v32, s[20:23], s64 offen sc1
s_mov_b64 exec, -1
Mvaa 92,232,104
s_lshl_b32 s3, s2, 2
s_add_u32 s3, s3, 5447680
v_lshlrev_b32_e64 v32, 10, v0
Mvaa 92,236,108
s_cmp_eq_u32 s32, 0
s_cselect_b32 s3, s3, 2146435072
Mvaa 96,224,112
s_mov_b64 exec, 0x1ff
buffer_store_dword v31, v32, s[20:23], s3 offen sc1
s_mov_b64 exec, -1
Mvaa 96,228,116
s_lshl_b32 s35, s34, 1
s_sub_u32 s36, 32, s35
s_add_u32 s35, s35, 2
Mvaa 100,232,112
s_lshl_b32 s44, s32, 12
s_lshl_b32 s58, s32, 1
s_sub_u32 s58, 7, s58
Mvaa 100,236,116
s_mul_i32 s58, s58, 33792
s_sub_u32 s3, 15, s34
s_lshl_b32 s45, s3, 3
Mvaa 104,224,120
s_add_u32 s45, s45, s32
s_lshl_b32 s46, s34, 3
s_add_u32 s46, s46, s32
Mvaa 104,228,124
s_mov_b32 s68, s42
s_and_b32 s69, s43, 0xffff
s_mov_b32 s70, 7340032
Mvaa 108,232,120
s_waitcnt lgkmcnt(0)
Mvaa 108,236,124
s_mov_b32 s71, 0x20000
s_cmp_eq_u32 s32, 0
s_cselect_b32 s37, 0, 2146435072
Mvaa 112,240,64
s_lshl_b32 s3, s33, 8
s_add_u32 s16, s4, s3
s_addc_u32 s17, s5, 0
s_and_b32 s17, s17, 0xffff
Mvaa 112,244,68
s_mov_b32 s18, 0
s_mov_b32 s19, 0x20000
s_sub_u32 s18, 8388608, s3
Mvaa 116,248,64
v_and_b32 v33, 15, v0
v_lshrrev_b32 v32, 1, v33
Mvaa 116,252,68
Ra 224,12,8192
Mvaa 120,240,72
v_and_b32 v33, 1, v0
v_lshlrev_b32 v32, 13, v32
Mvaa 120,244,76
v_lshl_add_u32 v45, v33, 7, v32
Mvaa 124,248,72
s_lshl_b32 s3, s32, 3
s_add_u32 s3, s3, s34
s_mul_i32 s47, s3, 65536
Mvaa 124,252,76
Ra 228,13,8192
Mvaa 128,240,80
s_bfe_u32 s6, s2, 131075
s_lshl_b32 s3, s32, 8
s_or_b32 s6, s6, s3
Mvaa 128,244,84
Mvaa 132,248,80
Mvaa 132,252,84
Ra 232,12,10240
Mvaa 136,240,88
Mvaa 136,244,92
Mvaa 140,248,88
Mvaa 140,252,92
Ra 236,13,10240
Mvaa 144,240,96
Mvaa 144,244,100
Mvaa 148,248,96
Mvaa 148,252,100
Mvaa 152,240,104
Mvaa 152,244,108
Mvaa 156,248,104
Mvaa 156,252,108
Mvaa 160,240,112
Mvaa 160,244,116
Mvaa 164,248,112
Mvaa 164,252,116
Mvaa 168,240,120
Mvaa 168,244,124
s_waitcnt vmcnt(16)
Mvaa 172,248,120
s_waitcnt lgkmcnt(0)
s_barrier
Mvaa 172,252,124
s_add_u32 m0, s57, 65536
Mvaa 176,224,64
buffer_load_dwordx4 v6, s[12:15], s52 offen offset:0 lds
Mvaa 176,228,68
Ta 0,16,0
Ta 2,16,2048
Mvaa 180,232,64
Mvaa 180,236,68
Ra 240,12,12288
Mvaa 184,224,72
buffer_load_dwordx4 v7, s[12:15], s53 offen offset:1024 lds
Mvaa 184,228,76
Ta 4,16,16384
Ta 6,16,18432
Mvaa 188,232,72
Mvaa 188,236,76
Ra 244,13,12288
Mvaa 192,224,80
buffer_load_dwordx4 v6, s[12:15], s54 offen offset:2048 lds
Mvaa 192,228,84
Ta 8,17,0
Ta 10,17,2048
Mvaa 196,232,80
Mvaa 196,236,84
Ra 248,12,14336
Mvaa 200,224,88
buffer_load_dwordx4 v7, s[12:15], s55 offen offset:3072 lds
Mvaa 200,228,92
Ta 12,17,16384
Ta 14,17,18432
Mvaa 204,232,88
Mvaa 204,236,92
s_add_u32 m0, s57, 69632
Ra 252,13,14336
Mvaa 208,224,96
buffer_load_dwordx4 v8, s[12:15], s52 offen offset:0 lds
Mvaa 208,228,100
Mvaa 212,232,96
Mvaa 212,236,100
Ta 16,18,0
Ta 18,18,2048
Mvaa 216,224,104
buffer_load_dwordx4 v9, s[12:15], s53 offen offset:1024 lds
Mvaa 216,228,108
Ta 20,18,16384
s_waitcnt lgkmcnt(9)
Ta 22,18,18432
Mvaa 220,232,104
Mvaa 220,236,108
Ta 24,19,0
Ta 26,19,2048
Mvaa 224,224,112
buffer_load_dwordx4 v8, s[12:15], s54 offen offset:2048 lds
Mvaa 224,228,116
Mvaa 228,232,112
Mvaa 228,236,116
Ta 28,19,16384
Ta 30,19,18432
Mvaa 232,224,120
buffer_load_dwordx4 v9, s[12:15], s55 offen offset:3072 lds
Mvaa 232,228,124
s_waitcnt vmcnt(16)
Ta 32,20,0
s_waitcnt lgkmcnt(9)
Ta 34,20,2048
Mvaa 236,232,120
s_barrier
v_xor_b32 v6, 3670016, v6
v_xor_b32 v7, 3670016, v7
Mvaa 236,236,124
s_add_u32 m0, s56, 65536
Ta 36,20,16384
Ta 38,20,18432
Mvaa 240,240,64
buffer_load_dwordx4 v2, s[8:11], s48 offen offset:0 lds
Mvaa 240,244,68
v_xor_b32 v8, 3670016, v8
v_xor_b32 v9, 3670016, v9
Mvaa 244,248,64
Mvaa 244,252,68
Ra 224,10,0
Mvaa 248,240,72
buffer_load_dwordx4 v3, s[8:11], s49 offen offset:1024 lds
Mvaa 248,244,76
Ta 40,21,0
Ta 42,21,2048
Mvaa 252,248,72
Mvaa 252,252,76
s_waitcnt lgkmcnt(9)
Ra 228,11,0
Maaa 128,240,80
buffer_load_dwordx4 v2, s[8:11], s50 offen offset:2048 lds
Maaa 128,244,84
Ta 44,21,16384
Ta 46,21,18432
Maaa 132,248,80
Maaa 132,252,84
Ra 232,10,2048
Maaa 136,240,88
buffer_load_dwordx4 v3, s[8:11], s51 offen offset:3072 lds
Maaa 136,244,92
Ta 48,22,0
Ta 50,22,2048
Maaa 140,248,88
Maaa 140,252,92
s_add_u32 m0, s56, 69632
s_waitcnt lgkmcnt(9)
Ra 236,11,2048
Maaa 144,240,96
buffer_load_dwordx4 v4, s[8:11], s48 offen offset:0 lds
Maaa 144,244,100
Maaa 148,248,96
Maaa 148,252,100
Ta 52,22,16384
Ta 54,22,18432
Maaa 152,240,104
buffer_load_dwordx4 v5, s[8:11], s49 offen offset:1024 lds
Maaa 152,244,108
Ta 56,23,0
Ta 58,23,2048
Maaa 156,248,104
Maaa 156,252,108
Ta 60,23,16384
s_waitcnt lgkmcnt(9)
Ta 62,23,18432
Maaa 160,240,112
buffer_load_dwordx4 v4, s[8:11], s50 offen offset:2048 lds
Maaa 160,244,116
Maaa 164,248,112
Maaa 164,252,116
Maaa 168,240,120
buffer_load_dwordx4 v5, s[8:11], s51 offen offset:3072 lds
Maaa 168,244,124
v_xor_b32 v2, 896, v2
v_xor_b32 v3, 896, v3
Maaa 172,248,120
s_waitcnt lgkmcnt(6)
buffer_load_dword v1, v47, s[60:63], 0 offen
v_xor_b32 v4, 896, v4
v_xor_b32 v5, 896, v5
Maaa 172,252,124
s_waitcnt lgkmcnt(0)
s_mul_i32 vcc_lo, s59, 1
v_xor_b32 v47, vcc_lo, v47
Mvaa 48,224,0
Mvaa 48,228,4
Mvaa 52,232,0
Mvaa 52,236,4
Ra 240,10,4096
Mvaa 56,224,8
Mvaa 56,228,12
Mvaa 60,232,8
Mvaa 60,236,12
Ra 244,11,4096
Mvaa 64,224,16
Mvaa 64,228,20
Mvaa 68,232,16
Mvaa 68,236,20
Ra 248,10,6144
Mvaa 72,224,24
Mvaa 72,228,28
Mvaa 76,232,24
Mvaa 76,236,28
Ra 252,11,6144
Mvaa 80,224,32
Mvaa 80,228,36
Mvaa 84,232,32
Mvaa 84,236,36
Mvaa 88,224,40
Mvaa 88,228,44
Mvaa 92,232,40
Mvaa 92,236,44
Mvaa 96,224,48
Mvaa 96,228,52
Mvaa 100,232,48
Mvaa 100,236,52
Mvaa 104,224,56
Mvaa 104,228,60
Mvaa 108,232,56
s_waitcnt lgkmcnt(0)
Mvaa 108,236,60
Mvaa 112,240,0
Mvaa 112,244,4
Mvaa 116,248,0
Mvaa 116,252,4
Ra 224,10,8192
Mvaa 120,240,8
Mvaa 120,244,12
Mvaa 124,248,8
Mvaa 124,252,12
Ra 228,11,8192
Mvaa 128,240,16
Mvaa 128,244,20
Mvaa 132,248,16
Mvaa 132,252,20
Ra 232,10,10240
Mvaa 136,240,24
Mvaa 136,244,28
Mvaa 140,248,24
Mvaa 140,252,28
Ra 236,11,10240
Mvaa 144,240,32
Mvaa 144,244,36
Mvaa 148,248,32
Mvaa 148,252,36
Mvaa 152,240,40
Mvaa 152,244,44
Mvaa 156,248,40
Mvaa 156,252,44
Mvaa 160,240,48
Mvaa 160,244,52
Mvaa 164,248,48
Mvaa 164,252,52
Mvaa 168,240,56
Mvaa 168,244,60
s_waitcnt vmcnt(9)
Mvaa 172,248,56
s_waitcnt lgkmcnt(0)
s_barrier
Mvaa 172,252,60
s_add_u32 m0, s57, 0
Mvaa 176,224,0
buffer_load_dwordx4 v6, s[12:15], s52 offen offset:0 lds
Mvaa 176,228,4
Ta 64,14,0
Ta 66,14,2048
Mvaa 180,232,0
Mvaa 180,236,4
Ra 240,10,12288
Mvaa 184,224,8
buffer_load_dwordx4 v7, s[12:15], s53 offen offset:1024 lds
Mvaa 184,228,12
Ta 68,14,16384
Ta 70,14,18432
Mvaa 188,232,8
Mvaa 188,236,12
Ra 244,11,12288
Mvaa 192,224,16
buffer_load_dwordx4 v6, s[12:15], s54 offen offset:2048 lds
Mvaa 192,228,20
Ta 72,15,0
Ta 74,15,2048
Mvaa 196,232,16
Mvaa 196,236,20
Ra 248,10,14336
Mvaa 200,224,24
buffer_load_dwordx4 v7, s[12:15], s55 offen offset:3072 lds
Mvaa 200,228,28
Ta 76,15,16384
Ta 78,15,18432
Mvaa 204,232,24
s_cmp_eq_u32 s6, 0
s_cselect_b32 s3, 0, 2146435072
Mvaa 204,236,28
s_add_u32 m0, s57, 4096
Ra 252,11,14336
Mvaa 208,224,32
buffer_load_dwordx4 v8, s[12:15], s52 offen offset:0 lds
Mvaa 208,228,36
s_mov_b64 exec, 1
buffer_atomic_add v30, v31, s[28:31], s3 offen sc1
s_mov_b64 exec, -1
Mvaa 212,232,32
Mvaa 212,236,36
Ta 80,24,0
Ta 82,24,2048
Mvaa 216,224,40
buffer_load_dwordx4 v9, s[12:15], s53 offen offset:1024 lds
Mvaa 216,228,44
Ta 84,24,16384
s_waitcnt lgkmcnt(9)
Ta 86,24,18432
Mvaa 220,232,40
Mvaa 220,236,44
Ta 88,25,0
Ta 90,25,2048
Mvaa 224,224,48
buffer_load_dwordx4 v8, s[12:15], s54 offen offset:2048 lds
Mvaa 224,228,52
Mvaa 228,232,48
Mvaa 228,236,52
Ta 92,25,16384
Ta 94,25,18432
Mvaa 232,224,56
buffer_load_dwordx4 v9, s[12:15], s55 offen offset:3072 lds
Mvaa 232,228,60
s_waitcnt vmcnt(10)
Ta 96,26,0
s_waitcnt lgkmcnt(9)
Ta 98,26,2048
Mvaa 236,232,56
s_barrier
v_xor_b32 v6, 524288, v6
v_xor_b32 v7, 524288, v7
Mvaa 236,236,60
s_add_u32 m0, s56, 0
Ta 100,26,16384
Ta 102,26,18432
Mvaa 240,240,0
buffer_load_dwordx4 v2, s[8:11], s48 offen offset:0 lds
Mvaa 240,244,4
v_xor_b32 v8, 524288, v8
v_xor_b32 v9, 524288, v9
Mvaa 244,248,0
Mvaa 244,252,4
Ra 224,12,0
Mvaa 248,240,8
buffer_load_dwordx4 v3, s[8:11], s49 offen offset:1024 lds
Mvaa 248,244,12
Ta 104,27,0
Ta 106,27,2048
Mvaa 252,248,8
Mvaa 252,252,12
s_waitcnt lgkmcnt(9)
Ra 228,13,0
Maaa 128,240,16
buffer_load_dwordx4 v2, s[8:11], s50 offen offset:2048 lds
Maaa 128,244,20
Ta 108,27,16384
Ta 110,27,18432
Maaa 132,248,16
Maaa 132,252,20
Ra 232,12,2048
Maaa 136,240,24
buffer_load_dwordx4 v3, s[8:11], s51 offen offset:3072 lds
Maaa 136,244,28
Ta 112,28,0
Ta 114,28,2048
Maaa 140,248,24
Maaa 140,252,28
s_add_u32 m0, s56, 4096
s_waitcnt lgkmcnt(9)
Ra 236,13,2048
Maaa 144,240,32
buffer_load_dwordx4 v4, s[8:11], s48 offen offset:0 lds
Maaa 144,244,36
Maaa 148,248,32
Maaa 148,252,36
Ta 116,28,16384
Ta 118,28,18432
Maaa 152,240,40
buffer_load_dwordx4 v5, s[8:11], s49 offen offset:1024 lds
Maaa 152,244,44
Ta 120,29,0
Ta 122,29,2048
Maaa 156,248,40
Maaa 156,252,44
Ta 124,29,16384
s_waitcnt lgkmcnt(9)
Ta 126,29,18432
Maaa 160,240,48
buffer_load_dwordx4 v4, s[8:11], s50 offen offset:2048 lds
Maaa 160,244,52
Maaa 164,248,48
Maaa 164,252,52
Maaa 168,240,56
buffer_load_dwordx4 v5, s[8:11], s51 offen offset:3072 lds
Maaa 168,244,60
v_xor_b32 v2, 128, v2
v_xor_b32 v3, 128, v3
Maaa 172,248,56
s_waitcnt lgkmcnt(6)
buffer_load_dword v1, v47, s[60:63], 0 offen
v_xor_b32 v4, 128, v4
v_xor_b32 v5, 128, v5
Maaa 172,252,60
s_waitcnt lgkmcnt(0)
s_mul_i32 vcc_lo, s59, 3
v_xor_b32 v47, vcc_lo, v47
Mvaa 48,224,64
buffer_load_dword v44, v45, s[16:19], s47 offen
Mvaa 48,228,68
s_add_u32 s47, s47, 2097152
Mvaa 52,232,64
Mvaa 52,236,68
Ra 240,12,4096
Mvaa 56,224,72
Mvaa 56,228,76
Mvaa 60,232,72
Mvaa 60,236,76
Ra 244,13,4096
Mvaa 64,224,80
Mvaa 64,228,84
Mvaa 68,232,80
Mvaa 68,236,84
Ra 248,12,6144
Mvaa 72,224,88
Mvaa 72,228,92
Mvaa 76,232,88
Mvaa 76,236,92
Ra 252,13,6144
Mvaa 80,224,96
Mvaa 80,228,100
Mvaa 84,232,96
Mvaa 84,236,100
Mvaa 88,224,104
Mvaa 88,228,108
Mvaa 92,232,104
Mvaa 92,236,108
Mvaa 96,224,112
Mvaa 96,228,116
Mvaa 100,232,112
s_cmp_eq_u32 s6, 1
s_cselect_b32 s3, 0, 2146435072
Mvaa 100,236,116
s_mov_b64 exec, 1
buffer_atomic_add v30, v31, s[28:31], s3 offen sc1
s_mov_b64 exec, -1
Mvaa 104,224,120
Mvaa 104,228,124
Mvaa 108,232,120
s_waitcnt lgkmcnt(0)
Mvaa 108,236,124
Mvaa 112,240,64
Mvaa 112,244,68
Mvaa 116,248,64
Mvaa 116,252,68
Ra 224,12,8192
Mvaa 120,240,72
Mvaa 120,244,76
Mvaa 124,248,72
Mvaa 124,252,76
Ra 228,13,8192
Mvaa 128,240,80
Mvaa 128,244,84
Mvaa 132,248,80
Mvaa 132,252,84
Ra 232,12,10240
Mvaa 136,240,88
Mvaa 136,244,92
Mvaa 140,248,88
Mvaa 140,252,92
Ra 236,13,10240
Mvaa 144,240,96
Mvaa 144,244,100
Mvaa 148,248,96
Mvaa 148,252,100
Mvaa 152,240,104
Mvaa 152,244,108
Mvaa 156,248,104
Mvaa 156,252,108
Mvaa 160,240,112
Mvaa 160,244,116
Mvaa 164,248,112
Mvaa 164,252,116
Mvaa 168,240,120
Mvaa 168,244,124
s_waitcnt vmcnt(11)
Mvaa 172,248,120
s_waitcnt lgkmcnt(0)
s_barrier
Mvaa 172,252,124
s_add_u32 m0, s57, 65536
Mvaa 176,224,64
buffer_load_dwordx4 v6, s[12:15], s52 offen offset:0 lds
Mvaa 176,228,68
Ta 0,16,0
Ta 2,16,2048
Mvaa 180,232,64
Mvaa 180,236,68
Ra 240,12,12288
Mvaa 184,224,72
buffer_load_dwordx4 v7, s[12:15], s53 offen offset:1024 lds
Mvaa 184,228,76
Ta 4,16,16384
Ta 6,16,18432
Mvaa 188,232,72
Mvaa 188,236,76
Ra 244,13,12288
Mvaa 192,224,80
buffer_load_dwordx4 v6, s[12:15], s54 offen offset:2048 lds
Mvaa 192,228,84
Ta 8,17,0
Ta 10,17,2048
Mvaa 196,232,80
Mvaa 196,236,84
Ra 248,12,14336
Mvaa 200,224,88
buffer_load_dwordx4 v7, s[12:15], s55 offen offset:3072 lds
Mvaa 200,228,92
Ta 12,17,16384
Ta 14,17,18432
Mvaa 204,232,88
Mvaa 204,236,92
s_add_u32 m0, s57, 69632
Ra 252,13,14336
Mvaa 208,224,96
buffer_load_dwordx4 v8, s[12:15], s52 offen offset:0 lds
Mvaa 208,228,100
Mvaa 212,232,96
Mvaa 212,236,100
Ta 16,18,0
Ta 18,18,2048
Mvaa 216,224,104
buffer_load_dwordx4 v9, s[12:15], s53 offen offset:1024 lds
Mvaa 216,228,108
Ta 20,18,16384
s_waitcnt lgkmcnt(9)
Ta 22,18,18432
Mvaa 220,232,104
Mvaa 220,236,108
Ta 24,19,0
Ta 26,19,2048
Mvaa 224,224,112
buffer_load_dwordx4 v8, s[12:15], s54 offen offset:2048 lds
Mvaa 224,228,116
Mvaa 228,232,112
Mvaa 228,236,116
Ta 28,19,16384
Ta 30,19,18432
Mvaa 232,224,120
buffer_load_dwordx4 v9, s[12:15], s55 offen offset:3072 lds
Mvaa 232,228,124
s_waitcnt vmcnt(11)
Ta 32,20,0
s_waitcnt lgkmcnt(9)
Ta 34,20,2048
Mvaa 236,232,120
s_barrier
v_xor_b32 v6, 1572864, v6
v_xor_b32 v7, 1572864, v7
Mvaa 236,236,124
s_add_u32 m0, s56, 65536
Ta 36,20,16384
Ta 38,20,18432
Mvaa 240,240,64
buffer_load_dwordx4 v2, s[8:11], s48 offen offset:0 lds
Mvaa 240,244,68
v_xor_b32 v8, 1572864, v8
v_xor_b32 v9, 1572864, v9
Mvaa 244,248,64
Mvaa 244,252,68
Ra 224,10,0
Mvaa 248,240,72
buffer_load_dwordx4 v3, s[8:11], s49 offen offset:1024 lds
Mvaa 248,244,76
Ta 40,21,0
Ta 42,21,2048
Mvaa 252,248,72
Mvaa 252,252,76
s_waitcnt lgkmcnt(9)
Ra 228,11,0
Maaa 128,240,80
buffer_load_dwordx4 v2, s[8:11], s50 offen offset:2048 lds
Maaa 128,244,84
Ta 44,21,16384
Ta 46,21,18432
Maaa 132,248,80
s_cmp_eq_u32 s6, 2
s_cselect_b32 s3, 0, 2146435072
Maaa 132,252,84
Ra 232,10,2048
Maaa 136,240,88
buffer_load_dwordx4 v3, s[8:11], s51 offen offset:3072 lds
Maaa 136,244,92
Ta 48,22,0
Ta 50,22,2048
Maaa 140,248,88
s_mov_b64 exec, 1
buffer_atomic_add v30, v31, s[28:31], s3 offen sc1
s_mov_b64 exec, -1
Maaa 140,252,92
s_add_u32 m0, s56, 69632
s_waitcnt lgkmcnt(9)
Ra 236,11,2048
Maaa 144,240,96
buffer_load_dwordx4 v4, s[8:11], s48 offen offset:0 lds
Maaa 144,244,100
Maaa 148,248,96
Maaa 148,252,100
Ta 52,22,16384
Ta 54,22,18432
Maaa 152,240,104
buffer_load_dwordx4 v5, s[8:11], s49 offen offset:1024 lds
Maaa 152,244,108
Ta 56,23,0
Ta 58,23,2048
Maaa 156,248,104
Maaa 156,252,108
Ta 60,23,16384
s_waitcnt lgkmcnt(9)
Ta 62,23,18432
Maaa 160,240,112
buffer_load_dwordx4 v4, s[8:11], s50 offen offset:2048 lds
Maaa 160,244,116
Maaa 164,248,112
Maaa 164,252,116
Maaa 168,240,120
buffer_load_dwordx4 v5, s[8:11], s51 offen offset:3072 lds
Maaa 168,244,124
v_xor_b32 v2, 384, v2
v_xor_b32 v3, 384, v3
Maaa 172,248,120
s_waitcnt lgkmcnt(6)
buffer_load_dword v1, v47, s[60:63], 0 offen
v_xor_b32 v4, 384, v4
v_xor_b32 v5, 384, v5
Maaa 172,252,124
s_waitcnt lgkmcnt(0)
s_mul_i32 vcc_lo, s59, 1
v_xor_b32_e64 v47, vcc_lo, v47
Mvaa 48,224,0
buffer_load_dword v44, v45, s[16:19], s47 offen
Mvaa 48,228,4
s_add_u32 s47, s47, 2097152
Mvaa 52,232,0
Mvaa 52,236,4
Ra 240,10,4096
Mvaa 56,224,8
Mvaa 56,228,12
Mvaa 60,232,8
Mvaa 60,236,12
Ra 244,11,4096
Mvaa 64,224,16
Mvaa 64,228,20
Mvaa 68,232,16
Mvaa 68,236,20
Ra 248,10,6144
Mvaa 72,224,24
Mvaa 72,228,28
Mvaa 76,232,24
Mvaa 76,236,28
Ra 252,11,6144
Mvaa 80,224,32
Mvaa 80,228,36
Mvaa 84,232,32
Mvaa 84,236,36
Mvaa 88,224,40
Mvaa 88,228,44
Mvaa 92,232,40
Mvaa 92,236,44
Mvaa 96,224,48
Mvaa 96,228,52
Mvaa 100,232,48
Mvaa 100,236,52
Mvaa 104,224,56
Mvaa 104,228,60
Mvaa 108,232,56
s_waitcnt lgkmcnt(0)
Mvaa 108,236,60
Mvaa 112,240,0
Mvaa 112,244,4
Mvaa 116,248,0
Mvaa 116,252,4
Ra 224,10,8192
Mvaa 120,240,8
Mvaa 120,244,12
Mvaa 124,248,8
Mvaa 124,252,12
Ra 228,11,8192
Mvaa 128,240,16
Mvaa 128,244,20
Mvaa 132,248,16
Mvaa 132,252,20
Ra 232,10,10240
Mvaa 136,240,24
Mvaa 136,244,28
Mvaa 140,248,24
Mvaa 140,252,28
Ra 236,11,10240
Mvaa 144,240,32
Mvaa 144,244,36
Mvaa 148,248,32
Mvaa 148,252,36
Mvaa 152,240,40
s_cmp_eq_u32 s6, 3
s_cselect_b32 s3, 0, 2146435072
Mvaa 152,244,44
s_mov_b64 exec, 1
buffer_atomic_add v30, v31, s[28:31], s3 offen sc1
s_mov_b64 exec, -1
Mvaa 156,248,40
Mvaa 156,252,44
Mvaa 160,240,48
Mvaa 160,244,52
Mvaa 164,248,48
Mvaa 164,252,52
Mvaa 168,240,56
Mvaa 168,244,60
s_waitcnt vmcnt(12)
Mvaa 172,248,56
s_waitcnt lgkmcnt(0)
s_barrier
Mvaa 172,252,60
s_add_u32 m0, s57, 0
Mvaa 176,224,0
buffer_load_dwordx4 v6, s[12:15], s52 offen offset:0 lds
Mvaa 176,228,4
Ta 64,14,0
Ta 66,14,2048
Mvaa 180,232,0
Mvaa 180,236,4
Ra 240,10,12288
Mvaa 184,224,8
buffer_load_dwordx4 v7, s[12:15], s53 offen offset:1024 lds
Mvaa 184,228,12
Ta 68,14,16384
Ta 70,14,18432
Mvaa 188,232,8
Mvaa 188,236,12
Ra 244,11,12288
Mvaa 192,224,16
buffer_load_dwordx4 v6, s[12:15], s54 offen offset:2048 lds
Mvaa 192,228,20
Ta 72,15,0
Ta 74,15,2048
Mvaa 196,232,16
Mvaa 196,236,20
Ra 248,10,14336
Mvaa 200,224,24
buffer_load_dwordx4 v7, s[12:15], s55 offen offset:3072 lds
Mvaa 200,228,28
Ta 76,15,16384
Ta 78,15,18432
Mvaa 204,232,24
Mvaa 204,236,28
s_add_u32 m0, s57, 4096
Ra 252,11,14336
Mvaa 208,224,32
buffer_load_dwordx4 v8, s[12:15], s52 offen offset:0 lds
Mvaa 208,228,36
Mvaa 212,232,32
Mvaa 212,236,36
Ta 80,24,0
Ta 82,24,2048
Mvaa 216,224,40
buffer_load_dwordx4 v9, s[12:15], s53 offen offset:1024 lds
Mvaa 216,228,44
Ta 84,24,16384
s_waitcnt lgkmcnt(9)
Ta 86,24,18432
Mvaa 220,232,40
Mvaa 220,236,44
Ta 88,25,0
Ta 90,25,2048
Mvaa 224,224,48
buffer_load_dwordx4 v8, s[12:15], s54 offen offset:2048 lds
Mvaa 224,228,52
Mvaa 228,232,48
Mvaa 228,236,52
Ta 92,25,16384
Ta 94,25,18432
Mvaa 232,224,56
buffer_load_dwordx4 v9, s[12:15], s55 offen offset:3072 lds
Mvaa 232,228,60
s_waitcnt vmcnt(11)
Ta 96,26,0
s_waitcnt lgkmcnt(9)
Ta 98,26,2048
Mvaa 236,232,56
s_barrier
v_xor_b32 v6, 524288, v6
v_xor_b32 v7, 524288, v7
Mvaa 236,236,60
s_add_u32 m0, s56, 0
Ta 100,26,16384
Ta 102,26,18432
Mvaa 240,240,0
buffer_load_dwordx4 v2, s[8:11], s48 offen offset:0 lds
Mvaa 240,244,4
v_xor_b32 v8, 524288, v8
v_xor_b32 v9, 524288, v9
Mvaa 244,248,0
Mvaa 244,252,4
Ra 224,12,0
Mvaa 248,240,8
buffer_load_dwordx4 v3, s[8:11], s49 offen offset:1024 lds
Mvaa 248,244,12
Ta 104,27,0
Ta 106,27,2048
Mvaa 252,248,8
Mvaa 252,252,12
s_waitcnt lgkmcnt(9)
Ra 228,13,0
Maaa 128,240,16
buffer_load_dwordx4 v2, s[8:11], s50 offen offset:2048 lds
Maaa 128,244,20
Ta 108,27,16384
Ta 110,27,18432
Maaa 132,248,16
Maaa 132,252,20
Ra 232,12,2048
Maaa 136,240,24
buffer_load_dwordx4 v3, s[8:11], s51 offen offset:3072 lds
Maaa 136,244,28
Ta 112,28,0
Ta 114,28,2048
Maaa 140,248,24
Maaa 140,252,28
s_add_u32 m0, s56, 4096
s_waitcnt lgkmcnt(9)
Ra 236,13,2048
Maaa 144,240,32
buffer_load_dwordx4 v4, s[8:11], s48 offen offset:0 lds
Maaa 144,244,36
Maaa 148,248,32
Maaa 148,252,36
Ta 116,28,16384
Ta 118,28,18432
Maaa 152,240,40
buffer_load_dwordx4 v5, s[8:11], s49 offen offset:1024 lds
Maaa 152,244,44
Ta 120,29,0
Ta 122,29,2048
Maaa 156,248,40
Maaa 156,252,44
Ta 124,29,16384
s_waitcnt lgkmcnt(9)
Ta 126,29,18432
Maaa 160,240,48
buffer_load_dwordx4 v4, s[8:11], s50 offen offset:2048 lds
Maaa 160,244,52
Maaa 164,248,48
Maaa 164,252,52
Maaa 168,240,56
buffer_load_dwordx4 v5, s[8:11], s51 offen offset:3072 lds
Maaa 168,244,60
v_xor_b32 v2, 128, v2
v_xor_b32 v3, 128, v3
Maaa 172,248,56
s_waitcnt lgkmcnt(6)
buffer_load_dword v1, v47, s[60:63], 0 offen
v_xor_b32 v4, 128, v4
v_xor_b32 v5, 128, v5
Maaa 172,252,60
s_waitcnt lgkmcnt(0)
s_mul_i32 vcc_lo, s59, 7
v_xor_b32 v47, vcc_lo, v47
Mvaa 48,224,64
buffer_load_dword v44, v45, s[16:19], s47 offen
Mvaa 48,228,68
s_add_u32 s47, s47, 2097152
v_lshrrev_b32 v32, 4, v0
v_and_b32 v33, 15, v0
Mvaa 52,232,64
s_lshl_b32 s3, s32, 4
v_add_u32 v34, s3, v32
v_lshlrev_b32_e64 v36, 1, v32
Mvaa 52,236,68
Ra 240,12,4096
Mvaa 56,224,72
v_xor_b32 v36, v36, v33
v_xor_b32 v37, 8, v36
Mvaa 56,228,76
Mvaa 60,232,72
Mvaa 60,236,76
Ra 244,13,4096
Mvaa 64,224,80
s_getpc_b64 s[6:7]
L_cpf3:
s_add_u32 s6, s6, (L_phase2-L_cpf3)&0xffffffff
s_addc_u32 s7, s7, ((L_phase2-L_cpf3)>>32)&0xffffffff
Mvaa 64,228,84
s_lshr_b32 s3, s2, 3
s_lshl_b32 s3, s3, 2
s_add_u32 s3, s3, s32
Mvaa 68,232,80
s_lshl_b32 s3, s3, 10
v_and_b32 v42, 7, v0
v_lshlrev_b32_e64 v42, 7, v42
Mvaa 68,236,84
Ra 248,12,6144
Mvaa 72,224,88
v_add_u32_e64 v42, s3, v42
v_min_u32 v42, L_k2_fin-L_phase2-4, v42
Mvaa 72,228,92
v_mov_b32_e64 v41, s7
Mvaa 76,232,88
v_add_co_u32 v40, vcc, s6, v42
s_nop 1
v_addc_co_u32 v41, vcc, 0, v41, vcc
Mvaa 76,236,92
Ra 252,13,6144
Mvaa 80,224,96
global_load_dword v38, v[40:41], off
Mvaa 80,228,100
Mvaa 84,232,96
Mvaa 84,236,100
Mvaa 88,224,104
Mvaa 88,228,108
Mvaa 92,232,104
Mvaa 92,236,108
Mvaa 96,224,112
Mvaa 96,228,116
Mvaa 100,232,112
Mvaa 100,236,116
Mvaa 104,224,120
Mvaa 104,228,124
Mvaa 108,232,120
s_waitcnt lgkmcnt(0)
Mvaa 108,236,124
Mvaa 112,240,64
Mvaa 112,244,68
Mvaa 116,248,64
Mvaa 116,252,68
Ra 224,12,8192
Mvaa 120,240,72
Mvaa 120,244,76
Mvaa 124,248,72
Mvaa 124,252,76
Ra 228,13,8192
Mvaa 128,240,80
Mvaa 128,244,84
Mvaa 132,248,80
Mvaa 132,252,84
Ra 232,12,10240
Mvaa 136,240,88
Mvaa 136,244,92
Mvaa 140,248,88
Mvaa 140,252,92
Ra 236,13,10240
Mvaa 144,240,96
Mvaa 144,244,100
Mvaa 148,248,96
Mvaa 148,252,100
Mvaa 152,240,104
Mvaa 152,244,108
Mvaa 156,248,104
Mvaa 156,252,108
Mvaa 160,240,112
Mvaa 160,244,116
Mvaa 164,248,112
Mvaa 164,252,116
Mvaa 168,240,120
Mvaa 168,244,124
s_waitcnt vmcnt(11)
Mvaa 172,248,120
s_waitcnt lgkmcnt(0)
s_barrier
Mvaa 172,252,124
s_add_u32 m0, s57, 65536
Mvaa 176,224,64
buffer_load_dwordx4 v6, s[12:15], s52 offen offset:0 lds
Mvaa 176,228,68
Ta 0,16,0
Ta 2,16,2048
Mvaa 180,232,64
Mvaa 180,236,68
Ra 240,12,12288
Mvaa 184,224,72
buffer_load_dwordx4 v7, s[12:15], s53 offen offset:1024 lds
Mvaa 184,228,76
Ta 4,16,16384
Ta 6,16,18432
Mvaa 188,232,72
Mvaa 188,236,76
Ra 244,13,12288
Mvaa 192,224,80
buffer_load_dwordx4 v6, s[12:15], s54 offen offset:2048 lds
Mvaa 192,228,84
Ta 8,17,0
Ta 10,17,2048
Mvaa 196,232,80
Mvaa 196,236,84
Ra 248,12,14336
Mvaa 200,224,88
buffer_load_dwordx4 v7, s[12:15], s55 offen offset:3072 lds
Mvaa 200,228,92
Ta 12,17,16384
Ta 14,17,18432
Mvaa 204,232,88
Mvaa 204,236,92
s_add_u32 m0, s57, 69632
Ra 252,13,14336
Mvaa 208,224,96
buffer_load_dwordx4 v8, s[12:15], s52 offen offset:0 lds
Mvaa 208,228,100
Mvaa 212,232,96
Mvaa 212,236,100
Ta 16,18,0
Ta 18,18,2048
Mvaa 216,224,104
buffer_load_dwordx4 v9, s[12:15], s53 offen offset:1024 lds
Mvaa 216,228,108
Ta 20,18,16384
s_waitcnt lgkmcnt(9)
Ta 22,18,18432
Mvaa 220,232,104
Mvaa 220,236,108
Ta 24,19,0
Ta 26,19,2048
Mvaa 224,224,112
buffer_load_dwordx4 v8, s[12:15], s54 offen offset:2048 lds
Mvaa 224,228,116
Mvaa 228,232,112
Mvaa 228,236,116
Ta 28,19,16384
Ta 30,19,18432
Mvaa 232,224,120
buffer_load_dwordx4 v9, s[12:15], s55 offen offset:3072 lds
Mvaa 232,228,124
s_waitcnt vmcnt(11)
Ta 32,20,0
s_waitcnt lgkmcnt(9)
Ta 34,20,2048
Mvaa 236,232,120
s_barrier
Mvaa 236,236,124
s_add_u32 m0, s56, 65536
Ta 36,20,16384
Ta 38,20,18432
Mvaa 240,240,64
buffer_load_dwordx4 v2, s[8:11], s48 offen offset:0 lds
Mvaa 240,244,68
Mvaa 244,248,64
Mvaa 244,252,68
Ra 224,10,0
Mvaa 248,240,72
buffer_load_dwordx4 v3, s[8:11], s49 offen offset:1024 lds
Mvaa 248,244,76
Ta 40,21,0
Ta 42,21,2048
Mvaa 252,248,72
Mvaa 252,252,76
s_waitcnt lgkmcnt(9)
Ra 228,11,0
Maaa 128,240,80
buffer_load_dwordx4 v2, s[8:11], s50 offen offset:2048 lds
Maaa 128,244,84
Ta 44,21,16384
Ta 46,21,18432
Maaa 132,248,80
Maaa 132,252,84
Ra 232,10,2048
Maaa 136,240,88
buffer_load_dwordx4 v3, s[8:11], s51 offen offset:3072 lds
Maaa 136,244,92
Ta 48,22,0
Ta 50,22,2048
Maaa 140,248,88
Maaa 140,252,92
s_add_u32 m0, s56, 69632
s_waitcnt lgkmcnt(9)
Ra 236,11,2048
Maaa 144,240,96
buffer_load_dwordx4 v4, s[8:11], s48 offen offset:0 lds
Maaa 144,244,100
Maaa 148,248,96
Maaa 148,252,100
Ta 52,22,16384
Ta 54,22,18432
Maaa 152,240,104
buffer_load_dwordx4 v5, s[8:11], s49 offen offset:1024 lds
Maaa 152,244,108
Ta 56,23,0
Ta 58,23,2048
Maaa 156,248,104
Maaa 156,252,108
Ta 60,23,16384
s_waitcnt lgkmcnt(9)
Ta 62,23,18432
Maaa 160,240,112
buffer_load_dwordx4 v4, s[8:11], s50 offen offset:2048 lds
Maaa 160,244,116
Maaa 164,248,112
Maaa 164,252,116
Maaa 168,240,120
buffer_load_dwordx4 v5, s[8:11], s51 offen offset:3072 lds
Maaa 168,244,124
Maaa 172,248,120
s_waitcnt lgkmcnt(6)
Maaa 172,252,124
s_waitcnt lgkmcnt(0)
Mvaa 48,224,0
buffer_load_dword v1, v31, s[28:31], s37 offen sc1
Mvaa 48,228,4
s_mov_b32 s8, s16
s_mov_b32 s9, s17
s_mov_b32 s10, s18
Mvaa 52,232,0
s_add_u32 s16, s66, 46137344
s_addc_u32 s17, s67, 0
s_and_b32 s17, s17, 0xffff
Mvaa 52,236,4
Ra 240,10,4096
Mvaa 56,224,8
s_mov_b32 s18, 16777216
s_mov_b32 s19, 0x20000
s_mov_b32 s48, 0
Mvaa 56,228,12
s_mov_b32 s49, 31744
s_mov_b32 s50, 63488
s_mov_b32 s51, 95232
Mvaa 60,232,8
v_lshlrev_b32 v35, 13, v34
Mvaa 60,236,12
Ra 244,11,4096
Mvaa 64,224,16
s_and_b32 s52, s33, 0
s_lshl_b32 s3, s52, 19
s_lshl_b32 s52, s52, 11
Mvaa 64,228,20
s_add_u32 s53, s52, s58
v_add_u32_e64 v35, s3, v35
v_lshl_add_u32 v8, v36, 4, v35
Mvaa 68,232,16
v_lshl_add_u32 v9, v37, 4, v35
v_lshlrev_b32_e64 v2, 4, v0
Mvaa 68,236,20
Ra 248,10,6144
Mvaa 72,224,24
v_add_u32 v3, 65536, v2
v_add_u32_e64 v4, s44, v2
Mvaa 72,228,28
v_mov_b32 v7, 0
v_lshlrev_b32 v35, 2, v32
Mvaa 76,232,24
v_sub_u32_e64 v35, v33, v35
Mvaa 76,236,28
Ra 252,11,6144
Mvaa 80,224,32
s_lshl_b32 s3, s32, 4
v_add_u32 v5, s3, v35
Mvaa 80,228,36
s_sub_u32 s3, 48, s3
v_add_u32 v6, s3, v35
Mvaa 84,232,32
s_mul_i32 s3, s33, 1116160
s_add_u32 s3, s3, 8388608
s_add_u32 s12, s66, s3
s_addc_u32 s13, s67, 0
s_and_b32 s13, s13, 0xffff
Mvaa 84,236,36
s_mov_b32 s14, 0
s_mov_b32 s15, 0x20000
s_mul_i32 s14, s36, 34816
Mvaa 88,224,40
buffer_load_dword v44, v45, s[8:11], s47 offen
Mvaa 88,228,44
s_add_u32 s47, s47, 2097152
v_lshrrev_b32 v42, 2, v33
v_lshl_add_u32 v43, v32, 3, v42
Mvaa 92,232,40
v_lshlrev_b32 v43, 8, v43
v_and_b32 v46, 3, v0
Mvaa 92,236,44
v_lshl_add_u32 v43, v46, 3, v43
v_and_b32_e64 v46, 1, v32
Mvaa 96,224,48
v_lshl_add_u32 v42, v46, 2, v42
v_lshl_add_u32 v16, v42, 5, v43
Mvaa 96,228,52
v_xor_b32 v17, 32, v16
v_xor_b32 v18, 64, v16
Mvaa 100,232,48
v_xor_b32 v19, 96, v16
v_xor_b32 v20, 128, v16
Mvaa 100,236,52
v_xor_b32 v21, 160, v16
v_xor_b32 v22, 192, v16
Mvaa 104,224,56
v_xor_b32 v23, 224, v16
Mvaa 104,228,60
Mvaa 108,232,56
s_waitcnt lgkmcnt(0)
Mvaa 108,236,60
Mvaa 112,240,0
Mvaa 112,244,4
Mvaa 116,248,0
Mvaa 116,252,4
Ra 224,10,8192
Mvaa 120,240,8
Mvaa 120,244,12
Mvaa 124,248,8
Mvaa 124,252,12
Ra 228,11,8192
Mvaa 128,240,16
Mvaa 128,244,20
Mvaa 132,248,16
Mvaa 132,252,20
Ra 232,10,10240
Mvaa 136,240,24
Mvaa 136,244,28
Mvaa 140,248,24
Mvaa 140,252,28
Ra 236,11,10240
Mvaa 144,240,32
Mvaa 144,244,36
Mvaa 148,248,32
Mvaa 148,252,36
Mvaa 152,240,40
Mvaa 152,244,44
Mvaa 156,248,40
Mvaa 156,252,44
Mvaa 160,240,48
Mvaa 160,244,52
Mvaa 164,248,48
Mvaa 164,252,52
Mvaa 168,240,56
Mvaa 168,244,60
s_waitcnt vmcnt(10)
Mvaa 172,248,56
s_waitcnt lgkmcnt(0)
s_barrier
Mvaa 172,252,60
s_add_u32 m0, s44, 0
Mvaa 176,224,0
buffer_load_dwordx4 v8, s[8:11], s48 offen offset:0 lds
Mvaa 176,228,4
Ta 64,14,0
Ta 66,14,2048
Mvaa 180,232,0
Mvaa 180,236,4
Ra 240,10,12288
Mvaa 184,224,8
buffer_load_dwordx4 v8, s[8:11], s49 offen offset:1024 lds
Mvaa 184,228,12
Ta 68,14,16384
Ta 70,14,18432
Mvaa 188,232,8
Mvaa 188,236,12
Ra 244,11,12288
Mvaa 192,224,16
buffer_load_dwordx4 v9, s[8:11], s50 offen offset:2048 lds
Mvaa 192,228,20
Ta 72,15,0
Ta 74,15,2048
Mvaa 196,232,16
Mvaa 196,236,20
Ra 248,10,14336
Mvaa 200,224,24
buffer_load_dwordx4 v9, s[8:11], s51 offen offset:3072 lds
Mvaa 200,228,28
Ta 76,15,16384
Ta 78,15,18432
Mvaa 204,232,24
v_xor_b32 v8, 524288, v8
v_xor_b32 v9, 524288, v9
Mvaa 204,236,28
s_add_u32 m0, s44, 16384
Ra 252,11,14336
Mvaa 208,224,32
buffer_load_dwordx4 v8, s[8:11], s48 offen offset:0 lds
Mvaa 208,228,36
Mvaa 212,232,32
Mvaa 212,236,36
Ta 80,24,0
Ta 82,24,2048
Mvaa 216,224,40
buffer_load_dwordx4 v8, s[8:11], s49 offen offset:1024 lds
Mvaa 216,228,44
Ta 84,24,16384
s_waitcnt lgkmcnt(9)
Ta 86,24,18432
Mvaa 220,232,40
Mvaa 220,236,44
Ta 88,25,0
Ta 90,25,2048
Mvaa 224,224,48
buffer_load_dwordx4 v9, s[8:11], s50 offen offset:2048 lds
Mvaa 224,228,52
Mvaa 228,232,48
s_mul_i32 s3, s45, 33792
v_add_u32_e64 v10, s3, v2
Mvaa 228,236,52
Ta 92,25,16384
Ta 94,25,18432
Mvaa 232,224,56
buffer_load_dwordx4 v9, s[8:11], s51 offen offset:3072 lds
Mvaa 232,228,60
s_waitcnt vmcnt(10)
Ta 96,26,0
s_waitcnt lgkmcnt(9)
Ta 98,26,2048
Mvaa 236,232,56
s_barrier
v_xor_b32 v8, 1572864, v8
v_xor_b32 v9, 1572864, v9
Mvaa 236,236,60
s_add_u32 m0, s44, 32768
Ta 100,26,16384
Ta 102,26,18432
Mvaa 240,240,0
buffer_load_dwordx4 v8, s[8:11], s48 offen offset:0 lds
Mvaa 240,244,4
s_mul_i32 s3, s46, 33792
v_add_u32 v11, s3, v2
Mvaa 244,248,0
Mvaa 244,252,4
Ra 224,12,0
Mvaa 248,240,8
buffer_load_dwordx4 v8, s[8:11], s49 offen offset:1024 lds
Mvaa 248,244,12
Ta 104,27,0
Ta 106,27,2048
Mvaa 252,248,8
Mvaa 252,252,12
s_waitcnt lgkmcnt(9)
Ra 228,13,0
Maaa 128,240,16
buffer_load_dwordx4 v9, s[8:11], s50 offen offset:2048 lds
Maaa 128,244,20
Ta 108,27,16384
Ta 110,27,18432
Maaa 132,248,16
Maaa 132,252,20
Ra 232,12,2048
Maaa 136,240,24
buffer_load_dwordx4 v9, s[8:11], s51 offen offset:3072 lds
Maaa 136,244,28
Ta 112,28,0
Ta 114,28,2048
Maaa 140,248,24
v_xor_b32 v8, 524288, v8
v_xor_b32 v9, 524288, v9
Maaa 140,252,28
s_add_u32 m0, s44, 49152
s_waitcnt lgkmcnt(9)
Ra 236,13,2048
Maaa 144,240,32
buffer_load_dwordx4 v8, s[8:11], s48 offen offset:0 lds
Maaa 144,244,36
Maaa 148,248,32
Maaa 148,252,36
Ta 116,28,16384
Ta 118,28,18432
Maaa 152,240,40
buffer_load_dwordx4 v8, s[8:11], s49 offen offset:1024 lds
Maaa 152,244,44
Ta 120,29,0
Ta 122,29,2048
Maaa 156,248,40
Maaa 156,252,44
Ta 124,29,16384
s_waitcnt lgkmcnt(9)
Ta 126,29,18432
Maaa 160,240,48
buffer_load_dwordx4 v9, s[8:11], s50 offen offset:2048 lds
Maaa 160,244,52
Maaa 164,248,48
Maaa 164,252,52
Maaa 168,240,56
buffer_load_dwordx4 v9, s[8:11], s51 offen offset:3072 lds
Maaa 168,244,60
v_xor_b32 v8, 3670016, v8
v_xor_b32 v9, 3670016, v9
Maaa 172,248,56
s_waitcnt lgkmcnt(6)
Maaa 172,252,60
s_waitcnt lgkmcnt(0)
Mvaa 48,224,64
v_mov_b32 v14, v40
v_mov_b32_e64 v15, v41
Mvaa 48,228,68
Mvaa 52,232,64
Mvaa 52,236,68
Ra 240,12,4096
Mvaa 56,224,72
Mvaa 56,228,76
Mvaa 60,232,72
Mvaa 60,236,76
Ra 244,13,4096
Mvaa 64,224,80
Vc 24,48,49
Vc 25,50,51
Mvaa 64,228,84
Vc 26,52,53
Vc 27,54,55
Mvaa 68,232,80
Mvaa 68,236,84
Ra 248,12,6144
Mvaa 72,224,88
Vc 28,56,57
Vc 29,58,59
Mvaa 72,228,92
Vc 30,60,61
Vc 31,62,63
Mvaa 76,232,88
Mvaa 76,236,92
Ra 252,13,6144
Mvaa 80,224,96
Vc 32,64,65
Vc 33,66,67
Mvaa 80,228,100
Vc 34,68,69
Vc 35,70,71
Mvaa 84,232,96
Mvaa 84,236,100
Mvaa 88,224,104
Vc 36,72,73
Vc 37,74,75
Mvaa 88,228,108
Vc 38,76,77
Vc 39,78,79
Mvaa 92,232,104
Mvaa 92,236,108
Mvaa 96,224,112
Vc 40,80,81
Vc 41,82,83
Mvaa 96,228,116
Vc 42,84,85
Vc 43,86,87
Mvaa 100,232,112
s_waitcnt vmcnt(12)
Mvaa 100,236,116
s_add_u32 s59, s38, 0
Mvaa 104,224,120
v_readfirstlane_b32 s3, v1
s_nop 0
s_or_b32 s3, s3, s37
s_cmp_lt_u32 s3, 256
s_cbranch_scc1 L_spinAv
L_spinArv:
s_barrier
Mvaa 104,228,124
buffer_store_dwordx4 v[24:27], v2, s[24:27], s59 offen offset:0 sc1
Mvaa 108,232,120
s_waitcnt lgkmcnt(0)
Mvaa 108,236,124
Vc 44,88,89
Vc 45,90,91
Mvaa 112,240,64
buffer_load_dwordx4 a[0:3], v10, s[20:23], s53 offen offset:0 sc1
Mvaa 112,244,68
Vc 46,92,93
Vc 47,94,95
Mvaa 116,248,64
Vc 48,96,97
Vc 49,98,99
Mvaa 116,252,68
Ra 224,12,8192
Mvaa 120,240,72
Vc 50,100,101
Vc 51,102,103
Mvaa 120,244,76
Vc 52,104,105
Vc 53,106,107
Mvaa 124,248,72
buffer_load_dwordx4 a[4:7], v10, s[20:23], s52 offen offset:0 sc1
Mvaa 124,252,76
Ra 228,13,8192
Mvaa 128,240,80
Vc 54,108,109
Vc 55,110,111
Mvaa 128,244,84
Vc 56,112,113
Vc 57,114,115
Mvaa 132,248,80
Vc 58,116,117
Vc 59,118,119
Mvaa 132,252,84
Ra 232,12,10240
Mvaa 136,240,88
buffer_load_dwordx4 a[8:11], v11, s[20:23], s53 offen offset:0 sc1
Mvaa 136,244,92
buffer_store_dwordx4 v[28:31], v2, s[24:27], s59 offen offset:1024 sc1
Mvaa 140,248,88
Vc 60,120,121
Vc 61,122,123
Mvaa 140,252,92
Ra 236,13,10240
Mvaa 144,240,96
Vc 62,124,125
Vc 63,126,127
Mvaa 144,244,100
Vc 64,128,129
Vc 65,130,131
Mvaa 148,248,96
buffer_load_dwordx4 a[12:15], v11, s[20:23], s52 offen offset:0 sc1
Mvaa 148,252,100
Vc 66,132,133
Vc 67,134,135
Mvaa 152,240,104
Vc 68,136,137
Vc 69,138,139
Mvaa 152,244,108
Vc 70,140,141
Vc 71,142,143
Mvaa 156,248,104
Mvaa 156,252,108
Mvaa 160,240,112
buffer_load_dwordx4 a[16:19], v10, s[20:23], s53 offen offset:1024 sc1
Mvaa 160,244,116
Vc 72,144,145
Vc 73,146,147
Mvaa 164,248,112
Vc 74,148,149
Vc 75,150,151
Mvaa 164,252,116
buffer_store_dwordx4 v[32:35], v2, s[24:27], s59 offen offset:2048 sc1
Mvaa 168,240,120
Vc 76,152,153
Vc 77,154,155
Mvaa 168,244,124
Vc 78,156,157
Vc 79,158,159
Mvaa 172,248,120
s_waitcnt lgkmcnt(0)
buffer_load_dwordx4 a[20:23], v10, s[20:23], s52 offen offset:1024 sc1
Mvaa 172,252,124
Mvaa 176,224,64
Vc 80,160,161
Vc 81,162,163
Mvaa 176,228,68
Vc 82,164,165
Vc 83,166,167
Mvaa 180,232,64
Mvaa 180,236,68
Ra 240,12,12288
Mvaa 184,224,72
buffer_load_dwordx4 a[24:27], v11, s[20:23], s53 offen offset:1024 sc1
Mvaa 184,228,76
Vc 84,168,169
Vc 85,170,171
Mvaa 188,232,72
Vc 86,172,173
Vc 87,174,175
Mvaa 188,236,76
Ra 244,13,12288
Mvaa 192,224,80
Vc 88,176,177
Vc 89,178,179
Mvaa 192,228,84
Vc 90,180,181
Vc 91,182,183
Mvaa 196,232,80
buffer_load_dwordx4 a[28:31], v11, s[20:23], s52 offen offset:1024 sc1
Mvaa 196,236,84
Ra 248,12,14336
s_xor_b32 s52, s52, 2048
Mvaa 200,224,88
s_add_u32 s53, s52, s58
Mvaa 200,228,92
Vc 92,184,185
Vc 93,186,187
Mvaa 204,232,88
Vc 94,188,189
Vc 95,190,191
Mvaa 204,236,92
Ra 252,13,14336
Mvaa 208,224,96
buffer_load_dwordx4 a[32:35], v10, s[20:23], s53 offen offset:0 sc1
Mvaa 208,228,100
buffer_store_dwordx4 v[36:39], v2, s[24:27], s59 offen offset:3072 sc1
Mvaa 212,232,96
Vc 96,192,193
Vc 97,194,195
Mvaa 212,236,100
Vc 98,196,197
Vc 99,198,199
Mvaa 216,224,104
Vc 100,200,201
Vc 101,202,203
Mvaa 216,228,108
Vc 102,204,205
Vc 103,206,207
Mvaa 220,232,104
buffer_load_dwordx4 a[36:39], v10, s[20:23], s52 offen offset:0 sc1
Mvaa 220,236,108
Mvaa 224,224,112
Vc 104,208,209
Vc 105,210,211
Mvaa 224,228,116
Vc 106,212,213
Vc 107,214,215
Mvaa 228,232,112
Mvaa 228,236,116
Mvaa 232,224,120
buffer_load_dwordx4 a[40:43], v11, s[20:23], s53 offen offset:0 sc1
Mvaa 232,228,124
Vc 108,216,217
Vc 109,218,219
Mvaa 236,232,120
s_waitcnt lgkmcnt(0)
Mvaa 236,236,124
Vc 110,220,221
Vc 111,222,223
Mvaa 240,240,64
s_add_u32 s59, s38, 4096
Mvaa 240,244,68
buffer_store_dwordx4 v[40:43], v2, s[24:27], s59 offen offset:0 sc1
Mvaa 244,248,64
buffer_load_dwordx4 a[44:47], v11, s[20:23], s52 offen offset:0 sc1
Mvaa 244,252,68
Vc 112,224,225
Vc 113,226,227
Mvaa 248,240,72
Vc 114,228,229
Vc 115,230,231
Mvaa 248,244,76
Vc 116,232,233
Vc 117,234,235
Mvaa 252,248,72
Vc 118,236,237
Vc 119,238,239
Mvaa 252,252,76
Maaa 128,240,80
buffer_load_dwordx4 a[48:51], v10, s[20:23], s53 offen offset:1024 sc1
Maaa 128,244,84
Ta 192,16,0
Ta 194,16,1024
Maaa 132,248,80
Vc 120,240,241
Vc 121,242,243
Maaa 132,252,84
Ta 196,17,0
Ta 198,17,1024
Maaa 136,240,88
Vc 122,244,245
Vc 123,246,247
Maaa 136,244,92
Ta 200,18,0
Ta 202,18,1024
Maaa 140,248,88
buffer_load_dwordx4 a[52:55], v10, s[20:23], s52 offen offset:1024 sc1
Maaa 140,252,92
Ta 204,19,0
Ta 206,19,1024
Maaa 144,240,96
Vc 124,248,249
Vc 125,250,251
Maaa 144,244,100
Ta 208,20,0
Ta 210,20,1024
Maaa 148,248,96
Vc 126,252,253
Vc 127,254,255
Maaa 148,252,100
Ta 212,21,0
Ta 214,21,1024
Maaa 152,240,104
buffer_load_dwordx4 a[56:59], v11, s[20:23], s53 offen offset:1024 sc1
Maaa 152,244,108
Ta 216,22,0
Ta 218,22,1024
Maaa 156,248,104
buffer_store_dwordx4 v[44:47], v2, s[24:27], s59 offen offset:1024 sc1
Maaa 156,252,108
Ta 220,23,0
s_waitcnt lgkmcnt(9)
Ta 222,23,1024
Maaa 160,240,112
Maaa 160,244,116
Maaa 164,248,112
buffer_load_dwordx4 a[60:63], v11, s[20:23], s52 offen offset:1024 sc1
Maaa 164,252,116
s_xor_b32 s52, s52, 6144
s_add_u32 s53, s52, s58
Maaa 168,240,120
Maaa 168,244,124
Maaa 172,248,120
Maaa 172,252,124
L_phase2:
s_nop 7
s_waitcnt vmcnt(16) lgkmcnt(0)
Zvaa 128,192,0
buffer_store_dwordx4 v[48:51], v2, s[24:27], s59 offen offset:2048 sc1
Zvaa 160,192,4
Ta 224,16,8192
Ta 226,16,9216
Zvaa 192,192,8
buffer_load_dwordx4 a[64:67], v10, s[20:23], s53 offen offset:0 sc1
Zvaa 224,192,12
s_mov_b32 s60, s40
s_and_b32 s61, s41, 0xffff
s_mov_b32 s62, 7340032
Zvaa 132,196,0
Ta 228,17,8192
Ta 230,17,9216
Zvaa 164,196,4
buffer_load_dwordx4 a[68:71], v10, s[20:23], s52 offen offset:0 sc1
Zvaa 196,196,8
s_mov_b32 s63, 0x20000
Zvaa 228,196,12
Ta 232,18,8192
Ta 234,18,9216
Zvaa 136,200,0
global_load_dword v13, v[14:15], off
Zvaa 168,200,4
buffer_load_dwordx4 a[72:75], v11, s[20:23], s53 offen offset:0 sc1
Zvaa 200,200,8
Ta 236,19,8192
Ta 238,19,9216
Zvaa 232,200,12
Zvaa 140,204,0
buffer_load_dwordx4 a[76:79], v11, s[20:23], s52 offen offset:0 sc1
Zvaa 172,204,4
Ta 240,20,8192
Ta 242,20,9216
Zvaa 204,204,8
Zvaa 236,204,12
Zvaa 144,208,0
s_waitcnt lgkmcnt(6)
Ta 244,21,8192
Ta 246,21,9216
Zvaa 176,208,4
buffer_load_dwordx4 a[80:83], v10, s[20:23], s53 offen offset:1024 sc1
Zvaa 208,208,8
Zvaa 240,208,12
Ta 248,22,8192
Ta 250,22,9216
Zvaa 148,212,0
buffer_load_dwordx4 a[84:87], v10, s[20:23], s52 offen offset:1024 sc1
Zvaa 180,212,4
Zvaa 212,212,8
Ta 252,23,8192
Ta 254,23,9216
Zvaa 244,212,12
Zvaa 152,216,0
buffer_load_dwordx4 a[88:91], v11, s[20:23], s53 offen offset:1024 sc1
Zvaa 184,216,4
Zvaa 216,216,8
buffer_load_dwordx4 a[92:95], v11, s[20:23], s52 offen offset:1024 sc1
Zvaa 248,216,12
s_xor_b32 s52, s52, 2048
s_add_u32 s53, s52, s58
Zvaa 156,220,0
buffer_store_dwordx4 v[52:55], v2, s[24:27], s59 offen offset:3072 sc1
Zvaa 188,220,4
Zvaa 220,220,8
s_waitcnt vmcnt(22) lgkmcnt(0)
Zvaa 252,220,12
s_barrier
Mvaa 128,224,16
Mvaa 160,224,20
s_add_u32 m0, s44, 0
Ta 192,16,16384
Ta 194,16,17408
Mvaa 192,224,24
buffer_load_dwordx4 v8, s[8:11], s48 offen offset:0 lds
Mvaa 224,224,28
Mvaa 132,228,16
Ta 196,17,16384
Ta 198,17,17408
Mvaa 164,228,20
Mvaa 196,228,24
buffer_load_dwordx4 v8, s[8:11], s49 offen offset:1024 lds
Mvaa 228,228,28
Ta 200,18,16384
Ta 202,18,17408
Mvaa 136,232,16
Mvaa 168,232,20
Mvaa 200,232,24
Ta 204,19,16384
Ta 206,19,17408
Mvaa 232,232,28
buffer_load_dwordx4 a[96:99], v10, s[20:23], s53 offen offset:0 sc1
Mvaa 140,236,16
Mvaa 172,236,20
Ta 208,20,16384
Ta 210,20,17408
Mvaa 204,236,24
Mvaa 236,236,28
Mvaa 144,240,16
s_waitcnt lgkmcnt(6)
Ta 212,21,16384
Ta 214,21,17408
Mvaa 176,240,20
buffer_load_dwordx4 a[100:103], v10, s[20:23], s52 offen offset:0 sc1
Mvaa 208,240,24
Mvaa 240,240,28
Ta 216,22,16384
Ta 218,22,17408
Mvaa 148,244,16
Mvaa 180,244,20
buffer_load_dwordx4 a[104:107], v11, s[20:23], s53 offen offset:0 sc1
Mvaa 212,244,24
Ta 220,23,16384
Ta 222,23,17408
Mvaa 244,244,28
s_add_u32 s59, s38, 8192
Mvaa 152,248,16
buffer_store_dwordx4 v[56:59], v2, s[24:27], s59 offen offset:0 sc1
Mvaa 184,248,20
buffer_load_dwordx4 a[108:111], v11, s[20:23], s52 offen offset:0 sc1
Mvaa 216,248,24
Ar 48,128
Ar 49,129
Mvaa 248,248,28
Ar 50,130
Ar 51,131
Mvaa 156,252,16
Ar 52,132
Ar 53,133
Mvaa 188,252,20
Ar 54,134
Ar 55,135
Mvaa 220,252,24
s_waitcnt vmcnt(23) lgkmcnt(0)
Vc 24,48,49
Vc 25,50,51
Mvaa 252,252,28
Vc 26,52,53
Vc 27,54,55
Mvaa 128,192,32
Mvaa 160,192,36
Ta 224,16,24576
Ta 226,16,25600
Mvaa 192,192,40
buffer_load_dwordx4 v9, s[8:11], s50 offen offset:2048 lds
Mvaa 224,192,44
Mvaa 132,196,32
Ta 228,17,24576
Ta 230,17,25600
Mvaa 164,196,36
Mvaa 196,196,40
buffer_load_dwordx4 v9, s[8:11], s51 offen offset:3072 lds
Mvaa 228,196,44
Ta 232,18,24576
Ta 234,18,25600
Mvaa 136,200,32
v_xor_b32 v8, 524288, v8
v_xor_b32 v9, 524288, v9
Mvaa 168,200,36
Mvaa 200,200,40
Ta 236,19,24576
Ta 238,19,25600
Mvaa 232,200,44
buffer_load_dwordx4 a[112:115], v10, s[20:23], s53 offen offset:1024 sc1
Mvaa 140,204,32
Mvaa 172,204,36
Ta 240,20,24576
Ta 242,20,25600
Mvaa 204,204,40
Mvaa 236,204,44
Mvaa 144,208,32
s_waitcnt lgkmcnt(6)
Ta 244,21,24576
Ta 246,21,25600
Mvaa 176,208,36
buffer_load_dwordx4 a[116:119], v10, s[20:23], s52 offen offset:1024 sc1
Mvaa 208,208,40
buffer_store_dwordx4 v[60:63], v2, s[24:27], s59 offen offset:1024 sc1
Mvaa 240,208,44
Ta 248,22,24576
Ta 250,22,25600
Mvaa 148,212,32
Ar 48,136
Ar 49,137
Mvaa 180,212,36
buffer_load_dwordx4 a[120:123], v11, s[20:23], s53 offen offset:1024 sc1
Mvaa 212,212,40
Ta 252,23,24576
Ta 254,23,25600
Mvaa 244,212,44
Ar 50,138
Ar 51,139
Mvaa 152,216,32
Ar 52,140
Ar 53,141
Mvaa 184,216,36
buffer_load_dwordx4 a[124:127], v11, s[20:23], s52 offen offset:1024 sc1
Mvaa 216,216,40
s_xor_b32 s52, s52, 14336
s_add_u32 s53, s52, s58
Mvaa 248,216,44
Ar 54,142
Ar 55,143
Mvaa 156,220,32
Vc 28,48,49
Vc 29,50,51
Mvaa 188,220,36
Vc 30,52,53
Vc 31,54,55
Mvaa 220,220,40
s_waitcnt vmcnt(25) lgkmcnt(0)
Mvaa 252,220,44
s_barrier
Mvaa 128,224,48
Mvaa 160,224,52
s_add_u32 m0, s44, 16384
Ta 192,16,32768
Ta 194,16,33792
Mvaa 192,224,56
buffer_load_dwordx4 v8, s[8:11], s48 offen offset:0 lds
Mvaa 224,224,60
Mvaa 132,228,48
Ta 196,17,32768
Ta 198,17,33792
Mvaa 164,228,52
Mvaa 196,228,56
buffer_load_dwordx4 v8, s[8:11], s49 offen offset:1024 lds
Mvaa 228,228,60
Ta 200,18,32768
Ta 202,18,33792
Mvaa 136,232,48
Mvaa 168,232,52
Mvaa 200,232,56
Ta 204,19,32768
Ta 206,19,33792
Mvaa 232,232,60
buffer_load_dwordx4 a[0:3], v10, s[20:23], s53 offen offset:0 sc1
Mvaa 140,236,48
buffer_store_dwordx4 v[64:67], v2, s[24:27], s59 offen offset:2048 sc1
Mvaa 172,236,52
Ta 208,20,32768
Ta 210,20,33792
Mvaa 204,236,56
Ar 48,144
Ar 49,145
Mvaa 236,236,60
Ar 50,146
Ar 51,147
Mvaa 144,240,48
s_waitcnt lgkmcnt(6)
Ta 212,21,32768
Ta 214,21,33792
Mvaa 176,240,52
buffer_load_dwordx4 a[4:7], v10, s[20:23], s52 offen offset:0 sc1
Mvaa 208,240,56
Ar 52,148
Ar 53,149
Mvaa 240,240,60
Ta 216,22,32768
Ta 218,22,33792
Mvaa 148,244,48
Ar 54,150
Ar 55,151
Mvaa 180,244,52
buffer_load_dwordx4 a[8:11], v11, s[20:23], s53 offen offset:0 sc1
Mvaa 212,244,56
Ta 220,23,32768
Ta 222,23,33792
Mvaa 244,244,60
Vc 32,48,49
Vc 33,50,51
Mvaa 152,248,48
Vc 34,52,53
Vc 35,54,55
Mvaa 184,248,52
buffer_load_dwordx4 a[12:15], v11, s[20:23], s52 offen offset:0 sc1
Mvaa 216,248,56
Mvaa 248,248,60
Mvaa 156,252,48
Mvaa 188,252,52
Mvaa 220,252,56
s_waitcnt vmcnt(26) lgkmcnt(0)
Mvaa 252,252,60
Mvaa 128,192,64
Mvaa 160,192,68
Ta 224,16,40960
Ta 226,16,41984
Mvaa 192,192,72
buffer_load_dwordx4 v9, s[8:11], s50 offen offset:2048 lds
Mvaa 224,192,76
Mvaa 132,196,64
Ta 228,17,40960
Ta 230,17,41984
Mvaa 164,196,68
Mvaa 196,196,72
buffer_load_dwordx4 v9, s[8:11], s51 offen offset:3072 lds
Mvaa 228,196,76
Ta 232,18,40960
Ta 234,18,41984
Mvaa 136,200,64
v_xor_b32 v8, 1572864, v8
v_xor_b32 v9, 1572864, v9
Mvaa 168,200,68
buffer_store_dwordx4 v[68:71], v2, s[24:27], s59 offen offset:3072 sc1
Mvaa 200,200,72
Ta 236,19,40960
Ta 238,19,41984
Mvaa 232,200,76
buffer_load_dwordx4 a[16:19], v10, s[20:23], s53 offen offset:1024 sc1
Mvaa 140,204,64
Ar 48,152
Ar 49,153
Mvaa 172,204,68
Ta 240,20,40960
Ta 242,20,41984
Mvaa 204,204,72
Ar 50,154
Ar 51,155
Mvaa 236,204,76
Ar 52,156
Ar 53,157
Mvaa 144,208,64
s_waitcnt lgkmcnt(6)
Ta 244,21,40960
Ta 246,21,41984
Mvaa 176,208,68
buffer_load_dwordx4 a[20:23], v10, s[20:23], s52 offen offset:1024 sc1
Mvaa 208,208,72
Ar 54,158
Ar 55,159
Mvaa 240,208,76
Ta 248,22,40960
Ta 250,22,41984
Mvaa 148,212,64
Vc 36,48,49
Vc 37,50,51
Mvaa 180,212,68
buffer_load_dwordx4 a[24:27], v11, s[20:23], s53 offen offset:1024 sc1
Mvaa 212,212,72
Ta 252,23,40960
Ta 254,23,41984
Mvaa 244,212,76
Vc 38,52,53
Vc 39,54,55
Mvaa 152,216,64
Mvaa 184,216,68
buffer_load_dwordx4 a[28:31], v11, s[20:23], s52 offen offset:1024 sc1
Mvaa 216,216,72
s_xor_b32 s52, s52, 2048
s_add_u32 s53, s52, s58
Mvaa 248,216,76
Mvaa 156,220,64
Mvaa 188,220,68
Mvaa 220,220,72
s_waitcnt vmcnt(29) lgkmcnt(0)
Mvaa 252,220,76
s_barrier
Mvaa 128,224,80
s_add_u32 s59, s38, 12288
Mvaa 160,224,84
s_add_u32 m0, s44, 32768
Ta 192,16,49152
Ta 194,16,50176
Mvaa 192,224,88
buffer_load_dwordx4 v8, s[8:11], s48 offen offset:0 lds
Mvaa 224,224,92
buffer_store_dwordx4 v[72:75], v2, s[24:27], s59 offen offset:0 sc1
Mvaa 132,228,80
Ta 196,17,49152
Ta 198,17,50176
Mvaa 164,228,84
Ar 48,160
Ar 49,161
Mvaa 196,228,88
buffer_load_dwordx4 v8, s[8:11], s49 offen offset:1024 lds
Mvaa 228,228,92
Ta 200,18,49152
Ta 202,18,50176
Mvaa 136,232,80
Ar 50,162
Ar 51,163
Mvaa 168,232,84
Ar 52,164
Ar 53,165
Mvaa 200,232,88
Ta 204,19,49152
Ta 206,19,50176
Mvaa 232,232,92
buffer_load_dwordx4 a[32:35], v10, s[20:23], s53 offen offset:0 sc1
Mvaa 140,236,80
Ar 54,166
Ar 55,167
Mvaa 172,236,84
Ta 208,20,49152
Ta 210,20,50176
Mvaa 204,236,88
Vc 40,48,49
Vc 41,50,51
Mvaa 236,236,92
Vc 42,52,53
Vc 43,54,55
Mvaa 144,240,80
s_waitcnt lgkmcnt(6)
Ta 212,21,49152
Ta 214,21,50176
Mvaa 176,240,84
buffer_load_dwordx4 a[36:39], v10, s[20:23], s52 offen offset:0 sc1
Mvaa 208,240,88
global_load_dword v13, v[14:15], off
Mvaa 240,240,92
Ta 216,22,49152
Ta 218,22,50176
Mvaa 148,244,80
Mvaa 180,244,84
buffer_load_dwordx4 a[40:43], v11, s[20:23], s53 offen offset:0 sc1
Mvaa 212,244,88
Ta 220,23,49152
Ta 222,23,50176
Mvaa 244,244,92
Mvaa 152,248,80
Mvaa 184,248,84
buffer_load_dwordx4 a[44:47], v11, s[20:23], s52 offen offset:0 sc1
Mvaa 216,248,88
Mvaa 248,248,92
buffer_store_dwordx4 v[76:79], v2, s[24:27], s59 offen offset:1024 sc1
Mvaa 156,252,80
Ar 48,168
Ar 49,169
Mvaa 188,252,84
Ar 50,170
Ar 51,171
Mvaa 220,252,88
s_waitcnt vmcnt(30) lgkmcnt(0)
Ar 52,172
Ar 53,173
Mvaa 252,252,92
Ar 54,174
Ar 55,175
Mvaa 128,192,96
Vc 44,48,49
Vc 45,50,51
Mvaa 160,192,100
Ta 224,16,57344
Ta 226,16,58368
Mvaa 192,192,104
buffer_load_dwordx4 v9, s[8:11], s50 offen offset:2048 lds
Mvaa 224,192,108
Vc 46,52,53
Vc 47,54,55
Mvaa 132,196,96
Ta 228,17,57344
Ta 230,17,58368
Mvaa 164,196,100
s_lshl_b32 s3, s32, 11
s_add_u32 s3, s3, 5242880
Mvaa 196,196,104
buffer_load_dwordx4 v9, s[8:11], s51 offen offset:3072 lds
Mvaa 228,196,108
Ta 232,18,57344
Ta 234,18,58368
Mvaa 136,200,96
v_xor_b32 v8, 524288, v8
v_xor_b32 v9, 524288, v9
Mvaa 168,200,100
buffer_load_dwordx4 v[56:59], v2, s[20:23], s3 offen offset:0 sc1
Mvaa 200,200,104
Ta 236,19,57344
Ta 238,19,58368
Mvaa 232,200,108
buffer_load_dwordx4 a[48:51], v10, s[20:23], s53 offen offset:1024 sc1
Mvaa 140,204,96
buffer_load_dwordx4 v[60:63], v2, s[20:23], s3 offen offset:1024 sc1
Mvaa 172,204,100
Ta 240,20,57344
Ta 242,20,58368
Mvaa 204,204,104
Mvaa 236,204,108
Mvaa 144,208,96
s_waitcnt lgkmcnt(6)
Ta 244,21,57344
Ta 246,21,58368
Mvaa 176,208,100
buffer_load_dwordx4 a[52:55], v10, s[20:23], s52 offen offset:1024 sc1
Mvaa 208,208,104
Mvaa 240,208,108
Ta 248,22,57344
Ta 250,22,58368
Mvaa 148,212,96
Mvaa 180,212,100
buffer_load_dwordx4 a[56:59], v11, s[20:23], s53 offen offset:1024 sc1
Mvaa 212,212,104
Ta 252,23,57344
Ta 254,23,58368
Mvaa 244,212,108
buffer_store_dwordx4 v[80:83], v2, s[24:27], s59 offen offset:2048 sc1
Mvaa 152,216,96
Mvaa 184,216,100
buffer_load_dwordx4 a[60:63], v11, s[20:23], s52 offen offset:1024 sc1
Mvaa 216,216,104
s_xor_b32 s52, s52, 6144
s_add_u32 s53, s52, s58
Mvaa 248,216,108
Mvaa 156,220,96
Mvaa 188,220,100
Mvaa 220,220,104
s_waitcnt vmcnt(32) lgkmcnt(0)
Mvaa 252,220,108
s_barrier
Mvaa 128,224,112
Mvaa 160,224,116
s_add_u32 m0, s44, 49152
Ta 192,16,0
Ta 194,16,1024
Mvaa 192,224,120
buffer_load_dwordx4 v8, s[8:11], s48 offen offset:0 lds
Mvaa 224,224,124
Mvaa 132,228,112
Ta 196,17,0
Ta 198,17,1024
Mvaa 164,228,116
Mvaa 196,228,120
buffer_load_dwordx4 v8, s[8:11], s49 offen offset:1024 lds
Mvaa 228,228,124
Ta 200,18,0
Ta 202,18,1024
Mvaa 136,232,112
Mvaa 168,232,116
Mvaa 200,232,120
Ta 204,19,0
Ta 206,19,1024
Mvaa 232,232,124
buffer_load_dwordx4 a[64:67], v10, s[20:23], s53 offen offset:0 sc1
Mvaa 140,236,112
Mvaa 172,236,116
Ta 208,20,0
Ta 210,20,1024
Mvaa 204,236,120
Mvaa 236,236,124
Mvaa 144,240,112
s_waitcnt lgkmcnt(6)
Ta 212,21,0
Ta 214,21,1024
Mvaa 176,240,116
buffer_load_dwordx4 a[68:71], v10, s[20:23], s52 offen offset:0 sc1
Mvaa 208,240,120
buffer_store_dwordx4 v[84:87], v2, s[24:27], s59 offen offset:3072 sc1
Mvaa 240,240,124
Ta 216,22,0
Ta 218,22,1024
Mvaa 148,244,112
Mvaa 180,244,116
buffer_load_dwordx4 a[72:75], v11, s[20:23], s53 offen offset:0 sc1
Mvaa 212,244,120
Ta 220,23,0
Ta 222,23,1024
Mvaa 244,244,124
Mvaa 152,248,112
Mvaa 184,248,116
buffer_load_dwordx4 a[76:79], v11, s[20:23], s52 offen offset:0 sc1
Mvaa 216,248,120
Mvaa 248,248,124
Mvaa 156,252,112
Mvaa 188,252,116
Mvaa 220,252,120
s_waitcnt vmcnt(32) lgkmcnt(0)
Mvaa 252,252,124
Mvaa 128,192,0
Mvaa 160,192,4
Ta 224,16,8192
Ta 226,16,9216
Mvaa 192,192,8
buffer_load_dwordx4 v9, s[8:11], s50 offen offset:2048 lds
Mvaa 224,192,12
Mvaa 132,196,0
Ta 228,17,8192
Ta 230,17,9216
Mvaa 164,196,4
Mvaa 196,196,8
buffer_load_dwordx4 v9, s[8:11], s51 offen offset:3072 lds
Mvaa 228,196,12
Ta 232,18,8192
Ta 234,18,9216
Mvaa 136,200,0
v_xor_b32 v8, 7864320, v8
v_xor_b32 v9, 7864320, v9
Mvaa 168,200,4
Mvaa 200,200,8
Ta 236,19,8192
Ta 238,19,9216
Mvaa 232,200,12
buffer_load_dwordx4 a[80:83], v10, s[20:23], s53 offen offset:1024 sc1
Mvaa 140,204,0
s_add_u32 s59, s38, 34816
Mvaa 172,204,4
Ta 240,20,8192
Ta 242,20,9216
Mvaa 204,204,8
buffer_store_dwordx4 v[88:91], v2, s[24:27], s59 offen offset:0 sc1
Mvaa 236,204,12
Mvaa 144,208,0
s_waitcnt lgkmcnt(6)
Ta 244,21,8192
Ta 246,21,9216
Mvaa 176,208,4
buffer_load_dwordx4 a[84:87], v10, s[20:23], s52 offen offset:1024 sc1
Mvaa 208,208,8
Mvaa 240,208,12
Ta 248,22,8192
Ta 250,22,9216
Mvaa 148,212,0
Mvaa 180,212,4
buffer_load_dwordx4 a[88:91], v11, s[20:23], s53 offen offset:1024 sc1
Mvaa 212,212,8
Ta 252,23,8192
Ta 254,23,9216
Mvaa 244,212,12
Mvaa 152,216,0
Mvaa 184,216,4
buffer_load_dwordx4 a[92:95], v11, s[20:23], s52 offen offset:1024 sc1
Mvaa 216,216,8
s_xor_b32 s52, s52, 2048
s_add_u32 s53, s52, s58
Mvaa 248,216,12
Mvaa 156,220,0
Mvaa 188,220,4
Mvaa 220,220,8
s_waitcnt vmcnt(32) lgkmcnt(0)
Mvaa 252,220,12
s_barrier
Mvaa 128,224,16
Mvaa 160,224,20
s_add_u32 m0, s44, 0
Ta 192,16,16384
Ta 194,16,17408
Mvaa 192,224,24
buffer_load_dwordx4 v8, s[8:11], s48 offen offset:0 lds
Mvaa 224,224,28
Mvaa 132,228,16
Ta 196,17,16384
Ta 198,17,17408
Mvaa 164,228,20
Mvaa 196,228,24
buffer_load_dwordx4 v8, s[8:11], s49 offen offset:1024 lds
Mvaa 228,228,28
Ta 200,18,16384
Ta 202,18,17408
Mvaa 136,232,16
buffer_store_dwordx4 v[92:95], v2, s[24:27], s59 offen offset:1024 sc1
Mvaa 168,232,20
Mvaa 200,232,24
Ta 204,19,16384
Ta 206,19,17408
Mvaa 232,232,28
buffer_load_dwordx4 a[96:99], v10, s[20:23], s53 offen offset:0 sc1
Mvaa 140,236,16
Mvaa 172,236,20
Ta 208,20,16384
Ta 210,20,17408
Mvaa 204,236,24
Mvaa 236,236,28
Mvaa 144,240,16
s_waitcnt lgkmcnt(6)
Ta 212,21,16384
Ta 214,21,17408
Mvaa 176,240,20
buffer_load_dwordx4 a[100:103], v10, s[20:23], s52 offen offset:0 sc1
Mvaa 208,240,24
Mvaa 240,240,28
Ta 216,22,16384
Ta 218,22,17408
Mvaa 148,244,16
Mvaa 180,244,20
buffer_load_dwordx4 a[104:107], v11, s[20:23], s53 offen offset:0 sc1
Mvaa 212,244,24
Ta 220,23,16384
Ta 222,23,17408
Mvaa 244,244,28
Mvaa 152,248,16
Mvaa 184,248,20
buffer_load_dwordx4 a[108:111], v11, s[20:23], s52 offen offset:0 sc1
Mvaa 216,248,24
Mvaa 248,248,28
Mvaa 156,252,16
Mvaa 188,252,20
Mvaa 220,252,24
s_waitcnt vmcnt(31) lgkmcnt(0)
Mvaa 252,252,28
Mvaa 128,192,32
buffer_store_dwordx4 v[96:99], v2, s[24:27], s59 offen offset:2048 sc1
Mvaa 160,192,36
Ta 224,16,24576
Ta 226,16,25600
Mvaa 192,192,40
buffer_load_dwordx4 v9, s[8:11], s50 offen offset:2048 lds
Mvaa 224,192,44
Mvaa 132,196,32
Ta 228,17,24576
Ta 230,17,25600
Mvaa 164,196,36
Mvaa 196,196,40
buffer_load_dwordx4 v9, s[8:11], s51 offen offset:3072 lds
Mvaa 228,196,44
Ta 232,18,24576
Ta 234,18,25600
Mvaa 136,200,32
v_xor_b32 v8, 524288, v8
v_xor_b32 v9, 524288, v9
Mvaa 168,200,36
Mvaa 200,200,40
Ta 236,19,24576
Ta 238,19,25600
Mvaa 232,200,44
buffer_load_dwordx4 a[112:115], v10, s[20:23], s53 offen offset:1024 sc1
Mvaa 140,204,32
Mvaa 172,204,36
Ta 240,20,24576
Ta 242,20,25600
Mvaa 204,204,40
Mvaa 236,204,44
Mvaa 144,208,32
s_waitcnt lgkmcnt(6)
Ta 244,21,24576
Ta 246,21,25600
Mvaa 176,208,36
buffer_load_dwordx4 a[116:119], v10, s[20:23], s52 offen offset:1024 sc1
Mvaa 208,208,40
Mvaa 240,208,44
Ta 248,22,24576
Ta 250,22,25600
Mvaa 148,212,32
Mvaa 180,212,36
buffer_load_dwordx4 a[120:123], v11, s[20:23], s53 offen offset:1024 sc1
Mvaa 212,212,40
Ta 252,23,24576
Ta 254,23,25600
Mvaa 244,212,44
Mvaa 152,216,32
Mvaa 184,216,36
buffer_load_dwordx4 a[124:127], v11, s[20:23], s52 offen offset:1024 sc1
Mvaa 216,216,40
s_xor_b32 s52, s52, 30720
s_add_u32 s53, s52, s58
Mvaa 248,216,44
buffer_store_dwordx4 v[100:103], v2, s[24:27], s59 offen offset:3072 sc1
Mvaa 156,220,32
Mvaa 188,220,36
Mvaa 220,220,40
s_waitcnt vmcnt(29) lgkmcnt(0)
Mvaa 252,220,44
s_barrier
Mvaa 128,224,48
Mvaa 160,224,52
s_add_u32 m0, s44, 16384
Ta 192,16,32768
Ta 194,16,33792
Mvaa 192,224,56
buffer_load_dwordx4 v8, s[8:11], s48 offen offset:0 lds
Mvaa 224,224,60
Mvaa 132,228,48
Ta 196,17,32768
Ta 198,17,33792
Mvaa 164,228,52
Mvaa 196,228,56
buffer_load_dwordx4 v8, s[8:11], s49 offen offset:1024 lds
Mvaa 228,228,60
Ta 200,18,32768
Ta 202,18,33792
Mvaa 136,232,48
Mvaa 168,232,52
Mvaa 200,232,56
Ta 204,19,32768
Ta 206,19,33792
Mvaa 232,232,60
buffer_load_dwordx4 a[0:3], v10, s[20:23], s53 offen offset:0 sc1
Mvaa 140,236,48
Mvaa 172,236,52
Ta 208,20,32768
Ta 210,20,33792
Mvaa 204,236,56
Mvaa 236,236,60
Mvaa 144,240,48
s_waitcnt lgkmcnt(6)
Ta 212,21,32768
Ta 214,21,33792
Mvaa 176,240,52
buffer_load_dwordx4 a[4:7], v10, s[20:23], s52 offen offset:0 sc1
Mvaa 208,240,56
Mvaa 240,240,60
Ta 216,22,32768
Ta 218,22,33792
Mvaa 148,244,48
Mvaa 180,244,52
buffer_load_dwordx4 a[8:11], v11, s[20:23], s53 offen offset:0 sc1
Mvaa 212,244,56
Ta 220,23,32768
Ta 222,23,33792
Mvaa 244,244,60
s_add_u32 s59, s38, 38912
Mvaa 152,248,48
buffer_store_dwordx4 v[104:107], v2, s[24:27], s59 offen offset:0 sc1
Mvaa 184,248,52
buffer_load_dwordx4 a[12:15], v11, s[20:23], s52 offen offset:0 sc1
Mvaa 216,248,56
Mvaa 248,248,60
Mvaa 156,252,48
Mvaa 188,252,52
Mvaa 220,252,56
s_waitcnt vmcnt(29) lgkmcnt(0)
Mvaa 252,252,60
Mvaa 128,192,64
v_max_u32 v14, v56, v57
v_min_u32_e64 v15, v56, v57
Mvaa 160,192,68
Ta 224,16,40960
Ta 226,16,41984
Mvaa 192,192,72
buffer_load_dwordx4 v9, s[8:11], s50 offen offset:2048 lds
Mvaa 224,192,76
v_med3_u32 v15, v14, v15, v58
v_max_u32_e64 v14, v14, v58
Mvaa 132,196,64
Ta 228,17,40960
Ta 230,17,41984
Mvaa 164,196,68
v_med3_u32 v15, v14, v15, v59
v_max_u32_e64 v14, v14, v59
Mvaa 196,196,72
buffer_load_dwordx4 v9, s[8:11], s51 offen offset:3072 lds
Mvaa 228,196,76
Ta 232,18,40960
Ta 234,18,41984
Mvaa 136,200,64
v_xor_b32 v8, 1572864, v8
v_xor_b32 v9, 1572864, v9
Mvaa 168,200,68
v_med3_u32 v15, v14, v15, v60
v_max_u32_e64 v14, v14, v60
Mvaa 200,200,72
Ta 236,19,40960
Ta 238,19,41984
Mvaa 232,200,76
buffer_load_dwordx4 a[16:19], v10, s[20:23], s53 offen offset:1024 sc1
Mvaa 140,204,64
v_med3_u32 v15, v14, v15, v61
v_max_u32_e64 v14, v14, v61
Mvaa 172,204,68
Ta 240,20,40960
Ta 242,20,41984
Mvaa 204,204,72
v_med3_u32 v15, v14, v15, v62
v_max_u32_e64 v14, v14, v62
Mvaa 236,204,76
v_med3_u32 v15, v14, v15, v63
v_max_u32_e64 v14, v14, v63
Mvaa 144,208,64
s_waitcnt lgkmcnt(6)
Ta 244,21,40960
Ta 246,21,41984
Mvaa 176,208,68
buffer_load_dwordx4 a[20:23], v10, s[20:23], s52 offen offset:1024 sc1
Mvaa 208,208,72
buffer_store_dwordx4 v[108:111], v2, s[24:27], s59 offen offset:1024 sc1
Mvaa 240,208,76
Ta 248,22,40960
Ta 250,22,41984
Mvaa 148,212,64
s_lshl_b32 s3, s32, 9
s_add_u32 s3, s3, 131072
v_lshlrev_b32_e64 v13, 3, v0
Mvaa 180,212,68
buffer_load_dwordx4 a[24:27], v11, s[20:23], s53 offen offset:1024 sc1
Mvaa 212,212,72
Ta 252,23,40960
Ta 254,23,41984
Mvaa 244,212,76
v_add_u32_e64 v56, s3, v13
v_add_u32 v13, 131072, v13
Mvaa 152,216,64
ds_write_b64 v56, v[14:15]
Mvaa 184,216,68
buffer_load_dwordx4 a[28:31], v11, s[20:23], s52 offen offset:1024 sc1
Mvaa 216,216,72
s_xor_b32 s52, s52, 2048
s_add_u32 s53, s52, s58
Mvaa 248,216,76
Mvaa 156,220,64
Mvaa 188,220,68
Mvaa 220,220,72
s_waitcnt vmcnt(29) lgkmcnt(0)
Mvaa 252,220,76
s_barrier
Mvaa 128,224,80
Mvaa 160,224,84
s_add_u32 m0, s44, 32768
Ta 192,16,49152
Ta 194,16,50176
Mvaa 192,224,88
buffer_load_dwordx4 v8, s[8:11], s48 offen offset:0 lds
Mvaa 224,224,92
Mvaa 132,228,80
Ta 196,17,49152
Ta 198,17,50176
Mvaa 164,228,84
Mvaa 196,228,88
buffer_load_dwordx4 v8, s[8:11], s49 offen offset:1024 lds
Mvaa 228,228,92
Ta 200,18,49152
Ta 202,18,50176
Mvaa 136,232,80
Mvaa 168,232,84
Mvaa 200,232,88
Ta 204,19,49152
Ta 206,19,50176
Mvaa 232,232,92
buffer_load_dwordx4 a[32:35], v10, s[20:23], s53 offen offset:0 sc1
Mvaa 140,236,80
buffer_store_dwordx4 v[112:115], v2, s[24:27], s59 offen offset:2048 sc1
Mvaa 172,236,84
Ta 208,20,49152
Ta 210,20,50176
Mvaa 204,236,88
Mvaa 236,236,92
Mvaa 144,240,80
s_waitcnt lgkmcnt(6)
Ta 212,21,49152
Ta 214,21,50176
Mvaa 176,240,84
buffer_load_dwordx4 a[36:39], v10, s[20:23], s52 offen offset:0 sc1
Mvaa 208,240,88
Mvaa 240,240,92
Ta 216,22,49152
Ta 218,22,50176
Mvaa 148,244,80
Mvaa 180,244,84
buffer_load_dwordx4 a[40:43], v11, s[20:23], s53 offen offset:0 sc1
Mvaa 212,244,88
Ta 220,23,49152
Ta 222,23,50176
Mvaa 244,244,92
Mvaa 152,248,80
Mvaa 184,248,84
buffer_load_dwordx4 a[44:47], v11, s[20:23], s52 offen offset:0 sc1
Mvaa 216,248,88
Mvaa 248,248,92
Mvaa 156,252,80
Mvaa 188,252,84
Mvaa 220,252,88
s_waitcnt vmcnt(29) lgkmcnt(0)
Mvaa 252,252,92
Mvaa 128,192,96
Mvaa 160,192,100
Ta 224,16,57344
Ta 226,16,58368
Mvaa 192,192,104
buffer_load_dwordx4 v9, s[8:11], s50 offen offset:2048 lds
Mvaa 224,192,108
Mvaa 132,196,96
Ta 228,17,57344
Ta 230,17,58368
Mvaa 164,196,100
Mvaa 196,196,104
buffer_load_dwordx4 v9, s[8:11], s51 offen offset:3072 lds
Mvaa 228,196,108
Ta 232,18,57344
Ta 234,18,58368
Mvaa 136,200,96
v_xor_b32 v8, 524288, v8
v_xor_b32 v9, 524288, v9
Mvaa 168,200,100
buffer_store_dwordx4 v[116:119], v2, s[24:27], s59 offen offset:3072 sc1
Mvaa 200,200,104
Ta 236,19,57344
Ta 238,19,58368
Mvaa 232,200,108
buffer_load_dwordx4 a[48:51], v10, s[20:23], s53 offen offset:1024 sc1
Mvaa 140,204,96
Mvaa 172,204,100
Ta 240,20,57344
Ta 242,20,58368
Mvaa 204,204,104
Mvaa 236,204,108
Mvaa 144,208,96
s_waitcnt lgkmcnt(6)
Ta 244,21,57344
Ta 246,21,58368
Mvaa 176,208,100
buffer_load_dwordx4 a[52:55], v10, s[20:23], s52 offen offset:1024 sc1
Mvaa 208,208,104
Mvaa 240,208,108
Ta 248,22,57344
Ta 250,22,58368
Mvaa 148,212,96
Mvaa 180,212,100
buffer_load_dwordx4 a[56:59], v11, s[20:23], s53 offen offset:1024 sc1
Mvaa 212,212,104
Ta 252,23,57344
Ta 254,23,58368
Mvaa 244,212,108
Mvaa 152,216,96
Mvaa 184,216,100
buffer_load_dwordx4 a[60:63], v11, s[20:23], s52 offen offset:1024 sc1
Mvaa 216,216,104
s_xor_b32 s52, s52, 6144
s_add_u32 s53, s52, s58
Mvaa 248,216,108
Mvaa 156,220,96
Mvaa 188,220,100
Mvaa 220,220,104
s_waitcnt vmcnt(29) lgkmcnt(0)
Mvaa 252,220,108
s_barrier
Mvaa 128,224,112
s_add_u32 s59, s38, 43008
Mvaa 160,224,116
s_add_u32 m0, s44, 49152
Ta 192,16,0
Ta 194,16,1024
Mvaa 192,224,120
buffer_load_dwordx4 v8, s[8:11], s48 offen offset:0 lds
Mvaa 224,224,124
buffer_store_dwordx4 v[120:123], v2, s[24:27], s59 offen offset:0 sc1
Mvaa 132,228,112
Ta 196,17,0
Ta 198,17,1024
Mvaa 164,228,116
ds_read_b64 v[56:57], v13 offset:0
ds_read_b64 v[58:59], v13 offset:512
Mvaa 196,228,120
buffer_load_dwordx4 v8, s[8:11], s49 offen offset:1024 lds
Mvaa 228,228,124
Ta 200,18,0
Ta 202,18,1024
Mvaa 136,232,112
ds_read_b64 v[60:61], v13 offset:1024
ds_read_b64 v[62:63], v13 offset:1536
Mvaa 168,232,116
Mvaa 200,232,120
Ta 204,19,0
Ta 206,19,1024
Mvaa 232,232,124
buffer_load_dwordx4 a[64:67], v10, s[20:23], s53 offen offset:0 sc1
Mvaa 140,236,112
s_waitcnt lgkmcnt(2)
v_max_u32 v14, v56, v57
v_min_u32 v15, v56, v57
Mvaa 172,236,116
Ta 208,20,0
Ta 210,20,1024
Mvaa 204,236,120
v_med3_u32 v15, v14, v15, v58
v_max_u32_e64 v14, v14, v58
Mvaa 236,236,124
v_med3_u32 v15, v14, v15, v59
v_max_u32_e64 v14, v14, v59
Mvaa 144,240,112
s_waitcnt lgkmcnt(6)
Ta 212,21,0
Ta 214,21,1024
Mvaa 176,240,116
buffer_load_dwordx4 a[68:71], v10, s[20:23], s52 offen offset:0 sc1
Mvaa 208,240,120
v_med3_u32 v15, v14, v15, v60
v_max_u32 v14, v14, v60
Mvaa 240,240,124
Ta 216,22,0
Ta 218,22,1024
Mvaa 148,244,112
v_med3_u32 v15, v14, v15, v61
v_max_u32_e64 v14, v14, v61
Mvaa 180,244,116
buffer_load_dwordx4 a[72:75], v11, s[20:23], s53 offen offset:0 sc1
Mvaa 212,244,120
Ta 220,23,0
Ta 222,23,1024
Mvaa 244,244,124
v_med3_u32 v15, v14, v15, v62
v_max_u32_e64 v14, v14, v62
Mvaa 152,248,112
v_med3_u32 v15, v14, v15, v63
v_max_u32_e64 v14, v14, v63
Mvaa 184,248,116
buffer_load_dwordx4 a[76:79], v11, s[20:23], s52 offen offset:0 sc1
Mvaa 216,248,120
v_mov_b32_e64 v13, v14
Mvaa 248,248,124
buffer_store_dwordx4 v[124:127], v2, s[24:27], s59 offen offset:1024 sc1
Mvaa 156,252,112
v_max_u32_dpp v13, v13, v13 quad_perm:[1,0,3,2] row_mask:0xf bank_mask:0xf
Mvaa 188,252,116
Mvaa 220,252,120
s_waitcnt vmcnt(29) lgkmcnt(0)
Mvaa 252,252,124
Mvaa 128,192,0
v_max_u32_dpp v13, v13, v13 quad_perm:[2,3,0,1] row_mask:0xf bank_mask:0xf
Mvaa 160,192,4
Ta 224,16,8192
Ta 226,16,9216
Mvaa 192,192,8
buffer_load_dwordx4 v9, s[8:11], s50 offen offset:2048 lds
Mvaa 224,192,12
v_max_u32_dpp v13, v13, v13 row_half_mirror row_mask:0xf bank_mask:0xf
Mvaa 132,196,0
Ta 228,17,8192
Ta 230,17,9216
Mvaa 164,196,4
v_max_u32_dpp v13, v13, v13 row_mirror row_mask:0xf bank_mask:0xf
Mvaa 196,196,8
buffer_load_dwordx4 v9, s[8:11], s51 offen offset:3072 lds
Mvaa 228,196,12
Ta 232,18,8192
Ta 234,18,9216
Mvaa 136,200,0
v_xor_b32 v8, 3670016, v8
v_xor_b32 v9, 3670016, v9
Mvaa 168,200,4
v_readlane_b32 s3, v13, 0
v_readlane_b32 s47, v13, 16
Mvaa 200,200,8
Ta 236,19,8192
Ta 238,19,9216
Mvaa 232,200,12
buffer_load_dwordx4 a[80:83], v10, s[20:23], s53 offen offset:1024 sc1
Mvaa 140,204,0
v_readlane_b32 s4, v13, 32
v_readlane_b32 s5, v13, 48
Mvaa 172,204,4
Ta 240,20,8192
Ta 242,20,9216
Mvaa 204,204,8
s_max_u32 s3, s3, s47
s_max_u32 s4, s4, s5
s_max_u32 s40, s3, s4
Mvaa 236,204,12
v_cmp_eq_u32 vcc, s40, v14
Mvaa 144,208,0
s_waitcnt lgkmcnt(6)
Ta 244,21,8192
Ta 246,21,9216
Mvaa 176,208,4
buffer_load_dwordx4 a[84:87], v10, s[20:23], s52 offen offset:1024 sc1
Mvaa 208,208,8
v_cndmask_b32 v13, v14, v15, vcc
Mvaa 240,208,12
Ta 248,22,8192
Ta 250,22,9216
Mvaa 148,212,0
v_max_u32_dpp v13, v13, v13 quad_perm:[1,0,3,2] row_mask:0xf bank_mask:0xf
Mvaa 180,212,4
buffer_load_dwordx4 a[88:91], v11, s[20:23], s53 offen offset:1024 sc1
Mvaa 212,212,8
Ta 252,23,8192
Ta 254,23,9216
Mvaa 244,212,12
buffer_store_dwordx4 v[24:27], v2, s[24:27], s59 offen offset:2048 sc1
Mvaa 152,216,0
v_max_u32_dpp v13, v13, v13 quad_perm:[2,3,0,1] row_mask:0xf bank_mask:0xf
Mvaa 184,216,4
buffer_load_dwordx4 a[92:95], v11, s[20:23], s52 offen offset:1024 sc1
Mvaa 216,216,8
s_xor_b32 s52, s52, 2048
s_add_u32 s53, s52, s58
Mvaa 248,216,12
v_max_u32_dpp v13, v13, v13 row_half_mirror row_mask:0xf bank_mask:0xf
Mvaa 156,220,0
s_nop 0
v_max_u32_dpp v13, v13, v13 row_mirror row_mask:0xf bank_mask:0xf
Mvaa 188,220,4
Mvaa 220,220,8
s_waitcnt vmcnt(29) lgkmcnt(0)
Mvaa 252,220,12
s_barrier
Mvaa 128,224,16
v_readlane_b32 s3, v13, 0
v_readlane_b32 s47, v13, 16
Mvaa 160,224,20
s_add_u32 m0, s44, 0
Ta 192,16,16384
Ta 194,16,17408
Mvaa 192,224,24
buffer_load_dwordx4 v8, s[8:11], s48 offen offset:0 lds
Mvaa 224,224,28
v_readlane_b32 s4, v13, 32
v_readlane_b32 s5, v13, 48
Mvaa 132,228,16
Ta 196,17,16384
Ta 198,17,17408
Mvaa 164,228,20
s_max_u32 s3, s3, s47
s_max_u32 s4, s4, s5
s_max_u32 s41, s3, s4
Mvaa 196,228,24
buffer_load_dwordx4 v8, s[8:11], s49 offen offset:1024 lds
Mvaa 228,228,28
Ta 200,18,16384
Ta 202,18,17408
Mvaa 136,232,16
s_and_b32 s3, s40, 0xffff
s_sub_u32 s42, 0xffff, s3
s_and_b32 s3, s41, 0xffff
Mvaa 168,232,20
s_sub_u32 s43, 0xffff, s3
v_mov_b32 v60, s40
v_not_b32_e64 v61, v60
Mvaa 200,232,24
Ta 204,19,16384
Ta 206,19,17408
Mvaa 232,232,28
buffer_load_dwordx4 a[96:99], v10, s[20:23], s53 offen offset:0 sc1
Mvaa 140,236,16
v_ashrrev_i32_e64 v61, 31, v61
v_or_b32 v61, 0x80000000, v61
Mvaa 172,236,20
Ta 208,20,16384
Ta 210,20,17408
Mvaa 204,236,24
v_xor_b32_e64 v60, v60, v61
v_and_b32 v60, 0xffff0000, v60
Mvaa 236,236,28
v_mul_f32 v60, 0xbfb8aa3b, v60
Mvaa 144,240,16
s_waitcnt lgkmcnt(6)
Ta 212,21,16384
Ta 214,21,17408
Mvaa 176,240,20
buffer_load_dwordx4 a[100:103], v10, s[20:23], s52 offen offset:0 sc1
Mvaa 208,240,24
buffer_store_dwordx4 v[28:31], v2, s[24:27], s59 offen offset:3072 sc1
Mvaa 240,240,28
Ta 216,22,16384
Ta 218,22,17408
Mvaa 148,244,16
Ve 60,60
Mvaa 180,244,20
buffer_load_dwordx4 a[104:107], v11, s[20:23], s53 offen offset:0 sc1
Mvaa 212,244,24
Ta 220,23,16384
Ta 222,23,17408
Mvaa 244,244,28
v_add_f32_e64 v60, 1.0, v60
Mvaa 152,248,16
v_rcp_f32_e64 v60, v60
Mvaa 184,248,20
buffer_load_dwordx4 a[108:111], v11, s[20:23], s52 offen offset:0 sc1
Mvaa 216,248,24
Vc 60,60,60
v_and_b32 v64, 0xffff0000, v60
Mvaa 248,248,28
v_mov_b32 v60, s41
v_not_b32 v61, v60
Mvaa 156,252,16
v_ashrrev_i32_e64 v61, 31, v61
v_or_b32 v61, 0x80000000, v61
Mvaa 188,252,20
v_xor_b32_e64 v60, v60, v61
v_and_b32 v60, 0xffff0000, v60
Mvaa 220,252,24
s_waitcnt vmcnt(29) lgkmcnt(0)
v_mul_f32 v60, 0xbfb8aa3b, v60
Mvaa 252,252,28
Ve 60,60
Mvaa 128,192,32
v_add_f32_e64 v60, 1.0, v60
Mvaa 160,192,36
Ta 224,16,24576
Ta 226,16,25600
Mvaa 192,192,40
buffer_load_dwordx4 v9, s[8:11], s50 offen offset:2048 lds
Mvaa 224,192,44
v_rcp_f32_e64 v60, v60
Mvaa 132,196,32
Ta 228,17,24576
Ta 230,17,25600
Mvaa 164,196,36
Vc 60,60,60
v_and_b32 v65, 0xffff0000, v60
Mvaa 196,196,40
buffer_load_dwordx4 v9, s[8:11], s51 offen offset:3072 lds
Mvaa 228,196,44
Ta 232,18,24576
Ta 234,18,25600
Mvaa 136,200,32
v_xor_b32 v8, 524288, v8
v_xor_b32 v9, 524288, v9
Mvaa 168,200,36
v_mov_b32 v48, 0
v_mov_b32 v49, 0
Mvaa 200,200,40
Ta 236,19,24576
Ta 238,19,25600
Mvaa 232,200,44
buffer_load_dwordx4 a[112:115], v10, s[20:23], s53 offen offset:1024 sc1
Mvaa 140,204,32
s_add_u32 s59, s38, 47104
Mvaa 172,204,36
Ta 240,20,24576
Ta 242,20,25600
Mvaa 204,204,40
buffer_store_dwordx4 v[32:35], v2, s[24:27], s59 offen offset:0 sc1
Mvaa 236,204,44
v_mov_b32 v50, 0
v_mov_b32 v51, 0
Mvaa 144,208,32
s_waitcnt lgkmcnt(6)
Ta 244,21,24576
Ta 246,21,25600
Mvaa 176,208,36
buffer_load_dwordx4 a[116:119], v10, s[20:23], s52 offen offset:1024 sc1
Mvaa 208,208,40
v_mov_b32 v52, 0
v_mov_b32_e64 v53, 0
Mvaa 240,208,44
Ta 248,22,24576
Ta 250,22,25600
Mvaa 148,212,32
v_mov_b32 v54, 0
v_mov_b32 v55, 0
Mvaa 180,212,36
buffer_load_dwordx4 a[120:123], v11, s[20:23], s53 offen offset:1024 sc1
Mvaa 212,212,40
Ta 252,23,24576
Ta 254,23,25600
Mvaa 244,212,44
v_mov_b32 v56, 0
v_mov_b32 v57, 0
Mvaa 152,216,32
v_mov_b32 v58, 0
v_mov_b32 v59, 0
Mvaa 184,216,36
buffer_load_dwordx4 a[124:127], v11, s[20:23], s52 offen offset:1024 sc1
Mvaa 216,216,40
s_xor_b32 s52, s52, 14336
s_add_u32 s53, s52, s58
Mvaa 248,216,44
v_mov_b32 v60, 0
v_mov_b32_e64 v61, 0
Mvaa 156,220,32
v_mov_b32 v62, 0
v_mov_b32 v63, 0
Mvaa 188,220,36
Mvaa 220,220,40
s_waitcnt vmcnt(29) lgkmcnt(0)
Mvaa 252,220,44
s_barrier
Mvaa 128,224,48
s_mul_i32 s3, s34, s34
s_mul_i32 s47, s33, 48
s_add_u32 s3, s3, s47
Mvaa 160,224,52
s_add_u32 m0, s44, 16384
Ta 192,16,32768
Ta 194,16,33792
Mvaa 192,224,56
buffer_load_dwordx4 v8, s[8:11], s48 offen offset:0 lds
Mvaa 224,224,60
s_lshl_b32 s3, s3, 2
s_add_u32 s3, s3, s32
s_lshl_b32 s3, s3, 7
Mvaa 132,228,48
Ta 196,17,32768
Ta 198,17,33792
Mvaa 164,228,52
s_sub_u32 s3, s3, 8704
s_cmp_ge_u32 s34, 4
s_cselect_b32 s3, s3, 0
s_cselect_b32 s40, 512, 0
s_cselect_b32 s47, 786432, 0
Mvaa 196,228,56
buffer_load_dwordx4 v8, s[8:11], s49 offen offset:1024 lds
Mvaa 228,228,60
Ta 200,18,32768
Ta 202,18,33792
Mvaa 136,232,48
buffer_store_dwordx4 v[36:39], v2, s[24:27], s59 offen offset:1024 sc1
Mvaa 168,232,52
v_subrev_u32_e64 v31, 0, v0
v_mul_lo_u32 v31, v31, s47
Mvaa 200,232,56
Ta 204,19,32768
Ta 206,19,33792
Mvaa 232,232,60
buffer_load_dwordx4 a[0:3], v10, s[20:23], s53 offen offset:0 sc1
Mvaa 140,236,48
v_min_u32 v31, 6553600, v31
v_mov_b32_e64 v28, s94
Mvaa 172,236,52
Ta 208,20,32768
Ta 210,20,33792
Mvaa 204,236,56
v_mov_b32 v29, s95
v_mov_b32 v30, v31
Mvaa 236,236,60
v_subrev_u32_e64 v31, 10, v0
v_mul_lo_u32 v31, v31, s47
Mvaa 144,240,48
s_waitcnt lgkmcnt(6)
Ta 212,21,32768
Ta 214,21,33792
Mvaa 176,240,52
buffer_load_dwordx4 a[4:7], v10, s[20:23], s52 offen offset:0 sc1
Mvaa 208,240,56
v_min_u32 v31, 6553600, v31
v_mov_b32 v14, s60
Mvaa 240,240,60
Ta 216,22,32768
Ta 218,22,33792
Mvaa 148,244,48
v_mov_b32_e64 v15, s61
Mvaa 180,244,52
buffer_load_dwordx4 a[8:11], v11, s[20:23], s53 offen offset:0 sc1
Mvaa 212,244,56
Ta 220,23,32768
Ta 222,23,33792
Mvaa 244,244,60
v_cmp_le_u32 vcc, 10, v0
Mvaa 152,248,48
s_nop 0
v_cndmask_b32 v28, v28, v14, vcc
v_cndmask_b32 v29, v29, v15, vcc
Mvaa 184,248,52
buffer_load_dwordx4 a[12:15], v11, s[20:23], s52 offen offset:0 sc1
Mvaa 216,248,56
v_cndmask_b32 v30, v30, v31, vcc
Mvaa 248,248,60
v_subrev_u32 v31, 20, v0
v_mul_lo_u32 v31, v31, s47
Mvaa 156,252,48
v_min_u32 v31, 6553600, v31
v_mov_b32_e64 v14, s68
Mvaa 188,252,52
v_mov_b32_e64 v15, s69
Mvaa 220,252,56
s_waitcnt vmcnt(29) lgkmcnt(0)
Mvaa 252,252,60
Mvaa 128,192,64
buffer_store_dwordx4 v[40:43], v2, s[24:27], s59 offen offset:2048 sc1
Mvaa 160,192,68
Ta 224,16,40960
Ta 226,16,41984
Mvaa 192,192,72
buffer_load_dwordx4 v9, s[8:11], s50 offen offset:2048 lds
Mvaa 224,192,76
v_cmp_le_u32 vcc, 20, v0
Mvaa 132,196,64
Ta 228,17,40960
Ta 230,17,41984
Mvaa 164,196,68
v_cndmask_b32 v28, v28, v14, vcc
v_cndmask_b32 v29, v29, v15, vcc
Mvaa 196,196,72
buffer_load_dwordx4 v9, s[8:11], s51 offen offset:3072 lds
Mvaa 228,196,76
Ta 232,18,40960
Ta 234,18,41984
Mvaa 136,200,64
v_xor_b32 v8, 1572864, v8
v_xor_b32 v9, 1572864, v9
Mvaa 168,200,68
v_cndmask_b32 v30, v30, v31, vcc
Mvaa 200,200,72
Ta 236,19,40960
Ta 238,19,41984
Mvaa 232,200,76
buffer_load_dwordx4 a[16:19], v10, s[20:23], s53 offen offset:1024 sc1
Mvaa 140,204,64
v_subrev_u32 v31, 30, v0
v_mul_lo_u32 v31, v31, s47
Mvaa 172,204,68
Ta 240,20,40960
Ta 242,20,41984
Mvaa 204,204,72
v_min_u32 v31, 7602176, v31
v_mov_b32_e64 v14, s92
Mvaa 236,204,76
v_mov_b32_e64 v15, s93
Mvaa 144,208,64
s_waitcnt lgkmcnt(6)
Ta 244,21,40960
Ta 246,21,41984
Mvaa 176,208,68
buffer_load_dwordx4 a[20:23], v10, s[20:23], s52 offen offset:1024 sc1
Mvaa 208,208,72
v_cmp_le_u32 vcc, 30, v0
Mvaa 240,208,76
Ta 248,22,40960
Ta 250,22,41984
Mvaa 148,212,64
v_cndmask_b32 v28, v28, v14, vcc
v_cndmask_b32 v29, v29, v15, vcc
Mvaa 180,212,68
buffer_load_dwordx4 a[24:27], v11, s[20:23], s53 offen offset:1024 sc1
Mvaa 212,212,72
Ta 252,23,40960
Ta 254,23,41984
Mvaa 244,212,76
v_cndmask_b32 v30, v30, v31, vcc
Mvaa 152,216,64
v_add_u32 v30, s3, v30
v_ashrrev_i32_e64 v31, 31, v30
Mvaa 184,216,68
buffer_load_dwordx4 a[28:31], v11, s[20:23], s52 offen offset:1024 sc1
Mvaa 216,216,72
s_xor_b32 s52, s52, 2048
s_add_u32 s53, s52, s58
Mvaa 248,216,76
buffer_store_dwordx4 v[44:47], v2, s[24:27], s59 offen offset:3072 sc1
Mvaa 156,220,64
v_mov_b32 v12, 1
v_and_b32_e64 v1, 15, v0
Mvaa 188,220,68
v_lshlrev_b32_e64 v1, 2, v1
Mvaa 220,220,72
s_waitcnt vmcnt(29) lgkmcnt(0)
v_lshl_add_u64 v[28:29], v[30:31], 0, v[28:29]
Mvaa 252,220,76
s_barrier
Mvaa 128,224,80
s_lshr_b32 s6, s33, 1
s_lshl_b32 s6, s6, 7
s_add_u32 s6, s6, 5296128
Mvaa 160,224,84
s_add_u32 m0, s44, 32768
Ta 192,16,49152
Ta 194,16,50176
Mvaa 192,224,88
buffer_load_dwordx4 v8, s[8:11], s48 offen offset:0 lds
Mvaa 224,224,92
s_cmp_eq_u32 s32, 0
s_cselect_b32 s6, s6, 2146435072
Mvaa 132,228,80
Ta 196,17,49152
Ta 198,17,50176
Mvaa 164,228,84
s_mov_b32 s41, 0
v_readfirstlane_b32 s100, v64
v_readfirstlane_b32 s101, v65
Mvaa 196,228,88
buffer_load_dwordx4 v8, s[8:11], s49 offen offset:1024 lds
Mvaa 228,228,92
Ta 200,18,49152
Ta 202,18,50176
Mvaa 136,232,80
Mvaa 168,232,84
Mvaa 200,232,88
Ta 204,19,49152
Ta 206,19,50176
Mvaa 232,232,92
buffer_load_dwordx4 a[32:35], v10, s[20:23], s53 offen offset:0 sc1
Mvaa 140,236,80
Mvaa 172,236,84
Ta 208,20,49152
Ta 210,20,50176
Mvaa 204,236,88
Mvaa 236,236,92
Mvaa 144,240,80
s_waitcnt lgkmcnt(6)
Ta 212,21,49152
Ta 214,21,50176
Mvaa 176,240,84
buffer_load_dwordx4 a[36:39], v10, s[20:23], s52 offen offset:0 sc1
Mvaa 208,240,88
Mvaa 240,240,92
Ta 216,22,49152
Ta 218,22,50176
Mvaa 148,244,80
Mvaa 180,244,84
buffer_load_dwordx4 a[40:43], v11, s[20:23], s53 offen offset:0 sc1
Mvaa 212,244,88
Ta 220,23,49152
Ta 222,23,50176
Mvaa 244,244,92
Mvaa 152,248,80
Mvaa 184,248,84
buffer_load_dwordx4 a[44:47], v11, s[20:23], s52 offen offset:0 sc1
Mvaa 216,248,88
Mvaa 248,248,92
Mvaa 156,252,80
Mvaa 188,252,84
Mvaa 220,252,88
s_waitcnt vmcnt(28) lgkmcnt(0)
Mvaa 252,252,92
Mvaa 128,192,96
Mvaa 160,192,100
Ta 224,16,57344
Ta 226,16,58368
Mvaa 192,192,104
buffer_load_dwordx4 v9, s[8:11], s50 offen offset:2048 lds
Mvaa 224,192,108
Mvaa 132,196,96
Ta 228,17,57344
Ta 230,17,58368
Mvaa 164,196,100
Mvaa 196,196,104
buffer_load_dwordx4 v9, s[8:11], s51 offen offset:3072 lds
Mvaa 228,196,108
Ta 232,18,57344
Ta 234,18,58368
Mvaa 136,200,96
v_xor_b32 v8, 524288, v8
v_xor_b32 v9, 524288, v9
Mvaa 168,200,100
Mvaa 200,200,104
Ta 236,19,57344
Ta 238,19,58368
Mvaa 232,200,108
buffer_load_dwordx4 a[48:51], v10, s[20:23], s53 offen offset:1024 sc1
Mvaa 140,204,96
Mvaa 172,204,100
Ta 240,20,57344
Ta 242,20,58368
Mvaa 204,204,104
Mvaa 236,204,108
Mvaa 144,208,96
s_waitcnt lgkmcnt(6)
Ta 244,21,57344
Ta 246,21,58368
Mvaa 176,208,100
buffer_load_dwordx4 a[52:55], v10, s[20:23], s52 offen offset:1024 sc1
Mvaa 208,208,104
Mvaa 240,208,108
Ta 248,22,57344
Ta 250,22,58368
Mvaa 148,212,96
Mvaa 180,212,100
buffer_load_dwordx4 a[56:59], v11, s[20:23], s53 offen offset:1024 sc1
Mvaa 212,212,104
Ta 252,23,57344
Ta 254,23,58368
Mvaa 244,212,108
Mvaa 152,216,96
Mvaa 184,216,100
buffer_load_dwordx4 a[60:63], v11, s[20:23], s52 offen offset:1024 sc1
Mvaa 216,216,104
s_xor_b32 s52, s52, 6144
s_add_u32 s53, s52, s58
Mvaa 248,216,108
Mvaa 156,220,96
Mvaa 188,220,100
Mvaa 220,220,104
s_waitcnt vmcnt(27) lgkmcnt(0)
Mvaa 252,220,108
s_barrier
Mvaa 128,224,112
Mvaa 160,224,116
s_add_u32 m0, s44, 49152
Ta 192,16,0
Ta 194,16,1024
Mvaa 192,224,120
buffer_load_dwordx4 v8, s[8:11], s48 offen offset:0 lds
Mvaa 224,224,124
Mvaa 132,228,112
Ta 196,17,0
Ta 198,17,1024
Mvaa 164,228,116
Mvaa 196,228,120
buffer_load_dwordx4 v8, s[8:11], s49 offen offset:1024 lds
Mvaa 228,228,124
Ta 200,18,0
Ta 202,18,1024
Mvaa 136,232,112
Mvaa 168,232,116
Mvaa 200,232,120
Ta 204,19,0
Ta 206,19,1024
Mvaa 232,232,124
buffer_load_dwordx4 a[64:67], v10, s[20:23], s53 offen offset:0 sc1
Mvaa 140,236,112
Mvaa 172,236,116
Ta 208,20,0
Ta 210,20,1024
Mvaa 204,236,120
Mvaa 236,236,124
Mvaa 144,240,112
s_waitcnt lgkmcnt(6)
Ta 212,21,0
Ta 214,21,1024
Mvaa 176,240,116
buffer_load_dwordx4 a[68:71], v10, s[20:23], s52 offen offset:0 sc1
Mvaa 208,240,120
Mvaa 240,240,124
Ta 216,22,0
Ta 218,22,1024
Mvaa 148,244,112
Mvaa 180,244,116
buffer_load_dwordx4 a[72:75], v11, s[20:23], s53 offen offset:0 sc1
Mvaa 212,244,120
Ta 220,23,0
Ta 222,23,1024
Mvaa 244,244,124
Mvaa 152,248,112
Mvaa 184,248,116
buffer_load_dwordx4 a[76:79], v11, s[20:23], s52 offen offset:0 sc1
Mvaa 216,248,120
Mvaa 248,248,124
Mvaa 156,252,112
Mvaa 188,252,116
Mvaa 220,252,120
s_waitcnt vmcnt(26) lgkmcnt(0)
Mvaa 252,252,124
Mvaa 128,192,0
Mvaa 160,192,4
Ta 224,16,8192
Ta 226,16,9216
Mvaa 192,192,8
buffer_load_dwordx4 v9, s[8:11], s50 offen offset:2048 lds
Mvaa 224,192,12
Mvaa 132,196,0
Ta 228,17,8192
Ta 230,17,9216
Mvaa 164,196,4
Mvaa 196,196,8
buffer_load_dwordx4 v9, s[8:11], s51 offen offset:3072 lds
Mvaa 228,196,12
Ta 232,18,8192
Ta 234,18,9216
Mvaa 136,200,0
v_xor_b32 v8, 7864320, v8
v_xor_b32 v9, 7864320, v9
Mvaa 168,200,4
Mvaa 200,200,8
Ta 236,19,8192
Ta 238,19,9216
Mvaa 232,200,12
buffer_load_dwordx4 a[80:83], v10, s[20:23], s53 offen offset:1024 sc1
Mvaa 140,204,0
Mvaa 172,204,4
Ta 240,20,8192
Ta 242,20,9216
Mvaa 204,204,8
Mvaa 236,204,12
Mvaa 144,208,0
s_waitcnt lgkmcnt(6)
Ta 244,21,8192
Ta 246,21,9216
Mvaa 176,208,4
buffer_load_dwordx4 a[84:87], v10, s[20:23], s52 offen offset:1024 sc1
Mvaa 208,208,8
Mvaa 240,208,12
Ta 248,22,8192
Ta 250,22,9216
Mvaa 148,212,0
Mvaa 180,212,4
buffer_load_dwordx4 a[88:91], v11, s[20:23], s53 offen offset:1024 sc1
Mvaa 212,212,8
Ta 252,23,8192
Ta 254,23,9216
Mvaa 244,212,12
Mvaa 152,216,0
Mvaa 184,216,4
buffer_load_dwordx4 a[92:95], v11, s[20:23], s52 offen offset:1024 sc1
Mvaa 216,216,8
s_xor_b32 s52, s52, 2048
s_add_u32 s53, s52, s58
Mvaa 248,216,12
Mvaa 156,220,0
Mvaa 188,220,4
Mvaa 220,220,8
s_waitcnt vmcnt(24) lgkmcnt(0)
Mvaa 252,220,12
s_barrier
Mvaa 128,224,16
s_mov_b64 exec, 1
buffer_store_dword v12, v7, s[20:23], s39 offen sc1
s_mov_b64 exec, -1
Mvaa 160,224,20
Ta 192,16,16384
Ta 194,16,17408
Mvaa 192,224,24
buffer_load_dwordx4 a[96:99], v10, s[20:23], s53 offen offset:0 sc1
Mvaa 224,224,28
s_mov_b32 s24, s60
s_mov_b32 s25, s61
s_mov_b32 s26, s62
Mvaa 132,228,16
Ta 196,17,16384
Ta 198,17,17408
Mvaa 164,228,20
s_mov_b32 s94, 1040356334
s_mov_b32 s95, 1040356334
s_sub_u32 s55, 15, s34
Mvaa 196,228,24
s_sub_u32 s45, s36, 3
s_sub_u32 s46, s35, 3
s_mov_b32 s54, s44
Mvaa 228,228,28
Ta 200,18,16384
Ta 202,18,17408
Mvaa 136,232,16
s_sub_u32 s35, s35, 2
s_sub_u32 s36, s36, 2
v_accvgpr_write_b32 a0, 0
Mvaa 168,232,20
buffer_load_dwordx4 a[100:103], v10, s[20:23], s52 offen offset:0 sc1
Mvaa 200,232,24
Ta 204,19,16384
Ta 206,19,17408
Mvaa 232,232,28
v_accvgpr_write_b32 a1, 0
v_accvgpr_write_b32 a2, 0
Mvaa 140,236,16
v_accvgpr_write_b32 a3, 0
v_accvgpr_write_b32 a4, 0
Mvaa 172,236,20
Ta 208,20,16384
Ta 210,20,17408
Mvaa 204,236,24
v_accvgpr_write_b32 a5, 0
v_accvgpr_write_b32 a6, 0
Mvaa 236,236,28
v_accvgpr_write_b32 a7, 0
v_accvgpr_write_b32 a8, 0
Mvaa 144,240,16
s_waitcnt lgkmcnt(6)
Ta 212,21,16384
Ta 214,21,17408
Mvaa 176,240,20
buffer_load_dwordx4 a[104:107], v11, s[20:23], s53 offen offset:0 sc1
Mvaa 208,240,24
v_accvgpr_write_b32 a9, 0
v_accvgpr_write_b32 a10, 0
Mvaa 240,240,28
Ta 216,22,16384
Ta 218,22,17408
Mvaa 148,244,16
v_accvgpr_write_b32 a11, 0
v_accvgpr_write_b32 a12, 0
Mvaa 180,244,20
v_accvgpr_write_b32 a13, 0
v_accvgpr_write_b32 a14, 0
Mvaa 212,244,24
Ta 220,23,16384
Ta 222,23,17408
Mvaa 244,244,28
v_accvgpr_write_b32 a15, 0
Mvaa 152,248,16
buffer_load_dwordx4 a[108:111], v11, s[20:23], s52 offen offset:0 sc1
Mvaa 184,248,20
Mvaa 216,248,24
Mvaa 248,248,28
Mvaa 156,252,16
Mvaa 188,252,20
Mvaa 220,252,24
s_waitcnt vmcnt(23) lgkmcnt(0)
Mvaa 252,252,28
Mvaa 128,192,32
v_accvgpr_write_b32 a16, 0
v_accvgpr_write_b32 a17, 0
Mvaa 160,192,36
Ta 224,16,24576
Ta 226,16,25600
Mvaa 192,192,40
buffer_load_dwordx4 a[112:115], v10, s[20:23], s53 offen offset:1024 sc1
Mvaa 224,192,44
v_accvgpr_write_b32 a18, 0
v_accvgpr_write_b32 a19, 0
Mvaa 132,196,32
Ta 228,17,24576
Ta 230,17,25600
Mvaa 164,196,36
v_accvgpr_write_b32 a20, 0
v_accvgpr_write_b32 a21, 0
Mvaa 196,196,40
v_accvgpr_write_b32 a22, 0
v_accvgpr_write_b32 a23, 0
Mvaa 228,196,44
Ta 232,18,24576
Ta 234,18,25600
Mvaa 136,200,32
v_accvgpr_write_b32 a24, 0
v_accvgpr_write_b32 a25, 0
Mvaa 168,200,36
buffer_load_dwordx4 a[116:119], v10, s[20:23], s52 offen offset:1024 sc1
Mvaa 200,200,40
Ta 236,19,24576
Ta 238,19,25600
Mvaa 232,200,44
v_accvgpr_write_b32 a26, 0
v_accvgpr_write_b32 a27, 0
Mvaa 140,204,32
v_accvgpr_write_b32 a28, 0
v_accvgpr_write_b32 a29, 0
Mvaa 172,204,36
Ta 240,20,24576
Ta 242,20,25600
Mvaa 204,204,40
v_accvgpr_write_b32 a30, 0
v_accvgpr_write_b32 a31, 0
Mvaa 236,204,44
Mvaa 144,208,32
s_waitcnt lgkmcnt(6)
Ta 244,21,24576
Ta 246,21,25600
Mvaa 176,208,36
buffer_load_dwordx4 a[120:123], v11, s[20:23], s53 offen offset:1024 sc1
Mvaa 208,208,40
Mvaa 240,208,44
Ta 248,22,24576
Ta 250,22,25600
Mvaa 148,212,32
Mvaa 180,212,36
Mvaa 212,212,40
Ta 252,23,24576
Ta 254,23,25600
Mvaa 244,212,44
Mvaa 152,216,32
buffer_load_dwordx4 a[124:127], v11, s[20:23], s52 offen offset:1024 sc1
Mvaa 184,216,36
Mvaa 216,216,40
Mvaa 248,216,44
Mvaa 156,220,32
Mvaa 188,220,36
Mvaa 220,220,40
s_waitcnt vmcnt(21) lgkmcnt(0)
Mvaa 252,220,44
s_barrier
Mvaa 128,224,48
v_accvgpr_write_b32 a32, 0
v_accvgpr_write_b32 a33, 0
Mvaa 160,224,52
Ta 192,16,32768
Ta 194,16,33792
Mvaa 192,224,56
v_accvgpr_write_b32 a34, 0
v_accvgpr_write_b32 a35, 0
Mvaa 224,224,60
v_accvgpr_write_b32 a36, 0
v_accvgpr_write_b32 a37, 0
Mvaa 132,228,48
Ta 196,17,32768
Ta 198,17,33792
Mvaa 164,228,52
v_accvgpr_write_b32 a38, 0
v_accvgpr_write_b32 a39, 0
Mvaa 196,228,56
v_accvgpr_write_b32 a40, 0
v_accvgpr_write_b32 a41, 0
Mvaa 228,228,60
Ta 200,18,32768
Ta 202,18,33792
Mvaa 136,232,48
v_accvgpr_write_b32 a42, 0
v_accvgpr_write_b32 a43, 0
Mvaa 168,232,52
v_accvgpr_write_b32 a44, 0
v_accvgpr_write_b32 a45, 0
Mvaa 200,232,56
Ta 204,19,32768
Ta 206,19,33792
Mvaa 232,232,60
buffer_load_dword v12, v1, s[20:23], s6 offen sc1
Mvaa 140,236,48
s_add_u32 m0, s44, 65536
s_mov_b32 s7, 0
Mvaa 172,236,52
Ta 208,20,32768
Ta 210,20,33792
Mvaa 204,236,56
v_accvgpr_write_b32 a46, 0
v_accvgpr_write_b32 a47, 0
Mvaa 236,236,60
Mvaa 144,240,48
s_waitcnt lgkmcnt(6)
Ta 212,21,32768
Ta 214,21,33792
Mvaa 176,240,52
Mvaa 208,240,56
Mvaa 240,240,60
Ta 216,22,32768
Ta 218,22,33792
Mvaa 148,244,48
Mvaa 180,244,52
Mvaa 212,244,56
Ta 220,23,32768
Ta 222,23,33792
Mvaa 244,244,60
Mvaa 152,248,48
Mvaa 184,248,52
Mvaa 216,248,56
Mvaa 248,248,60
Mvaa 156,252,48
Mvaa 188,252,52
Mvaa 220,252,56
s_waitcnt vmcnt(16) lgkmcnt(0)
Mvaa 252,252,60
Mvaa 128,192,64
v_accvgpr_write_b32 a48, 0
v_accvgpr_write_b32 a49, 0
Mvaa 160,192,68
Ta 224,16,40960
Ta 226,16,41984
Mvaa 192,192,72
v_accvgpr_write_b32 a50, 0
v_accvgpr_write_b32 a51, 0
Mvaa 224,192,76
v_accvgpr_write_b32 a52, 0
v_accvgpr_write_b32 a53, 0
Mvaa 132,196,64
Ta 228,17,40960
Ta 230,17,41984
Mvaa 164,196,68
v_accvgpr_write_b32 a54, 0
v_accvgpr_write_b32 a55, 0
Mvaa 196,196,72
v_accvgpr_write_b32 a56, 0
v_accvgpr_write_b32 a57, 0
Mvaa 228,196,76
Ta 232,18,40960
Ta 234,18,41984
Mvaa 136,200,64
v_accvgpr_write_b32 a58, 0
v_accvgpr_write_b32 a59, 0
Mvaa 168,200,68
v_accvgpr_write_b32 a60, 0
v_accvgpr_write_b32 a61, 0
Mvaa 200,200,72
Ta 236,19,40960
Ta 238,19,41984
Mvaa 232,200,76
v_accvgpr_write_b32 a62, 0
v_accvgpr_write_b32 a63, 0
Mvaa 140,204,64
Mvaa 172,204,68
Ta 240,20,40960
Ta 242,20,41984
Mvaa 204,204,72
Mvaa 236,204,76
Mvaa 144,208,64
s_waitcnt lgkmcnt(6)
Ta 244,21,40960
Ta 246,21,41984
Mvaa 176,208,68
Mvaa 208,208,72
Mvaa 240,208,76
Ta 248,22,40960
Ta 250,22,41984
Mvaa 148,212,64
Mvaa 180,212,68
Mvaa 212,212,72
Ta 252,23,40960
Ta 254,23,41984
Mvaa 244,212,76
Mvaa 152,216,64
Mvaa 184,216,68
Mvaa 216,216,72
Mvaa 248,216,76
Mvaa 156,220,64
Mvaa 188,220,68
Mvaa 220,220,72
s_waitcnt vmcnt(0) lgkmcnt(0)
Mvaa 252,220,76
s_cmp_lg_u32 s32, 0
s_cbranch_scc1 L_spinBr
v_cmp_ne_u32 vcc, 1, v12
s_cbranch_vccnz L_spinB
L_spinBr:
s_barrier
Mvaa 128,224,80
buffer_load_dwordx4 v4, s[12:15], s7 offen offset:0 sc1 lds
Mvaa 160,224,84
Ta 192,16,49152
Ta 194,16,50176
Mvaa 192,224,88
v_accvgpr_write_b32 a64, 0
v_accvgpr_write_b32 a65, 0
Mvaa 224,224,92
buffer_load_dwordx4 v4, s[12:15], s7 offen offset:1024 sc1 lds
Mvaa 132,228,80
Ta 196,17,49152
Ta 198,17,50176
Mvaa 164,228,84
v_accvgpr_write_b32 a66, 0
v_accvgpr_write_b32 a67, 0
Mvaa 196,228,88
buffer_load_dwordx4 v4, s[12:15], s7 offen offset:2048 sc1 lds
Mvaa 228,228,92
Ta 200,18,49152
Ta 202,18,50176
Mvaa 136,232,80
v_accvgpr_write_b32 a68, 0
v_accvgpr_write_b32 a69, 0
Mvaa 168,232,84
buffer_load_dwordx4 v4, s[12:15], s7 offen offset:3072 sc1 lds
Mvaa 200,232,88
Ta 204,19,49152
Ta 206,19,50176
Mvaa 232,232,92
s_add_u32 m0, s44, 98304
s_mov_b32 s7, 34816
Mvaa 140,236,80
buffer_load_dwordx4 v4, s[12:15], s7 offen offset:0 sc1 lds
Mvaa 172,236,84
Ta 208,20,49152
Ta 210,20,50176
Mvaa 204,236,88
v_accvgpr_write_b32 a70, 0
v_accvgpr_write_b32 a71, 0
Mvaa 236,236,92
buffer_load_dwordx4 v4, s[12:15], s7 offen offset:1024 sc1 lds
Mvaa 144,240,80
s_waitcnt lgkmcnt(6)
Ta 212,21,49152
Ta 214,21,50176
Mvaa 176,240,84
v_accvgpr_write_b32 a72, 0
v_accvgpr_write_b32 a73, 0
Mvaa 208,240,88
buffer_load_dwordx4 v4, s[12:15], s7 offen offset:2048 sc1 lds
Mvaa 240,240,92
Ta 216,22,49152
Ta 218,22,50176
Mvaa 148,244,80
v_accvgpr_write_b32 a74, 0
v_accvgpr_write_b32 a75, 0
Mvaa 180,244,84
buffer_load_dwordx4 v4, s[12:15], s7 offen offset:3072 sc1 lds
Mvaa 212,244,88
Ta 220,23,49152
Ta 222,23,50176
Mvaa 244,244,92
s_add_u32 m0, s44, 81920
s_mov_b32 s7, 17408
Mvaa 152,248,80
buffer_load_dwordx4 v4, s[12:15], s7 offen offset:0 sc1 lds
Mvaa 184,248,84
v_accvgpr_write_b32 a76, 0
v_accvgpr_write_b32 a77, 0
Mvaa 216,248,88
buffer_load_dwordx4 v4, s[12:15], s7 offen offset:1024 sc1 lds
Mvaa 248,248,92
v_accvgpr_write_b32 a78, 0
v_accvgpr_write_b32 a79, 0
Mvaa 156,252,80
Mvaa 188,252,84
Mvaa 220,252,88
s_waitcnt lgkmcnt(0)
Mvaa 252,252,92
Mvaa 128,192,96
buffer_load_dwordx4 v4, s[12:15], s7 offen offset:2048 sc1 lds
Mvaa 160,192,100
Ta 224,16,57344
Ta 226,16,58368
Mvaa 192,192,104
buffer_load_dwordx4 v4, s[12:15], s7 offen offset:3072 sc1 lds
Mvaa 224,192,108
s_add_u32 m0, s44, 114688
s_mov_b32 s7, 52224
Mvaa 132,196,96
Ta 228,17,57344
Ta 230,17,58368
Mvaa 164,196,100
buffer_load_dwordx4 v4, s[12:15], s7 offen offset:0 sc1 lds
Mvaa 196,196,104
buffer_load_dwordx4 v4, s[12:15], s7 offen offset:1024 sc1 lds
Mvaa 228,196,108
Ta 232,18,57344
Ta 234,18,58368
Mvaa 136,200,96
v_accvgpr_write_b32 a80, 0
v_accvgpr_write_b32 a81, 0
Mvaa 168,200,100
buffer_load_dwordx4 v4, s[12:15], s7 offen offset:2048 sc1 lds
Mvaa 200,200,104
Ta 236,19,57344
Ta 238,19,58368
Mvaa 232,200,108
v_accvgpr_write_b32 a82, 0
v_accvgpr_write_b32 a83, 0
Mvaa 140,204,96
buffer_load_dwordx4 v4, s[12:15], s7 offen offset:3072 sc1 lds
Mvaa 172,204,100
Ta 240,20,57344
Ta 242,20,58368
Mvaa 204,204,104
s_add_u32 m0, s44, 0
s_mov_b32 s7, 69632
Mvaa 236,204,108
buffer_load_dwordx4 v4, s[12:15], s7 offen offset:0 sc1 lds
Mvaa 144,208,96
s_waitcnt lgkmcnt(6)
Ta 244,21,57344
Ta 246,21,58368
Mvaa 176,208,100
buffer_load_dwordx4 v4, s[12:15], s7 offen offset:1024 sc1 lds
Mvaa 208,208,104
v_accvgpr_write_b32 a84, 0
v_accvgpr_write_b32 a85, 0
Mvaa 240,208,108
Ta 248,22,57344
Ta 250,22,58368
Mvaa 148,212,96
buffer_load_dwordx4 v4, s[12:15], s7 offen offset:2048 sc1 lds
Mvaa 180,212,100
v_accvgpr_write_b32 a86, 0
v_accvgpr_write_b32 a87, 0
Mvaa 212,212,104
Ta 252,23,57344
Ta 254,23,58368
Mvaa 244,212,108
buffer_load_dwordx4 v4, s[12:15], s7 offen offset:3072 sc1 lds
Mvaa 152,216,96
s_add_u32 m0, s44, 16384
s_mov_b32 s7, 87040
Mvaa 184,216,100
v_accvgpr_write_b32 a88, 0
v_accvgpr_write_b32 a89, 0
Mvaa 216,216,104
buffer_load_dwordx4 v4, s[12:15], s7 offen offset:0 sc1 lds
Mvaa 248,216,108
v_accvgpr_write_b32 a90, 0
v_accvgpr_write_b32 a91, 0
Mvaa 156,220,96
v_accvgpr_write_b32 a92, 0
v_accvgpr_write_b32 a93, 0
Mvaa 188,220,100
v_accvgpr_write_b32 a94, 0
v_accvgpr_write_b32 a95, 0
Mvaa 220,220,104
s_waitcnt vmcnt(17) lgkmcnt(0)
Mvaa 252,220,108
s_barrier
Mvaa 128,224,112
buffer_load_dwordx4 v4, s[12:15], s7 offen offset:1024 sc1 lds
Mvaa 132,228,112
buffer_load_dwordx4 v4, s[12:15], s7 offen offset:2048 sc1 lds
Mvaa 136,232,112
Ra 192,3,0
Ra 196,3,1024
Mvaa 140,236,112
buffer_load_dwordx4 v4, s[12:15], s7 offen offset:3072 sc1 lds
Mvaa 144,240,112
s_add_u32 m0, s44, 32768
s_mov_b32 s7, 104448
Mvaa 148,244,112
Ra 200,3,2048
Ra 204,3,3072
Mvaa 152,248,112
buffer_load_dwordx4 v4, s[12:15], s7 offen offset:0 sc1 lds
Mvaa 156,252,112
Ra 208,3,4096
Ra 212,3,5120
Mvaa 160,224,116
buffer_load_dwordx4 v4, s[12:15], s7 offen offset:1024 sc1 lds
Mvaa 164,228,116
Ra 216,3,6144
Ra 220,3,7168
Mvaa 168,232,116
Mvaa 172,236,116
buffer_load_dwordx4 v4, s[12:15], s7 offen offset:2048 sc1 lds
Mvaa 176,240,116
v_mul_f32 v128, s94, v128
v_mul_f32 v129, s94, v129
Mvaa 180,244,116
v_mul_f32 v130, s94, v130
v_mul_f32 v131, s94, v131
Mvaa 184,248,116
buffer_load_dwordx4 v4, s[12:15], s7 offen offset:3072 sc1 lds
Mvaa 188,252,116
v_mul_f32 v132, s94, v132
v_mul_f32 v133, s94, v133
Mvaa 192,224,120
v_mul_f32 v134, s94, v134
v_mul_f32 v135, s94, v135
Mvaa 196,228,120
Vc 128,128,129
Vc 129,130,131
Mvaa 200,232,120
Vc 130,132,133
Vc 131,134,135
Mvaa 204,236,120
Aw 128,128
Aw 129,129
Mvaa 208,240,120
Aw 130,130
Aw 131,131
Mvaa 212,244,120
v_mul_f32 v136, s94, v136
v_mul_f32 v137, s94, v137
Mvaa 216,248,120
v_mul_f32 v138, s94, v138
v_mul_f32 v139, s94, v139
Mvaa 220,252,120
v_mul_f32 v140, s94, v140
v_mul_f32 v141, s94, v141
Mvaa 224,224,124
v_mul_f32 v142, s94, v142
v_mul_f32 v143, s94, v143
Mvaa 228,228,124
Vc 136,136,137
Vc 137,138,139
Mvaa 232,232,124
Vc 138,140,141
Vc 139,142,143
Mvaa 236,236,124
Aw 132,136
Aw 133,137
Mvaa 240,240,124
Aw 134,138
Aw 135,139
Mvaa 244,244,124
v_mul_f32 v144, s94, v144
v_mul_f32 v145, s94, v145
Mvaa 248,248,124
v_mul_f32 v146, s94, v146
v_mul_f32 v147, s94, v147
Mvaa 252,252,124
v_mul_f32 v148, s94, v148
v_mul_f32 v149, s94, v149
Ra 224,3,8192
Ra 228,3,9216
Ra 232,3,10240
Ra 236,3,11264
Ra 240,3,12288
Ra 244,3,13312
Ra 248,3,14336
s_waitcnt lgkmcnt(9)
Ra 252,3,15360
v_mul_f32 v150, s94, v150
v_mul_f32_e64 v151, s94, v151
Vc 144,144,145
Vc 145,146,147
Vc 146,148,149
Vc 147,150,151
Aw 136,144
Aw 137,145
Aw 138,146
Aw 139,147
v_mul_f32 v152, s94, v152
v_mul_f32 v153, s94, v153
v_mul_f32 v154, s94, v154
v_mul_f32 v155, s94, v155
v_mul_f32 v156, s94, v156
v_mul_f32 v157, s94, v157
v_mul_f32 v158, s94, v158
v_mul_f32 v159, s94, v159
Vc 152,152,153
Vc 153,154,155
Vc 154,156,157
Vc 155,158,159
Aw 140,152
Aw 141,153
Aw 142,154
Aw 143,155
Zvaa 128,192,128
v_mul_f32 v160, s94, v160
v_mul_f32 v161, s94, v161
v_mul_f32 v162, s94, v162
v_mul_f32 v163, s94, v163
Mvaa 128,196,132
v_mul_f32 v164, s94, v164
v_mul_f32 v165, s94, v165
v_mul_f32 v166, s94, v166
v_mul_f32 v167, s94, v167
Mvaa 128,200,136
Vc 160,160,161
Vc 161,162,163
Vc 162,164,165
Vc 163,166,167
Mvaa 128,204,140
Aw 144,160
Aw 145,161
Aw 146,162
Aw 147,163
s_waitcnt lgkmcnt(8)
Zvaa 132,208,128
v_mul_f32 v168, s94, v168
v_mul_f32 v169, s94, v169
v_mul_f32 v170, s94, v170
v_mul_f32_e64 v171, s94, v171
Mvaa 132,212,132
v_mul_f32 v172, s94, v172
v_mul_f32 v173, s94, v173
v_mul_f32 v174, s94, v174
v_mul_f32 v175, s94, v175
Mvaa 132,216,136
Vc 168,168,169
Vc 169,170,171
Vc 170,172,173
Vc 171,174,175
Mvaa 132,220,140
Aw 148,168
Aw 149,169
Aw 150,170
Aw 151,171
s_waitcnt lgkmcnt(4)
Zvaa 136,224,128
v_mul_f32 v176, s94, v176
v_mul_f32 v177, s94, v177
v_mul_f32 v178, s94, v178
v_mul_f32_e64 v179, s94, v179
Mvaa 136,228,132
v_mul_f32 v180, s94, v180
v_mul_f32 v181, s94, v181
v_mul_f32 v182, s94, v182
v_mul_f32 v183, s94, v183
Mvaa 136,232,136
Vc 176,176,177
Vc 177,178,179
Vc 178,180,181
Vc 179,182,183
Mvaa 136,236,140
Aw 152,176
Aw 153,177
Aw 154,178
Aw 155,179
s_waitcnt lgkmcnt(0)
Zvaa 140,240,128
v_mul_f32 v184, s94, v184
v_mul_f32 v185, s94, v185
v_mul_f32 v186, s94, v186
v_mul_f32_e64 v187, s94, v187
Mvaa 140,244,132
v_mul_f32 v188, s94, v188
v_mul_f32 v189, s94, v189
v_mul_f32 v190, s94, v190
v_mul_f32 v191, s94, v191
Mvaa 140,248,136
Vc 184,184,185
Vc 185,186,187
Vc 186,188,189
Vc 187,190,191
Mvaa 140,252,140
Aw 156,184
Aw 157,185
Aw 158,186
Aw 159,187
Zvaa 144,192,144
v_mul_f32 v192, s94, v192
v_mul_f32 v193, s94, v193
v_mul_f32 v194, s94, v194
v_mul_f32 v195, s94, v195
Mvaa 144,196,148
v_mul_f32 v196, s94, v196
v_mul_f32 v197, s94, v197
v_mul_f32 v198, s94, v198
v_mul_f32 v199, s94, v199
Mvaa 144,200,152
Vc 192,192,193
Vc 193,194,195
Vc 194,196,197
Vc 195,198,199
Mvaa 144,204,156
Aw 160,192
Aw 161,193
Aw 162,194
Aw 163,195
Zvaa 148,208,144
v_mul_f32 v200, s94, v200
v_mul_f32 v201, s94, v201
v_mul_f32 v202, s94, v202
v_mul_f32 v203, s94, v203
Mvaa 148,212,148
v_mul_f32 v204, s94, v204
v_mul_f32 v205, s94, v205
v_mul_f32 v206, s94, v206
v_mul_f32 v207, s94, v207
Mvaa 148,216,152
Vc 200,200,201
Vc 201,202,203
Vc 202,204,205
Vc 203,206,207
Mvaa 148,220,156
Aw 164,200
Aw 165,201
Aw 166,202
Aw 167,203
Zvaa 152,224,144
v_mul_f32 v208, s94, v208
v_mul_f32 v209, s94, v209
v_mul_f32 v210, s94, v210
v_mul_f32 v211, s94, v211
Mvaa 152,228,148
v_mul_f32 v212, s94, v212
v_mul_f32 v213, s94, v213
v_mul_f32 v214, s94, v214
v_mul_f32 v215, s94, v215
Mvaa 152,232,152
Vc 208,208,209
Vc 209,210,211
Vc 210,212,213
Vc 211,214,215
Mvaa 152,236,156
Aw 168,208
Aw 169,209
Aw 170,210
Aw 171,211
Zvaa 156,240,144
v_mul_f32 v216, s94, v216
v_mul_f32 v217, s94, v217
v_mul_f32 v218, s94, v218
v_mul_f32 v219, s94, v219
Mvaa 156,244,148
v_mul_f32 v220, s94, v220
v_mul_f32 v221, s94, v221
v_mul_f32 v222, s94, v222
v_mul_f32 v223, s94, v223
Mvaa 156,248,152
Vc 216,216,217
Vc 217,218,219
Vc 218,220,221
Vc 219,222,223
Mvaa 156,252,156
Aw 172,216
Aw 173,217
Aw 174,218
Aw 175,219
Zvaa 160,192,160
v_mul_f32 v224, s94, v224
v_mul_f32 v225, s94, v225
v_mul_f32 v226, s94, v226
v_mul_f32 v227, s94, v227
Mvaa 160,196,164
v_mul_f32 v228, s94, v228
v_mul_f32 v229, s94, v229
v_mul_f32 v230, s94, v230
v_mul_f32 v231, s94, v231
Mvaa 160,200,168
Vc 224,224,225
Vc 225,226,227
Vc 226,228,229
Vc 227,230,231
Mvaa 160,204,172
Aw 176,224
Aw 177,225
Aw 178,226
Aw 179,227
Zvaa 164,208,160
v_mul_f32 v232, s94, v232
v_mul_f32 v233, s94, v233
v_mul_f32 v234, s94, v234
v_mul_f32 v235, s94, v235
Mvaa 164,212,164
v_mul_f32 v236, s94, v236
v_mul_f32 v237, s94, v237
v_mul_f32 v238, s94, v238
v_mul_f32 v239, s94, v239
Mvaa 164,216,168
Vc 232,232,233
Vc 233,234,235
Vc 234,236,237
Vc 235,238,239
Mvaa 164,220,172
Aw 180,232
Aw 181,233
Aw 182,234
Aw 183,235
Zvaa 168,224,160
v_mul_f32 v240, s94, v240
v_mul_f32 v241, s94, v241
v_mul_f32 v242, s94, v242
v_mul_f32 v243, s94, v243
Mvaa 168,228,164
v_mul_f32 v244, s94, v244
v_mul_f32 v245, s94, v245
v_mul_f32 v246, s94, v246
v_mul_f32 v247, s94, v247
Mvaa 168,232,168
Vc 240,240,241
Vc 241,242,243
Vc 242,244,245
Vc 243,246,247
Mvaa 168,236,172
Aw 184,240
Aw 185,241
Aw 186,242
Aw 187,243
Zvaa 172,240,160
v_mul_f32 v248, s94, v248
v_mul_f32 v249, s94, v249
v_mul_f32 v250, s94, v250
v_mul_f32 v251, s94, v251
Mvaa 172,244,164
v_mul_f32 v252, s94, v252
v_mul_f32 v253, s94, v253
v_mul_f32 v254, s94, v254
v_mul_f32 v255, s94, v255
Mvaa 172,248,168
Vc 248,248,249
Vc 249,250,251
Vc 250,252,253
Vc 251,254,255
Mvaa 172,252,172
Aw 188,248
Aw 189,249
Aw 190,250
Aw 191,251
Zvaa 176,192,176
v_accvgpr_write_b32 a96, 0
v_accvgpr_write_b32 a97, 0
v_accvgpr_write_b32 a98, 0
v_accvgpr_write_b32 a99, 0
Mvaa 176,196,180
v_accvgpr_write_b32 a100, 0
v_accvgpr_write_b32 a101, 0
v_accvgpr_write_b32 a102, 0
v_accvgpr_write_b32 a103, 0
Mvaa 176,200,184
v_accvgpr_write_b32 a104, 0
v_accvgpr_write_b32 a105, 0
v_accvgpr_write_b32 a106, 0
v_accvgpr_write_b32 a107, 0
Mvaa 176,204,188
v_accvgpr_write_b32 a108, 0
v_accvgpr_write_b32 a109, 0
v_accvgpr_write_b32 a110, 0
v_accvgpr_write_b32 a111, 0
Zvaa 180,208,176
v_accvgpr_write_b32 a112, 0
v_accvgpr_write_b32 a113, 0
v_accvgpr_write_b32 a114, 0
v_accvgpr_write_b32 a115, 0
Mvaa 180,212,180
v_accvgpr_write_b32 a116, 0
v_accvgpr_write_b32 a117, 0
v_accvgpr_write_b32 a118, 0
v_accvgpr_write_b32 a119, 0
Mvaa 180,216,184
v_accvgpr_write_b32 a120, 0
v_accvgpr_write_b32 a121, 0
v_accvgpr_write_b32 a122, 0
v_accvgpr_write_b32 a123, 0
Mvaa 180,220,188
v_accvgpr_write_b32 a124, 0
v_accvgpr_write_b32 a125, 0
v_accvgpr_write_b32 a126, 0
v_accvgpr_write_b32 a127, 0
s_waitcnt vmcnt(16)
s_barrier
s_add_u32 s53, s44, 65536
Zvaa 184,224,176
Ra 192,3,32768
v_mov_b32 v16, 0x3f803f80
v_mov_b32 v17, 0x3f803f80
v_mov_b32 v18, 0x3f803f80
v_mov_b32 v19, 0x3f803f80
Mvaa 184,228,180
Ra 196,3,33792
v_mov_b32 v20, 0xff800000
v_max3_f32 v22, v128, v129, v130
v_max3_f32 v22, v22, v131, v132
v_max3_f32 v22, v22, v133, v134
Mvaa 184,232,184
Ra 200,3,34816
v_max3_f32 v22, v22, v135, v136
v_max3_f32 v22, v22, v137, v138
v_max3_f32 v22, v22, v139, v140
v_max3_f32 v22, v22, v141, v142
Mvaa 184,236,188
Ra 204,3,35840
v_max_f32 v22, v22, v143
v_mov_b32 v1, v22
s_nop 1
v_permlane16_swap_b32 v1, v22
v_max_f32_e64 v22, v22, v1
Zvaa 188,240,176
Ra 208,3,36864
v_mov_b32 v1, v22
s_nop 1
v_permlane32_swap_b32 v1, v22
v_max_f32 v22, v22, v1
v_add_f32 v22, 0x41f80000, v22
Mvaa 188,244,180
Ra 212,3,37888
Vs 128,128,22
Vs 129,129,22
Vs 130,130,22
Vs 131,131,22
Mvaa 188,248,184
Ra 216,3,38912
Vs 132,132,22
Vs 133,133,22
Vs 134,134,22
Vs 135,135,22
Mvaa 188,252,188
Ra 220,3,39936
Vs 136,136,22
Vs 137,137,22
Vs 138,138,22
Vs 139,139,22
Vs 140,140,22
Vs 141,141,22
Vs 142,142,22
Vs 143,143,22
v_sub_f32 v32, 0, v22
v_sub_f32 v33, 0, v22
v_sub_f32 v34, 0, v22
v_sub_f32 v35, 0, v22
v_max3_f32 v22, v144, v145, v146
v_max3_f32 v22, v22, v147, v148
v_max3_f32 v22, v22, v149, v150
v_max3_f32 v22, v22, v151, v152
v_max3_f32 v22, v22, v153, v154
v_max3_f32 v22, v22, v155, v156
v_max3_f32 v22, v22, v157, v158
v_max_f32 v22, v22, v159
v_mov_b32 v1, v22
s_nop 1
v_permlane16_swap_b32 v1, v22
v_max_f32 v22, v22, v1
v_mov_b32 v1, v22
s_nop 1
v_permlane32_swap_b32 v1, v22
v_max_f32_e64 v22, v22, v1
v_add_f32 v22, 0x41f80000, v22
Vs 144,144,22
Vs 145,145,22
Vs 146,146,22
Vs 147,147,22
Vs 148,148,22
Vs 149,149,22
Vs 150,150,22
Vs 151,151,22
Vs 152,152,22
Vs 153,153,22
Vs 154,154,22
Vs 155,155,22
Vs 156,156,22
Vs 157,157,22
Vs 158,158,22
Vs 159,159,22
v_sub_f32 v36, 0, v22
v_sub_f32 v37, 0, v22
v_sub_f32 v38, 0, v22
v_sub_f32 v39, 0, v22
s_mov_b32 s38, 139264
s_mov_b32 s39, 121856
s_cmp_lg_u32 s34, 0
s_cbranch_scc1 L_k2_nomask0
v_cmp_gt_i32 s[56:57], 0, v5
v_cmp_gt_i32 s[58:59], 1, v5
v_cmp_gt_i32 s[60:61], 2, v5
v_cmp_gt_i32 s[62:63], 3, v5
s_nop 3
s_nop 0
v_cndmask_b32 v176, v176, v20, s[56:57]
v_cndmask_b32 v177, v177, v20, s[58:59]
v_cndmask_b32 v178, v178, v20, s[60:61]
v_cndmask_b32 v179, v179, v20, s[62:63]
v_cmp_gt_i32 s[56:57], 16, v5
v_cmp_gt_i32 s[58:59], 17, v5
v_cmp_gt_i32 s[60:61], 18, v5
v_cmp_gt_i32 s[62:63], 19, v5
v_cndmask_b32 v180, v180, v20, s[56:57]
v_cndmask_b32 v181, v181, v20, s[58:59]
v_cndmask_b32 v182, v182, v20, s[60:61]
v_cndmask_b32 v183, v183, v20, s[62:63]
v_cmp_gt_i32 s[56:57], 32, v5
v_cmp_gt_i32 s[58:59], 33, v5
v_cmp_gt_i32 s[60:61], 34, v5
v_cmp_gt_i32 s[62:63], 35, v5
v_cndmask_b32 v184, v184, v20, s[56:57]
v_cndmask_b32 v185, v185, v20, s[58:59]
v_cndmask_b32 v186, v186, v20, s[60:61]
v_cndmask_b32 v187, v187, v20, s[62:63]
v_cmp_gt_i32 s[56:57], 48, v5
v_cmp_gt_i32 s[58:59], 49, v5
v_cmp_gt_i32 s[60:61], 50, v5
v_cmp_gt_i32 s[62:63], 51, v5
v_cndmask_b32 v188, v188, v20, s[56:57]
v_cndmask_b32 v189, v189, v20, s[58:59]
v_cndmask_b32 v190, v190, v20, s[60:61]
v_cndmask_b32 v191, v191, v20, s[62:63]
L_k2_nomask0:
s_mov_b32 s37, 0
s_nop 0
v_max3_f32 v22, v160, v161, v162
v_max3_f32 v22, v22, v163, v164
v_max3_f32 v22, v22, v165, v166
v_max3_f32 v22, v22, v167, v168
v_max3_f32 v22, v22, v169, v170
v_max3_f32 v22, v22, v171, v172
v_max3_f32 v22, v22, v173, v174
v_max_f32 v22, v22, v175
v_mov_b32 v1, v22
s_nop 1
v_permlane16_swap_b32 v1, v22
v_max_f32 v22, v22, v1
v_mov_b32 v1, v22
s_nop 1
v_permlane32_swap_b32 v1, v22
v_max_f32_e64 v22, v22, v1
v_add_f32 v22, 0x41f80000, v22
Vs 160,160,22
Vs 161,161,22
Vs 162,162,22
Vs 163,163,22
Vs 164,164,22
Vs 165,165,22
Vs 166,166,22
Vs 167,167,22
Vs 168,168,22
Vs 169,169,22
Vs 170,170,22
Vs 171,171,22
Vs 172,172,22
Vs 173,173,22
Vs 174,174,22
Vs 175,175,22
v_sub_f32 v40, 0, v22
v_sub_f32 v41, 0, v22
v_sub_f32 v42, 0, v22
v_sub_f32 v43, 0, v22
v_max3_f32 v22, v176, v177, v178
v_max3_f32 v22, v22, v179, v180
v_max3_f32 v22, v22, v181, v182
v_max3_f32 v22, v22, v183, v184
v_max3_f32 v22, v22, v185, v186
v_max3_f32 v22, v22, v187, v188
v_max3_f32 v22, v22, v189, v190
v_max_f32 v22, v22, v191
v_mov_b32 v1, v22
s_nop 1
v_permlane16_swap_b32 v1, v22
v_max_f32 v22, v22, v1
v_mov_b32 v1, v22
s_nop 1
v_permlane32_swap_b32 v1, v22
v_max_f32_e64 v22, v22, v1
v_add_f32 v22, 0x41f80000, v22
Vs 176,176,22
Vs 177,177,22
Vs 178,178,22
Vs 179,179,22
Vs 180,180,22
Vs 181,181,22
Vs 182,182,22
Vs 183,183,22
Vs 184,184,22
Vs 185,185,22
Vs 186,186,22
Vs 187,187,22
Vs 188,188,22
Vs 189,189,22
Vs 190,190,22
Vs 191,191,22
v_sub_f32 v44, 0, v22
v_sub_f32 v45, 0, v22
v_sub_f32 v46, 0, v22
v_sub_f32 v47, 0, v22
Ve 8,128
Ve 9,129
Ve 10,130
Ve 11,131
Vc 64,8,9
Ve 12,144
Ve 13,145
Vc 65,10,11
Ve 14,146
Ve 15,147
Vc 72,12,13
Ve 8,160
Ve 9,161
Vc 73,14,15
Ve 10,162
Ve 11,163
Vc 80,8,9
Ve 12,176
Ve 13,177
Vc 81,10,11
Ve 14,178
Ve 15,179
Vc 88,12,13
Ve 8,132
Ve 9,133
Vc 89,14,15
Ve 10,134
Ve 11,135
Vc 66,8,9
Ve 12,148
Ve 13,149
Vc 67,10,11
Ve 14,150
Ve 15,151
Vc 74,12,13
Ve 8,164
Ve 9,165
Vc 75,14,15
Ve 10,166
Ve 11,167
Vc 82,8,9
Ve 12,180
Ve 13,181
Vc 83,10,11
Ve 14,182
Ve 15,183
Vc 90,12,13
Vc 91,14,15
v_or_b32_e64 v7, v64, v65
v_or3_b32 v7, v7, v72, v73
v_or3_b32 v7, v7, v80, v81
v_or3_b32 v7, v7, v88, v89
v_or3_b32 v7, v7, v66, v67
v_or3_b32 v7, v7, v74, v75
v_or3_b32 v7, v7, v82, v83
v_or3_b32 v7, v7, v90, v91
s_waitcnt lgkmcnt(4)
s_cmp_eq_u32 s34, 0
s_cbranch_scc1 L_k2_wlast
s_branch L_k2_wloop
L_k2_mk_wo:
v_cmp_gt_i32 s[56:57], 0, v5
v_cmp_gt_i32 s[58:59], 1, v5
v_cmp_gt_i32 s[60:61], 2, v5
v_cmp_gt_i32 s[62:63], 3, v5
s_nop 3
s_nop 0
v_cndmask_b32 v176, v176, v20, s[56:57]
v_cndmask_b32 v177, v177, v20, s[58:59]
v_cndmask_b32 v178, v178, v20, s[60:61]
v_cndmask_b32 v179, v179, v20, s[62:63]
v_cmp_gt_i32 s[56:57], 16, v5
v_cmp_gt_i32 s[58:59], 17, v5
v_cmp_gt_i32 s[60:61], 18, v5
v_cmp_gt_i32 s[62:63], 19, v5
v_cndmask_b32 v180, v180, v20, s[56:57]
v_cndmask_b32 v181, v181, v20, s[58:59]
v_cndmask_b32 v182, v182, v20, s[60:61]
v_cndmask_b32 v183, v183, v20, s[62:63]
v_cmp_gt_i32 s[56:57], 32, v5
v_cmp_gt_i32 s[58:59], 33, v5
v_cmp_gt_i32 s[60:61], 34, v5
v_cmp_gt_i32 s[62:63], 35, v5
v_cndmask_b32 v184, v184, v20, s[56:57]
v_cndmask_b32 v185, v185, v20, s[58:59]
v_cndmask_b32 v186, v186, v20, s[60:61]
v_cndmask_b32 v187, v187, v20, s[62:63]
v_cmp_gt_i32 s[56:57], 48, v5
v_cmp_gt_i32 s[58:59], 49, v5
v_cmp_gt_i32 s[60:61], 50, v5
v_cmp_gt_i32 s[62:63], 51, v5
v_cndmask_b32 v188, v188, v20, s[56:57]
v_cndmask_b32 v189, v189, v20, s[58:59]
v_cndmask_b32 v190, v190, v20, s[60:61]
v_cndmask_b32 v191, v191, v20, s[62:63]
s_branch L_k2_mkr_wo
L_k2_mk_tr:
v_cmp_gt_i32 s[56:57], 0, v5
v_cmp_gt_i32 s[58:59], 1, v5
v_cmp_gt_i32 s[60:61], 2, v5
v_cmp_gt_i32 s[62:63], 3, v5
s_nop 3
v_cndmask_b32 v144, v144, v20, s[56:57]
v_cndmask_b32 v145, v145, v20, s[58:59]
v_cndmask_b32 v146, v146, v20, s[60:61]
v_cndmask_b32 v147, v147, v20, s[62:63]
v_cmp_gt_i32 s[56:57], 16, v5
v_cmp_gt_i32 s[58:59], 17, v5
v_cmp_gt_i32 s[60:61], 18, v5
v_cmp_gt_i32 s[62:63], 19, v5
v_cndmask_b32 v148, v148, v20, s[56:57]
v_cndmask_b32 v149, v149, v20, s[58:59]
v_cndmask_b32 v150, v150, v20, s[60:61]
v_cndmask_b32 v151, v151, v20, s[62:63]
v_cmp_gt_i32 s[56:57], 32, v5
v_cmp_gt_i32 s[58:59], 33, v5
v_cmp_gt_i32 s[60:61], 34, v5
v_cmp_gt_i32 s[62:63], 35, v5
v_cndmask_b32 v152, v152, v20, s[56:57]
v_cndmask_b32 v153, v153, v20, s[58:59]
v_cndmask_b32 v154, v154, v20, s[60:61]
v_cndmask_b32 v155, v155, v20, s[62:63]
v_cmp_gt_i32 s[56:57], 48, v5
v_cmp_gt_i32 s[58:59], 49, v5
v_cmp_gt_i32 s[60:61], 50, v5
v_cmp_gt_i32 s[62:63], 51, v5
v_cndmask_b32 v156, v156, v20, s[56:57]
v_cndmask_b32 v157, v157, v20, s[58:59]
v_cndmask_b32 v158, v158, v20, s[60:61]
v_cndmask_b32 v159, v159, v20, s[62:63]
s_branch L_k2_mkr_tr
L_k2_mk_no:
v_cmp_gt_i32 s[56:57], 0, v5
v_cmp_gt_i32 s[58:59], 1, v5
v_cmp_gt_i32 s[60:61], 2, v5
v_cmp_gt_i32 s[62:63], 3, v5
s_nop 3
v_cndmask_b32 v144, v144, v20, s[56:57]
v_cndmask_b32 v145, v145, v20, s[58:59]
v_cndmask_b32 v146, v146, v20, s[60:61]
v_cndmask_b32 v147, v147, v20, s[62:63]
v_cmp_gt_i32 s[56:57], 16, v5
v_cmp_gt_i32 s[58:59], 17, v5
v_cmp_gt_i32 s[60:61], 18, v5
v_cmp_gt_i32 s[62:63], 19, v5
v_cndmask_b32 v148, v148, v20, s[56:57]
v_cndmask_b32 v149, v149, v20, s[58:59]
v_cndmask_b32 v150, v150, v20, s[60:61]
v_cndmask_b32 v151, v151, v20, s[62:63]
v_cmp_gt_i32 s[56:57], 32, v5
v_cmp_gt_i32 s[58:59], 33, v5
v_cmp_gt_i32 s[60:61], 34, v5
v_cmp_gt_i32 s[62:63], 35, v5
v_cndmask_b32 v152, v152, v20, s[56:57]
v_cndmask_b32 v153, v153, v20, s[58:59]
v_cndmask_b32 v154, v154, v20, s[60:61]
v_cndmask_b32 v155, v155, v20, s[62:63]
v_cmp_gt_i32 s[56:57], 48, v5
v_cmp_gt_i32 s[58:59], 49, v5
v_cmp_gt_i32 s[60:61], 50, v5
v_cmp_gt_i32 s[62:63], 51, v5
v_cndmask_b32 v156, v156, v20, s[56:57]
v_cndmask_b32 v157, v157, v20, s[58:59]
v_cndmask_b32 v158, v158, v20, s[60:61]
v_cndmask_b32 v159, v159, v20, s[62:63]
s_branch L_k2_mkr_no
L_pubB:
v_mov_b32 v24, 1
v_mov_b32 v25, 0
s_mov_b64 exec, 1
buffer_store_dword v24, v25, s[20:23], s64 offen sc1
s_mov_b64 exec, -1
s_branch L_pubBr
L_k2_wloop:
v_xor_b32 v2, 65536, v2
v_xor_b32 v3, 65536, v3
Cvaa 192,192,128,32
s_mov_b32 m0, s53
Ra 224,2,40960
v_lshl_add_u64 v[28:29], s[40:41], 0, v[28:29]
Mvaa 192,196,132
buffer_load_dwordx4 v4, s[12:15], s38 offen offset:0 sc1 lds
Mvaa 192,200,136
Ve 8,136
Mvaa 192,204,140
VE 9,137
Cvaa 208,192,144,36
Ra 228,2,41984
Vc 68,8,9
Mvaa 208,196,148
VE 10,138
Mvaa 208,200,152
VE 11,139
Mvaa 208,204,156
Ra 232,2,43008
Vc 69,10,11
Cvaa 224,192,160,40
Ra 236,2,44032
v_or3_b32 v7, v7, v68, v69
Mvaa 224,196,164
VE 12,152
Mvaa 224,200,168
VE 13,153
Mvaa 224,204,172
Ra 240,2,45056
Vc 76,12,13
Cvaa 240,192,176,44
VE 14,154
Mvaa 240,196,180
VE 15,155
Mvaa 240,200,184
Ra 244,2,46080
Vc 77,14,15
Mvaa 240,204,188
s_waitcnt lgkmcnt(6)
Ra 248,2,47104
v_or3_b32 v7, v7, v76, v77
Cvaa 196,208,128,32
buffer_load_dwordx4 v4, s[12:15], s38 offen offset:1024 sc1 lds
Mvaa 196,212,132
Ve 8,168
Mvaa 196,216,136
VE 9,169
Mvaa 196,220,140
Ra 252,2,48128
Vc 84,8,9
Cvaa 212,208,144,36
VE 10,170
Mvaa 212,212,148
VE 11,171
Mvaa 212,216,152
Ra 192,2,16384
Vc 85,10,11
Mvaa 212,220,156
Ra 196,2,24576
v_or3_b32 v7, v7, v84, v85
Cvaa 228,208,160,40
VE 12,184
Mvaa 228,212,164
VE 13,185
Mvaa 228,216,168
Ra 200,2,17408
Vc 92,12,13
Mvaa 228,220,172
VE 14,186
Cvaa 244,208,176,44
VE 15,187
Mvaa 244,212,180
buffer_load_dwordx4 v4, s[12:15], s38 offen offset:2048 sc1 lds
Mvaa 244,216,184
Ra 204,2,25600
Vc 93,14,15
Mvaa 244,220,188
s_waitcnt lgkmcnt(8)
Ve 8,140
Cvaa 200,224,128,32
Ra 208,2,18432
v_or3_b32 v7, v7, v92, v93
Mvaa 200,228,132
VE 9,141
Mvaa 200,232,136
Ra 212,2,26624
Vc 70,8,9
Mvaa 200,236,140
VE 10,142
Cvaa 216,224,144,36
VE 11,143
Mvaa 216,228,148
Ra 216,2,19456
Vc 71,10,11
Mvaa 216,232,152
Ra 220,2,27648
v_or3_b32 v7, v7, v70, v71
Mvaa 216,236,156
VE 12,156
Cvaa 232,224,160,40
VE 13,157
Mvaa 232,228,164
VE 14,158
Mvaa 232,232,168
VE 15,159
Mvaa 232,236,172
buffer_load_dwordx4 v4, s[12:15], s38 offen offset:3072 sc1 lds
Cvaa 248,224,176,44
VE 8,172
Mvaa 248,228,180
VE 9,173
Mvaa 248,232,184
Vc 78,12,13
Vc 79,14,15
Mvaa 248,236,188
s_waitcnt lgkmcnt(8)
Ve 10,174
Cvaa 204,240,128,32
VE 11,175
Mvaa 204,244,132
Vc 86,8,9
Vc 87,10,11
Mvaa 204,248,136
VE 12,188
Mvaa 204,252,140
VE 13,189
Cvaa 220,240,144,36
Vc 94,12,13
v_or3_b32 v7, v7, v78, v79
Mvaa 220,244,148
VE 14,190
Mvaa 220,248,152
VE 15,191
Mvaa 220,252,156
Vc 95,14,15
v_or3_b32 v7, v7, v86, v87
Cvaa 236,240,160,40
v_or3_b32 v7, v7, v94, v95
v_and_b32 v1, 0x40004000, v7
Mvaa 236,244,164
v_cmp_ne_u32 vcc, 0, v1
Mvaa 236,248,168
Mvaa 236,252,172
s_waitcnt vmcnt(12)
Cvaa 252,240,176,44
Mvaa 252,244,180
s_barrier
Mvaa 252,248,184
s_waitcnt lgkmcnt(4)
Mvaa 252,252,188
s_cbranch_vccnz L_k2_fb_we
L_k2_fbr_we:
Maav 0,192,64
Ve 8,192
Maav 0,196,68
s_add_u32 m0, s54, 49152
VE 9,193
Maav 32,192,72
buffer_load_dwordx4 v4, s[12:15], s39 offen offset:0 sc1 lds
Maav 32,196,76
s_add_u32 s37, s37, 1
Ra 224,2,20480
Vc 96,8,9
Maav 64,192,80
s_add_u32 s38, s38, 34816
Ve 10,194
Maav 64,196,84
VE 11,195
Maav 96,192,88
Ra 228,2,28672
Vc 97,10,11
Maav 96,196,92
Ra 232,2,21504
v_or_b32_e64 v7, v96, v97
Maav 4,200,64
VE 12,208
Maav 4,204,68
VE 13,209
Maav 36,200,72
Ra 236,2,29696
Vc 104,12,13
Maav 36,204,76
VE 14,210
Maav 68,200,80
VE 15,211
Maav 68,204,84
Ra 240,2,22528
Vc 105,14,15
Maav 100,200,88
Ra 244,2,30720
v_or3_b32 v7, v7, v104, v105
Maav 100,204,92
buffer_load_dwordx4 v4, s[12:15], s39 offen offset:1024 sc1 lds
Mvvv 48,16,64
VE 8,224
Mvvv 48,16,68
s_waitcnt lgkmcnt(6)
Ve 9,225
Maav 8,208,64
Ra 248,2,23552
Vc 112,8,9
Maav 8,212,68
VE 10,226
Maav 40,208,72
VE 11,227
Maav 40,212,76
Ra 252,2,31744
Vc 113,10,11
Maav 72,208,80
Ra 192,3,0
v_or3_b32 v7, v7, v112, v113
Maav 72,212,84
VE 12,240
Maav 104,208,88
VE 13,241
Maav 104,212,92
Ra 196,3,1024
Vc 120,12,13
Maav 12,216,64
VE 14,242
Maav 12,220,68
VE 15,243
Maav 44,216,72
Ra 200,3,2048
Vc 121,14,15
Maav 44,220,76
buffer_load_dwordx4 v4, s[12:15], s39 offen offset:2048 sc1 lds
Maav 76,216,80
Ra 204,3,3072
v_or3_b32 v7, v7, v120, v121
Maav 76,220,84
VE 8,196
Maav 108,216,88
VE 9,197
Maav 108,220,92
VE 10,198
Mvvv 52,16,72
VE 11,199
Mvvv 52,16,76
s_waitcnt lgkmcnt(8)
Ve 12,212
Maav 16,224,64
Ra 208,3,4096
Vc 98,8,9
Maav 16,228,68
Ra 212,3,5120
Vc 99,10,11
Maav 48,224,72
Ra 216,3,6144
v_or3_b32 v7, v7, v98, v99
Maav 48,228,76
VE 13,213
Maav 80,224,80
Ra 220,3,7168
Vc 106,12,13
Maav 80,228,84
VE 14,214
Maav 112,224,88
buffer_load_dwordx4 v4, s[12:15], s39 offen offset:3072 sc1 lds
Maav 112,228,92
s_add_u32 s39, s39, 34816
VE 15,215
Maav 20,232,64
VE 8,228
Maav 20,236,68
VE 9,229
Maav 52,232,72
VE 10,230
Maav 52,236,76
VE 11,231
Maav 84,232,80
Vc 107,14,15
Vc 114,8,9
Maav 84,236,84
VE 12,244
Maav 116,232,88
VE 13,245
Maav 116,236,92
Vc 115,10,11
Vc 122,12,13
Mvvv 56,16,80
VE 14,246
Mvvv 56,16,84
s_waitcnt lgkmcnt(8)
Ve 15,247
Maav 24,240,64
Vc 123,14,15
v_or3_b32 v7, v7, v106, v107
Maav 24,244,68
v_or3_b32 v7, v7, v114, v115
v_or3_b32 v7, v7, v122, v123
Maav 56,240,72
global_load_dword v30, v[28:29], off
Maav 56,244,76
Maav 88,240,80
Maav 88,244,84
Maav 120,240,88
Maav 120,244,92
Maav 28,248,64
Maav 28,252,68
Maav 60,248,72
Maav 60,252,76
Maav 92,248,80
Maav 92,252,84
Maav 124,248,88
Maav 124,252,92
Mvvv 60,16,88
s_waitcnt lgkmcnt(4)
Mvvv 60,16,92
Ve 8,200
Cvaa 128,192,128,32
s_add_u32 m0, s53, 32768
Ra 224,3,8192
v_lshl_add_u64 v[28:29], s[40:41], 0, v[28:29]
Mvaa 128,196,132
buffer_load_dwordx4 v4, s[12:15], s38 offen offset:0 sc1 lds
Mvaa 128,200,136
VE 9,201
Mvaa 128,204,140
Ra 228,3,9216
Vc 100,8,9
Cvaa 144,192,144,36
VE 10,202
Mvaa 144,196,148
VE 11,203
Mvaa 144,200,152
Ra 232,3,10240
Vc 101,10,11
Mvaa 144,204,156
Ra 236,3,11264
v_or3_b32 v7, v7, v100, v101
Cvaa 160,192,160,40
VE 12,216
Mvaa 160,196,164
VE 13,217
Mvaa 160,200,168
Ra 240,3,12288
Vc 108,12,13
Mvaa 160,204,172
VE 14,218
Cvaa 176,192,176,44
VE 15,219
Mvaa 176,196,180
Ra 244,3,13312
Vc 109,14,15
Mvaa 176,200,184
Ra 248,3,14336
v_or3_b32 v7, v7, v108, v109
Mvaa 176,204,188
s_waitcnt lgkmcnt(7)
Ve 8,232
Cvaa 132,208,128,32
buffer_load_dwordx4 v4, s[12:15], s38 offen offset:1024 sc1 lds
Mvaa 132,212,132
VE 9,233
Mvaa 132,216,136
Ra 252,3,15360
Vc 116,8,9
Mvaa 132,220,140
VE 10,234
Cvaa 148,208,144,36
VE 11,235
Mvaa 148,212,148
Ra 192,2,49152
Vc 117,10,11
Mvaa 148,216,152
Ra 196,2,57344
v_or3_b32 v7, v7, v116, v117
Mvaa 148,220,156
VE 12,248
Cvaa 164,208,160,40
VE 13,249
Mvaa 164,212,164
Ra 200,2,50176
Vc 124,12,13
Mvaa 164,216,168
VE 14,250
Mvaa 164,220,172
VE 15,251
Cvaa 180,208,176,44
Ra 204,2,58368
Vc 125,14,15
Mvaa 180,212,180
buffer_load_dwordx4 v4, s[12:15], s38 offen offset:2048 sc1 lds
Mvaa 180,216,184
VE 8,204
Mvaa 180,220,188
s_waitcnt lgkmcnt(8)
Ve 9,205
Cvaa 136,224,128,32
Ra 208,2,51200
Vc 102,8,9
Mvaa 136,228,132
Ra 212,2,59392
v_or3_b32 v7, v7, v124, v125
Mvaa 136,232,136
VE 10,206
Mvaa 136,236,140
VE 11,207
Cvaa 152,224,144,36
Ra 216,2,52224
Vc 103,10,11
Mvaa 152,228,148
Ra 220,2,60416
v_or3_b32 v7, v7, v102, v103
Mvaa 152,232,152
VE 12,220
Mvaa 152,236,156
VE 13,221
Cvaa 168,224,160,40
VE 14,222
Mvaa 168,228,164
VE 15,223
Mvaa 168,232,168
VE 8,236
Mvaa 168,236,172
buffer_load_dwordx4 v4, s[12:15], s38 offen offset:3072 sc1 lds
Cvaa 184,224,176,44
VE 9,237
Mvaa 184,228,180
Vc 110,12,13
Vc 111,14,15
Mvaa 184,232,184
VE 10,238
Mvaa 184,236,188
s_waitcnt lgkmcnt(8)
Ve 11,239
Cvaa 140,240,128,32
Vc 118,8,9
Vc 119,10,11
Mvaa 140,244,132
VE 12,252
Mvaa 140,248,136
VE 13,253
Mvaa 140,252,140
Vc 126,12,13
v_or3_b32 v7, v7, v110, v111
Cvaa 156,240,144,36
VE 14,254
Mvaa 156,244,148
VE 15,255
Mvaa 156,248,152
Vc 127,14,15
v_or3_b32 v7, v7, v118, v119
Mvaa 156,252,156
v_or3_b32 v7, v7, v126, v127
v_and_b32 v1, 0x40004000, v7
Cvaa 172,240,160,40
v_cmp_ne_u32 vcc, 0, v1
Mvaa 172,244,164
Mvaa 172,248,168
Mvaa 172,252,172
s_waitcnt vmcnt(12)
Cvaa 188,240,176,44
s_cmp_eq_u32 s37, s46
Mvaa 188,244,180
s_barrier
Mvaa 188,248,184
s_waitcnt lgkmcnt(4)
Mvaa 188,252,188
s_cbranch_vccnz L_k2_fb_wo
L_k2_fbr_wo:
Maav 0,192,96
s_cbranch_scc1 L_k2_mk_wo
L_k2_mkr_wo:
Ve 8,128
Maav 0,196,100
s_add_u32 m0, s53, 16384
VE 9,129
Maav 32,192,104
buffer_load_dwordx4 v4, s[12:15], s39 offen offset:0 sc1 lds
Maav 32,196,108
s_add_u32 s37, s37, 1
Ra 224,2,53248
Vc 64,8,9
Maav 64,192,112
s_add_u32 s38, s38, 34816
Ve 10,130
Maav 64,196,116
s_xor_b32 s53, s53, 65536
VE 11,131
Maav 96,192,120
s_xor_b32 s54, s54, 65536
Ra 228,2,61440
Vc 65,10,11
Maav 96,196,124
Ra 232,2,54272
v_or_b32_e64 v7, v64, v65
Maav 4,200,96
VE 12,144
Maav 4,204,100
VE 13,145
Maav 36,200,104
Ra 236,2,62464
Vc 72,12,13
Maav 36,204,108
VE 14,146
Maav 68,200,112
VE 15,147
Maav 68,204,116
Ra 240,2,55296
Vc 73,14,15
Maav 100,200,120
Ra 244,2,63488
v_or3_b32 v7, v7, v72, v73
Maav 100,204,124
buffer_load_dwordx4 v4, s[12:15], s39 offen offset:1024 sc1 lds
Mvvv 48,16,96
VE 8,160
Mvvv 48,16,100
s_waitcnt lgkmcnt(6)
Ve 9,161
Maav 8,208,96
Ra 248,2,56320
Vc 80,8,9
Maav 8,212,100
VE 10,162
Maav 40,208,104
VE 11,163
Maav 40,212,108
Ra 252,2,64512
Vc 81,10,11
Maav 72,208,112
Ra 192,3,32768
v_or3_b32 v7, v7, v80, v81
Maav 72,212,116
VE 12,176
Maav 104,208,120
VE 13,177
Maav 104,212,124
Ra 196,3,33792
Vc 88,12,13
Maav 12,216,96
VE 14,178
Maav 12,220,100
VE 15,179
Maav 44,216,104
Ra 200,3,34816
Vc 89,14,15
Maav 44,220,108
buffer_load_dwordx4 v4, s[12:15], s39 offen offset:2048 sc1 lds
Maav 76,216,112
Ra 204,3,35840
v_or3_b32 v7, v7, v88, v89
Maav 76,220,116
VE 8,132
Maav 108,216,120
VE 9,133
Maav 108,220,124
VE 10,134
Mvvv 52,16,104
VE 11,135
Mvvv 52,16,108
s_waitcnt lgkmcnt(8)
Ve 12,148
Maav 16,224,96
Ra 208,3,36864
Vc 66,8,9
Maav 16,228,100
Ra 212,3,37888
Vc 67,10,11
Maav 48,224,104
Ra 216,3,38912
v_or3_b32 v7, v7, v66, v67
Maav 48,228,108
VE 13,149
Maav 80,224,112
Ra 220,3,39936
Vc 74,12,13
Maav 80,228,116
VE 14,150
Maav 112,224,120
buffer_load_dwordx4 v4, s[12:15], s39 offen offset:3072 sc1 lds
Maav 112,228,124
s_add_u32 s39, s39, 34816
VE 15,151
Maav 20,232,96
VE 8,164
Maav 20,236,100
VE 9,165
Maav 52,232,104
VE 10,166
Maav 52,236,108
VE 11,167
Maav 84,232,112
Vc 75,14,15
Vc 82,8,9
Maav 84,236,116
VE 12,180
Maav 116,232,120
VE 13,181
Maav 116,236,124
Vc 83,10,11
Vc 90,12,13
Mvvv 56,16,112
VE 14,182
Mvvv 56,16,116
s_waitcnt lgkmcnt(8)
Ve 15,183
Maav 24,240,96
Vc 91,14,15
v_or3_b32 v7, v7, v74, v75
Maav 24,244,100
v_or3_b32 v7, v7, v82, v83
v_or3_b32 v7, v7, v90, v91
Maav 56,240,104
global_load_dword v30, v[28:29], off
Maav 56,244,108
Maav 88,240,112
Maav 88,244,116
Maav 120,240,120
Maav 120,244,124
Maav 28,248,96
Maav 28,252,100
Maav 60,248,104
Maav 60,252,108
Maav 92,248,112
Maav 92,252,116
Maav 124,248,120
Maav 124,252,124
s_cmp_lg_u32 s37, s35
Mvvv 60,16,120
s_waitcnt lgkmcnt(4)
Mvvv 60,16,124
s_cbranch_scc1 L_k2_wloop
L_k2_wlast:
v_xor_b32 v2, 65536, v2
v_xor_b32 v3, 65536, v3
Cvaa 192,192,128,32
s_mov_b32 m0, s53
Ra 224,2,40960
v_lshl_add_u64 v[28:29], s[40:41], 0, v[28:29]
Mvaa 192,196,132
buffer_load_dwordx4 v4, s[12:15], s38 offen offset:0 sc1 lds
Mvaa 192,200,136
VE 8,136
Mvaa 192,204,140
VE 9,137
Cvaa 208,192,144,36
Ra 228,2,41984
Vc 68,8,9
Mvaa 208,196,148
VE 10,138
Mvaa 208,200,152
VE 11,139
Mvaa 208,204,156
Ra 232,2,43008
Vc 69,10,11
Cvaa 224,192,160,40
Ra 236,2,44032
v_or3_b32 v7, v7, v68, v69
Mvaa 224,196,164
VE 12,152
Mvaa 224,200,168
VE 13,153
Mvaa 224,204,172
s_waitcnt lgkmcnt(4)
Ra 240,2,45056
Vc 76,12,13
Cvaa 196,208,128,32
buffer_load_dwordx4 v4, s[12:15], s38 offen offset:1024 sc1 lds
Mvaa 196,212,132
Ve 14,154
Mvaa 196,216,136
VE 15,155
Mvaa 196,220,140
Ra 244,2,46080
Vc 77,14,15
Cvaa 212,208,144,36
Ra 248,2,47104
v_or3_b32 v7, v7, v76, v77
Mvaa 212,212,148
VE 8,168
Mvaa 212,216,152
VE 9,169
Mvaa 212,220,156
Ra 252,2,48128
Vc 84,8,9
Cvaa 228,208,160,40
VE 10,170
Mvaa 228,212,164
buffer_load_dwordx4 v4, s[12:15], s38 offen offset:2048 sc1 lds
Mvaa 228,216,168
VE 11,171
Mvaa 228,220,172
s_waitcnt lgkmcnt(4)
Ra 192,2,16384
Vc 85,10,11
Cvaa 200,224,128,32
Ra 196,2,24576
v_or3_b32 v7, v7, v84, v85
Mvaa 200,228,132
Ve 12,184
Mvaa 200,232,136
VE 13,185
Mvaa 200,236,140
Ra 200,2,17408
Vc 92,12,13
Cvaa 216,224,144,36
VE 14,186
Mvaa 216,228,148
VE 15,187
Mvaa 216,232,152
Ra 204,2,25600
Vc 93,14,15
Mvaa 216,236,156
buffer_load_dwordx4 v4, s[12:15], s38 offen offset:3072 sc1 lds
Cvaa 232,224,160,40
Ra 208,2,18432
v_or3_b32 v7, v7, v92, v93
Mvaa 232,228,164
VE 8,140
Mvaa 232,232,168
VE 9,141
Mvaa 232,236,172
s_waitcnt lgkmcnt(5)
Ra 212,2,26624
Vc 70,8,9
Cvaa 204,240,128,32
Ve 10,142
Mvaa 204,244,132
VE 11,143
Mvaa 204,248,136
Ra 216,2,19456
Vc 71,10,11
Mvaa 204,252,140
Ra 220,2,27648
v_or3_b32 v7, v7, v70, v71
Cvaa 220,240,144,36
VE 12,156
Mvaa 220,244,148
VE 13,157
Mvaa 220,248,152
VE 14,158
Mvaa 220,252,156
s_waitcnt vmcnt(12)
Ve 15,159
Cvaa 236,240,160,40
VE 8,172
Mvaa 236,244,164
s_barrier
Ve 9,173
Mvaa 236,248,168
s_waitcnt lgkmcnt(4)
Vc 78,12,13
Vc 79,14,15
Ve 10,174
Ve 11,175
Ve 12,188
Ve 13,189
Ve 14,190
VE 15,191
Vc 86,8,9
Vc 87,10,11
Vc 94,12,13
Vc 95,14,15
v_or3_b32 v7, v7, v78, v79
v_or3_b32 v7, v7, v86, v87
v_or3_b32 v7, v7, v94, v95
v_and_b32 v1, 0x40004000, v7
v_cmp_ne_u32 vcc, 0, v1
Mvaa 236,252,172
s_cbranch_vccnz L_k2_fb_wl
L_k2_fbr_wl:
Maav 0,192,64
v_cmp_gt_i32 s[56:57], 0, v6
v_cmp_gt_i32 s[58:59], 1, v6
v_cmp_gt_i32 s[60:61], 2, v6
v_cmp_gt_i32 s[62:63], 3, v6
s_nop 3
s_nop 0
v_cndmask_b32 v224, v224, v20, s[56:57]
v_cndmask_b32 v225, v225, v20, s[58:59]
v_cndmask_b32 v226, v226, v20, s[60:61]
v_cndmask_b32 v227, v227, v20, s[62:63]
v_cmp_gt_i32 s[56:57], 16, v6
v_cmp_gt_i32 s[58:59], 17, v6
v_cmp_gt_i32 s[60:61], 18, v6
v_cmp_gt_i32 s[62:63], 19, v6
v_cndmask_b32 v228, v228, v20, s[56:57]
v_cndmask_b32 v229, v229, v20, s[58:59]
v_cndmask_b32 v230, v230, v20, s[60:61]
v_cndmask_b32 v231, v231, v20, s[62:63]
v_cmp_gt_i32 s[56:57], 32, v6
v_cmp_gt_i32 s[58:59], 33, v6
v_cmp_gt_i32 s[60:61], 34, v6
v_cmp_gt_i32 s[62:63], 35, v6
v_cndmask_b32 v232, v232, v20, s[56:57]
v_cndmask_b32 v233, v233, v20, s[58:59]
v_cndmask_b32 v234, v234, v20, s[60:61]
v_cndmask_b32 v235, v235, v20, s[62:63]
v_cmp_gt_i32 s[56:57], 48, v6
v_cmp_gt_i32 s[58:59], 49, v6
v_cmp_gt_i32 s[60:61], 50, v6
v_cmp_gt_i32 s[62:63], 51, v6
v_cndmask_b32 v236, v236, v20, s[56:57]
v_cndmask_b32 v237, v237, v20, s[58:59]
v_cndmask_b32 v238, v238, v20, s[60:61]
v_cndmask_b32 v239, v239, v20, s[62:63]
VE 8,192
Maav 0,196,68
s_add_u32 m0, s54, 49152
VE 9,193
Maav 32,192,72
buffer_load_dwordx4 v4, s[12:15], s39 offen offset:0 sc1 lds
Maav 32,196,76
s_add_u32 s37, s37, 1
Ra 224,2,20480
Vc 96,8,9
Maav 64,192,80
s_add_u32 s38, s38, 34816
Ve 10,194
Maav 64,196,84
VE 11,195
Maav 96,192,88
Ra 228,2,28672
Vc 97,10,11
Maav 96,196,92
Ra 232,2,21504
v_or_b32_e64 v7, v96, v97
Maav 4,200,64
VE 12,208
Maav 4,204,68
VE 13,209
Maav 36,200,72
Ra 236,2,29696
Vc 104,12,13
Maav 36,204,76
VE 14,210
Maav 68,200,80
VE 15,211
Maav 68,204,84
Ra 240,2,22528
Vc 105,14,15
Maav 100,200,88
Ra 244,2,30720
v_or3_b32 v7, v7, v104, v105
Maav 100,204,92
buffer_load_dwordx4 v4, s[12:15], s39 offen offset:1024 sc1 lds
Mvvv 48,16,64
VE 8,224
Mvvv 48,16,68
s_waitcnt lgkmcnt(6)
Ve 9,225
Maav 8,208,64
Ra 248,2,23552
Vc 112,8,9
Maav 8,212,68
VE 10,226
Maav 40,208,72
VE 11,227
Maav 40,212,76
Ra 252,2,31744
Vc 113,10,11
Maav 72,208,80
Ra 192,3,0
v_or3_b32 v7, v7, v112, v113
Maav 72,212,84
VE 12,196
Maav 104,208,88
VE 13,197
Maav 104,212,92
Ra 196,3,1024
Vc 98,12,13
Maav 12,216,64
VE 14,198
Maav 12,220,68
VE 15,199
Maav 44,216,72
Ra 200,3,2048
Vc 99,14,15
Maav 44,220,76
buffer_load_dwordx4 v4, s[12:15], s39 offen offset:2048 sc1 lds
Maav 76,216,80
Ra 204,3,3072
v_or3_b32 v7, v7, v98, v99
Maav 76,220,84
VE 8,212
Maav 108,216,88
VE 9,213
Maav 108,220,92
VE 10,214
Mvvv 52,16,72
VE 11,215
Mvvv 52,16,76
s_waitcnt lgkmcnt(8)
Ve 12,228
Maav 16,224,64
Ra 208,3,4096
Vc 106,8,9
Maav 16,228,68
Ra 212,3,5120
Vc 107,10,11
Maav 48,224,72
Ra 216,3,6144
v_or3_b32 v7, v7, v106, v107
Maav 48,228,76
VE 13,229
Maav 80,224,80
Ra 220,3,7168
Vc 114,12,13
Maav 80,228,84
VE 14,230
Maav 112,224,88
buffer_load_dwordx4 v4, s[12:15], s39 offen offset:3072 sc1 lds
Maav 112,228,92
s_add_u32 s39, s39, 34816
VE 15,231
Maav 20,232,64
VE 8,200
Maav 20,236,68
VE 9,201
Maav 52,232,72
VE 10,202
Maav 52,236,76
VE 11,203
Maav 84,232,80
Vc 115,14,15
Vc 100,8,9
Maav 84,236,84
VE 12,216
Maav 116,232,88
VE 13,217
Maav 116,236,92
Vc 101,10,11
Vc 108,12,13
Mvvv 56,16,80
VE 14,218
Mvvv 56,16,84
s_waitcnt lgkmcnt(8)
Ve 15,219
Maav 24,240,64
Vc 109,14,15
v_or3_b32 v7, v7, v114, v115
Maav 24,244,68
VE 8,232
Maav 56,240,72
global_load_dword v30, v[28:29], off
Maav 56,244,76
VE 9,233
Maav 88,240,80
Vc 116,8,9
v_or3_b32 v7, v7, v100, v101
Maav 88,244,84
VE 10,234
Maav 120,240,88
VE 11,235
Maav 120,244,92
Vc 117,10,11
v_or3_b32 v7, v7, v108, v109
Maav 28,248,64
v_or3_b32 v7, v7, v116, v117
Maav 28,252,68
Maav 60,248,72
Maav 60,252,76
Maav 92,248,80
Maav 92,252,84
Maav 124,248,88
Maav 124,252,92
Mvvv 60,16,88
s_waitcnt lgkmcnt(4)
Mvvv 60,16,92
Ve 12,204
Cvaa 128,192,128,32
s_add_u32 m0, s53, 32768
VE 13,205
Mvaa 128,196,132
buffer_load_dwordx4 v4, s[12:15], s38 offen offset:0 sc1 lds
Mvaa 128,200,136
Ra 224,3,8192
Vc 102,12,13
Mvaa 128,204,140
VE 14,206
Cvaa 144,192,144,36
VE 15,207
Mvaa 144,196,148
Ra 228,3,9216
Vc 103,14,15
Mvaa 144,200,152
Ra 232,3,10240
v_or3_b32 v7, v7, v102, v103
Mvaa 144,204,156
s_waitcnt lgkmcnt(3)
Ra 236,3,11264
Ra 240,3,12288
Cvaa 132,208,128,32
buffer_load_dwordx4 v4, s[12:15], s38 offen offset:1024 sc1 lds
Mvaa 132,212,132
Ve 8,220
Mvaa 132,216,136
VE 9,221
Mvaa 132,220,140
Ra 244,3,13312
Vc 110,8,9
Cvaa 148,208,144,36
VE 10,222
Mvaa 148,212,148
buffer_load_dwordx4 v4, s[12:15], s38 offen offset:2048 sc1 lds
Mvaa 148,216,152
VE 11,223
Mvaa 148,220,156
s_waitcnt lgkmcnt(2)
Ra 248,3,14336
Ra 252,3,15360
Cvaa 136,224,128,32
Ra 192,2,49152
Vc 111,10,11
Mvaa 136,228,132
Ra 196,2,57344
v_or3_b32 v7, v7, v110, v111
Mvaa 136,232,136
Ve 12,236
Mvaa 136,236,140
buffer_load_dwordx4 v4, s[12:15], s38 offen offset:3072 sc1 lds
Cvaa 152,224,144,36
VE 13,237
Mvaa 152,228,148
Ra 200,2,50176
Vc 118,12,13
Mvaa 152,232,152
VE 14,238
Mvaa 152,236,156
s_waitcnt lgkmcnt(3)
Ra 204,2,58368
Ra 208,2,51200
Cvaa 140,240,128,32
Ve 15,239
Mvaa 140,244,132
Ra 212,2,59392
Vc 119,14,15
Mvaa 140,248,136
Ra 216,2,52224
v_or3_b32 v7, v7, v118, v119
Mvaa 140,252,140
s_waitcnt vmcnt(12)
Ra 220,2,60416
v_and_b32 v1, 0x40004000, v7
Cvaa 156,240,144,36
s_cmp_eq_u32 s37, s45
v_cmp_ne_u32 vcc, 0, v1
Mvaa 156,244,148
s_barrier
Mvaa 156,248,152
s_waitcnt lgkmcnt(4)
Mvaa 156,252,156
s_cbranch_vccnz L_k2_fb_tr
L_k2_fbr_tr:
Maav 0,192,96
s_cbranch_scc1 L_k2_mk_tr
L_k2_mkr_tr:
Ve 8,128
Maav 0,196,100
s_add_u32 m0, s53, 16384
VE 9,129
Maav 32,192,104
buffer_load_dwordx4 v4, s[12:15], s39 offen offset:0 sc1 lds
Maav 32,196,108
s_add_u32 s37, s37, 1
Ra 224,2,53248
Vc 64,8,9
Maav 64,192,112
s_add_u32 s38, s38, 34816
Ve 10,130
Maav 64,196,116
s_xor_b32 s53, s53, 65536
VE 11,131
Maav 4,200,96
s_xor_b32 s54, s54, 65536
Ra 228,2,61440
Vc 65,10,11
Maav 4,204,100
Ra 232,2,54272
v_or_b32_e64 v7, v64, v65
Maav 36,200,104
VE 12,144
Maav 36,204,108
VE 13,145
Maav 68,200,112
Ra 236,2,62464
Vc 72,12,13
Maav 68,204,116
VE 14,146
Mvvv 48,16,96
VE 15,147
Mvvv 48,16,100
s_waitcnt lgkmcnt(4)
Ra 240,2,55296
Vc 73,14,15
Maav 8,208,96
buffer_load_dwordx4 v4, s[12:15], s39 offen offset:1024 sc1 lds
Maav 8,212,100
Ra 244,2,63488
v_or3_b32 v7, v7, v72, v73
Maav 40,208,104
Ve 8,132
Maav 40,212,108
VE 9,133
Maav 72,208,112
Ra 248,2,56320
Vc 66,8,9
Maav 72,212,116
VE 10,134
Maav 12,216,96
VE 11,135
Maav 12,220,100
Ra 252,2,64512
Vc 67,10,11
Maav 44,216,104
Ra 192,3,32768
v_or3_b32 v7, v7, v66, v67
Maav 44,220,108
VE 12,148
Maav 76,216,112
VE 13,149
Maav 76,220,116
Ra 196,3,33792
Vc 74,12,13
Mvvv 52,16,104
VE 14,150
Mvvv 52,16,108
s_waitcnt lgkmcnt(6)
Ve 15,151
Maav 16,224,96
buffer_load_dwordx4 v4, s[12:15], s39 offen offset:2048 sc1 lds
Maav 16,228,100
Ra 200,3,34816
Vc 75,14,15
Maav 48,224,104
Ra 204,3,35840
v_or3_b32 v7, v7, v74, v75
Maav 48,228,108
VE 8,136
Maav 80,224,112
Ra 208,3,36864
Ra 212,3,37888
Maav 80,228,116
Ra 216,3,38912
Ra 220,3,39936
Maav 20,232,96
Maav 20,236,100
Maav 52,232,104
Maav 52,236,108
Maav 84,232,112
Maav 84,236,116
buffer_load_dwordx4 v4, s[12:15], s39 offen offset:3072 sc1 lds
Mvvv 56,16,112
s_add_u32 s39, s39, 34816
Mvvv 56,16,116
s_waitcnt lgkmcnt(8)
Maav 24,240,96
Maav 24,244,100
Maav 56,240,104
Maav 56,244,108
Maav 88,240,112
Maav 88,244,116
Maav 28,248,96
Maav 28,252,100
Maav 60,248,104
Maav 60,252,108
Maav 92,248,112
s_waitcnt lgkmcnt(4)
Maav 92,252,116
s_getpc_b64 s[56:57]
L_cpf4:
s_add_u32 s56, s56, (L_k2_fin-L_cpf4)&0xffffffff
s_addc_u32 s57, s57, ((L_k2_fin-L_cpf4)>>32)&0xffffffff
s_lshr_b32 s58, s2, 3
s_lshl_b32 s58, s58, 2
s_add_u32 s58, s58, s32
s_lshl_b32 s58, s58, 10
v_and_b32 v162, 7, v0
v_lshlrev_b32 v162, 7, v162
v_add_u32 v162, s58, v162
v_min_u32 v162, L_p4_end-L_k2_fin-4, v162
v_mov_b32 v161, s57
v_add_co_u32 v160, vcc, s56, v162
s_nop 1
v_addc_co_u32 v161, vcc, 0, v161, vcc
global_load_dword v164, v[160:161], off
s_waitcnt vmcnt(9)
s_lshl_b32 s3, s34, 20
s_lshl_b32 s47, s33, 15
s_add_u32 s3, s3, s47
s_lshl_b32 s47, s32, 10
v_lshlrev_b32 v248, 4, v0
v_add_u32_e64 v249, s47, v248
s_sub_u32 s47, 7168, s47
v_add_u32 v248, s47, v248
v_rcp_f32 v250, v56
v_rcp_f32 v252, v60
v_mov_b32 v251, v250
v_mov_b32_e64 v253, v252
Ar 240,96
Ar 241,97
Ar 242,98
Ar 243,99
Ar 244,100
Ar 245,101
Ar 246,102
Ar 247,103
v_pk_mul_f32 v[240:241], v[240:241], v[252:253]
v_pk_mul_f32 v[242:243], v[242:243], v[252:253]
v_pk_mul_f32 v[244:245], v[244:245], v[252:253]
v_pk_mul_f32 v[246:247], v[246:247], v[252:253]
Vc 28,240,241
Vc 29,242,243
Vc 30,244,245
Vc 31,246,247
buffer_store_dwordx4 v[28:31], v249, s[16:19], s3 offen sc1
Ar 240,64
Ar 241,65
Ar 242,66
Ar 243,67
Ar 244,68
Ar 245,69
Ar 246,70
Ar 247,71
v_pk_mul_f32 v[240:241], v[240:241], v[250:251]
v_pk_mul_f32 v[242:243], v[242:243], v[250:251]
v_pk_mul_f32 v[244:245], v[244:245], v[250:251]
v_pk_mul_f32 v[246:247], v[246:247], v[250:251]
Vc 24,240,241
Vc 25,242,243
Vc 26,244,245
Vc 27,246,247
buffer_store_dwordx4 v[24:27], v248, s[16:19], s3 offen sc1
s_add_u32 s3, s3, 8192
Ar 240,104
Ar 241,105
Ar 242,106
Ar 243,107
Ar 244,108
Ar 245,109
Ar 246,110
Ar 247,111
v_pk_mul_f32 v[240:241], v[240:241], v[252:253]
v_pk_mul_f32 v[242:243], v[242:243], v[252:253]
v_pk_mul_f32 v[244:245], v[244:245], v[252:253]
v_pk_mul_f32 v[246:247], v[246:247], v[252:253]
Vc 28,240,241
Vc 29,242,243
Vc 30,244,245
Vc 31,246,247
buffer_store_dwordx4 v[28:31], v249, s[16:19], s3 offen sc1
Ar 240,72
Ar 241,73
Ar 242,74
Ar 243,75
Ar 244,76
Ar 245,77
Ar 246,78
Ar 247,79
v_pk_mul_f32 v[240:241], v[240:241], v[250:251]
v_pk_mul_f32 v[242:243], v[242:243], v[250:251]
v_pk_mul_f32 v[244:245], v[244:245], v[250:251]
v_pk_mul_f32 v[246:247], v[246:247], v[250:251]
Vc 24,240,241
Vc 25,242,243
Vc 26,244,245
Vc 27,246,247
buffer_store_dwordx4 v[24:27], v248, s[16:19], s3 offen sc1
s_add_u32 s3, s3, 8192
Ar 240,112
Ar 241,113
Ar 242,114
Ar 243,115
Ar 244,116
Ar 245,117
Ar 246,118
Ar 247,119
v_pk_mul_f32 v[240:241], v[240:241], v[252:253]
v_pk_mul_f32 v[242:243], v[242:243], v[252:253]
v_pk_mul_f32 v[244:245], v[244:245], v[252:253]
v_pk_mul_f32 v[246:247], v[246:247], v[252:253]
Vc 28,240,241
Vc 29,242,243
Vc 30,244,245
Vc 31,246,247
buffer_store_dwordx4 v[28:31], v249, s[16:19], s3 offen sc1
Ar 240,80
Ar 241,81
Ar 242,82
Ar 243,83
Ar 244,84
Ar 245,85
Ar 246,86
Ar 247,87
v_pk_mul_f32 v[240:241], v[240:241], v[250:251]
v_pk_mul_f32 v[242:243], v[242:243], v[250:251]
v_pk_mul_f32 v[244:245], v[244:245], v[250:251]
v_pk_mul_f32 v[246:247], v[246:247], v[250:251]
Vc 24,240,241
Vc 25,242,243
Vc 26,244,245
Vc 27,246,247
buffer_store_dwordx4 v[24:27], v248, s[16:19], s3 offen sc1
s_add_u32 s3, s3, 8192
Ar 240,120
Ar 241,121
Ar 242,122
Ar 243,123
Ar 244,124
Ar 245,125
Ar 246,126
Ar 247,127
v_pk_mul_f32 v[240:241], v[240:241], v[252:253]
v_pk_mul_f32 v[242:243], v[242:243], v[252:253]
v_pk_mul_f32 v[244:245], v[244:245], v[252:253]
v_pk_mul_f32 v[246:247], v[246:247], v[252:253]
Vc 28,240,241
Vc 29,242,243
Vc 30,244,245
Vc 31,246,247
buffer_store_dwordx4 v[28:31], v249, s[16:19], s3 offen sc1
Ar 240,88
Ar 241,89
Ar 242,90
Ar 243,91
Ar 244,92
Ar 245,93
Ar 246,94
Ar 247,95
v_pk_mul_f32 v[240:241], v[240:241], v[250:251]
v_pk_mul_f32 v[242:243], v[242:243], v[250:251]
v_pk_mul_f32 v[244:245], v[244:245], v[250:251]
v_pk_mul_f32 v[246:247], v[246:247], v[250:251]
Vc 24,240,241
Vc 25,242,243
Vc 26,244,245
Vc 27,246,247
buffer_store_dwordx4 v[24:27], v248, s[16:19], s3 offen sc1
s_add_u32 s52, s37, 2
s_load_dwordx2 s[94:95], s[0:1], 40
s_load_dwordx2 s[40:41], s[0:1], 0
s_load_dwordx4 s[8:11], s[0:1], 80
s_waitcnt vmcnt(8) lgkmcnt(0)
s_add_u32 s93, s2, 224
s_and_b32 s93, s93, 255
s_nop 0
s_mul_i32 s92, s93, 2341
s_lshr_b32 s92, s92, 16
s_mul_i32 s47, s92, 28
s_sub_u32 s4, s93, s47
s_mul_i32 s5, s92, 917504
s_lshl_b32 s47, s4, 8
s_add_u32 s5, s5, s47
s_cmp_eq_u32 s34, 7
s_cbranch_scc1 L_k2_fin
L_k2_nloop:
v_xor_b32 v2, 65536, v2
v_xor_b32 v3, 65536, v3
Cvaa 192,192,128,32
s_mov_b32 m0, s53
Ve 9,137
Mvaa 192,196,132
buffer_load_dwordx4 v4, s[12:15], s38 offen offset:0 sc1 lds
Mvaa 192,200,136
Ra 224,2,40960
Vc 68,8,9
Mvaa 192,204,140
VE 10,138
Cvaa 208,192,144,36
VE 11,139
Mvaa 208,196,148
Ra 228,2,41984
Vc 69,10,11
Mvaa 208,200,152
Ra 232,2,43008
v_or3_b32 v7, v7, v68, v69
Mvaa 208,204,156
s_waitcnt lgkmcnt(3)
Ra 236,2,44032
Ra 240,2,45056
Cvaa 196,208,128,32
buffer_load_dwordx4 v4, s[12:15], s38 offen offset:1024 sc1 lds
Mvaa 196,212,132
Ve 12,152
Mvaa 196,216,136
VE 13,153
Mvaa 196,220,140
Ra 244,2,46080
Vc 76,12,13
Cvaa 212,208,144,36
VE 14,154
Mvaa 212,212,148
buffer_load_dwordx4 v4, s[12:15], s38 offen offset:2048 sc1 lds
Mvaa 212,216,152
VE 15,155
Mvaa 212,220,156
s_waitcnt lgkmcnt(2)
Ra 248,2,47104
Ra 252,2,48128
Cvaa 200,224,128,32
Ra 192,2,16384
Vc 77,14,15
Mvaa 200,228,132
Ra 196,2,24576
v_or3_b32 v7, v7, v76, v77
Mvaa 200,232,136
Ve 8,140
Mvaa 200,236,140
buffer_load_dwordx4 v4, s[12:15], s38 offen offset:3072 sc1 lds
Cvaa 216,224,144,36
VE 9,141
Mvaa 216,228,148
Ra 200,2,17408
Vc 70,8,9
Mvaa 216,232,152
VE 10,142
Mvaa 216,236,156
s_waitcnt lgkmcnt(3)
Ra 204,2,25600
Ra 208,2,18432
Cvaa 204,240,128,32
Ve 11,143
Mvaa 204,244,132
s_cmp_lt_u32 s37, s52
Ra 212,2,26624
Vc 71,10,11
Mvaa 204,248,136
s_cbranch_scc1 L_nw_ne
s_waitcnt vmcnt(12)
L_nw_ne:
Ra 216,2,19456
v_or3_b32 v7, v7, v70, v71
Mvaa 204,252,140
Ve 12,156
Cvaa 220,240,144,36
VE 13,157
Mvaa 220,244,148
s_barrier
Ra 220,2,27648
Vc 78,12,13
Mvaa 220,248,152
s_waitcnt lgkmcnt(4)
Ve 14,158
Ve 15,159
s_nop 0
Vc 79,14,15
v_or3_b32 v7, v7, v78, v79
v_and_b32 v1, 0x40004000, v7
v_cmp_ne_u32 vcc, 0, v1
Mvaa 220,252,156
s_cbranch_vccnz L_k2_fb_ne
L_k2_fbr_ne:
Maav 0,192,64
Ve 8,192
Maav 0,196,68
s_add_u32 m0, s54, 49152
VE 9,193
Maav 32,192,72
buffer_load_dwordx4 v4, s[12:15], s39 offen offset:0 sc1 lds
Maav 32,196,76
s_cmp_eq_u32 s37, s52
Ra 224,2,20480
Vc 96,8,9
Maav 4,200,64
s_cbranch_scc1 L_pubB
L_pubBr:
VE 10,194
Maav 4,204,68
s_add_u32 s37, s37, 1
Ve 11,195
Maav 36,200,72
s_add_u32 s38, s38, 34816
Ra 228,2,28672
Vc 97,10,11
Maav 36,204,76
Ra 232,2,21504
v_or_b32_e64 v7, v96, v97
Mvvv 48,16,64
VE 12,208
Mvvv 48,16,68
s_waitcnt lgkmcnt(3)
Ra 236,2,29696
Ra 240,2,22528
Maav 8,208,64
buffer_load_dwordx4 v4, s[12:15], s39 offen offset:1024 sc1 lds
Maav 8,212,68
Ve 13,209
Maav 40,208,72
Ra 244,2,30720
Vc 104,12,13
Maav 40,212,76
VE 14,210
Maav 12,216,64
VE 15,211
Maav 12,220,68
Ra 248,2,23552
Vc 105,14,15
Maav 44,216,72
Ra 252,2,31744
v_or3_b32 v7, v7, v104, v105
Maav 44,220,76
VE 8,196
Mvvv 52,16,72
buffer_load_dwordx4 v4, s[12:15], s39 offen offset:2048 sc1 lds
Mvvv 52,16,76
s_waitcnt lgkmcnt(4)
Ve 9,197
Maav 16,224,64
Ra 192,3,0
Vc 98,8,9
Maav 16,228,68
VE 10,198
Maav 48,224,72
VE 11,199
Maav 48,228,76
Ra 196,3,1024
Vc 99,10,11
Maav 20,232,64
Ra 200,3,2048
v_or3_b32 v7, v7, v98, v99
Maav 20,236,68
Ra 204,3,3072
Ra 208,3,4096
Maav 52,232,72
buffer_load_dwordx4 v4, s[12:15], s39 offen offset:3072 sc1 lds
Maav 52,236,76
s_waitcnt lgkmcnt(5)
Ve 12,212
Maav 24,240,64
s_add_u32 s39, s39, 34816
VE 13,213
Maav 24,244,68
Ra 212,3,5120
Vc 106,12,13
Maav 56,240,72
VE 14,214
Maav 56,244,76
VE 15,215
Maav 28,248,64
Ra 216,3,6144
Vc 107,14,15
Maav 28,252,68
Ra 220,3,7168
v_or3_b32 v7, v7, v106, v107
Maav 60,248,72
s_waitcnt lgkmcnt(4)
Ve 8,200
Maav 60,252,76
VE 9,201
Cvaa 128,192,128,32
s_add_u32 m0, s53, 32768
Ra 224,3,8192
Vc 100,8,9
Mvaa 128,196,132
buffer_load_dwordx4 v4, s[12:15], s38 offen offset:0 sc1 lds
Mvaa 128,200,136
VE 10,202
Mvaa 128,204,140
VE 11,203
Cvaa 144,192,144,36
Ra 228,3,9216
Vc 101,10,11
Mvaa 144,196,148
Ra 232,3,10240
v_or3_b32 v7, v7, v100, v101
Mvaa 144,200,152
VE 12,216
Mvaa 144,204,156
s_waitcnt lgkmcnt(3)
Ra 236,3,11264
Ra 240,3,12288
Cvaa 132,208,128,32
buffer_load_dwordx4 v4, s[12:15], s38 offen offset:1024 sc1 lds
Mvaa 132,212,132
Ve 13,217
Mvaa 132,216,136
Ra 244,3,13312
Vc 108,12,13
Mvaa 132,220,140
VE 14,218
Cvaa 148,208,144,36
VE 15,219
Mvaa 148,212,148
buffer_load_dwordx4 v4, s[12:15], s38 offen offset:2048 sc1 lds
Mvaa 148,216,152
Ra 248,3,14336
Vc 109,14,15
Mvaa 148,220,156
s_waitcnt lgkmcnt(3)
Ra 252,3,15360
v_or3_b32 v7, v7, v108, v109
Cvaa 136,224,128,32
Ve 8,204
Mvaa 136,228,132
VE 9,205
Mvaa 136,232,136
Ra 192,2,49152
Vc 102,8,9
Mvaa 136,236,140
buffer_load_dwordx4 v4, s[12:15], s38 offen offset:3072 sc1 lds
Cvaa 152,224,144,36
VE 10,206
Mvaa 152,228,148
VE 11,207
Mvaa 152,232,152
Ra 196,2,57344
Vc 103,10,11
Mvaa 152,236,156
s_waitcnt lgkmcnt(2)
Ra 200,2,50176
Ra 204,2,58368
Cvaa 140,240,128,32
Ra 208,2,51200
v_or3_b32 v7, v7, v102, v103
Mvaa 140,244,132
s_cmp_lt_u32 s37, s52
VE 12,220
Mvaa 140,248,136
s_cbranch_scc1 L_nw_no
s_waitcnt vmcnt(12)
L_nw_no:
VE 13,221
Mvaa 140,252,140
Ra 212,2,59392
Vc 110,12,13
Cvaa 156,240,144,36
s_cmp_eq_u32 s37, s45
Ve 14,222
Mvaa 156,244,148
s_barrier
Ve 15,223
Mvaa 156,248,152
s_waitcnt lgkmcnt(2)
Ra 216,2,52224
Vc 111,14,15
v_or3_b32 v7, v7, v110, v111
v_and_b32 v1, 0x40004000, v7
v_cmp_ne_u32 vcc, 0, v1
Mvaa 156,252,156
s_cbranch_vccnz L_k2_fb_no
L_k2_fbr_no:
Ra 220,2,60416
Maav 0,192,96
s_cbranch_scc1 L_k2_mk_no
L_k2_mkr_no:
VE 8,128
Maav 0,196,100
s_add_u32 m0, s53, 16384
VE 9,129
Maav 32,192,104
buffer_load_dwordx4 v4, s[12:15], s39 offen offset:0 sc1 lds
Maav 32,196,108
s_add_u32 s37, s37, 1
Ra 224,2,53248
Vc 64,8,9
Maav 4,200,96
s_add_u32 s38, s38, 34816
Ve 10,130
Maav 4,204,100
s_xor_b32 s53, s53, 65536
VE 11,131
Maav 36,200,104
s_xor_b32 s54, s54, 65536
Ra 228,2,61440
Vc 65,10,11
Maav 36,204,108
Ra 232,2,54272
v_or_b32_e64 v7, v64, v65
Mvvv 48,16,96
VE 12,144
Mvvv 48,16,100
s_waitcnt lgkmcnt(3)
Ra 236,2,62464
Ra 240,2,55296
Maav 8,208,96
buffer_load_dwordx4 v4, s[12:15], s39 offen offset:1024 sc1 lds
Maav 8,212,100
Ve 13,145
Maav 40,208,104
Ra 244,2,63488
Vc 72,12,13
Maav 40,212,108
VE 14,146
Maav 12,216,96
VE 15,147
Maav 12,220,100
Ra 248,2,56320
Vc 73,14,15
Maav 44,216,104
Ra 252,2,64512
v_or3_b32 v7, v7, v72, v73
Maav 44,220,108
VE 8,132
Mvvv 52,16,104
buffer_load_dwordx4 v4, s[12:15], s39 offen offset:2048 sc1 lds
Mvvv 52,16,108
s_waitcnt lgkmcnt(4)
Ve 9,133
Maav 16,224,96
Ra 192,3,32768
Vc 66,8,9
Maav 16,228,100
VE 10,134
Maav 48,224,104
VE 11,135
Maav 48,228,108
Ra 196,3,33792
Vc 67,10,11
Maav 20,232,96
Ra 200,3,34816
v_or3_b32 v7, v7, v66, v67
Maav 20,236,100
Ra 204,3,35840
Ra 208,3,36864
Maav 52,232,104
buffer_load_dwordx4 v4, s[12:15], s39 offen offset:3072 sc1 lds
Maav 52,236,108
s_waitcnt lgkmcnt(5)
Ve 12,148
Maav 24,240,96
s_add_u32 s39, s39, 34816
VE 13,149
Maav 24,244,100
Ra 212,3,37888
Vc 74,12,13
Maav 56,240,104
VE 14,150
Maav 56,244,108
VE 15,151
Maav 28,248,96
Ra 216,3,38912
Vc 75,14,15
Maav 28,252,100
s_cmp_lg_u32 s37, s36
Ra 220,3,39936
v_or3_b32 v7, v7, v74, v75
Maav 60,248,104
s_waitcnt lgkmcnt(4)
VE 8,136
Maav 60,252,108
s_cbranch_scc1 L_k2_nloop
L_k2_fin:
v_xor_b32 v2, 65536, v2
v_xor_b32 v3, 65536, v3
s_lshr_b32 s3, s42, 4
s_mul_i32 s3, s3, 33792
s_and_b32 s47, s42, 15
s_lshl_b32 s47, s47, 4
s_add_u32 s3, s3, s47
v_mov_b32 v28, s3
s_lshr_b32 s3, s43, 4
s_mul_i32 s3, s3, 33792
s_and_b32 s47, s43, 15
s_lshl_b32 s47, s47, 4
s_add_u32 s3, s3, s47
v_mov_b32 v29, s3
v_lshrrev_b32 v24, 4, v0
v_and_b32 v25, 15, v0
v_cmp_eq_u32 vcc, 1, v25
s_lshl_b32 s3, s32, 4
v_add_u32 v26, s3, v24
v_cndmask_b32 v28, v28, v29, vcc
v_lshl_add_u32 v28, v24, 8, v28
v_mul_u32_u24 v26, 7168, v26
v_lshlrev_b32 v24, 1, v24
v_xor_b32 v24, v24, v25
v_xor_b32 v25, 8, v24
v_lshl_add_u32 v24, v24, 4, v26
v_lshl_add_u32 v25, v25, 4, v26
s_lshl_b32 s3, s92, 12
buffer_load_dwordx4 a[160:163], v28, s[20:23], s3 offen offset:0 sc1
buffer_load_dwordx4 a[164:167], v28, s[20:23], s3 offen offset:1024 sc1
buffer_load_dwordx4 a[168:171], v28, s[20:23], s3 offen offset:2048 sc1
buffer_load_dwordx4 a[172:175], v28, s[20:23], s3 offen offset:3072 sc1
Cvaa 192,192,128,32
s_add_u32 m0, s54, 0
s_add_u32 s3, s5, 0
Ve 9,137
Mvaa 192,196,132
buffer_load_dwordx4 v24, s[24:27], s3 offen offset:0 lds
Mvaa 192,200,136
Ra 224,2,40960
Ra 228,2,41984
Mvaa 192,204,140
s_waitcnt lgkmcnt(2)
Ra 232,2,43008
Ra 236,2,44032
Cvaa 196,208,128,32
s_add_u32 s3, s5, 27648
Ra 240,2,45056
Vc 68,8,9
Mvaa 196,212,132
buffer_load_dwordx4 v24, s[24:27], s3 offen offset:1024 lds
Mvaa 196,216,136
Ra 244,2,46080
Ra 248,2,47104
Mvaa 196,220,140
s_waitcnt lgkmcnt(3)
s_add_u32 s3, s5, 55296
Ra 252,2,48128
Ra 192,2,16384
Cvaa 200,224,128,32
buffer_load_dwordx4 v25, s[24:27], s3 offen offset:2048 lds
Mvaa 200,228,132
s_cmp_lt_u32 s37, s52
Ve 10,138
Mvaa 200,232,136
s_cbranch_scc1 L_nw_nl
s_waitcnt vmcnt(15)
L_nw_nl:
Ra 196,2,24576
Ra 200,2,17408
Mvaa 200,236,140
s_waitcnt lgkmcnt(3)
s_add_u32 s3, s5, 82944
Ra 204,2,25600
Ra 208,2,18432
Cvaa 204,240,128,32
buffer_load_dwordx4 v25, s[24:27], s3 offen offset:3072 lds
Mvaa 204,244,132
s_barrier
VE 11,139
Mvaa 204,248,136
s_waitcnt lgkmcnt(1)
Ra 212,2,26624
Vc 69,10,11
Ve 12,152
Ve 13,153
Ve 14,154
Ve 15,155
Ve 8,140
Ve 9,141
Ve 10,142
VE 11,143
Vc 76,12,13
Ve 12,156
Ve 13,157
Vc 77,14,15
Ve 14,158
Ve 15,159
Vc 70,8,9
Vc 71,10,11
Vc 78,12,13
Vc 79,14,15
v_or3_b32 v7, v7, v68, v69
v_or3_b32 v7, v7, v76, v77
v_or3_b32 v7, v7, v70, v71
v_or3_b32 v7, v7, v78, v79
v_and_b32 v1, 0x40004000, v7
v_cmp_ne_u32 vcc, 0, v1
Mvaa 204,252,140
s_cbranch_vccnz L_k2_fb_nl
L_k2_fbr_nl:
Ra 216,2,19456
Ra 220,2,27648
Maav 0,192,64
v_cmp_gt_i32 s[56:57], 0, v6
v_cmp_gt_i32 s[58:59], 1, v6
v_cmp_gt_i32 s[60:61], 2, v6
v_cmp_gt_i32 s[62:63], 3, v6
s_nop 3
s_nop 0
v_cndmask_b32 v192, v192, v20, s[56:57]
v_cndmask_b32 v193, v193, v20, s[58:59]
v_cndmask_b32 v194, v194, v20, s[60:61]
v_cndmask_b32 v195, v195, v20, s[62:63]
v_cmp_gt_i32 s[56:57], 16, v6
v_cmp_gt_i32 s[58:59], 17, v6
v_cmp_gt_i32 s[60:61], 18, v6
v_cmp_gt_i32 s[62:63], 19, v6
v_cndmask_b32 v196, v196, v20, s[56:57]
v_cndmask_b32 v197, v197, v20, s[58:59]
v_cndmask_b32 v198, v198, v20, s[60:61]
v_cndmask_b32 v199, v199, v20, s[62:63]
v_cmp_gt_i32 s[56:57], 32, v6
v_cmp_gt_i32 s[58:59], 33, v6
v_cmp_gt_i32 s[60:61], 34, v6
v_cmp_gt_i32 s[62:63], 35, v6
v_cndmask_b32 v200, v200, v20, s[56:57]
v_cndmask_b32 v201, v201, v20, s[58:59]
v_cndmask_b32 v202, v202, v20, s[60:61]
v_cndmask_b32 v203, v203, v20, s[62:63]
v_cmp_gt_i32 s[56:57], 48, v6
v_cmp_gt_i32 s[58:59], 49, v6
v_cmp_gt_i32 s[60:61], 50, v6
v_cmp_gt_i32 s[62:63], 51, v6
v_cndmask_b32 v204, v204, v20, s[56:57]
v_cndmask_b32 v205, v205, v20, s[58:59]
v_cndmask_b32 v206, v206, v20, s[60:61]
v_cndmask_b32 v207, v207, v20, s[62:63]
VE 8,192
Maav 0,196,68
s_add_u32 m0, s54, 16384
s_add_u32 s3, s5, 458752
VE 9,193
Maav 32,192,72
buffer_load_dwordx4 v24, s[24:27], s3 offen offset:0 lds
Maav 32,196,76
s_add_u32 s3, s5, 486400
Ra 224,2,20480
Vc 96,8,9
Maav 4,200,64
buffer_load_dwordx4 v24, s[24:27], s3 offen offset:1024 lds
Maav 4,204,68
s_mov_b32 s60, s8
s_and_b32 s61, s9, 0xffff
Ve 10,194
Maav 36,200,72
s_add_u32 s3, s5, 514048
VE 11,195
Maav 36,204,76
buffer_load_dwordx4 v25, s[24:27], s3 offen offset:2048 lds
Mvvv 48,16,64
s_mov_b32 s62, 7340032
Ra 228,2,28672
Vc 97,10,11
Mvvv 48,16,68
s_waitcnt lgkmcnt(2)
s_add_u32 s3, s5, 541696
Ra 232,2,21504
Ra 236,2,29696
Maav 8,208,64
buffer_load_dwordx4 v25, s[24:27], s3 offen offset:3072 lds
Maav 8,212,68
s_add_u32 m0, s54, 32768
s_add_u32 s3, s5, 0
Ra 240,2,22528
v_or_b32_e64 v7, v96, v97
Maav 40,208,72
buffer_load_dwordx4 v24, s[68:71], s3 offen offset:0 lds
Maav 40,212,76
s_mov_b32 s63, 0x20000
s_mov_b32 s56, s40
Ve 12,196
Maav 12,216,64
s_add_u32 s3, s5, 27648
VE 13,197
Maav 12,220,68
buffer_load_dwordx4 v24, s[68:71], s3 offen offset:1024 lds
Maav 44,216,72
s_and_b32 s57, s41, 0xffff
Ra 244,2,30720
Vc 98,12,13
Maav 44,220,76
s_add_u32 s3, s5, 55296
VE 14,198
Mvvv 52,16,72
buffer_load_dwordx4 v25, s[68:71], s3 offen offset:2048 lds
Mvvv 52,16,76
s_waitcnt lgkmcnt(2)
s_add_u32 s3, s5, 82944
Ra 248,2,23552
Ra 252,2,31744
Maav 16,224,64
buffer_load_dwordx4 v25, s[68:71], s3 offen offset:3072 lds
Maav 16,228,68
s_mov_b32 s58, 4194304
s_mov_b32 s59, 0x20000
Ve 15,199
Maav 48,224,72
s_add_u32 m0, s54, 49152
s_add_u32 s3, s5, 458752
Ra 192,2,49152
Vc 99,14,15
Maav 48,228,76
buffer_load_dwordx4 v24, s[68:71], s3 offen offset:0 lds
Maav 20,232,64
s_bfe_u32 s6, s2, 0x20001
Ra 196,2,57344
v_or3_b32 v7, v7, v98, v99
Maav 20,236,68
s_add_u32 s3, s5, 486400
Ra 200,2,50176
Ra 204,2,58368
Maav 52,232,72
buffer_load_dwordx4 v24, s[68:71], s3 offen offset:1024 lds
Maav 52,236,76
s_waitcnt lgkmcnt(4)
s_add_u32 s3, s5, 514048
Ve 8,200
Maav 24,240,64
buffer_load_dwordx4 v25, s[68:71], s3 offen offset:2048 lds
Maav 24,244,68
s_lshr_b32 s7, s34, 1
s_lshl_b32 s45, s7, 2
VE 9,201
Maav 56,240,72
s_add_u32 s3, s5, 541696
Ra 208,2,51200
Vc 100,8,9
Maav 56,244,76
buffer_load_dwordx4 v25, s[68:71], s3 offen offset:3072 lds
Maav 28,248,64
s_add_u32 s46, s45, s6
s_sub_u32 s46, 15, s46
VE 10,202
Maav 28,252,68
s_sub_u32 s45, 12, s45
Ra 212,2,59392
Ra 216,2,52224
Maav 60,248,72
s_waitcnt lgkmcnt(3)
Ra 220,2,60416
Ve 11,203
Ve 12,204
Ve 13,205
Ve 14,206
VE 15,207
Vc 101,10,11
Vc 102,12,13
Vc 103,14,15
v_or3_b32 v7, v7, v100, v101
v_or3_b32 v7, v7, v102, v103
Maav 60,252,76
s_add_u32 s45, s45, s6
v_and_b32 v1, 0x40004000, v7
v_cmp_ne_u32 vcc, 0, v1
s_cbranch_vccnz L_k2_fb_fi
L_k2_fbr_fi:
Maav 0,192,96
Ra 224,2,53248
Ra 228,2,61440
Maav 0,196,100
Ra 232,2,54272
Ra 236,2,62464
Maav 4,200,96
Ra 240,2,55296
Ra 244,2,63488
Maav 4,204,100
Ra 248,2,56320
Ra 252,2,64512
Mvvv 48,16,96
s_cmp_lt_u32 s7, 2
s_cselect_b32 s45, s46, s45
Mvvv 48,16,100
s_waitcnt lgkmcnt(8)
Maav 8,208,96
s_and_b32 s46, s2, 1
s_bfe_u32 s6, s2, 0x30003
s_lshl_b32 s6, s6, 1
Maav 8,212,100
s_add_u32 s46, s46, s6
s_mov_b32 s48, 0
s_mov_b32 s49, 15360
Maav 12,216,96
s_mov_b32 s50, 30720
s_mov_b32 s51, 46080
s_lshl_b32 s35, s32, 13
Maav 12,220,100
s_waitcnt lgkmcnt(4)
Maav 16,224,96
s_add_u32 s35, s35, 131072
s_and_b32 s52, s46, 1
s_lshl_b32 s37, s45, 20
Maav 16,228,100
s_lshl_b32 s7, s52, 19
s_add_u32 s37, s37, s7
s_add_u32 s37, s37, 46137344
Maav 20,232,96
s_lshr_b32 s7, s46, 1
s_lshl_b32 s7, s7, 8
s_lshl_b32 s6, s52, 22
Maav 20,236,100
s_waitcnt lgkmcnt(0)
Maav 24,240,96
s_add_u32 s6, s6, s7
s_add_u32 s12, s94, s6
s_addc_u32 s13, s95, 0
s_and_b32 s13, s13, 0xffff
Maav 24,244,100
s_mov_b32 s14, 0
s_mov_b32 s15, 0x20000
s_sub_u32 s14, 4194304, s7
Maav 28,248,96
s_mov_b32 s28, s94
s_and_b32 s29, s95, 0xffff
s_mov_b32 s30, 8388608
Maav 28,252,100
s_mov_b32 s31, 0x20000
s_lshl_b32 s7, s46, 7
s_lshl_b32 s36, s45, 18
s_nop 7
s_lshl_b32 s3, s55, 20
s_lshl_b32 s47, s33, 15
s_add_u32 s3, s3, s47
s_lshl_b32 s47, s32, 10
v_lshlrev_b32 v248, 4, v0
v_add_u32 v249, s47, v248
s_sub_u32 s47, 7168, s47
v_add_u32 v248, s47, v248
v_rcp_f32 v250, v48
v_rcp_f32 v252, v52
v_mov_b32 v251, v250
v_mov_b32_e64 v253, v252
Ar 240,32
Ar 241,33
Ar 242,34
Ar 243,35
Ar 244,36
Ar 245,37
Ar 246,38
Ar 247,39
v_pk_mul_f32 v[240:241], v[240:241], v[252:253]
v_pk_mul_f32 v[242:243], v[242:243], v[252:253]
v_pk_mul_f32 v[244:245], v[244:245], v[252:253]
v_pk_mul_f32 v[246:247], v[246:247], v[252:253]
Vc 28,240,241
Vc 29,242,243
Vc 30,244,245
Vc 31,246,247
buffer_store_dwordx4 v[28:31], v249, s[16:19], s3 offen sc1
Ar 240,0
Ar 241,1
Ar 242,2
Ar 243,3
Ar 244,4
Ar 245,5
Ar 246,6
Ar 247,7
v_pk_mul_f32 v[240:241], v[240:241], v[250:251]
v_pk_mul_f32 v[242:243], v[242:243], v[250:251]
v_pk_mul_f32 v[244:245], v[244:245], v[250:251]
v_pk_mul_f32 v[246:247], v[246:247], v[250:251]
Vc 24,240,241
Vc 25,242,243
Vc 26,244,245
Vc 27,246,247
buffer_store_dwordx4 v[24:27], v248, s[16:19], s3 offen sc1
s_add_u32 s3, s3, 8192
Ar 240,40
Ar 241,41
Ar 242,42
Ar 243,43
Ar 244,44
Ar 245,45
Ar 246,46
Ar 247,47
v_pk_mul_f32 v[240:241], v[240:241], v[252:253]
v_pk_mul_f32 v[242:243], v[242:243], v[252:253]
v_pk_mul_f32 v[244:245], v[244:245], v[252:253]
v_pk_mul_f32 v[246:247], v[246:247], v[252:253]
Vc 28,240,241
Vc 29,242,243
Vc 30,244,245
Vc 31,246,247
buffer_store_dwordx4 v[28:31], v249, s[16:19], s3 offen sc1
Ar 240,8
Ar 241,9
Ar 242,10
Ar 243,11
Ar 244,12
Ar 245,13
Ar 246,14
Ar 247,15
v_pk_mul_f32 v[240:241], v[240:241], v[250:251]
v_pk_mul_f32 v[242:243], v[242:243], v[250:251]
v_pk_mul_f32 v[244:245], v[244:245], v[250:251]
v_pk_mul_f32 v[246:247], v[246:247], v[250:251]
Vc 24,240,241
Vc 25,242,243
Vc 26,244,245
Vc 27,246,247
buffer_store_dwordx4 v[24:27], v248, s[16:19], s3 offen sc1
s_add_u32 s3, s3, 8192
Ar 240,48
Ar 241,49
Ar 242,50
Ar 243,51
Ar 244,52
Ar 245,53
Ar 246,54
Ar 247,55
v_pk_mul_f32 v[240:241], v[240:241], v[252:253]
v_pk_mul_f32 v[242:243], v[242:243], v[252:253]
v_pk_mul_f32 v[244:245], v[244:245], v[252:253]
v_pk_mul_f32 v[246:247], v[246:247], v[252:253]
Vc 28,240,241
Vc 29,242,243
Vc 30,244,245
Vc 31,246,247
buffer_store_dwordx4 v[28:31], v249, s[16:19], s3 offen sc1
Ar 240,16
Ar 241,17
Ar 242,18
Ar 243,19
Ar 244,20
Ar 245,21
Ar 246,22
Ar 247,23
v_pk_mul_f32 v[240:241], v[240:241], v[250:251]
v_pk_mul_f32 v[242:243], v[242:243], v[250:251]
v_pk_mul_f32 v[244:245], v[244:245], v[250:251]
v_pk_mul_f32 v[246:247], v[246:247], v[250:251]
Vc 24,240,241
Vc 25,242,243
Vc 26,244,245
Vc 27,246,247
buffer_store_dwordx4 v[24:27], v248, s[16:19], s3 offen sc1
s_add_u32 s3, s3, 8192
Ar 240,56
Ar 241,57
Ar 242,58
Ar 243,59
Ar 244,60
Ar 245,61
Ar 246,62
Ar 247,63
v_pk_mul_f32 v[240:241], v[240:241], v[252:253]
v_pk_mul_f32 v[242:243], v[242:243], v[252:253]
v_pk_mul_f32 v[244:245], v[244:245], v[252:253]
v_pk_mul_f32 v[246:247], v[246:247], v[252:253]
Vc 28,240,241
Vc 29,242,243
Vc 30,244,245
Vc 31,246,247
buffer_store_dwordx4 v[28:31], v249, s[16:19], s3 offen sc1
Ar 240,24
Ar 241,25
Ar 242,26
Ar 243,27
Ar 244,28
Ar 245,29
Ar 246,30
Ar 247,31
v_pk_mul_f32 v[240:241], v[240:241], v[250:251]
v_pk_mul_f32 v[242:243], v[242:243], v[250:251]
v_pk_mul_f32 v[244:245], v[244:245], v[250:251]
v_pk_mul_f32 v[246:247], v[246:247], v[250:251]
Vc 24,240,241
Vc 25,242,243
Vc 26,244,245
Vc 27,246,247
buffer_store_dwordx4 v[24:27], v248, s[16:19], s3 offen sc1
s_cmp_ge_u32 s93, 224
s_cbranch_scc1 L_noffn
v_lshrrev_b32 v24, 4, v0
v_bfe_u32 v25, v0, 2, 2
v_lshl_add_u32 v26, v24, 3, v25
v_lshlrev_b32 v26, 8, v26
v_and_b32 v27, 3, v0
v_lshl_add_u32 v26, v27, 3, v26
v_and_b32_e64 v27, 1, v24
v_lshl_add_u32 v25, v27, 2, v25
s_lshl_b32 s3, s32, 1
v_xor_b32 v25, s3, v25
v_lshl_add_u32 v26, v25, 5, v26
s_sub_u32 s3, s54, s44
v_add_u32 v26, s3, v26
v_xor_b32 v27, 32, v26
s_waitcnt vmcnt(8) lgkmcnt(0)
s_barrier
s_nop 0
ds_read_b64_tr_b16 v[128:129], v26 offset:0
ds_read_b64_tr_b16 v[130:131], v26 offset:1024
ds_read_b64_tr_b16 v[132:133], v27 offset:0
ds_read_b64_tr_b16 v[134:135], v27 offset:1024
ds_read_b64_tr_b16 v[136:137], v26 offset:8192
ds_read_b64_tr_b16 v[138:139], v26 offset:9216
ds_read_b64_tr_b16 v[140:141], v27 offset:8192
ds_read_b64_tr_b16 v[142:143], v27 offset:9216
ds_read_b64_tr_b16 v[144:145], v26 offset:16384
ds_read_b64_tr_b16 v[146:147], v26 offset:17408
ds_read_b64_tr_b16 v[148:149], v27 offset:16384
ds_read_b64_tr_b16 v[150:151], v27 offset:17408
ds_read_b64_tr_b16 v[152:153], v26 offset:24576
ds_read_b64_tr_b16 v[154:155], v26 offset:25600
ds_read_b64_tr_b16 v[156:157], v27 offset:24576
s_waitcnt lgkmcnt(9)
s_nop 0
ds_read_b64_tr_b16 v[158:159], v27 offset:25600
ds_read_b64_tr_b16 v[160:161], v26 offset:32768
ds_read_b64_tr_b16 v[162:163], v26 offset:33792
ds_read_b64_tr_b16 v[164:165], v27 offset:32768
ds_read_b64_tr_b16 v[166:167], v27 offset:33792
ds_read_b64_tr_b16 v[168:169], v26 offset:40960
s_waitcnt lgkmcnt(9)
s_nop 0
ds_read_b64_tr_b16 v[170:171], v26 offset:41984
ds_read_b64_tr_b16 v[172:173], v27 offset:40960
ds_read_b64_tr_b16 v[174:175], v27 offset:41984
ds_read_b64_tr_b16 v[176:177], v26 offset:49152
ds_read_b64_tr_b16 v[178:179], v26 offset:50176
ds_read_b64_tr_b16 v[180:181], v27 offset:49152
s_waitcnt lgkmcnt(9)
ds_read_b64_tr_b16 v[182:183], v27 offset:50176
ds_read_b64_tr_b16 v[184:185], v26 offset:57344
ds_read_b64_tr_b16 v[186:187], v26 offset:58368
ds_read_b64_tr_b16 v[188:189], v27 offset:57344
ds_read_b64_tr_b16 v[190:191], v27 offset:58368
v_and_b32 v25, 15, v0
v_mul_u32_u24 v28, 14336, v25
v_lshl_add_u32 v28, v24, 4, v28
v_mov_b32 v29, 2146435072
v_cmp_gt_u32 vcc, 2, v25
s_mul_i32 s3, s92, 57344
s_lshl_b32 s47, s4, 9
s_add_u32 s3, s3, s47
v_cndmask_b32 v28, v29, v28, vcc
s_lshl_b32 s47, s32, 7
s_add_u32 s3, s3, s47
s_add_u32 s3, s3, 6291456
Zvva 224,128,160
Zvva 228,132,160
Mvva 224,136,164
Mvva 228,140,164
Mvva 224,144,168
Mvva 228,148,168
Mvva 224,152,172
Mvva 228,156,172
s_waitcnt lgkmcnt(0)
Zvva 232,160,160
Zvva 236,164,160
Mvva 232,168,164
Mvva 236,172,164
Mvva 232,176,168
Mvva 236,180,168
Mvva 232,184,172
Mvva 236,188,172
L_noffn:
s_add_u32 s36, s36, s7
s_and_b32 s94, s7, 128
s_lshl_b32 s38, s45, 7
s_lshl_b32 s6, s52, 6
s_add_u32 s38, s38, s6
s_add_u32 s38, s38, 5300224
s_lshl_b32 s52, s32, 11
s_and_b32 s6, s32, 1
s_lshl_b32 s6, s6, 16
s_lshr_b32 s7, s32, 1
s_lshl_b32 s7, s7, 7
s_xor_b32 s7, s7, s94
s_xor_b32 s7, s7, 128
s_add_u32 s6, s6, s7
s_lshl_b32 s7, s32, 5
s_mov_b32 s68, s10
s_and_b32 s69, s11, 0xffff
s_mov_b32 s70, 4194304
s_mov_b32 s71, 0x20000
s_add_u32 s8, s66, s37
s_addc_u32 s9, s67, 0
s_and_b32 s9, s9, 0xffff
s_mov_b32 s10, 524288
s_mov_b32 s11, 0x20000
v_lshlrev_b32 v112, 4, v0
v_lshrrev_b32 v121, 4, v0
v_and_b32 v122, 7, v0
v_lshrrev_b32 v123, 3, v0
v_lshlrev_b32 v124, 1, v121
v_xor_b32 v124, v124, v122
v_lshlrev_b32_e64 v124, 4, v124
v_lshl_add_u32 v113, v123, 11, v124
v_add_u32 v114, s6, v113
v_lshrrev_b32 v124, 2, v0
v_bfe_u32 v126, v0, 3, 2
v_lshlrev_b32 v124, 7, v124
v_and_b32 v125, 3, v0
v_lshl_add_u32 v124, v125, 3, v124
v_lshl_add_u32 v115, v126, 5, v124
v_xor_b32 v116, 32, v115
v_xor_b32 v117, 64, v115
v_xor_b32 v118, 96, v115
v_add_u32 v120, s7, v123
v_lshlrev_b32 v119, 11, v120
v_lshl_add_u32 v119, v122, 4, v119
v_mov_b32 v126, 0
v_lshlrev_b32 v127, 2, v122
v_mov_b32 v24, 1
v_mul_u32_u24 v25, s65, v0
s_waitcnt vmcnt(0)
s_barrier
s_mov_b64 exec, 3
buffer_store_dword v24, v25, s[20:23], s64 offen sc1
s_mov_b64 exec, -1
s_cmp_lt_u32 s93, 224
s_cselect_b32 s3, s3, 8388608
s_add_u32 s7, s3, 28672
buffer_store_dwordx4 v[224:227], v28, s[20:23], s3 offen offset:0 sc1
buffer_store_dwordx4 v[228:231], v28, s[20:23], s3 offen offset:64 sc1
buffer_store_dwordx4 v[232:235], v28, s[20:23], s7 offen offset:0 sc1
buffer_store_dwordx4 v[236:239], v28, s[20:23], s7 offen offset:64 sc1
s_mov_b32 s3, s36
s_nop 0
buffer_load_dwordx4 v[18:21], v119, s[56:59], s3 offen
s_add_u32 s3, s3, 16384
buffer_load_dwordx4 v[22:25], v119, s[56:59], s3 offen
s_add_u32 s3, s3, 16384
buffer_load_dwordx4 v[26:29], v119, s[56:59], s3 offen
s_add_u32 s3, s3, 16384
buffer_load_dwordx4 v[30:33], v119, s[56:59], s3 offen
s_lshl_b32 s3, s45, 10
s_add_u32 s3, s3, 5259264
v_lshlrev_b32 v124, 3, v120
buffer_load_dwordx2 v[34:35], v124, s[20:23], s3 offen offset:0 sc1
buffer_load_dwordx2 v[36:37], v124, s[20:23], s3 offen offset:64 sc1
buffer_load_dwordx2 v[38:39], v124, s[20:23], s3 offen offset:128 sc1
buffer_load_dwordx2 v[40:41], v124, s[20:23], s3 offen offset:192 sc1
v_and_b32 v10, 15, v0
v_lshlrev_b32 v10, 2, v10
s_add_u32 s95, s32, 32
s_lshl_b32 s95, s95, 16
s_add_u32 s95, s95, s94
s_xor_b32 s95, s95, 128
s_add_u32 m0, s44, 0
s_nop 0
s_nop 0
buffer_load_dwordx4 v114, s[12:15], s48 offen offset:0 lds
buffer_load_dwordx4 v114, s[12:15], s49 offen offset:1024 lds
buffer_load_dwordx4 v114, s[12:15], s50 offen offset:2048 lds
buffer_load_dwordx4 v114, s[12:15], s51 offen offset:3072 lds
v_add_u32 v114, 131072, v114
s_add_u32 m0, s44, 16384
s_nop 0
s_nop 0
buffer_load_dwordx4 v114, s[12:15], s48 offen offset:0 lds
buffer_load_dwordx4 v114, s[12:15], s49 offen offset:1024 lds
buffer_load_dwordx4 v114, s[12:15], s50 offen offset:2048 lds
buffer_load_dwordx4 v114, s[12:15], s51 offen offset:3072 lds
v_add_u32 v114, 131072, v114
buffer_load_dword v124, v10, s[20:23], s38 offen sc1
v_add_u32 v12, 65536, v115
v_add_u32 v13, 65536, v116
v_add_u32 v14, 65536, v117
v_add_u32 v15, 65536, v118
s_and_b32 s39, s93, 15
s_lshr_b32 s37, s93, 4
s_lshl_b32 s54, s37, 2
s_add_u32 s54, s54, s32
s_lshl_b32 s3, s54, 17
s_lshl_b32 s7, s39, 7
s_add_u32 s3, s3, s7
s_cmp_lt_u32 s93, 224
s_cselect_b32 s3, s3, 2146435072
v_add_u32 v125, s3, v113
s_mov_b32 s40, 0
s_waitcnt vmcnt(9)
v_lshlrev_b32_e64 v42, 16, v18
v_and_b32 v43, 0xffff0000, v18
v_lshlrev_b32_e64 v44, 16, v19
v_and_b32 v45, 0xffff0000, v19
v_lshlrev_b32_e64 v46, 16, v20
v_and_b32 v47, 0xffff0000, v20
v_lshlrev_b32_e64 v48, 16, v21
v_and_b32 v49, 0xffff0000, v21
v_pk_add_f32 v[42:43], v[42:43], v[34:35] op_sel_hi:[1,0] neg_lo:[0,1] neg_hi:[0,1]
v_pk_add_f32 v[44:45], v[44:45], v[34:35] op_sel_hi:[1,0] neg_lo:[0,1] neg_hi:[0,1]
v_pk_add_f32 v[46:47], v[46:47], v[34:35] op_sel_hi:[1,0] neg_lo:[0,1] neg_hi:[0,1]
v_pk_add_f32 v[48:49], v[48:49], v[34:35] op_sel_hi:[1,0] neg_lo:[0,1] neg_hi:[0,1]
Vc 2,42,43
v_lshlrev_b32_e64 v42, 16, v2
v_and_b32 v43, 0xffff0000, v2
Vc 3,44,45
v_lshlrev_b32_e64 v44, 16, v3
v_and_b32 v45, 0xffff0000, v3
Vc 4,46,47
v_lshlrev_b32_e64 v46, 16, v4
v_and_b32 v47, 0xffff0000, v4
Vc 5,48,49
v_lshlrev_b32_e64 v48, 16, v5
v_and_b32 v49, 0xffff0000, v5
v_pk_mul_f32 v[42:43], v[42:43], v[34:35] op_sel:[0,1] op_sel_hi:[1,1]
v_pk_mul_f32 v[44:45], v[44:45], v[34:35] op_sel:[0,1] op_sel_hi:[1,1]
v_pk_mul_f32 v[46:47], v[46:47], v[34:35] op_sel:[0,1] op_sel_hi:[1,1]
v_pk_mul_f32 v[48:49], v[48:49], v[34:35] op_sel:[0,1] op_sel_hi:[1,1]
Vc 2,42,43
v_lshlrev_b32_e64 v42, 16, v2
v_and_b32 v43, 0xffff0000, v2
Vc 3,44,45
v_lshlrev_b32_e64 v44, 16, v3
v_and_b32 v45, 0xffff0000, v3
Vc 4,46,47
v_lshlrev_b32_e64 v46, 16, v4
v_and_b32 v47, 0xffff0000, v4
Vc 5,48,49
v_lshlrev_b32_e64 v48, 16, v5
v_and_b32 v49, 0xffff0000, v5
v_mul_f32 v2, 0xbfb8aa3b, v42
v_mul_f32 v3, 0xbfb8aa3b, v43
v_mul_f32 v4, 0xbfb8aa3b, v44
v_mul_f32 v5, 0xbfb8aa3b, v45
v_mul_f32 v6, 0xbfb8aa3b, v46
v_mul_f32 v7, 0xbfb8aa3b, v47
v_mul_f32 v8, 0xbfb8aa3b, v48
v_mul_f32 v9, 0xbfb8aa3b, v49
Ve 2,2
Ve 3,3
Ve 4,4
Ve 5,5
Ve 6,6
Ve 7,7
Ve 8,8
Ve 9,9
v_add_f32 v2, 1.0, v2
v_add_f32 v3, 1.0, v3
v_add_f32 v4, 1.0, v4
v_add_f32 v5, 1.0, v5
v_add_f32 v6, 1.0, v6
v_add_f32 v7, 1.0, v7
v_add_f32 v8, 1.0, v8
v_add_f32 v9, 1.0, v9
v_rcp_f32 v2, v2
v_rcp_f32 v3, v3
v_rcp_f32 v4, v4
v_rcp_f32 v5, v5
v_rcp_f32 v6, v6
v_rcp_f32 v7, v7
v_rcp_f32 v8, v8
v_rcp_f32 v9, v9
v_pk_mul_f32 v[42:43], v[42:43], v[2:3]
v_pk_mul_f32 v[44:45], v[44:45], v[4:5]
v_pk_mul_f32 v[46:47], v[46:47], v[6:7]
v_pk_mul_f32 v[48:49], v[48:49], v[8:9]
Vc 2,42,43
v_lshlrev_b32_e64 v42, 16, v2
v_and_b32 v43, 0xffff0000, v2
Vc 3,44,45
v_lshlrev_b32_e64 v44, 16, v3
v_and_b32 v45, 0xffff0000, v3
Vc 4,46,47
v_lshlrev_b32_e64 v46, 16, v4
v_and_b32 v47, 0xffff0000, v4
Vc 5,48,49
v_lshlrev_b32_e64 v48, 16, v5
v_and_b32 v49, 0xffff0000, v5
s_waitcnt vmcnt(0)
v_cmp_ne_u32 vcc, 1, v124
s_cbranch_vccnz L_spinC
s_nop 0
L_spinCr:
buffer_load_dwordx4 a[0:3], v112, s[8:11], s52 offen offset:0 sc1
buffer_load_dwordx4 a[4:7], v112, s[8:11], s52 offen offset:1024 sc1
s_add_u32 s52, s52, 8192
buffer_load_dwordx4 a[8:11], v112, s[8:11], s52 offen offset:0 sc1
buffer_load_dwordx4 a[12:15], v112, s[8:11], s52 offen offset:1024 sc1
s_add_u32 s52, s52, 8192
buffer_load_dwordx4 a[16:19], v112, s[8:11], s52 offen offset:0 sc1
buffer_load_dwordx4 a[20:23], v112, s[8:11], s52 offen offset:1024 sc1
s_add_u32 s52, s52, 8192
buffer_load_dwordx4 a[24:27], v112, s[8:11], s52 offen offset:0 sc1
buffer_load_dwordx4 a[28:31], v112, s[8:11], s52 offen offset:1024 sc1
s_add_u32 s52, s52, 8192
v_lshlrev_b32_e64 v50, 16, v22
v_and_b32 v51, 0xffff0000, v22
v_lshlrev_b32_e64 v52, 16, v23
v_and_b32 v53, 0xffff0000, v23
v_lshlrev_b32_e64 v54, 16, v24
v_and_b32 v55, 0xffff0000, v24
v_lshlrev_b32_e64 v56, 16, v25
v_and_b32 v57, 0xffff0000, v25
v_pk_add_f32 v[50:51], v[50:51], v[36:37] op_sel_hi:[1,0] neg_lo:[0,1] neg_hi:[0,1]
v_pk_add_f32 v[52:53], v[52:53], v[36:37] op_sel_hi:[1,0] neg_lo:[0,1] neg_hi:[0,1]
v_pk_add_f32 v[54:55], v[54:55], v[36:37] op_sel_hi:[1,0] neg_lo:[0,1] neg_hi:[0,1]
v_pk_add_f32 v[56:57], v[56:57], v[36:37] op_sel_hi:[1,0] neg_lo:[0,1] neg_hi:[0,1]
Vc 2,50,51
v_lshlrev_b32_e64 v50, 16, v2
v_and_b32 v51, 0xffff0000, v2
Vc 3,52,53
v_lshlrev_b32_e64 v52, 16, v3
v_and_b32 v53, 0xffff0000, v3
Vc 4,54,55
v_lshlrev_b32_e64 v54, 16, v4
v_and_b32 v55, 0xffff0000, v4
Vc 5,56,57
v_lshlrev_b32_e64 v56, 16, v5
v_and_b32 v57, 0xffff0000, v5
v_pk_mul_f32 v[50:51], v[50:51], v[36:37] op_sel:[0,1] op_sel_hi:[1,1]
v_pk_mul_f32 v[52:53], v[52:53], v[36:37] op_sel:[0,1] op_sel_hi:[1,1]
v_pk_mul_f32 v[54:55], v[54:55], v[36:37] op_sel:[0,1] op_sel_hi:[1,1]
v_pk_mul_f32 v[56:57], v[56:57], v[36:37] op_sel:[0,1] op_sel_hi:[1,1]
Vc 2,50,51
v_lshlrev_b32_e64 v50, 16, v2
v_and_b32 v51, 0xffff0000, v2
Vc 3,52,53
v_lshlrev_b32_e64 v52, 16, v3
v_and_b32 v53, 0xffff0000, v3
Vc 4,54,55
v_lshlrev_b32_e64 v54, 16, v4
v_and_b32 v55, 0xffff0000, v4
Vc 5,56,57
v_lshlrev_b32_e64 v56, 16, v5
v_and_b32 v57, 0xffff0000, v5
v_mul_f32 v2, 0xbfb8aa3b, v50
v_mul_f32 v3, 0xbfb8aa3b, v51
v_mul_f32 v4, 0xbfb8aa3b, v52
v_mul_f32 v5, 0xbfb8aa3b, v53
v_mul_f32 v6, 0xbfb8aa3b, v54
v_mul_f32 v7, 0xbfb8aa3b, v55
v_mul_f32 v8, 0xbfb8aa3b, v56
v_mul_f32 v9, 0xbfb8aa3b, v57
Ve 2,2
Ve 3,3
Ve 4,4
Ve 5,5
Ve 6,6
Ve 7,7
Ve 8,8
Ve 9,9
v_add_f32 v2, 1.0, v2
v_add_f32 v3, 1.0, v3
v_add_f32 v4, 1.0, v4
v_add_f32 v5, 1.0, v5
v_add_f32 v6, 1.0, v6
v_add_f32 v7, 1.0, v7
v_add_f32 v8, 1.0, v8
v_add_f32 v9, 1.0, v9
v_rcp_f32 v2, v2
v_rcp_f32 v3, v3
v_rcp_f32 v4, v4
v_rcp_f32 v5, v5
v_rcp_f32 v6, v6
v_rcp_f32 v7, v7
v_rcp_f32 v8, v8
v_rcp_f32 v9, v9
v_pk_mul_f32 v[50:51], v[50:51], v[2:3]
v_pk_mul_f32 v[52:53], v[52:53], v[4:5]
v_pk_mul_f32 v[54:55], v[54:55], v[6:7]
v_pk_mul_f32 v[56:57], v[56:57], v[8:9]
Vc 2,50,51
v_lshlrev_b32_e64 v50, 16, v2
v_and_b32 v51, 0xffff0000, v2
Vc 3,52,53
v_lshlrev_b32_e64 v52, 16, v3
v_and_b32 v53, 0xffff0000, v3
Vc 4,54,55
v_lshlrev_b32_e64 v54, 16, v4
v_and_b32 v55, 0xffff0000, v4
Vc 5,56,57
v_lshlrev_b32_e64 v56, 16, v5
v_and_b32 v57, 0xffff0000, v5
buffer_load_dwordx4 a[32:35], v112, s[8:11], s52 offen offset:0 sc1
buffer_load_dwordx4 a[36:39], v112, s[8:11], s52 offen offset:1024 sc1
s_add_u32 s52, s52, 8192
buffer_load_dwordx4 a[40:43], v112, s[8:11], s52 offen offset:0 sc1
buffer_load_dwordx4 a[44:47], v112, s[8:11], s52 offen offset:1024 sc1
s_add_u32 s52, s52, 8192
s_add_u32 m0, s44, 32768
s_nop 0
buffer_load_dwordx4 v114, s[12:15], s48 offen offset:0 lds
buffer_load_dwordx4 v114, s[12:15], s49 offen offset:1024 lds
buffer_load_dwordx4 v114, s[12:15], s50 offen offset:2048 lds
buffer_load_dwordx4 v114, s[12:15], s51 offen offset:3072 lds
v_add_u32 v114, 131072, v114
s_cmp_lg_u32 s40, 0
s_cbranch_scc1 L_nowd
s_add_u32 m0, s35, 0
s_nop 0
s_nop 0
buffer_load_dwordx4 v125, s[60:63], s48 offen offset:0 lds
buffer_load_dwordx4 v125, s[60:63], s49 offen offset:1024 lds
buffer_load_dwordx4 v125, s[60:63], s50 offen offset:2048 lds
buffer_load_dwordx4 v125, s[60:63], s51 offen offset:3072 lds
v_add_u32 v125, 65536, v125
s_add_u32 m0, s35, 4096
s_nop 0
buffer_load_dwordx4 v125, s[60:63], s48 offen offset:0 lds
buffer_load_dwordx4 v125, s[60:63], s49 offen offset:1024 lds
buffer_load_dwordx4 v125, s[60:63], s50 offen offset:2048 lds
buffer_load_dwordx4 v125, s[60:63], s51 offen offset:3072 lds
L_nowd:
s_cmp_lt_u32 s2, 128
s_cbranch_scc1 L_noc3
s_bfe_u32 s3, s2, 0x40003
s_lshl_b32 s3, s3, 2
s_add_u32 s3, s3, s32
s_lshl_b32 s3, s3, 15
s_and_b32 s7, s2, 1
s_lshl_b32 s7, s7, 22
s_add_u32 s3, s3, s7
s_add_u32 s3, s3, 384
v_and_b32 v1, 15, v0
v_lshlrev_b32 v1, 11, v1
v_lshrrev_b32_e64 v11, 5, v0
v_lshl_add_u32 v1, v11, 10, v1
buffer_load_dword v11, v1, s[28:31], s3 offen
L_noc3:
s_barrier
s_nop 0
ds_read_b64_tr_b16 v[192:193], v115 offset:0
ds_read_b64_tr_b16 v[194:195], v115 offset:2048
ds_read_b64_tr_b16 v[196:197], v116 offset:0
ds_read_b64_tr_b16 v[198:199], v116 offset:2048
ds_read_b64_tr_b16 v[200:201], v117 offset:0
ds_read_b64_tr_b16 v[202:203], v117 offset:2048
ds_read_b64_tr_b16 v[204:205], v118 offset:0
ds_read_b64_tr_b16 v[206:207], v118 offset:2048
ds_read_b64_tr_b16 v[208:209], v115 offset:4096
ds_read_b64_tr_b16 v[210:211], v115 offset:6144
ds_read_b64_tr_b16 v[212:213], v116 offset:4096
ds_read_b64_tr_b16 v[214:215], v116 offset:6144
ds_read_b64_tr_b16 v[216:217], v117 offset:4096
ds_read_b64_tr_b16 v[218:219], v117 offset:6144
ds_read_b64_tr_b16 v[220:221], v118 offset:4096
s_waitcnt lgkmcnt(9)
ds_read_b64_tr_b16 v[222:223], v118 offset:6144
s_waitcnt vmcnt(12)
Zvva 160,192,0
ds_read_b64_tr_b16 v[224:225], v115 offset:8192
ds_read_b64_tr_b16 v[226:227], v115 offset:10240
v_mov_b32 v125, 1
s_waitcnt lgkmcnt(8)
Mvva 160,208,8
s_lshl_b32 s6, s4, 3
s_add_u32 s6, s6, s92
s_lshl_b32 s6, s6, 2
Zvva 176,192,4
s_waitcnt lgkmcnt(6)
s_add_u32 m0, s44, 49152
ds_read_b64_tr_b16 v[240:241], v115 offset:12288
ds_read_b64_tr_b16 v[242:243], v115 offset:14336
Mvva 176,208,12
buffer_load_dwordx4 v114, s[12:15], s48 offen offset:0 lds
Zvva 164,196,0
ds_read_b64_tr_b16 v[228:229], v116 offset:8192
ds_read_b64_tr_b16 v[230:231], v116 offset:10240
Mvva 164,212,8
s_add_u32 s6, s6, 5447680
s_cmp_eq_u32 s32, 0
s_cselect_b32 s6, s6, s64
s_cmp_lt_u32 s93, 224
s_cselect_b32 s6, s6, 2146435072
Zvva 180,196,4
s_waitcnt lgkmcnt(8)
ds_read_b64_tr_b16 v[244:245], v116 offset:12288
ds_read_b64_tr_b16 v[246:247], v116 offset:14336
Mvva 180,212,12
buffer_load_dwordx4 v114, s[12:15], s49 offen offset:1024 lds
Zvva 168,200,0
ds_read_b64_tr_b16 v[232:233], v117 offset:8192
ds_read_b64_tr_b16 v[234:235], v117 offset:10240
Mvva 168,216,8
s_mov_b64 exec, 1
buffer_store_dword v125, v126, s[20:23], s6 offen sc1
s_mov_b64 exec, -1
Zvva 184,200,4
s_waitcnt lgkmcnt(10)
ds_read_b64_tr_b16 v[248:249], v117 offset:12288
ds_read_b64_tr_b16 v[250:251], v117 offset:14336
Mvva 184,216,12
buffer_load_dwordx4 v114, s[12:15], s50 offen offset:2048 lds
Zvva 172,204,0
ds_read_b64_tr_b16 v[236:237], v118 offset:8192
ds_read_b64_tr_b16 v[238:239], v118 offset:10240
Mvva 172,220,8
s_waitcnt lgkmcnt(10)
s_lshl_b32 s40, s45, 2
s_add_u32 s40, s40, s32
s_lshr_b32 s3, s42, 5
s_lshr_b32 s47, s43, 5
s_cmp_eq_u32 s3, s40
s_cselect_b32 s53, 1, 0
s_cmp_eq_u32 s47, s40
s_cselect_b32 s53, 1, s53
s_mov_b32 s40, 0
Zvva 188,204,4
s_barrier
ds_read_b64_tr_b16 v[252:253], v118 offset:12288
ds_read_b64_tr_b16 v[254:255], v118 offset:14336
Mvva 188,220,12
buffer_load_dwordx4 v114, s[12:15], s51 offen offset:3072 lds
v_add_u32 v114, 131072, v114
Zvva 128,224,0
ds_read_b64_tr_b16 v[192:193], v115 offset:16384
ds_read_b64_tr_b16 v[194:195], v115 offset:18432
Mvva 128,240,8
s_lshl_b32 s41, s46, 7
s_add_u32 s41, s41, 5449728
s_lshl_b32 s55, s46, 13
Zvva 144,224,4
s_waitcnt lgkmcnt(10)
ds_read_b64_tr_b16 v[208:209], v115 offset:20480
ds_read_b64_tr_b16 v[210:211], v115 offset:22528
Mvva 144,240,12
buffer_load_dwordx4 a[48:51], v112, s[8:11], s52 offen offset:0 sc1
Zvva 132,228,0
ds_read_b64_tr_b16 v[196:197], v116 offset:16384
ds_read_b64_tr_b16 v[198:199], v116 offset:18432
Mvva 132,244,8
s_add_u32 s55, s55, 5308416
s_add_u32 s16, s66, 88080384
s_addc_u32 s17, s67, 0
s_and_b32 s17, s17, 0xffff
Zvva 148,228,4
s_waitcnt lgkmcnt(10)
ds_read_b64_tr_b16 v[212:213], v116 offset:20480
ds_read_b64_tr_b16 v[214:215], v116 offset:22528
Mvva 148,244,12
buffer_load_dwordx4 a[52:55], v112, s[8:11], s52 offen offset:1024 sc1
s_add_u32 s52, s52, 8192
Zvva 136,232,0
ds_read_b64_tr_b16 v[200:201], v117 offset:16384
ds_read_b64_tr_b16 v[202:203], v117 offset:18432
Mvva 136,248,8
s_mov_b32 s18, 8388608
s_mov_b32 s19, 0x20000
s_lshl_b32 s24, s2, 2
Zvva 152,232,4
s_waitcnt lgkmcnt(10)
ds_read_b64_tr_b16 v[216:217], v117 offset:20480
ds_read_b64_tr_b16 v[218:219], v117 offset:22528
Mvva 152,248,12
buffer_load_dwordx4 a[56:59], v112, s[8:11], s52 offen offset:0 sc1
Zvva 140,236,0
ds_read_b64_tr_b16 v[204:205], v118 offset:16384
ds_read_b64_tr_b16 v[206:207], v118 offset:18432
Mvva 140,252,8
s_add_u32 s24, s24, s32
s_lshl_b32 s25, s24, 13
s_xor_b32 s26, s25, 32768
Zvva 156,236,4
s_waitcnt lgkmcnt(10)
ds_read_b64_tr_b16 v[220:221], v118 offset:20480
ds_read_b64_tr_b16 v[222:223], v118 offset:22528
Mvva 156,252,12
buffer_load_dwordx4 a[60:63], v112, s[8:11], s52 offen offset:1024 sc1
s_add_u32 s52, s52, 8192
s_waitcnt vmcnt(17)
Mvva 160,192,16
ds_read_b64_tr_b16 v[224:225], v115 offset:24576
ds_read_b64_tr_b16 v[226:227], v115 offset:26624
Mvva 160,208,24
s_lshl_b32 s24, s24, 2
s_xor_b32 s27, s24, 16
s_add_u32 s24, s24, 5452800
Mvva 176,192,20
s_waitcnt lgkmcnt(10)
s_add_u32 m0, s44, 65536
ds_read_b64_tr_b16 v[240:241], v115 offset:28672
ds_read_b64_tr_b16 v[242:243], v115 offset:30720
Mvva 176,208,28
buffer_load_dwordx4 v114, s[12:15], s48 offen offset:0 lds
Mvva 164,196,16
ds_read_b64_tr_b16 v[228:229], v116 offset:24576
ds_read_b64_tr_b16 v[230:231], v116 offset:26624
Mvva 164,212,24
s_add_u32 s27, s27, 5452800
v_lshlrev_b32 v58, 16, v26
v_and_b32 v59, 0xffff0000, v26
v_lshlrev_b32_e64 v60, 16, v27
v_and_b32 v61, 0xffff0000, v27
v_lshlrev_b32_e64 v62, 16, v28
Mvva 180,196,20
s_waitcnt lgkmcnt(10)
ds_read_b64_tr_b16 v[244:245], v116 offset:28672
ds_read_b64_tr_b16 v[246:247], v116 offset:30720
v_and_b32 v63, 0xffff0000, v28
Mvva 180,212,28
buffer_load_dwordx4 v114, s[12:15], s49 offen offset:1024 lds
Mvva 168,200,16
ds_read_b64_tr_b16 v[232:233], v117 offset:24576
ds_read_b64_tr_b16 v[234:235], v117 offset:26624
v_lshlrev_b32 v64, 16, v29
Mvva 168,216,24
v_and_b32 v65, 0xffff0000, v29
Vs 58,58,38
Vs 59,59,38
Vs 60,60,38
Vs 61,61,38
Mvva 184,200,20
s_waitcnt lgkmcnt(10)
ds_read_b64_tr_b16 v[248:249], v117 offset:28672
ds_read_b64_tr_b16 v[250:251], v117 offset:30720
Vs 62,62,38
Mvva 184,216,28
buffer_load_dwordx4 v114, s[12:15], s50 offen offset:2048 lds
Mvva 172,204,16
s_waitcnt vmcnt(12)
ds_read_b64_tr_b16 v[236:237], v118 offset:24576
ds_read_b64_tr_b16 v[238:239], v118 offset:26624
Vs 63,63,38
Mvva 172,220,24
s_waitcnt lgkmcnt(10)
Vs 64,64,38
v_sub_f32_e64 v65, v65, v38
Vc 2,58,59
v_lshlrev_b32_e64 v58, 16, v2
v_and_b32 v59, 0xffff0000, v2
Mvva 188,204,20
s_barrier
ds_read_b64_tr_b16 v[252:253], v118 offset:28672
ds_read_b64_tr_b16 v[254:255], v118 offset:30720
Vc 3,60,61
Mvva 188,220,28
buffer_load_dwordx4 v114, s[12:15], s51 offen offset:3072 lds
v_add_u32 v114, 131072, v114
Mvva 128,224,16
ds_read_b64_tr_b16 v[192:193], v115 offset:32768
ds_read_b64_tr_b16 v[194:195], v115 offset:34816
v_lshlrev_b32 v60, 16, v3
Mvva 128,240,24
v_and_b32 v61, 0xffff0000, v3
Vc 4,62,63
v_lshlrev_b32_e64 v62, 16, v4
v_and_b32 v63, 0xffff0000, v4
Vc 5,64,65
Mvva 144,224,20
s_waitcnt lgkmcnt(10)
ds_read_b64_tr_b16 v[208:209], v115 offset:36864
ds_read_b64_tr_b16 v[210:211], v115 offset:38912
v_lshlrev_b32 v64, 16, v5
Mvva 144,240,28
buffer_load_dwordx4 a[64:67], v112, s[8:11], s52 offen offset:0 sc1
Mvva 132,228,16
ds_read_b64_tr_b16 v[196:197], v116 offset:32768
ds_read_b64_tr_b16 v[198:199], v116 offset:34816
v_and_b32 v65, 0xffff0000, v5
Mvva 132,244,24
Vm 58,58,39
Vm 59,59,39
Vm 60,60,39
Vm 61,61,39
v_mul_f32_e64 v62, v62, v39
Mvva 148,228,20
s_waitcnt lgkmcnt(10)
ds_read_b64_tr_b16 v[212:213], v116 offset:36864
ds_read_b64_tr_b16 v[214:215], v116 offset:38912
Vm 63,63,39
Mvva 148,244,28
buffer_load_dwordx4 a[68:71], v112, s[8:11], s52 offen offset:1024 sc1
s_add_u32 s52, s52, 8192
Mvva 136,232,16
ds_read_b64_tr_b16 v[200:201], v117 offset:32768
ds_read_b64_tr_b16 v[202:203], v117 offset:34816
v_mul_f32_e64 v64, v64, v39
Mvva 136,248,24
v_mul_f32_e64 v65, v65, v39
Vc 2,58,59
v_lshlrev_b32_e64 v58, 16, v2
v_and_b32 v59, 0xffff0000, v2
Vc 3,60,61
Mvva 152,232,20
s_waitcnt lgkmcnt(10)
ds_read_b64_tr_b16 v[216:217], v117 offset:36864
ds_read_b64_tr_b16 v[218:219], v117 offset:38912
v_lshlrev_b32 v60, 16, v3
Mvva 152,248,28
buffer_load_dwordx4 a[72:75], v112, s[8:11], s52 offen offset:0 sc1
Mvva 140,236,16
ds_read_b64_tr_b16 v[204:205], v118 offset:32768
ds_read_b64_tr_b16 v[206:207], v118 offset:34816
v_and_b32 v61, 0xffff0000, v3
Mvva 140,252,24
Vc 4,62,63
v_lshlrev_b32_e64 v62, 16, v4
v_and_b32 v63, 0xffff0000, v4
Vc 5,64,65
v_lshlrev_b32_e64 v64, 16, v5
Mvva 156,236,20
s_waitcnt lgkmcnt(10)
ds_read_b64_tr_b16 v[220:221], v118 offset:36864
ds_read_b64_tr_b16 v[222:223], v118 offset:38912
v_and_b32 v65, 0xffff0000, v5
Mvva 156,252,28
buffer_load_dwordx4 a[76:79], v112, s[8:11], s52 offen offset:1024 sc1
s_add_u32 s52, s52, 8192
Mvva 160,192,32
ds_read_b64_tr_b16 v[224:225], v115 offset:40960
ds_read_b64_tr_b16 v[226:227], v115 offset:43008
v_mul_f32 v2, 0xbfb8aa3b, v58
Mvva 160,208,40
v_mul_f32 v3, 0xbfb8aa3b, v59
v_mul_f32 v4, 0xbfb8aa3b, v60
v_mul_f32 v5, 0xbfb8aa3b, v61
v_mul_f32 v6, 0xbfb8aa3b, v62
v_mul_f32 v7, 0xbfb8aa3b, v63
Mvva 176,192,36
s_waitcnt lgkmcnt(10)
s_add_u32 m0, s44, 81920
ds_read_b64_tr_b16 v[240:241], v115 offset:45056
ds_read_b64_tr_b16 v[242:243], v115 offset:47104
v_mul_f32 v8, 0xbfb8aa3b, v64
Mvva 176,208,44
buffer_load_dwordx4 v114, s[12:15], s48 offen offset:0 lds
Mvva 164,196,32
ds_read_b64_tr_b16 v[228:229], v116 offset:40960
ds_read_b64_tr_b16 v[230:231], v116 offset:43008
v_mul_f32 v9, 0xbfb8aa3b, v65
Mvva 164,212,40
Ve 2,2
Ve 3,3
Mvva 180,196,36
s_waitcnt lgkmcnt(10)
ds_read_b64_tr_b16 v[244:245], v116 offset:45056
ds_read_b64_tr_b16 v[246:247], v116 offset:47104
Mvva 180,212,44
buffer_load_dwordx4 v114, s[12:15], s49 offen offset:1024 lds
Mvva 168,200,32
ds_read_b64_tr_b16 v[232:233], v117 offset:40960
ds_read_b64_tr_b16 v[234:235], v117 offset:43008
Mvva 168,216,40
Ve 4,4
VE 5,5
Mvva 184,200,36
s_waitcnt lgkmcnt(10)
ds_read_b64_tr_b16 v[248:249], v117 offset:45056
ds_read_b64_tr_b16 v[250:251], v117 offset:47104
Mvva 184,216,44
buffer_load_dwordx4 v114, s[12:15], s50 offen offset:2048 lds
Mvva 172,204,32
s_waitcnt vmcnt(15)
ds_read_b64_tr_b16 v[236:237], v118 offset:40960
ds_read_b64_tr_b16 v[238:239], v118 offset:43008
Mvva 172,220,40
s_waitcnt lgkmcnt(10)
Ve 6,6
VE 7,7
Mvva 188,204,36
s_barrier
ds_read_b64_tr_b16 v[252:253], v118 offset:45056
ds_read_b64_tr_b16 v[254:255], v118 offset:47104
Mvva 188,220,44
buffer_load_dwordx4 v114, s[12:15], s51 offen offset:3072 lds
v_add_u32 v114, 131072, v114
Mvva 128,224,32
ds_read_b64_tr_b16 v[192:193], v115 offset:49152
ds_read_b64_tr_b16 v[194:195], v115 offset:51200
Mvva 128,240,40
Ve 8,8
Ve 9,9
v_add_f32 v2, 1.0, v2
Mvva 144,224,36
s_waitcnt lgkmcnt(10)
ds_read_b64_tr_b16 v[208:209], v115 offset:53248
ds_read_b64_tr_b16 v[210:211], v115 offset:55296
v_add_f32 v3, 1.0, v3
Mvva 144,240,44
buffer_load_dwordx4 a[80:83], v112, s[8:11], s52 offen offset:0 sc1
Mvva 132,228,32
ds_read_b64_tr_b16 v[196:197], v116 offset:49152
ds_read_b64_tr_b16 v[198:199], v116 offset:51200
v_add_f32_e64 v4, 1.0, v4
Mvva 132,244,40
v_add_f32 v5, 1.0, v5
v_add_f32 v6, 1.0, v6
v_add_f32 v7, 1.0, v7
v_add_f32 v8, 1.0, v8
v_add_f32_e64 v9, 1.0, v9
Mvva 148,228,36
s_waitcnt lgkmcnt(10)
ds_read_b64_tr_b16 v[212:213], v116 offset:53248
ds_read_b64_tr_b16 v[214:215], v116 offset:55296
Mvva 148,244,44
buffer_load_dwordx4 a[84:87], v112, s[8:11], s52 offen offset:1024 sc1
s_add_u32 s52, s52, 8192
Mvva 136,232,32
ds_read_b64_tr_b16 v[200:201], v117 offset:49152
ds_read_b64_tr_b16 v[202:203], v117 offset:51200
Mvva 136,248,40
v_rcp_f32 v2, v2
v_rcp_f32_e64 v3, v3
Mvva 152,232,36
s_waitcnt lgkmcnt(10)
ds_read_b64_tr_b16 v[216:217], v117 offset:53248
ds_read_b64_tr_b16 v[218:219], v117 offset:55296
Mvva 152,248,44
buffer_load_dwordx4 a[88:91], v112, s[8:11], s52 offen offset:0 sc1
Mvva 140,236,32
ds_read_b64_tr_b16 v[204:205], v118 offset:49152
ds_read_b64_tr_b16 v[206:207], v118 offset:51200
Mvva 140,252,40
v_rcp_f32 v4, v4
v_rcp_f32_e64 v5, v5
Mvva 156,236,36
s_waitcnt lgkmcnt(10)
ds_read_b64_tr_b16 v[220:221], v118 offset:53248
ds_read_b64_tr_b16 v[222:223], v118 offset:55296
Mvva 156,252,44
buffer_load_dwordx4 a[92:95], v112, s[8:11], s52 offen offset:1024 sc1
s_add_u32 s52, s52, 8192
s_waitcnt vmcnt(16)
Mvva 160,192,48
ds_read_b64_tr_b16 v[224:225], v115 offset:57344
ds_read_b64_tr_b16 v[226:227], v115 offset:59392
Mvva 160,208,56
v_rcp_f32 v6, v6
v_rcp_f32 v7, v7
Mvva 176,192,52
s_waitcnt lgkmcnt(10)
s_add_u32 m0, s44, 98304
ds_read_b64_tr_b16 v[240:241], v115 offset:61440
ds_read_b64_tr_b16 v[242:243], v115 offset:63488
Mvva 176,208,60
buffer_load_dwordx4 v114, s[12:15], s48 offen offset:0 lds
Mvva 164,196,48
ds_read_b64_tr_b16 v[228:229], v116 offset:57344
ds_read_b64_tr_b16 v[230:231], v116 offset:59392
Mvva 164,212,56
v_rcp_f32 v8, v8
v_rcp_f32 v9, v9
Vm 58,58,2
Mvva 180,196,52
s_waitcnt lgkmcnt(10)
ds_read_b64_tr_b16 v[244:245], v116 offset:61440
ds_read_b64_tr_b16 v[246:247], v116 offset:63488
Vm 59,59,3
Mvva 180,212,60
buffer_load_dwordx4 v114, s[12:15], s49 offen offset:1024 lds
Mvva 168,200,48
ds_read_b64_tr_b16 v[232:233], v117 offset:57344
ds_read_b64_tr_b16 v[234:235], v117 offset:59392
v_mul_f32_e64 v60, v60, v4
Mvva 168,216,56
Vm 61,61,5
Vm 62,62,6
Vm 63,63,7
Vm 64,64,8
v_mul_f32_e64 v65, v65, v9
Mvva 184,200,52
s_waitcnt lgkmcnt(10)
ds_read_b64_tr_b16 v[248:249], v117 offset:61440
ds_read_b64_tr_b16 v[250:251], v117 offset:63488
Vc 2,58,59
Mvva 184,216,60
buffer_load_dwordx4 v114, s[12:15], s50 offen offset:2048 lds
Mvva 172,204,48
s_waitcnt vmcnt(15)
ds_read_b64_tr_b16 v[236:237], v118 offset:57344
ds_read_b64_tr_b16 v[238:239], v118 offset:59392
v_lshlrev_b32_e64 v58, 16, v2
Mvva 172,220,56
s_waitcnt lgkmcnt(10)
v_and_b32 v59, 0xffff0000, v2
Vc 3,60,61
v_lshlrev_b32 v60, 16, v3
v_and_b32 v61, 0xffff0000, v3
Vc 4,62,63
Mvva 188,204,52
s_barrier
ds_read_b64_tr_b16 v[252:253], v118 offset:61440
ds_read_b64_tr_b16 v[254:255], v118 offset:63488
v_lshlrev_b32 v62, 16, v4
Mvva 188,220,60
buffer_load_dwordx4 v114, s[12:15], s51 offen offset:3072 lds
v_add_u32 v114, 131072, v114
Mvva 128,224,48
ds_read_b64_tr_b16 v[192:193], v12 offset:0
ds_read_b64_tr_b16 v[194:195], v12 offset:2048
v_and_b32 v63, 0xffff0000, v4
Mvva 128,240,56
Vc 5,64,65
v_lshlrev_b32_e64 v64, 16, v5
v_and_b32 v65, 0xffff0000, v5
v_lshlrev_b32_e64 v66, 16, v30
v_and_b32 v67, 0xffff0000, v30
Mvva 144,224,52
s_waitcnt lgkmcnt(10)
ds_read_b64_tr_b16 v[208:209], v12 offset:4096
ds_read_b64_tr_b16 v[210:211], v12 offset:6144
v_lshlrev_b32 v68, 16, v31
Mvva 144,240,60
buffer_load_dwordx4 a[96:99], v112, s[8:11], s52 offen offset:0 sc1
Mvva 132,228,48
ds_read_b64_tr_b16 v[196:197], v13 offset:0
ds_read_b64_tr_b16 v[198:199], v13 offset:2048
v_and_b32 v69, 0xffff0000, v31
Mvva 132,244,56
v_lshlrev_b32_e64 v70, 16, v32
v_and_b32 v71, 0xffff0000, v32
v_lshlrev_b32_e64 v72, 16, v33
v_and_b32 v73, 0xffff0000, v33
v_sub_f32_e64 v66, v66, v40
Mvva 148,228,52
s_waitcnt lgkmcnt(10)
ds_read_b64_tr_b16 v[212:213], v13 offset:4096
ds_read_b64_tr_b16 v[214:215], v13 offset:6144
Vs 67,67,40
Mvva 148,244,60
buffer_load_dwordx4 a[100:103], v112, s[8:11], s52 offen offset:1024 sc1
s_add_u32 s52, s52, 8192
Mvva 136,232,48
ds_read_b64_tr_b16 v[200:201], v14 offset:0
ds_read_b64_tr_b16 v[202:203], v14 offset:2048
v_sub_f32_e64 v68, v68, v40
Mvva 136,248,56
Vs 69,69,40
Vs 70,70,40
Vs 71,71,40
Vs 72,72,40
v_sub_f32_e64 v73, v73, v40
Mvva 152,232,52
s_waitcnt lgkmcnt(10)
ds_read_b64_tr_b16 v[216:217], v14 offset:4096
ds_read_b64_tr_b16 v[218:219], v14 offset:6144
Vc 2,66,67
Mvva 152,248,60
buffer_load_dwordx4 a[104:107], v112, s[8:11], s52 offen offset:0 sc1
Mvva 140,236,48
ds_read_b64_tr_b16 v[204:205], v15 offset:0
ds_read_b64_tr_b16 v[206:207], v15 offset:2048
v_lshlrev_b32 v66, 16, v2
Mvva 140,252,56
v_and_b32 v67, 0xffff0000, v2
Vc 3,68,69
v_lshlrev_b32_e64 v68, 16, v3
v_and_b32 v69, 0xffff0000, v3
Vc 4,70,71
Mvva 156,236,52
s_waitcnt lgkmcnt(10)
ds_read_b64_tr_b16 v[220:221], v15 offset:4096
ds_read_b64_tr_b16 v[222:223], v15 offset:6144
v_lshlrev_b32 v70, 16, v4
Mvva 156,252,60
buffer_load_dwordx4 a[108:111], v112, s[8:11], s52 offen offset:1024 sc1
s_add_u32 s52, s52, 8192
s_waitcnt vmcnt(16)
Mvva 160,192,64
ds_read_b64_tr_b16 v[224:225], v12 offset:8192
ds_read_b64_tr_b16 v[226:227], v12 offset:10240
v_and_b32 v71, 0xffff0000, v4
Mvva 160,208,72
s_cmp_lt_u32 s93, 224
s_cbranch_scc1 L_f2A
L_f2Ar:
Mvva 176,192,68
s_waitcnt lgkmcnt(10)
s_add_u32 m0, s44, 114688
ds_read_b64_tr_b16 v[240:241], v12 offset:12288
ds_read_b64_tr_b16 v[242:243], v12 offset:14336
Vc 5,72,73
Mvva 176,208,76
buffer_load_dwordx4 v114, s[12:15], s48 offen offset:0 lds
Mvva 164,196,64
ds_read_b64_tr_b16 v[228:229], v13 offset:8192
ds_read_b64_tr_b16 v[230:231], v13 offset:10240
v_lshlrev_b32 v72, 16, v5
Mvva 164,212,72
v_and_b32 v73, 0xffff0000, v5
Vm 66,66,41
Vm 67,67,41
Vm 68,68,41
Vm 69,69,41
Mvva 180,196,68
s_waitcnt lgkmcnt(10)
ds_read_b64_tr_b16 v[244:245], v13 offset:12288
ds_read_b64_tr_b16 v[246:247], v13 offset:14336
Vm 70,70,41
Mvva 180,212,76
buffer_load_dwordx4 v114, s[12:15], s49 offen offset:1024 lds
Mvva 168,200,64
ds_read_b64_tr_b16 v[232:233], v14 offset:8192
ds_read_b64_tr_b16 v[234:235], v14 offset:10240
v_mul_f32_e64 v71, v71, v41
Mvva 168,216,72
Vm 72,72,41
Vm 73,73,41
Vc 2,66,67
v_lshlrev_b32_e64 v66, 16, v2
v_and_b32 v67, 0xffff0000, v2
Mvva 184,200,68
s_waitcnt lgkmcnt(10)
ds_read_b64_tr_b16 v[248:249], v14 offset:12288
ds_read_b64_tr_b16 v[250:251], v14 offset:14336
Vc 3,68,69
Mvva 184,216,76
buffer_load_dwordx4 v114, s[12:15], s50 offen offset:2048 lds
Mvva 172,204,64
s_waitcnt vmcnt(15)
ds_read_b64_tr_b16 v[236:237], v15 offset:8192
ds_read_b64_tr_b16 v[238:239], v15 offset:10240
v_lshlrev_b32_e64 v68, 16, v3
Mvva 172,220,72
s_waitcnt lgkmcnt(10)
v_and_b32 v69, 0xffff0000, v3
Vc 4,70,71
v_lshlrev_b32 v70, 16, v4
v_and_b32 v71, 0xffff0000, v4
Vc 5,72,73
Mvva 188,204,68
s_barrier
ds_read_b64_tr_b16 v[252:253], v15 offset:12288
ds_read_b64_tr_b16 v[254:255], v15 offset:14336
v_lshlrev_b32 v72, 16, v5
Mvva 188,220,76
buffer_load_dwordx4 v114, s[12:15], s51 offen offset:3072 lds
v_add_u32 v114, 131072, v114
Mvva 128,224,64
ds_read_b64_tr_b16 v[192:193], v12 offset:16384
ds_read_b64_tr_b16 v[194:195], v12 offset:18432
v_and_b32 v73, 0xffff0000, v5
Mvva 128,240,72
v_mul_f32 v2, 0xbfb8aa3b, v66
v_mul_f32 v3, 0xbfb8aa3b, v67
v_mul_f32 v4, 0xbfb8aa3b, v68
v_mul_f32 v5, 0xbfb8aa3b, v69
v_mul_f32 v6, 0xbfb8aa3b, v70
Mvva 144,224,68
s_waitcnt lgkmcnt(10)
ds_read_b64_tr_b16 v[208:209], v12 offset:20480
ds_read_b64_tr_b16 v[210:211], v12 offset:22528
v_mul_f32 v7, 0xbfb8aa3b, v71
Mvva 144,240,76
buffer_load_dwordx4 a[112:115], v112, s[8:11], s52 offen offset:0 sc1
Mvva 132,228,64
ds_read_b64_tr_b16 v[196:197], v13 offset:16384
ds_read_b64_tr_b16 v[198:199], v13 offset:18432
v_mul_f32 v8, 0xbfb8aa3b, v72
Mvva 132,244,72
v_mul_f32 v9, 0xbfb8aa3b, v73
Ve 2,2
VE 3,3
Mvva 148,228,68
s_waitcnt lgkmcnt(10)
ds_read_b64_tr_b16 v[212:213], v13 offset:20480
ds_read_b64_tr_b16 v[214:215], v13 offset:22528
Mvva 148,244,76
buffer_load_dwordx4 a[116:119], v112, s[8:11], s52 offen offset:1024 sc1
s_add_u32 s52, s52, 8192
Mvva 136,232,64
ds_read_b64_tr_b16 v[200:201], v14 offset:16384
ds_read_b64_tr_b16 v[202:203], v14 offset:18432
Mvva 136,248,72
Ve 4,4
VE 5,5
Mvva 152,232,68
s_waitcnt lgkmcnt(10)
ds_read_b64_tr_b16 v[216:217], v14 offset:20480
ds_read_b64_tr_b16 v[218:219], v14 offset:22528
Mvva 152,248,76
buffer_load_dwordx4 a[120:123], v112, s[8:11], s52 offen offset:0 sc1
Mvva 140,236,64
ds_read_b64_tr_b16 v[204:205], v15 offset:16384
ds_read_b64_tr_b16 v[206:207], v15 offset:18432
Mvva 140,252,72
Ve 6,6
VE 7,7
Mvva 156,236,68
s_waitcnt lgkmcnt(10)
ds_read_b64_tr_b16 v[220:221], v15 offset:20480
ds_read_b64_tr_b16 v[222:223], v15 offset:22528
Mvva 156,252,76
buffer_load_dwordx4 a[124:127], v112, s[8:11], s52 offen offset:1024 sc1
s_add_u32 s52, s52, 8192
s_waitcnt vmcnt(16)
Mvva 160,192,80
ds_read_b64_tr_b16 v[224:225], v12 offset:24576
ds_read_b64_tr_b16 v[226:227], v12 offset:26624
Mvva 160,208,88
Ve 8,8
Ve 9,9
v_add_f32_e64 v2, 1.0, v2
Mvva 176,192,84
s_waitcnt lgkmcnt(10)
s_add_u32 m0, s44, 0
ds_read_b64_tr_b16 v[240:241], v12 offset:28672
ds_read_b64_tr_b16 v[242:243], v12 offset:30720
v_add_f32_e64 v3, 1.0, v3
Mvva 176,208,92
buffer_load_dwordx4 v114, s[12:15], s48 offen offset:0 lds
Mvva 164,196,80
ds_read_b64_tr_b16 v[228:229], v13 offset:24576
ds_read_b64_tr_b16 v[230:231], v13 offset:26624
v_add_f32_e64 v4, 1.0, v4
Mvva 164,212,88
v_add_f32 v5, 1.0, v5
v_add_f32 v6, 1.0, v6
v_add_f32 v7, 1.0, v7
v_add_f32 v8, 1.0, v8
v_add_f32_e64 v9, 1.0, v9
Mvva 180,196,84
s_waitcnt lgkmcnt(10)
ds_read_b64_tr_b16 v[244:245], v13 offset:28672
ds_read_b64_tr_b16 v[246:247], v13 offset:30720
Mvva 180,212,92
buffer_load_dwordx4 v114, s[12:15], s49 offen offset:1024 lds
Mvva 168,200,80
ds_read_b64_tr_b16 v[232:233], v14 offset:24576
ds_read_b64_tr_b16 v[234:235], v14 offset:26624
Mvva 168,216,88
v_rcp_f32 v2, v2
v_rcp_f32_e64 v3, v3
Mvva 184,200,84
s_waitcnt lgkmcnt(10)
ds_read_b64_tr_b16 v[248:249], v14 offset:28672
ds_read_b64_tr_b16 v[250:251], v14 offset:30720
Mvva 184,216,92
buffer_load_dwordx4 v114, s[12:15], s50 offen offset:2048 lds
Mvva 172,204,80
s_waitcnt vmcnt(15)
ds_read_b64_tr_b16 v[236:237], v15 offset:24576
ds_read_b64_tr_b16 v[238:239], v15 offset:26624
Mvva 172,220,88
s_waitcnt lgkmcnt(10)
v_rcp_f32 v4, v4
v_rcp_f32_e64 v5, v5
Mvva 188,204,84
s_barrier
ds_read_b64_tr_b16 v[252:253], v15 offset:28672
ds_read_b64_tr_b16 v[254:255], v15 offset:30720
Mvva 188,220,92
buffer_load_dwordx4 v114, s[12:15], s51 offen offset:3072 lds
v_add_u32 v114, 131072, v114
Mvva 128,224,80
ds_read_b64_tr_b16 v[192:193], v12 offset:32768
ds_read_b64_tr_b16 v[194:195], v12 offset:34816
Mvva 128,240,88
v_rcp_f32 v6, v6
v_rcp_f32_e64 v7, v7
Mvva 144,224,84
s_waitcnt lgkmcnt(10)
ds_read_b64_tr_b16 v[208:209], v12 offset:36864
ds_read_b64_tr_b16 v[210:211], v12 offset:38912
Mvva 144,240,92
buffer_load_dwordx4 a[128:131], v112, s[8:11], s52 offen offset:0 sc1
Mvva 132,228,80
ds_read_b64_tr_b16 v[196:197], v13 offset:32768
ds_read_b64_tr_b16 v[198:199], v13 offset:34816
Mvva 132,244,88
v_rcp_f32 v8, v8
v_rcp_f32 v9, v9
Vm 66,66,2
Mvva 148,228,84
s_waitcnt lgkmcnt(10)
ds_read_b64_tr_b16 v[212:213], v13 offset:36864
ds_read_b64_tr_b16 v[214:215], v13 offset:38912
Vm 67,67,3
Mvva 148,244,92
buffer_load_dwordx4 a[132:135], v112, s[8:11], s52 offen offset:1024 sc1
s_add_u32 s52, s52, 8192
Mvva 136,232,80
ds_read_b64_tr_b16 v[200:201], v14 offset:32768
ds_read_b64_tr_b16 v[202:203], v14 offset:34816
v_mul_f32_e64 v68, v68, v4
Mvva 136,248,88
Vm 69,69,5
Vm 70,70,6
Vm 71,71,7
Vm 72,72,8
v_mul_f32_e64 v73, v73, v9
Mvva 152,232,84
s_waitcnt lgkmcnt(10)
ds_read_b64_tr_b16 v[216:217], v14 offset:36864
ds_read_b64_tr_b16 v[218:219], v14 offset:38912
Vc 2,66,67
Mvva 152,248,92
buffer_load_dwordx4 a[136:139], v112, s[8:11], s52 offen offset:0 sc1
Mvva 140,236,80
ds_read_b64_tr_b16 v[204:205], v15 offset:32768
ds_read_b64_tr_b16 v[206:207], v15 offset:34816
v_lshlrev_b32 v66, 16, v2
Mvva 140,252,88
v_and_b32 v67, 0xffff0000, v2
Vc 3,68,69
v_lshlrev_b32_e64 v68, 16, v3
v_and_b32 v69, 0xffff0000, v3
Vc 4,70,71
Mvva 156,236,84
s_waitcnt lgkmcnt(10)
ds_read_b64_tr_b16 v[220:221], v15 offset:36864
ds_read_b64_tr_b16 v[222:223], v15 offset:38912
v_lshlrev_b32 v70, 16, v4
Mvva 156,252,92
buffer_load_dwordx4 a[140:143], v112, s[8:11], s52 offen offset:1024 sc1
s_add_u32 s52, s52, 8192
s_waitcnt vmcnt(16)
Mvva 160,192,96
ds_read_b64_tr_b16 v[224:225], v12 offset:40960
ds_read_b64_tr_b16 v[226:227], v12 offset:43008
v_and_b32 v71, 0xffff0000, v4
Mvva 160,208,104
Vc 5,72,73
v_lshlrev_b32 v72, 16, v5
v_and_b32 v73, 0xffff0000, v5
Mvva 176,192,100
s_waitcnt lgkmcnt(10)
s_add_u32 m0, s44, 16384
ds_read_b64_tr_b16 v[240:241], v12 offset:45056
ds_read_b64_tr_b16 v[242:243], v12 offset:47104
Mvva 176,208,108
buffer_load_dwordx4 v114, s[12:15], s48 offen offset:0 lds
Mvva 164,196,96
ds_read_b64_tr_b16 v[228:229], v13 offset:40960
ds_read_b64_tr_b16 v[230:231], v13 offset:43008
Mvva 164,212,104
Mvva 180,196,100
s_waitcnt lgkmcnt(10)
ds_read_b64_tr_b16 v[244:245], v13 offset:45056
ds_read_b64_tr_b16 v[246:247], v13 offset:47104
Mvva 180,212,108
buffer_load_dwordx4 v114, s[12:15], s49 offen offset:1024 lds
Mvva 168,200,96
ds_read_b64_tr_b16 v[232:233], v14 offset:40960
ds_read_b64_tr_b16 v[234:235], v14 offset:43008
Mvva 168,216,104
Mvva 184,200,100
s_waitcnt lgkmcnt(10)
ds_read_b64_tr_b16 v[248:249], v14 offset:45056
ds_read_b64_tr_b16 v[250:251], v14 offset:47104
Mvva 184,216,108
buffer_load_dwordx4 v114, s[12:15], s50 offen offset:2048 lds
Mvva 172,204,96
s_waitcnt vmcnt(15)
ds_read_b64_tr_b16 v[236:237], v15 offset:40960
ds_read_b64_tr_b16 v[238:239], v15 offset:43008
Mvva 172,220,104
s_waitcnt lgkmcnt(10)
s_cmp_lt_u32 s93, 224
s_cbranch_scc1 L_f2B
L_f2Br:
Mvva 188,204,100
s_barrier
ds_read_b64_tr_b16 v[252:253], v15 offset:45056
ds_read_b64_tr_b16 v[254:255], v15 offset:47104
Mvva 188,220,108
buffer_load_dwordx4 v114, s[12:15], s51 offen offset:3072 lds
v_add_u32 v114, 131072, v114
Mvva 128,224,96
ds_read_b64_tr_b16 v[192:193], v12 offset:49152
ds_read_b64_tr_b16 v[194:195], v12 offset:51200
Mvva 128,240,104
Mvva 144,224,100
s_waitcnt lgkmcnt(10)
ds_read_b64_tr_b16 v[208:209], v12 offset:53248
ds_read_b64_tr_b16 v[210:211], v12 offset:55296
Mvva 144,240,108
buffer_load_dwordx4 a[144:147], v112, s[8:11], s52 offen offset:0 sc1
Mvva 132,228,96
ds_read_b64_tr_b16 v[196:197], v13 offset:49152
ds_read_b64_tr_b16 v[198:199], v13 offset:51200
Mvva 132,244,104
Mvva 148,228,100
s_waitcnt lgkmcnt(10)
ds_read_b64_tr_b16 v[212:213], v13 offset:53248
ds_read_b64_tr_b16 v[214:215], v13 offset:55296
Mvva 148,244,108
buffer_load_dwordx4 a[148:151], v112, s[8:11], s52 offen offset:1024 sc1
s_add_u32 s52, s52, 8192
Mvva 136,232,96
ds_read_b64_tr_b16 v[200:201], v14 offset:49152
ds_read_b64_tr_b16 v[202:203], v14 offset:51200
Mvva 136,248,104
Mvva 152,232,100
s_waitcnt lgkmcnt(10)
ds_read_b64_tr_b16 v[216:217], v14 offset:53248
ds_read_b64_tr_b16 v[218:219], v14 offset:55296
Mvva 152,248,108
buffer_load_dwordx4 a[152:155], v112, s[8:11], s52 offen offset:0 sc1
Mvva 140,236,96
ds_read_b64_tr_b16 v[204:205], v15 offset:49152
ds_read_b64_tr_b16 v[206:207], v15 offset:51200
Mvva 140,252,104
Mvva 156,236,100
s_waitcnt lgkmcnt(10)
ds_read_b64_tr_b16 v[220:221], v15 offset:53248
ds_read_b64_tr_b16 v[222:223], v15 offset:55296
Mvva 156,252,108
buffer_load_dwordx4 a[156:159], v112, s[8:11], s52 offen offset:1024 sc1
s_add_u32 s52, s52, 8192
s_waitcnt vmcnt(16)
Mvva 160,192,112
ds_read_b64_tr_b16 v[224:225], v12 offset:57344
ds_read_b64_tr_b16 v[226:227], v12 offset:59392
Mvva 160,208,120
Mvva 176,192,116
s_waitcnt lgkmcnt(10)
s_add_u32 m0, s44, 32768
ds_read_b64_tr_b16 v[240:241], v12 offset:61440
ds_read_b64_tr_b16 v[242:243], v12 offset:63488
Mvva 176,208,124
buffer_load_dwordx4 v114, s[12:15], s48 offen offset:0 lds
Mvva 164,196,112
ds_read_b64_tr_b16 v[228:229], v13 offset:57344
ds_read_b64_tr_b16 v[230:231], v13 offset:59392
Mvva 164,212,120
Mvva 180,196,116
s_waitcnt lgkmcnt(10)
ds_read_b64_tr_b16 v[244:245], v13 offset:61440
ds_read_b64_tr_b16 v[246:247], v13 offset:63488
Mvva 180,212,124
buffer_load_dwordx4 v114, s[12:15], s49 offen offset:1024 lds
Mvva 168,200,112
ds_read_b64_tr_b16 v[232:233], v14 offset:57344
ds_read_b64_tr_b16 v[234:235], v14 offset:59392
Mvva 168,216,120
Mvva 184,200,116
s_waitcnt lgkmcnt(10)
ds_read_b64_tr_b16 v[248:249], v14 offset:61440
ds_read_b64_tr_b16 v[250:251], v14 offset:63488
Mvva 184,216,124
buffer_load_dwordx4 v114, s[12:15], s50 offen offset:2048 lds
Mvva 172,204,112
s_waitcnt vmcnt(15)
ds_read_b64_tr_b16 v[236:237], v15 offset:57344
ds_read_b64_tr_b16 v[238:239], v15 offset:59392
Mvva 172,220,120
s_waitcnt lgkmcnt(10)
Mvva 188,204,116
s_barrier
ds_read_b64_tr_b16 v[252:253], v15 offset:61440
ds_read_b64_tr_b16 v[254:255], v15 offset:63488
Mvva 188,220,124
buffer_load_dwordx4 v114, s[12:15], s51 offen offset:3072 lds
v_add_u32 v114, 131072, v114
Mvva 128,224,112
ds_read_b64_tr_b16 v[192:193], v115 offset:0
ds_read_b64_tr_b16 v[194:195], v115 offset:2048
Mvva 128,240,120
Mvva 144,224,116
s_waitcnt lgkmcnt(10)
ds_read_b64_tr_b16 v[208:209], v115 offset:4096
ds_read_b64_tr_b16 v[210:211], v115 offset:6144
Mvva 144,240,124
buffer_load_dwordx4 a[160:163], v112, s[8:11], s52 offen offset:0 sc1
Mvva 132,228,112
ds_read_b64_tr_b16 v[196:197], v116 offset:0
ds_read_b64_tr_b16 v[198:199], v116 offset:2048
Mvva 132,244,120
Mvva 148,228,116
s_waitcnt lgkmcnt(10)
ds_read_b64_tr_b16 v[212:213], v116 offset:4096
ds_read_b64_tr_b16 v[214:215], v116 offset:6144
Mvva 148,244,124
buffer_load_dwordx4 a[164:167], v112, s[8:11], s52 offen offset:1024 sc1
s_add_u32 s52, s52, 8192
Mvva 136,232,112
ds_read_b64_tr_b16 v[200:201], v117 offset:0
ds_read_b64_tr_b16 v[202:203], v117 offset:2048
Mvva 136,248,120
Mvva 152,232,116
s_waitcnt lgkmcnt(10)
ds_read_b64_tr_b16 v[216:217], v117 offset:4096
ds_read_b64_tr_b16 v[218:219], v117 offset:6144
Mvva 152,248,124
buffer_load_dwordx4 a[168:171], v112, s[8:11], s52 offen offset:0 sc1
Mvva 140,236,112
ds_read_b64_tr_b16 v[204:205], v118 offset:0
ds_read_b64_tr_b16 v[206:207], v118 offset:2048
Mvva 140,252,120
Mvva 156,236,116
s_waitcnt lgkmcnt(10)
ds_read_b64_tr_b16 v[220:221], v118 offset:4096
ds_read_b64_tr_b16 v[222:223], v118 offset:6144
Mvva 156,252,124
buffer_load_dwordx4 a[172:175], v112, s[8:11], s52 offen offset:1024 sc1
s_add_u32 s52, s52, 8192
s_waitcnt vmcnt(16)
Mvva 160,192,128
ds_read_b64_tr_b16 v[224:225], v115 offset:8192
ds_read_b64_tr_b16 v[226:227], v115 offset:10240
Mvva 160,208,136
Mvva 176,192,132
s_waitcnt lgkmcnt(10)
s_add_u32 m0, s44, 49152
ds_read_b64_tr_b16 v[240:241], v115 offset:12288
ds_read_b64_tr_b16 v[242:243], v115 offset:14336
Mvva 176,208,140
buffer_load_dwordx4 v114, s[12:15], s48 offen offset:0 lds
Mvva 164,196,128
ds_read_b64_tr_b16 v[228:229], v116 offset:8192
ds_read_b64_tr_b16 v[230:231], v116 offset:10240
Mvva 164,212,136
Mvva 180,196,132
s_waitcnt lgkmcnt(10)
ds_read_b64_tr_b16 v[244:245], v116 offset:12288
ds_read_b64_tr_b16 v[246:247], v116 offset:14336
Mvva 180,212,140
buffer_load_dwordx4 v114, s[12:15], s49 offen offset:1024 lds
Mvva 168,200,128
ds_read_b64_tr_b16 v[232:233], v117 offset:8192
ds_read_b64_tr_b16 v[234:235], v117 offset:10240
Mvva 168,216,136
Mvva 184,200,132
s_waitcnt lgkmcnt(10)
ds_read_b64_tr_b16 v[248:249], v117 offset:12288
ds_read_b64_tr_b16 v[250:251], v117 offset:14336
Mvva 184,216,140
buffer_load_dwordx4 v114, s[12:15], s50 offen offset:2048 lds
Mvva 172,204,128
s_waitcnt vmcnt(15)
ds_read_b64_tr_b16 v[236:237], v118 offset:8192
ds_read_b64_tr_b16 v[238:239], v118 offset:10240
Mvva 172,220,136
s_waitcnt lgkmcnt(10)
Mvva 188,204,132
s_barrier
ds_read_b64_tr_b16 v[252:253], v118 offset:12288
ds_read_b64_tr_b16 v[254:255], v118 offset:14336
Mvva 188,220,140
buffer_load_dwordx4 v114, s[12:15], s51 offen offset:3072 lds
v_add_u32 v114, 131072, v114
Mvva 128,224,128
ds_read_b64_tr_b16 v[192:193], v115 offset:16384
ds_read_b64_tr_b16 v[194:195], v115 offset:18432
Mvva 128,240,136
Mvva 144,224,132
s_waitcnt lgkmcnt(10)
ds_read_b64_tr_b16 v[208:209], v115 offset:20480
ds_read_b64_tr_b16 v[210:211], v115 offset:22528
Mvva 144,240,140
buffer_load_dwordx4 a[176:179], v112, s[8:11], s52 offen offset:0 sc1
Mvva 132,228,128
ds_read_b64_tr_b16 v[196:197], v116 offset:16384
ds_read_b64_tr_b16 v[198:199], v116 offset:18432
Mvva 132,244,136
Mvva 148,228,132
s_waitcnt lgkmcnt(10)
ds_read_b64_tr_b16 v[212:213], v116 offset:20480
ds_read_b64_tr_b16 v[214:215], v116 offset:22528
Mvva 148,244,140
buffer_load_dwordx4 a[180:183], v112, s[8:11], s52 offen offset:1024 sc1
s_add_u32 s52, s52, 8192
Mvva 136,232,128
ds_read_b64_tr_b16 v[200:201], v117 offset:16384
ds_read_b64_tr_b16 v[202:203], v117 offset:18432
Mvva 136,248,136
Mvva 152,232,132
s_waitcnt lgkmcnt(10)
ds_read_b64_tr_b16 v[216:217], v117 offset:20480
ds_read_b64_tr_b16 v[218:219], v117 offset:22528
Mvva 152,248,140
buffer_load_dwordx4 a[184:187], v112, s[8:11], s52 offen offset:0 sc1
Mvva 140,236,128
ds_read_b64_tr_b16 v[204:205], v118 offset:16384
ds_read_b64_tr_b16 v[206:207], v118 offset:18432
Mvva 140,252,136
s_cmp_lt_u32 s93, 224
s_cbranch_scc1 L_f2C
L_f2Cr:
Mvva 156,236,132
s_waitcnt lgkmcnt(10)
ds_read_b64_tr_b16 v[220:221], v118 offset:20480
ds_read_b64_tr_b16 v[222:223], v118 offset:22528
Mvva 156,252,140
buffer_load_dwordx4 a[188:191], v112, s[8:11], s52 offen offset:1024 sc1
s_add_u32 s52, s52, 8192
s_waitcnt vmcnt(16)
Mvva 160,192,144
ds_read_b64_tr_b16 v[224:225], v115 offset:24576
ds_read_b64_tr_b16 v[226:227], v115 offset:26624
Mvva 160,208,152
Mvva 176,192,148
s_waitcnt lgkmcnt(10)
s_add_u32 m0, s44, 65536
ds_read_b64_tr_b16 v[240:241], v115 offset:28672
ds_read_b64_tr_b16 v[242:243], v115 offset:30720
Mvva 176,208,156
buffer_load_dwordx4 v114, s[12:15], s48 offen offset:0 lds
Mvva 164,196,144
ds_read_b64_tr_b16 v[228:229], v116 offset:24576
ds_read_b64_tr_b16 v[230:231], v116 offset:26624
Mvva 164,212,152
Mvva 180,196,148
s_waitcnt lgkmcnt(10)
ds_read_b64_tr_b16 v[244:245], v116 offset:28672
ds_read_b64_tr_b16 v[246:247], v116 offset:30720
Mvva 180,212,156
buffer_load_dwordx4 v114, s[12:15], s49 offen offset:1024 lds
Mvva 168,200,144
ds_read_b64_tr_b16 v[232:233], v117 offset:24576
ds_read_b64_tr_b16 v[234:235], v117 offset:26624
Mvva 168,216,152
Mvva 184,200,148
s_waitcnt lgkmcnt(10)
ds_read_b64_tr_b16 v[248:249], v117 offset:28672
ds_read_b64_tr_b16 v[250:251], v117 offset:30720
Mvva 184,216,156
buffer_load_dwordx4 v114, s[12:15], s50 offen offset:2048 lds
Mvva 172,204,144
s_waitcnt vmcnt(15)
ds_read_b64_tr_b16 v[236:237], v118 offset:24576
ds_read_b64_tr_b16 v[238:239], v118 offset:26624
Mvva 172,220,152
s_waitcnt lgkmcnt(10)
Mvva 188,204,148
s_barrier
ds_read_b64_tr_b16 v[252:253], v118 offset:28672
ds_read_b64_tr_b16 v[254:255], v118 offset:30720
Mvva 188,220,156
buffer_load_dwordx4 v114, s[12:15], s51 offen offset:3072 lds
v_add_u32 v114, 131072, v114
Mvva 128,224,144
ds_read_b64_tr_b16 v[192:193], v115 offset:32768
ds_read_b64_tr_b16 v[194:195], v115 offset:34816
Mvva 128,240,152
s_cmp_ge_u32 s2, 128
s_cbranch_scc1 L_c31
L_c31r:
Mvva 144,224,148
s_waitcnt lgkmcnt(10)
ds_read_b64_tr_b16 v[208:209], v115 offset:36864
ds_read_b64_tr_b16 v[210:211], v115 offset:38912
Mvva 144,240,156
buffer_load_dwordx4 a[192:195], v112, s[8:11], s52 offen offset:0 sc1
Mvva 132,228,144
ds_read_b64_tr_b16 v[196:197], v116 offset:32768
ds_read_b64_tr_b16 v[198:199], v116 offset:34816
Mvva 132,244,152
Mvva 148,228,148
s_waitcnt lgkmcnt(10)
ds_read_b64_tr_b16 v[212:213], v116 offset:36864
ds_read_b64_tr_b16 v[214:215], v116 offset:38912
Mvva 148,244,156
buffer_load_dwordx4 a[196:199], v112, s[8:11], s52 offen offset:1024 sc1
s_add_u32 s52, s52, 8192
Mvva 136,232,144
ds_read_b64_tr_b16 v[200:201], v117 offset:32768
ds_read_b64_tr_b16 v[202:203], v117 offset:34816
Mvva 136,248,152
Mvva 152,232,148
s_waitcnt lgkmcnt(10)
ds_read_b64_tr_b16 v[216:217], v117 offset:36864
ds_read_b64_tr_b16 v[218:219], v117 offset:38912
Mvva 152,248,156
buffer_load_dwordx4 a[200:203], v112, s[8:11], s52 offen offset:0 sc1
Mvva 140,236,144
ds_read_b64_tr_b16 v[204:205], v118 offset:32768
ds_read_b64_tr_b16 v[206:207], v118 offset:34816
Mvva 140,252,152
Mvva 156,236,148
s_waitcnt lgkmcnt(10)
ds_read_b64_tr_b16 v[220:221], v118 offset:36864
ds_read_b64_tr_b16 v[222:223], v118 offset:38912
Mvva 156,252,156
buffer_load_dwordx4 a[204:207], v112, s[8:11], s52 offen offset:1024 sc1
s_add_u32 s52, s52, 8192
s_waitcnt vmcnt(16)
Mvva 160,192,160
ds_read_b64_tr_b16 v[224:225], v115 offset:40960
ds_read_b64_tr_b16 v[226:227], v115 offset:43008
Mvva 160,208,168
Mvva 176,192,164
s_waitcnt lgkmcnt(10)
s_add_u32 m0, s44, 81920
ds_read_b64_tr_b16 v[240:241], v115 offset:45056
ds_read_b64_tr_b16 v[242:243], v115 offset:47104
Mvva 176,208,172
buffer_load_dwordx4 v114, s[12:15], s48 offen offset:0 lds
Mvva 164,196,160
ds_read_b64_tr_b16 v[228:229], v116 offset:40960
ds_read_b64_tr_b16 v[230:231], v116 offset:43008
Mvva 164,212,168
Mvva 180,196,164
s_waitcnt lgkmcnt(10)
ds_read_b64_tr_b16 v[244:245], v116 offset:45056
ds_read_b64_tr_b16 v[246:247], v116 offset:47104
Mvva 180,212,172
buffer_load_dwordx4 v114, s[12:15], s49 offen offset:1024 lds
Mvva 168,200,160
ds_read_b64_tr_b16 v[232:233], v117 offset:40960
ds_read_b64_tr_b16 v[234:235], v117 offset:43008
Mvva 168,216,168
Mvva 184,200,164
s_waitcnt lgkmcnt(10)
ds_read_b64_tr_b16 v[248:249], v117 offset:45056
ds_read_b64_tr_b16 v[250:251], v117 offset:47104
Mvva 184,216,172
buffer_load_dwordx4 v114, s[12:15], s50 offen offset:2048 lds
Mvva 172,204,160
s_waitcnt vmcnt(15)
ds_read_b64_tr_b16 v[236:237], v118 offset:40960
ds_read_b64_tr_b16 v[238:239], v118 offset:43008
Mvva 172,220,168
s_waitcnt lgkmcnt(10)
Mvva 188,204,164
s_barrier
ds_read_b64_tr_b16 v[252:253], v118 offset:45056
ds_read_b64_tr_b16 v[254:255], v118 offset:47104
Mvva 188,220,172
buffer_load_dwordx4 v114, s[12:15], s51 offen offset:3072 lds
v_add_u32 v114, 131072, v114
Mvva 128,224,160
ds_read_b64_tr_b16 v[192:193], v115 offset:49152
ds_read_b64_tr_b16 v[194:195], v115 offset:51200
Mvva 128,240,168
Mvva 144,224,164
s_waitcnt lgkmcnt(10)
ds_read_b64_tr_b16 v[208:209], v115 offset:53248
ds_read_b64_tr_b16 v[210:211], v115 offset:55296
Mvva 144,240,172
buffer_load_dwordx4 a[208:211], v112, s[8:11], s52 offen offset:0 sc1
Mvva 132,228,160
ds_read_b64_tr_b16 v[196:197], v116 offset:49152
ds_read_b64_tr_b16 v[198:199], v116 offset:51200
Mvva 132,244,168
Mvva 148,228,164
s_waitcnt lgkmcnt(10)
ds_read_b64_tr_b16 v[212:213], v116 offset:53248
ds_read_b64_tr_b16 v[214:215], v116 offset:55296
Mvva 148,244,172
buffer_load_dwordx4 a[212:215], v112, s[8:11], s52 offen offset:1024 sc1
s_add_u32 s52, s52, 8192
Mvva 136,232,160
ds_read_b64_tr_b16 v[200:201], v117 offset:49152
ds_read_b64_tr_b16 v[202:203], v117 offset:51200
Mvva 136,248,168
Mvva 152,232,164
s_waitcnt lgkmcnt(10)
ds_read_b64_tr_b16 v[216:217], v117 offset:53248
ds_read_b64_tr_b16 v[218:219], v117 offset:55296
Mvva 152,248,172
buffer_load_dwordx4 a[216:219], v112, s[8:11], s52 offen offset:0 sc1
Mvva 140,236,160
ds_read_b64_tr_b16 v[204:205], v118 offset:49152
ds_read_b64_tr_b16 v[206:207], v118 offset:51200
Mvva 140,252,168
Mvva 156,236,164
s_waitcnt lgkmcnt(10)
ds_read_b64_tr_b16 v[220:221], v118 offset:53248
ds_read_b64_tr_b16 v[222:223], v118 offset:55296
Mvva 156,252,172
buffer_load_dwordx4 a[220:223], v112, s[8:11], s52 offen offset:1024 sc1
s_add_u32 s52, s52, 8192
s_waitcnt vmcnt(16)
Mvva 160,192,176
ds_read_b64_tr_b16 v[224:225], v115 offset:57344
ds_read_b64_tr_b16 v[226:227], v115 offset:59392
Mvva 160,208,184
Mvva 176,192,180
s_waitcnt lgkmcnt(10)
s_add_u32 m0, s44, 98304
ds_read_b64_tr_b16 v[240:241], v115 offset:61440
ds_read_b64_tr_b16 v[242:243], v115 offset:63488
Mvva 176,208,188
buffer_load_dwordx4 v114, s[12:15], s48 offen offset:0 lds
Mvva 164,196,176
ds_read_b64_tr_b16 v[228:229], v116 offset:57344
ds_read_b64_tr_b16 v[230:231], v116 offset:59392
Mvva 164,212,184
Mvva 180,196,180
s_waitcnt lgkmcnt(10)
ds_read_b64_tr_b16 v[244:245], v116 offset:61440
ds_read_b64_tr_b16 v[246:247], v116 offset:63488
Mvva 180,212,188
buffer_load_dwordx4 v114, s[12:15], s49 offen offset:1024 lds
Mvva 168,200,176
ds_read_b64_tr_b16 v[232:233], v117 offset:57344
ds_read_b64_tr_b16 v[234:235], v117 offset:59392
Mvva 168,216,184
s_cmp_lt_u32 s93, 224
s_cbranch_scc1 L_f2E
L_f2Er:
Mvva 184,200,180
s_waitcnt lgkmcnt(10)
ds_read_b64_tr_b16 v[248:249], v117 offset:61440
ds_read_b64_tr_b16 v[250:251], v117 offset:63488
Mvva 184,216,188
buffer_load_dwordx4 v114, s[12:15], s50 offen offset:2048 lds
Mvva 172,204,176
s_waitcnt vmcnt(15)
ds_read_b64_tr_b16 v[236:237], v118 offset:57344
ds_read_b64_tr_b16 v[238:239], v118 offset:59392
Mvva 172,220,184
s_waitcnt lgkmcnt(10)
Mvva 188,204,180
s_barrier
ds_read_b64_tr_b16 v[252:253], v118 offset:61440
ds_read_b64_tr_b16 v[254:255], v118 offset:63488
Mvva 188,220,188
buffer_load_dwordx4 v114, s[12:15], s51 offen offset:3072 lds
v_add_u32 v114, 131072, v114
Mvva 128,224,176
ds_read_b64_tr_b16 v[192:193], v12 offset:0
ds_read_b64_tr_b16 v[194:195], v12 offset:2048
Mvva 128,240,184
Mvva 144,224,180
s_waitcnt lgkmcnt(10)
ds_read_b64_tr_b16 v[208:209], v12 offset:4096
ds_read_b64_tr_b16 v[210:211], v12 offset:6144
Mvva 144,240,188
buffer_load_dwordx4 a[224:227], v112, s[8:11], s52 offen offset:0 sc1
Mvva 132,228,176
ds_read_b64_tr_b16 v[196:197], v13 offset:0
ds_read_b64_tr_b16 v[198:199], v13 offset:2048
Mvva 132,244,184
Mvva 148,228,180
s_waitcnt lgkmcnt(10)
ds_read_b64_tr_b16 v[212:213], v13 offset:4096
ds_read_b64_tr_b16 v[214:215], v13 offset:6144
Mvva 148,244,188
buffer_load_dwordx4 a[228:231], v112, s[8:11], s52 offen offset:1024 sc1
s_add_u32 s52, s52, 8192
Mvva 136,232,176
ds_read_b64_tr_b16 v[200:201], v14 offset:0
ds_read_b64_tr_b16 v[202:203], v14 offset:2048
Mvva 136,248,184
Mvva 152,232,180
s_waitcnt lgkmcnt(10)
ds_read_b64_tr_b16 v[216:217], v14 offset:4096
ds_read_b64_tr_b16 v[218:219], v14 offset:6144
Mvva 152,248,188
buffer_load_dwordx4 a[232:235], v112, s[8:11], s52 offen offset:0 sc1
Mvva 140,236,176
ds_read_b64_tr_b16 v[204:205], v15 offset:0
ds_read_b64_tr_b16 v[206:207], v15 offset:2048
Mvva 140,252,184
Mvva 156,236,180
s_waitcnt lgkmcnt(10)
ds_read_b64_tr_b16 v[220:221], v15 offset:4096
ds_read_b64_tr_b16 v[222:223], v15 offset:6144
Mvva 156,252,188
buffer_load_dwordx4 a[236:239], v112, s[8:11], s52 offen offset:1024 sc1
s_add_u32 s52, s52, 8192
s_waitcnt vmcnt(16)
Mvva 160,192,192
ds_read_b64_tr_b16 v[224:225], v12 offset:8192
ds_read_b64_tr_b16 v[226:227], v12 offset:10240
Mvva 160,208,200
Mvva 176,192,196
s_waitcnt lgkmcnt(10)
s_add_u32 m0, s44, 114688
ds_read_b64_tr_b16 v[240:241], v12 offset:12288
ds_read_b64_tr_b16 v[242:243], v12 offset:14336
Mvva 176,208,204
buffer_load_dwordx4 v114, s[12:15], s48 offen offset:0 lds
Mvva 164,196,192
ds_read_b64_tr_b16 v[228:229], v13 offset:8192
ds_read_b64_tr_b16 v[230:231], v13 offset:10240
Mvva 164,212,200
Mvva 180,196,196
s_waitcnt lgkmcnt(10)
ds_read_b64_tr_b16 v[244:245], v13 offset:12288
ds_read_b64_tr_b16 v[246:247], v13 offset:14336
Mvva 180,212,204
buffer_load_dwordx4 v114, s[12:15], s49 offen offset:1024 lds
Mvva 168,200,192
ds_read_b64_tr_b16 v[232:233], v14 offset:8192
ds_read_b64_tr_b16 v[234:235], v14 offset:10240
Mvva 168,216,200
Mvva 184,200,196
s_waitcnt lgkmcnt(10)
ds_read_b64_tr_b16 v[248:249], v14 offset:12288
ds_read_b64_tr_b16 v[250:251], v14 offset:14336
Mvva 184,216,204
buffer_load_dwordx4 v114, s[12:15], s50 offen offset:2048 lds
Mvva 172,204,192
s_waitcnt vmcnt(15)
ds_read_b64_tr_b16 v[236:237], v15 offset:8192
ds_read_b64_tr_b16 v[238:239], v15 offset:10240
Mvva 172,220,200
s_waitcnt lgkmcnt(10)
Mvva 188,204,196
s_barrier
ds_read_b64_tr_b16 v[252:253], v15 offset:12288
ds_read_b64_tr_b16 v[254:255], v15 offset:14336
Mvva 188,220,204
buffer_load_dwordx4 v114, s[12:15], s51 offen offset:3072 lds
v_add_u32_e64 v114, s95, v113
Mvva 128,224,192
ds_read_b64_tr_b16 v[192:193], v12 offset:16384
ds_read_b64_tr_b16 v[194:195], v12 offset:18432
Mvva 128,240,200
Mvva 144,224,196
s_waitcnt lgkmcnt(10)
ds_read_b64_tr_b16 v[208:209], v12 offset:20480
ds_read_b64_tr_b16 v[210:211], v12 offset:22528
Mvva 144,240,204
buffer_load_dwordx4 a[240:243], v112, s[8:11], s52 offen offset:0 sc1
Mvva 132,228,192
ds_read_b64_tr_b16 v[196:197], v13 offset:16384
ds_read_b64_tr_b16 v[198:199], v13 offset:18432
Mvva 132,244,200
Mvva 148,228,196
s_waitcnt lgkmcnt(10)
ds_read_b64_tr_b16 v[212:213], v13 offset:20480
ds_read_b64_tr_b16 v[214:215], v13 offset:22528
Mvva 148,244,204
buffer_load_dwordx4 a[244:247], v112, s[8:11], s52 offen offset:1024 sc1
s_add_u32 s52, s52, 8192
Mvva 136,232,192
ds_read_b64_tr_b16 v[200:201], v14 offset:16384
ds_read_b64_tr_b16 v[202:203], v14 offset:18432
Mvva 136,248,200
Mvva 152,232,196
s_waitcnt lgkmcnt(10)
ds_read_b64_tr_b16 v[216:217], v14 offset:20480
ds_read_b64_tr_b16 v[218:219], v14 offset:22528
Mvva 152,248,204
buffer_load_dwordx4 a[248:251], v112, s[8:11], s52 offen offset:0 sc1
Mvva 140,236,192
ds_read_b64_tr_b16 v[204:205], v15 offset:16384
ds_read_b64_tr_b16 v[206:207], v15 offset:18432
Mvva 140,252,200
Mvva 156,236,196
s_waitcnt lgkmcnt(10)
ds_read_b64_tr_b16 v[220:221], v15 offset:20480
ds_read_b64_tr_b16 v[222:223], v15 offset:22528
Mvva 156,252,204
buffer_load_dwordx4 a[252:255], v112, s[8:11], s52 offen offset:1024 sc1
s_add_u32 s52, s52, 8192
s_waitcnt vmcnt(16)
Mvva 160,192,208
s_add_u32 m0, s44, 0
ds_read_b64_tr_b16 v[224:225], v12 offset:24576
ds_read_b64_tr_b16 v[226:227], v12 offset:26624
Mvva 160,208,216
buffer_load_dwordx4 v114, s[12:15], s48 offen offset:0 lds
Mvva 176,192,212
s_waitcnt lgkmcnt(10)
ds_read_b64_tr_b16 v[240:241], v12 offset:28672
ds_read_b64_tr_b16 v[242:243], v12 offset:30720
Mvva 176,208,220
Mvva 164,196,208
ds_read_b64_tr_b16 v[228:229], v13 offset:24576
ds_read_b64_tr_b16 v[230:231], v13 offset:26624
Mvva 164,212,216
buffer_load_dwordx4 v114, s[12:15], s49 offen offset:1024 lds
Mvva 180,196,212
s_waitcnt lgkmcnt(10)
ds_read_b64_tr_b16 v[244:245], v13 offset:28672
ds_read_b64_tr_b16 v[246:247], v13 offset:30720
Mvva 180,212,220
buffer_load_dwordx4 v114, s[12:15], s50 offen offset:2048 lds
Mvva 168,200,208
ds_read_b64_tr_b16 v[232:233], v14 offset:24576
ds_read_b64_tr_b16 v[234:235], v14 offset:26624
Mvva 168,216,216
buffer_load_dwordx4 v114, s[12:15], s51 offen offset:3072 lds
v_add_u32 v114, 262144, v114
Mvva 184,200,212
s_waitcnt lgkmcnt(10)
ds_read_b64_tr_b16 v[248:249], v14 offset:28672
ds_read_b64_tr_b16 v[250:251], v14 offset:30720
Mvva 184,216,220
Mvva 172,204,208
s_waitcnt vmcnt(16)
ds_read_b64_tr_b16 v[236:237], v15 offset:24576
ds_read_b64_tr_b16 v[238:239], v15 offset:26624
Mvva 172,220,216
s_waitcnt lgkmcnt(10)
buffer_load_dwordx4 a[0:3], v112, s[8:11], s52 offen offset:0 sc1
Mvva 188,204,212
s_barrier
ds_read_b64_tr_b16 v[252:253], v15 offset:28672
ds_read_b64_tr_b16 v[254:255], v15 offset:30720
Mvva 188,220,220
buffer_load_dwordx4 a[4:7], v112, s[8:11], s52 offen offset:1024 sc1
s_add_u32 s52, s52, 8192
Mvva 128,224,208
ds_read_b64_tr_b16 v[192:193], v12 offset:32768
ds_read_b64_tr_b16 v[194:195], v12 offset:34816
Mvva 128,240,216
buffer_load_dwordx4 a[8:11], v112, s[8:11], s52 offen offset:0 sc1
Mvva 144,224,212
s_waitcnt lgkmcnt(10)
ds_read_b64_tr_b16 v[208:209], v12 offset:36864
ds_read_b64_tr_b16 v[210:211], v12 offset:38912
Mvva 144,240,220
Mvva 132,228,208
ds_read_b64_tr_b16 v[196:197], v13 offset:32768
ds_read_b64_tr_b16 v[198:199], v13 offset:34816
Mvva 132,244,216
buffer_load_dwordx4 a[12:15], v112, s[8:11], s52 offen offset:1024 sc1
s_add_u32 s52, s52, 8192
Mvva 148,228,212
s_waitcnt lgkmcnt(10)
ds_read_b64_tr_b16 v[212:213], v13 offset:36864
ds_read_b64_tr_b16 v[214:215], v13 offset:38912
Mvva 148,244,220
buffer_load_dwordx4 a[16:19], v112, s[8:11], s52 offen offset:0 sc1
Mvva 136,232,208
ds_read_b64_tr_b16 v[200:201], v14 offset:32768
ds_read_b64_tr_b16 v[202:203], v14 offset:34816
Mvva 136,248,216
buffer_load_dwordx4 a[20:23], v112, s[8:11], s52 offen offset:1024 sc1
s_add_u32 s52, s52, 8192
Mvva 152,232,212
s_waitcnt lgkmcnt(10)
ds_read_b64_tr_b16 v[216:217], v14 offset:36864
ds_read_b64_tr_b16 v[218:219], v14 offset:38912
Mvva 152,248,220
Mvva 140,236,208
ds_read_b64_tr_b16 v[204:205], v15 offset:32768
ds_read_b64_tr_b16 v[206:207], v15 offset:34816
Mvva 140,252,216
buffer_load_dwordx4 a[24:27], v112, s[8:11], s52 offen offset:0 sc1
Mvva 156,236,212
s_waitcnt lgkmcnt(10)
ds_read_b64_tr_b16 v[220:221], v15 offset:36864
ds_read_b64_tr_b16 v[222:223], v15 offset:38912
Mvva 156,252,220
buffer_load_dwordx4 a[28:31], v112, s[8:11], s52 offen offset:1024 sc1
s_add_u32 s52, s52, 8192
s_waitcnt vmcnt(20)
Mvva 160,192,224
s_add_u32 m0, s44, 16384
ds_read_b64_tr_b16 v[224:225], v12 offset:40960
ds_read_b64_tr_b16 v[226:227], v12 offset:43008
Mvva 160,208,232
buffer_load_dwordx4 v114, s[12:15], s48 offen offset:0 lds
Mvva 176,192,228
s_waitcnt lgkmcnt(10)
ds_read_b64_tr_b16 v[240:241], v12 offset:45056
ds_read_b64_tr_b16 v[242:243], v12 offset:47104
Mvva 176,208,236
Mvva 164,196,224
ds_read_b64_tr_b16 v[228:229], v13 offset:40960
ds_read_b64_tr_b16 v[230:231], v13 offset:43008
Mvva 164,212,232
buffer_load_dwordx4 v114, s[12:15], s49 offen offset:1024 lds
Mvva 180,196,228
s_waitcnt lgkmcnt(10)
ds_read_b64_tr_b16 v[244:245], v13 offset:45056
ds_read_b64_tr_b16 v[246:247], v13 offset:47104
Mvva 180,212,236
buffer_load_dwordx4 v114, s[12:15], s50 offen offset:2048 lds
Mvva 168,200,224
ds_read_b64_tr_b16 v[232:233], v14 offset:40960
ds_read_b64_tr_b16 v[234:235], v14 offset:43008
Mvva 168,216,232
buffer_load_dwordx4 v114, s[12:15], s51 offen offset:3072 lds
v_add_u32 v114, 262144, v114
Mvva 184,200,228
s_waitcnt lgkmcnt(10)
ds_read_b64_tr_b16 v[248:249], v14 offset:45056
ds_read_b64_tr_b16 v[250:251], v14 offset:47104
Mvva 184,216,236
Mvva 172,204,224
s_waitcnt vmcnt(20)
ds_read_b64_tr_b16 v[236:237], v15 offset:40960
ds_read_b64_tr_b16 v[238:239], v15 offset:43008
Mvva 172,220,232
s_waitcnt lgkmcnt(10)
buffer_load_dwordx4 a[32:35], v112, s[8:11], s52 offen offset:0 sc1
Mvva 188,204,228
s_barrier
ds_read_b64_tr_b16 v[252:253], v15 offset:45056
ds_read_b64_tr_b16 v[254:255], v15 offset:47104
Mvva 188,220,236
buffer_load_dwordx4 a[36:39], v112, s[8:11], s52 offen offset:1024 sc1
s_add_u32 s52, s52, 8192
Mvva 128,224,224
ds_read_b64_tr_b16 v[192:193], v12 offset:49152
ds_read_b64_tr_b16 v[194:195], v12 offset:51200
Mvva 128,240,232
buffer_load_dwordx4 a[40:43], v112, s[8:11], s52 offen offset:0 sc1
Mvva 144,224,228
s_waitcnt lgkmcnt(10)
ds_read_b64_tr_b16 v[208:209], v12 offset:53248
ds_read_b64_tr_b16 v[210:211], v12 offset:55296
Mvva 144,240,236
Mvva 132,228,224
ds_read_b64_tr_b16 v[196:197], v13 offset:49152
ds_read_b64_tr_b16 v[198:199], v13 offset:51200
Mvva 132,244,232
buffer_load_dwordx4 a[44:47], v112, s[8:11], s52 offen offset:1024 sc1
s_add_u32 s52, s52, 8192
Mvva 148,228,228
s_waitcnt lgkmcnt(10)
ds_read_b64_tr_b16 v[212:213], v13 offset:53248
ds_read_b64_tr_b16 v[214:215], v13 offset:55296
Mvva 148,244,236
buffer_load_dwordx4 a[48:51], v112, s[8:11], s52 offen offset:0 sc1
Mvva 136,232,224
ds_read_b64_tr_b16 v[200:201], v14 offset:49152
ds_read_b64_tr_b16 v[202:203], v14 offset:51200
Mvva 136,248,232
buffer_load_dwordx4 a[52:55], v112, s[8:11], s52 offen offset:1024 sc1
s_add_u32 s52, s52, 8192
Mvva 152,232,228
s_waitcnt lgkmcnt(10)
ds_read_b64_tr_b16 v[216:217], v14 offset:53248
ds_read_b64_tr_b16 v[218:219], v14 offset:55296
Mvva 152,248,236
Mvva 140,236,224
ds_read_b64_tr_b16 v[204:205], v15 offset:49152
ds_read_b64_tr_b16 v[206:207], v15 offset:51200
Mvva 140,252,232
buffer_load_dwordx4 a[56:59], v112, s[8:11], s52 offen offset:0 sc1
Mvva 156,236,228
s_waitcnt lgkmcnt(10)
ds_read_b64_tr_b16 v[220:221], v15 offset:53248
ds_read_b64_tr_b16 v[222:223], v15 offset:55296
Mvva 156,252,236
buffer_load_dwordx4 a[60:63], v112, s[8:11], s52 offen offset:1024 sc1
s_add_u32 s52, s52, 8192
s_waitcnt vmcnt(24)
Mvva 160,192,240
s_add_u32 m0, s44, 32768
ds_read_b64_tr_b16 v[224:225], v12 offset:57344
ds_read_b64_tr_b16 v[226:227], v12 offset:59392
Mvva 160,208,248
buffer_load_dwordx4 v114, s[12:15], s48 offen offset:0 lds
Mvva 176,192,244
s_waitcnt lgkmcnt(10)
ds_read_b64_tr_b16 v[240:241], v12 offset:61440
ds_read_b64_tr_b16 v[242:243], v12 offset:63488
Mvva 176,208,252
Mvva 164,196,240
ds_read_b64_tr_b16 v[228:229], v13 offset:57344
ds_read_b64_tr_b16 v[230:231], v13 offset:59392
Mvva 164,212,248
buffer_load_dwordx4 v114, s[12:15], s49 offen offset:1024 lds
Mvva 180,196,244
s_waitcnt lgkmcnt(10)
ds_read_b64_tr_b16 v[244:245], v13 offset:61440
ds_read_b64_tr_b16 v[246:247], v13 offset:63488
Mvva 180,212,252
buffer_load_dwordx4 v114, s[12:15], s50 offen offset:2048 lds
Mvva 168,200,240
ds_read_b64_tr_b16 v[232:233], v14 offset:57344
ds_read_b64_tr_b16 v[234:235], v14 offset:59392
Mvva 168,216,248
buffer_load_dwordx4 v114, s[12:15], s51 offen offset:3072 lds
v_add_u32 v114, 262144, v114
Mvva 184,200,244
s_waitcnt lgkmcnt(10)
ds_read_b64_tr_b16 v[248:249], v14 offset:61440
ds_read_b64_tr_b16 v[250:251], v14 offset:63488
Mvva 184,216,252
Mvva 172,204,240
s_waitcnt vmcnt(24)
ds_read_b64_tr_b16 v[236:237], v15 offset:57344
ds_read_b64_tr_b16 v[238:239], v15 offset:59392
Mvva 172,220,248
s_waitcnt lgkmcnt(10)
buffer_load_dwordx4 a[64:67], v112, s[8:11], s52 offen offset:0 sc1
Mvva 188,204,244
s_barrier
ds_read_b64_tr_b16 v[252:253], v15 offset:61440
ds_read_b64_tr_b16 v[254:255], v15 offset:63488
Mvva 188,220,252
buffer_load_dwordx4 a[68:71], v112, s[8:11], s52 offen offset:1024 sc1
s_add_u32 s52, s52, 8192
Mvva 128,224,240
ds_read_b64_tr_b16 v[192:193], v115 offset:0
ds_read_b64_tr_b16 v[194:195], v115 offset:2048
Mvva 128,240,248
buffer_load_dwordx4 a[72:75], v112, s[8:11], s52 offen offset:0 sc1
Mvva 144,224,244
s_waitcnt lgkmcnt(10)
ds_read_b64_tr_b16 v[208:209], v115 offset:4096
ds_read_b64_tr_b16 v[210:211], v115 offset:6144
Mvva 144,240,252
Mvva 132,228,240
ds_read_b64_tr_b16 v[196:197], v116 offset:0
ds_read_b64_tr_b16 v[198:199], v116 offset:2048
Mvva 132,244,248
buffer_load_dwordx4 a[76:79], v112, s[8:11], s52 offen offset:1024 sc1
s_add_u32 s52, s52, 8192
Mvva 148,228,244
s_waitcnt lgkmcnt(10)
ds_read_b64_tr_b16 v[212:213], v116 offset:4096
ds_read_b64_tr_b16 v[214:215], v116 offset:6144
Mvva 148,244,252
buffer_load_dwordx4 a[80:83], v112, s[8:11], s52 offen offset:0 sc1
Mvva 136,232,240
ds_read_b64_tr_b16 v[200:201], v117 offset:0
ds_read_b64_tr_b16 v[202:203], v117 offset:2048
Mvva 136,248,248
buffer_load_dwordx4 a[84:87], v112, s[8:11], s52 offen offset:1024 sc1
s_add_u32 s52, s52, 8192
Mvva 152,232,244
s_waitcnt lgkmcnt(10)
ds_read_b64_tr_b16 v[216:217], v117 offset:4096
ds_read_b64_tr_b16 v[218:219], v117 offset:6144
Mvva 152,248,252
Mvva 140,236,240
ds_read_b64_tr_b16 v[204:205], v118 offset:0
ds_read_b64_tr_b16 v[206:207], v118 offset:2048
Mvva 140,252,248
buffer_load_dwordx4 a[88:91], v112, s[8:11], s52 offen offset:0 sc1
Mvva 156,236,244
s_waitcnt lgkmcnt(10)
ds_read_b64_tr_b16 v[220:221], v118 offset:4096
ds_read_b64_tr_b16 v[222:223], v118 offset:6144
Mvva 156,252,252
buffer_load_dwordx4 a[92:95], v112, s[8:11], s52 offen offset:1024 sc1
s_add_u32 s52, s52, 8192
s_waitcnt vmcnt(28)
Mvva 160,192,0
s_add_u32 m0, s44, 49152
ds_read_b64_tr_b16 v[224:225], v115 offset:8192
ds_read_b64_tr_b16 v[226:227], v115 offset:10240
Mvva 160,208,8
buffer_load_dwordx4 v114, s[12:15], s48 offen offset:0 lds
Mvva 176,192,4
s_waitcnt lgkmcnt(10)
ds_read_b64_tr_b16 v[240:241], v115 offset:12288
ds_read_b64_tr_b16 v[242:243], v115 offset:14336
Mvva 176,208,12
Mvva 164,196,0
ds_read_b64_tr_b16 v[228:229], v116 offset:8192
ds_read_b64_tr_b16 v[230:231], v116 offset:10240
Mvva 164,212,8
buffer_load_dwordx4 v114, s[12:15], s49 offen offset:1024 lds
Mvva 180,196,4
s_waitcnt lgkmcnt(10)
ds_read_b64_tr_b16 v[244:245], v116 offset:12288
ds_read_b64_tr_b16 v[246:247], v116 offset:14336
Mvva 180,212,12
buffer_load_dwordx4 v114, s[12:15], s50 offen offset:2048 lds
Mvva 168,200,0
ds_read_b64_tr_b16 v[232:233], v117 offset:8192
ds_read_b64_tr_b16 v[234:235], v117 offset:10240
Mvva 168,216,8
buffer_load_dwordx4 v114, s[12:15], s51 offen offset:3072 lds
v_add_u32 v114, 262144, v114
Mvva 184,200,4
s_waitcnt lgkmcnt(10)
ds_read_b64_tr_b16 v[248:249], v117 offset:12288
ds_read_b64_tr_b16 v[250:251], v117 offset:14336
Mvva 184,216,12
Mvva 172,204,0
s_waitcnt vmcnt(24)
ds_read_b64_tr_b16 v[236:237], v118 offset:8192
ds_read_b64_tr_b16 v[238:239], v118 offset:10240
Mvva 172,220,8
s_waitcnt lgkmcnt(10)
buffer_load_dwordx4 a[96:99], v112, s[8:11], s52 offen offset:0 sc1
Mvva 188,204,4
s_barrier
ds_read_b64_tr_b16 v[252:253], v118 offset:12288
ds_read_b64_tr_b16 v[254:255], v118 offset:14336
Mvva 188,220,12
buffer_load_dwordx4 a[100:103], v112, s[8:11], s52 offen offset:1024 sc1
s_add_u32 s52, s52, 8192
Mvva 160,224,16
ds_read_b64_tr_b16 v[192:193], v115 offset:16384
ds_read_b64_tr_b16 v[194:195], v115 offset:18432
Mvva 160,240,24
buffer_load_dwordx4 a[104:107], v112, s[8:11], s52 offen offset:0 sc1
Mvva 176,224,20
s_waitcnt lgkmcnt(10)
ds_read_b64_tr_b16 v[208:209], v115 offset:20480
ds_read_b64_tr_b16 v[210:211], v115 offset:22528
Mvva 176,240,28
Mvva 164,228,16
ds_read_b64_tr_b16 v[196:197], v116 offset:16384
ds_read_b64_tr_b16 v[198:199], v116 offset:18432
Mvva 164,244,24
buffer_load_dwordx4 a[108:111], v112, s[8:11], s52 offen offset:1024 sc1
s_add_u32 s52, s52, 8192
Mvva 180,228,20
s_waitcnt lgkmcnt(10)
ds_read_b64_tr_b16 v[212:213], v116 offset:20480
ds_read_b64_tr_b16 v[214:215], v116 offset:22528
Mvva 180,244,28
buffer_load_dwordx4 a[112:115], v112, s[8:11], s52 offen offset:0 sc1
Mvva 168,232,16
ds_read_b64_tr_b16 v[200:201], v117 offset:16384
ds_read_b64_tr_b16 v[202:203], v117 offset:18432
Mvva 168,248,24
buffer_load_dwordx4 a[116:119], v112, s[8:11], s52 offen offset:1024 sc1
s_add_u32 s52, s52, 8192
Mvva 184,232,20
s_waitcnt lgkmcnt(10)
ds_read_b64_tr_b16 v[216:217], v117 offset:20480
ds_read_b64_tr_b16 v[218:219], v117 offset:22528
Mvva 184,248,28
Mvva 172,236,16
ds_read_b64_tr_b16 v[204:205], v118 offset:16384
ds_read_b64_tr_b16 v[206:207], v118 offset:18432
Mvva 172,252,24
buffer_load_dwordx4 a[120:123], v112, s[8:11], s52 offen offset:0 sc1
Mvva 188,236,20
s_waitcnt lgkmcnt(10)
ds_read_b64_tr_b16 v[220:221], v118 offset:20480
ds_read_b64_tr_b16 v[222:223], v118 offset:22528
Mvva 188,252,28
buffer_load_dwordx4 a[124:127], v112, s[8:11], s52 offen offset:1024 sc1
s_add_u32 s52, s52, 8192
s_waitcnt vmcnt(28)
Mvva 160,192,32
s_add_u32 m0, s44, 65536
ds_read_b64_tr_b16 v[224:225], v115 offset:24576
ds_read_b64_tr_b16 v[226:227], v115 offset:26624
Mvva 160,208,40
buffer_load_dwordx4 v114, s[12:15], s48 offen offset:0 lds
Mvva 176,192,36
s_waitcnt lgkmcnt(10)
ds_read_b64_tr_b16 v[240:241], v115 offset:28672
ds_read_b64_tr_b16 v[242:243], v115 offset:30720
Mvva 176,208,44
Mvva 164,196,32
ds_read_b64_tr_b16 v[228:229], v116 offset:24576
ds_read_b64_tr_b16 v[230:231], v116 offset:26624
Mvva 164,212,40
buffer_load_dwordx4 v114, s[12:15], s49 offen offset:1024 lds
Mvva 180,196,36
s_waitcnt lgkmcnt(10)
ds_read_b64_tr_b16 v[244:245], v116 offset:28672
ds_read_b64_tr_b16 v[246:247], v116 offset:30720
Mvva 180,212,44
buffer_load_dwordx4 v114, s[12:15], s50 offen offset:2048 lds
Mvva 168,200,32
ds_read_b64_tr_b16 v[232:233], v117 offset:24576
ds_read_b64_tr_b16 v[234:235], v117 offset:26624
Mvva 168,216,40
buffer_load_dwordx4 v114, s[12:15], s51 offen offset:3072 lds
v_add_u32 v114, 262144, v114
Mvva 184,200,36
s_waitcnt lgkmcnt(10)
ds_read_b64_tr_b16 v[248:249], v117 offset:28672
ds_read_b64_tr_b16 v[250:251], v117 offset:30720
Mvva 184,216,44
Mvva 172,204,32
s_waitcnt vmcnt(24)
ds_read_b64_tr_b16 v[236:237], v118 offset:24576
ds_read_b64_tr_b16 v[238:239], v118 offset:26624
Mvva 172,220,40
s_waitcnt lgkmcnt(10)
buffer_load_dwordx4 a[128:131], v112, s[8:11], s52 offen offset:0 sc1
Mvva 188,204,36
s_barrier
ds_read_b64_tr_b16 v[252:253], v118 offset:28672
ds_read_b64_tr_b16 v[254:255], v118 offset:30720
Mvva 188,220,44
buffer_load_dwordx4 a[132:135], v112, s[8:11], s52 offen offset:1024 sc1
s_add_u32 s52, s52, 8192
Mvva 160,224,48
ds_read_b64_tr_b16 v[192:193], v115 offset:32768
ds_read_b64_tr_b16 v[194:195], v115 offset:34816
Mvva 160,240,56
buffer_load_dwordx4 a[136:139], v112, s[8:11], s52 offen offset:0 sc1
Mvva 176,224,52
s_waitcnt lgkmcnt(10)
ds_read_b64_tr_b16 v[208:209], v115 offset:36864
ds_read_b64_tr_b16 v[210:211], v115 offset:38912
Mvva 176,240,60
Mvva 164,228,48
ds_read_b64_tr_b16 v[196:197], v116 offset:32768
ds_read_b64_tr_b16 v[198:199], v116 offset:34816
Mvva 164,244,56
buffer_load_dwordx4 a[140:143], v112, s[8:11], s52 offen offset:1024 sc1
s_add_u32 s52, s52, 8192
Mvva 180,228,52
s_waitcnt lgkmcnt(10)
ds_read_b64_tr_b16 v[212:213], v116 offset:36864
ds_read_b64_tr_b16 v[214:215], v116 offset:38912
Mvva 180,244,60
buffer_load_dwordx4 a[144:147], v112, s[8:11], s52 offen offset:0 sc1
Mvva 168,232,48
ds_read_b64_tr_b16 v[200:201], v117 offset:32768
ds_read_b64_tr_b16 v[202:203], v117 offset:34816
Mvva 168,248,56
buffer_load_dwordx4 a[148:151], v112, s[8:11], s52 offen offset:1024 sc1
s_add_u32 s52, s52, 8192
Mvva 184,232,52
s_waitcnt lgkmcnt(10)
ds_read_b64_tr_b16 v[216:217], v117 offset:36864
ds_read_b64_tr_b16 v[218:219], v117 offset:38912
Mvva 184,248,60
Mvva 172,236,48
ds_read_b64_tr_b16 v[204:205], v118 offset:32768
ds_read_b64_tr_b16 v[206:207], v118 offset:34816
Mvva 172,252,56
buffer_load_dwordx4 a[152:155], v112, s[8:11], s52 offen offset:0 sc1
Mvva 188,236,52
s_waitcnt lgkmcnt(10)
ds_read_b64_tr_b16 v[220:221], v118 offset:36864
ds_read_b64_tr_b16 v[222:223], v118 offset:38912
Mvva 188,252,60
buffer_load_dwordx4 a[156:159], v112, s[8:11], s52 offen offset:1024 sc1
s_add_u32 s52, s52, 8192
s_waitcnt vmcnt(28)
Mvva 160,192,64
s_add_u32 m0, s44, 81920
ds_read_b64_tr_b16 v[224:225], v115 offset:40960
ds_read_b64_tr_b16 v[226:227], v115 offset:43008
Mvva 160,208,72
buffer_load_dwordx4 v114, s[12:15], s48 offen offset:0 lds
Mvva 176,192,68
s_waitcnt lgkmcnt(10)
ds_read_b64_tr_b16 v[240:241], v115 offset:45056
ds_read_b64_tr_b16 v[242:243], v115 offset:47104
Mvva 176,208,76
Mvva 164,196,64
ds_read_b64_tr_b16 v[228:229], v116 offset:40960
ds_read_b64_tr_b16 v[230:231], v116 offset:43008
Mvva 164,212,72
buffer_load_dwordx4 v114, s[12:15], s49 offen offset:1024 lds
Mvva 180,196,68
s_waitcnt lgkmcnt(10)
ds_read_b64_tr_b16 v[244:245], v116 offset:45056
ds_read_b64_tr_b16 v[246:247], v116 offset:47104
Mvva 180,212,76
buffer_load_dwordx4 v114, s[12:15], s50 offen offset:2048 lds
Mvva 168,200,64
ds_read_b64_tr_b16 v[232:233], v117 offset:40960
ds_read_b64_tr_b16 v[234:235], v117 offset:43008
Mvva 168,216,72
buffer_load_dwordx4 v114, s[12:15], s51 offen offset:3072 lds
v_add_u32 v114, 262144, v114
Mvva 184,200,68
s_waitcnt lgkmcnt(10)
ds_read_b64_tr_b16 v[248:249], v117 offset:45056
ds_read_b64_tr_b16 v[250:251], v117 offset:47104
Mvva 184,216,76
Mvva 172,204,64
s_waitcnt vmcnt(24)
ds_read_b64_tr_b16 v[236:237], v118 offset:40960
ds_read_b64_tr_b16 v[238:239], v118 offset:43008
Mvva 172,220,72
s_waitcnt lgkmcnt(10)
buffer_load_dwordx4 a[160:163], v112, s[8:11], s52 offen offset:0 sc1
Mvva 188,204,68
s_barrier
ds_read_b64_tr_b16 v[252:253], v118 offset:45056
ds_read_b64_tr_b16 v[254:255], v118 offset:47104
Mvva 188,220,76
buffer_load_dwordx4 a[164:167], v112, s[8:11], s52 offen offset:1024 sc1
s_add_u32 s52, s52, 8192
Mvva 160,224,80
ds_read_b64_tr_b16 v[192:193], v115 offset:49152
ds_read_b64_tr_b16 v[194:195], v115 offset:51200
Mvva 160,240,88
buffer_load_dwordx4 a[168:171], v112, s[8:11], s52 offen offset:0 sc1
Mvva 176,224,84
s_waitcnt lgkmcnt(10)
ds_read_b64_tr_b16 v[208:209], v115 offset:53248
ds_read_b64_tr_b16 v[210:211], v115 offset:55296
Mvva 176,240,92
Mvva 164,228,80
ds_read_b64_tr_b16 v[196:197], v116 offset:49152
ds_read_b64_tr_b16 v[198:199], v116 offset:51200
Mvva 164,244,88
buffer_load_dwordx4 a[172:175], v112, s[8:11], s52 offen offset:1024 sc1
s_add_u32 s52, s52, 8192
Mvva 180,228,84
s_waitcnt lgkmcnt(10)
ds_read_b64_tr_b16 v[212:213], v116 offset:53248
ds_read_b64_tr_b16 v[214:215], v116 offset:55296
Mvva 180,244,92
buffer_load_dwordx4 a[176:179], v112, s[8:11], s52 offen offset:0 sc1
Mvva 168,232,80
ds_read_b64_tr_b16 v[200:201], v117 offset:49152
ds_read_b64_tr_b16 v[202:203], v117 offset:51200
Mvva 168,248,88
buffer_load_dwordx4 a[180:183], v112, s[8:11], s52 offen offset:1024 sc1
s_add_u32 s52, s52, 8192
Mvva 184,232,84
s_waitcnt lgkmcnt(10)
ds_read_b64_tr_b16 v[216:217], v117 offset:53248
ds_read_b64_tr_b16 v[218:219], v117 offset:55296
Mvva 184,248,92
Mvva 172,236,80
ds_read_b64_tr_b16 v[204:205], v118 offset:49152
ds_read_b64_tr_b16 v[206:207], v118 offset:51200
Mvva 172,252,88
buffer_load_dwordx4 a[184:187], v112, s[8:11], s52 offen offset:0 sc1
Mvva 188,236,84
s_waitcnt lgkmcnt(10)
ds_read_b64_tr_b16 v[220:221], v118 offset:53248
ds_read_b64_tr_b16 v[222:223], v118 offset:55296
Mvva 188,252,92
buffer_load_dwordx4 a[188:191], v112, s[8:11], s52 offen offset:1024 sc1
s_add_u32 s52, s52, 8192
s_waitcnt vmcnt(28)
Mvva 160,192,96
s_add_u32 m0, s44, 98304
ds_read_b64_tr_b16 v[224:225], v115 offset:57344
ds_read_b64_tr_b16 v[226:227], v115 offset:59392
Mvva 160,208,104
buffer_load_dwordx4 v114, s[12:15], s48 offen offset:0 lds
Mvva 176,192,100
s_waitcnt lgkmcnt(10)
ds_read_b64_tr_b16 v[240:241], v115 offset:61440
ds_read_b64_tr_b16 v[242:243], v115 offset:63488
Mvva 176,208,108
s_cmp_lg_u32 s53, 0
s_cbranch_scc1 L_yA
L_yAr:
Mvva 164,196,96
ds_read_b64_tr_b16 v[228:229], v116 offset:57344
ds_read_b64_tr_b16 v[230:231], v116 offset:59392
Mvva 164,212,104
buffer_load_dwordx4 v114, s[12:15], s49 offen offset:1024 lds
Mvva 180,196,100
s_waitcnt lgkmcnt(10)
ds_read_b64_tr_b16 v[244:245], v116 offset:61440
ds_read_b64_tr_b16 v[246:247], v116 offset:63488
Mvva 180,212,108
buffer_load_dwordx4 v114, s[12:15], s50 offen offset:2048 lds
Mvva 168,200,96
ds_read_b64_tr_b16 v[232:233], v117 offset:57344
ds_read_b64_tr_b16 v[234:235], v117 offset:59392
Mvva 168,216,104
buffer_load_dwordx4 v114, s[12:15], s51 offen offset:3072 lds
v_add_u32 v114, 262144, v114
Mvva 184,200,100
s_waitcnt lgkmcnt(10)
ds_read_b64_tr_b16 v[248:249], v117 offset:61440
ds_read_b64_tr_b16 v[250:251], v117 offset:63488
Mvva 184,216,108
Mvva 172,204,96
s_waitcnt vmcnt(24)
ds_read_b64_tr_b16 v[236:237], v118 offset:57344
ds_read_b64_tr_b16 v[238:239], v118 offset:59392
Mvva 172,220,104
s_waitcnt lgkmcnt(10)
buffer_load_dwordx4 a[192:195], v112, s[8:11], s52 offen offset:0 sc1
Mvva 188,204,100
s_barrier
ds_read_b64_tr_b16 v[252:253], v118 offset:61440
ds_read_b64_tr_b16 v[254:255], v118 offset:63488
Mvva 188,220,108
buffer_load_dwordx4 a[196:199], v112, s[8:11], s52 offen offset:1024 sc1
s_add_u32 s52, s52, 8192
Mvva 160,224,112
ds_read_b64_tr_b16 v[192:193], v12 offset:0
ds_read_b64_tr_b16 v[194:195], v12 offset:2048
Mvva 160,240,120
buffer_load_dwordx4 a[200:203], v112, s[8:11], s52 offen offset:0 sc1
Mvva 176,224,116
s_waitcnt lgkmcnt(10)
ds_read_b64_tr_b16 v[208:209], v12 offset:4096
ds_read_b64_tr_b16 v[210:211], v12 offset:6144
Mvva 176,240,124
Mvva 164,228,112
ds_read_b64_tr_b16 v[196:197], v13 offset:0
ds_read_b64_tr_b16 v[198:199], v13 offset:2048
Mvva 164,244,120
buffer_load_dwordx4 a[204:207], v112, s[8:11], s52 offen offset:1024 sc1
s_add_u32 s52, s52, 8192
Mvva 180,228,116
s_waitcnt lgkmcnt(10)
ds_read_b64_tr_b16 v[212:213], v13 offset:4096
ds_read_b64_tr_b16 v[214:215], v13 offset:6144
Mvva 180,244,124
buffer_load_dwordx4 a[208:211], v112, s[8:11], s52 offen offset:0 sc1
Mvva 168,232,112
ds_read_b64_tr_b16 v[200:201], v14 offset:0
ds_read_b64_tr_b16 v[202:203], v14 offset:2048
Mvva 168,248,120
buffer_load_dwordx4 a[212:215], v112, s[8:11], s52 offen offset:1024 sc1
s_add_u32 s52, s52, 8192
Mvva 184,232,116
s_waitcnt lgkmcnt(10)
ds_read_b64_tr_b16 v[216:217], v14 offset:4096
ds_read_b64_tr_b16 v[218:219], v14 offset:6144
Mvva 184,248,124
Mvva 172,236,112
ds_read_b64_tr_b16 v[204:205], v15 offset:0
ds_read_b64_tr_b16 v[206:207], v15 offset:2048
Mvva 172,252,120
buffer_load_dwordx4 a[216:219], v112, s[8:11], s52 offen offset:0 sc1
Mvva 188,236,116
s_waitcnt lgkmcnt(10)
ds_read_b64_tr_b16 v[220:221], v15 offset:4096
ds_read_b64_tr_b16 v[222:223], v15 offset:6144
Mvva 188,252,124
buffer_load_dwordx4 a[220:223], v112, s[8:11], s52 offen offset:1024 sc1
s_add_u32 s52, s52, 8192
s_waitcnt vmcnt(28)
Mvva 160,192,128
s_add_u32 m0, s44, 114688
ds_read_b64_tr_b16 v[224:225], v12 offset:8192
ds_read_b64_tr_b16 v[226:227], v12 offset:10240
Mvva 160,208,136
buffer_load_dwordx4 v114, s[12:15], s48 offen offset:0 lds
Mvva 176,192,132
s_waitcnt lgkmcnt(10)
ds_read_b64_tr_b16 v[240:241], v12 offset:12288
ds_read_b64_tr_b16 v[242:243], v12 offset:14336
Mvva 176,208,140
Mvva 164,196,128
ds_read_b64_tr_b16 v[228:229], v13 offset:8192
ds_read_b64_tr_b16 v[230:231], v13 offset:10240
Mvva 164,212,136
buffer_load_dwordx4 v114, s[12:15], s49 offen offset:1024 lds
Mvva 180,196,132
s_waitcnt lgkmcnt(10)
ds_read_b64_tr_b16 v[244:245], v13 offset:12288
ds_read_b64_tr_b16 v[246:247], v13 offset:14336
Mvva 180,212,140
buffer_load_dwordx4 v114, s[12:15], s50 offen offset:2048 lds
Mvva 168,200,128
ds_read_b64_tr_b16 v[232:233], v14 offset:8192
ds_read_b64_tr_b16 v[234:235], v14 offset:10240
Mvva 168,216,136
buffer_load_dwordx4 v114, s[12:15], s51 offen offset:3072 lds
s_xor_b32 s95, s95, 128
v_add_u32 v114, s95, v113
Mvva 184,200,132
s_waitcnt lgkmcnt(10)
ds_read_b64_tr_b16 v[248:249], v14 offset:12288
ds_read_b64_tr_b16 v[250:251], v14 offset:14336
Mvva 184,216,140
Mvva 172,204,128
s_waitcnt vmcnt(24)
ds_read_b64_tr_b16 v[236:237], v15 offset:8192
ds_read_b64_tr_b16 v[238:239], v15 offset:10240
Mvva 172,220,136
s_waitcnt lgkmcnt(10)
buffer_load_dwordx4 a[224:227], v112, s[8:11], s52 offen offset:0 sc1
Mvva 188,204,132
s_barrier
ds_read_b64_tr_b16 v[252:253], v15 offset:12288
ds_read_b64_tr_b16 v[254:255], v15 offset:14336
Mvva 188,220,140
buffer_load_dwordx4 a[228:231], v112, s[8:11], s52 offen offset:1024 sc1
s_add_u32 s52, s52, 8192
Mvva 160,224,144
ds_read_b64_tr_b16 v[192:193], v12 offset:16384
ds_read_b64_tr_b16 v[194:195], v12 offset:18432
Mvva 160,240,152
buffer_load_dwordx4 a[232:235], v112, s[8:11], s52 offen offset:0 sc1
Mvva 176,224,148
s_waitcnt lgkmcnt(10)
ds_read_b64_tr_b16 v[208:209], v12 offset:20480
ds_read_b64_tr_b16 v[210:211], v12 offset:22528
Mvva 176,240,156
Mvva 164,228,144
ds_read_b64_tr_b16 v[196:197], v13 offset:16384
ds_read_b64_tr_b16 v[198:199], v13 offset:18432
Mvva 164,244,152
buffer_load_dwordx4 a[236:239], v112, s[8:11], s52 offen offset:1024 sc1
s_add_u32 s52, s52, 8192
Mvva 180,228,148
s_waitcnt lgkmcnt(10)
ds_read_b64_tr_b16 v[212:213], v13 offset:20480
ds_read_b64_tr_b16 v[214:215], v13 offset:22528
Mvva 180,244,156
buffer_load_dwordx4 a[240:243], v112, s[8:11], s52 offen offset:0 sc1
Mvva 168,232,144
ds_read_b64_tr_b16 v[200:201], v14 offset:16384
ds_read_b64_tr_b16 v[202:203], v14 offset:18432
Mvva 168,248,152
buffer_load_dwordx4 a[244:247], v112, s[8:11], s52 offen offset:1024 sc1
s_add_u32 s52, s52, 8192
Mvva 184,232,148
s_waitcnt lgkmcnt(10)
ds_read_b64_tr_b16 v[216:217], v14 offset:20480
ds_read_b64_tr_b16 v[218:219], v14 offset:22528
Mvva 184,248,156
Mvva 172,236,144
ds_read_b64_tr_b16 v[204:205], v15 offset:16384
ds_read_b64_tr_b16 v[206:207], v15 offset:18432
Mvva 172,252,152
buffer_load_dwordx4 a[248:251], v112, s[8:11], s52 offen offset:0 sc1
Mvva 188,236,148
s_waitcnt lgkmcnt(10)
ds_read_b64_tr_b16 v[220:221], v15 offset:20480
ds_read_b64_tr_b16 v[222:223], v15 offset:22528
Mvva 188,252,156
buffer_load_dwordx4 a[252:255], v112, s[8:11], s52 offen offset:1024 sc1
s_add_u32 s52, s52, 8192
s_waitcnt vmcnt(28)
Mvva 160,192,160
s_add_u32 m0, s44, 0
ds_read_b64_tr_b16 v[224:225], v12 offset:24576
ds_read_b64_tr_b16 v[226:227], v12 offset:26624
Mvva 160,208,168
buffer_load_dwordx4 v114, s[12:15], s48 offen offset:0 lds
Mvva 176,192,164
s_waitcnt lgkmcnt(10)
ds_read_b64_tr_b16 v[240:241], v12 offset:28672
ds_read_b64_tr_b16 v[242:243], v12 offset:30720
Mvva 176,208,172
Mvva 164,196,160
ds_read_b64_tr_b16 v[228:229], v13 offset:24576
ds_read_b64_tr_b16 v[230:231], v13 offset:26624
Mvva 164,212,168
buffer_load_dwordx4 v114, s[12:15], s49 offen offset:1024 lds
Mvva 180,196,164
s_waitcnt lgkmcnt(10)
ds_read_b64_tr_b16 v[244:245], v13 offset:28672
ds_read_b64_tr_b16 v[246:247], v13 offset:30720
Mvva 180,212,172
buffer_load_dwordx4 v114, s[12:15], s50 offen offset:2048 lds
Mvva 168,200,160
ds_read_b64_tr_b16 v[232:233], v14 offset:24576
ds_read_b64_tr_b16 v[234:235], v14 offset:26624
Mvva 168,216,168
buffer_load_dwordx4 v114, s[12:15], s51 offen offset:3072 lds
v_add_u32 v114, 262144, v114
Mvva 184,200,164
s_waitcnt lgkmcnt(10)
ds_read_b64_tr_b16 v[248:249], v14 offset:28672
ds_read_b64_tr_b16 v[250:251], v14 offset:30720
Mvva 184,216,172
Mvva 172,204,160
s_waitcnt vmcnt(24)
s_add_u32 m0, s44, 16384
ds_read_b64_tr_b16 v[236:237], v15 offset:24576
ds_read_b64_tr_b16 v[238:239], v15 offset:26624
Mvva 172,220,168
s_waitcnt lgkmcnt(10)
buffer_load_dwordx4 v114, s[12:15], s48 offen offset:0 lds
Mvva 188,204,164
s_barrier
ds_read_b64_tr_b16 v[252:253], v15 offset:28672
ds_read_b64_tr_b16 v[254:255], v15 offset:30720
Mvva 188,220,172
buffer_load_dwordx4 v114, s[12:15], s49 offen offset:1024 lds
Mvva 160,224,176
ds_read_b64_tr_b16 v[192:193], v12 offset:32768
ds_read_b64_tr_b16 v[194:195], v12 offset:34816
Mvva 160,240,184
buffer_load_dwordx4 v114, s[12:15], s50 offen offset:2048 lds
Mvva 176,224,180
s_waitcnt lgkmcnt(10)
ds_read_b64_tr_b16 v[208:209], v12 offset:36864
ds_read_b64_tr_b16 v[210:211], v12 offset:38912
Mvva 176,240,188
s_cmp_lg_u32 s53, 0
s_cbranch_scc1 L_yB
L_yBr:
Mvva 164,228,176
ds_read_b64_tr_b16 v[196:197], v13 offset:32768
ds_read_b64_tr_b16 v[198:199], v13 offset:34816
Mvva 164,244,184
buffer_load_dwordx4 v114, s[12:15], s51 offen offset:3072 lds
v_add_u32 v114, 262144, v114
Mvva 180,228,180
s_waitcnt lgkmcnt(10)
s_add_u32 m0, s44, 32768
ds_read_b64_tr_b16 v[212:213], v13 offset:36864
ds_read_b64_tr_b16 v[214:215], v13 offset:38912
Mvva 180,244,188
buffer_load_dwordx4 v114, s[12:15], s48 offen offset:0 lds
Mvva 168,232,176
ds_read_b64_tr_b16 v[200:201], v14 offset:32768
ds_read_b64_tr_b16 v[202:203], v14 offset:34816
Mvva 168,248,184
buffer_load_dwordx4 v114, s[12:15], s49 offen offset:1024 lds
Mvva 184,232,180
s_waitcnt lgkmcnt(10)
ds_read_b64_tr_b16 v[216:217], v14 offset:36864
ds_read_b64_tr_b16 v[218:219], v14 offset:38912
Mvva 184,248,188
Mvva 172,236,176
ds_read_b64_tr_b16 v[204:205], v15 offset:32768
ds_read_b64_tr_b16 v[206:207], v15 offset:34816
Mvva 172,252,184
buffer_load_dwordx4 v114, s[12:15], s50 offen offset:2048 lds
Mvva 188,236,180
s_waitcnt lgkmcnt(10)
ds_read_b64_tr_b16 v[220:221], v15 offset:36864
ds_read_b64_tr_b16 v[222:223], v15 offset:38912
Mvva 188,252,188
buffer_load_dwordx4 v114, s[12:15], s51 offen offset:3072 lds
v_add_u32 v114, 262144, v114
s_waitcnt vmcnt(28)
Mvva 160,192,192
ds_read_b64_tr_b16 v[224:225], v12 offset:40960
ds_read_b64_tr_b16 v[226:227], v12 offset:43008
Mvva 160,208,200
Mvva 176,192,196
s_waitcnt lgkmcnt(10)
s_add_u32 m0, s44, 49152
ds_read_b64_tr_b16 v[240:241], v12 offset:45056
ds_read_b64_tr_b16 v[242:243], v12 offset:47104
Mvva 176,208,204
buffer_load_dwordx4 v114, s[12:15], s48 offen offset:0 lds
Mvva 164,196,192
ds_read_b64_tr_b16 v[228:229], v13 offset:40960
ds_read_b64_tr_b16 v[230:231], v13 offset:43008
Mvva 164,212,200
Mvva 180,196,196
s_waitcnt lgkmcnt(10)
ds_read_b64_tr_b16 v[244:245], v13 offset:45056
ds_read_b64_tr_b16 v[246:247], v13 offset:47104
Mvva 180,212,204
buffer_load_dwordx4 v114, s[12:15], s49 offen offset:1024 lds
Mvva 168,200,192
ds_read_b64_tr_b16 v[232:233], v14 offset:40960
ds_read_b64_tr_b16 v[234:235], v14 offset:43008
Mvva 168,216,200
Mvva 184,200,196
s_waitcnt lgkmcnt(10)
ds_read_b64_tr_b16 v[248:249], v14 offset:45056
ds_read_b64_tr_b16 v[250:251], v14 offset:47104
Mvva 184,216,204
buffer_load_dwordx4 v114, s[12:15], s50 offen offset:2048 lds
Mvva 172,204,192
s_waitcnt vmcnt(23)
ds_read_b64_tr_b16 v[236:237], v15 offset:40960
ds_read_b64_tr_b16 v[238:239], v15 offset:43008
Mvva 172,220,200
s_waitcnt lgkmcnt(10)
Mvva 188,204,196
s_barrier
ds_read_b64_tr_b16 v[252:253], v15 offset:45056
ds_read_b64_tr_b16 v[254:255], v15 offset:47104
Mvva 188,220,204
buffer_load_dwordx4 v114, s[12:15], s51 offen offset:3072 lds
v_add_u32 v114, 262144, v114
Mvva 160,224,208
ds_read_b64_tr_b16 v[192:193], v12 offset:49152
ds_read_b64_tr_b16 v[194:195], v12 offset:51200
Mvva 160,240,216
Mvva 176,224,212
s_waitcnt lgkmcnt(10)
s_add_u32 m0, s44, 65536
ds_read_b64_tr_b16 v[208:209], v12 offset:53248
ds_read_b64_tr_b16 v[210:211], v12 offset:55296
Mvva 176,240,220
buffer_load_dwordx4 v114, s[12:15], s48 offen offset:0 lds
Mvva 164,228,208
ds_read_b64_tr_b16 v[196:197], v13 offset:49152
ds_read_b64_tr_b16 v[198:199], v13 offset:51200
Mvva 164,244,216
Mvva 180,228,212
s_waitcnt lgkmcnt(10)
ds_read_b64_tr_b16 v[212:213], v13 offset:53248
ds_read_b64_tr_b16 v[214:215], v13 offset:55296
Mvva 180,244,220
buffer_load_dwordx4 v114, s[12:15], s49 offen offset:1024 lds
Mvva 168,232,208
ds_read_b64_tr_b16 v[200:201], v14 offset:49152
ds_read_b64_tr_b16 v[202:203], v14 offset:51200
Mvva 168,248,216
Mvva 184,232,212
s_waitcnt lgkmcnt(10)
ds_read_b64_tr_b16 v[216:217], v14 offset:53248
ds_read_b64_tr_b16 v[218:219], v14 offset:55296
Mvva 184,248,220
buffer_load_dwordx4 v114, s[12:15], s50 offen offset:2048 lds
Mvva 172,236,208
ds_read_b64_tr_b16 v[204:205], v15 offset:49152
ds_read_b64_tr_b16 v[206:207], v15 offset:51200
Mvva 172,252,216
Mvva 188,236,212
s_waitcnt lgkmcnt(10)
ds_read_b64_tr_b16 v[220:221], v15 offset:53248
ds_read_b64_tr_b16 v[222:223], v15 offset:55296
Mvva 188,252,220
buffer_load_dwordx4 v114, s[12:15], s51 offen offset:3072 lds
v_add_u32 v114, 262144, v114
s_waitcnt vmcnt(24)
Mvva 160,192,224
ds_read_b64_tr_b16 v[224:225], v12 offset:57344
ds_read_b64_tr_b16 v[226:227], v12 offset:59392
Mvva 160,208,232
Mvva 176,192,228
s_waitcnt lgkmcnt(10)
ds_read_b64_tr_b16 v[240:241], v12 offset:61440
ds_read_b64_tr_b16 v[242:243], v12 offset:63488
Mvva 176,208,236
Mvva 164,196,224
s_add_u32 m0, s44, 81920
ds_read_b64_tr_b16 v[228:229], v13 offset:57344
ds_read_b64_tr_b16 v[230:231], v13 offset:59392
Mvva 164,212,232
buffer_load_dwordx4 v114, s[12:15], s48 offen offset:0 lds
Mvva 180,196,228
s_waitcnt lgkmcnt(10)
ds_read_b64_tr_b16 v[244:245], v13 offset:61440
ds_read_b64_tr_b16 v[246:247], v13 offset:63488
Mvva 180,212,236
Mvva 168,200,224
ds_read_b64_tr_b16 v[232:233], v14 offset:57344
ds_read_b64_tr_b16 v[234:235], v14 offset:59392
Mvva 168,216,232
Mvva 184,200,228
s_waitcnt lgkmcnt(10)
ds_read_b64_tr_b16 v[248:249], v14 offset:61440
ds_read_b64_tr_b16 v[250:251], v14 offset:63488
Mvva 184,216,236
Mvva 172,204,224
s_waitcnt vmcnt(17)
ds_read_b64_tr_b16 v[236:237], v15 offset:57344
ds_read_b64_tr_b16 v[238:239], v15 offset:59392
Mvva 172,220,232
s_waitcnt lgkmcnt(10)
buffer_load_dwordx4 v114, s[12:15], s49 offen offset:1024 lds
Mvva 188,204,228
s_barrier
ds_read_b64_tr_b16 v[252:253], v15 offset:61440
ds_read_b64_tr_b16 v[254:255], v15 offset:63488
Mvva 188,220,236
Mvva 160,224,240
ds_read_b64_tr_b16 v[192:193], v115 offset:0
ds_read_b64_tr_b16 v[194:195], v115 offset:2048
Mvva 160,240,248
s_cmp_lg_u32 s40, 0
s_cbranch_scc1 L_yC
L_yCr:
Mvva 176,224,244
s_waitcnt lgkmcnt(10)
ds_read_b64_tr_b16 v[208:209], v115 offset:4096
ds_read_b64_tr_b16 v[210:211], v115 offset:6144
Mvva 176,240,252
Mvva 164,228,240
ds_read_b64_tr_b16 v[196:197], v116 offset:0
ds_read_b64_tr_b16 v[198:199], v116 offset:2048
Mvva 164,244,248
buffer_load_dwordx4 v114, s[12:15], s50 offen offset:2048 lds
Mvva 180,228,244
s_waitcnt lgkmcnt(10)
ds_read_b64_tr_b16 v[212:213], v116 offset:4096
ds_read_b64_tr_b16 v[214:215], v116 offset:6144
Mvva 180,244,252
Mvva 168,232,240
ds_read_b64_tr_b16 v[200:201], v117 offset:0
ds_read_b64_tr_b16 v[202:203], v117 offset:2048
Mvva 168,248,248
Mvva 184,232,244
s_waitcnt lgkmcnt(10)
ds_read_b64_tr_b16 v[216:217], v117 offset:4096
ds_read_b64_tr_b16 v[218:219], v117 offset:6144
Mvva 184,248,252
Mvva 172,236,240
ds_read_b64_tr_b16 v[204:205], v118 offset:0
ds_read_b64_tr_b16 v[206:207], v118 offset:2048
Mvva 172,252,248
buffer_load_dwordx4 v114, s[12:15], s51 offen offset:3072 lds
v_add_u32 v114, 262144, v114
Mvva 188,236,244
s_waitcnt lgkmcnt(10)
ds_read_b64_tr_b16 v[220:221], v118 offset:4096
ds_read_b64_tr_b16 v[222:223], v118 offset:6144
Mvva 188,252,252
Mvva 128,192,0
ds_read_b64_tr_b16 v[224:225], v115 offset:8192
ds_read_b64_tr_b16 v[226:227], v115 offset:10240
Mvva 128,208,8
Mvva 144,192,4
s_waitcnt lgkmcnt(10)
ds_read_b64_tr_b16 v[240:241], v115 offset:12288
ds_read_b64_tr_b16 v[242:243], v115 offset:14336
Mvva 144,208,12
Mvva 132,196,0
s_add_u32 m0, s44, 98304
ds_read_b64_tr_b16 v[228:229], v116 offset:8192
ds_read_b64_tr_b16 v[230:231], v116 offset:10240
Mvva 132,212,8
buffer_load_dwordx4 v114, s[12:15], s48 offen offset:0 lds
Mvva 148,196,4
s_waitcnt lgkmcnt(10)
ds_read_b64_tr_b16 v[244:245], v116 offset:12288
ds_read_b64_tr_b16 v[246:247], v116 offset:14336
Mvva 148,212,12
v_add_u32 v10, 4096, v112
Mvva 136,200,0
ds_read_b64_tr_b16 v[232:233], v117 offset:8192
ds_read_b64_tr_b16 v[234:235], v117 offset:10240
Mvva 136,216,8
buffer_store_dwordx4 v[160:163], v112, s[16:19], s26 offen offset:0 sc1
Mvva 152,200,4
s_waitcnt lgkmcnt(10)
ds_read_b64_tr_b16 v[248:249], v117 offset:12288
ds_read_b64_tr_b16 v[250:251], v117 offset:14336
Mvva 152,216,12
buffer_store_dwordx4 v[164:167], v112, s[16:19], s26 offen offset:1024 sc1
Mvva 140,204,0
s_waitcnt vmcnt(19)
ds_read_b64_tr_b16 v[236:237], v118 offset:8192
ds_read_b64_tr_b16 v[238:239], v118 offset:10240
Mvva 140,220,8
s_waitcnt lgkmcnt(10)
buffer_load_dwordx4 v114, s[12:15], s49 offen offset:1024 lds
Mvva 156,204,4
s_barrier
ds_read_b64_tr_b16 v[252:253], v118 offset:12288
ds_read_b64_tr_b16 v[254:255], v118 offset:14336
Mvva 156,220,12
buffer_store_dwordx4 v[168:171], v112, s[16:19], s26 offen offset:2048 sc1
Mvva 128,224,16
ds_read_b64_tr_b16 v[192:193], v115 offset:16384
ds_read_b64_tr_b16 v[194:195], v115 offset:18432
Mvva 128,240,24
buffer_store_dwordx4 v[172:175], v112, s[16:19], s26 offen offset:3072 sc1
Mvva 144,224,20
s_waitcnt lgkmcnt(10)
ds_read_b64_tr_b16 v[208:209], v115 offset:20480
ds_read_b64_tr_b16 v[210:211], v115 offset:22528
Mvva 144,240,28
buffer_store_dwordx4 v[176:179], v10, s[16:19], s26 offen offset:0 sc1
Mvva 132,228,16
ds_read_b64_tr_b16 v[196:197], v116 offset:16384
ds_read_b64_tr_b16 v[198:199], v116 offset:18432
Mvva 132,244,24
buffer_load_dwordx4 v114, s[12:15], s50 offen offset:2048 lds
Mvva 148,228,20
s_waitcnt lgkmcnt(10)
ds_read_b64_tr_b16 v[212:213], v116 offset:20480
ds_read_b64_tr_b16 v[214:215], v116 offset:22528
Mvva 148,244,28
buffer_store_dwordx4 v[180:183], v10, s[16:19], s26 offen offset:1024 sc1
Mvva 136,232,16
ds_read_b64_tr_b16 v[200:201], v117 offset:16384
ds_read_b64_tr_b16 v[202:203], v117 offset:18432
Mvva 136,248,24
buffer_store_dwordx4 v[184:187], v10, s[16:19], s26 offen offset:2048 sc1
Mvva 152,232,20
s_waitcnt lgkmcnt(10)
ds_read_b64_tr_b16 v[216:217], v117 offset:20480
ds_read_b64_tr_b16 v[218:219], v117 offset:22528
Mvva 152,248,28
buffer_store_dwordx4 v[188:191], v10, s[16:19], s26 offen offset:3072 sc1
Mvva 140,236,16
ds_read_b64_tr_b16 v[204:205], v118 offset:16384
ds_read_b64_tr_b16 v[206:207], v118 offset:18432
Mvva 140,252,24
buffer_load_dwordx4 v114, s[12:15], s51 offen offset:3072 lds
v_add_u32 v114, 262144, v114
Mvva 156,236,20
s_waitcnt lgkmcnt(10)
ds_read_b64_tr_b16 v[220:221], v118 offset:20480
ds_read_b64_tr_b16 v[222:223], v118 offset:22528
Mvva 156,252,28
v_mov_b32_e64 v16, 1
Mvva 128,192,32
ds_read_b64_tr_b16 v[224:225], v115 offset:24576
ds_read_b64_tr_b16 v[226:227], v115 offset:26624
Mvva 128,208,40
Mvva 144,192,36
s_waitcnt lgkmcnt(10)
ds_read_b64_tr_b16 v[240:241], v115 offset:28672
ds_read_b64_tr_b16 v[242:243], v115 offset:30720
Mvva 144,208,44
Mvva 132,196,32
s_add_u32 m0, s44, 114688
ds_read_b64_tr_b16 v[228:229], v116 offset:24576
ds_read_b64_tr_b16 v[230:231], v116 offset:26624
Mvva 132,212,40
buffer_load_dwordx4 v114, s[12:15], s48 offen offset:0 lds
Mvva 148,196,36
s_waitcnt lgkmcnt(10)
ds_read_b64_tr_b16 v[244:245], v116 offset:28672
ds_read_b64_tr_b16 v[246:247], v116 offset:30720
Mvva 148,212,44
Mvva 136,200,32
ds_read_b64_tr_b16 v[232:233], v117 offset:24576
ds_read_b64_tr_b16 v[234:235], v117 offset:26624
Mvva 136,216,40
Mvva 152,200,36
s_waitcnt lgkmcnt(10)
ds_read_b64_tr_b16 v[248:249], v117 offset:28672
ds_read_b64_tr_b16 v[250:251], v117 offset:30720
Mvva 152,216,44
Mvva 140,204,32
s_waitcnt vmcnt(25)
ds_read_b64_tr_b16 v[236:237], v118 offset:24576
ds_read_b64_tr_b16 v[238:239], v118 offset:26624
Mvva 140,220,40
s_waitcnt lgkmcnt(10)
buffer_load_dwordx4 v114, s[12:15], s49 offen offset:1024 lds
Mvva 156,204,36
s_barrier
ds_read_b64_tr_b16 v[252:253], v118 offset:28672
ds_read_b64_tr_b16 v[254:255], v118 offset:30720
Mvva 156,220,44
Mvva 128,224,48
ds_read_b64_tr_b16 v[192:193], v115 offset:32768
ds_read_b64_tr_b16 v[194:195], v115 offset:34816
Mvva 128,240,56
Mvva 144,224,52
s_waitcnt lgkmcnt(10)
ds_read_b64_tr_b16 v[208:209], v115 offset:36864
ds_read_b64_tr_b16 v[210:211], v115 offset:38912
Mvva 144,240,60
Mvva 132,228,48
ds_read_b64_tr_b16 v[196:197], v116 offset:32768
ds_read_b64_tr_b16 v[198:199], v116 offset:34816
Mvva 132,244,56
buffer_load_dwordx4 v114, s[12:15], s50 offen offset:2048 lds
Mvva 148,228,52
s_waitcnt lgkmcnt(10)
ds_read_b64_tr_b16 v[212:213], v116 offset:36864
ds_read_b64_tr_b16 v[214:215], v116 offset:38912
Mvva 148,244,60
Mvva 136,232,48
ds_read_b64_tr_b16 v[200:201], v117 offset:32768
ds_read_b64_tr_b16 v[202:203], v117 offset:34816
Mvva 136,248,56
Mvva 152,232,52
s_waitcnt lgkmcnt(10)
ds_read_b64_tr_b16 v[216:217], v117 offset:36864
ds_read_b64_tr_b16 v[218:219], v117 offset:38912
Mvva 152,248,60
Mvva 140,236,48
ds_read_b64_tr_b16 v[204:205], v118 offset:32768
ds_read_b64_tr_b16 v[206:207], v118 offset:34816
Mvva 140,252,56
buffer_load_dwordx4 v114, s[12:15], s51 offen offset:3072 lds
v_add_u32 v114, 262144, v114
Mvva 156,236,52
s_waitcnt lgkmcnt(10)
ds_read_b64_tr_b16 v[220:221], v118 offset:36864
ds_read_b64_tr_b16 v[222:223], v118 offset:38912
Mvva 156,252,60
Mvva 128,192,64
ds_read_b64_tr_b16 v[224:225], v115 offset:40960
ds_read_b64_tr_b16 v[226:227], v115 offset:43008
Mvva 128,208,72
Mvva 144,192,68
s_waitcnt lgkmcnt(10)
ds_read_b64_tr_b16 v[240:241], v115 offset:45056
ds_read_b64_tr_b16 v[242:243], v115 offset:47104
Mvva 144,208,76
Mvva 132,196,64
ds_read_b64_tr_b16 v[228:229], v116 offset:40960
ds_read_b64_tr_b16 v[230:231], v116 offset:43008
Mvva 132,212,72
Mvva 148,196,68
s_waitcnt lgkmcnt(10)
ds_read_b64_tr_b16 v[244:245], v116 offset:45056
ds_read_b64_tr_b16 v[246:247], v116 offset:47104
Mvva 148,212,76
Mvva 136,200,64
ds_read_b64_tr_b16 v[232:233], v117 offset:40960
ds_read_b64_tr_b16 v[234:235], v117 offset:43008
Mvva 136,216,72
Mvva 152,200,68
s_waitcnt lgkmcnt(10)
ds_read_b64_tr_b16 v[248:249], v117 offset:45056
ds_read_b64_tr_b16 v[250:251], v117 offset:47104
Mvva 152,216,76
Mvva 140,204,64
s_waitcnt vmcnt(24)
ds_read_b64_tr_b16 v[236:237], v118 offset:40960
ds_read_b64_tr_b16 v[238:239], v118 offset:43008
Mvva 140,220,72
s_waitcnt lgkmcnt(10)
Mvva 156,204,68
s_barrier
ds_read_b64_tr_b16 v[252:253], v118 offset:45056
ds_read_b64_tr_b16 v[254:255], v118 offset:47104
Mvva 156,220,76
Mvva 128,224,80
ds_read_b64_tr_b16 v[192:193], v115 offset:49152
ds_read_b64_tr_b16 v[194:195], v115 offset:51200
Mvva 128,240,88
Mvva 144,224,84
s_waitcnt lgkmcnt(10)
ds_read_b64_tr_b16 v[208:209], v115 offset:53248
ds_read_b64_tr_b16 v[210:211], v115 offset:55296
Mvva 144,240,92
Mvva 132,228,80
ds_read_b64_tr_b16 v[196:197], v116 offset:49152
ds_read_b64_tr_b16 v[198:199], v116 offset:51200
Mvva 132,244,88
Mvva 148,228,84
s_waitcnt lgkmcnt(10)
ds_read_b64_tr_b16 v[212:213], v116 offset:53248
ds_read_b64_tr_b16 v[214:215], v116 offset:55296
Mvva 148,244,92
Mvva 136,232,80
ds_read_b64_tr_b16 v[200:201], v117 offset:49152
ds_read_b64_tr_b16 v[202:203], v117 offset:51200
Mvva 136,248,88
Mvva 152,232,84
s_waitcnt lgkmcnt(10)
ds_read_b64_tr_b16 v[216:217], v117 offset:53248
ds_read_b64_tr_b16 v[218:219], v117 offset:55296
Mvva 152,248,92
Mvva 140,236,80
ds_read_b64_tr_b16 v[204:205], v118 offset:49152
ds_read_b64_tr_b16 v[206:207], v118 offset:51200
Mvva 140,252,88
Mvva 156,236,84
s_waitcnt lgkmcnt(10)
ds_read_b64_tr_b16 v[220:221], v118 offset:53248
ds_read_b64_tr_b16 v[222:223], v118 offset:55296
Mvva 156,252,92
Mvva 128,192,96
ds_read_b64_tr_b16 v[224:225], v115 offset:57344
ds_read_b64_tr_b16 v[226:227], v115 offset:59392
Mvva 128,208,104
Mvva 144,192,100
s_waitcnt lgkmcnt(10)
ds_read_b64_tr_b16 v[240:241], v115 offset:61440
ds_read_b64_tr_b16 v[242:243], v115 offset:63488
Mvva 144,208,108
Mvva 132,196,96
ds_read_b64_tr_b16 v[228:229], v116 offset:57344
ds_read_b64_tr_b16 v[230:231], v116 offset:59392
Mvva 132,212,104
Mvva 148,196,100
s_waitcnt lgkmcnt(10)
ds_read_b64_tr_b16 v[244:245], v116 offset:61440
ds_read_b64_tr_b16 v[246:247], v116 offset:63488
Mvva 148,212,108
s_waitcnt vmcnt(5)
s_mov_b64 exec, 1
buffer_store_dword v16, v126, s[20:23], s27 offen sc1
s_mov_b64 exec, -1
Mvva 136,200,96
ds_read_b64_tr_b16 v[232:233], v117 offset:57344
ds_read_b64_tr_b16 v[234:235], v117 offset:59392
Mvva 136,216,104
Mvva 152,200,100
s_waitcnt lgkmcnt(10)
ds_read_b64_tr_b16 v[248:249], v117 offset:61440
ds_read_b64_tr_b16 v[250:251], v117 offset:63488
Mvva 152,216,108
Mvva 140,204,96
ds_read_b64_tr_b16 v[236:237], v118 offset:57344
ds_read_b64_tr_b16 v[238:239], v118 offset:59392
Mvva 140,220,104
s_waitcnt lgkmcnt(10)
Mvva 156,204,100
s_barrier
ds_read_b64_tr_b16 v[252:253], v118 offset:61440
ds_read_b64_tr_b16 v[254:255], v118 offset:63488
Mvva 156,220,108
Mvva 128,224,112
ds_read_b64_tr_b16 v[192:193], v12 offset:0
ds_read_b64_tr_b16 v[194:195], v12 offset:2048
Mvva 128,240,120
Mvva 144,224,116
s_waitcnt lgkmcnt(10)
ds_read_b64_tr_b16 v[208:209], v12 offset:4096
ds_read_b64_tr_b16 v[210:211], v12 offset:6144
Mvva 144,240,124
Mvva 132,228,112
ds_read_b64_tr_b16 v[196:197], v13 offset:0
ds_read_b64_tr_b16 v[198:199], v13 offset:2048
Mvva 132,244,120
Mvva 148,228,116
s_waitcnt lgkmcnt(10)
ds_read_b64_tr_b16 v[212:213], v13 offset:4096
ds_read_b64_tr_b16 v[214:215], v13 offset:6144
Mvva 148,244,124
Mvva 136,232,112
ds_read_b64_tr_b16 v[200:201], v14 offset:0
ds_read_b64_tr_b16 v[202:203], v14 offset:2048
Mvva 136,248,120
Mvva 152,232,116
s_waitcnt lgkmcnt(10)
ds_read_b64_tr_b16 v[216:217], v14 offset:4096
ds_read_b64_tr_b16 v[218:219], v14 offset:6144
Mvva 152,248,124
Mvva 140,236,112
ds_read_b64_tr_b16 v[204:205], v15 offset:0
ds_read_b64_tr_b16 v[206:207], v15 offset:2048
Mvva 140,252,120
Mvva 156,236,116
s_waitcnt lgkmcnt(10)
ds_read_b64_tr_b16 v[220:221], v15 offset:4096
ds_read_b64_tr_b16 v[222:223], v15 offset:6144
Mvva 156,252,124
Mvva 128,192,128
ds_read_b64_tr_b16 v[224:225], v12 offset:8192
ds_read_b64_tr_b16 v[226:227], v12 offset:10240
Mvva 128,208,136
Mvva 144,192,132
s_waitcnt lgkmcnt(10)
ds_read_b64_tr_b16 v[240:241], v12 offset:12288
ds_read_b64_tr_b16 v[242:243], v12 offset:14336
Mvva 144,208,140
Mvva 132,196,128
ds_read_b64_tr_b16 v[228:229], v13 offset:8192
ds_read_b64_tr_b16 v[230:231], v13 offset:10240
Mvva 132,212,136
Mvva 148,196,132
s_waitcnt lgkmcnt(10)
ds_read_b64_tr_b16 v[244:245], v13 offset:12288
ds_read_b64_tr_b16 v[246:247], v13 offset:14336
Mvva 148,212,140
Mvva 136,200,128
ds_read_b64_tr_b16 v[232:233], v14 offset:8192
ds_read_b64_tr_b16 v[234:235], v14 offset:10240
Mvva 136,216,136
Mvva 152,200,132
s_waitcnt lgkmcnt(10)
ds_read_b64_tr_b16 v[248:249], v14 offset:12288
ds_read_b64_tr_b16 v[250:251], v14 offset:14336
Mvva 152,216,140
Mvva 140,204,128
ds_read_b64_tr_b16 v[236:237], v15 offset:8192
ds_read_b64_tr_b16 v[238:239], v15 offset:10240
Mvva 140,220,136
s_waitcnt lgkmcnt(10)
Mvva 156,204,132
s_barrier
ds_read_b64_tr_b16 v[252:253], v15 offset:12288
ds_read_b64_tr_b16 v[254:255], v15 offset:14336
Mvva 156,220,140
Mvva 128,224,144
ds_read_b64_tr_b16 v[192:193], v12 offset:16384
ds_read_b64_tr_b16 v[194:195], v12 offset:18432
Mvva 128,240,152
Mvva 144,224,148
s_waitcnt lgkmcnt(10)
ds_read_b64_tr_b16 v[208:209], v12 offset:20480
ds_read_b64_tr_b16 v[210:211], v12 offset:22528
Mvva 144,240,156
Mvva 132,228,144
ds_read_b64_tr_b16 v[196:197], v13 offset:16384
ds_read_b64_tr_b16 v[198:199], v13 offset:18432
Mvva 132,244,152
buffer_load_dword v17, v126, s[20:23], s24 offen sc1
Mvva 148,228,148
s_waitcnt lgkmcnt(10)
ds_read_b64_tr_b16 v[212:213], v13 offset:20480
ds_read_b64_tr_b16 v[214:215], v13 offset:22528
Mvva 148,244,156
Mvva 136,232,144
ds_read_b64_tr_b16 v[200:201], v14 offset:16384
ds_read_b64_tr_b16 v[202:203], v14 offset:18432
Mvva 136,248,152
Mvva 152,232,148
s_waitcnt lgkmcnt(10)
ds_read_b64_tr_b16 v[216:217], v14 offset:20480
ds_read_b64_tr_b16 v[218:219], v14 offset:22528
Mvva 152,248,156
Mvva 140,236,144
ds_read_b64_tr_b16 v[204:205], v15 offset:16384
ds_read_b64_tr_b16 v[206:207], v15 offset:18432
Mvva 140,252,152
Mvva 156,236,148
s_waitcnt lgkmcnt(10)
ds_read_b64_tr_b16 v[220:221], v15 offset:20480
ds_read_b64_tr_b16 v[222:223], v15 offset:22528
Mvva 156,252,156
Mvva 128,192,160
ds_read_b64_tr_b16 v[224:225], v12 offset:24576
ds_read_b64_tr_b16 v[226:227], v12 offset:26624
Mvva 128,208,168
Mvva 144,192,164
s_waitcnt lgkmcnt(10)
ds_read_b64_tr_b16 v[240:241], v12 offset:28672
ds_read_b64_tr_b16 v[242:243], v12 offset:30720
Mvva 144,208,172
Mvva 132,196,160
ds_read_b64_tr_b16 v[228:229], v13 offset:24576
ds_read_b64_tr_b16 v[230:231], v13 offset:26624
Mvva 132,212,168
Mvva 148,196,164
s_waitcnt lgkmcnt(10)
ds_read_b64_tr_b16 v[244:245], v13 offset:28672
ds_read_b64_tr_b16 v[246:247], v13 offset:30720
Mvva 148,212,172
Mvva 136,200,160
ds_read_b64_tr_b16 v[232:233], v14 offset:24576
ds_read_b64_tr_b16 v[234:235], v14 offset:26624
Mvva 136,216,168
Mvva 152,200,164
s_waitcnt lgkmcnt(10)
ds_read_b64_tr_b16 v[248:249], v14 offset:28672
ds_read_b64_tr_b16 v[250:251], v14 offset:30720
Mvva 152,216,172
Mvva 140,204,160
s_waitcnt vmcnt(6)
ds_read_b64_tr_b16 v[236:237], v15 offset:24576
ds_read_b64_tr_b16 v[238:239], v15 offset:26624
Mvva 140,220,168
s_waitcnt lgkmcnt(10)
Mvva 156,204,164
s_barrier
ds_read_b64_tr_b16 v[252:253], v15 offset:28672
ds_read_b64_tr_b16 v[254:255], v15 offset:30720
Mvva 156,220,172
Mvva 128,224,176
ds_read_b64_tr_b16 v[192:193], v12 offset:32768
ds_read_b64_tr_b16 v[194:195], v12 offset:34816
Mvva 128,240,184
Mvva 144,224,180
s_waitcnt lgkmcnt(10)
ds_read_b64_tr_b16 v[208:209], v12 offset:36864
ds_read_b64_tr_b16 v[210:211], v12 offset:38912
Mvva 144,240,188
Mvva 132,228,176
ds_read_b64_tr_b16 v[196:197], v13 offset:32768
ds_read_b64_tr_b16 v[198:199], v13 offset:34816
Mvva 132,244,184
Mvva 148,228,180
s_waitcnt lgkmcnt(10)
ds_read_b64_tr_b16 v[212:213], v13 offset:36864
ds_read_b64_tr_b16 v[214:215], v13 offset:38912
Mvva 148,244,188
Mvva 136,232,176
ds_read_b64_tr_b16 v[200:201], v14 offset:32768
ds_read_b64_tr_b16 v[202:203], v14 offset:34816
Mvva 136,248,184
Mvva 152,232,180
s_waitcnt lgkmcnt(10)
ds_read_b64_tr_b16 v[216:217], v14 offset:36864
ds_read_b64_tr_b16 v[218:219], v14 offset:38912
Mvva 152,248,188
s_waitcnt vmcnt(0)
v_cmp_ne_u32 vcc, 1, v17
s_mov_b32 s33, 0
s_cbranch_vccnz L_xno
buffer_load_dwordx4 v[160:163], v112, s[16:19], s25 offen offset:0 sc1
buffer_load_dwordx4 v[164:167], v112, s[16:19], s25 offen offset:1024 sc1
buffer_load_dwordx4 v[168:171], v112, s[16:19], s25 offen offset:2048 sc1
buffer_load_dwordx4 v[172:175], v112, s[16:19], s25 offen offset:3072 sc1
buffer_load_dwordx4 v[176:179], v10, s[16:19], s25 offen offset:0 sc1
buffer_load_dwordx4 v[180:183], v10, s[16:19], s25 offen offset:1024 sc1
buffer_load_dwordx4 v[184:187], v10, s[16:19], s25 offen offset:2048 sc1
buffer_load_dwordx4 v[188:191], v10, s[16:19], s25 offen offset:3072 sc1
s_mov_b32 s33, 1
L_xno:
Mvva 140,236,176
ds_read_b64_tr_b16 v[204:205], v15 offset:32768
ds_read_b64_tr_b16 v[206:207], v15 offset:34816
Mvva 140,252,184
Mvva 156,236,180
s_waitcnt lgkmcnt(10)
ds_read_b64_tr_b16 v[220:221], v15 offset:36864
ds_read_b64_tr_b16 v[222:223], v15 offset:38912
Mvva 156,252,188
Mvva 128,192,192
ds_read_b64_tr_b16 v[224:225], v12 offset:40960
ds_read_b64_tr_b16 v[226:227], v12 offset:43008
Mvva 128,208,200
Mvva 144,192,196
s_waitcnt lgkmcnt(10)
ds_read_b64_tr_b16 v[240:241], v12 offset:45056
ds_read_b64_tr_b16 v[242:243], v12 offset:47104
Mvva 144,208,204
Mvva 132,196,192
ds_read_b64_tr_b16 v[228:229], v13 offset:40960
ds_read_b64_tr_b16 v[230:231], v13 offset:43008
Mvva 132,212,200
Mvva 148,196,196
s_waitcnt lgkmcnt(10)
ds_read_b64_tr_b16 v[244:245], v13 offset:45056
ds_read_b64_tr_b16 v[246:247], v13 offset:47104
Mvva 148,212,204
Mvva 136,200,192
ds_read_b64_tr_b16 v[232:233], v14 offset:40960
ds_read_b64_tr_b16 v[234:235], v14 offset:43008
Mvva 136,216,200
Mvva 152,200,196
s_waitcnt lgkmcnt(10)
ds_read_b64_tr_b16 v[248:249], v14 offset:45056
ds_read_b64_tr_b16 v[250:251], v14 offset:47104
Mvva 152,216,204
Mvva 140,204,192
ds_read_b64_tr_b16 v[236:237], v15 offset:40960
ds_read_b64_tr_b16 v[238:239], v15 offset:43008
Mvva 140,220,200
s_waitcnt lgkmcnt(10)
Mvva 156,204,196
s_barrier
ds_read_b64_tr_b16 v[252:253], v15 offset:45056
ds_read_b64_tr_b16 v[254:255], v15 offset:47104
Mvva 156,220,204
Mvva 128,224,208
ds_read_b64_tr_b16 v[192:193], v12 offset:49152
ds_read_b64_tr_b16 v[194:195], v12 offset:51200
Mvva 128,240,216
Mvva 144,224,212
s_waitcnt lgkmcnt(10)
ds_read_b64_tr_b16 v[208:209], v12 offset:53248
ds_read_b64_tr_b16 v[210:211], v12 offset:55296
Mvva 144,240,220
Mvva 132,228,208
ds_read_b64_tr_b16 v[196:197], v13 offset:49152
ds_read_b64_tr_b16 v[198:199], v13 offset:51200
Mvva 132,244,216
Mvva 148,228,212
s_waitcnt lgkmcnt(10)
ds_read_b64_tr_b16 v[212:213], v13 offset:53248
ds_read_b64_tr_b16 v[214:215], v13 offset:55296
Mvva 148,244,220
Mvva 136,232,208
ds_read_b64_tr_b16 v[200:201], v14 offset:49152
ds_read_b64_tr_b16 v[202:203], v14 offset:51200
Mvva 136,248,216
Mvva 152,232,212
s_waitcnt lgkmcnt(10)
ds_read_b64_tr_b16 v[216:217], v14 offset:53248
ds_read_b64_tr_b16 v[218:219], v14 offset:55296
Mvva 152,248,220
Mvva 140,236,208
ds_read_b64_tr_b16 v[204:205], v15 offset:49152
ds_read_b64_tr_b16 v[206:207], v15 offset:51200
Mvva 140,252,216
Mvva 156,236,212
s_waitcnt lgkmcnt(10)
ds_read_b64_tr_b16 v[220:221], v15 offset:53248
ds_read_b64_tr_b16 v[222:223], v15 offset:55296
Mvva 156,252,220
Mvva 128,192,224
ds_read_b64_tr_b16 v[224:225], v12 offset:57344
ds_read_b64_tr_b16 v[226:227], v12 offset:59392
Mvva 128,208,232
Mvva 144,192,228
s_waitcnt lgkmcnt(10)
ds_read_b64_tr_b16 v[240:241], v12 offset:61440
ds_read_b64_tr_b16 v[242:243], v12 offset:63488
Mvva 144,208,236
Mvva 132,196,224
ds_read_b64_tr_b16 v[228:229], v13 offset:57344
ds_read_b64_tr_b16 v[230:231], v13 offset:59392
Mvva 132,212,232
Mvva 148,196,228
s_waitcnt lgkmcnt(10)
ds_read_b64_tr_b16 v[244:245], v13 offset:61440
ds_read_b64_tr_b16 v[246:247], v13 offset:63488
Mvva 148,212,236
Mvva 136,200,224
ds_read_b64_tr_b16 v[232:233], v14 offset:57344
ds_read_b64_tr_b16 v[234:235], v14 offset:59392
Mvva 136,216,232
Mvva 152,200,228
s_waitcnt lgkmcnt(10)
ds_read_b64_tr_b16 v[248:249], v14 offset:61440
ds_read_b64_tr_b16 v[250:251], v14 offset:63488
Mvva 152,216,236
Mvva 140,204,224
ds_read_b64_tr_b16 v[236:237], v15 offset:57344
ds_read_b64_tr_b16 v[238:239], v15 offset:59392
Mvva 140,220,232
s_waitcnt lgkmcnt(10)
Mvva 156,204,228
ds_read_b64_tr_b16 v[252:253], v15 offset:61440
ds_read_b64_tr_b16 v[254:255], v15 offset:63488
Mvva 156,220,236
Mvva 128,224,240
Mvva 128,240,248
Mvva 144,224,244
s_waitcnt lgkmcnt(8)
Mvva 144,240,252
Mvva 132,228,240
Mvva 132,244,248
Mvva 148,228,244
s_waitcnt lgkmcnt(4)
Mvva 148,244,252
Mvva 136,232,240
Mvva 136,248,248
Mvva 152,232,244
s_waitcnt lgkmcnt(0)
Mvva 152,248,252
Mvva 140,236,240
Mvva 140,252,248
Mvva 156,236,244
Mvva 156,252,252
s_cmp_lg_u32 s53, s40
s_cbranch_scc1 L_ysl
L_yslr:
v_and_b32 v124, 15, v0
v_lshlrev_b32 v74, 8, v124
v_add_u32 v74, s35, v74
v_xor_b32 v124, v124, v121
v_lshl_add_u32 v74, v124, 4, v74
v_xor_b32_e64 v75, 64, v74
v_xor_b32 v76, 128, v74
v_xor_b32 v77, 192, v74
v_lshlrev_b32 v125, 1, v122
v_xor_b32 v124, v123, v125
v_lshlrev_b32 v12, 8, v123
v_add_u32 v12, s35, v12
v_lshl_add_u32 v12, v124, 4, v12
v_xor_b32_e64 v13, 16, v12
v_xor_b32 v14, 128, v12
v_xor_b32 v15, 144, v12
s_cmp_eq_u32 s33, 0
s_cbranch_scc1 L_spinX
L_spinXr:
v_lshlrev_b32_e64 v80, 16, v18
v_and_b32 v81, 0xffff0000, v18
v_lshlrev_b32_e64 v82, 16, v19
v_and_b32 v83, 0xffff0000, v19
v_lshlrev_b32_e64 v84, 16, v20
v_and_b32 v85, 0xffff0000, v20
v_lshlrev_b32_e64 v86, 16, v21
v_and_b32 v87, 0xffff0000, v21
v_lshlrev_b32_e64 v88, 16, v22
v_and_b32 v89, 0xffff0000, v22
v_lshlrev_b32_e64 v90, 16, v23
v_and_b32 v91, 0xffff0000, v23
v_lshlrev_b32_e64 v92, 16, v24
v_and_b32 v93, 0xffff0000, v24
v_lshlrev_b32_e64 v94, 16, v25
v_and_b32 v95, 0xffff0000, v25
v_lshlrev_b32_e64 v96, 16, v26
v_and_b32 v97, 0xffff0000, v26
v_lshlrev_b32_e64 v98, 16, v27
v_and_b32 v99, 0xffff0000, v27
v_lshlrev_b32_e64 v100, 16, v28
v_and_b32 v101, 0xffff0000, v28
v_lshlrev_b32_e64 v102, 16, v29
v_and_b32 v103, 0xffff0000, v29
v_lshlrev_b32_e64 v104, 16, v30
v_and_b32 v105, 0xffff0000, v30
v_lshlrev_b32_e64 v106, 16, v31
v_and_b32 v107, 0xffff0000, v31
v_lshlrev_b32_e64 v108, 16, v32
v_and_b32 v109, 0xffff0000, v32
v_lshlrev_b32_e64 v110, 16, v33
v_and_b32 v111, 0xffff0000, v33
s_waitcnt vmcnt(0)
s_nop 0
v_pk_add_f32 v[128:129], v[128:129], v[160:161]
v_pk_add_f32 v[130:131], v[130:131], v[162:163]
ds_write_b128 v74, v[128:131] offset:0
v_pk_add_f32 v[132:133], v[132:133], v[164:165]
v_pk_add_f32 v[134:135], v[134:135], v[166:167]
ds_write_b128 v75, v[132:135] offset:0
v_pk_add_f32 v[136:137], v[136:137], v[168:169]
v_pk_add_f32 v[138:139], v[138:139], v[170:171]
ds_write_b128 v76, v[136:139] offset:0
v_pk_add_f32 v[140:141], v[140:141], v[172:173]
v_pk_add_f32 v[142:143], v[142:143], v[174:175]
ds_write_b128 v77, v[140:143] offset:0
v_pk_add_f32 v[144:145], v[144:145], v[176:177]
v_pk_add_f32 v[146:147], v[146:147], v[178:179]
ds_write_b128 v74, v[144:147] offset:4096
v_pk_add_f32 v[148:149], v[148:149], v[180:181]
v_pk_add_f32 v[150:151], v[150:151], v[182:183]
ds_write_b128 v75, v[148:151] offset:4096
v_pk_add_f32 v[152:153], v[152:153], v[184:185]
v_pk_add_f32 v[154:155], v[154:155], v[186:187]
ds_write_b128 v76, v[152:155] offset:4096
v_pk_add_f32 v[156:157], v[156:157], v[188:189]
v_pk_add_f32 v[158:159], v[158:159], v[190:191]
ds_write_b128 v77, v[156:159] offset:4096
Rv 192,12,0
Rv 196,13,0
Rv 200,14,2048
Rv 204,15,2048
Rv 208,12,4096
Rv 212,13,4096
Rv 216,14,6144
s_waitcnt lgkmcnt(9)
Rv 220,15,6144
s_waitcnt lgkmcnt(6)
Vc 224,192,193
v_lshlrev_b32_e64 v192, 16, v224
v_and_b32 v193, 0xffff0000, v224
Vc 225,194,195
v_lshlrev_b32_e64 v194, 16, v225
v_and_b32 v195, 0xffff0000, v225
Vc 226,196,197
v_lshlrev_b32_e64 v196, 16, v226
v_and_b32 v197, 0xffff0000, v226
Vc 227,198,199
v_lshlrev_b32_e64 v198, 16, v227
v_and_b32 v199, 0xffff0000, v227
v_pk_mul_f32 v[192:193], v[192:193], v[42:43]
v_pk_mul_f32 v[194:195], v[194:195], v[44:45]
v_pk_mul_f32 v[196:197], v[196:197], v[46:47]
v_pk_mul_f32 v[198:199], v[198:199], v[48:49]
Vc 224,192,193
v_lshlrev_b32_e64 v192, 16, v224
v_and_b32 v193, 0xffff0000, v224
Vc 225,194,195
v_lshlrev_b32_e64 v194, 16, v225
v_and_b32 v195, 0xffff0000, v225
Vc 226,196,197
v_lshlrev_b32_e64 v196, 16, v226
v_and_b32 v197, 0xffff0000, v226
Vc 227,198,199
v_lshlrev_b32_e64 v198, 16, v227
v_and_b32 v199, 0xffff0000, v227
v_pk_add_f32 v[192:193], v[192:193], v[80:81]
v_pk_add_f32 v[194:195], v[194:195], v[82:83]
v_pk_add_f32 v[196:197], v[196:197], v[84:85]
v_pk_add_f32 v[198:199], v[198:199], v[86:87]
Vc 224,192,193
Vc 225,194,195
Vc 226,196,197
Vc 227,198,199
buffer_store_dwordx4 v[224:227], v119, s[68:71], s36 offen sc1
s_add_u32 s36, s36, 16384
s_waitcnt lgkmcnt(4)
Vc 228,200,201
v_lshlrev_b32 v200, 16, v228
v_and_b32 v201, 0xffff0000, v228
Vc 229,202,203
v_lshlrev_b32_e64 v202, 16, v229
v_and_b32 v203, 0xffff0000, v229
Vc 230,204,205
v_lshlrev_b32_e64 v204, 16, v230
v_and_b32 v205, 0xffff0000, v230
Vc 231,206,207
v_lshlrev_b32_e64 v206, 16, v231
v_and_b32 v207, 0xffff0000, v231
v_pk_mul_f32 v[200:201], v[200:201], v[50:51]
v_pk_mul_f32 v[202:203], v[202:203], v[52:53]
v_pk_mul_f32 v[204:205], v[204:205], v[54:55]
v_pk_mul_f32 v[206:207], v[206:207], v[56:57]
Vc 228,200,201
v_lshlrev_b32_e64 v200, 16, v228
v_and_b32 v201, 0xffff0000, v228
Vc 229,202,203
v_lshlrev_b32_e64 v202, 16, v229
v_and_b32 v203, 0xffff0000, v229
Vc 230,204,205
v_lshlrev_b32_e64 v204, 16, v230
v_and_b32 v205, 0xffff0000, v230
Vc 231,206,207
v_lshlrev_b32_e64 v206, 16, v231
v_and_b32 v207, 0xffff0000, v231
v_pk_add_f32 v[200:201], v[200:201], v[88:89]
v_pk_add_f32 v[202:203], v[202:203], v[90:91]
v_pk_add_f32 v[204:205], v[204:205], v[92:93]
v_pk_add_f32 v[206:207], v[206:207], v[94:95]
Vc 228,200,201
Vc 229,202,203
Vc 230,204,205
Vc 231,206,207
buffer_store_dwordx4 v[228:231], v119, s[68:71], s36 offen sc1
s_add_u32 s36, s36, 16384
s_waitcnt lgkmcnt(2)
Vc 232,208,209
v_lshlrev_b32 v208, 16, v232
v_and_b32 v209, 0xffff0000, v232
Vc 233,210,211
v_lshlrev_b32_e64 v210, 16, v233
v_and_b32 v211, 0xffff0000, v233
Vc 234,212,213
v_lshlrev_b32_e64 v212, 16, v234
v_and_b32 v213, 0xffff0000, v234
Vc 235,214,215
v_lshlrev_b32_e64 v214, 16, v235
v_and_b32 v215, 0xffff0000, v235
v_pk_mul_f32 v[208:209], v[208:209], v[58:59]
v_pk_mul_f32 v[210:211], v[210:211], v[60:61]
v_pk_mul_f32 v[212:213], v[212:213], v[62:63]
v_pk_mul_f32 v[214:215], v[214:215], v[64:65]
Vc 232,208,209
v_lshlrev_b32_e64 v208, 16, v232
v_and_b32 v209, 0xffff0000, v232
Vc 233,210,211
v_lshlrev_b32_e64 v210, 16, v233
v_and_b32 v211, 0xffff0000, v233
Vc 234,212,213
v_lshlrev_b32_e64 v212, 16, v234
v_and_b32 v213, 0xffff0000, v234
Vc 235,214,215
v_lshlrev_b32_e64 v214, 16, v235
v_and_b32 v215, 0xffff0000, v235
v_pk_add_f32 v[208:209], v[208:209], v[96:97]
v_pk_add_f32 v[210:211], v[210:211], v[98:99]
v_pk_add_f32 v[212:213], v[212:213], v[100:101]
v_pk_add_f32 v[214:215], v[214:215], v[102:103]
Vc 232,208,209
Vc 233,210,211
Vc 234,212,213
Vc 235,214,215
buffer_store_dwordx4 v[232:235], v119, s[68:71], s36 offen sc1
s_add_u32 s36, s36, 16384
s_waitcnt lgkmcnt(0)
Vc 236,216,217
v_lshlrev_b32 v216, 16, v236
v_and_b32 v217, 0xffff0000, v236
Vc 237,218,219
v_lshlrev_b32_e64 v218, 16, v237
v_and_b32 v219, 0xffff0000, v237
Vc 238,220,221
v_lshlrev_b32_e64 v220, 16, v238
v_and_b32 v221, 0xffff0000, v238
Vc 239,222,223
v_lshlrev_b32_e64 v222, 16, v239
v_and_b32 v223, 0xffff0000, v239
v_pk_mul_f32 v[216:217], v[216:217], v[66:67]
v_pk_mul_f32 v[218:219], v[218:219], v[68:69]
v_pk_mul_f32 v[220:221], v[220:221], v[70:71]
v_pk_mul_f32 v[222:223], v[222:223], v[72:73]
Vc 236,216,217
v_lshlrev_b32_e64 v216, 16, v236
v_and_b32 v217, 0xffff0000, v236
Vc 237,218,219
v_lshlrev_b32_e64 v218, 16, v237
v_and_b32 v219, 0xffff0000, v237
Vc 238,220,221
v_lshlrev_b32_e64 v220, 16, v238
v_and_b32 v221, 0xffff0000, v238
Vc 239,222,223
v_lshlrev_b32_e64 v222, 16, v239
v_and_b32 v223, 0xffff0000, v239
v_pk_add_f32 v[216:217], v[216:217], v[104:105]
v_pk_add_f32 v[218:219], v[218:219], v[106:107]
v_pk_add_f32 v[220:221], v[220:221], v[108:109]
v_pk_add_f32 v[222:223], v[222:223], v[110:111]
Vc 236,216,217
Vc 237,218,219
Vc 238,220,221
Vc 239,222,223
buffer_store_dwordx4 v[236:239], v119, s[68:71], s36 offen sc1
L_k2_end:
s_endpgm
L_spinC:
s_add_u32 m0, s35, 0
s_nop 0
s_nop 0
buffer_load_dwordx4 v125, s[60:63], s48 offen offset:0 lds
buffer_load_dwordx4 v125, s[60:63], s49 offen offset:1024 lds
buffer_load_dwordx4 v125, s[60:63], s50 offen offset:2048 lds
buffer_load_dwordx4 v125, s[60:63], s51 offen offset:3072 lds
v_add_u32 v125, 65536, v125
s_add_u32 m0, s35, 4096
s_nop 0
buffer_load_dwordx4 v125, s[60:63], s48 offen offset:0 lds
buffer_load_dwordx4 v125, s[60:63], s49 offen offset:1024 lds
buffer_load_dwordx4 v125, s[60:63], s50 offen offset:2048 lds
buffer_load_dwordx4 v125, s[60:63], s51 offen offset:3072 lds
s_mov_b32 s40, 1
s_mov_b32 s47, 0x400000
L_spinC_l:
buffer_load_dword v124, v10, s[20:23], s38 offen sc1
s_sub_u32 s47, s47, 1
s_waitcnt vmcnt(0)
s_cmp_eq_u32 s47, 0
s_cbranch_scc1 L_spinC_lx
v_cmp_ne_u32 vcc, 1, v124
s_cbranch_vccz L_spinC_lx
s_sleep 4
s_branch L_spinC_l
L_spinC_lx:
s_branch L_spinCr
L_c31:
s_bfe_u32 s3, s2, 0x40003
s_lshl_b32 s3, s3, 2
s_add_u32 s3, s3, s32
s_lshl_b32 s3, s3, 15
s_and_b32 s7, s2, 1
s_lshl_b32 s7, s7, 22
s_add_u32 s3, s3, s7
s_add_u32 s3, s3, 2097536
v_and_b32 v1, 15, v0
v_lshlrev_b32 v1, 11, v1
v_lshrrev_b32 v11, 5, v0
v_lshl_add_u32 v1, v11, 10, v1
buffer_load_dword v11, v1, s[28:31], s3 offen
s_branch L_c31r
L_f2A:
s_lshr_b32 s5, s54, 1
s_lshl_b32 s5, s5, 5
s_add_u32 s5, s5, 5447680
buffer_load_dword v125, v127, s[20:23], s5 offen sc1
s_branch L_f2Ar
L_f2B:
s_waitcnt vmcnt(16)
v_cmp_ne_u32 vcc, 1, v125
s_cbranch_vccz L_f2lx
s_mov_b32 s47, 0x400000
L_f2l:
buffer_load_dword v125, v127, s[20:23], s5 offen sc1
s_sub_u32 s47, s47, 1
s_waitcnt vmcnt(0)
s_cmp_eq_u32 s47, 0
s_cbranch_scc1 L_f2lx
v_cmp_ne_u32 vcc, 1, v125
s_cbranch_vccz L_f2lx
s_sleep 8
s_branch L_f2l
L_f2lx:
s_lshl_b32 s3, s54, 8
s_add_u32 s3, s3, 6291456
v_mul_u32_u24 v124, 14336, v121
v_and_b32_e64 v125, 15, v0
v_lshl_add_u32 v124, v125, 4, v124
buffer_load_dwordx4 v[74:77], v124, s[20:23], s3 offen sc1
s_add_u32 s3, s3, 57344
buffer_load_dwordx4 v[78:81], v124, s[20:23], s3 offen sc1
s_add_u32 s3, s3, 57344
buffer_load_dwordx4 v[82:85], v124, s[20:23], s3 offen sc1
s_add_u32 s3, s3, 57344
buffer_load_dwordx4 v[86:89], v124, s[20:23], s3 offen sc1
s_add_u32 s3, s3, 57344
buffer_load_dwordx4 v[90:93], v124, s[20:23], s3 offen sc1
s_add_u32 s3, s3, 57344
buffer_load_dwordx4 v[94:97], v124, s[20:23], s3 offen sc1
s_add_u32 s3, s3, 57344
buffer_load_dwordx4 v[98:101], v124, s[20:23], s3 offen sc1
s_add_u32 s3, s3, 57344
buffer_load_dwordx4 v[102:105], v124, s[20:23], s3 offen sc1
s_branch L_f2Br
L_f2C:
v_add_u32 v106, s35, v115
v_add_u32 v107, s35, v116
v_add_u32 v108, s35, v117
v_add_u32 v109, s35, v118
s_waitcnt vmcnt(16) lgkmcnt(0)
v_pk_add_f32 v[74:75], v[74:75], v[78:79]
v_pk_add_f32 v[76:77], v[76:77], v[80:81]
v_pk_add_f32 v[74:75], v[74:75], v[82:83]
v_pk_add_f32 v[76:77], v[76:77], v[84:85]
v_pk_add_f32 v[74:75], v[74:75], v[86:87]
v_pk_add_f32 v[76:77], v[76:77], v[88:89]
v_pk_add_f32 v[74:75], v[74:75], v[90:91]
v_pk_add_f32 v[76:77], v[76:77], v[92:93]
v_pk_add_f32 v[74:75], v[74:75], v[94:95]
v_pk_add_f32 v[76:77], v[76:77], v[96:97]
v_pk_add_f32 v[74:75], v[74:75], v[98:99]
v_pk_add_f32 v[76:77], v[76:77], v[100:101]
v_pk_add_f32 v[74:75], v[74:75], v[102:103]
v_pk_add_f32 v[76:77], v[76:77], v[104:105]
Vc 125,74,75
v_lshlrev_b32_e64 v74, 16, v125
v_and_b32 v75, 0xffff0000, v125
Vc 125,76,77
v_lshlrev_b32_e64 v76, 16, v125
v_and_b32 v77, 0xffff0000, v125
v_mov_b32 v82, v74
v_mov_b32 v83, v75
v_mov_b32 v84, v76
v_mov_b32 v85, v77
v_permlane32_swap_b32 v82, v74
v_permlane32_swap_b32 v83, v75
v_permlane32_swap_b32 v84, v76
v_permlane32_swap_b32 v85, v77
v_mul_f32 v90, 0xbfb8aa3b, v82
v_mul_f32 v91, 0xbfb8aa3b, v83
v_mul_f32 v92, 0xbfb8aa3b, v84
v_mul_f32 v93, 0xbfb8aa3b, v85
Ve 90,90
Ve 91,91
Ve 92,92
Ve 93,93
v_add_f32 v90, 1.0, v90
v_add_f32 v91, 1.0, v91
v_add_f32 v92, 1.0, v92
v_add_f32 v93, 1.0, v93
v_rcp_f32 v90, v90
v_rcp_f32 v91, v91
v_rcp_f32 v92, v92
v_rcp_f32 v93, v93
Vm 82,82,90
Vm 83,83,91
Vm 84,84,92
Vm 85,85,93
Vc 125,82,83
v_lshlrev_b32_e64 v82, 16, v125
v_and_b32 v83, 0xffff0000, v125
Vc 125,84,85
v_lshlrev_b32_e64 v84, 16, v125
v_and_b32 v85, 0xffff0000, v125
Vm 74,74,82
Vm 75,75,83
Vm 76,76,84
Vm 77,77,85
Vc 90,74,75
Vc 91,76,77
v_and_b32 v124, 1, v121
v_lshlrev_b32 v124, 8, v124
v_and_b32_e64 v125, 15, v0
v_lshl_add_u32 v124, v125, 3, v124
v_add_u32_e64 v124, s35, v124
ds_read_b64_tr_b16 v[74:75], v106 offset:0
ds_read_b64_tr_b16 v[76:77], v106 offset:2048
ds_read_b64_tr_b16 v[78:79], v107 offset:0
ds_read_b64_tr_b16 v[80:81], v107 offset:2048
ds_read_b64_tr_b16 v[82:83], v108 offset:0
ds_read_b64_tr_b16 v[84:85], v108 offset:2048
ds_read_b64_tr_b16 v[86:87], v109 offset:0
ds_read_b64_tr_b16 v[88:89], v109 offset:2048
ds_write_b64 v124, v[90:91]
v_and_b32 v124, 1, v0
v_lshlrev_b32 v124, 8, v124
v_lshl_add_u32 v125, v121, 3, v124
v_add_u32_e64 v125, s35, v125
ds_read_b64 v[90:91], v125 offset:0
ds_read_b64 v[92:93], v125 offset:32
ds_read_b64 v[94:95], v125 offset:64
ds_read_b64 v[96:97], v125 offset:96
v_lshl_add_u32 v124, v121, 4, v124
v_add_u32 v124, s35, v124
s_waitcnt lgkmcnt(0)
Zvvv 98,74,90
ds_read_b64_tr_b16 v[74:75], v106 offset:4096
ds_read_b64_tr_b16 v[76:77], v106 offset:6144
Zvvv 102,78,90
ds_read_b64_tr_b16 v[78:79], v107 offset:4096
ds_read_b64_tr_b16 v[80:81], v107 offset:6144
s_waitcnt lgkmcnt(0)
Mvvv 98,74,94
Mvvv 102,78,94
s_nop 6
ds_write_b128 v124, v[98:101] offset:2048
ds_write_b128 v124, v[102:105] offset:2112
s_waitcnt lgkmcnt(0)
Zvvv 98,82,90
ds_read_b64_tr_b16 v[82:83], v108 offset:4096
ds_read_b64_tr_b16 v[84:85], v108 offset:6144
Zvvv 102,86,90
ds_read_b64_tr_b16 v[86:87], v109 offset:4096
ds_read_b64_tr_b16 v[88:89], v109 offset:6144
s_waitcnt lgkmcnt(0)
Mvvv 98,82,94
Mvvv 102,86,94
s_nop 6
ds_write_b128 v124, v[98:101] offset:2176
ds_write_b128 v124, v[102:105] offset:2240
s_waitcnt lgkmcnt(0)
s_barrier
s_cmp_lg_u32 s32, 0
s_cbranch_scc1 L_f2Cr
v_lshlrev_b32 v124, 3, v0
v_add_u32 v125, 133120, v124
ds_read_b64 v[74:75], v125 offset:0
ds_read_b64 v[76:77], v125 offset:8192
ds_read_b64 v[78:79], v125 offset:16384
ds_read_b64 v[80:81], v125 offset:24576
s_lshl_b32 s3, s39, 4
s_add_u32 s3, s3, s37
s_lshl_b32 s3, s3, 9
s_add_u32 s3, s3, 5308416
s_waitcnt lgkmcnt(0)
v_pk_add_f32 v[74:75], v[74:75], v[76:77]
v_pk_add_f32 v[78:79], v[78:79], v[80:81]
v_pk_add_f32 v[74:75], v[74:75], v[78:79]
buffer_store_dwordx2 v[74:75], v124, s[20:23], s3 offen sc1
s_branch L_f2Cr
L_f2E:
s_cmp_lg_u32 s32, 0
s_cbranch_scc1 L_f2Er
v_mov_b32 v125, 1
s_lshl_b32 s3, s39, 5
s_add_u32 s3, s3, s37
s_lshl_b32 s3, s3, 2
s_add_u32 s3, s3, 5449728
s_waitcnt vmcnt(16)
s_mov_b64 exec, 1
buffer_store_dword v125, v126, s[20:23], s3 offen sc1
s_mov_b64 exec, -1
s_branch L_f2Er
L_yA:
v_min_u32 v127, 13, v0
v_lshlrev_b32_e64 v127, 2, v127
buffer_load_dword v74, v127, s[20:23], s41 offen sc1
s_branch L_yAr
L_yB:
s_waitcnt vmcnt(6)
v_cmp_ne_u32 vcc, 1, v74
s_cbranch_vccnz L_yBr
s_mov_b32 s40, 1
v_lshlrev_b32 v124, 2, v0
v_lshlrev_b32 v125, 1, v0
s_lshl_b32 s7, s45, 2
s_add_u32 s7, s7, s32
s_lshr_b32 s3, s42, 5
s_cmp_lg_u32 s3, s7
s_cbranch_scc1 L_f_yl1
s_add_u32 s3, s55, 0
s_nop 0
s_add_u32 s7, s3, 4096
buffer_load_dword v76, v124, s[20:23], s3 offen offset:0 sc1
buffer_load_dword v77, v124, s[20:23], s3 offen offset:512 sc1
buffer_load_dword v78, v124, s[20:23], s3 offen offset:1024 sc1
buffer_load_dword v79, v124, s[20:23], s3 offen offset:1536 sc1
buffer_load_dword v80, v124, s[20:23], s3 offen offset:2048 sc1
buffer_load_dword v81, v124, s[20:23], s3 offen offset:2560 sc1
buffer_load_dword v82, v124, s[20:23], s3 offen offset:3072 sc1
buffer_load_dword v83, v124, s[20:23], s3 offen offset:3584 sc1
buffer_load_dword v84, v124, s[20:23], s7 offen offset:0 sc1
buffer_load_dword v85, v124, s[20:23], s7 offen offset:512 sc1
buffer_load_dword v86, v124, s[20:23], s7 offen offset:1024 sc1
buffer_load_dword v87, v124, s[20:23], s7 offen offset:1536 sc1
buffer_load_dword v88, v124, s[20:23], s7 offen offset:2048 sc1
buffer_load_dword v89, v124, s[20:23], s7 offen offset:2560 sc1
s_lshl_b32 s3, s42, 11
s_lshl_b32 s7, s46, 7
s_add_u32 s3, s3, s7
buffer_load_ushort v90, v125, s[56:59], s3 offen
s_lshl_b32 s3, s42, 3
s_add_u32 s3, s3, 5259264
buffer_load_dwordx2 v[92:93], v126, s[20:23], s3 offen sc1
L_f_yl1:
s_lshl_b32 s7, s45, 2
s_add_u32 s7, s7, s32
s_lshr_b32 s3, s43, 5
s_cmp_lg_u32 s3, s7
s_cbranch_scc1 L_f_yl2
s_nop 0
s_add_u32 s3, s55, 256
s_add_u32 s7, s3, 4096
buffer_load_dword v94, v124, s[20:23], s3 offen offset:0 sc1
buffer_load_dword v95, v124, s[20:23], s3 offen offset:512 sc1
buffer_load_dword v96, v124, s[20:23], s3 offen offset:1024 sc1
buffer_load_dword v97, v124, s[20:23], s3 offen offset:1536 sc1
buffer_load_dword v98, v124, s[20:23], s3 offen offset:2048 sc1
buffer_load_dword v99, v124, s[20:23], s3 offen offset:2560 sc1
buffer_load_dword v100, v124, s[20:23], s3 offen offset:3072 sc1
buffer_load_dword v101, v124, s[20:23], s3 offen offset:3584 sc1
buffer_load_dword v102, v124, s[20:23], s7 offen offset:0 sc1
buffer_load_dword v103, v124, s[20:23], s7 offen offset:512 sc1
buffer_load_dword v104, v124, s[20:23], s7 offen offset:1024 sc1
buffer_load_dword v105, v124, s[20:23], s7 offen offset:1536 sc1
buffer_load_dword v106, v124, s[20:23], s7 offen offset:2048 sc1
buffer_load_dword v107, v124, s[20:23], s7 offen offset:2560 sc1
s_lshl_b32 s3, s43, 11
s_lshl_b32 s7, s46, 7
s_add_u32 s3, s3, s7
buffer_load_ushort v108, v125, s[56:59], s3 offen
s_lshl_b32 s3, s43, 3
s_add_u32 s3, s3, 5259264
buffer_load_dwordx2 v[110:111], v126, s[20:23], s3 offen sc1
L_f_yl2:
s_branch L_yBr
L_yC:
s_waitcnt vmcnt(4)
s_lshl_b32 s7, s45, 2
s_add_u32 s7, s7, s32
s_lshr_b32 s3, s42, 5
s_cmp_lg_u32 s3, s7
s_cbranch_scc1 L_f_ys3
s_nop 0
v_pk_add_f32 v[76:77], v[76:77], v[78:79]
v_pk_add_f32 v[76:77], v[76:77], v[80:81]
v_pk_add_f32 v[76:77], v[76:77], v[82:83]
v_pk_add_f32 v[76:77], v[76:77], v[84:85]
v_pk_add_f32 v[76:77], v[76:77], v[86:87]
v_pk_add_f32 v[76:77], v[76:77], v[88:89]
Va 76,76,77
v_lshlrev_b32 v90, 16, v90
v_sub_f32_e64 v90, v90, v92
Vc 76,76,76
v_lshlrev_b32_e64 v76, 16, v76
Vc 90,90,90
v_lshlrev_b32 v90, 16, v90
v_mul_f32 v76, s100, v76
v_mul_f32_e64 v90, v90, v93
Vc 76,76,76
v_lshlrev_b32_e64 v76, 16, v76
Vc 90,90,90
v_lshlrev_b32 v90, 16, v90
Va 90,90,76
Vc 90,90,90
v_lshlrev_b32_e64 v90, 16, v90
v_mul_f32 v76, 0xbfb8aa3b, v90
Ve 76,76
s_nop 0
v_add_f32 v76, 1.0, v76
v_rcp_f32 v76, v76
s_nop 0
Vm 90,90,76
Vc 90,90,90
v_lshlrev_b32 v90, 16, v90
v_lshlrev_b32 v124, 2, v0
v_add_u32 v124, s35, v124
v_lshlrev_b32 v125, 5, v122
v_add_u32 v125, s35, v125
s_waitcnt lgkmcnt(0)
ds_write_b32 v124, v90
s_and_b32 s3, s42, 7
s_lshl_b32 s3, s3, 3
s_lshl_b64 s[4:5], 0xff, s3
s_bfe_u32 s3, s42, 0x20003
s_mov_b64 exec, s[4:5]
s_cmp_lg_u32 s3, 0
s_cbranch_scc1 L_f_yp4
ds_read_b64 v[42:43], v125
ds_read_b64 v[44:45], v125 offset:8
ds_read_b64 v[46:47], v125 offset:16
ds_read_b64 v[48:49], v125 offset:24
L_f_yp4:
s_cmp_lg_u32 s3, 1
s_cbranch_scc1 L_f_yp5
ds_read_b64 v[50:51], v125
ds_read_b64 v[52:53], v125 offset:8
ds_read_b64 v[54:55], v125 offset:16
ds_read_b64 v[56:57], v125 offset:24
L_f_yp5:
s_cmp_lg_u32 s3, 2
s_cbranch_scc1 L_f_yp6
ds_read_b64 v[58:59], v125
ds_read_b64 v[60:61], v125 offset:8
ds_read_b64 v[62:63], v125 offset:16
ds_read_b64 v[64:65], v125 offset:24
L_f_yp6:
s_cmp_lg_u32 s3, 3
s_cbranch_scc1 L_f_yp7
ds_read_b64 v[66:67], v125
ds_read_b64 v[68:69], v125 offset:8
s_waitcnt lgkmcnt(9)
ds_read_b64 v[70:71], v125 offset:16
ds_read_b64 v[72:73], v125 offset:24
L_f_yp7:
s_mov_b64 exec, -1
s_waitcnt lgkmcnt(0)
L_f_ys3:
s_lshl_b32 s7, s45, 2
s_add_u32 s7, s7, s32
s_lshr_b32 s3, s43, 5
s_cmp_lg_u32 s3, s7
s_cbranch_scc1 L_f_ys8
s_nop 0
v_pk_add_f32 v[94:95], v[94:95], v[96:97]
v_pk_add_f32 v[94:95], v[94:95], v[98:99]
v_pk_add_f32 v[94:95], v[94:95], v[100:101]
v_pk_add_f32 v[94:95], v[94:95], v[102:103]
v_pk_add_f32 v[94:95], v[94:95], v[104:105]
v_pk_add_f32 v[94:95], v[94:95], v[106:107]
Va 94,94,95
v_lshlrev_b32 v108, 16, v108
v_sub_f32_e64 v108, v108, v110
Vc 94,94,94
v_lshlrev_b32_e64 v94, 16, v94
Vc 108,108,108
v_lshlrev_b32 v108, 16, v108
v_mul_f32 v94, s101, v94
v_mul_f32_e64 v108, v108, v111
Vc 94,94,94
v_lshlrev_b32_e64 v94, 16, v94
Vc 108,108,108
v_lshlrev_b32 v108, 16, v108
Va 108,108,94
Vc 108,108,108
v_lshlrev_b32_e64 v108, 16, v108
v_mul_f32 v94, 0xbfb8aa3b, v108
Ve 94,94
s_nop 0
v_add_f32 v94, 1.0, v94
v_rcp_f32 v94, v94
s_nop 0
Vm 108,108,94
Vc 108,108,108
v_lshlrev_b32 v108, 16, v108
v_lshlrev_b32 v124, 2, v0
v_add_u32 v124, s35, v124
v_lshlrev_b32 v125, 5, v122
v_add_u32 v125, s35, v125
s_waitcnt lgkmcnt(0)
ds_write_b32 v124, v108
s_and_b32 s3, s43, 7
s_lshl_b32 s3, s3, 3
s_lshl_b64 s[4:5], 0xff, s3
s_bfe_u32 s3, s43, 0x20003
s_mov_b64 exec, s[4:5]
s_cmp_lg_u32 s3, 0
s_cbranch_scc1 L_f_yp9
ds_read_b64 v[42:43], v125
ds_read_b64 v[44:45], v125 offset:8
ds_read_b64 v[46:47], v125 offset:16
ds_read_b64 v[48:49], v125 offset:24
L_f_yp9:
s_cmp_lg_u32 s3, 1
s_cbranch_scc1 L_f_yp10
ds_read_b64 v[50:51], v125
ds_read_b64 v[52:53], v125 offset:8
ds_read_b64 v[54:55], v125 offset:16
ds_read_b64 v[56:57], v125 offset:24
L_f_yp10:
s_cmp_lg_u32 s3, 2
s_cbranch_scc1 L_f_yp11
ds_read_b64 v[58:59], v125
ds_read_b64 v[60:61], v125 offset:8
ds_read_b64 v[62:63], v125 offset:16
ds_read_b64 v[64:65], v125 offset:24
L_f_yp11:
s_cmp_lg_u32 s3, 3
s_cbranch_scc1 L_f_yp12
ds_read_b64 v[66:67], v125
ds_read_b64 v[68:69], v125 offset:8
s_waitcnt lgkmcnt(9)
ds_read_b64 v[70:71], v125 offset:16
ds_read_b64 v[72:73], v125 offset:24
L_f_yp12:
s_mov_b64 exec, -1
s_waitcnt lgkmcnt(0)
L_f_ys8:
s_branch L_yCr
L_p4_end:
L_spinAk:
s_mov_b32 s47, 0x400000
L_spinAk_l:
s_sleep 8
buffer_load_dword v1, v7, s[28:31], 0 offen sc1
s_waitcnt vmcnt(0)
v_readfirstlane_b32 s3, v1
s_sub_u32 s47, s47, 1
s_cmp_eq_u32 s47, 0
s_cbranch_scc1 L_spinArk
s_cmp_lt_u32 s3, 256
s_cbranch_scc1 L_spinAk_l
s_branch L_spinArk
L_spinAv:
s_mov_b32 s47, 0x400000
L_spinAv_l:
s_sleep 8
buffer_load_dword v1, v7, s[28:31], 0 offen sc1
s_waitcnt vmcnt(0)
v_readfirstlane_b32 s3, v1
s_sub_u32 s47, s47, 1
s_cmp_eq_u32 s47, 0
s_cbranch_scc1 L_spinArv
s_cmp_lt_u32 s3, 256
s_cbranch_scc1 L_spinAv_l
s_branch L_spinArv
L_spinB:
s_mov_b32 s59, 0x400000
L_spinB_l:
s_sleep 4
buffer_load_dword v12, v1, s[20:23], s6 offen sc1
s_sub_u32 s59, s59, 1
s_cmp_eq_u32 s59, 0
s_cbranch_scc1 L_spinBx
s_waitcnt vmcnt(0)
v_cmp_ne_u32 vcc, 1, v12
s_cbranch_vccnz L_spinB_l
L_spinBx:
s_waitcnt vmcnt(0)
s_branch L_spinBr
L_k2_fb_we:
s_nop 7
s_nop 0
v_max3_f32 v21, v128, v129, v130
v_max3_f32 v21, v21, v131, v132
v_max3_f32 v21, v21, v133, v134
v_max3_f32 v21, v21, v135, v136
v_max3_f32 v21, v21, v137, v138
v_max3_f32 v21, v21, v139, v140
v_max3_f32 v21, v21, v141, v142
v_max_f32 v21, v21, v143
v_mov_b32 v1, v21
s_nop 1
v_permlane16_swap_b32 v1, v21
v_max_f32 v21, v21, v1
v_mov_b32 v1, v21
s_nop 1
v_permlane32_swap_b32 v1, v21
v_max_f32_e64 v21, v21, v1
v_add_f32 v21, 0x41f80000, v21
v_max_f32 v21, 0, v21
Vs 128,128,21
Vs 129,129,21
Vs 130,130,21
Vs 131,131,21
Vs 132,132,21
Vs 133,133,21
Vs 134,134,21
Vs 135,135,21
Vs 136,136,21
Vs 137,137,21
Vs 138,138,21
Vs 139,139,21
Vs 140,140,21
Vs 141,141,21
Vs 142,142,21
Vs 143,143,21
Vs 192,192,21
Vs 193,193,21
Vs 194,194,21
Vs 195,195,21
Vs 196,196,21
Vs 197,197,21
Vs 198,198,21
Vs 199,199,21
Vs 200,200,21
Vs 201,201,21
Vs 202,202,21
Vs 203,203,21
Vs 204,204,21
Vs 205,205,21
Vs 206,206,21
Vs 207,207,21
Vs 32,32,21
Vs 33,33,21
Vs 34,34,21
v_sub_f32_e64 v35, v35, v21
v_exp_f32 v22, -v21
s_nop 0
Vm 48,48,22
Vm 49,49,22
Vm 50,50,22
v_mul_f32_e64 v51, v51, v22
Ar 8,0
Ar 9,1
Ar 10,2
Ar 11,3
Ar 12,4
Ar 13,5
Ar 14,6
Ar 15,7
Vm 8,8,22
Vm 9,9,22
Vm 10,10,22
Vm 11,11,22
Vm 12,12,22
Vm 13,13,22
Vm 14,14,22
Vm 15,15,22
Aw 0,8
Aw 1,9
Aw 2,10
Aw 3,11
Aw 4,12
Aw 5,13
Aw 6,14
Aw 7,15
Ar 8,8
Ar 9,9
Ar 10,10
Ar 11,11
Ar 12,12
Ar 13,13
Ar 14,14
Ar 15,15
Vm 8,8,22
Vm 9,9,22
Vm 10,10,22
Vm 11,11,22
Vm 12,12,22
Vm 13,13,22
Vm 14,14,22
Vm 15,15,22
Aw 8,8
Aw 9,9
Aw 10,10
Aw 11,11
Aw 12,12
Aw 13,13
Aw 14,14
Aw 15,15
Ar 8,16
Ar 9,17
Ar 10,18
Ar 11,19
Ar 12,20
Ar 13,21
Ar 14,22
Ar 15,23
Vm 8,8,22
Vm 9,9,22
Vm 10,10,22
Vm 11,11,22
Vm 12,12,22
Vm 13,13,22
Vm 14,14,22
Vm 15,15,22
Aw 16,8
Aw 17,9
Aw 18,10
Aw 19,11
Aw 20,12
Aw 21,13
Aw 22,14
Aw 23,15
Ar 8,24
Ar 9,25
Ar 10,26
Ar 11,27
Ar 12,28
Ar 13,29
Ar 14,30
Ar 15,31
Vm 8,8,22
Vm 9,9,22
Vm 10,10,22
Vm 11,11,22
Vm 12,12,22
Vm 13,13,22
Vm 14,14,22
Vm 15,15,22
Aw 24,8
Aw 25,9
Aw 26,10
Aw 27,11
Aw 28,12
Aw 29,13
Aw 30,14
Aw 31,15
v_max3_f32 v21, v144, v145, v146
v_max3_f32 v21, v21, v147, v148
v_max3_f32 v21, v21, v149, v150
v_max3_f32 v21, v21, v151, v152
v_max3_f32 v21, v21, v153, v154
v_max3_f32 v21, v21, v155, v156
v_max3_f32 v21, v21, v157, v158
v_max_f32 v21, v21, v159
v_mov_b32 v1, v21
s_nop 1
v_permlane16_swap_b32 v1, v21
v_max_f32 v21, v21, v1
v_mov_b32 v1, v21
s_nop 1
v_permlane32_swap_b32 v1, v21
v_max_f32_e64 v21, v21, v1
v_add_f32 v21, 0x41f80000, v21
v_max_f32 v21, 0, v21
Vs 144,144,21
Vs 145,145,21
Vs 146,146,21
Vs 147,147,21
Vs 148,148,21
Vs 149,149,21
Vs 150,150,21
Vs 151,151,21
Vs 152,152,21
Vs 153,153,21
Vs 154,154,21
Vs 155,155,21
Vs 156,156,21
Vs 157,157,21
Vs 158,158,21
Vs 159,159,21
Vs 208,208,21
Vs 209,209,21
Vs 210,210,21
Vs 211,211,21
Vs 212,212,21
Vs 213,213,21
Vs 214,214,21
Vs 215,215,21
Vs 216,216,21
Vs 217,217,21
Vs 218,218,21
Vs 219,219,21
Vs 220,220,21
Vs 221,221,21
Vs 222,222,21
Vs 223,223,21
Vs 36,36,21
Vs 37,37,21
Vs 38,38,21
v_sub_f32_e64 v39, v39, v21
v_exp_f32 v22, -v21
s_nop 0
Vm 52,52,22
Vm 53,53,22
Vm 54,54,22
v_mul_f32_e64 v55, v55, v22
Ar 8,32
Ar 9,33
Ar 10,34
Ar 11,35
Ar 12,36
Ar 13,37
Ar 14,38
Ar 15,39
Vm 8,8,22
Vm 9,9,22
Vm 10,10,22
Vm 11,11,22
Vm 12,12,22
Vm 13,13,22
Vm 14,14,22
Vm 15,15,22
Aw 32,8
Aw 33,9
Aw 34,10
Aw 35,11
Aw 36,12
Aw 37,13
Aw 38,14
Aw 39,15
Ar 8,40
Ar 9,41
Ar 10,42
Ar 11,43
Ar 12,44
Ar 13,45
Ar 14,46
Ar 15,47
Vm 8,8,22
Vm 9,9,22
Vm 10,10,22
Vm 11,11,22
Vm 12,12,22
Vm 13,13,22
Vm 14,14,22
Vm 15,15,22
Aw 40,8
Aw 41,9
Aw 42,10
Aw 43,11
Aw 44,12
Aw 45,13
Aw 46,14
Aw 47,15
Ar 8,48
Ar 9,49
Ar 10,50
Ar 11,51
Ar 12,52
Ar 13,53
Ar 14,54
Ar 15,55
Vm 8,8,22
Vm 9,9,22
Vm 10,10,22
Vm 11,11,22
Vm 12,12,22
Vm 13,13,22
Vm 14,14,22
Vm 15,15,22
Aw 48,8
Aw 49,9
Aw 50,10
Aw 51,11
Aw 52,12
Aw 53,13
Aw 54,14
Aw 55,15
Ar 8,56
Ar 9,57
Ar 10,58
Ar 11,59
Ar 12,60
Ar 13,61
Ar 14,62
Ar 15,63
Vm 8,8,22
Vm 9,9,22
Vm 10,10,22
Vm 11,11,22
Vm 12,12,22
Vm 13,13,22
Vm 14,14,22
Vm 15,15,22
Aw 56,8
Aw 57,9
Aw 58,10
Aw 59,11
Aw 60,12
Aw 61,13
Aw 62,14
Aw 63,15
v_max3_f32 v21, v160, v161, v162
v_max3_f32 v21, v21, v163, v164
v_max3_f32 v21, v21, v165, v166
v_max3_f32 v21, v21, v167, v168
v_max3_f32 v21, v21, v169, v170
v_max3_f32 v21, v21, v171, v172
v_max3_f32 v21, v21, v173, v174
v_max_f32 v21, v21, v175
v_mov_b32 v1, v21
s_nop 1
v_permlane16_swap_b32 v1, v21
v_max_f32 v21, v21, v1
v_mov_b32 v1, v21
s_nop 1
v_permlane32_swap_b32 v1, v21
v_max_f32_e64 v21, v21, v1
v_add_f32 v21, 0x41f80000, v21
v_max_f32 v21, 0, v21
Vs 160,160,21
Vs 161,161,21
Vs 162,162,21
Vs 163,163,21
Vs 164,164,21
Vs 165,165,21
Vs 166,166,21
Vs 167,167,21
Vs 168,168,21
Vs 169,169,21
Vs 170,170,21
Vs 171,171,21
Vs 172,172,21
Vs 173,173,21
Vs 174,174,21
Vs 175,175,21
Vs 224,224,21
Vs 225,225,21
Vs 226,226,21
Vs 227,227,21
Vs 228,228,21
Vs 229,229,21
Vs 230,230,21
Vs 231,231,21
Vs 232,232,21
Vs 233,233,21
Vs 234,234,21
Vs 235,235,21
Vs 236,236,21
Vs 237,237,21
Vs 238,238,21
Vs 239,239,21
Vs 40,40,21
Vs 41,41,21
Vs 42,42,21
v_sub_f32_e64 v43, v43, v21
v_exp_f32 v22, -v21
s_nop 0
Vm 56,56,22
Vm 57,57,22
Vm 58,58,22
v_mul_f32_e64 v59, v59, v22
Ar 8,64
Ar 9,65
Ar 10,66
Ar 11,67
Ar 12,68
Ar 13,69
Ar 14,70
Ar 15,71
Vm 8,8,22
Vm 9,9,22
Vm 10,10,22
Vm 11,11,22
Vm 12,12,22
Vm 13,13,22
Vm 14,14,22
Vm 15,15,22
Aw 64,8
Aw 65,9
Aw 66,10
Aw 67,11
Aw 68,12
Aw 69,13
Aw 70,14
Aw 71,15
Ar 8,72
Ar 9,73
Ar 10,74
Ar 11,75
Ar 12,76
Ar 13,77
Ar 14,78
Ar 15,79
Vm 8,8,22
Vm 9,9,22
Vm 10,10,22
Vm 11,11,22
Vm 12,12,22
Vm 13,13,22
Vm 14,14,22
Vm 15,15,22
Aw 72,8
Aw 73,9
Aw 74,10
Aw 75,11
Aw 76,12
Aw 77,13
Aw 78,14
Aw 79,15
Ar 8,80
Ar 9,81
Ar 10,82
Ar 11,83
Ar 12,84
Ar 13,85
Ar 14,86
Ar 15,87
Vm 8,8,22
Vm 9,9,22
Vm 10,10,22
Vm 11,11,22
Vm 12,12,22
Vm 13,13,22
Vm 14,14,22
Vm 15,15,22
Aw 80,8
Aw 81,9
Aw 82,10
Aw 83,11
Aw 84,12
Aw 85,13
Aw 86,14
Aw 87,15
Ar 8,88
Ar 9,89
Ar 10,90
Ar 11,91
Ar 12,92
Ar 13,93
Ar 14,94
Ar 15,95
Vm 8,8,22
Vm 9,9,22
Vm 10,10,22
Vm 11,11,22
Vm 12,12,22
Vm 13,13,22
Vm 14,14,22
Vm 15,15,22
Aw 88,8
Aw 89,9
Aw 90,10
Aw 91,11
Aw 92,12
Aw 93,13
Aw 94,14
Aw 95,15
v_max3_f32 v21, v176, v177, v178
v_max3_f32 v21, v21, v179, v180
v_max3_f32 v21, v21, v181, v182
v_max3_f32 v21, v21, v183, v184
v_max3_f32 v21, v21, v185, v186
v_max3_f32 v21, v21, v187, v188
v_max3_f32 v21, v21, v189, v190
v_max_f32 v21, v21, v191
v_mov_b32 v1, v21
s_nop 1
v_permlane16_swap_b32 v1, v21
v_max_f32 v21, v21, v1
v_mov_b32 v1, v21
s_nop 1
v_permlane32_swap_b32 v1, v21
v_max_f32_e64 v21, v21, v1
v_add_f32 v21, 0x41f80000, v21
v_max_f32 v21, 0, v21
Vs 176,176,21
Vs 177,177,21
Vs 178,178,21
Vs 179,179,21
Vs 180,180,21
Vs 181,181,21
Vs 182,182,21
Vs 183,183,21
Vs 184,184,21
Vs 185,185,21
Vs 186,186,21
Vs 187,187,21
Vs 188,188,21
Vs 189,189,21
Vs 190,190,21
Vs 191,191,21
Vs 240,240,21
Vs 241,241,21
Vs 242,242,21
Vs 243,243,21
Vs 244,244,21
Vs 245,245,21
Vs 246,246,21
Vs 247,247,21
Vs 248,248,21
Vs 249,249,21
Vs 250,250,21
Vs 251,251,21
Vs 252,252,21
Vs 253,253,21
Vs 254,254,21
Vs 255,255,21
Vs 44,44,21
Vs 45,45,21
Vs 46,46,21
v_sub_f32_e64 v47, v47, v21
v_exp_f32 v22, -v21
s_nop 0
Vm 60,60,22
Vm 61,61,22
Vm 62,62,22
v_mul_f32_e64 v63, v63, v22
Ar 8,96
Ar 9,97
Ar 10,98
Ar 11,99
Ar 12,100
Ar 13,101
Ar 14,102
Ar 15,103
Vm 8,8,22
Vm 9,9,22
Vm 10,10,22
Vm 11,11,22
Vm 12,12,22
Vm 13,13,22
Vm 14,14,22
Vm 15,15,22
Aw 96,8
Aw 97,9
Aw 98,10
Aw 99,11
Aw 100,12
Aw 101,13
Aw 102,14
Aw 103,15
Ar 8,104
Ar 9,105
Ar 10,106
Ar 11,107
Ar 12,108
Ar 13,109
Ar 14,110
Ar 15,111
Vm 8,8,22
Vm 9,9,22
Vm 10,10,22
Vm 11,11,22
Vm 12,12,22
Vm 13,13,22
Vm 14,14,22
Vm 15,15,22
Aw 104,8
Aw 105,9
Aw 106,10
Aw 107,11
Aw 108,12
Aw 109,13
Aw 110,14
Aw 111,15
Ar 8,112
Ar 9,113
Ar 10,114
Ar 11,115
Ar 12,116
Ar 13,117
Ar 14,118
Ar 15,119
Vm 8,8,22
Vm 9,9,22
Vm 10,10,22
Vm 11,11,22
Vm 12,12,22
Vm 13,13,22
Vm 14,14,22
Vm 15,15,22
Aw 112,8
Aw 113,9
Aw 114,10
Aw 115,11
Aw 116,12
Aw 117,13
Aw 118,14
Aw 119,15
Ar 8,120
Ar 9,121
Ar 10,122
Ar 11,123
Ar 12,124
Ar 13,125
Ar 14,126
Ar 15,127
Vm 8,8,22
Vm 9,9,22
Vm 10,10,22
Vm 11,11,22
Vm 12,12,22
Vm 13,13,22
Vm 14,14,22
Vm 15,15,22
Aw 120,8
Aw 121,9
Aw 122,10
Aw 123,11
Aw 124,12
Aw 125,13
Aw 126,14
Aw 127,15
Ve 8,128
Ve 9,129
s_nop 0
Vc 64,8,9
Ve 8,130
Ve 9,131
s_nop 0
Vc 65,8,9
Ve 8,144
Ve 9,145
s_nop 0
Vc 72,8,9
Ve 8,146
Ve 9,147
s_nop 0
Vc 73,8,9
Ve 8,160
Ve 9,161
s_nop 0
Vc 80,8,9
Ve 8,162
Ve 9,163
s_nop 0
Vc 81,8,9
Ve 8,176
Ve 9,177
s_nop 0
Vc 88,8,9
Ve 8,178
Ve 9,179
s_nop 0
Vc 89,8,9
Ve 8,132
Ve 9,133
s_nop 0
Vc 66,8,9
Ve 8,134
Ve 9,135
s_nop 0
Vc 67,8,9
Ve 8,148
Ve 9,149
s_nop 0
Vc 74,8,9
Ve 8,150
Ve 9,151
s_nop 0
Vc 75,8,9
Ve 8,164
Ve 9,165
s_nop 0
Vc 82,8,9
Ve 8,166
Ve 9,167
s_nop 0
Vc 83,8,9
Ve 8,180
Ve 9,181
s_nop 0
Vc 90,8,9
Ve 8,182
Ve 9,183
s_nop 0
Vc 91,8,9
Ve 8,136
Ve 9,137
s_nop 0
Vc 68,8,9
Ve 8,138
Ve 9,139
s_nop 0
Vc 69,8,9
Ve 8,152
Ve 9,153
s_nop 0
Vc 76,8,9
Ve 8,154
Ve 9,155
s_nop 0
Vc 77,8,9
Ve 8,168
Ve 9,169
s_nop 0
Vc 84,8,9
Ve 8,170
Ve 9,171
s_nop 0
Vc 85,8,9
Ve 8,184
Ve 9,185
s_nop 0
Vc 92,8,9
Ve 8,186
Ve 9,187
s_nop 0
Vc 93,8,9
Ve 8,140
Ve 9,141
s_nop 0
Vc 70,8,9
Ve 8,142
Ve 9,143
s_nop 0
Vc 71,8,9
Ve 8,156
Ve 9,157
s_nop 0
Vc 78,8,9
Ve 8,158
Ve 9,159
s_nop 0
Vc 79,8,9
Ve 8,172
Ve 9,173
s_nop 0
Vc 86,8,9
Ve 8,174
Ve 9,175
s_nop 0
Vc 87,8,9
Ve 8,188
Ve 9,189
s_nop 0
Vc 94,8,9
Ve 8,190
Ve 9,191
s_nop 0
Vc 95,8,9
s_nop 1
s_branch L_k2_fbr_we
L_k2_fb_wo:
s_nop 7
s_nop 0
v_max3_f32 v21, v192, v193, v194
v_max3_f32 v21, v21, v195, v196
v_max3_f32 v21, v21, v197, v198
v_max3_f32 v21, v21, v199, v200
v_max3_f32 v21, v21, v201, v202
v_max3_f32 v21, v21, v203, v204
v_max3_f32 v21, v21, v205, v206
v_max_f32 v21, v21, v207
v_mov_b32 v1, v21
s_nop 1
v_permlane16_swap_b32 v1, v21
v_max_f32 v21, v21, v1
v_mov_b32 v1, v21
s_nop 1
v_permlane32_swap_b32 v1, v21
v_max_f32_e64 v21, v21, v1
v_add_f32 v21, 0x41f80000, v21
v_max_f32 v21, 0, v21
Vs 192,192,21
Vs 193,193,21
Vs 194,194,21
Vs 195,195,21
Vs 196,196,21
Vs 197,197,21
Vs 198,198,21
Vs 199,199,21
Vs 200,200,21
Vs 201,201,21
Vs 202,202,21
Vs 203,203,21
Vs 204,204,21
Vs 205,205,21
Vs 206,206,21
Vs 207,207,21
Vs 128,128,21
Vs 129,129,21
Vs 130,130,21
Vs 131,131,21
Vs 132,132,21
Vs 133,133,21
Vs 134,134,21
Vs 135,135,21
Vs 136,136,21
Vs 137,137,21
Vs 138,138,21
Vs 139,139,21
Vs 140,140,21
Vs 141,141,21
Vs 142,142,21
Vs 143,143,21
Vs 32,32,21
Vs 33,33,21
Vs 34,34,21
v_sub_f32_e64 v35, v35, v21
v_exp_f32 v22, -v21
s_nop 0
Vm 48,48,22
Vm 49,49,22
Vm 50,50,22
v_mul_f32_e64 v51, v51, v22
Ar 8,0
Ar 9,1
Ar 10,2
Ar 11,3
Ar 12,4
Ar 13,5
Ar 14,6
Ar 15,7
Vm 8,8,22
Vm 9,9,22
Vm 10,10,22
Vm 11,11,22
Vm 12,12,22
Vm 13,13,22
Vm 14,14,22
Vm 15,15,22
Aw 0,8
Aw 1,9
Aw 2,10
Aw 3,11
Aw 4,12
Aw 5,13
Aw 6,14
Aw 7,15
Ar 8,8
Ar 9,9
Ar 10,10
Ar 11,11
Ar 12,12
Ar 13,13
Ar 14,14
Ar 15,15
Vm 8,8,22
Vm 9,9,22
Vm 10,10,22
Vm 11,11,22
Vm 12,12,22
Vm 13,13,22
Vm 14,14,22
Vm 15,15,22
Aw 8,8
Aw 9,9
Aw 10,10
Aw 11,11
Aw 12,12
Aw 13,13
Aw 14,14
Aw 15,15
Ar 8,16
Ar 9,17
Ar 10,18
Ar 11,19
Ar 12,20
Ar 13,21
Ar 14,22
Ar 15,23
Vm 8,8,22
Vm 9,9,22
Vm 10,10,22
Vm 11,11,22
Vm 12,12,22
Vm 13,13,22
Vm 14,14,22
Vm 15,15,22
Aw 16,8
Aw 17,9
Aw 18,10
Aw 19,11
Aw 20,12
Aw 21,13
Aw 22,14
Aw 23,15
Ar 8,24
Ar 9,25
Ar 10,26
Ar 11,27
Ar 12,28
Ar 13,29
Ar 14,30
Ar 15,31
Vm 8,8,22
Vm 9,9,22
Vm 10,10,22
Vm 11,11,22
Vm 12,12,22
Vm 13,13,22
Vm 14,14,22
Vm 15,15,22
Aw 24,8
Aw 25,9
Aw 26,10
Aw 27,11
Aw 28,12
Aw 29,13
Aw 30,14
Aw 31,15
v_max3_f32 v21, v208, v209, v210
v_max3_f32 v21, v21, v211, v212
v_max3_f32 v21, v21, v213, v214
v_max3_f32 v21, v21, v215, v216
v_max3_f32 v21, v21, v217, v218
v_max3_f32 v21, v21, v219, v220
v_max3_f32 v21, v21, v221, v222
v_max_f32 v21, v21, v223
v_mov_b32 v1, v21
s_nop 1
v_permlane16_swap_b32 v1, v21
v_max_f32 v21, v21, v1
v_mov_b32 v1, v21
s_nop 1
v_permlane32_swap_b32 v1, v21
v_max_f32_e64 v21, v21, v1
v_add_f32 v21, 0x41f80000, v21
v_max_f32 v21, 0, v21
Vs 208,208,21
Vs 209,209,21
Vs 210,210,21
Vs 211,211,21
Vs 212,212,21
Vs 213,213,21
Vs 214,214,21
Vs 215,215,21
Vs 216,216,21
Vs 217,217,21
Vs 218,218,21
Vs 219,219,21
Vs 220,220,21
Vs 221,221,21
Vs 222,222,21
Vs 223,223,21
Vs 144,144,21
Vs 145,145,21
Vs 146,146,21
Vs 147,147,21
Vs 148,148,21
Vs 149,149,21
Vs 150,150,21
Vs 151,151,21
Vs 152,152,21
Vs 153,153,21
Vs 154,154,21
Vs 155,155,21
Vs 156,156,21
Vs 157,157,21
Vs 158,158,21
Vs 159,159,21
Vs 36,36,21
Vs 37,37,21
Vs 38,38,21
v_sub_f32_e64 v39, v39, v21
v_exp_f32 v22, -v21
s_nop 0
Vm 52,52,22
Vm 53,53,22
Vm 54,54,22
v_mul_f32_e64 v55, v55, v22
Ar 8,32
Ar 9,33
Ar 10,34
Ar 11,35
Ar 12,36
Ar 13,37
Ar 14,38
Ar 15,39
Vm 8,8,22
Vm 9,9,22
Vm 10,10,22
Vm 11,11,22
Vm 12,12,22
Vm 13,13,22
Vm 14,14,22
Vm 15,15,22
Aw 32,8
Aw 33,9
Aw 34,10
Aw 35,11
Aw 36,12
Aw 37,13
Aw 38,14
Aw 39,15
Ar 8,40
Ar 9,41
Ar 10,42
Ar 11,43
Ar 12,44
Ar 13,45
Ar 14,46
Ar 15,47
Vm 8,8,22
Vm 9,9,22
Vm 10,10,22
Vm 11,11,22
Vm 12,12,22
Vm 13,13,22
Vm 14,14,22
Vm 15,15,22
Aw 40,8
Aw 41,9
Aw 42,10
Aw 43,11
Aw 44,12
Aw 45,13
Aw 46,14
Aw 47,15
Ar 8,48
Ar 9,49
Ar 10,50
Ar 11,51
Ar 12,52
Ar 13,53
Ar 14,54
Ar 15,55
Vm 8,8,22
Vm 9,9,22
Vm 10,10,22
Vm 11,11,22
Vm 12,12,22
Vm 13,13,22
Vm 14,14,22
Vm 15,15,22
Aw 48,8
Aw 49,9
Aw 50,10
Aw 51,11
Aw 52,12
Aw 53,13
Aw 54,14
Aw 55,15
Ar 8,56
Ar 9,57
Ar 10,58
Ar 11,59
Ar 12,60
Ar 13,61
Ar 14,62
Ar 15,63
Vm 8,8,22
Vm 9,9,22
Vm 10,10,22
Vm 11,11,22
Vm 12,12,22
Vm 13,13,22
Vm 14,14,22
Vm 15,15,22
Aw 56,8
Aw 57,9
Aw 58,10
Aw 59,11
Aw 60,12
Aw 61,13
Aw 62,14
Aw 63,15
v_max3_f32 v21, v224, v225, v226
v_max3_f32 v21, v21, v227, v228
v_max3_f32 v21, v21, v229, v230
v_max3_f32 v21, v21, v231, v232
v_max3_f32 v21, v21, v233, v234
v_max3_f32 v21, v21, v235, v236
v_max3_f32 v21, v21, v237, v238
v_max_f32 v21, v21, v239
v_mov_b32 v1, v21
s_nop 1
v_permlane16_swap_b32 v1, v21
v_max_f32 v21, v21, v1
v_mov_b32 v1, v21
s_nop 1
v_permlane32_swap_b32 v1, v21
v_max_f32_e64 v21, v21, v1
v_add_f32 v21, 0x41f80000, v21
v_max_f32 v21, 0, v21
Vs 224,224,21
Vs 225,225,21
Vs 226,226,21
Vs 227,227,21
Vs 228,228,21
Vs 229,229,21
Vs 230,230,21
Vs 231,231,21
Vs 232,232,21
Vs 233,233,21
Vs 234,234,21
Vs 235,235,21
Vs 236,236,21
Vs 237,237,21
Vs 238,238,21
Vs 239,239,21
Vs 160,160,21
Vs 161,161,21
Vs 162,162,21
Vs 163,163,21
Vs 164,164,21
Vs 165,165,21
Vs 166,166,21
Vs 167,167,21
Vs 168,168,21
Vs 169,169,21
Vs 170,170,21
Vs 171,171,21
Vs 172,172,21
Vs 173,173,21
Vs 174,174,21
Vs 175,175,21
Vs 40,40,21
Vs 41,41,21
Vs 42,42,21
v_sub_f32_e64 v43, v43, v21
v_exp_f32 v22, -v21
s_nop 0
Vm 56,56,22
Vm 57,57,22
Vm 58,58,22
v_mul_f32_e64 v59, v59, v22
Ar 8,64
Ar 9,65
Ar 10,66
Ar 11,67
Ar 12,68
Ar 13,69
Ar 14,70
Ar 15,71
Vm 8,8,22
Vm 9,9,22
Vm 10,10,22
Vm 11,11,22
Vm 12,12,22
Vm 13,13,22
Vm 14,14,22
Vm 15,15,22
Aw 64,8
Aw 65,9
Aw 66,10
Aw 67,11
Aw 68,12
Aw 69,13
Aw 70,14
Aw 71,15
Ar 8,72
Ar 9,73
Ar 10,74
Ar 11,75
Ar 12,76
Ar 13,77
Ar 14,78
Ar 15,79
Vm 8,8,22
Vm 9,9,22
Vm 10,10,22
Vm 11,11,22
Vm 12,12,22
Vm 13,13,22
Vm 14,14,22
Vm 15,15,22
Aw 72,8
Aw 73,9
Aw 74,10
Aw 75,11
Aw 76,12
Aw 77,13
Aw 78,14
Aw 79,15
Ar 8,80
Ar 9,81
Ar 10,82
Ar 11,83
Ar 12,84
Ar 13,85
Ar 14,86
Ar 15,87
Vm 8,8,22
Vm 9,9,22
Vm 10,10,22
Vm 11,11,22
Vm 12,12,22
Vm 13,13,22
Vm 14,14,22
Vm 15,15,22
Aw 80,8
Aw 81,9
Aw 82,10
Aw 83,11
Aw 84,12
Aw 85,13
Aw 86,14
Aw 87,15
Ar 8,88
Ar 9,89
Ar 10,90
Ar 11,91
Ar 12,92
Ar 13,93
Ar 14,94
Ar 15,95
Vm 8,8,22
Vm 9,9,22
Vm 10,10,22
Vm 11,11,22
Vm 12,12,22
Vm 13,13,22
Vm 14,14,22
Vm 15,15,22
Aw 88,8
Aw 89,9
Aw 90,10
Aw 91,11
Aw 92,12
Aw 93,13
Aw 94,14
Aw 95,15
v_max3_f32 v21, v240, v241, v242
v_max3_f32 v21, v21, v243, v244
v_max3_f32 v21, v21, v245, v246
v_max3_f32 v21, v21, v247, v248
v_max3_f32 v21, v21, v249, v250
v_max3_f32 v21, v21, v251, v252
v_max3_f32 v21, v21, v253, v254
v_max_f32 v21, v21, v255
v_mov_b32 v1, v21
s_nop 1
v_permlane16_swap_b32 v1, v21
v_max_f32 v21, v21, v1
v_mov_b32 v1, v21
s_nop 1
v_permlane32_swap_b32 v1, v21
v_max_f32_e64 v21, v21, v1
v_add_f32 v21, 0x41f80000, v21
v_max_f32 v21, 0, v21
Vs 240,240,21
Vs 241,241,21
Vs 242,242,21
Vs 243,243,21
Vs 244,244,21
Vs 245,245,21
Vs 246,246,21
Vs 247,247,21
Vs 248,248,21
Vs 249,249,21
Vs 250,250,21
Vs 251,251,21
Vs 252,252,21
Vs 253,253,21
Vs 254,254,21
Vs 255,255,21
Vs 176,176,21
Vs 177,177,21
Vs 178,178,21
Vs 179,179,21
Vs 180,180,21
Vs 181,181,21
Vs 182,182,21
Vs 183,183,21
Vs 184,184,21
Vs 185,185,21
Vs 186,186,21
Vs 187,187,21
Vs 188,188,21
Vs 189,189,21
Vs 190,190,21
Vs 191,191,21
Vs 44,44,21
Vs 45,45,21
Vs 46,46,21
v_sub_f32_e64 v47, v47, v21
v_exp_f32 v22, -v21
s_nop 0
Vm 60,60,22
Vm 61,61,22
Vm 62,62,22
v_mul_f32_e64 v63, v63, v22
Ar 8,96
Ar 9,97
Ar 10,98
Ar 11,99
Ar 12,100
Ar 13,101
Ar 14,102
Ar 15,103
Vm 8,8,22
Vm 9,9,22
Vm 10,10,22
Vm 11,11,22
Vm 12,12,22
Vm 13,13,22
Vm 14,14,22
Vm 15,15,22
Aw 96,8
Aw 97,9
Aw 98,10
Aw 99,11
Aw 100,12
Aw 101,13
Aw 102,14
Aw 103,15
Ar 8,104
Ar 9,105
Ar 10,106
Ar 11,107
Ar 12,108
Ar 13,109
Ar 14,110
Ar 15,111
Vm 8,8,22
Vm 9,9,22
Vm 10,10,22
Vm 11,11,22
Vm 12,12,22
Vm 13,13,22
Vm 14,14,22
Vm 15,15,22
Aw 104,8
Aw 105,9
Aw 106,10
Aw 107,11
Aw 108,12
Aw 109,13
Aw 110,14
Aw 111,15
Ar 8,112
Ar 9,113
Ar 10,114
Ar 11,115
Ar 12,116
Ar 13,117
Ar 14,118
Ar 15,119
Vm 8,8,22
Vm 9,9,22
Vm 10,10,22
Vm 11,11,22
Vm 12,12,22
Vm 13,13,22
Vm 14,14,22
Vm 15,15,22
Aw 112,8
Aw 113,9
Aw 114,10
Aw 115,11
Aw 116,12
Aw 117,13
Aw 118,14
Aw 119,15
Ar 8,120
Ar 9,121
Ar 10,122
Ar 11,123
Ar 12,124
Ar 13,125
Ar 14,126
Ar 15,127
Vm 8,8,22
Vm 9,9,22
Vm 10,10,22
Vm 11,11,22
Vm 12,12,22
Vm 13,13,22
Vm 14,14,22
Vm 15,15,22
Aw 120,8
Aw 121,9
Aw 122,10
Aw 123,11
Aw 124,12
Aw 125,13
Aw 126,14
Aw 127,15
Ve 8,192
Ve 9,193
s_nop 0
Vc 96,8,9
Ve 8,194
Ve 9,195
s_nop 0
Vc 97,8,9
Ve 8,208
Ve 9,209
s_nop 0
Vc 104,8,9
Ve 8,210
Ve 9,211
s_nop 0
Vc 105,8,9
Ve 8,224
Ve 9,225
s_nop 0
Vc 112,8,9
Ve 8,226
Ve 9,227
s_nop 0
Vc 113,8,9
Ve 8,240
Ve 9,241
s_nop 0
Vc 120,8,9
Ve 8,242
Ve 9,243
s_nop 0
Vc 121,8,9
Ve 8,196
Ve 9,197
s_nop 0
Vc 98,8,9
Ve 8,198
Ve 9,199
s_nop 0
Vc 99,8,9
Ve 8,212
Ve 9,213
s_nop 0
Vc 106,8,9
Ve 8,214
Ve 9,215
s_nop 0
Vc 107,8,9
Ve 8,228
Ve 9,229
s_nop 0
Vc 114,8,9
Ve 8,230
Ve 9,231
s_nop 0
Vc 115,8,9
Ve 8,244
Ve 9,245
s_nop 0
Vc 122,8,9
Ve 8,246
Ve 9,247
s_nop 0
Vc 123,8,9
Ve 8,200
Ve 9,201
s_nop 0
Vc 100,8,9
Ve 8,202
Ve 9,203
s_nop 0
Vc 101,8,9
Ve 8,216
Ve 9,217
s_nop 0
Vc 108,8,9
Ve 8,218
Ve 9,219
s_nop 0
Vc 109,8,9
Ve 8,232
Ve 9,233
s_nop 0
Vc 116,8,9
Ve 8,234
Ve 9,235
s_nop 0
Vc 117,8,9
Ve 8,248
Ve 9,249
s_nop 0
Vc 124,8,9
Ve 8,250
Ve 9,251
s_nop 0
Vc 125,8,9
Ve 8,204
Ve 9,205
s_nop 0
Vc 102,8,9
Ve 8,206
Ve 9,207
s_nop 0
Vc 103,8,9
Ve 8,220
Ve 9,221
s_nop 0
Vc 110,8,9
Ve 8,222
Ve 9,223
s_nop 0
Vc 111,8,9
Ve 8,236
Ve 9,237
s_nop 0
Vc 118,8,9
Ve 8,238
Ve 9,239
s_nop 0
Vc 119,8,9
Ve 8,252
Ve 9,253
s_nop 0
Vc 126,8,9
Ve 8,254
Ve 9,255
s_nop 0
Vc 127,8,9
s_nop 1
s_branch L_k2_fbr_wo
L_k2_fb_wl:
s_nop 7
s_nop 0
v_max3_f32 v21, v128, v129, v130
v_max3_f32 v21, v21, v131, v132
v_max3_f32 v21, v21, v133, v134
v_max3_f32 v21, v21, v135, v136
v_max3_f32 v21, v21, v137, v138
v_max3_f32 v21, v21, v139, v140
v_max3_f32 v21, v21, v141, v142
v_max_f32 v21, v21, v143
v_mov_b32 v1, v21
s_nop 1
v_permlane16_swap_b32 v1, v21
v_max_f32 v21, v21, v1
v_mov_b32 v1, v21
s_nop 1
v_permlane32_swap_b32 v1, v21
v_max_f32_e64 v21, v21, v1
v_add_f32 v21, 0x41f80000, v21
v_max_f32 v21, 0, v21
Vs 128,128,21
Vs 129,129,21
Vs 130,130,21
Vs 131,131,21
Vs 132,132,21
Vs 133,133,21
Vs 134,134,21
Vs 135,135,21
Vs 136,136,21
Vs 137,137,21
Vs 138,138,21
Vs 139,139,21
Vs 140,140,21
Vs 141,141,21
Vs 142,142,21
Vs 143,143,21
Vs 192,192,21
Vs 193,193,21
Vs 194,194,21
Vs 195,195,21
Vs 196,196,21
Vs 197,197,21
Vs 198,198,21
Vs 199,199,21
Vs 200,200,21
Vs 201,201,21
Vs 202,202,21
Vs 203,203,21
Vs 204,204,21
Vs 205,205,21
Vs 206,206,21
Vs 207,207,21
Vs 32,32,21
Vs 33,33,21
Vs 34,34,21
v_sub_f32_e64 v35, v35, v21
v_exp_f32 v22, -v21
s_nop 0
Vm 48,48,22
Vm 49,49,22
Vm 50,50,22
v_mul_f32_e64 v51, v51, v22
Ar 8,0
Ar 9,1
Ar 10,2
Ar 11,3
Ar 12,4
Ar 13,5
Ar 14,6
Ar 15,7
Vm 8,8,22
Vm 9,9,22
Vm 10,10,22
Vm 11,11,22
Vm 12,12,22
Vm 13,13,22
Vm 14,14,22
Vm 15,15,22
Aw 0,8
Aw 1,9
Aw 2,10
Aw 3,11
Aw 4,12
Aw 5,13
Aw 6,14
Aw 7,15
Ar 8,8
Ar 9,9
Ar 10,10
Ar 11,11
Ar 12,12
Ar 13,13
Ar 14,14
Ar 15,15
Vm 8,8,22
Vm 9,9,22
Vm 10,10,22
Vm 11,11,22
Vm 12,12,22
Vm 13,13,22
Vm 14,14,22
Vm 15,15,22
Aw 8,8
Aw 9,9
Aw 10,10
Aw 11,11
Aw 12,12
Aw 13,13
Aw 14,14
Aw 15,15
Ar 8,16
Ar 9,17
Ar 10,18
Ar 11,19
Ar 12,20
Ar 13,21
Ar 14,22
Ar 15,23
Vm 8,8,22
Vm 9,9,22
Vm 10,10,22
Vm 11,11,22
Vm 12,12,22
Vm 13,13,22
Vm 14,14,22
Vm 15,15,22
Aw 16,8
Aw 17,9
Aw 18,10
Aw 19,11
Aw 20,12
Aw 21,13
Aw 22,14
Aw 23,15
Ar 8,24
Ar 9,25
Ar 10,26
Ar 11,27
Ar 12,28
Ar 13,29
Ar 14,30
Ar 15,31
Vm 8,8,22
Vm 9,9,22
Vm 10,10,22
Vm 11,11,22
Vm 12,12,22
Vm 13,13,22
Vm 14,14,22
Vm 15,15,22
Aw 24,8
Aw 25,9
Aw 26,10
Aw 27,11
Aw 28,12
Aw 29,13
Aw 30,14
Aw 31,15
v_max3_f32 v21, v144, v145, v146
v_max3_f32 v21, v21, v147, v148
v_max3_f32 v21, v21, v149, v150
v_max3_f32 v21, v21, v151, v152
v_max3_f32 v21, v21, v153, v154
v_max3_f32 v21, v21, v155, v156
v_max3_f32 v21, v21, v157, v158
v_max_f32 v21, v21, v159
v_mov_b32 v1, v21
s_nop 1
v_permlane16_swap_b32 v1, v21
v_max_f32 v21, v21, v1
v_mov_b32 v1, v21
s_nop 1
v_permlane32_swap_b32 v1, v21
v_max_f32_e64 v21, v21, v1
v_add_f32 v21, 0x41f80000, v21
v_max_f32 v21, 0, v21
Vs 144,144,21
Vs 145,145,21
Vs 146,146,21
Vs 147,147,21
Vs 148,148,21
Vs 149,149,21
Vs 150,150,21
Vs 151,151,21
Vs 152,152,21
Vs 153,153,21
Vs 154,154,21
Vs 155,155,21
Vs 156,156,21
Vs 157,157,21
Vs 158,158,21
Vs 159,159,21
Vs 208,208,21
Vs 209,209,21
Vs 210,210,21
Vs 211,211,21
Vs 212,212,21
Vs 213,213,21
Vs 214,214,21
Vs 215,215,21
Vs 216,216,21
Vs 217,217,21
Vs 218,218,21
Vs 219,219,21
Vs 220,220,21
Vs 221,221,21
Vs 222,222,21
Vs 223,223,21
Vs 36,36,21
Vs 37,37,21
Vs 38,38,21
v_sub_f32_e64 v39, v39, v21
v_exp_f32 v22, -v21
s_nop 0
Vm 52,52,22
Vm 53,53,22
Vm 54,54,22
v_mul_f32_e64 v55, v55, v22
Ar 8,32
Ar 9,33
Ar 10,34
Ar 11,35
Ar 12,36
Ar 13,37
Ar 14,38
Ar 15,39
Vm 8,8,22
Vm 9,9,22
Vm 10,10,22
Vm 11,11,22
Vm 12,12,22
Vm 13,13,22
Vm 14,14,22
Vm 15,15,22
Aw 32,8
Aw 33,9
Aw 34,10
Aw 35,11
Aw 36,12
Aw 37,13
Aw 38,14
Aw 39,15
Ar 8,40
Ar 9,41
Ar 10,42
Ar 11,43
Ar 12,44
Ar 13,45
Ar 14,46
Ar 15,47
Vm 8,8,22
Vm 9,9,22
Vm 10,10,22
Vm 11,11,22
Vm 12,12,22
Vm 13,13,22
Vm 14,14,22
Vm 15,15,22
Aw 40,8
Aw 41,9
Aw 42,10
Aw 43,11
Aw 44,12
Aw 45,13
Aw 46,14
Aw 47,15
Ar 8,48
Ar 9,49
Ar 10,50
Ar 11,51
Ar 12,52
Ar 13,53
Ar 14,54
Ar 15,55
Vm 8,8,22
Vm 9,9,22
Vm 10,10,22
Vm 11,11,22
Vm 12,12,22
Vm 13,13,22
Vm 14,14,22
Vm 15,15,22
Aw 48,8
Aw 49,9
Aw 50,10
Aw 51,11
Aw 52,12
Aw 53,13
Aw 54,14
Aw 55,15
Ar 8,56
Ar 9,57
Ar 10,58
Ar 11,59
Ar 12,60
Ar 13,61
Ar 14,62
Ar 15,63
Vm 8,8,22
Vm 9,9,22
Vm 10,10,22
Vm 11,11,22
Vm 12,12,22
Vm 13,13,22
Vm 14,14,22
Vm 15,15,22
Aw 56,8
Aw 57,9
Aw 58,10
Aw 59,11
Aw 60,12
Aw 61,13
Aw 62,14
Aw 63,15
v_max3_f32 v21, v160, v161, v162
v_max3_f32 v21, v21, v163, v164
v_max3_f32 v21, v21, v165, v166
v_max3_f32 v21, v21, v167, v168
v_max3_f32 v21, v21, v169, v170
v_max3_f32 v21, v21, v171, v172
v_max3_f32 v21, v21, v173, v174
v_max_f32 v21, v21, v175
v_mov_b32 v1, v21
s_nop 1
v_permlane16_swap_b32 v1, v21
v_max_f32 v21, v21, v1
v_mov_b32 v1, v21
s_nop 1
v_permlane32_swap_b32 v1, v21
v_max_f32_e64 v21, v21, v1
v_add_f32 v21, 0x41f80000, v21
v_max_f32 v21, 0, v21
Vs 160,160,21
Vs 161,161,21
Vs 162,162,21
Vs 163,163,21
Vs 164,164,21
Vs 165,165,21
Vs 166,166,21
Vs 167,167,21
Vs 168,168,21
Vs 169,169,21
Vs 170,170,21
Vs 171,171,21
Vs 172,172,21
Vs 173,173,21
Vs 174,174,21
Vs 175,175,21
Vs 224,224,21
Vs 225,225,21
Vs 226,226,21
Vs 227,227,21
Vs 228,228,21
Vs 229,229,21
Vs 230,230,21
Vs 231,231,21
Vs 232,232,21
Vs 233,233,21
Vs 234,234,21
Vs 235,235,21
Vs 236,236,21
Vs 237,237,21
Vs 238,238,21
Vs 239,239,21
Vs 40,40,21
Vs 41,41,21
Vs 42,42,21
v_sub_f32_e64 v43, v43, v21
v_exp_f32 v22, -v21
s_nop 0
Vm 56,56,22
Vm 57,57,22
Vm 58,58,22
v_mul_f32_e64 v59, v59, v22
Ar 8,64
Ar 9,65
Ar 10,66
Ar 11,67
Ar 12,68
Ar 13,69
Ar 14,70
Ar 15,71
Vm 8,8,22
Vm 9,9,22
Vm 10,10,22
Vm 11,11,22
Vm 12,12,22
Vm 13,13,22
Vm 14,14,22
Vm 15,15,22
Aw 64,8
Aw 65,9
Aw 66,10
Aw 67,11
Aw 68,12
Aw 69,13
Aw 70,14
Aw 71,15
Ar 8,72
Ar 9,73
Ar 10,74
Ar 11,75
Ar 12,76
Ar 13,77
Ar 14,78
Ar 15,79
Vm 8,8,22
Vm 9,9,22
Vm 10,10,22
Vm 11,11,22
Vm 12,12,22
Vm 13,13,22
Vm 14,14,22
Vm 15,15,22
Aw 72,8
Aw 73,9
Aw 74,10
Aw 75,11
Aw 76,12
Aw 77,13
Aw 78,14
Aw 79,15
Ar 8,80
Ar 9,81
Ar 10,82
Ar 11,83
Ar 12,84
Ar 13,85
Ar 14,86
Ar 15,87
Vm 8,8,22
Vm 9,9,22
Vm 10,10,22
Vm 11,11,22
Vm 12,12,22
Vm 13,13,22
Vm 14,14,22
Vm 15,15,22
Aw 80,8
Aw 81,9
Aw 82,10
Aw 83,11
Aw 84,12
Aw 85,13
Aw 86,14
Aw 87,15
Ar 8,88
Ar 9,89
Ar 10,90
Ar 11,91
Ar 12,92
Ar 13,93
Ar 14,94
Ar 15,95
Vm 8,8,22
Vm 9,9,22
Vm 10,10,22
Vm 11,11,22
Vm 12,12,22
Vm 13,13,22
Vm 14,14,22
Vm 15,15,22
Aw 88,8
Aw 89,9
Aw 90,10
Aw 91,11
Aw 92,12
Aw 93,13
Aw 94,14
Aw 95,15
v_max3_f32 v21, v176, v177, v178
v_max3_f32 v21, v21, v179, v180
v_max3_f32 v21, v21, v181, v182
v_max3_f32 v21, v21, v183, v184
v_max3_f32 v21, v21, v185, v186
v_max3_f32 v21, v21, v187, v188
v_max3_f32 v21, v21, v189, v190
v_max_f32 v21, v21, v191
v_mov_b32 v1, v21
s_nop 1
v_permlane16_swap_b32 v1, v21
v_max_f32 v21, v21, v1
v_mov_b32 v1, v21
s_nop 1
v_permlane32_swap_b32 v1, v21
v_max_f32_e64 v21, v21, v1
v_add_f32 v21, 0x41f80000, v21
v_max_f32 v21, 0, v21
Vs 176,176,21
Vs 177,177,21
Vs 178,178,21
Vs 179,179,21
Vs 180,180,21
Vs 181,181,21
Vs 182,182,21
Vs 183,183,21
Vs 184,184,21
Vs 185,185,21
Vs 186,186,21
Vs 187,187,21
Vs 188,188,21
Vs 189,189,21
Vs 190,190,21
Vs 191,191,21
Vs 44,44,21
Vs 45,45,21
Vs 46,46,21
v_sub_f32_e64 v47, v47, v21
v_exp_f32 v22, -v21
s_nop 0
Vm 60,60,22
Vm 61,61,22
Vm 62,62,22
v_mul_f32_e64 v63, v63, v22
Ar 8,96
Ar 9,97
Ar 10,98
Ar 11,99
Ar 12,100
Ar 13,101
Ar 14,102
Ar 15,103
Vm 8,8,22
Vm 9,9,22
Vm 10,10,22
Vm 11,11,22
Vm 12,12,22
Vm 13,13,22
Vm 14,14,22
Vm 15,15,22
Aw 96,8
Aw 97,9
Aw 98,10
Aw 99,11
Aw 100,12
Aw 101,13
Aw 102,14
Aw 103,15
Ar 8,104
Ar 9,105
Ar 10,106
Ar 11,107
Ar 12,108
Ar 13,109
Ar 14,110
Ar 15,111
Vm 8,8,22
Vm 9,9,22
Vm 10,10,22
Vm 11,11,22
Vm 12,12,22
Vm 13,13,22
Vm 14,14,22
Vm 15,15,22
Aw 104,8
Aw 105,9
Aw 106,10
Aw 107,11
Aw 108,12
Aw 109,13
Aw 110,14
Aw 111,15
Ar 8,112
Ar 9,113
Ar 10,114
Ar 11,115
Ar 12,116
Ar 13,117
Ar 14,118
Ar 15,119
Vm 8,8,22
Vm 9,9,22
Vm 10,10,22
Vm 11,11,22
Vm 12,12,22
Vm 13,13,22
Vm 14,14,22
Vm 15,15,22
Aw 112,8
Aw 113,9
Aw 114,10
Aw 115,11
Aw 116,12
Aw 117,13
Aw 118,14
Aw 119,15
Ar 8,120
Ar 9,121
Ar 10,122
Ar 11,123
Ar 12,124
Ar 13,125
Ar 14,126
Ar 15,127
Vm 8,8,22
Vm 9,9,22
Vm 10,10,22
Vm 11,11,22
Vm 12,12,22
Vm 13,13,22
Vm 14,14,22
Vm 15,15,22
Aw 120,8
Aw 121,9
Aw 122,10
Aw 123,11
Aw 124,12
Aw 125,13
Aw 126,14
Aw 127,15
Ve 8,128
Ve 9,129
s_nop 0
Vc 64,8,9
Ve 8,130
Ve 9,131
s_nop 0
Vc 65,8,9
Ve 8,144
Ve 9,145
s_nop 0
Vc 72,8,9
Ve 8,146
Ve 9,147
s_nop 0
Vc 73,8,9
Ve 8,160
Ve 9,161
s_nop 0
Vc 80,8,9
Ve 8,162
Ve 9,163
s_nop 0
Vc 81,8,9
Ve 8,176
Ve 9,177
s_nop 0
Vc 88,8,9
Ve 8,178
Ve 9,179
s_nop 0
Vc 89,8,9
Ve 8,132
Ve 9,133
s_nop 0
Vc 66,8,9
Ve 8,134
Ve 9,135
s_nop 0
Vc 67,8,9
Ve 8,148
Ve 9,149
s_nop 0
Vc 74,8,9
Ve 8,150
Ve 9,151
s_nop 0
Vc 75,8,9
Ve 8,164
Ve 9,165
s_nop 0
Vc 82,8,9
Ve 8,166
Ve 9,167
s_nop 0
Vc 83,8,9
Ve 8,180
Ve 9,181
s_nop 0
Vc 90,8,9
Ve 8,182
Ve 9,183
s_nop 0
Vc 91,8,9
Ve 8,136
Ve 9,137
s_nop 0
Vc 68,8,9
Ve 8,138
Ve 9,139
s_nop 0
Vc 69,8,9
Ve 8,152
Ve 9,153
s_nop 0
Vc 76,8,9
Ve 8,154
Ve 9,155
s_nop 0
Vc 77,8,9
Ve 8,168
Ve 9,169
s_nop 0
Vc 84,8,9
Ve 8,170
Ve 9,171
s_nop 0
Vc 85,8,9
Ve 8,184
Ve 9,185
s_nop 0
Vc 92,8,9
Ve 8,186
Ve 9,187
s_nop 0
Vc 93,8,9
Ve 8,140
Ve 9,141
s_nop 0
Vc 70,8,9
Ve 8,142
Ve 9,143
s_nop 0
Vc 71,8,9
Ve 8,156
Ve 9,157
s_nop 0
Vc 78,8,9
Ve 8,158
Ve 9,159
s_nop 0
Vc 79,8,9
Ve 8,172
Ve 9,173
s_nop 0
Vc 86,8,9
Ve 8,174
Ve 9,175
s_nop 0
Vc 87,8,9
Ve 8,188
Ve 9,189
s_nop 0
Vc 94,8,9
Ve 8,190
Ve 9,191
s_nop 0
Vc 95,8,9
s_nop 1
s_branch L_k2_fbr_wl
L_k2_fb_tr:
s_nop 7
s_nop 0
v_max3_f32 v21, v192, v193, v194
v_max3_f32 v21, v21, v195, v196
v_max3_f32 v21, v21, v197, v198
v_max3_f32 v21, v21, v199, v200
v_max3_f32 v21, v21, v201, v202
v_max3_f32 v21, v21, v203, v204
v_max3_f32 v21, v21, v205, v206
v_max_f32 v21, v21, v207
v_mov_b32 v1, v21
s_nop 1
v_permlane16_swap_b32 v1, v21
v_max_f32 v21, v21, v1
v_mov_b32 v1, v21
s_nop 1
v_permlane32_swap_b32 v1, v21
v_max_f32_e64 v21, v21, v1
v_add_f32 v21, 0x41f80000, v21
v_max_f32 v21, 0, v21
Vs 192,192,21
Vs 193,193,21
Vs 194,194,21
Vs 195,195,21
Vs 196,196,21
Vs 197,197,21
Vs 198,198,21
Vs 199,199,21
Vs 200,200,21
Vs 201,201,21
Vs 202,202,21
Vs 203,203,21
Vs 204,204,21
Vs 205,205,21
Vs 206,206,21
Vs 207,207,21
Vs 128,128,21
Vs 129,129,21
Vs 130,130,21
Vs 131,131,21
Vs 132,132,21
Vs 133,133,21
Vs 134,134,21
Vs 135,135,21
Vs 136,136,21
Vs 137,137,21
Vs 138,138,21
Vs 139,139,21
Vs 140,140,21
Vs 141,141,21
Vs 142,142,21
Vs 143,143,21
Vs 32,32,21
Vs 33,33,21
Vs 34,34,21
v_sub_f32_e64 v35, v35, v21
v_exp_f32 v22, -v21
s_nop 0
Vm 48,48,22
Vm 49,49,22
Vm 50,50,22
v_mul_f32_e64 v51, v51, v22
Ar 8,0
Ar 9,1
Ar 10,2
Ar 11,3
Ar 12,4
Ar 13,5
Ar 14,6
Ar 15,7
Vm 8,8,22
Vm 9,9,22
Vm 10,10,22
Vm 11,11,22
Vm 12,12,22
Vm 13,13,22
Vm 14,14,22
Vm 15,15,22
Aw 0,8
Aw 1,9
Aw 2,10
Aw 3,11
Aw 4,12
Aw 5,13
Aw 6,14
Aw 7,15
Ar 8,8
Ar 9,9
Ar 10,10
Ar 11,11
Ar 12,12
Ar 13,13
Ar 14,14
Ar 15,15
Vm 8,8,22
Vm 9,9,22
Vm 10,10,22
Vm 11,11,22
Vm 12,12,22
Vm 13,13,22
Vm 14,14,22
Vm 15,15,22
Aw 8,8
Aw 9,9
Aw 10,10
Aw 11,11
Aw 12,12
Aw 13,13
Aw 14,14
Aw 15,15
Ar 8,16
Ar 9,17
Ar 10,18
Ar 11,19
Ar 12,20
Ar 13,21
Ar 14,22
Ar 15,23
Vm 8,8,22
Vm 9,9,22
Vm 10,10,22
Vm 11,11,22
Vm 12,12,22
Vm 13,13,22
Vm 14,14,22
Vm 15,15,22
Aw 16,8
Aw 17,9
Aw 18,10
Aw 19,11
Aw 20,12
Aw 21,13
Aw 22,14
Aw 23,15
Ar 8,24
Ar 9,25
Ar 10,26
Ar 11,27
Ar 12,28
Ar 13,29
Ar 14,30
Ar 15,31
Vm 8,8,22
Vm 9,9,22
Vm 10,10,22
Vm 11,11,22
Vm 12,12,22
Vm 13,13,22
Vm 14,14,22
Vm 15,15,22
Aw 24,8
Aw 25,9
Aw 26,10
Aw 27,11
Aw 28,12
Aw 29,13
Aw 30,14
Aw 31,15
v_max3_f32 v21, v208, v209, v210
v_max3_f32 v21, v21, v211, v212
v_max3_f32 v21, v21, v213, v214
v_max3_f32 v21, v21, v215, v216
v_max3_f32 v21, v21, v217, v218
v_max3_f32 v21, v21, v219, v220
v_max3_f32 v21, v21, v221, v222
v_max_f32 v21, v21, v223
v_mov_b32 v1, v21
s_nop 1
v_permlane16_swap_b32 v1, v21
v_max_f32 v21, v21, v1
v_mov_b32 v1, v21
s_nop 1
v_permlane32_swap_b32 v1, v21
v_max_f32_e64 v21, v21, v1
v_add_f32 v21, 0x41f80000, v21
v_max_f32 v21, 0, v21
Vs 208,208,21
Vs 209,209,21
Vs 210,210,21
Vs 211,211,21
Vs 212,212,21
Vs 213,213,21
Vs 214,214,21
Vs 215,215,21
Vs 216,216,21
Vs 217,217,21
Vs 218,218,21
Vs 219,219,21
Vs 220,220,21
Vs 221,221,21
Vs 222,222,21
Vs 223,223,21
Vs 144,144,21
Vs 145,145,21
Vs 146,146,21
Vs 147,147,21
Vs 148,148,21
Vs 149,149,21
Vs 150,150,21
Vs 151,151,21
Vs 152,152,21
Vs 153,153,21
Vs 154,154,21
Vs 155,155,21
Vs 156,156,21
Vs 157,157,21
Vs 158,158,21
Vs 159,159,21
Vs 36,36,21
Vs 37,37,21
Vs 38,38,21
v_sub_f32_e64 v39, v39, v21
v_exp_f32 v22, -v21
s_nop 0
Vm 52,52,22
Vm 53,53,22
Vm 54,54,22
v_mul_f32_e64 v55, v55, v22
Ar 8,32
Ar 9,33
Ar 10,34
Ar 11,35
Ar 12,36
Ar 13,37
Ar 14,38
Ar 15,39
Vm 8,8,22
Vm 9,9,22
Vm 10,10,22
Vm 11,11,22
Vm 12,12,22
Vm 13,13,22
Vm 14,14,22
Vm 15,15,22
Aw 32,8
Aw 33,9
Aw 34,10
Aw 35,11
Aw 36,12
Aw 37,13
Aw 38,14
Aw 39,15
Ar 8,40
Ar 9,41
Ar 10,42
Ar 11,43
Ar 12,44
Ar 13,45
Ar 14,46
Ar 15,47
Vm 8,8,22
Vm 9,9,22
Vm 10,10,22
Vm 11,11,22
Vm 12,12,22
Vm 13,13,22
Vm 14,14,22
Vm 15,15,22
Aw 40,8
Aw 41,9
Aw 42,10
Aw 43,11
Aw 44,12
Aw 45,13
Aw 46,14
Aw 47,15
Ar 8,48
Ar 9,49
Ar 10,50
Ar 11,51
Ar 12,52
Ar 13,53
Ar 14,54
Ar 15,55
Vm 8,8,22
Vm 9,9,22
Vm 10,10,22
Vm 11,11,22
Vm 12,12,22
Vm 13,13,22
Vm 14,14,22
Vm 15,15,22
Aw 48,8
Aw 49,9
Aw 50,10
Aw 51,11
Aw 52,12
Aw 53,13
Aw 54,14
Aw 55,15
Ar 8,56
Ar 9,57
Ar 10,58
Ar 11,59
Ar 12,60
Ar 13,61
Ar 14,62
Ar 15,63
Vm 8,8,22
Vm 9,9,22
Vm 10,10,22
Vm 11,11,22
Vm 12,12,22
Vm 13,13,22
Vm 14,14,22
Vm 15,15,22
Aw 56,8
Aw 57,9
Aw 58,10
Aw 59,11
Aw 60,12
Aw 61,13
Aw 62,14
Aw 63,15
v_max3_f32 v21, v224, v225, v226
v_max3_f32 v21, v21, v227, v228
v_max3_f32 v21, v21, v229, v230
v_max3_f32 v21, v21, v231, v232
v_max3_f32 v21, v21, v233, v234
v_max3_f32 v21, v21, v235, v236
v_max3_f32 v21, v21, v237, v238
v_max_f32 v21, v21, v239
v_mov_b32 v1, v21
s_nop 1
v_permlane16_swap_b32 v1, v21
v_max_f32 v21, v21, v1
v_mov_b32 v1, v21
s_nop 1
v_permlane32_swap_b32 v1, v21
v_max_f32_e64 v21, v21, v1
v_add_f32 v21, 0x41f80000, v21
v_max_f32 v21, 0, v21
Vs 224,224,21
Vs 225,225,21
Vs 226,226,21
Vs 227,227,21
Vs 228,228,21
Vs 229,229,21
Vs 230,230,21
Vs 231,231,21
Vs 232,232,21
Vs 233,233,21
Vs 234,234,21
Vs 235,235,21
Vs 236,236,21
Vs 237,237,21
Vs 238,238,21
Vs 239,239,21
Vs 40,40,21
Vs 41,41,21
Vs 42,42,21
v_sub_f32_e64 v43, v43, v21
v_exp_f32 v22, -v21
s_nop 0
Vm 56,56,22
Vm 57,57,22
Vm 58,58,22
v_mul_f32_e64 v59, v59, v22
Ar 8,64
Ar 9,65
Ar 10,66
Ar 11,67
Ar 12,68
Ar 13,69
Ar 14,70
Ar 15,71
Vm 8,8,22
Vm 9,9,22
Vm 10,10,22
Vm 11,11,22
Vm 12,12,22
Vm 13,13,22
Vm 14,14,22
Vm 15,15,22
Aw 64,8
Aw 65,9
Aw 66,10
Aw 67,11
Aw 68,12
Aw 69,13
Aw 70,14
Aw 71,15
Ar 8,72
Ar 9,73
Ar 10,74
Ar 11,75
Ar 12,76
Ar 13,77
Ar 14,78
Ar 15,79
Vm 8,8,22
Vm 9,9,22
Vm 10,10,22
Vm 11,11,22
Vm 12,12,22
Vm 13,13,22
Vm 14,14,22
Vm 15,15,22
Aw 72,8
Aw 73,9
Aw 74,10
Aw 75,11
Aw 76,12
Aw 77,13
Aw 78,14
Aw 79,15
Ar 8,80
Ar 9,81
Ar 10,82
Ar 11,83
Ar 12,84
Ar 13,85
Ar 14,86
Ar 15,87
Vm 8,8,22
Vm 9,9,22
Vm 10,10,22
Vm 11,11,22
Vm 12,12,22
Vm 13,13,22
Vm 14,14,22
Vm 15,15,22
Aw 80,8
Aw 81,9
Aw 82,10
Aw 83,11
Aw 84,12
Aw 85,13
Aw 86,14
Aw 87,15
Ar 8,88
Ar 9,89
Ar 10,90
Ar 11,91
Ar 12,92
Ar 13,93
Ar 14,94
Ar 15,95
Vm 8,8,22
Vm 9,9,22
Vm 10,10,22
Vm 11,11,22
Vm 12,12,22
Vm 13,13,22
Vm 14,14,22
Vm 15,15,22
Aw 88,8
Aw 89,9
Aw 90,10
Aw 91,11
Aw 92,12
Aw 93,13
Aw 94,14
Aw 95,15
Ve 8,192
Ve 9,193
s_nop 0
Vc 96,8,9
Ve 8,194
Ve 9,195
s_nop 0
Vc 97,8,9
Ve 8,208
Ve 9,209
s_nop 0
Vc 104,8,9
Ve 8,210
Ve 9,211
s_nop 0
Vc 105,8,9
Ve 8,224
Ve 9,225
s_nop 0
Vc 112,8,9
Ve 8,226
Ve 9,227
s_nop 0
Vc 113,8,9
Ve 8,196
Ve 9,197
s_nop 0
Vc 98,8,9
Ve 8,198
Ve 9,199
s_nop 0
Vc 99,8,9
Ve 8,212
Ve 9,213
s_nop 0
Vc 106,8,9
Ve 8,214
Ve 9,215
s_nop 0
Vc 107,8,9
Ve 8,228
Ve 9,229
s_nop 0
Vc 114,8,9
Ve 8,230
Ve 9,231
s_nop 0
Vc 115,8,9
Ve 8,200
Ve 9,201
s_nop 0
Vc 100,8,9
Ve 8,202
Ve 9,203
s_nop 0
Vc 101,8,9
Ve 8,216
Ve 9,217
s_nop 0
Vc 108,8,9
Ve 8,218
Ve 9,219
s_nop 0
Vc 109,8,9
Ve 8,232
Ve 9,233
s_nop 0
Vc 116,8,9
Ve 8,234
Ve 9,235
s_nop 0
Vc 117,8,9
Ve 8,204
Ve 9,205
s_nop 0
Vc 102,8,9
Ve 8,206
Ve 9,207
s_nop 0
Vc 103,8,9
Ve 8,220
Ve 9,221
s_nop 0
Vc 110,8,9
Ve 8,222
Ve 9,223
s_nop 0
Vc 111,8,9
Ve 8,236
Ve 9,237
s_nop 0
Vc 118,8,9
Ve 8,238
Ve 9,239
s_nop 0
Vc 119,8,9
s_nop 1
s_branch L_k2_fbr_tr
L_k2_fb_ne:
s_nop 7
s_nop 0
v_max3_f32 v21, v128, v129, v130
v_max3_f32 v21, v21, v131, v132
v_max3_f32 v21, v21, v133, v134
v_max3_f32 v21, v21, v135, v136
v_max3_f32 v21, v21, v137, v138
v_max3_f32 v21, v21, v139, v140
v_max3_f32 v21, v21, v141, v142
v_max_f32 v21, v21, v143
v_mov_b32 v1, v21
s_nop 1
v_permlane16_swap_b32 v1, v21
v_max_f32 v21, v21, v1
v_mov_b32 v1, v21
s_nop 1
v_permlane32_swap_b32 v1, v21
v_max_f32_e64 v21, v21, v1
v_add_f32 v21, 0x41f80000, v21
v_max_f32 v21, 0, v21
Vs 128,128,21
Vs 129,129,21
Vs 130,130,21
Vs 131,131,21
Vs 132,132,21
Vs 133,133,21
Vs 134,134,21
Vs 135,135,21
Vs 136,136,21
Vs 137,137,21
Vs 138,138,21
Vs 139,139,21
Vs 140,140,21
Vs 141,141,21
Vs 142,142,21
Vs 143,143,21
Vs 192,192,21
Vs 193,193,21
Vs 194,194,21
Vs 195,195,21
Vs 196,196,21
Vs 197,197,21
Vs 198,198,21
Vs 199,199,21
Vs 200,200,21
Vs 201,201,21
Vs 202,202,21
Vs 203,203,21
Vs 204,204,21
Vs 205,205,21
Vs 206,206,21
Vs 207,207,21
Vs 32,32,21
Vs 33,33,21
Vs 34,34,21
v_sub_f32_e64 v35, v35, v21
v_exp_f32 v22, -v21
s_nop 0
Vm 48,48,22
Vm 49,49,22
Vm 50,50,22
v_mul_f32_e64 v51, v51, v22
Ar 8,0
Ar 9,1
Ar 10,2
Ar 11,3
Ar 12,4
Ar 13,5
Ar 14,6
Ar 15,7
Vm 8,8,22
Vm 9,9,22
Vm 10,10,22
Vm 11,11,22
Vm 12,12,22
Vm 13,13,22
Vm 14,14,22
Vm 15,15,22
Aw 0,8
Aw 1,9
Aw 2,10
Aw 3,11
Aw 4,12
Aw 5,13
Aw 6,14
Aw 7,15
Ar 8,8
Ar 9,9
Ar 10,10
Ar 11,11
Ar 12,12
Ar 13,13
Ar 14,14
Ar 15,15
Vm 8,8,22
Vm 9,9,22
Vm 10,10,22
Vm 11,11,22
Vm 12,12,22
Vm 13,13,22
Vm 14,14,22
Vm 15,15,22
Aw 8,8
Aw 9,9
Aw 10,10
Aw 11,11
Aw 12,12
Aw 13,13
Aw 14,14
Aw 15,15
Ar 8,16
Ar 9,17
Ar 10,18
Ar 11,19
Ar 12,20
Ar 13,21
Ar 14,22
Ar 15,23
Vm 8,8,22
Vm 9,9,22
Vm 10,10,22
Vm 11,11,22
Vm 12,12,22
Vm 13,13,22
Vm 14,14,22
Vm 15,15,22
Aw 16,8
Aw 17,9
Aw 18,10
Aw 19,11
Aw 20,12
Aw 21,13
Aw 22,14
Aw 23,15
Ar 8,24
Ar 9,25
Ar 10,26
Ar 11,27
Ar 12,28
Ar 13,29
Ar 14,30
Ar 15,31
Vm 8,8,22
Vm 9,9,22
Vm 10,10,22
Vm 11,11,22
Vm 12,12,22
Vm 13,13,22
Vm 14,14,22
Vm 15,15,22
Aw 24,8
Aw 25,9
Aw 26,10
Aw 27,11
Aw 28,12
Aw 29,13
Aw 30,14
Aw 31,15
v_max3_f32 v21, v144, v145, v146
v_max3_f32 v21, v21, v147, v148
v_max3_f32 v21, v21, v149, v150
v_max3_f32 v21, v21, v151, v152
v_max3_f32 v21, v21, v153, v154
v_max3_f32 v21, v21, v155, v156
v_max3_f32 v21, v21, v157, v158
v_max_f32 v21, v21, v159
v_mov_b32 v1, v21
s_nop 1
v_permlane16_swap_b32 v1, v21
v_max_f32 v21, v21, v1
v_mov_b32 v1, v21
s_nop 1
v_permlane32_swap_b32 v1, v21
v_max_f32_e64 v21, v21, v1
v_add_f32 v21, 0x41f80000, v21
v_max_f32 v21, 0, v21
Vs 144,144,21
Vs 145,145,21
Vs 146,146,21
Vs 147,147,21
Vs 148,148,21
Vs 149,149,21
Vs 150,150,21
Vs 151,151,21
Vs 152,152,21
Vs 153,153,21
Vs 154,154,21
Vs 155,155,21
Vs 156,156,21
Vs 157,157,21
Vs 158,158,21
Vs 159,159,21
Vs 208,208,21
Vs 209,209,21
Vs 210,210,21
Vs 211,211,21
Vs 212,212,21
Vs 213,213,21
Vs 214,214,21
Vs 215,215,21
Vs 216,216,21
Vs 217,217,21
Vs 218,218,21
Vs 219,219,21
Vs 220,220,21
Vs 221,221,21
Vs 222,222,21
Vs 223,223,21
Vs 36,36,21
Vs 37,37,21
Vs 38,38,21
v_sub_f32_e64 v39, v39, v21
v_exp_f32 v22, -v21
s_nop 0
Vm 52,52,22
Vm 53,53,22
Vm 54,54,22
v_mul_f32_e64 v55, v55, v22
Ar 8,32
Ar 9,33
Ar 10,34
Ar 11,35
Ar 12,36
Ar 13,37
Ar 14,38
Ar 15,39
Vm 8,8,22
Vm 9,9,22
Vm 10,10,22
Vm 11,11,22
Vm 12,12,22
Vm 13,13,22
Vm 14,14,22
Vm 15,15,22
Aw 32,8
Aw 33,9
Aw 34,10
Aw 35,11
Aw 36,12
Aw 37,13
Aw 38,14
Aw 39,15
Ar 8,40
Ar 9,41
Ar 10,42
Ar 11,43
Ar 12,44
Ar 13,45
Ar 14,46
Ar 15,47
Vm 8,8,22
Vm 9,9,22
Vm 10,10,22
Vm 11,11,22
Vm 12,12,22
Vm 13,13,22
Vm 14,14,22
Vm 15,15,22
Aw 40,8
Aw 41,9
Aw 42,10
Aw 43,11
Aw 44,12
Aw 45,13
Aw 46,14
Aw 47,15
Ar 8,48
Ar 9,49
Ar 10,50
Ar 11,51
Ar 12,52
Ar 13,53
Ar 14,54
Ar 15,55
Vm 8,8,22
Vm 9,9,22
Vm 10,10,22
Vm 11,11,22
Vm 12,12,22
Vm 13,13,22
Vm 14,14,22
Vm 15,15,22
Aw 48,8
Aw 49,9
Aw 50,10
Aw 51,11
Aw 52,12
Aw 53,13
Aw 54,14
Aw 55,15
Ar 8,56
Ar 9,57
Ar 10,58
Ar 11,59
Ar 12,60
Ar 13,61
Ar 14,62
Ar 15,63
Vm 8,8,22
Vm 9,9,22
Vm 10,10,22
Vm 11,11,22
Vm 12,12,22
Vm 13,13,22
Vm 14,14,22
Vm 15,15,22
Aw 56,8
Aw 57,9
Aw 58,10
Aw 59,11
Aw 60,12
Aw 61,13
Aw 62,14
Aw 63,15
Ve 8,128
Ve 9,129
s_nop 0
Vc 64,8,9
Ve 8,130
Ve 9,131
s_nop 0
Vc 65,8,9
Ve 8,144
Ve 9,145
s_nop 0
Vc 72,8,9
Ve 8,146
Ve 9,147
s_nop 0
Vc 73,8,9
Ve 8,132
Ve 9,133
s_nop 0
Vc 66,8,9
Ve 8,134
Ve 9,135
s_nop 0
Vc 67,8,9
Ve 8,148
Ve 9,149
s_nop 0
Vc 74,8,9
Ve 8,150
Ve 9,151
s_nop 0
Vc 75,8,9
Ve 8,136
Ve 9,137
s_nop 0
Vc 68,8,9
Ve 8,138
Ve 9,139
s_nop 0
Vc 69,8,9
Ve 8,152
Ve 9,153
s_nop 0
Vc 76,8,9
Ve 8,154
Ve 9,155
s_nop 0
Vc 77,8,9
Ve 8,140
Ve 9,141
s_nop 0
Vc 70,8,9
Ve 8,142
Ve 9,143
s_nop 0
Vc 71,8,9
Ve 8,156
Ve 9,157
s_nop 0
Vc 78,8,9
Ve 8,158
Ve 9,159
s_nop 0
Vc 79,8,9
s_nop 1
s_branch L_k2_fbr_ne
L_k2_fb_no:
s_nop 7
s_nop 0
v_max3_f32 v21, v192, v193, v194
v_max3_f32 v21, v21, v195, v196
v_max3_f32 v21, v21, v197, v198
v_max3_f32 v21, v21, v199, v200
v_max3_f32 v21, v21, v201, v202
v_max3_f32 v21, v21, v203, v204
v_max3_f32 v21, v21, v205, v206
v_max_f32 v21, v21, v207
v_mov_b32 v1, v21
s_nop 1
v_permlane16_swap_b32 v1, v21
v_max_f32 v21, v21, v1
v_mov_b32 v1, v21
s_nop 1
v_permlane32_swap_b32 v1, v21
v_max_f32_e64 v21, v21, v1
v_add_f32 v21, 0x41f80000, v21
v_max_f32 v21, 0, v21
Vs 192,192,21
Vs 193,193,21
Vs 194,194,21
Vs 195,195,21
Vs 196,196,21
Vs 197,197,21
Vs 198,198,21
Vs 199,199,21
Vs 200,200,21
Vs 201,201,21
Vs 202,202,21
Vs 203,203,21
Vs 204,204,21
Vs 205,205,21
Vs 206,206,21
Vs 207,207,21
Vs 128,128,21
Vs 129,129,21
Vs 130,130,21
Vs 131,131,21
Vs 132,132,21
Vs 133,133,21
Vs 134,134,21
Vs 135,135,21
Vs 136,136,21
Vs 137,137,21
Vs 138,138,21
Vs 139,139,21
Vs 140,140,21
Vs 141,141,21
Vs 142,142,21
Vs 143,143,21
Vs 32,32,21
Vs 33,33,21
Vs 34,34,21
v_sub_f32_e64 v35, v35, v21
v_exp_f32 v22, -v21
s_nop 0
Vm 48,48,22
Vm 49,49,22
Vm 50,50,22
v_mul_f32_e64 v51, v51, v22
Ar 8,0
Ar 9,1
Ar 10,2
Ar 11,3
Ar 12,4
Ar 13,5
Ar 14,6
Ar 15,7
Vm 8,8,22
Vm 9,9,22
Vm 10,10,22
Vm 11,11,22
Vm 12,12,22
Vm 13,13,22
Vm 14,14,22
Vm 15,15,22
Aw 0,8
Aw 1,9
Aw 2,10
Aw 3,11
Aw 4,12
Aw 5,13
Aw 6,14
Aw 7,15
Ar 8,8
Ar 9,9
Ar 10,10
Ar 11,11
Ar 12,12
Ar 13,13
Ar 14,14
Ar 15,15
Vm 8,8,22
Vm 9,9,22
Vm 10,10,22
Vm 11,11,22
Vm 12,12,22
Vm 13,13,22
Vm 14,14,22
Vm 15,15,22
Aw 8,8
Aw 9,9
Aw 10,10
Aw 11,11
Aw 12,12
Aw 13,13
Aw 14,14
Aw 15,15
Ar 8,16
Ar 9,17
Ar 10,18
Ar 11,19
Ar 12,20
Ar 13,21
Ar 14,22
Ar 15,23
Vm 8,8,22
Vm 9,9,22
Vm 10,10,22
Vm 11,11,22
Vm 12,12,22
Vm 13,13,22
Vm 14,14,22
Vm 15,15,22
Aw 16,8
Aw 17,9
Aw 18,10
Aw 19,11
Aw 20,12
Aw 21,13
Aw 22,14
Aw 23,15
Ar 8,24
Ar 9,25
Ar 10,26
Ar 11,27
Ar 12,28
Ar 13,29
Ar 14,30
Ar 15,31
Vm 8,8,22
Vm 9,9,22
Vm 10,10,22
Vm 11,11,22
Vm 12,12,22
Vm 13,13,22
Vm 14,14,22
Vm 15,15,22
Aw 24,8
Aw 25,9
Aw 26,10
Aw 27,11
Aw 28,12
Aw 29,13
Aw 30,14
Aw 31,15
v_max3_f32 v21, v208, v209, v210
v_max3_f32 v21, v21, v211, v212
v_max3_f32 v21, v21, v213, v214
v_max3_f32 v21, v21, v215, v216
v_max3_f32 v21, v21, v217, v218
v_max3_f32 v21, v21, v219, v220
v_max3_f32 v21, v21, v221, v222
v_max_f32 v21, v21, v223
v_mov_b32 v1, v21
s_nop 1
v_permlane16_swap_b32 v1, v21
v_max_f32 v21, v21, v1
v_mov_b32 v1, v21
s_nop 1
v_permlane32_swap_b32 v1, v21
v_max_f32_e64 v21, v21, v1
v_add_f32 v21, 0x41f80000, v21
v_max_f32 v21, 0, v21
Vs 208,208,21
Vs 209,209,21
Vs 210,210,21
Vs 211,211,21
Vs 212,212,21
Vs 213,213,21
Vs 214,214,21
Vs 215,215,21
Vs 216,216,21
Vs 217,217,21
Vs 218,218,21
Vs 219,219,21
Vs 220,220,21
Vs 221,221,21
Vs 222,222,21
Vs 223,223,21
Vs 144,144,21
Vs 145,145,21
Vs 146,146,21
Vs 147,147,21
Vs 148,148,21
Vs 149,149,21
Vs 150,150,21
Vs 151,151,21
Vs 152,152,21
Vs 153,153,21
Vs 154,154,21
Vs 155,155,21
Vs 156,156,21
Vs 157,157,21
Vs 158,158,21
Vs 159,159,21
Vs 36,36,21
Vs 37,37,21
Vs 38,38,21
v_sub_f32_e64 v39, v39, v21
v_exp_f32 v22, -v21
s_nop 0
Vm 52,52,22
Vm 53,53,22
Vm 54,54,22
v_mul_f32_e64 v55, v55, v22
Ar 8,32
Ar 9,33
Ar 10,34
Ar 11,35
Ar 12,36
Ar 13,37
Ar 14,38
Ar 15,39
Vm 8,8,22
Vm 9,9,22
Vm 10,10,22
Vm 11,11,22
Vm 12,12,22
Vm 13,13,22
Vm 14,14,22
Vm 15,15,22
Aw 32,8
Aw 33,9
Aw 34,10
Aw 35,11
Aw 36,12
Aw 37,13
Aw 38,14
Aw 39,15
Ar 8,40
Ar 9,41
Ar 10,42
Ar 11,43
Ar 12,44
Ar 13,45
Ar 14,46
Ar 15,47
Vm 8,8,22
Vm 9,9,22
Vm 10,10,22
Vm 11,11,22
Vm 12,12,22
Vm 13,13,22
Vm 14,14,22
Vm 15,15,22
Aw 40,8
Aw 41,9
Aw 42,10
Aw 43,11
Aw 44,12
Aw 45,13
Aw 46,14
Aw 47,15
Ar 8,48
Ar 9,49
Ar 10,50
Ar 11,51
Ar 12,52
Ar 13,53
Ar 14,54
Ar 15,55
Vm 8,8,22
Vm 9,9,22
Vm 10,10,22
Vm 11,11,22
Vm 12,12,22
Vm 13,13,22
Vm 14,14,22
Vm 15,15,22
Aw 48,8
Aw 49,9
Aw 50,10
Aw 51,11
Aw 52,12
Aw 53,13
Aw 54,14
Aw 55,15
Ar 8,56
Ar 9,57
Ar 10,58
Ar 11,59
Ar 12,60
Ar 13,61
Ar 14,62
Ar 15,63
Vm 8,8,22
Vm 9,9,22
Vm 10,10,22
Vm 11,11,22
Vm 12,12,22
Vm 13,13,22
Vm 14,14,22
Vm 15,15,22
Aw 56,8
Aw 57,9
Aw 58,10
Aw 59,11
Aw 60,12
Aw 61,13
Aw 62,14
Aw 63,15
Ve 8,192
Ve 9,193
s_nop 0
Vc 96,8,9
Ve 8,194
Ve 9,195
s_nop 0
Vc 97,8,9
Ve 8,208
Ve 9,209
s_nop 0
Vc 104,8,9
Ve 8,210
Ve 9,211
s_nop 0
Vc 105,8,9
Ve 8,196
Ve 9,197
s_nop 0
Vc 98,8,9
Ve 8,198
Ve 9,199
s_nop 0
Vc 99,8,9
Ve 8,212
Ve 9,213
s_nop 0
Vc 106,8,9
Ve 8,214
Ve 9,215
s_nop 0
Vc 107,8,9
Ve 8,200
Ve 9,201
s_nop 0
Vc 100,8,9
Ve 8,202
Ve 9,203
s_nop 0
Vc 101,8,9
Ve 8,216
Ve 9,217
s_nop 0
Vc 108,8,9
Ve 8,218
Ve 9,219
s_nop 0
Vc 109,8,9
Ve 8,204
Ve 9,205
s_nop 0
Vc 102,8,9
Ve 8,206
Ve 9,207
s_nop 0
Vc 103,8,9
Ve 8,220
Ve 9,221
s_nop 0
Vc 110,8,9
Ve 8,222
Ve 9,223
s_nop 0
Vc 111,8,9
s_nop 1
s_branch L_k2_fbr_no
L_k2_fb_nl:
s_nop 7
s_nop 0
v_max3_f32 v21, v128, v129, v130
v_max3_f32 v21, v21, v131, v132
v_max3_f32 v21, v21, v133, v134
v_max3_f32 v21, v21, v135, v136
v_max3_f32 v21, v21, v137, v138
v_max3_f32 v21, v21, v139, v140
v_max3_f32 v21, v21, v141, v142
v_max_f32 v21, v21, v143
v_mov_b32 v1, v21
s_nop 1
v_permlane16_swap_b32 v1, v21
v_max_f32 v21, v21, v1
v_mov_b32 v1, v21
s_nop 1
v_permlane32_swap_b32 v1, v21
v_max_f32_e64 v21, v21, v1
v_add_f32 v21, 0x41f80000, v21
v_max_f32 v21, 0, v21
Vs 128,128,21
Vs 129,129,21
Vs 130,130,21
Vs 131,131,21
Vs 132,132,21
Vs 133,133,21
Vs 134,134,21
Vs 135,135,21
Vs 136,136,21
Vs 137,137,21
Vs 138,138,21
Vs 139,139,21
Vs 140,140,21
Vs 141,141,21
Vs 142,142,21
Vs 143,143,21
Vs 192,192,21
Vs 193,193,21
Vs 194,194,21
Vs 195,195,21
Vs 196,196,21
Vs 197,197,21
Vs 198,198,21
Vs 199,199,21
Vs 200,200,21
Vs 201,201,21
Vs 202,202,21
Vs 203,203,21
Vs 204,204,21
Vs 205,205,21
Vs 206,206,21
Vs 207,207,21
Vs 32,32,21
Vs 33,33,21
Vs 34,34,21
v_sub_f32_e64 v35, v35, v21
v_exp_f32 v22, -v21
s_nop 0
Vm 48,48,22
Vm 49,49,22
Vm 50,50,22
v_mul_f32_e64 v51, v51, v22
Ar 8,0
Ar 9,1
Ar 10,2
Ar 11,3
Ar 12,4
Ar 13,5
Ar 14,6
Ar 15,7
Vm 8,8,22
Vm 9,9,22
Vm 10,10,22
Vm 11,11,22
Vm 12,12,22
Vm 13,13,22
Vm 14,14,22
Vm 15,15,22
Aw 0,8
Aw 1,9
Aw 2,10
Aw 3,11
Aw 4,12
Aw 5,13
Aw 6,14
Aw 7,15
Ar 8,8
Ar 9,9
Ar 10,10
Ar 11,11
Ar 12,12
Ar 13,13
Ar 14,14
Ar 15,15
Vm 8,8,22
Vm 9,9,22
Vm 10,10,22
Vm 11,11,22
Vm 12,12,22
Vm 13,13,22
Vm 14,14,22
Vm 15,15,22
Aw 8,8
Aw 9,9
Aw 10,10
Aw 11,11
Aw 12,12
Aw 13,13
Aw 14,14
Aw 15,15
Ar 8,16
Ar 9,17
Ar 10,18
Ar 11,19
Ar 12,20
Ar 13,21
Ar 14,22
Ar 15,23
Vm 8,8,22
Vm 9,9,22
Vm 10,10,22
Vm 11,11,22
Vm 12,12,22
Vm 13,13,22
Vm 14,14,22
Vm 15,15,22
Aw 16,8
Aw 17,9
Aw 18,10
Aw 19,11
Aw 20,12
Aw 21,13
Aw 22,14
Aw 23,15
Ar 8,24
Ar 9,25
Ar 10,26
Ar 11,27
Ar 12,28
Ar 13,29
Ar 14,30
Ar 15,31
Vm 8,8,22
Vm 9,9,22
Vm 10,10,22
Vm 11,11,22
Vm 12,12,22
Vm 13,13,22
Vm 14,14,22
Vm 15,15,22
Aw 24,8
Aw 25,9
Aw 26,10
Aw 27,11
Aw 28,12
Aw 29,13
Aw 30,14
Aw 31,15
v_max3_f32 v21, v144, v145, v146
v_max3_f32 v21, v21, v147, v148
v_max3_f32 v21, v21, v149, v150
v_max3_f32 v21, v21, v151, v152
v_max3_f32 v21, v21, v153, v154
v_max3_f32 v21, v21, v155, v156
v_max3_f32 v21, v21, v157, v158
v_max_f32 v21, v21, v159
v_mov_b32 v1, v21
s_nop 1
v_permlane16_swap_b32 v1, v21
v_max_f32 v21, v21, v1
v_mov_b32 v1, v21
s_nop 1
v_permlane32_swap_b32 v1, v21
v_max_f32_e64 v21, v21, v1
v_add_f32 v21, 0x41f80000, v21
v_max_f32 v21, 0, v21
Vs 144,144,21
Vs 145,145,21
Vs 146,146,21
Vs 147,147,21
Vs 148,148,21
Vs 149,149,21
Vs 150,150,21
Vs 151,151,21
Vs 152,152,21
Vs 153,153,21
Vs 154,154,21
Vs 155,155,21
Vs 156,156,21
Vs 157,157,21
Vs 158,158,21
Vs 159,159,21
Vs 36,36,21
Vs 37,37,21
Vs 38,38,21
v_sub_f32_e64 v39, v39, v21
v_exp_f32 v22, -v21
s_nop 0
Vm 52,52,22
Vm 53,53,22
Vm 54,54,22
v_mul_f32_e64 v55, v55, v22
Ar 8,32
Ar 9,33
Ar 10,34
Ar 11,35
Ar 12,36
Ar 13,37
Ar 14,38
Ar 15,39
Vm 8,8,22
Vm 9,9,22
Vm 10,10,22
Vm 11,11,22
Vm 12,12,22
Vm 13,13,22
Vm 14,14,22
Vm 15,15,22
Aw 32,8
Aw 33,9
Aw 34,10
Aw 35,11
Aw 36,12
Aw 37,13
Aw 38,14
Aw 39,15
Ar 8,40
Ar 9,41
Ar 10,42
Ar 11,43
Ar 12,44
Ar 13,45
Ar 14,46
Ar 15,47
Vm 8,8,22
Vm 9,9,22
Vm 10,10,22
Vm 11,11,22
Vm 12,12,22
Vm 13,13,22
Vm 14,14,22
Vm 15,15,22
Aw 40,8
Aw 41,9
Aw 42,10
Aw 43,11
Aw 44,12
Aw 45,13
Aw 46,14
Aw 47,15
Ar 8,48
Ar 9,49
Ar 10,50
Ar 11,51
Ar 12,52
Ar 13,53
Ar 14,54
Ar 15,55
Vm 8,8,22
Vm 9,9,22
Vm 10,10,22
Vm 11,11,22
Vm 12,12,22
Vm 13,13,22
Vm 14,14,22
Vm 15,15,22
Aw 48,8
Aw 49,9
Aw 50,10
Aw 51,11
Aw 52,12
Aw 53,13
Aw 54,14
Aw 55,15
Ar 8,56
Ar 9,57
Ar 10,58
Ar 11,59
Ar 12,60
Ar 13,61
Ar 14,62
Ar 15,63
Vm 8,8,22
Vm 9,9,22
Vm 10,10,22
Vm 11,11,22
Vm 12,12,22
Vm 13,13,22
Vm 14,14,22
Vm 15,15,22
Aw 56,8
Aw 57,9
Aw 58,10
Aw 59,11
Aw 60,12
Aw 61,13
Aw 62,14
Aw 63,15
Ve 8,128
Ve 9,129
s_nop 0
Vc 64,8,9
Ve 8,130
Ve 9,131
s_nop 0
Vc 65,8,9
Ve 8,144
Ve 9,145
s_nop 0
Vc 72,8,9
Ve 8,146
Ve 9,147
s_nop 0
Vc 73,8,9
Ve 8,132
Ve 9,133
s_nop 0
Vc 66,8,9
Ve 8,134
Ve 9,135
s_nop 0
Vc 67,8,9
Ve 8,148
Ve 9,149
s_nop 0
Vc 74,8,9
Ve 8,150
Ve 9,151
s_nop 0
Vc 75,8,9
Ve 8,136
Ve 9,137
s_nop 0
Vc 68,8,9
Ve 8,138
Ve 9,139
s_nop 0
Vc 69,8,9
Ve 8,152
Ve 9,153
s_nop 0
Vc 76,8,9
Ve 8,154
Ve 9,155
s_nop 0
Vc 77,8,9
Ve 8,140
Ve 9,141
s_nop 0
Vc 70,8,9
Ve 8,142
Ve 9,143
s_nop 0
Vc 71,8,9
Ve 8,156
Ve 9,157
s_nop 0
Vc 78,8,9
Ve 8,158
Ve 9,159
s_nop 0
Vc 79,8,9
s_nop 1
s_branch L_k2_fbr_nl
L_k2_fb_fi:
s_nop 7
s_nop 0
v_max3_f32 v21, v192, v193, v194
v_max3_f32 v21, v21, v195, v196
v_max3_f32 v21, v21, v197, v198
v_max3_f32 v21, v21, v199, v200
v_max3_f32 v21, v21, v201, v202
v_max3_f32 v21, v21, v203, v204
v_max3_f32 v21, v21, v205, v206
v_max_f32 v21, v21, v207
v_mov_b32 v1, v21
s_nop 1
v_permlane16_swap_b32 v1, v21
v_max_f32 v21, v21, v1
v_mov_b32 v1, v21
s_nop 1
v_permlane32_swap_b32 v1, v21
v_max_f32_e64 v21, v21, v1
v_add_f32 v21, 0x41f80000, v21
v_max_f32 v21, 0, v21
Vs 192,192,21
Vs 193,193,21
Vs 194,194,21
Vs 195,195,21
Vs 196,196,21
Vs 197,197,21
Vs 198,198,21
Vs 199,199,21
Vs 200,200,21
Vs 201,201,21
Vs 202,202,21
Vs 203,203,21
Vs 204,204,21
Vs 205,205,21
Vs 206,206,21
Vs 207,207,21
Vs 32,32,21
Vs 33,33,21
Vs 34,34,21
v_sub_f32_e64 v35, v35, v21
v_exp_f32 v22, -v21
s_nop 0
Vm 48,48,22
Vm 49,49,22
Vm 50,50,22
v_mul_f32_e64 v51, v51, v22
Ar 8,0
Ar 9,1
Ar 10,2
Ar 11,3
Ar 12,4
Ar 13,5
Ar 14,6
Ar 15,7
Vm 8,8,22
Vm 9,9,22
Vm 10,10,22
Vm 11,11,22
Vm 12,12,22
Vm 13,13,22
Vm 14,14,22
Vm 15,15,22
Aw 0,8
Aw 1,9
Aw 2,10
Aw 3,11
Aw 4,12
Aw 5,13
Aw 6,14
Aw 7,15
Ar 8,8
Ar 9,9
Ar 10,10
Ar 11,11
Ar 12,12
Ar 13,13
Ar 14,14
Ar 15,15
Vm 8,8,22
Vm 9,9,22
Vm 10,10,22
Vm 11,11,22
Vm 12,12,22
Vm 13,13,22
Vm 14,14,22
Vm 15,15,22
Aw 8,8
Aw 9,9
Aw 10,10
Aw 11,11
Aw 12,12
Aw 13,13
Aw 14,14
Aw 15,15
Ar 8,16
Ar 9,17
Ar 10,18
Ar 11,19
Ar 12,20
Ar 13,21
Ar 14,22
Ar 15,23
Vm 8,8,22
Vm 9,9,22
Vm 10,10,22
Vm 11,11,22
Vm 12,12,22
Vm 13,13,22
Vm 14,14,22
Vm 15,15,22
Aw 16,8
Aw 17,9
Aw 18,10
Aw 19,11
Aw 20,12
Aw 21,13
Aw 22,14
Aw 23,15
Ar 8,24
Ar 9,25
Ar 10,26
Ar 11,27
Ar 12,28
Ar 13,29
Ar 14,30
Ar 15,31
Vm 8,8,22
Vm 9,9,22
Vm 10,10,22
Vm 11,11,22
Vm 12,12,22
Vm 13,13,22
Vm 14,14,22
Vm 15,15,22
Aw 24,8
Aw 25,9
Aw 26,10
Aw 27,11
Aw 28,12
Aw 29,13
Aw 30,14
Aw 31,15
Ve 8,192
Ve 9,193
s_nop 0
Vc 96,8,9
Ve 8,194
Ve 9,195
s_nop 0
Vc 97,8,9
Ve 8,196
Ve 9,197
s_nop 0
Vc 98,8,9
Ve 8,198
Ve 9,199
s_nop 0
Vc 99,8,9
Ve 8,200
Ve 9,201
s_nop 0
Vc 100,8,9
Ve 8,202
Ve 9,203
s_nop 0
Vc 101,8,9
Ve 8,204
Ve 9,205
s_nop 0
Vc 102,8,9
Ve 8,206
Ve 9,207
s_nop 0
Vc 103,8,9
s_nop 1
s_branch L_k2_fbr_fi
L_spinX:
s_mov_b32 s47, 0x400000
L_spinXl:
buffer_load_dword v17, v126, s[20:23], s24 offen sc1
s_sub_u32 s47, s47, 1
s_waitcnt vmcnt(0)
s_cmp_eq_u32 s47, 0
s_cbranch_scc1 L_spinXlx
v_cmp_ne_u32 vcc, 1, v17
s_cbranch_vccz L_spinXlx
s_sleep 1
s_branch L_spinXl
L_spinXlx:
buffer_load_dwordx4 v[160:163], v112, s[16:19], s25 offen offset:0 sc1
buffer_load_dwordx4 v[164:167], v112, s[16:19], s25 offen offset:1024 sc1
buffer_load_dwordx4 v[168:171], v112, s[16:19], s25 offen offset:2048 sc1
buffer_load_dwordx4 v[172:175], v112, s[16:19], s25 offen offset:3072 sc1
buffer_load_dwordx4 v[176:179], v10, s[16:19], s25 offen offset:0 sc1
buffer_load_dwordx4 v[180:183], v10, s[16:19], s25 offen offset:1024 sc1
buffer_load_dwordx4 v[184:187], v10, s[16:19], s25 offen offset:2048 sc1
buffer_load_dwordx4 v[188:191], v10, s[16:19], s25 offen offset:3072 sc1
s_branch L_spinXr
L_ysl:
s_mov_b32 s47, 0x400000
L_ysll:
buffer_load_dword v124, v127, s[20:23], s41 offen sc1
s_sub_u32 s47, s47, 1
s_waitcnt vmcnt(0)
s_cmp_eq_u32 s47, 0
s_cbranch_scc1 L_ysllx
v_cmp_ne_u32 vcc, 1, v124
s_cbranch_vccz L_ysllx
s_sleep 8
s_branch L_ysll
L_ysllx:
v_lshlrev_b32 v124, 2, v0
v_lshlrev_b32 v125, 1, v0
s_lshl_b32 s7, s45, 2
s_add_u32 s7, s7, s32
s_lshr_b32 s3, s42, 5
s_cmp_lg_u32 s3, s7
s_cbranch_scc1 L_f_yl13
s_add_u32 s3, s55, 0
s_nop 0
s_add_u32 s7, s3, 4096
buffer_load_dword v76, v124, s[20:23], s3 offen offset:0 sc1
buffer_load_dword v77, v124, s[20:23], s3 offen offset:512 sc1
buffer_load_dword v78, v124, s[20:23], s3 offen offset:1024 sc1
buffer_load_dword v79, v124, s[20:23], s3 offen offset:1536 sc1
buffer_load_dword v80, v124, s[20:23], s3 offen offset:2048 sc1
buffer_load_dword v81, v124, s[20:23], s3 offen offset:2560 sc1
buffer_load_dword v82, v124, s[20:23], s3 offen offset:3072 sc1
buffer_load_dword v83, v124, s[20:23], s3 offen offset:3584 sc1
buffer_load_dword v84, v124, s[20:23], s7 offen offset:0 sc1
buffer_load_dword v85, v124, s[20:23], s7 offen offset:512 sc1
buffer_load_dword v86, v124, s[20:23], s7 offen offset:1024 sc1
buffer_load_dword v87, v124, s[20:23], s7 offen offset:1536 sc1
buffer_load_dword v88, v124, s[20:23], s7 offen offset:2048 sc1
buffer_load_dword v89, v124, s[20:23], s7 offen offset:2560 sc1
s_lshl_b32 s3, s42, 11
s_lshl_b32 s7, s46, 7
s_add_u32 s3, s3, s7
buffer_load_ushort v90, v125, s[56:59], s3 offen
s_lshl_b32 s3, s42, 3
s_add_u32 s3, s3, 5259264
buffer_load_dwordx2 v[92:93], v126, s[20:23], s3 offen sc1
L_f_yl13:
s_lshl_b32 s7, s45, 2
s_add_u32 s7, s7, s32
s_lshr_b32 s3, s43, 5
s_cmp_lg_u32 s3, s7
s_cbranch_scc1 L_f_yl14
s_nop 0
s_add_u32 s3, s55, 256
s_add_u32 s7, s3, 4096
buffer_load_dword v94, v124, s[20:23], s3 offen offset:0 sc1
buffer_load_dword v95, v124, s[20:23], s3 offen offset:512 sc1
buffer_load_dword v96, v124, s[20:23], s3 offen offset:1024 sc1
buffer_load_dword v97, v124, s[20:23], s3 offen offset:1536 sc1
buffer_load_dword v98, v124, s[20:23], s3 offen offset:2048 sc1
buffer_load_dword v99, v124, s[20:23], s3 offen offset:2560 sc1
buffer_load_dword v100, v124, s[20:23], s3 offen offset:3072 sc1
buffer_load_dword v101, v124, s[20:23], s3 offen offset:3584 sc1
buffer_load_dword v102, v124, s[20:23], s7 offen offset:0 sc1
buffer_load_dword v103, v124, s[20:23], s7 offen offset:512 sc1
buffer_load_dword v104, v124, s[20:23], s7 offen offset:1024 sc1
buffer_load_dword v105, v124, s[20:23], s7 offen offset:1536 sc1
buffer_load_dword v106, v124, s[20:23], s7 offen offset:2048 sc1
buffer_load_dword v107, v124, s[20:23], s7 offen offset:2560 sc1
s_lshl_b32 s3, s43, 11
s_lshl_b32 s7, s46, 7
s_add_u32 s3, s3, s7
buffer_load_ushort v108, v125, s[56:59], s3 offen
s_lshl_b32 s3, s43, 3
s_add_u32 s3, s3, 5259264
buffer_load_dwordx2 v[110:111], v126, s[20:23], s3 offen sc1
L_f_yl14:
s_waitcnt vmcnt(0)
s_lshl_b32 s7, s45, 2
s_add_u32 s7, s7, s32
s_lshr_b32 s3, s42, 5
s_cmp_lg_u32 s3, s7
s_cbranch_scc1 L_f_ys15
v_pk_add_f32 v[76:77], v[76:77], v[78:79]
v_pk_add_f32 v[76:77], v[76:77], v[80:81]
v_pk_add_f32 v[76:77], v[76:77], v[82:83]
v_pk_add_f32 v[76:77], v[76:77], v[84:85]
v_pk_add_f32 v[76:77], v[76:77], v[86:87]
v_pk_add_f32 v[76:77], v[76:77], v[88:89]
Va 76,76,77
v_lshlrev_b32 v90, 16, v90
v_sub_f32_e64 v90, v90, v92
Vc 76,76,76
v_lshlrev_b32_e64 v76, 16, v76
Vc 90,90,90
v_lshlrev_b32 v90, 16, v90
v_mul_f32 v76, s100, v76
v_mul_f32_e64 v90, v90, v93
Vc 76,76,76
v_lshlrev_b32_e64 v76, 16, v76
Vc 90,90,90
v_lshlrev_b32 v90, 16, v90
Va 90,90,76
Vc 90,90,90
v_lshlrev_b32_e64 v90, 16, v90
v_mul_f32 v76, 0xbfb8aa3b, v90
Ve 76,76
s_nop 0
v_add_f32 v76, 1.0, v76
v_rcp_f32 v76, v76
s_nop 0
Vm 90,90,76
Vc 90,90,90
v_lshlrev_b32 v90, 16, v90
v_lshlrev_b32 v124, 2, v0
v_add_u32 v124, s35, v124
v_lshlrev_b32 v125, 5, v122
v_add_u32 v125, s35, v125
s_waitcnt lgkmcnt(0)
ds_write_b32 v124, v90
s_and_b32 s3, s42, 7
s_lshl_b32 s3, s3, 3
s_lshl_b64 s[4:5], 0xff, s3
s_bfe_u32 s3, s42, 0x20003
s_mov_b64 exec, s[4:5]
s_cmp_lg_u32 s3, 0
s_cbranch_scc1 L_f_yp16
ds_read_b64 v[42:43], v125
ds_read_b64 v[44:45], v125 offset:8
ds_read_b64 v[46:47], v125 offset:16
ds_read_b64 v[48:49], v125 offset:24
L_f_yp16:
s_cmp_lg_u32 s3, 1
s_cbranch_scc1 L_f_yp17
ds_read_b64 v[50:51], v125
ds_read_b64 v[52:53], v125 offset:8
ds_read_b64 v[54:55], v125 offset:16
ds_read_b64 v[56:57], v125 offset:24
L_f_yp17:
s_cmp_lg_u32 s3, 2
s_cbranch_scc1 L_f_yp18
ds_read_b64 v[58:59], v125
ds_read_b64 v[60:61], v125 offset:8
ds_read_b64 v[62:63], v125 offset:16
ds_read_b64 v[64:65], v125 offset:24
L_f_yp18:
s_cmp_lg_u32 s3, 3
s_cbranch_scc1 L_f_yp19
ds_read_b64 v[66:67], v125
ds_read_b64 v[68:69], v125 offset:8
s_waitcnt lgkmcnt(9)
ds_read_b64 v[70:71], v125 offset:16
ds_read_b64 v[72:73], v125 offset:24
L_f_yp19:
s_mov_b64 exec, -1
s_waitcnt lgkmcnt(0)
L_f_ys15:
s_lshl_b32 s7, s45, 2
s_add_u32 s7, s7, s32
s_lshr_b32 s3, s43, 5
s_cmp_lg_u32 s3, s7
s_cbranch_scc1 L_f_ys20
s_nop 0
v_pk_add_f32 v[94:95], v[94:95], v[96:97]
v_pk_add_f32 v[94:95], v[94:95], v[98:99]
v_pk_add_f32 v[94:95], v[94:95], v[100:101]
v_pk_add_f32 v[94:95], v[94:95], v[102:103]
v_pk_add_f32 v[94:95], v[94:95], v[104:105]
v_pk_add_f32 v[94:95], v[94:95], v[106:107]
Va 94,94,95
v_lshlrev_b32 v108, 16, v108
v_sub_f32_e64 v108, v108, v110
Vc 94,94,94
v_lshlrev_b32_e64 v94, 16, v94
Vc 108,108,108
v_lshlrev_b32 v108, 16, v108
v_mul_f32 v94, s101, v94
v_mul_f32_e64 v108, v108, v111
Vc 94,94,94
v_lshlrev_b32_e64 v94, 16, v94
Vc 108,108,108
v_lshlrev_b32 v108, 16, v108
Va 108,108,94
Vc 108,108,108
v_lshlrev_b32_e64 v108, 16, v108
v_mul_f32 v94, 0xbfb8aa3b, v108
Ve 94,94
s_nop 0
v_add_f32 v94, 1.0, v94
v_rcp_f32 v94, v94
s_nop 0
Vm 108,108,94
Vc 108,108,108
v_lshlrev_b32 v108, 16, v108
v_lshlrev_b32 v124, 2, v0
v_add_u32 v124, s35, v124
v_lshlrev_b32 v125, 5, v122
v_add_u32 v125, s35, v125
s_waitcnt lgkmcnt(0)
ds_write_b32 v124, v108
s_and_b32 s3, s43, 7
s_lshl_b32 s3, s3, 3
s_lshl_b64 s[4:5], 0xff, s3
s_bfe_u32 s3, s43, 0x20003
s_mov_b64 exec, s[4:5]
s_cmp_lg_u32 s3, 0
s_cbranch_scc1 L_f_yp21
ds_read_b64 v[42:43], v125
ds_read_b64 v[44:45], v125 offset:8
ds_read_b64 v[46:47], v125 offset:16
ds_read_b64 v[48:49], v125 offset:24
L_f_yp21:
s_cmp_lg_u32 s3, 1
s_cbranch_scc1 L_f_yp22
ds_read_b64 v[50:51], v125
ds_read_b64 v[52:53], v125 offset:8
ds_read_b64 v[54:55], v125 offset:16
ds_read_b64 v[56:57], v125 offset:24
L_f_yp22:
s_cmp_lg_u32 s3, 2
s_cbranch_scc1 L_f_yp23
ds_read_b64 v[58:59], v125
ds_read_b64 v[60:61], v125 offset:8
ds_read_b64 v[62:63], v125 offset:16
ds_read_b64 v[64:65], v125 offset:24
L_f_yp23:
s_cmp_lg_u32 s3, 3
s_cbranch_scc1 L_f_yp24
ds_read_b64 v[66:67], v125
ds_read_b64 v[68:69], v125 offset:8
s_waitcnt lgkmcnt(9)
ds_read_b64 v[70:71], v125 offset:16
ds_read_b64 v[72:73], v125 offset:24
L_f_yp24:
s_mov_b64 exec, -1
s_waitcnt lgkmcnt(0)
L_f_ys20:
s_branch L_yslr
.section .rodata,"a"
.p2align 6
.amdhsa_kernel recurrent_scan__compressed_kv_cla__moe_arch_mod__prompt_kernel
  .amdhsa_next_free_vgpr 512
  .amdhsa_next_free_sgpr 102
  .amdhsa_accum_offset 256
  .amdhsa_group_segment_fixed_size 0
  .amdhsa_kernarg_size 112
  .amdhsa_user_sgpr_count 2
  .amdhsa_user_sgpr_kernarg_segment_ptr 1
  .amdhsa_system_sgpr_workgroup_id_x 1
.end_amdhsa_kernel
```

```asm
; @launch grid=(256,1,1) block=(256,1,1) lds=163840
.amdgcn_target "amdgcn-amd-amdhsa--gfx950"
.macro Va d,x,y
v_add_f32 v\d, v\x, v\y
.endm
.macro Vc d,x,y
v_cvt_pk_bf16_f32 v\d, v\x, v\y
.endm
.macro Ra d,x,o
ds_read_b128 a[\d:\d+3], v\x offset:\o
.endm
.macro Ta d,x,o
ds_read_b64_tr_b16 a[\d:\d+1], v\x offset:\o
.endm
.macro Zvaa d,x,y
v_mfma_f32_16x16x32_bf16 v[\d:\d+3], a[\x:\x+3], a[\y:\y+3], 0
.endm
.macro Mvaa d,x,y
v_mfma_f32_16x16x32_bf16 v[\d:\d+3], a[\x:\x+3], a[\y:\y+3], v[\d:\d+3]
.endm
.macro Rv d,x,o
ds_read_b128 v[\d:\d+3], v\x offset:\o
.endm
.macro Zaaa d,x,y
v_mfma_f32_16x16x32_bf16 a[\d:\d+3], a[\x:\x+3], a[\y:\y+3], 0
.endm
.macro Maaa d,x,y
v_mfma_f32_16x16x32_bf16 a[\d:\d+3], a[\x:\x+3], a[\y:\y+3], a[\d:\d+3]
.endm
.macro Ar d,x
v_accvgpr_read_b32 v\d, a\x
.endm
.macro Ve d,x
v_exp_f32 v\d, v\x
.endm
.macro Aw d,x
v_accvgpr_write_b32 a\d, v\x
.endm
.macro Vs d,x,y
v_sub_f32 v\d, v\x, v\y
.endm
.macro Cvaa d,x,y,c
v_mfma_f32_16x16x32_bf16 v[\d:\d+3], a[\x:\x+3], a[\y:\y+3], v[\c:\c+3]
.endm
.macro VE d,x
v_exp_f32_e64 v\d, v\x
.endm
.macro Maav d,x,y
v_mfma_f32_16x16x32_bf16 a[\d:\d+3], a[\x:\x+3], v[\y:\y+3], a[\d:\d+3]
.endm
.macro Mvvv d,x,y
v_mfma_f32_16x16x32_bf16 v[\d:\d+3], v[\x:\x+3], v[\y:\y+3], v[\d:\d+3]
.endm
.macro Zvva d,x,y
v_mfma_f32_16x16x32_bf16 v[\d:\d+3], v[\x:\x+3], a[\y:\y+3], 0
.endm
.macro Mvva d,x,y
v_mfma_f32_16x16x32_bf16 v[\d:\d+3], v[\x:\x+3], a[\y:\y+3], v[\d:\d+3]
.endm
.macro Vm d,x,y
v_mul_f32 v\d, v\x, v\y
.endm
.macro Zvvv d,x,y
v_mfma_f32_16x16x32_bf16 v[\d:\d+3], v[\x:\x+3], v[\y:\y+3], 0
.endm
.text
.globl recurrent_scan__compressed_kv_cla__moe_arch_mod__prompt_kernel
.p2align 8
.type recurrent_scan__compressed_kv_cla__moe_arch_mod__prompt_kernel,@function
recurrent_scan__compressed_kv_cla__moe_arch_mod__prompt_kernel:
s_cmp_ge_u32 s2, 256
s_cbranch_scc1 L_k2_end
s_load_dwordx4 s[4:7], s[0:1], 0
s_load_dwordx2 s[44:45], s[0:1], 56
s_load_dwordx4 s[40:43], s[0:1], 24
s_load_dwordx4 s[64:67], s[0:1], 96
v_lshrrev_b32 v1, 6, v0
v_and_b32 v0, 63, v0
v_readfirstlane_b32 s32, v1
s_getpc_b64 s[68:69]
L_cpf1:
s_add_u32 s68, s68, (recurrent_scan__compressed_kv_cla__moe_arch_mod__prompt_kernel-L_cpf1)&0xffffffff
s_addc_u32 s69, s69, ((recurrent_scan__compressed_kv_cla__moe_arch_mod__prompt_kernel-L_cpf1)>>32)&0xffffffff
s_lshr_b32 s70, s2, 3
s_lshl_b32 s70, s70, 2
s_add_u32 s70, s70, s32
s_lshl_b32 s70, s70, 10
v_and_b32 v122, 7, v0
v_lshlrev_b32 v122, 7, v122
v_add_u32 v122, s70, v122
v_min_u32 v122, L_k2_fin-recurrent_scan__compressed_kv_cla__moe_arch_mod__prompt_kernel-4, v122
v_mov_b32 v121, s69
v_add_co_u32 v120, vcc, s68, v122
s_nop 1
v_addc_co_u32 v121, vcc, 0, v121, vcc
global_load_dword v124, v[120:121], off
v_lshrrev_b32 v33, 5, v0
v_and_b32 v31, 31, v0
v_lshlrev_b32_e64 v36, 4, v31
v_lshl_add_u32 v35, v33, 11, v36
s_lshl_b32 s36, s2, 14
s_lshl_b32 s37, s32, 12
s_add_u32 s36, s36, s37
s_mov_b32 s18, 4194304
s_mov_b32 s19, 0x20000
s_bfe_u32 s33, s2, 0x30003
s_lshr_b32 s35, s2, 7
s_bfe_u32 s3, s2, 0x10006
s_and_b32 s34, s2, 7
s_lshl_b32 s34, s34, 1
s_add_u32 s34, s34, s3
s_waitcnt lgkmcnt(0)
s_mov_b32 s16, s4
s_and_b32 s17, s5, 0xffff
buffer_load_dwordx4 v[48:51], v35, s[16:19], s36 offen offset:0
buffer_load_dwordx4 v[52:55], v35, s[16:19], s36 offen offset:512
buffer_load_dwordx4 v[56:59], v35, s[16:19], s36 offen offset:1024
buffer_load_dwordx4 v[60:63], v35, s[16:19], s36 offen offset:1536
s_cmp_eq_u32 s35, 0
s_cselect_b32 s40, s40, s42
s_cselect_b32 s41, s41, s43
s_lshl_b32 s3, s34, 9
s_add_u32 s12, s40, s3
s_addc_u32 s13, s41, 0
s_and_b32 s13, s13, 0xffff
s_mov_b32 s14, 0
s_mov_b32 s15, 0x20000
s_sub_u32 s14, 4194304, s3
s_lshl_b32 s3, s33, 18
s_add_u32 s8, s6, s3
s_addc_u32 s9, s7, 0
s_and_b32 s9, s9, 0xffff
s_mov_b32 s10, 262144
s_mov_b32 s11, 0x20000
s_and_b32 s58, s2, 7
s_mov_b32 s52, 0
s_mov_b32 s53, 15360
s_mov_b32 s54, 30720
s_mov_b32 s55, 46080
s_lshl_b32 s57, s32, 13
s_add_u32 s56, s57, 32768
s_lshl_b32 s3, s58, 2
s_add_u32 s3, s3, s32
s_lshl_b32 s3, s3, 4
v_add_u32 v30, s3, v33
v_lshlrev_b32 v30, 13, v30
v_lshlrev_b32 v34, 5, v33
v_xor_b32 v34, v34, v36
v_add_u32 v6, v34, v30
v_xor_b32_e64 v7, 64, v6
v_xor_b32 v8, 65664, v6
v_xor_b32 v9, 65728, v6
s_add_u32 m0, s57, 0
s_nop 0
buffer_load_dwordx4 v6, s[12:15], s52 offen offset:0 lds
buffer_load_dwordx4 v7, s[12:15], s53 offen offset:1024 lds
buffer_load_dwordx4 v6, s[12:15], s54 offen offset:2048 lds
buffer_load_dwordx4 v7, s[12:15], s55 offen offset:3072 lds
s_add_u32 m0, s57, 4096
s_nop 0
s_nop 0
buffer_load_dwordx4 v8, s[12:15], s52 offen offset:0 lds
buffer_load_dwordx4 v9, s[12:15], s53 offen offset:1024 lds
buffer_load_dwordx4 v8, s[12:15], s54 offen offset:2048 lds
buffer_load_dwordx4 v9, s[12:15], s55 offen offset:3072 lds
v_xor_b32 v6, 524288, v6
v_xor_b32 v7, 524288, v7
v_xor_b32 v8, 524288, v8
v_xor_b32 v9, 524288, v9
s_mov_b32 s48, 0
s_mov_b32 s49, 7168
s_mov_b32 s50, 14336
s_mov_b32 s51, 21504
v_lshrrev_b32 v30, 3, v0
v_lshlrev_b32 v30, 10, v30
s_lshl_b32 s3, s32, 16
s_lshl_b32 s39, s58, 7
s_add_u32 s3, s3, s39
v_and_b32 v31, 7, v0
v_lshrrev_b32 v32, 4, v0
v_xor_b32_e64 v31, v31, v32
v_lshl_add_u32 v30, v31, 4, v30
v_add_u32 v2, s3, v30
v_xor_b32 v3, 64, v2
v_xor_b32 v4, 32768, v2
v_xor_b32 v5, 32832, v2
s_cmp_lt_u32 s32, 2
s_cselect_b32 s60, s8, s12
s_cselect_b32 s61, s9, s13
s_cselect_b32 s62, s10, s14
s_mov_b32 s63, 0x20000
s_mov_b32 s59, 524288
s_cselect_b32 s59, 128, s59
s_cselect_b64 vcc, -1, 0
s_cselect_b32 s38, 32, 16
s_lshr_b32 s3, s2, 6
s_cmp_lt_u32 s32, 2
s_cselect_b32 s3, s3, s33
s_lshl_b32 s3, s3, 1
s_and_b32 s39, s32, 1
s_add_u32 s3, s3, s39
s_lshl_b32 s3, s3, 15
s_xor_b32 s39, s58, 2
s_mul_i32 s39, s39, s59
s_add_u32 s3, s3, s39
v_lshlrev_b32 v37, 10, v0
v_lshrrev_b32 v38, 2, v0
v_lshlrev_b32 v38, 13, v38
v_and_b32 v39, 3, v0
v_lshl_add_u32 v38, v39, 7, v38
v_cndmask_b32 v47, v38, v37, vcc
v_add_u32 v47, s3, v47
v_cmp_gt_u32 vcc, s38, v0
v_mov_b32 v37, 2146435072
s_nop 0
v_cndmask_b32 v47, v37, v47, vcc
s_mov_b32 s20, s66
s_and_b32 s21, s67, 0xffff
s_mov_b32 s22, 8388608
s_mov_b32 s23, 0x20000
s_add_u32 s24, s66, 8388608
s_addc_u32 s25, s67, 0
s_and_b32 s25, s25, 0xffff
s_mov_b32 s26, 35717120
s_mov_b32 s27, 0x20000
v_lshrrev_b32 v32, 4, v0
v_and_b32 v30, 15, v0
s_lshr_b32 s3, s32, 1
s_lshl_b32 s3, s3, 14
s_add_u32 s3, s3, 32768
v_lshlrev_b32 v31, 7, v30
v_add_u32 v31, s3, v31
v_lshrrev_b32 v34, 1, v30
v_xor_b32_e64 v34, v34, v32
v_lshl_add_u32 v10, v34, 4, v31
v_xor_b32 v11, 64, v10
v_lshrrev_b32 v30, 2, v30
v_lshl_add_u32 v31, v32, 3, v30
v_lshlrev_b32 v31, 9, v31
v_and_b32 v34, 3, v0
v_lshl_add_u32 v31, v34, 3, v31
s_and_b32 s3, s32, 1
s_lshl_b32 s3, s3, 8
v_add_u32 v31, s3, v31
v_and_b32 v34, 1, v32
v_lshl_add_u32 v30, v34, 2, v30
v_lshl_add_u32 v16, v30, 5, v31
v_xor_b32 v17, 32, v16
v_xor_b32 v18, 64, v16
v_xor_b32 v19, 96, v16
v_xor_b32 v20, 128, v16
v_xor_b32 v21, 160, v16
v_xor_b32 v22, 192, v16
v_xor_b32 v23, 224, v16
v_add_u32 v12, 65536, v10
v_add_u32 v13, 65536, v11
v_add_u32 v14, 65536, v16
v_add_u32 v15, 65536, v17
v_add_u32 v24, 65536, v18
v_add_u32 v25, 65536, v19
v_add_u32 v26, 65536, v20
v_add_u32 v27, 65536, v21
v_add_u32 v28, 65536, v22
v_add_u32 v29, 65536, v23
s_mov_b32 s28, s44
s_nop 0
s_and_b32 s29, s45, 0xffff
s_mov_b32 s30, 2048
s_mov_b32 s31, 0x20000
buffer_load_dwordx4 v[64:67], v36, s[28:31], 0 offen offset:0
buffer_load_dwordx4 v[68:71], v36, s[28:31], 0 offen offset:512
buffer_load_dwordx4 v[72:75], v36, s[28:31], 0 offen offset:1024
buffer_load_dwordx4 v[76:79], v36, s[28:31], 0 offen offset:1536
s_waitcnt vmcnt(12)
v_lshlrev_b32 v80, 16, v48
v_and_b32 v81, 0xffff0000, v48
v_lshlrev_b32_e64 v82, 16, v49
v_and_b32 v83, 0xffff0000, v49
v_lshlrev_b32_e64 v84, 16, v50
v_and_b32 v85, 0xffff0000, v50
v_lshlrev_b32_e64 v86, 16, v51
v_and_b32 v87, 0xffff0000, v51
v_lshlrev_b32_e64 v88, 16, v52
v_and_b32 v89, 0xffff0000, v52
v_lshlrev_b32_e64 v90, 16, v53
v_and_b32 v91, 0xffff0000, v53
v_lshlrev_b32_e64 v92, 16, v54
v_and_b32 v93, 0xffff0000, v54
v_lshlrev_b32_e64 v94, 16, v55
v_and_b32 v95, 0xffff0000, v55
v_lshlrev_b32_e64 v96, 16, v56
v_and_b32 v97, 0xffff0000, v56
v_lshlrev_b32_e64 v98, 16, v57
v_and_b32 v99, 0xffff0000, v57
v_lshlrev_b32_e64 v100, 16, v58
v_and_b32 v101, 0xffff0000, v58
v_lshlrev_b32_e64 v102, 16, v59
v_and_b32 v103, 0xffff0000, v59
v_lshlrev_b32_e64 v104, 16, v60
v_and_b32 v105, 0xffff0000, v60
v_lshlrev_b32_e64 v106, 16, v61
v_and_b32 v107, 0xffff0000, v61
v_lshlrev_b32_e64 v108, 16, v62
v_and_b32 v109, 0xffff0000, v62
v_lshlrev_b32_e64 v110, 16, v63
v_and_b32 v111, 0xffff0000, v63
v_pk_add_f32 v[40:41], v[80:81], v[82:83]
v_pk_add_f32 v[42:43], v[84:85], v[86:87]
v_pk_add_f32 v[40:41], v[40:41], v[88:89]
v_pk_add_f32 v[42:43], v[42:43], v[90:91]
v_pk_add_f32 v[40:41], v[40:41], v[92:93]
v_pk_add_f32 v[42:43], v[42:43], v[94:95]
v_pk_add_f32 v[40:41], v[40:41], v[96:97]
v_pk_add_f32 v[42:43], v[42:43], v[98:99]
v_pk_add_f32 v[40:41], v[40:41], v[100:101]
v_pk_add_f32 v[42:43], v[42:43], v[102:103]
v_pk_add_f32 v[40:41], v[40:41], v[104:105]
v_pk_add_f32 v[42:43], v[42:43], v[106:107]
v_pk_add_f32 v[40:41], v[40:41], v[108:109]
v_pk_add_f32 v[42:43], v[42:43], v[110:111]
v_pk_add_f32 v[40:41], v[40:41], v[42:43]
Va 38,40,41
s_nop 1
v_add_f32_dpp v38, v38, v38 quad_perm:[1,0,3,2] row_mask:0xf bank_mask:0xf
s_nop 1
v_add_f32_dpp v38, v38, v38 quad_perm:[2,3,0,1] row_mask:0xf bank_mask:0xf
s_nop 1
v_add_f32_dpp v38, v38, v38 row_half_mirror row_mask:0xf bank_mask:0xf
s_nop 1
v_add_f32_dpp v38, v38, v38 row_mirror row_mask:0xf bank_mask:0xf
v_mov_b32 v37, v38
s_nop 1
v_permlane16_swap_b32 v37, v38
Va 38,38,37
s_add_u32 m0, s56, 0
s_nop 0
buffer_load_dwordx4 v2, s[8:11], s48 offen offset:0 lds
buffer_load_dwordx4 v3, s[8:11], s49 offen offset:1024 lds
buffer_load_dwordx4 v2, s[8:11], s50 offen offset:2048 lds
buffer_load_dwordx4 v3, s[8:11], s51 offen offset:3072 lds
s_add_u32 m0, s56, 4096
s_nop 0
buffer_load_dwordx4 v4, s[8:11], s48 offen offset:0 lds
buffer_load_dwordx4 v5, s[8:11], s49 offen offset:1024 lds
buffer_load_dwordx4 v4, s[8:11], s50 offen offset:2048 lds
buffer_load_dwordx4 v5, s[8:11], s51 offen offset:3072 lds
v_xor_b32 v2, 128, v2
v_xor_b32 v3, 128, v3
v_xor_b32 v4, 128, v4
v_xor_b32 v5, 128, v5
v_mul_f32 v38, 0xba800000, v38
v_mov_b32_e64 v39, v38
v_pk_add_f32 v[112:113], v[80:81], v[38:39]
v_pk_mul_f32 v[40:41], v[112:113], v[112:113]
v_pk_add_f32 v[114:115], v[82:83], v[38:39]
v_pk_mul_f32 v[42:43], v[114:115], v[114:115]
v_pk_add_f32 v[116:117], v[84:85], v[38:39]
v_pk_fma_f32 v[40:41], v[116:117], v[116:117], v[40:41]
v_pk_add_f32 v[118:119], v[86:87], v[38:39]
v_pk_fma_f32 v[42:43], v[118:119], v[118:119], v[42:43]
v_pk_add_f32 v[112:113], v[88:89], v[38:39]
v_pk_fma_f32 v[40:41], v[112:113], v[112:113], v[40:41]
v_pk_add_f32 v[114:115], v[90:91], v[38:39]
v_pk_fma_f32 v[42:43], v[114:115], v[114:115], v[42:43]
v_pk_add_f32 v[116:117], v[92:93], v[38:39]
v_pk_fma_f32 v[40:41], v[116:117], v[116:117], v[40:41]
v_pk_add_f32 v[118:119], v[94:95], v[38:39]
v_pk_fma_f32 v[42:43], v[118:119], v[118:119], v[42:43]
v_pk_add_f32 v[112:113], v[96:97], v[38:39]
v_pk_fma_f32 v[40:41], v[112:113], v[112:113], v[40:41]
v_pk_add_f32 v[114:115], v[98:99], v[38:39]
v_pk_fma_f32 v[42:43], v[114:115], v[114:115], v[42:43]
v_pk_add_f32 v[116:117], v[100:101], v[38:39]
v_pk_fma_f32 v[40:41], v[116:117], v[116:117], v[40:41]
v_pk_add_f32 v[118:119], v[102:103], v[38:39]
v_pk_fma_f32 v[42:43], v[118:119], v[118:119], v[42:43]
v_pk_add_f32 v[112:113], v[104:105], v[38:39]
v_pk_fma_f32 v[40:41], v[112:113], v[112:113], v[40:41]
v_pk_add_f32 v[114:115], v[106:107], v[38:39]
v_pk_fma_f32 v[42:43], v[114:115], v[114:115], v[42:43]
v_pk_add_f32 v[116:117], v[108:109], v[38:39]
v_pk_fma_f32 v[40:41], v[116:117], v[116:117], v[40:41]
v_pk_add_f32 v[118:119], v[110:111], v[38:39]
v_pk_fma_f32 v[42:43], v[118:119], v[118:119], v[42:43]
v_pk_add_f32 v[40:41], v[40:41], v[42:43]
Va 40,40,41
s_nop 1
v_add_f32_dpp v40, v40, v40 quad_perm:[1,0,3,2] row_mask:0xf bank_mask:0xf
s_nop 1
v_add_f32_dpp v40, v40, v40 quad_perm:[2,3,0,1] row_mask:0xf bank_mask:0xf
s_nop 1
v_add_f32_dpp v40, v40, v40 row_half_mirror row_mask:0xf bank_mask:0xf
s_nop 1
v_add_f32_dpp v40, v40, v40 row_mirror row_mask:0xf bank_mask:0xf
v_mov_b32 v37, v40
s_nop 1
v_permlane16_swap_b32 v37, v40
v_add_f32_e64 v40, v40, v37
v_mul_f32 v40, 0x3a800000, v40
Vc 44,38,40
v_lshlrev_b32_e64 v38, 16, v44
v_and_b32 v40, 0xffff0000, v44
v_add_f32 v40, 0x3727c5ac, v40
Vc 44,40,40
v_lshlrev_b32 v40, 16, v44
v_sqrt_f32 v40, v40
v_mov_b32_e64 v39, v38
Vc 44,40,40
v_lshlrev_b32 v44, 16, v44
v_rcp_f32 v40, v44
v_pk_add_f32 v[80:81], v[80:81], v[38:39]
v_pk_add_f32 v[82:83], v[82:83], v[38:39]
v_pk_add_f32 v[84:85], v[84:85], v[38:39]
v_pk_add_f32 v[86:87], v[86:87], v[38:39]
v_pk_add_f32 v[88:89], v[88:89], v[38:39]
v_pk_add_f32 v[90:91], v[90:91], v[38:39]
v_pk_add_f32 v[92:93], v[92:93], v[38:39]
v_pk_add_f32 v[94:95], v[94:95], v[38:39]
v_pk_add_f32 v[96:97], v[96:97], v[38:39]
v_pk_add_f32 v[98:99], v[98:99], v[38:39]
v_pk_add_f32 v[100:101], v[100:101], v[38:39]
v_pk_add_f32 v[102:103], v[102:103], v[38:39]
v_pk_add_f32 v[104:105], v[104:105], v[38:39]
v_pk_add_f32 v[106:107], v[106:107], v[38:39]
v_pk_add_f32 v[108:109], v[108:109], v[38:39]
v_pk_add_f32 v[110:111], v[110:111], v[38:39]
v_fma_f32 v45, -v44, v40, 1.0
v_fma_f32 v40, v45, v40, v40
v_mov_b32_e64 v41, v40
Vc 48,80,81
Vc 49,82,83
Vc 50,84,85
Vc 51,86,87
Vc 52,88,89
Vc 53,90,91
Vc 54,92,93
Vc 55,94,95
Vc 56,96,97
Vc 57,98,99
Vc 58,100,101
Vc 59,102,103
Vc 60,104,105
Vc 61,106,107
Vc 62,108,109
Vc 63,110,111
v_lshlrev_b32_e64 v80, 16, v48
v_and_b32 v81, 0xffff0000, v48
v_lshlrev_b32_e64 v82, 16, v49
v_and_b32 v83, 0xffff0000, v49
v_lshlrev_b32_e64 v84, 16, v50
v_and_b32 v85, 0xffff0000, v50
v_lshlrev_b32_e64 v86, 16, v51
v_and_b32 v87, 0xffff0000, v51
v_lshlrev_b32_e64 v88, 16, v52
v_and_b32 v89, 0xffff0000, v52
v_lshlrev_b32_e64 v90, 16, v53
v_and_b32 v91, 0xffff0000, v53
v_lshlrev_b32_e64 v92, 16, v54
v_and_b32 v93, 0xffff0000, v54
v_lshlrev_b32_e64 v94, 16, v55
v_and_b32 v95, 0xffff0000, v55
v_lshlrev_b32_e64 v96, 16, v56
v_and_b32 v97, 0xffff0000, v56
v_lshlrev_b32_e64 v98, 16, v57
v_and_b32 v99, 0xffff0000, v57
v_lshlrev_b32_e64 v100, 16, v58
v_and_b32 v101, 0xffff0000, v58
v_lshlrev_b32_e64 v102, 16, v59
v_and_b32 v103, 0xffff0000, v59
v_lshlrev_b32_e64 v104, 16, v60
v_and_b32 v105, 0xffff0000, v60
v_lshlrev_b32_e64 v106, 16, v61
v_and_b32 v107, 0xffff0000, v61
v_lshlrev_b32_e64 v108, 16, v62
v_and_b32 v109, 0xffff0000, v62
v_lshlrev_b32_e64 v110, 16, v63
v_and_b32 v111, 0xffff0000, v63
v_pk_mul_f32 v[80:81], v[80:81], v[40:41]
v_pk_mul_f32 v[82:83], v[82:83], v[40:41]
v_pk_mul_f32 v[84:85], v[84:85], v[40:41]
v_pk_mul_f32 v[86:87], v[86:87], v[40:41]
v_pk_mul_f32 v[88:89], v[88:89], v[40:41]
v_pk_mul_f32 v[90:91], v[90:91], v[40:41]
v_pk_mul_f32 v[92:93], v[92:93], v[40:41]
v_pk_mul_f32 v[94:95], v[94:95], v[40:41]
v_pk_mul_f32 v[96:97], v[96:97], v[40:41]
v_pk_mul_f32 v[98:99], v[98:99], v[40:41]
v_pk_mul_f32 v[100:101], v[100:101], v[40:41]
v_pk_mul_f32 v[102:103], v[102:103], v[40:41]
v_pk_mul_f32 v[104:105], v[104:105], v[40:41]
v_pk_mul_f32 v[106:107], v[106:107], v[40:41]
v_pk_mul_f32 v[108:109], v[108:109], v[40:41]
v_pk_mul_f32 v[110:111], v[110:111], v[40:41]
Vc 48,80,81
Vc 49,82,83
Vc 50,84,85
Vc 51,86,87
Vc 52,88,89
Vc 53,90,91
Vc 54,92,93
Vc 55,94,95
Vc 56,96,97
Vc 57,98,99
Vc 58,100,101
Vc 59,102,103
Vc 60,104,105
Vc 61,106,107
Vc 62,108,109
Vc 63,110,111
s_mul_i32 s3, s32, 4128
s_add_u32 s3, s3, 131072
v_mul_u32_u24 v42, 2064, v33
v_add3_u32 v42, v42, v36, s3
ds_write_b128 v42, v[48:51] offset:0
ds_write_b128 v42, v[52:55] offset:512
ds_write_b128 v42, v[56:59] offset:1024
ds_write_b128 v42, v[60:63] offset:1536
s_waitcnt vmcnt(8)
v_lshlrev_b32 v80, 16, v48
v_and_b32 v81, 0xffff0000, v48
v_lshlrev_b32_e64 v112, 16, v64
v_and_b32 v113, 0xffff0000, v64
v_pk_mul_f32 v[42:43], v[80:81], v[112:113]
v_lshlrev_b32_e64 v82, 16, v49
v_and_b32 v83, 0xffff0000, v49
v_lshlrev_b32_e64 v114, 16, v65
v_and_b32 v115, 0xffff0000, v65
v_pk_mul_f32 v[44:45], v[82:83], v[114:115]
v_lshlrev_b32_e64 v84, 16, v50
v_and_b32 v85, 0xffff0000, v50
v_lshlrev_b32_e64 v116, 16, v66
v_and_b32 v117, 0xffff0000, v66
v_pk_fma_f32 v[42:43], v[84:85], v[116:117], v[42:43]
v_lshlrev_b32_e64 v86, 16, v51
v_and_b32 v87, 0xffff0000, v51
v_lshlrev_b32_e64 v118, 16, v67
v_and_b32 v119, 0xffff0000, v67
v_pk_fma_f32 v[44:45], v[86:87], v[118:119], v[44:45]
v_lshlrev_b32_e64 v88, 16, v52
v_and_b32 v89, 0xffff0000, v52
v_lshlrev_b32_e64 v112, 16, v68
v_and_b32 v113, 0xffff0000, v68
v_pk_fma_f32 v[42:43], v[88:89], v[112:113], v[42:43]
v_lshlrev_b32_e64 v90, 16, v53
v_and_b32 v91, 0xffff0000, v53
v_lshlrev_b32_e64 v114, 16, v69
v_and_b32 v115, 0xffff0000, v69
v_pk_fma_f32 v[44:45], v[90:91], v[114:115], v[44:45]
v_lshlrev_b32_e64 v92, 16, v54
v_and_b32 v93, 0xffff0000, v54
v_lshlrev_b32_e64 v116, 16, v70
v_and_b32 v117, 0xffff0000, v70
v_pk_fma_f32 v[42:43], v[92:93], v[116:117], v[42:43]
v_lshlrev_b32_e64 v94, 16, v55
v_and_b32 v95, 0xffff0000, v55
v_lshlrev_b32_e64 v118, 16, v71
v_and_b32 v119, 0xffff0000, v71
v_pk_fma_f32 v[44:45], v[94:95], v[118:119], v[44:45]
v_lshlrev_b32_e64 v96, 16, v56
v_and_b32 v97, 0xffff0000, v56
v_lshlrev_b32_e64 v112, 16, v72
v_and_b32 v113, 0xffff0000, v72
v_pk_fma_f32 v[42:43], v[96:97], v[112:113], v[42:43]
v_lshlrev_b32_e64 v98, 16, v57
v_and_b32 v99, 0xffff0000, v57
v_lshlrev_b32_e64 v114, 16, v73
v_and_b32 v115, 0xffff0000, v73
v_pk_fma_f32 v[44:45], v[98:99], v[114:115], v[44:45]
v_lshlrev_b32_e64 v100, 16, v58
v_and_b32 v101, 0xffff0000, v58
v_lshlrev_b32_e64 v116, 16, v74
v_and_b32 v117, 0xffff0000, v74
v_pk_fma_f32 v[42:43], v[100:101], v[116:117], v[42:43]
v_lshlrev_b32_e64 v102, 16, v59
v_and_b32 v103, 0xffff0000, v59
v_lshlrev_b32_e64 v118, 16, v75
v_and_b32 v119, 0xffff0000, v75
v_pk_fma_f32 v[44:45], v[102:103], v[118:119], v[44:45]
v_lshlrev_b32_e64 v104, 16, v60
v_and_b32 v105, 0xffff0000, v60
v_lshlrev_b32_e64 v112, 16, v76
v_and_b32 v113, 0xffff0000, v76
v_pk_fma_f32 v[42:43], v[104:105], v[112:113], v[42:43]
v_lshlrev_b32_e64 v106, 16, v61
v_and_b32 v107, 0xffff0000, v61
v_lshlrev_b32_e64 v114, 16, v77
v_and_b32 v115, 0xffff0000, v77
v_pk_fma_f32 v[44:45], v[106:107], v[114:115], v[44:45]
v_lshlrev_b32_e64 v108, 16, v62
v_and_b32 v109, 0xffff0000, v62
v_lshlrev_b32_e64 v116, 16, v78
v_and_b32 v117, 0xffff0000, v78
v_pk_fma_f32 v[42:43], v[108:109], v[116:117], v[42:43]
v_lshlrev_b32_e64 v110, 16, v63
v_and_b32 v111, 0xffff0000, v63
v_lshlrev_b32_e64 v118, 16, v79
v_and_b32 v119, 0xffff0000, v79
v_pk_fma_f32 v[44:45], v[110:111], v[118:119], v[44:45]
v_pk_add_f32 v[42:43], v[42:43], v[44:45]
Va 45,42,43
s_nop 1
v_add_f32_dpp v45, v45, v45 quad_perm:[1,0,3,2] row_mask:0xf bank_mask:0xf
s_nop 1
v_add_f32_dpp v45, v45, v45 quad_perm:[2,3,0,1] row_mask:0xf bank_mask:0xf
s_nop 1
v_add_f32_dpp v45, v45, v45 row_half_mirror row_mask:0xf bank_mask:0xf
s_nop 1
v_add_f32_dpp v45, v45, v45 row_mirror row_mask:0xf bank_mask:0xf
v_mov_b32 v37, v45
s_nop 1
v_permlane16_swap_b32 v37, v45
v_add_f32_e64 v45, v45, v37
Vc 45,45,45
v_ashrrev_i32_e64 v46, 31, v45
v_or_b32 v46, 0x80000000, v46
v_xor_b32_e64 v45, v45, v46
v_and_b32 v45, 0xffff0000, v45
s_lshr_b32 s3, s36, 11
v_add_u32 v46, s3, v33
v_sub_u32 v44, 0xffff, v46
v_or_b32 v45, v45, v44
v_lshlrev_b32 v44, 2, v46
v_lshlrev_b32_e64 v46, 3, v46
v_xor_b32 v38, 0x80000000, v38
v_mov_b32_e64 v39, v40
s_mov_b32 s3, 5242880
s_mov_b32 s39, 5259264
s_mov_b32 exec_lo, 1
s_mov_b32 exec_hi, 1
buffer_store_dword v45, v44, s[20:23], s3 offen sc1
buffer_store_dwordx2 v[38:39], v46, s[20:23], s39 offen sc1
s_mov_b64 exec, -1
s_load_dwordx2 s[4:5], s[0:1], 16
s_load_dwordx4 s[40:43], s[0:1], 64
s_load_dwordx2 s[92:93], s[0:1], 40
s_load_dwordx2 s[94:95], s[0:1], 80
s_load_dwordx2 s[100:101], s[0:1], 0
s_mov_b32 s28, s64
s_and_b32 s29, s65, 0xffff
s_mov_b32 s30, 256
s_mov_b32 s31, 0x20000
s_waitcnt vmcnt(2)
s_waitcnt lgkmcnt(0)
s_barrier
s_nop 0
Ra 224,10,0
Ra 228,11,0
Ra 232,10,2048
Ra 236,11,2048
Ta 0,16,0
Ta 2,16,2048
Ta 4,16,16384
Ta 6,16,18432
Ta 8,17,0
Ta 10,17,2048
Ta 12,17,16384
Ta 14,17,18432
Ta 16,18,0
Ta 18,18,2048
Ta 20,18,16384
s_waitcnt lgkmcnt(9)
s_nop 0
Ta 22,18,18432
Ta 24,19,0
Ta 26,19,2048
Ta 28,19,16384
Ta 30,19,18432
Ta 32,20,0
s_waitcnt lgkmcnt(9)
s_nop 0
Ta 34,20,2048
Ta 36,20,16384
Ta 38,20,18432
Ta 40,21,0
Ta 42,21,2048
Ta 44,21,16384
s_waitcnt lgkmcnt(9)
s_nop 0
Ta 46,21,18432
Ta 48,22,0
Ta 50,22,2048
Ta 52,22,16384
Ta 54,22,18432
Ta 56,23,0
s_waitcnt lgkmcnt(9)
Ta 58,23,2048
Ta 60,23,16384
Ta 62,23,18432
s_cmp_lg_u32 s35, 0
s_cbranch_scc1 L_k1_vpath
Zvaa 48,0,224
v_and_b32 v46, 7, v0
v_mul_u32_u24 v30, 2064, v46
Mvaa 48,4,228
s_add_u32 m0, s57, 65536
Zvaa 52,8,224
buffer_load_dwordx4 v6, s[12:15], s52 offen offset:0 lds
Mvaa 52,12,228
Ra 240,10,4096
Zvaa 56,16,224
buffer_load_dwordx4 v7, s[12:15], s53 offen offset:1024 lds
Mvaa 56,20,228
v_lshrrev_b32_e64 v31, 3, v0
Zvaa 60,24,224
buffer_load_dwordx4 v6, s[12:15], s54 offen offset:2048 lds
Mvaa 60,28,228
Ra 244,11,4096
Zvaa 64,32,224
buffer_load_dwordx4 v7, s[12:15], s55 offen offset:3072 lds
Mvaa 64,36,228
s_add_u32 m0, s57, 69632
s_waitcnt lgkmcnt(10)
Zvaa 68,40,224
buffer_load_dwordx4 v8, s[12:15], s52 offen offset:0 lds
Mvaa 68,44,228
Ra 248,10,6144
s_waitcnt lgkmcnt(7)
Zvaa 72,48,224
buffer_load_dwordx4 v9, s[12:15], s53 offen offset:1024 lds
Mvaa 72,52,228
s_lshl_b32 s3, s32, 9
s_add_u32 s3, s3, 131072
v_lshl_add_u32 v30, v31, 4, v30
s_waitcnt lgkmcnt(3)
Zvaa 76,56,224
buffer_load_dwordx4 v8, s[12:15], s54 offen offset:2048 lds
Mvaa 76,60,228
Ra 252,11,6144
Zvaa 80,0,232
buffer_load_dwordx4 v9, s[12:15], s55 offen offset:3072 lds
Mvaa 80,4,236
s_add_u32 m0, s56, 65536
v_xor_b32 v6, 1572864, v6
v_xor_b32 v7, 1572864, v7
Zvaa 84,8,232
buffer_load_dwordx4 v2, s[8:11], s48 offen offset:0 lds
Mvaa 84,12,236
v_xor_b32 v8, 1572864, v8
v_xor_b32 v9, 1572864, v9
Zvaa 88,16,232
buffer_load_dwordx4 v3, s[8:11], s49 offen offset:1024 lds
Mvaa 88,20,236
v_add_u32 v30, s3, v30
v_lshlrev_b32 v31, 8, v31
Zvaa 92,24,232
buffer_load_dwordx4 v2, s[8:11], s50 offen offset:2048 lds
Mvaa 92,28,236
v_lshl_add_u32 v46, v46, 4, v31
Zvaa 96,32,232
buffer_load_dwordx4 v3, s[8:11], s51 offen offset:3072 lds
Mvaa 96,36,236
s_add_u32 m0, s56, 69632
Zvaa 100,40,232
buffer_load_dwordx4 v4, s[8:11], s48 offen offset:0 lds
Mvaa 100,44,236
Rv 34,30,128
Rv 38,30,256
Zvaa 104,48,232
buffer_load_dwordx4 v5, s[8:11], s49 offen offset:1024 lds
Mvaa 104,52,236
Rv 42,30,384
Rv 30,30,0
Zvaa 108,56,232
s_waitcnt lgkmcnt(4)
buffer_load_dwordx4 v4, s[8:11], s50 offen offset:2048 lds
Mvaa 108,60,236
s_lshr_b32 s3, s2, 1
s_mul_i32 s3, s3, 33792
s_add_u32 s3, s3, s57
Zvaa 112,0,240
buffer_load_dwordx4 v5, s[8:11], s51 offen offset:3072 lds
Mvaa 112,4,244
v_xor_b32 v2, 384, v2
v_xor_b32 v3, 384, v3
Zvaa 116,8,240
s_and_b32 s39, s2, 1
s_lshl_b32 s39, s39, 7
s_add_u32 s3, s3, s39
Mvaa 116,12,244
Ra 224,10,8192
v_xor_b32 v4, 384, v4
Zvaa 120,16,240
s_add_u32 s39, s3, 4096
Mvaa 120,20,244
v_xor_b32 v5, 384, v5
Zvaa 124,24,240
Mvaa 124,28,244
Ra 228,11,8192
Zvaa 128,32,240
Mvaa 128,36,244
Zvaa 132,40,240
Mvaa 132,44,244
Ra 232,10,10240
Zvaa 136,48,240
buffer_load_dword v1, v47, s[60:63], 0 offen
Mvaa 136,52,244
s_mul_i32 vcc_lo, s59, 1
v_xor_b32 v47, vcc_lo, v47
Zvaa 140,56,240
Mvaa 140,60,244
Ra 236,11,10240
Zvaa 144,0,248
Mvaa 144,4,252
Zvaa 148,8,248
Mvaa 148,12,252
Zvaa 152,16,248
Mvaa 152,20,252
Zvaa 156,24,248
Mvaa 156,28,252
Zvaa 160,32,248
Mvaa 160,36,252
Zvaa 164,40,248
Mvaa 164,44,252
Zvaa 168,48,248
Mvaa 168,52,252
s_waitcnt vmcnt(9)
Zvaa 172,56,248
s_waitcnt lgkmcnt(0)
s_barrier
Mvaa 172,60,252
s_add_u32 m0, s57, 0
Zvaa 176,0,224
buffer_load_dwordx4 v6, s[12:15], s52 offen offset:0 lds
Mvaa 176,4,228
Ta 64,14,0
Ta 66,14,2048
Zvaa 180,8,224
Mvaa 180,12,228
Ra 240,10,12288
Zvaa 184,16,224
buffer_load_dwordx4 v7, s[12:15], s53 offen offset:1024 lds
Mvaa 184,20,228
Ta 68,14,16384
Ta 70,14,18432
Zvaa 188,24,224
Mvaa 188,28,228
Ra 244,11,12288
Zvaa 192,32,224
buffer_load_dwordx4 v6, s[12:15], s54 offen offset:2048 lds
Mvaa 192,36,228
Ta 72,15,0
Ta 74,15,2048
Zvaa 196,40,224
Mvaa 196,44,228
Ra 248,10,14336
Zvaa 200,48,224
buffer_load_dwordx4 v7, s[12:15], s55 offen offset:3072 lds
Mvaa 200,52,228
Ta 76,15,16384
Ta 78,15,18432
Zvaa 204,56,224
Mvaa 204,60,228
s_add_u32 m0, s57, 4096
Ra 252,11,14336
Zvaa 208,0,232
buffer_load_dwordx4 v8, s[12:15], s52 offen offset:0 lds
Mvaa 208,4,236
Zvaa 212,8,232
Mvaa 212,12,236
Ta 80,24,0
Ta 82,24,2048
Zvaa 216,16,232
buffer_load_dwordx4 v9, s[12:15], s53 offen offset:1024 lds
Mvaa 216,20,236
Ta 84,24,16384
s_waitcnt lgkmcnt(9)
Ta 86,24,18432
Zvaa 220,24,232
Mvaa 220,28,236
Ta 88,25,0
Ta 90,25,2048
Zvaa 224,32,232
buffer_load_dwordx4 v8, s[12:15], s54 offen offset:2048 lds
Mvaa 224,36,236
Zvaa 228,40,232
Mvaa 228,44,236
Ta 92,25,16384
Ta 94,25,18432
Zvaa 232,48,232
buffer_load_dwordx4 v9, s[12:15], s55 offen offset:3072 lds
Mvaa 232,52,236
s_waitcnt vmcnt(9)
Ta 96,26,0
s_waitcnt lgkmcnt(9)
Ta 98,26,2048
Zvaa 236,56,232
s_barrier
v_xor_b32 v6, 524288, v6
v_xor_b32 v7, 524288, v7
Mvaa 236,60,236
s_add_u32 m0, s56, 0
Ta 100,26,16384
Ta 102,26,18432
Zvaa 240,0,240
buffer_load_dwordx4 v2, s[8:11], s48 offen offset:0 lds
Mvaa 240,4,244
v_xor_b32 v8, 524288, v8
v_xor_b32 v9, 524288, v9
Zvaa 244,8,240
Mvaa 244,12,244
Ra 224,12,0
Zvaa 248,16,240
buffer_load_dwordx4 v3, s[8:11], s49 offen offset:1024 lds
Mvaa 248,20,244
Ta 104,27,0
Ta 106,27,2048
Zvaa 252,24,240
Mvaa 252,28,244
s_waitcnt lgkmcnt(9)
Ra 228,13,0
Zaaa 128,32,240
buffer_load_dwordx4 v2, s[8:11], s50 offen offset:2048 lds
Maaa 128,36,244
Ta 108,27,16384
Ta 110,27,18432
Zaaa 132,40,240
Maaa 132,44,244
Ra 232,12,2048
Zaaa 136,48,240
buffer_load_dwordx4 v3, s[8:11], s51 offen offset:3072 lds
Maaa 136,52,244
Ta 112,28,0
Ta 114,28,2048
Zaaa 140,56,240
Maaa 140,60,244
s_add_u32 m0, s56, 4096
s_waitcnt lgkmcnt(9)
Ra 236,13,2048
Zaaa 144,0,248
buffer_load_dwordx4 v4, s[8:11], s48 offen offset:0 lds
Maaa 144,4,252
Zaaa 148,8,248
Maaa 148,12,252
Ta 116,28,16384
Ta 118,28,18432
Zaaa 152,16,248
buffer_load_dwordx4 v5, s[8:11], s49 offen offset:1024 lds
Maaa 152,20,252
Ta 120,29,0
Ta 122,29,2048
Zaaa 156,24,248
Maaa 156,28,252
Ta 124,29,16384
s_waitcnt lgkmcnt(9)
Ta 126,29,18432
Zaaa 160,32,248
buffer_load_dwordx4 v4, s[8:11], s50 offen offset:2048 lds
Maaa 160,36,252
Zaaa 164,40,248
Maaa 164,44,252
Zaaa 168,48,248
buffer_load_dwordx4 v5, s[8:11], s51 offen offset:3072 lds
Maaa 168,52,252
v_xor_b32 v2, 128, v2
v_xor_b32 v3, 128, v3
Zaaa 172,56,248
s_waitcnt lgkmcnt(6)
buffer_load_dword v1, v47, s[60:63], 0 offen
v_xor_b32 v4, 128, v4
v_xor_b32 v5, 128, v5
Maaa 172,60,252
s_waitcnt lgkmcnt(0)
s_mul_i32 vcc_lo, s59, 7
v_xor_b32 v47, vcc_lo, v47
Mvaa 48,64,224
buffer_store_dwordx4 v[30:33], v46, s[20:23], s3 offen offset:0 sc1
Mvaa 48,68,228
buffer_store_dwordx4 v[34:37], v46, s[20:23], s3 offen offset:2048 sc1
Mvaa 52,72,224
buffer_store_dwordx4 v[38:41], v46, s[20:23], s39 offen offset:0 sc1
Mvaa 52,76,228
Ra 240,12,4096
Mvaa 56,80,224
buffer_store_dwordx4 v[42:45], v46, s[20:23], s39 offen offset:2048 sc1
Mvaa 56,84,228
s_lshl_b32 s3, s34, 1
s_and_b32 s36, s32, 1
s_add_u32 s3, s3, s36
Mvaa 60,88,224
s_mul_i32 s3, s3, 1116160
s_mul_i32 s36, s33, 139264
s_add_u32 s3, s3, s36
Mvaa 60,92,228
Ra 244,13,4096
Mvaa 64,96,224
s_lshr_b32 s36, s32, 1
s_mul_i32 s36, s36, 69632
s_add_u32 s3, s3, s36
Mvaa 64,100,228
s_add_u32 s38, s3, 0
s_lshl_b32 s39, s34, 7
s_lshl_b32 s36, s33, 2
Mvaa 68,104,224
s_add_u32 s39, s39, s36
s_add_u32 s39, s39, 5296128
v_mov_b32_e64 v30, 1
Mvaa 68,108,228
Ra 248,12,6144
Mvaa 72,112,224
v_mov_b32_e64 v31, 0
Mvaa 72,116,228
s_cmp_eq_u32 s32, 0
s_cselect_b32 s39, s39, 2146435072
Mvaa 76,120,224
s_mov_b64 exec, 1
buffer_store_dword v31, v31, s[20:23], s39 offen sc1
s_mov_b64 exec, -1
Mvaa 76,124,228
Ra 252,13,6144
Mvaa 80,64,232
s_and_b32 s33, s2, 7
s_lshl_b32 s33, s33, 2
s_bfe_u32 s3, s2, 0x20003
Mvaa 80,68,236
s_add_u32 s33, s33, s3
s_lshr_b32 s34, s2, 5
s_lshl_b32 s64, s34, 7
Mvaa 84,72,232
s_lshl_b32 s3, s33, 2
s_add_u32 s64, s64, s3
s_add_u32 s64, s64, 5300224
Mvaa 84,76,236
s_lshl_b32 s65, s34, 8
s_sub_u32 s65, 1920, s65
v_mul_u32_u24 v32, s65, v0
Mvaa 88,80,232
s_cmp_eq_u32 s32, 0
s_cselect_b32 s64, s64, 2146435072
Mvaa 88,84,236
s_mov_b64 exec, 3
buffer_store_dword v31, v32, s[20:23], s64 offen sc1
s_mov_b64 exec, -1
Mvaa 92,88,232
s_lshl_b32 s3, s2, 2
s_add_u32 s3, s3, 5447680
v_lshlrev_b32_e64 v32, 10, v0
Mvaa 92,92,236
s_cmp_eq_u32 s32, 0
s_cselect_b32 s3, s3, 2146435072
Mvaa 96,96,232
s_mov_b64 exec, 0x1ff
buffer_store_dword v31, v32, s[20:23], s3 offen sc1
s_mov_b64 exec, -1
Mvaa 96,100,236
s_lshl_b32 s35, s34, 1
s_sub_u32 s36, 32, s35
s_add_u32 s35, s35, 2
Mvaa 100,104,232
s_lshl_b32 s44, s32, 12
s_lshl_b32 s58, s32, 1
s_sub_u32 s58, 7, s58
Mvaa 100,108,236
s_mul_i32 s58, s58, 33792
s_sub_u32 s3, 15, s34
s_lshl_b32 s45, s3, 3
Mvaa 104,112,232
s_add_u32 s45, s45, s32
s_lshl_b32 s46, s34, 3
s_add_u32 s46, s46, s32
Mvaa 104,116,236
s_mov_b32 s68, s42
s_and_b32 s69, s43, 0xffff
s_mov_b32 s70, 7340032
Mvaa 108,120,232
s_waitcnt lgkmcnt(0)
Mvaa 108,124,236
s_mov_b32 s71, 0x20000
s_cmp_eq_u32 s32, 0
s_cselect_b32 s37, 0, 2146435072
Mvaa 112,64,240
s_lshl_b32 s3, s33, 8
s_add_u32 s16, s4, s3
s_addc_u32 s17, s5, 0
s_and_b32 s17, s17, 0xffff
Mvaa 112,68,244
s_mov_b32 s18, 0
s_mov_b32 s19, 0x20000
s_sub_u32 s18, 8388608, s3
Mvaa 116,72,240
v_and_b32 v33, 15, v0
v_lshrrev_b32 v32, 1, v33
Mvaa 116,76,244
Ra 224,12,8192
Mvaa 120,80,240
v_and_b32 v33, 1, v0
v_lshlrev_b32 v32, 13, v32
Mvaa 120,84,244
v_lshl_add_u32 v45, v33, 7, v32
Mvaa 124,88,240
s_lshl_b32 s3, s32, 3
s_add_u32 s3, s3, s34
s_mul_i32 s47, s3, 65536
Mvaa 124,92,244
Ra 228,13,8192
Mvaa 128,96,240
s_bfe_u32 s6, s2, 131075
s_lshl_b32 s3, s32, 8
s_or_b32 s6, s6, s3
Mvaa 128,100,244
Mvaa 132,104,240
Mvaa 132,108,244
Ra 232,12,10240
Mvaa 136,112,240
Mvaa 136,116,244
Mvaa 140,120,240
Mvaa 140,124,244
Ra 236,13,10240
Mvaa 144,64,248
Mvaa 144,68,252
Mvaa 148,72,248
Mvaa 148,76,252
Mvaa 152,80,248
Mvaa 152,84,252
Mvaa 156,88,248
Mvaa 156,92,252
Mvaa 160,96,248
Mvaa 160,100,252
Mvaa 164,104,248
Mvaa 164,108,252
Mvaa 168,112,248
Mvaa 168,116,252
s_waitcnt vmcnt(16)
Mvaa 172,120,248
s_waitcnt lgkmcnt(0)
s_barrier
Mvaa 172,124,252
s_add_u32 m0, s57, 65536
Mvaa 176,64,224
buffer_load_dwordx4 v6, s[12:15], s52 offen offset:0 lds
Mvaa 176,68,228
Ta 0,16,0
Ta 2,16,2048
Mvaa 180,72,224
Mvaa 180,76,228
Ra 240,12,12288
Mvaa 184,80,224
buffer_load_dwordx4 v7, s[12:15], s53 offen offset:1024 lds
Mvaa 184,84,228
Ta 4,16,16384
Ta 6,16,18432
Mvaa 188,88,224
Mvaa 188,92,228
Ra 244,13,12288
Mvaa 192,96,224
buffer_load_dwordx4 v6, s[12:15], s54 offen offset:2048 lds
Mvaa 192,100,228
Ta 8,17,0
Ta 10,17,2048
Mvaa 196,104,224
Mvaa 196,108,228
Ra 248,12,14336
Mvaa 200,112,224
buffer_load_dwordx4 v7, s[12:15], s55 offen offset:3072 lds
Mvaa 200,116,228
Ta 12,17,16384
Ta 14,17,18432
Mvaa 204,120,224
Mvaa 204,124,228
s_add_u32 m0, s57, 69632
Ra 252,13,14336
Mvaa 208,64,232
buffer_load_dwordx4 v8, s[12:15], s52 offen offset:0 lds
Mvaa 208,68,236
Mvaa 212,72,232
Mvaa 212,76,236
Ta 16,18,0
Ta 18,18,2048
Mvaa 216,80,232
buffer_load_dwordx4 v9, s[12:15], s53 offen offset:1024 lds
Mvaa 216,84,236
Ta 20,18,16384
s_waitcnt lgkmcnt(9)
Ta 22,18,18432
Mvaa 220,88,232
Mvaa 220,92,236
Ta 24,19,0
Ta 26,19,2048
Mvaa 224,96,232
buffer_load_dwordx4 v8, s[12:15], s54 offen offset:2048 lds
Mvaa 224,100,236
Mvaa 228,104,232
Mvaa 228,108,236
Ta 28,19,16384
Ta 30,19,18432
Mvaa 232,112,232
buffer_load_dwordx4 v9, s[12:15], s55 offen offset:3072 lds
Mvaa 232,116,236
s_waitcnt vmcnt(16)
Ta 32,20,0
s_waitcnt lgkmcnt(9)
Ta 34,20,2048
Mvaa 236,120,232
s_barrier
v_xor_b32 v6, 3670016, v6
v_xor_b32 v7, 3670016, v7
Mvaa 236,124,236
s_add_u32 m0, s56, 65536
Ta 36,20,16384
Ta 38,20,18432
Mvaa 240,64,240
buffer_load_dwordx4 v2, s[8:11], s48 offen offset:0 lds
Mvaa 240,68,244
v_xor_b32 v8, 3670016, v8
v_xor_b32 v9, 3670016, v9
Mvaa 244,72,240
Mvaa 244,76,244
Ra 224,10,0
Mvaa 248,80,240
buffer_load_dwordx4 v3, s[8:11], s49 offen offset:1024 lds
Mvaa 248,84,244
Ta 40,21,0
Ta 42,21,2048
Mvaa 252,88,240
Mvaa 252,92,244
s_waitcnt lgkmcnt(9)
Ra 228,11,0
Maaa 128,96,240
buffer_load_dwordx4 v2, s[8:11], s50 offen offset:2048 lds
Maaa 128,100,244
Ta 44,21,16384
Ta 46,21,18432
Maaa 132,104,240
Maaa 132,108,244
Ra 232,10,2048
Maaa 136,112,240
buffer_load_dwordx4 v3, s[8:11], s51 offen offset:3072 lds
Maaa 136,116,244
Ta 48,22,0
Ta 50,22,2048
Maaa 140,120,240
Maaa 140,124,244
s_add_u32 m0, s56, 69632
s_waitcnt lgkmcnt(9)
Ra 236,11,2048
Maaa 144,64,248
buffer_load_dwordx4 v4, s[8:11], s48 offen offset:0 lds
Maaa 144,68,252
Maaa 148,72,248
Maaa 148,76,252
Ta 52,22,16384
Ta 54,22,18432
Maaa 152,80,248
buffer_load_dwordx4 v5, s[8:11], s49 offen offset:1024 lds
Maaa 152,84,252
Ta 56,23,0
Ta 58,23,2048
Maaa 156,88,248
Maaa 156,92,252
Ta 60,23,16384
s_waitcnt lgkmcnt(9)
Ta 62,23,18432
Maaa 160,96,248
buffer_load_dwordx4 v4, s[8:11], s50 offen offset:2048 lds
Maaa 160,100,252
Maaa 164,104,248
Maaa 164,108,252
Maaa 168,112,248
buffer_load_dwordx4 v5, s[8:11], s51 offen offset:3072 lds
Maaa 168,116,252
v_xor_b32 v2, 896, v2
v_xor_b32 v3, 896, v3
Maaa 172,120,248
s_waitcnt lgkmcnt(6)
buffer_load_dword v1, v47, s[60:63], 0 offen
v_xor_b32 v4, 896, v4
v_xor_b32 v5, 896, v5
Maaa 172,124,252
s_waitcnt lgkmcnt(0)
s_mul_i32 vcc_lo, s59, 1
v_xor_b32 v47, vcc_lo, v47
Mvaa 48,0,224
Mvaa 48,4,228
Mvaa 52,8,224
Mvaa 52,12,228
Ra 240,10,4096
Mvaa 56,16,224
Mvaa 56,20,228
Mvaa 60,24,224
Mvaa 60,28,228
Ra 244,11,4096
Mvaa 64,32,224
Mvaa 64,36,228
Mvaa 68,40,224
Mvaa 68,44,228
Ra 248,10,6144
Mvaa 72,48,224
Mvaa 72,52,228
Mvaa 76,56,224
Mvaa 76,60,228
Ra 252,11,6144
Mvaa 80,0,232
Mvaa 80,4,236
Mvaa 84,8,232
Mvaa 84,12,236
Mvaa 88,16,232
Mvaa 88,20,236
Mvaa 92,24,232
Mvaa 92,28,236
Mvaa 96,32,232
Mvaa 96,36,236
Mvaa 100,40,232
Mvaa 100,44,236
Mvaa 104,48,232
Mvaa 104,52,236
Mvaa 108,56,232
s_waitcnt lgkmcnt(0)
Mvaa 108,60,236
Mvaa 112,0,240
Mvaa 112,4,244
Mvaa 116,8,240
Mvaa 116,12,244
Ra 224,10,8192
Mvaa 120,16,240
Mvaa 120,20,244
Mvaa 124,24,240
Mvaa 124,28,244
Ra 228,11,8192
Mvaa 128,32,240
Mvaa 128,36,244
Mvaa 132,40,240
Mvaa 132,44,244
Ra 232,10,10240
Mvaa 136,48,240
Mvaa 136,52,244
Mvaa 140,56,240
Mvaa 140,60,244
Ra 236,11,10240
Mvaa 144,0,248
Mvaa 144,4,252
Mvaa 148,8,248
Mvaa 148,12,252
Mvaa 152,16,248
Mvaa 152,20,252
Mvaa 156,24,248
Mvaa 156,28,252
Mvaa 160,32,248
Mvaa 160,36,252
Mvaa 164,40,248
Mvaa 164,44,252
Mvaa 168,48,248
Mvaa 168,52,252
s_waitcnt vmcnt(9)
Mvaa 172,56,248
s_waitcnt lgkmcnt(0)
s_barrier
Mvaa 172,60,252
s_add_u32 m0, s57, 0
Mvaa 176,0,224
buffer_load_dwordx4 v6, s[12:15], s52 offen offset:0 lds
Mvaa 176,4,228
Ta 64,14,0
Ta 66,14,2048
Mvaa 180,8,224
Mvaa 180,12,228
Ra 240,10,12288
Mvaa 184,16,224
buffer_load_dwordx4 v7, s[12:15], s53 offen offset:1024 lds
Mvaa 184,20,228
Ta 68,14,16384
Ta 70,14,18432
Mvaa 188,24,224
Mvaa 188,28,228
Ra 244,11,12288
Mvaa 192,32,224
buffer_load_dwordx4 v6, s[12:15], s54 offen offset:2048 lds
Mvaa 192,36,228
Ta 72,15,0
Ta 74,15,2048
Mvaa 196,40,224
Mvaa 196,44,228
Ra 248,10,14336
Mvaa 200,48,224
buffer_load_dwordx4 v7, s[12:15], s55 offen offset:3072 lds
Mvaa 200,52,228
Ta 76,15,16384
Ta 78,15,18432
Mvaa 204,56,224
s_cmp_eq_u32 s6, 0
s_cselect_b32 s3, 0, 2146435072
Mvaa 204,60,228
s_add_u32 m0, s57, 4096
Ra 252,11,14336
Mvaa 208,0,232
buffer_load_dwordx4 v8, s[12:15], s52 offen offset:0 lds
Mvaa 208,4,236
s_mov_b64 exec, 1
buffer_atomic_add v30, v31, s[28:31], s3 offen sc1
s_mov_b64 exec, -1
Mvaa 212,8,232
Mvaa 212,12,236
Ta 80,24,0
Ta 82,24,2048
Mvaa 216,16,232
buffer_load_dwordx4 v9, s[12:15], s53 offen offset:1024 lds
Mvaa 216,20,236
Ta 84,24,16384
s_waitcnt lgkmcnt(9)
Ta 86,24,18432
Mvaa 220,24,232
Mvaa 220,28,236
Ta 88,25,0
Ta 90,25,2048
Mvaa 224,32,232
buffer_load_dwordx4 v8, s[12:15], s54 offen offset:2048 lds
Mvaa 224,36,236
Mvaa 228,40,232
Mvaa 228,44,236
Ta 92,25,16384
Ta 94,25,18432
Mvaa 232,48,232
buffer_load_dwordx4 v9, s[12:15], s55 offen offset:3072 lds
Mvaa 232,52,236
s_waitcnt vmcnt(10)
Ta 96,26,0
s_waitcnt lgkmcnt(9)
Ta 98,26,2048
Mvaa 236,56,232
s_barrier
v_xor_b32 v6, 524288, v6
v_xor_b32 v7, 524288, v7
Mvaa 236,60,236
s_add_u32 m0, s56, 0
Ta 100,26,16384
Ta 102,26,18432
Mvaa 240,0,240
buffer_load_dwordx4 v2, s[8:11], s48 offen offset:0 lds
Mvaa 240,4,244
v_xor_b32 v8, 524288, v8
v_xor_b32 v9, 524288, v9
Mvaa 244,8,240
Mvaa 244,12,244
Ra 224,12,0
Mvaa 248,16,240
buffer_load_dwordx4 v3, s[8:11], s49 offen offset:1024 lds
Mvaa 248,20,244
Ta 104,27,0
Ta 106,27,2048
Mvaa 252,24,240
Mvaa 252,28,244
s_waitcnt lgkmcnt(9)
Ra 228,13,0
Maaa 128,32,240
buffer_load_dwordx4 v2, s[8:11], s50 offen offset:2048 lds
Maaa 128,36,244
Ta 108,27,16384
Ta 110,27,18432
Maaa 132,40,240
Maaa 132,44,244
Ra 232,12,2048
Maaa 136,48,240
buffer_load_dwordx4 v3, s[8:11], s51 offen offset:3072 lds
Maaa 136,52,244
Ta 112,28,0
Ta 114,28,2048
Maaa 140,56,240
Maaa 140,60,244
s_add_u32 m0, s56, 4096
s_waitcnt lgkmcnt(9)
Ra 236,13,2048
Maaa 144,0,248
buffer_load_dwordx4 v4, s[8:11], s48 offen offset:0 lds
Maaa 144,4,252
Maaa 148,8,248
Maaa 148,12,252
Ta 116,28,16384
Ta 118,28,18432
Maaa 152,16,248
buffer_load_dwordx4 v5, s[8:11], s49 offen offset:1024 lds
Maaa 152,20,252
Ta 120,29,0
Ta 122,29,2048
Maaa 156,24,248
Maaa 156,28,252
Ta 124,29,16384
s_waitcnt lgkmcnt(9)
Ta 126,29,18432
Maaa 160,32,248
buffer_load_dwordx4 v4, s[8:11], s50 offen offset:2048 lds
Maaa 160,36,252
Maaa 164,40,248
Maaa 164,44,252
Maaa 168,48,248
buffer_load_dwordx4 v5, s[8:11], s51 offen offset:3072 lds
Maaa 168,52,252
v_xor_b32 v2, 128, v2
v_xor_b32 v3, 128, v3
Maaa 172,56,248
s_waitcnt lgkmcnt(6)
buffer_load_dword v1, v47, s[60:63], 0 offen
v_xor_b32 v4, 128, v4
v_xor_b32 v5, 128, v5
Maaa 172,60,252
s_waitcnt lgkmcnt(0)
s_mul_i32 vcc_lo, s59, 3
v_xor_b32 v47, vcc_lo, v47
Mvaa 48,64,224
buffer_load_dword v44, v45, s[16:19], s47 offen
Mvaa 48,68,228
s_add_u32 s47, s47, 2097152
Mvaa 52,72,224
Mvaa 52,76,228
Ra 240,12,4096
Mvaa 56,80,224
Mvaa 56,84,228
Mvaa 60,88,224
Mvaa 60,92,228
Ra 244,13,4096
Mvaa 64,96,224
Mvaa 64,100,228
Mvaa 68,104,224
Mvaa 68,108,228
Ra 248,12,6144
Mvaa 72,112,224
Mvaa 72,116,228
Mvaa 76,120,224
Mvaa 76,124,228
Ra 252,13,6144
Mvaa 80,64,232
Mvaa 80,68,236
Mvaa 84,72,232
Mvaa 84,76,236
Mvaa 88,80,232
Mvaa 88,84,236
Mvaa 92,88,232
Mvaa 92,92,236
Mvaa 96,96,232
Mvaa 96,100,236
Mvaa 100,104,232
s_cmp_eq_u32 s6, 1
s_cselect_b32 s3, 0, 2146435072
Mvaa 100,108,236
s_mov_b64 exec, 1
buffer_atomic_add v30, v31, s[28:31], s3 offen sc1
s_mov_b64 exec, -1
Mvaa 104,112,232
Mvaa 104,116,236
Mvaa 108,120,232
s_waitcnt lgkmcnt(0)
Mvaa 108,124,236
Mvaa 112,64,240
Mvaa 112,68,244
Mvaa 116,72,240
Mvaa 116,76,244
Ra 224,12,8192
Mvaa 120,80,240
Mvaa 120,84,244
Mvaa 124,88,240
Mvaa 124,92,244
Ra 228,13,8192
Mvaa 128,96,240
Mvaa 128,100,244
Mvaa 132,104,240
Mvaa 132,108,244
Ra 232,12,10240
Mvaa 136,112,240
Mvaa 136,116,244
Mvaa 140,120,240
Mvaa 140,124,244
Ra 236,13,10240
Mvaa 144,64,248
Mvaa 144,68,252
Mvaa 148,72,248
Mvaa 148,76,252
Mvaa 152,80,248
Mvaa 152,84,252
Mvaa 156,88,248
Mvaa 156,92,252
Mvaa 160,96,248
Mvaa 160,100,252
Mvaa 164,104,248
Mvaa 164,108,252
Mvaa 168,112,248
Mvaa 168,116,252
s_waitcnt vmcnt(11)
Mvaa 172,120,248
s_waitcnt lgkmcnt(0)
s_barrier
Mvaa 172,124,252
s_add_u32 m0, s57, 65536
Mvaa 176,64,224
buffer_load_dwordx4 v6, s[12:15], s52 offen offset:0 lds
Mvaa 176,68,228
Ta 0,16,0
Ta 2,16,2048
Mvaa 180,72,224
Mvaa 180,76,228
Ra 240,12,12288
Mvaa 184,80,224
buffer_load_dwordx4 v7, s[12:15], s53 offen offset:1024 lds
Mvaa 184,84,228
Ta 4,16,16384
Ta 6,16,18432
Mvaa 188,88,224
Mvaa 188,92,228
Ra 244,13,12288
Mvaa 192,96,224
buffer_load_dwordx4 v6, s[12:15], s54 offen offset:2048 lds
Mvaa 192,100,228
Ta 8,17,0
Ta 10,17,2048
Mvaa 196,104,224
Mvaa 196,108,228
Ra 248,12,14336
Mvaa 200,112,224
buffer_load_dwordx4 v7, s[12:15], s55 offen offset:3072 lds
Mvaa 200,116,228
Ta 12,17,16384
Ta 14,17,18432
Mvaa 204,120,224
Mvaa 204,124,228
s_add_u32 m0, s57, 69632
Ra 252,13,14336
Mvaa 208,64,232
buffer_load_dwordx4 v8, s[12:15], s52 offen offset:0 lds
Mvaa 208,68,236
Mvaa 212,72,232
Mvaa 212,76,236
Ta 16,18,0
Ta 18,18,2048
Mvaa 216,80,232
buffer_load_dwordx4 v9, s[12:15], s53 offen offset:1024 lds
Mvaa 216,84,236
Ta 20,18,16384
s_waitcnt lgkmcnt(9)
Ta 22,18,18432
Mvaa 220,88,232
Mvaa 220,92,236
Ta 24,19,0
Ta 26,19,2048
Mvaa 224,96,232
buffer_load_dwordx4 v8, s[12:15], s54 offen offset:2048 lds
Mvaa 224,100,236
Mvaa 228,104,232
Mvaa 228,108,236
Ta 28,19,16384
Ta 30,19,18432
Mvaa 232,112,232
buffer_load_dwordx4 v9, s[12:15], s55 offen offset:3072 lds
Mvaa 232,116,236
s_waitcnt vmcnt(11)
Ta 32,20,0
s_waitcnt lgkmcnt(9)
Ta 34,20,2048
Mvaa 236,120,232
s_barrier
v_xor_b32 v6, 1572864, v6
v_xor_b32 v7, 1572864, v7
Mvaa 236,124,236
s_add_u32 m0, s56, 65536
Ta 36,20,16384
Ta 38,20,18432
Mvaa 240,64,240
buffer_load_dwordx4 v2, s[8:11], s48 offen offset:0 lds
Mvaa 240,68,244
v_xor_b32 v8, 1572864, v8
v_xor_b32 v9, 1572864, v9
Mvaa 244,72,240
Mvaa 244,76,244
Ra 224,10,0
Mvaa 248,80,240
buffer_load_dwordx4 v3, s[8:11], s49 offen offset:1024 lds
Mvaa 248,84,244
Ta 40,21,0
Ta 42,21,2048
Mvaa 252,88,240
Mvaa 252,92,244
s_waitcnt lgkmcnt(9)
Ra 228,11,0
Maaa 128,96,240
buffer_load_dwordx4 v2, s[8:11], s50 offen offset:2048 lds
Maaa 128,100,244
Ta 44,21,16384
Ta 46,21,18432
Maaa 132,104,240
s_cmp_eq_u32 s6, 2
s_cselect_b32 s3, 0, 2146435072
Maaa 132,108,244
Ra 232,10,2048
Maaa 136,112,240
buffer_load_dwordx4 v3, s[8:11], s51 offen offset:3072 lds
Maaa 136,116,244
Ta 48,22,0
Ta 50,22,2048
Maaa 140,120,240
s_mov_b64 exec, 1
buffer_atomic_add v30, v31, s[28:31], s3 offen sc1
s_mov_b64 exec, -1
Maaa 140,124,244
s_add_u32 m0, s56, 69632
s_waitcnt lgkmcnt(9)
Ra 236,11,2048
Maaa 144,64,248
buffer_load_dwordx4 v4, s[8:11], s48 offen offset:0 lds
Maaa 144,68,252
Maaa 148,72,248
Maaa 148,76,252
Ta 52,22,16384
Ta 54,22,18432
Maaa 152,80,248
buffer_load_dwordx4 v5, s[8:11], s49 offen offset:1024 lds
Maaa 152,84,252
Ta 56,23,0
Ta 58,23,2048
Maaa 156,88,248
Maaa 156,92,252
Ta 60,23,16384
s_waitcnt lgkmcnt(9)
Ta 62,23,18432
Maaa 160,96,248
buffer_load_dwordx4 v4, s[8:11], s50 offen offset:2048 lds
Maaa 160,100,252
Maaa 164,104,248
Maaa 164,108,252
Maaa 168,112,248
buffer_load_dwordx4 v5, s[8:11], s51 offen offset:3072 lds
Maaa 168,116,252
v_xor_b32 v2, 384, v2
v_xor_b32 v3, 384, v3
Maaa 172,120,248
s_waitcnt lgkmcnt(6)
buffer_load_dword v1, v47, s[60:63], 0 offen
v_xor_b32 v4, 384, v4
v_xor_b32 v5, 384, v5
Maaa 172,124,252
s_waitcnt lgkmcnt(0)
s_mul_i32 vcc_lo, s59, 1
v_xor_b32_e64 v47, vcc_lo, v47
Mvaa 48,0,224
buffer_load_dword v44, v45, s[16:19], s47 offen
Mvaa 48,4,228
s_add_u32 s47, s47, 2097152
Mvaa 52,8,224
Mvaa 52,12,228
Ra 240,10,4096
Mvaa 56,16,224
Mvaa 56,20,228
Mvaa 60,24,224
Mvaa 60,28,228
Ra 244,11,4096
Mvaa 64,32,224
Mvaa 64,36,228
Mvaa 68,40,224
Mvaa 68,44,228
Ra 248,10,6144
Mvaa 72,48,224
Mvaa 72,52,228
Mvaa 76,56,224
Mvaa 76,60,228
Ra 252,11,6144
Mvaa 80,0,232
Mvaa 80,4,236
Mvaa 84,8,232
Mvaa 84,12,236
Mvaa 88,16,232
Mvaa 88,20,236
Mvaa 92,24,232
Mvaa 92,28,236
Mvaa 96,32,232
Mvaa 96,36,236
Mvaa 100,40,232
Mvaa 100,44,236
Mvaa 104,48,232
Mvaa 104,52,236
Mvaa 108,56,232
s_waitcnt lgkmcnt(0)
Mvaa 108,60,236
Mvaa 112,0,240
Mvaa 112,4,244
Mvaa 116,8,240
Mvaa 116,12,244
Ra 224,10,8192
Mvaa 120,16,240
Mvaa 120,20,244
Mvaa 124,24,240
Mvaa 124,28,244
Ra 228,11,8192
Mvaa 128,32,240
Mvaa 128,36,244
Mvaa 132,40,240
Mvaa 132,44,244
Ra 232,10,10240
Mvaa 136,48,240
Mvaa 136,52,244
Mvaa 140,56,240
Mvaa 140,60,244
Ra 236,11,10240
Mvaa 144,0,248
Mvaa 144,4,252
Mvaa 148,8,248
Mvaa 148,12,252
Mvaa 152,16,248
s_cmp_eq_u32 s6, 3
s_cselect_b32 s3, 0, 2146435072
Mvaa 152,20,252
s_mov_b64 exec, 1
buffer_atomic_add v30, v31, s[28:31], s3 offen sc1
s_mov_b64 exec, -1
Mvaa 156,24,248
Mvaa 156,28,252
Mvaa 160,32,248
Mvaa 160,36,252
Mvaa 164,40,248
Mvaa 164,44,252
Mvaa 168,48,248
Mvaa 168,52,252
s_waitcnt vmcnt(12)
Mvaa 172,56,248
s_waitcnt lgkmcnt(0)
s_barrier
Mvaa 172,60,252
s_add_u32 m0, s57, 0
Mvaa 176,0,224
buffer_load_dwordx4 v6, s[12:15], s52 offen offset:0 lds
Mvaa 176,4,228
Ta 64,14,0
Ta 66,14,2048
Mvaa 180,8,224
Mvaa 180,12,228
Ra 240,10,12288
Mvaa 184,16,224
buffer_load_dwordx4 v7, s[12:15], s53 offen offset:1024 lds
Mvaa 184,20,228
Ta 68,14,16384
Ta 70,14,18432
Mvaa 188,24,224
Mvaa 188,28,228
Ra 244,11,12288
Mvaa 192,32,224
buffer_load_dwordx4 v6, s[12:15], s54 offen offset:2048 lds
Mvaa 192,36,228
Ta 72,15,0
Ta 74,15,2048
Mvaa 196,40,224
Mvaa 196,44,228
Ra 248,10,14336
Mvaa 200,48,224
buffer_load_dwordx4 v7, s[12:15], s55 offen offset:3072 lds
Mvaa 200,52,228
Ta 76,15,16384
Ta 78,15,18432
Mvaa 204,56,224
Mvaa 204,60,228
s_add_u32 m0, s57, 4096
Ra 252,11,14336
Mvaa 208,0,232
buffer_load_dwordx4 v8, s[12:15], s52 offen offset:0 lds
Mvaa 208,4,236
Mvaa 212,8,232
Mvaa 212,12,236
Ta 80,24,0
Ta 82,24,2048
Mvaa 216,16,232
buffer_load_dwordx4 v9, s[12:15], s53 offen offset:1024 lds
Mvaa 216,20,236
Ta 84,24,16384
s_waitcnt lgkmcnt(9)
Ta 86,24,18432
Mvaa 220,24,232
Mvaa 220,28,236
Ta 88,25,0
Ta 90,25,2048
Mvaa 224,32,232
buffer_load_dwordx4 v8, s[12:15], s54 offen offset:2048 lds
Mvaa 224,36,236
Mvaa 228,40,232
Mvaa 228,44,236
Ta 92,25,16384
Ta 94,25,18432
Mvaa 232,48,232
buffer_load_dwordx4 v9, s[12:15], s55 offen offset:3072 lds
Mvaa 232,52,236
s_waitcnt vmcnt(11)
Ta 96,26,0
s_waitcnt lgkmcnt(9)
Ta 98,26,2048
Mvaa 236,56,232
s_barrier
v_xor_b32 v6, 524288, v6
v_xor_b32 v7, 524288, v7
Mvaa 236,60,236
s_add_u32 m0, s56, 0
Ta 100,26,16384
Ta 102,26,18432
Mvaa 240,0,240
buffer_load_dwordx4 v2, s[8:11], s48 offen offset:0 lds
Mvaa 240,4,244
v_xor_b32 v8, 524288, v8
v_xor_b32 v9, 524288, v9
Mvaa 244,8,240
Mvaa 244,12,244
Ra 224,12,0
Mvaa 248,16,240
buffer_load_dwordx4 v3, s[8:11], s49 offen offset:1024 lds
Mvaa 248,20,244
Ta 104,27,0
Ta 106,27,2048
Mvaa 252,24,240
Mvaa 252,28,244
s_waitcnt lgkmcnt(9)
Ra 228,13,0
Maaa 128,32,240
buffer_load_dwordx4 v2, s[8:11], s50 offen offset:2048 lds
Maaa 128,36,244
Ta 108,27,16384
Ta 110,27,18432
Maaa 132,40,240
Maaa 132,44,244
Ra 232,12,2048
Maaa 136,48,240
buffer_load_dwordx4 v3, s[8:11], s51 offen offset:3072 lds
Maaa 136,52,244
Ta 112,28,0
Ta 114,28,2048
Maaa 140,56,240
Maaa 140,60,244
s_add_u32 m0, s56, 4096
s_waitcnt lgkmcnt(9)
Ra 236,13,2048
Maaa 144,0,248
buffer_load_dwordx4 v4, s[8:11], s48 offen offset:0 lds
Maaa 144,4,252
Maaa 148,8,248
Maaa 148,12,252
Ta 116,28,16384
Ta 118,28,18432
Maaa 152,16,248
buffer_load_dwordx4 v5, s[8:11], s49 offen offset:1024 lds
Maaa 152,20,252
Ta 120,29,0
Ta 122,29,2048
Maaa 156,24,248
Maaa 156,28,252
Ta 124,29,16384
s_waitcnt lgkmcnt(9)
Ta 126,29,18432
Maaa 160,32,248
buffer_load_dwordx4 v4, s[8:11], s50 offen offset:2048 lds
Maaa 160,36,252
Maaa 164,40,248
Maaa 164,44,252
Maaa 168,48,248
buffer_load_dwordx4 v5, s[8:11], s51 offen offset:3072 lds
Maaa 168,52,252
v_xor_b32 v2, 128, v2
v_xor_b32 v3, 128, v3
Maaa 172,56,248
s_waitcnt lgkmcnt(6)
buffer_load_dword v1, v47, s[60:63], 0 offen
v_xor_b32 v4, 128, v4
v_xor_b32 v5, 128, v5
Maaa 172,60,252
s_waitcnt lgkmcnt(0)
s_mul_i32 vcc_lo, s59, 7
v_xor_b32 v47, vcc_lo, v47
Mvaa 48,64,224
buffer_load_dword v44, v45, s[16:19], s47 offen
Mvaa 48,68,228
s_add_u32 s47, s47, 2097152
v_lshrrev_b32 v32, 4, v0
v_and_b32 v33, 15, v0
Mvaa 52,72,224
s_lshl_b32 s3, s32, 4
v_add_u32 v34, s3, v32
v_lshlrev_b32_e64 v36, 1, v32
Mvaa 52,76,228
Ra 240,12,4096
Mvaa 56,80,224
v_xor_b32 v36, v36, v33
v_xor_b32 v37, 8, v36
Mvaa 56,84,228
Mvaa 60,88,224
Mvaa 60,92,228
Ra 244,13,4096
Mvaa 64,96,224
s_getpc_b64 s[6:7]
L_cpf2:
s_add_u32 s6, s6, (L_phase2-L_cpf2)&0xffffffff
s_addc_u32 s7, s7, ((L_phase2-L_cpf2)>>32)&0xffffffff
Mvaa 64,100,228
s_lshr_b32 s3, s2, 3
s_lshl_b32 s3, s3, 2
s_add_u32 s3, s3, s32
Mvaa 68,104,224
s_lshl_b32 s3, s3, 10
v_and_b32 v42, 7, v0
v_lshlrev_b32_e64 v42, 7, v42
Mvaa 68,108,228
Ra 248,12,6144
Mvaa 72,112,224
v_add_u32_e64 v42, s3, v42
v_min_u32 v42, L_k2_fin-L_phase2-4, v42
Mvaa 72,116,228
v_mov_b32_e64 v41, s7
Mvaa 76,120,224
v_add_co_u32 v40, vcc, s6, v42
s_nop 1
v_addc_co_u32 v41, vcc, 0, v41, vcc
Mvaa 76,124,228
Ra 252,13,6144
Mvaa 80,64,232
global_load_dword v38, v[40:41], off
Mvaa 80,68,236
Mvaa 84,72,232
Mvaa 84,76,236
Mvaa 88,80,232
Mvaa 88,84,236
Mvaa 92,88,232
Mvaa 92,92,236
Mvaa 96,96,232
Mvaa 96,100,236
Mvaa 100,104,232
Mvaa 100,108,236
Mvaa 104,112,232
Mvaa 104,116,236
Mvaa 108,120,232
s_waitcnt lgkmcnt(0)
Mvaa 108,124,236
Mvaa 112,64,240
Mvaa 112,68,244
Mvaa 116,72,240
Mvaa 116,76,244
Ra 224,12,8192
Mvaa 120,80,240
Mvaa 120,84,244
Mvaa 124,88,240
Mvaa 124,92,244
Ra 228,13,8192
Mvaa 128,96,240
Mvaa 128,100,244
Mvaa 132,104,240
Mvaa 132,108,244
Ra 232,12,10240
Mvaa 136,112,240
Mvaa 136,116,244
Mvaa 140,120,240
Mvaa 140,124,244
Ra 236,13,10240
Mvaa 144,64,248
Mvaa 144,68,252
Mvaa 148,72,248
Mvaa 148,76,252
Mvaa 152,80,248
Mvaa 152,84,252
Mvaa 156,88,248
Mvaa 156,92,252
Mvaa 160,96,248
Mvaa 160,100,252
Mvaa 164,104,248
Mvaa 164,108,252
Mvaa 168,112,248
Mvaa 168,116,252
s_waitcnt vmcnt(11)
Mvaa 172,120,248
s_waitcnt lgkmcnt(0)
s_barrier
Mvaa 172,124,252
s_add_u32 m0, s57, 65536
Mvaa 176,64,224
buffer_load_dwordx4 v6, s[12:15], s52 offen offset:0 lds
Mvaa 176,68,228
Ta 0,16,0
Ta 2,16,2048
Mvaa 180,72,224
Mvaa 180,76,228
Ra 240,12,12288
Mvaa 184,80,224
buffer_load_dwordx4 v7, s[12:15], s53 offen offset:1024 lds
Mvaa 184,84,228
Ta 4,16,16384
Ta 6,16,18432
Mvaa 188,88,224
Mvaa 188,92,228
Ra 244,13,12288
Mvaa 192,96,224
buffer_load_dwordx4 v6, s[12:15], s54 offen offset:2048 lds
Mvaa 192,100,228
Ta 8,17,0
Ta 10,17,2048
Mvaa 196,104,224
Mvaa 196,108,228
Ra 248,12,14336
Mvaa 200,112,224
buffer_load_dwordx4 v7, s[12:15], s55 offen offset:3072 lds
Mvaa 200,116,228
Ta 12,17,16384
Ta 14,17,18432
Mvaa 204,120,224
Mvaa 204,124,228
s_add_u32 m0, s57, 69632
Ra 252,13,14336
Mvaa 208,64,232
buffer_load_dwordx4 v8, s[12:15], s52 offen offset:0 lds
Mvaa 208,68,236
Mvaa 212,72,232
Mvaa 212,76,236
Ta 16,18,0
Ta 18,18,2048
Mvaa 216,80,232
buffer_load_dwordx4 v9, s[12:15], s53 offen offset:1024 lds
Mvaa 216,84,236
Ta 20,18,16384
s_waitcnt lgkmcnt(9)
Ta 22,18,18432
Mvaa 220,88,232
Mvaa 220,92,236
Ta 24,19,0
Ta 26,19,2048
Mvaa 224,96,232
buffer_load_dwordx4 v8, s[12:15], s54 offen offset:2048 lds
Mvaa 224,100,236
Mvaa 228,104,232
Mvaa 228,108,236
Ta 28,19,16384
Ta 30,19,18432
Mvaa 232,112,232
buffer_load_dwordx4 v9, s[12:15], s55 offen offset:3072 lds
Mvaa 232,116,236
s_waitcnt vmcnt(11)
Ta 32,20,0
s_waitcnt lgkmcnt(9)
Ta 34,20,2048
Mvaa 236,120,232
s_barrier
Mvaa 236,124,236
s_add_u32 m0, s56, 65536
Ta 36,20,16384
Ta 38,20,18432
Mvaa 240,64,240
buffer_load_dwordx4 v2, s[8:11], s48 offen offset:0 lds
Mvaa 240,68,244
Mvaa 244,72,240
Mvaa 244,76,244
Ra 224,10,0
Mvaa 248,80,240
buffer_load_dwordx4 v3, s[8:11], s49 offen offset:1024 lds
Mvaa 248,84,244
Ta 40,21,0
Ta 42,21,2048
Mvaa 252,88,240
Mvaa 252,92,244
s_waitcnt lgkmcnt(9)
Ra 228,11,0
Maaa 128,96,240
buffer_load_dwordx4 v2, s[8:11], s50 offen offset:2048 lds
Maaa 128,100,244
Ta 44,21,16384
Ta 46,21,18432
Maaa 132,104,240
Maaa 132,108,244
Ra 232,10,2048
Maaa 136,112,240
buffer_load_dwordx4 v3, s[8:11], s51 offen offset:3072 lds
Maaa 136,116,244
Ta 48,22,0
Ta 50,22,2048
Maaa 140,120,240
Maaa 140,124,244
s_add_u32 m0, s56, 69632
s_waitcnt lgkmcnt(9)
Ra 236,11,2048
Maaa 144,64,248
buffer_load_dwordx4 v4, s[8:11], s48 offen offset:0 lds
Maaa 144,68,252
Maaa 148,72,248
Maaa 148,76,252
Ta 52,22,16384
Ta 54,22,18432
Maaa 152,80,248
buffer_load_dwordx4 v5, s[8:11], s49 offen offset:1024 lds
Maaa 152,84,252
Ta 56,23,0
Ta 58,23,2048
Maaa 156,88,248
Maaa 156,92,252
Ta 60,23,16384
s_waitcnt lgkmcnt(9)
Ta 62,23,18432
Maaa 160,96,248
buffer_load_dwordx4 v4, s[8:11], s50 offen offset:2048 lds
Maaa 160,100,252
Maaa 164,104,248
Maaa 164,108,252
Maaa 168,112,248
buffer_load_dwordx4 v5, s[8:11], s51 offen offset:3072 lds
Maaa 168,116,252
Maaa 172,120,248
s_waitcnt lgkmcnt(6)
Maaa 172,124,252
s_waitcnt lgkmcnt(0)
Mvaa 48,0,224
buffer_load_dword v1, v31, s[28:31], s37 offen sc1
Mvaa 48,4,228
s_mov_b32 s8, s16
s_mov_b32 s9, s17
s_mov_b32 s10, s18
Mvaa 52,8,224
s_add_u32 s16, s66, 46137344
s_addc_u32 s17, s67, 0
s_and_b32 s17, s17, 0xffff
Mvaa 52,12,228
Ra 240,10,4096
Mvaa 56,16,224
s_mov_b32 s18, 16777216
s_mov_b32 s19, 0x20000
s_mov_b32 s48, 0
Mvaa 56,20,228
s_mov_b32 s49, 31744
s_mov_b32 s50, 63488
s_mov_b32 s51, 95232
Mvaa 60,24,224
v_lshlrev_b32 v35, 13, v34
Mvaa 60,28,228
Ra 244,11,4096
Mvaa 64,32,224
s_and_b32 s52, s33, 0
s_lshl_b32 s3, s52, 19
s_lshl_b32 s52, s52, 11
Mvaa 64,36,228
s_add_u32 s53, s52, s58
v_add_u32_e64 v35, s3, v35
v_lshl_add_u32 v8, v36, 4, v35
Mvaa 68,40,224
v_lshl_add_u32 v9, v37, 4, v35
v_lshlrev_b32_e64 v2, 4, v0
Mvaa 68,44,228
Ra 248,10,6144
Mvaa 72,48,224
v_add_u32 v3, 65536, v2
v_add_u32_e64 v4, s44, v2
Mvaa 72,52,228
v_mov_b32 v7, 0
v_lshlrev_b32 v35, 2, v32
Mvaa 76,56,224
v_sub_u32_e64 v35, v33, v35
Mvaa 76,60,228
Ra 252,11,6144
Mvaa 80,0,232
s_lshl_b32 s3, s32, 4
v_add_u32 v5, s3, v35
Mvaa 80,4,236
s_sub_u32 s3, 48, s3
v_add_u32 v6, s3, v35
Mvaa 84,8,232
s_mul_i32 s3, s33, 1116160
s_add_u32 s3, s3, 8388608
s_add_u32 s12, s66, s3
s_addc_u32 s13, s67, 0
s_and_b32 s13, s13, 0xffff
Mvaa 84,12,236
s_mov_b32 s14, 0
s_mov_b32 s15, 0x20000
s_mul_i32 s14, s36, 34816
Mvaa 88,16,232
buffer_load_dword v44, v45, s[8:11], s47 offen
Mvaa 88,20,236
s_add_u32 s47, s47, 2097152
v_lshrrev_b32 v42, 2, v33
v_lshl_add_u32 v43, v32, 3, v42
Mvaa 92,24,232
v_lshlrev_b32 v43, 8, v43
v_and_b32 v46, 3, v0
Mvaa 92,28,236
v_lshl_add_u32 v43, v46, 3, v43
v_and_b32_e64 v46, 1, v32
Mvaa 96,32,232
v_lshl_add_u32 v42, v46, 2, v42
v_lshl_add_u32 v16, v42, 5, v43
Mvaa 96,36,236
v_xor_b32 v17, 32, v16
v_xor_b32 v18, 64, v16
Mvaa 100,40,232
v_xor_b32 v19, 96, v16
v_xor_b32 v20, 128, v16
Mvaa 100,44,236
v_xor_b32 v21, 160, v16
v_xor_b32 v22, 192, v16
Mvaa 104,48,232
v_xor_b32 v23, 224, v16
Mvaa 104,52,236
Mvaa 108,56,232
s_waitcnt lgkmcnt(0)
Mvaa 108,60,236
Mvaa 112,0,240
Mvaa 112,4,244
Mvaa 116,8,240
Mvaa 116,12,244
Ra 224,10,8192
Mvaa 120,16,240
Mvaa 120,20,244
Mvaa 124,24,240
Mvaa 124,28,244
Ra 228,11,8192
Mvaa 128,32,240
Mvaa 128,36,244
Mvaa 132,40,240
Mvaa 132,44,244
Ra 232,10,10240
Mvaa 136,48,240
Mvaa 136,52,244
Mvaa 140,56,240
Mvaa 140,60,244
Ra 236,11,10240
Mvaa 144,0,248
Mvaa 144,4,252
Mvaa 148,8,248
Mvaa 148,12,252
Mvaa 152,16,248
Mvaa 152,20,252
Mvaa 156,24,248
Mvaa 156,28,252
Mvaa 160,32,248
Mvaa 160,36,252
Mvaa 164,40,248
Mvaa 164,44,252
Mvaa 168,48,248
Mvaa 168,52,252
s_waitcnt vmcnt(10)
Mvaa 172,56,248
s_waitcnt lgkmcnt(0)
s_barrier
Mvaa 172,60,252
s_add_u32 m0, s44, 0
Mvaa 176,0,224
buffer_load_dwordx4 v8, s[8:11], s48 offen offset:0 lds
Mvaa 176,4,228
Ta 64,14,0
Ta 66,14,2048
Mvaa 180,8,224
Mvaa 180,12,228
Ra 240,10,12288
Mvaa 184,16,224
buffer_load_dwordx4 v8, s[8:11], s49 offen offset:1024 lds
Mvaa 184,20,228
Ta 68,14,16384
Ta 70,14,18432
Mvaa 188,24,224
Mvaa 188,28,228
Ra 244,11,12288
Mvaa 192,32,224
buffer_load_dwordx4 v9, s[8:11], s50 offen offset:2048 lds
Mvaa 192,36,228
Ta 72,15,0
Ta 74,15,2048
Mvaa 196,40,224
Mvaa 196,44,228
Ra 248,10,14336
Mvaa 200,48,224
buffer_load_dwordx4 v9, s[8:11], s51 offen offset:3072 lds
Mvaa 200,52,228
Ta 76,15,16384
Ta 78,15,18432
Mvaa 204,56,224
v_xor_b32 v8, 524288, v8
v_xor_b32 v9, 524288, v9
Mvaa 204,60,228
s_add_u32 m0, s44, 16384
Ra 252,11,14336
Mvaa 208,0,232
buffer_load_dwordx4 v8, s[8:11], s48 offen offset:0 lds
Mvaa 208,4,236
Mvaa 212,8,232
Mvaa 212,12,236
Ta 80,24,0
Ta 82,24,2048
Mvaa 216,16,232
buffer_load_dwordx4 v8, s[8:11], s49 offen offset:1024 lds
Mvaa 216,20,236
Ta 84,24,16384
s_waitcnt lgkmcnt(9)
Ta 86,24,18432
Mvaa 220,24,232
Mvaa 220,28,236
Ta 88,25,0
Ta 90,25,2048
Mvaa 224,32,232
buffer_load_dwordx4 v9, s[8:11], s50 offen offset:2048 lds
Mvaa 224,36,236
Mvaa 228,40,232
s_mul_i32 s3, s45, 33792
v_add_u32_e64 v10, s3, v2
Mvaa 228,44,236
Ta 92,25,16384
Ta 94,25,18432
Mvaa 232,48,232
buffer_load_dwordx4 v9, s[8:11], s51 offen offset:3072 lds
Mvaa 232,52,236
s_waitcnt vmcnt(10)
Ta 96,26,0
s_waitcnt lgkmcnt(9)
Ta 98,26,2048
Mvaa 236,56,232
s_barrier
v_xor_b32 v8, 1572864, v8
v_xor_b32 v9, 1572864, v9
Mvaa 236,60,236
s_add_u32 m0, s44, 32768
Ta 100,26,16384
Ta 102,26,18432
Mvaa 240,0,240
buffer_load_dwordx4 v8, s[8:11], s48 offen offset:0 lds
Mvaa 240,4,244
s_mul_i32 s3, s46, 33792
v_add_u32 v11, s3, v2
Mvaa 244,8,240
Mvaa 244,12,244
Ra 224,12,0
Mvaa 248,16,240
buffer_load_dwordx4 v8, s[8:11], s49 offen offset:1024 lds
Mvaa 248,20,244
Ta 104,27,0
Ta 106,27,2048
Mvaa 252,24,240
Mvaa 252,28,244
s_waitcnt lgkmcnt(9)
Ra 228,13,0
Maaa 128,32,240
buffer_load_dwordx4 v9, s[8:11], s50 offen offset:2048 lds
Maaa 128,36,244
Ta 108,27,16384
Ta 110,27,18432
Maaa 132,40,240
Maaa 132,44,244
Ra 232,12,2048
Maaa 136,48,240
buffer_load_dwordx4 v9, s[8:11], s51 offen offset:3072 lds
Maaa 136,52,244
Ta 112,28,0
Ta 114,28,2048
Maaa 140,56,240
v_xor_b32 v8, 524288, v8
v_xor_b32 v9, 524288, v9
Maaa 140,60,244
s_add_u32 m0, s44, 49152
s_waitcnt lgkmcnt(9)
Ra 236,13,2048
Maaa 144,0,248
buffer_load_dwordx4 v8, s[8:11], s48 offen offset:0 lds
Maaa 144,4,252
Maaa 148,8,248
Maaa 148,12,252
Ta 116,28,16384
Ta 118,28,18432
Maaa 152,16,248
buffer_load_dwordx4 v8, s[8:11], s49 offen offset:1024 lds
Maaa 152,20,252
Ta 120,29,0
Ta 122,29,2048
Maaa 156,24,248
Maaa 156,28,252
Ta 124,29,16384
s_waitcnt lgkmcnt(9)
Ta 126,29,18432
Maaa 160,32,248
buffer_load_dwordx4 v9, s[8:11], s50 offen offset:2048 lds
Maaa 160,36,252
Maaa 164,40,248
Maaa 164,44,252
Maaa 168,48,248
buffer_load_dwordx4 v9, s[8:11], s51 offen offset:3072 lds
Maaa 168,52,252
v_xor_b32 v8, 3670016, v8
v_xor_b32 v9, 3670016, v9
Maaa 172,56,248
s_waitcnt lgkmcnt(6)
Maaa 172,60,252
s_waitcnt lgkmcnt(0)
Mvaa 48,64,224
v_mov_b32 v14, v40
v_mov_b32_e64 v15, v41
Mvaa 48,68,228
Mvaa 52,72,224
Mvaa 52,76,228
Ra 240,12,4096
Mvaa 56,80,224
Mvaa 56,84,228
Mvaa 60,88,224
Mvaa 60,92,228
Ra 244,13,4096
Mvaa 64,96,224
Vc 24,48,49
Vc 25,50,51
Mvaa 64,100,228
Vc 26,52,53
Vc 27,54,55
Mvaa 68,104,224
Mvaa 68,108,228
Ra 248,12,6144
Mvaa 72,112,224
Vc 28,56,57
Vc 29,58,59
Mvaa 72,116,228
Vc 30,60,61
Vc 31,62,63
Mvaa 76,120,224
Mvaa 76,124,228
Ra 252,13,6144
Mvaa 80,64,232
Vc 32,64,65
Vc 33,66,67
Mvaa 80,68,236
Vc 34,68,69
Vc 35,70,71
Mvaa 84,72,232
Mvaa 84,76,236
Mvaa 88,80,232
Vc 36,72,73
Vc 37,74,75
Mvaa 88,84,236
Vc 38,76,77
Vc 39,78,79
Mvaa 92,88,232
Mvaa 92,92,236
Mvaa 96,96,232
Vc 40,80,81
Vc 41,82,83
Mvaa 96,100,236
Vc 42,84,85
Vc 43,86,87
Mvaa 100,104,232
s_waitcnt vmcnt(12)
Mvaa 100,108,236
s_add_u32 s59, s38, 0
Mvaa 104,112,232
v_readfirstlane_b32 s3, v1
s_nop 0
s_or_b32 s3, s3, s37
s_cmp_lt_u32 s3, 256
s_cbranch_scc1 L_spinAk
L_spinArk:
s_barrier
Mvaa 104,116,236
buffer_store_dwordx4 v[24:27], v2, s[24:27], s59 offen offset:0 sc1
Mvaa 108,120,232
s_waitcnt lgkmcnt(0)
Mvaa 108,124,236
Vc 44,88,89
Vc 45,90,91
Mvaa 112,64,240
buffer_load_dwordx4 a[0:3], v10, s[20:23], s53 offen offset:0 sc1
Mvaa 112,68,244
Vc 46,92,93
Vc 47,94,95
Mvaa 116,72,240
Vc 48,96,97
Vc 49,98,99
Mvaa 116,76,244
Ra 224,12,8192
Mvaa 120,80,240
Vc 50,100,101
Vc 51,102,103
Mvaa 120,84,244
Vc 52,104,105
Vc 53,106,107
Mvaa 124,88,240
buffer_load_dwordx4 a[4:7], v10, s[20:23], s52 offen offset:0 sc1
Mvaa 124,92,244
Ra 228,13,8192
Mvaa 128,96,240
Vc 54,108,109
Vc 55,110,111
Mvaa 128,100,244
Vc 56,112,113
Vc 57,114,115
Mvaa 132,104,240
Vc 58,116,117
Vc 59,118,119
Mvaa 132,108,244
Ra 232,12,10240
Mvaa 136,112,240
buffer_load_dwordx4 a[8:11], v11, s[20:23], s53 offen offset:0 sc1
Mvaa 136,116,244
buffer_store_dwordx4 v[28:31], v2, s[24:27], s59 offen offset:1024 sc1
Mvaa 140,120,240
Vc 60,120,121
Vc 61,122,123
Mvaa 140,124,244
Ra 236,13,10240
Mvaa 144,64,248
Vc 62,124,125
Vc 63,126,127
Mvaa 144,68,252
Vc 64,128,129
Vc 65,130,131
Mvaa 148,72,248
buffer_load_dwordx4 a[12:15], v11, s[20:23], s52 offen offset:0 sc1
Mvaa 148,76,252
Vc 66,132,133
Vc 67,134,135
Mvaa 152,80,248
Vc 68,136,137
Vc 69,138,139
Mvaa 152,84,252
Vc 70,140,141
Vc 71,142,143
Mvaa 156,88,248
Mvaa 156,92,252
Mvaa 160,96,248
buffer_load_dwordx4 a[16:19], v10, s[20:23], s53 offen offset:1024 sc1
Mvaa 160,100,252
Vc 72,144,145
Vc 73,146,147
Mvaa 164,104,248
Vc 74,148,149
Vc 75,150,151
Mvaa 164,108,252
buffer_store_dwordx4 v[32:35], v2, s[24:27], s59 offen offset:2048 sc1
Mvaa 168,112,248
Vc 76,152,153
Vc 77,154,155
Mvaa 168,116,252
Vc 78,156,157
Vc 79,158,159
Mvaa 172,120,248
s_waitcnt lgkmcnt(0)
buffer_load_dwordx4 a[20:23], v10, s[20:23], s52 offen offset:1024 sc1
Mvaa 172,124,252
Mvaa 176,64,224
Vc 80,160,161
Vc 81,162,163
Mvaa 176,68,228
Vc 82,164,165
Vc 83,166,167
Mvaa 180,72,224
Mvaa 180,76,228
Ra 240,12,12288
Mvaa 184,80,224
buffer_load_dwordx4 a[24:27], v11, s[20:23], s53 offen offset:1024 sc1
Mvaa 184,84,228
Vc 84,168,169
Vc 85,170,171
Mvaa 188,88,224
Vc 86,172,173
Vc 87,174,175
Mvaa 188,92,228
Ra 244,13,12288
Mvaa 192,96,224
Vc 88,176,177
Vc 89,178,179
Mvaa 192,100,228
Vc 90,180,181
Vc 91,182,183
Mvaa 196,104,224
buffer_load_dwordx4 a[28:31], v11, s[20:23], s52 offen offset:1024 sc1
Mvaa 196,108,228
Ra 248,12,14336
s_xor_b32 s52, s52, 2048
Mvaa 200,112,224
s_add_u32 s53, s52, s58
Mvaa 200,116,228
Vc 92,184,185
Vc 93,186,187
Mvaa 204,120,224
Vc 94,188,189
Vc 95,190,191
Mvaa 204,124,228
Ra 252,13,14336
Mvaa 208,64,232
buffer_load_dwordx4 a[32:35], v10, s[20:23], s53 offen offset:0 sc1
Mvaa 208,68,236
buffer_store_dwordx4 v[36:39], v2, s[24:27], s59 offen offset:3072 sc1
Mvaa 212,72,232
Vc 96,192,193
Vc 97,194,195
Mvaa 212,76,236
Vc 98,196,197
Vc 99,198,199
Mvaa 216,80,232
Vc 100,200,201
Vc 101,202,203
Mvaa 216,84,236
Vc 102,204,205
Vc 103,206,207
Mvaa 220,88,232
buffer_load_dwordx4 a[36:39], v10, s[20:23], s52 offen offset:0 sc1
Mvaa 220,92,236
Mvaa 224,96,232
Vc 104,208,209
Vc 105,210,211
Mvaa 224,100,236
Vc 106,212,213
Vc 107,214,215
Mvaa 228,104,232
Mvaa 228,108,236
Mvaa 232,112,232
buffer_load_dwordx4 a[40:43], v11, s[20:23], s53 offen offset:0 sc1
Mvaa 232,116,236
Vc 108,216,217
Vc 109,218,219
Mvaa 236,120,232
s_waitcnt lgkmcnt(0)
Mvaa 236,124,236
Vc 110,220,221
Vc 111,222,223
Mvaa 240,64,240
s_add_u32 s59, s38, 4096
Mvaa 240,68,244
buffer_store_dwordx4 v[40:43], v2, s[24:27], s59 offen offset:0 sc1
Mvaa 244,72,240
buffer_load_dwordx4 a[44:47], v11, s[20:23], s52 offen offset:0 sc1
Mvaa 244,76,244
Vc 112,224,225
Vc 113,226,227
Mvaa 248,80,240
Vc 114,228,229
Vc 115,230,231
Mvaa 248,84,244
Vc 116,232,233
Vc 117,234,235
Mvaa 252,88,240
Vc 118,236,237
Vc 119,238,239
Mvaa 252,92,244
Maaa 128,96,240
buffer_load_dwordx4 a[48:51], v10, s[20:23], s53 offen offset:1024 sc1
Maaa 128,100,244
Ta 192,16,0
Ta 194,16,1024
Maaa 132,104,240
Vc 120,240,241
Vc 121,242,243
Maaa 132,108,244
Ta 196,17,0
Ta 198,17,1024
Maaa 136,112,240
Vc 122,244,245
Vc 123,246,247
Maaa 136,116,244
Ta 200,18,0
Ta 202,18,1024
Maaa 140,120,240
buffer_load_dwordx4 a[52:55], v10, s[20:23], s52 offen offset:1024 sc1
Maaa 140,124,244
Ta 204,19,0
Ta 206,19,1024
Maaa 144,64,248
Vc 124,248,249
Vc 125,250,251
Maaa 144,68,252
Ta 208,20,0
Ta 210,20,1024
Maaa 148,72,248
Vc 126,252,253
Vc 127,254,255
Maaa 148,76,252
Ta 212,21,0
Ta 214,21,1024
Maaa 152,80,248
buffer_load_dwordx4 a[56:59], v11, s[20:23], s53 offen offset:1024 sc1
Maaa 152,84,252
Ta 216,22,0
Ta 218,22,1024
Maaa 156,88,248
buffer_store_dwordx4 v[44:47], v2, s[24:27], s59 offen offset:1024 sc1
Maaa 156,92,252
Ta 220,23,0
s_waitcnt lgkmcnt(9)
Ta 222,23,1024
Maaa 160,96,248
Maaa 160,100,252
Maaa 164,104,248
buffer_load_dwordx4 a[60:63], v11, s[20:23], s52 offen offset:1024 sc1
Maaa 164,108,252
s_xor_b32 s52, s52, 6144
s_add_u32 s53, s52, s58
Maaa 168,112,248
Maaa 168,116,252
Maaa 172,120,248
Maaa 172,124,252
s_branch L_phase2
L_k1_vpath:
Zvaa 48,224,0
v_and_b32_e64 v46, 7, v0
v_mul_u32_u24 v30, 2064, v46
Mvaa 48,228,4
s_add_u32 m0, s57, 65536
Zvaa 52,232,0
buffer_load_dwordx4 v6, s[12:15], s52 offen offset:0 lds
Mvaa 52,236,4
Ra 240,10,4096
Zvaa 56,224,8
buffer_load_dwordx4 v7, s[12:15], s53 offen offset:1024 lds
Mvaa 56,228,12
v_lshrrev_b32_e64 v31, 3, v0
Zvaa 60,232,8
buffer_load_dwordx4 v6, s[12:15], s54 offen offset:2048 lds
Mvaa 60,236,12
Ra 244,11,4096
Zvaa 64,224,16
buffer_load_dwordx4 v7, s[12:15], s55 offen offset:3072 lds
Mvaa 64,228,20
s_add_u32 m0, s57, 69632
Zvaa 68,232,16
buffer_load_dwordx4 v8, s[12:15], s52 offen offset:0 lds
Mvaa 68,236,20
Ra 248,10,6144
Zvaa 72,224,24
buffer_load_dwordx4 v9, s[12:15], s53 offen offset:1024 lds
Mvaa 72,228,28
s_lshl_b32 s3, s32, 9
s_add_u32 s3, s3, 131072
v_lshl_add_u32 v30, v31, 4, v30
Zvaa 76,232,24
buffer_load_dwordx4 v8, s[12:15], s54 offen offset:2048 lds
Mvaa 76,236,28
s_waitcnt lgkmcnt(9)
Ra 252,11,6144
Zvaa 80,224,32
buffer_load_dwordx4 v9, s[12:15], s55 offen offset:3072 lds
Mvaa 80,228,36
s_add_u32 m0, s56, 65536
v_xor_b32 v6, 1572864, v6
v_xor_b32 v7, 1572864, v7
Zvaa 84,232,32
buffer_load_dwordx4 v2, s[8:11], s48 offen offset:0 lds
Mvaa 84,236,36
v_xor_b32 v8, 1572864, v8
v_xor_b32 v9, 1572864, v9
Zvaa 88,224,40
buffer_load_dwordx4 v3, s[8:11], s49 offen offset:1024 lds
Mvaa 88,228,44
v_add_u32 v30, s3, v30
v_lshlrev_b32 v31, 8, v31
Zvaa 92,232,40
buffer_load_dwordx4 v2, s[8:11], s50 offen offset:2048 lds
Mvaa 92,236,44
v_lshl_add_u32 v46, v46, 4, v31
s_waitcnt lgkmcnt(8)
Zvaa 96,224,48
buffer_load_dwordx4 v3, s[8:11], s51 offen offset:3072 lds
Mvaa 96,228,52
s_add_u32 m0, s56, 69632
Zvaa 100,232,48
buffer_load_dwordx4 v4, s[8:11], s48 offen offset:0 lds
Mvaa 100,236,52
Rv 34,30,128
Rv 38,30,256
s_waitcnt lgkmcnt(6)
Zvaa 104,224,56
buffer_load_dwordx4 v5, s[8:11], s49 offen offset:1024 lds
Mvaa 104,228,60
Rv 42,30,384
Rv 30,30,0
Zvaa 108,232,56
s_waitcnt lgkmcnt(4)
buffer_load_dwordx4 v4, s[8:11], s50 offen offset:2048 lds
Mvaa 108,236,60
s_lshr_b32 s3, s2, 1
s_mul_i32 s3, s3, 33792
s_add_u32 s3, s3, s57
Zvaa 112,240,0
buffer_load_dwordx4 v5, s[8:11], s51 offen offset:3072 lds
Mvaa 112,244,4
v_xor_b32 v2, 384, v2
v_xor_b32 v3, 384, v3
Zvaa 116,248,0
s_and_b32 s39, s2, 1
s_lshl_b32 s39, s39, 7
s_add_u32 s3, s3, s39
Mvaa 116,252,4
Ra 224,10,8192
v_xor_b32 v4, 384, v4
Zvaa 120,240,8
s_add_u32 s39, s3, 4096
Mvaa 120,244,12
v_xor_b32 v5, 384, v5
Zvaa 124,248,8
Mvaa 124,252,12
Ra 228,11,8192
Zvaa 128,240,16
Mvaa 128,244,20
Zvaa 132,248,16
Mvaa 132,252,20
Ra 232,10,10240
Zvaa 136,240,24
buffer_load_dword v1, v47, s[60:63], 0 offen
Mvaa 136,244,28
s_mul_i32 vcc_lo, s59, 1
v_xor_b32 v47, vcc_lo, v47
Zvaa 140,248,24
Mvaa 140,252,28
Ra 236,11,10240
Zvaa 144,240,32
Mvaa 144,244,36
Zvaa 148,248,32
Mvaa 148,252,36
Zvaa 152,240,40
Mvaa 152,244,44
Zvaa 156,248,40
Mvaa 156,252,44
Zvaa 160,240,48
Mvaa 160,244,52
Zvaa 164,248,48
Mvaa 164,252,52
Zvaa 168,240,56
Mvaa 168,244,60
s_waitcnt vmcnt(9)
Zvaa 172,248,56
s_waitcnt lgkmcnt(0)
s_barrier
Mvaa 172,252,60
s_add_u32 m0, s57, 0
Zvaa 176,224,0
buffer_load_dwordx4 v6, s[12:15], s52 offen offset:0 lds
Mvaa 176,228,4
Ta 64,14,0
Ta 66,14,2048
Zvaa 180,232,0
Mvaa 180,236,4
Ra 240,10,12288
Zvaa 184,224,8
buffer_load_dwordx4 v7, s[12:15], s53 offen offset:1024 lds
Mvaa 184,228,12
Ta 68,14,16384
Ta 70,14,18432
Zvaa 188,232,8
Mvaa 188,236,12
Ra 244,11,12288
Zvaa 192,224,16
buffer_load_dwordx4 v6, s[12:15], s54 offen offset:2048 lds
Mvaa 192,228,20
Ta 72,15,0
Ta 74,15,2048
Zvaa 196,232,16
Mvaa 196,236,20
Ra 248,10,14336
Zvaa 200,224,24
buffer_load_dwordx4 v7, s[12:15], s55 offen offset:3072 lds
Mvaa 200,228,28
Ta 76,15,16384
Ta 78,15,18432
Zvaa 204,232,24
Mvaa 204,236,28
s_add_u32 m0, s57, 4096
Ra 252,11,14336
Zvaa 208,224,32
buffer_load_dwordx4 v8, s[12:15], s52 offen offset:0 lds
Mvaa 208,228,36
Zvaa 212,232,32
Mvaa 212,236,36
Ta 80,24,0
Ta 82,24,2048
Zvaa 216,224,40
buffer_load_dwordx4 v9, s[12:15], s53 offen offset:1024 lds
Mvaa 216,228,44
Ta 84,24,16384
s_waitcnt lgkmcnt(9)
Ta 86,24,18432
Zvaa 220,232,40
Mvaa 220,236,44
Ta 88,25,0
Ta 90,25,2048
Zvaa 224,224,48
buffer_load_dwordx4 v8, s[12:15], s54 offen offset:2048 lds
Mvaa 224,228,52
Zvaa 228,232,48
Mvaa 228,236,52
Ta 92,25,16384
Ta 94,25,18432
Zvaa 232,224,56
buffer_load_dwordx4 v9, s[12:15], s55 offen offset:3072 lds
Mvaa 232,228,60
s_waitcnt vmcnt(9)
Ta 96,26,0
s_waitcnt lgkmcnt(9)
Ta 98,26,2048
Zvaa 236,232,56
s_barrier
v_xor_b32 v6, 524288, v6
v_xor_b32 v7, 524288, v7
Mvaa 236,236,60
s_add_u32 m0, s56, 0
Ta 100,26,16384
Ta 102,26,18432
Zvaa 240,240,0
buffer_load_dwordx4 v2, s[8:11], s48 offen offset:0 lds
Mvaa 240,244,4
v_xor_b32 v8, 524288, v8
v_xor_b32 v9, 524288, v9
Zvaa 244,248,0
Mvaa 244,252,4
Ra 224,12,0
Zvaa 248,240,8
buffer_load_dwordx4 v3, s[8:11], s49 offen offset:1024 lds
Mvaa 248,244,12
Ta 104,27,0
Ta 106,27,2048
Zvaa 252,248,8
Mvaa 252,252,12
s_waitcnt lgkmcnt(9)
Ra 228,13,0
Zaaa 128,240,16
buffer_load_dwordx4 v2, s[8:11], s50 offen offset:2048 lds
Maaa 128,244,20
Ta 108,27,16384
Ta 110,27,18432
Zaaa 132,248,16
Maaa 132,252,20
Ra 232,12,2048
Zaaa 136,240,24
buffer_load_dwordx4 v3, s[8:11], s51 offen offset:3072 lds
Maaa 136,244,28
Ta 112,28,0
Ta 114,28,2048
Zaaa 140,248,24
Maaa 140,252,28
s_add_u32 m0, s56, 4096
s_waitcnt lgkmcnt(9)
Ra 236,13,2048
Zaaa 144,240,32
buffer_load_dwordx4 v4, s[8:11], s48 offen offset:0 lds
Maaa 144,244,36
Zaaa 148,248,32
Maaa 148,252,36
Ta 116,28,16384
Ta 118,28,18432
Zaaa 152,240,40
buffer_load_dwordx4 v5, s[8:11], s49 offen offset:1024 lds
Maaa 152,244,44
Ta 120,29,0
Ta 122,29,2048
Zaaa 156,248,40
Maaa 156,252,44
Ta 124,29,16384
s_waitcnt lgkmcnt(9)
Ta 126,29,18432
Zaaa 160,240,48
buffer_load_dwordx4 v4, s[8:11], s50 offen offset:2048 lds
Maaa 160,244,52
Zaaa 164,248,48
Maaa 164,252,52
Zaaa 168,240,56
buffer_load_dwordx4 v5, s[8:11], s51 offen offset:3072 lds
Maaa 168,244,60
v_xor_b32 v2, 128, v2
v_xor_b32 v3, 128, v3
Zaaa 172,248,56
s_waitcnt lgkmcnt(6)
buffer_load_dword v1, v47, s[60:63], 0 offen
v_xor_b32 v4, 128, v4
v_xor_b32 v5, 128, v5
Maaa 172,252,60
s_waitcnt lgkmcnt(0)
s_mul_i32 vcc_lo, s59, 7
v_xor_b32 v47, vcc_lo, v47
Mvaa 48,224,64
buffer_store_dwordx4 v[30:33], v46, s[20:23], s3 offen offset:0 sc1
Mvaa 48,228,68
buffer_store_dwordx4 v[34:37], v46, s[20:23], s3 offen offset:2048 sc1
Mvaa 52,232,64
buffer_store_dwordx4 v[38:41], v46, s[20:23], s39 offen offset:0 sc1
Mvaa 52,236,68
Ra 240,12,4096
Mvaa 56,224,72
buffer_store_dwordx4 v[42:45], v46, s[20:23], s39 offen offset:2048 sc1
Mvaa 56,228,76
s_lshl_b32 s3, s34, 1
s_and_b32 s36, s32, 1
s_add_u32 s3, s3, s36
Mvaa 60,232,72
s_mul_i32 s3, s3, 1116160
s_mul_i32 s36, s33, 139264
s_add_u32 s3, s3, s36
Mvaa 60,236,76
Ra 244,13,4096
Mvaa 64,224,80
s_lshr_b32 s36, s32, 1
s_mul_i32 s36, s36, 69632
s_add_u32 s3, s3, s36
Mvaa 64,228,84
s_add_u32 s38, s3, 17408
s_lshl_b32 s39, s34, 7
s_lshl_b32 s36, s33, 2
Mvaa 68,232,80
s_add_u32 s39, s39, s36
s_add_u32 s39, s39, 5296160
v_mov_b32 v30, 1
Mvaa 68,236,84
Ra 248,12,6144
Mvaa 72,224,88
v_mov_b32_e64 v31, 0
Mvaa 72,228,92
s_cmp_eq_u32 s32, 0
s_cselect_b32 s39, s39, 2146435072
Mvaa 76,232,88
s_mov_b64 exec, 1
buffer_store_dword v31, v31, s[20:23], s39 offen sc1
s_mov_b64 exec, -1
Mvaa 76,236,92
Ra 252,13,6144
Mvaa 80,224,96
s_and_b32 s33, s2, 7
s_lshl_b32 s33, s33, 2
s_bfe_u32 s3, s2, 0x20003
Mvaa 80,228,100
s_add_u32 s33, s33, s3
s_lshr_b32 s34, s2, 5
s_lshl_b32 s64, s34, 7
Mvaa 84,232,96
s_lshl_b32 s3, s33, 2
s_add_u32 s64, s64, s3
s_add_u32 s64, s64, 5300224
Mvaa 84,236,100
s_lshl_b32 s65, s34, 8
s_sub_u32 s65, 1920, s65
v_mul_u32_u24 v32, s65, v0
Mvaa 88,224,104
s_cmp_eq_u32 s32, 0
s_cselect_b32 s64, s64, 2146435072
Mvaa 88,228,108
s_mov_b64 exec, 3
buffer_store_dword v31, v32, s[20:23], s64 offen sc1
s_mov_b64 exec, -1
Mvaa 92,232,104
s_lshl_b32 s3, s2, 2
s_add_u32 s3, s3, 5447680
v_lshlrev_b32_e64 v32, 10, v0
Mvaa 92,236,108
s_cmp_eq_u32 s32, 0
s_cselect_b32 s3, s3, 2146435072
Mvaa 96,224,112
s_mov_b64 exec, 0x1ff
buffer_store_dword v31, v32, s[20:23], s3 offen sc1
s_mov_b64 exec, -1
Mvaa 96,228,116
s_lshl_b32 s35, s34, 1
s_sub_u32 s36, 32, s35
s_add_u32 s35, s35, 2
Mvaa 100,232,112
s_lshl_b32 s44, s32, 12
s_lshl_b32 s58, s32, 1
s_sub_u32 s58, 7, s58
Mvaa 100,236,116
s_mul_i32 s58, s58, 33792
s_sub_u32 s3, 15, s34
s_lshl_b32 s45, s3, 3
Mvaa 104,224,120
s_add_u32 s45, s45, s32
s_lshl_b32 s46, s34, 3
s_add_u32 s46, s46, s32
Mvaa 104,228,124
s_mov_b32 s68, s42
s_and_b32 s69, s43, 0xffff
s_mov_b32 s70, 7340032
Mvaa 108,232,120
s_waitcnt lgkmcnt(0)
Mvaa 108,236,124
s_mov_b32 s71, 0x20000
s_cmp_eq_u32 s32, 0
s_cselect_b32 s37, 0, 2146435072
Mvaa 112,240,64
s_lshl_b32 s3, s33, 8
s_add_u32 s16, s4, s3
s_addc_u32 s17, s5, 0
s_and_b32 s17, s17, 0xffff
Mvaa 112,244,68
s_mov_b32 s18, 0
s_mov_b32 s19, 0x20000
s_sub_u32 s18, 8388608, s3
Mvaa 116,248,64
v_and_b32 v33, 15, v0
v_lshrrev_b32 v32, 1, v33
Mvaa 116,252,68
Ra 224,12,8192
Mvaa 120,240,72
v_and_b32 v33, 1, v0
v_lshlrev_b32 v32, 13, v32
Mvaa 120,244,76
v_lshl_add_u32 v45, v33, 7, v32
Mvaa 124,248,72
s_lshl_b32 s3, s32, 3
s_add_u32 s3, s3, s34
s_mul_i32 s47, s3, 65536
Mvaa 124,252,76
Ra 228,13,8192
Mvaa 128,240,80
s_bfe_u32 s6, s2, 131075
s_lshl_b32 s3, s32, 8
s_or_b32 s6, s6, s3
Mvaa 128,244,84
Mvaa 132,248,80
Mvaa 132,252,84
Ra 232,12,10240
Mvaa 136,240,88
Mvaa 136,244,92
Mvaa 140,248,88
Mvaa 140,252,92
Ra 236,13,10240
Mvaa 144,240,96
Mvaa 144,244,100
Mvaa 148,248,96
Mvaa 148,252,100
Mvaa 152,240,104
Mvaa 152,244,108
Mvaa 156,248,104
Mvaa 156,252,108
Mvaa 160,240,112
Mvaa 160,244,116
Mvaa 164,248,112
Mvaa 164,252,116
Mvaa 168,240,120
Mvaa 168,244,124
s_waitcnt vmcnt(16)
Mvaa 172,248,120
s_waitcnt lgkmcnt(0)
s_barrier
Mvaa 172,252,124
s_add_u32 m0, s57, 65536
Mvaa 176,224,64
buffer_load_dwordx4 v6, s[12:15], s52 offen offset:0 lds
Mvaa 176,228,68
Ta 0,16,0
Ta 2,16,2048
Mvaa 180,232,64
Mvaa 180,236,68
Ra 240,12,12288
Mvaa 184,224,72
buffer_load_dwordx4 v7, s[12:15], s53 offen offset:1024 lds
Mvaa 184,228,76
Ta 4,16,16384
Ta 6,16,18432
Mvaa 188,232,72
Mvaa 188,236,76
Ra 244,13,12288
Mvaa 192,224,80
buffer_load_dwordx4 v6, s[12:15], s54 offen offset:2048 lds
Mvaa 192,228,84
Ta 8,17,0
Ta 10,17,2048
Mvaa 196,232,80
Mvaa 196,236,84
Ra 248,12,14336
Mvaa 200,224,88
buffer_load_dwordx4 v7, s[12:15], s55 offen offset:3072 lds
Mvaa 200,228,92
Ta 12,17,16384
Ta 14,17,18432
Mvaa 204,232,88
Mvaa 204,236,92
s_add_u32 m0, s57, 69632
Ra 252,13,14336
Mvaa 208,224,96
buffer_load_dwordx4 v8, s[12:15], s52 offen offset:0 lds
Mvaa 208,228,100
Mvaa 212,232,96
Mvaa 212,236,100
Ta 16,18,0
Ta 18,18,2048
Mvaa 216,224,104
buffer_load_dwordx4 v9, s[12:15], s53 offen offset:1024 lds
Mvaa 216,228,108
Ta 20,18,16384
s_waitcnt lgkmcnt(9)
Ta 22,18,18432
Mvaa 220,232,104
Mvaa 220,236,108
Ta 24,19,0
Ta 26,19,2048
Mvaa 224,224,112
buffer_load_dwordx4 v8, s[12:15], s54 offen offset:2048 lds
Mvaa 224,228,116
Mvaa 228,232,112
Mvaa 228,236,116
Ta 28,19,16384
Ta 30,19,18432
Mvaa 232,224,120
buffer_load_dwordx4 v9, s[12:15], s55 offen offset:3072 lds
Mvaa 232,228,124
s_waitcnt vmcnt(16)
Ta 32,20,0
s_waitcnt lgkmcnt(9)
Ta 34,20,2048
Mvaa 236,232,120
s_barrier
v_xor_b32 v6, 3670016, v6
v_xor_b32 v7, 3670016, v7
Mvaa 236,236,124
s_add_u32 m0, s56, 65536
Ta 36,20,16384
Ta 38,20,18432
Mvaa 240,240,64
buffer_load_dwordx4 v2, s[8:11], s48 offen offset:0 lds
Mvaa 240,244,68
v_xor_b32 v8, 3670016, v8
v_xor_b32 v9, 3670016, v9
Mvaa 244,248,64
Mvaa 244,252,68
Ra 224,10,0
Mvaa 248,240,72
buffer_load_dwordx4 v3, s[8:11], s49 offen offset:1024 lds
Mvaa 248,244,76
Ta 40,21,0
Ta 42,21,2048
Mvaa 252,248,72
Mvaa 252,252,76
s_waitcnt lgkmcnt(9)
Ra 228,11,0
Maaa 128,240,80
buffer_load_dwordx4 v2, s[8:11], s50 offen offset:2048 lds
Maaa 128,244,84
Ta 44,21,16384
Ta 46,21,18432
Maaa 132,248,80
Maaa 132,252,84
Ra 232,10,2048
Maaa 136,240,88
buffer_load_dwordx4 v3, s[8:11], s51 offen offset:3072 lds
Maaa 136,244,92
Ta 48,22,0
Ta 50,22,2048
Maaa 140,248,88
Maaa 140,252,92
s_add_u32 m0, s56, 69632
s_waitcnt lgkmcnt(9)
Ra 236,11,2048
Maaa 144,240,96
buffer_load_dwordx4 v4, s[8:11], s48 offen offset:0 lds
Maaa 144,244,100
Maaa 148,248,96
Maaa 148,252,100
Ta 52,22,16384
Ta 54,22,18432
Maaa 152,240,104
buffer_load_dwordx4 v5, s[8:11], s49 offen offset:1024 lds
Maaa 152,244,108
Ta 56,23,0
Ta 58,23,2048
Maaa 156,248,104
Maaa 156,252,108
Ta 60,23,16384
s_waitcnt lgkmcnt(9)
Ta 62,23,18432
Maaa 160,240,112
buffer_load_dwordx4 v4, s[8:11], s50 offen offset:2048 lds
Maaa 160,244,116
Maaa 164,248,112
Maaa 164,252,116
Maaa 168,240,120
buffer_load_dwordx4 v5, s[8:11], s51 offen offset:3072 lds
Maaa 168,244,124
v_xor_b32 v2, 896, v2
v_xor_b32 v3, 896, v3
Maaa 172,248,120
s_waitcnt lgkmcnt(6)
buffer_load_dword v1, v47, s[60:63], 0 offen
v_xor_b32 v4, 896, v4
v_xor_b32 v5, 896, v5
Maaa 172,252,124
s_waitcnt lgkmcnt(0)
s_mul_i32 vcc_lo, s59, 1
v_xor_b32 v47, vcc_lo, v47
Mvaa 48,224,0
Mvaa 48,228,4
Mvaa 52,232,0
Mvaa 52,236,4
Ra 240,10,4096
Mvaa 56,224,8
Mvaa 56,228,12
Mvaa 60,232,8
Mvaa 60,236,12
Ra 244,11,4096
Mvaa 64,224,16
Mvaa 64,228,20
Mvaa 68,232,16
Mvaa 68,236,20
Ra 248,10,6144
Mvaa 72,224,24
Mvaa 72,228,28
Mvaa 76,232,24
Mvaa 76,236,28
Ra 252,11,6144
Mvaa 80,224,32
Mvaa 80,228,36
Mvaa 84,232,32
Mvaa 84,236,36
Mvaa 88,224,40
Mvaa 88,228,44
Mvaa 92,232,40
Mvaa 92,236,44
Mvaa 96,224,48
Mvaa 96,228,52
Mvaa 100,232,48
Mvaa 100,236,52
Mvaa 104,224,56
Mvaa 104,228,60
Mvaa 108,232,56
s_waitcnt lgkmcnt(0)
Mvaa 108,236,60
Mvaa 112,240,0
Mvaa 112,244,4
Mvaa 116,248,0
Mvaa 116,252,4
Ra 224,10,8192
Mvaa 120,240,8
Mvaa 120,244,12
Mvaa 124,248,8
Mvaa 124,252,12
Ra 228,11,8192
Mvaa 128,240,16
Mvaa 128,244,20
Mvaa 132,248,16
Mvaa 132,252,20
Ra 232,10,10240
Mvaa 136,240,24
Mvaa 136,244,28
Mvaa 140,248,24
Mvaa 140,252,28
Ra 236,11,10240
Mvaa 144,240,32
Mvaa 144,244,36
Mvaa 148,248,32
Mvaa 148,252,36
Mvaa 152,240,40
Mvaa 152,244,44
Mvaa 156,248,40
Mvaa 156,252,44
Mvaa 160,240,48
Mvaa 160,244,52
Mvaa 164,248,48
Mvaa 164,252,52
Mvaa 168,240,56
Mvaa 168,244,60
s_waitcnt vmcnt(9)
Mvaa 172,248,56
s_waitcnt lgkmcnt(0)
s_barrier
Mvaa 172,252,60
s_add_u32 m0, s57, 0
Mvaa 176,224,0
buffer_load_dwordx4 v6, s[12:15], s52 offen offset:0 lds
Mvaa 176,228,4
Ta 64,14,0
Ta 66,14,2048
Mvaa 180,232,0
Mvaa 180,236,4
Ra 240,10,12288
Mvaa 184,224,8
buffer_load_dwordx4 v7, s[12:15], s53 offen offset:1024 lds
Mvaa 184,228,12
Ta 68,14,16384
Ta 70,14,18432
Mvaa 188,232,8
Mvaa 188,236,12
Ra 244,11,12288
Mvaa 192,224,16
buffer_load_dwordx4 v6, s[12:15], s54 offen offset:2048 lds
Mvaa 192,228,20
Ta 72,15,0
Ta 74,15,2048
Mvaa 196,232,16
Mvaa 196,236,20
Ra 248,10,14336
Mvaa 200,224,24
buffer_load_dwordx4 v7, s[12:15], s55 offen offset:3072 lds
Mvaa 200,228,28
Ta 76,15,16384
Ta 78,15,18432
Mvaa 204,232,24
s_cmp_eq_u32 s6, 0
s_cselect_b32 s3, 0, 2146435072
Mvaa 204,236,28
s_add_u32 m0, s57, 4096
Ra 252,11,14336
Mvaa 208,224,32
buffer_load_dwordx4 v8, s[12:15], s52 offen offset:0 lds
Mvaa 208,228,36
s_mov_b64 exec, 1
buffer_atomic_add v30, v31, s[28:31], s3 offen sc1
s_mov_b64 exec, -1
Mvaa 212,232,32
Mvaa 212,236,36
Ta 80,24,0
Ta 82,24,2048
Mvaa 216,224,40
buffer_load_dwordx4 v9, s[12:15], s53 offen offset:1024 lds
Mvaa 216,228,44
Ta 84,24,16384
s_waitcnt lgkmcnt(9)
Ta 86,24,18432
Mvaa 220,232,40
Mvaa 220,236,44
Ta 88,25,0
Ta 90,25,2048
Mvaa 224,224,48
buffer_load_dwordx4 v8, s[12:15], s54 offen offset:2048 lds
Mvaa 224,228,52
Mvaa 228,232,48
Mvaa 228,236,52
Ta 92,25,16384
Ta 94,25,18432
Mvaa 232,224,56
buffer_load_dwordx4 v9, s[12:15], s55 offen offset:3072 lds
Mvaa 232,228,60
s_waitcnt vmcnt(10)
Ta 96,26,0
s_waitcnt lgkmcnt(9)
Ta 98,26,2048
Mvaa 236,232,56
s_barrier
v_xor_b32 v6, 524288, v6
v_xor_b32 v7, 524288, v7
Mvaa 236,236,60
s_add_u32 m0, s56, 0
Ta 100,26,16384
Ta 102,26,18432
Mvaa 240,240,0
buffer_load_dwordx4 v2, s[8:11], s48 offen offset:0 lds
Mvaa 240,244,4
v_xor_b32 v8, 524288, v8
v_xor_b32 v9, 524288, v9
Mvaa 244,248,0
Mvaa 244,252,4
Ra 224,12,0
Mvaa 248,240,8
buffer_load_dwordx4 v3, s[8:11], s49 offen offset:1024 lds
Mvaa 248,244,12
Ta 104,27,0
Ta 106,27,2048
Mvaa 252,248,8
Mvaa 252,252,12
s_waitcnt lgkmcnt(9)
Ra 228,13,0
Maaa 128,240,16
buffer_load_dwordx4 v2, s[8:11], s50 offen offset:2048 lds
Maaa 128,244,20
Ta 108,27,16384
Ta 110,27,18432
Maaa 132,248,16
Maaa 132,252,20
Ra 232,12,2048
Maaa 136,240,24
buffer_load_dwordx4 v3, s[8:11], s51 offen offset:3072 lds
Maaa 136,244,28
Ta 112,28,0
Ta 114,28,2048
Maaa 140,248,24
Maaa 140,252,28
s_add_u32 m0, s56, 4096
s_waitcnt lgkmcnt(9)
Ra 236,13,2048
Maaa 144,240,32
buffer_load_dwordx4 v4, s[8:11], s48 offen offset:0 lds
Maaa 144,244,36
Maaa 148,248,32
Maaa 148,252,36
Ta 116,28,16384
Ta 118,28,18432
Maaa 152,240,40
buffer_load_dwordx4 v5, s[8:11], s49 offen offset:1024 lds
Maaa 152,244,44
Ta 120,29,0
Ta 122,29,2048
Maaa 156,248,40
Maaa 156,252,44
Ta 124,29,16384
s_waitcnt lgkmcnt(9)
Ta 126,29,18432
Maaa 160,240,48
buffer_load_dwordx4 v4, s[8:11], s50 offen offset:2048 lds
Maaa 160,244,52
Maaa 164,248,48
Maaa 164,252,52
Maaa 168,240,56
buffer_load_dwordx4 v5, s[8:11], s51 offen offset:3072 lds
Maaa 168,244,60
v_xor_b32 v2, 128, v2
v_xor_b32 v3, 128, v3
Maaa 172,248,56
s_waitcnt lgkmcnt(6)
buffer_load_dword v1, v47, s[60:63], 0 offen
v_xor_b32 v4, 128, v4
v_xor_b32 v5, 128, v5
Maaa 172,252,60
s_waitcnt lgkmcnt(0)
s_mul_i32 vcc_lo, s59, 3
v_xor_b32 v47, vcc_lo, v47
Mvaa 48,224,64
buffer_load_dword v44, v45, s[16:19], s47 offen
Mvaa 48,228,68
s_add_u32 s47, s47, 2097152
Mvaa 52,232,64
Mvaa 52,236,68
Ra 240,12,4096
Mvaa 56,224,72
Mvaa 56,228,76
Mvaa 60,232,72
Mvaa 60,236,76
Ra 244,13,4096
Mvaa 64,224,80
Mvaa 64,228,84
Mvaa 68,232,80
Mvaa 68,236,84
Ra 248,12,6144
Mvaa 72,224,88
Mvaa 72,228,92
Mvaa 76,232,88
Mvaa 76,236,92
Ra 252,13,6144
Mvaa 80,224,96
Mvaa 80,228,100
Mvaa 84,232,96
Mvaa 84,236,100
Mvaa 88,224,104
Mvaa 88,228,108
Mvaa 92,232,104
Mvaa 92,236,108
Mvaa 96,224,112
Mvaa 96,228,116
Mvaa 100,232,112
s_cmp_eq_u32 s6, 1
s_cselect_b32 s3, 0, 2146435072
Mvaa 100,236,116
s_mov_b64 exec, 1
buffer_atomic_add v30, v31, s[28:31], s3 offen sc1
s_mov_b64 exec, -1
Mvaa 104,224,120
Mvaa 104,228,124
Mvaa 108,232,120
s_waitcnt lgkmcnt(0)
Mvaa 108,236,124
Mvaa 112,240,64
Mvaa 112,244,68
Mvaa 116,248,64
Mvaa 116,252,68
Ra 224,12,8192
Mvaa 120,240,72
Mvaa 120,244,76
Mvaa 124,248,72
Mvaa 124,252,76
Ra 228,13,8192
Mvaa 128,240,80
Mvaa 128,244,84
Mvaa 132,248,80
Mvaa 132,252,84
Ra 232,12,10240
Mvaa 136,240,88
Mvaa 136,244,92
Mvaa 140,248,88
Mvaa 140,252,92
Ra 236,13,10240
Mvaa 144,240,96
Mvaa 144,244,100
Mvaa 148,248,96
Mvaa 148,252,100
Mvaa 152,240,104
Mvaa 152,244,108
Mvaa 156,248,104
Mvaa 156,252,108
Mvaa 160,240,112
Mvaa 160,244,116
Mvaa 164,248,112
Mvaa 164,252,116
Mvaa 168,240,120
Mvaa 168,244,124
s_waitcnt vmcnt(11)
Mvaa 172,248,120
s_waitcnt lgkmcnt(0)
s_barrier
Mvaa 172,252,124
s_add_u32 m0, s57, 65536
Mvaa 176,224,64
buffer_load_dwordx4 v6, s[12:15], s52 offen offset:0 lds
Mvaa 176,228,68
Ta 0,16,0
Ta 2,16,2048
Mvaa 180,232,64
Mvaa 180,236,68
Ra 240,12,12288
Mvaa 184,224,72
buffer_load_dwordx4 v7, s[12:15], s53 offen offset:1024 lds
Mvaa 184,228,76
Ta 4,16,16384
Ta 6,16,18432
Mvaa 188,232,72
Mvaa 188,236,76
Ra 244,13,12288
Mvaa 192,224,80
buffer_load_dwordx4 v6, s[12:15], s54 offen offset:2048 lds
Mvaa 192,228,84
Ta 8,17,0
Ta 10,17,2048
Mvaa 196,232,80
Mvaa 196,236,84
Ra 248,12,14336
Mvaa 200,224,88
buffer_load_dwordx4 v7, s[12:15], s55 offen offset:3072 lds
Mvaa 200,228,92
Ta 12,17,16384
Ta 14,17,18432
Mvaa 204,232,88
Mvaa 204,236,92
s_add_u32 m0, s57, 69632
Ra 252,13,14336
Mvaa 208,224,96
buffer_load_dwordx4 v8, s[12:15], s52 offen offset:0 lds
Mvaa 208,228,100
Mvaa 212,232,96
Mvaa 212,236,100
Ta 16,18,0
Ta 18,18,2048
Mvaa 216,224,104
buffer_load_dwordx4 v9, s[12:15], s53 offen offset:1024 lds
Mvaa 216,228,108
Ta 20,18,16384
s_waitcnt lgkmcnt(9)
Ta 22,18,18432
Mvaa 220,232,104
Mvaa 220,236,108
Ta 24,19,0
Ta 26,19,2048
Mvaa 224,224,112
buffer_load_dwordx4 v8, s[12:15], s54 offen offset:2048 lds
Mvaa 224,228,116
Mvaa 228,232,112
Mvaa 228,236,116
Ta 28,19,16384
Ta 30,19,18432
Mvaa 232,224,120
buffer_load_dwordx4 v9, s[12:15], s55 offen offset:3072 lds
Mvaa 232,228,124
s_waitcnt vmcnt(11)
Ta 32,20,0
s_waitcnt lgkmcnt(9)
Ta 34,20,2048
Mvaa 236,232,120
s_barrier
v_xor_b32 v6, 1572864, v6
v_xor_b32 v7, 1572864, v7
Mvaa 236,236,124
s_add_u32 m0, s56, 65536
Ta 36,20,16384
Ta 38,20,18432
Mvaa 240,240,64
buffer_load_dwordx4 v2, s[8:11], s48 offen offset:0 lds
Mvaa 240,244,68
v_xor_b32 v8, 1572864, v8
v_xor_b32 v9, 1572864, v9
Mvaa 244,248,64
Mvaa 244,252,68
Ra 224,10,0
Mvaa 248,240,72
buffer_load_dwordx4 v3, s[8:11], s49 offen offset:1024 lds
Mvaa 248,244,76
Ta 40,21,0
Ta 42,21,2048
Mvaa 252,248,72
Mvaa 252,252,76
s_waitcnt lgkmcnt(9)
Ra 228,11,0
Maaa 128,240,80
buffer_load_dwordx4 v2, s[8:11], s50 offen offset:2048 lds
Maaa 128,244,84
Ta 44,21,16384
Ta 46,21,18432
Maaa 132,248,80
s_cmp_eq_u32 s6, 2
s_cselect_b32 s3, 0, 2146435072
Maaa 132,252,84
Ra 232,10,2048
Maaa 136,240,88
buffer_load_dwordx4 v3, s[8:11], s51 offen offset:3072 lds
Maaa 136,244,92
Ta 48,22,0
Ta 50,22,2048
Maaa 140,248,88
s_mov_b64 exec, 1
buffer_atomic_add v30, v31, s[28:31], s3 offen sc1
s_mov_b64 exec, -1
Maaa 140,252,92
s_add_u32 m0, s56, 69632
s_waitcnt lgkmcnt(9)
Ra 236,11,2048
Maaa 144,240,96
buffer_load_dwordx4 v4, s[8:11], s48 offen offset:0 lds
Maaa 144,244,100
Maaa 148,248,96
Maaa 148,252,100
Ta 52,22,16384
Ta 54,22,18432
Maaa 152,240,104
buffer_load_dwordx4 v5, s[8:11], s49 offen offset:1024 lds
Maaa 152,244,108
Ta 56,23,0
Ta 58,23,2048
Maaa 156,248,104
Maaa 156,252,108
Ta 60,23,16384
s_waitcnt lgkmcnt(9)
Ta 62,23,18432
Maaa 160,240,112
buffer_load_dwordx4 v4, s[8:11], s50 offen offset:2048 lds
Maaa 160,244,116
Maaa 164,248,112
Maaa 164,252,116
Maaa 168,240,120
buffer_load_dwordx4 v5, s[8:11], s51 offen offset:3072 lds
Maaa 168,244,124
v_xor_b32 v2, 384, v2
v_xor_b32 v3, 384, v3
Maaa 172,248,120
s_waitcnt lgkmcnt(6)
buffer_load_dword v1, v47, s[60:63], 0 offen
v_xor_b32 v4, 384, v4
v_xor_b32 v5, 384, v5
Maaa 172,252,124
s_waitcnt lgkmcnt(0)
s_mul_i32 vcc_lo, s59, 1
v_xor_b32_e64 v47, vcc_lo, v47
Mvaa 48,224,0
buffer_load_dword v44, v45, s[16:19], s47 offen
Mvaa 48,228,4
s_add_u32 s47, s47, 2097152
Mvaa 52,232,0
Mvaa 52,236,4
Ra 240,10,4096
Mvaa 56,224,8
Mvaa 56,228,12
Mvaa 60,232,8
Mvaa 60,236,12
Ra 244,11,4096
Mvaa 64,224,16
Mvaa 64,228,20
Mvaa 68,232,16
Mvaa 68,236,20
Ra 248,10,6144
Mvaa 72,224,24
Mvaa 72,228,28
Mvaa 76,232,24
Mvaa 76,236,28
Ra 252,11,6144
Mvaa 80,224,32
Mvaa 80,228,36
Mvaa 84,232,32
Mvaa 84,236,36
Mvaa 88,224,40
Mvaa 88,228,44
Mvaa 92,232,40
Mvaa 92,236,44
Mvaa 96,224,48
Mvaa 96,228,52
Mvaa 100,232,48
Mvaa 100,236,52
Mvaa 104,224,56
Mvaa 104,228,60
Mvaa 108,232,56
s_waitcnt lgkmcnt(0)
Mvaa 108,236,60
Mvaa 112,240,0
Mvaa 112,244,4
Mvaa 116,248,0
Mvaa 116,252,4
Ra 224,10,8192
Mvaa 120,240,8
Mvaa 120,244,12
Mvaa 124,248,8
Mvaa 124,252,12
Ra 228,11,8192
Mvaa 128,240,16
Mvaa 128,244,20
Mvaa 132,248,16
Mvaa 132,252,20
Ra 232,10,10240
Mvaa 136,240,24
Mvaa 136,244,28
Mvaa 140,248,24
Mvaa 140,252,28
Ra 236,11,10240
Mvaa 144,240,32
Mvaa 144,244,36
Mvaa 148,248,32
Mvaa 148,252,36
Mvaa 152,240,40
s_cmp_eq_u32 s6, 3
s_cselect_b32 s3, 0, 2146435072
Mvaa 152,244,44
s_mov_b64 exec, 1
buffer_atomic_add v30, v31, s[28:31], s3 offen sc1
s_mov_b64 exec, -1
Mvaa 156,248,40
Mvaa 156,252,44
Mvaa 160,240,48
Mvaa 160,244,52
Mvaa 164,248,48
Mvaa 164,252,52
Mvaa 168,240,56
Mvaa 168,244,60
s_waitcnt vmcnt(12)
Mvaa 172,248,56
s_waitcnt lgkmcnt(0)
s_barrier
Mvaa 172,252,60
s_add_u32 m0, s57, 0
Mvaa 176,224,0
buffer_load_dwordx4 v6, s[12:15], s52 offen offset:0 lds
Mvaa 176,228,4
Ta 64,14,0
Ta 66,14,2048
Mvaa 180,232,0
Mvaa 180,236,4
Ra 240,10,12288
Mvaa 184,224,8
buffer_load_dwordx4 v7, s[12:15], s53 offen offset:1024 lds
Mvaa 184,228,12
Ta 68,14,16384
Ta 70,14,18432
Mvaa 188,232,8
Mvaa 188,236,12
Ra 244,11,12288
Mvaa 192,224,16
buffer_load_dwordx4 v6, s[12:15], s54 offen offset:2048 lds
Mvaa 192,228,20
Ta 72,15,0
Ta 74,15,2048
Mvaa 196,232,16
Mvaa 196,236,20
Ra 248,10,14336
Mvaa 200,224,24
buffer_load_dwordx4 v7, s[12:15], s55 offen offset:3072 lds
Mvaa 200,228,28
Ta 76,15,16384
Ta 78,15,18432
Mvaa 204,232,24
Mvaa 204,236,28
s_add_u32 m0, s57, 4096
Ra 252,11,14336
Mvaa 208,224,32
buffer_load_dwordx4 v8, s[12:15], s52 offen offset:0 lds
Mvaa 208,228,36
Mvaa 212,232,32
Mvaa 212,236,36
Ta 80,24,0
Ta 82,24,2048
Mvaa 216,224,40
buffer_load_dwordx4 v9, s[12:15], s53 offen offset:1024 lds
Mvaa 216,228,44
Ta 84,24,16384
s_waitcnt lgkmcnt(9)
Ta 86,24,18432
Mvaa 220,232,40
Mvaa 220,236,44
Ta 88,25,0
Ta 90,25,2048
Mvaa 224,224,48
buffer_load_dwordx4 v8, s[12:15], s54 offen offset:2048 lds
Mvaa 224,228,52
Mvaa 228,232,48
Mvaa 228,236,52
Ta 92,25,16384
Ta 94,25,18432
Mvaa 232,224,56
buffer_load_dwordx4 v9, s[12:15], s55 offen offset:3072 lds
Mvaa 232,228,60
s_waitcnt vmcnt(11)
Ta 96,26,0
s_waitcnt lgkmcnt(9)
Ta 98,26,2048
Mvaa 236,232,56
s_barrier
v_xor_b32 v6, 524288, v6
v_xor_b32 v7, 524288, v7
Mvaa 236,236,60
s_add_u32 m0, s56, 0
Ta 100,26,16384
Ta 102,26,18432
Mvaa 240,240,0
buffer_load_dwordx4 v2, s[8:11], s48 offen offset:0 lds
Mvaa 240,244,4
v_xor_b32 v8, 524288, v8
v_xor_b32 v9, 524288, v9
Mvaa 244,248,0
Mvaa 244,252,4
Ra 224,12,0
Mvaa 248,240,8
buffer_load_dwordx4 v3, s[8:11], s49 offen offset:1024 lds
Mvaa 248,244,12
Ta 104,27,0
Ta 106,27,2048
Mvaa 252,248,8
Mvaa 252,252,12
s_waitcnt lgkmcnt(9)
Ra 228,13,0
Maaa 128,240,16
buffer_load_dwordx4 v2, s[8:11], s50 offen offset:2048 lds
Maaa 128,244,20
Ta 108,27,16384
Ta 110,27,18432
Maaa 132,248,16
Maaa 132,252,20
Ra 232,12,2048
Maaa 136,240,24
buffer_load_dwordx4 v3, s[8:11], s51 offen offset:3072 lds
Maaa 136,244,28
Ta 112,28,0
Ta 114,28,2048
Maaa 140,248,24
Maaa 140,252,28
s_add_u32 m0, s56, 4096
s_waitcnt lgkmcnt(9)
Ra 236,13,2048
Maaa 144,240,32
buffer_load_dwordx4 v4, s[8:11], s48 offen offset:0 lds
Maaa 144,244,36
Maaa 148,248,32
Maaa 148,252,36
Ta 116,28,16384
Ta 118,28,18432
Maaa 152,240,40
buffer_load_dwordx4 v5, s[8:11], s49 offen offset:1024 lds
Maaa 152,244,44
Ta 120,29,0
Ta 122,29,2048
Maaa 156,248,40
Maaa 156,252,44
Ta 124,29,16384
s_waitcnt lgkmcnt(9)
Ta 126,29,18432
Maaa 160,240,48
buffer_load_dwordx4 v4, s[8:11], s50 offen offset:2048 lds
Maaa 160,244,52
Maaa 164,248,48
Maaa 164,252,52
Maaa 168,240,56
buffer_load_dwordx4 v5, s[8:11], s51 offen offset:3072 lds
Maaa 168,244,60
v_xor_b32 v2, 128, v2
v_xor_b32 v3, 128, v3
Maaa 172,248,56
s_waitcnt lgkmcnt(6)
buffer_load_dword v1, v47, s[60:63], 0 offen
v_xor_b32 v4, 128, v4
v_xor_b32 v5, 128, v5
Maaa 172,252,60
s_waitcnt lgkmcnt(0)
s_mul_i32 vcc_lo, s59, 7
v_xor_b32 v47, vcc_lo, v47
Mvaa 48,224,64
buffer_load_dword v44, v45, s[16:19], s47 offen
Mvaa 48,228,68
s_add_u32 s47, s47, 2097152
v_lshrrev_b32 v32, 4, v0
v_and_b32 v33, 15, v0
Mvaa 52,232,64
s_lshl_b32 s3, s32, 4
v_add_u32 v34, s3, v32
v_lshlrev_b32_e64 v36, 1, v32
Mvaa 52,236,68
Ra 240,12,4096
Mvaa 56,224,72
v_xor_b32 v36, v36, v33
v_xor_b32 v37, 8, v36
Mvaa 56,228,76
Mvaa 60,232,72
Mvaa 60,236,76
Ra 244,13,4096
Mvaa 64,224,80
s_getpc_b64 s[6:7]
L_cpf3:
s_add_u32 s6, s6, (L_phase2-L_cpf3)&0xffffffff
s_addc_u32 s7, s7, ((L_phase2-L_cpf3)>>32)&0xffffffff
Mvaa 64,228,84
s_lshr_b32 s3, s2, 3
s_lshl_b32 s3, s3, 2
s_add_u32 s3, s3, s32
Mvaa 68,232,80
s_lshl_b32 s3, s3, 10
v_and_b32 v42, 7, v0
v_lshlrev_b32_e64 v42, 7, v42
Mvaa 68,236,84
Ra 248,12,6144
Mvaa 72,224,88
v_add_u32_e64 v42, s3, v42
v_min_u32 v42, L_k2_fin-L_phase2-4, v42
Mvaa 72,228,92
v_mov_b32_e64 v41, s7
Mvaa 76,232,88
v_add_co_u32 v40, vcc, s6, v42
s_nop 1
v_addc_co_u32 v41, vcc, 0, v41, vcc
Mvaa 76,236,92
Ra 252,13,6144
Mvaa 80,224,96
global_load_dword v38, v[40:41], off
Mvaa 80,228,100
Mvaa 84,232,96
Mvaa 84,236,100
Mvaa 88,224,104
Mvaa 88,228,108
Mvaa 92,232,104
Mvaa 92,236,108
Mvaa 96,224,112
Mvaa 96,228,116
Mvaa 100,232,112
Mvaa 100,236,116
Mvaa 104,224,120
Mvaa 104,228,124
Mvaa 108,232,120
s_waitcnt lgkmcnt(0)
Mvaa 108,236,124
Mvaa 112,240,64
Mvaa 112,244,68
Mvaa 116,248,64
Mvaa 116,252,68
Ra 224,12,8192
Mvaa 120,240,72
Mvaa 120,244,76
Mvaa 124,248,72
Mvaa 124,252,76
Ra 228,13,8192
Mvaa 128,240,80
Mvaa 128,244,84
Mvaa 132,248,80
Mvaa 132,252,84
Ra 232,12,10240
Mvaa 136,240,88
Mvaa 136,244,92
Mvaa 140,248,88
Mvaa 140,252,92
Ra 236,13,10240
Mvaa 144,240,96
Mvaa 144,244,100
Mvaa 148,248,96
Mvaa 148,252,100
Mvaa 152,240,104
Mvaa 152,244,108
Mvaa 156,248,104
Mvaa 156,252,108
Mvaa 160,240,112
Mvaa 160,244,116
Mvaa 164,248,112
Mvaa 164,252,116
Mvaa 168,240,120
Mvaa 168,244,124
s_waitcnt vmcnt(11)
Mvaa 172,248,120
s_waitcnt lgkmcnt(0)
s_barrier
Mvaa 172,252,124
s_add_u32 m0, s57, 65536
Mvaa 176,224,64
buffer_load_dwordx4 v6, s[12:15], s52 offen offset:0 lds
Mvaa 176,228,68
Ta 0,16,0
Ta 2,16,2048
Mvaa 180,232,64
Mvaa 180,236,68
Ra 240,12,12288
Mvaa 184,224,72
buffer_load_dwordx4 v7, s[12:15], s53 offen offset:1024 lds
Mvaa 184,228,76
Ta 4,16,16384
Ta 6,16,18432
Mvaa 188,232,72
Mvaa 188,236,76
Ra 244,13,12288
Mvaa 192,224,80
buffer_load_dwordx4 v6, s[12:15], s54 offen offset:2048 lds
Mvaa 192,228,84
Ta 8,17,0
Ta 10,17,2048
Mvaa 196,232,80
Mvaa 196,236,84
Ra 248,12,14336
Mvaa 200,224,88
buffer_load_dwordx4 v7, s[12:15], s55 offen offset:3072 lds
Mvaa 200,228,92
Ta 12,17,16384
Ta 14,17,18432
Mvaa 204,232,88
Mvaa 204,236,92
s_add_u32 m0, s57, 69632
Ra 252,13,14336
Mvaa 208,224,96
buffer_load_dwordx4 v8, s[12:15], s52 offen offset:0 lds
Mvaa 208,228,100
Mvaa 212,232,96
Mvaa 212,236,100
Ta 16,18,0
Ta 18,18,2048
Mvaa 216,224,104
buffer_load_dwordx4 v9, s[12:15], s53 offen offset:1024 lds
Mvaa 216,228,108
Ta 20,18,16384
s_waitcnt lgkmcnt(9)
Ta 22,18,18432
Mvaa 220,232,104
Mvaa 220,236,108
Ta 24,19,0
Ta 26,19,2048
Mvaa 224,224,112
buffer_load_dwordx4 v8, s[12:15], s54 offen offset:2048 lds
Mvaa 224,228,116
Mvaa 228,232,112
Mvaa 228,236,116
Ta 28,19,16384
Ta 30,19,18432
Mvaa 232,224,120
buffer_load_dwordx4 v9, s[12:15], s55 offen offset:3072 lds
Mvaa 232,228,124
s_waitcnt vmcnt(11)
Ta 32,20,0
s_waitcnt lgkmcnt(9)
Ta 34,20,2048
Mvaa 236,232,120
s_barrier
Mvaa 236,236,124
s_add_u32 m0, s56, 65536
Ta 36,20,16384
Ta 38,20,18432
Mvaa 240,240,64
buffer_load_dwordx4 v2, s[8:11], s48 offen offset:0 lds
Mvaa 240,244,68
Mvaa 244,248,64
Mvaa 244,252,68
Ra 224,10,0
Mvaa 248,240,72
buffer_load_dwordx4 v3, s[8:11], s49 offen offset:1024 lds
Mvaa 248,244,76
Ta 40,21,0
Ta 42,21,2048
Mvaa 252,248,72
Mvaa 252,252,76
s_waitcnt lgkmcnt(9)
Ra 228,11,0
Maaa 128,240,80
buffer_load_dwordx4 v2, s[8:11], s50 offen offset:2048 lds
Maaa 128,244,84
Ta 44,21,16384
Ta 46,21,18432
Maaa 132,248,80
Maaa 132,252,84
Ra 232,10,2048
Maaa 136,240,88
buffer_load_dwordx4 v3, s[8:11], s51 offen offset:3072 lds
Maaa 136,244,92
Ta 48,22,0
Ta 50,22,2048
Maaa 140,248,88
Maaa 140,252,92
s_add_u32 m0, s56, 69632
s_waitcnt lgkmcnt(9)
Ra 236,11,2048
Maaa 144,240,96
buffer_load_dwordx4 v4, s[8:11], s48 offen offset:0 lds
Maaa 144,244,100
Maaa 148,248,96
Maaa 148,252,100
Ta 52,22,16384
Ta 54,22,18432
Maaa 152,240,104
buffer_load_dwordx4 v5, s[8:11], s49 offen offset:1024 lds
Maaa 152,244,108
Ta 56,23,0
Ta 58,23,2048
Maaa 156,248,104
Maaa 156,252,108
Ta 60,23,16384
s_waitcnt lgkmcnt(9)
Ta 62,23,18432
Maaa 160,240,112
buffer_load_dwordx4 v4, s[8:11], s50 offen offset:2048 lds
Maaa 160,244,116
Maaa 164,248,112
Maaa 164,252,116
Maaa 168,240,120
buffer_load_dwordx4 v5, s[8:11], s51 offen offset:3072 lds
Maaa 168,244,124
Maaa 172,248,120
s_waitcnt lgkmcnt(6)
Maaa 172,252,124
s_waitcnt lgkmcnt(0)
Mvaa 48,224,0
buffer_load_dword v1, v31, s[28:31], s37 offen sc1
Mvaa 48,228,4
s_mov_b32 s8, s16
s_mov_b32 s9, s17
s_mov_b32 s10, s18
Mvaa 52,232,0
s_add_u32 s16, s66, 46137344
s_addc_u32 s17, s67, 0
s_and_b32 s17, s17, 0xffff
Mvaa 52,236,4
Ra 240,10,4096
Mvaa 56,224,8
s_mov_b32 s18, 16777216
s_mov_b32 s19, 0x20000
s_mov_b32 s48, 0
Mvaa 56,228,12
s_mov_b32 s49, 31744
s_mov_b32 s50, 63488
s_mov_b32 s51, 95232
Mvaa 60,232,8
v_lshlrev_b32 v35, 13, v34
Mvaa 60,236,12
Ra 244,11,4096
Mvaa 64,224,16
s_and_b32 s52, s33, 0
s_lshl_b32 s3, s52, 19
s_lshl_b32 s52, s52, 11
Mvaa 64,228,20
s_add_u32 s53, s52, s58
v_add_u32_e64 v35, s3, v35
v_lshl_add_u32 v8, v36, 4, v35
Mvaa 68,232,16
v_lshl_add_u32 v9, v37, 4, v35
v_lshlrev_b32_e64 v2, 4, v0
Mvaa 68,236,20
Ra 248,10,6144
Mvaa 72,224,24
v_add_u32 v3, 65536, v2
v_add_u32_e64 v4, s44, v2
Mvaa 72,228,28
v_mov_b32 v7, 0
v_lshlrev_b32 v35, 2, v32
Mvaa 76,232,24
v_sub_u32_e64 v35, v33, v35
Mvaa 76,236,28
Ra 252,11,6144
Mvaa 80,224,32
s_lshl_b32 s3, s32, 4
v_add_u32 v5, s3, v35
Mvaa 80,228,36
s_sub_u32 s3, 48, s3
v_add_u32 v6, s3, v35
Mvaa 84,232,32
s_mul_i32 s3, s33, 1116160
s_add_u32 s3, s3, 8388608
s_add_u32 s12, s66, s3
s_addc_u32 s13, s67, 0
s_and_b32 s13, s13, 0xffff
Mvaa 84,236,36
s_mov_b32 s14, 0
s_mov_b32 s15, 0x20000
s_mul_i32 s14, s36, 34816
Mvaa 88,224,40
buffer_load_dword v44, v45, s[8:11], s47 offen
Mvaa 88,228,44
s_add_u32 s47, s47, 2097152
v_lshrrev_b32 v42, 2, v33
v_lshl_add_u32 v43, v32, 3, v42
Mvaa 92,232,40
v_lshlrev_b32 v43, 8, v43
v_and_b32 v46, 3, v0
Mvaa 92,236,44
v_lshl_add_u32 v43, v46, 3, v43
v_and_b32_e64 v46, 1, v32
Mvaa 96,224,48
v_lshl_add_u32 v42, v46, 2, v42
v_lshl_add_u32 v16, v42, 5, v43
Mvaa 96,228,52
v_xor_b32 v17, 32, v16
v_xor_b32 v18, 64, v16
Mvaa 100,232,48
v_xor_b32 v19, 96, v16
v_xor_b32 v20, 128, v16
Mvaa 100,236,52
v_xor_b32 v21, 160, v16
v_xor_b32 v22, 192, v16
Mvaa 104,224,56
v_xor_b32 v23, 224, v16
Mvaa 104,228,60
Mvaa 108,232,56
s_waitcnt lgkmcnt(0)
Mvaa 108,236,60
Mvaa 112,240,0
Mvaa 112,244,4
Mvaa 116,248,0
Mvaa 116,252,4
Ra 224,10,8192
Mvaa 120,240,8
Mvaa 120,244,12
Mvaa 124,248,8
Mvaa 124,252,12
Ra 228,11,8192
Mvaa 128,240,16
Mvaa 128,244,20
Mvaa 132,248,16
Mvaa 132,252,20
Ra 232,10,10240
Mvaa 136,240,24
Mvaa 136,244,28
Mvaa 140,248,24
Mvaa 140,252,28
Ra 236,11,10240
Mvaa 144,240,32
Mvaa 144,244,36
Mvaa 148,248,32
Mvaa 148,252,36
Mvaa 152,240,40
Mvaa 152,244,44
Mvaa 156,248,40
Mvaa 156,252,44
Mvaa 160,240,48
Mvaa 160,244,52
Mvaa 164,248,48
Mvaa 164,252,52
Mvaa 168,240,56
Mvaa 168,244,60
s_waitcnt vmcnt(10)
Mvaa 172,248,56
s_waitcnt lgkmcnt(0)
s_barrier
Mvaa 172,252,60
s_add_u32 m0, s44, 0
Mvaa 176,224,0
buffer_load_dwordx4 v8, s[8:11], s48 offen offset:0 lds
Mvaa 176,228,4
Ta 64,14,0
Ta 66,14,2048
Mvaa 180,232,0
Mvaa 180,236,4
Ra 240,10,12288
Mvaa 184,224,8
buffer_load_dwordx4 v8, s[8:11], s49 offen offset:1024 lds
Mvaa 184,228,12
Ta 68,14,16384
Ta 70,14,18432
Mvaa 188,232,8
Mvaa 188,236,12
Ra 244,11,12288
Mvaa 192,224,16
buffer_load_dwordx4 v9, s[8:11], s50 offen offset:2048 lds
Mvaa 192,228,20
Ta 72,15,0
Ta 74,15,2048
Mvaa 196,232,16
Mvaa 196,236,20
Ra 248,10,14336
Mvaa 200,224,24
buffer_load_dwordx4 v9, s[8:11], s51 offen offset:3072 lds
Mvaa 200,228,28
Ta 76,15,16384
Ta 78,15,18432
Mvaa 204,232,24
v_xor_b32 v8, 524288, v8
v_xor_b32 v9, 524288, v9
Mvaa 204,236,28
s_add_u32 m0, s44, 16384
Ra 252,11,14336
Mvaa 208,224,32
buffer_load_dwordx4 v8, s[8:11], s48 offen offset:0 lds
Mvaa 208,228,36
Mvaa 212,232,32
Mvaa 212,236,36
Ta 80,24,0
Ta 82,24,2048
Mvaa 216,224,40
buffer_load_dwordx4 v8, s[8:11], s49 offen offset:1024 lds
Mvaa 216,228,44
Ta 84,24,16384
s_waitcnt lgkmcnt(9)
Ta 86,24,18432
Mvaa 220,232,40
Mvaa 220,236,44
Ta 88,25,0
Ta 90,25,2048
Mvaa 224,224,48
buffer_load_dwordx4 v9, s[8:11], s50 offen offset:2048 lds
Mvaa 224,228,52
Mvaa 228,232,48
s_mul_i32 s3, s45, 33792
v_add_u32_e64 v10, s3, v2
Mvaa 228,236,52
Ta 92,25,16384
Ta 94,25,18432
Mvaa 232,224,56
buffer_load_dwordx4 v9, s[8:11], s51 offen offset:3072 lds
Mvaa 232,228,60
s_waitcnt vmcnt(10)
Ta 96,26,0
s_waitcnt lgkmcnt(9)
Ta 98,26,2048
Mvaa 236,232,56
s_barrier
v_xor_b32 v8, 1572864, v8
v_xor_b32 v9, 1572864, v9
Mvaa 236,236,60
s_add_u32 m0, s44, 32768
Ta 100,26,16384
Ta 102,26,18432
Mvaa 240,240,0
buffer_load_dwordx4 v8, s[8:11], s48 offen offset:0 lds
Mvaa 240,244,4
s_mul_i32 s3, s46, 33792
v_add_u32 v11, s3, v2
Mvaa 244,248,0
Mvaa 244,252,4
Ra 224,12,0
Mvaa 248,240,8
buffer_load_dwordx4 v8, s[8:11], s49 offen offset:1024 lds
Mvaa 248,244,12
Ta 104,27,0
Ta 106,27,2048
Mvaa 252,248,8
Mvaa 252,252,12
s_waitcnt lgkmcnt(9)
Ra 228,13,0
Maaa 128,240,16
buffer_load_dwordx4 v9, s[8:11], s50 offen offset:2048 lds
Maaa 128,244,20
Ta 108,27,16384
Ta 110,27,18432
Maaa 132,248,16
Maaa 132,252,20
Ra 232,12,2048
Maaa 136,240,24
buffer_load_dwordx4 v9, s[8:11], s51 offen offset:3072 lds
Maaa 136,244,28
Ta 112,28,0
Ta 114,28,2048
Maaa 140,248,24
v_xor_b32 v8, 524288, v8
v_xor_b32 v9, 524288, v9
Maaa 140,252,28
s_add_u32 m0, s44, 49152
s_waitcnt lgkmcnt(9)
Ra 236,13,2048
Maaa 144,240,32
buffer_load_dwordx4 v8, s[8:11], s48 offen offset:0 lds
Maaa 144,244,36
Maaa 148,248,32
Maaa 148,252,36
Ta 116,28,16384
Ta 118,28,18432
Maaa 152,240,40
buffer_load_dwordx4 v8, s[8:11], s49 offen offset:1024 lds
Maaa 152,244,44
Ta 120,29,0
Ta 122,29,2048
Maaa 156,248,40
Maaa 156,252,44
Ta 124,29,16384
s_waitcnt lgkmcnt(9)
Ta 126,29,18432
Maaa 160,240,48
buffer_load_dwordx4 v9, s[8:11], s50 offen offset:2048 lds
Maaa 160,244,52
Maaa 164,248,48
Maaa 164,252,52
Maaa 168,240,56
buffer_load_dwordx4 v9, s[8:11], s51 offen offset:3072 lds
Maaa 168,244,60
v_xor_b32 v8, 3670016, v8
v_xor_b32 v9, 3670016, v9
Maaa 172,248,56
s_waitcnt lgkmcnt(6)
Maaa 172,252,60
s_waitcnt lgkmcnt(0)
Mvaa 48,224,64
v_mov_b32 v14, v40
v_mov_b32_e64 v15, v41
Mvaa 48,228,68
Mvaa 52,232,64
Mvaa 52,236,68
Ra 240,12,4096
Mvaa 56,224,72
Mvaa 56,228,76
Mvaa 60,232,72
Mvaa 60,236,76
Ra 244,13,4096
Mvaa 64,224,80
Vc 24,48,49
Vc 25,50,51
Mvaa 64,228,84
Vc 26,52,53
Vc 27,54,55
Mvaa 68,232,80
Mvaa 68,236,84
Ra 248,12,6144
Mvaa 72,224,88
Vc 28,56,57
Vc 29,58,59
Mvaa 72,228,92
Vc 30,60,61
Vc 31,62,63
Mvaa 76,232,88
Mvaa 76,236,92
Ra 252,13,6144
Mvaa 80,224,96
Vc 32,64,65
Vc 33,66,67
Mvaa 80,228,100
Vc 34,68,69
Vc 35,70,71
Mvaa 84,232,96
Mvaa 84,236,100
Mvaa 88,224,104
Vc 36,72,73
Vc 37,74,75
Mvaa 88,228,108
Vc 38,76,77
Vc 39,78,79
Mvaa 92,232,104
Mvaa 92,236,108
Mvaa 96,224,112
Vc 40,80,81
Vc 41,82,83
Mvaa 96,228,116
Vc 42,84,85
Vc 43,86,87
Mvaa 100,232,112
s_waitcnt vmcnt(12)
Mvaa 100,236,116
s_add_u32 s59, s38, 0
Mvaa 104,224,120
v_readfirstlane_b32 s3, v1
s_nop 0
s_or_b32 s3, s3, s37
s_cmp_lt_u32 s3, 256
s_cbranch_scc1 L_spinAv
L_spinArv:
s_barrier
Mvaa 104,228,124
buffer_store_dwordx4 v[24:27], v2, s[24:27], s59 offen offset:0 sc1
Mvaa 108,232,120
s_waitcnt lgkmcnt(0)
Mvaa 108,236,124
Vc 44,88,89
Vc 45,90,91
Mvaa 112,240,64
buffer_load_dwordx4 a[0:3], v10, s[20:23], s53 offen offset:0 sc1
Mvaa 112,244,68
Vc 46,92,93
Vc 47,94,95
Mvaa 116,248,64
Vc 48,96,97
Vc 49,98,99
Mvaa 116,252,68
Ra 224,12,8192
Mvaa 120,240,72
Vc 50,100,101
Vc 51,102,103
Mvaa 120,244,76
Vc 52,104,105
Vc 53,106,107
Mvaa 124,248,72
buffer_load_dwordx4 a[4:7], v10, s[20:23], s52 offen offset:0 sc1
Mvaa 124,252,76
Ra 228,13,8192
Mvaa 128,240,80
Vc 54,108,109
Vc 55,110,111
Mvaa 128,244,84
Vc 56,112,113
Vc 57,114,115
Mvaa 132,248,80
Vc 58,116,117
Vc 59,118,119
Mvaa 132,252,84
Ra 232,12,10240
Mvaa 136,240,88
buffer_load_dwordx4 a[8:11], v11, s[20:23], s53 offen offset:0 sc1
Mvaa 136,244,92
buffer_store_dwordx4 v[28:31], v2, s[24:27], s59 offen offset:1024 sc1
Mvaa 140,248,88
Vc 60,120,121
Vc 61,122,123
Mvaa 140,252,92
Ra 236,13,10240
Mvaa 144,240,96
Vc 62,124,125
Vc 63,126,127
Mvaa 144,244,100
Vc 64,128,129
Vc 65,130,131
Mvaa 148,248,96
buffer_load_dwordx4 a[12:15], v11, s[20:23], s52 offen offset:0 sc1
Mvaa 148,252,100
Vc 66,132,133
Vc 67,134,135
Mvaa 152,240,104
Vc 68,136,137
Vc 69,138,139
Mvaa 152,244,108
Vc 70,140,141
Vc 71,142,143
Mvaa 156,248,104
Mvaa 156,252,108
Mvaa 160,240,112
buffer_load_dwordx4 a[16:19], v10, s[20:23], s53 offen offset:1024 sc1
Mvaa 160,244,116
Vc 72,144,145
Vc 73,146,147
Mvaa 164,248,112
Vc 74,148,149
Vc 75,150,151
Mvaa 164,252,116
buffer_store_dwordx4 v[32:35], v2, s[24:27], s59 offen offset:2048 sc1
Mvaa 168,240,120
Vc 76,152,153
Vc 77,154,155
Mvaa 168,244,124
Vc 78,156,157
Vc 79,158,159
Mvaa 172,248,120
s_waitcnt lgkmcnt(0)
buffer_load_dwordx4 a[20:23], v10, s[20:23], s52 offen offset:1024 sc1
Mvaa 172,252,124
Mvaa 176,224,64
Vc 80,160,161
Vc 81,162,163
Mvaa 176,228,68
Vc 82,164,165
Vc 83,166,167
Mvaa 180,232,64
Mvaa 180,236,68
Ra 240,12,12288
Mvaa 184,224,72
buffer_load_dwordx4 a[24:27], v11, s[20:23], s53 offen offset:1024 sc1
Mvaa 184,228,76
Vc 84,168,169
Vc 85,170,171
Mvaa 188,232,72
Vc 86,172,173
Vc 87,174,175
Mvaa 188,236,76
Ra 244,13,12288
Mvaa 192,224,80
Vc 88,176,177
Vc 89,178,179
Mvaa 192,228,84
Vc 90,180,181
Vc 91,182,183
Mvaa 196,232,80
buffer_load_dwordx4 a[28:31], v11, s[20:23], s52 offen offset:1024 sc1
Mvaa 196,236,84
Ra 248,12,14336
s_xor_b32 s52, s52, 2048
Mvaa 200,224,88
s_add_u32 s53, s52, s58
Mvaa 200,228,92
Vc 92,184,185
Vc 93,186,187
Mvaa 204,232,88
Vc 94,188,189
Vc 95,190,191
Mvaa 204,236,92
Ra 252,13,14336
Mvaa 208,224,96
buffer_load_dwordx4 a[32:35], v10, s[20:23], s53 offen offset:0 sc1
Mvaa 208,228,100
buffer_store_dwordx4 v[36:39], v2, s[24:27], s59 offen offset:3072 sc1
Mvaa 212,232,96
Vc 96,192,193
Vc 97,194,195
Mvaa 212,236,100
Vc 98,196,197
Vc 99,198,199
Mvaa 216,224,104
Vc 100,200,201
Vc 101,202,203
Mvaa 216,228,108
Vc 102,204,205
Vc 103,206,207
Mvaa 220,232,104
buffer_load_dwordx4 a[36:39], v10, s[20:23], s52 offen offset:0 sc1
Mvaa 220,236,108
Mvaa 224,224,112
Vc 104,208,209
Vc 105,210,211
Mvaa 224,228,116
Vc 106,212,213
Vc 107,214,215
Mvaa 228,232,112
Mvaa 228,236,116
Mvaa 232,224,120
buffer_load_dwordx4 a[40:43], v11, s[20:23], s53 offen offset:0 sc1
Mvaa 232,228,124
Vc 108,216,217
Vc 109,218,219
Mvaa 236,232,120
s_waitcnt lgkmcnt(0)
Mvaa 236,236,124
Vc 110,220,221
Vc 111,222,223
Mvaa 240,240,64
s_add_u32 s59, s38, 4096
Mvaa 240,244,68
buffer_store_dwordx4 v[40:43], v2, s[24:27], s59 offen offset:0 sc1
Mvaa 244,248,64
buffer_load_dwordx4 a[44:47], v11, s[20:23], s52 offen offset:0 sc1
Mvaa 244,252,68
Vc 112,224,225
Vc 113,226,227
Mvaa 248,240,72
Vc 114,228,229
Vc 115,230,231
Mvaa 248,244,76
Vc 116,232,233
Vc 117,234,235
Mvaa 252,248,72
Vc 118,236,237
Vc 119,238,239
Mvaa 252,252,76
Maaa 128,240,80
buffer_load_dwordx4 a[48:51], v10, s[20:23], s53 offen offset:1024 sc1
Maaa 128,244,84
Ta 192,16,0
Ta 194,16,1024
Maaa 132,248,80
Vc 120,240,241
Vc 121,242,243
Maaa 132,252,84
Ta 196,17,0
Ta 198,17,1024
Maaa 136,240,88
Vc 122,244,245
Vc 123,246,247
Maaa 136,244,92
Ta 200,18,0
Ta 202,18,1024
Maaa 140,248,88
buffer_load_dwordx4 a[52:55], v10, s[20:23], s52 offen offset:1024 sc1
Maaa 140,252,92
Ta 204,19,0
Ta 206,19,1024
Maaa 144,240,96
Vc 124,248,249
Vc 125,250,251
Maaa 144,244,100
Ta 208,20,0
Ta 210,20,1024
Maaa 148,248,96
Vc 126,252,253
Vc 127,254,255
Maaa 148,252,100
Ta 212,21,0
Ta 214,21,1024
Maaa 152,240,104
buffer_load_dwordx4 a[56:59], v11, s[20:23], s53 offen offset:1024 sc1
Maaa 152,244,108
Ta 216,22,0
Ta 218,22,1024
Maaa 156,248,104
buffer_store_dwordx4 v[44:47], v2, s[24:27], s59 offen offset:1024 sc1
Maaa 156,252,108
Ta 220,23,0
s_waitcnt lgkmcnt(9)
Ta 222,23,1024
Maaa 160,240,112
Maaa 160,244,116
Maaa 164,248,112
buffer_load_dwordx4 a[60:63], v11, s[20:23], s52 offen offset:1024 sc1
Maaa 164,252,116
s_xor_b32 s52, s52, 6144
s_add_u32 s53, s52, s58
Maaa 168,240,120
Maaa 168,244,124
Maaa 172,248,120
Maaa 172,252,124
L_phase2:
s_nop 7
s_waitcnt vmcnt(16) lgkmcnt(0)
Zvaa 128,192,0
buffer_store_dwordx4 v[48:51], v2, s[24:27], s59 offen offset:2048 sc1
Zvaa 160,192,4
Ta 224,16,8192
Ta 226,16,9216
Zvaa 192,192,8
buffer_load_dwordx4 a[64:67], v10, s[20:23], s53 offen offset:0 sc1
Zvaa 224,192,12
s_mov_b32 s60, s40
s_and_b32 s61, s41, 0xffff
s_mov_b32 s62, 7340032
Zvaa 132,196,0
Ta 228,17,8192
Ta 230,17,9216
Zvaa 164,196,4
buffer_load_dwordx4 a[68:71], v10, s[20:23], s52 offen offset:0 sc1
Zvaa 196,196,8
s_mov_b32 s63, 0x20000
Zvaa 228,196,12
Ta 232,18,8192
Ta 234,18,9216
Zvaa 136,200,0
global_load_dword v13, v[14:15], off
Zvaa 168,200,4
buffer_load_dwordx4 a[72:75], v11, s[20:23], s53 offen offset:0 sc1
Zvaa 200,200,8
Ta 236,19,8192
Ta 238,19,9216
Zvaa 232,200,12
Zvaa 140,204,0
buffer_load_dwordx4 a[76:79], v11, s[20:23], s52 offen offset:0 sc1
Zvaa 172,204,4
Ta 240,20,8192
Ta 242,20,9216
Zvaa 204,204,8
Zvaa 236,204,12
Zvaa 144,208,0
s_waitcnt lgkmcnt(6)
Ta 244,21,8192
Ta 246,21,9216
Zvaa 176,208,4
buffer_load_dwordx4 a[80:83], v10, s[20:23], s53 offen offset:1024 sc1
Zvaa 208,208,8
Zvaa 240,208,12
Ta 248,22,8192
Ta 250,22,9216
Zvaa 148,212,0
buffer_load_dwordx4 a[84:87], v10, s[20:23], s52 offen offset:1024 sc1
Zvaa 180,212,4
Zvaa 212,212,8
Ta 252,23,8192
Ta 254,23,9216
Zvaa 244,212,12
Zvaa 152,216,0
buffer_load_dwordx4 a[88:91], v11, s[20:23], s53 offen offset:1024 sc1
Zvaa 184,216,4
Zvaa 216,216,8
buffer_load_dwordx4 a[92:95], v11, s[20:23], s52 offen offset:1024 sc1
Zvaa 248,216,12
s_xor_b32 s52, s52, 2048
s_add_u32 s53, s52, s58
Zvaa 156,220,0
buffer_store_dwordx4 v[52:55], v2, s[24:27], s59 offen offset:3072 sc1
Zvaa 188,220,4
Zvaa 220,220,8
s_waitcnt vmcnt(22) lgkmcnt(0)
Zvaa 252,220,12
s_barrier
Mvaa 128,224,16
Mvaa 160,224,20
s_add_u32 m0, s44, 0
Ta 192,16,16384
Ta 194,16,17408
Mvaa 192,224,24
buffer_load_dwordx4 v8, s[8:11], s48 offen offset:0 lds
Mvaa 224,224,28
Mvaa 132,228,16
Ta 196,17,16384
Ta 198,17,17408
Mvaa 164,228,20
Mvaa 196,228,24
buffer_load_dwordx4 v8, s[8:11], s49 offen offset:1024 lds
Mvaa 228,228,28
Ta 200,18,16384
Ta 202,18,17408
Mvaa 136,232,16
Mvaa 168,232,20
Mvaa 200,232,24
Ta 204,19,16384
Ta 206,19,17408
Mvaa 232,232,28
buffer_load_dwordx4 a[96:99], v10, s[20:23], s53 offen offset:0 sc1
Mvaa 140,236,16
Mvaa 172,236,20
Ta 208,20,16384
Ta 210,20,17408
Mvaa 204,236,24
Mvaa 236,236,28
Mvaa 144,240,16
s_waitcnt lgkmcnt(6)
Ta 212,21,16384
Ta 214,21,17408
Mvaa 176,240,20
buffer_load_dwordx4 a[100:103], v10, s[20:23], s52 offen offset:0 sc1
Mvaa 208,240,24
Mvaa 240,240,28
Ta 216,22,16384
Ta 218,22,17408
Mvaa 148,244,16
Mvaa 180,244,20
buffer_load_dwordx4 a[104:107], v11, s[20:23], s53 offen offset:0 sc1
Mvaa 212,244,24
Ta 220,23,16384
Ta 222,23,17408
Mvaa 244,244,28
s_add_u32 s59, s38, 8192
Mvaa 152,248,16
buffer_store_dwordx4 v[56:59], v2, s[24:27], s59 offen offset:0 sc1
Mvaa 184,248,20
buffer_load_dwordx4 a[108:111], v11, s[20:23], s52 offen offset:0 sc1
Mvaa 216,248,24
Ar 48,128
Ar 49,129
Mvaa 248,248,28
Ar 50,130
Ar 51,131
Mvaa 156,252,16
Ar 52,132
Ar 53,133
Mvaa 188,252,20
Ar 54,134
Ar 55,135
Mvaa 220,252,24
s_waitcnt vmcnt(23) lgkmcnt(0)
Vc 24,48,49
Vc 25,50,51
Mvaa 252,252,28
Vc 26,52,53
Vc 27,54,55
Mvaa 128,192,32
Mvaa 160,192,36
Ta 224,16,24576
Ta 226,16,25600
Mvaa 192,192,40
buffer_load_dwordx4 v9, s[8:11], s50 offen offset:2048 lds
Mvaa 224,192,44
Mvaa 132,196,32
Ta 228,17,24576
Ta 230,17,25600
Mvaa 164,196,36
Mvaa 196,196,40
buffer_load_dwordx4 v9, s[8:11], s51 offen offset:3072 lds
Mvaa 228,196,44
Ta 232,18,24576
Ta 234,18,25600
Mvaa 136,200,32
v_xor_b32 v8, 524288, v8
v_xor_b32 v9, 524288, v9
Mvaa 168,200,36
Mvaa 200,200,40
Ta 236,19,24576
Ta 238,19,25600
Mvaa 232,200,44
buffer_load_dwordx4 a[112:115], v10, s[20:23], s53 offen offset:1024 sc1
Mvaa 140,204,32
Mvaa 172,204,36
Ta 240,20,24576
Ta 242,20,25600
Mvaa 204,204,40
Mvaa 236,204,44
Mvaa 144,208,32
s_waitcnt lgkmcnt(6)
Ta 244,21,24576
Ta 246,21,25600
Mvaa 176,208,36
buffer_load_dwordx4 a[116:119], v10, s[20:23], s52 offen offset:1024 sc1
Mvaa 208,208,40
buffer_store_dwordx4 v[60:63], v2, s[24:27], s59 offen offset:1024 sc1
Mvaa 240,208,44
Ta 248,22,24576
Ta 250,22,25600
Mvaa 148,212,32
Ar 48,136
Ar 49,137
Mvaa 180,212,36
buffer_load_dwordx4 a[120:123], v11, s[20:23], s53 offen offset:1024 sc1
Mvaa 212,212,40
Ta 252,23,24576
Ta 254,23,25600
Mvaa 244,212,44
Ar 50,138
Ar 51,139
Mvaa 152,216,32
Ar 52,140
Ar 53,141
Mvaa 184,216,36
buffer_load_dwordx4 a[124:127], v11, s[20:23], s52 offen offset:1024 sc1
Mvaa 216,216,40
s_xor_b32 s52, s52, 14336
s_add_u32 s53, s52, s58
Mvaa 248,216,44
Ar 54,142
Ar 55,143
Mvaa 156,220,32
Vc 28,48,49
Vc 29,50,51
Mvaa 188,220,36
Vc 30,52,53
Vc 31,54,55
Mvaa 220,220,40
s_waitcnt vmcnt(25) lgkmcnt(0)
Mvaa 252,220,44
s_barrier
Mvaa 128,224,48
Mvaa 160,224,52
s_add_u32 m0, s44, 16384
Ta 192,16,32768
Ta 194,16,33792
Mvaa 192,224,56
buffer_load_dwordx4 v8, s[8:11], s48 offen offset:0 lds
Mvaa 224,224,60
Mvaa 132,228,48
Ta 196,17,32768
Ta 198,17,33792
Mvaa 164,228,52
Mvaa 196,228,56
buffer_load_dwordx4 v8, s[8:11], s49 offen offset:1024 lds
Mvaa 228,228,60
Ta 200,18,32768
Ta 202,18,33792
Mvaa 136,232,48
Mvaa 168,232,52
Mvaa 200,232,56
Ta 204,19,32768
Ta 206,19,33792
Mvaa 232,232,60
buffer_load_dwordx4 a[0:3], v10, s[20:23], s53 offen offset:0 sc1
Mvaa 140,236,48
buffer_store_dwordx4 v[64:67], v2, s[24:27], s59 offen offset:2048 sc1
Mvaa 172,236,52
Ta 208,20,32768
Ta 210,20,33792
Mvaa 204,236,56
Ar 48,144
Ar 49,145
Mvaa 236,236,60
Ar 50,146
Ar 51,147
Mvaa 144,240,48
s_waitcnt lgkmcnt(6)
Ta 212,21,32768
Ta 214,21,33792
Mvaa 176,240,52
buffer_load_dwordx4 a[4:7], v10, s[20:23], s52 offen offset:0 sc1
Mvaa 208,240,56
Ar 52,148
Ar 53,149
Mvaa 240,240,60
Ta 216,22,32768
Ta 218,22,33792
Mvaa 148,244,48
Ar 54,150
Ar 55,151
Mvaa 180,244,52
buffer_load_dwordx4 a[8:11], v11, s[20:23], s53 offen offset:0 sc1
Mvaa 212,244,56
Ta 220,23,32768
Ta 222,23,33792
Mvaa 244,244,60
Vc 32,48,49
Vc 33,50,51
Mvaa 152,248,48
Vc 34,52,53
Vc 35,54,55
Mvaa 184,248,52
buffer_load_dwordx4 a[12:15], v11, s[20:23], s52 offen offset:0 sc1
Mvaa 216,248,56
Mvaa 248,248,60
Mvaa 156,252,48
Mvaa 188,252,52
Mvaa 220,252,56
s_waitcnt vmcnt(26) lgkmcnt(0)
Mvaa 252,252,60
Mvaa 128,192,64
Mvaa 160,192,68
Ta 224,16,40960
Ta 226,16,41984
Mvaa 192,192,72
buffer_load_dwordx4 v9, s[8:11], s50 offen offset:2048 lds
Mvaa 224,192,76
Mvaa 132,196,64
Ta 228,17,40960
Ta 230,17,41984
Mvaa 164,196,68
Mvaa 196,196,72
buffer_load_dwordx4 v9, s[8:11], s51 offen offset:3072 lds
Mvaa 228,196,76
Ta 232,18,40960
Ta 234,18,41984
Mvaa 136,200,64
v_xor_b32 v8, 1572864, v8
v_xor_b32 v9, 1572864, v9
Mvaa 168,200,68
buffer_store_dwordx4 v[68:71], v2, s[24:27], s59 offen offset:3072 sc1
Mvaa 200,200,72
Ta 236,19,40960
Ta 238,19,41984
Mvaa 232,200,76
buffer_load_dwordx4 a[16:19], v10, s[20:23], s53 offen offset:1024 sc1
Mvaa 140,204,64
Ar 48,152
Ar 49,153
Mvaa 172,204,68
Ta 240,20,40960
Ta 242,20,41984
Mvaa 204,204,72
Ar 50,154
Ar 51,155
Mvaa 236,204,76
Ar 52,156
Ar 53,157
Mvaa 144,208,64
s_waitcnt lgkmcnt(6)
Ta 244,21,40960
Ta 246,21,41984
Mvaa 176,208,68
buffer_load_dwordx4 a[20:23], v10, s[20:23], s52 offen offset:1024 sc1
Mvaa 208,208,72
Ar 54,158
Ar 55,159
Mvaa 240,208,76
Ta 248,22,40960
Ta 250,22,41984
Mvaa 148,212,64
Vc 36,48,49
Vc 37,50,51
Mvaa 180,212,68
buffer_load_dwordx4 a[24:27], v11, s[20:23], s53 offen offset:1024 sc1
Mvaa 212,212,72
Ta 252,23,40960
Ta 254,23,41984
Mvaa 244,212,76
Vc 38,52,53
Vc 39,54,55
Mvaa 152,216,64
Mvaa 184,216,68
buffer_load_dwordx4 a[28:31], v11, s[20:23], s52 offen offset:1024 sc1
Mvaa 216,216,72
s_xor_b32 s52, s52, 2048
s_add_u32 s53, s52, s58
Mvaa 248,216,76
Mvaa 156,220,64
Mvaa 188,220,68
Mvaa 220,220,72
s_waitcnt vmcnt(29) lgkmcnt(0)
Mvaa 252,220,76
s_barrier
Mvaa 128,224,80
s_add_u32 s59, s38, 12288
Mvaa 160,224,84
s_add_u32 m0, s44, 32768
Ta 192,16,49152
Ta 194,16,50176
Mvaa 192,224,88
buffer_load_dwordx4 v8, s[8:11], s48 offen offset:0 lds
Mvaa 224,224,92
buffer_store_dwordx4 v[72:75], v2, s[24:27], s59 offen offset:0 sc1
Mvaa 132,228,80
Ta 196,17,49152
Ta 198,17,50176
Mvaa 164,228,84
Ar 48,160
Ar 49,161
Mvaa 196,228,88
buffer_load_dwordx4 v8, s[8:11], s49 offen offset:1024 lds
Mvaa 228,228,92
Ta 200,18,49152
Ta 202,18,50176
Mvaa 136,232,80
Ar 50,162
Ar 51,163
Mvaa 168,232,84
Ar 52,164
Ar 53,165
Mvaa 200,232,88
Ta 204,19,49152
Ta 206,19,50176
Mvaa 232,232,92
buffer_load_dwordx4 a[32:35], v10, s[20:23], s53 offen offset:0 sc1
Mvaa 140,236,80
Ar 54,166
Ar 55,167
Mvaa 172,236,84
Ta 208,20,49152
Ta 210,20,50176
Mvaa 204,236,88
Vc 40,48,49
Vc 41,50,51
Mvaa 236,236,92
Vc 42,52,53
Vc 43,54,55
Mvaa 144,240,80
s_waitcnt lgkmcnt(6)
Ta 212,21,49152
Ta 214,21,50176
Mvaa 176,240,84
buffer_load_dwordx4 a[36:39], v10, s[20:23], s52 offen offset:0 sc1
Mvaa 208,240,88
global_load_dword v13, v[14:15], off
Mvaa 240,240,92
Ta 216,22,49152
Ta 218,22,50176
Mvaa 148,244,80
Mvaa 180,244,84
buffer_load_dwordx4 a[40:43], v11, s[20:23], s53 offen offset:0 sc1
Mvaa 212,244,88
Ta 220,23,49152
Ta 222,23,50176
Mvaa 244,244,92
Mvaa 152,248,80
Mvaa 184,248,84
buffer_load_dwordx4 a[44:47], v11, s[20:23], s52 offen offset:0 sc1
Mvaa 216,248,88
Mvaa 248,248,92
buffer_store_dwordx4 v[76:79], v2, s[24:27], s59 offen offset:1024 sc1
Mvaa 156,252,80
Ar 48,168
Ar 49,169
Mvaa 188,252,84
Ar 50,170
Ar 51,171
Mvaa 220,252,88
s_waitcnt vmcnt(30) lgkmcnt(0)
Ar 52,172
Ar 53,173
Mvaa 252,252,92
Ar 54,174
Ar 55,175
Mvaa 128,192,96
Vc 44,48,49
Vc 45,50,51
Mvaa 160,192,100
Ta 224,16,57344
Ta 226,16,58368
Mvaa 192,192,104
buffer_load_dwordx4 v9, s[8:11], s50 offen offset:2048 lds
Mvaa 224,192,108
Vc 46,52,53
Vc 47,54,55
Mvaa 132,196,96
Ta 228,17,57344
Ta 230,17,58368
Mvaa 164,196,100
s_lshl_b32 s3, s32, 11
s_add_u32 s3, s3, 5242880
Mvaa 196,196,104
buffer_load_dwordx4 v9, s[8:11], s51 offen offset:3072 lds
Mvaa 228,196,108
Ta 232,18,57344
Ta 234,18,58368
Mvaa 136,200,96
v_xor_b32 v8, 524288, v8
v_xor_b32 v9, 524288, v9
Mvaa 168,200,100
buffer_load_dwordx4 v[56:59], v2, s[20:23], s3 offen offset:0 sc1
Mvaa 200,200,104
Ta 236,19,57344
Ta 238,19,58368
Mvaa 232,200,108
buffer_load_dwordx4 a[48:51], v10, s[20:23], s53 offen offset:1024 sc1
Mvaa 140,204,96
buffer_load_dwordx4 v[60:63], v2, s[20:23], s3 offen offset:1024 sc1
Mvaa 172,204,100
Ta 240,20,57344
Ta 242,20,58368
Mvaa 204,204,104
Mvaa 236,204,108
Mvaa 144,208,96
s_waitcnt lgkmcnt(6)
Ta 244,21,57344
Ta 246,21,58368
Mvaa 176,208,100
buffer_load_dwordx4 a[52:55], v10, s[20:23], s52 offen offset:1024 sc1
Mvaa 208,208,104
Mvaa 240,208,108
Ta 248,22,57344
Ta 250,22,58368
Mvaa 148,212,96
Mvaa 180,212,100
buffer_load_dwordx4 a[56:59], v11, s[20:23], s53 offen offset:1024 sc1
Mvaa 212,212,104
Ta 252,23,57344
Ta 254,23,58368
Mvaa 244,212,108
buffer_store_dwordx4 v[80:83], v2, s[24:27], s59 offen offset:2048 sc1
Mvaa 152,216,96
Mvaa 184,216,100
buffer_load_dwordx4 a[60:63], v11, s[20:23], s52 offen offset:1024 sc1
Mvaa 216,216,104
s_xor_b32 s52, s52, 6144
s_add_u32 s53, s52, s58
Mvaa 248,216,108
Mvaa 156,220,96
Mvaa 188,220,100
Mvaa 220,220,104
s_waitcnt vmcnt(32) lgkmcnt(0)
Mvaa 252,220,108
s_barrier
Mvaa 128,224,112
Mvaa 160,224,116
s_add_u32 m0, s44, 49152
Ta 192,16,0
Ta 194,16,1024
Mvaa 192,224,120
buffer_load_dwordx4 v8, s[8:11], s48 offen offset:0 lds
Mvaa 224,224,124
Mvaa 132,228,112
Ta 196,17,0
Ta 198,17,1024
Mvaa 164,228,116
Mvaa 196,228,120
buffer_load_dwordx4 v8, s[8:11], s49 offen offset:1024 lds
Mvaa 228,228,124
Ta 200,18,0
Ta 202,18,1024
Mvaa 136,232,112
Mvaa 168,232,116
Mvaa 200,232,120
Ta 204,19,0
Ta 206,19,1024
Mvaa 232,232,124
buffer_load_dwordx4 a[64:67], v10, s[20:23], s53 offen offset:0 sc1
Mvaa 140,236,112
Mvaa 172,236,116
Ta 208,20,0
Ta 210,20,1024
Mvaa 204,236,120
Mvaa 236,236,124
Mvaa 144,240,112
s_waitcnt lgkmcnt(6)
Ta 212,21,0
Ta 214,21,1024
Mvaa 176,240,116
buffer_load_dwordx4 a[68:71], v10, s[20:23], s52 offen offset:0 sc1
Mvaa 208,240,120
buffer_store_dwordx4 v[84:87], v2, s[24:27], s59 offen offset:3072 sc1
Mvaa 240,240,124
Ta 216,22,0
Ta 218,22,1024
Mvaa 148,244,112
Mvaa 180,244,116
buffer_load_dwordx4 a[72:75], v11, s[20:23], s53 offen offset:0 sc1
Mvaa 212,244,120
Ta 220,23,0
Ta 222,23,1024
Mvaa 244,244,124
Mvaa 152,248,112
Mvaa 184,248,116
buffer_load_dwordx4 a[76:79], v11, s[20:23], s52 offen offset:0 sc1
Mvaa 216,248,120
Mvaa 248,248,124
Mvaa 156,252,112
Mvaa 188,252,116
Mvaa 220,252,120
s_waitcnt vmcnt(32) lgkmcnt(0)
Mvaa 252,252,124
Mvaa 128,192,0
Mvaa 160,192,4
Ta 224,16,8192
Ta 226,16,9216
Mvaa 192,192,8
buffer_load_dwordx4 v9, s[8:11], s50 offen offset:2048 lds
Mvaa 224,192,12
Mvaa 132,196,0
Ta 228,17,8192
Ta 230,17,9216
Mvaa 164,196,4
Mvaa 196,196,8
buffer_load_dwordx4 v9, s[8:11], s51 offen offset:3072 lds
Mvaa 228,196,12
Ta 232,18,8192
Ta 234,18,9216
Mvaa 136,200,0
v_xor_b32 v8, 7864320, v8
v_xor_b32 v9, 7864320, v9
Mvaa 168,200,4
Mvaa 200,200,8
Ta 236,19,8192
Ta 238,19,9216
Mvaa 232,200,12
buffer_load_dwordx4 a[80:83], v10, s[20:23], s53 offen offset:1024 sc1
Mvaa 140,204,0
s_add_u32 s59, s38, 34816
Mvaa 172,204,4
Ta 240,20,8192
Ta 242,20,9216
Mvaa 204,204,8
buffer_store_dwordx4 v[88:91], v2, s[24:27], s59 offen offset:0 sc1
Mvaa 236,204,12
Mvaa 144,208,0
s_waitcnt lgkmcnt(6)
Ta 244,21,8192
Ta 246,21,9216
Mvaa 176,208,4
buffer_load_dwordx4 a[84:87], v10, s[20:23], s52 offen offset:1024 sc1
Mvaa 208,208,8
Mvaa 240,208,12
Ta 248,22,8192
Ta 250,22,9216
Mvaa 148,212,0
Mvaa 180,212,4
buffer_load_dwordx4 a[88:91], v11, s[20:23], s53 offen offset:1024 sc1
Mvaa 212,212,8
Ta 252,23,8192
Ta 254,23,9216
Mvaa 244,212,12
Mvaa 152,216,0
Mvaa 184,216,4
buffer_load_dwordx4 a[92:95], v11, s[20:23], s52 offen offset:1024 sc1
Mvaa 216,216,8
s_xor_b32 s52, s52, 2048
s_add_u32 s53, s52, s58
Mvaa 248,216,12
Mvaa 156,220,0
Mvaa 188,220,4
Mvaa 220,220,8
s_waitcnt vmcnt(32) lgkmcnt(0)
Mvaa 252,220,12
s_barrier
Mvaa 128,224,16
Mvaa 160,224,20
s_add_u32 m0, s44, 0
Ta 192,16,16384
Ta 194,16,17408
Mvaa 192,224,24
buffer_load_dwordx4 v8, s[8:11], s48 offen offset:0 lds
Mvaa 224,224,28
Mvaa 132,228,16
Ta 196,17,16384
Ta 198,17,17408
Mvaa 164,228,20
Mvaa 196,228,24
buffer_load_dwordx4 v8, s[8:11], s49 offen offset:1024 lds
Mvaa 228,228,28
Ta 200,18,16384
Ta 202,18,17408
Mvaa 136,232,16
buffer_store_dwordx4 v[92:95], v2, s[24:27], s59 offen offset:1024 sc1
Mvaa 168,232,20
Mvaa 200,232,24
Ta 204,19,16384
Ta 206,19,17408
Mvaa 232,232,28
buffer_load_dwordx4 a[96:99], v10, s[20:23], s53 offen offset:0 sc1
Mvaa 140,236,16
Mvaa 172,236,20
Ta 208,20,16384
Ta 210,20,17408
Mvaa 204,236,24
Mvaa 236,236,28
Mvaa 144,240,16
s_waitcnt lgkmcnt(6)
Ta 212,21,16384
Ta 214,21,17408
Mvaa 176,240,20
buffer_load_dwordx4 a[100:103], v10, s[20:23], s52 offen offset:0 sc1
Mvaa 208,240,24
Mvaa 240,240,28
Ta 216,22,16384
Ta 218,22,17408
Mvaa 148,244,16
Mvaa 180,244,20
buffer_load_dwordx4 a[104:107], v11, s[20:23], s53 offen offset:0 sc1
Mvaa 212,244,24
Ta 220,23,16384
Ta 222,23,17408
Mvaa 244,244,28
Mvaa 152,248,16
Mvaa 184,248,20
buffer_load_dwordx4 a[108:111], v11, s[20:23], s52 offen offset:0 sc1
Mvaa 216,248,24
Mvaa 248,248,28
Mvaa 156,252,16
Mvaa 188,252,20
Mvaa 220,252,24
s_waitcnt vmcnt(31) lgkmcnt(0)
Mvaa 252,252,28
Mvaa 128,192,32
buffer_store_dwordx4 v[96:99], v2, s[24:27], s59 offen offset:2048 sc1
Mvaa 160,192,36
Ta 224,16,24576
Ta 226,16,25600
Mvaa 192,192,40
buffer_load_dwordx4 v9, s[8:11], s50 offen offset:2048 lds
Mvaa 224,192,44
Mvaa 132,196,32
Ta 228,17,24576
Ta 230,17,25600
Mvaa 164,196,36
Mvaa 196,196,40
buffer_load_dwordx4 v9, s[8:11], s51 offen offset:3072 lds
Mvaa 228,196,44
Ta 232,18,24576
Ta 234,18,25600
Mvaa 136,200,32
v_xor_b32 v8, 524288, v8
v_xor_b32 v9, 524288, v9
Mvaa 168,200,36
Mvaa 200,200,40
Ta 236,19,24576
Ta 238,19,25600
Mvaa 232,200,44
buffer_load_dwordx4 a[112:115], v10, s[20:23], s53 offen offset:1024 sc1
Mvaa 140,204,32
Mvaa 172,204,36
Ta 240,20,24576
Ta 242,20,25600
Mvaa 204,204,40
Mvaa 236,204,44
Mvaa 144,208,32
s_waitcnt lgkmcnt(6)
Ta 244,21,24576
Ta 246,21,25600
Mvaa 176,208,36
buffer_load_dwordx4 a[116:119], v10, s[20:23], s52 offen offset:1024 sc1
Mvaa 208,208,40
Mvaa 240,208,44
Ta 248,22,24576
Ta 250,22,25600
Mvaa 148,212,32
Mvaa 180,212,36
buffer_load_dwordx4 a[120:123], v11, s[20:23], s53 offen offset:1024 sc1
Mvaa 212,212,40
Ta 252,23,24576
Ta 254,23,25600
Mvaa 244,212,44
Mvaa 152,216,32
Mvaa 184,216,36
buffer_load_dwordx4 a[124:127], v11, s[20:23], s52 offen offset:1024 sc1
Mvaa 216,216,40
s_xor_b32 s52, s52, 30720
s_add_u32 s53, s52, s58
Mvaa 248,216,44
buffer_store_dwordx4 v[100:103], v2, s[24:27], s59 offen offset:3072 sc1
Mvaa 156,220,32
Mvaa 188,220,36
Mvaa 220,220,40
s_waitcnt vmcnt(29) lgkmcnt(0)
Mvaa 252,220,44
s_barrier
Mvaa 128,224,48
Mvaa 160,224,52
s_add_u32 m0, s44, 16384
Ta 192,16,32768
Ta 194,16,33792
Mvaa 192,224,56
buffer_load_dwordx4 v8, s[8:11], s48 offen offset:0 lds
Mvaa 224,224,60
Mvaa 132,228,48
Ta 196,17,32768
Ta 198,17,33792
Mvaa 164,228,52
Mvaa 196,228,56
buffer_load_dwordx4 v8, s[8:11], s49 offen offset:1024 lds
Mvaa 228,228,60
Ta 200,18,32768
Ta 202,18,33792
Mvaa 136,232,48
Mvaa 168,232,52
Mvaa 200,232,56
Ta 204,19,32768
Ta 206,19,33792
Mvaa 232,232,60
buffer_load_dwordx4 a[0:3], v10, s[20:23], s53 offen offset:0 sc1
Mvaa 140,236,48
Mvaa 172,236,52
Ta 208,20,32768
Ta 210,20,33792
Mvaa 204,236,56
Mvaa 236,236,60
Mvaa 144,240,48
s_waitcnt lgkmcnt(6)
Ta 212,21,32768
Ta 214,21,33792
Mvaa 176,240,52
buffer_load_dwordx4 a[4:7], v10, s[20:23], s52 offen offset:0 sc1
Mvaa 208,240,56
Mvaa 240,240,60
Ta 216,22,32768
Ta 218,22,33792
Mvaa 148,244,48
Mvaa 180,244,52
buffer_load_dwordx4 a[8:11], v11, s[20:23], s53 offen offset:0 sc1
Mvaa 212,244,56
Ta 220,23,32768
Ta 222,23,33792
Mvaa 244,244,60
s_add_u32 s59, s38, 38912
Mvaa 152,248,48
buffer_store_dwordx4 v[104:107], v2, s[24:27], s59 offen offset:0 sc1
Mvaa 184,248,52
buffer_load_dwordx4 a[12:15], v11, s[20:23], s52 offen offset:0 sc1
Mvaa 216,248,56
Mvaa 248,248,60
Mvaa 156,252,48
Mvaa 188,252,52
Mvaa 220,252,56
s_waitcnt vmcnt(29) lgkmcnt(0)
Mvaa 252,252,60
Mvaa 128,192,64
v_max_u32 v14, v56, v57
v_min_u32_e64 v15, v56, v57
Mvaa 160,192,68
Ta 224,16,40960
Ta 226,16,41984
Mvaa 192,192,72
buffer_load_dwordx4 v9, s[8:11], s50 offen offset:2048 lds
Mvaa 224,192,76
v_med3_u32 v15, v14, v15, v58
v_max_u32_e64 v14, v14, v58
Mvaa 132,196,64
Ta 228,17,40960
Ta 230,17,41984
Mvaa 164,196,68
v_med3_u32 v15, v14, v15, v59
v_max_u32_e64 v14, v14, v59
Mvaa 196,196,72
buffer_load_dwordx4 v9, s[8:11], s51 offen offset:3072 lds
Mvaa 228,196,76
Ta 232,18,40960
Ta 234,18,41984
Mvaa 136,200,64
v_xor_b32 v8, 1572864, v8
v_xor_b32 v9, 1572864, v9
Mvaa 168,200,68
v_med3_u32 v15, v14, v15, v60
v_max_u32_e64 v14, v14, v60
Mvaa 200,200,72
Ta 236,19,40960
Ta 238,19,41984
Mvaa 232,200,76
buffer_load_dwordx4 a[16:19], v10, s[20:23], s53 offen offset:1024 sc1
Mvaa 140,204,64
v_med3_u32 v15, v14, v15, v61
v_max_u32_e64 v14, v14, v61
Mvaa 172,204,68
Ta 240,20,40960
Ta 242,20,41984
Mvaa 204,204,72
v_med3_u32 v15, v14, v15, v62
v_max_u32_e64 v14, v14, v62
Mvaa 236,204,76
v_med3_u32 v15, v14, v15, v63
v_max_u32_e64 v14, v14, v63
Mvaa 144,208,64
s_waitcnt lgkmcnt(6)
Ta 244,21,40960
Ta 246,21,41984
Mvaa 176,208,68
buffer_load_dwordx4 a[20:23], v10, s[20:23], s52 offen offset:1024 sc1
Mvaa 208,208,72
buffer_store_dwordx4 v[108:111], v2, s[24:27], s59 offen offset:1024 sc1
Mvaa 240,208,76
Ta 248,22,40960
Ta 250,22,41984
Mvaa 148,212,64
s_lshl_b32 s3, s32, 9
s_add_u32 s3, s3, 131072
v_lshlrev_b32_e64 v13, 3, v0
Mvaa 180,212,68
buffer_load_dwordx4 a[24:27], v11, s[20:23], s53 offen offset:1024 sc1
Mvaa 212,212,72
Ta 252,23,40960
Ta 254,23,41984
Mvaa 244,212,76
v_add_u32_e64 v56, s3, v13
v_add_u32 v13, 131072, v13
Mvaa 152,216,64
ds_write_b64 v56, v[14:15]
Mvaa 184,216,68
buffer_load_dwordx4 a[28:31], v11, s[20:23], s52 offen offset:1024 sc1
Mvaa 216,216,72
s_xor_b32 s52, s52, 2048
s_add_u32 s53, s52, s58
Mvaa 248,216,76
Mvaa 156,220,64
Mvaa 188,220,68
Mvaa 220,220,72
s_waitcnt vmcnt(29) lgkmcnt(0)
Mvaa 252,220,76
s_barrier
Mvaa 128,224,80
Mvaa 160,224,84
s_add_u32 m0, s44, 32768
Ta 192,16,49152
Ta 194,16,50176
Mvaa 192,224,88
buffer_load_dwordx4 v8, s[8:11], s48 offen offset:0 lds
Mvaa 224,224,92
Mvaa 132,228,80
Ta 196,17,49152
Ta 198,17,50176
Mvaa 164,228,84
Mvaa 196,228,88
buffer_load_dwordx4 v8, s[8:11], s49 offen offset:1024 lds
Mvaa 228,228,92
Ta 200,18,49152
Ta 202,18,50176
Mvaa 136,232,80
Mvaa 168,232,84
Mvaa 200,232,88
Ta 204,19,49152
Ta 206,19,50176
Mvaa 232,232,92
buffer_load_dwordx4 a[32:35], v10, s[20:23], s53 offen offset:0 sc1
Mvaa 140,236,80
buffer_store_dwordx4 v[112:115], v2, s[24:27], s59 offen offset:2048 sc1
Mvaa 172,236,84
Ta 208,20,49152
Ta 210,20,50176
Mvaa 204,236,88
Mvaa 236,236,92
Mvaa 144,240,80
s_waitcnt lgkmcnt(6)
Ta 212,21,49152
Ta 214,21,50176
Mvaa 176,240,84
buffer_load_dwordx4 a[36:39], v10, s[20:23], s52 offen offset:0 sc1
Mvaa 208,240,88
Mvaa 240,240,92
Ta 216,22,49152
Ta 218,22,50176
Mvaa 148,244,80
Mvaa 180,244,84
buffer_load_dwordx4 a[40:43], v11, s[20:23], s53 offen offset:0 sc1
Mvaa 212,244,88
Ta 220,23,49152
Ta 222,23,50176
Mvaa 244,244,92
Mvaa 152,248,80
Mvaa 184,248,84
buffer_load_dwordx4 a[44:47], v11, s[20:23], s52 offen offset:0 sc1
Mvaa 216,248,88
Mvaa 248,248,92
Mvaa 156,252,80
Mvaa 188,252,84
Mvaa 220,252,88
s_waitcnt vmcnt(29) lgkmcnt(0)
Mvaa 252,252,92
Mvaa 128,192,96
Mvaa 160,192,100
Ta 224,16,57344
Ta 226,16,58368
Mvaa 192,192,104
buffer_load_dwordx4 v9, s[8:11], s50 offen offset:2048 lds
Mvaa 224,192,108
Mvaa 132,196,96
Ta 228,17,57344
Ta 230,17,58368
Mvaa 164,196,100
Mvaa 196,196,104
buffer_load_dwordx4 v9, s[8:11], s51 offen offset:3072 lds
Mvaa 228,196,108
Ta 232,18,57344
Ta 234,18,58368
Mvaa 136,200,96
v_xor_b32 v8, 524288, v8
v_xor_b32 v9, 524288, v9
Mvaa 168,200,100
buffer_store_dwordx4 v[116:119], v2, s[24:27], s59 offen offset:3072 sc1
Mvaa 200,200,104
Ta 236,19,57344
Ta 238,19,58368
Mvaa 232,200,108
buffer_load_dwordx4 a[48:51], v10, s[20:23], s53 offen offset:1024 sc1
Mvaa 140,204,96
Mvaa 172,204,100
Ta 240,20,57344
Ta 242,20,58368
Mvaa 204,204,104
Mvaa 236,204,108
Mvaa 144,208,96
s_waitcnt lgkmcnt(6)
Ta 244,21,57344
Ta 246,21,58368
Mvaa 176,208,100
buffer_load_dwordx4 a[52:55], v10, s[20:23], s52 offen offset:1024 sc1
Mvaa 208,208,104
Mvaa 240,208,108
Ta 248,22,57344
Ta 250,22,58368
Mvaa 148,212,96
Mvaa 180,212,100
buffer_load_dwordx4 a[56:59], v11, s[20:23], s53 offen offset:1024 sc1
Mvaa 212,212,104
Ta 252,23,57344
Ta 254,23,58368
Mvaa 244,212,108
Mvaa 152,216,96
Mvaa 184,216,100
buffer_load_dwordx4 a[60:63], v11, s[20:23], s52 offen offset:1024 sc1
Mvaa 216,216,104
s_xor_b32 s52, s52, 6144
s_add_u32 s53, s52, s58
Mvaa 248,216,108
Mvaa 156,220,96
Mvaa 188,220,100
Mvaa 220,220,104
s_waitcnt vmcnt(29) lgkmcnt(0)
Mvaa 252,220,108
s_barrier
Mvaa 128,224,112
s_add_u32 s59, s38, 43008
Mvaa 160,224,116
s_add_u32 m0, s44, 49152
Ta 192,16,0
Ta 194,16,1024
Mvaa 192,224,120
buffer_load_dwordx4 v8, s[8:11], s48 offen offset:0 lds
Mvaa 224,224,124
buffer_store_dwordx4 v[120:123], v2, s[24:27], s59 offen offset:0 sc1
Mvaa 132,228,112
Ta 196,17,0
Ta 198,17,1024
Mvaa 164,228,116
ds_read_b64 v[56:57], v13 offset:0
ds_read_b64 v[58:59], v13 offset:512
Mvaa 196,228,120
buffer_load_dwordx4 v8, s[8:11], s49 offen offset:1024 lds
Mvaa 228,228,124
Ta 200,18,0
Ta 202,18,1024
Mvaa 136,232,112
ds_read_b64 v[60:61], v13 offset:1024
ds_read_b64 v[62:63], v13 offset:1536
Mvaa 168,232,116
Mvaa 200,232,120
Ta 204,19,0
Ta 206,19,1024
Mvaa 232,232,124
buffer_load_dwordx4 a[64:67], v10, s[20:23], s53 offen offset:0 sc1
Mvaa 140,236,112
s_waitcnt lgkmcnt(2)
v_max_u32 v14, v56, v57
v_min_u32 v15, v56, v57
Mvaa 172,236,116
Ta 208,20,0
Ta 210,20,1024
Mvaa 204,236,120
v_med3_u32 v15, v14, v15, v58
v_max_u32_e64 v14, v14, v58
Mvaa 236,236,124
v_med3_u32 v15, v14, v15, v59
v_max_u32_e64 v14, v14, v59
Mvaa 144,240,112
s_waitcnt lgkmcnt(6)
Ta 212,21,0
Ta 214,21,1024
Mvaa 176,240,116
buffer_load_dwordx4 a[68:71], v10, s[20:23], s52 offen offset:0 sc1
Mvaa 208,240,120
v_med3_u32 v15, v14, v15, v60
v_max_u32 v14, v14, v60
Mvaa 240,240,124
Ta 216,22,0
Ta 218,22,1024
Mvaa 148,244,112
v_med3_u32 v15, v14, v15, v61
v_max_u32_e64 v14, v14, v61
Mvaa 180,244,116
buffer_load_dwordx4 a[72:75], v11, s[20:23], s53 offen offset:0 sc1
Mvaa 212,244,120
Ta 220,23,0
Ta 222,23,1024
Mvaa 244,244,124
v_med3_u32 v15, v14, v15, v62
v_max_u32_e64 v14, v14, v62
Mvaa 152,248,112
v_med3_u32 v15, v14, v15, v63
v_max_u32_e64 v14, v14, v63
Mvaa 184,248,116
buffer_load_dwordx4 a[76:79], v11, s[20:23], s52 offen offset:0 sc1
Mvaa 216,248,120
v_mov_b32_e64 v13, v14
Mvaa 248,248,124
buffer_store_dwordx4 v[124:127], v2, s[24:27], s59 offen offset:1024 sc1
Mvaa 156,252,112
v_max_u32_dpp v13, v13, v13 quad_perm:[1,0,3,2] row_mask:0xf bank_mask:0xf
Mvaa 188,252,116
Mvaa 220,252,120
s_waitcnt vmcnt(29) lgkmcnt(0)
Mvaa 252,252,124
Mvaa 128,192,0
v_max_u32_dpp v13, v13, v13 quad_perm:[2,3,0,1] row_mask:0xf bank_mask:0xf
Mvaa 160,192,4
Ta 224,16,8192
Ta 226,16,9216
Mvaa 192,192,8
buffer_load_dwordx4 v9, s[8:11], s50 offen offset:2048 lds
Mvaa 224,192,12
v_max_u32_dpp v13, v13, v13 row_half_mirror row_mask:0xf bank_mask:0xf
Mvaa 132,196,0
Ta 228,17,8192
Ta 230,17,9216
Mvaa 164,196,4
v_max_u32_dpp v13, v13, v13 row_mirror row_mask:0xf bank_mask:0xf
Mvaa 196,196,8
buffer_load_dwordx4 v9, s[8:11], s51 offen offset:3072 lds
Mvaa 228,196,12
Ta 232,18,8192
Ta 234,18,9216
Mvaa 136,200,0
v_xor_b32 v8, 3670016, v8
v_xor_b32 v9, 3670016, v9
Mvaa 168,200,4
v_readlane_b32 s3, v13, 0
v_readlane_b32 s47, v13, 16
Mvaa 200,200,8
Ta 236,19,8192
Ta 238,19,9216
Mvaa 232,200,12
buffer_load_dwordx4 a[80:83], v10, s[20:23], s53 offen offset:1024 sc1
Mvaa 140,204,0
v_readlane_b32 s4, v13, 32
v_readlane_b32 s5, v13, 48
Mvaa 172,204,4
Ta 240,20,8192
Ta 242,20,9216
Mvaa 204,204,8
s_max_u32 s3, s3, s47
s_max_u32 s4, s4, s5
s_max_u32 s40, s3, s4
Mvaa 236,204,12
v_cmp_eq_u32 vcc, s40, v14
Mvaa 144,208,0
s_waitcnt lgkmcnt(6)
Ta 244,21,8192
Ta 246,21,9216
Mvaa 176,208,4
buffer_load_dwordx4 a[84:87], v10, s[20:23], s52 offen offset:1024 sc1
Mvaa 208,208,8
v_cndmask_b32 v13, v14, v15, vcc
Mvaa 240,208,12
Ta 248,22,8192
Ta 250,22,9216
Mvaa 148,212,0
v_max_u32_dpp v13, v13, v13 quad_perm:[1,0,3,2] row_mask:0xf bank_mask:0xf
Mvaa 180,212,4
buffer_load_dwordx4 a[88:91], v11, s[20:23], s53 offen offset:1024 sc1
Mvaa 212,212,8
Ta 252,23,8192
Ta 254,23,9216
Mvaa 244,212,12
buffer_store_dwordx4 v[24:27], v2, s[24:27], s59 offen offset:2048 sc1
Mvaa 152,216,0
v_max_u32_dpp v13, v13, v13 quad_perm:[2,3,0,1] row_mask:0xf bank_mask:0xf
Mvaa 184,216,4
buffer_load_dwordx4 a[92:95], v11, s[20:23], s52 offen offset:1024 sc1
Mvaa 216,216,8
s_xor_b32 s52, s52, 2048
s_add_u32 s53, s52, s58
Mvaa 248,216,12
v_max_u32_dpp v13, v13, v13 row_half_mirror row_mask:0xf bank_mask:0xf
Mvaa 156,220,0
s_nop 0
v_max_u32_dpp v13, v13, v13 row_mirror row_mask:0xf bank_mask:0xf
Mvaa 188,220,4
Mvaa 220,220,8
s_waitcnt vmcnt(29) lgkmcnt(0)
Mvaa 252,220,12
s_barrier
Mvaa 128,224,16
v_readlane_b32 s3, v13, 0
v_readlane_b32 s47, v13, 16
Mvaa 160,224,20
s_add_u32 m0, s44, 0
Ta 192,16,16384
Ta 194,16,17408
Mvaa 192,224,24
buffer_load_dwordx4 v8, s[8:11], s48 offen offset:0 lds
Mvaa 224,224,28
v_readlane_b32 s4, v13, 32
v_readlane_b32 s5, v13, 48
Mvaa 132,228,16
Ta 196,17,16384
Ta 198,17,17408
Mvaa 164,228,20
s_max_u32 s3, s3, s47
s_max_u32 s4, s4, s5
s_max_u32 s41, s3, s4
Mvaa 196,228,24
buffer_load_dwordx4 v8, s[8:11], s49 offen offset:1024 lds
Mvaa 228,228,28
Ta 200,18,16384
Ta 202,18,17408
Mvaa 136,232,16
s_and_b32 s3, s40, 0xffff
s_sub_u32 s42, 0xffff, s3
s_and_b32 s3, s41, 0xffff
Mvaa 168,232,20
s_sub_u32 s43, 0xffff, s3
v_mov_b32 v60, s40
v_not_b32_e64 v61, v60
Mvaa 200,232,24
Ta 204,19,16384
Ta 206,19,17408
Mvaa 232,232,28
buffer_load_dwordx4 a[96:99], v10, s[20:23], s53 offen offset:0 sc1
Mvaa 140,236,16
v_ashrrev_i32_e64 v61, 31, v61
v_or_b32 v61, 0x80000000, v61
Mvaa 172,236,20
Ta 208,20,16384
Ta 210,20,17408
Mvaa 204,236,24
v_xor_b32_e64 v60, v60, v61
v_and_b32 v60, 0xffff0000, v60
Mvaa 236,236,28
v_mul_f32 v60, 0xbfb8aa3b, v60
Mvaa 144,240,16
s_waitcnt lgkmcnt(6)
Ta 212,21,16384
Ta 214,21,17408
Mvaa 176,240,20
buffer_load_dwordx4 a[100:103], v10, s[20:23], s52 offen offset:0 sc1
Mvaa 208,240,24
buffer_store_dwordx4 v[28:31], v2, s[24:27], s59 offen offset:3072 sc1
Mvaa 240,240,28
Ta 216,22,16384
Ta 218,22,17408
Mvaa 148,244,16
Ve 60,60
Mvaa 180,244,20
buffer_load_dwordx4 a[104:107], v11, s[20:23], s53 offen offset:0 sc1
Mvaa 212,244,24
Ta 220,23,16384
Ta 222,23,17408
Mvaa 244,244,28
v_add_f32_e64 v60, 1.0, v60
Mvaa 152,248,16
v_rcp_f32_e64 v60, v60
Mvaa 184,248,20
buffer_load_dwordx4 a[108:111], v11, s[20:23], s52 offen offset:0 sc1
Mvaa 216,248,24
Vc 60,60,60
v_and_b32 v64, 0xffff0000, v60
Mvaa 248,248,28
v_mov_b32 v60, s41
v_not_b32 v61, v60
Mvaa 156,252,16
v_ashrrev_i32_e64 v61, 31, v61
v_or_b32 v61, 0x80000000, v61
Mvaa 188,252,20
v_xor_b32_e64 v60, v60, v61
v_and_b32 v60, 0xffff0000, v60
Mvaa 220,252,24
s_waitcnt vmcnt(29) lgkmcnt(0)
v_mul_f32 v60, 0xbfb8aa3b, v60
Mvaa 252,252,28
Ve 60,60
Mvaa 128,192,32
v_add_f32_e64 v60, 1.0, v60
Mvaa 160,192,36
Ta 224,16,24576
Ta 226,16,25600
Mvaa 192,192,40
buffer_load_dwordx4 v9, s[8:11], s50 offen offset:2048 lds
Mvaa 224,192,44
v_rcp_f32_e64 v60, v60
Mvaa 132,196,32
Ta 228,17,24576
Ta 230,17,25600
Mvaa 164,196,36
Vc 60,60,60
v_and_b32 v65, 0xffff0000, v60
Mvaa 196,196,40
buffer_load_dwordx4 v9, s[8:11], s51 offen offset:3072 lds
Mvaa 228,196,44
Ta 232,18,24576
Ta 234,18,25600
Mvaa 136,200,32
v_xor_b32 v8, 524288, v8
v_xor_b32 v9, 524288, v9
Mvaa 168,200,36
v_mov_b32 v48, 0
v_mov_b32 v49, 0
Mvaa 200,200,40
Ta 236,19,24576
Ta 238,19,25600
Mvaa 232,200,44
buffer_load_dwordx4 a[112:115], v10, s[20:23], s53 offen offset:1024 sc1
Mvaa 140,204,32
s_add_u32 s59, s38, 47104
Mvaa 172,204,36
Ta 240,20,24576
Ta 242,20,25600
Mvaa 204,204,40
buffer_store_dwordx4 v[32:35], v2, s[24:27], s59 offen offset:0 sc1
Mvaa 236,204,44
v_mov_b32 v50, 0
v_mov_b32 v51, 0
Mvaa 144,208,32
s_waitcnt lgkmcnt(6)
Ta 244,21,24576
Ta 246,21,25600
Mvaa 176,208,36
buffer_load_dwordx4 a[116:119], v10, s[20:23], s52 offen offset:1024 sc1
Mvaa 208,208,40
v_mov_b32 v52, 0
v_mov_b32_e64 v53, 0
Mvaa 240,208,44
Ta 248,22,24576
Ta 250,22,25600
Mvaa 148,212,32
v_mov_b32 v54, 0
v_mov_b32 v55, 0
Mvaa 180,212,36
buffer_load_dwordx4 a[120:123], v11, s[20:23], s53 offen offset:1024 sc1
Mvaa 212,212,40
Ta 252,23,24576
Ta 254,23,25600
Mvaa 244,212,44
v_mov_b32 v56, 0
v_mov_b32 v57, 0
Mvaa 152,216,32
v_mov_b32 v58, 0
v_mov_b32 v59, 0
Mvaa 184,216,36
buffer_load_dwordx4 a[124:127], v11, s[20:23], s52 offen offset:1024 sc1
Mvaa 216,216,40
s_xor_b32 s52, s52, 14336
s_add_u32 s53, s52, s58
Mvaa 248,216,44
v_mov_b32 v60, 0
v_mov_b32_e64 v61, 0
Mvaa 156,220,32
v_mov_b32 v62, 0
v_mov_b32 v63, 0
Mvaa 188,220,36
Mvaa 220,220,40
s_waitcnt vmcnt(29) lgkmcnt(0)
Mvaa 252,220,44
s_barrier
Mvaa 128,224,48
s_mul_i32 s3, s34, s34
s_mul_i32 s47, s33, 48
s_add_u32 s3, s3, s47
Mvaa 160,224,52
s_add_u32 m0, s44, 16384
Ta 192,16,32768
Ta 194,16,33792
Mvaa 192,224,56
buffer_load_dwordx4 v8, s[8:11], s48 offen offset:0 lds
Mvaa 224,224,60
s_lshl_b32 s3, s3, 2
s_add_u32 s3, s3, s32
s_lshl_b32 s3, s3, 7
Mvaa 132,228,48
Ta 196,17,32768
Ta 198,17,33792
Mvaa 164,228,52
s_sub_u32 s3, s3, 8704
s_cmp_ge_u32 s34, 4
s_cselect_b32 s3, s3, 0
s_cselect_b32 s40, 512, 0
s_cselect_b32 s47, 786432, 0
Mvaa 196,228,56
buffer_load_dwordx4 v8, s[8:11], s49 offen offset:1024 lds
Mvaa 228,228,60
Ta 200,18,32768
Ta 202,18,33792
Mvaa 136,232,48
buffer_store_dwordx4 v[36:39], v2, s[24:27], s59 offen offset:1024 sc1
Mvaa 168,232,52
v_subrev_u32_e64 v31, 0, v0
v_mul_lo_u32 v31, v31, s47
Mvaa 200,232,56
Ta 204,19,32768
Ta 206,19,33792
Mvaa 232,232,60
buffer_load_dwordx4 a[0:3], v10, s[20:23], s53 offen offset:0 sc1
Mvaa 140,236,48
v_min_u32 v31, 6553600, v31
v_mov_b32_e64 v28, s94
Mvaa 172,236,52
Ta 208,20,32768
Ta 210,20,33792
Mvaa 204,236,56
v_mov_b32 v29, s95
v_mov_b32 v30, v31
Mvaa 236,236,60
v_subrev_u32_e64 v31, 10, v0
v_mul_lo_u32 v31, v31, s47
Mvaa 144,240,48
s_waitcnt lgkmcnt(6)
Ta 212,21,32768
Ta 214,21,33792
Mvaa 176,240,52
buffer_load_dwordx4 a[4:7], v10, s[20:23], s52 offen offset:0 sc1
Mvaa 208,240,56
v_min_u32 v31, 6553600, v31
v_mov_b32 v14, s60
Mvaa 240,240,60
Ta 216,22,32768
Ta 218,22,33792
Mvaa 148,244,48
v_mov_b32_e64 v15, s61
Mvaa 180,244,52
buffer_load_dwordx4 a[8:11], v11, s[20:23], s53 offen offset:0 sc1
Mvaa 212,244,56
Ta 220,23,32768
Ta 222,23,33792
Mvaa 244,244,60
v_cmp_le_u32 vcc, 10, v0
Mvaa 152,248,48
s_nop 0
v_cndmask_b32 v28, v28, v14, vcc
v_cndmask_b32 v29, v29, v15, vcc
Mvaa 184,248,52
buffer_load_dwordx4 a[12:15], v11, s[20:23], s52 offen offset:0 sc1
Mvaa 216,248,56
v_cndmask_b32 v30, v30, v31, vcc
Mvaa 248,248,60
v_subrev_u32 v31, 20, v0
v_mul_lo_u32 v31, v31, s47
Mvaa 156,252,48
v_min_u32 v31, 6553600, v31
v_mov_b32_e64 v14, s68
Mvaa 188,252,52
v_mov_b32_e64 v15, s69
Mvaa 220,252,56
s_waitcnt vmcnt(29) lgkmcnt(0)
Mvaa 252,252,60
Mvaa 128,192,64
buffer_store_dwordx4 v[40:43], v2, s[24:27], s59 offen offset:2048 sc1
Mvaa 160,192,68
Ta 224,16,40960
Ta 226,16,41984
Mvaa 192,192,72
buffer_load_dwordx4 v9, s[8:11], s50 offen offset:2048 lds
Mvaa 224,192,76
v_cmp_le_u32 vcc, 20, v0
Mvaa 132,196,64
Ta 228,17,40960
Ta 230,17,41984
Mvaa 164,196,68
v_cndmask_b32 v28, v28, v14, vcc
v_cndmask_b32 v29, v29, v15, vcc
Mvaa 196,196,72
buffer_load_dwordx4 v9, s[8:11], s51 offen offset:3072 lds
Mvaa 228,196,76
Ta 232,18,40960
Ta 234,18,41984
Mvaa 136,200,64
v_xor_b32 v8, 1572864, v8
v_xor_b32 v9, 1572864, v9
Mvaa 168,200,68
v_cndmask_b32 v30, v30, v31, vcc
Mvaa 200,200,72
Ta 236,19,40960
Ta 238,19,41984
Mvaa 232,200,76
buffer_load_dwordx4 a[16:19], v10, s[20:23], s53 offen offset:1024 sc1
Mvaa 140,204,64
v_subrev_u32 v31, 30, v0
v_mul_lo_u32 v31, v31, s47
Mvaa 172,204,68
Ta 240,20,40960
Ta 242,20,41984
Mvaa 204,204,72
v_min_u32 v31, 7602176, v31
v_mov_b32_e64 v14, s92
Mvaa 236,204,76
v_mov_b32_e64 v15, s93
Mvaa 144,208,64
s_waitcnt lgkmcnt(6)
Ta 244,21,40960
Ta 246,21,41984
Mvaa 176,208,68
buffer_load_dwordx4 a[20:23], v10, s[20:23], s52 offen offset:1024 sc1
Mvaa 208,208,72
v_cmp_le_u32 vcc, 30, v0
Mvaa 240,208,76
Ta 248,22,40960
Ta 250,22,41984
Mvaa 148,212,64
v_cndmask_b32 v28, v28, v14, vcc
v_cndmask_b32 v29, v29, v15, vcc
Mvaa 180,212,68
buffer_load_dwordx4 a[24:27], v11, s[20:23], s53 offen offset:1024 sc1
Mvaa 212,212,72
Ta 252,23,40960
Ta 254,23,41984
Mvaa 244,212,76
v_cndmask_b32 v30, v30, v31, vcc
Mvaa 152,216,64
v_add_u32 v30, s3, v30
v_ashrrev_i32_e64 v31, 31, v30
Mvaa 184,216,68
buffer_load_dwordx4 a[28:31], v11, s[20:23], s52 offen offset:1024 sc1
Mvaa 216,216,72
s_xor_b32 s52, s52, 2048
s_add_u32 s53, s52, s58
Mvaa 248,216,76
buffer_store_dwordx4 v[44:47], v2, s[24:27], s59 offen offset:3072 sc1
Mvaa 156,220,64
v_mov_b32 v12, 1
v_and_b32_e64 v1, 15, v0
Mvaa 188,220,68
v_lshlrev_b32_e64 v1, 2, v1
Mvaa 220,220,72
s_waitcnt vmcnt(29) lgkmcnt(0)
v_lshl_add_u64 v[28:29], v[30:31], 0, v[28:29]
Mvaa 252,220,76
s_barrier
Mvaa 128,224,80
s_lshr_b32 s6, s33, 1
s_lshl_b32 s6, s6, 7
s_add_u32 s6, s6, 5296128
Mvaa 160,224,84
s_add_u32 m0, s44, 32768
Ta 192,16,49152
Ta 194,16,50176
Mvaa 192,224,88
buffer_load_dwordx4 v8, s[8:11], s48 offen offset:0 lds
Mvaa 224,224,92
s_cmp_eq_u32 s32, 0
s_cselect_b32 s6, s6, 2146435072
Mvaa 132,228,80
Ta 196,17,49152
Ta 198,17,50176
Mvaa 164,228,84
s_mov_b32 s41, 0
v_readfirstlane_b32 s100, v64
v_readfirstlane_b32 s101, v65
Mvaa 196,228,88
buffer_load_dwordx4 v8, s[8:11], s49 offen offset:1024 lds
Mvaa 228,228,92
Ta 200,18,49152
Ta 202,18,50176
Mvaa 136,232,80
Mvaa 168,232,84
Mvaa 200,232,88
Ta 204,19,49152
Ta 206,19,50176
Mvaa 232,232,92
buffer_load_dwordx4 a[32:35], v10, s[20:23], s53 offen offset:0 sc1
Mvaa 140,236,80
Mvaa 172,236,84
Ta 208,20,49152
Ta 210,20,50176
Mvaa 204,236,88
Mvaa 236,236,92
Mvaa 144,240,80
s_waitcnt lgkmcnt(6)
Ta 212,21,49152
Ta 214,21,50176
Mvaa 176,240,84
buffer_load_dwordx4 a[36:39], v10, s[20:23], s52 offen offset:0 sc1
Mvaa 208,240,88
Mvaa 240,240,92
Ta 216,22,49152
Ta 218,22,50176
Mvaa 148,244,80
Mvaa 180,244,84
buffer_load_dwordx4 a[40:43], v11, s[20:23], s53 offen offset:0 sc1
Mvaa 212,244,88
Ta 220,23,49152
Ta 222,23,50176
Mvaa 244,244,92
Mvaa 152,248,80
Mvaa 184,248,84
buffer_load_dwordx4 a[44:47], v11, s[20:23], s52 offen offset:0 sc1
Mvaa 216,248,88
Mvaa 248,248,92
Mvaa 156,252,80
Mvaa 188,252,84
Mvaa 220,252,88
s_waitcnt vmcnt(28) lgkmcnt(0)
Mvaa 252,252,92
Mvaa 128,192,96
Mvaa 160,192,100
Ta 224,16,57344
Ta 226,16,58368
Mvaa 192,192,104
buffer_load_dwordx4 v9, s[8:11], s50 offen offset:2048 lds
Mvaa 224,192,108
Mvaa 132,196,96
Ta 228,17,57344
Ta 230,17,58368
Mvaa 164,196,100
Mvaa 196,196,104
buffer_load_dwordx4 v9, s[8:11], s51 offen offset:3072 lds
Mvaa 228,196,108
Ta 232,18,57344
Ta 234,18,58368
Mvaa 136,200,96
v_xor_b32 v8, 524288, v8
v_xor_b32 v9, 524288, v9
Mvaa 168,200,100
Mvaa 200,200,104
Ta 236,19,57344
Ta 238,19,58368
Mvaa 232,200,108
buffer_load_dwordx4 a[48:51], v10, s[20:23], s53 offen offset:1024 sc1
Mvaa 140,204,96
Mvaa 172,204,100
Ta 240,20,57344
Ta 242,20,58368
Mvaa 204,204,104
Mvaa 236,204,108
Mvaa 144,208,96
s_waitcnt lgkmcnt(6)
Ta 244,21,57344
Ta 246,21,58368
Mvaa 176,208,100
buffer_load_dwordx4 a[52:55], v10, s[20:23], s52 offen offset:1024 sc1
Mvaa 208,208,104
Mvaa 240,208,108
Ta 248,22,57344
Ta 250,22,58368
Mvaa 148,212,96
Mvaa 180,212,100
buffer_load_dwordx4 a[56:59], v11, s[20:23], s53 offen offset:1024 sc1
Mvaa 212,212,104
Ta 252,23,57344
Ta 254,23,58368
Mvaa 244,212,108
Mvaa 152,216,96
Mvaa 184,216,100
buffer_load_dwordx4 a[60:63], v11, s[20:23], s52 offen offset:1024 sc1
Mvaa 216,216,104
s_xor_b32 s52, s52, 6144
s_add_u32 s53, s52, s58
Mvaa 248,216,108
Mvaa 156,220,96
Mvaa 188,220,100
Mvaa 220,220,104
s_waitcnt vmcnt(27) lgkmcnt(0)
Mvaa 252,220,108
s_barrier
Mvaa 128,224,112
Mvaa 160,224,116
s_add_u32 m0, s44, 49152
Ta 192,16,0
Ta 194,16,1024
Mvaa 192,224,120
buffer_load_dwordx4 v8, s[8:11], s48 offen offset:0 lds
Mvaa 224,224,124
Mvaa 132,228,112
Ta 196,17,0
Ta 198,17,1024
Mvaa 164,228,116
Mvaa 196,228,120
buffer_load_dwordx4 v8, s[8:11], s49 offen offset:1024 lds
Mvaa 228,228,124
Ta 200,18,0
Ta 202,18,1024
Mvaa 136,232,112
Mvaa 168,232,116
Mvaa 200,232,120
Ta 204,19,0
Ta 206,19,1024
Mvaa 232,232,124
buffer_load_dwordx4 a[64:67], v10, s[20:23], s53 offen offset:0 sc1
Mvaa 140,236,112
Mvaa 172,236,116
Ta 208,20,0
Ta 210,20,1024
Mvaa 204,236,120
Mvaa 236,236,124
Mvaa 144,240,112
s_waitcnt lgkmcnt(6)
Ta 212,21,0
Ta 214,21,1024
Mvaa 176,240,116
buffer_load_dwordx4 a[68:71], v10, s[20:23], s52 offen offset:0 sc1
Mvaa 208,240,120
Mvaa 240,240,124
Ta 216,22,0
Ta 218,22,1024
Mvaa 148,244,112
Mvaa 180,244,116
buffer_load_dwordx4 a[72:75], v11, s[20:23], s53 offen offset:0 sc1
Mvaa 212,244,120
Ta 220,23,0
Ta 222,23,1024
Mvaa 244,244,124
Mvaa 152,248,112
Mvaa 184,248,116
buffer_load_dwordx4 a[76:79], v11, s[20:23], s52 offen offset:0 sc1
Mvaa 216,248,120
Mvaa 248,248,124
Mvaa 156,252,112
Mvaa 188,252,116
Mvaa 220,252,120
s_waitcnt vmcnt(26) lgkmcnt(0)
Mvaa 252,252,124
Mvaa 128,192,0
Mvaa 160,192,4
Ta 224,16,8192
Ta 226,16,9216
Mvaa 192,192,8
buffer_load_dwordx4 v9, s[8:11], s50 offen offset:2048 lds
Mvaa 224,192,12
Mvaa 132,196,0
Ta 228,17,8192
Ta 230,17,9216
Mvaa 164,196,4
Mvaa 196,196,8
buffer_load_dwordx4 v9, s[8:11], s51 offen offset:3072 lds
Mvaa 228,196,12
Ta 232,18,8192
Ta 234,18,9216
Mvaa 136,200,0
v_xor_b32 v8, 7864320, v8
v_xor_b32 v9, 7864320, v9
Mvaa 168,200,4
Mvaa 200,200,8
Ta 236,19,8192
Ta 238,19,9216
Mvaa 232,200,12
buffer_load_dwordx4 a[80:83], v10, s[20:23], s53 offen offset:1024 sc1
Mvaa 140,204,0
Mvaa 172,204,4
Ta 240,20,8192
Ta 242,20,9216
Mvaa 204,204,8
Mvaa 236,204,12
Mvaa 144,208,0
s_waitcnt lgkmcnt(6)
Ta 244,21,8192
Ta 246,21,9216
Mvaa 176,208,4
buffer_load_dwordx4 a[84:87], v10, s[20:23], s52 offen offset:1024 sc1
Mvaa 208,208,8
Mvaa 240,208,12
Ta 248,22,8192
Ta 250,22,9216
Mvaa 148,212,0
Mvaa 180,212,4
buffer_load_dwordx4 a[88:91], v11, s[20:23], s53 offen offset:1024 sc1
Mvaa 212,212,8
Ta 252,23,8192
Ta 254,23,9216
Mvaa 244,212,12
Mvaa 152,216,0
Mvaa 184,216,4
buffer_load_dwordx4 a[92:95], v11, s[20:23], s52 offen offset:1024 sc1
Mvaa 216,216,8
s_xor_b32 s52, s52, 2048
s_add_u32 s53, s52, s58
Mvaa 248,216,12
Mvaa 156,220,0
Mvaa 188,220,4
Mvaa 220,220,8
s_waitcnt vmcnt(24) lgkmcnt(0)
Mvaa 252,220,12
s_barrier
Mvaa 128,224,16
s_mov_b64 exec, 1
buffer_store_dword v12, v7, s[20:23], s39 offen sc1
s_mov_b64 exec, -1
Mvaa 160,224,20
Ta 192,16,16384
Ta 194,16,17408
Mvaa 192,224,24
buffer_load_dwordx4 a[96:99], v10, s[20:23], s53 offen offset:0 sc1
Mvaa 224,224,28
s_mov_b32 s24, s60
s_mov_b32 s25, s61
s_mov_b32 s26, s62
Mvaa 132,228,16
Ta 196,17,16384
Ta 198,17,17408
Mvaa 164,228,20
s_mov_b32 s94, 1040356334
s_mov_b32 s95, 1040356334
s_sub_u32 s55, 15, s34
Mvaa 196,228,24
s_sub_u32 s45, s36, 3
s_sub_u32 s46, s35, 3
s_mov_b32 s54, s44
Mvaa 228,228,28
Ta 200,18,16384
Ta 202,18,17408
Mvaa 136,232,16
s_sub_u32 s35, s35, 2
s_sub_u32 s36, s36, 2
v_accvgpr_write_b32 a0, 0
Mvaa 168,232,20
buffer_load_dwordx4 a[100:103], v10, s[20:23], s52 offen offset:0 sc1
Mvaa 200,232,24
Ta 204,19,16384
Ta 206,19,17408
Mvaa 232,232,28
v_accvgpr_write_b32 a1, 0
v_accvgpr_write_b32 a2, 0
Mvaa 140,236,16
v_accvgpr_write_b32 a3, 0
v_accvgpr_write_b32 a4, 0
Mvaa 172,236,20
Ta 208,20,16384
Ta 210,20,17408
Mvaa 204,236,24
v_accvgpr_write_b32 a5, 0
v_accvgpr_write_b32 a6, 0
Mvaa 236,236,28
v_accvgpr_write_b32 a7, 0
v_accvgpr_write_b32 a8, 0
Mvaa 144,240,16
s_waitcnt lgkmcnt(6)
Ta 212,21,16384
Ta 214,21,17408
Mvaa 176,240,20
buffer_load_dwordx4 a[104:107], v11, s[20:23], s53 offen offset:0 sc1
Mvaa 208,240,24
v_accvgpr_write_b32 a9, 0
v_accvgpr_write_b32 a10, 0
Mvaa 240,240,28
Ta 216,22,16384
Ta 218,22,17408
Mvaa 148,244,16
v_accvgpr_write_b32 a11, 0
v_accvgpr_write_b32 a12, 0
Mvaa 180,244,20
v_accvgpr_write_b32 a13, 0
v_accvgpr_write_b32 a14, 0
Mvaa 212,244,24
Ta 220,23,16384
Ta 222,23,17408
Mvaa 244,244,28
v_accvgpr_write_b32 a15, 0
Mvaa 152,248,16
buffer_load_dwordx4 a[108:111], v11, s[20:23], s52 offen offset:0 sc1
Mvaa 184,248,20
Mvaa 216,248,24
Mvaa 248,248,28
Mvaa 156,252,16
Mvaa 188,252,20
Mvaa 220,252,24
s_waitcnt vmcnt(23) lgkmcnt(0)
Mvaa 252,252,28
Mvaa 128,192,32
v_accvgpr_write_b32 a16, 0
v_accvgpr_write_b32 a17, 0
Mvaa 160,192,36
Ta 224,16,24576
Ta 226,16,25600
Mvaa 192,192,40
buffer_load_dwordx4 a[112:115], v10, s[20:23], s53 offen offset:1024 sc1
Mvaa 224,192,44
v_accvgpr_write_b32 a18, 0
v_accvgpr_write_b32 a19, 0
Mvaa 132,196,32
Ta 228,17,24576
Ta 230,17,25600
Mvaa 164,196,36
v_accvgpr_write_b32 a20, 0
v_accvgpr_write_b32 a21, 0
Mvaa 196,196,40
v_accvgpr_write_b32 a22, 0
v_accvgpr_write_b32 a23, 0
Mvaa 228,196,44
Ta 232,18,24576
Ta 234,18,25600
Mvaa 136,200,32
v_accvgpr_write_b32 a24, 0
v_accvgpr_write_b32 a25, 0
Mvaa 168,200,36
buffer_load_dwordx4 a[116:119], v10, s[20:23], s52 offen offset:1024 sc1
Mvaa 200,200,40
Ta 236,19,24576
Ta 238,19,25600
Mvaa 232,200,44
v_accvgpr_write_b32 a26, 0
v_accvgpr_write_b32 a27, 0
Mvaa 140,204,32
v_accvgpr_write_b32 a28, 0
v_accvgpr_write_b32 a29, 0
Mvaa 172,204,36
Ta 240,20,24576
Ta 242,20,25600
Mvaa 204,204,40
v_accvgpr_write_b32 a30, 0
v_accvgpr_write_b32 a31, 0
Mvaa 236,204,44
Mvaa 144,208,32
s_waitcnt lgkmcnt(6)
Ta 244,21,24576
Ta 246,21,25600
Mvaa 176,208,36
buffer_load_dwordx4 a[120:123], v11, s[20:23], s53 offen offset:1024 sc1
Mvaa 208,208,40
Mvaa 240,208,44
Ta 248,22,24576
Ta 250,22,25600
Mvaa 148,212,32
Mvaa 180,212,36
Mvaa 212,212,40
Ta 252,23,24576
Ta 254,23,25600
Mvaa 244,212,44
Mvaa 152,216,32
buffer_load_dwordx4 a[124:127], v11, s[20:23], s52 offen offset:1024 sc1
Mvaa 184,216,36
Mvaa 216,216,40
Mvaa 248,216,44
Mvaa 156,220,32
Mvaa 188,220,36
Mvaa 220,220,40
s_waitcnt vmcnt(21) lgkmcnt(0)
Mvaa 252,220,44
s_barrier
Mvaa 128,224,48
v_accvgpr_write_b32 a32, 0
v_accvgpr_write_b32 a33, 0
Mvaa 160,224,52
Ta 192,16,32768
Ta 194,16,33792
Mvaa 192,224,56
v_accvgpr_write_b32 a34, 0
v_accvgpr_write_b32 a35, 0
Mvaa 224,224,60
v_accvgpr_write_b32 a36, 0
v_accvgpr_write_b32 a37, 0
Mvaa 132,228,48
Ta 196,17,32768
Ta 198,17,33792
Mvaa 164,228,52
v_accvgpr_write_b32 a38, 0
v_accvgpr_write_b32 a39, 0
Mvaa 196,228,56
v_accvgpr_write_b32 a40, 0
v_accvgpr_write_b32 a41, 0
Mvaa 228,228,60
Ta 200,18,32768
Ta 202,18,33792
Mvaa 136,232,48
v_accvgpr_write_b32 a42, 0
v_accvgpr_write_b32 a43, 0
Mvaa 168,232,52
v_accvgpr_write_b32 a44, 0
v_accvgpr_write_b32 a45, 0
Mvaa 200,232,56
Ta 204,19,32768
Ta 206,19,33792
Mvaa 232,232,60
buffer_load_dword v12, v1, s[20:23], s6 offen sc1
Mvaa 140,236,48
s_add_u32 m0, s44, 65536
s_mov_b32 s7, 0
Mvaa 172,236,52
Ta 208,20,32768
Ta 210,20,33792
Mvaa 204,236,56
v_accvgpr_write_b32 a46, 0
v_accvgpr_write_b32 a47, 0
Mvaa 236,236,60
Mvaa 144,240,48
s_waitcnt lgkmcnt(6)
Ta 212,21,32768
Ta 214,21,33792
Mvaa 176,240,52
Mvaa 208,240,56
Mvaa 240,240,60
Ta 216,22,32768
Ta 218,22,33792
Mvaa 148,244,48
Mvaa 180,244,52
Mvaa 212,244,56
Ta 220,23,32768
Ta 222,23,33792
Mvaa 244,244,60
Mvaa 152,248,48
Mvaa 184,248,52
Mvaa 216,248,56
Mvaa 248,248,60
Mvaa 156,252,48
Mvaa 188,252,52
Mvaa 220,252,56
s_waitcnt vmcnt(16) lgkmcnt(0)
Mvaa 252,252,60
Mvaa 128,192,64
v_accvgpr_write_b32 a48, 0
v_accvgpr_write_b32 a49, 0
Mvaa 160,192,68
Ta 224,16,40960
Ta 226,16,41984
Mvaa 192,192,72
v_accvgpr_write_b32 a50, 0
v_accvgpr_write_b32 a51, 0
Mvaa 224,192,76
v_accvgpr_write_b32 a52, 0
v_accvgpr_write_b32 a53, 0
Mvaa 132,196,64
Ta 228,17,40960
Ta 230,17,41984
Mvaa 164,196,68
v_accvgpr_write_b32 a54, 0
v_accvgpr_write_b32 a55, 0
Mvaa 196,196,72
v_accvgpr_write_b32 a56, 0
v_accvgpr_write_b32 a57, 0
Mvaa 228,196,76
Ta 232,18,40960
Ta 234,18,41984
Mvaa 136,200,64
v_accvgpr_write_b32 a58, 0
v_accvgpr_write_b32 a59, 0
Mvaa 168,200,68
v_accvgpr_write_b32 a60, 0
v_accvgpr_write_b32 a61, 0
Mvaa 200,200,72
Ta 236,19,40960
Ta 238,19,41984
Mvaa 232,200,76
v_accvgpr_write_b32 a62, 0
v_accvgpr_write_b32 a63, 0
Mvaa 140,204,64
Mvaa 172,204,68
Ta 240,20,40960
Ta 242,20,41984
Mvaa 204,204,72
Mvaa 236,204,76
Mvaa 144,208,64
s_waitcnt lgkmcnt(6)
Ta 244,21,40960
Ta 246,21,41984
Mvaa 176,208,68
Mvaa 208,208,72
Mvaa 240,208,76
Ta 248,22,40960
Ta 250,22,41984
Mvaa 148,212,64
Mvaa 180,212,68
Mvaa 212,212,72
Ta 252,23,40960
Ta 254,23,41984
Mvaa 244,212,76
Mvaa 152,216,64
Mvaa 184,216,68
Mvaa 216,216,72
Mvaa 248,216,76
Mvaa 156,220,64
Mvaa 188,220,68
Mvaa 220,220,72
s_waitcnt vmcnt(0) lgkmcnt(0)
Mvaa 252,220,76
s_cmp_lg_u32 s32, 0
s_cbranch_scc1 L_spinBr
v_cmp_ne_u32 vcc, 1, v12
s_cbranch_vccnz L_spinB
L_spinBr:
s_barrier
Mvaa 128,224,80
buffer_load_dwordx4 v4, s[12:15], s7 offen offset:0 sc1 lds
Mvaa 160,224,84
Ta 192,16,49152
Ta 194,16,50176
Mvaa 192,224,88
v_accvgpr_write_b32 a64, 0
v_accvgpr_write_b32 a65, 0
Mvaa 224,224,92
buffer_load_dwordx4 v4, s[12:15], s7 offen offset:1024 sc1 lds
Mvaa 132,228,80
Ta 196,17,49152
Ta 198,17,50176
Mvaa 164,228,84
v_accvgpr_write_b32 a66, 0
v_accvgpr_write_b32 a67, 0
Mvaa 196,228,88
buffer_load_dwordx4 v4, s[12:15], s7 offen offset:2048 sc1 lds
Mvaa 228,228,92
Ta 200,18,49152
Ta 202,18,50176
Mvaa 136,232,80
v_accvgpr_write_b32 a68, 0
v_accvgpr_write_b32 a69, 0
Mvaa 168,232,84
buffer_load_dwordx4 v4, s[12:15], s7 offen offset:3072 sc1 lds
Mvaa 200,232,88
Ta 204,19,49152
Ta 206,19,50176
Mvaa 232,232,92
s_add_u32 m0, s44, 98304
s_mov_b32 s7, 34816
Mvaa 140,236,80
buffer_load_dwordx4 v4, s[12:15], s7 offen offset:0 sc1 lds
Mvaa 172,236,84
Ta 208,20,49152
Ta 210,20,50176
Mvaa 204,236,88
v_accvgpr_write_b32 a70, 0
v_accvgpr_write_b32 a71, 0
Mvaa 236,236,92
buffer_load_dwordx4 v4, s[12:15], s7 offen offset:1024 sc1 lds
Mvaa 144,240,80
s_waitcnt lgkmcnt(6)
Ta 212,21,49152
Ta 214,21,50176
Mvaa 176,240,84
v_accvgpr_write_b32 a72, 0
v_accvgpr_write_b32 a73, 0
Mvaa 208,240,88
buffer_load_dwordx4 v4, s[12:15], s7 offen offset:2048 sc1 lds
Mvaa 240,240,92
Ta 216,22,49152
Ta 218,22,50176
Mvaa 148,244,80
v_accvgpr_write_b32 a74, 0
v_accvgpr_write_b32 a75, 0
Mvaa 180,244,84
buffer_load_dwordx4 v4, s[12:15], s7 offen offset:3072 sc1 lds
Mvaa 212,244,88
Ta 220,23,49152
Ta 222,23,50176
Mvaa 244,244,92
s_add_u32 m0, s44, 81920
s_mov_b32 s7, 17408
Mvaa 152,248,80
buffer_load_dwordx4 v4, s[12:15], s7 offen offset:0 sc1 lds
Mvaa 184,248,84
v_accvgpr_write_b32 a76, 0
v_accvgpr_write_b32 a77, 0
Mvaa 216,248,88
buffer_load_dwordx4 v4, s[12:15], s7 offen offset:1024 sc1 lds
Mvaa 248,248,92
v_accvgpr_write_b32 a78, 0
v_accvgpr_write_b32 a79, 0
Mvaa 156,252,80
Mvaa 188,252,84
Mvaa 220,252,88
s_waitcnt lgkmcnt(0)
Mvaa 252,252,92
Mvaa 128,192,96
buffer_load_dwordx4 v4, s[12:15], s7 offen offset:2048 sc1 lds
Mvaa 160,192,100
Ta 224,16,57344
Ta 226,16,58368
Mvaa 192,192,104
buffer_load_dwordx4 v4, s[12:15], s7 offen offset:3072 sc1 lds
Mvaa 224,192,108
s_add_u32 m0, s44, 114688
s_mov_b32 s7, 52224
Mvaa 132,196,96
Ta 228,17,57344
Ta 230,17,58368
Mvaa 164,196,100
buffer_load_dwordx4 v4, s[12:15], s7 offen offset:0 sc1 lds
Mvaa 196,196,104
buffer_load_dwordx4 v4, s[12:15], s7 offen offset:1024 sc1 lds
Mvaa 228,196,108
Ta 232,18,57344
Ta 234,18,58368
Mvaa 136,200,96
v_accvgpr_write_b32 a80, 0
v_accvgpr_write_b32 a81, 0
Mvaa 168,200,100
buffer_load_dwordx4 v4, s[12:15], s7 offen offset:2048 sc1 lds
Mvaa 200,200,104
Ta 236,19,57344
Ta 238,19,58368
Mvaa 232,200,108
v_accvgpr_write_b32 a82, 0
v_accvgpr_write_b32 a83, 0
Mvaa 140,204,96
buffer_load_dwordx4 v4, s[12:15], s7 offen offset:3072 sc1 lds
Mvaa 172,204,100
Ta 240,20,57344
Ta 242,20,58368
Mvaa 204,204,104
s_add_u32 m0, s44, 0
s_mov_b32 s7, 69632
Mvaa 236,204,108
buffer_load_dwordx4 v4, s[12:15], s7 offen offset:0 sc1 lds
Mvaa 144,208,96
s_waitcnt lgkmcnt(6)
Ta 244,21,57344
Ta 246,21,58368
Mvaa 176,208,100
buffer_load_dwordx4 v4, s[12:15], s7 offen offset:1024 sc1 lds
Mvaa 208,208,104
v_accvgpr_write_b32 a84, 0
v_accvgpr_write_b32 a85, 0
Mvaa 240,208,108
Ta 248,22,57344
Ta 250,22,58368
Mvaa 148,212,96
buffer_load_dwordx4 v4, s[12:15], s7 offen offset:2048 sc1 lds
Mvaa 180,212,100
v_accvgpr_write_b32 a86, 0
v_accvgpr_write_b32 a87, 0
Mvaa 212,212,104
Ta 252,23,57344
Ta 254,23,58368
Mvaa 244,212,108
buffer_load_dwordx4 v4, s[12:15], s7 offen offset:3072 sc1 lds
Mvaa 152,216,96
s_add_u32 m0, s44, 16384
s_mov_b32 s7, 87040
Mvaa 184,216,100
v_accvgpr_write_b32 a88, 0
v_accvgpr_write_b32 a89, 0
Mvaa 216,216,104
buffer_load_dwordx4 v4, s[12:15], s7 offen offset:0 sc1 lds
Mvaa 248,216,108
v_accvgpr_write_b32 a90, 0
v_accvgpr_write_b32 a91, 0
Mvaa 156,220,96
v_accvgpr_write_b32 a92, 0
v_accvgpr_write_b32 a93, 0
Mvaa 188,220,100
v_accvgpr_write_b32 a94, 0
v_accvgpr_write_b32 a95, 0
Mvaa 220,220,104
s_waitcnt vmcnt(17) lgkmcnt(0)
Mvaa 252,220,108
s_barrier
Mvaa 128,224,112
buffer_load_dwordx4 v4, s[12:15], s7 offen offset:1024 sc1 lds
Mvaa 132,228,112
buffer_load_dwordx4 v4, s[12:15], s7 offen offset:2048 sc1 lds
Mvaa 136,232,112
Ra 192,3,0
Ra 196,3,1024
Mvaa 140,236,112
buffer_load_dwordx4 v4, s[12:15], s7 offen offset:3072 sc1 lds
Mvaa 144,240,112
s_add_u32 m0, s44, 32768
s_mov_b32 s7, 104448
Mvaa 148,244,112
Ra 200,3,2048
Ra 204,3,3072
Mvaa 152,248,112
buffer_load_dwordx4 v4, s[12:15], s7 offen offset:0 sc1 lds
Mvaa 156,252,112
Ra 208,3,4096
Ra 212,3,5120
Mvaa 160,224,116
buffer_load_dwordx4 v4, s[12:15], s7 offen offset:1024 sc1 lds
Mvaa 164,228,116
Ra 216,3,6144
Ra 220,3,7168
Mvaa 168,232,116
Mvaa 172,236,116
buffer_load_dwordx4 v4, s[12:15], s7 offen offset:2048 sc1 lds
Mvaa 176,240,116
v_mul_f32 v128, s94, v128
v_mul_f32 v129, s94, v129
Mvaa 180,244,116
v_mul_f32 v130, s94, v130
v_mul_f32 v131, s94, v131
Mvaa 184,248,116
buffer_load_dwordx4 v4, s[12:15], s7 offen offset:3072 sc1 lds
Mvaa 188,252,116
v_mul_f32 v132, s94, v132
v_mul_f32 v133, s94, v133
Mvaa 192,224,120
v_mul_f32 v134, s94, v134
v_mul_f32 v135, s94, v135
Mvaa 196,228,120
Vc 128,128,129
Vc 129,130,131
Mvaa 200,232,120
Vc 130,132,133
Vc 131,134,135
Mvaa 204,236,120
Aw 128,128
Aw 129,129
Mvaa 208,240,120
Aw 130,130
Aw 131,131
Mvaa 212,244,120
v_mul_f32 v136, s94, v136
v_mul_f32 v137, s94, v137
Mvaa 216,248,120
v_mul_f32 v138, s94, v138
v_mul_f32 v139, s94, v139
Mvaa 220,252,120
v_mul_f32 v140, s94, v140
v_mul_f32 v141, s94, v141
Mvaa 224,224,124
v_mul_f32 v142, s94, v142
v_mul_f32 v143, s94, v143
Mvaa 228,228,124
Vc 136,136,137
Vc 137,138,139
Mvaa 232,232,124
Vc 138,140,141
Vc 139,142,143
Mvaa 236,236,124
Aw 132,136
Aw 133,137
Mvaa 240,240,124
Aw 134,138
Aw 135,139
Mvaa 244,244,124
v_mul_f32 v144, s94, v144
v_mul_f32 v145, s94, v145
Mvaa 248,248,124
v_mul_f32 v146, s94, v146
v_mul_f32 v147, s94, v147
Mvaa 252,252,124
v_mul_f32 v148, s94, v148
v_mul_f32 v149, s94, v149
Ra 224,3,8192
Ra 228,3,9216
Ra 232,3,10240
Ra 236,3,11264
Ra 240,3,12288
Ra 244,3,13312
Ra 248,3,14336
s_waitcnt lgkmcnt(9)
Ra 252,3,15360
v_mul_f32 v150, s94, v150
v_mul_f32_e64 v151, s94, v151
Vc 144,144,145
Vc 145,146,147
Vc 146,148,149
Vc 147,150,151
Aw 136,144
Aw 137,145
Aw 138,146
Aw 139,147
v_mul_f32 v152, s94, v152
v_mul_f32 v153, s94, v153
v_mul_f32 v154, s94, v154
v_mul_f32 v155, s94, v155
v_mul_f32 v156, s94, v156
v_mul_f32 v157, s94, v157
v_mul_f32 v158, s94, v158
v_mul_f32 v159, s94, v159
Vc 152,152,153
Vc 153,154,155
Vc 154,156,157
Vc 155,158,159
Aw 140,152
Aw 141,153
Aw 142,154
Aw 143,155
Zvaa 128,192,128
v_mul_f32 v160, s94, v160
v_mul_f32 v161, s94, v161
v_mul_f32 v162, s94, v162
v_mul_f32 v163, s94, v163
Mvaa 128,196,132
v_mul_f32 v164, s94, v164
v_mul_f32 v165, s94, v165
v_mul_f32 v166, s94, v166
v_mul_f32 v167, s94, v167
Mvaa 128,200,136
Vc 160,160,161
Vc 161,162,163
Vc 162,164,165
Vc 163,166,167
Mvaa 128,204,140
Aw 144,160
Aw 145,161
Aw 146,162
Aw 147,163
s_waitcnt lgkmcnt(8)
Zvaa 132,208,128
v_mul_f32 v168, s94, v168
v_mul_f32 v169, s94, v169
v_mul_f32 v170, s94, v170
v_mul_f32_e64 v171, s94, v171
Mvaa 132,212,132
v_mul_f32 v172, s94, v172
v_mul_f32 v173, s94, v173
v_mul_f32 v174, s94, v174
v_mul_f32 v175, s94, v175
Mvaa 132,216,136
Vc 168,168,169
Vc 169,170,171
Vc 170,172,173
Vc 171,174,175
Mvaa 132,220,140
Aw 148,168
Aw 149,169
Aw 150,170
Aw 151,171
s_waitcnt lgkmcnt(4)
Zvaa 136,224,128
v_mul_f32 v176, s94, v176
v_mul_f32 v177, s94, v177
v_mul_f32 v178, s94, v178
v_mul_f32_e64 v179, s94, v179
Mvaa 136,228,132
v_mul_f32 v180, s94, v180
v_mul_f32 v181, s94, v181
v_mul_f32 v182, s94, v182
v_mul_f32 v183, s94, v183
Mvaa 136,232,136
Vc 176,176,177
Vc 177,178,179
Vc 178,180,181
Vc 179,182,183
Mvaa 136,236,140
Aw 152,176
Aw 153,177
Aw 154,178
Aw 155,179
s_waitcnt lgkmcnt(0)
Zvaa 140,240,128
v_mul_f32 v184, s94, v184
v_mul_f32 v185, s94, v185
v_mul_f32 v186, s94, v186
v_mul_f32_e64 v187, s94, v187
Mvaa 140,244,132
v_mul_f32 v188, s94, v188
v_mul_f32 v189, s94, v189
v_mul_f32 v190, s94, v190
v_mul_f32 v191, s94, v191
Mvaa 140,248,136
Vc 184,184,185
Vc 185,186,187
Vc 186,188,189
Vc 187,190,191
Mvaa 140,252,140
Aw 156,184
Aw 157,185
Aw 158,186
Aw 159,187
Zvaa 144,192,144
v_mul_f32 v192, s94, v192
v_mul_f32 v193, s94, v193
v_mul_f32 v194, s94, v194
v_mul_f32 v195, s94, v195
Mvaa 144,196,148
v_mul_f32 v196, s94, v196
v_mul_f32 v197, s94, v197
v_mul_f32 v198, s94, v198
v_mul_f32 v199, s94, v199
Mvaa 144,200,152
Vc 192,192,193
Vc 193,194,195
Vc 194,196,197
Vc 195,198,199
Mvaa 144,204,156
Aw 160,192
Aw 161,193
Aw 162,194
Aw 163,195
Zvaa 148,208,144
v_mul_f32 v200, s94, v200
v_mul_f32 v201, s94, v201
v_mul_f32 v202, s94, v202
v_mul_f32 v203, s94, v203
Mvaa 148,212,148
v_mul_f32 v204, s94, v204
v_mul_f32 v205, s94, v205
v_mul_f32 v206, s94, v206
v_mul_f32 v207, s94, v207
Mvaa 148,216,152
Vc 200,200,201
Vc 201,202,203
Vc 202,204,205
Vc 203,206,207
Mvaa 148,220,156
Aw 164,200
Aw 165,201
Aw 166,202
Aw 167,203
Zvaa 152,224,144
v_mul_f32 v208, s94, v208
v_mul_f32 v209, s94, v209
v_mul_f32 v210, s94, v210
v_mul_f32 v211, s94, v211
Mvaa 152,228,148
v_mul_f32 v212, s94, v212
v_mul_f32 v213, s94, v213
v_mul_f32 v214, s94, v214
v_mul_f32 v215, s94, v215
Mvaa 152,232,152
Vc 208,208,209
Vc 209,210,211
Vc 210,212,213
Vc 211,214,215
Mvaa 152,236,156
Aw 168,208
Aw 169,209
Aw 170,210
Aw 171,211
Zvaa 156,240,144
v_mul_f32 v216, s94, v216
v_mul_f32 v217, s94, v217
v_mul_f32 v218, s94, v218
v_mul_f32 v219, s94, v219
Mvaa 156,244,148
v_mul_f32 v220, s94, v220
v_mul_f32 v221, s94, v221
v_mul_f32 v222, s94, v222
v_mul_f32 v223, s94, v223
Mvaa 156,248,152
Vc 216,216,217
Vc 217,218,219
Vc 218,220,221
Vc 219,222,223
Mvaa 156,252,156
Aw 172,216
Aw 173,217
Aw 174,218
Aw 175,219
Zvaa 160,192,160
v_mul_f32 v224, s94, v224
v_mul_f32 v225, s94, v225
v_mul_f32 v226, s94, v226
v_mul_f32 v227, s94, v227
Mvaa 160,196,164
v_mul_f32 v228, s94, v228
v_mul_f32 v229, s94, v229
v_mul_f32 v230, s94, v230
v_mul_f32 v231, s94, v231
Mvaa 160,200,168
Vc 224,224,225
Vc 225,226,227
Vc 226,228,229
Vc 227,230,231
Mvaa 160,204,172
Aw 176,224
Aw 177,225
Aw 178,226
Aw 179,227
Zvaa 164,208,160
v_mul_f32 v232, s94, v232
v_mul_f32 v233, s94, v233
v_mul_f32 v234, s94, v234
v_mul_f32 v235, s94, v235
Mvaa 164,212,164
v_mul_f32 v236, s94, v236
v_mul_f32 v237, s94, v237
v_mul_f32 v238, s94, v238
v_mul_f32 v239, s94, v239
Mvaa 164,216,168
Vc 232,232,233
Vc 233,234,235
Vc 234,236,237
Vc 235,238,239
Mvaa 164,220,172
Aw 180,232
Aw 181,233
Aw 182,234
Aw 183,235
Zvaa 168,224,160
v_mul_f32 v240, s94, v240
v_mul_f32 v241, s94, v241
v_mul_f32 v242, s94, v242
v_mul_f32 v243, s94, v243
Mvaa 168,228,164
v_mul_f32 v244, s94, v244
v_mul_f32 v245, s94, v245
v_mul_f32 v246, s94, v246
v_mul_f32 v247, s94, v247
Mvaa 168,232,168
Vc 240,240,241
Vc 241,242,243
Vc 242,244,245
Vc 243,246,247
Mvaa 168,236,172
Aw 184,240
Aw 185,241
Aw 186,242
Aw 187,243
Zvaa 172,240,160
v_mul_f32 v248, s94, v248
v_mul_f32 v249, s94, v249
v_mul_f32 v250, s94, v250
v_mul_f32 v251, s94, v251
Mvaa 172,244,164
v_mul_f32 v252, s94, v252
v_mul_f32 v253, s94, v253
v_mul_f32 v254, s94, v254
v_mul_f32 v255, s94, v255
Mvaa 172,248,168
Vc 248,248,249
Vc 249,250,251
Vc 250,252,253
Vc 251,254,255
Mvaa 172,252,172
Aw 188,248
Aw 189,249
Aw 190,250
Aw 191,251
Zvaa 176,192,176
v_accvgpr_write_b32 a96, 0
v_accvgpr_write_b32 a97, 0
v_accvgpr_write_b32 a98, 0
v_accvgpr_write_b32 a99, 0
Mvaa 176,196,180
v_accvgpr_write_b32 a100, 0
v_accvgpr_write_b32 a101, 0
v_accvgpr_write_b32 a102, 0
v_accvgpr_write_b32 a103, 0
Mvaa 176,200,184
v_accvgpr_write_b32 a104, 0
v_accvgpr_write_b32 a105, 0
v_accvgpr_write_b32 a106, 0
v_accvgpr_write_b32 a107, 0
Mvaa 176,204,188
v_accvgpr_write_b32 a108, 0
v_accvgpr_write_b32 a109, 0
v_accvgpr_write_b32 a110, 0
v_accvgpr_write_b32 a111, 0
Zvaa 180,208,176
v_accvgpr_write_b32 a112, 0
v_accvgpr_write_b32 a113, 0
v_accvgpr_write_b32 a114, 0
v_accvgpr_write_b32 a115, 0
Mvaa 180,212,180
v_accvgpr_write_b32 a116, 0
v_accvgpr_write_b32 a117, 0
v_accvgpr_write_b32 a118, 0
v_accvgpr_write_b32 a119, 0
Mvaa 180,216,184
v_accvgpr_write_b32 a120, 0
v_accvgpr_write_b32 a121, 0
v_accvgpr_write_b32 a122, 0
v_accvgpr_write_b32 a123, 0
Mvaa 180,220,188
v_accvgpr_write_b32 a124, 0
v_accvgpr_write_b32 a125, 0
v_accvgpr_write_b32 a126, 0
v_accvgpr_write_b32 a127, 0
s_waitcnt vmcnt(16)
s_barrier
s_add_u32 s53, s44, 65536
Zvaa 184,224,176
Ra 192,3,32768
v_mov_b32 v16, 0x3f803f80
v_mov_b32 v17, 0x3f803f80
v_mov_b32 v18, 0x3f803f80
v_mov_b32 v19, 0x3f803f80
Mvaa 184,228,180
Ra 196,3,33792
v_mov_b32 v20, 0xff800000
v_max3_f32 v22, v128, v129, v130
v_max3_f32 v22, v22, v131, v132
v_max3_f32 v22, v22, v133, v134
Mvaa 184,232,184
Ra 200,3,34816
v_max3_f32 v22, v22, v135, v136
v_max3_f32 v22, v22, v137, v138
v_max3_f32 v22, v22, v139, v140
v_max3_f32 v22, v22, v141, v142
Mvaa 184,236,188
Ra 204,3,35840
v_max_f32 v22, v22, v143
v_mov_b32 v1, v22
s_nop 1
v_permlane16_swap_b32 v1, v22
v_max_f32_e64 v22, v22, v1
Zvaa 188,240,176
Ra 208,3,36864
v_mov_b32 v1, v22
s_nop 1
v_permlane32_swap_b32 v1, v22
v_max_f32 v22, v22, v1
v_add_f32 v22, 0x41f80000, v22
Mvaa 188,244,180
Ra 212,3,37888
Vs 128,128,22
Vs 129,129,22
Vs 130,130,22
Vs 131,131,22
Mvaa 188,248,184
Ra 216,3,38912
Vs 132,132,22
Vs 133,133,22
Vs 134,134,22
Vs 135,135,22
Mvaa 188,252,188
Ra 220,3,39936
Vs 136,136,22
Vs 137,137,22
Vs 138,138,22
Vs 139,139,22
Vs 140,140,22
Vs 141,141,22
Vs 142,142,22
Vs 143,143,22
v_sub_f32 v32, 0, v22
v_sub_f32 v33, 0, v22
v_sub_f32 v34, 0, v22
v_sub_f32 v35, 0, v22
v_max3_f32 v22, v144, v145, v146
v_max3_f32 v22, v22, v147, v148
v_max3_f32 v22, v22, v149, v150
v_max3_f32 v22, v22, v151, v152
v_max3_f32 v22, v22, v153, v154
v_max3_f32 v22, v22, v155, v156
v_max3_f32 v22, v22, v157, v158
v_max_f32 v22, v22, v159
v_mov_b32 v1, v22
s_nop 1
v_permlane16_swap_b32 v1, v22
v_max_f32 v22, v22, v1
v_mov_b32 v1, v22
s_nop 1
v_permlane32_swap_b32 v1, v22
v_max_f32_e64 v22, v22, v1
v_add_f32 v22, 0x41f80000, v22
Vs 144,144,22
Vs 145,145,22
Vs 146,146,22
Vs 147,147,22
Vs 148,148,22
Vs 149,149,22
Vs 150,150,22
Vs 151,151,22
Vs 152,152,22
Vs 153,153,22
Vs 154,154,22
Vs 155,155,22
Vs 156,156,22
Vs 157,157,22
Vs 158,158,22
Vs 159,159,22
v_sub_f32 v36, 0, v22
v_sub_f32 v37, 0, v22
v_sub_f32 v38, 0, v22
v_sub_f32 v39, 0, v22
s_mov_b32 s38, 139264
s_mov_b32 s39, 121856
s_cmp_lg_u32 s34, 0
s_cbranch_scc1 L_k2_nomask0
v_cmp_gt_i32 s[56:57], 0, v5
v_cmp_gt_i32 s[58:59], 1, v5
v_cmp_gt_i32 s[60:61], 2, v5
v_cmp_gt_i32 s[62:63], 3, v5
s_nop 3
s_nop 0
v_cndmask_b32 v176, v176, v20, s[56:57]
v_cndmask_b32 v177, v177, v20, s[58:59]
v_cndmask_b32 v178, v178, v20, s[60:61]
v_cndmask_b32 v179, v179, v20, s[62:63]
v_cmp_gt_i32 s[56:57], 16, v5
v_cmp_gt_i32 s[58:59], 17, v5
v_cmp_gt_i32 s[60:61], 18, v5
v_cmp_gt_i32 s[62:63], 19, v5
v_cndmask_b32 v180, v180, v20, s[56:57]
v_cndmask_b32 v181, v181, v20, s[58:59]
v_cndmask_b32 v182, v182, v20, s[60:61]
v_cndmask_b32 v183, v183, v20, s[62:63]
v_cmp_gt_i32 s[56:57], 32, v5
v_cmp_gt_i32 s[58:59], 33, v5
v_cmp_gt_i32 s[60:61], 34, v5
v_cmp_gt_i32 s[62:63], 35, v5
v_cndmask_b32 v184, v184, v20, s[56:57]
v_cndmask_b32 v185, v185, v20, s[58:59]
v_cndmask_b32 v186, v186, v20, s[60:61]
v_cndmask_b32 v187, v187, v20, s[62:63]
v_cmp_gt_i32 s[56:57], 48, v5
v_cmp_gt_i32 s[58:59], 49, v5
v_cmp_gt_i32 s[60:61], 50, v5
v_cmp_gt_i32 s[62:63], 51, v5
v_cndmask_b32 v188, v188, v20, s[56:57]
v_cndmask_b32 v189, v189, v20, s[58:59]
v_cndmask_b32 v190, v190, v20, s[60:61]
v_cndmask_b32 v191, v191, v20, s[62:63]
L_k2_nomask0:
s_mov_b32 s37, 0
s_nop 0
v_max3_f32 v22, v160, v161, v162
v_max3_f32 v22, v22, v163, v164
v_max3_f32 v22, v22, v165, v166
v_max3_f32 v22, v22, v167, v168
v_max3_f32 v22, v22, v169, v170
v_max3_f32 v22, v22, v171, v172
v_max3_f32 v22, v22, v173, v174
v_max_f32 v22, v22, v175
v_mov_b32 v1, v22
s_nop 1
v_permlane16_swap_b32 v1, v22
v_max_f32 v22, v22, v1
v_mov_b32 v1, v22
s_nop 1
v_permlane32_swap_b32 v1, v22
v_max_f32_e64 v22, v22, v1
v_add_f32 v22, 0x41f80000, v22
Vs 160,160,22
Vs 161,161,22
Vs 162,162,22
Vs 163,163,22
Vs 164,164,22
Vs 165,165,22
Vs 166,166,22
Vs 167,167,22
Vs 168,168,22
Vs 169,169,22
Vs 170,170,22
Vs 171,171,22
Vs 172,172,22
Vs 173,173,22
Vs 174,174,22
Vs 175,175,22
v_sub_f32 v40, 0, v22
v_sub_f32 v41, 0, v22
v_sub_f32 v42, 0, v22
v_sub_f32 v43, 0, v22
v_max3_f32 v22, v176, v177, v178
v_max3_f32 v22, v22, v179, v180
v_max3_f32 v22, v22, v181, v182
v_max3_f32 v22, v22, v183, v184
v_max3_f32 v22, v22, v185, v186
v_max3_f32 v22, v22, v187, v188
v_max3_f32 v22, v22, v189, v190
v_max_f32 v22, v22, v191
v_mov_b32 v1, v22
s_nop 1
v_permlane16_swap_b32 v1, v22
v_max_f32 v22, v22, v1
v_mov_b32 v1, v22
s_nop 1
v_permlane32_swap_b32 v1, v22
v_max_f32_e64 v22, v22, v1
v_add_f32 v22, 0x41f80000, v22
Vs 176,176,22
Vs 177,177,22
Vs 178,178,22
Vs 179,179,22
Vs 180,180,22
Vs 181,181,22
Vs 182,182,22
Vs 183,183,22
Vs 184,184,22
Vs 185,185,22
Vs 186,186,22
Vs 187,187,22
Vs 188,188,22
Vs 189,189,22
Vs 190,190,22
Vs 191,191,22
v_sub_f32 v44, 0, v22
v_sub_f32 v45, 0, v22
v_sub_f32 v46, 0, v22
v_sub_f32 v47, 0, v22
Ve 8,128
Ve 9,129
Ve 10,130
Ve 11,131
Vc 64,8,9
Ve 12,144
Ve 13,145
Vc 65,10,11
Ve 14,146
Ve 15,147
Vc 72,12,13
Ve 8,160
Ve 9,161
Vc 73,14,15
Ve 10,162
Ve 11,163
Vc 80,8,9
Ve 12,176
Ve 13,177
Vc 81,10,11
Ve 14,178
Ve 15,179
Vc 88,12,13
Ve 8,132
Ve 9,133
Vc 89,14,15
Ve 10,134
Ve 11,135
Vc 66,8,9
Ve 12,148
Ve 13,149
Vc 67,10,11
Ve 14,150
Ve 15,151
Vc 74,12,13
Ve 8,164
Ve 9,165
Vc 75,14,15
Ve 10,166
Ve 11,167
Vc 82,8,9
Ve 12,180
Ve 13,181
Vc 83,10,11
Ve 14,182
Ve 15,183
Vc 90,12,13
Vc 91,14,15
v_or_b32_e64 v7, v64, v65
v_or3_b32 v7, v7, v72, v73
v_or3_b32 v7, v7, v80, v81
v_or3_b32 v7, v7, v88, v89
v_or3_b32 v7, v7, v66, v67
v_or3_b32 v7, v7, v74, v75
v_or3_b32 v7, v7, v82, v83
v_or3_b32 v7, v7, v90, v91
s_waitcnt lgkmcnt(4)
s_cmp_eq_u32 s34, 0
s_cbranch_scc1 L_k2_wlast
s_branch L_k2_wloop
L_k2_mk_wo:
v_cmp_gt_i32 s[56:57], 0, v5
v_cmp_gt_i32 s[58:59], 1, v5
v_cmp_gt_i32 s[60:61], 2, v5
v_cmp_gt_i32 s[62:63], 3, v5
s_nop 3
s_nop 0
v_cndmask_b32 v176, v176, v20, s[56:57]
v_cndmask_b32 v177, v177, v20, s[58:59]
v_cndmask_b32 v178, v178, v20, s[60:61]
v_cndmask_b32 v179, v179, v20, s[62:63]
v_cmp_gt_i32 s[56:57], 16, v5
v_cmp_gt_i32 s[58:59], 17, v5
v_cmp_gt_i32 s[60:61], 18, v5
v_cmp_gt_i32 s[62:63], 19, v5
v_cndmask_b32 v180, v180, v20, s[56:57]
v_cndmask_b32 v181, v181, v20, s[58:59]
v_cndmask_b32 v182, v182, v20, s[60:61]
v_cndmask_b32 v183, v183, v20, s[62:63]
v_cmp_gt_i32 s[56:57], 32, v5
v_cmp_gt_i32 s[58:59], 33, v5
v_cmp_gt_i32 s[60:61], 34, v5
v_cmp_gt_i32 s[62:63], 35, v5
v_cndmask_b32 v184, v184, v20, s[56:57]
v_cndmask_b32 v185, v185, v20, s[58:59]
v_cndmask_b32 v186, v186, v20, s[60:61]
v_cndmask_b32 v187, v187, v20, s[62:63]
v_cmp_gt_i32 s[56:57], 48, v5
v_cmp_gt_i32 s[58:59], 49, v5
v_cmp_gt_i32 s[60:61], 50, v5
v_cmp_gt_i32 s[62:63], 51, v5
v_cndmask_b32 v188, v188, v20, s[56:57]
v_cndmask_b32 v189, v189, v20, s[58:59]
v_cndmask_b32 v190, v190, v20, s[60:61]
v_cndmask_b32 v191, v191, v20, s[62:63]
s_branch L_k2_mkr_wo
L_k2_mk_tr:
v_cmp_gt_i32 s[56:57], 0, v5
v_cmp_gt_i32 s[58:59], 1, v5
v_cmp_gt_i32 s[60:61], 2, v5
v_cmp_gt_i32 s[62:63], 3, v5
s_nop 3
v_cndmask_b32 v144, v144, v20, s[56:57]
v_cndmask_b32 v145, v145, v20, s[58:59]
v_cndmask_b32 v146, v146, v20, s[60:61]
v_cndmask_b32 v147, v147, v20, s[62:63]
v_cmp_gt_i32 s[56:57], 16, v5
v_cmp_gt_i32 s[58:59], 17, v5
v_cmp_gt_i32 s[60:61], 18, v5
v_cmp_gt_i32 s[62:63], 19, v5
v_cndmask_b32 v148, v148, v20, s[56:57]
v_cndmask_b32 v149, v149, v20, s[58:59]
v_cndmask_b32 v150, v150, v20, s[60:61]
v_cndmask_b32 v151, v151, v20, s[62:63]
v_cmp_gt_i32 s[56:57], 32, v5
v_cmp_gt_i32 s[58:59], 33, v5
v_cmp_gt_i32 s[60:61], 34, v5
v_cmp_gt_i32 s[62:63], 35, v5
v_cndmask_b32 v152, v152, v20, s[56:57]
v_cndmask_b32 v153, v153, v20, s[58:59]
v_cndmask_b32 v154, v154, v20, s[60:61]
v_cndmask_b32 v155, v155, v20, s[62:63]
v_cmp_gt_i32 s[56:57], 48, v5
v_cmp_gt_i32 s[58:59], 49, v5
v_cmp_gt_i32 s[60:61], 50, v5
v_cmp_gt_i32 s[62:63], 51, v5
v_cndmask_b32 v156, v156, v20, s[56:57]
v_cndmask_b32 v157, v157, v20, s[58:59]
v_cndmask_b32 v158, v158, v20, s[60:61]
v_cndmask_b32 v159, v159, v20, s[62:63]
s_branch L_k2_mkr_tr
L_k2_mk_no:
v_cmp_gt_i32 s[56:57], 0, v5
v_cmp_gt_i32 s[58:59], 1, v5
v_cmp_gt_i32 s[60:61], 2, v5
v_cmp_gt_i32 s[62:63], 3, v5
s_nop 3
v_cndmask_b32 v144, v144, v20, s[56:57]
v_cndmask_b32 v145, v145, v20, s[58:59]
v_cndmask_b32 v146, v146, v20, s[60:61]
v_cndmask_b32 v147, v147, v20, s[62:63]
v_cmp_gt_i32 s[56:57], 16, v5
v_cmp_gt_i32 s[58:59], 17, v5
v_cmp_gt_i32 s[60:61], 18, v5
v_cmp_gt_i32 s[62:63], 19, v5
v_cndmask_b32 v148, v148, v20, s[56:57]
v_cndmask_b32 v149, v149, v20, s[58:59]
v_cndmask_b32 v150, v150, v20, s[60:61]
v_cndmask_b32 v151, v151, v20, s[62:63]
v_cmp_gt_i32 s[56:57], 32, v5
v_cmp_gt_i32 s[58:59], 33, v5
v_cmp_gt_i32 s[60:61], 34, v5
v_cmp_gt_i32 s[62:63], 35, v5
v_cndmask_b32 v152, v152, v20, s[56:57]
v_cndmask_b32 v153, v153, v20, s[58:59]
v_cndmask_b32 v154, v154, v20, s[60:61]
v_cndmask_b32 v155, v155, v20, s[62:63]
v_cmp_gt_i32 s[56:57], 48, v5
v_cmp_gt_i32 s[58:59], 49, v5
v_cmp_gt_i32 s[60:61], 50, v5
v_cmp_gt_i32 s[62:63], 51, v5
v_cndmask_b32 v156, v156, v20, s[56:57]
v_cndmask_b32 v157, v157, v20, s[58:59]
v_cndmask_b32 v158, v158, v20, s[60:61]
v_cndmask_b32 v159, v159, v20, s[62:63]
s_branch L_k2_mkr_no
L_pubB:
v_mov_b32 v24, 1
v_mov_b32 v25, 0
s_mov_b64 exec, 1
buffer_store_dword v24, v25, s[20:23], s64 offen sc1
s_mov_b64 exec, -1
s_branch L_pubBr
L_k2_wloop:
v_xor_b32 v2, 65536, v2
v_xor_b32 v3, 65536, v3
Cvaa 192,192,128,32
s_mov_b32 m0, s53
Ra 224,2,40960
v_lshl_add_u64 v[28:29], s[40:41], 0, v[28:29]
Mvaa 192,196,132
buffer_load_dwordx4 v4, s[12:15], s38 offen offset:0 sc1 lds
Mvaa 192,200,136
Ve 8,136
Mvaa 192,204,140
VE 9,137
Cvaa 208,192,144,36
Ra 228,2,41984
Vc 68,8,9
Mvaa 208,196,148
VE 10,138
Mvaa 208,200,152
VE 11,139
Mvaa 208,204,156
Ra 232,2,43008
Vc 69,10,11
Cvaa 224,192,160,40
Ra 236,2,44032
v_or3_b32 v7, v7, v68, v69
Mvaa 224,196,164
VE 12,152
Mvaa 224,200,168
VE 13,153
Mvaa 224,204,172
Ra 240,2,45056
Vc 76,12,13
Cvaa 240,192,176,44
VE 14,154
Mvaa 240,196,180
VE 15,155
Mvaa 240,200,184
Ra 244,2,46080
Vc 77,14,15
Mvaa 240,204,188
s_waitcnt lgkmcnt(6)
Ra 248,2,47104
v_or3_b32 v7, v7, v76, v77
Cvaa 196,208,128,32
buffer_load_dwordx4 v4, s[12:15], s38 offen offset:1024 sc1 lds
Mvaa 196,212,132
Ve 8,168
Mvaa 196,216,136
VE 9,169
Mvaa 196,220,140
Ra 252,2,48128
Vc 84,8,9
Cvaa 212,208,144,36
VE 10,170
Mvaa 212,212,148
VE 11,171
Mvaa 212,216,152
Ra 192,2,16384
Vc 85,10,11
Mvaa 212,220,156
Ra 196,2,24576
v_or3_b32 v7, v7, v84, v85
Cvaa 228,208,160,40
VE 12,184
Mvaa 228,212,164
VE 13,185
Mvaa 228,216,168
Ra 200,2,17408
Vc 92,12,13
Mvaa 228,220,172
VE 14,186
Cvaa 244,208,176,44
VE 15,187
Mvaa 244,212,180
buffer_load_dwordx4 v4, s[12:15], s38 offen offset:2048 sc1 lds
Mvaa 244,216,184
Ra 204,2,25600
Vc 93,14,15
Mvaa 244,220,188
s_waitcnt lgkmcnt(8)
Ve 8,140
Cvaa 200,224,128,32
Ra 208,2,18432
v_or3_b32 v7, v7, v92, v93
Mvaa 200,228,132
VE 9,141
Mvaa 200,232,136
Ra 212,2,26624
Vc 70,8,9
Mvaa 200,236,140
VE 10,142
Cvaa 216,224,144,36
VE 11,143
Mvaa 216,228,148
Ra 216,2,19456
Vc 71,10,11
Mvaa 216,232,152
Ra 220,2,27648
v_or3_b32 v7, v7, v70, v71
Mvaa 216,236,156
VE 12,156
Cvaa 232,224,160,40
VE 13,157
Mvaa 232,228,164
VE 14,158
Mvaa 232,232,168
VE 15,159
Mvaa 232,236,172
buffer_load_dwordx4 v4, s[12:15], s38 offen offset:3072 sc1 lds
Cvaa 248,224,176,44
VE 8,172
Mvaa 248,228,180
VE 9,173
Mvaa 248,232,184
Vc 78,12,13
Vc 79,14,15
Mvaa 248,236,188
s_waitcnt lgkmcnt(8)
Ve 10,174
Cvaa 204,240,128,32
VE 11,175
Mvaa 204,244,132
Vc 86,8,9
Vc 87,10,11
Mvaa 204,248,136
VE 12,188
Mvaa 204,252,140
VE 13,189
Cvaa 220,240,144,36
Vc 94,12,13
v_or3_b32 v7, v7, v78, v79
Mvaa 220,244,148
VE 14,190
Mvaa 220,248,152
VE 15,191
Mvaa 220,252,156
Vc 95,14,15
v_or3_b32 v7, v7, v86, v87
Cvaa 236,240,160,40
v_or3_b32 v7, v7, v94, v95
v_and_b32 v1, 0x40004000, v7
Mvaa 236,244,164
v_cmp_ne_u32 vcc, 0, v1
Mvaa 236,248,168
Mvaa 236,252,172
s_waitcnt vmcnt(12)
Cvaa 252,240,176,44
Mvaa 252,244,180
s_barrier
Mvaa 252,248,184
s_waitcnt lgkmcnt(4)
Mvaa 252,252,188
s_cbranch_vccnz L_k2_fb_we
L_k2_fbr_we:
Maav 0,192,64
Ve 8,192
Maav 0,196,68
s_add_u32 m0, s54, 49152
VE 9,193
Maav 32,192,72
buffer_load_dwordx4 v4, s[12:15], s39 offen offset:0 sc1 lds
Maav 32,196,76
s_add_u32 s37, s37, 1
Ra 224,2,20480
Vc 96,8,9
Maav 64,192,80
s_add_u32 s38, s38, 34816
Ve 10,194
Maav 64,196,84
VE 11,195
Maav 96,192,88
Ra 228,2,28672
Vc 97,10,11
Maav 96,196,92
Ra 232,2,21504
v_or_b32_e64 v7, v96, v97
Maav 4,200,64
VE 12,208
Maav 4,204,68
VE 13,209
Maav 36,200,72
Ra 236,2,29696
Vc 104,12,13
Maav 36,204,76
VE 14,210
Maav 68,200,80
VE 15,211
Maav 68,204,84
Ra 240,2,22528
Vc 105,14,15
Maav 100,200,88
Ra 244,2,30720
v_or3_b32 v7, v7, v104, v105
Maav 100,204,92
buffer_load_dwordx4 v4, s[12:15], s39 offen offset:1024 sc1 lds
Mvvv 48,16,64
VE 8,224
Mvvv 48,16,68
s_waitcnt lgkmcnt(6)
Ve 9,225
Maav 8,208,64
Ra 248,2,23552
Vc 112,8,9
Maav 8,212,68
VE 10,226
Maav 40,208,72
VE 11,227
Maav 40,212,76
Ra 252,2,31744
Vc 113,10,11
Maav 72,208,80
Ra 192,3,0
v_or3_b32 v7, v7, v112, v113
Maav 72,212,84
VE 12,240
Maav 104,208,88
VE 13,241
Maav 104,212,92
Ra 196,3,1024
Vc 120,12,13
Maav 12,216,64
VE 14,242
Maav 12,220,68
VE 15,243
Maav 44,216,72
Ra 200,3,2048
Vc 121,14,15
Maav 44,220,76
buffer_load_dwordx4 v4, s[12:15], s39 offen offset:2048 sc1 lds
Maav 76,216,80
Ra 204,3,3072
v_or3_b32 v7, v7, v120, v121
Maav 76,220,84
VE 8,196
Maav 108,216,88
VE 9,197
Maav 108,220,92
VE 10,198
Mvvv 52,16,72
VE 11,199
Mvvv 52,16,76
s_waitcnt lgkmcnt(8)
Ve 12,212
Maav 16,224,64
Ra 208,3,4096
Vc 98,8,9
Maav 16,228,68
Ra 212,3,5120
Vc 99,10,11
Maav 48,224,72
Ra 216,3,6144
v_or3_b32 v7, v7, v98, v99
Maav 48,228,76
VE 13,213
Maav 80,224,80
Ra 220,3,7168
Vc 106,12,13
Maav 80,228,84
VE 14,214
Maav 112,224,88
buffer_load_dwordx4 v4, s[12:15], s39 offen offset:3072 sc1 lds
Maav 112,228,92
s_add_u32 s39, s39, 34816
VE 15,215
Maav 20,232,64
VE 8,228
Maav 20,236,68
VE 9,229
Maav 52,232,72
VE 10,230
Maav 52,236,76
VE 11,231
Maav 84,232,80
Vc 107,14,15
Vc 114,8,9
Maav 84,236,84
VE 12,244
Maav 116,232,88
VE 13,245
Maav 116,236,92
Vc 115,10,11
Vc 122,12,13
Mvvv 56,16,80
VE 14,246
Mvvv 56,16,84
s_waitcnt lgkmcnt(8)
Ve 15,247
Maav 24,240,64
Vc 123,14,15
v_or3_b32 v7, v7, v106, v107
Maav 24,244,68
v_or3_b32 v7, v7, v114, v115
v_or3_b32 v7, v7, v122, v123
Maav 56,240,72
global_load_dword v30, v[28:29], off
Maav 56,244,76
Maav 88,240,80
Maav 88,244,84
Maav 120,240,88
Maav 120,244,92
Maav 28,248,64
Maav 28,252,68
Maav 60,248,72
Maav 60,252,76
Maav 92,248,80
Maav 92,252,84
Maav 124,248,88
Maav 124,252,92
Mvvv 60,16,88
s_waitcnt lgkmcnt(4)
Mvvv 60,16,92
Ve 8,200
Cvaa 128,192,128,32
s_add_u32 m0, s53, 32768
Ra 224,3,8192
v_lshl_add_u64 v[28:29], s[40:41], 0, v[28:29]
Mvaa 128,196,132
buffer_load_dwordx4 v4, s[12:15], s38 offen offset:0 sc1 lds
Mvaa 128,200,136
VE 9,201
Mvaa 128,204,140
Ra 228,3,9216
Vc 100,8,9
Cvaa 144,192,144,36
VE 10,202
Mvaa 144,196,148
VE 11,203
Mvaa 144,200,152
Ra 232,3,10240
Vc 101,10,11
Mvaa 144,204,156
Ra 236,3,11264
v_or3_b32 v7, v7, v100, v101
Cvaa 160,192,160,40
VE 12,216
Mvaa 160,196,164
VE 13,217
Mvaa 160,200,168
Ra 240,3,12288
Vc 108,12,13
Mvaa 160,204,172
VE 14,218
Cvaa 176,192,176,44
VE 15,219
Mvaa 176,196,180
Ra 244,3,13312
Vc 109,14,15
Mvaa 176,200,184
Ra 248,3,14336
v_or3_b32 v7, v7, v108, v109
Mvaa 176,204,188
s_waitcnt lgkmcnt(7)
Ve 8,232
Cvaa 132,208,128,32
buffer_load_dwordx4 v4, s[12:15], s38 offen offset:1024 sc1 lds
Mvaa 132,212,132
VE 9,233
Mvaa 132,216,136
Ra 252,3,15360
Vc 116,8,9
Mvaa 132,220,140
VE 10,234
Cvaa 148,208,144,36
VE 11,235
Mvaa 148,212,148
Ra 192,2,49152
Vc 117,10,11
Mvaa 148,216,152
Ra 196,2,57344
v_or3_b32 v7, v7, v116, v117
Mvaa 148,220,156
VE 12,248
Cvaa 164,208,160,40
VE 13,249
Mvaa 164,212,164
Ra 200,2,50176
Vc 124,12,13
Mvaa 164,216,168
VE 14,250
Mvaa 164,220,172
VE 15,251
Cvaa 180,208,176,44
Ra 204,2,58368
Vc 125,14,15
Mvaa 180,212,180
buffer_load_dwordx4 v4, s[12:15], s38 offen offset:2048 sc1 lds
Mvaa 180,216,184
VE 8,204
Mvaa 180,220,188
s_waitcnt lgkmcnt(8)
Ve 9,205
Cvaa 136,224,128,32
Ra 208,2,51200
Vc 102,8,9
Mvaa 136,228,132
Ra 212,2,59392
v_or3_b32 v7, v7, v124, v125
Mvaa 136,232,136
VE 10,206
Mvaa 136,236,140
VE 11,207
Cvaa 152,224,144,36
Ra 216,2,52224
Vc 103,10,11
Mvaa 152,228,148
Ra 220,2,60416
v_or3_b32 v7, v7, v102, v103
Mvaa 152,232,152
VE 12,220
Mvaa 152,236,156
VE 13,221
Cvaa 168,224,160,40
VE 14,222
Mvaa 168,228,164
VE 15,223
Mvaa 168,232,168
VE 8,236
Mvaa 168,236,172
buffer_load_dwordx4 v4, s[12:15], s38 offen offset:3072 sc1 lds
Cvaa 184,224,176,44
VE 9,237
Mvaa 184,228,180
Vc 110,12,13
Vc 111,14,15
Mvaa 184,232,184
VE 10,238
Mvaa 184,236,188
s_waitcnt lgkmcnt(8)
Ve 11,239
Cvaa 140,240,128,32
Vc 118,8,9
Vc 119,10,11
Mvaa 140,244,132
VE 12,252
Mvaa 140,248,136
VE 13,253
Mvaa 140,252,140
Vc 126,12,13
v_or3_b32 v7, v7, v110, v111
Cvaa 156,240,144,36
VE 14,254
Mvaa 156,244,148
VE 15,255
Mvaa 156,248,152
Vc 127,14,15
v_or3_b32 v7, v7, v118, v119
Mvaa 156,252,156
v_or3_b32 v7, v7, v126, v127
v_and_b32 v1, 0x40004000, v7
Cvaa 172,240,160,40
v_cmp_ne_u32 vcc, 0, v1
Mvaa 172,244,164
Mvaa 172,248,168
Mvaa 172,252,172
s_waitcnt vmcnt(12)
Cvaa 188,240,176,44
s_cmp_eq_u32 s37, s46
Mvaa 188,244,180
s_barrier
Mvaa 188,248,184
s_waitcnt lgkmcnt(4)
Mvaa 188,252,188
s_cbranch_vccnz L_k2_fb_wo
L_k2_fbr_wo:
Maav 0,192,96
s_cbranch_scc1 L_k2_mk_wo
L_k2_mkr_wo:
Ve 8,128
Maav 0,196,100
s_add_u32 m0, s53, 16384
VE 9,129
Maav 32,192,104
buffer_load_dwordx4 v4, s[12:15], s39 offen offset:0 sc1 lds
Maav 32,196,108
s_add_u32 s37, s37, 1
Ra 224,2,53248
Vc 64,8,9
Maav 64,192,112
s_add_u32 s38, s38, 34816
Ve 10,130
Maav 64,196,116
s_xor_b32 s53, s53, 65536
VE 11,131
Maav 96,192,120
s_xor_b32 s54, s54, 65536
Ra 228,2,61440
Vc 65,10,11
Maav 96,196,124
Ra 232,2,54272
v_or_b32_e64 v7, v64, v65
Maav 4,200,96
VE 12,144
Maav 4,204,100
VE 13,145
Maav 36,200,104
Ra 236,2,62464
Vc 72,12,13
Maav 36,204,108
VE 14,146
Maav 68,200,112
VE 15,147
Maav 68,204,116
Ra 240,2,55296
Vc 73,14,15
Maav 100,200,120
Ra 244,2,63488
v_or3_b32 v7, v7, v72, v73
Maav 100,204,124
buffer_load_dwordx4 v4, s[12:15], s39 offen offset:1024 sc1 lds
Mvvv 48,16,96
VE 8,160
Mvvv 48,16,100
s_waitcnt lgkmcnt(6)
Ve 9,161
Maav 8,208,96
Ra 248,2,56320
Vc 80,8,9
Maav 8,212,100
VE 10,162
Maav 40,208,104
VE 11,163
Maav 40,212,108
Ra 252,2,64512
Vc 81,10,11
Maav 72,208,112
Ra 192,3,32768
v_or3_b32 v7, v7, v80, v81
Maav 72,212,116
VE 12,176
Maav 104,208,120
VE 13,177
Maav 104,212,124
Ra 196,3,33792
Vc 88,12,13
Maav 12,216,96
VE 14,178
Maav 12,220,100
VE 15,179
Maav 44,216,104
Ra 200,3,34816
Vc 89,14,15
Maav 44,220,108
buffer_load_dwordx4 v4, s[12:15], s39 offen offset:2048 sc1 lds
Maav 76,216,112
Ra 204,3,35840
v_or3_b32 v7, v7, v88, v89
Maav 76,220,116
VE 8,132
Maav 108,216,120
VE 9,133
Maav 108,220,124
VE 10,134
Mvvv 52,16,104
VE 11,135
Mvvv 52,16,108
s_waitcnt lgkmcnt(8)
Ve 12,148
Maav 16,224,96
Ra 208,3,36864
Vc 66,8,9
Maav 16,228,100
Ra 212,3,37888
Vc 67,10,11
Maav 48,224,104
Ra 216,3,38912
v_or3_b32 v7, v7, v66, v67
Maav 48,228,108
VE 13,149
Maav 80,224,112
Ra 220,3,39936
Vc 74,12,13
Maav 80,228,116
VE 14,150
Maav 112,224,120
buffer_load_dwordx4 v4, s[12:15], s39 offen offset:3072 sc1 lds
Maav 112,228,124
s_add_u32 s39, s39, 34816
VE 15,151
Maav 20,232,96
VE 8,164
Maav 20,236,100
VE 9,165
Maav 52,232,104
VE 10,166
Maav 52,236,108
VE 11,167
Maav 84,232,112
Vc 75,14,15
Vc 82,8,9
Maav 84,236,116
VE 12,180
Maav 116,232,120
VE 13,181
Maav 116,236,124
Vc 83,10,11
Vc 90,12,13
Mvvv 56,16,112
VE 14,182
Mvvv 56,16,116
s_waitcnt lgkmcnt(8)
Ve 15,183
Maav 24,240,96
Vc 91,14,15
v_or3_b32 v7, v7, v74, v75
Maav 24,244,100
v_or3_b32 v7, v7, v82, v83
v_or3_b32 v7, v7, v90, v91
Maav 56,240,104
global_load_dword v30, v[28:29], off
Maav 56,244,108
Maav 88,240,112
Maav 88,244,116
Maav 120,240,120
Maav 120,244,124
Maav 28,248,96
Maav 28,252,100
Maav 60,248,104
Maav 60,252,108
Maav 92,248,112
Maav 92,252,116
Maav 124,248,120
Maav 124,252,124
s_cmp_lg_u32 s37, s35
Mvvv 60,16,120
s_waitcnt lgkmcnt(4)
Mvvv 60,16,124
s_cbranch_scc1 L_k2_wloop
L_k2_wlast:
v_xor_b32 v2, 65536, v2
v_xor_b32 v3, 65536, v3
Cvaa 192,192,128,32
s_mov_b32 m0, s53
Ra 224,2,40960
v_lshl_add_u64 v[28:29], s[40:41], 0, v[28:29]
Mvaa 192,196,132
buffer_load_dwordx4 v4, s[12:15], s38 offen offset:0 sc1 lds
Mvaa 192,200,136
VE 8,136
Mvaa 192,204,140
VE 9,137
Cvaa 208,192,144,36
Ra 228,2,41984
Vc 68,8,9
Mvaa 208,196,148
VE 10,138
Mvaa 208,200,152
VE 11,139
Mvaa 208,204,156
Ra 232,2,43008
Vc 69,10,11
Cvaa 224,192,160,40
Ra 236,2,44032
v_or3_b32 v7, v7, v68, v69
Mvaa 224,196,164
VE 12,152
Mvaa 224,200,168
VE 13,153
Mvaa 224,204,172
s_waitcnt lgkmcnt(4)
Ra 240,2,45056
Vc 76,12,13
Cvaa 196,208,128,32
buffer_load_dwordx4 v4, s[12:15], s38 offen offset:1024 sc1 lds
Mvaa 196,212,132
Ve 14,154
Mvaa 196,216,136
VE 15,155
Mvaa 196,220,140
Ra 244,2,46080
Vc 77,14,15
Cvaa 212,208,144,36
Ra 248,2,47104
v_or3_b32 v7, v7, v76, v77
Mvaa 212,212,148
VE 8,168
Mvaa 212,216,152
VE 9,169
Mvaa 212,220,156
Ra 252,2,48128
Vc 84,8,9
Cvaa 228,208,160,40
VE 10,170
Mvaa 228,212,164
buffer_load_dwordx4 v4, s[12:15], s38 offen offset:2048 sc1 lds
Mvaa 228,216,168
VE 11,171
Mvaa 228,220,172
s_waitcnt lgkmcnt(4)
Ra 192,2,16384
Vc 85,10,11
Cvaa 200,224,128,32
Ra 196,2,24576
v_or3_b32 v7, v7, v84, v85
Mvaa 200,228,132
Ve 12,184
Mvaa 200,232,136
VE 13,185
Mvaa 200,236,140
Ra 200,2,17408
Vc 92,12,13
Cvaa 216,224,144,36
VE 14,186
Mvaa 216,228,148
VE 15,187
Mvaa 216,232,152
Ra 204,2,25600
Vc 93,14,15
Mvaa 216,236,156
buffer_load_dwordx4 v4, s[12:15], s38 offen offset:3072 sc1 lds
Cvaa 232,224,160,40
Ra 208,2,18432
v_or3_b32 v7, v7, v92, v93
Mvaa 232,228,164
VE 8,140
Mvaa 232,232,168
VE 9,141
Mvaa 232,236,172
s_waitcnt lgkmcnt(5)
Ra 212,2,26624
Vc 70,8,9
Cvaa 204,240,128,32
Ve 10,142
Mvaa 204,244,132
VE 11,143
Mvaa 204,248,136
Ra 216,2,19456
Vc 71,10,11
Mvaa 204,252,140
Ra 220,2,27648
v_or3_b32 v7, v7, v70, v71
Cvaa 220,240,144,36
VE 12,156
Mvaa 220,244,148
VE 13,157
Mvaa 220,248,152
VE 14,158
Mvaa 220,252,156
s_waitcnt vmcnt(12)
Ve 15,159
Cvaa 236,240,160,40
VE 8,172
Mvaa 236,244,164
s_barrier
Ve 9,173
Mvaa 236,248,168
s_waitcnt lgkmcnt(4)
Vc 78,12,13
Vc 79,14,15
Ve 10,174
Ve 11,175
Ve 12,188
Ve 13,189
Ve 14,190
VE 15,191
Vc 86,8,9
Vc 87,10,11
Vc 94,12,13
Vc 95,14,15
v_or3_b32 v7, v7, v78, v79
v_or3_b32 v7, v7, v86, v87
v_or3_b32 v7, v7, v94, v95
v_and_b32 v1, 0x40004000, v7
v_cmp_ne_u32 vcc, 0, v1
Mvaa 236,252,172
s_cbranch_vccnz L_k2_fb_wl
L_k2_fbr_wl:
Maav 0,192,64
v_cmp_gt_i32 s[56:57], 0, v6
v_cmp_gt_i32 s[58:59], 1, v6
v_cmp_gt_i32 s[60:61], 2, v6
v_cmp_gt_i32 s[62:63], 3, v6
s_nop 3
s_nop 0
v_cndmask_b32 v224, v224, v20, s[56:57]
v_cndmask_b32 v225, v225, v20, s[58:59]
v_cndmask_b32 v226, v226, v20, s[60:61]
v_cndmask_b32 v227, v227, v20, s[62:63]
v_cmp_gt_i32 s[56:57], 16, v6
v_cmp_gt_i32 s[58:59], 17, v6
v_cmp_gt_i32 s[60:61], 18, v6
v_cmp_gt_i32 s[62:63], 19, v6
v_cndmask_b32 v228, v228, v20, s[56:57]
v_cndmask_b32 v229, v229, v20, s[58:59]
v_cndmask_b32 v230, v230, v20, s[60:61]
v_cndmask_b32 v231, v231, v20, s[62:63]
v_cmp_gt_i32 s[56:57], 32, v6
v_cmp_gt_i32 s[58:59], 33, v6
v_cmp_gt_i32 s[60:61], 34, v6
v_cmp_gt_i32 s[62:63], 35, v6
v_cndmask_b32 v232, v232, v20, s[56:57]
v_cndmask_b32 v233, v233, v20, s[58:59]
v_cndmask_b32 v234, v234, v20, s[60:61]
v_cndmask_b32 v235, v235, v20, s[62:63]
v_cmp_gt_i32 s[56:57], 48, v6
v_cmp_gt_i32 s[58:59], 49, v6
v_cmp_gt_i32 s[60:61], 50, v6
v_cmp_gt_i32 s[62:63], 51, v6
v_cndmask_b32 v236, v236, v20, s[56:57]
v_cndmask_b32 v237, v237, v20, s[58:59]
v_cndmask_b32 v238, v238, v20, s[60:61]
v_cndmask_b32 v239, v239, v20, s[62:63]
VE 8,192
Maav 0,196,68
s_add_u32 m0, s54, 49152
VE 9,193
Maav 32,192,72
buffer_load_dwordx4 v4, s[12:15], s39 offen offset:0 sc1 lds
Maav 32,196,76
s_add_u32 s37, s37, 1
Ra 224,2,20480
Vc 96,8,9
Maav 64,192,80
s_add_u32 s38, s38, 34816
Ve 10,194
Maav 64,196,84
VE 11,195
Maav 96,192,88
Ra 228,2,28672
Vc 97,10,11
Maav 96,196,92
Ra 232,2,21504
v_or_b32_e64 v7, v96, v97
Maav 4,200,64
VE 12,208
Maav 4,204,68
VE 13,209
Maav 36,200,72
Ra 236,2,29696
Vc 104,12,13
Maav 36,204,76
VE 14,210
Maav 68,200,80
VE 15,211
Maav 68,204,84
Ra 240,2,22528
Vc 105,14,15
Maav 100,200,88
Ra 244,2,30720
v_or3_b32 v7, v7, v104, v105
Maav 100,204,92
buffer_load_dwordx4 v4, s[12:15], s39 offen offset:1024 sc1 lds
Mvvv 48,16,64
VE 8,224
Mvvv 48,16,68
s_waitcnt lgkmcnt(6)
Ve 9,225
Maav 8,208,64
Ra 248,2,23552
Vc 112,8,9
Maav 8,212,68
VE 10,226
Maav 40,208,72
VE 11,227
Maav 40,212,76
Ra 252,2,31744
Vc 113,10,11
Maav 72,208,80
Ra 192,3,0
v_or3_b32 v7, v7, v112, v113
Maav 72,212,84
VE 12,196
Maav 104,208,88
VE 13,197
Maav 104,212,92
Ra 196,3,1024
Vc 98,12,13
Maav 12,216,64
VE 14,198
Maav 12,220,68
VE 15,199
Maav 44,216,72
Ra 200,3,2048
Vc 99,14,15
Maav 44,220,76
buffer_load_dwordx4 v4, s[12:15], s39 offen offset:2048 sc1 lds
Maav 76,216,80
Ra 204,3,3072
v_or3_b32 v7, v7, v98, v99
Maav 76,220,84
VE 8,212
Maav 108,216,88
VE 9,213
Maav 108,220,92
VE 10,214
Mvvv 52,16,72
VE 11,215
Mvvv 52,16,76
s_waitcnt lgkmcnt(8)
Ve 12,228
Maav 16,224,64
Ra 208,3,4096
Vc 106,8,9
Maav 16,228,68
Ra 212,3,5120
Vc 107,10,11
Maav 48,224,72
Ra 216,3,6144
v_or3_b32 v7, v7, v106, v107
Maav 48,228,76
VE 13,229
Maav 80,224,80
Ra 220,3,7168
Vc 114,12,13
Maav 80,228,84
VE 14,230
Maav 112,224,88
buffer_load_dwordx4 v4, s[12:15], s39 offen offset:3072 sc1 lds
Maav 112,228,92
s_add_u32 s39, s39, 34816
VE 15,231
Maav 20,232,64
VE 8,200
Maav 20,236,68
VE 9,201
Maav 52,232,72
VE 10,202
Maav 52,236,76
VE 11,203
Maav 84,232,80
Vc 115,14,15
Vc 100,8,9
Maav 84,236,84
VE 12,216
Maav 116,232,88
VE 13,217
Maav 116,236,92
Vc 101,10,11
Vc 108,12,13
Mvvv 56,16,80
VE 14,218
Mvvv 56,16,84
s_waitcnt lgkmcnt(8)
Ve 15,219
Maav 24,240,64
Vc 109,14,15
v_or3_b32 v7, v7, v114, v115
Maav 24,244,68
VE 8,232
Maav 56,240,72
global_load_dword v30, v[28:29], off
Maav 56,244,76
VE 9,233
Maav 88,240,80
Vc 116,8,9
v_or3_b32 v7, v7, v100, v101
Maav 88,244,84
VE 10,234
Maav 120,240,88
VE 11,235
Maav 120,244,92
Vc 117,10,11
v_or3_b32 v7, v7, v108, v109
Maav 28,248,64
v_or3_b32 v7, v7, v116, v117
Maav 28,252,68
Maav 60,248,72
Maav 60,252,76
Maav 92,248,80
Maav 92,252,84
Maav 124,248,88
Maav 124,252,92
Mvvv 60,16,88
s_waitcnt lgkmcnt(4)
Mvvv 60,16,92
Ve 12,204
Cvaa 128,192,128,32
s_add_u32 m0, s53, 32768
VE 13,205
Mvaa 128,196,132
buffer_load_dwordx4 v4, s[12:15], s38 offen offset:0 sc1 lds
Mvaa 128,200,136
Ra 224,3,8192
Vc 102,12,13
Mvaa 128,204,140
VE 14,206
Cvaa 144,192,144,36
VE 15,207
Mvaa 144,196,148
Ra 228,3,9216
Vc 103,14,15
Mvaa 144,200,152
Ra 232,3,10240
v_or3_b32 v7, v7, v102, v103
Mvaa 144,204,156
s_waitcnt lgkmcnt(3)
Ra 236,3,11264
Ra 240,3,12288
Cvaa 132,208,128,32
buffer_load_dwordx4 v4, s[12:15], s38 offen offset:1024 sc1 lds
Mvaa 132,212,132
Ve 8,220
Mvaa 132,216,136
VE 9,221
Mvaa 132,220,140
Ra 244,3,13312
Vc 110,8,9
Cvaa 148,208,144,36
VE 10,222
Mvaa 148,212,148
buffer_load_dwordx4 v4, s[12:15], s38 offen offset:2048 sc1 lds
Mvaa 148,216,152
VE 11,223
Mvaa 148,220,156
s_waitcnt lgkmcnt(2)
Ra 248,3,14336
Ra 252,3,15360
Cvaa 136,224,128,32
Ra 192,2,49152
Vc 111,10,11
Mvaa 136,228,132
Ra 196,2,57344
v_or3_b32 v7, v7, v110, v111
Mvaa 136,232,136
Ve 12,236
Mvaa 136,236,140
buffer_load_dwordx4 v4, s[12:15], s38 offen offset:3072 sc1 lds
Cvaa 152,224,144,36
VE 13,237
Mvaa 152,228,148
Ra 200,2,50176
Vc 118,12,13
Mvaa 152,232,152
VE 14,238
Mvaa 152,236,156
s_waitcnt lgkmcnt(3)
Ra 204,2,58368
Ra 208,2,51200
Cvaa 140,240,128,32
Ve 15,239
Mvaa 140,244,132
Ra 212,2,59392
Vc 119,14,15
Mvaa 140,248,136
Ra 216,2,52224
v_or3_b32 v7, v7, v118, v119
Mvaa 140,252,140
s_waitcnt vmcnt(12)
Ra 220,2,60416
v_and_b32 v1, 0x40004000, v7
Cvaa 156,240,144,36
s_cmp_eq_u32 s37, s45
v_cmp_ne_u32 vcc, 0, v1
Mvaa 156,244,148
s_barrier
Mvaa 156,248,152
s_waitcnt lgkmcnt(4)
Mvaa 156,252,156
s_cbranch_vccnz L_k2_fb_tr
L_k2_fbr_tr:
Maav 0,192,96
s_cbranch_scc1 L_k2_mk_tr
L_k2_mkr_tr:
Ve 8,128
Maav 0,196,100
s_add_u32 m0, s53, 16384
VE 9,129
Maav 32,192,104
buffer_load_dwordx4 v4, s[12:15], s39 offen offset:0 sc1 lds
Maav 32,196,108
s_add_u32 s37, s37, 1
Ra 224,2,53248
Vc 64,8,9
Maav 64,192,112
s_add_u32 s38, s38, 34816
Ve 10,130
Maav 64,196,116
s_xor_b32 s53, s53, 65536
VE 11,131
Maav 4,200,96
s_xor_b32 s54, s54, 65536
Ra 228,2,61440
Vc 65,10,11
Maav 4,204,100
Ra 232,2,54272
v_or_b32_e64 v7, v64, v65
Maav 36,200,104
VE 12,144
Maav 36,204,108
VE 13,145
Maav 68,200,112
Ra 236,2,62464
Vc 72,12,13
Maav 68,204,116
VE 14,146
Mvvv 48,16,96
VE 15,147
Mvvv 48,16,100
s_waitcnt lgkmcnt(4)
Ra 240,2,55296
Vc 73,14,15
Maav 8,208,96
buffer_load_dwordx4 v4, s[12:15], s39 offen offset:1024 sc1 lds
Maav 8,212,100
Ra 244,2,63488
v_or3_b32 v7, v7, v72, v73
Maav 40,208,104
Ve 8,132
Maav 40,212,108
VE 9,133
Maav 72,208,112
Ra 248,2,56320
Vc 66,8,9
Maav 72,212,116
VE 10,134
Maav 12,216,96
VE 11,135
Maav 12,220,100
Ra 252,2,64512
Vc 67,10,11
Maav 44,216,104
Ra 192,3,32768
v_or3_b32 v7, v7, v66, v67
Maav 44,220,108
VE 12,148
Maav 76,216,112
VE 13,149
Maav 76,220,116
Ra 196,3,33792
Vc 74,12,13
Mvvv 52,16,104
VE 14,150
Mvvv 52,16,108
s_waitcnt lgkmcnt(6)
Ve 15,151
Maav 16,224,96
buffer_load_dwordx4 v4, s[12:15], s39 offen offset:2048 sc1 lds
Maav 16,228,100
Ra 200,3,34816
Vc 75,14,15
Maav 48,224,104
Ra 204,3,35840
v_or3_b32 v7, v7, v74, v75
Maav 48,228,108
VE 8,136
Maav 80,224,112
Ra 208,3,36864
Ra 212,3,37888
Maav 80,228,116
Ra 216,3,38912
Ra 220,3,39936
Maav 20,232,96
Maav 20,236,100
Maav 52,232,104
Maav 52,236,108
Maav 84,232,112
Maav 84,236,116
buffer_load_dwordx4 v4, s[12:15], s39 offen offset:3072 sc1 lds
Mvvv 56,16,112
s_add_u32 s39, s39, 34816
Mvvv 56,16,116
s_waitcnt lgkmcnt(8)
Maav 24,240,96
Maav 24,244,100
Maav 56,240,104
Maav 56,244,108
Maav 88,240,112
Maav 88,244,116
Maav 28,248,96
Maav 28,252,100
Maav 60,248,104
Maav 60,252,108
Maav 92,248,112
s_waitcnt lgkmcnt(4)
Maav 92,252,116
s_getpc_b64 s[56:57]
L_cpf4:
s_add_u32 s56, s56, (L_k2_fin-L_cpf4)&0xffffffff
s_addc_u32 s57, s57, ((L_k2_fin-L_cpf4)>>32)&0xffffffff
s_lshr_b32 s58, s2, 3
s_lshl_b32 s58, s58, 2
s_add_u32 s58, s58, s32
s_lshl_b32 s58, s58, 10
v_and_b32 v162, 7, v0
v_lshlrev_b32 v162, 7, v162
v_add_u32 v162, s58, v162
v_min_u32 v162, L_p4_end-L_k2_fin-4, v162
v_mov_b32 v161, s57
v_add_co_u32 v160, vcc, s56, v162
s_nop 1
v_addc_co_u32 v161, vcc, 0, v161, vcc
global_load_dword v164, v[160:161], off
s_waitcnt vmcnt(9)
s_lshl_b32 s3, s34, 20
s_lshl_b32 s47, s33, 15
s_add_u32 s3, s3, s47
s_lshl_b32 s47, s32, 10
v_lshlrev_b32 v248, 4, v0
v_add_u32_e64 v249, s47, v248
s_sub_u32 s47, 7168, s47
v_add_u32 v248, s47, v248
v_rcp_f32 v250, v56
v_rcp_f32 v252, v60
v_mov_b32 v251, v250
v_mov_b32_e64 v253, v252
Ar 240,96
Ar 241,97
Ar 242,98
Ar 243,99
Ar 244,100
Ar 245,101
Ar 246,102
Ar 247,103
v_pk_mul_f32 v[240:241], v[240:241], v[252:253]
v_pk_mul_f32 v[242:243], v[242:243], v[252:253]
v_pk_mul_f32 v[244:245], v[244:245], v[252:253]
v_pk_mul_f32 v[246:247], v[246:247], v[252:253]
Vc 28,240,241
Vc 29,242,243
Vc 30,244,245
Vc 31,246,247
buffer_store_dwordx4 v[28:31], v249, s[16:19], s3 offen sc1
Ar 240,64
Ar 241,65
Ar 242,66
Ar 243,67
Ar 244,68
Ar 245,69
Ar 246,70
Ar 247,71
v_pk_mul_f32 v[240:241], v[240:241], v[250:251]
v_pk_mul_f32 v[242:243], v[242:243], v[250:251]
v_pk_mul_f32 v[244:245], v[244:245], v[250:251]
v_pk_mul_f32 v[246:247], v[246:247], v[250:251]
Vc 24,240,241
Vc 25,242,243
Vc 26,244,245
Vc 27,246,247
buffer_store_dwordx4 v[24:27], v248, s[16:19], s3 offen sc1
s_add_u32 s3, s3, 8192
Ar 240,104
Ar 241,105
Ar 242,106
Ar 243,107
Ar 244,108
Ar 245,109
Ar 246,110
Ar 247,111
v_pk_mul_f32 v[240:241], v[240:241], v[252:253]
v_pk_mul_f32 v[242:243], v[242:243], v[252:253]
v_pk_mul_f32 v[244:245], v[244:245], v[252:253]
v_pk_mul_f32 v[246:247], v[246:247], v[252:253]
Vc 28,240,241
Vc 29,242,243
Vc 30,244,245
Vc 31,246,247
buffer_store_dwordx4 v[28:31], v249, s[16:19], s3 offen sc1
Ar 240,72
Ar 241,73
Ar 242,74
Ar 243,75
Ar 244,76
Ar 245,77
Ar 246,78
Ar 247,79
v_pk_mul_f32 v[240:241], v[240:241], v[250:251]
v_pk_mul_f32 v[242:243], v[242:243], v[250:251]
v_pk_mul_f32 v[244:245], v[244:245], v[250:251]
v_pk_mul_f32 v[246:247], v[246:247], v[250:251]
Vc 24,240,241
Vc 25,242,243
Vc 26,244,245
Vc 27,246,247
buffer_store_dwordx4 v[24:27], v248, s[16:19], s3 offen sc1
s_add_u32 s3, s3, 8192
Ar 240,112
Ar 241,113
Ar 242,114
Ar 243,115
Ar 244,116
Ar 245,117
Ar 246,118
Ar 247,119
v_pk_mul_f32 v[240:241], v[240:241], v[252:253]
v_pk_mul_f32 v[242:243], v[242:243], v[252:253]
v_pk_mul_f32 v[244:245], v[244:245], v[252:253]
v_pk_mul_f32 v[246:247], v[246:247], v[252:253]
Vc 28,240,241
Vc 29,242,243
Vc 30,244,245
Vc 31,246,247
buffer_store_dwordx4 v[28:31], v249, s[16:19], s3 offen sc1
Ar 240,80
Ar 241,81
Ar 242,82
Ar 243,83
Ar 244,84
Ar 245,85
Ar 246,86
Ar 247,87
v_pk_mul_f32 v[240:241], v[240:241], v[250:251]
v_pk_mul_f32 v[242:243], v[242:243], v[250:251]
v_pk_mul_f32 v[244:245], v[244:245], v[250:251]
v_pk_mul_f32 v[246:247], v[246:247], v[250:251]
Vc 24,240,241
Vc 25,242,243
Vc 26,244,245
Vc 27,246,247
buffer_store_dwordx4 v[24:27], v248, s[16:19], s3 offen sc1
s_add_u32 s3, s3, 8192
Ar 240,120
Ar 241,121
Ar 242,122
Ar 243,123
Ar 244,124
Ar 245,125
Ar 246,126
Ar 247,127
v_pk_mul_f32 v[240:241], v[240:241], v[252:253]
v_pk_mul_f32 v[242:243], v[242:243], v[252:253]
v_pk_mul_f32 v[244:245], v[244:245], v[252:253]
v_pk_mul_f32 v[246:247], v[246:247], v[252:253]
Vc 28,240,241
Vc 29,242,243
Vc 30,244,245
Vc 31,246,247
buffer_store_dwordx4 v[28:31], v249, s[16:19], s3 offen sc1
Ar 240,88
Ar 241,89
Ar 242,90
Ar 243,91
Ar 244,92
Ar 245,93
Ar 246,94
Ar 247,95
v_pk_mul_f32 v[240:241], v[240:241], v[250:251]
v_pk_mul_f32 v[242:243], v[242:243], v[250:251]
v_pk_mul_f32 v[244:245], v[244:245], v[250:251]
v_pk_mul_f32 v[246:247], v[246:247], v[250:251]
Vc 24,240,241
Vc 25,242,243
Vc 26,244,245
Vc 27,246,247
buffer_store_dwordx4 v[24:27], v248, s[16:19], s3 offen sc1
s_add_u32 s52, s37, 2
s_load_dwordx2 s[94:95], s[0:1], 40
s_load_dwordx2 s[40:41], s[0:1], 0
s_load_dwordx4 s[8:11], s[0:1], 80
s_waitcnt vmcnt(8) lgkmcnt(0)
s_add_u32 s93, s2, 224
s_and_b32 s93, s93, 255
s_nop 0
s_mul_i32 s92, s93, 2341
s_lshr_b32 s92, s92, 16
s_mul_i32 s47, s92, 28
s_sub_u32 s4, s93, s47
s_mul_i32 s5, s92, 917504
s_lshl_b32 s47, s4, 8
s_add_u32 s5, s5, s47
s_cmp_eq_u32 s34, 7
s_cbranch_scc1 L_k2_fin
L_k2_nloop:
v_xor_b32 v2, 65536, v2
v_xor_b32 v3, 65536, v3
Cvaa 192,192,128,32
s_mov_b32 m0, s53
Ve 9,137
Mvaa 192,196,132
buffer_load_dwordx4 v4, s[12:15], s38 offen offset:0 sc1 lds
Mvaa 192,200,136
Ra 224,2,40960
Vc 68,8,9
Mvaa 192,204,140
VE 10,138
Cvaa 208,192,144,36
VE 11,139
Mvaa 208,196,148
Ra 228,2,41984
Vc 69,10,11
Mvaa 208,200,152
Ra 232,2,43008
v_or3_b32 v7, v7, v68, v69
Mvaa 208,204,156
s_waitcnt lgkmcnt(3)
Ra 236,2,44032
Ra 240,2,45056
Cvaa 196,208,128,32
buffer_load_dwordx4 v4, s[12:15], s38 offen offset:1024 sc1 lds
Mvaa 196,212,132
Ve 12,152
Mvaa 196,216,136
VE 13,153
Mvaa 196,220,140
Ra 244,2,46080
Vc 76,12,13
Cvaa 212,208,144,36
VE 14,154
Mvaa 212,212,148
buffer_load_dwordx4 v4, s[12:15], s38 offen offset:2048 sc1 lds
Mvaa 212,216,152
VE 15,155
Mvaa 212,220,156
s_waitcnt lgkmcnt(2)
Ra 248,2,47104
Ra 252,2,48128
Cvaa 200,224,128,32
Ra 192,2,16384
Vc 77,14,15
Mvaa 200,228,132
Ra 196,2,24576
v_or3_b32 v7, v7, v76, v77
Mvaa 200,232,136
Ve 8,140
Mvaa 200,236,140
buffer_load_dwordx4 v4, s[12:15], s38 offen offset:3072 sc1 lds
Cvaa 216,224,144,36
VE 9,141
Mvaa 216,228,148
Ra 200,2,17408
Vc 70,8,9
Mvaa 216,232,152
VE 10,142
Mvaa 216,236,156
s_waitcnt lgkmcnt(3)
Ra 204,2,25600
Ra 208,2,18432
Cvaa 204,240,128,32
Ve 11,143
Mvaa 204,244,132
s_cmp_lt_u32 s37, s52
Ra 212,2,26624
Vc 71,10,11
Mvaa 204,248,136
s_cbranch_scc1 L_nw_ne
s_waitcnt vmcnt(12)
L_nw_ne:
Ra 216,2,19456
v_or3_b32 v7, v7, v70, v71
Mvaa 204,252,140
Ve 12,156
Cvaa 220,240,144,36
VE 13,157
Mvaa 220,244,148
s_barrier
Ra 220,2,27648
Vc 78,12,13
Mvaa 220,248,152
s_waitcnt lgkmcnt(4)
Ve 14,158
Ve 15,159
s_nop 0
Vc 79,14,15
v_or3_b32 v7, v7, v78, v79
v_and_b32 v1, 0x40004000, v7
v_cmp_ne_u32 vcc, 0, v1
Mvaa 220,252,156
s_cbranch_vccnz L_k2_fb_ne
L_k2_fbr_ne:
Maav 0,192,64
Ve 8,192
Maav 0,196,68
s_add_u32 m0, s54, 49152
VE 9,193
Maav 32,192,72
buffer_load_dwordx4 v4, s[12:15], s39 offen offset:0 sc1 lds
Maav 32,196,76
s_cmp_eq_u32 s37, s52
Ra 224,2,20480
Vc 96,8,9
Maav 4,200,64
s_cbranch_scc1 L_pubB
L_pubBr:
VE 10,194
Maav 4,204,68
s_add_u32 s37, s37, 1
Ve 11,195
Maav 36,200,72
s_add_u32 s38, s38, 34816
Ra 228,2,28672
Vc 97,10,11
Maav 36,204,76
Ra 232,2,21504
v_or_b32_e64 v7, v96, v97
Mvvv 48,16,64
VE 12,208
Mvvv 48,16,68
s_waitcnt lgkmcnt(3)
Ra 236,2,29696
Ra 240,2,22528
Maav 8,208,64
buffer_load_dwordx4 v4, s[12:15], s39 offen offset:1024 sc1 lds
Maav 8,212,68
Ve 13,209
Maav 40,208,72
Ra 244,2,30720
Vc 104,12,13
Maav 40,212,76
VE 14,210
Maav 12,216,64
VE 15,211
Maav 12,220,68
Ra 248,2,23552
Vc 105,14,15
Maav 44,216,72
Ra 252,2,31744
v_or3_b32 v7, v7, v104, v105
Maav 44,220,76
VE 8,196
Mvvv 52,16,72
buffer_load_dwordx4 v4, s[12:15], s39 offen offset:2048 sc1 lds
Mvvv 52,16,76
s_waitcnt lgkmcnt(4)
Ve 9,197
Maav 16,224,64
Ra 192,3,0
Vc 98,8,9
Maav 16,228,68
VE 10,198
Maav 48,224,72
VE 11,199
Maav 48,228,76
Ra 196,3,1024
Vc 99,10,11
Maav 20,232,64
Ra 200,3,2048
v_or3_b32 v7, v7, v98, v99
Maav 20,236,68
Ra 204,3,3072
Ra 208,3,4096
Maav 52,232,72
buffer_load_dwordx4 v4, s[12:15], s39 offen offset:3072 sc1 lds
Maav 52,236,76
s_waitcnt lgkmcnt(5)
Ve 12,212
Maav 24,240,64
s_add_u32 s39, s39, 34816
VE 13,213
Maav 24,244,68
Ra 212,3,5120
Vc 106,12,13
Maav 56,240,72
VE 14,214
Maav 56,244,76
VE 15,215
Maav 28,248,64
Ra 216,3,6144
Vc 107,14,15
Maav 28,252,68
Ra 220,3,7168
v_or3_b32 v7, v7, v106, v107
Maav 60,248,72
s_waitcnt lgkmcnt(4)
Ve 8,200
Maav 60,252,76
VE 9,201
Cvaa 128,192,128,32
s_add_u32 m0, s53, 32768
Ra 224,3,8192
Vc 100,8,9
Mvaa 128,196,132
buffer_load_dwordx4 v4, s[12:15], s38 offen offset:0 sc1 lds
Mvaa 128,200,136
VE 10,202
Mvaa 128,204,140
VE 11,203
Cvaa 144,192,144,36
Ra 228,3,9216
Vc 101,10,11
Mvaa 144,196,148
Ra 232,3,10240
v_or3_b32 v7, v7, v100, v101
Mvaa 144,200,152
VE 12,216
Mvaa 144,204,156
s_waitcnt lgkmcnt(3)
Ra 236,3,11264
Ra 240,3,12288
Cvaa 132,208,128,32
buffer_load_dwordx4 v4, s[12:15], s38 offen offset:1024 sc1 lds
Mvaa 132,212,132
Ve 13,217
Mvaa 132,216,136
Ra 244,3,13312
Vc 108,12,13
Mvaa 132,220,140
VE 14,218
Cvaa 148,208,144,36
VE 15,219
Mvaa 148,212,148
buffer_load_dwordx4 v4, s[12:15], s38 offen offset:2048 sc1 lds
Mvaa 148,216,152
Ra 248,3,14336
Vc 109,14,15
Mvaa 148,220,156
s_waitcnt lgkmcnt(3)
Ra 252,3,15360
v_or3_b32 v7, v7, v108, v109
Cvaa 136,224,128,32
Ve 8,204
Mvaa 136,228,132
VE 9,205
Mvaa 136,232,136
Ra 192,2,49152
Vc 102,8,9
Mvaa 136,236,140
buffer_load_dwordx4 v4, s[12:15], s38 offen offset:3072 sc1 lds
Cvaa 152,224,144,36
VE 10,206
Mvaa 152,228,148
VE 11,207
Mvaa 152,232,152
Ra 196,2,57344
Vc 103,10,11
Mvaa 152,236,156
s_waitcnt lgkmcnt(2)
Ra 200,2,50176
Ra 204,2,58368
Cvaa 140,240,128,32
Ra 208,2,51200
v_or3_b32 v7, v7, v102, v103
Mvaa 140,244,132
s_cmp_lt_u32 s37, s52
VE 12,220
Mvaa 140,248,136
s_cbranch_scc1 L_nw_no
s_waitcnt vmcnt(12)
L_nw_no:
VE 13,221
Mvaa 140,252,140
Ra 212,2,59392
Vc 110,12,13
Cvaa 156,240,144,36
s_cmp_eq_u32 s37, s45
Ve 14,222
Mvaa 156,244,148
s_barrier
Ve 15,223
Mvaa 156,248,152
s_waitcnt lgkmcnt(2)
Ra 216,2,52224
Vc 111,14,15
v_or3_b32 v7, v7, v110, v111
v_and_b32 v1, 0x40004000, v7
v_cmp_ne_u32 vcc, 0, v1
Mvaa 156,252,156
s_cbranch_vccnz L_k2_fb_no
L_k2_fbr_no:
Ra 220,2,60416
Maav 0,192,96
s_cbranch_scc1 L_k2_mk_no
L_k2_mkr_no:
VE 8,128
Maav 0,196,100
s_add_u32 m0, s53, 16384
VE 9,129
Maav 32,192,104
buffer_load_dwordx4 v4, s[12:15], s39 offen offset:0 sc1 lds
Maav 32,196,108
s_add_u32 s37, s37, 1
Ra 224,2,53248
Vc 64,8,9
Maav 4,200,96
s_add_u32 s38, s38, 34816
Ve 10,130
Maav 4,204,100
s_xor_b32 s53, s53, 65536
VE 11,131
Maav 36,200,104
s_xor_b32 s54, s54, 65536
Ra 228,2,61440
Vc 65,10,11
Maav 36,204,108
Ra 232,2,54272
v_or_b32_e64 v7, v64, v65
Mvvv 48,16,96
VE 12,144
Mvvv 48,16,100
s_waitcnt lgkmcnt(3)
Ra 236,2,62464
Ra 240,2,55296
Maav 8,208,96
buffer_load_dwordx4 v4, s[12:15], s39 offen offset:1024 sc1 lds
Maav 8,212,100
Ve 13,145
Maav 40,208,104
Ra 244,2,63488
Vc 72,12,13
Maav 40,212,108
VE 14,146
Maav 12,216,96
VE 15,147
Maav 12,220,100
Ra 248,2,56320
Vc 73,14,15
Maav 44,216,104
Ra 252,2,64512
v_or3_b32 v7, v7, v72, v73
Maav 44,220,108
VE 8,132
Mvvv 52,16,104
buffer_load_dwordx4 v4, s[12:15], s39 offen offset:2048 sc1 lds
Mvvv 52,16,108
s_waitcnt lgkmcnt(4)
Ve 9,133
Maav 16,224,96
Ra 192,3,32768
Vc 66,8,9
Maav 16,228,100
VE 10,134
Maav 48,224,104
VE 11,135
Maav 48,228,108
Ra 196,3,33792
Vc 67,10,11
Maav 20,232,96
Ra 200,3,34816
v_or3_b32 v7, v7, v66, v67
Maav 20,236,100
Ra 204,3,35840
Ra 208,3,36864
Maav 52,232,104
buffer_load_dwordx4 v4, s[12:15], s39 offen offset:3072 sc1 lds
Maav 52,236,108
s_waitcnt lgkmcnt(5)
Ve 12,148
Maav 24,240,96
s_add_u32 s39, s39, 34816
VE 13,149
Maav 24,244,100
Ra 212,3,37888
Vc 74,12,13
Maav 56,240,104
VE 14,150
Maav 56,244,108
VE 15,151
Maav 28,248,96
Ra 216,3,38912
Vc 75,14,15
Maav 28,252,100
s_cmp_lg_u32 s37, s36
Ra 220,3,39936
v_or3_b32 v7, v7, v74, v75
Maav 60,248,104
s_waitcnt lgkmcnt(4)
VE 8,136
Maav 60,252,108
s_cbranch_scc1 L_k2_nloop
L_k2_fin:
v_xor_b32 v2, 65536, v2
v_xor_b32 v3, 65536, v3
s_lshr_b32 s3, s42, 4
s_mul_i32 s3, s3, 33792
s_and_b32 s47, s42, 15
s_lshl_b32 s47, s47, 4
s_add_u32 s3, s3, s47
v_mov_b32 v28, s3
s_lshr_b32 s3, s43, 4
s_mul_i32 s3, s3, 33792
s_and_b32 s47, s43, 15
s_lshl_b32 s47, s47, 4
s_add_u32 s3, s3, s47
v_mov_b32 v29, s3
v_lshrrev_b32 v24, 4, v0
v_and_b32 v25, 15, v0
v_cmp_eq_u32 vcc, 1, v25
s_lshl_b32 s3, s32, 4
v_add_u32 v26, s3, v24
v_cndmask_b32 v28, v28, v29, vcc
v_lshl_add_u32 v28, v24, 8, v28
v_mul_u32_u24 v26, 7168, v26
v_lshlrev_b32 v24, 1, v24
v_xor_b32 v24, v24, v25
v_xor_b32 v25, 8, v24
v_lshl_add_u32 v24, v24, 4, v26
v_lshl_add_u32 v25, v25, 4, v26
s_lshl_b32 s3, s92, 12
buffer_load_dwordx4 a[160:163], v28, s[20:23], s3 offen offset:0 sc1
buffer_load_dwordx4 a[164:167], v28, s[20:23], s3 offen offset:1024 sc1
buffer_load_dwordx4 a[168:171], v28, s[20:23], s3 offen offset:2048 sc1
buffer_load_dwordx4 a[172:175], v28, s[20:23], s3 offen offset:3072 sc1
Cvaa 192,192,128,32
s_add_u32 m0, s54, 0
s_add_u32 s3, s5, 0
Ve 9,137
Mvaa 192,196,132
buffer_load_dwordx4 v24, s[24:27], s3 offen offset:0 lds
Mvaa 192,200,136
Ra 224,2,40960
Ra 228,2,41984
Mvaa 192,204,140
s_waitcnt lgkmcnt(2)
Ra 232,2,43008
Ra 236,2,44032
Cvaa 196,208,128,32
s_add_u32 s3, s5, 27648
Ra 240,2,45056
Vc 68,8,9
Mvaa 196,212,132
buffer_load_dwordx4 v24, s[24:27], s3 offen offset:1024 lds
Mvaa 196,216,136
Ra 244,2,46080
Ra 248,2,47104
Mvaa 196,220,140
s_waitcnt lgkmcnt(3)
s_add_u32 s3, s5, 55296
Ra 252,2,48128
Ra 192,2,16384
Cvaa 200,224,128,32
buffer_load_dwordx4 v25, s[24:27], s3 offen offset:2048 lds
Mvaa 200,228,132
s_cmp_lt_u32 s37, s52
Ve 10,138
Mvaa 200,232,136
s_cbranch_scc1 L_nw_nl
s_waitcnt vmcnt(15)
L_nw_nl:
Ra 196,2,24576
Ra 200,2,17408
Mvaa 200,236,140
s_waitcnt lgkmcnt(3)
s_add_u32 s3, s5, 82944
Ra 204,2,25600
Ra 208,2,18432
Cvaa 204,240,128,32
buffer_load_dwordx4 v25, s[24:27], s3 offen offset:3072 lds
Mvaa 204,244,132
s_barrier
VE 11,139
Mvaa 204,248,136
s_waitcnt lgkmcnt(1)
Ra 212,2,26624
Vc 69,10,11
Ve 12,152
Ve 13,153
Ve 14,154
Ve 15,155
Ve 8,140
Ve 9,141
Ve 10,142
VE 11,143
Vc 76,12,13
Ve 12,156
Ve 13,157
Vc 77,14,15
Ve 14,158
Ve 15,159
Vc 70,8,9
Vc 71,10,11
Vc 78,12,13
Vc 79,14,15
v_or3_b32 v7, v7, v68, v69
v_or3_b32 v7, v7, v76, v77
v_or3_b32 v7, v7, v70, v71
v_or3_b32 v7, v7, v78, v79
v_and_b32 v1, 0x40004000, v7
v_cmp_ne_u32 vcc, 0, v1
Mvaa 204,252,140
s_cbranch_vccnz L_k2_fb_nl
L_k2_fbr_nl:
Ra 216,2,19456
Ra 220,2,27648
Maav 0,192,64
v_cmp_gt_i32 s[56:57], 0, v6
v_cmp_gt_i32 s[58:59], 1, v6
v_cmp_gt_i32 s[60:61], 2, v6
v_cmp_gt_i32 s[62:63], 3, v6
s_nop 3
s_nop 0
v_cndmask_b32 v192, v192, v20, s[56:57]
v_cndmask_b32 v193, v193, v20, s[58:59]
v_cndmask_b32 v194, v194, v20, s[60:61]
v_cndmask_b32 v195, v195, v20, s[62:63]
v_cmp_gt_i32 s[56:57], 16, v6
v_cmp_gt_i32 s[58:59], 17, v6
v_cmp_gt_i32 s[60:61], 18, v6
v_cmp_gt_i32 s[62:63], 19, v6
v_cndmask_b32 v196, v196, v20, s[56:57]
v_cndmask_b32 v197, v197, v20, s[58:59]
v_cndmask_b32 v198, v198, v20, s[60:61]
v_cndmask_b32 v199, v199, v20, s[62:63]
v_cmp_gt_i32 s[56:57], 32, v6
v_cmp_gt_i32 s[58:59], 33, v6
v_cmp_gt_i32 s[60:61], 34, v6
v_cmp_gt_i32 s[62:63], 35, v6
v_cndmask_b32 v200, v200, v20, s[56:57]
v_cndmask_b32 v201, v201, v20, s[58:59]
v_cndmask_b32 v202, v202, v20, s[60:61]
v_cndmask_b32 v203, v203, v20, s[62:63]
v_cmp_gt_i32 s[56:57], 48, v6
v_cmp_gt_i32 s[58:59], 49, v6
v_cmp_gt_i32 s[60:61], 50, v6
v_cmp_gt_i32 s[62:63], 51, v6
v_cndmask_b32 v204, v204, v20, s[56:57]
v_cndmask_b32 v205, v205, v20, s[58:59]
v_cndmask_b32 v206, v206, v20, s[60:61]
v_cndmask_b32 v207, v207, v20, s[62:63]
VE 8,192
Maav 0,196,68
s_add_u32 m0, s54, 16384
s_add_u32 s3, s5, 458752
VE 9,193
Maav 32,192,72
buffer_load_dwordx4 v24, s[24:27], s3 offen offset:0 lds
Maav 32,196,76
s_add_u32 s3, s5, 486400
Ra 224,2,20480
Vc 96,8,9
Maav 4,200,64
buffer_load_dwordx4 v24, s[24:27], s3 offen offset:1024 lds
Maav 4,204,68
s_mov_b32 s60, s8
s_and_b32 s61, s9, 0xffff
Ve 10,194
Maav 36,200,72
s_add_u32 s3, s5, 514048
VE 11,195
Maav 36,204,76
buffer_load_dwordx4 v25, s[24:27], s3 offen offset:2048 lds
Mvvv 48,16,64
s_mov_b32 s62, 7340032
Ra 228,2,28672
Vc 97,10,11
Mvvv 48,16,68
s_waitcnt lgkmcnt(2)
s_add_u32 s3, s5, 541696
Ra 232,2,21504
Ra 236,2,29696
Maav 8,208,64
buffer_load_dwordx4 v25, s[24:27], s3 offen offset:3072 lds
Maav 8,212,68
s_add_u32 m0, s54, 32768
s_add_u32 s3, s5, 0
Ra 240,2,22528
v_or_b32_e64 v7, v96, v97
Maav 40,208,72
buffer_load_dwordx4 v24, s[68:71], s3 offen offset:0 lds
Maav 40,212,76
s_mov_b32 s63, 0x20000
s_mov_b32 s56, s40
Ve 12,196
Maav 12,216,64
s_add_u32 s3, s5, 27648
VE 13,197
Maav 12,220,68
buffer_load_dwordx4 v24, s[68:71], s3 offen offset:1024 lds
Maav 44,216,72
s_and_b32 s57, s41, 0xffff
Ra 244,2,30720
Vc 98,12,13
Maav 44,220,76
s_add_u32 s3, s5, 55296
VE 14,198
Mvvv 52,16,72
buffer_load_dwordx4 v25, s[68:71], s3 offen offset:2048 lds
Mvvv 52,16,76
s_waitcnt lgkmcnt(2)
s_add_u32 s3, s5, 82944
Ra 248,2,23552
Ra 252,2,31744
Maav 16,224,64
buffer_load_dwordx4 v25, s[68:71], s3 offen offset:3072 lds
Maav 16,228,68
s_mov_b32 s58, 4194304
s_mov_b32 s59, 0x20000
Ve 15,199
Maav 48,224,72
s_add_u32 m0, s54, 49152
s_add_u32 s3, s5, 458752
Ra 192,2,49152
Vc 99,14,15
Maav 48,228,76
buffer_load_dwordx4 v24, s[68:71], s3 offen offset:0 lds
Maav 20,232,64
s_bfe_u32 s6, s2, 0x20001
Ra 196,2,57344
v_or3_b32 v7, v7, v98, v99
Maav 20,236,68
s_add_u32 s3, s5, 486400
Ra 200,2,50176
Ra 204,2,58368
Maav 52,232,72
buffer_load_dwordx4 v24, s[68:71], s3 offen offset:1024 lds
Maav 52,236,76
s_waitcnt lgkmcnt(4)
s_add_u32 s3, s5, 514048
Ve 8,200
Maav 24,240,64
buffer_load_dwordx4 v25, s[68:71], s3 offen offset:2048 lds
Maav 24,244,68
s_lshr_b32 s7, s34, 1
s_lshl_b32 s45, s7, 2
VE 9,201
Maav 56,240,72
s_add_u32 s3, s5, 541696
Ra 208,2,51200
Vc 100,8,9
Maav 56,244,76
buffer_load_dwordx4 v25, s[68:71], s3 offen offset:3072 lds
Maav 28,248,64
s_add_u32 s46, s45, s6
s_sub_u32 s46, 15, s46
VE 10,202
Maav 28,252,68
s_sub_u32 s45, 12, s45
Ra 212,2,59392
Ra 216,2,52224
Maav 60,248,72
s_waitcnt lgkmcnt(3)
Ra 220,2,60416
Ve 11,203
Ve 12,204
Ve 13,205
Ve 14,206
VE 15,207
Vc 101,10,11
Vc 102,12,13
Vc 103,14,15
v_or3_b32 v7, v7, v100, v101
v_or3_b32 v7, v7, v102, v103
Maav 60,252,76
s_add_u32 s45, s45, s6
v_and_b32 v1, 0x40004000, v7
v_cmp_ne_u32 vcc, 0, v1
s_cbranch_vccnz L_k2_fb_fi
L_k2_fbr_fi:
Maav 0,192,96
Ra 224,2,53248
Ra 228,2,61440
Maav 0,196,100
Ra 232,2,54272
Ra 236,2,62464
Maav 4,200,96
Ra 240,2,55296
Ra 244,2,63488
Maav 4,204,100
Ra 248,2,56320
Ra 252,2,64512
Mvvv 48,16,96
s_cmp_lt_u32 s7, 2
s_cselect_b32 s45, s46, s45
Mvvv 48,16,100
s_waitcnt lgkmcnt(8)
Maav 8,208,96
s_and_b32 s46, s2, 1
s_bfe_u32 s6, s2, 0x30003
s_lshl_b32 s6, s6, 1
Maav 8,212,100
s_add_u32 s46, s46, s6
s_mov_b32 s48, 0
s_mov_b32 s49, 15360
Maav 12,216,96
s_mov_b32 s50, 30720
s_mov_b32 s51, 46080
s_lshl_b32 s35, s32, 13
Maav 12,220,100
s_waitcnt lgkmcnt(4)
Maav 16,224,96
s_add_u32 s35, s35, 131072
s_and_b32 s52, s46, 1
s_lshl_b32 s37, s45, 20
Maav 16,228,100
s_lshl_b32 s7, s52, 19
s_add_u32 s37, s37, s7
s_add_u32 s37, s37, 46137344
Maav 20,232,96
s_lshr_b32 s7, s46, 1
s_lshl_b32 s7, s7, 8
s_lshl_b32 s6, s52, 22
Maav 20,236,100
s_waitcnt lgkmcnt(0)
Maav 24,240,96
s_add_u32 s6, s6, s7
s_add_u32 s12, s94, s6
s_addc_u32 s13, s95, 0
s_and_b32 s13, s13, 0xffff
Maav 24,244,100
s_mov_b32 s14, 0
s_mov_b32 s15, 0x20000
s_sub_u32 s14, 4194304, s7
Maav 28,248,96
s_mov_b32 s28, s94
s_and_b32 s29, s95, 0xffff
s_mov_b32 s30, 8388608
Maav 28,252,100
s_mov_b32 s31, 0x20000
s_lshl_b32 s7, s46, 7
s_lshl_b32 s36, s45, 18
s_nop 7
s_lshl_b32 s3, s55, 20
s_lshl_b32 s47, s33, 15
s_add_u32 s3, s3, s47
s_lshl_b32 s47, s32, 10
v_lshlrev_b32 v248, 4, v0
v_add_u32 v249, s47, v248
s_sub_u32 s47, 7168, s47
v_add_u32 v248, s47, v248
v_rcp_f32 v250, v48
v_rcp_f32 v252, v52
v_mov_b32 v251, v250
v_mov_b32_e64 v253, v252
Ar 240,32
Ar 241,33
Ar 242,34
Ar 243,35
Ar 244,36
Ar 245,37
Ar 246,38
Ar 247,39
v_pk_mul_f32 v[240:241], v[240:241], v[252:253]
v_pk_mul_f32 v[242:243], v[242:243], v[252:253]
v_pk_mul_f32 v[244:245], v[244:245], v[252:253]
v_pk_mul_f32 v[246:247], v[246:247], v[252:253]
Vc 28,240,241
Vc 29,242,243
Vc 30,244,245
Vc 31,246,247
buffer_store_dwordx4 v[28:31], v249, s[16:19], s3 offen sc1
Ar 240,0
Ar 241,1
Ar 242,2
Ar 243,3
Ar 244,4
Ar 245,5
Ar 246,6
Ar 247,7
v_pk_mul_f32 v[240:241], v[240:241], v[250:251]
v_pk_mul_f32 v[242:243], v[242:243], v[250:251]
v_pk_mul_f32 v[244:245], v[244:245], v[250:251]
v_pk_mul_f32 v[246:247], v[246:247], v[250:251]
Vc 24,240,241
Vc 25,242,243
Vc 26,244,245
Vc 27,246,247
buffer_store_dwordx4 v[24:27], v248, s[16:19], s3 offen sc1
s_add_u32 s3, s3, 8192
Ar 240,40
Ar 241,41
Ar 242,42
Ar 243,43
Ar 244,44
Ar 245,45
Ar 246,46
Ar 247,47
v_pk_mul_f32 v[240:241], v[240:241], v[252:253]
v_pk_mul_f32 v[242:243], v[242:243], v[252:253]
v_pk_mul_f32 v[244:245], v[244:245], v[252:253]
v_pk_mul_f32 v[246:247], v[246:247], v[252:253]
Vc 28,240,241
Vc 29,242,243
Vc 30,244,245
Vc 31,246,247
buffer_store_dwordx4 v[28:31], v249, s[16:19], s3 offen sc1
Ar 240,8
Ar 241,9
Ar 242,10
Ar 243,11
Ar 244,12
Ar 245,13
Ar 246,14
Ar 247,15
v_pk_mul_f32 v[240:241], v[240:241], v[250:251]
v_pk_mul_f32 v[242:243], v[242:243], v[250:251]
v_pk_mul_f32 v[244:245], v[244:245], v[250:251]
v_pk_mul_f32 v[246:247], v[246:247], v[250:251]
Vc 24,240,241
Vc 25,242,243
Vc 26,244,245
Vc 27,246,247
buffer_store_dwordx4 v[24:27], v248, s[16:19], s3 offen sc1
s_add_u32 s3, s3, 8192
Ar 240,48
Ar 241,49
Ar 242,50
Ar 243,51
Ar 244,52
Ar 245,53
Ar 246,54
Ar 247,55
v_pk_mul_f32 v[240:241], v[240:241], v[252:253]
v_pk_mul_f32 v[242:243], v[242:243], v[252:253]
v_pk_mul_f32 v[244:245], v[244:245], v[252:253]
v_pk_mul_f32 v[246:247], v[246:247], v[252:253]
Vc 28,240,241
Vc 29,242,243
Vc 30,244,245
Vc 31,246,247
buffer_store_dwordx4 v[28:31], v249, s[16:19], s3 offen sc1
Ar 240,16
Ar 241,17
Ar 242,18
Ar 243,19
Ar 244,20
Ar 245,21
Ar 246,22
Ar 247,23
v_pk_mul_f32 v[240:241], v[240:241], v[250:251]
v_pk_mul_f32 v[242:243], v[242:243], v[250:251]
v_pk_mul_f32 v[244:245], v[244:245], v[250:251]
v_pk_mul_f32 v[246:247], v[246:247], v[250:251]
Vc 24,240,241
Vc 25,242,243
Vc 26,244,245
Vc 27,246,247
buffer_store_dwordx4 v[24:27], v248, s[16:19], s3 offen sc1
s_add_u32 s3, s3, 8192
Ar 240,56
Ar 241,57
Ar 242,58
Ar 243,59
Ar 244,60
Ar 245,61
Ar 246,62
Ar 247,63
v_pk_mul_f32 v[240:241], v[240:241], v[252:253]
v_pk_mul_f32 v[242:243], v[242:243], v[252:253]
v_pk_mul_f32 v[244:245], v[244:245], v[252:253]
v_pk_mul_f32 v[246:247], v[246:247], v[252:253]
Vc 28,240,241
Vc 29,242,243
Vc 30,244,245
Vc 31,246,247
buffer_store_dwordx4 v[28:31], v249, s[16:19], s3 offen sc1
Ar 240,24
Ar 241,25
Ar 242,26
Ar 243,27
Ar 244,28
Ar 245,29
Ar 246,30
Ar 247,31
v_pk_mul_f32 v[240:241], v[240:241], v[250:251]
v_pk_mul_f32 v[242:243], v[242:243], v[250:251]
v_pk_mul_f32 v[244:245], v[244:245], v[250:251]
v_pk_mul_f32 v[246:247], v[246:247], v[250:251]
Vc 24,240,241
Vc 25,242,243
Vc 26,244,245
Vc 27,246,247
buffer_store_dwordx4 v[24:27], v248, s[16:19], s3 offen sc1
s_cmp_ge_u32 s93, 224
s_cbranch_scc1 L_noffn
v_lshrrev_b32 v24, 4, v0
v_bfe_u32 v25, v0, 2, 2
v_lshl_add_u32 v26, v24, 3, v25
v_lshlrev_b32 v26, 8, v26
v_and_b32 v27, 3, v0
v_lshl_add_u32 v26, v27, 3, v26
v_and_b32_e64 v27, 1, v24
v_lshl_add_u32 v25, v27, 2, v25
s_lshl_b32 s3, s32, 1
v_xor_b32 v25, s3, v25
v_lshl_add_u32 v26, v25, 5, v26
s_sub_u32 s3, s54, s44
v_add_u32 v26, s3, v26
v_xor_b32 v27, 32, v26
s_waitcnt vmcnt(8) lgkmcnt(0)
s_barrier
s_nop 0
ds_read_b64_tr_b16 v[128:129], v26 offset:0
ds_read_b64_tr_b16 v[130:131], v26 offset:1024
ds_read_b64_tr_b16 v[132:133], v27 offset:0
ds_read_b64_tr_b16 v[134:135], v27 offset:1024
ds_read_b64_tr_b16 v[136:137], v26 offset:8192
ds_read_b64_tr_b16 v[138:139], v26 offset:9216
ds_read_b64_tr_b16 v[140:141], v27 offset:8192
ds_read_b64_tr_b16 v[142:143], v27 offset:9216
ds_read_b64_tr_b16 v[144:145], v26 offset:16384
ds_read_b64_tr_b16 v[146:147], v26 offset:17408
ds_read_b64_tr_b16 v[148:149], v27 offset:16384
ds_read_b64_tr_b16 v[150:151], v27 offset:17408
ds_read_b64_tr_b16 v[152:153], v26 offset:24576
ds_read_b64_tr_b16 v[154:155], v26 offset:25600
ds_read_b64_tr_b16 v[156:157], v27 offset:24576
s_waitcnt lgkmcnt(9)
s_nop 0
ds_read_b64_tr_b16 v[158:159], v27 offset:25600
ds_read_b64_tr_b16 v[160:161], v26 offset:32768
ds_read_b64_tr_b16 v[162:163], v26 offset:33792
ds_read_b64_tr_b16 v[164:165], v27 offset:32768
ds_read_b64_tr_b16 v[166:167], v27 offset:33792
ds_read_b64_tr_b16 v[168:169], v26 offset:40960
s_waitcnt lgkmcnt(9)
s_nop 0
ds_read_b64_tr_b16 v[170:171], v26 offset:41984
ds_read_b64_tr_b16 v[172:173], v27 offset:40960
ds_read_b64_tr_b16 v[174:175], v27 offset:41984
ds_read_b64_tr_b16 v[176:177], v26 offset:49152
ds_read_b64_tr_b16 v[178:179], v26 offset:50176
ds_read_b64_tr_b16 v[180:181], v27 offset:49152
s_waitcnt lgkmcnt(9)
ds_read_b64_tr_b16 v[182:183], v27 offset:50176
ds_read_b64_tr_b16 v[184:185], v26 offset:57344
ds_read_b64_tr_b16 v[186:187], v26 offset:58368
ds_read_b64_tr_b16 v[188:189], v27 offset:57344
ds_read_b64_tr_b16 v[190:191], v27 offset:58368
v_and_b32 v25, 15, v0
v_mul_u32_u24 v28, 14336, v25
v_lshl_add_u32 v28, v24, 4, v28
v_mov_b32 v29, 2146435072
v_cmp_gt_u32 vcc, 2, v25
s_mul_i32 s3, s92, 57344
s_lshl_b32 s47, s4, 9
s_add_u32 s3, s3, s47
v_cndmask_b32 v28, v29, v28, vcc
s_lshl_b32 s47, s32, 7
s_add_u32 s3, s3, s47
s_add_u32 s3, s3, 6291456
Zvva 224,128,160
Zvva 228,132,160
Mvva 224,136,164
Mvva 228,140,164
Mvva 224,144,168
Mvva 228,148,168
Mvva 224,152,172
Mvva 228,156,172
s_waitcnt lgkmcnt(0)
Zvva 232,160,160
Zvva 236,164,160
Mvva 232,168,164
Mvva 236,172,164
Mvva 232,176,168
Mvva 236,180,168
Mvva 232,184,172
Mvva 236,188,172
L_noffn:
s_add_u32 s36, s36, s7
s_and_b32 s94, s7, 128
s_lshl_b32 s38, s45, 7
s_lshl_b32 s6, s52, 6
s_add_u32 s38, s38, s6
s_add_u32 s38, s38, 5300224
s_lshl_b32 s52, s32, 11
s_lshl_b32 s6, s32, 16
s_add_u32 s6, s6, s94
s_xor_b32 s6, s6, 128
s_lshl_b32 s7, s32, 5
s_mov_b32 s68, s10
s_and_b32 s69, s11, 0xffff
s_mov_b32 s70, 4194304
s_mov_b32 s71, 0x20000
s_add_u32 s8, s66, s37
s_addc_u32 s9, s67, 0
s_and_b32 s9, s9, 0xffff
s_mov_b32 s10, 524288
s_mov_b32 s11, 0x20000
v_lshlrev_b32 v112, 4, v0
v_lshrrev_b32 v121, 4, v0
v_and_b32 v122, 7, v0
v_lshrrev_b32 v123, 3, v0
v_lshlrev_b32 v124, 1, v121
v_xor_b32 v124, v124, v122
v_lshlrev_b32_e64 v124, 4, v124
v_lshl_add_u32 v113, v123, 11, v124
v_add_u32 v114, s6, v113
v_lshrrev_b32 v124, 2, v0
v_bfe_u32 v126, v0, 3, 2
v_lshlrev_b32 v124, 7, v124
v_and_b32 v125, 3, v0
v_lshl_add_u32 v124, v125, 3, v124
v_lshl_add_u32 v115, v126, 5, v124
v_xor_b32 v116, 32, v115
v_xor_b32 v117, 64, v115
v_xor_b32 v118, 96, v115
v_add_u32 v120, s7, v123
v_lshlrev_b32 v119, 11, v120
v_lshl_add_u32 v119, v122, 4, v119
v_mov_b32 v126, 0
v_lshlrev_b32 v127, 2, v122
v_mov_b32 v24, 1
v_mul_u32_u24 v25, s65, v0
s_waitcnt vmcnt(0)
s_barrier
s_mov_b64 exec, 3
buffer_store_dword v24, v25, s[20:23], s64 offen sc1
s_mov_b64 exec, -1
s_cmp_lt_u32 s93, 224
s_cselect_b32 s3, s3, 8388608
s_add_u32 s7, s3, 28672
buffer_store_dwordx4 v[224:227], v28, s[20:23], s3 offen offset:0 sc1
buffer_store_dwordx4 v[228:231], v28, s[20:23], s3 offen offset:64 sc1
buffer_store_dwordx4 v[232:235], v28, s[20:23], s7 offen offset:0 sc1
buffer_store_dwordx4 v[236:239], v28, s[20:23], s7 offen offset:64 sc1
s_mov_b32 s3, s36
s_nop 0
buffer_load_dwordx4 v[18:21], v119, s[56:59], s3 offen
s_add_u32 s3, s3, 16384
buffer_load_dwordx4 v[22:25], v119, s[56:59], s3 offen
s_add_u32 s3, s3, 16384
buffer_load_dwordx4 v[26:29], v119, s[56:59], s3 offen
s_add_u32 s3, s3, 16384
buffer_load_dwordx4 v[30:33], v119, s[56:59], s3 offen
s_lshl_b32 s3, s45, 10
s_add_u32 s3, s3, 5259264
v_lshlrev_b32 v124, 3, v120
buffer_load_dwordx2 v[34:35], v124, s[20:23], s3 offen offset:0 sc1
buffer_load_dwordx2 v[36:37], v124, s[20:23], s3 offen offset:64 sc1
buffer_load_dwordx2 v[38:39], v124, s[20:23], s3 offen offset:128 sc1
buffer_load_dwordx2 v[40:41], v124, s[20:23], s3 offen offset:192 sc1
v_and_b32 v10, 15, v0
v_lshlrev_b32 v10, 2, v10
s_add_u32 s95, s32, 32
s_lshl_b32 s95, s95, 16
s_add_u32 s95, s95, s94
s_xor_b32 s95, s95, 128
s_add_u32 m0, s44, 0
s_nop 0
s_nop 0
buffer_load_dwordx4 v114, s[12:15], s48 offen offset:0 lds
buffer_load_dwordx4 v114, s[12:15], s49 offen offset:1024 lds
buffer_load_dwordx4 v114, s[12:15], s50 offen offset:2048 lds
buffer_load_dwordx4 v114, s[12:15], s51 offen offset:3072 lds
v_xor_b32 v114, 128, v114
s_add_u32 m0, s44, 16384
s_nop 0
s_nop 0
buffer_load_dwordx4 v114, s[12:15], s48 offen offset:0 lds
buffer_load_dwordx4 v114, s[12:15], s49 offen offset:1024 lds
buffer_load_dwordx4 v114, s[12:15], s50 offen offset:2048 lds
buffer_load_dwordx4 v114, s[12:15], s51 offen offset:3072 lds
v_xor_b32 v114, 128, v114
v_add_u32 v114, 262144, v114
buffer_load_dword v124, v10, s[20:23], s38 offen sc1
v_add_u32 v12, 65536, v115
v_add_u32 v13, 65536, v116
v_add_u32 v14, 65536, v117
v_add_u32 v15, 65536, v118
s_and_b32 s39, s93, 15
s_lshr_b32 s37, s93, 4
s_lshl_b32 s54, s37, 2
s_add_u32 s54, s54, s32
s_lshl_b32 s3, s54, 17
s_lshl_b32 s7, s39, 7
s_add_u32 s3, s3, s7
s_cmp_lt_u32 s93, 224
s_cselect_b32 s3, s3, 2146435072
v_add_u32 v125, s3, v113
s_mov_b32 s40, 0
s_waitcnt vmcnt(9)
v_lshlrev_b32_e64 v42, 16, v18
v_and_b32 v43, 0xffff0000, v18
v_lshlrev_b32_e64 v44, 16, v19
v_and_b32 v45, 0xffff0000, v19
v_lshlrev_b32_e64 v46, 16, v20
v_and_b32 v47, 0xffff0000, v20
v_lshlrev_b32_e64 v48, 16, v21
v_and_b32 v49, 0xffff0000, v21
v_pk_add_f32 v[42:43], v[42:43], v[34:35] op_sel_hi:[1,0] neg_lo:[0,1] neg_hi:[0,1]
v_pk_add_f32 v[44:45], v[44:45], v[34:35] op_sel_hi:[1,0] neg_lo:[0,1] neg_hi:[0,1]
v_pk_add_f32 v[46:47], v[46:47], v[34:35] op_sel_hi:[1,0] neg_lo:[0,1] neg_hi:[0,1]
v_pk_add_f32 v[48:49], v[48:49], v[34:35] op_sel_hi:[1,0] neg_lo:[0,1] neg_hi:[0,1]
Vc 2,42,43
v_lshlrev_b32_e64 v42, 16, v2
v_and_b32 v43, 0xffff0000, v2
Vc 3,44,45
v_lshlrev_b32_e64 v44, 16, v3
v_and_b32 v45, 0xffff0000, v3
Vc 4,46,47
v_lshlrev_b32_e64 v46, 16, v4
v_and_b32 v47, 0xffff0000, v4
Vc 5,48,49
v_lshlrev_b32_e64 v48, 16, v5
v_and_b32 v49, 0xffff0000, v5
v_pk_mul_f32 v[42:43], v[42:43], v[34:35] op_sel:[0,1] op_sel_hi:[1,1]
v_pk_mul_f32 v[44:45], v[44:45], v[34:35] op_sel:[0,1] op_sel_hi:[1,1]
v_pk_mul_f32 v[46:47], v[46:47], v[34:35] op_sel:[0,1] op_sel_hi:[1,1]
v_pk_mul_f32 v[48:49], v[48:49], v[34:35] op_sel:[0,1] op_sel_hi:[1,1]
Vc 2,42,43
v_lshlrev_b32_e64 v42, 16, v2
v_and_b32 v43, 0xffff0000, v2
Vc 3,44,45
v_lshlrev_b32_e64 v44, 16, v3
v_and_b32 v45, 0xffff0000, v3
Vc 4,46,47
v_lshlrev_b32_e64 v46, 16, v4
v_and_b32 v47, 0xffff0000, v4
Vc 5,48,49
v_lshlrev_b32_e64 v48, 16, v5
v_and_b32 v49, 0xffff0000, v5
v_mul_f32 v2, 0xbfb8aa3b, v42
v_mul_f32 v3, 0xbfb8aa3b, v43
v_mul_f32 v4, 0xbfb8aa3b, v44
v_mul_f32 v5, 0xbfb8aa3b, v45
v_mul_f32 v6, 0xbfb8aa3b, v46
v_mul_f32 v7, 0xbfb8aa3b, v47
v_mul_f32 v8, 0xbfb8aa3b, v48
v_mul_f32 v9, 0xbfb8aa3b, v49
Ve 2,2
Ve 3,3
Ve 4,4
Ve 5,5
Ve 6,6
Ve 7,7
Ve 8,8
Ve 9,9
v_add_f32 v2, 1.0, v2
v_add_f32 v3, 1.0, v3
v_add_f32 v4, 1.0, v4
v_add_f32 v5, 1.0, v5
v_add_f32 v6, 1.0, v6
v_add_f32 v7, 1.0, v7
v_add_f32 v8, 1.0, v8
v_add_f32 v9, 1.0, v9
v_rcp_f32 v2, v2
v_rcp_f32 v3, v3
v_rcp_f32 v4, v4
v_rcp_f32 v5, v5
v_rcp_f32 v6, v6
v_rcp_f32 v7, v7
v_rcp_f32 v8, v8
v_rcp_f32 v9, v9
v_pk_mul_f32 v[42:43], v[42:43], v[2:3]
v_pk_mul_f32 v[44:45], v[44:45], v[4:5]
v_pk_mul_f32 v[46:47], v[46:47], v[6:7]
v_pk_mul_f32 v[48:49], v[48:49], v[8:9]
Vc 2,42,43
v_lshlrev_b32_e64 v42, 16, v2
v_and_b32 v43, 0xffff0000, v2
Vc 3,44,45
v_lshlrev_b32_e64 v44, 16, v3
v_and_b32 v45, 0xffff0000, v3
Vc 4,46,47
v_lshlrev_b32_e64 v46, 16, v4
v_and_b32 v47, 0xffff0000, v4
Vc 5,48,49
v_lshlrev_b32_e64 v48, 16, v5
v_and_b32 v49, 0xffff0000, v5
s_waitcnt vmcnt(0)
v_cmp_ne_u32 vcc, 1, v124
s_cbranch_vccnz L_spinC
s_nop 0
L_spinCr:
buffer_load_dwordx4 a[0:3], v112, s[8:11], s52 offen offset:0 sc1
buffer_load_dwordx4 a[4:7], v112, s[8:11], s52 offen offset:1024 sc1
s_add_u32 s52, s52, 8192
buffer_load_dwordx4 a[8:11], v112, s[8:11], s52 offen offset:0 sc1
buffer_load_dwordx4 a[12:15], v112, s[8:11], s52 offen offset:1024 sc1
s_add_u32 s52, s52, 8192
buffer_load_dwordx4 a[16:19], v112, s[8:11], s52 offen offset:0 sc1
buffer_load_dwordx4 a[20:23], v112, s[8:11], s52 offen offset:1024 sc1
s_add_u32 s52, s52, 8192
buffer_load_dwordx4 a[24:27], v112, s[8:11], s52 offen offset:0 sc1
buffer_load_dwordx4 a[28:31], v112, s[8:11], s52 offen offset:1024 sc1
s_add_u32 s52, s52, 8192
buffer_load_dwordx4 a[32:35], v112, s[8:11], s52 offen offset:0 sc1
buffer_load_dwordx4 a[36:39], v112, s[8:11], s52 offen offset:1024 sc1
s_add_u32 s52, s52, 8192
buffer_load_dwordx4 a[40:43], v112, s[8:11], s52 offen offset:0 sc1
buffer_load_dwordx4 a[44:47], v112, s[8:11], s52 offen offset:1024 sc1
s_add_u32 s52, s52, 8192
v_lshlrev_b32_e64 v50, 16, v22
v_and_b32 v51, 0xffff0000, v22
v_lshlrev_b32_e64 v52, 16, v23
v_and_b32 v53, 0xffff0000, v23
v_lshlrev_b32_e64 v54, 16, v24
v_and_b32 v55, 0xffff0000, v24
v_lshlrev_b32_e64 v56, 16, v25
v_and_b32 v57, 0xffff0000, v25
v_pk_add_f32 v[50:51], v[50:51], v[36:37] op_sel_hi:[1,0] neg_lo:[0,1] neg_hi:[0,1]
v_pk_add_f32 v[52:53], v[52:53], v[36:37] op_sel_hi:[1,0] neg_lo:[0,1] neg_hi:[0,1]
v_pk_add_f32 v[54:55], v[54:55], v[36:37] op_sel_hi:[1,0] neg_lo:[0,1] neg_hi:[0,1]
v_pk_add_f32 v[56:57], v[56:57], v[36:37] op_sel_hi:[1,0] neg_lo:[0,1] neg_hi:[0,1]
Vc 2,50,51
v_lshlrev_b32_e64 v50, 16, v2
v_and_b32 v51, 0xffff0000, v2
Vc 3,52,53
v_lshlrev_b32_e64 v52, 16, v3
v_and_b32 v53, 0xffff0000, v3
Vc 4,54,55
v_lshlrev_b32_e64 v54, 16, v4
v_and_b32 v55, 0xffff0000, v4
Vc 5,56,57
v_lshlrev_b32_e64 v56, 16, v5
v_and_b32 v57, 0xffff0000, v5
v_pk_mul_f32 v[50:51], v[50:51], v[36:37] op_sel:[0,1] op_sel_hi:[1,1]
v_pk_mul_f32 v[52:53], v[52:53], v[36:37] op_sel:[0,1] op_sel_hi:[1,1]
v_pk_mul_f32 v[54:55], v[54:55], v[36:37] op_sel:[0,1] op_sel_hi:[1,1]
v_pk_mul_f32 v[56:57], v[56:57], v[36:37] op_sel:[0,1] op_sel_hi:[1,1]
Vc 2,50,51
v_lshlrev_b32_e64 v50, 16, v2
v_and_b32 v51, 0xffff0000, v2
Vc 3,52,53
v_lshlrev_b32_e64 v52, 16, v3
v_and_b32 v53, 0xffff0000, v3
Vc 4,54,55
v_lshlrev_b32_e64 v54, 16, v4
v_and_b32 v55, 0xffff0000, v4
Vc 5,56,57
v_lshlrev_b32_e64 v56, 16, v5
v_and_b32 v57, 0xffff0000, v5
v_mul_f32 v2, 0xbfb8aa3b, v50
v_mul_f32 v3, 0xbfb8aa3b, v51
v_mul_f32 v4, 0xbfb8aa3b, v52
v_mul_f32 v5, 0xbfb8aa3b, v53
v_mul_f32 v6, 0xbfb8aa3b, v54
v_mul_f32 v7, 0xbfb8aa3b, v55
v_mul_f32 v8, 0xbfb8aa3b, v56
v_mul_f32 v9, 0xbfb8aa3b, v57
Ve 2,2
Ve 3,3
Ve 4,4
Ve 5,5
Ve 6,6
Ve 7,7
Ve 8,8
Ve 9,9
v_add_f32 v2, 1.0, v2
v_add_f32 v3, 1.0, v3
v_add_f32 v4, 1.0, v4
v_add_f32 v5, 1.0, v5
v_add_f32 v6, 1.0, v6
v_add_f32 v7, 1.0, v7
v_add_f32 v8, 1.0, v8
v_add_f32 v9, 1.0, v9
v_rcp_f32 v2, v2
v_rcp_f32 v3, v3
v_rcp_f32 v4, v4
v_rcp_f32 v5, v5
v_rcp_f32 v6, v6
v_rcp_f32 v7, v7
v_rcp_f32 v8, v8
v_rcp_f32 v9, v9
v_pk_mul_f32 v[50:51], v[50:51], v[2:3]
v_pk_mul_f32 v[52:53], v[52:53], v[4:5]
v_pk_mul_f32 v[54:55], v[54:55], v[6:7]
v_pk_mul_f32 v[56:57], v[56:57], v[8:9]
Vc 2,50,51
v_lshlrev_b32_e64 v50, 16, v2
v_and_b32 v51, 0xffff0000, v2
Vc 3,52,53
v_lshlrev_b32_e64 v52, 16, v3
v_and_b32 v53, 0xffff0000, v3
Vc 4,54,55
v_lshlrev_b32_e64 v54, 16, v4
v_and_b32 v55, 0xffff0000, v4
Vc 5,56,57
v_lshlrev_b32_e64 v56, 16, v5
v_and_b32 v57, 0xffff0000, v5
v_lshlrev_b32_e64 v58, 16, v26
v_and_b32 v59, 0xffff0000, v26
v_lshlrev_b32_e64 v60, 16, v27
v_and_b32 v61, 0xffff0000, v27
v_lshlrev_b32_e64 v62, 16, v28
v_and_b32 v63, 0xffff0000, v28
v_lshlrev_b32_e64 v64, 16, v29
v_and_b32 v65, 0xffff0000, v29
v_pk_add_f32 v[58:59], v[58:59], v[38:39] op_sel_hi:[1,0] neg_lo:[0,1] neg_hi:[0,1]
v_pk_add_f32 v[60:61], v[60:61], v[38:39] op_sel_hi:[1,0] neg_lo:[0,1] neg_hi:[0,1]
v_pk_add_f32 v[62:63], v[62:63], v[38:39] op_sel_hi:[1,0] neg_lo:[0,1] neg_hi:[0,1]
v_pk_add_f32 v[64:65], v[64:65], v[38:39] op_sel_hi:[1,0] neg_lo:[0,1] neg_hi:[0,1]
Vc 2,58,59
v_lshlrev_b32_e64 v58, 16, v2
v_and_b32 v59, 0xffff0000, v2
Vc 3,60,61
v_lshlrev_b32_e64 v60, 16, v3
v_and_b32 v61, 0xffff0000, v3
Vc 4,62,63
v_lshlrev_b32_e64 v62, 16, v4
v_and_b32 v63, 0xffff0000, v4
Vc 5,64,65
v_lshlrev_b32_e64 v64, 16, v5
v_and_b32 v65, 0xffff0000, v5
v_pk_mul_f32 v[58:59], v[58:59], v[38:39] op_sel:[0,1] op_sel_hi:[1,1]
v_pk_mul_f32 v[60:61], v[60:61], v[38:39] op_sel:[0,1] op_sel_hi:[1,1]
v_pk_mul_f32 v[62:63], v[62:63], v[38:39] op_sel:[0,1] op_sel_hi:[1,1]
v_pk_mul_f32 v[64:65], v[64:65], v[38:39] op_sel:[0,1] op_sel_hi:[1,1]
Vc 2,58,59
v_lshlrev_b32_e64 v58, 16, v2
v_and_b32 v59, 0xffff0000, v2
Vc 3,60,61
v_lshlrev_b32_e64 v60, 16, v3
v_and_b32 v61, 0xffff0000, v3
Vc 4,62,63
v_lshlrev_b32_e64 v62, 16, v4
v_and_b32 v63, 0xffff0000, v4
Vc 5,64,65
v_lshlrev_b32_e64 v64, 16, v5
v_and_b32 v65, 0xffff0000, v5
v_mul_f32 v2, 0xbfb8aa3b, v58
v_mul_f32 v3, 0xbfb8aa3b, v59
v_mul_f32 v4, 0xbfb8aa3b, v60
v_mul_f32 v5, 0xbfb8aa3b, v61
v_mul_f32 v6, 0xbfb8aa3b, v62
v_mul_f32 v7, 0xbfb8aa3b, v63
v_mul_f32 v8, 0xbfb8aa3b, v64
v_mul_f32 v9, 0xbfb8aa3b, v65
Ve 2,2
Ve 3,3
Ve 4,4
Ve 5,5
Ve 6,6
Ve 7,7
Ve 8,8
Ve 9,9
v_add_f32 v2, 1.0, v2
v_add_f32 v3, 1.0, v3
v_add_f32 v4, 1.0, v4
v_add_f32 v5, 1.0, v5
v_add_f32 v6, 1.0, v6
v_add_f32 v7, 1.0, v7
v_add_f32 v8, 1.0, v8
v_add_f32 v9, 1.0, v9
v_rcp_f32 v2, v2
v_rcp_f32 v3, v3
v_rcp_f32 v4, v4
v_rcp_f32 v5, v5
v_rcp_f32 v6, v6
v_rcp_f32 v7, v7
v_rcp_f32 v8, v8
v_rcp_f32 v9, v9
v_pk_mul_f32 v[58:59], v[58:59], v[2:3]
v_pk_mul_f32 v[60:61], v[60:61], v[4:5]
v_pk_mul_f32 v[62:63], v[62:63], v[6:7]
v_pk_mul_f32 v[64:65], v[64:65], v[8:9]
Vc 2,58,59
v_lshlrev_b32_e64 v58, 16, v2
v_and_b32 v59, 0xffff0000, v2
Vc 3,60,61
v_lshlrev_b32_e64 v60, 16, v3
v_and_b32 v61, 0xffff0000, v3
Vc 4,62,63
v_lshlrev_b32_e64 v62, 16, v4
v_and_b32 v63, 0xffff0000, v4
Vc 5,64,65
v_lshlrev_b32_e64 v64, 16, v5
v_and_b32 v65, 0xffff0000, v5
buffer_load_dwordx4 a[48:51], v112, s[8:11], s52 offen offset:0 sc1
buffer_load_dwordx4 a[52:55], v112, s[8:11], s52 offen offset:1024 sc1
s_add_u32 s52, s52, 8192
buffer_load_dwordx4 a[56:59], v112, s[8:11], s52 offen offset:0 sc1
buffer_load_dwordx4 a[60:63], v112, s[8:11], s52 offen offset:1024 sc1
s_add_u32 s52, s52, 8192
s_add_u32 m0, s44, 32768
s_nop 0
buffer_load_dwordx4 v114, s[12:15], s48 offen offset:0 lds
buffer_load_dwordx4 v114, s[12:15], s49 offen offset:1024 lds
buffer_load_dwordx4 v114, s[12:15], s50 offen offset:2048 lds
buffer_load_dwordx4 v114, s[12:15], s51 offen offset:3072 lds
v_xor_b32 v114, 128, v114
s_cmp_lg_u32 s40, 0
s_cbranch_scc1 L_nowd
s_add_u32 m0, s35, 0
s_nop 0
s_nop 0
buffer_load_dwordx4 v125, s[60:63], s48 offen offset:0 lds
buffer_load_dwordx4 v125, s[60:63], s49 offen offset:1024 lds
buffer_load_dwordx4 v125, s[60:63], s50 offen offset:2048 lds
buffer_load_dwordx4 v125, s[60:63], s51 offen offset:3072 lds
v_add_u32 v125, 65536, v125
s_add_u32 m0, s35, 4096
s_nop 0
buffer_load_dwordx4 v125, s[60:63], s48 offen offset:0 lds
buffer_load_dwordx4 v125, s[60:63], s49 offen offset:1024 lds
buffer_load_dwordx4 v125, s[60:63], s50 offen offset:2048 lds
buffer_load_dwordx4 v125, s[60:63], s51 offen offset:3072 lds
L_nowd:
s_cmp_lt_u32 s2, 128
s_cbranch_scc1 L_noc3
s_bfe_u32 s3, s2, 0x40003
s_lshl_b32 s3, s3, 2
s_add_u32 s3, s3, s32
s_lshl_b32 s3, s3, 15
s_and_b32 s7, s2, 1
s_lshl_b32 s7, s7, 22
s_add_u32 s3, s3, s7
s_add_u32 s3, s3, 384
v_and_b32 v1, 15, v0
v_lshlrev_b32 v1, 11, v1
v_lshrrev_b32_e64 v11, 5, v0
v_lshl_add_u32 v1, v11, 10, v1
buffer_load_dword v11, v1, s[28:31], s3 offen
L_noc3:
s_barrier
s_nop 0
ds_read_b64_tr_b16 v[192:193], v115 offset:0
ds_read_b64_tr_b16 v[194:195], v115 offset:2048
ds_read_b64_tr_b16 v[196:197], v115 offset:4096
ds_read_b64_tr_b16 v[198:199], v115 offset:6144
ds_read_b64_tr_b16 v[200:201], v115 offset:8192
ds_read_b64_tr_b16 v[202:203], v115 offset:10240
ds_read_b64_tr_b16 v[204:205], v115 offset:12288
ds_read_b64_tr_b16 v[206:207], v115 offset:14336
ds_read_b64_tr_b16 v[208:209], v116 offset:0
ds_read_b64_tr_b16 v[210:211], v116 offset:2048
ds_read_b64_tr_b16 v[212:213], v116 offset:4096
ds_read_b64_tr_b16 v[214:215], v116 offset:6144
ds_read_b64_tr_b16 v[216:217], v116 offset:8192
ds_read_b64_tr_b16 v[218:219], v116 offset:10240
ds_read_b64_tr_b16 v[220:221], v116 offset:12288
s_waitcnt lgkmcnt(9)
ds_read_b64_tr_b16 v[222:223], v116 offset:14336
s_waitcnt vmcnt(12)
s_waitcnt lgkmcnt(8)
Zvva 160,192,0
ds_read_b64_tr_b16 v[224:225], v117 offset:0
ds_read_b64_tr_b16 v[226:227], v117 offset:2048
v_mov_b32 v125, 1
Mvva 160,196,8
s_lshl_b32 s6, s4, 3
s_add_u32 s6, s6, s92
s_lshl_b32 s6, s6, 2
Mvva 160,200,16
s_add_u32 m0, s44, 49152
ds_read_b64_tr_b16 v[228:229], v117 offset:4096
ds_read_b64_tr_b16 v[230:231], v117 offset:6144
Mvva 160,204,24
buffer_load_dwordx4 v114, s[12:15], s48 offen offset:0 lds
Zvva 176,192,4
s_waitcnt lgkmcnt(4)
ds_read_b64_tr_b16 v[232:233], v117 offset:8192
ds_read_b64_tr_b16 v[234:235], v117 offset:10240
Mvva 176,196,12
s_add_u32 s6, s6, 5447680
s_cmp_eq_u32 s32, 0
s_cselect_b32 s6, s6, s64
s_cmp_lt_u32 s93, 224
s_cselect_b32 s6, s6, 2146435072
Mvva 176,200,20
ds_read_b64_tr_b16 v[236:237], v117 offset:12288
ds_read_b64_tr_b16 v[238:239], v117 offset:14336
Mvva 176,204,28
buffer_load_dwordx4 v114, s[12:15], s49 offen offset:1024 lds
Zvva 164,208,0
ds_read_b64_tr_b16 v[240:241], v118 offset:0
ds_read_b64_tr_b16 v[242:243], v118 offset:2048
Mvva 164,212,8
s_mov_b64 exec, 1
buffer_store_dword v125, v126, s[20:23], s6 offen sc1
s_mov_b64 exec, -1
Mvva 164,216,16
s_waitcnt lgkmcnt(2)
ds_read_b64_tr_b16 v[244:245], v118 offset:4096
ds_read_b64_tr_b16 v[246:247], v118 offset:6144
Mvva 164,220,24
buffer_load_dwordx4 v114, s[12:15], s50 offen offset:2048 lds
Zvva 180,208,4
ds_read_b64_tr_b16 v[248:249], v118 offset:8192
ds_read_b64_tr_b16 v[250:251], v118 offset:10240
Mvva 180,212,12
s_lshl_b32 s40, s45, 2
s_add_u32 s40, s40, s32
s_lshr_b32 s3, s42, 5
s_lshr_b32 s47, s43, 5
s_cmp_eq_u32 s3, s40
s_cselect_b32 s53, 1, 0
s_cmp_eq_u32 s47, s40
s_cselect_b32 s53, 1, s53
s_mov_b32 s40, 0
Mvva 180,216,20
s_barrier
ds_read_b64_tr_b16 v[252:253], v118 offset:12288
ds_read_b64_tr_b16 v[254:255], v118 offset:14336
Mvva 180,220,28
buffer_load_dwordx4 v114, s[12:15], s51 offen offset:3072 lds
v_xor_b32 v114, 128, v114
v_add_u32 v114, 262144, v114
Zvva 168,224,0
ds_read_b64_tr_b16 v[192:193], v115 offset:16384
ds_read_b64_tr_b16 v[194:195], v115 offset:18432
Mvva 168,228,8
s_lshl_b32 s41, s46, 7
s_add_u32 s41, s41, 5449728
s_lshl_b32 s55, s46, 13
Mvva 168,232,16
ds_read_b64_tr_b16 v[196:197], v115 offset:20480
ds_read_b64_tr_b16 v[198:199], v115 offset:22528
Mvva 168,236,24
buffer_load_dwordx4 a[64:67], v112, s[8:11], s52 offen offset:0 sc1
Zvva 184,224,4
s_waitcnt lgkmcnt(4)
ds_read_b64_tr_b16 v[200:201], v115 offset:24576
ds_read_b64_tr_b16 v[202:203], v115 offset:26624
Mvva 184,228,12
s_add_u32 s55, s55, 5308416
s_add_u32 s16, s66, 88080384
s_addc_u32 s17, s67, 0
s_and_b32 s17, s17, 0xffff
Mvva 184,232,20
ds_read_b64_tr_b16 v[204:205], v115 offset:28672
ds_read_b64_tr_b16 v[206:207], v115 offset:30720
Mvva 184,236,28
buffer_load_dwordx4 a[68:71], v112, s[8:11], s52 offen offset:1024 sc1
s_add_u32 s52, s52, 8192
Zvva 172,240,0
ds_read_b64_tr_b16 v[208:209], v116 offset:16384
ds_read_b64_tr_b16 v[210:211], v116 offset:18432
Mvva 172,244,8
s_mov_b32 s18, 8388608
s_mov_b32 s19, 0x20000
s_lshl_b32 s24, s2, 2
Mvva 172,248,16
ds_read_b64_tr_b16 v[212:213], v116 offset:20480
ds_read_b64_tr_b16 v[214:215], v116 offset:22528
Mvva 172,252,24
buffer_load_dwordx4 a[72:75], v112, s[8:11], s52 offen offset:0 sc1
Zvva 188,240,4
s_waitcnt lgkmcnt(4)
ds_read_b64_tr_b16 v[216:217], v116 offset:24576
ds_read_b64_tr_b16 v[218:219], v116 offset:26624
Mvva 188,244,12
s_add_u32 s24, s24, s32
s_lshl_b32 s25, s24, 13
s_xor_b32 s26, s25, 32768
Mvva 188,248,20
ds_read_b64_tr_b16 v[220:221], v116 offset:28672
ds_read_b64_tr_b16 v[222:223], v116 offset:30720
Mvva 188,252,28
buffer_load_dwordx4 a[76:79], v112, s[8:11], s52 offen offset:1024 sc1
s_add_u32 s52, s52, 8192
Zvva 128,192,0
ds_read_b64_tr_b16 v[224:225], v117 offset:16384
ds_read_b64_tr_b16 v[226:227], v117 offset:18432
Mvva 128,196,8
s_lshl_b32 s24, s24, 2
s_xor_b32 s27, s24, 16
s_add_u32 s24, s24, 5452800
Mvva 128,200,16
s_add_u32 m0, s44, 65536
ds_read_b64_tr_b16 v[228:229], v117 offset:20480
ds_read_b64_tr_b16 v[230:231], v117 offset:22528
Mvva 128,204,24
buffer_load_dwordx4 v114, s[12:15], s48 offen offset:0 lds
Zvva 144,192,4
s_waitcnt lgkmcnt(4)
ds_read_b64_tr_b16 v[232:233], v117 offset:24576
ds_read_b64_tr_b16 v[234:235], v117 offset:26624
Mvva 144,196,12
s_add_u32 s27, s27, 5452800
v_add_u32 v106, s35, v115
v_add_u32 v107, s35, v116
v_add_u32_e64 v108, s35, v117
Mvva 144,200,20
ds_read_b64_tr_b16 v[236:237], v117 offset:28672
ds_read_b64_tr_b16 v[238:239], v117 offset:30720
v_add_u32_e64 v109, s35, v118
Mvva 144,204,28
buffer_load_dwordx4 v114, s[12:15], s49 offen offset:1024 lds
Zvva 132,208,0
ds_read_b64_tr_b16 v[240:241], v118 offset:16384
ds_read_b64_tr_b16 v[242:243], v118 offset:18432
v_and_b32_e64 v2, 1, v121
Mvva 132,212,8
v_lshlrev_b32 v2, 8, v2
v_and_b32 v3, 15, v0
v_lshl_add_u32 v2, v3, 3, v2
Mvva 132,216,16
s_waitcnt lgkmcnt(2)
ds_read_b64_tr_b16 v[244:245], v118 offset:20480
ds_read_b64_tr_b16 v[246:247], v118 offset:22528
v_add_u32 v2, s35, v2
Mvva 132,220,24
buffer_load_dwordx4 v114, s[12:15], s50 offen offset:2048 lds
Zvva 148,208,4
s_waitcnt vmcnt(12)
ds_read_b64_tr_b16 v[248:249], v118 offset:24576
ds_read_b64_tr_b16 v[250:251], v118 offset:26624
v_and_b32 v4, 1, v0
Mvva 148,212,12
v_lshlrev_b32 v4, 8, v4
v_add_u32 v4, s35, v4
v_lshl_add_u32 v3, v121, 3, v4
Mvva 148,216,20
s_barrier
ds_read_b64_tr_b16 v[252:253], v118 offset:28672
ds_read_b64_tr_b16 v[254:255], v118 offset:30720
v_lshl_add_u32 v4, v121, 4, v4
Mvva 148,220,28
buffer_load_dwordx4 v114, s[12:15], s51 offen offset:3072 lds
v_xor_b32 v114, 128, v114
Zvva 136,224,0
ds_read_b64_tr_b16 v[192:193], v115 offset:32768
ds_read_b64_tr_b16 v[194:195], v115 offset:34816
v_lshlrev_b32 v5, 3, v0
Mvva 136,228,8
v_add_u32 v6, 133120, v5
v_mov_b32_e64 v7, 1
Mvva 136,232,16
ds_read_b64_tr_b16 v[196:197], v115 offset:36864
ds_read_b64_tr_b16 v[198:199], v115 offset:38912
Mvva 136,236,24
buffer_load_dwordx4 a[80:83], v112, s[8:11], s52 offen offset:0 sc1
Zvva 152,224,4
s_waitcnt lgkmcnt(4)
ds_read_b64_tr_b16 v[200:201], v115 offset:40960
ds_read_b64_tr_b16 v[202:203], v115 offset:43008
Mvva 152,228,12
s_lshl_b32 s4, s39, 4
s_add_u32 s4, s4, s37
s_lshl_b32 s4, s4, 9
Mvva 152,232,20
ds_read_b64_tr_b16 v[204:205], v115 offset:45056
ds_read_b64_tr_b16 v[206:207], v115 offset:47104
Mvva 152,236,28
buffer_load_dwordx4 a[84:87], v112, s[8:11], s52 offen offset:1024 sc1
s_add_u32 s52, s52, 8192
Zvva 140,240,0
ds_read_b64_tr_b16 v[208:209], v116 offset:32768
ds_read_b64_tr_b16 v[210:211], v116 offset:34816
Mvva 140,244,8
s_add_u32 s4, s4, 5308416
s_lshl_b32 s6, s39, 5
s_add_u32 s6, s6, s37
Mvva 140,248,16
ds_read_b64_tr_b16 v[212:213], v116 offset:36864
ds_read_b64_tr_b16 v[214:215], v116 offset:38912
Mvva 140,252,24
buffer_load_dwordx4 a[88:91], v112, s[8:11], s52 offen offset:0 sc1
Zvva 156,240,4
s_waitcnt lgkmcnt(4)
ds_read_b64_tr_b16 v[216:217], v116 offset:40960
ds_read_b64_tr_b16 v[218:219], v116 offset:43008
Mvva 156,244,12
s_lshl_b32 s6, s6, 2
s_add_u32 s6, s6, 5449728
s_cmp_eq_u32 s32, 0
s_cselect_b32 s4, s4, s64
s_cselect_b32 s6, s6, s64
Mvva 156,248,20
ds_read_b64_tr_b16 v[220:221], v116 offset:45056
ds_read_b64_tr_b16 v[222:223], v116 offset:47104
Mvva 156,252,28
buffer_load_dwordx4 a[92:95], v112, s[8:11], s52 offen offset:1024 sc1
s_add_u32 s52, s52, 8192
Mvva 160,192,32
ds_read_b64_tr_b16 v[224:225], v117 offset:32768
ds_read_b64_tr_b16 v[226:227], v117 offset:34816
Mvva 160,196,40
s_cmp_lt_u32 s93, 224
s_cselect_b32 s4, s4, 2146435072
s_cselect_b32 s6, s6, 2146435072
Mvva 160,200,48
s_add_u32 m0, s44, 81920
ds_read_b64_tr_b16 v[228:229], v117 offset:36864
ds_read_b64_tr_b16 v[230:231], v117 offset:38912
Mvva 160,204,56
buffer_load_dwordx4 v114, s[12:15], s48 offen offset:0 lds
Mvva 176,192,36
s_waitcnt lgkmcnt(4)
ds_read_b64_tr_b16 v[232:233], v117 offset:40960
ds_read_b64_tr_b16 v[234:235], v117 offset:43008
Mvva 176,196,44
Mvva 176,200,52
ds_read_b64_tr_b16 v[236:237], v117 offset:45056
ds_read_b64_tr_b16 v[238:239], v117 offset:47104
Mvva 176,204,60
buffer_load_dwordx4 v114, s[12:15], s49 offen offset:1024 lds
Mvva 164,208,32
ds_read_b64_tr_b16 v[240:241], v118 offset:32768
ds_read_b64_tr_b16 v[242:243], v118 offset:34816
Mvva 164,212,40
Mvva 164,216,48
s_waitcnt lgkmcnt(2)
ds_read_b64_tr_b16 v[244:245], v118 offset:36864
ds_read_b64_tr_b16 v[246:247], v118 offset:38912
Mvva 164,220,56
buffer_load_dwordx4 v114, s[12:15], s50 offen offset:2048 lds
Mvva 180,208,36
s_waitcnt vmcnt(15)
ds_read_b64_tr_b16 v[248:249], v118 offset:40960
ds_read_b64_tr_b16 v[250:251], v118 offset:43008
Mvva 180,212,44
Mvva 180,216,52
s_barrier
ds_read_b64_tr_b16 v[252:253], v118 offset:45056
ds_read_b64_tr_b16 v[254:255], v118 offset:47104
Mvva 180,220,60
buffer_load_dwordx4 v114, s[12:15], s51 offen offset:3072 lds
v_xor_b32 v114, 128, v114
v_add_u32 v114, 262144, v114
Mvva 168,224,32
ds_read_b64_tr_b16 v[192:193], v115 offset:49152
ds_read_b64_tr_b16 v[194:195], v115 offset:51200
Mvva 168,228,40
Mvva 168,232,48
ds_read_b64_tr_b16 v[196:197], v115 offset:53248
ds_read_b64_tr_b16 v[198:199], v115 offset:55296
Mvva 168,236,56
buffer_load_dwordx4 a[96:99], v112, s[8:11], s52 offen offset:0 sc1
Mvva 184,224,36
s_waitcnt lgkmcnt(4)
ds_read_b64_tr_b16 v[200:201], v115 offset:57344
ds_read_b64_tr_b16 v[202:203], v115 offset:59392
Mvva 184,228,44
Mvva 184,232,52
ds_read_b64_tr_b16 v[204:205], v115 offset:61440
ds_read_b64_tr_b16 v[206:207], v115 offset:63488
Mvva 184,236,60
buffer_load_dwordx4 a[100:103], v112, s[8:11], s52 offen offset:1024 sc1
s_add_u32 s52, s52, 8192
Mvva 172,240,32
ds_read_b64_tr_b16 v[208:209], v116 offset:49152
ds_read_b64_tr_b16 v[210:211], v116 offset:51200
Mvva 172,244,40
Mvva 172,248,48
ds_read_b64_tr_b16 v[212:213], v116 offset:53248
ds_read_b64_tr_b16 v[214:215], v116 offset:55296
Mvva 172,252,56
buffer_load_dwordx4 a[104:107], v112, s[8:11], s52 offen offset:0 sc1
Mvva 188,240,36
s_waitcnt lgkmcnt(4)
ds_read_b64_tr_b16 v[216:217], v116 offset:57344
ds_read_b64_tr_b16 v[218:219], v116 offset:59392
Mvva 188,244,44
Mvva 188,248,52
ds_read_b64_tr_b16 v[220:221], v116 offset:61440
ds_read_b64_tr_b16 v[222:223], v116 offset:63488
Mvva 188,252,60
buffer_load_dwordx4 a[108:111], v112, s[8:11], s52 offen offset:1024 sc1
s_add_u32 s52, s52, 8192
Mvva 128,192,32
ds_read_b64_tr_b16 v[224:225], v117 offset:49152
ds_read_b64_tr_b16 v[226:227], v117 offset:51200
Mvva 128,196,40
Mvva 128,200,48
s_add_u32 m0, s44, 98304
ds_read_b64_tr_b16 v[228:229], v117 offset:53248
ds_read_b64_tr_b16 v[230:231], v117 offset:55296
Mvva 128,204,56
buffer_load_dwordx4 v114, s[12:15], s48 offen offset:0 lds
Mvva 144,192,36
s_waitcnt lgkmcnt(4)
ds_read_b64_tr_b16 v[232:233], v117 offset:57344
ds_read_b64_tr_b16 v[234:235], v117 offset:59392
Mvva 144,196,44
Mvva 144,200,52
ds_read_b64_tr_b16 v[236:237], v117 offset:61440
ds_read_b64_tr_b16 v[238:239], v117 offset:63488
Mvva 144,204,60
buffer_load_dwordx4 v114, s[12:15], s49 offen offset:1024 lds
Mvva 132,208,32
ds_read_b64_tr_b16 v[240:241], v118 offset:49152
ds_read_b64_tr_b16 v[242:243], v118 offset:51200
Mvva 132,212,40
Mvva 132,216,48
s_waitcnt lgkmcnt(2)
ds_read_b64_tr_b16 v[244:245], v118 offset:53248
ds_read_b64_tr_b16 v[246:247], v118 offset:55296
Mvva 132,220,56
buffer_load_dwordx4 v114, s[12:15], s50 offen offset:2048 lds
Mvva 148,208,36
s_waitcnt vmcnt(15)
ds_read_b64_tr_b16 v[248:249], v118 offset:57344
ds_read_b64_tr_b16 v[250:251], v118 offset:59392
Mvva 148,212,44
Mvva 148,216,52
s_barrier
ds_read_b64_tr_b16 v[252:253], v118 offset:61440
ds_read_b64_tr_b16 v[254:255], v118 offset:63488
Mvva 148,220,60
buffer_load_dwordx4 v114, s[12:15], s51 offen offset:3072 lds
v_xor_b32 v114, 128, v114
Mvva 136,224,32
ds_read_b64_tr_b16 v[192:193], v12 offset:0
ds_read_b64_tr_b16 v[194:195], v12 offset:2048
Mvva 136,228,40
Mvva 136,232,48
ds_read_b64_tr_b16 v[196:197], v12 offset:4096
ds_read_b64_tr_b16 v[198:199], v12 offset:6144
Mvva 136,236,56
buffer_load_dwordx4 a[112:115], v112, s[8:11], s52 offen offset:0 sc1
Mvva 152,224,36
s_waitcnt lgkmcnt(4)
ds_read_b64_tr_b16 v[200:201], v12 offset:8192
ds_read_b64_tr_b16 v[202:203], v12 offset:10240
Mvva 152,228,44
Mvva 152,232,52
ds_read_b64_tr_b16 v[204:205], v12 offset:12288
ds_read_b64_tr_b16 v[206:207], v12 offset:14336
Mvva 152,236,60
buffer_load_dwordx4 a[116:119], v112, s[8:11], s52 offen offset:1024 sc1
s_add_u32 s52, s52, 8192
Mvva 140,240,32
ds_read_b64_tr_b16 v[208:209], v13 offset:0
ds_read_b64_tr_b16 v[210:211], v13 offset:2048
Mvva 140,244,40
Mvva 140,248,48
ds_read_b64_tr_b16 v[212:213], v13 offset:4096
ds_read_b64_tr_b16 v[214:215], v13 offset:6144
Mvva 140,252,56
buffer_load_dwordx4 a[120:123], v112, s[8:11], s52 offen offset:0 sc1
Mvva 156,240,36
s_waitcnt lgkmcnt(4)
ds_read_b64_tr_b16 v[216:217], v13 offset:8192
ds_read_b64_tr_b16 v[218:219], v13 offset:10240
Mvva 156,244,44
Mvva 156,248,52
s_waitcnt vmcnt(15)
ds_read_b64_tr_b16 v[220:221], v13 offset:12288
ds_read_b64_tr_b16 v[222:223], v13 offset:14336
Mvva 156,252,60
buffer_load_dwordx4 a[124:127], v112, s[8:11], s52 offen offset:1024 sc1
s_add_u32 s52, s52, 8192
Mvva 160,192,64
ds_read_b64_tr_b16 v[224:225], v14 offset:0
ds_read_b64_tr_b16 v[226:227], v14 offset:2048
Mvva 160,196,72
Mvva 160,200,80
s_add_u32 m0, s44, 114688
ds_read_b64_tr_b16 v[228:229], v14 offset:4096
ds_read_b64_tr_b16 v[230:231], v14 offset:6144
Mvva 160,204,88
buffer_load_dwordx4 v114, s[12:15], s48 offen offset:0 lds
Mvva 176,192,68
s_waitcnt lgkmcnt(4)
ds_read_b64_tr_b16 v[232:233], v14 offset:8192
ds_read_b64_tr_b16 v[234:235], v14 offset:10240
Mvva 176,196,76
Mvva 176,200,84
ds_read_b64_tr_b16 v[236:237], v14 offset:12288
ds_read_b64_tr_b16 v[238:239], v14 offset:14336
Mvva 176,204,92
buffer_load_dwordx4 v114, s[12:15], s49 offen offset:1024 lds
Mvva 164,208,64
ds_read_b64_tr_b16 v[240:241], v15 offset:0
ds_read_b64_tr_b16 v[242:243], v15 offset:2048
Mvva 164,212,72
Mvva 164,216,80
s_waitcnt lgkmcnt(2)
ds_read_b64_tr_b16 v[244:245], v15 offset:4096
ds_read_b64_tr_b16 v[246:247], v15 offset:6144
Mvva 164,220,88
buffer_load_dwordx4 v114, s[12:15], s50 offen offset:2048 lds
Mvva 180,208,68
s_waitcnt vmcnt(15)
ds_read_b64_tr_b16 v[248:249], v15 offset:8192
ds_read_b64_tr_b16 v[250:251], v15 offset:10240
Mvva 180,212,76
Mvva 180,216,84
s_barrier
ds_read_b64_tr_b16 v[252:253], v15 offset:12288
ds_read_b64_tr_b16 v[254:255], v15 offset:14336
Mvva 180,220,92
buffer_load_dwordx4 v114, s[12:15], s51 offen offset:3072 lds
v_xor_b32 v114, 128, v114
v_add_u32 v114, 262144, v114
Mvva 168,224,64
ds_read_b64_tr_b16 v[192:193], v12 offset:16384
ds_read_b64_tr_b16 v[194:195], v12 offset:18432
Mvva 168,228,72
Mvva 168,232,80
ds_read_b64_tr_b16 v[196:197], v12 offset:20480
ds_read_b64_tr_b16 v[198:199], v12 offset:22528
Mvva 168,236,88
buffer_load_dwordx4 a[128:131], v112, s[8:11], s52 offen offset:0 sc1
Mvva 184,224,68
s_waitcnt lgkmcnt(4)
ds_read_b64_tr_b16 v[200:201], v12 offset:24576
ds_read_b64_tr_b16 v[202:203], v12 offset:26624
Mvva 184,228,76
Mvva 184,232,84
ds_read_b64_tr_b16 v[204:205], v12 offset:28672
ds_read_b64_tr_b16 v[206:207], v12 offset:30720
Mvva 184,236,92
buffer_load_dwordx4 a[132:135], v112, s[8:11], s52 offen offset:1024 sc1
s_add_u32 s52, s52, 8192
Mvva 172,240,64
ds_read_b64_tr_b16 v[208:209], v13 offset:16384
ds_read_b64_tr_b16 v[210:211], v13 offset:18432
Mvva 172,244,72
Mvva 172,248,80
ds_read_b64_tr_b16 v[212:213], v13 offset:20480
ds_read_b64_tr_b16 v[214:215], v13 offset:22528
Mvva 172,252,88
buffer_load_dwordx4 a[136:139], v112, s[8:11], s52 offen offset:0 sc1
Mvva 188,240,68
s_waitcnt lgkmcnt(4)
ds_read_b64_tr_b16 v[216:217], v13 offset:24576
ds_read_b64_tr_b16 v[218:219], v13 offset:26624
Mvva 188,244,76
Mvva 188,248,84
ds_read_b64_tr_b16 v[220:221], v13 offset:28672
ds_read_b64_tr_b16 v[222:223], v13 offset:30720
Mvva 188,252,92
buffer_load_dwordx4 a[140:143], v112, s[8:11], s52 offen offset:1024 sc1
s_add_u32 s52, s52, 8192
Mvva 128,192,64
ds_read_b64_tr_b16 v[224:225], v14 offset:16384
ds_read_b64_tr_b16 v[226:227], v14 offset:18432
Mvva 128,196,72
s_cmp_lt_u32 s93, 224
s_cbranch_scc1 L_f2A
L_f2Ar:
Mvva 128,200,80
s_add_u32 m0, s44, 0
ds_read_b64_tr_b16 v[228:229], v14 offset:20480
ds_read_b64_tr_b16 v[230:231], v14 offset:22528
Mvva 128,204,88
buffer_load_dwordx4 v114, s[12:15], s48 offen offset:0 lds
Mvva 144,192,68
s_waitcnt lgkmcnt(4)
ds_read_b64_tr_b16 v[232:233], v14 offset:24576
ds_read_b64_tr_b16 v[234:235], v14 offset:26624
Mvva 144,196,76
Mvva 144,200,84
ds_read_b64_tr_b16 v[236:237], v14 offset:28672
ds_read_b64_tr_b16 v[238:239], v14 offset:30720
Mvva 144,204,92
buffer_load_dwordx4 v114, s[12:15], s49 offen offset:1024 lds
Mvva 132,208,64
ds_read_b64_tr_b16 v[240:241], v15 offset:16384
ds_read_b64_tr_b16 v[242:243], v15 offset:18432
Mvva 132,212,72
Mvva 132,216,80
s_waitcnt lgkmcnt(2)
ds_read_b64_tr_b16 v[244:245], v15 offset:20480
ds_read_b64_tr_b16 v[246:247], v15 offset:22528
Mvva 132,220,88
buffer_load_dwordx4 v114, s[12:15], s50 offen offset:2048 lds
Mvva 148,208,68
s_waitcnt vmcnt(15)
ds_read_b64_tr_b16 v[248:249], v15 offset:24576
ds_read_b64_tr_b16 v[250:251], v15 offset:26624
Mvva 148,212,76
Mvva 148,216,84
s_barrier
ds_read_b64_tr_b16 v[252:253], v15 offset:28672
ds_read_b64_tr_b16 v[254:255], v15 offset:30720
Mvva 148,220,92
buffer_load_dwordx4 v114, s[12:15], s51 offen offset:3072 lds
v_xor_b32 v114, 128, v114
Mvva 136,224,64
ds_read_b64_tr_b16 v[192:193], v12 offset:32768
ds_read_b64_tr_b16 v[194:195], v12 offset:34816
Mvva 136,228,72
Mvva 136,232,80
ds_read_b64_tr_b16 v[196:197], v12 offset:36864
ds_read_b64_tr_b16 v[198:199], v12 offset:38912
Mvva 136,236,88
buffer_load_dwordx4 a[144:147], v112, s[8:11], s52 offen offset:0 sc1
Mvva 152,224,68
s_waitcnt lgkmcnt(4)
ds_read_b64_tr_b16 v[200:201], v12 offset:40960
ds_read_b64_tr_b16 v[202:203], v12 offset:43008
Mvva 152,228,76
Mvva 152,232,84
ds_read_b64_tr_b16 v[204:205], v12 offset:45056
ds_read_b64_tr_b16 v[206:207], v12 offset:47104
Mvva 152,236,92
buffer_load_dwordx4 a[148:151], v112, s[8:11], s52 offen offset:1024 sc1
s_add_u32 s52, s52, 8192
Mvva 140,240,64
ds_read_b64_tr_b16 v[208:209], v13 offset:32768
ds_read_b64_tr_b16 v[210:211], v13 offset:34816
Mvva 140,244,72
Mvva 140,248,80
ds_read_b64_tr_b16 v[212:213], v13 offset:36864
ds_read_b64_tr_b16 v[214:215], v13 offset:38912
Mvva 140,252,88
buffer_load_dwordx4 a[152:155], v112, s[8:11], s52 offen offset:0 sc1
Mvva 156,240,68
s_waitcnt lgkmcnt(4)
ds_read_b64_tr_b16 v[216:217], v13 offset:40960
ds_read_b64_tr_b16 v[218:219], v13 offset:43008
Mvva 156,244,76
Mvva 156,248,84
s_waitcnt vmcnt(15)
ds_read_b64_tr_b16 v[220:221], v13 offset:45056
ds_read_b64_tr_b16 v[222:223], v13 offset:47104
Mvva 156,252,92
buffer_load_dwordx4 a[156:159], v112, s[8:11], s52 offen offset:1024 sc1
s_add_u32 s52, s52, 8192
Mvva 160,192,96
ds_read_b64_tr_b16 v[224:225], v14 offset:32768
ds_read_b64_tr_b16 v[226:227], v14 offset:34816
Mvva 160,196,104
Mvva 160,200,112
s_add_u32 m0, s44, 16384
ds_read_b64_tr_b16 v[228:229], v14 offset:36864
ds_read_b64_tr_b16 v[230:231], v14 offset:38912
Mvva 160,204,120
buffer_load_dwordx4 v114, s[12:15], s48 offen offset:0 lds
Mvva 176,192,100
s_waitcnt lgkmcnt(4)
ds_read_b64_tr_b16 v[232:233], v14 offset:40960
ds_read_b64_tr_b16 v[234:235], v14 offset:43008
Mvva 176,196,108
Mvva 176,200,116
ds_read_b64_tr_b16 v[236:237], v14 offset:45056
ds_read_b64_tr_b16 v[238:239], v14 offset:47104
Mvva 176,204,124
buffer_load_dwordx4 v114, s[12:15], s49 offen offset:1024 lds
Mvva 164,208,96
ds_read_b64_tr_b16 v[240:241], v15 offset:32768
ds_read_b64_tr_b16 v[242:243], v15 offset:34816
Mvva 164,212,104
Mvva 164,216,112
s_waitcnt lgkmcnt(2)
ds_read_b64_tr_b16 v[244:245], v15 offset:36864
ds_read_b64_tr_b16 v[246:247], v15 offset:38912
Mvva 164,220,120
buffer_load_dwordx4 v114, s[12:15], s50 offen offset:2048 lds
Mvva 180,208,100
s_waitcnt vmcnt(15)
ds_read_b64_tr_b16 v[248:249], v15 offset:40960
ds_read_b64_tr_b16 v[250:251], v15 offset:43008
Mvva 180,212,108
Mvva 180,216,116
s_barrier
ds_read_b64_tr_b16 v[252:253], v15 offset:45056
ds_read_b64_tr_b16 v[254:255], v15 offset:47104
Mvva 180,220,124
buffer_load_dwordx4 v114, s[12:15], s51 offen offset:3072 lds
v_xor_b32 v114, 128, v114
v_add_u32 v114, 262144, v114
Mvva 168,224,96
ds_read_b64_tr_b16 v[192:193], v12 offset:49152
ds_read_b64_tr_b16 v[194:195], v12 offset:51200
Mvva 168,228,104
Mvva 168,232,112
ds_read_b64_tr_b16 v[196:197], v12 offset:53248
ds_read_b64_tr_b16 v[198:199], v12 offset:55296
Mvva 168,236,120
buffer_load_dwordx4 a[160:163], v112, s[8:11], s52 offen offset:0 sc1
Mvva 184,224,100
s_waitcnt lgkmcnt(4)
ds_read_b64_tr_b16 v[200:201], v12 offset:57344
ds_read_b64_tr_b16 v[202:203], v12 offset:59392
Mvva 184,228,108
Mvva 184,232,116
ds_read_b64_tr_b16 v[204:205], v12 offset:61440
ds_read_b64_tr_b16 v[206:207], v12 offset:63488
Mvva 184,236,124
buffer_load_dwordx4 a[164:167], v112, s[8:11], s52 offen offset:1024 sc1
s_add_u32 s52, s52, 8192
Mvva 172,240,96
ds_read_b64_tr_b16 v[208:209], v13 offset:49152
ds_read_b64_tr_b16 v[210:211], v13 offset:51200
Mvva 172,244,104
Mvva 172,248,112
ds_read_b64_tr_b16 v[212:213], v13 offset:53248
ds_read_b64_tr_b16 v[214:215], v13 offset:55296
Mvva 172,252,120
buffer_load_dwordx4 a[168:171], v112, s[8:11], s52 offen offset:0 sc1
Mvva 188,240,100
s_waitcnt lgkmcnt(4)
ds_read_b64_tr_b16 v[216:217], v13 offset:57344
ds_read_b64_tr_b16 v[218:219], v13 offset:59392
Mvva 188,244,108
Mvva 188,248,116
ds_read_b64_tr_b16 v[220:221], v13 offset:61440
ds_read_b64_tr_b16 v[222:223], v13 offset:63488
Mvva 188,252,124
buffer_load_dwordx4 a[172:175], v112, s[8:11], s52 offen offset:1024 sc1
s_add_u32 s52, s52, 8192
Mvva 128,192,96
ds_read_b64_tr_b16 v[224:225], v14 offset:49152
ds_read_b64_tr_b16 v[226:227], v14 offset:51200
Mvva 128,196,104
Mvva 128,200,112
s_add_u32 m0, s44, 32768
ds_read_b64_tr_b16 v[228:229], v14 offset:53248
ds_read_b64_tr_b16 v[230:231], v14 offset:55296
Mvva 128,204,120
buffer_load_dwordx4 v114, s[12:15], s48 offen offset:0 lds
Mvva 144,192,100
s_waitcnt lgkmcnt(4)
ds_read_b64_tr_b16 v[232:233], v14 offset:57344
ds_read_b64_tr_b16 v[234:235], v14 offset:59392
Mvva 144,196,108
Mvva 144,200,116
ds_read_b64_tr_b16 v[236:237], v14 offset:61440
ds_read_b64_tr_b16 v[238:239], v14 offset:63488
Mvva 144,204,124
buffer_load_dwordx4 v114, s[12:15], s49 offen offset:1024 lds
Mvva 132,208,96
ds_read_b64_tr_b16 v[240:241], v15 offset:49152
ds_read_b64_tr_b16 v[242:243], v15 offset:51200
Mvva 132,212,104
Mvva 132,216,112
s_waitcnt lgkmcnt(2)
ds_read_b64_tr_b16 v[244:245], v15 offset:53248
ds_read_b64_tr_b16 v[246:247], v15 offset:55296
Mvva 132,220,120
buffer_load_dwordx4 v114, s[12:15], s50 offen offset:2048 lds
Mvva 148,208,100
s_waitcnt vmcnt(15)
ds_read_b64_tr_b16 v[248:249], v15 offset:57344
ds_read_b64_tr_b16 v[250:251], v15 offset:59392
Mvva 148,212,108
s_cmp_lt_u32 s93, 224
s_cbranch_scc1 L_f2B
L_f2Br:
Mvva 148,216,116
s_barrier
ds_read_b64_tr_b16 v[252:253], v15 offset:61440
ds_read_b64_tr_b16 v[254:255], v15 offset:63488
Mvva 148,220,124
buffer_load_dwordx4 v114, s[12:15], s51 offen offset:3072 lds
v_xor_b32 v114, 128, v114
Mvva 136,224,96
ds_read_b64_tr_b16 v[192:193], v115 offset:0
ds_read_b64_tr_b16 v[194:195], v115 offset:2048
Mvva 136,228,104
Mvva 136,232,112
ds_read_b64_tr_b16 v[196:197], v115 offset:4096
ds_read_b64_tr_b16 v[198:199], v115 offset:6144
Mvva 136,236,120
buffer_load_dwordx4 a[176:179], v112, s[8:11], s52 offen offset:0 sc1
Mvva 152,224,100
s_waitcnt lgkmcnt(4)
ds_read_b64_tr_b16 v[200:201], v115 offset:8192
ds_read_b64_tr_b16 v[202:203], v115 offset:10240
Mvva 152,228,108
Mvva 152,232,116
ds_read_b64_tr_b16 v[204:205], v115 offset:12288
ds_read_b64_tr_b16 v[206:207], v115 offset:14336
Mvva 152,236,124
buffer_load_dwordx4 a[180:183], v112, s[8:11], s52 offen offset:1024 sc1
s_add_u32 s52, s52, 8192
Mvva 140,240,96
ds_read_b64_tr_b16 v[208:209], v116 offset:0
ds_read_b64_tr_b16 v[210:211], v116 offset:2048
Mvva 140,244,104
Mvva 140,248,112
ds_read_b64_tr_b16 v[212:213], v116 offset:4096
ds_read_b64_tr_b16 v[214:215], v116 offset:6144
Mvva 140,252,120
buffer_load_dwordx4 a[184:187], v112, s[8:11], s52 offen offset:0 sc1
Mvva 156,240,100
s_waitcnt lgkmcnt(4)
ds_read_b64_tr_b16 v[216:217], v116 offset:8192
ds_read_b64_tr_b16 v[218:219], v116 offset:10240
Mvva 156,244,108
Mvva 156,248,116
s_waitcnt vmcnt(15)
ds_read_b64_tr_b16 v[220:221], v116 offset:12288
ds_read_b64_tr_b16 v[222:223], v116 offset:14336
Mvva 156,252,124
buffer_load_dwordx4 a[188:191], v112, s[8:11], s52 offen offset:1024 sc1
s_add_u32 s52, s52, 8192
Mvva 160,192,128
ds_read_b64_tr_b16 v[224:225], v117 offset:0
ds_read_b64_tr_b16 v[226:227], v117 offset:2048
Mvva 160,196,136
Mvva 160,200,144
s_add_u32 m0, s44, 49152
ds_read_b64_tr_b16 v[228:229], v117 offset:4096
ds_read_b64_tr_b16 v[230:231], v117 offset:6144
Mvva 160,204,152
buffer_load_dwordx4 v114, s[12:15], s48 offen offset:0 lds
Mvva 176,192,132
s_waitcnt lgkmcnt(4)
ds_read_b64_tr_b16 v[232:233], v117 offset:8192
ds_read_b64_tr_b16 v[234:235], v117 offset:10240
Mvva 176,196,140
Mvva 176,200,148
ds_read_b64_tr_b16 v[236:237], v117 offset:12288
ds_read_b64_tr_b16 v[238:239], v117 offset:14336
Mvva 176,204,156
buffer_load_dwordx4 v114, s[12:15], s49 offen offset:1024 lds
Mvva 164,208,128
ds_read_b64_tr_b16 v[240:241], v118 offset:0
ds_read_b64_tr_b16 v[242:243], v118 offset:2048
Mvva 164,212,136
Mvva 164,216,144
s_waitcnt lgkmcnt(2)
ds_read_b64_tr_b16 v[244:245], v118 offset:4096
ds_read_b64_tr_b16 v[246:247], v118 offset:6144
Mvva 164,220,152
buffer_load_dwordx4 v114, s[12:15], s50 offen offset:2048 lds
Mvva 180,208,132
s_waitcnt vmcnt(15)
ds_read_b64_tr_b16 v[248:249], v118 offset:8192
ds_read_b64_tr_b16 v[250:251], v118 offset:10240
Mvva 180,212,140
Mvva 180,216,148
s_barrier
ds_read_b64_tr_b16 v[252:253], v118 offset:12288
ds_read_b64_tr_b16 v[254:255], v118 offset:14336
Mvva 180,220,156
buffer_load_dwordx4 v114, s[12:15], s51 offen offset:3072 lds
v_xor_b32 v114, 128, v114
v_add_u32 v114, 262144, v114
Mvva 168,224,128
ds_read_b64_tr_b16 v[192:193], v115 offset:16384
ds_read_b64_tr_b16 v[194:195], v115 offset:18432
Mvva 168,228,136
Mvva 168,232,144
ds_read_b64_tr_b16 v[196:197], v115 offset:20480
ds_read_b64_tr_b16 v[198:199], v115 offset:22528
Mvva 168,236,152
buffer_load_dwordx4 a[192:195], v112, s[8:11], s52 offen offset:0 sc1
Mvva 184,224,132
s_waitcnt lgkmcnt(4)
ds_read_b64_tr_b16 v[200:201], v115 offset:24576
ds_read_b64_tr_b16 v[202:203], v115 offset:26624
Mvva 184,228,140
Mvva 184,232,148
ds_read_b64_tr_b16 v[204:205], v115 offset:28672
ds_read_b64_tr_b16 v[206:207], v115 offset:30720
Mvva 184,236,156
buffer_load_dwordx4 a[196:199], v112, s[8:11], s52 offen offset:1024 sc1
s_add_u32 s52, s52, 8192
Mvva 172,240,128
ds_read_b64_tr_b16 v[208:209], v116 offset:16384
ds_read_b64_tr_b16 v[210:211], v116 offset:18432
Mvva 172,244,136
Mvva 172,248,144
ds_read_b64_tr_b16 v[212:213], v116 offset:20480
ds_read_b64_tr_b16 v[214:215], v116 offset:22528
Mvva 172,252,152
buffer_load_dwordx4 a[200:203], v112, s[8:11], s52 offen offset:0 sc1
Mvva 188,240,132
s_waitcnt lgkmcnt(4)
ds_read_b64_tr_b16 v[216:217], v116 offset:24576
ds_read_b64_tr_b16 v[218:219], v116 offset:26624
Mvva 188,244,140
Mvva 188,248,148
ds_read_b64_tr_b16 v[220:221], v116 offset:28672
ds_read_b64_tr_b16 v[222:223], v116 offset:30720
Mvva 188,252,156
buffer_load_dwordx4 a[204:207], v112, s[8:11], s52 offen offset:1024 sc1
s_add_u32 s52, s52, 8192
Mvva 128,192,128
ds_read_b64_tr_b16 v[224:225], v117 offset:16384
ds_read_b64_tr_b16 v[226:227], v117 offset:18432
Mvva 128,196,136
Mvva 128,200,144
s_add_u32 m0, s44, 65536
ds_read_b64_tr_b16 v[228:229], v117 offset:20480
ds_read_b64_tr_b16 v[230:231], v117 offset:22528
Mvva 128,204,152
buffer_load_dwordx4 v114, s[12:15], s48 offen offset:0 lds
Mvva 144,192,132
s_waitcnt lgkmcnt(4)
ds_read_b64_tr_b16 v[232:233], v117 offset:24576
ds_read_b64_tr_b16 v[234:235], v117 offset:26624
Mvva 144,196,140
Mvva 144,200,148
ds_read_b64_tr_b16 v[236:237], v117 offset:28672
ds_read_b64_tr_b16 v[238:239], v117 offset:30720
Mvva 144,204,156
buffer_load_dwordx4 v114, s[12:15], s49 offen offset:1024 lds
Mvva 132,208,128
ds_read_b64_tr_b16 v[240:241], v118 offset:16384
ds_read_b64_tr_b16 v[242:243], v118 offset:18432
Mvva 132,212,136
Mvva 132,216,144
s_waitcnt lgkmcnt(2)
ds_read_b64_tr_b16 v[244:245], v118 offset:20480
ds_read_b64_tr_b16 v[246:247], v118 offset:22528
Mvva 132,220,152
buffer_load_dwordx4 v114, s[12:15], s50 offen offset:2048 lds
Mvva 148,208,132
s_waitcnt vmcnt(15)
ds_read_b64_tr_b16 v[248:249], v118 offset:24576
ds_read_b64_tr_b16 v[250:251], v118 offset:26624
Mvva 148,212,140
Mvva 148,216,148
s_barrier
ds_read_b64_tr_b16 v[252:253], v118 offset:28672
ds_read_b64_tr_b16 v[254:255], v118 offset:30720
Mvva 148,220,156
buffer_load_dwordx4 v114, s[12:15], s51 offen offset:3072 lds
v_xor_b32 v114, 128, v114
Mvva 136,224,128
ds_read_b64_tr_b16 v[192:193], v115 offset:32768
ds_read_b64_tr_b16 v[194:195], v115 offset:34816
Mvva 136,228,136
s_cmp_ge_u32 s2, 128
s_cbranch_scc1 L_c31
L_c31r:
Mvva 136,232,144
ds_read_b64_tr_b16 v[196:197], v115 offset:36864
ds_read_b64_tr_b16 v[198:199], v115 offset:38912
Mvva 136,236,152
buffer_load_dwordx4 a[208:211], v112, s[8:11], s52 offen offset:0 sc1
Mvva 152,224,132
s_waitcnt lgkmcnt(4)
ds_read_b64_tr_b16 v[200:201], v115 offset:40960
ds_read_b64_tr_b16 v[202:203], v115 offset:43008
Mvva 152,228,140
Mvva 152,232,148
ds_read_b64_tr_b16 v[204:205], v115 offset:45056
ds_read_b64_tr_b16 v[206:207], v115 offset:47104
Mvva 152,236,156
buffer_load_dwordx4 a[212:215], v112, s[8:11], s52 offen offset:1024 sc1
s_add_u32 s52, s52, 8192
Mvva 140,240,128
ds_read_b64_tr_b16 v[208:209], v116 offset:32768
ds_read_b64_tr_b16 v[210:211], v116 offset:34816
Mvva 140,244,136
Mvva 140,248,144
ds_read_b64_tr_b16 v[212:213], v116 offset:36864
ds_read_b64_tr_b16 v[214:215], v116 offset:38912
Mvva 140,252,152
buffer_load_dwordx4 a[216:219], v112, s[8:11], s52 offen offset:0 sc1
Mvva 156,240,132
s_waitcnt lgkmcnt(4)
ds_read_b64_tr_b16 v[216:217], v116 offset:40960
ds_read_b64_tr_b16 v[218:219], v116 offset:43008
Mvva 156,244,140
s_waitcnt vmcnt(16)
Va 74,74,78
Va 75,75,79
Va 76,76,80
Mvva 156,248,148
s_waitcnt vmcnt(15)
ds_read_b64_tr_b16 v[220:221], v116 offset:45056
ds_read_b64_tr_b16 v[222:223], v116 offset:47104
Va 77,77,81
Mvva 156,252,156
buffer_load_dwordx4 a[220:223], v112, s[8:11], s52 offen offset:1024 sc1
s_add_u32 s52, s52, 8192
Mvva 160,192,160
ds_read_b64_tr_b16 v[224:225], v117 offset:32768
ds_read_b64_tr_b16 v[226:227], v117 offset:34816
v_add_f32_e64 v74, v74, v82
Mvva 160,196,168
Va 75,75,83
Va 76,76,84
v_add_f32_e64 v77, v77, v85
Mvva 160,200,176
s_add_u32 m0, s44, 81920
ds_read_b64_tr_b16 v[228:229], v117 offset:36864
ds_read_b64_tr_b16 v[230:231], v117 offset:38912
v_add_f32_e64 v74, v74, v86
Mvva 160,204,184
buffer_load_dwordx4 v114, s[12:15], s48 offen offset:0 lds
Mvva 176,192,164
s_waitcnt lgkmcnt(4)
ds_read_b64_tr_b16 v[232:233], v117 offset:40960
ds_read_b64_tr_b16 v[234:235], v117 offset:43008
Va 75,75,87
Mvva 176,196,172
Va 76,76,88
Va 77,77,89
v_add_f32_e64 v74, v74, v90
Mvva 176,200,180
ds_read_b64_tr_b16 v[236:237], v117 offset:45056
ds_read_b64_tr_b16 v[238:239], v117 offset:47104
v_add_f32_e64 v75, v75, v91
Mvva 176,204,188
buffer_load_dwordx4 v114, s[12:15], s49 offen offset:1024 lds
Mvva 164,208,160
ds_read_b64_tr_b16 v[240:241], v118 offset:32768
ds_read_b64_tr_b16 v[242:243], v118 offset:34816
v_add_f32_e64 v76, v76, v92
Mvva 164,212,168
Va 77,77,93
Va 74,74,94
v_add_f32_e64 v75, v75, v95
Mvva 164,216,176
s_waitcnt lgkmcnt(2)
ds_read_b64_tr_b16 v[244:245], v118 offset:36864
ds_read_b64_tr_b16 v[246:247], v118 offset:38912
Va 76,76,96
Mvva 164,220,184
buffer_load_dwordx4 v114, s[12:15], s50 offen offset:2048 lds
Mvva 180,208,164
s_waitcnt vmcnt(15)
ds_read_b64_tr_b16 v[248:249], v118 offset:40960
ds_read_b64_tr_b16 v[250:251], v118 offset:43008
Va 77,77,97
Mvva 180,212,172
Va 74,74,98
Va 75,75,99
v_add_f32_e64 v76, v76, v100
Mvva 180,216,180
s_barrier
ds_read_b64_tr_b16 v[252:253], v118 offset:45056
ds_read_b64_tr_b16 v[254:255], v118 offset:47104
Va 77,77,101
Mvva 180,220,188
buffer_load_dwordx4 v114, s[12:15], s51 offen offset:3072 lds
v_xor_b32 v114, 128, v114
v_add_u32 v114, 262144, v114
Mvva 168,224,160
ds_read_b64_tr_b16 v[192:193], v115 offset:49152
ds_read_b64_tr_b16 v[194:195], v115 offset:51200
v_add_f32_e64 v74, v74, v102
Mvva 168,228,168
Va 75,75,103
Va 76,76,104
v_add_f32_e64 v77, v77, v105
Mvva 168,232,176
ds_read_b64_tr_b16 v[196:197], v115 offset:53248
ds_read_b64_tr_b16 v[198:199], v115 offset:55296
Mvva 168,236,184
buffer_load_dwordx4 a[224:227], v112, s[8:11], s52 offen offset:0 sc1
Mvva 184,224,164
s_waitcnt lgkmcnt(4)
ds_read_b64_tr_b16 v[200:201], v115 offset:57344
ds_read_b64_tr_b16 v[202:203], v115 offset:59392
Mvva 184,228,172
ds_read_b64_tr_b16 v[90:91], v106 offset:0
ds_read_b64_tr_b16 v[92:93], v106 offset:2048
ds_read_b64_tr_b16 v[94:95], v107 offset:0
Mvva 184,232,180
ds_read_b64_tr_b16 v[204:205], v115 offset:61440
ds_read_b64_tr_b16 v[206:207], v115 offset:63488
Mvva 184,236,188
buffer_load_dwordx4 a[228:231], v112, s[8:11], s52 offen offset:1024 sc1
s_add_u32 s52, s52, 8192
Mvva 172,240,160
ds_read_b64_tr_b16 v[208:209], v116 offset:49152
ds_read_b64_tr_b16 v[210:211], v116 offset:51200
Mvva 172,244,168
ds_read_b64_tr_b16 v[96:97], v107 offset:2048
ds_read_b64_tr_b16 v[98:99], v108 offset:0
s_waitcnt lgkmcnt(9)
ds_read_b64_tr_b16 v[100:101], v108 offset:2048
Mvva 172,248,176
ds_read_b64_tr_b16 v[212:213], v116 offset:53248
ds_read_b64_tr_b16 v[214:215], v116 offset:55296
Mvva 172,252,184
buffer_load_dwordx4 a[232:235], v112, s[8:11], s52 offen offset:0 sc1
Mvva 188,240,164
s_waitcnt lgkmcnt(7)
ds_read_b64_tr_b16 v[216:217], v116 offset:57344
ds_read_b64_tr_b16 v[218:219], v116 offset:59392
Mvva 188,244,172
ds_read_b64_tr_b16 v[102:103], v109 offset:0
ds_read_b64_tr_b16 v[104:105], v109 offset:2048
Vc 8,74,75
Mvva 188,248,180
ds_read_b64_tr_b16 v[220:221], v116 offset:61440
ds_read_b64_tr_b16 v[222:223], v116 offset:63488
v_lshlrev_b32 v74, 16, v8
Mvva 188,252,188
buffer_load_dwordx4 a[236:239], v112, s[8:11], s52 offen offset:1024 sc1
s_add_u32 s52, s52, 8192
Mvva 128,192,160
ds_read_b64_tr_b16 v[224:225], v117 offset:49152
ds_read_b64_tr_b16 v[226:227], v117 offset:51200
v_and_b32 v75, 0xffff0000, v8
Mvva 128,196,168
Vc 8,76,77
v_lshlrev_b32_e64 v76, 16, v8
v_and_b32 v77, 0xffff0000, v8
Mvva 128,200,176
s_add_u32 m0, s44, 98304
s_waitcnt lgkmcnt(9)
ds_read_b64_tr_b16 v[228:229], v117 offset:53248
ds_read_b64_tr_b16 v[230:231], v117 offset:55296
v_mov_b32 v78, v74
Mvva 128,204,184
buffer_load_dwordx4 v114, s[12:15], s48 offen offset:0 lds
Mvva 144,192,164
s_waitcnt lgkmcnt(4)
ds_read_b64_tr_b16 v[232:233], v117 offset:57344
ds_read_b64_tr_b16 v[234:235], v117 offset:59392
v_mov_b32 v79, v75
Mvva 144,196,172
v_mov_b32 v80, v76
v_mov_b32 v81, v77
v_permlane32_swap_b32 v78, v74
Mvva 144,200,180
ds_read_b64_tr_b16 v[236:237], v117 offset:61440
ds_read_b64_tr_b16 v[238:239], v117 offset:63488
v_permlane32_swap_b32 v79, v75
Mvva 144,204,188
buffer_load_dwordx4 v114, s[12:15], s49 offen offset:1024 lds
Mvva 132,208,160
ds_read_b64_tr_b16 v[240:241], v118 offset:49152
ds_read_b64_tr_b16 v[242:243], v118 offset:51200
v_permlane32_swap_b32 v80, v76
Mvva 132,212,168
v_permlane32_swap_b32 v81, v77
v_mul_f32 v82, 0xbfb8aa3b, v78
v_mul_f32 v83, 0xbfb8aa3b, v79
Mvva 132,216,176
s_waitcnt lgkmcnt(2)
ds_read_b64_tr_b16 v[244:245], v118 offset:53248
ds_read_b64_tr_b16 v[246:247], v118 offset:55296
v_mul_f32 v84, 0xbfb8aa3b, v80
Mvva 132,220,184
buffer_load_dwordx4 v114, s[12:15], s50 offen offset:2048 lds
Mvva 148,208,164
s_waitcnt vmcnt(15)
ds_read_b64_tr_b16 v[248:249], v118 offset:57344
ds_read_b64_tr_b16 v[250:251], v118 offset:59392
v_mul_f32 v85, 0xbfb8aa3b, v81
Mvva 148,212,172
VE 82,82
Mvva 148,216,180
s_barrier
ds_read_b64_tr_b16 v[252:253], v118 offset:61440
ds_read_b64_tr_b16 v[254:255], v118 offset:63488
Mvva 148,220,188
buffer_load_dwordx4 v114, s[12:15], s51 offen offset:3072 lds
v_xor_b32 v114, 128, v114
Mvva 136,224,160
ds_read_b64_tr_b16 v[192:193], v12 offset:0
ds_read_b64_tr_b16 v[194:195], v12 offset:2048
Mvva 136,228,168
Ve 83,83
Mvva 136,232,176
ds_read_b64_tr_b16 v[196:197], v12 offset:4096
ds_read_b64_tr_b16 v[198:199], v12 offset:6144
Mvva 136,236,184
buffer_load_dwordx4 a[240:243], v112, s[8:11], s52 offen offset:0 sc1
Mvva 152,224,164
s_waitcnt lgkmcnt(4)
ds_read_b64_tr_b16 v[200:201], v12 offset:8192
ds_read_b64_tr_b16 v[202:203], v12 offset:10240
Mvva 152,228,172
Ve 84,84
Mvva 152,232,180
ds_read_b64_tr_b16 v[204:205], v12 offset:12288
ds_read_b64_tr_b16 v[206:207], v12 offset:14336
Mvva 152,236,188
buffer_load_dwordx4 a[244:247], v112, s[8:11], s52 offen offset:1024 sc1
s_add_u32 s52, s52, 8192
Mvva 140,240,160
ds_read_b64_tr_b16 v[208:209], v13 offset:0
ds_read_b64_tr_b16 v[210:211], v13 offset:2048
Mvva 140,244,168
Ve 85,85
v_add_f32 v82, 1.0, v82
Mvva 140,248,176
ds_read_b64_tr_b16 v[212:213], v13 offset:4096
ds_read_b64_tr_b16 v[214:215], v13 offset:6144
v_add_f32_e64 v83, 1.0, v83
Mvva 140,252,184
buffer_load_dwordx4 a[248:251], v112, s[8:11], s52 offen offset:0 sc1
Mvva 156,240,164
s_waitcnt lgkmcnt(4)
ds_read_b64_tr_b16 v[216:217], v13 offset:8192
ds_read_b64_tr_b16 v[218:219], v13 offset:10240
v_add_f32 v84, 1.0, v84
Mvva 156,244,172
v_add_f32 v85, 1.0, v85
v_rcp_f32 v82, v82
Mvva 156,248,180
s_waitcnt vmcnt(15)
ds_read_b64_tr_b16 v[220:221], v13 offset:12288
ds_read_b64_tr_b16 v[222:223], v13 offset:14336
Mvva 156,252,188
buffer_load_dwordx4 a[252:255], v112, s[8:11], s52 offen offset:1024 sc1
s_add_u32 s52, s52, 8192
Mvva 160,192,192
ds_read_b64_tr_b16 v[224:225], v14 offset:0
ds_read_b64_tr_b16 v[226:227], v14 offset:2048
Mvva 160,196,200
v_rcp_f32 v83, v83
Mvva 160,200,208
s_add_u32 m0, s44, 114688
ds_read_b64_tr_b16 v[228:229], v14 offset:4096
ds_read_b64_tr_b16 v[230:231], v14 offset:6144
Mvva 160,204,216
buffer_load_dwordx4 v114, s[12:15], s48 offen offset:0 lds
Mvva 176,192,196
s_waitcnt lgkmcnt(4)
ds_read_b64_tr_b16 v[232:233], v14 offset:8192
ds_read_b64_tr_b16 v[234:235], v14 offset:10240
Mvva 176,196,204
v_rcp_f32 v84, v84
Mvva 176,200,212
ds_read_b64_tr_b16 v[236:237], v14 offset:12288
ds_read_b64_tr_b16 v[238:239], v14 offset:14336
Mvva 176,204,220
buffer_load_dwordx4 v114, s[12:15], s49 offen offset:1024 lds
Mvva 164,208,192
ds_read_b64_tr_b16 v[240:241], v15 offset:0
ds_read_b64_tr_b16 v[242:243], v15 offset:2048
Mvva 164,212,200
v_rcp_f32 v85, v85
Vm 78,78,82
Mvva 164,216,208
s_waitcnt lgkmcnt(2)
ds_read_b64_tr_b16 v[244:245], v15 offset:4096
ds_read_b64_tr_b16 v[246:247], v15 offset:6144
Vm 79,79,83
Mvva 164,220,216
buffer_load_dwordx4 v114, s[12:15], s50 offen offset:2048 lds
Mvva 180,208,196
s_waitcnt vmcnt(15)
ds_read_b64_tr_b16 v[248:249], v15 offset:8192
ds_read_b64_tr_b16 v[250:251], v15 offset:10240
Vm 80,80,84
Mvva 180,212,204
v_mul_f32_e64 v81, v81, v85
Vc 8,78,79
v_lshlrev_b32_e64 v78, 16, v8
Mvva 180,216,212
s_barrier
ds_read_b64_tr_b16 v[252:253], v15 offset:12288
ds_read_b64_tr_b16 v[254:255], v15 offset:14336
v_and_b32 v79, 0xffff0000, v8
Mvva 180,220,220
buffer_load_dwordx4 v114, s[12:15], s51 offen offset:3072 lds
v_xor_b32 v114, 128, v114
v_add_u32 v114, 262144, v114
Mvva 168,224,192
ds_read_b64_tr_b16 v[192:193], v12 offset:16384
ds_read_b64_tr_b16 v[194:195], v12 offset:18432
Vc 8,80,81
Mvva 168,228,200
v_lshlrev_b32 v80, 16, v8
v_and_b32 v81, 0xffff0000, v8
v_mul_f32_e64 v74, v74, v78
Mvva 168,232,208
ds_read_b64_tr_b16 v[196:197], v12 offset:20480
ds_read_b64_tr_b16 v[198:199], v12 offset:22528
v_mul_f32_e64 v75, v75, v79
Mvva 168,236,216
buffer_load_dwordx4 a[0:3], v112, s[8:11], s52 offen offset:0 sc1
Mvva 184,224,196
s_waitcnt lgkmcnt(4)
ds_read_b64_tr_b16 v[200:201], v12 offset:24576
ds_read_b64_tr_b16 v[202:203], v12 offset:26624
Vm 76,76,80
Mvva 184,228,204
v_mul_f32_e64 v77, v77, v81
Vc 8,74,75
Vc 9,76,77
Mvva 184,232,212
ds_read_b64_tr_b16 v[204:205], v12 offset:28672
ds_read_b64_tr_b16 v[206:207], v12 offset:30720
Mvva 184,236,220
buffer_load_dwordx4 a[4:7], v112, s[8:11], s52 offen offset:1024 sc1
s_add_u32 s52, s52, 8192
Mvva 172,240,192
ds_read_b64_tr_b16 v[208:209], v13 offset:16384
ds_read_b64_tr_b16 v[210:211], v13 offset:18432
Mvva 172,244,200
ds_write_b64 v2, v[8:9]
ds_read_b64 v[74:75], v3 offset:0
ds_read_b64 v[76:77], v3 offset:32
Mvva 172,248,208
ds_read_b64_tr_b16 v[212:213], v13 offset:20480
ds_read_b64_tr_b16 v[214:215], v13 offset:22528
Mvva 172,252,216
buffer_load_dwordx4 a[8:11], v112, s[8:11], s52 offen offset:0 sc1
Mvva 188,240,196
s_waitcnt lgkmcnt(7)
ds_read_b64_tr_b16 v[216:217], v13 offset:24576
ds_read_b64_tr_b16 v[218:219], v13 offset:26624
Mvva 188,244,204
ds_read_b64 v[78:79], v3 offset:64
ds_read_b64 v[80:81], v3 offset:96
Mvva 188,248,212
ds_read_b64_tr_b16 v[220:221], v13 offset:28672
ds_read_b64_tr_b16 v[222:223], v13 offset:30720
Mvva 188,252,220
buffer_load_dwordx4 a[12:15], v112, s[8:11], s52 offen offset:1024 sc1
s_add_u32 s52, s52, 8192
Mvva 128,192,192
ds_read_b64_tr_b16 v[224:225], v14 offset:16384
ds_read_b64_tr_b16 v[226:227], v14 offset:18432
Mvva 128,196,200
Mvva 128,200,208
s_add_u32 m0, s44, 0
s_waitcnt lgkmcnt(9)
ds_read_b64_tr_b16 v[228:229], v14 offset:20480
ds_read_b64_tr_b16 v[230:231], v14 offset:22528
Mvva 128,204,216
buffer_load_dwordx4 v114, s[12:15], s48 offen offset:0 lds
Mvva 144,192,196
s_waitcnt lgkmcnt(4)
ds_read_b64_tr_b16 v[232:233], v14 offset:24576
ds_read_b64_tr_b16 v[234:235], v14 offset:26624
Mvva 144,196,204
Zvvv 82,90,74
Mvva 144,200,212
ds_read_b64_tr_b16 v[236:237], v14 offset:28672
ds_read_b64_tr_b16 v[238:239], v14 offset:30720
Mvva 144,204,220
buffer_load_dwordx4 v114, s[12:15], s49 offen offset:1024 lds
Mvva 132,208,192
ds_read_b64_tr_b16 v[240:241], v15 offset:16384
ds_read_b64_tr_b16 v[242:243], v15 offset:18432
Mvva 132,212,200
Zvvv 86,94,74
Mvva 132,216,208
s_waitcnt lgkmcnt(2)
ds_read_b64_tr_b16 v[244:245], v15 offset:20480
ds_read_b64_tr_b16 v[246:247], v15 offset:22528
Mvva 132,220,216
buffer_load_dwordx4 v114, s[12:15], s50 offen offset:2048 lds
Mvva 148,208,196
s_waitcnt vmcnt(15)
ds_read_b64_tr_b16 v[248:249], v15 offset:24576
ds_read_b64_tr_b16 v[250:251], v15 offset:26624
Mvva 148,212,204
ds_read_b64_tr_b16 v[90:91], v106 offset:4096
ds_read_b64_tr_b16 v[92:93], v106 offset:6144
ds_read_b64_tr_b16 v[94:95], v107 offset:4096
Mvva 148,216,212
s_barrier
ds_read_b64_tr_b16 v[252:253], v15 offset:28672
ds_read_b64_tr_b16 v[254:255], v15 offset:30720
Mvva 148,220,220
buffer_load_dwordx4 v114, s[12:15], s51 offen offset:3072 lds
v_add_u32 v114, 262144, v114
Mvva 136,224,192
ds_read_b64_tr_b16 v[192:193], v12 offset:32768
ds_read_b64_tr_b16 v[194:195], v12 offset:34816
Mvva 136,228,200
ds_read_b64_tr_b16 v[96:97], v107 offset:6144
Mvva 136,232,208
ds_read_b64_tr_b16 v[196:197], v12 offset:36864
s_waitcnt lgkmcnt(9)
ds_read_b64_tr_b16 v[198:199], v12 offset:38912
Mvva 136,236,216
buffer_load_dwordx4 a[16:19], v112, s[8:11], s52 offen offset:0 sc1
Mvva 152,224,196
s_waitcnt lgkmcnt(5)
ds_read_b64_tr_b16 v[200:201], v12 offset:40960
ds_read_b64_tr_b16 v[202:203], v12 offset:43008
Mvva 152,228,204
Mvva 152,232,212
ds_read_b64_tr_b16 v[204:205], v12 offset:45056
ds_read_b64_tr_b16 v[206:207], v12 offset:47104
Mvva 152,236,220
buffer_load_dwordx4 a[20:23], v112, s[8:11], s52 offen offset:1024 sc1
s_add_u32 s52, s52, 8192
Mvva 140,240,192
ds_read_b64_tr_b16 v[208:209], v13 offset:32768
ds_read_b64_tr_b16 v[210:211], v13 offset:34816
Mvva 140,244,200
s_waitcnt lgkmcnt(8)
Mvvv 82,90,78
Mvva 140,248,208
ds_read_b64_tr_b16 v[212:213], v13 offset:36864
ds_read_b64_tr_b16 v[214:215], v13 offset:38912
Mvva 140,252,216
buffer_load_dwordx4 a[24:27], v112, s[8:11], s52 offen offset:0 sc1
Mvva 156,240,196
s_waitcnt lgkmcnt(4)
ds_read_b64_tr_b16 v[216:217], v13 offset:40960
ds_read_b64_tr_b16 v[218:219], v13 offset:43008
Mvva 156,244,204
Mvvv 86,94,78
Mvva 156,248,212
s_waitcnt vmcnt(15)
ds_read_b64_tr_b16 v[220:221], v13 offset:45056
ds_read_b64_tr_b16 v[222:223], v13 offset:47104
Mvva 156,252,220
buffer_load_dwordx4 a[28:31], v112, s[8:11], s52 offen offset:1024 sc1
s_add_u32 s52, s52, 8192
Mvva 160,192,224
s_add_u32 m0, s44, 16384
ds_read_b64_tr_b16 v[224:225], v14 offset:32768
ds_read_b64_tr_b16 v[226:227], v14 offset:34816
Mvva 160,196,232
buffer_load_dwordx4 v114, s[12:15], s48 offen offset:0 lds
Mvva 160,200,240
ds_read_b64_tr_b16 v[228:229], v14 offset:36864
ds_read_b64_tr_b16 v[230:231], v14 offset:38912
Mvva 160,204,248
Mvva 176,192,228
s_waitcnt lgkmcnt(4)
ds_read_b64_tr_b16 v[232:233], v14 offset:40960
ds_read_b64_tr_b16 v[234:235], v14 offset:43008
Mvva 176,196,236
buffer_load_dwordx4 v114, s[12:15], s49 offen offset:1024 lds
Mvva 176,200,244
ds_read_b64_tr_b16 v[236:237], v14 offset:45056
ds_read_b64_tr_b16 v[238:239], v14 offset:47104
Mvva 176,204,252
buffer_load_dwordx4 v114, s[12:15], s50 offen offset:2048 lds
Mvva 164,208,224
ds_read_b64_tr_b16 v[240:241], v15 offset:32768
ds_read_b64_tr_b16 v[242:243], v15 offset:34816
Mvva 164,212,232
buffer_load_dwordx4 v114, s[12:15], s51 offen offset:3072 lds
v_add_u32 v114, 262144, v114
Mvva 164,216,240
s_waitcnt lgkmcnt(2)
ds_read_b64_tr_b16 v[244:245], v15 offset:36864
ds_read_b64_tr_b16 v[246:247], v15 offset:38912
Mvva 164,220,248
ds_write_b128 v4, v[82:85] offset:2048
ds_write_b128 v4, v[86:89] offset:2112
Mvva 180,208,228
s_waitcnt vmcnt(16)
ds_read_b64_tr_b16 v[248:249], v15 offset:40960
ds_read_b64_tr_b16 v[250:251], v15 offset:43008
Mvva 180,212,236
buffer_load_dwordx4 a[32:35], v112, s[8:11], s52 offen offset:0 sc1
Mvva 180,216,244
s_barrier
ds_read_b64_tr_b16 v[252:253], v15 offset:45056
ds_read_b64_tr_b16 v[254:255], v15 offset:47104
Mvva 180,220,252
buffer_load_dwordx4 a[36:39], v112, s[8:11], s52 offen offset:1024 sc1
s_add_u32 s52, s52, 8192
Mvva 168,224,224
ds_read_b64_tr_b16 v[192:193], v12 offset:49152
ds_read_b64_tr_b16 v[194:195], v12 offset:51200
Mvva 168,228,232
buffer_load_dwordx4 a[40:43], v112, s[8:11], s52 offen offset:0 sc1
Mvva 168,232,240
ds_read_b64_tr_b16 v[196:197], v12 offset:53248
ds_read_b64_tr_b16 v[198:199], v12 offset:55296
Mvva 168,236,248
Mvva 184,224,228
s_waitcnt lgkmcnt(4)
ds_read_b64_tr_b16 v[200:201], v12 offset:57344
ds_read_b64_tr_b16 v[202:203], v12 offset:59392
Mvva 184,228,236
buffer_load_dwordx4 a[44:47], v112, s[8:11], s52 offen offset:1024 sc1
s_add_u32 s52, s52, 8192
Mvva 184,232,244
ds_read_b64_tr_b16 v[204:205], v12 offset:61440
ds_read_b64_tr_b16 v[206:207], v12 offset:63488
Mvva 184,236,252
buffer_load_dwordx4 a[48:51], v112, s[8:11], s52 offen offset:0 sc1
Mvva 172,240,224
ds_read_b64_tr_b16 v[208:209], v13 offset:49152
ds_read_b64_tr_b16 v[210:211], v13 offset:51200
Mvva 172,244,232
buffer_load_dwordx4 a[52:55], v112, s[8:11], s52 offen offset:1024 sc1
s_add_u32 s52, s52, 8192
Mvva 172,248,240
ds_read_b64_tr_b16 v[212:213], v13 offset:53248
ds_read_b64_tr_b16 v[214:215], v13 offset:55296
Mvva 172,252,248
Zvvv 82,98,74
Mvva 188,240,228
s_waitcnt lgkmcnt(4)
ds_read_b64_tr_b16 v[216:217], v13 offset:57344
ds_read_b64_tr_b16 v[218:219], v13 offset:59392
Mvva 188,244,236
buffer_load_dwordx4 a[56:59], v112, s[8:11], s52 offen offset:0 sc1
Mvva 188,248,244
ds_read_b64_tr_b16 v[220:221], v13 offset:61440
ds_read_b64_tr_b16 v[222:223], v13 offset:63488
Mvva 188,252,252
buffer_load_dwordx4 a[60:63], v112, s[8:11], s52 offen offset:1024 sc1
s_add_u32 s52, s52, 8192
Mvva 128,192,224
s_add_u32 m0, s44, 32768
ds_read_b64_tr_b16 v[224:225], v14 offset:49152
ds_read_b64_tr_b16 v[226:227], v14 offset:51200
Mvva 128,196,232
buffer_load_dwordx4 v114, s[12:15], s48 offen offset:0 lds
Mvva 128,200,240
ds_read_b64_tr_b16 v[228:229], v14 offset:53248
ds_read_b64_tr_b16 v[230:231], v14 offset:55296
Mvva 128,204,248
Zvvv 86,102,74
Mvva 144,192,228
s_waitcnt lgkmcnt(4)
ds_read_b64_tr_b16 v[232:233], v14 offset:57344
ds_read_b64_tr_b16 v[234:235], v14 offset:59392
Mvva 144,196,236
buffer_load_dwordx4 v114, s[12:15], s49 offen offset:1024 lds
Mvva 144,200,244
ds_read_b64_tr_b16 v[236:237], v14 offset:61440
ds_read_b64_tr_b16 v[238:239], v14 offset:63488
Mvva 144,204,252
buffer_load_dwordx4 v114, s[12:15], s50 offen offset:2048 lds
Mvva 132,208,224
ds_read_b64_tr_b16 v[240:241], v15 offset:49152
ds_read_b64_tr_b16 v[242:243], v15 offset:51200
Mvva 132,212,232
buffer_load_dwordx4 v114, s[12:15], s51 offen offset:3072 lds
v_add_u32 v114, 262144, v114
Mvva 132,216,240
s_waitcnt lgkmcnt(2)
ds_read_b64_tr_b16 v[244:245], v15 offset:53248
ds_read_b64_tr_b16 v[246:247], v15 offset:55296
Mvva 132,220,248
ds_read_b64_tr_b16 v[98:99], v108 offset:4096
ds_read_b64_tr_b16 v[100:101], v108 offset:6144
ds_read_b64_tr_b16 v[102:103], v109 offset:4096
Mvva 148,208,228
s_waitcnt vmcnt(20)
ds_read_b64_tr_b16 v[248:249], v15 offset:57344
ds_read_b64_tr_b16 v[250:251], v15 offset:59392
Mvva 148,212,236
buffer_load_dwordx4 a[64:67], v112, s[8:11], s52 offen offset:0 sc1
Mvva 148,216,244
s_barrier
ds_read_b64_tr_b16 v[252:253], v15 offset:61440
ds_read_b64_tr_b16 v[254:255], v15 offset:63488
Mvva 148,220,252
buffer_load_dwordx4 a[68:71], v112, s[8:11], s52 offen offset:1024 sc1
s_add_u32 s52, s52, 8192
Mvva 136,224,224
ds_read_b64_tr_b16 v[192:193], v115 offset:0
ds_read_b64_tr_b16 v[194:195], v115 offset:2048
Mvva 136,228,232
buffer_load_dwordx4 a[72:75], v112, s[8:11], s52 offen offset:0 sc1
Mvva 136,232,240
ds_read_b64_tr_b16 v[196:197], v115 offset:4096
ds_read_b64_tr_b16 v[198:199], v115 offset:6144
Mvva 136,236,248
s_waitcnt lgkmcnt(9)
ds_read_b64_tr_b16 v[104:105], v109 offset:6144
Mvva 152,224,228
s_waitcnt lgkmcnt(5)
ds_read_b64_tr_b16 v[200:201], v115 offset:8192
ds_read_b64_tr_b16 v[202:203], v115 offset:10240
Mvva 152,228,236
buffer_load_dwordx4 a[76:79], v112, s[8:11], s52 offen offset:1024 sc1
s_add_u32 s52, s52, 8192
Mvva 152,232,244
ds_read_b64_tr_b16 v[204:205], v115 offset:12288
ds_read_b64_tr_b16 v[206:207], v115 offset:14336
Mvva 152,236,252
buffer_load_dwordx4 a[80:83], v112, s[8:11], s52 offen offset:0 sc1
Mvva 140,240,224
ds_read_b64_tr_b16 v[208:209], v116 offset:0
ds_read_b64_tr_b16 v[210:211], v116 offset:2048
Mvva 140,244,232
buffer_load_dwordx4 a[84:87], v112, s[8:11], s52 offen offset:1024 sc1
s_add_u32 s52, s52, 8192
Mvva 140,248,240
ds_read_b64_tr_b16 v[212:213], v116 offset:4096
ds_read_b64_tr_b16 v[214:215], v116 offset:6144
Mvva 140,252,248
Mvva 156,240,228
s_waitcnt lgkmcnt(4)
ds_read_b64_tr_b16 v[216:217], v116 offset:8192
ds_read_b64_tr_b16 v[218:219], v116 offset:10240
Mvva 156,244,236
buffer_load_dwordx4 a[88:91], v112, s[8:11], s52 offen offset:0 sc1
Mvva 156,248,244
s_waitcnt vmcnt(23)
ds_read_b64_tr_b16 v[220:221], v116 offset:12288
ds_read_b64_tr_b16 v[222:223], v116 offset:14336
Mvva 156,252,252
buffer_load_dwordx4 a[92:95], v112, s[8:11], s52 offen offset:1024 sc1
s_add_u32 s52, s52, 8192
Mvva 160,192,0
s_add_u32 m0, s44, 49152
ds_read_b64_tr_b16 v[224:225], v117 offset:0
ds_read_b64_tr_b16 v[226:227], v117 offset:2048
Mvva 160,196,8
buffer_load_dwordx4 v114, s[12:15], s48 offen offset:0 lds
Mvva 160,200,16
ds_read_b64_tr_b16 v[228:229], v117 offset:4096
ds_read_b64_tr_b16 v[230:231], v117 offset:6144
Mvva 160,204,24
Mvvv 82,98,78
Mvva 176,192,4
s_waitcnt lgkmcnt(4)
ds_read_b64_tr_b16 v[232:233], v117 offset:8192
ds_read_b64_tr_b16 v[234:235], v117 offset:10240
Mvva 176,196,12
buffer_load_dwordx4 v114, s[12:15], s49 offen offset:1024 lds
Mvva 176,200,20
ds_read_b64_tr_b16 v[236:237], v117 offset:12288
ds_read_b64_tr_b16 v[238:239], v117 offset:14336
Mvva 176,204,28
buffer_load_dwordx4 v114, s[12:15], s50 offen offset:2048 lds
Mvva 164,208,0
ds_read_b64_tr_b16 v[240:241], v118 offset:0
ds_read_b64_tr_b16 v[242:243], v118 offset:2048
Mvva 164,212,8
buffer_load_dwordx4 v114, s[12:15], s51 offen offset:3072 lds
v_add_u32 v114, 262144, v114
Mvva 164,216,16
s_waitcnt lgkmcnt(2)
ds_read_b64_tr_b16 v[244:245], v118 offset:4096
ds_read_b64_tr_b16 v[246:247], v118 offset:6144
Mvva 164,220,24
Mvvv 86,102,78
Mvva 180,208,4
s_waitcnt vmcnt(24)
ds_read_b64_tr_b16 v[248:249], v118 offset:8192
ds_read_b64_tr_b16 v[250:251], v118 offset:10240
Mvva 180,212,12
buffer_load_dwordx4 a[96:99], v112, s[8:11], s52 offen offset:0 sc1
Mvva 180,216,20
s_barrier
ds_read_b64_tr_b16 v[252:253], v118 offset:12288
ds_read_b64_tr_b16 v[254:255], v118 offset:14336
Mvva 180,220,28
buffer_load_dwordx4 a[100:103], v112, s[8:11], s52 offen offset:1024 sc1
s_add_u32 s52, s52, 8192
Mvva 168,224,0
ds_read_b64_tr_b16 v[192:193], v115 offset:16384
ds_read_b64_tr_b16 v[194:195], v115 offset:18432
Mvva 168,228,8
buffer_load_dwordx4 a[104:107], v112, s[8:11], s52 offen offset:0 sc1
Mvva 168,232,16
ds_read_b64_tr_b16 v[196:197], v115 offset:20480
ds_read_b64_tr_b16 v[198:199], v115 offset:22528
Mvva 168,236,24
Mvva 184,224,4
s_waitcnt lgkmcnt(4)
ds_read_b64_tr_b16 v[200:201], v115 offset:24576
ds_read_b64_tr_b16 v[202:203], v115 offset:26624
Mvva 184,228,12
buffer_load_dwordx4 a[108:111], v112, s[8:11], s52 offen offset:1024 sc1
s_add_u32 s52, s52, 8192
Mvva 184,232,20
ds_read_b64_tr_b16 v[204:205], v115 offset:28672
ds_read_b64_tr_b16 v[206:207], v115 offset:30720
Mvva 184,236,28
buffer_load_dwordx4 a[112:115], v112, s[8:11], s52 offen offset:0 sc1
Mvva 172,240,0
ds_read_b64_tr_b16 v[208:209], v116 offset:16384
ds_read_b64_tr_b16 v[210:211], v116 offset:18432
Mvva 172,244,8
buffer_load_dwordx4 a[116:119], v112, s[8:11], s52 offen offset:1024 sc1
s_add_u32 s52, s52, 8192
Mvva 172,248,16
ds_read_b64_tr_b16 v[212:213], v116 offset:20480
ds_read_b64_tr_b16 v[214:215], v116 offset:22528
Mvva 172,252,24
ds_write_b128 v4, v[82:85] offset:2176
ds_write_b128 v4, v[86:89] offset:2240
Mvva 188,240,4
s_waitcnt lgkmcnt(6)
ds_read_b64_tr_b16 v[216:217], v116 offset:24576
ds_read_b64_tr_b16 v[218:219], v116 offset:26624
Mvva 188,244,12
buffer_load_dwordx4 a[120:123], v112, s[8:11], s52 offen offset:0 sc1
Mvva 188,248,20
s_waitcnt vmcnt(23)
ds_read_b64_tr_b16 v[220:221], v116 offset:28672
ds_read_b64_tr_b16 v[222:223], v116 offset:30720
Mvva 188,252,28
buffer_load_dwordx4 a[124:127], v112, s[8:11], s52 offen offset:1024 sc1
s_add_u32 s52, s52, 8192
Mvva 160,192,32
s_add_u32 m0, s44, 65536
ds_read_b64_tr_b16 v[224:225], v117 offset:16384
ds_read_b64_tr_b16 v[226:227], v117 offset:18432
Mvva 160,196,40
buffer_load_dwordx4 v114, s[12:15], s48 offen offset:0 lds
Mvva 160,200,48
ds_read_b64_tr_b16 v[228:229], v117 offset:20480
ds_read_b64_tr_b16 v[230:231], v117 offset:22528
Mvva 160,204,56
Mvva 176,192,36
s_waitcnt lgkmcnt(4)
ds_read_b64_tr_b16 v[232:233], v117 offset:24576
ds_read_b64_tr_b16 v[234:235], v117 offset:26624
Mvva 176,196,44
buffer_load_dwordx4 v114, s[12:15], s49 offen offset:1024 lds
Mvva 176,200,52
ds_read_b64_tr_b16 v[236:237], v117 offset:28672
ds_read_b64_tr_b16 v[238:239], v117 offset:30720
Mvva 176,204,60
buffer_load_dwordx4 v114, s[12:15], s50 offen offset:2048 lds
Mvva 164,208,32
ds_read_b64_tr_b16 v[240:241], v118 offset:16384
ds_read_b64_tr_b16 v[242:243], v118 offset:18432
Mvva 164,212,40
buffer_load_dwordx4 v114, s[12:15], s51 offen offset:3072 lds
v_add_u32 v114, 262144, v114
Mvva 164,216,48
s_waitcnt lgkmcnt(2)
ds_read_b64_tr_b16 v[244:245], v118 offset:20480
ds_read_b64_tr_b16 v[246:247], v118 offset:22528
Mvva 164,220,56
Mvva 180,208,36
s_waitcnt vmcnt(24)
ds_read_b64_tr_b16 v[248:249], v118 offset:24576
ds_read_b64_tr_b16 v[250:251], v118 offset:26624
Mvva 180,212,44
buffer_load_dwordx4 a[128:131], v112, s[8:11], s52 offen offset:0 sc1
Mvva 180,216,52
s_barrier
ds_read_b64_tr_b16 v[252:253], v118 offset:28672
ds_read_b64_tr_b16 v[254:255], v118 offset:30720
Mvva 180,220,60
buffer_load_dwordx4 a[132:135], v112, s[8:11], s52 offen offset:1024 sc1
s_add_u32 s52, s52, 8192
Mvva 168,224,32
ds_read_b64_tr_b16 v[192:193], v115 offset:32768
ds_read_b64_tr_b16 v[194:195], v115 offset:34816
Mvva 168,228,40
buffer_load_dwordx4 a[136:139], v112, s[8:11], s52 offen offset:0 sc1
Mvva 168,232,48
ds_read_b64_tr_b16 v[196:197], v115 offset:36864
ds_read_b64_tr_b16 v[198:199], v115 offset:38912
Mvva 168,236,56
ds_read_b64 v[74:75], v6 offset:0
ds_read_b64 v[76:77], v6 offset:8192
ds_read_b64 v[78:79], v6 offset:16384
Mvva 184,224,36
s_waitcnt lgkmcnt(7)
ds_read_b64_tr_b16 v[200:201], v115 offset:40960
ds_read_b64_tr_b16 v[202:203], v115 offset:43008
Mvva 184,228,44
buffer_load_dwordx4 a[140:143], v112, s[8:11], s52 offen offset:1024 sc1
s_add_u32 s52, s52, 8192
Mvva 184,232,52
ds_read_b64_tr_b16 v[204:205], v115 offset:45056
ds_read_b64_tr_b16 v[206:207], v115 offset:47104
Mvva 184,236,60
buffer_load_dwordx4 a[144:147], v112, s[8:11], s52 offen offset:0 sc1
Mvva 172,240,32
ds_read_b64_tr_b16 v[208:209], v116 offset:32768
ds_read_b64_tr_b16 v[210:211], v116 offset:34816
Mvva 172,244,40
buffer_load_dwordx4 a[148:151], v112, s[8:11], s52 offen offset:1024 sc1
s_add_u32 s52, s52, 8192
Mvva 172,248,48
ds_read_b64_tr_b16 v[212:213], v116 offset:36864
ds_read_b64_tr_b16 v[214:215], v116 offset:38912
Mvva 172,252,56
s_waitcnt lgkmcnt(9)
ds_read_b64 v[80:81], v6 offset:24576
Mvva 188,240,36
s_waitcnt lgkmcnt(5)
ds_read_b64_tr_b16 v[216:217], v116 offset:40960
ds_read_b64_tr_b16 v[218:219], v116 offset:43008
Mvva 188,244,44
buffer_load_dwordx4 a[152:155], v112, s[8:11], s52 offen offset:0 sc1
Mvva 188,248,52
s_waitcnt vmcnt(23)
ds_read_b64_tr_b16 v[220:221], v116 offset:45056
ds_read_b64_tr_b16 v[222:223], v116 offset:47104
Mvva 188,252,60
buffer_load_dwordx4 a[156:159], v112, s[8:11], s52 offen offset:1024 sc1
s_add_u32 s52, s52, 8192
Mvva 160,192,64
s_add_u32 m0, s44, 81920
ds_read_b64_tr_b16 v[224:225], v117 offset:32768
ds_read_b64_tr_b16 v[226:227], v117 offset:34816
Mvva 160,196,72
buffer_load_dwordx4 v114, s[12:15], s48 offen offset:0 lds
Mvva 160,200,80
ds_read_b64_tr_b16 v[228:229], v117 offset:36864
ds_read_b64_tr_b16 v[230:231], v117 offset:38912
Mvva 160,204,88
Mvva 176,192,68
s_waitcnt lgkmcnt(4)
ds_read_b64_tr_b16 v[232:233], v117 offset:40960
ds_read_b64_tr_b16 v[234:235], v117 offset:43008
Mvva 176,196,76
buffer_load_dwordx4 v114, s[12:15], s49 offen offset:1024 lds
Mvva 176,200,84
ds_read_b64_tr_b16 v[236:237], v117 offset:45056
ds_read_b64_tr_b16 v[238:239], v117 offset:47104
Mvva 176,204,92
buffer_load_dwordx4 v114, s[12:15], s50 offen offset:2048 lds
Mvva 164,208,64
ds_read_b64_tr_b16 v[240:241], v118 offset:32768
ds_read_b64_tr_b16 v[242:243], v118 offset:34816
Mvva 164,212,72
buffer_load_dwordx4 v114, s[12:15], s51 offen offset:3072 lds
v_add_u32 v114, 262144, v114
Mvva 164,216,80
s_waitcnt lgkmcnt(2)
ds_read_b64_tr_b16 v[244:245], v118 offset:36864
ds_read_b64_tr_b16 v[246:247], v118 offset:38912
Mvva 164,220,88
Va 74,74,76
Va 78,78,80
Va 75,75,77
Mvva 180,208,68
s_waitcnt vmcnt(24)
ds_read_b64_tr_b16 v[248:249], v118 offset:40960
ds_read_b64_tr_b16 v[250:251], v118 offset:43008
Va 79,79,81
Mvva 180,212,76
buffer_load_dwordx4 a[160:163], v112, s[8:11], s52 offen offset:0 sc1
Mvva 180,216,84
s_barrier
ds_read_b64_tr_b16 v[252:253], v118 offset:45056
ds_read_b64_tr_b16 v[254:255], v118 offset:47104
Va 74,74,78
Mvva 180,220,92
buffer_load_dwordx4 a[164:167], v112, s[8:11], s52 offen offset:1024 sc1
s_add_u32 s52, s52, 8192
Mvva 168,224,64
ds_read_b64_tr_b16 v[192:193], v115 offset:49152
ds_read_b64_tr_b16 v[194:195], v115 offset:51200
v_add_f32_e64 v75, v75, v79
Mvva 168,228,72
buffer_load_dwordx4 a[168:171], v112, s[8:11], s52 offen offset:0 sc1
Mvva 168,232,80
ds_read_b64_tr_b16 v[196:197], v115 offset:53248
ds_read_b64_tr_b16 v[198:199], v115 offset:55296
Mvva 168,236,88
buffer_store_dwordx2 v[74:75], v5, s[20:23], s4 offen sc1
Mvva 184,224,68
s_waitcnt lgkmcnt(4)
ds_read_b64_tr_b16 v[200:201], v115 offset:57344
ds_read_b64_tr_b16 v[202:203], v115 offset:59392
Mvva 184,228,76
buffer_load_dwordx4 a[172:175], v112, s[8:11], s52 offen offset:1024 sc1
s_add_u32 s52, s52, 8192
Mvva 184,232,84
ds_read_b64_tr_b16 v[204:205], v115 offset:61440
ds_read_b64_tr_b16 v[206:207], v115 offset:63488
Mvva 184,236,92
buffer_load_dwordx4 a[176:179], v112, s[8:11], s52 offen offset:0 sc1
Mvva 172,240,64
ds_read_b64_tr_b16 v[208:209], v116 offset:49152
ds_read_b64_tr_b16 v[210:211], v116 offset:51200
Mvva 172,244,72
buffer_load_dwordx4 a[180:183], v112, s[8:11], s52 offen offset:1024 sc1
s_add_u32 s52, s52, 8192
Mvva 172,248,80
ds_read_b64_tr_b16 v[212:213], v116 offset:53248
ds_read_b64_tr_b16 v[214:215], v116 offset:55296
Mvva 172,252,88
Mvva 188,240,68
s_waitcnt lgkmcnt(4)
ds_read_b64_tr_b16 v[216:217], v116 offset:57344
ds_read_b64_tr_b16 v[218:219], v116 offset:59392
Mvva 188,244,76
buffer_load_dwordx4 a[184:187], v112, s[8:11], s52 offen offset:0 sc1
Mvva 188,248,84
s_waitcnt vmcnt(24)
ds_read_b64_tr_b16 v[220:221], v116 offset:61440
ds_read_b64_tr_b16 v[222:223], v116 offset:63488
Mvva 188,252,92
buffer_load_dwordx4 a[188:191], v112, s[8:11], s52 offen offset:1024 sc1
s_add_u32 s52, s52, 8192
Mvva 160,192,96
s_add_u32 m0, s44, 98304
ds_read_b64_tr_b16 v[224:225], v117 offset:49152
ds_read_b64_tr_b16 v[226:227], v117 offset:51200
Mvva 160,196,104
buffer_load_dwordx4 v114, s[12:15], s48 offen offset:0 lds
Mvva 160,200,112
ds_read_b64_tr_b16 v[228:229], v117 offset:53248
ds_read_b64_tr_b16 v[230:231], v117 offset:55296
Mvva 160,204,120
Mvva 176,192,100
s_waitcnt lgkmcnt(4)
ds_read_b64_tr_b16 v[232:233], v117 offset:57344
ds_read_b64_tr_b16 v[234:235], v117 offset:59392
Mvva 176,196,108
buffer_load_dwordx4 v114, s[12:15], s49 offen offset:1024 lds
Mvva 176,200,116
ds_read_b64_tr_b16 v[236:237], v117 offset:61440
ds_read_b64_tr_b16 v[238:239], v117 offset:63488
Mvva 176,204,124
buffer_load_dwordx4 v114, s[12:15], s50 offen offset:2048 lds
Mvva 164,208,96
ds_read_b64_tr_b16 v[240:241], v118 offset:49152
ds_read_b64_tr_b16 v[242:243], v118 offset:51200
Mvva 164,212,104
buffer_load_dwordx4 v114, s[12:15], s51 offen offset:3072 lds
v_add_u32 v114, 262144, v114
Mvva 164,216,112
s_waitcnt lgkmcnt(2)
ds_read_b64_tr_b16 v[244:245], v118 offset:53248
ds_read_b64_tr_b16 v[246:247], v118 offset:55296
Mvva 164,220,120
Mvva 180,208,100
s_waitcnt vmcnt(25)
ds_read_b64_tr_b16 v[248:249], v118 offset:57344
ds_read_b64_tr_b16 v[250:251], v118 offset:59392
Mvva 180,212,108
buffer_load_dwordx4 a[192:195], v112, s[8:11], s52 offen offset:0 sc1
Mvva 180,216,116
s_barrier
ds_read_b64_tr_b16 v[252:253], v118 offset:61440
ds_read_b64_tr_b16 v[254:255], v118 offset:63488
Mvva 180,220,124
buffer_load_dwordx4 a[196:199], v112, s[8:11], s52 offen offset:1024 sc1
s_add_u32 s52, s52, 8192
Mvva 168,224,96
ds_read_b64_tr_b16 v[192:193], v12 offset:0
ds_read_b64_tr_b16 v[194:195], v12 offset:2048
Mvva 168,228,104
buffer_load_dwordx4 a[200:203], v112, s[8:11], s52 offen offset:0 sc1
Mvva 168,232,112
ds_read_b64_tr_b16 v[196:197], v12 offset:4096
ds_read_b64_tr_b16 v[198:199], v12 offset:6144
Mvva 168,236,120
Mvva 184,224,100
s_waitcnt lgkmcnt(4)
ds_read_b64_tr_b16 v[200:201], v12 offset:8192
ds_read_b64_tr_b16 v[202:203], v12 offset:10240
Mvva 184,228,108
buffer_load_dwordx4 a[204:207], v112, s[8:11], s52 offen offset:1024 sc1
s_add_u32 s52, s52, 8192
Mvva 184,232,116
ds_read_b64_tr_b16 v[204:205], v12 offset:12288
ds_read_b64_tr_b16 v[206:207], v12 offset:14336
Mvva 184,236,124
buffer_load_dwordx4 a[208:211], v112, s[8:11], s52 offen offset:0 sc1
Mvva 172,240,96
ds_read_b64_tr_b16 v[208:209], v13 offset:0
ds_read_b64_tr_b16 v[210:211], v13 offset:2048
Mvva 172,244,104
buffer_load_dwordx4 a[212:215], v112, s[8:11], s52 offen offset:1024 sc1
s_add_u32 s52, s52, 8192
Mvva 172,248,112
ds_read_b64_tr_b16 v[212:213], v13 offset:4096
ds_read_b64_tr_b16 v[214:215], v13 offset:6144
Mvva 172,252,120
Mvva 188,240,100
s_waitcnt lgkmcnt(4)
ds_read_b64_tr_b16 v[216:217], v13 offset:8192
ds_read_b64_tr_b16 v[218:219], v13 offset:10240
Mvva 188,244,108
buffer_load_dwordx4 a[216:219], v112, s[8:11], s52 offen offset:0 sc1
Mvva 188,248,116
s_waitcnt vmcnt(24)
ds_read_b64_tr_b16 v[220:221], v13 offset:12288
ds_read_b64_tr_b16 v[222:223], v13 offset:14336
Mvva 188,252,124
buffer_load_dwordx4 a[220:223], v112, s[8:11], s52 offen offset:1024 sc1
s_add_u32 s52, s52, 8192
Mvva 160,192,128
s_add_u32 m0, s44, 114688
ds_read_b64_tr_b16 v[224:225], v14 offset:0
ds_read_b64_tr_b16 v[226:227], v14 offset:2048
Mvva 160,196,136
buffer_load_dwordx4 v114, s[12:15], s48 offen offset:0 lds
Mvva 160,200,144
ds_read_b64_tr_b16 v[228:229], v14 offset:4096
ds_read_b64_tr_b16 v[230:231], v14 offset:6144
Mvva 160,204,152
Mvva 176,192,132
s_waitcnt lgkmcnt(4)
ds_read_b64_tr_b16 v[232:233], v14 offset:8192
ds_read_b64_tr_b16 v[234:235], v14 offset:10240
Mvva 176,196,140
buffer_load_dwordx4 v114, s[12:15], s49 offen offset:1024 lds
Mvva 176,200,148
ds_read_b64_tr_b16 v[236:237], v14 offset:12288
ds_read_b64_tr_b16 v[238:239], v14 offset:14336
Mvva 176,204,156
buffer_load_dwordx4 v114, s[12:15], s50 offen offset:2048 lds
Mvva 164,208,128
ds_read_b64_tr_b16 v[240:241], v15 offset:0
ds_read_b64_tr_b16 v[242:243], v15 offset:2048
Mvva 164,212,136
buffer_load_dwordx4 v114, s[12:15], s51 offen offset:3072 lds
s_xor_b32 s95, s95, 128
v_add_u32 v114, s95, v113
Mvva 164,216,144
s_waitcnt lgkmcnt(2)
ds_read_b64_tr_b16 v[244:245], v15 offset:4096
ds_read_b64_tr_b16 v[246:247], v15 offset:6144
Mvva 164,220,152
Mvva 180,208,132
s_waitcnt vmcnt(25)
ds_read_b64_tr_b16 v[248:249], v15 offset:8192
ds_read_b64_tr_b16 v[250:251], v15 offset:10240
Mvva 180,212,140
buffer_load_dwordx4 a[224:227], v112, s[8:11], s52 offen offset:0 sc1
Mvva 180,216,148
s_barrier
ds_read_b64_tr_b16 v[252:253], v15 offset:12288
ds_read_b64_tr_b16 v[254:255], v15 offset:14336
Mvva 180,220,156
buffer_load_dwordx4 a[228:231], v112, s[8:11], s52 offen offset:1024 sc1
s_add_u32 s52, s52, 8192
Mvva 168,224,128
ds_read_b64_tr_b16 v[192:193], v12 offset:16384
ds_read_b64_tr_b16 v[194:195], v12 offset:18432
Mvva 168,228,136
buffer_load_dwordx4 a[232:235], v112, s[8:11], s52 offen offset:0 sc1
Mvva 168,232,144
ds_read_b64_tr_b16 v[196:197], v12 offset:20480
ds_read_b64_tr_b16 v[198:199], v12 offset:22528
Mvva 168,236,152
s_waitcnt vmcnt(24)
s_mov_b64 exec, 1
buffer_store_dword v7, v126, s[20:23], s6 offen sc1
s_mov_b64 exec, -1
Mvva 184,224,132
s_waitcnt lgkmcnt(4)
ds_read_b64_tr_b16 v[200:201], v12 offset:24576
ds_read_b64_tr_b16 v[202:203], v12 offset:26624
Mvva 184,228,140
buffer_load_dwordx4 a[236:239], v112, s[8:11], s52 offen offset:1024 sc1
s_add_u32 s52, s52, 8192
Mvva 184,232,148
ds_read_b64_tr_b16 v[204:205], v12 offset:28672
ds_read_b64_tr_b16 v[206:207], v12 offset:30720
Mvva 184,236,156
buffer_load_dwordx4 a[240:243], v112, s[8:11], s52 offen offset:0 sc1
Mvva 172,240,128
ds_read_b64_tr_b16 v[208:209], v13 offset:16384
ds_read_b64_tr_b16 v[210:211], v13 offset:18432
Mvva 172,244,136
buffer_load_dwordx4 a[244:247], v112, s[8:11], s52 offen offset:1024 sc1
s_add_u32 s52, s52, 8192
Mvva 172,248,144
ds_read_b64_tr_b16 v[212:213], v13 offset:20480
ds_read_b64_tr_b16 v[214:215], v13 offset:22528
Mvva 172,252,152
v_lshlrev_b32 v66, 16, v30
v_and_b32 v67, 0xffff0000, v30
v_lshlrev_b32_e64 v68, 16, v31
Mvva 188,240,132
s_waitcnt lgkmcnt(4)
ds_read_b64_tr_b16 v[216:217], v13 offset:24576
ds_read_b64_tr_b16 v[218:219], v13 offset:26624
v_and_b32 v69, 0xffff0000, v31
Mvva 188,244,140
buffer_load_dwordx4 a[248:251], v112, s[8:11], s52 offen offset:0 sc1
Mvva 188,248,148
s_waitcnt vmcnt(24)
ds_read_b64_tr_b16 v[220:221], v13 offset:28672
ds_read_b64_tr_b16 v[222:223], v13 offset:30720
v_lshlrev_b32_e64 v70, 16, v32
Mvva 188,252,156
buffer_load_dwordx4 a[252:255], v112, s[8:11], s52 offen offset:1024 sc1
s_add_u32 s52, s52, 8192
Mvva 160,192,160
s_add_u32 m0, s44, 0
ds_read_b64_tr_b16 v[224:225], v14 offset:16384
ds_read_b64_tr_b16 v[226:227], v14 offset:18432
Mvva 160,196,168
buffer_load_dwordx4 v114, s[12:15], s48 offen offset:0 lds
Mvva 160,200,176
ds_read_b64_tr_b16 v[228:229], v14 offset:20480
ds_read_b64_tr_b16 v[230:231], v14 offset:22528
Mvva 160,204,184
v_and_b32 v71, 0xffff0000, v32
v_lshlrev_b32 v72, 16, v33
Mvva 176,192,164
s_waitcnt lgkmcnt(4)
ds_read_b64_tr_b16 v[232:233], v14 offset:24576
ds_read_b64_tr_b16 v[234:235], v14 offset:26624
Mvva 176,196,172
buffer_load_dwordx4 v114, s[12:15], s49 offen offset:1024 lds
Mvva 176,200,180
ds_read_b64_tr_b16 v[236:237], v14 offset:28672
ds_read_b64_tr_b16 v[238:239], v14 offset:30720
Mvva 176,204,188
buffer_load_dwordx4 v114, s[12:15], s50 offen offset:2048 lds
Mvva 164,208,160
ds_read_b64_tr_b16 v[240:241], v15 offset:16384
ds_read_b64_tr_b16 v[242:243], v15 offset:18432
Mvva 164,212,168
buffer_load_dwordx4 v114, s[12:15], s51 offen offset:3072 lds
v_add_u32 v114, 262144, v114
Mvva 164,216,176
s_waitcnt lgkmcnt(2)
ds_read_b64_tr_b16 v[244:245], v15 offset:20480
ds_read_b64_tr_b16 v[246:247], v15 offset:22528
Mvva 164,220,184
v_and_b32 v73, 0xffff0000, v33
v_sub_f32_e64 v66, v66, v40
Mvva 180,208,164
s_waitcnt vmcnt(25)
s_add_u32 m0, s44, 16384
ds_read_b64_tr_b16 v[248:249], v15 offset:24576
ds_read_b64_tr_b16 v[250:251], v15 offset:26624
Mvva 180,212,172
buffer_load_dwordx4 v114, s[12:15], s48 offen offset:0 lds
Mvva 180,216,180
s_barrier
ds_read_b64_tr_b16 v[252:253], v15 offset:28672
ds_read_b64_tr_b16 v[254:255], v15 offset:30720
Mvva 180,220,188
buffer_load_dwordx4 v114, s[12:15], s49 offen offset:1024 lds
Mvva 168,224,160
ds_read_b64_tr_b16 v[192:193], v12 offset:32768
ds_read_b64_tr_b16 v[194:195], v12 offset:34816
Mvva 168,228,168
buffer_load_dwordx4 v114, s[12:15], s50 offen offset:2048 lds
Mvva 168,232,176
ds_read_b64_tr_b16 v[196:197], v12 offset:36864
ds_read_b64_tr_b16 v[198:199], v12 offset:38912
Mvva 168,236,184
Vs 67,67,40
Vs 68,68,40
Mvva 184,224,164
s_waitcnt lgkmcnt(4)
ds_read_b64_tr_b16 v[200:201], v12 offset:40960
ds_read_b64_tr_b16 v[202:203], v12 offset:43008
Mvva 184,228,172
buffer_load_dwordx4 v114, s[12:15], s51 offen offset:3072 lds
v_add_u32 v114, 262144, v114
Mvva 184,232,180
s_add_u32 m0, s44, 32768
ds_read_b64_tr_b16 v[204:205], v12 offset:45056
ds_read_b64_tr_b16 v[206:207], v12 offset:47104
Mvva 184,236,188
buffer_load_dwordx4 v114, s[12:15], s48 offen offset:0 lds
Mvva 172,240,160
ds_read_b64_tr_b16 v[208:209], v13 offset:32768
ds_read_b64_tr_b16 v[210:211], v13 offset:34816
Mvva 172,244,168
buffer_load_dwordx4 v114, s[12:15], s49 offen offset:1024 lds
Mvva 172,248,176
ds_read_b64_tr_b16 v[212:213], v13 offset:36864
ds_read_b64_tr_b16 v[214:215], v13 offset:38912
Mvva 172,252,184
Vs 69,69,40
v_sub_f32_e64 v70, v70, v40
Mvva 188,240,164
s_waitcnt lgkmcnt(4)
ds_read_b64_tr_b16 v[216:217], v13 offset:40960
ds_read_b64_tr_b16 v[218:219], v13 offset:43008
Mvva 188,244,172
buffer_load_dwordx4 v114, s[12:15], s50 offen offset:2048 lds
Mvva 188,248,180
s_waitcnt vmcnt(24)
ds_read_b64_tr_b16 v[220:221], v13 offset:45056
ds_read_b64_tr_b16 v[222:223], v13 offset:47104
Mvva 188,252,188
buffer_load_dwordx4 v114, s[12:15], s51 offen offset:3072 lds
v_add_u32 v114, 262144, v114
Mvva 160,192,192
ds_read_b64_tr_b16 v[224:225], v14 offset:32768
ds_read_b64_tr_b16 v[226:227], v14 offset:34816
Mvva 160,196,200
Vs 71,71,40
Vs 72,72,40
Mvva 160,200,208
s_add_u32 m0, s44, 49152
ds_read_b64_tr_b16 v[228:229], v14 offset:36864
ds_read_b64_tr_b16 v[230:231], v14 offset:38912
Mvva 160,204,216
buffer_load_dwordx4 v114, s[12:15], s48 offen offset:0 lds
Mvva 176,192,196
s_waitcnt lgkmcnt(4)
ds_read_b64_tr_b16 v[232:233], v14 offset:40960
ds_read_b64_tr_b16 v[234:235], v14 offset:43008
Mvva 176,196,204
Vs 73,73,40
Vc 2,66,67
Mvva 176,200,212
ds_read_b64_tr_b16 v[236:237], v14 offset:45056
ds_read_b64_tr_b16 v[238:239], v14 offset:47104
Mvva 176,204,220
buffer_load_dwordx4 v114, s[12:15], s49 offen offset:1024 lds
Mvva 164,208,192
ds_read_b64_tr_b16 v[240:241], v15 offset:32768
ds_read_b64_tr_b16 v[242:243], v15 offset:34816
Mvva 164,212,200
v_lshlrev_b32_e64 v66, 16, v2
v_and_b32 v67, 0xffff0000, v2
Mvva 164,216,208
s_waitcnt lgkmcnt(2)
ds_read_b64_tr_b16 v[244:245], v15 offset:36864
ds_read_b64_tr_b16 v[246:247], v15 offset:38912
Mvva 164,220,216
buffer_load_dwordx4 v114, s[12:15], s50 offen offset:2048 lds
Mvva 180,208,196
s_waitcnt vmcnt(24)
ds_read_b64_tr_b16 v[248:249], v15 offset:40960
ds_read_b64_tr_b16 v[250:251], v15 offset:43008
Mvva 180,212,204
Vc 3,68,69
v_lshlrev_b32_e64 v68, 16, v3
Mvva 180,216,212
s_barrier
ds_read_b64_tr_b16 v[252:253], v15 offset:45056
ds_read_b64_tr_b16 v[254:255], v15 offset:47104
Mvva 180,220,220
buffer_load_dwordx4 v114, s[12:15], s51 offen offset:3072 lds
v_add_u32 v114, 262144, v114
Mvva 168,224,192
ds_read_b64_tr_b16 v[192:193], v12 offset:49152
ds_read_b64_tr_b16 v[194:195], v12 offset:51200
Mvva 168,228,200
v_and_b32 v69, 0xffff0000, v3
Vc 4,70,71
Mvva 168,232,208
s_add_u32 m0, s44, 65536
ds_read_b64_tr_b16 v[196:197], v12 offset:53248
ds_read_b64_tr_b16 v[198:199], v12 offset:55296
Mvva 168,236,216
buffer_load_dwordx4 v114, s[12:15], s48 offen offset:0 lds
Mvva 184,224,196
s_waitcnt lgkmcnt(4)
ds_read_b64_tr_b16 v[200:201], v12 offset:57344
ds_read_b64_tr_b16 v[202:203], v12 offset:59392
Mvva 184,228,204
v_lshlrev_b32_e64 v70, 16, v4
v_and_b32 v71, 0xffff0000, v4
Mvva 184,232,212
ds_read_b64_tr_b16 v[204:205], v12 offset:61440
ds_read_b64_tr_b16 v[206:207], v12 offset:63488
Mvva 184,236,220
buffer_load_dwordx4 v114, s[12:15], s49 offen offset:1024 lds
Mvva 172,240,192
ds_read_b64_tr_b16 v[208:209], v13 offset:49152
ds_read_b64_tr_b16 v[210:211], v13 offset:51200
Mvva 172,244,200
Vc 5,72,73
v_lshlrev_b32_e64 v72, 16, v5
Mvva 172,248,208
ds_read_b64_tr_b16 v[212:213], v13 offset:53248
ds_read_b64_tr_b16 v[214:215], v13 offset:55296
Mvva 172,252,216
buffer_load_dwordx4 v114, s[12:15], s50 offen offset:2048 lds
Mvva 188,240,196
s_waitcnt lgkmcnt(4)
ds_read_b64_tr_b16 v[216:217], v13 offset:57344
ds_read_b64_tr_b16 v[218:219], v13 offset:59392
Mvva 188,244,204
v_and_b32 v73, 0xffff0000, v5
Vm 66,66,41
Mvva 188,248,212
s_waitcnt vmcnt(19)
ds_read_b64_tr_b16 v[220:221], v13 offset:61440
ds_read_b64_tr_b16 v[222:223], v13 offset:63488
Mvva 188,252,220
buffer_load_dwordx4 v114, s[12:15], s51 offen offset:3072 lds
v_add_u32 v114, 262144, v114
Mvva 160,192,224
ds_read_b64_tr_b16 v[224:225], v14 offset:49152
ds_read_b64_tr_b16 v[226:227], v14 offset:51200
Mvva 160,196,232
Vm 67,67,41
v_mul_f32_e64 v68, v68, v41
Mvva 160,200,240
ds_read_b64_tr_b16 v[228:229], v14 offset:53248
ds_read_b64_tr_b16 v[230:231], v14 offset:55296
Mvva 160,204,248
Vm 69,69,41
Vm 70,70,41
Mvva 176,192,228
s_waitcnt lgkmcnt(4)
s_add_u32 m0, s44, 81920
ds_read_b64_tr_b16 v[232:233], v14 offset:57344
ds_read_b64_tr_b16 v[234:235], v14 offset:59392
Mvva 176,196,236
buffer_load_dwordx4 v114, s[12:15], s48 offen offset:0 lds
Mvva 176,200,244
ds_read_b64_tr_b16 v[236:237], v14 offset:61440
ds_read_b64_tr_b16 v[238:239], v14 offset:63488
Mvva 176,204,252
Vm 71,71,41
v_mul_f32_e64 v72, v72, v41
Mvva 164,208,224
ds_read_b64_tr_b16 v[240:241], v15 offset:49152
ds_read_b64_tr_b16 v[242:243], v15 offset:51200
Mvva 164,212,232
v_mul_f32_e64 v73, v73, v41
Vc 2,66,67
Mvva 164,216,240
s_waitcnt lgkmcnt(2)
ds_read_b64_tr_b16 v[244:245], v15 offset:53248
ds_read_b64_tr_b16 v[246:247], v15 offset:55296
Mvva 164,220,248
v_lshlrev_b32 v66, 16, v2
v_and_b32 v67, 0xffff0000, v2
Mvva 180,208,228
s_waitcnt vmcnt(17)
ds_read_b64_tr_b16 v[248:249], v15 offset:57344
ds_read_b64_tr_b16 v[250:251], v15 offset:59392
Mvva 180,212,236
buffer_load_dwordx4 v114, s[12:15], s49 offen offset:1024 lds
Mvva 180,216,244
s_barrier
ds_read_b64_tr_b16 v[252:253], v15 offset:61440
ds_read_b64_tr_b16 v[254:255], v15 offset:63488
Mvva 180,220,252
Vc 3,68,69
v_lshlrev_b32_e64 v68, 16, v3
Mvva 168,224,224
ds_read_b64_tr_b16 v[192:193], v115 offset:0
ds_read_b64_tr_b16 v[194:195], v115 offset:2048
Mvva 168,228,232
v_and_b32 v69, 0xffff0000, v3
Vc 4,70,71
Mvva 168,232,240
ds_read_b64_tr_b16 v[196:197], v115 offset:4096
ds_read_b64_tr_b16 v[198:199], v115 offset:6144
Mvva 168,236,248
v_lshlrev_b32_e64 v70, 16, v4
v_and_b32 v71, 0xffff0000, v4
Mvva 184,224,228
s_waitcnt lgkmcnt(4)
ds_read_b64_tr_b16 v[200:201], v115 offset:8192
ds_read_b64_tr_b16 v[202:203], v115 offset:10240
Mvva 184,228,236
buffer_load_dwordx4 v114, s[12:15], s50 offen offset:2048 lds
Mvva 184,232,244
ds_read_b64_tr_b16 v[204:205], v115 offset:12288
ds_read_b64_tr_b16 v[206:207], v115 offset:14336
Mvva 184,236,252
Vc 5,72,73
v_lshlrev_b32 v72, 16, v5
Mvva 172,240,224
ds_read_b64_tr_b16 v[208:209], v116 offset:0
ds_read_b64_tr_b16 v[210:211], v116 offset:2048
Mvva 172,244,232
v_and_b32 v73, 0xffff0000, v5
v_mul_f32 v2, 0xbfb8aa3b, v66
Mvva 172,248,240
ds_read_b64_tr_b16 v[212:213], v116 offset:4096
ds_read_b64_tr_b16 v[214:215], v116 offset:6144
Mvva 172,252,248
v_mul_f32 v3, 0xbfb8aa3b, v67
v_mul_f32 v4, 0xbfb8aa3b, v68
Mvva 188,240,228
s_waitcnt lgkmcnt(4)
ds_read_b64_tr_b16 v[216:217], v116 offset:8192
ds_read_b64_tr_b16 v[218:219], v116 offset:10240
Mvva 188,244,236
buffer_load_dwordx4 v114, s[12:15], s51 offen offset:3072 lds
v_add_u32 v114, 262144, v114
Mvva 188,248,244
ds_read_b64_tr_b16 v[220:221], v116 offset:12288
ds_read_b64_tr_b16 v[222:223], v116 offset:14336
Mvva 188,252,252
v_mul_f32 v5, 0xbfb8aa3b, v69
v_mul_f32 v6, 0xbfb8aa3b, v70
Mvva 128,192,0
ds_read_b64_tr_b16 v[224:225], v117 offset:0
ds_read_b64_tr_b16 v[226:227], v117 offset:2048
Mvva 128,196,8
v_mul_f32 v7, 0xbfb8aa3b, v71
v_mul_f32 v8, 0xbfb8aa3b, v72
Mvva 128,200,16
ds_read_b64_tr_b16 v[228:229], v117 offset:4096
ds_read_b64_tr_b16 v[230:231], v117 offset:6144
Mvva 128,204,24
v_mul_f32 v9, 0xbfb8aa3b, v73
Mvva 144,192,4
s_waitcnt lgkmcnt(4)
s_add_u32 m0, s44, 98304
ds_read_b64_tr_b16 v[232:233], v117 offset:8192
ds_read_b64_tr_b16 v[234:235], v117 offset:10240
Mvva 144,196,12
buffer_load_dwordx4 v114, s[12:15], s48 offen offset:0 lds
Mvva 144,200,20
ds_read_b64_tr_b16 v[236:237], v117 offset:12288
ds_read_b64_tr_b16 v[238:239], v117 offset:14336
Mvva 144,204,28
v_add_u32 v10, 4096, v112
Mvva 132,208,0
ds_read_b64_tr_b16 v[240:241], v118 offset:0
ds_read_b64_tr_b16 v[242:243], v118 offset:2048
Mvva 132,212,8
buffer_store_dwordx4 v[160:163], v112, s[16:19], s26 offen offset:0 sc1
Mvva 132,216,16
s_waitcnt lgkmcnt(2)
ds_read_b64_tr_b16 v[244:245], v118 offset:4096
ds_read_b64_tr_b16 v[246:247], v118 offset:6144
Mvva 132,220,24
buffer_store_dwordx4 v[164:167], v112, s[16:19], s26 offen offset:1024 sc1
Mvva 148,208,4
s_waitcnt vmcnt(19)
ds_read_b64_tr_b16 v[248:249], v118 offset:8192
ds_read_b64_tr_b16 v[250:251], v118 offset:10240
Mvva 148,212,12
buffer_load_dwordx4 v114, s[12:15], s49 offen offset:1024 lds
Mvva 148,216,20
s_barrier
ds_read_b64_tr_b16 v[252:253], v118 offset:12288
ds_read_b64_tr_b16 v[254:255], v118 offset:14336
Mvva 148,220,28
buffer_store_dwordx4 v[168:171], v112, s[16:19], s26 offen offset:2048 sc1
Mvva 136,224,0
ds_read_b64_tr_b16 v[192:193], v115 offset:16384
ds_read_b64_tr_b16 v[194:195], v115 offset:18432
Mvva 136,228,8
buffer_store_dwordx4 v[172:175], v112, s[16:19], s26 offen offset:3072 sc1
Mvva 136,232,16
ds_read_b64_tr_b16 v[196:197], v115 offset:20480
ds_read_b64_tr_b16 v[198:199], v115 offset:22528
Mvva 136,236,24
buffer_store_dwordx4 v[176:179], v10, s[16:19], s26 offen offset:0 sc1
Mvva 152,224,4
s_waitcnt lgkmcnt(4)
ds_read_b64_tr_b16 v[200:201], v115 offset:24576
ds_read_b64_tr_b16 v[202:203], v115 offset:26624
Mvva 152,228,12
buffer_load_dwordx4 v114, s[12:15], s50 offen offset:2048 lds
Mvva 152,232,20
ds_read_b64_tr_b16 v[204:205], v115 offset:28672
ds_read_b64_tr_b16 v[206:207], v115 offset:30720
Mvva 152,236,28
buffer_store_dwordx4 v[180:183], v10, s[16:19], s26 offen offset:1024 sc1
Mvva 140,240,0
ds_read_b64_tr_b16 v[208:209], v116 offset:16384
ds_read_b64_tr_b16 v[210:211], v116 offset:18432
Mvva 140,244,8
buffer_store_dwordx4 v[184:187], v10, s[16:19], s26 offen offset:2048 sc1
Mvva 140,248,16
ds_read_b64_tr_b16 v[212:213], v116 offset:20480
ds_read_b64_tr_b16 v[214:215], v116 offset:22528
Mvva 140,252,24
buffer_store_dwordx4 v[188:191], v10, s[16:19], s26 offen offset:3072 sc1
Mvva 156,240,4
s_waitcnt lgkmcnt(4)
ds_read_b64_tr_b16 v[216:217], v116 offset:24576
ds_read_b64_tr_b16 v[218:219], v116 offset:26624
Mvva 156,244,12
buffer_load_dwordx4 v114, s[12:15], s51 offen offset:3072 lds
v_add_u32 v114, 262144, v114
Mvva 156,248,20
ds_read_b64_tr_b16 v[220:221], v116 offset:28672
ds_read_b64_tr_b16 v[222:223], v116 offset:30720
Mvva 156,252,28
v_mov_b32 v16, 1
Mvva 128,192,32
ds_read_b64_tr_b16 v[224:225], v117 offset:16384
ds_read_b64_tr_b16 v[226:227], v117 offset:18432
Mvva 128,196,40
VE 2,2
Mvva 128,200,48
ds_read_b64_tr_b16 v[228:229], v117 offset:20480
ds_read_b64_tr_b16 v[230:231], v117 offset:22528
Mvva 128,204,56
VE 3,3
Mvva 144,192,36
s_waitcnt lgkmcnt(4)
s_add_u32 m0, s44, 114688
ds_read_b64_tr_b16 v[232:233], v117 offset:24576
ds_read_b64_tr_b16 v[234:235], v117 offset:26624
Mvva 144,196,44
buffer_load_dwordx4 v114, s[12:15], s48 offen offset:0 lds
Mvva 144,200,52
ds_read_b64_tr_b16 v[236:237], v117 offset:28672
ds_read_b64_tr_b16 v[238:239], v117 offset:30720
Mvva 144,204,60
Ve 4,4
Mvva 132,208,32
ds_read_b64_tr_b16 v[240:241], v118 offset:16384
ds_read_b64_tr_b16 v[242:243], v118 offset:18432
Mvva 132,212,40
VE 5,5
Mvva 132,216,48
s_waitcnt lgkmcnt(2)
ds_read_b64_tr_b16 v[244:245], v118 offset:20480
ds_read_b64_tr_b16 v[246:247], v118 offset:22528
Mvva 132,220,56
Ve 6,6
Mvva 148,208,36
s_waitcnt vmcnt(25)
ds_read_b64_tr_b16 v[248:249], v118 offset:24576
ds_read_b64_tr_b16 v[250:251], v118 offset:26624
Mvva 148,212,44
buffer_load_dwordx4 v114, s[12:15], s49 offen offset:1024 lds
Mvva 148,216,52
s_barrier
ds_read_b64_tr_b16 v[252:253], v118 offset:28672
ds_read_b64_tr_b16 v[254:255], v118 offset:30720
Mvva 148,220,60
VE 7,7
Mvva 136,224,32
ds_read_b64_tr_b16 v[192:193], v115 offset:32768
ds_read_b64_tr_b16 v[194:195], v115 offset:34816
Mvva 136,228,40
s_cmp_lg_u32 s53, 0
s_cbranch_scc1 L_yA
L_yAr:
Mvva 136,232,48
ds_read_b64_tr_b16 v[196:197], v115 offset:36864
ds_read_b64_tr_b16 v[198:199], v115 offset:38912
Mvva 136,236,56
VE 8,8
Mvva 152,224,36
s_waitcnt lgkmcnt(4)
ds_read_b64_tr_b16 v[200:201], v115 offset:40960
ds_read_b64_tr_b16 v[202:203], v115 offset:43008
Mvva 152,228,44
buffer_load_dwordx4 v114, s[12:15], s50 offen offset:2048 lds
Mvva 152,232,52
ds_read_b64_tr_b16 v[204:205], v115 offset:45056
ds_read_b64_tr_b16 v[206:207], v115 offset:47104
Mvva 152,236,60
Ve 9,9
Mvva 140,240,32
ds_read_b64_tr_b16 v[208:209], v116 offset:32768
ds_read_b64_tr_b16 v[210:211], v116 offset:34816
Mvva 140,244,40
v_add_f32 v2, 1.0, v2
v_add_f32 v3, 1.0, v3
Mvva 140,248,48
ds_read_b64_tr_b16 v[212:213], v116 offset:36864
ds_read_b64_tr_b16 v[214:215], v116 offset:38912
Mvva 140,252,56
v_add_f32 v4, 1.0, v4
v_add_f32 v5, 1.0, v5
Mvva 156,240,36
s_waitcnt lgkmcnt(4)
ds_read_b64_tr_b16 v[216:217], v116 offset:40960
ds_read_b64_tr_b16 v[218:219], v116 offset:43008
Mvva 156,244,44
buffer_load_dwordx4 v114, s[12:15], s51 offen offset:3072 lds
v_add_u32 v114, 262144, v114
Mvva 156,248,52
ds_read_b64_tr_b16 v[220:221], v116 offset:45056
ds_read_b64_tr_b16 v[222:223], v116 offset:47104
Mvva 156,252,60
v_add_f32 v6, 1.0, v6
v_add_f32_e64 v7, 1.0, v7
Mvva 128,192,64
ds_read_b64_tr_b16 v[224:225], v117 offset:32768
ds_read_b64_tr_b16 v[226:227], v117 offset:34816
Mvva 128,196,72
v_add_f32 v8, 1.0, v8
v_add_f32 v9, 1.0, v9
Mvva 128,200,80
ds_read_b64_tr_b16 v[228:229], v117 offset:36864
ds_read_b64_tr_b16 v[230:231], v117 offset:38912
Mvva 128,204,88
v_rcp_f32_e64 v2, v2
Mvva 144,192,68
s_waitcnt lgkmcnt(4)
ds_read_b64_tr_b16 v[232:233], v117 offset:40960
ds_read_b64_tr_b16 v[234:235], v117 offset:43008
Mvva 144,196,76
v_rcp_f32 v3, v3
Mvva 144,200,84
ds_read_b64_tr_b16 v[236:237], v117 offset:45056
ds_read_b64_tr_b16 v[238:239], v117 offset:47104
Mvva 144,204,92
v_rcp_f32_e64 v4, v4
Mvva 132,208,64
ds_read_b64_tr_b16 v[240:241], v118 offset:32768
ds_read_b64_tr_b16 v[242:243], v118 offset:34816
Mvva 132,212,72
v_rcp_f32_e64 v5, v5
Mvva 132,216,80
s_waitcnt lgkmcnt(2)
ds_read_b64_tr_b16 v[244:245], v118 offset:36864
ds_read_b64_tr_b16 v[246:247], v118 offset:38912
Mvva 132,220,88
v_rcp_f32 v6, v6
Mvva 148,208,68
s_waitcnt vmcnt(24)
ds_read_b64_tr_b16 v[248:249], v118 offset:40960
ds_read_b64_tr_b16 v[250:251], v118 offset:43008
Mvva 148,212,76
v_rcp_f32 v7, v7
Mvva 148,216,84
s_barrier
ds_read_b64_tr_b16 v[252:253], v118 offset:45056
ds_read_b64_tr_b16 v[254:255], v118 offset:47104
Mvva 148,220,92
v_rcp_f32 v8, v8
Mvva 136,224,64
ds_read_b64_tr_b16 v[192:193], v115 offset:49152
ds_read_b64_tr_b16 v[194:195], v115 offset:51200
Mvva 136,228,72
v_rcp_f32_e64 v9, v9
Mvva 136,232,80
ds_read_b64_tr_b16 v[196:197], v115 offset:53248
ds_read_b64_tr_b16 v[198:199], v115 offset:55296
Mvva 136,236,88
Vm 66,66,2
Vm 67,67,3
Mvva 152,224,68
s_waitcnt lgkmcnt(4)
ds_read_b64_tr_b16 v[200:201], v115 offset:57344
ds_read_b64_tr_b16 v[202:203], v115 offset:59392
Mvva 152,228,76
Vm 68,68,4
v_mul_f32_e64 v69, v69, v5
Mvva 152,232,84
ds_read_b64_tr_b16 v[204:205], v115 offset:61440
ds_read_b64_tr_b16 v[206:207], v115 offset:63488
Mvva 152,236,92
Vm 70,70,6
Vm 71,71,7
Mvva 140,240,64
ds_read_b64_tr_b16 v[208:209], v116 offset:49152
ds_read_b64_tr_b16 v[210:211], v116 offset:51200
Mvva 140,244,72
Vm 72,72,8
Vm 73,73,9
Mvva 140,248,80
ds_read_b64_tr_b16 v[212:213], v116 offset:53248
ds_read_b64_tr_b16 v[214:215], v116 offset:55296
Mvva 140,252,88
Vc 2,66,67
v_lshlrev_b32_e64 v66, 16, v2
Mvva 156,240,68
s_waitcnt lgkmcnt(4)
ds_read_b64_tr_b16 v[216:217], v116 offset:57344
ds_read_b64_tr_b16 v[218:219], v116 offset:59392
Mvva 156,244,76
v_and_b32 v67, 0xffff0000, v2
Vc 3,68,69
Mvva 156,248,84
ds_read_b64_tr_b16 v[220:221], v116 offset:61440
ds_read_b64_tr_b16 v[222:223], v116 offset:63488
Mvva 156,252,92
v_lshlrev_b32 v68, 16, v3
v_and_b32 v69, 0xffff0000, v3
Mvva 128,192,96
ds_read_b64_tr_b16 v[224:225], v117 offset:49152
ds_read_b64_tr_b16 v[226:227], v117 offset:51200
Mvva 128,196,104
Vc 4,70,71
v_lshlrev_b32_e64 v70, 16, v4
Mvva 128,200,112
ds_read_b64_tr_b16 v[228:229], v117 offset:53248
ds_read_b64_tr_b16 v[230:231], v117 offset:55296
Mvva 128,204,120
v_and_b32 v71, 0xffff0000, v4
Vc 5,72,73
Mvva 144,192,100
s_waitcnt lgkmcnt(4)
ds_read_b64_tr_b16 v[232:233], v117 offset:57344
ds_read_b64_tr_b16 v[234:235], v117 offset:59392
Mvva 144,196,108
v_lshlrev_b32 v72, 16, v5
v_and_b32 v73, 0xffff0000, v5
Mvva 144,200,116
ds_read_b64_tr_b16 v[236:237], v117 offset:61440
ds_read_b64_tr_b16 v[238:239], v117 offset:63488
Mvva 144,204,124
s_waitcnt vmcnt(5)
s_mov_b64 exec, 1
buffer_store_dword v16, v126, s[20:23], s27 offen sc1
s_mov_b64 exec, -1
Mvva 132,208,96
ds_read_b64_tr_b16 v[240:241], v118 offset:49152
ds_read_b64_tr_b16 v[242:243], v118 offset:51200
Mvva 132,212,104
Mvva 132,216,112
s_waitcnt lgkmcnt(2)
ds_read_b64_tr_b16 v[244:245], v118 offset:53248
ds_read_b64_tr_b16 v[246:247], v118 offset:55296
Mvva 132,220,120
Mvva 148,208,100
ds_read_b64_tr_b16 v[248:249], v118 offset:57344
ds_read_b64_tr_b16 v[250:251], v118 offset:59392
Mvva 148,212,108
Mvva 148,216,116
s_barrier
ds_read_b64_tr_b16 v[252:253], v118 offset:61440
ds_read_b64_tr_b16 v[254:255], v118 offset:63488
Mvva 148,220,124
Mvva 136,224,96
ds_read_b64_tr_b16 v[192:193], v12 offset:0
ds_read_b64_tr_b16 v[194:195], v12 offset:2048
Mvva 136,228,104
Mvva 136,232,112
ds_read_b64_tr_b16 v[196:197], v12 offset:4096
ds_read_b64_tr_b16 v[198:199], v12 offset:6144
Mvva 136,236,120
Mvva 152,224,100
s_waitcnt lgkmcnt(4)
ds_read_b64_tr_b16 v[200:201], v12 offset:8192
ds_read_b64_tr_b16 v[202:203], v12 offset:10240
Mvva 152,228,108
Mvva 152,232,116
ds_read_b64_tr_b16 v[204:205], v12 offset:12288
ds_read_b64_tr_b16 v[206:207], v12 offset:14336
Mvva 152,236,124
s_cmp_lg_u32 s53, 0
s_cbranch_scc1 L_yB
L_yBr:
Mvva 140,240,96
ds_read_b64_tr_b16 v[208:209], v13 offset:0
ds_read_b64_tr_b16 v[210:211], v13 offset:2048
Mvva 140,244,104
Mvva 140,248,112
ds_read_b64_tr_b16 v[212:213], v13 offset:4096
ds_read_b64_tr_b16 v[214:215], v13 offset:6144
Mvva 140,252,120
Mvva 156,240,100
s_waitcnt lgkmcnt(4)
ds_read_b64_tr_b16 v[216:217], v13 offset:8192
ds_read_b64_tr_b16 v[218:219], v13 offset:10240
Mvva 156,244,108
Mvva 156,248,116
ds_read_b64_tr_b16 v[220:221], v13 offset:12288
ds_read_b64_tr_b16 v[222:223], v13 offset:14336
Mvva 156,252,124
Mvva 128,192,128
ds_read_b64_tr_b16 v[224:225], v14 offset:0
ds_read_b64_tr_b16 v[226:227], v14 offset:2048
Mvva 128,196,136
Mvva 128,200,144
ds_read_b64_tr_b16 v[228:229], v14 offset:4096
ds_read_b64_tr_b16 v[230:231], v14 offset:6144
Mvva 128,204,152
Mvva 144,192,132
s_waitcnt lgkmcnt(4)
ds_read_b64_tr_b16 v[232:233], v14 offset:8192
ds_read_b64_tr_b16 v[234:235], v14 offset:10240
Mvva 144,196,140
Mvva 144,200,148
ds_read_b64_tr_b16 v[236:237], v14 offset:12288
ds_read_b64_tr_b16 v[238:239], v14 offset:14336
Mvva 144,204,156
Mvva 132,208,128
ds_read_b64_tr_b16 v[240:241], v15 offset:0
ds_read_b64_tr_b16 v[242:243], v15 offset:2048
Mvva 132,212,136
Mvva 132,216,144
s_waitcnt lgkmcnt(2)
ds_read_b64_tr_b16 v[244:245], v15 offset:4096
ds_read_b64_tr_b16 v[246:247], v15 offset:6144
Mvva 132,220,152
Mvva 148,208,132
ds_read_b64_tr_b16 v[248:249], v15 offset:8192
ds_read_b64_tr_b16 v[250:251], v15 offset:10240
Mvva 148,212,140
Mvva 148,216,148
s_barrier
ds_read_b64_tr_b16 v[252:253], v15 offset:12288
ds_read_b64_tr_b16 v[254:255], v15 offset:14336
Mvva 148,220,156
Mvva 136,224,128
ds_read_b64_tr_b16 v[192:193], v12 offset:16384
ds_read_b64_tr_b16 v[194:195], v12 offset:18432
Mvva 136,228,136
Mvva 136,232,144
ds_read_b64_tr_b16 v[196:197], v12 offset:20480
ds_read_b64_tr_b16 v[198:199], v12 offset:22528
Mvva 136,236,152
Mvva 152,224,132
s_waitcnt lgkmcnt(4)
ds_read_b64_tr_b16 v[200:201], v12 offset:24576
ds_read_b64_tr_b16 v[202:203], v12 offset:26624
Mvva 152,228,140
buffer_load_dword v17, v126, s[20:23], s24 offen sc1
Mvva 152,232,148
ds_read_b64_tr_b16 v[204:205], v12 offset:28672
ds_read_b64_tr_b16 v[206:207], v12 offset:30720
Mvva 152,236,156
Mvva 140,240,128
ds_read_b64_tr_b16 v[208:209], v13 offset:16384
ds_read_b64_tr_b16 v[210:211], v13 offset:18432
Mvva 140,244,136
Mvva 140,248,144
ds_read_b64_tr_b16 v[212:213], v13 offset:20480
ds_read_b64_tr_b16 v[214:215], v13 offset:22528
Mvva 140,252,152
Mvva 156,240,132
s_waitcnt lgkmcnt(4)
ds_read_b64_tr_b16 v[216:217], v13 offset:24576
ds_read_b64_tr_b16 v[218:219], v13 offset:26624
Mvva 156,244,140
Mvva 156,248,148
ds_read_b64_tr_b16 v[220:221], v13 offset:28672
ds_read_b64_tr_b16 v[222:223], v13 offset:30720
Mvva 156,252,156
Mvva 128,192,160
ds_read_b64_tr_b16 v[224:225], v14 offset:16384
ds_read_b64_tr_b16 v[226:227], v14 offset:18432
Mvva 128,196,168
Mvva 128,200,176
ds_read_b64_tr_b16 v[228:229], v14 offset:20480
ds_read_b64_tr_b16 v[230:231], v14 offset:22528
Mvva 128,204,184
Mvva 144,192,164
s_waitcnt lgkmcnt(4)
ds_read_b64_tr_b16 v[232:233], v14 offset:24576
ds_read_b64_tr_b16 v[234:235], v14 offset:26624
Mvva 144,196,172
Mvva 144,200,180
ds_read_b64_tr_b16 v[236:237], v14 offset:28672
ds_read_b64_tr_b16 v[238:239], v14 offset:30720
Mvva 144,204,188
Mvva 132,208,160
ds_read_b64_tr_b16 v[240:241], v15 offset:16384
ds_read_b64_tr_b16 v[242:243], v15 offset:18432
Mvva 132,212,168
Mvva 132,216,176
s_waitcnt lgkmcnt(2)
ds_read_b64_tr_b16 v[244:245], v15 offset:20480
ds_read_b64_tr_b16 v[246:247], v15 offset:22528
Mvva 132,220,184
Mvva 148,208,164
s_waitcnt vmcnt(6)
ds_read_b64_tr_b16 v[248:249], v15 offset:24576
ds_read_b64_tr_b16 v[250:251], v15 offset:26624
Mvva 148,212,172
Mvva 148,216,180
s_barrier
ds_read_b64_tr_b16 v[252:253], v15 offset:28672
ds_read_b64_tr_b16 v[254:255], v15 offset:30720
Mvva 148,220,188
Mvva 136,224,160
ds_read_b64_tr_b16 v[192:193], v12 offset:32768
ds_read_b64_tr_b16 v[194:195], v12 offset:34816
Mvva 136,228,168
s_cmp_lg_u32 s40, 0
s_cbranch_scc1 L_yC
L_yCr:
Mvva 136,232,176
ds_read_b64_tr_b16 v[196:197], v12 offset:36864
ds_read_b64_tr_b16 v[198:199], v12 offset:38912
Mvva 136,236,184
Mvva 152,224,164
s_waitcnt lgkmcnt(4)
ds_read_b64_tr_b16 v[200:201], v12 offset:40960
ds_read_b64_tr_b16 v[202:203], v12 offset:43008
Mvva 152,228,172
Mvva 152,232,180
ds_read_b64_tr_b16 v[204:205], v12 offset:45056
ds_read_b64_tr_b16 v[206:207], v12 offset:47104
Mvva 152,236,188
Mvva 140,240,160
ds_read_b64_tr_b16 v[208:209], v13 offset:32768
ds_read_b64_tr_b16 v[210:211], v13 offset:34816
Mvva 140,244,168
Mvva 140,248,176
ds_read_b64_tr_b16 v[212:213], v13 offset:36864
ds_read_b64_tr_b16 v[214:215], v13 offset:38912
Mvva 140,252,184
s_waitcnt vmcnt(0)
v_cmp_ne_u32 vcc, 1, v17
s_mov_b32 s33, 0
s_cbranch_vccnz L_xno
s_nop 0
buffer_load_dwordx4 v[160:163], v112, s[16:19], s25 offen offset:0 sc1
buffer_load_dwordx4 v[164:167], v112, s[16:19], s25 offen offset:1024 sc1
buffer_load_dwordx4 v[168:171], v112, s[16:19], s25 offen offset:2048 sc1
buffer_load_dwordx4 v[172:175], v112, s[16:19], s25 offen offset:3072 sc1
buffer_load_dwordx4 v[176:179], v10, s[16:19], s25 offen offset:0 sc1
buffer_load_dwordx4 v[180:183], v10, s[16:19], s25 offen offset:1024 sc1
buffer_load_dwordx4 v[184:187], v10, s[16:19], s25 offen offset:2048 sc1
buffer_load_dwordx4 v[188:191], v10, s[16:19], s25 offen offset:3072 sc1
s_mov_b32 s33, 1
L_xno:
Mvva 156,240,164
s_waitcnt lgkmcnt(4)
ds_read_b64_tr_b16 v[216:217], v13 offset:40960
ds_read_b64_tr_b16 v[218:219], v13 offset:43008
Mvva 156,244,172
Mvva 156,248,180
ds_read_b64_tr_b16 v[220:221], v13 offset:45056
ds_read_b64_tr_b16 v[222:223], v13 offset:47104
Mvva 156,252,188
Mvva 128,192,192
ds_read_b64_tr_b16 v[224:225], v14 offset:32768
ds_read_b64_tr_b16 v[226:227], v14 offset:34816
Mvva 128,196,200
Mvva 128,200,208
ds_read_b64_tr_b16 v[228:229], v14 offset:36864
ds_read_b64_tr_b16 v[230:231], v14 offset:38912
Mvva 128,204,216
Mvva 144,192,196
s_waitcnt lgkmcnt(4)
ds_read_b64_tr_b16 v[232:233], v14 offset:40960
ds_read_b64_tr_b16 v[234:235], v14 offset:43008
Mvva 144,196,204
Mvva 144,200,212
ds_read_b64_tr_b16 v[236:237], v14 offset:45056
ds_read_b64_tr_b16 v[238:239], v14 offset:47104
Mvva 144,204,220
Mvva 132,208,192
ds_read_b64_tr_b16 v[240:241], v15 offset:32768
ds_read_b64_tr_b16 v[242:243], v15 offset:34816
Mvva 132,212,200
Mvva 132,216,208
s_waitcnt lgkmcnt(2)
ds_read_b64_tr_b16 v[244:245], v15 offset:36864
ds_read_b64_tr_b16 v[246:247], v15 offset:38912
Mvva 132,220,216
Mvva 148,208,196
ds_read_b64_tr_b16 v[248:249], v15 offset:40960
ds_read_b64_tr_b16 v[250:251], v15 offset:43008
Mvva 148,212,204
Mvva 148,216,212
s_barrier
ds_read_b64_tr_b16 v[252:253], v15 offset:45056
ds_read_b64_tr_b16 v[254:255], v15 offset:47104
Mvva 148,220,220
Mvva 136,224,192
ds_read_b64_tr_b16 v[192:193], v12 offset:49152
ds_read_b64_tr_b16 v[194:195], v12 offset:51200
Mvva 136,228,200
Mvva 136,232,208
ds_read_b64_tr_b16 v[196:197], v12 offset:53248
ds_read_b64_tr_b16 v[198:199], v12 offset:55296
Mvva 136,236,216
Mvva 152,224,196
s_waitcnt lgkmcnt(4)
ds_read_b64_tr_b16 v[200:201], v12 offset:57344
ds_read_b64_tr_b16 v[202:203], v12 offset:59392
Mvva 152,228,204
Mvva 152,232,212
ds_read_b64_tr_b16 v[204:205], v12 offset:61440
ds_read_b64_tr_b16 v[206:207], v12 offset:63488
Mvva 152,236,220
Mvva 140,240,192
ds_read_b64_tr_b16 v[208:209], v13 offset:49152
ds_read_b64_tr_b16 v[210:211], v13 offset:51200
Mvva 140,244,200
Mvva 140,248,208
ds_read_b64_tr_b16 v[212:213], v13 offset:53248
ds_read_b64_tr_b16 v[214:215], v13 offset:55296
Mvva 140,252,216
Mvva 156,240,196
s_waitcnt lgkmcnt(4)
ds_read_b64_tr_b16 v[216:217], v13 offset:57344
ds_read_b64_tr_b16 v[218:219], v13 offset:59392
Mvva 156,244,204
Mvva 156,248,212
ds_read_b64_tr_b16 v[220:221], v13 offset:61440
ds_read_b64_tr_b16 v[222:223], v13 offset:63488
Mvva 156,252,220
Mvva 128,192,224
ds_read_b64_tr_b16 v[224:225], v14 offset:49152
ds_read_b64_tr_b16 v[226:227], v14 offset:51200
Mvva 128,196,232
Mvva 128,200,240
ds_read_b64_tr_b16 v[228:229], v14 offset:53248
ds_read_b64_tr_b16 v[230:231], v14 offset:55296
Mvva 128,204,248
Mvva 144,192,228
s_waitcnt lgkmcnt(4)
ds_read_b64_tr_b16 v[232:233], v14 offset:57344
ds_read_b64_tr_b16 v[234:235], v14 offset:59392
Mvva 144,196,236
Mvva 144,200,244
ds_read_b64_tr_b16 v[236:237], v14 offset:61440
ds_read_b64_tr_b16 v[238:239], v14 offset:63488
Mvva 144,204,252
Mvva 132,208,224
ds_read_b64_tr_b16 v[240:241], v15 offset:49152
ds_read_b64_tr_b16 v[242:243], v15 offset:51200
Mvva 132,212,232
Mvva 132,216,240
s_waitcnt lgkmcnt(2)
ds_read_b64_tr_b16 v[244:245], v15 offset:53248
ds_read_b64_tr_b16 v[246:247], v15 offset:55296
Mvva 132,220,248
Mvva 148,208,228
ds_read_b64_tr_b16 v[248:249], v15 offset:57344
ds_read_b64_tr_b16 v[250:251], v15 offset:59392
Mvva 148,212,236
Mvva 148,216,244
ds_read_b64_tr_b16 v[252:253], v15 offset:61440
ds_read_b64_tr_b16 v[254:255], v15 offset:63488
Mvva 148,220,252
Mvva 136,224,224
Mvva 136,228,232
Mvva 136,232,240
Mvva 136,236,248
Mvva 152,224,228
s_waitcnt lgkmcnt(0)
Mvva 152,228,236
Mvva 152,232,244
Mvva 152,236,252
Mvva 140,240,224
Mvva 140,244,232
Mvva 140,248,240
Mvva 140,252,248
Mvva 156,240,228
Mvva 156,244,236
Mvva 156,248,244
Mvva 156,252,252
s_cmp_lg_u32 s53, s40
s_cbranch_scc1 L_ysl
L_yslr:
v_and_b32 v124, 15, v0
v_lshlrev_b32 v74, 8, v124
v_add_u32 v74, s35, v74
v_xor_b32 v124, v124, v121
v_lshl_add_u32 v74, v124, 4, v74
v_xor_b32_e64 v75, 64, v74
v_xor_b32 v76, 128, v74
v_xor_b32 v77, 192, v74
v_lshlrev_b32 v125, 1, v122
v_xor_b32 v124, v123, v125
v_lshlrev_b32 v12, 8, v123
v_add_u32 v12, s35, v12
v_lshl_add_u32 v12, v124, 4, v12
v_xor_b32_e64 v13, 16, v12
v_xor_b32 v14, 128, v12
v_xor_b32 v15, 144, v12
s_cmp_eq_u32 s33, 0
s_cbranch_scc1 L_spinX
L_spinXr:
v_lshlrev_b32_e64 v80, 16, v18
v_and_b32 v81, 0xffff0000, v18
v_lshlrev_b32_e64 v82, 16, v19
v_and_b32 v83, 0xffff0000, v19
v_lshlrev_b32_e64 v84, 16, v20
v_and_b32 v85, 0xffff0000, v20
v_lshlrev_b32_e64 v86, 16, v21
v_and_b32 v87, 0xffff0000, v21
v_lshlrev_b32_e64 v88, 16, v22
v_and_b32 v89, 0xffff0000, v22
v_lshlrev_b32_e64 v90, 16, v23
v_and_b32 v91, 0xffff0000, v23
v_lshlrev_b32_e64 v92, 16, v24
v_and_b32 v93, 0xffff0000, v24
v_lshlrev_b32_e64 v94, 16, v25
v_and_b32 v95, 0xffff0000, v25
v_lshlrev_b32_e64 v96, 16, v26
v_and_b32 v97, 0xffff0000, v26
v_lshlrev_b32_e64 v98, 16, v27
v_and_b32 v99, 0xffff0000, v27
v_lshlrev_b32_e64 v100, 16, v28
v_and_b32 v101, 0xffff0000, v28
v_lshlrev_b32_e64 v102, 16, v29
v_and_b32 v103, 0xffff0000, v29
v_lshlrev_b32_e64 v104, 16, v30
v_and_b32 v105, 0xffff0000, v30
v_lshlrev_b32_e64 v106, 16, v31
v_and_b32 v107, 0xffff0000, v31
v_lshlrev_b32_e64 v108, 16, v32
v_and_b32 v109, 0xffff0000, v32
v_lshlrev_b32_e64 v110, 16, v33
v_and_b32 v111, 0xffff0000, v33
s_waitcnt vmcnt(0)
s_nop 0
v_pk_add_f32 v[128:129], v[128:129], v[160:161]
v_pk_add_f32 v[130:131], v[130:131], v[162:163]
ds_write_b128 v74, v[128:131] offset:0
v_pk_add_f32 v[132:133], v[132:133], v[164:165]
v_pk_add_f32 v[134:135], v[134:135], v[166:167]
ds_write_b128 v75, v[132:135] offset:0
v_pk_add_f32 v[136:137], v[136:137], v[168:169]
v_pk_add_f32 v[138:139], v[138:139], v[170:171]
ds_write_b128 v76, v[136:139] offset:0
v_pk_add_f32 v[140:141], v[140:141], v[172:173]
v_pk_add_f32 v[142:143], v[142:143], v[174:175]
ds_write_b128 v77, v[140:143] offset:0
v_pk_add_f32 v[144:145], v[144:145], v[176:177]
v_pk_add_f32 v[146:147], v[146:147], v[178:179]
ds_write_b128 v74, v[144:147] offset:4096
v_pk_add_f32 v[148:149], v[148:149], v[180:181]
v_pk_add_f32 v[150:151], v[150:151], v[182:183]
ds_write_b128 v75, v[148:151] offset:4096
v_pk_add_f32 v[152:153], v[152:153], v[184:185]
v_pk_add_f32 v[154:155], v[154:155], v[186:187]
ds_write_b128 v76, v[152:155] offset:4096
v_pk_add_f32 v[156:157], v[156:157], v[188:189]
v_pk_add_f32 v[158:159], v[158:159], v[190:191]
ds_write_b128 v77, v[156:159] offset:4096
Rv 192,12,0
Rv 196,13,0
Rv 200,14,2048
Rv 204,15,2048
Rv 208,12,4096
Rv 212,13,4096
Rv 216,14,6144
s_waitcnt lgkmcnt(9)
Rv 220,15,6144
s_waitcnt lgkmcnt(6)
Vc 224,192,193
v_lshlrev_b32_e64 v192, 16, v224
v_and_b32 v193, 0xffff0000, v224
Vc 225,194,195
v_lshlrev_b32_e64 v194, 16, v225
v_and_b32 v195, 0xffff0000, v225
Vc 226,196,197
v_lshlrev_b32_e64 v196, 16, v226
v_and_b32 v197, 0xffff0000, v226
Vc 227,198,199
v_lshlrev_b32_e64 v198, 16, v227
v_and_b32 v199, 0xffff0000, v227
v_pk_mul_f32 v[192:193], v[192:193], v[42:43]
v_pk_mul_f32 v[194:195], v[194:195], v[44:45]
v_pk_mul_f32 v[196:197], v[196:197], v[46:47]
v_pk_mul_f32 v[198:199], v[198:199], v[48:49]
Vc 224,192,193
v_lshlrev_b32_e64 v192, 16, v224
v_and_b32 v193, 0xffff0000, v224
Vc 225,194,195
v_lshlrev_b32_e64 v194, 16, v225
v_and_b32 v195, 0xffff0000, v225
Vc 226,196,197
v_lshlrev_b32_e64 v196, 16, v226
v_and_b32 v197, 0xffff0000, v226
Vc 227,198,199
v_lshlrev_b32_e64 v198, 16, v227
v_and_b32 v199, 0xffff0000, v227
v_pk_add_f32 v[192:193], v[192:193], v[80:81]
v_pk_add_f32 v[194:195], v[194:195], v[82:83]
v_pk_add_f32 v[196:197], v[196:197], v[84:85]
v_pk_add_f32 v[198:199], v[198:199], v[86:87]
Vc 224,192,193
Vc 225,194,195
Vc 226,196,197
Vc 227,198,199
buffer_store_dwordx4 v[224:227], v119, s[68:71], s36 offen sc1
s_add_u32 s36, s36, 16384
s_waitcnt lgkmcnt(4)
Vc 228,200,201
v_lshlrev_b32 v200, 16, v228
v_and_b32 v201, 0xffff0000, v228
Vc 229,202,203
v_lshlrev_b32_e64 v202, 16, v229
v_and_b32 v203, 0xffff0000, v229
Vc 230,204,205
v_lshlrev_b32_e64 v204, 16, v230
v_and_b32 v205, 0xffff0000, v230
Vc 231,206,207
v_lshlrev_b32_e64 v206, 16, v231
v_and_b32 v207, 0xffff0000, v231
v_pk_mul_f32 v[200:201], v[200:201], v[50:51]
v_pk_mul_f32 v[202:203], v[202:203], v[52:53]
v_pk_mul_f32 v[204:205], v[204:205], v[54:55]
v_pk_mul_f32 v[206:207], v[206:207], v[56:57]
Vc 228,200,201
v_lshlrev_b32_e64 v200, 16, v228
v_and_b32 v201, 0xffff0000, v228
Vc 229,202,203
v_lshlrev_b32_e64 v202, 16, v229
v_and_b32 v203, 0xffff0000, v229
Vc 230,204,205
v_lshlrev_b32_e64 v204, 16, v230
v_and_b32 v205, 0xffff0000, v230
Vc 231,206,207
v_lshlrev_b32_e64 v206, 16, v231
v_and_b32 v207, 0xffff0000, v231
v_pk_add_f32 v[200:201], v[200:201], v[88:89]
v_pk_add_f32 v[202:203], v[202:203], v[90:91]
v_pk_add_f32 v[204:205], v[204:205], v[92:93]
v_pk_add_f32 v[206:207], v[206:207], v[94:95]
Vc 228,200,201
Vc 229,202,203
Vc 230,204,205
Vc 231,206,207
buffer_store_dwordx4 v[228:231], v119, s[68:71], s36 offen sc1
s_add_u32 s36, s36, 16384
s_waitcnt lgkmcnt(2)
Vc 232,208,209
v_lshlrev_b32 v208, 16, v232
v_and_b32 v209, 0xffff0000, v232
Vc 233,210,211
v_lshlrev_b32_e64 v210, 16, v233
v_and_b32 v211, 0xffff0000, v233
Vc 234,212,213
v_lshlrev_b32_e64 v212, 16, v234
v_and_b32 v213, 0xffff0000, v234
Vc 235,214,215
v_lshlrev_b32_e64 v214, 16, v235
v_and_b32 v215, 0xffff0000, v235
v_pk_mul_f32 v[208:209], v[208:209], v[58:59]
v_pk_mul_f32 v[210:211], v[210:211], v[60:61]
v_pk_mul_f32 v[212:213], v[212:213], v[62:63]
v_pk_mul_f32 v[214:215], v[214:215], v[64:65]
Vc 232,208,209
v_lshlrev_b32_e64 v208, 16, v232
v_and_b32 v209, 0xffff0000, v232
Vc 233,210,211
v_lshlrev_b32_e64 v210, 16, v233
v_and_b32 v211, 0xffff0000, v233
Vc 234,212,213
v_lshlrev_b32_e64 v212, 16, v234
v_and_b32 v213, 0xffff0000, v234
Vc 235,214,215
v_lshlrev_b32_e64 v214, 16, v235
v_and_b32 v215, 0xffff0000, v235
v_pk_add_f32 v[208:209], v[208:209], v[96:97]
v_pk_add_f32 v[210:211], v[210:211], v[98:99]
v_pk_add_f32 v[212:213], v[212:213], v[100:101]
v_pk_add_f32 v[214:215], v[214:215], v[102:103]
Vc 232,208,209
Vc 233,210,211
Vc 234,212,213
Vc 235,214,215
buffer_store_dwordx4 v[232:235], v119, s[68:71], s36 offen sc1
s_add_u32 s36, s36, 16384
s_waitcnt lgkmcnt(0)
Vc 236,216,217
v_lshlrev_b32 v216, 16, v236
v_and_b32 v217, 0xffff0000, v236
Vc 237,218,219
v_lshlrev_b32_e64 v218, 16, v237
v_and_b32 v219, 0xffff0000, v237
Vc 238,220,221
v_lshlrev_b32_e64 v220, 16, v238
v_and_b32 v221, 0xffff0000, v238
Vc 239,222,223
v_lshlrev_b32_e64 v222, 16, v239
v_and_b32 v223, 0xffff0000, v239
v_pk_mul_f32 v[216:217], v[216:217], v[66:67]
v_pk_mul_f32 v[218:219], v[218:219], v[68:69]
v_pk_mul_f32 v[220:221], v[220:221], v[70:71]
v_pk_mul_f32 v[222:223], v[222:223], v[72:73]
Vc 236,216,217
v_lshlrev_b32_e64 v216, 16, v236
v_and_b32 v217, 0xffff0000, v236
Vc 237,218,219
v_lshlrev_b32_e64 v218, 16, v237
v_and_b32 v219, 0xffff0000, v237
Vc 238,220,221
v_lshlrev_b32_e64 v220, 16, v238
v_and_b32 v221, 0xffff0000, v238
Vc 239,222,223
v_lshlrev_b32_e64 v222, 16, v239
v_and_b32 v223, 0xffff0000, v239
v_pk_add_f32 v[216:217], v[216:217], v[104:105]
v_pk_add_f32 v[218:219], v[218:219], v[106:107]
v_pk_add_f32 v[220:221], v[220:221], v[108:109]
v_pk_add_f32 v[222:223], v[222:223], v[110:111]
Vc 236,216,217
Vc 237,218,219
Vc 238,220,221
Vc 239,222,223
buffer_store_dwordx4 v[236:239], v119, s[68:71], s36 offen sc1
L_k2_end:
s_endpgm
L_spinC:
s_add_u32 m0, s35, 0
s_nop 0
s_nop 0
buffer_load_dwordx4 v125, s[60:63], s48 offen offset:0 lds
buffer_load_dwordx4 v125, s[60:63], s49 offen offset:1024 lds
buffer_load_dwordx4 v125, s[60:63], s50 offen offset:2048 lds
buffer_load_dwordx4 v125, s[60:63], s51 offen offset:3072 lds
v_add_u32 v125, 65536, v125
s_add_u32 m0, s35, 4096
s_nop 0
buffer_load_dwordx4 v125, s[60:63], s48 offen offset:0 lds
buffer_load_dwordx4 v125, s[60:63], s49 offen offset:1024 lds
buffer_load_dwordx4 v125, s[60:63], s50 offen offset:2048 lds
buffer_load_dwordx4 v125, s[60:63], s51 offen offset:3072 lds
s_mov_b32 s40, 1
s_mov_b32 s47, 0x400000
L_spinC_l:
buffer_load_dword v124, v10, s[20:23], s38 offen sc1
s_sub_u32 s47, s47, 1
s_waitcnt vmcnt(0)
s_cmp_eq_u32 s47, 0
s_cbranch_scc1 L_spinC_lx
v_cmp_ne_u32 vcc, 1, v124
s_cbranch_vccz L_spinC_lx
s_sleep 4
s_branch L_spinC_l
L_spinC_lx:
s_branch L_spinCr
L_c31:
s_bfe_u32 s3, s2, 0x40003
s_lshl_b32 s3, s3, 2
s_add_u32 s3, s3, s32
s_lshl_b32 s3, s3, 15
s_and_b32 s7, s2, 1
s_lshl_b32 s7, s7, 22
s_add_u32 s3, s3, s7
s_add_u32 s3, s3, 2097536
v_and_b32 v1, 15, v0
v_lshlrev_b32 v1, 11, v1
v_lshrrev_b32 v11, 5, v0
v_lshl_add_u32 v1, v11, 10, v1
buffer_load_dword v11, v1, s[28:31], s3 offen
s_branch L_c31r
L_f2A:
s_lshr_b32 s5, s54, 1
s_lshl_b32 s5, s5, 5
s_add_u32 s5, s5, 5447680
buffer_load_dword v125, v127, s[20:23], s5 offen sc1
s_branch L_f2Ar
L_f2B:
s_waitcnt vmcnt(16)
v_cmp_ne_u32 vcc, 1, v125
s_cbranch_vccz L_f2lx
s_mov_b32 s47, 0x400000
L_f2l:
buffer_load_dword v125, v127, s[20:23], s5 offen sc1
s_sub_u32 s47, s47, 1
s_waitcnt vmcnt(0)
s_cmp_eq_u32 s47, 0
s_cbranch_scc1 L_f2lx
v_cmp_ne_u32 vcc, 1, v125
s_cbranch_vccz L_f2lx
s_sleep 8
s_branch L_f2l
L_f2lx:
s_lshl_b32 s3, s54, 8
s_add_u32 s3, s3, 6291456
v_mul_u32_u24 v124, 14336, v121
v_and_b32_e64 v125, 15, v0
v_lshl_add_u32 v124, v125, 4, v124
buffer_load_dwordx4 v[74:77], v124, s[20:23], s3 offen sc1
s_add_u32 s3, s3, 57344
buffer_load_dwordx4 v[78:81], v124, s[20:23], s3 offen sc1
s_add_u32 s3, s3, 57344
buffer_load_dwordx4 v[82:85], v124, s[20:23], s3 offen sc1
s_add_u32 s3, s3, 57344
buffer_load_dwordx4 v[86:89], v124, s[20:23], s3 offen sc1
s_add_u32 s3, s3, 57344
buffer_load_dwordx4 v[90:93], v124, s[20:23], s3 offen sc1
s_add_u32 s3, s3, 57344
buffer_load_dwordx4 v[94:97], v124, s[20:23], s3 offen sc1
s_add_u32 s3, s3, 57344
buffer_load_dwordx4 v[98:101], v124, s[20:23], s3 offen sc1
s_add_u32 s3, s3, 57344
buffer_load_dwordx4 v[102:105], v124, s[20:23], s3 offen sc1
s_branch L_f2Br
L_yA:
v_min_u32 v127, 13, v0
v_lshlrev_b32_e64 v127, 2, v127
buffer_load_dword v74, v127, s[20:23], s41 offen sc1
s_branch L_yAr
L_yB:
s_waitcnt vmcnt(1)
v_cmp_ne_u32 vcc, 1, v74
s_cbranch_vccnz L_yBr
s_mov_b32 s40, 1
v_lshlrev_b32 v124, 2, v0
v_lshlrev_b32 v125, 1, v0
s_lshl_b32 s7, s45, 2
s_add_u32 s7, s7, s32
s_lshr_b32 s3, s42, 5
s_cmp_lg_u32 s3, s7
s_cbranch_scc1 L_f_yl1
s_add_u32 s3, s55, 0
s_nop 0
s_add_u32 s7, s3, 4096
buffer_load_dword v76, v124, s[20:23], s3 offen offset:0 sc1
buffer_load_dword v77, v124, s[20:23], s3 offen offset:512 sc1
buffer_load_dword v78, v124, s[20:23], s3 offen offset:1024 sc1
buffer_load_dword v79, v124, s[20:23], s3 offen offset:1536 sc1
buffer_load_dword v80, v124, s[20:23], s3 offen offset:2048 sc1
buffer_load_dword v81, v124, s[20:23], s3 offen offset:2560 sc1
buffer_load_dword v82, v124, s[20:23], s3 offen offset:3072 sc1
buffer_load_dword v83, v124, s[20:23], s3 offen offset:3584 sc1
buffer_load_dword v84, v124, s[20:23], s7 offen offset:0 sc1
buffer_load_dword v85, v124, s[20:23], s7 offen offset:512 sc1
buffer_load_dword v86, v124, s[20:23], s7 offen offset:1024 sc1
buffer_load_dword v87, v124, s[20:23], s7 offen offset:1536 sc1
buffer_load_dword v88, v124, s[20:23], s7 offen offset:2048 sc1
buffer_load_dword v89, v124, s[20:23], s7 offen offset:2560 sc1
s_lshl_b32 s3, s42, 11
s_lshl_b32 s7, s46, 7
s_add_u32 s3, s3, s7
buffer_load_ushort v90, v125, s[56:59], s3 offen
s_lshl_b32 s3, s42, 3
s_add_u32 s3, s3, 5259264
buffer_load_dwordx2 v[92:93], v126, s[20:23], s3 offen sc1
L_f_yl1:
s_lshl_b32 s7, s45, 2
s_add_u32 s7, s7, s32
s_lshr_b32 s3, s43, 5
s_cmp_lg_u32 s3, s7
s_cbranch_scc1 L_f_yl2
s_nop 0
s_add_u32 s3, s55, 256
s_add_u32 s7, s3, 4096
buffer_load_dword v94, v124, s[20:23], s3 offen offset:0 sc1
buffer_load_dword v95, v124, s[20:23], s3 offen offset:512 sc1
buffer_load_dword v96, v124, s[20:23], s3 offen offset:1024 sc1
buffer_load_dword v97, v124, s[20:23], s3 offen offset:1536 sc1
buffer_load_dword v98, v124, s[20:23], s3 offen offset:2048 sc1
buffer_load_dword v99, v124, s[20:23], s3 offen offset:2560 sc1
buffer_load_dword v100, v124, s[20:23], s3 offen offset:3072 sc1
buffer_load_dword v101, v124, s[20:23], s3 offen offset:3584 sc1
buffer_load_dword v102, v124, s[20:23], s7 offen offset:0 sc1
buffer_load_dword v103, v124, s[20:23], s7 offen offset:512 sc1
buffer_load_dword v104, v124, s[20:23], s7 offen offset:1024 sc1
buffer_load_dword v105, v124, s[20:23], s7 offen offset:1536 sc1
buffer_load_dword v106, v124, s[20:23], s7 offen offset:2048 sc1
buffer_load_dword v107, v124, s[20:23], s7 offen offset:2560 sc1
s_lshl_b32 s3, s43, 11
s_lshl_b32 s7, s46, 7
s_add_u32 s3, s3, s7
buffer_load_ushort v108, v125, s[56:59], s3 offen
s_lshl_b32 s3, s43, 3
s_add_u32 s3, s3, 5259264
buffer_load_dwordx2 v[110:111], v126, s[20:23], s3 offen sc1
L_f_yl2:
s_branch L_yBr
L_yC:
s_waitcnt vmcnt(1)
s_lshl_b32 s7, s45, 2
s_add_u32 s7, s7, s32
s_lshr_b32 s3, s42, 5
s_cmp_lg_u32 s3, s7
s_cbranch_scc1 L_f_ys3
s_nop 0
v_pk_add_f32 v[76:77], v[76:77], v[78:79]
v_pk_add_f32 v[76:77], v[76:77], v[80:81]
v_pk_add_f32 v[76:77], v[76:77], v[82:83]
v_pk_add_f32 v[76:77], v[76:77], v[84:85]
v_pk_add_f32 v[76:77], v[76:77], v[86:87]
v_pk_add_f32 v[76:77], v[76:77], v[88:89]
Va 76,76,77
v_lshlrev_b32 v90, 16, v90
v_sub_f32_e64 v90, v90, v92
Vc 76,76,76
v_lshlrev_b32_e64 v76, 16, v76
Vc 90,90,90
v_lshlrev_b32 v90, 16, v90
v_mul_f32 v76, s100, v76
v_mul_f32_e64 v90, v90, v93
Vc 76,76,76
v_lshlrev_b32_e64 v76, 16, v76
Vc 90,90,90
v_lshlrev_b32 v90, 16, v90
Va 90,90,76
Vc 90,90,90
v_lshlrev_b32_e64 v90, 16, v90
v_mul_f32 v76, 0xbfb8aa3b, v90
Ve 76,76
s_nop 0
v_add_f32 v76, 1.0, v76
v_rcp_f32 v76, v76
s_nop 0
Vm 90,90,76
Vc 90,90,90
v_lshlrev_b32 v90, 16, v90
v_lshlrev_b32 v124, 2, v0
v_add_u32 v124, s35, v124
v_lshlrev_b32 v125, 5, v122
v_add_u32 v125, s35, v125
s_waitcnt lgkmcnt(0)
ds_write_b32 v124, v90
s_and_b32 s3, s42, 7
s_lshl_b32 s3, s3, 3
s_lshl_b64 s[4:5], 0xff, s3
s_bfe_u32 s3, s42, 0x20003
s_mov_b64 exec, s[4:5]
s_cmp_lg_u32 s3, 0
s_cbranch_scc1 L_f_yp4
ds_read_b64 v[42:43], v125
ds_read_b64 v[44:45], v125 offset:8
ds_read_b64 v[46:47], v125 offset:16
ds_read_b64 v[48:49], v125 offset:24
L_f_yp4:
s_cmp_lg_u32 s3, 1
s_cbranch_scc1 L_f_yp5
ds_read_b64 v[50:51], v125
ds_read_b64 v[52:53], v125 offset:8
ds_read_b64 v[54:55], v125 offset:16
ds_read_b64 v[56:57], v125 offset:24
L_f_yp5:
s_cmp_lg_u32 s3, 2
s_cbranch_scc1 L_f_yp6
ds_read_b64 v[58:59], v125
ds_read_b64 v[60:61], v125 offset:8
ds_read_b64 v[62:63], v125 offset:16
ds_read_b64 v[64:65], v125 offset:24
L_f_yp6:
s_cmp_lg_u32 s3, 3
s_cbranch_scc1 L_f_yp7
ds_read_b64 v[66:67], v125
ds_read_b64 v[68:69], v125 offset:8
s_waitcnt lgkmcnt(9)
ds_read_b64 v[70:71], v125 offset:16
ds_read_b64 v[72:73], v125 offset:24
L_f_yp7:
s_mov_b64 exec, -1
s_waitcnt lgkmcnt(0)
L_f_ys3:
s_lshl_b32 s7, s45, 2
s_add_u32 s7, s7, s32
s_lshr_b32 s3, s43, 5
s_cmp_lg_u32 s3, s7
s_cbranch_scc1 L_f_ys8
s_nop 0
v_pk_add_f32 v[94:95], v[94:95], v[96:97]
v_pk_add_f32 v[94:95], v[94:95], v[98:99]
v_pk_add_f32 v[94:95], v[94:95], v[100:101]
v_pk_add_f32 v[94:95], v[94:95], v[102:103]
v_pk_add_f32 v[94:95], v[94:95], v[104:105]
v_pk_add_f32 v[94:95], v[94:95], v[106:107]
Va 94,94,95
v_lshlrev_b32 v108, 16, v108
v_sub_f32_e64 v108, v108, v110
Vc 94,94,94
v_lshlrev_b32_e64 v94, 16, v94
Vc 108,108,108
v_lshlrev_b32 v108, 16, v108
v_mul_f32 v94, s101, v94
v_mul_f32_e64 v108, v108, v111
Vc 94,94,94
v_lshlrev_b32_e64 v94, 16, v94
Vc 108,108,108
v_lshlrev_b32 v108, 16, v108
Va 108,108,94
Vc 108,108,108
v_lshlrev_b32_e64 v108, 16, v108
v_mul_f32 v94, 0xbfb8aa3b, v108
Ve 94,94
s_nop 0
v_add_f32 v94, 1.0, v94
v_rcp_f32 v94, v94
s_nop 0
Vm 108,108,94
Vc 108,108,108
v_lshlrev_b32 v108, 16, v108
v_lshlrev_b32 v124, 2, v0
v_add_u32 v124, s35, v124
v_lshlrev_b32 v125, 5, v122
v_add_u32 v125, s35, v125
s_waitcnt lgkmcnt(0)
ds_write_b32 v124, v108
s_and_b32 s3, s43, 7
s_lshl_b32 s3, s3, 3
s_lshl_b64 s[4:5], 0xff, s3
s_bfe_u32 s3, s43, 0x20003
s_mov_b64 exec, s[4:5]
s_cmp_lg_u32 s3, 0
s_cbranch_scc1 L_f_yp9
ds_read_b64 v[42:43], v125
ds_read_b64 v[44:45], v125 offset:8
ds_read_b64 v[46:47], v125 offset:16
ds_read_b64 v[48:49], v125 offset:24
L_f_yp9:
s_cmp_lg_u32 s3, 1
s_cbranch_scc1 L_f_yp10
ds_read_b64 v[50:51], v125
ds_read_b64 v[52:53], v125 offset:8
ds_read_b64 v[54:55], v125 offset:16
ds_read_b64 v[56:57], v125 offset:24
L_f_yp10:
s_cmp_lg_u32 s3, 2
s_cbranch_scc1 L_f_yp11
ds_read_b64 v[58:59], v125
ds_read_b64 v[60:61], v125 offset:8
ds_read_b64 v[62:63], v125 offset:16
ds_read_b64 v[64:65], v125 offset:24
L_f_yp11:
s_cmp_lg_u32 s3, 3
s_cbranch_scc1 L_f_yp12
ds_read_b64 v[66:67], v125
ds_read_b64 v[68:69], v125 offset:8
s_waitcnt lgkmcnt(9)
ds_read_b64 v[70:71], v125 offset:16
ds_read_b64 v[72:73], v125 offset:24
L_f_yp12:
s_mov_b64 exec, -1
s_waitcnt lgkmcnt(0)
L_f_ys8:
s_branch L_yCr
L_p4_end:
L_spinAk:
s_mov_b32 s47, 0x400000
L_spinAk_l:
s_sleep 8
buffer_load_dword v1, v7, s[28:31], 0 offen sc1
s_waitcnt vmcnt(0)
v_readfirstlane_b32 s3, v1
s_sub_u32 s47, s47, 1
s_cmp_eq_u32 s47, 0
s_cbranch_scc1 L_spinArk
s_cmp_lt_u32 s3, 256
s_cbranch_scc1 L_spinAk_l
s_branch L_spinArk
L_spinAv:
s_mov_b32 s47, 0x400000
L_spinAv_l:
s_sleep 8
buffer_load_dword v1, v7, s[28:31], 0 offen sc1
s_waitcnt vmcnt(0)
v_readfirstlane_b32 s3, v1
s_sub_u32 s47, s47, 1
s_cmp_eq_u32 s47, 0
s_cbranch_scc1 L_spinArv
s_cmp_lt_u32 s3, 256
s_cbranch_scc1 L_spinAv_l
s_branch L_spinArv
L_spinB:
s_mov_b32 s59, 0x400000
L_spinB_l:
s_sleep 4
buffer_load_dword v12, v1, s[20:23], s6 offen sc1
s_sub_u32 s59, s59, 1
s_cmp_eq_u32 s59, 0
s_cbranch_scc1 L_spinBx
s_waitcnt vmcnt(0)
v_cmp_ne_u32 vcc, 1, v12
s_cbranch_vccnz L_spinB_l
L_spinBx:
s_waitcnt vmcnt(0)
s_branch L_spinBr
L_k2_fb_we:
s_nop 7
s_nop 0
v_max3_f32 v21, v128, v129, v130
v_max3_f32 v21, v21, v131, v132
v_max3_f32 v21, v21, v133, v134
v_max3_f32 v21, v21, v135, v136
v_max3_f32 v21, v21, v137, v138
v_max3_f32 v21, v21, v139, v140
v_max3_f32 v21, v21, v141, v142
v_max_f32 v21, v21, v143
v_mov_b32 v1, v21
s_nop 1
v_permlane16_swap_b32 v1, v21
v_max_f32 v21, v21, v1
v_mov_b32 v1, v21
s_nop 1
v_permlane32_swap_b32 v1, v21
v_max_f32_e64 v21, v21, v1
v_add_f32 v21, 0x41f80000, v21
v_max_f32 v21, 0, v21
Vs 128,128,21
Vs 129,129,21
Vs 130,130,21
Vs 131,131,21
Vs 132,132,21
Vs 133,133,21
Vs 134,134,21
Vs 135,135,21
Vs 136,136,21
Vs 137,137,21
Vs 138,138,21
Vs 139,139,21
Vs 140,140,21
Vs 141,141,21
Vs 142,142,21
Vs 143,143,21
Vs 192,192,21
Vs 193,193,21
Vs 194,194,21
Vs 195,195,21
Vs 196,196,21
Vs 197,197,21
Vs 198,198,21
Vs 199,199,21
Vs 200,200,21
Vs 201,201,21
Vs 202,202,21
Vs 203,203,21
Vs 204,204,21
Vs 205,205,21
Vs 206,206,21
Vs 207,207,21
Vs 32,32,21
Vs 33,33,21
Vs 34,34,21
v_sub_f32_e64 v35, v35, v21
v_exp_f32 v22, -v21
s_nop 0
Vm 48,48,22
Vm 49,49,22
Vm 50,50,22
v_mul_f32_e64 v51, v51, v22
Ar 8,0
Ar 9,1
Ar 10,2
Ar 11,3
Ar 12,4
Ar 13,5
Ar 14,6
Ar 15,7
Vm 8,8,22
Vm 9,9,22
Vm 10,10,22
Vm 11,11,22
Vm 12,12,22
Vm 13,13,22
Vm 14,14,22
Vm 15,15,22
Aw 0,8
Aw 1,9
Aw 2,10
Aw 3,11
Aw 4,12
Aw 5,13
Aw 6,14
Aw 7,15
Ar 8,8
Ar 9,9
Ar 10,10
Ar 11,11
Ar 12,12
Ar 13,13
Ar 14,14
Ar 15,15
Vm 8,8,22
Vm 9,9,22
Vm 10,10,22
Vm 11,11,22
Vm 12,12,22
Vm 13,13,22
Vm 14,14,22
Vm 15,15,22
Aw 8,8
Aw 9,9
Aw 10,10
Aw 11,11
Aw 12,12
Aw 13,13
Aw 14,14
Aw 15,15
Ar 8,16
Ar 9,17
Ar 10,18
Ar 11,19
Ar 12,20
Ar 13,21
Ar 14,22
Ar 15,23
Vm 8,8,22
Vm 9,9,22
Vm 10,10,22
Vm 11,11,22
Vm 12,12,22
Vm 13,13,22
Vm 14,14,22
Vm 15,15,22
Aw 16,8
Aw 17,9
Aw 18,10
Aw 19,11
Aw 20,12
Aw 21,13
Aw 22,14
Aw 23,15
Ar 8,24
Ar 9,25
Ar 10,26
Ar 11,27
Ar 12,28
Ar 13,29
Ar 14,30
Ar 15,31
Vm 8,8,22
Vm 9,9,22
Vm 10,10,22
Vm 11,11,22
Vm 12,12,22
Vm 13,13,22
Vm 14,14,22
Vm 15,15,22
Aw 24,8
Aw 25,9
Aw 26,10
Aw 27,11
Aw 28,12
Aw 29,13
Aw 30,14
Aw 31,15
v_max3_f32 v21, v144, v145, v146
v_max3_f32 v21, v21, v147, v148
v_max3_f32 v21, v21, v149, v150
v_max3_f32 v21, v21, v151, v152
v_max3_f32 v21, v21, v153, v154
v_max3_f32 v21, v21, v155, v156
v_max3_f32 v21, v21, v157, v158
v_max_f32 v21, v21, v159
v_mov_b32 v1, v21
s_nop 1
v_permlane16_swap_b32 v1, v21
v_max_f32 v21, v21, v1
v_mov_b32 v1, v21
s_nop 1
v_permlane32_swap_b32 v1, v21
v_max_f32_e64 v21, v21, v1
v_add_f32 v21, 0x41f80000, v21
v_max_f32 v21, 0, v21
Vs 144,144,21
Vs 145,145,21
Vs 146,146,21
Vs 147,147,21
Vs 148,148,21
Vs 149,149,21
Vs 150,150,21
Vs 151,151,21
Vs 152,152,21
Vs 153,153,21
Vs 154,154,21
Vs 155,155,21
Vs 156,156,21
Vs 157,157,21
Vs 158,158,21
Vs 159,159,21
Vs 208,208,21
Vs 209,209,21
Vs 210,210,21
Vs 211,211,21
Vs 212,212,21
Vs 213,213,21
Vs 214,214,21
Vs 215,215,21
Vs 216,216,21
Vs 217,217,21
Vs 218,218,21
Vs 219,219,21
Vs 220,220,21
Vs 221,221,21
Vs 222,222,21
Vs 223,223,21
Vs 36,36,21
Vs 37,37,21
Vs 38,38,21
v_sub_f32_e64 v39, v39, v21
v_exp_f32 v22, -v21
s_nop 0
Vm 52,52,22
Vm 53,53,22
Vm 54,54,22
v_mul_f32_e64 v55, v55, v22
Ar 8,32
Ar 9,33
Ar 10,34
Ar 11,35
Ar 12,36
Ar 13,37
Ar 14,38
Ar 15,39
Vm 8,8,22
Vm 9,9,22
Vm 10,10,22
Vm 11,11,22
Vm 12,12,22
Vm 13,13,22
Vm 14,14,22
Vm 15,15,22
Aw 32,8
Aw 33,9
Aw 34,10
Aw 35,11
Aw 36,12
Aw 37,13
Aw 38,14
Aw 39,15
Ar 8,40
Ar 9,41
Ar 10,42
Ar 11,43
Ar 12,44
Ar 13,45
Ar 14,46
Ar 15,47
Vm 8,8,22
Vm 9,9,22
Vm 10,10,22
Vm 11,11,22
Vm 12,12,22
Vm 13,13,22
Vm 14,14,22
Vm 15,15,22
Aw 40,8
Aw 41,9
Aw 42,10
Aw 43,11
Aw 44,12
Aw 45,13
Aw 46,14
Aw 47,15
Ar 8,48
Ar 9,49
Ar 10,50
Ar 11,51
Ar 12,52
Ar 13,53
Ar 14,54
Ar 15,55
Vm 8,8,22
Vm 9,9,22
Vm 10,10,22
Vm 11,11,22
Vm 12,12,22
Vm 13,13,22
Vm 14,14,22
Vm 15,15,22
Aw 48,8
Aw 49,9
Aw 50,10
Aw 51,11
Aw 52,12
Aw 53,13
Aw 54,14
Aw 55,15
Ar 8,56
Ar 9,57
Ar 10,58
Ar 11,59
Ar 12,60
Ar 13,61
Ar 14,62
Ar 15,63
Vm 8,8,22
Vm 9,9,22
Vm 10,10,22
Vm 11,11,22
Vm 12,12,22
Vm 13,13,22
Vm 14,14,22
Vm 15,15,22
Aw 56,8
Aw 57,9
Aw 58,10
Aw 59,11
Aw 60,12
Aw 61,13
Aw 62,14
Aw 63,15
v_max3_f32 v21, v160, v161, v162
v_max3_f32 v21, v21, v163, v164
v_max3_f32 v21, v21, v165, v166
v_max3_f32 v21, v21, v167, v168
v_max3_f32 v21, v21, v169, v170
v_max3_f32 v21, v21, v171, v172
v_max3_f32 v21, v21, v173, v174
v_max_f32 v21, v21, v175
v_mov_b32 v1, v21
s_nop 1
v_permlane16_swap_b32 v1, v21
v_max_f32 v21, v21, v1
v_mov_b32 v1, v21
s_nop 1
v_permlane32_swap_b32 v1, v21
v_max_f32_e64 v21, v21, v1
v_add_f32 v21, 0x41f80000, v21
v_max_f32 v21, 0, v21
Vs 160,160,21
Vs 161,161,21
Vs 162,162,21
Vs 163,163,21
Vs 164,164,21
Vs 165,165,21
Vs 166,166,21
Vs 167,167,21
Vs 168,168,21
Vs 169,169,21
Vs 170,170,21
Vs 171,171,21
Vs 172,172,21
Vs 173,173,21
Vs 174,174,21
Vs 175,175,21
Vs 224,224,21
Vs 225,225,21
Vs 226,226,21
Vs 227,227,21
Vs 228,228,21
Vs 229,229,21
Vs 230,230,21
Vs 231,231,21
Vs 232,232,21
Vs 233,233,21
Vs 234,234,21
Vs 235,235,21
Vs 236,236,21
Vs 237,237,21
Vs 238,238,21
Vs 239,239,21
Vs 40,40,21
Vs 41,41,21
Vs 42,42,21
v_sub_f32_e64 v43, v43, v21
v_exp_f32 v22, -v21
s_nop 0
Vm 56,56,22
Vm 57,57,22
Vm 58,58,22
v_mul_f32_e64 v59, v59, v22
Ar 8,64
Ar 9,65
Ar 10,66
Ar 11,67
Ar 12,68
Ar 13,69
Ar 14,70
Ar 15,71
Vm 8,8,22
Vm 9,9,22
Vm 10,10,22
Vm 11,11,22
Vm 12,12,22
Vm 13,13,22
Vm 14,14,22
Vm 15,15,22
Aw 64,8
Aw 65,9
Aw 66,10
Aw 67,11
Aw 68,12
Aw 69,13
Aw 70,14
Aw 71,15
Ar 8,72
Ar 9,73
Ar 10,74
Ar 11,75
Ar 12,76
Ar 13,77
Ar 14,78
Ar 15,79
Vm 8,8,22
Vm 9,9,22
Vm 10,10,22
Vm 11,11,22
Vm 12,12,22
Vm 13,13,22
Vm 14,14,22
Vm 15,15,22
Aw 72,8
Aw 73,9
Aw 74,10
Aw 75,11
Aw 76,12
Aw 77,13
Aw 78,14
Aw 79,15
Ar 8,80
Ar 9,81
Ar 10,82
Ar 11,83
Ar 12,84
Ar 13,85
Ar 14,86
Ar 15,87
Vm 8,8,22
Vm 9,9,22
Vm 10,10,22
Vm 11,11,22
Vm 12,12,22
Vm 13,13,22
Vm 14,14,22
Vm 15,15,22
Aw 80,8
Aw 81,9
Aw 82,10
Aw 83,11
Aw 84,12
Aw 85,13
Aw 86,14
Aw 87,15
Ar 8,88
Ar 9,89
Ar 10,90
Ar 11,91
Ar 12,92
Ar 13,93
Ar 14,94
Ar 15,95
Vm 8,8,22
Vm 9,9,22
Vm 10,10,22
Vm 11,11,22
Vm 12,12,22
Vm 13,13,22
Vm 14,14,22
Vm 15,15,22
Aw 88,8
Aw 89,9
Aw 90,10
Aw 91,11
Aw 92,12
Aw 93,13
Aw 94,14
Aw 95,15
v_max3_f32 v21, v176, v177, v178
v_max3_f32 v21, v21, v179, v180
v_max3_f32 v21, v21, v181, v182
v_max3_f32 v21, v21, v183, v184
v_max3_f32 v21, v21, v185, v186
v_max3_f32 v21, v21, v187, v188
v_max3_f32 v21, v21, v189, v190
v_max_f32 v21, v21, v191
v_mov_b32 v1, v21
s_nop 1
v_permlane16_swap_b32 v1, v21
v_max_f32 v21, v21, v1
v_mov_b32 v1, v21
s_nop 1
v_permlane32_swap_b32 v1, v21
v_max_f32_e64 v21, v21, v1
v_add_f32 v21, 0x41f80000, v21
v_max_f32 v21, 0, v21
Vs 176,176,21
Vs 177,177,21
Vs 178,178,21
Vs 179,179,21
Vs 180,180,21
Vs 181,181,21
Vs 182,182,21
Vs 183,183,21
Vs 184,184,21
Vs 185,185,21
Vs 186,186,21
Vs 187,187,21
Vs 188,188,21
Vs 189,189,21
Vs 190,190,21
Vs 191,191,21
Vs 240,240,21
Vs 241,241,21
Vs 242,242,21
Vs 243,243,21
Vs 244,244,21
Vs 245,245,21
Vs 246,246,21
Vs 247,247,21
Vs 248,248,21
Vs 249,249,21
Vs 250,250,21
Vs 251,251,21
Vs 252,252,21
Vs 253,253,21
Vs 254,254,21
Vs 255,255,21
Vs 44,44,21
Vs 45,45,21
Vs 46,46,21
v_sub_f32_e64 v47, v47, v21
v_exp_f32 v22, -v21
s_nop 0
Vm 60,60,22
Vm 61,61,22
Vm 62,62,22
v_mul_f32_e64 v63, v63, v22
Ar 8,96
Ar 9,97
Ar 10,98
Ar 11,99
Ar 12,100
Ar 13,101
Ar 14,102
Ar 15,103
Vm 8,8,22
Vm 9,9,22
Vm 10,10,22
Vm 11,11,22
Vm 12,12,22
Vm 13,13,22
Vm 14,14,22
Vm 15,15,22
Aw 96,8
Aw 97,9
Aw 98,10
Aw 99,11
Aw 100,12
Aw 101,13
Aw 102,14
Aw 103,15
Ar 8,104
Ar 9,105
Ar 10,106
Ar 11,107
Ar 12,108
Ar 13,109
Ar 14,110
Ar 15,111
Vm 8,8,22
Vm 9,9,22
Vm 10,10,22
Vm 11,11,22
Vm 12,12,22
Vm 13,13,22
Vm 14,14,22
Vm 15,15,22
Aw 104,8
Aw 105,9
Aw 106,10
Aw 107,11
Aw 108,12
Aw 109,13
Aw 110,14
Aw 111,15
Ar 8,112
Ar 9,113
Ar 10,114
Ar 11,115
Ar 12,116
Ar 13,117
Ar 14,118
Ar 15,119
Vm 8,8,22
Vm 9,9,22
Vm 10,10,22
Vm 11,11,22
Vm 12,12,22
Vm 13,13,22
Vm 14,14,22
Vm 15,15,22
Aw 112,8
Aw 113,9
Aw 114,10
Aw 115,11
Aw 116,12
Aw 117,13
Aw 118,14
Aw 119,15
Ar 8,120
Ar 9,121
Ar 10,122
Ar 11,123
Ar 12,124
Ar 13,125
Ar 14,126
Ar 15,127
Vm 8,8,22
Vm 9,9,22
Vm 10,10,22
Vm 11,11,22
Vm 12,12,22
Vm 13,13,22
Vm 14,14,22
Vm 15,15,22
Aw 120,8
Aw 121,9
Aw 122,10
Aw 123,11
Aw 124,12
Aw 125,13
Aw 126,14
Aw 127,15
Ve 8,128
Ve 9,129
s_nop 0
Vc 64,8,9
Ve 8,130
Ve 9,131
s_nop 0
Vc 65,8,9
Ve 8,144
Ve 9,145
s_nop 0
Vc 72,8,9
Ve 8,146
Ve 9,147
s_nop 0
Vc 73,8,9
Ve 8,160
Ve 9,161
s_nop 0
Vc 80,8,9
Ve 8,162
Ve 9,163
s_nop 0
Vc 81,8,9
Ve 8,176
Ve 9,177
s_nop 0
Vc 88,8,9
Ve 8,178
Ve 9,179
s_nop 0
Vc 89,8,9
Ve 8,132
Ve 9,133
s_nop 0
Vc 66,8,9
Ve 8,134
Ve 9,135
s_nop 0
Vc 67,8,9
Ve 8,148
Ve 9,149
s_nop 0
Vc 74,8,9
Ve 8,150
Ve 9,151
s_nop 0
Vc 75,8,9
Ve 8,164
Ve 9,165
s_nop 0
Vc 82,8,9
Ve 8,166
Ve 9,167
s_nop 0
Vc 83,8,9
Ve 8,180
Ve 9,181
s_nop 0
Vc 90,8,9
Ve 8,182
Ve 9,183
s_nop 0
Vc 91,8,9
Ve 8,136
Ve 9,137
s_nop 0
Vc 68,8,9
Ve 8,138
Ve 9,139
s_nop 0
Vc 69,8,9
Ve 8,152
Ve 9,153
s_nop 0
Vc 76,8,9
Ve 8,154
Ve 9,155
s_nop 0
Vc 77,8,9
Ve 8,168
Ve 9,169
s_nop 0
Vc 84,8,9
Ve 8,170
Ve 9,171
s_nop 0
Vc 85,8,9
Ve 8,184
Ve 9,185
s_nop 0
Vc 92,8,9
Ve 8,186
Ve 9,187
s_nop 0
Vc 93,8,9
Ve 8,140
Ve 9,141
s_nop 0
Vc 70,8,9
Ve 8,142
Ve 9,143
s_nop 0
Vc 71,8,9
Ve 8,156
Ve 9,157
s_nop 0
Vc 78,8,9
Ve 8,158
Ve 9,159
s_nop 0
Vc 79,8,9
Ve 8,172
Ve 9,173
s_nop 0
Vc 86,8,9
Ve 8,174
Ve 9,175
s_nop 0
Vc 87,8,9
Ve 8,188
Ve 9,189
s_nop 0
Vc 94,8,9
Ve 8,190
Ve 9,191
s_nop 0
Vc 95,8,9
s_nop 1
s_branch L_k2_fbr_we
L_k2_fb_wo:
s_nop 7
s_nop 0
v_max3_f32 v21, v192, v193, v194
v_max3_f32 v21, v21, v195, v196
v_max3_f32 v21, v21, v197, v198
v_max3_f32 v21, v21, v199, v200
v_max3_f32 v21, v21, v201, v202
v_max3_f32 v21, v21, v203, v204
v_max3_f32 v21, v21, v205, v206
v_max_f32 v21, v21, v207
v_mov_b32 v1, v21
s_nop 1
v_permlane16_swap_b32 v1, v21
v_max_f32 v21, v21, v1
v_mov_b32 v1, v21
s_nop 1
v_permlane32_swap_b32 v1, v21
v_max_f32_e64 v21, v21, v1
v_add_f32 v21, 0x41f80000, v21
v_max_f32 v21, 0, v21
Vs 192,192,21
Vs 193,193,21
Vs 194,194,21
Vs 195,195,21
Vs 196,196,21
Vs 197,197,21
Vs 198,198,21
Vs 199,199,21
Vs 200,200,21
Vs 201,201,21
Vs 202,202,21
Vs 203,203,21
Vs 204,204,21
Vs 205,205,21
Vs 206,206,21
Vs 207,207,21
Vs 128,128,21
Vs 129,129,21
Vs 130,130,21
Vs 131,131,21
Vs 132,132,21
Vs 133,133,21
Vs 134,134,21
Vs 135,135,21
Vs 136,136,21
Vs 137,137,21
Vs 138,138,21
Vs 139,139,21
Vs 140,140,21
Vs 141,141,21
Vs 142,142,21
Vs 143,143,21
Vs 32,32,21
Vs 33,33,21
Vs 34,34,21
v_sub_f32_e64 v35, v35, v21
v_exp_f32 v22, -v21
s_nop 0
Vm 48,48,22
Vm 49,49,22
Vm 50,50,22
v_mul_f32_e64 v51, v51, v22
Ar 8,0
Ar 9,1
Ar 10,2
Ar 11,3
Ar 12,4
Ar 13,5
Ar 14,6
Ar 15,7
Vm 8,8,22
Vm 9,9,22
Vm 10,10,22
Vm 11,11,22
Vm 12,12,22
Vm 13,13,22
Vm 14,14,22
Vm 15,15,22
Aw 0,8
Aw 1,9
Aw 2,10
Aw 3,11
Aw 4,12
Aw 5,13
Aw 6,14
Aw 7,15
Ar 8,8
Ar 9,9
Ar 10,10
Ar 11,11
Ar 12,12
Ar 13,13
Ar 14,14
Ar 15,15
Vm 8,8,22
Vm 9,9,22
Vm 10,10,22
Vm 11,11,22
Vm 12,12,22
Vm 13,13,22
Vm 14,14,22
Vm 15,15,22
Aw 8,8
Aw 9,9
Aw 10,10
Aw 11,11
Aw 12,12
Aw 13,13
Aw 14,14
Aw 15,15
Ar 8,16
Ar 9,17
Ar 10,18
Ar 11,19
Ar 12,20
Ar 13,21
Ar 14,22
Ar 15,23
Vm 8,8,22
Vm 9,9,22
Vm 10,10,22
Vm 11,11,22
Vm 12,12,22
Vm 13,13,22
Vm 14,14,22
Vm 15,15,22
Aw 16,8
Aw 17,9
Aw 18,10
Aw 19,11
Aw 20,12
Aw 21,13
Aw 22,14
Aw 23,15
Ar 8,24
Ar 9,25
Ar 10,26
Ar 11,27
Ar 12,28
Ar 13,29
Ar 14,30
Ar 15,31
Vm 8,8,22
Vm 9,9,22
Vm 10,10,22
Vm 11,11,22
Vm 12,12,22
Vm 13,13,22
Vm 14,14,22
Vm 15,15,22
Aw 24,8
Aw 25,9
Aw 26,10
Aw 27,11
Aw 28,12
Aw 29,13
Aw 30,14
Aw 31,15
v_max3_f32 v21, v208, v209, v210
v_max3_f32 v21, v21, v211, v212
v_max3_f32 v21, v21, v213, v214
v_max3_f32 v21, v21, v215, v216
v_max3_f32 v21, v21, v217, v218
v_max3_f32 v21, v21, v219, v220
v_max3_f32 v21, v21, v221, v222
v_max_f32 v21, v21, v223
v_mov_b32 v1, v21
s_nop 1
v_permlane16_swap_b32 v1, v21
v_max_f32 v21, v21, v1
v_mov_b32 v1, v21
s_nop 1
v_permlane32_swap_b32 v1, v21
v_max_f32_e64 v21, v21, v1
v_add_f32 v21, 0x41f80000, v21
v_max_f32 v21, 0, v21
Vs 208,208,21
Vs 209,209,21
Vs 210,210,21
Vs 211,211,21
Vs 212,212,21
Vs 213,213,21
Vs 214,214,21
Vs 215,215,21
Vs 216,216,21
Vs 217,217,21
Vs 218,218,21
Vs 219,219,21
Vs 220,220,21
Vs 221,221,21
Vs 222,222,21
Vs 223,223,21
Vs 144,144,21
Vs 145,145,21
Vs 146,146,21
Vs 147,147,21
Vs 148,148,21
Vs 149,149,21
Vs 150,150,21
Vs 151,151,21
Vs 152,152,21
Vs 153,153,21
Vs 154,154,21
Vs 155,155,21
Vs 156,156,21
Vs 157,157,21
Vs 158,158,21
Vs 159,159,21
Vs 36,36,21
Vs 37,37,21
Vs 38,38,21
v_sub_f32_e64 v39, v39, v21
v_exp_f32 v22, -v21
s_nop 0
Vm 52,52,22
Vm 53,53,22
Vm 54,54,22
v_mul_f32_e64 v55, v55, v22
Ar 8,32
Ar 9,33
Ar 10,34
Ar 11,35
Ar 12,36
Ar 13,37
Ar 14,38
Ar 15,39
Vm 8,8,22
Vm 9,9,22
Vm 10,10,22
Vm 11,11,22
Vm 12,12,22
Vm 13,13,22
Vm 14,14,22
Vm 15,15,22
Aw 32,8
Aw 33,9
Aw 34,10
Aw 35,11
Aw 36,12
Aw 37,13
Aw 38,14
Aw 39,15
Ar 8,40
Ar 9,41
Ar 10,42
Ar 11,43
Ar 12,44
Ar 13,45
Ar 14,46
Ar 15,47
Vm 8,8,22
Vm 9,9,22
Vm 10,10,22
Vm 11,11,22
Vm 12,12,22
Vm 13,13,22
Vm 14,14,22
Vm 15,15,22
Aw 40,8
Aw 41,9
Aw 42,10
Aw 43,11
Aw 44,12
Aw 45,13
Aw 46,14
Aw 47,15
Ar 8,48
Ar 9,49
Ar 10,50
Ar 11,51
Ar 12,52
Ar 13,53
Ar 14,54
Ar 15,55
Vm 8,8,22
Vm 9,9,22
Vm 10,10,22
Vm 11,11,22
Vm 12,12,22
Vm 13,13,22
Vm 14,14,22
Vm 15,15,22
Aw 48,8
Aw 49,9
Aw 50,10
Aw 51,11
Aw 52,12
Aw 53,13
Aw 54,14
Aw 55,15
Ar 8,56
Ar 9,57
Ar 10,58
Ar 11,59
Ar 12,60
Ar 13,61
Ar 14,62
Ar 15,63
Vm 8,8,22
Vm 9,9,22
Vm 10,10,22
Vm 11,11,22
Vm 12,12,22
Vm 13,13,22
Vm 14,14,22
Vm 15,15,22
Aw 56,8
Aw 57,9
Aw 58,10
Aw 59,11
Aw 60,12
Aw 61,13
Aw 62,14
Aw 63,15
v_max3_f32 v21, v224, v225, v226
v_max3_f32 v21, v21, v227, v228
v_max3_f32 v21, v21, v229, v230
v_max3_f32 v21, v21, v231, v232
v_max3_f32 v21, v21, v233, v234
v_max3_f32 v21, v21, v235, v236
v_max3_f32 v21, v21, v237, v238
v_max_f32 v21, v21, v239
v_mov_b32 v1, v21
s_nop 1
v_permlane16_swap_b32 v1, v21
v_max_f32 v21, v21, v1
v_mov_b32 v1, v21
s_nop 1
v_permlane32_swap_b32 v1, v21
v_max_f32_e64 v21, v21, v1
v_add_f32 v21, 0x41f80000, v21
v_max_f32 v21, 0, v21
Vs 224,224,21
Vs 225,225,21
Vs 226,226,21
Vs 227,227,21
Vs 228,228,21
Vs 229,229,21
Vs 230,230,21
Vs 231,231,21
Vs 232,232,21
Vs 233,233,21
Vs 234,234,21
Vs 235,235,21
Vs 236,236,21
Vs 237,237,21
Vs 238,238,21
Vs 239,239,21
Vs 160,160,21
Vs 161,161,21
Vs 162,162,21
Vs 163,163,21
Vs 164,164,21
Vs 165,165,21
Vs 166,166,21
Vs 167,167,21
Vs 168,168,21
Vs 169,169,21
Vs 170,170,21
Vs 171,171,21
Vs 172,172,21
Vs 173,173,21
Vs 174,174,21
Vs 175,175,21
Vs 40,40,21
Vs 41,41,21
Vs 42,42,21
v_sub_f32_e64 v43, v43, v21
v_exp_f32 v22, -v21
s_nop 0
Vm 56,56,22
Vm 57,57,22
Vm 58,58,22
v_mul_f32_e64 v59, v59, v22
Ar 8,64
Ar 9,65
Ar 10,66
Ar 11,67
Ar 12,68
Ar 13,69
Ar 14,70
Ar 15,71
Vm 8,8,22
Vm 9,9,22
Vm 10,10,22
Vm 11,11,22
Vm 12,12,22
Vm 13,13,22
Vm 14,14,22
Vm 15,15,22
Aw 64,8
Aw 65,9
Aw 66,10
Aw 67,11
Aw 68,12
Aw 69,13
Aw 70,14
Aw 71,15
Ar 8,72
Ar 9,73
Ar 10,74
Ar 11,75
Ar 12,76
Ar 13,77
Ar 14,78
Ar 15,79
Vm 8,8,22
Vm 9,9,22
Vm 10,10,22
Vm 11,11,22
Vm 12,12,22
Vm 13,13,22
Vm 14,14,22
Vm 15,15,22
Aw 72,8
Aw 73,9
Aw 74,10
Aw 75,11
Aw 76,12
Aw 77,13
Aw 78,14
Aw 79,15
Ar 8,80
Ar 9,81
Ar 10,82
Ar 11,83
Ar 12,84
Ar 13,85
Ar 14,86
Ar 15,87
Vm 8,8,22
Vm 9,9,22
Vm 10,10,22
Vm 11,11,22
Vm 12,12,22
Vm 13,13,22
Vm 14,14,22
Vm 15,15,22
Aw 80,8
Aw 81,9
Aw 82,10
Aw 83,11
Aw 84,12
Aw 85,13
Aw 86,14
Aw 87,15
Ar 8,88
Ar 9,89
Ar 10,90
Ar 11,91
Ar 12,92
Ar 13,93
Ar 14,94
Ar 15,95
Vm 8,8,22
Vm 9,9,22
Vm 10,10,22
Vm 11,11,22
Vm 12,12,22
Vm 13,13,22
Vm 14,14,22
Vm 15,15,22
Aw 88,8
Aw 89,9
Aw 90,10
Aw 91,11
Aw 92,12
Aw 93,13
Aw 94,14
Aw 95,15
v_max3_f32 v21, v240, v241, v242
v_max3_f32 v21, v21, v243, v244
v_max3_f32 v21, v21, v245, v246
v_max3_f32 v21, v21, v247, v248
v_max3_f32 v21, v21, v249, v250
v_max3_f32 v21, v21, v251, v252
v_max3_f32 v21, v21, v253, v254
v_max_f32 v21, v21, v255
v_mov_b32 v1, v21
s_nop 1
v_permlane16_swap_b32 v1, v21
v_max_f32 v21, v21, v1
v_mov_b32 v1, v21
s_nop 1
v_permlane32_swap_b32 v1, v21
v_max_f32_e64 v21, v21, v1
v_add_f32 v21, 0x41f80000, v21
v_max_f32 v21, 0, v21
Vs 240,240,21
Vs 241,241,21
Vs 242,242,21
Vs 243,243,21
Vs 244,244,21
Vs 245,245,21
Vs 246,246,21
Vs 247,247,21
Vs 248,248,21
Vs 249,249,21
Vs 250,250,21
Vs 251,251,21
Vs 252,252,21
Vs 253,253,21
Vs 254,254,21
Vs 255,255,21
Vs 176,176,21
Vs 177,177,21
Vs 178,178,21
Vs 179,179,21
Vs 180,180,21
Vs 181,181,21
Vs 182,182,21
Vs 183,183,21
Vs 184,184,21
Vs 185,185,21
Vs 186,186,21
Vs 187,187,21
Vs 188,188,21
Vs 189,189,21
Vs 190,190,21
Vs 191,191,21
Vs 44,44,21
Vs 45,45,21
Vs 46,46,21
v_sub_f32_e64 v47, v47, v21
v_exp_f32 v22, -v21
s_nop 0
Vm 60,60,22
Vm 61,61,22
Vm 62,62,22
v_mul_f32_e64 v63, v63, v22
Ar 8,96
Ar 9,97
Ar 10,98
Ar 11,99
Ar 12,100
Ar 13,101
Ar 14,102
Ar 15,103
Vm 8,8,22
Vm 9,9,22
Vm 10,10,22
Vm 11,11,22
Vm 12,12,22
Vm 13,13,22
Vm 14,14,22
Vm 15,15,22
Aw 96,8
Aw 97,9
Aw 98,10
Aw 99,11
Aw 100,12
Aw 101,13
Aw 102,14
Aw 103,15
Ar 8,104
Ar 9,105
Ar 10,106
Ar 11,107
Ar 12,108
Ar 13,109
Ar 14,110
Ar 15,111
Vm 8,8,22
Vm 9,9,22
Vm 10,10,22
Vm 11,11,22
Vm 12,12,22
Vm 13,13,22
Vm 14,14,22
Vm 15,15,22
Aw 104,8
Aw 105,9
Aw 106,10
Aw 107,11
Aw 108,12
Aw 109,13
Aw 110,14
Aw 111,15
Ar 8,112
Ar 9,113
Ar 10,114
Ar 11,115
Ar 12,116
Ar 13,117
Ar 14,118
Ar 15,119
Vm 8,8,22
Vm 9,9,22
Vm 10,10,22
Vm 11,11,22
Vm 12,12,22
Vm 13,13,22
Vm 14,14,22
Vm 15,15,22
Aw 112,8
Aw 113,9
Aw 114,10
Aw 115,11
Aw 116,12
Aw 117,13
Aw 118,14
Aw 119,15
Ar 8,120
Ar 9,121
Ar 10,122
Ar 11,123
Ar 12,124
Ar 13,125
Ar 14,126
Ar 15,127
Vm 8,8,22
Vm 9,9,22
Vm 10,10,22
Vm 11,11,22
Vm 12,12,22
Vm 13,13,22
Vm 14,14,22
Vm 15,15,22
Aw 120,8
Aw 121,9
Aw 122,10
Aw 123,11
Aw 124,12
Aw 125,13
Aw 126,14
Aw 127,15
Ve 8,192
Ve 9,193
s_nop 0
Vc 96,8,9
Ve 8,194
Ve 9,195
s_nop 0
Vc 97,8,9
Ve 8,208
Ve 9,209
s_nop 0
Vc 104,8,9
Ve 8,210
Ve 9,211
s_nop 0
Vc 105,8,9
Ve 8,224
Ve 9,225
s_nop 0
Vc 112,8,9
Ve 8,226
Ve 9,227
s_nop 0
Vc 113,8,9
Ve 8,240
Ve 9,241
s_nop 0
Vc 120,8,9
Ve 8,242
Ve 9,243
s_nop 0
Vc 121,8,9
Ve 8,196
Ve 9,197
s_nop 0
Vc 98,8,9
Ve 8,198
Ve 9,199
s_nop 0
Vc 99,8,9
Ve 8,212
Ve 9,213
s_nop 0
Vc 106,8,9
Ve 8,214
Ve 9,215
s_nop 0
Vc 107,8,9
Ve 8,228
Ve 9,229
s_nop 0
Vc 114,8,9
Ve 8,230
Ve 9,231
s_nop 0
Vc 115,8,9
Ve 8,244
Ve 9,245
s_nop 0
Vc 122,8,9
Ve 8,246
Ve 9,247
s_nop 0
Vc 123,8,9
Ve 8,200
Ve 9,201
s_nop 0
Vc 100,8,9
Ve 8,202
Ve 9,203
s_nop 0
Vc 101,8,9
Ve 8,216
Ve 9,217
s_nop 0
Vc 108,8,9
Ve 8,218
Ve 9,219
s_nop 0
Vc 109,8,9
Ve 8,232
Ve 9,233
s_nop 0
Vc 116,8,9
Ve 8,234
Ve 9,235
s_nop 0
Vc 117,8,9
Ve 8,248
Ve 9,249
s_nop 0
Vc 124,8,9
Ve 8,250
Ve 9,251
s_nop 0
Vc 125,8,9
Ve 8,204
Ve 9,205
s_nop 0
Vc 102,8,9
Ve 8,206
Ve 9,207
s_nop 0
Vc 103,8,9
Ve 8,220
Ve 9,221
s_nop 0
Vc 110,8,9
Ve 8,222
Ve 9,223
s_nop 0
Vc 111,8,9
Ve 8,236
Ve 9,237
s_nop 0
Vc 118,8,9
Ve 8,238
Ve 9,239
s_nop 0
Vc 119,8,9
Ve 8,252
Ve 9,253
s_nop 0
Vc 126,8,9
Ve 8,254
Ve 9,255
s_nop 0
Vc 127,8,9
s_nop 1
s_branch L_k2_fbr_wo
L_k2_fb_wl:
s_nop 7
s_nop 0
v_max3_f32 v21, v128, v129, v130
v_max3_f32 v21, v21, v131, v132
v_max3_f32 v21, v21, v133, v134
v_max3_f32 v21, v21, v135, v136
v_max3_f32 v21, v21, v137, v138
v_max3_f32 v21, v21, v139, v140
v_max3_f32 v21, v21, v141, v142
v_max_f32 v21, v21, v143
v_mov_b32 v1, v21
s_nop 1
v_permlane16_swap_b32 v1, v21
v_max_f32 v21, v21, v1
v_mov_b32 v1, v21
s_nop 1
v_permlane32_swap_b32 v1, v21
v_max_f32_e64 v21, v21, v1
v_add_f32 v21, 0x41f80000, v21
v_max_f32 v21, 0, v21
Vs 128,128,21
Vs 129,129,21
Vs 130,130,21
Vs 131,131,21
Vs 132,132,21
Vs 133,133,21
Vs 134,134,21
Vs 135,135,21
Vs 136,136,21
Vs 137,137,21
Vs 138,138,21
Vs 139,139,21
Vs 140,140,21
Vs 141,141,21
Vs 142,142,21
Vs 143,143,21
Vs 192,192,21
Vs 193,193,21
Vs 194,194,21
Vs 195,195,21
Vs 196,196,21
Vs 197,197,21
Vs 198,198,21
Vs 199,199,21
Vs 200,200,21
Vs 201,201,21
Vs 202,202,21
Vs 203,203,21
Vs 204,204,21
Vs 205,205,21
Vs 206,206,21
Vs 207,207,21
Vs 32,32,21
Vs 33,33,21
Vs 34,34,21
v_sub_f32_e64 v35, v35, v21
v_exp_f32 v22, -v21
s_nop 0
Vm 48,48,22
Vm 49,49,22
Vm 50,50,22
v_mul_f32_e64 v51, v51, v22
Ar 8,0
Ar 9,1
Ar 10,2
Ar 11,3
Ar 12,4
Ar 13,5
Ar 14,6
Ar 15,7
Vm 8,8,22
Vm 9,9,22
Vm 10,10,22
Vm 11,11,22
Vm 12,12,22
Vm 13,13,22
Vm 14,14,22
Vm 15,15,22
Aw 0,8
Aw 1,9
Aw 2,10
Aw 3,11
Aw 4,12
Aw 5,13
Aw 6,14
Aw 7,15
Ar 8,8
Ar 9,9
Ar 10,10
Ar 11,11
Ar 12,12
Ar 13,13
Ar 14,14
Ar 15,15
Vm 8,8,22
Vm 9,9,22
Vm 10,10,22
Vm 11,11,22
Vm 12,12,22
Vm 13,13,22
Vm 14,14,22
Vm 15,15,22
Aw 8,8
Aw 9,9
Aw 10,10
Aw 11,11
Aw 12,12
Aw 13,13
Aw 14,14
Aw 15,15
Ar 8,16
Ar 9,17
Ar 10,18
Ar 11,19
Ar 12,20
Ar 13,21
Ar 14,22
Ar 15,23
Vm 8,8,22
Vm 9,9,22
Vm 10,10,22
Vm 11,11,22
Vm 12,12,22
Vm 13,13,22
Vm 14,14,22
Vm 15,15,22
Aw 16,8
Aw 17,9
Aw 18,10
Aw 19,11
Aw 20,12
Aw 21,13
Aw 22,14
Aw 23,15
Ar 8,24
Ar 9,25
Ar 10,26
Ar 11,27
Ar 12,28
Ar 13,29
Ar 14,30
Ar 15,31
Vm 8,8,22
Vm 9,9,22
Vm 10,10,22
Vm 11,11,22
Vm 12,12,22
Vm 13,13,22
Vm 14,14,22
Vm 15,15,22
Aw 24,8
Aw 25,9
Aw 26,10
Aw 27,11
Aw 28,12
Aw 29,13
Aw 30,14
Aw 31,15
v_max3_f32 v21, v144, v145, v146
v_max3_f32 v21, v21, v147, v148
v_max3_f32 v21, v21, v149, v150
v_max3_f32 v21, v21, v151, v152
v_max3_f32 v21, v21, v153, v154
v_max3_f32 v21, v21, v155, v156
v_max3_f32 v21, v21, v157, v158
v_max_f32 v21, v21, v159
v_mov_b32 v1, v21
s_nop 1
v_permlane16_swap_b32 v1, v21
v_max_f32 v21, v21, v1
v_mov_b32 v1, v21
s_nop 1
v_permlane32_swap_b32 v1, v21
v_max_f32_e64 v21, v21, v1
v_add_f32 v21, 0x41f80000, v21
v_max_f32 v21, 0, v21
Vs 144,144,21
Vs 145,145,21
Vs 146,146,21
Vs 147,147,21
Vs 148,148,21
Vs 149,149,21
Vs 150,150,21
Vs 151,151,21
Vs 152,152,21
Vs 153,153,21
Vs 154,154,21
Vs 155,155,21
Vs 156,156,21
Vs 157,157,21
Vs 158,158,21
Vs 159,159,21
Vs 208,208,21
Vs 209,209,21
Vs 210,210,21
Vs 211,211,21
Vs 212,212,21
Vs 213,213,21
Vs 214,214,21
Vs 215,215,21
Vs 216,216,21
Vs 217,217,21
Vs 218,218,21
Vs 219,219,21
Vs 220,220,21
Vs 221,221,21
Vs 222,222,21
Vs 223,223,21
Vs 36,36,21
Vs 37,37,21
Vs 38,38,21
v_sub_f32_e64 v39, v39, v21
v_exp_f32 v22, -v21
s_nop 0
Vm 52,52,22
Vm 53,53,22
Vm 54,54,22
v_mul_f32_e64 v55, v55, v22
Ar 8,32
Ar 9,33
Ar 10,34
Ar 11,35
Ar 12,36
Ar 13,37
Ar 14,38
Ar 15,39
Vm 8,8,22
Vm 9,9,22
Vm 10,10,22
Vm 11,11,22
Vm 12,12,22
Vm 13,13,22
Vm 14,14,22
Vm 15,15,22
Aw 32,8
Aw 33,9
Aw 34,10
Aw 35,11
Aw 36,12
Aw 37,13
Aw 38,14
Aw 39,15
Ar 8,40
Ar 9,41
Ar 10,42
Ar 11,43
Ar 12,44
Ar 13,45
Ar 14,46
Ar 15,47
Vm 8,8,22
Vm 9,9,22
Vm 10,10,22
Vm 11,11,22
Vm 12,12,22
Vm 13,13,22
Vm 14,14,22
Vm 15,15,22
Aw 40,8
Aw 41,9
Aw 42,10
Aw 43,11
Aw 44,12
Aw 45,13
Aw 46,14
Aw 47,15
Ar 8,48
Ar 9,49
Ar 10,50
Ar 11,51
Ar 12,52
Ar 13,53
Ar 14,54
Ar 15,55
Vm 8,8,22
Vm 9,9,22
Vm 10,10,22
Vm 11,11,22
Vm 12,12,22
Vm 13,13,22
Vm 14,14,22
Vm 15,15,22
Aw 48,8
Aw 49,9
Aw 50,10
Aw 51,11
Aw 52,12
Aw 53,13
Aw 54,14
Aw 55,15
Ar 8,56
Ar 9,57
Ar 10,58
Ar 11,59
Ar 12,60
Ar 13,61
Ar 14,62
Ar 15,63
Vm 8,8,22
Vm 9,9,22
Vm 10,10,22
Vm 11,11,22
Vm 12,12,22
Vm 13,13,22
Vm 14,14,22
Vm 15,15,22
Aw 56,8
Aw 57,9
Aw 58,10
Aw 59,11
Aw 60,12
Aw 61,13
Aw 62,14
Aw 63,15
v_max3_f32 v21, v160, v161, v162
v_max3_f32 v21, v21, v163, v164
v_max3_f32 v21, v21, v165, v166
v_max3_f32 v21, v21, v167, v168
v_max3_f32 v21, v21, v169, v170
v_max3_f32 v21, v21, v171, v172
v_max3_f32 v21, v21, v173, v174
v_max_f32 v21, v21, v175
v_mov_b32 v1, v21
s_nop 1
v_permlane16_swap_b32 v1, v21
v_max_f32 v21, v21, v1
v_mov_b32 v1, v21
s_nop 1
v_permlane32_swap_b32 v1, v21
v_max_f32_e64 v21, v21, v1
v_add_f32 v21, 0x41f80000, v21
v_max_f32 v21, 0, v21
Vs 160,160,21
Vs 161,161,21
Vs 162,162,21
Vs 163,163,21
Vs 164,164,21
Vs 165,165,21
Vs 166,166,21
Vs 167,167,21
Vs 168,168,21
Vs 169,169,21
Vs 170,170,21
Vs 171,171,21
Vs 172,172,21
Vs 173,173,21
Vs 174,174,21
Vs 175,175,21
Vs 224,224,21
Vs 225,225,21
Vs 226,226,21
Vs 227,227,21
Vs 228,228,21
Vs 229,229,21
Vs 230,230,21
Vs 231,231,21
Vs 232,232,21
Vs 233,233,21
Vs 234,234,21
Vs 235,235,21
Vs 236,236,21
Vs 237,237,21
Vs 238,238,21
Vs 239,239,21
Vs 40,40,21
Vs 41,41,21
Vs 42,42,21
v_sub_f32_e64 v43, v43, v21
v_exp_f32 v22, -v21
s_nop 0
Vm 56,56,22
Vm 57,57,22
Vm 58,58,22
v_mul_f32_e64 v59, v59, v22
Ar 8,64
Ar 9,65
Ar 10,66
Ar 11,67
Ar 12,68
Ar 13,69
Ar 14,70
Ar 15,71
Vm 8,8,22
Vm 9,9,22
Vm 10,10,22
Vm 11,11,22
Vm 12,12,22
Vm 13,13,22
Vm 14,14,22
Vm 15,15,22
Aw 64,8
Aw 65,9
Aw 66,10
Aw 67,11
Aw 68,12
Aw 69,13
Aw 70,14
Aw 71,15
Ar 8,72
Ar 9,73
Ar 10,74
Ar 11,75
Ar 12,76
Ar 13,77
Ar 14,78
Ar 15,79
Vm 8,8,22
Vm 9,9,22
Vm 10,10,22
Vm 11,11,22
Vm 12,12,22
Vm 13,13,22
Vm 14,14,22
Vm 15,15,22
Aw 72,8
Aw 73,9
Aw 74,10
Aw 75,11
Aw 76,12
Aw 77,13
Aw 78,14
Aw 79,15
Ar 8,80
Ar 9,81
Ar 10,82
Ar 11,83
Ar 12,84
Ar 13,85
Ar 14,86
Ar 15,87
Vm 8,8,22
Vm 9,9,22
Vm 10,10,22
Vm 11,11,22
Vm 12,12,22
Vm 13,13,22
Vm 14,14,22
Vm 15,15,22
Aw 80,8
Aw 81,9
Aw 82,10
Aw 83,11
Aw 84,12
Aw 85,13
Aw 86,14
Aw 87,15
Ar 8,88
Ar 9,89
Ar 10,90
Ar 11,91
Ar 12,92
Ar 13,93
Ar 14,94
Ar 15,95
Vm 8,8,22
Vm 9,9,22
Vm 10,10,22
Vm 11,11,22
Vm 12,12,22
Vm 13,13,22
Vm 14,14,22
Vm 15,15,22
Aw 88,8
Aw 89,9
Aw 90,10
Aw 91,11
Aw 92,12
Aw 93,13
Aw 94,14
Aw 95,15
v_max3_f32 v21, v176, v177, v178
v_max3_f32 v21, v21, v179, v180
v_max3_f32 v21, v21, v181, v182
v_max3_f32 v21, v21, v183, v184
v_max3_f32 v21, v21, v185, v186
v_max3_f32 v21, v21, v187, v188
v_max3_f32 v21, v21, v189, v190
v_max_f32 v21, v21, v191
v_mov_b32 v1, v21
s_nop 1
v_permlane16_swap_b32 v1, v21
v_max_f32 v21, v21, v1
v_mov_b32 v1, v21
s_nop 1
v_permlane32_swap_b32 v1, v21
v_max_f32_e64 v21, v21, v1
v_add_f32 v21, 0x41f80000, v21
v_max_f32 v21, 0, v21
Vs 176,176,21
Vs 177,177,21
Vs 178,178,21
Vs 179,179,21
Vs 180,180,21
Vs 181,181,21
Vs 182,182,21
Vs 183,183,21
Vs 184,184,21
Vs 185,185,21
Vs 186,186,21
Vs 187,187,21
Vs 188,188,21
Vs 189,189,21
Vs 190,190,21
Vs 191,191,21
Vs 44,44,21
Vs 45,45,21
Vs 46,46,21
v_sub_f32_e64 v47, v47, v21
v_exp_f32 v22, -v21
s_nop 0
Vm 60,60,22
Vm 61,61,22
Vm 62,62,22
v_mul_f32_e64 v63, v63, v22
Ar 8,96
Ar 9,97
Ar 10,98
Ar 11,99
Ar 12,100
Ar 13,101
Ar 14,102
Ar 15,103
Vm 8,8,22
Vm 9,9,22
Vm 10,10,22
Vm 11,11,22
Vm 12,12,22
Vm 13,13,22
Vm 14,14,22
Vm 15,15,22
Aw 96,8
Aw 97,9
Aw 98,10
Aw 99,11
Aw 100,12
Aw 101,13
Aw 102,14
Aw 103,15
Ar 8,104
Ar 9,105
Ar 10,106
Ar 11,107
Ar 12,108
Ar 13,109
Ar 14,110
Ar 15,111
Vm 8,8,22
Vm 9,9,22
Vm 10,10,22
Vm 11,11,22
Vm 12,12,22
Vm 13,13,22
Vm 14,14,22
Vm 15,15,22
Aw 104,8
Aw 105,9
Aw 106,10
Aw 107,11
Aw 108,12
Aw 109,13
Aw 110,14
Aw 111,15
Ar 8,112
Ar 9,113
Ar 10,114
Ar 11,115
Ar 12,116
Ar 13,117
Ar 14,118
Ar 15,119
Vm 8,8,22
Vm 9,9,22
Vm 10,10,22
Vm 11,11,22
Vm 12,12,22
Vm 13,13,22
Vm 14,14,22
Vm 15,15,22
Aw 112,8
Aw 113,9
Aw 114,10
Aw 115,11
Aw 116,12
Aw 117,13
Aw 118,14
Aw 119,15
Ar 8,120
Ar 9,121
Ar 10,122
Ar 11,123
Ar 12,124
Ar 13,125
Ar 14,126
Ar 15,127
Vm 8,8,22
Vm 9,9,22
Vm 10,10,22
Vm 11,11,22
Vm 12,12,22
Vm 13,13,22
Vm 14,14,22
Vm 15,15,22
Aw 120,8
Aw 121,9
Aw 122,10
Aw 123,11
Aw 124,12
Aw 125,13
Aw 126,14
Aw 127,15
Ve 8,128
Ve 9,129
s_nop 0
Vc 64,8,9
Ve 8,130
Ve 9,131
s_nop 0
Vc 65,8,9
Ve 8,144
Ve 9,145
s_nop 0
Vc 72,8,9
Ve 8,146
Ve 9,147
s_nop 0
Vc 73,8,9
Ve 8,160
Ve 9,161
s_nop 0
Vc 80,8,9
Ve 8,162
Ve 9,163
s_nop 0
Vc 81,8,9
Ve 8,176
Ve 9,177
s_nop 0
Vc 88,8,9
Ve 8,178
Ve 9,179
s_nop 0
Vc 89,8,9
Ve 8,132
Ve 9,133
s_nop 0
Vc 66,8,9
Ve 8,134
Ve 9,135
s_nop 0
Vc 67,8,9
Ve 8,148
Ve 9,149
s_nop 0
Vc 74,8,9
Ve 8,150
Ve 9,151
s_nop 0
Vc 75,8,9
Ve 8,164
Ve 9,165
s_nop 0
Vc 82,8,9
Ve 8,166
Ve 9,167
s_nop 0
Vc 83,8,9
Ve 8,180
Ve 9,181
s_nop 0
Vc 90,8,9
Ve 8,182
Ve 9,183
s_nop 0
Vc 91,8,9
Ve 8,136
Ve 9,137
s_nop 0
Vc 68,8,9
Ve 8,138
Ve 9,139
s_nop 0
Vc 69,8,9
Ve 8,152
Ve 9,153
s_nop 0
Vc 76,8,9
Ve 8,154
Ve 9,155
s_nop 0
Vc 77,8,9
Ve 8,168
Ve 9,169
s_nop 0
Vc 84,8,9
Ve 8,170
Ve 9,171
s_nop 0
Vc 85,8,9
Ve 8,184
Ve 9,185
s_nop 0
Vc 92,8,9
Ve 8,186
Ve 9,187
s_nop 0
Vc 93,8,9
Ve 8,140
Ve 9,141
s_nop 0
Vc 70,8,9
Ve 8,142
Ve 9,143
s_nop 0
Vc 71,8,9
Ve 8,156
Ve 9,157
s_nop 0
Vc 78,8,9
Ve 8,158
Ve 9,159
s_nop 0
Vc 79,8,9
Ve 8,172
Ve 9,173
s_nop 0
Vc 86,8,9
Ve 8,174
Ve 9,175
s_nop 0
Vc 87,8,9
Ve 8,188
Ve 9,189
s_nop 0
Vc 94,8,9
Ve 8,190
Ve 9,191
s_nop 0
Vc 95,8,9
s_nop 1
s_branch L_k2_fbr_wl
L_k2_fb_tr:
s_nop 7
s_nop 0
v_max3_f32 v21, v192, v193, v194
v_max3_f32 v21, v21, v195, v196
v_max3_f32 v21, v21, v197, v198
v_max3_f32 v21, v21, v199, v200
v_max3_f32 v21, v21, v201, v202
v_max3_f32 v21, v21, v203, v204
v_max3_f32 v21, v21, v205, v206
v_max_f32 v21, v21, v207
v_mov_b32 v1, v21
s_nop 1
v_permlane16_swap_b32 v1, v21
v_max_f32 v21, v21, v1
v_mov_b32 v1, v21
s_nop 1
v_permlane32_swap_b32 v1, v21
v_max_f32_e64 v21, v21, v1
v_add_f32 v21, 0x41f80000, v21
v_max_f32 v21, 0, v21
Vs 192,192,21
Vs 193,193,21
Vs 194,194,21
Vs 195,195,21
Vs 196,196,21
Vs 197,197,21
Vs 198,198,21
Vs 199,199,21
Vs 200,200,21
Vs 201,201,21
Vs 202,202,21
Vs 203,203,21
Vs 204,204,21
Vs 205,205,21
Vs 206,206,21
Vs 207,207,21
Vs 128,128,21
Vs 129,129,21
Vs 130,130,21
Vs 131,131,21
Vs 132,132,21
Vs 133,133,21
Vs 134,134,21
Vs 135,135,21
Vs 136,136,21
Vs 137,137,21
Vs 138,138,21
Vs 139,139,21
Vs 140,140,21
Vs 141,141,21
Vs 142,142,21
Vs 143,143,21
Vs 32,32,21
Vs 33,33,21
Vs 34,34,21
v_sub_f32_e64 v35, v35, v21
v_exp_f32 v22, -v21
s_nop 0
Vm 48,48,22
Vm 49,49,22
Vm 50,50,22
v_mul_f32_e64 v51, v51, v22
Ar 8,0
Ar 9,1
Ar 10,2
Ar 11,3
Ar 12,4
Ar 13,5
Ar 14,6
Ar 15,7
Vm 8,8,22
Vm 9,9,22
Vm 10,10,22
Vm 11,11,22
Vm 12,12,22
Vm 13,13,22
Vm 14,14,22
Vm 15,15,22
Aw 0,8
Aw 1,9
Aw 2,10
Aw 3,11
Aw 4,12
Aw 5,13
Aw 6,14
Aw 7,15
Ar 8,8
Ar 9,9
Ar 10,10
Ar 11,11
Ar 12,12
Ar 13,13
Ar 14,14
Ar 15,15
Vm 8,8,22
Vm 9,9,22
Vm 10,10,22
Vm 11,11,22
Vm 12,12,22
Vm 13,13,22
Vm 14,14,22
Vm 15,15,22
Aw 8,8
Aw 9,9
Aw 10,10
Aw 11,11
Aw 12,12
Aw 13,13
Aw 14,14
Aw 15,15
Ar 8,16
Ar 9,17
Ar 10,18
Ar 11,19
Ar 12,20
Ar 13,21
Ar 14,22
Ar 15,23
Vm 8,8,22
Vm 9,9,22
Vm 10,10,22
Vm 11,11,22
Vm 12,12,22
Vm 13,13,22
Vm 14,14,22
Vm 15,15,22
Aw 16,8
Aw 17,9
Aw 18,10
Aw 19,11
Aw 20,12
Aw 21,13
Aw 22,14
Aw 23,15
Ar 8,24
Ar 9,25
Ar 10,26
Ar 11,27
Ar 12,28
Ar 13,29
Ar 14,30
Ar 15,31
Vm 8,8,22
Vm 9,9,22
Vm 10,10,22
Vm 11,11,22
Vm 12,12,22
Vm 13,13,22
Vm 14,14,22
Vm 15,15,22
Aw 24,8
Aw 25,9
Aw 26,10
Aw 27,11
Aw 28,12
Aw 29,13
Aw 30,14
Aw 31,15
v_max3_f32 v21, v208, v209, v210
v_max3_f32 v21, v21, v211, v212
v_max3_f32 v21, v21, v213, v214
v_max3_f32 v21, v21, v215, v216
v_max3_f32 v21, v21, v217, v218
v_max3_f32 v21, v21, v219, v220
v_max3_f32 v21, v21, v221, v222
v_max_f32 v21, v21, v223
v_mov_b32 v1, v21
s_nop 1
v_permlane16_swap_b32 v1, v21
v_max_f32 v21, v21, v1
v_mov_b32 v1, v21
s_nop 1
v_permlane32_swap_b32 v1, v21
v_max_f32_e64 v21, v21, v1
v_add_f32 v21, 0x41f80000, v21
v_max_f32 v21, 0, v21
Vs 208,208,21
Vs 209,209,21
Vs 210,210,21
Vs 211,211,21
Vs 212,212,21
Vs 213,213,21
Vs 214,214,21
Vs 215,215,21
Vs 216,216,21
Vs 217,217,21
Vs 218,218,21
Vs 219,219,21
Vs 220,220,21
Vs 221,221,21
Vs 222,222,21
Vs 223,223,21
Vs 144,144,21
Vs 145,145,21
Vs 146,146,21
Vs 147,147,21
Vs 148,148,21
Vs 149,149,21
Vs 150,150,21
Vs 151,151,21
Vs 152,152,21
Vs 153,153,21
Vs 154,154,21
Vs 155,155,21
Vs 156,156,21
Vs 157,157,21
Vs 158,158,21
Vs 159,159,21
Vs 36,36,21
Vs 37,37,21
Vs 38,38,21
v_sub_f32_e64 v39, v39, v21
v_exp_f32 v22, -v21
s_nop 0
Vm 52,52,22
Vm 53,53,22
Vm 54,54,22
v_mul_f32_e64 v55, v55, v22
Ar 8,32
Ar 9,33
Ar 10,34
Ar 11,35
Ar 12,36
Ar 13,37
Ar 14,38
Ar 15,39
Vm 8,8,22
Vm 9,9,22
Vm 10,10,22
Vm 11,11,22
Vm 12,12,22
Vm 13,13,22
Vm 14,14,22
Vm 15,15,22
Aw 32,8
Aw 33,9
Aw 34,10
Aw 35,11
Aw 36,12
Aw 37,13
Aw 38,14
Aw 39,15
Ar 8,40
Ar 9,41
Ar 10,42
Ar 11,43
Ar 12,44
Ar 13,45
Ar 14,46
Ar 15,47
Vm 8,8,22
Vm 9,9,22
Vm 10,10,22
Vm 11,11,22
Vm 12,12,22
Vm 13,13,22
Vm 14,14,22
Vm 15,15,22
Aw 40,8
Aw 41,9
Aw 42,10
Aw 43,11
Aw 44,12
Aw 45,13
Aw 46,14
Aw 47,15
Ar 8,48
Ar 9,49
Ar 10,50
Ar 11,51
Ar 12,52
Ar 13,53
Ar 14,54
Ar 15,55
Vm 8,8,22
Vm 9,9,22
Vm 10,10,22
Vm 11,11,22
Vm 12,12,22
Vm 13,13,22
Vm 14,14,22
Vm 15,15,22
Aw 48,8
Aw 49,9
Aw 50,10
Aw 51,11
Aw 52,12
Aw 53,13
Aw 54,14
Aw 55,15
Ar 8,56
Ar 9,57
Ar 10,58
Ar 11,59
Ar 12,60
Ar 13,61
Ar 14,62
Ar 15,63
Vm 8,8,22
Vm 9,9,22
Vm 10,10,22
Vm 11,11,22
Vm 12,12,22
Vm 13,13,22
Vm 14,14,22
Vm 15,15,22
Aw 56,8
Aw 57,9
Aw 58,10
Aw 59,11
Aw 60,12
Aw 61,13
Aw 62,14
Aw 63,15
v_max3_f32 v21, v224, v225, v226
v_max3_f32 v21, v21, v227, v228
v_max3_f32 v21, v21, v229, v230
v_max3_f32 v21, v21, v231, v232
v_max3_f32 v21, v21, v233, v234
v_max3_f32 v21, v21, v235, v236
v_max3_f32 v21, v21, v237, v238
v_max_f32 v21, v21, v239
v_mov_b32 v1, v21
s_nop 1
v_permlane16_swap_b32 v1, v21
v_max_f32 v21, v21, v1
v_mov_b32 v1, v21
s_nop 1
v_permlane32_swap_b32 v1, v21
v_max_f32_e64 v21, v21, v1
v_add_f32 v21, 0x41f80000, v21
v_max_f32 v21, 0, v21
Vs 224,224,21
Vs 225,225,21
Vs 226,226,21
Vs 227,227,21
Vs 228,228,21
Vs 229,229,21
Vs 230,230,21
Vs 231,231,21
Vs 232,232,21
Vs 233,233,21
Vs 234,234,21
Vs 235,235,21
Vs 236,236,21
Vs 237,237,21
Vs 238,238,21
Vs 239,239,21
Vs 40,40,21
Vs 41,41,21
Vs 42,42,21
v_sub_f32_e64 v43, v43, v21
v_exp_f32 v22, -v21
s_nop 0
Vm 56,56,22
Vm 57,57,22
Vm 58,58,22
v_mul_f32_e64 v59, v59, v22
Ar 8,64
Ar 9,65
Ar 10,66
Ar 11,67
Ar 12,68
Ar 13,69
Ar 14,70
Ar 15,71
Vm 8,8,22
Vm 9,9,22
Vm 10,10,22
Vm 11,11,22
Vm 12,12,22
Vm 13,13,22
Vm 14,14,22
Vm 15,15,22
Aw 64,8
Aw 65,9
Aw 66,10
Aw 67,11
Aw 68,12
Aw 69,13
Aw 70,14
Aw 71,15
Ar 8,72
Ar 9,73
Ar 10,74
Ar 11,75
Ar 12,76
Ar 13,77
Ar 14,78
Ar 15,79
Vm 8,8,22
Vm 9,9,22
Vm 10,10,22
Vm 11,11,22
Vm 12,12,22
Vm 13,13,22
Vm 14,14,22
Vm 15,15,22
Aw 72,8
Aw 73,9
Aw 74,10
Aw 75,11
Aw 76,12
Aw 77,13
Aw 78,14
Aw 79,15
Ar 8,80
Ar 9,81
Ar 10,82
Ar 11,83
Ar 12,84
Ar 13,85
Ar 14,86
Ar 15,87
Vm 8,8,22
Vm 9,9,22
Vm 10,10,22
Vm 11,11,22
Vm 12,12,22
Vm 13,13,22
Vm 14,14,22
Vm 15,15,22
Aw 80,8
Aw 81,9
Aw 82,10
Aw 83,11
Aw 84,12
Aw 85,13
Aw 86,14
Aw 87,15
Ar 8,88
Ar 9,89
Ar 10,90
Ar 11,91
Ar 12,92
Ar 13,93
Ar 14,94
Ar 15,95
Vm 8,8,22
Vm 9,9,22
Vm 10,10,22
Vm 11,11,22
Vm 12,12,22
Vm 13,13,22
Vm 14,14,22
Vm 15,15,22
Aw 88,8
Aw 89,9
Aw 90,10
Aw 91,11
Aw 92,12
Aw 93,13
Aw 94,14
Aw 95,15
Ve 8,192
Ve 9,193
s_nop 0
Vc 96,8,9
Ve 8,194
Ve 9,195
s_nop 0
Vc 97,8,9
Ve 8,208
Ve 9,209
s_nop 0
Vc 104,8,9
Ve 8,210
Ve 9,211
s_nop 0
Vc 105,8,9
Ve 8,224
Ve 9,225
s_nop 0
Vc 112,8,9
Ve 8,226
Ve 9,227
s_nop 0
Vc 113,8,9
Ve 8,196
Ve 9,197
s_nop 0
Vc 98,8,9
Ve 8,198
Ve 9,199
s_nop 0
Vc 99,8,9
Ve 8,212
Ve 9,213
s_nop 0
Vc 106,8,9
Ve 8,214
Ve 9,215
s_nop 0
Vc 107,8,9
Ve 8,228
Ve 9,229
s_nop 0
Vc 114,8,9
Ve 8,230
Ve 9,231
s_nop 0
Vc 115,8,9
Ve 8,200
Ve 9,201
s_nop 0
Vc 100,8,9
Ve 8,202
Ve 9,203
s_nop 0
Vc 101,8,9
Ve 8,216
Ve 9,217
s_nop 0
Vc 108,8,9
Ve 8,218
Ve 9,219
s_nop 0
Vc 109,8,9
Ve 8,232
Ve 9,233
s_nop 0
Vc 116,8,9
Ve 8,234
Ve 9,235
s_nop 0
Vc 117,8,9
Ve 8,204
Ve 9,205
s_nop 0
Vc 102,8,9
Ve 8,206
Ve 9,207
s_nop 0
Vc 103,8,9
Ve 8,220
Ve 9,221
s_nop 0
Vc 110,8,9
Ve 8,222
Ve 9,223
s_nop 0
Vc 111,8,9
Ve 8,236
Ve 9,237
s_nop 0
Vc 118,8,9
Ve 8,238
Ve 9,239
s_nop 0
Vc 119,8,9
s_nop 1
s_branch L_k2_fbr_tr
L_k2_fb_ne:
s_nop 7
s_nop 0
v_max3_f32 v21, v128, v129, v130
v_max3_f32 v21, v21, v131, v132
v_max3_f32 v21, v21, v133, v134
v_max3_f32 v21, v21, v135, v136
v_max3_f32 v21, v21, v137, v138
v_max3_f32 v21, v21, v139, v140
v_max3_f32 v21, v21, v141, v142
v_max_f32 v21, v21, v143
v_mov_b32 v1, v21
s_nop 1
v_permlane16_swap_b32 v1, v21
v_max_f32 v21, v21, v1
v_mov_b32 v1, v21
s_nop 1
v_permlane32_swap_b32 v1, v21
v_max_f32_e64 v21, v21, v1
v_add_f32 v21, 0x41f80000, v21
v_max_f32 v21, 0, v21
Vs 128,128,21
Vs 129,129,21
Vs 130,130,21
Vs 131,131,21
Vs 132,132,21
Vs 133,133,21
Vs 134,134,21
Vs 135,135,21
Vs 136,136,21
Vs 137,137,21
Vs 138,138,21
Vs 139,139,21
Vs 140,140,21
Vs 141,141,21
Vs 142,142,21
Vs 143,143,21
Vs 192,192,21
Vs 193,193,21
Vs 194,194,21
Vs 195,195,21
Vs 196,196,21
Vs 197,197,21
Vs 198,198,21
Vs 199,199,21
Vs 200,200,21
Vs 201,201,21
Vs 202,202,21
Vs 203,203,21
Vs 204,204,21
Vs 205,205,21
Vs 206,206,21
Vs 207,207,21
Vs 32,32,21
Vs 33,33,21
Vs 34,34,21
v_sub_f32_e64 v35, v35, v21
v_exp_f32 v22, -v21
s_nop 0
Vm 48,48,22
Vm 49,49,22
Vm 50,50,22
v_mul_f32_e64 v51, v51, v22
Ar 8,0
Ar 9,1
Ar 10,2
Ar 11,3
Ar 12,4
Ar 13,5
Ar 14,6
Ar 15,7
Vm 8,8,22
Vm 9,9,22
Vm 10,10,22
Vm 11,11,22
Vm 12,12,22
Vm 13,13,22
Vm 14,14,22
Vm 15,15,22
Aw 0,8
Aw 1,9
Aw 2,10
Aw 3,11
Aw 4,12
Aw 5,13
Aw 6,14
Aw 7,15
Ar 8,8
Ar 9,9
Ar 10,10
Ar 11,11
Ar 12,12
Ar 13,13
Ar 14,14
Ar 15,15
Vm 8,8,22
Vm 9,9,22
Vm 10,10,22
Vm 11,11,22
Vm 12,12,22
Vm 13,13,22
Vm 14,14,22
Vm 15,15,22
Aw 8,8
Aw 9,9
Aw 10,10
Aw 11,11
Aw 12,12
Aw 13,13
Aw 14,14
Aw 15,15
Ar 8,16
Ar 9,17
Ar 10,18
Ar 11,19
Ar 12,20
Ar 13,21
Ar 14,22
Ar 15,23
Vm 8,8,22
Vm 9,9,22
Vm 10,10,22
Vm 11,11,22
Vm 12,12,22
Vm 13,13,22
Vm 14,14,22
Vm 15,15,22
Aw 16,8
Aw 17,9
Aw 18,10
Aw 19,11
Aw 20,12
Aw 21,13
Aw 22,14
Aw 23,15
Ar 8,24
Ar 9,25
Ar 10,26
Ar 11,27
Ar 12,28
Ar 13,29
Ar 14,30
Ar 15,31
Vm 8,8,22
Vm 9,9,22
Vm 10,10,22
Vm 11,11,22
Vm 12,12,22
Vm 13,13,22
Vm 14,14,22
Vm 15,15,22
Aw 24,8
Aw 25,9
Aw 26,10
Aw 27,11
Aw 28,12
Aw 29,13
Aw 30,14
Aw 31,15
v_max3_f32 v21, v144, v145, v146
v_max3_f32 v21, v21, v147, v148
v_max3_f32 v21, v21, v149, v150
v_max3_f32 v21, v21, v151, v152
v_max3_f32 v21, v21, v153, v154
v_max3_f32 v21, v21, v155, v156
v_max3_f32 v21, v21, v157, v158
v_max_f32 v21, v21, v159
v_mov_b32 v1, v21
s_nop 1
v_permlane16_swap_b32 v1, v21
v_max_f32 v21, v21, v1
v_mov_b32 v1, v21
s_nop 1
v_permlane32_swap_b32 v1, v21
v_max_f32_e64 v21, v21, v1
v_add_f32 v21, 0x41f80000, v21
v_max_f32 v21, 0, v21
Vs 144,144,21
Vs 145,145,21
Vs 146,146,21
Vs 147,147,21
Vs 148,148,21
Vs 149,149,21
Vs 150,150,21
Vs 151,151,21
Vs 152,152,21
Vs 153,153,21
Vs 154,154,21
Vs 155,155,21
Vs 156,156,21
Vs 157,157,21
Vs 158,158,21
Vs 159,159,21
Vs 208,208,21
Vs 209,209,21
Vs 210,210,21
Vs 211,211,21
Vs 212,212,21
Vs 213,213,21
Vs 214,214,21
Vs 215,215,21
Vs 216,216,21
Vs 217,217,21
Vs 218,218,21
Vs 219,219,21
Vs 220,220,21
Vs 221,221,21
Vs 222,222,21
Vs 223,223,21
Vs 36,36,21
Vs 37,37,21
Vs 38,38,21
v_sub_f32_e64 v39, v39, v21
v_exp_f32 v22, -v21
s_nop 0
Vm 52,52,22
Vm 53,53,22
Vm 54,54,22
v_mul_f32_e64 v55, v55, v22
Ar 8,32
Ar 9,33
Ar 10,34
Ar 11,35
Ar 12,36
Ar 13,37
Ar 14,38
Ar 15,39
Vm 8,8,22
Vm 9,9,22
Vm 10,10,22
Vm 11,11,22
Vm 12,12,22
Vm 13,13,22
Vm 14,14,22
Vm 15,15,22
Aw 32,8
Aw 33,9
Aw 34,10
Aw 35,11
Aw 36,12
Aw 37,13
Aw 38,14
Aw 39,15
Ar 8,40
Ar 9,41
Ar 10,42
Ar 11,43
Ar 12,44
Ar 13,45
Ar 14,46
Ar 15,47
Vm 8,8,22
Vm 9,9,22
Vm 10,10,22
Vm 11,11,22
Vm 12,12,22
Vm 13,13,22
Vm 14,14,22
Vm 15,15,22
Aw 40,8
Aw 41,9
Aw 42,10
Aw 43,11
Aw 44,12
Aw 45,13
Aw 46,14
Aw 47,15
Ar 8,48
Ar 9,49
Ar 10,50
Ar 11,51
Ar 12,52
Ar 13,53
Ar 14,54
Ar 15,55
Vm 8,8,22
Vm 9,9,22
Vm 10,10,22
Vm 11,11,22
Vm 12,12,22
Vm 13,13,22
Vm 14,14,22
Vm 15,15,22
Aw 48,8
Aw 49,9
Aw 50,10
Aw 51,11
Aw 52,12
Aw 53,13
Aw 54,14
Aw 55,15
Ar 8,56
Ar 9,57
Ar 10,58
Ar 11,59
Ar 12,60
Ar 13,61
Ar 14,62
Ar 15,63
Vm 8,8,22
Vm 9,9,22
Vm 10,10,22
Vm 11,11,22
Vm 12,12,22
Vm 13,13,22
Vm 14,14,22
Vm 15,15,22
Aw 56,8
Aw 57,9
Aw 58,10
Aw 59,11
Aw 60,12
Aw 61,13
Aw 62,14
Aw 63,15
Ve 8,128
Ve 9,129
s_nop 0
Vc 64,8,9
Ve 8,130
Ve 9,131
s_nop 0
Vc 65,8,9
Ve 8,144
Ve 9,145
s_nop 0
Vc 72,8,9
Ve 8,146
Ve 9,147
s_nop 0
Vc 73,8,9
Ve 8,132
Ve 9,133
s_nop 0
Vc 66,8,9
Ve 8,134
Ve 9,135
s_nop 0
Vc 67,8,9
Ve 8,148
Ve 9,149
s_nop 0
Vc 74,8,9
Ve 8,150
Ve 9,151
s_nop 0
Vc 75,8,9
Ve 8,136
Ve 9,137
s_nop 0
Vc 68,8,9
Ve 8,138
Ve 9,139
s_nop 0
Vc 69,8,9
Ve 8,152
Ve 9,153
s_nop 0
Vc 76,8,9
Ve 8,154
Ve 9,155
s_nop 0
Vc 77,8,9
Ve 8,140
Ve 9,141
s_nop 0
Vc 70,8,9
Ve 8,142
Ve 9,143
s_nop 0
Vc 71,8,9
Ve 8,156
Ve 9,157
s_nop 0
Vc 78,8,9
Ve 8,158
Ve 9,159
s_nop 0
Vc 79,8,9
s_nop 1
s_branch L_k2_fbr_ne
L_k2_fb_no:
s_nop 7
s_nop 0
v_max3_f32 v21, v192, v193, v194
v_max3_f32 v21, v21, v195, v196
v_max3_f32 v21, v21, v197, v198
v_max3_f32 v21, v21, v199, v200
v_max3_f32 v21, v21, v201, v202
v_max3_f32 v21, v21, v203, v204
v_max3_f32 v21, v21, v205, v206
v_max_f32 v21, v21, v207
v_mov_b32 v1, v21
s_nop 1
v_permlane16_swap_b32 v1, v21
v_max_f32 v21, v21, v1
v_mov_b32 v1, v21
s_nop 1
v_permlane32_swap_b32 v1, v21
v_max_f32_e64 v21, v21, v1
v_add_f32 v21, 0x41f80000, v21
v_max_f32 v21, 0, v21
Vs 192,192,21
Vs 193,193,21
Vs 194,194,21
Vs 195,195,21
Vs 196,196,21
Vs 197,197,21
Vs 198,198,21
Vs 199,199,21
Vs 200,200,21
Vs 201,201,21
Vs 202,202,21
Vs 203,203,21
Vs 204,204,21
Vs 205,205,21
Vs 206,206,21
Vs 207,207,21
Vs 128,128,21
Vs 129,129,21
Vs 130,130,21
Vs 131,131,21
Vs 132,132,21
Vs 133,133,21
Vs 134,134,21
Vs 135,135,21
Vs 136,136,21
Vs 137,137,21
Vs 138,138,21
Vs 139,139,21
Vs 140,140,21
Vs 141,141,21
Vs 142,142,21
Vs 143,143,21
Vs 32,32,21
Vs 33,33,21
Vs 34,34,21
v_sub_f32_e64 v35, v35, v21
v_exp_f32 v22, -v21
s_nop 0
Vm 48,48,22
Vm 49,49,22
Vm 50,50,22
v_mul_f32_e64 v51, v51, v22
Ar 8,0
Ar 9,1
Ar 10,2
Ar 11,3
Ar 12,4
Ar 13,5
Ar 14,6
Ar 15,7
Vm 8,8,22
Vm 9,9,22
Vm 10,10,22
Vm 11,11,22
Vm 12,12,22
Vm 13,13,22
Vm 14,14,22
Vm 15,15,22
Aw 0,8
Aw 1,9
Aw 2,10
Aw 3,11
Aw 4,12
Aw 5,13
Aw 6,14
Aw 7,15
Ar 8,8
Ar 9,9
Ar 10,10
Ar 11,11
Ar 12,12
Ar 13,13
Ar 14,14
Ar 15,15
Vm 8,8,22
Vm 9,9,22
Vm 10,10,22
Vm 11,11,22
Vm 12,12,22
Vm 13,13,22
Vm 14,14,22
Vm 15,15,22
Aw 8,8
Aw 9,9
Aw 10,10
Aw 11,11
Aw 12,12
Aw 13,13
Aw 14,14
Aw 15,15
Ar 8,16
Ar 9,17
Ar 10,18
Ar 11,19
Ar 12,20
Ar 13,21
Ar 14,22
Ar 15,23
Vm 8,8,22
Vm 9,9,22
Vm 10,10,22
Vm 11,11,22
Vm 12,12,22
Vm 13,13,22
Vm 14,14,22
Vm 15,15,22
Aw 16,8
Aw 17,9
Aw 18,10
Aw 19,11
Aw 20,12
Aw 21,13
Aw 22,14
Aw 23,15
Ar 8,24
Ar 9,25
Ar 10,26
Ar 11,27
Ar 12,28
Ar 13,29
Ar 14,30
Ar 15,31
Vm 8,8,22
Vm 9,9,22
Vm 10,10,22
Vm 11,11,22
Vm 12,12,22
Vm 13,13,22
Vm 14,14,22
Vm 15,15,22
Aw 24,8
Aw 25,9
Aw 26,10
Aw 27,11
Aw 28,12
Aw 29,13
Aw 30,14
Aw 31,15
v_max3_f32 v21, v208, v209, v210
v_max3_f32 v21, v21, v211, v212
v_max3_f32 v21, v21, v213, v214
v_max3_f32 v21, v21, v215, v216
v_max3_f32 v21, v21, v217, v218
v_max3_f32 v21, v21, v219, v220
v_max3_f32 v21, v21, v221, v222
v_max_f32 v21, v21, v223
v_mov_b32 v1, v21
s_nop 1
v_permlane16_swap_b32 v1, v21
v_max_f32 v21, v21, v1
v_mov_b32 v1, v21
s_nop 1
v_permlane32_swap_b32 v1, v21
v_max_f32_e64 v21, v21, v1
v_add_f32 v21, 0x41f80000, v21
v_max_f32 v21, 0, v21
Vs 208,208,21
Vs 209,209,21
Vs 210,210,21
Vs 211,211,21
Vs 212,212,21
Vs 213,213,21
Vs 214,214,21
Vs 215,215,21
Vs 216,216,21
Vs 217,217,21
Vs 218,218,21
Vs 219,219,21
Vs 220,220,21
Vs 221,221,21
Vs 222,222,21
Vs 223,223,21
Vs 144,144,21
Vs 145,145,21
Vs 146,146,21
Vs 147,147,21
Vs 148,148,21
Vs 149,149,21
Vs 150,150,21
Vs 151,151,21
Vs 152,152,21
Vs 153,153,21
Vs 154,154,21
Vs 155,155,21
Vs 156,156,21
Vs 157,157,21
Vs 158,158,21
Vs 159,159,21
Vs 36,36,21
Vs 37,37,21
Vs 38,38,21
v_sub_f32_e64 v39, v39, v21
v_exp_f32 v22, -v21
s_nop 0
Vm 52,52,22
Vm 53,53,22
Vm 54,54,22
v_mul_f32_e64 v55, v55, v22
Ar 8,32
Ar 9,33
Ar 10,34
Ar 11,35
Ar 12,36
Ar 13,37
Ar 14,38
Ar 15,39
Vm 8,8,22
Vm 9,9,22
Vm 10,10,22
Vm 11,11,22
Vm 12,12,22
Vm 13,13,22
Vm 14,14,22
Vm 15,15,22
Aw 32,8
Aw 33,9
Aw 34,10
Aw 35,11
Aw 36,12
Aw 37,13
Aw 38,14
Aw 39,15
Ar 8,40
Ar 9,41
Ar 10,42
Ar 11,43
Ar 12,44
Ar 13,45
Ar 14,46
Ar 15,47
Vm 8,8,22
Vm 9,9,22
Vm 10,10,22
Vm 11,11,22
Vm 12,12,22
Vm 13,13,22
Vm 14,14,22
Vm 15,15,22
Aw 40,8
Aw 41,9
Aw 42,10
Aw 43,11
Aw 44,12
Aw 45,13
Aw 46,14
Aw 47,15
Ar 8,48
Ar 9,49
Ar 10,50
Ar 11,51
Ar 12,52
Ar 13,53
Ar 14,54
Ar 15,55
Vm 8,8,22
Vm 9,9,22
Vm 10,10,22
Vm 11,11,22
Vm 12,12,22
Vm 13,13,22
Vm 14,14,22
Vm 15,15,22
Aw 48,8
Aw 49,9
Aw 50,10
Aw 51,11
Aw 52,12
Aw 53,13
Aw 54,14
Aw 55,15
Ar 8,56
Ar 9,57
Ar 10,58
Ar 11,59
Ar 12,60
Ar 13,61
Ar 14,62
Ar 15,63
Vm 8,8,22
Vm 9,9,22
Vm 10,10,22
Vm 11,11,22
Vm 12,12,22
Vm 13,13,22
Vm 14,14,22
Vm 15,15,22
Aw 56,8
Aw 57,9
Aw 58,10
Aw 59,11
Aw 60,12
Aw 61,13
Aw 62,14
Aw 63,15
Ve 8,192
Ve 9,193
s_nop 0
Vc 96,8,9
Ve 8,194
Ve 9,195
s_nop 0
Vc 97,8,9
Ve 8,208
Ve 9,209
s_nop 0
Vc 104,8,9
Ve 8,210
Ve 9,211
s_nop 0
Vc 105,8,9
Ve 8,196
Ve 9,197
s_nop 0
Vc 98,8,9
Ve 8,198
Ve 9,199
s_nop 0
Vc 99,8,9
Ve 8,212
Ve 9,213
s_nop 0
Vc 106,8,9
Ve 8,214
Ve 9,215
s_nop 0
Vc 107,8,9
Ve 8,200
Ve 9,201
s_nop 0
Vc 100,8,9
Ve 8,202
Ve 9,203
s_nop 0
Vc 101,8,9
Ve 8,216
Ve 9,217
s_nop 0
Vc 108,8,9
Ve 8,218
Ve 9,219
s_nop 0
Vc 109,8,9
Ve 8,204
Ve 9,205
s_nop 0
Vc 102,8,9
Ve 8,206
Ve 9,207
s_nop 0
Vc 103,8,9
Ve 8,220
Ve 9,221
s_nop 0
Vc 110,8,9
Ve 8,222
Ve 9,223
s_nop 0
Vc 111,8,9
s_nop 1
s_branch L_k2_fbr_no
L_k2_fb_nl:
s_nop 7
s_nop 0
v_max3_f32 v21, v128, v129, v130
v_max3_f32 v21, v21, v131, v132
v_max3_f32 v21, v21, v133, v134
v_max3_f32 v21, v21, v135, v136
v_max3_f32 v21, v21, v137, v138
v_max3_f32 v21, v21, v139, v140
v_max3_f32 v21, v21, v141, v142
v_max_f32 v21, v21, v143
v_mov_b32 v1, v21
s_nop 1
v_permlane16_swap_b32 v1, v21
v_max_f32 v21, v21, v1
v_mov_b32 v1, v21
s_nop 1
v_permlane32_swap_b32 v1, v21
v_max_f32_e64 v21, v21, v1
v_add_f32 v21, 0x41f80000, v21
v_max_f32 v21, 0, v21
Vs 128,128,21
Vs 129,129,21
Vs 130,130,21
Vs 131,131,21
Vs 132,132,21
Vs 133,133,21
Vs 134,134,21
Vs 135,135,21
Vs 136,136,21
Vs 137,137,21
Vs 138,138,21
Vs 139,139,21
Vs 140,140,21
Vs 141,141,21
Vs 142,142,21
Vs 143,143,21
Vs 192,192,21
Vs 193,193,21
Vs 194,194,21
Vs 195,195,21
Vs 196,196,21
Vs 197,197,21
Vs 198,198,21
Vs 199,199,21
Vs 200,200,21
Vs 201,201,21
Vs 202,202,21
Vs 203,203,21
Vs 204,204,21
Vs 205,205,21
Vs 206,206,21
Vs 207,207,21
Vs 32,32,21
Vs 33,33,21
Vs 34,34,21
v_sub_f32_e64 v35, v35, v21
v_exp_f32 v22, -v21
s_nop 0
Vm 48,48,22
Vm 49,49,22
Vm 50,50,22
v_mul_f32_e64 v51, v51, v22
Ar 8,0
Ar 9,1
Ar 10,2
Ar 11,3
Ar 12,4
Ar 13,5
Ar 14,6
Ar 15,7
Vm 8,8,22
Vm 9,9,22
Vm 10,10,22
Vm 11,11,22
Vm 12,12,22
Vm 13,13,22
Vm 14,14,22
Vm 15,15,22
Aw 0,8
Aw 1,9
Aw 2,10
Aw 3,11
Aw 4,12
Aw 5,13
Aw 6,14
Aw 7,15
Ar 8,8
Ar 9,9
Ar 10,10
Ar 11,11
Ar 12,12
Ar 13,13
Ar 14,14
Ar 15,15
Vm 8,8,22
Vm 9,9,22
Vm 10,10,22
Vm 11,11,22
Vm 12,12,22
Vm 13,13,22
Vm 14,14,22
Vm 15,15,22
Aw 8,8
Aw 9,9
Aw 10,10
Aw 11,11
Aw 12,12
Aw 13,13
Aw 14,14
Aw 15,15
Ar 8,16
Ar 9,17
Ar 10,18
Ar 11,19
Ar 12,20
Ar 13,21
Ar 14,22
Ar 15,23
Vm 8,8,22
Vm 9,9,22
Vm 10,10,22
Vm 11,11,22
Vm 12,12,22
Vm 13,13,22
Vm 14,14,22
Vm 15,15,22
Aw 16,8
Aw 17,9
Aw 18,10
Aw 19,11
Aw 20,12
Aw 21,13
Aw 22,14
Aw 23,15
Ar 8,24
Ar 9,25
Ar 10,26
Ar 11,27
Ar 12,28
Ar 13,29
Ar 14,30
Ar 15,31
Vm 8,8,22
Vm 9,9,22
Vm 10,10,22
Vm 11,11,22
Vm 12,12,22
Vm 13,13,22
Vm 14,14,22
Vm 15,15,22
Aw 24,8
Aw 25,9
Aw 26,10
Aw 27,11
Aw 28,12
Aw 29,13
Aw 30,14
Aw 31,15
v_max3_f32 v21, v144, v145, v146
v_max3_f32 v21, v21, v147, v148
v_max3_f32 v21, v21, v149, v150
v_max3_f32 v21, v21, v151, v152
v_max3_f32 v21, v21, v153, v154
v_max3_f32 v21, v21, v155, v156
v_max3_f32 v21, v21, v157, v158
v_max_f32 v21, v21, v159
v_mov_b32 v1, v21
s_nop 1
v_permlane16_swap_b32 v1, v21
v_max_f32 v21, v21, v1
v_mov_b32 v1, v21
s_nop 1
v_permlane32_swap_b32 v1, v21
v_max_f32_e64 v21, v21, v1
v_add_f32 v21, 0x41f80000, v21
v_max_f32 v21, 0, v21
Vs 144,144,21
Vs 145,145,21
Vs 146,146,21
Vs 147,147,21
Vs 148,148,21
Vs 149,149,21
Vs 150,150,21
Vs 151,151,21
Vs 152,152,21
Vs 153,153,21
Vs 154,154,21
Vs 155,155,21
Vs 156,156,21
Vs 157,157,21
Vs 158,158,21
Vs 159,159,21
Vs 36,36,21
Vs 37,37,21
Vs 38,38,21
v_sub_f32_e64 v39, v39, v21
v_exp_f32 v22, -v21
s_nop 0
Vm 52,52,22
Vm 53,53,22
Vm 54,54,22
v_mul_f32_e64 v55, v55, v22
Ar 8,32
Ar 9,33
Ar 10,34
Ar 11,35
Ar 12,36
Ar 13,37
Ar 14,38
Ar 15,39
Vm 8,8,22
Vm 9,9,22
Vm 10,10,22
Vm 11,11,22
Vm 12,12,22
Vm 13,13,22
Vm 14,14,22
Vm 15,15,22
Aw 32,8
Aw 33,9
Aw 34,10
Aw 35,11
Aw 36,12
Aw 37,13
Aw 38,14
Aw 39,15
Ar 8,40
Ar 9,41
Ar 10,42
Ar 11,43
Ar 12,44
Ar 13,45
Ar 14,46
Ar 15,47
Vm 8,8,22
Vm 9,9,22
Vm 10,10,22
Vm 11,11,22
Vm 12,12,22
Vm 13,13,22
Vm 14,14,22
Vm 15,15,22
Aw 40,8
Aw 41,9
Aw 42,10
Aw 43,11
Aw 44,12
Aw 45,13
Aw 46,14
Aw 47,15
Ar 8,48
Ar 9,49
Ar 10,50
Ar 11,51
Ar 12,52
Ar 13,53
Ar 14,54
Ar 15,55
Vm 8,8,22
Vm 9,9,22
Vm 10,10,22
Vm 11,11,22
Vm 12,12,22
Vm 13,13,22
Vm 14,14,22
Vm 15,15,22
Aw 48,8
Aw 49,9
Aw 50,10
Aw 51,11
Aw 52,12
Aw 53,13
Aw 54,14
Aw 55,15
Ar 8,56
Ar 9,57
Ar 10,58
Ar 11,59
Ar 12,60
Ar 13,61
Ar 14,62
Ar 15,63
Vm 8,8,22
Vm 9,9,22
Vm 10,10,22
Vm 11,11,22
Vm 12,12,22
Vm 13,13,22
Vm 14,14,22
Vm 15,15,22
Aw 56,8
Aw 57,9
Aw 58,10
Aw 59,11
Aw 60,12
Aw 61,13
Aw 62,14
Aw 63,15
Ve 8,128
Ve 9,129
s_nop 0
Vc 64,8,9
Ve 8,130
Ve 9,131
s_nop 0
Vc 65,8,9
Ve 8,144
Ve 9,145
s_nop 0
Vc 72,8,9
Ve 8,146
Ve 9,147
s_nop 0
Vc 73,8,9
Ve 8,132
Ve 9,133
s_nop 0
Vc 66,8,9
Ve 8,134
Ve 9,135
s_nop 0
Vc 67,8,9
Ve 8,148
Ve 9,149
s_nop 0
Vc 74,8,9
Ve 8,150
Ve 9,151
s_nop 0
Vc 75,8,9
Ve 8,136
Ve 9,137
s_nop 0
Vc 68,8,9
Ve 8,138
Ve 9,139
s_nop 0
Vc 69,8,9
Ve 8,152
Ve 9,153
s_nop 0
Vc 76,8,9
Ve 8,154
Ve 9,155
s_nop 0
Vc 77,8,9
Ve 8,140
Ve 9,141
s_nop 0
Vc 70,8,9
Ve 8,142
Ve 9,143
s_nop 0
Vc 71,8,9
Ve 8,156
Ve 9,157
s_nop 0
Vc 78,8,9
Ve 8,158
Ve 9,159
s_nop 0
Vc 79,8,9
s_nop 1
s_branch L_k2_fbr_nl
L_k2_fb_fi:
s_nop 7
s_nop 0
v_max3_f32 v21, v192, v193, v194
v_max3_f32 v21, v21, v195, v196
v_max3_f32 v21, v21, v197, v198
v_max3_f32 v21, v21, v199, v200
v_max3_f32 v21, v21, v201, v202
v_max3_f32 v21, v21, v203, v204
v_max3_f32 v21, v21, v205, v206
v_max_f32 v21, v21, v207
v_mov_b32 v1, v21
s_nop 1
v_permlane16_swap_b32 v1, v21
v_max_f32 v21, v21, v1
v_mov_b32 v1, v21
s_nop 1
v_permlane32_swap_b32 v1, v21
v_max_f32_e64 v21, v21, v1
v_add_f32 v21, 0x41f80000, v21
v_max_f32 v21, 0, v21
Vs 192,192,21
Vs 193,193,21
Vs 194,194,21
Vs 195,195,21
Vs 196,196,21
Vs 197,197,21
Vs 198,198,21
Vs 199,199,21
Vs 200,200,21
Vs 201,201,21
Vs 202,202,21
Vs 203,203,21
Vs 204,204,21
Vs 205,205,21
Vs 206,206,21
Vs 207,207,21
Vs 32,32,21
Vs 33,33,21
Vs 34,34,21
v_sub_f32_e64 v35, v35, v21
v_exp_f32 v22, -v21
s_nop 0
Vm 48,48,22
Vm 49,49,22
Vm 50,50,22
v_mul_f32_e64 v51, v51, v22
Ar 8,0
Ar 9,1
Ar 10,2
Ar 11,3
Ar 12,4
Ar 13,5
Ar 14,6
Ar 15,7
Vm 8,8,22
Vm 9,9,22
Vm 10,10,22
Vm 11,11,22
Vm 12,12,22
Vm 13,13,22
Vm 14,14,22
Vm 15,15,22
Aw 0,8
Aw 1,9
Aw 2,10
Aw 3,11
Aw 4,12
Aw 5,13
Aw 6,14
Aw 7,15
Ar 8,8
Ar 9,9
Ar 10,10
Ar 11,11
Ar 12,12
Ar 13,13
Ar 14,14
Ar 15,15
Vm 8,8,22
Vm 9,9,22
Vm 10,10,22
Vm 11,11,22
Vm 12,12,22
Vm 13,13,22
Vm 14,14,22
Vm 15,15,22
Aw 8,8
Aw 9,9
Aw 10,10
Aw 11,11
Aw 12,12
Aw 13,13
Aw 14,14
Aw 15,15
Ar 8,16
Ar 9,17
Ar 10,18
Ar 11,19
Ar 12,20
Ar 13,21
Ar 14,22
Ar 15,23
Vm 8,8,22
Vm 9,9,22
Vm 10,10,22
Vm 11,11,22
Vm 12,12,22
Vm 13,13,22
Vm 14,14,22
Vm 15,15,22
Aw 16,8
Aw 17,9
Aw 18,10
Aw 19,11
Aw 20,12
Aw 21,13
Aw 22,14
Aw 23,15
Ar 8,24
Ar 9,25
Ar 10,26
Ar 11,27
Ar 12,28
Ar 13,29
Ar 14,30
Ar 15,31
Vm 8,8,22
Vm 9,9,22
Vm 10,10,22
Vm 11,11,22
Vm 12,12,22
Vm 13,13,22
Vm 14,14,22
Vm 15,15,22
Aw 24,8
Aw 25,9
Aw 26,10
Aw 27,11
Aw 28,12
Aw 29,13
Aw 30,14
Aw 31,15
Ve 8,192
Ve 9,193
s_nop 0
Vc 96,8,9
Ve 8,194
Ve 9,195
s_nop 0
Vc 97,8,9
Ve 8,196
Ve 9,197
s_nop 0
Vc 98,8,9
Ve 8,198
Ve 9,199
s_nop 0
Vc 99,8,9
Ve 8,200
Ve 9,201
s_nop 0
Vc 100,8,9
Ve 8,202
Ve 9,203
s_nop 0
Vc 101,8,9
Ve 8,204
Ve 9,205
s_nop 0
Vc 102,8,9
Ve 8,206
Ve 9,207
s_nop 0
Vc 103,8,9
s_nop 1
s_branch L_k2_fbr_fi
L_spinX:
s_mov_b32 s47, 0x400000
L_spinXl:
buffer_load_dword v17, v126, s[20:23], s24 offen sc1
s_sub_u32 s47, s47, 1
s_waitcnt vmcnt(0)
s_cmp_eq_u32 s47, 0
s_cbranch_scc1 L_spinXlx
v_cmp_ne_u32 vcc, 1, v17
s_cbranch_vccz L_spinXlx
s_sleep 1
s_branch L_spinXl
L_spinXlx:
buffer_load_dwordx4 v[160:163], v112, s[16:19], s25 offen offset:0 sc1
buffer_load_dwordx4 v[164:167], v112, s[16:19], s25 offen offset:1024 sc1
buffer_load_dwordx4 v[168:171], v112, s[16:19], s25 offen offset:2048 sc1
buffer_load_dwordx4 v[172:175], v112, s[16:19], s25 offen offset:3072 sc1
buffer_load_dwordx4 v[176:179], v10, s[16:19], s25 offen offset:0 sc1
buffer_load_dwordx4 v[180:183], v10, s[16:19], s25 offen offset:1024 sc1
buffer_load_dwordx4 v[184:187], v10, s[16:19], s25 offen offset:2048 sc1
buffer_load_dwordx4 v[188:191], v10, s[16:19], s25 offen offset:3072 sc1
s_branch L_spinXr
L_ysl:
s_mov_b32 s47, 0x400000
L_ysll:
buffer_load_dword v124, v127, s[20:23], s41 offen sc1
s_sub_u32 s47, s47, 1
s_waitcnt vmcnt(0)
s_cmp_eq_u32 s47, 0
s_cbranch_scc1 L_ysllx
v_cmp_ne_u32 vcc, 1, v124
s_cbranch_vccz L_ysllx
s_sleep 8
s_branch L_ysll
L_ysllx:
v_lshlrev_b32 v124, 2, v0
v_lshlrev_b32 v125, 1, v0
s_lshl_b32 s7, s45, 2
s_add_u32 s7, s7, s32
s_lshr_b32 s3, s42, 5
s_cmp_lg_u32 s3, s7
s_cbranch_scc1 L_f_yl13
s_add_u32 s3, s55, 0
s_nop 0
s_add_u32 s7, s3, 4096
buffer_load_dword v76, v124, s[20:23], s3 offen offset:0 sc1
buffer_load_dword v77, v124, s[20:23], s3 offen offset:512 sc1
buffer_load_dword v78, v124, s[20:23], s3 offen offset:1024 sc1
buffer_load_dword v79, v124, s[20:23], s3 offen offset:1536 sc1
buffer_load_dword v80, v124, s[20:23], s3 offen offset:2048 sc1
buffer_load_dword v81, v124, s[20:23], s3 offen offset:2560 sc1
buffer_load_dword v82, v124, s[20:23], s3 offen offset:3072 sc1
buffer_load_dword v83, v124, s[20:23], s3 offen offset:3584 sc1
buffer_load_dword v84, v124, s[20:23], s7 offen offset:0 sc1
buffer_load_dword v85, v124, s[20:23], s7 offen offset:512 sc1
buffer_load_dword v86, v124, s[20:23], s7 offen offset:1024 sc1
buffer_load_dword v87, v124, s[20:23], s7 offen offset:1536 sc1
buffer_load_dword v88, v124, s[20:23], s7 offen offset:2048 sc1
buffer_load_dword v89, v124, s[20:23], s7 offen offset:2560 sc1
s_lshl_b32 s3, s42, 11
s_lshl_b32 s7, s46, 7
s_add_u32 s3, s3, s7
buffer_load_ushort v90, v125, s[56:59], s3 offen
s_lshl_b32 s3, s42, 3
s_add_u32 s3, s3, 5259264
buffer_load_dwordx2 v[92:93], v126, s[20:23], s3 offen sc1
L_f_yl13:
s_lshl_b32 s7, s45, 2
s_add_u32 s7, s7, s32
s_lshr_b32 s3, s43, 5
s_cmp_lg_u32 s3, s7
s_cbranch_scc1 L_f_yl14
s_nop 0
s_add_u32 s3, s55, 256
s_add_u32 s7, s3, 4096
buffer_load_dword v94, v124, s[20:23], s3 offen offset:0 sc1
buffer_load_dword v95, v124, s[20:23], s3 offen offset:512 sc1
buffer_load_dword v96, v124, s[20:23], s3 offen offset:1024 sc1
buffer_load_dword v97, v124, s[20:23], s3 offen offset:1536 sc1
buffer_load_dword v98, v124, s[20:23], s3 offen offset:2048 sc1
buffer_load_dword v99, v124, s[20:23], s3 offen offset:2560 sc1
buffer_load_dword v100, v124, s[20:23], s3 offen offset:3072 sc1
buffer_load_dword v101, v124, s[20:23], s3 offen offset:3584 sc1
buffer_load_dword v102, v124, s[20:23], s7 offen offset:0 sc1
buffer_load_dword v103, v124, s[20:23], s7 offen offset:512 sc1
buffer_load_dword v104, v124, s[20:23], s7 offen offset:1024 sc1
buffer_load_dword v105, v124, s[20:23], s7 offen offset:1536 sc1
buffer_load_dword v106, v124, s[20:23], s7 offen offset:2048 sc1
buffer_load_dword v107, v124, s[20:23], s7 offen offset:2560 sc1
s_lshl_b32 s3, s43, 11
s_lshl_b32 s7, s46, 7
s_add_u32 s3, s3, s7
buffer_load_ushort v108, v125, s[56:59], s3 offen
s_lshl_b32 s3, s43, 3
s_add_u32 s3, s3, 5259264
buffer_load_dwordx2 v[110:111], v126, s[20:23], s3 offen sc1
L_f_yl14:
s_waitcnt vmcnt(0)
s_lshl_b32 s7, s45, 2
s_add_u32 s7, s7, s32
s_lshr_b32 s3, s42, 5
s_cmp_lg_u32 s3, s7
s_cbranch_scc1 L_f_ys15
v_pk_add_f32 v[76:77], v[76:77], v[78:79]
v_pk_add_f32 v[76:77], v[76:77], v[80:81]
v_pk_add_f32 v[76:77], v[76:77], v[82:83]
v_pk_add_f32 v[76:77], v[76:77], v[84:85]
v_pk_add_f32 v[76:77], v[76:77], v[86:87]
v_pk_add_f32 v[76:77], v[76:77], v[88:89]
Va 76,76,77
v_lshlrev_b32 v90, 16, v90
v_sub_f32_e64 v90, v90, v92
Vc 76,76,76
v_lshlrev_b32_e64 v76, 16, v76
Vc 90,90,90
v_lshlrev_b32 v90, 16, v90
v_mul_f32 v76, s100, v76
v_mul_f32_e64 v90, v90, v93
Vc 76,76,76
v_lshlrev_b32_e64 v76, 16, v76
Vc 90,90,90
v_lshlrev_b32 v90, 16, v90
Va 90,90,76
Vc 90,90,90
v_lshlrev_b32_e64 v90, 16, v90
v_mul_f32 v76, 0xbfb8aa3b, v90
Ve 76,76
s_nop 0
v_add_f32 v76, 1.0, v76
v_rcp_f32 v76, v76
s_nop 0
Vm 90,90,76
Vc 90,90,90
v_lshlrev_b32 v90, 16, v90
v_lshlrev_b32 v124, 2, v0
v_add_u32 v124, s35, v124
v_lshlrev_b32 v125, 5, v122
v_add_u32 v125, s35, v125
s_waitcnt lgkmcnt(0)
ds_write_b32 v124, v90
s_and_b32 s3, s42, 7
s_lshl_b32 s3, s3, 3
s_lshl_b64 s[4:5], 0xff, s3
s_bfe_u32 s3, s42, 0x20003
s_mov_b64 exec, s[4:5]
s_cmp_lg_u32 s3, 0
s_cbranch_scc1 L_f_yp16
ds_read_b64 v[42:43], v125
ds_read_b64 v[44:45], v125 offset:8
ds_read_b64 v[46:47], v125 offset:16
ds_read_b64 v[48:49], v125 offset:24
L_f_yp16:
s_cmp_lg_u32 s3, 1
s_cbranch_scc1 L_f_yp17
ds_read_b64 v[50:51], v125
ds_read_b64 v[52:53], v125 offset:8
ds_read_b64 v[54:55], v125 offset:16
ds_read_b64 v[56:57], v125 offset:24
L_f_yp17:
s_cmp_lg_u32 s3, 2
s_cbranch_scc1 L_f_yp18
ds_read_b64 v[58:59], v125
ds_read_b64 v[60:61], v125 offset:8
ds_read_b64 v[62:63], v125 offset:16
ds_read_b64 v[64:65], v125 offset:24
L_f_yp18:
s_cmp_lg_u32 s3, 3
s_cbranch_scc1 L_f_yp19
ds_read_b64 v[66:67], v125
ds_read_b64 v[68:69], v125 offset:8
s_waitcnt lgkmcnt(9)
ds_read_b64 v[70:71], v125 offset:16
ds_read_b64 v[72:73], v125 offset:24
L_f_yp19:
s_mov_b64 exec, -1
s_waitcnt lgkmcnt(0)
L_f_ys15:
s_lshl_b32 s7, s45, 2
s_add_u32 s7, s7, s32
s_lshr_b32 s3, s43, 5
s_cmp_lg_u32 s3, s7
s_cbranch_scc1 L_f_ys20
s_nop 0
v_pk_add_f32 v[94:95], v[94:95], v[96:97]
v_pk_add_f32 v[94:95], v[94:95], v[98:99]
v_pk_add_f32 v[94:95], v[94:95], v[100:101]
v_pk_add_f32 v[94:95], v[94:95], v[102:103]
v_pk_add_f32 v[94:95], v[94:95], v[104:105]
v_pk_add_f32 v[94:95], v[94:95], v[106:107]
Va 94,94,95
v_lshlrev_b32 v108, 16, v108
v_sub_f32_e64 v108, v108, v110
Vc 94,94,94
v_lshlrev_b32_e64 v94, 16, v94
Vc 108,108,108
v_lshlrev_b32 v108, 16, v108
v_mul_f32 v94, s101, v94
v_mul_f32_e64 v108, v108, v111
Vc 94,94,94
v_lshlrev_b32_e64 v94, 16, v94
Vc 108,108,108
v_lshlrev_b32 v108, 16, v108
Va 108,108,94
Vc 108,108,108
v_lshlrev_b32_e64 v108, 16, v108
v_mul_f32 v94, 0xbfb8aa3b, v108
Ve 94,94
s_nop 0
v_add_f32 v94, 1.0, v94
v_rcp_f32 v94, v94
s_nop 0
Vm 108,108,94
Vc 108,108,108
v_lshlrev_b32 v108, 16, v108
v_lshlrev_b32 v124, 2, v0
v_add_u32 v124, s35, v124
v_lshlrev_b32 v125, 5, v122
v_add_u32 v125, s35, v125
s_waitcnt lgkmcnt(0)
ds_write_b32 v124, v108
s_and_b32 s3, s43, 7
s_lshl_b32 s3, s3, 3
s_lshl_b64 s[4:5], 0xff, s3
s_bfe_u32 s3, s43, 0x20003
s_mov_b64 exec, s[4:5]
s_cmp_lg_u32 s3, 0
s_cbranch_scc1 L_f_yp21
ds_read_b64 v[42:43], v125
ds_read_b64 v[44:45], v125 offset:8
ds_read_b64 v[46:47], v125 offset:16
ds_read_b64 v[48:49], v125 offset:24
L_f_yp21:
s_cmp_lg_u32 s3, 1
s_cbranch_scc1 L_f_yp22
ds_read_b64 v[50:51], v125
ds_read_b64 v[52:53], v125 offset:8
ds_read_b64 v[54:55], v125 offset:16
ds_read_b64 v[56:57], v125 offset:24
L_f_yp22:
s_cmp_lg_u32 s3, 2
s_cbranch_scc1 L_f_yp23
ds_read_b64 v[58:59], v125
ds_read_b64 v[60:61], v125 offset:8
ds_read_b64 v[62:63], v125 offset:16
ds_read_b64 v[64:65], v125 offset:24
L_f_yp23:
s_cmp_lg_u32 s3, 3
s_cbranch_scc1 L_f_yp24
ds_read_b64 v[66:67], v125
ds_read_b64 v[68:69], v125 offset:8
s_waitcnt lgkmcnt(9)
ds_read_b64 v[70:71], v125 offset:16
ds_read_b64 v[72:73], v125 offset:24
L_f_yp24:
s_mov_b64 exec, -1
s_waitcnt lgkmcnt(0)
L_f_ys20:
s_branch L_yslr
.section .rodata,"a"
.p2align 6
.amdhsa_kernel recurrent_scan__compressed_kv_cla__moe_arch_mod__prompt_kernel
  .amdhsa_next_free_vgpr 512
  .amdhsa_next_free_sgpr 102
  .amdhsa_accum_offset 256
  .amdhsa_group_segment_fixed_size 0
  .amdhsa_kernarg_size 112
  .amdhsa_user_sgpr_count 2
  .amdhsa_user_sgpr_kernarg_segment_ptr 1
  .amdhsa_system_sgpr_workgroup_id_x 1
.end_amdhsa_kernel
```

```asm
; @launch grid=(256,1,1) block=(256,1,1) lds=163840
.amdgcn_target "amdgcn-amd-amdhsa--gfx950"
.macro Va d,x,y
v_add_f32 v\d, v\x, v\y
.endm
.macro Vc d,x,y
v_cvt_pk_bf16_f32 v\d, v\x, v\y
.endm
.macro Ra d,x,o
ds_read_b128 a[\d:\d+3], v\x offset:\o
.endm
.macro Ta d,x,o
ds_read_b64_tr_b16 a[\d:\d+1], v\x offset:\o
.endm
.macro Zvaa d,x,y
v_mfma_f32_16x16x32_bf16 v[\d:\d+3], a[\x:\x+3], a[\y:\y+3], 0
.endm
.macro Mvaa d,x,y
v_mfma_f32_16x16x32_bf16 v[\d:\d+3], a[\x:\x+3], a[\y:\y+3], v[\d:\d+3]
.endm
.macro Rv d,x,o
ds_read_b128 v[\d:\d+3], v\x offset:\o
.endm
.macro Zaaa d,x,y
v_mfma_f32_16x16x32_bf16 a[\d:\d+3], a[\x:\x+3], a[\y:\y+3], 0
.endm
.macro Maaa d,x,y
v_mfma_f32_16x16x32_bf16 a[\d:\d+3], a[\x:\x+3], a[\y:\y+3], a[\d:\d+3]
.endm
.macro Ar d,x
v_accvgpr_read_b32 v\d, a\x
.endm
.macro Ve d,x
v_exp_f32 v\d, v\x
.endm
.macro Aw d,x
v_accvgpr_write_b32 a\d, v\x
.endm
.macro Vs d,x,y
v_sub_f32 v\d, v\x, v\y
.endm
.macro Cvaa d,x,y,c
v_mfma_f32_16x16x32_bf16 v[\d:\d+3], a[\x:\x+3], a[\y:\y+3], v[\c:\c+3]
.endm
.macro VE d,x
v_exp_f32_e64 v\d, v\x
.endm
.macro Maav d,x,y
v_mfma_f32_16x16x32_bf16 a[\d:\d+3], a[\x:\x+3], v[\y:\y+3], a[\d:\d+3]
.endm
.macro Mvvv d,x,y
v_mfma_f32_16x16x32_bf16 v[\d:\d+3], v[\x:\x+3], v[\y:\y+3], v[\d:\d+3]
.endm
.macro Zvva d,x,y
v_mfma_f32_16x16x32_bf16 v[\d:\d+3], v[\x:\x+3], a[\y:\y+3], 0
.endm
.macro Mvva d,x,y
v_mfma_f32_16x16x32_bf16 v[\d:\d+3], v[\x:\x+3], a[\y:\y+3], v[\d:\d+3]
.endm
.macro Vm d,x,y
v_mul_f32 v\d, v\x, v\y
.endm
.macro Zvvv d,x,y
v_mfma_f32_16x16x32_bf16 v[\d:\d+3], v[\x:\x+3], v[\y:\y+3], 0
.endm
.text
.globl recurrent_scan__compressed_kv_cla__moe_arch_mod__prompt_kernel
.p2align 8
.type recurrent_scan__compressed_kv_cla__moe_arch_mod__prompt_kernel,@function
recurrent_scan__compressed_kv_cla__moe_arch_mod__prompt_kernel:
s_cmp_ge_u32 s2, 256
s_cbranch_scc1 L_k2_end
s_load_dwordx4 s[4:7], s[0:1], 0
s_load_dwordx2 s[44:45], s[0:1], 56
s_load_dwordx4 s[40:43], s[0:1], 24
s_load_dwordx4 s[64:67], s[0:1], 96
v_lshrrev_b32 v1, 6, v0
v_and_b32 v0, 63, v0
v_readfirstlane_b32 s32, v1
s_getpc_b64 s[68:69]
L_cpf1:
s_add_u32 s68, s68, (recurrent_scan__compressed_kv_cla__moe_arch_mod__prompt_kernel-L_cpf1)&0xffffffff
s_addc_u32 s69, s69, ((recurrent_scan__compressed_kv_cla__moe_arch_mod__prompt_kernel-L_cpf1)>>32)&0xffffffff
s_lshr_b32 s70, s2, 3
s_lshl_b32 s70, s70, 2
s_add_u32 s70, s70, s32
s_lshl_b32 s70, s70, 10
v_and_b32 v122, 7, v0
v_lshlrev_b32 v122, 7, v122
v_add_u32 v122, s70, v122
v_min_u32 v122, L_k2_fin-recurrent_scan__compressed_kv_cla__moe_arch_mod__prompt_kernel-4, v122
v_mov_b32 v121, s69
v_add_co_u32 v120, vcc, s68, v122
s_nop 1
v_addc_co_u32 v121, vcc, 0, v121, vcc
global_load_dword v124, v[120:121], off
v_lshrrev_b32 v33, 5, v0
v_and_b32 v31, 31, v0
v_lshlrev_b32_e64 v36, 4, v31
v_lshl_add_u32 v35, v33, 11, v36
s_lshl_b32 s36, s2, 14
s_lshl_b32 s37, s32, 12
s_add_u32 s36, s36, s37
s_mov_b32 s18, 4194304
s_mov_b32 s19, 0x20000
s_bfe_u32 s33, s2, 0x30003
s_lshr_b32 s35, s2, 7
s_bfe_u32 s3, s2, 0x10006
s_and_b32 s34, s2, 7
s_lshl_b32 s34, s34, 1
s_add_u32 s34, s34, s3
s_waitcnt lgkmcnt(0)
s_mov_b32 s16, s4
s_and_b32 s17, s5, 0xffff
buffer_load_dwordx4 v[48:51], v35, s[16:19], s36 offen offset:0
buffer_load_dwordx4 v[52:55], v35, s[16:19], s36 offen offset:512
buffer_load_dwordx4 v[56:59], v35, s[16:19], s36 offen offset:1024
buffer_load_dwordx4 v[60:63], v35, s[16:19], s36 offen offset:1536
s_cmp_eq_u32 s35, 0
s_cselect_b32 s40, s40, s42
s_cselect_b32 s41, s41, s43
s_lshl_b32 s3, s34, 9
s_add_u32 s12, s40, s3
s_addc_u32 s13, s41, 0
s_and_b32 s13, s13, 0xffff
s_mov_b32 s14, 0
s_mov_b32 s15, 0x20000
s_sub_u32 s14, 4194304, s3
s_lshl_b32 s3, s33, 18
s_add_u32 s8, s6, s3
s_addc_u32 s9, s7, 0
s_and_b32 s9, s9, 0xffff
s_mov_b32 s10, 262144
s_mov_b32 s11, 0x20000
s_and_b32 s58, s2, 7
s_mov_b32 s52, 0
s_mov_b32 s53, 15360
s_mov_b32 s54, 30720
s_mov_b32 s55, 46080
s_lshl_b32 s57, s32, 13
s_add_u32 s56, s57, 32768
s_lshl_b32 s3, s58, 2
s_add_u32 s3, s3, s32
s_lshl_b32 s3, s3, 4
v_add_u32 v30, s3, v33
v_lshlrev_b32 v30, 13, v30
v_lshlrev_b32 v34, 5, v33
v_xor_b32 v34, v34, v36
v_add_u32 v6, v34, v30
v_xor_b32_e64 v7, 64, v6
v_xor_b32 v8, 65664, v6
v_xor_b32 v9, 65728, v6
s_add_u32 m0, s57, 0
s_nop 0
buffer_load_dwordx4 v6, s[12:15], s52 offen offset:0 lds
buffer_load_dwordx4 v7, s[12:15], s53 offen offset:1024 lds
buffer_load_dwordx4 v6, s[12:15], s54 offen offset:2048 lds
buffer_load_dwordx4 v7, s[12:15], s55 offen offset:3072 lds
s_add_u32 m0, s57, 4096
s_nop 0
s_nop 0
buffer_load_dwordx4 v8, s[12:15], s52 offen offset:0 lds
buffer_load_dwordx4 v9, s[12:15], s53 offen offset:1024 lds
buffer_load_dwordx4 v8, s[12:15], s54 offen offset:2048 lds
buffer_load_dwordx4 v9, s[12:15], s55 offen offset:3072 lds
v_xor_b32 v6, 524288, v6
v_xor_b32 v7, 524288, v7
v_xor_b32 v8, 524288, v8
v_xor_b32 v9, 524288, v9
s_mov_b32 s48, 0
s_mov_b32 s49, 7168
s_mov_b32 s50, 14336
s_mov_b32 s51, 21504
v_lshrrev_b32 v30, 3, v0
v_lshlrev_b32 v30, 10, v30
s_lshl_b32 s3, s32, 16
s_lshl_b32 s39, s58, 7
s_add_u32 s3, s3, s39
v_and_b32 v31, 7, v0
v_lshrrev_b32 v32, 4, v0
v_xor_b32_e64 v31, v31, v32
v_lshl_add_u32 v30, v31, 4, v30
v_add_u32 v2, s3, v30
v_xor_b32 v3, 64, v2
v_xor_b32 v4, 32768, v2
v_xor_b32 v5, 32832, v2
s_cmp_lt_u32 s32, 2
s_cselect_b32 s60, s8, s12
s_cselect_b32 s61, s9, s13
s_cselect_b32 s62, s10, s14
s_mov_b32 s63, 0x20000
s_mov_b32 s59, 524288
s_cselect_b32 s59, 128, s59
s_cselect_b64 vcc, -1, 0
s_cselect_b32 s38, 32, 16
s_lshr_b32 s3, s2, 6
s_cmp_lt_u32 s32, 2
s_cselect_b32 s3, s3, s33
s_lshl_b32 s3, s3, 1
s_and_b32 s39, s32, 1
s_add_u32 s3, s3, s39
s_lshl_b32 s3, s3, 15
s_xor_b32 s39, s58, 2
s_mul_i32 s39, s39, s59
s_add_u32 s3, s3, s39
v_lshlrev_b32 v37, 10, v0
v_lshrrev_b32 v38, 2, v0
v_lshlrev_b32 v38, 13, v38
v_and_b32 v39, 3, v0
v_lshl_add_u32 v38, v39, 7, v38
v_cndmask_b32 v47, v38, v37, vcc
v_add_u32 v47, s3, v47
v_cmp_gt_u32 vcc, s38, v0
v_mov_b32 v37, 2146435072
s_nop 0
v_cndmask_b32 v47, v37, v47, vcc
s_mov_b32 s20, s66
s_and_b32 s21, s67, 0xffff
s_mov_b32 s22, 8388608
s_mov_b32 s23, 0x20000
s_add_u32 s24, s66, 8388608
s_addc_u32 s25, s67, 0
s_and_b32 s25, s25, 0xffff
s_mov_b32 s26, 35717120
s_mov_b32 s27, 0x20000
v_lshrrev_b32 v32, 4, v0
v_and_b32 v30, 15, v0
s_lshr_b32 s3, s32, 1
s_lshl_b32 s3, s3, 14
s_add_u32 s3, s3, 32768
v_lshlrev_b32 v31, 7, v30
v_add_u32 v31, s3, v31
v_lshrrev_b32 v34, 1, v30
v_xor_b32_e64 v34, v34, v32
v_lshl_add_u32 v10, v34, 4, v31
v_xor_b32 v11, 64, v10
v_lshrrev_b32 v30, 2, v30
v_lshl_add_u32 v31, v32, 3, v30
v_lshlrev_b32 v31, 9, v31
v_and_b32 v34, 3, v0
v_lshl_add_u32 v31, v34, 3, v31
s_and_b32 s3, s32, 1
s_lshl_b32 s3, s3, 8
v_add_u32 v31, s3, v31
v_and_b32 v34, 1, v32
v_lshl_add_u32 v30, v34, 2, v30
v_lshl_add_u32 v16, v30, 5, v31
v_xor_b32 v17, 32, v16
v_xor_b32 v18, 64, v16
v_xor_b32 v19, 96, v16
v_xor_b32 v20, 128, v16
v_xor_b32 v21, 160, v16
v_xor_b32 v22, 192, v16
v_xor_b32 v23, 224, v16
v_add_u32 v12, 65536, v10
v_add_u32 v13, 65536, v11
v_add_u32 v14, 65536, v16
v_add_u32 v15, 65536, v17
v_add_u32 v24, 65536, v18
v_add_u32 v25, 65536, v19
v_add_u32 v26, 65536, v20
v_add_u32 v27, 65536, v21
v_add_u32 v28, 65536, v22
v_add_u32 v29, 65536, v23
s_mov_b32 s28, s44
s_nop 0
s_and_b32 s29, s45, 0xffff
s_mov_b32 s30, 2048
s_mov_b32 s31, 0x20000
buffer_load_dwordx4 v[64:67], v36, s[28:31], 0 offen offset:0
buffer_load_dwordx4 v[68:71], v36, s[28:31], 0 offen offset:512
buffer_load_dwordx4 v[72:75], v36, s[28:31], 0 offen offset:1024
buffer_load_dwordx4 v[76:79], v36, s[28:31], 0 offen offset:1536
s_waitcnt vmcnt(12)
v_lshlrev_b32 v80, 16, v48
v_and_b32 v81, 0xffff0000, v48
v_lshlrev_b32_e64 v82, 16, v49
v_and_b32 v83, 0xffff0000, v49
v_lshlrev_b32_e64 v84, 16, v50
v_and_b32 v85, 0xffff0000, v50
v_lshlrev_b32_e64 v86, 16, v51
v_and_b32 v87, 0xffff0000, v51
v_lshlrev_b32_e64 v88, 16, v52
v_and_b32 v89, 0xffff0000, v52
v_lshlrev_b32_e64 v90, 16, v53
v_and_b32 v91, 0xffff0000, v53
v_lshlrev_b32_e64 v92, 16, v54
v_and_b32 v93, 0xffff0000, v54
v_lshlrev_b32_e64 v94, 16, v55
v_and_b32 v95, 0xffff0000, v55
v_lshlrev_b32_e64 v96, 16, v56
v_and_b32 v97, 0xffff0000, v56
v_lshlrev_b32_e64 v98, 16, v57
v_and_b32 v99, 0xffff0000, v57
v_lshlrev_b32_e64 v100, 16, v58
v_and_b32 v101, 0xffff0000, v58
v_lshlrev_b32_e64 v102, 16, v59
v_and_b32 v103, 0xffff0000, v59
v_lshlrev_b32_e64 v104, 16, v60
v_and_b32 v105, 0xffff0000, v60
v_lshlrev_b32_e64 v106, 16, v61
v_and_b32 v107, 0xffff0000, v61
v_lshlrev_b32_e64 v108, 16, v62
v_and_b32 v109, 0xffff0000, v62
v_lshlrev_b32_e64 v110, 16, v63
v_and_b32 v111, 0xffff0000, v63
v_pk_add_f32 v[40:41], v[80:81], v[82:83]
v_pk_add_f32 v[42:43], v[84:85], v[86:87]
v_pk_add_f32 v[40:41], v[40:41], v[88:89]
v_pk_add_f32 v[42:43], v[42:43], v[90:91]
v_pk_add_f32 v[40:41], v[40:41], v[92:93]
v_pk_add_f32 v[42:43], v[42:43], v[94:95]
v_pk_add_f32 v[40:41], v[40:41], v[96:97]
v_pk_add_f32 v[42:43], v[42:43], v[98:99]
v_pk_add_f32 v[40:41], v[40:41], v[100:101]
v_pk_add_f32 v[42:43], v[42:43], v[102:103]
v_pk_add_f32 v[40:41], v[40:41], v[104:105]
v_pk_add_f32 v[42:43], v[42:43], v[106:107]
v_pk_add_f32 v[40:41], v[40:41], v[108:109]
v_pk_add_f32 v[42:43], v[42:43], v[110:111]
v_pk_add_f32 v[40:41], v[40:41], v[42:43]
Va 38,40,41
s_nop 1
v_add_f32_dpp v38, v38, v38 quad_perm:[1,0,3,2] row_mask:0xf bank_mask:0xf
s_nop 1
v_add_f32_dpp v38, v38, v38 quad_perm:[2,3,0,1] row_mask:0xf bank_mask:0xf
s_nop 1
v_add_f32_dpp v38, v38, v38 row_half_mirror row_mask:0xf bank_mask:0xf
s_nop 1
v_add_f32_dpp v38, v38, v38 row_mirror row_mask:0xf bank_mask:0xf
v_mov_b32 v37, v38
s_nop 1
v_permlane16_swap_b32 v37, v38
Va 38,38,37
s_add_u32 m0, s56, 0
s_nop 0
buffer_load_dwordx4 v2, s[8:11], s48 offen offset:0 lds
buffer_load_dwordx4 v3, s[8:11], s49 offen offset:1024 lds
buffer_load_dwordx4 v2, s[8:11], s50 offen offset:2048 lds
buffer_load_dwordx4 v3, s[8:11], s51 offen offset:3072 lds
s_add_u32 m0, s56, 4096
s_nop 0
buffer_load_dwordx4 v4, s[8:11], s48 offen offset:0 lds
buffer_load_dwordx4 v5, s[8:11], s49 offen offset:1024 lds
buffer_load_dwordx4 v4, s[8:11], s50 offen offset:2048 lds
buffer_load_dwordx4 v5, s[8:11], s51 offen offset:3072 lds
v_xor_b32 v2, 128, v2
v_xor_b32 v3, 128, v3
v_xor_b32 v4, 128, v4
v_xor_b32 v5, 128, v5
v_mul_f32 v38, 0xba800000, v38
v_mov_b32_e64 v39, v38
v_pk_add_f32 v[112:113], v[80:81], v[38:39]
v_pk_mul_f32 v[40:41], v[112:113], v[112:113]
v_pk_add_f32 v[114:115], v[82:83], v[38:39]
v_pk_mul_f32 v[42:43], v[114:115], v[114:115]
v_pk_add_f32 v[116:117], v[84:85], v[38:39]
v_pk_fma_f32 v[40:41], v[116:117], v[116:117], v[40:41]
v_pk_add_f32 v[118:119], v[86:87], v[38:39]
v_pk_fma_f32 v[42:43], v[118:119], v[118:119], v[42:43]
v_pk_add_f32 v[112:113], v[88:89], v[38:39]
v_pk_fma_f32 v[40:41], v[112:113], v[112:113], v[40:41]
v_pk_add_f32 v[114:115], v[90:91], v[38:39]
v_pk_fma_f32 v[42:43], v[114:115], v[114:115], v[42:43]
v_pk_add_f32 v[116:117], v[92:93], v[38:39]
v_pk_fma_f32 v[40:41], v[116:117], v[116:117], v[40:41]
v_pk_add_f32 v[118:119], v[94:95], v[38:39]
v_pk_fma_f32 v[42:43], v[118:119], v[118:119], v[42:43]
v_pk_add_f32 v[112:113], v[96:97], v[38:39]
v_pk_fma_f32 v[40:41], v[112:113], v[112:113], v[40:41]
v_pk_add_f32 v[114:115], v[98:99], v[38:39]
v_pk_fma_f32 v[42:43], v[114:115], v[114:115], v[42:43]
v_pk_add_f32 v[116:117], v[100:101], v[38:39]
v_pk_fma_f32 v[40:41], v[116:117], v[116:117], v[40:41]
v_pk_add_f32 v[118:119], v[102:103], v[38:39]
v_pk_fma_f32 v[42:43], v[118:119], v[118:119], v[42:43]
v_pk_add_f32 v[112:113], v[104:105], v[38:39]
v_pk_fma_f32 v[40:41], v[112:113], v[112:113], v[40:41]
v_pk_add_f32 v[114:115], v[106:107], v[38:39]
v_pk_fma_f32 v[42:43], v[114:115], v[114:115], v[42:43]
v_pk_add_f32 v[116:117], v[108:109], v[38:39]
v_pk_fma_f32 v[40:41], v[116:117], v[116:117], v[40:41]
v_pk_add_f32 v[118:119], v[110:111], v[38:39]
v_pk_fma_f32 v[42:43], v[118:119], v[118:119], v[42:43]
v_pk_add_f32 v[40:41], v[40:41], v[42:43]
Va 40,40,41
s_nop 1
v_add_f32_dpp v40, v40, v40 quad_perm:[1,0,3,2] row_mask:0xf bank_mask:0xf
s_nop 1
v_add_f32_dpp v40, v40, v40 quad_perm:[2,3,0,1] row_mask:0xf bank_mask:0xf
s_nop 1
v_add_f32_dpp v40, v40, v40 row_half_mirror row_mask:0xf bank_mask:0xf
s_nop 1
v_add_f32_dpp v40, v40, v40 row_mirror row_mask:0xf bank_mask:0xf
v_mov_b32 v37, v40
s_nop 1
v_permlane16_swap_b32 v37, v40
v_add_f32_e64 v40, v40, v37
v_mul_f32 v40, 0x3a800000, v40
Vc 44,38,40
v_lshlrev_b32_e64 v38, 16, v44
v_and_b32 v40, 0xffff0000, v44
v_add_f32 v40, 0x3727c5ac, v40
Vc 44,40,40
v_lshlrev_b32 v40, 16, v44
v_sqrt_f32 v40, v40
v_mov_b32_e64 v39, v38
Vc 44,40,40
v_lshlrev_b32 v44, 16, v44
v_rcp_f32 v40, v44
v_pk_add_f32 v[80:81], v[80:81], v[38:39]
v_pk_add_f32 v[82:83], v[82:83], v[38:39]
v_pk_add_f32 v[84:85], v[84:85], v[38:39]
v_pk_add_f32 v[86:87], v[86:87], v[38:39]
v_pk_add_f32 v[88:89], v[88:89], v[38:39]
v_pk_add_f32 v[90:91], v[90:91], v[38:39]
v_pk_add_f32 v[92:93], v[92:93], v[38:39]
v_pk_add_f32 v[94:95], v[94:95], v[38:39]
v_pk_add_f32 v[96:97], v[96:97], v[38:39]
v_pk_add_f32 v[98:99], v[98:99], v[38:39]
v_pk_add_f32 v[100:101], v[100:101], v[38:39]
v_pk_add_f32 v[102:103], v[102:103], v[38:39]
v_pk_add_f32 v[104:105], v[104:105], v[38:39]
v_pk_add_f32 v[106:107], v[106:107], v[38:39]
v_pk_add_f32 v[108:109], v[108:109], v[38:39]
v_pk_add_f32 v[110:111], v[110:111], v[38:39]
v_fma_f32 v45, -v44, v40, 1.0
v_fma_f32 v40, v45, v40, v40
v_mov_b32_e64 v41, v40
Vc 48,80,81
Vc 49,82,83
Vc 50,84,85
Vc 51,86,87
Vc 52,88,89
Vc 53,90,91
Vc 54,92,93
Vc 55,94,95
Vc 56,96,97
Vc 57,98,99
Vc 58,100,101
Vc 59,102,103
Vc 60,104,105
Vc 61,106,107
Vc 62,108,109
Vc 63,110,111
v_lshlrev_b32_e64 v80, 16, v48
v_and_b32 v81, 0xffff0000, v48
v_lshlrev_b32_e64 v82, 16, v49
v_and_b32 v83, 0xffff0000, v49
v_lshlrev_b32_e64 v84, 16, v50
v_and_b32 v85, 0xffff0000, v50
v_lshlrev_b32_e64 v86, 16, v51
v_and_b32 v87, 0xffff0000, v51
v_lshlrev_b32_e64 v88, 16, v52
v_and_b32 v89, 0xffff0000, v52
v_lshlrev_b32_e64 v90, 16, v53
v_and_b32 v91, 0xffff0000, v53
v_lshlrev_b32_e64 v92, 16, v54
v_and_b32 v93, 0xffff0000, v54
v_lshlrev_b32_e64 v94, 16, v55
v_and_b32 v95, 0xffff0000, v55
v_lshlrev_b32_e64 v96, 16, v56
v_and_b32 v97, 0xffff0000, v56
v_lshlrev_b32_e64 v98, 16, v57
v_and_b32 v99, 0xffff0000, v57
v_lshlrev_b32_e64 v100, 16, v58
v_and_b32 v101, 0xffff0000, v58
v_lshlrev_b32_e64 v102, 16, v59
v_and_b32 v103, 0xffff0000, v59
v_lshlrev_b32_e64 v104, 16, v60
v_and_b32 v105, 0xffff0000, v60
v_lshlrev_b32_e64 v106, 16, v61
v_and_b32 v107, 0xffff0000, v61
v_lshlrev_b32_e64 v108, 16, v62
v_and_b32 v109, 0xffff0000, v62
v_lshlrev_b32_e64 v110, 16, v63
v_and_b32 v111, 0xffff0000, v63
v_pk_mul_f32 v[80:81], v[80:81], v[40:41]
v_pk_mul_f32 v[82:83], v[82:83], v[40:41]
v_pk_mul_f32 v[84:85], v[84:85], v[40:41]
v_pk_mul_f32 v[86:87], v[86:87], v[40:41]
v_pk_mul_f32 v[88:89], v[88:89], v[40:41]
v_pk_mul_f32 v[90:91], v[90:91], v[40:41]
v_pk_mul_f32 v[92:93], v[92:93], v[40:41]
v_pk_mul_f32 v[94:95], v[94:95], v[40:41]
v_pk_mul_f32 v[96:97], v[96:97], v[40:41]
v_pk_mul_f32 v[98:99], v[98:99], v[40:41]
v_pk_mul_f32 v[100:101], v[100:101], v[40:41]
v_pk_mul_f32 v[102:103], v[102:103], v[40:41]
v_pk_mul_f32 v[104:105], v[104:105], v[40:41]
v_pk_mul_f32 v[106:107], v[106:107], v[40:41]
v_pk_mul_f32 v[108:109], v[108:109], v[40:41]
v_pk_mul_f32 v[110:111], v[110:111], v[40:41]
Vc 48,80,81
Vc 49,82,83
Vc 50,84,85
Vc 51,86,87
Vc 52,88,89
Vc 53,90,91
Vc 54,92,93
Vc 55,94,95
Vc 56,96,97
Vc 57,98,99
Vc 58,100,101
Vc 59,102,103
Vc 60,104,105
Vc 61,106,107
Vc 62,108,109
Vc 63,110,111
s_mul_i32 s3, s32, 4128
s_add_u32 s3, s3, 131072
v_mul_u32_u24 v42, 2064, v33
v_add3_u32 v42, v42, v36, s3
ds_write_b128 v42, v[48:51] offset:0
ds_write_b128 v42, v[52:55] offset:512
ds_write_b128 v42, v[56:59] offset:1024
ds_write_b128 v42, v[60:63] offset:1536
s_waitcnt vmcnt(8)
v_lshlrev_b32 v80, 16, v48
v_and_b32 v81, 0xffff0000, v48
v_lshlrev_b32_e64 v112, 16, v64
v_and_b32 v113, 0xffff0000, v64
v_pk_mul_f32 v[42:43], v[80:81], v[112:113]
v_lshlrev_b32_e64 v82, 16, v49
v_and_b32 v83, 0xffff0000, v49
v_lshlrev_b32_e64 v114, 16, v65
v_and_b32 v115, 0xffff0000, v65
v_pk_mul_f32 v[44:45], v[82:83], v[114:115]
v_lshlrev_b32_e64 v84, 16, v50
v_and_b32 v85, 0xffff0000, v50
v_lshlrev_b32_e64 v116, 16, v66
v_and_b32 v117, 0xffff0000, v66
v_pk_fma_f32 v[42:43], v[84:85], v[116:117], v[42:43]
v_lshlrev_b32_e64 v86, 16, v51
v_and_b32 v87, 0xffff0000, v51
v_lshlrev_b32_e64 v118, 16, v67
v_and_b32 v119, 0xffff0000, v67
v_pk_fma_f32 v[44:45], v[86:87], v[118:119], v[44:45]
v_lshlrev_b32_e64 v88, 16, v52
v_and_b32 v89, 0xffff0000, v52
v_lshlrev_b32_e64 v112, 16, v68
v_and_b32 v113, 0xffff0000, v68
v_pk_fma_f32 v[42:43], v[88:89], v[112:113], v[42:43]
v_lshlrev_b32_e64 v90, 16, v53
v_and_b32 v91, 0xffff0000, v53
v_lshlrev_b32_e64 v114, 16, v69
v_and_b32 v115, 0xffff0000, v69
v_pk_fma_f32 v[44:45], v[90:91], v[114:115], v[44:45]
v_lshlrev_b32_e64 v92, 16, v54
v_and_b32 v93, 0xffff0000, v54
v_lshlrev_b32_e64 v116, 16, v70
v_and_b32 v117, 0xffff0000, v70
v_pk_fma_f32 v[42:43], v[92:93], v[116:117], v[42:43]
v_lshlrev_b32_e64 v94, 16, v55
v_and_b32 v95, 0xffff0000, v55
v_lshlrev_b32_e64 v118, 16, v71
v_and_b32 v119, 0xffff0000, v71
v_pk_fma_f32 v[44:45], v[94:95], v[118:119], v[44:45]
v_lshlrev_b32_e64 v96, 16, v56
v_and_b32 v97, 0xffff0000, v56
v_lshlrev_b32_e64 v112, 16, v72
v_and_b32 v113, 0xffff0000, v72
v_pk_fma_f32 v[42:43], v[96:97], v[112:113], v[42:43]
v_lshlrev_b32_e64 v98, 16, v57
v_and_b32 v99, 0xffff0000, v57
v_lshlrev_b32_e64 v114, 16, v73
v_and_b32 v115, 0xffff0000, v73
v_pk_fma_f32 v[44:45], v[98:99], v[114:115], v[44:45]
v_lshlrev_b32_e64 v100, 16, v58
v_and_b32 v101, 0xffff0000, v58
v_lshlrev_b32_e64 v116, 16, v74
v_and_b32 v117, 0xffff0000, v74
v_pk_fma_f32 v[42:43], v[100:101], v[116:117], v[42:43]
v_lshlrev_b32_e64 v102, 16, v59
v_and_b32 v103, 0xffff0000, v59
v_lshlrev_b32_e64 v118, 16, v75
v_and_b32 v119, 0xffff0000, v75
v_pk_fma_f32 v[44:45], v[102:103], v[118:119], v[44:45]
v_lshlrev_b32_e64 v104, 16, v60
v_and_b32 v105, 0xffff0000, v60
v_lshlrev_b32_e64 v112, 16, v76
v_and_b32 v113, 0xffff0000, v76
v_pk_fma_f32 v[42:43], v[104:105], v[112:113], v[42:43]
v_lshlrev_b32_e64 v106, 16, v61
v_and_b32 v107, 0xffff0000, v61
v_lshlrev_b32_e64 v114, 16, v77
v_and_b32 v115, 0xffff0000, v77
v_pk_fma_f32 v[44:45], v[106:107], v[114:115], v[44:45]
v_lshlrev_b32_e64 v108, 16, v62
v_and_b32 v109, 0xffff0000, v62
v_lshlrev_b32_e64 v116, 16, v78
v_and_b32 v117, 0xffff0000, v78
v_pk_fma_f32 v[42:43], v[108:109], v[116:117], v[42:43]
v_lshlrev_b32_e64 v110, 16, v63
v_and_b32 v111, 0xffff0000, v63
v_lshlrev_b32_e64 v118, 16, v79
v_and_b32 v119, 0xffff0000, v79
v_pk_fma_f32 v[44:45], v[110:111], v[118:119], v[44:45]
v_pk_add_f32 v[42:43], v[42:43], v[44:45]
Va 45,42,43
s_nop 1
v_add_f32_dpp v45, v45, v45 quad_perm:[1,0,3,2] row_mask:0xf bank_mask:0xf
s_nop 1
v_add_f32_dpp v45, v45, v45 quad_perm:[2,3,0,1] row_mask:0xf bank_mask:0xf
s_nop 1
v_add_f32_dpp v45, v45, v45 row_half_mirror row_mask:0xf bank_mask:0xf
s_nop 1
v_add_f32_dpp v45, v45, v45 row_mirror row_mask:0xf bank_mask:0xf
v_mov_b32 v37, v45
s_nop 1
v_permlane16_swap_b32 v37, v45
v_add_f32_e64 v45, v45, v37
Vc 45,45,45
v_ashrrev_i32_e64 v46, 31, v45
v_or_b32 v46, 0x80000000, v46
v_xor_b32_e64 v45, v45, v46
v_and_b32 v45, 0xffff0000, v45
s_lshr_b32 s3, s36, 11
v_add_u32 v46, s3, v33
v_sub_u32 v44, 0xffff, v46
v_or_b32 v45, v45, v44
v_lshlrev_b32 v44, 2, v46
v_lshlrev_b32_e64 v46, 3, v46
v_xor_b32 v38, 0x80000000, v38
v_mov_b32_e64 v39, v40
s_mov_b32 s3, 5242880
s_mov_b32 s39, 5259264
s_mov_b32 exec_lo, 1
s_mov_b32 exec_hi, 1
buffer_store_dword v45, v44, s[20:23], s3 offen sc1
buffer_store_dwordx2 v[38:39], v46, s[20:23], s39 offen sc1
s_mov_b64 exec, -1
s_load_dwordx2 s[4:5], s[0:1], 16
s_load_dwordx4 s[40:43], s[0:1], 64
s_load_dwordx2 s[92:93], s[0:1], 40
s_load_dwordx2 s[94:95], s[0:1], 80
s_load_dwordx2 s[100:101], s[0:1], 0
s_mov_b32 s28, s64
s_and_b32 s29, s65, 0xffff
s_mov_b32 s30, 256
s_mov_b32 s31, 0x20000
s_waitcnt vmcnt(2)
s_waitcnt lgkmcnt(0)
s_barrier
s_nop 0
Ra 224,10,0
Ra 228,11,0
Ra 232,10,2048
Ra 236,11,2048
Ta 0,16,0
Ta 2,16,2048
Ta 4,16,16384
Ta 6,16,18432
Ta 8,17,0
Ta 10,17,2048
Ta 12,17,16384
Ta 14,17,18432
Ta 16,18,0
Ta 18,18,2048
Ta 20,18,16384
s_waitcnt lgkmcnt(9)
s_nop 0
Ta 22,18,18432
Ta 24,19,0
Ta 26,19,2048
Ta 28,19,16384
Ta 30,19,18432
Ta 32,20,0
s_waitcnt lgkmcnt(9)
s_nop 0
Ta 34,20,2048
Ta 36,20,16384
Ta 38,20,18432
Ta 40,21,0
Ta 42,21,2048
Ta 44,21,16384
s_waitcnt lgkmcnt(9)
s_nop 0
Ta 46,21,18432
Ta 48,22,0
Ta 50,22,2048
Ta 52,22,16384
Ta 54,22,18432
Ta 56,23,0
s_waitcnt lgkmcnt(9)
Ta 58,23,2048
Ta 60,23,16384
Ta 62,23,18432
s_cmp_lg_u32 s35, 0
s_cbranch_scc1 L_k1_vpath
Zvaa 48,0,224
v_and_b32 v46, 7, v0
v_mul_u32_u24 v30, 2064, v46
Mvaa 48,4,228
s_add_u32 m0, s57, 65536
Zvaa 52,8,224
buffer_load_dwordx4 v6, s[12:15], s52 offen offset:0 lds
Mvaa 52,12,228
Ra 240,10,4096
Zvaa 56,16,224
buffer_load_dwordx4 v7, s[12:15], s53 offen offset:1024 lds
Mvaa 56,20,228
v_lshrrev_b32_e64 v31, 3, v0
Zvaa 60,24,224
buffer_load_dwordx4 v6, s[12:15], s54 offen offset:2048 lds
Mvaa 60,28,228
Ra 244,11,4096
Zvaa 64,32,224
buffer_load_dwordx4 v7, s[12:15], s55 offen offset:3072 lds
Mvaa 64,36,228
s_add_u32 m0, s57, 69632
s_waitcnt lgkmcnt(10)
Zvaa 68,40,224
buffer_load_dwordx4 v8, s[12:15], s52 offen offset:0 lds
Mvaa 68,44,228
Ra 248,10,6144
s_waitcnt lgkmcnt(7)
Zvaa 72,48,224
buffer_load_dwordx4 v9, s[12:15], s53 offen offset:1024 lds
Mvaa 72,52,228
s_lshl_b32 s3, s32, 9
s_add_u32 s3, s3, 131072
v_lshl_add_u32 v30, v31, 4, v30
s_waitcnt lgkmcnt(3)
Zvaa 76,56,224
buffer_load_dwordx4 v8, s[12:15], s54 offen offset:2048 lds
Mvaa 76,60,228
Ra 252,11,6144
Zvaa 80,0,232
buffer_load_dwordx4 v9, s[12:15], s55 offen offset:3072 lds
Mvaa 80,4,236
s_add_u32 m0, s56, 65536
v_xor_b32 v6, 1572864, v6
v_xor_b32 v7, 1572864, v7
Zvaa 84,8,232
buffer_load_dwordx4 v2, s[8:11], s48 offen offset:0 lds
Mvaa 84,12,236
v_xor_b32 v8, 1572864, v8
v_xor_b32 v9, 1572864, v9
Zvaa 88,16,232
buffer_load_dwordx4 v3, s[8:11], s49 offen offset:1024 lds
Mvaa 88,20,236
v_add_u32 v30, s3, v30
v_lshlrev_b32 v31, 8, v31
Zvaa 92,24,232
buffer_load_dwordx4 v2, s[8:11], s50 offen offset:2048 lds
Mvaa 92,28,236
v_lshl_add_u32 v46, v46, 4, v31
Zvaa 96,32,232
buffer_load_dwordx4 v3, s[8:11], s51 offen offset:3072 lds
Mvaa 96,36,236
s_add_u32 m0, s56, 69632
Zvaa 100,40,232
buffer_load_dwordx4 v4, s[8:11], s48 offen offset:0 lds
Mvaa 100,44,236
Rv 34,30,128
Rv 38,30,256
Zvaa 104,48,232
buffer_load_dwordx4 v5, s[8:11], s49 offen offset:1024 lds
Mvaa 104,52,236
Rv 42,30,384
Rv 30,30,0
Zvaa 108,56,232
s_waitcnt lgkmcnt(4)
buffer_load_dwordx4 v4, s[8:11], s50 offen offset:2048 lds
Mvaa 108,60,236
s_lshr_b32 s3, s2, 1
s_mul_i32 s3, s3, 33792
s_add_u32 s3, s3, s57
Zvaa 112,0,240
buffer_load_dwordx4 v5, s[8:11], s51 offen offset:3072 lds
Mvaa 112,4,244
v_xor_b32 v2, 384, v2
v_xor_b32 v3, 384, v3
Zvaa 116,8,240
s_and_b32 s39, s2, 1
s_lshl_b32 s39, s39, 7
s_add_u32 s3, s3, s39
Mvaa 116,12,244
Ra 224,10,8192
v_xor_b32 v4, 384, v4
Zvaa 120,16,240
s_add_u32 s39, s3, 4096
Mvaa 120,20,244
v_xor_b32 v5, 384, v5
Zvaa 124,24,240
Mvaa 124,28,244
Ra 228,11,8192
Zvaa 128,32,240
Mvaa 128,36,244
Zvaa 132,40,240
Mvaa 132,44,244
Ra 232,10,10240
Zvaa 136,48,240
buffer_load_dword v1, v47, s[60:63], 0 offen
Mvaa 136,52,244
s_mul_i32 vcc_lo, s59, 1
v_xor_b32 v47, vcc_lo, v47
Zvaa 140,56,240
Mvaa 140,60,244
Ra 236,11,10240
Zvaa 144,0,248
Mvaa 144,4,252
Zvaa 148,8,248
Mvaa 148,12,252
Zvaa 152,16,248
Mvaa 152,20,252
Zvaa 156,24,248
Mvaa 156,28,252
Zvaa 160,32,248
Mvaa 160,36,252
Zvaa 164,40,248
Mvaa 164,44,252
Zvaa 168,48,248
Mvaa 168,52,252
s_waitcnt vmcnt(9)
Zvaa 172,56,248
s_waitcnt lgkmcnt(0)
s_barrier
Mvaa 172,60,252
s_add_u32 m0, s57, 0
Zvaa 176,0,224
buffer_load_dwordx4 v6, s[12:15], s52 offen offset:0 lds
Mvaa 176,4,228
Ta 64,14,0
Ta 66,14,2048
Zvaa 180,8,224
Mvaa 180,12,228
Ra 240,10,12288
Zvaa 184,16,224
buffer_load_dwordx4 v7, s[12:15], s53 offen offset:1024 lds
Mvaa 184,20,228
Ta 68,14,16384
Ta 70,14,18432
Zvaa 188,24,224
Mvaa 188,28,228
Ra 244,11,12288
Zvaa 192,32,224
buffer_load_dwordx4 v6, s[12:15], s54 offen offset:2048 lds
Mvaa 192,36,228
Ta 72,15,0
Ta 74,15,2048
Zvaa 196,40,224
Mvaa 196,44,228
Ra 248,10,14336
Zvaa 200,48,224
buffer_load_dwordx4 v7, s[12:15], s55 offen offset:3072 lds
Mvaa 200,52,228
Ta 76,15,16384
Ta 78,15,18432
Zvaa 204,56,224
Mvaa 204,60,228
s_add_u32 m0, s57, 4096
Ra 252,11,14336
Zvaa 208,0,232
buffer_load_dwordx4 v8, s[12:15], s52 offen offset:0 lds
Mvaa 208,4,236
Zvaa 212,8,232
Mvaa 212,12,236
Ta 80,24,0
Ta 82,24,2048
Zvaa 216,16,232
buffer_load_dwordx4 v9, s[12:15], s53 offen offset:1024 lds
Mvaa 216,20,236
Ta 84,24,16384
s_waitcnt lgkmcnt(9)
Ta 86,24,18432
Zvaa 220,24,232
Mvaa 220,28,236
Ta 88,25,0
Ta 90,25,2048
Zvaa 224,32,232
buffer_load_dwordx4 v8, s[12:15], s54 offen offset:2048 lds
Mvaa 224,36,236
Zvaa 228,40,232
Mvaa 228,44,236
Ta 92,25,16384
Ta 94,25,18432
Zvaa 232,48,232
buffer_load_dwordx4 v9, s[12:15], s55 offen offset:3072 lds
Mvaa 232,52,236
s_waitcnt vmcnt(9)
Ta 96,26,0
s_waitcnt lgkmcnt(9)
Ta 98,26,2048
Zvaa 236,56,232
s_barrier
v_xor_b32 v6, 524288, v6
v_xor_b32 v7, 524288, v7
Mvaa 236,60,236
s_add_u32 m0, s56, 0
Ta 100,26,16384
Ta 102,26,18432
Zvaa 240,0,240
buffer_load_dwordx4 v2, s[8:11], s48 offen offset:0 lds
Mvaa 240,4,244
v_xor_b32 v8, 524288, v8
v_xor_b32 v9, 524288, v9
Zvaa 244,8,240
Mvaa 244,12,244
Ra 224,12,0
Zvaa 248,16,240
buffer_load_dwordx4 v3, s[8:11], s49 offen offset:1024 lds
Mvaa 248,20,244
Ta 104,27,0
Ta 106,27,2048
Zvaa 252,24,240
Mvaa 252,28,244
s_waitcnt lgkmcnt(9)
Ra 228,13,0
Zaaa 128,32,240
buffer_load_dwordx4 v2, s[8:11], s50 offen offset:2048 lds
Maaa 128,36,244
Ta 108,27,16384
Ta 110,27,18432
Zaaa 132,40,240
Maaa 132,44,244
Ra 232,12,2048
Zaaa 136,48,240
buffer_load_dwordx4 v3, s[8:11], s51 offen offset:3072 lds
Maaa 136,52,244
Ta 112,28,0
Ta 114,28,2048
Zaaa 140,56,240
Maaa 140,60,244
s_add_u32 m0, s56, 4096
s_waitcnt lgkmcnt(9)
Ra 236,13,2048
Zaaa 144,0,248
buffer_load_dwordx4 v4, s[8:11], s48 offen offset:0 lds
Maaa 144,4,252
Zaaa 148,8,248
Maaa 148,12,252
Ta 116,28,16384
Ta 118,28,18432
Zaaa 152,16,248
buffer_load_dwordx4 v5, s[8:11], s49 offen offset:1024 lds
Maaa 152,20,252
Ta 120,29,0
Ta 122,29,2048
Zaaa 156,24,248
Maaa 156,28,252
Ta 124,29,16384
s_waitcnt lgkmcnt(9)
Ta 126,29,18432
Zaaa 160,32,248
buffer_load_dwordx4 v4, s[8:11], s50 offen offset:2048 lds
Maaa 160,36,252
Zaaa 164,40,248
Maaa 164,44,252
Zaaa 168,48,248
buffer_load_dwordx4 v5, s[8:11], s51 offen offset:3072 lds
Maaa 168,52,252
v_xor_b32 v2, 128, v2
v_xor_b32 v3, 128, v3
Zaaa 172,56,248
s_waitcnt lgkmcnt(6)
buffer_load_dword v1, v47, s[60:63], 0 offen
v_xor_b32 v4, 128, v4
v_xor_b32 v5, 128, v5
Maaa 172,60,252
s_waitcnt lgkmcnt(0)
s_mul_i32 vcc_lo, s59, 7
v_xor_b32 v47, vcc_lo, v47
Mvaa 48,64,224
buffer_store_dwordx4 v[30:33], v46, s[20:23], s3 offen offset:0 sc1
Mvaa 48,68,228
buffer_store_dwordx4 v[34:37], v46, s[20:23], s3 offen offset:2048 sc1
Mvaa 52,72,224
buffer_store_dwordx4 v[38:41], v46, s[20:23], s39 offen offset:0 sc1
Mvaa 52,76,228
Ra 240,12,4096
Mvaa 56,80,224
buffer_store_dwordx4 v[42:45], v46, s[20:23], s39 offen offset:2048 sc1
Mvaa 56,84,228
s_lshl_b32 s3, s34, 1
s_and_b32 s36, s32, 1
s_add_u32 s3, s3, s36
Mvaa 60,88,224
s_mul_i32 s3, s3, 1116160
s_mul_i32 s36, s33, 139264
s_add_u32 s3, s3, s36
Mvaa 60,92,228
Ra 244,13,4096
Mvaa 64,96,224
s_lshr_b32 s36, s32, 1
s_mul_i32 s36, s36, 69632
s_add_u32 s3, s3, s36
Mvaa 64,100,228
s_add_u32 s38, s3, 0
s_lshl_b32 s39, s34, 7
s_lshl_b32 s36, s33, 2
Mvaa 68,104,224
s_add_u32 s39, s39, s36
s_add_u32 s39, s39, 5296128
v_mov_b32_e64 v30, 1
Mvaa 68,108,228
Ra 248,12,6144
Mvaa 72,112,224
v_mov_b32_e64 v31, 0
Mvaa 72,116,228
s_cmp_eq_u32 s32, 0
s_cselect_b32 s39, s39, 2146435072
Mvaa 76,120,224
s_mov_b64 exec, 1
buffer_store_dword v31, v31, s[20:23], s39 offen sc1
s_mov_b64 exec, -1
Mvaa 76,124,228
Ra 252,13,6144
Mvaa 80,64,232
s_and_b32 s33, s2, 7
s_lshl_b32 s33, s33, 2
s_bfe_u32 s3, s2, 0x20003
Mvaa 80,68,236
s_add_u32 s33, s33, s3
s_lshr_b32 s34, s2, 5
s_lshl_b32 s64, s34, 7
Mvaa 84,72,232
s_lshl_b32 s3, s33, 2
s_add_u32 s64, s64, s3
s_add_u32 s64, s64, 5300224
Mvaa 84,76,236
s_lshl_b32 s65, s34, 8
s_sub_u32 s65, 1920, s65
v_mul_u32_u24 v32, s65, v0
Mvaa 88,80,232
s_cmp_eq_u32 s32, 0
s_cselect_b32 s64, s64, 2146435072
Mvaa 88,84,236
s_mov_b64 exec, 3
buffer_store_dword v31, v32, s[20:23], s64 offen sc1
s_mov_b64 exec, -1
Mvaa 92,88,232
s_lshl_b32 s3, s2, 2
s_add_u32 s3, s3, 5447680
v_lshlrev_b32_e64 v32, 10, v0
Mvaa 92,92,236
s_cmp_eq_u32 s32, 0
s_cselect_b32 s3, s3, 2146435072
Mvaa 96,96,232
s_mov_b64 exec, 0x1ff
buffer_store_dword v31, v32, s[20:23], s3 offen sc1
s_mov_b64 exec, -1
Mvaa 96,100,236
s_lshl_b32 s35, s34, 1
s_sub_u32 s36, 32, s35
s_add_u32 s35, s35, 2
Mvaa 100,104,232
s_lshl_b32 s44, s32, 12
s_lshl_b32 s58, s32, 1
s_sub_u32 s58, 7, s58
Mvaa 100,108,236
s_mul_i32 s58, s58, 33792
s_sub_u32 s3, 15, s34
s_lshl_b32 s45, s3, 3
Mvaa 104,112,232
s_add_u32 s45, s45, s32
s_lshl_b32 s46, s34, 3
s_add_u32 s46, s46, s32
Mvaa 104,116,236
s_mov_b32 s68, s42
s_and_b32 s69, s43, 0xffff
s_mov_b32 s70, 7340032
Mvaa 108,120,232
s_waitcnt lgkmcnt(0)
Mvaa 108,124,236
s_mov_b32 s71, 0x20000
s_cmp_eq_u32 s32, 0
s_cselect_b32 s37, 0, 2146435072
Mvaa 112,64,240
s_lshl_b32 s3, s33, 8
s_add_u32 s16, s4, s3
s_addc_u32 s17, s5, 0
s_and_b32 s17, s17, 0xffff
Mvaa 112,68,244
s_mov_b32 s18, 0
s_mov_b32 s19, 0x20000
s_sub_u32 s18, 8388608, s3
Mvaa 116,72,240
v_and_b32 v33, 15, v0
v_lshrrev_b32 v32, 1, v33
Mvaa 116,76,244
Ra 224,12,8192
Mvaa 120,80,240
v_and_b32 v33, 1, v0
v_lshlrev_b32 v32, 13, v32
Mvaa 120,84,244
v_lshl_add_u32 v45, v33, 7, v32
Mvaa 124,88,240
s_lshl_b32 s3, s32, 3
s_add_u32 s3, s3, s34
s_mul_i32 s47, s3, 65536
Mvaa 124,92,244
Ra 228,13,8192
Mvaa 128,96,240
s_bfe_u32 s6, s2, 131075
s_lshl_b32 s3, s32, 8
s_or_b32 s6, s6, s3
Mvaa 128,100,244
Mvaa 132,104,240
Mvaa 132,108,244
Ra 232,12,10240
Mvaa 136,112,240
Mvaa 136,116,244
Mvaa 140,120,240
Mvaa 140,124,244
Ra 236,13,10240
Mvaa 144,64,248
Mvaa 144,68,252
Mvaa 148,72,248
Mvaa 148,76,252
Mvaa 152,80,248
Mvaa 152,84,252
Mvaa 156,88,248
Mvaa 156,92,252
Mvaa 160,96,248
Mvaa 160,100,252
Mvaa 164,104,248
Mvaa 164,108,252
Mvaa 168,112,248
Mvaa 168,116,252
s_waitcnt vmcnt(16)
Mvaa 172,120,248
s_waitcnt lgkmcnt(0)
s_barrier
Mvaa 172,124,252
s_add_u32 m0, s57, 65536
Mvaa 176,64,224
buffer_load_dwordx4 v6, s[12:15], s52 offen offset:0 lds
Mvaa 176,68,228
Ta 0,16,0
Ta 2,16,2048
Mvaa 180,72,224
Mvaa 180,76,228
Ra 240,12,12288
Mvaa 184,80,224
buffer_load_dwordx4 v7, s[12:15], s53 offen offset:1024 lds
Mvaa 184,84,228
Ta 4,16,16384
Ta 6,16,18432
Mvaa 188,88,224
Mvaa 188,92,228
Ra 244,13,12288
Mvaa 192,96,224
buffer_load_dwordx4 v6, s[12:15], s54 offen offset:2048 lds
Mvaa 192,100,228
Ta 8,17,0
Ta 10,17,2048
Mvaa 196,104,224
Mvaa 196,108,228
Ra 248,12,14336
Mvaa 200,112,224
buffer_load_dwordx4 v7, s[12:15], s55 offen offset:3072 lds
Mvaa 200,116,228
Ta 12,17,16384
Ta 14,17,18432
Mvaa 204,120,224
Mvaa 204,124,228
s_add_u32 m0, s57, 69632
Ra 252,13,14336
Mvaa 208,64,232
buffer_load_dwordx4 v8, s[12:15], s52 offen offset:0 lds
Mvaa 208,68,236
Mvaa 212,72,232
Mvaa 212,76,236
Ta 16,18,0
Ta 18,18,2048
Mvaa 216,80,232
buffer_load_dwordx4 v9, s[12:15], s53 offen offset:1024 lds
Mvaa 216,84,236
Ta 20,18,16384
s_waitcnt lgkmcnt(9)
Ta 22,18,18432
Mvaa 220,88,232
Mvaa 220,92,236
Ta 24,19,0
Ta 26,19,2048
Mvaa 224,96,232
buffer_load_dwordx4 v8, s[12:15], s54 offen offset:2048 lds
Mvaa 224,100,236
Mvaa 228,104,232
Mvaa 228,108,236
Ta 28,19,16384
Ta 30,19,18432
Mvaa 232,112,232
buffer_load_dwordx4 v9, s[12:15], s55 offen offset:3072 lds
Mvaa 232,116,236
s_waitcnt vmcnt(16)
Ta 32,20,0
s_waitcnt lgkmcnt(9)
Ta 34,20,2048
Mvaa 236,120,232
s_barrier
v_xor_b32 v6, 3670016, v6
v_xor_b32 v7, 3670016, v7
Mvaa 236,124,236
s_add_u32 m0, s56, 65536
Ta 36,20,16384
Ta 38,20,18432
Mvaa 240,64,240
buffer_load_dwordx4 v2, s[8:11], s48 offen offset:0 lds
Mvaa 240,68,244
v_xor_b32 v8, 3670016, v8
v_xor_b32 v9, 3670016, v9
Mvaa 244,72,240
Mvaa 244,76,244
Ra 224,10,0
Mvaa 248,80,240
buffer_load_dwordx4 v3, s[8:11], s49 offen offset:1024 lds
Mvaa 248,84,244
Ta 40,21,0
Ta 42,21,2048
Mvaa 252,88,240
Mvaa 252,92,244
s_waitcnt lgkmcnt(9)
Ra 228,11,0
Maaa 128,96,240
buffer_load_dwordx4 v2, s[8:11], s50 offen offset:2048 lds
Maaa 128,100,244
Ta 44,21,16384
Ta 46,21,18432
Maaa 132,104,240
Maaa 132,108,244
Ra 232,10,2048
Maaa 136,112,240
buffer_load_dwordx4 v3, s[8:11], s51 offen offset:3072 lds
Maaa 136,116,244
Ta 48,22,0
Ta 50,22,2048
Maaa 140,120,240
Maaa 140,124,244
s_add_u32 m0, s56, 69632
s_waitcnt lgkmcnt(9)
Ra 236,11,2048
Maaa 144,64,248
buffer_load_dwordx4 v4, s[8:11], s48 offen offset:0 lds
Maaa 144,68,252
Maaa 148,72,248
Maaa 148,76,252
Ta 52,22,16384
Ta 54,22,18432
Maaa 152,80,248
buffer_load_dwordx4 v5, s[8:11], s49 offen offset:1024 lds
Maaa 152,84,252
Ta 56,23,0
Ta 58,23,2048
Maaa 156,88,248
Maaa 156,92,252
Ta 60,23,16384
s_waitcnt lgkmcnt(9)
Ta 62,23,18432
Maaa 160,96,248
buffer_load_dwordx4 v4, s[8:11], s50 offen offset:2048 lds
Maaa 160,100,252
Maaa 164,104,248
Maaa 164,108,252
Maaa 168,112,248
buffer_load_dwordx4 v5, s[8:11], s51 offen offset:3072 lds
Maaa 168,116,252
v_xor_b32 v2, 896, v2
v_xor_b32 v3, 896, v3
Maaa 172,120,248
s_waitcnt lgkmcnt(6)
buffer_load_dword v1, v47, s[60:63], 0 offen
v_xor_b32 v4, 896, v4
v_xor_b32 v5, 896, v5
Maaa 172,124,252
s_waitcnt lgkmcnt(0)
s_mul_i32 vcc_lo, s59, 1
v_xor_b32 v47, vcc_lo, v47
Mvaa 48,0,224
Mvaa 48,4,228
Mvaa 52,8,224
Mvaa 52,12,228
Ra 240,10,4096
Mvaa 56,16,224
Mvaa 56,20,228
Mvaa 60,24,224
Mvaa 60,28,228
Ra 244,11,4096
Mvaa 64,32,224
Mvaa 64,36,228
Mvaa 68,40,224
Mvaa 68,44,228
Ra 248,10,6144
Mvaa 72,48,224
Mvaa 72,52,228
Mvaa 76,56,224
Mvaa 76,60,228
Ra 252,11,6144
Mvaa 80,0,232
Mvaa 80,4,236
Mvaa 84,8,232
Mvaa 84,12,236
Mvaa 88,16,232
Mvaa 88,20,236
Mvaa 92,24,232
Mvaa 92,28,236
Mvaa 96,32,232
Mvaa 96,36,236
Mvaa 100,40,232
Mvaa 100,44,236
Mvaa 104,48,232
Mvaa 104,52,236
Mvaa 108,56,232
s_waitcnt lgkmcnt(0)
Mvaa 108,60,236
Mvaa 112,0,240
Mvaa 112,4,244
Mvaa 116,8,240
Mvaa 116,12,244
Ra 224,10,8192
Mvaa 120,16,240
Mvaa 120,20,244
Mvaa 124,24,240
Mvaa 124,28,244
Ra 228,11,8192
Mvaa 128,32,240
Mvaa 128,36,244
Mvaa 132,40,240
Mvaa 132,44,244
Ra 232,10,10240
Mvaa 136,48,240
Mvaa 136,52,244
Mvaa 140,56,240
Mvaa 140,60,244
Ra 236,11,10240
Mvaa 144,0,248
Mvaa 144,4,252
Mvaa 148,8,248
Mvaa 148,12,252
Mvaa 152,16,248
Mvaa 152,20,252
Mvaa 156,24,248
Mvaa 156,28,252
Mvaa 160,32,248
Mvaa 160,36,252
Mvaa 164,40,248
Mvaa 164,44,252
Mvaa 168,48,248
Mvaa 168,52,252
s_waitcnt vmcnt(9)
Mvaa 172,56,248
s_waitcnt lgkmcnt(0)
s_barrier
Mvaa 172,60,252
s_add_u32 m0, s57, 0
Mvaa 176,0,224
buffer_load_dwordx4 v6, s[12:15], s52 offen offset:0 lds
Mvaa 176,4,228
Ta 64,14,0
Ta 66,14,2048
Mvaa 180,8,224
Mvaa 180,12,228
Ra 240,10,12288
Mvaa 184,16,224
buffer_load_dwordx4 v7, s[12:15], s53 offen offset:1024 lds
Mvaa 184,20,228
Ta 68,14,16384
Ta 70,14,18432
Mvaa 188,24,224
Mvaa 188,28,228
Ra 244,11,12288
Mvaa 192,32,224
buffer_load_dwordx4 v6, s[12:15], s54 offen offset:2048 lds
Mvaa 192,36,228
Ta 72,15,0
Ta 74,15,2048
Mvaa 196,40,224
Mvaa 196,44,228
Ra 248,10,14336
Mvaa 200,48,224
buffer_load_dwordx4 v7, s[12:15], s55 offen offset:3072 lds
Mvaa 200,52,228
Ta 76,15,16384
Ta 78,15,18432
Mvaa 204,56,224
s_cmp_eq_u32 s6, 0
s_cselect_b32 s3, 0, 2146435072
Mvaa 204,60,228
s_add_u32 m0, s57, 4096
Ra 252,11,14336
Mvaa 208,0,232
buffer_load_dwordx4 v8, s[12:15], s52 offen offset:0 lds
Mvaa 208,4,236
s_mov_b64 exec, 1
buffer_atomic_add v30, v31, s[28:31], s3 offen sc1
s_mov_b64 exec, -1
Mvaa 212,8,232
Mvaa 212,12,236
Ta 80,24,0
Ta 82,24,2048
Mvaa 216,16,232
buffer_load_dwordx4 v9, s[12:15], s53 offen offset:1024 lds
Mvaa 216,20,236
Ta 84,24,16384
s_waitcnt lgkmcnt(9)
Ta 86,24,18432
Mvaa 220,24,232
Mvaa 220,28,236
Ta 88,25,0
Ta 90,25,2048
Mvaa 224,32,232
buffer_load_dwordx4 v8, s[12:15], s54 offen offset:2048 lds
Mvaa 224,36,236
Mvaa 228,40,232
Mvaa 228,44,236
Ta 92,25,16384
Ta 94,25,18432
Mvaa 232,48,232
buffer_load_dwordx4 v9, s[12:15], s55 offen offset:3072 lds
Mvaa 232,52,236
s_waitcnt vmcnt(10)
Ta 96,26,0
s_waitcnt lgkmcnt(9)
Ta 98,26,2048
Mvaa 236,56,232
s_barrier
v_xor_b32 v6, 524288, v6
v_xor_b32 v7, 524288, v7
Mvaa 236,60,236
s_add_u32 m0, s56, 0
Ta 100,26,16384
Ta 102,26,18432
Mvaa 240,0,240
buffer_load_dwordx4 v2, s[8:11], s48 offen offset:0 lds
Mvaa 240,4,244
v_xor_b32 v8, 524288, v8
v_xor_b32 v9, 524288, v9
Mvaa 244,8,240
Mvaa 244,12,244
Ra 224,12,0
Mvaa 248,16,240
buffer_load_dwordx4 v3, s[8:11], s49 offen offset:1024 lds
Mvaa 248,20,244
Ta 104,27,0
Ta 106,27,2048
Mvaa 252,24,240
Mvaa 252,28,244
s_waitcnt lgkmcnt(9)
Ra 228,13,0
Maaa 128,32,240
buffer_load_dwordx4 v2, s[8:11], s50 offen offset:2048 lds
Maaa 128,36,244
Ta 108,27,16384
Ta 110,27,18432
Maaa 132,40,240
Maaa 132,44,244
Ra 232,12,2048
Maaa 136,48,240
buffer_load_dwordx4 v3, s[8:11], s51 offen offset:3072 lds
Maaa 136,52,244
Ta 112,28,0
Ta 114,28,2048
Maaa 140,56,240
Maaa 140,60,244
s_add_u32 m0, s56, 4096
s_waitcnt lgkmcnt(9)
Ra 236,13,2048
Maaa 144,0,248
buffer_load_dwordx4 v4, s[8:11], s48 offen offset:0 lds
Maaa 144,4,252
Maaa 148,8,248
Maaa 148,12,252
Ta 116,28,16384
Ta 118,28,18432
Maaa 152,16,248
buffer_load_dwordx4 v5, s[8:11], s49 offen offset:1024 lds
Maaa 152,20,252
Ta 120,29,0
Ta 122,29,2048
Maaa 156,24,248
Maaa 156,28,252
Ta 124,29,16384
s_waitcnt lgkmcnt(9)
Ta 126,29,18432
Maaa 160,32,248
buffer_load_dwordx4 v4, s[8:11], s50 offen offset:2048 lds
Maaa 160,36,252
Maaa 164,40,248
Maaa 164,44,252
Maaa 168,48,248
buffer_load_dwordx4 v5, s[8:11], s51 offen offset:3072 lds
Maaa 168,52,252
v_xor_b32 v2, 128, v2
v_xor_b32 v3, 128, v3
Maaa 172,56,248
s_waitcnt lgkmcnt(6)
buffer_load_dword v1, v47, s[60:63], 0 offen
v_xor_b32 v4, 128, v4
v_xor_b32 v5, 128, v5
Maaa 172,60,252
s_waitcnt lgkmcnt(0)
s_mul_i32 vcc_lo, s59, 3
v_xor_b32 v47, vcc_lo, v47
Mvaa 48,64,224
buffer_load_dword v44, v45, s[16:19], s47 offen
Mvaa 48,68,228
s_add_u32 s47, s47, 2097152
Mvaa 52,72,224
Mvaa 52,76,228
Ra 240,12,4096
Mvaa 56,80,224
Mvaa 56,84,228
Mvaa 60,88,224
Mvaa 60,92,228
Ra 244,13,4096
Mvaa 64,96,224
Mvaa 64,100,228
Mvaa 68,104,224
Mvaa 68,108,228
Ra 248,12,6144
Mvaa 72,112,224
Mvaa 72,116,228
Mvaa 76,120,224
Mvaa 76,124,228
Ra 252,13,6144
Mvaa 80,64,232
Mvaa 80,68,236
Mvaa 84,72,232
Mvaa 84,76,236
Mvaa 88,80,232
Mvaa 88,84,236
Mvaa 92,88,232
Mvaa 92,92,236
Mvaa 96,96,232
Mvaa 96,100,236
Mvaa 100,104,232
s_cmp_eq_u32 s6, 1
s_cselect_b32 s3, 0, 2146435072
Mvaa 100,108,236
s_mov_b64 exec, 1
buffer_atomic_add v30, v31, s[28:31], s3 offen sc1
s_mov_b64 exec, -1
Mvaa 104,112,232
Mvaa 104,116,236
Mvaa 108,120,232
s_waitcnt lgkmcnt(0)
Mvaa 108,124,236
Mvaa 112,64,240
Mvaa 112,68,244
Mvaa 116,72,240
Mvaa 116,76,244
Ra 224,12,8192
Mvaa 120,80,240
Mvaa 120,84,244
Mvaa 124,88,240
Mvaa 124,92,244
Ra 228,13,8192
Mvaa 128,96,240
Mvaa 128,100,244
Mvaa 132,104,240
Mvaa 132,108,244
Ra 232,12,10240
Mvaa 136,112,240
Mvaa 136,116,244
Mvaa 140,120,240
Mvaa 140,124,244
Ra 236,13,10240
Mvaa 144,64,248
Mvaa 144,68,252
Mvaa 148,72,248
Mvaa 148,76,252
Mvaa 152,80,248
Mvaa 152,84,252
Mvaa 156,88,248
Mvaa 156,92,252
Mvaa 160,96,248
Mvaa 160,100,252
Mvaa 164,104,248
Mvaa 164,108,252
Mvaa 168,112,248
Mvaa 168,116,252
s_waitcnt vmcnt(11)
Mvaa 172,120,248
s_waitcnt lgkmcnt(0)
s_barrier
Mvaa 172,124,252
s_add_u32 m0, s57, 65536
Mvaa 176,64,224
buffer_load_dwordx4 v6, s[12:15], s52 offen offset:0 lds
Mvaa 176,68,228
Ta 0,16,0
Ta 2,16,2048
Mvaa 180,72,224
Mvaa 180,76,228
Ra 240,12,12288
Mvaa 184,80,224
buffer_load_dwordx4 v7, s[12:15], s53 offen offset:1024 lds
Mvaa 184,84,228
Ta 4,16,16384
Ta 6,16,18432
Mvaa 188,88,224
Mvaa 188,92,228
Ra 244,13,12288
Mvaa 192,96,224
buffer_load_dwordx4 v6, s[12:15], s54 offen offset:2048 lds
Mvaa 192,100,228
Ta 8,17,0
Ta 10,17,2048
Mvaa 196,104,224
Mvaa 196,108,228
Ra 248,12,14336
Mvaa 200,112,224
buffer_load_dwordx4 v7, s[12:15], s55 offen offset:3072 lds
Mvaa 200,116,228
Ta 12,17,16384
Ta 14,17,18432
Mvaa 204,120,224
Mvaa 204,124,228
s_add_u32 m0, s57, 69632
Ra 252,13,14336
Mvaa 208,64,232
buffer_load_dwordx4 v8, s[12:15], s52 offen offset:0 lds
Mvaa 208,68,236
Mvaa 212,72,232
Mvaa 212,76,236
Ta 16,18,0
Ta 18,18,2048
Mvaa 216,80,232
buffer_load_dwordx4 v9, s[12:15], s53 offen offset:1024 lds
Mvaa 216,84,236
Ta 20,18,16384
s_waitcnt lgkmcnt(9)
Ta 22,18,18432
Mvaa 220,88,232
Mvaa 220,92,236
Ta 24,19,0
Ta 26,19,2048
Mvaa 224,96,232
buffer_load_dwordx4 v8, s[12:15], s54 offen offset:2048 lds
Mvaa 224,100,236
Mvaa 228,104,232
Mvaa 228,108,236
Ta 28,19,16384
Ta 30,19,18432
Mvaa 232,112,232
buffer_load_dwordx4 v9, s[12:15], s55 offen offset:3072 lds
Mvaa 232,116,236
s_waitcnt vmcnt(11)
Ta 32,20,0
s_waitcnt lgkmcnt(9)
Ta 34,20,2048
Mvaa 236,120,232
s_barrier
v_xor_b32 v6, 1572864, v6
v_xor_b32 v7, 1572864, v7
Mvaa 236,124,236
s_add_u32 m0, s56, 65536
Ta 36,20,16384
Ta 38,20,18432
Mvaa 240,64,240
buffer_load_dwordx4 v2, s[8:11], s48 offen offset:0 lds
Mvaa 240,68,244
v_xor_b32 v8, 1572864, v8
v_xor_b32 v9, 1572864, v9
Mvaa 244,72,240
Mvaa 244,76,244
Ra 224,10,0
Mvaa 248,80,240
buffer_load_dwordx4 v3, s[8:11], s49 offen offset:1024 lds
Mvaa 248,84,244
Ta 40,21,0
Ta 42,21,2048
Mvaa 252,88,240
Mvaa 252,92,244
s_waitcnt lgkmcnt(9)
Ra 228,11,0
Maaa 128,96,240
buffer_load_dwordx4 v2, s[8:11], s50 offen offset:2048 lds
Maaa 128,100,244
Ta 44,21,16384
Ta 46,21,18432
Maaa 132,104,240
s_cmp_eq_u32 s6, 2
s_cselect_b32 s3, 0, 2146435072
Maaa 132,108,244
Ra 232,10,2048
Maaa 136,112,240
buffer_load_dwordx4 v3, s[8:11], s51 offen offset:3072 lds
Maaa 136,116,244
Ta 48,22,0
Ta 50,22,2048
Maaa 140,120,240
s_mov_b64 exec, 1
buffer_atomic_add v30, v31, s[28:31], s3 offen sc1
s_mov_b64 exec, -1
Maaa 140,124,244
s_add_u32 m0, s56, 69632
s_waitcnt lgkmcnt(9)
Ra 236,11,2048
Maaa 144,64,248
buffer_load_dwordx4 v4, s[8:11], s48 offen offset:0 lds
Maaa 144,68,252
Maaa 148,72,248
Maaa 148,76,252
Ta 52,22,16384
Ta 54,22,18432
Maaa 152,80,248
buffer_load_dwordx4 v5, s[8:11], s49 offen offset:1024 lds
Maaa 152,84,252
Ta 56,23,0
Ta 58,23,2048
Maaa 156,88,248
Maaa 156,92,252
Ta 60,23,16384
s_waitcnt lgkmcnt(9)
Ta 62,23,18432
Maaa 160,96,248
buffer_load_dwordx4 v4, s[8:11], s50 offen offset:2048 lds
Maaa 160,100,252
Maaa 164,104,248
Maaa 164,108,252
Maaa 168,112,248
buffer_load_dwordx4 v5, s[8:11], s51 offen offset:3072 lds
Maaa 168,116,252
v_xor_b32 v2, 384, v2
v_xor_b32 v3, 384, v3
Maaa 172,120,248
s_waitcnt lgkmcnt(6)
buffer_load_dword v1, v47, s[60:63], 0 offen
v_xor_b32 v4, 384, v4
v_xor_b32 v5, 384, v5
Maaa 172,124,252
s_waitcnt lgkmcnt(0)
s_mul_i32 vcc_lo, s59, 1
v_xor_b32_e64 v47, vcc_lo, v47
Mvaa 48,0,224
buffer_load_dword v44, v45, s[16:19], s47 offen
Mvaa 48,4,228
s_add_u32 s47, s47, 2097152
Mvaa 52,8,224
Mvaa 52,12,228
Ra 240,10,4096
Mvaa 56,16,224
Mvaa 56,20,228
Mvaa 60,24,224
Mvaa 60,28,228
Ra 244,11,4096
Mvaa 64,32,224
Mvaa 64,36,228
Mvaa 68,40,224
Mvaa 68,44,228
Ra 248,10,6144
Mvaa 72,48,224
Mvaa 72,52,228
Mvaa 76,56,224
Mvaa 76,60,228
Ra 252,11,6144
Mvaa 80,0,232
Mvaa 80,4,236
Mvaa 84,8,232
Mvaa 84,12,236
Mvaa 88,16,232
Mvaa 88,20,236
Mvaa 92,24,232
Mvaa 92,28,236
Mvaa 96,32,232
Mvaa 96,36,236
Mvaa 100,40,232
Mvaa 100,44,236
Mvaa 104,48,232
Mvaa 104,52,236
Mvaa 108,56,232
s_waitcnt lgkmcnt(0)
Mvaa 108,60,236
Mvaa 112,0,240
Mvaa 112,4,244
Mvaa 116,8,240
Mvaa 116,12,244
Ra 224,10,8192
Mvaa 120,16,240
Mvaa 120,20,244
Mvaa 124,24,240
Mvaa 124,28,244
Ra 228,11,8192
Mvaa 128,32,240
Mvaa 128,36,244
Mvaa 132,40,240
Mvaa 132,44,244
Ra 232,10,10240
Mvaa 136,48,240
Mvaa 136,52,244
Mvaa 140,56,240
Mvaa 140,60,244
Ra 236,11,10240
Mvaa 144,0,248
Mvaa 144,4,252
Mvaa 148,8,248
Mvaa 148,12,252
Mvaa 152,16,248
s_cmp_eq_u32 s6, 3
s_cselect_b32 s3, 0, 2146435072
Mvaa 152,20,252
s_mov_b64 exec, 1
buffer_atomic_add v30, v31, s[28:31], s3 offen sc1
s_mov_b64 exec, -1
Mvaa 156,24,248
Mvaa 156,28,252
Mvaa 160,32,248
Mvaa 160,36,252
Mvaa 164,40,248
Mvaa 164,44,252
Mvaa 168,48,248
Mvaa 168,52,252
s_waitcnt vmcnt(12)
Mvaa 172,56,248
s_waitcnt lgkmcnt(0)
s_barrier
Mvaa 172,60,252
s_add_u32 m0, s57, 0
Mvaa 176,0,224
buffer_load_dwordx4 v6, s[12:15], s52 offen offset:0 lds
Mvaa 176,4,228
Ta 64,14,0
Ta 66,14,2048
Mvaa 180,8,224
Mvaa 180,12,228
Ra 240,10,12288
Mvaa 184,16,224
buffer_load_dwordx4 v7, s[12:15], s53 offen offset:1024 lds
Mvaa 184,20,228
Ta 68,14,16384
Ta 70,14,18432
Mvaa 188,24,224
Mvaa 188,28,228
Ra 244,11,12288
Mvaa 192,32,224
buffer_load_dwordx4 v6, s[12:15], s54 offen offset:2048 lds
Mvaa 192,36,228
Ta 72,15,0
Ta 74,15,2048
Mvaa 196,40,224
Mvaa 196,44,228
Ra 248,10,14336
Mvaa 200,48,224
buffer_load_dwordx4 v7, s[12:15], s55 offen offset:3072 lds
Mvaa 200,52,228
Ta 76,15,16384
Ta 78,15,18432
Mvaa 204,56,224
Mvaa 204,60,228
s_add_u32 m0, s57, 4096
Ra 252,11,14336
Mvaa 208,0,232
buffer_load_dwordx4 v8, s[12:15], s52 offen offset:0 lds
Mvaa 208,4,236
Mvaa 212,8,232
Mvaa 212,12,236
Ta 80,24,0
Ta 82,24,2048
Mvaa 216,16,232
buffer_load_dwordx4 v9, s[12:15], s53 offen offset:1024 lds
Mvaa 216,20,236
Ta 84,24,16384
s_waitcnt lgkmcnt(9)
Ta 86,24,18432
Mvaa 220,24,232
Mvaa 220,28,236
Ta 88,25,0
Ta 90,25,2048
Mvaa 224,32,232
buffer_load_dwordx4 v8, s[12:15], s54 offen offset:2048 lds
Mvaa 224,36,236
Mvaa 228,40,232
Mvaa 228,44,236
Ta 92,25,16384
Ta 94,25,18432
Mvaa 232,48,232
buffer_load_dwordx4 v9, s[12:15], s55 offen offset:3072 lds
Mvaa 232,52,236
s_waitcnt vmcnt(11)
Ta 96,26,0
s_waitcnt lgkmcnt(9)
Ta 98,26,2048
Mvaa 236,56,232
s_barrier
v_xor_b32 v6, 524288, v6
v_xor_b32 v7, 524288, v7
Mvaa 236,60,236
s_add_u32 m0, s56, 0
Ta 100,26,16384
Ta 102,26,18432
Mvaa 240,0,240
buffer_load_dwordx4 v2, s[8:11], s48 offen offset:0 lds
Mvaa 240,4,244
v_xor_b32 v8, 524288, v8
v_xor_b32 v9, 524288, v9
Mvaa 244,8,240
Mvaa 244,12,244
Ra 224,12,0
Mvaa 248,16,240
buffer_load_dwordx4 v3, s[8:11], s49 offen offset:1024 lds
Mvaa 248,20,244
Ta 104,27,0
Ta 106,27,2048
Mvaa 252,24,240
Mvaa 252,28,244
s_waitcnt lgkmcnt(9)
Ra 228,13,0
Maaa 128,32,240
buffer_load_dwordx4 v2, s[8:11], s50 offen offset:2048 lds
Maaa 128,36,244
Ta 108,27,16384
Ta 110,27,18432
Maaa 132,40,240
Maaa 132,44,244
Ra 232,12,2048
Maaa 136,48,240
buffer_load_dwordx4 v3, s[8:11], s51 offen offset:3072 lds
Maaa 136,52,244
Ta 112,28,0
Ta 114,28,2048
Maaa 140,56,240
Maaa 140,60,244
s_add_u32 m0, s56, 4096
s_waitcnt lgkmcnt(9)
Ra 236,13,2048
Maaa 144,0,248
buffer_load_dwordx4 v4, s[8:11], s48 offen offset:0 lds
Maaa 144,4,252
Maaa 148,8,248
Maaa 148,12,252
Ta 116,28,16384
Ta 118,28,18432
Maaa 152,16,248
buffer_load_dwordx4 v5, s[8:11], s49 offen offset:1024 lds
Maaa 152,20,252
Ta 120,29,0
Ta 122,29,2048
Maaa 156,24,248
Maaa 156,28,252
Ta 124,29,16384
s_waitcnt lgkmcnt(9)
Ta 126,29,18432
Maaa 160,32,248
buffer_load_dwordx4 v4, s[8:11], s50 offen offset:2048 lds
Maaa 160,36,252
Maaa 164,40,248
Maaa 164,44,252
Maaa 168,48,248
buffer_load_dwordx4 v5, s[8:11], s51 offen offset:3072 lds
Maaa 168,52,252
v_xor_b32 v2, 128, v2
v_xor_b32 v3, 128, v3
Maaa 172,56,248
s_waitcnt lgkmcnt(6)
buffer_load_dword v1, v47, s[60:63], 0 offen
v_xor_b32 v4, 128, v4
v_xor_b32 v5, 128, v5
Maaa 172,60,252
s_waitcnt lgkmcnt(0)
s_mul_i32 vcc_lo, s59, 7
v_xor_b32 v47, vcc_lo, v47
Mvaa 48,64,224
buffer_load_dword v44, v45, s[16:19], s47 offen
Mvaa 48,68,228
s_add_u32 s47, s47, 2097152
v_lshrrev_b32 v32, 4, v0
v_and_b32 v33, 15, v0
Mvaa 52,72,224
s_lshl_b32 s3, s32, 4
v_add_u32 v34, s3, v32
v_lshlrev_b32_e64 v36, 1, v32
Mvaa 52,76,228
Ra 240,12,4096
Mvaa 56,80,224
v_xor_b32 v36, v36, v33
v_xor_b32 v37, 8, v36
Mvaa 56,84,228
Mvaa 60,88,224
Mvaa 60,92,228
Ra 244,13,4096
Mvaa 64,96,224
s_getpc_b64 s[6:7]
L_cpf2:
s_add_u32 s6, s6, (L_phase2-L_cpf2)&0xffffffff
s_addc_u32 s7, s7, ((L_phase2-L_cpf2)>>32)&0xffffffff
Mvaa 64,100,228
s_lshr_b32 s3, s2, 3
s_lshl_b32 s3, s3, 2
s_add_u32 s3, s3, s32
Mvaa 68,104,224
s_lshl_b32 s3, s3, 10
v_and_b32 v42, 7, v0
v_lshlrev_b32_e64 v42, 7, v42
Mvaa 68,108,228
Ra 248,12,6144
Mvaa 72,112,224
v_add_u32_e64 v42, s3, v42
v_min_u32 v42, L_k2_fin-L_phase2-4, v42
Mvaa 72,116,228
v_mov_b32_e64 v41, s7
Mvaa 76,120,224
v_add_co_u32 v40, vcc, s6, v42
s_nop 1
v_addc_co_u32 v41, vcc, 0, v41, vcc
Mvaa 76,124,228
Ra 252,13,6144
Mvaa 80,64,232
global_load_dword v38, v[40:41], off
Mvaa 80,68,236
Mvaa 84,72,232
Mvaa 84,76,236
Mvaa 88,80,232
Mvaa 88,84,236
Mvaa 92,88,232
Mvaa 92,92,236
Mvaa 96,96,232
Mvaa 96,100,236
Mvaa 100,104,232
Mvaa 100,108,236
Mvaa 104,112,232
Mvaa 104,116,236
Mvaa 108,120,232
s_waitcnt lgkmcnt(0)
Mvaa 108,124,236
Mvaa 112,64,240
Mvaa 112,68,244
Mvaa 116,72,240
Mvaa 116,76,244
Ra 224,12,8192
Mvaa 120,80,240
Mvaa 120,84,244
Mvaa 124,88,240
Mvaa 124,92,244
Ra 228,13,8192
Mvaa 128,96,240
Mvaa 128,100,244
Mvaa 132,104,240
Mvaa 132,108,244
Ra 232,12,10240
Mvaa 136,112,240
Mvaa 136,116,244
Mvaa 140,120,240
Mvaa 140,124,244
Ra 236,13,10240
Mvaa 144,64,248
Mvaa 144,68,252
Mvaa 148,72,248
Mvaa 148,76,252
Mvaa 152,80,248
Mvaa 152,84,252
Mvaa 156,88,248
Mvaa 156,92,252
Mvaa 160,96,248
Mvaa 160,100,252
Mvaa 164,104,248
Mvaa 164,108,252
Mvaa 168,112,248
Mvaa 168,116,252
s_waitcnt vmcnt(11)
Mvaa 172,120,248
s_waitcnt lgkmcnt(0)
s_barrier
Mvaa 172,124,252
s_add_u32 m0, s57, 65536
Mvaa 176,64,224
buffer_load_dwordx4 v6, s[12:15], s52 offen offset:0 lds
Mvaa 176,68,228
Ta 0,16,0
Ta 2,16,2048
Mvaa 180,72,224
Mvaa 180,76,228
Ra 240,12,12288
Mvaa 184,80,224
buffer_load_dwordx4 v7, s[12:15], s53 offen offset:1024 lds
Mvaa 184,84,228
Ta 4,16,16384
Ta 6,16,18432
Mvaa 188,88,224
Mvaa 188,92,228
Ra 244,13,12288
Mvaa 192,96,224
buffer_load_dwordx4 v6, s[12:15], s54 offen offset:2048 lds
Mvaa 192,100,228
Ta 8,17,0
Ta 10,17,2048
Mvaa 196,104,224
Mvaa 196,108,228
Ra 248,12,14336
Mvaa 200,112,224
buffer_load_dwordx4 v7, s[12:15], s55 offen offset:3072 lds
Mvaa 200,116,228
Ta 12,17,16384
Ta 14,17,18432
Mvaa 204,120,224
Mvaa 204,124,228
s_add_u32 m0, s57, 69632
Ra 252,13,14336
Mvaa 208,64,232
buffer_load_dwordx4 v8, s[12:15], s52 offen offset:0 lds
Mvaa 208,68,236
Mvaa 212,72,232
Mvaa 212,76,236
Ta 16,18,0
Ta 18,18,2048
Mvaa 216,80,232
buffer_load_dwordx4 v9, s[12:15], s53 offen offset:1024 lds
Mvaa 216,84,236
Ta 20,18,16384
s_waitcnt lgkmcnt(9)
Ta 22,18,18432
Mvaa 220,88,232
Mvaa 220,92,236
Ta 24,19,0
Ta 26,19,2048
Mvaa 224,96,232
buffer_load_dwordx4 v8, s[12:15], s54 offen offset:2048 lds
Mvaa 224,100,236
Mvaa 228,104,232
Mvaa 228,108,236
Ta 28,19,16384
Ta 30,19,18432
Mvaa 232,112,232
buffer_load_dwordx4 v9, s[12:15], s55 offen offset:3072 lds
Mvaa 232,116,236
s_waitcnt vmcnt(11)
Ta 32,20,0
s_waitcnt lgkmcnt(9)
Ta 34,20,2048
Mvaa 236,120,232
s_barrier
Mvaa 236,124,236
s_add_u32 m0, s56, 65536
Ta 36,20,16384
Ta 38,20,18432
Mvaa 240,64,240
buffer_load_dwordx4 v2, s[8:11], s48 offen offset:0 lds
Mvaa 240,68,244
Mvaa 244,72,240
Mvaa 244,76,244
Ra 224,10,0
Mvaa 248,80,240
buffer_load_dwordx4 v3, s[8:11], s49 offen offset:1024 lds
Mvaa 248,84,244
Ta 40,21,0
Ta 42,21,2048
Mvaa 252,88,240
Mvaa 252,92,244
s_waitcnt lgkmcnt(9)
Ra 228,11,0
Maaa 128,96,240
buffer_load_dwordx4 v2, s[8:11], s50 offen offset:2048 lds
Maaa 128,100,244
Ta 44,21,16384
Ta 46,21,18432
Maaa 132,104,240
Maaa 132,108,244
Ra 232,10,2048
Maaa 136,112,240
buffer_load_dwordx4 v3, s[8:11], s51 offen offset:3072 lds
Maaa 136,116,244
Ta 48,22,0
Ta 50,22,2048
Maaa 140,120,240
Maaa 140,124,244
s_add_u32 m0, s56, 69632
s_waitcnt lgkmcnt(9)
Ra 236,11,2048
Maaa 144,64,248
buffer_load_dwordx4 v4, s[8:11], s48 offen offset:0 lds
Maaa 144,68,252
Maaa 148,72,248
Maaa 148,76,252
Ta 52,22,16384
Ta 54,22,18432
Maaa 152,80,248
buffer_load_dwordx4 v5, s[8:11], s49 offen offset:1024 lds
Maaa 152,84,252
Ta 56,23,0
Ta 58,23,2048
Maaa 156,88,248
Maaa 156,92,252
Ta 60,23,16384
s_waitcnt lgkmcnt(9)
Ta 62,23,18432
Maaa 160,96,248
buffer_load_dwordx4 v4, s[8:11], s50 offen offset:2048 lds
Maaa 160,100,252
Maaa 164,104,248
Maaa 164,108,252
Maaa 168,112,248
buffer_load_dwordx4 v5, s[8:11], s51 offen offset:3072 lds
Maaa 168,116,252
Maaa 172,120,248
s_waitcnt lgkmcnt(6)
Maaa 172,124,252
s_waitcnt lgkmcnt(0)
Mvaa 48,0,224
buffer_load_dword v1, v31, s[28:31], s37 offen sc1
Mvaa 48,4,228
s_mov_b32 s8, s16
s_mov_b32 s9, s17
s_mov_b32 s10, s18
Mvaa 52,8,224
s_add_u32 s16, s66, 46137344
s_addc_u32 s17, s67, 0
s_and_b32 s17, s17, 0xffff
Mvaa 52,12,228
Ra 240,10,4096
Mvaa 56,16,224
s_mov_b32 s18, 16777216
s_mov_b32 s19, 0x20000
s_mov_b32 s48, 0
Mvaa 56,20,228
s_mov_b32 s49, 31744
s_mov_b32 s50, 63488
s_mov_b32 s51, 95232
Mvaa 60,24,224
v_lshlrev_b32 v35, 13, v34
Mvaa 60,28,228
Ra 244,11,4096
Mvaa 64,32,224
s_and_b32 s52, s33, 0
s_lshl_b32 s3, s52, 19
s_lshl_b32 s52, s52, 11
Mvaa 64,36,228
s_add_u32 s53, s52, s58
v_add_u32_e64 v35, s3, v35
v_lshl_add_u32 v8, v36, 4, v35
Mvaa 68,40,224
v_lshl_add_u32 v9, v37, 4, v35
v_lshlrev_b32_e64 v2, 4, v0
Mvaa 68,44,228
Ra 248,10,6144
Mvaa 72,48,224
v_add_u32 v3, 65536, v2
v_add_u32_e64 v4, s44, v2
Mvaa 72,52,228
v_mov_b32 v7, 0
v_lshlrev_b32 v35, 2, v32
Mvaa 76,56,224
v_sub_u32_e64 v35, v33, v35
Mvaa 76,60,228
Ra 252,11,6144
Mvaa 80,0,232
s_lshl_b32 s3, s32, 4
v_add_u32 v5, s3, v35
Mvaa 80,4,236
s_sub_u32 s3, 48, s3
v_add_u32 v6, s3, v35
Mvaa 84,8,232
s_mul_i32 s3, s33, 1116160
s_add_u32 s3, s3, 8388608
s_add_u32 s12, s66, s3
s_addc_u32 s13, s67, 0
s_and_b32 s13, s13, 0xffff
Mvaa 84,12,236
s_mov_b32 s14, 0
s_mov_b32 s15, 0x20000
s_mul_i32 s14, s36, 34816
Mvaa 88,16,232
buffer_load_dword v44, v45, s[8:11], s47 offen
Mvaa 88,20,236
s_add_u32 s47, s47, 2097152
v_lshrrev_b32 v42, 2, v33
v_lshl_add_u32 v43, v32, 3, v42
Mvaa 92,24,232
v_lshlrev_b32 v43, 8, v43
v_and_b32 v46, 3, v0
Mvaa 92,28,236
v_lshl_add_u32 v43, v46, 3, v43
v_and_b32_e64 v46, 1, v32
Mvaa 96,32,232
v_lshl_add_u32 v42, v46, 2, v42
v_lshl_add_u32 v16, v42, 5, v43
Mvaa 96,36,236
v_xor_b32 v17, 32, v16
v_xor_b32 v18, 64, v16
Mvaa 100,40,232
v_xor_b32 v19, 96, v16
v_xor_b32 v20, 128, v16
Mvaa 100,44,236
v_xor_b32 v21, 160, v16
v_xor_b32 v22, 192, v16
Mvaa 104,48,232
v_xor_b32 v23, 224, v16
Mvaa 104,52,236
Mvaa 108,56,232
s_waitcnt lgkmcnt(0)
Mvaa 108,60,236
Mvaa 112,0,240
Mvaa 112,4,244
Mvaa 116,8,240
Mvaa 116,12,244
Ra 224,10,8192
Mvaa 120,16,240
Mvaa 120,20,244
Mvaa 124,24,240
Mvaa 124,28,244
Ra 228,11,8192
Mvaa 128,32,240
Mvaa 128,36,244
Mvaa 132,40,240
Mvaa 132,44,244
Ra 232,10,10240
Mvaa 136,48,240
Mvaa 136,52,244
Mvaa 140,56,240
Mvaa 140,60,244
Ra 236,11,10240
Mvaa 144,0,248
Mvaa 144,4,252
Mvaa 148,8,248
Mvaa 148,12,252
Mvaa 152,16,248
Mvaa 152,20,252
Mvaa 156,24,248
Mvaa 156,28,252
Mvaa 160,32,248
Mvaa 160,36,252
Mvaa 164,40,248
Mvaa 164,44,252
Mvaa 168,48,248
Mvaa 168,52,252
s_waitcnt vmcnt(10)
Mvaa 172,56,248
s_waitcnt lgkmcnt(0)
s_barrier
Mvaa 172,60,252
s_add_u32 m0, s44, 0
Mvaa 176,0,224
buffer_load_dwordx4 v8, s[8:11], s48 offen offset:0 lds
Mvaa 176,4,228
Ta 64,14,0
Ta 66,14,2048
Mvaa 180,8,224
Mvaa 180,12,228
Ra 240,10,12288
Mvaa 184,16,224
buffer_load_dwordx4 v8, s[8:11], s49 offen offset:1024 lds
Mvaa 184,20,228
Ta 68,14,16384
Ta 70,14,18432
Mvaa 188,24,224
Mvaa 188,28,228
Ra 244,11,12288
Mvaa 192,32,224
buffer_load_dwordx4 v9, s[8:11], s50 offen offset:2048 lds
Mvaa 192,36,228
Ta 72,15,0
Ta 74,15,2048
Mvaa 196,40,224
Mvaa 196,44,228
Ra 248,10,14336
Mvaa 200,48,224
buffer_load_dwordx4 v9, s[8:11], s51 offen offset:3072 lds
Mvaa 200,52,228
Ta 76,15,16384
Ta 78,15,18432
Mvaa 204,56,224
v_xor_b32 v8, 524288, v8
v_xor_b32 v9, 524288, v9
Mvaa 204,60,228
s_add_u32 m0, s44, 16384
Ra 252,11,14336
Mvaa 208,0,232
buffer_load_dwordx4 v8, s[8:11], s48 offen offset:0 lds
Mvaa 208,4,236
Mvaa 212,8,232
Mvaa 212,12,236
Ta 80,24,0
Ta 82,24,2048
Mvaa 216,16,232
buffer_load_dwordx4 v8, s[8:11], s49 offen offset:1024 lds
Mvaa 216,20,236
Ta 84,24,16384
s_waitcnt lgkmcnt(9)
Ta 86,24,18432
Mvaa 220,24,232
Mvaa 220,28,236
Ta 88,25,0
Ta 90,25,2048
Mvaa 224,32,232
buffer_load_dwordx4 v9, s[8:11], s50 offen offset:2048 lds
Mvaa 224,36,236
Mvaa 228,40,232
s_mul_i32 s3, s45, 33792
v_add_u32_e64 v10, s3, v2
Mvaa 228,44,236
Ta 92,25,16384
Ta 94,25,18432
Mvaa 232,48,232
buffer_load_dwordx4 v9, s[8:11], s51 offen offset:3072 lds
Mvaa 232,52,236
s_waitcnt vmcnt(10)
Ta 96,26,0
s_waitcnt lgkmcnt(9)
Ta 98,26,2048
Mvaa 236,56,232
s_barrier
v_xor_b32 v8, 1572864, v8
v_xor_b32 v9, 1572864, v9
Mvaa 236,60,236
s_add_u32 m0, s44, 32768
Ta 100,26,16384
Ta 102,26,18432
Mvaa 240,0,240
buffer_load_dwordx4 v8, s[8:11], s48 offen offset:0 lds
Mvaa 240,4,244
s_mul_i32 s3, s46, 33792
v_add_u32 v11, s3, v2
Mvaa 244,8,240
Mvaa 244,12,244
Ra 224,12,0
Mvaa 248,16,240
buffer_load_dwordx4 v8, s[8:11], s49 offen offset:1024 lds
Mvaa 248,20,244
Ta 104,27,0
Ta 106,27,2048
Mvaa 252,24,240
Mvaa 252,28,244
s_waitcnt lgkmcnt(9)
Ra 228,13,0
Maaa 128,32,240
buffer_load_dwordx4 v9, s[8:11], s50 offen offset:2048 lds
Maaa 128,36,244
Ta 108,27,16384
Ta 110,27,18432
Maaa 132,40,240
Maaa 132,44,244
Ra 232,12,2048
Maaa 136,48,240
buffer_load_dwordx4 v9, s[8:11], s51 offen offset:3072 lds
Maaa 136,52,244
Ta 112,28,0
Ta 114,28,2048
Maaa 140,56,240
v_xor_b32 v8, 524288, v8
v_xor_b32 v9, 524288, v9
Maaa 140,60,244
s_add_u32 m0, s44, 49152
s_waitcnt lgkmcnt(9)
Ra 236,13,2048
Maaa 144,0,248
buffer_load_dwordx4 v8, s[8:11], s48 offen offset:0 lds
Maaa 144,4,252
Maaa 148,8,248
Maaa 148,12,252
Ta 116,28,16384
Ta 118,28,18432
Maaa 152,16,248
buffer_load_dwordx4 v8, s[8:11], s49 offen offset:1024 lds
Maaa 152,20,252
Ta 120,29,0
Ta 122,29,2048
Maaa 156,24,248
Maaa 156,28,252
Ta 124,29,16384
s_waitcnt lgkmcnt(9)
Ta 126,29,18432
Maaa 160,32,248
buffer_load_dwordx4 v9, s[8:11], s50 offen offset:2048 lds
Maaa 160,36,252
Maaa 164,40,248
Maaa 164,44,252
Maaa 168,48,248
buffer_load_dwordx4 v9, s[8:11], s51 offen offset:3072 lds
Maaa 168,52,252
v_xor_b32 v8, 3670016, v8
v_xor_b32 v9, 3670016, v9
Maaa 172,56,248
s_waitcnt lgkmcnt(6)
Maaa 172,60,252
s_waitcnt lgkmcnt(0)
Mvaa 48,64,224
v_mov_b32 v14, v40
v_mov_b32_e64 v15, v41
Mvaa 48,68,228
Mvaa 52,72,224
Mvaa 52,76,228
Ra 240,12,4096
Mvaa 56,80,224
Mvaa 56,84,228
Mvaa 60,88,224
Mvaa 60,92,228
Ra 244,13,4096
Mvaa 64,96,224
Vc 24,48,49
Vc 25,50,51
Mvaa 64,100,228
Vc 26,52,53
Vc 27,54,55
Mvaa 68,104,224
Mvaa 68,108,228
Ra 248,12,6144
Mvaa 72,112,224
Vc 28,56,57
Vc 29,58,59
Mvaa 72,116,228
Vc 30,60,61
Vc 31,62,63
Mvaa 76,120,224
Mvaa 76,124,228
Ra 252,13,6144
Mvaa 80,64,232
Vc 32,64,65
Vc 33,66,67
Mvaa 80,68,236
Vc 34,68,69
Vc 35,70,71
Mvaa 84,72,232
Mvaa 84,76,236
Mvaa 88,80,232
Vc 36,72,73
Vc 37,74,75
Mvaa 88,84,236
Vc 38,76,77
Vc 39,78,79
Mvaa 92,88,232
Mvaa 92,92,236
Mvaa 96,96,232
Vc 40,80,81
Vc 41,82,83
Mvaa 96,100,236
Vc 42,84,85
Vc 43,86,87
Mvaa 100,104,232
s_waitcnt vmcnt(12)
Mvaa 100,108,236
s_add_u32 s59, s38, 0
Mvaa 104,112,232
v_readfirstlane_b32 s3, v1
s_nop 0
s_or_b32 s3, s3, s37
s_cmp_lt_u32 s3, 256
s_cbranch_scc1 L_spinAk
L_spinArk:
s_barrier
Mvaa 104,116,236
buffer_store_dwordx4 v[24:27], v2, s[24:27], s59 offen offset:0 sc1
Mvaa 108,120,232
s_waitcnt lgkmcnt(0)
Mvaa 108,124,236
Vc 44,88,89
Vc 45,90,91
Mvaa 112,64,240
buffer_load_dwordx4 a[0:3], v10, s[20:23], s53 offen offset:0 sc1
Mvaa 112,68,244
Vc 46,92,93
Vc 47,94,95
Mvaa 116,72,240
Vc 48,96,97
Vc 49,98,99
Mvaa 116,76,244
Ra 224,12,8192
Mvaa 120,80,240
Vc 50,100,101
Vc 51,102,103
Mvaa 120,84,244
Vc 52,104,105
Vc 53,106,107
Mvaa 124,88,240
buffer_load_dwordx4 a[4:7], v10, s[20:23], s52 offen offset:0 sc1
Mvaa 124,92,244
Ra 228,13,8192
Mvaa 128,96,240
Vc 54,108,109
Vc 55,110,111
Mvaa 128,100,244
Vc 56,112,113
Vc 57,114,115
Mvaa 132,104,240
Vc 58,116,117
Vc 59,118,119
Mvaa 132,108,244
Ra 232,12,10240
Mvaa 136,112,240
buffer_load_dwordx4 a[8:11], v11, s[20:23], s53 offen offset:0 sc1
Mvaa 136,116,244
buffer_store_dwordx4 v[28:31], v2, s[24:27], s59 offen offset:1024 sc1
Mvaa 140,120,240
Vc 60,120,121
Vc 61,122,123
Mvaa 140,124,244
Ra 236,13,10240
Mvaa 144,64,248
Vc 62,124,125
Vc 63,126,127
Mvaa 144,68,252
Vc 64,128,129
Vc 65,130,131
Mvaa 148,72,248
buffer_load_dwordx4 a[12:15], v11, s[20:23], s52 offen offset:0 sc1
Mvaa 148,76,252
Vc 66,132,133
Vc 67,134,135
Mvaa 152,80,248
Vc 68,136,137
Vc 69,138,139
Mvaa 152,84,252
Vc 70,140,141
Vc 71,142,143
Mvaa 156,88,248
Mvaa 156,92,252
Mvaa 160,96,248
buffer_load_dwordx4 a[16:19], v10, s[20:23], s53 offen offset:1024 sc1
Mvaa 160,100,252
Vc 72,144,145
Vc 73,146,147
Mvaa 164,104,248
Vc 74,148,149
Vc 75,150,151
Mvaa 164,108,252
buffer_store_dwordx4 v[32:35], v2, s[24:27], s59 offen offset:2048 sc1
Mvaa 168,112,248
Vc 76,152,153
Vc 77,154,155
Mvaa 168,116,252
Vc 78,156,157
Vc 79,158,159
Mvaa 172,120,248
s_waitcnt lgkmcnt(0)
buffer_load_dwordx4 a[20:23], v10, s[20:23], s52 offen offset:1024 sc1
Mvaa 172,124,252
Mvaa 176,64,224
Vc 80,160,161
Vc 81,162,163
Mvaa 176,68,228
Vc 82,164,165
Vc 83,166,167
Mvaa 180,72,224
Mvaa 180,76,228
Ra 240,12,12288
Mvaa 184,80,224
buffer_load_dwordx4 a[24:27], v11, s[20:23], s53 offen offset:1024 sc1
Mvaa 184,84,228
Vc 84,168,169
Vc 85,170,171
Mvaa 188,88,224
Vc 86,172,173
Vc 87,174,175
Mvaa 188,92,228
Ra 244,13,12288
Mvaa 192,96,224
Vc 88,176,177
Vc 89,178,179
Mvaa 192,100,228
Vc 90,180,181
Vc 91,182,183
Mvaa 196,104,224
buffer_load_dwordx4 a[28:31], v11, s[20:23], s52 offen offset:1024 sc1
Mvaa 196,108,228
Ra 248,12,14336
s_xor_b32 s52, s52, 2048
Mvaa 200,112,224
s_add_u32 s53, s52, s58
Mvaa 200,116,228
Vc 92,184,185
Vc 93,186,187
Mvaa 204,120,224
Vc 94,188,189
Vc 95,190,191
Mvaa 204,124,228
Ra 252,13,14336
Mvaa 208,64,232
buffer_load_dwordx4 a[32:35], v10, s[20:23], s53 offen offset:0 sc1
Mvaa 208,68,236
buffer_store_dwordx4 v[36:39], v2, s[24:27], s59 offen offset:3072 sc1
Mvaa 212,72,232
Vc 96,192,193
Vc 97,194,195
Mvaa 212,76,236
Vc 98,196,197
Vc 99,198,199
Mvaa 216,80,232
Vc 100,200,201
Vc 101,202,203
Mvaa 216,84,236
Vc 102,204,205
Vc 103,206,207
Mvaa 220,88,232
buffer_load_dwordx4 a[36:39], v10, s[20:23], s52 offen offset:0 sc1
Mvaa 220,92,236
Mvaa 224,96,232
Vc 104,208,209
Vc 105,210,211
Mvaa 224,100,236
Vc 106,212,213
Vc 107,214,215
Mvaa 228,104,232
Mvaa 228,108,236
Mvaa 232,112,232
buffer_load_dwordx4 a[40:43], v11, s[20:23], s53 offen offset:0 sc1
Mvaa 232,116,236
Vc 108,216,217
Vc 109,218,219
Mvaa 236,120,232
s_waitcnt lgkmcnt(0)
Mvaa 236,124,236
Vc 110,220,221
Vc 111,222,223
Mvaa 240,64,240
s_add_u32 s59, s38, 4096
Mvaa 240,68,244
buffer_store_dwordx4 v[40:43], v2, s[24:27], s59 offen offset:0 sc1
Mvaa 244,72,240
buffer_load_dwordx4 a[44:47], v11, s[20:23], s52 offen offset:0 sc1
Mvaa 244,76,244
Vc 112,224,225
Vc 113,226,227
Mvaa 248,80,240
Vc 114,228,229
Vc 115,230,231
Mvaa 248,84,244
Vc 116,232,233
Vc 117,234,235
Mvaa 252,88,240
Vc 118,236,237
Vc 119,238,239
Mvaa 252,92,244
Maaa 128,96,240
buffer_load_dwordx4 a[48:51], v10, s[20:23], s53 offen offset:1024 sc1
Maaa 128,100,244
Ta 192,16,0
Ta 194,16,1024
Maaa 132,104,240
Vc 120,240,241
Vc 121,242,243
Maaa 132,108,244
Ta 196,17,0
Ta 198,17,1024
Maaa 136,112,240
Vc 122,244,245
Vc 123,246,247
Maaa 136,116,244
Ta 200,18,0
Ta 202,18,1024
Maaa 140,120,240
buffer_load_dwordx4 a[52:55], v10, s[20:23], s52 offen offset:1024 sc1
Maaa 140,124,244
Ta 204,19,0
Ta 206,19,1024
Maaa 144,64,248
Vc 124,248,249
Vc 125,250,251
Maaa 144,68,252
Ta 208,20,0
Ta 210,20,1024
Maaa 148,72,248
Vc 126,252,253
Vc 127,254,255
Maaa 148,76,252
Ta 212,21,0
Ta 214,21,1024
Maaa 152,80,248
buffer_load_dwordx4 a[56:59], v11, s[20:23], s53 offen offset:1024 sc1
Maaa 152,84,252
Ta 216,22,0
Ta 218,22,1024
Maaa 156,88,248
buffer_store_dwordx4 v[44:47], v2, s[24:27], s59 offen offset:1024 sc1
Maaa 156,92,252
Ta 220,23,0
s_waitcnt lgkmcnt(9)
Ta 222,23,1024
Maaa 160,96,248
Maaa 160,100,252
Maaa 164,104,248
buffer_load_dwordx4 a[60:63], v11, s[20:23], s52 offen offset:1024 sc1
Maaa 164,108,252
s_xor_b32 s52, s52, 6144
s_add_u32 s53, s52, s58
Maaa 168,112,248
Maaa 168,116,252
Maaa 172,120,248
Maaa 172,124,252
s_branch L_phase2
L_k1_vpath:
Zvaa 48,224,0
v_and_b32_e64 v46, 7, v0
v_mul_u32_u24 v30, 2064, v46
Mvaa 48,228,4
s_add_u32 m0, s57, 65536
Zvaa 52,232,0
buffer_load_dwordx4 v6, s[12:15], s52 offen offset:0 lds
Mvaa 52,236,4
Ra 240,10,4096
Zvaa 56,224,8
buffer_load_dwordx4 v7, s[12:15], s53 offen offset:1024 lds
Mvaa 56,228,12
v_lshrrev_b32_e64 v31, 3, v0
Zvaa 60,232,8
buffer_load_dwordx4 v6, s[12:15], s54 offen offset:2048 lds
Mvaa 60,236,12
Ra 244,11,4096
Zvaa 64,224,16
buffer_load_dwordx4 v7, s[12:15], s55 offen offset:3072 lds
Mvaa 64,228,20
s_add_u32 m0, s57, 69632
Zvaa 68,232,16
buffer_load_dwordx4 v8, s[12:15], s52 offen offset:0 lds
Mvaa 68,236,20
Ra 248,10,6144
Zvaa 72,224,24
buffer_load_dwordx4 v9, s[12:15], s53 offen offset:1024 lds
Mvaa 72,228,28
s_lshl_b32 s3, s32, 9
s_add_u32 s3, s3, 131072
v_lshl_add_u32 v30, v31, 4, v30
Zvaa 76,232,24
buffer_load_dwordx4 v8, s[12:15], s54 offen offset:2048 lds
Mvaa 76,236,28
s_waitcnt lgkmcnt(9)
Ra 252,11,6144
Zvaa 80,224,32
buffer_load_dwordx4 v9, s[12:15], s55 offen offset:3072 lds
Mvaa 80,228,36
s_add_u32 m0, s56, 65536
v_xor_b32 v6, 1572864, v6
v_xor_b32 v7, 1572864, v7
Zvaa 84,232,32
buffer_load_dwordx4 v2, s[8:11], s48 offen offset:0 lds
Mvaa 84,236,36
v_xor_b32 v8, 1572864, v8
v_xor_b32 v9, 1572864, v9
Zvaa 88,224,40
buffer_load_dwordx4 v3, s[8:11], s49 offen offset:1024 lds
Mvaa 88,228,44
v_add_u32 v30, s3, v30
v_lshlrev_b32 v31, 8, v31
Zvaa 92,232,40
buffer_load_dwordx4 v2, s[8:11], s50 offen offset:2048 lds
Mvaa 92,236,44
v_lshl_add_u32 v46, v46, 4, v31
s_waitcnt lgkmcnt(8)
Zvaa 96,224,48
buffer_load_dwordx4 v3, s[8:11], s51 offen offset:3072 lds
Mvaa 96,228,52
s_add_u32 m0, s56, 69632
Zvaa 100,232,48
buffer_load_dwordx4 v4, s[8:11], s48 offen offset:0 lds
Mvaa 100,236,52
Rv 34,30,128
Rv 38,30,256
s_waitcnt lgkmcnt(6)
Zvaa 104,224,56
buffer_load_dwordx4 v5, s[8:11], s49 offen offset:1024 lds
Mvaa 104,228,60
Rv 42,30,384
Rv 30,30,0
Zvaa 108,232,56
s_waitcnt lgkmcnt(4)
buffer_load_dwordx4 v4, s[8:11], s50 offen offset:2048 lds
Mvaa 108,236,60
s_lshr_b32 s3, s2, 1
s_mul_i32 s3, s3, 33792
s_add_u32 s3, s3, s57
Zvaa 112,240,0
buffer_load_dwordx4 v5, s[8:11], s51 offen offset:3072 lds
Mvaa 112,244,4
v_xor_b32 v2, 384, v2
v_xor_b32 v3, 384, v3
Zvaa 116,248,0
s_and_b32 s39, s2, 1
s_lshl_b32 s39, s39, 7
s_add_u32 s3, s3, s39
Mvaa 116,252,4
Ra 224,10,8192
v_xor_b32 v4, 384, v4
Zvaa 120,240,8
s_add_u32 s39, s3, 4096
Mvaa 120,244,12
v_xor_b32 v5, 384, v5
Zvaa 124,248,8
Mvaa 124,252,12
Ra 228,11,8192
Zvaa 128,240,16
Mvaa 128,244,20
Zvaa 132,248,16
Mvaa 132,252,20
Ra 232,10,10240
Zvaa 136,240,24
buffer_load_dword v1, v47, s[60:63], 0 offen
Mvaa 136,244,28
s_mul_i32 vcc_lo, s59, 1
v_xor_b32 v47, vcc_lo, v47
Zvaa 140,248,24
Mvaa 140,252,28
Ra 236,11,10240
Zvaa 144,240,32
Mvaa 144,244,36
Zvaa 148,248,32
Mvaa 148,252,36
Zvaa 152,240,40
Mvaa 152,244,44
Zvaa 156,248,40
Mvaa 156,252,44
Zvaa 160,240,48
Mvaa 160,244,52
Zvaa 164,248,48
Mvaa 164,252,52
Zvaa 168,240,56
Mvaa 168,244,60
s_waitcnt vmcnt(9)
Zvaa 172,248,56
s_waitcnt lgkmcnt(0)
s_barrier
Mvaa 172,252,60
s_add_u32 m0, s57, 0
Zvaa 176,224,0
buffer_load_dwordx4 v6, s[12:15], s52 offen offset:0 lds
Mvaa 176,228,4
Ta 64,14,0
Ta 66,14,2048
Zvaa 180,232,0
Mvaa 180,236,4
Ra 240,10,12288
Zvaa 184,224,8
buffer_load_dwordx4 v7, s[12:15], s53 offen offset:1024 lds
Mvaa 184,228,12
Ta 68,14,16384
Ta 70,14,18432
Zvaa 188,232,8
Mvaa 188,236,12
Ra 244,11,12288
Zvaa 192,224,16
buffer_load_dwordx4 v6, s[12:15], s54 offen offset:2048 lds
Mvaa 192,228,20
Ta 72,15,0
Ta 74,15,2048
Zvaa 196,232,16
Mvaa 196,236,20
Ra 248,10,14336
Zvaa 200,224,24
buffer_load_dwordx4 v7, s[12:15], s55 offen offset:3072 lds
Mvaa 200,228,28
Ta 76,15,16384
Ta 78,15,18432
Zvaa 204,232,24
Mvaa 204,236,28
s_add_u32 m0, s57, 4096
Ra 252,11,14336
Zvaa 208,224,32
buffer_load_dwordx4 v8, s[12:15], s52 offen offset:0 lds
Mvaa 208,228,36
Zvaa 212,232,32
Mvaa 212,236,36
Ta 80,24,0
Ta 82,24,2048
Zvaa 216,224,40
buffer_load_dwordx4 v9, s[12:15], s53 offen offset:1024 lds
Mvaa 216,228,44
Ta 84,24,16384
s_waitcnt lgkmcnt(9)
Ta 86,24,18432
Zvaa 220,232,40
Mvaa 220,236,44
Ta 88,25,0
Ta 90,25,2048
Zvaa 224,224,48
buffer_load_dwordx4 v8, s[12:15], s54 offen offset:2048 lds
Mvaa 224,228,52
Zvaa 228,232,48
Mvaa 228,236,52
Ta 92,25,16384
Ta 94,25,18432
Zvaa 232,224,56
buffer_load_dwordx4 v9, s[12:15], s55 offen offset:3072 lds
Mvaa 232,228,60
s_waitcnt vmcnt(9)
Ta 96,26,0
s_waitcnt lgkmcnt(9)
Ta 98,26,2048
Zvaa 236,232,56
s_barrier
v_xor_b32 v6, 524288, v6
v_xor_b32 v7, 524288, v7
Mvaa 236,236,60
s_add_u32 m0, s56, 0
Ta 100,26,16384
Ta 102,26,18432
Zvaa 240,240,0
buffer_load_dwordx4 v2, s[8:11], s48 offen offset:0 lds
Mvaa 240,244,4
v_xor_b32 v8, 524288, v8
v_xor_b32 v9, 524288, v9
Zvaa 244,248,0
Mvaa 244,252,4
Ra 224,12,0
Zvaa 248,240,8
buffer_load_dwordx4 v3, s[8:11], s49 offen offset:1024 lds
Mvaa 248,244,12
Ta 104,27,0
Ta 106,27,2048
Zvaa 252,248,8
Mvaa 252,252,12
s_waitcnt lgkmcnt(9)
Ra 228,13,0
Zaaa 128,240,16
buffer_load_dwordx4 v2, s[8:11], s50 offen offset:2048 lds
Maaa 128,244,20
Ta 108,27,16384
Ta 110,27,18432
Zaaa 132,248,16
Maaa 132,252,20
Ra 232,12,2048
Zaaa 136,240,24
buffer_load_dwordx4 v3, s[8:11], s51 offen offset:3072 lds
Maaa 136,244,28
Ta 112,28,0
Ta 114,28,2048
Zaaa 140,248,24
Maaa 140,252,28
s_add_u32 m0, s56, 4096
s_waitcnt lgkmcnt(9)
Ra 236,13,2048
Zaaa 144,240,32
buffer_load_dwordx4 v4, s[8:11], s48 offen offset:0 lds
Maaa 144,244,36
Zaaa 148,248,32
Maaa 148,252,36
Ta 116,28,16384
Ta 118,28,18432
Zaaa 152,240,40
buffer_load_dwordx4 v5, s[8:11], s49 offen offset:1024 lds
Maaa 152,244,44
Ta 120,29,0
Ta 122,29,2048
Zaaa 156,248,40
Maaa 156,252,44
Ta 124,29,16384
s_waitcnt lgkmcnt(9)
Ta 126,29,18432
Zaaa 160,240,48
buffer_load_dwordx4 v4, s[8:11], s50 offen offset:2048 lds
Maaa 160,244,52
Zaaa 164,248,48
Maaa 164,252,52
Zaaa 168,240,56
buffer_load_dwordx4 v5, s[8:11], s51 offen offset:3072 lds
Maaa 168,244,60
v_xor_b32 v2, 128, v2
v_xor_b32 v3, 128, v3
Zaaa 172,248,56
s_waitcnt lgkmcnt(6)
buffer_load_dword v1, v47, s[60:63], 0 offen
v_xor_b32 v4, 128, v4
v_xor_b32 v5, 128, v5
Maaa 172,252,60
s_waitcnt lgkmcnt(0)
s_mul_i32 vcc_lo, s59, 7
v_xor_b32 v47, vcc_lo, v47
Mvaa 48,224,64
buffer_store_dwordx4 v[30:33], v46, s[20:23], s3 offen offset:0 sc1
Mvaa 48,228,68
buffer_store_dwordx4 v[34:37], v46, s[20:23], s3 offen offset:2048 sc1
Mvaa 52,232,64
buffer_store_dwordx4 v[38:41], v46, s[20:23], s39 offen offset:0 sc1
Mvaa 52,236,68
Ra 240,12,4096
Mvaa 56,224,72
buffer_store_dwordx4 v[42:45], v46, s[20:23], s39 offen offset:2048 sc1
Mvaa 56,228,76
s_lshl_b32 s3, s34, 1
s_and_b32 s36, s32, 1
s_add_u32 s3, s3, s36
Mvaa 60,232,72
s_mul_i32 s3, s3, 1116160
s_mul_i32 s36, s33, 139264
s_add_u32 s3, s3, s36
Mvaa 60,236,76
Ra 244,13,4096
Mvaa 64,224,80
s_lshr_b32 s36, s32, 1
s_mul_i32 s36, s36, 69632
s_add_u32 s3, s3, s36
Mvaa 64,228,84
s_add_u32 s38, s3, 17408
s_lshl_b32 s39, s34, 7
s_lshl_b32 s36, s33, 2
Mvaa 68,232,80
s_add_u32 s39, s39, s36
s_add_u32 s39, s39, 5296160
v_mov_b32 v30, 1
Mvaa 68,236,84
Ra 248,12,6144
Mvaa 72,224,88
v_mov_b32_e64 v31, 0
Mvaa 72,228,92
s_cmp_eq_u32 s32, 0
s_cselect_b32 s39, s39, 2146435072
Mvaa 76,232,88
s_mov_b64 exec, 1
buffer_store_dword v31, v31, s[20:23], s39 offen sc1
s_mov_b64 exec, -1
Mvaa 76,236,92
Ra 252,13,6144
Mvaa 80,224,96
s_and_b32 s33, s2, 7
s_lshl_b32 s33, s33, 2
s_bfe_u32 s3, s2, 0x20003
Mvaa 80,228,100
s_add_u32 s33, s33, s3
s_lshr_b32 s34, s2, 5
s_lshl_b32 s64, s34, 7
Mvaa 84,232,96
s_lshl_b32 s3, s33, 2
s_add_u32 s64, s64, s3
s_add_u32 s64, s64, 5300224
Mvaa 84,236,100
s_lshl_b32 s65, s34, 8
s_sub_u32 s65, 1920, s65
v_mul_u32_u24 v32, s65, v0
Mvaa 88,224,104
s_cmp_eq_u32 s32, 0
s_cselect_b32 s64, s64, 2146435072
Mvaa 88,228,108
s_mov_b64 exec, 3
buffer_store_dword v31, v32, s[20:23], s64 offen sc1
s_mov_b64 exec, -1
Mvaa 92,232,104
s_lshl_b32 s3, s2, 2
s_add_u32 s3, s3, 5447680
v_lshlrev_b32_e64 v32, 10, v0
Mvaa 92,236,108
s_cmp_eq_u32 s32, 0
s_cselect_b32 s3, s3, 2146435072
Mvaa 96,224,112
s_mov_b64 exec, 0x1ff
buffer_store_dword v31, v32, s[20:23], s3 offen sc1
s_mov_b64 exec, -1
Mvaa 96,228,116
s_lshl_b32 s35, s34, 1
s_sub_u32 s36, 32, s35
s_add_u32 s35, s35, 2
Mvaa 100,232,112
s_lshl_b32 s44, s32, 12
s_lshl_b32 s58, s32, 1
s_sub_u32 s58, 7, s58
Mvaa 100,236,116
s_mul_i32 s58, s58, 33792
s_sub_u32 s3, 15, s34
s_lshl_b32 s45, s3, 3
Mvaa 104,224,120
s_add_u32 s45, s45, s32
s_lshl_b32 s46, s34, 3
s_add_u32 s46, s46, s32
Mvaa 104,228,124
s_mov_b32 s68, s42
s_and_b32 s69, s43, 0xffff
s_mov_b32 s70, 7340032
Mvaa 108,232,120
s_waitcnt lgkmcnt(0)
Mvaa 108,236,124
s_mov_b32 s71, 0x20000
s_cmp_eq_u32 s32, 0
s_cselect_b32 s37, 0, 2146435072
Mvaa 112,240,64
s_lshl_b32 s3, s33, 8
s_add_u32 s16, s4, s3
s_addc_u32 s17, s5, 0
s_and_b32 s17, s17, 0xffff
Mvaa 112,244,68
s_mov_b32 s18, 0
s_mov_b32 s19, 0x20000
s_sub_u32 s18, 8388608, s3
Mvaa 116,248,64
v_and_b32 v33, 15, v0
v_lshrrev_b32 v32, 1, v33
Mvaa 116,252,68
Ra 224,12,8192
Mvaa 120,240,72
v_and_b32 v33, 1, v0
v_lshlrev_b32 v32, 13, v32
Mvaa 120,244,76
v_lshl_add_u32 v45, v33, 7, v32
Mvaa 124,248,72
s_lshl_b32 s3, s32, 3
s_add_u32 s3, s3, s34
s_mul_i32 s47, s3, 65536
Mvaa 124,252,76
Ra 228,13,8192
Mvaa 128,240,80
s_bfe_u32 s6, s2, 131075
s_lshl_b32 s3, s32, 8
s_or_b32 s6, s6, s3
Mvaa 128,244,84
Mvaa 132,248,80
Mvaa 132,252,84
Ra 232,12,10240
Mvaa 136,240,88
Mvaa 136,244,92
Mvaa 140,248,88
Mvaa 140,252,92
Ra 236,13,10240
Mvaa 144,240,96
Mvaa 144,244,100
Mvaa 148,248,96
Mvaa 148,252,100
Mvaa 152,240,104
Mvaa 152,244,108
Mvaa 156,248,104
Mvaa 156,252,108
Mvaa 160,240,112
Mvaa 160,244,116
Mvaa 164,248,112
Mvaa 164,252,116
Mvaa 168,240,120
Mvaa 168,244,124
s_waitcnt vmcnt(16)
Mvaa 172,248,120
s_waitcnt lgkmcnt(0)
s_barrier
Mvaa 172,252,124
s_add_u32 m0, s57, 65536
Mvaa 176,224,64
buffer_load_dwordx4 v6, s[12:15], s52 offen offset:0 lds
Mvaa 176,228,68
Ta 0,16,0
Ta 2,16,2048
Mvaa 180,232,64
Mvaa 180,236,68
Ra 240,12,12288
Mvaa 184,224,72
buffer_load_dwordx4 v7, s[12:15], s53 offen offset:1024 lds
Mvaa 184,228,76
Ta 4,16,16384
Ta 6,16,18432
Mvaa 188,232,72
Mvaa 188,236,76
Ra 244,13,12288
Mvaa 192,224,80
buffer_load_dwordx4 v6, s[12:15], s54 offen offset:2048 lds
Mvaa 192,228,84
Ta 8,17,0
Ta 10,17,2048
Mvaa 196,232,80
Mvaa 196,236,84
Ra 248,12,14336
Mvaa 200,224,88
buffer_load_dwordx4 v7, s[12:15], s55 offen offset:3072 lds
Mvaa 200,228,92
Ta 12,17,16384
Ta 14,17,18432
Mvaa 204,232,88
Mvaa 204,236,92
s_add_u32 m0, s57, 69632
Ra 252,13,14336
Mvaa 208,224,96
buffer_load_dwordx4 v8, s[12:15], s52 offen offset:0 lds
Mvaa 208,228,100
Mvaa 212,232,96
Mvaa 212,236,100
Ta 16,18,0
Ta 18,18,2048
Mvaa 216,224,104
buffer_load_dwordx4 v9, s[12:15], s53 offen offset:1024 lds
Mvaa 216,228,108
Ta 20,18,16384
s_waitcnt lgkmcnt(9)
Ta 22,18,18432
Mvaa 220,232,104
Mvaa 220,236,108
Ta 24,19,0
Ta 26,19,2048
Mvaa 224,224,112
buffer_load_dwordx4 v8, s[12:15], s54 offen offset:2048 lds
Mvaa 224,228,116
Mvaa 228,232,112
Mvaa 228,236,116
Ta 28,19,16384
Ta 30,19,18432
Mvaa 232,224,120
buffer_load_dwordx4 v9, s[12:15], s55 offen offset:3072 lds
Mvaa 232,228,124
s_waitcnt vmcnt(16)
Ta 32,20,0
s_waitcnt lgkmcnt(9)
Ta 34,20,2048
Mvaa 236,232,120
s_barrier
v_xor_b32 v6, 3670016, v6
v_xor_b32 v7, 3670016, v7
Mvaa 236,236,124
s_add_u32 m0, s56, 65536
Ta 36,20,16384
Ta 38,20,18432
Mvaa 240,240,64
buffer_load_dwordx4 v2, s[8:11], s48 offen offset:0 lds
Mvaa 240,244,68
v_xor_b32 v8, 3670016, v8
v_xor_b32 v9, 3670016, v9
Mvaa 244,248,64
Mvaa 244,252,68
Ra 224,10,0
Mvaa 248,240,72
buffer_load_dwordx4 v3, s[8:11], s49 offen offset:1024 lds
Mvaa 248,244,76
Ta 40,21,0
Ta 42,21,2048
Mvaa 252,248,72
Mvaa 252,252,76
s_waitcnt lgkmcnt(9)
Ra 228,11,0
Maaa 128,240,80
buffer_load_dwordx4 v2, s[8:11], s50 offen offset:2048 lds
Maaa 128,244,84
Ta 44,21,16384
Ta 46,21,18432
Maaa 132,248,80
Maaa 132,252,84
Ra 232,10,2048
Maaa 136,240,88
buffer_load_dwordx4 v3, s[8:11], s51 offen offset:3072 lds
Maaa 136,244,92
Ta 48,22,0
Ta 50,22,2048
Maaa 140,248,88
Maaa 140,252,92
s_add_u32 m0, s56, 69632
s_waitcnt lgkmcnt(9)
Ra 236,11,2048
Maaa 144,240,96
buffer_load_dwordx4 v4, s[8:11], s48 offen offset:0 lds
Maaa 144,244,100
Maaa 148,248,96
Maaa 148,252,100
Ta 52,22,16384
Ta 54,22,18432
Maaa 152,240,104
buffer_load_dwordx4 v5, s[8:11], s49 offen offset:1024 lds
Maaa 152,244,108
Ta 56,23,0
Ta 58,23,2048
Maaa 156,248,104
Maaa 156,252,108
Ta 60,23,16384
s_waitcnt lgkmcnt(9)
Ta 62,23,18432
Maaa 160,240,112
buffer_load_dwordx4 v4, s[8:11], s50 offen offset:2048 lds
Maaa 160,244,116
Maaa 164,248,112
Maaa 164,252,116
Maaa 168,240,120
buffer_load_dwordx4 v5, s[8:11], s51 offen offset:3072 lds
Maaa 168,244,124
v_xor_b32 v2, 896, v2
v_xor_b32 v3, 896, v3
Maaa 172,248,120
s_waitcnt lgkmcnt(6)
buffer_load_dword v1, v47, s[60:63], 0 offen
v_xor_b32 v4, 896, v4
v_xor_b32 v5, 896, v5
Maaa 172,252,124
s_waitcnt lgkmcnt(0)
s_mul_i32 vcc_lo, s59, 1
v_xor_b32 v47, vcc_lo, v47
Mvaa 48,224,0
Mvaa 48,228,4
Mvaa 52,232,0
Mvaa 52,236,4
Ra 240,10,4096
Mvaa 56,224,8
Mvaa 56,228,12
Mvaa 60,232,8
Mvaa 60,236,12
Ra 244,11,4096
Mvaa 64,224,16
Mvaa 64,228,20
Mvaa 68,232,16
Mvaa 68,236,20
Ra 248,10,6144
Mvaa 72,224,24
Mvaa 72,228,28
Mvaa 76,232,24
Mvaa 76,236,28
Ra 252,11,6144
Mvaa 80,224,32
Mvaa 80,228,36
Mvaa 84,232,32
Mvaa 84,236,36
Mvaa 88,224,40
Mvaa 88,228,44
Mvaa 92,232,40
Mvaa 92,236,44
Mvaa 96,224,48
Mvaa 96,228,52
Mvaa 100,232,48
Mvaa 100,236,52
Mvaa 104,224,56
Mvaa 104,228,60
Mvaa 108,232,56
s_waitcnt lgkmcnt(0)
Mvaa 108,236,60
Mvaa 112,240,0
Mvaa 112,244,4
Mvaa 116,248,0
Mvaa 116,252,4
Ra 224,10,8192
Mvaa 120,240,8
Mvaa 120,244,12
Mvaa 124,248,8
Mvaa 124,252,12
Ra 228,11,8192
Mvaa 128,240,16
Mvaa 128,244,20
Mvaa 132,248,16
Mvaa 132,252,20
Ra 232,10,10240
Mvaa 136,240,24
Mvaa 136,244,28
Mvaa 140,248,24
Mvaa 140,252,28
Ra 236,11,10240
Mvaa 144,240,32
Mvaa 144,244,36
Mvaa 148,248,32
Mvaa 148,252,36
Mvaa 152,240,40
Mvaa 152,244,44
Mvaa 156,248,40
Mvaa 156,252,44
Mvaa 160,240,48
Mvaa 160,244,52
Mvaa 164,248,48
Mvaa 164,252,52
Mvaa 168,240,56
Mvaa 168,244,60
s_waitcnt vmcnt(9)
Mvaa 172,248,56
s_waitcnt lgkmcnt(0)
s_barrier
Mvaa 172,252,60
s_add_u32 m0, s57, 0
Mvaa 176,224,0
buffer_load_dwordx4 v6, s[12:15], s52 offen offset:0 lds
Mvaa 176,228,4
Ta 64,14,0
Ta 66,14,2048
Mvaa 180,232,0
Mvaa 180,236,4
Ra 240,10,12288
Mvaa 184,224,8
buffer_load_dwordx4 v7, s[12:15], s53 offen offset:1024 lds
Mvaa 184,228,12
Ta 68,14,16384
Ta 70,14,18432
Mvaa 188,232,8
Mvaa 188,236,12
Ra 244,11,12288
Mvaa 192,224,16
buffer_load_dwordx4 v6, s[12:15], s54 offen offset:2048 lds
Mvaa 192,228,20
Ta 72,15,0
Ta 74,15,2048
Mvaa 196,232,16
Mvaa 196,236,20
Ra 248,10,14336
Mvaa 200,224,24
buffer_load_dwordx4 v7, s[12:15], s55 offen offset:3072 lds
Mvaa 200,228,28
Ta 76,15,16384
Ta 78,15,18432
Mvaa 204,232,24
s_cmp_eq_u32 s6, 0
s_cselect_b32 s3, 0, 2146435072
Mvaa 204,236,28
s_add_u32 m0, s57, 4096
Ra 252,11,14336
Mvaa 208,224,32
buffer_load_dwordx4 v8, s[12:15], s52 offen offset:0 lds
Mvaa 208,228,36
s_mov_b64 exec, 1
buffer_atomic_add v30, v31, s[28:31], s3 offen sc1
s_mov_b64 exec, -1
Mvaa 212,232,32
Mvaa 212,236,36
Ta 80,24,0
Ta 82,24,2048
Mvaa 216,224,40
buffer_load_dwordx4 v9, s[12:15], s53 offen offset:1024 lds
Mvaa 216,228,44
Ta 84,24,16384
s_waitcnt lgkmcnt(9)
Ta 86,24,18432
Mvaa 220,232,40
Mvaa 220,236,44
Ta 88,25,0
Ta 90,25,2048
Mvaa 224,224,48
buffer_load_dwordx4 v8, s[12:15], s54 offen offset:2048 lds
Mvaa 224,228,52
Mvaa 228,232,48
Mvaa 228,236,52
Ta 92,25,16384
Ta 94,25,18432
Mvaa 232,224,56
buffer_load_dwordx4 v9, s[12:15], s55 offen offset:3072 lds
Mvaa 232,228,60
s_waitcnt vmcnt(10)
Ta 96,26,0
s_waitcnt lgkmcnt(9)
Ta 98,26,2048
Mvaa 236,232,56
s_barrier
v_xor_b32 v6, 524288, v6
v_xor_b32 v7, 524288, v7
Mvaa 236,236,60
s_add_u32 m0, s56, 0
Ta 100,26,16384
Ta 102,26,18432
Mvaa 240,240,0
buffer_load_dwordx4 v2, s[8:11], s48 offen offset:0 lds
Mvaa 240,244,4
v_xor_b32 v8, 524288, v8
v_xor_b32 v9, 524288, v9
Mvaa 244,248,0
Mvaa 244,252,4
Ra 224,12,0
Mvaa 248,240,8
buffer_load_dwordx4 v3, s[8:11], s49 offen offset:1024 lds
Mvaa 248,244,12
Ta 104,27,0
Ta 106,27,2048
Mvaa 252,248,8
Mvaa 252,252,12
s_waitcnt lgkmcnt(9)
Ra 228,13,0
Maaa 128,240,16
buffer_load_dwordx4 v2, s[8:11], s50 offen offset:2048 lds
Maaa 128,244,20
Ta 108,27,16384
Ta 110,27,18432
Maaa 132,248,16
Maaa 132,252,20
Ra 232,12,2048
Maaa 136,240,24
buffer_load_dwordx4 v3, s[8:11], s51 offen offset:3072 lds
Maaa 136,244,28
Ta 112,28,0
Ta 114,28,2048
Maaa 140,248,24
Maaa 140,252,28
s_add_u32 m0, s56, 4096
s_waitcnt lgkmcnt(9)
Ra 236,13,2048
Maaa 144,240,32
buffer_load_dwordx4 v4, s[8:11], s48 offen offset:0 lds
Maaa 144,244,36
Maaa 148,248,32
Maaa 148,252,36
Ta 116,28,16384
Ta 118,28,18432
Maaa 152,240,40
buffer_load_dwordx4 v5, s[8:11], s49 offen offset:1024 lds
Maaa 152,244,44
Ta 120,29,0
Ta 122,29,2048
Maaa 156,248,40
Maaa 156,252,44
Ta 124,29,16384
s_waitcnt lgkmcnt(9)
Ta 126,29,18432
Maaa 160,240,48
buffer_load_dwordx4 v4, s[8:11], s50 offen offset:2048 lds
Maaa 160,244,52
Maaa 164,248,48
Maaa 164,252,52
Maaa 168,240,56
buffer_load_dwordx4 v5, s[8:11], s51 offen offset:3072 lds
Maaa 168,244,60
v_xor_b32 v2, 128, v2
v_xor_b32 v3, 128, v3
Maaa 172,248,56
s_waitcnt lgkmcnt(6)
buffer_load_dword v1, v47, s[60:63], 0 offen
v_xor_b32 v4, 128, v4
v_xor_b32 v5, 128, v5
Maaa 172,252,60
s_waitcnt lgkmcnt(0)
s_mul_i32 vcc_lo, s59, 3
v_xor_b32 v47, vcc_lo, v47
Mvaa 48,224,64
buffer_load_dword v44, v45, s[16:19], s47 offen
Mvaa 48,228,68
s_add_u32 s47, s47, 2097152
Mvaa 52,232,64
Mvaa 52,236,68
Ra 240,12,4096
Mvaa 56,224,72
Mvaa 56,228,76
Mvaa 60,232,72
Mvaa 60,236,76
Ra 244,13,4096
Mvaa 64,224,80
Mvaa 64,228,84
Mvaa 68,232,80
Mvaa 68,236,84
Ra 248,12,6144
Mvaa 72,224,88
Mvaa 72,228,92
Mvaa 76,232,88
Mvaa 76,236,92
Ra 252,13,6144
Mvaa 80,224,96
Mvaa 80,228,100
Mvaa 84,232,96
Mvaa 84,236,100
Mvaa 88,224,104
Mvaa 88,228,108
Mvaa 92,232,104
Mvaa 92,236,108
Mvaa 96,224,112
Mvaa 96,228,116
Mvaa 100,232,112
s_cmp_eq_u32 s6, 1
s_cselect_b32 s3, 0, 2146435072
Mvaa 100,236,116
s_mov_b64 exec, 1
buffer_atomic_add v30, v31, s[28:31], s3 offen sc1
s_mov_b64 exec, -1
Mvaa 104,224,120
Mvaa 104,228,124
Mvaa 108,232,120
s_waitcnt lgkmcnt(0)
Mvaa 108,236,124
Mvaa 112,240,64
Mvaa 112,244,68
Mvaa 116,248,64
Mvaa 116,252,68
Ra 224,12,8192
Mvaa 120,240,72
Mvaa 120,244,76
Mvaa 124,248,72
Mvaa 124,252,76
Ra 228,13,8192
Mvaa 128,240,80
Mvaa 128,244,84
Mvaa 132,248,80
Mvaa 132,252,84
Ra 232,12,10240
Mvaa 136,240,88
Mvaa 136,244,92
Mvaa 140,248,88
Mvaa 140,252,92
Ra 236,13,10240
Mvaa 144,240,96
Mvaa 144,244,100
Mvaa 148,248,96
Mvaa 148,252,100
Mvaa 152,240,104
Mvaa 152,244,108
Mvaa 156,248,104
Mvaa 156,252,108
Mvaa 160,240,112
Mvaa 160,244,116
Mvaa 164,248,112
Mvaa 164,252,116
Mvaa 168,240,120
Mvaa 168,244,124
s_waitcnt vmcnt(11)
Mvaa 172,248,120
s_waitcnt lgkmcnt(0)
s_barrier
Mvaa 172,252,124
s_add_u32 m0, s57, 65536
Mvaa 176,224,64
buffer_load_dwordx4 v6, s[12:15], s52 offen offset:0 lds
Mvaa 176,228,68
Ta 0,16,0
Ta 2,16,2048
Mvaa 180,232,64
Mvaa 180,236,68
Ra 240,12,12288
Mvaa 184,224,72
buffer_load_dwordx4 v7, s[12:15], s53 offen offset:1024 lds
Mvaa 184,228,76
Ta 4,16,16384
Ta 6,16,18432
Mvaa 188,232,72
Mvaa 188,236,76
Ra 244,13,12288
Mvaa 192,224,80
buffer_load_dwordx4 v6, s[12:15], s54 offen offset:2048 lds
Mvaa 192,228,84
Ta 8,17,0
Ta 10,17,2048
Mvaa 196,232,80
Mvaa 196,236,84
Ra 248,12,14336
Mvaa 200,224,88
buffer_load_dwordx4 v7, s[12:15], s55 offen offset:3072 lds
Mvaa 200,228,92
Ta 12,17,16384
Ta 14,17,18432
Mvaa 204,232,88
Mvaa 204,236,92
s_add_u32 m0, s57, 69632
Ra 252,13,14336
Mvaa 208,224,96
buffer_load_dwordx4 v8, s[12:15], s52 offen offset:0 lds
Mvaa 208,228,100
Mvaa 212,232,96
Mvaa 212,236,100
Ta 16,18,0
Ta 18,18,2048
Mvaa 216,224,104
buffer_load_dwordx4 v9, s[12:15], s53 offen offset:1024 lds
Mvaa 216,228,108
Ta 20,18,16384
s_waitcnt lgkmcnt(9)
Ta 22,18,18432
Mvaa 220,232,104
Mvaa 220,236,108
Ta 24,19,0
Ta 26,19,2048
Mvaa 224,224,112
buffer_load_dwordx4 v8, s[12:15], s54 offen offset:2048 lds
Mvaa 224,228,116
Mvaa 228,232,112
Mvaa 228,236,116
Ta 28,19,16384
Ta 30,19,18432
Mvaa 232,224,120
buffer_load_dwordx4 v9, s[12:15], s55 offen offset:3072 lds
Mvaa 232,228,124
s_waitcnt vmcnt(11)
Ta 32,20,0
s_waitcnt lgkmcnt(9)
Ta 34,20,2048
Mvaa 236,232,120
s_barrier
v_xor_b32 v6, 1572864, v6
v_xor_b32 v7, 1572864, v7
Mvaa 236,236,124
s_add_u32 m0, s56, 65536
Ta 36,20,16384
Ta 38,20,18432
Mvaa 240,240,64
buffer_load_dwordx4 v2, s[8:11], s48 offen offset:0 lds
Mvaa 240,244,68
v_xor_b32 v8, 1572864, v8
v_xor_b32 v9, 1572864, v9
Mvaa 244,248,64
Mvaa 244,252,68
Ra 224,10,0
Mvaa 248,240,72
buffer_load_dwordx4 v3, s[8:11], s49 offen offset:1024 lds
Mvaa 248,244,76
Ta 40,21,0
Ta 42,21,2048
Mvaa 252,248,72
Mvaa 252,252,76
s_waitcnt lgkmcnt(9)
Ra 228,11,0
Maaa 128,240,80
buffer_load_dwordx4 v2, s[8:11], s50 offen offset:2048 lds
Maaa 128,244,84
Ta 44,21,16384
Ta 46,21,18432
Maaa 132,248,80
s_cmp_eq_u32 s6, 2
s_cselect_b32 s3, 0, 2146435072
Maaa 132,252,84
Ra 232,10,2048
Maaa 136,240,88
buffer_load_dwordx4 v3, s[8:11], s51 offen offset:3072 lds
Maaa 136,244,92
Ta 48,22,0
Ta 50,22,2048
Maaa 140,248,88
s_mov_b64 exec, 1
buffer_atomic_add v30, v31, s[28:31], s3 offen sc1
s_mov_b64 exec, -1
Maaa 140,252,92
s_add_u32 m0, s56, 69632
s_waitcnt lgkmcnt(9)
Ra 236,11,2048
Maaa 144,240,96
buffer_load_dwordx4 v4, s[8:11], s48 offen offset:0 lds
Maaa 144,244,100
Maaa 148,248,96
Maaa 148,252,100
Ta 52,22,16384
Ta 54,22,18432
Maaa 152,240,104
buffer_load_dwordx4 v5, s[8:11], s49 offen offset:1024 lds
Maaa 152,244,108
Ta 56,23,0
Ta 58,23,2048
Maaa 156,248,104
Maaa 156,252,108
Ta 60,23,16384
s_waitcnt lgkmcnt(9)
Ta 62,23,18432
Maaa 160,240,112
buffer_load_dwordx4 v4, s[8:11], s50 offen offset:2048 lds
Maaa 160,244,116
Maaa 164,248,112
Maaa 164,252,116
Maaa 168,240,120
buffer_load_dwordx4 v5, s[8:11], s51 offen offset:3072 lds
Maaa 168,244,124
v_xor_b32 v2, 384, v2
v_xor_b32 v3, 384, v3
Maaa 172,248,120
s_waitcnt lgkmcnt(6)
buffer_load_dword v1, v47, s[60:63], 0 offen
v_xor_b32 v4, 384, v4
v_xor_b32 v5, 384, v5
Maaa 172,252,124
s_waitcnt lgkmcnt(0)
s_mul_i32 vcc_lo, s59, 1
v_xor_b32_e64 v47, vcc_lo, v47
Mvaa 48,224,0
buffer_load_dword v44, v45, s[16:19], s47 offen
Mvaa 48,228,4
s_add_u32 s47, s47, 2097152
Mvaa 52,232,0
Mvaa 52,236,4
Ra 240,10,4096
Mvaa 56,224,8
Mvaa 56,228,12
Mvaa 60,232,8
Mvaa 60,236,12
Ra 244,11,4096
Mvaa 64,224,16
Mvaa 64,228,20
Mvaa 68,232,16
Mvaa 68,236,20
Ra 248,10,6144
Mvaa 72,224,24
Mvaa 72,228,28
Mvaa 76,232,24
Mvaa 76,236,28
Ra 252,11,6144
Mvaa 80,224,32
Mvaa 80,228,36
Mvaa 84,232,32
Mvaa 84,236,36
Mvaa 88,224,40
Mvaa 88,228,44
Mvaa 92,232,40
Mvaa 92,236,44
Mvaa 96,224,48
Mvaa 96,228,52
Mvaa 100,232,48
Mvaa 100,236,52
Mvaa 104,224,56
Mvaa 104,228,60
Mvaa 108,232,56
s_waitcnt lgkmcnt(0)
Mvaa 108,236,60
Mvaa 112,240,0
Mvaa 112,244,4
Mvaa 116,248,0
Mvaa 116,252,4
Ra 224,10,8192
Mvaa 120,240,8
Mvaa 120,244,12
Mvaa 124,248,8
Mvaa 124,252,12
Ra 228,11,8192
Mvaa 128,240,16
Mvaa 128,244,20
Mvaa 132,248,16
Mvaa 132,252,20
Ra 232,10,10240
Mvaa 136,240,24
Mvaa 136,244,28
Mvaa 140,248,24
Mvaa 140,252,28
Ra 236,11,10240
Mvaa 144,240,32
Mvaa 144,244,36
Mvaa 148,248,32
Mvaa 148,252,36
Mvaa 152,240,40
s_cmp_eq_u32 s6, 3
s_cselect_b32 s3, 0, 2146435072
Mvaa 152,244,44
s_mov_b64 exec, 1
buffer_atomic_add v30, v31, s[28:31], s3 offen sc1
s_mov_b64 exec, -1
Mvaa 156,248,40
Mvaa 156,252,44
Mvaa 160,240,48
Mvaa 160,244,52
Mvaa 164,248,48
Mvaa 164,252,52
Mvaa 168,240,56
Mvaa 168,244,60
s_waitcnt vmcnt(12)
Mvaa 172,248,56
s_waitcnt lgkmcnt(0)
s_barrier
Mvaa 172,252,60
s_add_u32 m0, s57, 0
Mvaa 176,224,0
buffer_load_dwordx4 v6, s[12:15], s52 offen offset:0 lds
Mvaa 176,228,4
Ta 64,14,0
Ta 66,14,2048
Mvaa 180,232,0
Mvaa 180,236,4
Ra 240,10,12288
Mvaa 184,224,8
buffer_load_dwordx4 v7, s[12:15], s53 offen offset:1024 lds
Mvaa 184,228,12
Ta 68,14,16384
Ta 70,14,18432
Mvaa 188,232,8
Mvaa 188,236,12
Ra 244,11,12288
Mvaa 192,224,16
buffer_load_dwordx4 v6, s[12:15], s54 offen offset:2048 lds
Mvaa 192,228,20
Ta 72,15,0
Ta 74,15,2048
Mvaa 196,232,16
Mvaa 196,236,20
Ra 248,10,14336
Mvaa 200,224,24
buffer_load_dwordx4 v7, s[12:15], s55 offen offset:3072 lds
Mvaa 200,228,28
Ta 76,15,16384
Ta 78,15,18432
Mvaa 204,232,24
Mvaa 204,236,28
s_add_u32 m0, s57, 4096
Ra 252,11,14336
Mvaa 208,224,32
buffer_load_dwordx4 v8, s[12:15], s52 offen offset:0 lds
Mvaa 208,228,36
Mvaa 212,232,32
Mvaa 212,236,36
Ta 80,24,0
Ta 82,24,2048
Mvaa 216,224,40
buffer_load_dwordx4 v9, s[12:15], s53 offen offset:1024 lds
Mvaa 216,228,44
Ta 84,24,16384
s_waitcnt lgkmcnt(9)
Ta 86,24,18432
Mvaa 220,232,40
Mvaa 220,236,44
Ta 88,25,0
Ta 90,25,2048
Mvaa 224,224,48
buffer_load_dwordx4 v8, s[12:15], s54 offen offset:2048 lds
Mvaa 224,228,52
Mvaa 228,232,48
Mvaa 228,236,52
Ta 92,25,16384
Ta 94,25,18432
Mvaa 232,224,56
buffer_load_dwordx4 v9, s[12:15], s55 offen offset:3072 lds
Mvaa 232,228,60
s_waitcnt vmcnt(11)
Ta 96,26,0
s_waitcnt lgkmcnt(9)
Ta 98,26,2048
Mvaa 236,232,56
s_barrier
v_xor_b32 v6, 524288, v6
v_xor_b32 v7, 524288, v7
Mvaa 236,236,60
s_add_u32 m0, s56, 0
Ta 100,26,16384
Ta 102,26,18432
Mvaa 240,240,0
buffer_load_dwordx4 v2, s[8:11], s48 offen offset:0 lds
Mvaa 240,244,4
v_xor_b32 v8, 524288, v8
v_xor_b32 v9, 524288, v9
Mvaa 244,248,0
Mvaa 244,252,4
Ra 224,12,0
Mvaa 248,240,8
buffer_load_dwordx4 v3, s[8:11], s49 offen offset:1024 lds
Mvaa 248,244,12
Ta 104,27,0
Ta 106,27,2048
Mvaa 252,248,8
Mvaa 252,252,12
s_waitcnt lgkmcnt(9)
Ra 228,13,0
Maaa 128,240,16
buffer_load_dwordx4 v2, s[8:11], s50 offen offset:2048 lds
Maaa 128,244,20
Ta 108,27,16384
Ta 110,27,18432
Maaa 132,248,16
Maaa 132,252,20
Ra 232,12,2048
Maaa 136,240,24
buffer_load_dwordx4 v3, s[8:11], s51 offen offset:3072 lds
Maaa 136,244,28
Ta 112,28,0
Ta 114,28,2048
Maaa 140,248,24
Maaa 140,252,28
s_add_u32 m0, s56, 4096
s_waitcnt lgkmcnt(9)
Ra 236,13,2048
Maaa 144,240,32
buffer_load_dwordx4 v4, s[8:11], s48 offen offset:0 lds
Maaa 144,244,36
Maaa 148,248,32
Maaa 148,252,36
Ta 116,28,16384
Ta 118,28,18432
Maaa 152,240,40
buffer_load_dwordx4 v5, s[8:11], s49 offen offset:1024 lds
Maaa 152,244,44
Ta 120,29,0
Ta 122,29,2048
Maaa 156,248,40
Maaa 156,252,44
Ta 124,29,16384
s_waitcnt lgkmcnt(9)
Ta 126,29,18432
Maaa 160,240,48
buffer_load_dwordx4 v4, s[8:11], s50 offen offset:2048 lds
Maaa 160,244,52
Maaa 164,248,48
Maaa 164,252,52
Maaa 168,240,56
buffer_load_dwordx4 v5, s[8:11], s51 offen offset:3072 lds
Maaa 168,244,60
v_xor_b32 v2, 128, v2
v_xor_b32 v3, 128, v3
Maaa 172,248,56
s_waitcnt lgkmcnt(6)
buffer_load_dword v1, v47, s[60:63], 0 offen
v_xor_b32 v4, 128, v4
v_xor_b32 v5, 128, v5
Maaa 172,252,60
s_waitcnt lgkmcnt(0)
s_mul_i32 vcc_lo, s59, 7
v_xor_b32 v47, vcc_lo, v47
Mvaa 48,224,64
buffer_load_dword v44, v45, s[16:19], s47 offen
Mvaa 48,228,68
s_add_u32 s47, s47, 2097152
v_lshrrev_b32 v32, 4, v0
v_and_b32 v33, 15, v0
Mvaa 52,232,64
s_lshl_b32 s3, s32, 4
v_add_u32 v34, s3, v32
v_lshlrev_b32_e64 v36, 1, v32
Mvaa 52,236,68
Ra 240,12,4096
Mvaa 56,224,72
v_xor_b32 v36, v36, v33
v_xor_b32 v37, 8, v36
Mvaa 56,228,76
Mvaa 60,232,72
Mvaa 60,236,76
Ra 244,13,4096
Mvaa 64,224,80
s_getpc_b64 s[6:7]
L_cpf3:
s_add_u32 s6, s6, (L_phase2-L_cpf3)&0xffffffff
s_addc_u32 s7, s7, ((L_phase2-L_cpf3)>>32)&0xffffffff
Mvaa 64,228,84
s_lshr_b32 s3, s2, 3
s_lshl_b32 s3, s3, 2
s_add_u32 s3, s3, s32
Mvaa 68,232,80
s_lshl_b32 s3, s3, 10
v_and_b32 v42, 7, v0
v_lshlrev_b32_e64 v42, 7, v42
Mvaa 68,236,84
Ra 248,12,6144
Mvaa 72,224,88
v_add_u32_e64 v42, s3, v42
v_min_u32 v42, L_k2_fin-L_phase2-4, v42
Mvaa 72,228,92
v_mov_b32_e64 v41, s7
Mvaa 76,232,88
v_add_co_u32 v40, vcc, s6, v42
s_nop 1
v_addc_co_u32 v41, vcc, 0, v41, vcc
Mvaa 76,236,92
Ra 252,13,6144
Mvaa 80,224,96
global_load_dword v38, v[40:41], off
Mvaa 80,228,100
Mvaa 84,232,96
Mvaa 84,236,100
Mvaa 88,224,104
Mvaa 88,228,108
Mvaa 92,232,104
Mvaa 92,236,108
Mvaa 96,224,112
Mvaa 96,228,116
Mvaa 100,232,112
Mvaa 100,236,116
Mvaa 104,224,120
Mvaa 104,228,124
Mvaa 108,232,120
s_waitcnt lgkmcnt(0)
Mvaa 108,236,124
Mvaa 112,240,64
Mvaa 112,244,68
Mvaa 116,248,64
Mvaa 116,252,68
Ra 224,12,8192
Mvaa 120,240,72
Mvaa 120,244,76
Mvaa 124,248,72
Mvaa 124,252,76
Ra 228,13,8192
Mvaa 128,240,80
Mvaa 128,244,84
Mvaa 132,248,80
Mvaa 132,252,84
Ra 232,12,10240
Mvaa 136,240,88
Mvaa 136,244,92
Mvaa 140,248,88
Mvaa 140,252,92
Ra 236,13,10240
Mvaa 144,240,96
Mvaa 144,244,100
Mvaa 148,248,96
Mvaa 148,252,100
Mvaa 152,240,104
Mvaa 152,244,108
Mvaa 156,248,104
Mvaa 156,252,108
Mvaa 160,240,112
Mvaa 160,244,116
Mvaa 164,248,112
Mvaa 164,252,116
Mvaa 168,240,120
Mvaa 168,244,124
s_waitcnt vmcnt(11)
Mvaa 172,248,120
s_waitcnt lgkmcnt(0)
s_barrier
Mvaa 172,252,124
s_add_u32 m0, s57, 65536
Mvaa 176,224,64
buffer_load_dwordx4 v6, s[12:15], s52 offen offset:0 lds
Mvaa 176,228,68
Ta 0,16,0
Ta 2,16,2048
Mvaa 180,232,64
Mvaa 180,236,68
Ra 240,12,12288
Mvaa 184,224,72
buffer_load_dwordx4 v7, s[12:15], s53 offen offset:1024 lds
Mvaa 184,228,76
Ta 4,16,16384
Ta 6,16,18432
Mvaa 188,232,72
Mvaa 188,236,76
Ra 244,13,12288
Mvaa 192,224,80
buffer_load_dwordx4 v6, s[12:15], s54 offen offset:2048 lds
Mvaa 192,228,84
Ta 8,17,0
Ta 10,17,2048
Mvaa 196,232,80
Mvaa 196,236,84
Ra 248,12,14336
Mvaa 200,224,88
buffer_load_dwordx4 v7, s[12:15], s55 offen offset:3072 lds
Mvaa 200,228,92
Ta 12,17,16384
Ta 14,17,18432
Mvaa 204,232,88
Mvaa 204,236,92
s_add_u32 m0, s57, 69632
Ra 252,13,14336
Mvaa 208,224,96
buffer_load_dwordx4 v8, s[12:15], s52 offen offset:0 lds
Mvaa 208,228,100
Mvaa 212,232,96
Mvaa 212,236,100
Ta 16,18,0
Ta 18,18,2048
Mvaa 216,224,104
buffer_load_dwordx4 v9, s[12:15], s53 offen offset:1024 lds
Mvaa 216,228,108
Ta 20,18,16384
s_waitcnt lgkmcnt(9)
Ta 22,18,18432
Mvaa 220,232,104
Mvaa 220,236,108
Ta 24,19,0
Ta 26,19,2048
Mvaa 224,224,112
buffer_load_dwordx4 v8, s[12:15], s54 offen offset:2048 lds
Mvaa 224,228,116
Mvaa 228,232,112
Mvaa 228,236,116
Ta 28,19,16384
Ta 30,19,18432
Mvaa 232,224,120
buffer_load_dwordx4 v9, s[12:15], s55 offen offset:3072 lds
Mvaa 232,228,124
s_waitcnt vmcnt(11)
Ta 32,20,0
s_waitcnt lgkmcnt(9)
Ta 34,20,2048
Mvaa 236,232,120
s_barrier
Mvaa 236,236,124
s_add_u32 m0, s56, 65536
Ta 36,20,16384
Ta 38,20,18432
Mvaa 240,240,64
buffer_load_dwordx4 v2, s[8:11], s48 offen offset:0 lds
Mvaa 240,244,68
Mvaa 244,248,64
Mvaa 244,252,68
Ra 224,10,0
Mvaa 248,240,72
buffer_load_dwordx4 v3, s[8:11], s49 offen offset:1024 lds
Mvaa 248,244,76
Ta 40,21,0
Ta 42,21,2048
Mvaa 252,248,72
Mvaa 252,252,76
s_waitcnt lgkmcnt(9)
Ra 228,11,0
Maaa 128,240,80
buffer_load_dwordx4 v2, s[8:11], s50 offen offset:2048 lds
Maaa 128,244,84
Ta 44,21,16384
Ta 46,21,18432
Maaa 132,248,80
Maaa 132,252,84
Ra 232,10,2048
Maaa 136,240,88
buffer_load_dwordx4 v3, s[8:11], s51 offen offset:3072 lds
Maaa 136,244,92
Ta 48,22,0
Ta 50,22,2048
Maaa 140,248,88
Maaa 140,252,92
s_add_u32 m0, s56, 69632
s_waitcnt lgkmcnt(9)
Ra 236,11,2048
Maaa 144,240,96
buffer_load_dwordx4 v4, s[8:11], s48 offen offset:0 lds
Maaa 144,244,100
Maaa 148,248,96
Maaa 148,252,100
Ta 52,22,16384
Ta 54,22,18432
Maaa 152,240,104
buffer_load_dwordx4 v5, s[8:11], s49 offen offset:1024 lds
Maaa 152,244,108
Ta 56,23,0
Ta 58,23,2048
Maaa 156,248,104
Maaa 156,252,108
Ta 60,23,16384
s_waitcnt lgkmcnt(9)
Ta 62,23,18432
Maaa 160,240,112
buffer_load_dwordx4 v4, s[8:11], s50 offen offset:2048 lds
Maaa 160,244,116
Maaa 164,248,112
Maaa 164,252,116
Maaa 168,240,120
buffer_load_dwordx4 v5, s[8:11], s51 offen offset:3072 lds
Maaa 168,244,124
Maaa 172,248,120
s_waitcnt lgkmcnt(6)
Maaa 172,252,124
s_waitcnt lgkmcnt(0)
Mvaa 48,224,0
buffer_load_dword v1, v31, s[28:31], s37 offen sc1
Mvaa 48,228,4
s_mov_b32 s8, s16
s_mov_b32 s9, s17
s_mov_b32 s10, s18
Mvaa 52,232,0
s_add_u32 s16, s66, 46137344
s_addc_u32 s17, s67, 0
s_and_b32 s17, s17, 0xffff
Mvaa 52,236,4
Ra 240,10,4096
Mvaa 56,224,8
s_mov_b32 s18, 16777216
s_mov_b32 s19, 0x20000
s_mov_b32 s48, 0
Mvaa 56,228,12
s_mov_b32 s49, 31744
s_mov_b32 s50, 63488
s_mov_b32 s51, 95232
Mvaa 60,232,8
v_lshlrev_b32 v35, 13, v34
Mvaa 60,236,12
Ra 244,11,4096
Mvaa 64,224,16
s_and_b32 s52, s33, 0
s_lshl_b32 s3, s52, 19
s_lshl_b32 s52, s52, 11
Mvaa 64,228,20
s_add_u32 s53, s52, s58
v_add_u32_e64 v35, s3, v35
v_lshl_add_u32 v8, v36, 4, v35
Mvaa 68,232,16
v_lshl_add_u32 v9, v37, 4, v35
v_lshlrev_b32_e64 v2, 4, v0
Mvaa 68,236,20
Ra 248,10,6144
Mvaa 72,224,24
v_add_u32 v3, 65536, v2
v_add_u32_e64 v4, s44, v2
Mvaa 72,228,28
v_mov_b32 v7, 0
v_lshlrev_b32 v35, 2, v32
Mvaa 76,232,24
v_sub_u32_e64 v35, v33, v35
Mvaa 76,236,28
Ra 252,11,6144
Mvaa 80,224,32
s_lshl_b32 s3, s32, 4
v_add_u32 v5, s3, v35
Mvaa 80,228,36
s_sub_u32 s3, 48, s3
v_add_u32 v6, s3, v35
Mvaa 84,232,32
s_mul_i32 s3, s33, 1116160
s_add_u32 s3, s3, 8388608
s_add_u32 s12, s66, s3
s_addc_u32 s13, s67, 0
s_and_b32 s13, s13, 0xffff
Mvaa 84,236,36
s_mov_b32 s14, 0
s_mov_b32 s15, 0x20000
s_mul_i32 s14, s36, 34816
Mvaa 88,224,40
buffer_load_dword v44, v45, s[8:11], s47 offen
Mvaa 88,228,44
s_add_u32 s47, s47, 2097152
v_lshrrev_b32 v42, 2, v33
v_lshl_add_u32 v43, v32, 3, v42
Mvaa 92,232,40
v_lshlrev_b32 v43, 8, v43
v_and_b32 v46, 3, v0
Mvaa 92,236,44
v_lshl_add_u32 v43, v46, 3, v43
v_and_b32_e64 v46, 1, v32
Mvaa 96,224,48
v_lshl_add_u32 v42, v46, 2, v42
v_lshl_add_u32 v16, v42, 5, v43
Mvaa 96,228,52
v_xor_b32 v17, 32, v16
v_xor_b32 v18, 64, v16
Mvaa 100,232,48
v_xor_b32 v19, 96, v16
v_xor_b32 v20, 128, v16
Mvaa 100,236,52
v_xor_b32 v21, 160, v16
v_xor_b32 v22, 192, v16
Mvaa 104,224,56
v_xor_b32 v23, 224, v16
Mvaa 104,228,60
Mvaa 108,232,56
s_waitcnt lgkmcnt(0)
Mvaa 108,236,60
Mvaa 112,240,0
Mvaa 112,244,4
Mvaa 116,248,0
Mvaa 116,252,4
Ra 224,10,8192
Mvaa 120,240,8
Mvaa 120,244,12
Mvaa 124,248,8
Mvaa 124,252,12
Ra 228,11,8192
Mvaa 128,240,16
Mvaa 128,244,20
Mvaa 132,248,16
Mvaa 132,252,20
Ra 232,10,10240
Mvaa 136,240,24
Mvaa 136,244,28
Mvaa 140,248,24
Mvaa 140,252,28
Ra 236,11,10240
Mvaa 144,240,32
Mvaa 144,244,36
Mvaa 148,248,32
Mvaa 148,252,36
Mvaa 152,240,40
Mvaa 152,244,44
Mvaa 156,248,40
Mvaa 156,252,44
Mvaa 160,240,48
Mvaa 160,244,52
Mvaa 164,248,48
Mvaa 164,252,52
Mvaa 168,240,56
Mvaa 168,244,60
s_waitcnt vmcnt(10)
Mvaa 172,248,56
s_waitcnt lgkmcnt(0)
s_barrier
Mvaa 172,252,60
s_add_u32 m0, s44, 0
Mvaa 176,224,0
buffer_load_dwordx4 v8, s[8:11], s48 offen offset:0 lds
Mvaa 176,228,4
Ta 64,14,0
Ta 66,14,2048
Mvaa 180,232,0
Mvaa 180,236,4
Ra 240,10,12288
Mvaa 184,224,8
buffer_load_dwordx4 v8, s[8:11], s49 offen offset:1024 lds
Mvaa 184,228,12
Ta 68,14,16384
Ta 70,14,18432
Mvaa 188,232,8
Mvaa 188,236,12
Ra 244,11,12288
Mvaa 192,224,16
buffer_load_dwordx4 v9, s[8:11], s50 offen offset:2048 lds
Mvaa 192,228,20
Ta 72,15,0
Ta 74,15,2048
Mvaa 196,232,16
Mvaa 196,236,20
Ra 248,10,14336
Mvaa 200,224,24
buffer_load_dwordx4 v9, s[8:11], s51 offen offset:3072 lds
Mvaa 200,228,28
Ta 76,15,16384
Ta 78,15,18432
Mvaa 204,232,24
v_xor_b32 v8, 524288, v8
v_xor_b32 v9, 524288, v9
Mvaa 204,236,28
s_add_u32 m0, s44, 16384
Ra 252,11,14336
Mvaa 208,224,32
buffer_load_dwordx4 v8, s[8:11], s48 offen offset:0 lds
Mvaa 208,228,36
Mvaa 212,232,32
Mvaa 212,236,36
Ta 80,24,0
Ta 82,24,2048
Mvaa 216,224,40
buffer_load_dwordx4 v8, s[8:11], s49 offen offset:1024 lds
Mvaa 216,228,44
Ta 84,24,16384
s_waitcnt lgkmcnt(9)
Ta 86,24,18432
Mvaa 220,232,40
Mvaa 220,236,44
Ta 88,25,0
Ta 90,25,2048
Mvaa 224,224,48
buffer_load_dwordx4 v9, s[8:11], s50 offen offset:2048 lds
Mvaa 224,228,52
Mvaa 228,232,48
s_mul_i32 s3, s45, 33792
v_add_u32_e64 v10, s3, v2
Mvaa 228,236,52
Ta 92,25,16384
Ta 94,25,18432
Mvaa 232,224,56
buffer_load_dwordx4 v9, s[8:11], s51 offen offset:3072 lds
Mvaa 232,228,60
s_waitcnt vmcnt(10)
Ta 96,26,0
s_waitcnt lgkmcnt(9)
Ta 98,26,2048
Mvaa 236,232,56
s_barrier
v_xor_b32 v8, 1572864, v8
v_xor_b32 v9, 1572864, v9
Mvaa 236,236,60
s_add_u32 m0, s44, 32768
Ta 100,26,16384
Ta 102,26,18432
Mvaa 240,240,0
buffer_load_dwordx4 v8, s[8:11], s48 offen offset:0 lds
Mvaa 240,244,4
s_mul_i32 s3, s46, 33792
v_add_u32 v11, s3, v2
Mvaa 244,248,0
Mvaa 244,252,4
Ra 224,12,0
Mvaa 248,240,8
buffer_load_dwordx4 v8, s[8:11], s49 offen offset:1024 lds
Mvaa 248,244,12
Ta 104,27,0
Ta 106,27,2048
Mvaa 252,248,8
Mvaa 252,252,12
s_waitcnt lgkmcnt(9)
Ra 228,13,0
Maaa 128,240,16
buffer_load_dwordx4 v9, s[8:11], s50 offen offset:2048 lds
Maaa 128,244,20
Ta 108,27,16384
Ta 110,27,18432
Maaa 132,248,16
Maaa 132,252,20
Ra 232,12,2048
Maaa 136,240,24
buffer_load_dwordx4 v9, s[8:11], s51 offen offset:3072 lds
Maaa 136,244,28
Ta 112,28,0
Ta 114,28,2048
Maaa 140,248,24
v_xor_b32 v8, 524288, v8
v_xor_b32 v9, 524288, v9
Maaa 140,252,28
s_add_u32 m0, s44, 49152
s_waitcnt lgkmcnt(9)
Ra 236,13,2048
Maaa 144,240,32
buffer_load_dwordx4 v8, s[8:11], s48 offen offset:0 lds
Maaa 144,244,36
Maaa 148,248,32
Maaa 148,252,36
Ta 116,28,16384
Ta 118,28,18432
Maaa 152,240,40
buffer_load_dwordx4 v8, s[8:11], s49 offen offset:1024 lds
Maaa 152,244,44
Ta 120,29,0
Ta 122,29,2048
Maaa 156,248,40
Maaa 156,252,44
Ta 124,29,16384
s_waitcnt lgkmcnt(9)
Ta 126,29,18432
Maaa 160,240,48
buffer_load_dwordx4 v9, s[8:11], s50 offen offset:2048 lds
Maaa 160,244,52
Maaa 164,248,48
Maaa 164,252,52
Maaa 168,240,56
buffer_load_dwordx4 v9, s[8:11], s51 offen offset:3072 lds
Maaa 168,244,60
v_xor_b32 v8, 3670016, v8
v_xor_b32 v9, 3670016, v9
Maaa 172,248,56
s_waitcnt lgkmcnt(6)
Maaa 172,252,60
s_waitcnt lgkmcnt(0)
Mvaa 48,224,64
v_mov_b32 v14, v40
v_mov_b32_e64 v15, v41
Mvaa 48,228,68
Mvaa 52,232,64
Mvaa 52,236,68
Ra 240,12,4096
Mvaa 56,224,72
Mvaa 56,228,76
Mvaa 60,232,72
Mvaa 60,236,76
Ra 244,13,4096
Mvaa 64,224,80
Vc 24,48,49
Vc 25,50,51
Mvaa 64,228,84
Vc 26,52,53
Vc 27,54,55
Mvaa 68,232,80
Mvaa 68,236,84
Ra 248,12,6144
Mvaa 72,224,88
Vc 28,56,57
Vc 29,58,59
Mvaa 72,228,92
Vc 30,60,61
Vc 31,62,63
Mvaa 76,232,88
Mvaa 76,236,92
Ra 252,13,6144
Mvaa 80,224,96
Vc 32,64,65
Vc 33,66,67
Mvaa 80,228,100
Vc 34,68,69
Vc 35,70,71
Mvaa 84,232,96
Mvaa 84,236,100
Mvaa 88,224,104
Vc 36,72,73
Vc 37,74,75
Mvaa 88,228,108
Vc 38,76,77
Vc 39,78,79
Mvaa 92,232,104
Mvaa 92,236,108
Mvaa 96,224,112
Vc 40,80,81
Vc 41,82,83
Mvaa 96,228,116
Vc 42,84,85
Vc 43,86,87
Mvaa 100,232,112
s_waitcnt vmcnt(12)
Mvaa 100,236,116
s_add_u32 s59, s38, 0
Mvaa 104,224,120
v_readfirstlane_b32 s3, v1
s_nop 0
s_or_b32 s3, s3, s37
s_cmp_lt_u32 s3, 256
s_cbranch_scc1 L_spinAv
L_spinArv:
s_barrier
Mvaa 104,228,124
buffer_store_dwordx4 v[24:27], v2, s[24:27], s59 offen offset:0 sc1
Mvaa 108,232,120
s_waitcnt lgkmcnt(0)
Mvaa 108,236,124
Vc 44,88,89
Vc 45,90,91
Mvaa 112,240,64
buffer_load_dwordx4 a[0:3], v10, s[20:23], s53 offen offset:0 sc1
Mvaa 112,244,68
Vc 46,92,93
Vc 47,94,95
Mvaa 116,248,64
Vc 48,96,97
Vc 49,98,99
Mvaa 116,252,68
Ra 224,12,8192
Mvaa 120,240,72
Vc 50,100,101
Vc 51,102,103
Mvaa 120,244,76
Vc 52,104,105
Vc 53,106,107
Mvaa 124,248,72
buffer_load_dwordx4 a[4:7], v10, s[20:23], s52 offen offset:0 sc1
Mvaa 124,252,76
Ra 228,13,8192
Mvaa 128,240,80
Vc 54,108,109
Vc 55,110,111
Mvaa 128,244,84
Vc 56,112,113
Vc 57,114,115
Mvaa 132,248,80
Vc 58,116,117
Vc 59,118,119
Mvaa 132,252,84
Ra 232,12,10240
Mvaa 136,240,88
buffer_load_dwordx4 a[8:11], v11, s[20:23], s53 offen offset:0 sc1
Mvaa 136,244,92
buffer_store_dwordx4 v[28:31], v2, s[24:27], s59 offen offset:1024 sc1
Mvaa 140,248,88
Vc 60,120,121
Vc 61,122,123
Mvaa 140,252,92
Ra 236,13,10240
Mvaa 144,240,96
Vc 62,124,125
Vc 63,126,127
Mvaa 144,244,100
Vc 64,128,129
Vc 65,130,131
Mvaa 148,248,96
buffer_load_dwordx4 a[12:15], v11, s[20:23], s52 offen offset:0 sc1
Mvaa 148,252,100
Vc 66,132,133
Vc 67,134,135
Mvaa 152,240,104
Vc 68,136,137
Vc 69,138,139
Mvaa 152,244,108
Vc 70,140,141
Vc 71,142,143
Mvaa 156,248,104
Mvaa 156,252,108
Mvaa 160,240,112
buffer_load_dwordx4 a[16:19], v10, s[20:23], s53 offen offset:1024 sc1
Mvaa 160,244,116
Vc 72,144,145
Vc 73,146,147
Mvaa 164,248,112
Vc 74,148,149
Vc 75,150,151
Mvaa 164,252,116
buffer_store_dwordx4 v[32:35], v2, s[24:27], s59 offen offset:2048 sc1
Mvaa 168,240,120
Vc 76,152,153
Vc 77,154,155
Mvaa 168,244,124
Vc 78,156,157
Vc 79,158,159
Mvaa 172,248,120
s_waitcnt lgkmcnt(0)
buffer_load_dwordx4 a[20:23], v10, s[20:23], s52 offen offset:1024 sc1
Mvaa 172,252,124
Mvaa 176,224,64
Vc 80,160,161
Vc 81,162,163
Mvaa 176,228,68
Vc 82,164,165
Vc 83,166,167
Mvaa 180,232,64
Mvaa 180,236,68
Ra 240,12,12288
Mvaa 184,224,72
buffer_load_dwordx4 a[24:27], v11, s[20:23], s53 offen offset:1024 sc1
Mvaa 184,228,76
Vc 84,168,169
Vc 85,170,171
Mvaa 188,232,72
Vc 86,172,173
Vc 87,174,175
Mvaa 188,236,76
Ra 244,13,12288
Mvaa 192,224,80
Vc 88,176,177
Vc 89,178,179
Mvaa 192,228,84
Vc 90,180,181
Vc 91,182,183
Mvaa 196,232,80
buffer_load_dwordx4 a[28:31], v11, s[20:23], s52 offen offset:1024 sc1
Mvaa 196,236,84
Ra 248,12,14336
s_xor_b32 s52, s52, 2048
Mvaa 200,224,88
s_add_u32 s53, s52, s58
Mvaa 200,228,92
Vc 92,184,185
Vc 93,186,187
Mvaa 204,232,88
Vc 94,188,189
Vc 95,190,191
Mvaa 204,236,92
Ra 252,13,14336
Mvaa 208,224,96
buffer_load_dwordx4 a[32:35], v10, s[20:23], s53 offen offset:0 sc1
Mvaa 208,228,100
buffer_store_dwordx4 v[36:39], v2, s[24:27], s59 offen offset:3072 sc1
Mvaa 212,232,96
Vc 96,192,193
Vc 97,194,195
Mvaa 212,236,100
Vc 98,196,197
Vc 99,198,199
Mvaa 216,224,104
Vc 100,200,201
Vc 101,202,203
Mvaa 216,228,108
Vc 102,204,205
Vc 103,206,207
Mvaa 220,232,104
buffer_load_dwordx4 a[36:39], v10, s[20:23], s52 offen offset:0 sc1
Mvaa 220,236,108
Mvaa 224,224,112
Vc 104,208,209
Vc 105,210,211
Mvaa 224,228,116
Vc 106,212,213
Vc 107,214,215
Mvaa 228,232,112
Mvaa 228,236,116
Mvaa 232,224,120
buffer_load_dwordx4 a[40:43], v11, s[20:23], s53 offen offset:0 sc1
Mvaa 232,228,124
Vc 108,216,217
Vc 109,218,219
Mvaa 236,232,120
s_waitcnt lgkmcnt(0)
Mvaa 236,236,124
Vc 110,220,221
Vc 111,222,223
Mvaa 240,240,64
s_add_u32 s59, s38, 4096
Mvaa 240,244,68
buffer_store_dwordx4 v[40:43], v2, s[24:27], s59 offen offset:0 sc1
Mvaa 244,248,64
buffer_load_dwordx4 a[44:47], v11, s[20:23], s52 offen offset:0 sc1
Mvaa 244,252,68
Vc 112,224,225
Vc 113,226,227
Mvaa 248,240,72
Vc 114,228,229
Vc 115,230,231
Mvaa 248,244,76
Vc 116,232,233
Vc 117,234,235
Mvaa 252,248,72
Vc 118,236,237
Vc 119,238,239
Mvaa 252,252,76
Maaa 128,240,80
buffer_load_dwordx4 a[48:51], v10, s[20:23], s53 offen offset:1024 sc1
Maaa 128,244,84
Ta 192,16,0
Ta 194,16,1024
Maaa 132,248,80
Vc 120,240,241
Vc 121,242,243
Maaa 132,252,84
Ta 196,17,0
Ta 198,17,1024
Maaa 136,240,88
Vc 122,244,245
Vc 123,246,247
Maaa 136,244,92
Ta 200,18,0
Ta 202,18,1024
Maaa 140,248,88
buffer_load_dwordx4 a[52:55], v10, s[20:23], s52 offen offset:1024 sc1
Maaa 140,252,92
Ta 204,19,0
Ta 206,19,1024
Maaa 144,240,96
Vc 124,248,249
Vc 125,250,251
Maaa 144,244,100
Ta 208,20,0
Ta 210,20,1024
Maaa 148,248,96
Vc 126,252,253
Vc 127,254,255
Maaa 148,252,100
Ta 212,21,0
Ta 214,21,1024
Maaa 152,240,104
buffer_load_dwordx4 a[56:59], v11, s[20:23], s53 offen offset:1024 sc1
Maaa 152,244,108
Ta 216,22,0
Ta 218,22,1024
Maaa 156,248,104
buffer_store_dwordx4 v[44:47], v2, s[24:27], s59 offen offset:1024 sc1
Maaa 156,252,108
Ta 220,23,0
s_waitcnt lgkmcnt(9)
Ta 222,23,1024
Maaa 160,240,112
Maaa 160,244,116
Maaa 164,248,112
buffer_load_dwordx4 a[60:63], v11, s[20:23], s52 offen offset:1024 sc1
Maaa 164,252,116
s_xor_b32 s52, s52, 6144
s_add_u32 s53, s52, s58
Maaa 168,240,120
Maaa 168,244,124
Maaa 172,248,120
Maaa 172,252,124
L_phase2:
s_nop 7
s_waitcnt vmcnt(16) lgkmcnt(0)
Zvaa 128,192,0
buffer_store_dwordx4 v[48:51], v2, s[24:27], s59 offen offset:2048 sc1
Zvaa 160,192,4
Ta 224,16,8192
Ta 226,16,9216
Zvaa 192,192,8
buffer_load_dwordx4 a[64:67], v10, s[20:23], s53 offen offset:0 sc1
Zvaa 224,192,12
s_mov_b32 s60, s40
s_and_b32 s61, s41, 0xffff
s_mov_b32 s62, 7340032
Zvaa 132,196,0
Ta 228,17,8192
Ta 230,17,9216
Zvaa 164,196,4
buffer_load_dwordx4 a[68:71], v10, s[20:23], s52 offen offset:0 sc1
Zvaa 196,196,8
s_mov_b32 s63, 0x20000
Zvaa 228,196,12
Ta 232,18,8192
Ta 234,18,9216
Zvaa 136,200,0
global_load_dword v13, v[14:15], off
Zvaa 168,200,4
buffer_load_dwordx4 a[72:75], v11, s[20:23], s53 offen offset:0 sc1
Zvaa 200,200,8
Ta 236,19,8192
Ta 238,19,9216
Zvaa 232,200,12
Zvaa 140,204,0
buffer_load_dwordx4 a[76:79], v11, s[20:23], s52 offen offset:0 sc1
Zvaa 172,204,4
Ta 240,20,8192
Ta 242,20,9216
Zvaa 204,204,8
Zvaa 236,204,12
Zvaa 144,208,0
s_waitcnt lgkmcnt(6)
Ta 244,21,8192
Ta 246,21,9216
Zvaa 176,208,4
buffer_load_dwordx4 a[80:83], v10, s[20:23], s53 offen offset:1024 sc1
Zvaa 208,208,8
Zvaa 240,208,12
Ta 248,22,8192
Ta 250,22,9216
Zvaa 148,212,0
buffer_load_dwordx4 a[84:87], v10, s[20:23], s52 offen offset:1024 sc1
Zvaa 180,212,4
Zvaa 212,212,8
Ta 252,23,8192
Ta 254,23,9216
Zvaa 244,212,12
Zvaa 152,216,0
buffer_load_dwordx4 a[88:91], v11, s[20:23], s53 offen offset:1024 sc1
Zvaa 184,216,4
Zvaa 216,216,8
buffer_load_dwordx4 a[92:95], v11, s[20:23], s52 offen offset:1024 sc1
Zvaa 248,216,12
s_xor_b32 s52, s52, 2048
s_add_u32 s53, s52, s58
Zvaa 156,220,0
buffer_store_dwordx4 v[52:55], v2, s[24:27], s59 offen offset:3072 sc1
Zvaa 188,220,4
Zvaa 220,220,8
s_waitcnt vmcnt(22) lgkmcnt(0)
Zvaa 252,220,12
s_barrier
Mvaa 128,224,16
Mvaa 160,224,20
s_add_u32 m0, s44, 0
Ta 192,16,16384
Ta 194,16,17408
Mvaa 192,224,24
buffer_load_dwordx4 v8, s[8:11], s48 offen offset:0 lds
Mvaa 224,224,28
Mvaa 132,228,16
Ta 196,17,16384
Ta 198,17,17408
Mvaa 164,228,20
Mvaa 196,228,24
buffer_load_dwordx4 v8, s[8:11], s49 offen offset:1024 lds
Mvaa 228,228,28
Ta 200,18,16384
Ta 202,18,17408
Mvaa 136,232,16
Mvaa 168,232,20
Mvaa 200,232,24
Ta 204,19,16384
Ta 206,19,17408
Mvaa 232,232,28
buffer_load_dwordx4 a[96:99], v10, s[20:23], s53 offen offset:0 sc1
Mvaa 140,236,16
Mvaa 172,236,20
Ta 208,20,16384
Ta 210,20,17408
Mvaa 204,236,24
Mvaa 236,236,28
Mvaa 144,240,16
s_waitcnt lgkmcnt(6)
Ta 212,21,16384
Ta 214,21,17408
Mvaa 176,240,20
buffer_load_dwordx4 a[100:103], v10, s[20:23], s52 offen offset:0 sc1
Mvaa 208,240,24
Mvaa 240,240,28
Ta 216,22,16384
Ta 218,22,17408
Mvaa 148,244,16
Mvaa 180,244,20
buffer_load_dwordx4 a[104:107], v11, s[20:23], s53 offen offset:0 sc1
Mvaa 212,244,24
Ta 220,23,16384
Ta 222,23,17408
Mvaa 244,244,28
s_add_u32 s59, s38, 8192
Mvaa 152,248,16
buffer_store_dwordx4 v[56:59], v2, s[24:27], s59 offen offset:0 sc1
Mvaa 184,248,20
buffer_load_dwordx4 a[108:111], v11, s[20:23], s52 offen offset:0 sc1
Mvaa 216,248,24
Ar 48,128
Ar 49,129
Mvaa 248,248,28
Ar 50,130
Ar 51,131
Mvaa 156,252,16
Ar 52,132
Ar 53,133
Mvaa 188,252,20
Ar 54,134
Ar 55,135
Mvaa 220,252,24
s_waitcnt vmcnt(23) lgkmcnt(0)
Vc 24,48,49
Vc 25,50,51
Mvaa 252,252,28
Vc 26,52,53
Vc 27,54,55
Mvaa 128,192,32
Mvaa 160,192,36
Ta 224,16,24576
Ta 226,16,25600
Mvaa 192,192,40
buffer_load_dwordx4 v9, s[8:11], s50 offen offset:2048 lds
Mvaa 224,192,44
Mvaa 132,196,32
Ta 228,17,24576
Ta 230,17,25600
Mvaa 164,196,36
Mvaa 196,196,40
buffer_load_dwordx4 v9, s[8:11], s51 offen offset:3072 lds
Mvaa 228,196,44
Ta 232,18,24576
Ta 234,18,25600
Mvaa 136,200,32
v_xor_b32 v8, 524288, v8
v_xor_b32 v9, 524288, v9
Mvaa 168,200,36
Mvaa 200,200,40
Ta 236,19,24576
Ta 238,19,25600
Mvaa 232,200,44
buffer_load_dwordx4 a[112:115], v10, s[20:23], s53 offen offset:1024 sc1
Mvaa 140,204,32
Mvaa 172,204,36
Ta 240,20,24576
Ta 242,20,25600
Mvaa 204,204,40
Mvaa 236,204,44
Mvaa 144,208,32
s_waitcnt lgkmcnt(6)
Ta 244,21,24576
Ta 246,21,25600
Mvaa 176,208,36
buffer_load_dwordx4 a[116:119], v10, s[20:23], s52 offen offset:1024 sc1
Mvaa 208,208,40
buffer_store_dwordx4 v[60:63], v2, s[24:27], s59 offen offset:1024 sc1
Mvaa 240,208,44
Ta 248,22,24576
Ta 250,22,25600
Mvaa 148,212,32
Ar 48,136
Ar 49,137
Mvaa 180,212,36
buffer_load_dwordx4 a[120:123], v11, s[20:23], s53 offen offset:1024 sc1
Mvaa 212,212,40
Ta 252,23,24576
Ta 254,23,25600
Mvaa 244,212,44
Ar 50,138
Ar 51,139
Mvaa 152,216,32
Ar 52,140
Ar 53,141
Mvaa 184,216,36
buffer_load_dwordx4 a[124:127], v11, s[20:23], s52 offen offset:1024 sc1
Mvaa 216,216,40
s_xor_b32 s52, s52, 14336
s_add_u32 s53, s52, s58
Mvaa 248,216,44
Ar 54,142
Ar 55,143
Mvaa 156,220,32
Vc 28,48,49
Vc 29,50,51
Mvaa 188,220,36
Vc 30,52,53
Vc 31,54,55
Mvaa 220,220,40
s_waitcnt vmcnt(25) lgkmcnt(0)
Mvaa 252,220,44
s_barrier
Mvaa 128,224,48
Mvaa 160,224,52
s_add_u32 m0, s44, 16384
Ta 192,16,32768
Ta 194,16,33792
Mvaa 192,224,56
buffer_load_dwordx4 v8, s[8:11], s48 offen offset:0 lds
Mvaa 224,224,60
Mvaa 132,228,48
Ta 196,17,32768
Ta 198,17,33792
Mvaa 164,228,52
Mvaa 196,228,56
buffer_load_dwordx4 v8, s[8:11], s49 offen offset:1024 lds
Mvaa 228,228,60
Ta 200,18,32768
Ta 202,18,33792
Mvaa 136,232,48
Mvaa 168,232,52
Mvaa 200,232,56
Ta 204,19,32768
Ta 206,19,33792
Mvaa 232,232,60
buffer_load_dwordx4 a[0:3], v10, s[20:23], s53 offen offset:0 sc1
Mvaa 140,236,48
buffer_store_dwordx4 v[64:67], v2, s[24:27], s59 offen offset:2048 sc1
Mvaa 172,236,52
Ta 208,20,32768
Ta 210,20,33792
Mvaa 204,236,56
Ar 48,144
Ar 49,145
Mvaa 236,236,60
Ar 50,146
Ar 51,147
Mvaa 144,240,48
s_waitcnt lgkmcnt(6)
Ta 212,21,32768
Ta 214,21,33792
Mvaa 176,240,52
buffer_load_dwordx4 a[4:7], v10, s[20:23], s52 offen offset:0 sc1
Mvaa 208,240,56
Ar 52,148
Ar 53,149
Mvaa 240,240,60
Ta 216,22,32768
Ta 218,22,33792
Mvaa 148,244,48
Ar 54,150
Ar 55,151
Mvaa 180,244,52
buffer_load_dwordx4 a[8:11], v11, s[20:23], s53 offen offset:0 sc1
Mvaa 212,244,56
Ta 220,23,32768
Ta 222,23,33792
Mvaa 244,244,60
Vc 32,48,49
Vc 33,50,51
Mvaa 152,248,48
Vc 34,52,53
Vc 35,54,55
Mvaa 184,248,52
buffer_load_dwordx4 a[12:15], v11, s[20:23], s52 offen offset:0 sc1
Mvaa 216,248,56
Mvaa 248,248,60
Mvaa 156,252,48
Mvaa 188,252,52
Mvaa 220,252,56
s_waitcnt vmcnt(26) lgkmcnt(0)
Mvaa 252,252,60
Mvaa 128,192,64
Mvaa 160,192,68
Ta 224,16,40960
Ta 226,16,41984
Mvaa 192,192,72
buffer_load_dwordx4 v9, s[8:11], s50 offen offset:2048 lds
Mvaa 224,192,76
Mvaa 132,196,64
Ta 228,17,40960
Ta 230,17,41984
Mvaa 164,196,68
Mvaa 196,196,72
buffer_load_dwordx4 v9, s[8:11], s51 offen offset:3072 lds
Mvaa 228,196,76
Ta 232,18,40960
Ta 234,18,41984
Mvaa 136,200,64
v_xor_b32 v8, 1572864, v8
v_xor_b32 v9, 1572864, v9
Mvaa 168,200,68
buffer_store_dwordx4 v[68:71], v2, s[24:27], s59 offen offset:3072 sc1
Mvaa 200,200,72
Ta 236,19,40960
Ta 238,19,41984
Mvaa 232,200,76
buffer_load_dwordx4 a[16:19], v10, s[20:23], s53 offen offset:1024 sc1
Mvaa 140,204,64
Ar 48,152
Ar 49,153
Mvaa 172,204,68
Ta 240,20,40960
Ta 242,20,41984
Mvaa 204,204,72
Ar 50,154
Ar 51,155
Mvaa 236,204,76
Ar 52,156
Ar 53,157
Mvaa 144,208,64
s_waitcnt lgkmcnt(6)
Ta 244,21,40960
Ta 246,21,41984
Mvaa 176,208,68
buffer_load_dwordx4 a[20:23], v10, s[20:23], s52 offen offset:1024 sc1
Mvaa 208,208,72
Ar 54,158
Ar 55,159
Mvaa 240,208,76
Ta 248,22,40960
Ta 250,22,41984
Mvaa 148,212,64
Vc 36,48,49
Vc 37,50,51
Mvaa 180,212,68
buffer_load_dwordx4 a[24:27], v11, s[20:23], s53 offen offset:1024 sc1
Mvaa 212,212,72
Ta 252,23,40960
Ta 254,23,41984
Mvaa 244,212,76
Vc 38,52,53
Vc 39,54,55
Mvaa 152,216,64
Mvaa 184,216,68
buffer_load_dwordx4 a[28:31], v11, s[20:23], s52 offen offset:1024 sc1
Mvaa 216,216,72
s_xor_b32 s52, s52, 2048
s_add_u32 s53, s52, s58
Mvaa 248,216,76
Mvaa 156,220,64
Mvaa 188,220,68
Mvaa 220,220,72
s_waitcnt vmcnt(29) lgkmcnt(0)
Mvaa 252,220,76
s_barrier
Mvaa 128,224,80
s_add_u32 s59, s38, 12288
Mvaa 160,224,84
s_add_u32 m0, s44, 32768
Ta 192,16,49152
Ta 194,16,50176
Mvaa 192,224,88
buffer_load_dwordx4 v8, s[8:11], s48 offen offset:0 lds
Mvaa 224,224,92
buffer_store_dwordx4 v[72:75], v2, s[24:27], s59 offen offset:0 sc1
Mvaa 132,228,80
Ta 196,17,49152
Ta 198,17,50176
Mvaa 164,228,84
Ar 48,160
Ar 49,161
Mvaa 196,228,88
buffer_load_dwordx4 v8, s[8:11], s49 offen offset:1024 lds
Mvaa 228,228,92
Ta 200,18,49152
Ta 202,18,50176
Mvaa 136,232,80
Ar 50,162
Ar 51,163
Mvaa 168,232,84
Ar 52,164
Ar 53,165
Mvaa 200,232,88
Ta 204,19,49152
Ta 206,19,50176
Mvaa 232,232,92
buffer_load_dwordx4 a[32:35], v10, s[20:23], s53 offen offset:0 sc1
Mvaa 140,236,80
Ar 54,166
Ar 55,167
Mvaa 172,236,84
Ta 208,20,49152
Ta 210,20,50176
Mvaa 204,236,88
Vc 40,48,49
Vc 41,50,51
Mvaa 236,236,92
Vc 42,52,53
Vc 43,54,55
Mvaa 144,240,80
s_waitcnt lgkmcnt(6)
Ta 212,21,49152
Ta 214,21,50176
Mvaa 176,240,84
buffer_load_dwordx4 a[36:39], v10, s[20:23], s52 offen offset:0 sc1
Mvaa 208,240,88
global_load_dword v13, v[14:15], off
Mvaa 240,240,92
Ta 216,22,49152
Ta 218,22,50176
Mvaa 148,244,80
Mvaa 180,244,84
buffer_load_dwordx4 a[40:43], v11, s[20:23], s53 offen offset:0 sc1
Mvaa 212,244,88
Ta 220,23,49152
Ta 222,23,50176
Mvaa 244,244,92
Mvaa 152,248,80
Mvaa 184,248,84
buffer_load_dwordx4 a[44:47], v11, s[20:23], s52 offen offset:0 sc1
Mvaa 216,248,88
Mvaa 248,248,92
buffer_store_dwordx4 v[76:79], v2, s[24:27], s59 offen offset:1024 sc1
Mvaa 156,252,80
Ar 48,168
Ar 49,169
Mvaa 188,252,84
Ar 50,170
Ar 51,171
Mvaa 220,252,88
s_waitcnt vmcnt(30) lgkmcnt(0)
Ar 52,172
Ar 53,173
Mvaa 252,252,92
Ar 54,174
Ar 55,175
Mvaa 128,192,96
Vc 44,48,49
Vc 45,50,51
Mvaa 160,192,100
Ta 224,16,57344
Ta 226,16,58368
Mvaa 192,192,104
buffer_load_dwordx4 v9, s[8:11], s50 offen offset:2048 lds
Mvaa 224,192,108
Vc 46,52,53
Vc 47,54,55
Mvaa 132,196,96
Ta 228,17,57344
Ta 230,17,58368
Mvaa 164,196,100
s_lshl_b32 s3, s32, 11
s_add_u32 s3, s3, 5242880
Mvaa 196,196,104
buffer_load_dwordx4 v9, s[8:11], s51 offen offset:3072 lds
Mvaa 228,196,108
Ta 232,18,57344
Ta 234,18,58368
Mvaa 136,200,96
v_xor_b32 v8, 524288, v8
v_xor_b32 v9, 524288, v9
Mvaa 168,200,100
buffer_load_dwordx4 v[56:59], v2, s[20:23], s3 offen offset:0 sc1
Mvaa 200,200,104
Ta 236,19,57344
Ta 238,19,58368
Mvaa 232,200,108
buffer_load_dwordx4 a[48:51], v10, s[20:23], s53 offen offset:1024 sc1
Mvaa 140,204,96
buffer_load_dwordx4 v[60:63], v2, s[20:23], s3 offen offset:1024 sc1
Mvaa 172,204,100
Ta 240,20,57344
Ta 242,20,58368
Mvaa 204,204,104
Mvaa 236,204,108
Mvaa 144,208,96
s_waitcnt lgkmcnt(6)
Ta 244,21,57344
Ta 246,21,58368
Mvaa 176,208,100
buffer_load_dwordx4 a[52:55], v10, s[20:23], s52 offen offset:1024 sc1
Mvaa 208,208,104
Mvaa 240,208,108
Ta 248,22,57344
Ta 250,22,58368
Mvaa 148,212,96
Mvaa 180,212,100
buffer_load_dwordx4 a[56:59], v11, s[20:23], s53 offen offset:1024 sc1
Mvaa 212,212,104
Ta 252,23,57344
Ta 254,23,58368
Mvaa 244,212,108
buffer_store_dwordx4 v[80:83], v2, s[24:27], s59 offen offset:2048 sc1
Mvaa 152,216,96
Mvaa 184,216,100
buffer_load_dwordx4 a[60:63], v11, s[20:23], s52 offen offset:1024 sc1
Mvaa 216,216,104
s_xor_b32 s52, s52, 6144
s_add_u32 s53, s52, s58
Mvaa 248,216,108
Mvaa 156,220,96
Mvaa 188,220,100
Mvaa 220,220,104
s_waitcnt vmcnt(32) lgkmcnt(0)
Mvaa 252,220,108
s_barrier
Mvaa 128,224,112
Mvaa 160,224,116
s_add_u32 m0, s44, 49152
Ta 192,16,0
Ta 194,16,1024
Mvaa 192,224,120
buffer_load_dwordx4 v8, s[8:11], s48 offen offset:0 lds
Mvaa 224,224,124
Mvaa 132,228,112
Ta 196,17,0
Ta 198,17,1024
Mvaa 164,228,116
Mvaa 196,228,120
buffer_load_dwordx4 v8, s[8:11], s49 offen offset:1024 lds
Mvaa 228,228,124
Ta 200,18,0
Ta 202,18,1024
Mvaa 136,232,112
Mvaa 168,232,116
Mvaa 200,232,120
Ta 204,19,0
Ta 206,19,1024
Mvaa 232,232,124
buffer_load_dwordx4 a[64:67], v10, s[20:23], s53 offen offset:0 sc1
Mvaa 140,236,112
Mvaa 172,236,116
Ta 208,20,0
Ta 210,20,1024
Mvaa 204,236,120
Mvaa 236,236,124
Mvaa 144,240,112
s_waitcnt lgkmcnt(6)
Ta 212,21,0
Ta 214,21,1024
Mvaa 176,240,116
buffer_load_dwordx4 a[68:71], v10, s[20:23], s52 offen offset:0 sc1
Mvaa 208,240,120
buffer_store_dwordx4 v[84:87], v2, s[24:27], s59 offen offset:3072 sc1
Mvaa 240,240,124
Ta 216,22,0
Ta 218,22,1024
Mvaa 148,244,112
Mvaa 180,244,116
buffer_load_dwordx4 a[72:75], v11, s[20:23], s53 offen offset:0 sc1
Mvaa 212,244,120
Ta 220,23,0
Ta 222,23,1024
Mvaa 244,244,124
Mvaa 152,248,112
Mvaa 184,248,116
buffer_load_dwordx4 a[76:79], v11, s[20:23], s52 offen offset:0 sc1
Mvaa 216,248,120
Mvaa 248,248,124
Mvaa 156,252,112
Mvaa 188,252,116
Mvaa 220,252,120
s_waitcnt vmcnt(32) lgkmcnt(0)
Mvaa 252,252,124
Mvaa 128,192,0
Mvaa 160,192,4
Ta 224,16,8192
Ta 226,16,9216
Mvaa 192,192,8
buffer_load_dwordx4 v9, s[8:11], s50 offen offset:2048 lds
Mvaa 224,192,12
Mvaa 132,196,0
Ta 228,17,8192
Ta 230,17,9216
Mvaa 164,196,4
Mvaa 196,196,8
buffer_load_dwordx4 v9, s[8:11], s51 offen offset:3072 lds
Mvaa 228,196,12
Ta 232,18,8192
Ta 234,18,9216
Mvaa 136,200,0
v_xor_b32 v8, 7864320, v8
v_xor_b32 v9, 7864320, v9
Mvaa 168,200,4
Mvaa 200,200,8
Ta 236,19,8192
Ta 238,19,9216
Mvaa 232,200,12
buffer_load_dwordx4 a[80:83], v10, s[20:23], s53 offen offset:1024 sc1
Mvaa 140,204,0
s_add_u32 s59, s38, 34816
Mvaa 172,204,4
Ta 240,20,8192
Ta 242,20,9216
Mvaa 204,204,8
buffer_store_dwordx4 v[88:91], v2, s[24:27], s59 offen offset:0 sc1
Mvaa 236,204,12
Mvaa 144,208,0
s_waitcnt lgkmcnt(6)
Ta 244,21,8192
Ta 246,21,9216
Mvaa 176,208,4
buffer_load_dwordx4 a[84:87], v10, s[20:23], s52 offen offset:1024 sc1
Mvaa 208,208,8
Mvaa 240,208,12
Ta 248,22,8192
Ta 250,22,9216
Mvaa 148,212,0
Mvaa 180,212,4
buffer_load_dwordx4 a[88:91], v11, s[20:23], s53 offen offset:1024 sc1
Mvaa 212,212,8
Ta 252,23,8192
Ta 254,23,9216
Mvaa 244,212,12
Mvaa 152,216,0
Mvaa 184,216,4
buffer_load_dwordx4 a[92:95], v11, s[20:23], s52 offen offset:1024 sc1
Mvaa 216,216,8
s_xor_b32 s52, s52, 2048
s_add_u32 s53, s52, s58
Mvaa 248,216,12
Mvaa 156,220,0
Mvaa 188,220,4
Mvaa 220,220,8
s_waitcnt vmcnt(32) lgkmcnt(0)
Mvaa 252,220,12
s_barrier
Mvaa 128,224,16
Mvaa 160,224,20
s_add_u32 m0, s44, 0
Ta 192,16,16384
Ta 194,16,17408
Mvaa 192,224,24
buffer_load_dwordx4 v8, s[8:11], s48 offen offset:0 lds
Mvaa 224,224,28
Mvaa 132,228,16
Ta 196,17,16384
Ta 198,17,17408
Mvaa 164,228,20
Mvaa 196,228,24
buffer_load_dwordx4 v8, s[8:11], s49 offen offset:1024 lds
Mvaa 228,228,28
Ta 200,18,16384
Ta 202,18,17408
Mvaa 136,232,16
buffer_store_dwordx4 v[92:95], v2, s[24:27], s59 offen offset:1024 sc1
Mvaa 168,232,20
Mvaa 200,232,24
Ta 204,19,16384
Ta 206,19,17408
Mvaa 232,232,28
buffer_load_dwordx4 a[96:99], v10, s[20:23], s53 offen offset:0 sc1
Mvaa 140,236,16
Mvaa 172,236,20
Ta 208,20,16384
Ta 210,20,17408
Mvaa 204,236,24
Mvaa 236,236,28
Mvaa 144,240,16
s_waitcnt lgkmcnt(6)
Ta 212,21,16384
Ta 214,21,17408
Mvaa 176,240,20
buffer_load_dwordx4 a[100:103], v10, s[20:23], s52 offen offset:0 sc1
Mvaa 208,240,24
Mvaa 240,240,28
Ta 216,22,16384
Ta 218,22,17408
Mvaa 148,244,16
Mvaa 180,244,20
buffer_load_dwordx4 a[104:107], v11, s[20:23], s53 offen offset:0 sc1
Mvaa 212,244,24
Ta 220,23,16384
Ta 222,23,17408
Mvaa 244,244,28
Mvaa 152,248,16
Mvaa 184,248,20
buffer_load_dwordx4 a[108:111], v11, s[20:23], s52 offen offset:0 sc1
Mvaa 216,248,24
Mvaa 248,248,28
Mvaa 156,252,16
Mvaa 188,252,20
Mvaa 220,252,24
s_waitcnt vmcnt(31) lgkmcnt(0)
Mvaa 252,252,28
Mvaa 128,192,32
buffer_store_dwordx4 v[96:99], v2, s[24:27], s59 offen offset:2048 sc1
Mvaa 160,192,36
Ta 224,16,24576
Ta 226,16,25600
Mvaa 192,192,40
buffer_load_dwordx4 v9, s[8:11], s50 offen offset:2048 lds
Mvaa 224,192,44
Mvaa 132,196,32
Ta 228,17,24576
Ta 230,17,25600
Mvaa 164,196,36
Mvaa 196,196,40
buffer_load_dwordx4 v9, s[8:11], s51 offen offset:3072 lds
Mvaa 228,196,44
Ta 232,18,24576
Ta 234,18,25600
Mvaa 136,200,32
v_xor_b32 v8, 524288, v8
v_xor_b32 v9, 524288, v9
Mvaa 168,200,36
Mvaa 200,200,40
Ta 236,19,24576
Ta 238,19,25600
Mvaa 232,200,44
buffer_load_dwordx4 a[112:115], v10, s[20:23], s53 offen offset:1024 sc1
Mvaa 140,204,32
Mvaa 172,204,36
Ta 240,20,24576
Ta 242,20,25600
Mvaa 204,204,40
Mvaa 236,204,44
Mvaa 144,208,32
s_waitcnt lgkmcnt(6)
Ta 244,21,24576
Ta 246,21,25600
Mvaa 176,208,36
buffer_load_dwordx4 a[116:119], v10, s[20:23], s52 offen offset:1024 sc1
Mvaa 208,208,40
Mvaa 240,208,44
Ta 248,22,24576
Ta 250,22,25600
Mvaa 148,212,32
Mvaa 180,212,36
buffer_load_dwordx4 a[120:123], v11, s[20:23], s53 offen offset:1024 sc1
Mvaa 212,212,40
Ta 252,23,24576
Ta 254,23,25600
Mvaa 244,212,44
Mvaa 152,216,32
Mvaa 184,216,36
buffer_load_dwordx4 a[124:127], v11, s[20:23], s52 offen offset:1024 sc1
Mvaa 216,216,40
s_xor_b32 s52, s52, 30720
s_add_u32 s53, s52, s58
Mvaa 248,216,44
buffer_store_dwordx4 v[100:103], v2, s[24:27], s59 offen offset:3072 sc1
Mvaa 156,220,32
Mvaa 188,220,36
Mvaa 220,220,40
s_waitcnt vmcnt(29) lgkmcnt(0)
Mvaa 252,220,44
s_barrier
Mvaa 128,224,48
Mvaa 160,224,52
s_add_u32 m0, s44, 16384
Ta 192,16,32768
Ta 194,16,33792
Mvaa 192,224,56
buffer_load_dwordx4 v8, s[8:11], s48 offen offset:0 lds
Mvaa 224,224,60
Mvaa 132,228,48
Ta 196,17,32768
Ta 198,17,33792
Mvaa 164,228,52
Mvaa 196,228,56
buffer_load_dwordx4 v8, s[8:11], s49 offen offset:1024 lds
Mvaa 228,228,60
Ta 200,18,32768
Ta 202,18,33792
Mvaa 136,232,48
Mvaa 168,232,52
Mvaa 200,232,56
Ta 204,19,32768
Ta 206,19,33792
Mvaa 232,232,60
buffer_load_dwordx4 a[0:3], v10, s[20:23], s53 offen offset:0 sc1
Mvaa 140,236,48
Mvaa 172,236,52
Ta 208,20,32768
Ta 210,20,33792
Mvaa 204,236,56
Mvaa 236,236,60
Mvaa 144,240,48
s_waitcnt lgkmcnt(6)
Ta 212,21,32768
Ta 214,21,33792
Mvaa 176,240,52
buffer_load_dwordx4 a[4:7], v10, s[20:23], s52 offen offset:0 sc1
Mvaa 208,240,56
Mvaa 240,240,60
Ta 216,22,32768
Ta 218,22,33792
Mvaa 148,244,48
Mvaa 180,244,52
buffer_load_dwordx4 a[8:11], v11, s[20:23], s53 offen offset:0 sc1
Mvaa 212,244,56
Ta 220,23,32768
Ta 222,23,33792
Mvaa 244,244,60
s_add_u32 s59, s38, 38912
Mvaa 152,248,48
buffer_store_dwordx4 v[104:107], v2, s[24:27], s59 offen offset:0 sc1
Mvaa 184,248,52
buffer_load_dwordx4 a[12:15], v11, s[20:23], s52 offen offset:0 sc1
Mvaa 216,248,56
Mvaa 248,248,60
Mvaa 156,252,48
Mvaa 188,252,52
Mvaa 220,252,56
s_waitcnt vmcnt(29) lgkmcnt(0)
Mvaa 252,252,60
Mvaa 128,192,64
v_max_u32 v14, v56, v57
v_min_u32_e64 v15, v56, v57
Mvaa 160,192,68
Ta 224,16,40960
Ta 226,16,41984
Mvaa 192,192,72
buffer_load_dwordx4 v9, s[8:11], s50 offen offset:2048 lds
Mvaa 224,192,76
v_med3_u32 v15, v14, v15, v58
v_max_u32_e64 v14, v14, v58
Mvaa 132,196,64
Ta 228,17,40960
Ta 230,17,41984
Mvaa 164,196,68
v_med3_u32 v15, v14, v15, v59
v_max_u32_e64 v14, v14, v59
Mvaa 196,196,72
buffer_load_dwordx4 v9, s[8:11], s51 offen offset:3072 lds
Mvaa 228,196,76
Ta 232,18,40960
Ta 234,18,41984
Mvaa 136,200,64
v_xor_b32 v8, 1572864, v8
v_xor_b32 v9, 1572864, v9
Mvaa 168,200,68
v_med3_u32 v15, v14, v15, v60
v_max_u32_e64 v14, v14, v60
Mvaa 200,200,72
Ta 236,19,40960
Ta 238,19,41984
Mvaa 232,200,76
buffer_load_dwordx4 a[16:19], v10, s[20:23], s53 offen offset:1024 sc1
Mvaa 140,204,64
v_med3_u32 v15, v14, v15, v61
v_max_u32_e64 v14, v14, v61
Mvaa 172,204,68
Ta 240,20,40960
Ta 242,20,41984
Mvaa 204,204,72
v_med3_u32 v15, v14, v15, v62
v_max_u32_e64 v14, v14, v62
Mvaa 236,204,76
v_med3_u32 v15, v14, v15, v63
v_max_u32_e64 v14, v14, v63
Mvaa 144,208,64
s_waitcnt lgkmcnt(6)
Ta 244,21,40960
Ta 246,21,41984
Mvaa 176,208,68
buffer_load_dwordx4 a[20:23], v10, s[20:23], s52 offen offset:1024 sc1
Mvaa 208,208,72
buffer_store_dwordx4 v[108:111], v2, s[24:27], s59 offen offset:1024 sc1
Mvaa 240,208,76
Ta 248,22,40960
Ta 250,22,41984
Mvaa 148,212,64
s_lshl_b32 s3, s32, 9
s_add_u32 s3, s3, 131072
v_lshlrev_b32_e64 v13, 3, v0
Mvaa 180,212,68
buffer_load_dwordx4 a[24:27], v11, s[20:23], s53 offen offset:1024 sc1
Mvaa 212,212,72
Ta 252,23,40960
Ta 254,23,41984
Mvaa 244,212,76
v_add_u32_e64 v56, s3, v13
v_add_u32 v13, 131072, v13
Mvaa 152,216,64
ds_write_b64 v56, v[14:15]
Mvaa 184,216,68
buffer_load_dwordx4 a[28:31], v11, s[20:23], s52 offen offset:1024 sc1
Mvaa 216,216,72
s_xor_b32 s52, s52, 2048
s_add_u32 s53, s52, s58
Mvaa 248,216,76
Mvaa 156,220,64
Mvaa 188,220,68
Mvaa 220,220,72
s_waitcnt vmcnt(29) lgkmcnt(0)
Mvaa 252,220,76
s_barrier
Mvaa 128,224,80
Mvaa 160,224,84
s_add_u32 m0, s44, 32768
Ta 192,16,49152
Ta 194,16,50176
Mvaa 192,224,88
buffer_load_dwordx4 v8, s[8:11], s48 offen offset:0 lds
Mvaa 224,224,92
Mvaa 132,228,80
Ta 196,17,49152
Ta 198,17,50176
Mvaa 164,228,84
Mvaa 196,228,88
buffer_load_dwordx4 v8, s[8:11], s49 offen offset:1024 lds
Mvaa 228,228,92
Ta 200,18,49152
Ta 202,18,50176
Mvaa 136,232,80
Mvaa 168,232,84
Mvaa 200,232,88
Ta 204,19,49152
Ta 206,19,50176
Mvaa 232,232,92
buffer_load_dwordx4 a[32:35], v10, s[20:23], s53 offen offset:0 sc1
Mvaa 140,236,80
buffer_store_dwordx4 v[112:115], v2, s[24:27], s59 offen offset:2048 sc1
Mvaa 172,236,84
Ta 208,20,49152
Ta 210,20,50176
Mvaa 204,236,88
Mvaa 236,236,92
Mvaa 144,240,80
s_waitcnt lgkmcnt(6)
Ta 212,21,49152
Ta 214,21,50176
Mvaa 176,240,84
buffer_load_dwordx4 a[36:39], v10, s[20:23], s52 offen offset:0 sc1
Mvaa 208,240,88
Mvaa 240,240,92
Ta 216,22,49152
Ta 218,22,50176
Mvaa 148,244,80
Mvaa 180,244,84
buffer_load_dwordx4 a[40:43], v11, s[20:23], s53 offen offset:0 sc1
Mvaa 212,244,88
Ta 220,23,49152
Ta 222,23,50176
Mvaa 244,244,92
Mvaa 152,248,80
Mvaa 184,248,84
buffer_load_dwordx4 a[44:47], v11, s[20:23], s52 offen offset:0 sc1
Mvaa 216,248,88
Mvaa 248,248,92
Mvaa 156,252,80
Mvaa 188,252,84
Mvaa 220,252,88
s_waitcnt vmcnt(29) lgkmcnt(0)
Mvaa 252,252,92
Mvaa 128,192,96
Mvaa 160,192,100
Ta 224,16,57344
Ta 226,16,58368
Mvaa 192,192,104
buffer_load_dwordx4 v9, s[8:11], s50 offen offset:2048 lds
Mvaa 224,192,108
Mvaa 132,196,96
Ta 228,17,57344
Ta 230,17,58368
Mvaa 164,196,100
Mvaa 196,196,104
buffer_load_dwordx4 v9, s[8:11], s51 offen offset:3072 lds
Mvaa 228,196,108
Ta 232,18,57344
Ta 234,18,58368
Mvaa 136,200,96
v_xor_b32 v8, 524288, v8
v_xor_b32 v9, 524288, v9
Mvaa 168,200,100
buffer_store_dwordx4 v[116:119], v2, s[24:27], s59 offen offset:3072 sc1
Mvaa 200,200,104
Ta 236,19,57344
Ta 238,19,58368
Mvaa 232,200,108
buffer_load_dwordx4 a[48:51], v10, s[20:23], s53 offen offset:1024 sc1
Mvaa 140,204,96
Mvaa 172,204,100
Ta 240,20,57344
Ta 242,20,58368
Mvaa 204,204,104
Mvaa 236,204,108
Mvaa 144,208,96
s_waitcnt lgkmcnt(6)
Ta 244,21,57344
Ta 246,21,58368
Mvaa 176,208,100
buffer_load_dwordx4 a[52:55], v10, s[20:23], s52 offen offset:1024 sc1
Mvaa 208,208,104
Mvaa 240,208,108
Ta 248,22,57344
Ta 250,22,58368
Mvaa 148,212,96
Mvaa 180,212,100
buffer_load_dwordx4 a[56:59], v11, s[20:23], s53 offen offset:1024 sc1
Mvaa 212,212,104
Ta 252,23,57344
Ta 254,23,58368
Mvaa 244,212,108
Mvaa 152,216,96
Mvaa 184,216,100
buffer_load_dwordx4 a[60:63], v11, s[20:23], s52 offen offset:1024 sc1
Mvaa 216,216,104
s_xor_b32 s52, s52, 6144
s_add_u32 s53, s52, s58
Mvaa 248,216,108
Mvaa 156,220,96
Mvaa 188,220,100
Mvaa 220,220,104
s_waitcnt vmcnt(29) lgkmcnt(0)
Mvaa 252,220,108
s_barrier
Mvaa 128,224,112
s_add_u32 s59, s38, 43008
Mvaa 160,224,116
s_add_u32 m0, s44, 49152
Ta 192,16,0
Ta 194,16,1024
Mvaa 192,224,120
buffer_load_dwordx4 v8, s[8:11], s48 offen offset:0 lds
Mvaa 224,224,124
buffer_store_dwordx4 v[120:123], v2, s[24:27], s59 offen offset:0 sc1
Mvaa 132,228,112
Ta 196,17,0
Ta 198,17,1024
Mvaa 164,228,116
ds_read_b64 v[56:57], v13 offset:0
ds_read_b64 v[58:59], v13 offset:512
Mvaa 196,228,120
buffer_load_dwordx4 v8, s[8:11], s49 offen offset:1024 lds
Mvaa 228,228,124
Ta 200,18,0
Ta 202,18,1024
Mvaa 136,232,112
ds_read_b64 v[60:61], v13 offset:1024
ds_read_b64 v[62:63], v13 offset:1536
Mvaa 168,232,116
Mvaa 200,232,120
Ta 204,19,0
Ta 206,19,1024
Mvaa 232,232,124
buffer_load_dwordx4 a[64:67], v10, s[20:23], s53 offen offset:0 sc1
Mvaa 140,236,112
s_waitcnt lgkmcnt(2)
v_max_u32 v14, v56, v57
v_min_u32 v15, v56, v57
Mvaa 172,236,116
Ta 208,20,0
Ta 210,20,1024
Mvaa 204,236,120
v_med3_u32 v15, v14, v15, v58
v_max_u32_e64 v14, v14, v58
Mvaa 236,236,124
v_med3_u32 v15, v14, v15, v59
v_max_u32_e64 v14, v14, v59
Mvaa 144,240,112
s_waitcnt lgkmcnt(6)
Ta 212,21,0
Ta 214,21,1024
Mvaa 176,240,116
buffer_load_dwordx4 a[68:71], v10, s[20:23], s52 offen offset:0 sc1
Mvaa 208,240,120
v_med3_u32 v15, v14, v15, v60
v_max_u32 v14, v14, v60
Mvaa 240,240,124
Ta 216,22,0
Ta 218,22,1024
Mvaa 148,244,112
v_med3_u32 v15, v14, v15, v61
v_max_u32_e64 v14, v14, v61
Mvaa 180,244,116
buffer_load_dwordx4 a[72:75], v11, s[20:23], s53 offen offset:0 sc1
Mvaa 212,244,120
Ta 220,23,0
Ta 222,23,1024
Mvaa 244,244,124
v_med3_u32 v15, v14, v15, v62
v_max_u32_e64 v14, v14, v62
Mvaa 152,248,112
v_med3_u32 v15, v14, v15, v63
v_max_u32_e64 v14, v14, v63
Mvaa 184,248,116
buffer_load_dwordx4 a[76:79], v11, s[20:23], s52 offen offset:0 sc1
Mvaa 216,248,120
v_mov_b32_e64 v13, v14
Mvaa 248,248,124
buffer_store_dwordx4 v[124:127], v2, s[24:27], s59 offen offset:1024 sc1
Mvaa 156,252,112
v_max_u32_dpp v13, v13, v13 quad_perm:[1,0,3,2] row_mask:0xf bank_mask:0xf
Mvaa 188,252,116
Mvaa 220,252,120
s_waitcnt vmcnt(29) lgkmcnt(0)
Mvaa 252,252,124
Mvaa 128,192,0
v_max_u32_dpp v13, v13, v13 quad_perm:[2,3,0,1] row_mask:0xf bank_mask:0xf
Mvaa 160,192,4
Ta 224,16,8192
Ta 226,16,9216
Mvaa 192,192,8
buffer_load_dwordx4 v9, s[8:11], s50 offen offset:2048 lds
Mvaa 224,192,12
v_max_u32_dpp v13, v13, v13 row_half_mirror row_mask:0xf bank_mask:0xf
Mvaa 132,196,0
Ta 228,17,8192
Ta 230,17,9216
Mvaa 164,196,4
v_max_u32_dpp v13, v13, v13 row_mirror row_mask:0xf bank_mask:0xf
Mvaa 196,196,8
buffer_load_dwordx4 v9, s[8:11], s51 offen offset:3072 lds
Mvaa 228,196,12
Ta 232,18,8192
Ta 234,18,9216
Mvaa 136,200,0
v_xor_b32 v8, 3670016, v8
v_xor_b32 v9, 3670016, v9
Mvaa 168,200,4
v_readlane_b32 s3, v13, 0
v_readlane_b32 s47, v13, 16
Mvaa 200,200,8
Ta 236,19,8192
Ta 238,19,9216
Mvaa 232,200,12
buffer_load_dwordx4 a[80:83], v10, s[20:23], s53 offen offset:1024 sc1
Mvaa 140,204,0
v_readlane_b32 s4, v13, 32
v_readlane_b32 s5, v13, 48
Mvaa 172,204,4
Ta 240,20,8192
Ta 242,20,9216
Mvaa 204,204,8
s_max_u32 s3, s3, s47
s_max_u32 s4, s4, s5
s_max_u32 s40, s3, s4
Mvaa 236,204,12
v_cmp_eq_u32 vcc, s40, v14
Mvaa 144,208,0
s_waitcnt lgkmcnt(6)
Ta 244,21,8192
Ta 246,21,9216
Mvaa 176,208,4
buffer_load_dwordx4 a[84:87], v10, s[20:23], s52 offen offset:1024 sc1
Mvaa 208,208,8
v_cndmask_b32 v13, v14, v15, vcc
Mvaa 240,208,12
Ta 248,22,8192
Ta 250,22,9216
Mvaa 148,212,0
v_max_u32_dpp v13, v13, v13 quad_perm:[1,0,3,2] row_mask:0xf bank_mask:0xf
Mvaa 180,212,4
buffer_load_dwordx4 a[88:91], v11, s[20:23], s53 offen offset:1024 sc1
Mvaa 212,212,8
Ta 252,23,8192
Ta 254,23,9216
Mvaa 244,212,12
buffer_store_dwordx4 v[24:27], v2, s[24:27], s59 offen offset:2048 sc1
Mvaa 152,216,0
v_max_u32_dpp v13, v13, v13 quad_perm:[2,3,0,1] row_mask:0xf bank_mask:0xf
Mvaa 184,216,4
buffer_load_dwordx4 a[92:95], v11, s[20:23], s52 offen offset:1024 sc1
Mvaa 216,216,8
s_xor_b32 s52, s52, 2048
s_add_u32 s53, s52, s58
Mvaa 248,216,12
v_max_u32_dpp v13, v13, v13 row_half_mirror row_mask:0xf bank_mask:0xf
Mvaa 156,220,0
s_nop 0
v_max_u32_dpp v13, v13, v13 row_mirror row_mask:0xf bank_mask:0xf
Mvaa 188,220,4
Mvaa 220,220,8
s_waitcnt vmcnt(29) lgkmcnt(0)
Mvaa 252,220,12
s_barrier
Mvaa 128,224,16
v_readlane_b32 s3, v13, 0
v_readlane_b32 s47, v13, 16
Mvaa 160,224,20
s_add_u32 m0, s44, 0
Ta 192,16,16384
Ta 194,16,17408
Mvaa 192,224,24
buffer_load_dwordx4 v8, s[8:11], s48 offen offset:0 lds
Mvaa 224,224,28
v_readlane_b32 s4, v13, 32
v_readlane_b32 s5, v13, 48
Mvaa 132,228,16
Ta 196,17,16384
Ta 198,17,17408
Mvaa 164,228,20
s_max_u32 s3, s3, s47
s_max_u32 s4, s4, s5
s_max_u32 s41, s3, s4
Mvaa 196,228,24
buffer_load_dwordx4 v8, s[8:11], s49 offen offset:1024 lds
Mvaa 228,228,28
Ta 200,18,16384
Ta 202,18,17408
Mvaa 136,232,16
s_and_b32 s3, s40, 0xffff
s_sub_u32 s42, 0xffff, s3
s_and_b32 s3, s41, 0xffff
Mvaa 168,232,20
s_sub_u32 s43, 0xffff, s3
v_mov_b32 v60, s40
v_not_b32_e64 v61, v60
Mvaa 200,232,24
Ta 204,19,16384
Ta 206,19,17408
Mvaa 232,232,28
buffer_load_dwordx4 a[96:99], v10, s[20:23], s53 offen offset:0 sc1
Mvaa 140,236,16
v_ashrrev_i32_e64 v61, 31, v61
v_or_b32 v61, 0x80000000, v61
Mvaa 172,236,20
Ta 208,20,16384
Ta 210,20,17408
Mvaa 204,236,24
v_xor_b32_e64 v60, v60, v61
v_and_b32 v60, 0xffff0000, v60
Mvaa 236,236,28
v_mul_f32 v60, 0xbfb8aa3b, v60
Mvaa 144,240,16
s_waitcnt lgkmcnt(6)
Ta 212,21,16384
Ta 214,21,17408
Mvaa 176,240,20
buffer_load_dwordx4 a[100:103], v10, s[20:23], s52 offen offset:0 sc1
Mvaa 208,240,24
buffer_store_dwordx4 v[28:31], v2, s[24:27], s59 offen offset:3072 sc1
Mvaa 240,240,28
Ta 216,22,16384
Ta 218,22,17408
Mvaa 148,244,16
Ve 60,60
Mvaa 180,244,20
buffer_load_dwordx4 a[104:107], v11, s[20:23], s53 offen offset:0 sc1
Mvaa 212,244,24
Ta 220,23,16384
Ta 222,23,17408
Mvaa 244,244,28
v_add_f32_e64 v60, 1.0, v60
Mvaa 152,248,16
v_rcp_f32_e64 v60, v60
Mvaa 184,248,20
buffer_load_dwordx4 a[108:111], v11, s[20:23], s52 offen offset:0 sc1
Mvaa 216,248,24
Vc 60,60,60
v_and_b32 v64, 0xffff0000, v60
Mvaa 248,248,28
v_mov_b32 v60, s41
v_not_b32 v61, v60
Mvaa 156,252,16
v_ashrrev_i32_e64 v61, 31, v61
v_or_b32 v61, 0x80000000, v61
Mvaa 188,252,20
v_xor_b32_e64 v60, v60, v61
v_and_b32 v60, 0xffff0000, v60
Mvaa 220,252,24
s_waitcnt vmcnt(29) lgkmcnt(0)
v_mul_f32 v60, 0xbfb8aa3b, v60
Mvaa 252,252,28
Ve 60,60
Mvaa 128,192,32
v_add_f32_e64 v60, 1.0, v60
Mvaa 160,192,36
Ta 224,16,24576
Ta 226,16,25600
Mvaa 192,192,40
buffer_load_dwordx4 v9, s[8:11], s50 offen offset:2048 lds
Mvaa 224,192,44
v_rcp_f32_e64 v60, v60
Mvaa 132,196,32
Ta 228,17,24576
Ta 230,17,25600
Mvaa 164,196,36
Vc 60,60,60
v_and_b32 v65, 0xffff0000, v60
Mvaa 196,196,40
buffer_load_dwordx4 v9, s[8:11], s51 offen offset:3072 lds
Mvaa 228,196,44
Ta 232,18,24576
Ta 234,18,25600
Mvaa 136,200,32
v_xor_b32 v8, 524288, v8
v_xor_b32 v9, 524288, v9
Mvaa 168,200,36
v_mov_b32 v48, 0
v_mov_b32 v49, 0
Mvaa 200,200,40
Ta 236,19,24576
Ta 238,19,25600
Mvaa 232,200,44
buffer_load_dwordx4 a[112:115], v10, s[20:23], s53 offen offset:1024 sc1
Mvaa 140,204,32
s_add_u32 s59, s38, 47104
Mvaa 172,204,36
Ta 240,20,24576
Ta 242,20,25600
Mvaa 204,204,40
buffer_store_dwordx4 v[32:35], v2, s[24:27], s59 offen offset:0 sc1
Mvaa 236,204,44
v_mov_b32 v50, 0
v_mov_b32 v51, 0
Mvaa 144,208,32
s_waitcnt lgkmcnt(6)
Ta 244,21,24576
Ta 246,21,25600
Mvaa 176,208,36
buffer_load_dwordx4 a[116:119], v10, s[20:23], s52 offen offset:1024 sc1
Mvaa 208,208,40
v_mov_b32 v52, 0
v_mov_b32_e64 v53, 0
Mvaa 240,208,44
Ta 248,22,24576
Ta 250,22,25600
Mvaa 148,212,32
v_mov_b32 v54, 0
v_mov_b32 v55, 0
Mvaa 180,212,36
buffer_load_dwordx4 a[120:123], v11, s[20:23], s53 offen offset:1024 sc1
Mvaa 212,212,40
Ta 252,23,24576
Ta 254,23,25600
Mvaa 244,212,44
v_mov_b32 v56, 0
v_mov_b32 v57, 0
Mvaa 152,216,32
v_mov_b32 v58, 0
v_mov_b32 v59, 0
Mvaa 184,216,36
buffer_load_dwordx4 a[124:127], v11, s[20:23], s52 offen offset:1024 sc1
Mvaa 216,216,40
s_xor_b32 s52, s52, 14336
s_add_u32 s53, s52, s58
Mvaa 248,216,44
v_mov_b32 v60, 0
v_mov_b32_e64 v61, 0
Mvaa 156,220,32
v_mov_b32 v62, 0
v_mov_b32 v63, 0
Mvaa 188,220,36
Mvaa 220,220,40
s_waitcnt vmcnt(29) lgkmcnt(0)
Mvaa 252,220,44
s_barrier
Mvaa 128,224,48
s_mul_i32 s3, s34, s34
s_mul_i32 s47, s33, 48
s_add_u32 s3, s3, s47
Mvaa 160,224,52
s_add_u32 m0, s44, 16384
Ta 192,16,32768
Ta 194,16,33792
Mvaa 192,224,56
buffer_load_dwordx4 v8, s[8:11], s48 offen offset:0 lds
Mvaa 224,224,60
s_lshl_b32 s3, s3, 2
s_add_u32 s3, s3, s32
s_lshl_b32 s3, s3, 7
Mvaa 132,228,48
Ta 196,17,32768
Ta 198,17,33792
Mvaa 164,228,52
s_sub_u32 s3, s3, 8704
s_cmp_ge_u32 s34, 4
s_cselect_b32 s3, s3, 0
s_cselect_b32 s40, 512, 0
s_cselect_b32 s47, 786432, 0
Mvaa 196,228,56
buffer_load_dwordx4 v8, s[8:11], s49 offen offset:1024 lds
Mvaa 228,228,60
Ta 200,18,32768
Ta 202,18,33792
Mvaa 136,232,48
buffer_store_dwordx4 v[36:39], v2, s[24:27], s59 offen offset:1024 sc1
Mvaa 168,232,52
v_subrev_u32_e64 v31, 0, v0
v_mul_lo_u32 v31, v31, s47
Mvaa 200,232,56
Ta 204,19,32768
Ta 206,19,33792
Mvaa 232,232,60
buffer_load_dwordx4 a[0:3], v10, s[20:23], s53 offen offset:0 sc1
Mvaa 140,236,48
v_min_u32 v31, 6553600, v31
v_mov_b32_e64 v28, s94
Mvaa 172,236,52
Ta 208,20,32768
Ta 210,20,33792
Mvaa 204,236,56
v_mov_b32 v29, s95
v_mov_b32 v30, v31
Mvaa 236,236,60
v_subrev_u32_e64 v31, 10, v0
v_mul_lo_u32 v31, v31, s47
Mvaa 144,240,48
s_waitcnt lgkmcnt(6)
Ta 212,21,32768
Ta 214,21,33792
Mvaa 176,240,52
buffer_load_dwordx4 a[4:7], v10, s[20:23], s52 offen offset:0 sc1
Mvaa 208,240,56
v_min_u32 v31, 6553600, v31
v_mov_b32 v14, s60
Mvaa 240,240,60
Ta 216,22,32768
Ta 218,22,33792
Mvaa 148,244,48
v_mov_b32_e64 v15, s61
Mvaa 180,244,52
buffer_load_dwordx4 a[8:11], v11, s[20:23], s53 offen offset:0 sc1
Mvaa 212,244,56
Ta 220,23,32768
Ta 222,23,33792
Mvaa 244,244,60
v_cmp_le_u32 vcc, 10, v0
Mvaa 152,248,48
s_nop 0
v_cndmask_b32 v28, v28, v14, vcc
v_cndmask_b32 v29, v29, v15, vcc
Mvaa 184,248,52
buffer_load_dwordx4 a[12:15], v11, s[20:23], s52 offen offset:0 sc1
Mvaa 216,248,56
v_cndmask_b32 v30, v30, v31, vcc
Mvaa 248,248,60
v_subrev_u32 v31, 20, v0
v_mul_lo_u32 v31, v31, s47
Mvaa 156,252,48
v_min_u32 v31, 6553600, v31
v_mov_b32_e64 v14, s68
Mvaa 188,252,52
v_mov_b32_e64 v15, s69
Mvaa 220,252,56
s_waitcnt vmcnt(29) lgkmcnt(0)
Mvaa 252,252,60
Mvaa 128,192,64
buffer_store_dwordx4 v[40:43], v2, s[24:27], s59 offen offset:2048 sc1
Mvaa 160,192,68
Ta 224,16,40960
Ta 226,16,41984
Mvaa 192,192,72
buffer_load_dwordx4 v9, s[8:11], s50 offen offset:2048 lds
Mvaa 224,192,76
v_cmp_le_u32 vcc, 20, v0
Mvaa 132,196,64
Ta 228,17,40960
Ta 230,17,41984
Mvaa 164,196,68
v_cndmask_b32 v28, v28, v14, vcc
v_cndmask_b32 v29, v29, v15, vcc
Mvaa 196,196,72
buffer_load_dwordx4 v9, s[8:11], s51 offen offset:3072 lds
Mvaa 228,196,76
Ta 232,18,40960
Ta 234,18,41984
Mvaa 136,200,64
v_xor_b32 v8, 1572864, v8
v_xor_b32 v9, 1572864, v9
Mvaa 168,200,68
v_cndmask_b32 v30, v30, v31, vcc
Mvaa 200,200,72
Ta 236,19,40960
Ta 238,19,41984
Mvaa 232,200,76
buffer_load_dwordx4 a[16:19], v10, s[20:23], s53 offen offset:1024 sc1
Mvaa 140,204,64
v_subrev_u32 v31, 30, v0
v_mul_lo_u32 v31, v31, s47
Mvaa 172,204,68
Ta 240,20,40960
Ta 242,20,41984
Mvaa 204,204,72
v_min_u32 v31, 7602176, v31
v_mov_b32_e64 v14, s92
Mvaa 236,204,76
v_mov_b32_e64 v15, s93
Mvaa 144,208,64
s_waitcnt lgkmcnt(6)
Ta 244,21,40960
Ta 246,21,41984
Mvaa 176,208,68
buffer_load_dwordx4 a[20:23], v10, s[20:23], s52 offen offset:1024 sc1
Mvaa 208,208,72
v_cmp_le_u32 vcc, 30, v0
Mvaa 240,208,76
Ta 248,22,40960
Ta 250,22,41984
Mvaa 148,212,64
v_cndmask_b32 v28, v28, v14, vcc
v_cndmask_b32 v29, v29, v15, vcc
Mvaa 180,212,68
buffer_load_dwordx4 a[24:27], v11, s[20:23], s53 offen offset:1024 sc1
Mvaa 212,212,72
Ta 252,23,40960
Ta 254,23,41984
Mvaa 244,212,76
v_cndmask_b32 v30, v30, v31, vcc
Mvaa 152,216,64
v_add_u32 v30, s3, v30
v_ashrrev_i32_e64 v31, 31, v30
Mvaa 184,216,68
buffer_load_dwordx4 a[28:31], v11, s[20:23], s52 offen offset:1024 sc1
Mvaa 216,216,72
s_xor_b32 s52, s52, 2048
s_add_u32 s53, s52, s58
Mvaa 248,216,76
buffer_store_dwordx4 v[44:47], v2, s[24:27], s59 offen offset:3072 sc1
Mvaa 156,220,64
v_mov_b32 v12, 1
v_and_b32_e64 v1, 15, v0
Mvaa 188,220,68
v_lshlrev_b32_e64 v1, 2, v1
Mvaa 220,220,72
s_waitcnt vmcnt(29) lgkmcnt(0)
v_lshl_add_u64 v[28:29], v[30:31], 0, v[28:29]
Mvaa 252,220,76
s_barrier
Mvaa 128,224,80
s_lshr_b32 s6, s33, 1
s_lshl_b32 s6, s6, 7
s_add_u32 s6, s6, 5296128
Mvaa 160,224,84
s_add_u32 m0, s44, 32768
Ta 192,16,49152
Ta 194,16,50176
Mvaa 192,224,88
buffer_load_dwordx4 v8, s[8:11], s48 offen offset:0 lds
Mvaa 224,224,92
s_cmp_eq_u32 s32, 0
s_cselect_b32 s6, s6, 2146435072
Mvaa 132,228,80
Ta 196,17,49152
Ta 198,17,50176
Mvaa 164,228,84
s_mov_b32 s41, 0
v_readfirstlane_b32 s100, v64
v_readfirstlane_b32 s101, v65
Mvaa 196,228,88
buffer_load_dwordx4 v8, s[8:11], s49 offen offset:1024 lds
Mvaa 228,228,92
Ta 200,18,49152
Ta 202,18,50176
Mvaa 136,232,80
Mvaa 168,232,84
Mvaa 200,232,88
Ta 204,19,49152
Ta 206,19,50176
Mvaa 232,232,92
buffer_load_dwordx4 a[32:35], v10, s[20:23], s53 offen offset:0 sc1
Mvaa 140,236,80
Mvaa 172,236,84
Ta 208,20,49152
Ta 210,20,50176
Mvaa 204,236,88
Mvaa 236,236,92
Mvaa 144,240,80
s_waitcnt lgkmcnt(6)
Ta 212,21,49152
Ta 214,21,50176
Mvaa 176,240,84
buffer_load_dwordx4 a[36:39], v10, s[20:23], s52 offen offset:0 sc1
Mvaa 208,240,88
Mvaa 240,240,92
Ta 216,22,49152
Ta 218,22,50176
Mvaa 148,244,80
Mvaa 180,244,84
buffer_load_dwordx4 a[40:43], v11, s[20:23], s53 offen offset:0 sc1
Mvaa 212,244,88
Ta 220,23,49152
Ta 222,23,50176
Mvaa 244,244,92
Mvaa 152,248,80
Mvaa 184,248,84
buffer_load_dwordx4 a[44:47], v11, s[20:23], s52 offen offset:0 sc1
Mvaa 216,248,88
Mvaa 248,248,92
Mvaa 156,252,80
Mvaa 188,252,84
Mvaa 220,252,88
s_waitcnt vmcnt(28) lgkmcnt(0)
Mvaa 252,252,92
Mvaa 128,192,96
Mvaa 160,192,100
Ta 224,16,57344
Ta 226,16,58368
Mvaa 192,192,104
buffer_load_dwordx4 v9, s[8:11], s50 offen offset:2048 lds
Mvaa 224,192,108
Mvaa 132,196,96
Ta 228,17,57344
Ta 230,17,58368
Mvaa 164,196,100
Mvaa 196,196,104
buffer_load_dwordx4 v9, s[8:11], s51 offen offset:3072 lds
Mvaa 228,196,108
Ta 232,18,57344
Ta 234,18,58368
Mvaa 136,200,96
v_xor_b32 v8, 524288, v8
v_xor_b32 v9, 524288, v9
Mvaa 168,200,100
Mvaa 200,200,104
Ta 236,19,57344
Ta 238,19,58368
Mvaa 232,200,108
buffer_load_dwordx4 a[48:51], v10, s[20:23], s53 offen offset:1024 sc1
Mvaa 140,204,96
Mvaa 172,204,100
Ta 240,20,57344
Ta 242,20,58368
Mvaa 204,204,104
Mvaa 236,204,108
Mvaa 144,208,96
s_waitcnt lgkmcnt(6)
Ta 244,21,57344
Ta 246,21,58368
Mvaa 176,208,100
buffer_load_dwordx4 a[52:55], v10, s[20:23], s52 offen offset:1024 sc1
Mvaa 208,208,104
Mvaa 240,208,108
Ta 248,22,57344
Ta 250,22,58368
Mvaa 148,212,96
Mvaa 180,212,100
buffer_load_dwordx4 a[56:59], v11, s[20:23], s53 offen offset:1024 sc1
Mvaa 212,212,104
Ta 252,23,57344
Ta 254,23,58368
Mvaa 244,212,108
Mvaa 152,216,96
Mvaa 184,216,100
buffer_load_dwordx4 a[60:63], v11, s[20:23], s52 offen offset:1024 sc1
Mvaa 216,216,104
s_xor_b32 s52, s52, 6144
s_add_u32 s53, s52, s58
Mvaa 248,216,108
Mvaa 156,220,96
Mvaa 188,220,100
Mvaa 220,220,104
s_waitcnt vmcnt(27) lgkmcnt(0)
Mvaa 252,220,108
s_barrier
Mvaa 128,224,112
Mvaa 160,224,116
s_add_u32 m0, s44, 49152
Ta 192,16,0
Ta 194,16,1024
Mvaa 192,224,120
buffer_load_dwordx4 v8, s[8:11], s48 offen offset:0 lds
Mvaa 224,224,124
Mvaa 132,228,112
Ta 196,17,0
Ta 198,17,1024
Mvaa 164,228,116
Mvaa 196,228,120
buffer_load_dwordx4 v8, s[8:11], s49 offen offset:1024 lds
Mvaa 228,228,124
Ta 200,18,0
Ta 202,18,1024
Mvaa 136,232,112
Mvaa 168,232,116
Mvaa 200,232,120
Ta 204,19,0
Ta 206,19,1024
Mvaa 232,232,124
buffer_load_dwordx4 a[64:67], v10, s[20:23], s53 offen offset:0 sc1
Mvaa 140,236,112
Mvaa 172,236,116
Ta 208,20,0
Ta 210,20,1024
Mvaa 204,236,120
Mvaa 236,236,124
Mvaa 144,240,112
s_waitcnt lgkmcnt(6)
Ta 212,21,0
Ta 214,21,1024
Mvaa 176,240,116
buffer_load_dwordx4 a[68:71], v10, s[20:23], s52 offen offset:0 sc1
Mvaa 208,240,120
Mvaa 240,240,124
Ta 216,22,0
Ta 218,22,1024
Mvaa 148,244,112
Mvaa 180,244,116
buffer_load_dwordx4 a[72:75], v11, s[20:23], s53 offen offset:0 sc1
Mvaa 212,244,120
Ta 220,23,0
Ta 222,23,1024
Mvaa 244,244,124
Mvaa 152,248,112
Mvaa 184,248,116
buffer_load_dwordx4 a[76:79], v11, s[20:23], s52 offen offset:0 sc1
Mvaa 216,248,120
Mvaa 248,248,124
Mvaa 156,252,112
Mvaa 188,252,116
Mvaa 220,252,120
s_waitcnt vmcnt(26) lgkmcnt(0)
Mvaa 252,252,124
Mvaa 128,192,0
Mvaa 160,192,4
Ta 224,16,8192
Ta 226,16,9216
Mvaa 192,192,8
buffer_load_dwordx4 v9, s[8:11], s50 offen offset:2048 lds
Mvaa 224,192,12
Mvaa 132,196,0
Ta 228,17,8192
Ta 230,17,9216
Mvaa 164,196,4
Mvaa 196,196,8
buffer_load_dwordx4 v9, s[8:11], s51 offen offset:3072 lds
Mvaa 228,196,12
Ta 232,18,8192
Ta 234,18,9216
Mvaa 136,200,0
v_xor_b32 v8, 7864320, v8
v_xor_b32 v9, 7864320, v9
Mvaa 168,200,4
Mvaa 200,200,8
Ta 236,19,8192
Ta 238,19,9216
Mvaa 232,200,12
buffer_load_dwordx4 a[80:83], v10, s[20:23], s53 offen offset:1024 sc1
Mvaa 140,204,0
Mvaa 172,204,4
Ta 240,20,8192
Ta 242,20,9216
Mvaa 204,204,8
Mvaa 236,204,12
Mvaa 144,208,0
s_waitcnt lgkmcnt(6)
Ta 244,21,8192
Ta 246,21,9216
Mvaa 176,208,4
buffer_load_dwordx4 a[84:87], v10, s[20:23], s52 offen offset:1024 sc1
Mvaa 208,208,8
Mvaa 240,208,12
Ta 248,22,8192
Ta 250,22,9216
Mvaa 148,212,0
Mvaa 180,212,4
buffer_load_dwordx4 a[88:91], v11, s[20:23], s53 offen offset:1024 sc1
Mvaa 212,212,8
Ta 252,23,8192
Ta 254,23,9216
Mvaa 244,212,12
Mvaa 152,216,0
Mvaa 184,216,4
buffer_load_dwordx4 a[92:95], v11, s[20:23], s52 offen offset:1024 sc1
Mvaa 216,216,8
s_xor_b32 s52, s52, 2048
s_add_u32 s53, s52, s58
Mvaa 248,216,12
Mvaa 156,220,0
Mvaa 188,220,4
Mvaa 220,220,8
s_waitcnt vmcnt(24) lgkmcnt(0)
Mvaa 252,220,12
s_barrier
Mvaa 128,224,16
s_mov_b64 exec, 1
buffer_store_dword v12, v7, s[20:23], s39 offen sc1
s_mov_b64 exec, -1
Mvaa 160,224,20
Ta 192,16,16384
Ta 194,16,17408
Mvaa 192,224,24
buffer_load_dwordx4 a[96:99], v10, s[20:23], s53 offen offset:0 sc1
Mvaa 224,224,28
s_mov_b32 s24, s60
s_mov_b32 s25, s61
s_mov_b32 s26, s62
Mvaa 132,228,16
Ta 196,17,16384
Ta 198,17,17408
Mvaa 164,228,20
s_mov_b32 s94, 1040356334
s_mov_b32 s95, 1040356334
s_sub_u32 s55, 15, s34
Mvaa 196,228,24
s_sub_u32 s45, s36, 3
s_sub_u32 s46, s35, 3
s_mov_b32 s54, s44
Mvaa 228,228,28
Ta 200,18,16384
Ta 202,18,17408
Mvaa 136,232,16
s_sub_u32 s35, s35, 2
s_sub_u32 s36, s36, 2
v_accvgpr_write_b32 a0, 0
Mvaa 168,232,20
buffer_load_dwordx4 a[100:103], v10, s[20:23], s52 offen offset:0 sc1
Mvaa 200,232,24
Ta 204,19,16384
Ta 206,19,17408
Mvaa 232,232,28
v_accvgpr_write_b32 a1, 0
v_accvgpr_write_b32 a2, 0
Mvaa 140,236,16
v_accvgpr_write_b32 a3, 0
v_accvgpr_write_b32 a4, 0
Mvaa 172,236,20
Ta 208,20,16384
Ta 210,20,17408
Mvaa 204,236,24
v_accvgpr_write_b32 a5, 0
v_accvgpr_write_b32 a6, 0
Mvaa 236,236,28
v_accvgpr_write_b32 a7, 0
v_accvgpr_write_b32 a8, 0
Mvaa 144,240,16
s_waitcnt lgkmcnt(6)
Ta 212,21,16384
Ta 214,21,17408
Mvaa 176,240,20
buffer_load_dwordx4 a[104:107], v11, s[20:23], s53 offen offset:0 sc1
Mvaa 208,240,24
v_accvgpr_write_b32 a9, 0
v_accvgpr_write_b32 a10, 0
Mvaa 240,240,28
Ta 216,22,16384
Ta 218,22,17408
Mvaa 148,244,16
v_accvgpr_write_b32 a11, 0
v_accvgpr_write_b32 a12, 0
Mvaa 180,244,20
v_accvgpr_write_b32 a13, 0
v_accvgpr_write_b32 a14, 0
Mvaa 212,244,24
Ta 220,23,16384
Ta 222,23,17408
Mvaa 244,244,28
v_accvgpr_write_b32 a15, 0
Mvaa 152,248,16
buffer_load_dwordx4 a[108:111], v11, s[20:23], s52 offen offset:0 sc1
Mvaa 184,248,20
Mvaa 216,248,24
Mvaa 248,248,28
Mvaa 156,252,16
Mvaa 188,252,20
Mvaa 220,252,24
s_waitcnt vmcnt(23) lgkmcnt(0)
Mvaa 252,252,28
Mvaa 128,192,32
v_accvgpr_write_b32 a16, 0
v_accvgpr_write_b32 a17, 0
Mvaa 160,192,36
Ta 224,16,24576
Ta 226,16,25600
Mvaa 192,192,40
buffer_load_dwordx4 a[112:115], v10, s[20:23], s53 offen offset:1024 sc1
Mvaa 224,192,44
v_accvgpr_write_b32 a18, 0
v_accvgpr_write_b32 a19, 0
Mvaa 132,196,32
Ta 228,17,24576
Ta 230,17,25600
Mvaa 164,196,36
v_accvgpr_write_b32 a20, 0
v_accvgpr_write_b32 a21, 0
Mvaa 196,196,40
v_accvgpr_write_b32 a22, 0
v_accvgpr_write_b32 a23, 0
Mvaa 228,196,44
Ta 232,18,24576
Ta 234,18,25600
Mvaa 136,200,32
v_accvgpr_write_b32 a24, 0
v_accvgpr_write_b32 a25, 0
Mvaa 168,200,36
buffer_load_dwordx4 a[116:119], v10, s[20:23], s52 offen offset:1024 sc1
Mvaa 200,200,40
Ta 236,19,24576
Ta 238,19,25600
Mvaa 232,200,44
v_accvgpr_write_b32 a26, 0
v_accvgpr_write_b32 a27, 0
Mvaa 140,204,32
v_accvgpr_write_b32 a28, 0
v_accvgpr_write_b32 a29, 0
Mvaa 172,204,36
Ta 240,20,24576
Ta 242,20,25600
Mvaa 204,204,40
v_accvgpr_write_b32 a30, 0
v_accvgpr_write_b32 a31, 0
Mvaa 236,204,44
Mvaa 144,208,32
s_waitcnt lgkmcnt(6)
Ta 244,21,24576
Ta 246,21,25600
Mvaa 176,208,36
buffer_load_dwordx4 a[120:123], v11, s[20:23], s53 offen offset:1024 sc1
Mvaa 208,208,40
Mvaa 240,208,44
Ta 248,22,24576
Ta 250,22,25600
Mvaa 148,212,32
Mvaa 180,212,36
Mvaa 212,212,40
Ta 252,23,24576
Ta 254,23,25600
Mvaa 244,212,44
Mvaa 152,216,32
buffer_load_dwordx4 a[124:127], v11, s[20:23], s52 offen offset:1024 sc1
Mvaa 184,216,36
Mvaa 216,216,40
Mvaa 248,216,44
Mvaa 156,220,32
Mvaa 188,220,36
Mvaa 220,220,40
s_waitcnt vmcnt(21) lgkmcnt(0)
Mvaa 252,220,44
s_barrier
Mvaa 128,224,48
v_accvgpr_write_b32 a32, 0
v_accvgpr_write_b32 a33, 0
Mvaa 160,224,52
Ta 192,16,32768
Ta 194,16,33792
Mvaa 192,224,56
v_accvgpr_write_b32 a34, 0
v_accvgpr_write_b32 a35, 0
Mvaa 224,224,60
v_accvgpr_write_b32 a36, 0
v_accvgpr_write_b32 a37, 0
Mvaa 132,228,48
Ta 196,17,32768
Ta 198,17,33792
Mvaa 164,228,52
v_accvgpr_write_b32 a38, 0
v_accvgpr_write_b32 a39, 0
Mvaa 196,228,56
v_accvgpr_write_b32 a40, 0
v_accvgpr_write_b32 a41, 0
Mvaa 228,228,60
Ta 200,18,32768
Ta 202,18,33792
Mvaa 136,232,48
v_accvgpr_write_b32 a42, 0
v_accvgpr_write_b32 a43, 0
Mvaa 168,232,52
v_accvgpr_write_b32 a44, 0
v_accvgpr_write_b32 a45, 0
Mvaa 200,232,56
Ta 204,19,32768
Ta 206,19,33792
Mvaa 232,232,60
buffer_load_dword v12, v1, s[20:23], s6 offen sc1
Mvaa 140,236,48
s_add_u32 m0, s44, 65536
s_mov_b32 s7, 0
Mvaa 172,236,52
Ta 208,20,32768
Ta 210,20,33792
Mvaa 204,236,56
v_accvgpr_write_b32 a46, 0
v_accvgpr_write_b32 a47, 0
Mvaa 236,236,60
Mvaa 144,240,48
s_waitcnt lgkmcnt(6)
Ta 212,21,32768
Ta 214,21,33792
Mvaa 176,240,52
Mvaa 208,240,56
Mvaa 240,240,60
Ta 216,22,32768
Ta 218,22,33792
Mvaa 148,244,48
Mvaa 180,244,52
Mvaa 212,244,56
Ta 220,23,32768
Ta 222,23,33792
Mvaa 244,244,60
Mvaa 152,248,48
Mvaa 184,248,52
Mvaa 216,248,56
Mvaa 248,248,60
Mvaa 156,252,48
Mvaa 188,252,52
Mvaa 220,252,56
s_waitcnt vmcnt(16) lgkmcnt(0)
Mvaa 252,252,60
Mvaa 128,192,64
v_accvgpr_write_b32 a48, 0
v_accvgpr_write_b32 a49, 0
Mvaa 160,192,68
Ta 224,16,40960
Ta 226,16,41984
Mvaa 192,192,72
v_accvgpr_write_b32 a50, 0
v_accvgpr_write_b32 a51, 0
Mvaa 224,192,76
v_accvgpr_write_b32 a52, 0
v_accvgpr_write_b32 a53, 0
Mvaa 132,196,64
Ta 228,17,40960
Ta 230,17,41984
Mvaa 164,196,68
v_accvgpr_write_b32 a54, 0
v_accvgpr_write_b32 a55, 0
Mvaa 196,196,72
v_accvgpr_write_b32 a56, 0
v_accvgpr_write_b32 a57, 0
Mvaa 228,196,76
Ta 232,18,40960
Ta 234,18,41984
Mvaa 136,200,64
v_accvgpr_write_b32 a58, 0
v_accvgpr_write_b32 a59, 0
Mvaa 168,200,68
v_accvgpr_write_b32 a60, 0
v_accvgpr_write_b32 a61, 0
Mvaa 200,200,72
Ta 236,19,40960
Ta 238,19,41984
Mvaa 232,200,76
v_accvgpr_write_b32 a62, 0
v_accvgpr_write_b32 a63, 0
Mvaa 140,204,64
Mvaa 172,204,68
Ta 240,20,40960
Ta 242,20,41984
Mvaa 204,204,72
Mvaa 236,204,76
Mvaa 144,208,64
s_waitcnt lgkmcnt(6)
Ta 244,21,40960
Ta 246,21,41984
Mvaa 176,208,68
Mvaa 208,208,72
Mvaa 240,208,76
Ta 248,22,40960
Ta 250,22,41984
Mvaa 148,212,64
Mvaa 180,212,68
Mvaa 212,212,72
Ta 252,23,40960
Ta 254,23,41984
Mvaa 244,212,76
Mvaa 152,216,64
Mvaa 184,216,68
Mvaa 216,216,72
Mvaa 248,216,76
Mvaa 156,220,64
Mvaa 188,220,68
Mvaa 220,220,72
s_waitcnt vmcnt(0) lgkmcnt(0)
Mvaa 252,220,76
s_cmp_lg_u32 s32, 0
s_cbranch_scc1 L_spinBr
v_cmp_ne_u32 vcc, 1, v12
s_cbranch_vccnz L_spinB
L_spinBr:
s_barrier
Mvaa 128,224,80
buffer_load_dwordx4 v4, s[12:15], s7 offen offset:0 sc1 lds
Mvaa 160,224,84
Ta 192,16,49152
Ta 194,16,50176
Mvaa 192,224,88
v_accvgpr_write_b32 a64, 0
v_accvgpr_write_b32 a65, 0
Mvaa 224,224,92
buffer_load_dwordx4 v4, s[12:15], s7 offen offset:1024 sc1 lds
Mvaa 132,228,80
Ta 196,17,49152
Ta 198,17,50176
Mvaa 164,228,84
v_accvgpr_write_b32 a66, 0
v_accvgpr_write_b32 a67, 0
Mvaa 196,228,88
buffer_load_dwordx4 v4, s[12:15], s7 offen offset:2048 sc1 lds
Mvaa 228,228,92
Ta 200,18,49152
Ta 202,18,50176
Mvaa 136,232,80
v_accvgpr_write_b32 a68, 0
v_accvgpr_write_b32 a69, 0
Mvaa 168,232,84
buffer_load_dwordx4 v4, s[12:15], s7 offen offset:3072 sc1 lds
Mvaa 200,232,88
Ta 204,19,49152
Ta 206,19,50176
Mvaa 232,232,92
s_add_u32 m0, s44, 98304
s_mov_b32 s7, 34816
Mvaa 140,236,80
buffer_load_dwordx4 v4, s[12:15], s7 offen offset:0 sc1 lds
Mvaa 172,236,84
Ta 208,20,49152
Ta 210,20,50176
Mvaa 204,236,88
v_accvgpr_write_b32 a70, 0
v_accvgpr_write_b32 a71, 0
Mvaa 236,236,92
buffer_load_dwordx4 v4, s[12:15], s7 offen offset:1024 sc1 lds
Mvaa 144,240,80
s_waitcnt lgkmcnt(6)
Ta 212,21,49152
Ta 214,21,50176
Mvaa 176,240,84
v_accvgpr_write_b32 a72, 0
v_accvgpr_write_b32 a73, 0
Mvaa 208,240,88
buffer_load_dwordx4 v4, s[12:15], s7 offen offset:2048 sc1 lds
Mvaa 240,240,92
Ta 216,22,49152
Ta 218,22,50176
Mvaa 148,244,80
v_accvgpr_write_b32 a74, 0
v_accvgpr_write_b32 a75, 0
Mvaa 180,244,84
buffer_load_dwordx4 v4, s[12:15], s7 offen offset:3072 sc1 lds
Mvaa 212,244,88
Ta 220,23,49152
Ta 222,23,50176
Mvaa 244,244,92
s_add_u32 m0, s44, 81920
s_mov_b32 s7, 17408
Mvaa 152,248,80
buffer_load_dwordx4 v4, s[12:15], s7 offen offset:0 sc1 lds
Mvaa 184,248,84
v_accvgpr_write_b32 a76, 0
v_accvgpr_write_b32 a77, 0
Mvaa 216,248,88
buffer_load_dwordx4 v4, s[12:15], s7 offen offset:1024 sc1 lds
Mvaa 248,248,92
v_accvgpr_write_b32 a78, 0
v_accvgpr_write_b32 a79, 0
Mvaa 156,252,80
Mvaa 188,252,84
Mvaa 220,252,88
s_waitcnt lgkmcnt(0)
Mvaa 252,252,92
Mvaa 128,192,96
buffer_load_dwordx4 v4, s[12:15], s7 offen offset:2048 sc1 lds
Mvaa 160,192,100
Ta 224,16,57344
Ta 226,16,58368
Mvaa 192,192,104
buffer_load_dwordx4 v4, s[12:15], s7 offen offset:3072 sc1 lds
Mvaa 224,192,108
s_add_u32 m0, s44, 114688
s_mov_b32 s7, 52224
Mvaa 132,196,96
Ta 228,17,57344
Ta 230,17,58368
Mvaa 164,196,100
buffer_load_dwordx4 v4, s[12:15], s7 offen offset:0 sc1 lds
Mvaa 196,196,104
buffer_load_dwordx4 v4, s[12:15], s7 offen offset:1024 sc1 lds
Mvaa 228,196,108
Ta 232,18,57344
Ta 234,18,58368
Mvaa 136,200,96
v_accvgpr_write_b32 a80, 0
v_accvgpr_write_b32 a81, 0
Mvaa 168,200,100
buffer_load_dwordx4 v4, s[12:15], s7 offen offset:2048 sc1 lds
Mvaa 200,200,104
Ta 236,19,57344
Ta 238,19,58368
Mvaa 232,200,108
v_accvgpr_write_b32 a82, 0
v_accvgpr_write_b32 a83, 0
Mvaa 140,204,96
buffer_load_dwordx4 v4, s[12:15], s7 offen offset:3072 sc1 lds
Mvaa 172,204,100
Ta 240,20,57344
Ta 242,20,58368
Mvaa 204,204,104
s_add_u32 m0, s44, 0
s_mov_b32 s7, 69632
Mvaa 236,204,108
buffer_load_dwordx4 v4, s[12:15], s7 offen offset:0 sc1 lds
Mvaa 144,208,96
s_waitcnt lgkmcnt(6)
Ta 244,21,57344
Ta 246,21,58368
Mvaa 176,208,100
buffer_load_dwordx4 v4, s[12:15], s7 offen offset:1024 sc1 lds
Mvaa 208,208,104
v_accvgpr_write_b32 a84, 0
v_accvgpr_write_b32 a85, 0
Mvaa 240,208,108
Ta 248,22,57344
Ta 250,22,58368
Mvaa 148,212,96
buffer_load_dwordx4 v4, s[12:15], s7 offen offset:2048 sc1 lds
Mvaa 180,212,100
v_accvgpr_write_b32 a86, 0
v_accvgpr_write_b32 a87, 0
Mvaa 212,212,104
Ta 252,23,57344
Ta 254,23,58368
Mvaa 244,212,108
buffer_load_dwordx4 v4, s[12:15], s7 offen offset:3072 sc1 lds
Mvaa 152,216,96
s_add_u32 m0, s44, 16384
s_mov_b32 s7, 87040
Mvaa 184,216,100
v_accvgpr_write_b32 a88, 0
v_accvgpr_write_b32 a89, 0
Mvaa 216,216,104
buffer_load_dwordx4 v4, s[12:15], s7 offen offset:0 sc1 lds
Mvaa 248,216,108
v_accvgpr_write_b32 a90, 0
v_accvgpr_write_b32 a91, 0
Mvaa 156,220,96
v_accvgpr_write_b32 a92, 0
v_accvgpr_write_b32 a93, 0
Mvaa 188,220,100
v_accvgpr_write_b32 a94, 0
v_accvgpr_write_b32 a95, 0
Mvaa 220,220,104
s_waitcnt vmcnt(17) lgkmcnt(0)
Mvaa 252,220,108
s_barrier
Mvaa 128,224,112
buffer_load_dwordx4 v4, s[12:15], s7 offen offset:1024 sc1 lds
Mvaa 132,228,112
buffer_load_dwordx4 v4, s[12:15], s7 offen offset:2048 sc1 lds
Mvaa 136,232,112
Ra 192,3,0
Ra 196,3,1024
Mvaa 140,236,112
buffer_load_dwordx4 v4, s[12:15], s7 offen offset:3072 sc1 lds
Mvaa 144,240,112
s_add_u32 m0, s44, 32768
s_mov_b32 s7, 104448
Mvaa 148,244,112
Ra 200,3,2048
Ra 204,3,3072
Mvaa 152,248,112
buffer_load_dwordx4 v4, s[12:15], s7 offen offset:0 sc1 lds
Mvaa 156,252,112
Ra 208,3,4096
Ra 212,3,5120
Mvaa 160,224,116
buffer_load_dwordx4 v4, s[12:15], s7 offen offset:1024 sc1 lds
Mvaa 164,228,116
Ra 216,3,6144
Ra 220,3,7168
Mvaa 168,232,116
Mvaa 172,236,116
buffer_load_dwordx4 v4, s[12:15], s7 offen offset:2048 sc1 lds
Mvaa 176,240,116
v_mul_f32 v128, s94, v128
v_mul_f32 v129, s94, v129
Mvaa 180,244,116
v_mul_f32 v130, s94, v130
v_mul_f32 v131, s94, v131
Mvaa 184,248,116
buffer_load_dwordx4 v4, s[12:15], s7 offen offset:3072 sc1 lds
Mvaa 188,252,116
v_mul_f32 v132, s94, v132
v_mul_f32 v133, s94, v133
Mvaa 192,224,120
v_mul_f32 v134, s94, v134
v_mul_f32 v135, s94, v135
Mvaa 196,228,120
Vc 128,128,129
Vc 129,130,131
Mvaa 200,232,120
Vc 130,132,133
Vc 131,134,135
Mvaa 204,236,120
Aw 128,128
Aw 129,129
Mvaa 208,240,120
Aw 130,130
Aw 131,131
Mvaa 212,244,120
v_mul_f32 v136, s94, v136
v_mul_f32 v137, s94, v137
Mvaa 216,248,120
v_mul_f32 v138, s94, v138
v_mul_f32 v139, s94, v139
Mvaa 220,252,120
v_mul_f32 v140, s94, v140
v_mul_f32 v141, s94, v141
Mvaa 224,224,124
v_mul_f32 v142, s94, v142
v_mul_f32 v143, s94, v143
Mvaa 228,228,124
Vc 136,136,137
Vc 137,138,139
Mvaa 232,232,124
Vc 138,140,141
Vc 139,142,143
Mvaa 236,236,124
Aw 132,136
Aw 133,137
Mvaa 240,240,124
Aw 134,138
Aw 135,139
Mvaa 244,244,124
v_mul_f32 v144, s94, v144
v_mul_f32 v145, s94, v145
Mvaa 248,248,124
v_mul_f32 v146, s94, v146
v_mul_f32 v147, s94, v147
Mvaa 252,252,124
v_mul_f32 v148, s94, v148
v_mul_f32 v149, s94, v149
Ra 224,3,8192
Ra 228,3,9216
Ra 232,3,10240
Ra 236,3,11264
Ra 240,3,12288
Ra 244,3,13312
Ra 248,3,14336
s_waitcnt lgkmcnt(9)
Ra 252,3,15360
v_mul_f32 v150, s94, v150
v_mul_f32_e64 v151, s94, v151
Vc 144,144,145
Vc 145,146,147
Vc 146,148,149
Vc 147,150,151
Aw 136,144
Aw 137,145
Aw 138,146
Aw 139,147
v_mul_f32 v152, s94, v152
v_mul_f32 v153, s94, v153
v_mul_f32 v154, s94, v154
v_mul_f32 v155, s94, v155
v_mul_f32 v156, s94, v156
v_mul_f32 v157, s94, v157
v_mul_f32 v158, s94, v158
v_mul_f32 v159, s94, v159
Vc 152,152,153
Vc 153,154,155
Vc 154,156,157
Vc 155,158,159
Aw 140,152
Aw 141,153
Aw 142,154
Aw 143,155
Zvaa 128,192,128
v_mul_f32 v160, s94, v160
v_mul_f32 v161, s94, v161
v_mul_f32 v162, s94, v162
v_mul_f32 v163, s94, v163
Mvaa 128,196,132
v_mul_f32 v164, s94, v164
v_mul_f32 v165, s94, v165
v_mul_f32 v166, s94, v166
v_mul_f32 v167, s94, v167
Mvaa 128,200,136
Vc 160,160,161
Vc 161,162,163
Vc 162,164,165
Vc 163,166,167
Mvaa 128,204,140
Aw 144,160
Aw 145,161
Aw 146,162
Aw 147,163
s_waitcnt lgkmcnt(8)
Zvaa 132,208,128
v_mul_f32 v168, s94, v168
v_mul_f32 v169, s94, v169
v_mul_f32 v170, s94, v170
v_mul_f32_e64 v171, s94, v171
Mvaa 132,212,132
v_mul_f32 v172, s94, v172
v_mul_f32 v173, s94, v173
v_mul_f32 v174, s94, v174
v_mul_f32 v175, s94, v175
Mvaa 132,216,136
Vc 168,168,169
Vc 169,170,171
Vc 170,172,173
Vc 171,174,175
Mvaa 132,220,140
Aw 148,168
Aw 149,169
Aw 150,170
Aw 151,171
s_waitcnt lgkmcnt(4)
Zvaa 136,224,128
v_mul_f32 v176, s94, v176
v_mul_f32 v177, s94, v177
v_mul_f32 v178, s94, v178
v_mul_f32_e64 v179, s94, v179
Mvaa 136,228,132
v_mul_f32 v180, s94, v180
v_mul_f32 v181, s94, v181
v_mul_f32 v182, s94, v182
v_mul_f32 v183, s94, v183
Mvaa 136,232,136
Vc 176,176,177
Vc 177,178,179
Vc 178,180,181
Vc 179,182,183
Mvaa 136,236,140
Aw 152,176
Aw 153,177
Aw 154,178
Aw 155,179
s_waitcnt lgkmcnt(0)
Zvaa 140,240,128
v_mul_f32 v184, s94, v184
v_mul_f32 v185, s94, v185
v_mul_f32 v186, s94, v186
v_mul_f32_e64 v187, s94, v187
Mvaa 140,244,132
v_mul_f32 v188, s94, v188
v_mul_f32 v189, s94, v189
v_mul_f32 v190, s94, v190
v_mul_f32 v191, s94, v191
Mvaa 140,248,136
Vc 184,184,185
Vc 185,186,187
Vc 186,188,189
Vc 187,190,191
Mvaa 140,252,140
Aw 156,184
Aw 157,185
Aw 158,186
Aw 159,187
Zvaa 144,192,144
v_mul_f32 v192, s94, v192
v_mul_f32 v193, s94, v193
v_mul_f32 v194, s94, v194
v_mul_f32 v195, s94, v195
Mvaa 144,196,148
v_mul_f32 v196, s94, v196
v_mul_f32 v197, s94, v197
v_mul_f32 v198, s94, v198
v_mul_f32 v199, s94, v199
Mvaa 144,200,152
Vc 192,192,193
Vc 193,194,195
Vc 194,196,197
Vc 195,198,199
Mvaa 144,204,156
Aw 160,192
Aw 161,193
Aw 162,194
Aw 163,195
Zvaa 148,208,144
v_mul_f32 v200, s94, v200
v_mul_f32 v201, s94, v201
v_mul_f32 v202, s94, v202
v_mul_f32 v203, s94, v203
Mvaa 148,212,148
v_mul_f32 v204, s94, v204
v_mul_f32 v205, s94, v205
v_mul_f32 v206, s94, v206
v_mul_f32 v207, s94, v207
Mvaa 148,216,152
Vc 200,200,201
Vc 201,202,203
Vc 202,204,205
Vc 203,206,207
Mvaa 148,220,156
Aw 164,200
Aw 165,201
Aw 166,202
Aw 167,203
Zvaa 152,224,144
v_mul_f32 v208, s94, v208
v_mul_f32 v209, s94, v209
v_mul_f32 v210, s94, v210
v_mul_f32 v211, s94, v211
Mvaa 152,228,148
v_mul_f32 v212, s94, v212
v_mul_f32 v213, s94, v213
v_mul_f32 v214, s94, v214
v_mul_f32 v215, s94, v215
Mvaa 152,232,152
Vc 208,208,209
Vc 209,210,211
Vc 210,212,213
Vc 211,214,215
Mvaa 152,236,156
Aw 168,208
Aw 169,209
Aw 170,210
Aw 171,211
Zvaa 156,240,144
v_mul_f32 v216, s94, v216
v_mul_f32 v217, s94, v217
v_mul_f32 v218, s94, v218
v_mul_f32 v219, s94, v219
Mvaa 156,244,148
v_mul_f32 v220, s94, v220
v_mul_f32 v221, s94, v221
v_mul_f32 v222, s94, v222
v_mul_f32 v223, s94, v223
Mvaa 156,248,152
Vc 216,216,217
Vc 217,218,219
Vc 218,220,221
Vc 219,222,223
Mvaa 156,252,156
Aw 172,216
Aw 173,217
Aw 174,218
Aw 175,219
Zvaa 160,192,160
v_mul_f32 v224, s94, v224
v_mul_f32 v225, s94, v225
v_mul_f32 v226, s94, v226
v_mul_f32 v227, s94, v227
Mvaa 160,196,164
v_mul_f32 v228, s94, v228
v_mul_f32 v229, s94, v229
v_mul_f32 v230, s94, v230
v_mul_f32 v231, s94, v231
Mvaa 160,200,168
Vc 224,224,225
Vc 225,226,227
Vc 226,228,229
Vc 227,230,231
Mvaa 160,204,172
Aw 176,224
Aw 177,225
Aw 178,226
Aw 179,227
Zvaa 164,208,160
v_mul_f32 v232, s94, v232
v_mul_f32 v233, s94, v233
v_mul_f32 v234, s94, v234
v_mul_f32 v235, s94, v235
Mvaa 164,212,164
v_mul_f32 v236, s94, v236
v_mul_f32 v237, s94, v237
v_mul_f32 v238, s94, v238
v_mul_f32 v239, s94, v239
Mvaa 164,216,168
Vc 232,232,233
Vc 233,234,235
Vc 234,236,237
Vc 235,238,239
Mvaa 164,220,172
Aw 180,232
Aw 181,233
Aw 182,234
Aw 183,235
Zvaa 168,224,160
v_mul_f32 v240, s94, v240
v_mul_f32 v241, s94, v241
v_mul_f32 v242, s94, v242
v_mul_f32 v243, s94, v243
Mvaa 168,228,164
v_mul_f32 v244, s94, v244
v_mul_f32 v245, s94, v245
v_mul_f32 v246, s94, v246
v_mul_f32 v247, s94, v247
Mvaa 168,232,168
Vc 240,240,241
Vc 241,242,243
Vc 242,244,245
Vc 243,246,247
Mvaa 168,236,172
Aw 184,240
Aw 185,241
Aw 186,242
Aw 187,243
Zvaa 172,240,160
v_mul_f32 v248, s94, v248
v_mul_f32 v249, s94, v249
v_mul_f32 v250, s94, v250
v_mul_f32 v251, s94, v251
Mvaa 172,244,164
v_mul_f32 v252, s94, v252
v_mul_f32 v253, s94, v253
v_mul_f32 v254, s94, v254
v_mul_f32 v255, s94, v255
Mvaa 172,248,168
Vc 248,248,249
Vc 249,250,251
Vc 250,252,253
Vc 251,254,255
Mvaa 172,252,172
Aw 188,248
Aw 189,249
Aw 190,250
Aw 191,251
Zvaa 176,192,176
v_accvgpr_write_b32 a96, 0
v_accvgpr_write_b32 a97, 0
v_accvgpr_write_b32 a98, 0
v_accvgpr_write_b32 a99, 0
Mvaa 176,196,180
v_accvgpr_write_b32 a100, 0
v_accvgpr_write_b32 a101, 0
v_accvgpr_write_b32 a102, 0
v_accvgpr_write_b32 a103, 0
Mvaa 176,200,184
v_accvgpr_write_b32 a104, 0
v_accvgpr_write_b32 a105, 0
v_accvgpr_write_b32 a106, 0
v_accvgpr_write_b32 a107, 0
Mvaa 176,204,188
v_accvgpr_write_b32 a108, 0
v_accvgpr_write_b32 a109, 0
v_accvgpr_write_b32 a110, 0
v_accvgpr_write_b32 a111, 0
Zvaa 180,208,176
v_accvgpr_write_b32 a112, 0
v_accvgpr_write_b32 a113, 0
v_accvgpr_write_b32 a114, 0
v_accvgpr_write_b32 a115, 0
Mvaa 180,212,180
v_accvgpr_write_b32 a116, 0
v_accvgpr_write_b32 a117, 0
v_accvgpr_write_b32 a118, 0
v_accvgpr_write_b32 a119, 0
Mvaa 180,216,184
v_accvgpr_write_b32 a120, 0
v_accvgpr_write_b32 a121, 0
v_accvgpr_write_b32 a122, 0
v_accvgpr_write_b32 a123, 0
Mvaa 180,220,188
v_accvgpr_write_b32 a124, 0
v_accvgpr_write_b32 a125, 0
v_accvgpr_write_b32 a126, 0
v_accvgpr_write_b32 a127, 0
s_waitcnt vmcnt(16)
s_barrier
s_add_u32 s53, s44, 65536
Zvaa 184,224,176
Ra 192,3,32768
v_mov_b32 v16, 0x3f803f80
v_mov_b32 v17, 0x3f803f80
v_mov_b32 v18, 0x3f803f80
v_mov_b32 v19, 0x3f803f80
Mvaa 184,228,180
Ra 196,3,33792
v_mov_b32 v20, 0xff800000
v_max3_f32 v22, v128, v129, v130
v_max3_f32 v22, v22, v131, v132
v_max3_f32 v22, v22, v133, v134
Mvaa 184,232,184
Ra 200,3,34816
v_max3_f32 v22, v22, v135, v136
v_max3_f32 v22, v22, v137, v138
v_max3_f32 v22, v22, v139, v140
v_max3_f32 v22, v22, v141, v142
Mvaa 184,236,188
Ra 204,3,35840
v_max_f32 v22, v22, v143
v_mov_b32 v1, v22
s_nop 1
v_permlane16_swap_b32 v1, v22
v_max_f32_e64 v22, v22, v1
Zvaa 188,240,176
Ra 208,3,36864
v_mov_b32 v1, v22
s_nop 1
v_permlane32_swap_b32 v1, v22
v_max_f32 v22, v22, v1
v_add_f32 v22, 0x41f80000, v22
Mvaa 188,244,180
Ra 212,3,37888
Vs 128,128,22
Vs 129,129,22
Vs 130,130,22
Vs 131,131,22
Mvaa 188,248,184
Ra 216,3,38912
Vs 132,132,22
Vs 133,133,22
Vs 134,134,22
Vs 135,135,22
Mvaa 188,252,188
Ra 220,3,39936
Vs 136,136,22
Vs 137,137,22
Vs 138,138,22
Vs 139,139,22
Vs 140,140,22
Vs 141,141,22
Vs 142,142,22
Vs 143,143,22
v_sub_f32 v32, 0, v22
v_sub_f32 v33, 0, v22
v_sub_f32 v34, 0, v22
v_sub_f32 v35, 0, v22
v_max3_f32 v22, v144, v145, v146
v_max3_f32 v22, v22, v147, v148
v_max3_f32 v22, v22, v149, v150
v_max3_f32 v22, v22, v151, v152
v_max3_f32 v22, v22, v153, v154
v_max3_f32 v22, v22, v155, v156
v_max3_f32 v22, v22, v157, v158
v_max_f32 v22, v22, v159
v_mov_b32 v1, v22
s_nop 1
v_permlane16_swap_b32 v1, v22
v_max_f32 v22, v22, v1
v_mov_b32 v1, v22
s_nop 1
v_permlane32_swap_b32 v1, v22
v_max_f32_e64 v22, v22, v1
v_add_f32 v22, 0x41f80000, v22
Vs 144,144,22
Vs 145,145,22
Vs 146,146,22
Vs 147,147,22
Vs 148,148,22
Vs 149,149,22
Vs 150,150,22
Vs 151,151,22
Vs 152,152,22
Vs 153,153,22
Vs 154,154,22
Vs 155,155,22
Vs 156,156,22
Vs 157,157,22
Vs 158,158,22
Vs 159,159,22
v_sub_f32 v36, 0, v22
v_sub_f32 v37, 0, v22
v_sub_f32 v38, 0, v22
v_sub_f32 v39, 0, v22
s_mov_b32 s38, 139264
s_mov_b32 s39, 121856
s_cmp_lg_u32 s34, 0
s_cbranch_scc1 L_k2_nomask0
v_cmp_gt_i32 s[56:57], 0, v5
v_cmp_gt_i32 s[58:59], 1, v5
v_cmp_gt_i32 s[60:61], 2, v5
v_cmp_gt_i32 s[62:63], 3, v5
s_nop 3
s_nop 0
v_cndmask_b32 v176, v176, v20, s[56:57]
v_cndmask_b32 v177, v177, v20, s[58:59]
v_cndmask_b32 v178, v178, v20, s[60:61]
v_cndmask_b32 v179, v179, v20, s[62:63]
v_cmp_gt_i32 s[56:57], 16, v5
v_cmp_gt_i32 s[58:59], 17, v5
v_cmp_gt_i32 s[60:61], 18, v5
v_cmp_gt_i32 s[62:63], 19, v5
v_cndmask_b32 v180, v180, v20, s[56:57]
v_cndmask_b32 v181, v181, v20, s[58:59]
v_cndmask_b32 v182, v182, v20, s[60:61]
v_cndmask_b32 v183, v183, v20, s[62:63]
v_cmp_gt_i32 s[56:57], 32, v5
v_cmp_gt_i32 s[58:59], 33, v5
v_cmp_gt_i32 s[60:61], 34, v5
v_cmp_gt_i32 s[62:63], 35, v5
v_cndmask_b32 v184, v184, v20, s[56:57]
v_cndmask_b32 v185, v185, v20, s[58:59]
v_cndmask_b32 v186, v186, v20, s[60:61]
v_cndmask_b32 v187, v187, v20, s[62:63]
v_cmp_gt_i32 s[56:57], 48, v5
v_cmp_gt_i32 s[58:59], 49, v5
v_cmp_gt_i32 s[60:61], 50, v5
v_cmp_gt_i32 s[62:63], 51, v5
v_cndmask_b32 v188, v188, v20, s[56:57]
v_cndmask_b32 v189, v189, v20, s[58:59]
v_cndmask_b32 v190, v190, v20, s[60:61]
v_cndmask_b32 v191, v191, v20, s[62:63]
L_k2_nomask0:
s_mov_b32 s37, 0
s_nop 0
v_max3_f32 v22, v160, v161, v162
v_max3_f32 v22, v22, v163, v164
v_max3_f32 v22, v22, v165, v166
v_max3_f32 v22, v22, v167, v168
v_max3_f32 v22, v22, v169, v170
v_max3_f32 v22, v22, v171, v172
v_max3_f32 v22, v22, v173, v174
v_max_f32 v22, v22, v175
v_mov_b32 v1, v22
s_nop 1
v_permlane16_swap_b32 v1, v22
v_max_f32 v22, v22, v1
v_mov_b32 v1, v22
s_nop 1
v_permlane32_swap_b32 v1, v22
v_max_f32_e64 v22, v22, v1
v_add_f32 v22, 0x41f80000, v22
Vs 160,160,22
Vs 161,161,22
Vs 162,162,22
Vs 163,163,22
Vs 164,164,22
Vs 165,165,22
Vs 166,166,22
Vs 167,167,22
Vs 168,168,22
Vs 169,169,22
Vs 170,170,22
Vs 171,171,22
Vs 172,172,22
Vs 173,173,22
Vs 174,174,22
Vs 175,175,22
v_sub_f32 v40, 0, v22
v_sub_f32 v41, 0, v22
v_sub_f32 v42, 0, v22
v_sub_f32 v43, 0, v22
v_max3_f32 v22, v176, v177, v178
v_max3_f32 v22, v22, v179, v180
v_max3_f32 v22, v22, v181, v182
v_max3_f32 v22, v22, v183, v184
v_max3_f32 v22, v22, v185, v186
v_max3_f32 v22, v22, v187, v188
v_max3_f32 v22, v22, v189, v190
v_max_f32 v22, v22, v191
v_mov_b32 v1, v22
s_nop 1
v_permlane16_swap_b32 v1, v22
v_max_f32 v22, v22, v1
v_mov_b32 v1, v22
s_nop 1
v_permlane32_swap_b32 v1, v22
v_max_f32_e64 v22, v22, v1
v_add_f32 v22, 0x41f80000, v22
Vs 176,176,22
Vs 177,177,22
Vs 178,178,22
Vs 179,179,22
Vs 180,180,22
Vs 181,181,22
Vs 182,182,22
Vs 183,183,22
Vs 184,184,22
Vs 185,185,22
Vs 186,186,22
Vs 187,187,22
Vs 188,188,22
Vs 189,189,22
Vs 190,190,22
Vs 191,191,22
v_sub_f32 v44, 0, v22
v_sub_f32 v45, 0, v22
v_sub_f32 v46, 0, v22
v_sub_f32 v47, 0, v22
Ve 8,128
Ve 9,129
Ve 10,130
Ve 11,131
Vc 64,8,9
Ve 12,144
Ve 13,145
Vc 65,10,11
Ve 14,146
Ve 15,147
Vc 72,12,13
Ve 8,160
Ve 9,161
Vc 73,14,15
Ve 10,162
Ve 11,163
Vc 80,8,9
Ve 12,176
Ve 13,177
Vc 81,10,11
Ve 14,178
Ve 15,179
Vc 88,12,13
Ve 8,132
Ve 9,133
Vc 89,14,15
Ve 10,134
Ve 11,135
Vc 66,8,9
Ve 12,148
Ve 13,149
Vc 67,10,11
Ve 14,150
Ve 15,151
Vc 74,12,13
Ve 8,164
Ve 9,165
Vc 75,14,15
Ve 10,166
Ve 11,167
Vc 82,8,9
Ve 12,180
Ve 13,181
Vc 83,10,11
Ve 14,182
Ve 15,183
Vc 90,12,13
Vc 91,14,15
v_or_b32_e64 v7, v64, v65
v_or3_b32 v7, v7, v72, v73
v_or3_b32 v7, v7, v80, v81
v_or3_b32 v7, v7, v88, v89
v_or3_b32 v7, v7, v66, v67
v_or3_b32 v7, v7, v74, v75
v_or3_b32 v7, v7, v82, v83
v_or3_b32 v7, v7, v90, v91
s_waitcnt lgkmcnt(4)
s_cmp_eq_u32 s34, 0
s_cbranch_scc1 L_k2_wlast
s_branch L_k2_wloop
L_k2_mk_wo:
v_cmp_gt_i32 s[56:57], 0, v5
v_cmp_gt_i32 s[58:59], 1, v5
v_cmp_gt_i32 s[60:61], 2, v5
v_cmp_gt_i32 s[62:63], 3, v5
s_nop 3
s_nop 0
v_cndmask_b32 v176, v176, v20, s[56:57]
v_cndmask_b32 v177, v177, v20, s[58:59]
v_cndmask_b32 v178, v178, v20, s[60:61]
v_cndmask_b32 v179, v179, v20, s[62:63]
v_cmp_gt_i32 s[56:57], 16, v5
v_cmp_gt_i32 s[58:59], 17, v5
v_cmp_gt_i32 s[60:61], 18, v5
v_cmp_gt_i32 s[62:63], 19, v5
v_cndmask_b32 v180, v180, v20, s[56:57]
v_cndmask_b32 v181, v181, v20, s[58:59]
v_cndmask_b32 v182, v182, v20, s[60:61]
v_cndmask_b32 v183, v183, v20, s[62:63]
v_cmp_gt_i32 s[56:57], 32, v5
v_cmp_gt_i32 s[58:59], 33, v5
v_cmp_gt_i32 s[60:61], 34, v5
v_cmp_gt_i32 s[62:63], 35, v5
v_cndmask_b32 v184, v184, v20, s[56:57]
v_cndmask_b32 v185, v185, v20, s[58:59]
v_cndmask_b32 v186, v186, v20, s[60:61]
v_cndmask_b32 v187, v187, v20, s[62:63]
v_cmp_gt_i32 s[56:57], 48, v5
v_cmp_gt_i32 s[58:59], 49, v5
v_cmp_gt_i32 s[60:61], 50, v5
v_cmp_gt_i32 s[62:63], 51, v5
v_cndmask_b32 v188, v188, v20, s[56:57]
v_cndmask_b32 v189, v189, v20, s[58:59]
v_cndmask_b32 v190, v190, v20, s[60:61]
v_cndmask_b32 v191, v191, v20, s[62:63]
s_branch L_k2_mkr_wo
L_k2_mk_tr:
v_cmp_gt_i32 s[56:57], 0, v5
v_cmp_gt_i32 s[58:59], 1, v5
v_cmp_gt_i32 s[60:61], 2, v5
v_cmp_gt_i32 s[62:63], 3, v5
s_nop 3
v_cndmask_b32 v144, v144, v20, s[56:57]
v_cndmask_b32 v145, v145, v20, s[58:59]
v_cndmask_b32 v146, v146, v20, s[60:61]
v_cndmask_b32 v147, v147, v20, s[62:63]
v_cmp_gt_i32 s[56:57], 16, v5
v_cmp_gt_i32 s[58:59], 17, v5
v_cmp_gt_i32 s[60:61], 18, v5
v_cmp_gt_i32 s[62:63], 19, v5
v_cndmask_b32 v148, v148, v20, s[56:57]
v_cndmask_b32 v149, v149, v20, s[58:59]
v_cndmask_b32 v150, v150, v20, s[60:61]
v_cndmask_b32 v151, v151, v20, s[62:63]
v_cmp_gt_i32 s[56:57], 32, v5
v_cmp_gt_i32 s[58:59], 33, v5
v_cmp_gt_i32 s[60:61], 34, v5
v_cmp_gt_i32 s[62:63], 35, v5
v_cndmask_b32 v152, v152, v20, s[56:57]
v_cndmask_b32 v153, v153, v20, s[58:59]
v_cndmask_b32 v154, v154, v20, s[60:61]
v_cndmask_b32 v155, v155, v20, s[62:63]
v_cmp_gt_i32 s[56:57], 48, v5
v_cmp_gt_i32 s[58:59], 49, v5
v_cmp_gt_i32 s[60:61], 50, v5
v_cmp_gt_i32 s[62:63], 51, v5
v_cndmask_b32 v156, v156, v20, s[56:57]
v_cndmask_b32 v157, v157, v20, s[58:59]
v_cndmask_b32 v158, v158, v20, s[60:61]
v_cndmask_b32 v159, v159, v20, s[62:63]
s_branch L_k2_mkr_tr
L_k2_mk_no:
v_cmp_gt_i32 s[56:57], 0, v5
v_cmp_gt_i32 s[58:59], 1, v5
v_cmp_gt_i32 s[60:61], 2, v5
v_cmp_gt_i32 s[62:63], 3, v5
s_nop 3
v_cndmask_b32 v144, v144, v20, s[56:57]
v_cndmask_b32 v145, v145, v20, s[58:59]
v_cndmask_b32 v146, v146, v20, s[60:61]
v_cndmask_b32 v147, v147, v20, s[62:63]
v_cmp_gt_i32 s[56:57], 16, v5
v_cmp_gt_i32 s[58:59], 17, v5
v_cmp_gt_i32 s[60:61], 18, v5
v_cmp_gt_i32 s[62:63], 19, v5
v_cndmask_b32 v148, v148, v20, s[56:57]
v_cndmask_b32 v149, v149, v20, s[58:59]
v_cndmask_b32 v150, v150, v20, s[60:61]
v_cndmask_b32 v151, v151, v20, s[62:63]
v_cmp_gt_i32 s[56:57], 32, v5
v_cmp_gt_i32 s[58:59], 33, v5
v_cmp_gt_i32 s[60:61], 34, v5
v_cmp_gt_i32 s[62:63], 35, v5
v_cndmask_b32 v152, v152, v20, s[56:57]
v_cndmask_b32 v153, v153, v20, s[58:59]
v_cndmask_b32 v154, v154, v20, s[60:61]
v_cndmask_b32 v155, v155, v20, s[62:63]
v_cmp_gt_i32 s[56:57], 48, v5
v_cmp_gt_i32 s[58:59], 49, v5
v_cmp_gt_i32 s[60:61], 50, v5
v_cmp_gt_i32 s[62:63], 51, v5
v_cndmask_b32 v156, v156, v20, s[56:57]
v_cndmask_b32 v157, v157, v20, s[58:59]
v_cndmask_b32 v158, v158, v20, s[60:61]
v_cndmask_b32 v159, v159, v20, s[62:63]
s_branch L_k2_mkr_no
L_pubB:
v_mov_b32 v24, 1
v_mov_b32 v25, 0
s_mov_b64 exec, 1
buffer_store_dword v24, v25, s[20:23], s64 offen sc1
s_mov_b64 exec, -1
s_branch L_pubBr
L_k2_wloop:
v_xor_b32 v2, 65536, v2
v_xor_b32 v3, 65536, v3
Cvaa 192,192,128,32
s_mov_b32 m0, s53
Ra 224,2,40960
v_lshl_add_u64 v[28:29], s[40:41], 0, v[28:29]
Mvaa 192,196,132
buffer_load_dwordx4 v4, s[12:15], s38 offen offset:0 sc1 lds
Mvaa 192,200,136
Ve 8,136
Mvaa 192,204,140
VE 9,137
Cvaa 208,192,144,36
Ra 228,2,41984
Vc 68,8,9
Mvaa 208,196,148
VE 10,138
Mvaa 208,200,152
VE 11,139
Mvaa 208,204,156
Ra 232,2,43008
Vc 69,10,11
Cvaa 224,192,160,40
Ra 236,2,44032
v_or3_b32 v7, v7, v68, v69
Mvaa 224,196,164
VE 12,152
Mvaa 224,200,168
VE 13,153
Mvaa 224,204,172
Ra 240,2,45056
Vc 76,12,13
Cvaa 240,192,176,44
VE 14,154
Mvaa 240,196,180
VE 15,155
Mvaa 240,200,184
Ra 244,2,46080
Vc 77,14,15
Mvaa 240,204,188
s_waitcnt lgkmcnt(6)
Ra 248,2,47104
v_or3_b32 v7, v7, v76, v77
Cvaa 196,208,128,32
buffer_load_dwordx4 v4, s[12:15], s38 offen offset:1024 sc1 lds
Mvaa 196,212,132
Ve 8,168
Mvaa 196,216,136
VE 9,169
Mvaa 196,220,140
Ra 252,2,48128
Vc 84,8,9
Cvaa 212,208,144,36
VE 10,170
Mvaa 212,212,148
VE 11,171
Mvaa 212,216,152
Ra 192,2,16384
Vc 85,10,11
Mvaa 212,220,156
Ra 196,2,24576
v_or3_b32 v7, v7, v84, v85
Cvaa 228,208,160,40
VE 12,184
Mvaa 228,212,164
VE 13,185
Mvaa 228,216,168
Ra 200,2,17408
Vc 92,12,13
Mvaa 228,220,172
VE 14,186
Cvaa 244,208,176,44
VE 15,187
Mvaa 244,212,180
buffer_load_dwordx4 v4, s[12:15], s38 offen offset:2048 sc1 lds
Mvaa 244,216,184
Ra 204,2,25600
Vc 93,14,15
Mvaa 244,220,188
s_waitcnt lgkmcnt(8)
Ve 8,140
Cvaa 200,224,128,32
Ra 208,2,18432
v_or3_b32 v7, v7, v92, v93
Mvaa 200,228,132
VE 9,141
Mvaa 200,232,136
Ra 212,2,26624
Vc 70,8,9
Mvaa 200,236,140
VE 10,142
Cvaa 216,224,144,36
VE 11,143
Mvaa 216,228,148
Ra 216,2,19456
Vc 71,10,11
Mvaa 216,232,152
Ra 220,2,27648
v_or3_b32 v7, v7, v70, v71
Mvaa 216,236,156
VE 12,156
Cvaa 232,224,160,40
VE 13,157
Mvaa 232,228,164
VE 14,158
Mvaa 232,232,168
VE 15,159
Mvaa 232,236,172
buffer_load_dwordx4 v4, s[12:15], s38 offen offset:3072 sc1 lds
Cvaa 248,224,176,44
VE 8,172
Mvaa 248,228,180
VE 9,173
Mvaa 248,232,184
Vc 78,12,13
Vc 79,14,15
Mvaa 248,236,188
s_waitcnt lgkmcnt(8)
Ve 10,174
Cvaa 204,240,128,32
VE 11,175
Mvaa 204,244,132
Vc 86,8,9
Vc 87,10,11
Mvaa 204,248,136
VE 12,188
Mvaa 204,252,140
VE 13,189
Cvaa 220,240,144,36
Vc 94,12,13
v_or3_b32 v7, v7, v78, v79
Mvaa 220,244,148
VE 14,190
Mvaa 220,248,152
VE 15,191
Mvaa 220,252,156
Vc 95,14,15
v_or3_b32 v7, v7, v86, v87
Cvaa 236,240,160,40
v_or3_b32 v7, v7, v94, v95
v_and_b32 v1, 0x40004000, v7
Mvaa 236,244,164
v_cmp_ne_u32 vcc, 0, v1
Mvaa 236,248,168
Mvaa 236,252,172
s_waitcnt vmcnt(12)
Cvaa 252,240,176,44
Mvaa 252,244,180
s_barrier
Mvaa 252,248,184
s_waitcnt lgkmcnt(4)
Mvaa 252,252,188
s_cbranch_vccnz L_k2_fb_we
L_k2_fbr_we:
Maav 0,192,64
Ve 8,192
Maav 0,196,68
s_add_u32 m0, s54, 49152
VE 9,193
Maav 32,192,72
buffer_load_dwordx4 v4, s[12:15], s39 offen offset:0 sc1 lds
Maav 32,196,76
s_add_u32 s37, s37, 1
Ra 224,2,20480
Vc 96,8,9
Maav 64,192,80
s_add_u32 s38, s38, 34816
Ve 10,194
Maav 64,196,84
VE 11,195
Maav 96,192,88
Ra 228,2,28672
Vc 97,10,11
Maav 96,196,92
Ra 232,2,21504
v_or_b32_e64 v7, v96, v97
Maav 4,200,64
VE 12,208
Maav 4,204,68
VE 13,209
Maav 36,200,72
Ra 236,2,29696
Vc 104,12,13
Maav 36,204,76
VE 14,210
Maav 68,200,80
VE 15,211
Maav 68,204,84
Ra 240,2,22528
Vc 105,14,15
Maav 100,200,88
Ra 244,2,30720
v_or3_b32 v7, v7, v104, v105
Maav 100,204,92
buffer_load_dwordx4 v4, s[12:15], s39 offen offset:1024 sc1 lds
Mvvv 48,16,64
VE 8,224
Mvvv 48,16,68
s_waitcnt lgkmcnt(6)
Ve 9,225
Maav 8,208,64
Ra 248,2,23552
Vc 112,8,9
Maav 8,212,68
VE 10,226
Maav 40,208,72
VE 11,227
Maav 40,212,76
Ra 252,2,31744
Vc 113,10,11
Maav 72,208,80
Ra 192,3,0
v_or3_b32 v7, v7, v112, v113
Maav 72,212,84
VE 12,240
Maav 104,208,88
VE 13,241
Maav 104,212,92
Ra 196,3,1024
Vc 120,12,13
Maav 12,216,64
VE 14,242
Maav 12,220,68
VE 15,243
Maav 44,216,72
Ra 200,3,2048
Vc 121,14,15
Maav 44,220,76
buffer_load_dwordx4 v4, s[12:15], s39 offen offset:2048 sc1 lds
Maav 76,216,80
Ra 204,3,3072
v_or3_b32 v7, v7, v120, v121
Maav 76,220,84
VE 8,196
Maav 108,216,88
VE 9,197
Maav 108,220,92
VE 10,198
Mvvv 52,16,72
VE 11,199
Mvvv 52,16,76
s_waitcnt lgkmcnt(8)
Ve 12,212
Maav 16,224,64
Ra 208,3,4096
Vc 98,8,9
Maav 16,228,68
Ra 212,3,5120
Vc 99,10,11
Maav 48,224,72
Ra 216,3,6144
v_or3_b32 v7, v7, v98, v99
Maav 48,228,76
VE 13,213
Maav 80,224,80
Ra 220,3,7168
Vc 106,12,13
Maav 80,228,84
VE 14,214
Maav 112,224,88
buffer_load_dwordx4 v4, s[12:15], s39 offen offset:3072 sc1 lds
Maav 112,228,92
s_add_u32 s39, s39, 34816
VE 15,215
Maav 20,232,64
VE 8,228
Maav 20,236,68
VE 9,229
Maav 52,232,72
VE 10,230
Maav 52,236,76
VE 11,231
Maav 84,232,80
Vc 107,14,15
Vc 114,8,9
Maav 84,236,84
VE 12,244
Maav 116,232,88
VE 13,245
Maav 116,236,92
Vc 115,10,11
Vc 122,12,13
Mvvv 56,16,80
VE 14,246
Mvvv 56,16,84
s_waitcnt lgkmcnt(8)
Ve 15,247
Maav 24,240,64
Vc 123,14,15
v_or3_b32 v7, v7, v106, v107
Maav 24,244,68
v_or3_b32 v7, v7, v114, v115
v_or3_b32 v7, v7, v122, v123
Maav 56,240,72
global_load_dword v30, v[28:29], off
Maav 56,244,76
Maav 88,240,80
Maav 88,244,84
Maav 120,240,88
Maav 120,244,92
Maav 28,248,64
Maav 28,252,68
Maav 60,248,72
Maav 60,252,76
Maav 92,248,80
Maav 92,252,84
Maav 124,248,88
Maav 124,252,92
Mvvv 60,16,88
s_waitcnt lgkmcnt(4)
Mvvv 60,16,92
Ve 8,200
Cvaa 128,192,128,32
s_add_u32 m0, s53, 32768
Ra 224,3,8192
v_lshl_add_u64 v[28:29], s[40:41], 0, v[28:29]
Mvaa 128,196,132
buffer_load_dwordx4 v4, s[12:15], s38 offen offset:0 sc1 lds
Mvaa 128,200,136
VE 9,201
Mvaa 128,204,140
Ra 228,3,9216
Vc 100,8,9
Cvaa 144,192,144,36
VE 10,202
Mvaa 144,196,148
VE 11,203
Mvaa 144,200,152
Ra 232,3,10240
Vc 101,10,11
Mvaa 144,204,156
Ra 236,3,11264
v_or3_b32 v7, v7, v100, v101
Cvaa 160,192,160,40
VE 12,216
Mvaa 160,196,164
VE 13,217
Mvaa 160,200,168
Ra 240,3,12288
Vc 108,12,13
Mvaa 160,204,172
VE 14,218
Cvaa 176,192,176,44
VE 15,219
Mvaa 176,196,180
Ra 244,3,13312
Vc 109,14,15
Mvaa 176,200,184
Ra 248,3,14336
v_or3_b32 v7, v7, v108, v109
Mvaa 176,204,188
s_waitcnt lgkmcnt(7)
Ve 8,232
Cvaa 132,208,128,32
buffer_load_dwordx4 v4, s[12:15], s38 offen offset:1024 sc1 lds
Mvaa 132,212,132
VE 9,233
Mvaa 132,216,136
Ra 252,3,15360
Vc 116,8,9
Mvaa 132,220,140
VE 10,234
Cvaa 148,208,144,36
VE 11,235
Mvaa 148,212,148
Ra 192,2,49152
Vc 117,10,11
Mvaa 148,216,152
Ra 196,2,57344
v_or3_b32 v7, v7, v116, v117
Mvaa 148,220,156
VE 12,248
Cvaa 164,208,160,40
VE 13,249
Mvaa 164,212,164
Ra 200,2,50176
Vc 124,12,13
Mvaa 164,216,168
VE 14,250
Mvaa 164,220,172
VE 15,251
Cvaa 180,208,176,44
Ra 204,2,58368
Vc 125,14,15
Mvaa 180,212,180
buffer_load_dwordx4 v4, s[12:15], s38 offen offset:2048 sc1 lds
Mvaa 180,216,184
VE 8,204
Mvaa 180,220,188
s_waitcnt lgkmcnt(8)
Ve 9,205
Cvaa 136,224,128,32
Ra 208,2,51200
Vc 102,8,9
Mvaa 136,228,132
Ra 212,2,59392
v_or3_b32 v7, v7, v124, v125
Mvaa 136,232,136
VE 10,206
Mvaa 136,236,140
VE 11,207
Cvaa 152,224,144,36
Ra 216,2,52224
Vc 103,10,11
Mvaa 152,228,148
Ra 220,2,60416
v_or3_b32 v7, v7, v102, v103
Mvaa 152,232,152
VE 12,220
Mvaa 152,236,156
VE 13,221
Cvaa 168,224,160,40
VE 14,222
Mvaa 168,228,164
VE 15,223
Mvaa 168,232,168
VE 8,236
Mvaa 168,236,172
buffer_load_dwordx4 v4, s[12:15], s38 offen offset:3072 sc1 lds
Cvaa 184,224,176,44
VE 9,237
Mvaa 184,228,180
Vc 110,12,13
Vc 111,14,15
Mvaa 184,232,184
VE 10,238
Mvaa 184,236,188
s_waitcnt lgkmcnt(8)
Ve 11,239
Cvaa 140,240,128,32
Vc 118,8,9
Vc 119,10,11
Mvaa 140,244,132
VE 12,252
Mvaa 140,248,136
VE 13,253
Mvaa 140,252,140
Vc 126,12,13
v_or3_b32 v7, v7, v110, v111
Cvaa 156,240,144,36
VE 14,254
Mvaa 156,244,148
VE 15,255
Mvaa 156,248,152
Vc 127,14,15
v_or3_b32 v7, v7, v118, v119
Mvaa 156,252,156
v_or3_b32 v7, v7, v126, v127
v_and_b32 v1, 0x40004000, v7
Cvaa 172,240,160,40
v_cmp_ne_u32 vcc, 0, v1
Mvaa 172,244,164
Mvaa 172,248,168
Mvaa 172,252,172
s_waitcnt vmcnt(12)
Cvaa 188,240,176,44
s_cmp_eq_u32 s37, s46
Mvaa 188,244,180
s_barrier
Mvaa 188,248,184
s_waitcnt lgkmcnt(4)
Mvaa 188,252,188
s_cbranch_vccnz L_k2_fb_wo
L_k2_fbr_wo:
Maav 0,192,96
s_cbranch_scc1 L_k2_mk_wo
L_k2_mkr_wo:
Ve 8,128
Maav 0,196,100
s_add_u32 m0, s53, 16384
VE 9,129
Maav 32,192,104
buffer_load_dwordx4 v4, s[12:15], s39 offen offset:0 sc1 lds
Maav 32,196,108
s_add_u32 s37, s37, 1
Ra 224,2,53248
Vc 64,8,9
Maav 64,192,112
s_add_u32 s38, s38, 34816
Ve 10,130
Maav 64,196,116
s_xor_b32 s53, s53, 65536
VE 11,131
Maav 96,192,120
s_xor_b32 s54, s54, 65536
Ra 228,2,61440
Vc 65,10,11
Maav 96,196,124
Ra 232,2,54272
v_or_b32_e64 v7, v64, v65
Maav 4,200,96
VE 12,144
Maav 4,204,100
VE 13,145
Maav 36,200,104
Ra 236,2,62464
Vc 72,12,13
Maav 36,204,108
VE 14,146
Maav 68,200,112
VE 15,147
Maav 68,204,116
Ra 240,2,55296
Vc 73,14,15
Maav 100,200,120
Ra 244,2,63488
v_or3_b32 v7, v7, v72, v73
Maav 100,204,124
buffer_load_dwordx4 v4, s[12:15], s39 offen offset:1024 sc1 lds
Mvvv 48,16,96
VE 8,160
Mvvv 48,16,100
s_waitcnt lgkmcnt(6)
Ve 9,161
Maav 8,208,96
Ra 248,2,56320
Vc 80,8,9
Maav 8,212,100
VE 10,162
Maav 40,208,104
VE 11,163
Maav 40,212,108
Ra 252,2,64512
Vc 81,10,11
Maav 72,208,112
Ra 192,3,32768
v_or3_b32 v7, v7, v80, v81
Maav 72,212,116
VE 12,176
Maav 104,208,120
VE 13,177
Maav 104,212,124
Ra 196,3,33792
Vc 88,12,13
Maav 12,216,96
VE 14,178
Maav 12,220,100
VE 15,179
Maav 44,216,104
Ra 200,3,34816
Vc 89,14,15
Maav 44,220,108
buffer_load_dwordx4 v4, s[12:15], s39 offen offset:2048 sc1 lds
Maav 76,216,112
Ra 204,3,35840
v_or3_b32 v7, v7, v88, v89
Maav 76,220,116
VE 8,132
Maav 108,216,120
VE 9,133
Maav 108,220,124
VE 10,134
Mvvv 52,16,104
VE 11,135
Mvvv 52,16,108
s_waitcnt lgkmcnt(8)
Ve 12,148
Maav 16,224,96
Ra 208,3,36864
Vc 66,8,9
Maav 16,228,100
Ra 212,3,37888
Vc 67,10,11
Maav 48,224,104
Ra 216,3,38912
v_or3_b32 v7, v7, v66, v67
Maav 48,228,108
VE 13,149
Maav 80,224,112
Ra 220,3,39936
Vc 74,12,13
Maav 80,228,116
VE 14,150
Maav 112,224,120
buffer_load_dwordx4 v4, s[12:15], s39 offen offset:3072 sc1 lds
Maav 112,228,124
s_add_u32 s39, s39, 34816
VE 15,151
Maav 20,232,96
VE 8,164
Maav 20,236,100
VE 9,165
Maav 52,232,104
VE 10,166
Maav 52,236,108
VE 11,167
Maav 84,232,112
Vc 75,14,15
Vc 82,8,9
Maav 84,236,116
VE 12,180
Maav 116,232,120
VE 13,181
Maav 116,236,124
Vc 83,10,11
Vc 90,12,13
Mvvv 56,16,112
VE 14,182
Mvvv 56,16,116
s_waitcnt lgkmcnt(8)
Ve 15,183
Maav 24,240,96
Vc 91,14,15
v_or3_b32 v7, v7, v74, v75
Maav 24,244,100
v_or3_b32 v7, v7, v82, v83
v_or3_b32 v7, v7, v90, v91
Maav 56,240,104
global_load_dword v30, v[28:29], off
Maav 56,244,108
Maav 88,240,112
Maav 88,244,116
Maav 120,240,120
Maav 120,244,124
Maav 28,248,96
Maav 28,252,100
Maav 60,248,104
Maav 60,252,108
Maav 92,248,112
Maav 92,252,116
Maav 124,248,120
Maav 124,252,124
s_cmp_lg_u32 s37, s35
Mvvv 60,16,120
s_waitcnt lgkmcnt(4)
Mvvv 60,16,124
s_cbranch_scc1 L_k2_wloop
L_k2_wlast:
v_xor_b32 v2, 65536, v2
v_xor_b32 v3, 65536, v3
Cvaa 192,192,128,32
s_mov_b32 m0, s53
Ra 224,2,40960
v_lshl_add_u64 v[28:29], s[40:41], 0, v[28:29]
Mvaa 192,196,132
buffer_load_dwordx4 v4, s[12:15], s38 offen offset:0 sc1 lds
Mvaa 192,200,136
VE 8,136
Mvaa 192,204,140
VE 9,137
Cvaa 208,192,144,36
Ra 228,2,41984
Vc 68,8,9
Mvaa 208,196,148
VE 10,138
Mvaa 208,200,152
VE 11,139
Mvaa 208,204,156
Ra 232,2,43008
Vc 69,10,11
Cvaa 224,192,160,40
Ra 236,2,44032
v_or3_b32 v7, v7, v68, v69
Mvaa 224,196,164
VE 12,152
Mvaa 224,200,168
VE 13,153
Mvaa 224,204,172
s_waitcnt lgkmcnt(4)
Ra 240,2,45056
Vc 76,12,13
Cvaa 196,208,128,32
buffer_load_dwordx4 v4, s[12:15], s38 offen offset:1024 sc1 lds
Mvaa 196,212,132
Ve 14,154
Mvaa 196,216,136
VE 15,155
Mvaa 196,220,140
Ra 244,2,46080
Vc 77,14,15
Cvaa 212,208,144,36
Ra 248,2,47104
v_or3_b32 v7, v7, v76, v77
Mvaa 212,212,148
VE 8,168
Mvaa 212,216,152
VE 9,169
Mvaa 212,220,156
Ra 252,2,48128
Vc 84,8,9
Cvaa 228,208,160,40
VE 10,170
Mvaa 228,212,164
buffer_load_dwordx4 v4, s[12:15], s38 offen offset:2048 sc1 lds
Mvaa 228,216,168
VE 11,171
Mvaa 228,220,172
s_waitcnt lgkmcnt(4)
Ra 192,2,16384
Vc 85,10,11
Cvaa 200,224,128,32
Ra 196,2,24576
v_or3_b32 v7, v7, v84, v85
Mvaa 200,228,132
Ve 12,184
Mvaa 200,232,136
VE 13,185
Mvaa 200,236,140
Ra 200,2,17408
Vc 92,12,13
Cvaa 216,224,144,36
VE 14,186
Mvaa 216,228,148
VE 15,187
Mvaa 216,232,152
Ra 204,2,25600
Vc 93,14,15
Mvaa 216,236,156
buffer_load_dwordx4 v4, s[12:15], s38 offen offset:3072 sc1 lds
Cvaa 232,224,160,40
Ra 208,2,18432
v_or3_b32 v7, v7, v92, v93
Mvaa 232,228,164
VE 8,140
Mvaa 232,232,168
VE 9,141
Mvaa 232,236,172
s_waitcnt lgkmcnt(5)
Ra 212,2,26624
Vc 70,8,9
Cvaa 204,240,128,32
Ve 10,142
Mvaa 204,244,132
VE 11,143
Mvaa 204,248,136
Ra 216,2,19456
Vc 71,10,11
Mvaa 204,252,140
Ra 220,2,27648
v_or3_b32 v7, v7, v70, v71
Cvaa 220,240,144,36
VE 12,156
Mvaa 220,244,148
VE 13,157
Mvaa 220,248,152
VE 14,158
Mvaa 220,252,156
s_waitcnt vmcnt(12)
Ve 15,159
Cvaa 236,240,160,40
VE 8,172
Mvaa 236,244,164
s_barrier
Ve 9,173
Mvaa 236,248,168
s_waitcnt lgkmcnt(4)
Vc 78,12,13
Vc 79,14,15
Ve 10,174
Ve 11,175
Ve 12,188
Ve 13,189
Ve 14,190
VE 15,191
Vc 86,8,9
Vc 87,10,11
Vc 94,12,13
Vc 95,14,15
v_or3_b32 v7, v7, v78, v79
v_or3_b32 v7, v7, v86, v87
v_or3_b32 v7, v7, v94, v95
v_and_b32 v1, 0x40004000, v7
v_cmp_ne_u32 vcc, 0, v1
Mvaa 236,252,172
s_cbranch_vccnz L_k2_fb_wl
L_k2_fbr_wl:
Maav 0,192,64
v_cmp_gt_i32 s[56:57], 0, v6
v_cmp_gt_i32 s[58:59], 1, v6
v_cmp_gt_i32 s[60:61], 2, v6
v_cmp_gt_i32 s[62:63], 3, v6
s_nop 3
s_nop 0
v_cndmask_b32 v224, v224, v20, s[56:57]
v_cndmask_b32 v225, v225, v20, s[58:59]
v_cndmask_b32 v226, v226, v20, s[60:61]
v_cndmask_b32 v227, v227, v20, s[62:63]
v_cmp_gt_i32 s[56:57], 16, v6
v_cmp_gt_i32 s[58:59], 17, v6
v_cmp_gt_i32 s[60:61], 18, v6
v_cmp_gt_i32 s[62:63], 19, v6
v_cndmask_b32 v228, v228, v20, s[56:57]
v_cndmask_b32 v229, v229, v20, s[58:59]
v_cndmask_b32 v230, v230, v20, s[60:61]
v_cndmask_b32 v231, v231, v20, s[62:63]
v_cmp_gt_i32 s[56:57], 32, v6
v_cmp_gt_i32 s[58:59], 33, v6
v_cmp_gt_i32 s[60:61], 34, v6
v_cmp_gt_i32 s[62:63], 35, v6
v_cndmask_b32 v232, v232, v20, s[56:57]
v_cndmask_b32 v233, v233, v20, s[58:59]
v_cndmask_b32 v234, v234, v20, s[60:61]
v_cndmask_b32 v235, v235, v20, s[62:63]
v_cmp_gt_i32 s[56:57], 48, v6
v_cmp_gt_i32 s[58:59], 49, v6
v_cmp_gt_i32 s[60:61], 50, v6
v_cmp_gt_i32 s[62:63], 51, v6
v_cndmask_b32 v236, v236, v20, s[56:57]
v_cndmask_b32 v237, v237, v20, s[58:59]
v_cndmask_b32 v238, v238, v20, s[60:61]
v_cndmask_b32 v239, v239, v20, s[62:63]
VE 8,192
Maav 0,196,68
s_add_u32 m0, s54, 49152
VE 9,193
Maav 32,192,72
buffer_load_dwordx4 v4, s[12:15], s39 offen offset:0 sc1 lds
Maav 32,196,76
s_add_u32 s37, s37, 1
Ra 224,2,20480
Vc 96,8,9
Maav 64,192,80
s_add_u32 s38, s38, 34816
Ve 10,194
Maav 64,196,84
VE 11,195
Maav 96,192,88
Ra 228,2,28672
Vc 97,10,11
Maav 96,196,92
Ra 232,2,21504
v_or_b32_e64 v7, v96, v97
Maav 4,200,64
VE 12,208
Maav 4,204,68
VE 13,209
Maav 36,200,72
Ra 236,2,29696
Vc 104,12,13
Maav 36,204,76
VE 14,210
Maav 68,200,80
VE 15,211
Maav 68,204,84
Ra 240,2,22528
Vc 105,14,15
Maav 100,200,88
Ra 244,2,30720
v_or3_b32 v7, v7, v104, v105
Maav 100,204,92
buffer_load_dwordx4 v4, s[12:15], s39 offen offset:1024 sc1 lds
Mvvv 48,16,64
VE 8,224
Mvvv 48,16,68
s_waitcnt lgkmcnt(6)
Ve 9,225
Maav 8,208,64
Ra 248,2,23552
Vc 112,8,9
Maav 8,212,68
VE 10,226
Maav 40,208,72
VE 11,227
Maav 40,212,76
Ra 252,2,31744
Vc 113,10,11
Maav 72,208,80
Ra 192,3,0
v_or3_b32 v7, v7, v112, v113
Maav 72,212,84
VE 12,196
Maav 104,208,88
VE 13,197
Maav 104,212,92
Ra 196,3,1024
Vc 98,12,13
Maav 12,216,64
VE 14,198
Maav 12,220,68
VE 15,199
Maav 44,216,72
Ra 200,3,2048
Vc 99,14,15
Maav 44,220,76
buffer_load_dwordx4 v4, s[12:15], s39 offen offset:2048 sc1 lds
Maav 76,216,80
Ra 204,3,3072
v_or3_b32 v7, v7, v98, v99
Maav 76,220,84
VE 8,212
Maav 108,216,88
VE 9,213
Maav 108,220,92
VE 10,214
Mvvv 52,16,72
VE 11,215
Mvvv 52,16,76
s_waitcnt lgkmcnt(8)
Ve 12,228
Maav 16,224,64
Ra 208,3,4096
Vc 106,8,9
Maav 16,228,68
Ra 212,3,5120
Vc 107,10,11
Maav 48,224,72
Ra 216,3,6144
v_or3_b32 v7, v7, v106, v107
Maav 48,228,76
VE 13,229
Maav 80,224,80
Ra 220,3,7168
Vc 114,12,13
Maav 80,228,84
VE 14,230
Maav 112,224,88
buffer_load_dwordx4 v4, s[12:15], s39 offen offset:3072 sc1 lds
Maav 112,228,92
s_add_u32 s39, s39, 34816
VE 15,231
Maav 20,232,64
VE 8,200
Maav 20,236,68
VE 9,201
Maav 52,232,72
VE 10,202
Maav 52,236,76
VE 11,203
Maav 84,232,80
Vc 115,14,15
Vc 100,8,9
Maav 84,236,84
VE 12,216
Maav 116,232,88
VE 13,217
Maav 116,236,92
Vc 101,10,11
Vc 108,12,13
Mvvv 56,16,80
VE 14,218
Mvvv 56,16,84
s_waitcnt lgkmcnt(8)
Ve 15,219
Maav 24,240,64
Vc 109,14,15
v_or3_b32 v7, v7, v114, v115
Maav 24,244,68
VE 8,232
Maav 56,240,72
global_load_dword v30, v[28:29], off
Maav 56,244,76
VE 9,233
Maav 88,240,80
Vc 116,8,9
v_or3_b32 v7, v7, v100, v101
Maav 88,244,84
VE 10,234
Maav 120,240,88
VE 11,235
Maav 120,244,92
Vc 117,10,11
v_or3_b32 v7, v7, v108, v109
Maav 28,248,64
v_or3_b32 v7, v7, v116, v117
Maav 28,252,68
Maav 60,248,72
Maav 60,252,76
Maav 92,248,80
Maav 92,252,84
Maav 124,248,88
Maav 124,252,92
Mvvv 60,16,88
s_waitcnt lgkmcnt(4)
Mvvv 60,16,92
Ve 12,204
Cvaa 128,192,128,32
s_add_u32 m0, s53, 32768
VE 13,205
Mvaa 128,196,132
buffer_load_dwordx4 v4, s[12:15], s38 offen offset:0 sc1 lds
Mvaa 128,200,136
Ra 224,3,8192
Vc 102,12,13
Mvaa 128,204,140
VE 14,206
Cvaa 144,192,144,36
VE 15,207
Mvaa 144,196,148
Ra 228,3,9216
Vc 103,14,15
Mvaa 144,200,152
Ra 232,3,10240
v_or3_b32 v7, v7, v102, v103
Mvaa 144,204,156
s_waitcnt lgkmcnt(3)
Ra 236,3,11264
Ra 240,3,12288
Cvaa 132,208,128,32
buffer_load_dwordx4 v4, s[12:15], s38 offen offset:1024 sc1 lds
Mvaa 132,212,132
Ve 8,220
Mvaa 132,216,136
VE 9,221
Mvaa 132,220,140
Ra 244,3,13312
Vc 110,8,9
Cvaa 148,208,144,36
VE 10,222
Mvaa 148,212,148
buffer_load_dwordx4 v4, s[12:15], s38 offen offset:2048 sc1 lds
Mvaa 148,216,152
VE 11,223
Mvaa 148,220,156
s_waitcnt lgkmcnt(2)
Ra 248,3,14336
Ra 252,3,15360
Cvaa 136,224,128,32
Ra 192,2,49152
Vc 111,10,11
Mvaa 136,228,132
Ra 196,2,57344
v_or3_b32 v7, v7, v110, v111
Mvaa 136,232,136
Ve 12,236
Mvaa 136,236,140
buffer_load_dwordx4 v4, s[12:15], s38 offen offset:3072 sc1 lds
Cvaa 152,224,144,36
VE 13,237
Mvaa 152,228,148
Ra 200,2,50176
Vc 118,12,13
Mvaa 152,232,152
VE 14,238
Mvaa 152,236,156
s_waitcnt lgkmcnt(3)
Ra 204,2,58368
Ra 208,2,51200
Cvaa 140,240,128,32
Ve 15,239
Mvaa 140,244,132
Ra 212,2,59392
Vc 119,14,15
Mvaa 140,248,136
Ra 216,2,52224
v_or3_b32 v7, v7, v118, v119
Mvaa 140,252,140
s_waitcnt vmcnt(12)
Ra 220,2,60416
v_and_b32 v1, 0x40004000, v7
Cvaa 156,240,144,36
s_cmp_eq_u32 s37, s45
v_cmp_ne_u32 vcc, 0, v1
Mvaa 156,244,148
s_barrier
Mvaa 156,248,152
s_waitcnt lgkmcnt(4)
Mvaa 156,252,156
s_cbranch_vccnz L_k2_fb_tr
L_k2_fbr_tr:
Maav 0,192,96
s_cbranch_scc1 L_k2_mk_tr
L_k2_mkr_tr:
Ve 8,128
Maav 0,196,100
s_add_u32 m0, s53, 16384
VE 9,129
Maav 32,192,104
buffer_load_dwordx4 v4, s[12:15], s39 offen offset:0 sc1 lds
Maav 32,196,108
s_add_u32 s37, s37, 1
Ra 224,2,53248
Vc 64,8,9
Maav 64,192,112
s_add_u32 s38, s38, 34816
Ve 10,130
Maav 64,196,116
s_xor_b32 s53, s53, 65536
VE 11,131
Maav 4,200,96
s_xor_b32 s54, s54, 65536
Ra 228,2,61440
Vc 65,10,11
Maav 4,204,100
Ra 232,2,54272
v_or_b32_e64 v7, v64, v65
Maav 36,200,104
VE 12,144
Maav 36,204,108
VE 13,145
Maav 68,200,112
Ra 236,2,62464
Vc 72,12,13
Maav 68,204,116
VE 14,146
Mvvv 48,16,96
VE 15,147
Mvvv 48,16,100
s_waitcnt lgkmcnt(4)
Ra 240,2,55296
Vc 73,14,15
Maav 8,208,96
buffer_load_dwordx4 v4, s[12:15], s39 offen offset:1024 sc1 lds
Maav 8,212,100
Ra 244,2,63488
v_or3_b32 v7, v7, v72, v73
Maav 40,208,104
Ve 8,132
Maav 40,212,108
VE 9,133
Maav 72,208,112
Ra 248,2,56320
Vc 66,8,9
Maav 72,212,116
VE 10,134
Maav 12,216,96
VE 11,135
Maav 12,220,100
Ra 252,2,64512
Vc 67,10,11
Maav 44,216,104
Ra 192,3,32768
v_or3_b32 v7, v7, v66, v67
Maav 44,220,108
VE 12,148
Maav 76,216,112
VE 13,149
Maav 76,220,116
Ra 196,3,33792
Vc 74,12,13
Mvvv 52,16,104
VE 14,150
Mvvv 52,16,108
s_waitcnt lgkmcnt(6)
Ve 15,151
Maav 16,224,96
buffer_load_dwordx4 v4, s[12:15], s39 offen offset:2048 sc1 lds
Maav 16,228,100
Ra 200,3,34816
Vc 75,14,15
Maav 48,224,104
Ra 204,3,35840
v_or3_b32 v7, v7, v74, v75
Maav 48,228,108
VE 8,136
Maav 80,224,112
Ra 208,3,36864
Ra 212,3,37888
Maav 80,228,116
Ra 216,3,38912
Ra 220,3,39936
Maav 20,232,96
Maav 20,236,100
Maav 52,232,104
Maav 52,236,108
Maav 84,232,112
Maav 84,236,116
buffer_load_dwordx4 v4, s[12:15], s39 offen offset:3072 sc1 lds
Mvvv 56,16,112
s_add_u32 s39, s39, 34816
Mvvv 56,16,116
s_waitcnt lgkmcnt(8)
Maav 24,240,96
Maav 24,244,100
Maav 56,240,104
Maav 56,244,108
Maav 88,240,112
Maav 88,244,116
Maav 28,248,96
Maav 28,252,100
Maav 60,248,104
Maav 60,252,108
Maav 92,248,112
s_waitcnt lgkmcnt(4)
Maav 92,252,116
s_getpc_b64 s[56:57]
L_cpf4:
s_add_u32 s56, s56, (L_k2_fin-L_cpf4)&0xffffffff
s_addc_u32 s57, s57, ((L_k2_fin-L_cpf4)>>32)&0xffffffff
s_lshr_b32 s58, s2, 3
s_lshl_b32 s58, s58, 2
s_add_u32 s58, s58, s32
s_lshl_b32 s58, s58, 10
v_and_b32 v162, 7, v0
v_lshlrev_b32 v162, 7, v162
v_add_u32 v162, s58, v162
v_min_u32 v162, L_p4_end-L_k2_fin-4, v162
v_mov_b32 v161, s57
v_add_co_u32 v160, vcc, s56, v162
s_nop 1
v_addc_co_u32 v161, vcc, 0, v161, vcc
global_load_dword v164, v[160:161], off
s_waitcnt vmcnt(9)
s_lshl_b32 s3, s34, 20
s_lshl_b32 s47, s33, 15
s_add_u32 s3, s3, s47
s_lshl_b32 s47, s32, 10
v_lshlrev_b32 v248, 4, v0
v_add_u32_e64 v249, s47, v248
s_sub_u32 s47, 7168, s47
v_add_u32 v248, s47, v248
v_rcp_f32 v250, v56
v_rcp_f32 v252, v60
v_mov_b32 v251, v250
v_mov_b32_e64 v253, v252
Ar 240,96
Ar 241,97
Ar 242,98
Ar 243,99
Ar 244,100
Ar 245,101
Ar 246,102
Ar 247,103
v_pk_mul_f32 v[240:241], v[240:241], v[252:253]
v_pk_mul_f32 v[242:243], v[242:243], v[252:253]
v_pk_mul_f32 v[244:245], v[244:245], v[252:253]
v_pk_mul_f32 v[246:247], v[246:247], v[252:253]
Vc 28,240,241
Vc 29,242,243
Vc 30,244,245
Vc 31,246,247
buffer_store_dwordx4 v[28:31], v249, s[16:19], s3 offen sc1
Ar 240,64
Ar 241,65
Ar 242,66
Ar 243,67
Ar 244,68
Ar 245,69
Ar 246,70
Ar 247,71
v_pk_mul_f32 v[240:241], v[240:241], v[250:251]
v_pk_mul_f32 v[242:243], v[242:243], v[250:251]
v_pk_mul_f32 v[244:245], v[244:245], v[250:251]
v_pk_mul_f32 v[246:247], v[246:247], v[250:251]
Vc 24,240,241
Vc 25,242,243
Vc 26,244,245
Vc 27,246,247
buffer_store_dwordx4 v[24:27], v248, s[16:19], s3 offen sc1
s_add_u32 s3, s3, 8192
Ar 240,104
Ar 241,105
Ar 242,106
Ar 243,107
Ar 244,108
Ar 245,109
Ar 246,110
Ar 247,111
v_pk_mul_f32 v[240:241], v[240:241], v[252:253]
v_pk_mul_f32 v[242:243], v[242:243], v[252:253]
v_pk_mul_f32 v[244:245], v[244:245], v[252:253]
v_pk_mul_f32 v[246:247], v[246:247], v[252:253]
Vc 28,240,241
Vc 29,242,243
Vc 30,244,245
Vc 31,246,247
buffer_store_dwordx4 v[28:31], v249, s[16:19], s3 offen sc1
Ar 240,72
Ar 241,73
Ar 242,74
Ar 243,75
Ar 244,76
Ar 245,77
Ar 246,78
Ar 247,79
v_pk_mul_f32 v[240:241], v[240:241], v[250:251]
v_pk_mul_f32 v[242:243], v[242:243], v[250:251]
v_pk_mul_f32 v[244:245], v[244:245], v[250:251]
v_pk_mul_f32 v[246:247], v[246:247], v[250:251]
Vc 24,240,241
Vc 25,242,243
Vc 26,244,245
Vc 27,246,247
buffer_store_dwordx4 v[24:27], v248, s[16:19], s3 offen sc1
s_add_u32 s3, s3, 8192
Ar 240,112
Ar 241,113
Ar 242,114
Ar 243,115
Ar 244,116
Ar 245,117
Ar 246,118
Ar 247,119
v_pk_mul_f32 v[240:241], v[240:241], v[252:253]
v_pk_mul_f32 v[242:243], v[242:243], v[252:253]
v_pk_mul_f32 v[244:245], v[244:245], v[252:253]
v_pk_mul_f32 v[246:247], v[246:247], v[252:253]
Vc 28,240,241
Vc 29,242,243
Vc 30,244,245
Vc 31,246,247
buffer_store_dwordx4 v[28:31], v249, s[16:19], s3 offen sc1
Ar 240,80
Ar 241,81
Ar 242,82
Ar 243,83
Ar 244,84
Ar 245,85
Ar 246,86
Ar 247,87
v_pk_mul_f32 v[240:241], v[240:241], v[250:251]
v_pk_mul_f32 v[242:243], v[242:243], v[250:251]
v_pk_mul_f32 v[244:245], v[244:245], v[250:251]
v_pk_mul_f32 v[246:247], v[246:247], v[250:251]
Vc 24,240,241
Vc 25,242,243
Vc 26,244,245
Vc 27,246,247
buffer_store_dwordx4 v[24:27], v248, s[16:19], s3 offen sc1
s_add_u32 s3, s3, 8192
Ar 240,120
Ar 241,121
Ar 242,122
Ar 243,123
Ar 244,124
Ar 245,125
Ar 246,126
Ar 247,127
v_pk_mul_f32 v[240:241], v[240:241], v[252:253]
v_pk_mul_f32 v[242:243], v[242:243], v[252:253]
v_pk_mul_f32 v[244:245], v[244:245], v[252:253]
v_pk_mul_f32 v[246:247], v[246:247], v[252:253]
Vc 28,240,241
Vc 29,242,243
Vc 30,244,245
Vc 31,246,247
buffer_store_dwordx4 v[28:31], v249, s[16:19], s3 offen sc1
Ar 240,88
Ar 241,89
Ar 242,90
Ar 243,91
Ar 244,92
Ar 245,93
Ar 246,94
Ar 247,95
v_pk_mul_f32 v[240:241], v[240:241], v[250:251]
v_pk_mul_f32 v[242:243], v[242:243], v[250:251]
v_pk_mul_f32 v[244:245], v[244:245], v[250:251]
v_pk_mul_f32 v[246:247], v[246:247], v[250:251]
Vc 24,240,241
Vc 25,242,243
Vc 26,244,245
Vc 27,246,247
buffer_store_dwordx4 v[24:27], v248, s[16:19], s3 offen sc1
s_add_u32 s52, s37, 2
s_load_dwordx2 s[94:95], s[0:1], 40
s_load_dwordx2 s[40:41], s[0:1], 0
s_load_dwordx4 s[8:11], s[0:1], 80
s_waitcnt vmcnt(8) lgkmcnt(0)
s_add_u32 s93, s2, 224
s_and_b32 s93, s93, 255
s_nop 0
s_mul_i32 s92, s93, 2341
s_lshr_b32 s92, s92, 16
s_mul_i32 s47, s92, 28
s_sub_u32 s4, s93, s47
s_mul_i32 s5, s92, 917504
s_lshl_b32 s47, s4, 8
s_add_u32 s5, s5, s47
s_cmp_ge_u32 s34, 1
s_cselect_b32 s5, s5, 8388608
s_cmp_eq_u32 s34, 7
s_cbranch_scc1 L_k2_fin
L_k2_nloop:
v_xor_b32 v2, 65536, v2
v_xor_b32 v3, 65536, v3
Cvaa 192,192,128,32
s_mov_b32 m0, s53
VE 9,137
Mvaa 192,196,132
buffer_load_dwordx4 v4, s[12:15], s38 offen offset:0 sc1 lds
Mvaa 192,200,136
Ra 224,2,40960
Vc 68,8,9
Mvaa 192,204,140
VE 10,138
Cvaa 208,192,144,36
VE 11,139
Mvaa 208,196,148
Ra 228,2,41984
Vc 69,10,11
Mvaa 208,200,152
Ra 232,2,43008
v_or3_b32 v7, v7, v68, v69
Mvaa 208,204,156
s_waitcnt lgkmcnt(3)
Ra 236,2,44032
Ra 240,2,45056
Cvaa 196,208,128,32
buffer_load_dwordx4 v4, s[12:15], s38 offen offset:1024 sc1 lds
Mvaa 196,212,132
Ve 12,152
Mvaa 196,216,136
VE 13,153
Mvaa 196,220,140
Ra 244,2,46080
Vc 76,12,13
Cvaa 212,208,144,36
VE 14,154
Mvaa 212,212,148
buffer_load_dwordx4 v4, s[12:15], s38 offen offset:2048 sc1 lds
Mvaa 212,216,152
VE 15,155
Mvaa 212,220,156
s_waitcnt lgkmcnt(2)
Ra 248,2,47104
Ra 252,2,48128
Cvaa 200,224,128,32
Ra 192,2,16384
Vc 77,14,15
Mvaa 200,228,132
Ra 196,2,24576
v_or3_b32 v7, v7, v76, v77
Mvaa 200,232,136
Ve 8,140
Mvaa 200,236,140
buffer_load_dwordx4 v4, s[12:15], s38 offen offset:3072 sc1 lds
Cvaa 216,224,144,36
VE 9,141
Mvaa 216,228,148
Ra 200,2,17408
Vc 70,8,9
Mvaa 216,232,152
VE 10,142
Mvaa 216,236,156
s_waitcnt lgkmcnt(3)
Ra 204,2,25600
Ra 208,2,18432
Cvaa 204,240,128,32
Ve 11,143
Mvaa 204,244,132
s_cmp_lt_u32 s37, s52
Ra 212,2,26624
Vc 71,10,11
Mvaa 204,248,136
s_cbranch_scc1 L_nw_ne
s_waitcnt vmcnt(12)
L_nw_ne:
Ra 216,2,19456
v_or3_b32 v7, v7, v70, v71
Mvaa 204,252,140
Ve 12,156
Cvaa 220,240,144,36
VE 13,157
Mvaa 220,244,148
s_barrier
Ra 220,2,27648
Vc 78,12,13
Mvaa 220,248,152
s_waitcnt lgkmcnt(4)
Ve 14,158
Ve 15,159
s_nop 0
Vc 79,14,15
v_or3_b32 v7, v7, v78, v79
v_and_b32 v1, 0x40004000, v7
v_cmp_ne_u32 vcc, 0, v1
Mvaa 220,252,156
s_cbranch_vccnz L_k2_fb_ne
L_k2_fbr_ne:
Maav 0,192,64
Ve 8,192
Maav 0,196,68
s_add_u32 m0, s54, 49152
VE 9,193
Maav 32,192,72
buffer_load_dwordx4 v4, s[12:15], s39 offen offset:0 sc1 lds
Maav 32,196,76
s_cmp_eq_u32 s37, s52
Ra 224,2,20480
Vc 96,8,9
Maav 4,200,64
s_cbranch_scc1 L_pubB
L_pubBr:
VE 10,194
Maav 4,204,68
s_add_u32 s37, s37, 1
Ve 11,195
Maav 36,200,72
s_add_u32 s38, s38, 34816
Ra 228,2,28672
Vc 97,10,11
Maav 36,204,76
Ra 232,2,21504
v_or_b32_e64 v7, v96, v97
Mvvv 48,16,64
VE 12,208
Mvvv 48,16,68
s_waitcnt lgkmcnt(3)
Ra 236,2,29696
Ra 240,2,22528
Maav 8,208,64
buffer_load_dwordx4 v4, s[12:15], s39 offen offset:1024 sc1 lds
Maav 8,212,68
Ve 13,209
Maav 40,208,72
Ra 244,2,30720
Vc 104,12,13
Maav 40,212,76
VE 14,210
Maav 12,216,64
VE 15,211
Maav 12,220,68
Ra 248,2,23552
Vc 105,14,15
Maav 44,216,72
Ra 252,2,31744
v_or3_b32 v7, v7, v104, v105
Maav 44,220,76
VE 8,196
Mvvv 52,16,72
buffer_load_dwordx4 v4, s[12:15], s39 offen offset:2048 sc1 lds
Mvvv 52,16,76
s_waitcnt lgkmcnt(4)
Ve 9,197
Maav 16,224,64
Ra 192,3,0
Vc 98,8,9
Maav 16,228,68
VE 10,198
Maav 48,224,72
VE 11,199
Maav 48,228,76
Ra 196,3,1024
Vc 99,10,11
Maav 20,232,64
Ra 200,3,2048
v_or3_b32 v7, v7, v98, v99
Maav 20,236,68
Ra 204,3,3072
Ra 208,3,4096
Maav 52,232,72
buffer_load_dwordx4 v4, s[12:15], s39 offen offset:3072 sc1 lds
Maav 52,236,76
s_waitcnt lgkmcnt(5)
Ve 12,212
Maav 24,240,64
s_add_u32 s39, s39, 34816
VE 13,213
Maav 24,244,68
Ra 212,3,5120
Vc 106,12,13
Maav 56,240,72
VE 14,214
Maav 56,244,76
VE 15,215
Maav 28,248,64
Ra 216,3,6144
Vc 107,14,15
Maav 28,252,68
Ra 220,3,7168
v_or3_b32 v7, v7, v106, v107
Maav 60,248,72
s_waitcnt lgkmcnt(4)
Ve 8,200
Maav 60,252,76
VE 9,201
Cvaa 128,192,128,32
s_add_u32 m0, s53, 32768
Ra 224,3,8192
Vc 100,8,9
Mvaa 128,196,132
buffer_load_dwordx4 v4, s[12:15], s38 offen offset:0 sc1 lds
Mvaa 128,200,136
VE 10,202
Mvaa 128,204,140
VE 11,203
Cvaa 144,192,144,36
Ra 228,3,9216
Vc 101,10,11
Mvaa 144,196,148
Ra 232,3,10240
v_or3_b32 v7, v7, v100, v101
Mvaa 144,200,152
VE 12,216
Mvaa 144,204,156
s_waitcnt lgkmcnt(3)
Ra 236,3,11264
Ra 240,3,12288
Cvaa 132,208,128,32
buffer_load_dwordx4 v4, s[12:15], s38 offen offset:1024 sc1 lds
Mvaa 132,212,132
Ve 13,217
Mvaa 132,216,136
Ra 244,3,13312
Vc 108,12,13
Mvaa 132,220,140
VE 14,218
Cvaa 148,208,144,36
VE 15,219
Mvaa 148,212,148
buffer_load_dwordx4 v4, s[12:15], s38 offen offset:2048 sc1 lds
Mvaa 148,216,152
Ra 248,3,14336
Vc 109,14,15
Mvaa 148,220,156
s_waitcnt lgkmcnt(3)
Ra 252,3,15360
v_or3_b32 v7, v7, v108, v109
Cvaa 136,224,128,32
Ve 8,204
Mvaa 136,228,132
VE 9,205
Mvaa 136,232,136
Ra 192,2,49152
Vc 102,8,9
Mvaa 136,236,140
buffer_load_dwordx4 v4, s[12:15], s38 offen offset:3072 sc1 lds
Cvaa 152,224,144,36
VE 10,206
Mvaa 152,228,148
VE 11,207
Mvaa 152,232,152
Ra 196,2,57344
Vc 103,10,11
Mvaa 152,236,156
s_waitcnt lgkmcnt(2)
Ra 200,2,50176
Ra 204,2,58368
Cvaa 140,240,128,32
Ra 208,2,51200
v_or3_b32 v7, v7, v102, v103
Mvaa 140,244,132
s_cmp_lt_u32 s37, s52
VE 12,220
Mvaa 140,248,136
s_cbranch_scc1 L_nw_no
s_waitcnt vmcnt(12)
L_nw_no:
VE 13,221
Mvaa 140,252,140
Ra 212,2,59392
Vc 110,12,13
Cvaa 156,240,144,36
s_cmp_eq_u32 s37, s45
Ve 14,222
Mvaa 156,244,148
s_barrier
Ve 15,223
Mvaa 156,248,152
s_waitcnt lgkmcnt(2)
Ra 216,2,52224
Vc 111,14,15
v_or3_b32 v7, v7, v110, v111
v_and_b32 v1, 0x40004000, v7
v_cmp_ne_u32 vcc, 0, v1
Mvaa 156,252,156
s_cbranch_vccnz L_k2_fb_no
L_k2_fbr_no:
Ra 220,2,60416
Maav 0,192,96
s_cbranch_scc1 L_k2_mk_no
L_k2_mkr_no:
VE 8,128
Maav 0,196,100
s_add_u32 m0, s53, 16384
VE 9,129
Maav 32,192,104
buffer_load_dwordx4 v4, s[12:15], s39 offen offset:0 sc1 lds
Maav 32,196,108
s_add_u32 s37, s37, 1
Ra 224,2,53248
Vc 64,8,9
Maav 4,200,96
s_add_u32 s38, s38, 34816
Ve 10,130
Maav 4,204,100
s_xor_b32 s53, s53, 65536
VE 11,131
Maav 36,200,104
s_xor_b32 s54, s54, 65536
Ra 228,2,61440
Vc 65,10,11
Maav 36,204,108
Ra 232,2,54272
v_or_b32_e64 v7, v64, v65
Mvvv 48,16,96
VE 12,144
Mvvv 48,16,100
s_waitcnt lgkmcnt(3)
Ra 236,2,62464
Ra 240,2,55296
Maav 8,208,96
buffer_load_dwordx4 v4, s[12:15], s39 offen offset:1024 sc1 lds
Maav 8,212,100
Ve 13,145
Maav 40,208,104
Ra 244,2,63488
Vc 72,12,13
Maav 40,212,108
VE 14,146
Maav 12,216,96
VE 15,147
Maav 12,220,100
Ra 248,2,56320
Vc 73,14,15
Maav 44,216,104
Ra 252,2,64512
v_or3_b32 v7, v7, v72, v73
Maav 44,220,108
VE 8,132
Mvvv 52,16,104
buffer_load_dwordx4 v4, s[12:15], s39 offen offset:2048 sc1 lds
Mvvv 52,16,108
s_waitcnt lgkmcnt(4)
Ve 9,133
Maav 16,224,96
Ra 192,3,32768
Vc 66,8,9
Maav 16,228,100
VE 10,134
Maav 48,224,104
VE 11,135
Maav 48,228,108
Ra 196,3,33792
Vc 67,10,11
Maav 20,232,96
Ra 200,3,34816
v_or3_b32 v7, v7, v66, v67
Maav 20,236,100
Ra 204,3,35840
Ra 208,3,36864
Maav 52,232,104
buffer_load_dwordx4 v4, s[12:15], s39 offen offset:3072 sc1 lds
Maav 52,236,108
s_waitcnt lgkmcnt(5)
Ve 12,148
Maav 24,240,96
s_add_u32 s39, s39, 34816
VE 13,149
Maav 24,244,100
Ra 212,3,37888
Vc 74,12,13
Maav 56,240,104
VE 14,150
Maav 56,244,108
VE 15,151
Maav 28,248,96
Ra 216,3,38912
Vc 75,14,15
Maav 28,252,100
s_cmp_lg_u32 s37, s36
Ra 220,3,39936
v_or3_b32 v7, v7, v74, v75
Maav 60,248,104
s_waitcnt lgkmcnt(4)
VE 8,136
Maav 60,252,108
s_cbranch_scc1 L_k2_nloop
L_k2_fin:
v_xor_b32 v2, 65536, v2
v_xor_b32 v3, 65536, v3
s_lshr_b32 s3, s42, 4
s_mul_i32 s3, s3, 33792
s_and_b32 s47, s42, 15
s_lshl_b32 s47, s47, 4
s_add_u32 s3, s3, s47
v_mov_b32 v28, s3
s_lshr_b32 s3, s43, 4
s_mul_i32 s3, s3, 33792
s_and_b32 s47, s43, 15
s_lshl_b32 s47, s47, 4
s_add_u32 s3, s3, s47
v_mov_b32 v29, s3
v_lshrrev_b32 v24, 4, v0
v_and_b32 v25, 15, v0
v_cmp_eq_u32 vcc, 1, v25
s_lshl_b32 s3, s32, 4
v_add_u32 v26, s3, v24
v_cndmask_b32 v28, v28, v29, vcc
v_lshl_add_u32 v28, v24, 8, v28
v_mul_u32_u24 v26, 7168, v26
v_lshlrev_b32 v24, 1, v24
v_xor_b32 v24, v24, v25
v_xor_b32 v25, 8, v24
v_lshl_add_u32 v24, v24, 4, v26
v_lshl_add_u32 v25, v25, 4, v26
s_lshl_b32 s3, s92, 12
buffer_load_dwordx4 a[160:163], v28, s[20:23], s3 offen offset:0 sc1
buffer_load_dwordx4 a[164:167], v28, s[20:23], s3 offen offset:1024 sc1
buffer_load_dwordx4 a[168:171], v28, s[20:23], s3 offen offset:2048 sc1
buffer_load_dwordx4 a[172:175], v28, s[20:23], s3 offen offset:3072 sc1
Cvaa 192,192,128,32
s_add_u32 m0, s54, 0
s_add_u32 s3, s5, 0
Ve 9,137
Mvaa 192,196,132
buffer_load_dwordx4 v24, s[24:27], s3 offen offset:0 lds
Mvaa 192,200,136
Ra 224,2,40960
Ra 228,2,41984
Mvaa 192,204,140
s_waitcnt lgkmcnt(2)
Ra 232,2,43008
Ra 236,2,44032
Cvaa 196,208,128,32
s_add_u32 s3, s5, 27648
Ra 240,2,45056
Vc 68,8,9
Mvaa 196,212,132
buffer_load_dwordx4 v24, s[24:27], s3 offen offset:1024 lds
Mvaa 196,216,136
Ra 244,2,46080
Ra 248,2,47104
Mvaa 196,220,140
s_waitcnt lgkmcnt(3)
s_add_u32 s3, s5, 55296
Ra 252,2,48128
Ra 192,2,16384
Cvaa 200,224,128,32
buffer_load_dwordx4 v25, s[24:27], s3 offen offset:2048 lds
Mvaa 200,228,132
s_cmp_lt_u32 s37, s52
Ve 10,138
Mvaa 200,232,136
s_cbranch_scc1 L_nw_nl
s_waitcnt vmcnt(15)
L_nw_nl:
Ra 196,2,24576
Ra 200,2,17408
Mvaa 200,236,140
s_waitcnt lgkmcnt(3)
s_add_u32 s3, s5, 82944
Ra 204,2,25600
Ra 208,2,18432
Cvaa 204,240,128,32
buffer_load_dwordx4 v25, s[24:27], s3 offen offset:3072 lds
Mvaa 204,244,132
s_barrier
VE 11,139
Mvaa 204,248,136
s_waitcnt lgkmcnt(1)
Ra 212,2,26624
Vc 69,10,11
Ve 12,152
Ve 13,153
Ve 14,154
Ve 15,155
Ve 8,140
Ve 9,141
Ve 10,142
VE 11,143
Vc 76,12,13
Ve 12,156
Ve 13,157
Vc 77,14,15
Ve 14,158
Ve 15,159
Vc 70,8,9
Vc 71,10,11
Vc 78,12,13
Vc 79,14,15
v_or3_b32 v7, v7, v68, v69
v_or3_b32 v7, v7, v76, v77
v_or3_b32 v7, v7, v70, v71
v_or3_b32 v7, v7, v78, v79
v_and_b32 v1, 0x40004000, v7
v_cmp_ne_u32 vcc, 0, v1
Mvaa 204,252,140
s_cbranch_vccnz L_k2_fb_nl
L_k2_fbr_nl:
Ra 216,2,19456
Ra 220,2,27648
Maav 0,192,64
v_cmp_gt_i32 s[56:57], 0, v6
v_cmp_gt_i32 s[58:59], 1, v6
v_cmp_gt_i32 s[60:61], 2, v6
v_cmp_gt_i32 s[62:63], 3, v6
s_nop 3
s_nop 0
v_cndmask_b32 v192, v192, v20, s[56:57]
v_cndmask_b32 v193, v193, v20, s[58:59]
v_cndmask_b32 v194, v194, v20, s[60:61]
v_cndmask_b32 v195, v195, v20, s[62:63]
v_cmp_gt_i32 s[56:57], 16, v6
v_cmp_gt_i32 s[58:59], 17, v6
v_cmp_gt_i32 s[60:61], 18, v6
v_cmp_gt_i32 s[62:63], 19, v6
v_cndmask_b32 v196, v196, v20, s[56:57]
v_cndmask_b32 v197, v197, v20, s[58:59]
v_cndmask_b32 v198, v198, v20, s[60:61]
v_cndmask_b32 v199, v199, v20, s[62:63]
v_cmp_gt_i32 s[56:57], 32, v6
v_cmp_gt_i32 s[58:59], 33, v6
v_cmp_gt_i32 s[60:61], 34, v6
v_cmp_gt_i32 s[62:63], 35, v6
v_cndmask_b32 v200, v200, v20, s[56:57]
v_cndmask_b32 v201, v201, v20, s[58:59]
v_cndmask_b32 v202, v202, v20, s[60:61]
v_cndmask_b32 v203, v203, v20, s[62:63]
v_cmp_gt_i32 s[56:57], 48, v6
v_cmp_gt_i32 s[58:59], 49, v6
v_cmp_gt_i32 s[60:61], 50, v6
v_cmp_gt_i32 s[62:63], 51, v6
v_cndmask_b32 v204, v204, v20, s[56:57]
v_cndmask_b32 v205, v205, v20, s[58:59]
v_cndmask_b32 v206, v206, v20, s[60:61]
v_cndmask_b32 v207, v207, v20, s[62:63]
VE 8,192
Maav 0,196,68
s_add_u32 m0, s54, 16384
s_add_u32 s3, s5, 458752
VE 9,193
Maav 32,192,72
buffer_load_dwordx4 v24, s[24:27], s3 offen offset:0 lds
Maav 32,196,76
s_add_u32 s3, s5, 486400
Ra 224,2,20480
Vc 96,8,9
Maav 4,200,64
buffer_load_dwordx4 v24, s[24:27], s3 offen offset:1024 lds
Maav 4,204,68
s_mov_b32 s60, s8
s_and_b32 s61, s9, 0xffff
Ve 10,194
Maav 36,200,72
s_add_u32 s3, s5, 514048
VE 11,195
Maav 36,204,76
buffer_load_dwordx4 v25, s[24:27], s3 offen offset:2048 lds
Mvvv 48,16,64
s_mov_b32 s62, 7340032
Ra 228,2,28672
Vc 97,10,11
Mvvv 48,16,68
s_waitcnt lgkmcnt(2)
s_add_u32 s3, s5, 541696
Ra 232,2,21504
Ra 236,2,29696
Maav 8,208,64
buffer_load_dwordx4 v25, s[24:27], s3 offen offset:3072 lds
Maav 8,212,68
s_add_u32 m0, s54, 32768
s_add_u32 s3, s5, 0
Ra 240,2,22528
v_or_b32_e64 v7, v96, v97
Maav 40,208,72
buffer_load_dwordx4 v24, s[68:71], s3 offen offset:0 lds
Maav 40,212,76
s_mov_b32 s63, 0x20000
s_mov_b32 s56, s40
Ve 12,196
Maav 12,216,64
s_add_u32 s3, s5, 27648
VE 13,197
Maav 12,220,68
buffer_load_dwordx4 v24, s[68:71], s3 offen offset:1024 lds
Maav 44,216,72
s_and_b32 s57, s41, 0xffff
Ra 244,2,30720
Vc 98,12,13
Maav 44,220,76
s_add_u32 s3, s5, 55296
VE 14,198
Mvvv 52,16,72
buffer_load_dwordx4 v25, s[68:71], s3 offen offset:2048 lds
Mvvv 52,16,76
s_waitcnt lgkmcnt(2)
s_add_u32 s3, s5, 82944
Ra 248,2,23552
Ra 252,2,31744
Maav 16,224,64
buffer_load_dwordx4 v25, s[68:71], s3 offen offset:3072 lds
Maav 16,228,68
s_mov_b32 s58, 4194304
s_mov_b32 s59, 0x20000
Ve 15,199
Maav 48,224,72
s_add_u32 m0, s54, 49152
s_add_u32 s3, s5, 458752
Ra 192,2,49152
Vc 99,14,15
Maav 48,228,76
buffer_load_dwordx4 v24, s[68:71], s3 offen offset:0 lds
Maav 20,232,64
s_bfe_u32 s6, s2, 0x20001
Ra 196,2,57344
v_or3_b32 v7, v7, v98, v99
Maav 20,236,68
s_add_u32 s3, s5, 486400
Ra 200,2,50176
Ra 204,2,58368
Maav 52,232,72
buffer_load_dwordx4 v24, s[68:71], s3 offen offset:1024 lds
Maav 52,236,76
s_waitcnt lgkmcnt(4)
s_add_u32 s3, s5, 514048
Ve 8,200
Maav 24,240,64
buffer_load_dwordx4 v25, s[68:71], s3 offen offset:2048 lds
Maav 24,244,68
s_lshr_b32 s7, s34, 1
s_lshl_b32 s45, s7, 2
VE 9,201
Maav 56,240,72
s_add_u32 s3, s5, 541696
Ra 208,2,51200
Vc 100,8,9
Maav 56,244,76
buffer_load_dwordx4 v25, s[68:71], s3 offen offset:3072 lds
Maav 28,248,64
s_add_u32 s46, s45, s6
s_sub_u32 s46, 15, s46
VE 10,202
Maav 28,252,68
s_sub_u32 s45, 12, s45
Ra 212,2,59392
Ra 216,2,52224
Maav 60,248,72
s_waitcnt lgkmcnt(3)
Ra 220,2,60416
Ve 11,203
Ve 12,204
Ve 13,205
Ve 14,206
VE 15,207
Vc 101,10,11
Vc 102,12,13
Vc 103,14,15
v_or3_b32 v7, v7, v100, v101
v_or3_b32 v7, v7, v102, v103
Maav 60,252,76
s_add_u32 s45, s45, s6
v_and_b32 v1, 0x40004000, v7
v_cmp_ne_u32 vcc, 0, v1
s_cbranch_vccnz L_k2_fb_fi
L_k2_fbr_fi:
Maav 0,192,96
Ra 224,2,53248
Ra 228,2,61440
Maav 0,196,100
Ra 232,2,54272
Ra 236,2,62464
Maav 4,200,96
Ra 240,2,55296
Ra 244,2,63488
Maav 4,204,100
Ra 248,2,56320
Ra 252,2,64512
Mvvv 48,16,96
s_cmp_lt_u32 s7, 2
s_cselect_b32 s45, s46, s45
Mvvv 48,16,100
s_waitcnt lgkmcnt(8)
Maav 8,208,96
s_and_b32 s46, s2, 1
s_bfe_u32 s6, s2, 0x30003
s_lshl_b32 s6, s6, 1
Maav 8,212,100
s_add_u32 s46, s46, s6
s_mov_b32 s48, 0
s_mov_b32 s49, 15360
Maav 12,216,96
s_mov_b32 s50, 30720
s_mov_b32 s51, 46080
s_lshl_b32 s35, s32, 13
Maav 12,220,100
s_waitcnt lgkmcnt(4)
Maav 16,224,96
s_add_u32 s35, s35, 131072
s_and_b32 s52, s46, 1
s_lshl_b32 s37, s45, 20
Maav 16,228,100
s_lshl_b32 s7, s52, 19
s_add_u32 s37, s37, s7
s_add_u32 s37, s37, 46137344
Maav 20,232,96
s_lshr_b32 s7, s46, 1
s_lshl_b32 s7, s7, 8
s_lshl_b32 s6, s52, 22
Maav 20,236,100
s_waitcnt lgkmcnt(0)
Maav 24,240,96
s_add_u32 s6, s6, s7
s_add_u32 s12, s94, s6
s_addc_u32 s13, s95, 0
s_and_b32 s13, s13, 0xffff
Maav 24,244,100
s_mov_b32 s14, 0
s_mov_b32 s15, 0x20000
s_sub_u32 s14, 4194304, s7
Maav 28,248,96
s_mov_b32 s28, s94
s_and_b32 s29, s95, 0xffff
s_mov_b32 s30, 8388608
Maav 28,252,100
s_mov_b32 s31, 0x20000
s_lshl_b32 s7, s46, 7
s_lshl_b32 s36, s45, 18
s_nop 7
s_lshl_b32 s3, s55, 20
s_lshl_b32 s47, s33, 15
s_add_u32 s3, s3, s47
s_lshl_b32 s47, s32, 10
v_lshlrev_b32 v248, 4, v0
v_add_u32 v249, s47, v248
s_sub_u32 s47, 7168, s47
v_add_u32 v248, s47, v248
v_rcp_f32 v250, v48
v_rcp_f32 v252, v52
v_mov_b32 v251, v250
v_mov_b32_e64 v253, v252
Ar 240,32
Ar 241,33
Ar 242,34
Ar 243,35
Ar 244,36
Ar 245,37
Ar 246,38
Ar 247,39
v_pk_mul_f32 v[240:241], v[240:241], v[252:253]
v_pk_mul_f32 v[242:243], v[242:243], v[252:253]
v_pk_mul_f32 v[244:245], v[244:245], v[252:253]
v_pk_mul_f32 v[246:247], v[246:247], v[252:253]
Vc 28,240,241
Vc 29,242,243
Vc 30,244,245
Vc 31,246,247
buffer_store_dwordx4 v[28:31], v249, s[16:19], s3 offen sc1
Ar 240,0
Ar 241,1
Ar 242,2
Ar 243,3
Ar 244,4
Ar 245,5
Ar 246,6
Ar 247,7
v_pk_mul_f32 v[240:241], v[240:241], v[250:251]
v_pk_mul_f32 v[242:243], v[242:243], v[250:251]
v_pk_mul_f32 v[244:245], v[244:245], v[250:251]
v_pk_mul_f32 v[246:247], v[246:247], v[250:251]
Vc 24,240,241
Vc 25,242,243
Vc 26,244,245
Vc 27,246,247
buffer_store_dwordx4 v[24:27], v248, s[16:19], s3 offen sc1
s_add_u32 s3, s3, 8192
Ar 240,40
Ar 241,41
Ar 242,42
Ar 243,43
Ar 244,44
Ar 245,45
Ar 246,46
Ar 247,47
v_pk_mul_f32 v[240:241], v[240:241], v[252:253]
v_pk_mul_f32 v[242:243], v[242:243], v[252:253]
v_pk_mul_f32 v[244:245], v[244:245], v[252:253]
v_pk_mul_f32 v[246:247], v[246:247], v[252:253]
Vc 28,240,241
Vc 29,242,243
Vc 30,244,245
Vc 31,246,247
buffer_store_dwordx4 v[28:31], v249, s[16:19], s3 offen sc1
Ar 240,8
Ar 241,9
Ar 242,10
Ar 243,11
Ar 244,12
Ar 245,13
Ar 246,14
Ar 247,15
v_pk_mul_f32 v[240:241], v[240:241], v[250:251]
v_pk_mul_f32 v[242:243], v[242:243], v[250:251]
v_pk_mul_f32 v[244:245], v[244:245], v[250:251]
v_pk_mul_f32 v[246:247], v[246:247], v[250:251]
Vc 24,240,241
Vc 25,242,243
Vc 26,244,245
Vc 27,246,247
buffer_store_dwordx4 v[24:27], v248, s[16:19], s3 offen sc1
s_add_u32 s3, s3, 8192
Ar 240,48
Ar 241,49
Ar 242,50
Ar 243,51
Ar 244,52
Ar 245,53
Ar 246,54
Ar 247,55
v_pk_mul_f32 v[240:241], v[240:241], v[252:253]
v_pk_mul_f32 v[242:243], v[242:243], v[252:253]
v_pk_mul_f32 v[244:245], v[244:245], v[252:253]
v_pk_mul_f32 v[246:247], v[246:247], v[252:253]
Vc 28,240,241
Vc 29,242,243
Vc 30,244,245
Vc 31,246,247
buffer_store_dwordx4 v[28:31], v249, s[16:19], s3 offen sc1
Ar 240,16
Ar 241,17
Ar 242,18
Ar 243,19
Ar 244,20
Ar 245,21
Ar 246,22
Ar 247,23
v_pk_mul_f32 v[240:241], v[240:241], v[250:251]
v_pk_mul_f32 v[242:243], v[242:243], v[250:251]
v_pk_mul_f32 v[244:245], v[244:245], v[250:251]
v_pk_mul_f32 v[246:247], v[246:247], v[250:251]
Vc 24,240,241
Vc 25,242,243
Vc 26,244,245
Vc 27,246,247
buffer_store_dwordx4 v[24:27], v248, s[16:19], s3 offen sc1
s_add_u32 s3, s3, 8192
Ar 240,56
Ar 241,57
Ar 242,58
Ar 243,59
Ar 244,60
Ar 245,61
Ar 246,62
Ar 247,63
v_pk_mul_f32 v[240:241], v[240:241], v[252:253]
v_pk_mul_f32 v[242:243], v[242:243], v[252:253]
v_pk_mul_f32 v[244:245], v[244:245], v[252:253]
v_pk_mul_f32 v[246:247], v[246:247], v[252:253]
Vc 28,240,241
Vc 29,242,243
Vc 30,244,245
Vc 31,246,247
buffer_store_dwordx4 v[28:31], v249, s[16:19], s3 offen sc1
Ar 240,24
Ar 241,25
Ar 242,26
Ar 243,27
Ar 244,28
Ar 245,29
Ar 246,30
Ar 247,31
v_pk_mul_f32 v[240:241], v[240:241], v[250:251]
v_pk_mul_f32 v[242:243], v[242:243], v[250:251]
v_pk_mul_f32 v[244:245], v[244:245], v[250:251]
v_pk_mul_f32 v[246:247], v[246:247], v[250:251]
Vc 24,240,241
Vc 25,242,243
Vc 26,244,245
Vc 27,246,247
buffer_store_dwordx4 v[24:27], v248, s[16:19], s3 offen sc1
s_cmp_lt_u32 s34, 1
s_cbranch_scc1 L_noffn
v_lshrrev_b32_e64 v24, 4, v0
v_bfe_u32 v25, v0, 2, 2
v_lshl_add_u32 v26, v24, 3, v25
v_lshlrev_b32 v26, 8, v26
v_and_b32 v27, 3, v0
v_lshl_add_u32 v26, v27, 3, v26
v_and_b32_e64 v27, 1, v24
v_lshl_add_u32 v25, v27, 2, v25
s_lshl_b32 s3, s32, 1
v_xor_b32 v25, s3, v25
v_lshl_add_u32 v26, v25, 5, v26
s_sub_u32 s3, s54, s44
v_add_u32 v26, s3, v26
v_xor_b32 v27, 32, v26
s_waitcnt vmcnt(8) lgkmcnt(0)
s_barrier
s_nop 0
ds_read_b64_tr_b16 v[128:129], v26 offset:0
ds_read_b64_tr_b16 v[130:131], v26 offset:1024
ds_read_b64_tr_b16 v[132:133], v27 offset:0
ds_read_b64_tr_b16 v[134:135], v27 offset:1024
ds_read_b64_tr_b16 v[136:137], v26 offset:8192
ds_read_b64_tr_b16 v[138:139], v26 offset:9216
ds_read_b64_tr_b16 v[140:141], v27 offset:8192
ds_read_b64_tr_b16 v[142:143], v27 offset:9216
ds_read_b64_tr_b16 v[144:145], v26 offset:16384
ds_read_b64_tr_b16 v[146:147], v26 offset:17408
ds_read_b64_tr_b16 v[148:149], v27 offset:16384
ds_read_b64_tr_b16 v[150:151], v27 offset:17408
ds_read_b64_tr_b16 v[152:153], v26 offset:24576
ds_read_b64_tr_b16 v[154:155], v26 offset:25600
ds_read_b64_tr_b16 v[156:157], v27 offset:24576
s_waitcnt lgkmcnt(9)
s_nop 0
ds_read_b64_tr_b16 v[158:159], v27 offset:25600
ds_read_b64_tr_b16 v[160:161], v26 offset:32768
ds_read_b64_tr_b16 v[162:163], v26 offset:33792
ds_read_b64_tr_b16 v[164:165], v27 offset:32768
ds_read_b64_tr_b16 v[166:167], v27 offset:33792
ds_read_b64_tr_b16 v[168:169], v26 offset:40960
s_waitcnt lgkmcnt(9)
s_nop 0
ds_read_b64_tr_b16 v[170:171], v26 offset:41984
ds_read_b64_tr_b16 v[172:173], v27 offset:40960
ds_read_b64_tr_b16 v[174:175], v27 offset:41984
ds_read_b64_tr_b16 v[176:177], v26 offset:49152
ds_read_b64_tr_b16 v[178:179], v26 offset:50176
ds_read_b64_tr_b16 v[180:181], v27 offset:49152
s_waitcnt lgkmcnt(9)
ds_read_b64_tr_b16 v[182:183], v27 offset:50176
ds_read_b64_tr_b16 v[184:185], v26 offset:57344
ds_read_b64_tr_b16 v[186:187], v26 offset:58368
ds_read_b64_tr_b16 v[188:189], v27 offset:57344
ds_read_b64_tr_b16 v[190:191], v27 offset:58368
v_and_b32 v25, 15, v0
v_mul_u32_u24 v28, 14336, v25
v_lshl_add_u32 v28, v24, 4, v28
v_mov_b32 v29, 2146435072
v_cmp_gt_u32 vcc, 2, v25
s_mul_i32 s3, s92, 57344
s_lshl_b32 s47, s4, 9
s_add_u32 s3, s3, s47
v_cndmask_b32 v28, v29, v28, vcc
s_lshl_b32 s47, s32, 7
s_add_u32 s3, s3, s47
s_add_u32 s3, s3, 6291456
Zvva 224,128,160
Zvva 228,132,160
Mvva 224,136,164
Mvva 228,140,164
Mvva 224,144,168
Mvva 228,148,168
Mvva 224,152,172
Mvva 228,156,172
s_waitcnt lgkmcnt(0)
Zvva 232,160,160
Zvva 236,164,160
Mvva 232,168,164
Mvva 236,172,164
Mvva 232,176,168
Mvva 236,180,168
Mvva 232,184,172
Mvva 236,188,172
L_noffn:
s_add_u32 s36, s36, s7
s_and_b32 s94, s7, 128
s_lshl_b32 s38, s45, 7
s_lshl_b32 s6, s52, 6
s_add_u32 s38, s38, s6
s_add_u32 s38, s38, 5300224
s_lshl_b32 s52, s32, 11
s_lshl_b32 s6, s32, 16
s_add_u32 s6, s6, s94
s_xor_b32 s6, s6, 128
s_lshl_b32 s7, s32, 5
s_mov_b32 s68, s10
s_and_b32 s69, s11, 0xffff
s_mov_b32 s70, 4194304
s_mov_b32 s71, 0x20000
s_add_u32 s8, s66, s37
s_addc_u32 s9, s67, 0
s_and_b32 s9, s9, 0xffff
s_mov_b32 s10, 524288
s_mov_b32 s11, 0x20000
v_lshlrev_b32 v112, 4, v0
v_lshrrev_b32 v121, 4, v0
v_and_b32 v122, 7, v0
v_lshrrev_b32 v123, 3, v0
v_lshlrev_b32 v124, 1, v121
v_xor_b32 v124, v124, v122
v_lshlrev_b32_e64 v124, 4, v124
v_lshl_add_u32 v113, v123, 11, v124
v_add_u32 v114, s6, v113
v_lshrrev_b32 v124, 2, v0
v_bfe_u32 v126, v0, 3, 2
v_lshlrev_b32 v124, 7, v124
v_and_b32 v125, 3, v0
v_lshl_add_u32 v124, v125, 3, v124
v_lshl_add_u32 v115, v126, 5, v124
v_xor_b32 v116, 32, v115
v_xor_b32 v117, 64, v115
v_xor_b32 v118, 96, v115
v_add_u32 v120, s7, v123
v_lshlrev_b32 v119, 11, v120
v_lshl_add_u32 v119, v122, 4, v119
v_mov_b32 v126, 0
v_lshlrev_b32 v127, 2, v122
v_mov_b32 v24, 1
v_mul_u32_u24 v25, s65, v0
s_waitcnt vmcnt(0)
s_barrier
s_mov_b64 exec, 3
buffer_store_dword v24, v25, s[20:23], s64 offen sc1
s_mov_b64 exec, -1
s_cmp_ge_u32 s34, 1
s_nop 0
s_cselect_b32 s3, s3, 8388608
s_add_u32 s7, s3, 28672
buffer_store_dwordx4 v[224:227], v28, s[20:23], s3 offen offset:0 sc1
buffer_store_dwordx4 v[228:231], v28, s[20:23], s3 offen offset:64 sc1
buffer_store_dwordx4 v[232:235], v28, s[20:23], s7 offen offset:0 sc1
buffer_store_dwordx4 v[236:239], v28, s[20:23], s7 offen offset:64 sc1
s_lshl_b32 s33, s4, 3
s_add_u32 s33, s33, s92
s_mov_b32 s65, s33
s_mov_b32 s3, s36
buffer_load_dwordx4 v[18:21], v119, s[56:59], s3 offen
s_add_u32 s3, s3, 16384
buffer_load_dwordx4 v[22:25], v119, s[56:59], s3 offen
s_add_u32 s3, s3, 16384
buffer_load_dwordx4 v[26:29], v119, s[56:59], s3 offen
s_add_u32 s3, s3, 16384
buffer_load_dwordx4 v[30:33], v119, s[56:59], s3 offen
s_lshl_b32 s3, s45, 10
s_add_u32 s3, s3, 5259264
v_lshlrev_b32 v124, 3, v120
buffer_load_dwordx2 v[34:35], v124, s[20:23], s3 offen offset:0 sc1
buffer_load_dwordx2 v[36:37], v124, s[20:23], s3 offen offset:64 sc1
buffer_load_dwordx2 v[38:39], v124, s[20:23], s3 offen offset:128 sc1
buffer_load_dwordx2 v[40:41], v124, s[20:23], s3 offen offset:192 sc1
v_and_b32 v10, 15, v0
v_lshlrev_b32 v10, 2, v10
s_add_u32 s95, s32, 32
s_lshl_b32 s95, s95, 16
s_add_u32 s95, s95, s94
s_xor_b32 s95, s95, 128
s_add_u32 m0, s44, 0
s_nop 0
s_nop 0
buffer_load_dwordx4 v114, s[12:15], s48 offen offset:0 lds
buffer_load_dwordx4 v114, s[12:15], s49 offen offset:1024 lds
buffer_load_dwordx4 v114, s[12:15], s50 offen offset:2048 lds
buffer_load_dwordx4 v114, s[12:15], s51 offen offset:3072 lds
v_xor_b32 v114, 128, v114
s_add_u32 m0, s44, 16384
s_nop 0
s_nop 0
buffer_load_dwordx4 v114, s[12:15], s48 offen offset:0 lds
buffer_load_dwordx4 v114, s[12:15], s49 offen offset:1024 lds
buffer_load_dwordx4 v114, s[12:15], s50 offen offset:2048 lds
buffer_load_dwordx4 v114, s[12:15], s51 offen offset:3072 lds
v_xor_b32 v114, 128, v114
v_add_u32 v114, 262144, v114
buffer_load_dword v124, v10, s[20:23], s38 offen sc1
v_add_u32 v12, 65536, v115
v_add_u32 v13, 65536, v116
v_add_u32 v14, 65536, v117
v_add_u32 v15, 65536, v118
s_and_b32 s39, s93, 15
s_lshr_b32 s37, s93, 4
s_lshl_b32 s54, s37, 2
s_add_u32 s54, s54, s32
s_lshl_b32 s3, s54, 17
s_lshl_b32 s7, s39, 7
s_add_u32 s3, s3, s7
s_cmp_lt_u32 s93, 224
s_cselect_b32 s3, s3, 2146435072
v_add_u32 v125, s3, v113
s_mov_b32 s40, 0
s_waitcnt vmcnt(9)
v_lshlrev_b32_e64 v42, 16, v18
v_and_b32 v43, 0xffff0000, v18
v_lshlrev_b32_e64 v44, 16, v19
v_and_b32 v45, 0xffff0000, v19
v_lshlrev_b32_e64 v46, 16, v20
v_and_b32 v47, 0xffff0000, v20
v_lshlrev_b32_e64 v48, 16, v21
v_and_b32 v49, 0xffff0000, v21
v_pk_add_f32 v[42:43], v[42:43], v[34:35] op_sel_hi:[1,0] neg_lo:[0,1] neg_hi:[0,1]
v_pk_add_f32 v[44:45], v[44:45], v[34:35] op_sel_hi:[1,0] neg_lo:[0,1] neg_hi:[0,1]
v_pk_add_f32 v[46:47], v[46:47], v[34:35] op_sel_hi:[1,0] neg_lo:[0,1] neg_hi:[0,1]
v_pk_add_f32 v[48:49], v[48:49], v[34:35] op_sel_hi:[1,0] neg_lo:[0,1] neg_hi:[0,1]
Vc 2,42,43
v_lshlrev_b32_e64 v42, 16, v2
v_and_b32 v43, 0xffff0000, v2
Vc 3,44,45
v_lshlrev_b32_e64 v44, 16, v3
v_and_b32 v45, 0xffff0000, v3
Vc 4,46,47
v_lshlrev_b32_e64 v46, 16, v4
v_and_b32 v47, 0xffff0000, v4
Vc 5,48,49
v_lshlrev_b32_e64 v48, 16, v5
v_and_b32 v49, 0xffff0000, v5
v_pk_mul_f32 v[42:43], v[42:43], v[34:35] op_sel:[0,1] op_sel_hi:[1,1]
v_pk_mul_f32 v[44:45], v[44:45], v[34:35] op_sel:[0,1] op_sel_hi:[1,1]
v_pk_mul_f32 v[46:47], v[46:47], v[34:35] op_sel:[0,1] op_sel_hi:[1,1]
v_pk_mul_f32 v[48:49], v[48:49], v[34:35] op_sel:[0,1] op_sel_hi:[1,1]
Vc 2,42,43
v_lshlrev_b32_e64 v42, 16, v2
v_and_b32 v43, 0xffff0000, v2
Vc 3,44,45
v_lshlrev_b32_e64 v44, 16, v3
v_and_b32 v45, 0xffff0000, v3
Vc 4,46,47
v_lshlrev_b32_e64 v46, 16, v4
v_and_b32 v47, 0xffff0000, v4
Vc 5,48,49
v_lshlrev_b32_e64 v48, 16, v5
v_and_b32 v49, 0xffff0000, v5
v_mul_f32 v2, 0xbfb8aa3b, v42
v_mul_f32 v3, 0xbfb8aa3b, v43
v_mul_f32 v4, 0xbfb8aa3b, v44
v_mul_f32 v5, 0xbfb8aa3b, v45
v_mul_f32 v6, 0xbfb8aa3b, v46
v_mul_f32 v7, 0xbfb8aa3b, v47
v_mul_f32 v8, 0xbfb8aa3b, v48
v_mul_f32 v9, 0xbfb8aa3b, v49
Ve 2,2
Ve 3,3
Ve 4,4
Ve 5,5
Ve 6,6
Ve 7,7
Ve 8,8
Ve 9,9
v_add_f32 v2, 1.0, v2
v_add_f32 v3, 1.0, v3
v_add_f32 v4, 1.0, v4
v_add_f32 v5, 1.0, v5
v_add_f32 v6, 1.0, v6
v_add_f32 v7, 1.0, v7
v_add_f32 v8, 1.0, v8
v_add_f32 v9, 1.0, v9
v_rcp_f32 v2, v2
v_rcp_f32 v3, v3
v_rcp_f32 v4, v4
v_rcp_f32 v5, v5
v_rcp_f32 v6, v6
v_rcp_f32 v7, v7
v_rcp_f32 v8, v8
v_rcp_f32 v9, v9
v_pk_mul_f32 v[42:43], v[42:43], v[2:3]
v_pk_mul_f32 v[44:45], v[44:45], v[4:5]
v_pk_mul_f32 v[46:47], v[46:47], v[6:7]
v_pk_mul_f32 v[48:49], v[48:49], v[8:9]
Vc 2,42,43
v_lshlrev_b32_e64 v42, 16, v2
v_and_b32 v43, 0xffff0000, v2
Vc 3,44,45
v_lshlrev_b32_e64 v44, 16, v3
v_and_b32 v45, 0xffff0000, v3
Vc 4,46,47
v_lshlrev_b32_e64 v46, 16, v4
v_and_b32 v47, 0xffff0000, v4
Vc 5,48,49
v_lshlrev_b32_e64 v48, 16, v5
v_and_b32 v49, 0xffff0000, v5
s_waitcnt vmcnt(0)
v_cmp_ne_u32 vcc, 1, v124
s_cbranch_vccnz L_spinC
s_nop 0
L_spinCr:
buffer_load_dwordx4 a[0:3], v112, s[8:11], s52 offen offset:0 sc1
buffer_load_dwordx4 a[4:7], v112, s[8:11], s52 offen offset:1024 sc1
s_add_u32 s52, s52, 8192
buffer_load_dwordx4 a[8:11], v112, s[8:11], s52 offen offset:0 sc1
buffer_load_dwordx4 a[12:15], v112, s[8:11], s52 offen offset:1024 sc1
s_add_u32 s52, s52, 8192
buffer_load_dwordx4 a[16:19], v112, s[8:11], s52 offen offset:0 sc1
buffer_load_dwordx4 a[20:23], v112, s[8:11], s52 offen offset:1024 sc1
s_add_u32 s52, s52, 8192
buffer_load_dwordx4 a[24:27], v112, s[8:11], s52 offen offset:0 sc1
buffer_load_dwordx4 a[28:31], v112, s[8:11], s52 offen offset:1024 sc1
s_add_u32 s52, s52, 8192
buffer_load_dwordx4 a[32:35], v112, s[8:11], s52 offen offset:0 sc1
buffer_load_dwordx4 a[36:39], v112, s[8:11], s52 offen offset:1024 sc1
s_add_u32 s52, s52, 8192
buffer_load_dwordx4 a[40:43], v112, s[8:11], s52 offen offset:0 sc1
buffer_load_dwordx4 a[44:47], v112, s[8:11], s52 offen offset:1024 sc1
s_add_u32 s52, s52, 8192
v_lshlrev_b32_e64 v50, 16, v22
v_and_b32 v51, 0xffff0000, v22
v_lshlrev_b32_e64 v52, 16, v23
v_and_b32 v53, 0xffff0000, v23
v_lshlrev_b32_e64 v54, 16, v24
v_and_b32 v55, 0xffff0000, v24
v_lshlrev_b32_e64 v56, 16, v25
v_and_b32 v57, 0xffff0000, v25
v_pk_add_f32 v[50:51], v[50:51], v[36:37] op_sel_hi:[1,0] neg_lo:[0,1] neg_hi:[0,1]
v_pk_add_f32 v[52:53], v[52:53], v[36:37] op_sel_hi:[1,0] neg_lo:[0,1] neg_hi:[0,1]
v_pk_add_f32 v[54:55], v[54:55], v[36:37] op_sel_hi:[1,0] neg_lo:[0,1] neg_hi:[0,1]
v_pk_add_f32 v[56:57], v[56:57], v[36:37] op_sel_hi:[1,0] neg_lo:[0,1] neg_hi:[0,1]
Vc 2,50,51
v_lshlrev_b32_e64 v50, 16, v2
v_and_b32 v51, 0xffff0000, v2
Vc 3,52,53
v_lshlrev_b32_e64 v52, 16, v3
v_and_b32 v53, 0xffff0000, v3
Vc 4,54,55
v_lshlrev_b32_e64 v54, 16, v4
v_and_b32 v55, 0xffff0000, v4
Vc 5,56,57
v_lshlrev_b32_e64 v56, 16, v5
v_and_b32 v57, 0xffff0000, v5
v_pk_mul_f32 v[50:51], v[50:51], v[36:37] op_sel:[0,1] op_sel_hi:[1,1]
v_pk_mul_f32 v[52:53], v[52:53], v[36:37] op_sel:[0,1] op_sel_hi:[1,1]
v_pk_mul_f32 v[54:55], v[54:55], v[36:37] op_sel:[0,1] op_sel_hi:[1,1]
v_pk_mul_f32 v[56:57], v[56:57], v[36:37] op_sel:[0,1] op_sel_hi:[1,1]
Vc 2,50,51
v_lshlrev_b32_e64 v50, 16, v2
v_and_b32 v51, 0xffff0000, v2
Vc 3,52,53
v_lshlrev_b32_e64 v52, 16, v3
v_and_b32 v53, 0xffff0000, v3
Vc 4,54,55
v_lshlrev_b32_e64 v54, 16, v4
v_and_b32 v55, 0xffff0000, v4
Vc 5,56,57
v_lshlrev_b32_e64 v56, 16, v5
v_and_b32 v57, 0xffff0000, v5
v_mul_f32 v2, 0xbfb8aa3b, v50
v_mul_f32 v3, 0xbfb8aa3b, v51
v_mul_f32 v4, 0xbfb8aa3b, v52
v_mul_f32 v5, 0xbfb8aa3b, v53
v_mul_f32 v6, 0xbfb8aa3b, v54
v_mul_f32 v7, 0xbfb8aa3b, v55
v_mul_f32 v8, 0xbfb8aa3b, v56
v_mul_f32 v9, 0xbfb8aa3b, v57
Ve 2,2
Ve 3,3
Ve 4,4
Ve 5,5
Ve 6,6
Ve 7,7
Ve 8,8
Ve 9,9
v_add_f32 v2, 1.0, v2
v_add_f32 v3, 1.0, v3
v_add_f32 v4, 1.0, v4
v_add_f32 v5, 1.0, v5
v_add_f32 v6, 1.0, v6
v_add_f32 v7, 1.0, v7
v_add_f32 v8, 1.0, v8
v_add_f32 v9, 1.0, v9
v_rcp_f32 v2, v2
v_rcp_f32 v3, v3
v_rcp_f32 v4, v4
v_rcp_f32 v5, v5
v_rcp_f32 v6, v6
v_rcp_f32 v7, v7
v_rcp_f32 v8, v8
v_rcp_f32 v9, v9
v_pk_mul_f32 v[50:51], v[50:51], v[2:3]
v_pk_mul_f32 v[52:53], v[52:53], v[4:5]
v_pk_mul_f32 v[54:55], v[54:55], v[6:7]
v_pk_mul_f32 v[56:57], v[56:57], v[8:9]
Vc 2,50,51
v_lshlrev_b32_e64 v50, 16, v2
v_and_b32 v51, 0xffff0000, v2
Vc 3,52,53
v_lshlrev_b32_e64 v52, 16, v3
v_and_b32 v53, 0xffff0000, v3
Vc 4,54,55
v_lshlrev_b32_e64 v54, 16, v4
v_and_b32 v55, 0xffff0000, v4
Vc 5,56,57
v_lshlrev_b32_e64 v56, 16, v5
v_and_b32 v57, 0xffff0000, v5
v_lshlrev_b32_e64 v58, 16, v26
v_and_b32 v59, 0xffff0000, v26
v_lshlrev_b32_e64 v60, 16, v27
v_and_b32 v61, 0xffff0000, v27
v_lshlrev_b32_e64 v62, 16, v28
v_and_b32 v63, 0xffff0000, v28
v_lshlrev_b32_e64 v64, 16, v29
v_and_b32 v65, 0xffff0000, v29
v_pk_add_f32 v[58:59], v[58:59], v[38:39] op_sel_hi:[1,0] neg_lo:[0,1] neg_hi:[0,1]
v_pk_add_f32 v[60:61], v[60:61], v[38:39] op_sel_hi:[1,0] neg_lo:[0,1] neg_hi:[0,1]
v_pk_add_f32 v[62:63], v[62:63], v[38:39] op_sel_hi:[1,0] neg_lo:[0,1] neg_hi:[0,1]
v_pk_add_f32 v[64:65], v[64:65], v[38:39] op_sel_hi:[1,0] neg_lo:[0,1] neg_hi:[0,1]
Vc 2,58,59
v_lshlrev_b32_e64 v58, 16, v2
v_and_b32 v59, 0xffff0000, v2
Vc 3,60,61
v_lshlrev_b32_e64 v60, 16, v3
v_and_b32 v61, 0xffff0000, v3
Vc 4,62,63
v_lshlrev_b32_e64 v62, 16, v4
v_and_b32 v63, 0xffff0000, v4
Vc 5,64,65
v_lshlrev_b32_e64 v64, 16, v5
v_and_b32 v65, 0xffff0000, v5
v_pk_mul_f32 v[58:59], v[58:59], v[38:39] op_sel:[0,1] op_sel_hi:[1,1]
v_pk_mul_f32 v[60:61], v[60:61], v[38:39] op_sel:[0,1] op_sel_hi:[1,1]
v_pk_mul_f32 v[62:63], v[62:63], v[38:39] op_sel:[0,1] op_sel_hi:[1,1]
v_pk_mul_f32 v[64:65], v[64:65], v[38:39] op_sel:[0,1] op_sel_hi:[1,1]
Vc 2,58,59
v_lshlrev_b32_e64 v58, 16, v2
v_and_b32 v59, 0xffff0000, v2
Vc 3,60,61
v_lshlrev_b32_e64 v60, 16, v3
v_and_b32 v61, 0xffff0000, v3
Vc 4,62,63
v_lshlrev_b32_e64 v62, 16, v4
v_and_b32 v63, 0xffff0000, v4
Vc 5,64,65
v_lshlrev_b32_e64 v64, 16, v5
v_and_b32 v65, 0xffff0000, v5
v_mul_f32 v2, 0xbfb8aa3b, v58
v_mul_f32 v3, 0xbfb8aa3b, v59
v_mul_f32 v4, 0xbfb8aa3b, v60
v_mul_f32 v5, 0xbfb8aa3b, v61
v_mul_f32 v6, 0xbfb8aa3b, v62
v_mul_f32 v7, 0xbfb8aa3b, v63
v_mul_f32 v8, 0xbfb8aa3b, v64
v_mul_f32 v9, 0xbfb8aa3b, v65
Ve 2,2
Ve 3,3
Ve 4,4
Ve 5,5
Ve 6,6
Ve 7,7
Ve 8,8
Ve 9,9
v_add_f32 v2, 1.0, v2
v_add_f32 v3, 1.0, v3
v_add_f32 v4, 1.0, v4
v_add_f32 v5, 1.0, v5
v_add_f32 v6, 1.0, v6
v_add_f32 v7, 1.0, v7
v_add_f32 v8, 1.0, v8
v_add_f32 v9, 1.0, v9
v_rcp_f32 v2, v2
v_rcp_f32 v3, v3
v_rcp_f32 v4, v4
v_rcp_f32 v5, v5
v_rcp_f32 v6, v6
v_rcp_f32 v7, v7
v_rcp_f32 v8, v8
v_rcp_f32 v9, v9
v_pk_mul_f32 v[58:59], v[58:59], v[2:3]
v_pk_mul_f32 v[60:61], v[60:61], v[4:5]
v_pk_mul_f32 v[62:63], v[62:63], v[6:7]
v_pk_mul_f32 v[64:65], v[64:65], v[8:9]
Vc 2,58,59
v_lshlrev_b32_e64 v58, 16, v2
v_and_b32 v59, 0xffff0000, v2
Vc 3,60,61
v_lshlrev_b32_e64 v60, 16, v3
v_and_b32 v61, 0xffff0000, v3
Vc 4,62,63
v_lshlrev_b32_e64 v62, 16, v4
v_and_b32 v63, 0xffff0000, v4
Vc 5,64,65
v_lshlrev_b32_e64 v64, 16, v5
v_and_b32 v65, 0xffff0000, v5
buffer_load_dwordx4 a[48:51], v112, s[8:11], s52 offen offset:0 sc1
buffer_load_dwordx4 a[52:55], v112, s[8:11], s52 offen offset:1024 sc1
s_add_u32 s52, s52, 8192
buffer_load_dwordx4 a[56:59], v112, s[8:11], s52 offen offset:0 sc1
buffer_load_dwordx4 a[60:63], v112, s[8:11], s52 offen offset:1024 sc1
s_add_u32 s52, s52, 8192
s_add_u32 m0, s44, 32768
s_nop 0
buffer_load_dwordx4 v114, s[12:15], s48 offen offset:0 lds
buffer_load_dwordx4 v114, s[12:15], s49 offen offset:1024 lds
buffer_load_dwordx4 v114, s[12:15], s50 offen offset:2048 lds
buffer_load_dwordx4 v114, s[12:15], s51 offen offset:3072 lds
v_xor_b32 v114, 128, v114
s_cmp_lg_u32 s40, 0
s_cbranch_scc1 L_nowd
s_add_u32 m0, s35, 0
s_nop 0
s_nop 0
buffer_load_dwordx4 v125, s[60:63], s48 offen offset:0 lds
buffer_load_dwordx4 v125, s[60:63], s49 offen offset:1024 lds
buffer_load_dwordx4 v125, s[60:63], s50 offen offset:2048 lds
buffer_load_dwordx4 v125, s[60:63], s51 offen offset:3072 lds
v_add_u32 v125, 65536, v125
s_add_u32 m0, s35, 4096
s_nop 0
buffer_load_dwordx4 v125, s[60:63], s48 offen offset:0 lds
buffer_load_dwordx4 v125, s[60:63], s49 offen offset:1024 lds
buffer_load_dwordx4 v125, s[60:63], s50 offen offset:2048 lds
buffer_load_dwordx4 v125, s[60:63], s51 offen offset:3072 lds
L_nowd:
s_cmp_lt_u32 s2, 128
s_cbranch_scc1 L_noc3
s_bfe_u32 s3, s2, 0x40003
s_lshl_b32 s3, s3, 2
s_add_u32 s3, s3, s32
s_lshl_b32 s3, s3, 15
s_and_b32 s7, s2, 1
s_lshl_b32 s7, s7, 22
s_add_u32 s3, s3, s7
s_add_u32 s3, s3, 384
v_and_b32 v1, 15, v0
v_lshlrev_b32 v1, 11, v1
v_lshrrev_b32_e64 v11, 5, v0
v_lshl_add_u32 v1, v11, 10, v1
buffer_load_dword v11, v1, s[28:31], s3 offen
L_noc3:
s_barrier
s_nop 0
ds_read_b64_tr_b16 v[192:193], v115 offset:0
ds_read_b64_tr_b16 v[194:195], v115 offset:2048
ds_read_b64_tr_b16 v[196:197], v115 offset:4096
ds_read_b64_tr_b16 v[198:199], v115 offset:6144
ds_read_b64_tr_b16 v[200:201], v115 offset:8192
ds_read_b64_tr_b16 v[202:203], v115 offset:10240
ds_read_b64_tr_b16 v[204:205], v115 offset:12288
ds_read_b64_tr_b16 v[206:207], v115 offset:14336
ds_read_b64_tr_b16 v[208:209], v116 offset:0
ds_read_b64_tr_b16 v[210:211], v116 offset:2048
ds_read_b64_tr_b16 v[212:213], v116 offset:4096
ds_read_b64_tr_b16 v[214:215], v116 offset:6144
ds_read_b64_tr_b16 v[216:217], v116 offset:8192
ds_read_b64_tr_b16 v[218:219], v116 offset:10240
ds_read_b64_tr_b16 v[220:221], v116 offset:12288
s_waitcnt lgkmcnt(9)
ds_read_b64_tr_b16 v[222:223], v116 offset:14336
s_waitcnt vmcnt(12)
s_waitcnt lgkmcnt(8)
Zvva 160,192,0
ds_read_b64_tr_b16 v[224:225], v117 offset:0
ds_read_b64_tr_b16 v[226:227], v117 offset:2048
v_mov_b32 v125, 1
Mvva 160,196,8
s_sub_u32 s65, s65, s33
s_lshl_b32 s65, s65, 2
v_mul_lo_u32 v124, v0, s65
Mvva 160,200,16
s_add_u32 m0, s44, 49152
ds_read_b64_tr_b16 v[228:229], v117 offset:4096
ds_read_b64_tr_b16 v[230:231], v117 offset:6144
Mvva 160,204,24
buffer_load_dwordx4 v114, s[12:15], s48 offen offset:0 lds
Zvva 176,192,4
s_waitcnt lgkmcnt(4)
ds_read_b64_tr_b16 v[232:233], v117 offset:8192
ds_read_b64_tr_b16 v[234:235], v117 offset:10240
Mvva 176,196,12
s_lshl_b32 s6, s33, 2
v_add_u32_e64 v124, s6, v124
Mvva 176,200,20
ds_read_b64_tr_b16 v[236:237], v117 offset:12288
ds_read_b64_tr_b16 v[238:239], v117 offset:14336
Mvva 176,204,28
buffer_load_dwordx4 v114, s[12:15], s49 offen offset:1024 lds
Zvva 164,208,0
ds_read_b64_tr_b16 v[240:241], v118 offset:0
ds_read_b64_tr_b16 v[242:243], v118 offset:2048
Mvva 164,212,8
s_mov_b32 s6, 5447680
s_cmp_eq_u32 s32, 0
s_cselect_b32 s6, s6, s64
s_cmp_ge_u32 s34, 1
s_cselect_b32 s6, s6, 2146435072
Mvva 164,216,16
s_waitcnt lgkmcnt(2)
ds_read_b64_tr_b16 v[244:245], v118 offset:4096
ds_read_b64_tr_b16 v[246:247], v118 offset:6144
Mvva 164,220,24
buffer_load_dwordx4 v114, s[12:15], s50 offen offset:2048 lds
Zvva 180,208,4
ds_read_b64_tr_b16 v[248:249], v118 offset:8192
ds_read_b64_tr_b16 v[250:251], v118 offset:10240
Mvva 180,212,12
s_mov_b64 exec, 3
buffer_store_dword v125, v124, s[20:23], s6 offen sc1
s_mov_b64 exec, -1
Mvva 180,216,20
s_barrier
ds_read_b64_tr_b16 v[252:253], v118 offset:12288
ds_read_b64_tr_b16 v[254:255], v118 offset:14336
Mvva 180,220,28
buffer_load_dwordx4 v114, s[12:15], s51 offen offset:3072 lds
v_xor_b32 v114, 128, v114
v_add_u32 v114, 262144, v114
Zvva 168,224,0
ds_read_b64_tr_b16 v[192:193], v115 offset:16384
ds_read_b64_tr_b16 v[194:195], v115 offset:18432
Mvva 168,228,8
s_lshl_b32 s40, s45, 2
s_add_u32 s40, s40, s32
s_lshr_b32 s3, s42, 5
s_lshr_b32 s47, s43, 5
s_cmp_eq_u32 s3, s40
s_cselect_b32 s53, 1, 0
s_cmp_eq_u32 s47, s40
s_cselect_b32 s53, 1, s53
s_mov_b32 s40, 0
Mvva 168,232,16
ds_read_b64_tr_b16 v[196:197], v115 offset:20480
ds_read_b64_tr_b16 v[198:199], v115 offset:22528
Mvva 168,236,24
buffer_load_dwordx4 a[64:67], v112, s[8:11], s52 offen offset:0 sc1
Zvva 184,224,4
s_waitcnt lgkmcnt(4)
ds_read_b64_tr_b16 v[200:201], v115 offset:24576
ds_read_b64_tr_b16 v[202:203], v115 offset:26624
Mvva 184,228,12
s_lshl_b32 s41, s46, 7
s_add_u32 s41, s41, 5449728
s_lshl_b32 s55, s46, 13
Mvva 184,232,20
ds_read_b64_tr_b16 v[204:205], v115 offset:28672
ds_read_b64_tr_b16 v[206:207], v115 offset:30720
Mvva 184,236,28
buffer_load_dwordx4 a[68:71], v112, s[8:11], s52 offen offset:1024 sc1
s_add_u32 s52, s52, 8192
Zvva 172,240,0
ds_read_b64_tr_b16 v[208:209], v116 offset:16384
ds_read_b64_tr_b16 v[210:211], v116 offset:18432
Mvva 172,244,8
s_add_u32 s55, s55, 5308416
s_add_u32 s16, s66, 88080384
s_addc_u32 s17, s67, 0
s_and_b32 s17, s17, 0xffff
Mvva 172,248,16
ds_read_b64_tr_b16 v[212:213], v116 offset:20480
ds_read_b64_tr_b16 v[214:215], v116 offset:22528
Mvva 172,252,24
buffer_load_dwordx4 a[72:75], v112, s[8:11], s52 offen offset:0 sc1
Zvva 188,240,4
s_waitcnt lgkmcnt(4)
ds_read_b64_tr_b16 v[216:217], v116 offset:24576
ds_read_b64_tr_b16 v[218:219], v116 offset:26624
Mvva 188,244,12
s_mov_b32 s18, 8388608
s_mov_b32 s19, 0x20000
s_lshl_b32 s24, s2, 2
Mvva 188,248,20
ds_read_b64_tr_b16 v[220:221], v116 offset:28672
ds_read_b64_tr_b16 v[222:223], v116 offset:30720
Mvva 188,252,28
buffer_load_dwordx4 a[76:79], v112, s[8:11], s52 offen offset:1024 sc1
s_add_u32 s52, s52, 8192
Zvva 128,192,0
ds_read_b64_tr_b16 v[224:225], v117 offset:16384
ds_read_b64_tr_b16 v[226:227], v117 offset:18432
Mvva 128,196,8
s_add_u32 s24, s24, s32
s_lshl_b32 s25, s24, 13
s_xor_b32 s26, s25, 32768
Mvva 128,200,16
s_add_u32 m0, s44, 65536
ds_read_b64_tr_b16 v[228:229], v117 offset:20480
ds_read_b64_tr_b16 v[230:231], v117 offset:22528
Mvva 128,204,24
buffer_load_dwordx4 v114, s[12:15], s48 offen offset:0 lds
Zvva 144,192,4
s_waitcnt lgkmcnt(4)
ds_read_b64_tr_b16 v[232:233], v117 offset:24576
ds_read_b64_tr_b16 v[234:235], v117 offset:26624
Mvva 144,196,12
s_lshl_b32 s24, s24, 2
s_xor_b32 s27, s24, 16
s_add_u32 s24, s24, 5452800
Mvva 144,200,20
ds_read_b64_tr_b16 v[236:237], v117 offset:28672
ds_read_b64_tr_b16 v[238:239], v117 offset:30720
Mvva 144,204,28
buffer_load_dwordx4 v114, s[12:15], s49 offen offset:1024 lds
Zvva 132,208,0
ds_read_b64_tr_b16 v[240:241], v118 offset:16384
ds_read_b64_tr_b16 v[242:243], v118 offset:18432
Mvva 132,212,8
s_add_u32 s27, s27, 5452800
v_add_u32 v106, s35, v115
v_add_u32 v107, s35, v116
v_add_u32 v108, s35, v117
Mvva 132,216,16
s_waitcnt lgkmcnt(2)
ds_read_b64_tr_b16 v[244:245], v118 offset:20480
ds_read_b64_tr_b16 v[246:247], v118 offset:22528
v_add_u32 v109, s35, v118
Mvva 132,220,24
buffer_load_dwordx4 v114, s[12:15], s50 offen offset:2048 lds
Zvva 148,208,4
s_waitcnt vmcnt(12)
ds_read_b64_tr_b16 v[248:249], v118 offset:24576
ds_read_b64_tr_b16 v[250:251], v118 offset:26624
v_and_b32 v2, 1, v121
Mvva 148,212,12
v_lshlrev_b32 v2, 8, v2
v_and_b32 v3, 15, v0
v_lshl_add_u32 v2, v3, 3, v2
Mvva 148,216,20
s_barrier
ds_read_b64_tr_b16 v[252:253], v118 offset:28672
ds_read_b64_tr_b16 v[254:255], v118 offset:30720
v_add_u32 v2, s35, v2
Mvva 148,220,28
buffer_load_dwordx4 v114, s[12:15], s51 offen offset:3072 lds
v_xor_b32 v114, 128, v114
Zvva 136,224,0
ds_read_b64_tr_b16 v[192:193], v115 offset:32768
ds_read_b64_tr_b16 v[194:195], v115 offset:34816
v_and_b32_e64 v4, 1, v0
Mvva 136,228,8
v_lshlrev_b32 v4, 8, v4
v_add_u32 v4, s35, v4
v_lshl_add_u32 v3, v121, 3, v4
Mvva 136,232,16
ds_read_b64_tr_b16 v[196:197], v115 offset:36864
ds_read_b64_tr_b16 v[198:199], v115 offset:38912
v_lshl_add_u32 v4, v121, 4, v4
Mvva 136,236,24
buffer_load_dwordx4 a[80:83], v112, s[8:11], s52 offen offset:0 sc1
Zvva 152,224,4
s_waitcnt lgkmcnt(4)
ds_read_b64_tr_b16 v[200:201], v115 offset:40960
ds_read_b64_tr_b16 v[202:203], v115 offset:43008
v_lshlrev_b32 v5, 3, v0
Mvva 152,228,12
v_add_u32 v6, 133120, v5
v_mov_b32_e64 v7, 1
Mvva 152,232,20
ds_read_b64_tr_b16 v[204:205], v115 offset:45056
ds_read_b64_tr_b16 v[206:207], v115 offset:47104
Mvva 152,236,28
buffer_load_dwordx4 a[84:87], v112, s[8:11], s52 offen offset:1024 sc1
s_add_u32 s52, s52, 8192
Zvva 140,240,0
ds_read_b64_tr_b16 v[208:209], v116 offset:32768
ds_read_b64_tr_b16 v[210:211], v116 offset:34816
Mvva 140,244,8
s_lshl_b32 s4, s39, 4
s_add_u32 s4, s4, s37
s_lshl_b32 s4, s4, 9
Mvva 140,248,16
ds_read_b64_tr_b16 v[212:213], v116 offset:36864
ds_read_b64_tr_b16 v[214:215], v116 offset:38912
Mvva 140,252,24
buffer_load_dwordx4 a[88:91], v112, s[8:11], s52 offen offset:0 sc1
Zvva 156,240,4
s_waitcnt lgkmcnt(4)
ds_read_b64_tr_b16 v[216:217], v116 offset:40960
ds_read_b64_tr_b16 v[218:219], v116 offset:43008
Mvva 156,244,12
s_add_u32 s4, s4, 5308416
s_lshl_b32 s6, s39, 5
s_add_u32 s6, s6, s37
Mvva 156,248,20
ds_read_b64_tr_b16 v[220:221], v116 offset:45056
ds_read_b64_tr_b16 v[222:223], v116 offset:47104
Mvva 156,252,28
buffer_load_dwordx4 a[92:95], v112, s[8:11], s52 offen offset:1024 sc1
s_add_u32 s52, s52, 8192
Mvva 160,192,32
ds_read_b64_tr_b16 v[224:225], v117 offset:32768
ds_read_b64_tr_b16 v[226:227], v117 offset:34816
Mvva 160,196,40
s_lshl_b32 s6, s6, 2
s_add_u32 s6, s6, 5449728
s_cmp_eq_u32 s32, 0
s_cselect_b32 s4, s4, s64
s_cselect_b32 s6, s6, s64
Mvva 160,200,48
s_add_u32 m0, s44, 81920
ds_read_b64_tr_b16 v[228:229], v117 offset:36864
ds_read_b64_tr_b16 v[230:231], v117 offset:38912
Mvva 160,204,56
buffer_load_dwordx4 v114, s[12:15], s48 offen offset:0 lds
Mvva 176,192,36
s_waitcnt lgkmcnt(4)
ds_read_b64_tr_b16 v[232:233], v117 offset:40960
ds_read_b64_tr_b16 v[234:235], v117 offset:43008
Mvva 176,196,44
s_cmp_lt_u32 s93, 224
s_cselect_b32 s4, s4, 2146435072
s_cselect_b32 s6, s6, 2146435072
Mvva 176,200,52
ds_read_b64_tr_b16 v[236:237], v117 offset:45056
ds_read_b64_tr_b16 v[238:239], v117 offset:47104
Mvva 176,204,60
buffer_load_dwordx4 v114, s[12:15], s49 offen offset:1024 lds
Mvva 164,208,32
ds_read_b64_tr_b16 v[240:241], v118 offset:32768
ds_read_b64_tr_b16 v[242:243], v118 offset:34816
Mvva 164,212,40
Mvva 164,216,48
s_waitcnt lgkmcnt(2)
ds_read_b64_tr_b16 v[244:245], v118 offset:36864
ds_read_b64_tr_b16 v[246:247], v118 offset:38912
Mvva 164,220,56
buffer_load_dwordx4 v114, s[12:15], s50 offen offset:2048 lds
Mvva 180,208,36
s_waitcnt vmcnt(15)
ds_read_b64_tr_b16 v[248:249], v118 offset:40960
ds_read_b64_tr_b16 v[250:251], v118 offset:43008
Mvva 180,212,44
Mvva 180,216,52
s_barrier
ds_read_b64_tr_b16 v[252:253], v118 offset:45056
ds_read_b64_tr_b16 v[254:255], v118 offset:47104
Mvva 180,220,60
buffer_load_dwordx4 v114, s[12:15], s51 offen offset:3072 lds
v_xor_b32 v114, 128, v114
v_add_u32 v114, 262144, v114
Mvva 168,224,32
ds_read_b64_tr_b16 v[192:193], v115 offset:49152
ds_read_b64_tr_b16 v[194:195], v115 offset:51200
Mvva 168,228,40
Mvva 168,232,48
ds_read_b64_tr_b16 v[196:197], v115 offset:53248
ds_read_b64_tr_b16 v[198:199], v115 offset:55296
Mvva 168,236,56
buffer_load_dwordx4 a[96:99], v112, s[8:11], s52 offen offset:0 sc1
Mvva 184,224,36
s_waitcnt lgkmcnt(4)
ds_read_b64_tr_b16 v[200:201], v115 offset:57344
ds_read_b64_tr_b16 v[202:203], v115 offset:59392
Mvva 184,228,44
Mvva 184,232,52
ds_read_b64_tr_b16 v[204:205], v115 offset:61440
ds_read_b64_tr_b16 v[206:207], v115 offset:63488
Mvva 184,236,60
buffer_load_dwordx4 a[100:103], v112, s[8:11], s52 offen offset:1024 sc1
s_add_u32 s52, s52, 8192
Mvva 172,240,32
ds_read_b64_tr_b16 v[208:209], v116 offset:49152
ds_read_b64_tr_b16 v[210:211], v116 offset:51200
Mvva 172,244,40
Mvva 172,248,48
ds_read_b64_tr_b16 v[212:213], v116 offset:53248
ds_read_b64_tr_b16 v[214:215], v116 offset:55296
Mvva 172,252,56
buffer_load_dwordx4 a[104:107], v112, s[8:11], s52 offen offset:0 sc1
Mvva 188,240,36
s_waitcnt lgkmcnt(4)
ds_read_b64_tr_b16 v[216:217], v116 offset:57344
ds_read_b64_tr_b16 v[218:219], v116 offset:59392
Mvva 188,244,44
Mvva 188,248,52
ds_read_b64_tr_b16 v[220:221], v116 offset:61440
ds_read_b64_tr_b16 v[222:223], v116 offset:63488
Mvva 188,252,60
buffer_load_dwordx4 a[108:111], v112, s[8:11], s52 offen offset:1024 sc1
s_add_u32 s52, s52, 8192
Mvva 128,192,32
ds_read_b64_tr_b16 v[224:225], v117 offset:49152
ds_read_b64_tr_b16 v[226:227], v117 offset:51200
Mvva 128,196,40
Mvva 128,200,48
s_add_u32 m0, s44, 98304
ds_read_b64_tr_b16 v[228:229], v117 offset:53248
ds_read_b64_tr_b16 v[230:231], v117 offset:55296
Mvva 128,204,56
buffer_load_dwordx4 v114, s[12:15], s48 offen offset:0 lds
Mvva 144,192,36
s_waitcnt lgkmcnt(4)
ds_read_b64_tr_b16 v[232:233], v117 offset:57344
ds_read_b64_tr_b16 v[234:235], v117 offset:59392
Mvva 144,196,44
Mvva 144,200,52
ds_read_b64_tr_b16 v[236:237], v117 offset:61440
ds_read_b64_tr_b16 v[238:239], v117 offset:63488
Mvva 144,204,60
buffer_load_dwordx4 v114, s[12:15], s49 offen offset:1024 lds
Mvva 132,208,32
ds_read_b64_tr_b16 v[240:241], v118 offset:49152
ds_read_b64_tr_b16 v[242:243], v118 offset:51200
Mvva 132,212,40
Mvva 132,216,48
s_waitcnt lgkmcnt(2)
ds_read_b64_tr_b16 v[244:245], v118 offset:53248
ds_read_b64_tr_b16 v[246:247], v118 offset:55296
Mvva 132,220,56
buffer_load_dwordx4 v114, s[12:15], s50 offen offset:2048 lds
Mvva 148,208,36
s_waitcnt vmcnt(15)
ds_read_b64_tr_b16 v[248:249], v118 offset:57344
ds_read_b64_tr_b16 v[250:251], v118 offset:59392
Mvva 148,212,44
Mvva 148,216,52
s_barrier
ds_read_b64_tr_b16 v[252:253], v118 offset:61440
ds_read_b64_tr_b16 v[254:255], v118 offset:63488
Mvva 148,220,60
buffer_load_dwordx4 v114, s[12:15], s51 offen offset:3072 lds
v_xor_b32 v114, 128, v114
Mvva 136,224,32
ds_read_b64_tr_b16 v[192:193], v12 offset:0
ds_read_b64_tr_b16 v[194:195], v12 offset:2048
Mvva 136,228,40
Mvva 136,232,48
ds_read_b64_tr_b16 v[196:197], v12 offset:4096
ds_read_b64_tr_b16 v[198:199], v12 offset:6144
Mvva 136,236,56
buffer_load_dwordx4 a[112:115], v112, s[8:11], s52 offen offset:0 sc1
Mvva 152,224,36
s_waitcnt lgkmcnt(4)
ds_read_b64_tr_b16 v[200:201], v12 offset:8192
ds_read_b64_tr_b16 v[202:203], v12 offset:10240
Mvva 152,228,44
Mvva 152,232,52
ds_read_b64_tr_b16 v[204:205], v12 offset:12288
ds_read_b64_tr_b16 v[206:207], v12 offset:14336
Mvva 152,236,60
buffer_load_dwordx4 a[116:119], v112, s[8:11], s52 offen offset:1024 sc1
s_add_u32 s52, s52, 8192
Mvva 140,240,32
ds_read_b64_tr_b16 v[208:209], v13 offset:0
ds_read_b64_tr_b16 v[210:211], v13 offset:2048
Mvva 140,244,40
Mvva 140,248,48
ds_read_b64_tr_b16 v[212:213], v13 offset:4096
ds_read_b64_tr_b16 v[214:215], v13 offset:6144
Mvva 140,252,56
buffer_load_dwordx4 a[120:123], v112, s[8:11], s52 offen offset:0 sc1
Mvva 156,240,36
s_waitcnt lgkmcnt(4)
ds_read_b64_tr_b16 v[216:217], v13 offset:8192
ds_read_b64_tr_b16 v[218:219], v13 offset:10240
Mvva 156,244,44
Mvva 156,248,52
s_waitcnt vmcnt(15)
ds_read_b64_tr_b16 v[220:221], v13 offset:12288
ds_read_b64_tr_b16 v[222:223], v13 offset:14336
Mvva 156,252,60
buffer_load_dwordx4 a[124:127], v112, s[8:11], s52 offen offset:1024 sc1
s_add_u32 s52, s52, 8192
Mvva 160,192,64
ds_read_b64_tr_b16 v[224:225], v14 offset:0
ds_read_b64_tr_b16 v[226:227], v14 offset:2048
Mvva 160,196,72
Mvva 160,200,80
s_add_u32 m0, s44, 114688
ds_read_b64_tr_b16 v[228:229], v14 offset:4096
ds_read_b64_tr_b16 v[230:231], v14 offset:6144
Mvva 160,204,88
buffer_load_dwordx4 v114, s[12:15], s48 offen offset:0 lds
Mvva 176,192,68
s_waitcnt lgkmcnt(4)
ds_read_b64_tr_b16 v[232:233], v14 offset:8192
ds_read_b64_tr_b16 v[234:235], v14 offset:10240
Mvva 176,196,76
Mvva 176,200,84
ds_read_b64_tr_b16 v[236:237], v14 offset:12288
ds_read_b64_tr_b16 v[238:239], v14 offset:14336
Mvva 176,204,92
buffer_load_dwordx4 v114, s[12:15], s49 offen offset:1024 lds
Mvva 164,208,64
ds_read_b64_tr_b16 v[240:241], v15 offset:0
ds_read_b64_tr_b16 v[242:243], v15 offset:2048
Mvva 164,212,72
Mvva 164,216,80
s_waitcnt lgkmcnt(2)
ds_read_b64_tr_b16 v[244:245], v15 offset:4096
ds_read_b64_tr_b16 v[246:247], v15 offset:6144
Mvva 164,220,88
buffer_load_dwordx4 v114, s[12:15], s50 offen offset:2048 lds
Mvva 180,208,68
s_waitcnt vmcnt(15)
ds_read_b64_tr_b16 v[248:249], v15 offset:8192
ds_read_b64_tr_b16 v[250:251], v15 offset:10240
Mvva 180,212,76
Mvva 180,216,84
s_barrier
ds_read_b64_tr_b16 v[252:253], v15 offset:12288
ds_read_b64_tr_b16 v[254:255], v15 offset:14336
Mvva 180,220,92
buffer_load_dwordx4 v114, s[12:15], s51 offen offset:3072 lds
v_xor_b32 v114, 128, v114
v_add_u32 v114, 262144, v114
Mvva 168,224,64
ds_read_b64_tr_b16 v[192:193], v12 offset:16384
ds_read_b64_tr_b16 v[194:195], v12 offset:18432
Mvva 168,228,72
Mvva 168,232,80
ds_read_b64_tr_b16 v[196:197], v12 offset:20480
ds_read_b64_tr_b16 v[198:199], v12 offset:22528
Mvva 168,236,88
buffer_load_dwordx4 a[128:131], v112, s[8:11], s52 offen offset:0 sc1
Mvva 184,224,68
s_waitcnt lgkmcnt(4)
ds_read_b64_tr_b16 v[200:201], v12 offset:24576
ds_read_b64_tr_b16 v[202:203], v12 offset:26624
Mvva 184,228,76
Mvva 184,232,84
ds_read_b64_tr_b16 v[204:205], v12 offset:28672
ds_read_b64_tr_b16 v[206:207], v12 offset:30720
Mvva 184,236,92
buffer_load_dwordx4 a[132:135], v112, s[8:11], s52 offen offset:1024 sc1
s_add_u32 s52, s52, 8192
Mvva 172,240,64
ds_read_b64_tr_b16 v[208:209], v13 offset:16384
ds_read_b64_tr_b16 v[210:211], v13 offset:18432
Mvva 172,244,72
Mvva 172,248,80
ds_read_b64_tr_b16 v[212:213], v13 offset:20480
ds_read_b64_tr_b16 v[214:215], v13 offset:22528
Mvva 172,252,88
buffer_load_dwordx4 a[136:139], v112, s[8:11], s52 offen offset:0 sc1
Mvva 188,240,68
s_waitcnt lgkmcnt(4)
ds_read_b64_tr_b16 v[216:217], v13 offset:24576
ds_read_b64_tr_b16 v[218:219], v13 offset:26624
Mvva 188,244,76
Mvva 188,248,84
ds_read_b64_tr_b16 v[220:221], v13 offset:28672
ds_read_b64_tr_b16 v[222:223], v13 offset:30720
Mvva 188,252,92
buffer_load_dwordx4 a[140:143], v112, s[8:11], s52 offen offset:1024 sc1
s_add_u32 s52, s52, 8192
Mvva 128,192,64
ds_read_b64_tr_b16 v[224:225], v14 offset:16384
ds_read_b64_tr_b16 v[226:227], v14 offset:18432
Mvva 128,196,72
s_cmp_lt_u32 s93, 224
s_cbranch_scc1 L_f2A
L_f2Ar:
Mvva 128,200,80
s_add_u32 m0, s44, 0
ds_read_b64_tr_b16 v[228:229], v14 offset:20480
ds_read_b64_tr_b16 v[230:231], v14 offset:22528
Mvva 128,204,88
buffer_load_dwordx4 v114, s[12:15], s48 offen offset:0 lds
Mvva 144,192,68
s_waitcnt lgkmcnt(4)
ds_read_b64_tr_b16 v[232:233], v14 offset:24576
ds_read_b64_tr_b16 v[234:235], v14 offset:26624
Mvva 144,196,76
Mvva 144,200,84
ds_read_b64_tr_b16 v[236:237], v14 offset:28672
ds_read_b64_tr_b16 v[238:239], v14 offset:30720
Mvva 144,204,92
buffer_load_dwordx4 v114, s[12:15], s49 offen offset:1024 lds
Mvva 132,208,64
ds_read_b64_tr_b16 v[240:241], v15 offset:16384
ds_read_b64_tr_b16 v[242:243], v15 offset:18432
Mvva 132,212,72
Mvva 132,216,80
s_waitcnt lgkmcnt(2)
ds_read_b64_tr_b16 v[244:245], v15 offset:20480
ds_read_b64_tr_b16 v[246:247], v15 offset:22528
Mvva 132,220,88
buffer_load_dwordx4 v114, s[12:15], s50 offen offset:2048 lds
Mvva 148,208,68
s_waitcnt vmcnt(15)
ds_read_b64_tr_b16 v[248:249], v15 offset:24576
ds_read_b64_tr_b16 v[250:251], v15 offset:26624
Mvva 148,212,76
Mvva 148,216,84
s_barrier
ds_read_b64_tr_b16 v[252:253], v15 offset:28672
ds_read_b64_tr_b16 v[254:255], v15 offset:30720
Mvva 148,220,92
buffer_load_dwordx4 v114, s[12:15], s51 offen offset:3072 lds
v_xor_b32 v114, 128, v114
Mvva 136,224,64
ds_read_b64_tr_b16 v[192:193], v12 offset:32768
ds_read_b64_tr_b16 v[194:195], v12 offset:34816
Mvva 136,228,72
Mvva 136,232,80
ds_read_b64_tr_b16 v[196:197], v12 offset:36864
ds_read_b64_tr_b16 v[198:199], v12 offset:38912
Mvva 136,236,88
buffer_load_dwordx4 a[144:147], v112, s[8:11], s52 offen offset:0 sc1
Mvva 152,224,68
s_waitcnt lgkmcnt(4)
ds_read_b64_tr_b16 v[200:201], v12 offset:40960
ds_read_b64_tr_b16 v[202:203], v12 offset:43008
Mvva 152,228,76
Mvva 152,232,84
ds_read_b64_tr_b16 v[204:205], v12 offset:45056
ds_read_b64_tr_b16 v[206:207], v12 offset:47104
Mvva 152,236,92
buffer_load_dwordx4 a[148:151], v112, s[8:11], s52 offen offset:1024 sc1
s_add_u32 s52, s52, 8192
Mvva 140,240,64
ds_read_b64_tr_b16 v[208:209], v13 offset:32768
ds_read_b64_tr_b16 v[210:211], v13 offset:34816
Mvva 140,244,72
Mvva 140,248,80
ds_read_b64_tr_b16 v[212:213], v13 offset:36864
ds_read_b64_tr_b16 v[214:215], v13 offset:38912
Mvva 140,252,88
buffer_load_dwordx4 a[152:155], v112, s[8:11], s52 offen offset:0 sc1
Mvva 156,240,68
s_waitcnt lgkmcnt(4)
ds_read_b64_tr_b16 v[216:217], v13 offset:40960
ds_read_b64_tr_b16 v[218:219], v13 offset:43008
Mvva 156,244,76
Mvva 156,248,84
s_waitcnt vmcnt(15)
ds_read_b64_tr_b16 v[220:221], v13 offset:45056
ds_read_b64_tr_b16 v[222:223], v13 offset:47104
Mvva 156,252,92
buffer_load_dwordx4 a[156:159], v112, s[8:11], s52 offen offset:1024 sc1
s_add_u32 s52, s52, 8192
Mvva 160,192,96
ds_read_b64_tr_b16 v[224:225], v14 offset:32768
ds_read_b64_tr_b16 v[226:227], v14 offset:34816
Mvva 160,196,104
Mvva 160,200,112
s_add_u32 m0, s44, 16384
ds_read_b64_tr_b16 v[228:229], v14 offset:36864
ds_read_b64_tr_b16 v[230:231], v14 offset:38912
Mvva 160,204,120
buffer_load_dwordx4 v114, s[12:15], s48 offen offset:0 lds
Mvva 176,192,100
s_waitcnt lgkmcnt(4)
ds_read_b64_tr_b16 v[232:233], v14 offset:40960
ds_read_b64_tr_b16 v[234:235], v14 offset:43008
Mvva 176,196,108
Mvva 176,200,116
ds_read_b64_tr_b16 v[236:237], v14 offset:45056
ds_read_b64_tr_b16 v[238:239], v14 offset:47104
Mvva 176,204,124
buffer_load_dwordx4 v114, s[12:15], s49 offen offset:1024 lds
Mvva 164,208,96
ds_read_b64_tr_b16 v[240:241], v15 offset:32768
ds_read_b64_tr_b16 v[242:243], v15 offset:34816
Mvva 164,212,104
Mvva 164,216,112
s_waitcnt lgkmcnt(2)
ds_read_b64_tr_b16 v[244:245], v15 offset:36864
ds_read_b64_tr_b16 v[246:247], v15 offset:38912
Mvva 164,220,120
buffer_load_dwordx4 v114, s[12:15], s50 offen offset:2048 lds
Mvva 180,208,100
s_waitcnt vmcnt(15)
ds_read_b64_tr_b16 v[248:249], v15 offset:40960
ds_read_b64_tr_b16 v[250:251], v15 offset:43008
Mvva 180,212,108
Mvva 180,216,116
s_barrier
ds_read_b64_tr_b16 v[252:253], v15 offset:45056
ds_read_b64_tr_b16 v[254:255], v15 offset:47104
Mvva 180,220,124
buffer_load_dwordx4 v114, s[12:15], s51 offen offset:3072 lds
v_xor_b32 v114, 128, v114
v_add_u32 v114, 262144, v114
Mvva 168,224,96
ds_read_b64_tr_b16 v[192:193], v12 offset:49152
ds_read_b64_tr_b16 v[194:195], v12 offset:51200
Mvva 168,228,104
Mvva 168,232,112
ds_read_b64_tr_b16 v[196:197], v12 offset:53248
ds_read_b64_tr_b16 v[198:199], v12 offset:55296
Mvva 168,236,120
buffer_load_dwordx4 a[160:163], v112, s[8:11], s52 offen offset:0 sc1
Mvva 184,224,100
s_waitcnt lgkmcnt(4)
ds_read_b64_tr_b16 v[200:201], v12 offset:57344
ds_read_b64_tr_b16 v[202:203], v12 offset:59392
Mvva 184,228,108
Mvva 184,232,116
ds_read_b64_tr_b16 v[204:205], v12 offset:61440
ds_read_b64_tr_b16 v[206:207], v12 offset:63488
Mvva 184,236,124
buffer_load_dwordx4 a[164:167], v112, s[8:11], s52 offen offset:1024 sc1
s_add_u32 s52, s52, 8192
Mvva 172,240,96
ds_read_b64_tr_b16 v[208:209], v13 offset:49152
ds_read_b64_tr_b16 v[210:211], v13 offset:51200
Mvva 172,244,104
Mvva 172,248,112
ds_read_b64_tr_b16 v[212:213], v13 offset:53248
ds_read_b64_tr_b16 v[214:215], v13 offset:55296
Mvva 172,252,120
buffer_load_dwordx4 a[168:171], v112, s[8:11], s52 offen offset:0 sc1
Mvva 188,240,100
s_waitcnt lgkmcnt(4)
ds_read_b64_tr_b16 v[216:217], v13 offset:57344
ds_read_b64_tr_b16 v[218:219], v13 offset:59392
Mvva 188,244,108
Mvva 188,248,116
ds_read_b64_tr_b16 v[220:221], v13 offset:61440
ds_read_b64_tr_b16 v[222:223], v13 offset:63488
Mvva 188,252,124
buffer_load_dwordx4 a[172:175], v112, s[8:11], s52 offen offset:1024 sc1
s_add_u32 s52, s52, 8192
Mvva 128,192,96
ds_read_b64_tr_b16 v[224:225], v14 offset:49152
ds_read_b64_tr_b16 v[226:227], v14 offset:51200
Mvva 128,196,104
Mvva 128,200,112
s_add_u32 m0, s44, 32768
ds_read_b64_tr_b16 v[228:229], v14 offset:53248
ds_read_b64_tr_b16 v[230:231], v14 offset:55296
Mvva 128,204,120
buffer_load_dwordx4 v114, s[12:15], s48 offen offset:0 lds
Mvva 144,192,100
s_waitcnt lgkmcnt(4)
ds_read_b64_tr_b16 v[232:233], v14 offset:57344
ds_read_b64_tr_b16 v[234:235], v14 offset:59392
Mvva 144,196,108
Mvva 144,200,116
ds_read_b64_tr_b16 v[236:237], v14 offset:61440
ds_read_b64_tr_b16 v[238:239], v14 offset:63488
Mvva 144,204,124
buffer_load_dwordx4 v114, s[12:15], s49 offen offset:1024 lds
Mvva 132,208,96
ds_read_b64_tr_b16 v[240:241], v15 offset:49152
ds_read_b64_tr_b16 v[242:243], v15 offset:51200
Mvva 132,212,104
Mvva 132,216,112
s_waitcnt lgkmcnt(2)
ds_read_b64_tr_b16 v[244:245], v15 offset:53248
ds_read_b64_tr_b16 v[246:247], v15 offset:55296
Mvva 132,220,120
buffer_load_dwordx4 v114, s[12:15], s50 offen offset:2048 lds
Mvva 148,208,100
s_waitcnt vmcnt(15)
ds_read_b64_tr_b16 v[248:249], v15 offset:57344
ds_read_b64_tr_b16 v[250:251], v15 offset:59392
Mvva 148,212,108
s_cmp_lt_u32 s93, 224
s_cbranch_scc1 L_f2B
L_f2Br:
Mvva 148,216,116
s_barrier
ds_read_b64_tr_b16 v[252:253], v15 offset:61440
ds_read_b64_tr_b16 v[254:255], v15 offset:63488
Mvva 148,220,124
buffer_load_dwordx4 v114, s[12:15], s51 offen offset:3072 lds
v_xor_b32 v114, 128, v114
Mvva 136,224,96
ds_read_b64_tr_b16 v[192:193], v115 offset:0
ds_read_b64_tr_b16 v[194:195], v115 offset:2048
Mvva 136,228,104
Mvva 136,232,112
ds_read_b64_tr_b16 v[196:197], v115 offset:4096
ds_read_b64_tr_b16 v[198:199], v115 offset:6144
Mvva 136,236,120
buffer_load_dwordx4 a[176:179], v112, s[8:11], s52 offen offset:0 sc1
Mvva 152,224,100
s_waitcnt lgkmcnt(4)
ds_read_b64_tr_b16 v[200:201], v115 offset:8192
ds_read_b64_tr_b16 v[202:203], v115 offset:10240
Mvva 152,228,108
Mvva 152,232,116
ds_read_b64_tr_b16 v[204:205], v115 offset:12288
ds_read_b64_tr_b16 v[206:207], v115 offset:14336
Mvva 152,236,124
buffer_load_dwordx4 a[180:183], v112, s[8:11], s52 offen offset:1024 sc1
s_add_u32 s52, s52, 8192
Mvva 140,240,96
ds_read_b64_tr_b16 v[208:209], v116 offset:0
ds_read_b64_tr_b16 v[210:211], v116 offset:2048
Mvva 140,244,104
Mvva 140,248,112
ds_read_b64_tr_b16 v[212:213], v116 offset:4096
ds_read_b64_tr_b16 v[214:215], v116 offset:6144
Mvva 140,252,120
buffer_load_dwordx4 a[184:187], v112, s[8:11], s52 offen offset:0 sc1
Mvva 156,240,100
s_waitcnt lgkmcnt(4)
ds_read_b64_tr_b16 v[216:217], v116 offset:8192
ds_read_b64_tr_b16 v[218:219], v116 offset:10240
Mvva 156,244,108
Mvva 156,248,116
s_waitcnt vmcnt(15)
ds_read_b64_tr_b16 v[220:221], v116 offset:12288
ds_read_b64_tr_b16 v[222:223], v116 offset:14336
Mvva 156,252,124
buffer_load_dwordx4 a[188:191], v112, s[8:11], s52 offen offset:1024 sc1
s_add_u32 s52, s52, 8192
Mvva 160,192,128
ds_read_b64_tr_b16 v[224:225], v117 offset:0
ds_read_b64_tr_b16 v[226:227], v117 offset:2048
Mvva 160,196,136
Mvva 160,200,144
s_add_u32 m0, s44, 49152
ds_read_b64_tr_b16 v[228:229], v117 offset:4096
ds_read_b64_tr_b16 v[230:231], v117 offset:6144
Mvva 160,204,152
buffer_load_dwordx4 v114, s[12:15], s48 offen offset:0 lds
Mvva 176,192,132
s_waitcnt lgkmcnt(4)
ds_read_b64_tr_b16 v[232:233], v117 offset:8192
ds_read_b64_tr_b16 v[234:235], v117 offset:10240
Mvva 176,196,140
Mvva 176,200,148
ds_read_b64_tr_b16 v[236:237], v117 offset:12288
ds_read_b64_tr_b16 v[238:239], v117 offset:14336
Mvva 176,204,156
buffer_load_dwordx4 v114, s[12:15], s49 offen offset:1024 lds
Mvva 164,208,128
ds_read_b64_tr_b16 v[240:241], v118 offset:0
ds_read_b64_tr_b16 v[242:243], v118 offset:2048
Mvva 164,212,136
Mvva 164,216,144
s_waitcnt lgkmcnt(2)
ds_read_b64_tr_b16 v[244:245], v118 offset:4096
ds_read_b64_tr_b16 v[246:247], v118 offset:6144
Mvva 164,220,152
buffer_load_dwordx4 v114, s[12:15], s50 offen offset:2048 lds
Mvva 180,208,132
s_waitcnt vmcnt(15)
ds_read_b64_tr_b16 v[248:249], v118 offset:8192
ds_read_b64_tr_b16 v[250:251], v118 offset:10240
Mvva 180,212,140
Mvva 180,216,148
s_barrier
ds_read_b64_tr_b16 v[252:253], v118 offset:12288
ds_read_b64_tr_b16 v[254:255], v118 offset:14336
Mvva 180,220,156
buffer_load_dwordx4 v114, s[12:15], s51 offen offset:3072 lds
v_xor_b32 v114, 128, v114
v_add_u32 v114, 262144, v114
Mvva 168,224,128
ds_read_b64_tr_b16 v[192:193], v115 offset:16384
ds_read_b64_tr_b16 v[194:195], v115 offset:18432
Mvva 168,228,136
Mvva 168,232,144
ds_read_b64_tr_b16 v[196:197], v115 offset:20480
ds_read_b64_tr_b16 v[198:199], v115 offset:22528
Mvva 168,236,152
buffer_load_dwordx4 a[192:195], v112, s[8:11], s52 offen offset:0 sc1
Mvva 184,224,132
s_waitcnt lgkmcnt(4)
ds_read_b64_tr_b16 v[200:201], v115 offset:24576
ds_read_b64_tr_b16 v[202:203], v115 offset:26624
Mvva 184,228,140
Mvva 184,232,148
ds_read_b64_tr_b16 v[204:205], v115 offset:28672
ds_read_b64_tr_b16 v[206:207], v115 offset:30720
Mvva 184,236,156
buffer_load_dwordx4 a[196:199], v112, s[8:11], s52 offen offset:1024 sc1
s_add_u32 s52, s52, 8192
Mvva 172,240,128
ds_read_b64_tr_b16 v[208:209], v116 offset:16384
ds_read_b64_tr_b16 v[210:211], v116 offset:18432
Mvva 172,244,136
Mvva 172,248,144
ds_read_b64_tr_b16 v[212:213], v116 offset:20480
ds_read_b64_tr_b16 v[214:215], v116 offset:22528
Mvva 172,252,152
buffer_load_dwordx4 a[200:203], v112, s[8:11], s52 offen offset:0 sc1
Mvva 188,240,132
s_waitcnt lgkmcnt(4)
ds_read_b64_tr_b16 v[216:217], v116 offset:24576
ds_read_b64_tr_b16 v[218:219], v116 offset:26624
Mvva 188,244,140
Mvva 188,248,148
ds_read_b64_tr_b16 v[220:221], v116 offset:28672
ds_read_b64_tr_b16 v[222:223], v116 offset:30720
Mvva 188,252,156
buffer_load_dwordx4 a[204:207], v112, s[8:11], s52 offen offset:1024 sc1
s_add_u32 s52, s52, 8192
Mvva 128,192,128
ds_read_b64_tr_b16 v[224:225], v117 offset:16384
ds_read_b64_tr_b16 v[226:227], v117 offset:18432
Mvva 128,196,136
Mvva 128,200,144
s_add_u32 m0, s44, 65536
ds_read_b64_tr_b16 v[228:229], v117 offset:20480
ds_read_b64_tr_b16 v[230:231], v117 offset:22528
Mvva 128,204,152
buffer_load_dwordx4 v114, s[12:15], s48 offen offset:0 lds
Mvva 144,192,132
s_waitcnt lgkmcnt(4)
ds_read_b64_tr_b16 v[232:233], v117 offset:24576
ds_read_b64_tr_b16 v[234:235], v117 offset:26624
Mvva 144,196,140
Mvva 144,200,148
ds_read_b64_tr_b16 v[236:237], v117 offset:28672
ds_read_b64_tr_b16 v[238:239], v117 offset:30720
Mvva 144,204,156
buffer_load_dwordx4 v114, s[12:15], s49 offen offset:1024 lds
Mvva 132,208,128
ds_read_b64_tr_b16 v[240:241], v118 offset:16384
ds_read_b64_tr_b16 v[242:243], v118 offset:18432
Mvva 132,212,136
Mvva 132,216,144
s_waitcnt lgkmcnt(2)
ds_read_b64_tr_b16 v[244:245], v118 offset:20480
ds_read_b64_tr_b16 v[246:247], v118 offset:22528
Mvva 132,220,152
buffer_load_dwordx4 v114, s[12:15], s50 offen offset:2048 lds
Mvva 148,208,132
s_waitcnt vmcnt(15)
ds_read_b64_tr_b16 v[248:249], v118 offset:24576
ds_read_b64_tr_b16 v[250:251], v118 offset:26624
Mvva 148,212,140
Mvva 148,216,148
s_barrier
ds_read_b64_tr_b16 v[252:253], v118 offset:28672
ds_read_b64_tr_b16 v[254:255], v118 offset:30720
Mvva 148,220,156
buffer_load_dwordx4 v114, s[12:15], s51 offen offset:3072 lds
v_xor_b32 v114, 128, v114
Mvva 136,224,128
ds_read_b64_tr_b16 v[192:193], v115 offset:32768
ds_read_b64_tr_b16 v[194:195], v115 offset:34816
Mvva 136,228,136
s_cmp_ge_u32 s2, 128
s_cbranch_scc1 L_c31
L_c31r:
Mvva 136,232,144
ds_read_b64_tr_b16 v[196:197], v115 offset:36864
ds_read_b64_tr_b16 v[198:199], v115 offset:38912
Mvva 136,236,152
buffer_load_dwordx4 a[208:211], v112, s[8:11], s52 offen offset:0 sc1
Mvva 152,224,132
s_waitcnt lgkmcnt(4)
ds_read_b64_tr_b16 v[200:201], v115 offset:40960
ds_read_b64_tr_b16 v[202:203], v115 offset:43008
Mvva 152,228,140
Mvva 152,232,148
ds_read_b64_tr_b16 v[204:205], v115 offset:45056
ds_read_b64_tr_b16 v[206:207], v115 offset:47104
Mvva 152,236,156
buffer_load_dwordx4 a[212:215], v112, s[8:11], s52 offen offset:1024 sc1
s_add_u32 s52, s52, 8192
Mvva 140,240,128
ds_read_b64_tr_b16 v[208:209], v116 offset:32768
ds_read_b64_tr_b16 v[210:211], v116 offset:34816
Mvva 140,244,136
Mvva 140,248,144
ds_read_b64_tr_b16 v[212:213], v116 offset:36864
ds_read_b64_tr_b16 v[214:215], v116 offset:38912
Mvva 140,252,152
buffer_load_dwordx4 a[216:219], v112, s[8:11], s52 offen offset:0 sc1
Mvva 156,240,132
s_waitcnt lgkmcnt(4)
ds_read_b64_tr_b16 v[216:217], v116 offset:40960
ds_read_b64_tr_b16 v[218:219], v116 offset:43008
Mvva 156,244,140
s_waitcnt vmcnt(16)
Va 74,74,78
Va 75,75,79
v_add_f32_e64 v76, v76, v80
Mvva 156,248,148
s_waitcnt vmcnt(15)
ds_read_b64_tr_b16 v[220:221], v116 offset:45056
ds_read_b64_tr_b16 v[222:223], v116 offset:47104
Va 77,77,81
Mvva 156,252,156
buffer_load_dwordx4 a[220:223], v112, s[8:11], s52 offen offset:1024 sc1
s_add_u32 s52, s52, 8192
Mvva 160,192,160
ds_read_b64_tr_b16 v[224:225], v117 offset:32768
ds_read_b64_tr_b16 v[226:227], v117 offset:34816
v_add_f32_e64 v74, v74, v82
Mvva 160,196,168
Va 75,75,83
Va 76,76,84
v_add_f32_e64 v77, v77, v85
Mvva 160,200,176
s_add_u32 m0, s44, 81920
ds_read_b64_tr_b16 v[228:229], v117 offset:36864
ds_read_b64_tr_b16 v[230:231], v117 offset:38912
v_add_f32_e64 v74, v74, v86
Mvva 160,204,184
buffer_load_dwordx4 v114, s[12:15], s48 offen offset:0 lds
Mvva 176,192,164
s_waitcnt lgkmcnt(4)
ds_read_b64_tr_b16 v[232:233], v117 offset:40960
ds_read_b64_tr_b16 v[234:235], v117 offset:43008
Va 75,75,87
Mvva 176,196,172
Va 76,76,88
Va 77,77,89
v_add_f32_e64 v74, v74, v90
Mvva 176,200,180
ds_read_b64_tr_b16 v[236:237], v117 offset:45056
ds_read_b64_tr_b16 v[238:239], v117 offset:47104
v_add_f32_e64 v75, v75, v91
Mvva 176,204,188
buffer_load_dwordx4 v114, s[12:15], s49 offen offset:1024 lds
Mvva 164,208,160
ds_read_b64_tr_b16 v[240:241], v118 offset:32768
ds_read_b64_tr_b16 v[242:243], v118 offset:34816
v_add_f32_e64 v76, v76, v92
Mvva 164,212,168
Va 77,77,93
Va 74,74,94
v_add_f32_e64 v75, v75, v95
Mvva 164,216,176
s_waitcnt lgkmcnt(2)
ds_read_b64_tr_b16 v[244:245], v118 offset:36864
ds_read_b64_tr_b16 v[246:247], v118 offset:38912
Va 76,76,96
Mvva 164,220,184
buffer_load_dwordx4 v114, s[12:15], s50 offen offset:2048 lds
Mvva 180,208,164
s_waitcnt vmcnt(15)
ds_read_b64_tr_b16 v[248:249], v118 offset:40960
ds_read_b64_tr_b16 v[250:251], v118 offset:43008
Va 77,77,97
Mvva 180,212,172
Va 74,74,98
Va 75,75,99
v_add_f32_e64 v76, v76, v100
Mvva 180,216,180
s_barrier
ds_read_b64_tr_b16 v[252:253], v118 offset:45056
ds_read_b64_tr_b16 v[254:255], v118 offset:47104
Va 77,77,101
Mvva 180,220,188
buffer_load_dwordx4 v114, s[12:15], s51 offen offset:3072 lds
v_xor_b32 v114, 128, v114
v_add_u32 v114, 262144, v114
Mvva 168,224,160
ds_read_b64_tr_b16 v[192:193], v115 offset:49152
ds_read_b64_tr_b16 v[194:195], v115 offset:51200
v_add_f32_e64 v74, v74, v102
Mvva 168,228,168
Va 75,75,103
Va 76,76,104
v_add_f32_e64 v77, v77, v105
Mvva 168,232,176
ds_read_b64_tr_b16 v[196:197], v115 offset:53248
ds_read_b64_tr_b16 v[198:199], v115 offset:55296
Mvva 168,236,184
buffer_load_dwordx4 a[224:227], v112, s[8:11], s52 offen offset:0 sc1
Mvva 184,224,164
s_waitcnt lgkmcnt(4)
ds_read_b64_tr_b16 v[200:201], v115 offset:57344
ds_read_b64_tr_b16 v[202:203], v115 offset:59392
Mvva 184,228,172
ds_read_b64_tr_b16 v[90:91], v106 offset:0
ds_read_b64_tr_b16 v[92:93], v106 offset:2048
ds_read_b64_tr_b16 v[94:95], v107 offset:0
Mvva 184,232,180
ds_read_b64_tr_b16 v[204:205], v115 offset:61440
ds_read_b64_tr_b16 v[206:207], v115 offset:63488
Mvva 184,236,188
buffer_load_dwordx4 a[228:231], v112, s[8:11], s52 offen offset:1024 sc1
s_add_u32 s52, s52, 8192
Mvva 172,240,160
ds_read_b64_tr_b16 v[208:209], v116 offset:49152
ds_read_b64_tr_b16 v[210:211], v116 offset:51200
Mvva 172,244,168
ds_read_b64_tr_b16 v[96:97], v107 offset:2048
ds_read_b64_tr_b16 v[98:99], v108 offset:0
s_waitcnt lgkmcnt(9)
ds_read_b64_tr_b16 v[100:101], v108 offset:2048
Mvva 172,248,176
ds_read_b64_tr_b16 v[212:213], v116 offset:53248
ds_read_b64_tr_b16 v[214:215], v116 offset:55296
Mvva 172,252,184
buffer_load_dwordx4 a[232:235], v112, s[8:11], s52 offen offset:0 sc1
Mvva 188,240,164
s_waitcnt lgkmcnt(7)
ds_read_b64_tr_b16 v[216:217], v116 offset:57344
ds_read_b64_tr_b16 v[218:219], v116 offset:59392
Mvva 188,244,172
ds_read_b64_tr_b16 v[102:103], v109 offset:0
ds_read_b64_tr_b16 v[104:105], v109 offset:2048
Vc 8,74,75
Mvva 188,248,180
ds_read_b64_tr_b16 v[220:221], v116 offset:61440
ds_read_b64_tr_b16 v[222:223], v116 offset:63488
v_lshlrev_b32 v74, 16, v8
Mvva 188,252,188
buffer_load_dwordx4 a[236:239], v112, s[8:11], s52 offen offset:1024 sc1
s_add_u32 s52, s52, 8192
Mvva 128,192,160
ds_read_b64_tr_b16 v[224:225], v117 offset:49152
ds_read_b64_tr_b16 v[226:227], v117 offset:51200
v_and_b32 v75, 0xffff0000, v8
Mvva 128,196,168
Vc 8,76,77
v_lshlrev_b32_e64 v76, 16, v8
v_and_b32 v77, 0xffff0000, v8
Mvva 128,200,176
s_add_u32 m0, s44, 98304
s_waitcnt lgkmcnt(9)
ds_read_b64_tr_b16 v[228:229], v117 offset:53248
ds_read_b64_tr_b16 v[230:231], v117 offset:55296
v_mov_b32 v78, v74
Mvva 128,204,184
buffer_load_dwordx4 v114, s[12:15], s48 offen offset:0 lds
Mvva 144,192,164
s_waitcnt lgkmcnt(4)
ds_read_b64_tr_b16 v[232:233], v117 offset:57344
ds_read_b64_tr_b16 v[234:235], v117 offset:59392
v_mov_b32 v79, v75
Mvva 144,196,172
v_mov_b32 v80, v76
v_mov_b32 v81, v77
v_permlane32_swap_b32 v78, v74
Mvva 144,200,180
ds_read_b64_tr_b16 v[236:237], v117 offset:61440
ds_read_b64_tr_b16 v[238:239], v117 offset:63488
v_permlane32_swap_b32 v79, v75
Mvva 144,204,188
buffer_load_dwordx4 v114, s[12:15], s49 offen offset:1024 lds
Mvva 132,208,160
ds_read_b64_tr_b16 v[240:241], v118 offset:49152
ds_read_b64_tr_b16 v[242:243], v118 offset:51200
v_permlane32_swap_b32 v80, v76
Mvva 132,212,168
v_permlane32_swap_b32 v81, v77
v_mul_f32 v82, 0xbfb8aa3b, v78
v_mul_f32 v83, 0xbfb8aa3b, v79
Mvva 132,216,176
s_waitcnt lgkmcnt(2)
ds_read_b64_tr_b16 v[244:245], v118 offset:53248
ds_read_b64_tr_b16 v[246:247], v118 offset:55296
v_mul_f32 v84, 0xbfb8aa3b, v80
Mvva 132,220,184
buffer_load_dwordx4 v114, s[12:15], s50 offen offset:2048 lds
Mvva 148,208,164
s_waitcnt vmcnt(15)
ds_read_b64_tr_b16 v[248:249], v118 offset:57344
ds_read_b64_tr_b16 v[250:251], v118 offset:59392
v_mul_f32 v85, 0xbfb8aa3b, v81
Mvva 148,212,172
VE 82,82
Mvva 148,216,180
s_barrier
ds_read_b64_tr_b16 v[252:253], v118 offset:61440
ds_read_b64_tr_b16 v[254:255], v118 offset:63488
Mvva 148,220,188
buffer_load_dwordx4 v114, s[12:15], s51 offen offset:3072 lds
v_xor_b32 v114, 128, v114
Mvva 136,224,160
ds_read_b64_tr_b16 v[192:193], v12 offset:0
ds_read_b64_tr_b16 v[194:195], v12 offset:2048
Mvva 136,228,168
Ve 83,83
Mvva 136,232,176
ds_read_b64_tr_b16 v[196:197], v12 offset:4096
ds_read_b64_tr_b16 v[198:199], v12 offset:6144
Mvva 136,236,184
buffer_load_dwordx4 a[240:243], v112, s[8:11], s52 offen offset:0 sc1
Mvva 152,224,164
s_waitcnt lgkmcnt(4)
ds_read_b64_tr_b16 v[200:201], v12 offset:8192
ds_read_b64_tr_b16 v[202:203], v12 offset:10240
Mvva 152,228,172
Ve 84,84
Mvva 152,232,180
ds_read_b64_tr_b16 v[204:205], v12 offset:12288
ds_read_b64_tr_b16 v[206:207], v12 offset:14336
Mvva 152,236,188
buffer_load_dwordx4 a[244:247], v112, s[8:11], s52 offen offset:1024 sc1
s_add_u32 s52, s52, 8192
Mvva 140,240,160
ds_read_b64_tr_b16 v[208:209], v13 offset:0
ds_read_b64_tr_b16 v[210:211], v13 offset:2048
Mvva 140,244,168
Ve 85,85
v_add_f32 v82, 1.0, v82
Mvva 140,248,176
ds_read_b64_tr_b16 v[212:213], v13 offset:4096
ds_read_b64_tr_b16 v[214:215], v13 offset:6144
v_add_f32_e64 v83, 1.0, v83
Mvva 140,252,184
buffer_load_dwordx4 a[248:251], v112, s[8:11], s52 offen offset:0 sc1
Mvva 156,240,164
s_waitcnt lgkmcnt(4)
ds_read_b64_tr_b16 v[216:217], v13 offset:8192
ds_read_b64_tr_b16 v[218:219], v13 offset:10240
v_add_f32 v84, 1.0, v84
Mvva 156,244,172
v_add_f32 v85, 1.0, v85
v_rcp_f32 v82, v82
Mvva 156,248,180
s_waitcnt vmcnt(15)
ds_read_b64_tr_b16 v[220:221], v13 offset:12288
ds_read_b64_tr_b16 v[222:223], v13 offset:14336
Mvva 156,252,188
buffer_load_dwordx4 a[252:255], v112, s[8:11], s52 offen offset:1024 sc1
s_add_u32 s52, s52, 8192
Mvva 160,192,192
ds_read_b64_tr_b16 v[224:225], v14 offset:0
ds_read_b64_tr_b16 v[226:227], v14 offset:2048
Mvva 160,196,200
v_rcp_f32 v83, v83
Mvva 160,200,208
s_add_u32 m0, s44, 114688
ds_read_b64_tr_b16 v[228:229], v14 offset:4096
ds_read_b64_tr_b16 v[230:231], v14 offset:6144
Mvva 160,204,216
buffer_load_dwordx4 v114, s[12:15], s48 offen offset:0 lds
Mvva 176,192,196
s_waitcnt lgkmcnt(4)
ds_read_b64_tr_b16 v[232:233], v14 offset:8192
ds_read_b64_tr_b16 v[234:235], v14 offset:10240
Mvva 176,196,204
v_rcp_f32 v84, v84
Mvva 176,200,212
ds_read_b64_tr_b16 v[236:237], v14 offset:12288
ds_read_b64_tr_b16 v[238:239], v14 offset:14336
Mvva 176,204,220
buffer_load_dwordx4 v114, s[12:15], s49 offen offset:1024 lds
Mvva 164,208,192
ds_read_b64_tr_b16 v[240:241], v15 offset:0
ds_read_b64_tr_b16 v[242:243], v15 offset:2048
Mvva 164,212,200
v_rcp_f32 v85, v85
Vm 78,78,82
Mvva 164,216,208
s_waitcnt lgkmcnt(2)
ds_read_b64_tr_b16 v[244:245], v15 offset:4096
ds_read_b64_tr_b16 v[246:247], v15 offset:6144
Vm 79,79,83
Mvva 164,220,216
buffer_load_dwordx4 v114, s[12:15], s50 offen offset:2048 lds
Mvva 180,208,196
s_waitcnt vmcnt(15)
ds_read_b64_tr_b16 v[248:249], v15 offset:8192
ds_read_b64_tr_b16 v[250:251], v15 offset:10240
Vm 80,80,84
Mvva 180,212,204
v_mul_f32_e64 v81, v81, v85
Vc 8,78,79
v_lshlrev_b32_e64 v78, 16, v8
Mvva 180,216,212
s_barrier
ds_read_b64_tr_b16 v[252:253], v15 offset:12288
ds_read_b64_tr_b16 v[254:255], v15 offset:14336
v_and_b32 v79, 0xffff0000, v8
Mvva 180,220,220
buffer_load_dwordx4 v114, s[12:15], s51 offen offset:3072 lds
v_xor_b32 v114, 128, v114
v_add_u32 v114, 262144, v114
Mvva 168,224,192
ds_read_b64_tr_b16 v[192:193], v12 offset:16384
ds_read_b64_tr_b16 v[194:195], v12 offset:18432
Vc 8,80,81
Mvva 168,228,200
v_lshlrev_b32 v80, 16, v8
v_and_b32 v81, 0xffff0000, v8
v_mul_f32_e64 v74, v74, v78
Mvva 168,232,208
ds_read_b64_tr_b16 v[196:197], v12 offset:20480
ds_read_b64_tr_b16 v[198:199], v12 offset:22528
v_mul_f32_e64 v75, v75, v79
Mvva 168,236,216
buffer_load_dwordx4 a[0:3], v112, s[8:11], s52 offen offset:0 sc1
Mvva 184,224,196
s_waitcnt lgkmcnt(4)
ds_read_b64_tr_b16 v[200:201], v12 offset:24576
ds_read_b64_tr_b16 v[202:203], v12 offset:26624
Vm 76,76,80
Mvva 184,228,204
v_mul_f32_e64 v77, v77, v81
Vc 8,74,75
Vc 9,76,77
Mvva 184,232,212
ds_read_b64_tr_b16 v[204:205], v12 offset:28672
ds_read_b64_tr_b16 v[206:207], v12 offset:30720
Mvva 184,236,220
buffer_load_dwordx4 a[4:7], v112, s[8:11], s52 offen offset:1024 sc1
s_add_u32 s52, s52, 8192
Mvva 172,240,192
ds_read_b64_tr_b16 v[208:209], v13 offset:16384
ds_read_b64_tr_b16 v[210:211], v13 offset:18432
Mvva 172,244,200
ds_write_b64 v2, v[8:9]
ds_read_b64 v[74:75], v3 offset:0
ds_read_b64 v[76:77], v3 offset:32
Mvva 172,248,208
ds_read_b64_tr_b16 v[212:213], v13 offset:20480
ds_read_b64_tr_b16 v[214:215], v13 offset:22528
Mvva 172,252,216
buffer_load_dwordx4 a[8:11], v112, s[8:11], s52 offen offset:0 sc1
Mvva 188,240,196
s_waitcnt lgkmcnt(7)
ds_read_b64_tr_b16 v[216:217], v13 offset:24576
ds_read_b64_tr_b16 v[218:219], v13 offset:26624
Mvva 188,244,204
ds_read_b64 v[78:79], v3 offset:64
ds_read_b64 v[80:81], v3 offset:96
Mvva 188,248,212
ds_read_b64_tr_b16 v[220:221], v13 offset:28672
ds_read_b64_tr_b16 v[222:223], v13 offset:30720
Mvva 188,252,220
buffer_load_dwordx4 a[12:15], v112, s[8:11], s52 offen offset:1024 sc1
s_add_u32 s52, s52, 8192
Mvva 128,192,192
ds_read_b64_tr_b16 v[224:225], v14 offset:16384
ds_read_b64_tr_b16 v[226:227], v14 offset:18432
Mvva 128,196,200
Mvva 128,200,208
s_add_u32 m0, s44, 0
s_waitcnt lgkmcnt(9)
ds_read_b64_tr_b16 v[228:229], v14 offset:20480
ds_read_b64_tr_b16 v[230:231], v14 offset:22528
Mvva 128,204,216
buffer_load_dwordx4 v114, s[12:15], s48 offen offset:0 lds
Mvva 144,192,196
s_waitcnt lgkmcnt(4)
ds_read_b64_tr_b16 v[232:233], v14 offset:24576
ds_read_b64_tr_b16 v[234:235], v14 offset:26624
Mvva 144,196,204
Zvvv 82,90,74
Mvva 144,200,212
ds_read_b64_tr_b16 v[236:237], v14 offset:28672
ds_read_b64_tr_b16 v[238:239], v14 offset:30720
Mvva 144,204,220
buffer_load_dwordx4 v114, s[12:15], s49 offen offset:1024 lds
Mvva 132,208,192
ds_read_b64_tr_b16 v[240:241], v15 offset:16384
ds_read_b64_tr_b16 v[242:243], v15 offset:18432
Mvva 132,212,200
Zvvv 86,94,74
Mvva 132,216,208
s_waitcnt lgkmcnt(2)
ds_read_b64_tr_b16 v[244:245], v15 offset:20480
ds_read_b64_tr_b16 v[246:247], v15 offset:22528
Mvva 132,220,216
buffer_load_dwordx4 v114, s[12:15], s50 offen offset:2048 lds
Mvva 148,208,196
s_waitcnt vmcnt(15)
ds_read_b64_tr_b16 v[248:249], v15 offset:24576
ds_read_b64_tr_b16 v[250:251], v15 offset:26624
Mvva 148,212,204
ds_read_b64_tr_b16 v[90:91], v106 offset:4096
ds_read_b64_tr_b16 v[92:93], v106 offset:6144
ds_read_b64_tr_b16 v[94:95], v107 offset:4096
Mvva 148,216,212
s_barrier
ds_read_b64_tr_b16 v[252:253], v15 offset:28672
ds_read_b64_tr_b16 v[254:255], v15 offset:30720
Mvva 148,220,220
buffer_load_dwordx4 v114, s[12:15], s51 offen offset:3072 lds
v_add_u32 v114, 262144, v114
Mvva 136,224,192
ds_read_b64_tr_b16 v[192:193], v12 offset:32768
ds_read_b64_tr_b16 v[194:195], v12 offset:34816
Mvva 136,228,200
ds_read_b64_tr_b16 v[96:97], v107 offset:6144
Mvva 136,232,208
ds_read_b64_tr_b16 v[196:197], v12 offset:36864
s_waitcnt lgkmcnt(9)
ds_read_b64_tr_b16 v[198:199], v12 offset:38912
Mvva 136,236,216
buffer_load_dwordx4 a[16:19], v112, s[8:11], s52 offen offset:0 sc1
Mvva 152,224,196
s_waitcnt lgkmcnt(5)
ds_read_b64_tr_b16 v[200:201], v12 offset:40960
ds_read_b64_tr_b16 v[202:203], v12 offset:43008
Mvva 152,228,204
Mvva 152,232,212
ds_read_b64_tr_b16 v[204:205], v12 offset:45056
ds_read_b64_tr_b16 v[206:207], v12 offset:47104
Mvva 152,236,220
buffer_load_dwordx4 a[20:23], v112, s[8:11], s52 offen offset:1024 sc1
s_add_u32 s52, s52, 8192
Mvva 140,240,192
ds_read_b64_tr_b16 v[208:209], v13 offset:32768
ds_read_b64_tr_b16 v[210:211], v13 offset:34816
Mvva 140,244,200
s_waitcnt lgkmcnt(8)
Mvvv 82,90,78
Mvva 140,248,208
ds_read_b64_tr_b16 v[212:213], v13 offset:36864
ds_read_b64_tr_b16 v[214:215], v13 offset:38912
Mvva 140,252,216
buffer_load_dwordx4 a[24:27], v112, s[8:11], s52 offen offset:0 sc1
Mvva 156,240,196
s_waitcnt lgkmcnt(4)
ds_read_b64_tr_b16 v[216:217], v13 offset:40960
ds_read_b64_tr_b16 v[218:219], v13 offset:43008
Mvva 156,244,204
Mvvv 86,94,78
Mvva 156,248,212
s_waitcnt vmcnt(15)
ds_read_b64_tr_b16 v[220:221], v13 offset:45056
ds_read_b64_tr_b16 v[222:223], v13 offset:47104
Mvva 156,252,220
buffer_load_dwordx4 a[28:31], v112, s[8:11], s52 offen offset:1024 sc1
s_add_u32 s52, s52, 8192
Mvva 160,192,224
s_add_u32 m0, s44, 16384
ds_read_b64_tr_b16 v[224:225], v14 offset:32768
ds_read_b64_tr_b16 v[226:227], v14 offset:34816
Mvva 160,196,232
buffer_load_dwordx4 v114, s[12:15], s48 offen offset:0 lds
Mvva 160,200,240
ds_read_b64_tr_b16 v[228:229], v14 offset:36864
ds_read_b64_tr_b16 v[230:231], v14 offset:38912
Mvva 160,204,248
Mvva 176,192,228
s_waitcnt lgkmcnt(4)
ds_read_b64_tr_b16 v[232:233], v14 offset:40960
ds_read_b64_tr_b16 v[234:235], v14 offset:43008
Mvva 176,196,236
buffer_load_dwordx4 v114, s[12:15], s49 offen offset:1024 lds
Mvva 176,200,244
ds_read_b64_tr_b16 v[236:237], v14 offset:45056
ds_read_b64_tr_b16 v[238:239], v14 offset:47104
Mvva 176,204,252
buffer_load_dwordx4 v114, s[12:15], s50 offen offset:2048 lds
Mvva 164,208,224
ds_read_b64_tr_b16 v[240:241], v15 offset:32768
ds_read_b64_tr_b16 v[242:243], v15 offset:34816
Mvva 164,212,232
buffer_load_dwordx4 v114, s[12:15], s51 offen offset:3072 lds
v_add_u32 v114, 262144, v114
Mvva 164,216,240
s_waitcnt lgkmcnt(2)
ds_read_b64_tr_b16 v[244:245], v15 offset:36864
ds_read_b64_tr_b16 v[246:247], v15 offset:38912
Mvva 164,220,248
ds_write_b128 v4, v[82:85] offset:2048
ds_write_b128 v4, v[86:89] offset:2112
Mvva 180,208,228
s_waitcnt vmcnt(16)
ds_read_b64_tr_b16 v[248:249], v15 offset:40960
ds_read_b64_tr_b16 v[250:251], v15 offset:43008
Mvva 180,212,236
buffer_load_dwordx4 a[32:35], v112, s[8:11], s52 offen offset:0 sc1
Mvva 180,216,244
s_barrier
ds_read_b64_tr_b16 v[252:253], v15 offset:45056
ds_read_b64_tr_b16 v[254:255], v15 offset:47104
Mvva 180,220,252
buffer_load_dwordx4 a[36:39], v112, s[8:11], s52 offen offset:1024 sc1
s_add_u32 s52, s52, 8192
Mvva 168,224,224
ds_read_b64_tr_b16 v[192:193], v12 offset:49152
ds_read_b64_tr_b16 v[194:195], v12 offset:51200
Mvva 168,228,232
buffer_load_dwordx4 a[40:43], v112, s[8:11], s52 offen offset:0 sc1
Mvva 168,232,240
ds_read_b64_tr_b16 v[196:197], v12 offset:53248
ds_read_b64_tr_b16 v[198:199], v12 offset:55296
Mvva 168,236,248
Mvva 184,224,228
s_waitcnt lgkmcnt(4)
ds_read_b64_tr_b16 v[200:201], v12 offset:57344
ds_read_b64_tr_b16 v[202:203], v12 offset:59392
Mvva 184,228,236
buffer_load_dwordx4 a[44:47], v112, s[8:11], s52 offen offset:1024 sc1
s_add_u32 s52, s52, 8192
Mvva 184,232,244
ds_read_b64_tr_b16 v[204:205], v12 offset:61440
ds_read_b64_tr_b16 v[206:207], v12 offset:63488
Mvva 184,236,252
buffer_load_dwordx4 a[48:51], v112, s[8:11], s52 offen offset:0 sc1
Mvva 172,240,224
ds_read_b64_tr_b16 v[208:209], v13 offset:49152
ds_read_b64_tr_b16 v[210:211], v13 offset:51200
Mvva 172,244,232
buffer_load_dwordx4 a[52:55], v112, s[8:11], s52 offen offset:1024 sc1
s_add_u32 s52, s52, 8192
Mvva 172,248,240
ds_read_b64_tr_b16 v[212:213], v13 offset:53248
ds_read_b64_tr_b16 v[214:215], v13 offset:55296
Mvva 172,252,248
Zvvv 82,98,74
Mvva 188,240,228
s_waitcnt lgkmcnt(4)
ds_read_b64_tr_b16 v[216:217], v13 offset:57344
ds_read_b64_tr_b16 v[218:219], v13 offset:59392
Mvva 188,244,236
buffer_load_dwordx4 a[56:59], v112, s[8:11], s52 offen offset:0 sc1
Mvva 188,248,244
ds_read_b64_tr_b16 v[220:221], v13 offset:61440
ds_read_b64_tr_b16 v[222:223], v13 offset:63488
Mvva 188,252,252
buffer_load_dwordx4 a[60:63], v112, s[8:11], s52 offen offset:1024 sc1
s_add_u32 s52, s52, 8192
Mvva 128,192,224
s_add_u32 m0, s44, 32768
ds_read_b64_tr_b16 v[224:225], v14 offset:49152
ds_read_b64_tr_b16 v[226:227], v14 offset:51200
Mvva 128,196,232
buffer_load_dwordx4 v114, s[12:15], s48 offen offset:0 lds
Mvva 128,200,240
ds_read_b64_tr_b16 v[228:229], v14 offset:53248
ds_read_b64_tr_b16 v[230:231], v14 offset:55296
Mvva 128,204,248
Zvvv 86,102,74
Mvva 144,192,228
s_waitcnt lgkmcnt(4)
ds_read_b64_tr_b16 v[232:233], v14 offset:57344
ds_read_b64_tr_b16 v[234:235], v14 offset:59392
Mvva 144,196,236
buffer_load_dwordx4 v114, s[12:15], s49 offen offset:1024 lds
Mvva 144,200,244
ds_read_b64_tr_b16 v[236:237], v14 offset:61440
ds_read_b64_tr_b16 v[238:239], v14 offset:63488
Mvva 144,204,252
buffer_load_dwordx4 v114, s[12:15], s50 offen offset:2048 lds
Mvva 132,208,224
ds_read_b64_tr_b16 v[240:241], v15 offset:49152
ds_read_b64_tr_b16 v[242:243], v15 offset:51200
Mvva 132,212,232
buffer_load_dwordx4 v114, s[12:15], s51 offen offset:3072 lds
v_add_u32 v114, 262144, v114
Mvva 132,216,240
s_waitcnt lgkmcnt(2)
ds_read_b64_tr_b16 v[244:245], v15 offset:53248
ds_read_b64_tr_b16 v[246:247], v15 offset:55296
Mvva 132,220,248
ds_read_b64_tr_b16 v[98:99], v108 offset:4096
ds_read_b64_tr_b16 v[100:101], v108 offset:6144
ds_read_b64_tr_b16 v[102:103], v109 offset:4096
Mvva 148,208,228
s_waitcnt vmcnt(20)
ds_read_b64_tr_b16 v[248:249], v15 offset:57344
ds_read_b64_tr_b16 v[250:251], v15 offset:59392
Mvva 148,212,236
buffer_load_dwordx4 a[64:67], v112, s[8:11], s52 offen offset:0 sc1
Mvva 148,216,244
s_barrier
ds_read_b64_tr_b16 v[252:253], v15 offset:61440
ds_read_b64_tr_b16 v[254:255], v15 offset:63488
Mvva 148,220,252
buffer_load_dwordx4 a[68:71], v112, s[8:11], s52 offen offset:1024 sc1
s_add_u32 s52, s52, 8192
Mvva 136,224,224
ds_read_b64_tr_b16 v[192:193], v115 offset:0
ds_read_b64_tr_b16 v[194:195], v115 offset:2048
Mvva 136,228,232
buffer_load_dwordx4 a[72:75], v112, s[8:11], s52 offen offset:0 sc1
Mvva 136,232,240
ds_read_b64_tr_b16 v[196:197], v115 offset:4096
ds_read_b64_tr_b16 v[198:199], v115 offset:6144
Mvva 136,236,248
s_waitcnt lgkmcnt(9)
ds_read_b64_tr_b16 v[104:105], v109 offset:6144
Mvva 152,224,228
s_waitcnt lgkmcnt(5)
ds_read_b64_tr_b16 v[200:201], v115 offset:8192
ds_read_b64_tr_b16 v[202:203], v115 offset:10240
Mvva 152,228,236
buffer_load_dwordx4 a[76:79], v112, s[8:11], s52 offen offset:1024 sc1
s_add_u32 s52, s52, 8192
Mvva 152,232,244
ds_read_b64_tr_b16 v[204:205], v115 offset:12288
ds_read_b64_tr_b16 v[206:207], v115 offset:14336
Mvva 152,236,252
buffer_load_dwordx4 a[80:83], v112, s[8:11], s52 offen offset:0 sc1
Mvva 140,240,224
ds_read_b64_tr_b16 v[208:209], v116 offset:0
ds_read_b64_tr_b16 v[210:211], v116 offset:2048
Mvva 140,244,232
buffer_load_dwordx4 a[84:87], v112, s[8:11], s52 offen offset:1024 sc1
s_add_u32 s52, s52, 8192
Mvva 140,248,240
ds_read_b64_tr_b16 v[212:213], v116 offset:4096
ds_read_b64_tr_b16 v[214:215], v116 offset:6144
Mvva 140,252,248
Mvva 156,240,228
s_waitcnt lgkmcnt(4)
ds_read_b64_tr_b16 v[216:217], v116 offset:8192
ds_read_b64_tr_b16 v[218:219], v116 offset:10240
Mvva 156,244,236
buffer_load_dwordx4 a[88:91], v112, s[8:11], s52 offen offset:0 sc1
Mvva 156,248,244
s_waitcnt vmcnt(23)
ds_read_b64_tr_b16 v[220:221], v116 offset:12288
ds_read_b64_tr_b16 v[222:223], v116 offset:14336
Mvva 156,252,252
buffer_load_dwordx4 a[92:95], v112, s[8:11], s52 offen offset:1024 sc1
s_add_u32 s52, s52, 8192
Mvva 160,192,0
s_add_u32 m0, s44, 49152
ds_read_b64_tr_b16 v[224:225], v117 offset:0
ds_read_b64_tr_b16 v[226:227], v117 offset:2048
Mvva 160,196,8
buffer_load_dwordx4 v114, s[12:15], s48 offen offset:0 lds
Mvva 160,200,16
ds_read_b64_tr_b16 v[228:229], v117 offset:4096
ds_read_b64_tr_b16 v[230:231], v117 offset:6144
Mvva 160,204,24
Mvvv 82,98,78
Mvva 176,192,4
s_waitcnt lgkmcnt(4)
ds_read_b64_tr_b16 v[232:233], v117 offset:8192
ds_read_b64_tr_b16 v[234:235], v117 offset:10240
Mvva 176,196,12
buffer_load_dwordx4 v114, s[12:15], s49 offen offset:1024 lds
Mvva 176,200,20
ds_read_b64_tr_b16 v[236:237], v117 offset:12288
ds_read_b64_tr_b16 v[238:239], v117 offset:14336
Mvva 176,204,28
buffer_load_dwordx4 v114, s[12:15], s50 offen offset:2048 lds
Mvva 164,208,0
ds_read_b64_tr_b16 v[240:241], v118 offset:0
ds_read_b64_tr_b16 v[242:243], v118 offset:2048
Mvva 164,212,8
buffer_load_dwordx4 v114, s[12:15], s51 offen offset:3072 lds
v_add_u32 v114, 262144, v114
Mvva 164,216,16
s_waitcnt lgkmcnt(2)
ds_read_b64_tr_b16 v[244:245], v118 offset:4096
ds_read_b64_tr_b16 v[246:247], v118 offset:6144
Mvva 164,220,24
Mvvv 86,102,78
Mvva 180,208,4
s_waitcnt vmcnt(24)
ds_read_b64_tr_b16 v[248:249], v118 offset:8192
ds_read_b64_tr_b16 v[250:251], v118 offset:10240
Mvva 180,212,12
buffer_load_dwordx4 a[96:99], v112, s[8:11], s52 offen offset:0 sc1
Mvva 180,216,20
s_barrier
ds_read_b64_tr_b16 v[252:253], v118 offset:12288
ds_read_b64_tr_b16 v[254:255], v118 offset:14336
Mvva 180,220,28
buffer_load_dwordx4 a[100:103], v112, s[8:11], s52 offen offset:1024 sc1
s_add_u32 s52, s52, 8192
Mvva 168,224,0
ds_read_b64_tr_b16 v[192:193], v115 offset:16384
ds_read_b64_tr_b16 v[194:195], v115 offset:18432
Mvva 168,228,8
buffer_load_dwordx4 a[104:107], v112, s[8:11], s52 offen offset:0 sc1
Mvva 168,232,16
ds_read_b64_tr_b16 v[196:197], v115 offset:20480
ds_read_b64_tr_b16 v[198:199], v115 offset:22528
Mvva 168,236,24
Mvva 184,224,4
s_waitcnt lgkmcnt(4)
ds_read_b64_tr_b16 v[200:201], v115 offset:24576
ds_read_b64_tr_b16 v[202:203], v115 offset:26624
Mvva 184,228,12
buffer_load_dwordx4 a[108:111], v112, s[8:11], s52 offen offset:1024 sc1
s_add_u32 s52, s52, 8192
Mvva 184,232,20
ds_read_b64_tr_b16 v[204:205], v115 offset:28672
ds_read_b64_tr_b16 v[206:207], v115 offset:30720
Mvva 184,236,28
buffer_load_dwordx4 a[112:115], v112, s[8:11], s52 offen offset:0 sc1
Mvva 172,240,0
ds_read_b64_tr_b16 v[208:209], v116 offset:16384
ds_read_b64_tr_b16 v[210:211], v116 offset:18432
Mvva 172,244,8
buffer_load_dwordx4 a[116:119], v112, s[8:11], s52 offen offset:1024 sc1
s_add_u32 s52, s52, 8192
Mvva 172,248,16
ds_read_b64_tr_b16 v[212:213], v116 offset:20480
ds_read_b64_tr_b16 v[214:215], v116 offset:22528
Mvva 172,252,24
ds_write_b128 v4, v[82:85] offset:2176
ds_write_b128 v4, v[86:89] offset:2240
Mvva 188,240,4
s_waitcnt lgkmcnt(6)
ds_read_b64_tr_b16 v[216:217], v116 offset:24576
ds_read_b64_tr_b16 v[218:219], v116 offset:26624
Mvva 188,244,12
buffer_load_dwordx4 a[120:123], v112, s[8:11], s52 offen offset:0 sc1
Mvva 188,248,20
s_waitcnt vmcnt(23)
ds_read_b64_tr_b16 v[220:221], v116 offset:28672
ds_read_b64_tr_b16 v[222:223], v116 offset:30720
Mvva 188,252,28
buffer_load_dwordx4 a[124:127], v112, s[8:11], s52 offen offset:1024 sc1
s_add_u32 s52, s52, 8192
Mvva 160,192,32
s_add_u32 m0, s44, 65536
ds_read_b64_tr_b16 v[224:225], v117 offset:16384
ds_read_b64_tr_b16 v[226:227], v117 offset:18432
Mvva 160,196,40
buffer_load_dwordx4 v114, s[12:15], s48 offen offset:0 lds
Mvva 160,200,48
ds_read_b64_tr_b16 v[228:229], v117 offset:20480
ds_read_b64_tr_b16 v[230:231], v117 offset:22528
Mvva 160,204,56
Mvva 176,192,36
s_waitcnt lgkmcnt(4)
ds_read_b64_tr_b16 v[232:233], v117 offset:24576
ds_read_b64_tr_b16 v[234:235], v117 offset:26624
Mvva 176,196,44
buffer_load_dwordx4 v114, s[12:15], s49 offen offset:1024 lds
Mvva 176,200,52
ds_read_b64_tr_b16 v[236:237], v117 offset:28672
ds_read_b64_tr_b16 v[238:239], v117 offset:30720
Mvva 176,204,60
buffer_load_dwordx4 v114, s[12:15], s50 offen offset:2048 lds
Mvva 164,208,32
ds_read_b64_tr_b16 v[240:241], v118 offset:16384
ds_read_b64_tr_b16 v[242:243], v118 offset:18432
Mvva 164,212,40
buffer_load_dwordx4 v114, s[12:15], s51 offen offset:3072 lds
v_add_u32 v114, 262144, v114
Mvva 164,216,48
s_waitcnt lgkmcnt(2)
ds_read_b64_tr_b16 v[244:245], v118 offset:20480
ds_read_b64_tr_b16 v[246:247], v118 offset:22528
Mvva 164,220,56
Mvva 180,208,36
s_waitcnt vmcnt(24)
ds_read_b64_tr_b16 v[248:249], v118 offset:24576
ds_read_b64_tr_b16 v[250:251], v118 offset:26624
Mvva 180,212,44
buffer_load_dwordx4 a[128:131], v112, s[8:11], s52 offen offset:0 sc1
Mvva 180,216,52
s_barrier
ds_read_b64_tr_b16 v[252:253], v118 offset:28672
ds_read_b64_tr_b16 v[254:255], v118 offset:30720
Mvva 180,220,60
buffer_load_dwordx4 a[132:135], v112, s[8:11], s52 offen offset:1024 sc1
s_add_u32 s52, s52, 8192
Mvva 168,224,32
ds_read_b64_tr_b16 v[192:193], v115 offset:32768
ds_read_b64_tr_b16 v[194:195], v115 offset:34816
Mvva 168,228,40
buffer_load_dwordx4 a[136:139], v112, s[8:11], s52 offen offset:0 sc1
Mvva 168,232,48
ds_read_b64_tr_b16 v[196:197], v115 offset:36864
ds_read_b64_tr_b16 v[198:199], v115 offset:38912
Mvva 168,236,56
ds_read_b64 v[74:75], v6 offset:0
ds_read_b64 v[76:77], v6 offset:8192
ds_read_b64 v[78:79], v6 offset:16384
Mvva 184,224,36
s_waitcnt lgkmcnt(7)
ds_read_b64_tr_b16 v[200:201], v115 offset:40960
ds_read_b64_tr_b16 v[202:203], v115 offset:43008
Mvva 184,228,44
buffer_load_dwordx4 a[140:143], v112, s[8:11], s52 offen offset:1024 sc1
s_add_u32 s52, s52, 8192
Mvva 184,232,52
ds_read_b64_tr_b16 v[204:205], v115 offset:45056
ds_read_b64_tr_b16 v[206:207], v115 offset:47104
Mvva 184,236,60
buffer_load_dwordx4 a[144:147], v112, s[8:11], s52 offen offset:0 sc1
Mvva 172,240,32
ds_read_b64_tr_b16 v[208:209], v116 offset:32768
ds_read_b64_tr_b16 v[210:211], v116 offset:34816
Mvva 172,244,40
buffer_load_dwordx4 a[148:151], v112, s[8:11], s52 offen offset:1024 sc1
s_add_u32 s52, s52, 8192
Mvva 172,248,48
ds_read_b64_tr_b16 v[212:213], v116 offset:36864
ds_read_b64_tr_b16 v[214:215], v116 offset:38912
Mvva 172,252,56
s_waitcnt lgkmcnt(9)
ds_read_b64 v[80:81], v6 offset:24576
Mvva 188,240,36
s_waitcnt lgkmcnt(5)
ds_read_b64_tr_b16 v[216:217], v116 offset:40960
ds_read_b64_tr_b16 v[218:219], v116 offset:43008
Mvva 188,244,44
buffer_load_dwordx4 a[152:155], v112, s[8:11], s52 offen offset:0 sc1
Mvva 188,248,52
s_waitcnt vmcnt(23)
ds_read_b64_tr_b16 v[220:221], v116 offset:45056
ds_read_b64_tr_b16 v[222:223], v116 offset:47104
Mvva 188,252,60
buffer_load_dwordx4 a[156:159], v112, s[8:11], s52 offen offset:1024 sc1
s_add_u32 s52, s52, 8192
Mvva 160,192,64
s_add_u32 m0, s44, 81920
ds_read_b64_tr_b16 v[224:225], v117 offset:32768
ds_read_b64_tr_b16 v[226:227], v117 offset:34816
Mvva 160,196,72
buffer_load_dwordx4 v114, s[12:15], s48 offen offset:0 lds
Mvva 160,200,80
ds_read_b64_tr_b16 v[228:229], v117 offset:36864
ds_read_b64_tr_b16 v[230:231], v117 offset:38912
Mvva 160,204,88
Mvva 176,192,68
s_waitcnt lgkmcnt(4)
ds_read_b64_tr_b16 v[232:233], v117 offset:40960
ds_read_b64_tr_b16 v[234:235], v117 offset:43008
Mvva 176,196,76
buffer_load_dwordx4 v114, s[12:15], s49 offen offset:1024 lds
Mvva 176,200,84
ds_read_b64_tr_b16 v[236:237], v117 offset:45056
ds_read_b64_tr_b16 v[238:239], v117 offset:47104
Mvva 176,204,92
buffer_load_dwordx4 v114, s[12:15], s50 offen offset:2048 lds
Mvva 164,208,64
ds_read_b64_tr_b16 v[240:241], v118 offset:32768
ds_read_b64_tr_b16 v[242:243], v118 offset:34816
Mvva 164,212,72
buffer_load_dwordx4 v114, s[12:15], s51 offen offset:3072 lds
v_add_u32 v114, 262144, v114
Mvva 164,216,80
s_waitcnt lgkmcnt(2)
ds_read_b64_tr_b16 v[244:245], v118 offset:36864
ds_read_b64_tr_b16 v[246:247], v118 offset:38912
Mvva 164,220,88
Va 74,74,76
Va 78,78,80
Va 75,75,77
Mvva 180,208,68
s_waitcnt vmcnt(24)
ds_read_b64_tr_b16 v[248:249], v118 offset:40960
ds_read_b64_tr_b16 v[250:251], v118 offset:43008
Va 79,79,81
Mvva 180,212,76
buffer_load_dwordx4 a[160:163], v112, s[8:11], s52 offen offset:0 sc1
Mvva 180,216,84
s_barrier
ds_read_b64_tr_b16 v[252:253], v118 offset:45056
ds_read_b64_tr_b16 v[254:255], v118 offset:47104
Va 74,74,78
Mvva 180,220,92
buffer_load_dwordx4 a[164:167], v112, s[8:11], s52 offen offset:1024 sc1
s_add_u32 s52, s52, 8192
Mvva 168,224,64
ds_read_b64_tr_b16 v[192:193], v115 offset:49152
ds_read_b64_tr_b16 v[194:195], v115 offset:51200
v_add_f32_e64 v75, v75, v79
Mvva 168,228,72
buffer_load_dwordx4 a[168:171], v112, s[8:11], s52 offen offset:0 sc1
Mvva 168,232,80
ds_read_b64_tr_b16 v[196:197], v115 offset:53248
ds_read_b64_tr_b16 v[198:199], v115 offset:55296
Mvva 168,236,88
buffer_store_dwordx2 v[74:75], v5, s[20:23], s4 offen sc1
Mvva 184,224,68
s_waitcnt lgkmcnt(4)
ds_read_b64_tr_b16 v[200:201], v115 offset:57344
ds_read_b64_tr_b16 v[202:203], v115 offset:59392
Mvva 184,228,76
buffer_load_dwordx4 a[172:175], v112, s[8:11], s52 offen offset:1024 sc1
s_add_u32 s52, s52, 8192
Mvva 184,232,84
ds_read_b64_tr_b16 v[204:205], v115 offset:61440
ds_read_b64_tr_b16 v[206:207], v115 offset:63488
Mvva 184,236,92
buffer_load_dwordx4 a[176:179], v112, s[8:11], s52 offen offset:0 sc1
Mvva 172,240,64
ds_read_b64_tr_b16 v[208:209], v116 offset:49152
ds_read_b64_tr_b16 v[210:211], v116 offset:51200
Mvva 172,244,72
buffer_load_dwordx4 a[180:183], v112, s[8:11], s52 offen offset:1024 sc1
s_add_u32 s52, s52, 8192
Mvva 172,248,80
ds_read_b64_tr_b16 v[212:213], v116 offset:53248
ds_read_b64_tr_b16 v[214:215], v116 offset:55296
Mvva 172,252,88
Mvva 188,240,68
s_waitcnt lgkmcnt(4)
ds_read_b64_tr_b16 v[216:217], v116 offset:57344
ds_read_b64_tr_b16 v[218:219], v116 offset:59392
Mvva 188,244,76
buffer_load_dwordx4 a[184:187], v112, s[8:11], s52 offen offset:0 sc1
Mvva 188,248,84
s_waitcnt vmcnt(24)
ds_read_b64_tr_b16 v[220:221], v116 offset:61440
ds_read_b64_tr_b16 v[222:223], v116 offset:63488
Mvva 188,252,92
buffer_load_dwordx4 a[188:191], v112, s[8:11], s52 offen offset:1024 sc1
s_add_u32 s52, s52, 8192
Mvva 160,192,96
s_add_u32 m0, s44, 98304
ds_read_b64_tr_b16 v[224:225], v117 offset:49152
ds_read_b64_tr_b16 v[226:227], v117 offset:51200
Mvva 160,196,104
buffer_load_dwordx4 v114, s[12:15], s48 offen offset:0 lds
Mvva 160,200,112
ds_read_b64_tr_b16 v[228:229], v117 offset:53248
ds_read_b64_tr_b16 v[230:231], v117 offset:55296
Mvva 160,204,120
Mvva 176,192,100
s_waitcnt lgkmcnt(4)
ds_read_b64_tr_b16 v[232:233], v117 offset:57344
ds_read_b64_tr_b16 v[234:235], v117 offset:59392
Mvva 176,196,108
buffer_load_dwordx4 v114, s[12:15], s49 offen offset:1024 lds
Mvva 176,200,116
ds_read_b64_tr_b16 v[236:237], v117 offset:61440
ds_read_b64_tr_b16 v[238:239], v117 offset:63488
Mvva 176,204,124
buffer_load_dwordx4 v114, s[12:15], s50 offen offset:2048 lds
Mvva 164,208,96
ds_read_b64_tr_b16 v[240:241], v118 offset:49152
ds_read_b64_tr_b16 v[242:243], v118 offset:51200
Mvva 164,212,104
buffer_load_dwordx4 v114, s[12:15], s51 offen offset:3072 lds
v_add_u32 v114, 262144, v114
Mvva 164,216,112
s_waitcnt lgkmcnt(2)
ds_read_b64_tr_b16 v[244:245], v118 offset:53248
ds_read_b64_tr_b16 v[246:247], v118 offset:55296
Mvva 164,220,120
Mvva 180,208,100
s_waitcnt vmcnt(25)
ds_read_b64_tr_b16 v[248:249], v118 offset:57344
ds_read_b64_tr_b16 v[250:251], v118 offset:59392
Mvva 180,212,108
buffer_load_dwordx4 a[192:195], v112, s[8:11], s52 offen offset:0 sc1
Mvva 180,216,116
s_barrier
ds_read_b64_tr_b16 v[252:253], v118 offset:61440
ds_read_b64_tr_b16 v[254:255], v118 offset:63488
Mvva 180,220,124
buffer_load_dwordx4 a[196:199], v112, s[8:11], s52 offen offset:1024 sc1
s_add_u32 s52, s52, 8192
Mvva 168,224,96
ds_read_b64_tr_b16 v[192:193], v12 offset:0
ds_read_b64_tr_b16 v[194:195], v12 offset:2048
Mvva 168,228,104
buffer_load_dwordx4 a[200:203], v112, s[8:11], s52 offen offset:0 sc1
Mvva 168,232,112
ds_read_b64_tr_b16 v[196:197], v12 offset:4096
ds_read_b64_tr_b16 v[198:199], v12 offset:6144
Mvva 168,236,120
Mvva 184,224,100
s_waitcnt lgkmcnt(4)
ds_read_b64_tr_b16 v[200:201], v12 offset:8192
ds_read_b64_tr_b16 v[202:203], v12 offset:10240
Mvva 184,228,108
buffer_load_dwordx4 a[204:207], v112, s[8:11], s52 offen offset:1024 sc1
s_add_u32 s52, s52, 8192
Mvva 184,232,116
ds_read_b64_tr_b16 v[204:205], v12 offset:12288
ds_read_b64_tr_b16 v[206:207], v12 offset:14336
Mvva 184,236,124
buffer_load_dwordx4 a[208:211], v112, s[8:11], s52 offen offset:0 sc1
Mvva 172,240,96
ds_read_b64_tr_b16 v[208:209], v13 offset:0
ds_read_b64_tr_b16 v[210:211], v13 offset:2048
Mvva 172,244,104
buffer_load_dwordx4 a[212:215], v112, s[8:11], s52 offen offset:1024 sc1
s_add_u32 s52, s52, 8192
Mvva 172,248,112
ds_read_b64_tr_b16 v[212:213], v13 offset:4096
ds_read_b64_tr_b16 v[214:215], v13 offset:6144
Mvva 172,252,120
Mvva 188,240,100
s_waitcnt lgkmcnt(4)
ds_read_b64_tr_b16 v[216:217], v13 offset:8192
ds_read_b64_tr_b16 v[218:219], v13 offset:10240
Mvva 188,244,108
buffer_load_dwordx4 a[216:219], v112, s[8:11], s52 offen offset:0 sc1
Mvva 188,248,116
s_waitcnt vmcnt(24)
ds_read_b64_tr_b16 v[220:221], v13 offset:12288
ds_read_b64_tr_b16 v[222:223], v13 offset:14336
Mvva 188,252,124
buffer_load_dwordx4 a[220:223], v112, s[8:11], s52 offen offset:1024 sc1
s_add_u32 s52, s52, 8192
Mvva 160,192,128
s_add_u32 m0, s44, 114688
ds_read_b64_tr_b16 v[224:225], v14 offset:0
ds_read_b64_tr_b16 v[226:227], v14 offset:2048
Mvva 160,196,136
buffer_load_dwordx4 v114, s[12:15], s48 offen offset:0 lds
Mvva 160,200,144
ds_read_b64_tr_b16 v[228:229], v14 offset:4096
ds_read_b64_tr_b16 v[230:231], v14 offset:6144
Mvva 160,204,152
Mvva 176,192,132
s_waitcnt lgkmcnt(4)
ds_read_b64_tr_b16 v[232:233], v14 offset:8192
ds_read_b64_tr_b16 v[234:235], v14 offset:10240
Mvva 176,196,140
buffer_load_dwordx4 v114, s[12:15], s49 offen offset:1024 lds
Mvva 176,200,148
ds_read_b64_tr_b16 v[236:237], v14 offset:12288
ds_read_b64_tr_b16 v[238:239], v14 offset:14336
Mvva 176,204,156
buffer_load_dwordx4 v114, s[12:15], s50 offen offset:2048 lds
Mvva 164,208,128
ds_read_b64_tr_b16 v[240:241], v15 offset:0
ds_read_b64_tr_b16 v[242:243], v15 offset:2048
Mvva 164,212,136
buffer_load_dwordx4 v114, s[12:15], s51 offen offset:3072 lds
s_xor_b32 s95, s95, 128
v_add_u32 v114, s95, v113
Mvva 164,216,144
s_waitcnt lgkmcnt(2)
ds_read_b64_tr_b16 v[244:245], v15 offset:4096
ds_read_b64_tr_b16 v[246:247], v15 offset:6144
Mvva 164,220,152
Mvva 180,208,132
s_waitcnt vmcnt(25)
ds_read_b64_tr_b16 v[248:249], v15 offset:8192
ds_read_b64_tr_b16 v[250:251], v15 offset:10240
Mvva 180,212,140
buffer_load_dwordx4 a[224:227], v112, s[8:11], s52 offen offset:0 sc1
Mvva 180,216,148
s_barrier
ds_read_b64_tr_b16 v[252:253], v15 offset:12288
ds_read_b64_tr_b16 v[254:255], v15 offset:14336
Mvva 180,220,156
buffer_load_dwordx4 a[228:231], v112, s[8:11], s52 offen offset:1024 sc1
s_add_u32 s52, s52, 8192
Mvva 168,224,128
ds_read_b64_tr_b16 v[192:193], v12 offset:16384
ds_read_b64_tr_b16 v[194:195], v12 offset:18432
Mvva 168,228,136
buffer_load_dwordx4 a[232:235], v112, s[8:11], s52 offen offset:0 sc1
Mvva 168,232,144
ds_read_b64_tr_b16 v[196:197], v12 offset:20480
ds_read_b64_tr_b16 v[198:199], v12 offset:22528
Mvva 168,236,152
s_waitcnt vmcnt(24)
s_mov_b64 exec, 1
buffer_store_dword v7, v126, s[20:23], s6 offen sc1
s_mov_b64 exec, -1
Mvva 184,224,132
s_waitcnt lgkmcnt(4)
ds_read_b64_tr_b16 v[200:201], v12 offset:24576
ds_read_b64_tr_b16 v[202:203], v12 offset:26624
Mvva 184,228,140
buffer_load_dwordx4 a[236:239], v112, s[8:11], s52 offen offset:1024 sc1
s_add_u32 s52, s52, 8192
Mvva 184,232,148
ds_read_b64_tr_b16 v[204:205], v12 offset:28672
ds_read_b64_tr_b16 v[206:207], v12 offset:30720
Mvva 184,236,156
buffer_load_dwordx4 a[240:243], v112, s[8:11], s52 offen offset:0 sc1
Mvva 172,240,128
ds_read_b64_tr_b16 v[208:209], v13 offset:16384
ds_read_b64_tr_b16 v[210:211], v13 offset:18432
Mvva 172,244,136
buffer_load_dwordx4 a[244:247], v112, s[8:11], s52 offen offset:1024 sc1
s_add_u32 s52, s52, 8192
Mvva 172,248,144
ds_read_b64_tr_b16 v[212:213], v13 offset:20480
ds_read_b64_tr_b16 v[214:215], v13 offset:22528
Mvva 172,252,152
v_lshlrev_b32 v66, 16, v30
v_and_b32 v67, 0xffff0000, v30
v_lshlrev_b32_e64 v68, 16, v31
Mvva 188,240,132
s_waitcnt lgkmcnt(4)
ds_read_b64_tr_b16 v[216:217], v13 offset:24576
ds_read_b64_tr_b16 v[218:219], v13 offset:26624
v_and_b32 v69, 0xffff0000, v31
Mvva 188,244,140
buffer_load_dwordx4 a[248:251], v112, s[8:11], s52 offen offset:0 sc1
Mvva 188,248,148
s_waitcnt vmcnt(24)
ds_read_b64_tr_b16 v[220:221], v13 offset:28672
ds_read_b64_tr_b16 v[222:223], v13 offset:30720
v_lshlrev_b32_e64 v70, 16, v32
Mvva 188,252,156
buffer_load_dwordx4 a[252:255], v112, s[8:11], s52 offen offset:1024 sc1
s_add_u32 s52, s52, 8192
Mvva 160,192,160
s_add_u32 m0, s44, 0
ds_read_b64_tr_b16 v[224:225], v14 offset:16384
ds_read_b64_tr_b16 v[226:227], v14 offset:18432
Mvva 160,196,168
buffer_load_dwordx4 v114, s[12:15], s48 offen offset:0 lds
Mvva 160,200,176
ds_read_b64_tr_b16 v[228:229], v14 offset:20480
ds_read_b64_tr_b16 v[230:231], v14 offset:22528
Mvva 160,204,184
v_and_b32 v71, 0xffff0000, v32
v_lshlrev_b32 v72, 16, v33
Mvva 176,192,164
s_waitcnt lgkmcnt(4)
ds_read_b64_tr_b16 v[232:233], v14 offset:24576
ds_read_b64_tr_b16 v[234:235], v14 offset:26624
Mvva 176,196,172
buffer_load_dwordx4 v114, s[12:15], s49 offen offset:1024 lds
Mvva 176,200,180
ds_read_b64_tr_b16 v[236:237], v14 offset:28672
ds_read_b64_tr_b16 v[238:239], v14 offset:30720
Mvva 176,204,188
buffer_load_dwordx4 v114, s[12:15], s50 offen offset:2048 lds
Mvva 164,208,160
ds_read_b64_tr_b16 v[240:241], v15 offset:16384
ds_read_b64_tr_b16 v[242:243], v15 offset:18432
Mvva 164,212,168
buffer_load_dwordx4 v114, s[12:15], s51 offen offset:3072 lds
v_add_u32 v114, 262144, v114
Mvva 164,216,176
s_waitcnt lgkmcnt(2)
ds_read_b64_tr_b16 v[244:245], v15 offset:20480
ds_read_b64_tr_b16 v[246:247], v15 offset:22528
Mvva 164,220,184
v_and_b32 v73, 0xffff0000, v33
v_sub_f32_e64 v66, v66, v40
Mvva 180,208,164
s_waitcnt vmcnt(25)
s_add_u32 m0, s44, 16384
ds_read_b64_tr_b16 v[248:249], v15 offset:24576
ds_read_b64_tr_b16 v[250:251], v15 offset:26624
Mvva 180,212,172
buffer_load_dwordx4 v114, s[12:15], s48 offen offset:0 lds
Mvva 180,216,180
s_barrier
ds_read_b64_tr_b16 v[252:253], v15 offset:28672
ds_read_b64_tr_b16 v[254:255], v15 offset:30720
Mvva 180,220,188
buffer_load_dwordx4 v114, s[12:15], s49 offen offset:1024 lds
Mvva 168,224,160
ds_read_b64_tr_b16 v[192:193], v12 offset:32768
ds_read_b64_tr_b16 v[194:195], v12 offset:34816
Mvva 168,228,168
buffer_load_dwordx4 v114, s[12:15], s50 offen offset:2048 lds
Mvva 168,232,176
ds_read_b64_tr_b16 v[196:197], v12 offset:36864
ds_read_b64_tr_b16 v[198:199], v12 offset:38912
Mvva 168,236,184
Vs 67,67,40
Vs 68,68,40
Mvva 184,224,164
s_waitcnt lgkmcnt(4)
ds_read_b64_tr_b16 v[200:201], v12 offset:40960
ds_read_b64_tr_b16 v[202:203], v12 offset:43008
Mvva 184,228,172
buffer_load_dwordx4 v114, s[12:15], s51 offen offset:3072 lds
v_add_u32 v114, 262144, v114
Mvva 184,232,180
s_add_u32 m0, s44, 32768
ds_read_b64_tr_b16 v[204:205], v12 offset:45056
ds_read_b64_tr_b16 v[206:207], v12 offset:47104
Mvva 184,236,188
buffer_load_dwordx4 v114, s[12:15], s48 offen offset:0 lds
Mvva 172,240,160
ds_read_b64_tr_b16 v[208:209], v13 offset:32768
ds_read_b64_tr_b16 v[210:211], v13 offset:34816
Mvva 172,244,168
buffer_load_dwordx4 v114, s[12:15], s49 offen offset:1024 lds
Mvva 172,248,176
ds_read_b64_tr_b16 v[212:213], v13 offset:36864
ds_read_b64_tr_b16 v[214:215], v13 offset:38912
Mvva 172,252,184
Vs 69,69,40
v_sub_f32_e64 v70, v70, v40
Mvva 188,240,164
s_waitcnt lgkmcnt(4)
ds_read_b64_tr_b16 v[216:217], v13 offset:40960
ds_read_b64_tr_b16 v[218:219], v13 offset:43008
Mvva 188,244,172
buffer_load_dwordx4 v114, s[12:15], s50 offen offset:2048 lds
Mvva 188,248,180
s_waitcnt vmcnt(24)
ds_read_b64_tr_b16 v[220:221], v13 offset:45056
ds_read_b64_tr_b16 v[222:223], v13 offset:47104
Mvva 188,252,188
buffer_load_dwordx4 v114, s[12:15], s51 offen offset:3072 lds
v_add_u32 v114, 262144, v114
Mvva 160,192,192
ds_read_b64_tr_b16 v[224:225], v14 offset:32768
ds_read_b64_tr_b16 v[226:227], v14 offset:34816
Mvva 160,196,200
Vs 71,71,40
Vs 72,72,40
Mvva 160,200,208
s_add_u32 m0, s44, 49152
ds_read_b64_tr_b16 v[228:229], v14 offset:36864
ds_read_b64_tr_b16 v[230:231], v14 offset:38912
Mvva 160,204,216
buffer_load_dwordx4 v114, s[12:15], s48 offen offset:0 lds
Mvva 176,192,196
s_waitcnt lgkmcnt(4)
ds_read_b64_tr_b16 v[232:233], v14 offset:40960
ds_read_b64_tr_b16 v[234:235], v14 offset:43008
Mvva 176,196,204
Vs 73,73,40
Vc 2,66,67
Mvva 176,200,212
ds_read_b64_tr_b16 v[236:237], v14 offset:45056
ds_read_b64_tr_b16 v[238:239], v14 offset:47104
Mvva 176,204,220
buffer_load_dwordx4 v114, s[12:15], s49 offen offset:1024 lds
Mvva 164,208,192
ds_read_b64_tr_b16 v[240:241], v15 offset:32768
ds_read_b64_tr_b16 v[242:243], v15 offset:34816
Mvva 164,212,200
v_lshlrev_b32_e64 v66, 16, v2
v_and_b32 v67, 0xffff0000, v2
Mvva 164,216,208
s_waitcnt lgkmcnt(2)
ds_read_b64_tr_b16 v[244:245], v15 offset:36864
ds_read_b64_tr_b16 v[246:247], v15 offset:38912
Mvva 164,220,216
buffer_load_dwordx4 v114, s[12:15], s50 offen offset:2048 lds
Mvva 180,208,196
s_waitcnt vmcnt(24)
ds_read_b64_tr_b16 v[248:249], v15 offset:40960
ds_read_b64_tr_b16 v[250:251], v15 offset:43008
Mvva 180,212,204
Vc 3,68,69
v_lshlrev_b32_e64 v68, 16, v3
Mvva 180,216,212
s_barrier
ds_read_b64_tr_b16 v[252:253], v15 offset:45056
ds_read_b64_tr_b16 v[254:255], v15 offset:47104
Mvva 180,220,220
buffer_load_dwordx4 v114, s[12:15], s51 offen offset:3072 lds
v_add_u32 v114, 262144, v114
Mvva 168,224,192
ds_read_b64_tr_b16 v[192:193], v12 offset:49152
ds_read_b64_tr_b16 v[194:195], v12 offset:51200
Mvva 168,228,200
v_and_b32 v69, 0xffff0000, v3
Vc 4,70,71
Mvva 168,232,208
s_add_u32 m0, s44, 65536
ds_read_b64_tr_b16 v[196:197], v12 offset:53248
ds_read_b64_tr_b16 v[198:199], v12 offset:55296
Mvva 168,236,216
buffer_load_dwordx4 v114, s[12:15], s48 offen offset:0 lds
Mvva 184,224,196
s_waitcnt lgkmcnt(4)
ds_read_b64_tr_b16 v[200:201], v12 offset:57344
ds_read_b64_tr_b16 v[202:203], v12 offset:59392
Mvva 184,228,204
v_lshlrev_b32_e64 v70, 16, v4
v_and_b32 v71, 0xffff0000, v4
Mvva 184,232,212
ds_read_b64_tr_b16 v[204:205], v12 offset:61440
ds_read_b64_tr_b16 v[206:207], v12 offset:63488
Mvva 184,236,220
buffer_load_dwordx4 v114, s[12:15], s49 offen offset:1024 lds
Mvva 172,240,192
ds_read_b64_tr_b16 v[208:209], v13 offset:49152
ds_read_b64_tr_b16 v[210:211], v13 offset:51200
Mvva 172,244,200
Vc 5,72,73
v_lshlrev_b32_e64 v72, 16, v5
Mvva 172,248,208
ds_read_b64_tr_b16 v[212:213], v13 offset:53248
ds_read_b64_tr_b16 v[214:215], v13 offset:55296
Mvva 172,252,216
buffer_load_dwordx4 v114, s[12:15], s50 offen offset:2048 lds
Mvva 188,240,196
s_waitcnt lgkmcnt(4)
ds_read_b64_tr_b16 v[216:217], v13 offset:57344
ds_read_b64_tr_b16 v[218:219], v13 offset:59392
Mvva 188,244,204
v_and_b32 v73, 0xffff0000, v5
Vm 66,66,41
Mvva 188,248,212
s_waitcnt vmcnt(19)
ds_read_b64_tr_b16 v[220:221], v13 offset:61440
ds_read_b64_tr_b16 v[222:223], v13 offset:63488
Mvva 188,252,220
buffer_load_dwordx4 v114, s[12:15], s51 offen offset:3072 lds
v_add_u32 v114, 262144, v114
Mvva 160,192,224
ds_read_b64_tr_b16 v[224:225], v14 offset:49152
ds_read_b64_tr_b16 v[226:227], v14 offset:51200
Mvva 160,196,232
Vm 67,67,41
v_mul_f32_e64 v68, v68, v41
Mvva 160,200,240
ds_read_b64_tr_b16 v[228:229], v14 offset:53248
ds_read_b64_tr_b16 v[230:231], v14 offset:55296
Mvva 160,204,248
Vm 69,69,41
Vm 70,70,41
Mvva 176,192,228
s_waitcnt lgkmcnt(4)
s_add_u32 m0, s44, 81920
ds_read_b64_tr_b16 v[232:233], v14 offset:57344
ds_read_b64_tr_b16 v[234:235], v14 offset:59392
Mvva 176,196,236
buffer_load_dwordx4 v114, s[12:15], s48 offen offset:0 lds
Mvva 176,200,244
ds_read_b64_tr_b16 v[236:237], v14 offset:61440
ds_read_b64_tr_b16 v[238:239], v14 offset:63488
Mvva 176,204,252
Vm 71,71,41
v_mul_f32_e64 v72, v72, v41
Mvva 164,208,224
ds_read_b64_tr_b16 v[240:241], v15 offset:49152
ds_read_b64_tr_b16 v[242:243], v15 offset:51200
Mvva 164,212,232
v_mul_f32_e64 v73, v73, v41
Vc 2,66,67
Mvva 164,216,240
s_waitcnt lgkmcnt(2)
ds_read_b64_tr_b16 v[244:245], v15 offset:53248
ds_read_b64_tr_b16 v[246:247], v15 offset:55296
Mvva 164,220,248
v_lshlrev_b32 v66, 16, v2
v_and_b32 v67, 0xffff0000, v2
Mvva 180,208,228
s_waitcnt vmcnt(17)
ds_read_b64_tr_b16 v[248:249], v15 offset:57344
ds_read_b64_tr_b16 v[250:251], v15 offset:59392
Mvva 180,212,236
buffer_load_dwordx4 v114, s[12:15], s49 offen offset:1024 lds
Mvva 180,216,244
s_barrier
ds_read_b64_tr_b16 v[252:253], v15 offset:61440
ds_read_b64_tr_b16 v[254:255], v15 offset:63488
Mvva 180,220,252
Vc 3,68,69
v_lshlrev_b32_e64 v68, 16, v3
Mvva 168,224,224
ds_read_b64_tr_b16 v[192:193], v115 offset:0
ds_read_b64_tr_b16 v[194:195], v115 offset:2048
Mvva 168,228,232
v_and_b32 v69, 0xffff0000, v3
Vc 4,70,71
Mvva 168,232,240
ds_read_b64_tr_b16 v[196:197], v115 offset:4096
ds_read_b64_tr_b16 v[198:199], v115 offset:6144
Mvva 168,236,248
v_lshlrev_b32_e64 v70, 16, v4
v_and_b32 v71, 0xffff0000, v4
Mvva 184,224,228
s_waitcnt lgkmcnt(4)
ds_read_b64_tr_b16 v[200:201], v115 offset:8192
ds_read_b64_tr_b16 v[202:203], v115 offset:10240
Mvva 184,228,236
buffer_load_dwordx4 v114, s[12:15], s50 offen offset:2048 lds
Mvva 184,232,244
ds_read_b64_tr_b16 v[204:205], v115 offset:12288
ds_read_b64_tr_b16 v[206:207], v115 offset:14336
Mvva 184,236,252
Vc 5,72,73
v_lshlrev_b32 v72, 16, v5
Mvva 172,240,224
ds_read_b64_tr_b16 v[208:209], v116 offset:0
ds_read_b64_tr_b16 v[210:211], v116 offset:2048
Mvva 172,244,232
v_and_b32 v73, 0xffff0000, v5
v_mul_f32 v2, 0xbfb8aa3b, v66
Mvva 172,248,240
ds_read_b64_tr_b16 v[212:213], v116 offset:4096
ds_read_b64_tr_b16 v[214:215], v116 offset:6144
Mvva 172,252,248
v_mul_f32 v3, 0xbfb8aa3b, v67
v_mul_f32 v4, 0xbfb8aa3b, v68
Mvva 188,240,228
s_waitcnt lgkmcnt(4)
ds_read_b64_tr_b16 v[216:217], v116 offset:8192
ds_read_b64_tr_b16 v[218:219], v116 offset:10240
Mvva 188,244,236
buffer_load_dwordx4 v114, s[12:15], s51 offen offset:3072 lds
v_add_u32 v114, 262144, v114
Mvva 188,248,244
ds_read_b64_tr_b16 v[220:221], v116 offset:12288
ds_read_b64_tr_b16 v[222:223], v116 offset:14336
Mvva 188,252,252
v_mul_f32 v5, 0xbfb8aa3b, v69
v_mul_f32 v6, 0xbfb8aa3b, v70
Mvva 128,192,0
ds_read_b64_tr_b16 v[224:225], v117 offset:0
ds_read_b64_tr_b16 v[226:227], v117 offset:2048
Mvva 128,196,8
v_mul_f32 v7, 0xbfb8aa3b, v71
v_mul_f32 v8, 0xbfb8aa3b, v72
Mvva 128,200,16
ds_read_b64_tr_b16 v[228:229], v117 offset:4096
ds_read_b64_tr_b16 v[230:231], v117 offset:6144
Mvva 128,204,24
v_mul_f32 v9, 0xbfb8aa3b, v73
Mvva 144,192,4
s_waitcnt lgkmcnt(4)
s_add_u32 m0, s44, 98304
ds_read_b64_tr_b16 v[232:233], v117 offset:8192
ds_read_b64_tr_b16 v[234:235], v117 offset:10240
Mvva 144,196,12
buffer_load_dwordx4 v114, s[12:15], s48 offen offset:0 lds
Mvva 144,200,20
ds_read_b64_tr_b16 v[236:237], v117 offset:12288
ds_read_b64_tr_b16 v[238:239], v117 offset:14336
Mvva 144,204,28
v_add_u32 v10, 4096, v112
Mvva 132,208,0
ds_read_b64_tr_b16 v[240:241], v118 offset:0
ds_read_b64_tr_b16 v[242:243], v118 offset:2048
Mvva 132,212,8
buffer_store_dwordx4 v[160:163], v112, s[16:19], s26 offen offset:0 sc1
Mvva 132,216,16
s_waitcnt lgkmcnt(2)
ds_read_b64_tr_b16 v[244:245], v118 offset:4096
ds_read_b64_tr_b16 v[246:247], v118 offset:6144
Mvva 132,220,24
buffer_store_dwordx4 v[164:167], v112, s[16:19], s26 offen offset:1024 sc1
Mvva 148,208,4
s_waitcnt vmcnt(19)
ds_read_b64_tr_b16 v[248:249], v118 offset:8192
ds_read_b64_tr_b16 v[250:251], v118 offset:10240
Mvva 148,212,12
buffer_load_dwordx4 v114, s[12:15], s49 offen offset:1024 lds
Mvva 148,216,20
s_barrier
ds_read_b64_tr_b16 v[252:253], v118 offset:12288
ds_read_b64_tr_b16 v[254:255], v118 offset:14336
Mvva 148,220,28
buffer_store_dwordx4 v[168:171], v112, s[16:19], s26 offen offset:2048 sc1
Mvva 136,224,0
ds_read_b64_tr_b16 v[192:193], v115 offset:16384
ds_read_b64_tr_b16 v[194:195], v115 offset:18432
Mvva 136,228,8
buffer_store_dwordx4 v[172:175], v112, s[16:19], s26 offen offset:3072 sc1
Mvva 136,232,16
ds_read_b64_tr_b16 v[196:197], v115 offset:20480
ds_read_b64_tr_b16 v[198:199], v115 offset:22528
Mvva 136,236,24
buffer_store_dwordx4 v[176:179], v10, s[16:19], s26 offen offset:0 sc1
Mvva 152,224,4
s_waitcnt lgkmcnt(4)
ds_read_b64_tr_b16 v[200:201], v115 offset:24576
ds_read_b64_tr_b16 v[202:203], v115 offset:26624
Mvva 152,228,12
buffer_load_dwordx4 v114, s[12:15], s50 offen offset:2048 lds
Mvva 152,232,20
ds_read_b64_tr_b16 v[204:205], v115 offset:28672
ds_read_b64_tr_b16 v[206:207], v115 offset:30720
Mvva 152,236,28
buffer_store_dwordx4 v[180:183], v10, s[16:19], s26 offen offset:1024 sc1
Mvva 140,240,0
ds_read_b64_tr_b16 v[208:209], v116 offset:16384
ds_read_b64_tr_b16 v[210:211], v116 offset:18432
Mvva 140,244,8
buffer_store_dwordx4 v[184:187], v10, s[16:19], s26 offen offset:2048 sc1
Mvva 140,248,16
ds_read_b64_tr_b16 v[212:213], v116 offset:20480
ds_read_b64_tr_b16 v[214:215], v116 offset:22528
Mvva 140,252,24
buffer_store_dwordx4 v[188:191], v10, s[16:19], s26 offen offset:3072 sc1
Mvva 156,240,4
s_waitcnt lgkmcnt(4)
ds_read_b64_tr_b16 v[216:217], v116 offset:24576
ds_read_b64_tr_b16 v[218:219], v116 offset:26624
Mvva 156,244,12
buffer_load_dwordx4 v114, s[12:15], s51 offen offset:3072 lds
v_add_u32 v114, 262144, v114
Mvva 156,248,20
ds_read_b64_tr_b16 v[220:221], v116 offset:28672
ds_read_b64_tr_b16 v[222:223], v116 offset:30720
Mvva 156,252,28
v_mov_b32 v16, 1
Mvva 128,192,32
ds_read_b64_tr_b16 v[224:225], v117 offset:16384
ds_read_b64_tr_b16 v[226:227], v117 offset:18432
Mvva 128,196,40
VE 2,2
Mvva 128,200,48
ds_read_b64_tr_b16 v[228:229], v117 offset:20480
ds_read_b64_tr_b16 v[230:231], v117 offset:22528
Mvva 128,204,56
VE 3,3
Mvva 144,192,36
s_waitcnt lgkmcnt(4)
s_add_u32 m0, s44, 114688
ds_read_b64_tr_b16 v[232:233], v117 offset:24576
ds_read_b64_tr_b16 v[234:235], v117 offset:26624
Mvva 144,196,44
buffer_load_dwordx4 v114, s[12:15], s48 offen offset:0 lds
Mvva 144,200,52
ds_read_b64_tr_b16 v[236:237], v117 offset:28672
ds_read_b64_tr_b16 v[238:239], v117 offset:30720
Mvva 144,204,60
Ve 4,4
Mvva 132,208,32
ds_read_b64_tr_b16 v[240:241], v118 offset:16384
ds_read_b64_tr_b16 v[242:243], v118 offset:18432
Mvva 132,212,40
VE 5,5
Mvva 132,216,48
s_waitcnt lgkmcnt(2)
ds_read_b64_tr_b16 v[244:245], v118 offset:20480
ds_read_b64_tr_b16 v[246:247], v118 offset:22528
Mvva 132,220,56
Ve 6,6
Mvva 148,208,36
s_waitcnt vmcnt(25)
ds_read_b64_tr_b16 v[248:249], v118 offset:24576
ds_read_b64_tr_b16 v[250:251], v118 offset:26624
Mvva 148,212,44
buffer_load_dwordx4 v114, s[12:15], s49 offen offset:1024 lds
Mvva 148,216,52
s_barrier
ds_read_b64_tr_b16 v[252:253], v118 offset:28672
ds_read_b64_tr_b16 v[254:255], v118 offset:30720
Mvva 148,220,60
VE 7,7
Mvva 136,224,32
ds_read_b64_tr_b16 v[192:193], v115 offset:32768
ds_read_b64_tr_b16 v[194:195], v115 offset:34816
Mvva 136,228,40
s_cmp_lg_u32 s53, 0
s_cbranch_scc1 L_yA
L_yAr:
Mvva 136,232,48
ds_read_b64_tr_b16 v[196:197], v115 offset:36864
ds_read_b64_tr_b16 v[198:199], v115 offset:38912
Mvva 136,236,56
VE 8,8
Mvva 152,224,36
s_waitcnt lgkmcnt(4)
ds_read_b64_tr_b16 v[200:201], v115 offset:40960
ds_read_b64_tr_b16 v[202:203], v115 offset:43008
Mvva 152,228,44
buffer_load_dwordx4 v114, s[12:15], s50 offen offset:2048 lds
Mvva 152,232,52
ds_read_b64_tr_b16 v[204:205], v115 offset:45056
ds_read_b64_tr_b16 v[206:207], v115 offset:47104
Mvva 152,236,60
Ve 9,9
Mvva 140,240,32
ds_read_b64_tr_b16 v[208:209], v116 offset:32768
ds_read_b64_tr_b16 v[210:211], v116 offset:34816
Mvva 140,244,40
v_add_f32 v2, 1.0, v2
v_add_f32 v3, 1.0, v3
Mvva 140,248,48
ds_read_b64_tr_b16 v[212:213], v116 offset:36864
ds_read_b64_tr_b16 v[214:215], v116 offset:38912
Mvva 140,252,56
v_add_f32 v4, 1.0, v4
v_add_f32 v5, 1.0, v5
Mvva 156,240,36
s_waitcnt lgkmcnt(4)
ds_read_b64_tr_b16 v[216:217], v116 offset:40960
ds_read_b64_tr_b16 v[218:219], v116 offset:43008
Mvva 156,244,44
buffer_load_dwordx4 v114, s[12:15], s51 offen offset:3072 lds
v_add_u32 v114, 262144, v114
Mvva 156,248,52
ds_read_b64_tr_b16 v[220:221], v116 offset:45056
ds_read_b64_tr_b16 v[222:223], v116 offset:47104
Mvva 156,252,60
v_add_f32 v6, 1.0, v6
v_add_f32_e64 v7, 1.0, v7
Mvva 128,192,64
ds_read_b64_tr_b16 v[224:225], v117 offset:32768
ds_read_b64_tr_b16 v[226:227], v117 offset:34816
Mvva 128,196,72
v_add_f32 v8, 1.0, v8
v_add_f32 v9, 1.0, v9
Mvva 128,200,80
ds_read_b64_tr_b16 v[228:229], v117 offset:36864
ds_read_b64_tr_b16 v[230:231], v117 offset:38912
Mvva 128,204,88
v_rcp_f32_e64 v2, v2
Mvva 144,192,68
s_waitcnt lgkmcnt(4)
ds_read_b64_tr_b16 v[232:233], v117 offset:40960
ds_read_b64_tr_b16 v[234:235], v117 offset:43008
Mvva 144,196,76
v_rcp_f32 v3, v3
Mvva 144,200,84
ds_read_b64_tr_b16 v[236:237], v117 offset:45056
ds_read_b64_tr_b16 v[238:239], v117 offset:47104
Mvva 144,204,92
v_rcp_f32_e64 v4, v4
Mvva 132,208,64
ds_read_b64_tr_b16 v[240:241], v118 offset:32768
ds_read_b64_tr_b16 v[242:243], v118 offset:34816
Mvva 132,212,72
v_rcp_f32_e64 v5, v5
Mvva 132,216,80
s_waitcnt lgkmcnt(2)
ds_read_b64_tr_b16 v[244:245], v118 offset:36864
ds_read_b64_tr_b16 v[246:247], v118 offset:38912
Mvva 132,220,88
v_rcp_f32 v6, v6
Mvva 148,208,68
s_waitcnt vmcnt(24)
ds_read_b64_tr_b16 v[248:249], v118 offset:40960
ds_read_b64_tr_b16 v[250:251], v118 offset:43008
Mvva 148,212,76
v_rcp_f32 v7, v7
Mvva 148,216,84
s_barrier
ds_read_b64_tr_b16 v[252:253], v118 offset:45056
ds_read_b64_tr_b16 v[254:255], v118 offset:47104
Mvva 148,220,92
v_rcp_f32 v8, v8
Mvva 136,224,64
ds_read_b64_tr_b16 v[192:193], v115 offset:49152
ds_read_b64_tr_b16 v[194:195], v115 offset:51200
Mvva 136,228,72
v_rcp_f32_e64 v9, v9
Mvva 136,232,80
ds_read_b64_tr_b16 v[196:197], v115 offset:53248
ds_read_b64_tr_b16 v[198:199], v115 offset:55296
Mvva 136,236,88
Vm 66,66,2
Vm 67,67,3
Mvva 152,224,68
s_waitcnt lgkmcnt(4)
ds_read_b64_tr_b16 v[200:201], v115 offset:57344
ds_read_b64_tr_b16 v[202:203], v115 offset:59392
Mvva 152,228,76
Vm 68,68,4
v_mul_f32_e64 v69, v69, v5
Mvva 152,232,84
ds_read_b64_tr_b16 v[204:205], v115 offset:61440
ds_read_b64_tr_b16 v[206:207], v115 offset:63488
Mvva 152,236,92
Vm 70,70,6
Vm 71,71,7
Mvva 140,240,64
ds_read_b64_tr_b16 v[208:209], v116 offset:49152
ds_read_b64_tr_b16 v[210:211], v116 offset:51200
Mvva 140,244,72
Vm 72,72,8
Vm 73,73,9
Mvva 140,248,80
ds_read_b64_tr_b16 v[212:213], v116 offset:53248
ds_read_b64_tr_b16 v[214:215], v116 offset:55296
Mvva 140,252,88
Vc 2,66,67
v_lshlrev_b32_e64 v66, 16, v2
Mvva 156,240,68
s_waitcnt lgkmcnt(4)
ds_read_b64_tr_b16 v[216:217], v116 offset:57344
ds_read_b64_tr_b16 v[218:219], v116 offset:59392
Mvva 156,244,76
v_and_b32 v67, 0xffff0000, v2
Vc 3,68,69
Mvva 156,248,84
ds_read_b64_tr_b16 v[220:221], v116 offset:61440
ds_read_b64_tr_b16 v[222:223], v116 offset:63488
Mvva 156,252,92
v_lshlrev_b32 v68, 16, v3
v_and_b32 v69, 0xffff0000, v3
Mvva 128,192,96
ds_read_b64_tr_b16 v[224:225], v117 offset:49152
ds_read_b64_tr_b16 v[226:227], v117 offset:51200
Mvva 128,196,104
Vc 4,70,71
v_lshlrev_b32_e64 v70, 16, v4
Mvva 128,200,112
ds_read_b64_tr_b16 v[228:229], v117 offset:53248
ds_read_b64_tr_b16 v[230:231], v117 offset:55296
Mvva 128,204,120
v_and_b32 v71, 0xffff0000, v4
Vc 5,72,73
Mvva 144,192,100
s_waitcnt lgkmcnt(4)
ds_read_b64_tr_b16 v[232:233], v117 offset:57344
ds_read_b64_tr_b16 v[234:235], v117 offset:59392
Mvva 144,196,108
v_lshlrev_b32 v72, 16, v5
v_and_b32 v73, 0xffff0000, v5
Mvva 144,200,116
ds_read_b64_tr_b16 v[236:237], v117 offset:61440
ds_read_b64_tr_b16 v[238:239], v117 offset:63488
Mvva 144,204,124
s_waitcnt vmcnt(5)
s_mov_b64 exec, 1
buffer_store_dword v16, v126, s[20:23], s27 offen sc1
s_mov_b64 exec, -1
Mvva 132,208,96
ds_read_b64_tr_b16 v[240:241], v118 offset:49152
ds_read_b64_tr_b16 v[242:243], v118 offset:51200
Mvva 132,212,104
Mvva 132,216,112
s_waitcnt lgkmcnt(2)
ds_read_b64_tr_b16 v[244:245], v118 offset:53248
ds_read_b64_tr_b16 v[246:247], v118 offset:55296
Mvva 132,220,120
Mvva 148,208,100
ds_read_b64_tr_b16 v[248:249], v118 offset:57344
ds_read_b64_tr_b16 v[250:251], v118 offset:59392
Mvva 148,212,108
Mvva 148,216,116
s_barrier
ds_read_b64_tr_b16 v[252:253], v118 offset:61440
ds_read_b64_tr_b16 v[254:255], v118 offset:63488
Mvva 148,220,124
Mvva 136,224,96
ds_read_b64_tr_b16 v[192:193], v12 offset:0
ds_read_b64_tr_b16 v[194:195], v12 offset:2048
Mvva 136,228,104
Mvva 136,232,112
ds_read_b64_tr_b16 v[196:197], v12 offset:4096
ds_read_b64_tr_b16 v[198:199], v12 offset:6144
Mvva 136,236,120
Mvva 152,224,100
s_waitcnt lgkmcnt(4)
ds_read_b64_tr_b16 v[200:201], v12 offset:8192
ds_read_b64_tr_b16 v[202:203], v12 offset:10240
Mvva 152,228,108
Mvva 152,232,116
ds_read_b64_tr_b16 v[204:205], v12 offset:12288
ds_read_b64_tr_b16 v[206:207], v12 offset:14336
Mvva 152,236,124
s_cmp_lg_u32 s53, 0
s_cbranch_scc1 L_yB
L_yBr:
Mvva 140,240,96
ds_read_b64_tr_b16 v[208:209], v13 offset:0
ds_read_b64_tr_b16 v[210:211], v13 offset:2048
Mvva 140,244,104
Mvva 140,248,112
ds_read_b64_tr_b16 v[212:213], v13 offset:4096
ds_read_b64_tr_b16 v[214:215], v13 offset:6144
Mvva 140,252,120
Mvva 156,240,100
s_waitcnt lgkmcnt(4)
ds_read_b64_tr_b16 v[216:217], v13 offset:8192
ds_read_b64_tr_b16 v[218:219], v13 offset:10240
Mvva 156,244,108
Mvva 156,248,116
ds_read_b64_tr_b16 v[220:221], v13 offset:12288
ds_read_b64_tr_b16 v[222:223], v13 offset:14336
Mvva 156,252,124
Mvva 128,192,128
ds_read_b64_tr_b16 v[224:225], v14 offset:0
ds_read_b64_tr_b16 v[226:227], v14 offset:2048
Mvva 128,196,136
Mvva 128,200,144
ds_read_b64_tr_b16 v[228:229], v14 offset:4096
ds_read_b64_tr_b16 v[230:231], v14 offset:6144
Mvva 128,204,152
Mvva 144,192,132
s_waitcnt lgkmcnt(4)
ds_read_b64_tr_b16 v[232:233], v14 offset:8192
ds_read_b64_tr_b16 v[234:235], v14 offset:10240
Mvva 144,196,140
Mvva 144,200,148
ds_read_b64_tr_b16 v[236:237], v14 offset:12288
ds_read_b64_tr_b16 v[238:239], v14 offset:14336
Mvva 144,204,156
Mvva 132,208,128
ds_read_b64_tr_b16 v[240:241], v15 offset:0
ds_read_b64_tr_b16 v[242:243], v15 offset:2048
Mvva 132,212,136
Mvva 132,216,144
s_waitcnt lgkmcnt(2)
ds_read_b64_tr_b16 v[244:245], v15 offset:4096
ds_read_b64_tr_b16 v[246:247], v15 offset:6144
Mvva 132,220,152
Mvva 148,208,132
ds_read_b64_tr_b16 v[248:249], v15 offset:8192
ds_read_b64_tr_b16 v[250:251], v15 offset:10240
Mvva 148,212,140
Mvva 148,216,148
s_barrier
ds_read_b64_tr_b16 v[252:253], v15 offset:12288
ds_read_b64_tr_b16 v[254:255], v15 offset:14336
Mvva 148,220,156
Mvva 136,224,128
ds_read_b64_tr_b16 v[192:193], v12 offset:16384
ds_read_b64_tr_b16 v[194:195], v12 offset:18432
Mvva 136,228,136
Mvva 136,232,144
ds_read_b64_tr_b16 v[196:197], v12 offset:20480
ds_read_b64_tr_b16 v[198:199], v12 offset:22528
Mvva 136,236,152
Mvva 152,224,132
s_waitcnt lgkmcnt(4)
ds_read_b64_tr_b16 v[200:201], v12 offset:24576
ds_read_b64_tr_b16 v[202:203], v12 offset:26624
Mvva 152,228,140
buffer_load_dword v17, v126, s[20:23], s24 offen sc1
Mvva 152,232,148
ds_read_b64_tr_b16 v[204:205], v12 offset:28672
ds_read_b64_tr_b16 v[206:207], v12 offset:30720
Mvva 152,236,156
Mvva 140,240,128
ds_read_b64_tr_b16 v[208:209], v13 offset:16384
ds_read_b64_tr_b16 v[210:211], v13 offset:18432
Mvva 140,244,136
Mvva 140,248,144
ds_read_b64_tr_b16 v[212:213], v13 offset:20480
ds_read_b64_tr_b16 v[214:215], v13 offset:22528
Mvva 140,252,152
Mvva 156,240,132
s_waitcnt lgkmcnt(4)
ds_read_b64_tr_b16 v[216:217], v13 offset:24576
ds_read_b64_tr_b16 v[218:219], v13 offset:26624
Mvva 156,244,140
Mvva 156,248,148
ds_read_b64_tr_b16 v[220:221], v13 offset:28672
ds_read_b64_tr_b16 v[222:223], v13 offset:30720
Mvva 156,252,156
Mvva 128,192,160
ds_read_b64_tr_b16 v[224:225], v14 offset:16384
ds_read_b64_tr_b16 v[226:227], v14 offset:18432
Mvva 128,196,168
Mvva 128,200,176
ds_read_b64_tr_b16 v[228:229], v14 offset:20480
ds_read_b64_tr_b16 v[230:231], v14 offset:22528
Mvva 128,204,184
Mvva 144,192,164
s_waitcnt lgkmcnt(4)
ds_read_b64_tr_b16 v[232:233], v14 offset:24576
ds_read_b64_tr_b16 v[234:235], v14 offset:26624
Mvva 144,196,172
Mvva 144,200,180
ds_read_b64_tr_b16 v[236:237], v14 offset:28672
ds_read_b64_tr_b16 v[238:239], v14 offset:30720
Mvva 144,204,188
Mvva 132,208,160
ds_read_b64_tr_b16 v[240:241], v15 offset:16384
ds_read_b64_tr_b16 v[242:243], v15 offset:18432
Mvva 132,212,168
Mvva 132,216,176
s_waitcnt lgkmcnt(2)
ds_read_b64_tr_b16 v[244:245], v15 offset:20480
ds_read_b64_tr_b16 v[246:247], v15 offset:22528
Mvva 132,220,184
Mvva 148,208,164
s_waitcnt vmcnt(6)
ds_read_b64_tr_b16 v[248:249], v15 offset:24576
ds_read_b64_tr_b16 v[250:251], v15 offset:26624
Mvva 148,212,172
Mvva 148,216,180
s_barrier
ds_read_b64_tr_b16 v[252:253], v15 offset:28672
ds_read_b64_tr_b16 v[254:255], v15 offset:30720
Mvva 148,220,188
Mvva 136,224,160
ds_read_b64_tr_b16 v[192:193], v12 offset:32768
ds_read_b64_tr_b16 v[194:195], v12 offset:34816
Mvva 136,228,168
s_cmp_lg_u32 s40, 0
s_cbranch_scc1 L_yC
L_yCr:
Mvva 136,232,176
ds_read_b64_tr_b16 v[196:197], v12 offset:36864
ds_read_b64_tr_b16 v[198:199], v12 offset:38912
Mvva 136,236,184
Mvva 152,224,164
s_waitcnt lgkmcnt(4)
ds_read_b64_tr_b16 v[200:201], v12 offset:40960
ds_read_b64_tr_b16 v[202:203], v12 offset:43008
Mvva 152,228,172
Mvva 152,232,180
ds_read_b64_tr_b16 v[204:205], v12 offset:45056
ds_read_b64_tr_b16 v[206:207], v12 offset:47104
Mvva 152,236,188
Mvva 140,240,160
ds_read_b64_tr_b16 v[208:209], v13 offset:32768
ds_read_b64_tr_b16 v[210:211], v13 offset:34816
Mvva 140,244,168
Mvva 140,248,176
ds_read_b64_tr_b16 v[212:213], v13 offset:36864
ds_read_b64_tr_b16 v[214:215], v13 offset:38912
Mvva 140,252,184
s_waitcnt vmcnt(0)
v_cmp_ne_u32 vcc, 1, v17
s_mov_b32 s33, 0
s_cbranch_vccnz L_xno
s_nop 0
buffer_load_dwordx4 v[160:163], v112, s[16:19], s25 offen offset:0 sc1
buffer_load_dwordx4 v[164:167], v112, s[16:19], s25 offen offset:1024 sc1
buffer_load_dwordx4 v[168:171], v112, s[16:19], s25 offen offset:2048 sc1
buffer_load_dwordx4 v[172:175], v112, s[16:19], s25 offen offset:3072 sc1
buffer_load_dwordx4 v[176:179], v10, s[16:19], s25 offen offset:0 sc1
buffer_load_dwordx4 v[180:183], v10, s[16:19], s25 offen offset:1024 sc1
buffer_load_dwordx4 v[184:187], v10, s[16:19], s25 offen offset:2048 sc1
buffer_load_dwordx4 v[188:191], v10, s[16:19], s25 offen offset:3072 sc1
s_mov_b32 s33, 1
L_xno:
Mvva 156,240,164
s_waitcnt lgkmcnt(4)
ds_read_b64_tr_b16 v[216:217], v13 offset:40960
ds_read_b64_tr_b16 v[218:219], v13 offset:43008
Mvva 156,244,172
Mvva 156,248,180
ds_read_b64_tr_b16 v[220:221], v13 offset:45056
ds_read_b64_tr_b16 v[222:223], v13 offset:47104
Mvva 156,252,188
Mvva 128,192,192
ds_read_b64_tr_b16 v[224:225], v14 offset:32768
ds_read_b64_tr_b16 v[226:227], v14 offset:34816
Mvva 128,196,200
Mvva 128,200,208
ds_read_b64_tr_b16 v[228:229], v14 offset:36864
ds_read_b64_tr_b16 v[230:231], v14 offset:38912
Mvva 128,204,216
Mvva 144,192,196
s_waitcnt lgkmcnt(4)
ds_read_b64_tr_b16 v[232:233], v14 offset:40960
ds_read_b64_tr_b16 v[234:235], v14 offset:43008
Mvva 144,196,204
Mvva 144,200,212
ds_read_b64_tr_b16 v[236:237], v14 offset:45056
ds_read_b64_tr_b16 v[238:239], v14 offset:47104
Mvva 144,204,220
Mvva 132,208,192
ds_read_b64_tr_b16 v[240:241], v15 offset:32768
ds_read_b64_tr_b16 v[242:243], v15 offset:34816
Mvva 132,212,200
Mvva 132,216,208
s_waitcnt lgkmcnt(2)
ds_read_b64_tr_b16 v[244:245], v15 offset:36864
ds_read_b64_tr_b16 v[246:247], v15 offset:38912
Mvva 132,220,216
Mvva 148,208,196
ds_read_b64_tr_b16 v[248:249], v15 offset:40960
ds_read_b64_tr_b16 v[250:251], v15 offset:43008
Mvva 148,212,204
Mvva 148,216,212
s_barrier
ds_read_b64_tr_b16 v[252:253], v15 offset:45056
ds_read_b64_tr_b16 v[254:255], v15 offset:47104
Mvva 148,220,220
Mvva 136,224,192
ds_read_b64_tr_b16 v[192:193], v12 offset:49152
ds_read_b64_tr_b16 v[194:195], v12 offset:51200
Mvva 136,228,200
Mvva 136,232,208
ds_read_b64_tr_b16 v[196:197], v12 offset:53248
ds_read_b64_tr_b16 v[198:199], v12 offset:55296
Mvva 136,236,216
Mvva 152,224,196
s_waitcnt lgkmcnt(4)
ds_read_b64_tr_b16 v[200:201], v12 offset:57344
ds_read_b64_tr_b16 v[202:203], v12 offset:59392
Mvva 152,228,204
Mvva 152,232,212
ds_read_b64_tr_b16 v[204:205], v12 offset:61440
ds_read_b64_tr_b16 v[206:207], v12 offset:63488
Mvva 152,236,220
Mvva 140,240,192
ds_read_b64_tr_b16 v[208:209], v13 offset:49152
ds_read_b64_tr_b16 v[210:211], v13 offset:51200
Mvva 140,244,200
Mvva 140,248,208
ds_read_b64_tr_b16 v[212:213], v13 offset:53248
ds_read_b64_tr_b16 v[214:215], v13 offset:55296
Mvva 140,252,216
Mvva 156,240,196
s_waitcnt lgkmcnt(4)
ds_read_b64_tr_b16 v[216:217], v13 offset:57344
ds_read_b64_tr_b16 v[218:219], v13 offset:59392
Mvva 156,244,204
Mvva 156,248,212
ds_read_b64_tr_b16 v[220:221], v13 offset:61440
ds_read_b64_tr_b16 v[222:223], v13 offset:63488
Mvva 156,252,220
Mvva 128,192,224
ds_read_b64_tr_b16 v[224:225], v14 offset:49152
ds_read_b64_tr_b16 v[226:227], v14 offset:51200
Mvva 128,196,232
Mvva 128,200,240
ds_read_b64_tr_b16 v[228:229], v14 offset:53248
ds_read_b64_tr_b16 v[230:231], v14 offset:55296
Mvva 128,204,248
Mvva 144,192,228
s_waitcnt lgkmcnt(4)
ds_read_b64_tr_b16 v[232:233], v14 offset:57344
ds_read_b64_tr_b16 v[234:235], v14 offset:59392
Mvva 144,196,236
Mvva 144,200,244
ds_read_b64_tr_b16 v[236:237], v14 offset:61440
ds_read_b64_tr_b16 v[238:239], v14 offset:63488
Mvva 144,204,252
Mvva 132,208,224
ds_read_b64_tr_b16 v[240:241], v15 offset:49152
ds_read_b64_tr_b16 v[242:243], v15 offset:51200
Mvva 132,212,232
Mvva 132,216,240
s_waitcnt lgkmcnt(2)
ds_read_b64_tr_b16 v[244:245], v15 offset:53248
ds_read_b64_tr_b16 v[246:247], v15 offset:55296
Mvva 132,220,248
Mvva 148,208,228
ds_read_b64_tr_b16 v[248:249], v15 offset:57344
ds_read_b64_tr_b16 v[250:251], v15 offset:59392
Mvva 148,212,236
Mvva 148,216,244
ds_read_b64_tr_b16 v[252:253], v15 offset:61440
ds_read_b64_tr_b16 v[254:255], v15 offset:63488
Mvva 148,220,252
Mvva 136,224,224
Mvva 136,228,232
Mvva 136,232,240
Mvva 136,236,248
Mvva 152,224,228
s_waitcnt lgkmcnt(0)
Mvva 152,228,236
Mvva 152,232,244
Mvva 152,236,252
Mvva 140,240,224
Mvva 140,244,232
Mvva 140,248,240
Mvva 140,252,248
Mvva 156,240,228
Mvva 156,244,236
Mvva 156,248,244
Mvva 156,252,252
s_cmp_lg_u32 s53, s40
s_cbranch_scc1 L_ysl
L_yslr:
v_and_b32 v124, 15, v0
v_lshlrev_b32 v74, 8, v124
v_add_u32 v74, s35, v74
v_xor_b32 v124, v124, v121
v_lshl_add_u32 v74, v124, 4, v74
v_xor_b32_e64 v75, 64, v74
v_xor_b32 v76, 128, v74
v_xor_b32 v77, 192, v74
v_lshlrev_b32 v125, 1, v122
v_xor_b32 v124, v123, v125
v_lshlrev_b32 v12, 8, v123
v_add_u32 v12, s35, v12
v_lshl_add_u32 v12, v124, 4, v12
v_xor_b32_e64 v13, 16, v12
v_xor_b32 v14, 128, v12
v_xor_b32 v15, 144, v12
s_cmp_eq_u32 s33, 0
s_cbranch_scc1 L_spinX
L_spinXr:
v_lshlrev_b32_e64 v80, 16, v18
v_and_b32 v81, 0xffff0000, v18
v_lshlrev_b32_e64 v82, 16, v19
v_and_b32 v83, 0xffff0000, v19
v_lshlrev_b32_e64 v84, 16, v20
v_and_b32 v85, 0xffff0000, v20
v_lshlrev_b32_e64 v86, 16, v21
v_and_b32 v87, 0xffff0000, v21
v_lshlrev_b32_e64 v88, 16, v22
v_and_b32 v89, 0xffff0000, v22
v_lshlrev_b32_e64 v90, 16, v23
v_and_b32 v91, 0xffff0000, v23
v_lshlrev_b32_e64 v92, 16, v24
v_and_b32 v93, 0xffff0000, v24
v_lshlrev_b32_e64 v94, 16, v25
v_and_b32 v95, 0xffff0000, v25
v_lshlrev_b32_e64 v96, 16, v26
v_and_b32 v97, 0xffff0000, v26
v_lshlrev_b32_e64 v98, 16, v27
v_and_b32 v99, 0xffff0000, v27
v_lshlrev_b32_e64 v100, 16, v28
v_and_b32 v101, 0xffff0000, v28
v_lshlrev_b32_e64 v102, 16, v29
v_and_b32 v103, 0xffff0000, v29
v_lshlrev_b32_e64 v104, 16, v30
v_and_b32 v105, 0xffff0000, v30
v_lshlrev_b32_e64 v106, 16, v31
v_and_b32 v107, 0xffff0000, v31
v_lshlrev_b32_e64 v108, 16, v32
v_and_b32 v109, 0xffff0000, v32
v_lshlrev_b32_e64 v110, 16, v33
v_and_b32 v111, 0xffff0000, v33
s_waitcnt vmcnt(0)
s_nop 0
v_pk_add_f32 v[128:129], v[128:129], v[160:161]
v_pk_add_f32 v[130:131], v[130:131], v[162:163]
ds_write_b128 v74, v[128:131] offset:0
v_pk_add_f32 v[132:133], v[132:133], v[164:165]
v_pk_add_f32 v[134:135], v[134:135], v[166:167]
ds_write_b128 v75, v[132:135] offset:0
v_pk_add_f32 v[136:137], v[136:137], v[168:169]
v_pk_add_f32 v[138:139], v[138:139], v[170:171]
ds_write_b128 v76, v[136:139] offset:0
v_pk_add_f32 v[140:141], v[140:141], v[172:173]
v_pk_add_f32 v[142:143], v[142:143], v[174:175]
ds_write_b128 v77, v[140:143] offset:0
v_pk_add_f32 v[144:145], v[144:145], v[176:177]
v_pk_add_f32 v[146:147], v[146:147], v[178:179]
ds_write_b128 v74, v[144:147] offset:4096
v_pk_add_f32 v[148:149], v[148:149], v[180:181]
v_pk_add_f32 v[150:151], v[150:151], v[182:183]
ds_write_b128 v75, v[148:151] offset:4096
v_pk_add_f32 v[152:153], v[152:153], v[184:185]
v_pk_add_f32 v[154:155], v[154:155], v[186:187]
ds_write_b128 v76, v[152:155] offset:4096
v_pk_add_f32 v[156:157], v[156:157], v[188:189]
v_pk_add_f32 v[158:159], v[158:159], v[190:191]
ds_write_b128 v77, v[156:159] offset:4096
Rv 192,12,0
Rv 196,13,0
Rv 200,14,2048
Rv 204,15,2048
Rv 208,12,4096
Rv 212,13,4096
Rv 216,14,6144
s_waitcnt lgkmcnt(9)
Rv 220,15,6144
s_waitcnt lgkmcnt(6)
Vc 224,192,193
v_lshlrev_b32_e64 v192, 16, v224
v_and_b32 v193, 0xffff0000, v224
Vc 225,194,195
v_lshlrev_b32_e64 v194, 16, v225
v_and_b32 v195, 0xffff0000, v225
Vc 226,196,197
v_lshlrev_b32_e64 v196, 16, v226
v_and_b32 v197, 0xffff0000, v226
Vc 227,198,199
v_lshlrev_b32_e64 v198, 16, v227
v_and_b32 v199, 0xffff0000, v227
v_pk_mul_f32 v[192:193], v[192:193], v[42:43]
v_pk_mul_f32 v[194:195], v[194:195], v[44:45]
v_pk_mul_f32 v[196:197], v[196:197], v[46:47]
v_pk_mul_f32 v[198:199], v[198:199], v[48:49]
Vc 224,192,193
v_lshlrev_b32_e64 v192, 16, v224
v_and_b32 v193, 0xffff0000, v224
Vc 225,194,195
v_lshlrev_b32_e64 v194, 16, v225
v_and_b32 v195, 0xffff0000, v225
Vc 226,196,197
v_lshlrev_b32_e64 v196, 16, v226
v_and_b32 v197, 0xffff0000, v226
Vc 227,198,199
v_lshlrev_b32_e64 v198, 16, v227
v_and_b32 v199, 0xffff0000, v227
v_pk_add_f32 v[192:193], v[192:193], v[80:81]
v_pk_add_f32 v[194:195], v[194:195], v[82:83]
v_pk_add_f32 v[196:197], v[196:197], v[84:85]
v_pk_add_f32 v[198:199], v[198:199], v[86:87]
Vc 224,192,193
Vc 225,194,195
Vc 226,196,197
Vc 227,198,199
buffer_store_dwordx4 v[224:227], v119, s[68:71], s36 offen sc1
s_add_u32 s36, s36, 16384
s_waitcnt lgkmcnt(4)
Vc 228,200,201
v_lshlrev_b32 v200, 16, v228
v_and_b32 v201, 0xffff0000, v228
Vc 229,202,203
v_lshlrev_b32_e64 v202, 16, v229
v_and_b32 v203, 0xffff0000, v229
Vc 230,204,205
v_lshlrev_b32_e64 v204, 16, v230
v_and_b32 v205, 0xffff0000, v230
Vc 231,206,207
v_lshlrev_b32_e64 v206, 16, v231
v_and_b32 v207, 0xffff0000, v231
v_pk_mul_f32 v[200:201], v[200:201], v[50:51]
v_pk_mul_f32 v[202:203], v[202:203], v[52:53]
v_pk_mul_f32 v[204:205], v[204:205], v[54:55]
v_pk_mul_f32 v[206:207], v[206:207], v[56:57]
Vc 228,200,201
v_lshlrev_b32_e64 v200, 16, v228
v_and_b32 v201, 0xffff0000, v228
Vc 229,202,203
v_lshlrev_b32_e64 v202, 16, v229
v_and_b32 v203, 0xffff0000, v229
Vc 230,204,205
v_lshlrev_b32_e64 v204, 16, v230
v_and_b32 v205, 0xffff0000, v230
Vc 231,206,207
v_lshlrev_b32_e64 v206, 16, v231
v_and_b32 v207, 0xffff0000, v231
v_pk_add_f32 v[200:201], v[200:201], v[88:89]
v_pk_add_f32 v[202:203], v[202:203], v[90:91]
v_pk_add_f32 v[204:205], v[204:205], v[92:93]
v_pk_add_f32 v[206:207], v[206:207], v[94:95]
Vc 228,200,201
Vc 229,202,203
Vc 230,204,205
Vc 231,206,207
buffer_store_dwordx4 v[228:231], v119, s[68:71], s36 offen sc1
s_add_u32 s36, s36, 16384
s_waitcnt lgkmcnt(2)
Vc 232,208,209
v_lshlrev_b32 v208, 16, v232
v_and_b32 v209, 0xffff0000, v232
Vc 233,210,211
v_lshlrev_b32_e64 v210, 16, v233
v_and_b32 v211, 0xffff0000, v233
Vc 234,212,213
v_lshlrev_b32_e64 v212, 16, v234
v_and_b32 v213, 0xffff0000, v234
Vc 235,214,215
v_lshlrev_b32_e64 v214, 16, v235
v_and_b32 v215, 0xffff0000, v235
v_pk_mul_f32 v[208:209], v[208:209], v[58:59]
v_pk_mul_f32 v[210:211], v[210:211], v[60:61]
v_pk_mul_f32 v[212:213], v[212:213], v[62:63]
v_pk_mul_f32 v[214:215], v[214:215], v[64:65]
Vc 232,208,209
v_lshlrev_b32_e64 v208, 16, v232
v_and_b32 v209, 0xffff0000, v232
Vc 233,210,211
v_lshlrev_b32_e64 v210, 16, v233
v_and_b32 v211, 0xffff0000, v233
Vc 234,212,213
v_lshlrev_b32_e64 v212, 16, v234
v_and_b32 v213, 0xffff0000, v234
Vc 235,214,215
v_lshlrev_b32_e64 v214, 16, v235
v_and_b32 v215, 0xffff0000, v235
v_pk_add_f32 v[208:209], v[208:209], v[96:97]
v_pk_add_f32 v[210:211], v[210:211], v[98:99]
v_pk_add_f32 v[212:213], v[212:213], v[100:101]
v_pk_add_f32 v[214:215], v[214:215], v[102:103]
Vc 232,208,209
Vc 233,210,211
Vc 234,212,213
Vc 235,214,215
buffer_store_dwordx4 v[232:235], v119, s[68:71], s36 offen sc1
s_add_u32 s36, s36, 16384
s_waitcnt lgkmcnt(0)
Vc 236,216,217
v_lshlrev_b32 v216, 16, v236
v_and_b32 v217, 0xffff0000, v236
Vc 237,218,219
v_lshlrev_b32_e64 v218, 16, v237
v_and_b32 v219, 0xffff0000, v237
Vc 238,220,221
v_lshlrev_b32_e64 v220, 16, v238
v_and_b32 v221, 0xffff0000, v238
Vc 239,222,223
v_lshlrev_b32_e64 v222, 16, v239
v_and_b32 v223, 0xffff0000, v239
v_pk_mul_f32 v[216:217], v[216:217], v[66:67]
v_pk_mul_f32 v[218:219], v[218:219], v[68:69]
v_pk_mul_f32 v[220:221], v[220:221], v[70:71]
v_pk_mul_f32 v[222:223], v[222:223], v[72:73]
Vc 236,216,217
v_lshlrev_b32_e64 v216, 16, v236
v_and_b32 v217, 0xffff0000, v236
Vc 237,218,219
v_lshlrev_b32_e64 v218, 16, v237
v_and_b32 v219, 0xffff0000, v237
Vc 238,220,221
v_lshlrev_b32_e64 v220, 16, v238
v_and_b32 v221, 0xffff0000, v238
Vc 239,222,223
v_lshlrev_b32_e64 v222, 16, v239
v_and_b32 v223, 0xffff0000, v239
v_pk_add_f32 v[216:217], v[216:217], v[104:105]
v_pk_add_f32 v[218:219], v[218:219], v[106:107]
v_pk_add_f32 v[220:221], v[220:221], v[108:109]
v_pk_add_f32 v[222:223], v[222:223], v[110:111]
Vc 236,216,217
Vc 237,218,219
Vc 238,220,221
Vc 239,222,223
buffer_store_dwordx4 v[236:239], v119, s[68:71], s36 offen sc1
L_k2_end:
s_endpgm
L_spinC:
s_add_u32 m0, s35, 0
s_nop 0
s_nop 0
buffer_load_dwordx4 v125, s[60:63], s48 offen offset:0 lds
buffer_load_dwordx4 v125, s[60:63], s49 offen offset:1024 lds
buffer_load_dwordx4 v125, s[60:63], s50 offen offset:2048 lds
buffer_load_dwordx4 v125, s[60:63], s51 offen offset:3072 lds
v_add_u32 v125, 65536, v125
s_add_u32 m0, s35, 4096
s_nop 0
buffer_load_dwordx4 v125, s[60:63], s48 offen offset:0 lds
buffer_load_dwordx4 v125, s[60:63], s49 offen offset:1024 lds
buffer_load_dwordx4 v125, s[60:63], s50 offen offset:2048 lds
buffer_load_dwordx4 v125, s[60:63], s51 offen offset:3072 lds
s_mov_b32 s40, 1
s_mov_b32 s47, 0x400000
L_spinC_l:
buffer_load_dword v124, v10, s[20:23], s38 offen sc1
s_sub_u32 s47, s47, 1
s_waitcnt vmcnt(0)
s_cmp_eq_u32 s47, 0
s_cbranch_scc1 L_spinC_lx
v_cmp_ne_u32 vcc, 1, v124
s_cbranch_vccz L_spinC_lx
s_sleep 4
s_branch L_spinC_l
L_spinC_lx:
s_branch L_spinCr
L_c31:
s_bfe_u32 s3, s2, 0x40003
s_lshl_b32 s3, s3, 2
s_add_u32 s3, s3, s32
s_lshl_b32 s3, s3, 15
s_and_b32 s7, s2, 1
s_lshl_b32 s7, s7, 22
s_add_u32 s3, s3, s7
s_add_u32 s3, s3, 2097536
v_and_b32 v1, 15, v0
v_lshlrev_b32 v1, 11, v1
v_lshrrev_b32 v11, 5, v0
v_lshl_add_u32 v1, v11, 10, v1
buffer_load_dword v11, v1, s[28:31], s3 offen
s_branch L_c31r
L_f2A:
s_lshr_b32 s5, s54, 1
s_lshl_b32 s5, s5, 5
s_add_u32 s5, s5, 5447680
buffer_load_dword v125, v127, s[20:23], s5 offen sc1
s_branch L_f2Ar
L_f2B:
s_waitcnt vmcnt(16)
v_cmp_ne_u32 vcc, 1, v125
s_cbranch_vccz L_f2lx
s_mov_b32 s47, 0x400000
L_f2l:
buffer_load_dword v125, v127, s[20:23], s5 offen sc1
s_sub_u32 s47, s47, 1
s_waitcnt vmcnt(0)
s_cmp_eq_u32 s47, 0
s_cbranch_scc1 L_f2lx
v_cmp_ne_u32 vcc, 1, v125
s_cbranch_vccz L_f2lx
s_sleep 8
s_branch L_f2l
L_f2lx:
s_lshl_b32 s3, s54, 8
s_add_u32 s3, s3, 6291456
v_mul_u32_u24 v124, 14336, v121
v_and_b32_e64 v125, 15, v0
v_lshl_add_u32 v124, v125, 4, v124
buffer_load_dwordx4 v[74:77], v124, s[20:23], s3 offen sc1
s_add_u32 s3, s3, 57344
buffer_load_dwordx4 v[78:81], v124, s[20:23], s3 offen sc1
s_add_u32 s3, s3, 57344
buffer_load_dwordx4 v[82:85], v124, s[20:23], s3 offen sc1
s_add_u32 s3, s3, 57344
buffer_load_dwordx4 v[86:89], v124, s[20:23], s3 offen sc1
s_add_u32 s3, s3, 57344
buffer_load_dwordx4 v[90:93], v124, s[20:23], s3 offen sc1
s_add_u32 s3, s3, 57344
buffer_load_dwordx4 v[94:97], v124, s[20:23], s3 offen sc1
s_add_u32 s3, s3, 57344
buffer_load_dwordx4 v[98:101], v124, s[20:23], s3 offen sc1
s_add_u32 s3, s3, 57344
buffer_load_dwordx4 v[102:105], v124, s[20:23], s3 offen sc1
s_branch L_f2Br
L_yA:
v_min_u32 v127, 13, v0
v_lshlrev_b32_e64 v127, 2, v127
buffer_load_dword v74, v127, s[20:23], s41 offen sc1
s_branch L_yAr
L_yB:
s_waitcnt vmcnt(1)
v_cmp_ne_u32 vcc, 1, v74
s_cbranch_vccnz L_yBr
s_mov_b32 s40, 1
v_lshlrev_b32 v124, 2, v0
v_lshlrev_b32 v125, 1, v0
s_lshl_b32 s7, s45, 2
s_add_u32 s7, s7, s32
s_lshr_b32 s3, s42, 5
s_cmp_lg_u32 s3, s7
s_cbranch_scc1 L_f_yl1
s_add_u32 s3, s55, 0
s_nop 0
s_add_u32 s7, s3, 4096
buffer_load_dword v76, v124, s[20:23], s3 offen offset:0 sc1
buffer_load_dword v77, v124, s[20:23], s3 offen offset:512 sc1
buffer_load_dword v78, v124, s[20:23], s3 offen offset:1024 sc1
buffer_load_dword v79, v124, s[20:23], s3 offen offset:1536 sc1
buffer_load_dword v80, v124, s[20:23], s3 offen offset:2048 sc1
buffer_load_dword v81, v124, s[20:23], s3 offen offset:2560 sc1
buffer_load_dword v82, v124, s[20:23], s3 offen offset:3072 sc1
buffer_load_dword v83, v124, s[20:23], s3 offen offset:3584 sc1
buffer_load_dword v84, v124, s[20:23], s7 offen offset:0 sc1
buffer_load_dword v85, v124, s[20:23], s7 offen offset:512 sc1
buffer_load_dword v86, v124, s[20:23], s7 offen offset:1024 sc1
buffer_load_dword v87, v124, s[20:23], s7 offen offset:1536 sc1
buffer_load_dword v88, v124, s[20:23], s7 offen offset:2048 sc1
buffer_load_dword v89, v124, s[20:23], s7 offen offset:2560 sc1
s_lshl_b32 s3, s42, 11
s_lshl_b32 s7, s46, 7
s_add_u32 s3, s3, s7
buffer_load_ushort v90, v125, s[56:59], s3 offen
s_lshl_b32 s3, s42, 3
s_add_u32 s3, s3, 5259264
buffer_load_dwordx2 v[92:93], v126, s[20:23], s3 offen sc1
L_f_yl1:
s_lshl_b32 s7, s45, 2
s_add_u32 s7, s7, s32
s_lshr_b32 s3, s43, 5
s_cmp_lg_u32 s3, s7
s_cbranch_scc1 L_f_yl2
s_nop 0
s_add_u32 s3, s55, 256
s_add_u32 s7, s3, 4096
buffer_load_dword v94, v124, s[20:23], s3 offen offset:0 sc1
buffer_load_dword v95, v124, s[20:23], s3 offen offset:512 sc1
buffer_load_dword v96, v124, s[20:23], s3 offen offset:1024 sc1
buffer_load_dword v97, v124, s[20:23], s3 offen offset:1536 sc1
buffer_load_dword v98, v124, s[20:23], s3 offen offset:2048 sc1
buffer_load_dword v99, v124, s[20:23], s3 offen offset:2560 sc1
buffer_load_dword v100, v124, s[20:23], s3 offen offset:3072 sc1
buffer_load_dword v101, v124, s[20:23], s3 offen offset:3584 sc1
buffer_load_dword v102, v124, s[20:23], s7 offen offset:0 sc1
buffer_load_dword v103, v124, s[20:23], s7 offen offset:512 sc1
buffer_load_dword v104, v124, s[20:23], s7 offen offset:1024 sc1
buffer_load_dword v105, v124, s[20:23], s7 offen offset:1536 sc1
buffer_load_dword v106, v124, s[20:23], s7 offen offset:2048 sc1
buffer_load_dword v107, v124, s[20:23], s7 offen offset:2560 sc1
s_lshl_b32 s3, s43, 11
s_lshl_b32 s7, s46, 7
s_add_u32 s3, s3, s7
buffer_load_ushort v108, v125, s[56:59], s3 offen
s_lshl_b32 s3, s43, 3
s_add_u32 s3, s3, 5259264
buffer_load_dwordx2 v[110:111], v126, s[20:23], s3 offen sc1
L_f_yl2:
s_branch L_yBr
L_yC:
s_waitcnt vmcnt(1)
s_lshl_b32 s7, s45, 2
s_add_u32 s7, s7, s32
s_lshr_b32 s3, s42, 5
s_cmp_lg_u32 s3, s7
s_cbranch_scc1 L_f_ys3
s_nop 0
v_pk_add_f32 v[76:77], v[76:77], v[78:79]
v_pk_add_f32 v[76:77], v[76:77], v[80:81]
v_pk_add_f32 v[76:77], v[76:77], v[82:83]
v_pk_add_f32 v[76:77], v[76:77], v[84:85]
v_pk_add_f32 v[76:77], v[76:77], v[86:87]
v_pk_add_f32 v[76:77], v[76:77], v[88:89]
Va 76,76,77
v_lshlrev_b32 v90, 16, v90
v_sub_f32_e64 v90, v90, v92
Vc 76,76,76
v_lshlrev_b32_e64 v76, 16, v76
Vc 90,90,90
v_lshlrev_b32 v90, 16, v90
v_mul_f32 v76, s100, v76
v_mul_f32_e64 v90, v90, v93
Vc 76,76,76
v_lshlrev_b32_e64 v76, 16, v76
Vc 90,90,90
v_lshlrev_b32 v90, 16, v90
Va 90,90,76
Vc 90,90,90
v_lshlrev_b32_e64 v90, 16, v90
v_mul_f32 v76, 0xbfb8aa3b, v90
Ve 76,76
s_nop 0
v_add_f32 v76, 1.0, v76
v_rcp_f32 v76, v76
s_nop 0
Vm 90,90,76
Vc 90,90,90
v_lshlrev_b32 v90, 16, v90
v_lshlrev_b32 v124, 2, v0
v_add_u32 v124, s35, v124
v_lshlrev_b32 v125, 5, v122
v_add_u32 v125, s35, v125
s_waitcnt lgkmcnt(0)
ds_write_b32 v124, v90
s_and_b32 s3, s42, 7
s_lshl_b32 s3, s3, 3
s_lshl_b64 s[4:5], 0xff, s3
s_bfe_u32 s3, s42, 0x20003
s_mov_b64 exec, s[4:5]
s_cmp_lg_u32 s3, 0
s_cbranch_scc1 L_f_yp4
ds_read_b64 v[42:43], v125
ds_read_b64 v[44:45], v125 offset:8
ds_read_b64 v[46:47], v125 offset:16
ds_read_b64 v[48:49], v125 offset:24
L_f_yp4:
s_cmp_lg_u32 s3, 1
s_cbranch_scc1 L_f_yp5
ds_read_b64 v[50:51], v125
ds_read_b64 v[52:53], v125 offset:8
ds_read_b64 v[54:55], v125 offset:16
ds_read_b64 v[56:57], v125 offset:24
L_f_yp5:
s_cmp_lg_u32 s3, 2
s_cbranch_scc1 L_f_yp6
ds_read_b64 v[58:59], v125
ds_read_b64 v[60:61], v125 offset:8
ds_read_b64 v[62:63], v125 offset:16
ds_read_b64 v[64:65], v125 offset:24
L_f_yp6:
s_cmp_lg_u32 s3, 3
s_cbranch_scc1 L_f_yp7
ds_read_b64 v[66:67], v125
ds_read_b64 v[68:69], v125 offset:8
s_waitcnt lgkmcnt(9)
ds_read_b64 v[70:71], v125 offset:16
ds_read_b64 v[72:73], v125 offset:24
L_f_yp7:
s_mov_b64 exec, -1
s_waitcnt lgkmcnt(0)
L_f_ys3:
s_lshl_b32 s7, s45, 2
s_add_u32 s7, s7, s32
s_lshr_b32 s3, s43, 5
s_cmp_lg_u32 s3, s7
s_cbranch_scc1 L_f_ys8
s_nop 0
v_pk_add_f32 v[94:95], v[94:95], v[96:97]
v_pk_add_f32 v[94:95], v[94:95], v[98:99]
v_pk_add_f32 v[94:95], v[94:95], v[100:101]
v_pk_add_f32 v[94:95], v[94:95], v[102:103]
v_pk_add_f32 v[94:95], v[94:95], v[104:105]
v_pk_add_f32 v[94:95], v[94:95], v[106:107]
Va 94,94,95
v_lshlrev_b32 v108, 16, v108
v_sub_f32_e64 v108, v108, v110
Vc 94,94,94
v_lshlrev_b32_e64 v94, 16, v94
Vc 108,108,108
v_lshlrev_b32 v108, 16, v108
v_mul_f32 v94, s101, v94
v_mul_f32_e64 v108, v108, v111
Vc 94,94,94
v_lshlrev_b32_e64 v94, 16, v94
Vc 108,108,108
v_lshlrev_b32 v108, 16, v108
Va 108,108,94
Vc 108,108,108
v_lshlrev_b32_e64 v108, 16, v108
v_mul_f32 v94, 0xbfb8aa3b, v108
Ve 94,94
s_nop 0
v_add_f32 v94, 1.0, v94
v_rcp_f32 v94, v94
s_nop 0
Vm 108,108,94
Vc 108,108,108
v_lshlrev_b32 v108, 16, v108
v_lshlrev_b32 v124, 2, v0
v_add_u32 v124, s35, v124
v_lshlrev_b32 v125, 5, v122
v_add_u32 v125, s35, v125
s_waitcnt lgkmcnt(0)
ds_write_b32 v124, v108
s_and_b32 s3, s43, 7
s_lshl_b32 s3, s3, 3
s_lshl_b64 s[4:5], 0xff, s3
s_bfe_u32 s3, s43, 0x20003
s_mov_b64 exec, s[4:5]
s_cmp_lg_u32 s3, 0
s_cbranch_scc1 L_f_yp9
ds_read_b64 v[42:43], v125
ds_read_b64 v[44:45], v125 offset:8
ds_read_b64 v[46:47], v125 offset:16
ds_read_b64 v[48:49], v125 offset:24
L_f_yp9:
s_cmp_lg_u32 s3, 1
s_cbranch_scc1 L_f_yp10
ds_read_b64 v[50:51], v125
ds_read_b64 v[52:53], v125 offset:8
ds_read_b64 v[54:55], v125 offset:16
ds_read_b64 v[56:57], v125 offset:24
L_f_yp10:
s_cmp_lg_u32 s3, 2
s_cbranch_scc1 L_f_yp11
ds_read_b64 v[58:59], v125
ds_read_b64 v[60:61], v125 offset:8
ds_read_b64 v[62:63], v125 offset:16
ds_read_b64 v[64:65], v125 offset:24
L_f_yp11:
s_cmp_lg_u32 s3, 3
s_cbranch_scc1 L_f_yp12
ds_read_b64 v[66:67], v125
ds_read_b64 v[68:69], v125 offset:8
s_waitcnt lgkmcnt(9)
ds_read_b64 v[70:71], v125 offset:16
ds_read_b64 v[72:73], v125 offset:24
L_f_yp12:
s_mov_b64 exec, -1
s_waitcnt lgkmcnt(0)
L_f_ys8:
s_branch L_yCr
L_p4_end:
L_spinAk:
s_mov_b32 s47, 0x400000
L_spinAk_l:
s_sleep 8
buffer_load_dword v1, v7, s[28:31], 0 offen sc1
s_waitcnt vmcnt(0)
v_readfirstlane_b32 s3, v1
s_sub_u32 s47, s47, 1
s_cmp_eq_u32 s47, 0
s_cbranch_scc1 L_spinArk
s_cmp_lt_u32 s3, 256
s_cbranch_scc1 L_spinAk_l
s_branch L_spinArk
L_spinAv:
s_mov_b32 s47, 0x400000
L_spinAv_l:
s_sleep 8
buffer_load_dword v1, v7, s[28:31], 0 offen sc1
s_waitcnt vmcnt(0)
v_readfirstlane_b32 s3, v1
s_sub_u32 s47, s47, 1
s_cmp_eq_u32 s47, 0
s_cbranch_scc1 L_spinArv
s_cmp_lt_u32 s3, 256
s_cbranch_scc1 L_spinAv_l
s_branch L_spinArv
L_spinB:
s_mov_b32 s59, 0x400000
L_spinB_l:
s_sleep 4
buffer_load_dword v12, v1, s[20:23], s6 offen sc1
s_sub_u32 s59, s59, 1
s_cmp_eq_u32 s59, 0
s_cbranch_scc1 L_spinBx
s_waitcnt vmcnt(0)
v_cmp_ne_u32 vcc, 1, v12
s_cbranch_vccnz L_spinB_l
L_spinBx:
s_waitcnt vmcnt(0)
s_branch L_spinBr
L_k2_fb_we:
s_nop 7
s_nop 0
v_max3_f32 v21, v128, v129, v130
v_max3_f32 v21, v21, v131, v132
v_max3_f32 v21, v21, v133, v134
v_max3_f32 v21, v21, v135, v136
v_max3_f32 v21, v21, v137, v138
v_max3_f32 v21, v21, v139, v140
v_max3_f32 v21, v21, v141, v142
v_max_f32 v21, v21, v143
v_mov_b32 v1, v21
s_nop 1
v_permlane16_swap_b32 v1, v21
v_max_f32 v21, v21, v1
v_mov_b32 v1, v21
s_nop 1
v_permlane32_swap_b32 v1, v21
v_max_f32_e64 v21, v21, v1
v_add_f32 v21, 0x41f80000, v21
v_max_f32 v21, 0, v21
Vs 128,128,21
Vs 129,129,21
Vs 130,130,21
Vs 131,131,21
Vs 132,132,21
Vs 133,133,21
Vs 134,134,21
Vs 135,135,21
Vs 136,136,21
Vs 137,137,21
Vs 138,138,21
Vs 139,139,21
Vs 140,140,21
Vs 141,141,21
Vs 142,142,21
Vs 143,143,21
Vs 192,192,21
Vs 193,193,21
Vs 194,194,21
Vs 195,195,21
Vs 196,196,21
Vs 197,197,21
Vs 198,198,21
Vs 199,199,21
Vs 200,200,21
Vs 201,201,21
Vs 202,202,21
Vs 203,203,21
Vs 204,204,21
Vs 205,205,21
Vs 206,206,21
Vs 207,207,21
Vs 32,32,21
Vs 33,33,21
Vs 34,34,21
v_sub_f32_e64 v35, v35, v21
v_exp_f32 v22, -v21
s_nop 0
Vm 48,48,22
Vm 49,49,22
Vm 50,50,22
v_mul_f32_e64 v51, v51, v22
Ar 8,0
Ar 9,1
Ar 10,2
Ar 11,3
Ar 12,4
Ar 13,5
Ar 14,6
Ar 15,7
Vm 8,8,22
Vm 9,9,22
Vm 10,10,22
Vm 11,11,22
Vm 12,12,22
Vm 13,13,22
Vm 14,14,22
Vm 15,15,22
Aw 0,8
Aw 1,9
Aw 2,10
Aw 3,11
Aw 4,12
Aw 5,13
Aw 6,14
Aw 7,15
Ar 8,8
Ar 9,9
Ar 10,10
Ar 11,11
Ar 12,12
Ar 13,13
Ar 14,14
Ar 15,15
Vm 8,8,22
Vm 9,9,22
Vm 10,10,22
Vm 11,11,22
Vm 12,12,22
Vm 13,13,22
Vm 14,14,22
Vm 15,15,22
Aw 8,8
Aw 9,9
Aw 10,10
Aw 11,11
Aw 12,12
Aw 13,13
Aw 14,14
Aw 15,15
Ar 8,16
Ar 9,17
Ar 10,18
Ar 11,19
Ar 12,20
Ar 13,21
Ar 14,22
Ar 15,23
Vm 8,8,22
Vm 9,9,22
Vm 10,10,22
Vm 11,11,22
Vm 12,12,22
Vm 13,13,22
Vm 14,14,22
Vm 15,15,22
Aw 16,8
Aw 17,9
Aw 18,10
Aw 19,11
Aw 20,12
Aw 21,13
Aw 22,14
Aw 23,15
Ar 8,24
Ar 9,25
Ar 10,26
Ar 11,27
Ar 12,28
Ar 13,29
Ar 14,30
Ar 15,31
Vm 8,8,22
Vm 9,9,22
Vm 10,10,22
Vm 11,11,22
Vm 12,12,22
Vm 13,13,22
Vm 14,14,22
Vm 15,15,22
Aw 24,8
Aw 25,9
Aw 26,10
Aw 27,11
Aw 28,12
Aw 29,13
Aw 30,14
Aw 31,15
v_max3_f32 v21, v144, v145, v146
v_max3_f32 v21, v21, v147, v148
v_max3_f32 v21, v21, v149, v150
v_max3_f32 v21, v21, v151, v152
v_max3_f32 v21, v21, v153, v154
v_max3_f32 v21, v21, v155, v156
v_max3_f32 v21, v21, v157, v158
v_max_f32 v21, v21, v159
v_mov_b32 v1, v21
s_nop 1
v_permlane16_swap_b32 v1, v21
v_max_f32 v21, v21, v1
v_mov_b32 v1, v21
s_nop 1
v_permlane32_swap_b32 v1, v21
v_max_f32_e64 v21, v21, v1
v_add_f32 v21, 0x41f80000, v21
v_max_f32 v21, 0, v21
Vs 144,144,21
Vs 145,145,21
Vs 146,146,21
Vs 147,147,21
Vs 148,148,21
Vs 149,149,21
Vs 150,150,21
Vs 151,151,21
Vs 152,152,21
Vs 153,153,21
Vs 154,154,21
Vs 155,155,21
Vs 156,156,21
Vs 157,157,21
Vs 158,158,21
Vs 159,159,21
Vs 208,208,21
Vs 209,209,21
Vs 210,210,21
Vs 211,211,21
Vs 212,212,21
Vs 213,213,21
Vs 214,214,21
Vs 215,215,21
Vs 216,216,21
Vs 217,217,21
Vs 218,218,21
Vs 219,219,21
Vs 220,220,21
Vs 221,221,21
Vs 222,222,21
Vs 223,223,21
Vs 36,36,21
Vs 37,37,21
Vs 38,38,21
v_sub_f32_e64 v39, v39, v21
v_exp_f32 v22, -v21
s_nop 0
Vm 52,52,22
Vm 53,53,22
Vm 54,54,22
v_mul_f32_e64 v55, v55, v22
Ar 8,32
Ar 9,33
Ar 10,34
Ar 11,35
Ar 12,36
Ar 13,37
Ar 14,38
Ar 15,39
Vm 8,8,22
Vm 9,9,22
Vm 10,10,22
Vm 11,11,22
Vm 12,12,22
Vm 13,13,22
Vm 14,14,22
Vm 15,15,22
Aw 32,8
Aw 33,9
Aw 34,10
Aw 35,11
Aw 36,12
Aw 37,13
Aw 38,14
Aw 39,15
Ar 8,40
Ar 9,41
Ar 10,42
Ar 11,43
Ar 12,44
Ar 13,45
Ar 14,46
Ar 15,47
Vm 8,8,22
Vm 9,9,22
Vm 10,10,22
Vm 11,11,22
Vm 12,12,22
Vm 13,13,22
Vm 14,14,22
Vm 15,15,22
Aw 40,8
Aw 41,9
Aw 42,10
Aw 43,11
Aw 44,12
Aw 45,13
Aw 46,14
Aw 47,15
Ar 8,48
Ar 9,49
Ar 10,50
Ar 11,51
Ar 12,52
Ar 13,53
Ar 14,54
Ar 15,55
Vm 8,8,22
Vm 9,9,22
Vm 10,10,22
Vm 11,11,22
Vm 12,12,22
Vm 13,13,22
Vm 14,14,22
Vm 15,15,22
Aw 48,8
Aw 49,9
Aw 50,10
Aw 51,11
Aw 52,12
Aw 53,13
Aw 54,14
Aw 55,15
Ar 8,56
Ar 9,57
Ar 10,58
Ar 11,59
Ar 12,60
Ar 13,61
Ar 14,62
Ar 15,63
Vm 8,8,22
Vm 9,9,22
Vm 10,10,22
Vm 11,11,22
Vm 12,12,22
Vm 13,13,22
Vm 14,14,22
Vm 15,15,22
Aw 56,8
Aw 57,9
Aw 58,10
Aw 59,11
Aw 60,12
Aw 61,13
Aw 62,14
Aw 63,15
v_max3_f32 v21, v160, v161, v162
v_max3_f32 v21, v21, v163, v164
v_max3_f32 v21, v21, v165, v166
v_max3_f32 v21, v21, v167, v168
v_max3_f32 v21, v21, v169, v170
v_max3_f32 v21, v21, v171, v172
v_max3_f32 v21, v21, v173, v174
v_max_f32 v21, v21, v175
v_mov_b32 v1, v21
s_nop 1
v_permlane16_swap_b32 v1, v21
v_max_f32 v21, v21, v1
v_mov_b32 v1, v21
s_nop 1
v_permlane32_swap_b32 v1, v21
v_max_f32_e64 v21, v21, v1
v_add_f32 v21, 0x41f80000, v21
v_max_f32 v21, 0, v21
Vs 160,160,21
Vs 161,161,21
Vs 162,162,21
Vs 163,163,21
Vs 164,164,21
Vs 165,165,21
Vs 166,166,21
Vs 167,167,21
Vs 168,168,21
Vs 169,169,21
Vs 170,170,21
Vs 171,171,21
Vs 172,172,21
Vs 173,173,21
Vs 174,174,21
Vs 175,175,21
Vs 224,224,21
Vs 225,225,21
Vs 226,226,21
Vs 227,227,21
Vs 228,228,21
Vs 229,229,21
Vs 230,230,21
Vs 231,231,21
Vs 232,232,21
Vs 233,233,21
Vs 234,234,21
Vs 235,235,21
Vs 236,236,21
Vs 237,237,21
Vs 238,238,21
Vs 239,239,21
Vs 40,40,21
Vs 41,41,21
Vs 42,42,21
v_sub_f32_e64 v43, v43, v21
v_exp_f32 v22, -v21
s_nop 0
Vm 56,56,22
Vm 57,57,22
Vm 58,58,22
v_mul_f32_e64 v59, v59, v22
Ar 8,64
Ar 9,65
Ar 10,66
Ar 11,67
Ar 12,68
Ar 13,69
Ar 14,70
Ar 15,71
Vm 8,8,22
Vm 9,9,22
Vm 10,10,22
Vm 11,11,22
Vm 12,12,22
Vm 13,13,22
Vm 14,14,22
Vm 15,15,22
Aw 64,8
Aw 65,9
Aw 66,10
Aw 67,11
Aw 68,12
Aw 69,13
Aw 70,14
Aw 71,15
Ar 8,72
Ar 9,73
Ar 10,74
Ar 11,75
Ar 12,76
Ar 13,77
Ar 14,78
Ar 15,79
Vm 8,8,22
Vm 9,9,22
Vm 10,10,22
Vm 11,11,22
Vm 12,12,22
Vm 13,13,22
Vm 14,14,22
Vm 15,15,22
Aw 72,8
Aw 73,9
Aw 74,10
Aw 75,11
Aw 76,12
Aw 77,13
Aw 78,14
Aw 79,15
Ar 8,80
Ar 9,81
Ar 10,82
Ar 11,83
Ar 12,84
Ar 13,85
Ar 14,86
Ar 15,87
Vm 8,8,22
Vm 9,9,22
Vm 10,10,22
Vm 11,11,22
Vm 12,12,22
Vm 13,13,22
Vm 14,14,22
Vm 15,15,22
Aw 80,8
Aw 81,9
Aw 82,10
Aw 83,11
Aw 84,12
Aw 85,13
Aw 86,14
Aw 87,15
Ar 8,88
Ar 9,89
Ar 10,90
Ar 11,91
Ar 12,92
Ar 13,93
Ar 14,94
Ar 15,95
Vm 8,8,22
Vm 9,9,22
Vm 10,10,22
Vm 11,11,22
Vm 12,12,22
Vm 13,13,22
Vm 14,14,22
Vm 15,15,22
Aw 88,8
Aw 89,9
Aw 90,10
Aw 91,11
Aw 92,12
Aw 93,13
Aw 94,14
Aw 95,15
v_max3_f32 v21, v176, v177, v178
v_max3_f32 v21, v21, v179, v180
v_max3_f32 v21, v21, v181, v182
v_max3_f32 v21, v21, v183, v184
v_max3_f32 v21, v21, v185, v186
v_max3_f32 v21, v21, v187, v188
v_max3_f32 v21, v21, v189, v190
v_max_f32 v21, v21, v191
v_mov_b32 v1, v21
s_nop 1
v_permlane16_swap_b32 v1, v21
v_max_f32 v21, v21, v1
v_mov_b32 v1, v21
s_nop 1
v_permlane32_swap_b32 v1, v21
v_max_f32_e64 v21, v21, v1
v_add_f32 v21, 0x41f80000, v21
v_max_f32 v21, 0, v21
Vs 176,176,21
Vs 177,177,21
Vs 178,178,21
Vs 179,179,21
Vs 180,180,21
Vs 181,181,21
Vs 182,182,21
Vs 183,183,21
Vs 184,184,21
Vs 185,185,21
Vs 186,186,21
Vs 187,187,21
Vs 188,188,21
Vs 189,189,21
Vs 190,190,21
Vs 191,191,21
Vs 240,240,21
Vs 241,241,21
Vs 242,242,21
Vs 243,243,21
Vs 244,244,21
Vs 245,245,21
Vs 246,246,21
Vs 247,247,21
Vs 248,248,21
Vs 249,249,21
Vs 250,250,21
Vs 251,251,21
Vs 252,252,21
Vs 253,253,21
Vs 254,254,21
Vs 255,255,21
Vs 44,44,21
Vs 45,45,21
Vs 46,46,21
v_sub_f32_e64 v47, v47, v21
v_exp_f32 v22, -v21
s_nop 0
Vm 60,60,22
Vm 61,61,22
Vm 62,62,22
v_mul_f32_e64 v63, v63, v22
Ar 8,96
Ar 9,97
Ar 10,98
Ar 11,99
Ar 12,100
Ar 13,101
Ar 14,102
Ar 15,103
Vm 8,8,22
Vm 9,9,22
Vm 10,10,22
Vm 11,11,22
Vm 12,12,22
Vm 13,13,22
Vm 14,14,22
Vm 15,15,22
Aw 96,8
Aw 97,9
Aw 98,10
Aw 99,11
Aw 100,12
Aw 101,13
Aw 102,14
Aw 103,15
Ar 8,104
Ar 9,105
Ar 10,106
Ar 11,107
Ar 12,108
Ar 13,109
Ar 14,110
Ar 15,111
Vm 8,8,22
Vm 9,9,22
Vm 10,10,22
Vm 11,11,22
Vm 12,12,22
Vm 13,13,22
Vm 14,14,22
Vm 15,15,22
Aw 104,8
Aw 105,9
Aw 106,10
Aw 107,11
Aw 108,12
Aw 109,13
Aw 110,14
Aw 111,15
Ar 8,112
Ar 9,113
Ar 10,114
Ar 11,115
Ar 12,116
Ar 13,117
Ar 14,118
Ar 15,119
Vm 8,8,22
Vm 9,9,22
Vm 10,10,22
Vm 11,11,22
Vm 12,12,22
Vm 13,13,22
Vm 14,14,22
Vm 15,15,22
Aw 112,8
Aw 113,9
Aw 114,10
Aw 115,11
Aw 116,12
Aw 117,13
Aw 118,14
Aw 119,15
Ar 8,120
Ar 9,121
Ar 10,122
Ar 11,123
Ar 12,124
Ar 13,125
Ar 14,126
Ar 15,127
Vm 8,8,22
Vm 9,9,22
Vm 10,10,22
Vm 11,11,22
Vm 12,12,22
Vm 13,13,22
Vm 14,14,22
Vm 15,15,22
Aw 120,8
Aw 121,9
Aw 122,10
Aw 123,11
Aw 124,12
Aw 125,13
Aw 126,14
Aw 127,15
Ve 8,128
Ve 9,129
s_nop 0
Vc 64,8,9
Ve 8,130
Ve 9,131
s_nop 0
Vc 65,8,9
Ve 8,144
Ve 9,145
s_nop 0
Vc 72,8,9
Ve 8,146
Ve 9,147
s_nop 0
Vc 73,8,9
Ve 8,160
Ve 9,161
s_nop 0
Vc 80,8,9
Ve 8,162
Ve 9,163
s_nop 0
Vc 81,8,9
Ve 8,176
Ve 9,177
s_nop 0
Vc 88,8,9
Ve 8,178
Ve 9,179
s_nop 0
Vc 89,8,9
Ve 8,132
Ve 9,133
s_nop 0
Vc 66,8,9
Ve 8,134
Ve 9,135
s_nop 0
Vc 67,8,9
Ve 8,148
Ve 9,149
s_nop 0
Vc 74,8,9
Ve 8,150
Ve 9,151
s_nop 0
Vc 75,8,9
Ve 8,164
Ve 9,165
s_nop 0
Vc 82,8,9
Ve 8,166
Ve 9,167
s_nop 0
Vc 83,8,9
Ve 8,180
Ve 9,181
s_nop 0
Vc 90,8,9
Ve 8,182
Ve 9,183
s_nop 0
Vc 91,8,9
Ve 8,136
Ve 9,137
s_nop 0
Vc 68,8,9
Ve 8,138
Ve 9,139
s_nop 0
Vc 69,8,9
Ve 8,152
Ve 9,153
s_nop 0
Vc 76,8,9
Ve 8,154
Ve 9,155
s_nop 0
Vc 77,8,9
Ve 8,168
Ve 9,169
s_nop 0
Vc 84,8,9
Ve 8,170
Ve 9,171
s_nop 0
Vc 85,8,9
Ve 8,184
Ve 9,185
s_nop 0
Vc 92,8,9
Ve 8,186
Ve 9,187
s_nop 0
Vc 93,8,9
Ve 8,140
Ve 9,141
s_nop 0
Vc 70,8,9
Ve 8,142
Ve 9,143
s_nop 0
Vc 71,8,9
Ve 8,156
Ve 9,157
s_nop 0
Vc 78,8,9
Ve 8,158
Ve 9,159
s_nop 0
Vc 79,8,9
Ve 8,172
Ve 9,173
s_nop 0
Vc 86,8,9
Ve 8,174
Ve 9,175
s_nop 0
Vc 87,8,9
Ve 8,188
Ve 9,189
s_nop 0
Vc 94,8,9
Ve 8,190
Ve 9,191
s_nop 0
Vc 95,8,9
s_nop 1
s_branch L_k2_fbr_we
L_k2_fb_wo:
s_nop 7
s_nop 0
v_max3_f32 v21, v192, v193, v194
v_max3_f32 v21, v21, v195, v196
v_max3_f32 v21, v21, v197, v198
v_max3_f32 v21, v21, v199, v200
v_max3_f32 v21, v21, v201, v202
v_max3_f32 v21, v21, v203, v204
v_max3_f32 v21, v21, v205, v206
v_max_f32 v21, v21, v207
v_mov_b32 v1, v21
s_nop 1
v_permlane16_swap_b32 v1, v21
v_max_f32 v21, v21, v1
v_mov_b32 v1, v21
s_nop 1
v_permlane32_swap_b32 v1, v21
v_max_f32_e64 v21, v21, v1
v_add_f32 v21, 0x41f80000, v21
v_max_f32 v21, 0, v21
Vs 192,192,21
Vs 193,193,21
Vs 194,194,21
Vs 195,195,21
Vs 196,196,21
Vs 197,197,21
Vs 198,198,21
Vs 199,199,21
Vs 200,200,21
Vs 201,201,21
Vs 202,202,21
Vs 203,203,21
Vs 204,204,21
Vs 205,205,21
Vs 206,206,21
Vs 207,207,21
Vs 128,128,21
Vs 129,129,21
Vs 130,130,21
Vs 131,131,21
Vs 132,132,21
Vs 133,133,21
Vs 134,134,21
Vs 135,135,21
Vs 136,136,21
Vs 137,137,21
Vs 138,138,21
Vs 139,139,21
Vs 140,140,21
Vs 141,141,21
Vs 142,142,21
Vs 143,143,21
Vs 32,32,21
Vs 33,33,21
Vs 34,34,21
v_sub_f32_e64 v35, v35, v21
v_exp_f32 v22, -v21
s_nop 0
Vm 48,48,22
Vm 49,49,22
Vm 50,50,22
v_mul_f32_e64 v51, v51, v22
Ar 8,0
Ar 9,1
Ar 10,2
Ar 11,3
Ar 12,4
Ar 13,5
Ar 14,6
Ar 15,7
Vm 8,8,22
Vm 9,9,22
Vm 10,10,22
Vm 11,11,22
Vm 12,12,22
Vm 13,13,22
Vm 14,14,22
Vm 15,15,22
Aw 0,8
Aw 1,9
Aw 2,10
Aw 3,11
Aw 4,12
Aw 5,13
Aw 6,14
Aw 7,15
Ar 8,8
Ar 9,9
Ar 10,10
Ar 11,11
Ar 12,12
Ar 13,13
Ar 14,14
Ar 15,15
Vm 8,8,22
Vm 9,9,22
Vm 10,10,22
Vm 11,11,22
Vm 12,12,22
Vm 13,13,22
Vm 14,14,22
Vm 15,15,22
Aw 8,8
Aw 9,9
Aw 10,10
Aw 11,11
Aw 12,12
Aw 13,13
Aw 14,14
Aw 15,15
Ar 8,16
Ar 9,17
Ar 10,18
Ar 11,19
Ar 12,20
Ar 13,21
Ar 14,22
Ar 15,23
Vm 8,8,22
Vm 9,9,22
Vm 10,10,22
Vm 11,11,22
Vm 12,12,22
Vm 13,13,22
Vm 14,14,22
Vm 15,15,22
Aw 16,8
Aw 17,9
Aw 18,10
Aw 19,11
Aw 20,12
Aw 21,13
Aw 22,14
Aw 23,15
Ar 8,24
Ar 9,25
Ar 10,26
Ar 11,27
Ar 12,28
Ar 13,29
Ar 14,30
Ar 15,31
Vm 8,8,22
Vm 9,9,22
Vm 10,10,22
Vm 11,11,22
Vm 12,12,22
Vm 13,13,22
Vm 14,14,22
Vm 15,15,22
Aw 24,8
Aw 25,9
Aw 26,10
Aw 27,11
Aw 28,12
Aw 29,13
Aw 30,14
Aw 31,15
v_max3_f32 v21, v208, v209, v210
v_max3_f32 v21, v21, v211, v212
v_max3_f32 v21, v21, v213, v214
v_max3_f32 v21, v21, v215, v216
v_max3_f32 v21, v21, v217, v218
v_max3_f32 v21, v21, v219, v220
v_max3_f32 v21, v21, v221, v222
v_max_f32 v21, v21, v223
v_mov_b32 v1, v21
s_nop 1
v_permlane16_swap_b32 v1, v21
v_max_f32 v21, v21, v1
v_mov_b32 v1, v21
s_nop 1
v_permlane32_swap_b32 v1, v21
v_max_f32_e64 v21, v21, v1
v_add_f32 v21, 0x41f80000, v21
v_max_f32 v21, 0, v21
Vs 208,208,21
Vs 209,209,21
Vs 210,210,21
Vs 211,211,21
Vs 212,212,21
Vs 213,213,21
Vs 214,214,21
Vs 215,215,21
Vs 216,216,21
Vs 217,217,21
Vs 218,218,21
Vs 219,219,21
Vs 220,220,21
Vs 221,221,21
Vs 222,222,21
Vs 223,223,21
Vs 144,144,21
Vs 145,145,21
Vs 146,146,21
Vs 147,147,21
Vs 148,148,21
Vs 149,149,21
Vs 150,150,21
Vs 151,151,21
Vs 152,152,21
Vs 153,153,21
Vs 154,154,21
Vs 155,155,21
Vs 156,156,21
Vs 157,157,21
Vs 158,158,21
Vs 159,159,21
Vs 36,36,21
Vs 37,37,21
Vs 38,38,21
v_sub_f32_e64 v39, v39, v21
v_exp_f32 v22, -v21
s_nop 0
Vm 52,52,22
Vm 53,53,22
Vm 54,54,22
v_mul_f32_e64 v55, v55, v22
Ar 8,32
Ar 9,33
Ar 10,34
Ar 11,35
Ar 12,36
Ar 13,37
Ar 14,38
Ar 15,39
Vm 8,8,22
Vm 9,9,22
Vm 10,10,22
Vm 11,11,22
Vm 12,12,22
Vm 13,13,22
Vm 14,14,22
Vm 15,15,22
Aw 32,8
Aw 33,9
Aw 34,10
Aw 35,11
Aw 36,12
Aw 37,13
Aw 38,14
Aw 39,15
Ar 8,40
Ar 9,41
Ar 10,42
Ar 11,43
Ar 12,44
Ar 13,45
Ar 14,46
Ar 15,47
Vm 8,8,22
Vm 9,9,22
Vm 10,10,22
Vm 11,11,22
Vm 12,12,22
Vm 13,13,22
Vm 14,14,22
Vm 15,15,22
Aw 40,8
Aw 41,9
Aw 42,10
Aw 43,11
Aw 44,12
Aw 45,13
Aw 46,14
Aw 47,15
Ar 8,48
Ar 9,49
Ar 10,50
Ar 11,51
Ar 12,52
Ar 13,53
Ar 14,54
Ar 15,55
Vm 8,8,22
Vm 9,9,22
Vm 10,10,22
Vm 11,11,22
Vm 12,12,22
Vm 13,13,22
Vm 14,14,22
Vm 15,15,22
Aw 48,8
Aw 49,9
Aw 50,10
Aw 51,11
Aw 52,12
Aw 53,13
Aw 54,14
Aw 55,15
Ar 8,56
Ar 9,57
Ar 10,58
Ar 11,59
Ar 12,60
Ar 13,61
Ar 14,62
Ar 15,63
Vm 8,8,22
Vm 9,9,22
Vm 10,10,22
Vm 11,11,22
Vm 12,12,22
Vm 13,13,22
Vm 14,14,22
Vm 15,15,22
Aw 56,8
Aw 57,9
Aw 58,10
Aw 59,11
Aw 60,12
Aw 61,13
Aw 62,14
Aw 63,15
v_max3_f32 v21, v224, v225, v226
v_max3_f32 v21, v21, v227, v228
v_max3_f32 v21, v21, v229, v230
v_max3_f32 v21, v21, v231, v232
v_max3_f32 v21, v21, v233, v234
v_max3_f32 v21, v21, v235, v236
v_max3_f32 v21, v21, v237, v238
v_max_f32 v21, v21, v239
v_mov_b32 v1, v21
s_nop 1
v_permlane16_swap_b32 v1, v21
v_max_f32 v21, v21, v1
v_mov_b32 v1, v21
s_nop 1
v_permlane32_swap_b32 v1, v21
v_max_f32_e64 v21, v21, v1
v_add_f32 v21, 0x41f80000, v21
v_max_f32 v21, 0, v21
Vs 224,224,21
Vs 225,225,21
Vs 226,226,21
Vs 227,227,21
Vs 228,228,21
Vs 229,229,21
Vs 230,230,21
Vs 231,231,21
Vs 232,232,21
Vs 233,233,21
Vs 234,234,21
Vs 235,235,21
Vs 236,236,21
Vs 237,237,21
Vs 238,238,21
Vs 239,239,21
Vs 160,160,21
Vs 161,161,21
Vs 162,162,21
Vs 163,163,21
Vs 164,164,21
Vs 165,165,21
Vs 166,166,21
Vs 167,167,21
Vs 168,168,21
Vs 169,169,21
Vs 170,170,21
Vs 171,171,21
Vs 172,172,21
Vs 173,173,21
Vs 174,174,21
Vs 175,175,21
Vs 40,40,21
Vs 41,41,21
Vs 42,42,21
v_sub_f32_e64 v43, v43, v21
v_exp_f32 v22, -v21
s_nop 0
Vm 56,56,22
Vm 57,57,22
Vm 58,58,22
v_mul_f32_e64 v59, v59, v22
Ar 8,64
Ar 9,65
Ar 10,66
Ar 11,67
Ar 12,68
Ar 13,69
Ar 14,70
Ar 15,71
Vm 8,8,22
Vm 9,9,22
Vm 10,10,22
Vm 11,11,22
Vm 12,12,22
Vm 13,13,22
Vm 14,14,22
Vm 15,15,22
Aw 64,8
Aw 65,9
Aw 66,10
Aw 67,11
Aw 68,12
Aw 69,13
Aw 70,14
Aw 71,15
Ar 8,72
Ar 9,73
Ar 10,74
Ar 11,75
Ar 12,76
Ar 13,77
Ar 14,78
Ar 15,79
Vm 8,8,22
Vm 9,9,22
Vm 10,10,22
Vm 11,11,22
Vm 12,12,22
Vm 13,13,22
Vm 14,14,22
Vm 15,15,22
Aw 72,8
Aw 73,9
Aw 74,10
Aw 75,11
Aw 76,12
Aw 77,13
Aw 78,14
Aw 79,15
Ar 8,80
Ar 9,81
Ar 10,82
Ar 11,83
Ar 12,84
Ar 13,85
Ar 14,86
Ar 15,87
Vm 8,8,22
Vm 9,9,22
Vm 10,10,22
Vm 11,11,22
Vm 12,12,22
Vm 13,13,22
Vm 14,14,22
Vm 15,15,22
Aw 80,8
Aw 81,9
Aw 82,10
Aw 83,11
Aw 84,12
Aw 85,13
Aw 86,14
Aw 87,15
Ar 8,88
Ar 9,89
Ar 10,90
Ar 11,91
Ar 12,92
Ar 13,93
Ar 14,94
Ar 15,95
Vm 8,8,22
Vm 9,9,22
Vm 10,10,22
Vm 11,11,22
Vm 12,12,22
Vm 13,13,22
Vm 14,14,22
Vm 15,15,22
Aw 88,8
Aw 89,9
Aw 90,10
Aw 91,11
Aw 92,12
Aw 93,13
Aw 94,14
Aw 95,15
v_max3_f32 v21, v240, v241, v242
v_max3_f32 v21, v21, v243, v244
v_max3_f32 v21, v21, v245, v246
v_max3_f32 v21, v21, v247, v248
v_max3_f32 v21, v21, v249, v250
v_max3_f32 v21, v21, v251, v252
v_max3_f32 v21, v21, v253, v254
v_max_f32 v21, v21, v255
v_mov_b32 v1, v21
s_nop 1
v_permlane16_swap_b32 v1, v21
v_max_f32 v21, v21, v1
v_mov_b32 v1, v21
s_nop 1
v_permlane32_swap_b32 v1, v21
v_max_f32_e64 v21, v21, v1
v_add_f32 v21, 0x41f80000, v21
v_max_f32 v21, 0, v21
Vs 240,240,21
Vs 241,241,21
Vs 242,242,21
Vs 243,243,21
Vs 244,244,21
Vs 245,245,21
Vs 246,246,21
Vs 247,247,21
Vs 248,248,21
Vs 249,249,21
Vs 250,250,21
Vs 251,251,21
Vs 252,252,21
Vs 253,253,21
Vs 254,254,21
Vs 255,255,21
Vs 176,176,21
Vs 177,177,21
Vs 178,178,21
Vs 179,179,21
Vs 180,180,21
Vs 181,181,21
Vs 182,182,21
Vs 183,183,21
Vs 184,184,21
Vs 185,185,21
Vs 186,186,21
Vs 187,187,21
Vs 188,188,21
Vs 189,189,21
Vs 190,190,21
Vs 191,191,21
Vs 44,44,21
Vs 45,45,21
Vs 46,46,21
v_sub_f32_e64 v47, v47, v21
v_exp_f32 v22, -v21
s_nop 0
Vm 60,60,22
Vm 61,61,22
Vm 62,62,22
v_mul_f32_e64 v63, v63, v22
Ar 8,96
Ar 9,97
Ar 10,98
Ar 11,99
Ar 12,100
Ar 13,101
Ar 14,102
Ar 15,103
Vm 8,8,22
Vm 9,9,22
Vm 10,10,22
Vm 11,11,22
Vm 12,12,22
Vm 13,13,22
Vm 14,14,22
Vm 15,15,22
Aw 96,8
Aw 97,9
Aw 98,10
Aw 99,11
Aw 100,12
Aw 101,13
Aw 102,14
Aw 103,15
Ar 8,104
Ar 9,105
Ar 10,106
Ar 11,107
Ar 12,108
Ar 13,109
Ar 14,110
Ar 15,111
Vm 8,8,22
Vm 9,9,22
Vm 10,10,22
Vm 11,11,22
Vm 12,12,22
Vm 13,13,22
Vm 14,14,22
Vm 15,15,22
Aw 104,8
Aw 105,9
Aw 106,10
Aw 107,11
Aw 108,12
Aw 109,13
Aw 110,14
Aw 111,15
Ar 8,112
Ar 9,113
Ar 10,114
Ar 11,115
Ar 12,116
Ar 13,117
Ar 14,118
Ar 15,119
Vm 8,8,22
Vm 9,9,22
Vm 10,10,22
Vm 11,11,22
Vm 12,12,22
Vm 13,13,22
Vm 14,14,22
Vm 15,15,22
Aw 112,8
Aw 113,9
Aw 114,10
Aw 115,11
Aw 116,12
Aw 117,13
Aw 118,14
Aw 119,15
Ar 8,120
Ar 9,121
Ar 10,122
Ar 11,123
Ar 12,124
Ar 13,125
Ar 14,126
Ar 15,127
Vm 8,8,22
Vm 9,9,22
Vm 10,10,22
Vm 11,11,22
Vm 12,12,22
Vm 13,13,22
Vm 14,14,22
Vm 15,15,22
Aw 120,8
Aw 121,9
Aw 122,10
Aw 123,11
Aw 124,12
Aw 125,13
Aw 126,14
Aw 127,15
Ve 8,192
Ve 9,193
s_nop 0
Vc 96,8,9
Ve 8,194
Ve 9,195
s_nop 0
Vc 97,8,9
Ve 8,208
Ve 9,209
s_nop 0
Vc 104,8,9
Ve 8,210
Ve 9,211
s_nop 0
Vc 105,8,9
Ve 8,224
Ve 9,225
s_nop 0
Vc 112,8,9
Ve 8,226
Ve 9,227
s_nop 0
Vc 113,8,9
Ve 8,240
Ve 9,241
s_nop 0
Vc 120,8,9
Ve 8,242
Ve 9,243
s_nop 0
Vc 121,8,9
Ve 8,196
Ve 9,197
s_nop 0
Vc 98,8,9
Ve 8,198
Ve 9,199
s_nop 0
Vc 99,8,9
Ve 8,212
Ve 9,213
s_nop 0
Vc 106,8,9
Ve 8,214
Ve 9,215
s_nop 0
Vc 107,8,9
Ve 8,228
Ve 9,229
s_nop 0
Vc 114,8,9
Ve 8,230
Ve 9,231
s_nop 0
Vc 115,8,9
Ve 8,244
Ve 9,245
s_nop 0
Vc 122,8,9
Ve 8,246
Ve 9,247
s_nop 0
Vc 123,8,9
Ve 8,200
Ve 9,201
s_nop 0
Vc 100,8,9
Ve 8,202
Ve 9,203
s_nop 0
Vc 101,8,9
Ve 8,216
Ve 9,217
s_nop 0
Vc 108,8,9
Ve 8,218
Ve 9,219
s_nop 0
Vc 109,8,9
Ve 8,232
Ve 9,233
s_nop 0
Vc 116,8,9
Ve 8,234
Ve 9,235
s_nop 0
Vc 117,8,9
Ve 8,248
Ve 9,249
s_nop 0
Vc 124,8,9
Ve 8,250
Ve 9,251
s_nop 0
Vc 125,8,9
Ve 8,204
Ve 9,205
s_nop 0
Vc 102,8,9
Ve 8,206
Ve 9,207
s_nop 0
Vc 103,8,9
Ve 8,220
Ve 9,221
s_nop 0
Vc 110,8,9
Ve 8,222
Ve 9,223
s_nop 0
Vc 111,8,9
Ve 8,236
Ve 9,237
s_nop 0
Vc 118,8,9
Ve 8,238
Ve 9,239
s_nop 0
Vc 119,8,9
Ve 8,252
Ve 9,253
s_nop 0
Vc 126,8,9
Ve 8,254
Ve 9,255
s_nop 0
Vc 127,8,9
s_nop 1
s_branch L_k2_fbr_wo
L_k2_fb_wl:
s_nop 7
s_nop 0
v_max3_f32 v21, v128, v129, v130
v_max3_f32 v21, v21, v131, v132
v_max3_f32 v21, v21, v133, v134
v_max3_f32 v21, v21, v135, v136
v_max3_f32 v21, v21, v137, v138
v_max3_f32 v21, v21, v139, v140
v_max3_f32 v21, v21, v141, v142
v_max_f32 v21, v21, v143
v_mov_b32 v1, v21
s_nop 1
v_permlane16_swap_b32 v1, v21
v_max_f32 v21, v21, v1
v_mov_b32 v1, v21
s_nop 1
v_permlane32_swap_b32 v1, v21
v_max_f32_e64 v21, v21, v1
v_add_f32 v21, 0x41f80000, v21
v_max_f32 v21, 0, v21
Vs 128,128,21
Vs 129,129,21
Vs 130,130,21
Vs 131,131,21
Vs 132,132,21
Vs 133,133,21
Vs 134,134,21
Vs 135,135,21
Vs 136,136,21
Vs 137,137,21
Vs 138,138,21
Vs 139,139,21
Vs 140,140,21
Vs 141,141,21
Vs 142,142,21
Vs 143,143,21
Vs 192,192,21
Vs 193,193,21
Vs 194,194,21
Vs 195,195,21
Vs 196,196,21
Vs 197,197,21
Vs 198,198,21
Vs 199,199,21
Vs 200,200,21
Vs 201,201,21
Vs 202,202,21
Vs 203,203,21
Vs 204,204,21
Vs 205,205,21
Vs 206,206,21
Vs 207,207,21
Vs 32,32,21
Vs 33,33,21
Vs 34,34,21
v_sub_f32_e64 v35, v35, v21
v_exp_f32 v22, -v21
s_nop 0
Vm 48,48,22
Vm 49,49,22
Vm 50,50,22
v_mul_f32_e64 v51, v51, v22
Ar 8,0
Ar 9,1
Ar 10,2
Ar 11,3
Ar 12,4
Ar 13,5
Ar 14,6
Ar 15,7
Vm 8,8,22
Vm 9,9,22
Vm 10,10,22
Vm 11,11,22
Vm 12,12,22
Vm 13,13,22
Vm 14,14,22
Vm 15,15,22
Aw 0,8
Aw 1,9
Aw 2,10
Aw 3,11
Aw 4,12
Aw 5,13
Aw 6,14
Aw 7,15
Ar 8,8
Ar 9,9
Ar 10,10
Ar 11,11
Ar 12,12
Ar 13,13
Ar 14,14
Ar 15,15
Vm 8,8,22
Vm 9,9,22
Vm 10,10,22
Vm 11,11,22
Vm 12,12,22
Vm 13,13,22
Vm 14,14,22
Vm 15,15,22
Aw 8,8
Aw 9,9
Aw 10,10
Aw 11,11
Aw 12,12
Aw 13,13
Aw 14,14
Aw 15,15
Ar 8,16
Ar 9,17
Ar 10,18
Ar 11,19
Ar 12,20
Ar 13,21
Ar 14,22
Ar 15,23
Vm 8,8,22
Vm 9,9,22
Vm 10,10,22
Vm 11,11,22
Vm 12,12,22
Vm 13,13,22
Vm 14,14,22
Vm 15,15,22
Aw 16,8
Aw 17,9
Aw 18,10
Aw 19,11
Aw 20,12
Aw 21,13
Aw 22,14
Aw 23,15
Ar 8,24
Ar 9,25
Ar 10,26
Ar 11,27
Ar 12,28
Ar 13,29
Ar 14,30
Ar 15,31
Vm 8,8,22
Vm 9,9,22
Vm 10,10,22
Vm 11,11,22
Vm 12,12,22
Vm 13,13,22
Vm 14,14,22
Vm 15,15,22
Aw 24,8
Aw 25,9
Aw 26,10
Aw 27,11
Aw 28,12
Aw 29,13
Aw 30,14
Aw 31,15
v_max3_f32 v21, v144, v145, v146
v_max3_f32 v21, v21, v147, v148
v_max3_f32 v21, v21, v149, v150
v_max3_f32 v21, v21, v151, v152
v_max3_f32 v21, v21, v153, v154
v_max3_f32 v21, v21, v155, v156
v_max3_f32 v21, v21, v157, v158
v_max_f32 v21, v21, v159
v_mov_b32 v1, v21
s_nop 1
v_permlane16_swap_b32 v1, v21
v_max_f32 v21, v21, v1
v_mov_b32 v1, v21
s_nop 1
v_permlane32_swap_b32 v1, v21
v_max_f32_e64 v21, v21, v1
v_add_f32 v21, 0x41f80000, v21
v_max_f32 v21, 0, v21
Vs 144,144,21
Vs 145,145,21
Vs 146,146,21
Vs 147,147,21
Vs 148,148,21
Vs 149,149,21
Vs 150,150,21
Vs 151,151,21
Vs 152,152,21
Vs 153,153,21
Vs 154,154,21
Vs 155,155,21
Vs 156,156,21
Vs 157,157,21
Vs 158,158,21
Vs 159,159,21
Vs 208,208,21
Vs 209,209,21
Vs 210,210,21
Vs 211,211,21
Vs 212,212,21
Vs 213,213,21
Vs 214,214,21
Vs 215,215,21
Vs 216,216,21
Vs 217,217,21
Vs 218,218,21
Vs 219,219,21
Vs 220,220,21
Vs 221,221,21
Vs 222,222,21
Vs 223,223,21
Vs 36,36,21
Vs 37,37,21
Vs 38,38,21
v_sub_f32_e64 v39, v39, v21
v_exp_f32 v22, -v21
s_nop 0
Vm 52,52,22
Vm 53,53,22
Vm 54,54,22
v_mul_f32_e64 v55, v55, v22
Ar 8,32
Ar 9,33
Ar 10,34
Ar 11,35
Ar 12,36
Ar 13,37
Ar 14,38
Ar 15,39
Vm 8,8,22
Vm 9,9,22
Vm 10,10,22
Vm 11,11,22
Vm 12,12,22
Vm 13,13,22
Vm 14,14,22
Vm 15,15,22
Aw 32,8
Aw 33,9
Aw 34,10
Aw 35,11
Aw 36,12
Aw 37,13
Aw 38,14
Aw 39,15
Ar 8,40
Ar 9,41
Ar 10,42
Ar 11,43
Ar 12,44
Ar 13,45
Ar 14,46
Ar 15,47
Vm 8,8,22
Vm 9,9,22
Vm 10,10,22
Vm 11,11,22
Vm 12,12,22
Vm 13,13,22
Vm 14,14,22
Vm 15,15,22
Aw 40,8
Aw 41,9
Aw 42,10
Aw 43,11
Aw 44,12
Aw 45,13
Aw 46,14
Aw 47,15
Ar 8,48
Ar 9,49
Ar 10,50
Ar 11,51
Ar 12,52
Ar 13,53
Ar 14,54
Ar 15,55
Vm 8,8,22
Vm 9,9,22
Vm 10,10,22
Vm 11,11,22
Vm 12,12,22
Vm 13,13,22
Vm 14,14,22
Vm 15,15,22
Aw 48,8
Aw 49,9
Aw 50,10
Aw 51,11
Aw 52,12
Aw 53,13
Aw 54,14
Aw 55,15
Ar 8,56
Ar 9,57
Ar 10,58
Ar 11,59
Ar 12,60
Ar 13,61
Ar 14,62
Ar 15,63
Vm 8,8,22
Vm 9,9,22
Vm 10,10,22
Vm 11,11,22
Vm 12,12,22
Vm 13,13,22
Vm 14,14,22
Vm 15,15,22
Aw 56,8
Aw 57,9
Aw 58,10
Aw 59,11
Aw 60,12
Aw 61,13
Aw 62,14
Aw 63,15
v_max3_f32 v21, v160, v161, v162
v_max3_f32 v21, v21, v163, v164
v_max3_f32 v21, v21, v165, v166
v_max3_f32 v21, v21, v167, v168
v_max3_f32 v21, v21, v169, v170
v_max3_f32 v21, v21, v171, v172
v_max3_f32 v21, v21, v173, v174
v_max_f32 v21, v21, v175
v_mov_b32 v1, v21
s_nop 1
v_permlane16_swap_b32 v1, v21
v_max_f32 v21, v21, v1
v_mov_b32 v1, v21
s_nop 1
v_permlane32_swap_b32 v1, v21
v_max_f32_e64 v21, v21, v1
v_add_f32 v21, 0x41f80000, v21
v_max_f32 v21, 0, v21
Vs 160,160,21
Vs 161,161,21
Vs 162,162,21
Vs 163,163,21
Vs 164,164,21
Vs 165,165,21
Vs 166,166,21
Vs 167,167,21
Vs 168,168,21
Vs 169,169,21
Vs 170,170,21
Vs 171,171,21
Vs 172,172,21
Vs 173,173,21
Vs 174,174,21
Vs 175,175,21
Vs 224,224,21
Vs 225,225,21
Vs 226,226,21
Vs 227,227,21
Vs 228,228,21
Vs 229,229,21
Vs 230,230,21
Vs 231,231,21
Vs 232,232,21
Vs 233,233,21
Vs 234,234,21
Vs 235,235,21
Vs 236,236,21
Vs 237,237,21
Vs 238,238,21
Vs 239,239,21
Vs 40,40,21
Vs 41,41,21
Vs 42,42,21
v_sub_f32_e64 v43, v43, v21
v_exp_f32 v22, -v21
s_nop 0
Vm 56,56,22
Vm 57,57,22
Vm 58,58,22
v_mul_f32_e64 v59, v59, v22
Ar 8,64
Ar 9,65
Ar 10,66
Ar 11,67
Ar 12,68
Ar 13,69
Ar 14,70
Ar 15,71
Vm 8,8,22
Vm 9,9,22
Vm 10,10,22
Vm 11,11,22
Vm 12,12,22
Vm 13,13,22
Vm 14,14,22
Vm 15,15,22
Aw 64,8
Aw 65,9
Aw 66,10
Aw 67,11
Aw 68,12
Aw 69,13
Aw 70,14
Aw 71,15
Ar 8,72
Ar 9,73
Ar 10,74
Ar 11,75
Ar 12,76
Ar 13,77
Ar 14,78
Ar 15,79
Vm 8,8,22
Vm 9,9,22
Vm 10,10,22
Vm 11,11,22
Vm 12,12,22
Vm 13,13,22
Vm 14,14,22
Vm 15,15,22
Aw 72,8
Aw 73,9
Aw 74,10
Aw 75,11
Aw 76,12
Aw 77,13
Aw 78,14
Aw 79,15
Ar 8,80
Ar 9,81
Ar 10,82
Ar 11,83
Ar 12,84
Ar 13,85
Ar 14,86
Ar 15,87
Vm 8,8,22
Vm 9,9,22
Vm 10,10,22
Vm 11,11,22
Vm 12,12,22
Vm 13,13,22
Vm 14,14,22
Vm 15,15,22
Aw 80,8
Aw 81,9
Aw 82,10
Aw 83,11
Aw 84,12
Aw 85,13
Aw 86,14
Aw 87,15
Ar 8,88
Ar 9,89
Ar 10,90
Ar 11,91
Ar 12,92
Ar 13,93
Ar 14,94
Ar 15,95
Vm 8,8,22
Vm 9,9,22
Vm 10,10,22
Vm 11,11,22
Vm 12,12,22
Vm 13,13,22
Vm 14,14,22
Vm 15,15,22
Aw 88,8
Aw 89,9
Aw 90,10
Aw 91,11
Aw 92,12
Aw 93,13
Aw 94,14
Aw 95,15
v_max3_f32 v21, v176, v177, v178
v_max3_f32 v21, v21, v179, v180
v_max3_f32 v21, v21, v181, v182
v_max3_f32 v21, v21, v183, v184
v_max3_f32 v21, v21, v185, v186
v_max3_f32 v21, v21, v187, v188
v_max3_f32 v21, v21, v189, v190
v_max_f32 v21, v21, v191
v_mov_b32 v1, v21
s_nop 1
v_permlane16_swap_b32 v1, v21
v_max_f32 v21, v21, v1
v_mov_b32 v1, v21
s_nop 1
v_permlane32_swap_b32 v1, v21
v_max_f32_e64 v21, v21, v1
v_add_f32 v21, 0x41f80000, v21
v_max_f32 v21, 0, v21
Vs 176,176,21
Vs 177,177,21
Vs 178,178,21
Vs 179,179,21
Vs 180,180,21
Vs 181,181,21
Vs 182,182,21
Vs 183,183,21
Vs 184,184,21
Vs 185,185,21
Vs 186,186,21
Vs 187,187,21
Vs 188,188,21
Vs 189,189,21
Vs 190,190,21
Vs 191,191,21
Vs 44,44,21
Vs 45,45,21
Vs 46,46,21
v_sub_f32_e64 v47, v47, v21
v_exp_f32 v22, -v21
s_nop 0
Vm 60,60,22
Vm 61,61,22
Vm 62,62,22
v_mul_f32_e64 v63, v63, v22
Ar 8,96
Ar 9,97
Ar 10,98
Ar 11,99
Ar 12,100
Ar 13,101
Ar 14,102
Ar 15,103
Vm 8,8,22
Vm 9,9,22
Vm 10,10,22
Vm 11,11,22
Vm 12,12,22
Vm 13,13,22
Vm 14,14,22
Vm 15,15,22
Aw 96,8
Aw 97,9
Aw 98,10
Aw 99,11
Aw 100,12
Aw 101,13
Aw 102,14
Aw 103,15
Ar 8,104
Ar 9,105
Ar 10,106
Ar 11,107
Ar 12,108
Ar 13,109
Ar 14,110
Ar 15,111
Vm 8,8,22
Vm 9,9,22
Vm 10,10,22
Vm 11,11,22
Vm 12,12,22
Vm 13,13,22
Vm 14,14,22
Vm 15,15,22
Aw 104,8
Aw 105,9
Aw 106,10
Aw 107,11
Aw 108,12
Aw 109,13
Aw 110,14
Aw 111,15
Ar 8,112
Ar 9,113
Ar 10,114
Ar 11,115
Ar 12,116
Ar 13,117
Ar 14,118
Ar 15,119
Vm 8,8,22
Vm 9,9,22
Vm 10,10,22
Vm 11,11,22
Vm 12,12,22
Vm 13,13,22
Vm 14,14,22
Vm 15,15,22
Aw 112,8
Aw 113,9
Aw 114,10
Aw 115,11
Aw 116,12
Aw 117,13
Aw 118,14
Aw 119,15
Ar 8,120
Ar 9,121
Ar 10,122
Ar 11,123
Ar 12,124
Ar 13,125
Ar 14,126
Ar 15,127
Vm 8,8,22
Vm 9,9,22
Vm 10,10,22
Vm 11,11,22
Vm 12,12,22
Vm 13,13,22
Vm 14,14,22
Vm 15,15,22
Aw 120,8
Aw 121,9
Aw 122,10
Aw 123,11
Aw 124,12
Aw 125,13
Aw 126,14
Aw 127,15
Ve 8,128
Ve 9,129
s_nop 0
Vc 64,8,9
Ve 8,130
Ve 9,131
s_nop 0
Vc 65,8,9
Ve 8,144
Ve 9,145
s_nop 0
Vc 72,8,9
Ve 8,146
Ve 9,147
s_nop 0
Vc 73,8,9
Ve 8,160
Ve 9,161
s_nop 0
Vc 80,8,9
Ve 8,162
Ve 9,163
s_nop 0
Vc 81,8,9
Ve 8,176
Ve 9,177
s_nop 0
Vc 88,8,9
Ve 8,178
Ve 9,179
s_nop 0
Vc 89,8,9
Ve 8,132
Ve 9,133
s_nop 0
Vc 66,8,9
Ve 8,134
Ve 9,135
s_nop 0
Vc 67,8,9
Ve 8,148
Ve 9,149
s_nop 0
Vc 74,8,9
Ve 8,150
Ve 9,151
s_nop 0
Vc 75,8,9
Ve 8,164
Ve 9,165
s_nop 0
Vc 82,8,9
Ve 8,166
Ve 9,167
s_nop 0
Vc 83,8,9
Ve 8,180
Ve 9,181
s_nop 0
Vc 90,8,9
Ve 8,182
Ve 9,183
s_nop 0
Vc 91,8,9
Ve 8,136
Ve 9,137
s_nop 0
Vc 68,8,9
Ve 8,138
Ve 9,139
s_nop 0
Vc 69,8,9
Ve 8,152
Ve 9,153
s_nop 0
Vc 76,8,9
Ve 8,154
Ve 9,155
s_nop 0
Vc 77,8,9
Ve 8,168
Ve 9,169
s_nop 0
Vc 84,8,9
Ve 8,170
Ve 9,171
s_nop 0
Vc 85,8,9
Ve 8,184
Ve 9,185
s_nop 0
Vc 92,8,9
Ve 8,186
Ve 9,187
s_nop 0
Vc 93,8,9
Ve 8,140
Ve 9,141
s_nop 0
Vc 70,8,9
Ve 8,142
Ve 9,143
s_nop 0
Vc 71,8,9
Ve 8,156
Ve 9,157
s_nop 0
Vc 78,8,9
Ve 8,158
Ve 9,159
s_nop 0
Vc 79,8,9
Ve 8,172
Ve 9,173
s_nop 0
Vc 86,8,9
Ve 8,174
Ve 9,175
s_nop 0
Vc 87,8,9
Ve 8,188
Ve 9,189
s_nop 0
Vc 94,8,9
Ve 8,190
Ve 9,191
s_nop 0
Vc 95,8,9
s_nop 1
s_branch L_k2_fbr_wl
L_k2_fb_tr:
s_nop 7
s_nop 0
v_max3_f32 v21, v192, v193, v194
v_max3_f32 v21, v21, v195, v196
v_max3_f32 v21, v21, v197, v198
v_max3_f32 v21, v21, v199, v200
v_max3_f32 v21, v21, v201, v202
v_max3_f32 v21, v21, v203, v204
v_max3_f32 v21, v21, v205, v206
v_max_f32 v21, v21, v207
v_mov_b32 v1, v21
s_nop 1
v_permlane16_swap_b32 v1, v21
v_max_f32 v21, v21, v1
v_mov_b32 v1, v21
s_nop 1
v_permlane32_swap_b32 v1, v21
v_max_f32_e64 v21, v21, v1
v_add_f32 v21, 0x41f80000, v21
v_max_f32 v21, 0, v21
Vs 192,192,21
Vs 193,193,21
Vs 194,194,21
Vs 195,195,21
Vs 196,196,21
Vs 197,197,21
Vs 198,198,21
Vs 199,199,21
Vs 200,200,21
Vs 201,201,21
Vs 202,202,21
Vs 203,203,21
Vs 204,204,21
Vs 205,205,21
Vs 206,206,21
Vs 207,207,21
Vs 128,128,21
Vs 129,129,21
Vs 130,130,21
Vs 131,131,21
Vs 132,132,21
Vs 133,133,21
Vs 134,134,21
Vs 135,135,21
Vs 136,136,21
Vs 137,137,21
Vs 138,138,21
Vs 139,139,21
Vs 140,140,21
Vs 141,141,21
Vs 142,142,21
Vs 143,143,21
Vs 32,32,21
Vs 33,33,21
Vs 34,34,21
v_sub_f32_e64 v35, v35, v21
v_exp_f32 v22, -v21
s_nop 0
Vm 48,48,22
Vm 49,49,22
Vm 50,50,22
v_mul_f32_e64 v51, v51, v22
Ar 8,0
Ar 9,1
Ar 10,2
Ar 11,3
Ar 12,4
Ar 13,5
Ar 14,6
Ar 15,7
Vm 8,8,22
Vm 9,9,22
Vm 10,10,22
Vm 11,11,22
Vm 12,12,22
Vm 13,13,22
Vm 14,14,22
Vm 15,15,22
Aw 0,8
Aw 1,9
Aw 2,10
Aw 3,11
Aw 4,12
Aw 5,13
Aw 6,14
Aw 7,15
Ar 8,8
Ar 9,9
Ar 10,10
Ar 11,11
Ar 12,12
Ar 13,13
Ar 14,14
Ar 15,15
Vm 8,8,22
Vm 9,9,22
Vm 10,10,22
Vm 11,11,22
Vm 12,12,22
Vm 13,13,22
Vm 14,14,22
Vm 15,15,22
Aw 8,8
Aw 9,9
Aw 10,10
Aw 11,11
Aw 12,12
Aw 13,13
Aw 14,14
Aw 15,15
Ar 8,16
Ar 9,17
Ar 10,18
Ar 11,19
Ar 12,20
Ar 13,21
Ar 14,22
Ar 15,23
Vm 8,8,22
Vm 9,9,22
Vm 10,10,22
Vm 11,11,22
Vm 12,12,22
Vm 13,13,22
Vm 14,14,22
Vm 15,15,22
Aw 16,8
Aw 17,9
Aw 18,10
Aw 19,11
Aw 20,12
Aw 21,13
Aw 22,14
Aw 23,15
Ar 8,24
Ar 9,25
Ar 10,26
Ar 11,27
Ar 12,28
Ar 13,29
Ar 14,30
Ar 15,31
Vm 8,8,22
Vm 9,9,22
Vm 10,10,22
Vm 11,11,22
Vm 12,12,22
Vm 13,13,22
Vm 14,14,22
Vm 15,15,22
Aw 24,8
Aw 25,9
Aw 26,10
Aw 27,11
Aw 28,12
Aw 29,13
Aw 30,14
Aw 31,15
v_max3_f32 v21, v208, v209, v210
v_max3_f32 v21, v21, v211, v212
v_max3_f32 v21, v21, v213, v214
v_max3_f32 v21, v21, v215, v216
v_max3_f32 v21, v21, v217, v218
v_max3_f32 v21, v21, v219, v220
v_max3_f32 v21, v21, v221, v222
v_max_f32 v21, v21, v223
v_mov_b32 v1, v21
s_nop 1
v_permlane16_swap_b32 v1, v21
v_max_f32 v21, v21, v1
v_mov_b32 v1, v21
s_nop 1
v_permlane32_swap_b32 v1, v21
v_max_f32_e64 v21, v21, v1
v_add_f32 v21, 0x41f80000, v21
v_max_f32 v21, 0, v21
Vs 208,208,21
Vs 209,209,21
Vs 210,210,21
Vs 211,211,21
Vs 212,212,21
Vs 213,213,21
Vs 214,214,21
Vs 215,215,21
Vs 216,216,21
Vs 217,217,21
Vs 218,218,21
Vs 219,219,21
Vs 220,220,21
Vs 221,221,21
Vs 222,222,21
Vs 223,223,21
Vs 144,144,21
Vs 145,145,21
Vs 146,146,21
Vs 147,147,21
Vs 148,148,21
Vs 149,149,21
Vs 150,150,21
Vs 151,151,21
Vs 152,152,21
Vs 153,153,21
Vs 154,154,21
Vs 155,155,21
Vs 156,156,21
Vs 157,157,21
Vs 158,158,21
Vs 159,159,21
Vs 36,36,21
Vs 37,37,21
Vs 38,38,21
v_sub_f32_e64 v39, v39, v21
v_exp_f32 v22, -v21
s_nop 0
Vm 52,52,22
Vm 53,53,22
Vm 54,54,22
v_mul_f32_e64 v55, v55, v22
Ar 8,32
Ar 9,33
Ar 10,34
Ar 11,35
Ar 12,36
Ar 13,37
Ar 14,38
Ar 15,39
Vm 8,8,22
Vm 9,9,22
Vm 10,10,22
Vm 11,11,22
Vm 12,12,22
Vm 13,13,22
Vm 14,14,22
Vm 15,15,22
Aw 32,8
Aw 33,9
Aw 34,10
Aw 35,11
Aw 36,12
Aw 37,13
Aw 38,14
Aw 39,15
Ar 8,40
Ar 9,41
Ar 10,42
Ar 11,43
Ar 12,44
Ar 13,45
Ar 14,46
Ar 15,47
Vm 8,8,22
Vm 9,9,22
Vm 10,10,22
Vm 11,11,22
Vm 12,12,22
Vm 13,13,22
Vm 14,14,22
Vm 15,15,22
Aw 40,8
Aw 41,9
Aw 42,10
Aw 43,11
Aw 44,12
Aw 45,13
Aw 46,14
Aw 47,15
Ar 8,48
Ar 9,49
Ar 10,50
Ar 11,51
Ar 12,52
Ar 13,53
Ar 14,54
Ar 15,55
Vm 8,8,22
Vm 9,9,22
Vm 10,10,22
Vm 11,11,22
Vm 12,12,22
Vm 13,13,22
Vm 14,14,22
Vm 15,15,22
Aw 48,8
Aw 49,9
Aw 50,10
Aw 51,11
Aw 52,12
Aw 53,13
Aw 54,14
Aw 55,15
Ar 8,56
Ar 9,57
Ar 10,58
Ar 11,59
Ar 12,60
Ar 13,61
Ar 14,62
Ar 15,63
Vm 8,8,22
Vm 9,9,22
Vm 10,10,22
Vm 11,11,22
Vm 12,12,22
Vm 13,13,22
Vm 14,14,22
Vm 15,15,22
Aw 56,8
Aw 57,9
Aw 58,10
Aw 59,11
Aw 60,12
Aw 61,13
Aw 62,14
Aw 63,15
v_max3_f32 v21, v224, v225, v226
v_max3_f32 v21, v21, v227, v228
v_max3_f32 v21, v21, v229, v230
v_max3_f32 v21, v21, v231, v232
v_max3_f32 v21, v21, v233, v234
v_max3_f32 v21, v21, v235, v236
v_max3_f32 v21, v21, v237, v238
v_max_f32 v21, v21, v239
v_mov_b32 v1, v21
s_nop 1
v_permlane16_swap_b32 v1, v21
v_max_f32 v21, v21, v1
v_mov_b32 v1, v21
s_nop 1
v_permlane32_swap_b32 v1, v21
v_max_f32_e64 v21, v21, v1
v_add_f32 v21, 0x41f80000, v21
v_max_f32 v21, 0, v21
Vs 224,224,21
Vs 225,225,21
Vs 226,226,21
Vs 227,227,21
Vs 228,228,21
Vs 229,229,21
Vs 230,230,21
Vs 231,231,21
Vs 232,232,21
Vs 233,233,21
Vs 234,234,21
Vs 235,235,21
Vs 236,236,21
Vs 237,237,21
Vs 238,238,21
Vs 239,239,21
Vs 40,40,21
Vs 41,41,21
Vs 42,42,21
v_sub_f32_e64 v43, v43, v21
v_exp_f32 v22, -v21
s_nop 0
Vm 56,56,22
Vm 57,57,22
Vm 58,58,22
v_mul_f32_e64 v59, v59, v22
Ar 8,64
Ar 9,65
Ar 10,66
Ar 11,67
Ar 12,68
Ar 13,69
Ar 14,70
Ar 15,71
Vm 8,8,22
Vm 9,9,22
Vm 10,10,22
Vm 11,11,22
Vm 12,12,22
Vm 13,13,22
Vm 14,14,22
Vm 15,15,22
Aw 64,8
Aw 65,9
Aw 66,10
Aw 67,11
Aw 68,12
Aw 69,13
Aw 70,14
Aw 71,15
Ar 8,72
Ar 9,73
Ar 10,74
Ar 11,75
Ar 12,76
Ar 13,77
Ar 14,78
Ar 15,79
Vm 8,8,22
Vm 9,9,22
Vm 10,10,22
Vm 11,11,22
Vm 12,12,22
Vm 13,13,22
Vm 14,14,22
Vm 15,15,22
Aw 72,8
Aw 73,9
Aw 74,10
Aw 75,11
Aw 76,12
Aw 77,13
Aw 78,14
Aw 79,15
Ar 8,80
Ar 9,81
Ar 10,82
Ar 11,83
Ar 12,84
Ar 13,85
Ar 14,86
Ar 15,87
Vm 8,8,22
Vm 9,9,22
Vm 10,10,22
Vm 11,11,22
Vm 12,12,22
Vm 13,13,22
Vm 14,14,22
Vm 15,15,22
Aw 80,8
Aw 81,9
Aw 82,10
Aw 83,11
Aw 84,12
Aw 85,13
Aw 86,14
Aw 87,15
Ar 8,88
Ar 9,89
Ar 10,90
Ar 11,91
Ar 12,92
Ar 13,93
Ar 14,94
Ar 15,95
Vm 8,8,22
Vm 9,9,22
Vm 10,10,22
Vm 11,11,22
Vm 12,12,22
Vm 13,13,22
Vm 14,14,22
Vm 15,15,22
Aw 88,8
Aw 89,9
Aw 90,10
Aw 91,11
Aw 92,12
Aw 93,13
Aw 94,14
Aw 95,15
Ve 8,192
Ve 9,193
s_nop 0
Vc 96,8,9
Ve 8,194
Ve 9,195
s_nop 0
Vc 97,8,9
Ve 8,208
Ve 9,209
s_nop 0
Vc 104,8,9
Ve 8,210
Ve 9,211
s_nop 0
Vc 105,8,9
Ve 8,224
Ve 9,225
s_nop 0
Vc 112,8,9
Ve 8,226
Ve 9,227
s_nop 0
Vc 113,8,9
Ve 8,196
Ve 9,197
s_nop 0
Vc 98,8,9
Ve 8,198
Ve 9,199
s_nop 0
Vc 99,8,9
Ve 8,212
Ve 9,213
s_nop 0
Vc 106,8,9
Ve 8,214
Ve 9,215
s_nop 0
Vc 107,8,9
Ve 8,228
Ve 9,229
s_nop 0
Vc 114,8,9
Ve 8,230
Ve 9,231
s_nop 0
Vc 115,8,9
Ve 8,200
Ve 9,201
s_nop 0
Vc 100,8,9
Ve 8,202
Ve 9,203
s_nop 0
Vc 101,8,9
Ve 8,216
Ve 9,217
s_nop 0
Vc 108,8,9
Ve 8,218
Ve 9,219
s_nop 0
Vc 109,8,9
Ve 8,232
Ve 9,233
s_nop 0
Vc 116,8,9
Ve 8,234
Ve 9,235
s_nop 0
Vc 117,8,9
Ve 8,204
Ve 9,205
s_nop 0
Vc 102,8,9
Ve 8,206
Ve 9,207
s_nop 0
Vc 103,8,9
Ve 8,220
Ve 9,221
s_nop 0
Vc 110,8,9
Ve 8,222
Ve 9,223
s_nop 0
Vc 111,8,9
Ve 8,236
Ve 9,237
s_nop 0
Vc 118,8,9
Ve 8,238
Ve 9,239
s_nop 0
Vc 119,8,9
s_nop 1
s_branch L_k2_fbr_tr
L_k2_fb_ne:
s_nop 7
s_nop 0
v_max3_f32 v21, v128, v129, v130
v_max3_f32 v21, v21, v131, v132
v_max3_f32 v21, v21, v133, v134
v_max3_f32 v21, v21, v135, v136
v_max3_f32 v21, v21, v137, v138
v_max3_f32 v21, v21, v139, v140
v_max3_f32 v21, v21, v141, v142
v_max_f32 v21, v21, v143
v_mov_b32 v1, v21
s_nop 1
v_permlane16_swap_b32 v1, v21
v_max_f32 v21, v21, v1
v_mov_b32 v1, v21
s_nop 1
v_permlane32_swap_b32 v1, v21
v_max_f32_e64 v21, v21, v1
v_add_f32 v21, 0x41f80000, v21
v_max_f32 v21, 0, v21
Vs 128,128,21
Vs 129,129,21
Vs 130,130,21
Vs 131,131,21
Vs 132,132,21
Vs 133,133,21
Vs 134,134,21
Vs 135,135,21
Vs 136,136,21
Vs 137,137,21
Vs 138,138,21
Vs 139,139,21
Vs 140,140,21
Vs 141,141,21
Vs 142,142,21
Vs 143,143,21
Vs 192,192,21
Vs 193,193,21
Vs 194,194,21
Vs 195,195,21
Vs 196,196,21
Vs 197,197,21
Vs 198,198,21
Vs 199,199,21
Vs 200,200,21
Vs 201,201,21
Vs 202,202,21
Vs 203,203,21
Vs 204,204,21
Vs 205,205,21
Vs 206,206,21
Vs 207,207,21
Vs 32,32,21
Vs 33,33,21
Vs 34,34,21
v_sub_f32_e64 v35, v35, v21
v_exp_f32 v22, -v21
s_nop 0
Vm 48,48,22
Vm 49,49,22
Vm 50,50,22
v_mul_f32_e64 v51, v51, v22
Ar 8,0
Ar 9,1
Ar 10,2
Ar 11,3
Ar 12,4
Ar 13,5
Ar 14,6
Ar 15,7
Vm 8,8,22
Vm 9,9,22
Vm 10,10,22
Vm 11,11,22
Vm 12,12,22
Vm 13,13,22
Vm 14,14,22
Vm 15,15,22
Aw 0,8
Aw 1,9
Aw 2,10
Aw 3,11
Aw 4,12
Aw 5,13
Aw 6,14
Aw 7,15
Ar 8,8
Ar 9,9
Ar 10,10
Ar 11,11
Ar 12,12
Ar 13,13
Ar 14,14
Ar 15,15
Vm 8,8,22
Vm 9,9,22
Vm 10,10,22
Vm 11,11,22
Vm 12,12,22
Vm 13,13,22
Vm 14,14,22
Vm 15,15,22
Aw 8,8
Aw 9,9
Aw 10,10
Aw 11,11
Aw 12,12
Aw 13,13
Aw 14,14
Aw 15,15
Ar 8,16
Ar 9,17
Ar 10,18
Ar 11,19
Ar 12,20
Ar 13,21
Ar 14,22
Ar 15,23
Vm 8,8,22
Vm 9,9,22
Vm 10,10,22
Vm 11,11,22
Vm 12,12,22
Vm 13,13,22
Vm 14,14,22
Vm 15,15,22
Aw 16,8
Aw 17,9
Aw 18,10
Aw 19,11
Aw 20,12
Aw 21,13
Aw 22,14
Aw 23,15
Ar 8,24
Ar 9,25
Ar 10,26
Ar 11,27
Ar 12,28
Ar 13,29
Ar 14,30
Ar 15,31
Vm 8,8,22
Vm 9,9,22
Vm 10,10,22
Vm 11,11,22
Vm 12,12,22
Vm 13,13,22
Vm 14,14,22
Vm 15,15,22
Aw 24,8
Aw 25,9
Aw 26,10
Aw 27,11
Aw 28,12
Aw 29,13
Aw 30,14
Aw 31,15
v_max3_f32 v21, v144, v145, v146
v_max3_f32 v21, v21, v147, v148
v_max3_f32 v21, v21, v149, v150
v_max3_f32 v21, v21, v151, v152
v_max3_f32 v21, v21, v153, v154
v_max3_f32 v21, v21, v155, v156
v_max3_f32 v21, v21, v157, v158
v_max_f32 v21, v21, v159
v_mov_b32 v1, v21
s_nop 1
v_permlane16_swap_b32 v1, v21
v_max_f32 v21, v21, v1
v_mov_b32 v1, v21
s_nop 1
v_permlane32_swap_b32 v1, v21
v_max_f32_e64 v21, v21, v1
v_add_f32 v21, 0x41f80000, v21
v_max_f32 v21, 0, v21
Vs 144,144,21
Vs 145,145,21
Vs 146,146,21
Vs 147,147,21
Vs 148,148,21
Vs 149,149,21
Vs 150,150,21
Vs 151,151,21
Vs 152,152,21
Vs 153,153,21
Vs 154,154,21
Vs 155,155,21
Vs 156,156,21
Vs 157,157,21
Vs 158,158,21
Vs 159,159,21
Vs 208,208,21
Vs 209,209,21
Vs 210,210,21
Vs 211,211,21
Vs 212,212,21
Vs 213,213,21
Vs 214,214,21
Vs 215,215,21
Vs 216,216,21
Vs 217,217,21
Vs 218,218,21
Vs 219,219,21
Vs 220,220,21
Vs 221,221,21
Vs 222,222,21
Vs 223,223,21
Vs 36,36,21
Vs 37,37,21
Vs 38,38,21
v_sub_f32_e64 v39, v39, v21
v_exp_f32 v22, -v21
s_nop 0
Vm 52,52,22
Vm 53,53,22
Vm 54,54,22
v_mul_f32_e64 v55, v55, v22
Ar 8,32
Ar 9,33
Ar 10,34
Ar 11,35
Ar 12,36
Ar 13,37
Ar 14,38
Ar 15,39
Vm 8,8,22
Vm 9,9,22
Vm 10,10,22
Vm 11,11,22
Vm 12,12,22
Vm 13,13,22
Vm 14,14,22
Vm 15,15,22
Aw 32,8
Aw 33,9
Aw 34,10
Aw 35,11
Aw 36,12
Aw 37,13
Aw 38,14
Aw 39,15
Ar 8,40
Ar 9,41
Ar 10,42
Ar 11,43
Ar 12,44
Ar 13,45
Ar 14,46
Ar 15,47
Vm 8,8,22
Vm 9,9,22
Vm 10,10,22
Vm 11,11,22
Vm 12,12,22
Vm 13,13,22
Vm 14,14,22
Vm 15,15,22
Aw 40,8
Aw 41,9
Aw 42,10
Aw 43,11
Aw 44,12
Aw 45,13
Aw 46,14
Aw 47,15
Ar 8,48
Ar 9,49
Ar 10,50
Ar 11,51
Ar 12,52
Ar 13,53
Ar 14,54
Ar 15,55
Vm 8,8,22
Vm 9,9,22
Vm 10,10,22
Vm 11,11,22
Vm 12,12,22
Vm 13,13,22
Vm 14,14,22
Vm 15,15,22
Aw 48,8
Aw 49,9
Aw 50,10
Aw 51,11
Aw 52,12
Aw 53,13
Aw 54,14
Aw 55,15
Ar 8,56
Ar 9,57
Ar 10,58
Ar 11,59
Ar 12,60
Ar 13,61
Ar 14,62
Ar 15,63
Vm 8,8,22
Vm 9,9,22
Vm 10,10,22
Vm 11,11,22
Vm 12,12,22
Vm 13,13,22
Vm 14,14,22
Vm 15,15,22
Aw 56,8
Aw 57,9
Aw 58,10
Aw 59,11
Aw 60,12
Aw 61,13
Aw 62,14
Aw 63,15
Ve 8,128
Ve 9,129
s_nop 0
Vc 64,8,9
Ve 8,130
Ve 9,131
s_nop 0
Vc 65,8,9
Ve 8,144
Ve 9,145
s_nop 0
Vc 72,8,9
Ve 8,146
Ve 9,147
s_nop 0
Vc 73,8,9
Ve 8,132
Ve 9,133
s_nop 0
Vc 66,8,9
Ve 8,134
Ve 9,135
s_nop 0
Vc 67,8,9
Ve 8,148
Ve 9,149
s_nop 0
Vc 74,8,9
Ve 8,150
Ve 9,151
s_nop 0
Vc 75,8,9
Ve 8,136
Ve 9,137
s_nop 0
Vc 68,8,9
Ve 8,138
Ve 9,139
s_nop 0
Vc 69,8,9
Ve 8,152
Ve 9,153
s_nop 0
Vc 76,8,9
Ve 8,154
Ve 9,155
s_nop 0
Vc 77,8,9
Ve 8,140
Ve 9,141
s_nop 0
Vc 70,8,9
Ve 8,142
Ve 9,143
s_nop 0
Vc 71,8,9
Ve 8,156
Ve 9,157
s_nop 0
Vc 78,8,9
Ve 8,158
Ve 9,159
s_nop 0
Vc 79,8,9
s_nop 1
s_branch L_k2_fbr_ne
L_k2_fb_no:
s_nop 7
s_nop 0
v_max3_f32 v21, v192, v193, v194
v_max3_f32 v21, v21, v195, v196
v_max3_f32 v21, v21, v197, v198
v_max3_f32 v21, v21, v199, v200
v_max3_f32 v21, v21, v201, v202
v_max3_f32 v21, v21, v203, v204
v_max3_f32 v21, v21, v205, v206
v_max_f32 v21, v21, v207
v_mov_b32 v1, v21
s_nop 1
v_permlane16_swap_b32 v1, v21
v_max_f32 v21, v21, v1
v_mov_b32 v1, v21
s_nop 1
v_permlane32_swap_b32 v1, v21
v_max_f32_e64 v21, v21, v1
v_add_f32 v21, 0x41f80000, v21
v_max_f32 v21, 0, v21
Vs 192,192,21
Vs 193,193,21
Vs 194,194,21
Vs 195,195,21
Vs 196,196,21
Vs 197,197,21
Vs 198,198,21
Vs 199,199,21
Vs 200,200,21
Vs 201,201,21
Vs 202,202,21
Vs 203,203,21
Vs 204,204,21
Vs 205,205,21
Vs 206,206,21
Vs 207,207,21
Vs 128,128,21
Vs 129,129,21
Vs 130,130,21
Vs 131,131,21
Vs 132,132,21
Vs 133,133,21
Vs 134,134,21
Vs 135,135,21
Vs 136,136,21
Vs 137,137,21
Vs 138,138,21
Vs 139,139,21
Vs 140,140,21
Vs 141,141,21
Vs 142,142,21
Vs 143,143,21
Vs 32,32,21
Vs 33,33,21
Vs 34,34,21
v_sub_f32_e64 v35, v35, v21
v_exp_f32 v22, -v21
s_nop 0
Vm 48,48,22
Vm 49,49,22
Vm 50,50,22
v_mul_f32_e64 v51, v51, v22
Ar 8,0
Ar 9,1
Ar 10,2
Ar 11,3
Ar 12,4
Ar 13,5
Ar 14,6
Ar 15,7
Vm 8,8,22
Vm 9,9,22
Vm 10,10,22
Vm 11,11,22
Vm 12,12,22
Vm 13,13,22
Vm 14,14,22
Vm 15,15,22
Aw 0,8
Aw 1,9
Aw 2,10
Aw 3,11
Aw 4,12
Aw 5,13
Aw 6,14
Aw 7,15
Ar 8,8
Ar 9,9
Ar 10,10
Ar 11,11
Ar 12,12
Ar 13,13
Ar 14,14
Ar 15,15
Vm 8,8,22
Vm 9,9,22
Vm 10,10,22
Vm 11,11,22
Vm 12,12,22
Vm 13,13,22
Vm 14,14,22
Vm 15,15,22
Aw 8,8
Aw 9,9
Aw 10,10
Aw 11,11
Aw 12,12
Aw 13,13
Aw 14,14
Aw 15,15
Ar 8,16
Ar 9,17
Ar 10,18
Ar 11,19
Ar 12,20
Ar 13,21
Ar 14,22
Ar 15,23
Vm 8,8,22
Vm 9,9,22
Vm 10,10,22
Vm 11,11,22
Vm 12,12,22
Vm 13,13,22
Vm 14,14,22
Vm 15,15,22
Aw 16,8
Aw 17,9
Aw 18,10
Aw 19,11
Aw 20,12
Aw 21,13
Aw 22,14
Aw 23,15
Ar 8,24
Ar 9,25
Ar 10,26
Ar 11,27
Ar 12,28
Ar 13,29
Ar 14,30
Ar 15,31
Vm 8,8,22
Vm 9,9,22
Vm 10,10,22
Vm 11,11,22
Vm 12,12,22
Vm 13,13,22
Vm 14,14,22
Vm 15,15,22
Aw 24,8
Aw 25,9
Aw 26,10
Aw 27,11
Aw 28,12
Aw 29,13
Aw 30,14
Aw 31,15
v_max3_f32 v21, v208, v209, v210
v_max3_f32 v21, v21, v211, v212
v_max3_f32 v21, v21, v213, v214
v_max3_f32 v21, v21, v215, v216
v_max3_f32 v21, v21, v217, v218
v_max3_f32 v21, v21, v219, v220
v_max3_f32 v21, v21, v221, v222
v_max_f32 v21, v21, v223
v_mov_b32 v1, v21
s_nop 1
v_permlane16_swap_b32 v1, v21
v_max_f32 v21, v21, v1
v_mov_b32 v1, v21
s_nop 1
v_permlane32_swap_b32 v1, v21
v_max_f32_e64 v21, v21, v1
v_add_f32 v21, 0x41f80000, v21
v_max_f32 v21, 0, v21
Vs 208,208,21
Vs 209,209,21
Vs 210,210,21
Vs 211,211,21
Vs 212,212,21
Vs 213,213,21
Vs 214,214,21
Vs 215,215,21
Vs 216,216,21
Vs 217,217,21
Vs 218,218,21
Vs 219,219,21
Vs 220,220,21
Vs 221,221,21
Vs 222,222,21
Vs 223,223,21
Vs 144,144,21
Vs 145,145,21
Vs 146,146,21
Vs 147,147,21
Vs 148,148,21
Vs 149,149,21
Vs 150,150,21
Vs 151,151,21
Vs 152,152,21
Vs 153,153,21
Vs 154,154,21
Vs 155,155,21
Vs 156,156,21
Vs 157,157,21
Vs 158,158,21
Vs 159,159,21
Vs 36,36,21
Vs 37,37,21
Vs 38,38,21
v_sub_f32_e64 v39, v39, v21
v_exp_f32 v22, -v21
s_nop 0
Vm 52,52,22
Vm 53,53,22
Vm 54,54,22
v_mul_f32_e64 v55, v55, v22
Ar 8,32
Ar 9,33
Ar 10,34
Ar 11,35
Ar 12,36
Ar 13,37
Ar 14,38
Ar 15,39
Vm 8,8,22
Vm 9,9,22
Vm 10,10,22
Vm 11,11,22
Vm 12,12,22
Vm 13,13,22
Vm 14,14,22
Vm 15,15,22
Aw 32,8
Aw 33,9
Aw 34,10
Aw 35,11
Aw 36,12
Aw 37,13
Aw 38,14
Aw 39,15
Ar 8,40
Ar 9,41
Ar 10,42
Ar 11,43
Ar 12,44
Ar 13,45
Ar 14,46
Ar 15,47
Vm 8,8,22
Vm 9,9,22
Vm 10,10,22
Vm 11,11,22
Vm 12,12,22
Vm 13,13,22
Vm 14,14,22
Vm 15,15,22
Aw 40,8
Aw 41,9
Aw 42,10
Aw 43,11
Aw 44,12
Aw 45,13
Aw 46,14
Aw 47,15
Ar 8,48
Ar 9,49
Ar 10,50
Ar 11,51
Ar 12,52
Ar 13,53
Ar 14,54
Ar 15,55
Vm 8,8,22
Vm 9,9,22
Vm 10,10,22
Vm 11,11,22
Vm 12,12,22
Vm 13,13,22
Vm 14,14,22
Vm 15,15,22
Aw 48,8
Aw 49,9
Aw 50,10
Aw 51,11
Aw 52,12
Aw 53,13
Aw 54,14
Aw 55,15
Ar 8,56
Ar 9,57
Ar 10,58
Ar 11,59
Ar 12,60
Ar 13,61
Ar 14,62
Ar 15,63
Vm 8,8,22
Vm 9,9,22
Vm 10,10,22
Vm 11,11,22
Vm 12,12,22
Vm 13,13,22
Vm 14,14,22
Vm 15,15,22
Aw 56,8
Aw 57,9
Aw 58,10
Aw 59,11
Aw 60,12
Aw 61,13
Aw 62,14
Aw 63,15
Ve 8,192
Ve 9,193
s_nop 0
Vc 96,8,9
Ve 8,194
Ve 9,195
s_nop 0
Vc 97,8,9
Ve 8,208
Ve 9,209
s_nop 0
Vc 104,8,9
Ve 8,210
Ve 9,211
s_nop 0
Vc 105,8,9
Ve 8,196
Ve 9,197
s_nop 0
Vc 98,8,9
Ve 8,198
Ve 9,199
s_nop 0
Vc 99,8,9
Ve 8,212
Ve 9,213
s_nop 0
Vc 106,8,9
Ve 8,214
Ve 9,215
s_nop 0
Vc 107,8,9
Ve 8,200
Ve 9,201
s_nop 0
Vc 100,8,9
Ve 8,202
Ve 9,203
s_nop 0
Vc 101,8,9
Ve 8,216
Ve 9,217
s_nop 0
Vc 108,8,9
Ve 8,218
Ve 9,219
s_nop 0
Vc 109,8,9
Ve 8,204
Ve 9,205
s_nop 0
Vc 102,8,9
Ve 8,206
Ve 9,207
s_nop 0
Vc 103,8,9
Ve 8,220
Ve 9,221
s_nop 0
Vc 110,8,9
Ve 8,222
Ve 9,223
s_nop 0
Vc 111,8,9
s_nop 1
s_branch L_k2_fbr_no
L_k2_fb_nl:
s_nop 7
s_nop 0
v_max3_f32 v21, v128, v129, v130
v_max3_f32 v21, v21, v131, v132
v_max3_f32 v21, v21, v133, v134
v_max3_f32 v21, v21, v135, v136
v_max3_f32 v21, v21, v137, v138
v_max3_f32 v21, v21, v139, v140
v_max3_f32 v21, v21, v141, v142
v_max_f32 v21, v21, v143
v_mov_b32 v1, v21
s_nop 1
v_permlane16_swap_b32 v1, v21
v_max_f32 v21, v21, v1
v_mov_b32 v1, v21
s_nop 1
v_permlane32_swap_b32 v1, v21
v_max_f32_e64 v21, v21, v1
v_add_f32 v21, 0x41f80000, v21
v_max_f32 v21, 0, v21
Vs 128,128,21
Vs 129,129,21
Vs 130,130,21
Vs 131,131,21
Vs 132,132,21
Vs 133,133,21
Vs 134,134,21
Vs 135,135,21
Vs 136,136,21
Vs 137,137,21
Vs 138,138,21
Vs 139,139,21
Vs 140,140,21
Vs 141,141,21
Vs 142,142,21
Vs 143,143,21
Vs 192,192,21
Vs 193,193,21
Vs 194,194,21
Vs 195,195,21
Vs 196,196,21
Vs 197,197,21
Vs 198,198,21
Vs 199,199,21
Vs 200,200,21
Vs 201,201,21
Vs 202,202,21
Vs 203,203,21
Vs 204,204,21
Vs 205,205,21
Vs 206,206,21
Vs 207,207,21
Vs 32,32,21
Vs 33,33,21
Vs 34,34,21
v_sub_f32_e64 v35, v35, v21
v_exp_f32 v22, -v21
s_nop 0
Vm 48,48,22
Vm 49,49,22
Vm 50,50,22
v_mul_f32_e64 v51, v51, v22
Ar 8,0
Ar 9,1
Ar 10,2
Ar 11,3
Ar 12,4
Ar 13,5
Ar 14,6
Ar 15,7
Vm 8,8,22
Vm 9,9,22
Vm 10,10,22
Vm 11,11,22
Vm 12,12,22
Vm 13,13,22
Vm 14,14,22
Vm 15,15,22
Aw 0,8
Aw 1,9
Aw 2,10
Aw 3,11
Aw 4,12
Aw 5,13
Aw 6,14
Aw 7,15
Ar 8,8
Ar 9,9
Ar 10,10
Ar 11,11
Ar 12,12
Ar 13,13
Ar 14,14
Ar 15,15
Vm 8,8,22
Vm 9,9,22
Vm 10,10,22
Vm 11,11,22
Vm 12,12,22
Vm 13,13,22
Vm 14,14,22
Vm 15,15,22
Aw 8,8
Aw 9,9
Aw 10,10
Aw 11,11
Aw 12,12
Aw 13,13
Aw 14,14
Aw 15,15
Ar 8,16
Ar 9,17
Ar 10,18
Ar 11,19
Ar 12,20
Ar 13,21
Ar 14,22
Ar 15,23
Vm 8,8,22
Vm 9,9,22
Vm 10,10,22
Vm 11,11,22
Vm 12,12,22
Vm 13,13,22
Vm 14,14,22
Vm 15,15,22
Aw 16,8
Aw 17,9
Aw 18,10
Aw 19,11
Aw 20,12
Aw 21,13
Aw 22,14
Aw 23,15
Ar 8,24
Ar 9,25
Ar 10,26
Ar 11,27
Ar 12,28
Ar 13,29
Ar 14,30
Ar 15,31
Vm 8,8,22
Vm 9,9,22
Vm 10,10,22
Vm 11,11,22
Vm 12,12,22
Vm 13,13,22
Vm 14,14,22
Vm 15,15,22
Aw 24,8
Aw 25,9
Aw 26,10
Aw 27,11
Aw 28,12
Aw 29,13
Aw 30,14
Aw 31,15
v_max3_f32 v21, v144, v145, v146
v_max3_f32 v21, v21, v147, v148
v_max3_f32 v21, v21, v149, v150
v_max3_f32 v21, v21, v151, v152
v_max3_f32 v21, v21, v153, v154
v_max3_f32 v21, v21, v155, v156
v_max3_f32 v21, v21, v157, v158
v_max_f32 v21, v21, v159
v_mov_b32 v1, v21
s_nop 1
v_permlane16_swap_b32 v1, v21
v_max_f32 v21, v21, v1
v_mov_b32 v1, v21
s_nop 1
v_permlane32_swap_b32 v1, v21
v_max_f32_e64 v21, v21, v1
v_add_f32 v21, 0x41f80000, v21
v_max_f32 v21, 0, v21
Vs 144,144,21
Vs 145,145,21
Vs 146,146,21
Vs 147,147,21
Vs 148,148,21
Vs 149,149,21
Vs 150,150,21
Vs 151,151,21
Vs 152,152,21
Vs 153,153,21
Vs 154,154,21
Vs 155,155,21
Vs 156,156,21
Vs 157,157,21
Vs 158,158,21
Vs 159,159,21
Vs 36,36,21
Vs 37,37,21
Vs 38,38,21
v_sub_f32_e64 v39, v39, v21
v_exp_f32 v22, -v21
s_nop 0
Vm 52,52,22
Vm 53,53,22
Vm 54,54,22
v_mul_f32_e64 v55, v55, v22
Ar 8,32
Ar 9,33
Ar 10,34
Ar 11,35
Ar 12,36
Ar 13,37
Ar 14,38
Ar 15,39
Vm 8,8,22
Vm 9,9,22
Vm 10,10,22
Vm 11,11,22
Vm 12,12,22
Vm 13,13,22
Vm 14,14,22
Vm 15,15,22
Aw 32,8
Aw 33,9
Aw 34,10
Aw 35,11
Aw 36,12
Aw 37,13
Aw 38,14
Aw 39,15
Ar 8,40
Ar 9,41
Ar 10,42
Ar 11,43
Ar 12,44
Ar 13,45
Ar 14,46
Ar 15,47
Vm 8,8,22
Vm 9,9,22
Vm 10,10,22
Vm 11,11,22
Vm 12,12,22
Vm 13,13,22
Vm 14,14,22
Vm 15,15,22
Aw 40,8
Aw 41,9
Aw 42,10
Aw 43,11
Aw 44,12
Aw 45,13
Aw 46,14
Aw 47,15
Ar 8,48
Ar 9,49
Ar 10,50
Ar 11,51
Ar 12,52
Ar 13,53
Ar 14,54
Ar 15,55
Vm 8,8,22
Vm 9,9,22
Vm 10,10,22
Vm 11,11,22
Vm 12,12,22
Vm 13,13,22
Vm 14,14,22
Vm 15,15,22
Aw 48,8
Aw 49,9
Aw 50,10
Aw 51,11
Aw 52,12
Aw 53,13
Aw 54,14
Aw 55,15
Ar 8,56
Ar 9,57
Ar 10,58
Ar 11,59
Ar 12,60
Ar 13,61
Ar 14,62
Ar 15,63
Vm 8,8,22
Vm 9,9,22
Vm 10,10,22
Vm 11,11,22
Vm 12,12,22
Vm 13,13,22
Vm 14,14,22
Vm 15,15,22
Aw 56,8
Aw 57,9
Aw 58,10
Aw 59,11
Aw 60,12
Aw 61,13
Aw 62,14
Aw 63,15
Ve 8,128
Ve 9,129
s_nop 0
Vc 64,8,9
Ve 8,130
Ve 9,131
s_nop 0
Vc 65,8,9
Ve 8,144
Ve 9,145
s_nop 0
Vc 72,8,9
Ve 8,146
Ve 9,147
s_nop 0
Vc 73,8,9
Ve 8,132
Ve 9,133
s_nop 0
Vc 66,8,9
Ve 8,134
Ve 9,135
s_nop 0
Vc 67,8,9
Ve 8,148
Ve 9,149
s_nop 0
Vc 74,8,9
Ve 8,150
Ve 9,151
s_nop 0
Vc 75,8,9
Ve 8,136
Ve 9,137
s_nop 0
Vc 68,8,9
Ve 8,138
Ve 9,139
s_nop 0
Vc 69,8,9
Ve 8,152
Ve 9,153
s_nop 0
Vc 76,8,9
Ve 8,154
Ve 9,155
s_nop 0
Vc 77,8,9
Ve 8,140
Ve 9,141
s_nop 0
Vc 70,8,9
Ve 8,142
Ve 9,143
s_nop 0
Vc 71,8,9
Ve 8,156
Ve 9,157
s_nop 0
Vc 78,8,9
Ve 8,158
Ve 9,159
s_nop 0
Vc 79,8,9
s_nop 1
s_branch L_k2_fbr_nl
L_k2_fb_fi:
s_nop 7
s_nop 0
v_max3_f32 v21, v192, v193, v194
v_max3_f32 v21, v21, v195, v196
v_max3_f32 v21, v21, v197, v198
v_max3_f32 v21, v21, v199, v200
v_max3_f32 v21, v21, v201, v202
v_max3_f32 v21, v21, v203, v204
v_max3_f32 v21, v21, v205, v206
v_max_f32 v21, v21, v207
v_mov_b32 v1, v21
s_nop 1
v_permlane16_swap_b32 v1, v21
v_max_f32 v21, v21, v1
v_mov_b32 v1, v21
s_nop 1
v_permlane32_swap_b32 v1, v21
v_max_f32_e64 v21, v21, v1
v_add_f32 v21, 0x41f80000, v21
v_max_f32 v21, 0, v21
Vs 192,192,21
Vs 193,193,21
Vs 194,194,21
Vs 195,195,21
Vs 196,196,21
Vs 197,197,21
Vs 198,198,21
Vs 199,199,21
Vs 200,200,21
Vs 201,201,21
Vs 202,202,21
Vs 203,203,21
Vs 204,204,21
Vs 205,205,21
Vs 206,206,21
Vs 207,207,21
Vs 32,32,21
Vs 33,33,21
Vs 34,34,21
v_sub_f32_e64 v35, v35, v21
v_exp_f32 v22, -v21
s_nop 0
Vm 48,48,22
Vm 49,49,22
Vm 50,50,22
v_mul_f32_e64 v51, v51, v22
Ar 8,0
Ar 9,1
Ar 10,2
Ar 11,3
Ar 12,4
Ar 13,5
Ar 14,6
Ar 15,7
Vm 8,8,22
Vm 9,9,22
Vm 10,10,22
Vm 11,11,22
Vm 12,12,22
Vm 13,13,22
Vm 14,14,22
Vm 15,15,22
Aw 0,8
Aw 1,9
Aw 2,10
Aw 3,11
Aw 4,12
Aw 5,13
Aw 6,14
Aw 7,15
Ar 8,8
Ar 9,9
Ar 10,10
Ar 11,11
Ar 12,12
Ar 13,13
Ar 14,14
Ar 15,15
Vm 8,8,22
Vm 9,9,22
Vm 10,10,22
Vm 11,11,22
Vm 12,12,22
Vm 13,13,22
Vm 14,14,22
Vm 15,15,22
Aw 8,8
Aw 9,9
Aw 10,10
Aw 11,11
Aw 12,12
Aw 13,13
Aw 14,14
Aw 15,15
Ar 8,16
Ar 9,17
Ar 10,18
Ar 11,19
Ar 12,20
Ar 13,21
Ar 14,22
Ar 15,23
Vm 8,8,22
Vm 9,9,22
Vm 10,10,22
Vm 11,11,22
Vm 12,12,22
Vm 13,13,22
Vm 14,14,22
Vm 15,15,22
Aw 16,8
Aw 17,9
Aw 18,10
Aw 19,11
Aw 20,12
Aw 21,13
Aw 22,14
Aw 23,15
Ar 8,24
Ar 9,25
Ar 10,26
Ar 11,27
Ar 12,28
Ar 13,29
Ar 14,30
Ar 15,31
Vm 8,8,22
Vm 9,9,22
Vm 10,10,22
Vm 11,11,22
Vm 12,12,22
Vm 13,13,22
Vm 14,14,22
Vm 15,15,22
Aw 24,8
Aw 25,9
Aw 26,10
Aw 27,11
Aw 28,12
Aw 29,13
Aw 30,14
Aw 31,15
Ve 8,192
Ve 9,193
s_nop 0
Vc 96,8,9
Ve 8,194
Ve 9,195
s_nop 0
Vc 97,8,9
Ve 8,196
Ve 9,197
s_nop 0
Vc 98,8,9
Ve 8,198
Ve 9,199
s_nop 0
Vc 99,8,9
Ve 8,200
Ve 9,201
s_nop 0
Vc 100,8,9
Ve 8,202
Ve 9,203
s_nop 0
Vc 101,8,9
Ve 8,204
Ve 9,205
s_nop 0
Vc 102,8,9
Ve 8,206
Ve 9,207
s_nop 0
Vc 103,8,9
s_nop 1
s_branch L_k2_fbr_fi
L_spinX:
s_mov_b32 s47, 0x400000
L_spinXl:
buffer_load_dword v17, v126, s[20:23], s24 offen sc1
s_sub_u32 s47, s47, 1
s_waitcnt vmcnt(0)
s_cmp_eq_u32 s47, 0
s_cbranch_scc1 L_spinXlx
v_cmp_ne_u32 vcc, 1, v17
s_cbranch_vccz L_spinXlx
s_sleep 1
s_branch L_spinXl
L_spinXlx:
buffer_load_dwordx4 v[160:163], v112, s[16:19], s25 offen offset:0 sc1
buffer_load_dwordx4 v[164:167], v112, s[16:19], s25 offen offset:1024 sc1
buffer_load_dwordx4 v[168:171], v112, s[16:19], s25 offen offset:2048 sc1
buffer_load_dwordx4 v[172:175], v112, s[16:19], s25 offen offset:3072 sc1
buffer_load_dwordx4 v[176:179], v10, s[16:19], s25 offen offset:0 sc1
buffer_load_dwordx4 v[180:183], v10, s[16:19], s25 offen offset:1024 sc1
buffer_load_dwordx4 v[184:187], v10, s[16:19], s25 offen offset:2048 sc1
buffer_load_dwordx4 v[188:191], v10, s[16:19], s25 offen offset:3072 sc1
s_branch L_spinXr
L_ysl:
s_mov_b32 s47, 0x400000
L_ysll:
buffer_load_dword v124, v127, s[20:23], s41 offen sc1
s_sub_u32 s47, s47, 1
s_waitcnt vmcnt(0)
s_cmp_eq_u32 s47, 0
s_cbranch_scc1 L_ysllx
v_cmp_ne_u32 vcc, 1, v124
s_cbranch_vccz L_ysllx
s_sleep 8
s_branch L_ysll
L_ysllx:
v_lshlrev_b32 v124, 2, v0
v_lshlrev_b32 v125, 1, v0
s_lshl_b32 s7, s45, 2
s_add_u32 s7, s7, s32
s_lshr_b32 s3, s42, 5
s_cmp_lg_u32 s3, s7
s_cbranch_scc1 L_f_yl13
s_add_u32 s3, s55, 0
s_nop 0
s_add_u32 s7, s3, 4096
buffer_load_dword v76, v124, s[20:23], s3 offen offset:0 sc1
buffer_load_dword v77, v124, s[20:23], s3 offen offset:512 sc1
buffer_load_dword v78, v124, s[20:23], s3 offen offset:1024 sc1
buffer_load_dword v79, v124, s[20:23], s3 offen offset:1536 sc1
buffer_load_dword v80, v124, s[20:23], s3 offen offset:2048 sc1
buffer_load_dword v81, v124, s[20:23], s3 offen offset:2560 sc1
buffer_load_dword v82, v124, s[20:23], s3 offen offset:3072 sc1
buffer_load_dword v83, v124, s[20:23], s3 offen offset:3584 sc1
buffer_load_dword v84, v124, s[20:23], s7 offen offset:0 sc1
buffer_load_dword v85, v124, s[20:23], s7 offen offset:512 sc1
buffer_load_dword v86, v124, s[20:23], s7 offen offset:1024 sc1
buffer_load_dword v87, v124, s[20:23], s7 offen offset:1536 sc1
buffer_load_dword v88, v124, s[20:23], s7 offen offset:2048 sc1
buffer_load_dword v89, v124, s[20:23], s7 offen offset:2560 sc1
s_lshl_b32 s3, s42, 11
s_lshl_b32 s7, s46, 7
s_add_u32 s3, s3, s7
buffer_load_ushort v90, v125, s[56:59], s3 offen
s_lshl_b32 s3, s42, 3
s_add_u32 s3, s3, 5259264
buffer_load_dwordx2 v[92:93], v126, s[20:23], s3 offen sc1
L_f_yl13:
s_lshl_b32 s7, s45, 2
s_add_u32 s7, s7, s32
s_lshr_b32 s3, s43, 5
s_cmp_lg_u32 s3, s7
s_cbranch_scc1 L_f_yl14
s_nop 0
s_add_u32 s3, s55, 256
s_add_u32 s7, s3, 4096
buffer_load_dword v94, v124, s[20:23], s3 offen offset:0 sc1
buffer_load_dword v95, v124, s[20:23], s3 offen offset:512 sc1
buffer_load_dword v96, v124, s[20:23], s3 offen offset:1024 sc1
buffer_load_dword v97, v124, s[20:23], s3 offen offset:1536 sc1
buffer_load_dword v98, v124, s[20:23], s3 offen offset:2048 sc1
buffer_load_dword v99, v124, s[20:23], s3 offen offset:2560 sc1
buffer_load_dword v100, v124, s[20:23], s3 offen offset:3072 sc1
buffer_load_dword v101, v124, s[20:23], s3 offen offset:3584 sc1
buffer_load_dword v102, v124, s[20:23], s7 offen offset:0 sc1
buffer_load_dword v103, v124, s[20:23], s7 offen offset:512 sc1
buffer_load_dword v104, v124, s[20:23], s7 offen offset:1024 sc1
buffer_load_dword v105, v124, s[20:23], s7 offen offset:1536 sc1
buffer_load_dword v106, v124, s[20:23], s7 offen offset:2048 sc1
buffer_load_dword v107, v124, s[20:23], s7 offen offset:2560 sc1
s_lshl_b32 s3, s43, 11
s_lshl_b32 s7, s46, 7
s_add_u32 s3, s3, s7
buffer_load_ushort v108, v125, s[56:59], s3 offen
s_lshl_b32 s3, s43, 3
s_add_u32 s3, s3, 5259264
buffer_load_dwordx2 v[110:111], v126, s[20:23], s3 offen sc1
L_f_yl14:
s_waitcnt vmcnt(0)
s_lshl_b32 s7, s45, 2
s_add_u32 s7, s7, s32
s_lshr_b32 s3, s42, 5
s_cmp_lg_u32 s3, s7
s_cbranch_scc1 L_f_ys15
v_pk_add_f32 v[76:77], v[76:77], v[78:79]
v_pk_add_f32 v[76:77], v[76:77], v[80:81]
v_pk_add_f32 v[76:77], v[76:77], v[82:83]
v_pk_add_f32 v[76:77], v[76:77], v[84:85]
v_pk_add_f32 v[76:77], v[76:77], v[86:87]
v_pk_add_f32 v[76:77], v[76:77], v[88:89]
Va 76,76,77
v_lshlrev_b32 v90, 16, v90
v_sub_f32_e64 v90, v90, v92
Vc 76,76,76
v_lshlrev_b32_e64 v76, 16, v76
Vc 90,90,90
v_lshlrev_b32 v90, 16, v90
v_mul_f32 v76, s100, v76
v_mul_f32_e64 v90, v90, v93
Vc 76,76,76
v_lshlrev_b32_e64 v76, 16, v76
Vc 90,90,90
v_lshlrev_b32 v90, 16, v90
Va 90,90,76
Vc 90,90,90
v_lshlrev_b32_e64 v90, 16, v90
v_mul_f32 v76, 0xbfb8aa3b, v90
Ve 76,76
s_nop 0
v_add_f32 v76, 1.0, v76
v_rcp_f32 v76, v76
s_nop 0
Vm 90,90,76
Vc 90,90,90
v_lshlrev_b32 v90, 16, v90
v_lshlrev_b32 v124, 2, v0
v_add_u32 v124, s35, v124
v_lshlrev_b32 v125, 5, v122
v_add_u32 v125, s35, v125
s_waitcnt lgkmcnt(0)
ds_write_b32 v124, v90
s_and_b32 s3, s42, 7
s_lshl_b32 s3, s3, 3
s_lshl_b64 s[4:5], 0xff, s3
s_bfe_u32 s3, s42, 0x20003
s_mov_b64 exec, s[4:5]
s_cmp_lg_u32 s3, 0
s_cbranch_scc1 L_f_yp16
ds_read_b64 v[42:43], v125
ds_read_b64 v[44:45], v125 offset:8
ds_read_b64 v[46:47], v125 offset:16
ds_read_b64 v[48:49], v125 offset:24
L_f_yp16:
s_cmp_lg_u32 s3, 1
s_cbranch_scc1 L_f_yp17
ds_read_b64 v[50:51], v125
ds_read_b64 v[52:53], v125 offset:8
ds_read_b64 v[54:55], v125 offset:16
ds_read_b64 v[56:57], v125 offset:24
L_f_yp17:
s_cmp_lg_u32 s3, 2
s_cbranch_scc1 L_f_yp18
ds_read_b64 v[58:59], v125
ds_read_b64 v[60:61], v125 offset:8
ds_read_b64 v[62:63], v125 offset:16
ds_read_b64 v[64:65], v125 offset:24
L_f_yp18:
s_cmp_lg_u32 s3, 3
s_cbranch_scc1 L_f_yp19
ds_read_b64 v[66:67], v125
ds_read_b64 v[68:69], v125 offset:8
s_waitcnt lgkmcnt(9)
ds_read_b64 v[70:71], v125 offset:16
ds_read_b64 v[72:73], v125 offset:24
L_f_yp19:
s_mov_b64 exec, -1
s_waitcnt lgkmcnt(0)
L_f_ys15:
s_lshl_b32 s7, s45, 2
s_add_u32 s7, s7, s32
s_lshr_b32 s3, s43, 5
s_cmp_lg_u32 s3, s7
s_cbranch_scc1 L_f_ys20
s_nop 0
v_pk_add_f32 v[94:95], v[94:95], v[96:97]
v_pk_add_f32 v[94:95], v[94:95], v[98:99]
v_pk_add_f32 v[94:95], v[94:95], v[100:101]
v_pk_add_f32 v[94:95], v[94:95], v[102:103]
v_pk_add_f32 v[94:95], v[94:95], v[104:105]
v_pk_add_f32 v[94:95], v[94:95], v[106:107]
Va 94,94,95
v_lshlrev_b32 v108, 16, v108
v_sub_f32_e64 v108, v108, v110
Vc 94,94,94
v_lshlrev_b32_e64 v94, 16, v94
Vc 108,108,108
v_lshlrev_b32 v108, 16, v108
v_mul_f32 v94, s101, v94
v_mul_f32_e64 v108, v108, v111
Vc 94,94,94
v_lshlrev_b32_e64 v94, 16, v94
Vc 108,108,108
v_lshlrev_b32 v108, 16, v108
Va 108,108,94
Vc 108,108,108
v_lshlrev_b32_e64 v108, 16, v108
v_mul_f32 v94, 0xbfb8aa3b, v108
Ve 94,94
s_nop 0
v_add_f32 v94, 1.0, v94
v_rcp_f32 v94, v94
s_nop 0
Vm 108,108,94
Vc 108,108,108
v_lshlrev_b32 v108, 16, v108
v_lshlrev_b32 v124, 2, v0
v_add_u32 v124, s35, v124
v_lshlrev_b32 v125, 5, v122
v_add_u32 v125, s35, v125
s_waitcnt lgkmcnt(0)
ds_write_b32 v124, v108
s_and_b32 s3, s43, 7
s_lshl_b32 s3, s3, 3
s_lshl_b64 s[4:5], 0xff, s3
s_bfe_u32 s3, s43, 0x20003
s_mov_b64 exec, s[4:5]
s_cmp_lg_u32 s3, 0
s_cbranch_scc1 L_f_yp21
ds_read_b64 v[42:43], v125
ds_read_b64 v[44:45], v125 offset:8
ds_read_b64 v[46:47], v125 offset:16
ds_read_b64 v[48:49], v125 offset:24
L_f_yp21:
s_cmp_lg_u32 s3, 1
s_cbranch_scc1 L_f_yp22
ds_read_b64 v[50:51], v125
ds_read_b64 v[52:53], v125 offset:8
ds_read_b64 v[54:55], v125 offset:16
ds_read_b64 v[56:57], v125 offset:24
L_f_yp22:
s_cmp_lg_u32 s3, 2
s_cbranch_scc1 L_f_yp23
ds_read_b64 v[58:59], v125
ds_read_b64 v[60:61], v125 offset:8
ds_read_b64 v[62:63], v125 offset:16
ds_read_b64 v[64:65], v125 offset:24
L_f_yp23:
s_cmp_lg_u32 s3, 3
s_cbranch_scc1 L_f_yp24
ds_read_b64 v[66:67], v125
ds_read_b64 v[68:69], v125 offset:8
s_waitcnt lgkmcnt(9)
ds_read_b64 v[70:71], v125 offset:16
ds_read_b64 v[72:73], v125 offset:24
L_f_yp24:
s_mov_b64 exec, -1
s_waitcnt lgkmcnt(0)
L_f_ys20:
s_branch L_yslr
.section .rodata,"a"
.p2align 6
.amdhsa_kernel recurrent_scan__compressed_kv_cla__moe_arch_mod__prompt_kernel
  .amdhsa_next_free_vgpr 512
  .amdhsa_next_free_sgpr 102
  .amdhsa_accum_offset 256
  .amdhsa_group_segment_fixed_size 0
  .amdhsa_kernarg_size 112
  .amdhsa_user_sgpr_count 2
  .amdhsa_user_sgpr_kernarg_segment_ptr 1
  .amdhsa_system_sgpr_workgroup_id_x 1
.end_amdhsa_kernel
```

```asm
; @launch grid=(256,1,1) block=(256,1,1) lds=163840
.amdgcn_target "amdgcn-amd-amdhsa--gfx950"
.macro Va d,x,y
v_add_f32 v\d, v\x, v\y
.endm
.macro Vc d,x,y
v_cvt_pk_bf16_f32 v\d, v\x, v\y
.endm
.macro Ra d,x,o
ds_read_b128 a[\d:\d+3], v\x offset:\o
.endm
.macro Ta d,x,o
ds_read_b64_tr_b16 a[\d:\d+1], v\x offset:\o
.endm
.macro Zvaa d,x,y
v_mfma_f32_16x16x32_bf16 v[\d:\d+3], a[\x:\x+3], a[\y:\y+3], 0
.endm
.macro Mvaa d,x,y
v_mfma_f32_16x16x32_bf16 v[\d:\d+3], a[\x:\x+3], a[\y:\y+3], v[\d:\d+3]
.endm
.macro Rv d,x,o
ds_read_b128 v[\d:\d+3], v\x offset:\o
.endm
.macro Zaaa d,x,y
v_mfma_f32_16x16x32_bf16 a[\d:\d+3], a[\x:\x+3], a[\y:\y+3], 0
.endm
.macro Maaa d,x,y
v_mfma_f32_16x16x32_bf16 a[\d:\d+3], a[\x:\x+3], a[\y:\y+3], a[\d:\d+3]
.endm
.macro Ar d,x
v_accvgpr_read_b32 v\d, a\x
.endm
.macro Ve d,x
v_exp_f32 v\d, v\x
.endm
.macro Aw d,x
v_accvgpr_write_b32 a\d, v\x
.endm
.macro Vs d,x,y
v_sub_f32 v\d, v\x, v\y
.endm
.macro Cvaa d,x,y,c
v_mfma_f32_16x16x32_bf16 v[\d:\d+3], a[\x:\x+3], a[\y:\y+3], v[\c:\c+3]
.endm
.macro VE d,x
v_exp_f32_e64 v\d, v\x
.endm
.macro Maav d,x,y
v_mfma_f32_16x16x32_bf16 a[\d:\d+3], a[\x:\x+3], v[\y:\y+3], a[\d:\d+3]
.endm
.macro Mvvv d,x,y
v_mfma_f32_16x16x32_bf16 v[\d:\d+3], v[\x:\x+3], v[\y:\y+3], v[\d:\d+3]
.endm
.macro Zvva d,x,y
v_mfma_f32_16x16x32_bf16 v[\d:\d+3], v[\x:\x+3], a[\y:\y+3], 0
.endm
.macro Mvva d,x,y
v_mfma_f32_16x16x32_bf16 v[\d:\d+3], v[\x:\x+3], a[\y:\y+3], v[\d:\d+3]
.endm
.macro Vm d,x,y
v_mul_f32 v\d, v\x, v\y
.endm
.macro Zvvv d,x,y
v_mfma_f32_16x16x32_bf16 v[\d:\d+3], v[\x:\x+3], v[\y:\y+3], 0
.endm
.text
.globl recurrent_scan__compressed_kv_cla__moe_arch_mod__prompt_kernel
.p2align 8
.type recurrent_scan__compressed_kv_cla__moe_arch_mod__prompt_kernel,@function
recurrent_scan__compressed_kv_cla__moe_arch_mod__prompt_kernel:
s_cmp_ge_u32 s2, 256
s_cbranch_scc1 L_k2_end
s_load_dwordx4 s[4:7], s[0:1], 0
s_load_dwordx2 s[44:45], s[0:1], 56
s_load_dwordx4 s[40:43], s[0:1], 24
s_load_dwordx4 s[64:67], s[0:1], 96
v_lshrrev_b32 v1, 6, v0
v_and_b32 v0, 63, v0
v_readfirstlane_b32 s32, v1
s_getpc_b64 s[68:69]
L_cpf1:
s_add_u32 s68, s68, (recurrent_scan__compressed_kv_cla__moe_arch_mod__prompt_kernel-L_cpf1)&0xffffffff
s_addc_u32 s69, s69, ((recurrent_scan__compressed_kv_cla__moe_arch_mod__prompt_kernel-L_cpf1)>>32)&0xffffffff
s_lshr_b32 s70, s2, 3
s_lshl_b32 s70, s70, 2
s_add_u32 s70, s70, s32
s_lshl_b32 s70, s70, 10
v_and_b32 v122, 7, v0
v_lshlrev_b32 v122, 7, v122
v_add_u32 v122, s70, v122
v_min_u32 v122, L_k2_fin-recurrent_scan__compressed_kv_cla__moe_arch_mod__prompt_kernel-4, v122
v_mov_b32 v121, s69
v_add_co_u32 v120, vcc, s68, v122
s_nop 1
v_addc_co_u32 v121, vcc, 0, v121, vcc
global_load_dword v124, v[120:121], off
v_lshrrev_b32 v33, 5, v0
v_and_b32 v31, 31, v0
v_lshlrev_b32_e64 v36, 4, v31
v_lshl_add_u32 v35, v33, 11, v36
s_lshl_b32 s36, s2, 14
s_lshl_b32 s37, s32, 12
s_add_u32 s36, s36, s37
s_mov_b32 s18, 4194304
s_mov_b32 s19, 0x20000
s_bfe_u32 s33, s2, 0x30003
s_lshr_b32 s35, s2, 7
s_bfe_u32 s3, s2, 0x10006
s_and_b32 s34, s2, 7
s_lshl_b32 s34, s34, 1
s_add_u32 s34, s34, s3
s_waitcnt lgkmcnt(0)
s_mov_b32 s16, s4
s_and_b32 s17, s5, 0xffff
buffer_load_dwordx4 v[48:51], v35, s[16:19], s36 offen offset:0
buffer_load_dwordx4 v[52:55], v35, s[16:19], s36 offen offset:512
buffer_load_dwordx4 v[56:59], v35, s[16:19], s36 offen offset:1024
buffer_load_dwordx4 v[60:63], v35, s[16:19], s36 offen offset:1536
s_cmp_eq_u32 s35, 0
s_cselect_b32 s40, s40, s42
s_cselect_b32 s41, s41, s43
s_lshl_b32 s3, s34, 9
s_add_u32 s12, s40, s3
s_addc_u32 s13, s41, 0
s_and_b32 s13, s13, 0xffff
s_mov_b32 s14, 0
s_mov_b32 s15, 0x20000
s_sub_u32 s14, 4194304, s3
s_lshl_b32 s3, s33, 18
s_add_u32 s8, s6, s3
s_addc_u32 s9, s7, 0
s_and_b32 s9, s9, 0xffff
s_mov_b32 s10, 262144
s_mov_b32 s11, 0x20000
s_and_b32 s58, s2, 7
s_mov_b32 s52, 0
s_mov_b32 s53, 15360
s_mov_b32 s54, 30720
s_mov_b32 s55, 46080
s_lshl_b32 s57, s32, 13
s_add_u32 s56, s57, 32768
s_lshl_b32 s3, s58, 2
s_add_u32 s3, s3, s32
s_lshl_b32 s3, s3, 4
v_add_u32 v30, s3, v33
v_lshlrev_b32 v30, 13, v30
v_lshlrev_b32 v34, 5, v33
v_xor_b32 v34, v34, v36
v_add_u32 v6, v34, v30
v_xor_b32_e64 v7, 64, v6
v_xor_b32 v8, 65664, v6
v_xor_b32 v9, 65728, v6
s_add_u32 m0, s57, 0
s_nop 0
buffer_load_dwordx4 v6, s[12:15], s52 offen offset:0 lds
buffer_load_dwordx4 v7, s[12:15], s53 offen offset:1024 lds
buffer_load_dwordx4 v6, s[12:15], s54 offen offset:2048 lds
buffer_load_dwordx4 v7, s[12:15], s55 offen offset:3072 lds
s_add_u32 m0, s57, 4096
s_nop 0
s_nop 0
buffer_load_dwordx4 v8, s[12:15], s52 offen offset:0 lds
buffer_load_dwordx4 v9, s[12:15], s53 offen offset:1024 lds
buffer_load_dwordx4 v8, s[12:15], s54 offen offset:2048 lds
buffer_load_dwordx4 v9, s[12:15], s55 offen offset:3072 lds
v_xor_b32 v6, 524288, v6
v_xor_b32 v7, 524288, v7
v_xor_b32 v8, 524288, v8
v_xor_b32 v9, 524288, v9
s_mov_b32 s48, 0
s_mov_b32 s49, 7168
s_mov_b32 s50, 14336
s_mov_b32 s51, 21504
v_lshrrev_b32 v30, 3, v0
v_lshlrev_b32 v30, 10, v30
s_lshl_b32 s3, s32, 16
s_lshl_b32 s39, s58, 7
s_add_u32 s3, s3, s39
v_and_b32 v31, 7, v0
v_lshrrev_b32 v32, 4, v0
v_xor_b32_e64 v31, v31, v32
v_lshl_add_u32 v30, v31, 4, v30
v_add_u32 v2, s3, v30
v_xor_b32 v3, 64, v2
v_xor_b32 v4, 32768, v2
v_xor_b32 v5, 32832, v2
s_cmp_lt_u32 s32, 2
s_cselect_b32 s60, s8, s12
s_cselect_b32 s61, s9, s13
s_cselect_b32 s62, s10, s14
s_mov_b32 s63, 0x20000
s_mov_b32 s59, 524288
s_cselect_b32 s59, 128, s59
s_cselect_b64 vcc, -1, 0
s_cselect_b32 s38, 32, 16
s_lshr_b32 s3, s2, 6
s_cmp_lt_u32 s32, 2
s_cselect_b32 s3, s3, s33
s_lshl_b32 s3, s3, 1
s_and_b32 s39, s32, 1
s_add_u32 s3, s3, s39
s_lshl_b32 s3, s3, 15
s_xor_b32 s39, s58, 2
s_mul_i32 s39, s39, s59
s_add_u32 s3, s3, s39
v_lshlrev_b32 v37, 10, v0
v_lshrrev_b32 v38, 2, v0
v_lshlrev_b32 v38, 13, v38
v_and_b32 v39, 3, v0
v_lshl_add_u32 v38, v39, 7, v38
v_cndmask_b32 v47, v38, v37, vcc
v_add_u32 v47, s3, v47
v_cmp_gt_u32 vcc, s38, v0
v_mov_b32 v37, 2146435072
s_nop 0
v_cndmask_b32 v47, v37, v47, vcc
s_mov_b32 s20, s66
s_and_b32 s21, s67, 0xffff
s_mov_b32 s22, 8388608
s_mov_b32 s23, 0x20000
s_add_u32 s24, s66, 8388608
s_addc_u32 s25, s67, 0
s_and_b32 s25, s25, 0xffff
s_mov_b32 s26, 35717120
s_mov_b32 s27, 0x20000
v_lshrrev_b32 v32, 4, v0
v_and_b32 v30, 15, v0
s_lshr_b32 s3, s32, 1
s_lshl_b32 s3, s3, 14
s_add_u32 s3, s3, 32768
v_lshlrev_b32 v31, 7, v30
v_add_u32 v31, s3, v31
v_lshrrev_b32 v34, 1, v30
v_xor_b32_e64 v34, v34, v32
v_lshl_add_u32 v10, v34, 4, v31
v_xor_b32 v11, 64, v10
v_lshrrev_b32 v30, 2, v30
v_lshl_add_u32 v31, v32, 3, v30
v_lshlrev_b32 v31, 9, v31
v_and_b32 v34, 3, v0
v_lshl_add_u32 v31, v34, 3, v31
s_and_b32 s3, s32, 1
s_lshl_b32 s3, s3, 8
v_add_u32 v31, s3, v31
v_and_b32 v34, 1, v32
v_lshl_add_u32 v30, v34, 2, v30
v_lshl_add_u32 v16, v30, 5, v31
v_xor_b32 v17, 32, v16
v_xor_b32 v18, 64, v16
v_xor_b32 v19, 96, v16
v_xor_b32 v20, 128, v16
v_xor_b32 v21, 160, v16
v_xor_b32 v22, 192, v16
v_xor_b32 v23, 224, v16
v_add_u32 v12, 65536, v10
v_add_u32 v13, 65536, v11
v_add_u32 v14, 65536, v16
v_add_u32 v15, 65536, v17
v_add_u32 v24, 65536, v18
v_add_u32 v25, 65536, v19
v_add_u32 v26, 65536, v20
v_add_u32 v27, 65536, v21
v_add_u32 v28, 65536, v22
v_add_u32 v29, 65536, v23
s_mov_b32 s28, s44
s_nop 0
s_and_b32 s29, s45, 0xffff
s_mov_b32 s30, 2048
s_mov_b32 s31, 0x20000
buffer_load_dwordx4 v[64:67], v36, s[28:31], 0 offen offset:0
buffer_load_dwordx4 v[68:71], v36, s[28:31], 0 offen offset:512
buffer_load_dwordx4 v[72:75], v36, s[28:31], 0 offen offset:1024
buffer_load_dwordx4 v[76:79], v36, s[28:31], 0 offen offset:1536
s_waitcnt vmcnt(12)
v_lshlrev_b32 v80, 16, v48
v_and_b32 v81, 0xffff0000, v48
v_lshlrev_b32_e64 v82, 16, v49
v_and_b32 v83, 0xffff0000, v49
v_lshlrev_b32_e64 v84, 16, v50
v_and_b32 v85, 0xffff0000, v50
v_lshlrev_b32_e64 v86, 16, v51
v_and_b32 v87, 0xffff0000, v51
v_lshlrev_b32_e64 v88, 16, v52
v_and_b32 v89, 0xffff0000, v52
v_lshlrev_b32_e64 v90, 16, v53
v_and_b32 v91, 0xffff0000, v53
v_lshlrev_b32_e64 v92, 16, v54
v_and_b32 v93, 0xffff0000, v54
v_lshlrev_b32_e64 v94, 16, v55
v_and_b32 v95, 0xffff0000, v55
v_lshlrev_b32_e64 v96, 16, v56
v_and_b32 v97, 0xffff0000, v56
v_lshlrev_b32_e64 v98, 16, v57
v_and_b32 v99, 0xffff0000, v57
v_lshlrev_b32_e64 v100, 16, v58
v_and_b32 v101, 0xffff0000, v58
v_lshlrev_b32_e64 v102, 16, v59
v_and_b32 v103, 0xffff0000, v59
v_lshlrev_b32_e64 v104, 16, v60
v_and_b32 v105, 0xffff0000, v60
v_lshlrev_b32_e64 v106, 16, v61
v_and_b32 v107, 0xffff0000, v61
v_lshlrev_b32_e64 v108, 16, v62
v_and_b32 v109, 0xffff0000, v62
v_lshlrev_b32_e64 v110, 16, v63
v_and_b32 v111, 0xffff0000, v63
v_pk_add_f32 v[40:41], v[80:81], v[82:83]
v_pk_add_f32 v[42:43], v[84:85], v[86:87]
v_pk_add_f32 v[40:41], v[40:41], v[88:89]
v_pk_add_f32 v[42:43], v[42:43], v[90:91]
v_pk_add_f32 v[40:41], v[40:41], v[92:93]
v_pk_add_f32 v[42:43], v[42:43], v[94:95]
v_pk_add_f32 v[40:41], v[40:41], v[96:97]
v_pk_add_f32 v[42:43], v[42:43], v[98:99]
v_pk_add_f32 v[40:41], v[40:41], v[100:101]
v_pk_add_f32 v[42:43], v[42:43], v[102:103]
v_pk_add_f32 v[40:41], v[40:41], v[104:105]
v_pk_add_f32 v[42:43], v[42:43], v[106:107]
v_pk_add_f32 v[40:41], v[40:41], v[108:109]
v_pk_add_f32 v[42:43], v[42:43], v[110:111]
v_pk_add_f32 v[40:41], v[40:41], v[42:43]
Va 38,40,41
s_nop 1
v_add_f32_dpp v38, v38, v38 quad_perm:[1,0,3,2] row_mask:0xf bank_mask:0xf
s_nop 1
v_add_f32_dpp v38, v38, v38 quad_perm:[2,3,0,1] row_mask:0xf bank_mask:0xf
s_nop 1
v_add_f32_dpp v38, v38, v38 row_half_mirror row_mask:0xf bank_mask:0xf
s_nop 1
v_add_f32_dpp v38, v38, v38 row_mirror row_mask:0xf bank_mask:0xf
v_mov_b32 v37, v38
s_nop 1
v_permlane16_swap_b32 v37, v38
Va 38,38,37
s_add_u32 m0, s56, 0
s_nop 0
buffer_load_dwordx4 v2, s[8:11], s48 offen offset:0 lds
buffer_load_dwordx4 v3, s[8:11], s49 offen offset:1024 lds
buffer_load_dwordx4 v2, s[8:11], s50 offen offset:2048 lds
buffer_load_dwordx4 v3, s[8:11], s51 offen offset:3072 lds
s_add_u32 m0, s56, 4096
s_nop 0
buffer_load_dwordx4 v4, s[8:11], s48 offen offset:0 lds
buffer_load_dwordx4 v5, s[8:11], s49 offen offset:1024 lds
buffer_load_dwordx4 v4, s[8:11], s50 offen offset:2048 lds
buffer_load_dwordx4 v5, s[8:11], s51 offen offset:3072 lds
v_xor_b32 v2, 128, v2
v_xor_b32 v3, 128, v3
v_xor_b32 v4, 128, v4
v_xor_b32 v5, 128, v5
v_mul_f32 v38, 0xba800000, v38
v_mov_b32_e64 v39, v38
v_pk_add_f32 v[112:113], v[80:81], v[38:39]
v_pk_mul_f32 v[40:41], v[112:113], v[112:113]
v_pk_add_f32 v[114:115], v[82:83], v[38:39]
v_pk_mul_f32 v[42:43], v[114:115], v[114:115]
v_pk_add_f32 v[116:117], v[84:85], v[38:39]
v_pk_fma_f32 v[40:41], v[116:117], v[116:117], v[40:41]
v_pk_add_f32 v[118:119], v[86:87], v[38:39]
v_pk_fma_f32 v[42:43], v[118:119], v[118:119], v[42:43]
v_pk_add_f32 v[112:113], v[88:89], v[38:39]
v_pk_fma_f32 v[40:41], v[112:113], v[112:113], v[40:41]
v_pk_add_f32 v[114:115], v[90:91], v[38:39]
v_pk_fma_f32 v[42:43], v[114:115], v[114:115], v[42:43]
v_pk_add_f32 v[116:117], v[92:93], v[38:39]
v_pk_fma_f32 v[40:41], v[116:117], v[116:117], v[40:41]
v_pk_add_f32 v[118:119], v[94:95], v[38:39]
v_pk_fma_f32 v[42:43], v[118:119], v[118:119], v[42:43]
v_pk_add_f32 v[112:113], v[96:97], v[38:39]
v_pk_fma_f32 v[40:41], v[112:113], v[112:113], v[40:41]
v_pk_add_f32 v[114:115], v[98:99], v[38:39]
v_pk_fma_f32 v[42:43], v[114:115], v[114:115], v[42:43]
v_pk_add_f32 v[116:117], v[100:101], v[38:39]
v_pk_fma_f32 v[40:41], v[116:117], v[116:117], v[40:41]
v_pk_add_f32 v[118:119], v[102:103], v[38:39]
v_pk_fma_f32 v[42:43], v[118:119], v[118:119], v[42:43]
v_pk_add_f32 v[112:113], v[104:105], v[38:39]
v_pk_fma_f32 v[40:41], v[112:113], v[112:113], v[40:41]
v_pk_add_f32 v[114:115], v[106:107], v[38:39]
v_pk_fma_f32 v[42:43], v[114:115], v[114:115], v[42:43]
v_pk_add_f32 v[116:117], v[108:109], v[38:39]
v_pk_fma_f32 v[40:41], v[116:117], v[116:117], v[40:41]
v_pk_add_f32 v[118:119], v[110:111], v[38:39]
v_pk_fma_f32 v[42:43], v[118:119], v[118:119], v[42:43]
v_pk_add_f32 v[40:41], v[40:41], v[42:43]
Va 40,40,41
s_nop 1
v_add_f32_dpp v40, v40, v40 quad_perm:[1,0,3,2] row_mask:0xf bank_mask:0xf
s_nop 1
v_add_f32_dpp v40, v40, v40 quad_perm:[2,3,0,1] row_mask:0xf bank_mask:0xf
s_nop 1
v_add_f32_dpp v40, v40, v40 row_half_mirror row_mask:0xf bank_mask:0xf
s_nop 1
v_add_f32_dpp v40, v40, v40 row_mirror row_mask:0xf bank_mask:0xf
v_mov_b32 v37, v40
s_nop 1
v_permlane16_swap_b32 v37, v40
v_add_f32_e64 v40, v40, v37
v_mul_f32 v40, 0x3a800000, v40
Vc 44,38,40
v_lshlrev_b32_e64 v38, 16, v44
v_and_b32 v40, 0xffff0000, v44
v_add_f32 v40, 0x3727c5ac, v40
Vc 44,40,40
v_lshlrev_b32 v40, 16, v44
v_sqrt_f32 v40, v40
v_mov_b32_e64 v39, v38
Vc 44,40,40
v_lshlrev_b32 v44, 16, v44
v_rcp_f32 v40, v44
v_pk_add_f32 v[80:81], v[80:81], v[38:39]
v_pk_add_f32 v[82:83], v[82:83], v[38:39]
v_pk_add_f32 v[84:85], v[84:85], v[38:39]
v_pk_add_f32 v[86:87], v[86:87], v[38:39]
v_pk_add_f32 v[88:89], v[88:89], v[38:39]
v_pk_add_f32 v[90:91], v[90:91], v[38:39]
v_pk_add_f32 v[92:93], v[92:93], v[38:39]
v_pk_add_f32 v[94:95], v[94:95], v[38:39]
v_pk_add_f32 v[96:97], v[96:97], v[38:39]
v_pk_add_f32 v[98:99], v[98:99], v[38:39]
v_pk_add_f32 v[100:101], v[100:101], v[38:39]
v_pk_add_f32 v[102:103], v[102:103], v[38:39]
v_pk_add_f32 v[104:105], v[104:105], v[38:39]
v_pk_add_f32 v[106:107], v[106:107], v[38:39]
v_pk_add_f32 v[108:109], v[108:109], v[38:39]
v_pk_add_f32 v[110:111], v[110:111], v[38:39]
v_fma_f32 v45, -v44, v40, 1.0
v_fma_f32 v40, v45, v40, v40
v_mov_b32_e64 v41, v40
Vc 48,80,81
Vc 49,82,83
Vc 50,84,85
Vc 51,86,87
Vc 52,88,89
Vc 53,90,91
Vc 54,92,93
Vc 55,94,95
Vc 56,96,97
Vc 57,98,99
Vc 58,100,101
Vc 59,102,103
Vc 60,104,105
Vc 61,106,107
Vc 62,108,109
Vc 63,110,111
v_lshlrev_b32_e64 v80, 16, v48
v_and_b32 v81, 0xffff0000, v48
v_lshlrev_b32_e64 v82, 16, v49
v_and_b32 v83, 0xffff0000, v49
v_lshlrev_b32_e64 v84, 16, v50
v_and_b32 v85, 0xffff0000, v50
v_lshlrev_b32_e64 v86, 16, v51
v_and_b32 v87, 0xffff0000, v51
v_lshlrev_b32_e64 v88, 16, v52
v_and_b32 v89, 0xffff0000, v52
v_lshlrev_b32_e64 v90, 16, v53
v_and_b32 v91, 0xffff0000, v53
v_lshlrev_b32_e64 v92, 16, v54
v_and_b32 v93, 0xffff0000, v54
v_lshlrev_b32_e64 v94, 16, v55
v_and_b32 v95, 0xffff0000, v55
v_lshlrev_b32_e64 v96, 16, v56
v_and_b32 v97, 0xffff0000, v56
v_lshlrev_b32_e64 v98, 16, v57
v_and_b32 v99, 0xffff0000, v57
v_lshlrev_b32_e64 v100, 16, v58
v_and_b32 v101, 0xffff0000, v58
v_lshlrev_b32_e64 v102, 16, v59
v_and_b32 v103, 0xffff0000, v59
v_lshlrev_b32_e64 v104, 16, v60
v_and_b32 v105, 0xffff0000, v60
v_lshlrev_b32_e64 v106, 16, v61
v_and_b32 v107, 0xffff0000, v61
v_lshlrev_b32_e64 v108, 16, v62
v_and_b32 v109, 0xffff0000, v62
v_lshlrev_b32_e64 v110, 16, v63
v_and_b32 v111, 0xffff0000, v63
v_pk_mul_f32 v[80:81], v[80:81], v[40:41]
v_pk_mul_f32 v[82:83], v[82:83], v[40:41]
v_pk_mul_f32 v[84:85], v[84:85], v[40:41]
v_pk_mul_f32 v[86:87], v[86:87], v[40:41]
v_pk_mul_f32 v[88:89], v[88:89], v[40:41]
v_pk_mul_f32 v[90:91], v[90:91], v[40:41]
v_pk_mul_f32 v[92:93], v[92:93], v[40:41]
v_pk_mul_f32 v[94:95], v[94:95], v[40:41]
v_pk_mul_f32 v[96:97], v[96:97], v[40:41]
v_pk_mul_f32 v[98:99], v[98:99], v[40:41]
v_pk_mul_f32 v[100:101], v[100:101], v[40:41]
v_pk_mul_f32 v[102:103], v[102:103], v[40:41]
v_pk_mul_f32 v[104:105], v[104:105], v[40:41]
v_pk_mul_f32 v[106:107], v[106:107], v[40:41]
v_pk_mul_f32 v[108:109], v[108:109], v[40:41]
v_pk_mul_f32 v[110:111], v[110:111], v[40:41]
Vc 48,80,81
Vc 49,82,83
Vc 50,84,85
Vc 51,86,87
Vc 52,88,89
Vc 53,90,91
Vc 54,92,93
Vc 55,94,95
Vc 56,96,97
Vc 57,98,99
Vc 58,100,101
Vc 59,102,103
Vc 60,104,105
Vc 61,106,107
Vc 62,108,109
Vc 63,110,111
s_mul_i32 s3, s32, 4128
s_add_u32 s3, s3, 131072
v_mul_u32_u24 v42, 2064, v33
v_add3_u32 v42, v42, v36, s3
ds_write_b128 v42, v[48:51] offset:0
ds_write_b128 v42, v[52:55] offset:512
ds_write_b128 v42, v[56:59] offset:1024
ds_write_b128 v42, v[60:63] offset:1536
s_waitcnt vmcnt(8)
v_lshlrev_b32 v80, 16, v48
v_and_b32 v81, 0xffff0000, v48
v_lshlrev_b32_e64 v112, 16, v64
v_and_b32 v113, 0xffff0000, v64
v_pk_mul_f32 v[42:43], v[80:81], v[112:113]
v_lshlrev_b32_e64 v82, 16, v49
v_and_b32 v83, 0xffff0000, v49
v_lshlrev_b32_e64 v114, 16, v65
v_and_b32 v115, 0xffff0000, v65
v_pk_mul_f32 v[44:45], v[82:83], v[114:115]
v_lshlrev_b32_e64 v84, 16, v50
v_and_b32 v85, 0xffff0000, v50
v_lshlrev_b32_e64 v116, 16, v66
v_and_b32 v117, 0xffff0000, v66
v_pk_fma_f32 v[42:43], v[84:85], v[116:117], v[42:43]
v_lshlrev_b32_e64 v86, 16, v51
v_and_b32 v87, 0xffff0000, v51
v_lshlrev_b32_e64 v118, 16, v67
v_and_b32 v119, 0xffff0000, v67
v_pk_fma_f32 v[44:45], v[86:87], v[118:119], v[44:45]
v_lshlrev_b32_e64 v88, 16, v52
v_and_b32 v89, 0xffff0000, v52
v_lshlrev_b32_e64 v112, 16, v68
v_and_b32 v113, 0xffff0000, v68
v_pk_fma_f32 v[42:43], v[88:89], v[112:113], v[42:43]
v_lshlrev_b32_e64 v90, 16, v53
v_and_b32 v91, 0xffff0000, v53
v_lshlrev_b32_e64 v114, 16, v69
v_and_b32 v115, 0xffff0000, v69
v_pk_fma_f32 v[44:45], v[90:91], v[114:115], v[44:45]
v_lshlrev_b32_e64 v92, 16, v54
v_and_b32 v93, 0xffff0000, v54
v_lshlrev_b32_e64 v116, 16, v70
v_and_b32 v117, 0xffff0000, v70
v_pk_fma_f32 v[42:43], v[92:93], v[116:117], v[42:43]
v_lshlrev_b32_e64 v94, 16, v55
v_and_b32 v95, 0xffff0000, v55
v_lshlrev_b32_e64 v118, 16, v71
v_and_b32 v119, 0xffff0000, v71
v_pk_fma_f32 v[44:45], v[94:95], v[118:119], v[44:45]
v_lshlrev_b32_e64 v96, 16, v56
v_and_b32 v97, 0xffff0000, v56
v_lshlrev_b32_e64 v112, 16, v72
v_and_b32 v113, 0xffff0000, v72
v_pk_fma_f32 v[42:43], v[96:97], v[112:113], v[42:43]
v_lshlrev_b32_e64 v98, 16, v57
v_and_b32 v99, 0xffff0000, v57
v_lshlrev_b32_e64 v114, 16, v73
v_and_b32 v115, 0xffff0000, v73
v_pk_fma_f32 v[44:45], v[98:99], v[114:115], v[44:45]
v_lshlrev_b32_e64 v100, 16, v58
v_and_b32 v101, 0xffff0000, v58
v_lshlrev_b32_e64 v116, 16, v74
v_and_b32 v117, 0xffff0000, v74
v_pk_fma_f32 v[42:43], v[100:101], v[116:117], v[42:43]
v_lshlrev_b32_e64 v102, 16, v59
v_and_b32 v103, 0xffff0000, v59
v_lshlrev_b32_e64 v118, 16, v75
v_and_b32 v119, 0xffff0000, v75
v_pk_fma_f32 v[44:45], v[102:103], v[118:119], v[44:45]
v_lshlrev_b32_e64 v104, 16, v60
v_and_b32 v105, 0xffff0000, v60
v_lshlrev_b32_e64 v112, 16, v76
v_and_b32 v113, 0xffff0000, v76
v_pk_fma_f32 v[42:43], v[104:105], v[112:113], v[42:43]
v_lshlrev_b32_e64 v106, 16, v61
v_and_b32 v107, 0xffff0000, v61
v_lshlrev_b32_e64 v114, 16, v77
v_and_b32 v115, 0xffff0000, v77
v_pk_fma_f32 v[44:45], v[106:107], v[114:115], v[44:45]
v_lshlrev_b32_e64 v108, 16, v62
v_and_b32 v109, 0xffff0000, v62
v_lshlrev_b32_e64 v116, 16, v78
v_and_b32 v117, 0xffff0000, v78
v_pk_fma_f32 v[42:43], v[108:109], v[116:117], v[42:43]
v_lshlrev_b32_e64 v110, 16, v63
v_and_b32 v111, 0xffff0000, v63
v_lshlrev_b32_e64 v118, 16, v79
v_and_b32 v119, 0xffff0000, v79
v_pk_fma_f32 v[44:45], v[110:111], v[118:119], v[44:45]
v_pk_add_f32 v[42:43], v[42:43], v[44:45]
Va 45,42,43
s_nop 1
v_add_f32_dpp v45, v45, v45 quad_perm:[1,0,3,2] row_mask:0xf bank_mask:0xf
s_nop 1
v_add_f32_dpp v45, v45, v45 quad_perm:[2,3,0,1] row_mask:0xf bank_mask:0xf
s_nop 1
v_add_f32_dpp v45, v45, v45 row_half_mirror row_mask:0xf bank_mask:0xf
s_nop 1
v_add_f32_dpp v45, v45, v45 row_mirror row_mask:0xf bank_mask:0xf
v_mov_b32 v37, v45
s_nop 1
v_permlane16_swap_b32 v37, v45
v_add_f32_e64 v45, v45, v37
Vc 45,45,45
v_ashrrev_i32_e64 v46, 31, v45
v_or_b32 v46, 0x80000000, v46
v_xor_b32_e64 v45, v45, v46
v_and_b32 v45, 0xffff0000, v45
s_lshr_b32 s3, s36, 11
v_add_u32 v46, s3, v33
v_sub_u32 v44, 0xffff, v46
v_or_b32 v45, v45, v44
v_lshlrev_b32 v44, 2, v46
v_lshlrev_b32_e64 v46, 3, v46
v_xor_b32 v38, 0x80000000, v38
v_mov_b32_e64 v39, v40
s_mov_b32 s3, 5242880
s_mov_b32 s39, 5259264
s_mov_b32 exec_lo, 1
s_mov_b32 exec_hi, 1
buffer_store_dword v45, v44, s[20:23], s3 offen sc1
buffer_store_dwordx2 v[38:39], v46, s[20:23], s39 offen sc1
s_mov_b64 exec, -1
s_load_dwordx2 s[4:5], s[0:1], 16
s_load_dwordx4 s[40:43], s[0:1], 64
s_load_dwordx2 s[92:93], s[0:1], 40
s_load_dwordx2 s[94:95], s[0:1], 80
s_load_dwordx2 s[100:101], s[0:1], 0
s_mov_b32 s28, s64
s_and_b32 s29, s65, 0xffff
s_mov_b32 s30, 256
s_mov_b32 s31, 0x20000
s_waitcnt vmcnt(2)
s_waitcnt lgkmcnt(0)
s_barrier
s_nop 0
Ra 224,10,0
Ra 228,11,0
Ra 232,10,2048
Ra 236,11,2048
Ta 0,16,0
Ta 2,16,2048
Ta 4,16,16384
Ta 6,16,18432
Ta 8,17,0
Ta 10,17,2048
Ta 12,17,16384
Ta 14,17,18432
Ta 16,18,0
Ta 18,18,2048
Ta 20,18,16384
s_waitcnt lgkmcnt(9)
s_nop 0
Ta 22,18,18432
Ta 24,19,0
Ta 26,19,2048
Ta 28,19,16384
Ta 30,19,18432
Ta 32,20,0
s_waitcnt lgkmcnt(9)
s_nop 0
Ta 34,20,2048
Ta 36,20,16384
Ta 38,20,18432
Ta 40,21,0
Ta 42,21,2048
Ta 44,21,16384
s_waitcnt lgkmcnt(9)
s_nop 0
Ta 46,21,18432
Ta 48,22,0
Ta 50,22,2048
Ta 52,22,16384
Ta 54,22,18432
Ta 56,23,0
s_waitcnt lgkmcnt(9)
Ta 58,23,2048
Ta 60,23,16384
Ta 62,23,18432
s_cmp_lg_u32 s35, 0
s_cbranch_scc1 L_k1_vpath
Zvaa 48,0,224
v_and_b32 v46, 7, v0
v_mul_u32_u24 v30, 2064, v46
Mvaa 48,4,228
s_add_u32 m0, s57, 65536
Zvaa 52,8,224
buffer_load_dwordx4 v6, s[12:15], s52 offen offset:0 lds
Mvaa 52,12,228
Ra 240,10,4096
Zvaa 56,16,224
buffer_load_dwordx4 v7, s[12:15], s53 offen offset:1024 lds
Mvaa 56,20,228
v_lshrrev_b32_e64 v31, 3, v0
Zvaa 60,24,224
buffer_load_dwordx4 v6, s[12:15], s54 offen offset:2048 lds
Mvaa 60,28,228
Ra 244,11,4096
Zvaa 64,32,224
buffer_load_dwordx4 v7, s[12:15], s55 offen offset:3072 lds
Mvaa 64,36,228
s_add_u32 m0, s57, 69632
s_waitcnt lgkmcnt(10)
Zvaa 68,40,224
buffer_load_dwordx4 v8, s[12:15], s52 offen offset:0 lds
Mvaa 68,44,228
Ra 248,10,6144
s_waitcnt lgkmcnt(7)
Zvaa 72,48,224
buffer_load_dwordx4 v9, s[12:15], s53 offen offset:1024 lds
Mvaa 72,52,228
s_lshl_b32 s3, s32, 9
s_add_u32 s3, s3, 131072
v_lshl_add_u32 v30, v31, 4, v30
s_waitcnt lgkmcnt(3)
Zvaa 76,56,224
buffer_load_dwordx4 v8, s[12:15], s54 offen offset:2048 lds
Mvaa 76,60,228
Ra 252,11,6144
Zvaa 80,0,232
buffer_load_dwordx4 v9, s[12:15], s55 offen offset:3072 lds
Mvaa 80,4,236
s_add_u32 m0, s56, 65536
v_xor_b32 v6, 1572864, v6
v_xor_b32 v7, 1572864, v7
Zvaa 84,8,232
buffer_load_dwordx4 v2, s[8:11], s48 offen offset:0 lds
Mvaa 84,12,236
v_xor_b32 v8, 1572864, v8
v_xor_b32 v9, 1572864, v9
Zvaa 88,16,232
buffer_load_dwordx4 v3, s[8:11], s49 offen offset:1024 lds
Mvaa 88,20,236
v_add_u32 v30, s3, v30
v_lshlrev_b32 v31, 8, v31
Zvaa 92,24,232
buffer_load_dwordx4 v2, s[8:11], s50 offen offset:2048 lds
Mvaa 92,28,236
v_lshl_add_u32 v46, v46, 4, v31
Zvaa 96,32,232
buffer_load_dwordx4 v3, s[8:11], s51 offen offset:3072 lds
Mvaa 96,36,236
s_add_u32 m0, s56, 69632
Zvaa 100,40,232
buffer_load_dwordx4 v4, s[8:11], s48 offen offset:0 lds
Mvaa 100,44,236
Rv 34,30,128
Rv 38,30,256
Zvaa 104,48,232
buffer_load_dwordx4 v5, s[8:11], s49 offen offset:1024 lds
Mvaa 104,52,236
Rv 42,30,384
Rv 30,30,0
Zvaa 108,56,232
s_waitcnt lgkmcnt(4)
buffer_load_dwordx4 v4, s[8:11], s50 offen offset:2048 lds
Mvaa 108,60,236
s_lshr_b32 s3, s2, 1
s_mul_i32 s3, s3, 33792
s_add_u32 s3, s3, s57
Zvaa 112,0,240
buffer_load_dwordx4 v5, s[8:11], s51 offen offset:3072 lds
Mvaa 112,4,244
v_xor_b32 v2, 384, v2
v_xor_b32 v3, 384, v3
Zvaa 116,8,240
s_and_b32 s39, s2, 1
s_lshl_b32 s39, s39, 7
s_add_u32 s3, s3, s39
Mvaa 116,12,244
Ra 224,10,8192
v_xor_b32 v4, 384, v4
Zvaa 120,16,240
s_add_u32 s39, s3, 4096
Mvaa 120,20,244
v_xor_b32 v5, 384, v5
Zvaa 124,24,240
Mvaa 124,28,244
Ra 228,11,8192
Zvaa 128,32,240
Mvaa 128,36,244
Zvaa 132,40,240
Mvaa 132,44,244
Ra 232,10,10240
Zvaa 136,48,240
buffer_load_dword v1, v47, s[60:63], 0 offen
Mvaa 136,52,244
s_mul_i32 vcc_lo, s59, 1
v_xor_b32 v47, vcc_lo, v47
Zvaa 140,56,240
Mvaa 140,60,244
Ra 236,11,10240
Zvaa 144,0,248
Mvaa 144,4,252
Zvaa 148,8,248
Mvaa 148,12,252
Zvaa 152,16,248
Mvaa 152,20,252
Zvaa 156,24,248
Mvaa 156,28,252
Zvaa 160,32,248
Mvaa 160,36,252
Zvaa 164,40,248
Mvaa 164,44,252
Zvaa 168,48,248
Mvaa 168,52,252
s_waitcnt vmcnt(9)
Zvaa 172,56,248
s_waitcnt lgkmcnt(0)
s_barrier
Mvaa 172,60,252
s_add_u32 m0, s57, 0
Zvaa 176,0,224
buffer_load_dwordx4 v6, s[12:15], s52 offen offset:0 lds
Mvaa 176,4,228
Ta 64,14,0
Ta 66,14,2048
Zvaa 180,8,224
Mvaa 180,12,228
Ra 240,10,12288
Zvaa 184,16,224
buffer_load_dwordx4 v7, s[12:15], s53 offen offset:1024 lds
Mvaa 184,20,228
Ta 68,14,16384
Ta 70,14,18432
Zvaa 188,24,224
Mvaa 188,28,228
Ra 244,11,12288
Zvaa 192,32,224
buffer_load_dwordx4 v6, s[12:15], s54 offen offset:2048 lds
Mvaa 192,36,228
Ta 72,15,0
Ta 74,15,2048
Zvaa 196,40,224
Mvaa 196,44,228
Ra 248,10,14336
Zvaa 200,48,224
buffer_load_dwordx4 v7, s[12:15], s55 offen offset:3072 lds
Mvaa 200,52,228
Ta 76,15,16384
Ta 78,15,18432
Zvaa 204,56,224
Mvaa 204,60,228
s_add_u32 m0, s57, 4096
Ra 252,11,14336
Zvaa 208,0,232
buffer_load_dwordx4 v8, s[12:15], s52 offen offset:0 lds
Mvaa 208,4,236
Zvaa 212,8,232
Mvaa 212,12,236
Ta 80,24,0
Ta 82,24,2048
Zvaa 216,16,232
buffer_load_dwordx4 v9, s[12:15], s53 offen offset:1024 lds
Mvaa 216,20,236
Ta 84,24,16384
s_waitcnt lgkmcnt(9)
Ta 86,24,18432
Zvaa 220,24,232
Mvaa 220,28,236
Ta 88,25,0
Ta 90,25,2048
Zvaa 224,32,232
buffer_load_dwordx4 v8, s[12:15], s54 offen offset:2048 lds
Mvaa 224,36,236
Zvaa 228,40,232
Mvaa 228,44,236
Ta 92,25,16384
Ta 94,25,18432
Zvaa 232,48,232
buffer_load_dwordx4 v9, s[12:15], s55 offen offset:3072 lds
Mvaa 232,52,236
s_waitcnt vmcnt(9)
Ta 96,26,0
s_waitcnt lgkmcnt(9)
Ta 98,26,2048
Zvaa 236,56,232
s_barrier
v_xor_b32 v6, 524288, v6
v_xor_b32 v7, 524288, v7
Mvaa 236,60,236
s_add_u32 m0, s56, 0
Ta 100,26,16384
Ta 102,26,18432
Zvaa 240,0,240
buffer_load_dwordx4 v2, s[8:11], s48 offen offset:0 lds
Mvaa 240,4,244
v_xor_b32 v8, 524288, v8
v_xor_b32 v9, 524288, v9
Zvaa 244,8,240
Mvaa 244,12,244
Ra 224,12,0
Zvaa 248,16,240
buffer_load_dwordx4 v3, s[8:11], s49 offen offset:1024 lds
Mvaa 248,20,244
Ta 104,27,0
Ta 106,27,2048
Zvaa 252,24,240
Mvaa 252,28,244
s_waitcnt lgkmcnt(9)
Ra 228,13,0
Zaaa 128,32,240
buffer_load_dwordx4 v2, s[8:11], s50 offen offset:2048 lds
Maaa 128,36,244
Ta 108,27,16384
Ta 110,27,18432
Zaaa 132,40,240
Maaa 132,44,244
Ra 232,12,2048
Zaaa 136,48,240
buffer_load_dwordx4 v3, s[8:11], s51 offen offset:3072 lds
Maaa 136,52,244
Ta 112,28,0
Ta 114,28,2048
Zaaa 140,56,240
Maaa 140,60,244
s_add_u32 m0, s56, 4096
s_waitcnt lgkmcnt(9)
Ra 236,13,2048
Zaaa 144,0,248
buffer_load_dwordx4 v4, s[8:11], s48 offen offset:0 lds
Maaa 144,4,252
Zaaa 148,8,248
Maaa 148,12,252
Ta 116,28,16384
Ta 118,28,18432
Zaaa 152,16,248
buffer_load_dwordx4 v5, s[8:11], s49 offen offset:1024 lds
Maaa 152,20,252
Ta 120,29,0
Ta 122,29,2048
Zaaa 156,24,248
Maaa 156,28,252
Ta 124,29,16384
s_waitcnt lgkmcnt(9)
Ta 126,29,18432
Zaaa 160,32,248
buffer_load_dwordx4 v4, s[8:11], s50 offen offset:2048 lds
Maaa 160,36,252
Zaaa 164,40,248
Maaa 164,44,252
Zaaa 168,48,248
buffer_load_dwordx4 v5, s[8:11], s51 offen offset:3072 lds
Maaa 168,52,252
v_xor_b32 v2, 128, v2
v_xor_b32 v3, 128, v3
Zaaa 172,56,248
s_waitcnt lgkmcnt(6)
buffer_load_dword v1, v47, s[60:63], 0 offen
v_xor_b32 v4, 128, v4
v_xor_b32 v5, 128, v5
Maaa 172,60,252
s_waitcnt lgkmcnt(0)
s_mul_i32 vcc_lo, s59, 7
v_xor_b32 v47, vcc_lo, v47
Mvaa 48,64,224
buffer_store_dwordx4 v[30:33], v46, s[20:23], s3 offen offset:0 sc1
Mvaa 48,68,228
buffer_store_dwordx4 v[34:37], v46, s[20:23], s3 offen offset:2048 sc1
Mvaa 52,72,224
buffer_store_dwordx4 v[38:41], v46, s[20:23], s39 offen offset:0 sc1
Mvaa 52,76,228
Ra 240,12,4096
Mvaa 56,80,224
buffer_store_dwordx4 v[42:45], v46, s[20:23], s39 offen offset:2048 sc1
Mvaa 56,84,228
s_lshl_b32 s3, s34, 1
s_and_b32 s36, s32, 1
s_add_u32 s3, s3, s36
Mvaa 60,88,224
s_mul_i32 s3, s3, 1116160
s_mul_i32 s36, s33, 139264
s_add_u32 s3, s3, s36
Mvaa 60,92,228
Ra 244,13,4096
Mvaa 64,96,224
s_lshr_b32 s36, s32, 1
s_mul_i32 s36, s36, 69632
s_add_u32 s3, s3, s36
Mvaa 64,100,228
s_add_u32 s38, s3, 0
s_lshl_b32 s39, s34, 7
s_lshl_b32 s36, s33, 2
Mvaa 68,104,224
s_add_u32 s39, s39, s36
s_add_u32 s39, s39, 5296128
v_mov_b32_e64 v30, 1
Mvaa 68,108,228
Ra 248,12,6144
Mvaa 72,112,224
v_mov_b32_e64 v31, 0
Mvaa 72,116,228
s_cmp_eq_u32 s32, 0
s_cselect_b32 s39, s39, 2146435072
Mvaa 76,120,224
s_mov_b64 exec, 1
buffer_store_dword v31, v31, s[20:23], s39 offen sc1
s_mov_b64 exec, -1
Mvaa 76,124,228
Ra 252,13,6144
Mvaa 80,64,232
s_and_b32 s33, s2, 7
s_lshl_b32 s33, s33, 2
s_bfe_u32 s3, s2, 0x20003
Mvaa 80,68,236
s_add_u32 s33, s33, s3
s_lshr_b32 s34, s2, 5
s_lshl_b32 s64, s34, 7
Mvaa 84,72,232
s_lshl_b32 s3, s33, 2
s_add_u32 s64, s64, s3
s_add_u32 s64, s64, 5300224
Mvaa 84,76,236
s_lshl_b32 s65, s34, 8
s_sub_u32 s65, 1920, s65
v_mul_u32_u24 v32, s65, v0
Mvaa 88,80,232
s_cmp_eq_u32 s32, 0
s_cselect_b32 s64, s64, 2146435072
Mvaa 88,84,236
s_mov_b64 exec, 3
buffer_store_dword v31, v32, s[20:23], s64 offen sc1
s_mov_b64 exec, -1
Mvaa 92,88,232
s_lshl_b32 s3, s2, 2
s_add_u32 s3, s3, 5447680
v_lshlrev_b32_e64 v32, 10, v0
Mvaa 92,92,236
s_cmp_eq_u32 s32, 0
s_cselect_b32 s3, s3, 2146435072
Mvaa 96,96,232
s_mov_b64 exec, 0x1ff
buffer_store_dword v31, v32, s[20:23], s3 offen sc1
s_mov_b64 exec, -1
Mvaa 96,100,236
s_lshl_b32 s35, s34, 1
s_sub_u32 s36, 32, s35
s_add_u32 s35, s35, 2
Mvaa 100,104,232
s_lshl_b32 s44, s32, 12
s_lshl_b32 s58, s32, 1
s_sub_u32 s58, 7, s58
Mvaa 100,108,236
s_mul_i32 s58, s58, 33792
s_sub_u32 s3, 15, s34
s_lshl_b32 s45, s3, 3
Mvaa 104,112,232
s_add_u32 s45, s45, s32
s_lshl_b32 s46, s34, 3
s_add_u32 s46, s46, s32
Mvaa 104,116,236
s_mov_b32 s68, s42
s_and_b32 s69, s43, 0xffff
s_mov_b32 s70, 7340032
Mvaa 108,120,232
s_waitcnt lgkmcnt(0)
Mvaa 108,124,236
s_mov_b32 s71, 0x20000
s_cmp_eq_u32 s32, 0
s_cselect_b32 s37, 0, 2146435072
Mvaa 112,64,240
s_lshl_b32 s3, s33, 8
s_add_u32 s16, s4, s3
s_addc_u32 s17, s5, 0
s_and_b32 s17, s17, 0xffff
Mvaa 112,68,244
s_mov_b32 s18, 0
s_mov_b32 s19, 0x20000
s_sub_u32 s18, 8388608, s3
Mvaa 116,72,240
v_and_b32 v33, 15, v0
v_lshrrev_b32 v32, 1, v33
Mvaa 116,76,244
Ra 224,12,8192
Mvaa 120,80,240
v_and_b32 v33, 1, v0
v_lshlrev_b32 v32, 13, v32
Mvaa 120,84,244
v_lshl_add_u32 v45, v33, 7, v32
Mvaa 124,88,240
s_lshl_b32 s3, s32, 3
s_add_u32 s3, s3, s34
s_mul_i32 s47, s3, 65536
Mvaa 124,92,244
Ra 228,13,8192
Mvaa 128,96,240
s_bfe_u32 s6, s2, 131075
s_lshl_b32 s3, s32, 8
s_or_b32 s6, s6, s3
Mvaa 128,100,244
Mvaa 132,104,240
Mvaa 132,108,244
Ra 232,12,10240
Mvaa 136,112,240
Mvaa 136,116,244
Mvaa 140,120,240
Mvaa 140,124,244
Ra 236,13,10240
Mvaa 144,64,248
Mvaa 144,68,252
Mvaa 148,72,248
Mvaa 148,76,252
Mvaa 152,80,248
Mvaa 152,84,252
Mvaa 156,88,248
Mvaa 156,92,252
Mvaa 160,96,248
Mvaa 160,100,252
Mvaa 164,104,248
Mvaa 164,108,252
Mvaa 168,112,248
Mvaa 168,116,252
s_waitcnt vmcnt(16)
Mvaa 172,120,248
s_waitcnt lgkmcnt(0)
s_barrier
Mvaa 172,124,252
s_add_u32 m0, s57, 65536
Mvaa 176,64,224
buffer_load_dwordx4 v6, s[12:15], s52 offen offset:0 lds
Mvaa 176,68,228
Ta 0,16,0
Ta 2,16,2048
Mvaa 180,72,224
Mvaa 180,76,228
Ra 240,12,12288
Mvaa 184,80,224
buffer_load_dwordx4 v7, s[12:15], s53 offen offset:1024 lds
Mvaa 184,84,228
Ta 4,16,16384
Ta 6,16,18432
Mvaa 188,88,224
Mvaa 188,92,228
Ra 244,13,12288
Mvaa 192,96,224
buffer_load_dwordx4 v6, s[12:15], s54 offen offset:2048 lds
Mvaa 192,100,228
Ta 8,17,0
Ta 10,17,2048
Mvaa 196,104,224
Mvaa 196,108,228
Ra 248,12,14336
Mvaa 200,112,224
buffer_load_dwordx4 v7, s[12:15], s55 offen offset:3072 lds
Mvaa 200,116,228
Ta 12,17,16384
Ta 14,17,18432
Mvaa 204,120,224
Mvaa 204,124,228
s_add_u32 m0, s57, 69632
Ra 252,13,14336
Mvaa 208,64,232
buffer_load_dwordx4 v8, s[12:15], s52 offen offset:0 lds
Mvaa 208,68,236
Mvaa 212,72,232
Mvaa 212,76,236
Ta 16,18,0
Ta 18,18,2048
Mvaa 216,80,232
buffer_load_dwordx4 v9, s[12:15], s53 offen offset:1024 lds
Mvaa 216,84,236
Ta 20,18,16384
s_waitcnt lgkmcnt(9)
Ta 22,18,18432
Mvaa 220,88,232
Mvaa 220,92,236
Ta 24,19,0
Ta 26,19,2048
Mvaa 224,96,232
buffer_load_dwordx4 v8, s[12:15], s54 offen offset:2048 lds
Mvaa 224,100,236
Mvaa 228,104,232
Mvaa 228,108,236
Ta 28,19,16384
Ta 30,19,18432
Mvaa 232,112,232
buffer_load_dwordx4 v9, s[12:15], s55 offen offset:3072 lds
Mvaa 232,116,236
s_waitcnt vmcnt(16)
Ta 32,20,0
s_waitcnt lgkmcnt(9)
Ta 34,20,2048
Mvaa 236,120,232
s_barrier
v_xor_b32 v6, 3670016, v6
v_xor_b32 v7, 3670016, v7
Mvaa 236,124,236
s_add_u32 m0, s56, 65536
Ta 36,20,16384
Ta 38,20,18432
Mvaa 240,64,240
buffer_load_dwordx4 v2, s[8:11], s48 offen offset:0 lds
Mvaa 240,68,244
v_xor_b32 v8, 3670016, v8
v_xor_b32 v9, 3670016, v9
Mvaa 244,72,240
Mvaa 244,76,244
Ra 224,10,0
Mvaa 248,80,240
buffer_load_dwordx4 v3, s[8:11], s49 offen offset:1024 lds
Mvaa 248,84,244
Ta 40,21,0
Ta 42,21,2048
Mvaa 252,88,240
Mvaa 252,92,244
s_waitcnt lgkmcnt(9)
Ra 228,11,0
Maaa 128,96,240
buffer_load_dwordx4 v2, s[8:11], s50 offen offset:2048 lds
Maaa 128,100,244
Ta 44,21,16384
Ta 46,21,18432
Maaa 132,104,240
Maaa 132,108,244
Ra 232,10,2048
Maaa 136,112,240
buffer_load_dwordx4 v3, s[8:11], s51 offen offset:3072 lds
Maaa 136,116,244
Ta 48,22,0
Ta 50,22,2048
Maaa 140,120,240
Maaa 140,124,244
s_add_u32 m0, s56, 69632
s_waitcnt lgkmcnt(9)
Ra 236,11,2048
Maaa 144,64,248
buffer_load_dwordx4 v4, s[8:11], s48 offen offset:0 lds
Maaa 144,68,252
Maaa 148,72,248
Maaa 148,76,252
Ta 52,22,16384
Ta 54,22,18432
Maaa 152,80,248
buffer_load_dwordx4 v5, s[8:11], s49 offen offset:1024 lds
Maaa 152,84,252
Ta 56,23,0
Ta 58,23,2048
Maaa 156,88,248
Maaa 156,92,252
Ta 60,23,16384
s_waitcnt lgkmcnt(9)
Ta 62,23,18432
Maaa 160,96,248
buffer_load_dwordx4 v4, s[8:11], s50 offen offset:2048 lds
Maaa 160,100,252
Maaa 164,104,248
Maaa 164,108,252
Maaa 168,112,248
buffer_load_dwordx4 v5, s[8:11], s51 offen offset:3072 lds
Maaa 168,116,252
v_xor_b32 v2, 896, v2
v_xor_b32 v3, 896, v3
Maaa 172,120,248
s_waitcnt lgkmcnt(6)
buffer_load_dword v1, v47, s[60:63], 0 offen
v_xor_b32 v4, 896, v4
v_xor_b32 v5, 896, v5
Maaa 172,124,252
s_waitcnt lgkmcnt(0)
s_mul_i32 vcc_lo, s59, 1
v_xor_b32 v47, vcc_lo, v47
Mvaa 48,0,224
Mvaa 48,4,228
Mvaa 52,8,224
Mvaa 52,12,228
Ra 240,10,4096
Mvaa 56,16,224
Mvaa 56,20,228
Mvaa 60,24,224
Mvaa 60,28,228
Ra 244,11,4096
Mvaa 64,32,224
Mvaa 64,36,228
Mvaa 68,40,224
Mvaa 68,44,228
Ra 248,10,6144
Mvaa 72,48,224
Mvaa 72,52,228
Mvaa 76,56,224
Mvaa 76,60,228
Ra 252,11,6144
Mvaa 80,0,232
Mvaa 80,4,236
Mvaa 84,8,232
Mvaa 84,12,236
Mvaa 88,16,232
Mvaa 88,20,236
Mvaa 92,24,232
Mvaa 92,28,236
Mvaa 96,32,232
Mvaa 96,36,236
Mvaa 100,40,232
Mvaa 100,44,236
Mvaa 104,48,232
Mvaa 104,52,236
Mvaa 108,56,232
s_waitcnt lgkmcnt(0)
Mvaa 108,60,236
Mvaa 112,0,240
Mvaa 112,4,244
Mvaa 116,8,240
Mvaa 116,12,244
Ra 224,10,8192
Mvaa 120,16,240
Mvaa 120,20,244
Mvaa 124,24,240
Mvaa 124,28,244
Ra 228,11,8192
Mvaa 128,32,240
Mvaa 128,36,244
Mvaa 132,40,240
Mvaa 132,44,244
Ra 232,10,10240
Mvaa 136,48,240
Mvaa 136,52,244
Mvaa 140,56,240
Mvaa 140,60,244
Ra 236,11,10240
Mvaa 144,0,248
Mvaa 144,4,252
Mvaa 148,8,248
Mvaa 148,12,252
Mvaa 152,16,248
Mvaa 152,20,252
Mvaa 156,24,248
Mvaa 156,28,252
Mvaa 160,32,248
Mvaa 160,36,252
Mvaa 164,40,248
Mvaa 164,44,252
Mvaa 168,48,248
Mvaa 168,52,252
s_waitcnt vmcnt(9)
Mvaa 172,56,248
s_waitcnt lgkmcnt(0)
s_barrier
Mvaa 172,60,252
s_add_u32 m0, s57, 0
Mvaa 176,0,224
buffer_load_dwordx4 v6, s[12:15], s52 offen offset:0 lds
Mvaa 176,4,228
Ta 64,14,0
Ta 66,14,2048
Mvaa 180,8,224
Mvaa 180,12,228
Ra 240,10,12288
Mvaa 184,16,224
buffer_load_dwordx4 v7, s[12:15], s53 offen offset:1024 lds
Mvaa 184,20,228
Ta 68,14,16384
Ta 70,14,18432
Mvaa 188,24,224
Mvaa 188,28,228
Ra 244,11,12288
Mvaa 192,32,224
buffer_load_dwordx4 v6, s[12:15], s54 offen offset:2048 lds
Mvaa 192,36,228
Ta 72,15,0
Ta 74,15,2048
Mvaa 196,40,224
Mvaa 196,44,228
Ra 248,10,14336
Mvaa 200,48,224
buffer_load_dwordx4 v7, s[12:15], s55 offen offset:3072 lds
Mvaa 200,52,228
Ta 76,15,16384
Ta 78,15,18432
Mvaa 204,56,224
s_cmp_eq_u32 s6, 0
s_cselect_b32 s3, 0, 2146435072
Mvaa 204,60,228
s_add_u32 m0, s57, 4096
Ra 252,11,14336
Mvaa 208,0,232
buffer_load_dwordx4 v8, s[12:15], s52 offen offset:0 lds
Mvaa 208,4,236
s_mov_b64 exec, 1
buffer_atomic_add v30, v31, s[28:31], s3 offen sc1
s_mov_b64 exec, -1
Mvaa 212,8,232
Mvaa 212,12,236
Ta 80,24,0
Ta 82,24,2048
Mvaa 216,16,232
buffer_load_dwordx4 v9, s[12:15], s53 offen offset:1024 lds
Mvaa 216,20,236
Ta 84,24,16384
s_waitcnt lgkmcnt(9)
Ta 86,24,18432
Mvaa 220,24,232
Mvaa 220,28,236
Ta 88,25,0
Ta 90,25,2048
Mvaa 224,32,232
buffer_load_dwordx4 v8, s[12:15], s54 offen offset:2048 lds
Mvaa 224,36,236
Mvaa 228,40,232
Mvaa 228,44,236
Ta 92,25,16384
Ta 94,25,18432
Mvaa 232,48,232
buffer_load_dwordx4 v9, s[12:15], s55 offen offset:3072 lds
Mvaa 232,52,236
s_waitcnt vmcnt(10)
Ta 96,26,0
s_waitcnt lgkmcnt(9)
Ta 98,26,2048
Mvaa 236,56,232
s_barrier
v_xor_b32 v6, 524288, v6
v_xor_b32 v7, 524288, v7
Mvaa 236,60,236
s_add_u32 m0, s56, 0
Ta 100,26,16384
Ta 102,26,18432
Mvaa 240,0,240
buffer_load_dwordx4 v2, s[8:11], s48 offen offset:0 lds
Mvaa 240,4,244
v_xor_b32 v8, 524288, v8
v_xor_b32 v9, 524288, v9
Mvaa 244,8,240
Mvaa 244,12,244
Ra 224,12,0
Mvaa 248,16,240
buffer_load_dwordx4 v3, s[8:11], s49 offen offset:1024 lds
Mvaa 248,20,244
Ta 104,27,0
Ta 106,27,2048
Mvaa 252,24,240
Mvaa 252,28,244
s_waitcnt lgkmcnt(9)
Ra 228,13,0
Maaa 128,32,240
buffer_load_dwordx4 v2, s[8:11], s50 offen offset:2048 lds
Maaa 128,36,244
Ta 108,27,16384
Ta 110,27,18432
Maaa 132,40,240
Maaa 132,44,244
Ra 232,12,2048
Maaa 136,48,240
buffer_load_dwordx4 v3, s[8:11], s51 offen offset:3072 lds
Maaa 136,52,244
Ta 112,28,0
Ta 114,28,2048
Maaa 140,56,240
Maaa 140,60,244
s_add_u32 m0, s56, 4096
s_waitcnt lgkmcnt(9)
Ra 236,13,2048
Maaa 144,0,248
buffer_load_dwordx4 v4, s[8:11], s48 offen offset:0 lds
Maaa 144,4,252
Maaa 148,8,248
Maaa 148,12,252
Ta 116,28,16384
Ta 118,28,18432
Maaa 152,16,248
buffer_load_dwordx4 v5, s[8:11], s49 offen offset:1024 lds
Maaa 152,20,252
Ta 120,29,0
Ta 122,29,2048
Maaa 156,24,248
Maaa 156,28,252
Ta 124,29,16384
s_waitcnt lgkmcnt(9)
Ta 126,29,18432
Maaa 160,32,248
buffer_load_dwordx4 v4, s[8:11], s50 offen offset:2048 lds
Maaa 160,36,252
Maaa 164,40,248
Maaa 164,44,252
Maaa 168,48,248
buffer_load_dwordx4 v5, s[8:11], s51 offen offset:3072 lds
Maaa 168,52,252
v_xor_b32 v2, 128, v2
v_xor_b32 v3, 128, v3
Maaa 172,56,248
s_waitcnt lgkmcnt(6)
buffer_load_dword v1, v47, s[60:63], 0 offen
v_xor_b32 v4, 128, v4
v_xor_b32 v5, 128, v5
Maaa 172,60,252
s_waitcnt lgkmcnt(0)
s_mul_i32 vcc_lo, s59, 3
v_xor_b32 v47, vcc_lo, v47
Mvaa 48,64,224
buffer_load_dword v44, v45, s[16:19], s47 offen
Mvaa 48,68,228
s_add_u32 s47, s47, 2097152
Mvaa 52,72,224
Mvaa 52,76,228
Ra 240,12,4096
Mvaa 56,80,224
Mvaa 56,84,228
Mvaa 60,88,224
Mvaa 60,92,228
Ra 244,13,4096
Mvaa 64,96,224
Mvaa 64,100,228
Mvaa 68,104,224
Mvaa 68,108,228
Ra 248,12,6144
Mvaa 72,112,224
Mvaa 72,116,228
Mvaa 76,120,224
Mvaa 76,124,228
Ra 252,13,6144
Mvaa 80,64,232
Mvaa 80,68,236
Mvaa 84,72,232
Mvaa 84,76,236
Mvaa 88,80,232
Mvaa 88,84,236
Mvaa 92,88,232
Mvaa 92,92,236
Mvaa 96,96,232
Mvaa 96,100,236
Mvaa 100,104,232
s_cmp_eq_u32 s6, 1
s_cselect_b32 s3, 0, 2146435072
Mvaa 100,108,236
s_mov_b64 exec, 1
buffer_atomic_add v30, v31, s[28:31], s3 offen sc1
s_mov_b64 exec, -1
Mvaa 104,112,232
Mvaa 104,116,236
Mvaa 108,120,232
s_waitcnt lgkmcnt(0)
Mvaa 108,124,236
Mvaa 112,64,240
Mvaa 112,68,244
Mvaa 116,72,240
Mvaa 116,76,244
Ra 224,12,8192
Mvaa 120,80,240
Mvaa 120,84,244
Mvaa 124,88,240
Mvaa 124,92,244
Ra 228,13,8192
Mvaa 128,96,240
Mvaa 128,100,244
Mvaa 132,104,240
Mvaa 132,108,244
Ra 232,12,10240
Mvaa 136,112,240
Mvaa 136,116,244
Mvaa 140,120,240
Mvaa 140,124,244
Ra 236,13,10240
Mvaa 144,64,248
Mvaa 144,68,252
Mvaa 148,72,248
Mvaa 148,76,252
Mvaa 152,80,248
Mvaa 152,84,252
Mvaa 156,88,248
Mvaa 156,92,252
Mvaa 160,96,248
Mvaa 160,100,252
Mvaa 164,104,248
Mvaa 164,108,252
Mvaa 168,112,248
Mvaa 168,116,252
s_waitcnt vmcnt(11)
Mvaa 172,120,248
s_waitcnt lgkmcnt(0)
s_barrier
Mvaa 172,124,252
s_add_u32 m0, s57, 65536
Mvaa 176,64,224
buffer_load_dwordx4 v6, s[12:15], s52 offen offset:0 lds
Mvaa 176,68,228
Ta 0,16,0
Ta 2,16,2048
Mvaa 180,72,224
Mvaa 180,76,228
Ra 240,12,12288
Mvaa 184,80,224
buffer_load_dwordx4 v7, s[12:15], s53 offen offset:1024 lds
Mvaa 184,84,228
Ta 4,16,16384
Ta 6,16,18432
Mvaa 188,88,224
Mvaa 188,92,228
Ra 244,13,12288
Mvaa 192,96,224
buffer_load_dwordx4 v6, s[12:15], s54 offen offset:2048 lds
Mvaa 192,100,228
Ta 8,17,0
Ta 10,17,2048
Mvaa 196,104,224
Mvaa 196,108,228
Ra 248,12,14336
Mvaa 200,112,224
buffer_load_dwordx4 v7, s[12:15], s55 offen offset:3072 lds
Mvaa 200,116,228
Ta 12,17,16384
Ta 14,17,18432
Mvaa 204,120,224
Mvaa 204,124,228
s_add_u32 m0, s57, 69632
Ra 252,13,14336
Mvaa 208,64,232
buffer_load_dwordx4 v8, s[12:15], s52 offen offset:0 lds
Mvaa 208,68,236
Mvaa 212,72,232
Mvaa 212,76,236
Ta 16,18,0
Ta 18,18,2048
Mvaa 216,80,232
buffer_load_dwordx4 v9, s[12:15], s53 offen offset:1024 lds
Mvaa 216,84,236
Ta 20,18,16384
s_waitcnt lgkmcnt(9)
Ta 22,18,18432
Mvaa 220,88,232
Mvaa 220,92,236
Ta 24,19,0
Ta 26,19,2048
Mvaa 224,96,232
buffer_load_dwordx4 v8, s[12:15], s54 offen offset:2048 lds
Mvaa 224,100,236
Mvaa 228,104,232
Mvaa 228,108,236
Ta 28,19,16384
Ta 30,19,18432
Mvaa 232,112,232
buffer_load_dwordx4 v9, s[12:15], s55 offen offset:3072 lds
Mvaa 232,116,236
s_waitcnt vmcnt(11)
Ta 32,20,0
s_waitcnt lgkmcnt(9)
Ta 34,20,2048
Mvaa 236,120,232
s_barrier
v_xor_b32 v6, 1572864, v6
v_xor_b32 v7, 1572864, v7
Mvaa 236,124,236
s_add_u32 m0, s56, 65536
Ta 36,20,16384
Ta 38,20,18432
Mvaa 240,64,240
buffer_load_dwordx4 v2, s[8:11], s48 offen offset:0 lds
Mvaa 240,68,244
v_xor_b32 v8, 1572864, v8
v_xor_b32 v9, 1572864, v9
Mvaa 244,72,240
Mvaa 244,76,244
Ra 224,10,0
Mvaa 248,80,240
buffer_load_dwordx4 v3, s[8:11], s49 offen offset:1024 lds
Mvaa 248,84,244
Ta 40,21,0
Ta 42,21,2048
Mvaa 252,88,240
Mvaa 252,92,244
s_waitcnt lgkmcnt(9)
Ra 228,11,0
Maaa 128,96,240
buffer_load_dwordx4 v2, s[8:11], s50 offen offset:2048 lds
Maaa 128,100,244
Ta 44,21,16384
Ta 46,21,18432
Maaa 132,104,240
s_cmp_eq_u32 s6, 2
s_cselect_b32 s3, 0, 2146435072
Maaa 132,108,244
Ra 232,10,2048
Maaa 136,112,240
buffer_load_dwordx4 v3, s[8:11], s51 offen offset:3072 lds
Maaa 136,116,244
Ta 48,22,0
Ta 50,22,2048
Maaa 140,120,240
s_mov_b64 exec, 1
buffer_atomic_add v30, v31, s[28:31], s3 offen sc1
s_mov_b64 exec, -1
Maaa 140,124,244
s_add_u32 m0, s56, 69632
s_waitcnt lgkmcnt(9)
Ra 236,11,2048
Maaa 144,64,248
buffer_load_dwordx4 v4, s[8:11], s48 offen offset:0 lds
Maaa 144,68,252
Maaa 148,72,248
Maaa 148,76,252
Ta 52,22,16384
Ta 54,22,18432
Maaa 152,80,248
buffer_load_dwordx4 v5, s[8:11], s49 offen offset:1024 lds
Maaa 152,84,252
Ta 56,23,0
Ta 58,23,2048
Maaa 156,88,248
Maaa 156,92,252
Ta 60,23,16384
s_waitcnt lgkmcnt(9)
Ta 62,23,18432
Maaa 160,96,248
buffer_load_dwordx4 v4, s[8:11], s50 offen offset:2048 lds
Maaa 160,100,252
Maaa 164,104,248
Maaa 164,108,252
Maaa 168,112,248
buffer_load_dwordx4 v5, s[8:11], s51 offen offset:3072 lds
Maaa 168,116,252
v_xor_b32 v2, 384, v2
v_xor_b32 v3, 384, v3
Maaa 172,120,248
s_waitcnt lgkmcnt(6)
buffer_load_dword v1, v47, s[60:63], 0 offen
v_xor_b32 v4, 384, v4
v_xor_b32 v5, 384, v5
Maaa 172,124,252
s_waitcnt lgkmcnt(0)
s_mul_i32 vcc_lo, s59, 1
v_xor_b32_e64 v47, vcc_lo, v47
Mvaa 48,0,224
buffer_load_dword v44, v45, s[16:19], s47 offen
Mvaa 48,4,228
s_add_u32 s47, s47, 2097152
Mvaa 52,8,224
Mvaa 52,12,228
Ra 240,10,4096
Mvaa 56,16,224
Mvaa 56,20,228
Mvaa 60,24,224
Mvaa 60,28,228
Ra 244,11,4096
Mvaa 64,32,224
Mvaa 64,36,228
Mvaa 68,40,224
Mvaa 68,44,228
Ra 248,10,6144
Mvaa 72,48,224
Mvaa 72,52,228
Mvaa 76,56,224
Mvaa 76,60,228
Ra 252,11,6144
Mvaa 80,0,232
Mvaa 80,4,236
Mvaa 84,8,232
Mvaa 84,12,236
Mvaa 88,16,232
Mvaa 88,20,236
Mvaa 92,24,232
Mvaa 92,28,236
Mvaa 96,32,232
Mvaa 96,36,236
Mvaa 100,40,232
Mvaa 100,44,236
Mvaa 104,48,232
Mvaa 104,52,236
Mvaa 108,56,232
s_waitcnt lgkmcnt(0)
Mvaa 108,60,236
Mvaa 112,0,240
Mvaa 112,4,244
Mvaa 116,8,240
Mvaa 116,12,244
Ra 224,10,8192
Mvaa 120,16,240
Mvaa 120,20,244
Mvaa 124,24,240
Mvaa 124,28,244
Ra 228,11,8192
Mvaa 128,32,240
Mvaa 128,36,244
Mvaa 132,40,240
Mvaa 132,44,244
Ra 232,10,10240
Mvaa 136,48,240
Mvaa 136,52,244
Mvaa 140,56,240
Mvaa 140,60,244
Ra 236,11,10240
Mvaa 144,0,248
Mvaa 144,4,252
Mvaa 148,8,248
Mvaa 148,12,252
Mvaa 152,16,248
s_cmp_eq_u32 s6, 3
s_cselect_b32 s3, 0, 2146435072
Mvaa 152,20,252
s_mov_b64 exec, 1
buffer_atomic_add v30, v31, s[28:31], s3 offen sc1
s_mov_b64 exec, -1
Mvaa 156,24,248
Mvaa 156,28,252
Mvaa 160,32,248
Mvaa 160,36,252
Mvaa 164,40,248
Mvaa 164,44,252
Mvaa 168,48,248
Mvaa 168,52,252
s_waitcnt vmcnt(12)
Mvaa 172,56,248
s_waitcnt lgkmcnt(0)
s_barrier
Mvaa 172,60,252
s_add_u32 m0, s57, 0
Mvaa 176,0,224
buffer_load_dwordx4 v6, s[12:15], s52 offen offset:0 lds
Mvaa 176,4,228
Ta 64,14,0
Ta 66,14,2048
Mvaa 180,8,224
Mvaa 180,12,228
Ra 240,10,12288
Mvaa 184,16,224
buffer_load_dwordx4 v7, s[12:15], s53 offen offset:1024 lds
Mvaa 184,20,228
Ta 68,14,16384
Ta 70,14,18432
Mvaa 188,24,224
Mvaa 188,28,228
Ra 244,11,12288
Mvaa 192,32,224
buffer_load_dwordx4 v6, s[12:15], s54 offen offset:2048 lds
Mvaa 192,36,228
Ta 72,15,0
Ta 74,15,2048
Mvaa 196,40,224
Mvaa 196,44,228
Ra 248,10,14336
Mvaa 200,48,224
buffer_load_dwordx4 v7, s[12:15], s55 offen offset:3072 lds
Mvaa 200,52,228
Ta 76,15,16384
Ta 78,15,18432
Mvaa 204,56,224
Mvaa 204,60,228
s_add_u32 m0, s57, 4096
Ra 252,11,14336
Mvaa 208,0,232
buffer_load_dwordx4 v8, s[12:15], s52 offen offset:0 lds
Mvaa 208,4,236
Mvaa 212,8,232
Mvaa 212,12,236
Ta 80,24,0
Ta 82,24,2048
Mvaa 216,16,232
buffer_load_dwordx4 v9, s[12:15], s53 offen offset:1024 lds
Mvaa 216,20,236
Ta 84,24,16384
s_waitcnt lgkmcnt(9)
Ta 86,24,18432
Mvaa 220,24,232
Mvaa 220,28,236
Ta 88,25,0
Ta 90,25,2048
Mvaa 224,32,232
buffer_load_dwordx4 v8, s[12:15], s54 offen offset:2048 lds
Mvaa 224,36,236
Mvaa 228,40,232
Mvaa 228,44,236
Ta 92,25,16384
Ta 94,25,18432
Mvaa 232,48,232
buffer_load_dwordx4 v9, s[12:15], s55 offen offset:3072 lds
Mvaa 232,52,236
s_waitcnt vmcnt(11)
Ta 96,26,0
s_waitcnt lgkmcnt(9)
Ta 98,26,2048
Mvaa 236,56,232
s_barrier
v_xor_b32 v6, 524288, v6
v_xor_b32 v7, 524288, v7
Mvaa 236,60,236
s_add_u32 m0, s56, 0
Ta 100,26,16384
Ta 102,26,18432
Mvaa 240,0,240
buffer_load_dwordx4 v2, s[8:11], s48 offen offset:0 lds
Mvaa 240,4,244
v_xor_b32 v8, 524288, v8
v_xor_b32 v9, 524288, v9
Mvaa 244,8,240
Mvaa 244,12,244
Ra 224,12,0
Mvaa 248,16,240
buffer_load_dwordx4 v3, s[8:11], s49 offen offset:1024 lds
Mvaa 248,20,244
Ta 104,27,0
Ta 106,27,2048
Mvaa 252,24,240
Mvaa 252,28,244
s_waitcnt lgkmcnt(9)
Ra 228,13,0
Maaa 128,32,240
buffer_load_dwordx4 v2, s[8:11], s50 offen offset:2048 lds
Maaa 128,36,244
Ta 108,27,16384
Ta 110,27,18432
Maaa 132,40,240
Maaa 132,44,244
Ra 232,12,2048
Maaa 136,48,240
buffer_load_dwordx4 v3, s[8:11], s51 offen offset:3072 lds
Maaa 136,52,244
Ta 112,28,0
Ta 114,28,2048
Maaa 140,56,240
Maaa 140,60,244
s_add_u32 m0, s56, 4096
s_waitcnt lgkmcnt(9)
Ra 236,13,2048
Maaa 144,0,248
buffer_load_dwordx4 v4, s[8:11], s48 offen offset:0 lds
Maaa 144,4,252
Maaa 148,8,248
Maaa 148,12,252
Ta 116,28,16384
Ta 118,28,18432
Maaa 152,16,248
buffer_load_dwordx4 v5, s[8:11], s49 offen offset:1024 lds
Maaa 152,20,252
Ta 120,29,0
Ta 122,29,2048
Maaa 156,24,248
Maaa 156,28,252
Ta 124,29,16384
s_waitcnt lgkmcnt(9)
Ta 126,29,18432
Maaa 160,32,248
buffer_load_dwordx4 v4, s[8:11], s50 offen offset:2048 lds
Maaa 160,36,252
Maaa 164,40,248
Maaa 164,44,252
Maaa 168,48,248
buffer_load_dwordx4 v5, s[8:11], s51 offen offset:3072 lds
Maaa 168,52,252
v_xor_b32 v2, 128, v2
v_xor_b32 v3, 128, v3
Maaa 172,56,248
s_waitcnt lgkmcnt(6)
buffer_load_dword v1, v47, s[60:63], 0 offen
v_xor_b32 v4, 128, v4
v_xor_b32 v5, 128, v5
Maaa 172,60,252
s_waitcnt lgkmcnt(0)
s_mul_i32 vcc_lo, s59, 7
v_xor_b32 v47, vcc_lo, v47
Mvaa 48,64,224
buffer_load_dword v44, v45, s[16:19], s47 offen
Mvaa 48,68,228
s_add_u32 s47, s47, 2097152
v_lshrrev_b32 v32, 4, v0
v_and_b32 v33, 15, v0
Mvaa 52,72,224
s_lshl_b32 s3, s32, 4
v_add_u32 v34, s3, v32
v_lshlrev_b32_e64 v36, 1, v32
Mvaa 52,76,228
Ra 240,12,4096
Mvaa 56,80,224
v_xor_b32 v36, v36, v33
v_xor_b32 v37, 8, v36
Mvaa 56,84,228
Mvaa 60,88,224
Mvaa 60,92,228
Ra 244,13,4096
Mvaa 64,96,224
s_getpc_b64 s[6:7]
L_cpf2:
s_add_u32 s6, s6, (L_phase2-L_cpf2)&0xffffffff
s_addc_u32 s7, s7, ((L_phase2-L_cpf2)>>32)&0xffffffff
Mvaa 64,100,228
s_lshr_b32 s3, s2, 3
s_lshl_b32 s3, s3, 2
s_add_u32 s3, s3, s32
Mvaa 68,104,224
s_lshl_b32 s3, s3, 10
v_and_b32 v42, 7, v0
v_lshlrev_b32_e64 v42, 7, v42
Mvaa 68,108,228
Ra 248,12,6144
Mvaa 72,112,224
v_add_u32_e64 v42, s3, v42
v_min_u32 v42, L_k2_fin-L_phase2-4, v42
Mvaa 72,116,228
v_mov_b32_e64 v41, s7
Mvaa 76,120,224
v_add_co_u32 v40, vcc, s6, v42
s_nop 1
v_addc_co_u32 v41, vcc, 0, v41, vcc
Mvaa 76,124,228
Ra 252,13,6144
Mvaa 80,64,232
global_load_dword v38, v[40:41], off
Mvaa 80,68,236
Mvaa 84,72,232
Mvaa 84,76,236
Mvaa 88,80,232
Mvaa 88,84,236
Mvaa 92,88,232
Mvaa 92,92,236
Mvaa 96,96,232
Mvaa 96,100,236
Mvaa 100,104,232
Mvaa 100,108,236
Mvaa 104,112,232
Mvaa 104,116,236
Mvaa 108,120,232
s_waitcnt lgkmcnt(0)
Mvaa 108,124,236
Mvaa 112,64,240
Mvaa 112,68,244
Mvaa 116,72,240
Mvaa 116,76,244
Ra 224,12,8192
Mvaa 120,80,240
Mvaa 120,84,244
Mvaa 124,88,240
Mvaa 124,92,244
Ra 228,13,8192
Mvaa 128,96,240
Mvaa 128,100,244
Mvaa 132,104,240
Mvaa 132,108,244
Ra 232,12,10240
Mvaa 136,112,240
Mvaa 136,116,244
Mvaa 140,120,240
Mvaa 140,124,244
Ra 236,13,10240
Mvaa 144,64,248
Mvaa 144,68,252
Mvaa 148,72,248
Mvaa 148,76,252
Mvaa 152,80,248
Mvaa 152,84,252
Mvaa 156,88,248
Mvaa 156,92,252
Mvaa 160,96,248
Mvaa 160,100,252
Mvaa 164,104,248
Mvaa 164,108,252
Mvaa 168,112,248
Mvaa 168,116,252
s_waitcnt vmcnt(11)
Mvaa 172,120,248
s_waitcnt lgkmcnt(0)
s_barrier
Mvaa 172,124,252
s_add_u32 m0, s57, 65536
Mvaa 176,64,224
buffer_load_dwordx4 v6, s[12:15], s52 offen offset:0 lds
Mvaa 176,68,228
Ta 0,16,0
Ta 2,16,2048
Mvaa 180,72,224
Mvaa 180,76,228
Ra 240,12,12288
Mvaa 184,80,224
buffer_load_dwordx4 v7, s[12:15], s53 offen offset:1024 lds
Mvaa 184,84,228
Ta 4,16,16384
Ta 6,16,18432
Mvaa 188,88,224
Mvaa 188,92,228
Ra 244,13,12288
Mvaa 192,96,224
buffer_load_dwordx4 v6, s[12:15], s54 offen offset:2048 lds
Mvaa 192,100,228
Ta 8,17,0
Ta 10,17,2048
Mvaa 196,104,224
Mvaa 196,108,228
Ra 248,12,14336
Mvaa 200,112,224
buffer_load_dwordx4 v7, s[12:15], s55 offen offset:3072 lds
Mvaa 200,116,228
Ta 12,17,16384
Ta 14,17,18432
Mvaa 204,120,224
Mvaa 204,124,228
s_add_u32 m0, s57, 69632
Ra 252,13,14336
Mvaa 208,64,232
buffer_load_dwordx4 v8, s[12:15], s52 offen offset:0 lds
Mvaa 208,68,236
Mvaa 212,72,232
Mvaa 212,76,236
Ta 16,18,0
Ta 18,18,2048
Mvaa 216,80,232
buffer_load_dwordx4 v9, s[12:15], s53 offen offset:1024 lds
Mvaa 216,84,236
Ta 20,18,16384
s_waitcnt lgkmcnt(9)
Ta 22,18,18432
Mvaa 220,88,232
Mvaa 220,92,236
Ta 24,19,0
Ta 26,19,2048
Mvaa 224,96,232
buffer_load_dwordx4 v8, s[12:15], s54 offen offset:2048 lds
Mvaa 224,100,236
Mvaa 228,104,232
Mvaa 228,108,236
Ta 28,19,16384
Ta 30,19,18432
Mvaa 232,112,232
buffer_load_dwordx4 v9, s[12:15], s55 offen offset:3072 lds
Mvaa 232,116,236
s_waitcnt vmcnt(11)
Ta 32,20,0
s_waitcnt lgkmcnt(9)
Ta 34,20,2048
Mvaa 236,120,232
s_barrier
Mvaa 236,124,236
s_add_u32 m0, s56, 65536
Ta 36,20,16384
Ta 38,20,18432
Mvaa 240,64,240
buffer_load_dwordx4 v2, s[8:11], s48 offen offset:0 lds
Mvaa 240,68,244
Mvaa 244,72,240
Mvaa 244,76,244
Ra 224,10,0
Mvaa 248,80,240
buffer_load_dwordx4 v3, s[8:11], s49 offen offset:1024 lds
Mvaa 248,84,244
Ta 40,21,0
Ta 42,21,2048
Mvaa 252,88,240
Mvaa 252,92,244
s_waitcnt lgkmcnt(9)
Ra 228,11,0
Maaa 128,96,240
buffer_load_dwordx4 v2, s[8:11], s50 offen offset:2048 lds
Maaa 128,100,244
Ta 44,21,16384
Ta 46,21,18432
Maaa 132,104,240
Maaa 132,108,244
Ra 232,10,2048
Maaa 136,112,240
buffer_load_dwordx4 v3, s[8:11], s51 offen offset:3072 lds
Maaa 136,116,244
Ta 48,22,0
Ta 50,22,2048
Maaa 140,120,240
Maaa 140,124,244
s_add_u32 m0, s56, 69632
s_waitcnt lgkmcnt(9)
Ra 236,11,2048
Maaa 144,64,248
buffer_load_dwordx4 v4, s[8:11], s48 offen offset:0 lds
Maaa 144,68,252
Maaa 148,72,248
Maaa 148,76,252
Ta 52,22,16384
Ta 54,22,18432
Maaa 152,80,248
buffer_load_dwordx4 v5, s[8:11], s49 offen offset:1024 lds
Maaa 152,84,252
Ta 56,23,0
Ta 58,23,2048
Maaa 156,88,248
Maaa 156,92,252
Ta 60,23,16384
s_waitcnt lgkmcnt(9)
Ta 62,23,18432
Maaa 160,96,248
buffer_load_dwordx4 v4, s[8:11], s50 offen offset:2048 lds
Maaa 160,100,252
Maaa 164,104,248
Maaa 164,108,252
Maaa 168,112,248
buffer_load_dwordx4 v5, s[8:11], s51 offen offset:3072 lds
Maaa 168,116,252
Maaa 172,120,248
s_waitcnt lgkmcnt(6)
Maaa 172,124,252
s_waitcnt lgkmcnt(0)
Mvaa 48,0,224
buffer_load_dword v1, v31, s[28:31], s37 offen sc1
Mvaa 48,4,228
s_mov_b32 s8, s16
s_mov_b32 s9, s17
s_mov_b32 s10, s18
Mvaa 52,8,224
s_add_u32 s16, s66, 46137344
s_addc_u32 s17, s67, 0
s_and_b32 s17, s17, 0xffff
Mvaa 52,12,228
Ra 240,10,4096
Mvaa 56,16,224
s_mov_b32 s18, 16777216
s_mov_b32 s19, 0x20000
s_mov_b32 s48, 0
Mvaa 56,20,228
s_mov_b32 s49, 31744
s_mov_b32 s50, 63488
s_mov_b32 s51, 95232
Mvaa 60,24,224
v_lshlrev_b32 v35, 13, v34
Mvaa 60,28,228
Ra 244,11,4096
Mvaa 64,32,224
s_and_b32 s52, s33, 0
s_lshl_b32 s3, s52, 19
s_lshl_b32 s52, s52, 11
Mvaa 64,36,228
s_add_u32 s53, s52, s58
v_add_u32_e64 v35, s3, v35
v_lshl_add_u32 v8, v36, 4, v35
Mvaa 68,40,224
v_lshl_add_u32 v9, v37, 4, v35
v_lshlrev_b32_e64 v2, 4, v0
Mvaa 68,44,228
Ra 248,10,6144
Mvaa 72,48,224
v_add_u32 v3, 65536, v2
v_add_u32_e64 v4, s44, v2
Mvaa 72,52,228
v_mov_b32 v7, 0
v_lshlrev_b32 v35, 2, v32
Mvaa 76,56,224
v_sub_u32_e64 v35, v33, v35
Mvaa 76,60,228
Ra 252,11,6144
Mvaa 80,0,232
s_lshl_b32 s3, s32, 4
v_add_u32 v5, s3, v35
Mvaa 80,4,236
s_sub_u32 s3, 48, s3
v_add_u32 v6, s3, v35
Mvaa 84,8,232
s_mul_i32 s3, s33, 1116160
s_add_u32 s3, s3, 8388608
s_add_u32 s12, s66, s3
s_addc_u32 s13, s67, 0
s_and_b32 s13, s13, 0xffff
Mvaa 84,12,236
s_mov_b32 s14, 0
s_mov_b32 s15, 0x20000
s_mul_i32 s14, s36, 34816
Mvaa 88,16,232
buffer_load_dword v44, v45, s[8:11], s47 offen
Mvaa 88,20,236
s_add_u32 s47, s47, 2097152
v_lshrrev_b32 v42, 2, v33
v_lshl_add_u32 v43, v32, 3, v42
Mvaa 92,24,232
v_lshlrev_b32 v43, 8, v43
v_and_b32 v46, 3, v0
Mvaa 92,28,236
v_lshl_add_u32 v43, v46, 3, v43
v_and_b32_e64 v46, 1, v32
Mvaa 96,32,232
v_lshl_add_u32 v42, v46, 2, v42
v_lshl_add_u32 v16, v42, 5, v43
Mvaa 96,36,236
v_xor_b32 v17, 32, v16
v_xor_b32 v18, 64, v16
Mvaa 100,40,232
v_xor_b32 v19, 96, v16
v_xor_b32 v20, 128, v16
Mvaa 100,44,236
v_xor_b32 v21, 160, v16
v_xor_b32 v22, 192, v16
Mvaa 104,48,232
v_xor_b32 v23, 224, v16
Mvaa 104,52,236
Mvaa 108,56,232
s_waitcnt lgkmcnt(0)
Mvaa 108,60,236
Mvaa 112,0,240
Mvaa 112,4,244
Mvaa 116,8,240
Mvaa 116,12,244
Ra 224,10,8192
Mvaa 120,16,240
Mvaa 120,20,244
Mvaa 124,24,240
Mvaa 124,28,244
Ra 228,11,8192
Mvaa 128,32,240
Mvaa 128,36,244
Mvaa 132,40,240
Mvaa 132,44,244
Ra 232,10,10240
Mvaa 136,48,240
Mvaa 136,52,244
Mvaa 140,56,240
Mvaa 140,60,244
Ra 236,11,10240
Mvaa 144,0,248
Mvaa 144,4,252
Mvaa 148,8,248
Mvaa 148,12,252
Mvaa 152,16,248
Mvaa 152,20,252
Mvaa 156,24,248
Mvaa 156,28,252
Mvaa 160,32,248
Mvaa 160,36,252
Mvaa 164,40,248
Mvaa 164,44,252
Mvaa 168,48,248
Mvaa 168,52,252
s_waitcnt vmcnt(10)
Mvaa 172,56,248
s_waitcnt lgkmcnt(0)
s_barrier
Mvaa 172,60,252
s_add_u32 m0, s44, 0
Mvaa 176,0,224
buffer_load_dwordx4 v8, s[8:11], s48 offen offset:0 lds
Mvaa 176,4,228
Ta 64,14,0
Ta 66,14,2048
Mvaa 180,8,224
Mvaa 180,12,228
Ra 240,10,12288
Mvaa 184,16,224
buffer_load_dwordx4 v8, s[8:11], s49 offen offset:1024 lds
Mvaa 184,20,228
Ta 68,14,16384
Ta 70,14,18432
Mvaa 188,24,224
Mvaa 188,28,228
Ra 244,11,12288
Mvaa 192,32,224
buffer_load_dwordx4 v9, s[8:11], s50 offen offset:2048 lds
Mvaa 192,36,228
Ta 72,15,0
Ta 74,15,2048
Mvaa 196,40,224
Mvaa 196,44,228
Ra 248,10,14336
Mvaa 200,48,224
buffer_load_dwordx4 v9, s[8:11], s51 offen offset:3072 lds
Mvaa 200,52,228
Ta 76,15,16384
Ta 78,15,18432
Mvaa 204,56,224
v_xor_b32 v8, 524288, v8
v_xor_b32 v9, 524288, v9
Mvaa 204,60,228
s_add_u32 m0, s44, 16384
Ra 252,11,14336
Mvaa 208,0,232
buffer_load_dwordx4 v8, s[8:11], s48 offen offset:0 lds
Mvaa 208,4,236
Mvaa 212,8,232
Mvaa 212,12,236
Ta 80,24,0
Ta 82,24,2048
Mvaa 216,16,232
buffer_load_dwordx4 v8, s[8:11], s49 offen offset:1024 lds
Mvaa 216,20,236
Ta 84,24,16384
s_waitcnt lgkmcnt(9)
Ta 86,24,18432
Mvaa 220,24,232
Mvaa 220,28,236
Ta 88,25,0
Ta 90,25,2048
Mvaa 224,32,232
buffer_load_dwordx4 v9, s[8:11], s50 offen offset:2048 lds
Mvaa 224,36,236
Mvaa 228,40,232
s_mul_i32 s3, s45, 33792
v_add_u32_e64 v10, s3, v2
Mvaa 228,44,236
Ta 92,25,16384
Ta 94,25,18432
Mvaa 232,48,232
buffer_load_dwordx4 v9, s[8:11], s51 offen offset:3072 lds
Mvaa 232,52,236
s_waitcnt vmcnt(10)
Ta 96,26,0
s_waitcnt lgkmcnt(9)
Ta 98,26,2048
Mvaa 236,56,232
s_barrier
v_xor_b32 v8, 1572864, v8
v_xor_b32 v9, 1572864, v9
Mvaa 236,60,236
s_add_u32 m0, s44, 32768
Ta 100,26,16384
Ta 102,26,18432
Mvaa 240,0,240
buffer_load_dwordx4 v8, s[8:11], s48 offen offset:0 lds
Mvaa 240,4,244
s_mul_i32 s3, s46, 33792
v_add_u32 v11, s3, v2
Mvaa 244,8,240
Mvaa 244,12,244
Ra 224,12,0
Mvaa 248,16,240
buffer_load_dwordx4 v8, s[8:11], s49 offen offset:1024 lds
Mvaa 248,20,244
Ta 104,27,0
Ta 106,27,2048
Mvaa 252,24,240
Mvaa 252,28,244
s_waitcnt lgkmcnt(9)
Ra 228,13,0
Maaa 128,32,240
buffer_load_dwordx4 v9, s[8:11], s50 offen offset:2048 lds
Maaa 128,36,244
Ta 108,27,16384
Ta 110,27,18432
Maaa 132,40,240
Maaa 132,44,244
Ra 232,12,2048
Maaa 136,48,240
buffer_load_dwordx4 v9, s[8:11], s51 offen offset:3072 lds
Maaa 136,52,244
Ta 112,28,0
Ta 114,28,2048
Maaa 140,56,240
v_xor_b32 v8, 524288, v8
v_xor_b32 v9, 524288, v9
Maaa 140,60,244
s_add_u32 m0, s44, 49152
s_waitcnt lgkmcnt(9)
Ra 236,13,2048
Maaa 144,0,248
buffer_load_dwordx4 v8, s[8:11], s48 offen offset:0 lds
Maaa 144,4,252
Maaa 148,8,248
Maaa 148,12,252
Ta 116,28,16384
Ta 118,28,18432
Maaa 152,16,248
buffer_load_dwordx4 v8, s[8:11], s49 offen offset:1024 lds
Maaa 152,20,252
Ta 120,29,0
Ta 122,29,2048
Maaa 156,24,248
Maaa 156,28,252
Ta 124,29,16384
s_waitcnt lgkmcnt(9)
Ta 126,29,18432
Maaa 160,32,248
buffer_load_dwordx4 v9, s[8:11], s50 offen offset:2048 lds
Maaa 160,36,252
Maaa 164,40,248
Maaa 164,44,252
Maaa 168,48,248
buffer_load_dwordx4 v9, s[8:11], s51 offen offset:3072 lds
Maaa 168,52,252
v_xor_b32 v8, 3670016, v8
v_xor_b32 v9, 3670016, v9
Maaa 172,56,248
s_waitcnt lgkmcnt(6)
Maaa 172,60,252
s_waitcnt lgkmcnt(0)
Mvaa 48,64,224
v_mov_b32 v14, v40
v_mov_b32_e64 v15, v41
Mvaa 48,68,228
Mvaa 52,72,224
Mvaa 52,76,228
Ra 240,12,4096
Mvaa 56,80,224
Mvaa 56,84,228
Mvaa 60,88,224
Mvaa 60,92,228
Ra 244,13,4096
Mvaa 64,96,224
Vc 24,48,49
Vc 25,50,51
Mvaa 64,100,228
Vc 26,52,53
Vc 27,54,55
Mvaa 68,104,224
Mvaa 68,108,228
Ra 248,12,6144
Mvaa 72,112,224
Vc 28,56,57
Vc 29,58,59
Mvaa 72,116,228
Vc 30,60,61
Vc 31,62,63
Mvaa 76,120,224
Mvaa 76,124,228
Ra 252,13,6144
Mvaa 80,64,232
Vc 32,64,65
Vc 33,66,67
Mvaa 80,68,236
Vc 34,68,69
Vc 35,70,71
Mvaa 84,72,232
Mvaa 84,76,236
Mvaa 88,80,232
Vc 36,72,73
Vc 37,74,75
Mvaa 88,84,236
Vc 38,76,77
Vc 39,78,79
Mvaa 92,88,232
Mvaa 92,92,236
Mvaa 96,96,232
Vc 40,80,81
Vc 41,82,83
Mvaa 96,100,236
Vc 42,84,85
Vc 43,86,87
Mvaa 100,104,232
s_waitcnt vmcnt(12)
Mvaa 100,108,236
s_add_u32 s59, s38, 0
Mvaa 104,112,232
v_readfirstlane_b32 s3, v1
s_nop 0
s_or_b32 s3, s3, s37
s_cmp_lt_u32 s3, 256
s_cbranch_scc1 L_spinAk
L_spinArk:
s_barrier
Mvaa 104,116,236
buffer_store_dwordx4 v[24:27], v2, s[24:27], s59 offen offset:0 sc1
Mvaa 108,120,232
s_waitcnt lgkmcnt(0)
Mvaa 108,124,236
Vc 44,88,89
Vc 45,90,91
Mvaa 112,64,240
buffer_load_dwordx4 a[0:3], v10, s[20:23], s53 offen offset:0 sc1
Mvaa 112,68,244
Vc 46,92,93
Vc 47,94,95
Mvaa 116,72,240
Vc 48,96,97
Vc 49,98,99
Mvaa 116,76,244
Ra 224,12,8192
Mvaa 120,80,240
Vc 50,100,101
Vc 51,102,103
Mvaa 120,84,244
Vc 52,104,105
Vc 53,106,107
Mvaa 124,88,240
buffer_load_dwordx4 a[4:7], v10, s[20:23], s52 offen offset:0 sc1
Mvaa 124,92,244
Ra 228,13,8192
Mvaa 128,96,240
Vc 54,108,109
Vc 55,110,111
Mvaa 128,100,244
Vc 56,112,113
Vc 57,114,115
Mvaa 132,104,240
Vc 58,116,117
Vc 59,118,119
Mvaa 132,108,244
Ra 232,12,10240
Mvaa 136,112,240
buffer_load_dwordx4 a[8:11], v11, s[20:23], s53 offen offset:0 sc1
Mvaa 136,116,244
buffer_store_dwordx4 v[28:31], v2, s[24:27], s59 offen offset:1024 sc1
Mvaa 140,120,240
Vc 60,120,121
Vc 61,122,123
Mvaa 140,124,244
Ra 236,13,10240
Mvaa 144,64,248
Vc 62,124,125
Vc 63,126,127
Mvaa 144,68,252
Vc 64,128,129
Vc 65,130,131
Mvaa 148,72,248
buffer_load_dwordx4 a[12:15], v11, s[20:23], s52 offen offset:0 sc1
Mvaa 148,76,252
Vc 66,132,133
Vc 67,134,135
Mvaa 152,80,248
Vc 68,136,137
Vc 69,138,139
Mvaa 152,84,252
Vc 70,140,141
Vc 71,142,143
Mvaa 156,88,248
Mvaa 156,92,252
Mvaa 160,96,248
buffer_load_dwordx4 a[16:19], v10, s[20:23], s53 offen offset:1024 sc1
Mvaa 160,100,252
Vc 72,144,145
Vc 73,146,147
Mvaa 164,104,248
Vc 74,148,149
Vc 75,150,151
Mvaa 164,108,252
buffer_store_dwordx4 v[32:35], v2, s[24:27], s59 offen offset:2048 sc1
Mvaa 168,112,248
Vc 76,152,153
Vc 77,154,155
Mvaa 168,116,252
Vc 78,156,157
Vc 79,158,159
Mvaa 172,120,248
s_waitcnt lgkmcnt(0)
buffer_load_dwordx4 a[20:23], v10, s[20:23], s52 offen offset:1024 sc1
Mvaa 172,124,252
Mvaa 176,64,224
Vc 80,160,161
Vc 81,162,163
Mvaa 176,68,228
Vc 82,164,165
Vc 83,166,167
Mvaa 180,72,224
Mvaa 180,76,228
Ra 240,12,12288
Mvaa 184,80,224
buffer_load_dwordx4 a[24:27], v11, s[20:23], s53 offen offset:1024 sc1
Mvaa 184,84,228
Vc 84,168,169
Vc 85,170,171
Mvaa 188,88,224
Vc 86,172,173
Vc 87,174,175
Mvaa 188,92,228
Ra 244,13,12288
Mvaa 192,96,224
Vc 88,176,177
Vc 89,178,179
Mvaa 192,100,228
Vc 90,180,181
Vc 91,182,183
Mvaa 196,104,224
buffer_load_dwordx4 a[28:31], v11, s[20:23], s52 offen offset:1024 sc1
Mvaa 196,108,228
Ra 248,12,14336
s_xor_b32 s52, s52, 2048
Mvaa 200,112,224
s_add_u32 s53, s52, s58
Mvaa 200,116,228
Vc 92,184,185
Vc 93,186,187
Mvaa 204,120,224
Vc 94,188,189
Vc 95,190,191
Mvaa 204,124,228
Ra 252,13,14336
Mvaa 208,64,232
buffer_load_dwordx4 a[32:35], v10, s[20:23], s53 offen offset:0 sc1
Mvaa 208,68,236
buffer_store_dwordx4 v[36:39], v2, s[24:27], s59 offen offset:3072 sc1
Mvaa 212,72,232
Vc 96,192,193
Vc 97,194,195
Mvaa 212,76,236
Vc 98,196,197
Vc 99,198,199
Mvaa 216,80,232
Vc 100,200,201
Vc 101,202,203
Mvaa 216,84,236
Vc 102,204,205
Vc 103,206,207
Mvaa 220,88,232
buffer_load_dwordx4 a[36:39], v10, s[20:23], s52 offen offset:0 sc1
Mvaa 220,92,236
Mvaa 224,96,232
Vc 104,208,209
Vc 105,210,211
Mvaa 224,100,236
Vc 106,212,213
Vc 107,214,215
Mvaa 228,104,232
Mvaa 228,108,236
Mvaa 232,112,232
buffer_load_dwordx4 a[40:43], v11, s[20:23], s53 offen offset:0 sc1
Mvaa 232,116,236
Vc 108,216,217
Vc 109,218,219
Mvaa 236,120,232
s_waitcnt lgkmcnt(0)
Mvaa 236,124,236
Vc 110,220,221
Vc 111,222,223
Mvaa 240,64,240
s_add_u32 s59, s38, 4096
Mvaa 240,68,244
buffer_store_dwordx4 v[40:43], v2, s[24:27], s59 offen offset:0 sc1
Mvaa 244,72,240
buffer_load_dwordx4 a[44:47], v11, s[20:23], s52 offen offset:0 sc1
Mvaa 244,76,244
Vc 112,224,225
Vc 113,226,227
Mvaa 248,80,240
Vc 114,228,229
Vc 115,230,231
Mvaa 248,84,244
Vc 116,232,233
Vc 117,234,235
Mvaa 252,88,240
Vc 118,236,237
Vc 119,238,239
Mvaa 252,92,244
Maaa 128,96,240
buffer_load_dwordx4 a[48:51], v10, s[20:23], s53 offen offset:1024 sc1
Maaa 128,100,244
Ta 192,16,0
Ta 194,16,1024
Maaa 132,104,240
Vc 120,240,241
Vc 121,242,243
Maaa 132,108,244
Ta 196,17,0
Ta 198,17,1024
Maaa 136,112,240
Vc 122,244,245
Vc 123,246,247
Maaa 136,116,244
Ta 200,18,0
Ta 202,18,1024
Maaa 140,120,240
buffer_load_dwordx4 a[52:55], v10, s[20:23], s52 offen offset:1024 sc1
Maaa 140,124,244
Ta 204,19,0
Ta 206,19,1024
Maaa 144,64,248
Vc 124,248,249
Vc 125,250,251
Maaa 144,68,252
Ta 208,20,0
Ta 210,20,1024
Maaa 148,72,248
Vc 126,252,253
Vc 127,254,255
Maaa 148,76,252
Ta 212,21,0
Ta 214,21,1024
Maaa 152,80,248
buffer_load_dwordx4 a[56:59], v11, s[20:23], s53 offen offset:1024 sc1
Maaa 152,84,252
Ta 216,22,0
Ta 218,22,1024
Maaa 156,88,248
buffer_store_dwordx4 v[44:47], v2, s[24:27], s59 offen offset:1024 sc1
Maaa 156,92,252
Ta 220,23,0
s_waitcnt lgkmcnt(9)
Ta 222,23,1024
Maaa 160,96,248
Maaa 160,100,252
Maaa 164,104,248
buffer_load_dwordx4 a[60:63], v11, s[20:23], s52 offen offset:1024 sc1
Maaa 164,108,252
s_xor_b32 s52, s52, 6144
s_add_u32 s53, s52, s58
Maaa 168,112,248
Maaa 168,116,252
Maaa 172,120,248
Maaa 172,124,252
s_branch L_phase2
L_k1_vpath:
Zvaa 48,224,0
v_and_b32_e64 v46, 7, v0
v_mul_u32_u24 v30, 2064, v46
Mvaa 48,228,4
s_add_u32 m0, s57, 65536
Zvaa 52,232,0
buffer_load_dwordx4 v6, s[12:15], s52 offen offset:0 lds
Mvaa 52,236,4
Ra 240,10,4096
Zvaa 56,224,8
buffer_load_dwordx4 v7, s[12:15], s53 offen offset:1024 lds
Mvaa 56,228,12
v_lshrrev_b32_e64 v31, 3, v0
Zvaa 60,232,8
buffer_load_dwordx4 v6, s[12:15], s54 offen offset:2048 lds
Mvaa 60,236,12
Ra 244,11,4096
Zvaa 64,224,16
buffer_load_dwordx4 v7, s[12:15], s55 offen offset:3072 lds
Mvaa 64,228,20
s_add_u32 m0, s57, 69632
Zvaa 68,232,16
buffer_load_dwordx4 v8, s[12:15], s52 offen offset:0 lds
Mvaa 68,236,20
Ra 248,10,6144
Zvaa 72,224,24
buffer_load_dwordx4 v9, s[12:15], s53 offen offset:1024 lds
Mvaa 72,228,28
s_lshl_b32 s3, s32, 9
s_add_u32 s3, s3, 131072
v_lshl_add_u32 v30, v31, 4, v30
Zvaa 76,232,24
buffer_load_dwordx4 v8, s[12:15], s54 offen offset:2048 lds
Mvaa 76,236,28
s_waitcnt lgkmcnt(9)
Ra 252,11,6144
Zvaa 80,224,32
buffer_load_dwordx4 v9, s[12:15], s55 offen offset:3072 lds
Mvaa 80,228,36
s_add_u32 m0, s56, 65536
v_xor_b32 v6, 1572864, v6
v_xor_b32 v7, 1572864, v7
Zvaa 84,232,32
buffer_load_dwordx4 v2, s[8:11], s48 offen offset:0 lds
Mvaa 84,236,36
v_xor_b32 v8, 1572864, v8
v_xor_b32 v9, 1572864, v9
Zvaa 88,224,40
buffer_load_dwordx4 v3, s[8:11], s49 offen offset:1024 lds
Mvaa 88,228,44
v_add_u32 v30, s3, v30
v_lshlrev_b32 v31, 8, v31
Zvaa 92,232,40
buffer_load_dwordx4 v2, s[8:11], s50 offen offset:2048 lds
Mvaa 92,236,44
v_lshl_add_u32 v46, v46, 4, v31
s_waitcnt lgkmcnt(8)
Zvaa 96,224,48
buffer_load_dwordx4 v3, s[8:11], s51 offen offset:3072 lds
Mvaa 96,228,52
s_add_u32 m0, s56, 69632
Zvaa 100,232,48
buffer_load_dwordx4 v4, s[8:11], s48 offen offset:0 lds
Mvaa 100,236,52
Rv 34,30,128
Rv 38,30,256
s_waitcnt lgkmcnt(6)
Zvaa 104,224,56
buffer_load_dwordx4 v5, s[8:11], s49 offen offset:1024 lds
Mvaa 104,228,60
Rv 42,30,384
Rv 30,30,0
Zvaa 108,232,56
s_waitcnt lgkmcnt(4)
buffer_load_dwordx4 v4, s[8:11], s50 offen offset:2048 lds
Mvaa 108,236,60
s_lshr_b32 s3, s2, 1
s_mul_i32 s3, s3, 33792
s_add_u32 s3, s3, s57
Zvaa 112,240,0
buffer_load_dwordx4 v5, s[8:11], s51 offen offset:3072 lds
Mvaa 112,244,4
v_xor_b32 v2, 384, v2
v_xor_b32 v3, 384, v3
Zvaa 116,248,0
s_and_b32 s39, s2, 1
s_lshl_b32 s39, s39, 7
s_add_u32 s3, s3, s39
Mvaa 116,252,4
Ra 224,10,8192
v_xor_b32 v4, 384, v4
Zvaa 120,240,8
s_add_u32 s39, s3, 4096
Mvaa 120,244,12
v_xor_b32 v5, 384, v5
Zvaa 124,248,8
Mvaa 124,252,12
Ra 228,11,8192
Zvaa 128,240,16
Mvaa 128,244,20
Zvaa 132,248,16
Mvaa 132,252,20
Ra 232,10,10240
Zvaa 136,240,24
buffer_load_dword v1, v47, s[60:63], 0 offen
Mvaa 136,244,28
s_mul_i32 vcc_lo, s59, 1
v_xor_b32 v47, vcc_lo, v47
Zvaa 140,248,24
Mvaa 140,252,28
Ra 236,11,10240
Zvaa 144,240,32
Mvaa 144,244,36
Zvaa 148,248,32
Mvaa 148,252,36
Zvaa 152,240,40
Mvaa 152,244,44
Zvaa 156,248,40
Mvaa 156,252,44
Zvaa 160,240,48
Mvaa 160,244,52
Zvaa 164,248,48
Mvaa 164,252,52
Zvaa 168,240,56
Mvaa 168,244,60
s_waitcnt vmcnt(9)
Zvaa 172,248,56
s_waitcnt lgkmcnt(0)
s_barrier
Mvaa 172,252,60
s_add_u32 m0, s57, 0
Zvaa 176,224,0
buffer_load_dwordx4 v6, s[12:15], s52 offen offset:0 lds
Mvaa 176,228,4
Ta 64,14,0
Ta 66,14,2048
Zvaa 180,232,0
Mvaa 180,236,4
Ra 240,10,12288
Zvaa 184,224,8
buffer_load_dwordx4 v7, s[12:15], s53 offen offset:1024 lds
Mvaa 184,228,12
Ta 68,14,16384
Ta 70,14,18432
Zvaa 188,232,8
Mvaa 188,236,12
Ra 244,11,12288
Zvaa 192,224,16
buffer_load_dwordx4 v6, s[12:15], s54 offen offset:2048 lds
Mvaa 192,228,20
Ta 72,15,0
Ta 74,15,2048
Zvaa 196,232,16
Mvaa 196,236,20
Ra 248,10,14336
Zvaa 200,224,24
buffer_load_dwordx4 v7, s[12:15], s55 offen offset:3072 lds
Mvaa 200,228,28
Ta 76,15,16384
Ta 78,15,18432
Zvaa 204,232,24
Mvaa 204,236,28
s_add_u32 m0, s57, 4096
Ra 252,11,14336
Zvaa 208,224,32
buffer_load_dwordx4 v8, s[12:15], s52 offen offset:0 lds
Mvaa 208,228,36
Zvaa 212,232,32
Mvaa 212,236,36
Ta 80,24,0
Ta 82,24,2048
Zvaa 216,224,40
buffer_load_dwordx4 v9, s[12:15], s53 offen offset:1024 lds
Mvaa 216,228,44
Ta 84,24,16384
s_waitcnt lgkmcnt(9)
Ta 86,24,18432
Zvaa 220,232,40
Mvaa 220,236,44
Ta 88,25,0
Ta 90,25,2048
Zvaa 224,224,48
buffer_load_dwordx4 v8, s[12:15], s54 offen offset:2048 lds
Mvaa 224,228,52
Zvaa 228,232,48
Mvaa 228,236,52
Ta 92,25,16384
Ta 94,25,18432
Zvaa 232,224,56
buffer_load_dwordx4 v9, s[12:15], s55 offen offset:3072 lds
Mvaa 232,228,60
s_waitcnt vmcnt(9)
Ta 96,26,0
s_waitcnt lgkmcnt(9)
Ta 98,26,2048
Zvaa 236,232,56
s_barrier
v_xor_b32 v6, 524288, v6
v_xor_b32 v7, 524288, v7
Mvaa 236,236,60
s_add_u32 m0, s56, 0
Ta 100,26,16384
Ta 102,26,18432
Zvaa 240,240,0
buffer_load_dwordx4 v2, s[8:11], s48 offen offset:0 lds
Mvaa 240,244,4
v_xor_b32 v8, 524288, v8
v_xor_b32 v9, 524288, v9
Zvaa 244,248,0
Mvaa 244,252,4
Ra 224,12,0
Zvaa 248,240,8
buffer_load_dwordx4 v3, s[8:11], s49 offen offset:1024 lds
Mvaa 248,244,12
Ta 104,27,0
Ta 106,27,2048
Zvaa 252,248,8
Mvaa 252,252,12
s_waitcnt lgkmcnt(9)
Ra 228,13,0
Zaaa 128,240,16
buffer_load_dwordx4 v2, s[8:11], s50 offen offset:2048 lds
Maaa 128,244,20
Ta 108,27,16384
Ta 110,27,18432
Zaaa 132,248,16
Maaa 132,252,20
Ra 232,12,2048
Zaaa 136,240,24
buffer_load_dwordx4 v3, s[8:11], s51 offen offset:3072 lds
Maaa 136,244,28
Ta 112,28,0
Ta 114,28,2048
Zaaa 140,248,24
Maaa 140,252,28
s_add_u32 m0, s56, 4096
s_waitcnt lgkmcnt(9)
Ra 236,13,2048
Zaaa 144,240,32
buffer_load_dwordx4 v4, s[8:11], s48 offen offset:0 lds
Maaa 144,244,36
Zaaa 148,248,32
Maaa 148,252,36
Ta 116,28,16384
Ta 118,28,18432
Zaaa 152,240,40
buffer_load_dwordx4 v5, s[8:11], s49 offen offset:1024 lds
Maaa 152,244,44
Ta 120,29,0
Ta 122,29,2048
Zaaa 156,248,40
Maaa 156,252,44
Ta 124,29,16384
s_waitcnt lgkmcnt(9)
Ta 126,29,18432
Zaaa 160,240,48
buffer_load_dwordx4 v4, s[8:11], s50 offen offset:2048 lds
Maaa 160,244,52
Zaaa 164,248,48
Maaa 164,252,52
Zaaa 168,240,56
buffer_load_dwordx4 v5, s[8:11], s51 offen offset:3072 lds
Maaa 168,244,60
v_xor_b32 v2, 128, v2
v_xor_b32 v3, 128, v3
Zaaa 172,248,56
s_waitcnt lgkmcnt(6)
buffer_load_dword v1, v47, s[60:63], 0 offen
v_xor_b32 v4, 128, v4
v_xor_b32 v5, 128, v5
Maaa 172,252,60
s_waitcnt lgkmcnt(0)
s_mul_i32 vcc_lo, s59, 7
v_xor_b32 v47, vcc_lo, v47
Mvaa 48,224,64
buffer_store_dwordx4 v[30:33], v46, s[20:23], s3 offen offset:0 sc1
Mvaa 48,228,68
buffer_store_dwordx4 v[34:37], v46, s[20:23], s3 offen offset:2048 sc1
Mvaa 52,232,64
buffer_store_dwordx4 v[38:41], v46, s[20:23], s39 offen offset:0 sc1
Mvaa 52,236,68
Ra 240,12,4096
Mvaa 56,224,72
buffer_store_dwordx4 v[42:45], v46, s[20:23], s39 offen offset:2048 sc1
Mvaa 56,228,76
s_lshl_b32 s3, s34, 1
s_and_b32 s36, s32, 1
s_add_u32 s3, s3, s36
Mvaa 60,232,72
s_mul_i32 s3, s3, 1116160
s_mul_i32 s36, s33, 139264
s_add_u32 s3, s3, s36
Mvaa 60,236,76
Ra 244,13,4096
Mvaa 64,224,80
s_lshr_b32 s36, s32, 1
s_mul_i32 s36, s36, 69632
s_add_u32 s3, s3, s36
Mvaa 64,228,84
s_add_u32 s38, s3, 17408
s_lshl_b32 s39, s34, 7
s_lshl_b32 s36, s33, 2
Mvaa 68,232,80
s_add_u32 s39, s39, s36
s_add_u32 s39, s39, 5296160
v_mov_b32 v30, 1
Mvaa 68,236,84
Ra 248,12,6144
Mvaa 72,224,88
v_mov_b32_e64 v31, 0
Mvaa 72,228,92
s_cmp_eq_u32 s32, 0
s_cselect_b32 s39, s39, 2146435072
Mvaa 76,232,88
s_mov_b64 exec, 1
buffer_store_dword v31, v31, s[20:23], s39 offen sc1
s_mov_b64 exec, -1
Mvaa 76,236,92
Ra 252,13,6144
Mvaa 80,224,96
s_and_b32 s33, s2, 7
s_lshl_b32 s33, s33, 2
s_bfe_u32 s3, s2, 0x20003
Mvaa 80,228,100
s_add_u32 s33, s33, s3
s_lshr_b32 s34, s2, 5
s_lshl_b32 s64, s34, 7
Mvaa 84,232,96
s_lshl_b32 s3, s33, 2
s_add_u32 s64, s64, s3
s_add_u32 s64, s64, 5300224
Mvaa 84,236,100
s_lshl_b32 s65, s34, 8
s_sub_u32 s65, 1920, s65
v_mul_u32_u24 v32, s65, v0
Mvaa 88,224,104
s_cmp_eq_u32 s32, 0
s_cselect_b32 s64, s64, 2146435072
Mvaa 88,228,108
s_mov_b64 exec, 3
buffer_store_dword v31, v32, s[20:23], s64 offen sc1
s_mov_b64 exec, -1
Mvaa 92,232,104
s_lshl_b32 s3, s2, 2
s_add_u32 s3, s3, 5447680
v_lshlrev_b32_e64 v32, 10, v0
Mvaa 92,236,108
s_cmp_eq_u32 s32, 0
s_cselect_b32 s3, s3, 2146435072
Mvaa 96,224,112
s_mov_b64 exec, 0x1ff
buffer_store_dword v31, v32, s[20:23], s3 offen sc1
s_mov_b64 exec, -1
Mvaa 96,228,116
s_lshl_b32 s35, s34, 1
s_sub_u32 s36, 32, s35
s_add_u32 s35, s35, 2
Mvaa 100,232,112
s_lshl_b32 s44, s32, 12
s_lshl_b32 s58, s32, 1
s_sub_u32 s58, 7, s58
Mvaa 100,236,116
s_mul_i32 s58, s58, 33792
s_sub_u32 s3, 15, s34
s_lshl_b32 s45, s3, 3
Mvaa 104,224,120
s_add_u32 s45, s45, s32
s_lshl_b32 s46, s34, 3
s_add_u32 s46, s46, s32
Mvaa 104,228,124
s_mov_b32 s68, s42
s_and_b32 s69, s43, 0xffff
s_mov_b32 s70, 7340032
Mvaa 108,232,120
s_waitcnt lgkmcnt(0)
Mvaa 108,236,124
s_mov_b32 s71, 0x20000
s_cmp_eq_u32 s32, 0
s_cselect_b32 s37, 0, 2146435072
Mvaa 112,240,64
s_lshl_b32 s3, s33, 8
s_add_u32 s16, s4, s3
s_addc_u32 s17, s5, 0
s_and_b32 s17, s17, 0xffff
Mvaa 112,244,68
s_mov_b32 s18, 0
s_mov_b32 s19, 0x20000
s_sub_u32 s18, 8388608, s3
Mvaa 116,248,64
v_and_b32 v33, 15, v0
v_lshrrev_b32 v32, 1, v33
Mvaa 116,252,68
Ra 224,12,8192
Mvaa 120,240,72
v_and_b32 v33, 1, v0
v_lshlrev_b32 v32, 13, v32
Mvaa 120,244,76
v_lshl_add_u32 v45, v33, 7, v32
Mvaa 124,248,72
s_lshl_b32 s3, s32, 3
s_add_u32 s3, s3, s34
s_mul_i32 s47, s3, 65536
Mvaa 124,252,76
Ra 228,13,8192
Mvaa 128,240,80
s_bfe_u32 s6, s2, 131075
s_lshl_b32 s3, s32, 8
s_or_b32 s6, s6, s3
Mvaa 128,244,84
Mvaa 132,248,80
Mvaa 132,252,84
Ra 232,12,10240
Mvaa 136,240,88
Mvaa 136,244,92
Mvaa 140,248,88
Mvaa 140,252,92
Ra 236,13,10240
Mvaa 144,240,96
Mvaa 144,244,100
Mvaa 148,248,96
Mvaa 148,252,100
Mvaa 152,240,104
Mvaa 152,244,108
Mvaa 156,248,104
Mvaa 156,252,108
Mvaa 160,240,112
Mvaa 160,244,116
Mvaa 164,248,112
Mvaa 164,252,116
Mvaa 168,240,120
Mvaa 168,244,124
s_waitcnt vmcnt(16)
Mvaa 172,248,120
s_waitcnt lgkmcnt(0)
s_barrier
Mvaa 172,252,124
s_add_u32 m0, s57, 65536
Mvaa 176,224,64
buffer_load_dwordx4 v6, s[12:15], s52 offen offset:0 lds
Mvaa 176,228,68
Ta 0,16,0
Ta 2,16,2048
Mvaa 180,232,64
Mvaa 180,236,68
Ra 240,12,12288
Mvaa 184,224,72
buffer_load_dwordx4 v7, s[12:15], s53 offen offset:1024 lds
Mvaa 184,228,76
Ta 4,16,16384
Ta 6,16,18432
Mvaa 188,232,72
Mvaa 188,236,76
Ra 244,13,12288
Mvaa 192,224,80
buffer_load_dwordx4 v6, s[12:15], s54 offen offset:2048 lds
Mvaa 192,228,84
Ta 8,17,0
Ta 10,17,2048
Mvaa 196,232,80
Mvaa 196,236,84
Ra 248,12,14336
Mvaa 200,224,88
buffer_load_dwordx4 v7, s[12:15], s55 offen offset:3072 lds
Mvaa 200,228,92
Ta 12,17,16384
Ta 14,17,18432
Mvaa 204,232,88
Mvaa 204,236,92
s_add_u32 m0, s57, 69632
Ra 252,13,14336
Mvaa 208,224,96
buffer_load_dwordx4 v8, s[12:15], s52 offen offset:0 lds
Mvaa 208,228,100
Mvaa 212,232,96
Mvaa 212,236,100
Ta 16,18,0
Ta 18,18,2048
Mvaa 216,224,104
buffer_load_dwordx4 v9, s[12:15], s53 offen offset:1024 lds
Mvaa 216,228,108
Ta 20,18,16384
s_waitcnt lgkmcnt(9)
Ta 22,18,18432
Mvaa 220,232,104
Mvaa 220,236,108
Ta 24,19,0
Ta 26,19,2048
Mvaa 224,224,112
buffer_load_dwordx4 v8, s[12:15], s54 offen offset:2048 lds
Mvaa 224,228,116
Mvaa 228,232,112
Mvaa 228,236,116
Ta 28,19,16384
Ta 30,19,18432
Mvaa 232,224,120
buffer_load_dwordx4 v9, s[12:15], s55 offen offset:3072 lds
Mvaa 232,228,124
s_waitcnt vmcnt(16)
Ta 32,20,0
s_waitcnt lgkmcnt(9)
Ta 34,20,2048
Mvaa 236,232,120
s_barrier
v_xor_b32 v6, 3670016, v6
v_xor_b32 v7, 3670016, v7
Mvaa 236,236,124
s_add_u32 m0, s56, 65536
Ta 36,20,16384
Ta 38,20,18432
Mvaa 240,240,64
buffer_load_dwordx4 v2, s[8:11], s48 offen offset:0 lds
Mvaa 240,244,68
v_xor_b32 v8, 3670016, v8
v_xor_b32 v9, 3670016, v9
Mvaa 244,248,64
Mvaa 244,252,68
Ra 224,10,0
Mvaa 248,240,72
buffer_load_dwordx4 v3, s[8:11], s49 offen offset:1024 lds
Mvaa 248,244,76
Ta 40,21,0
Ta 42,21,2048
Mvaa 252,248,72
Mvaa 252,252,76
s_waitcnt lgkmcnt(9)
Ra 228,11,0
Maaa 128,240,80
buffer_load_dwordx4 v2, s[8:11], s50 offen offset:2048 lds
Maaa 128,244,84
Ta 44,21,16384
Ta 46,21,18432
Maaa 132,248,80
Maaa 132,252,84
Ra 232,10,2048
Maaa 136,240,88
buffer_load_dwordx4 v3, s[8:11], s51 offen offset:3072 lds
Maaa 136,244,92
Ta 48,22,0
Ta 50,22,2048
Maaa 140,248,88
Maaa 140,252,92
s_add_u32 m0, s56, 69632
s_waitcnt lgkmcnt(9)
Ra 236,11,2048
Maaa 144,240,96
buffer_load_dwordx4 v4, s[8:11], s48 offen offset:0 lds
Maaa 144,244,100
Maaa 148,248,96
Maaa 148,252,100
Ta 52,22,16384
Ta 54,22,18432
Maaa 152,240,104
buffer_load_dwordx4 v5, s[8:11], s49 offen offset:1024 lds
Maaa 152,244,108
Ta 56,23,0
Ta 58,23,2048
Maaa 156,248,104
Maaa 156,252,108
Ta 60,23,16384
s_waitcnt lgkmcnt(9)
Ta 62,23,18432
Maaa 160,240,112
buffer_load_dwordx4 v4, s[8:11], s50 offen offset:2048 lds
Maaa 160,244,116
Maaa 164,248,112
Maaa 164,252,116
Maaa 168,240,120
buffer_load_dwordx4 v5, s[8:11], s51 offen offset:3072 lds
Maaa 168,244,124
v_xor_b32 v2, 896, v2
v_xor_b32 v3, 896, v3
Maaa 172,248,120
s_waitcnt lgkmcnt(6)
buffer_load_dword v1, v47, s[60:63], 0 offen
v_xor_b32 v4, 896, v4
v_xor_b32 v5, 896, v5
Maaa 172,252,124
s_waitcnt lgkmcnt(0)
s_mul_i32 vcc_lo, s59, 1
v_xor_b32 v47, vcc_lo, v47
Mvaa 48,224,0
Mvaa 48,228,4
Mvaa 52,232,0
Mvaa 52,236,4
Ra 240,10,4096
Mvaa 56,224,8
Mvaa 56,228,12
Mvaa 60,232,8
Mvaa 60,236,12
Ra 244,11,4096
Mvaa 64,224,16
Mvaa 64,228,20
Mvaa 68,232,16
Mvaa 68,236,20
Ra 248,10,6144
Mvaa 72,224,24
Mvaa 72,228,28
Mvaa 76,232,24
Mvaa 76,236,28
Ra 252,11,6144
Mvaa 80,224,32
Mvaa 80,228,36
Mvaa 84,232,32
Mvaa 84,236,36
Mvaa 88,224,40
Mvaa 88,228,44
Mvaa 92,232,40
Mvaa 92,236,44
Mvaa 96,224,48
Mvaa 96,228,52
Mvaa 100,232,48
Mvaa 100,236,52
Mvaa 104,224,56
Mvaa 104,228,60
Mvaa 108,232,56
s_waitcnt lgkmcnt(0)
Mvaa 108,236,60
Mvaa 112,240,0
Mvaa 112,244,4
Mvaa 116,248,0
Mvaa 116,252,4
Ra 224,10,8192
Mvaa 120,240,8
Mvaa 120,244,12
Mvaa 124,248,8
Mvaa 124,252,12
Ra 228,11,8192
Mvaa 128,240,16
Mvaa 128,244,20
Mvaa 132,248,16
Mvaa 132,252,20
Ra 232,10,10240
Mvaa 136,240,24
Mvaa 136,244,28
Mvaa 140,248,24
Mvaa 140,252,28
Ra 236,11,10240
Mvaa 144,240,32
Mvaa 144,244,36
Mvaa 148,248,32
Mvaa 148,252,36
Mvaa 152,240,40
Mvaa 152,244,44
Mvaa 156,248,40
Mvaa 156,252,44
Mvaa 160,240,48
Mvaa 160,244,52
Mvaa 164,248,48
Mvaa 164,252,52
Mvaa 168,240,56
Mvaa 168,244,60
s_waitcnt vmcnt(9)
Mvaa 172,248,56
s_waitcnt lgkmcnt(0)
s_barrier
Mvaa 172,252,60
s_add_u32 m0, s57, 0
Mvaa 176,224,0
buffer_load_dwordx4 v6, s[12:15], s52 offen offset:0 lds
Mvaa 176,228,4
Ta 64,14,0
Ta 66,14,2048
Mvaa 180,232,0
Mvaa 180,236,4
Ra 240,10,12288
Mvaa 184,224,8
buffer_load_dwordx4 v7, s[12:15], s53 offen offset:1024 lds
Mvaa 184,228,12
Ta 68,14,16384
Ta 70,14,18432
Mvaa 188,232,8
Mvaa 188,236,12
Ra 244,11,12288
Mvaa 192,224,16
buffer_load_dwordx4 v6, s[12:15], s54 offen offset:2048 lds
Mvaa 192,228,20
Ta 72,15,0
Ta 74,15,2048
Mvaa 196,232,16
Mvaa 196,236,20
Ra 248,10,14336
Mvaa 200,224,24
buffer_load_dwordx4 v7, s[12:15], s55 offen offset:3072 lds
Mvaa 200,228,28
Ta 76,15,16384
Ta 78,15,18432
Mvaa 204,232,24
s_cmp_eq_u32 s6, 0
s_cselect_b32 s3, 0, 2146435072
Mvaa 204,236,28
s_add_u32 m0, s57, 4096
Ra 252,11,14336
Mvaa 208,224,32
buffer_load_dwordx4 v8, s[12:15], s52 offen offset:0 lds
Mvaa 208,228,36
s_mov_b64 exec, 1
buffer_atomic_add v30, v31, s[28:31], s3 offen sc1
s_mov_b64 exec, -1
Mvaa 212,232,32
Mvaa 212,236,36
Ta 80,24,0
Ta 82,24,2048
Mvaa 216,224,40
buffer_load_dwordx4 v9, s[12:15], s53 offen offset:1024 lds
Mvaa 216,228,44
Ta 84,24,16384
s_waitcnt lgkmcnt(9)
Ta 86,24,18432
Mvaa 220,232,40
Mvaa 220,236,44
Ta 88,25,0
Ta 90,25,2048
Mvaa 224,224,48
buffer_load_dwordx4 v8, s[12:15], s54 offen offset:2048 lds
Mvaa 224,228,52
Mvaa 228,232,48
Mvaa 228,236,52
Ta 92,25,16384
Ta 94,25,18432
Mvaa 232,224,56
buffer_load_dwordx4 v9, s[12:15], s55 offen offset:3072 lds
Mvaa 232,228,60
s_waitcnt vmcnt(10)
Ta 96,26,0
s_waitcnt lgkmcnt(9)
Ta 98,26,2048
Mvaa 236,232,56
s_barrier
v_xor_b32 v6, 524288, v6
v_xor_b32 v7, 524288, v7
Mvaa 236,236,60
s_add_u32 m0, s56, 0
Ta 100,26,16384
Ta 102,26,18432
Mvaa 240,240,0
buffer_load_dwordx4 v2, s[8:11], s48 offen offset:0 lds
Mvaa 240,244,4
v_xor_b32 v8, 524288, v8
v_xor_b32 v9, 524288, v9
Mvaa 244,248,0
Mvaa 244,252,4
Ra 224,12,0
Mvaa 248,240,8
buffer_load_dwordx4 v3, s[8:11], s49 offen offset:1024 lds
Mvaa 248,244,12
Ta 104,27,0
Ta 106,27,2048
Mvaa 252,248,8
Mvaa 252,252,12
s_waitcnt lgkmcnt(9)
Ra 228,13,0
Maaa 128,240,16
buffer_load_dwordx4 v2, s[8:11], s50 offen offset:2048 lds
Maaa 128,244,20
Ta 108,27,16384
Ta 110,27,18432
Maaa 132,248,16
Maaa 132,252,20
Ra 232,12,2048
Maaa 136,240,24
buffer_load_dwordx4 v3, s[8:11], s51 offen offset:3072 lds
Maaa 136,244,28
Ta 112,28,0
Ta 114,28,2048
Maaa 140,248,24
Maaa 140,252,28
s_add_u32 m0, s56, 4096
s_waitcnt lgkmcnt(9)
Ra 236,13,2048
Maaa 144,240,32
buffer_load_dwordx4 v4, s[8:11], s48 offen offset:0 lds
Maaa 144,244,36
Maaa 148,248,32
Maaa 148,252,36
Ta 116,28,16384
Ta 118,28,18432
Maaa 152,240,40
buffer_load_dwordx4 v5, s[8:11], s49 offen offset:1024 lds
Maaa 152,244,44
Ta 120,29,0
Ta 122,29,2048
Maaa 156,248,40
Maaa 156,252,44
Ta 124,29,16384
s_waitcnt lgkmcnt(9)
Ta 126,29,18432
Maaa 160,240,48
buffer_load_dwordx4 v4, s[8:11], s50 offen offset:2048 lds
Maaa 160,244,52
Maaa 164,248,48
Maaa 164,252,52
Maaa 168,240,56
buffer_load_dwordx4 v5, s[8:11], s51 offen offset:3072 lds
Maaa 168,244,60
v_xor_b32 v2, 128, v2
v_xor_b32 v3, 128, v3
Maaa 172,248,56
s_waitcnt lgkmcnt(6)
buffer_load_dword v1, v47, s[60:63], 0 offen
v_xor_b32 v4, 128, v4
v_xor_b32 v5, 128, v5
Maaa 172,252,60
s_waitcnt lgkmcnt(0)
s_mul_i32 vcc_lo, s59, 3
v_xor_b32 v47, vcc_lo, v47
Mvaa 48,224,64
buffer_load_dword v44, v45, s[16:19], s47 offen
Mvaa 48,228,68
s_add_u32 s47, s47, 2097152
Mvaa 52,232,64
Mvaa 52,236,68
Ra 240,12,4096
Mvaa 56,224,72
Mvaa 56,228,76
Mvaa 60,232,72
Mvaa 60,236,76
Ra 244,13,4096
Mvaa 64,224,80
Mvaa 64,228,84
Mvaa 68,232,80
Mvaa 68,236,84
Ra 248,12,6144
Mvaa 72,224,88
Mvaa 72,228,92
Mvaa 76,232,88
Mvaa 76,236,92
Ra 252,13,6144
Mvaa 80,224,96
Mvaa 80,228,100
Mvaa 84,232,96
Mvaa 84,236,100
Mvaa 88,224,104
Mvaa 88,228,108
Mvaa 92,232,104
Mvaa 92,236,108
Mvaa 96,224,112
Mvaa 96,228,116
Mvaa 100,232,112
s_cmp_eq_u32 s6, 1
s_cselect_b32 s3, 0, 2146435072
Mvaa 100,236,116
s_mov_b64 exec, 1
buffer_atomic_add v30, v31, s[28:31], s3 offen sc1
s_mov_b64 exec, -1
Mvaa 104,224,120
Mvaa 104,228,124
Mvaa 108,232,120
s_waitcnt lgkmcnt(0)
Mvaa 108,236,124
Mvaa 112,240,64
Mvaa 112,244,68
Mvaa 116,248,64
Mvaa 116,252,68
Ra 224,12,8192
Mvaa 120,240,72
Mvaa 120,244,76
Mvaa 124,248,72
Mvaa 124,252,76
Ra 228,13,8192
Mvaa 128,240,80
Mvaa 128,244,84
Mvaa 132,248,80
Mvaa 132,252,84
Ra 232,12,10240
Mvaa 136,240,88
Mvaa 136,244,92
Mvaa 140,248,88
Mvaa 140,252,92
Ra 236,13,10240
Mvaa 144,240,96
Mvaa 144,244,100
Mvaa 148,248,96
Mvaa 148,252,100
Mvaa 152,240,104
Mvaa 152,244,108
Mvaa 156,248,104
Mvaa 156,252,108
Mvaa 160,240,112
Mvaa 160,244,116
Mvaa 164,248,112
Mvaa 164,252,116
Mvaa 168,240,120
Mvaa 168,244,124
s_waitcnt vmcnt(11)
Mvaa 172,248,120
s_waitcnt lgkmcnt(0)
s_barrier
Mvaa 172,252,124
s_add_u32 m0, s57, 65536
Mvaa 176,224,64
buffer_load_dwordx4 v6, s[12:15], s52 offen offset:0 lds
Mvaa 176,228,68
Ta 0,16,0
Ta 2,16,2048
Mvaa 180,232,64
Mvaa 180,236,68
Ra 240,12,12288
Mvaa 184,224,72
buffer_load_dwordx4 v7, s[12:15], s53 offen offset:1024 lds
Mvaa 184,228,76
Ta 4,16,16384
Ta 6,16,18432
Mvaa 188,232,72
Mvaa 188,236,76
Ra 244,13,12288
Mvaa 192,224,80
buffer_load_dwordx4 v6, s[12:15], s54 offen offset:2048 lds
Mvaa 192,228,84
Ta 8,17,0
Ta 10,17,2048
Mvaa 196,232,80
Mvaa 196,236,84
Ra 248,12,14336
Mvaa 200,224,88
buffer_load_dwordx4 v7, s[12:15], s55 offen offset:3072 lds
Mvaa 200,228,92
Ta 12,17,16384
Ta 14,17,18432
Mvaa 204,232,88
Mvaa 204,236,92
s_add_u32 m0, s57, 69632
Ra 252,13,14336
Mvaa 208,224,96
buffer_load_dwordx4 v8, s[12:15], s52 offen offset:0 lds
Mvaa 208,228,100
Mvaa 212,232,96
Mvaa 212,236,100
Ta 16,18,0
Ta 18,18,2048
Mvaa 216,224,104
buffer_load_dwordx4 v9, s[12:15], s53 offen offset:1024 lds
Mvaa 216,228,108
Ta 20,18,16384
s_waitcnt lgkmcnt(9)
Ta 22,18,18432
Mvaa 220,232,104
Mvaa 220,236,108
Ta 24,19,0
Ta 26,19,2048
Mvaa 224,224,112
buffer_load_dwordx4 v8, s[12:15], s54 offen offset:2048 lds
Mvaa 224,228,116
Mvaa 228,232,112
Mvaa 228,236,116
Ta 28,19,16384
Ta 30,19,18432
Mvaa 232,224,120
buffer_load_dwordx4 v9, s[12:15], s55 offen offset:3072 lds
Mvaa 232,228,124
s_waitcnt vmcnt(11)
Ta 32,20,0
s_waitcnt lgkmcnt(9)
Ta 34,20,2048
Mvaa 236,232,120
s_barrier
v_xor_b32 v6, 1572864, v6
v_xor_b32 v7, 1572864, v7
Mvaa 236,236,124
s_add_u32 m0, s56, 65536
Ta 36,20,16384
Ta 38,20,18432
Mvaa 240,240,64
buffer_load_dwordx4 v2, s[8:11], s48 offen offset:0 lds
Mvaa 240,244,68
v_xor_b32 v8, 1572864, v8
v_xor_b32 v9, 1572864, v9
Mvaa 244,248,64
Mvaa 244,252,68
Ra 224,10,0
Mvaa 248,240,72
buffer_load_dwordx4 v3, s[8:11], s49 offen offset:1024 lds
Mvaa 248,244,76
Ta 40,21,0
Ta 42,21,2048
Mvaa 252,248,72
Mvaa 252,252,76
s_waitcnt lgkmcnt(9)
Ra 228,11,0
Maaa 128,240,80
buffer_load_dwordx4 v2, s[8:11], s50 offen offset:2048 lds
Maaa 128,244,84
Ta 44,21,16384
Ta 46,21,18432
Maaa 132,248,80
s_cmp_eq_u32 s6, 2
s_cselect_b32 s3, 0, 2146435072
Maaa 132,252,84
Ra 232,10,2048
Maaa 136,240,88
buffer_load_dwordx4 v3, s[8:11], s51 offen offset:3072 lds
Maaa 136,244,92
Ta 48,22,0
Ta 50,22,2048
Maaa 140,248,88
s_mov_b64 exec, 1
buffer_atomic_add v30, v31, s[28:31], s3 offen sc1
s_mov_b64 exec, -1
Maaa 140,252,92
s_add_u32 m0, s56, 69632
s_waitcnt lgkmcnt(9)
Ra 236,11,2048
Maaa 144,240,96
buffer_load_dwordx4 v4, s[8:11], s48 offen offset:0 lds
Maaa 144,244,100
Maaa 148,248,96
Maaa 148,252,100
Ta 52,22,16384
Ta 54,22,18432
Maaa 152,240,104
buffer_load_dwordx4 v5, s[8:11], s49 offen offset:1024 lds
Maaa 152,244,108
Ta 56,23,0
Ta 58,23,2048
Maaa 156,248,104
Maaa 156,252,108
Ta 60,23,16384
s_waitcnt lgkmcnt(9)
Ta 62,23,18432
Maaa 160,240,112
buffer_load_dwordx4 v4, s[8:11], s50 offen offset:2048 lds
Maaa 160,244,116
Maaa 164,248,112
Maaa 164,252,116
Maaa 168,240,120
buffer_load_dwordx4 v5, s[8:11], s51 offen offset:3072 lds
Maaa 168,244,124
v_xor_b32 v2, 384, v2
v_xor_b32 v3, 384, v3
Maaa 172,248,120
s_waitcnt lgkmcnt(6)
buffer_load_dword v1, v47, s[60:63], 0 offen
v_xor_b32 v4, 384, v4
v_xor_b32 v5, 384, v5
Maaa 172,252,124
s_waitcnt lgkmcnt(0)
s_mul_i32 vcc_lo, s59, 1
v_xor_b32_e64 v47, vcc_lo, v47
Mvaa 48,224,0
buffer_load_dword v44, v45, s[16:19], s47 offen
Mvaa 48,228,4
s_add_u32 s47, s47, 2097152
Mvaa 52,232,0
Mvaa 52,236,4
Ra 240,10,4096
Mvaa 56,224,8
Mvaa 56,228,12
Mvaa 60,232,8
Mvaa 60,236,12
Ra 244,11,4096
Mvaa 64,224,16
Mvaa 64,228,20
Mvaa 68,232,16
Mvaa 68,236,20
Ra 248,10,6144
Mvaa 72,224,24
Mvaa 72,228,28
Mvaa 76,232,24
Mvaa 76,236,28
Ra 252,11,6144
Mvaa 80,224,32
Mvaa 80,228,36
Mvaa 84,232,32
Mvaa 84,236,36
Mvaa 88,224,40
Mvaa 88,228,44
Mvaa 92,232,40
Mvaa 92,236,44
Mvaa 96,224,48
Mvaa 96,228,52
Mvaa 100,232,48
Mvaa 100,236,52
Mvaa 104,224,56
Mvaa 104,228,60
Mvaa 108,232,56
s_waitcnt lgkmcnt(0)
Mvaa 108,236,60
Mvaa 112,240,0
Mvaa 112,244,4
Mvaa 116,248,0
Mvaa 116,252,4
Ra 224,10,8192
Mvaa 120,240,8
Mvaa 120,244,12
Mvaa 124,248,8
Mvaa 124,252,12
Ra 228,11,8192
Mvaa 128,240,16
Mvaa 128,244,20
Mvaa 132,248,16
Mvaa 132,252,20
Ra 232,10,10240
Mvaa 136,240,24
Mvaa 136,244,28
Mvaa 140,248,24
Mvaa 140,252,28
Ra 236,11,10240
Mvaa 144,240,32
Mvaa 144,244,36
Mvaa 148,248,32
Mvaa 148,252,36
Mvaa 152,240,40
s_cmp_eq_u32 s6, 3
s_cselect_b32 s3, 0, 2146435072
Mvaa 152,244,44
s_mov_b64 exec, 1
buffer_atomic_add v30, v31, s[28:31], s3 offen sc1
s_mov_b64 exec, -1
Mvaa 156,248,40
Mvaa 156,252,44
Mvaa 160,240,48
Mvaa 160,244,52
Mvaa 164,248,48
Mvaa 164,252,52
Mvaa 168,240,56
Mvaa 168,244,60
s_waitcnt vmcnt(12)
Mvaa 172,248,56
s_waitcnt lgkmcnt(0)
s_barrier
Mvaa 172,252,60
s_add_u32 m0, s57, 0
Mvaa 176,224,0
buffer_load_dwordx4 v6, s[12:15], s52 offen offset:0 lds
Mvaa 176,228,4
Ta 64,14,0
Ta 66,14,2048
Mvaa 180,232,0
Mvaa 180,236,4
Ra 240,10,12288
Mvaa 184,224,8
buffer_load_dwordx4 v7, s[12:15], s53 offen offset:1024 lds
Mvaa 184,228,12
Ta 68,14,16384
Ta 70,14,18432
Mvaa 188,232,8
Mvaa 188,236,12
Ra 244,11,12288
Mvaa 192,224,16
buffer_load_dwordx4 v6, s[12:15], s54 offen offset:2048 lds
Mvaa 192,228,20
Ta 72,15,0
Ta 74,15,2048
Mvaa 196,232,16
Mvaa 196,236,20
Ra 248,10,14336
Mvaa 200,224,24
buffer_load_dwordx4 v7, s[12:15], s55 offen offset:3072 lds
Mvaa 200,228,28
Ta 76,15,16384
Ta 78,15,18432
Mvaa 204,232,24
Mvaa 204,236,28
s_add_u32 m0, s57, 4096
Ra 252,11,14336
Mvaa 208,224,32
buffer_load_dwordx4 v8, s[12:15], s52 offen offset:0 lds
Mvaa 208,228,36
Mvaa 212,232,32
Mvaa 212,236,36
Ta 80,24,0
Ta 82,24,2048
Mvaa 216,224,40
buffer_load_dwordx4 v9, s[12:15], s53 offen offset:1024 lds
Mvaa 216,228,44
Ta 84,24,16384
s_waitcnt lgkmcnt(9)
Ta 86,24,18432
Mvaa 220,232,40
Mvaa 220,236,44
Ta 88,25,0
Ta 90,25,2048
Mvaa 224,224,48
buffer_load_dwordx4 v8, s[12:15], s54 offen offset:2048 lds
Mvaa 224,228,52
Mvaa 228,232,48
Mvaa 228,236,52
Ta 92,25,16384
Ta 94,25,18432
Mvaa 232,224,56
buffer_load_dwordx4 v9, s[12:15], s55 offen offset:3072 lds
Mvaa 232,228,60
s_waitcnt vmcnt(11)
Ta 96,26,0
s_waitcnt lgkmcnt(9)
Ta 98,26,2048
Mvaa 236,232,56
s_barrier
v_xor_b32 v6, 524288, v6
v_xor_b32 v7, 524288, v7
Mvaa 236,236,60
s_add_u32 m0, s56, 0
Ta 100,26,16384
Ta 102,26,18432
Mvaa 240,240,0
buffer_load_dwordx4 v2, s[8:11], s48 offen offset:0 lds
Mvaa 240,244,4
v_xor_b32 v8, 524288, v8
v_xor_b32 v9, 524288, v9
Mvaa 244,248,0
Mvaa 244,252,4
Ra 224,12,0
Mvaa 248,240,8
buffer_load_dwordx4 v3, s[8:11], s49 offen offset:1024 lds
Mvaa 248,244,12
Ta 104,27,0
Ta 106,27,2048
Mvaa 252,248,8
Mvaa 252,252,12
s_waitcnt lgkmcnt(9)
Ra 228,13,0
Maaa 128,240,16
buffer_load_dwordx4 v2, s[8:11], s50 offen offset:2048 lds
Maaa 128,244,20
Ta 108,27,16384
Ta 110,27,18432
Maaa 132,248,16
Maaa 132,252,20
Ra 232,12,2048
Maaa 136,240,24
buffer_load_dwordx4 v3, s[8:11], s51 offen offset:3072 lds
Maaa 136,244,28
Ta 112,28,0
Ta 114,28,2048
Maaa 140,248,24
Maaa 140,252,28
s_add_u32 m0, s56, 4096
s_waitcnt lgkmcnt(9)
Ra 236,13,2048
Maaa 144,240,32
buffer_load_dwordx4 v4, s[8:11], s48 offen offset:0 lds
Maaa 144,244,36
Maaa 148,248,32
Maaa 148,252,36
Ta 116,28,16384
Ta 118,28,18432
Maaa 152,240,40
buffer_load_dwordx4 v5, s[8:11], s49 offen offset:1024 lds
Maaa 152,244,44
Ta 120,29,0
Ta 122,29,2048
Maaa 156,248,40
Maaa 156,252,44
Ta 124,29,16384
s_waitcnt lgkmcnt(9)
Ta 126,29,18432
Maaa 160,240,48
buffer_load_dwordx4 v4, s[8:11], s50 offen offset:2048 lds
Maaa 160,244,52
Maaa 164,248,48
Maaa 164,252,52
Maaa 168,240,56
buffer_load_dwordx4 v5, s[8:11], s51 offen offset:3072 lds
Maaa 168,244,60
v_xor_b32 v2, 128, v2
v_xor_b32 v3, 128, v3
Maaa 172,248,56
s_waitcnt lgkmcnt(6)
buffer_load_dword v1, v47, s[60:63], 0 offen
v_xor_b32 v4, 128, v4
v_xor_b32 v5, 128, v5
Maaa 172,252,60
s_waitcnt lgkmcnt(0)
s_mul_i32 vcc_lo, s59, 7
v_xor_b32 v47, vcc_lo, v47
Mvaa 48,224,64
buffer_load_dword v44, v45, s[16:19], s47 offen
Mvaa 48,228,68
s_add_u32 s47, s47, 2097152
v_lshrrev_b32 v32, 4, v0
v_and_b32 v33, 15, v0
Mvaa 52,232,64
s_lshl_b32 s3, s32, 4
v_add_u32 v34, s3, v32
v_lshlrev_b32_e64 v36, 1, v32
Mvaa 52,236,68
Ra 240,12,4096
Mvaa 56,224,72
v_xor_b32 v36, v36, v33
v_xor_b32 v37, 8, v36
Mvaa 56,228,76
Mvaa 60,232,72
Mvaa 60,236,76
Ra 244,13,4096
Mvaa 64,224,80
s_getpc_b64 s[6:7]
L_cpf3:
s_add_u32 s6, s6, (L_phase2-L_cpf3)&0xffffffff
s_addc_u32 s7, s7, ((L_phase2-L_cpf3)>>32)&0xffffffff
Mvaa 64,228,84
s_lshr_b32 s3, s2, 3
s_lshl_b32 s3, s3, 2
s_add_u32 s3, s3, s32
Mvaa 68,232,80
s_lshl_b32 s3, s3, 10
v_and_b32 v42, 7, v0
v_lshlrev_b32_e64 v42, 7, v42
Mvaa 68,236,84
Ra 248,12,6144
Mvaa 72,224,88
v_add_u32_e64 v42, s3, v42
v_min_u32 v42, L_k2_fin-L_phase2-4, v42
Mvaa 72,228,92
v_mov_b32_e64 v41, s7
Mvaa 76,232,88
v_add_co_u32 v40, vcc, s6, v42
s_nop 1
v_addc_co_u32 v41, vcc, 0, v41, vcc
Mvaa 76,236,92
Ra 252,13,6144
Mvaa 80,224,96
global_load_dword v38, v[40:41], off
Mvaa 80,228,100
Mvaa 84,232,96
Mvaa 84,236,100
Mvaa 88,224,104
Mvaa 88,228,108
Mvaa 92,232,104
Mvaa 92,236,108
Mvaa 96,224,112
Mvaa 96,228,116
Mvaa 100,232,112
Mvaa 100,236,116
Mvaa 104,224,120
Mvaa 104,228,124
Mvaa 108,232,120
s_waitcnt lgkmcnt(0)
Mvaa 108,236,124
Mvaa 112,240,64
Mvaa 112,244,68
Mvaa 116,248,64
Mvaa 116,252,68
Ra 224,12,8192
Mvaa 120,240,72
Mvaa 120,244,76
Mvaa 124,248,72
Mvaa 124,252,76
Ra 228,13,8192
Mvaa 128,240,80
Mvaa 128,244,84
Mvaa 132,248,80
Mvaa 132,252,84
Ra 232,12,10240
Mvaa 136,240,88
Mvaa 136,244,92
Mvaa 140,248,88
Mvaa 140,252,92
Ra 236,13,10240
Mvaa 144,240,96
Mvaa 144,244,100
Mvaa 148,248,96
Mvaa 148,252,100
Mvaa 152,240,104
Mvaa 152,244,108
Mvaa 156,248,104
Mvaa 156,252,108
Mvaa 160,240,112
Mvaa 160,244,116
Mvaa 164,248,112
Mvaa 164,252,116
Mvaa 168,240,120
Mvaa 168,244,124
s_waitcnt vmcnt(11)
Mvaa 172,248,120
s_waitcnt lgkmcnt(0)
s_barrier
Mvaa 172,252,124
s_add_u32 m0, s57, 65536
Mvaa 176,224,64
buffer_load_dwordx4 v6, s[12:15], s52 offen offset:0 lds
Mvaa 176,228,68
Ta 0,16,0
Ta 2,16,2048
Mvaa 180,232,64
Mvaa 180,236,68
Ra 240,12,12288
Mvaa 184,224,72
buffer_load_dwordx4 v7, s[12:15], s53 offen offset:1024 lds
Mvaa 184,228,76
Ta 4,16,16384
Ta 6,16,18432
Mvaa 188,232,72
Mvaa 188,236,76
Ra 244,13,12288
Mvaa 192,224,80
buffer_load_dwordx4 v6, s[12:15], s54 offen offset:2048 lds
Mvaa 192,228,84
Ta 8,17,0
Ta 10,17,2048
Mvaa 196,232,80
Mvaa 196,236,84
Ra 248,12,14336
Mvaa 200,224,88
buffer_load_dwordx4 v7, s[12:15], s55 offen offset:3072 lds
Mvaa 200,228,92
Ta 12,17,16384
Ta 14,17,18432
Mvaa 204,232,88
Mvaa 204,236,92
s_add_u32 m0, s57, 69632
Ra 252,13,14336
Mvaa 208,224,96
buffer_load_dwordx4 v8, s[12:15], s52 offen offset:0 lds
Mvaa 208,228,100
Mvaa 212,232,96
Mvaa 212,236,100
Ta 16,18,0
Ta 18,18,2048
Mvaa 216,224,104
buffer_load_dwordx4 v9, s[12:15], s53 offen offset:1024 lds
Mvaa 216,228,108
Ta 20,18,16384
s_waitcnt lgkmcnt(9)
Ta 22,18,18432
Mvaa 220,232,104
Mvaa 220,236,108
Ta 24,19,0
Ta 26,19,2048
Mvaa 224,224,112
buffer_load_dwordx4 v8, s[12:15], s54 offen offset:2048 lds
Mvaa 224,228,116
Mvaa 228,232,112
Mvaa 228,236,116
Ta 28,19,16384
Ta 30,19,18432
Mvaa 232,224,120
buffer_load_dwordx4 v9, s[12:15], s55 offen offset:3072 lds
Mvaa 232,228,124
s_waitcnt vmcnt(11)
Ta 32,20,0
s_waitcnt lgkmcnt(9)
Ta 34,20,2048
Mvaa 236,232,120
s_barrier
Mvaa 236,236,124
s_add_u32 m0, s56, 65536
Ta 36,20,16384
Ta 38,20,18432
Mvaa 240,240,64
buffer_load_dwordx4 v2, s[8:11], s48 offen offset:0 lds
Mvaa 240,244,68
Mvaa 244,248,64
Mvaa 244,252,68
Ra 224,10,0
Mvaa 248,240,72
buffer_load_dwordx4 v3, s[8:11], s49 offen offset:1024 lds
Mvaa 248,244,76
Ta 40,21,0
Ta 42,21,2048
Mvaa 252,248,72
Mvaa 252,252,76
s_waitcnt lgkmcnt(9)
Ra 228,11,0
Maaa 128,240,80
buffer_load_dwordx4 v2, s[8:11], s50 offen offset:2048 lds
Maaa 128,244,84
Ta 44,21,16384
Ta 46,21,18432
Maaa 132,248,80
Maaa 132,252,84
Ra 232,10,2048
Maaa 136,240,88
buffer_load_dwordx4 v3, s[8:11], s51 offen offset:3072 lds
Maaa 136,244,92
Ta 48,22,0
Ta 50,22,2048
Maaa 140,248,88
Maaa 140,252,92
s_add_u32 m0, s56, 69632
s_waitcnt lgkmcnt(9)
Ra 236,11,2048
Maaa 144,240,96
buffer_load_dwordx4 v4, s[8:11], s48 offen offset:0 lds
Maaa 144,244,100
Maaa 148,248,96
Maaa 148,252,100
Ta 52,22,16384
Ta 54,22,18432
Maaa 152,240,104
buffer_load_dwordx4 v5, s[8:11], s49 offen offset:1024 lds
Maaa 152,244,108
Ta 56,23,0
Ta 58,23,2048
Maaa 156,248,104
Maaa 156,252,108
Ta 60,23,16384
s_waitcnt lgkmcnt(9)
Ta 62,23,18432
Maaa 160,240,112
buffer_load_dwordx4 v4, s[8:11], s50 offen offset:2048 lds
Maaa 160,244,116
Maaa 164,248,112
Maaa 164,252,116
Maaa 168,240,120
buffer_load_dwordx4 v5, s[8:11], s51 offen offset:3072 lds
Maaa 168,244,124
Maaa 172,248,120
s_waitcnt lgkmcnt(6)
Maaa 172,252,124
s_waitcnt lgkmcnt(0)
Mvaa 48,224,0
buffer_load_dword v1, v31, s[28:31], s37 offen sc1
Mvaa 48,228,4
s_mov_b32 s8, s16
s_mov_b32 s9, s17
s_mov_b32 s10, s18
Mvaa 52,232,0
s_add_u32 s16, s66, 46137344
s_addc_u32 s17, s67, 0
s_and_b32 s17, s17, 0xffff
Mvaa 52,236,4
Ra 240,10,4096
Mvaa 56,224,8
s_mov_b32 s18, 16777216
s_mov_b32 s19, 0x20000
s_mov_b32 s48, 0
Mvaa 56,228,12
s_mov_b32 s49, 31744
s_mov_b32 s50, 63488
s_mov_b32 s51, 95232
Mvaa 60,232,8
v_lshlrev_b32 v35, 13, v34
Mvaa 60,236,12
Ra 244,11,4096
Mvaa 64,224,16
s_and_b32 s52, s33, 0
s_lshl_b32 s3, s52, 19
s_lshl_b32 s52, s52, 11
Mvaa 64,228,20
s_add_u32 s53, s52, s58
v_add_u32_e64 v35, s3, v35
v_lshl_add_u32 v8, v36, 4, v35
Mvaa 68,232,16
v_lshl_add_u32 v9, v37, 4, v35
v_lshlrev_b32_e64 v2, 4, v0
Mvaa 68,236,20
Ra 248,10,6144
Mvaa 72,224,24
v_add_u32 v3, 65536, v2
v_add_u32_e64 v4, s44, v2
Mvaa 72,228,28
v_mov_b32 v7, 0
v_lshlrev_b32 v35, 2, v32
Mvaa 76,232,24
v_sub_u32_e64 v35, v33, v35
Mvaa 76,236,28
Ra 252,11,6144
Mvaa 80,224,32
s_lshl_b32 s3, s32, 4
v_add_u32 v5, s3, v35
Mvaa 80,228,36
s_sub_u32 s3, 48, s3
v_add_u32 v6, s3, v35
Mvaa 84,232,32
s_mul_i32 s3, s33, 1116160
s_add_u32 s3, s3, 8388608
s_add_u32 s12, s66, s3
s_addc_u32 s13, s67, 0
s_and_b32 s13, s13, 0xffff
Mvaa 84,236,36
s_mov_b32 s14, 0
s_mov_b32 s15, 0x20000
s_mul_i32 s14, s36, 34816
Mvaa 88,224,40
buffer_load_dword v44, v45, s[8:11], s47 offen
Mvaa 88,228,44
s_add_u32 s47, s47, 2097152
v_lshrrev_b32 v42, 2, v33
v_lshl_add_u32 v43, v32, 3, v42
Mvaa 92,232,40
v_lshlrev_b32 v43, 8, v43
v_and_b32 v46, 3, v0
Mvaa 92,236,44
v_lshl_add_u32 v43, v46, 3, v43
v_and_b32_e64 v46, 1, v32
Mvaa 96,224,48
v_lshl_add_u32 v42, v46, 2, v42
v_lshl_add_u32 v16, v42, 5, v43
Mvaa 96,228,52
v_xor_b32 v17, 32, v16
v_xor_b32 v18, 64, v16
Mvaa 100,232,48
v_xor_b32 v19, 96, v16
v_xor_b32 v20, 128, v16
Mvaa 100,236,52
v_xor_b32 v21, 160, v16
v_xor_b32 v22, 192, v16
Mvaa 104,224,56
v_xor_b32 v23, 224, v16
Mvaa 104,228,60
Mvaa 108,232,56
s_waitcnt lgkmcnt(0)
Mvaa 108,236,60
Mvaa 112,240,0
Mvaa 112,244,4
Mvaa 116,248,0
Mvaa 116,252,4
Ra 224,10,8192
Mvaa 120,240,8
Mvaa 120,244,12
Mvaa 124,248,8
Mvaa 124,252,12
Ra 228,11,8192
Mvaa 128,240,16
Mvaa 128,244,20
Mvaa 132,248,16
Mvaa 132,252,20
Ra 232,10,10240
Mvaa 136,240,24
Mvaa 136,244,28
Mvaa 140,248,24
Mvaa 140,252,28
Ra 236,11,10240
Mvaa 144,240,32
Mvaa 144,244,36
Mvaa 148,248,32
Mvaa 148,252,36
Mvaa 152,240,40
Mvaa 152,244,44
Mvaa 156,248,40
Mvaa 156,252,44
Mvaa 160,240,48
Mvaa 160,244,52
Mvaa 164,248,48
Mvaa 164,252,52
Mvaa 168,240,56
Mvaa 168,244,60
s_waitcnt vmcnt(10)
Mvaa 172,248,56
s_waitcnt lgkmcnt(0)
s_barrier
Mvaa 172,252,60
s_add_u32 m0, s44, 0
Mvaa 176,224,0
buffer_load_dwordx4 v8, s[8:11], s48 offen offset:0 lds
Mvaa 176,228,4
Ta 64,14,0
Ta 66,14,2048
Mvaa 180,232,0
Mvaa 180,236,4
Ra 240,10,12288
Mvaa 184,224,8
buffer_load_dwordx4 v8, s[8:11], s49 offen offset:1024 lds
Mvaa 184,228,12
Ta 68,14,16384
Ta 70,14,18432
Mvaa 188,232,8
Mvaa 188,236,12
Ra 244,11,12288
Mvaa 192,224,16
buffer_load_dwordx4 v9, s[8:11], s50 offen offset:2048 lds
Mvaa 192,228,20
Ta 72,15,0
Ta 74,15,2048
Mvaa 196,232,16
Mvaa 196,236,20
Ra 248,10,14336
Mvaa 200,224,24
buffer_load_dwordx4 v9, s[8:11], s51 offen offset:3072 lds
Mvaa 200,228,28
Ta 76,15,16384
Ta 78,15,18432
Mvaa 204,232,24
v_xor_b32 v8, 524288, v8
v_xor_b32 v9, 524288, v9
Mvaa 204,236,28
s_add_u32 m0, s44, 16384
Ra 252,11,14336
Mvaa 208,224,32
buffer_load_dwordx4 v8, s[8:11], s48 offen offset:0 lds
Mvaa 208,228,36
Mvaa 212,232,32
Mvaa 212,236,36
Ta 80,24,0
Ta 82,24,2048
Mvaa 216,224,40
buffer_load_dwordx4 v8, s[8:11], s49 offen offset:1024 lds
Mvaa 216,228,44
Ta 84,24,16384
s_waitcnt lgkmcnt(9)
Ta 86,24,18432
Mvaa 220,232,40
Mvaa 220,236,44
Ta 88,25,0
Ta 90,25,2048
Mvaa 224,224,48
buffer_load_dwordx4 v9, s[8:11], s50 offen offset:2048 lds
Mvaa 224,228,52
Mvaa 228,232,48
s_mul_i32 s3, s45, 33792
v_add_u32_e64 v10, s3, v2
Mvaa 228,236,52
Ta 92,25,16384
Ta 94,25,18432
Mvaa 232,224,56
buffer_load_dwordx4 v9, s[8:11], s51 offen offset:3072 lds
Mvaa 232,228,60
s_waitcnt vmcnt(10)
Ta 96,26,0
s_waitcnt lgkmcnt(9)
Ta 98,26,2048
Mvaa 236,232,56
s_barrier
v_xor_b32 v8, 1572864, v8
v_xor_b32 v9, 1572864, v9
Mvaa 236,236,60
s_add_u32 m0, s44, 32768
Ta 100,26,16384
Ta 102,26,18432
Mvaa 240,240,0
buffer_load_dwordx4 v8, s[8:11], s48 offen offset:0 lds
Mvaa 240,244,4
s_mul_i32 s3, s46, 33792
v_add_u32 v11, s3, v2
Mvaa 244,248,0
Mvaa 244,252,4
Ra 224,12,0
Mvaa 248,240,8
buffer_load_dwordx4 v8, s[8:11], s49 offen offset:1024 lds
Mvaa 248,244,12
Ta 104,27,0
Ta 106,27,2048
Mvaa 252,248,8
Mvaa 252,252,12
s_waitcnt lgkmcnt(9)
Ra 228,13,0
Maaa 128,240,16
buffer_load_dwordx4 v9, s[8:11], s50 offen offset:2048 lds
Maaa 128,244,20
Ta 108,27,16384
Ta 110,27,18432
Maaa 132,248,16
Maaa 132,252,20
Ra 232,12,2048
Maaa 136,240,24
buffer_load_dwordx4 v9, s[8:11], s51 offen offset:3072 lds
Maaa 136,244,28
Ta 112,28,0
Ta 114,28,2048
Maaa 140,248,24
v_xor_b32 v8, 524288, v8
v_xor_b32 v9, 524288, v9
Maaa 140,252,28
s_add_u32 m0, s44, 49152
s_waitcnt lgkmcnt(9)
Ra 236,13,2048
Maaa 144,240,32
buffer_load_dwordx4 v8, s[8:11], s48 offen offset:0 lds
Maaa 144,244,36
Maaa 148,248,32
Maaa 148,252,36
Ta 116,28,16384
Ta 118,28,18432
Maaa 152,240,40
buffer_load_dwordx4 v8, s[8:11], s49 offen offset:1024 lds
Maaa 152,244,44
Ta 120,29,0
Ta 122,29,2048
Maaa 156,248,40
Maaa 156,252,44
Ta 124,29,16384
s_waitcnt lgkmcnt(9)
Ta 126,29,18432
Maaa 160,240,48
buffer_load_dwordx4 v9, s[8:11], s50 offen offset:2048 lds
Maaa 160,244,52
Maaa 164,248,48
Maaa 164,252,52
Maaa 168,240,56
buffer_load_dwordx4 v9, s[8:11], s51 offen offset:3072 lds
Maaa 168,244,60
v_xor_b32 v8, 3670016, v8
v_xor_b32 v9, 3670016, v9
Maaa 172,248,56
s_waitcnt lgkmcnt(6)
Maaa 172,252,60
s_waitcnt lgkmcnt(0)
Mvaa 48,224,64
v_mov_b32 v14, v40
v_mov_b32_e64 v15, v41
Mvaa 48,228,68
Mvaa 52,232,64
Mvaa 52,236,68
Ra 240,12,4096
Mvaa 56,224,72
Mvaa 56,228,76
Mvaa 60,232,72
Mvaa 60,236,76
Ra 244,13,4096
Mvaa 64,224,80
Vc 24,48,49
Vc 25,50,51
Mvaa 64,228,84
Vc 26,52,53
Vc 27,54,55
Mvaa 68,232,80
Mvaa 68,236,84
Ra 248,12,6144
Mvaa 72,224,88
Vc 28,56,57
Vc 29,58,59
Mvaa 72,228,92
Vc 30,60,61
Vc 31,62,63
Mvaa 76,232,88
Mvaa 76,236,92
Ra 252,13,6144
Mvaa 80,224,96
Vc 32,64,65
Vc 33,66,67
Mvaa 80,228,100
Vc 34,68,69
Vc 35,70,71
Mvaa 84,232,96
Mvaa 84,236,100
Mvaa 88,224,104
Vc 36,72,73
Vc 37,74,75
Mvaa 88,228,108
Vc 38,76,77
Vc 39,78,79
Mvaa 92,232,104
Mvaa 92,236,108
Mvaa 96,224,112
Vc 40,80,81
Vc 41,82,83
Mvaa 96,228,116
Vc 42,84,85
Vc 43,86,87
Mvaa 100,232,112
s_waitcnt vmcnt(12)
Mvaa 100,236,116
s_add_u32 s59, s38, 0
Mvaa 104,224,120
v_readfirstlane_b32 s3, v1
s_nop 0
s_or_b32 s3, s3, s37
s_cmp_lt_u32 s3, 256
s_cbranch_scc1 L_spinAv
L_spinArv:
s_barrier
Mvaa 104,228,124
buffer_store_dwordx4 v[24:27], v2, s[24:27], s59 offen offset:0 sc1
Mvaa 108,232,120
s_waitcnt lgkmcnt(0)
Mvaa 108,236,124
Vc 44,88,89
Vc 45,90,91
Mvaa 112,240,64
buffer_load_dwordx4 a[0:3], v10, s[20:23], s53 offen offset:0 sc1
Mvaa 112,244,68
Vc 46,92,93
Vc 47,94,95
Mvaa 116,248,64
Vc 48,96,97
Vc 49,98,99
Mvaa 116,252,68
Ra 224,12,8192
Mvaa 120,240,72
Vc 50,100,101
Vc 51,102,103
Mvaa 120,244,76
Vc 52,104,105
Vc 53,106,107
Mvaa 124,248,72
buffer_load_dwordx4 a[4:7], v10, s[20:23], s52 offen offset:0 sc1
Mvaa 124,252,76
Ra 228,13,8192
Mvaa 128,240,80
Vc 54,108,109
Vc 55,110,111
Mvaa 128,244,84
Vc 56,112,113
Vc 57,114,115
Mvaa 132,248,80
Vc 58,116,117
Vc 59,118,119
Mvaa 132,252,84
Ra 232,12,10240
Mvaa 136,240,88
buffer_load_dwordx4 a[8:11], v11, s[20:23], s53 offen offset:0 sc1
Mvaa 136,244,92
buffer_store_dwordx4 v[28:31], v2, s[24:27], s59 offen offset:1024 sc1
Mvaa 140,248,88
Vc 60,120,121
Vc 61,122,123
Mvaa 140,252,92
Ra 236,13,10240
Mvaa 144,240,96
Vc 62,124,125
Vc 63,126,127
Mvaa 144,244,100
Vc 64,128,129
Vc 65,130,131
Mvaa 148,248,96
buffer_load_dwordx4 a[12:15], v11, s[20:23], s52 offen offset:0 sc1
Mvaa 148,252,100
Vc 66,132,133
Vc 67,134,135
Mvaa 152,240,104
Vc 68,136,137
Vc 69,138,139
Mvaa 152,244,108
Vc 70,140,141
Vc 71,142,143
Mvaa 156,248,104
Mvaa 156,252,108
Mvaa 160,240,112
buffer_load_dwordx4 a[16:19], v10, s[20:23], s53 offen offset:1024 sc1
Mvaa 160,244,116
Vc 72,144,145
Vc 73,146,147
Mvaa 164,248,112
Vc 74,148,149
Vc 75,150,151
Mvaa 164,252,116
buffer_store_dwordx4 v[32:35], v2, s[24:27], s59 offen offset:2048 sc1
Mvaa 168,240,120
Vc 76,152,153
Vc 77,154,155
Mvaa 168,244,124
Vc 78,156,157
Vc 79,158,159
Mvaa 172,248,120
s_waitcnt lgkmcnt(0)
buffer_load_dwordx4 a[20:23], v10, s[20:23], s52 offen offset:1024 sc1
Mvaa 172,252,124
Mvaa 176,224,64
Vc 80,160,161
Vc 81,162,163
Mvaa 176,228,68
Vc 82,164,165
Vc 83,166,167
Mvaa 180,232,64
Mvaa 180,236,68
Ra 240,12,12288
Mvaa 184,224,72
buffer_load_dwordx4 a[24:27], v11, s[20:23], s53 offen offset:1024 sc1
Mvaa 184,228,76
Vc 84,168,169
Vc 85,170,171
Mvaa 188,232,72
Vc 86,172,173
Vc 87,174,175
Mvaa 188,236,76
Ra 244,13,12288
Mvaa 192,224,80
Vc 88,176,177
Vc 89,178,179
Mvaa 192,228,84
Vc 90,180,181
Vc 91,182,183
Mvaa 196,232,80
buffer_load_dwordx4 a[28:31], v11, s[20:23], s52 offen offset:1024 sc1
Mvaa 196,236,84
Ra 248,12,14336
s_xor_b32 s52, s52, 2048
Mvaa 200,224,88
s_add_u32 s53, s52, s58
Mvaa 200,228,92
Vc 92,184,185
Vc 93,186,187
Mvaa 204,232,88
Vc 94,188,189
Vc 95,190,191
Mvaa 204,236,92
Ra 252,13,14336
Mvaa 208,224,96
buffer_load_dwordx4 a[32:35], v10, s[20:23], s53 offen offset:0 sc1
Mvaa 208,228,100
buffer_store_dwordx4 v[36:39], v2, s[24:27], s59 offen offset:3072 sc1
Mvaa 212,232,96
Vc 96,192,193
Vc 97,194,195
Mvaa 212,236,100
Vc 98,196,197
Vc 99,198,199
Mvaa 216,224,104
Vc 100,200,201
Vc 101,202,203
Mvaa 216,228,108
Vc 102,204,205
Vc 103,206,207
Mvaa 220,232,104
buffer_load_dwordx4 a[36:39], v10, s[20:23], s52 offen offset:0 sc1
Mvaa 220,236,108
Mvaa 224,224,112
Vc 104,208,209
Vc 105,210,211
Mvaa 224,228,116
Vc 106,212,213
Vc 107,214,215
Mvaa 228,232,112
Mvaa 228,236,116
Mvaa 232,224,120
buffer_load_dwordx4 a[40:43], v11, s[20:23], s53 offen offset:0 sc1
Mvaa 232,228,124
Vc 108,216,217
Vc 109,218,219
Mvaa 236,232,120
s_waitcnt lgkmcnt(0)
Mvaa 236,236,124
Vc 110,220,221
Vc 111,222,223
Mvaa 240,240,64
s_add_u32 s59, s38, 4096
Mvaa 240,244,68
buffer_store_dwordx4 v[40:43], v2, s[24:27], s59 offen offset:0 sc1
Mvaa 244,248,64
buffer_load_dwordx4 a[44:47], v11, s[20:23], s52 offen offset:0 sc1
Mvaa 244,252,68
Vc 112,224,225
Vc 113,226,227
Mvaa 248,240,72
Vc 114,228,229
Vc 115,230,231
Mvaa 248,244,76
Vc 116,232,233
Vc 117,234,235
Mvaa 252,248,72
Vc 118,236,237
Vc 119,238,239
Mvaa 252,252,76
Maaa 128,240,80
buffer_load_dwordx4 a[48:51], v10, s[20:23], s53 offen offset:1024 sc1
Maaa 128,244,84
Ta 192,16,0
Ta 194,16,1024
Maaa 132,248,80
Vc 120,240,241
Vc 121,242,243
Maaa 132,252,84
Ta 196,17,0
Ta 198,17,1024
Maaa 136,240,88
Vc 122,244,245
Vc 123,246,247
Maaa 136,244,92
Ta 200,18,0
Ta 202,18,1024
Maaa 140,248,88
buffer_load_dwordx4 a[52:55], v10, s[20:23], s52 offen offset:1024 sc1
Maaa 140,252,92
Ta 204,19,0
Ta 206,19,1024
Maaa 144,240,96
Vc 124,248,249
Vc 125,250,251
Maaa 144,244,100
Ta 208,20,0
Ta 210,20,1024
Maaa 148,248,96
Vc 126,252,253
Vc 127,254,255
Maaa 148,252,100
Ta 212,21,0
Ta 214,21,1024
Maaa 152,240,104
buffer_load_dwordx4 a[56:59], v11, s[20:23], s53 offen offset:1024 sc1
Maaa 152,244,108
Ta 216,22,0
Ta 218,22,1024
Maaa 156,248,104
buffer_store_dwordx4 v[44:47], v2, s[24:27], s59 offen offset:1024 sc1
Maaa 156,252,108
Ta 220,23,0
s_waitcnt lgkmcnt(9)
Ta 222,23,1024
Maaa 160,240,112
Maaa 160,244,116
Maaa 164,248,112
buffer_load_dwordx4 a[60:63], v11, s[20:23], s52 offen offset:1024 sc1
Maaa 164,252,116
s_xor_b32 s52, s52, 6144
s_add_u32 s53, s52, s58
Maaa 168,240,120
Maaa 168,244,124
Maaa 172,248,120
Maaa 172,252,124
L_phase2:
s_nop 7
s_waitcnt vmcnt(16) lgkmcnt(0)
Zvaa 128,192,0
buffer_store_dwordx4 v[48:51], v2, s[24:27], s59 offen offset:2048 sc1
Zvaa 160,192,4
Ta 224,16,8192
Ta 226,16,9216
Zvaa 192,192,8
buffer_load_dwordx4 a[64:67], v10, s[20:23], s53 offen offset:0 sc1
Zvaa 224,192,12
s_mov_b32 s60, s40
s_and_b32 s61, s41, 0xffff
s_mov_b32 s62, 7340032
Zvaa 132,196,0
Ta 228,17,8192
Ta 230,17,9216
Zvaa 164,196,4
buffer_load_dwordx4 a[68:71], v10, s[20:23], s52 offen offset:0 sc1
Zvaa 196,196,8
s_mov_b32 s63, 0x20000
Zvaa 228,196,12
Ta 232,18,8192
Ta 234,18,9216
Zvaa 136,200,0
global_load_dword v13, v[14:15], off
Zvaa 168,200,4
buffer_load_dwordx4 a[72:75], v11, s[20:23], s53 offen offset:0 sc1
Zvaa 200,200,8
Ta 236,19,8192
Ta 238,19,9216
Zvaa 232,200,12
Zvaa 140,204,0
buffer_load_dwordx4 a[76:79], v11, s[20:23], s52 offen offset:0 sc1
Zvaa 172,204,4
Ta 240,20,8192
Ta 242,20,9216
Zvaa 204,204,8
Zvaa 236,204,12
Zvaa 144,208,0
s_waitcnt lgkmcnt(6)
Ta 244,21,8192
Ta 246,21,9216
Zvaa 176,208,4
buffer_load_dwordx4 a[80:83], v10, s[20:23], s53 offen offset:1024 sc1
Zvaa 208,208,8
Zvaa 240,208,12
Ta 248,22,8192
Ta 250,22,9216
Zvaa 148,212,0
buffer_load_dwordx4 a[84:87], v10, s[20:23], s52 offen offset:1024 sc1
Zvaa 180,212,4
Zvaa 212,212,8
Ta 252,23,8192
Ta 254,23,9216
Zvaa 244,212,12
Zvaa 152,216,0
buffer_load_dwordx4 a[88:91], v11, s[20:23], s53 offen offset:1024 sc1
Zvaa 184,216,4
Zvaa 216,216,8
buffer_load_dwordx4 a[92:95], v11, s[20:23], s52 offen offset:1024 sc1
Zvaa 248,216,12
s_xor_b32 s52, s52, 2048
s_add_u32 s53, s52, s58
Zvaa 156,220,0
buffer_store_dwordx4 v[52:55], v2, s[24:27], s59 offen offset:3072 sc1
Zvaa 188,220,4
Zvaa 220,220,8
s_waitcnt vmcnt(22) lgkmcnt(0)
Zvaa 252,220,12
s_barrier
Mvaa 128,224,16
Mvaa 160,224,20
s_add_u32 m0, s44, 0
Ta 192,16,16384
Ta 194,16,17408
Mvaa 192,224,24
buffer_load_dwordx4 v8, s[8:11], s48 offen offset:0 lds
Mvaa 224,224,28
Mvaa 132,228,16
Ta 196,17,16384
Ta 198,17,17408
Mvaa 164,228,20
Mvaa 196,228,24
buffer_load_dwordx4 v8, s[8:11], s49 offen offset:1024 lds
Mvaa 228,228,28
Ta 200,18,16384
Ta 202,18,17408
Mvaa 136,232,16
Mvaa 168,232,20
Mvaa 200,232,24
Ta 204,19,16384
Ta 206,19,17408
Mvaa 232,232,28
buffer_load_dwordx4 a[96:99], v10, s[20:23], s53 offen offset:0 sc1
Mvaa 140,236,16
Mvaa 172,236,20
Ta 208,20,16384
Ta 210,20,17408
Mvaa 204,236,24
Mvaa 236,236,28
Mvaa 144,240,16
s_waitcnt lgkmcnt(6)
Ta 212,21,16384
Ta 214,21,17408
Mvaa 176,240,20
buffer_load_dwordx4 a[100:103], v10, s[20:23], s52 offen offset:0 sc1
Mvaa 208,240,24
Mvaa 240,240,28
Ta 216,22,16384
Ta 218,22,17408
Mvaa 148,244,16
Mvaa 180,244,20
buffer_load_dwordx4 a[104:107], v11, s[20:23], s53 offen offset:0 sc1
Mvaa 212,244,24
Ta 220,23,16384
Ta 222,23,17408
Mvaa 244,244,28
s_add_u32 s59, s38, 8192
Mvaa 152,248,16
buffer_store_dwordx4 v[56:59], v2, s[24:27], s59 offen offset:0 sc1
Mvaa 184,248,20
buffer_load_dwordx4 a[108:111], v11, s[20:23], s52 offen offset:0 sc1
Mvaa 216,248,24
Ar 48,128
Ar 49,129
Mvaa 248,248,28
Ar 50,130
Ar 51,131
Mvaa 156,252,16
Ar 52,132
Ar 53,133
Mvaa 188,252,20
Ar 54,134
Ar 55,135
Mvaa 220,252,24
s_waitcnt vmcnt(23) lgkmcnt(0)
Vc 24,48,49
Vc 25,50,51
Mvaa 252,252,28
Vc 26,52,53
Vc 27,54,55
Mvaa 128,192,32
Mvaa 160,192,36
Ta 224,16,24576
Ta 226,16,25600
Mvaa 192,192,40
buffer_load_dwordx4 v9, s[8:11], s50 offen offset:2048 lds
Mvaa 224,192,44
Mvaa 132,196,32
Ta 228,17,24576
Ta 230,17,25600
Mvaa 164,196,36
Mvaa 196,196,40
buffer_load_dwordx4 v9, s[8:11], s51 offen offset:3072 lds
Mvaa 228,196,44
Ta 232,18,24576
Ta 234,18,25600
Mvaa 136,200,32
v_xor_b32 v8, 524288, v8
v_xor_b32 v9, 524288, v9
Mvaa 168,200,36
Mvaa 200,200,40
Ta 236,19,24576
Ta 238,19,25600
Mvaa 232,200,44
buffer_load_dwordx4 a[112:115], v10, s[20:23], s53 offen offset:1024 sc1
Mvaa 140,204,32
Mvaa 172,204,36
Ta 240,20,24576
Ta 242,20,25600
Mvaa 204,204,40
Mvaa 236,204,44
Mvaa 144,208,32
s_waitcnt lgkmcnt(6)
Ta 244,21,24576
Ta 246,21,25600
Mvaa 176,208,36
buffer_load_dwordx4 a[116:119], v10, s[20:23], s52 offen offset:1024 sc1
Mvaa 208,208,40
buffer_store_dwordx4 v[60:63], v2, s[24:27], s59 offen offset:1024 sc1
Mvaa 240,208,44
Ta 248,22,24576
Ta 250,22,25600
Mvaa 148,212,32
Ar 48,136
Ar 49,137
Mvaa 180,212,36
buffer_load_dwordx4 a[120:123], v11, s[20:23], s53 offen offset:1024 sc1
Mvaa 212,212,40
Ta 252,23,24576
Ta 254,23,25600
Mvaa 244,212,44
Ar 50,138
Ar 51,139
Mvaa 152,216,32
Ar 52,140
Ar 53,141
Mvaa 184,216,36
buffer_load_dwordx4 a[124:127], v11, s[20:23], s52 offen offset:1024 sc1
Mvaa 216,216,40
s_xor_b32 s52, s52, 14336
s_add_u32 s53, s52, s58
Mvaa 248,216,44
Ar 54,142
Ar 55,143
Mvaa 156,220,32
Vc 28,48,49
Vc 29,50,51
Mvaa 188,220,36
Vc 30,52,53
Vc 31,54,55
Mvaa 220,220,40
s_waitcnt vmcnt(25) lgkmcnt(0)
Mvaa 252,220,44
s_barrier
Mvaa 128,224,48
Mvaa 160,224,52
s_add_u32 m0, s44, 16384
Ta 192,16,32768
Ta 194,16,33792
Mvaa 192,224,56
buffer_load_dwordx4 v8, s[8:11], s48 offen offset:0 lds
Mvaa 224,224,60
Mvaa 132,228,48
Ta 196,17,32768
Ta 198,17,33792
Mvaa 164,228,52
Mvaa 196,228,56
buffer_load_dwordx4 v8, s[8:11], s49 offen offset:1024 lds
Mvaa 228,228,60
Ta 200,18,32768
Ta 202,18,33792
Mvaa 136,232,48
Mvaa 168,232,52
Mvaa 200,232,56
Ta 204,19,32768
Ta 206,19,33792
Mvaa 232,232,60
buffer_load_dwordx4 a[0:3], v10, s[20:23], s53 offen offset:0 sc1
Mvaa 140,236,48
buffer_store_dwordx4 v[64:67], v2, s[24:27], s59 offen offset:2048 sc1
Mvaa 172,236,52
Ta 208,20,32768
Ta 210,20,33792
Mvaa 204,236,56
Ar 48,144
Ar 49,145
Mvaa 236,236,60
Ar 50,146
Ar 51,147
Mvaa 144,240,48
s_waitcnt lgkmcnt(6)
Ta 212,21,32768
Ta 214,21,33792
Mvaa 176,240,52
buffer_load_dwordx4 a[4:7], v10, s[20:23], s52 offen offset:0 sc1
Mvaa 208,240,56
Ar 52,148
Ar 53,149
Mvaa 240,240,60
Ta 216,22,32768
Ta 218,22,33792
Mvaa 148,244,48
Ar 54,150
Ar 55,151
Mvaa 180,244,52
buffer_load_dwordx4 a[8:11], v11, s[20:23], s53 offen offset:0 sc1
Mvaa 212,244,56
Ta 220,23,32768
Ta 222,23,33792
Mvaa 244,244,60
Vc 32,48,49
Vc 33,50,51
Mvaa 152,248,48
Vc 34,52,53
Vc 35,54,55
Mvaa 184,248,52
buffer_load_dwordx4 a[12:15], v11, s[20:23], s52 offen offset:0 sc1
Mvaa 216,248,56
Mvaa 248,248,60
Mvaa 156,252,48
Mvaa 188,252,52
Mvaa 220,252,56
s_waitcnt vmcnt(26) lgkmcnt(0)
Mvaa 252,252,60
Mvaa 128,192,64
Mvaa 160,192,68
Ta 224,16,40960
Ta 226,16,41984
Mvaa 192,192,72
buffer_load_dwordx4 v9, s[8:11], s50 offen offset:2048 lds
Mvaa 224,192,76
Mvaa 132,196,64
Ta 228,17,40960
Ta 230,17,41984
Mvaa 164,196,68
Mvaa 196,196,72
buffer_load_dwordx4 v9, s[8:11], s51 offen offset:3072 lds
Mvaa 228,196,76
Ta 232,18,40960
Ta 234,18,41984
Mvaa 136,200,64
v_xor_b32 v8, 1572864, v8
v_xor_b32 v9, 1572864, v9
Mvaa 168,200,68
buffer_store_dwordx4 v[68:71], v2, s[24:27], s59 offen offset:3072 sc1
Mvaa 200,200,72
Ta 236,19,40960
Ta 238,19,41984
Mvaa 232,200,76
buffer_load_dwordx4 a[16:19], v10, s[20:23], s53 offen offset:1024 sc1
Mvaa 140,204,64
Ar 48,152
Ar 49,153
Mvaa 172,204,68
Ta 240,20,40960
Ta 242,20,41984
Mvaa 204,204,72
Ar 50,154
Ar 51,155
Mvaa 236,204,76
Ar 52,156
Ar 53,157
Mvaa 144,208,64
s_waitcnt lgkmcnt(6)
Ta 244,21,40960
Ta 246,21,41984
Mvaa 176,208,68
buffer_load_dwordx4 a[20:23], v10, s[20:23], s52 offen offset:1024 sc1
Mvaa 208,208,72
Ar 54,158
Ar 55,159
Mvaa 240,208,76
Ta 248,22,40960
Ta 250,22,41984
Mvaa 148,212,64
Vc 36,48,49
Vc 37,50,51
Mvaa 180,212,68
buffer_load_dwordx4 a[24:27], v11, s[20:23], s53 offen offset:1024 sc1
Mvaa 212,212,72
Ta 252,23,40960
Ta 254,23,41984
Mvaa 244,212,76
Vc 38,52,53
Vc 39,54,55
Mvaa 152,216,64
Mvaa 184,216,68
buffer_load_dwordx4 a[28:31], v11, s[20:23], s52 offen offset:1024 sc1
Mvaa 216,216,72
s_xor_b32 s52, s52, 2048
s_add_u32 s53, s52, s58
Mvaa 248,216,76
Mvaa 156,220,64
Mvaa 188,220,68
Mvaa 220,220,72
s_waitcnt vmcnt(29) lgkmcnt(0)
Mvaa 252,220,76
s_barrier
Mvaa 128,224,80
s_add_u32 s59, s38, 12288
Mvaa 160,224,84
s_add_u32 m0, s44, 32768
Ta 192,16,49152
Ta 194,16,50176
Mvaa 192,224,88
buffer_load_dwordx4 v8, s[8:11], s48 offen offset:0 lds
Mvaa 224,224,92
buffer_store_dwordx4 v[72:75], v2, s[24:27], s59 offen offset:0 sc1
Mvaa 132,228,80
Ta 196,17,49152
Ta 198,17,50176
Mvaa 164,228,84
Ar 48,160
Ar 49,161
Mvaa 196,228,88
buffer_load_dwordx4 v8, s[8:11], s49 offen offset:1024 lds
Mvaa 228,228,92
Ta 200,18,49152
Ta 202,18,50176
Mvaa 136,232,80
Ar 50,162
Ar 51,163
Mvaa 168,232,84
Ar 52,164
Ar 53,165
Mvaa 200,232,88
Ta 204,19,49152
Ta 206,19,50176
Mvaa 232,232,92
buffer_load_dwordx4 a[32:35], v10, s[20:23], s53 offen offset:0 sc1
Mvaa 140,236,80
Ar 54,166
Ar 55,167
Mvaa 172,236,84
Ta 208,20,49152
Ta 210,20,50176
Mvaa 204,236,88
Vc 40,48,49
Vc 41,50,51
Mvaa 236,236,92
Vc 42,52,53
Vc 43,54,55
Mvaa 144,240,80
s_waitcnt lgkmcnt(6)
Ta 212,21,49152
Ta 214,21,50176
Mvaa 176,240,84
buffer_load_dwordx4 a[36:39], v10, s[20:23], s52 offen offset:0 sc1
Mvaa 208,240,88
global_load_dword v13, v[14:15], off
Mvaa 240,240,92
Ta 216,22,49152
Ta 218,22,50176
Mvaa 148,244,80
Mvaa 180,244,84
buffer_load_dwordx4 a[40:43], v11, s[20:23], s53 offen offset:0 sc1
Mvaa 212,244,88
Ta 220,23,49152
Ta 222,23,50176
Mvaa 244,244,92
Mvaa 152,248,80
Mvaa 184,248,84
buffer_load_dwordx4 a[44:47], v11, s[20:23], s52 offen offset:0 sc1
Mvaa 216,248,88
Mvaa 248,248,92
buffer_store_dwordx4 v[76:79], v2, s[24:27], s59 offen offset:1024 sc1
Mvaa 156,252,80
Ar 48,168
Ar 49,169
Mvaa 188,252,84
Ar 50,170
Ar 51,171
Mvaa 220,252,88
s_waitcnt vmcnt(30) lgkmcnt(0)
Ar 52,172
Ar 53,173
Mvaa 252,252,92
Ar 54,174
Ar 55,175
Mvaa 128,192,96
Vc 44,48,49
Vc 45,50,51
Mvaa 160,192,100
Ta 224,16,57344
Ta 226,16,58368
Mvaa 192,192,104
buffer_load_dwordx4 v9, s[8:11], s50 offen offset:2048 lds
Mvaa 224,192,108
Vc 46,52,53
Vc 47,54,55
Mvaa 132,196,96
Ta 228,17,57344
Ta 230,17,58368
Mvaa 164,196,100
s_lshl_b32 s3, s32, 11
s_add_u32 s3, s3, 5242880
Mvaa 196,196,104
buffer_load_dwordx4 v9, s[8:11], s51 offen offset:3072 lds
Mvaa 228,196,108
Ta 232,18,57344
Ta 234,18,58368
Mvaa 136,200,96
v_xor_b32 v8, 524288, v8
v_xor_b32 v9, 524288, v9
Mvaa 168,200,100
buffer_load_dwordx4 v[56:59], v2, s[20:23], s3 offen offset:0 sc1
Mvaa 200,200,104
Ta 236,19,57344
Ta 238,19,58368
Mvaa 232,200,108
buffer_load_dwordx4 a[48:51], v10, s[20:23], s53 offen offset:1024 sc1
Mvaa 140,204,96
buffer_load_dwordx4 v[60:63], v2, s[20:23], s3 offen offset:1024 sc1
Mvaa 172,204,100
Ta 240,20,57344
Ta 242,20,58368
Mvaa 204,204,104
Mvaa 236,204,108
Mvaa 144,208,96
s_waitcnt lgkmcnt(6)
Ta 244,21,57344
Ta 246,21,58368
Mvaa 176,208,100
buffer_load_dwordx4 a[52:55], v10, s[20:23], s52 offen offset:1024 sc1
Mvaa 208,208,104
Mvaa 240,208,108
Ta 248,22,57344
Ta 250,22,58368
Mvaa 148,212,96
Mvaa 180,212,100
buffer_load_dwordx4 a[56:59], v11, s[20:23], s53 offen offset:1024 sc1
Mvaa 212,212,104
Ta 252,23,57344
Ta 254,23,58368
Mvaa 244,212,108
buffer_store_dwordx4 v[80:83], v2, s[24:27], s59 offen offset:2048 sc1
Mvaa 152,216,96
Mvaa 184,216,100
buffer_load_dwordx4 a[60:63], v11, s[20:23], s52 offen offset:1024 sc1
Mvaa 216,216,104
s_xor_b32 s52, s52, 6144
s_add_u32 s53, s52, s58
Mvaa 248,216,108
Mvaa 156,220,96
Mvaa 188,220,100
Mvaa 220,220,104
s_waitcnt vmcnt(32) lgkmcnt(0)
Mvaa 252,220,108
s_barrier
Mvaa 128,224,112
Mvaa 160,224,116
s_add_u32 m0, s44, 49152
Ta 192,16,0
Ta 194,16,1024
Mvaa 192,224,120
buffer_load_dwordx4 v8, s[8:11], s48 offen offset:0 lds
Mvaa 224,224,124
Mvaa 132,228,112
Ta 196,17,0
Ta 198,17,1024
Mvaa 164,228,116
Mvaa 196,228,120
buffer_load_dwordx4 v8, s[8:11], s49 offen offset:1024 lds
Mvaa 228,228,124
Ta 200,18,0
Ta 202,18,1024
Mvaa 136,232,112
Mvaa 168,232,116
Mvaa 200,232,120
Ta 204,19,0
Ta 206,19,1024
Mvaa 232,232,124
buffer_load_dwordx4 a[64:67], v10, s[20:23], s53 offen offset:0 sc1
Mvaa 140,236,112
Mvaa 172,236,116
Ta 208,20,0
Ta 210,20,1024
Mvaa 204,236,120
Mvaa 236,236,124
Mvaa 144,240,112
s_waitcnt lgkmcnt(6)
Ta 212,21,0
Ta 214,21,1024
Mvaa 176,240,116
buffer_load_dwordx4 a[68:71], v10, s[20:23], s52 offen offset:0 sc1
Mvaa 208,240,120
buffer_store_dwordx4 v[84:87], v2, s[24:27], s59 offen offset:3072 sc1
Mvaa 240,240,124
Ta 216,22,0
Ta 218,22,1024
Mvaa 148,244,112
Mvaa 180,244,116
buffer_load_dwordx4 a[72:75], v11, s[20:23], s53 offen offset:0 sc1
Mvaa 212,244,120
Ta 220,23,0
Ta 222,23,1024
Mvaa 244,244,124
Mvaa 152,248,112
Mvaa 184,248,116
buffer_load_dwordx4 a[76:79], v11, s[20:23], s52 offen offset:0 sc1
Mvaa 216,248,120
Mvaa 248,248,124
Mvaa 156,252,112
Mvaa 188,252,116
Mvaa 220,252,120
s_waitcnt vmcnt(32) lgkmcnt(0)
Mvaa 252,252,124
Mvaa 128,192,0
Mvaa 160,192,4
Ta 224,16,8192
Ta 226,16,9216
Mvaa 192,192,8
buffer_load_dwordx4 v9, s[8:11], s50 offen offset:2048 lds
Mvaa 224,192,12
Mvaa 132,196,0
Ta 228,17,8192
Ta 230,17,9216
Mvaa 164,196,4
Mvaa 196,196,8
buffer_load_dwordx4 v9, s[8:11], s51 offen offset:3072 lds
Mvaa 228,196,12
Ta 232,18,8192
Ta 234,18,9216
Mvaa 136,200,0
v_xor_b32 v8, 7864320, v8
v_xor_b32 v9, 7864320, v9
Mvaa 168,200,4
Mvaa 200,200,8
Ta 236,19,8192
Ta 238,19,9216
Mvaa 232,200,12
buffer_load_dwordx4 a[80:83], v10, s[20:23], s53 offen offset:1024 sc1
Mvaa 140,204,0
s_add_u32 s59, s38, 34816
Mvaa 172,204,4
Ta 240,20,8192
Ta 242,20,9216
Mvaa 204,204,8
buffer_store_dwordx4 v[88:91], v2, s[24:27], s59 offen offset:0 sc1
Mvaa 236,204,12
Mvaa 144,208,0
s_waitcnt lgkmcnt(6)
Ta 244,21,8192
Ta 246,21,9216
Mvaa 176,208,4
buffer_load_dwordx4 a[84:87], v10, s[20:23], s52 offen offset:1024 sc1
Mvaa 208,208,8
Mvaa 240,208,12
Ta 248,22,8192
Ta 250,22,9216
Mvaa 148,212,0
Mvaa 180,212,4
buffer_load_dwordx4 a[88:91], v11, s[20:23], s53 offen offset:1024 sc1
Mvaa 212,212,8
Ta 252,23,8192
Ta 254,23,9216
Mvaa 244,212,12
Mvaa 152,216,0
Mvaa 184,216,4
buffer_load_dwordx4 a[92:95], v11, s[20:23], s52 offen offset:1024 sc1
Mvaa 216,216,8
s_xor_b32 s52, s52, 2048
s_add_u32 s53, s52, s58
Mvaa 248,216,12
Mvaa 156,220,0
Mvaa 188,220,4
Mvaa 220,220,8
s_waitcnt vmcnt(32) lgkmcnt(0)
Mvaa 252,220,12
s_barrier
Mvaa 128,224,16
Mvaa 160,224,20
s_add_u32 m0, s44, 0
Ta 192,16,16384
Ta 194,16,17408
Mvaa 192,224,24
buffer_load_dwordx4 v8, s[8:11], s48 offen offset:0 lds
Mvaa 224,224,28
Mvaa 132,228,16
Ta 196,17,16384
Ta 198,17,17408
Mvaa 164,228,20
Mvaa 196,228,24
buffer_load_dwordx4 v8, s[8:11], s49 offen offset:1024 lds
Mvaa 228,228,28
Ta 200,18,16384
Ta 202,18,17408
Mvaa 136,232,16
buffer_store_dwordx4 v[92:95], v2, s[24:27], s59 offen offset:1024 sc1
Mvaa 168,232,20
Mvaa 200,232,24
Ta 204,19,16384
Ta 206,19,17408
Mvaa 232,232,28
buffer_load_dwordx4 a[96:99], v10, s[20:23], s53 offen offset:0 sc1
Mvaa 140,236,16
Mvaa 172,236,20
Ta 208,20,16384
Ta 210,20,17408
Mvaa 204,236,24
Mvaa 236,236,28
Mvaa 144,240,16
s_waitcnt lgkmcnt(6)
Ta 212,21,16384
Ta 214,21,17408
Mvaa 176,240,20
buffer_load_dwordx4 a[100:103], v10, s[20:23], s52 offen offset:0 sc1
Mvaa 208,240,24
Mvaa 240,240,28
Ta 216,22,16384
Ta 218,22,17408
Mvaa 148,244,16
Mvaa 180,244,20
buffer_load_dwordx4 a[104:107], v11, s[20:23], s53 offen offset:0 sc1
Mvaa 212,244,24
Ta 220,23,16384
Ta 222,23,17408
Mvaa 244,244,28
Mvaa 152,248,16
Mvaa 184,248,20
buffer_load_dwordx4 a[108:111], v11, s[20:23], s52 offen offset:0 sc1
Mvaa 216,248,24
Mvaa 248,248,28
Mvaa 156,252,16
Mvaa 188,252,20
Mvaa 220,252,24
s_waitcnt vmcnt(31) lgkmcnt(0)
Mvaa 252,252,28
Mvaa 128,192,32
buffer_store_dwordx4 v[96:99], v2, s[24:27], s59 offen offset:2048 sc1
Mvaa 160,192,36
Ta 224,16,24576
Ta 226,16,25600
Mvaa 192,192,40
buffer_load_dwordx4 v9, s[8:11], s50 offen offset:2048 lds
Mvaa 224,192,44
Mvaa 132,196,32
Ta 228,17,24576
Ta 230,17,25600
Mvaa 164,196,36
Mvaa 196,196,40
buffer_load_dwordx4 v9, s[8:11], s51 offen offset:3072 lds
Mvaa 228,196,44
Ta 232,18,24576
Ta 234,18,25600
Mvaa 136,200,32
v_xor_b32 v8, 524288, v8
v_xor_b32 v9, 524288, v9
Mvaa 168,200,36
Mvaa 200,200,40
Ta 236,19,24576
Ta 238,19,25600
Mvaa 232,200,44
buffer_load_dwordx4 a[112:115], v10, s[20:23], s53 offen offset:1024 sc1
Mvaa 140,204,32
Mvaa 172,204,36
Ta 240,20,24576
Ta 242,20,25600
Mvaa 204,204,40
Mvaa 236,204,44
Mvaa 144,208,32
s_waitcnt lgkmcnt(6)
Ta 244,21,24576
Ta 246,21,25600
Mvaa 176,208,36
buffer_load_dwordx4 a[116:119], v10, s[20:23], s52 offen offset:1024 sc1
Mvaa 208,208,40
Mvaa 240,208,44
Ta 248,22,24576
Ta 250,22,25600
Mvaa 148,212,32
Mvaa 180,212,36
buffer_load_dwordx4 a[120:123], v11, s[20:23], s53 offen offset:1024 sc1
Mvaa 212,212,40
Ta 252,23,24576
Ta 254,23,25600
Mvaa 244,212,44
Mvaa 152,216,32
Mvaa 184,216,36
buffer_load_dwordx4 a[124:127], v11, s[20:23], s52 offen offset:1024 sc1
Mvaa 216,216,40
s_xor_b32 s52, s52, 30720
s_add_u32 s53, s52, s58
Mvaa 248,216,44
buffer_store_dwordx4 v[100:103], v2, s[24:27], s59 offen offset:3072 sc1
Mvaa 156,220,32
Mvaa 188,220,36
Mvaa 220,220,40
s_waitcnt vmcnt(29) lgkmcnt(0)
Mvaa 252,220,44
s_barrier
Mvaa 128,224,48
Mvaa 160,224,52
s_add_u32 m0, s44, 16384
Ta 192,16,32768
Ta 194,16,33792
Mvaa 192,224,56
buffer_load_dwordx4 v8, s[8:11], s48 offen offset:0 lds
Mvaa 224,224,60
Mvaa 132,228,48
Ta 196,17,32768
Ta 198,17,33792
Mvaa 164,228,52
Mvaa 196,228,56
buffer_load_dwordx4 v8, s[8:11], s49 offen offset:1024 lds
Mvaa 228,228,60
Ta 200,18,32768
Ta 202,18,33792
Mvaa 136,232,48
Mvaa 168,232,52
Mvaa 200,232,56
Ta 204,19,32768
Ta 206,19,33792
Mvaa 232,232,60
buffer_load_dwordx4 a[0:3], v10, s[20:23], s53 offen offset:0 sc1
Mvaa 140,236,48
Mvaa 172,236,52
Ta 208,20,32768
Ta 210,20,33792
Mvaa 204,236,56
Mvaa 236,236,60
Mvaa 144,240,48
s_waitcnt lgkmcnt(6)
Ta 212,21,32768
Ta 214,21,33792
Mvaa 176,240,52
buffer_load_dwordx4 a[4:7], v10, s[20:23], s52 offen offset:0 sc1
Mvaa 208,240,56
Mvaa 240,240,60
Ta 216,22,32768
Ta 218,22,33792
Mvaa 148,244,48
Mvaa 180,244,52
buffer_load_dwordx4 a[8:11], v11, s[20:23], s53 offen offset:0 sc1
Mvaa 212,244,56
Ta 220,23,32768
Ta 222,23,33792
Mvaa 244,244,60
s_add_u32 s59, s38, 38912
Mvaa 152,248,48
buffer_store_dwordx4 v[104:107], v2, s[24:27], s59 offen offset:0 sc1
Mvaa 184,248,52
buffer_load_dwordx4 a[12:15], v11, s[20:23], s52 offen offset:0 sc1
Mvaa 216,248,56
Mvaa 248,248,60
Mvaa 156,252,48
Mvaa 188,252,52
Mvaa 220,252,56
s_waitcnt vmcnt(29) lgkmcnt(0)
Mvaa 252,252,60
Mvaa 128,192,64
v_max_u32 v14, v56, v57
v_min_u32_e64 v15, v56, v57
Mvaa 160,192,68
Ta 224,16,40960
Ta 226,16,41984
Mvaa 192,192,72
buffer_load_dwordx4 v9, s[8:11], s50 offen offset:2048 lds
Mvaa 224,192,76
v_med3_u32 v15, v14, v15, v58
v_max_u32_e64 v14, v14, v58
Mvaa 132,196,64
Ta 228,17,40960
Ta 230,17,41984
Mvaa 164,196,68
v_med3_u32 v15, v14, v15, v59
v_max_u32_e64 v14, v14, v59
Mvaa 196,196,72
buffer_load_dwordx4 v9, s[8:11], s51 offen offset:3072 lds
Mvaa 228,196,76
Ta 232,18,40960
Ta 234,18,41984
Mvaa 136,200,64
v_xor_b32 v8, 1572864, v8
v_xor_b32 v9, 1572864, v9
Mvaa 168,200,68
v_med3_u32 v15, v14, v15, v60
v_max_u32_e64 v14, v14, v60
Mvaa 200,200,72
Ta 236,19,40960
Ta 238,19,41984
Mvaa 232,200,76
buffer_load_dwordx4 a[16:19], v10, s[20:23], s53 offen offset:1024 sc1
Mvaa 140,204,64
v_med3_u32 v15, v14, v15, v61
v_max_u32_e64 v14, v14, v61
Mvaa 172,204,68
Ta 240,20,40960
Ta 242,20,41984
Mvaa 204,204,72
v_med3_u32 v15, v14, v15, v62
v_max_u32_e64 v14, v14, v62
Mvaa 236,204,76
v_med3_u32 v15, v14, v15, v63
v_max_u32_e64 v14, v14, v63
Mvaa 144,208,64
s_waitcnt lgkmcnt(6)
Ta 244,21,40960
Ta 246,21,41984
Mvaa 176,208,68
buffer_load_dwordx4 a[20:23], v10, s[20:23], s52 offen offset:1024 sc1
Mvaa 208,208,72
buffer_store_dwordx4 v[108:111], v2, s[24:27], s59 offen offset:1024 sc1
Mvaa 240,208,76
Ta 248,22,40960
Ta 250,22,41984
Mvaa 148,212,64
s_lshl_b32 s3, s32, 9
s_add_u32 s3, s3, 131072
v_lshlrev_b32_e64 v13, 3, v0
Mvaa 180,212,68
buffer_load_dwordx4 a[24:27], v11, s[20:23], s53 offen offset:1024 sc1
Mvaa 212,212,72
Ta 252,23,40960
Ta 254,23,41984
Mvaa 244,212,76
v_add_u32_e64 v56, s3, v13
v_add_u32 v13, 131072, v13
Mvaa 152,216,64
ds_write_b64 v56, v[14:15]
Mvaa 184,216,68
buffer_load_dwordx4 a[28:31], v11, s[20:23], s52 offen offset:1024 sc1
Mvaa 216,216,72
s_xor_b32 s52, s52, 2048
s_add_u32 s53, s52, s58
Mvaa 248,216,76
Mvaa 156,220,64
Mvaa 188,220,68
Mvaa 220,220,72
s_waitcnt vmcnt(29) lgkmcnt(0)
Mvaa 252,220,76
s_barrier
Mvaa 128,224,80
Mvaa 160,224,84
s_add_u32 m0, s44, 32768
Ta 192,16,49152
Ta 194,16,50176
Mvaa 192,224,88
buffer_load_dwordx4 v8, s[8:11], s48 offen offset:0 lds
Mvaa 224,224,92
Mvaa 132,228,80
Ta 196,17,49152
Ta 198,17,50176
Mvaa 164,228,84
Mvaa 196,228,88
buffer_load_dwordx4 v8, s[8:11], s49 offen offset:1024 lds
Mvaa 228,228,92
Ta 200,18,49152
Ta 202,18,50176
Mvaa 136,232,80
Mvaa 168,232,84
Mvaa 200,232,88
Ta 204,19,49152
Ta 206,19,50176
Mvaa 232,232,92
buffer_load_dwordx4 a[32:35], v10, s[20:23], s53 offen offset:0 sc1
Mvaa 140,236,80
buffer_store_dwordx4 v[112:115], v2, s[24:27], s59 offen offset:2048 sc1
Mvaa 172,236,84
Ta 208,20,49152
Ta 210,20,50176
Mvaa 204,236,88
Mvaa 236,236,92
Mvaa 144,240,80
s_waitcnt lgkmcnt(6)
Ta 212,21,49152
Ta 214,21,50176
Mvaa 176,240,84
buffer_load_dwordx4 a[36:39], v10, s[20:23], s52 offen offset:0 sc1
Mvaa 208,240,88
Mvaa 240,240,92
Ta 216,22,49152
Ta 218,22,50176
Mvaa 148,244,80
Mvaa 180,244,84
buffer_load_dwordx4 a[40:43], v11, s[20:23], s53 offen offset:0 sc1
Mvaa 212,244,88
Ta 220,23,49152
Ta 222,23,50176
Mvaa 244,244,92
Mvaa 152,248,80
Mvaa 184,248,84
buffer_load_dwordx4 a[44:47], v11, s[20:23], s52 offen offset:0 sc1
Mvaa 216,248,88
Mvaa 248,248,92
Mvaa 156,252,80
Mvaa 188,252,84
Mvaa 220,252,88
s_waitcnt vmcnt(29) lgkmcnt(0)
Mvaa 252,252,92
Mvaa 128,192,96
Mvaa 160,192,100
Ta 224,16,57344
Ta 226,16,58368
Mvaa 192,192,104
buffer_load_dwordx4 v9, s[8:11], s50 offen offset:2048 lds
Mvaa 224,192,108
Mvaa 132,196,96
Ta 228,17,57344
Ta 230,17,58368
Mvaa 164,196,100
Mvaa 196,196,104
buffer_load_dwordx4 v9, s[8:11], s51 offen offset:3072 lds
Mvaa 228,196,108
Ta 232,18,57344
Ta 234,18,58368
Mvaa 136,200,96
v_xor_b32 v8, 524288, v8
v_xor_b32 v9, 524288, v9
Mvaa 168,200,100
buffer_store_dwordx4 v[116:119], v2, s[24:27], s59 offen offset:3072 sc1
Mvaa 200,200,104
Ta 236,19,57344
Ta 238,19,58368
Mvaa 232,200,108
buffer_load_dwordx4 a[48:51], v10, s[20:23], s53 offen offset:1024 sc1
Mvaa 140,204,96
Mvaa 172,204,100
Ta 240,20,57344
Ta 242,20,58368
Mvaa 204,204,104
Mvaa 236,204,108
Mvaa 144,208,96
s_waitcnt lgkmcnt(6)
Ta 244,21,57344
Ta 246,21,58368
Mvaa 176,208,100
buffer_load_dwordx4 a[52:55], v10, s[20:23], s52 offen offset:1024 sc1
Mvaa 208,208,104
Mvaa 240,208,108
Ta 248,22,57344
Ta 250,22,58368
Mvaa 148,212,96
Mvaa 180,212,100
buffer_load_dwordx4 a[56:59], v11, s[20:23], s53 offen offset:1024 sc1
Mvaa 212,212,104
Ta 252,23,57344
Ta 254,23,58368
Mvaa 244,212,108
Mvaa 152,216,96
Mvaa 184,216,100
buffer_load_dwordx4 a[60:63], v11, s[20:23], s52 offen offset:1024 sc1
Mvaa 216,216,104
s_xor_b32 s52, s52, 6144
s_add_u32 s53, s52, s58
Mvaa 248,216,108
Mvaa 156,220,96
Mvaa 188,220,100
Mvaa 220,220,104
s_waitcnt vmcnt(29) lgkmcnt(0)
Mvaa 252,220,108
s_barrier
Mvaa 128,224,112
s_add_u32 s59, s38, 43008
Mvaa 160,224,116
s_add_u32 m0, s44, 49152
Ta 192,16,0
Ta 194,16,1024
Mvaa 192,224,120
buffer_load_dwordx4 v8, s[8:11], s48 offen offset:0 lds
Mvaa 224,224,124
buffer_store_dwordx4 v[120:123], v2, s[24:27], s59 offen offset:0 sc1
Mvaa 132,228,112
Ta 196,17,0
Ta 198,17,1024
Mvaa 164,228,116
ds_read_b64 v[56:57], v13 offset:0
ds_read_b64 v[58:59], v13 offset:512
Mvaa 196,228,120
buffer_load_dwordx4 v8, s[8:11], s49 offen offset:1024 lds
Mvaa 228,228,124
Ta 200,18,0
Ta 202,18,1024
Mvaa 136,232,112
ds_read_b64 v[60:61], v13 offset:1024
ds_read_b64 v[62:63], v13 offset:1536
Mvaa 168,232,116
Mvaa 200,232,120
Ta 204,19,0
Ta 206,19,1024
Mvaa 232,232,124
buffer_load_dwordx4 a[64:67], v10, s[20:23], s53 offen offset:0 sc1
Mvaa 140,236,112
s_waitcnt lgkmcnt(2)
v_max_u32 v14, v56, v57
v_min_u32 v15, v56, v57
Mvaa 172,236,116
Ta 208,20,0
Ta 210,20,1024
Mvaa 204,236,120
v_med3_u32 v15, v14, v15, v58
v_max_u32_e64 v14, v14, v58
Mvaa 236,236,124
v_med3_u32 v15, v14, v15, v59
v_max_u32_e64 v14, v14, v59
Mvaa 144,240,112
s_waitcnt lgkmcnt(6)
Ta 212,21,0
Ta 214,21,1024
Mvaa 176,240,116
buffer_load_dwordx4 a[68:71], v10, s[20:23], s52 offen offset:0 sc1
Mvaa 208,240,120
v_med3_u32 v15, v14, v15, v60
v_max_u32 v14, v14, v60
Mvaa 240,240,124
Ta 216,22,0
Ta 218,22,1024
Mvaa 148,244,112
v_med3_u32 v15, v14, v15, v61
v_max_u32_e64 v14, v14, v61
Mvaa 180,244,116
buffer_load_dwordx4 a[72:75], v11, s[20:23], s53 offen offset:0 sc1
Mvaa 212,244,120
Ta 220,23,0
Ta 222,23,1024
Mvaa 244,244,124
v_med3_u32 v15, v14, v15, v62
v_max_u32_e64 v14, v14, v62
Mvaa 152,248,112
v_med3_u32 v15, v14, v15, v63
v_max_u32_e64 v14, v14, v63
Mvaa 184,248,116
buffer_load_dwordx4 a[76:79], v11, s[20:23], s52 offen offset:0 sc1
Mvaa 216,248,120
v_mov_b32_e64 v13, v14
Mvaa 248,248,124
buffer_store_dwordx4 v[124:127], v2, s[24:27], s59 offen offset:1024 sc1
Mvaa 156,252,112
v_max_u32_dpp v13, v13, v13 quad_perm:[1,0,3,2] row_mask:0xf bank_mask:0xf
Mvaa 188,252,116
Mvaa 220,252,120
s_waitcnt vmcnt(29) lgkmcnt(0)
Mvaa 252,252,124
Mvaa 128,192,0
v_max_u32_dpp v13, v13, v13 quad_perm:[2,3,0,1] row_mask:0xf bank_mask:0xf
Mvaa 160,192,4
Ta 224,16,8192
Ta 226,16,9216
Mvaa 192,192,8
buffer_load_dwordx4 v9, s[8:11], s50 offen offset:2048 lds
Mvaa 224,192,12
v_max_u32_dpp v13, v13, v13 row_half_mirror row_mask:0xf bank_mask:0xf
Mvaa 132,196,0
Ta 228,17,8192
Ta 230,17,9216
Mvaa 164,196,4
v_max_u32_dpp v13, v13, v13 row_mirror row_mask:0xf bank_mask:0xf
Mvaa 196,196,8
buffer_load_dwordx4 v9, s[8:11], s51 offen offset:3072 lds
Mvaa 228,196,12
Ta 232,18,8192
Ta 234,18,9216
Mvaa 136,200,0
v_xor_b32 v8, 3670016, v8
v_xor_b32 v9, 3670016, v9
Mvaa 168,200,4
v_readlane_b32 s3, v13, 0
v_readlane_b32 s47, v13, 16
Mvaa 200,200,8
Ta 236,19,8192
Ta 238,19,9216
Mvaa 232,200,12
buffer_load_dwordx4 a[80:83], v10, s[20:23], s53 offen offset:1024 sc1
Mvaa 140,204,0
v_readlane_b32 s4, v13, 32
v_readlane_b32 s5, v13, 48
Mvaa 172,204,4
Ta 240,20,8192
Ta 242,20,9216
Mvaa 204,204,8
s_max_u32 s3, s3, s47
s_max_u32 s4, s4, s5
s_max_u32 s40, s3, s4
Mvaa 236,204,12
v_cmp_eq_u32 vcc, s40, v14
Mvaa 144,208,0
s_waitcnt lgkmcnt(6)
Ta 244,21,8192
Ta 246,21,9216
Mvaa 176,208,4
buffer_load_dwordx4 a[84:87], v10, s[20:23], s52 offen offset:1024 sc1
Mvaa 208,208,8
v_cndmask_b32 v13, v14, v15, vcc
Mvaa 240,208,12
Ta 248,22,8192
Ta 250,22,9216
Mvaa 148,212,0
v_max_u32_dpp v13, v13, v13 quad_perm:[1,0,3,2] row_mask:0xf bank_mask:0xf
Mvaa 180,212,4
buffer_load_dwordx4 a[88:91], v11, s[20:23], s53 offen offset:1024 sc1
Mvaa 212,212,8
Ta 252,23,8192
Ta 254,23,9216
Mvaa 244,212,12
buffer_store_dwordx4 v[24:27], v2, s[24:27], s59 offen offset:2048 sc1
Mvaa 152,216,0
v_max_u32_dpp v13, v13, v13 quad_perm:[2,3,0,1] row_mask:0xf bank_mask:0xf
Mvaa 184,216,4
buffer_load_dwordx4 a[92:95], v11, s[20:23], s52 offen offset:1024 sc1
Mvaa 216,216,8
s_xor_b32 s52, s52, 2048
s_add_u32 s53, s52, s58
Mvaa 248,216,12
v_max_u32_dpp v13, v13, v13 row_half_mirror row_mask:0xf bank_mask:0xf
Mvaa 156,220,0
s_nop 0
v_max_u32_dpp v13, v13, v13 row_mirror row_mask:0xf bank_mask:0xf
Mvaa 188,220,4
Mvaa 220,220,8
s_waitcnt vmcnt(29) lgkmcnt(0)
Mvaa 252,220,12
s_barrier
Mvaa 128,224,16
v_readlane_b32 s3, v13, 0
v_readlane_b32 s47, v13, 16
Mvaa 160,224,20
s_add_u32 m0, s44, 0
Ta 192,16,16384
Ta 194,16,17408
Mvaa 192,224,24
buffer_load_dwordx4 v8, s[8:11], s48 offen offset:0 lds
Mvaa 224,224,28
v_readlane_b32 s4, v13, 32
v_readlane_b32 s5, v13, 48
Mvaa 132,228,16
Ta 196,17,16384
Ta 198,17,17408
Mvaa 164,228,20
s_max_u32 s3, s3, s47
s_max_u32 s4, s4, s5
s_max_u32 s41, s3, s4
Mvaa 196,228,24
buffer_load_dwordx4 v8, s[8:11], s49 offen offset:1024 lds
Mvaa 228,228,28
Ta 200,18,16384
Ta 202,18,17408
Mvaa 136,232,16
s_and_b32 s3, s40, 0xffff
s_sub_u32 s42, 0xffff, s3
s_and_b32 s3, s41, 0xffff
Mvaa 168,232,20
s_sub_u32 s43, 0xffff, s3
v_mov_b32 v60, s40
v_not_b32_e64 v61, v60
Mvaa 200,232,24
Ta 204,19,16384
Ta 206,19,17408
Mvaa 232,232,28
buffer_load_dwordx4 a[96:99], v10, s[20:23], s53 offen offset:0 sc1
Mvaa 140,236,16
v_ashrrev_i32_e64 v61, 31, v61
v_or_b32 v61, 0x80000000, v61
Mvaa 172,236,20
Ta 208,20,16384
Ta 210,20,17408
Mvaa 204,236,24
v_xor_b32_e64 v60, v60, v61
v_and_b32 v60, 0xffff0000, v60
Mvaa 236,236,28
v_mul_f32 v60, 0xbfb8aa3b, v60
Mvaa 144,240,16
s_waitcnt lgkmcnt(6)
Ta 212,21,16384
Ta 214,21,17408
Mvaa 176,240,20
buffer_load_dwordx4 a[100:103], v10, s[20:23], s52 offen offset:0 sc1
Mvaa 208,240,24
buffer_store_dwordx4 v[28:31], v2, s[24:27], s59 offen offset:3072 sc1
Mvaa 240,240,28
Ta 216,22,16384
Ta 218,22,17408
Mvaa 148,244,16
Ve 60,60
Mvaa 180,244,20
buffer_load_dwordx4 a[104:107], v11, s[20:23], s53 offen offset:0 sc1
Mvaa 212,244,24
Ta 220,23,16384
Ta 222,23,17408
Mvaa 244,244,28
v_add_f32_e64 v60, 1.0, v60
Mvaa 152,248,16
v_rcp_f32_e64 v60, v60
Mvaa 184,248,20
buffer_load_dwordx4 a[108:111], v11, s[20:23], s52 offen offset:0 sc1
Mvaa 216,248,24
Vc 60,60,60
v_and_b32 v64, 0xffff0000, v60
Mvaa 248,248,28
v_mov_b32 v60, s41
v_not_b32 v61, v60
Mvaa 156,252,16
v_ashrrev_i32_e64 v61, 31, v61
v_or_b32 v61, 0x80000000, v61
Mvaa 188,252,20
v_xor_b32_e64 v60, v60, v61
v_and_b32 v60, 0xffff0000, v60
Mvaa 220,252,24
s_waitcnt vmcnt(29) lgkmcnt(0)
v_mul_f32 v60, 0xbfb8aa3b, v60
Mvaa 252,252,28
Ve 60,60
Mvaa 128,192,32
v_add_f32_e64 v60, 1.0, v60
Mvaa 160,192,36
Ta 224,16,24576
Ta 226,16,25600
Mvaa 192,192,40
buffer_load_dwordx4 v9, s[8:11], s50 offen offset:2048 lds
Mvaa 224,192,44
v_rcp_f32_e64 v60, v60
Mvaa 132,196,32
Ta 228,17,24576
Ta 230,17,25600
Mvaa 164,196,36
Vc 60,60,60
v_and_b32 v65, 0xffff0000, v60
Mvaa 196,196,40
buffer_load_dwordx4 v9, s[8:11], s51 offen offset:3072 lds
Mvaa 228,196,44
Ta 232,18,24576
Ta 234,18,25600
Mvaa 136,200,32
v_xor_b32 v8, 524288, v8
v_xor_b32 v9, 524288, v9
Mvaa 168,200,36
v_mov_b32 v48, 0
v_mov_b32 v49, 0
Mvaa 200,200,40
Ta 236,19,24576
Ta 238,19,25600
Mvaa 232,200,44
buffer_load_dwordx4 a[112:115], v10, s[20:23], s53 offen offset:1024 sc1
Mvaa 140,204,32
s_add_u32 s59, s38, 47104
Mvaa 172,204,36
Ta 240,20,24576
Ta 242,20,25600
Mvaa 204,204,40
buffer_store_dwordx4 v[32:35], v2, s[24:27], s59 offen offset:0 sc1
Mvaa 236,204,44
v_mov_b32 v50, 0
v_mov_b32 v51, 0
Mvaa 144,208,32
s_waitcnt lgkmcnt(6)
Ta 244,21,24576
Ta 246,21,25600
Mvaa 176,208,36
buffer_load_dwordx4 a[116:119], v10, s[20:23], s52 offen offset:1024 sc1
Mvaa 208,208,40
v_mov_b32 v52, 0
v_mov_b32_e64 v53, 0
Mvaa 240,208,44
Ta 248,22,24576
Ta 250,22,25600
Mvaa 148,212,32
v_mov_b32 v54, 0
v_mov_b32 v55, 0
Mvaa 180,212,36
buffer_load_dwordx4 a[120:123], v11, s[20:23], s53 offen offset:1024 sc1
Mvaa 212,212,40
Ta 252,23,24576
Ta 254,23,25600
Mvaa 244,212,44
v_mov_b32 v56, 0
v_mov_b32 v57, 0
Mvaa 152,216,32
v_mov_b32 v58, 0
v_mov_b32 v59, 0
Mvaa 184,216,36
buffer_load_dwordx4 a[124:127], v11, s[20:23], s52 offen offset:1024 sc1
Mvaa 216,216,40
s_xor_b32 s52, s52, 14336
s_add_u32 s53, s52, s58
Mvaa 248,216,44
v_mov_b32 v60, 0
v_mov_b32_e64 v61, 0
Mvaa 156,220,32
v_mov_b32 v62, 0
v_mov_b32 v63, 0
Mvaa 188,220,36
Mvaa 220,220,40
s_waitcnt vmcnt(29) lgkmcnt(0)
Mvaa 252,220,44
s_barrier
Mvaa 128,224,48
s_mul_i32 s3, s34, s34
s_mul_i32 s47, s33, 48
s_add_u32 s3, s3, s47
Mvaa 160,224,52
s_add_u32 m0, s44, 16384
Ta 192,16,32768
Ta 194,16,33792
Mvaa 192,224,56
buffer_load_dwordx4 v8, s[8:11], s48 offen offset:0 lds
Mvaa 224,224,60
s_lshl_b32 s3, s3, 2
s_add_u32 s3, s3, s32
s_lshl_b32 s3, s3, 7
Mvaa 132,228,48
Ta 196,17,32768
Ta 198,17,33792
Mvaa 164,228,52
s_sub_u32 s3, s3, 8704
s_cmp_ge_u32 s34, 4
s_cselect_b32 s3, s3, 0
s_cselect_b32 s40, 512, 0
s_cselect_b32 s47, 786432, 0
Mvaa 196,228,56
buffer_load_dwordx4 v8, s[8:11], s49 offen offset:1024 lds
Mvaa 228,228,60
Ta 200,18,32768
Ta 202,18,33792
Mvaa 136,232,48
buffer_store_dwordx4 v[36:39], v2, s[24:27], s59 offen offset:1024 sc1
Mvaa 168,232,52
v_subrev_u32_e64 v31, 0, v0
v_mul_lo_u32 v31, v31, s47
Mvaa 200,232,56
Ta 204,19,32768
Ta 206,19,33792
Mvaa 232,232,60
buffer_load_dwordx4 a[0:3], v10, s[20:23], s53 offen offset:0 sc1
Mvaa 140,236,48
v_min_u32 v31, 6553600, v31
v_mov_b32_e64 v28, s94
Mvaa 172,236,52
Ta 208,20,32768
Ta 210,20,33792
Mvaa 204,236,56
v_mov_b32 v29, s95
v_mov_b32 v30, v31
Mvaa 236,236,60
v_subrev_u32_e64 v31, 10, v0
v_mul_lo_u32 v31, v31, s47
Mvaa 144,240,48
s_waitcnt lgkmcnt(6)
Ta 212,21,32768
Ta 214,21,33792
Mvaa 176,240,52
buffer_load_dwordx4 a[4:7], v10, s[20:23], s52 offen offset:0 sc1
Mvaa 208,240,56
v_min_u32 v31, 6553600, v31
v_mov_b32 v14, s68
Mvaa 240,240,60
Ta 216,22,32768
Ta 218,22,33792
Mvaa 148,244,48
v_mov_b32_e64 v15, s69
Mvaa 180,244,52
buffer_load_dwordx4 a[8:11], v11, s[20:23], s53 offen offset:0 sc1
Mvaa 212,244,56
Ta 220,23,32768
Ta 222,23,33792
Mvaa 244,244,60
v_cmp_le_u32 vcc, 10, v0
Mvaa 152,248,48
s_nop 0
v_cndmask_b32 v28, v28, v14, vcc
v_cndmask_b32 v29, v29, v15, vcc
Mvaa 184,248,52
buffer_load_dwordx4 a[12:15], v11, s[20:23], s52 offen offset:0 sc1
Mvaa 216,248,56
v_cndmask_b32 v30, v30, v31, vcc
Mvaa 248,248,60
v_subrev_u32 v31, 20, v0
v_mul_lo_u32 v31, v31, s47
Mvaa 156,252,48
v_min_u32 v31, 7602176, v31
v_mov_b32_e64 v14, s92
Mvaa 188,252,52
v_mov_b32_e64 v15, s93
Mvaa 220,252,56
s_waitcnt vmcnt(29) lgkmcnt(0)
Mvaa 252,252,60
Mvaa 128,192,64
buffer_store_dwordx4 v[40:43], v2, s[24:27], s59 offen offset:2048 sc1
Mvaa 160,192,68
Ta 224,16,40960
Ta 226,16,41984
Mvaa 192,192,72
buffer_load_dwordx4 v9, s[8:11], s50 offen offset:2048 lds
Mvaa 224,192,76
v_cmp_le_u32 vcc, 20, v0
Mvaa 132,196,64
Ta 228,17,40960
Ta 230,17,41984
Mvaa 164,196,68
v_cndmask_b32 v28, v28, v14, vcc
v_cndmask_b32 v29, v29, v15, vcc
Mvaa 196,196,72
buffer_load_dwordx4 v9, s[8:11], s51 offen offset:3072 lds
Mvaa 228,196,76
Ta 232,18,40960
Ta 234,18,41984
Mvaa 136,200,64
v_xor_b32 v8, 1572864, v8
v_xor_b32 v9, 1572864, v9
Mvaa 168,200,68
v_cndmask_b32 v30, v30, v31, vcc
Mvaa 200,200,72
Ta 236,19,40960
Ta 238,19,41984
Mvaa 232,200,76
buffer_load_dwordx4 a[16:19], v10, s[20:23], s53 offen offset:1024 sc1
Mvaa 140,204,64
v_add_u32 v30, s3, v30
v_ashrrev_i32_e64 v31, 31, v30
Mvaa 172,204,68
Ta 240,20,40960
Ta 242,20,41984
Mvaa 204,204,72
v_lshl_add_u64 v[28:29], v[30:31], 0, v[28:29]
Mvaa 236,204,76
s_mov_b32 s41, 0
v_readfirstlane_b32 s100, v64
v_readfirstlane_b32 s101, v65
Mvaa 144,208,64
s_waitcnt lgkmcnt(6)
Ta 244,21,40960
Ta 246,21,41984
Mvaa 176,208,68
buffer_load_dwordx4 a[20:23], v10, s[20:23], s52 offen offset:1024 sc1
Mvaa 208,208,72
Mvaa 240,208,76
Ta 248,22,40960
Ta 250,22,41984
Mvaa 148,212,64
Mvaa 180,212,68
buffer_load_dwordx4 a[24:27], v11, s[20:23], s53 offen offset:1024 sc1
Mvaa 212,212,72
Ta 252,23,40960
Ta 254,23,41984
Mvaa 244,212,76
Mvaa 152,216,64
Mvaa 184,216,68
buffer_load_dwordx4 a[28:31], v11, s[20:23], s52 offen offset:1024 sc1
Mvaa 216,216,72
s_xor_b32 s52, s52, 2048
s_add_u32 s53, s52, s58
Mvaa 248,216,76
buffer_store_dwordx4 v[44:47], v2, s[24:27], s59 offen offset:3072 sc1
Mvaa 156,220,64
v_mov_b32 v12, 1
v_and_b32_e64 v1, 15, v0
Mvaa 188,220,68
v_lshlrev_b32_e64 v1, 2, v1
Mvaa 220,220,72
s_waitcnt vmcnt(29) lgkmcnt(0)
Mvaa 252,220,76
s_barrier
Mvaa 128,224,80
s_lshr_b32 s6, s33, 1
s_lshl_b32 s6, s6, 7
s_add_u32 s6, s6, 5296128
Mvaa 160,224,84
s_add_u32 m0, s44, 32768
Ta 192,16,49152
Ta 194,16,50176
Mvaa 192,224,88
buffer_load_dwordx4 v8, s[8:11], s48 offen offset:0 lds
Mvaa 224,224,92
s_cmp_eq_u32 s32, 0
s_cselect_b32 s6, s6, 2146435072
Mvaa 132,228,80
Ta 196,17,49152
Ta 198,17,50176
Mvaa 164,228,84
Mvaa 196,228,88
buffer_load_dwordx4 v8, s[8:11], s49 offen offset:1024 lds
Mvaa 228,228,92
Ta 200,18,49152
Ta 202,18,50176
Mvaa 136,232,80
Mvaa 168,232,84
Mvaa 200,232,88
Ta 204,19,49152
Ta 206,19,50176
Mvaa 232,232,92
buffer_load_dwordx4 a[32:35], v10, s[20:23], s53 offen offset:0 sc1
Mvaa 140,236,80
Mvaa 172,236,84
Ta 208,20,49152
Ta 210,20,50176
Mvaa 204,236,88
Mvaa 236,236,92
Mvaa 144,240,80
s_waitcnt lgkmcnt(6)
Ta 212,21,49152
Ta 214,21,50176
Mvaa 176,240,84
buffer_load_dwordx4 a[36:39], v10, s[20:23], s52 offen offset:0 sc1
Mvaa 208,240,88
Mvaa 240,240,92
Ta 216,22,49152
Ta 218,22,50176
Mvaa 148,244,80
Mvaa 180,244,84
buffer_load_dwordx4 a[40:43], v11, s[20:23], s53 offen offset:0 sc1
Mvaa 212,244,88
Ta 220,23,49152
Ta 222,23,50176
Mvaa 244,244,92
Mvaa 152,248,80
Mvaa 184,248,84
buffer_load_dwordx4 a[44:47], v11, s[20:23], s52 offen offset:0 sc1
Mvaa 216,248,88
Mvaa 248,248,92
Mvaa 156,252,80
Mvaa 188,252,84
Mvaa 220,252,88
s_waitcnt vmcnt(28) lgkmcnt(0)
Mvaa 252,252,92
Mvaa 128,192,96
Mvaa 160,192,100
Ta 224,16,57344
Ta 226,16,58368
Mvaa 192,192,104
buffer_load_dwordx4 v9, s[8:11], s50 offen offset:2048 lds
Mvaa 224,192,108
Mvaa 132,196,96
Ta 228,17,57344
Ta 230,17,58368
Mvaa 164,196,100
Mvaa 196,196,104
buffer_load_dwordx4 v9, s[8:11], s51 offen offset:3072 lds
Mvaa 228,196,108
Ta 232,18,57344
Ta 234,18,58368
Mvaa 136,200,96
v_xor_b32 v8, 524288, v8
v_xor_b32 v9, 524288, v9
Mvaa 168,200,100
Mvaa 200,200,104
Ta 236,19,57344
Ta 238,19,58368
Mvaa 232,200,108
buffer_load_dwordx4 a[48:51], v10, s[20:23], s53 offen offset:1024 sc1
Mvaa 140,204,96
Mvaa 172,204,100
Ta 240,20,57344
Ta 242,20,58368
Mvaa 204,204,104
Mvaa 236,204,108
Mvaa 144,208,96
s_waitcnt lgkmcnt(6)
Ta 244,21,57344
Ta 246,21,58368
Mvaa 176,208,100
buffer_load_dwordx4 a[52:55], v10, s[20:23], s52 offen offset:1024 sc1
Mvaa 208,208,104
Mvaa 240,208,108
Ta 248,22,57344
Ta 250,22,58368
Mvaa 148,212,96
Mvaa 180,212,100
buffer_load_dwordx4 a[56:59], v11, s[20:23], s53 offen offset:1024 sc1
Mvaa 212,212,104
Ta 252,23,57344
Ta 254,23,58368
Mvaa 244,212,108
Mvaa 152,216,96
Mvaa 184,216,100
buffer_load_dwordx4 a[60:63], v11, s[20:23], s52 offen offset:1024 sc1
Mvaa 216,216,104
s_xor_b32 s52, s52, 6144
s_add_u32 s53, s52, s58
Mvaa 248,216,108
Mvaa 156,220,96
Mvaa 188,220,100
Mvaa 220,220,104
s_waitcnt vmcnt(27) lgkmcnt(0)
Mvaa 252,220,108
s_barrier
Mvaa 128,224,112
Mvaa 160,224,116
s_add_u32 m0, s44, 49152
Ta 192,16,0
Ta 194,16,1024
Mvaa 192,224,120
buffer_load_dwordx4 v8, s[8:11], s48 offen offset:0 lds
Mvaa 224,224,124
Mvaa 132,228,112
Ta 196,17,0
Ta 198,17,1024
Mvaa 164,228,116
Mvaa 196,228,120
buffer_load_dwordx4 v8, s[8:11], s49 offen offset:1024 lds
Mvaa 228,228,124
Ta 200,18,0
Ta 202,18,1024
Mvaa 136,232,112
Mvaa 168,232,116
Mvaa 200,232,120
Ta 204,19,0
Ta 206,19,1024
Mvaa 232,232,124
buffer_load_dwordx4 a[64:67], v10, s[20:23], s53 offen offset:0 sc1
Mvaa 140,236,112
Mvaa 172,236,116
Ta 208,20,0
Ta 210,20,1024
Mvaa 204,236,120
Mvaa 236,236,124
Mvaa 144,240,112
s_waitcnt lgkmcnt(6)
Ta 212,21,0
Ta 214,21,1024
Mvaa 176,240,116
buffer_load_dwordx4 a[68:71], v10, s[20:23], s52 offen offset:0 sc1
Mvaa 208,240,120
Mvaa 240,240,124
Ta 216,22,0
Ta 218,22,1024
Mvaa 148,244,112
Mvaa 180,244,116
buffer_load_dwordx4 a[72:75], v11, s[20:23], s53 offen offset:0 sc1
Mvaa 212,244,120
Ta 220,23,0
Ta 222,23,1024
Mvaa 244,244,124
Mvaa 152,248,112
Mvaa 184,248,116
buffer_load_dwordx4 a[76:79], v11, s[20:23], s52 offen offset:0 sc1
Mvaa 216,248,120
Mvaa 248,248,124
Mvaa 156,252,112
Mvaa 188,252,116
Mvaa 220,252,120
s_waitcnt vmcnt(26) lgkmcnt(0)
Mvaa 252,252,124
Mvaa 128,192,0
Mvaa 160,192,4
Ta 224,16,8192
Ta 226,16,9216
Mvaa 192,192,8
buffer_load_dwordx4 v9, s[8:11], s50 offen offset:2048 lds
Mvaa 224,192,12
Mvaa 132,196,0
Ta 228,17,8192
Ta 230,17,9216
Mvaa 164,196,4
Mvaa 196,196,8
buffer_load_dwordx4 v9, s[8:11], s51 offen offset:3072 lds
Mvaa 228,196,12
Ta 232,18,8192
Ta 234,18,9216
Mvaa 136,200,0
v_xor_b32 v8, 7864320, v8
v_xor_b32 v9, 7864320, v9
Mvaa 168,200,4
Mvaa 200,200,8
Ta 236,19,8192
Ta 238,19,9216
Mvaa 232,200,12
buffer_load_dwordx4 a[80:83], v10, s[20:23], s53 offen offset:1024 sc1
Mvaa 140,204,0
Mvaa 172,204,4
Ta 240,20,8192
Ta 242,20,9216
Mvaa 204,204,8
Mvaa 236,204,12
Mvaa 144,208,0
s_waitcnt lgkmcnt(6)
Ta 244,21,8192
Ta 246,21,9216
Mvaa 176,208,4
buffer_load_dwordx4 a[84:87], v10, s[20:23], s52 offen offset:1024 sc1
Mvaa 208,208,8
Mvaa 240,208,12
Ta 248,22,8192
Ta 250,22,9216
Mvaa 148,212,0
Mvaa 180,212,4
buffer_load_dwordx4 a[88:91], v11, s[20:23], s53 offen offset:1024 sc1
Mvaa 212,212,8
Ta 252,23,8192
Ta 254,23,9216
Mvaa 244,212,12
Mvaa 152,216,0
Mvaa 184,216,4
buffer_load_dwordx4 a[92:95], v11, s[20:23], s52 offen offset:1024 sc1
Mvaa 216,216,8
s_xor_b32 s52, s52, 2048
s_add_u32 s53, s52, s58
Mvaa 248,216,12
Mvaa 156,220,0
Mvaa 188,220,4
Mvaa 220,220,8
s_waitcnt vmcnt(24) lgkmcnt(0)
Mvaa 252,220,12
s_barrier
Mvaa 128,224,16
s_mov_b64 exec, 1
buffer_store_dword v12, v7, s[20:23], s39 offen sc1
s_mov_b64 exec, -1
Mvaa 160,224,20
Ta 192,16,16384
Ta 194,16,17408
Mvaa 192,224,24
buffer_load_dwordx4 a[96:99], v10, s[20:23], s53 offen offset:0 sc1
Mvaa 224,224,28
s_mov_b32 s24, s60
s_mov_b32 s25, s61
s_mov_b32 s26, s62
Mvaa 132,228,16
Ta 196,17,16384
Ta 198,17,17408
Mvaa 164,228,20
s_add_u32 s93, s2, 224
s_and_b32 s93, s93, 255
s_mul_i32 s92, s93, 2341
Mvaa 196,228,24
s_lshr_b32 s92, s92, 16
s_mul_i32 s47, s92, 28
s_sub_u32 s4, s93, s47
Mvaa 228,228,28
Ta 200,18,16384
Ta 202,18,17408
Mvaa 136,232,16
s_mul_i32 s5, s92, 917504
s_lshl_b32 s47, s4, 8
s_add_u32 s5, s5, s47
Mvaa 168,232,20
buffer_load_dwordx4 a[100:103], v10, s[20:23], s52 offen offset:0 sc1
Mvaa 200,232,24
Ta 204,19,16384
Ta 206,19,17408
Mvaa 232,232,28
v_lshrrev_b32 v24, 4, v0
v_and_b32_e64 v25, 15, v0
Mvaa 140,236,16
s_lshl_b32 s3, s32, 4
v_add_u32 v26, s3, v24
v_mul_u32_u24 v26, 7168, v26
Mvaa 172,236,20
Ta 208,20,16384
Ta 210,20,17408
Mvaa 204,236,24
v_lshlrev_b32 v24, 1, v24
v_xor_b32 v24, v24, v25
Mvaa 236,236,28
v_lshl_add_u32 v24, v24, 4, v26
v_xor_b32 v25, 128, v24
Mvaa 144,240,16
s_waitcnt lgkmcnt(6)
Ta 212,21,16384
Ta 214,21,17408
Mvaa 176,240,20
buffer_load_dwordx4 a[104:107], v11, s[20:23], s53 offen offset:0 sc1
Mvaa 208,240,24
s_mov_b32 s94, 1040356334
s_mov_b32 s95, 1040356334
s_sub_u32 s55, 15, s34
Mvaa 240,240,28
Ta 216,22,16384
Ta 218,22,17408
Mvaa 148,244,16
s_sub_u32 s45, s36, 3
s_sub_u32 s46, s35, 3
s_mov_b32 s54, s44
Mvaa 180,244,20
s_sub_u32 s35, s35, 2
s_sub_u32 s36, s36, 2
v_accvgpr_write_b32 a0, 0
Mvaa 212,244,24
Ta 220,23,16384
Ta 222,23,17408
Mvaa 244,244,28
v_accvgpr_write_b32 a1, 0
v_accvgpr_write_b32 a2, 0
Mvaa 152,248,16
buffer_load_dwordx4 a[108:111], v11, s[20:23], s52 offen offset:0 sc1
Mvaa 184,248,20
v_accvgpr_write_b32 a3, 0
v_accvgpr_write_b32 a4, 0
Mvaa 216,248,24
v_accvgpr_write_b32 a5, 0
v_accvgpr_write_b32 a6, 0
Mvaa 248,248,28
v_accvgpr_write_b32 a7, 0
v_accvgpr_write_b32 a8, 0
Mvaa 156,252,16
v_accvgpr_write_b32 a9, 0
v_accvgpr_write_b32 a10, 0
Mvaa 188,252,20
v_accvgpr_write_b32 a11, 0
v_accvgpr_write_b32 a12, 0
Mvaa 220,252,24
s_waitcnt vmcnt(23) lgkmcnt(0)
v_accvgpr_write_b32 a13, 0
v_accvgpr_write_b32 a14, 0
Mvaa 252,252,28
v_accvgpr_write_b32 a15, 0
Mvaa 128,192,32
v_accvgpr_write_b32 a16, 0
v_accvgpr_write_b32 a17, 0
Mvaa 160,192,36
Ta 224,16,24576
Ta 226,16,25600
Mvaa 192,192,40
buffer_load_dwordx4 a[112:115], v10, s[20:23], s53 offen offset:1024 sc1
Mvaa 224,192,44
v_accvgpr_write_b32 a18, 0
v_accvgpr_write_b32 a19, 0
Mvaa 132,196,32
Ta 228,17,24576
Ta 230,17,25600
Mvaa 164,196,36
v_accvgpr_write_b32 a20, 0
v_accvgpr_write_b32 a21, 0
Mvaa 196,196,40
v_accvgpr_write_b32 a22, 0
v_accvgpr_write_b32 a23, 0
Mvaa 228,196,44
Ta 232,18,24576
Ta 234,18,25600
Mvaa 136,200,32
v_accvgpr_write_b32 a24, 0
v_accvgpr_write_b32 a25, 0
Mvaa 168,200,36
buffer_load_dwordx4 a[116:119], v10, s[20:23], s52 offen offset:1024 sc1
Mvaa 200,200,40
Ta 236,19,24576
Ta 238,19,25600
Mvaa 232,200,44
v_accvgpr_write_b32 a26, 0
v_accvgpr_write_b32 a27, 0
Mvaa 140,204,32
v_accvgpr_write_b32 a28, 0
v_accvgpr_write_b32 a29, 0
Mvaa 172,204,36
Ta 240,20,24576
Ta 242,20,25600
Mvaa 204,204,40
v_accvgpr_write_b32 a30, 0
v_accvgpr_write_b32 a31, 0
Mvaa 236,204,44
Mvaa 144,208,32
s_waitcnt lgkmcnt(6)
Ta 244,21,24576
Ta 246,21,25600
Mvaa 176,208,36
buffer_load_dwordx4 a[120:123], v11, s[20:23], s53 offen offset:1024 sc1
Mvaa 208,208,40
Mvaa 240,208,44
Ta 248,22,24576
Ta 250,22,25600
Mvaa 148,212,32
Mvaa 180,212,36
Mvaa 212,212,40
Ta 252,23,24576
Ta 254,23,25600
Mvaa 244,212,44
Mvaa 152,216,32
buffer_load_dwordx4 a[124:127], v11, s[20:23], s52 offen offset:1024 sc1
Mvaa 184,216,36
Mvaa 216,216,40
Mvaa 248,216,44
Mvaa 156,220,32
Mvaa 188,220,36
Mvaa 220,220,40
s_waitcnt vmcnt(21) lgkmcnt(0)
Mvaa 252,220,44
s_barrier
Mvaa 128,224,48
v_accvgpr_write_b32 a32, 0
v_accvgpr_write_b32 a33, 0
Mvaa 160,224,52
Ta 192,16,32768
Ta 194,16,33792
Mvaa 192,224,56
v_accvgpr_write_b32 a34, 0
v_accvgpr_write_b32 a35, 0
Mvaa 224,224,60
v_accvgpr_write_b32 a36, 0
v_accvgpr_write_b32 a37, 0
Mvaa 132,228,48
Ta 196,17,32768
Ta 198,17,33792
Mvaa 164,228,52
v_accvgpr_write_b32 a38, 0
v_accvgpr_write_b32 a39, 0
Mvaa 196,228,56
v_accvgpr_write_b32 a40, 0
v_accvgpr_write_b32 a41, 0
Mvaa 228,228,60
Ta 200,18,32768
Ta 202,18,33792
Mvaa 136,232,48
v_accvgpr_write_b32 a42, 0
v_accvgpr_write_b32 a43, 0
Mvaa 168,232,52
v_accvgpr_write_b32 a44, 0
v_accvgpr_write_b32 a45, 0
Mvaa 200,232,56
Ta 204,19,32768
Ta 206,19,33792
Mvaa 232,232,60
buffer_load_dword v12, v1, s[20:23], s6 offen sc1
Mvaa 140,236,48
s_add_u32 m0, s44, 65536
s_mov_b32 s7, 0
Mvaa 172,236,52
Ta 208,20,32768
Ta 210,20,33792
Mvaa 204,236,56
v_accvgpr_write_b32 a46, 0
v_accvgpr_write_b32 a47, 0
Mvaa 236,236,60
Mvaa 144,240,48
s_waitcnt lgkmcnt(6)
Ta 212,21,32768
Ta 214,21,33792
Mvaa 176,240,52
Mvaa 208,240,56
Mvaa 240,240,60
Ta 216,22,32768
Ta 218,22,33792
Mvaa 148,244,48
Mvaa 180,244,52
Mvaa 212,244,56
Ta 220,23,32768
Ta 222,23,33792
Mvaa 244,244,60
Mvaa 152,248,48
Mvaa 184,248,52
Mvaa 216,248,56
Mvaa 248,248,60
Mvaa 156,252,48
Mvaa 188,252,52
Mvaa 220,252,56
s_waitcnt vmcnt(16) lgkmcnt(0)
Mvaa 252,252,60
Mvaa 128,192,64
v_accvgpr_write_b32 a48, 0
v_accvgpr_write_b32 a49, 0
Mvaa 160,192,68
Ta 224,16,40960
Ta 226,16,41984
Mvaa 192,192,72
v_accvgpr_write_b32 a50, 0
v_accvgpr_write_b32 a51, 0
Mvaa 224,192,76
v_accvgpr_write_b32 a52, 0
v_accvgpr_write_b32 a53, 0
Mvaa 132,196,64
Ta 228,17,40960
Ta 230,17,41984
Mvaa 164,196,68
v_accvgpr_write_b32 a54, 0
v_accvgpr_write_b32 a55, 0
Mvaa 196,196,72
v_accvgpr_write_b32 a56, 0
v_accvgpr_write_b32 a57, 0
Mvaa 228,196,76
Ta 232,18,40960
Ta 234,18,41984
Mvaa 136,200,64
v_accvgpr_write_b32 a58, 0
v_accvgpr_write_b32 a59, 0
Mvaa 168,200,68
v_accvgpr_write_b32 a60, 0
v_accvgpr_write_b32 a61, 0
Mvaa 200,200,72
Ta 236,19,40960
Ta 238,19,41984
Mvaa 232,200,76
v_accvgpr_write_b32 a62, 0
v_accvgpr_write_b32 a63, 0
Mvaa 140,204,64
Mvaa 172,204,68
Ta 240,20,40960
Ta 242,20,41984
Mvaa 204,204,72
Mvaa 236,204,76
Mvaa 144,208,64
s_waitcnt lgkmcnt(6)
Ta 244,21,40960
Ta 246,21,41984
Mvaa 176,208,68
Mvaa 208,208,72
Mvaa 240,208,76
Ta 248,22,40960
Ta 250,22,41984
Mvaa 148,212,64
Mvaa 180,212,68
Mvaa 212,212,72
Ta 252,23,40960
Ta 254,23,41984
Mvaa 244,212,76
Mvaa 152,216,64
Mvaa 184,216,68
Mvaa 216,216,72
Mvaa 248,216,76
Mvaa 156,220,64
Mvaa 188,220,68
Mvaa 220,220,72
s_waitcnt vmcnt(0) lgkmcnt(0)
Mvaa 252,220,76
s_cmp_lg_u32 s32, 0
s_cbranch_scc1 L_spinBr
v_cmp_ne_u32 vcc, 1, v12
s_cbranch_vccnz L_spinB
L_spinBr:
s_barrier
Mvaa 128,224,80
buffer_load_dwordx4 v4, s[12:15], s7 offen offset:0 sc1 lds
Mvaa 160,224,84
Ta 192,16,49152
Ta 194,16,50176
Mvaa 192,224,88
v_accvgpr_write_b32 a64, 0
v_accvgpr_write_b32 a65, 0
Mvaa 224,224,92
buffer_load_dwordx4 v4, s[12:15], s7 offen offset:1024 sc1 lds
Mvaa 132,228,80
Ta 196,17,49152
Ta 198,17,50176
Mvaa 164,228,84
v_accvgpr_write_b32 a66, 0
v_accvgpr_write_b32 a67, 0
Mvaa 196,228,88
buffer_load_dwordx4 v4, s[12:15], s7 offen offset:2048 sc1 lds
Mvaa 228,228,92
Ta 200,18,49152
Ta 202,18,50176
Mvaa 136,232,80
v_accvgpr_write_b32 a68, 0
v_accvgpr_write_b32 a69, 0
Mvaa 168,232,84
buffer_load_dwordx4 v4, s[12:15], s7 offen offset:3072 sc1 lds
Mvaa 200,232,88
Ta 204,19,49152
Ta 206,19,50176
Mvaa 232,232,92
s_add_u32 m0, s44, 98304
s_mov_b32 s7, 34816
Mvaa 140,236,80
buffer_load_dwordx4 v4, s[12:15], s7 offen offset:0 sc1 lds
Mvaa 172,236,84
Ta 208,20,49152
Ta 210,20,50176
Mvaa 204,236,88
v_accvgpr_write_b32 a70, 0
v_accvgpr_write_b32 a71, 0
Mvaa 236,236,92
buffer_load_dwordx4 v4, s[12:15], s7 offen offset:1024 sc1 lds
Mvaa 144,240,80
s_waitcnt lgkmcnt(6)
Ta 212,21,49152
Ta 214,21,50176
Mvaa 176,240,84
v_accvgpr_write_b32 a72, 0
v_accvgpr_write_b32 a73, 0
Mvaa 208,240,88
buffer_load_dwordx4 v4, s[12:15], s7 offen offset:2048 sc1 lds
Mvaa 240,240,92
Ta 216,22,49152
Ta 218,22,50176
Mvaa 148,244,80
v_accvgpr_write_b32 a74, 0
v_accvgpr_write_b32 a75, 0
Mvaa 180,244,84
buffer_load_dwordx4 v4, s[12:15], s7 offen offset:3072 sc1 lds
Mvaa 212,244,88
Ta 220,23,49152
Ta 222,23,50176
Mvaa 244,244,92
s_add_u32 m0, s44, 81920
s_mov_b32 s7, 17408
Mvaa 152,248,80
buffer_load_dwordx4 v4, s[12:15], s7 offen offset:0 sc1 lds
Mvaa 184,248,84
v_accvgpr_write_b32 a76, 0
v_accvgpr_write_b32 a77, 0
Mvaa 216,248,88
buffer_load_dwordx4 v4, s[12:15], s7 offen offset:1024 sc1 lds
Mvaa 248,248,92
v_accvgpr_write_b32 a78, 0
v_accvgpr_write_b32 a79, 0
Mvaa 156,252,80
Mvaa 188,252,84
Mvaa 220,252,88
s_waitcnt lgkmcnt(0)
Mvaa 252,252,92
Mvaa 128,192,96
buffer_load_dwordx4 v4, s[12:15], s7 offen offset:2048 sc1 lds
Mvaa 160,192,100
Ta 224,16,57344
Ta 226,16,58368
Mvaa 192,192,104
buffer_load_dwordx4 v4, s[12:15], s7 offen offset:3072 sc1 lds
Mvaa 224,192,108
s_add_u32 m0, s44, 114688
s_mov_b32 s7, 52224
Mvaa 132,196,96
Ta 228,17,57344
Ta 230,17,58368
Mvaa 164,196,100
buffer_load_dwordx4 v4, s[12:15], s7 offen offset:0 sc1 lds
Mvaa 196,196,104
buffer_load_dwordx4 v4, s[12:15], s7 offen offset:1024 sc1 lds
Mvaa 228,196,108
Ta 232,18,57344
Ta 234,18,58368
Mvaa 136,200,96
v_accvgpr_write_b32 a80, 0
v_accvgpr_write_b32 a81, 0
Mvaa 168,200,100
buffer_load_dwordx4 v4, s[12:15], s7 offen offset:2048 sc1 lds
Mvaa 200,200,104
Ta 236,19,57344
Ta 238,19,58368
Mvaa 232,200,108
v_accvgpr_write_b32 a82, 0
v_accvgpr_write_b32 a83, 0
Mvaa 140,204,96
buffer_load_dwordx4 v4, s[12:15], s7 offen offset:3072 sc1 lds
Mvaa 172,204,100
Ta 240,20,57344
Ta 242,20,58368
Mvaa 204,204,104
s_add_u32 m0, s44, 0
s_mov_b32 s7, 69632
Mvaa 236,204,108
buffer_load_dwordx4 v4, s[12:15], s7 offen offset:0 sc1 lds
Mvaa 144,208,96
s_waitcnt lgkmcnt(6)
Ta 244,21,57344
Ta 246,21,58368
Mvaa 176,208,100
buffer_load_dwordx4 v4, s[12:15], s7 offen offset:1024 sc1 lds
Mvaa 208,208,104
v_accvgpr_write_b32 a84, 0
v_accvgpr_write_b32 a85, 0
Mvaa 240,208,108
Ta 248,22,57344
Ta 250,22,58368
Mvaa 148,212,96
buffer_load_dwordx4 v4, s[12:15], s7 offen offset:2048 sc1 lds
Mvaa 180,212,100
v_accvgpr_write_b32 a86, 0
v_accvgpr_write_b32 a87, 0
Mvaa 212,212,104
Ta 252,23,57344
Ta 254,23,58368
Mvaa 244,212,108
buffer_load_dwordx4 v4, s[12:15], s7 offen offset:3072 sc1 lds
Mvaa 152,216,96
s_add_u32 m0, s44, 16384
s_mov_b32 s7, 87040
Mvaa 184,216,100
v_accvgpr_write_b32 a88, 0
v_accvgpr_write_b32 a89, 0
Mvaa 216,216,104
buffer_load_dwordx4 v4, s[12:15], s7 offen offset:0 sc1 lds
Mvaa 248,216,108
v_accvgpr_write_b32 a90, 0
v_accvgpr_write_b32 a91, 0
Mvaa 156,220,96
v_accvgpr_write_b32 a92, 0
v_accvgpr_write_b32 a93, 0
Mvaa 188,220,100
v_accvgpr_write_b32 a94, 0
v_accvgpr_write_b32 a95, 0
Mvaa 220,220,104
s_waitcnt vmcnt(17) lgkmcnt(0)
Mvaa 252,220,108
s_barrier
Mvaa 128,224,112
buffer_load_dwordx4 v4, s[12:15], s7 offen offset:1024 sc1 lds
Mvaa 132,228,112
buffer_load_dwordx4 v4, s[12:15], s7 offen offset:2048 sc1 lds
Mvaa 136,232,112
Ra 192,3,0
Ra 196,3,1024
Mvaa 140,236,112
buffer_load_dwordx4 v4, s[12:15], s7 offen offset:3072 sc1 lds
Mvaa 144,240,112
s_add_u32 m0, s44, 32768
s_mov_b32 s7, 104448
Mvaa 148,244,112
Ra 200,3,2048
Ra 204,3,3072
Mvaa 152,248,112
buffer_load_dwordx4 v4, s[12:15], s7 offen offset:0 sc1 lds
Mvaa 156,252,112
Ra 208,3,4096
Ra 212,3,5120
Mvaa 160,224,116
buffer_load_dwordx4 v4, s[12:15], s7 offen offset:1024 sc1 lds
Mvaa 164,228,116
Ra 216,3,6144
Ra 220,3,7168
Mvaa 168,232,116
Mvaa 172,236,116
buffer_load_dwordx4 v4, s[12:15], s7 offen offset:2048 sc1 lds
Mvaa 176,240,116
v_mul_f32 v128, s94, v128
v_mul_f32_e64 v129, s94, v129
Mvaa 180,244,116
v_mul_f32 v130, s94, v130
v_mul_f32 v131, s94, v131
Mvaa 184,248,116
buffer_load_dwordx4 v4, s[12:15], s7 offen offset:3072 sc1 lds
Mvaa 188,252,116
v_mul_f32 v132, s94, v132
v_mul_f32 v133, s94, v133
Mvaa 192,224,120
v_mul_f32 v134, s94, v134
v_mul_f32 v135, s94, v135
Mvaa 196,228,120
Vc 128,128,129
Vc 129,130,131
Mvaa 200,232,120
Vc 130,132,133
Vc 131,134,135
Mvaa 204,236,120
Aw 128,128
Aw 129,129
Mvaa 208,240,120
Aw 130,130
Aw 131,131
Mvaa 212,244,120
v_mul_f32 v136, s94, v136
v_mul_f32 v137, s94, v137
Mvaa 216,248,120
v_mul_f32 v138, s94, v138
v_mul_f32 v139, s94, v139
Mvaa 220,252,120
v_mul_f32 v140, s94, v140
v_mul_f32 v141, s94, v141
Mvaa 224,224,124
v_mul_f32 v142, s94, v142
v_mul_f32 v143, s94, v143
Mvaa 228,228,124
Vc 136,136,137
Vc 137,138,139
Mvaa 232,232,124
Vc 138,140,141
Vc 139,142,143
Mvaa 236,236,124
Aw 132,136
Aw 133,137
Mvaa 240,240,124
Aw 134,138
Aw 135,139
Mvaa 244,244,124
v_mul_f32 v144, s94, v144
v_mul_f32 v145, s94, v145
Mvaa 248,248,124
v_mul_f32 v146, s94, v146
v_mul_f32 v147, s94, v147
Mvaa 252,252,124
v_mul_f32 v148, s94, v148
v_mul_f32 v149, s94, v149
Ra 224,3,8192
Ra 228,3,9216
Ra 232,3,10240
Ra 236,3,11264
Ra 240,3,12288
Ra 244,3,13312
Ra 248,3,14336
s_waitcnt lgkmcnt(9)
Ra 252,3,15360
v_mul_f32 v150, s94, v150
v_mul_f32_e64 v151, s94, v151
Vc 144,144,145
Vc 145,146,147
Vc 146,148,149
Vc 147,150,151
Aw 136,144
Aw 137,145
Aw 138,146
Aw 139,147
v_mul_f32 v152, s94, v152
v_mul_f32 v153, s94, v153
v_mul_f32 v154, s94, v154
v_mul_f32 v155, s94, v155
v_mul_f32 v156, s94, v156
v_mul_f32 v157, s94, v157
v_mul_f32 v158, s94, v158
v_mul_f32 v159, s94, v159
Vc 152,152,153
Vc 153,154,155
Vc 154,156,157
Vc 155,158,159
Aw 140,152
Aw 141,153
Aw 142,154
Aw 143,155
Zvaa 128,192,128
v_mul_f32 v160, s94, v160
v_mul_f32 v161, s94, v161
v_mul_f32 v162, s94, v162
v_mul_f32 v163, s94, v163
Mvaa 128,196,132
v_mul_f32 v164, s94, v164
v_mul_f32 v165, s94, v165
v_mul_f32 v166, s94, v166
v_mul_f32 v167, s94, v167
Mvaa 128,200,136
Vc 160,160,161
Vc 161,162,163
Vc 162,164,165
Vc 163,166,167
Mvaa 128,204,140
Aw 144,160
Aw 145,161
Aw 146,162
Aw 147,163
s_waitcnt lgkmcnt(8)
Zvaa 132,208,128
v_mul_f32 v168, s94, v168
v_mul_f32 v169, s94, v169
v_mul_f32 v170, s94, v170
v_mul_f32_e64 v171, s94, v171
Mvaa 132,212,132
v_mul_f32 v172, s94, v172
v_mul_f32 v173, s94, v173
v_mul_f32 v174, s94, v174
v_mul_f32 v175, s94, v175
Mvaa 132,216,136
Vc 168,168,169
Vc 169,170,171
Vc 170,172,173
Vc 171,174,175
Mvaa 132,220,140
Aw 148,168
Aw 149,169
Aw 150,170
Aw 151,171
s_waitcnt lgkmcnt(4)
Zvaa 136,224,128
v_mul_f32 v176, s94, v176
v_mul_f32 v177, s94, v177
v_mul_f32 v178, s94, v178
v_mul_f32_e64 v179, s94, v179
Mvaa 136,228,132
v_mul_f32 v180, s94, v180
v_mul_f32 v181, s94, v181
v_mul_f32 v182, s94, v182
v_mul_f32 v183, s94, v183
Mvaa 136,232,136
Vc 176,176,177
Vc 177,178,179
Vc 178,180,181
Vc 179,182,183
Mvaa 136,236,140
Aw 152,176
Aw 153,177
Aw 154,178
Aw 155,179
s_waitcnt lgkmcnt(0)
Zvaa 140,240,128
v_mul_f32 v184, s94, v184
v_mul_f32 v185, s94, v185
v_mul_f32 v186, s94, v186
v_mul_f32_e64 v187, s94, v187
Mvaa 140,244,132
v_mul_f32 v188, s94, v188
v_mul_f32 v189, s94, v189
v_mul_f32 v190, s94, v190
v_mul_f32 v191, s94, v191
Mvaa 140,248,136
Vc 184,184,185
Vc 185,186,187
Vc 186,188,189
Vc 187,190,191
Mvaa 140,252,140
Aw 156,184
Aw 157,185
Aw 158,186
Aw 159,187
Zvaa 144,192,144
v_mul_f32 v192, s94, v192
v_mul_f32 v193, s94, v193
v_mul_f32 v194, s94, v194
v_mul_f32 v195, s94, v195
Mvaa 144,196,148
v_mul_f32 v196, s94, v196
v_mul_f32 v197, s94, v197
v_mul_f32 v198, s94, v198
v_mul_f32 v199, s94, v199
Mvaa 144,200,152
Vc 192,192,193
Vc 193,194,195
Vc 194,196,197
Vc 195,198,199
Mvaa 144,204,156
Aw 160,192
Aw 161,193
Aw 162,194
Aw 163,195
Zvaa 148,208,144
v_mul_f32 v200, s94, v200
v_mul_f32 v201, s94, v201
v_mul_f32 v202, s94, v202
v_mul_f32 v203, s94, v203
Mvaa 148,212,148
v_mul_f32 v204, s94, v204
v_mul_f32 v205, s94, v205
v_mul_f32 v206, s94, v206
v_mul_f32 v207, s94, v207
Mvaa 148,216,152
Vc 200,200,201
Vc 201,202,203
Vc 202,204,205
Vc 203,206,207
Mvaa 148,220,156
Aw 164,200
Aw 165,201
Aw 166,202
Aw 167,203
Zvaa 152,224,144
v_mul_f32 v208, s94, v208
v_mul_f32 v209, s94, v209
v_mul_f32 v210, s94, v210
v_mul_f32 v211, s94, v211
Mvaa 152,228,148
v_mul_f32 v212, s94, v212
v_mul_f32 v213, s94, v213
v_mul_f32 v214, s94, v214
v_mul_f32 v215, s94, v215
Mvaa 152,232,152
Vc 208,208,209
Vc 209,210,211
Vc 210,212,213
Vc 211,214,215
Mvaa 152,236,156
Aw 168,208
Aw 169,209
Aw 170,210
Aw 171,211
Zvaa 156,240,144
v_mul_f32 v216, s94, v216
v_mul_f32 v217, s94, v217
v_mul_f32 v218, s94, v218
v_mul_f32 v219, s94, v219
Mvaa 156,244,148
v_mul_f32 v220, s94, v220
v_mul_f32 v221, s94, v221
v_mul_f32 v222, s94, v222
v_mul_f32 v223, s94, v223
Mvaa 156,248,152
Vc 216,216,217
Vc 217,218,219
Vc 218,220,221
Vc 219,222,223
Mvaa 156,252,156
Aw 172,216
Aw 173,217
Aw 174,218
Aw 175,219
Zvaa 160,192,160
v_mul_f32 v224, s94, v224
v_mul_f32 v225, s94, v225
v_mul_f32 v226, s94, v226
v_mul_f32 v227, s94, v227
Mvaa 160,196,164
v_mul_f32 v228, s94, v228
v_mul_f32 v229, s94, v229
v_mul_f32 v230, s94, v230
v_mul_f32 v231, s94, v231
Mvaa 160,200,168
Vc 224,224,225
Vc 225,226,227
Vc 226,228,229
Vc 227,230,231
Mvaa 160,204,172
Aw 176,224
Aw 177,225
Aw 178,226
Aw 179,227
Zvaa 164,208,160
v_mul_f32 v232, s94, v232
v_mul_f32 v233, s94, v233
v_mul_f32 v234, s94, v234
v_mul_f32 v235, s94, v235
Mvaa 164,212,164
v_mul_f32 v236, s94, v236
v_mul_f32 v237, s94, v237
v_mul_f32 v238, s94, v238
v_mul_f32 v239, s94, v239
Mvaa 164,216,168
Vc 232,232,233
Vc 233,234,235
Vc 234,236,237
Vc 235,238,239
Mvaa 164,220,172
Aw 180,232
Aw 181,233
Aw 182,234
Aw 183,235
Zvaa 168,224,160
v_mul_f32 v240, s94, v240
v_mul_f32 v241, s94, v241
v_mul_f32 v242, s94, v242
v_mul_f32 v243, s94, v243
Mvaa 168,228,164
v_mul_f32 v244, s94, v244
v_mul_f32 v245, s94, v245
v_mul_f32 v246, s94, v246
v_mul_f32 v247, s94, v247
Mvaa 168,232,168
Vc 240,240,241
Vc 241,242,243
Vc 242,244,245
Vc 243,246,247
Mvaa 168,236,172
Aw 184,240
Aw 185,241
Aw 186,242
Aw 187,243
Zvaa 172,240,160
v_mul_f32 v248, s94, v248
v_mul_f32 v249, s94, v249
v_mul_f32 v250, s94, v250
v_mul_f32 v251, s94, v251
Mvaa 172,244,164
v_mul_f32 v252, s94, v252
v_mul_f32 v253, s94, v253
v_mul_f32 v254, s94, v254
v_mul_f32 v255, s94, v255
Mvaa 172,248,168
Vc 248,248,249
Vc 249,250,251
Vc 250,252,253
Vc 251,254,255
Mvaa 172,252,172
Aw 188,248
Aw 189,249
Aw 190,250
Aw 191,251
Zvaa 176,192,176
v_accvgpr_write_b32 a96, 0
v_accvgpr_write_b32 a97, 0
v_accvgpr_write_b32 a98, 0
v_accvgpr_write_b32 a99, 0
Mvaa 176,196,180
v_accvgpr_write_b32 a100, 0
v_accvgpr_write_b32 a101, 0
v_accvgpr_write_b32 a102, 0
v_accvgpr_write_b32 a103, 0
Mvaa 176,200,184
v_accvgpr_write_b32 a104, 0
v_accvgpr_write_b32 a105, 0
v_accvgpr_write_b32 a106, 0
v_accvgpr_write_b32 a107, 0
Mvaa 176,204,188
v_accvgpr_write_b32 a108, 0
v_accvgpr_write_b32 a109, 0
v_accvgpr_write_b32 a110, 0
v_accvgpr_write_b32 a111, 0
Zvaa 180,208,176
v_accvgpr_write_b32 a112, 0
v_accvgpr_write_b32 a113, 0
v_accvgpr_write_b32 a114, 0
v_accvgpr_write_b32 a115, 0
Mvaa 180,212,180
v_accvgpr_write_b32 a116, 0
v_accvgpr_write_b32 a117, 0
v_accvgpr_write_b32 a118, 0
v_accvgpr_write_b32 a119, 0
Mvaa 180,216,184
v_accvgpr_write_b32 a120, 0
v_accvgpr_write_b32 a121, 0
v_accvgpr_write_b32 a122, 0
v_accvgpr_write_b32 a123, 0
Mvaa 180,220,188
v_accvgpr_write_b32 a124, 0
v_accvgpr_write_b32 a125, 0
v_accvgpr_write_b32 a126, 0
v_accvgpr_write_b32 a127, 0
s_waitcnt vmcnt(16)
s_barrier
s_add_u32 s53, s44, 65536
Zvaa 184,224,176
Ra 192,3,32768
v_mov_b32 v16, 0x3f803f80
v_mov_b32 v17, 0x3f803f80
v_mov_b32 v18, 0x3f803f80
v_mov_b32 v19, 0x3f803f80
Mvaa 184,228,180
Ra 196,3,33792
v_mov_b32 v20, 0xff800000
v_max3_f32 v22, v128, v129, v130
v_max3_f32 v22, v22, v131, v132
v_max3_f32 v22, v22, v133, v134
Mvaa 184,232,184
Ra 200,3,34816
v_max3_f32 v22, v22, v135, v136
v_max3_f32 v22, v22, v137, v138
v_max3_f32 v22, v22, v139, v140
v_max3_f32 v22, v22, v141, v142
Mvaa 184,236,188
Ra 204,3,35840
v_max_f32 v22, v22, v143
v_mov_b32 v1, v22
s_nop 1
v_permlane16_swap_b32 v1, v22
v_max_f32_e64 v22, v22, v1
Zvaa 188,240,176
Ra 208,3,36864
v_mov_b32 v1, v22
s_nop 1
v_permlane32_swap_b32 v1, v22
v_max_f32 v22, v22, v1
v_add_f32 v22, 0x41f80000, v22
Mvaa 188,244,180
Ra 212,3,37888
Vs 128,128,22
Vs 129,129,22
Vs 130,130,22
Vs 131,131,22
Mvaa 188,248,184
Ra 216,3,38912
Vs 132,132,22
Vs 133,133,22
Vs 134,134,22
Vs 135,135,22
Mvaa 188,252,188
Ra 220,3,39936
Vs 136,136,22
Vs 137,137,22
Vs 138,138,22
Vs 139,139,22
Vs 140,140,22
Vs 141,141,22
Vs 142,142,22
Vs 143,143,22
v_sub_f32 v32, 0, v22
v_sub_f32 v33, 0, v22
v_sub_f32 v34, 0, v22
v_sub_f32 v35, 0, v22
v_max3_f32 v22, v144, v145, v146
v_max3_f32 v22, v22, v147, v148
v_max3_f32 v22, v22, v149, v150
v_max3_f32 v22, v22, v151, v152
v_max3_f32 v22, v22, v153, v154
v_max3_f32 v22, v22, v155, v156
v_max3_f32 v22, v22, v157, v158
v_max_f32 v22, v22, v159
v_mov_b32 v1, v22
s_nop 1
v_permlane16_swap_b32 v1, v22
v_max_f32 v22, v22, v1
v_mov_b32 v1, v22
s_nop 1
v_permlane32_swap_b32 v1, v22
v_max_f32_e64 v22, v22, v1
v_add_f32 v22, 0x41f80000, v22
Vs 144,144,22
Vs 145,145,22
Vs 146,146,22
Vs 147,147,22
Vs 148,148,22
Vs 149,149,22
Vs 150,150,22
Vs 151,151,22
Vs 152,152,22
Vs 153,153,22
Vs 154,154,22
Vs 155,155,22
Vs 156,156,22
Vs 157,157,22
Vs 158,158,22
Vs 159,159,22
v_sub_f32 v36, 0, v22
v_sub_f32 v37, 0, v22
v_sub_f32 v38, 0, v22
v_sub_f32 v39, 0, v22
s_mov_b32 s38, 139264
s_mov_b32 s39, 121856
s_cmp_lg_u32 s34, 0
s_cbranch_scc1 L_k2_nomask0
v_cmp_gt_i32 s[56:57], 0, v5
v_cmp_gt_i32 s[58:59], 1, v5
v_cmp_gt_i32 s[60:61], 2, v5
v_cmp_gt_i32 s[62:63], 3, v5
s_nop 3
s_nop 0
v_cndmask_b32 v176, v176, v20, s[56:57]
v_cndmask_b32 v177, v177, v20, s[58:59]
v_cndmask_b32 v178, v178, v20, s[60:61]
v_cndmask_b32 v179, v179, v20, s[62:63]
v_cmp_gt_i32 s[56:57], 16, v5
v_cmp_gt_i32 s[58:59], 17, v5
v_cmp_gt_i32 s[60:61], 18, v5
v_cmp_gt_i32 s[62:63], 19, v5
v_cndmask_b32 v180, v180, v20, s[56:57]
v_cndmask_b32 v181, v181, v20, s[58:59]
v_cndmask_b32 v182, v182, v20, s[60:61]
v_cndmask_b32 v183, v183, v20, s[62:63]
v_cmp_gt_i32 s[56:57], 32, v5
v_cmp_gt_i32 s[58:59], 33, v5
v_cmp_gt_i32 s[60:61], 34, v5
v_cmp_gt_i32 s[62:63], 35, v5
v_cndmask_b32 v184, v184, v20, s[56:57]
v_cndmask_b32 v185, v185, v20, s[58:59]
v_cndmask_b32 v186, v186, v20, s[60:61]
v_cndmask_b32 v187, v187, v20, s[62:63]
v_cmp_gt_i32 s[56:57], 48, v5
v_cmp_gt_i32 s[58:59], 49, v5
v_cmp_gt_i32 s[60:61], 50, v5
v_cmp_gt_i32 s[62:63], 51, v5
v_cndmask_b32 v188, v188, v20, s[56:57]
v_cndmask_b32 v189, v189, v20, s[58:59]
v_cndmask_b32 v190, v190, v20, s[60:61]
v_cndmask_b32 v191, v191, v20, s[62:63]
L_k2_nomask0:
s_mov_b32 s37, 0
s_nop 0
v_max3_f32 v22, v160, v161, v162
v_max3_f32 v22, v22, v163, v164
v_max3_f32 v22, v22, v165, v166
v_max3_f32 v22, v22, v167, v168
v_max3_f32 v22, v22, v169, v170
v_max3_f32 v22, v22, v171, v172
v_max3_f32 v22, v22, v173, v174
v_max_f32 v22, v22, v175
v_mov_b32 v1, v22
s_nop 1
v_permlane16_swap_b32 v1, v22
v_max_f32 v22, v22, v1
v_mov_b32 v1, v22
s_nop 1
v_permlane32_swap_b32 v1, v22
v_max_f32_e64 v22, v22, v1
v_add_f32 v22, 0x41f80000, v22
Vs 160,160,22
Vs 161,161,22
Vs 162,162,22
Vs 163,163,22
Vs 164,164,22
Vs 165,165,22
Vs 166,166,22
Vs 167,167,22
Vs 168,168,22
Vs 169,169,22
Vs 170,170,22
Vs 171,171,22
Vs 172,172,22
Vs 173,173,22
Vs 174,174,22
Vs 175,175,22
v_sub_f32 v40, 0, v22
v_sub_f32 v41, 0, v22
v_sub_f32 v42, 0, v22
v_sub_f32 v43, 0, v22
v_max3_f32 v22, v176, v177, v178
v_max3_f32 v22, v22, v179, v180
v_max3_f32 v22, v22, v181, v182
v_max3_f32 v22, v22, v183, v184
v_max3_f32 v22, v22, v185, v186
v_max3_f32 v22, v22, v187, v188
v_max3_f32 v22, v22, v189, v190
v_max_f32 v22, v22, v191
v_mov_b32 v1, v22
s_nop 1
v_permlane16_swap_b32 v1, v22
v_max_f32 v22, v22, v1
v_mov_b32 v1, v22
s_nop 1
v_permlane32_swap_b32 v1, v22
v_max_f32_e64 v22, v22, v1
v_add_f32 v22, 0x41f80000, v22
Vs 176,176,22
Vs 177,177,22
Vs 178,178,22
Vs 179,179,22
Vs 180,180,22
Vs 181,181,22
Vs 182,182,22
Vs 183,183,22
Vs 184,184,22
Vs 185,185,22
Vs 186,186,22
Vs 187,187,22
Vs 188,188,22
Vs 189,189,22
Vs 190,190,22
Vs 191,191,22
v_sub_f32 v44, 0, v22
v_sub_f32 v45, 0, v22
v_sub_f32 v46, 0, v22
v_sub_f32 v47, 0, v22
Ve 8,128
Ve 9,129
Ve 10,130
Ve 11,131
Vc 64,8,9
Ve 12,144
Ve 13,145
Vc 65,10,11
Ve 14,146
Ve 15,147
Vc 72,12,13
Ve 8,160
Ve 9,161
Vc 73,14,15
Ve 10,162
Ve 11,163
Vc 80,8,9
Ve 12,176
Ve 13,177
Vc 81,10,11
Ve 14,178
Ve 15,179
Vc 88,12,13
Ve 8,132
Ve 9,133
Vc 89,14,15
Ve 10,134
Ve 11,135
Vc 66,8,9
Ve 12,148
Ve 13,149
Vc 67,10,11
Ve 14,150
Ve 15,151
Vc 74,12,13
Ve 8,164
Ve 9,165
Vc 75,14,15
Ve 10,166
Ve 11,167
Vc 82,8,9
Ve 12,180
Ve 13,181
Vc 83,10,11
Ve 14,182
Ve 15,183
Vc 90,12,13
Vc 91,14,15
v_or_b32_e64 v7, v64, v65
v_or3_b32 v7, v7, v72, v73
v_or3_b32 v7, v7, v80, v81
v_or3_b32 v7, v7, v88, v89
v_or3_b32 v7, v7, v66, v67
v_or3_b32 v7, v7, v74, v75
v_or3_b32 v7, v7, v82, v83
v_or3_b32 v7, v7, v90, v91
s_waitcnt lgkmcnt(4)
s_cmp_eq_u32 s34, 0
s_cbranch_scc1 L_k2_wlast
s_branch L_k2_wloop
L_k2_mk_wo:
v_cmp_gt_i32 s[56:57], 0, v5
v_cmp_gt_i32 s[58:59], 1, v5
v_cmp_gt_i32 s[60:61], 2, v5
v_cmp_gt_i32 s[62:63], 3, v5
s_nop 3
s_nop 0
v_cndmask_b32 v176, v176, v20, s[56:57]
v_cndmask_b32 v177, v177, v20, s[58:59]
v_cndmask_b32 v178, v178, v20, s[60:61]
v_cndmask_b32 v179, v179, v20, s[62:63]
v_cmp_gt_i32 s[56:57], 16, v5
v_cmp_gt_i32 s[58:59], 17, v5
v_cmp_gt_i32 s[60:61], 18, v5
v_cmp_gt_i32 s[62:63], 19, v5
v_cndmask_b32 v180, v180, v20, s[56:57]
v_cndmask_b32 v181, v181, v20, s[58:59]
v_cndmask_b32 v182, v182, v20, s[60:61]
v_cndmask_b32 v183, v183, v20, s[62:63]
v_cmp_gt_i32 s[56:57], 32, v5
v_cmp_gt_i32 s[58:59], 33, v5
v_cmp_gt_i32 s[60:61], 34, v5
v_cmp_gt_i32 s[62:63], 35, v5
v_cndmask_b32 v184, v184, v20, s[56:57]
v_cndmask_b32 v185, v185, v20, s[58:59]
v_cndmask_b32 v186, v186, v20, s[60:61]
v_cndmask_b32 v187, v187, v20, s[62:63]
v_cmp_gt_i32 s[56:57], 48, v5
v_cmp_gt_i32 s[58:59], 49, v5
v_cmp_gt_i32 s[60:61], 50, v5
v_cmp_gt_i32 s[62:63], 51, v5
v_cndmask_b32 v188, v188, v20, s[56:57]
v_cndmask_b32 v189, v189, v20, s[58:59]
v_cndmask_b32 v190, v190, v20, s[60:61]
v_cndmask_b32 v191, v191, v20, s[62:63]
s_branch L_k2_mkr_wo
L_k2_mk_tr:
v_cmp_gt_i32 s[56:57], 0, v5
v_cmp_gt_i32 s[58:59], 1, v5
v_cmp_gt_i32 s[60:61], 2, v5
v_cmp_gt_i32 s[62:63], 3, v5
s_nop 3
v_cndmask_b32 v144, v144, v20, s[56:57]
v_cndmask_b32 v145, v145, v20, s[58:59]
v_cndmask_b32 v146, v146, v20, s[60:61]
v_cndmask_b32 v147, v147, v20, s[62:63]
v_cmp_gt_i32 s[56:57], 16, v5
v_cmp_gt_i32 s[58:59], 17, v5
v_cmp_gt_i32 s[60:61], 18, v5
v_cmp_gt_i32 s[62:63], 19, v5
v_cndmask_b32 v148, v148, v20, s[56:57]
v_cndmask_b32 v149, v149, v20, s[58:59]
v_cndmask_b32 v150, v150, v20, s[60:61]
v_cndmask_b32 v151, v151, v20, s[62:63]
v_cmp_gt_i32 s[56:57], 32, v5
v_cmp_gt_i32 s[58:59], 33, v5
v_cmp_gt_i32 s[60:61], 34, v5
v_cmp_gt_i32 s[62:63], 35, v5
v_cndmask_b32 v152, v152, v20, s[56:57]
v_cndmask_b32 v153, v153, v20, s[58:59]
v_cndmask_b32 v154, v154, v20, s[60:61]
v_cndmask_b32 v155, v155, v20, s[62:63]
v_cmp_gt_i32 s[56:57], 48, v5
v_cmp_gt_i32 s[58:59], 49, v5
v_cmp_gt_i32 s[60:61], 50, v5
v_cmp_gt_i32 s[62:63], 51, v5
v_cndmask_b32 v156, v156, v20, s[56:57]
v_cndmask_b32 v157, v157, v20, s[58:59]
v_cndmask_b32 v158, v158, v20, s[60:61]
v_cndmask_b32 v159, v159, v20, s[62:63]
s_branch L_k2_mkr_tr
L_k2_mk_no:
v_cmp_gt_i32 s[56:57], 0, v5
v_cmp_gt_i32 s[58:59], 1, v5
v_cmp_gt_i32 s[60:61], 2, v5
v_cmp_gt_i32 s[62:63], 3, v5
s_nop 3
v_cndmask_b32 v144, v144, v20, s[56:57]
v_cndmask_b32 v145, v145, v20, s[58:59]
v_cndmask_b32 v146, v146, v20, s[60:61]
v_cndmask_b32 v147, v147, v20, s[62:63]
v_cmp_gt_i32 s[56:57], 16, v5
v_cmp_gt_i32 s[58:59], 17, v5
v_cmp_gt_i32 s[60:61], 18, v5
v_cmp_gt_i32 s[62:63], 19, v5
v_cndmask_b32 v148, v148, v20, s[56:57]
v_cndmask_b32 v149, v149, v20, s[58:59]
v_cndmask_b32 v150, v150, v20, s[60:61]
v_cndmask_b32 v151, v151, v20, s[62:63]
v_cmp_gt_i32 s[56:57], 32, v5
v_cmp_gt_i32 s[58:59], 33, v5
v_cmp_gt_i32 s[60:61], 34, v5
v_cmp_gt_i32 s[62:63], 35, v5
v_cndmask_b32 v152, v152, v20, s[56:57]
v_cndmask_b32 v153, v153, v20, s[58:59]
v_cndmask_b32 v154, v154, v20, s[60:61]
v_cndmask_b32 v155, v155, v20, s[62:63]
v_cmp_gt_i32 s[56:57], 48, v5
v_cmp_gt_i32 s[58:59], 49, v5
v_cmp_gt_i32 s[60:61], 50, v5
v_cmp_gt_i32 s[62:63], 51, v5
v_cndmask_b32 v156, v156, v20, s[56:57]
v_cndmask_b32 v157, v157, v20, s[58:59]
v_cndmask_b32 v158, v158, v20, s[60:61]
v_cndmask_b32 v159, v159, v20, s[62:63]
s_branch L_k2_mkr_no
L_pubB:
v_mov_b32 v24, 1
v_mov_b32 v25, 0
s_mov_b64 exec, 1
buffer_store_dword v24, v25, s[20:23], s64 offen sc1
s_mov_b64 exec, -1
s_branch L_pubBr
L_k2_wloop:
v_xor_b32 v2, 65536, v2
v_xor_b32 v3, 65536, v3
Cvaa 192,192,128,32
s_mov_b32 m0, s53
Ra 224,2,40960
v_lshl_add_u64 v[28:29], s[40:41], 0, v[28:29]
Mvaa 192,196,132
buffer_load_dwordx4 v4, s[12:15], s38 offen offset:0 sc1 lds
Mvaa 192,200,136
Ve 8,136
Mvaa 192,204,140
VE 9,137
Cvaa 208,192,144,36
Ra 228,2,41984
Vc 68,8,9
Mvaa 208,196,148
VE 10,138
Mvaa 208,200,152
VE 11,139
Mvaa 208,204,156
Ra 232,2,43008
Vc 69,10,11
Cvaa 224,192,160,40
Ra 236,2,44032
v_or3_b32 v7, v7, v68, v69
Mvaa 224,196,164
VE 12,152
Mvaa 224,200,168
VE 13,153
Mvaa 224,204,172
Ra 240,2,45056
Vc 76,12,13
Cvaa 240,192,176,44
VE 14,154
Mvaa 240,196,180
VE 15,155
Mvaa 240,200,184
Ra 244,2,46080
Vc 77,14,15
Mvaa 240,204,188
s_waitcnt lgkmcnt(6)
Ra 248,2,47104
v_or3_b32 v7, v7, v76, v77
Cvaa 196,208,128,32
buffer_load_dwordx4 v4, s[12:15], s38 offen offset:1024 sc1 lds
Mvaa 196,212,132
Ve 8,168
Mvaa 196,216,136
VE 9,169
Mvaa 196,220,140
Ra 252,2,48128
Vc 84,8,9
Cvaa 212,208,144,36
VE 10,170
Mvaa 212,212,148
VE 11,171
Mvaa 212,216,152
Ra 192,2,16384
Vc 85,10,11
Mvaa 212,220,156
Ra 196,2,24576
v_or3_b32 v7, v7, v84, v85
Cvaa 228,208,160,40
VE 12,184
Mvaa 228,212,164
VE 13,185
Mvaa 228,216,168
Ra 200,2,17408
Vc 92,12,13
Mvaa 228,220,172
VE 14,186
Cvaa 244,208,176,44
VE 15,187
Mvaa 244,212,180
buffer_load_dwordx4 v4, s[12:15], s38 offen offset:2048 sc1 lds
Mvaa 244,216,184
Ra 204,2,25600
Vc 93,14,15
Mvaa 244,220,188
s_waitcnt lgkmcnt(8)
Ve 8,140
Cvaa 200,224,128,32
Ra 208,2,18432
v_or3_b32 v7, v7, v92, v93
Mvaa 200,228,132
VE 9,141
Mvaa 200,232,136
Ra 212,2,26624
Vc 70,8,9
Mvaa 200,236,140
VE 10,142
Cvaa 216,224,144,36
VE 11,143
Mvaa 216,228,148
Ra 216,2,19456
Vc 71,10,11
Mvaa 216,232,152
Ra 220,2,27648
v_or3_b32 v7, v7, v70, v71
Mvaa 216,236,156
VE 12,156
Cvaa 232,224,160,40
VE 13,157
Mvaa 232,228,164
VE 14,158
Mvaa 232,232,168
VE 15,159
Mvaa 232,236,172
buffer_load_dwordx4 v4, s[12:15], s38 offen offset:3072 sc1 lds
Cvaa 248,224,176,44
VE 8,172
Mvaa 248,228,180
VE 9,173
Mvaa 248,232,184
Vc 78,12,13
Vc 79,14,15
Mvaa 248,236,188
s_waitcnt lgkmcnt(8)
Ve 10,174
Cvaa 204,240,128,32
VE 11,175
Mvaa 204,244,132
Vc 86,8,9
Vc 87,10,11
Mvaa 204,248,136
VE 12,188
Mvaa 204,252,140
VE 13,189
Cvaa 220,240,144,36
Vc 94,12,13
v_or3_b32 v7, v7, v78, v79
Mvaa 220,244,148
VE 14,190
Mvaa 220,248,152
VE 15,191
Mvaa 220,252,156
Vc 95,14,15
v_or3_b32 v7, v7, v86, v87
Cvaa 236,240,160,40
v_or3_b32 v7, v7, v94, v95
v_and_b32 v1, 0x40004000, v7
Mvaa 236,244,164
v_cmp_ne_u32 vcc, 0, v1
Mvaa 236,248,168
Mvaa 236,252,172
s_waitcnt vmcnt(12)
Cvaa 252,240,176,44
Mvaa 252,244,180
s_barrier
Mvaa 252,248,184
s_waitcnt lgkmcnt(4)
Mvaa 252,252,188
s_cbranch_vccnz L_k2_fb_we
L_k2_fbr_we:
Maav 0,192,64
Ve 8,192
Maav 0,196,68
s_add_u32 m0, s54, 49152
VE 9,193
Maav 32,192,72
buffer_load_dwordx4 v4, s[12:15], s39 offen offset:0 sc1 lds
Maav 32,196,76
s_add_u32 s37, s37, 1
Ra 224,2,20480
Vc 96,8,9
Maav 64,192,80
s_add_u32 s38, s38, 34816
Ve 10,194
Maav 64,196,84
VE 11,195
Maav 96,192,88
Ra 228,2,28672
Vc 97,10,11
Maav 96,196,92
Ra 232,2,21504
v_or_b32_e64 v7, v96, v97
Maav 4,200,64
VE 12,208
Maav 4,204,68
VE 13,209
Maav 36,200,72
Ra 236,2,29696
Vc 104,12,13
Maav 36,204,76
VE 14,210
Maav 68,200,80
VE 15,211
Maav 68,204,84
Ra 240,2,22528
Vc 105,14,15
Maav 100,200,88
Ra 244,2,30720
v_or3_b32 v7, v7, v104, v105
Maav 100,204,92
buffer_load_dwordx4 v4, s[12:15], s39 offen offset:1024 sc1 lds
Mvvv 48,16,64
VE 8,224
Mvvv 48,16,68
s_waitcnt lgkmcnt(6)
Ve 9,225
Maav 8,208,64
Ra 248,2,23552
Vc 112,8,9
Maav 8,212,68
VE 10,226
Maav 40,208,72
VE 11,227
Maav 40,212,76
Ra 252,2,31744
Vc 113,10,11
Maav 72,208,80
Ra 192,3,0
v_or3_b32 v7, v7, v112, v113
Maav 72,212,84
VE 12,240
Maav 104,208,88
VE 13,241
Maav 104,212,92
Ra 196,3,1024
Vc 120,12,13
Maav 12,216,64
VE 14,242
Maav 12,220,68
VE 15,243
Maav 44,216,72
Ra 200,3,2048
Vc 121,14,15
Maav 44,220,76
buffer_load_dwordx4 v4, s[12:15], s39 offen offset:2048 sc1 lds
Maav 76,216,80
Ra 204,3,3072
v_or3_b32 v7, v7, v120, v121
Maav 76,220,84
VE 8,196
Maav 108,216,88
VE 9,197
Maav 108,220,92
VE 10,198
Mvvv 52,16,72
VE 11,199
Mvvv 52,16,76
s_waitcnt lgkmcnt(8)
Ve 12,212
Maav 16,224,64
Ra 208,3,4096
Vc 98,8,9
Maav 16,228,68
Ra 212,3,5120
Vc 99,10,11
Maav 48,224,72
Ra 216,3,6144
v_or3_b32 v7, v7, v98, v99
Maav 48,228,76
VE 13,213
Maav 80,224,80
Ra 220,3,7168
Vc 106,12,13
Maav 80,228,84
VE 14,214
Maav 112,224,88
buffer_load_dwordx4 v4, s[12:15], s39 offen offset:3072 sc1 lds
Maav 112,228,92
s_add_u32 s39, s39, 34816
VE 15,215
Maav 20,232,64
VE 8,228
Maav 20,236,68
VE 9,229
Maav 52,232,72
VE 10,230
Maav 52,236,76
VE 11,231
Maav 84,232,80
Vc 107,14,15
Vc 114,8,9
Maav 84,236,84
VE 12,244
Maav 116,232,88
VE 13,245
Maav 116,236,92
Vc 115,10,11
Vc 122,12,13
Mvvv 56,16,80
VE 14,246
Mvvv 56,16,84
s_waitcnt lgkmcnt(8)
Ve 15,247
Maav 24,240,64
Vc 123,14,15
v_or3_b32 v7, v7, v106, v107
Maav 24,244,68
v_or3_b32 v7, v7, v114, v115
v_or3_b32 v7, v7, v122, v123
Maav 56,240,72
global_load_dword v30, v[28:29], off
Maav 56,244,76
Maav 88,240,80
Maav 88,244,84
Maav 120,240,88
Maav 120,244,92
Maav 28,248,64
Maav 28,252,68
Maav 60,248,72
Maav 60,252,76
Maav 92,248,80
Maav 92,252,84
Maav 124,248,88
Maav 124,252,92
Mvvv 60,16,88
s_waitcnt lgkmcnt(4)
Mvvv 60,16,92
Ve 8,200
Cvaa 128,192,128,32
s_add_u32 m0, s53, 32768
Ra 224,3,8192
v_lshl_add_u64 v[28:29], s[40:41], 0, v[28:29]
Mvaa 128,196,132
buffer_load_dwordx4 v4, s[12:15], s38 offen offset:0 sc1 lds
Mvaa 128,200,136
VE 9,201
Mvaa 128,204,140
Ra 228,3,9216
Vc 100,8,9
Cvaa 144,192,144,36
VE 10,202
Mvaa 144,196,148
VE 11,203
Mvaa 144,200,152
Ra 232,3,10240
Vc 101,10,11
Mvaa 144,204,156
Ra 236,3,11264
v_or3_b32 v7, v7, v100, v101
Cvaa 160,192,160,40
VE 12,216
Mvaa 160,196,164
VE 13,217
Mvaa 160,200,168
Ra 240,3,12288
Vc 108,12,13
Mvaa 160,204,172
VE 14,218
Cvaa 176,192,176,44
VE 15,219
Mvaa 176,196,180
Ra 244,3,13312
Vc 109,14,15
Mvaa 176,200,184
Ra 248,3,14336
v_or3_b32 v7, v7, v108, v109
Mvaa 176,204,188
s_waitcnt lgkmcnt(7)
Ve 8,232
Cvaa 132,208,128,32
buffer_load_dwordx4 v4, s[12:15], s38 offen offset:1024 sc1 lds
Mvaa 132,212,132
VE 9,233
Mvaa 132,216,136
Ra 252,3,15360
Vc 116,8,9
Mvaa 132,220,140
VE 10,234
Cvaa 148,208,144,36
VE 11,235
Mvaa 148,212,148
Ra 192,2,49152
Vc 117,10,11
Mvaa 148,216,152
Ra 196,2,57344
v_or3_b32 v7, v7, v116, v117
Mvaa 148,220,156
VE 12,248
Cvaa 164,208,160,40
VE 13,249
Mvaa 164,212,164
Ra 200,2,50176
Vc 124,12,13
Mvaa 164,216,168
VE 14,250
Mvaa 164,220,172
VE 15,251
Cvaa 180,208,176,44
Ra 204,2,58368
Vc 125,14,15
Mvaa 180,212,180
buffer_load_dwordx4 v4, s[12:15], s38 offen offset:2048 sc1 lds
Mvaa 180,216,184
VE 8,204
Mvaa 180,220,188
s_waitcnt lgkmcnt(8)
Ve 9,205
Cvaa 136,224,128,32
Ra 208,2,51200
Vc 102,8,9
Mvaa 136,228,132
Ra 212,2,59392
v_or3_b32 v7, v7, v124, v125
Mvaa 136,232,136
VE 10,206
Mvaa 136,236,140
VE 11,207
Cvaa 152,224,144,36
Ra 216,2,52224
Vc 103,10,11
Mvaa 152,228,148
Ra 220,2,60416
v_or3_b32 v7, v7, v102, v103
Mvaa 152,232,152
VE 12,220
Mvaa 152,236,156
VE 13,221
Cvaa 168,224,160,40
VE 14,222
Mvaa 168,228,164
VE 15,223
Mvaa 168,232,168
VE 8,236
Mvaa 168,236,172
buffer_load_dwordx4 v4, s[12:15], s38 offen offset:3072 sc1 lds
Cvaa 184,224,176,44
VE 9,237
Mvaa 184,228,180
Vc 110,12,13
Vc 111,14,15
Mvaa 184,232,184
VE 10,238
Mvaa 184,236,188
s_waitcnt lgkmcnt(8)
Ve 11,239
Cvaa 140,240,128,32
Vc 118,8,9
Vc 119,10,11
Mvaa 140,244,132
VE 12,252
Mvaa 140,248,136
VE 13,253
Mvaa 140,252,140
Vc 126,12,13
v_or3_b32 v7, v7, v110, v111
Cvaa 156,240,144,36
VE 14,254
Mvaa 156,244,148
VE 15,255
Mvaa 156,248,152
Vc 127,14,15
v_or3_b32 v7, v7, v118, v119
Mvaa 156,252,156
v_or3_b32 v7, v7, v126, v127
v_and_b32 v1, 0x40004000, v7
Cvaa 172,240,160,40
v_cmp_ne_u32 vcc, 0, v1
Mvaa 172,244,164
Mvaa 172,248,168
Mvaa 172,252,172
s_waitcnt vmcnt(12)
Cvaa 188,240,176,44
s_cmp_eq_u32 s37, s46
Mvaa 188,244,180
s_barrier
Mvaa 188,248,184
s_waitcnt lgkmcnt(4)
Mvaa 188,252,188
s_cbranch_vccnz L_k2_fb_wo
L_k2_fbr_wo:
Maav 0,192,96
s_cbranch_scc1 L_k2_mk_wo
L_k2_mkr_wo:
Ve 8,128
Maav 0,196,100
s_add_u32 m0, s53, 16384
VE 9,129
Maav 32,192,104
buffer_load_dwordx4 v4, s[12:15], s39 offen offset:0 sc1 lds
Maav 32,196,108
s_add_u32 s37, s37, 1
Ra 224,2,53248
Vc 64,8,9
Maav 64,192,112
s_add_u32 s38, s38, 34816
Ve 10,130
Maav 64,196,116
s_xor_b32 s53, s53, 65536
VE 11,131
Maav 96,192,120
s_xor_b32 s54, s54, 65536
Ra 228,2,61440
Vc 65,10,11
Maav 96,196,124
Ra 232,2,54272
v_or_b32_e64 v7, v64, v65
Maav 4,200,96
VE 12,144
Maav 4,204,100
VE 13,145
Maav 36,200,104
Ra 236,2,62464
Vc 72,12,13
Maav 36,204,108
VE 14,146
Maav 68,200,112
VE 15,147
Maav 68,204,116
Ra 240,2,55296
Vc 73,14,15
Maav 100,200,120
Ra 244,2,63488
v_or3_b32 v7, v7, v72, v73
Maav 100,204,124
buffer_load_dwordx4 v4, s[12:15], s39 offen offset:1024 sc1 lds
Mvvv 48,16,96
VE 8,160
Mvvv 48,16,100
s_waitcnt lgkmcnt(6)
Ve 9,161
Maav 8,208,96
Ra 248,2,56320
Vc 80,8,9
Maav 8,212,100
VE 10,162
Maav 40,208,104
VE 11,163
Maav 40,212,108
Ra 252,2,64512
Vc 81,10,11
Maav 72,208,112
Ra 192,3,32768
v_or3_b32 v7, v7, v80, v81
Maav 72,212,116
VE 12,176
Maav 104,208,120
VE 13,177
Maav 104,212,124
Ra 196,3,33792
Vc 88,12,13
Maav 12,216,96
VE 14,178
Maav 12,220,100
VE 15,179
Maav 44,216,104
Ra 200,3,34816
Vc 89,14,15
Maav 44,220,108
buffer_load_dwordx4 v4, s[12:15], s39 offen offset:2048 sc1 lds
Maav 76,216,112
Ra 204,3,35840
v_or3_b32 v7, v7, v88, v89
Maav 76,220,116
VE 8,132
Maav 108,216,120
VE 9,133
Maav 108,220,124
VE 10,134
Mvvv 52,16,104
VE 11,135
Mvvv 52,16,108
s_waitcnt lgkmcnt(8)
Ve 12,148
Maav 16,224,96
Ra 208,3,36864
Vc 66,8,9
Maav 16,228,100
Ra 212,3,37888
Vc 67,10,11
Maav 48,224,104
Ra 216,3,38912
v_or3_b32 v7, v7, v66, v67
Maav 48,228,108
VE 13,149
Maav 80,224,112
Ra 220,3,39936
Vc 74,12,13
Maav 80,228,116
VE 14,150
Maav 112,224,120
buffer_load_dwordx4 v4, s[12:15], s39 offen offset:3072 sc1 lds
Maav 112,228,124
s_add_u32 s39, s39, 34816
VE 15,151
Maav 20,232,96
VE 8,164
Maav 20,236,100
VE 9,165
Maav 52,232,104
VE 10,166
Maav 52,236,108
VE 11,167
Maav 84,232,112
Vc 75,14,15
Vc 82,8,9
Maav 84,236,116
VE 12,180
Maav 116,232,120
VE 13,181
Maav 116,236,124
Vc 83,10,11
Vc 90,12,13
Mvvv 56,16,112
VE 14,182
Mvvv 56,16,116
s_waitcnt lgkmcnt(8)
Ve 15,183
Maav 24,240,96
Vc 91,14,15
v_or3_b32 v7, v7, v74, v75
Maav 24,244,100
v_or3_b32 v7, v7, v82, v83
v_or3_b32 v7, v7, v90, v91
Maav 56,240,104
global_load_dword v30, v[28:29], off
Maav 56,244,108
Maav 88,240,112
Maav 88,244,116
Maav 120,240,120
Maav 120,244,124
Maav 28,248,96
Maav 28,252,100
Maav 60,248,104
Maav 60,252,108
Maav 92,248,112
Maav 92,252,116
Maav 124,248,120
Maav 124,252,124
s_cmp_lg_u32 s37, s35
Mvvv 60,16,120
s_waitcnt lgkmcnt(4)
Mvvv 60,16,124
s_cbranch_scc1 L_k2_wloop
L_k2_wlast:
v_xor_b32 v2, 65536, v2
v_xor_b32 v3, 65536, v3
Cvaa 192,192,128,32
s_mov_b32 m0, s53
Ra 224,2,40960
v_lshl_add_u64 v[28:29], s[40:41], 0, v[28:29]
Mvaa 192,196,132
buffer_load_dwordx4 v4, s[12:15], s38 offen offset:0 sc1 lds
Mvaa 192,200,136
VE 8,136
Mvaa 192,204,140
VE 9,137
Cvaa 208,192,144,36
Ra 228,2,41984
Vc 68,8,9
Mvaa 208,196,148
VE 10,138
Mvaa 208,200,152
VE 11,139
Mvaa 208,204,156
Ra 232,2,43008
Vc 69,10,11
Cvaa 224,192,160,40
Ra 236,2,44032
v_or3_b32 v7, v7, v68, v69
Mvaa 224,196,164
VE 12,152
Mvaa 224,200,168
VE 13,153
Mvaa 224,204,172
s_waitcnt lgkmcnt(4)
Ra 240,2,45056
Vc 76,12,13
Cvaa 196,208,128,32
buffer_load_dwordx4 v4, s[12:15], s38 offen offset:1024 sc1 lds
Mvaa 196,212,132
Ve 14,154
Mvaa 196,216,136
VE 15,155
Mvaa 196,220,140
Ra 244,2,46080
Vc 77,14,15
Cvaa 212,208,144,36
Ra 248,2,47104
v_or3_b32 v7, v7, v76, v77
Mvaa 212,212,148
VE 8,168
Mvaa 212,216,152
VE 9,169
Mvaa 212,220,156
Ra 252,2,48128
Vc 84,8,9
Cvaa 228,208,160,40
VE 10,170
Mvaa 228,212,164
buffer_load_dwordx4 v4, s[12:15], s38 offen offset:2048 sc1 lds
Mvaa 228,216,168
VE 11,171
Mvaa 228,220,172
s_waitcnt lgkmcnt(4)
Ra 192,2,16384
Vc 85,10,11
Cvaa 200,224,128,32
Ra 196,2,24576
v_or3_b32 v7, v7, v84, v85
Mvaa 200,228,132
Ve 12,184
Mvaa 200,232,136
VE 13,185
Mvaa 200,236,140
Ra 200,2,17408
Vc 92,12,13
Cvaa 216,224,144,36
VE 14,186
Mvaa 216,228,148
VE 15,187
Mvaa 216,232,152
Ra 204,2,25600
Vc 93,14,15
Mvaa 216,236,156
buffer_load_dwordx4 v4, s[12:15], s38 offen offset:3072 sc1 lds
Cvaa 232,224,160,40
Ra 208,2,18432
v_or3_b32 v7, v7, v92, v93
Mvaa 232,228,164
VE 8,140
Mvaa 232,232,168
VE 9,141
Mvaa 232,236,172
s_waitcnt lgkmcnt(5)
Ra 212,2,26624
Vc 70,8,9
Cvaa 204,240,128,32
Ve 10,142
Mvaa 204,244,132
VE 11,143
Mvaa 204,248,136
Ra 216,2,19456
Vc 71,10,11
Mvaa 204,252,140
Ra 220,2,27648
v_or3_b32 v7, v7, v70, v71
Cvaa 220,240,144,36
VE 12,156
Mvaa 220,244,148
VE 13,157
Mvaa 220,248,152
VE 14,158
Mvaa 220,252,156
s_waitcnt vmcnt(12)
Ve 15,159
Cvaa 236,240,160,40
VE 8,172
Mvaa 236,244,164
s_barrier
Ve 9,173
Mvaa 236,248,168
s_waitcnt lgkmcnt(4)
Vc 78,12,13
Vc 79,14,15
Ve 10,174
Ve 11,175
Ve 12,188
Ve 13,189
Ve 14,190
VE 15,191
Vc 86,8,9
Vc 87,10,11
Vc 94,12,13
Vc 95,14,15
v_or3_b32 v7, v7, v78, v79
v_or3_b32 v7, v7, v86, v87
v_or3_b32 v7, v7, v94, v95
v_and_b32 v1, 0x40004000, v7
v_cmp_ne_u32 vcc, 0, v1
Mvaa 236,252,172
s_cbranch_vccnz L_k2_fb_wl
L_k2_fbr_wl:
Maav 0,192,64
v_cmp_gt_i32 s[56:57], 0, v6
v_cmp_gt_i32 s[58:59], 1, v6
v_cmp_gt_i32 s[60:61], 2, v6
v_cmp_gt_i32 s[62:63], 3, v6
s_nop 3
s_nop 0
v_cndmask_b32 v224, v224, v20, s[56:57]
v_cndmask_b32 v225, v225, v20, s[58:59]
v_cndmask_b32 v226, v226, v20, s[60:61]
v_cndmask_b32 v227, v227, v20, s[62:63]
v_cmp_gt_i32 s[56:57], 16, v6
v_cmp_gt_i32 s[58:59], 17, v6
v_cmp_gt_i32 s[60:61], 18, v6
v_cmp_gt_i32 s[62:63], 19, v6
v_cndmask_b32 v228, v228, v20, s[56:57]
v_cndmask_b32 v229, v229, v20, s[58:59]
v_cndmask_b32 v230, v230, v20, s[60:61]
v_cndmask_b32 v231, v231, v20, s[62:63]
v_cmp_gt_i32 s[56:57], 32, v6
v_cmp_gt_i32 s[58:59], 33, v6
v_cmp_gt_i32 s[60:61], 34, v6
v_cmp_gt_i32 s[62:63], 35, v6
v_cndmask_b32 v232, v232, v20, s[56:57]
v_cndmask_b32 v233, v233, v20, s[58:59]
v_cndmask_b32 v234, v234, v20, s[60:61]
v_cndmask_b32 v235, v235, v20, s[62:63]
v_cmp_gt_i32 s[56:57], 48, v6
v_cmp_gt_i32 s[58:59], 49, v6
v_cmp_gt_i32 s[60:61], 50, v6
v_cmp_gt_i32 s[62:63], 51, v6
v_cndmask_b32 v236, v236, v20, s[56:57]
v_cndmask_b32 v237, v237, v20, s[58:59]
v_cndmask_b32 v238, v238, v20, s[60:61]
v_cndmask_b32 v239, v239, v20, s[62:63]
VE 8,192
Maav 0,196,68
s_add_u32 m0, s54, 49152
VE 9,193
Maav 32,192,72
buffer_load_dwordx4 v4, s[12:15], s39 offen offset:0 sc1 lds
Maav 32,196,76
s_add_u32 s37, s37, 1
Ra 224,2,20480
Vc 96,8,9
Maav 64,192,80
s_add_u32 s38, s38, 34816
Ve 10,194
Maav 64,196,84
VE 11,195
Maav 96,192,88
Ra 228,2,28672
Vc 97,10,11
Maav 96,196,92
buffer_load_dwordx4 v4, s[12:15], s39 offen offset:1024 sc1 lds
Maav 4,200,64
Ra 232,2,21504
v_or_b32_e64 v7, v96, v97
Maav 4,204,68
VE 12,208
Maav 36,200,72
VE 13,209
Maav 36,204,76
Ra 236,2,29696
Vc 104,12,13
Maav 68,200,80
buffer_load_dwordx4 v4, s[12:15], s39 offen offset:2048 sc1 lds
Maav 68,204,84
VE 14,210
Maav 100,200,88
VE 15,211
Maav 100,204,92
Ra 240,2,22528
Vc 105,14,15
Mvvv 48,16,64
Ra 244,2,30720
v_or3_b32 v7, v7, v104, v105
Mvvv 48,16,68
s_waitcnt lgkmcnt(6)
Ve 8,224
Maav 8,208,64
buffer_load_dwordx4 v4, s[12:15], s39 offen offset:3072 sc1 lds
Maav 8,212,68
s_add_u32 s39, s39, 34816
VE 9,225
Maav 40,208,72
Ra 248,2,23552
Vc 112,8,9
Maav 40,212,76
VE 10,226
Maav 72,208,80
global_load_dword v30, v[28:29], off
Maav 72,212,84
VE 11,227
Maav 104,208,88
Ra 252,2,31744
Vc 113,10,11
Maav 104,212,92
Ra 192,3,0
v_or3_b32 v7, v7, v112, v113
Maav 12,216,64
VE 12,196
Maav 12,220,68
s_add_u32 m0, s44, 131072
s_add_u32 s3, s5, 0
Ve 13,197
Maav 44,216,72
buffer_load_dwordx4 v24, s[24:27], s3 offen offset:0 lds
Maav 44,220,76
Ra 196,3,1024
Vc 98,12,13
Maav 76,216,80
VE 14,198
Maav 76,220,84
VE 15,199
Maav 108,216,88
s_add_u32 s3, s5, 27648
Ra 200,3,2048
Vc 99,14,15
Maav 108,220,92
buffer_load_dwordx4 v24, s[24:27], s3 offen offset:1024 lds
Mvvv 52,16,72
Ra 204,3,3072
v_or3_b32 v7, v7, v98, v99
Mvvv 52,16,76
s_waitcnt lgkmcnt(8)
Ve 8,212
Maav 16,224,64
VE 9,213
Maav 16,228,68
s_add_u32 s3, s5, 55296
Ra 208,3,4096
Vc 106,8,9
Maav 48,224,72
buffer_load_dwordx4 v25, s[24:27], s3 offen offset:2048 lds
Maav 48,228,76
VE 10,214
Maav 80,224,80
VE 11,215
Maav 80,228,84
Ra 212,3,5120
Vc 107,10,11
Maav 112,224,88
s_add_u32 s3, s5, 82944
Ra 216,3,6144
v_or3_b32 v7, v7, v106, v107
Maav 112,228,92
buffer_load_dwordx4 v25, s[24:27], s3 offen offset:3072 lds
Maav 20,232,64
VE 12,228
Maav 20,236,68
VE 13,229
Maav 52,232,72
Ra 220,3,7168
Vc 114,12,13
Maav 52,236,76
VE 14,230
Maav 84,232,80
s_add_u32 m0, s44, 147456
s_add_u32 s3, s5, 458752
VE 15,231
Maav 84,236,84
buffer_load_dwordx4 v24, s[24:27], s3 offen offset:0 lds
Maav 116,232,88
VE 8,200
Maav 116,236,92
VE 9,201
Mvvv 56,16,80
VE 10,202
Mvvv 56,16,84
s_waitcnt lgkmcnt(8)
Ve 11,203
Maav 24,240,64
s_add_u32 s3, s5, 486400
Vc 115,14,15
Vc 100,8,9
Maav 24,244,68
buffer_load_dwordx4 v24, s[24:27], s3 offen offset:1024 lds
Maav 56,240,72
VE 12,216
Maav 56,244,76
VE 13,217
Maav 88,240,80
s_add_u32 s3, s5, 514048
Vc 101,10,11
Vc 108,12,13
Maav 88,244,84
buffer_load_dwordx4 v25, s[24:27], s3 offen offset:2048 lds
Maav 120,240,88
VE 14,218
Maav 120,244,92
VE 15,219
Maav 28,248,64
Vc 109,14,15
v_or3_b32 v7, v7, v114, v115
Maav 28,252,68
s_add_u32 s3, s5, 541696
VE 8,232
Maav 60,248,72
buffer_load_dwordx4 v25, s[24:27], s3 offen offset:3072 lds
Maav 60,252,76
VE 9,233
Maav 92,248,80
Vc 116,8,9
v_or3_b32 v7, v7, v100, v101
Maav 92,252,84
VE 10,234
Maav 124,248,88
VE 11,235
Maav 124,252,92
Vc 117,10,11
v_or3_b32 v7, v7, v108, v109
Mvvv 60,16,88
s_waitcnt lgkmcnt(4)
v_or3_b32 v7, v7, v116, v117
Mvvv 60,16,92
Ve 12,204
Cvaa 128,192,128,32
s_add_u32 m0, s53, 32768
VE 13,205
Mvaa 128,196,132
buffer_load_dwordx4 v4, s[12:15], s38 offen offset:0 sc1 lds
Mvaa 128,200,136
Ra 224,3,8192
Vc 102,12,13
Mvaa 128,204,140
VE 14,206
Cvaa 144,192,144,36
VE 15,207
Mvaa 144,196,148
Ra 228,3,9216
Vc 103,14,15
Mvaa 144,200,152
Ra 232,3,10240
v_or3_b32 v7, v7, v102, v103
Mvaa 144,204,156
s_waitcnt lgkmcnt(3)
Ra 236,3,11264
Ra 240,3,12288
Cvaa 132,208,128,32
buffer_load_dwordx4 v4, s[12:15], s38 offen offset:1024 sc1 lds
Mvaa 132,212,132
Ve 8,220
Mvaa 132,216,136
VE 9,221
Mvaa 132,220,140
Ra 244,3,13312
Vc 110,8,9
Cvaa 148,208,144,36
VE 10,222
Mvaa 148,212,148
buffer_load_dwordx4 v4, s[12:15], s38 offen offset:2048 sc1 lds
Mvaa 148,216,152
VE 11,223
Mvaa 148,220,156
s_waitcnt lgkmcnt(2)
Ra 248,3,14336
Ra 252,3,15360
Cvaa 136,224,128,32
Ra 192,2,49152
Vc 111,10,11
Mvaa 136,228,132
Ra 196,2,57344
v_or3_b32 v7, v7, v110, v111
Mvaa 136,232,136
Ve 12,236
Mvaa 136,236,140
buffer_load_dwordx4 v4, s[12:15], s38 offen offset:3072 sc1 lds
Cvaa 152,224,144,36
VE 13,237
Mvaa 152,228,148
Ra 200,2,50176
Vc 118,12,13
Mvaa 152,232,152
VE 14,238
Mvaa 152,236,156
s_waitcnt lgkmcnt(3)
Ra 204,2,58368
Ra 208,2,51200
Cvaa 140,240,128,32
Ve 15,239
Mvaa 140,244,132
Ra 212,2,59392
Vc 119,14,15
Mvaa 140,248,136
Ra 216,2,52224
v_or3_b32 v7, v7, v118, v119
Mvaa 140,252,140
s_waitcnt vmcnt(12)
Ra 220,2,60416
v_and_b32 v1, 0x40004000, v7
Cvaa 156,240,144,36
s_cmp_eq_u32 s37, s45
v_cmp_ne_u32 vcc, 0, v1
Mvaa 156,244,148
s_barrier
Mvaa 156,248,152
s_waitcnt lgkmcnt(4)
Mvaa 156,252,156
s_cbranch_vccnz L_k2_fb_tr
L_k2_fbr_tr:
Maav 0,192,96
s_cbranch_scc1 L_k2_mk_tr
L_k2_mkr_tr:
Ve 8,128
Maav 0,196,100
s_add_u32 m0, s53, 16384
VE 9,129
Maav 32,192,104
buffer_load_dwordx4 v4, s[12:15], s39 offen offset:0 sc1 lds
Maav 32,196,108
s_add_u32 s37, s37, 1
Ra 224,2,53248
Vc 64,8,9
Maav 64,192,112
s_add_u32 s38, s38, 34816
Ve 10,130
Maav 64,196,116
s_xor_b32 s53, s53, 65536
VE 11,131
Maav 4,200,96
s_xor_b32 s54, s54, 65536
Ra 228,2,61440
Vc 65,10,11
Maav 4,204,100
Ra 232,2,54272
v_or_b32_e64 v7, v64, v65
Maav 36,200,104
VE 12,144
Maav 36,204,108
VE 13,145
Maav 68,200,112
Ra 236,2,62464
Vc 72,12,13
Maav 68,204,116
VE 14,146
Mvvv 48,16,96
VE 15,147
Mvvv 48,16,100
s_waitcnt lgkmcnt(4)
Ra 240,2,55296
Vc 73,14,15
Maav 8,208,96
buffer_load_dwordx4 v4, s[12:15], s39 offen offset:1024 sc1 lds
Maav 8,212,100
Ra 244,2,63488
v_or3_b32 v7, v7, v72, v73
Maav 40,208,104
Ve 8,132
Maav 40,212,108
VE 9,133
Maav 72,208,112
Ra 248,2,56320
Vc 66,8,9
Maav 72,212,116
VE 10,134
Maav 12,216,96
VE 11,135
Maav 12,220,100
Ra 252,2,64512
Vc 67,10,11
Maav 44,216,104
Ra 192,3,32768
v_or3_b32 v7, v7, v66, v67
Maav 44,220,108
VE 12,148
Maav 76,216,112
VE 13,149
Maav 76,220,116
Ra 196,3,33792
Vc 74,12,13
Mvvv 52,16,104
VE 14,150
Mvvv 52,16,108
s_waitcnt lgkmcnt(6)
Ve 15,151
Maav 16,224,96
buffer_load_dwordx4 v4, s[12:15], s39 offen offset:2048 sc1 lds
Maav 16,228,100
Ra 200,3,34816
Vc 75,14,15
Maav 48,224,104
Ra 204,3,35840
v_or3_b32 v7, v7, v74, v75
Maav 48,228,108
VE 8,136
Maav 80,224,112
Ra 208,3,36864
Ra 212,3,37888
Maav 80,228,116
Ra 216,3,38912
Ra 220,3,39936
Maav 20,232,96
Maav 20,236,100
Maav 52,232,104
Maav 52,236,108
Maav 84,232,112
Maav 84,236,116
buffer_load_dwordx4 v4, s[12:15], s39 offen offset:3072 sc1 lds
Mvvv 56,16,112
s_add_u32 s39, s39, 34816
Mvvv 56,16,116
s_waitcnt lgkmcnt(8)
Maav 24,240,96
Maav 24,244,100
Maav 56,240,104
Maav 56,244,108
Maav 88,240,112
Maav 88,244,116
Maav 28,248,96
Maav 28,252,100
Maav 60,248,104
Maav 60,252,108
Maav 92,248,112
s_waitcnt lgkmcnt(4)
Maav 92,252,116
s_getpc_b64 s[56:57]
L_cpf4:
s_add_u32 s56, s56, (L_k2_fin-L_cpf4)&0xffffffff
s_addc_u32 s57, s57, ((L_k2_fin-L_cpf4)>>32)&0xffffffff
s_lshr_b32 s58, s2, 3
s_lshl_b32 s58, s58, 2
s_add_u32 s58, s58, s32
s_lshl_b32 s58, s58, 10
v_and_b32 v162, 7, v0
v_lshlrev_b32 v162, 7, v162
v_add_u32 v162, s58, v162
v_min_u32 v162, L_p4_end-L_k2_fin-4, v162
v_mov_b32 v161, s57
v_add_co_u32 v160, vcc, s56, v162
s_nop 1
v_addc_co_u32 v161, vcc, 0, v161, vcc
global_load_dword v164, v[160:161], off
s_waitcnt vmcnt(9)
s_lshl_b32 s3, s34, 20
s_lshl_b32 s47, s33, 15
s_add_u32 s3, s3, s47
s_lshl_b32 s47, s32, 10
v_lshlrev_b32 v248, 4, v0
v_add_u32_e64 v249, s47, v248
s_sub_u32 s47, 7168, s47
v_add_u32 v248, s47, v248
v_rcp_f32 v250, v56
v_rcp_f32 v252, v60
v_mov_b32 v251, v250
v_mov_b32_e64 v253, v252
Ar 240,96
Ar 241,97
Ar 242,98
Ar 243,99
Ar 244,100
Ar 245,101
Ar 246,102
Ar 247,103
v_pk_mul_f32 v[240:241], v[240:241], v[252:253]
v_pk_mul_f32 v[242:243], v[242:243], v[252:253]
v_pk_mul_f32 v[244:245], v[244:245], v[252:253]
v_pk_mul_f32 v[246:247], v[246:247], v[252:253]
Vc 28,240,241
Vc 29,242,243
Vc 30,244,245
Vc 31,246,247
buffer_store_dwordx4 v[28:31], v249, s[16:19], s3 offen sc1
Ar 240,64
Ar 241,65
Ar 242,66
Ar 243,67
Ar 244,68
Ar 245,69
Ar 246,70
Ar 247,71
v_pk_mul_f32 v[240:241], v[240:241], v[250:251]
v_pk_mul_f32 v[242:243], v[242:243], v[250:251]
v_pk_mul_f32 v[244:245], v[244:245], v[250:251]
v_pk_mul_f32 v[246:247], v[246:247], v[250:251]
Vc 24,240,241
Vc 25,242,243
Vc 26,244,245
Vc 27,246,247
buffer_store_dwordx4 v[24:27], v248, s[16:19], s3 offen sc1
s_add_u32 s3, s3, 8192
Ar 240,104
Ar 241,105
Ar 242,106
Ar 243,107
Ar 244,108
Ar 245,109
Ar 246,110
Ar 247,111
v_pk_mul_f32 v[240:241], v[240:241], v[252:253]
v_pk_mul_f32 v[242:243], v[242:243], v[252:253]
v_pk_mul_f32 v[244:245], v[244:245], v[252:253]
v_pk_mul_f32 v[246:247], v[246:247], v[252:253]
Vc 28,240,241
Vc 29,242,243
Vc 30,244,245
Vc 31,246,247
buffer_store_dwordx4 v[28:31], v249, s[16:19], s3 offen sc1
Ar 240,72
Ar 241,73
Ar 242,74
Ar 243,75
Ar 244,76
Ar 245,77
Ar 246,78
Ar 247,79
v_pk_mul_f32 v[240:241], v[240:241], v[250:251]
v_pk_mul_f32 v[242:243], v[242:243], v[250:251]
v_pk_mul_f32 v[244:245], v[244:245], v[250:251]
v_pk_mul_f32 v[246:247], v[246:247], v[250:251]
Vc 24,240,241
Vc 25,242,243
Vc 26,244,245
Vc 27,246,247
buffer_store_dwordx4 v[24:27], v248, s[16:19], s3 offen sc1
s_add_u32 s3, s3, 8192
Ar 240,112
Ar 241,113
Ar 242,114
Ar 243,115
Ar 244,116
Ar 245,117
Ar 246,118
Ar 247,119
v_pk_mul_f32 v[240:241], v[240:241], v[252:253]
v_pk_mul_f32 v[242:243], v[242:243], v[252:253]
v_pk_mul_f32 v[244:245], v[244:245], v[252:253]
v_pk_mul_f32 v[246:247], v[246:247], v[252:253]
Vc 28,240,241
Vc 29,242,243
Vc 30,244,245
Vc 31,246,247
buffer_store_dwordx4 v[28:31], v249, s[16:19], s3 offen sc1
Ar 240,80
Ar 241,81
Ar 242,82
Ar 243,83
Ar 244,84
Ar 245,85
Ar 246,86
Ar 247,87
v_pk_mul_f32 v[240:241], v[240:241], v[250:251]
v_pk_mul_f32 v[242:243], v[242:243], v[250:251]
v_pk_mul_f32 v[244:245], v[244:245], v[250:251]
v_pk_mul_f32 v[246:247], v[246:247], v[250:251]
Vc 24,240,241
Vc 25,242,243
Vc 26,244,245
Vc 27,246,247
buffer_store_dwordx4 v[24:27], v248, s[16:19], s3 offen sc1
s_add_u32 s3, s3, 8192
Ar 240,120
Ar 241,121
Ar 242,122
Ar 243,123
Ar 244,124
Ar 245,125
Ar 246,126
Ar 247,127
v_pk_mul_f32 v[240:241], v[240:241], v[252:253]
v_pk_mul_f32 v[242:243], v[242:243], v[252:253]
v_pk_mul_f32 v[244:245], v[244:245], v[252:253]
v_pk_mul_f32 v[246:247], v[246:247], v[252:253]
Vc 28,240,241
Vc 29,242,243
Vc 30,244,245
Vc 31,246,247
buffer_store_dwordx4 v[28:31], v249, s[16:19], s3 offen sc1
Ar 240,88
Ar 241,89
Ar 242,90
Ar 243,91
Ar 244,92
Ar 245,93
Ar 246,94
Ar 247,95
v_pk_mul_f32 v[240:241], v[240:241], v[250:251]
v_pk_mul_f32 v[242:243], v[242:243], v[250:251]
v_pk_mul_f32 v[244:245], v[244:245], v[250:251]
v_pk_mul_f32 v[246:247], v[246:247], v[250:251]
Vc 24,240,241
Vc 25,242,243
Vc 26,244,245
Vc 27,246,247
buffer_store_dwordx4 v[24:27], v248, s[16:19], s3 offen sc1
s_add_u32 s52, s37, 2
s_load_dwordx2 s[94:95], s[0:1], 40
s_load_dwordx2 s[40:41], s[0:1], 0
s_load_dwordx4 s[8:11], s[0:1], 80
s_waitcnt vmcnt(8) lgkmcnt(0)
s_cmp_eq_u32 s34, 7
s_cbranch_scc1 L_k2_fin
L_k2_nloop:
v_xor_b32 v2, 65536, v2
v_xor_b32 v3, 65536, v3
Cvaa 192,192,128,32
s_mov_b32 m0, s53
Ve 9,137
Mvaa 192,196,132
buffer_load_dwordx4 v4, s[12:15], s38 offen offset:0 sc1 lds
Mvaa 192,200,136
Ra 224,2,40960
Vc 68,8,9
Mvaa 192,204,140
VE 10,138
Cvaa 208,192,144,36
VE 11,139
Mvaa 208,196,148
Ra 228,2,41984
Vc 69,10,11
Mvaa 208,200,152
Ra 232,2,43008
v_or3_b32 v7, v7, v68, v69
Mvaa 208,204,156
s_waitcnt lgkmcnt(3)
Ra 236,2,44032
Ra 240,2,45056
Cvaa 196,208,128,32
buffer_load_dwordx4 v4, s[12:15], s38 offen offset:1024 sc1 lds
Mvaa 196,212,132
Ve 12,152
Mvaa 196,216,136
VE 13,153
Mvaa 196,220,140
Ra 244,2,46080
Vc 76,12,13
Cvaa 212,208,144,36
VE 14,154
Mvaa 212,212,148
buffer_load_dwordx4 v4, s[12:15], s38 offen offset:2048 sc1 lds
Mvaa 212,216,152
VE 15,155
Mvaa 212,220,156
s_waitcnt lgkmcnt(2)
Ra 248,2,47104
Ra 252,2,48128
Cvaa 200,224,128,32
Ra 192,2,16384
Vc 77,14,15
Mvaa 200,228,132
Ra 196,2,24576
v_or3_b32 v7, v7, v76, v77
Mvaa 200,232,136
Ve 8,140
Mvaa 200,236,140
buffer_load_dwordx4 v4, s[12:15], s38 offen offset:3072 sc1 lds
Cvaa 216,224,144,36
VE 9,141
Mvaa 216,228,148
Ra 200,2,17408
Vc 70,8,9
Mvaa 216,232,152
VE 10,142
Mvaa 216,236,156
s_waitcnt lgkmcnt(3)
Ra 204,2,25600
Ra 208,2,18432
Cvaa 204,240,128,32
Ve 11,143
Mvaa 204,244,132
s_cmp_lt_u32 s37, s52
Ra 212,2,26624
Vc 71,10,11
Mvaa 204,248,136
s_cbranch_scc1 L_nw_ne
s_waitcnt vmcnt(12)
L_nw_ne:
Ra 216,2,19456
v_or3_b32 v7, v7, v70, v71
Mvaa 204,252,140
Ve 12,156
Cvaa 220,240,144,36
VE 13,157
Mvaa 220,244,148
s_barrier
Ra 220,2,27648
Vc 78,12,13
Mvaa 220,248,152
s_waitcnt lgkmcnt(4)
Ve 14,158
Ve 15,159
s_nop 0
Vc 79,14,15
v_or3_b32 v7, v7, v78, v79
v_and_b32 v1, 0x40004000, v7
v_cmp_ne_u32 vcc, 0, v1
Mvaa 220,252,156
s_cbranch_vccnz L_k2_fb_ne
L_k2_fbr_ne:
Maav 0,192,64
Ve 8,192
Maav 0,196,68
s_add_u32 m0, s54, 49152
VE 9,193
Maav 32,192,72
buffer_load_dwordx4 v4, s[12:15], s39 offen offset:0 sc1 lds
Maav 32,196,76
s_cmp_eq_u32 s37, s52
Ra 224,2,20480
Vc 96,8,9
Maav 4,200,64
s_cbranch_scc1 L_pubB
L_pubBr:
VE 10,194
Maav 4,204,68
s_add_u32 s37, s37, 1
Ve 11,195
Maav 36,200,72
s_add_u32 s38, s38, 34816
Ra 228,2,28672
Vc 97,10,11
Maav 36,204,76
Ra 232,2,21504
v_or_b32_e64 v7, v96, v97
Mvvv 48,16,64
VE 12,208
Mvvv 48,16,68
s_waitcnt lgkmcnt(3)
Ra 236,2,29696
Ra 240,2,22528
Maav 8,208,64
buffer_load_dwordx4 v4, s[12:15], s39 offen offset:1024 sc1 lds
Maav 8,212,68
Ve 13,209
Maav 40,208,72
Ra 244,2,30720
Vc 104,12,13
Maav 40,212,76
VE 14,210
Maav 12,216,64
VE 15,211
Maav 12,220,68
Ra 248,2,23552
Vc 105,14,15
Maav 44,216,72
Ra 252,2,31744
v_or3_b32 v7, v7, v104, v105
Maav 44,220,76
VE 8,196
Mvvv 52,16,72
buffer_load_dwordx4 v4, s[12:15], s39 offen offset:2048 sc1 lds
Mvvv 52,16,76
s_waitcnt lgkmcnt(4)
Ve 9,197
Maav 16,224,64
Ra 192,3,0
Vc 98,8,9
Maav 16,228,68
VE 10,198
Maav 48,224,72
VE 11,199
Maav 48,228,76
Ra 196,3,1024
Vc 99,10,11
Maav 20,232,64
Ra 200,3,2048
v_or3_b32 v7, v7, v98, v99
Maav 20,236,68
Ra 204,3,3072
Ra 208,3,4096
Maav 52,232,72
buffer_load_dwordx4 v4, s[12:15], s39 offen offset:3072 sc1 lds
Maav 52,236,76
s_waitcnt lgkmcnt(5)
Ve 12,212
Maav 24,240,64
s_add_u32 s39, s39, 34816
VE 13,213
Maav 24,244,68
Ra 212,3,5120
Vc 106,12,13
Maav 56,240,72
VE 14,214
Maav 56,244,76
VE 15,215
Maav 28,248,64
Ra 216,3,6144
Vc 107,14,15
Maav 28,252,68
Ra 220,3,7168
v_or3_b32 v7, v7, v106, v107
Maav 60,248,72
s_waitcnt lgkmcnt(4)
Ve 8,200
Maav 60,252,76
VE 9,201
Cvaa 128,192,128,32
s_add_u32 m0, s53, 32768
Ra 224,3,8192
Vc 100,8,9
Mvaa 128,196,132
buffer_load_dwordx4 v4, s[12:15], s38 offen offset:0 sc1 lds
Mvaa 128,200,136
VE 10,202
Mvaa 128,204,140
VE 11,203
Cvaa 144,192,144,36
Ra 228,3,9216
Vc 101,10,11
Mvaa 144,196,148
Ra 232,3,10240
v_or3_b32 v7, v7, v100, v101
Mvaa 144,200,152
VE 12,216
Mvaa 144,204,156
s_waitcnt lgkmcnt(3)
Ra 236,3,11264
Ra 240,3,12288
Cvaa 132,208,128,32
buffer_load_dwordx4 v4, s[12:15], s38 offen offset:1024 sc1 lds
Mvaa 132,212,132
Ve 13,217
Mvaa 132,216,136
Ra 244,3,13312
Vc 108,12,13
Mvaa 132,220,140
VE 14,218
Cvaa 148,208,144,36
VE 15,219
Mvaa 148,212,148
buffer_load_dwordx4 v4, s[12:15], s38 offen offset:2048 sc1 lds
Mvaa 148,216,152
Ra 248,3,14336
Vc 109,14,15
Mvaa 148,220,156
s_waitcnt lgkmcnt(3)
Ra 252,3,15360
v_or3_b32 v7, v7, v108, v109
Cvaa 136,224,128,32
Ve 8,204
Mvaa 136,228,132
VE 9,205
Mvaa 136,232,136
Ra 192,2,49152
Vc 102,8,9
Mvaa 136,236,140
buffer_load_dwordx4 v4, s[12:15], s38 offen offset:3072 sc1 lds
Cvaa 152,224,144,36
VE 10,206
Mvaa 152,228,148
VE 11,207
Mvaa 152,232,152
Ra 196,2,57344
Vc 103,10,11
Mvaa 152,236,156
s_waitcnt lgkmcnt(2)
Ra 200,2,50176
Ra 204,2,58368
Cvaa 140,240,128,32
Ra 208,2,51200
v_or3_b32 v7, v7, v102, v103
Mvaa 140,244,132
s_cmp_lt_u32 s37, s52
VE 12,220
Mvaa 140,248,136
s_cbranch_scc1 L_nw_no
s_waitcnt vmcnt(12)
L_nw_no:
VE 13,221
Mvaa 140,252,140
Ra 212,2,59392
Vc 110,12,13
Cvaa 156,240,144,36
s_cmp_eq_u32 s37, s45
Ve 14,222
Mvaa 156,244,148
s_barrier
Ve 15,223
Mvaa 156,248,152
s_waitcnt lgkmcnt(2)
Ra 216,2,52224
Vc 111,14,15
v_or3_b32 v7, v7, v110, v111
v_and_b32 v1, 0x40004000, v7
v_cmp_ne_u32 vcc, 0, v1
Mvaa 156,252,156
s_cbranch_vccnz L_k2_fb_no
L_k2_fbr_no:
Ra 220,2,60416
Maav 0,192,96
s_cbranch_scc1 L_k2_mk_no
L_k2_mkr_no:
VE 8,128
Maav 0,196,100
s_add_u32 m0, s53, 16384
VE 9,129
Maav 32,192,104
buffer_load_dwordx4 v4, s[12:15], s39 offen offset:0 sc1 lds
Maav 32,196,108
s_add_u32 s37, s37, 1
Ra 224,2,53248
Vc 64,8,9
Maav 4,200,96
s_add_u32 s38, s38, 34816
Ve 10,130
Maav 4,204,100
s_xor_b32 s53, s53, 65536
VE 11,131
Maav 36,200,104
s_xor_b32 s54, s54, 65536
Ra 228,2,61440
Vc 65,10,11
Maav 36,204,108
Ra 232,2,54272
v_or_b32_e64 v7, v64, v65
Mvvv 48,16,96
VE 12,144
Mvvv 48,16,100
s_waitcnt lgkmcnt(3)
Ra 236,2,62464
Ra 240,2,55296
Maav 8,208,96
buffer_load_dwordx4 v4, s[12:15], s39 offen offset:1024 sc1 lds
Maav 8,212,100
Ve 13,145
Maav 40,208,104
Ra 244,2,63488
Vc 72,12,13
Maav 40,212,108
VE 14,146
Maav 12,216,96
VE 15,147
Maav 12,220,100
Ra 248,2,56320
Vc 73,14,15
Maav 44,216,104
Ra 252,2,64512
v_or3_b32 v7, v7, v72, v73
Maav 44,220,108
VE 8,132
Mvvv 52,16,104
buffer_load_dwordx4 v4, s[12:15], s39 offen offset:2048 sc1 lds
Mvvv 52,16,108
s_waitcnt lgkmcnt(4)
Ve 9,133
Maav 16,224,96
Ra 192,3,32768
Vc 66,8,9
Maav 16,228,100
VE 10,134
Maav 48,224,104
VE 11,135
Maav 48,228,108
Ra 196,3,33792
Vc 67,10,11
Maav 20,232,96
Ra 200,3,34816
v_or3_b32 v7, v7, v66, v67
Maav 20,236,100
Ra 204,3,35840
Ra 208,3,36864
Maav 52,232,104
buffer_load_dwordx4 v4, s[12:15], s39 offen offset:3072 sc1 lds
Maav 52,236,108
s_waitcnt lgkmcnt(5)
Ve 12,148
Maav 24,240,96
s_add_u32 s39, s39, 34816
VE 13,149
Maav 24,244,100
Ra 212,3,37888
Vc 74,12,13
Maav 56,240,104
VE 14,150
Maav 56,244,108
VE 15,151
Maav 28,248,96
Ra 216,3,38912
Vc 75,14,15
Maav 28,252,100
s_cmp_lg_u32 s37, s36
Ra 220,3,39936
v_or3_b32 v7, v7, v74, v75
Maav 60,248,104
s_waitcnt lgkmcnt(4)
VE 8,136
Maav 60,252,108
s_cbranch_scc1 L_k2_nloop
L_k2_fin:
v_xor_b32 v2, 65536, v2
v_xor_b32 v3, 65536, v3
s_lshr_b32 s3, s42, 4
s_mul_i32 s3, s3, 33792
s_and_b32 s47, s42, 15
s_lshl_b32 s47, s47, 4
s_add_u32 s3, s3, s47
v_mov_b32 v28, s3
s_lshr_b32 s3, s43, 4
s_mul_i32 s3, s3, 33792
s_and_b32 s47, s43, 15
s_lshl_b32 s47, s47, 4
s_add_u32 s3, s3, s47
v_mov_b32 v29, s3
v_lshrrev_b32 v24, 4, v0
v_and_b32 v25, 15, v0
v_cmp_eq_u32 vcc, 1, v25
s_lshl_b32 s3, s32, 4
v_add_u32 v26, s3, v24
v_cndmask_b32 v28, v28, v29, vcc
v_lshl_add_u32 v28, v24, 8, v28
v_mul_u32_u24 v26, 7168, v26
v_lshlrev_b32 v24, 1, v24
v_xor_b32 v24, v24, v25
v_xor_b32 v25, 8, v24
v_lshl_add_u32 v24, v24, 4, v26
v_lshl_add_u32 v25, v25, 4, v26
s_lshl_b32 s3, s92, 12
buffer_load_dwordx4 a[160:163], v28, s[20:23], s3 offen offset:0 sc1
buffer_load_dwordx4 a[164:167], v28, s[20:23], s3 offen offset:1024 sc1
buffer_load_dwordx4 a[168:171], v28, s[20:23], s3 offen offset:2048 sc1
buffer_load_dwordx4 a[172:175], v28, s[20:23], s3 offen offset:3072 sc1
Cvaa 192,192,128,32
s_add_u32 m0, s54, 0
s_add_u32 s3, s5, 0
Ve 9,137
Mvaa 192,196,132
buffer_load_dwordx4 v24, s[68:71], s3 offen offset:0 lds
Mvaa 192,200,136
Ra 224,2,40960
Ra 228,2,41984
Mvaa 192,204,140
s_waitcnt lgkmcnt(2)
Ra 232,2,43008
Ra 236,2,44032
Cvaa 196,208,128,32
s_add_u32 s3, s5, 27648
Ra 240,2,45056
Vc 68,8,9
Mvaa 196,212,132
buffer_load_dwordx4 v24, s[68:71], s3 offen offset:1024 lds
Mvaa 196,216,136
Ra 244,2,46080
Ra 248,2,47104
Mvaa 196,220,140
s_waitcnt lgkmcnt(3)
s_add_u32 s3, s5, 55296
Ra 252,2,48128
Ra 192,2,16384
Cvaa 200,224,128,32
buffer_load_dwordx4 v25, s[68:71], s3 offen offset:2048 lds
Mvaa 200,228,132
s_cmp_lt_u32 s37, s52
Ve 10,138
Mvaa 200,232,136
s_cbranch_scc1 L_nw_nl
s_waitcnt vmcnt(15)
L_nw_nl:
Ra 196,2,24576
Ra 200,2,17408
Mvaa 200,236,140
s_waitcnt lgkmcnt(3)
s_add_u32 s3, s5, 82944
Ra 204,2,25600
Ra 208,2,18432
Cvaa 204,240,128,32
buffer_load_dwordx4 v25, s[68:71], s3 offen offset:3072 lds
Mvaa 204,244,132
s_barrier
VE 11,139
Mvaa 204,248,136
s_waitcnt lgkmcnt(1)
Ra 212,2,26624
Vc 69,10,11
Ve 12,152
Ve 13,153
Ve 14,154
Ve 15,155
Ve 8,140
Ve 9,141
Ve 10,142
VE 11,143
Vc 76,12,13
Ve 12,156
Ve 13,157
Vc 77,14,15
Ve 14,158
Ve 15,159
Vc 70,8,9
Vc 71,10,11
Vc 78,12,13
Vc 79,14,15
v_or3_b32 v7, v7, v68, v69
v_or3_b32 v7, v7, v76, v77
v_or3_b32 v7, v7, v70, v71
v_or3_b32 v7, v7, v78, v79
v_and_b32 v1, 0x40004000, v7
v_cmp_ne_u32 vcc, 0, v1
Mvaa 204,252,140
s_cbranch_vccnz L_k2_fb_nl
L_k2_fbr_nl:
Ra 216,2,19456
Ra 220,2,27648
Maav 0,192,64
v_cmp_gt_i32 s[56:57], 0, v6
v_cmp_gt_i32 s[58:59], 1, v6
v_cmp_gt_i32 s[60:61], 2, v6
v_cmp_gt_i32 s[62:63], 3, v6
s_nop 3
s_nop 0
v_cndmask_b32 v192, v192, v20, s[56:57]
v_cndmask_b32 v193, v193, v20, s[58:59]
v_cndmask_b32 v194, v194, v20, s[60:61]
v_cndmask_b32 v195, v195, v20, s[62:63]
v_cmp_gt_i32 s[56:57], 16, v6
v_cmp_gt_i32 s[58:59], 17, v6
v_cmp_gt_i32 s[60:61], 18, v6
v_cmp_gt_i32 s[62:63], 19, v6
v_cndmask_b32 v196, v196, v20, s[56:57]
v_cndmask_b32 v197, v197, v20, s[58:59]
v_cndmask_b32 v198, v198, v20, s[60:61]
v_cndmask_b32 v199, v199, v20, s[62:63]
v_cmp_gt_i32 s[56:57], 32, v6
v_cmp_gt_i32 s[58:59], 33, v6
v_cmp_gt_i32 s[60:61], 34, v6
v_cmp_gt_i32 s[62:63], 35, v6
v_cndmask_b32 v200, v200, v20, s[56:57]
v_cndmask_b32 v201, v201, v20, s[58:59]
v_cndmask_b32 v202, v202, v20, s[60:61]
v_cndmask_b32 v203, v203, v20, s[62:63]
v_cmp_gt_i32 s[56:57], 48, v6
v_cmp_gt_i32 s[58:59], 49, v6
v_cmp_gt_i32 s[60:61], 50, v6
v_cmp_gt_i32 s[62:63], 51, v6
v_cndmask_b32 v204, v204, v20, s[56:57]
v_cndmask_b32 v205, v205, v20, s[58:59]
v_cndmask_b32 v206, v206, v20, s[60:61]
v_cndmask_b32 v207, v207, v20, s[62:63]
VE 8,192
Maav 0,196,68
s_add_u32 m0, s54, 16384
s_add_u32 s3, s5, 458752
VE 9,193
Maav 32,192,72
buffer_load_dwordx4 v24, s[68:71], s3 offen offset:0 lds
Maav 32,196,76
s_mov_b32 s60, s8
Ra 224,2,20480
Vc 96,8,9
Maav 4,200,64
s_and_b32 s61, s9, 0xffff
s_mov_b32 s62, 7340032
Ve 10,194
Maav 4,204,68
s_mov_b32 s63, 0x20000
s_mov_b32 s56, s40
Ve 11,195
Maav 36,200,72
s_and_b32 s57, s41, 0xffff
Ra 228,2,28672
Vc 97,10,11
Maav 36,204,76
s_mov_b32 s58, 4194304
Ra 232,2,21504
v_or_b32_e64 v7, v96, v97
Mvvv 48,16,64
s_mov_b32 s59, 0x20000
s_bfe_u32 s6, s2, 0x20001
VE 12,196
Mvvv 48,16,68
s_waitcnt lgkmcnt(3)
s_add_u32 s3, s5, 486400
Ra 236,2,29696
Ra 240,2,22528
Maav 8,208,64
buffer_load_dwordx4 v24, s[68:71], s3 offen offset:1024 lds
Maav 8,212,68
s_lshr_b32 s7, s34, 1
s_lshl_b32 s45, s7, 2
Ve 13,197
Maav 40,208,72
s_add_u32 s46, s45, s6
Ra 244,2,30720
Vc 98,12,13
Maav 40,212,76
s_sub_u32 s46, 15, s46
s_sub_u32 s45, 12, s45
Ve 14,198
Maav 12,216,64
s_add_u32 s45, s45, s6
Ve 15,199
Maav 12,220,68
s_cmp_lt_u32 s7, 2
s_cselect_b32 s45, s46, s45
Ra 248,2,23552
Vc 99,14,15
Maav 44,216,72
s_and_b32 s46, s2, 1
Ra 252,2,31744
v_or3_b32 v7, v7, v98, v99
Maav 44,220,76
s_add_u32 s3, s5, 514048
Ve 8,200
Mvvv 52,16,72
buffer_load_dwordx4 v25, s[68:71], s3 offen offset:2048 lds
Mvvv 52,16,76
s_waitcnt lgkmcnt(4)
Ve 9,201
Maav 16,224,64
s_bfe_u32 s6, s2, 0x30003
Ra 192,2,49152
Vc 100,8,9
Maav 16,228,68
s_lshl_b32 s6, s6, 1
s_add_u32 s46, s46, s6
VE 10,202
Maav 48,224,72
s_mov_b32 s48, 0
s_mov_b32 s49, 15360
Ve 11,203
Maav 48,228,76
s_mov_b32 s50, 30720
Ra 196,2,57344
Vc 101,10,11
Maav 20,232,64
s_mov_b32 s51, 46080
Ra 200,2,50176
v_or3_b32 v7, v7, v100, v101
Maav 20,236,68
s_add_u32 s3, s5, 541696
Ra 204,2,58368
Ra 208,2,51200
Maav 52,232,72
buffer_load_dwordx4 v25, s[68:71], s3 offen offset:3072 lds
Maav 52,236,76
s_waitcnt lgkmcnt(5)
Ve 12,204
Maav 24,240,64
s_lshl_b32 s35, s32, 13
s_add_u32 s35, s35, 131072
Ve 13,205
Maav 24,244,68
s_and_b32 s52, s46, 1
Ra 212,2,59392
Vc 102,12,13
Maav 56,240,72
s_lshl_b32 s37, s45, 20
s_lshl_b32 s7, s52, 19
Ve 14,206
Maav 56,244,76
s_add_u32 s37, s37, s7
s_add_u32 s37, s37, 46137344
Ve 15,207
Maav 28,248,64
s_lshr_b32 s7, s46, 1
Ra 216,2,52224
Vc 103,14,15
Maav 28,252,68
s_lshl_b32 s7, s7, 8
Ra 220,2,60416
v_or3_b32 v7, v7, v102, v103
Maav 60,248,72
s_waitcnt lgkmcnt(4)
Maav 60,252,76
s_lshl_b32 s6, s52, 22
s_add_u32 s6, s6, s7
v_and_b32 v1, 0x40004000, v7
v_cmp_ne_u32 vcc, 0, v1
s_cbranch_vccnz L_k2_fb_fi
L_k2_fbr_fi:
Maav 0,192,96
Ra 224,2,53248
Ra 228,2,61440
Maav 0,196,100
Ra 232,2,54272
Ra 236,2,62464
Maav 4,200,96
Ra 240,2,55296
Ra 244,2,63488
Maav 4,204,100
Ra 248,2,56320
Ra 252,2,64512
Mvvv 48,16,96
s_add_u32 s12, s94, s6
s_addc_u32 s13, s95, 0
s_and_b32 s13, s13, 0xffff
Mvvv 48,16,100
s_waitcnt lgkmcnt(8)
Maav 8,208,96
s_mov_b32 s14, 0
s_mov_b32 s15, 0x20000
s_sub_u32 s14, 4194304, s7
Maav 8,212,100
s_mov_b32 s28, s94
s_and_b32 s29, s95, 0xffff
s_mov_b32 s30, 8388608
Maav 12,216,96
s_mov_b32 s31, 0x20000
s_lshl_b32 s7, s46, 7
s_lshl_b32 s36, s45, 18
Maav 12,220,100
s_waitcnt lgkmcnt(4)
Maav 16,224,96
s_add_u32 s36, s36, s7
s_and_b32 s94, s7, 128
s_lshl_b32 s38, s45, 7
Maav 16,228,100
s_lshl_b32 s6, s52, 6
s_add_u32 s38, s38, s6
s_add_u32 s38, s38, 5300224
Maav 20,232,96
s_lshl_b32 s52, s32, 11
s_lshl_b32 s6, s32, 16
s_add_u32 s6, s6, s94
Maav 20,236,100
s_waitcnt lgkmcnt(0)
Maav 24,240,96
s_xor_b32 s6, s6, 128
s_lshl_b32 s7, s32, 5
s_mov_b32 s68, s10
Maav 24,244,100
s_and_b32 s69, s11, 0xffff
s_mov_b32 s70, 4194304
s_mov_b32 s71, 0x20000
s_add_u32 s8, s66, s37
s_addc_u32 s9, s67, 0
s_and_b32 s9, s9, 0xffff
Maav 28,248,96
s_mov_b32 s10, 524288
s_mov_b32 s11, 0x20000
v_lshlrev_b32 v112, 4, v0
v_lshrrev_b32_e64 v121, 4, v0
Maav 28,252,100
v_and_b32 v122, 7, v0
v_lshrrev_b32 v123, 3, v0
v_lshlrev_b32 v124, 1, v121
s_nop 7
s_lshl_b32 s3, s55, 20
s_lshl_b32 s47, s33, 15
s_add_u32 s3, s3, s47
s_lshl_b32 s47, s32, 10
v_lshlrev_b32 v248, 4, v0
v_add_u32 v249, s47, v248
s_sub_u32 s47, 7168, s47
v_add_u32 v248, s47, v248
v_rcp_f32 v250, v48
v_rcp_f32 v252, v52
v_mov_b32 v251, v250
v_mov_b32_e64 v253, v252
Ar 240,32
Ar 241,33
Ar 242,34
Ar 243,35
Ar 244,36
Ar 245,37
Ar 246,38
Ar 247,39
v_pk_mul_f32 v[240:241], v[240:241], v[252:253]
v_pk_mul_f32 v[242:243], v[242:243], v[252:253]
v_pk_mul_f32 v[244:245], v[244:245], v[252:253]
v_pk_mul_f32 v[246:247], v[246:247], v[252:253]
Vc 28,240,241
Vc 29,242,243
Vc 30,244,245
Vc 31,246,247
buffer_store_dwordx4 v[28:31], v249, s[16:19], s3 offen sc1
Ar 240,0
Ar 241,1
Ar 242,2
Ar 243,3
Ar 244,4
Ar 245,5
Ar 246,6
Ar 247,7
v_pk_mul_f32 v[240:241], v[240:241], v[250:251]
v_pk_mul_f32 v[242:243], v[242:243], v[250:251]
v_pk_mul_f32 v[244:245], v[244:245], v[250:251]
v_pk_mul_f32 v[246:247], v[246:247], v[250:251]
Vc 24,240,241
Vc 25,242,243
Vc 26,244,245
Vc 27,246,247
buffer_store_dwordx4 v[24:27], v248, s[16:19], s3 offen sc1
s_add_u32 s3, s3, 8192
Ar 240,40
Ar 241,41
Ar 242,42
Ar 243,43
Ar 244,44
Ar 245,45
Ar 246,46
Ar 247,47
v_pk_mul_f32 v[240:241], v[240:241], v[252:253]
v_pk_mul_f32 v[242:243], v[242:243], v[252:253]
v_pk_mul_f32 v[244:245], v[244:245], v[252:253]
v_pk_mul_f32 v[246:247], v[246:247], v[252:253]
Vc 28,240,241
Vc 29,242,243
Vc 30,244,245
Vc 31,246,247
buffer_store_dwordx4 v[28:31], v249, s[16:19], s3 offen sc1
Ar 240,8
Ar 241,9
Ar 242,10
Ar 243,11
Ar 244,12
Ar 245,13
Ar 246,14
Ar 247,15
v_pk_mul_f32 v[240:241], v[240:241], v[250:251]
v_pk_mul_f32 v[242:243], v[242:243], v[250:251]
v_pk_mul_f32 v[244:245], v[244:245], v[250:251]
v_pk_mul_f32 v[246:247], v[246:247], v[250:251]
Vc 24,240,241
Vc 25,242,243
Vc 26,244,245
Vc 27,246,247
buffer_store_dwordx4 v[24:27], v248, s[16:19], s3 offen sc1
s_add_u32 s3, s3, 8192
Ar 240,48
Ar 241,49
Ar 242,50
Ar 243,51
Ar 244,52
Ar 245,53
Ar 246,54
Ar 247,55
v_pk_mul_f32 v[240:241], v[240:241], v[252:253]
v_pk_mul_f32 v[242:243], v[242:243], v[252:253]
v_pk_mul_f32 v[244:245], v[244:245], v[252:253]
v_pk_mul_f32 v[246:247], v[246:247], v[252:253]
Vc 28,240,241
Vc 29,242,243
Vc 30,244,245
Vc 31,246,247
buffer_store_dwordx4 v[28:31], v249, s[16:19], s3 offen sc1
Ar 240,16
Ar 241,17
Ar 242,18
Ar 243,19
Ar 244,20
Ar 245,21
Ar 246,22
Ar 247,23
v_pk_mul_f32 v[240:241], v[240:241], v[250:251]
v_pk_mul_f32 v[242:243], v[242:243], v[250:251]
v_pk_mul_f32 v[244:245], v[244:245], v[250:251]
v_pk_mul_f32 v[246:247], v[246:247], v[250:251]
Vc 24,240,241
Vc 25,242,243
Vc 26,244,245
Vc 27,246,247
buffer_store_dwordx4 v[24:27], v248, s[16:19], s3 offen sc1
s_add_u32 s3, s3, 8192
Ar 240,56
Ar 241,57
Ar 242,58
Ar 243,59
Ar 244,60
Ar 245,61
Ar 246,62
Ar 247,63
v_pk_mul_f32 v[240:241], v[240:241], v[252:253]
v_pk_mul_f32 v[242:243], v[242:243], v[252:253]
v_pk_mul_f32 v[244:245], v[244:245], v[252:253]
v_pk_mul_f32 v[246:247], v[246:247], v[252:253]
Vc 28,240,241
Vc 29,242,243
Vc 30,244,245
Vc 31,246,247
buffer_store_dwordx4 v[28:31], v249, s[16:19], s3 offen sc1
Ar 240,24
Ar 241,25
Ar 242,26
Ar 243,27
Ar 244,28
Ar 245,29
Ar 246,30
Ar 247,31
v_pk_mul_f32 v[240:241], v[240:241], v[250:251]
v_pk_mul_f32 v[242:243], v[242:243], v[250:251]
v_pk_mul_f32 v[244:245], v[244:245], v[250:251]
v_pk_mul_f32 v[246:247], v[246:247], v[250:251]
Vc 24,240,241
Vc 25,242,243
Vc 26,244,245
Vc 27,246,247
buffer_store_dwordx4 v[24:27], v248, s[16:19], s3 offen sc1
s_cmp_lt_u32 s34, 1
s_cbranch_scc1 L_noffn
v_lshrrev_b32_e64 v24, 4, v0
v_bfe_u32 v25, v0, 2, 2
v_lshl_add_u32 v26, v24, 3, v25
v_lshlrev_b32 v26, 8, v26
v_and_b32 v27, 3, v0
v_lshl_add_u32 v26, v27, 3, v26
v_and_b32_e64 v27, 1, v24
v_lshl_add_u32 v25, v27, 2, v25
s_lshl_b32 s3, s32, 1
v_xor_b32 v25, s3, v25
v_lshl_add_u32 v26, v25, 5, v26
s_sub_u32 s3, s54, s44
v_add_u32 v30, s3, v26
v_xor_b32_e64 v31, 32, v30
v_add_u32 v26, 131072, v26
v_xor_b32 v27, 32, v26
s_waitcnt vmcnt(8) lgkmcnt(0)
s_barrier
s_nop 0
ds_read_b64_tr_b16 v[128:129], v26 offset:0
ds_read_b64_tr_b16 v[130:131], v26 offset:1024
ds_read_b64_tr_b16 v[132:133], v27 offset:0
ds_read_b64_tr_b16 v[134:135], v27 offset:1024
ds_read_b64_tr_b16 v[136:137], v26 offset:8192
ds_read_b64_tr_b16 v[138:139], v26 offset:9216
ds_read_b64_tr_b16 v[140:141], v27 offset:8192
ds_read_b64_tr_b16 v[142:143], v27 offset:9216
ds_read_b64_tr_b16 v[144:145], v26 offset:16384
ds_read_b64_tr_b16 v[146:147], v26 offset:17408
ds_read_b64_tr_b16 v[148:149], v27 offset:16384
ds_read_b64_tr_b16 v[150:151], v27 offset:17408
ds_read_b64_tr_b16 v[152:153], v26 offset:24576
ds_read_b64_tr_b16 v[154:155], v26 offset:25600
ds_read_b64_tr_b16 v[156:157], v27 offset:24576
s_waitcnt lgkmcnt(9)
s_nop 0
ds_read_b64_tr_b16 v[158:159], v27 offset:25600
ds_read_b64_tr_b16 v[160:161], v30 offset:0
ds_read_b64_tr_b16 v[162:163], v30 offset:1024
ds_read_b64_tr_b16 v[164:165], v31 offset:0
ds_read_b64_tr_b16 v[166:167], v31 offset:1024
ds_read_b64_tr_b16 v[168:169], v30 offset:8192
s_waitcnt lgkmcnt(9)
s_nop 0
ds_read_b64_tr_b16 v[170:171], v30 offset:9216
ds_read_b64_tr_b16 v[172:173], v31 offset:8192
ds_read_b64_tr_b16 v[174:175], v31 offset:9216
ds_read_b64_tr_b16 v[176:177], v30 offset:16384
ds_read_b64_tr_b16 v[178:179], v30 offset:17408
ds_read_b64_tr_b16 v[180:181], v31 offset:16384
s_waitcnt lgkmcnt(9)
ds_read_b64_tr_b16 v[182:183], v31 offset:17408
ds_read_b64_tr_b16 v[184:185], v30 offset:24576
ds_read_b64_tr_b16 v[186:187], v30 offset:25600
ds_read_b64_tr_b16 v[188:189], v31 offset:24576
ds_read_b64_tr_b16 v[190:191], v31 offset:25600
v_and_b32 v25, 15, v0
v_mul_u32_u24 v28, 14336, v25
v_lshl_add_u32 v28, v24, 4, v28
v_mov_b32 v29, 2146435072
v_cmp_gt_u32 vcc, 2, v25
s_mul_i32 s3, s92, 57344
s_lshl_b32 s47, s4, 9
s_add_u32 s3, s3, s47
v_cndmask_b32 v28, v29, v28, vcc
s_lshl_b32 s47, s32, 7
s_add_u32 s3, s3, s47
s_add_u32 s3, s3, 6291456
Zvva 224,128,160
Zvva 228,132,160
Mvva 224,136,164
Mvva 228,140,164
Mvva 224,144,168
Mvva 228,148,168
Mvva 224,152,172
Mvva 228,156,172
s_waitcnt lgkmcnt(0)
Zvva 232,160,160
Zvva 236,164,160
Mvva 232,168,164
Mvva 236,172,164
Mvva 232,176,168
Mvva 236,180,168
Mvva 232,184,172
Mvva 236,188,172
L_noffn:
v_xor_b32 v124, v124, v122
v_lshlrev_b32_e64 v124, 4, v124
v_lshl_add_u32 v113, v123, 11, v124
v_add_u32 v114, s6, v113
v_lshrrev_b32 v124, 2, v0
v_bfe_u32 v126, v0, 3, 2
v_lshlrev_b32 v124, 7, v124
v_and_b32 v125, 3, v0
v_lshl_add_u32 v124, v125, 3, v124
v_lshl_add_u32 v115, v126, 5, v124
v_xor_b32 v116, 32, v115
v_xor_b32 v117, 64, v115
v_xor_b32 v118, 96, v115
v_add_u32 v120, s7, v123
v_lshlrev_b32 v119, 11, v120
v_lshl_add_u32 v119, v122, 4, v119
v_mov_b32 v126, 0
v_lshlrev_b32 v127, 2, v122
v_mov_b32 v24, 1
v_mul_u32_u24 v25, s65, v0
s_waitcnt vmcnt(0)
s_barrier
s_mov_b64 exec, 3
buffer_store_dword v24, v25, s[20:23], s64 offen sc1
s_mov_b64 exec, -1
s_cmp_ge_u32 s34, 1
s_nop 0
s_cselect_b32 s3, s3, 8388608
s_add_u32 s7, s3, 28672
buffer_store_dwordx4 v[224:227], v28, s[20:23], s3 offen offset:0 sc1
buffer_store_dwordx4 v[228:231], v28, s[20:23], s3 offen offset:64 sc1
buffer_store_dwordx4 v[232:235], v28, s[20:23], s7 offen offset:0 sc1
buffer_store_dwordx4 v[236:239], v28, s[20:23], s7 offen offset:64 sc1
s_lshl_b32 s33, s4, 3
s_add_u32 s33, s33, s92
s_mov_b32 s65, s33
s_mov_b32 s3, s36
buffer_load_dwordx4 v[18:21], v119, s[56:59], s3 offen
s_add_u32 s3, s3, 16384
buffer_load_dwordx4 v[22:25], v119, s[56:59], s3 offen
s_add_u32 s3, s3, 16384
buffer_load_dwordx4 v[26:29], v119, s[56:59], s3 offen
s_add_u32 s3, s3, 16384
buffer_load_dwordx4 v[30:33], v119, s[56:59], s3 offen
s_lshl_b32 s3, s45, 10
s_add_u32 s3, s3, 5259264
v_lshlrev_b32 v124, 3, v120
buffer_load_dwordx2 v[34:35], v124, s[20:23], s3 offen offset:0 sc1
buffer_load_dwordx2 v[36:37], v124, s[20:23], s3 offen offset:64 sc1
buffer_load_dwordx2 v[38:39], v124, s[20:23], s3 offen offset:128 sc1
buffer_load_dwordx2 v[40:41], v124, s[20:23], s3 offen offset:192 sc1
v_and_b32 v10, 15, v0
v_lshlrev_b32 v10, 2, v10
s_add_u32 s95, s32, 32
s_lshl_b32 s95, s95, 16
s_add_u32 s95, s95, s94
s_xor_b32 s95, s95, 128
s_add_u32 m0, s44, 0
s_nop 0
s_nop 0
buffer_load_dwordx4 v114, s[12:15], s48 offen offset:0 lds
buffer_load_dwordx4 v114, s[12:15], s49 offen offset:1024 lds
buffer_load_dwordx4 v114, s[12:15], s50 offen offset:2048 lds
buffer_load_dwordx4 v114, s[12:15], s51 offen offset:3072 lds
v_xor_b32 v114, 128, v114
s_add_u32 m0, s44, 16384
s_nop 0
s_nop 0
buffer_load_dwordx4 v114, s[12:15], s48 offen offset:0 lds
buffer_load_dwordx4 v114, s[12:15], s49 offen offset:1024 lds
buffer_load_dwordx4 v114, s[12:15], s50 offen offset:2048 lds
buffer_load_dwordx4 v114, s[12:15], s51 offen offset:3072 lds
v_xor_b32 v114, 128, v114
v_add_u32 v114, 262144, v114
buffer_load_dword v124, v10, s[20:23], s38 offen sc1
v_add_u32 v12, 65536, v115
v_add_u32 v13, 65536, v116
v_add_u32 v14, 65536, v117
v_add_u32 v15, 65536, v118
s_and_b32 s39, s93, 15
s_lshr_b32 s37, s93, 4
s_lshl_b32 s54, s37, 2
s_add_u32 s54, s54, s32
s_lshl_b32 s3, s54, 17
s_lshl_b32 s7, s39, 7
s_add_u32 s3, s3, s7
s_cmp_lt_u32 s93, 224
s_cselect_b32 s3, s3, 2146435072
v_add_u32 v125, s3, v113
s_mov_b32 s40, 0
s_waitcnt vmcnt(9)
v_lshlrev_b32_e64 v42, 16, v18
v_and_b32 v43, 0xffff0000, v18
v_lshlrev_b32_e64 v44, 16, v19
v_and_b32 v45, 0xffff0000, v19
v_lshlrev_b32_e64 v46, 16, v20
v_and_b32 v47, 0xffff0000, v20
v_lshlrev_b32_e64 v48, 16, v21
v_and_b32 v49, 0xffff0000, v21
v_pk_add_f32 v[42:43], v[42:43], v[34:35] op_sel_hi:[1,0] neg_lo:[0,1] neg_hi:[0,1]
v_pk_add_f32 v[44:45], v[44:45], v[34:35] op_sel_hi:[1,0] neg_lo:[0,1] neg_hi:[0,1]
v_pk_add_f32 v[46:47], v[46:47], v[34:35] op_sel_hi:[1,0] neg_lo:[0,1] neg_hi:[0,1]
v_pk_add_f32 v[48:49], v[48:49], v[34:35] op_sel_hi:[1,0] neg_lo:[0,1] neg_hi:[0,1]
Vc 2,42,43
v_lshlrev_b32_e64 v42, 16, v2
v_and_b32 v43, 0xffff0000, v2
Vc 3,44,45
v_lshlrev_b32_e64 v44, 16, v3
v_and_b32 v45, 0xffff0000, v3
Vc 4,46,47
v_lshlrev_b32_e64 v46, 16, v4
v_and_b32 v47, 0xffff0000, v4
Vc 5,48,49
v_lshlrev_b32_e64 v48, 16, v5
v_and_b32 v49, 0xffff0000, v5
v_pk_mul_f32 v[42:43], v[42:43], v[34:35] op_sel:[0,1] op_sel_hi:[1,1]
v_pk_mul_f32 v[44:45], v[44:45], v[34:35] op_sel:[0,1] op_sel_hi:[1,1]
v_pk_mul_f32 v[46:47], v[46:47], v[34:35] op_sel:[0,1] op_sel_hi:[1,1]
v_pk_mul_f32 v[48:49], v[48:49], v[34:35] op_sel:[0,1] op_sel_hi:[1,1]
Vc 2,42,43
v_lshlrev_b32_e64 v42, 16, v2
v_and_b32 v43, 0xffff0000, v2
Vc 3,44,45
v_lshlrev_b32_e64 v44, 16, v3
v_and_b32 v45, 0xffff0000, v3
Vc 4,46,47
v_lshlrev_b32_e64 v46, 16, v4
v_and_b32 v47, 0xffff0000, v4
Vc 5,48,49
v_lshlrev_b32_e64 v48, 16, v5
v_and_b32 v49, 0xffff0000, v5
v_mul_f32 v2, 0xbfb8aa3b, v42
v_mul_f32 v3, 0xbfb8aa3b, v43
v_mul_f32 v4, 0xbfb8aa3b, v44
v_mul_f32 v5, 0xbfb8aa3b, v45
v_mul_f32 v6, 0xbfb8aa3b, v46
v_mul_f32 v7, 0xbfb8aa3b, v47
v_mul_f32 v8, 0xbfb8aa3b, v48
v_mul_f32 v9, 0xbfb8aa3b, v49
Ve 2,2
Ve 3,3
Ve 4,4
Ve 5,5
Ve 6,6
Ve 7,7
Ve 8,8
Ve 9,9
v_add_f32 v2, 1.0, v2
v_add_f32 v3, 1.0, v3
v_add_f32 v4, 1.0, v4
v_add_f32 v5, 1.0, v5
v_add_f32 v6, 1.0, v6
v_add_f32 v7, 1.0, v7
v_add_f32 v8, 1.0, v8
v_add_f32 v9, 1.0, v9
v_rcp_f32 v2, v2
v_rcp_f32 v3, v3
v_rcp_f32 v4, v4
v_rcp_f32 v5, v5
v_rcp_f32 v6, v6
v_rcp_f32 v7, v7
v_rcp_f32 v8, v8
v_rcp_f32 v9, v9
v_pk_mul_f32 v[42:43], v[42:43], v[2:3]
v_pk_mul_f32 v[44:45], v[44:45], v[4:5]
v_pk_mul_f32 v[46:47], v[46:47], v[6:7]
v_pk_mul_f32 v[48:49], v[48:49], v[8:9]
Vc 2,42,43
v_lshlrev_b32_e64 v42, 16, v2
v_and_b32 v43, 0xffff0000, v2
Vc 3,44,45
v_lshlrev_b32_e64 v44, 16, v3
v_and_b32 v45, 0xffff0000, v3
Vc 4,46,47
v_lshlrev_b32_e64 v46, 16, v4
v_and_b32 v47, 0xffff0000, v4
Vc 5,48,49
v_lshlrev_b32_e64 v48, 16, v5
v_and_b32 v49, 0xffff0000, v5
s_waitcnt vmcnt(0)
v_cmp_ne_u32 vcc, 1, v124
s_cbranch_vccnz L_spinC
s_nop 0
L_spinCr:
buffer_load_dwordx4 a[0:3], v112, s[8:11], s52 offen offset:0 sc1
buffer_load_dwordx4 a[4:7], v112, s[8:11], s52 offen offset:1024 sc1
s_add_u32 s52, s52, 8192
buffer_load_dwordx4 a[8:11], v112, s[8:11], s52 offen offset:0 sc1
buffer_load_dwordx4 a[12:15], v112, s[8:11], s52 offen offset:1024 sc1
s_add_u32 s52, s52, 8192
buffer_load_dwordx4 a[16:19], v112, s[8:11], s52 offen offset:0 sc1
buffer_load_dwordx4 a[20:23], v112, s[8:11], s52 offen offset:1024 sc1
s_add_u32 s52, s52, 8192
buffer_load_dwordx4 a[24:27], v112, s[8:11], s52 offen offset:0 sc1
buffer_load_dwordx4 a[28:31], v112, s[8:11], s52 offen offset:1024 sc1
s_add_u32 s52, s52, 8192
buffer_load_dwordx4 a[32:35], v112, s[8:11], s52 offen offset:0 sc1
buffer_load_dwordx4 a[36:39], v112, s[8:11], s52 offen offset:1024 sc1
s_add_u32 s52, s52, 8192
buffer_load_dwordx4 a[40:43], v112, s[8:11], s52 offen offset:0 sc1
buffer_load_dwordx4 a[44:47], v112, s[8:11], s52 offen offset:1024 sc1
s_add_u32 s52, s52, 8192
v_lshlrev_b32_e64 v50, 16, v22
v_and_b32 v51, 0xffff0000, v22
v_lshlrev_b32_e64 v52, 16, v23
v_and_b32 v53, 0xffff0000, v23
v_lshlrev_b32_e64 v54, 16, v24
v_and_b32 v55, 0xffff0000, v24
v_lshlrev_b32_e64 v56, 16, v25
v_and_b32 v57, 0xffff0000, v25
v_pk_add_f32 v[50:51], v[50:51], v[36:37] op_sel_hi:[1,0] neg_lo:[0,1] neg_hi:[0,1]
v_pk_add_f32 v[52:53], v[52:53], v[36:37] op_sel_hi:[1,0] neg_lo:[0,1] neg_hi:[0,1]
v_pk_add_f32 v[54:55], v[54:55], v[36:37] op_sel_hi:[1,0] neg_lo:[0,1] neg_hi:[0,1]
v_pk_add_f32 v[56:57], v[56:57], v[36:37] op_sel_hi:[1,0] neg_lo:[0,1] neg_hi:[0,1]
Vc 2,50,51
v_lshlrev_b32_e64 v50, 16, v2
v_and_b32 v51, 0xffff0000, v2
Vc 3,52,53
v_lshlrev_b32_e64 v52, 16, v3
v_and_b32 v53, 0xffff0000, v3
Vc 4,54,55
v_lshlrev_b32_e64 v54, 16, v4
v_and_b32 v55, 0xffff0000, v4
Vc 5,56,57
v_lshlrev_b32_e64 v56, 16, v5
v_and_b32 v57, 0xffff0000, v5
v_pk_mul_f32 v[50:51], v[50:51], v[36:37] op_sel:[0,1] op_sel_hi:[1,1]
v_pk_mul_f32 v[52:53], v[52:53], v[36:37] op_sel:[0,1] op_sel_hi:[1,1]
v_pk_mul_f32 v[54:55], v[54:55], v[36:37] op_sel:[0,1] op_sel_hi:[1,1]
v_pk_mul_f32 v[56:57], v[56:57], v[36:37] op_sel:[0,1] op_sel_hi:[1,1]
Vc 2,50,51
v_lshlrev_b32_e64 v50, 16, v2
v_and_b32 v51, 0xffff0000, v2
Vc 3,52,53
v_lshlrev_b32_e64 v52, 16, v3
v_and_b32 v53, 0xffff0000, v3
Vc 4,54,55
v_lshlrev_b32_e64 v54, 16, v4
v_and_b32 v55, 0xffff0000, v4
Vc 5,56,57
v_lshlrev_b32_e64 v56, 16, v5
v_and_b32 v57, 0xffff0000, v5
v_mul_f32 v2, 0xbfb8aa3b, v50
v_mul_f32 v3, 0xbfb8aa3b, v51
v_mul_f32 v4, 0xbfb8aa3b, v52
v_mul_f32 v5, 0xbfb8aa3b, v53
v_mul_f32 v6, 0xbfb8aa3b, v54
v_mul_f32 v7, 0xbfb8aa3b, v55
v_mul_f32 v8, 0xbfb8aa3b, v56
v_mul_f32 v9, 0xbfb8aa3b, v57
Ve 2,2
Ve 3,3
Ve 4,4
Ve 5,5
Ve 6,6
Ve 7,7
Ve 8,8
Ve 9,9
v_add_f32 v2, 1.0, v2
v_add_f32 v3, 1.0, v3
v_add_f32 v4, 1.0, v4
v_add_f32 v5, 1.0, v5
v_add_f32 v6, 1.0, v6
v_add_f32 v7, 1.0, v7
v_add_f32 v8, 1.0, v8
v_add_f32 v9, 1.0, v9
v_rcp_f32 v2, v2
v_rcp_f32 v3, v3
v_rcp_f32 v4, v4
v_rcp_f32 v5, v5
v_rcp_f32 v6, v6
v_rcp_f32 v7, v7
v_rcp_f32 v8, v8
v_rcp_f32 v9, v9
v_pk_mul_f32 v[50:51], v[50:51], v[2:3]
v_pk_mul_f32 v[52:53], v[52:53], v[4:5]
v_pk_mul_f32 v[54:55], v[54:55], v[6:7]
v_pk_mul_f32 v[56:57], v[56:57], v[8:9]
Vc 2,50,51
v_lshlrev_b32_e64 v50, 16, v2
v_and_b32 v51, 0xffff0000, v2
Vc 3,52,53
v_lshlrev_b32_e64 v52, 16, v3
v_and_b32 v53, 0xffff0000, v3
Vc 4,54,55
v_lshlrev_b32_e64 v54, 16, v4
v_and_b32 v55, 0xffff0000, v4
Vc 5,56,57
v_lshlrev_b32_e64 v56, 16, v5
v_and_b32 v57, 0xffff0000, v5
v_lshlrev_b32_e64 v58, 16, v26
v_and_b32 v59, 0xffff0000, v26
v_lshlrev_b32_e64 v60, 16, v27
v_and_b32 v61, 0xffff0000, v27
v_lshlrev_b32_e64 v62, 16, v28
v_and_b32 v63, 0xffff0000, v28
v_lshlrev_b32_e64 v64, 16, v29
v_and_b32 v65, 0xffff0000, v29
v_pk_add_f32 v[58:59], v[58:59], v[38:39] op_sel_hi:[1,0] neg_lo:[0,1] neg_hi:[0,1]
v_pk_add_f32 v[60:61], v[60:61], v[38:39] op_sel_hi:[1,0] neg_lo:[0,1] neg_hi:[0,1]
v_pk_add_f32 v[62:63], v[62:63], v[38:39] op_sel_hi:[1,0] neg_lo:[0,1] neg_hi:[0,1]
v_pk_add_f32 v[64:65], v[64:65], v[38:39] op_sel_hi:[1,0] neg_lo:[0,1] neg_hi:[0,1]
Vc 2,58,59
v_lshlrev_b32_e64 v58, 16, v2
v_and_b32 v59, 0xffff0000, v2
Vc 3,60,61
v_lshlrev_b32_e64 v60, 16, v3
v_and_b32 v61, 0xffff0000, v3
Vc 4,62,63
v_lshlrev_b32_e64 v62, 16, v4
v_and_b32 v63, 0xffff0000, v4
Vc 5,64,65
v_lshlrev_b32_e64 v64, 16, v5
v_and_b32 v65, 0xffff0000, v5
v_pk_mul_f32 v[58:59], v[58:59], v[38:39] op_sel:[0,1] op_sel_hi:[1,1]
v_pk_mul_f32 v[60:61], v[60:61], v[38:39] op_sel:[0,1] op_sel_hi:[1,1]
v_pk_mul_f32 v[62:63], v[62:63], v[38:39] op_sel:[0,1] op_sel_hi:[1,1]
v_pk_mul_f32 v[64:65], v[64:65], v[38:39] op_sel:[0,1] op_sel_hi:[1,1]
Vc 2,58,59
v_lshlrev_b32_e64 v58, 16, v2
v_and_b32 v59, 0xffff0000, v2
Vc 3,60,61
v_lshlrev_b32_e64 v60, 16, v3
v_and_b32 v61, 0xffff0000, v3
Vc 4,62,63
v_lshlrev_b32_e64 v62, 16, v4
v_and_b32 v63, 0xffff0000, v4
Vc 5,64,65
v_lshlrev_b32_e64 v64, 16, v5
v_and_b32 v65, 0xffff0000, v5
v_mul_f32 v2, 0xbfb8aa3b, v58
v_mul_f32 v3, 0xbfb8aa3b, v59
v_mul_f32 v4, 0xbfb8aa3b, v60
v_mul_f32 v5, 0xbfb8aa3b, v61
v_mul_f32 v6, 0xbfb8aa3b, v62
v_mul_f32 v7, 0xbfb8aa3b, v63
v_mul_f32 v8, 0xbfb8aa3b, v64
v_mul_f32 v9, 0xbfb8aa3b, v65
Ve 2,2
Ve 3,3
Ve 4,4
Ve 5,5
Ve 6,6
Ve 7,7
Ve 8,8
Ve 9,9
v_add_f32 v2, 1.0, v2
v_add_f32 v3, 1.0, v3
v_add_f32 v4, 1.0, v4
v_add_f32 v5, 1.0, v5
v_add_f32 v6, 1.0, v6
v_add_f32 v7, 1.0, v7
v_add_f32 v8, 1.0, v8
v_add_f32 v9, 1.0, v9
v_rcp_f32 v2, v2
v_rcp_f32 v3, v3
v_rcp_f32 v4, v4
v_rcp_f32 v5, v5
v_rcp_f32 v6, v6
v_rcp_f32 v7, v7
v_rcp_f32 v8, v8
v_rcp_f32 v9, v9
v_pk_mul_f32 v[58:59], v[58:59], v[2:3]
v_pk_mul_f32 v[60:61], v[60:61], v[4:5]
v_pk_mul_f32 v[62:63], v[62:63], v[6:7]
v_pk_mul_f32 v[64:65], v[64:65], v[8:9]
Vc 2,58,59
v_lshlrev_b32_e64 v58, 16, v2
v_and_b32 v59, 0xffff0000, v2
Vc 3,60,61
v_lshlrev_b32_e64 v60, 16, v3
v_and_b32 v61, 0xffff0000, v3
Vc 4,62,63
v_lshlrev_b32_e64 v62, 16, v4
v_and_b32 v63, 0xffff0000, v4
Vc 5,64,65
v_lshlrev_b32_e64 v64, 16, v5
v_and_b32 v65, 0xffff0000, v5
buffer_load_dwordx4 a[48:51], v112, s[8:11], s52 offen offset:0 sc1
buffer_load_dwordx4 a[52:55], v112, s[8:11], s52 offen offset:1024 sc1
s_add_u32 s52, s52, 8192
buffer_load_dwordx4 a[56:59], v112, s[8:11], s52 offen offset:0 sc1
buffer_load_dwordx4 a[60:63], v112, s[8:11], s52 offen offset:1024 sc1
s_add_u32 s52, s52, 8192
s_add_u32 m0, s44, 32768
s_nop 0
buffer_load_dwordx4 v114, s[12:15], s48 offen offset:0 lds
buffer_load_dwordx4 v114, s[12:15], s49 offen offset:1024 lds
buffer_load_dwordx4 v114, s[12:15], s50 offen offset:2048 lds
buffer_load_dwordx4 v114, s[12:15], s51 offen offset:3072 lds
v_xor_b32 v114, 128, v114
s_cmp_lg_u32 s40, 0
s_cbranch_scc1 L_nowd
s_add_u32 m0, s35, 0
s_nop 0
s_nop 0
buffer_load_dwordx4 v125, s[60:63], s48 offen offset:0 lds
buffer_load_dwordx4 v125, s[60:63], s49 offen offset:1024 lds
buffer_load_dwordx4 v125, s[60:63], s50 offen offset:2048 lds
buffer_load_dwordx4 v125, s[60:63], s51 offen offset:3072 lds
v_add_u32 v125, 65536, v125
s_add_u32 m0, s35, 4096
s_nop 0
buffer_load_dwordx4 v125, s[60:63], s48 offen offset:0 lds
buffer_load_dwordx4 v125, s[60:63], s49 offen offset:1024 lds
buffer_load_dwordx4 v125, s[60:63], s50 offen offset:2048 lds
buffer_load_dwordx4 v125, s[60:63], s51 offen offset:3072 lds
L_nowd:
s_cmp_lt_u32 s2, 128
s_cbranch_scc1 L_noc3
s_bfe_u32 s3, s2, 0x40003
s_lshl_b32 s3, s3, 2
s_add_u32 s3, s3, s32
s_lshl_b32 s3, s3, 15
s_and_b32 s7, s2, 1
s_lshl_b32 s7, s7, 22
s_add_u32 s3, s3, s7
s_add_u32 s3, s3, 384
v_and_b32 v1, 15, v0
v_lshlrev_b32 v1, 11, v1
v_lshrrev_b32_e64 v11, 5, v0
v_lshl_add_u32 v1, v11, 10, v1
buffer_load_dword v11, v1, s[28:31], s3 offen
L_noc3:
s_barrier
s_nop 0
ds_read_b64_tr_b16 v[192:193], v115 offset:0
ds_read_b64_tr_b16 v[194:195], v115 offset:2048
ds_read_b64_tr_b16 v[196:197], v115 offset:4096
ds_read_b64_tr_b16 v[198:199], v115 offset:6144
ds_read_b64_tr_b16 v[200:201], v115 offset:8192
ds_read_b64_tr_b16 v[202:203], v115 offset:10240
ds_read_b64_tr_b16 v[204:205], v115 offset:12288
ds_read_b64_tr_b16 v[206:207], v115 offset:14336
ds_read_b64_tr_b16 v[208:209], v116 offset:0
ds_read_b64_tr_b16 v[210:211], v116 offset:2048
ds_read_b64_tr_b16 v[212:213], v116 offset:4096
ds_read_b64_tr_b16 v[214:215], v116 offset:6144
ds_read_b64_tr_b16 v[216:217], v116 offset:8192
ds_read_b64_tr_b16 v[218:219], v116 offset:10240
ds_read_b64_tr_b16 v[220:221], v116 offset:12288
s_waitcnt lgkmcnt(9)
ds_read_b64_tr_b16 v[222:223], v116 offset:14336
s_waitcnt vmcnt(12)
s_waitcnt lgkmcnt(8)
Zvva 160,192,0
ds_read_b64_tr_b16 v[224:225], v117 offset:0
ds_read_b64_tr_b16 v[226:227], v117 offset:2048
v_mov_b32 v125, 1
Mvva 160,196,8
s_sub_u32 s65, s65, s33
s_lshl_b32 s65, s65, 2
v_mul_lo_u32 v124, v0, s65
Mvva 160,200,16
s_add_u32 m0, s44, 49152
ds_read_b64_tr_b16 v[228:229], v117 offset:4096
ds_read_b64_tr_b16 v[230:231], v117 offset:6144
Mvva 160,204,24
buffer_load_dwordx4 v114, s[12:15], s48 offen offset:0 lds
Zvva 176,192,4
s_waitcnt lgkmcnt(4)
ds_read_b64_tr_b16 v[232:233], v117 offset:8192
ds_read_b64_tr_b16 v[234:235], v117 offset:10240
Mvva 176,196,12
s_lshl_b32 s6, s33, 2
v_add_u32_e64 v124, s6, v124
Mvva 176,200,20
ds_read_b64_tr_b16 v[236:237], v117 offset:12288
ds_read_b64_tr_b16 v[238:239], v117 offset:14336
Mvva 176,204,28
buffer_load_dwordx4 v114, s[12:15], s49 offen offset:1024 lds
Zvva 164,208,0
ds_read_b64_tr_b16 v[240:241], v118 offset:0
ds_read_b64_tr_b16 v[242:243], v118 offset:2048
Mvva 164,212,8
s_mov_b32 s6, 5447680
s_cmp_eq_u32 s32, 0
s_cselect_b32 s6, s6, s64
s_cmp_ge_u32 s34, 1
s_cselect_b32 s6, s6, 2146435072
Mvva 164,216,16
s_waitcnt lgkmcnt(2)
ds_read_b64_tr_b16 v[244:245], v118 offset:4096
ds_read_b64_tr_b16 v[246:247], v118 offset:6144
Mvva 164,220,24
buffer_load_dwordx4 v114, s[12:15], s50 offen offset:2048 lds
Zvva 180,208,4
ds_read_b64_tr_b16 v[248:249], v118 offset:8192
ds_read_b64_tr_b16 v[250:251], v118 offset:10240
Mvva 180,212,12
s_mov_b64 exec, 3
buffer_store_dword v125, v124, s[20:23], s6 offen sc1
s_mov_b64 exec, -1
Mvva 180,216,20
s_barrier
ds_read_b64_tr_b16 v[252:253], v118 offset:12288
ds_read_b64_tr_b16 v[254:255], v118 offset:14336
Mvva 180,220,28
buffer_load_dwordx4 v114, s[12:15], s51 offen offset:3072 lds
v_xor_b32 v114, 128, v114
v_add_u32 v114, 262144, v114
Zvva 168,224,0
ds_read_b64_tr_b16 v[192:193], v115 offset:16384
ds_read_b64_tr_b16 v[194:195], v115 offset:18432
Mvva 168,228,8
s_lshl_b32 s40, s45, 2
s_add_u32 s40, s40, s32
s_lshr_b32 s3, s42, 5
s_lshr_b32 s47, s43, 5
s_cmp_eq_u32 s3, s40
s_cselect_b32 s53, 1, 0
s_cmp_eq_u32 s47, s40
s_cselect_b32 s53, 1, s53
s_mov_b32 s40, 0
Mvva 168,232,16
ds_read_b64_tr_b16 v[196:197], v115 offset:20480
ds_read_b64_tr_b16 v[198:199], v115 offset:22528
Mvva 168,236,24
buffer_load_dwordx4 a[64:67], v112, s[8:11], s52 offen offset:0 sc1
Zvva 184,224,4
s_waitcnt lgkmcnt(4)
ds_read_b64_tr_b16 v[200:201], v115 offset:24576
ds_read_b64_tr_b16 v[202:203], v115 offset:26624
Mvva 184,228,12
s_lshl_b32 s41, s46, 7
s_add_u32 s41, s41, 5449728
s_lshl_b32 s55, s46, 13
Mvva 184,232,20
ds_read_b64_tr_b16 v[204:205], v115 offset:28672
ds_read_b64_tr_b16 v[206:207], v115 offset:30720
Mvva 184,236,28
buffer_load_dwordx4 a[68:71], v112, s[8:11], s52 offen offset:1024 sc1
s_add_u32 s52, s52, 8192
Zvva 172,240,0
ds_read_b64_tr_b16 v[208:209], v116 offset:16384
ds_read_b64_tr_b16 v[210:211], v116 offset:18432
Mvva 172,244,8
s_add_u32 s55, s55, 5308416
s_add_u32 s16, s66, 88080384
s_addc_u32 s17, s67, 0
s_and_b32 s17, s17, 0xffff
Mvva 172,248,16
ds_read_b64_tr_b16 v[212:213], v116 offset:20480
ds_read_b64_tr_b16 v[214:215], v116 offset:22528
Mvva 172,252,24
buffer_load_dwordx4 a[72:75], v112, s[8:11], s52 offen offset:0 sc1
Zvva 188,240,4
s_waitcnt lgkmcnt(4)
ds_read_b64_tr_b16 v[216:217], v116 offset:24576
ds_read_b64_tr_b16 v[218:219], v116 offset:26624
Mvva 188,244,12
s_mov_b32 s18, 8388608
s_mov_b32 s19, 0x20000
s_lshl_b32 s24, s2, 2
Mvva 188,248,20
ds_read_b64_tr_b16 v[220:221], v116 offset:28672
ds_read_b64_tr_b16 v[222:223], v116 offset:30720
Mvva 188,252,28
buffer_load_dwordx4 a[76:79], v112, s[8:11], s52 offen offset:1024 sc1
s_add_u32 s52, s52, 8192
Zvva 128,192,0
ds_read_b64_tr_b16 v[224:225], v117 offset:16384
ds_read_b64_tr_b16 v[226:227], v117 offset:18432
Mvva 128,196,8
s_add_u32 s24, s24, s32
s_lshl_b32 s25, s24, 13
s_xor_b32 s26, s25, 32768
Mvva 128,200,16
s_add_u32 m0, s44, 65536
ds_read_b64_tr_b16 v[228:229], v117 offset:20480
ds_read_b64_tr_b16 v[230:231], v117 offset:22528
Mvva 128,204,24
buffer_load_dwordx4 v114, s[12:15], s48 offen offset:0 lds
Zvva 144,192,4
s_waitcnt lgkmcnt(4)
ds_read_b64_tr_b16 v[232:233], v117 offset:24576
ds_read_b64_tr_b16 v[234:235], v117 offset:26624
Mvva 144,196,12
s_lshl_b32 s24, s24, 2
s_xor_b32 s27, s24, 16
s_add_u32 s24, s24, 5452800
Mvva 144,200,20
ds_read_b64_tr_b16 v[236:237], v117 offset:28672
ds_read_b64_tr_b16 v[238:239], v117 offset:30720
Mvva 144,204,28
buffer_load_dwordx4 v114, s[12:15], s49 offen offset:1024 lds
Zvva 132,208,0
ds_read_b64_tr_b16 v[240:241], v118 offset:16384
ds_read_b64_tr_b16 v[242:243], v118 offset:18432
Mvva 132,212,8
s_add_u32 s27, s27, 5452800
v_add_u32 v106, s35, v115
v_add_u32 v107, s35, v116
v_add_u32 v108, s35, v117
Mvva 132,216,16
s_waitcnt lgkmcnt(2)
ds_read_b64_tr_b16 v[244:245], v118 offset:20480
ds_read_b64_tr_b16 v[246:247], v118 offset:22528
v_add_u32 v109, s35, v118
Mvva 132,220,24
buffer_load_dwordx4 v114, s[12:15], s50 offen offset:2048 lds
Zvva 148,208,4
s_waitcnt vmcnt(12)
ds_read_b64_tr_b16 v[248:249], v118 offset:24576
ds_read_b64_tr_b16 v[250:251], v118 offset:26624
v_and_b32 v2, 1, v121
Mvva 148,212,12
v_lshlrev_b32 v2, 8, v2
v_and_b32 v3, 15, v0
v_lshl_add_u32 v2, v3, 3, v2
Mvva 148,216,20
s_barrier
ds_read_b64_tr_b16 v[252:253], v118 offset:28672
ds_read_b64_tr_b16 v[254:255], v118 offset:30720
v_add_u32 v2, s35, v2
Mvva 148,220,28
buffer_load_dwordx4 v114, s[12:15], s51 offen offset:3072 lds
v_xor_b32 v114, 128, v114
Zvva 136,224,0
ds_read_b64_tr_b16 v[192:193], v115 offset:32768
ds_read_b64_tr_b16 v[194:195], v115 offset:34816
v_and_b32_e64 v4, 1, v0
Mvva 136,228,8
v_lshlrev_b32 v4, 8, v4
v_add_u32 v4, s35, v4
v_lshl_add_u32 v3, v121, 3, v4
Mvva 136,232,16
ds_read_b64_tr_b16 v[196:197], v115 offset:36864
ds_read_b64_tr_b16 v[198:199], v115 offset:38912
v_lshl_add_u32 v4, v121, 4, v4
Mvva 136,236,24
buffer_load_dwordx4 a[80:83], v112, s[8:11], s52 offen offset:0 sc1
Zvva 152,224,4
s_waitcnt lgkmcnt(4)
ds_read_b64_tr_b16 v[200:201], v115 offset:40960
ds_read_b64_tr_b16 v[202:203], v115 offset:43008
v_lshlrev_b32 v5, 3, v0
Mvva 152,228,12
v_add_u32 v6, 133120, v5
v_mov_b32_e64 v7, 1
Mvva 152,232,20
ds_read_b64_tr_b16 v[204:205], v115 offset:45056
ds_read_b64_tr_b16 v[206:207], v115 offset:47104
Mvva 152,236,28
buffer_load_dwordx4 a[84:87], v112, s[8:11], s52 offen offset:1024 sc1
s_add_u32 s52, s52, 8192
Zvva 140,240,0
ds_read_b64_tr_b16 v[208:209], v116 offset:32768
ds_read_b64_tr_b16 v[210:211], v116 offset:34816
Mvva 140,244,8
s_lshl_b32 s4, s39, 4
s_add_u32 s4, s4, s37
s_lshl_b32 s4, s4, 9
Mvva 140,248,16
ds_read_b64_tr_b16 v[212:213], v116 offset:36864
ds_read_b64_tr_b16 v[214:215], v116 offset:38912
Mvva 140,252,24
buffer_load_dwordx4 a[88:91], v112, s[8:11], s52 offen offset:0 sc1
Zvva 156,240,4
s_waitcnt lgkmcnt(4)
ds_read_b64_tr_b16 v[216:217], v116 offset:40960
ds_read_b64_tr_b16 v[218:219], v116 offset:43008
Mvva 156,244,12
s_add_u32 s4, s4, 5308416
s_lshl_b32 s6, s39, 5
s_add_u32 s6, s6, s37
Mvva 156,248,20
ds_read_b64_tr_b16 v[220:221], v116 offset:45056
ds_read_b64_tr_b16 v[222:223], v116 offset:47104
Mvva 156,252,28
buffer_load_dwordx4 a[92:95], v112, s[8:11], s52 offen offset:1024 sc1
s_add_u32 s52, s52, 8192
Mvva 160,192,32
ds_read_b64_tr_b16 v[224:225], v117 offset:32768
ds_read_b64_tr_b16 v[226:227], v117 offset:34816
Mvva 160,196,40
s_lshl_b32 s6, s6, 2
s_add_u32 s6, s6, 5449728
s_cmp_eq_u32 s32, 0
s_cselect_b32 s4, s4, s64
s_cselect_b32 s6, s6, s64
Mvva 160,200,48
s_add_u32 m0, s44, 81920
ds_read_b64_tr_b16 v[228:229], v117 offset:36864
ds_read_b64_tr_b16 v[230:231], v117 offset:38912
Mvva 160,204,56
buffer_load_dwordx4 v114, s[12:15], s48 offen offset:0 lds
Mvva 176,192,36
s_waitcnt lgkmcnt(4)
ds_read_b64_tr_b16 v[232:233], v117 offset:40960
ds_read_b64_tr_b16 v[234:235], v117 offset:43008
Mvva 176,196,44
s_cmp_lt_u32 s93, 224
s_cselect_b32 s4, s4, 2146435072
s_cselect_b32 s6, s6, 2146435072
Mvva 176,200,52
ds_read_b64_tr_b16 v[236:237], v117 offset:45056
ds_read_b64_tr_b16 v[238:239], v117 offset:47104
Mvva 176,204,60
buffer_load_dwordx4 v114, s[12:15], s49 offen offset:1024 lds
Mvva 164,208,32
ds_read_b64_tr_b16 v[240:241], v118 offset:32768
ds_read_b64_tr_b16 v[242:243], v118 offset:34816
Mvva 164,212,40
Mvva 164,216,48
s_waitcnt lgkmcnt(2)
ds_read_b64_tr_b16 v[244:245], v118 offset:36864
ds_read_b64_tr_b16 v[246:247], v118 offset:38912
Mvva 164,220,56
buffer_load_dwordx4 v114, s[12:15], s50 offen offset:2048 lds
Mvva 180,208,36
s_waitcnt vmcnt(15)
ds_read_b64_tr_b16 v[248:249], v118 offset:40960
ds_read_b64_tr_b16 v[250:251], v118 offset:43008
Mvva 180,212,44
Mvva 180,216,52
s_barrier
ds_read_b64_tr_b16 v[252:253], v118 offset:45056
ds_read_b64_tr_b16 v[254:255], v118 offset:47104
Mvva 180,220,60
buffer_load_dwordx4 v114, s[12:15], s51 offen offset:3072 lds
v_xor_b32 v114, 128, v114
v_add_u32 v114, 262144, v114
Mvva 168,224,32
ds_read_b64_tr_b16 v[192:193], v115 offset:49152
ds_read_b64_tr_b16 v[194:195], v115 offset:51200
Mvva 168,228,40
Mvva 168,232,48
ds_read_b64_tr_b16 v[196:197], v115 offset:53248
ds_read_b64_tr_b16 v[198:199], v115 offset:55296
Mvva 168,236,56
buffer_load_dwordx4 a[96:99], v112, s[8:11], s52 offen offset:0 sc1
Mvva 184,224,36
s_waitcnt lgkmcnt(4)
ds_read_b64_tr_b16 v[200:201], v115 offset:57344
ds_read_b64_tr_b16 v[202:203], v115 offset:59392
Mvva 184,228,44
Mvva 184,232,52
ds_read_b64_tr_b16 v[204:205], v115 offset:61440
ds_read_b64_tr_b16 v[206:207], v115 offset:63488
Mvva 184,236,60
buffer_load_dwordx4 a[100:103], v112, s[8:11], s52 offen offset:1024 sc1
s_add_u32 s52, s52, 8192
Mvva 172,240,32
ds_read_b64_tr_b16 v[208:209], v116 offset:49152
ds_read_b64_tr_b16 v[210:211], v116 offset:51200
Mvva 172,244,40
Mvva 172,248,48
ds_read_b64_tr_b16 v[212:213], v116 offset:53248
ds_read_b64_tr_b16 v[214:215], v116 offset:55296
Mvva 172,252,56
buffer_load_dwordx4 a[104:107], v112, s[8:11], s52 offen offset:0 sc1
Mvva 188,240,36
s_waitcnt lgkmcnt(4)
ds_read_b64_tr_b16 v[216:217], v116 offset:57344
ds_read_b64_tr_b16 v[218:219], v116 offset:59392
Mvva 188,244,44
Mvva 188,248,52
ds_read_b64_tr_b16 v[220:221], v116 offset:61440
ds_read_b64_tr_b16 v[222:223], v116 offset:63488
Mvva 188,252,60
buffer_load_dwordx4 a[108:111], v112, s[8:11], s52 offen offset:1024 sc1
s_add_u32 s52, s52, 8192
Mvva 128,192,32
ds_read_b64_tr_b16 v[224:225], v117 offset:49152
ds_read_b64_tr_b16 v[226:227], v117 offset:51200
Mvva 128,196,40
Mvva 128,200,48
s_add_u32 m0, s44, 98304
ds_read_b64_tr_b16 v[228:229], v117 offset:53248
ds_read_b64_tr_b16 v[230:231], v117 offset:55296
Mvva 128,204,56
buffer_load_dwordx4 v114, s[12:15], s48 offen offset:0 lds
Mvva 144,192,36
s_waitcnt lgkmcnt(4)
ds_read_b64_tr_b16 v[232:233], v117 offset:57344
ds_read_b64_tr_b16 v[234:235], v117 offset:59392
Mvva 144,196,44
Mvva 144,200,52
ds_read_b64_tr_b16 v[236:237], v117 offset:61440
ds_read_b64_tr_b16 v[238:239], v117 offset:63488
Mvva 144,204,60
buffer_load_dwordx4 v114, s[12:15], s49 offen offset:1024 lds
Mvva 132,208,32
ds_read_b64_tr_b16 v[240:241], v118 offset:49152
ds_read_b64_tr_b16 v[242:243], v118 offset:51200
Mvva 132,212,40
Mvva 132,216,48
s_waitcnt lgkmcnt(2)
ds_read_b64_tr_b16 v[244:245], v118 offset:53248
ds_read_b64_tr_b16 v[246:247], v118 offset:55296
Mvva 132,220,56
buffer_load_dwordx4 v114, s[12:15], s50 offen offset:2048 lds
Mvva 148,208,36
s_waitcnt vmcnt(15)
ds_read_b64_tr_b16 v[248:249], v118 offset:57344
ds_read_b64_tr_b16 v[250:251], v118 offset:59392
Mvva 148,212,44
Mvva 148,216,52
s_barrier
ds_read_b64_tr_b16 v[252:253], v118 offset:61440
ds_read_b64_tr_b16 v[254:255], v118 offset:63488
Mvva 148,220,60
buffer_load_dwordx4 v114, s[12:15], s51 offen offset:3072 lds
v_xor_b32 v114, 128, v114
Mvva 136,224,32
ds_read_b64_tr_b16 v[192:193], v12 offset:0
ds_read_b64_tr_b16 v[194:195], v12 offset:2048
Mvva 136,228,40
Mvva 136,232,48
ds_read_b64_tr_b16 v[196:197], v12 offset:4096
ds_read_b64_tr_b16 v[198:199], v12 offset:6144
Mvva 136,236,56
buffer_load_dwordx4 a[112:115], v112, s[8:11], s52 offen offset:0 sc1
Mvva 152,224,36
s_waitcnt lgkmcnt(4)
ds_read_b64_tr_b16 v[200:201], v12 offset:8192
ds_read_b64_tr_b16 v[202:203], v12 offset:10240
Mvva 152,228,44
Mvva 152,232,52
ds_read_b64_tr_b16 v[204:205], v12 offset:12288
ds_read_b64_tr_b16 v[206:207], v12 offset:14336
Mvva 152,236,60
buffer_load_dwordx4 a[116:119], v112, s[8:11], s52 offen offset:1024 sc1
s_add_u32 s52, s52, 8192
Mvva 140,240,32
ds_read_b64_tr_b16 v[208:209], v13 offset:0
ds_read_b64_tr_b16 v[210:211], v13 offset:2048
Mvva 140,244,40
Mvva 140,248,48
ds_read_b64_tr_b16 v[212:213], v13 offset:4096
ds_read_b64_tr_b16 v[214:215], v13 offset:6144
Mvva 140,252,56
buffer_load_dwordx4 a[120:123], v112, s[8:11], s52 offen offset:0 sc1
Mvva 156,240,36
s_waitcnt lgkmcnt(4)
ds_read_b64_tr_b16 v[216:217], v13 offset:8192
ds_read_b64_tr_b16 v[218:219], v13 offset:10240
Mvva 156,244,44
Mvva 156,248,52
s_waitcnt vmcnt(15)
ds_read_b64_tr_b16 v[220:221], v13 offset:12288
ds_read_b64_tr_b16 v[222:223], v13 offset:14336
Mvva 156,252,60
buffer_load_dwordx4 a[124:127], v112, s[8:11], s52 offen offset:1024 sc1
s_add_u32 s52, s52, 8192
Mvva 160,192,64
ds_read_b64_tr_b16 v[224:225], v14 offset:0
ds_read_b64_tr_b16 v[226:227], v14 offset:2048
Mvva 160,196,72
Mvva 160,200,80
s_add_u32 m0, s44, 114688
ds_read_b64_tr_b16 v[228:229], v14 offset:4096
ds_read_b64_tr_b16 v[230:231], v14 offset:6144
Mvva 160,204,88
buffer_load_dwordx4 v114, s[12:15], s48 offen offset:0 lds
Mvva 176,192,68
s_waitcnt lgkmcnt(4)
ds_read_b64_tr_b16 v[232:233], v14 offset:8192
ds_read_b64_tr_b16 v[234:235], v14 offset:10240
Mvva 176,196,76
Mvva 176,200,84
ds_read_b64_tr_b16 v[236:237], v14 offset:12288
ds_read_b64_tr_b16 v[238:239], v14 offset:14336
Mvva 176,204,92
buffer_load_dwordx4 v114, s[12:15], s49 offen offset:1024 lds
Mvva 164,208,64
ds_read_b64_tr_b16 v[240:241], v15 offset:0
ds_read_b64_tr_b16 v[242:243], v15 offset:2048
Mvva 164,212,72
Mvva 164,216,80
s_waitcnt lgkmcnt(2)
ds_read_b64_tr_b16 v[244:245], v15 offset:4096
ds_read_b64_tr_b16 v[246:247], v15 offset:6144
Mvva 164,220,88
buffer_load_dwordx4 v114, s[12:15], s50 offen offset:2048 lds
Mvva 180,208,68
s_waitcnt vmcnt(15)
ds_read_b64_tr_b16 v[248:249], v15 offset:8192
ds_read_b64_tr_b16 v[250:251], v15 offset:10240
Mvva 180,212,76
Mvva 180,216,84
s_barrier
ds_read_b64_tr_b16 v[252:253], v15 offset:12288
ds_read_b64_tr_b16 v[254:255], v15 offset:14336
Mvva 180,220,92
buffer_load_dwordx4 v114, s[12:15], s51 offen offset:3072 lds
v_xor_b32 v114, 128, v114
v_add_u32 v114, 262144, v114
Mvva 168,224,64
ds_read_b64_tr_b16 v[192:193], v12 offset:16384
ds_read_b64_tr_b16 v[194:195], v12 offset:18432
Mvva 168,228,72
Mvva 168,232,80
ds_read_b64_tr_b16 v[196:197], v12 offset:20480
ds_read_b64_tr_b16 v[198:199], v12 offset:22528
Mvva 168,236,88
buffer_load_dwordx4 a[128:131], v112, s[8:11], s52 offen offset:0 sc1
Mvva 184,224,68
s_waitcnt lgkmcnt(4)
ds_read_b64_tr_b16 v[200:201], v12 offset:24576
ds_read_b64_tr_b16 v[202:203], v12 offset:26624
Mvva 184,228,76
Mvva 184,232,84
ds_read_b64_tr_b16 v[204:205], v12 offset:28672
ds_read_b64_tr_b16 v[206:207], v12 offset:30720
Mvva 184,236,92
buffer_load_dwordx4 a[132:135], v112, s[8:11], s52 offen offset:1024 sc1
s_add_u32 s52, s52, 8192
Mvva 172,240,64
ds_read_b64_tr_b16 v[208:209], v13 offset:16384
ds_read_b64_tr_b16 v[210:211], v13 offset:18432
Mvva 172,244,72
Mvva 172,248,80
ds_read_b64_tr_b16 v[212:213], v13 offset:20480
ds_read_b64_tr_b16 v[214:215], v13 offset:22528
Mvva 172,252,88
buffer_load_dwordx4 a[136:139], v112, s[8:11], s52 offen offset:0 sc1
Mvva 188,240,68
s_waitcnt lgkmcnt(4)
ds_read_b64_tr_b16 v[216:217], v13 offset:24576
ds_read_b64_tr_b16 v[218:219], v13 offset:26624
Mvva 188,244,76
Mvva 188,248,84
ds_read_b64_tr_b16 v[220:221], v13 offset:28672
ds_read_b64_tr_b16 v[222:223], v13 offset:30720
Mvva 188,252,92
buffer_load_dwordx4 a[140:143], v112, s[8:11], s52 offen offset:1024 sc1
s_add_u32 s52, s52, 8192
Mvva 128,192,64
ds_read_b64_tr_b16 v[224:225], v14 offset:16384
ds_read_b64_tr_b16 v[226:227], v14 offset:18432
Mvva 128,196,72
s_cmp_lt_u32 s93, 224
s_cbranch_scc1 L_f2A
L_f2Ar:
Mvva 128,200,80
s_add_u32 m0, s44, 0
ds_read_b64_tr_b16 v[228:229], v14 offset:20480
ds_read_b64_tr_b16 v[230:231], v14 offset:22528
Mvva 128,204,88
buffer_load_dwordx4 v114, s[12:15], s48 offen offset:0 lds
Mvva 144,192,68
s_waitcnt lgkmcnt(4)
ds_read_b64_tr_b16 v[232:233], v14 offset:24576
ds_read_b64_tr_b16 v[234:235], v14 offset:26624
Mvva 144,196,76
Mvva 144,200,84
ds_read_b64_tr_b16 v[236:237], v14 offset:28672
ds_read_b64_tr_b16 v[238:239], v14 offset:30720
Mvva 144,204,92
buffer_load_dwordx4 v114, s[12:15], s49 offen offset:1024 lds
Mvva 132,208,64
ds_read_b64_tr_b16 v[240:241], v15 offset:16384
ds_read_b64_tr_b16 v[242:243], v15 offset:18432
Mvva 132,212,72
Mvva 132,216,80
s_waitcnt lgkmcnt(2)
ds_read_b64_tr_b16 v[244:245], v15 offset:20480
ds_read_b64_tr_b16 v[246:247], v15 offset:22528
Mvva 132,220,88
buffer_load_dwordx4 v114, s[12:15], s50 offen offset:2048 lds
Mvva 148,208,68
s_waitcnt vmcnt(15)
ds_read_b64_tr_b16 v[248:249], v15 offset:24576
ds_read_b64_tr_b16 v[250:251], v15 offset:26624
Mvva 148,212,76
Mvva 148,216,84
s_barrier
ds_read_b64_tr_b16 v[252:253], v15 offset:28672
ds_read_b64_tr_b16 v[254:255], v15 offset:30720
Mvva 148,220,92
buffer_load_dwordx4 v114, s[12:15], s51 offen offset:3072 lds
v_xor_b32 v114, 128, v114
Mvva 136,224,64
ds_read_b64_tr_b16 v[192:193], v12 offset:32768
ds_read_b64_tr_b16 v[194:195], v12 offset:34816
Mvva 136,228,72
Mvva 136,232,80
ds_read_b64_tr_b16 v[196:197], v12 offset:36864
ds_read_b64_tr_b16 v[198:199], v12 offset:38912
Mvva 136,236,88
buffer_load_dwordx4 a[144:147], v112, s[8:11], s52 offen offset:0 sc1
Mvva 152,224,68
s_waitcnt lgkmcnt(4)
ds_read_b64_tr_b16 v[200:201], v12 offset:40960
ds_read_b64_tr_b16 v[202:203], v12 offset:43008
Mvva 152,228,76
Mvva 152,232,84
ds_read_b64_tr_b16 v[204:205], v12 offset:45056
ds_read_b64_tr_b16 v[206:207], v12 offset:47104
Mvva 152,236,92
buffer_load_dwordx4 a[148:151], v112, s[8:11], s52 offen offset:1024 sc1
s_add_u32 s52, s52, 8192
Mvva 140,240,64
ds_read_b64_tr_b16 v[208:209], v13 offset:32768
ds_read_b64_tr_b16 v[210:211], v13 offset:34816
Mvva 140,244,72
Mvva 140,248,80
ds_read_b64_tr_b16 v[212:213], v13 offset:36864
ds_read_b64_tr_b16 v[214:215], v13 offset:38912
Mvva 140,252,88
buffer_load_dwordx4 a[152:155], v112, s[8:11], s52 offen offset:0 sc1
Mvva 156,240,68
s_waitcnt lgkmcnt(4)
ds_read_b64_tr_b16 v[216:217], v13 offset:40960
ds_read_b64_tr_b16 v[218:219], v13 offset:43008
Mvva 156,244,76
Mvva 156,248,84
s_waitcnt vmcnt(15)
ds_read_b64_tr_b16 v[220:221], v13 offset:45056
ds_read_b64_tr_b16 v[222:223], v13 offset:47104
Mvva 156,252,92
buffer_load_dwordx4 a[156:159], v112, s[8:11], s52 offen offset:1024 sc1
s_add_u32 s52, s52, 8192
Mvva 160,192,96
ds_read_b64_tr_b16 v[224:225], v14 offset:32768
ds_read_b64_tr_b16 v[226:227], v14 offset:34816
Mvva 160,196,104
Mvva 160,200,112
s_add_u32 m0, s44, 16384
ds_read_b64_tr_b16 v[228:229], v14 offset:36864
ds_read_b64_tr_b16 v[230:231], v14 offset:38912
Mvva 160,204,120
buffer_load_dwordx4 v114, s[12:15], s48 offen offset:0 lds
Mvva 176,192,100
s_waitcnt lgkmcnt(4)
ds_read_b64_tr_b16 v[232:233], v14 offset:40960
ds_read_b64_tr_b16 v[234:235], v14 offset:43008
Mvva 176,196,108
Mvva 176,200,116
ds_read_b64_tr_b16 v[236:237], v14 offset:45056
ds_read_b64_tr_b16 v[238:239], v14 offset:47104
Mvva 176,204,124
buffer_load_dwordx4 v114, s[12:15], s49 offen offset:1024 lds
Mvva 164,208,96
ds_read_b64_tr_b16 v[240:241], v15 offset:32768
ds_read_b64_tr_b16 v[242:243], v15 offset:34816
Mvva 164,212,104
Mvva 164,216,112
s_waitcnt lgkmcnt(2)
ds_read_b64_tr_b16 v[244:245], v15 offset:36864
ds_read_b64_tr_b16 v[246:247], v15 offset:38912
Mvva 164,220,120
buffer_load_dwordx4 v114, s[12:15], s50 offen offset:2048 lds
Mvva 180,208,100
s_waitcnt vmcnt(15)
ds_read_b64_tr_b16 v[248:249], v15 offset:40960
ds_read_b64_tr_b16 v[250:251], v15 offset:43008
Mvva 180,212,108
Mvva 180,216,116
s_barrier
ds_read_b64_tr_b16 v[252:253], v15 offset:45056
ds_read_b64_tr_b16 v[254:255], v15 offset:47104
Mvva 180,220,124
buffer_load_dwordx4 v114, s[12:15], s51 offen offset:3072 lds
v_xor_b32 v114, 128, v114
v_add_u32 v114, 262144, v114
Mvva 168,224,96
ds_read_b64_tr_b16 v[192:193], v12 offset:49152
ds_read_b64_tr_b16 v[194:195], v12 offset:51200
Mvva 168,228,104
Mvva 168,232,112
ds_read_b64_tr_b16 v[196:197], v12 offset:53248
ds_read_b64_tr_b16 v[198:199], v12 offset:55296
Mvva 168,236,120
buffer_load_dwordx4 a[160:163], v112, s[8:11], s52 offen offset:0 sc1
Mvva 184,224,100
s_waitcnt lgkmcnt(4)
ds_read_b64_tr_b16 v[200:201], v12 offset:57344
ds_read_b64_tr_b16 v[202:203], v12 offset:59392
Mvva 184,228,108
Mvva 184,232,116
ds_read_b64_tr_b16 v[204:205], v12 offset:61440
ds_read_b64_tr_b16 v[206:207], v12 offset:63488
Mvva 184,236,124
buffer_load_dwordx4 a[164:167], v112, s[8:11], s52 offen offset:1024 sc1
s_add_u32 s52, s52, 8192
Mvva 172,240,96
ds_read_b64_tr_b16 v[208:209], v13 offset:49152
ds_read_b64_tr_b16 v[210:211], v13 offset:51200
Mvva 172,244,104
Mvva 172,248,112
ds_read_b64_tr_b16 v[212:213], v13 offset:53248
ds_read_b64_tr_b16 v[214:215], v13 offset:55296
Mvva 172,252,120
buffer_load_dwordx4 a[168:171], v112, s[8:11], s52 offen offset:0 sc1
Mvva 188,240,100
s_waitcnt lgkmcnt(4)
ds_read_b64_tr_b16 v[216:217], v13 offset:57344
ds_read_b64_tr_b16 v[218:219], v13 offset:59392
Mvva 188,244,108
Mvva 188,248,116
ds_read_b64_tr_b16 v[220:221], v13 offset:61440
ds_read_b64_tr_b16 v[222:223], v13 offset:63488
Mvva 188,252,124
buffer_load_dwordx4 a[172:175], v112, s[8:11], s52 offen offset:1024 sc1
s_add_u32 s52, s52, 8192
Mvva 128,192,96
ds_read_b64_tr_b16 v[224:225], v14 offset:49152
ds_read_b64_tr_b16 v[226:227], v14 offset:51200
Mvva 128,196,104
Mvva 128,200,112
s_add_u32 m0, s44, 32768
ds_read_b64_tr_b16 v[228:229], v14 offset:53248
ds_read_b64_tr_b16 v[230:231], v14 offset:55296
Mvva 128,204,120
buffer_load_dwordx4 v114, s[12:15], s48 offen offset:0 lds
Mvva 144,192,100
s_waitcnt lgkmcnt(4)
ds_read_b64_tr_b16 v[232:233], v14 offset:57344
ds_read_b64_tr_b16 v[234:235], v14 offset:59392
Mvva 144,196,108
Mvva 144,200,116
ds_read_b64_tr_b16 v[236:237], v14 offset:61440
ds_read_b64_tr_b16 v[238:239], v14 offset:63488
Mvva 144,204,124
buffer_load_dwordx4 v114, s[12:15], s49 offen offset:1024 lds
Mvva 132,208,96
ds_read_b64_tr_b16 v[240:241], v15 offset:49152
ds_read_b64_tr_b16 v[242:243], v15 offset:51200
Mvva 132,212,104
Mvva 132,216,112
s_waitcnt lgkmcnt(2)
ds_read_b64_tr_b16 v[244:245], v15 offset:53248
ds_read_b64_tr_b16 v[246:247], v15 offset:55296
Mvva 132,220,120
buffer_load_dwordx4 v114, s[12:15], s50 offen offset:2048 lds
Mvva 148,208,100
s_waitcnt vmcnt(15)
ds_read_b64_tr_b16 v[248:249], v15 offset:57344
ds_read_b64_tr_b16 v[250:251], v15 offset:59392
Mvva 148,212,108
s_cmp_lt_u32 s93, 224
s_cbranch_scc1 L_f2B
L_f2Br:
Mvva 148,216,116
s_barrier
ds_read_b64_tr_b16 v[252:253], v15 offset:61440
ds_read_b64_tr_b16 v[254:255], v15 offset:63488
Mvva 148,220,124
buffer_load_dwordx4 v114, s[12:15], s51 offen offset:3072 lds
v_xor_b32 v114, 128, v114
Mvva 136,224,96
ds_read_b64_tr_b16 v[192:193], v115 offset:0
ds_read_b64_tr_b16 v[194:195], v115 offset:2048
Mvva 136,228,104
Mvva 136,232,112
ds_read_b64_tr_b16 v[196:197], v115 offset:4096
ds_read_b64_tr_b16 v[198:199], v115 offset:6144
Mvva 136,236,120
buffer_load_dwordx4 a[176:179], v112, s[8:11], s52 offen offset:0 sc1
Mvva 152,224,100
s_waitcnt lgkmcnt(4)
ds_read_b64_tr_b16 v[200:201], v115 offset:8192
ds_read_b64_tr_b16 v[202:203], v115 offset:10240
Mvva 152,228,108
Mvva 152,232,116
ds_read_b64_tr_b16 v[204:205], v115 offset:12288
ds_read_b64_tr_b16 v[206:207], v115 offset:14336
Mvva 152,236,124
buffer_load_dwordx4 a[180:183], v112, s[8:11], s52 offen offset:1024 sc1
s_add_u32 s52, s52, 8192
Mvva 140,240,96
ds_read_b64_tr_b16 v[208:209], v116 offset:0
ds_read_b64_tr_b16 v[210:211], v116 offset:2048
Mvva 140,244,104
Mvva 140,248,112
ds_read_b64_tr_b16 v[212:213], v116 offset:4096
ds_read_b64_tr_b16 v[214:215], v116 offset:6144
Mvva 140,252,120
buffer_load_dwordx4 a[184:187], v112, s[8:11], s52 offen offset:0 sc1
Mvva 156,240,100
s_waitcnt lgkmcnt(4)
ds_read_b64_tr_b16 v[216:217], v116 offset:8192
ds_read_b64_tr_b16 v[218:219], v116 offset:10240
Mvva 156,244,108
Mvva 156,248,116
s_waitcnt vmcnt(15)
ds_read_b64_tr_b16 v[220:221], v116 offset:12288
ds_read_b64_tr_b16 v[222:223], v116 offset:14336
Mvva 156,252,124
buffer_load_dwordx4 a[188:191], v112, s[8:11], s52 offen offset:1024 sc1
s_add_u32 s52, s52, 8192
Mvva 160,192,128
ds_read_b64_tr_b16 v[224:225], v117 offset:0
ds_read_b64_tr_b16 v[226:227], v117 offset:2048
Mvva 160,196,136
Mvva 160,200,144
s_add_u32 m0, s44, 49152
ds_read_b64_tr_b16 v[228:229], v117 offset:4096
ds_read_b64_tr_b16 v[230:231], v117 offset:6144
Mvva 160,204,152
buffer_load_dwordx4 v114, s[12:15], s48 offen offset:0 lds
Mvva 176,192,132
s_waitcnt lgkmcnt(4)
ds_read_b64_tr_b16 v[232:233], v117 offset:8192
ds_read_b64_tr_b16 v[234:235], v117 offset:10240
Mvva 176,196,140
Mvva 176,200,148
ds_read_b64_tr_b16 v[236:237], v117 offset:12288
ds_read_b64_tr_b16 v[238:239], v117 offset:14336
Mvva 176,204,156
buffer_load_dwordx4 v114, s[12:15], s49 offen offset:1024 lds
Mvva 164,208,128
ds_read_b64_tr_b16 v[240:241], v118 offset:0
ds_read_b64_tr_b16 v[242:243], v118 offset:2048
Mvva 164,212,136
Mvva 164,216,144
s_waitcnt lgkmcnt(2)
ds_read_b64_tr_b16 v[244:245], v118 offset:4096
ds_read_b64_tr_b16 v[246:247], v118 offset:6144
Mvva 164,220,152
buffer_load_dwordx4 v114, s[12:15], s50 offen offset:2048 lds
Mvva 180,208,132
s_waitcnt vmcnt(15)
ds_read_b64_tr_b16 v[248:249], v118 offset:8192
ds_read_b64_tr_b16 v[250:251], v118 offset:10240
Mvva 180,212,140
Mvva 180,216,148
s_barrier
ds_read_b64_tr_b16 v[252:253], v118 offset:12288
ds_read_b64_tr_b16 v[254:255], v118 offset:14336
Mvva 180,220,156
buffer_load_dwordx4 v114, s[12:15], s51 offen offset:3072 lds
v_xor_b32 v114, 128, v114
v_add_u32 v114, 262144, v114
Mvva 168,224,128
ds_read_b64_tr_b16 v[192:193], v115 offset:16384
ds_read_b64_tr_b16 v[194:195], v115 offset:18432
Mvva 168,228,136
Mvva 168,232,144
ds_read_b64_tr_b16 v[196:197], v115 offset:20480
ds_read_b64_tr_b16 v[198:199], v115 offset:22528
Mvva 168,236,152
buffer_load_dwordx4 a[192:195], v112, s[8:11], s52 offen offset:0 sc1
Mvva 184,224,132
s_waitcnt lgkmcnt(4)
ds_read_b64_tr_b16 v[200:201], v115 offset:24576
ds_read_b64_tr_b16 v[202:203], v115 offset:26624
Mvva 184,228,140
Mvva 184,232,148
ds_read_b64_tr_b16 v[204:205], v115 offset:28672
ds_read_b64_tr_b16 v[206:207], v115 offset:30720
Mvva 184,236,156
buffer_load_dwordx4 a[196:199], v112, s[8:11], s52 offen offset:1024 sc1
s_add_u32 s52, s52, 8192
Mvva 172,240,128
ds_read_b64_tr_b16 v[208:209], v116 offset:16384
ds_read_b64_tr_b16 v[210:211], v116 offset:18432
Mvva 172,244,136
Mvva 172,248,144
ds_read_b64_tr_b16 v[212:213], v116 offset:20480
ds_read_b64_tr_b16 v[214:215], v116 offset:22528
Mvva 172,252,152
buffer_load_dwordx4 a[200:203], v112, s[8:11], s52 offen offset:0 sc1
Mvva 188,240,132
s_waitcnt lgkmcnt(4)
ds_read_b64_tr_b16 v[216:217], v116 offset:24576
ds_read_b64_tr_b16 v[218:219], v116 offset:26624
Mvva 188,244,140
Mvva 188,248,148
ds_read_b64_tr_b16 v[220:221], v116 offset:28672
ds_read_b64_tr_b16 v[222:223], v116 offset:30720
Mvva 188,252,156
buffer_load_dwordx4 a[204:207], v112, s[8:11], s52 offen offset:1024 sc1
s_add_u32 s52, s52, 8192
Mvva 128,192,128
ds_read_b64_tr_b16 v[224:225], v117 offset:16384
ds_read_b64_tr_b16 v[226:227], v117 offset:18432
Mvva 128,196,136
Mvva 128,200,144
s_add_u32 m0, s44, 65536
ds_read_b64_tr_b16 v[228:229], v117 offset:20480
ds_read_b64_tr_b16 v[230:231], v117 offset:22528
Mvva 128,204,152
buffer_load_dwordx4 v114, s[12:15], s48 offen offset:0 lds
Mvva 144,192,132
s_waitcnt lgkmcnt(4)
ds_read_b64_tr_b16 v[232:233], v117 offset:24576
ds_read_b64_tr_b16 v[234:235], v117 offset:26624
Mvva 144,196,140
Mvva 144,200,148
ds_read_b64_tr_b16 v[236:237], v117 offset:28672
ds_read_b64_tr_b16 v[238:239], v117 offset:30720
Mvva 144,204,156
buffer_load_dwordx4 v114, s[12:15], s49 offen offset:1024 lds
Mvva 132,208,128
ds_read_b64_tr_b16 v[240:241], v118 offset:16384
ds_read_b64_tr_b16 v[242:243], v118 offset:18432
Mvva 132,212,136
Mvva 132,216,144
s_waitcnt lgkmcnt(2)
ds_read_b64_tr_b16 v[244:245], v118 offset:20480
ds_read_b64_tr_b16 v[246:247], v118 offset:22528
Mvva 132,220,152
buffer_load_dwordx4 v114, s[12:15], s50 offen offset:2048 lds
Mvva 148,208,132
s_waitcnt vmcnt(15)
ds_read_b64_tr_b16 v[248:249], v118 offset:24576
ds_read_b64_tr_b16 v[250:251], v118 offset:26624
Mvva 148,212,140
Mvva 148,216,148
s_barrier
ds_read_b64_tr_b16 v[252:253], v118 offset:28672
ds_read_b64_tr_b16 v[254:255], v118 offset:30720
Mvva 148,220,156
buffer_load_dwordx4 v114, s[12:15], s51 offen offset:3072 lds
v_xor_b32 v114, 128, v114
Mvva 136,224,128
ds_read_b64_tr_b16 v[192:193], v115 offset:32768
ds_read_b64_tr_b16 v[194:195], v115 offset:34816
Mvva 136,228,136
s_cmp_ge_u32 s2, 128
s_cbranch_scc1 L_c31
L_c31r:
Mvva 136,232,144
ds_read_b64_tr_b16 v[196:197], v115 offset:36864
ds_read_b64_tr_b16 v[198:199], v115 offset:38912
Mvva 136,236,152
buffer_load_dwordx4 a[208:211], v112, s[8:11], s52 offen offset:0 sc1
Mvva 152,224,132
s_waitcnt lgkmcnt(4)
ds_read_b64_tr_b16 v[200:201], v115 offset:40960
ds_read_b64_tr_b16 v[202:203], v115 offset:43008
Mvva 152,228,140
Mvva 152,232,148
ds_read_b64_tr_b16 v[204:205], v115 offset:45056
ds_read_b64_tr_b16 v[206:207], v115 offset:47104
Mvva 152,236,156
buffer_load_dwordx4 a[212:215], v112, s[8:11], s52 offen offset:1024 sc1
s_add_u32 s52, s52, 8192
Mvva 140,240,128
ds_read_b64_tr_b16 v[208:209], v116 offset:32768
ds_read_b64_tr_b16 v[210:211], v116 offset:34816
Mvva 140,244,136
Mvva 140,248,144
ds_read_b64_tr_b16 v[212:213], v116 offset:36864
ds_read_b64_tr_b16 v[214:215], v116 offset:38912
Mvva 140,252,152
buffer_load_dwordx4 a[216:219], v112, s[8:11], s52 offen offset:0 sc1
Mvva 156,240,132
s_waitcnt lgkmcnt(4)
ds_read_b64_tr_b16 v[216:217], v116 offset:40960
ds_read_b64_tr_b16 v[218:219], v116 offset:43008
Mvva 156,244,140
s_waitcnt vmcnt(16)
Va 74,74,78
Va 75,75,79
v_add_f32_e64 v76, v76, v80
Mvva 156,248,148
s_waitcnt vmcnt(15)
ds_read_b64_tr_b16 v[220:221], v116 offset:45056
ds_read_b64_tr_b16 v[222:223], v116 offset:47104
Va 77,77,81
Mvva 156,252,156
buffer_load_dwordx4 a[220:223], v112, s[8:11], s52 offen offset:1024 sc1
s_add_u32 s52, s52, 8192
Mvva 160,192,160
ds_read_b64_tr_b16 v[224:225], v117 offset:32768
ds_read_b64_tr_b16 v[226:227], v117 offset:34816
v_add_f32_e64 v74, v74, v82
Mvva 160,196,168
Va 75,75,83
Va 76,76,84
v_add_f32_e64 v77, v77, v85
Mvva 160,200,176
s_add_u32 m0, s44, 81920
ds_read_b64_tr_b16 v[228:229], v117 offset:36864
ds_read_b64_tr_b16 v[230:231], v117 offset:38912
v_add_f32_e64 v74, v74, v86
Mvva 160,204,184
buffer_load_dwordx4 v114, s[12:15], s48 offen offset:0 lds
Mvva 176,192,164
s_waitcnt lgkmcnt(4)
ds_read_b64_tr_b16 v[232:233], v117 offset:40960
ds_read_b64_tr_b16 v[234:235], v117 offset:43008
Va 75,75,87
Mvva 176,196,172
Va 76,76,88
Va 77,77,89
v_add_f32_e64 v74, v74, v90
Mvva 176,200,180
ds_read_b64_tr_b16 v[236:237], v117 offset:45056
ds_read_b64_tr_b16 v[238:239], v117 offset:47104
v_add_f32_e64 v75, v75, v91
Mvva 176,204,188
buffer_load_dwordx4 v114, s[12:15], s49 offen offset:1024 lds
Mvva 164,208,160
ds_read_b64_tr_b16 v[240:241], v118 offset:32768
ds_read_b64_tr_b16 v[242:243], v118 offset:34816
v_add_f32_e64 v76, v76, v92
Mvva 164,212,168
Va 77,77,93
Va 74,74,94
v_add_f32_e64 v75, v75, v95
Mvva 164,216,176
s_waitcnt lgkmcnt(2)
ds_read_b64_tr_b16 v[244:245], v118 offset:36864
ds_read_b64_tr_b16 v[246:247], v118 offset:38912
Va 76,76,96
Mvva 164,220,184
buffer_load_dwordx4 v114, s[12:15], s50 offen offset:2048 lds
Mvva 180,208,164
s_waitcnt vmcnt(15)
ds_read_b64_tr_b16 v[248:249], v118 offset:40960
ds_read_b64_tr_b16 v[250:251], v118 offset:43008
Va 77,77,97
Mvva 180,212,172
Va 74,74,98
Va 75,75,99
v_add_f32_e64 v76, v76, v100
Mvva 180,216,180
s_barrier
ds_read_b64_tr_b16 v[252:253], v118 offset:45056
ds_read_b64_tr_b16 v[254:255], v118 offset:47104
Va 77,77,101
Mvva 180,220,188
buffer_load_dwordx4 v114, s[12:15], s51 offen offset:3072 lds
v_xor_b32 v114, 128, v114
v_add_u32 v114, 262144, v114
Mvva 168,224,160
ds_read_b64_tr_b16 v[192:193], v115 offset:49152
ds_read_b64_tr_b16 v[194:195], v115 offset:51200
v_add_f32_e64 v74, v74, v102
Mvva 168,228,168
Va 75,75,103
Va 76,76,104
v_add_f32_e64 v77, v77, v105
Mvva 168,232,176
ds_read_b64_tr_b16 v[196:197], v115 offset:53248
ds_read_b64_tr_b16 v[198:199], v115 offset:55296
Mvva 168,236,184
buffer_load_dwordx4 a[224:227], v112, s[8:11], s52 offen offset:0 sc1
Mvva 184,224,164
s_waitcnt lgkmcnt(4)
ds_read_b64_tr_b16 v[200:201], v115 offset:57344
ds_read_b64_tr_b16 v[202:203], v115 offset:59392
Mvva 184,228,172
ds_read_b64_tr_b16 v[90:91], v106 offset:0
ds_read_b64_tr_b16 v[92:93], v106 offset:2048
ds_read_b64_tr_b16 v[94:95], v107 offset:0
Mvva 184,232,180
ds_read_b64_tr_b16 v[204:205], v115 offset:61440
ds_read_b64_tr_b16 v[206:207], v115 offset:63488
Mvva 184,236,188
buffer_load_dwordx4 a[228:231], v112, s[8:11], s52 offen offset:1024 sc1
s_add_u32 s52, s52, 8192
Mvva 172,240,160
ds_read_b64_tr_b16 v[208:209], v116 offset:49152
ds_read_b64_tr_b16 v[210:211], v116 offset:51200
Mvva 172,244,168
ds_read_b64_tr_b16 v[96:97], v107 offset:2048
ds_read_b64_tr_b16 v[98:99], v108 offset:0
s_waitcnt lgkmcnt(9)
ds_read_b64_tr_b16 v[100:101], v108 offset:2048
Mvva 172,248,176
ds_read_b64_tr_b16 v[212:213], v116 offset:53248
ds_read_b64_tr_b16 v[214:215], v116 offset:55296
Mvva 172,252,184
buffer_load_dwordx4 a[232:235], v112, s[8:11], s52 offen offset:0 sc1
Mvva 188,240,164
s_waitcnt lgkmcnt(7)
ds_read_b64_tr_b16 v[216:217], v116 offset:57344
ds_read_b64_tr_b16 v[218:219], v116 offset:59392
Mvva 188,244,172
ds_read_b64_tr_b16 v[102:103], v109 offset:0
ds_read_b64_tr_b16 v[104:105], v109 offset:2048
Vc 8,74,75
Mvva 188,248,180
ds_read_b64_tr_b16 v[220:221], v116 offset:61440
ds_read_b64_tr_b16 v[222:223], v116 offset:63488
v_lshlrev_b32 v74, 16, v8
Mvva 188,252,188
buffer_load_dwordx4 a[236:239], v112, s[8:11], s52 offen offset:1024 sc1
s_add_u32 s52, s52, 8192
Mvva 128,192,160
ds_read_b64_tr_b16 v[224:225], v117 offset:49152
ds_read_b64_tr_b16 v[226:227], v117 offset:51200
v_and_b32 v75, 0xffff0000, v8
Mvva 128,196,168
Vc 8,76,77
v_lshlrev_b32_e64 v76, 16, v8
v_and_b32 v77, 0xffff0000, v8
Mvva 128,200,176
s_add_u32 m0, s44, 98304
s_waitcnt lgkmcnt(9)
ds_read_b64_tr_b16 v[228:229], v117 offset:53248
ds_read_b64_tr_b16 v[230:231], v117 offset:55296
v_mov_b32 v78, v74
Mvva 128,204,184
buffer_load_dwordx4 v114, s[12:15], s48 offen offset:0 lds
Mvva 144,192,164
s_waitcnt lgkmcnt(4)
ds_read_b64_tr_b16 v[232:233], v117 offset:57344
ds_read_b64_tr_b16 v[234:235], v117 offset:59392
v_mov_b32 v79, v75
Mvva 144,196,172
v_mov_b32 v80, v76
v_mov_b32 v81, v77
v_permlane32_swap_b32 v78, v74
Mvva 144,200,180
ds_read_b64_tr_b16 v[236:237], v117 offset:61440
ds_read_b64_tr_b16 v[238:239], v117 offset:63488
v_permlane32_swap_b32 v79, v75
Mvva 144,204,188
buffer_load_dwordx4 v114, s[12:15], s49 offen offset:1024 lds
Mvva 132,208,160
ds_read_b64_tr_b16 v[240:241], v118 offset:49152
ds_read_b64_tr_b16 v[242:243], v118 offset:51200
v_permlane32_swap_b32 v80, v76
Mvva 132,212,168
v_permlane32_swap_b32 v81, v77
v_mul_f32 v82, 0xbfb8aa3b, v78
v_mul_f32 v83, 0xbfb8aa3b, v79
Mvva 132,216,176
s_waitcnt lgkmcnt(2)
ds_read_b64_tr_b16 v[244:245], v118 offset:53248
ds_read_b64_tr_b16 v[246:247], v118 offset:55296
v_mul_f32 v84, 0xbfb8aa3b, v80
Mvva 132,220,184
buffer_load_dwordx4 v114, s[12:15], s50 offen offset:2048 lds
Mvva 148,208,164
s_waitcnt vmcnt(15)
ds_read_b64_tr_b16 v[248:249], v118 offset:57344
ds_read_b64_tr_b16 v[250:251], v118 offset:59392
v_mul_f32 v85, 0xbfb8aa3b, v81
Mvva 148,212,172
VE 82,82
Mvva 148,216,180
s_barrier
ds_read_b64_tr_b16 v[252:253], v118 offset:61440
ds_read_b64_tr_b16 v[254:255], v118 offset:63488
Mvva 148,220,188
buffer_load_dwordx4 v114, s[12:15], s51 offen offset:3072 lds
v_xor_b32 v114, 128, v114
Mvva 136,224,160
ds_read_b64_tr_b16 v[192:193], v12 offset:0
ds_read_b64_tr_b16 v[194:195], v12 offset:2048
Mvva 136,228,168
Ve 83,83
Mvva 136,232,176
ds_read_b64_tr_b16 v[196:197], v12 offset:4096
ds_read_b64_tr_b16 v[198:199], v12 offset:6144
Mvva 136,236,184
buffer_load_dwordx4 a[240:243], v112, s[8:11], s52 offen offset:0 sc1
Mvva 152,224,164
s_waitcnt lgkmcnt(4)
ds_read_b64_tr_b16 v[200:201], v12 offset:8192
ds_read_b64_tr_b16 v[202:203], v12 offset:10240
Mvva 152,228,172
Ve 84,84
Mvva 152,232,180
ds_read_b64_tr_b16 v[204:205], v12 offset:12288
ds_read_b64_tr_b16 v[206:207], v12 offset:14336
Mvva 152,236,188
buffer_load_dwordx4 a[244:247], v112, s[8:11], s52 offen offset:1024 sc1
s_add_u32 s52, s52, 8192
Mvva 140,240,160
ds_read_b64_tr_b16 v[208:209], v13 offset:0
ds_read_b64_tr_b16 v[210:211], v13 offset:2048
Mvva 140,244,168
Ve 85,85
v_add_f32 v82, 1.0, v82
Mvva 140,248,176
ds_read_b64_tr_b16 v[212:213], v13 offset:4096
ds_read_b64_tr_b16 v[214:215], v13 offset:6144
v_add_f32_e64 v83, 1.0, v83
Mvva 140,252,184
buffer_load_dwordx4 a[248:251], v112, s[8:11], s52 offen offset:0 sc1
Mvva 156,240,164
s_waitcnt lgkmcnt(4)
ds_read_b64_tr_b16 v[216:217], v13 offset:8192
ds_read_b64_tr_b16 v[218:219], v13 offset:10240
v_add_f32 v84, 1.0, v84
Mvva 156,244,172
v_add_f32 v85, 1.0, v85
v_rcp_f32 v82, v82
Mvva 156,248,180
s_waitcnt vmcnt(15)
ds_read_b64_tr_b16 v[220:221], v13 offset:12288
ds_read_b64_tr_b16 v[222:223], v13 offset:14336
Mvva 156,252,188
buffer_load_dwordx4 a[252:255], v112, s[8:11], s52 offen offset:1024 sc1
s_add_u32 s52, s52, 8192
Mvva 160,192,192
ds_read_b64_tr_b16 v[224:225], v14 offset:0
ds_read_b64_tr_b16 v[226:227], v14 offset:2048
Mvva 160,196,200
v_rcp_f32 v83, v83
Mvva 160,200,208
s_add_u32 m0, s44, 114688
ds_read_b64_tr_b16 v[228:229], v14 offset:4096
ds_read_b64_tr_b16 v[230:231], v14 offset:6144
Mvva 160,204,216
buffer_load_dwordx4 v114, s[12:15], s48 offen offset:0 lds
Mvva 176,192,196
s_waitcnt lgkmcnt(4)
ds_read_b64_tr_b16 v[232:233], v14 offset:8192
ds_read_b64_tr_b16 v[234:235], v14 offset:10240
Mvva 176,196,204
v_rcp_f32 v84, v84
Mvva 176,200,212
ds_read_b64_tr_b16 v[236:237], v14 offset:12288
ds_read_b64_tr_b16 v[238:239], v14 offset:14336
Mvva 176,204,220
buffer_load_dwordx4 v114, s[12:15], s49 offen offset:1024 lds
Mvva 164,208,192
ds_read_b64_tr_b16 v[240:241], v15 offset:0
ds_read_b64_tr_b16 v[242:243], v15 offset:2048
Mvva 164,212,200
v_rcp_f32 v85, v85
Vm 78,78,82
Mvva 164,216,208
s_waitcnt lgkmcnt(2)
ds_read_b64_tr_b16 v[244:245], v15 offset:4096
ds_read_b64_tr_b16 v[246:247], v15 offset:6144
Vm 79,79,83
Mvva 164,220,216
buffer_load_dwordx4 v114, s[12:15], s50 offen offset:2048 lds
Mvva 180,208,196
s_waitcnt vmcnt(15)
ds_read_b64_tr_b16 v[248:249], v15 offset:8192
ds_read_b64_tr_b16 v[250:251], v15 offset:10240
Vm 80,80,84
Mvva 180,212,204
v_mul_f32_e64 v81, v81, v85
Vc 8,78,79
v_lshlrev_b32_e64 v78, 16, v8
Mvva 180,216,212
s_barrier
ds_read_b64_tr_b16 v[252:253], v15 offset:12288
ds_read_b64_tr_b16 v[254:255], v15 offset:14336
v_and_b32 v79, 0xffff0000, v8
Mvva 180,220,220
buffer_load_dwordx4 v114, s[12:15], s51 offen offset:3072 lds
v_xor_b32 v114, 128, v114
v_add_u32 v114, 262144, v114
Mvva 168,224,192
ds_read_b64_tr_b16 v[192:193], v12 offset:16384
ds_read_b64_tr_b16 v[194:195], v12 offset:18432
Vc 8,80,81
Mvva 168,228,200
v_lshlrev_b32 v80, 16, v8
v_and_b32 v81, 0xffff0000, v8
v_mul_f32_e64 v74, v74, v78
Mvva 168,232,208
ds_read_b64_tr_b16 v[196:197], v12 offset:20480
ds_read_b64_tr_b16 v[198:199], v12 offset:22528
v_mul_f32_e64 v75, v75, v79
Mvva 168,236,216
buffer_load_dwordx4 a[0:3], v112, s[8:11], s52 offen offset:0 sc1
Mvva 184,224,196
s_waitcnt lgkmcnt(4)
ds_read_b64_tr_b16 v[200:201], v12 offset:24576
ds_read_b64_tr_b16 v[202:203], v12 offset:26624
Vm 76,76,80
Mvva 184,228,204
v_mul_f32_e64 v77, v77, v81
Vc 8,74,75
Vc 9,76,77
Mvva 184,232,212
ds_read_b64_tr_b16 v[204:205], v12 offset:28672
ds_read_b64_tr_b16 v[206:207], v12 offset:30720
Mvva 184,236,220
buffer_load_dwordx4 a[4:7], v112, s[8:11], s52 offen offset:1024 sc1
s_add_u32 s52, s52, 8192
Mvva 172,240,192
ds_read_b64_tr_b16 v[208:209], v13 offset:16384
ds_read_b64_tr_b16 v[210:211], v13 offset:18432
Mvva 172,244,200
ds_write_b64 v2, v[8:9]
ds_read_b64 v[74:75], v3 offset:0
ds_read_b64 v[76:77], v3 offset:32
Mvva 172,248,208
ds_read_b64_tr_b16 v[212:213], v13 offset:20480
ds_read_b64_tr_b16 v[214:215], v13 offset:22528
Mvva 172,252,216
buffer_load_dwordx4 a[8:11], v112, s[8:11], s52 offen offset:0 sc1
Mvva 188,240,196
s_waitcnt lgkmcnt(7)
ds_read_b64_tr_b16 v[216:217], v13 offset:24576
ds_read_b64_tr_b16 v[218:219], v13 offset:26624
Mvva 188,244,204
ds_read_b64 v[78:79], v3 offset:64
ds_read_b64 v[80:81], v3 offset:96
Mvva 188,248,212
ds_read_b64_tr_b16 v[220:221], v13 offset:28672
ds_read_b64_tr_b16 v[222:223], v13 offset:30720
Mvva 188,252,220
buffer_load_dwordx4 a[12:15], v112, s[8:11], s52 offen offset:1024 sc1
s_add_u32 s52, s52, 8192
Mvva 128,192,192
ds_read_b64_tr_b16 v[224:225], v14 offset:16384
ds_read_b64_tr_b16 v[226:227], v14 offset:18432
Mvva 128,196,200
Mvva 128,200,208
s_add_u32 m0, s44, 0
s_waitcnt lgkmcnt(9)
ds_read_b64_tr_b16 v[228:229], v14 offset:20480
ds_read_b64_tr_b16 v[230:231], v14 offset:22528
Mvva 128,204,216
buffer_load_dwordx4 v114, s[12:15], s48 offen offset:0 lds
Mvva 144,192,196
s_waitcnt lgkmcnt(4)
ds_read_b64_tr_b16 v[232:233], v14 offset:24576
ds_read_b64_tr_b16 v[234:235], v14 offset:26624
Mvva 144,196,204
Zvvv 82,90,74
Mvva 144,200,212
ds_read_b64_tr_b16 v[236:237], v14 offset:28672
ds_read_b64_tr_b16 v[238:239], v14 offset:30720
Mvva 144,204,220
buffer_load_dwordx4 v114, s[12:15], s49 offen offset:1024 lds
Mvva 132,208,192
ds_read_b64_tr_b16 v[240:241], v15 offset:16384
ds_read_b64_tr_b16 v[242:243], v15 offset:18432
Mvva 132,212,200
Zvvv 86,94,74
Mvva 132,216,208
s_waitcnt lgkmcnt(2)
ds_read_b64_tr_b16 v[244:245], v15 offset:20480
ds_read_b64_tr_b16 v[246:247], v15 offset:22528
Mvva 132,220,216
buffer_load_dwordx4 v114, s[12:15], s50 offen offset:2048 lds
Mvva 148,208,196
s_waitcnt vmcnt(15)
ds_read_b64_tr_b16 v[248:249], v15 offset:24576
ds_read_b64_tr_b16 v[250:251], v15 offset:26624
Mvva 148,212,204
ds_read_b64_tr_b16 v[90:91], v106 offset:4096
ds_read_b64_tr_b16 v[92:93], v106 offset:6144
ds_read_b64_tr_b16 v[94:95], v107 offset:4096
Mvva 148,216,212
s_barrier
ds_read_b64_tr_b16 v[252:253], v15 offset:28672
ds_read_b64_tr_b16 v[254:255], v15 offset:30720
Mvva 148,220,220
buffer_load_dwordx4 v114, s[12:15], s51 offen offset:3072 lds
v_add_u32 v114, 262144, v114
Mvva 136,224,192
ds_read_b64_tr_b16 v[192:193], v12 offset:32768
ds_read_b64_tr_b16 v[194:195], v12 offset:34816
Mvva 136,228,200
ds_read_b64_tr_b16 v[96:97], v107 offset:6144
Mvva 136,232,208
ds_read_b64_tr_b16 v[196:197], v12 offset:36864
s_waitcnt lgkmcnt(9)
ds_read_b64_tr_b16 v[198:199], v12 offset:38912
Mvva 136,236,216
buffer_load_dwordx4 a[16:19], v112, s[8:11], s52 offen offset:0 sc1
Mvva 152,224,196
s_waitcnt lgkmcnt(5)
ds_read_b64_tr_b16 v[200:201], v12 offset:40960
ds_read_b64_tr_b16 v[202:203], v12 offset:43008
Mvva 152,228,204
Mvva 152,232,212
ds_read_b64_tr_b16 v[204:205], v12 offset:45056
ds_read_b64_tr_b16 v[206:207], v12 offset:47104
Mvva 152,236,220
buffer_load_dwordx4 a[20:23], v112, s[8:11], s52 offen offset:1024 sc1
s_add_u32 s52, s52, 8192
Mvva 140,240,192
ds_read_b64_tr_b16 v[208:209], v13 offset:32768
ds_read_b64_tr_b16 v[210:211], v13 offset:34816
Mvva 140,244,200
s_waitcnt lgkmcnt(8)
Mvvv 82,90,78
Mvva 140,248,208
ds_read_b64_tr_b16 v[212:213], v13 offset:36864
ds_read_b64_tr_b16 v[214:215], v13 offset:38912
Mvva 140,252,216
buffer_load_dwordx4 a[24:27], v112, s[8:11], s52 offen offset:0 sc1
Mvva 156,240,196
s_waitcnt lgkmcnt(4)
ds_read_b64_tr_b16 v[216:217], v13 offset:40960
ds_read_b64_tr_b16 v[218:219], v13 offset:43008
Mvva 156,244,204
Mvvv 86,94,78
Mvva 156,248,212
s_waitcnt vmcnt(15)
ds_read_b64_tr_b16 v[220:221], v13 offset:45056
ds_read_b64_tr_b16 v[222:223], v13 offset:47104
Mvva 156,252,220
buffer_load_dwordx4 a[28:31], v112, s[8:11], s52 offen offset:1024 sc1
s_add_u32 s52, s52, 8192
Mvva 160,192,224
s_add_u32 m0, s44, 16384
ds_read_b64_tr_b16 v[224:225], v14 offset:32768
ds_read_b64_tr_b16 v[226:227], v14 offset:34816
Mvva 160,196,232
buffer_load_dwordx4 v114, s[12:15], s48 offen offset:0 lds
Mvva 160,200,240
ds_read_b64_tr_b16 v[228:229], v14 offset:36864
ds_read_b64_tr_b16 v[230:231], v14 offset:38912
Mvva 160,204,248
Mvva 176,192,228
s_waitcnt lgkmcnt(4)
ds_read_b64_tr_b16 v[232:233], v14 offset:40960
ds_read_b64_tr_b16 v[234:235], v14 offset:43008
Mvva 176,196,236
buffer_load_dwordx4 v114, s[12:15], s49 offen offset:1024 lds
Mvva 176,200,244
ds_read_b64_tr_b16 v[236:237], v14 offset:45056
ds_read_b64_tr_b16 v[238:239], v14 offset:47104
Mvva 176,204,252
buffer_load_dwordx4 v114, s[12:15], s50 offen offset:2048 lds
Mvva 164,208,224
ds_read_b64_tr_b16 v[240:241], v15 offset:32768
ds_read_b64_tr_b16 v[242:243], v15 offset:34816
Mvva 164,212,232
buffer_load_dwordx4 v114, s[12:15], s51 offen offset:3072 lds
v_add_u32 v114, 262144, v114
Mvva 164,216,240
s_waitcnt lgkmcnt(2)
ds_read_b64_tr_b16 v[244:245], v15 offset:36864
ds_read_b64_tr_b16 v[246:247], v15 offset:38912
Mvva 164,220,248
ds_write_b128 v4, v[82:85] offset:2048
ds_write_b128 v4, v[86:89] offset:2112
Mvva 180,208,228
s_waitcnt vmcnt(16)
ds_read_b64_tr_b16 v[248:249], v15 offset:40960
ds_read_b64_tr_b16 v[250:251], v15 offset:43008
Mvva 180,212,236
buffer_load_dwordx4 a[32:35], v112, s[8:11], s52 offen offset:0 sc1
Mvva 180,216,244
s_barrier
ds_read_b64_tr_b16 v[252:253], v15 offset:45056
ds_read_b64_tr_b16 v[254:255], v15 offset:47104
Mvva 180,220,252
buffer_load_dwordx4 a[36:39], v112, s[8:11], s52 offen offset:1024 sc1
s_add_u32 s52, s52, 8192
Mvva 168,224,224
ds_read_b64_tr_b16 v[192:193], v12 offset:49152
ds_read_b64_tr_b16 v[194:195], v12 offset:51200
Mvva 168,228,232
buffer_load_dwordx4 a[40:43], v112, s[8:11], s52 offen offset:0 sc1
Mvva 168,232,240
ds_read_b64_tr_b16 v[196:197], v12 offset:53248
ds_read_b64_tr_b16 v[198:199], v12 offset:55296
Mvva 168,236,248
Mvva 184,224,228
s_waitcnt lgkmcnt(4)
ds_read_b64_tr_b16 v[200:201], v12 offset:57344
ds_read_b64_tr_b16 v[202:203], v12 offset:59392
Mvva 184,228,236
buffer_load_dwordx4 a[44:47], v112, s[8:11], s52 offen offset:1024 sc1
s_add_u32 s52, s52, 8192
Mvva 184,232,244
ds_read_b64_tr_b16 v[204:205], v12 offset:61440
ds_read_b64_tr_b16 v[206:207], v12 offset:63488
Mvva 184,236,252
buffer_load_dwordx4 a[48:51], v112, s[8:11], s52 offen offset:0 sc1
Mvva 172,240,224
ds_read_b64_tr_b16 v[208:209], v13 offset:49152
ds_read_b64_tr_b16 v[210:211], v13 offset:51200
Mvva 172,244,232
buffer_load_dwordx4 a[52:55], v112, s[8:11], s52 offen offset:1024 sc1
s_add_u32 s52, s52, 8192
Mvva 172,248,240
ds_read_b64_tr_b16 v[212:213], v13 offset:53248
ds_read_b64_tr_b16 v[214:215], v13 offset:55296
Mvva 172,252,248
Zvvv 82,98,74
Mvva 188,240,228
s_waitcnt lgkmcnt(4)
ds_read_b64_tr_b16 v[216:217], v13 offset:57344
ds_read_b64_tr_b16 v[218:219], v13 offset:59392
Mvva 188,244,236
buffer_load_dwordx4 a[56:59], v112, s[8:11], s52 offen offset:0 sc1
Mvva 188,248,244
ds_read_b64_tr_b16 v[220:221], v13 offset:61440
ds_read_b64_tr_b16 v[222:223], v13 offset:63488
Mvva 188,252,252
buffer_load_dwordx4 a[60:63], v112, s[8:11], s52 offen offset:1024 sc1
s_add_u32 s52, s52, 8192
Mvva 128,192,224
s_add_u32 m0, s44, 32768
ds_read_b64_tr_b16 v[224:225], v14 offset:49152
ds_read_b64_tr_b16 v[226:227], v14 offset:51200
Mvva 128,196,232
buffer_load_dwordx4 v114, s[12:15], s48 offen offset:0 lds
Mvva 128,200,240
ds_read_b64_tr_b16 v[228:229], v14 offset:53248
ds_read_b64_tr_b16 v[230:231], v14 offset:55296
Mvva 128,204,248
Zvvv 86,102,74
Mvva 144,192,228
s_waitcnt lgkmcnt(4)
ds_read_b64_tr_b16 v[232:233], v14 offset:57344
ds_read_b64_tr_b16 v[234:235], v14 offset:59392
Mvva 144,196,236
buffer_load_dwordx4 v114, s[12:15], s49 offen offset:1024 lds
Mvva 144,200,244
ds_read_b64_tr_b16 v[236:237], v14 offset:61440
ds_read_b64_tr_b16 v[238:239], v14 offset:63488
Mvva 144,204,252
buffer_load_dwordx4 v114, s[12:15], s50 offen offset:2048 lds
Mvva 132,208,224
ds_read_b64_tr_b16 v[240:241], v15 offset:49152
ds_read_b64_tr_b16 v[242:243], v15 offset:51200
Mvva 132,212,232
buffer_load_dwordx4 v114, s[12:15], s51 offen offset:3072 lds
v_add_u32 v114, 262144, v114
Mvva 132,216,240
s_waitcnt lgkmcnt(2)
ds_read_b64_tr_b16 v[244:245], v15 offset:53248
ds_read_b64_tr_b16 v[246:247], v15 offset:55296
Mvva 132,220,248
ds_read_b64_tr_b16 v[98:99], v108 offset:4096
ds_read_b64_tr_b16 v[100:101], v108 offset:6144
ds_read_b64_tr_b16 v[102:103], v109 offset:4096
Mvva 148,208,228
s_waitcnt vmcnt(20)
ds_read_b64_tr_b16 v[248:249], v15 offset:57344
ds_read_b64_tr_b16 v[250:251], v15 offset:59392
Mvva 148,212,236
buffer_load_dwordx4 a[64:67], v112, s[8:11], s52 offen offset:0 sc1
Mvva 148,216,244
s_barrier
ds_read_b64_tr_b16 v[252:253], v15 offset:61440
ds_read_b64_tr_b16 v[254:255], v15 offset:63488
Mvva 148,220,252
buffer_load_dwordx4 a[68:71], v112, s[8:11], s52 offen offset:1024 sc1
s_add_u32 s52, s52, 8192
Mvva 136,224,224
ds_read_b64_tr_b16 v[192:193], v115 offset:0
ds_read_b64_tr_b16 v[194:195], v115 offset:2048
Mvva 136,228,232
buffer_load_dwordx4 a[72:75], v112, s[8:11], s52 offen offset:0 sc1
Mvva 136,232,240
ds_read_b64_tr_b16 v[196:197], v115 offset:4096
ds_read_b64_tr_b16 v[198:199], v115 offset:6144
Mvva 136,236,248
s_waitcnt lgkmcnt(9)
ds_read_b64_tr_b16 v[104:105], v109 offset:6144
Mvva 152,224,228
s_waitcnt lgkmcnt(5)
ds_read_b64_tr_b16 v[200:201], v115 offset:8192
ds_read_b64_tr_b16 v[202:203], v115 offset:10240
Mvva 152,228,236
buffer_load_dwordx4 a[76:79], v112, s[8:11], s52 offen offset:1024 sc1
s_add_u32 s52, s52, 8192
Mvva 152,232,244
ds_read_b64_tr_b16 v[204:205], v115 offset:12288
ds_read_b64_tr_b16 v[206:207], v115 offset:14336
Mvva 152,236,252
buffer_load_dwordx4 a[80:83], v112, s[8:11], s52 offen offset:0 sc1
Mvva 140,240,224
ds_read_b64_tr_b16 v[208:209], v116 offset:0
ds_read_b64_tr_b16 v[210:211], v116 offset:2048
Mvva 140,244,232
buffer_load_dwordx4 a[84:87], v112, s[8:11], s52 offen offset:1024 sc1
s_add_u32 s52, s52, 8192
Mvva 140,248,240
ds_read_b64_tr_b16 v[212:213], v116 offset:4096
ds_read_b64_tr_b16 v[214:215], v116 offset:6144
Mvva 140,252,248
Mvva 156,240,228
s_waitcnt lgkmcnt(4)
ds_read_b64_tr_b16 v[216:217], v116 offset:8192
ds_read_b64_tr_b16 v[218:219], v116 offset:10240
Mvva 156,244,236
buffer_load_dwordx4 a[88:91], v112, s[8:11], s52 offen offset:0 sc1
Mvva 156,248,244
s_waitcnt vmcnt(23)
ds_read_b64_tr_b16 v[220:221], v116 offset:12288
ds_read_b64_tr_b16 v[222:223], v116 offset:14336
Mvva 156,252,252
buffer_load_dwordx4 a[92:95], v112, s[8:11], s52 offen offset:1024 sc1
s_add_u32 s52, s52, 8192
Mvva 160,192,0
s_add_u32 m0, s44, 49152
ds_read_b64_tr_b16 v[224:225], v117 offset:0
ds_read_b64_tr_b16 v[226:227], v117 offset:2048
Mvva 160,196,8
buffer_load_dwordx4 v114, s[12:15], s48 offen offset:0 lds
Mvva 160,200,16
ds_read_b64_tr_b16 v[228:229], v117 offset:4096
ds_read_b64_tr_b16 v[230:231], v117 offset:6144
Mvva 160,204,24
Mvvv 82,98,78
Mvva 176,192,4
s_waitcnt lgkmcnt(4)
ds_read_b64_tr_b16 v[232:233], v117 offset:8192
ds_read_b64_tr_b16 v[234:235], v117 offset:10240
Mvva 176,196,12
buffer_load_dwordx4 v114, s[12:15], s49 offen offset:1024 lds
Mvva 176,200,20
ds_read_b64_tr_b16 v[236:237], v117 offset:12288
ds_read_b64_tr_b16 v[238:239], v117 offset:14336
Mvva 176,204,28
buffer_load_dwordx4 v114, s[12:15], s50 offen offset:2048 lds
Mvva 164,208,0
ds_read_b64_tr_b16 v[240:241], v118 offset:0
ds_read_b64_tr_b16 v[242:243], v118 offset:2048
Mvva 164,212,8
buffer_load_dwordx4 v114, s[12:15], s51 offen offset:3072 lds
v_add_u32 v114, 262144, v114
Mvva 164,216,16
s_waitcnt lgkmcnt(2)
ds_read_b64_tr_b16 v[244:245], v118 offset:4096
ds_read_b64_tr_b16 v[246:247], v118 offset:6144
Mvva 164,220,24
Mvvv 86,102,78
Mvva 180,208,4
s_waitcnt vmcnt(24)
ds_read_b64_tr_b16 v[248:249], v118 offset:8192
ds_read_b64_tr_b16 v[250:251], v118 offset:10240
Mvva 180,212,12
buffer_load_dwordx4 a[96:99], v112, s[8:11], s52 offen offset:0 sc1
Mvva 180,216,20
s_barrier
ds_read_b64_tr_b16 v[252:253], v118 offset:12288
ds_read_b64_tr_b16 v[254:255], v118 offset:14336
Mvva 180,220,28
buffer_load_dwordx4 a[100:103], v112, s[8:11], s52 offen offset:1024 sc1
s_add_u32 s52, s52, 8192
Mvva 168,224,0
ds_read_b64_tr_b16 v[192:193], v115 offset:16384
ds_read_b64_tr_b16 v[194:195], v115 offset:18432
Mvva 168,228,8
buffer_load_dwordx4 a[104:107], v112, s[8:11], s52 offen offset:0 sc1
Mvva 168,232,16
ds_read_b64_tr_b16 v[196:197], v115 offset:20480
ds_read_b64_tr_b16 v[198:199], v115 offset:22528
Mvva 168,236,24
Mvva 184,224,4
s_waitcnt lgkmcnt(4)
ds_read_b64_tr_b16 v[200:201], v115 offset:24576
ds_read_b64_tr_b16 v[202:203], v115 offset:26624
Mvva 184,228,12
buffer_load_dwordx4 a[108:111], v112, s[8:11], s52 offen offset:1024 sc1
s_add_u32 s52, s52, 8192
Mvva 184,232,20
ds_read_b64_tr_b16 v[204:205], v115 offset:28672
ds_read_b64_tr_b16 v[206:207], v115 offset:30720
Mvva 184,236,28
buffer_load_dwordx4 a[112:115], v112, s[8:11], s52 offen offset:0 sc1
Mvva 172,240,0
ds_read_b64_tr_b16 v[208:209], v116 offset:16384
ds_read_b64_tr_b16 v[210:211], v116 offset:18432
Mvva 172,244,8
buffer_load_dwordx4 a[116:119], v112, s[8:11], s52 offen offset:1024 sc1
s_add_u32 s52, s52, 8192
Mvva 172,248,16
ds_read_b64_tr_b16 v[212:213], v116 offset:20480
ds_read_b64_tr_b16 v[214:215], v116 offset:22528
Mvva 172,252,24
ds_write_b128 v4, v[82:85] offset:2176
ds_write_b128 v4, v[86:89] offset:2240
Mvva 188,240,4
s_waitcnt lgkmcnt(6)
ds_read_b64_tr_b16 v[216:217], v116 offset:24576
ds_read_b64_tr_b16 v[218:219], v116 offset:26624
Mvva 188,244,12
buffer_load_dwordx4 a[120:123], v112, s[8:11], s52 offen offset:0 sc1
Mvva 188,248,20
s_waitcnt vmcnt(23)
ds_read_b64_tr_b16 v[220:221], v116 offset:28672
ds_read_b64_tr_b16 v[222:223], v116 offset:30720
Mvva 188,252,28
buffer_load_dwordx4 a[124:127], v112, s[8:11], s52 offen offset:1024 sc1
s_add_u32 s52, s52, 8192
Mvva 160,192,32
s_add_u32 m0, s44, 65536
ds_read_b64_tr_b16 v[224:225], v117 offset:16384
ds_read_b64_tr_b16 v[226:227], v117 offset:18432
Mvva 160,196,40
buffer_load_dwordx4 v114, s[12:15], s48 offen offset:0 lds
Mvva 160,200,48
ds_read_b64_tr_b16 v[228:229], v117 offset:20480
ds_read_b64_tr_b16 v[230:231], v117 offset:22528
Mvva 160,204,56
Mvva 176,192,36
s_waitcnt lgkmcnt(4)
ds_read_b64_tr_b16 v[232:233], v117 offset:24576
ds_read_b64_tr_b16 v[234:235], v117 offset:26624
Mvva 176,196,44
buffer_load_dwordx4 v114, s[12:15], s49 offen offset:1024 lds
Mvva 176,200,52
ds_read_b64_tr_b16 v[236:237], v117 offset:28672
ds_read_b64_tr_b16 v[238:239], v117 offset:30720
Mvva 176,204,60
buffer_load_dwordx4 v114, s[12:15], s50 offen offset:2048 lds
Mvva 164,208,32
ds_read_b64_tr_b16 v[240:241], v118 offset:16384
ds_read_b64_tr_b16 v[242:243], v118 offset:18432
Mvva 164,212,40
buffer_load_dwordx4 v114, s[12:15], s51 offen offset:3072 lds
v_add_u32 v114, 262144, v114
Mvva 164,216,48
s_waitcnt lgkmcnt(2)
ds_read_b64_tr_b16 v[244:245], v118 offset:20480
ds_read_b64_tr_b16 v[246:247], v118 offset:22528
Mvva 164,220,56
Mvva 180,208,36
s_waitcnt vmcnt(24)
ds_read_b64_tr_b16 v[248:249], v118 offset:24576
ds_read_b64_tr_b16 v[250:251], v118 offset:26624
Mvva 180,212,44
buffer_load_dwordx4 a[128:131], v112, s[8:11], s52 offen offset:0 sc1
Mvva 180,216,52
s_barrier
ds_read_b64_tr_b16 v[252:253], v118 offset:28672
ds_read_b64_tr_b16 v[254:255], v118 offset:30720
Mvva 180,220,60
buffer_load_dwordx4 a[132:135], v112, s[8:11], s52 offen offset:1024 sc1
s_add_u32 s52, s52, 8192
Mvva 168,224,32
ds_read_b64_tr_b16 v[192:193], v115 offset:32768
ds_read_b64_tr_b16 v[194:195], v115 offset:34816
Mvva 168,228,40
buffer_load_dwordx4 a[136:139], v112, s[8:11], s52 offen offset:0 sc1
Mvva 168,232,48
ds_read_b64_tr_b16 v[196:197], v115 offset:36864
ds_read_b64_tr_b16 v[198:199], v115 offset:38912
Mvva 168,236,56
ds_read_b64 v[74:75], v6 offset:0
ds_read_b64 v[76:77], v6 offset:8192
ds_read_b64 v[78:79], v6 offset:16384
Mvva 184,224,36
s_waitcnt lgkmcnt(7)
ds_read_b64_tr_b16 v[200:201], v115 offset:40960
ds_read_b64_tr_b16 v[202:203], v115 offset:43008
Mvva 184,228,44
buffer_load_dwordx4 a[140:143], v112, s[8:11], s52 offen offset:1024 sc1
s_add_u32 s52, s52, 8192
Mvva 184,232,52
ds_read_b64_tr_b16 v[204:205], v115 offset:45056
ds_read_b64_tr_b16 v[206:207], v115 offset:47104
Mvva 184,236,60
buffer_load_dwordx4 a[144:147], v112, s[8:11], s52 offen offset:0 sc1
Mvva 172,240,32
ds_read_b64_tr_b16 v[208:209], v116 offset:32768
ds_read_b64_tr_b16 v[210:211], v116 offset:34816
Mvva 172,244,40
buffer_load_dwordx4 a[148:151], v112, s[8:11], s52 offen offset:1024 sc1
s_add_u32 s52, s52, 8192
Mvva 172,248,48
ds_read_b64_tr_b16 v[212:213], v116 offset:36864
ds_read_b64_tr_b16 v[214:215], v116 offset:38912
Mvva 172,252,56
s_waitcnt lgkmcnt(9)
ds_read_b64 v[80:81], v6 offset:24576
Mvva 188,240,36
s_waitcnt lgkmcnt(5)
ds_read_b64_tr_b16 v[216:217], v116 offset:40960
ds_read_b64_tr_b16 v[218:219], v116 offset:43008
Mvva 188,244,44
buffer_load_dwordx4 a[152:155], v112, s[8:11], s52 offen offset:0 sc1
Mvva 188,248,52
s_waitcnt vmcnt(23)
ds_read_b64_tr_b16 v[220:221], v116 offset:45056
ds_read_b64_tr_b16 v[222:223], v116 offset:47104
Mvva 188,252,60
buffer_load_dwordx4 a[156:159], v112, s[8:11], s52 offen offset:1024 sc1
s_add_u32 s52, s52, 8192
Mvva 160,192,64
s_add_u32 m0, s44, 81920
ds_read_b64_tr_b16 v[224:225], v117 offset:32768
ds_read_b64_tr_b16 v[226:227], v117 offset:34816
Mvva 160,196,72
buffer_load_dwordx4 v114, s[12:15], s48 offen offset:0 lds
Mvva 160,200,80
ds_read_b64_tr_b16 v[228:229], v117 offset:36864
ds_read_b64_tr_b16 v[230:231], v117 offset:38912
Mvva 160,204,88
Mvva 176,192,68
s_waitcnt lgkmcnt(4)
ds_read_b64_tr_b16 v[232:233], v117 offset:40960
ds_read_b64_tr_b16 v[234:235], v117 offset:43008
Mvva 176,196,76
buffer_load_dwordx4 v114, s[12:15], s49 offen offset:1024 lds
Mvva 176,200,84
ds_read_b64_tr_b16 v[236:237], v117 offset:45056
ds_read_b64_tr_b16 v[238:239], v117 offset:47104
Mvva 176,204,92
buffer_load_dwordx4 v114, s[12:15], s50 offen offset:2048 lds
Mvva 164,208,64
ds_read_b64_tr_b16 v[240:241], v118 offset:32768
ds_read_b64_tr_b16 v[242:243], v118 offset:34816
Mvva 164,212,72
buffer_load_dwordx4 v114, s[12:15], s51 offen offset:3072 lds
v_add_u32 v114, 262144, v114
Mvva 164,216,80
s_waitcnt lgkmcnt(2)
ds_read_b64_tr_b16 v[244:245], v118 offset:36864
ds_read_b64_tr_b16 v[246:247], v118 offset:38912
Mvva 164,220,88
Va 74,74,76
Va 78,78,80
Va 75,75,77
Mvva 180,208,68
s_waitcnt vmcnt(24)
ds_read_b64_tr_b16 v[248:249], v118 offset:40960
ds_read_b64_tr_b16 v[250:251], v118 offset:43008
Va 79,79,81
Mvva 180,212,76
buffer_load_dwordx4 a[160:163], v112, s[8:11], s52 offen offset:0 sc1
Mvva 180,216,84
s_barrier
ds_read_b64_tr_b16 v[252:253], v118 offset:45056
ds_read_b64_tr_b16 v[254:255], v118 offset:47104
Va 74,74,78
Mvva 180,220,92
buffer_load_dwordx4 a[164:167], v112, s[8:11], s52 offen offset:1024 sc1
s_add_u32 s52, s52, 8192
Mvva 168,224,64
ds_read_b64_tr_b16 v[192:193], v115 offset:49152
ds_read_b64_tr_b16 v[194:195], v115 offset:51200
v_add_f32_e64 v75, v75, v79
Mvva 168,228,72
buffer_load_dwordx4 a[168:171], v112, s[8:11], s52 offen offset:0 sc1
Mvva 168,232,80
ds_read_b64_tr_b16 v[196:197], v115 offset:53248
ds_read_b64_tr_b16 v[198:199], v115 offset:55296
Mvva 168,236,88
buffer_store_dwordx2 v[74:75], v5, s[20:23], s4 offen sc1
Mvva 184,224,68
s_waitcnt lgkmcnt(4)
ds_read_b64_tr_b16 v[200:201], v115 offset:57344
ds_read_b64_tr_b16 v[202:203], v115 offset:59392
Mvva 184,228,76
buffer_load_dwordx4 a[172:175], v112, s[8:11], s52 offen offset:1024 sc1
s_add_u32 s52, s52, 8192
Mvva 184,232,84
ds_read_b64_tr_b16 v[204:205], v115 offset:61440
ds_read_b64_tr_b16 v[206:207], v115 offset:63488
Mvva 184,236,92
buffer_load_dwordx4 a[176:179], v112, s[8:11], s52 offen offset:0 sc1
Mvva 172,240,64
ds_read_b64_tr_b16 v[208:209], v116 offset:49152
ds_read_b64_tr_b16 v[210:211], v116 offset:51200
Mvva 172,244,72
buffer_load_dwordx4 a[180:183], v112, s[8:11], s52 offen offset:1024 sc1
s_add_u32 s52, s52, 8192
Mvva 172,248,80
ds_read_b64_tr_b16 v[212:213], v116 offset:53248
ds_read_b64_tr_b16 v[214:215], v116 offset:55296
Mvva 172,252,88
Mvva 188,240,68
s_waitcnt lgkmcnt(4)
ds_read_b64_tr_b16 v[216:217], v116 offset:57344
ds_read_b64_tr_b16 v[218:219], v116 offset:59392
Mvva 188,244,76
buffer_load_dwordx4 a[184:187], v112, s[8:11], s52 offen offset:0 sc1
Mvva 188,248,84
s_waitcnt vmcnt(24)
ds_read_b64_tr_b16 v[220:221], v116 offset:61440
ds_read_b64_tr_b16 v[222:223], v116 offset:63488
Mvva 188,252,92
buffer_load_dwordx4 a[188:191], v112, s[8:11], s52 offen offset:1024 sc1
s_add_u32 s52, s52, 8192
Mvva 160,192,96
s_add_u32 m0, s44, 98304
ds_read_b64_tr_b16 v[224:225], v117 offset:49152
ds_read_b64_tr_b16 v[226:227], v117 offset:51200
Mvva 160,196,104
buffer_load_dwordx4 v114, s[12:15], s48 offen offset:0 lds
Mvva 160,200,112
ds_read_b64_tr_b16 v[228:229], v117 offset:53248
ds_read_b64_tr_b16 v[230:231], v117 offset:55296
Mvva 160,204,120
Mvva 176,192,100
s_waitcnt lgkmcnt(4)
ds_read_b64_tr_b16 v[232:233], v117 offset:57344
ds_read_b64_tr_b16 v[234:235], v117 offset:59392
Mvva 176,196,108
buffer_load_dwordx4 v114, s[12:15], s49 offen offset:1024 lds
Mvva 176,200,116
ds_read_b64_tr_b16 v[236:237], v117 offset:61440
ds_read_b64_tr_b16 v[238:239], v117 offset:63488
Mvva 176,204,124
buffer_load_dwordx4 v114, s[12:15], s50 offen offset:2048 lds
Mvva 164,208,96
ds_read_b64_tr_b16 v[240:241], v118 offset:49152
ds_read_b64_tr_b16 v[242:243], v118 offset:51200
Mvva 164,212,104
buffer_load_dwordx4 v114, s[12:15], s51 offen offset:3072 lds
v_add_u32 v114, 262144, v114
Mvva 164,216,112
s_waitcnt lgkmcnt(2)
ds_read_b64_tr_b16 v[244:245], v118 offset:53248
ds_read_b64_tr_b16 v[246:247], v118 offset:55296
Mvva 164,220,120
Mvva 180,208,100
s_waitcnt vmcnt(25)
ds_read_b64_tr_b16 v[248:249], v118 offset:57344
ds_read_b64_tr_b16 v[250:251], v118 offset:59392
Mvva 180,212,108
buffer_load_dwordx4 a[192:195], v112, s[8:11], s52 offen offset:0 sc1
Mvva 180,216,116
s_barrier
ds_read_b64_tr_b16 v[252:253], v118 offset:61440
ds_read_b64_tr_b16 v[254:255], v118 offset:63488
Mvva 180,220,124
buffer_load_dwordx4 a[196:199], v112, s[8:11], s52 offen offset:1024 sc1
s_add_u32 s52, s52, 8192
Mvva 168,224,96
ds_read_b64_tr_b16 v[192:193], v12 offset:0
ds_read_b64_tr_b16 v[194:195], v12 offset:2048
Mvva 168,228,104
buffer_load_dwordx4 a[200:203], v112, s[8:11], s52 offen offset:0 sc1
Mvva 168,232,112
ds_read_b64_tr_b16 v[196:197], v12 offset:4096
ds_read_b64_tr_b16 v[198:199], v12 offset:6144
Mvva 168,236,120
Mvva 184,224,100
s_waitcnt lgkmcnt(4)
ds_read_b64_tr_b16 v[200:201], v12 offset:8192
ds_read_b64_tr_b16 v[202:203], v12 offset:10240
Mvva 184,228,108
buffer_load_dwordx4 a[204:207], v112, s[8:11], s52 offen offset:1024 sc1
s_add_u32 s52, s52, 8192
Mvva 184,232,116
ds_read_b64_tr_b16 v[204:205], v12 offset:12288
ds_read_b64_tr_b16 v[206:207], v12 offset:14336
Mvva 184,236,124
buffer_load_dwordx4 a[208:211], v112, s[8:11], s52 offen offset:0 sc1
Mvva 172,240,96
ds_read_b64_tr_b16 v[208:209], v13 offset:0
ds_read_b64_tr_b16 v[210:211], v13 offset:2048
Mvva 172,244,104
buffer_load_dwordx4 a[212:215], v112, s[8:11], s52 offen offset:1024 sc1
s_add_u32 s52, s52, 8192
Mvva 172,248,112
ds_read_b64_tr_b16 v[212:213], v13 offset:4096
ds_read_b64_tr_b16 v[214:215], v13 offset:6144
Mvva 172,252,120
Mvva 188,240,100
s_waitcnt lgkmcnt(4)
ds_read_b64_tr_b16 v[216:217], v13 offset:8192
ds_read_b64_tr_b16 v[218:219], v13 offset:10240
Mvva 188,244,108
buffer_load_dwordx4 a[216:219], v112, s[8:11], s52 offen offset:0 sc1
Mvva 188,248,116
s_waitcnt vmcnt(24)
ds_read_b64_tr_b16 v[220:221], v13 offset:12288
ds_read_b64_tr_b16 v[222:223], v13 offset:14336
Mvva 188,252,124
buffer_load_dwordx4 a[220:223], v112, s[8:11], s52 offen offset:1024 sc1
s_add_u32 s52, s52, 8192
Mvva 160,192,128
s_add_u32 m0, s44, 114688
ds_read_b64_tr_b16 v[224:225], v14 offset:0
ds_read_b64_tr_b16 v[226:227], v14 offset:2048
Mvva 160,196,136
buffer_load_dwordx4 v114, s[12:15], s48 offen offset:0 lds
Mvva 160,200,144
ds_read_b64_tr_b16 v[228:229], v14 offset:4096
ds_read_b64_tr_b16 v[230:231], v14 offset:6144
Mvva 160,204,152
Mvva 176,192,132
s_waitcnt lgkmcnt(4)
ds_read_b64_tr_b16 v[232:233], v14 offset:8192
ds_read_b64_tr_b16 v[234:235], v14 offset:10240
Mvva 176,196,140
buffer_load_dwordx4 v114, s[12:15], s49 offen offset:1024 lds
Mvva 176,200,148
ds_read_b64_tr_b16 v[236:237], v14 offset:12288
ds_read_b64_tr_b16 v[238:239], v14 offset:14336
Mvva 176,204,156
buffer_load_dwordx4 v114, s[12:15], s50 offen offset:2048 lds
Mvva 164,208,128
ds_read_b64_tr_b16 v[240:241], v15 offset:0
ds_read_b64_tr_b16 v[242:243], v15 offset:2048
Mvva 164,212,136
buffer_load_dwordx4 v114, s[12:15], s51 offen offset:3072 lds
s_xor_b32 s95, s95, 128
v_add_u32 v114, s95, v113
Mvva 164,216,144
s_waitcnt lgkmcnt(2)
ds_read_b64_tr_b16 v[244:245], v15 offset:4096
ds_read_b64_tr_b16 v[246:247], v15 offset:6144
Mvva 164,220,152
Mvva 180,208,132
s_waitcnt vmcnt(25)
ds_read_b64_tr_b16 v[248:249], v15 offset:8192
ds_read_b64_tr_b16 v[250:251], v15 offset:10240
Mvva 180,212,140
buffer_load_dwordx4 a[224:227], v112, s[8:11], s52 offen offset:0 sc1
Mvva 180,216,148
s_barrier
ds_read_b64_tr_b16 v[252:253], v15 offset:12288
ds_read_b64_tr_b16 v[254:255], v15 offset:14336
Mvva 180,220,156
buffer_load_dwordx4 a[228:231], v112, s[8:11], s52 offen offset:1024 sc1
s_add_u32 s52, s52, 8192
Mvva 168,224,128
ds_read_b64_tr_b16 v[192:193], v12 offset:16384
ds_read_b64_tr_b16 v[194:195], v12 offset:18432
Mvva 168,228,136
buffer_load_dwordx4 a[232:235], v112, s[8:11], s52 offen offset:0 sc1
Mvva 168,232,144
ds_read_b64_tr_b16 v[196:197], v12 offset:20480
ds_read_b64_tr_b16 v[198:199], v12 offset:22528
Mvva 168,236,152
s_waitcnt vmcnt(24)
s_mov_b64 exec, 1
buffer_store_dword v7, v126, s[20:23], s6 offen sc1
s_mov_b64 exec, -1
Mvva 184,224,132
s_waitcnt lgkmcnt(4)
ds_read_b64_tr_b16 v[200:201], v12 offset:24576
ds_read_b64_tr_b16 v[202:203], v12 offset:26624
Mvva 184,228,140
buffer_load_dwordx4 a[236:239], v112, s[8:11], s52 offen offset:1024 sc1
s_add_u32 s52, s52, 8192
Mvva 184,232,148
ds_read_b64_tr_b16 v[204:205], v12 offset:28672
ds_read_b64_tr_b16 v[206:207], v12 offset:30720
Mvva 184,236,156
buffer_load_dwordx4 a[240:243], v112, s[8:11], s52 offen offset:0 sc1
Mvva 172,240,128
ds_read_b64_tr_b16 v[208:209], v13 offset:16384
ds_read_b64_tr_b16 v[210:211], v13 offset:18432
Mvva 172,244,136
buffer_load_dwordx4 a[244:247], v112, s[8:11], s52 offen offset:1024 sc1
s_add_u32 s52, s52, 8192
Mvva 172,248,144
ds_read_b64_tr_b16 v[212:213], v13 offset:20480
ds_read_b64_tr_b16 v[214:215], v13 offset:22528
Mvva 172,252,152
v_lshlrev_b32 v66, 16, v30
v_and_b32 v67, 0xffff0000, v30
v_lshlrev_b32_e64 v68, 16, v31
Mvva 188,240,132
s_waitcnt lgkmcnt(4)
ds_read_b64_tr_b16 v[216:217], v13 offset:24576
ds_read_b64_tr_b16 v[218:219], v13 offset:26624
v_and_b32 v69, 0xffff0000, v31
Mvva 188,244,140
buffer_load_dwordx4 a[248:251], v112, s[8:11], s52 offen offset:0 sc1
Mvva 188,248,148
s_waitcnt vmcnt(24)
ds_read_b64_tr_b16 v[220:221], v13 offset:28672
ds_read_b64_tr_b16 v[222:223], v13 offset:30720
v_lshlrev_b32_e64 v70, 16, v32
Mvva 188,252,156
buffer_load_dwordx4 a[252:255], v112, s[8:11], s52 offen offset:1024 sc1
s_add_u32 s52, s52, 8192
Mvva 160,192,160
s_add_u32 m0, s44, 0
ds_read_b64_tr_b16 v[224:225], v14 offset:16384
ds_read_b64_tr_b16 v[226:227], v14 offset:18432
Mvva 160,196,168
buffer_load_dwordx4 v114, s[12:15], s48 offen offset:0 lds
Mvva 160,200,176
ds_read_b64_tr_b16 v[228:229], v14 offset:20480
ds_read_b64_tr_b16 v[230:231], v14 offset:22528
Mvva 160,204,184
v_and_b32 v71, 0xffff0000, v32
v_lshlrev_b32 v72, 16, v33
Mvva 176,192,164
s_waitcnt lgkmcnt(4)
ds_read_b64_tr_b16 v[232:233], v14 offset:24576
ds_read_b64_tr_b16 v[234:235], v14 offset:26624
Mvva 176,196,172
buffer_load_dwordx4 v114, s[12:15], s49 offen offset:1024 lds
Mvva 176,200,180
ds_read_b64_tr_b16 v[236:237], v14 offset:28672
ds_read_b64_tr_b16 v[238:239], v14 offset:30720
Mvva 176,204,188
buffer_load_dwordx4 v114, s[12:15], s50 offen offset:2048 lds
Mvva 164,208,160
ds_read_b64_tr_b16 v[240:241], v15 offset:16384
ds_read_b64_tr_b16 v[242:243], v15 offset:18432
Mvva 164,212,168
buffer_load_dwordx4 v114, s[12:15], s51 offen offset:3072 lds
v_add_u32 v114, 262144, v114
Mvva 164,216,176
s_waitcnt lgkmcnt(2)
ds_read_b64_tr_b16 v[244:245], v15 offset:20480
ds_read_b64_tr_b16 v[246:247], v15 offset:22528
Mvva 164,220,184
v_and_b32 v73, 0xffff0000, v33
v_sub_f32_e64 v66, v66, v40
Mvva 180,208,164
s_waitcnt vmcnt(25)
s_add_u32 m0, s44, 16384
ds_read_b64_tr_b16 v[248:249], v15 offset:24576
ds_read_b64_tr_b16 v[250:251], v15 offset:26624
Mvva 180,212,172
buffer_load_dwordx4 v114, s[12:15], s48 offen offset:0 lds
Mvva 180,216,180
s_barrier
ds_read_b64_tr_b16 v[252:253], v15 offset:28672
ds_read_b64_tr_b16 v[254:255], v15 offset:30720
Mvva 180,220,188
buffer_load_dwordx4 v114, s[12:15], s49 offen offset:1024 lds
Mvva 168,224,160
ds_read_b64_tr_b16 v[192:193], v12 offset:32768
ds_read_b64_tr_b16 v[194:195], v12 offset:34816
Mvva 168,228,168
buffer_load_dwordx4 v114, s[12:15], s50 offen offset:2048 lds
Mvva 168,232,176
ds_read_b64_tr_b16 v[196:197], v12 offset:36864
ds_read_b64_tr_b16 v[198:199], v12 offset:38912
Mvva 168,236,184
Vs 67,67,40
Vs 68,68,40
Mvva 184,224,164
s_waitcnt lgkmcnt(4)
ds_read_b64_tr_b16 v[200:201], v12 offset:40960
ds_read_b64_tr_b16 v[202:203], v12 offset:43008
Mvva 184,228,172
buffer_load_dwordx4 v114, s[12:15], s51 offen offset:3072 lds
v_add_u32 v114, 262144, v114
Mvva 184,232,180
s_add_u32 m0, s44, 32768
ds_read_b64_tr_b16 v[204:205], v12 offset:45056
ds_read_b64_tr_b16 v[206:207], v12 offset:47104
Mvva 184,236,188
buffer_load_dwordx4 v114, s[12:15], s48 offen offset:0 lds
Mvva 172,240,160
ds_read_b64_tr_b16 v[208:209], v13 offset:32768
ds_read_b64_tr_b16 v[210:211], v13 offset:34816
Mvva 172,244,168
buffer_load_dwordx4 v114, s[12:15], s49 offen offset:1024 lds
Mvva 172,248,176
ds_read_b64_tr_b16 v[212:213], v13 offset:36864
ds_read_b64_tr_b16 v[214:215], v13 offset:38912
Mvva 172,252,184
Vs 69,69,40
v_sub_f32_e64 v70, v70, v40
Mvva 188,240,164
s_waitcnt lgkmcnt(4)
ds_read_b64_tr_b16 v[216:217], v13 offset:40960
ds_read_b64_tr_b16 v[218:219], v13 offset:43008
Mvva 188,244,172
buffer_load_dwordx4 v114, s[12:15], s50 offen offset:2048 lds
Mvva 188,248,180
s_waitcnt vmcnt(24)
ds_read_b64_tr_b16 v[220:221], v13 offset:45056
ds_read_b64_tr_b16 v[222:223], v13 offset:47104
Mvva 188,252,188
buffer_load_dwordx4 v114, s[12:15], s51 offen offset:3072 lds
v_add_u32 v114, 262144, v114
Mvva 160,192,192
ds_read_b64_tr_b16 v[224:225], v14 offset:32768
ds_read_b64_tr_b16 v[226:227], v14 offset:34816
Mvva 160,196,200
Vs 71,71,40
Vs 72,72,40
Mvva 160,200,208
s_add_u32 m0, s44, 49152
ds_read_b64_tr_b16 v[228:229], v14 offset:36864
ds_read_b64_tr_b16 v[230:231], v14 offset:38912
Mvva 160,204,216
buffer_load_dwordx4 v114, s[12:15], s48 offen offset:0 lds
Mvva 176,192,196
s_waitcnt lgkmcnt(4)
ds_read_b64_tr_b16 v[232:233], v14 offset:40960
ds_read_b64_tr_b16 v[234:235], v14 offset:43008
Mvva 176,196,204
Vs 73,73,40
Vc 2,66,67
Mvva 176,200,212
ds_read_b64_tr_b16 v[236:237], v14 offset:45056
ds_read_b64_tr_b16 v[238:239], v14 offset:47104
Mvva 176,204,220
buffer_load_dwordx4 v114, s[12:15], s49 offen offset:1024 lds
Mvva 164,208,192
ds_read_b64_tr_b16 v[240:241], v15 offset:32768
ds_read_b64_tr_b16 v[242:243], v15 offset:34816
Mvva 164,212,200
v_lshlrev_b32_e64 v66, 16, v2
v_and_b32 v67, 0xffff0000, v2
Mvva 164,216,208
s_waitcnt lgkmcnt(2)
ds_read_b64_tr_b16 v[244:245], v15 offset:36864
ds_read_b64_tr_b16 v[246:247], v15 offset:38912
Mvva 164,220,216
buffer_load_dwordx4 v114, s[12:15], s50 offen offset:2048 lds
Mvva 180,208,196
s_waitcnt vmcnt(24)
ds_read_b64_tr_b16 v[248:249], v15 offset:40960
ds_read_b64_tr_b16 v[250:251], v15 offset:43008
Mvva 180,212,204
Vc 3,68,69
v_lshlrev_b32_e64 v68, 16, v3
Mvva 180,216,212
s_barrier
ds_read_b64_tr_b16 v[252:253], v15 offset:45056
ds_read_b64_tr_b16 v[254:255], v15 offset:47104
Mvva 180,220,220
buffer_load_dwordx4 v114, s[12:15], s51 offen offset:3072 lds
v_add_u32 v114, 262144, v114
Mvva 168,224,192
ds_read_b64_tr_b16 v[192:193], v12 offset:49152
ds_read_b64_tr_b16 v[194:195], v12 offset:51200
Mvva 168,228,200
v_and_b32 v69, 0xffff0000, v3
Vc 4,70,71
Mvva 168,232,208
s_add_u32 m0, s44, 65536
ds_read_b64_tr_b16 v[196:197], v12 offset:53248
ds_read_b64_tr_b16 v[198:199], v12 offset:55296
Mvva 168,236,216
buffer_load_dwordx4 v114, s[12:15], s48 offen offset:0 lds
Mvva 184,224,196
s_waitcnt lgkmcnt(4)
ds_read_b64_tr_b16 v[200:201], v12 offset:57344
ds_read_b64_tr_b16 v[202:203], v12 offset:59392
Mvva 184,228,204
v_lshlrev_b32_e64 v70, 16, v4
v_and_b32 v71, 0xffff0000, v4
Mvva 184,232,212
ds_read_b64_tr_b16 v[204:205], v12 offset:61440
ds_read_b64_tr_b16 v[206:207], v12 offset:63488
Mvva 184,236,220
buffer_load_dwordx4 v114, s[12:15], s49 offen offset:1024 lds
Mvva 172,240,192
ds_read_b64_tr_b16 v[208:209], v13 offset:49152
ds_read_b64_tr_b16 v[210:211], v13 offset:51200
Mvva 172,244,200
Vc 5,72,73
v_lshlrev_b32_e64 v72, 16, v5
Mvva 172,248,208
ds_read_b64_tr_b16 v[212:213], v13 offset:53248
ds_read_b64_tr_b16 v[214:215], v13 offset:55296
Mvva 172,252,216
buffer_load_dwordx4 v114, s[12:15], s50 offen offset:2048 lds
Mvva 188,240,196
s_waitcnt lgkmcnt(4)
ds_read_b64_tr_b16 v[216:217], v13 offset:57344
ds_read_b64_tr_b16 v[218:219], v13 offset:59392
Mvva 188,244,204
v_and_b32 v73, 0xffff0000, v5
Vm 66,66,41
Mvva 188,248,212
s_waitcnt vmcnt(19)
ds_read_b64_tr_b16 v[220:221], v13 offset:61440
ds_read_b64_tr_b16 v[222:223], v13 offset:63488
Mvva 188,252,220
buffer_load_dwordx4 v114, s[12:15], s51 offen offset:3072 lds
v_add_u32 v114, 262144, v114
Mvva 160,192,224
ds_read_b64_tr_b16 v[224:225], v14 offset:49152
ds_read_b64_tr_b16 v[226:227], v14 offset:51200
Mvva 160,196,232
Vm 67,67,41
v_mul_f32_e64 v68, v68, v41
Mvva 160,200,240
ds_read_b64_tr_b16 v[228:229], v14 offset:53248
ds_read_b64_tr_b16 v[230:231], v14 offset:55296
Mvva 160,204,248
Vm 69,69,41
Vm 70,70,41
Mvva 176,192,228
s_waitcnt lgkmcnt(4)
s_add_u32 m0, s44, 81920
ds_read_b64_tr_b16 v[232:233], v14 offset:57344
ds_read_b64_tr_b16 v[234:235], v14 offset:59392
Mvva 176,196,236
buffer_load_dwordx4 v114, s[12:15], s48 offen offset:0 lds
Mvva 176,200,244
ds_read_b64_tr_b16 v[236:237], v14 offset:61440
ds_read_b64_tr_b16 v[238:239], v14 offset:63488
Mvva 176,204,252
Vm 71,71,41
v_mul_f32_e64 v72, v72, v41
Mvva 164,208,224
ds_read_b64_tr_b16 v[240:241], v15 offset:49152
ds_read_b64_tr_b16 v[242:243], v15 offset:51200
Mvva 164,212,232
v_mul_f32_e64 v73, v73, v41
Vc 2,66,67
Mvva 164,216,240
s_waitcnt lgkmcnt(2)
ds_read_b64_tr_b16 v[244:245], v15 offset:53248
ds_read_b64_tr_b16 v[246:247], v15 offset:55296
Mvva 164,220,248
v_lshlrev_b32 v66, 16, v2
v_and_b32 v67, 0xffff0000, v2
Mvva 180,208,228
s_waitcnt vmcnt(17)
ds_read_b64_tr_b16 v[248:249], v15 offset:57344
ds_read_b64_tr_b16 v[250:251], v15 offset:59392
Mvva 180,212,236
buffer_load_dwordx4 v114, s[12:15], s49 offen offset:1024 lds
Mvva 180,216,244
s_barrier
ds_read_b64_tr_b16 v[252:253], v15 offset:61440
ds_read_b64_tr_b16 v[254:255], v15 offset:63488
Mvva 180,220,252
Vc 3,68,69
v_lshlrev_b32_e64 v68, 16, v3
Mvva 168,224,224
ds_read_b64_tr_b16 v[192:193], v115 offset:0
ds_read_b64_tr_b16 v[194:195], v115 offset:2048
Mvva 168,228,232
v_and_b32 v69, 0xffff0000, v3
Vc 4,70,71
Mvva 168,232,240
ds_read_b64_tr_b16 v[196:197], v115 offset:4096
ds_read_b64_tr_b16 v[198:199], v115 offset:6144
Mvva 168,236,248
v_lshlrev_b32_e64 v70, 16, v4
v_and_b32 v71, 0xffff0000, v4
Mvva 184,224,228
s_waitcnt lgkmcnt(4)
ds_read_b64_tr_b16 v[200:201], v115 offset:8192
ds_read_b64_tr_b16 v[202:203], v115 offset:10240
Mvva 184,228,236
buffer_load_dwordx4 v114, s[12:15], s50 offen offset:2048 lds
Mvva 184,232,244
ds_read_b64_tr_b16 v[204:205], v115 offset:12288
ds_read_b64_tr_b16 v[206:207], v115 offset:14336
Mvva 184,236,252
Vc 5,72,73
v_lshlrev_b32 v72, 16, v5
Mvva 172,240,224
ds_read_b64_tr_b16 v[208:209], v116 offset:0
ds_read_b64_tr_b16 v[210:211], v116 offset:2048
Mvva 172,244,232
v_and_b32 v73, 0xffff0000, v5
v_mul_f32 v2, 0xbfb8aa3b, v66
Mvva 172,248,240
ds_read_b64_tr_b16 v[212:213], v116 offset:4096
ds_read_b64_tr_b16 v[214:215], v116 offset:6144
Mvva 172,252,248
v_mul_f32 v3, 0xbfb8aa3b, v67
v_mul_f32 v4, 0xbfb8aa3b, v68
Mvva 188,240,228
s_waitcnt lgkmcnt(4)
ds_read_b64_tr_b16 v[216:217], v116 offset:8192
ds_read_b64_tr_b16 v[218:219], v116 offset:10240
Mvva 188,244,236
buffer_load_dwordx4 v114, s[12:15], s51 offen offset:3072 lds
v_add_u32 v114, 262144, v114
Mvva 188,248,244
ds_read_b64_tr_b16 v[220:221], v116 offset:12288
ds_read_b64_tr_b16 v[222:223], v116 offset:14336
Mvva 188,252,252
v_mul_f32 v5, 0xbfb8aa3b, v69
v_mul_f32 v6, 0xbfb8aa3b, v70
Mvva 128,192,0
ds_read_b64_tr_b16 v[224:225], v117 offset:0
ds_read_b64_tr_b16 v[226:227], v117 offset:2048
Mvva 128,196,8
v_mul_f32 v7, 0xbfb8aa3b, v71
v_mul_f32 v8, 0xbfb8aa3b, v72
Mvva 128,200,16
ds_read_b64_tr_b16 v[228:229], v117 offset:4096
ds_read_b64_tr_b16 v[230:231], v117 offset:6144
Mvva 128,204,24
v_mul_f32 v9, 0xbfb8aa3b, v73
Mvva 144,192,4
s_waitcnt lgkmcnt(4)
s_add_u32 m0, s44, 98304
ds_read_b64_tr_b16 v[232:233], v117 offset:8192
ds_read_b64_tr_b16 v[234:235], v117 offset:10240
Mvva 144,196,12
buffer_load_dwordx4 v114, s[12:15], s48 offen offset:0 lds
Mvva 144,200,20
ds_read_b64_tr_b16 v[236:237], v117 offset:12288
ds_read_b64_tr_b16 v[238:239], v117 offset:14336
Mvva 144,204,28
v_add_u32 v10, 4096, v112
Mvva 132,208,0
ds_read_b64_tr_b16 v[240:241], v118 offset:0
ds_read_b64_tr_b16 v[242:243], v118 offset:2048
Mvva 132,212,8
buffer_store_dwordx4 v[160:163], v112, s[16:19], s26 offen offset:0 sc1
Mvva 132,216,16
s_waitcnt lgkmcnt(2)
ds_read_b64_tr_b16 v[244:245], v118 offset:4096
ds_read_b64_tr_b16 v[246:247], v118 offset:6144
Mvva 132,220,24
buffer_store_dwordx4 v[164:167], v112, s[16:19], s26 offen offset:1024 sc1
Mvva 148,208,4
s_waitcnt vmcnt(19)
ds_read_b64_tr_b16 v[248:249], v118 offset:8192
ds_read_b64_tr_b16 v[250:251], v118 offset:10240
Mvva 148,212,12
buffer_load_dwordx4 v114, s[12:15], s49 offen offset:1024 lds
Mvva 148,216,20
s_barrier
ds_read_b64_tr_b16 v[252:253], v118 offset:12288
ds_read_b64_tr_b16 v[254:255], v118 offset:14336
Mvva 148,220,28
buffer_store_dwordx4 v[168:171], v112, s[16:19], s26 offen offset:2048 sc1
Mvva 136,224,0
ds_read_b64_tr_b16 v[192:193], v115 offset:16384
ds_read_b64_tr_b16 v[194:195], v115 offset:18432
Mvva 136,228,8
buffer_store_dwordx4 v[172:175], v112, s[16:19], s26 offen offset:3072 sc1
Mvva 136,232,16
ds_read_b64_tr_b16 v[196:197], v115 offset:20480
ds_read_b64_tr_b16 v[198:199], v115 offset:22528
Mvva 136,236,24
buffer_store_dwordx4 v[176:179], v10, s[16:19], s26 offen offset:0 sc1
Mvva 152,224,4
s_waitcnt lgkmcnt(4)
ds_read_b64_tr_b16 v[200:201], v115 offset:24576
ds_read_b64_tr_b16 v[202:203], v115 offset:26624
Mvva 152,228,12
buffer_load_dwordx4 v114, s[12:15], s50 offen offset:2048 lds
Mvva 152,232,20
ds_read_b64_tr_b16 v[204:205], v115 offset:28672
ds_read_b64_tr_b16 v[206:207], v115 offset:30720
Mvva 152,236,28
buffer_store_dwordx4 v[180:183], v10, s[16:19], s26 offen offset:1024 sc1
Mvva 140,240,0
ds_read_b64_tr_b16 v[208:209], v116 offset:16384
ds_read_b64_tr_b16 v[210:211], v116 offset:18432
Mvva 140,244,8
buffer_store_dwordx4 v[184:187], v10, s[16:19], s26 offen offset:2048 sc1
Mvva 140,248,16
ds_read_b64_tr_b16 v[212:213], v116 offset:20480
ds_read_b64_tr_b16 v[214:215], v116 offset:22528
Mvva 140,252,24
buffer_store_dwordx4 v[188:191], v10, s[16:19], s26 offen offset:3072 sc1
Mvva 156,240,4
s_waitcnt lgkmcnt(4)
ds_read_b64_tr_b16 v[216:217], v116 offset:24576
ds_read_b64_tr_b16 v[218:219], v116 offset:26624
Mvva 156,244,12
buffer_load_dwordx4 v114, s[12:15], s51 offen offset:3072 lds
v_add_u32 v114, 262144, v114
Mvva 156,248,20
ds_read_b64_tr_b16 v[220:221], v116 offset:28672
ds_read_b64_tr_b16 v[222:223], v116 offset:30720
Mvva 156,252,28
v_mov_b32 v16, 1
Mvva 128,192,32
ds_read_b64_tr_b16 v[224:225], v117 offset:16384
ds_read_b64_tr_b16 v[226:227], v117 offset:18432
Mvva 128,196,40
VE 2,2
Mvva 128,200,48
ds_read_b64_tr_b16 v[228:229], v117 offset:20480
ds_read_b64_tr_b16 v[230:231], v117 offset:22528
Mvva 128,204,56
VE 3,3
Mvva 144,192,36
s_waitcnt lgkmcnt(4)
s_add_u32 m0, s44, 114688
ds_read_b64_tr_b16 v[232:233], v117 offset:24576
ds_read_b64_tr_b16 v[234:235], v117 offset:26624
Mvva 144,196,44
buffer_load_dwordx4 v114, s[12:15], s48 offen offset:0 lds
Mvva 144,200,52
ds_read_b64_tr_b16 v[236:237], v117 offset:28672
ds_read_b64_tr_b16 v[238:239], v117 offset:30720
Mvva 144,204,60
Ve 4,4
Mvva 132,208,32
ds_read_b64_tr_b16 v[240:241], v118 offset:16384
ds_read_b64_tr_b16 v[242:243], v118 offset:18432
Mvva 132,212,40
VE 5,5
Mvva 132,216,48
s_waitcnt lgkmcnt(2)
ds_read_b64_tr_b16 v[244:245], v118 offset:20480
ds_read_b64_tr_b16 v[246:247], v118 offset:22528
Mvva 132,220,56
Ve 6,6
Mvva 148,208,36
s_waitcnt vmcnt(25)
ds_read_b64_tr_b16 v[248:249], v118 offset:24576
ds_read_b64_tr_b16 v[250:251], v118 offset:26624
Mvva 148,212,44
buffer_load_dwordx4 v114, s[12:15], s49 offen offset:1024 lds
Mvva 148,216,52
s_barrier
ds_read_b64_tr_b16 v[252:253], v118 offset:28672
ds_read_b64_tr_b16 v[254:255], v118 offset:30720
Mvva 148,220,60
VE 7,7
Mvva 136,224,32
ds_read_b64_tr_b16 v[192:193], v115 offset:32768
ds_read_b64_tr_b16 v[194:195], v115 offset:34816
Mvva 136,228,40
s_cmp_lg_u32 s53, 0
s_cbranch_scc1 L_yA
L_yAr:
Mvva 136,232,48
ds_read_b64_tr_b16 v[196:197], v115 offset:36864
ds_read_b64_tr_b16 v[198:199], v115 offset:38912
Mvva 136,236,56
VE 8,8
Mvva 152,224,36
s_waitcnt lgkmcnt(4)
ds_read_b64_tr_b16 v[200:201], v115 offset:40960
ds_read_b64_tr_b16 v[202:203], v115 offset:43008
Mvva 152,228,44
buffer_load_dwordx4 v114, s[12:15], s50 offen offset:2048 lds
Mvva 152,232,52
ds_read_b64_tr_b16 v[204:205], v115 offset:45056
ds_read_b64_tr_b16 v[206:207], v115 offset:47104
Mvva 152,236,60
Ve 9,9
Mvva 140,240,32
ds_read_b64_tr_b16 v[208:209], v116 offset:32768
ds_read_b64_tr_b16 v[210:211], v116 offset:34816
Mvva 140,244,40
v_add_f32 v2, 1.0, v2
v_add_f32 v3, 1.0, v3
Mvva 140,248,48
ds_read_b64_tr_b16 v[212:213], v116 offset:36864
ds_read_b64_tr_b16 v[214:215], v116 offset:38912
Mvva 140,252,56
v_add_f32 v4, 1.0, v4
v_add_f32 v5, 1.0, v5
Mvva 156,240,36
s_waitcnt lgkmcnt(4)
ds_read_b64_tr_b16 v[216:217], v116 offset:40960
ds_read_b64_tr_b16 v[218:219], v116 offset:43008
Mvva 156,244,44
buffer_load_dwordx4 v114, s[12:15], s51 offen offset:3072 lds
v_add_u32 v114, 262144, v114
Mvva 156,248,52
ds_read_b64_tr_b16 v[220:221], v116 offset:45056
ds_read_b64_tr_b16 v[222:223], v116 offset:47104
Mvva 156,252,60
v_add_f32 v6, 1.0, v6
v_add_f32_e64 v7, 1.0, v7
Mvva 128,192,64
ds_read_b64_tr_b16 v[224:225], v117 offset:32768
ds_read_b64_tr_b16 v[226:227], v117 offset:34816
Mvva 128,196,72
v_add_f32 v8, 1.0, v8
v_add_f32 v9, 1.0, v9
Mvva 128,200,80
ds_read_b64_tr_b16 v[228:229], v117 offset:36864
ds_read_b64_tr_b16 v[230:231], v117 offset:38912
Mvva 128,204,88
v_rcp_f32_e64 v2, v2
Mvva 144,192,68
s_waitcnt lgkmcnt(4)
ds_read_b64_tr_b16 v[232:233], v117 offset:40960
ds_read_b64_tr_b16 v[234:235], v117 offset:43008
Mvva 144,196,76
v_rcp_f32 v3, v3
Mvva 144,200,84
ds_read_b64_tr_b16 v[236:237], v117 offset:45056
ds_read_b64_tr_b16 v[238:239], v117 offset:47104
Mvva 144,204,92
v_rcp_f32_e64 v4, v4
Mvva 132,208,64
ds_read_b64_tr_b16 v[240:241], v118 offset:32768
ds_read_b64_tr_b16 v[242:243], v118 offset:34816
Mvva 132,212,72
v_rcp_f32_e64 v5, v5
Mvva 132,216,80
s_waitcnt lgkmcnt(2)
ds_read_b64_tr_b16 v[244:245], v118 offset:36864
ds_read_b64_tr_b16 v[246:247], v118 offset:38912
Mvva 132,220,88
v_rcp_f32 v6, v6
Mvva 148,208,68
s_waitcnt vmcnt(24)
ds_read_b64_tr_b16 v[248:249], v118 offset:40960
ds_read_b64_tr_b16 v[250:251], v118 offset:43008
Mvva 148,212,76
v_rcp_f32 v7, v7
Mvva 148,216,84
s_barrier
ds_read_b64_tr_b16 v[252:253], v118 offset:45056
ds_read_b64_tr_b16 v[254:255], v118 offset:47104
Mvva 148,220,92
v_rcp_f32 v8, v8
Mvva 136,224,64
ds_read_b64_tr_b16 v[192:193], v115 offset:49152
ds_read_b64_tr_b16 v[194:195], v115 offset:51200
Mvva 136,228,72
v_rcp_f32_e64 v9, v9
Mvva 136,232,80
ds_read_b64_tr_b16 v[196:197], v115 offset:53248
ds_read_b64_tr_b16 v[198:199], v115 offset:55296
Mvva 136,236,88
Vm 66,66,2
Vm 67,67,3
Mvva 152,224,68
s_waitcnt lgkmcnt(4)
ds_read_b64_tr_b16 v[200:201], v115 offset:57344
ds_read_b64_tr_b16 v[202:203], v115 offset:59392
Mvva 152,228,76
Vm 68,68,4
v_mul_f32_e64 v69, v69, v5
Mvva 152,232,84
ds_read_b64_tr_b16 v[204:205], v115 offset:61440
ds_read_b64_tr_b16 v[206:207], v115 offset:63488
Mvva 152,236,92
Vm 70,70,6
Vm 71,71,7
Mvva 140,240,64
ds_read_b64_tr_b16 v[208:209], v116 offset:49152
ds_read_b64_tr_b16 v[210:211], v116 offset:51200
Mvva 140,244,72
Vm 72,72,8
Vm 73,73,9
Mvva 140,248,80
ds_read_b64_tr_b16 v[212:213], v116 offset:53248
ds_read_b64_tr_b16 v[214:215], v116 offset:55296
Mvva 140,252,88
Vc 2,66,67
v_lshlrev_b32_e64 v66, 16, v2
Mvva 156,240,68
s_waitcnt lgkmcnt(4)
ds_read_b64_tr_b16 v[216:217], v116 offset:57344
ds_read_b64_tr_b16 v[218:219], v116 offset:59392
Mvva 156,244,76
v_and_b32 v67, 0xffff0000, v2
Vc 3,68,69
Mvva 156,248,84
ds_read_b64_tr_b16 v[220:221], v116 offset:61440
ds_read_b64_tr_b16 v[222:223], v116 offset:63488
Mvva 156,252,92
v_lshlrev_b32 v68, 16, v3
v_and_b32 v69, 0xffff0000, v3
Mvva 128,192,96
ds_read_b64_tr_b16 v[224:225], v117 offset:49152
ds_read_b64_tr_b16 v[226:227], v117 offset:51200
Mvva 128,196,104
Vc 4,70,71
v_lshlrev_b32_e64 v70, 16, v4
Mvva 128,200,112
ds_read_b64_tr_b16 v[228:229], v117 offset:53248
ds_read_b64_tr_b16 v[230:231], v117 offset:55296
Mvva 128,204,120
v_and_b32 v71, 0xffff0000, v4
Vc 5,72,73
Mvva 144,192,100
s_waitcnt lgkmcnt(4)
ds_read_b64_tr_b16 v[232:233], v117 offset:57344
ds_read_b64_tr_b16 v[234:235], v117 offset:59392
Mvva 144,196,108
v_lshlrev_b32 v72, 16, v5
v_and_b32 v73, 0xffff0000, v5
Mvva 144,200,116
ds_read_b64_tr_b16 v[236:237], v117 offset:61440
ds_read_b64_tr_b16 v[238:239], v117 offset:63488
Mvva 144,204,124
s_waitcnt vmcnt(5)
s_mov_b64 exec, 1
buffer_store_dword v16, v126, s[20:23], s27 offen sc1
s_mov_b64 exec, -1
Mvva 132,208,96
ds_read_b64_tr_b16 v[240:241], v118 offset:49152
ds_read_b64_tr_b16 v[242:243], v118 offset:51200
Mvva 132,212,104
Mvva 132,216,112
s_waitcnt lgkmcnt(2)
ds_read_b64_tr_b16 v[244:245], v118 offset:53248
ds_read_b64_tr_b16 v[246:247], v118 offset:55296
Mvva 132,220,120
Mvva 148,208,100
ds_read_b64_tr_b16 v[248:249], v118 offset:57344
ds_read_b64_tr_b16 v[250:251], v118 offset:59392
Mvva 148,212,108
Mvva 148,216,116
s_barrier
ds_read_b64_tr_b16 v[252:253], v118 offset:61440
ds_read_b64_tr_b16 v[254:255], v118 offset:63488
Mvva 148,220,124
Mvva 136,224,96
ds_read_b64_tr_b16 v[192:193], v12 offset:0
ds_read_b64_tr_b16 v[194:195], v12 offset:2048
Mvva 136,228,104
Mvva 136,232,112
ds_read_b64_tr_b16 v[196:197], v12 offset:4096
ds_read_b64_tr_b16 v[198:199], v12 offset:6144
Mvva 136,236,120
Mvva 152,224,100
s_waitcnt lgkmcnt(4)
ds_read_b64_tr_b16 v[200:201], v12 offset:8192
ds_read_b64_tr_b16 v[202:203], v12 offset:10240
Mvva 152,228,108
Mvva 152,232,116
ds_read_b64_tr_b16 v[204:205], v12 offset:12288
ds_read_b64_tr_b16 v[206:207], v12 offset:14336
Mvva 152,236,124
s_cmp_lg_u32 s53, 0
s_cbranch_scc1 L_yB
L_yBr:
Mvva 140,240,96
ds_read_b64_tr_b16 v[208:209], v13 offset:0
ds_read_b64_tr_b16 v[210:211], v13 offset:2048
Mvva 140,244,104
Mvva 140,248,112
ds_read_b64_tr_b16 v[212:213], v13 offset:4096
ds_read_b64_tr_b16 v[214:215], v13 offset:6144
Mvva 140,252,120
Mvva 156,240,100
s_waitcnt lgkmcnt(4)
ds_read_b64_tr_b16 v[216:217], v13 offset:8192
ds_read_b64_tr_b16 v[218:219], v13 offset:10240
Mvva 156,244,108
Mvva 156,248,116
ds_read_b64_tr_b16 v[220:221], v13 offset:12288
ds_read_b64_tr_b16 v[222:223], v13 offset:14336
Mvva 156,252,124
Mvva 128,192,128
ds_read_b64_tr_b16 v[224:225], v14 offset:0
ds_read_b64_tr_b16 v[226:227], v14 offset:2048
Mvva 128,196,136
Mvva 128,200,144
ds_read_b64_tr_b16 v[228:229], v14 offset:4096
ds_read_b64_tr_b16 v[230:231], v14 offset:6144
Mvva 128,204,152
Mvva 144,192,132
s_waitcnt lgkmcnt(4)
ds_read_b64_tr_b16 v[232:233], v14 offset:8192
ds_read_b64_tr_b16 v[234:235], v14 offset:10240
Mvva 144,196,140
Mvva 144,200,148
ds_read_b64_tr_b16 v[236:237], v14 offset:12288
ds_read_b64_tr_b16 v[238:239], v14 offset:14336
Mvva 144,204,156
Mvva 132,208,128
ds_read_b64_tr_b16 v[240:241], v15 offset:0
ds_read_b64_tr_b16 v[242:243], v15 offset:2048
Mvva 132,212,136
Mvva 132,216,144
s_waitcnt lgkmcnt(2)
ds_read_b64_tr_b16 v[244:245], v15 offset:4096
ds_read_b64_tr_b16 v[246:247], v15 offset:6144
Mvva 132,220,152
Mvva 148,208,132
ds_read_b64_tr_b16 v[248:249], v15 offset:8192
ds_read_b64_tr_b16 v[250:251], v15 offset:10240
Mvva 148,212,140
Mvva 148,216,148
s_barrier
ds_read_b64_tr_b16 v[252:253], v15 offset:12288
ds_read_b64_tr_b16 v[254:255], v15 offset:14336
Mvva 148,220,156
Mvva 136,224,128
ds_read_b64_tr_b16 v[192:193], v12 offset:16384
ds_read_b64_tr_b16 v[194:195], v12 offset:18432
Mvva 136,228,136
Mvva 136,232,144
ds_read_b64_tr_b16 v[196:197], v12 offset:20480
ds_read_b64_tr_b16 v[198:199], v12 offset:22528
Mvva 136,236,152
Mvva 152,224,132
s_waitcnt lgkmcnt(4)
ds_read_b64_tr_b16 v[200:201], v12 offset:24576
ds_read_b64_tr_b16 v[202:203], v12 offset:26624
Mvva 152,228,140
buffer_load_dword v17, v126, s[20:23], s24 offen sc1
Mvva 152,232,148
ds_read_b64_tr_b16 v[204:205], v12 offset:28672
ds_read_b64_tr_b16 v[206:207], v12 offset:30720
Mvva 152,236,156
Mvva 140,240,128
ds_read_b64_tr_b16 v[208:209], v13 offset:16384
ds_read_b64_tr_b16 v[210:211], v13 offset:18432
Mvva 140,244,136
Mvva 140,248,144
ds_read_b64_tr_b16 v[212:213], v13 offset:20480
ds_read_b64_tr_b16 v[214:215], v13 offset:22528
Mvva 140,252,152
Mvva 156,240,132
s_waitcnt lgkmcnt(4)
ds_read_b64_tr_b16 v[216:217], v13 offset:24576
ds_read_b64_tr_b16 v[218:219], v13 offset:26624
Mvva 156,244,140
Mvva 156,248,148
ds_read_b64_tr_b16 v[220:221], v13 offset:28672
ds_read_b64_tr_b16 v[222:223], v13 offset:30720
Mvva 156,252,156
Mvva 128,192,160
ds_read_b64_tr_b16 v[224:225], v14 offset:16384
ds_read_b64_tr_b16 v[226:227], v14 offset:18432
Mvva 128,196,168
Mvva 128,200,176
ds_read_b64_tr_b16 v[228:229], v14 offset:20480
ds_read_b64_tr_b16 v[230:231], v14 offset:22528
Mvva 128,204,184
Mvva 144,192,164
s_waitcnt lgkmcnt(4)
ds_read_b64_tr_b16 v[232:233], v14 offset:24576
ds_read_b64_tr_b16 v[234:235], v14 offset:26624
Mvva 144,196,172
Mvva 144,200,180
ds_read_b64_tr_b16 v[236:237], v14 offset:28672
ds_read_b64_tr_b16 v[238:239], v14 offset:30720
Mvva 144,204,188
Mvva 132,208,160
ds_read_b64_tr_b16 v[240:241], v15 offset:16384
ds_read_b64_tr_b16 v[242:243], v15 offset:18432
Mvva 132,212,168
Mvva 132,216,176
s_waitcnt lgkmcnt(2)
ds_read_b64_tr_b16 v[244:245], v15 offset:20480
ds_read_b64_tr_b16 v[246:247], v15 offset:22528
Mvva 132,220,184
Mvva 148,208,164
s_waitcnt vmcnt(6)
ds_read_b64_tr_b16 v[248:249], v15 offset:24576
ds_read_b64_tr_b16 v[250:251], v15 offset:26624
Mvva 148,212,172
Mvva 148,216,180
s_barrier
ds_read_b64_tr_b16 v[252:253], v15 offset:28672
ds_read_b64_tr_b16 v[254:255], v15 offset:30720
Mvva 148,220,188
Mvva 136,224,160
ds_read_b64_tr_b16 v[192:193], v12 offset:32768
ds_read_b64_tr_b16 v[194:195], v12 offset:34816
Mvva 136,228,168
s_cmp_lg_u32 s40, 0
s_cbranch_scc1 L_yC
L_yCr:
Mvva 136,232,176
ds_read_b64_tr_b16 v[196:197], v12 offset:36864
ds_read_b64_tr_b16 v[198:199], v12 offset:38912
Mvva 136,236,184
Mvva 152,224,164
s_waitcnt lgkmcnt(4)
ds_read_b64_tr_b16 v[200:201], v12 offset:40960
ds_read_b64_tr_b16 v[202:203], v12 offset:43008
Mvva 152,228,172
Mvva 152,232,180
ds_read_b64_tr_b16 v[204:205], v12 offset:45056
ds_read_b64_tr_b16 v[206:207], v12 offset:47104
Mvva 152,236,188
Mvva 140,240,160
ds_read_b64_tr_b16 v[208:209], v13 offset:32768
ds_read_b64_tr_b16 v[210:211], v13 offset:34816
Mvva 140,244,168
Mvva 140,248,176
ds_read_b64_tr_b16 v[212:213], v13 offset:36864
ds_read_b64_tr_b16 v[214:215], v13 offset:38912
Mvva 140,252,184
s_waitcnt vmcnt(0)
v_cmp_ne_u32 vcc, 1, v17
s_mov_b32 s33, 0
s_cbranch_vccnz L_xno
s_nop 0
buffer_load_dwordx4 v[160:163], v112, s[16:19], s25 offen offset:0 sc1
buffer_load_dwordx4 v[164:167], v112, s[16:19], s25 offen offset:1024 sc1
buffer_load_dwordx4 v[168:171], v112, s[16:19], s25 offen offset:2048 sc1
buffer_load_dwordx4 v[172:175], v112, s[16:19], s25 offen offset:3072 sc1
buffer_load_dwordx4 v[176:179], v10, s[16:19], s25 offen offset:0 sc1
buffer_load_dwordx4 v[180:183], v10, s[16:19], s25 offen offset:1024 sc1
buffer_load_dwordx4 v[184:187], v10, s[16:19], s25 offen offset:2048 sc1
buffer_load_dwordx4 v[188:191], v10, s[16:19], s25 offen offset:3072 sc1
s_mov_b32 s33, 1
L_xno:
Mvva 156,240,164
s_waitcnt lgkmcnt(4)
ds_read_b64_tr_b16 v[216:217], v13 offset:40960
ds_read_b64_tr_b16 v[218:219], v13 offset:43008
Mvva 156,244,172
Mvva 156,248,180
ds_read_b64_tr_b16 v[220:221], v13 offset:45056
ds_read_b64_tr_b16 v[222:223], v13 offset:47104
Mvva 156,252,188
Mvva 128,192,192
ds_read_b64_tr_b16 v[224:225], v14 offset:32768
ds_read_b64_tr_b16 v[226:227], v14 offset:34816
Mvva 128,196,200
Mvva 128,200,208
ds_read_b64_tr_b16 v[228:229], v14 offset:36864
ds_read_b64_tr_b16 v[230:231], v14 offset:38912
Mvva 128,204,216
Mvva 144,192,196
s_waitcnt lgkmcnt(4)
ds_read_b64_tr_b16 v[232:233], v14 offset:40960
ds_read_b64_tr_b16 v[234:235], v14 offset:43008
Mvva 144,196,204
Mvva 144,200,212
ds_read_b64_tr_b16 v[236:237], v14 offset:45056
ds_read_b64_tr_b16 v[238:239], v14 offset:47104
Mvva 144,204,220
Mvva 132,208,192
ds_read_b64_tr_b16 v[240:241], v15 offset:32768
ds_read_b64_tr_b16 v[242:243], v15 offset:34816
Mvva 132,212,200
Mvva 132,216,208
s_waitcnt lgkmcnt(2)
ds_read_b64_tr_b16 v[244:245], v15 offset:36864
ds_read_b64_tr_b16 v[246:247], v15 offset:38912
Mvva 132,220,216
Mvva 148,208,196
ds_read_b64_tr_b16 v[248:249], v15 offset:40960
ds_read_b64_tr_b16 v[250:251], v15 offset:43008
Mvva 148,212,204
Mvva 148,216,212
s_barrier
ds_read_b64_tr_b16 v[252:253], v15 offset:45056
ds_read_b64_tr_b16 v[254:255], v15 offset:47104
Mvva 148,220,220
Mvva 136,224,192
ds_read_b64_tr_b16 v[192:193], v12 offset:49152
ds_read_b64_tr_b16 v[194:195], v12 offset:51200
Mvva 136,228,200
Mvva 136,232,208
ds_read_b64_tr_b16 v[196:197], v12 offset:53248
ds_read_b64_tr_b16 v[198:199], v12 offset:55296
Mvva 136,236,216
Mvva 152,224,196
s_waitcnt lgkmcnt(4)
ds_read_b64_tr_b16 v[200:201], v12 offset:57344
ds_read_b64_tr_b16 v[202:203], v12 offset:59392
Mvva 152,228,204
Mvva 152,232,212
ds_read_b64_tr_b16 v[204:205], v12 offset:61440
ds_read_b64_tr_b16 v[206:207], v12 offset:63488
Mvva 152,236,220
Mvva 140,240,192
ds_read_b64_tr_b16 v[208:209], v13 offset:49152
ds_read_b64_tr_b16 v[210:211], v13 offset:51200
Mvva 140,244,200
Mvva 140,248,208
ds_read_b64_tr_b16 v[212:213], v13 offset:53248
ds_read_b64_tr_b16 v[214:215], v13 offset:55296
Mvva 140,252,216
Mvva 156,240,196
s_waitcnt lgkmcnt(4)
ds_read_b64_tr_b16 v[216:217], v13 offset:57344
ds_read_b64_tr_b16 v[218:219], v13 offset:59392
Mvva 156,244,204
Mvva 156,248,212
ds_read_b64_tr_b16 v[220:221], v13 offset:61440
ds_read_b64_tr_b16 v[222:223], v13 offset:63488
Mvva 156,252,220
Mvva 128,192,224
ds_read_b64_tr_b16 v[224:225], v14 offset:49152
ds_read_b64_tr_b16 v[226:227], v14 offset:51200
Mvva 128,196,232
Mvva 128,200,240
ds_read_b64_tr_b16 v[228:229], v14 offset:53248
ds_read_b64_tr_b16 v[230:231], v14 offset:55296
Mvva 128,204,248
Mvva 144,192,228
s_waitcnt lgkmcnt(4)
ds_read_b64_tr_b16 v[232:233], v14 offset:57344
ds_read_b64_tr_b16 v[234:235], v14 offset:59392
Mvva 144,196,236
Mvva 144,200,244
ds_read_b64_tr_b16 v[236:237], v14 offset:61440
ds_read_b64_tr_b16 v[238:239], v14 offset:63488
Mvva 144,204,252
Mvva 132,208,224
ds_read_b64_tr_b16 v[240:241], v15 offset:49152
ds_read_b64_tr_b16 v[242:243], v15 offset:51200
Mvva 132,212,232
Mvva 132,216,240
s_waitcnt lgkmcnt(2)
ds_read_b64_tr_b16 v[244:245], v15 offset:53248
ds_read_b64_tr_b16 v[246:247], v15 offset:55296
Mvva 132,220,248
Mvva 148,208,228
ds_read_b64_tr_b16 v[248:249], v15 offset:57344
ds_read_b64_tr_b16 v[250:251], v15 offset:59392
Mvva 148,212,236
Mvva 148,216,244
ds_read_b64_tr_b16 v[252:253], v15 offset:61440
ds_read_b64_tr_b16 v[254:255], v15 offset:63488
Mvva 148,220,252
Mvva 136,224,224
Mvva 136,228,232
Mvva 136,232,240
Mvva 136,236,248
Mvva 152,224,228
s_waitcnt lgkmcnt(0)
Mvva 152,228,236
Mvva 152,232,244
Mvva 152,236,252
Mvva 140,240,224
Mvva 140,244,232
Mvva 140,248,240
Mvva 140,252,248
Mvva 156,240,228
Mvva 156,244,236
Mvva 156,248,244
Mvva 156,252,252
s_cmp_lg_u32 s53, s40
s_cbranch_scc1 L_ysl
L_yslr:
v_and_b32 v124, 15, v0
v_lshlrev_b32 v74, 8, v124
v_add_u32 v74, s35, v74
v_xor_b32 v124, v124, v121
v_lshl_add_u32 v74, v124, 4, v74
v_xor_b32_e64 v75, 64, v74
v_xor_b32 v76, 128, v74
v_xor_b32 v77, 192, v74
v_lshlrev_b32 v125, 1, v122
v_xor_b32 v124, v123, v125
v_lshlrev_b32 v12, 8, v123
v_add_u32 v12, s35, v12
v_lshl_add_u32 v12, v124, 4, v12
v_xor_b32_e64 v13, 16, v12
v_xor_b32 v14, 128, v12
v_xor_b32 v15, 144, v12
s_cmp_eq_u32 s33, 0
s_cbranch_scc1 L_spinX
L_spinXr:
v_lshlrev_b32_e64 v80, 16, v18
v_and_b32 v81, 0xffff0000, v18
v_lshlrev_b32_e64 v82, 16, v19
v_and_b32 v83, 0xffff0000, v19
v_lshlrev_b32_e64 v84, 16, v20
v_and_b32 v85, 0xffff0000, v20
v_lshlrev_b32_e64 v86, 16, v21
v_and_b32 v87, 0xffff0000, v21
v_lshlrev_b32_e64 v88, 16, v22
v_and_b32 v89, 0xffff0000, v22
v_lshlrev_b32_e64 v90, 16, v23
v_and_b32 v91, 0xffff0000, v23
v_lshlrev_b32_e64 v92, 16, v24
v_and_b32 v93, 0xffff0000, v24
v_lshlrev_b32_e64 v94, 16, v25
v_and_b32 v95, 0xffff0000, v25
v_lshlrev_b32_e64 v96, 16, v26
v_and_b32 v97, 0xffff0000, v26
v_lshlrev_b32_e64 v98, 16, v27
v_and_b32 v99, 0xffff0000, v27
v_lshlrev_b32_e64 v100, 16, v28
v_and_b32 v101, 0xffff0000, v28
v_lshlrev_b32_e64 v102, 16, v29
v_and_b32 v103, 0xffff0000, v29
v_lshlrev_b32_e64 v104, 16, v30
v_and_b32 v105, 0xffff0000, v30
v_lshlrev_b32_e64 v106, 16, v31
v_and_b32 v107, 0xffff0000, v31
v_lshlrev_b32_e64 v108, 16, v32
v_and_b32 v109, 0xffff0000, v32
v_lshlrev_b32_e64 v110, 16, v33
v_and_b32 v111, 0xffff0000, v33
s_waitcnt vmcnt(0)
s_nop 0
v_pk_add_f32 v[128:129], v[128:129], v[160:161]
v_pk_add_f32 v[130:131], v[130:131], v[162:163]
ds_write_b128 v74, v[128:131] offset:0
v_pk_add_f32 v[132:133], v[132:133], v[164:165]
v_pk_add_f32 v[134:135], v[134:135], v[166:167]
ds_write_b128 v75, v[132:135] offset:0
v_pk_add_f32 v[136:137], v[136:137], v[168:169]
v_pk_add_f32 v[138:139], v[138:139], v[170:171]
ds_write_b128 v76, v[136:139] offset:0
v_pk_add_f32 v[140:141], v[140:141], v[172:173]
v_pk_add_f32 v[142:143], v[142:143], v[174:175]
ds_write_b128 v77, v[140:143] offset:0
v_pk_add_f32 v[144:145], v[144:145], v[176:177]
v_pk_add_f32 v[146:147], v[146:147], v[178:179]
ds_write_b128 v74, v[144:147] offset:4096
v_pk_add_f32 v[148:149], v[148:149], v[180:181]
v_pk_add_f32 v[150:151], v[150:151], v[182:183]
ds_write_b128 v75, v[148:151] offset:4096
v_pk_add_f32 v[152:153], v[152:153], v[184:185]
v_pk_add_f32 v[154:155], v[154:155], v[186:187]
ds_write_b128 v76, v[152:155] offset:4096
v_pk_add_f32 v[156:157], v[156:157], v[188:189]
v_pk_add_f32 v[158:159], v[158:159], v[190:191]
ds_write_b128 v77, v[156:159] offset:4096
Rv 192,12,0
Rv 196,13,0
Rv 200,14,2048
Rv 204,15,2048
Rv 208,12,4096
Rv 212,13,4096
Rv 216,14,6144
s_waitcnt lgkmcnt(9)
Rv 220,15,6144
s_waitcnt lgkmcnt(6)
Vc 224,192,193
v_lshlrev_b32_e64 v192, 16, v224
v_and_b32 v193, 0xffff0000, v224
Vc 225,194,195
v_lshlrev_b32_e64 v194, 16, v225
v_and_b32 v195, 0xffff0000, v225
Vc 226,196,197
v_lshlrev_b32_e64 v196, 16, v226
v_and_b32 v197, 0xffff0000, v226
Vc 227,198,199
v_lshlrev_b32_e64 v198, 16, v227
v_and_b32 v199, 0xffff0000, v227
v_pk_mul_f32 v[192:193], v[192:193], v[42:43]
v_pk_mul_f32 v[194:195], v[194:195], v[44:45]
v_pk_mul_f32 v[196:197], v[196:197], v[46:47]
v_pk_mul_f32 v[198:199], v[198:199], v[48:49]
Vc 224,192,193
v_lshlrev_b32_e64 v192, 16, v224
v_and_b32 v193, 0xffff0000, v224
Vc 225,194,195
v_lshlrev_b32_e64 v194, 16, v225
v_and_b32 v195, 0xffff0000, v225
Vc 226,196,197
v_lshlrev_b32_e64 v196, 16, v226
v_and_b32 v197, 0xffff0000, v226
Vc 227,198,199
v_lshlrev_b32_e64 v198, 16, v227
v_and_b32 v199, 0xffff0000, v227
v_pk_add_f32 v[192:193], v[192:193], v[80:81]
v_pk_add_f32 v[194:195], v[194:195], v[82:83]
v_pk_add_f32 v[196:197], v[196:197], v[84:85]
v_pk_add_f32 v[198:199], v[198:199], v[86:87]
Vc 224,192,193
Vc 225,194,195
Vc 226,196,197
Vc 227,198,199
buffer_store_dwordx4 v[224:227], v119, s[68:71], s36 offen sc1
s_add_u32 s36, s36, 16384
s_waitcnt lgkmcnt(4)
Vc 228,200,201
v_lshlrev_b32 v200, 16, v228
v_and_b32 v201, 0xffff0000, v228
Vc 229,202,203
v_lshlrev_b32_e64 v202, 16, v229
v_and_b32 v203, 0xffff0000, v229
Vc 230,204,205
v_lshlrev_b32_e64 v204, 16, v230
v_and_b32 v205, 0xffff0000, v230
Vc 231,206,207
v_lshlrev_b32_e64 v206, 16, v231
v_and_b32 v207, 0xffff0000, v231
v_pk_mul_f32 v[200:201], v[200:201], v[50:51]
v_pk_mul_f32 v[202:203], v[202:203], v[52:53]
v_pk_mul_f32 v[204:205], v[204:205], v[54:55]
v_pk_mul_f32 v[206:207], v[206:207], v[56:57]
Vc 228,200,201
v_lshlrev_b32_e64 v200, 16, v228
v_and_b32 v201, 0xffff0000, v228
Vc 229,202,203
v_lshlrev_b32_e64 v202, 16, v229
v_and_b32 v203, 0xffff0000, v229
Vc 230,204,205
v_lshlrev_b32_e64 v204, 16, v230
v_and_b32 v205, 0xffff0000, v230
Vc 231,206,207
v_lshlrev_b32_e64 v206, 16, v231
v_and_b32 v207, 0xffff0000, v231
v_pk_add_f32 v[200:201], v[200:201], v[88:89]
v_pk_add_f32 v[202:203], v[202:203], v[90:91]
v_pk_add_f32 v[204:205], v[204:205], v[92:93]
v_pk_add_f32 v[206:207], v[206:207], v[94:95]
Vc 228,200,201
Vc 229,202,203
Vc 230,204,205
Vc 231,206,207
buffer_store_dwordx4 v[228:231], v119, s[68:71], s36 offen sc1
s_add_u32 s36, s36, 16384
s_waitcnt lgkmcnt(2)
Vc 232,208,209
v_lshlrev_b32 v208, 16, v232
v_and_b32 v209, 0xffff0000, v232
Vc 233,210,211
v_lshlrev_b32_e64 v210, 16, v233
v_and_b32 v211, 0xffff0000, v233
Vc 234,212,213
v_lshlrev_b32_e64 v212, 16, v234
v_and_b32 v213, 0xffff0000, v234
Vc 235,214,215
v_lshlrev_b32_e64 v214, 16, v235
v_and_b32 v215, 0xffff0000, v235
v_pk_mul_f32 v[208:209], v[208:209], v[58:59]
v_pk_mul_f32 v[210:211], v[210:211], v[60:61]
v_pk_mul_f32 v[212:213], v[212:213], v[62:63]
v_pk_mul_f32 v[214:215], v[214:215], v[64:65]
Vc 232,208,209
v_lshlrev_b32_e64 v208, 16, v232
v_and_b32 v209, 0xffff0000, v232
Vc 233,210,211
v_lshlrev_b32_e64 v210, 16, v233
v_and_b32 v211, 0xffff0000, v233
Vc 234,212,213
v_lshlrev_b32_e64 v212, 16, v234
v_and_b32 v213, 0xffff0000, v234
Vc 235,214,215
v_lshlrev_b32_e64 v214, 16, v235
v_and_b32 v215, 0xffff0000, v235
v_pk_add_f32 v[208:209], v[208:209], v[96:97]
v_pk_add_f32 v[210:211], v[210:211], v[98:99]
v_pk_add_f32 v[212:213], v[212:213], v[100:101]
v_pk_add_f32 v[214:215], v[214:215], v[102:103]
Vc 232,208,209
Vc 233,210,211
Vc 234,212,213
Vc 235,214,215
buffer_store_dwordx4 v[232:235], v119, s[68:71], s36 offen sc1
s_add_u32 s36, s36, 16384
s_waitcnt lgkmcnt(0)
Vc 236,216,217
v_lshlrev_b32 v216, 16, v236
v_and_b32 v217, 0xffff0000, v236
Vc 237,218,219
v_lshlrev_b32_e64 v218, 16, v237
v_and_b32 v219, 0xffff0000, v237
Vc 238,220,221
v_lshlrev_b32_e64 v220, 16, v238
v_and_b32 v221, 0xffff0000, v238
Vc 239,222,223
v_lshlrev_b32_e64 v222, 16, v239
v_and_b32 v223, 0xffff0000, v239
v_pk_mul_f32 v[216:217], v[216:217], v[66:67]
v_pk_mul_f32 v[218:219], v[218:219], v[68:69]
v_pk_mul_f32 v[220:221], v[220:221], v[70:71]
v_pk_mul_f32 v[222:223], v[222:223], v[72:73]
Vc 236,216,217
v_lshlrev_b32_e64 v216, 16, v236
v_and_b32 v217, 0xffff0000, v236
Vc 237,218,219
v_lshlrev_b32_e64 v218, 16, v237
v_and_b32 v219, 0xffff0000, v237
Vc 238,220,221
v_lshlrev_b32_e64 v220, 16, v238
v_and_b32 v221, 0xffff0000, v238
Vc 239,222,223
v_lshlrev_b32_e64 v222, 16, v239
v_and_b32 v223, 0xffff0000, v239
v_pk_add_f32 v[216:217], v[216:217], v[104:105]
v_pk_add_f32 v[218:219], v[218:219], v[106:107]
v_pk_add_f32 v[220:221], v[220:221], v[108:109]
v_pk_add_f32 v[222:223], v[222:223], v[110:111]
Vc 236,216,217
Vc 237,218,219
Vc 238,220,221
Vc 239,222,223
buffer_store_dwordx4 v[236:239], v119, s[68:71], s36 offen sc1
L_k2_end:
s_endpgm
L_spinC:
s_add_u32 m0, s35, 0
s_nop 0
s_nop 0
buffer_load_dwordx4 v125, s[60:63], s48 offen offset:0 lds
buffer_load_dwordx4 v125, s[60:63], s49 offen offset:1024 lds
buffer_load_dwordx4 v125, s[60:63], s50 offen offset:2048 lds
buffer_load_dwordx4 v125, s[60:63], s51 offen offset:3072 lds
v_add_u32 v125, 65536, v125
s_add_u32 m0, s35, 4096
s_nop 0
buffer_load_dwordx4 v125, s[60:63], s48 offen offset:0 lds
buffer_load_dwordx4 v125, s[60:63], s49 offen offset:1024 lds
buffer_load_dwordx4 v125, s[60:63], s50 offen offset:2048 lds
buffer_load_dwordx4 v125, s[60:63], s51 offen offset:3072 lds
s_mov_b32 s40, 1
s_mov_b32 s47, 0x400000
L_spinC_l:
buffer_load_dword v124, v10, s[20:23], s38 offen sc1
s_sub_u32 s47, s47, 1
s_waitcnt vmcnt(0)
s_cmp_eq_u32 s47, 0
s_cbranch_scc1 L_spinC_lx
v_cmp_ne_u32 vcc, 1, v124
s_cbranch_vccz L_spinC_lx
s_sleep 4
s_branch L_spinC_l
L_spinC_lx:
s_branch L_spinCr
L_c31:
s_bfe_u32 s3, s2, 0x40003
s_lshl_b32 s3, s3, 2
s_add_u32 s3, s3, s32
s_lshl_b32 s3, s3, 15
s_and_b32 s7, s2, 1
s_lshl_b32 s7, s7, 22
s_add_u32 s3, s3, s7
s_add_u32 s3, s3, 2097536
v_and_b32 v1, 15, v0
v_lshlrev_b32 v1, 11, v1
v_lshrrev_b32 v11, 5, v0
v_lshl_add_u32 v1, v11, 10, v1
buffer_load_dword v11, v1, s[28:31], s3 offen
s_branch L_c31r
L_f2A:
s_lshr_b32 s5, s54, 1
s_lshl_b32 s5, s5, 5
s_add_u32 s5, s5, 5447680
buffer_load_dword v125, v127, s[20:23], s5 offen sc1
s_branch L_f2Ar
L_f2B:
s_waitcnt vmcnt(16)
v_cmp_ne_u32 vcc, 1, v125
s_cbranch_vccz L_f2lx
s_mov_b32 s47, 0x400000
L_f2l:
buffer_load_dword v125, v127, s[20:23], s5 offen sc1
s_sub_u32 s47, s47, 1
s_waitcnt vmcnt(0)
s_cmp_eq_u32 s47, 0
s_cbranch_scc1 L_f2lx
v_cmp_ne_u32 vcc, 1, v125
s_cbranch_vccz L_f2lx
s_sleep 8
s_branch L_f2l
L_f2lx:
s_lshl_b32 s3, s54, 8
s_add_u32 s3, s3, 6291456
v_mul_u32_u24 v124, 14336, v121
v_and_b32_e64 v125, 15, v0
v_lshl_add_u32 v124, v125, 4, v124
buffer_load_dwordx4 v[74:77], v124, s[20:23], s3 offen sc1
s_add_u32 s3, s3, 57344
buffer_load_dwordx4 v[78:81], v124, s[20:23], s3 offen sc1
s_add_u32 s3, s3, 57344
buffer_load_dwordx4 v[82:85], v124, s[20:23], s3 offen sc1
s_add_u32 s3, s3, 57344
buffer_load_dwordx4 v[86:89], v124, s[20:23], s3 offen sc1
s_add_u32 s3, s3, 57344
buffer_load_dwordx4 v[90:93], v124, s[20:23], s3 offen sc1
s_add_u32 s3, s3, 57344
buffer_load_dwordx4 v[94:97], v124, s[20:23], s3 offen sc1
s_add_u32 s3, s3, 57344
buffer_load_dwordx4 v[98:101], v124, s[20:23], s3 offen sc1
s_add_u32 s3, s3, 57344
buffer_load_dwordx4 v[102:105], v124, s[20:23], s3 offen sc1
s_branch L_f2Br
L_yA:
v_min_u32 v127, 13, v0
v_lshlrev_b32_e64 v127, 2, v127
buffer_load_dword v74, v127, s[20:23], s41 offen sc1
s_branch L_yAr
L_yB:
s_waitcnt vmcnt(1)
v_cmp_ne_u32 vcc, 1, v74
s_cbranch_vccnz L_yBr
s_mov_b32 s40, 1
v_lshlrev_b32 v124, 2, v0
v_lshlrev_b32 v125, 1, v0
s_lshl_b32 s7, s45, 2
s_add_u32 s7, s7, s32
s_lshr_b32 s3, s42, 5
s_cmp_lg_u32 s3, s7
s_cbranch_scc1 L_f_yl1
s_add_u32 s3, s55, 0
s_nop 0
s_add_u32 s7, s3, 4096
buffer_load_dword v76, v124, s[20:23], s3 offen offset:0 sc1
buffer_load_dword v77, v124, s[20:23], s3 offen offset:512 sc1
buffer_load_dword v78, v124, s[20:23], s3 offen offset:1024 sc1
buffer_load_dword v79, v124, s[20:23], s3 offen offset:1536 sc1
buffer_load_dword v80, v124, s[20:23], s3 offen offset:2048 sc1
buffer_load_dword v81, v124, s[20:23], s3 offen offset:2560 sc1
buffer_load_dword v82, v124, s[20:23], s3 offen offset:3072 sc1
buffer_load_dword v83, v124, s[20:23], s3 offen offset:3584 sc1
buffer_load_dword v84, v124, s[20:23], s7 offen offset:0 sc1
buffer_load_dword v85, v124, s[20:23], s7 offen offset:512 sc1
buffer_load_dword v86, v124, s[20:23], s7 offen offset:1024 sc1
buffer_load_dword v87, v124, s[20:23], s7 offen offset:1536 sc1
buffer_load_dword v88, v124, s[20:23], s7 offen offset:2048 sc1
buffer_load_dword v89, v124, s[20:23], s7 offen offset:2560 sc1
s_lshl_b32 s3, s42, 11
s_lshl_b32 s7, s46, 7
s_add_u32 s3, s3, s7
buffer_load_ushort v90, v125, s[56:59], s3 offen
s_lshl_b32 s3, s42, 3
s_add_u32 s3, s3, 5259264
buffer_load_dwordx2 v[92:93], v126, s[20:23], s3 offen sc1
L_f_yl1:
s_lshl_b32 s7, s45, 2
s_add_u32 s7, s7, s32
s_lshr_b32 s3, s43, 5
s_cmp_lg_u32 s3, s7
s_cbranch_scc1 L_f_yl2
s_nop 0
s_add_u32 s3, s55, 256
s_add_u32 s7, s3, 4096
buffer_load_dword v94, v124, s[20:23], s3 offen offset:0 sc1
buffer_load_dword v95, v124, s[20:23], s3 offen offset:512 sc1
buffer_load_dword v96, v124, s[20:23], s3 offen offset:1024 sc1
buffer_load_dword v97, v124, s[20:23], s3 offen offset:1536 sc1
buffer_load_dword v98, v124, s[20:23], s3 offen offset:2048 sc1
buffer_load_dword v99, v124, s[20:23], s3 offen offset:2560 sc1
buffer_load_dword v100, v124, s[20:23], s3 offen offset:3072 sc1
buffer_load_dword v101, v124, s[20:23], s3 offen offset:3584 sc1
buffer_load_dword v102, v124, s[20:23], s7 offen offset:0 sc1
buffer_load_dword v103, v124, s[20:23], s7 offen offset:512 sc1
buffer_load_dword v104, v124, s[20:23], s7 offen offset:1024 sc1
buffer_load_dword v105, v124, s[20:23], s7 offen offset:1536 sc1
buffer_load_dword v106, v124, s[20:23], s7 offen offset:2048 sc1
buffer_load_dword v107, v124, s[20:23], s7 offen offset:2560 sc1
s_lshl_b32 s3, s43, 11
s_lshl_b32 s7, s46, 7
s_add_u32 s3, s3, s7
buffer_load_ushort v108, v125, s[56:59], s3 offen
s_lshl_b32 s3, s43, 3
s_add_u32 s3, s3, 5259264
buffer_load_dwordx2 v[110:111], v126, s[20:23], s3 offen sc1
L_f_yl2:
s_branch L_yBr
L_yC:
s_waitcnt vmcnt(1)
s_lshl_b32 s7, s45, 2
s_add_u32 s7, s7, s32
s_lshr_b32 s3, s42, 5
s_cmp_lg_u32 s3, s7
s_cbranch_scc1 L_f_ys3
s_nop 0
v_pk_add_f32 v[76:77], v[76:77], v[78:79]
v_pk_add_f32 v[76:77], v[76:77], v[80:81]
v_pk_add_f32 v[76:77], v[76:77], v[82:83]
v_pk_add_f32 v[76:77], v[76:77], v[84:85]
v_pk_add_f32 v[76:77], v[76:77], v[86:87]
v_pk_add_f32 v[76:77], v[76:77], v[88:89]
Va 76,76,77
v_lshlrev_b32 v90, 16, v90
v_sub_f32_e64 v90, v90, v92
Vc 76,76,76
v_lshlrev_b32_e64 v76, 16, v76
Vc 90,90,90
v_lshlrev_b32 v90, 16, v90
v_mul_f32 v76, s100, v76
v_mul_f32_e64 v90, v90, v93
Vc 76,76,76
v_lshlrev_b32_e64 v76, 16, v76
Vc 90,90,90
v_lshlrev_b32 v90, 16, v90
Va 90,90,76
Vc 90,90,90
v_lshlrev_b32_e64 v90, 16, v90
v_mul_f32 v76, 0xbfb8aa3b, v90
Ve 76,76
s_nop 0
v_add_f32 v76, 1.0, v76
v_rcp_f32 v76, v76
s_nop 0
Vm 90,90,76
Vc 90,90,90
v_lshlrev_b32 v90, 16, v90
v_lshlrev_b32 v124, 2, v0
v_add_u32 v124, s35, v124
v_lshlrev_b32 v125, 5, v122
v_add_u32 v125, s35, v125
s_waitcnt lgkmcnt(0)
ds_write_b32 v124, v90
s_and_b32 s3, s42, 7
s_lshl_b32 s3, s3, 3
s_lshl_b64 s[4:5], 0xff, s3
s_bfe_u32 s3, s42, 0x20003
s_mov_b64 exec, s[4:5]
s_cmp_lg_u32 s3, 0
s_cbranch_scc1 L_f_yp4
ds_read_b64 v[42:43], v125
ds_read_b64 v[44:45], v125 offset:8
ds_read_b64 v[46:47], v125 offset:16
ds_read_b64 v[48:49], v125 offset:24
L_f_yp4:
s_cmp_lg_u32 s3, 1
s_cbranch_scc1 L_f_yp5
ds_read_b64 v[50:51], v125
ds_read_b64 v[52:53], v125 offset:8
ds_read_b64 v[54:55], v125 offset:16
ds_read_b64 v[56:57], v125 offset:24
L_f_yp5:
s_cmp_lg_u32 s3, 2
s_cbranch_scc1 L_f_yp6
ds_read_b64 v[58:59], v125
ds_read_b64 v[60:61], v125 offset:8
ds_read_b64 v[62:63], v125 offset:16
ds_read_b64 v[64:65], v125 offset:24
L_f_yp6:
s_cmp_lg_u32 s3, 3
s_cbranch_scc1 L_f_yp7
ds_read_b64 v[66:67], v125
ds_read_b64 v[68:69], v125 offset:8
s_waitcnt lgkmcnt(9)
ds_read_b64 v[70:71], v125 offset:16
ds_read_b64 v[72:73], v125 offset:24
L_f_yp7:
s_mov_b64 exec, -1
s_waitcnt lgkmcnt(0)
L_f_ys3:
s_lshl_b32 s7, s45, 2
s_add_u32 s7, s7, s32
s_lshr_b32 s3, s43, 5
s_cmp_lg_u32 s3, s7
s_cbranch_scc1 L_f_ys8
s_nop 0
v_pk_add_f32 v[94:95], v[94:95], v[96:97]
v_pk_add_f32 v[94:95], v[94:95], v[98:99]
v_pk_add_f32 v[94:95], v[94:95], v[100:101]
v_pk_add_f32 v[94:95], v[94:95], v[102:103]
v_pk_add_f32 v[94:95], v[94:95], v[104:105]
v_pk_add_f32 v[94:95], v[94:95], v[106:107]
Va 94,94,95
v_lshlrev_b32 v108, 16, v108
v_sub_f32_e64 v108, v108, v110
Vc 94,94,94
v_lshlrev_b32_e64 v94, 16, v94
Vc 108,108,108
v_lshlrev_b32 v108, 16, v108
v_mul_f32 v94, s101, v94
v_mul_f32_e64 v108, v108, v111
Vc 94,94,94
v_lshlrev_b32_e64 v94, 16, v94
Vc 108,108,108
v_lshlrev_b32 v108, 16, v108
Va 108,108,94
Vc 108,108,108
v_lshlrev_b32_e64 v108, 16, v108
v_mul_f32 v94, 0xbfb8aa3b, v108
Ve 94,94
s_nop 0
v_add_f32 v94, 1.0, v94
v_rcp_f32 v94, v94
s_nop 0
Vm 108,108,94
Vc 108,108,108
v_lshlrev_b32 v108, 16, v108
v_lshlrev_b32 v124, 2, v0
v_add_u32 v124, s35, v124
v_lshlrev_b32 v125, 5, v122
v_add_u32 v125, s35, v125
s_waitcnt lgkmcnt(0)
ds_write_b32 v124, v108
s_and_b32 s3, s43, 7
s_lshl_b32 s3, s3, 3
s_lshl_b64 s[4:5], 0xff, s3
s_bfe_u32 s3, s43, 0x20003
s_mov_b64 exec, s[4:5]
s_cmp_lg_u32 s3, 0
s_cbranch_scc1 L_f_yp9
ds_read_b64 v[42:43], v125
ds_read_b64 v[44:45], v125 offset:8
ds_read_b64 v[46:47], v125 offset:16
ds_read_b64 v[48:49], v125 offset:24
L_f_yp9:
s_cmp_lg_u32 s3, 1
s_cbranch_scc1 L_f_yp10
ds_read_b64 v[50:51], v125
ds_read_b64 v[52:53], v125 offset:8
ds_read_b64 v[54:55], v125 offset:16
ds_read_b64 v[56:57], v125 offset:24
L_f_yp10:
s_cmp_lg_u32 s3, 2
s_cbranch_scc1 L_f_yp11
ds_read_b64 v[58:59], v125
ds_read_b64 v[60:61], v125 offset:8
ds_read_b64 v[62:63], v125 offset:16
ds_read_b64 v[64:65], v125 offset:24
L_f_yp11:
s_cmp_lg_u32 s3, 3
s_cbranch_scc1 L_f_yp12
ds_read_b64 v[66:67], v125
ds_read_b64 v[68:69], v125 offset:8
s_waitcnt lgkmcnt(9)
ds_read_b64 v[70:71], v125 offset:16
ds_read_b64 v[72:73], v125 offset:24
L_f_yp12:
s_mov_b64 exec, -1
s_waitcnt lgkmcnt(0)
L_f_ys8:
s_branch L_yCr
L_p4_end:
L_spinAk:
s_mov_b32 s47, 0x400000
L_spinAk_l:
s_sleep 8
buffer_load_dword v1, v7, s[28:31], 0 offen sc1
s_waitcnt vmcnt(0)
v_readfirstlane_b32 s3, v1
s_sub_u32 s47, s47, 1
s_cmp_eq_u32 s47, 0
s_cbranch_scc1 L_spinArk
s_cmp_lt_u32 s3, 256
s_cbranch_scc1 L_spinAk_l
s_branch L_spinArk
L_spinAv:
s_mov_b32 s47, 0x400000
L_spinAv_l:
s_sleep 8
buffer_load_dword v1, v7, s[28:31], 0 offen sc1
s_waitcnt vmcnt(0)
v_readfirstlane_b32 s3, v1
s_sub_u32 s47, s47, 1
s_cmp_eq_u32 s47, 0
s_cbranch_scc1 L_spinArv
s_cmp_lt_u32 s3, 256
s_cbranch_scc1 L_spinAv_l
s_branch L_spinArv
L_spinB:
s_mov_b32 s59, 0x400000
L_spinB_l:
s_sleep 4
buffer_load_dword v12, v1, s[20:23], s6 offen sc1
s_sub_u32 s59, s59, 1
s_cmp_eq_u32 s59, 0
s_cbranch_scc1 L_spinBx
s_waitcnt vmcnt(0)
v_cmp_ne_u32 vcc, 1, v12
s_cbranch_vccnz L_spinB_l
L_spinBx:
s_waitcnt vmcnt(0)
s_branch L_spinBr
L_k2_fb_we:
s_nop 7
s_nop 0
v_max3_f32 v21, v128, v129, v130
v_max3_f32 v21, v21, v131, v132
v_max3_f32 v21, v21, v133, v134
v_max3_f32 v21, v21, v135, v136
v_max3_f32 v21, v21, v137, v138
v_max3_f32 v21, v21, v139, v140
v_max3_f32 v21, v21, v141, v142
v_max_f32 v21, v21, v143
v_mov_b32 v1, v21
s_nop 1
v_permlane16_swap_b32 v1, v21
v_max_f32 v21, v21, v1
v_mov_b32 v1, v21
s_nop 1
v_permlane32_swap_b32 v1, v21
v_max_f32_e64 v21, v21, v1
v_add_f32 v21, 0x41f80000, v21
v_max_f32 v21, 0, v21
Vs 128,128,21
Vs 129,129,21
Vs 130,130,21
Vs 131,131,21
Vs 132,132,21
Vs 133,133,21
Vs 134,134,21
Vs 135,135,21
Vs 136,136,21
Vs 137,137,21
Vs 138,138,21
Vs 139,139,21
Vs 140,140,21
Vs 141,141,21
Vs 142,142,21
Vs 143,143,21
Vs 192,192,21
Vs 193,193,21
Vs 194,194,21
Vs 195,195,21
Vs 196,196,21
Vs 197,197,21
Vs 198,198,21
Vs 199,199,21
Vs 200,200,21
Vs 201,201,21
Vs 202,202,21
Vs 203,203,21
Vs 204,204,21
Vs 205,205,21
Vs 206,206,21
Vs 207,207,21
Vs 32,32,21
Vs 33,33,21
Vs 34,34,21
v_sub_f32_e64 v35, v35, v21
v_exp_f32 v22, -v21
s_nop 0
Vm 48,48,22
Vm 49,49,22
Vm 50,50,22
v_mul_f32_e64 v51, v51, v22
Ar 8,0
Ar 9,1
Ar 10,2
Ar 11,3
Ar 12,4
Ar 13,5
Ar 14,6
Ar 15,7
Vm 8,8,22
Vm 9,9,22
Vm 10,10,22
Vm 11,11,22
Vm 12,12,22
Vm 13,13,22
Vm 14,14,22
Vm 15,15,22
Aw 0,8
Aw 1,9
Aw 2,10
Aw 3,11
Aw 4,12
Aw 5,13
Aw 6,14
Aw 7,15
Ar 8,8
Ar 9,9
Ar 10,10
Ar 11,11
Ar 12,12
Ar 13,13
Ar 14,14
Ar 15,15
Vm 8,8,22
Vm 9,9,22
Vm 10,10,22
Vm 11,11,22
Vm 12,12,22
Vm 13,13,22
Vm 14,14,22
Vm 15,15,22
Aw 8,8
Aw 9,9
Aw 10,10
Aw 11,11
Aw 12,12
Aw 13,13
Aw 14,14
Aw 15,15
Ar 8,16
Ar 9,17
Ar 10,18
Ar 11,19
Ar 12,20
Ar 13,21
Ar 14,22
Ar 15,23
Vm 8,8,22
Vm 9,9,22
Vm 10,10,22
Vm 11,11,22
Vm 12,12,22
Vm 13,13,22
Vm 14,14,22
Vm 15,15,22
Aw 16,8
Aw 17,9
Aw 18,10
Aw 19,11
Aw 20,12
Aw 21,13
Aw 22,14
Aw 23,15
Ar 8,24
Ar 9,25
Ar 10,26
Ar 11,27
Ar 12,28
Ar 13,29
Ar 14,30
Ar 15,31
Vm 8,8,22
Vm 9,9,22
Vm 10,10,22
Vm 11,11,22
Vm 12,12,22
Vm 13,13,22
Vm 14,14,22
Vm 15,15,22
Aw 24,8
Aw 25,9
Aw 26,10
Aw 27,11
Aw 28,12
Aw 29,13
Aw 30,14
Aw 31,15
v_max3_f32 v21, v144, v145, v146
v_max3_f32 v21, v21, v147, v148
v_max3_f32 v21, v21, v149, v150
v_max3_f32 v21, v21, v151, v152
v_max3_f32 v21, v21, v153, v154
v_max3_f32 v21, v21, v155, v156
v_max3_f32 v21, v21, v157, v158
v_max_f32 v21, v21, v159
v_mov_b32 v1, v21
s_nop 1
v_permlane16_swap_b32 v1, v21
v_max_f32 v21, v21, v1
v_mov_b32 v1, v21
s_nop 1
v_permlane32_swap_b32 v1, v21
v_max_f32_e64 v21, v21, v1
v_add_f32 v21, 0x41f80000, v21
v_max_f32 v21, 0, v21
Vs 144,144,21
Vs 145,145,21
Vs 146,146,21
Vs 147,147,21
Vs 148,148,21
Vs 149,149,21
Vs 150,150,21
Vs 151,151,21
Vs 152,152,21
Vs 153,153,21
Vs 154,154,21
Vs 155,155,21
Vs 156,156,21
Vs 157,157,21
Vs 158,158,21
Vs 159,159,21
Vs 208,208,21
Vs 209,209,21
Vs 210,210,21
Vs 211,211,21
Vs 212,212,21
Vs 213,213,21
Vs 214,214,21
Vs 215,215,21
Vs 216,216,21
Vs 217,217,21
Vs 218,218,21
Vs 219,219,21
Vs 220,220,21
Vs 221,221,21
Vs 222,222,21
Vs 223,223,21
Vs 36,36,21
Vs 37,37,21
Vs 38,38,21
v_sub_f32_e64 v39, v39, v21
v_exp_f32 v22, -v21
s_nop 0
Vm 52,52,22
Vm 53,53,22
Vm 54,54,22
v_mul_f32_e64 v55, v55, v22
Ar 8,32
Ar 9,33
Ar 10,34
Ar 11,35
Ar 12,36
Ar 13,37
Ar 14,38
Ar 15,39
Vm 8,8,22
Vm 9,9,22
Vm 10,10,22
Vm 11,11,22
Vm 12,12,22
Vm 13,13,22
Vm 14,14,22
Vm 15,15,22
Aw 32,8
Aw 33,9
Aw 34,10
Aw 35,11
Aw 36,12
Aw 37,13
Aw 38,14
Aw 39,15
Ar 8,40
Ar 9,41
Ar 10,42
Ar 11,43
Ar 12,44
Ar 13,45
Ar 14,46
Ar 15,47
Vm 8,8,22
Vm 9,9,22
Vm 10,10,22
Vm 11,11,22
Vm 12,12,22
Vm 13,13,22
Vm 14,14,22
Vm 15,15,22
Aw 40,8
Aw 41,9
Aw 42,10
Aw 43,11
Aw 44,12
Aw 45,13
Aw 46,14
Aw 47,15
Ar 8,48
Ar 9,49
Ar 10,50
Ar 11,51
Ar 12,52
Ar 13,53
Ar 14,54
Ar 15,55
Vm 8,8,22
Vm 9,9,22
Vm 10,10,22
Vm 11,11,22
Vm 12,12,22
Vm 13,13,22
Vm 14,14,22
Vm 15,15,22
Aw 48,8
Aw 49,9
Aw 50,10
Aw 51,11
Aw 52,12
Aw 53,13
Aw 54,14
Aw 55,15
Ar 8,56
Ar 9,57
Ar 10,58
Ar 11,59
Ar 12,60
Ar 13,61
Ar 14,62
Ar 15,63
Vm 8,8,22
Vm 9,9,22
Vm 10,10,22
Vm 11,11,22
Vm 12,12,22
Vm 13,13,22
Vm 14,14,22
Vm 15,15,22
Aw 56,8
Aw 57,9
Aw 58,10
Aw 59,11
Aw 60,12
Aw 61,13
Aw 62,14
Aw 63,15
v_max3_f32 v21, v160, v161, v162
v_max3_f32 v21, v21, v163, v164
v_max3_f32 v21, v21, v165, v166
v_max3_f32 v21, v21, v167, v168
v_max3_f32 v21, v21, v169, v170
v_max3_f32 v21, v21, v171, v172
v_max3_f32 v21, v21, v173, v174
v_max_f32 v21, v21, v175
v_mov_b32 v1, v21
s_nop 1
v_permlane16_swap_b32 v1, v21
v_max_f32 v21, v21, v1
v_mov_b32 v1, v21
s_nop 1
v_permlane32_swap_b32 v1, v21
v_max_f32_e64 v21, v21, v1
v_add_f32 v21, 0x41f80000, v21
v_max_f32 v21, 0, v21
Vs 160,160,21
Vs 161,161,21
Vs 162,162,21
Vs 163,163,21
Vs 164,164,21
Vs 165,165,21
Vs 166,166,21
Vs 167,167,21
Vs 168,168,21
Vs 169,169,21
Vs 170,170,21
Vs 171,171,21
Vs 172,172,21
Vs 173,173,21
Vs 174,174,21
Vs 175,175,21
Vs 224,224,21
Vs 225,225,21
Vs 226,226,21
Vs 227,227,21
Vs 228,228,21
Vs 229,229,21
Vs 230,230,21
Vs 231,231,21
Vs 232,232,21
Vs 233,233,21
Vs 234,234,21
Vs 235,235,21
Vs 236,236,21
Vs 237,237,21
Vs 238,238,21
Vs 239,239,21
Vs 40,40,21
Vs 41,41,21
Vs 42,42,21
v_sub_f32_e64 v43, v43, v21
v_exp_f32 v22, -v21
s_nop 0
Vm 56,56,22
Vm 57,57,22
Vm 58,58,22
v_mul_f32_e64 v59, v59, v22
Ar 8,64
Ar 9,65
Ar 10,66
Ar 11,67
Ar 12,68
Ar 13,69
Ar 14,70
Ar 15,71
Vm 8,8,22
Vm 9,9,22
Vm 10,10,22
Vm 11,11,22
Vm 12,12,22
Vm 13,13,22
Vm 14,14,22
Vm 15,15,22
Aw 64,8
Aw 65,9
Aw 66,10
Aw 67,11
Aw 68,12
Aw 69,13
Aw 70,14
Aw 71,15
Ar 8,72
Ar 9,73
Ar 10,74
Ar 11,75
Ar 12,76
Ar 13,77
Ar 14,78
Ar 15,79
Vm 8,8,22
Vm 9,9,22
Vm 10,10,22
Vm 11,11,22
Vm 12,12,22
Vm 13,13,22
Vm 14,14,22
Vm 15,15,22
Aw 72,8
Aw 73,9
Aw 74,10
Aw 75,11
Aw 76,12
Aw 77,13
Aw 78,14
Aw 79,15
Ar 8,80
Ar 9,81
Ar 10,82
Ar 11,83
Ar 12,84
Ar 13,85
Ar 14,86
Ar 15,87
Vm 8,8,22
Vm 9,9,22
Vm 10,10,22
Vm 11,11,22
Vm 12,12,22
Vm 13,13,22
Vm 14,14,22
Vm 15,15,22
Aw 80,8
Aw 81,9
Aw 82,10
Aw 83,11
Aw 84,12
Aw 85,13
Aw 86,14
Aw 87,15
Ar 8,88
Ar 9,89
Ar 10,90
Ar 11,91
Ar 12,92
Ar 13,93
Ar 14,94
Ar 15,95
Vm 8,8,22
Vm 9,9,22
Vm 10,10,22
Vm 11,11,22
Vm 12,12,22
Vm 13,13,22
Vm 14,14,22
Vm 15,15,22
Aw 88,8
Aw 89,9
Aw 90,10
Aw 91,11
Aw 92,12
Aw 93,13
Aw 94,14
Aw 95,15
v_max3_f32 v21, v176, v177, v178
v_max3_f32 v21, v21, v179, v180
v_max3_f32 v21, v21, v181, v182
v_max3_f32 v21, v21, v183, v184
v_max3_f32 v21, v21, v185, v186
v_max3_f32 v21, v21, v187, v188
v_max3_f32 v21, v21, v189, v190
v_max_f32 v21, v21, v191
v_mov_b32 v1, v21
s_nop 1
v_permlane16_swap_b32 v1, v21
v_max_f32 v21, v21, v1
v_mov_b32 v1, v21
s_nop 1
v_permlane32_swap_b32 v1, v21
v_max_f32_e64 v21, v21, v1
v_add_f32 v21, 0x41f80000, v21
v_max_f32 v21, 0, v21
Vs 176,176,21
Vs 177,177,21
Vs 178,178,21
Vs 179,179,21
Vs 180,180,21
Vs 181,181,21
Vs 182,182,21
Vs 183,183,21
Vs 184,184,21
Vs 185,185,21
Vs 186,186,21
Vs 187,187,21
Vs 188,188,21
Vs 189,189,21
Vs 190,190,21
Vs 191,191,21
Vs 240,240,21
Vs 241,241,21
Vs 242,242,21
Vs 243,243,21
Vs 244,244,21
Vs 245,245,21
Vs 246,246,21
Vs 247,247,21
Vs 248,248,21
Vs 249,249,21
Vs 250,250,21
Vs 251,251,21
Vs 252,252,21
Vs 253,253,21
Vs 254,254,21
Vs 255,255,21
Vs 44,44,21
Vs 45,45,21
Vs 46,46,21
v_sub_f32_e64 v47, v47, v21
v_exp_f32 v22, -v21
s_nop 0
Vm 60,60,22
Vm 61,61,22
Vm 62,62,22
v_mul_f32_e64 v63, v63, v22
Ar 8,96
Ar 9,97
Ar 10,98
Ar 11,99
Ar 12,100
Ar 13,101
Ar 14,102
Ar 15,103
Vm 8,8,22
Vm 9,9,22
Vm 10,10,22
Vm 11,11,22
Vm 12,12,22
Vm 13,13,22
Vm 14,14,22
Vm 15,15,22
Aw 96,8
Aw 97,9
Aw 98,10
Aw 99,11
Aw 100,12
Aw 101,13
Aw 102,14
Aw 103,15
Ar 8,104
Ar 9,105
Ar 10,106
Ar 11,107
Ar 12,108
Ar 13,109
Ar 14,110
Ar 15,111
Vm 8,8,22
Vm 9,9,22
Vm 10,10,22
Vm 11,11,22
Vm 12,12,22
Vm 13,13,22
Vm 14,14,22
Vm 15,15,22
Aw 104,8
Aw 105,9
Aw 106,10
Aw 107,11
Aw 108,12
Aw 109,13
Aw 110,14
Aw 111,15
Ar 8,112
Ar 9,113
Ar 10,114
Ar 11,115
Ar 12,116
Ar 13,117
Ar 14,118
Ar 15,119
Vm 8,8,22
Vm 9,9,22
Vm 10,10,22
Vm 11,11,22
Vm 12,12,22
Vm 13,13,22
Vm 14,14,22
Vm 15,15,22
Aw 112,8
Aw 113,9
Aw 114,10
Aw 115,11
Aw 116,12
Aw 117,13
Aw 118,14
Aw 119,15
Ar 8,120
Ar 9,121
Ar 10,122
Ar 11,123
Ar 12,124
Ar 13,125
Ar 14,126
Ar 15,127
Vm 8,8,22
Vm 9,9,22
Vm 10,10,22
Vm 11,11,22
Vm 12,12,22
Vm 13,13,22
Vm 14,14,22
Vm 15,15,22
Aw 120,8
Aw 121,9
Aw 122,10
Aw 123,11
Aw 124,12
Aw 125,13
Aw 126,14
Aw 127,15
Ve 8,128
Ve 9,129
s_nop 0
Vc 64,8,9
Ve 8,130
Ve 9,131
s_nop 0
Vc 65,8,9
Ve 8,144
Ve 9,145
s_nop 0
Vc 72,8,9
Ve 8,146
Ve 9,147
s_nop 0
Vc 73,8,9
Ve 8,160
Ve 9,161
s_nop 0
Vc 80,8,9
Ve 8,162
Ve 9,163
s_nop 0
Vc 81,8,9
Ve 8,176
Ve 9,177
s_nop 0
Vc 88,8,9
Ve 8,178
Ve 9,179
s_nop 0
Vc 89,8,9
Ve 8,132
Ve 9,133
s_nop 0
Vc 66,8,9
Ve 8,134
Ve 9,135
s_nop 0
Vc 67,8,9
Ve 8,148
Ve 9,149
s_nop 0
Vc 74,8,9
Ve 8,150
Ve 9,151
s_nop 0
Vc 75,8,9
Ve 8,164
Ve 9,165
s_nop 0
Vc 82,8,9
Ve 8,166
Ve 9,167
s_nop 0
Vc 83,8,9
Ve 8,180
Ve 9,181
s_nop 0
Vc 90,8,9
Ve 8,182
Ve 9,183
s_nop 0
Vc 91,8,9
Ve 8,136
Ve 9,137
s_nop 0
Vc 68,8,9
Ve 8,138
Ve 9,139
s_nop 0
Vc 69,8,9
Ve 8,152
Ve 9,153
s_nop 0
Vc 76,8,9
Ve 8,154
Ve 9,155
s_nop 0
Vc 77,8,9
Ve 8,168
Ve 9,169
s_nop 0
Vc 84,8,9
Ve 8,170
Ve 9,171
s_nop 0
Vc 85,8,9
Ve 8,184
Ve 9,185
s_nop 0
Vc 92,8,9
Ve 8,186
Ve 9,187
s_nop 0
Vc 93,8,9
Ve 8,140
Ve 9,141
s_nop 0
Vc 70,8,9
Ve 8,142
Ve 9,143
s_nop 0
Vc 71,8,9
Ve 8,156
Ve 9,157
s_nop 0
Vc 78,8,9
Ve 8,158
Ve 9,159
s_nop 0
Vc 79,8,9
Ve 8,172
Ve 9,173
s_nop 0
Vc 86,8,9
Ve 8,174
Ve 9,175
s_nop 0
Vc 87,8,9
Ve 8,188
Ve 9,189
s_nop 0
Vc 94,8,9
Ve 8,190
Ve 9,191
s_nop 0
Vc 95,8,9
s_nop 1
s_branch L_k2_fbr_we
L_k2_fb_wo:
s_nop 7
s_nop 0
v_max3_f32 v21, v192, v193, v194
v_max3_f32 v21, v21, v195, v196
v_max3_f32 v21, v21, v197, v198
v_max3_f32 v21, v21, v199, v200
v_max3_f32 v21, v21, v201, v202
v_max3_f32 v21, v21, v203, v204
v_max3_f32 v21, v21, v205, v206
v_max_f32 v21, v21, v207
v_mov_b32 v1, v21
s_nop 1
v_permlane16_swap_b32 v1, v21
v_max_f32 v21, v21, v1
v_mov_b32 v1, v21
s_nop 1
v_permlane32_swap_b32 v1, v21
v_max_f32_e64 v21, v21, v1
v_add_f32 v21, 0x41f80000, v21
v_max_f32 v21, 0, v21
Vs 192,192,21
Vs 193,193,21
Vs 194,194,21
Vs 195,195,21
Vs 196,196,21
Vs 197,197,21
Vs 198,198,21
Vs 199,199,21
Vs 200,200,21
Vs 201,201,21
Vs 202,202,21
Vs 203,203,21
Vs 204,204,21
Vs 205,205,21
Vs 206,206,21
Vs 207,207,21
Vs 128,128,21
Vs 129,129,21
Vs 130,130,21
Vs 131,131,21
Vs 132,132,21
Vs 133,133,21
Vs 134,134,21
Vs 135,135,21
Vs 136,136,21
Vs 137,137,21
Vs 138,138,21
Vs 139,139,21
Vs 140,140,21
Vs 141,141,21
Vs 142,142,21
Vs 143,143,21
Vs 32,32,21
Vs 33,33,21
Vs 34,34,21
v_sub_f32_e64 v35, v35, v21
v_exp_f32 v22, -v21
s_nop 0
Vm 48,48,22
Vm 49,49,22
Vm 50,50,22
v_mul_f32_e64 v51, v51, v22
Ar 8,0
Ar 9,1
Ar 10,2
Ar 11,3
Ar 12,4
Ar 13,5
Ar 14,6
Ar 15,7
Vm 8,8,22
Vm 9,9,22
Vm 10,10,22
Vm 11,11,22
Vm 12,12,22
Vm 13,13,22
Vm 14,14,22
Vm 15,15,22
Aw 0,8
Aw 1,9
Aw 2,10
Aw 3,11
Aw 4,12
Aw 5,13
Aw 6,14
Aw 7,15
Ar 8,8
Ar 9,9
Ar 10,10
Ar 11,11
Ar 12,12
Ar 13,13
Ar 14,14
Ar 15,15
Vm 8,8,22
Vm 9,9,22
Vm 10,10,22
Vm 11,11,22
Vm 12,12,22
Vm 13,13,22
Vm 14,14,22
Vm 15,15,22
Aw 8,8
Aw 9,9
Aw 10,10
Aw 11,11
Aw 12,12
Aw 13,13
Aw 14,14
Aw 15,15
Ar 8,16
Ar 9,17
Ar 10,18
Ar 11,19
Ar 12,20
Ar 13,21
Ar 14,22
Ar 15,23
Vm 8,8,22
Vm 9,9,22
Vm 10,10,22
Vm 11,11,22
Vm 12,12,22
Vm 13,13,22
Vm 14,14,22
Vm 15,15,22
Aw 16,8
Aw 17,9
Aw 18,10
Aw 19,11
Aw 20,12
Aw 21,13
Aw 22,14
Aw 23,15
Ar 8,24
Ar 9,25
Ar 10,26
Ar 11,27
Ar 12,28
Ar 13,29
Ar 14,30
Ar 15,31
Vm 8,8,22
Vm 9,9,22
Vm 10,10,22
Vm 11,11,22
Vm 12,12,22
Vm 13,13,22
Vm 14,14,22
Vm 15,15,22
Aw 24,8
Aw 25,9
Aw 26,10
Aw 27,11
Aw 28,12
Aw 29,13
Aw 30,14
Aw 31,15
v_max3_f32 v21, v208, v209, v210
v_max3_f32 v21, v21, v211, v212
v_max3_f32 v21, v21, v213, v214
v_max3_f32 v21, v21, v215, v216
v_max3_f32 v21, v21, v217, v218
v_max3_f32 v21, v21, v219, v220
v_max3_f32 v21, v21, v221, v222
v_max_f32 v21, v21, v223
v_mov_b32 v1, v21
s_nop 1
v_permlane16_swap_b32 v1, v21
v_max_f32 v21, v21, v1
v_mov_b32 v1, v21
s_nop 1
v_permlane32_swap_b32 v1, v21
v_max_f32_e64 v21, v21, v1
v_add_f32 v21, 0x41f80000, v21
v_max_f32 v21, 0, v21
Vs 208,208,21
Vs 209,209,21
Vs 210,210,21
Vs 211,211,21
Vs 212,212,21
Vs 213,213,21
Vs 214,214,21
Vs 215,215,21
Vs 216,216,21
Vs 217,217,21
Vs 218,218,21
Vs 219,219,21
Vs 220,220,21
Vs 221,221,21
Vs 222,222,21
Vs 223,223,21
Vs 144,144,21
Vs 145,145,21
Vs 146,146,21
Vs 147,147,21
Vs 148,148,21
Vs 149,149,21
Vs 150,150,21
Vs 151,151,21
Vs 152,152,21
Vs 153,153,21
Vs 154,154,21
Vs 155,155,21
Vs 156,156,21
Vs 157,157,21
Vs 158,158,21
Vs 159,159,21
Vs 36,36,21
Vs 37,37,21
Vs 38,38,21
v_sub_f32_e64 v39, v39, v21
v_exp_f32 v22, -v21
s_nop 0
Vm 52,52,22
Vm 53,53,22
Vm 54,54,22
v_mul_f32_e64 v55, v55, v22
Ar 8,32
Ar 9,33
Ar 10,34
Ar 11,35
Ar 12,36
Ar 13,37
Ar 14,38
Ar 15,39
Vm 8,8,22
Vm 9,9,22
Vm 10,10,22
Vm 11,11,22
Vm 12,12,22
Vm 13,13,22
Vm 14,14,22
Vm 15,15,22
Aw 32,8
Aw 33,9
Aw 34,10
Aw 35,11
Aw 36,12
Aw 37,13
Aw 38,14
Aw 39,15
Ar 8,40
Ar 9,41
Ar 10,42
Ar 11,43
Ar 12,44
Ar 13,45
Ar 14,46
Ar 15,47
Vm 8,8,22
Vm 9,9,22
Vm 10,10,22
Vm 11,11,22
Vm 12,12,22
Vm 13,13,22
Vm 14,14,22
Vm 15,15,22
Aw 40,8
Aw 41,9
Aw 42,10
Aw 43,11
Aw 44,12
Aw 45,13
Aw 46,14
Aw 47,15
Ar 8,48
Ar 9,49
Ar 10,50
Ar 11,51
Ar 12,52
Ar 13,53
Ar 14,54
Ar 15,55
Vm 8,8,22
Vm 9,9,22
Vm 10,10,22
Vm 11,11,22
Vm 12,12,22
Vm 13,13,22
Vm 14,14,22
Vm 15,15,22
Aw 48,8
Aw 49,9
Aw 50,10
Aw 51,11
Aw 52,12
Aw 53,13
Aw 54,14
Aw 55,15
Ar 8,56
Ar 9,57
Ar 10,58
Ar 11,59
Ar 12,60
Ar 13,61
Ar 14,62
Ar 15,63
Vm 8,8,22
Vm 9,9,22
Vm 10,10,22
Vm 11,11,22
Vm 12,12,22
Vm 13,13,22
Vm 14,14,22
Vm 15,15,22
Aw 56,8
Aw 57,9
Aw 58,10
Aw 59,11
Aw 60,12
Aw 61,13
Aw 62,14
Aw 63,15
v_max3_f32 v21, v224, v225, v226
v_max3_f32 v21, v21, v227, v228
v_max3_f32 v21, v21, v229, v230
v_max3_f32 v21, v21, v231, v232
v_max3_f32 v21, v21, v233, v234
v_max3_f32 v21, v21, v235, v236
v_max3_f32 v21, v21, v237, v238
v_max_f32 v21, v21, v239
v_mov_b32 v1, v21
s_nop 1
v_permlane16_swap_b32 v1, v21
v_max_f32 v21, v21, v1
v_mov_b32 v1, v21
s_nop 1
v_permlane32_swap_b32 v1, v21
v_max_f32_e64 v21, v21, v1
v_add_f32 v21, 0x41f80000, v21
v_max_f32 v21, 0, v21
Vs 224,224,21
Vs 225,225,21
Vs 226,226,21
Vs 227,227,21
Vs 228,228,21
Vs 229,229,21
Vs 230,230,21
Vs 231,231,21
Vs 232,232,21
Vs 233,233,21
Vs 234,234,21
Vs 235,235,21
Vs 236,236,21
Vs 237,237,21
Vs 238,238,21
Vs 239,239,21
Vs 160,160,21
Vs 161,161,21
Vs 162,162,21
Vs 163,163,21
Vs 164,164,21
Vs 165,165,21
Vs 166,166,21
Vs 167,167,21
Vs 168,168,21
Vs 169,169,21
Vs 170,170,21
Vs 171,171,21
Vs 172,172,21
Vs 173,173,21
Vs 174,174,21
Vs 175,175,21
Vs 40,40,21
Vs 41,41,21
Vs 42,42,21
v_sub_f32_e64 v43, v43, v21
v_exp_f32 v22, -v21
s_nop 0
Vm 56,56,22
Vm 57,57,22
Vm 58,58,22
v_mul_f32_e64 v59, v59, v22
Ar 8,64
Ar 9,65
Ar 10,66
Ar 11,67
Ar 12,68
Ar 13,69
Ar 14,70
Ar 15,71
Vm 8,8,22
Vm 9,9,22
Vm 10,10,22
Vm 11,11,22
Vm 12,12,22
Vm 13,13,22
Vm 14,14,22
Vm 15,15,22
Aw 64,8
Aw 65,9
Aw 66,10
Aw 67,11
Aw 68,12
Aw 69,13
Aw 70,14
Aw 71,15
Ar 8,72
Ar 9,73
Ar 10,74
Ar 11,75
Ar 12,76
Ar 13,77
Ar 14,78
Ar 15,79
Vm 8,8,22
Vm 9,9,22
Vm 10,10,22
Vm 11,11,22
Vm 12,12,22
Vm 13,13,22
Vm 14,14,22
Vm 15,15,22
Aw 72,8
Aw 73,9
Aw 74,10
Aw 75,11
Aw 76,12
Aw 77,13
Aw 78,14
Aw 79,15
Ar 8,80
Ar 9,81
Ar 10,82
Ar 11,83
Ar 12,84
Ar 13,85
Ar 14,86
Ar 15,87
Vm 8,8,22
Vm 9,9,22
Vm 10,10,22
Vm 11,11,22
Vm 12,12,22
Vm 13,13,22
Vm 14,14,22
Vm 15,15,22
Aw 80,8
Aw 81,9
Aw 82,10
Aw 83,11
Aw 84,12
Aw 85,13
Aw 86,14
Aw 87,15
Ar 8,88
Ar 9,89
Ar 10,90
Ar 11,91
Ar 12,92
Ar 13,93
Ar 14,94
Ar 15,95
Vm 8,8,22
Vm 9,9,22
Vm 10,10,22
Vm 11,11,22
Vm 12,12,22
Vm 13,13,22
Vm 14,14,22
Vm 15,15,22
Aw 88,8
Aw 89,9
Aw 90,10
Aw 91,11
Aw 92,12
Aw 93,13
Aw 94,14
Aw 95,15
v_max3_f32 v21, v240, v241, v242
v_max3_f32 v21, v21, v243, v244
v_max3_f32 v21, v21, v245, v246
v_max3_f32 v21, v21, v247, v248
v_max3_f32 v21, v21, v249, v250
v_max3_f32 v21, v21, v251, v252
v_max3_f32 v21, v21, v253, v254
v_max_f32 v21, v21, v255
v_mov_b32 v1, v21
s_nop 1
v_permlane16_swap_b32 v1, v21
v_max_f32 v21, v21, v1
v_mov_b32 v1, v21
s_nop 1
v_permlane32_swap_b32 v1, v21
v_max_f32_e64 v21, v21, v1
v_add_f32 v21, 0x41f80000, v21
v_max_f32 v21, 0, v21
Vs 240,240,21
Vs 241,241,21
Vs 242,242,21
Vs 243,243,21
Vs 244,244,21
Vs 245,245,21
Vs 246,246,21
Vs 247,247,21
Vs 248,248,21
Vs 249,249,21
Vs 250,250,21
Vs 251,251,21
Vs 252,252,21
Vs 253,253,21
Vs 254,254,21
Vs 255,255,21
Vs 176,176,21
Vs 177,177,21
Vs 178,178,21
Vs 179,179,21
Vs 180,180,21
Vs 181,181,21
Vs 182,182,21
Vs 183,183,21
Vs 184,184,21
Vs 185,185,21
Vs 186,186,21
Vs 187,187,21
Vs 188,188,21
Vs 189,189,21
Vs 190,190,21
Vs 191,191,21
Vs 44,44,21
Vs 45,45,21
Vs 46,46,21
v_sub_f32_e64 v47, v47, v21
v_exp_f32 v22, -v21
s_nop 0
Vm 60,60,22
Vm 61,61,22
Vm 62,62,22
v_mul_f32_e64 v63, v63, v22
Ar 8,96
Ar 9,97
Ar 10,98
Ar 11,99
Ar 12,100
Ar 13,101
Ar 14,102
Ar 15,103
Vm 8,8,22
Vm 9,9,22
Vm 10,10,22
Vm 11,11,22
Vm 12,12,22
Vm 13,13,22
Vm 14,14,22
Vm 15,15,22
Aw 96,8
Aw 97,9
Aw 98,10
Aw 99,11
Aw 100,12
Aw 101,13
Aw 102,14
Aw 103,15
Ar 8,104
Ar 9,105
Ar 10,106
Ar 11,107
Ar 12,108
Ar 13,109
Ar 14,110
Ar 15,111
Vm 8,8,22
Vm 9,9,22
Vm 10,10,22
Vm 11,11,22
Vm 12,12,22
Vm 13,13,22
Vm 14,14,22
Vm 15,15,22
Aw 104,8
Aw 105,9
Aw 106,10
Aw 107,11
Aw 108,12
Aw 109,13
Aw 110,14
Aw 111,15
Ar 8,112
Ar 9,113
Ar 10,114
Ar 11,115
Ar 12,116
Ar 13,117
Ar 14,118
Ar 15,119
Vm 8,8,22
Vm 9,9,22
Vm 10,10,22
Vm 11,11,22
Vm 12,12,22
Vm 13,13,22
Vm 14,14,22
Vm 15,15,22
Aw 112,8
Aw 113,9
Aw 114,10
Aw 115,11
Aw 116,12
Aw 117,13
Aw 118,14
Aw 119,15
Ar 8,120
Ar 9,121
Ar 10,122
Ar 11,123
Ar 12,124
Ar 13,125
Ar 14,126
Ar 15,127
Vm 8,8,22
Vm 9,9,22
Vm 10,10,22
Vm 11,11,22
Vm 12,12,22
Vm 13,13,22
Vm 14,14,22
Vm 15,15,22
Aw 120,8
Aw 121,9
Aw 122,10
Aw 123,11
Aw 124,12
Aw 125,13
Aw 126,14
Aw 127,15
Ve 8,192
Ve 9,193
s_nop 0
Vc 96,8,9
Ve 8,194
Ve 9,195
s_nop 0
Vc 97,8,9
Ve 8,208
Ve 9,209
s_nop 0
Vc 104,8,9
Ve 8,210
Ve 9,211
s_nop 0
Vc 105,8,9
Ve 8,224
Ve 9,225
s_nop 0
Vc 112,8,9
Ve 8,226
Ve 9,227
s_nop 0
Vc 113,8,9
Ve 8,240
Ve 9,241
s_nop 0
Vc 120,8,9
Ve 8,242
Ve 9,243
s_nop 0
Vc 121,8,9
Ve 8,196
Ve 9,197
s_nop 0
Vc 98,8,9
Ve 8,198
Ve 9,199
s_nop 0
Vc 99,8,9
Ve 8,212
Ve 9,213
s_nop 0
Vc 106,8,9
Ve 8,214
Ve 9,215
s_nop 0
Vc 107,8,9
Ve 8,228
Ve 9,229
s_nop 0
Vc 114,8,9
Ve 8,230
Ve 9,231
s_nop 0
Vc 115,8,9
Ve 8,244
Ve 9,245
s_nop 0
Vc 122,8,9
Ve 8,246
Ve 9,247
s_nop 0
Vc 123,8,9
Ve 8,200
Ve 9,201
s_nop 0
Vc 100,8,9
Ve 8,202
Ve 9,203
s_nop 0
Vc 101,8,9
Ve 8,216
Ve 9,217
s_nop 0
Vc 108,8,9
Ve 8,218
Ve 9,219
s_nop 0
Vc 109,8,9
Ve 8,232
Ve 9,233
s_nop 0
Vc 116,8,9
Ve 8,234
Ve 9,235
s_nop 0
Vc 117,8,9
Ve 8,248
Ve 9,249
s_nop 0
Vc 124,8,9
Ve 8,250
Ve 9,251
s_nop 0
Vc 125,8,9
Ve 8,204
Ve 9,205
s_nop 0
Vc 102,8,9
Ve 8,206
Ve 9,207
s_nop 0
Vc 103,8,9
Ve 8,220
Ve 9,221
s_nop 0
Vc 110,8,9
Ve 8,222
Ve 9,223
s_nop 0
Vc 111,8,9
Ve 8,236
Ve 9,237
s_nop 0
Vc 118,8,9
Ve 8,238
Ve 9,239
s_nop 0
Vc 119,8,9
Ve 8,252
Ve 9,253
s_nop 0
Vc 126,8,9
Ve 8,254
Ve 9,255
s_nop 0
Vc 127,8,9
s_nop 1
s_branch L_k2_fbr_wo
L_k2_fb_wl:
s_nop 7
s_nop 0
v_max3_f32 v21, v128, v129, v130
v_max3_f32 v21, v21, v131, v132
v_max3_f32 v21, v21, v133, v134
v_max3_f32 v21, v21, v135, v136
v_max3_f32 v21, v21, v137, v138
v_max3_f32 v21, v21, v139, v140
v_max3_f32 v21, v21, v141, v142
v_max_f32 v21, v21, v143
v_mov_b32 v1, v21
s_nop 1
v_permlane16_swap_b32 v1, v21
v_max_f32 v21, v21, v1
v_mov_b32 v1, v21
s_nop 1
v_permlane32_swap_b32 v1, v21
v_max_f32_e64 v21, v21, v1
v_add_f32 v21, 0x41f80000, v21
v_max_f32 v21, 0, v21
Vs 128,128,21
Vs 129,129,21
Vs 130,130,21
Vs 131,131,21
Vs 132,132,21
Vs 133,133,21
Vs 134,134,21
Vs 135,135,21
Vs 136,136,21
Vs 137,137,21
Vs 138,138,21
Vs 139,139,21
Vs 140,140,21
Vs 141,141,21
Vs 142,142,21
Vs 143,143,21
Vs 192,192,21
Vs 193,193,21
Vs 194,194,21
Vs 195,195,21
Vs 196,196,21
Vs 197,197,21
Vs 198,198,21
Vs 199,199,21
Vs 200,200,21
Vs 201,201,21
Vs 202,202,21
Vs 203,203,21
Vs 204,204,21
Vs 205,205,21
Vs 206,206,21
Vs 207,207,21
Vs 32,32,21
Vs 33,33,21
Vs 34,34,21
v_sub_f32_e64 v35, v35, v21
v_exp_f32 v22, -v21
s_nop 0
Vm 48,48,22
Vm 49,49,22
Vm 50,50,22
v_mul_f32_e64 v51, v51, v22
Ar 8,0
Ar 9,1
Ar 10,2
Ar 11,3
Ar 12,4
Ar 13,5
Ar 14,6
Ar 15,7
Vm 8,8,22
Vm 9,9,22
Vm 10,10,22
Vm 11,11,22
Vm 12,12,22
Vm 13,13,22
Vm 14,14,22
Vm 15,15,22
Aw 0,8
Aw 1,9
Aw 2,10
Aw 3,11
Aw 4,12
Aw 5,13
Aw 6,14
Aw 7,15
Ar 8,8
Ar 9,9
Ar 10,10
Ar 11,11
Ar 12,12
Ar 13,13
Ar 14,14
Ar 15,15
Vm 8,8,22
Vm 9,9,22
Vm 10,10,22
Vm 11,11,22
Vm 12,12,22
Vm 13,13,22
Vm 14,14,22
Vm 15,15,22
Aw 8,8
Aw 9,9
Aw 10,10
Aw 11,11
Aw 12,12
Aw 13,13
Aw 14,14
Aw 15,15
Ar 8,16
Ar 9,17
Ar 10,18
Ar 11,19
Ar 12,20
Ar 13,21
Ar 14,22
Ar 15,23
Vm 8,8,22
Vm 9,9,22
Vm 10,10,22
Vm 11,11,22
Vm 12,12,22
Vm 13,13,22
Vm 14,14,22
Vm 15,15,22
Aw 16,8
Aw 17,9
Aw 18,10
Aw 19,11
Aw 20,12
Aw 21,13
Aw 22,14
Aw 23,15
Ar 8,24
Ar 9,25
Ar 10,26
Ar 11,27
Ar 12,28
Ar 13,29
Ar 14,30
Ar 15,31
Vm 8,8,22
Vm 9,9,22
Vm 10,10,22
Vm 11,11,22
Vm 12,12,22
Vm 13,13,22
Vm 14,14,22
Vm 15,15,22
Aw 24,8
Aw 25,9
Aw 26,10
Aw 27,11
Aw 28,12
Aw 29,13
Aw 30,14
Aw 31,15
v_max3_f32 v21, v144, v145, v146
v_max3_f32 v21, v21, v147, v148
v_max3_f32 v21, v21, v149, v150
v_max3_f32 v21, v21, v151, v152
v_max3_f32 v21, v21, v153, v154
v_max3_f32 v21, v21, v155, v156
v_max3_f32 v21, v21, v157, v158
v_max_f32 v21, v21, v159
v_mov_b32 v1, v21
s_nop 1
v_permlane16_swap_b32 v1, v21
v_max_f32 v21, v21, v1
v_mov_b32 v1, v21
s_nop 1
v_permlane32_swap_b32 v1, v21
v_max_f32_e64 v21, v21, v1
v_add_f32 v21, 0x41f80000, v21
v_max_f32 v21, 0, v21
Vs 144,144,21
Vs 145,145,21
Vs 146,146,21
Vs 147,147,21
Vs 148,148,21
Vs 149,149,21
Vs 150,150,21
Vs 151,151,21
Vs 152,152,21
Vs 153,153,21
Vs 154,154,21
Vs 155,155,21
Vs 156,156,21
Vs 157,157,21
Vs 158,158,21
Vs 159,159,21
Vs 208,208,21
Vs 209,209,21
Vs 210,210,21
Vs 211,211,21
Vs 212,212,21
Vs 213,213,21
Vs 214,214,21
Vs 215,215,21
Vs 216,216,21
Vs 217,217,21
Vs 218,218,21
Vs 219,219,21
Vs 220,220,21
Vs 221,221,21
Vs 222,222,21
Vs 223,223,21
Vs 36,36,21
Vs 37,37,21
Vs 38,38,21
v_sub_f32_e64 v39, v39, v21
v_exp_f32 v22, -v21
s_nop 0
Vm 52,52,22
Vm 53,53,22
Vm 54,54,22
v_mul_f32_e64 v55, v55, v22
Ar 8,32
Ar 9,33
Ar 10,34
Ar 11,35
Ar 12,36
Ar 13,37
Ar 14,38
Ar 15,39
Vm 8,8,22
Vm 9,9,22
Vm 10,10,22
Vm 11,11,22
Vm 12,12,22
Vm 13,13,22
Vm 14,14,22
Vm 15,15,22
Aw 32,8
Aw 33,9
Aw 34,10
Aw 35,11
Aw 36,12
Aw 37,13
Aw 38,14
Aw 39,15
Ar 8,40
Ar 9,41
Ar 10,42
Ar 11,43
Ar 12,44
Ar 13,45
Ar 14,46
Ar 15,47
Vm 8,8,22
Vm 9,9,22
Vm 10,10,22
Vm 11,11,22
Vm 12,12,22
Vm 13,13,22
Vm 14,14,22
Vm 15,15,22
Aw 40,8
Aw 41,9
Aw 42,10
Aw 43,11
Aw 44,12
Aw 45,13
Aw 46,14
Aw 47,15
Ar 8,48
Ar 9,49
Ar 10,50
Ar 11,51
Ar 12,52
Ar 13,53
Ar 14,54
Ar 15,55
Vm 8,8,22
Vm 9,9,22
Vm 10,10,22
Vm 11,11,22
Vm 12,12,22
Vm 13,13,22
Vm 14,14,22
Vm 15,15,22
Aw 48,8
Aw 49,9
Aw 50,10
Aw 51,11
Aw 52,12
Aw 53,13
Aw 54,14
Aw 55,15
Ar 8,56
Ar 9,57
Ar 10,58
Ar 11,59
Ar 12,60
Ar 13,61
Ar 14,62
Ar 15,63
Vm 8,8,22
Vm 9,9,22
Vm 10,10,22
Vm 11,11,22
Vm 12,12,22
Vm 13,13,22
Vm 14,14,22
Vm 15,15,22
Aw 56,8
Aw 57,9
Aw 58,10
Aw 59,11
Aw 60,12
Aw 61,13
Aw 62,14
Aw 63,15
v_max3_f32 v21, v160, v161, v162
v_max3_f32 v21, v21, v163, v164
v_max3_f32 v21, v21, v165, v166
v_max3_f32 v21, v21, v167, v168
v_max3_f32 v21, v21, v169, v170
v_max3_f32 v21, v21, v171, v172
v_max3_f32 v21, v21, v173, v174
v_max_f32 v21, v21, v175
v_mov_b32 v1, v21
s_nop 1
v_permlane16_swap_b32 v1, v21
v_max_f32 v21, v21, v1
v_mov_b32 v1, v21
s_nop 1
v_permlane32_swap_b32 v1, v21
v_max_f32_e64 v21, v21, v1
v_add_f32 v21, 0x41f80000, v21
v_max_f32 v21, 0, v21
Vs 160,160,21
Vs 161,161,21
Vs 162,162,21
Vs 163,163,21
Vs 164,164,21
Vs 165,165,21
Vs 166,166,21
Vs 167,167,21
Vs 168,168,21
Vs 169,169,21
Vs 170,170,21
Vs 171,171,21
Vs 172,172,21
Vs 173,173,21
Vs 174,174,21
Vs 175,175,21
Vs 224,224,21
Vs 225,225,21
Vs 226,226,21
Vs 227,227,21
Vs 228,228,21
Vs 229,229,21
Vs 230,230,21
Vs 231,231,21
Vs 232,232,21
Vs 233,233,21
Vs 234,234,21
Vs 235,235,21
Vs 236,236,21
Vs 237,237,21
Vs 238,238,21
Vs 239,239,21
Vs 40,40,21
Vs 41,41,21
Vs 42,42,21
v_sub_f32_e64 v43, v43, v21
v_exp_f32 v22, -v21
s_nop 0
Vm 56,56,22
Vm 57,57,22
Vm 58,58,22
v_mul_f32_e64 v59, v59, v22
Ar 8,64
Ar 9,65
Ar 10,66
Ar 11,67
Ar 12,68
Ar 13,69
Ar 14,70
Ar 15,71
Vm 8,8,22
Vm 9,9,22
Vm 10,10,22
Vm 11,11,22
Vm 12,12,22
Vm 13,13,22
Vm 14,14,22
Vm 15,15,22
Aw 64,8
Aw 65,9
Aw 66,10
Aw 67,11
Aw 68,12
Aw 69,13
Aw 70,14
Aw 71,15
Ar 8,72
Ar 9,73
Ar 10,74
Ar 11,75
Ar 12,76
Ar 13,77
Ar 14,78
Ar 15,79
Vm 8,8,22
Vm 9,9,22
Vm 10,10,22
Vm 11,11,22
Vm 12,12,22
Vm 13,13,22
Vm 14,14,22
Vm 15,15,22
Aw 72,8
Aw 73,9
Aw 74,10
Aw 75,11
Aw 76,12
Aw 77,13
Aw 78,14
Aw 79,15
Ar 8,80
Ar 9,81
Ar 10,82
Ar 11,83
Ar 12,84
Ar 13,85
Ar 14,86
Ar 15,87
Vm 8,8,22
Vm 9,9,22
Vm 10,10,22
Vm 11,11,22
Vm 12,12,22
Vm 13,13,22
Vm 14,14,22
Vm 15,15,22
Aw 80,8
Aw 81,9
Aw 82,10
Aw 83,11
Aw 84,12
Aw 85,13
Aw 86,14
Aw 87,15
Ar 8,88
Ar 9,89
Ar 10,90
Ar 11,91
Ar 12,92
Ar 13,93
Ar 14,94
Ar 15,95
Vm 8,8,22
Vm 9,9,22
Vm 10,10,22
Vm 11,11,22
Vm 12,12,22
Vm 13,13,22
Vm 14,14,22
Vm 15,15,22
Aw 88,8
Aw 89,9
Aw 90,10
Aw 91,11
Aw 92,12
Aw 93,13
Aw 94,14
Aw 95,15
v_max3_f32 v21, v176, v177, v178
v_max3_f32 v21, v21, v179, v180
v_max3_f32 v21, v21, v181, v182
v_max3_f32 v21, v21, v183, v184
v_max3_f32 v21, v21, v185, v186
v_max3_f32 v21, v21, v187, v188
v_max3_f32 v21, v21, v189, v190
v_max_f32 v21, v21, v191
v_mov_b32 v1, v21
s_nop 1
v_permlane16_swap_b32 v1, v21
v_max_f32 v21, v21, v1
v_mov_b32 v1, v21
s_nop 1
v_permlane32_swap_b32 v1, v21
v_max_f32_e64 v21, v21, v1
v_add_f32 v21, 0x41f80000, v21
v_max_f32 v21, 0, v21
Vs 176,176,21
Vs 177,177,21
Vs 178,178,21
Vs 179,179,21
Vs 180,180,21
Vs 181,181,21
Vs 182,182,21
Vs 183,183,21
Vs 184,184,21
Vs 185,185,21
Vs 186,186,21
Vs 187,187,21
Vs 188,188,21
Vs 189,189,21
Vs 190,190,21
Vs 191,191,21
Vs 44,44,21
Vs 45,45,21
Vs 46,46,21
v_sub_f32_e64 v47, v47, v21
v_exp_f32 v22, -v21
s_nop 0
Vm 60,60,22
Vm 61,61,22
Vm 62,62,22
v_mul_f32_e64 v63, v63, v22
Ar 8,96
Ar 9,97
Ar 10,98
Ar 11,99
Ar 12,100
Ar 13,101
Ar 14,102
Ar 15,103
Vm 8,8,22
Vm 9,9,22
Vm 10,10,22
Vm 11,11,22
Vm 12,12,22
Vm 13,13,22
Vm 14,14,22
Vm 15,15,22
Aw 96,8
Aw 97,9
Aw 98,10
Aw 99,11
Aw 100,12
Aw 101,13
Aw 102,14
Aw 103,15
Ar 8,104
Ar 9,105
Ar 10,106
Ar 11,107
Ar 12,108
Ar 13,109
Ar 14,110
Ar 15,111
Vm 8,8,22
Vm 9,9,22
Vm 10,10,22
Vm 11,11,22
Vm 12,12,22
Vm 13,13,22
Vm 14,14,22
Vm 15,15,22
Aw 104,8
Aw 105,9
Aw 106,10
Aw 107,11
Aw 108,12
Aw 109,13
Aw 110,14
Aw 111,15
Ar 8,112
Ar 9,113
Ar 10,114
Ar 11,115
Ar 12,116
Ar 13,117
Ar 14,118
Ar 15,119
Vm 8,8,22
Vm 9,9,22
Vm 10,10,22
Vm 11,11,22
Vm 12,12,22
Vm 13,13,22
Vm 14,14,22
Vm 15,15,22
Aw 112,8
Aw 113,9
Aw 114,10
Aw 115,11
Aw 116,12
Aw 117,13
Aw 118,14
Aw 119,15
Ar 8,120
Ar 9,121
Ar 10,122
Ar 11,123
Ar 12,124
Ar 13,125
Ar 14,126
Ar 15,127
Vm 8,8,22
Vm 9,9,22
Vm 10,10,22
Vm 11,11,22
Vm 12,12,22
Vm 13,13,22
Vm 14,14,22
Vm 15,15,22
Aw 120,8
Aw 121,9
Aw 122,10
Aw 123,11
Aw 124,12
Aw 125,13
Aw 126,14
Aw 127,15
Ve 8,128
Ve 9,129
s_nop 0
Vc 64,8,9
Ve 8,130
Ve 9,131
s_nop 0
Vc 65,8,9
Ve 8,144
Ve 9,145
s_nop 0
Vc 72,8,9
Ve 8,146
Ve 9,147
s_nop 0
Vc 73,8,9
Ve 8,160
Ve 9,161
s_nop 0
Vc 80,8,9
Ve 8,162
Ve 9,163
s_nop 0
Vc 81,8,9
Ve 8,176
Ve 9,177
s_nop 0
Vc 88,8,9
Ve 8,178
Ve 9,179
s_nop 0
Vc 89,8,9
Ve 8,132
Ve 9,133
s_nop 0
Vc 66,8,9
Ve 8,134
Ve 9,135
s_nop 0
Vc 67,8,9
Ve 8,148
Ve 9,149
s_nop 0
Vc 74,8,9
Ve 8,150
Ve 9,151
s_nop 0
Vc 75,8,9
Ve 8,164
Ve 9,165
s_nop 0
Vc 82,8,9
Ve 8,166
Ve 9,167
s_nop 0
Vc 83,8,9
Ve 8,180
Ve 9,181
s_nop 0
Vc 90,8,9
Ve 8,182
Ve 9,183
s_nop 0
Vc 91,8,9
Ve 8,136
Ve 9,137
s_nop 0
Vc 68,8,9
Ve 8,138
Ve 9,139
s_nop 0
Vc 69,8,9
Ve 8,152
Ve 9,153
s_nop 0
Vc 76,8,9
Ve 8,154
Ve 9,155
s_nop 0
Vc 77,8,9
Ve 8,168
Ve 9,169
s_nop 0
Vc 84,8,9
Ve 8,170
Ve 9,171
s_nop 0
Vc 85,8,9
Ve 8,184
Ve 9,185
s_nop 0
Vc 92,8,9
Ve 8,186
Ve 9,187
s_nop 0
Vc 93,8,9
Ve 8,140
Ve 9,141
s_nop 0
Vc 70,8,9
Ve 8,142
Ve 9,143
s_nop 0
Vc 71,8,9
Ve 8,156
Ve 9,157
s_nop 0
Vc 78,8,9
Ve 8,158
Ve 9,159
s_nop 0
Vc 79,8,9
Ve 8,172
Ve 9,173
s_nop 0
Vc 86,8,9
Ve 8,174
Ve 9,175
s_nop 0
Vc 87,8,9
Ve 8,188
Ve 9,189
s_nop 0
Vc 94,8,9
Ve 8,190
Ve 9,191
s_nop 0
Vc 95,8,9
s_nop 1
s_branch L_k2_fbr_wl
L_k2_fb_tr:
s_nop 7
s_nop 0
v_max3_f32 v21, v192, v193, v194
v_max3_f32 v21, v21, v195, v196
v_max3_f32 v21, v21, v197, v198
v_max3_f32 v21, v21, v199, v200
v_max3_f32 v21, v21, v201, v202
v_max3_f32 v21, v21, v203, v204
v_max3_f32 v21, v21, v205, v206
v_max_f32 v21, v21, v207
v_mov_b32 v1, v21
s_nop 1
v_permlane16_swap_b32 v1, v21
v_max_f32 v21, v21, v1
v_mov_b32 v1, v21
s_nop 1
v_permlane32_swap_b32 v1, v21
v_max_f32_e64 v21, v21, v1
v_add_f32 v21, 0x41f80000, v21
v_max_f32 v21, 0, v21
Vs 192,192,21
Vs 193,193,21
Vs 194,194,21
Vs 195,195,21
Vs 196,196,21
Vs 197,197,21
Vs 198,198,21
Vs 199,199,21
Vs 200,200,21
Vs 201,201,21
Vs 202,202,21
Vs 203,203,21
Vs 204,204,21
Vs 205,205,21
Vs 206,206,21
Vs 207,207,21
Vs 128,128,21
Vs 129,129,21
Vs 130,130,21
Vs 131,131,21
Vs 132,132,21
Vs 133,133,21
Vs 134,134,21
Vs 135,135,21
Vs 136,136,21
Vs 137,137,21
Vs 138,138,21
Vs 139,139,21
Vs 140,140,21
Vs 141,141,21
Vs 142,142,21
Vs 143,143,21
Vs 32,32,21
Vs 33,33,21
Vs 34,34,21
v_sub_f32_e64 v35, v35, v21
v_exp_f32 v22, -v21
s_nop 0
Vm 48,48,22
Vm 49,49,22
Vm 50,50,22
v_mul_f32_e64 v51, v51, v22
Ar 8,0
Ar 9,1
Ar 10,2
Ar 11,3
Ar 12,4
Ar 13,5
Ar 14,6
Ar 15,7
Vm 8,8,22
Vm 9,9,22
Vm 10,10,22
Vm 11,11,22
Vm 12,12,22
Vm 13,13,22
Vm 14,14,22
Vm 15,15,22
Aw 0,8
Aw 1,9
Aw 2,10
Aw 3,11
Aw 4,12
Aw 5,13
Aw 6,14
Aw 7,15
Ar 8,8
Ar 9,9
Ar 10,10
Ar 11,11
Ar 12,12
Ar 13,13
Ar 14,14
Ar 15,15
Vm 8,8,22
Vm 9,9,22
Vm 10,10,22
Vm 11,11,22
Vm 12,12,22
Vm 13,13,22
Vm 14,14,22
Vm 15,15,22
Aw 8,8
Aw 9,9
Aw 10,10
Aw 11,11
Aw 12,12
Aw 13,13
Aw 14,14
Aw 15,15
Ar 8,16
Ar 9,17
Ar 10,18
Ar 11,19
Ar 12,20
Ar 13,21
Ar 14,22
Ar 15,23
Vm 8,8,22
Vm 9,9,22
Vm 10,10,22
Vm 11,11,22
Vm 12,12,22
Vm 13,13,22
Vm 14,14,22
Vm 15,15,22
Aw 16,8
Aw 17,9
Aw 18,10
Aw 19,11
Aw 20,12
Aw 21,13
Aw 22,14
Aw 23,15
Ar 8,24
Ar 9,25
Ar 10,26
Ar 11,27
Ar 12,28
Ar 13,29
Ar 14,30
Ar 15,31
Vm 8,8,22
Vm 9,9,22
Vm 10,10,22
Vm 11,11,22
Vm 12,12,22
Vm 13,13,22
Vm 14,14,22
Vm 15,15,22
Aw 24,8
Aw 25,9
Aw 26,10
Aw 27,11
Aw 28,12
Aw 29,13
Aw 30,14
Aw 31,15
v_max3_f32 v21, v208, v209, v210
v_max3_f32 v21, v21, v211, v212
v_max3_f32 v21, v21, v213, v214
v_max3_f32 v21, v21, v215, v216
v_max3_f32 v21, v21, v217, v218
v_max3_f32 v21, v21, v219, v220
v_max3_f32 v21, v21, v221, v222
v_max_f32 v21, v21, v223
v_mov_b32 v1, v21
s_nop 1
v_permlane16_swap_b32 v1, v21
v_max_f32 v21, v21, v1
v_mov_b32 v1, v21
s_nop 1
v_permlane32_swap_b32 v1, v21
v_max_f32_e64 v21, v21, v1
v_add_f32 v21, 0x41f80000, v21
v_max_f32 v21, 0, v21
Vs 208,208,21
Vs 209,209,21
Vs 210,210,21
Vs 211,211,21
Vs 212,212,21
Vs 213,213,21
Vs 214,214,21
Vs 215,215,21
Vs 216,216,21
Vs 217,217,21
Vs 218,218,21
Vs 219,219,21
Vs 220,220,21
Vs 221,221,21
Vs 222,222,21
Vs 223,223,21
Vs 144,144,21
Vs 145,145,21
Vs 146,146,21
Vs 147,147,21
Vs 148,148,21
Vs 149,149,21
Vs 150,150,21
Vs 151,151,21
Vs 152,152,21
Vs 153,153,21
Vs 154,154,21
Vs 155,155,21
Vs 156,156,21
Vs 157,157,21
Vs 158,158,21
Vs 159,159,21
Vs 36,36,21
Vs 37,37,21
Vs 38,38,21
v_sub_f32_e64 v39, v39, v21
v_exp_f32 v22, -v21
s_nop 0
Vm 52,52,22
Vm 53,53,22
Vm 54,54,22
v_mul_f32_e64 v55, v55, v22
Ar 8,32
Ar 9,33
Ar 10,34
Ar 11,35
Ar 12,36
Ar 13,37
Ar 14,38
Ar 15,39
Vm 8,8,22
Vm 9,9,22
Vm 10,10,22
Vm 11,11,22
Vm 12,12,22
Vm 13,13,22
Vm 14,14,22
Vm 15,15,22
Aw 32,8
Aw 33,9
Aw 34,10
Aw 35,11
Aw 36,12
Aw 37,13
Aw 38,14
Aw 39,15
Ar 8,40
Ar 9,41
Ar 10,42
Ar 11,43
Ar 12,44
Ar 13,45
Ar 14,46
Ar 15,47
Vm 8,8,22
Vm 9,9,22
Vm 10,10,22
Vm 11,11,22
Vm 12,12,22
Vm 13,13,22
Vm 14,14,22
Vm 15,15,22
Aw 40,8
Aw 41,9
Aw 42,10
Aw 43,11
Aw 44,12
Aw 45,13
Aw 46,14
Aw 47,15
Ar 8,48
Ar 9,49
Ar 10,50
Ar 11,51
Ar 12,52
Ar 13,53
Ar 14,54
Ar 15,55
Vm 8,8,22
Vm 9,9,22
Vm 10,10,22
Vm 11,11,22
Vm 12,12,22
Vm 13,13,22
Vm 14,14,22
Vm 15,15,22
Aw 48,8
Aw 49,9
Aw 50,10
Aw 51,11
Aw 52,12
Aw 53,13
Aw 54,14
Aw 55,15
Ar 8,56
Ar 9,57
Ar 10,58
Ar 11,59
Ar 12,60
Ar 13,61
Ar 14,62
Ar 15,63
Vm 8,8,22
Vm 9,9,22
Vm 10,10,22
Vm 11,11,22
Vm 12,12,22
Vm 13,13,22
Vm 14,14,22
Vm 15,15,22
Aw 56,8
Aw 57,9
Aw 58,10
Aw 59,11
Aw 60,12
Aw 61,13
Aw 62,14
Aw 63,15
v_max3_f32 v21, v224, v225, v226
v_max3_f32 v21, v21, v227, v228
v_max3_f32 v21, v21, v229, v230
v_max3_f32 v21, v21, v231, v232
v_max3_f32 v21, v21, v233, v234
v_max3_f32 v21, v21, v235, v236
v_max3_f32 v21, v21, v237, v238
v_max_f32 v21, v21, v239
v_mov_b32 v1, v21
s_nop 1
v_permlane16_swap_b32 v1, v21
v_max_f32 v21, v21, v1
v_mov_b32 v1, v21
s_nop 1
v_permlane32_swap_b32 v1, v21
v_max_f32_e64 v21, v21, v1
v_add_f32 v21, 0x41f80000, v21
v_max_f32 v21, 0, v21
Vs 224,224,21
Vs 225,225,21
Vs 226,226,21
Vs 227,227,21
Vs 228,228,21
Vs 229,229,21
Vs 230,230,21
Vs 231,231,21
Vs 232,232,21
Vs 233,233,21
Vs 234,234,21
Vs 235,235,21
Vs 236,236,21
Vs 237,237,21
Vs 238,238,21
Vs 239,239,21
Vs 40,40,21
Vs 41,41,21
Vs 42,42,21
v_sub_f32_e64 v43, v43, v21
v_exp_f32 v22, -v21
s_nop 0
Vm 56,56,22
Vm 57,57,22
Vm 58,58,22
v_mul_f32_e64 v59, v59, v22
Ar 8,64
Ar 9,65
Ar 10,66
Ar 11,67
Ar 12,68
Ar 13,69
Ar 14,70
Ar 15,71
Vm 8,8,22
Vm 9,9,22
Vm 10,10,22
Vm 11,11,22
Vm 12,12,22
Vm 13,13,22
Vm 14,14,22
Vm 15,15,22
Aw 64,8
Aw 65,9
Aw 66,10
Aw 67,11
Aw 68,12
Aw 69,13
Aw 70,14
Aw 71,15
Ar 8,72
Ar 9,73
Ar 10,74
Ar 11,75
Ar 12,76
Ar 13,77
Ar 14,78
Ar 15,79
Vm 8,8,22
Vm 9,9,22
Vm 10,10,22
Vm 11,11,22
Vm 12,12,22
Vm 13,13,22
Vm 14,14,22
Vm 15,15,22
Aw 72,8
Aw 73,9
Aw 74,10
Aw 75,11
Aw 76,12
Aw 77,13
Aw 78,14
Aw 79,15
Ar 8,80
Ar 9,81
Ar 10,82
Ar 11,83
Ar 12,84
Ar 13,85
Ar 14,86
Ar 15,87
Vm 8,8,22
Vm 9,9,22
Vm 10,10,22
Vm 11,11,22
Vm 12,12,22
Vm 13,13,22
Vm 14,14,22
Vm 15,15,22
Aw 80,8
Aw 81,9
Aw 82,10
Aw 83,11
Aw 84,12
Aw 85,13
Aw 86,14
Aw 87,15
Ar 8,88
Ar 9,89
Ar 10,90
Ar 11,91
Ar 12,92
Ar 13,93
Ar 14,94
Ar 15,95
Vm 8,8,22
Vm 9,9,22
Vm 10,10,22
Vm 11,11,22
Vm 12,12,22
Vm 13,13,22
Vm 14,14,22
Vm 15,15,22
Aw 88,8
Aw 89,9
Aw 90,10
Aw 91,11
Aw 92,12
Aw 93,13
Aw 94,14
Aw 95,15
Ve 8,192
Ve 9,193
s_nop 0
Vc 96,8,9
Ve 8,194
Ve 9,195
s_nop 0
Vc 97,8,9
Ve 8,208
Ve 9,209
s_nop 0
Vc 104,8,9
Ve 8,210
Ve 9,211
s_nop 0
Vc 105,8,9
Ve 8,224
Ve 9,225
s_nop 0
Vc 112,8,9
Ve 8,226
Ve 9,227
s_nop 0
Vc 113,8,9
Ve 8,196
Ve 9,197
s_nop 0
Vc 98,8,9
Ve 8,198
Ve 9,199
s_nop 0
Vc 99,8,9
Ve 8,212
Ve 9,213
s_nop 0
Vc 106,8,9
Ve 8,214
Ve 9,215
s_nop 0
Vc 107,8,9
Ve 8,228
Ve 9,229
s_nop 0
Vc 114,8,9
Ve 8,230
Ve 9,231
s_nop 0
Vc 115,8,9
Ve 8,200
Ve 9,201
s_nop 0
Vc 100,8,9
Ve 8,202
Ve 9,203
s_nop 0
Vc 101,8,9
Ve 8,216
Ve 9,217
s_nop 0
Vc 108,8,9
Ve 8,218
Ve 9,219
s_nop 0
Vc 109,8,9
Ve 8,232
Ve 9,233
s_nop 0
Vc 116,8,9
Ve 8,234
Ve 9,235
s_nop 0
Vc 117,8,9
Ve 8,204
Ve 9,205
s_nop 0
Vc 102,8,9
Ve 8,206
Ve 9,207
s_nop 0
Vc 103,8,9
Ve 8,220
Ve 9,221
s_nop 0
Vc 110,8,9
Ve 8,222
Ve 9,223
s_nop 0
Vc 111,8,9
Ve 8,236
Ve 9,237
s_nop 0
Vc 118,8,9
Ve 8,238
Ve 9,239
s_nop 0
Vc 119,8,9
s_nop 1
s_branch L_k2_fbr_tr
L_k2_fb_ne:
s_nop 7
s_nop 0
v_max3_f32 v21, v128, v129, v130
v_max3_f32 v21, v21, v131, v132
v_max3_f32 v21, v21, v133, v134
v_max3_f32 v21, v21, v135, v136
v_max3_f32 v21, v21, v137, v138
v_max3_f32 v21, v21, v139, v140
v_max3_f32 v21, v21, v141, v142
v_max_f32 v21, v21, v143
v_mov_b32 v1, v21
s_nop 1
v_permlane16_swap_b32 v1, v21
v_max_f32 v21, v21, v1
v_mov_b32 v1, v21
s_nop 1
v_permlane32_swap_b32 v1, v21
v_max_f32_e64 v21, v21, v1
v_add_f32 v21, 0x41f80000, v21
v_max_f32 v21, 0, v21
Vs 128,128,21
Vs 129,129,21
Vs 130,130,21
Vs 131,131,21
Vs 132,132,21
Vs 133,133,21
Vs 134,134,21
Vs 135,135,21
Vs 136,136,21
Vs 137,137,21
Vs 138,138,21
Vs 139,139,21
Vs 140,140,21
Vs 141,141,21
Vs 142,142,21
Vs 143,143,21
Vs 192,192,21
Vs 193,193,21
Vs 194,194,21
Vs 195,195,21
Vs 196,196,21
Vs 197,197,21
Vs 198,198,21
Vs 199,199,21
Vs 200,200,21
Vs 201,201,21
Vs 202,202,21
Vs 203,203,21
Vs 204,204,21
Vs 205,205,21
Vs 206,206,21
Vs 207,207,21
Vs 32,32,21
Vs 33,33,21
Vs 34,34,21
v_sub_f32_e64 v35, v35, v21
v_exp_f32 v22, -v21
s_nop 0
Vm 48,48,22
Vm 49,49,22
Vm 50,50,22
v_mul_f32_e64 v51, v51, v22
Ar 8,0
Ar 9,1
Ar 10,2
Ar 11,3
Ar 12,4
Ar 13,5
Ar 14,6
Ar 15,7
Vm 8,8,22
Vm 9,9,22
Vm 10,10,22
Vm 11,11,22
Vm 12,12,22
Vm 13,13,22
Vm 14,14,22
Vm 15,15,22
Aw 0,8
Aw 1,9
Aw 2,10
Aw 3,11
Aw 4,12
Aw 5,13
Aw 6,14
Aw 7,15
Ar 8,8
Ar 9,9
Ar 10,10
Ar 11,11
Ar 12,12
Ar 13,13
Ar 14,14
Ar 15,15
Vm 8,8,22
Vm 9,9,22
Vm 10,10,22
Vm 11,11,22
Vm 12,12,22
Vm 13,13,22
Vm 14,14,22
Vm 15,15,22
Aw 8,8
Aw 9,9
Aw 10,10
Aw 11,11
Aw 12,12
Aw 13,13
Aw 14,14
Aw 15,15
Ar 8,16
Ar 9,17
Ar 10,18
Ar 11,19
Ar 12,20
Ar 13,21
Ar 14,22
Ar 15,23
Vm 8,8,22
Vm 9,9,22
Vm 10,10,22
Vm 11,11,22
Vm 12,12,22
Vm 13,13,22
Vm 14,14,22
Vm 15,15,22
Aw 16,8
Aw 17,9
Aw 18,10
Aw 19,11
Aw 20,12
Aw 21,13
Aw 22,14
Aw 23,15
Ar 8,24
Ar 9,25
Ar 10,26
Ar 11,27
Ar 12,28
Ar 13,29
Ar 14,30
Ar 15,31
Vm 8,8,22
Vm 9,9,22
Vm 10,10,22
Vm 11,11,22
Vm 12,12,22
Vm 13,13,22
Vm 14,14,22
Vm 15,15,22
Aw 24,8
Aw 25,9
Aw 26,10
Aw 27,11
Aw 28,12
Aw 29,13
Aw 30,14
Aw 31,15
v_max3_f32 v21, v144, v145, v146
v_max3_f32 v21, v21, v147, v148
v_max3_f32 v21, v21, v149, v150
v_max3_f32 v21, v21, v151, v152
v_max3_f32 v21, v21, v153, v154
v_max3_f32 v21, v21, v155, v156
v_max3_f32 v21, v21, v157, v158
v_max_f32 v21, v21, v159
v_mov_b32 v1, v21
s_nop 1
v_permlane16_swap_b32 v1, v21
v_max_f32 v21, v21, v1
v_mov_b32 v1, v21
s_nop 1
v_permlane32_swap_b32 v1, v21
v_max_f32_e64 v21, v21, v1
v_add_f32 v21, 0x41f80000, v21
v_max_f32 v21, 0, v21
Vs 144,144,21
Vs 145,145,21
Vs 146,146,21
Vs 147,147,21
Vs 148,148,21
Vs 149,149,21
Vs 150,150,21
Vs 151,151,21
Vs 152,152,21
Vs 153,153,21
Vs 154,154,21
Vs 155,155,21
Vs 156,156,21
Vs 157,157,21
Vs 158,158,21
Vs 159,159,21
Vs 208,208,21
Vs 209,209,21
Vs 210,210,21
Vs 211,211,21
Vs 212,212,21
Vs 213,213,21
Vs 214,214,21
Vs 215,215,21
Vs 216,216,21
Vs 217,217,21
Vs 218,218,21
Vs 219,219,21
Vs 220,220,21
Vs 221,221,21
Vs 222,222,21
Vs 223,223,21
Vs 36,36,21
Vs 37,37,21
Vs 38,38,21
v_sub_f32_e64 v39, v39, v21
v_exp_f32 v22, -v21
s_nop 0
Vm 52,52,22
Vm 53,53,22
Vm 54,54,22
v_mul_f32_e64 v55, v55, v22
Ar 8,32
Ar 9,33
Ar 10,34
Ar 11,35
Ar 12,36
Ar 13,37
Ar 14,38
Ar 15,39
Vm 8,8,22
Vm 9,9,22
Vm 10,10,22
Vm 11,11,22
Vm 12,12,22
Vm 13,13,22
Vm 14,14,22
Vm 15,15,22
Aw 32,8
Aw 33,9
Aw 34,10
Aw 35,11
Aw 36,12
Aw 37,13
Aw 38,14
Aw 39,15
Ar 8,40
Ar 9,41
Ar 10,42
Ar 11,43
Ar 12,44
Ar 13,45
Ar 14,46
Ar 15,47
Vm 8,8,22
Vm 9,9,22
Vm 10,10,22
Vm 11,11,22
Vm 12,12,22
Vm 13,13,22
Vm 14,14,22
Vm 15,15,22
Aw 40,8
Aw 41,9
Aw 42,10
Aw 43,11
Aw 44,12
Aw 45,13
Aw 46,14
Aw 47,15
Ar 8,48
Ar 9,49
Ar 10,50
Ar 11,51
Ar 12,52
Ar 13,53
Ar 14,54
Ar 15,55
Vm 8,8,22
Vm 9,9,22
Vm 10,10,22
Vm 11,11,22
Vm 12,12,22
Vm 13,13,22
Vm 14,14,22
Vm 15,15,22
Aw 48,8
Aw 49,9
Aw 50,10
Aw 51,11
Aw 52,12
Aw 53,13
Aw 54,14
Aw 55,15
Ar 8,56
Ar 9,57
Ar 10,58
Ar 11,59
Ar 12,60
Ar 13,61
Ar 14,62
Ar 15,63
Vm 8,8,22
Vm 9,9,22
Vm 10,10,22
Vm 11,11,22
Vm 12,12,22
Vm 13,13,22
Vm 14,14,22
Vm 15,15,22
Aw 56,8
Aw 57,9
Aw 58,10
Aw 59,11
Aw 60,12
Aw 61,13
Aw 62,14
Aw 63,15
Ve 8,128
Ve 9,129
s_nop 0
Vc 64,8,9
Ve 8,130
Ve 9,131
s_nop 0
Vc 65,8,9
Ve 8,144
Ve 9,145
s_nop 0
Vc 72,8,9
Ve 8,146
Ve 9,147
s_nop 0
Vc 73,8,9
Ve 8,132
Ve 9,133
s_nop 0
Vc 66,8,9
Ve 8,134
Ve 9,135
s_nop 0
Vc 67,8,9
Ve 8,148
Ve 9,149
s_nop 0
Vc 74,8,9
Ve 8,150
Ve 9,151
s_nop 0
Vc 75,8,9
Ve 8,136
Ve 9,137
s_nop 0
Vc 68,8,9
Ve 8,138
Ve 9,139
s_nop 0
Vc 69,8,9
Ve 8,152
Ve 9,153
s_nop 0
Vc 76,8,9
Ve 8,154
Ve 9,155
s_nop 0
Vc 77,8,9
Ve 8,140
Ve 9,141
s_nop 0
Vc 70,8,9
Ve 8,142
Ve 9,143
s_nop 0
Vc 71,8,9
Ve 8,156
Ve 9,157
s_nop 0
Vc 78,8,9
Ve 8,158
Ve 9,159
s_nop 0
Vc 79,8,9
s_nop 1
s_branch L_k2_fbr_ne
L_k2_fb_no:
s_nop 7
s_nop 0
v_max3_f32 v21, v192, v193, v194
v_max3_f32 v21, v21, v195, v196
v_max3_f32 v21, v21, v197, v198
v_max3_f32 v21, v21, v199, v200
v_max3_f32 v21, v21, v201, v202
v_max3_f32 v21, v21, v203, v204
v_max3_f32 v21, v21, v205, v206
v_max_f32 v21, v21, v207
v_mov_b32 v1, v21
s_nop 1
v_permlane16_swap_b32 v1, v21
v_max_f32 v21, v21, v1
v_mov_b32 v1, v21
s_nop 1
v_permlane32_swap_b32 v1, v21
v_max_f32_e64 v21, v21, v1
v_add_f32 v21, 0x41f80000, v21
v_max_f32 v21, 0, v21
Vs 192,192,21
Vs 193,193,21
Vs 194,194,21
Vs 195,195,21
Vs 196,196,21
Vs 197,197,21
Vs 198,198,21
Vs 199,199,21
Vs 200,200,21
Vs 201,201,21
Vs 202,202,21
Vs 203,203,21
Vs 204,204,21
Vs 205,205,21
Vs 206,206,21
Vs 207,207,21
Vs 128,128,21
Vs 129,129,21
Vs 130,130,21
Vs 131,131,21
Vs 132,132,21
Vs 133,133,21
Vs 134,134,21
Vs 135,135,21
Vs 136,136,21
Vs 137,137,21
Vs 138,138,21
Vs 139,139,21
Vs 140,140,21
Vs 141,141,21
Vs 142,142,21
Vs 143,143,21
Vs 32,32,21
Vs 33,33,21
Vs 34,34,21
v_sub_f32_e64 v35, v35, v21
v_exp_f32 v22, -v21
s_nop 0
Vm 48,48,22
Vm 49,49,22
Vm 50,50,22
v_mul_f32_e64 v51, v51, v22
Ar 8,0
Ar 9,1
Ar 10,2
Ar 11,3
Ar 12,4
Ar 13,5
Ar 14,6
Ar 15,7
Vm 8,8,22
Vm 9,9,22
Vm 10,10,22
Vm 11,11,22
Vm 12,12,22
Vm 13,13,22
Vm 14,14,22
Vm 15,15,22
Aw 0,8
Aw 1,9
Aw 2,10
Aw 3,11
Aw 4,12
Aw 5,13
Aw 6,14
Aw 7,15
Ar 8,8
Ar 9,9
Ar 10,10
Ar 11,11
Ar 12,12
Ar 13,13
Ar 14,14
Ar 15,15
Vm 8,8,22
Vm 9,9,22
Vm 10,10,22
Vm 11,11,22
Vm 12,12,22
Vm 13,13,22
Vm 14,14,22
Vm 15,15,22
Aw 8,8
Aw 9,9
Aw 10,10
Aw 11,11
Aw 12,12
Aw 13,13
Aw 14,14
Aw 15,15
Ar 8,16
Ar 9,17
Ar 10,18
Ar 11,19
Ar 12,20
Ar 13,21
Ar 14,22
Ar 15,23
Vm 8,8,22
Vm 9,9,22
Vm 10,10,22
Vm 11,11,22
Vm 12,12,22
Vm 13,13,22
Vm 14,14,22
Vm 15,15,22
Aw 16,8
Aw 17,9
Aw 18,10
Aw 19,11
Aw 20,12
Aw 21,13
Aw 22,14
Aw 23,15
Ar 8,24
Ar 9,25
Ar 10,26
Ar 11,27
Ar 12,28
Ar 13,29
Ar 14,30
Ar 15,31
Vm 8,8,22
Vm 9,9,22
Vm 10,10,22
Vm 11,11,22
Vm 12,12,22
Vm 13,13,22
Vm 14,14,22
Vm 15,15,22
Aw 24,8
Aw 25,9
Aw 26,10
Aw 27,11
Aw 28,12
Aw 29,13
Aw 30,14
Aw 31,15
v_max3_f32 v21, v208, v209, v210
v_max3_f32 v21, v21, v211, v212
v_max3_f32 v21, v21, v213, v214
v_max3_f32 v21, v21, v215, v216
v_max3_f32 v21, v21, v217, v218
v_max3_f32 v21, v21, v219, v220
v_max3_f32 v21, v21, v221, v222
v_max_f32 v21, v21, v223
v_mov_b32 v1, v21
s_nop 1
v_permlane16_swap_b32 v1, v21
v_max_f32 v21, v21, v1
v_mov_b32 v1, v21
s_nop 1
v_permlane32_swap_b32 v1, v21
v_max_f32_e64 v21, v21, v1
v_add_f32 v21, 0x41f80000, v21
v_max_f32 v21, 0, v21
Vs 208,208,21
Vs 209,209,21
Vs 210,210,21
Vs 211,211,21
Vs 212,212,21
Vs 213,213,21
Vs 214,214,21
Vs 215,215,21
Vs 216,216,21
Vs 217,217,21
Vs 218,218,21
Vs 219,219,21
Vs 220,220,21
Vs 221,221,21
Vs 222,222,21
Vs 223,223,21
Vs 144,144,21
Vs 145,145,21
Vs 146,146,21
Vs 147,147,21
Vs 148,148,21
Vs 149,149,21
Vs 150,150,21
Vs 151,151,21
Vs 152,152,21
Vs 153,153,21
Vs 154,154,21
Vs 155,155,21
Vs 156,156,21
Vs 157,157,21
Vs 158,158,21
Vs 159,159,21
Vs 36,36,21
Vs 37,37,21
Vs 38,38,21
v_sub_f32_e64 v39, v39, v21
v_exp_f32 v22, -v21
s_nop 0
Vm 52,52,22
Vm 53,53,22
Vm 54,54,22
v_mul_f32_e64 v55, v55, v22
Ar 8,32
Ar 9,33
Ar 10,34
Ar 11,35
Ar 12,36
Ar 13,37
Ar 14,38
Ar 15,39
Vm 8,8,22
Vm 9,9,22
Vm 10,10,22
Vm 11,11,22
Vm 12,12,22
Vm 13,13,22
Vm 14,14,22
Vm 15,15,22
Aw 32,8
Aw 33,9
Aw 34,10
Aw 35,11
Aw 36,12
Aw 37,13
Aw 38,14
Aw 39,15
Ar 8,40
Ar 9,41
Ar 10,42
Ar 11,43
Ar 12,44
Ar 13,45
Ar 14,46
Ar 15,47
Vm 8,8,22
Vm 9,9,22
Vm 10,10,22
Vm 11,11,22
Vm 12,12,22
Vm 13,13,22
Vm 14,14,22
Vm 15,15,22
Aw 40,8
Aw 41,9
Aw 42,10
Aw 43,11
Aw 44,12
Aw 45,13
Aw 46,14
Aw 47,15
Ar 8,48
Ar 9,49
Ar 10,50
Ar 11,51
Ar 12,52
Ar 13,53
Ar 14,54
Ar 15,55
Vm 8,8,22
Vm 9,9,22
Vm 10,10,22
Vm 11,11,22
Vm 12,12,22
Vm 13,13,22
Vm 14,14,22
Vm 15,15,22
Aw 48,8
Aw 49,9
Aw 50,10
Aw 51,11
Aw 52,12
Aw 53,13
Aw 54,14
Aw 55,15
Ar 8,56
Ar 9,57
Ar 10,58
Ar 11,59
Ar 12,60
Ar 13,61
Ar 14,62
Ar 15,63
Vm 8,8,22
Vm 9,9,22
Vm 10,10,22
Vm 11,11,22
Vm 12,12,22
Vm 13,13,22
Vm 14,14,22
Vm 15,15,22
Aw 56,8
Aw 57,9
Aw 58,10
Aw 59,11
Aw 60,12
Aw 61,13
Aw 62,14
Aw 63,15
Ve 8,192
Ve 9,193
s_nop 0
Vc 96,8,9
Ve 8,194
Ve 9,195
s_nop 0
Vc 97,8,9
Ve 8,208
Ve 9,209
s_nop 0
Vc 104,8,9
Ve 8,210
Ve 9,211
s_nop 0
Vc 105,8,9
Ve 8,196
Ve 9,197
s_nop 0
Vc 98,8,9
Ve 8,198
Ve 9,199
s_nop 0
Vc 99,8,9
Ve 8,212
Ve 9,213
s_nop 0
Vc 106,8,9
Ve 8,214
Ve 9,215
s_nop 0
Vc 107,8,9
Ve 8,200
Ve 9,201
s_nop 0
Vc 100,8,9
Ve 8,202
Ve 9,203
s_nop 0
Vc 101,8,9
Ve 8,216
Ve 9,217
s_nop 0
Vc 108,8,9
Ve 8,218
Ve 9,219
s_nop 0
Vc 109,8,9
Ve 8,204
Ve 9,205
s_nop 0
Vc 102,8,9
Ve 8,206
Ve 9,207
s_nop 0
Vc 103,8,9
Ve 8,220
Ve 9,221
s_nop 0
Vc 110,8,9
Ve 8,222
Ve 9,223
s_nop 0
Vc 111,8,9
s_nop 1
s_branch L_k2_fbr_no
L_k2_fb_nl:
s_nop 7
s_nop 0
v_max3_f32 v21, v128, v129, v130
v_max3_f32 v21, v21, v131, v132
v_max3_f32 v21, v21, v133, v134
v_max3_f32 v21, v21, v135, v136
v_max3_f32 v21, v21, v137, v138
v_max3_f32 v21, v21, v139, v140
v_max3_f32 v21, v21, v141, v142
v_max_f32 v21, v21, v143
v_mov_b32 v1, v21
s_nop 1
v_permlane16_swap_b32 v1, v21
v_max_f32 v21, v21, v1
v_mov_b32 v1, v21
s_nop 1
v_permlane32_swap_b32 v1, v21
v_max_f32_e64 v21, v21, v1
v_add_f32 v21, 0x41f80000, v21
v_max_f32 v21, 0, v21
Vs 128,128,21
Vs 129,129,21
Vs 130,130,21
Vs 131,131,21
Vs 132,132,21
Vs 133,133,21
Vs 134,134,21
Vs 135,135,21
Vs 136,136,21
Vs 137,137,21
Vs 138,138,21
Vs 139,139,21
Vs 140,140,21
Vs 141,141,21
Vs 142,142,21
Vs 143,143,21
Vs 192,192,21
Vs 193,193,21
Vs 194,194,21
Vs 195,195,21
Vs 196,196,21
Vs 197,197,21
Vs 198,198,21
Vs 199,199,21
Vs 200,200,21
Vs 201,201,21
Vs 202,202,21
Vs 203,203,21
Vs 204,204,21
Vs 205,205,21
Vs 206,206,21
Vs 207,207,21
Vs 32,32,21
Vs 33,33,21
Vs 34,34,21
v_sub_f32_e64 v35, v35, v21
v_exp_f32 v22, -v21
s_nop 0
Vm 48,48,22
Vm 49,49,22
Vm 50,50,22
v_mul_f32_e64 v51, v51, v22
Ar 8,0
Ar 9,1
Ar 10,2
Ar 11,3
Ar 12,4
Ar 13,5
Ar 14,6
Ar 15,7
Vm 8,8,22
Vm 9,9,22
Vm 10,10,22
Vm 11,11,22
Vm 12,12,22
Vm 13,13,22
Vm 14,14,22
Vm 15,15,22
Aw 0,8
Aw 1,9
Aw 2,10
Aw 3,11
Aw 4,12
Aw 5,13
Aw 6,14
Aw 7,15
Ar 8,8
Ar 9,9
Ar 10,10
Ar 11,11
Ar 12,12
Ar 13,13
Ar 14,14
Ar 15,15
Vm 8,8,22
Vm 9,9,22
Vm 10,10,22
Vm 11,11,22
Vm 12,12,22
Vm 13,13,22
Vm 14,14,22
Vm 15,15,22
Aw 8,8
Aw 9,9
Aw 10,10
Aw 11,11
Aw 12,12
Aw 13,13
Aw 14,14
Aw 15,15
Ar 8,16
Ar 9,17
Ar 10,18
Ar 11,19
Ar 12,20
Ar 13,21
Ar 14,22
Ar 15,23
Vm 8,8,22
Vm 9,9,22
Vm 10,10,22
Vm 11,11,22
Vm 12,12,22
Vm 13,13,22
Vm 14,14,22
Vm 15,15,22
Aw 16,8
Aw 17,9
Aw 18,10
Aw 19,11
Aw 20,12
Aw 21,13
Aw 22,14
Aw 23,15
Ar 8,24
Ar 9,25
Ar 10,26
Ar 11,27
Ar 12,28
Ar 13,29
Ar 14,30
Ar 15,31
Vm 8,8,22
Vm 9,9,22
Vm 10,10,22
Vm 11,11,22
Vm 12,12,22
Vm 13,13,22
Vm 14,14,22
Vm 15,15,22
Aw 24,8
Aw 25,9
Aw 26,10
Aw 27,11
Aw 28,12
Aw 29,13
Aw 30,14
Aw 31,15
v_max3_f32 v21, v144, v145, v146
v_max3_f32 v21, v21, v147, v148
v_max3_f32 v21, v21, v149, v150
v_max3_f32 v21, v21, v151, v152
v_max3_f32 v21, v21, v153, v154
v_max3_f32 v21, v21, v155, v156
v_max3_f32 v21, v21, v157, v158
v_max_f32 v21, v21, v159
v_mov_b32 v1, v21
s_nop 1
v_permlane16_swap_b32 v1, v21
v_max_f32 v21, v21, v1
v_mov_b32 v1, v21
s_nop 1
v_permlane32_swap_b32 v1, v21
v_max_f32_e64 v21, v21, v1
v_add_f32 v21, 0x41f80000, v21
v_max_f32 v21, 0, v21
Vs 144,144,21
Vs 145,145,21
Vs 146,146,21
Vs 147,147,21
Vs 148,148,21
Vs 149,149,21
Vs 150,150,21
Vs 151,151,21
Vs 152,152,21
Vs 153,153,21
Vs 154,154,21
Vs 155,155,21
Vs 156,156,21
Vs 157,157,21
Vs 158,158,21
Vs 159,159,21
Vs 36,36,21
Vs 37,37,21
Vs 38,38,21
v_sub_f32_e64 v39, v39, v21
v_exp_f32 v22, -v21
s_nop 0
Vm 52,52,22
Vm 53,53,22
Vm 54,54,22
v_mul_f32_e64 v55, v55, v22
Ar 8,32
Ar 9,33
Ar 10,34
Ar 11,35
Ar 12,36
Ar 13,37
Ar 14,38
Ar 15,39
Vm 8,8,22
Vm 9,9,22
Vm 10,10,22
Vm 11,11,22
Vm 12,12,22
Vm 13,13,22
Vm 14,14,22
Vm 15,15,22
Aw 32,8
Aw 33,9
Aw 34,10
Aw 35,11
Aw 36,12
Aw 37,13
Aw 38,14
Aw 39,15
Ar 8,40
Ar 9,41
Ar 10,42
Ar 11,43
Ar 12,44
Ar 13,45
Ar 14,46
Ar 15,47
Vm 8,8,22
Vm 9,9,22
Vm 10,10,22
Vm 11,11,22
Vm 12,12,22
Vm 13,13,22
Vm 14,14,22
Vm 15,15,22
Aw 40,8
Aw 41,9
Aw 42,10
Aw 43,11
Aw 44,12
Aw 45,13
Aw 46,14
Aw 47,15
Ar 8,48
Ar 9,49
Ar 10,50
Ar 11,51
Ar 12,52
Ar 13,53
Ar 14,54
Ar 15,55
Vm 8,8,22
Vm 9,9,22
Vm 10,10,22
Vm 11,11,22
Vm 12,12,22
Vm 13,13,22
Vm 14,14,22
Vm 15,15,22
Aw 48,8
Aw 49,9
Aw 50,10
Aw 51,11
Aw 52,12
Aw 53,13
Aw 54,14
Aw 55,15
Ar 8,56
Ar 9,57
Ar 10,58
Ar 11,59
Ar 12,60
Ar 13,61
Ar 14,62
Ar 15,63
Vm 8,8,22
Vm 9,9,22
Vm 10,10,22
Vm 11,11,22
Vm 12,12,22
Vm 13,13,22
Vm 14,14,22
Vm 15,15,22
Aw 56,8
Aw 57,9
Aw 58,10
Aw 59,11
Aw 60,12
Aw 61,13
Aw 62,14
Aw 63,15
Ve 8,128
Ve 9,129
s_nop 0
Vc 64,8,9
Ve 8,130
Ve 9,131
s_nop 0
Vc 65,8,9
Ve 8,144
Ve 9,145
s_nop 0
Vc 72,8,9
Ve 8,146
Ve 9,147
s_nop 0
Vc 73,8,9
Ve 8,132
Ve 9,133
s_nop 0
Vc 66,8,9
Ve 8,134
Ve 9,135
s_nop 0
Vc 67,8,9
Ve 8,148
Ve 9,149
s_nop 0
Vc 74,8,9
Ve 8,150
Ve 9,151
s_nop 0
Vc 75,8,9
Ve 8,136
Ve 9,137
s_nop 0
Vc 68,8,9
Ve 8,138
Ve 9,139
s_nop 0
Vc 69,8,9
Ve 8,152
Ve 9,153
s_nop 0
Vc 76,8,9
Ve 8,154
Ve 9,155
s_nop 0
Vc 77,8,9
Ve 8,140
Ve 9,141
s_nop 0
Vc 70,8,9
Ve 8,142
Ve 9,143
s_nop 0
Vc 71,8,9
Ve 8,156
Ve 9,157
s_nop 0
Vc 78,8,9
Ve 8,158
Ve 9,159
s_nop 0
Vc 79,8,9
s_nop 1
s_branch L_k2_fbr_nl
L_k2_fb_fi:
s_nop 7
s_nop 0
v_max3_f32 v21, v192, v193, v194
v_max3_f32 v21, v21, v195, v196
v_max3_f32 v21, v21, v197, v198
v_max3_f32 v21, v21, v199, v200
v_max3_f32 v21, v21, v201, v202
v_max3_f32 v21, v21, v203, v204
v_max3_f32 v21, v21, v205, v206
v_max_f32 v21, v21, v207
v_mov_b32 v1, v21
s_nop 1
v_permlane16_swap_b32 v1, v21
v_max_f32 v21, v21, v1
v_mov_b32 v1, v21
s_nop 1
v_permlane32_swap_b32 v1, v21
v_max_f32_e64 v21, v21, v1
v_add_f32 v21, 0x41f80000, v21
v_max_f32 v21, 0, v21
Vs 192,192,21
Vs 193,193,21
Vs 194,194,21
Vs 195,195,21
Vs 196,196,21
Vs 197,197,21
Vs 198,198,21
Vs 199,199,21
Vs 200,200,21
Vs 201,201,21
Vs 202,202,21
Vs 203,203,21
Vs 204,204,21
Vs 205,205,21
Vs 206,206,21
Vs 207,207,21
Vs 32,32,21
Vs 33,33,21
Vs 34,34,21
v_sub_f32_e64 v35, v35, v21
v_exp_f32 v22, -v21
s_nop 0
Vm 48,48,22
Vm 49,49,22
Vm 50,50,22
v_mul_f32_e64 v51, v51, v22
Ar 8,0
Ar 9,1
Ar 10,2
Ar 11,3
Ar 12,4
Ar 13,5
Ar 14,6
Ar 15,7
Vm 8,8,22
Vm 9,9,22
Vm 10,10,22
Vm 11,11,22
Vm 12,12,22
Vm 13,13,22
Vm 14,14,22
Vm 15,15,22
Aw 0,8
Aw 1,9
Aw 2,10
Aw 3,11
Aw 4,12
Aw 5,13
Aw 6,14
Aw 7,15
Ar 8,8
Ar 9,9
Ar 10,10
Ar 11,11
Ar 12,12
Ar 13,13
Ar 14,14
Ar 15,15
Vm 8,8,22
Vm 9,9,22
Vm 10,10,22
Vm 11,11,22
Vm 12,12,22
Vm 13,13,22
Vm 14,14,22
Vm 15,15,22
Aw 8,8
Aw 9,9
Aw 10,10
Aw 11,11
Aw 12,12
Aw 13,13
Aw 14,14
Aw 15,15
Ar 8,16
Ar 9,17
Ar 10,18
Ar 11,19
Ar 12,20
Ar 13,21
Ar 14,22
Ar 15,23
Vm 8,8,22
Vm 9,9,22
Vm 10,10,22
Vm 11,11,22
Vm 12,12,22
Vm 13,13,22
Vm 14,14,22
Vm 15,15,22
Aw 16,8
Aw 17,9
Aw 18,10
Aw 19,11
Aw 20,12
Aw 21,13
Aw 22,14
Aw 23,15
Ar 8,24
Ar 9,25
Ar 10,26
Ar 11,27
Ar 12,28
Ar 13,29
Ar 14,30
Ar 15,31
Vm 8,8,22
Vm 9,9,22
Vm 10,10,22
Vm 11,11,22
Vm 12,12,22
Vm 13,13,22
Vm 14,14,22
Vm 15,15,22
Aw 24,8
Aw 25,9
Aw 26,10
Aw 27,11
Aw 28,12
Aw 29,13
Aw 30,14
Aw 31,15
Ve 8,192
Ve 9,193
s_nop 0
Vc 96,8,9
Ve 8,194
Ve 9,195
s_nop 0
Vc 97,8,9
Ve 8,196
Ve 9,197
s_nop 0
Vc 98,8,9
Ve 8,198
Ve 9,199
s_nop 0
Vc 99,8,9
Ve 8,200
Ve 9,201
s_nop 0
Vc 100,8,9
Ve 8,202
Ve 9,203
s_nop 0
Vc 101,8,9
Ve 8,204
Ve 9,205
s_nop 0
Vc 102,8,9
Ve 8,206
Ve 9,207
s_nop 0
Vc 103,8,9
s_nop 1
s_branch L_k2_fbr_fi
L_spinX:
s_mov_b32 s47, 0x400000
L_spinXl:
buffer_load_dword v17, v126, s[20:23], s24 offen sc1
s_sub_u32 s47, s47, 1
s_waitcnt vmcnt(0)
s_cmp_eq_u32 s47, 0
s_cbranch_scc1 L_spinXlx
v_cmp_ne_u32 vcc, 1, v17
s_cbranch_vccz L_spinXlx
s_sleep 1
s_branch L_spinXl
L_spinXlx:
buffer_load_dwordx4 v[160:163], v112, s[16:19], s25 offen offset:0 sc1
buffer_load_dwordx4 v[164:167], v112, s[16:19], s25 offen offset:1024 sc1
buffer_load_dwordx4 v[168:171], v112, s[16:19], s25 offen offset:2048 sc1
buffer_load_dwordx4 v[172:175], v112, s[16:19], s25 offen offset:3072 sc1
buffer_load_dwordx4 v[176:179], v10, s[16:19], s25 offen offset:0 sc1
buffer_load_dwordx4 v[180:183], v10, s[16:19], s25 offen offset:1024 sc1
buffer_load_dwordx4 v[184:187], v10, s[16:19], s25 offen offset:2048 sc1
buffer_load_dwordx4 v[188:191], v10, s[16:19], s25 offen offset:3072 sc1
s_branch L_spinXr
L_ysl:
s_mov_b32 s47, 0x400000
L_ysll:
buffer_load_dword v124, v127, s[20:23], s41 offen sc1
s_sub_u32 s47, s47, 1
s_waitcnt vmcnt(0)
s_cmp_eq_u32 s47, 0
s_cbranch_scc1 L_ysllx
v_cmp_ne_u32 vcc, 1, v124
s_cbranch_vccz L_ysllx
s_sleep 8
s_branch L_ysll
L_ysllx:
v_lshlrev_b32 v124, 2, v0
v_lshlrev_b32 v125, 1, v0
s_lshl_b32 s7, s45, 2
s_add_u32 s7, s7, s32
s_lshr_b32 s3, s42, 5
s_cmp_lg_u32 s3, s7
s_cbranch_scc1 L_f_yl13
s_add_u32 s3, s55, 0
s_nop 0
s_add_u32 s7, s3, 4096
buffer_load_dword v76, v124, s[20:23], s3 offen offset:0 sc1
buffer_load_dword v77, v124, s[20:23], s3 offen offset:512 sc1
buffer_load_dword v78, v124, s[20:23], s3 offen offset:1024 sc1
buffer_load_dword v79, v124, s[20:23], s3 offen offset:1536 sc1
buffer_load_dword v80, v124, s[20:23], s3 offen offset:2048 sc1
buffer_load_dword v81, v124, s[20:23], s3 offen offset:2560 sc1
buffer_load_dword v82, v124, s[20:23], s3 offen offset:3072 sc1
buffer_load_dword v83, v124, s[20:23], s3 offen offset:3584 sc1
buffer_load_dword v84, v124, s[20:23], s7 offen offset:0 sc1
buffer_load_dword v85, v124, s[20:23], s7 offen offset:512 sc1
buffer_load_dword v86, v124, s[20:23], s7 offen offset:1024 sc1
buffer_load_dword v87, v124, s[20:23], s7 offen offset:1536 sc1
buffer_load_dword v88, v124, s[20:23], s7 offen offset:2048 sc1
buffer_load_dword v89, v124, s[20:23], s7 offen offset:2560 sc1
s_lshl_b32 s3, s42, 11
s_lshl_b32 s7, s46, 7
s_add_u32 s3, s3, s7
buffer_load_ushort v90, v125, s[56:59], s3 offen
s_lshl_b32 s3, s42, 3
s_add_u32 s3, s3, 5259264
buffer_load_dwordx2 v[92:93], v126, s[20:23], s3 offen sc1
L_f_yl13:
s_lshl_b32 s7, s45, 2
s_add_u32 s7, s7, s32
s_lshr_b32 s3, s43, 5
s_cmp_lg_u32 s3, s7
s_cbranch_scc1 L_f_yl14
s_nop 0
s_add_u32 s3, s55, 256
s_add_u32 s7, s3, 4096
buffer_load_dword v94, v124, s[20:23], s3 offen offset:0 sc1
buffer_load_dword v95, v124, s[20:23], s3 offen offset:512 sc1
buffer_load_dword v96, v124, s[20:23], s3 offen offset:1024 sc1
buffer_load_dword v97, v124, s[20:23], s3 offen offset:1536 sc1
buffer_load_dword v98, v124, s[20:23], s3 offen offset:2048 sc1
buffer_load_dword v99, v124, s[20:23], s3 offen offset:2560 sc1
buffer_load_dword v100, v124, s[20:23], s3 offen offset:3072 sc1
buffer_load_dword v101, v124, s[20:23], s3 offen offset:3584 sc1
buffer_load_dword v102, v124, s[20:23], s7 offen offset:0 sc1
buffer_load_dword v103, v124, s[20:23], s7 offen offset:512 sc1
buffer_load_dword v104, v124, s[20:23], s7 offen offset:1024 sc1
buffer_load_dword v105, v124, s[20:23], s7 offen offset:1536 sc1
buffer_load_dword v106, v124, s[20:23], s7 offen offset:2048 sc1
buffer_load_dword v107, v124, s[20:23], s7 offen offset:2560 sc1
s_lshl_b32 s3, s43, 11
s_lshl_b32 s7, s46, 7
s_add_u32 s3, s3, s7
buffer_load_ushort v108, v125, s[56:59], s3 offen
s_lshl_b32 s3, s43, 3
s_add_u32 s3, s3, 5259264
buffer_load_dwordx2 v[110:111], v126, s[20:23], s3 offen sc1
L_f_yl14:
s_waitcnt vmcnt(0)
s_lshl_b32 s7, s45, 2
s_add_u32 s7, s7, s32
s_lshr_b32 s3, s42, 5
s_cmp_lg_u32 s3, s7
s_cbranch_scc1 L_f_ys15
v_pk_add_f32 v[76:77], v[76:77], v[78:79]
v_pk_add_f32 v[76:77], v[76:77], v[80:81]
v_pk_add_f32 v[76:77], v[76:77], v[82:83]
v_pk_add_f32 v[76:77], v[76:77], v[84:85]
v_pk_add_f32 v[76:77], v[76:77], v[86:87]
v_pk_add_f32 v[76:77], v[76:77], v[88:89]
Va 76,76,77
v_lshlrev_b32 v90, 16, v90
v_sub_f32_e64 v90, v90, v92
Vc 76,76,76
v_lshlrev_b32_e64 v76, 16, v76
Vc 90,90,90
v_lshlrev_b32 v90, 16, v90
v_mul_f32 v76, s100, v76
v_mul_f32_e64 v90, v90, v93
Vc 76,76,76
v_lshlrev_b32_e64 v76, 16, v76
Vc 90,90,90
v_lshlrev_b32 v90, 16, v90
Va 90,90,76
Vc 90,90,90
v_lshlrev_b32_e64 v90, 16, v90
v_mul_f32 v76, 0xbfb8aa3b, v90
Ve 76,76
s_nop 0
v_add_f32 v76, 1.0, v76
v_rcp_f32 v76, v76
s_nop 0
Vm 90,90,76
Vc 90,90,90
v_lshlrev_b32 v90, 16, v90
v_lshlrev_b32 v124, 2, v0
v_add_u32 v124, s35, v124
v_lshlrev_b32 v125, 5, v122
v_add_u32 v125, s35, v125
s_waitcnt lgkmcnt(0)
ds_write_b32 v124, v90
s_and_b32 s3, s42, 7
s_lshl_b32 s3, s3, 3
s_lshl_b64 s[4:5], 0xff, s3
s_bfe_u32 s3, s42, 0x20003
s_mov_b64 exec, s[4:5]
s_cmp_lg_u32 s3, 0
s_cbranch_scc1 L_f_yp16
ds_read_b64 v[42:43], v125
ds_read_b64 v[44:45], v125 offset:8
ds_read_b64 v[46:47], v125 offset:16
ds_read_b64 v[48:49], v125 offset:24
L_f_yp16:
s_cmp_lg_u32 s3, 1
s_cbranch_scc1 L_f_yp17
ds_read_b64 v[50:51], v125
ds_read_b64 v[52:53], v125 offset:8
ds_read_b64 v[54:55], v125 offset:16
ds_read_b64 v[56:57], v125 offset:24
L_f_yp17:
s_cmp_lg_u32 s3, 2
s_cbranch_scc1 L_f_yp18
ds_read_b64 v[58:59], v125
ds_read_b64 v[60:61], v125 offset:8
ds_read_b64 v[62:63], v125 offset:16
ds_read_b64 v[64:65], v125 offset:24
L_f_yp18:
s_cmp_lg_u32 s3, 3
s_cbranch_scc1 L_f_yp19
ds_read_b64 v[66:67], v125
ds_read_b64 v[68:69], v125 offset:8
s_waitcnt lgkmcnt(9)
ds_read_b64 v[70:71], v125 offset:16
ds_read_b64 v[72:73], v125 offset:24
L_f_yp19:
s_mov_b64 exec, -1
s_waitcnt lgkmcnt(0)
L_f_ys15:
s_lshl_b32 s7, s45, 2
s_add_u32 s7, s7, s32
s_lshr_b32 s3, s43, 5
s_cmp_lg_u32 s3, s7
s_cbranch_scc1 L_f_ys20
s_nop 0
v_pk_add_f32 v[94:95], v[94:95], v[96:97]
v_pk_add_f32 v[94:95], v[94:95], v[98:99]
v_pk_add_f32 v[94:95], v[94:95], v[100:101]
v_pk_add_f32 v[94:95], v[94:95], v[102:103]
v_pk_add_f32 v[94:95], v[94:95], v[104:105]
v_pk_add_f32 v[94:95], v[94:95], v[106:107]
Va 94,94,95
v_lshlrev_b32 v108, 16, v108
v_sub_f32_e64 v108, v108, v110
Vc 94,94,94
v_lshlrev_b32_e64 v94, 16, v94
Vc 108,108,108
v_lshlrev_b32 v108, 16, v108
v_mul_f32 v94, s101, v94
v_mul_f32_e64 v108, v108, v111
Vc 94,94,94
v_lshlrev_b32_e64 v94, 16, v94
Vc 108,108,108
v_lshlrev_b32 v108, 16, v108
Va 108,108,94
Vc 108,108,108
v_lshlrev_b32_e64 v108, 16, v108
v_mul_f32 v94, 0xbfb8aa3b, v108
Ve 94,94
s_nop 0
v_add_f32 v94, 1.0, v94
v_rcp_f32 v94, v94
s_nop 0
Vm 108,108,94
Vc 108,108,108
v_lshlrev_b32 v108, 16, v108
v_lshlrev_b32 v124, 2, v0
v_add_u32 v124, s35, v124
v_lshlrev_b32 v125, 5, v122
v_add_u32 v125, s35, v125
s_waitcnt lgkmcnt(0)
ds_write_b32 v124, v108
s_and_b32 s3, s43, 7
s_lshl_b32 s3, s3, 3
s_lshl_b64 s[4:5], 0xff, s3
s_bfe_u32 s3, s43, 0x20003
s_mov_b64 exec, s[4:5]
s_cmp_lg_u32 s3, 0
s_cbranch_scc1 L_f_yp21
ds_read_b64 v[42:43], v125
ds_read_b64 v[44:45], v125 offset:8
ds_read_b64 v[46:47], v125 offset:16
ds_read_b64 v[48:49], v125 offset:24
L_f_yp21:
s_cmp_lg_u32 s3, 1
s_cbranch_scc1 L_f_yp22
ds_read_b64 v[50:51], v125
ds_read_b64 v[52:53], v125 offset:8
ds_read_b64 v[54:55], v125 offset:16
ds_read_b64 v[56:57], v125 offset:24
L_f_yp22:
s_cmp_lg_u32 s3, 2
s_cbranch_scc1 L_f_yp23
ds_read_b64 v[58:59], v125
ds_read_b64 v[60:61], v125 offset:8
ds_read_b64 v[62:63], v125 offset:16
ds_read_b64 v[64:65], v125 offset:24
L_f_yp23:
s_cmp_lg_u32 s3, 3
s_cbranch_scc1 L_f_yp24
ds_read_b64 v[66:67], v125
ds_read_b64 v[68:69], v125 offset:8
s_waitcnt lgkmcnt(9)
ds_read_b64 v[70:71], v125 offset:16
ds_read_b64 v[72:73], v125 offset:24
L_f_yp24:
s_mov_b64 exec, -1
s_waitcnt lgkmcnt(0)
L_f_ys20:
s_branch L_yslr
.section .rodata,"a"
.p2align 6
.amdhsa_kernel recurrent_scan__compressed_kv_cla__moe_arch_mod__prompt_kernel
  .amdhsa_next_free_vgpr 512
  .amdhsa_next_free_sgpr 102
  .amdhsa_accum_offset 256
  .amdhsa_group_segment_fixed_size 0
  .amdhsa_kernarg_size 112
  .amdhsa_user_sgpr_count 2
  .amdhsa_user_sgpr_kernarg_segment_ptr 1
  .amdhsa_system_sgpr_workgroup_id_x 1
.end_amdhsa_kernel
```

```asm
; @launch grid=(256,1,1) block=(256,1,1) lds=163840
.amdgcn_target "amdgcn-amd-amdhsa--gfx950"
.macro Va d,x,y
v_add_f32 v\d, v\x, v\y
.endm
.macro Vc d,x,y
v_cvt_pk_bf16_f32 v\d, v\x, v\y
.endm
.macro Ra d,x,o
ds_read_b128 a[\d:\d+3], v\x offset:\o
.endm
.macro Ta d,x,o
ds_read_b64_tr_b16 a[\d:\d+1], v\x offset:\o
.endm
.macro Zvaa d,x,y
v_mfma_f32_16x16x32_bf16 v[\d:\d+3], a[\x:\x+3], a[\y:\y+3], 0
.endm
.macro Mvaa d,x,y
v_mfma_f32_16x16x32_bf16 v[\d:\d+3], a[\x:\x+3], a[\y:\y+3], v[\d:\d+3]
.endm
.macro Rv d,x,o
ds_read_b128 v[\d:\d+3], v\x offset:\o
.endm
.macro Zaaa d,x,y
v_mfma_f32_16x16x32_bf16 a[\d:\d+3], a[\x:\x+3], a[\y:\y+3], 0
.endm
.macro Maaa d,x,y
v_mfma_f32_16x16x32_bf16 a[\d:\d+3], a[\x:\x+3], a[\y:\y+3], a[\d:\d+3]
.endm
.macro Ar d,x
v_accvgpr_read_b32 v\d, a\x
.endm
.macro Ve d,x
v_exp_f32 v\d, v\x
.endm
.macro Aw d,x
v_accvgpr_write_b32 a\d, v\x
.endm
.macro Vs d,x,y
v_sub_f32 v\d, v\x, v\y
.endm
.macro Cvaa d,x,y,c
v_mfma_f32_16x16x32_bf16 v[\d:\d+3], a[\x:\x+3], a[\y:\y+3], v[\c:\c+3]
.endm
.macro VE d,x
v_exp_f32_e64 v\d, v\x
.endm
.macro Maav d,x,y
v_mfma_f32_16x16x32_bf16 a[\d:\d+3], a[\x:\x+3], v[\y:\y+3], a[\d:\d+3]
.endm
.macro Mvvv d,x,y
v_mfma_f32_16x16x32_bf16 v[\d:\d+3], v[\x:\x+3], v[\y:\y+3], v[\d:\d+3]
.endm
.macro Zvva d,x,y
v_mfma_f32_16x16x32_bf16 v[\d:\d+3], v[\x:\x+3], a[\y:\y+3], 0
.endm
.macro Mvva d,x,y
v_mfma_f32_16x16x32_bf16 v[\d:\d+3], v[\x:\x+3], a[\y:\y+3], v[\d:\d+3]
.endm
.macro Vm d,x,y
v_mul_f32 v\d, v\x, v\y
.endm
.macro Zvvv d,x,y
v_mfma_f32_16x16x32_bf16 v[\d:\d+3], v[\x:\x+3], v[\y:\y+3], 0
.endm
.text
.globl recurrent_scan__compressed_kv_cla__moe_arch_mod__prompt_kernel
.p2align 8
.type recurrent_scan__compressed_kv_cla__moe_arch_mod__prompt_kernel,@function
recurrent_scan__compressed_kv_cla__moe_arch_mod__prompt_kernel:
s_cmp_ge_u32 s2, 256
s_cbranch_scc1 L_k2_end
s_load_dwordx4 s[4:7], s[0:1], 0
s_load_dwordx2 s[44:45], s[0:1], 56
s_load_dwordx4 s[40:43], s[0:1], 24
s_load_dwordx4 s[64:67], s[0:1], 96
v_lshrrev_b32 v1, 6, v0
v_and_b32 v0, 63, v0
v_readfirstlane_b32 s32, v1
s_getpc_b64 s[68:69]
L_cpf1:
s_add_u32 s68, s68, (recurrent_scan__compressed_kv_cla__moe_arch_mod__prompt_kernel-L_cpf1)&0xffffffff
s_addc_u32 s69, s69, ((recurrent_scan__compressed_kv_cla__moe_arch_mod__prompt_kernel-L_cpf1)>>32)&0xffffffff
s_lshr_b32 s70, s2, 3
s_lshl_b32 s70, s70, 2
s_add_u32 s70, s70, s32
s_lshl_b32 s70, s70, 10
v_and_b32 v122, 7, v0
v_lshlrev_b32 v122, 7, v122
v_add_u32 v122, s70, v122
v_min_u32 v122, L_k2_fin-recurrent_scan__compressed_kv_cla__moe_arch_mod__prompt_kernel-4, v122
v_mov_b32 v121, s69
v_add_co_u32 v120, vcc, s68, v122
s_nop 1
v_addc_co_u32 v121, vcc, 0, v121, vcc
global_load_dword v124, v[120:121], off
v_lshrrev_b32 v33, 5, v0
v_and_b32 v31, 31, v0
v_lshlrev_b32_e64 v36, 4, v31
v_lshl_add_u32 v35, v33, 11, v36
s_lshl_b32 s36, s2, 14
s_lshl_b32 s37, s32, 12
s_add_u32 s36, s36, s37
s_mov_b32 s18, 4194304
s_mov_b32 s19, 0x20000
s_bfe_u32 s33, s2, 0x30003
s_lshr_b32 s35, s2, 7
s_bfe_u32 s3, s2, 0x10006
s_and_b32 s34, s2, 7
s_lshl_b32 s34, s34, 1
s_add_u32 s34, s34, s3
s_waitcnt lgkmcnt(0)
s_mov_b32 s16, s4
s_and_b32 s17, s5, 0xffff
buffer_load_dwordx4 v[48:51], v35, s[16:19], s36 offen offset:0
buffer_load_dwordx4 v[52:55], v35, s[16:19], s36 offen offset:512
buffer_load_dwordx4 v[56:59], v35, s[16:19], s36 offen offset:1024
buffer_load_dwordx4 v[60:63], v35, s[16:19], s36 offen offset:1536
s_cmp_eq_u32 s35, 0
s_cselect_b32 s40, s40, s42
s_cselect_b32 s41, s41, s43
s_lshl_b32 s3, s34, 9
s_add_u32 s12, s40, s3
s_addc_u32 s13, s41, 0
s_and_b32 s13, s13, 0xffff
s_mov_b32 s14, 0
s_mov_b32 s15, 0x20000
s_sub_u32 s14, 4194304, s3
s_lshl_b32 s3, s33, 18
s_add_u32 s8, s6, s3
s_addc_u32 s9, s7, 0
s_and_b32 s9, s9, 0xffff
s_mov_b32 s10, 262144
s_mov_b32 s11, 0x20000
s_and_b32 s58, s2, 7
s_mov_b32 s52, 0
s_mov_b32 s53, 15360
s_mov_b32 s54, 30720
s_mov_b32 s55, 46080
s_lshl_b32 s57, s32, 13
s_add_u32 s56, s57, 32768
s_lshl_b32 s3, s58, 2
s_add_u32 s3, s3, s32
s_lshl_b32 s3, s3, 4
v_add_u32 v30, s3, v33
v_lshlrev_b32 v30, 13, v30
v_lshlrev_b32 v34, 5, v33
v_xor_b32 v34, v34, v36
v_add_u32 v6, v34, v30
v_xor_b32_e64 v7, 64, v6
v_xor_b32 v8, 65664, v6
v_xor_b32 v9, 65728, v6
s_add_u32 m0, s57, 0
s_nop 0
buffer_load_dwordx4 v6, s[12:15], s52 offen offset:0 lds
buffer_load_dwordx4 v7, s[12:15], s53 offen offset:1024 lds
buffer_load_dwordx4 v6, s[12:15], s54 offen offset:2048 lds
buffer_load_dwordx4 v7, s[12:15], s55 offen offset:3072 lds
s_add_u32 m0, s57, 4096
s_nop 0
s_nop 0
buffer_load_dwordx4 v8, s[12:15], s52 offen offset:0 lds
buffer_load_dwordx4 v9, s[12:15], s53 offen offset:1024 lds
buffer_load_dwordx4 v8, s[12:15], s54 offen offset:2048 lds
buffer_load_dwordx4 v9, s[12:15], s55 offen offset:3072 lds
v_xor_b32 v6, 524288, v6
v_xor_b32 v7, 524288, v7
v_xor_b32 v8, 524288, v8
v_xor_b32 v9, 524288, v9
s_mov_b32 s48, 0
s_mov_b32 s49, 7168
s_mov_b32 s50, 14336
s_mov_b32 s51, 21504
v_lshrrev_b32 v30, 3, v0
v_lshlrev_b32 v30, 10, v30
s_lshl_b32 s3, s32, 16
s_lshl_b32 s39, s58, 7
s_add_u32 s3, s3, s39
v_and_b32 v31, 7, v0
v_lshrrev_b32 v32, 4, v0
v_xor_b32_e64 v31, v31, v32
v_lshl_add_u32 v30, v31, 4, v30
v_add_u32 v2, s3, v30
v_xor_b32 v3, 64, v2
v_xor_b32 v4, 32768, v2
v_xor_b32 v5, 32832, v2
s_cmp_lt_u32 s32, 2
s_cselect_b32 s60, s8, s12
s_cselect_b32 s61, s9, s13
s_cselect_b32 s62, s10, s14
s_mov_b32 s63, 0x20000
s_mov_b32 s59, 524288
s_cselect_b32 s59, 128, s59
s_cselect_b64 vcc, -1, 0
s_cselect_b32 s38, 32, 16
s_lshr_b32 s3, s2, 6
s_cmp_lt_u32 s32, 2
s_cselect_b32 s3, s3, s33
s_lshl_b32 s3, s3, 1
s_and_b32 s39, s32, 1
s_add_u32 s3, s3, s39
s_lshl_b32 s3, s3, 15
s_xor_b32 s39, s58, 2
s_mul_i32 s39, s39, s59
s_add_u32 s3, s3, s39
v_lshlrev_b32 v37, 10, v0
v_lshrrev_b32 v38, 2, v0
v_lshlrev_b32 v38, 13, v38
v_and_b32 v39, 3, v0
v_lshl_add_u32 v38, v39, 7, v38
v_cndmask_b32 v47, v38, v37, vcc
v_add_u32 v47, s3, v47
v_cmp_gt_u32 vcc, s38, v0
v_mov_b32 v37, 2146435072
s_nop 0
v_cndmask_b32 v47, v37, v47, vcc
s_mov_b32 s20, s66
s_and_b32 s21, s67, 0xffff
s_mov_b32 s22, 8388608
s_mov_b32 s23, 0x20000
s_add_u32 s24, s66, 8388608
s_addc_u32 s25, s67, 0
s_and_b32 s25, s25, 0xffff
s_mov_b32 s26, 35717120
s_mov_b32 s27, 0x20000
v_lshrrev_b32 v32, 4, v0
v_and_b32 v30, 15, v0
s_lshr_b32 s3, s32, 1
s_lshl_b32 s3, s3, 14
s_add_u32 s3, s3, 32768
v_lshlrev_b32 v31, 7, v30
v_add_u32 v31, s3, v31
v_lshrrev_b32 v34, 1, v30
v_xor_b32_e64 v34, v34, v32
v_lshl_add_u32 v10, v34, 4, v31
v_xor_b32 v11, 64, v10
v_lshrrev_b32 v30, 2, v30
v_lshl_add_u32 v31, v32, 3, v30
v_lshlrev_b32 v31, 9, v31
v_and_b32 v34, 3, v0
v_lshl_add_u32 v31, v34, 3, v31
s_and_b32 s3, s32, 1
s_lshl_b32 s3, s3, 8
v_add_u32 v31, s3, v31
v_and_b32 v34, 1, v32
v_lshl_add_u32 v30, v34, 2, v30
v_lshl_add_u32 v16, v30, 5, v31
v_xor_b32 v17, 32, v16
v_xor_b32 v18, 64, v16
v_xor_b32 v19, 96, v16
v_xor_b32 v20, 128, v16
v_xor_b32 v21, 160, v16
v_xor_b32 v22, 192, v16
v_xor_b32 v23, 224, v16
v_add_u32 v12, 65536, v10
v_add_u32 v13, 65536, v11
v_add_u32 v14, 65536, v16
v_add_u32 v15, 65536, v17
v_add_u32 v24, 65536, v18
v_add_u32 v25, 65536, v19
v_add_u32 v26, 65536, v20
v_add_u32 v27, 65536, v21
v_add_u32 v28, 65536, v22
v_add_u32 v29, 65536, v23
s_mov_b32 s28, s44
s_nop 0
s_and_b32 s29, s45, 0xffff
s_mov_b32 s30, 2048
s_mov_b32 s31, 0x20000
buffer_load_dwordx4 v[64:67], v36, s[28:31], 0 offen offset:0
buffer_load_dwordx4 v[68:71], v36, s[28:31], 0 offen offset:512
buffer_load_dwordx4 v[72:75], v36, s[28:31], 0 offen offset:1024
buffer_load_dwordx4 v[76:79], v36, s[28:31], 0 offen offset:1536
s_waitcnt vmcnt(12)
v_lshlrev_b32 v80, 16, v48
v_and_b32 v81, 0xffff0000, v48
v_lshlrev_b32_e64 v82, 16, v49
v_and_b32 v83, 0xffff0000, v49
v_lshlrev_b32_e64 v84, 16, v50
v_and_b32 v85, 0xffff0000, v50
v_lshlrev_b32_e64 v86, 16, v51
v_and_b32 v87, 0xffff0000, v51
v_lshlrev_b32_e64 v88, 16, v52
v_and_b32 v89, 0xffff0000, v52
v_lshlrev_b32_e64 v90, 16, v53
v_and_b32 v91, 0xffff0000, v53
v_lshlrev_b32_e64 v92, 16, v54
v_and_b32 v93, 0xffff0000, v54
v_lshlrev_b32_e64 v94, 16, v55
v_and_b32 v95, 0xffff0000, v55
v_lshlrev_b32_e64 v96, 16, v56
v_and_b32 v97, 0xffff0000, v56
v_lshlrev_b32_e64 v98, 16, v57
v_and_b32 v99, 0xffff0000, v57
v_lshlrev_b32_e64 v100, 16, v58
v_and_b32 v101, 0xffff0000, v58
v_lshlrev_b32_e64 v102, 16, v59
v_and_b32 v103, 0xffff0000, v59
v_lshlrev_b32_e64 v104, 16, v60
v_and_b32 v105, 0xffff0000, v60
v_lshlrev_b32_e64 v106, 16, v61
v_and_b32 v107, 0xffff0000, v61
v_lshlrev_b32_e64 v108, 16, v62
v_and_b32 v109, 0xffff0000, v62
v_lshlrev_b32_e64 v110, 16, v63
v_and_b32 v111, 0xffff0000, v63
v_pk_add_f32 v[40:41], v[80:81], v[82:83]
v_pk_add_f32 v[42:43], v[84:85], v[86:87]
v_pk_add_f32 v[40:41], v[40:41], v[88:89]
v_pk_add_f32 v[42:43], v[42:43], v[90:91]
v_pk_add_f32 v[40:41], v[40:41], v[92:93]
v_pk_add_f32 v[42:43], v[42:43], v[94:95]
v_pk_add_f32 v[40:41], v[40:41], v[96:97]
v_pk_add_f32 v[42:43], v[42:43], v[98:99]
v_pk_add_f32 v[40:41], v[40:41], v[100:101]
v_pk_add_f32 v[42:43], v[42:43], v[102:103]
v_pk_add_f32 v[40:41], v[40:41], v[104:105]
v_pk_add_f32 v[42:43], v[42:43], v[106:107]
v_pk_add_f32 v[40:41], v[40:41], v[108:109]
v_pk_add_f32 v[42:43], v[42:43], v[110:111]
v_pk_add_f32 v[40:41], v[40:41], v[42:43]
Va 38,40,41
s_nop 1
v_add_f32_dpp v38, v38, v38 quad_perm:[1,0,3,2] row_mask:0xf bank_mask:0xf
s_nop 1
v_add_f32_dpp v38, v38, v38 quad_perm:[2,3,0,1] row_mask:0xf bank_mask:0xf
s_nop 1
v_add_f32_dpp v38, v38, v38 row_half_mirror row_mask:0xf bank_mask:0xf
s_nop 1
v_add_f32_dpp v38, v38, v38 row_mirror row_mask:0xf bank_mask:0xf
v_mov_b32 v37, v38
s_nop 1
v_permlane16_swap_b32 v37, v38
Va 38,38,37
s_add_u32 m0, s56, 0
s_nop 0
buffer_load_dwordx4 v2, s[8:11], s48 offen offset:0 lds
buffer_load_dwordx4 v3, s[8:11], s49 offen offset:1024 lds
buffer_load_dwordx4 v2, s[8:11], s50 offen offset:2048 lds
buffer_load_dwordx4 v3, s[8:11], s51 offen offset:3072 lds
s_add_u32 m0, s56, 4096
s_nop 0
buffer_load_dwordx4 v4, s[8:11], s48 offen offset:0 lds
buffer_load_dwordx4 v5, s[8:11], s49 offen offset:1024 lds
buffer_load_dwordx4 v4, s[8:11], s50 offen offset:2048 lds
buffer_load_dwordx4 v5, s[8:11], s51 offen offset:3072 lds
v_xor_b32 v2, 128, v2
v_xor_b32 v3, 128, v3
v_xor_b32 v4, 128, v4
v_xor_b32 v5, 128, v5
v_mul_f32 v38, 0xba800000, v38
v_mov_b32_e64 v39, v38
v_pk_add_f32 v[112:113], v[80:81], v[38:39]
v_pk_mul_f32 v[40:41], v[112:113], v[112:113]
v_pk_add_f32 v[114:115], v[82:83], v[38:39]
v_pk_mul_f32 v[42:43], v[114:115], v[114:115]
v_pk_add_f32 v[116:117], v[84:85], v[38:39]
v_pk_fma_f32 v[40:41], v[116:117], v[116:117], v[40:41]
v_pk_add_f32 v[118:119], v[86:87], v[38:39]
v_pk_fma_f32 v[42:43], v[118:119], v[118:119], v[42:43]
v_pk_add_f32 v[112:113], v[88:89], v[38:39]
v_pk_fma_f32 v[40:41], v[112:113], v[112:113], v[40:41]
v_pk_add_f32 v[114:115], v[90:91], v[38:39]
v_pk_fma_f32 v[42:43], v[114:115], v[114:115], v[42:43]
v_pk_add_f32 v[116:117], v[92:93], v[38:39]
v_pk_fma_f32 v[40:41], v[116:117], v[116:117], v[40:41]
v_pk_add_f32 v[118:119], v[94:95], v[38:39]
v_pk_fma_f32 v[42:43], v[118:119], v[118:119], v[42:43]
v_pk_add_f32 v[112:113], v[96:97], v[38:39]
v_pk_fma_f32 v[40:41], v[112:113], v[112:113], v[40:41]
v_pk_add_f32 v[114:115], v[98:99], v[38:39]
v_pk_fma_f32 v[42:43], v[114:115], v[114:115], v[42:43]
v_pk_add_f32 v[116:117], v[100:101], v[38:39]
v_pk_fma_f32 v[40:41], v[116:117], v[116:117], v[40:41]
v_pk_add_f32 v[118:119], v[102:103], v[38:39]
v_pk_fma_f32 v[42:43], v[118:119], v[118:119], v[42:43]
v_pk_add_f32 v[112:113], v[104:105], v[38:39]
v_pk_fma_f32 v[40:41], v[112:113], v[112:113], v[40:41]
v_pk_add_f32 v[114:115], v[106:107], v[38:39]
v_pk_fma_f32 v[42:43], v[114:115], v[114:115], v[42:43]
v_pk_add_f32 v[116:117], v[108:109], v[38:39]
v_pk_fma_f32 v[40:41], v[116:117], v[116:117], v[40:41]
v_pk_add_f32 v[118:119], v[110:111], v[38:39]
v_pk_fma_f32 v[42:43], v[118:119], v[118:119], v[42:43]
v_pk_add_f32 v[40:41], v[40:41], v[42:43]
Va 40,40,41
s_nop 1
v_add_f32_dpp v40, v40, v40 quad_perm:[1,0,3,2] row_mask:0xf bank_mask:0xf
s_nop 1
v_add_f32_dpp v40, v40, v40 quad_perm:[2,3,0,1] row_mask:0xf bank_mask:0xf
s_nop 1
v_add_f32_dpp v40, v40, v40 row_half_mirror row_mask:0xf bank_mask:0xf
s_nop 1
v_add_f32_dpp v40, v40, v40 row_mirror row_mask:0xf bank_mask:0xf
v_mov_b32 v37, v40
s_nop 1
v_permlane16_swap_b32 v37, v40
v_add_f32_e64 v40, v40, v37
v_mul_f32 v40, 0x3a800000, v40
Vc 44,38,40
v_lshlrev_b32_e64 v38, 16, v44
v_and_b32 v40, 0xffff0000, v44
v_add_f32 v40, 0x3727c5ac, v40
Vc 44,40,40
v_lshlrev_b32 v40, 16, v44
v_sqrt_f32 v40, v40
v_mov_b32_e64 v39, v38
Vc 44,40,40
v_lshlrev_b32 v44, 16, v44
v_rcp_f32 v40, v44
v_pk_add_f32 v[80:81], v[80:81], v[38:39]
v_pk_add_f32 v[82:83], v[82:83], v[38:39]
v_pk_add_f32 v[84:85], v[84:85], v[38:39]
v_pk_add_f32 v[86:87], v[86:87], v[38:39]
v_pk_add_f32 v[88:89], v[88:89], v[38:39]
v_pk_add_f32 v[90:91], v[90:91], v[38:39]
v_pk_add_f32 v[92:93], v[92:93], v[38:39]
v_pk_add_f32 v[94:95], v[94:95], v[38:39]
v_pk_add_f32 v[96:97], v[96:97], v[38:39]
v_pk_add_f32 v[98:99], v[98:99], v[38:39]
v_pk_add_f32 v[100:101], v[100:101], v[38:39]
v_pk_add_f32 v[102:103], v[102:103], v[38:39]
v_pk_add_f32 v[104:105], v[104:105], v[38:39]
v_pk_add_f32 v[106:107], v[106:107], v[38:39]
v_pk_add_f32 v[108:109], v[108:109], v[38:39]
v_pk_add_f32 v[110:111], v[110:111], v[38:39]
v_fma_f32 v45, -v44, v40, 1.0
v_fma_f32 v40, v45, v40, v40
v_mov_b32_e64 v41, v40
Vc 48,80,81
Vc 49,82,83
Vc 50,84,85
Vc 51,86,87
Vc 52,88,89
Vc 53,90,91
Vc 54,92,93
Vc 55,94,95
Vc 56,96,97
Vc 57,98,99
Vc 58,100,101
Vc 59,102,103
Vc 60,104,105
Vc 61,106,107
Vc 62,108,109
Vc 63,110,111
v_lshlrev_b32_e64 v80, 16, v48
v_and_b32 v81, 0xffff0000, v48
v_lshlrev_b32_e64 v82, 16, v49
v_and_b32 v83, 0xffff0000, v49
v_lshlrev_b32_e64 v84, 16, v50
v_and_b32 v85, 0xffff0000, v50
v_lshlrev_b32_e64 v86, 16, v51
v_and_b32 v87, 0xffff0000, v51
v_lshlrev_b32_e64 v88, 16, v52
v_and_b32 v89, 0xffff0000, v52
v_lshlrev_b32_e64 v90, 16, v53
v_and_b32 v91, 0xffff0000, v53
v_lshlrev_b32_e64 v92, 16, v54
v_and_b32 v93, 0xffff0000, v54
v_lshlrev_b32_e64 v94, 16, v55
v_and_b32 v95, 0xffff0000, v55
v_lshlrev_b32_e64 v96, 16, v56
v_and_b32 v97, 0xffff0000, v56
v_lshlrev_b32_e64 v98, 16, v57
v_and_b32 v99, 0xffff0000, v57
v_lshlrev_b32_e64 v100, 16, v58
v_and_b32 v101, 0xffff0000, v58
v_lshlrev_b32_e64 v102, 16, v59
v_and_b32 v103, 0xffff0000, v59
v_lshlrev_b32_e64 v104, 16, v60
v_and_b32 v105, 0xffff0000, v60
v_lshlrev_b32_e64 v106, 16, v61
v_and_b32 v107, 0xffff0000, v61
v_lshlrev_b32_e64 v108, 16, v62
v_and_b32 v109, 0xffff0000, v62
v_lshlrev_b32_e64 v110, 16, v63
v_and_b32 v111, 0xffff0000, v63
v_pk_mul_f32 v[80:81], v[80:81], v[40:41]
v_pk_mul_f32 v[82:83], v[82:83], v[40:41]
v_pk_mul_f32 v[84:85], v[84:85], v[40:41]
v_pk_mul_f32 v[86:87], v[86:87], v[40:41]
v_pk_mul_f32 v[88:89], v[88:89], v[40:41]
v_pk_mul_f32 v[90:91], v[90:91], v[40:41]
v_pk_mul_f32 v[92:93], v[92:93], v[40:41]
v_pk_mul_f32 v[94:95], v[94:95], v[40:41]
v_pk_mul_f32 v[96:97], v[96:97], v[40:41]
v_pk_mul_f32 v[98:99], v[98:99], v[40:41]
v_pk_mul_f32 v[100:101], v[100:101], v[40:41]
v_pk_mul_f32 v[102:103], v[102:103], v[40:41]
v_pk_mul_f32 v[104:105], v[104:105], v[40:41]
v_pk_mul_f32 v[106:107], v[106:107], v[40:41]
v_pk_mul_f32 v[108:109], v[108:109], v[40:41]
v_pk_mul_f32 v[110:111], v[110:111], v[40:41]
Vc 48,80,81
Vc 49,82,83
Vc 50,84,85
Vc 51,86,87
Vc 52,88,89
Vc 53,90,91
Vc 54,92,93
Vc 55,94,95
Vc 56,96,97
Vc 57,98,99
Vc 58,100,101
Vc 59,102,103
Vc 60,104,105
Vc 61,106,107
Vc 62,108,109
Vc 63,110,111
s_mul_i32 s3, s32, 4128
s_add_u32 s3, s3, 131072
v_mul_u32_u24 v42, 2064, v33
v_add3_u32 v42, v42, v36, s3
ds_write_b128 v42, v[48:51] offset:0
ds_write_b128 v42, v[52:55] offset:512
ds_write_b128 v42, v[56:59] offset:1024
ds_write_b128 v42, v[60:63] offset:1536
s_waitcnt vmcnt(8)
v_lshlrev_b32 v80, 16, v48
v_and_b32 v81, 0xffff0000, v48
v_lshlrev_b32_e64 v112, 16, v64
v_and_b32 v113, 0xffff0000, v64
v_pk_mul_f32 v[42:43], v[80:81], v[112:113]
v_lshlrev_b32_e64 v82, 16, v49
v_and_b32 v83, 0xffff0000, v49
v_lshlrev_b32_e64 v114, 16, v65
v_and_b32 v115, 0xffff0000, v65
v_pk_mul_f32 v[44:45], v[82:83], v[114:115]
v_lshlrev_b32_e64 v84, 16, v50
v_and_b32 v85, 0xffff0000, v50
v_lshlrev_b32_e64 v116, 16, v66
v_and_b32 v117, 0xffff0000, v66
v_pk_fma_f32 v[42:43], v[84:85], v[116:117], v[42:43]
v_lshlrev_b32_e64 v86, 16, v51
v_and_b32 v87, 0xffff0000, v51
v_lshlrev_b32_e64 v118, 16, v67
v_and_b32 v119, 0xffff0000, v67
v_pk_fma_f32 v[44:45], v[86:87], v[118:119], v[44:45]
v_lshlrev_b32_e64 v88, 16, v52
v_and_b32 v89, 0xffff0000, v52
v_lshlrev_b32_e64 v112, 16, v68
v_and_b32 v113, 0xffff0000, v68
v_pk_fma_f32 v[42:43], v[88:89], v[112:113], v[42:43]
v_lshlrev_b32_e64 v90, 16, v53
v_and_b32 v91, 0xffff0000, v53
v_lshlrev_b32_e64 v114, 16, v69
v_and_b32 v115, 0xffff0000, v69
v_pk_fma_f32 v[44:45], v[90:91], v[114:115], v[44:45]
v_lshlrev_b32_e64 v92, 16, v54
v_and_b32 v93, 0xffff0000, v54
v_lshlrev_b32_e64 v116, 16, v70
v_and_b32 v117, 0xffff0000, v70
v_pk_fma_f32 v[42:43], v[92:93], v[116:117], v[42:43]
v_lshlrev_b32_e64 v94, 16, v55
v_and_b32 v95, 0xffff0000, v55
v_lshlrev_b32_e64 v118, 16, v71
v_and_b32 v119, 0xffff0000, v71
v_pk_fma_f32 v[44:45], v[94:95], v[118:119], v[44:45]
v_lshlrev_b32_e64 v96, 16, v56
v_and_b32 v97, 0xffff0000, v56
v_lshlrev_b32_e64 v112, 16, v72
v_and_b32 v113, 0xffff0000, v72
v_pk_fma_f32 v[42:43], v[96:97], v[112:113], v[42:43]
v_lshlrev_b32_e64 v98, 16, v57
v_and_b32 v99, 0xffff0000, v57
v_lshlrev_b32_e64 v114, 16, v73
v_and_b32 v115, 0xffff0000, v73
v_pk_fma_f32 v[44:45], v[98:99], v[114:115], v[44:45]
v_lshlrev_b32_e64 v100, 16, v58
v_and_b32 v101, 0xffff0000, v58
v_lshlrev_b32_e64 v116, 16, v74
v_and_b32 v117, 0xffff0000, v74
v_pk_fma_f32 v[42:43], v[100:101], v[116:117], v[42:43]
v_lshlrev_b32_e64 v102, 16, v59
v_and_b32 v103, 0xffff0000, v59
v_lshlrev_b32_e64 v118, 16, v75
v_and_b32 v119, 0xffff0000, v75
v_pk_fma_f32 v[44:45], v[102:103], v[118:119], v[44:45]
v_lshlrev_b32_e64 v104, 16, v60
v_and_b32 v105, 0xffff0000, v60
v_lshlrev_b32_e64 v112, 16, v76
v_and_b32 v113, 0xffff0000, v76
v_pk_fma_f32 v[42:43], v[104:105], v[112:113], v[42:43]
v_lshlrev_b32_e64 v106, 16, v61
v_and_b32 v107, 0xffff0000, v61
v_lshlrev_b32_e64 v114, 16, v77
v_and_b32 v115, 0xffff0000, v77
v_pk_fma_f32 v[44:45], v[106:107], v[114:115], v[44:45]
v_lshlrev_b32_e64 v108, 16, v62
v_and_b32 v109, 0xffff0000, v62
v_lshlrev_b32_e64 v116, 16, v78
v_and_b32 v117, 0xffff0000, v78
v_pk_fma_f32 v[42:43], v[108:109], v[116:117], v[42:43]
v_lshlrev_b32_e64 v110, 16, v63
v_and_b32 v111, 0xffff0000, v63
v_lshlrev_b32_e64 v118, 16, v79
v_and_b32 v119, 0xffff0000, v79
v_pk_fma_f32 v[44:45], v[110:111], v[118:119], v[44:45]
v_pk_add_f32 v[42:43], v[42:43], v[44:45]
Va 45,42,43
s_nop 1
v_add_f32_dpp v45, v45, v45 quad_perm:[1,0,3,2] row_mask:0xf bank_mask:0xf
s_nop 1
v_add_f32_dpp v45, v45, v45 quad_perm:[2,3,0,1] row_mask:0xf bank_mask:0xf
s_nop 1
v_add_f32_dpp v45, v45, v45 row_half_mirror row_mask:0xf bank_mask:0xf
s_nop 1
v_add_f32_dpp v45, v45, v45 row_mirror row_mask:0xf bank_mask:0xf
v_mov_b32 v37, v45
s_nop 1
v_permlane16_swap_b32 v37, v45
v_add_f32_e64 v45, v45, v37
Vc 45,45,45
v_ashrrev_i32_e64 v46, 31, v45
v_or_b32 v46, 0x80000000, v46
v_xor_b32_e64 v45, v45, v46
v_and_b32 v45, 0xffff0000, v45
s_lshr_b32 s3, s36, 11
v_add_u32 v46, s3, v33
v_sub_u32 v44, 0xffff, v46
v_or_b32 v45, v45, v44
v_lshlrev_b32 v44, 2, v46
v_lshlrev_b32_e64 v46, 3, v46
v_xor_b32 v38, 0x80000000, v38
v_mov_b32_e64 v39, v40
s_mov_b32 s3, 5242880
s_mov_b32 s39, 5259264
s_mov_b32 exec_lo, 1
s_mov_b32 exec_hi, 1
buffer_store_dword v45, v44, s[20:23], s3 offen sc1
buffer_store_dwordx2 v[38:39], v46, s[20:23], s39 offen sc1
s_mov_b64 exec, -1
s_load_dwordx2 s[4:5], s[0:1], 16
s_load_dwordx4 s[40:43], s[0:1], 64
s_load_dwordx2 s[92:93], s[0:1], 40
s_load_dwordx2 s[94:95], s[0:1], 80
s_load_dwordx2 s[100:101], s[0:1], 0
s_mov_b32 s28, s64
s_and_b32 s29, s65, 0xffff
s_mov_b32 s30, 256
s_mov_b32 s31, 0x20000
s_waitcnt vmcnt(2)
s_waitcnt lgkmcnt(0)
s_barrier
s_nop 0
Ra 224,10,0
Ra 228,11,0
Ra 232,10,2048
Ra 236,11,2048
Ta 0,16,0
Ta 2,16,2048
Ta 4,16,16384
Ta 6,16,18432
Ta 8,17,0
Ta 10,17,2048
Ta 12,17,16384
Ta 14,17,18432
Ta 16,18,0
Ta 18,18,2048
Ta 20,18,16384
s_waitcnt lgkmcnt(9)
s_nop 0
Ta 22,18,18432
Ta 24,19,0
Ta 26,19,2048
Ta 28,19,16384
Ta 30,19,18432
Ta 32,20,0
s_waitcnt lgkmcnt(9)
s_nop 0
Ta 34,20,2048
Ta 36,20,16384
Ta 38,20,18432
Ta 40,21,0
Ta 42,21,2048
Ta 44,21,16384
s_waitcnt lgkmcnt(9)
s_nop 0
Ta 46,21,18432
Ta 48,22,0
Ta 50,22,2048
Ta 52,22,16384
Ta 54,22,18432
Ta 56,23,0
s_waitcnt lgkmcnt(9)
Ta 58,23,2048
Ta 60,23,16384
Ta 62,23,18432
s_cmp_lg_u32 s35, 0
s_cbranch_scc1 L_k1_vpath
Zvaa 48,0,224
v_and_b32 v46, 7, v0
v_mul_u32_u24 v30, 2064, v46
Mvaa 48,4,228
s_add_u32 m0, s57, 65536
Zvaa 52,8,224
buffer_load_dwordx4 v6, s[12:15], s52 offen offset:0 lds
Mvaa 52,12,228
Ra 240,10,4096
Zvaa 56,16,224
buffer_load_dwordx4 v7, s[12:15], s53 offen offset:1024 lds
Mvaa 56,20,228
v_lshrrev_b32_e64 v31, 3, v0
Zvaa 60,24,224
buffer_load_dwordx4 v6, s[12:15], s54 offen offset:2048 lds
Mvaa 60,28,228
Ra 244,11,4096
Zvaa 64,32,224
buffer_load_dwordx4 v7, s[12:15], s55 offen offset:3072 lds
Mvaa 64,36,228
s_add_u32 m0, s57, 69632
s_waitcnt lgkmcnt(10)
Zvaa 68,40,224
buffer_load_dwordx4 v8, s[12:15], s52 offen offset:0 lds
Mvaa 68,44,228
Ra 248,10,6144
s_waitcnt lgkmcnt(7)
Zvaa 72,48,224
buffer_load_dwordx4 v9, s[12:15], s53 offen offset:1024 lds
Mvaa 72,52,228
s_lshl_b32 s3, s32, 9
s_add_u32 s3, s3, 131072
v_lshl_add_u32 v30, v31, 4, v30
s_waitcnt lgkmcnt(3)
Zvaa 76,56,224
buffer_load_dwordx4 v8, s[12:15], s54 offen offset:2048 lds
Mvaa 76,60,228
Ra 252,11,6144
Zvaa 80,0,232
buffer_load_dwordx4 v9, s[12:15], s55 offen offset:3072 lds
Mvaa 80,4,236
s_add_u32 m0, s56, 65536
v_xor_b32 v6, 1572864, v6
v_xor_b32 v7, 1572864, v7
Zvaa 84,8,232
buffer_load_dwordx4 v2, s[8:11], s48 offen offset:0 lds
Mvaa 84,12,236
v_xor_b32 v8, 1572864, v8
v_xor_b32 v9, 1572864, v9
Zvaa 88,16,232
buffer_load_dwordx4 v3, s[8:11], s49 offen offset:1024 lds
Mvaa 88,20,236
v_add_u32 v30, s3, v30
v_lshlrev_b32 v31, 8, v31
Zvaa 92,24,232
buffer_load_dwordx4 v2, s[8:11], s50 offen offset:2048 lds
Mvaa 92,28,236
v_lshl_add_u32 v46, v46, 4, v31
Zvaa 96,32,232
buffer_load_dwordx4 v3, s[8:11], s51 offen offset:3072 lds
Mvaa 96,36,236
s_add_u32 m0, s56, 69632
Zvaa 100,40,232
buffer_load_dwordx4 v4, s[8:11], s48 offen offset:0 lds
Mvaa 100,44,236
Rv 34,30,128
Rv 38,30,256
Zvaa 104,48,232
buffer_load_dwordx4 v5, s[8:11], s49 offen offset:1024 lds
Mvaa 104,52,236
Rv 42,30,384
Rv 30,30,0
Zvaa 108,56,232
s_waitcnt lgkmcnt(4)
buffer_load_dwordx4 v4, s[8:11], s50 offen offset:2048 lds
Mvaa 108,60,236
s_lshr_b32 s3, s2, 1
s_mul_i32 s3, s3, 33792
s_add_u32 s3, s3, s57
Zvaa 112,0,240
buffer_load_dwordx4 v5, s[8:11], s51 offen offset:3072 lds
Mvaa 112,4,244
v_xor_b32 v2, 384, v2
v_xor_b32 v3, 384, v3
Zvaa 116,8,240
s_and_b32 s39, s2, 1
s_lshl_b32 s39, s39, 7
s_add_u32 s3, s3, s39
Mvaa 116,12,244
Ra 224,10,8192
v_xor_b32 v4, 384, v4
Zvaa 120,16,240
s_add_u32 s39, s3, 4096
Mvaa 120,20,244
v_xor_b32 v5, 384, v5
Zvaa 124,24,240
Mvaa 124,28,244
Ra 228,11,8192
Zvaa 128,32,240
Mvaa 128,36,244
Zvaa 132,40,240
Mvaa 132,44,244
Ra 232,10,10240
Zvaa 136,48,240
buffer_load_dword v1, v47, s[60:63], 0 offen
Mvaa 136,52,244
s_mul_i32 vcc_lo, s59, 1
v_xor_b32 v47, vcc_lo, v47
Zvaa 140,56,240
Mvaa 140,60,244
Ra 236,11,10240
Zvaa 144,0,248
Mvaa 144,4,252
Zvaa 148,8,248
Mvaa 148,12,252
Zvaa 152,16,248
Mvaa 152,20,252
Zvaa 156,24,248
Mvaa 156,28,252
Zvaa 160,32,248
Mvaa 160,36,252
Zvaa 164,40,248
Mvaa 164,44,252
Zvaa 168,48,248
Mvaa 168,52,252
s_waitcnt vmcnt(9)
Zvaa 172,56,248
s_waitcnt lgkmcnt(0)
s_barrier
Mvaa 172,60,252
s_add_u32 m0, s57, 0
Zvaa 176,0,224
buffer_load_dwordx4 v6, s[12:15], s52 offen offset:0 lds
Mvaa 176,4,228
Ta 64,14,0
Ta 66,14,2048
Zvaa 180,8,224
Mvaa 180,12,228
Ra 240,10,12288
Zvaa 184,16,224
buffer_load_dwordx4 v7, s[12:15], s53 offen offset:1024 lds
Mvaa 184,20,228
Ta 68,14,16384
Ta 70,14,18432
Zvaa 188,24,224
Mvaa 188,28,228
Ra 244,11,12288
Zvaa 192,32,224
buffer_load_dwordx4 v6, s[12:15], s54 offen offset:2048 lds
Mvaa 192,36,228
Ta 72,15,0
Ta 74,15,2048
Zvaa 196,40,224
Mvaa 196,44,228
Ra 248,10,14336
Zvaa 200,48,224
buffer_load_dwordx4 v7, s[12:15], s55 offen offset:3072 lds
Mvaa 200,52,228
Ta 76,15,16384
Ta 78,15,18432
Zvaa 204,56,224
Mvaa 204,60,228
s_add_u32 m0, s57, 4096
Ra 252,11,14336
Zvaa 208,0,232
buffer_load_dwordx4 v8, s[12:15], s52 offen offset:0 lds
Mvaa 208,4,236
Zvaa 212,8,232
Mvaa 212,12,236
Ta 80,24,0
Ta 82,24,2048
Zvaa 216,16,232
buffer_load_dwordx4 v9, s[12:15], s53 offen offset:1024 lds
Mvaa 216,20,236
Ta 84,24,16384
s_waitcnt lgkmcnt(9)
Ta 86,24,18432
Zvaa 220,24,232
Mvaa 220,28,236
Ta 88,25,0
Ta 90,25,2048
Zvaa 224,32,232
buffer_load_dwordx4 v8, s[12:15], s54 offen offset:2048 lds
Mvaa 224,36,236
Zvaa 228,40,232
Mvaa 228,44,236
Ta 92,25,16384
Ta 94,25,18432
Zvaa 232,48,232
buffer_load_dwordx4 v9, s[12:15], s55 offen offset:3072 lds
Mvaa 232,52,236
s_waitcnt vmcnt(9)
Ta 96,26,0
s_waitcnt lgkmcnt(9)
Ta 98,26,2048
Zvaa 236,56,232
s_barrier
v_xor_b32 v6, 524288, v6
v_xor_b32 v7, 524288, v7
Mvaa 236,60,236
s_add_u32 m0, s56, 0
Ta 100,26,16384
Ta 102,26,18432
Zvaa 240,0,240
buffer_load_dwordx4 v2, s[8:11], s48 offen offset:0 lds
Mvaa 240,4,244
v_xor_b32 v8, 524288, v8
v_xor_b32 v9, 524288, v9
Zvaa 244,8,240
Mvaa 244,12,244
Ra 224,12,0
Zvaa 248,16,240
buffer_load_dwordx4 v3, s[8:11], s49 offen offset:1024 lds
Mvaa 248,20,244
Ta 104,27,0
Ta 106,27,2048
Zvaa 252,24,240
Mvaa 252,28,244
s_waitcnt lgkmcnt(9)
Ra 228,13,0
Zaaa 128,32,240
buffer_load_dwordx4 v2, s[8:11], s50 offen offset:2048 lds
Maaa 128,36,244
Ta 108,27,16384
Ta 110,27,18432
Zaaa 132,40,240
Maaa 132,44,244
Ra 232,12,2048
Zaaa 136,48,240
buffer_load_dwordx4 v3, s[8:11], s51 offen offset:3072 lds
Maaa 136,52,244
Ta 112,28,0
Ta 114,28,2048
Zaaa 140,56,240
Maaa 140,60,244
s_add_u32 m0, s56, 4096
s_waitcnt lgkmcnt(9)
Ra 236,13,2048
Zaaa 144,0,248
buffer_load_dwordx4 v4, s[8:11], s48 offen offset:0 lds
Maaa 144,4,252
Zaaa 148,8,248
Maaa 148,12,252
Ta 116,28,16384
Ta 118,28,18432
Zaaa 152,16,248
buffer_load_dwordx4 v5, s[8:11], s49 offen offset:1024 lds
Maaa 152,20,252
Ta 120,29,0
Ta 122,29,2048
Zaaa 156,24,248
Maaa 156,28,252
Ta 124,29,16384
s_waitcnt lgkmcnt(9)
Ta 126,29,18432
Zaaa 160,32,248
buffer_load_dwordx4 v4, s[8:11], s50 offen offset:2048 lds
Maaa 160,36,252
Zaaa 164,40,248
Maaa 164,44,252
Zaaa 168,48,248
buffer_load_dwordx4 v5, s[8:11], s51 offen offset:3072 lds
Maaa 168,52,252
v_xor_b32 v2, 128, v2
v_xor_b32 v3, 128, v3
Zaaa 172,56,248
s_waitcnt lgkmcnt(6)
buffer_load_dword v1, v47, s[60:63], 0 offen
v_xor_b32 v4, 128, v4
v_xor_b32 v5, 128, v5
Maaa 172,60,252
s_waitcnt lgkmcnt(0)
s_mul_i32 vcc_lo, s59, 7
v_xor_b32 v47, vcc_lo, v47
Mvaa 48,64,224
buffer_store_dwordx4 v[30:33], v46, s[20:23], s3 offen offset:0 sc1
Mvaa 48,68,228
buffer_store_dwordx4 v[34:37], v46, s[20:23], s3 offen offset:2048 sc1
Mvaa 52,72,224
buffer_store_dwordx4 v[38:41], v46, s[20:23], s39 offen offset:0 sc1
Mvaa 52,76,228
Ra 240,12,4096
Mvaa 56,80,224
buffer_store_dwordx4 v[42:45], v46, s[20:23], s39 offen offset:2048 sc1
Mvaa 56,84,228
s_lshl_b32 s3, s34, 1
s_and_b32 s36, s32, 1
s_add_u32 s3, s3, s36
Mvaa 60,88,224
s_mul_i32 s3, s3, 1116160
s_mul_i32 s36, s33, 139264
s_add_u32 s3, s3, s36
Mvaa 60,92,228
Ra 244,13,4096
Mvaa 64,96,224
s_lshr_b32 s36, s32, 1
s_mul_i32 s36, s36, 69632
s_add_u32 s3, s3, s36
Mvaa 64,100,228
s_add_u32 s38, s3, 0
s_lshl_b32 s39, s34, 7
s_lshl_b32 s36, s33, 2
Mvaa 68,104,224
s_add_u32 s39, s39, s36
s_add_u32 s39, s39, 5296128
v_mov_b32_e64 v30, 1
Mvaa 68,108,228
Ra 248,12,6144
Mvaa 72,112,224
v_mov_b32_e64 v31, 0
Mvaa 72,116,228
s_cmp_eq_u32 s32, 0
s_cselect_b32 s39, s39, 2146435072
Mvaa 76,120,224
s_mov_b64 exec, 1
buffer_store_dword v31, v31, s[20:23], s39 offen sc1
s_mov_b64 exec, -1
Mvaa 76,124,228
Ra 252,13,6144
Mvaa 80,64,232
s_and_b32 s33, s2, 7
s_lshl_b32 s33, s33, 2
s_bfe_u32 s3, s2, 0x20003
Mvaa 80,68,236
s_add_u32 s33, s33, s3
s_lshr_b32 s34, s2, 5
s_lshl_b32 s64, s34, 7
Mvaa 84,72,232
s_lshl_b32 s3, s33, 2
s_add_u32 s64, s64, s3
s_add_u32 s64, s64, 5300224
Mvaa 84,76,236
s_lshl_b32 s65, s34, 8
s_sub_u32 s65, 1920, s65
v_mul_u32_u24 v32, s65, v0
Mvaa 88,80,232
s_cmp_eq_u32 s32, 0
s_cselect_b32 s64, s64, 2146435072
Mvaa 88,84,236
s_mov_b64 exec, 3
buffer_store_dword v31, v32, s[20:23], s64 offen sc1
s_mov_b64 exec, -1
Mvaa 92,88,232
s_lshl_b32 s3, s2, 2
s_add_u32 s3, s3, 5447680
v_lshlrev_b32_e64 v32, 10, v0
Mvaa 92,92,236
s_cmp_eq_u32 s32, 0
s_cselect_b32 s3, s3, 2146435072
Mvaa 96,96,232
s_mov_b64 exec, 0x1ff
buffer_store_dword v31, v32, s[20:23], s3 offen sc1
s_mov_b64 exec, -1
Mvaa 96,100,236
s_lshl_b32 s35, s34, 1
s_sub_u32 s36, 32, s35
s_add_u32 s35, s35, 2
Mvaa 100,104,232
s_lshl_b32 s44, s32, 12
s_lshl_b32 s58, s32, 1
s_sub_u32 s58, 7, s58
Mvaa 100,108,236
s_mul_i32 s58, s58, 33792
s_sub_u32 s3, 15, s34
s_lshl_b32 s45, s3, 3
Mvaa 104,112,232
s_add_u32 s45, s45, s32
s_lshl_b32 s46, s34, 3
s_add_u32 s46, s46, s32
Mvaa 104,116,236
s_mov_b32 s68, s42
s_and_b32 s69, s43, 0xffff
s_mov_b32 s70, 7340032
Mvaa 108,120,232
s_waitcnt lgkmcnt(0)
Mvaa 108,124,236
s_mov_b32 s71, 0x20000
s_cmp_eq_u32 s32, 0
s_cselect_b32 s37, 0, 2146435072
Mvaa 112,64,240
s_lshl_b32 s3, s33, 8
s_add_u32 s16, s4, s3
s_addc_u32 s17, s5, 0
s_and_b32 s17, s17, 0xffff
Mvaa 112,68,244
s_mov_b32 s18, 0
s_mov_b32 s19, 0x20000
s_sub_u32 s18, 8388608, s3
Mvaa 116,72,240
v_and_b32 v33, 15, v0
v_lshrrev_b32 v32, 1, v33
Mvaa 116,76,244
Ra 224,12,8192
Mvaa 120,80,240
v_and_b32 v33, 1, v0
v_lshlrev_b32 v32, 13, v32
Mvaa 120,84,244
v_lshl_add_u32 v45, v33, 7, v32
Mvaa 124,88,240
s_lshl_b32 s3, s32, 3
s_add_u32 s3, s3, s34
s_mul_i32 s47, s3, 65536
Mvaa 124,92,244
Ra 228,13,8192
Mvaa 128,96,240
s_bfe_u32 s6, s2, 131075
s_lshl_b32 s3, s32, 8
s_or_b32 s6, s6, s3
Mvaa 128,100,244
Mvaa 132,104,240
Mvaa 132,108,244
Ra 232,12,10240
Mvaa 136,112,240
Mvaa 136,116,244
Mvaa 140,120,240
Mvaa 140,124,244
Ra 236,13,10240
Mvaa 144,64,248
Mvaa 144,68,252
Mvaa 148,72,248
Mvaa 148,76,252
Mvaa 152,80,248
Mvaa 152,84,252
Mvaa 156,88,248
Mvaa 156,92,252
Mvaa 160,96,248
Mvaa 160,100,252
Mvaa 164,104,248
Mvaa 164,108,252
Mvaa 168,112,248
Mvaa 168,116,252
s_waitcnt vmcnt(16)
Mvaa 172,120,248
s_waitcnt lgkmcnt(0)
s_barrier
Mvaa 172,124,252
s_add_u32 m0, s57, 65536
Mvaa 176,64,224
buffer_load_dwordx4 v6, s[12:15], s52 offen offset:0 lds
Mvaa 176,68,228
Ta 0,16,0
Ta 2,16,2048
Mvaa 180,72,224
Mvaa 180,76,228
Ra 240,12,12288
Mvaa 184,80,224
buffer_load_dwordx4 v7, s[12:15], s53 offen offset:1024 lds
Mvaa 184,84,228
Ta 4,16,16384
Ta 6,16,18432
Mvaa 188,88,224
Mvaa 188,92,228
Ra 244,13,12288
Mvaa 192,96,224
buffer_load_dwordx4 v6, s[12:15], s54 offen offset:2048 lds
Mvaa 192,100,228
Ta 8,17,0
Ta 10,17,2048
Mvaa 196,104,224
Mvaa 196,108,228
Ra 248,12,14336
Mvaa 200,112,224
buffer_load_dwordx4 v7, s[12:15], s55 offen offset:3072 lds
Mvaa 200,116,228
Ta 12,17,16384
Ta 14,17,18432
Mvaa 204,120,224
Mvaa 204,124,228
s_add_u32 m0, s57, 69632
Ra 252,13,14336
Mvaa 208,64,232
buffer_load_dwordx4 v8, s[12:15], s52 offen offset:0 lds
Mvaa 208,68,236
Mvaa 212,72,232
Mvaa 212,76,236
Ta 16,18,0
Ta 18,18,2048
Mvaa 216,80,232
buffer_load_dwordx4 v9, s[12:15], s53 offen offset:1024 lds
Mvaa 216,84,236
Ta 20,18,16384
s_waitcnt lgkmcnt(9)
Ta 22,18,18432
Mvaa 220,88,232
Mvaa 220,92,236
Ta 24,19,0
Ta 26,19,2048
Mvaa 224,96,232
buffer_load_dwordx4 v8, s[12:15], s54 offen offset:2048 lds
Mvaa 224,100,236
Mvaa 228,104,232
Mvaa 228,108,236
Ta 28,19,16384
Ta 30,19,18432
Mvaa 232,112,232
buffer_load_dwordx4 v9, s[12:15], s55 offen offset:3072 lds
Mvaa 232,116,236
s_waitcnt vmcnt(16)
Ta 32,20,0
s_waitcnt lgkmcnt(9)
Ta 34,20,2048
Mvaa 236,120,232
s_barrier
v_xor_b32 v6, 3670016, v6
v_xor_b32 v7, 3670016, v7
Mvaa 236,124,236
s_add_u32 m0, s56, 65536
Ta 36,20,16384
Ta 38,20,18432
Mvaa 240,64,240
buffer_load_dwordx4 v2, s[8:11], s48 offen offset:0 lds
Mvaa 240,68,244
v_xor_b32 v8, 3670016, v8
v_xor_b32 v9, 3670016, v9
Mvaa 244,72,240
Mvaa 244,76,244
Ra 224,10,0
Mvaa 248,80,240
buffer_load_dwordx4 v3, s[8:11], s49 offen offset:1024 lds
Mvaa 248,84,244
Ta 40,21,0
Ta 42,21,2048
Mvaa 252,88,240
Mvaa 252,92,244
s_waitcnt lgkmcnt(9)
Ra 228,11,0
Maaa 128,96,240
buffer_load_dwordx4 v2, s[8:11], s50 offen offset:2048 lds
Maaa 128,100,244
Ta 44,21,16384
Ta 46,21,18432
Maaa 132,104,240
Maaa 132,108,244
Ra 232,10,2048
Maaa 136,112,240
buffer_load_dwordx4 v3, s[8:11], s51 offen offset:3072 lds
Maaa 136,116,244
Ta 48,22,0
Ta 50,22,2048
Maaa 140,120,240
Maaa 140,124,244
s_add_u32 m0, s56, 69632
s_waitcnt lgkmcnt(9)
Ra 236,11,2048
Maaa 144,64,248
buffer_load_dwordx4 v4, s[8:11], s48 offen offset:0 lds
Maaa 144,68,252
Maaa 148,72,248
Maaa 148,76,252
Ta 52,22,16384
Ta 54,22,18432
Maaa 152,80,248
buffer_load_dwordx4 v5, s[8:11], s49 offen offset:1024 lds
Maaa 152,84,252
Ta 56,23,0
Ta 58,23,2048
Maaa 156,88,248
Maaa 156,92,252
Ta 60,23,16384
s_waitcnt lgkmcnt(9)
Ta 62,23,18432
Maaa 160,96,248
buffer_load_dwordx4 v4, s[8:11], s50 offen offset:2048 lds
Maaa 160,100,252
Maaa 164,104,248
Maaa 164,108,252
Maaa 168,112,248
buffer_load_dwordx4 v5, s[8:11], s51 offen offset:3072 lds
Maaa 168,116,252
v_xor_b32 v2, 896, v2
v_xor_b32 v3, 896, v3
Maaa 172,120,248
s_waitcnt lgkmcnt(6)
buffer_load_dword v1, v47, s[60:63], 0 offen
v_xor_b32 v4, 896, v4
v_xor_b32 v5, 896, v5
Maaa 172,124,252
s_waitcnt lgkmcnt(0)
s_mul_i32 vcc_lo, s59, 1
v_xor_b32 v47, vcc_lo, v47
Mvaa 48,0,224
Mvaa 48,4,228
Mvaa 52,8,224
Mvaa 52,12,228
Ra 240,10,4096
Mvaa 56,16,224
Mvaa 56,20,228
Mvaa 60,24,224
Mvaa 60,28,228
Ra 244,11,4096
Mvaa 64,32,224
Mvaa 64,36,228
Mvaa 68,40,224
Mvaa 68,44,228
Ra 248,10,6144
Mvaa 72,48,224
Mvaa 72,52,228
Mvaa 76,56,224
Mvaa 76,60,228
Ra 252,11,6144
Mvaa 80,0,232
Mvaa 80,4,236
Mvaa 84,8,232
Mvaa 84,12,236
Mvaa 88,16,232
Mvaa 88,20,236
Mvaa 92,24,232
Mvaa 92,28,236
Mvaa 96,32,232
Mvaa 96,36,236
Mvaa 100,40,232
Mvaa 100,44,236
Mvaa 104,48,232
Mvaa 104,52,236
Mvaa 108,56,232
s_waitcnt lgkmcnt(0)
Mvaa 108,60,236
Mvaa 112,0,240
Mvaa 112,4,244
Mvaa 116,8,240
Mvaa 116,12,244
Ra 224,10,8192
Mvaa 120,16,240
Mvaa 120,20,244
Mvaa 124,24,240
Mvaa 124,28,244
Ra 228,11,8192
Mvaa 128,32,240
Mvaa 128,36,244
Mvaa 132,40,240
Mvaa 132,44,244
Ra 232,10,10240
Mvaa 136,48,240
Mvaa 136,52,244
Mvaa 140,56,240
Mvaa 140,60,244
Ra 236,11,10240
Mvaa 144,0,248
Mvaa 144,4,252
Mvaa 148,8,248
Mvaa 148,12,252
Mvaa 152,16,248
Mvaa 152,20,252
Mvaa 156,24,248
Mvaa 156,28,252
Mvaa 160,32,248
Mvaa 160,36,252
Mvaa 164,40,248
Mvaa 164,44,252
Mvaa 168,48,248
Mvaa 168,52,252
s_waitcnt vmcnt(9)
Mvaa 172,56,248
s_waitcnt lgkmcnt(0)
s_barrier
Mvaa 172,60,252
s_add_u32 m0, s57, 0
Mvaa 176,0,224
buffer_load_dwordx4 v6, s[12:15], s52 offen offset:0 lds
Mvaa 176,4,228
Ta 64,14,0
Ta 66,14,2048
Mvaa 180,8,224
Mvaa 180,12,228
Ra 240,10,12288
Mvaa 184,16,224
buffer_load_dwordx4 v7, s[12:15], s53 offen offset:1024 lds
Mvaa 184,20,228
Ta 68,14,16384
Ta 70,14,18432
Mvaa 188,24,224
Mvaa 188,28,228
Ra 244,11,12288
Mvaa 192,32,224
buffer_load_dwordx4 v6, s[12:15], s54 offen offset:2048 lds
Mvaa 192,36,228
Ta 72,15,0
Ta 74,15,2048
Mvaa 196,40,224
Mvaa 196,44,228
Ra 248,10,14336
Mvaa 200,48,224
buffer_load_dwordx4 v7, s[12:15], s55 offen offset:3072 lds
Mvaa 200,52,228
Ta 76,15,16384
Ta 78,15,18432
Mvaa 204,56,224
s_cmp_eq_u32 s6, 0
s_cselect_b32 s3, 0, 2146435072
Mvaa 204,60,228
s_add_u32 m0, s57, 4096
Ra 252,11,14336
Mvaa 208,0,232
buffer_load_dwordx4 v8, s[12:15], s52 offen offset:0 lds
Mvaa 208,4,236
s_mov_b64 exec, 1
buffer_atomic_add v30, v31, s[28:31], s3 offen sc1
s_mov_b64 exec, -1
Mvaa 212,8,232
Mvaa 212,12,236
Ta 80,24,0
Ta 82,24,2048
Mvaa 216,16,232
buffer_load_dwordx4 v9, s[12:15], s53 offen offset:1024 lds
Mvaa 216,20,236
Ta 84,24,16384
s_waitcnt lgkmcnt(9)
Ta 86,24,18432
Mvaa 220,24,232
Mvaa 220,28,236
Ta 88,25,0
Ta 90,25,2048
Mvaa 224,32,232
buffer_load_dwordx4 v8, s[12:15], s54 offen offset:2048 lds
Mvaa 224,36,236
Mvaa 228,40,232
Mvaa 228,44,236
Ta 92,25,16384
Ta 94,25,18432
Mvaa 232,48,232
buffer_load_dwordx4 v9, s[12:15], s55 offen offset:3072 lds
Mvaa 232,52,236
s_waitcnt vmcnt(10)
Ta 96,26,0
s_waitcnt lgkmcnt(9)
Ta 98,26,2048
Mvaa 236,56,232
s_barrier
v_xor_b32 v6, 524288, v6
v_xor_b32 v7, 524288, v7
Mvaa 236,60,236
s_add_u32 m0, s56, 0
Ta 100,26,16384
Ta 102,26,18432
Mvaa 240,0,240
buffer_load_dwordx4 v2, s[8:11], s48 offen offset:0 lds
Mvaa 240,4,244
v_xor_b32 v8, 524288, v8
v_xor_b32 v9, 524288, v9
Mvaa 244,8,240
Mvaa 244,12,244
Ra 224,12,0
Mvaa 248,16,240
buffer_load_dwordx4 v3, s[8:11], s49 offen offset:1024 lds
Mvaa 248,20,244
Ta 104,27,0
Ta 106,27,2048
Mvaa 252,24,240
Mvaa 252,28,244
s_waitcnt lgkmcnt(9)
Ra 228,13,0
Maaa 128,32,240
buffer_load_dwordx4 v2, s[8:11], s50 offen offset:2048 lds
Maaa 128,36,244
Ta 108,27,16384
Ta 110,27,18432
Maaa 132,40,240
Maaa 132,44,244
Ra 232,12,2048
Maaa 136,48,240
buffer_load_dwordx4 v3, s[8:11], s51 offen offset:3072 lds
Maaa 136,52,244
Ta 112,28,0
Ta 114,28,2048
Maaa 140,56,240
Maaa 140,60,244
s_add_u32 m0, s56, 4096
s_waitcnt lgkmcnt(9)
Ra 236,13,2048
Maaa 144,0,248
buffer_load_dwordx4 v4, s[8:11], s48 offen offset:0 lds
Maaa 144,4,252
Maaa 148,8,248
Maaa 148,12,252
Ta 116,28,16384
Ta 118,28,18432
Maaa 152,16,248
buffer_load_dwordx4 v5, s[8:11], s49 offen offset:1024 lds
Maaa 152,20,252
Ta 120,29,0
Ta 122,29,2048
Maaa 156,24,248
Maaa 156,28,252
Ta 124,29,16384
s_waitcnt lgkmcnt(9)
Ta 126,29,18432
Maaa 160,32,248
buffer_load_dwordx4 v4, s[8:11], s50 offen offset:2048 lds
Maaa 160,36,252
Maaa 164,40,248
Maaa 164,44,252
Maaa 168,48,248
buffer_load_dwordx4 v5, s[8:11], s51 offen offset:3072 lds
Maaa 168,52,252
v_xor_b32 v2, 128, v2
v_xor_b32 v3, 128, v3
Maaa 172,56,248
s_waitcnt lgkmcnt(6)
buffer_load_dword v1, v47, s[60:63], 0 offen
v_xor_b32 v4, 128, v4
v_xor_b32 v5, 128, v5
Maaa 172,60,252
s_waitcnt lgkmcnt(0)
s_mul_i32 vcc_lo, s59, 3
v_xor_b32 v47, vcc_lo, v47
Mvaa 48,64,224
buffer_load_dword v44, v45, s[16:19], s47 offen
Mvaa 48,68,228
s_add_u32 s47, s47, 2097152
Mvaa 52,72,224
Mvaa 52,76,228
Ra 240,12,4096
Mvaa 56,80,224
Mvaa 56,84,228
Mvaa 60,88,224
Mvaa 60,92,228
Ra 244,13,4096
Mvaa 64,96,224
Mvaa 64,100,228
Mvaa 68,104,224
Mvaa 68,108,228
Ra 248,12,6144
Mvaa 72,112,224
Mvaa 72,116,228
Mvaa 76,120,224
Mvaa 76,124,228
Ra 252,13,6144
Mvaa 80,64,232
Mvaa 80,68,236
Mvaa 84,72,232
Mvaa 84,76,236
Mvaa 88,80,232
Mvaa 88,84,236
Mvaa 92,88,232
Mvaa 92,92,236
Mvaa 96,96,232
Mvaa 96,100,236
Mvaa 100,104,232
s_cmp_eq_u32 s6, 1
s_cselect_b32 s3, 0, 2146435072
Mvaa 100,108,236
s_mov_b64 exec, 1
buffer_atomic_add v30, v31, s[28:31], s3 offen sc1
s_mov_b64 exec, -1
Mvaa 104,112,232
Mvaa 104,116,236
Mvaa 108,120,232
s_waitcnt lgkmcnt(0)
Mvaa 108,124,236
Mvaa 112,64,240
Mvaa 112,68,244
Mvaa 116,72,240
Mvaa 116,76,244
Ra 224,12,8192
Mvaa 120,80,240
Mvaa 120,84,244
Mvaa 124,88,240
Mvaa 124,92,244
Ra 228,13,8192
Mvaa 128,96,240
Mvaa 128,100,244
Mvaa 132,104,240
Mvaa 132,108,244
Ra 232,12,10240
Mvaa 136,112,240
Mvaa 136,116,244
Mvaa 140,120,240
Mvaa 140,124,244
Ra 236,13,10240
Mvaa 144,64,248
Mvaa 144,68,252
Mvaa 148,72,248
Mvaa 148,76,252
Mvaa 152,80,248
Mvaa 152,84,252
Mvaa 156,88,248
Mvaa 156,92,252
Mvaa 160,96,248
Mvaa 160,100,252
Mvaa 164,104,248
Mvaa 164,108,252
Mvaa 168,112,248
Mvaa 168,116,252
s_waitcnt vmcnt(11)
Mvaa 172,120,248
s_waitcnt lgkmcnt(0)
s_barrier
Mvaa 172,124,252
s_add_u32 m0, s57, 65536
Mvaa 176,64,224
buffer_load_dwordx4 v6, s[12:15], s52 offen offset:0 lds
Mvaa 176,68,228
Ta 0,16,0
Ta 2,16,2048
Mvaa 180,72,224
Mvaa 180,76,228
Ra 240,12,12288
Mvaa 184,80,224
buffer_load_dwordx4 v7, s[12:15], s53 offen offset:1024 lds
Mvaa 184,84,228
Ta 4,16,16384
Ta 6,16,18432
Mvaa 188,88,224
Mvaa 188,92,228
Ra 244,13,12288
Mvaa 192,96,224
buffer_load_dwordx4 v6, s[12:15], s54 offen offset:2048 lds
Mvaa 192,100,228
Ta 8,17,0
Ta 10,17,2048
Mvaa 196,104,224
Mvaa 196,108,228
Ra 248,12,14336
Mvaa 200,112,224
buffer_load_dwordx4 v7, s[12:15], s55 offen offset:3072 lds
Mvaa 200,116,228
Ta 12,17,16384
Ta 14,17,18432
Mvaa 204,120,224
Mvaa 204,124,228
s_add_u32 m0, s57, 69632
Ra 252,13,14336
Mvaa 208,64,232
buffer_load_dwordx4 v8, s[12:15], s52 offen offset:0 lds
Mvaa 208,68,236
Mvaa 212,72,232
Mvaa 212,76,236
Ta 16,18,0
Ta 18,18,2048
Mvaa 216,80,232
buffer_load_dwordx4 v9, s[12:15], s53 offen offset:1024 lds
Mvaa 216,84,236
Ta 20,18,16384
s_waitcnt lgkmcnt(9)
Ta 22,18,18432
Mvaa 220,88,232
Mvaa 220,92,236
Ta 24,19,0
Ta 26,19,2048
Mvaa 224,96,232
buffer_load_dwordx4 v8, s[12:15], s54 offen offset:2048 lds
Mvaa 224,100,236
Mvaa 228,104,232
Mvaa 228,108,236
Ta 28,19,16384
Ta 30,19,18432
Mvaa 232,112,232
buffer_load_dwordx4 v9, s[12:15], s55 offen offset:3072 lds
Mvaa 232,116,236
s_waitcnt vmcnt(11)
Ta 32,20,0
s_waitcnt lgkmcnt(9)
Ta 34,20,2048
Mvaa 236,120,232
s_barrier
v_xor_b32 v6, 1572864, v6
v_xor_b32 v7, 1572864, v7
Mvaa 236,124,236
s_add_u32 m0, s56, 65536
Ta 36,20,16384
Ta 38,20,18432
Mvaa 240,64,240
buffer_load_dwordx4 v2, s[8:11], s48 offen offset:0 lds
Mvaa 240,68,244
v_xor_b32 v8, 1572864, v8
v_xor_b32 v9, 1572864, v9
Mvaa 244,72,240
Mvaa 244,76,244
Ra 224,10,0
Mvaa 248,80,240
buffer_load_dwordx4 v3, s[8:11], s49 offen offset:1024 lds
Mvaa 248,84,244
Ta 40,21,0
Ta 42,21,2048
Mvaa 252,88,240
Mvaa 252,92,244
s_waitcnt lgkmcnt(9)
Ra 228,11,0
Maaa 128,96,240
buffer_load_dwordx4 v2, s[8:11], s50 offen offset:2048 lds
Maaa 128,100,244
Ta 44,21,16384
Ta 46,21,18432
Maaa 132,104,240
s_cmp_eq_u32 s6, 2
s_cselect_b32 s3, 0, 2146435072
Maaa 132,108,244
Ra 232,10,2048
Maaa 136,112,240
buffer_load_dwordx4 v3, s[8:11], s51 offen offset:3072 lds
Maaa 136,116,244
Ta 48,22,0
Ta 50,22,2048
Maaa 140,120,240
s_mov_b64 exec, 1
buffer_atomic_add v30, v31, s[28:31], s3 offen sc1
s_mov_b64 exec, -1
Maaa 140,124,244
s_add_u32 m0, s56, 69632
s_waitcnt lgkmcnt(9)
Ra 236,11,2048
Maaa 144,64,248
buffer_load_dwordx4 v4, s[8:11], s48 offen offset:0 lds
Maaa 144,68,252
Maaa 148,72,248
Maaa 148,76,252
Ta 52,22,16384
Ta 54,22,18432
Maaa 152,80,248
buffer_load_dwordx4 v5, s[8:11], s49 offen offset:1024 lds
Maaa 152,84,252
Ta 56,23,0
Ta 58,23,2048
Maaa 156,88,248
Maaa 156,92,252
Ta 60,23,16384
s_waitcnt lgkmcnt(9)
Ta 62,23,18432
Maaa 160,96,248
buffer_load_dwordx4 v4, s[8:11], s50 offen offset:2048 lds
Maaa 160,100,252
Maaa 164,104,248
Maaa 164,108,252
Maaa 168,112,248
buffer_load_dwordx4 v5, s[8:11], s51 offen offset:3072 lds
Maaa 168,116,252
v_xor_b32 v2, 384, v2
v_xor_b32 v3, 384, v3
Maaa 172,120,248
s_waitcnt lgkmcnt(6)
buffer_load_dword v1, v47, s[60:63], 0 offen
v_xor_b32 v4, 384, v4
v_xor_b32 v5, 384, v5
Maaa 172,124,252
s_waitcnt lgkmcnt(0)
s_mul_i32 vcc_lo, s59, 1
v_xor_b32_e64 v47, vcc_lo, v47
Mvaa 48,0,224
buffer_load_dword v44, v45, s[16:19], s47 offen
Mvaa 48,4,228
s_add_u32 s47, s47, 2097152
Mvaa 52,8,224
Mvaa 52,12,228
Ra 240,10,4096
Mvaa 56,16,224
Mvaa 56,20,228
Mvaa 60,24,224
Mvaa 60,28,228
Ra 244,11,4096
Mvaa 64,32,224
Mvaa 64,36,228
Mvaa 68,40,224
Mvaa 68,44,228
Ra 248,10,6144
Mvaa 72,48,224
Mvaa 72,52,228
Mvaa 76,56,224
Mvaa 76,60,228
Ra 252,11,6144
Mvaa 80,0,232
Mvaa 80,4,236
Mvaa 84,8,232
Mvaa 84,12,236
Mvaa 88,16,232
Mvaa 88,20,236
Mvaa 92,24,232
Mvaa 92,28,236
Mvaa 96,32,232
Mvaa 96,36,236
Mvaa 100,40,232
Mvaa 100,44,236
Mvaa 104,48,232
Mvaa 104,52,236
Mvaa 108,56,232
s_waitcnt lgkmcnt(0)
Mvaa 108,60,236
Mvaa 112,0,240
Mvaa 112,4,244
Mvaa 116,8,240
Mvaa 116,12,244
Ra 224,10,8192
Mvaa 120,16,240
Mvaa 120,20,244
Mvaa 124,24,240
Mvaa 124,28,244
Ra 228,11,8192
Mvaa 128,32,240
Mvaa 128,36,244
Mvaa 132,40,240
Mvaa 132,44,244
Ra 232,10,10240
Mvaa 136,48,240
Mvaa 136,52,244
Mvaa 140,56,240
Mvaa 140,60,244
Ra 236,11,10240
Mvaa 144,0,248
Mvaa 144,4,252
Mvaa 148,8,248
Mvaa 148,12,252
Mvaa 152,16,248
s_cmp_eq_u32 s6, 3
s_cselect_b32 s3, 0, 2146435072
Mvaa 152,20,252
s_mov_b64 exec, 1
buffer_atomic_add v30, v31, s[28:31], s3 offen sc1
s_mov_b64 exec, -1
Mvaa 156,24,248
Mvaa 156,28,252
Mvaa 160,32,248
Mvaa 160,36,252
Mvaa 164,40,248
Mvaa 164,44,252
Mvaa 168,48,248
Mvaa 168,52,252
s_waitcnt vmcnt(12)
Mvaa 172,56,248
s_waitcnt lgkmcnt(0)
s_barrier
Mvaa 172,60,252
s_add_u32 m0, s57, 0
Mvaa 176,0,224
buffer_load_dwordx4 v6, s[12:15], s52 offen offset:0 lds
Mvaa 176,4,228
Ta 64,14,0
Ta 66,14,2048
Mvaa 180,8,224
Mvaa 180,12,228
Ra 240,10,12288
Mvaa 184,16,224
buffer_load_dwordx4 v7, s[12:15], s53 offen offset:1024 lds
Mvaa 184,20,228
Ta 68,14,16384
Ta 70,14,18432
Mvaa 188,24,224
Mvaa 188,28,228
Ra 244,11,12288
Mvaa 192,32,224
buffer_load_dwordx4 v6, s[12:15], s54 offen offset:2048 lds
Mvaa 192,36,228
Ta 72,15,0
Ta 74,15,2048
Mvaa 196,40,224
Mvaa 196,44,228
Ra 248,10,14336
Mvaa 200,48,224
buffer_load_dwordx4 v7, s[12:15], s55 offen offset:3072 lds
Mvaa 200,52,228
Ta 76,15,16384
Ta 78,15,18432
Mvaa 204,56,224
Mvaa 204,60,228
s_add_u32 m0, s57, 4096
Ra 252,11,14336
Mvaa 208,0,232
buffer_load_dwordx4 v8, s[12:15], s52 offen offset:0 lds
Mvaa 208,4,236
Mvaa 212,8,232
Mvaa 212,12,236
Ta 80,24,0
Ta 82,24,2048
Mvaa 216,16,232
buffer_load_dwordx4 v9, s[12:15], s53 offen offset:1024 lds
Mvaa 216,20,236
Ta 84,24,16384
s_waitcnt lgkmcnt(9)
Ta 86,24,18432
Mvaa 220,24,232
Mvaa 220,28,236
Ta 88,25,0
Ta 90,25,2048
Mvaa 224,32,232
buffer_load_dwordx4 v8, s[12:15], s54 offen offset:2048 lds
Mvaa 224,36,236
Mvaa 228,40,232
Mvaa 228,44,236
Ta 92,25,16384
Ta 94,25,18432
Mvaa 232,48,232
buffer_load_dwordx4 v9, s[12:15], s55 offen offset:3072 lds
Mvaa 232,52,236
s_waitcnt vmcnt(11)
Ta 96,26,0
s_waitcnt lgkmcnt(9)
Ta 98,26,2048
Mvaa 236,56,232
s_barrier
v_xor_b32 v6, 524288, v6
v_xor_b32 v7, 524288, v7
Mvaa 236,60,236
s_add_u32 m0, s56, 0
Ta 100,26,16384
Ta 102,26,18432
Mvaa 240,0,240
buffer_load_dwordx4 v2, s[8:11], s48 offen offset:0 lds
Mvaa 240,4,244
v_xor_b32 v8, 524288, v8
v_xor_b32 v9, 524288, v9
Mvaa 244,8,240
Mvaa 244,12,244
Ra 224,12,0
Mvaa 248,16,240
buffer_load_dwordx4 v3, s[8:11], s49 offen offset:1024 lds
Mvaa 248,20,244
Ta 104,27,0
Ta 106,27,2048
Mvaa 252,24,240
Mvaa 252,28,244
s_waitcnt lgkmcnt(9)
Ra 228,13,0
Maaa 128,32,240
buffer_load_dwordx4 v2, s[8:11], s50 offen offset:2048 lds
Maaa 128,36,244
Ta 108,27,16384
Ta 110,27,18432
Maaa 132,40,240
Maaa 132,44,244
Ra 232,12,2048
Maaa 136,48,240
buffer_load_dwordx4 v3, s[8:11], s51 offen offset:3072 lds
Maaa 136,52,244
Ta 112,28,0
Ta 114,28,2048
Maaa 140,56,240
Maaa 140,60,244
s_add_u32 m0, s56, 4096
s_waitcnt lgkmcnt(9)
Ra 236,13,2048
Maaa 144,0,248
buffer_load_dwordx4 v4, s[8:11], s48 offen offset:0 lds
Maaa 144,4,252
Maaa 148,8,248
Maaa 148,12,252
Ta 116,28,16384
Ta 118,28,18432
Maaa 152,16,248
buffer_load_dwordx4 v5, s[8:11], s49 offen offset:1024 lds
Maaa 152,20,252
Ta 120,29,0
Ta 122,29,2048
Maaa 156,24,248
Maaa 156,28,252
Ta 124,29,16384
s_waitcnt lgkmcnt(9)
Ta 126,29,18432
Maaa 160,32,248
buffer_load_dwordx4 v4, s[8:11], s50 offen offset:2048 lds
Maaa 160,36,252
Maaa 164,40,248
Maaa 164,44,252
Maaa 168,48,248
buffer_load_dwordx4 v5, s[8:11], s51 offen offset:3072 lds
Maaa 168,52,252
v_xor_b32 v2, 128, v2
v_xor_b32 v3, 128, v3
Maaa 172,56,248
s_waitcnt lgkmcnt(6)
buffer_load_dword v1, v47, s[60:63], 0 offen
v_xor_b32 v4, 128, v4
v_xor_b32 v5, 128, v5
Maaa 172,60,252
s_waitcnt lgkmcnt(0)
s_mul_i32 vcc_lo, s59, 7
v_xor_b32 v47, vcc_lo, v47
Mvaa 48,64,224
buffer_load_dword v44, v45, s[16:19], s47 offen
Mvaa 48,68,228
s_add_u32 s47, s47, 2097152
v_lshrrev_b32 v32, 4, v0
v_and_b32 v33, 15, v0
Mvaa 52,72,224
s_lshl_b32 s3, s32, 4
v_add_u32 v34, s3, v32
v_lshlrev_b32_e64 v36, 1, v32
Mvaa 52,76,228
Ra 240,12,4096
Mvaa 56,80,224
v_xor_b32 v36, v36, v33
v_xor_b32 v37, 8, v36
Mvaa 56,84,228
Mvaa 60,88,224
Mvaa 60,92,228
Ra 244,13,4096
Mvaa 64,96,224
s_getpc_b64 s[6:7]
L_cpf2:
s_add_u32 s6, s6, (L_phase2-L_cpf2)&0xffffffff
s_addc_u32 s7, s7, ((L_phase2-L_cpf2)>>32)&0xffffffff
Mvaa 64,100,228
s_lshr_b32 s3, s2, 3
s_lshl_b32 s3, s3, 2
s_add_u32 s3, s3, s32
Mvaa 68,104,224
s_lshl_b32 s3, s3, 10
v_and_b32 v42, 7, v0
v_lshlrev_b32_e64 v42, 7, v42
Mvaa 68,108,228
Ra 248,12,6144
Mvaa 72,112,224
v_add_u32_e64 v42, s3, v42
v_min_u32 v42, L_k2_fin-L_phase2-4, v42
Mvaa 72,116,228
v_mov_b32_e64 v41, s7
Mvaa 76,120,224
v_add_co_u32 v40, vcc, s6, v42
s_nop 1
v_addc_co_u32 v41, vcc, 0, v41, vcc
Mvaa 76,124,228
Ra 252,13,6144
Mvaa 80,64,232
global_load_dword v38, v[40:41], off
Mvaa 80,68,236
Mvaa 84,72,232
Mvaa 84,76,236
Mvaa 88,80,232
Mvaa 88,84,236
Mvaa 92,88,232
Mvaa 92,92,236
Mvaa 96,96,232
Mvaa 96,100,236
Mvaa 100,104,232
Mvaa 100,108,236
Mvaa 104,112,232
Mvaa 104,116,236
Mvaa 108,120,232
s_waitcnt lgkmcnt(0)
Mvaa 108,124,236
Mvaa 112,64,240
Mvaa 112,68,244
Mvaa 116,72,240
Mvaa 116,76,244
Ra 224,12,8192
Mvaa 120,80,240
Mvaa 120,84,244
Mvaa 124,88,240
Mvaa 124,92,244
Ra 228,13,8192
Mvaa 128,96,240
Mvaa 128,100,244
Mvaa 132,104,240
Mvaa 132,108,244
Ra 232,12,10240
Mvaa 136,112,240
Mvaa 136,116,244
Mvaa 140,120,240
Mvaa 140,124,244
Ra 236,13,10240
Mvaa 144,64,248
Mvaa 144,68,252
Mvaa 148,72,248
Mvaa 148,76,252
Mvaa 152,80,248
Mvaa 152,84,252
Mvaa 156,88,248
Mvaa 156,92,252
Mvaa 160,96,248
Mvaa 160,100,252
Mvaa 164,104,248
Mvaa 164,108,252
Mvaa 168,112,248
Mvaa 168,116,252
s_waitcnt vmcnt(11)
Mvaa 172,120,248
s_waitcnt lgkmcnt(0)
s_barrier
Mvaa 172,124,252
s_add_u32 m0, s57, 65536
Mvaa 176,64,224
buffer_load_dwordx4 v6, s[12:15], s52 offen offset:0 lds
Mvaa 176,68,228
Ta 0,16,0
Ta 2,16,2048
Mvaa 180,72,224
Mvaa 180,76,228
Ra 240,12,12288
Mvaa 184,80,224
buffer_load_dwordx4 v7, s[12:15], s53 offen offset:1024 lds
Mvaa 184,84,228
Ta 4,16,16384
Ta 6,16,18432
Mvaa 188,88,224
Mvaa 188,92,228
Ra 244,13,12288
Mvaa 192,96,224
buffer_load_dwordx4 v6, s[12:15], s54 offen offset:2048 lds
Mvaa 192,100,228
Ta 8,17,0
Ta 10,17,2048
Mvaa 196,104,224
Mvaa 196,108,228
Ra 248,12,14336
Mvaa 200,112,224
buffer_load_dwordx4 v7, s[12:15], s55 offen offset:3072 lds
Mvaa 200,116,228
Ta 12,17,16384
Ta 14,17,18432
Mvaa 204,120,224
Mvaa 204,124,228
s_add_u32 m0, s57, 69632
Ra 252,13,14336
Mvaa 208,64,232
buffer_load_dwordx4 v8, s[12:15], s52 offen offset:0 lds
Mvaa 208,68,236
Mvaa 212,72,232
Mvaa 212,76,236
Ta 16,18,0
Ta 18,18,2048
Mvaa 216,80,232
buffer_load_dwordx4 v9, s[12:15], s53 offen offset:1024 lds
Mvaa 216,84,236
Ta 20,18,16384
s_waitcnt lgkmcnt(9)
Ta 22,18,18432
Mvaa 220,88,232
Mvaa 220,92,236
Ta 24,19,0
Ta 26,19,2048
Mvaa 224,96,232
buffer_load_dwordx4 v8, s[12:15], s54 offen offset:2048 lds
Mvaa 224,100,236
Mvaa 228,104,232
Mvaa 228,108,236
Ta 28,19,16384
Ta 30,19,18432
Mvaa 232,112,232
buffer_load_dwordx4 v9, s[12:15], s55 offen offset:3072 lds
Mvaa 232,116,236
s_waitcnt vmcnt(11)
Ta 32,20,0
s_waitcnt lgkmcnt(9)
Ta 34,20,2048
Mvaa 236,120,232
s_barrier
Mvaa 236,124,236
s_add_u32 m0, s56, 65536
Ta 36,20,16384
Ta 38,20,18432
Mvaa 240,64,240
buffer_load_dwordx4 v2, s[8:11], s48 offen offset:0 lds
Mvaa 240,68,244
Mvaa 244,72,240
Mvaa 244,76,244
Ra 224,10,0
Mvaa 248,80,240
buffer_load_dwordx4 v3, s[8:11], s49 offen offset:1024 lds
Mvaa 248,84,244
Ta 40,21,0
Ta 42,21,2048
Mvaa 252,88,240
Mvaa 252,92,244
s_waitcnt lgkmcnt(9)
Ra 228,11,0
Maaa 128,96,240
buffer_load_dwordx4 v2, s[8:11], s50 offen offset:2048 lds
Maaa 128,100,244
Ta 44,21,16384
Ta 46,21,18432
Maaa 132,104,240
Maaa 132,108,244
Ra 232,10,2048
Maaa 136,112,240
buffer_load_dwordx4 v3, s[8:11], s51 offen offset:3072 lds
Maaa 136,116,244
Ta 48,22,0
Ta 50,22,2048
Maaa 140,120,240
Maaa 140,124,244
s_add_u32 m0, s56, 69632
s_waitcnt lgkmcnt(9)
Ra 236,11,2048
Maaa 144,64,248
buffer_load_dwordx4 v4, s[8:11], s48 offen offset:0 lds
Maaa 144,68,252
Maaa 148,72,248
Maaa 148,76,252
Ta 52,22,16384
Ta 54,22,18432
Maaa 152,80,248
buffer_load_dwordx4 v5, s[8:11], s49 offen offset:1024 lds
Maaa 152,84,252
Ta 56,23,0
Ta 58,23,2048
Maaa 156,88,248
Maaa 156,92,252
Ta 60,23,16384
s_waitcnt lgkmcnt(9)
Ta 62,23,18432
Maaa 160,96,248
buffer_load_dwordx4 v4, s[8:11], s50 offen offset:2048 lds
Maaa 160,100,252
Maaa 164,104,248
Maaa 164,108,252
Maaa 168,112,248
buffer_load_dwordx4 v5, s[8:11], s51 offen offset:3072 lds
Maaa 168,116,252
Maaa 172,120,248
s_waitcnt lgkmcnt(6)
Maaa 172,124,252
s_waitcnt lgkmcnt(0)
Mvaa 48,0,224
buffer_load_dword v1, v31, s[28:31], s37 offen sc1
Mvaa 48,4,228
s_mov_b32 s8, s16
s_mov_b32 s9, s17
s_mov_b32 s10, s18
Mvaa 52,8,224
s_add_u32 s16, s66, 46137344
s_addc_u32 s17, s67, 0
s_and_b32 s17, s17, 0xffff
Mvaa 52,12,228
Ra 240,10,4096
Mvaa 56,16,224
s_mov_b32 s18, 16777216
s_mov_b32 s19, 0x20000
s_mov_b32 s48, 0
Mvaa 56,20,228
s_mov_b32 s49, 31744
s_mov_b32 s50, 63488
s_mov_b32 s51, 95232
Mvaa 60,24,224
v_lshlrev_b32 v35, 13, v34
Mvaa 60,28,228
Ra 244,11,4096
Mvaa 64,32,224
s_and_b32 s52, s33, 0
s_lshl_b32 s3, s52, 19
s_lshl_b32 s52, s52, 11
Mvaa 64,36,228
s_add_u32 s53, s52, s58
v_add_u32_e64 v35, s3, v35
v_lshl_add_u32 v8, v36, 4, v35
Mvaa 68,40,224
v_lshl_add_u32 v9, v37, 4, v35
v_lshlrev_b32_e64 v2, 4, v0
Mvaa 68,44,228
Ra 248,10,6144
Mvaa 72,48,224
v_add_u32 v3, 65536, v2
v_add_u32_e64 v4, s44, v2
Mvaa 72,52,228
v_mov_b32 v7, 0
v_lshlrev_b32 v35, 2, v32
Mvaa 76,56,224
v_sub_u32_e64 v35, v33, v35
Mvaa 76,60,228
Ra 252,11,6144
Mvaa 80,0,232
s_lshl_b32 s3, s32, 4
v_add_u32 v5, s3, v35
Mvaa 80,4,236
s_sub_u32 s3, 48, s3
v_add_u32 v6, s3, v35
Mvaa 84,8,232
s_mul_i32 s3, s33, 1116160
s_add_u32 s3, s3, 8388608
s_add_u32 s12, s66, s3
s_addc_u32 s13, s67, 0
s_and_b32 s13, s13, 0xffff
Mvaa 84,12,236
s_mov_b32 s14, 0
s_mov_b32 s15, 0x20000
s_mul_i32 s14, s36, 34816
Mvaa 88,16,232
buffer_load_dword v44, v45, s[8:11], s47 offen
Mvaa 88,20,236
s_add_u32 s47, s47, 2097152
v_lshrrev_b32 v42, 2, v33
v_lshl_add_u32 v43, v32, 3, v42
Mvaa 92,24,232
v_lshlrev_b32 v43, 8, v43
v_and_b32 v46, 3, v0
Mvaa 92,28,236
v_lshl_add_u32 v43, v46, 3, v43
v_and_b32_e64 v46, 1, v32
Mvaa 96,32,232
v_lshl_add_u32 v42, v46, 2, v42
v_lshl_add_u32 v16, v42, 5, v43
Mvaa 96,36,236
v_xor_b32 v17, 32, v16
v_xor_b32 v18, 64, v16
Mvaa 100,40,232
v_xor_b32 v19, 96, v16
v_xor_b32 v20, 128, v16
Mvaa 100,44,236
v_xor_b32 v21, 160, v16
v_xor_b32 v22, 192, v16
Mvaa 104,48,232
v_xor_b32 v23, 224, v16
Mvaa 104,52,236
Mvaa 108,56,232
s_waitcnt lgkmcnt(0)
Mvaa 108,60,236
Mvaa 112,0,240
Mvaa 112,4,244
Mvaa 116,8,240
Mvaa 116,12,244
Ra 224,10,8192
Mvaa 120,16,240
Mvaa 120,20,244
Mvaa 124,24,240
Mvaa 124,28,244
Ra 228,11,8192
Mvaa 128,32,240
Mvaa 128,36,244
Mvaa 132,40,240
Mvaa 132,44,244
Ra 232,10,10240
Mvaa 136,48,240
Mvaa 136,52,244
Mvaa 140,56,240
Mvaa 140,60,244
Ra 236,11,10240
Mvaa 144,0,248
Mvaa 144,4,252
Mvaa 148,8,248
Mvaa 148,12,252
Mvaa 152,16,248
Mvaa 152,20,252
Mvaa 156,24,248
Mvaa 156,28,252
Mvaa 160,32,248
Mvaa 160,36,252
Mvaa 164,40,248
Mvaa 164,44,252
Mvaa 168,48,248
Mvaa 168,52,252
s_waitcnt vmcnt(10)
Mvaa 172,56,248
s_waitcnt lgkmcnt(0)
s_barrier
Mvaa 172,60,252
s_add_u32 m0, s44, 0
Mvaa 176,0,224
buffer_load_dwordx4 v8, s[8:11], s48 offen offset:0 lds
Mvaa 176,4,228
Ta 64,14,0
Ta 66,14,2048
Mvaa 180,8,224
Mvaa 180,12,228
Ra 240,10,12288
Mvaa 184,16,224
buffer_load_dwordx4 v8, s[8:11], s49 offen offset:1024 lds
Mvaa 184,20,228
Ta 68,14,16384
Ta 70,14,18432
Mvaa 188,24,224
Mvaa 188,28,228
Ra 244,11,12288
Mvaa 192,32,224
buffer_load_dwordx4 v9, s[8:11], s50 offen offset:2048 lds
Mvaa 192,36,228
Ta 72,15,0
Ta 74,15,2048
Mvaa 196,40,224
Mvaa 196,44,228
Ra 248,10,14336
Mvaa 200,48,224
buffer_load_dwordx4 v9, s[8:11], s51 offen offset:3072 lds
Mvaa 200,52,228
Ta 76,15,16384
Ta 78,15,18432
Mvaa 204,56,224
v_xor_b32 v8, 524288, v8
v_xor_b32 v9, 524288, v9
Mvaa 204,60,228
s_add_u32 m0, s44, 16384
Ra 252,11,14336
Mvaa 208,0,232
buffer_load_dwordx4 v8, s[8:11], s48 offen offset:0 lds
Mvaa 208,4,236
Mvaa 212,8,232
Mvaa 212,12,236
Ta 80,24,0
Ta 82,24,2048
Mvaa 216,16,232
buffer_load_dwordx4 v8, s[8:11], s49 offen offset:1024 lds
Mvaa 216,20,236
Ta 84,24,16384
s_waitcnt lgkmcnt(9)
Ta 86,24,18432
Mvaa 220,24,232
Mvaa 220,28,236
Ta 88,25,0
Ta 90,25,2048
Mvaa 224,32,232
buffer_load_dwordx4 v9, s[8:11], s50 offen offset:2048 lds
Mvaa 224,36,236
Mvaa 228,40,232
s_mul_i32 s3, s45, 33792
v_add_u32_e64 v10, s3, v2
Mvaa 228,44,236
Ta 92,25,16384
Ta 94,25,18432
Mvaa 232,48,232
buffer_load_dwordx4 v9, s[8:11], s51 offen offset:3072 lds
Mvaa 232,52,236
s_waitcnt vmcnt(10)
Ta 96,26,0
s_waitcnt lgkmcnt(9)
Ta 98,26,2048
Mvaa 236,56,232
s_barrier
v_xor_b32 v8, 1572864, v8
v_xor_b32 v9, 1572864, v9
Mvaa 236,60,236
s_add_u32 m0, s44, 32768
Ta 100,26,16384
Ta 102,26,18432
Mvaa 240,0,240
buffer_load_dwordx4 v8, s[8:11], s48 offen offset:0 lds
Mvaa 240,4,244
s_mul_i32 s3, s46, 33792
v_add_u32 v11, s3, v2
Mvaa 244,8,240
Mvaa 244,12,244
Ra 224,12,0
Mvaa 248,16,240
buffer_load_dwordx4 v8, s[8:11], s49 offen offset:1024 lds
Mvaa 248,20,244
Ta 104,27,0
Ta 106,27,2048
Mvaa 252,24,240
Mvaa 252,28,244
s_waitcnt lgkmcnt(9)
Ra 228,13,0
Maaa 128,32,240
buffer_load_dwordx4 v9, s[8:11], s50 offen offset:2048 lds
Maaa 128,36,244
Ta 108,27,16384
Ta 110,27,18432
Maaa 132,40,240
Maaa 132,44,244
Ra 232,12,2048
Maaa 136,48,240
buffer_load_dwordx4 v9, s[8:11], s51 offen offset:3072 lds
Maaa 136,52,244
Ta 112,28,0
Ta 114,28,2048
Maaa 140,56,240
v_xor_b32 v8, 524288, v8
v_xor_b32 v9, 524288, v9
Maaa 140,60,244
s_add_u32 m0, s44, 49152
s_waitcnt lgkmcnt(9)
Ra 236,13,2048
Maaa 144,0,248
buffer_load_dwordx4 v8, s[8:11], s48 offen offset:0 lds
Maaa 144,4,252
Maaa 148,8,248
Maaa 148,12,252
Ta 116,28,16384
Ta 118,28,18432
Maaa 152,16,248
buffer_load_dwordx4 v8, s[8:11], s49 offen offset:1024 lds
Maaa 152,20,252
Ta 120,29,0
Ta 122,29,2048
Maaa 156,24,248
Maaa 156,28,252
Ta 124,29,16384
s_waitcnt lgkmcnt(9)
Ta 126,29,18432
Maaa 160,32,248
buffer_load_dwordx4 v9, s[8:11], s50 offen offset:2048 lds
Maaa 160,36,252
Maaa 164,40,248
Maaa 164,44,252
Maaa 168,48,248
buffer_load_dwordx4 v9, s[8:11], s51 offen offset:3072 lds
Maaa 168,52,252
v_xor_b32 v8, 3670016, v8
v_xor_b32 v9, 3670016, v9
Maaa 172,56,248
s_waitcnt lgkmcnt(6)
Maaa 172,60,252
s_waitcnt lgkmcnt(0)
Mvaa 48,64,224
v_mov_b32 v14, v40
v_mov_b32_e64 v15, v41
Mvaa 48,68,228
Mvaa 52,72,224
Mvaa 52,76,228
Ra 240,12,4096
Mvaa 56,80,224
Mvaa 56,84,228
Mvaa 60,88,224
Mvaa 60,92,228
Ra 244,13,4096
Mvaa 64,96,224
Vc 24,48,49
Vc 25,50,51
Mvaa 64,100,228
Vc 26,52,53
Vc 27,54,55
Mvaa 68,104,224
Mvaa 68,108,228
Ra 248,12,6144
Mvaa 72,112,224
Vc 28,56,57
Vc 29,58,59
Mvaa 72,116,228
Vc 30,60,61
Vc 31,62,63
Mvaa 76,120,224
Mvaa 76,124,228
Ra 252,13,6144
Mvaa 80,64,232
Vc 32,64,65
Vc 33,66,67
Mvaa 80,68,236
Vc 34,68,69
Vc 35,70,71
Mvaa 84,72,232
Mvaa 84,76,236
Mvaa 88,80,232
Vc 36,72,73
Vc 37,74,75
Mvaa 88,84,236
Vc 38,76,77
Vc 39,78,79
Mvaa 92,88,232
Mvaa 92,92,236
Mvaa 96,96,232
Vc 40,80,81
Vc 41,82,83
Mvaa 96,100,236
Vc 42,84,85
Vc 43,86,87
Mvaa 100,104,232
s_waitcnt vmcnt(12)
Mvaa 100,108,236
s_add_u32 s59, s38, 0
Mvaa 104,112,232
v_readfirstlane_b32 s3, v1
s_nop 0
s_or_b32 s3, s3, s37
s_cmp_lt_u32 s3, 256
s_cbranch_scc1 L_spinAk
L_spinArk:
s_barrier
Mvaa 104,116,236
buffer_store_dwordx4 v[24:27], v2, s[24:27], s59 offen offset:0 sc1
Mvaa 108,120,232
s_waitcnt lgkmcnt(0)
Mvaa 108,124,236
Vc 44,88,89
Vc 45,90,91
Mvaa 112,64,240
buffer_load_dwordx4 a[0:3], v10, s[20:23], s53 offen offset:0 sc1
Mvaa 112,68,244
Vc 46,92,93
Vc 47,94,95
Mvaa 116,72,240
Vc 48,96,97
Vc 49,98,99
Mvaa 116,76,244
Ra 224,12,8192
Mvaa 120,80,240
Vc 50,100,101
Vc 51,102,103
Mvaa 120,84,244
Vc 52,104,105
Vc 53,106,107
Mvaa 124,88,240
buffer_load_dwordx4 a[4:7], v10, s[20:23], s52 offen offset:0 sc1
Mvaa 124,92,244
Ra 228,13,8192
Mvaa 128,96,240
Vc 54,108,109
Vc 55,110,111
Mvaa 128,100,244
Vc 56,112,113
Vc 57,114,115
Mvaa 132,104,240
Vc 58,116,117
Vc 59,118,119
Mvaa 132,108,244
Ra 232,12,10240
Mvaa 136,112,240
buffer_load_dwordx4 a[8:11], v11, s[20:23], s53 offen offset:0 sc1
Mvaa 136,116,244
buffer_store_dwordx4 v[28:31], v2, s[24:27], s59 offen offset:1024 sc1
Mvaa 140,120,240
Vc 60,120,121
Vc 61,122,123
Mvaa 140,124,244
Ra 236,13,10240
Mvaa 144,64,248
Vc 62,124,125
Vc 63,126,127
Mvaa 144,68,252
Vc 64,128,129
Vc 65,130,131
Mvaa 148,72,248
buffer_load_dwordx4 a[12:15], v11, s[20:23], s52 offen offset:0 sc1
Mvaa 148,76,252
Vc 66,132,133
Vc 67,134,135
Mvaa 152,80,248
Vc 68,136,137
Vc 69,138,139
Mvaa 152,84,252
Vc 70,140,141
Vc 71,142,143
Mvaa 156,88,248
Mvaa 156,92,252
Mvaa 160,96,248
buffer_load_dwordx4 a[16:19], v10, s[20:23], s53 offen offset:1024 sc1
Mvaa 160,100,252
Vc 72,144,145
Vc 73,146,147
Mvaa 164,104,248
Vc 74,148,149
Vc 75,150,151
Mvaa 164,108,252
buffer_store_dwordx4 v[32:35], v2, s[24:27], s59 offen offset:2048 sc1
Mvaa 168,112,248
Vc 76,152,153
Vc 77,154,155
Mvaa 168,116,252
Vc 78,156,157
Vc 79,158,159
Mvaa 172,120,248
s_waitcnt lgkmcnt(0)
buffer_load_dwordx4 a[20:23], v10, s[20:23], s52 offen offset:1024 sc1
Mvaa 172,124,252
Mvaa 176,64,224
Vc 80,160,161
Vc 81,162,163
Mvaa 176,68,228
Vc 82,164,165
Vc 83,166,167
Mvaa 180,72,224
Mvaa 180,76,228
Ra 240,12,12288
Mvaa 184,80,224
buffer_load_dwordx4 a[24:27], v11, s[20:23], s53 offen offset:1024 sc1
Mvaa 184,84,228
Vc 84,168,169
Vc 85,170,171
Mvaa 188,88,224
Vc 86,172,173
Vc 87,174,175
Mvaa 188,92,228
Ra 244,13,12288
Mvaa 192,96,224
Vc 88,176,177
Vc 89,178,179
Mvaa 192,100,228
Vc 90,180,181
Vc 91,182,183
Mvaa 196,104,224
buffer_load_dwordx4 a[28:31], v11, s[20:23], s52 offen offset:1024 sc1
Mvaa 196,108,228
Ra 248,12,14336
s_xor_b32 s52, s52, 2048
Mvaa 200,112,224
s_add_u32 s53, s52, s58
Mvaa 200,116,228
Vc 92,184,185
Vc 93,186,187
Mvaa 204,120,224
Vc 94,188,189
Vc 95,190,191
Mvaa 204,124,228
Ra 252,13,14336
Mvaa 208,64,232
buffer_load_dwordx4 a[32:35], v10, s[20:23], s53 offen offset:0 sc1
Mvaa 208,68,236
buffer_store_dwordx4 v[36:39], v2, s[24:27], s59 offen offset:3072 sc1
Mvaa 212,72,232
Vc 96,192,193
Vc 97,194,195
Mvaa 212,76,236
Vc 98,196,197
Vc 99,198,199
Mvaa 216,80,232
Vc 100,200,201
Vc 101,202,203
Mvaa 216,84,236
Vc 102,204,205
Vc 103,206,207
Mvaa 220,88,232
buffer_load_dwordx4 a[36:39], v10, s[20:23], s52 offen offset:0 sc1
Mvaa 220,92,236
Mvaa 224,96,232
Vc 104,208,209
Vc 105,210,211
Mvaa 224,100,236
Vc 106,212,213
Vc 107,214,215
Mvaa 228,104,232
Mvaa 228,108,236
Mvaa 232,112,232
buffer_load_dwordx4 a[40:43], v11, s[20:23], s53 offen offset:0 sc1
Mvaa 232,116,236
Vc 108,216,217
Vc 109,218,219
Mvaa 236,120,232
s_waitcnt lgkmcnt(0)
Mvaa 236,124,236
Vc 110,220,221
Vc 111,222,223
Mvaa 240,64,240
s_add_u32 s59, s38, 4096
Mvaa 240,68,244
buffer_store_dwordx4 v[40:43], v2, s[24:27], s59 offen offset:0 sc1
Mvaa 244,72,240
buffer_load_dwordx4 a[44:47], v11, s[20:23], s52 offen offset:0 sc1
Mvaa 244,76,244
Vc 112,224,225
Vc 113,226,227
Mvaa 248,80,240
Vc 114,228,229
Vc 115,230,231
Mvaa 248,84,244
Vc 116,232,233
Vc 117,234,235
Mvaa 252,88,240
Vc 118,236,237
Vc 119,238,239
Mvaa 252,92,244
Maaa 128,96,240
buffer_load_dwordx4 a[48:51], v10, s[20:23], s53 offen offset:1024 sc1
Maaa 128,100,244
Ta 192,16,0
Ta 194,16,1024
Maaa 132,104,240
Vc 120,240,241
Vc 121,242,243
Maaa 132,108,244
Ta 196,17,0
Ta 198,17,1024
Maaa 136,112,240
Vc 122,244,245
Vc 123,246,247
Maaa 136,116,244
Ta 200,18,0
Ta 202,18,1024
Maaa 140,120,240
buffer_load_dwordx4 a[52:55], v10, s[20:23], s52 offen offset:1024 sc1
Maaa 140,124,244
Ta 204,19,0
Ta 206,19,1024
Maaa 144,64,248
Vc 124,248,249
Vc 125,250,251
Maaa 144,68,252
Ta 208,20,0
Ta 210,20,1024
Maaa 148,72,248
Vc 126,252,253
Vc 127,254,255
Maaa 148,76,252
Ta 212,21,0
Ta 214,21,1024
Maaa 152,80,248
buffer_load_dwordx4 a[56:59], v11, s[20:23], s53 offen offset:1024 sc1
Maaa 152,84,252
Ta 216,22,0
Ta 218,22,1024
Maaa 156,88,248
buffer_store_dwordx4 v[44:47], v2, s[24:27], s59 offen offset:1024 sc1
Maaa 156,92,252
Ta 220,23,0
s_waitcnt lgkmcnt(9)
Ta 222,23,1024
Maaa 160,96,248
Maaa 160,100,252
Maaa 164,104,248
buffer_load_dwordx4 a[60:63], v11, s[20:23], s52 offen offset:1024 sc1
Maaa 164,108,252
s_xor_b32 s52, s52, 6144
s_add_u32 s53, s52, s58
Maaa 168,112,248
Maaa 168,116,252
Maaa 172,120,248
Maaa 172,124,252
s_branch L_phase2
L_k1_vpath:
Zvaa 48,224,0
v_and_b32_e64 v46, 7, v0
v_mul_u32_u24 v30, 2064, v46
Mvaa 48,228,4
s_add_u32 m0, s57, 65536
Zvaa 52,232,0
buffer_load_dwordx4 v6, s[12:15], s52 offen offset:0 lds
Mvaa 52,236,4
Ra 240,10,4096
Zvaa 56,224,8
buffer_load_dwordx4 v7, s[12:15], s53 offen offset:1024 lds
Mvaa 56,228,12
v_lshrrev_b32_e64 v31, 3, v0
Zvaa 60,232,8
buffer_load_dwordx4 v6, s[12:15], s54 offen offset:2048 lds
Mvaa 60,236,12
Ra 244,11,4096
Zvaa 64,224,16
buffer_load_dwordx4 v7, s[12:15], s55 offen offset:3072 lds
Mvaa 64,228,20
s_add_u32 m0, s57, 69632
Zvaa 68,232,16
buffer_load_dwordx4 v8, s[12:15], s52 offen offset:0 lds
Mvaa 68,236,20
Ra 248,10,6144
Zvaa 72,224,24
buffer_load_dwordx4 v9, s[12:15], s53 offen offset:1024 lds
Mvaa 72,228,28
s_lshl_b32 s3, s32, 9
s_add_u32 s3, s3, 131072
v_lshl_add_u32 v30, v31, 4, v30
Zvaa 76,232,24
buffer_load_dwordx4 v8, s[12:15], s54 offen offset:2048 lds
Mvaa 76,236,28
s_waitcnt lgkmcnt(9)
Ra 252,11,6144
Zvaa 80,224,32
buffer_load_dwordx4 v9, s[12:15], s55 offen offset:3072 lds
Mvaa 80,228,36
s_add_u32 m0, s56, 65536
v_xor_b32 v6, 1572864, v6
v_xor_b32 v7, 1572864, v7
Zvaa 84,232,32
buffer_load_dwordx4 v2, s[8:11], s48 offen offset:0 lds
Mvaa 84,236,36
v_xor_b32 v8, 1572864, v8
v_xor_b32 v9, 1572864, v9
Zvaa 88,224,40
buffer_load_dwordx4 v3, s[8:11], s49 offen offset:1024 lds
Mvaa 88,228,44
v_add_u32 v30, s3, v30
v_lshlrev_b32 v31, 8, v31
Zvaa 92,232,40
buffer_load_dwordx4 v2, s[8:11], s50 offen offset:2048 lds
Mvaa 92,236,44
v_lshl_add_u32 v46, v46, 4, v31
s_waitcnt lgkmcnt(8)
Zvaa 96,224,48
buffer_load_dwordx4 v3, s[8:11], s51 offen offset:3072 lds
Mvaa 96,228,52
s_add_u32 m0, s56, 69632
Zvaa 100,232,48
buffer_load_dwordx4 v4, s[8:11], s48 offen offset:0 lds
Mvaa 100,236,52
Rv 34,30,128
Rv 38,30,256
s_waitcnt lgkmcnt(6)
Zvaa 104,224,56
buffer_load_dwordx4 v5, s[8:11], s49 offen offset:1024 lds
Mvaa 104,228,60
Rv 42,30,384
Rv 30,30,0
Zvaa 108,232,56
s_waitcnt lgkmcnt(4)
buffer_load_dwordx4 v4, s[8:11], s50 offen offset:2048 lds
Mvaa 108,236,60
s_lshr_b32 s3, s2, 1
s_mul_i32 s3, s3, 33792
s_add_u32 s3, s3, s57
Zvaa 112,240,0
buffer_load_dwordx4 v5, s[8:11], s51 offen offset:3072 lds
Mvaa 112,244,4
v_xor_b32 v2, 384, v2
v_xor_b32 v3, 384, v3
Zvaa 116,248,0
s_and_b32 s39, s2, 1
s_lshl_b32 s39, s39, 7
s_add_u32 s3, s3, s39
Mvaa 116,252,4
Ra 224,10,8192
v_xor_b32 v4, 384, v4
Zvaa 120,240,8
s_add_u32 s39, s3, 4096
Mvaa 120,244,12
v_xor_b32 v5, 384, v5
Zvaa 124,248,8
Mvaa 124,252,12
Ra 228,11,8192
Zvaa 128,240,16
Mvaa 128,244,20
Zvaa 132,248,16
Mvaa 132,252,20
Ra 232,10,10240
Zvaa 136,240,24
buffer_load_dword v1, v47, s[60:63], 0 offen
Mvaa 136,244,28
s_mul_i32 vcc_lo, s59, 1
v_xor_b32 v47, vcc_lo, v47
Zvaa 140,248,24
Mvaa 140,252,28
Ra 236,11,10240
Zvaa 144,240,32
Mvaa 144,244,36
Zvaa 148,248,32
Mvaa 148,252,36
Zvaa 152,240,40
Mvaa 152,244,44
Zvaa 156,248,40
Mvaa 156,252,44
Zvaa 160,240,48
Mvaa 160,244,52
Zvaa 164,248,48
Mvaa 164,252,52
Zvaa 168,240,56
Mvaa 168,244,60
s_waitcnt vmcnt(9)
Zvaa 172,248,56
s_waitcnt lgkmcnt(0)
s_barrier
Mvaa 172,252,60
s_add_u32 m0, s57, 0
Zvaa 176,224,0
buffer_load_dwordx4 v6, s[12:15], s52 offen offset:0 lds
Mvaa 176,228,4
Ta 64,14,0
Ta 66,14,2048
Zvaa 180,232,0
Mvaa 180,236,4
Ra 240,10,12288
Zvaa 184,224,8
buffer_load_dwordx4 v7, s[12:15], s53 offen offset:1024 lds
Mvaa 184,228,12
Ta 68,14,16384
Ta 70,14,18432
Zvaa 188,232,8
Mvaa 188,236,12
Ra 244,11,12288
Zvaa 192,224,16
buffer_load_dwordx4 v6, s[12:15], s54 offen offset:2048 lds
Mvaa 192,228,20
Ta 72,15,0
Ta 74,15,2048
Zvaa 196,232,16
Mvaa 196,236,20
Ra 248,10,14336
Zvaa 200,224,24
buffer_load_dwordx4 v7, s[12:15], s55 offen offset:3072 lds
Mvaa 200,228,28
Ta 76,15,16384
Ta 78,15,18432
Zvaa 204,232,24
Mvaa 204,236,28
s_add_u32 m0, s57, 4096
Ra 252,11,14336
Zvaa 208,224,32
buffer_load_dwordx4 v8, s[12:15], s52 offen offset:0 lds
Mvaa 208,228,36
Zvaa 212,232,32
Mvaa 212,236,36
Ta 80,24,0
Ta 82,24,2048
Zvaa 216,224,40
buffer_load_dwordx4 v9, s[12:15], s53 offen offset:1024 lds
Mvaa 216,228,44
Ta 84,24,16384
s_waitcnt lgkmcnt(9)
Ta 86,24,18432
Zvaa 220,232,40
Mvaa 220,236,44
Ta 88,25,0
Ta 90,25,2048
Zvaa 224,224,48
buffer_load_dwordx4 v8, s[12:15], s54 offen offset:2048 lds
Mvaa 224,228,52
Zvaa 228,232,48
Mvaa 228,236,52
Ta 92,25,16384
Ta 94,25,18432
Zvaa 232,224,56
buffer_load_dwordx4 v9, s[12:15], s55 offen offset:3072 lds
Mvaa 232,228,60
s_waitcnt vmcnt(9)
Ta 96,26,0
s_waitcnt lgkmcnt(9)
Ta 98,26,2048
Zvaa 236,232,56
s_barrier
v_xor_b32 v6, 524288, v6
v_xor_b32 v7, 524288, v7
Mvaa 236,236,60
s_add_u32 m0, s56, 0
Ta 100,26,16384
Ta 102,26,18432
Zvaa 240,240,0
buffer_load_dwordx4 v2, s[8:11], s48 offen offset:0 lds
Mvaa 240,244,4
v_xor_b32 v8, 524288, v8
v_xor_b32 v9, 524288, v9
Zvaa 244,248,0
Mvaa 244,252,4
Ra 224,12,0
Zvaa 248,240,8
buffer_load_dwordx4 v3, s[8:11], s49 offen offset:1024 lds
Mvaa 248,244,12
Ta 104,27,0
Ta 106,27,2048
Zvaa 252,248,8
Mvaa 252,252,12
s_waitcnt lgkmcnt(9)
Ra 228,13,0
Zaaa 128,240,16
buffer_load_dwordx4 v2, s[8:11], s50 offen offset:2048 lds
Maaa 128,244,20
Ta 108,27,16384
Ta 110,27,18432
Zaaa 132,248,16
Maaa 132,252,20
Ra 232,12,2048
Zaaa 136,240,24
buffer_load_dwordx4 v3, s[8:11], s51 offen offset:3072 lds
Maaa 136,244,28
Ta 112,28,0
Ta 114,28,2048
Zaaa 140,248,24
Maaa 140,252,28
s_add_u32 m0, s56, 4096
s_waitcnt lgkmcnt(9)
Ra 236,13,2048
Zaaa 144,240,32
buffer_load_dwordx4 v4, s[8:11], s48 offen offset:0 lds
Maaa 144,244,36
Zaaa 148,248,32
Maaa 148,252,36
Ta 116,28,16384
Ta 118,28,18432
Zaaa 152,240,40
buffer_load_dwordx4 v5, s[8:11], s49 offen offset:1024 lds
Maaa 152,244,44
Ta 120,29,0
Ta 122,29,2048
Zaaa 156,248,40
Maaa 156,252,44
Ta 124,29,16384
s_waitcnt lgkmcnt(9)
Ta 126,29,18432
Zaaa 160,240,48
buffer_load_dwordx4 v4, s[8:11], s50 offen offset:2048 lds
Maaa 160,244,52
Zaaa 164,248,48
Maaa 164,252,52
Zaaa 168,240,56
buffer_load_dwordx4 v5, s[8:11], s51 offen offset:3072 lds
Maaa 168,244,60
v_xor_b32 v2, 128, v2
v_xor_b32 v3, 128, v3
Zaaa 172,248,56
s_waitcnt lgkmcnt(6)
buffer_load_dword v1, v47, s[60:63], 0 offen
v_xor_b32 v4, 128, v4
v_xor_b32 v5, 128, v5
Maaa 172,252,60
s_waitcnt lgkmcnt(0)
s_mul_i32 vcc_lo, s59, 7
v_xor_b32 v47, vcc_lo, v47
Mvaa 48,224,64
buffer_store_dwordx4 v[30:33], v46, s[20:23], s3 offen offset:0 sc1
Mvaa 48,228,68
buffer_store_dwordx4 v[34:37], v46, s[20:23], s3 offen offset:2048 sc1
Mvaa 52,232,64
buffer_store_dwordx4 v[38:41], v46, s[20:23], s39 offen offset:0 sc1
Mvaa 52,236,68
Ra 240,12,4096
Mvaa 56,224,72
buffer_store_dwordx4 v[42:45], v46, s[20:23], s39 offen offset:2048 sc1
Mvaa 56,228,76
s_lshl_b32 s3, s34, 1
s_and_b32 s36, s32, 1
s_add_u32 s3, s3, s36
Mvaa 60,232,72
s_mul_i32 s3, s3, 1116160
s_mul_i32 s36, s33, 139264
s_add_u32 s3, s3, s36
Mvaa 60,236,76
Ra 244,13,4096
Mvaa 64,224,80
s_lshr_b32 s36, s32, 1
s_mul_i32 s36, s36, 69632
s_add_u32 s3, s3, s36
Mvaa 64,228,84
s_add_u32 s38, s3, 17408
s_lshl_b32 s39, s34, 7
s_lshl_b32 s36, s33, 2
Mvaa 68,232,80
s_add_u32 s39, s39, s36
s_add_u32 s39, s39, 5296160
v_mov_b32 v30, 1
Mvaa 68,236,84
Ra 248,12,6144
Mvaa 72,224,88
v_mov_b32_e64 v31, 0
Mvaa 72,228,92
s_cmp_eq_u32 s32, 0
s_cselect_b32 s39, s39, 2146435072
Mvaa 76,232,88
s_mov_b64 exec, 1
buffer_store_dword v31, v31, s[20:23], s39 offen sc1
s_mov_b64 exec, -1
Mvaa 76,236,92
Ra 252,13,6144
Mvaa 80,224,96
s_and_b32 s33, s2, 7
s_lshl_b32 s33, s33, 2
s_bfe_u32 s3, s2, 0x20003
Mvaa 80,228,100
s_add_u32 s33, s33, s3
s_lshr_b32 s34, s2, 5
s_lshl_b32 s64, s34, 7
Mvaa 84,232,96
s_lshl_b32 s3, s33, 2
s_add_u32 s64, s64, s3
s_add_u32 s64, s64, 5300224
Mvaa 84,236,100
s_lshl_b32 s65, s34, 8
s_sub_u32 s65, 1920, s65
v_mul_u32_u24 v32, s65, v0
Mvaa 88,224,104
s_cmp_eq_u32 s32, 0
s_cselect_b32 s64, s64, 2146435072
Mvaa 88,228,108
s_mov_b64 exec, 3
buffer_store_dword v31, v32, s[20:23], s64 offen sc1
s_mov_b64 exec, -1
Mvaa 92,232,104
s_lshl_b32 s3, s2, 2
s_add_u32 s3, s3, 5447680
v_lshlrev_b32_e64 v32, 10, v0
Mvaa 92,236,108
s_cmp_eq_u32 s32, 0
s_cselect_b32 s3, s3, 2146435072
Mvaa 96,224,112
s_mov_b64 exec, 0x1ff
buffer_store_dword v31, v32, s[20:23], s3 offen sc1
s_mov_b64 exec, -1
Mvaa 96,228,116
s_lshl_b32 s35, s34, 1
s_sub_u32 s36, 32, s35
s_add_u32 s35, s35, 2
Mvaa 100,232,112
s_lshl_b32 s44, s32, 12
s_lshl_b32 s58, s32, 1
s_sub_u32 s58, 7, s58
Mvaa 100,236,116
s_mul_i32 s58, s58, 33792
s_sub_u32 s3, 15, s34
s_lshl_b32 s45, s3, 3
Mvaa 104,224,120
s_add_u32 s45, s45, s32
s_lshl_b32 s46, s34, 3
s_add_u32 s46, s46, s32
Mvaa 104,228,124
s_mov_b32 s68, s42
s_and_b32 s69, s43, 0xffff
s_mov_b32 s70, 7340032
Mvaa 108,232,120
s_waitcnt lgkmcnt(0)
Mvaa 108,236,124
s_mov_b32 s71, 0x20000
s_cmp_eq_u32 s32, 0
s_cselect_b32 s37, 0, 2146435072
Mvaa 112,240,64
s_lshl_b32 s3, s33, 8
s_add_u32 s16, s4, s3
s_addc_u32 s17, s5, 0
s_and_b32 s17, s17, 0xffff
Mvaa 112,244,68
s_mov_b32 s18, 0
s_mov_b32 s19, 0x20000
s_sub_u32 s18, 8388608, s3
Mvaa 116,248,64
v_and_b32 v33, 15, v0
v_lshrrev_b32 v32, 1, v33
Mvaa 116,252,68
Ra 224,12,8192
Mvaa 120,240,72
v_and_b32 v33, 1, v0
v_lshlrev_b32 v32, 13, v32
Mvaa 120,244,76
v_lshl_add_u32 v45, v33, 7, v32
Mvaa 124,248,72
s_lshl_b32 s3, s32, 3
s_add_u32 s3, s3, s34
s_mul_i32 s47, s3, 65536
Mvaa 124,252,76
Ra 228,13,8192
Mvaa 128,240,80
s_bfe_u32 s6, s2, 131075
s_lshl_b32 s3, s32, 8
s_or_b32 s6, s6, s3
Mvaa 128,244,84
Mvaa 132,248,80
Mvaa 132,252,84
Ra 232,12,10240
Mvaa 136,240,88
Mvaa 136,244,92
Mvaa 140,248,88
Mvaa 140,252,92
Ra 236,13,10240
Mvaa 144,240,96
Mvaa 144,244,100
Mvaa 148,248,96
Mvaa 148,252,100
Mvaa 152,240,104
Mvaa 152,244,108
Mvaa 156,248,104
Mvaa 156,252,108
Mvaa 160,240,112
Mvaa 160,244,116
Mvaa 164,248,112
Mvaa 164,252,116
Mvaa 168,240,120
Mvaa 168,244,124
s_waitcnt vmcnt(16)
Mvaa 172,248,120
s_waitcnt lgkmcnt(0)
s_barrier
Mvaa 172,252,124
s_add_u32 m0, s57, 65536
Mvaa 176,224,64
buffer_load_dwordx4 v6, s[12:15], s52 offen offset:0 lds
Mvaa 176,228,68
Ta 0,16,0
Ta 2,16,2048
Mvaa 180,232,64
Mvaa 180,236,68
Ra 240,12,12288
Mvaa 184,224,72
buffer_load_dwordx4 v7, s[12:15], s53 offen offset:1024 lds
Mvaa 184,228,76
Ta 4,16,16384
Ta 6,16,18432
Mvaa 188,232,72
Mvaa 188,236,76
Ra 244,13,12288
Mvaa 192,224,80
buffer_load_dwordx4 v6, s[12:15], s54 offen offset:2048 lds
Mvaa 192,228,84
Ta 8,17,0
Ta 10,17,2048
Mvaa 196,232,80
Mvaa 196,236,84
Ra 248,12,14336
Mvaa 200,224,88
buffer_load_dwordx4 v7, s[12:15], s55 offen offset:3072 lds
Mvaa 200,228,92
Ta 12,17,16384
Ta 14,17,18432
Mvaa 204,232,88
Mvaa 204,236,92
s_add_u32 m0, s57, 69632
Ra 252,13,14336
Mvaa 208,224,96
buffer_load_dwordx4 v8, s[12:15], s52 offen offset:0 lds
Mvaa 208,228,100
Mvaa 212,232,96
Mvaa 212,236,100
Ta 16,18,0
Ta 18,18,2048
Mvaa 216,224,104
buffer_load_dwordx4 v9, s[12:15], s53 offen offset:1024 lds
Mvaa 216,228,108
Ta 20,18,16384
s_waitcnt lgkmcnt(9)
Ta 22,18,18432
Mvaa 220,232,104
Mvaa 220,236,108
Ta 24,19,0
Ta 26,19,2048
Mvaa 224,224,112
buffer_load_dwordx4 v8, s[12:15], s54 offen offset:2048 lds
Mvaa 224,228,116
Mvaa 228,232,112
Mvaa 228,236,116
Ta 28,19,16384
Ta 30,19,18432
Mvaa 232,224,120
buffer_load_dwordx4 v9, s[12:15], s55 offen offset:3072 lds
Mvaa 232,228,124
s_waitcnt vmcnt(16)
Ta 32,20,0
s_waitcnt lgkmcnt(9)
Ta 34,20,2048
Mvaa 236,232,120
s_barrier
v_xor_b32 v6, 3670016, v6
v_xor_b32 v7, 3670016, v7
Mvaa 236,236,124
s_add_u32 m0, s56, 65536
Ta 36,20,16384
Ta 38,20,18432
Mvaa 240,240,64
buffer_load_dwordx4 v2, s[8:11], s48 offen offset:0 lds
Mvaa 240,244,68
v_xor_b32 v8, 3670016, v8
v_xor_b32 v9, 3670016, v9
Mvaa 244,248,64
Mvaa 244,252,68
Ra 224,10,0
Mvaa 248,240,72
buffer_load_dwordx4 v3, s[8:11], s49 offen offset:1024 lds
Mvaa 248,244,76
Ta 40,21,0
Ta 42,21,2048
Mvaa 252,248,72
Mvaa 252,252,76
s_waitcnt lgkmcnt(9)
Ra 228,11,0
Maaa 128,240,80
buffer_load_dwordx4 v2, s[8:11], s50 offen offset:2048 lds
Maaa 128,244,84
Ta 44,21,16384
Ta 46,21,18432
Maaa 132,248,80
Maaa 132,252,84
Ra 232,10,2048
Maaa 136,240,88
buffer_load_dwordx4 v3, s[8:11], s51 offen offset:3072 lds
Maaa 136,244,92
Ta 48,22,0
Ta 50,22,2048
Maaa 140,248,88
Maaa 140,252,92
s_add_u32 m0, s56, 69632
s_waitcnt lgkmcnt(9)
Ra 236,11,2048
Maaa 144,240,96
buffer_load_dwordx4 v4, s[8:11], s48 offen offset:0 lds
Maaa 144,244,100
Maaa 148,248,96
Maaa 148,252,100
Ta 52,22,16384
Ta 54,22,18432
Maaa 152,240,104
buffer_load_dwordx4 v5, s[8:11], s49 offen offset:1024 lds
Maaa 152,244,108
Ta 56,23,0
Ta 58,23,2048
Maaa 156,248,104
Maaa 156,252,108
Ta 60,23,16384
s_waitcnt lgkmcnt(9)
Ta 62,23,18432
Maaa 160,240,112
buffer_load_dwordx4 v4, s[8:11], s50 offen offset:2048 lds
Maaa 160,244,116
Maaa 164,248,112
Maaa 164,252,116
Maaa 168,240,120
buffer_load_dwordx4 v5, s[8:11], s51 offen offset:3072 lds
Maaa 168,244,124
v_xor_b32 v2, 896, v2
v_xor_b32 v3, 896, v3
Maaa 172,248,120
s_waitcnt lgkmcnt(6)
buffer_load_dword v1, v47, s[60:63], 0 offen
v_xor_b32 v4, 896, v4
v_xor_b32 v5, 896, v5
Maaa 172,252,124
s_waitcnt lgkmcnt(0)
s_mul_i32 vcc_lo, s59, 1
v_xor_b32 v47, vcc_lo, v47
Mvaa 48,224,0
Mvaa 48,228,4
Mvaa 52,232,0
Mvaa 52,236,4
Ra 240,10,4096
Mvaa 56,224,8
Mvaa 56,228,12
Mvaa 60,232,8
Mvaa 60,236,12
Ra 244,11,4096
Mvaa 64,224,16
Mvaa 64,228,20
Mvaa 68,232,16
Mvaa 68,236,20
Ra 248,10,6144
Mvaa 72,224,24
Mvaa 72,228,28
Mvaa 76,232,24
Mvaa 76,236,28
Ra 252,11,6144
Mvaa 80,224,32
Mvaa 80,228,36
Mvaa 84,232,32
Mvaa 84,236,36
Mvaa 88,224,40
Mvaa 88,228,44
Mvaa 92,232,40
Mvaa 92,236,44
Mvaa 96,224,48
Mvaa 96,228,52
Mvaa 100,232,48
Mvaa 100,236,52
Mvaa 104,224,56
Mvaa 104,228,60
Mvaa 108,232,56
s_waitcnt lgkmcnt(0)
Mvaa 108,236,60
Mvaa 112,240,0
Mvaa 112,244,4
Mvaa 116,248,0
Mvaa 116,252,4
Ra 224,10,8192
Mvaa 120,240,8
Mvaa 120,244,12
Mvaa 124,248,8
Mvaa 124,252,12
Ra 228,11,8192
Mvaa 128,240,16
Mvaa 128,244,20
Mvaa 132,248,16
Mvaa 132,252,20
Ra 232,10,10240
Mvaa 136,240,24
Mvaa 136,244,28
Mvaa 140,248,24
Mvaa 140,252,28
Ra 236,11,10240
Mvaa 144,240,32
Mvaa 144,244,36
Mvaa 148,248,32
Mvaa 148,252,36
Mvaa 152,240,40
Mvaa 152,244,44
Mvaa 156,248,40
Mvaa 156,252,44
Mvaa 160,240,48
Mvaa 160,244,52
Mvaa 164,248,48
Mvaa 164,252,52
Mvaa 168,240,56
Mvaa 168,244,60
s_waitcnt vmcnt(9)
Mvaa 172,248,56
s_waitcnt lgkmcnt(0)
s_barrier
Mvaa 172,252,60
s_add_u32 m0, s57, 0
Mvaa 176,224,0
buffer_load_dwordx4 v6, s[12:15], s52 offen offset:0 lds
Mvaa 176,228,4
Ta 64,14,0
Ta 66,14,2048
Mvaa 180,232,0
Mvaa 180,236,4
Ra 240,10,12288
Mvaa 184,224,8
buffer_load_dwordx4 v7, s[12:15], s53 offen offset:1024 lds
Mvaa 184,228,12
Ta 68,14,16384
Ta 70,14,18432
Mvaa 188,232,8
Mvaa 188,236,12
Ra 244,11,12288
Mvaa 192,224,16
buffer_load_dwordx4 v6, s[12:15], s54 offen offset:2048 lds
Mvaa 192,228,20
Ta 72,15,0
Ta 74,15,2048
Mvaa 196,232,16
Mvaa 196,236,20
Ra 248,10,14336
Mvaa 200,224,24
buffer_load_dwordx4 v7, s[12:15], s55 offen offset:3072 lds
Mvaa 200,228,28
Ta 76,15,16384
Ta 78,15,18432
Mvaa 204,232,24
s_cmp_eq_u32 s6, 0
s_cselect_b32 s3, 0, 2146435072
Mvaa 204,236,28
s_add_u32 m0, s57, 4096
Ra 252,11,14336
Mvaa 208,224,32
buffer_load_dwordx4 v8, s[12:15], s52 offen offset:0 lds
Mvaa 208,228,36
s_mov_b64 exec, 1
buffer_atomic_add v30, v31, s[28:31], s3 offen sc1
s_mov_b64 exec, -1
Mvaa 212,232,32
Mvaa 212,236,36
Ta 80,24,0
Ta 82,24,2048
Mvaa 216,224,40
buffer_load_dwordx4 v9, s[12:15], s53 offen offset:1024 lds
Mvaa 216,228,44
Ta 84,24,16384
s_waitcnt lgkmcnt(9)
Ta 86,24,18432
Mvaa 220,232,40
Mvaa 220,236,44
Ta 88,25,0
Ta 90,25,2048
Mvaa 224,224,48
buffer_load_dwordx4 v8, s[12:15], s54 offen offset:2048 lds
Mvaa 224,228,52
Mvaa 228,232,48
Mvaa 228,236,52
Ta 92,25,16384
Ta 94,25,18432
Mvaa 232,224,56
buffer_load_dwordx4 v9, s[12:15], s55 offen offset:3072 lds
Mvaa 232,228,60
s_waitcnt vmcnt(10)
Ta 96,26,0
s_waitcnt lgkmcnt(9)
Ta 98,26,2048
Mvaa 236,232,56
s_barrier
v_xor_b32 v6, 524288, v6
v_xor_b32 v7, 524288, v7
Mvaa 236,236,60
s_add_u32 m0, s56, 0
Ta 100,26,16384
Ta 102,26,18432
Mvaa 240,240,0
buffer_load_dwordx4 v2, s[8:11], s48 offen offset:0 lds
Mvaa 240,244,4
v_xor_b32 v8, 524288, v8
v_xor_b32 v9, 524288, v9
Mvaa 244,248,0
Mvaa 244,252,4
Ra 224,12,0
Mvaa 248,240,8
buffer_load_dwordx4 v3, s[8:11], s49 offen offset:1024 lds
Mvaa 248,244,12
Ta 104,27,0
Ta 106,27,2048
Mvaa 252,248,8
Mvaa 252,252,12
s_waitcnt lgkmcnt(9)
Ra 228,13,0
Maaa 128,240,16
buffer_load_dwordx4 v2, s[8:11], s50 offen offset:2048 lds
Maaa 128,244,20
Ta 108,27,16384
Ta 110,27,18432
Maaa 132,248,16
Maaa 132,252,20
Ra 232,12,2048
Maaa 136,240,24
buffer_load_dwordx4 v3, s[8:11], s51 offen offset:3072 lds
Maaa 136,244,28
Ta 112,28,0
Ta 114,28,2048
Maaa 140,248,24
Maaa 140,252,28
s_add_u32 m0, s56, 4096
s_waitcnt lgkmcnt(9)
Ra 236,13,2048
Maaa 144,240,32
buffer_load_dwordx4 v4, s[8:11], s48 offen offset:0 lds
Maaa 144,244,36
Maaa 148,248,32
Maaa 148,252,36
Ta 116,28,16384
Ta 118,28,18432
Maaa 152,240,40
buffer_load_dwordx4 v5, s[8:11], s49 offen offset:1024 lds
Maaa 152,244,44
Ta 120,29,0
Ta 122,29,2048
Maaa 156,248,40
Maaa 156,252,44
Ta 124,29,16384
s_waitcnt lgkmcnt(9)
Ta 126,29,18432
Maaa 160,240,48
buffer_load_dwordx4 v4, s[8:11], s50 offen offset:2048 lds
Maaa 160,244,52
Maaa 164,248,48
Maaa 164,252,52
Maaa 168,240,56
buffer_load_dwordx4 v5, s[8:11], s51 offen offset:3072 lds
Maaa 168,244,60
v_xor_b32 v2, 128, v2
v_xor_b32 v3, 128, v3
Maaa 172,248,56
s_waitcnt lgkmcnt(6)
buffer_load_dword v1, v47, s[60:63], 0 offen
v_xor_b32 v4, 128, v4
v_xor_b32 v5, 128, v5
Maaa 172,252,60
s_waitcnt lgkmcnt(0)
s_mul_i32 vcc_lo, s59, 3
v_xor_b32 v47, vcc_lo, v47
Mvaa 48,224,64
buffer_load_dword v44, v45, s[16:19], s47 offen
Mvaa 48,228,68
s_add_u32 s47, s47, 2097152
Mvaa 52,232,64
Mvaa 52,236,68
Ra 240,12,4096
Mvaa 56,224,72
Mvaa 56,228,76
Mvaa 60,232,72
Mvaa 60,236,76
Ra 244,13,4096
Mvaa 64,224,80
Mvaa 64,228,84
Mvaa 68,232,80
Mvaa 68,236,84
Ra 248,12,6144
Mvaa 72,224,88
Mvaa 72,228,92
Mvaa 76,232,88
Mvaa 76,236,92
Ra 252,13,6144
Mvaa 80,224,96
Mvaa 80,228,100
Mvaa 84,232,96
Mvaa 84,236,100
Mvaa 88,224,104
Mvaa 88,228,108
Mvaa 92,232,104
Mvaa 92,236,108
Mvaa 96,224,112
Mvaa 96,228,116
Mvaa 100,232,112
s_cmp_eq_u32 s6, 1
s_cselect_b32 s3, 0, 2146435072
Mvaa 100,236,116
s_mov_b64 exec, 1
buffer_atomic_add v30, v31, s[28:31], s3 offen sc1
s_mov_b64 exec, -1
Mvaa 104,224,120
Mvaa 104,228,124
Mvaa 108,232,120
s_waitcnt lgkmcnt(0)
Mvaa 108,236,124
Mvaa 112,240,64
Mvaa 112,244,68
Mvaa 116,248,64
Mvaa 116,252,68
Ra 224,12,8192
Mvaa 120,240,72
Mvaa 120,244,76
Mvaa 124,248,72
Mvaa 124,252,76
Ra 228,13,8192
Mvaa 128,240,80
Mvaa 128,244,84
Mvaa 132,248,80
Mvaa 132,252,84
Ra 232,12,10240
Mvaa 136,240,88
Mvaa 136,244,92
Mvaa 140,248,88
Mvaa 140,252,92
Ra 236,13,10240
Mvaa 144,240,96
Mvaa 144,244,100
Mvaa 148,248,96
Mvaa 148,252,100
Mvaa 152,240,104
Mvaa 152,244,108
Mvaa 156,248,104
Mvaa 156,252,108
Mvaa 160,240,112
Mvaa 160,244,116
Mvaa 164,248,112
Mvaa 164,252,116
Mvaa 168,240,120
Mvaa 168,244,124
s_waitcnt vmcnt(11)
Mvaa 172,248,120
s_waitcnt lgkmcnt(0)
s_barrier
Mvaa 172,252,124
s_add_u32 m0, s57, 65536
Mvaa 176,224,64
buffer_load_dwordx4 v6, s[12:15], s52 offen offset:0 lds
Mvaa 176,228,68
Ta 0,16,0
Ta 2,16,2048
Mvaa 180,232,64
Mvaa 180,236,68
Ra 240,12,12288
Mvaa 184,224,72
buffer_load_dwordx4 v7, s[12:15], s53 offen offset:1024 lds
Mvaa 184,228,76
Ta 4,16,16384
Ta 6,16,18432
Mvaa 188,232,72
Mvaa 188,236,76
Ra 244,13,12288
Mvaa 192,224,80
buffer_load_dwordx4 v6, s[12:15], s54 offen offset:2048 lds
Mvaa 192,228,84
Ta 8,17,0
Ta 10,17,2048
Mvaa 196,232,80
Mvaa 196,236,84
Ra 248,12,14336
Mvaa 200,224,88
buffer_load_dwordx4 v7, s[12:15], s55 offen offset:3072 lds
Mvaa 200,228,92
Ta 12,17,16384
Ta 14,17,18432
Mvaa 204,232,88
Mvaa 204,236,92
s_add_u32 m0, s57, 69632
Ra 252,13,14336
Mvaa 208,224,96
buffer_load_dwordx4 v8, s[12:15], s52 offen offset:0 lds
Mvaa 208,228,100
Mvaa 212,232,96
Mvaa 212,236,100
Ta 16,18,0
Ta 18,18,2048
Mvaa 216,224,104
buffer_load_dwordx4 v9, s[12:15], s53 offen offset:1024 lds
Mvaa 216,228,108
Ta 20,18,16384
s_waitcnt lgkmcnt(9)
Ta 22,18,18432
Mvaa 220,232,104
Mvaa 220,236,108
Ta 24,19,0
Ta 26,19,2048
Mvaa 224,224,112
buffer_load_dwordx4 v8, s[12:15], s54 offen offset:2048 lds
Mvaa 224,228,116
Mvaa 228,232,112
Mvaa 228,236,116
Ta 28,19,16384
Ta 30,19,18432
Mvaa 232,224,120
buffer_load_dwordx4 v9, s[12:15], s55 offen offset:3072 lds
Mvaa 232,228,124
s_waitcnt vmcnt(11)
Ta 32,20,0
s_waitcnt lgkmcnt(9)
Ta 34,20,2048
Mvaa 236,232,120
s_barrier
v_xor_b32 v6, 1572864, v6
v_xor_b32 v7, 1572864, v7
Mvaa 236,236,124
s_add_u32 m0, s56, 65536
Ta 36,20,16384
Ta 38,20,18432
Mvaa 240,240,64
buffer_load_dwordx4 v2, s[8:11], s48 offen offset:0 lds
Mvaa 240,244,68
v_xor_b32 v8, 1572864, v8
v_xor_b32 v9, 1572864, v9
Mvaa 244,248,64
Mvaa 244,252,68
Ra 224,10,0
Mvaa 248,240,72
buffer_load_dwordx4 v3, s[8:11], s49 offen offset:1024 lds
Mvaa 248,244,76
Ta 40,21,0
Ta 42,21,2048
Mvaa 252,248,72
Mvaa 252,252,76
s_waitcnt lgkmcnt(9)
Ra 228,11,0
Maaa 128,240,80
buffer_load_dwordx4 v2, s[8:11], s50 offen offset:2048 lds
Maaa 128,244,84
Ta 44,21,16384
Ta 46,21,18432
Maaa 132,248,80
s_cmp_eq_u32 s6, 2
s_cselect_b32 s3, 0, 2146435072
Maaa 132,252,84
Ra 232,10,2048
Maaa 136,240,88
buffer_load_dwordx4 v3, s[8:11], s51 offen offset:3072 lds
Maaa 136,244,92
Ta 48,22,0
Ta 50,22,2048
Maaa 140,248,88
s_mov_b64 exec, 1
buffer_atomic_add v30, v31, s[28:31], s3 offen sc1
s_mov_b64 exec, -1
Maaa 140,252,92
s_add_u32 m0, s56, 69632
s_waitcnt lgkmcnt(9)
Ra 236,11,2048
Maaa 144,240,96
buffer_load_dwordx4 v4, s[8:11], s48 offen offset:0 lds
Maaa 144,244,100
Maaa 148,248,96
Maaa 148,252,100
Ta 52,22,16384
Ta 54,22,18432
Maaa 152,240,104
buffer_load_dwordx4 v5, s[8:11], s49 offen offset:1024 lds
Maaa 152,244,108
Ta 56,23,0
Ta 58,23,2048
Maaa 156,248,104
Maaa 156,252,108
Ta 60,23,16384
s_waitcnt lgkmcnt(9)
Ta 62,23,18432
Maaa 160,240,112
buffer_load_dwordx4 v4, s[8:11], s50 offen offset:2048 lds
Maaa 160,244,116
Maaa 164,248,112
Maaa 164,252,116
Maaa 168,240,120
buffer_load_dwordx4 v5, s[8:11], s51 offen offset:3072 lds
Maaa 168,244,124
v_xor_b32 v2, 384, v2
v_xor_b32 v3, 384, v3
Maaa 172,248,120
s_waitcnt lgkmcnt(6)
buffer_load_dword v1, v47, s[60:63], 0 offen
v_xor_b32 v4, 384, v4
v_xor_b32 v5, 384, v5
Maaa 172,252,124
s_waitcnt lgkmcnt(0)
s_mul_i32 vcc_lo, s59, 1
v_xor_b32_e64 v47, vcc_lo, v47
Mvaa 48,224,0
buffer_load_dword v44, v45, s[16:19], s47 offen
Mvaa 48,228,4
s_add_u32 s47, s47, 2097152
Mvaa 52,232,0
Mvaa 52,236,4
Ra 240,10,4096
Mvaa 56,224,8
Mvaa 56,228,12
Mvaa 60,232,8
Mvaa 60,236,12
Ra 244,11,4096
Mvaa 64,224,16
Mvaa 64,228,20
Mvaa 68,232,16
Mvaa 68,236,20
Ra 248,10,6144
Mvaa 72,224,24
Mvaa 72,228,28
Mvaa 76,232,24
Mvaa 76,236,28
Ra 252,11,6144
Mvaa 80,224,32
Mvaa 80,228,36
Mvaa 84,232,32
Mvaa 84,236,36
Mvaa 88,224,40
Mvaa 88,228,44
Mvaa 92,232,40
Mvaa 92,236,44
Mvaa 96,224,48
Mvaa 96,228,52
Mvaa 100,232,48
Mvaa 100,236,52
Mvaa 104,224,56
Mvaa 104,228,60
Mvaa 108,232,56
s_waitcnt lgkmcnt(0)
Mvaa 108,236,60
Mvaa 112,240,0
Mvaa 112,244,4
Mvaa 116,248,0
Mvaa 116,252,4
Ra 224,10,8192
Mvaa 120,240,8
Mvaa 120,244,12
Mvaa 124,248,8
Mvaa 124,252,12
Ra 228,11,8192
Mvaa 128,240,16
Mvaa 128,244,20
Mvaa 132,248,16
Mvaa 132,252,20
Ra 232,10,10240
Mvaa 136,240,24
Mvaa 136,244,28
Mvaa 140,248,24
Mvaa 140,252,28
Ra 236,11,10240
Mvaa 144,240,32
Mvaa 144,244,36
Mvaa 148,248,32
Mvaa 148,252,36
Mvaa 152,240,40
s_cmp_eq_u32 s6, 3
s_cselect_b32 s3, 0, 2146435072
Mvaa 152,244,44
s_mov_b64 exec, 1
buffer_atomic_add v30, v31, s[28:31], s3 offen sc1
s_mov_b64 exec, -1
Mvaa 156,248,40
Mvaa 156,252,44
Mvaa 160,240,48
Mvaa 160,244,52
Mvaa 164,248,48
Mvaa 164,252,52
Mvaa 168,240,56
Mvaa 168,244,60
s_waitcnt vmcnt(12)
Mvaa 172,248,56
s_waitcnt lgkmcnt(0)
s_barrier
Mvaa 172,252,60
s_add_u32 m0, s57, 0
Mvaa 176,224,0
buffer_load_dwordx4 v6, s[12:15], s52 offen offset:0 lds
Mvaa 176,228,4
Ta 64,14,0
Ta 66,14,2048
Mvaa 180,232,0
Mvaa 180,236,4
Ra 240,10,12288
Mvaa 184,224,8
buffer_load_dwordx4 v7, s[12:15], s53 offen offset:1024 lds
Mvaa 184,228,12
Ta 68,14,16384
Ta 70,14,18432
Mvaa 188,232,8
Mvaa 188,236,12
Ra 244,11,12288
Mvaa 192,224,16
buffer_load_dwordx4 v6, s[12:15], s54 offen offset:2048 lds
Mvaa 192,228,20
Ta 72,15,0
Ta 74,15,2048
Mvaa 196,232,16
Mvaa 196,236,20
Ra 248,10,14336
Mvaa 200,224,24
buffer_load_dwordx4 v7, s[12:15], s55 offen offset:3072 lds
Mvaa 200,228,28
Ta 76,15,16384
Ta 78,15,18432
Mvaa 204,232,24
Mvaa 204,236,28
s_add_u32 m0, s57, 4096
Ra 252,11,14336
Mvaa 208,224,32
buffer_load_dwordx4 v8, s[12:15], s52 offen offset:0 lds
Mvaa 208,228,36
Mvaa 212,232,32
Mvaa 212,236,36
Ta 80,24,0
Ta 82,24,2048
Mvaa 216,224,40
buffer_load_dwordx4 v9, s[12:15], s53 offen offset:1024 lds
Mvaa 216,228,44
Ta 84,24,16384
s_waitcnt lgkmcnt(9)
Ta 86,24,18432
Mvaa 220,232,40
Mvaa 220,236,44
Ta 88,25,0
Ta 90,25,2048
Mvaa 224,224,48
buffer_load_dwordx4 v8, s[12:15], s54 offen offset:2048 lds
Mvaa 224,228,52
Mvaa 228,232,48
Mvaa 228,236,52
Ta 92,25,16384
Ta 94,25,18432
Mvaa 232,224,56
buffer_load_dwordx4 v9, s[12:15], s55 offen offset:3072 lds
Mvaa 232,228,60
s_waitcnt vmcnt(11)
Ta 96,26,0
s_waitcnt lgkmcnt(9)
Ta 98,26,2048
Mvaa 236,232,56
s_barrier
v_xor_b32 v6, 524288, v6
v_xor_b32 v7, 524288, v7
Mvaa 236,236,60
s_add_u32 m0, s56, 0
Ta 100,26,16384
Ta 102,26,18432
Mvaa 240,240,0
buffer_load_dwordx4 v2, s[8:11], s48 offen offset:0 lds
Mvaa 240,244,4
v_xor_b32 v8, 524288, v8
v_xor_b32 v9, 524288, v9
Mvaa 244,248,0
Mvaa 244,252,4
Ra 224,12,0
Mvaa 248,240,8
buffer_load_dwordx4 v3, s[8:11], s49 offen offset:1024 lds
Mvaa 248,244,12
Ta 104,27,0
Ta 106,27,2048
Mvaa 252,248,8
Mvaa 252,252,12
s_waitcnt lgkmcnt(9)
Ra 228,13,0
Maaa 128,240,16
buffer_load_dwordx4 v2, s[8:11], s50 offen offset:2048 lds
Maaa 128,244,20
Ta 108,27,16384
Ta 110,27,18432
Maaa 132,248,16
Maaa 132,252,20
Ra 232,12,2048
Maaa 136,240,24
buffer_load_dwordx4 v3, s[8:11], s51 offen offset:3072 lds
Maaa 136,244,28
Ta 112,28,0
Ta 114,28,2048
Maaa 140,248,24
Maaa 140,252,28
s_add_u32 m0, s56, 4096
s_waitcnt lgkmcnt(9)
Ra 236,13,2048
Maaa 144,240,32
buffer_load_dwordx4 v4, s[8:11], s48 offen offset:0 lds
Maaa 144,244,36
Maaa 148,248,32
Maaa 148,252,36
Ta 116,28,16384
Ta 118,28,18432
Maaa 152,240,40
buffer_load_dwordx4 v5, s[8:11], s49 offen offset:1024 lds
Maaa 152,244,44
Ta 120,29,0
Ta 122,29,2048
Maaa 156,248,40
Maaa 156,252,44
Ta 124,29,16384
s_waitcnt lgkmcnt(9)
Ta 126,29,18432
Maaa 160,240,48
buffer_load_dwordx4 v4, s[8:11], s50 offen offset:2048 lds
Maaa 160,244,52
Maaa 164,248,48
Maaa 164,252,52
Maaa 168,240,56
buffer_load_dwordx4 v5, s[8:11], s51 offen offset:3072 lds
Maaa 168,244,60
v_xor_b32 v2, 128, v2
v_xor_b32 v3, 128, v3
Maaa 172,248,56
s_waitcnt lgkmcnt(6)
buffer_load_dword v1, v47, s[60:63], 0 offen
v_xor_b32 v4, 128, v4
v_xor_b32 v5, 128, v5
Maaa 172,252,60
s_waitcnt lgkmcnt(0)
s_mul_i32 vcc_lo, s59, 7
v_xor_b32 v47, vcc_lo, v47
Mvaa 48,224,64
buffer_load_dword v44, v45, s[16:19], s47 offen
Mvaa 48,228,68
s_add_u32 s47, s47, 2097152
v_lshrrev_b32 v32, 4, v0
v_and_b32 v33, 15, v0
Mvaa 52,232,64
s_lshl_b32 s3, s32, 4
v_add_u32 v34, s3, v32
v_lshlrev_b32_e64 v36, 1, v32
Mvaa 52,236,68
Ra 240,12,4096
Mvaa 56,224,72
v_xor_b32 v36, v36, v33
v_xor_b32 v37, 8, v36
Mvaa 56,228,76
Mvaa 60,232,72
Mvaa 60,236,76
Ra 244,13,4096
Mvaa 64,224,80
s_getpc_b64 s[6:7]
L_cpf3:
s_add_u32 s6, s6, (L_phase2-L_cpf3)&0xffffffff
s_addc_u32 s7, s7, ((L_phase2-L_cpf3)>>32)&0xffffffff
Mvaa 64,228,84
s_lshr_b32 s3, s2, 3
s_lshl_b32 s3, s3, 2
s_add_u32 s3, s3, s32
Mvaa 68,232,80
s_lshl_b32 s3, s3, 10
v_and_b32 v42, 7, v0
v_lshlrev_b32_e64 v42, 7, v42
Mvaa 68,236,84
Ra 248,12,6144
Mvaa 72,224,88
v_add_u32_e64 v42, s3, v42
v_min_u32 v42, L_k2_fin-L_phase2-4, v42
Mvaa 72,228,92
v_mov_b32_e64 v41, s7
Mvaa 76,232,88
v_add_co_u32 v40, vcc, s6, v42
s_nop 1
v_addc_co_u32 v41, vcc, 0, v41, vcc
Mvaa 76,236,92
Ra 252,13,6144
Mvaa 80,224,96
global_load_dword v38, v[40:41], off
Mvaa 80,228,100
Mvaa 84,232,96
Mvaa 84,236,100
Mvaa 88,224,104
Mvaa 88,228,108
Mvaa 92,232,104
Mvaa 92,236,108
Mvaa 96,224,112
Mvaa 96,228,116
Mvaa 100,232,112
Mvaa 100,236,116
Mvaa 104,224,120
Mvaa 104,228,124
Mvaa 108,232,120
s_waitcnt lgkmcnt(0)
Mvaa 108,236,124
Mvaa 112,240,64
Mvaa 112,244,68
Mvaa 116,248,64
Mvaa 116,252,68
Ra 224,12,8192
Mvaa 120,240,72
Mvaa 120,244,76
Mvaa 124,248,72
Mvaa 124,252,76
Ra 228,13,8192
Mvaa 128,240,80
Mvaa 128,244,84
Mvaa 132,248,80
Mvaa 132,252,84
Ra 232,12,10240
Mvaa 136,240,88
Mvaa 136,244,92
Mvaa 140,248,88
Mvaa 140,252,92
Ra 236,13,10240
Mvaa 144,240,96
Mvaa 144,244,100
Mvaa 148,248,96
Mvaa 148,252,100
Mvaa 152,240,104
Mvaa 152,244,108
Mvaa 156,248,104
Mvaa 156,252,108
Mvaa 160,240,112
Mvaa 160,244,116
Mvaa 164,248,112
Mvaa 164,252,116
Mvaa 168,240,120
Mvaa 168,244,124
s_waitcnt vmcnt(11)
Mvaa 172,248,120
s_waitcnt lgkmcnt(0)
s_barrier
Mvaa 172,252,124
s_add_u32 m0, s57, 65536
Mvaa 176,224,64
buffer_load_dwordx4 v6, s[12:15], s52 offen offset:0 lds
Mvaa 176,228,68
Ta 0,16,0
Ta 2,16,2048
Mvaa 180,232,64
Mvaa 180,236,68
Ra 240,12,12288
Mvaa 184,224,72
buffer_load_dwordx4 v7, s[12:15], s53 offen offset:1024 lds
Mvaa 184,228,76
Ta 4,16,16384
Ta 6,16,18432
Mvaa 188,232,72
Mvaa 188,236,76
Ra 244,13,12288
Mvaa 192,224,80
buffer_load_dwordx4 v6, s[12:15], s54 offen offset:2048 lds
Mvaa 192,228,84
Ta 8,17,0
Ta 10,17,2048
Mvaa 196,232,80
Mvaa 196,236,84
Ra 248,12,14336
Mvaa 200,224,88
buffer_load_dwordx4 v7, s[12:15], s55 offen offset:3072 lds
Mvaa 200,228,92
Ta 12,17,16384
Ta 14,17,18432
Mvaa 204,232,88
Mvaa 204,236,92
s_add_u32 m0, s57, 69632
Ra 252,13,14336
Mvaa 208,224,96
buffer_load_dwordx4 v8, s[12:15], s52 offen offset:0 lds
Mvaa 208,228,100
Mvaa 212,232,96
Mvaa 212,236,100
Ta 16,18,0
Ta 18,18,2048
Mvaa 216,224,104
buffer_load_dwordx4 v9, s[12:15], s53 offen offset:1024 lds
Mvaa 216,228,108
Ta 20,18,16384
s_waitcnt lgkmcnt(9)
Ta 22,18,18432
Mvaa 220,232,104
Mvaa 220,236,108
Ta 24,19,0
Ta 26,19,2048
Mvaa 224,224,112
buffer_load_dwordx4 v8, s[12:15], s54 offen offset:2048 lds
Mvaa 224,228,116
Mvaa 228,232,112
Mvaa 228,236,116
Ta 28,19,16384
Ta 30,19,18432
Mvaa 232,224,120
buffer_load_dwordx4 v9, s[12:15], s55 offen offset:3072 lds
Mvaa 232,228,124
s_waitcnt vmcnt(11)
Ta 32,20,0
s_waitcnt lgkmcnt(9)
Ta 34,20,2048
Mvaa 236,232,120
s_barrier
Mvaa 236,236,124
s_add_u32 m0, s56, 65536
Ta 36,20,16384
Ta 38,20,18432
Mvaa 240,240,64
buffer_load_dwordx4 v2, s[8:11], s48 offen offset:0 lds
Mvaa 240,244,68
Mvaa 244,248,64
Mvaa 244,252,68
Ra 224,10,0
Mvaa 248,240,72
buffer_load_dwordx4 v3, s[8:11], s49 offen offset:1024 lds
Mvaa 248,244,76
Ta 40,21,0
Ta 42,21,2048
Mvaa 252,248,72
Mvaa 252,252,76
s_waitcnt lgkmcnt(9)
Ra 228,11,0
Maaa 128,240,80
buffer_load_dwordx4 v2, s[8:11], s50 offen offset:2048 lds
Maaa 128,244,84
Ta 44,21,16384
Ta 46,21,18432
Maaa 132,248,80
Maaa 132,252,84
Ra 232,10,2048
Maaa 136,240,88
buffer_load_dwordx4 v3, s[8:11], s51 offen offset:3072 lds
Maaa 136,244,92
Ta 48,22,0
Ta 50,22,2048
Maaa 140,248,88
Maaa 140,252,92
s_add_u32 m0, s56, 69632
s_waitcnt lgkmcnt(9)
Ra 236,11,2048
Maaa 144,240,96
buffer_load_dwordx4 v4, s[8:11], s48 offen offset:0 lds
Maaa 144,244,100
Maaa 148,248,96
Maaa 148,252,100
Ta 52,22,16384
Ta 54,22,18432
Maaa 152,240,104
buffer_load_dwordx4 v5, s[8:11], s49 offen offset:1024 lds
Maaa 152,244,108
Ta 56,23,0
Ta 58,23,2048
Maaa 156,248,104
Maaa 156,252,108
Ta 60,23,16384
s_waitcnt lgkmcnt(9)
Ta 62,23,18432
Maaa 160,240,112
buffer_load_dwordx4 v4, s[8:11], s50 offen offset:2048 lds
Maaa 160,244,116
Maaa 164,248,112
Maaa 164,252,116
Maaa 168,240,120
buffer_load_dwordx4 v5, s[8:11], s51 offen offset:3072 lds
Maaa 168,244,124
Maaa 172,248,120
s_waitcnt lgkmcnt(6)
Maaa 172,252,124
s_waitcnt lgkmcnt(0)
Mvaa 48,224,0
buffer_load_dword v1, v31, s[28:31], s37 offen sc1
Mvaa 48,228,4
s_mov_b32 s8, s16
s_mov_b32 s9, s17
s_mov_b32 s10, s18
Mvaa 52,232,0
s_add_u32 s16, s66, 46137344
s_addc_u32 s17, s67, 0
s_and_b32 s17, s17, 0xffff
Mvaa 52,236,4
Ra 240,10,4096
Mvaa 56,224,8
s_mov_b32 s18, 16777216
s_mov_b32 s19, 0x20000
s_mov_b32 s48, 0
Mvaa 56,228,12
s_mov_b32 s49, 31744
s_mov_b32 s50, 63488
s_mov_b32 s51, 95232
Mvaa 60,232,8
v_lshlrev_b32 v35, 13, v34
Mvaa 60,236,12
Ra 244,11,4096
Mvaa 64,224,16
s_and_b32 s52, s33, 0
s_lshl_b32 s3, s52, 19
s_lshl_b32 s52, s52, 11
Mvaa 64,228,20
s_add_u32 s53, s52, s58
v_add_u32_e64 v35, s3, v35
v_lshl_add_u32 v8, v36, 4, v35
Mvaa 68,232,16
v_lshl_add_u32 v9, v37, 4, v35
v_lshlrev_b32_e64 v2, 4, v0
Mvaa 68,236,20
Ra 248,10,6144
Mvaa 72,224,24
v_add_u32 v3, 65536, v2
v_add_u32_e64 v4, s44, v2
Mvaa 72,228,28
v_mov_b32 v7, 0
v_lshlrev_b32 v35, 2, v32
Mvaa 76,232,24
v_sub_u32_e64 v35, v33, v35
Mvaa 76,236,28
Ra 252,11,6144
Mvaa 80,224,32
s_lshl_b32 s3, s32, 4
v_add_u32 v5, s3, v35
Mvaa 80,228,36
s_sub_u32 s3, 48, s3
v_add_u32 v6, s3, v35
Mvaa 84,232,32
s_mul_i32 s3, s33, 1116160
s_add_u32 s3, s3, 8388608
s_add_u32 s12, s66, s3
s_addc_u32 s13, s67, 0
s_and_b32 s13, s13, 0xffff
Mvaa 84,236,36
s_mov_b32 s14, 0
s_mov_b32 s15, 0x20000
s_mul_i32 s14, s36, 34816
Mvaa 88,224,40
buffer_load_dword v44, v45, s[8:11], s47 offen
Mvaa 88,228,44
s_add_u32 s47, s47, 2097152
v_lshrrev_b32 v42, 2, v33
v_lshl_add_u32 v43, v32, 3, v42
Mvaa 92,232,40
v_lshlrev_b32 v43, 8, v43
v_and_b32 v46, 3, v0
Mvaa 92,236,44
v_lshl_add_u32 v43, v46, 3, v43
v_and_b32_e64 v46, 1, v32
Mvaa 96,224,48
v_lshl_add_u32 v42, v46, 2, v42
v_lshl_add_u32 v16, v42, 5, v43
Mvaa 96,228,52
v_xor_b32 v17, 32, v16
v_xor_b32 v18, 64, v16
Mvaa 100,232,48
v_xor_b32 v19, 96, v16
v_xor_b32 v20, 128, v16
Mvaa 100,236,52
v_xor_b32 v21, 160, v16
v_xor_b32 v22, 192, v16
Mvaa 104,224,56
v_xor_b32 v23, 224, v16
Mvaa 104,228,60
Mvaa 108,232,56
s_waitcnt lgkmcnt(0)
Mvaa 108,236,60
Mvaa 112,240,0
Mvaa 112,244,4
Mvaa 116,248,0
Mvaa 116,252,4
Ra 224,10,8192
Mvaa 120,240,8
Mvaa 120,244,12
Mvaa 124,248,8
Mvaa 124,252,12
Ra 228,11,8192
Mvaa 128,240,16
Mvaa 128,244,20
Mvaa 132,248,16
Mvaa 132,252,20
Ra 232,10,10240
Mvaa 136,240,24
Mvaa 136,244,28
Mvaa 140,248,24
Mvaa 140,252,28
Ra 236,11,10240
Mvaa 144,240,32
Mvaa 144,244,36
Mvaa 148,248,32
Mvaa 148,252,36
Mvaa 152,240,40
Mvaa 152,244,44
Mvaa 156,248,40
Mvaa 156,252,44
Mvaa 160,240,48
Mvaa 160,244,52
Mvaa 164,248,48
Mvaa 164,252,52
Mvaa 168,240,56
Mvaa 168,244,60
s_waitcnt vmcnt(10)
Mvaa 172,248,56
s_waitcnt lgkmcnt(0)
s_barrier
Mvaa 172,252,60
s_add_u32 m0, s44, 0
Mvaa 176,224,0
buffer_load_dwordx4 v8, s[8:11], s48 offen offset:0 lds
Mvaa 176,228,4
Ta 64,14,0
Ta 66,14,2048
Mvaa 180,232,0
Mvaa 180,236,4
Ra 240,10,12288
Mvaa 184,224,8
buffer_load_dwordx4 v8, s[8:11], s49 offen offset:1024 lds
Mvaa 184,228,12
Ta 68,14,16384
Ta 70,14,18432
Mvaa 188,232,8
Mvaa 188,236,12
Ra 244,11,12288
Mvaa 192,224,16
buffer_load_dwordx4 v9, s[8:11], s50 offen offset:2048 lds
Mvaa 192,228,20
Ta 72,15,0
Ta 74,15,2048
Mvaa 196,232,16
Mvaa 196,236,20
Ra 248,10,14336
Mvaa 200,224,24
buffer_load_dwordx4 v9, s[8:11], s51 offen offset:3072 lds
Mvaa 200,228,28
Ta 76,15,16384
Ta 78,15,18432
Mvaa 204,232,24
v_xor_b32 v8, 524288, v8
v_xor_b32 v9, 524288, v9
Mvaa 204,236,28
s_add_u32 m0, s44, 16384
Ra 252,11,14336
Mvaa 208,224,32
buffer_load_dwordx4 v8, s[8:11], s48 offen offset:0 lds
Mvaa 208,228,36
Mvaa 212,232,32
Mvaa 212,236,36
Ta 80,24,0
Ta 82,24,2048
Mvaa 216,224,40
buffer_load_dwordx4 v8, s[8:11], s49 offen offset:1024 lds
Mvaa 216,228,44
Ta 84,24,16384
s_waitcnt lgkmcnt(9)
Ta 86,24,18432
Mvaa 220,232,40
Mvaa 220,236,44
Ta 88,25,0
Ta 90,25,2048
Mvaa 224,224,48
buffer_load_dwordx4 v9, s[8:11], s50 offen offset:2048 lds
Mvaa 224,228,52
Mvaa 228,232,48
s_mul_i32 s3, s45, 33792
v_add_u32_e64 v10, s3, v2
Mvaa 228,236,52
Ta 92,25,16384
Ta 94,25,18432
Mvaa 232,224,56
buffer_load_dwordx4 v9, s[8:11], s51 offen offset:3072 lds
Mvaa 232,228,60
s_waitcnt vmcnt(10)
Ta 96,26,0
s_waitcnt lgkmcnt(9)
Ta 98,26,2048
Mvaa 236,232,56
s_barrier
v_xor_b32 v8, 1572864, v8
v_xor_b32 v9, 1572864, v9
Mvaa 236,236,60
s_add_u32 m0, s44, 32768
Ta 100,26,16384
Ta 102,26,18432
Mvaa 240,240,0
buffer_load_dwordx4 v8, s[8:11], s48 offen offset:0 lds
Mvaa 240,244,4
s_mul_i32 s3, s46, 33792
v_add_u32 v11, s3, v2
Mvaa 244,248,0
Mvaa 244,252,4
Ra 224,12,0
Mvaa 248,240,8
buffer_load_dwordx4 v8, s[8:11], s49 offen offset:1024 lds
Mvaa 248,244,12
Ta 104,27,0
Ta 106,27,2048
Mvaa 252,248,8
Mvaa 252,252,12
s_waitcnt lgkmcnt(9)
Ra 228,13,0
Maaa 128,240,16
buffer_load_dwordx4 v9, s[8:11], s50 offen offset:2048 lds
Maaa 128,244,20
Ta 108,27,16384
Ta 110,27,18432
Maaa 132,248,16
Maaa 132,252,20
Ra 232,12,2048
Maaa 136,240,24
buffer_load_dwordx4 v9, s[8:11], s51 offen offset:3072 lds
Maaa 136,244,28
Ta 112,28,0
Ta 114,28,2048
Maaa 140,248,24
v_xor_b32 v8, 524288, v8
v_xor_b32 v9, 524288, v9
Maaa 140,252,28
s_add_u32 m0, s44, 49152
s_waitcnt lgkmcnt(9)
Ra 236,13,2048
Maaa 144,240,32
buffer_load_dwordx4 v8, s[8:11], s48 offen offset:0 lds
Maaa 144,244,36
Maaa 148,248,32
Maaa 148,252,36
Ta 116,28,16384
Ta 118,28,18432
Maaa 152,240,40
buffer_load_dwordx4 v8, s[8:11], s49 offen offset:1024 lds
Maaa 152,244,44
Ta 120,29,0
Ta 122,29,2048
Maaa 156,248,40
Maaa 156,252,44
Ta 124,29,16384
s_waitcnt lgkmcnt(9)
Ta 126,29,18432
Maaa 160,240,48
buffer_load_dwordx4 v9, s[8:11], s50 offen offset:2048 lds
Maaa 160,244,52
Maaa 164,248,48
Maaa 164,252,52
Maaa 168,240,56
buffer_load_dwordx4 v9, s[8:11], s51 offen offset:3072 lds
Maaa 168,244,60
v_xor_b32 v8, 3670016, v8
v_xor_b32 v9, 3670016, v9
Maaa 172,248,56
s_waitcnt lgkmcnt(6)
Maaa 172,252,60
s_waitcnt lgkmcnt(0)
Mvaa 48,224,64
v_mov_b32 v14, v40
v_mov_b32_e64 v15, v41
Mvaa 48,228,68
Mvaa 52,232,64
Mvaa 52,236,68
Ra 240,12,4096
Mvaa 56,224,72
Mvaa 56,228,76
Mvaa 60,232,72
Mvaa 60,236,76
Ra 244,13,4096
Mvaa 64,224,80
Vc 24,48,49
Vc 25,50,51
Mvaa 64,228,84
Vc 26,52,53
Vc 27,54,55
Mvaa 68,232,80
Mvaa 68,236,84
Ra 248,12,6144
Mvaa 72,224,88
Vc 28,56,57
Vc 29,58,59
Mvaa 72,228,92
Vc 30,60,61
Vc 31,62,63
Mvaa 76,232,88
Mvaa 76,236,92
Ra 252,13,6144
Mvaa 80,224,96
Vc 32,64,65
Vc 33,66,67
Mvaa 80,228,100
Vc 34,68,69
Vc 35,70,71
Mvaa 84,232,96
Mvaa 84,236,100
Mvaa 88,224,104
Vc 36,72,73
Vc 37,74,75
Mvaa 88,228,108
Vc 38,76,77
Vc 39,78,79
Mvaa 92,232,104
Mvaa 92,236,108
Mvaa 96,224,112
Vc 40,80,81
Vc 41,82,83
Mvaa 96,228,116
Vc 42,84,85
Vc 43,86,87
Mvaa 100,232,112
s_waitcnt vmcnt(12)
Mvaa 100,236,116
s_add_u32 s59, s38, 0
Mvaa 104,224,120
v_readfirstlane_b32 s3, v1
s_nop 0
s_or_b32 s3, s3, s37
s_cmp_lt_u32 s3, 256
s_cbranch_scc1 L_spinAv
L_spinArv:
s_barrier
Mvaa 104,228,124
buffer_store_dwordx4 v[24:27], v2, s[24:27], s59 offen offset:0 sc1
Mvaa 108,232,120
s_waitcnt lgkmcnt(0)
Mvaa 108,236,124
Vc 44,88,89
Vc 45,90,91
Mvaa 112,240,64
buffer_load_dwordx4 a[0:3], v10, s[20:23], s53 offen offset:0 sc1
Mvaa 112,244,68
Vc 46,92,93
Vc 47,94,95
Mvaa 116,248,64
Vc 48,96,97
Vc 49,98,99
Mvaa 116,252,68
Ra 224,12,8192
Mvaa 120,240,72
Vc 50,100,101
Vc 51,102,103
Mvaa 120,244,76
Vc 52,104,105
Vc 53,106,107
Mvaa 124,248,72
buffer_load_dwordx4 a[4:7], v10, s[20:23], s52 offen offset:0 sc1
Mvaa 124,252,76
Ra 228,13,8192
Mvaa 128,240,80
Vc 54,108,109
Vc 55,110,111
Mvaa 128,244,84
Vc 56,112,113
Vc 57,114,115
Mvaa 132,248,80
Vc 58,116,117
Vc 59,118,119
Mvaa 132,252,84
Ra 232,12,10240
Mvaa 136,240,88
buffer_load_dwordx4 a[8:11], v11, s[20:23], s53 offen offset:0 sc1
Mvaa 136,244,92
buffer_store_dwordx4 v[28:31], v2, s[24:27], s59 offen offset:1024 sc1
Mvaa 140,248,88
Vc 60,120,121
Vc 61,122,123
Mvaa 140,252,92
Ra 236,13,10240
Mvaa 144,240,96
Vc 62,124,125
Vc 63,126,127
Mvaa 144,244,100
Vc 64,128,129
Vc 65,130,131
Mvaa 148,248,96
buffer_load_dwordx4 a[12:15], v11, s[20:23], s52 offen offset:0 sc1
Mvaa 148,252,100
Vc 66,132,133
Vc 67,134,135
Mvaa 152,240,104
Vc 68,136,137
Vc 69,138,139
Mvaa 152,244,108
Vc 70,140,141
Vc 71,142,143
Mvaa 156,248,104
Mvaa 156,252,108
Mvaa 160,240,112
buffer_load_dwordx4 a[16:19], v10, s[20:23], s53 offen offset:1024 sc1
Mvaa 160,244,116
Vc 72,144,145
Vc 73,146,147
Mvaa 164,248,112
Vc 74,148,149
Vc 75,150,151
Mvaa 164,252,116
buffer_store_dwordx4 v[32:35], v2, s[24:27], s59 offen offset:2048 sc1
Mvaa 168,240,120
Vc 76,152,153
Vc 77,154,155
Mvaa 168,244,124
Vc 78,156,157
Vc 79,158,159
Mvaa 172,248,120
s_waitcnt lgkmcnt(0)
buffer_load_dwordx4 a[20:23], v10, s[20:23], s52 offen offset:1024 sc1
Mvaa 172,252,124
Mvaa 176,224,64
Vc 80,160,161
Vc 81,162,163
Mvaa 176,228,68
Vc 82,164,165
Vc 83,166,167
Mvaa 180,232,64
Mvaa 180,236,68
Ra 240,12,12288
Mvaa 184,224,72
buffer_load_dwordx4 a[24:27], v11, s[20:23], s53 offen offset:1024 sc1
Mvaa 184,228,76
Vc 84,168,169
Vc 85,170,171
Mvaa 188,232,72
Vc 86,172,173
Vc 87,174,175
Mvaa 188,236,76
Ra 244,13,12288
Mvaa 192,224,80
Vc 88,176,177
Vc 89,178,179
Mvaa 192,228,84
Vc 90,180,181
Vc 91,182,183
Mvaa 196,232,80
buffer_load_dwordx4 a[28:31], v11, s[20:23], s52 offen offset:1024 sc1
Mvaa 196,236,84
Ra 248,12,14336
s_xor_b32 s52, s52, 2048
Mvaa 200,224,88
s_add_u32 s53, s52, s58
Mvaa 200,228,92
Vc 92,184,185
Vc 93,186,187
Mvaa 204,232,88
Vc 94,188,189
Vc 95,190,191
Mvaa 204,236,92
Ra 252,13,14336
Mvaa 208,224,96
buffer_load_dwordx4 a[32:35], v10, s[20:23], s53 offen offset:0 sc1
Mvaa 208,228,100
buffer_store_dwordx4 v[36:39], v2, s[24:27], s59 offen offset:3072 sc1
Mvaa 212,232,96
Vc 96,192,193
Vc 97,194,195
Mvaa 212,236,100
Vc 98,196,197
Vc 99,198,199
Mvaa 216,224,104
Vc 100,200,201
Vc 101,202,203
Mvaa 216,228,108
Vc 102,204,205
Vc 103,206,207
Mvaa 220,232,104
buffer_load_dwordx4 a[36:39], v10, s[20:23], s52 offen offset:0 sc1
Mvaa 220,236,108
Mvaa 224,224,112
Vc 104,208,209
Vc 105,210,211
Mvaa 224,228,116
Vc 106,212,213
Vc 107,214,215
Mvaa 228,232,112
Mvaa 228,236,116
Mvaa 232,224,120
buffer_load_dwordx4 a[40:43], v11, s[20:23], s53 offen offset:0 sc1
Mvaa 232,228,124
Vc 108,216,217
Vc 109,218,219
Mvaa 236,232,120
s_waitcnt lgkmcnt(0)
Mvaa 236,236,124
Vc 110,220,221
Vc 111,222,223
Mvaa 240,240,64
s_add_u32 s59, s38, 4096
Mvaa 240,244,68
buffer_store_dwordx4 v[40:43], v2, s[24:27], s59 offen offset:0 sc1
Mvaa 244,248,64
buffer_load_dwordx4 a[44:47], v11, s[20:23], s52 offen offset:0 sc1
Mvaa 244,252,68
Vc 112,224,225
Vc 113,226,227
Mvaa 248,240,72
Vc 114,228,229
Vc 115,230,231
Mvaa 248,244,76
Vc 116,232,233
Vc 117,234,235
Mvaa 252,248,72
Vc 118,236,237
Vc 119,238,239
Mvaa 252,252,76
Maaa 128,240,80
buffer_load_dwordx4 a[48:51], v10, s[20:23], s53 offen offset:1024 sc1
Maaa 128,244,84
Ta 192,16,0
Ta 194,16,1024
Maaa 132,248,80
Vc 120,240,241
Vc 121,242,243
Maaa 132,252,84
Ta 196,17,0
Ta 198,17,1024
Maaa 136,240,88
Vc 122,244,245
Vc 123,246,247
Maaa 136,244,92
Ta 200,18,0
Ta 202,18,1024
Maaa 140,248,88
buffer_load_dwordx4 a[52:55], v10, s[20:23], s52 offen offset:1024 sc1
Maaa 140,252,92
Ta 204,19,0
Ta 206,19,1024
Maaa 144,240,96
Vc 124,248,249
Vc 125,250,251
Maaa 144,244,100
Ta 208,20,0
Ta 210,20,1024
Maaa 148,248,96
Vc 126,252,253
Vc 127,254,255
Maaa 148,252,100
Ta 212,21,0
Ta 214,21,1024
Maaa 152,240,104
buffer_load_dwordx4 a[56:59], v11, s[20:23], s53 offen offset:1024 sc1
Maaa 152,244,108
Ta 216,22,0
Ta 218,22,1024
Maaa 156,248,104
buffer_store_dwordx4 v[44:47], v2, s[24:27], s59 offen offset:1024 sc1
Maaa 156,252,108
Ta 220,23,0
s_waitcnt lgkmcnt(9)
Ta 222,23,1024
Maaa 160,240,112
Maaa 160,244,116
Maaa 164,248,112
buffer_load_dwordx4 a[60:63], v11, s[20:23], s52 offen offset:1024 sc1
Maaa 164,252,116
s_xor_b32 s52, s52, 6144
s_add_u32 s53, s52, s58
Maaa 168,240,120
Maaa 168,244,124
Maaa 172,248,120
Maaa 172,252,124
L_phase2:
s_nop 7
s_waitcnt vmcnt(16) lgkmcnt(0)
Zvaa 128,192,0
buffer_store_dwordx4 v[48:51], v2, s[24:27], s59 offen offset:2048 sc1
Zvaa 160,192,4
Ta 224,16,8192
Ta 226,16,9216
Zvaa 192,192,8
buffer_load_dwordx4 a[64:67], v10, s[20:23], s53 offen offset:0 sc1
Zvaa 224,192,12
s_mov_b32 s60, s40
s_and_b32 s61, s41, 0xffff
s_mov_b32 s62, 7340032
Zvaa 132,196,0
Ta 228,17,8192
Ta 230,17,9216
Zvaa 164,196,4
buffer_load_dwordx4 a[68:71], v10, s[20:23], s52 offen offset:0 sc1
Zvaa 196,196,8
s_mov_b32 s63, 0x20000
Zvaa 228,196,12
Ta 232,18,8192
Ta 234,18,9216
Zvaa 136,200,0
global_load_dword v13, v[14:15], off
Zvaa 168,200,4
buffer_load_dwordx4 a[72:75], v11, s[20:23], s53 offen offset:0 sc1
Zvaa 200,200,8
Ta 236,19,8192
Ta 238,19,9216
Zvaa 232,200,12
Zvaa 140,204,0
buffer_load_dwordx4 a[76:79], v11, s[20:23], s52 offen offset:0 sc1
Zvaa 172,204,4
Ta 240,20,8192
Ta 242,20,9216
Zvaa 204,204,8
Zvaa 236,204,12
Zvaa 144,208,0
s_waitcnt lgkmcnt(6)
Ta 244,21,8192
Ta 246,21,9216
Zvaa 176,208,4
buffer_load_dwordx4 a[80:83], v10, s[20:23], s53 offen offset:1024 sc1
Zvaa 208,208,8
Zvaa 240,208,12
Ta 248,22,8192
Ta 250,22,9216
Zvaa 148,212,0
buffer_load_dwordx4 a[84:87], v10, s[20:23], s52 offen offset:1024 sc1
Zvaa 180,212,4
Zvaa 212,212,8
Ta 252,23,8192
Ta 254,23,9216
Zvaa 244,212,12
Zvaa 152,216,0
buffer_load_dwordx4 a[88:91], v11, s[20:23], s53 offen offset:1024 sc1
Zvaa 184,216,4
Zvaa 216,216,8
buffer_load_dwordx4 a[92:95], v11, s[20:23], s52 offen offset:1024 sc1
Zvaa 248,216,12
s_xor_b32 s52, s52, 2048
s_add_u32 s53, s52, s58
Zvaa 156,220,0
buffer_store_dwordx4 v[52:55], v2, s[24:27], s59 offen offset:3072 sc1
Zvaa 188,220,4
Zvaa 220,220,8
s_waitcnt vmcnt(22) lgkmcnt(0)
Zvaa 252,220,12
s_barrier
Mvaa 128,224,16
Mvaa 160,224,20
s_add_u32 m0, s44, 0
Ta 192,16,16384
Ta 194,16,17408
Mvaa 192,224,24
buffer_load_dwordx4 v8, s[8:11], s48 offen offset:0 lds
Mvaa 224,224,28
Mvaa 132,228,16
Ta 196,17,16384
Ta 198,17,17408
Mvaa 164,228,20
Mvaa 196,228,24
buffer_load_dwordx4 v8, s[8:11], s49 offen offset:1024 lds
Mvaa 228,228,28
Ta 200,18,16384
Ta 202,18,17408
Mvaa 136,232,16
Mvaa 168,232,20
Mvaa 200,232,24
Ta 204,19,16384
Ta 206,19,17408
Mvaa 232,232,28
buffer_load_dwordx4 a[96:99], v10, s[20:23], s53 offen offset:0 sc1
Mvaa 140,236,16
Mvaa 172,236,20
Ta 208,20,16384
Ta 210,20,17408
Mvaa 204,236,24
Mvaa 236,236,28
Mvaa 144,240,16
s_waitcnt lgkmcnt(6)
Ta 212,21,16384
Ta 214,21,17408
Mvaa 176,240,20
buffer_load_dwordx4 a[100:103], v10, s[20:23], s52 offen offset:0 sc1
Mvaa 208,240,24
Mvaa 240,240,28
Ta 216,22,16384
Ta 218,22,17408
Mvaa 148,244,16
Mvaa 180,244,20
buffer_load_dwordx4 a[104:107], v11, s[20:23], s53 offen offset:0 sc1
Mvaa 212,244,24
Ta 220,23,16384
Ta 222,23,17408
Mvaa 244,244,28
s_add_u32 s59, s38, 8192
Mvaa 152,248,16
buffer_store_dwordx4 v[56:59], v2, s[24:27], s59 offen offset:0 sc1
Mvaa 184,248,20
buffer_load_dwordx4 a[108:111], v11, s[20:23], s52 offen offset:0 sc1
Mvaa 216,248,24
Ar 48,128
Ar 49,129
Mvaa 248,248,28
Ar 50,130
Ar 51,131
Mvaa 156,252,16
Ar 52,132
Ar 53,133
Mvaa 188,252,20
Ar 54,134
Ar 55,135
Mvaa 220,252,24
s_waitcnt vmcnt(23) lgkmcnt(0)
Vc 24,48,49
Vc 25,50,51
Mvaa 252,252,28
Vc 26,52,53
Vc 27,54,55
Mvaa 128,192,32
Mvaa 160,192,36
Ta 224,16,24576
Ta 226,16,25600
Mvaa 192,192,40
buffer_load_dwordx4 v9, s[8:11], s50 offen offset:2048 lds
Mvaa 224,192,44
Mvaa 132,196,32
Ta 228,17,24576
Ta 230,17,25600
Mvaa 164,196,36
Mvaa 196,196,40
buffer_load_dwordx4 v9, s[8:11], s51 offen offset:3072 lds
Mvaa 228,196,44
Ta 232,18,24576
Ta 234,18,25600
Mvaa 136,200,32
v_xor_b32 v8, 524288, v8
v_xor_b32 v9, 524288, v9
Mvaa 168,200,36
Mvaa 200,200,40
Ta 236,19,24576
Ta 238,19,25600
Mvaa 232,200,44
buffer_load_dwordx4 a[112:115], v10, s[20:23], s53 offen offset:1024 sc1
Mvaa 140,204,32
Mvaa 172,204,36
Ta 240,20,24576
Ta 242,20,25600
Mvaa 204,204,40
Mvaa 236,204,44
Mvaa 144,208,32
s_waitcnt lgkmcnt(6)
Ta 244,21,24576
Ta 246,21,25600
Mvaa 176,208,36
buffer_load_dwordx4 a[116:119], v10, s[20:23], s52 offen offset:1024 sc1
Mvaa 208,208,40
buffer_store_dwordx4 v[60:63], v2, s[24:27], s59 offen offset:1024 sc1
Mvaa 240,208,44
Ta 248,22,24576
Ta 250,22,25600
Mvaa 148,212,32
Ar 48,136
Ar 49,137
Mvaa 180,212,36
buffer_load_dwordx4 a[120:123], v11, s[20:23], s53 offen offset:1024 sc1
Mvaa 212,212,40
Ta 252,23,24576
Ta 254,23,25600
Mvaa 244,212,44
Ar 50,138
Ar 51,139
Mvaa 152,216,32
Ar 52,140
Ar 53,141
Mvaa 184,216,36
buffer_load_dwordx4 a[124:127], v11, s[20:23], s52 offen offset:1024 sc1
Mvaa 216,216,40
s_xor_b32 s52, s52, 14336
s_add_u32 s53, s52, s58
Mvaa 248,216,44
Ar 54,142
Ar 55,143
Mvaa 156,220,32
Vc 28,48,49
Vc 29,50,51
Mvaa 188,220,36
Vc 30,52,53
Vc 31,54,55
Mvaa 220,220,40
s_waitcnt vmcnt(25) lgkmcnt(0)
Mvaa 252,220,44
s_barrier
Mvaa 128,224,48
Mvaa 160,224,52
s_add_u32 m0, s44, 16384
Ta 192,16,32768
Ta 194,16,33792
Mvaa 192,224,56
buffer_load_dwordx4 v8, s[8:11], s48 offen offset:0 lds
Mvaa 224,224,60
Mvaa 132,228,48
Ta 196,17,32768
Ta 198,17,33792
Mvaa 164,228,52
Mvaa 196,228,56
buffer_load_dwordx4 v8, s[8:11], s49 offen offset:1024 lds
Mvaa 228,228,60
Ta 200,18,32768
Ta 202,18,33792
Mvaa 136,232,48
Mvaa 168,232,52
Mvaa 200,232,56
Ta 204,19,32768
Ta 206,19,33792
Mvaa 232,232,60
buffer_load_dwordx4 a[0:3], v10, s[20:23], s53 offen offset:0 sc1
Mvaa 140,236,48
buffer_store_dwordx4 v[64:67], v2, s[24:27], s59 offen offset:2048 sc1
Mvaa 172,236,52
Ta 208,20,32768
Ta 210,20,33792
Mvaa 204,236,56
Ar 48,144
Ar 49,145
Mvaa 236,236,60
Ar 50,146
Ar 51,147
Mvaa 144,240,48
s_waitcnt lgkmcnt(6)
Ta 212,21,32768
Ta 214,21,33792
Mvaa 176,240,52
buffer_load_dwordx4 a[4:7], v10, s[20:23], s52 offen offset:0 sc1
Mvaa 208,240,56
Ar 52,148
Ar 53,149
Mvaa 240,240,60
Ta 216,22,32768
Ta 218,22,33792
Mvaa 148,244,48
Ar 54,150
Ar 55,151
Mvaa 180,244,52
buffer_load_dwordx4 a[8:11], v11, s[20:23], s53 offen offset:0 sc1
Mvaa 212,244,56
Ta 220,23,32768
Ta 222,23,33792
Mvaa 244,244,60
Vc 32,48,49
Vc 33,50,51
Mvaa 152,248,48
Vc 34,52,53
Vc 35,54,55
Mvaa 184,248,52
buffer_load_dwordx4 a[12:15], v11, s[20:23], s52 offen offset:0 sc1
Mvaa 216,248,56
Mvaa 248,248,60
Mvaa 156,252,48
Mvaa 188,252,52
Mvaa 220,252,56
s_waitcnt vmcnt(26) lgkmcnt(0)
Mvaa 252,252,60
Mvaa 128,192,64
Mvaa 160,192,68
Ta 224,16,40960
Ta 226,16,41984
Mvaa 192,192,72
buffer_load_dwordx4 v9, s[8:11], s50 offen offset:2048 lds
Mvaa 224,192,76
Mvaa 132,196,64
Ta 228,17,40960
Ta 230,17,41984
Mvaa 164,196,68
Mvaa 196,196,72
buffer_load_dwordx4 v9, s[8:11], s51 offen offset:3072 lds
Mvaa 228,196,76
Ta 232,18,40960
Ta 234,18,41984
Mvaa 136,200,64
v_xor_b32 v8, 1572864, v8
v_xor_b32 v9, 1572864, v9
Mvaa 168,200,68
buffer_store_dwordx4 v[68:71], v2, s[24:27], s59 offen offset:3072 sc1
Mvaa 200,200,72
Ta 236,19,40960
Ta 238,19,41984
Mvaa 232,200,76
buffer_load_dwordx4 a[16:19], v10, s[20:23], s53 offen offset:1024 sc1
Mvaa 140,204,64
Ar 48,152
Ar 49,153
Mvaa 172,204,68
Ta 240,20,40960
Ta 242,20,41984
Mvaa 204,204,72
Ar 50,154
Ar 51,155
Mvaa 236,204,76
Ar 52,156
Ar 53,157
Mvaa 144,208,64
s_waitcnt lgkmcnt(6)
Ta 244,21,40960
Ta 246,21,41984
Mvaa 176,208,68
buffer_load_dwordx4 a[20:23], v10, s[20:23], s52 offen offset:1024 sc1
Mvaa 208,208,72
Ar 54,158
Ar 55,159
Mvaa 240,208,76
Ta 248,22,40960
Ta 250,22,41984
Mvaa 148,212,64
Vc 36,48,49
Vc 37,50,51
Mvaa 180,212,68
buffer_load_dwordx4 a[24:27], v11, s[20:23], s53 offen offset:1024 sc1
Mvaa 212,212,72
Ta 252,23,40960
Ta 254,23,41984
Mvaa 244,212,76
Vc 38,52,53
Vc 39,54,55
Mvaa 152,216,64
Mvaa 184,216,68
buffer_load_dwordx4 a[28:31], v11, s[20:23], s52 offen offset:1024 sc1
Mvaa 216,216,72
s_xor_b32 s52, s52, 2048
s_add_u32 s53, s52, s58
Mvaa 248,216,76
Mvaa 156,220,64
Mvaa 188,220,68
Mvaa 220,220,72
s_waitcnt vmcnt(29) lgkmcnt(0)
Mvaa 252,220,76
s_barrier
Mvaa 128,224,80
s_add_u32 s59, s38, 12288
Mvaa 160,224,84
s_add_u32 m0, s44, 32768
Ta 192,16,49152
Ta 194,16,50176
Mvaa 192,224,88
buffer_load_dwordx4 v8, s[8:11], s48 offen offset:0 lds
Mvaa 224,224,92
buffer_store_dwordx4 v[72:75], v2, s[24:27], s59 offen offset:0 sc1
Mvaa 132,228,80
Ta 196,17,49152
Ta 198,17,50176
Mvaa 164,228,84
Ar 48,160
Ar 49,161
Mvaa 196,228,88
buffer_load_dwordx4 v8, s[8:11], s49 offen offset:1024 lds
Mvaa 228,228,92
Ta 200,18,49152
Ta 202,18,50176
Mvaa 136,232,80
Ar 50,162
Ar 51,163
Mvaa 168,232,84
Ar 52,164
Ar 53,165
Mvaa 200,232,88
Ta 204,19,49152
Ta 206,19,50176
Mvaa 232,232,92
buffer_load_dwordx4 a[32:35], v10, s[20:23], s53 offen offset:0 sc1
Mvaa 140,236,80
Ar 54,166
Ar 55,167
Mvaa 172,236,84
Ta 208,20,49152
Ta 210,20,50176
Mvaa 204,236,88
Vc 40,48,49
Vc 41,50,51
Mvaa 236,236,92
Vc 42,52,53
Vc 43,54,55
Mvaa 144,240,80
s_waitcnt lgkmcnt(6)
Ta 212,21,49152
Ta 214,21,50176
Mvaa 176,240,84
buffer_load_dwordx4 a[36:39], v10, s[20:23], s52 offen offset:0 sc1
Mvaa 208,240,88
global_load_dword v13, v[14:15], off
Mvaa 240,240,92
Ta 216,22,49152
Ta 218,22,50176
Mvaa 148,244,80
Mvaa 180,244,84
buffer_load_dwordx4 a[40:43], v11, s[20:23], s53 offen offset:0 sc1
Mvaa 212,244,88
Ta 220,23,49152
Ta 222,23,50176
Mvaa 244,244,92
Mvaa 152,248,80
Mvaa 184,248,84
buffer_load_dwordx4 a[44:47], v11, s[20:23], s52 offen offset:0 sc1
Mvaa 216,248,88
Mvaa 248,248,92
buffer_store_dwordx4 v[76:79], v2, s[24:27], s59 offen offset:1024 sc1
Mvaa 156,252,80
Ar 48,168
Ar 49,169
Mvaa 188,252,84
Ar 50,170
Ar 51,171
Mvaa 220,252,88
s_waitcnt vmcnt(30) lgkmcnt(0)
Ar 52,172
Ar 53,173
Mvaa 252,252,92
Ar 54,174
Ar 55,175
Mvaa 128,192,96
Vc 44,48,49
Vc 45,50,51
Mvaa 160,192,100
Ta 224,16,57344
Ta 226,16,58368
Mvaa 192,192,104
buffer_load_dwordx4 v9, s[8:11], s50 offen offset:2048 lds
Mvaa 224,192,108
Vc 46,52,53
Vc 47,54,55
Mvaa 132,196,96
Ta 228,17,57344
Ta 230,17,58368
Mvaa 164,196,100
s_lshl_b32 s3, s32, 11
s_add_u32 s3, s3, 5242880
Mvaa 196,196,104
buffer_load_dwordx4 v9, s[8:11], s51 offen offset:3072 lds
Mvaa 228,196,108
Ta 232,18,57344
Ta 234,18,58368
Mvaa 136,200,96
v_xor_b32 v8, 524288, v8
v_xor_b32 v9, 524288, v9
Mvaa 168,200,100
buffer_load_dwordx4 v[56:59], v2, s[20:23], s3 offen offset:0 sc1
Mvaa 200,200,104
Ta 236,19,57344
Ta 238,19,58368
Mvaa 232,200,108
buffer_load_dwordx4 a[48:51], v10, s[20:23], s53 offen offset:1024 sc1
Mvaa 140,204,96
buffer_load_dwordx4 v[60:63], v2, s[20:23], s3 offen offset:1024 sc1
Mvaa 172,204,100
Ta 240,20,57344
Ta 242,20,58368
Mvaa 204,204,104
Mvaa 236,204,108
Mvaa 144,208,96
s_waitcnt lgkmcnt(6)
Ta 244,21,57344
Ta 246,21,58368
Mvaa 176,208,100
buffer_load_dwordx4 a[52:55], v10, s[20:23], s52 offen offset:1024 sc1
Mvaa 208,208,104
Mvaa 240,208,108
Ta 248,22,57344
Ta 250,22,58368
Mvaa 148,212,96
Mvaa 180,212,100
buffer_load_dwordx4 a[56:59], v11, s[20:23], s53 offen offset:1024 sc1
Mvaa 212,212,104
Ta 252,23,57344
Ta 254,23,58368
Mvaa 244,212,108
buffer_store_dwordx4 v[80:83], v2, s[24:27], s59 offen offset:2048 sc1
Mvaa 152,216,96
Mvaa 184,216,100
buffer_load_dwordx4 a[60:63], v11, s[20:23], s52 offen offset:1024 sc1
Mvaa 216,216,104
s_xor_b32 s52, s52, 6144
s_add_u32 s53, s52, s58
Mvaa 248,216,108
Mvaa 156,220,96
Mvaa 188,220,100
Mvaa 220,220,104
s_waitcnt vmcnt(32) lgkmcnt(0)
Mvaa 252,220,108
s_barrier
Mvaa 128,224,112
Mvaa 160,224,116
s_add_u32 m0, s44, 49152
Ta 192,16,0
Ta 194,16,1024
Mvaa 192,224,120
buffer_load_dwordx4 v8, s[8:11], s48 offen offset:0 lds
Mvaa 224,224,124
Mvaa 132,228,112
Ta 196,17,0
Ta 198,17,1024
Mvaa 164,228,116
Mvaa 196,228,120
buffer_load_dwordx4 v8, s[8:11], s49 offen offset:1024 lds
Mvaa 228,228,124
Ta 200,18,0
Ta 202,18,1024
Mvaa 136,232,112
Mvaa 168,232,116
Mvaa 200,232,120
Ta 204,19,0
Ta 206,19,1024
Mvaa 232,232,124
buffer_load_dwordx4 a[64:67], v10, s[20:23], s53 offen offset:0 sc1
Mvaa 140,236,112
Mvaa 172,236,116
Ta 208,20,0
Ta 210,20,1024
Mvaa 204,236,120
Mvaa 236,236,124
Mvaa 144,240,112
s_waitcnt lgkmcnt(6)
Ta 212,21,0
Ta 214,21,1024
Mvaa 176,240,116
buffer_load_dwordx4 a[68:71], v10, s[20:23], s52 offen offset:0 sc1
Mvaa 208,240,120
buffer_store_dwordx4 v[84:87], v2, s[24:27], s59 offen offset:3072 sc1
Mvaa 240,240,124
Ta 216,22,0
Ta 218,22,1024
Mvaa 148,244,112
Mvaa 180,244,116
buffer_load_dwordx4 a[72:75], v11, s[20:23], s53 offen offset:0 sc1
Mvaa 212,244,120
Ta 220,23,0
Ta 222,23,1024
Mvaa 244,244,124
Mvaa 152,248,112
Mvaa 184,248,116
buffer_load_dwordx4 a[76:79], v11, s[20:23], s52 offen offset:0 sc1
Mvaa 216,248,120
Mvaa 248,248,124
Mvaa 156,252,112
Mvaa 188,252,116
Mvaa 220,252,120
s_waitcnt vmcnt(32) lgkmcnt(0)
Mvaa 252,252,124
Mvaa 128,192,0
Mvaa 160,192,4
Ta 224,16,8192
Ta 226,16,9216
Mvaa 192,192,8
buffer_load_dwordx4 v9, s[8:11], s50 offen offset:2048 lds
Mvaa 224,192,12
Mvaa 132,196,0
Ta 228,17,8192
Ta 230,17,9216
Mvaa 164,196,4
Mvaa 196,196,8
buffer_load_dwordx4 v9, s[8:11], s51 offen offset:3072 lds
Mvaa 228,196,12
Ta 232,18,8192
Ta 234,18,9216
Mvaa 136,200,0
v_xor_b32 v8, 7864320, v8
v_xor_b32 v9, 7864320, v9
Mvaa 168,200,4
Mvaa 200,200,8
Ta 236,19,8192
Ta 238,19,9216
Mvaa 232,200,12
buffer_load_dwordx4 a[80:83], v10, s[20:23], s53 offen offset:1024 sc1
Mvaa 140,204,0
s_add_u32 s59, s38, 34816
Mvaa 172,204,4
Ta 240,20,8192
Ta 242,20,9216
Mvaa 204,204,8
buffer_store_dwordx4 v[88:91], v2, s[24:27], s59 offen offset:0 sc1
Mvaa 236,204,12
Mvaa 144,208,0
s_waitcnt lgkmcnt(6)
Ta 244,21,8192
Ta 246,21,9216
Mvaa 176,208,4
buffer_load_dwordx4 a[84:87], v10, s[20:23], s52 offen offset:1024 sc1
Mvaa 208,208,8
Mvaa 240,208,12
Ta 248,22,8192
Ta 250,22,9216
Mvaa 148,212,0
Mvaa 180,212,4
buffer_load_dwordx4 a[88:91], v11, s[20:23], s53 offen offset:1024 sc1
Mvaa 212,212,8
Ta 252,23,8192
Ta 254,23,9216
Mvaa 244,212,12
Mvaa 152,216,0
Mvaa 184,216,4
buffer_load_dwordx4 a[92:95], v11, s[20:23], s52 offen offset:1024 sc1
Mvaa 216,216,8
s_xor_b32 s52, s52, 2048
s_add_u32 s53, s52, s58
Mvaa 248,216,12
Mvaa 156,220,0
Mvaa 188,220,4
Mvaa 220,220,8
s_waitcnt vmcnt(32) lgkmcnt(0)
Mvaa 252,220,12
s_barrier
Mvaa 128,224,16
Mvaa 160,224,20
s_add_u32 m0, s44, 0
Ta 192,16,16384
Ta 194,16,17408
Mvaa 192,224,24
buffer_load_dwordx4 v8, s[8:11], s48 offen offset:0 lds
Mvaa 224,224,28
Mvaa 132,228,16
Ta 196,17,16384
Ta 198,17,17408
Mvaa 164,228,20
Mvaa 196,228,24
buffer_load_dwordx4 v8, s[8:11], s49 offen offset:1024 lds
Mvaa 228,228,28
Ta 200,18,16384
Ta 202,18,17408
Mvaa 136,232,16
buffer_store_dwordx4 v[92:95], v2, s[24:27], s59 offen offset:1024 sc1
Mvaa 168,232,20
Mvaa 200,232,24
Ta 204,19,16384
Ta 206,19,17408
Mvaa 232,232,28
buffer_load_dwordx4 a[96:99], v10, s[20:23], s53 offen offset:0 sc1
Mvaa 140,236,16
Mvaa 172,236,20
Ta 208,20,16384
Ta 210,20,17408
Mvaa 204,236,24
Mvaa 236,236,28
Mvaa 144,240,16
s_waitcnt lgkmcnt(6)
Ta 212,21,16384
Ta 214,21,17408
Mvaa 176,240,20
buffer_load_dwordx4 a[100:103], v10, s[20:23], s52 offen offset:0 sc1
Mvaa 208,240,24
Mvaa 240,240,28
Ta 216,22,16384
Ta 218,22,17408
Mvaa 148,244,16
Mvaa 180,244,20
buffer_load_dwordx4 a[104:107], v11, s[20:23], s53 offen offset:0 sc1
Mvaa 212,244,24
Ta 220,23,16384
Ta 222,23,17408
Mvaa 244,244,28
Mvaa 152,248,16
Mvaa 184,248,20
buffer_load_dwordx4 a[108:111], v11, s[20:23], s52 offen offset:0 sc1
Mvaa 216,248,24
Mvaa 248,248,28
Mvaa 156,252,16
Mvaa 188,252,20
Mvaa 220,252,24
s_waitcnt vmcnt(31) lgkmcnt(0)
Mvaa 252,252,28
Mvaa 128,192,32
buffer_store_dwordx4 v[96:99], v2, s[24:27], s59 offen offset:2048 sc1
Mvaa 160,192,36
Ta 224,16,24576
Ta 226,16,25600
Mvaa 192,192,40
buffer_load_dwordx4 v9, s[8:11], s50 offen offset:2048 lds
Mvaa 224,192,44
Mvaa 132,196,32
Ta 228,17,24576
Ta 230,17,25600
Mvaa 164,196,36
Mvaa 196,196,40
buffer_load_dwordx4 v9, s[8:11], s51 offen offset:3072 lds
Mvaa 228,196,44
Ta 232,18,24576
Ta 234,18,25600
Mvaa 136,200,32
v_xor_b32 v8, 524288, v8
v_xor_b32 v9, 524288, v9
Mvaa 168,200,36
Mvaa 200,200,40
Ta 236,19,24576
Ta 238,19,25600
Mvaa 232,200,44
buffer_load_dwordx4 a[112:115], v10, s[20:23], s53 offen offset:1024 sc1
Mvaa 140,204,32
Mvaa 172,204,36
Ta 240,20,24576
Ta 242,20,25600
Mvaa 204,204,40
Mvaa 236,204,44
Mvaa 144,208,32
s_waitcnt lgkmcnt(6)
Ta 244,21,24576
Ta 246,21,25600
Mvaa 176,208,36
buffer_load_dwordx4 a[116:119], v10, s[20:23], s52 offen offset:1024 sc1
Mvaa 208,208,40
Mvaa 240,208,44
Ta 248,22,24576
Ta 250,22,25600
Mvaa 148,212,32
Mvaa 180,212,36
buffer_load_dwordx4 a[120:123], v11, s[20:23], s53 offen offset:1024 sc1
Mvaa 212,212,40
Ta 252,23,24576
Ta 254,23,25600
Mvaa 244,212,44
Mvaa 152,216,32
Mvaa 184,216,36
buffer_load_dwordx4 a[124:127], v11, s[20:23], s52 offen offset:1024 sc1
Mvaa 216,216,40
s_xor_b32 s52, s52, 30720
s_add_u32 s53, s52, s58
Mvaa 248,216,44
buffer_store_dwordx4 v[100:103], v2, s[24:27], s59 offen offset:3072 sc1
Mvaa 156,220,32
Mvaa 188,220,36
Mvaa 220,220,40
s_waitcnt vmcnt(29) lgkmcnt(0)
Mvaa 252,220,44
s_barrier
Mvaa 128,224,48
Mvaa 160,224,52
s_add_u32 m0, s44, 16384
Ta 192,16,32768
Ta 194,16,33792
Mvaa 192,224,56
buffer_load_dwordx4 v8, s[8:11], s48 offen offset:0 lds
Mvaa 224,224,60
Mvaa 132,228,48
Ta 196,17,32768
Ta 198,17,33792
Mvaa 164,228,52
Mvaa 196,228,56
buffer_load_dwordx4 v8, s[8:11], s49 offen offset:1024 lds
Mvaa 228,228,60
Ta 200,18,32768
Ta 202,18,33792
Mvaa 136,232,48
Mvaa 168,232,52
Mvaa 200,232,56
Ta 204,19,32768
Ta 206,19,33792
Mvaa 232,232,60
buffer_load_dwordx4 a[0:3], v10, s[20:23], s53 offen offset:0 sc1
Mvaa 140,236,48
Mvaa 172,236,52
Ta 208,20,32768
Ta 210,20,33792
Mvaa 204,236,56
Mvaa 236,236,60
Mvaa 144,240,48
s_waitcnt lgkmcnt(6)
Ta 212,21,32768
Ta 214,21,33792
Mvaa 176,240,52
buffer_load_dwordx4 a[4:7], v10, s[20:23], s52 offen offset:0 sc1
Mvaa 208,240,56
Mvaa 240,240,60
Ta 216,22,32768
Ta 218,22,33792
Mvaa 148,244,48
Mvaa 180,244,52
buffer_load_dwordx4 a[8:11], v11, s[20:23], s53 offen offset:0 sc1
Mvaa 212,244,56
Ta 220,23,32768
Ta 222,23,33792
Mvaa 244,244,60
s_add_u32 s59, s38, 38912
Mvaa 152,248,48
buffer_store_dwordx4 v[104:107], v2, s[24:27], s59 offen offset:0 sc1
Mvaa 184,248,52
buffer_load_dwordx4 a[12:15], v11, s[20:23], s52 offen offset:0 sc1
Mvaa 216,248,56
Mvaa 248,248,60
Mvaa 156,252,48
Mvaa 188,252,52
Mvaa 220,252,56
s_waitcnt vmcnt(29) lgkmcnt(0)
Mvaa 252,252,60
Mvaa 128,192,64
v_max_u32 v14, v56, v57
v_min_u32_e64 v15, v56, v57
Mvaa 160,192,68
Ta 224,16,40960
Ta 226,16,41984
Mvaa 192,192,72
buffer_load_dwordx4 v9, s[8:11], s50 offen offset:2048 lds
Mvaa 224,192,76
v_med3_u32 v15, v14, v15, v58
v_max_u32_e64 v14, v14, v58
Mvaa 132,196,64
Ta 228,17,40960
Ta 230,17,41984
Mvaa 164,196,68
v_med3_u32 v15, v14, v15, v59
v_max_u32_e64 v14, v14, v59
Mvaa 196,196,72
buffer_load_dwordx4 v9, s[8:11], s51 offen offset:3072 lds
Mvaa 228,196,76
Ta 232,18,40960
Ta 234,18,41984
Mvaa 136,200,64
v_xor_b32 v8, 1572864, v8
v_xor_b32 v9, 1572864, v9
Mvaa 168,200,68
v_med3_u32 v15, v14, v15, v60
v_max_u32_e64 v14, v14, v60
Mvaa 200,200,72
Ta 236,19,40960
Ta 238,19,41984
Mvaa 232,200,76
buffer_load_dwordx4 a[16:19], v10, s[20:23], s53 offen offset:1024 sc1
Mvaa 140,204,64
v_med3_u32 v15, v14, v15, v61
v_max_u32_e64 v14, v14, v61
Mvaa 172,204,68
Ta 240,20,40960
Ta 242,20,41984
Mvaa 204,204,72
v_med3_u32 v15, v14, v15, v62
v_max_u32_e64 v14, v14, v62
Mvaa 236,204,76
v_med3_u32 v15, v14, v15, v63
v_max_u32_e64 v14, v14, v63
Mvaa 144,208,64
s_waitcnt lgkmcnt(6)
Ta 244,21,40960
Ta 246,21,41984
Mvaa 176,208,68
buffer_load_dwordx4 a[20:23], v10, s[20:23], s52 offen offset:1024 sc1
Mvaa 208,208,72
buffer_store_dwordx4 v[108:111], v2, s[24:27], s59 offen offset:1024 sc1
Mvaa 240,208,76
Ta 248,22,40960
Ta 250,22,41984
Mvaa 148,212,64
s_lshl_b32 s3, s32, 9
s_add_u32 s3, s3, 131072
v_lshlrev_b32_e64 v13, 3, v0
Mvaa 180,212,68
buffer_load_dwordx4 a[24:27], v11, s[20:23], s53 offen offset:1024 sc1
Mvaa 212,212,72
Ta 252,23,40960
Ta 254,23,41984
Mvaa 244,212,76
v_add_u32_e64 v56, s3, v13
v_add_u32 v13, 131072, v13
Mvaa 152,216,64
ds_write_b64 v56, v[14:15]
Mvaa 184,216,68
buffer_load_dwordx4 a[28:31], v11, s[20:23], s52 offen offset:1024 sc1
Mvaa 216,216,72
s_xor_b32 s52, s52, 2048
s_add_u32 s53, s52, s58
Mvaa 248,216,76
Mvaa 156,220,64
Mvaa 188,220,68
Mvaa 220,220,72
s_waitcnt vmcnt(29) lgkmcnt(0)
Mvaa 252,220,76
s_barrier
Mvaa 128,224,80
Mvaa 160,224,84
s_add_u32 m0, s44, 32768
Ta 192,16,49152
Ta 194,16,50176
Mvaa 192,224,88
buffer_load_dwordx4 v8, s[8:11], s48 offen offset:0 lds
Mvaa 224,224,92
Mvaa 132,228,80
Ta 196,17,49152
Ta 198,17,50176
Mvaa 164,228,84
Mvaa 196,228,88
buffer_load_dwordx4 v8, s[8:11], s49 offen offset:1024 lds
Mvaa 228,228,92
Ta 200,18,49152
Ta 202,18,50176
Mvaa 136,232,80
Mvaa 168,232,84
Mvaa 200,232,88
Ta 204,19,49152
Ta 206,19,50176
Mvaa 232,232,92
buffer_load_dwordx4 a[32:35], v10, s[20:23], s53 offen offset:0 sc1
Mvaa 140,236,80
buffer_store_dwordx4 v[112:115], v2, s[24:27], s59 offen offset:2048 sc1
Mvaa 172,236,84
Ta 208,20,49152
Ta 210,20,50176
Mvaa 204,236,88
Mvaa 236,236,92
Mvaa 144,240,80
s_waitcnt lgkmcnt(6)
Ta 212,21,49152
Ta 214,21,50176
Mvaa 176,240,84
buffer_load_dwordx4 a[36:39], v10, s[20:23], s52 offen offset:0 sc1
Mvaa 208,240,88
Mvaa 240,240,92
Ta 216,22,49152
Ta 218,22,50176
Mvaa 148,244,80
Mvaa 180,244,84
buffer_load_dwordx4 a[40:43], v11, s[20:23], s53 offen offset:0 sc1
Mvaa 212,244,88
Ta 220,23,49152
Ta 222,23,50176
Mvaa 244,244,92
Mvaa 152,248,80
Mvaa 184,248,84
buffer_load_dwordx4 a[44:47], v11, s[20:23], s52 offen offset:0 sc1
Mvaa 216,248,88
Mvaa 248,248,92
Mvaa 156,252,80
Mvaa 188,252,84
Mvaa 220,252,88
s_waitcnt vmcnt(29) lgkmcnt(0)
Mvaa 252,252,92
Mvaa 128,192,96
Mvaa 160,192,100
Ta 224,16,57344
Ta 226,16,58368
Mvaa 192,192,104
buffer_load_dwordx4 v9, s[8:11], s50 offen offset:2048 lds
Mvaa 224,192,108
Mvaa 132,196,96
Ta 228,17,57344
Ta 230,17,58368
Mvaa 164,196,100
Mvaa 196,196,104
buffer_load_dwordx4 v9, s[8:11], s51 offen offset:3072 lds
Mvaa 228,196,108
Ta 232,18,57344
Ta 234,18,58368
Mvaa 136,200,96
v_xor_b32 v8, 524288, v8
v_xor_b32 v9, 524288, v9
Mvaa 168,200,100
buffer_store_dwordx4 v[116:119], v2, s[24:27], s59 offen offset:3072 sc1
Mvaa 200,200,104
Ta 236,19,57344
Ta 238,19,58368
Mvaa 232,200,108
buffer_load_dwordx4 a[48:51], v10, s[20:23], s53 offen offset:1024 sc1
Mvaa 140,204,96
Mvaa 172,204,100
Ta 240,20,57344
Ta 242,20,58368
Mvaa 204,204,104
Mvaa 236,204,108
Mvaa 144,208,96
s_waitcnt lgkmcnt(6)
Ta 244,21,57344
Ta 246,21,58368
Mvaa 176,208,100
buffer_load_dwordx4 a[52:55], v10, s[20:23], s52 offen offset:1024 sc1
Mvaa 208,208,104
Mvaa 240,208,108
Ta 248,22,57344
Ta 250,22,58368
Mvaa 148,212,96
Mvaa 180,212,100
buffer_load_dwordx4 a[56:59], v11, s[20:23], s53 offen offset:1024 sc1
Mvaa 212,212,104
Ta 252,23,57344
Ta 254,23,58368
Mvaa 244,212,108
Mvaa 152,216,96
Mvaa 184,216,100
buffer_load_dwordx4 a[60:63], v11, s[20:23], s52 offen offset:1024 sc1
Mvaa 216,216,104
s_xor_b32 s52, s52, 6144
s_add_u32 s53, s52, s58
Mvaa 248,216,108
Mvaa 156,220,96
Mvaa 188,220,100
Mvaa 220,220,104
s_waitcnt vmcnt(29) lgkmcnt(0)
Mvaa 252,220,108
s_barrier
Mvaa 128,224,112
s_add_u32 s59, s38, 43008
Mvaa 160,224,116
s_add_u32 m0, s44, 49152
Ta 192,16,0
Ta 194,16,1024
Mvaa 192,224,120
buffer_load_dwordx4 v8, s[8:11], s48 offen offset:0 lds
Mvaa 224,224,124
buffer_store_dwordx4 v[120:123], v2, s[24:27], s59 offen offset:0 sc1
Mvaa 132,228,112
Ta 196,17,0
Ta 198,17,1024
Mvaa 164,228,116
ds_read_b64 v[56:57], v13 offset:0
ds_read_b64 v[58:59], v13 offset:512
Mvaa 196,228,120
buffer_load_dwordx4 v8, s[8:11], s49 offen offset:1024 lds
Mvaa 228,228,124
Ta 200,18,0
Ta 202,18,1024
Mvaa 136,232,112
ds_read_b64 v[60:61], v13 offset:1024
ds_read_b64 v[62:63], v13 offset:1536
Mvaa 168,232,116
Mvaa 200,232,120
Ta 204,19,0
Ta 206,19,1024
Mvaa 232,232,124
buffer_load_dwordx4 a[64:67], v10, s[20:23], s53 offen offset:0 sc1
Mvaa 140,236,112
s_waitcnt lgkmcnt(2)
v_max_u32 v14, v56, v57
v_min_u32 v15, v56, v57
Mvaa 172,236,116
Ta 208,20,0
Ta 210,20,1024
Mvaa 204,236,120
v_med3_u32 v15, v14, v15, v58
v_max_u32_e64 v14, v14, v58
Mvaa 236,236,124
v_med3_u32 v15, v14, v15, v59
v_max_u32_e64 v14, v14, v59
Mvaa 144,240,112
s_waitcnt lgkmcnt(6)
Ta 212,21,0
Ta 214,21,1024
Mvaa 176,240,116
buffer_load_dwordx4 a[68:71], v10, s[20:23], s52 offen offset:0 sc1
Mvaa 208,240,120
v_med3_u32 v15, v14, v15, v60
v_max_u32 v14, v14, v60
Mvaa 240,240,124
Ta 216,22,0
Ta 218,22,1024
Mvaa 148,244,112
v_med3_u32 v15, v14, v15, v61
v_max_u32_e64 v14, v14, v61
Mvaa 180,244,116
buffer_load_dwordx4 a[72:75], v11, s[20:23], s53 offen offset:0 sc1
Mvaa 212,244,120
Ta 220,23,0
Ta 222,23,1024
Mvaa 244,244,124
v_med3_u32 v15, v14, v15, v62
v_max_u32_e64 v14, v14, v62
Mvaa 152,248,112
v_med3_u32 v15, v14, v15, v63
v_max_u32_e64 v14, v14, v63
Mvaa 184,248,116
buffer_load_dwordx4 a[76:79], v11, s[20:23], s52 offen offset:0 sc1
Mvaa 216,248,120
v_mov_b32_e64 v13, v14
Mvaa 248,248,124
buffer_store_dwordx4 v[124:127], v2, s[24:27], s59 offen offset:1024 sc1
Mvaa 156,252,112
v_max_u32_dpp v13, v13, v13 quad_perm:[1,0,3,2] row_mask:0xf bank_mask:0xf
Mvaa 188,252,116
Mvaa 220,252,120
s_waitcnt vmcnt(29) lgkmcnt(0)
Mvaa 252,252,124
Mvaa 128,192,0
v_max_u32_dpp v13, v13, v13 quad_perm:[2,3,0,1] row_mask:0xf bank_mask:0xf
Mvaa 160,192,4
Ta 224,16,8192
Ta 226,16,9216
Mvaa 192,192,8
buffer_load_dwordx4 v9, s[8:11], s50 offen offset:2048 lds
Mvaa 224,192,12
v_max_u32_dpp v13, v13, v13 row_half_mirror row_mask:0xf bank_mask:0xf
Mvaa 132,196,0
Ta 228,17,8192
Ta 230,17,9216
Mvaa 164,196,4
v_max_u32_dpp v13, v13, v13 row_mirror row_mask:0xf bank_mask:0xf
Mvaa 196,196,8
buffer_load_dwordx4 v9, s[8:11], s51 offen offset:3072 lds
Mvaa 228,196,12
Ta 232,18,8192
Ta 234,18,9216
Mvaa 136,200,0
v_xor_b32 v8, 3670016, v8
v_xor_b32 v9, 3670016, v9
Mvaa 168,200,4
v_readlane_b32 s3, v13, 0
v_readlane_b32 s47, v13, 16
Mvaa 200,200,8
Ta 236,19,8192
Ta 238,19,9216
Mvaa 232,200,12
buffer_load_dwordx4 a[80:83], v10, s[20:23], s53 offen offset:1024 sc1
Mvaa 140,204,0
v_readlane_b32 s4, v13, 32
v_readlane_b32 s5, v13, 48
Mvaa 172,204,4
Ta 240,20,8192
Ta 242,20,9216
Mvaa 204,204,8
s_max_u32 s3, s3, s47
s_max_u32 s4, s4, s5
s_max_u32 s40, s3, s4
Mvaa 236,204,12
v_cmp_eq_u32 vcc, s40, v14
Mvaa 144,208,0
s_waitcnt lgkmcnt(6)
Ta 244,21,8192
Ta 246,21,9216
Mvaa 176,208,4
buffer_load_dwordx4 a[84:87], v10, s[20:23], s52 offen offset:1024 sc1
Mvaa 208,208,8
v_cndmask_b32 v13, v14, v15, vcc
Mvaa 240,208,12
Ta 248,22,8192
Ta 250,22,9216
Mvaa 148,212,0
v_max_u32_dpp v13, v13, v13 quad_perm:[1,0,3,2] row_mask:0xf bank_mask:0xf
Mvaa 180,212,4
buffer_load_dwordx4 a[88:91], v11, s[20:23], s53 offen offset:1024 sc1
Mvaa 212,212,8
Ta 252,23,8192
Ta 254,23,9216
Mvaa 244,212,12
buffer_store_dwordx4 v[24:27], v2, s[24:27], s59 offen offset:2048 sc1
Mvaa 152,216,0
v_max_u32_dpp v13, v13, v13 quad_perm:[2,3,0,1] row_mask:0xf bank_mask:0xf
Mvaa 184,216,4
buffer_load_dwordx4 a[92:95], v11, s[20:23], s52 offen offset:1024 sc1
Mvaa 216,216,8
s_xor_b32 s52, s52, 2048
s_add_u32 s53, s52, s58
Mvaa 248,216,12
v_max_u32_dpp v13, v13, v13 row_half_mirror row_mask:0xf bank_mask:0xf
Mvaa 156,220,0
s_nop 0
v_max_u32_dpp v13, v13, v13 row_mirror row_mask:0xf bank_mask:0xf
Mvaa 188,220,4
Mvaa 220,220,8
s_waitcnt vmcnt(29) lgkmcnt(0)
Mvaa 252,220,12
s_barrier
Mvaa 128,224,16
v_readlane_b32 s3, v13, 0
v_readlane_b32 s47, v13, 16
Mvaa 160,224,20
s_add_u32 m0, s44, 0
Ta 192,16,16384
Ta 194,16,17408
Mvaa 192,224,24
buffer_load_dwordx4 v8, s[8:11], s48 offen offset:0 lds
Mvaa 224,224,28
v_readlane_b32 s4, v13, 32
v_readlane_b32 s5, v13, 48
Mvaa 132,228,16
Ta 196,17,16384
Ta 198,17,17408
Mvaa 164,228,20
s_max_u32 s3, s3, s47
s_max_u32 s4, s4, s5
s_max_u32 s41, s3, s4
Mvaa 196,228,24
buffer_load_dwordx4 v8, s[8:11], s49 offen offset:1024 lds
Mvaa 228,228,28
Ta 200,18,16384
Ta 202,18,17408
Mvaa 136,232,16
s_and_b32 s3, s40, 0xffff
s_sub_u32 s42, 0xffff, s3
s_and_b32 s3, s41, 0xffff
Mvaa 168,232,20
s_sub_u32 s43, 0xffff, s3
v_mov_b32 v60, s40
v_not_b32_e64 v61, v60
Mvaa 200,232,24
Ta 204,19,16384
Ta 206,19,17408
Mvaa 232,232,28
buffer_load_dwordx4 a[96:99], v10, s[20:23], s53 offen offset:0 sc1
Mvaa 140,236,16
v_ashrrev_i32_e64 v61, 31, v61
v_or_b32 v61, 0x80000000, v61
Mvaa 172,236,20
Ta 208,20,16384
Ta 210,20,17408
Mvaa 204,236,24
v_xor_b32_e64 v60, v60, v61
v_and_b32 v60, 0xffff0000, v60
Mvaa 236,236,28
v_mul_f32 v60, 0xbfb8aa3b, v60
Mvaa 144,240,16
s_waitcnt lgkmcnt(6)
Ta 212,21,16384
Ta 214,21,17408
Mvaa 176,240,20
buffer_load_dwordx4 a[100:103], v10, s[20:23], s52 offen offset:0 sc1
Mvaa 208,240,24
buffer_store_dwordx4 v[28:31], v2, s[24:27], s59 offen offset:3072 sc1
Mvaa 240,240,28
Ta 216,22,16384
Ta 218,22,17408
Mvaa 148,244,16
Ve 60,60
Mvaa 180,244,20
buffer_load_dwordx4 a[104:107], v11, s[20:23], s53 offen offset:0 sc1
Mvaa 212,244,24
Ta 220,23,16384
Ta 222,23,17408
Mvaa 244,244,28
v_add_f32_e64 v60, 1.0, v60
Mvaa 152,248,16
v_rcp_f32_e64 v60, v60
Mvaa 184,248,20
buffer_load_dwordx4 a[108:111], v11, s[20:23], s52 offen offset:0 sc1
Mvaa 216,248,24
Vc 60,60,60
v_and_b32 v64, 0xffff0000, v60
Mvaa 248,248,28
v_mov_b32 v60, s41
v_not_b32 v61, v60
Mvaa 156,252,16
v_ashrrev_i32_e64 v61, 31, v61
v_or_b32 v61, 0x80000000, v61
Mvaa 188,252,20
v_xor_b32_e64 v60, v60, v61
v_and_b32 v60, 0xffff0000, v60
Mvaa 220,252,24
s_waitcnt vmcnt(29) lgkmcnt(0)
v_mul_f32 v60, 0xbfb8aa3b, v60
Mvaa 252,252,28
Ve 60,60
Mvaa 128,192,32
v_add_f32_e64 v60, 1.0, v60
Mvaa 160,192,36
Ta 224,16,24576
Ta 226,16,25600
Mvaa 192,192,40
buffer_load_dwordx4 v9, s[8:11], s50 offen offset:2048 lds
Mvaa 224,192,44
v_rcp_f32_e64 v60, v60
Mvaa 132,196,32
Ta 228,17,24576
Ta 230,17,25600
Mvaa 164,196,36
Vc 60,60,60
v_and_b32 v65, 0xffff0000, v60
Mvaa 196,196,40
buffer_load_dwordx4 v9, s[8:11], s51 offen offset:3072 lds
Mvaa 228,196,44
Ta 232,18,24576
Ta 234,18,25600
Mvaa 136,200,32
v_xor_b32 v8, 524288, v8
v_xor_b32 v9, 524288, v9
Mvaa 168,200,36
v_mov_b32 v48, 0
v_mov_b32 v49, 0
Mvaa 200,200,40
Ta 236,19,24576
Ta 238,19,25600
Mvaa 232,200,44
buffer_load_dwordx4 a[112:115], v10, s[20:23], s53 offen offset:1024 sc1
Mvaa 140,204,32
s_add_u32 s59, s38, 47104
Mvaa 172,204,36
Ta 240,20,24576
Ta 242,20,25600
Mvaa 204,204,40
buffer_store_dwordx4 v[32:35], v2, s[24:27], s59 offen offset:0 sc1
Mvaa 236,204,44
v_mov_b32 v50, 0
v_mov_b32 v51, 0
Mvaa 144,208,32
s_waitcnt lgkmcnt(6)
Ta 244,21,24576
Ta 246,21,25600
Mvaa 176,208,36
buffer_load_dwordx4 a[116:119], v10, s[20:23], s52 offen offset:1024 sc1
Mvaa 208,208,40
v_mov_b32 v52, 0
v_mov_b32_e64 v53, 0
Mvaa 240,208,44
Ta 248,22,24576
Ta 250,22,25600
Mvaa 148,212,32
v_mov_b32 v54, 0
v_mov_b32 v55, 0
Mvaa 180,212,36
buffer_load_dwordx4 a[120:123], v11, s[20:23], s53 offen offset:1024 sc1
Mvaa 212,212,40
Ta 252,23,24576
Ta 254,23,25600
Mvaa 244,212,44
v_mov_b32 v56, 0
v_mov_b32 v57, 0
Mvaa 152,216,32
v_mov_b32 v58, 0
v_mov_b32 v59, 0
Mvaa 184,216,36
buffer_load_dwordx4 a[124:127], v11, s[20:23], s52 offen offset:1024 sc1
Mvaa 216,216,40
s_xor_b32 s52, s52, 14336
s_add_u32 s53, s52, s58
Mvaa 248,216,44
v_mov_b32 v60, 0
v_mov_b32_e64 v61, 0
Mvaa 156,220,32
v_mov_b32 v62, 0
v_mov_b32 v63, 0
Mvaa 188,220,36
Mvaa 220,220,40
s_waitcnt vmcnt(29) lgkmcnt(0)
Mvaa 252,220,44
s_barrier
Mvaa 128,224,48
s_mul_i32 s3, s34, s34
s_mul_i32 s47, s33, 48
s_add_u32 s3, s3, s47
Mvaa 160,224,52
s_add_u32 m0, s44, 16384
Ta 192,16,32768
Ta 194,16,33792
Mvaa 192,224,56
buffer_load_dwordx4 v8, s[8:11], s48 offen offset:0 lds
Mvaa 224,224,60
s_lshl_b32 s3, s3, 2
s_add_u32 s3, s3, s32
s_lshl_b32 s3, s3, 7
Mvaa 132,228,48
Ta 196,17,32768
Ta 198,17,33792
Mvaa 164,228,52
s_sub_u32 s3, s3, 8704
s_cmp_ge_u32 s34, 4
s_cselect_b32 s3, s3, 0
s_cselect_b32 s40, 512, 0
s_cselect_b32 s47, 786432, 0
Mvaa 196,228,56
buffer_load_dwordx4 v8, s[8:11], s49 offen offset:1024 lds
Mvaa 228,228,60
Ta 200,18,32768
Ta 202,18,33792
Mvaa 136,232,48
buffer_store_dwordx4 v[36:39], v2, s[24:27], s59 offen offset:1024 sc1
Mvaa 168,232,52
v_subrev_u32_e64 v31, 0, v0
v_mul_lo_u32 v31, v31, s47
Mvaa 200,232,56
Ta 204,19,32768
Ta 206,19,33792
Mvaa 232,232,60
buffer_load_dwordx4 a[0:3], v10, s[20:23], s53 offen offset:0 sc1
Mvaa 140,236,48
v_min_u32 v31, 6553600, v31
v_mov_b32_e64 v28, s94
Mvaa 172,236,52
Ta 208,20,32768
Ta 210,20,33792
Mvaa 204,236,56
v_mov_b32 v29, s95
v_mov_b32 v30, v31
Mvaa 236,236,60
v_subrev_u32_e64 v31, 10, v0
v_mul_lo_u32 v31, v31, s47
Mvaa 144,240,48
s_waitcnt lgkmcnt(6)
Ta 212,21,32768
Ta 214,21,33792
Mvaa 176,240,52
buffer_load_dwordx4 a[4:7], v10, s[20:23], s52 offen offset:0 sc1
Mvaa 208,240,56
v_min_u32 v31, 6553600, v31
v_mov_b32 v14, s68
Mvaa 240,240,60
Ta 216,22,32768
Ta 218,22,33792
Mvaa 148,244,48
v_mov_b32_e64 v15, s69
Mvaa 180,244,52
buffer_load_dwordx4 a[8:11], v11, s[20:23], s53 offen offset:0 sc1
Mvaa 212,244,56
Ta 220,23,32768
Ta 222,23,33792
Mvaa 244,244,60
v_cmp_le_u32 vcc, 10, v0
Mvaa 152,248,48
s_nop 0
v_cndmask_b32 v28, v28, v14, vcc
v_cndmask_b32 v29, v29, v15, vcc
Mvaa 184,248,52
buffer_load_dwordx4 a[12:15], v11, s[20:23], s52 offen offset:0 sc1
Mvaa 216,248,56
v_cndmask_b32 v30, v30, v31, vcc
Mvaa 248,248,60
v_subrev_u32 v31, 20, v0
v_mul_lo_u32 v31, v31, s47
Mvaa 156,252,48
v_min_u32 v31, 7602176, v31
v_mov_b32_e64 v14, s92
Mvaa 188,252,52
v_mov_b32_e64 v15, s93
Mvaa 220,252,56
s_waitcnt vmcnt(29) lgkmcnt(0)
Mvaa 252,252,60
Mvaa 128,192,64
buffer_store_dwordx4 v[40:43], v2, s[24:27], s59 offen offset:2048 sc1
Mvaa 160,192,68
Ta 224,16,40960
Ta 226,16,41984
Mvaa 192,192,72
buffer_load_dwordx4 v9, s[8:11], s50 offen offset:2048 lds
Mvaa 224,192,76
v_cmp_le_u32 vcc, 20, v0
Mvaa 132,196,64
Ta 228,17,40960
Ta 230,17,41984
Mvaa 164,196,68
v_cndmask_b32 v28, v28, v14, vcc
v_cndmask_b32 v29, v29, v15, vcc
Mvaa 196,196,72
buffer_load_dwordx4 v9, s[8:11], s51 offen offset:3072 lds
Mvaa 228,196,76
Ta 232,18,40960
Ta 234,18,41984
Mvaa 136,200,64
v_xor_b32 v8, 1572864, v8
v_xor_b32 v9, 1572864, v9
Mvaa 168,200,68
v_cndmask_b32 v30, v30, v31, vcc
Mvaa 200,200,72
Ta 236,19,40960
Ta 238,19,41984
Mvaa 232,200,76
buffer_load_dwordx4 a[16:19], v10, s[20:23], s53 offen offset:1024 sc1
Mvaa 140,204,64
v_add_u32 v30, s3, v30
v_ashrrev_i32_e64 v31, 31, v30
Mvaa 172,204,68
Ta 240,20,40960
Ta 242,20,41984
Mvaa 204,204,72
v_lshl_add_u64 v[28:29], v[30:31], 0, v[28:29]
Mvaa 236,204,76
s_mov_b32 s41, 0
v_readfirstlane_b32 s100, v64
v_readfirstlane_b32 s101, v65
Mvaa 144,208,64
s_waitcnt lgkmcnt(6)
Ta 244,21,40960
Ta 246,21,41984
Mvaa 176,208,68
buffer_load_dwordx4 a[20:23], v10, s[20:23], s52 offen offset:1024 sc1
Mvaa 208,208,72
Mvaa 240,208,76
Ta 248,22,40960
Ta 250,22,41984
Mvaa 148,212,64
Mvaa 180,212,68
buffer_load_dwordx4 a[24:27], v11, s[20:23], s53 offen offset:1024 sc1
Mvaa 212,212,72
Ta 252,23,40960
Ta 254,23,41984
Mvaa 244,212,76
Mvaa 152,216,64
Mvaa 184,216,68
buffer_load_dwordx4 a[28:31], v11, s[20:23], s52 offen offset:1024 sc1
Mvaa 216,216,72
s_xor_b32 s52, s52, 2048
s_add_u32 s53, s52, s58
Mvaa 248,216,76
buffer_store_dwordx4 v[44:47], v2, s[24:27], s59 offen offset:3072 sc1
Mvaa 156,220,64
v_mov_b32 v12, 1
v_and_b32_e64 v1, 15, v0
Mvaa 188,220,68
v_lshlrev_b32_e64 v1, 2, v1
Mvaa 220,220,72
s_waitcnt vmcnt(29) lgkmcnt(0)
Mvaa 252,220,76
s_barrier
Mvaa 128,224,80
s_lshr_b32 s6, s33, 1
s_lshl_b32 s6, s6, 7
s_add_u32 s6, s6, 5296128
Mvaa 160,224,84
s_add_u32 m0, s44, 32768
Ta 192,16,49152
Ta 194,16,50176
Mvaa 192,224,88
buffer_load_dwordx4 v8, s[8:11], s48 offen offset:0 lds
Mvaa 224,224,92
s_cmp_eq_u32 s32, 0
s_cselect_b32 s6, s6, 2146435072
Mvaa 132,228,80
Ta 196,17,49152
Ta 198,17,50176
Mvaa 164,228,84
Mvaa 196,228,88
buffer_load_dwordx4 v8, s[8:11], s49 offen offset:1024 lds
Mvaa 228,228,92
Ta 200,18,49152
Ta 202,18,50176
Mvaa 136,232,80
Mvaa 168,232,84
Mvaa 200,232,88
Ta 204,19,49152
Ta 206,19,50176
Mvaa 232,232,92
buffer_load_dwordx4 a[32:35], v10, s[20:23], s53 offen offset:0 sc1
Mvaa 140,236,80
Mvaa 172,236,84
Ta 208,20,49152
Ta 210,20,50176
Mvaa 204,236,88
Mvaa 236,236,92
Mvaa 144,240,80
s_waitcnt lgkmcnt(6)
Ta 212,21,49152
Ta 214,21,50176
Mvaa 176,240,84
buffer_load_dwordx4 a[36:39], v10, s[20:23], s52 offen offset:0 sc1
Mvaa 208,240,88
Mvaa 240,240,92
Ta 216,22,49152
Ta 218,22,50176
Mvaa 148,244,80
Mvaa 180,244,84
buffer_load_dwordx4 a[40:43], v11, s[20:23], s53 offen offset:0 sc1
Mvaa 212,244,88
Ta 220,23,49152
Ta 222,23,50176
Mvaa 244,244,92
Mvaa 152,248,80
Mvaa 184,248,84
buffer_load_dwordx4 a[44:47], v11, s[20:23], s52 offen offset:0 sc1
Mvaa 216,248,88
Mvaa 248,248,92
Mvaa 156,252,80
Mvaa 188,252,84
Mvaa 220,252,88
s_waitcnt vmcnt(28) lgkmcnt(0)
Mvaa 252,252,92
Mvaa 128,192,96
Mvaa 160,192,100
Ta 224,16,57344
Ta 226,16,58368
Mvaa 192,192,104
buffer_load_dwordx4 v9, s[8:11], s50 offen offset:2048 lds
Mvaa 224,192,108
Mvaa 132,196,96
Ta 228,17,57344
Ta 230,17,58368
Mvaa 164,196,100
Mvaa 196,196,104
buffer_load_dwordx4 v9, s[8:11], s51 offen offset:3072 lds
Mvaa 228,196,108
Ta 232,18,57344
Ta 234,18,58368
Mvaa 136,200,96
v_xor_b32 v8, 524288, v8
v_xor_b32 v9, 524288, v9
Mvaa 168,200,100
Mvaa 200,200,104
Ta 236,19,57344
Ta 238,19,58368
Mvaa 232,200,108
buffer_load_dwordx4 a[48:51], v10, s[20:23], s53 offen offset:1024 sc1
Mvaa 140,204,96
Mvaa 172,204,100
Ta 240,20,57344
Ta 242,20,58368
Mvaa 204,204,104
Mvaa 236,204,108
Mvaa 144,208,96
s_waitcnt lgkmcnt(6)
Ta 244,21,57344
Ta 246,21,58368
Mvaa 176,208,100
buffer_load_dwordx4 a[52:55], v10, s[20:23], s52 offen offset:1024 sc1
Mvaa 208,208,104
Mvaa 240,208,108
Ta 248,22,57344
Ta 250,22,58368
Mvaa 148,212,96
Mvaa 180,212,100
buffer_load_dwordx4 a[56:59], v11, s[20:23], s53 offen offset:1024 sc1
Mvaa 212,212,104
Ta 252,23,57344
Ta 254,23,58368
Mvaa 244,212,108
Mvaa 152,216,96
Mvaa 184,216,100
buffer_load_dwordx4 a[60:63], v11, s[20:23], s52 offen offset:1024 sc1
Mvaa 216,216,104
s_xor_b32 s52, s52, 6144
s_add_u32 s53, s52, s58
Mvaa 248,216,108
Mvaa 156,220,96
Mvaa 188,220,100
Mvaa 220,220,104
s_waitcnt vmcnt(27) lgkmcnt(0)
Mvaa 252,220,108
s_barrier
Mvaa 128,224,112
Mvaa 160,224,116
s_add_u32 m0, s44, 49152
Ta 192,16,0
Ta 194,16,1024
Mvaa 192,224,120
buffer_load_dwordx4 v8, s[8:11], s48 offen offset:0 lds
Mvaa 224,224,124
Mvaa 132,228,112
Ta 196,17,0
Ta 198,17,1024
Mvaa 164,228,116
Mvaa 196,228,120
buffer_load_dwordx4 v8, s[8:11], s49 offen offset:1024 lds
Mvaa 228,228,124
Ta 200,18,0
Ta 202,18,1024
Mvaa 136,232,112
Mvaa 168,232,116
Mvaa 200,232,120
Ta 204,19,0
Ta 206,19,1024
Mvaa 232,232,124
buffer_load_dwordx4 a[64:67], v10, s[20:23], s53 offen offset:0 sc1
Mvaa 140,236,112
Mvaa 172,236,116
Ta 208,20,0
Ta 210,20,1024
Mvaa 204,236,120
Mvaa 236,236,124
Mvaa 144,240,112
s_waitcnt lgkmcnt(6)
Ta 212,21,0
Ta 214,21,1024
Mvaa 176,240,116
buffer_load_dwordx4 a[68:71], v10, s[20:23], s52 offen offset:0 sc1
Mvaa 208,240,120
Mvaa 240,240,124
Ta 216,22,0
Ta 218,22,1024
Mvaa 148,244,112
Mvaa 180,244,116
buffer_load_dwordx4 a[72:75], v11, s[20:23], s53 offen offset:0 sc1
Mvaa 212,244,120
Ta 220,23,0
Ta 222,23,1024
Mvaa 244,244,124
Mvaa 152,248,112
Mvaa 184,248,116
buffer_load_dwordx4 a[76:79], v11, s[20:23], s52 offen offset:0 sc1
Mvaa 216,248,120
Mvaa 248,248,124
Mvaa 156,252,112
Mvaa 188,252,116
Mvaa 220,252,120
s_waitcnt vmcnt(26) lgkmcnt(0)
Mvaa 252,252,124
Mvaa 128,192,0
Mvaa 160,192,4
Ta 224,16,8192
Ta 226,16,9216
Mvaa 192,192,8
buffer_load_dwordx4 v9, s[8:11], s50 offen offset:2048 lds
Mvaa 224,192,12
Mvaa 132,196,0
Ta 228,17,8192
Ta 230,17,9216
Mvaa 164,196,4
Mvaa 196,196,8
buffer_load_dwordx4 v9, s[8:11], s51 offen offset:3072 lds
Mvaa 228,196,12
Ta 232,18,8192
Ta 234,18,9216
Mvaa 136,200,0
v_xor_b32 v8, 7864320, v8
v_xor_b32 v9, 7864320, v9
Mvaa 168,200,4
Mvaa 200,200,8
Ta 236,19,8192
Ta 238,19,9216
Mvaa 232,200,12
buffer_load_dwordx4 a[80:83], v10, s[20:23], s53 offen offset:1024 sc1
Mvaa 140,204,0
Mvaa 172,204,4
Ta 240,20,8192
Ta 242,20,9216
Mvaa 204,204,8
Mvaa 236,204,12
Mvaa 144,208,0
s_waitcnt lgkmcnt(6)
Ta 244,21,8192
Ta 246,21,9216
Mvaa 176,208,4
buffer_load_dwordx4 a[84:87], v10, s[20:23], s52 offen offset:1024 sc1
Mvaa 208,208,8
Mvaa 240,208,12
Ta 248,22,8192
Ta 250,22,9216
Mvaa 148,212,0
Mvaa 180,212,4
buffer_load_dwordx4 a[88:91], v11, s[20:23], s53 offen offset:1024 sc1
Mvaa 212,212,8
Ta 252,23,8192
Ta 254,23,9216
Mvaa 244,212,12
Mvaa 152,216,0
Mvaa 184,216,4
buffer_load_dwordx4 a[92:95], v11, s[20:23], s52 offen offset:1024 sc1
Mvaa 216,216,8
s_xor_b32 s52, s52, 2048
s_add_u32 s53, s52, s58
Mvaa 248,216,12
Mvaa 156,220,0
Mvaa 188,220,4
Mvaa 220,220,8
s_waitcnt vmcnt(24) lgkmcnt(0)
Mvaa 252,220,12
s_barrier
Mvaa 128,224,16
s_mov_b64 exec, 1
buffer_store_dword v12, v7, s[20:23], s39 offen sc1
s_mov_b64 exec, -1
Mvaa 160,224,20
Ta 192,16,16384
Ta 194,16,17408
Mvaa 192,224,24
buffer_load_dwordx4 a[96:99], v10, s[20:23], s53 offen offset:0 sc1
Mvaa 224,224,28
s_mov_b32 s24, s60
s_mov_b32 s25, s61
s_mov_b32 s26, s62
Mvaa 132,228,16
Ta 196,17,16384
Ta 198,17,17408
Mvaa 164,228,20
s_add_u32 s93, s2, 224
s_and_b32 s93, s93, 255
s_mul_i32 s92, s93, 2341
Mvaa 196,228,24
s_lshr_b32 s92, s92, 16
s_mul_i32 s47, s92, 28
s_sub_u32 s4, s93, s47
Mvaa 228,228,28
Ta 200,18,16384
Ta 202,18,17408
Mvaa 136,232,16
s_mul_i32 s5, s92, 917504
s_lshl_b32 s47, s4, 8
s_add_u32 s5, s5, s47
Mvaa 168,232,20
buffer_load_dwordx4 a[100:103], v10, s[20:23], s52 offen offset:0 sc1
Mvaa 200,232,24
Ta 204,19,16384
Ta 206,19,17408
Mvaa 232,232,28
v_lshrrev_b32 v24, 4, v0
v_and_b32_e64 v25, 15, v0
Mvaa 140,236,16
s_lshl_b32 s3, s32, 4
v_add_u32 v26, s3, v24
v_mul_u32_u24 v26, 7168, v26
Mvaa 172,236,20
Ta 208,20,16384
Ta 210,20,17408
Mvaa 204,236,24
v_lshlrev_b32 v24, 1, v24
v_xor_b32 v24, v24, v25
Mvaa 236,236,28
v_lshl_add_u32 v24, v24, 4, v26
v_xor_b32 v25, 128, v24
Mvaa 144,240,16
s_waitcnt lgkmcnt(6)
Ta 212,21,16384
Ta 214,21,17408
Mvaa 176,240,20
buffer_load_dwordx4 a[104:107], v11, s[20:23], s53 offen offset:0 sc1
Mvaa 208,240,24
s_mov_b32 s94, 1040356334
s_mov_b32 s95, 1040356334
s_sub_u32 s55, 15, s34
Mvaa 240,240,28
Ta 216,22,16384
Ta 218,22,17408
Mvaa 148,244,16
s_sub_u32 s45, s36, 3
s_sub_u32 s46, s35, 3
s_mov_b32 s54, s44
Mvaa 180,244,20
s_sub_u32 s35, s35, 2
s_sub_u32 s36, s36, 2
v_accvgpr_write_b32 a0, 0
Mvaa 212,244,24
Ta 220,23,16384
Ta 222,23,17408
Mvaa 244,244,28
v_accvgpr_write_b32 a1, 0
v_accvgpr_write_b32 a2, 0
Mvaa 152,248,16
buffer_load_dwordx4 a[108:111], v11, s[20:23], s52 offen offset:0 sc1
Mvaa 184,248,20
v_accvgpr_write_b32 a3, 0
v_accvgpr_write_b32 a4, 0
Mvaa 216,248,24
v_accvgpr_write_b32 a5, 0
v_accvgpr_write_b32 a6, 0
Mvaa 248,248,28
v_accvgpr_write_b32 a7, 0
v_accvgpr_write_b32 a8, 0
Mvaa 156,252,16
v_accvgpr_write_b32 a9, 0
v_accvgpr_write_b32 a10, 0
Mvaa 188,252,20
v_accvgpr_write_b32 a11, 0
v_accvgpr_write_b32 a12, 0
Mvaa 220,252,24
s_waitcnt vmcnt(23) lgkmcnt(0)
v_accvgpr_write_b32 a13, 0
v_accvgpr_write_b32 a14, 0
Mvaa 252,252,28
v_accvgpr_write_b32 a15, 0
Mvaa 128,192,32
v_accvgpr_write_b32 a16, 0
v_accvgpr_write_b32 a17, 0
Mvaa 160,192,36
Ta 224,16,24576
Ta 226,16,25600
Mvaa 192,192,40
buffer_load_dwordx4 a[112:115], v10, s[20:23], s53 offen offset:1024 sc1
Mvaa 224,192,44
v_accvgpr_write_b32 a18, 0
v_accvgpr_write_b32 a19, 0
Mvaa 132,196,32
Ta 228,17,24576
Ta 230,17,25600
Mvaa 164,196,36
v_accvgpr_write_b32 a20, 0
v_accvgpr_write_b32 a21, 0
Mvaa 196,196,40
v_accvgpr_write_b32 a22, 0
v_accvgpr_write_b32 a23, 0
Mvaa 228,196,44
Ta 232,18,24576
Ta 234,18,25600
Mvaa 136,200,32
v_accvgpr_write_b32 a24, 0
v_accvgpr_write_b32 a25, 0
Mvaa 168,200,36
buffer_load_dwordx4 a[116:119], v10, s[20:23], s52 offen offset:1024 sc1
Mvaa 200,200,40
Ta 236,19,24576
Ta 238,19,25600
Mvaa 232,200,44
v_accvgpr_write_b32 a26, 0
v_accvgpr_write_b32 a27, 0
Mvaa 140,204,32
v_accvgpr_write_b32 a28, 0
v_accvgpr_write_b32 a29, 0
Mvaa 172,204,36
Ta 240,20,24576
Ta 242,20,25600
Mvaa 204,204,40
v_accvgpr_write_b32 a30, 0
v_accvgpr_write_b32 a31, 0
Mvaa 236,204,44
Mvaa 144,208,32
s_waitcnt lgkmcnt(6)
Ta 244,21,24576
Ta 246,21,25600
Mvaa 176,208,36
buffer_load_dwordx4 a[120:123], v11, s[20:23], s53 offen offset:1024 sc1
Mvaa 208,208,40
Mvaa 240,208,44
Ta 248,22,24576
Ta 250,22,25600
Mvaa 148,212,32
Mvaa 180,212,36
Mvaa 212,212,40
Ta 252,23,24576
Ta 254,23,25600
Mvaa 244,212,44
Mvaa 152,216,32
buffer_load_dwordx4 a[124:127], v11, s[20:23], s52 offen offset:1024 sc1
Mvaa 184,216,36
Mvaa 216,216,40
Mvaa 248,216,44
Mvaa 156,220,32
Mvaa 188,220,36
Mvaa 220,220,40
s_waitcnt vmcnt(21) lgkmcnt(0)
Mvaa 252,220,44
s_barrier
Mvaa 128,224,48
v_accvgpr_write_b32 a32, 0
v_accvgpr_write_b32 a33, 0
Mvaa 160,224,52
Ta 192,16,32768
Ta 194,16,33792
Mvaa 192,224,56
v_accvgpr_write_b32 a34, 0
v_accvgpr_write_b32 a35, 0
Mvaa 224,224,60
v_accvgpr_write_b32 a36, 0
v_accvgpr_write_b32 a37, 0
Mvaa 132,228,48
Ta 196,17,32768
Ta 198,17,33792
Mvaa 164,228,52
v_accvgpr_write_b32 a38, 0
v_accvgpr_write_b32 a39, 0
Mvaa 196,228,56
v_accvgpr_write_b32 a40, 0
v_accvgpr_write_b32 a41, 0
Mvaa 228,228,60
Ta 200,18,32768
Ta 202,18,33792
Mvaa 136,232,48
v_accvgpr_write_b32 a42, 0
v_accvgpr_write_b32 a43, 0
Mvaa 168,232,52
v_accvgpr_write_b32 a44, 0
v_accvgpr_write_b32 a45, 0
Mvaa 200,232,56
Ta 204,19,32768
Ta 206,19,33792
Mvaa 232,232,60
buffer_load_dword v12, v1, s[20:23], s6 offen sc1
Mvaa 140,236,48
s_add_u32 m0, s44, 65536
s_mov_b32 s7, 0
Mvaa 172,236,52
Ta 208,20,32768
Ta 210,20,33792
Mvaa 204,236,56
v_accvgpr_write_b32 a46, 0
v_accvgpr_write_b32 a47, 0
Mvaa 236,236,60
Mvaa 144,240,48
s_waitcnt lgkmcnt(6)
Ta 212,21,32768
Ta 214,21,33792
Mvaa 176,240,52
Mvaa 208,240,56
Mvaa 240,240,60
Ta 216,22,32768
Ta 218,22,33792
Mvaa 148,244,48
Mvaa 180,244,52
Mvaa 212,244,56
Ta 220,23,32768
Ta 222,23,33792
Mvaa 244,244,60
Mvaa 152,248,48
Mvaa 184,248,52
Mvaa 216,248,56
Mvaa 248,248,60
Mvaa 156,252,48
Mvaa 188,252,52
Mvaa 220,252,56
s_waitcnt vmcnt(16) lgkmcnt(0)
Mvaa 252,252,60
Mvaa 128,192,64
v_accvgpr_write_b32 a48, 0
v_accvgpr_write_b32 a49, 0
Mvaa 160,192,68
Ta 224,16,40960
Ta 226,16,41984
Mvaa 192,192,72
v_accvgpr_write_b32 a50, 0
v_accvgpr_write_b32 a51, 0
Mvaa 224,192,76
v_accvgpr_write_b32 a52, 0
v_accvgpr_write_b32 a53, 0
Mvaa 132,196,64
Ta 228,17,40960
Ta 230,17,41984
Mvaa 164,196,68
v_accvgpr_write_b32 a54, 0
v_accvgpr_write_b32 a55, 0
Mvaa 196,196,72
v_accvgpr_write_b32 a56, 0
v_accvgpr_write_b32 a57, 0
Mvaa 228,196,76
Ta 232,18,40960
Ta 234,18,41984
Mvaa 136,200,64
v_accvgpr_write_b32 a58, 0
v_accvgpr_write_b32 a59, 0
Mvaa 168,200,68
v_accvgpr_write_b32 a60, 0
v_accvgpr_write_b32 a61, 0
Mvaa 200,200,72
Ta 236,19,40960
Ta 238,19,41984
Mvaa 232,200,76
v_accvgpr_write_b32 a62, 0
v_accvgpr_write_b32 a63, 0
Mvaa 140,204,64
Mvaa 172,204,68
Ta 240,20,40960
Ta 242,20,41984
Mvaa 204,204,72
Mvaa 236,204,76
Mvaa 144,208,64
s_waitcnt lgkmcnt(6)
Ta 244,21,40960
Ta 246,21,41984
Mvaa 176,208,68
Mvaa 208,208,72
Mvaa 240,208,76
Ta 248,22,40960
Ta 250,22,41984
Mvaa 148,212,64
Mvaa 180,212,68
Mvaa 212,212,72
Ta 252,23,40960
Ta 254,23,41984
Mvaa 244,212,76
Mvaa 152,216,64
Mvaa 184,216,68
Mvaa 216,216,72
Mvaa 248,216,76
Mvaa 156,220,64
Mvaa 188,220,68
Mvaa 220,220,72
s_waitcnt vmcnt(0) lgkmcnt(0)
Mvaa 252,220,76
s_cmp_lg_u32 s32, 0
s_cbranch_scc1 L_spinBr
v_cmp_ne_u32 vcc, 1, v12
s_cbranch_vccnz L_spinB
L_spinBr:
s_barrier
Mvaa 128,224,80
buffer_load_dwordx4 v4, s[12:15], s7 offen offset:0 sc1 lds
Mvaa 160,224,84
Ta 192,16,49152
Ta 194,16,50176
Mvaa 192,224,88
v_accvgpr_write_b32 a64, 0
v_accvgpr_write_b32 a65, 0
Mvaa 224,224,92
buffer_load_dwordx4 v4, s[12:15], s7 offen offset:1024 sc1 lds
Mvaa 132,228,80
Ta 196,17,49152
Ta 198,17,50176
Mvaa 164,228,84
v_accvgpr_write_b32 a66, 0
v_accvgpr_write_b32 a67, 0
Mvaa 196,228,88
buffer_load_dwordx4 v4, s[12:15], s7 offen offset:2048 sc1 lds
Mvaa 228,228,92
Ta 200,18,49152
Ta 202,18,50176
Mvaa 136,232,80
v_accvgpr_write_b32 a68, 0
v_accvgpr_write_b32 a69, 0
Mvaa 168,232,84
buffer_load_dwordx4 v4, s[12:15], s7 offen offset:3072 sc1 lds
Mvaa 200,232,88
Ta 204,19,49152
Ta 206,19,50176
Mvaa 232,232,92
s_add_u32 m0, s44, 98304
s_mov_b32 s7, 34816
Mvaa 140,236,80
buffer_load_dwordx4 v4, s[12:15], s7 offen offset:0 sc1 lds
Mvaa 172,236,84
Ta 208,20,49152
Ta 210,20,50176
Mvaa 204,236,88
v_accvgpr_write_b32 a70, 0
v_accvgpr_write_b32 a71, 0
Mvaa 236,236,92
buffer_load_dwordx4 v4, s[12:15], s7 offen offset:1024 sc1 lds
Mvaa 144,240,80
s_waitcnt lgkmcnt(6)
Ta 212,21,49152
Ta 214,21,50176
Mvaa 176,240,84
v_accvgpr_write_b32 a72, 0
v_accvgpr_write_b32 a73, 0
Mvaa 208,240,88
buffer_load_dwordx4 v4, s[12:15], s7 offen offset:2048 sc1 lds
Mvaa 240,240,92
Ta 216,22,49152
Ta 218,22,50176
Mvaa 148,244,80
v_accvgpr_write_b32 a74, 0
v_accvgpr_write_b32 a75, 0
Mvaa 180,244,84
buffer_load_dwordx4 v4, s[12:15], s7 offen offset:3072 sc1 lds
Mvaa 212,244,88
Ta 220,23,49152
Ta 222,23,50176
Mvaa 244,244,92
s_add_u32 m0, s44, 81920
s_mov_b32 s7, 17408
Mvaa 152,248,80
buffer_load_dwordx4 v4, s[12:15], s7 offen offset:0 sc1 lds
Mvaa 184,248,84
v_accvgpr_write_b32 a76, 0
v_accvgpr_write_b32 a77, 0
Mvaa 216,248,88
buffer_load_dwordx4 v4, s[12:15], s7 offen offset:1024 sc1 lds
Mvaa 248,248,92
v_accvgpr_write_b32 a78, 0
v_accvgpr_write_b32 a79, 0
Mvaa 156,252,80
Mvaa 188,252,84
Mvaa 220,252,88
s_waitcnt lgkmcnt(0)
Mvaa 252,252,92
Mvaa 128,192,96
buffer_load_dwordx4 v4, s[12:15], s7 offen offset:2048 sc1 lds
Mvaa 160,192,100
Ta 224,16,57344
Ta 226,16,58368
Mvaa 192,192,104
buffer_load_dwordx4 v4, s[12:15], s7 offen offset:3072 sc1 lds
Mvaa 224,192,108
s_add_u32 m0, s44, 114688
s_mov_b32 s7, 52224
Mvaa 132,196,96
Ta 228,17,57344
Ta 230,17,58368
Mvaa 164,196,100
buffer_load_dwordx4 v4, s[12:15], s7 offen offset:0 sc1 lds
Mvaa 196,196,104
buffer_load_dwordx4 v4, s[12:15], s7 offen offset:1024 sc1 lds
Mvaa 228,196,108
Ta 232,18,57344
Ta 234,18,58368
Mvaa 136,200,96
v_accvgpr_write_b32 a80, 0
v_accvgpr_write_b32 a81, 0
Mvaa 168,200,100
buffer_load_dwordx4 v4, s[12:15], s7 offen offset:2048 sc1 lds
Mvaa 200,200,104
Ta 236,19,57344
Ta 238,19,58368
Mvaa 232,200,108
v_accvgpr_write_b32 a82, 0
v_accvgpr_write_b32 a83, 0
Mvaa 140,204,96
buffer_load_dwordx4 v4, s[12:15], s7 offen offset:3072 sc1 lds
Mvaa 172,204,100
Ta 240,20,57344
Ta 242,20,58368
Mvaa 204,204,104
s_add_u32 m0, s44, 0
s_mov_b32 s7, 69632
Mvaa 236,204,108
buffer_load_dwordx4 v4, s[12:15], s7 offen offset:0 sc1 lds
Mvaa 144,208,96
s_waitcnt lgkmcnt(6)
Ta 244,21,57344
Ta 246,21,58368
Mvaa 176,208,100
buffer_load_dwordx4 v4, s[12:15], s7 offen offset:1024 sc1 lds
Mvaa 208,208,104
v_accvgpr_write_b32 a84, 0
v_accvgpr_write_b32 a85, 0
Mvaa 240,208,108
Ta 248,22,57344
Ta 250,22,58368
Mvaa 148,212,96
buffer_load_dwordx4 v4, s[12:15], s7 offen offset:2048 sc1 lds
Mvaa 180,212,100
v_accvgpr_write_b32 a86, 0
v_accvgpr_write_b32 a87, 0
Mvaa 212,212,104
Ta 252,23,57344
Ta 254,23,58368
Mvaa 244,212,108
buffer_load_dwordx4 v4, s[12:15], s7 offen offset:3072 sc1 lds
Mvaa 152,216,96
s_add_u32 m0, s44, 16384
s_mov_b32 s7, 87040
Mvaa 184,216,100
v_accvgpr_write_b32 a88, 0
v_accvgpr_write_b32 a89, 0
Mvaa 216,216,104
buffer_load_dwordx4 v4, s[12:15], s7 offen offset:0 sc1 lds
Mvaa 248,216,108
v_accvgpr_write_b32 a90, 0
v_accvgpr_write_b32 a91, 0
Mvaa 156,220,96
v_accvgpr_write_b32 a92, 0
v_accvgpr_write_b32 a93, 0
Mvaa 188,220,100
v_accvgpr_write_b32 a94, 0
v_accvgpr_write_b32 a95, 0
Mvaa 220,220,104
s_waitcnt vmcnt(17) lgkmcnt(0)
Mvaa 252,220,108
s_barrier
Mvaa 128,224,112
buffer_load_dwordx4 v4, s[12:15], s7 offen offset:1024 sc1 lds
Mvaa 132,228,112
buffer_load_dwordx4 v4, s[12:15], s7 offen offset:2048 sc1 lds
Mvaa 136,232,112
Ra 192,3,0
Ra 196,3,1024
Mvaa 140,236,112
buffer_load_dwordx4 v4, s[12:15], s7 offen offset:3072 sc1 lds
Mvaa 144,240,112
s_add_u32 m0, s44, 32768
s_mov_b32 s7, 104448
Mvaa 148,244,112
Ra 200,3,2048
Ra 204,3,3072
Mvaa 152,248,112
buffer_load_dwordx4 v4, s[12:15], s7 offen offset:0 sc1 lds
Mvaa 156,252,112
Ra 208,3,4096
Ra 212,3,5120
Mvaa 160,224,116
buffer_load_dwordx4 v4, s[12:15], s7 offen offset:1024 sc1 lds
Mvaa 164,228,116
Ra 216,3,6144
Ra 220,3,7168
Mvaa 168,232,116
Mvaa 172,236,116
buffer_load_dwordx4 v4, s[12:15], s7 offen offset:2048 sc1 lds
Mvaa 176,240,116
v_mul_f32 v128, s94, v128
v_mul_f32_e64 v129, s94, v129
Mvaa 180,244,116
v_mul_f32 v130, s94, v130
v_mul_f32 v131, s94, v131
Mvaa 184,248,116
buffer_load_dwordx4 v4, s[12:15], s7 offen offset:3072 sc1 lds
Mvaa 188,252,116
v_mul_f32 v132, s94, v132
v_mul_f32 v133, s94, v133
Mvaa 192,224,120
v_mul_f32 v134, s94, v134
v_mul_f32 v135, s94, v135
Mvaa 196,228,120
Vc 128,128,129
Vc 129,130,131
Mvaa 200,232,120
Vc 130,132,133
Vc 131,134,135
Mvaa 204,236,120
Aw 128,128
Aw 129,129
Mvaa 208,240,120
Aw 130,130
Aw 131,131
Mvaa 212,244,120
v_mul_f32 v136, s94, v136
v_mul_f32 v137, s94, v137
Mvaa 216,248,120
v_mul_f32 v138, s94, v138
v_mul_f32 v139, s94, v139
Mvaa 220,252,120
v_mul_f32 v140, s94, v140
v_mul_f32 v141, s94, v141
Mvaa 224,224,124
v_mul_f32 v142, s94, v142
v_mul_f32 v143, s94, v143
Mvaa 228,228,124
Vc 136,136,137
Vc 137,138,139
Mvaa 232,232,124
Vc 138,140,141
Vc 139,142,143
Mvaa 236,236,124
Aw 132,136
Aw 133,137
Mvaa 240,240,124
Aw 134,138
Aw 135,139
Mvaa 244,244,124
v_mul_f32 v144, s94, v144
v_mul_f32 v145, s94, v145
Mvaa 248,248,124
v_mul_f32 v146, s94, v146
v_mul_f32 v147, s94, v147
Mvaa 252,252,124
v_mul_f32 v148, s94, v148
v_mul_f32 v149, s94, v149
Ra 224,3,8192
Ra 228,3,9216
Ra 232,3,10240
Ra 236,3,11264
Ra 240,3,12288
Ra 244,3,13312
Ra 248,3,14336
s_waitcnt lgkmcnt(9)
Ra 252,3,15360
v_mul_f32 v150, s94, v150
v_mul_f32_e64 v151, s94, v151
Vc 144,144,145
Vc 145,146,147
Vc 146,148,149
Vc 147,150,151
Aw 136,144
Aw 137,145
Aw 138,146
Aw 139,147
v_mul_f32 v152, s94, v152
v_mul_f32 v153, s94, v153
v_mul_f32 v154, s94, v154
v_mul_f32 v155, s94, v155
v_mul_f32 v156, s94, v156
v_mul_f32 v157, s94, v157
v_mul_f32 v158, s94, v158
v_mul_f32 v159, s94, v159
Vc 152,152,153
Vc 153,154,155
Vc 154,156,157
Vc 155,158,159
Aw 140,152
Aw 141,153
Aw 142,154
Aw 143,155
Zvaa 128,192,128
v_mul_f32 v160, s94, v160
v_mul_f32 v161, s94, v161
v_mul_f32 v162, s94, v162
v_mul_f32 v163, s94, v163
Mvaa 128,196,132
v_mul_f32 v164, s94, v164
v_mul_f32 v165, s94, v165
v_mul_f32 v166, s94, v166
v_mul_f32 v167, s94, v167
Mvaa 128,200,136
Vc 160,160,161
Vc 161,162,163
Vc 162,164,165
Vc 163,166,167
Mvaa 128,204,140
Aw 144,160
Aw 145,161
Aw 146,162
Aw 147,163
s_waitcnt lgkmcnt(8)
Zvaa 132,208,128
v_mul_f32 v168, s94, v168
v_mul_f32 v169, s94, v169
v_mul_f32 v170, s94, v170
v_mul_f32_e64 v171, s94, v171
Mvaa 132,212,132
v_mul_f32 v172, s94, v172
v_mul_f32 v173, s94, v173
v_mul_f32 v174, s94, v174
v_mul_f32 v175, s94, v175
Mvaa 132,216,136
Vc 168,168,169
Vc 169,170,171
Vc 170,172,173
Vc 171,174,175
Mvaa 132,220,140
Aw 148,168
Aw 149,169
Aw 150,170
Aw 151,171
s_waitcnt lgkmcnt(4)
Zvaa 136,224,128
v_mul_f32 v176, s94, v176
v_mul_f32 v177, s94, v177
v_mul_f32 v178, s94, v178
v_mul_f32_e64 v179, s94, v179
Mvaa 136,228,132
v_mul_f32 v180, s94, v180
v_mul_f32 v181, s94, v181
v_mul_f32 v182, s94, v182
v_mul_f32 v183, s94, v183
Mvaa 136,232,136
Vc 176,176,177
Vc 177,178,179
Vc 178,180,181
Vc 179,182,183
Mvaa 136,236,140
Aw 152,176
Aw 153,177
Aw 154,178
Aw 155,179
s_waitcnt lgkmcnt(0)
Zvaa 140,240,128
v_mul_f32 v184, s94, v184
v_mul_f32 v185, s94, v185
v_mul_f32 v186, s94, v186
v_mul_f32_e64 v187, s94, v187
Mvaa 140,244,132
v_mul_f32 v188, s94, v188
v_mul_f32 v189, s94, v189
v_mul_f32 v190, s94, v190
v_mul_f32 v191, s94, v191
Mvaa 140,248,136
Vc 184,184,185
Vc 185,186,187
Vc 186,188,189
Vc 187,190,191
Mvaa 140,252,140
Aw 156,184
Aw 157,185
Aw 158,186
Aw 159,187
Zvaa 144,192,144
v_mul_f32 v192, s94, v192
v_mul_f32 v193, s94, v193
v_mul_f32 v194, s94, v194
v_mul_f32 v195, s94, v195
Mvaa 144,196,148
v_mul_f32 v196, s94, v196
v_mul_f32 v197, s94, v197
v_mul_f32 v198, s94, v198
v_mul_f32 v199, s94, v199
Mvaa 144,200,152
Vc 192,192,193
Vc 193,194,195
Vc 194,196,197
Vc 195,198,199
Mvaa 144,204,156
Aw 160,192
Aw 161,193
Aw 162,194
Aw 163,195
Zvaa 148,208,144
v_mul_f32 v200, s94, v200
v_mul_f32 v201, s94, v201
v_mul_f32 v202, s94, v202
v_mul_f32 v203, s94, v203
Mvaa 148,212,148
v_mul_f32 v204, s94, v204
v_mul_f32 v205, s94, v205
v_mul_f32 v206, s94, v206
v_mul_f32 v207, s94, v207
Mvaa 148,216,152
Vc 200,200,201
Vc 201,202,203
Vc 202,204,205
Vc 203,206,207
Mvaa 148,220,156
Aw 164,200
Aw 165,201
Aw 166,202
Aw 167,203
Zvaa 152,224,144
v_mul_f32 v208, s94, v208
v_mul_f32 v209, s94, v209
v_mul_f32 v210, s94, v210
v_mul_f32 v211, s94, v211
Mvaa 152,228,148
v_mul_f32 v212, s94, v212
v_mul_f32 v213, s94, v213
v_mul_f32 v214, s94, v214
v_mul_f32 v215, s94, v215
Mvaa 152,232,152
Vc 208,208,209
Vc 209,210,211
Vc 210,212,213
Vc 211,214,215
Mvaa 152,236,156
Aw 168,208
Aw 169,209
Aw 170,210
Aw 171,211
Zvaa 156,240,144
v_mul_f32 v216, s94, v216
v_mul_f32 v217, s94, v217
v_mul_f32 v218, s94, v218
v_mul_f32 v219, s94, v219
Mvaa 156,244,148
v_mul_f32 v220, s94, v220
v_mul_f32 v221, s94, v221
v_mul_f32 v222, s94, v222
v_mul_f32 v223, s94, v223
Mvaa 156,248,152
Vc 216,216,217
Vc 217,218,219
Vc 218,220,221
Vc 219,222,223
Mvaa 156,252,156
Aw 172,216
Aw 173,217
Aw 174,218
Aw 175,219
Zvaa 160,192,160
v_mul_f32 v224, s94, v224
v_mul_f32 v225, s94, v225
v_mul_f32 v226, s94, v226
v_mul_f32 v227, s94, v227
Mvaa 160,196,164
v_mul_f32 v228, s94, v228
v_mul_f32 v229, s94, v229
v_mul_f32 v230, s94, v230
v_mul_f32 v231, s94, v231
Mvaa 160,200,168
Vc 224,224,225
Vc 225,226,227
Vc 226,228,229
Vc 227,230,231
Mvaa 160,204,172
Aw 176,224
Aw 177,225
Aw 178,226
Aw 179,227
Zvaa 164,208,160
v_mul_f32 v232, s94, v232
v_mul_f32 v233, s94, v233
v_mul_f32 v234, s94, v234
v_mul_f32 v235, s94, v235
Mvaa 164,212,164
v_mul_f32 v236, s94, v236
v_mul_f32 v237, s94, v237
v_mul_f32 v238, s94, v238
v_mul_f32 v239, s94, v239
Mvaa 164,216,168
Vc 232,232,233
Vc 233,234,235
Vc 234,236,237
Vc 235,238,239
Mvaa 164,220,172
Aw 180,232
Aw 181,233
Aw 182,234
Aw 183,235
Zvaa 168,224,160
v_mul_f32 v240, s94, v240
v_mul_f32 v241, s94, v241
v_mul_f32 v242, s94, v242
v_mul_f32 v243, s94, v243
Mvaa 168,228,164
v_mul_f32 v244, s94, v244
v_mul_f32 v245, s94, v245
v_mul_f32 v246, s94, v246
v_mul_f32 v247, s94, v247
Mvaa 168,232,168
Vc 240,240,241
Vc 241,242,243
Vc 242,244,245
Vc 243,246,247
Mvaa 168,236,172
Aw 184,240
Aw 185,241
Aw 186,242
Aw 187,243
Zvaa 172,240,160
v_mul_f32 v248, s94, v248
v_mul_f32 v249, s94, v249
v_mul_f32 v250, s94, v250
v_mul_f32 v251, s94, v251
Mvaa 172,244,164
v_mul_f32 v252, s94, v252
v_mul_f32 v253, s94, v253
v_mul_f32 v254, s94, v254
v_mul_f32 v255, s94, v255
Mvaa 172,248,168
Vc 248,248,249
Vc 249,250,251
Vc 250,252,253
Vc 251,254,255
Mvaa 172,252,172
Aw 188,248
Aw 189,249
Aw 190,250
Aw 191,251
Zvaa 176,192,176
v_accvgpr_write_b32 a96, 0
v_accvgpr_write_b32 a97, 0
v_accvgpr_write_b32 a98, 0
v_accvgpr_write_b32 a99, 0
Mvaa 176,196,180
v_accvgpr_write_b32 a100, 0
v_accvgpr_write_b32 a101, 0
v_accvgpr_write_b32 a102, 0
v_accvgpr_write_b32 a103, 0
Mvaa 176,200,184
v_accvgpr_write_b32 a104, 0
v_accvgpr_write_b32 a105, 0
v_accvgpr_write_b32 a106, 0
v_accvgpr_write_b32 a107, 0
Mvaa 176,204,188
v_accvgpr_write_b32 a108, 0
v_accvgpr_write_b32 a109, 0
v_accvgpr_write_b32 a110, 0
v_accvgpr_write_b32 a111, 0
Zvaa 180,208,176
v_accvgpr_write_b32 a112, 0
v_accvgpr_write_b32 a113, 0
v_accvgpr_write_b32 a114, 0
v_accvgpr_write_b32 a115, 0
Mvaa 180,212,180
v_accvgpr_write_b32 a116, 0
v_accvgpr_write_b32 a117, 0
v_accvgpr_write_b32 a118, 0
v_accvgpr_write_b32 a119, 0
Mvaa 180,216,184
v_accvgpr_write_b32 a120, 0
v_accvgpr_write_b32 a121, 0
v_accvgpr_write_b32 a122, 0
v_accvgpr_write_b32 a123, 0
Mvaa 180,220,188
v_accvgpr_write_b32 a124, 0
v_accvgpr_write_b32 a125, 0
v_accvgpr_write_b32 a126, 0
v_accvgpr_write_b32 a127, 0
s_waitcnt vmcnt(16)
s_barrier
s_add_u32 s53, s44, 65536
Zvaa 184,224,176
Ra 192,3,32768
v_mov_b32 v16, 0x3f803f80
v_mov_b32 v17, 0x3f803f80
v_mov_b32 v18, 0x3f803f80
v_mov_b32 v19, 0x3f803f80
Mvaa 184,228,180
Ra 196,3,33792
v_mov_b32 v20, 0xff800000
v_max3_f32 v22, v128, v129, v130
v_max3_f32 v22, v22, v131, v132
v_max3_f32 v22, v22, v133, v134
Mvaa 184,232,184
Ra 200,3,34816
v_max3_f32 v22, v22, v135, v136
v_max3_f32 v22, v22, v137, v138
v_max3_f32 v22, v22, v139, v140
v_max3_f32 v22, v22, v141, v142
Mvaa 184,236,188
Ra 204,3,35840
v_max_f32 v22, v22, v143
v_mov_b32 v1, v22
s_nop 1
v_permlane16_swap_b32 v1, v22
v_max_f32_e64 v22, v22, v1
Zvaa 188,240,176
Ra 208,3,36864
v_mov_b32 v1, v22
s_nop 1
v_permlane32_swap_b32 v1, v22
v_max_f32 v22, v22, v1
v_add_f32 v22, 0x41f80000, v22
Mvaa 188,244,180
Ra 212,3,37888
Vs 128,128,22
Vs 129,129,22
Vs 130,130,22
Vs 131,131,22
Mvaa 188,248,184
Ra 216,3,38912
Vs 132,132,22
Vs 133,133,22
Vs 134,134,22
Vs 135,135,22
Mvaa 188,252,188
Ra 220,3,39936
Vs 136,136,22
Vs 137,137,22
Vs 138,138,22
Vs 139,139,22
Vs 140,140,22
Vs 141,141,22
Vs 142,142,22
Vs 143,143,22
v_sub_f32 v32, 0, v22
v_sub_f32 v33, 0, v22
v_sub_f32 v34, 0, v22
v_sub_f32 v35, 0, v22
v_max3_f32 v22, v144, v145, v146
v_max3_f32 v22, v22, v147, v148
v_max3_f32 v22, v22, v149, v150
v_max3_f32 v22, v22, v151, v152
v_max3_f32 v22, v22, v153, v154
v_max3_f32 v22, v22, v155, v156
v_max3_f32 v22, v22, v157, v158
v_max_f32 v22, v22, v159
v_mov_b32 v1, v22
s_nop 1
v_permlane16_swap_b32 v1, v22
v_max_f32 v22, v22, v1
v_mov_b32 v1, v22
s_nop 1
v_permlane32_swap_b32 v1, v22
v_max_f32_e64 v22, v22, v1
v_add_f32 v22, 0x41f80000, v22
Vs 144,144,22
Vs 145,145,22
Vs 146,146,22
Vs 147,147,22
Vs 148,148,22
Vs 149,149,22
Vs 150,150,22
Vs 151,151,22
Vs 152,152,22
Vs 153,153,22
Vs 154,154,22
Vs 155,155,22
Vs 156,156,22
Vs 157,157,22
Vs 158,158,22
Vs 159,159,22
v_sub_f32 v36, 0, v22
v_sub_f32 v37, 0, v22
v_sub_f32 v38, 0, v22
v_sub_f32 v39, 0, v22
s_mov_b32 s38, 139264
s_mov_b32 s39, 121856
s_cmp_lg_u32 s34, 0
s_cbranch_scc1 L_k2_nomask0
v_cmp_gt_i32 s[56:57], 0, v5
v_cmp_gt_i32 s[58:59], 1, v5
v_cmp_gt_i32 s[60:61], 2, v5
v_cmp_gt_i32 s[62:63], 3, v5
s_nop 3
s_nop 0
v_cndmask_b32 v176, v176, v20, s[56:57]
v_cndmask_b32 v177, v177, v20, s[58:59]
v_cndmask_b32 v178, v178, v20, s[60:61]
v_cndmask_b32 v179, v179, v20, s[62:63]
v_cmp_gt_i32 s[56:57], 16, v5
v_cmp_gt_i32 s[58:59], 17, v5
v_cmp_gt_i32 s[60:61], 18, v5
v_cmp_gt_i32 s[62:63], 19, v5
v_cndmask_b32 v180, v180, v20, s[56:57]
v_cndmask_b32 v181, v181, v20, s[58:59]
v_cndmask_b32 v182, v182, v20, s[60:61]
v_cndmask_b32 v183, v183, v20, s[62:63]
v_cmp_gt_i32 s[56:57], 32, v5
v_cmp_gt_i32 s[58:59], 33, v5
v_cmp_gt_i32 s[60:61], 34, v5
v_cmp_gt_i32 s[62:63], 35, v5
v_cndmask_b32 v184, v184, v20, s[56:57]
v_cndmask_b32 v185, v185, v20, s[58:59]
v_cndmask_b32 v186, v186, v20, s[60:61]
v_cndmask_b32 v187, v187, v20, s[62:63]
v_cmp_gt_i32 s[56:57], 48, v5
v_cmp_gt_i32 s[58:59], 49, v5
v_cmp_gt_i32 s[60:61], 50, v5
v_cmp_gt_i32 s[62:63], 51, v5
v_cndmask_b32 v188, v188, v20, s[56:57]
v_cndmask_b32 v189, v189, v20, s[58:59]
v_cndmask_b32 v190, v190, v20, s[60:61]
v_cndmask_b32 v191, v191, v20, s[62:63]
L_k2_nomask0:
s_mov_b32 s37, 0
s_nop 0
v_max3_f32 v22, v160, v161, v162
v_max3_f32 v22, v22, v163, v164
v_max3_f32 v22, v22, v165, v166
v_max3_f32 v22, v22, v167, v168
v_max3_f32 v22, v22, v169, v170
v_max3_f32 v22, v22, v171, v172
v_max3_f32 v22, v22, v173, v174
v_max_f32 v22, v22, v175
v_mov_b32 v1, v22
s_nop 1
v_permlane16_swap_b32 v1, v22
v_max_f32 v22, v22, v1
v_mov_b32 v1, v22
s_nop 1
v_permlane32_swap_b32 v1, v22
v_max_f32_e64 v22, v22, v1
v_add_f32 v22, 0x41f80000, v22
Vs 160,160,22
Vs 161,161,22
Vs 162,162,22
Vs 163,163,22
Vs 164,164,22
Vs 165,165,22
Vs 166,166,22
Vs 167,167,22
Vs 168,168,22
Vs 169,169,22
Vs 170,170,22
Vs 171,171,22
Vs 172,172,22
Vs 173,173,22
Vs 174,174,22
Vs 175,175,22
v_sub_f32 v40, 0, v22
v_sub_f32 v41, 0, v22
v_sub_f32 v42, 0, v22
v_sub_f32 v43, 0, v22
v_max3_f32 v22, v176, v177, v178
v_max3_f32 v22, v22, v179, v180
v_max3_f32 v22, v22, v181, v182
v_max3_f32 v22, v22, v183, v184
v_max3_f32 v22, v22, v185, v186
v_max3_f32 v22, v22, v187, v188
v_max3_f32 v22, v22, v189, v190
v_max_f32 v22, v22, v191
v_mov_b32 v1, v22
s_nop 1
v_permlane16_swap_b32 v1, v22
v_max_f32 v22, v22, v1
v_mov_b32 v1, v22
s_nop 1
v_permlane32_swap_b32 v1, v22
v_max_f32_e64 v22, v22, v1
v_add_f32 v22, 0x41f80000, v22
Vs 176,176,22
Vs 177,177,22
Vs 178,178,22
Vs 179,179,22
Vs 180,180,22
Vs 181,181,22
Vs 182,182,22
Vs 183,183,22
Vs 184,184,22
Vs 185,185,22
Vs 186,186,22
Vs 187,187,22
Vs 188,188,22
Vs 189,189,22
Vs 190,190,22
Vs 191,191,22
v_sub_f32 v44, 0, v22
v_sub_f32 v45, 0, v22
v_sub_f32 v46, 0, v22
v_sub_f32 v47, 0, v22
Ve 8,128
Ve 9,129
Ve 10,130
Ve 11,131
Vc 64,8,9
Ve 12,144
Ve 13,145
Vc 65,10,11
Ve 14,146
Ve 15,147
Vc 72,12,13
Ve 8,160
Ve 9,161
Vc 73,14,15
Ve 10,162
Ve 11,163
Vc 80,8,9
Ve 12,176
Ve 13,177
Vc 81,10,11
Ve 14,178
Ve 15,179
Vc 88,12,13
Ve 8,132
Ve 9,133
Vc 89,14,15
Ve 10,134
Ve 11,135
Vc 66,8,9
Ve 12,148
Ve 13,149
Vc 67,10,11
Ve 14,150
Ve 15,151
Vc 74,12,13
Ve 8,164
Ve 9,165
Vc 75,14,15
Ve 10,166
Ve 11,167
Vc 82,8,9
Ve 12,180
Ve 13,181
Vc 83,10,11
Ve 14,182
Ve 15,183
Vc 90,12,13
Vc 91,14,15
v_or_b32_e64 v7, v64, v65
v_or3_b32 v7, v7, v72, v73
v_or3_b32 v7, v7, v80, v81
v_or3_b32 v7, v7, v88, v89
v_or3_b32 v7, v7, v66, v67
v_or3_b32 v7, v7, v74, v75
v_or3_b32 v7, v7, v82, v83
v_or3_b32 v7, v7, v90, v91
s_waitcnt lgkmcnt(4)
s_cmp_eq_u32 s34, 0
s_cbranch_scc1 L_k2_wlast
s_branch L_k2_wloop
L_k2_mk_wo:
v_cmp_gt_i32 s[56:57], 0, v5
v_cmp_gt_i32 s[58:59], 1, v5
v_cmp_gt_i32 s[60:61], 2, v5
v_cmp_gt_i32 s[62:63], 3, v5
s_nop 3
s_nop 0
v_cndmask_b32 v176, v176, v20, s[56:57]
v_cndmask_b32 v177, v177, v20, s[58:59]
v_cndmask_b32 v178, v178, v20, s[60:61]
v_cndmask_b32 v179, v179, v20, s[62:63]
v_cmp_gt_i32 s[56:57], 16, v5
v_cmp_gt_i32 s[58:59], 17, v5
v_cmp_gt_i32 s[60:61], 18, v5
v_cmp_gt_i32 s[62:63], 19, v5
v_cndmask_b32 v180, v180, v20, s[56:57]
v_cndmask_b32 v181, v181, v20, s[58:59]
v_cndmask_b32 v182, v182, v20, s[60:61]
v_cndmask_b32 v183, v183, v20, s[62:63]
v_cmp_gt_i32 s[56:57], 32, v5
v_cmp_gt_i32 s[58:59], 33, v5
v_cmp_gt_i32 s[60:61], 34, v5
v_cmp_gt_i32 s[62:63], 35, v5
v_cndmask_b32 v184, v184, v20, s[56:57]
v_cndmask_b32 v185, v185, v20, s[58:59]
v_cndmask_b32 v186, v186, v20, s[60:61]
v_cndmask_b32 v187, v187, v20, s[62:63]
v_cmp_gt_i32 s[56:57], 48, v5
v_cmp_gt_i32 s[58:59], 49, v5
v_cmp_gt_i32 s[60:61], 50, v5
v_cmp_gt_i32 s[62:63], 51, v5
v_cndmask_b32 v188, v188, v20, s[56:57]
v_cndmask_b32 v189, v189, v20, s[58:59]
v_cndmask_b32 v190, v190, v20, s[60:61]
v_cndmask_b32 v191, v191, v20, s[62:63]
s_branch L_k2_mkr_wo
L_k2_mk_tr:
v_cmp_gt_i32 s[56:57], 0, v5
v_cmp_gt_i32 s[58:59], 1, v5
v_cmp_gt_i32 s[60:61], 2, v5
v_cmp_gt_i32 s[62:63], 3, v5
s_nop 3
v_cndmask_b32 v144, v144, v20, s[56:57]
v_cndmask_b32 v145, v145, v20, s[58:59]
v_cndmask_b32 v146, v146, v20, s[60:61]
v_cndmask_b32 v147, v147, v20, s[62:63]
v_cmp_gt_i32 s[56:57], 16, v5
v_cmp_gt_i32 s[58:59], 17, v5
v_cmp_gt_i32 s[60:61], 18, v5
v_cmp_gt_i32 s[62:63], 19, v5
v_cndmask_b32 v148, v148, v20, s[56:57]
v_cndmask_b32 v149, v149, v20, s[58:59]
v_cndmask_b32 v150, v150, v20, s[60:61]
v_cndmask_b32 v151, v151, v20, s[62:63]
v_cmp_gt_i32 s[56:57], 32, v5
v_cmp_gt_i32 s[58:59], 33, v5
v_cmp_gt_i32 s[60:61], 34, v5
v_cmp_gt_i32 s[62:63], 35, v5
v_cndmask_b32 v152, v152, v20, s[56:57]
v_cndmask_b32 v153, v153, v20, s[58:59]
v_cndmask_b32 v154, v154, v20, s[60:61]
v_cndmask_b32 v155, v155, v20, s[62:63]
v_cmp_gt_i32 s[56:57], 48, v5
v_cmp_gt_i32 s[58:59], 49, v5
v_cmp_gt_i32 s[60:61], 50, v5
v_cmp_gt_i32 s[62:63], 51, v5
v_cndmask_b32 v156, v156, v20, s[56:57]
v_cndmask_b32 v157, v157, v20, s[58:59]
v_cndmask_b32 v158, v158, v20, s[60:61]
v_cndmask_b32 v159, v159, v20, s[62:63]
s_branch L_k2_mkr_tr
L_k2_mk_no:
v_cmp_gt_i32 s[56:57], 0, v5
v_cmp_gt_i32 s[58:59], 1, v5
v_cmp_gt_i32 s[60:61], 2, v5
v_cmp_gt_i32 s[62:63], 3, v5
s_nop 3
v_cndmask_b32 v144, v144, v20, s[56:57]
v_cndmask_b32 v145, v145, v20, s[58:59]
v_cndmask_b32 v146, v146, v20, s[60:61]
v_cndmask_b32 v147, v147, v20, s[62:63]
v_cmp_gt_i32 s[56:57], 16, v5
v_cmp_gt_i32 s[58:59], 17, v5
v_cmp_gt_i32 s[60:61], 18, v5
v_cmp_gt_i32 s[62:63], 19, v5
v_cndmask_b32 v148, v148, v20, s[56:57]
v_cndmask_b32 v149, v149, v20, s[58:59]
v_cndmask_b32 v150, v150, v20, s[60:61]
v_cndmask_b32 v151, v151, v20, s[62:63]
v_cmp_gt_i32 s[56:57], 32, v5
v_cmp_gt_i32 s[58:59], 33, v5
v_cmp_gt_i32 s[60:61], 34, v5
v_cmp_gt_i32 s[62:63], 35, v5
v_cndmask_b32 v152, v152, v20, s[56:57]
v_cndmask_b32 v153, v153, v20, s[58:59]
v_cndmask_b32 v154, v154, v20, s[60:61]
v_cndmask_b32 v155, v155, v20, s[62:63]
v_cmp_gt_i32 s[56:57], 48, v5
v_cmp_gt_i32 s[58:59], 49, v5
v_cmp_gt_i32 s[60:61], 50, v5
v_cmp_gt_i32 s[62:63], 51, v5
v_cndmask_b32 v156, v156, v20, s[56:57]
v_cndmask_b32 v157, v157, v20, s[58:59]
v_cndmask_b32 v158, v158, v20, s[60:61]
v_cndmask_b32 v159, v159, v20, s[62:63]
s_branch L_k2_mkr_no
L_pubB:
v_mov_b32 v24, 1
v_mov_b32 v25, 0
s_mov_b64 exec, 1
buffer_store_dword v24, v25, s[20:23], s64 offen sc1
s_mov_b64 exec, -1
s_branch L_pubBr
L_k2_wloop:
v_xor_b32 v2, 65536, v2
v_xor_b32 v3, 65536, v3
Cvaa 192,192,128,32
s_mov_b32 m0, s53
Ra 224,2,40960
v_lshl_add_u64 v[28:29], s[40:41], 0, v[28:29]
Mvaa 192,196,132
buffer_load_dwordx4 v4, s[12:15], s38 offen offset:0 sc1 lds
Mvaa 192,200,136
Ve 8,136
Mvaa 192,204,140
VE 9,137
Cvaa 208,192,144,36
Ra 228,2,41984
Vc 68,8,9
Mvaa 208,196,148
VE 10,138
Mvaa 208,200,152
VE 11,139
Mvaa 208,204,156
Ra 232,2,43008
Vc 69,10,11
Cvaa 224,192,160,40
Ra 236,2,44032
v_or3_b32 v7, v7, v68, v69
Mvaa 224,196,164
VE 12,152
Mvaa 224,200,168
VE 13,153
Mvaa 224,204,172
Ra 240,2,45056
Vc 76,12,13
Cvaa 240,192,176,44
VE 14,154
Mvaa 240,196,180
VE 15,155
Mvaa 240,200,184
Ra 244,2,46080
Vc 77,14,15
Mvaa 240,204,188
s_waitcnt lgkmcnt(6)
Ra 248,2,47104
v_or3_b32 v7, v7, v76, v77
Cvaa 196,208,128,32
buffer_load_dwordx4 v4, s[12:15], s38 offen offset:1024 sc1 lds
Mvaa 196,212,132
Ve 8,168
Mvaa 196,216,136
VE 9,169
Mvaa 196,220,140
Ra 252,2,48128
Vc 84,8,9
Cvaa 212,208,144,36
VE 10,170
Mvaa 212,212,148
VE 11,171
Mvaa 212,216,152
Ra 192,2,16384
Vc 85,10,11
Mvaa 212,220,156
Ra 196,2,24576
v_or3_b32 v7, v7, v84, v85
Cvaa 228,208,160,40
VE 12,184
Mvaa 228,212,164
VE 13,185
Mvaa 228,216,168
Ra 200,2,17408
Vc 92,12,13
Mvaa 228,220,172
VE 14,186
Cvaa 244,208,176,44
VE 15,187
Mvaa 244,212,180
buffer_load_dwordx4 v4, s[12:15], s38 offen offset:2048 sc1 lds
Mvaa 244,216,184
Ra 204,2,25600
Vc 93,14,15
Mvaa 244,220,188
s_waitcnt lgkmcnt(8)
Ve 8,140
Cvaa 200,224,128,32
Ra 208,2,18432
v_or3_b32 v7, v7, v92, v93
Mvaa 200,228,132
VE 9,141
Mvaa 200,232,136
Ra 212,2,26624
Vc 70,8,9
Mvaa 200,236,140
VE 10,142
Cvaa 216,224,144,36
VE 11,143
Mvaa 216,228,148
Ra 216,2,19456
Vc 71,10,11
Mvaa 216,232,152
Ra 220,2,27648
v_or3_b32 v7, v7, v70, v71
Mvaa 216,236,156
VE 12,156
Cvaa 232,224,160,40
VE 13,157
Mvaa 232,228,164
VE 14,158
Mvaa 232,232,168
VE 15,159
Mvaa 232,236,172
buffer_load_dwordx4 v4, s[12:15], s38 offen offset:3072 sc1 lds
Cvaa 248,224,176,44
VE 8,172
Mvaa 248,228,180
VE 9,173
Mvaa 248,232,184
Vc 78,12,13
Vc 79,14,15
Mvaa 248,236,188
s_waitcnt lgkmcnt(8)
Ve 10,174
Cvaa 204,240,128,32
VE 11,175
Mvaa 204,244,132
Vc 86,8,9
Vc 87,10,11
Mvaa 204,248,136
VE 12,188
Mvaa 204,252,140
VE 13,189
Cvaa 220,240,144,36
Vc 94,12,13
v_or3_b32 v7, v7, v78, v79
Mvaa 220,244,148
VE 14,190
Mvaa 220,248,152
VE 15,191
Mvaa 220,252,156
Vc 95,14,15
v_or3_b32 v7, v7, v86, v87
Cvaa 236,240,160,40
v_or3_b32 v7, v7, v94, v95
v_and_b32 v1, 0x40004000, v7
Mvaa 236,244,164
v_cmp_ne_u32 vcc, 0, v1
Mvaa 236,248,168
Mvaa 236,252,172
s_waitcnt vmcnt(12)
Cvaa 252,240,176,44
Mvaa 252,244,180
s_barrier
Mvaa 252,248,184
s_waitcnt lgkmcnt(4)
Mvaa 252,252,188
s_cbranch_vccnz L_k2_fb_we
L_k2_fbr_we:
Maav 0,192,64
Ve 8,192
Maav 0,196,68
s_add_u32 m0, s54, 49152
VE 9,193
Maav 32,192,72
buffer_load_dwordx4 v4, s[12:15], s39 offen offset:0 sc1 lds
Maav 32,196,76
s_add_u32 s37, s37, 1
Ra 224,2,20480
Vc 96,8,9
Maav 64,192,80
s_add_u32 s38, s38, 34816
Ve 10,194
Maav 64,196,84
VE 11,195
Maav 96,192,88
Ra 228,2,28672
Vc 97,10,11
Maav 96,196,92
Ra 232,2,21504
v_or_b32_e64 v7, v96, v97
Maav 4,200,64
VE 12,208
Maav 4,204,68
VE 13,209
Maav 36,200,72
Ra 236,2,29696
Vc 104,12,13
Maav 36,204,76
VE 14,210
Maav 68,200,80
VE 15,211
Maav 68,204,84
Ra 240,2,22528
Vc 105,14,15
Maav 100,200,88
Ra 244,2,30720
v_or3_b32 v7, v7, v104, v105
Maav 100,204,92
buffer_load_dwordx4 v4, s[12:15], s39 offen offset:1024 sc1 lds
Mvvv 48,16,64
VE 8,224
Mvvv 48,16,68
s_waitcnt lgkmcnt(6)
Ve 9,225
Maav 8,208,64
Ra 248,2,23552
Vc 112,8,9
Maav 8,212,68
VE 10,226
Maav 40,208,72
VE 11,227
Maav 40,212,76
Ra 252,2,31744
Vc 113,10,11
Maav 72,208,80
Ra 192,3,0
v_or3_b32 v7, v7, v112, v113
Maav 72,212,84
VE 12,240
Maav 104,208,88
VE 13,241
Maav 104,212,92
Ra 196,3,1024
Vc 120,12,13
Maav 12,216,64
VE 14,242
Maav 12,220,68
VE 15,243
Maav 44,216,72
Ra 200,3,2048
Vc 121,14,15
Maav 44,220,76
buffer_load_dwordx4 v4, s[12:15], s39 offen offset:2048 sc1 lds
Maav 76,216,80
Ra 204,3,3072
v_or3_b32 v7, v7, v120, v121
Maav 76,220,84
VE 8,196
Maav 108,216,88
VE 9,197
Maav 108,220,92
VE 10,198
Mvvv 52,16,72
VE 11,199
Mvvv 52,16,76
s_waitcnt lgkmcnt(8)
Ve 12,212
Maav 16,224,64
Ra 208,3,4096
Vc 98,8,9
Maav 16,228,68
Ra 212,3,5120
Vc 99,10,11
Maav 48,224,72
Ra 216,3,6144
v_or3_b32 v7, v7, v98, v99
Maav 48,228,76
VE 13,213
Maav 80,224,80
Ra 220,3,7168
Vc 106,12,13
Maav 80,228,84
VE 14,214
Maav 112,224,88
buffer_load_dwordx4 v4, s[12:15], s39 offen offset:3072 sc1 lds
Maav 112,228,92
s_add_u32 s39, s39, 34816
VE 15,215
Maav 20,232,64
VE 8,228
Maav 20,236,68
VE 9,229
Maav 52,232,72
VE 10,230
Maav 52,236,76
VE 11,231
Maav 84,232,80
Vc 107,14,15
Vc 114,8,9
Maav 84,236,84
VE 12,244
Maav 116,232,88
VE 13,245
Maav 116,236,92
Vc 115,10,11
Vc 122,12,13
Mvvv 56,16,80
VE 14,246
Mvvv 56,16,84
s_waitcnt lgkmcnt(8)
Ve 15,247
Maav 24,240,64
Vc 123,14,15
v_or3_b32 v7, v7, v106, v107
Maav 24,244,68
v_or3_b32 v7, v7, v114, v115
v_or3_b32 v7, v7, v122, v123
Maav 56,240,72
global_load_dword v30, v[28:29], off
Maav 56,244,76
Maav 88,240,80
Maav 88,244,84
Maav 120,240,88
Maav 120,244,92
Maav 28,248,64
Maav 28,252,68
Maav 60,248,72
Maav 60,252,76
Maav 92,248,80
Maav 92,252,84
Maav 124,248,88
Maav 124,252,92
Mvvv 60,16,88
s_waitcnt lgkmcnt(4)
Mvvv 60,16,92
Ve 8,200
Cvaa 128,192,128,32
s_add_u32 m0, s53, 32768
Ra 224,3,8192
v_lshl_add_u64 v[28:29], s[40:41], 0, v[28:29]
Mvaa 128,196,132
buffer_load_dwordx4 v4, s[12:15], s38 offen offset:0 sc1 lds
Mvaa 128,200,136
VE 9,201
Mvaa 128,204,140
Ra 228,3,9216
Vc 100,8,9
Cvaa 144,192,144,36
VE 10,202
Mvaa 144,196,148
VE 11,203
Mvaa 144,200,152
Ra 232,3,10240
Vc 101,10,11
Mvaa 144,204,156
Ra 236,3,11264
v_or3_b32 v7, v7, v100, v101
Cvaa 160,192,160,40
VE 12,216
Mvaa 160,196,164
VE 13,217
Mvaa 160,200,168
Ra 240,3,12288
Vc 108,12,13
Mvaa 160,204,172
VE 14,218
Cvaa 176,192,176,44
VE 15,219
Mvaa 176,196,180
Ra 244,3,13312
Vc 109,14,15
Mvaa 176,200,184
Ra 248,3,14336
v_or3_b32 v7, v7, v108, v109
Mvaa 176,204,188
s_waitcnt lgkmcnt(7)
Ve 8,232
Cvaa 132,208,128,32
buffer_load_dwordx4 v4, s[12:15], s38 offen offset:1024 sc1 lds
Mvaa 132,212,132
VE 9,233
Mvaa 132,216,136
Ra 252,3,15360
Vc 116,8,9
Mvaa 132,220,140
VE 10,234
Cvaa 148,208,144,36
VE 11,235
Mvaa 148,212,148
Ra 192,2,49152
Vc 117,10,11
Mvaa 148,216,152
Ra 196,2,57344
v_or3_b32 v7, v7, v116, v117
Mvaa 148,220,156
VE 12,248
Cvaa 164,208,160,40
VE 13,249
Mvaa 164,212,164
Ra 200,2,50176
Vc 124,12,13
Mvaa 164,216,168
VE 14,250
Mvaa 164,220,172
VE 15,251
Cvaa 180,208,176,44
Ra 204,2,58368
Vc 125,14,15
Mvaa 180,212,180
buffer_load_dwordx4 v4, s[12:15], s38 offen offset:2048 sc1 lds
Mvaa 180,216,184
VE 8,204
Mvaa 180,220,188
s_waitcnt lgkmcnt(8)
Ve 9,205
Cvaa 136,224,128,32
Ra 208,2,51200
Vc 102,8,9
Mvaa 136,228,132
Ra 212,2,59392
v_or3_b32 v7, v7, v124, v125
Mvaa 136,232,136
VE 10,206
Mvaa 136,236,140
VE 11,207
Cvaa 152,224,144,36
Ra 216,2,52224
Vc 103,10,11
Mvaa 152,228,148
Ra 220,2,60416
v_or3_b32 v7, v7, v102, v103
Mvaa 152,232,152
VE 12,220
Mvaa 152,236,156
VE 13,221
Cvaa 168,224,160,40
VE 14,222
Mvaa 168,228,164
VE 15,223
Mvaa 168,232,168
VE 8,236
Mvaa 168,236,172
buffer_load_dwordx4 v4, s[12:15], s38 offen offset:3072 sc1 lds
Cvaa 184,224,176,44
VE 9,237
Mvaa 184,228,180
Vc 110,12,13
Vc 111,14,15
Mvaa 184,232,184
VE 10,238
Mvaa 184,236,188
s_waitcnt lgkmcnt(8)
Ve 11,239
Cvaa 140,240,128,32
Vc 118,8,9
Vc 119,10,11
Mvaa 140,244,132
VE 12,252
Mvaa 140,248,136
VE 13,253
Mvaa 140,252,140
Vc 126,12,13
v_or3_b32 v7, v7, v110, v111
Cvaa 156,240,144,36
VE 14,254
Mvaa 156,244,148
VE 15,255
Mvaa 156,248,152
Vc 127,14,15
v_or3_b32 v7, v7, v118, v119
Mvaa 156,252,156
v_or3_b32 v7, v7, v126, v127
v_and_b32 v1, 0x40004000, v7
Cvaa 172,240,160,40
v_cmp_ne_u32 vcc, 0, v1
Mvaa 172,244,164
Mvaa 172,248,168
Mvaa 172,252,172
s_waitcnt vmcnt(12)
Cvaa 188,240,176,44
s_cmp_eq_u32 s37, s46
Mvaa 188,244,180
s_barrier
Mvaa 188,248,184
s_waitcnt lgkmcnt(4)
Mvaa 188,252,188
s_cbranch_vccnz L_k2_fb_wo
L_k2_fbr_wo:
Maav 0,192,96
s_cbranch_scc1 L_k2_mk_wo
L_k2_mkr_wo:
Ve 8,128
Maav 0,196,100
s_add_u32 m0, s53, 16384
VE 9,129
Maav 32,192,104
buffer_load_dwordx4 v4, s[12:15], s39 offen offset:0 sc1 lds
Maav 32,196,108
s_add_u32 s37, s37, 1
Ra 224,2,53248
Vc 64,8,9
Maav 64,192,112
s_add_u32 s38, s38, 34816
Ve 10,130
Maav 64,196,116
s_xor_b32 s53, s53, 65536
VE 11,131
Maav 96,192,120
s_xor_b32 s54, s54, 65536
Ra 228,2,61440
Vc 65,10,11
Maav 96,196,124
Ra 232,2,54272
v_or_b32_e64 v7, v64, v65
Maav 4,200,96
VE 12,144
Maav 4,204,100
VE 13,145
Maav 36,200,104
Ra 236,2,62464
Vc 72,12,13
Maav 36,204,108
VE 14,146
Maav 68,200,112
VE 15,147
Maav 68,204,116
Ra 240,2,55296
Vc 73,14,15
Maav 100,200,120
Ra 244,2,63488
v_or3_b32 v7, v7, v72, v73
Maav 100,204,124
buffer_load_dwordx4 v4, s[12:15], s39 offen offset:1024 sc1 lds
Mvvv 48,16,96
VE 8,160
Mvvv 48,16,100
s_waitcnt lgkmcnt(6)
Ve 9,161
Maav 8,208,96
Ra 248,2,56320
Vc 80,8,9
Maav 8,212,100
VE 10,162
Maav 40,208,104
VE 11,163
Maav 40,212,108
Ra 252,2,64512
Vc 81,10,11
Maav 72,208,112
Ra 192,3,32768
v_or3_b32 v7, v7, v80, v81
Maav 72,212,116
VE 12,176
Maav 104,208,120
VE 13,177
Maav 104,212,124
Ra 196,3,33792
Vc 88,12,13
Maav 12,216,96
VE 14,178
Maav 12,220,100
VE 15,179
Maav 44,216,104
Ra 200,3,34816
Vc 89,14,15
Maav 44,220,108
buffer_load_dwordx4 v4, s[12:15], s39 offen offset:2048 sc1 lds
Maav 76,216,112
Ra 204,3,35840
v_or3_b32 v7, v7, v88, v89
Maav 76,220,116
VE 8,132
Maav 108,216,120
VE 9,133
Maav 108,220,124
VE 10,134
Mvvv 52,16,104
VE 11,135
Mvvv 52,16,108
s_waitcnt lgkmcnt(8)
Ve 12,148
Maav 16,224,96
Ra 208,3,36864
Vc 66,8,9
Maav 16,228,100
Ra 212,3,37888
Vc 67,10,11
Maav 48,224,104
Ra 216,3,38912
v_or3_b32 v7, v7, v66, v67
Maav 48,228,108
VE 13,149
Maav 80,224,112
Ra 220,3,39936
Vc 74,12,13
Maav 80,228,116
VE 14,150
Maav 112,224,120
buffer_load_dwordx4 v4, s[12:15], s39 offen offset:3072 sc1 lds
Maav 112,228,124
s_add_u32 s39, s39, 34816
VE 15,151
Maav 20,232,96
VE 8,164
Maav 20,236,100
VE 9,165
Maav 52,232,104
VE 10,166
Maav 52,236,108
VE 11,167
Maav 84,232,112
Vc 75,14,15
Vc 82,8,9
Maav 84,236,116
VE 12,180
Maav 116,232,120
VE 13,181
Maav 116,236,124
Vc 83,10,11
Vc 90,12,13
Mvvv 56,16,112
VE 14,182
Mvvv 56,16,116
s_waitcnt lgkmcnt(8)
Ve 15,183
Maav 24,240,96
Vc 91,14,15
v_or3_b32 v7, v7, v74, v75
Maav 24,244,100
v_or3_b32 v7, v7, v82, v83
v_or3_b32 v7, v7, v90, v91
Maav 56,240,104
global_load_dword v30, v[28:29], off
Maav 56,244,108
Maav 88,240,112
Maav 88,244,116
Maav 120,240,120
Maav 120,244,124
Maav 28,248,96
Maav 28,252,100
Maav 60,248,104
Maav 60,252,108
Maav 92,248,112
Maav 92,252,116
Maav 124,248,120
Maav 124,252,124
s_cmp_lg_u32 s37, s35
Mvvv 60,16,120
s_waitcnt lgkmcnt(4)
Mvvv 60,16,124
s_cbranch_scc1 L_k2_wloop
L_k2_wlast:
v_xor_b32 v2, 65536, v2
v_xor_b32 v3, 65536, v3
Cvaa 192,192,128,32
s_mov_b32 m0, s53
Ra 224,2,40960
v_lshl_add_u64 v[28:29], s[40:41], 0, v[28:29]
Mvaa 192,196,132
buffer_load_dwordx4 v4, s[12:15], s38 offen offset:0 sc1 lds
Mvaa 192,200,136
VE 8,136
Mvaa 192,204,140
VE 9,137
Cvaa 208,192,144,36
Ra 228,2,41984
Vc 68,8,9
Mvaa 208,196,148
VE 10,138
Mvaa 208,200,152
VE 11,139
Mvaa 208,204,156
Ra 232,2,43008
Vc 69,10,11
Cvaa 224,192,160,40
Ra 236,2,44032
v_or3_b32 v7, v7, v68, v69
Mvaa 224,196,164
VE 12,152
Mvaa 224,200,168
VE 13,153
Mvaa 224,204,172
s_waitcnt lgkmcnt(4)
Ra 240,2,45056
Vc 76,12,13
Cvaa 196,208,128,32
buffer_load_dwordx4 v4, s[12:15], s38 offen offset:1024 sc1 lds
Mvaa 196,212,132
Ve 14,154
Mvaa 196,216,136
VE 15,155
Mvaa 196,220,140
Ra 244,2,46080
Vc 77,14,15
Cvaa 212,208,144,36
Ra 248,2,47104
v_or3_b32 v7, v7, v76, v77
Mvaa 212,212,148
VE 8,168
Mvaa 212,216,152
VE 9,169
Mvaa 212,220,156
Ra 252,2,48128
Vc 84,8,9
Cvaa 228,208,160,40
VE 10,170
Mvaa 228,212,164
buffer_load_dwordx4 v4, s[12:15], s38 offen offset:2048 sc1 lds
Mvaa 228,216,168
VE 11,171
Mvaa 228,220,172
s_waitcnt lgkmcnt(4)
Ra 192,2,16384
Vc 85,10,11
Cvaa 200,224,128,32
Ra 196,2,24576
v_or3_b32 v7, v7, v84, v85
Mvaa 200,228,132
Ve 12,184
Mvaa 200,232,136
VE 13,185
Mvaa 200,236,140
Ra 200,2,17408
Vc 92,12,13
Cvaa 216,224,144,36
VE 14,186
Mvaa 216,228,148
VE 15,187
Mvaa 216,232,152
Ra 204,2,25600
Vc 93,14,15
Mvaa 216,236,156
buffer_load_dwordx4 v4, s[12:15], s38 offen offset:3072 sc1 lds
Cvaa 232,224,160,40
Ra 208,2,18432
v_or3_b32 v7, v7, v92, v93
Mvaa 232,228,164
VE 8,140
Mvaa 232,232,168
VE 9,141
Mvaa 232,236,172
s_waitcnt lgkmcnt(5)
Ra 212,2,26624
Vc 70,8,9
Cvaa 204,240,128,32
Ve 10,142
Mvaa 204,244,132
VE 11,143
Mvaa 204,248,136
Ra 216,2,19456
Vc 71,10,11
Mvaa 204,252,140
Ra 220,2,27648
v_or3_b32 v7, v7, v70, v71
Cvaa 220,240,144,36
VE 12,156
Mvaa 220,244,148
VE 13,157
Mvaa 220,248,152
VE 14,158
Mvaa 220,252,156
s_waitcnt vmcnt(12)
Ve 15,159
Cvaa 236,240,160,40
VE 8,172
Mvaa 236,244,164
s_barrier
Ve 9,173
Mvaa 236,248,168
s_waitcnt lgkmcnt(4)
Vc 78,12,13
Vc 79,14,15
Ve 10,174
Ve 11,175
Ve 12,188
Ve 13,189
Ve 14,190
VE 15,191
Vc 86,8,9
Vc 87,10,11
Vc 94,12,13
Vc 95,14,15
v_or3_b32 v7, v7, v78, v79
v_or3_b32 v7, v7, v86, v87
v_or3_b32 v7, v7, v94, v95
v_and_b32 v1, 0x40004000, v7
v_cmp_ne_u32 vcc, 0, v1
Mvaa 236,252,172
s_cbranch_vccnz L_k2_fb_wl
L_k2_fbr_wl:
Maav 0,192,64
v_cmp_gt_i32 s[56:57], 0, v6
v_cmp_gt_i32 s[58:59], 1, v6
v_cmp_gt_i32 s[60:61], 2, v6
v_cmp_gt_i32 s[62:63], 3, v6
s_nop 3
s_nop 0
v_cndmask_b32 v224, v224, v20, s[56:57]
v_cndmask_b32 v225, v225, v20, s[58:59]
v_cndmask_b32 v226, v226, v20, s[60:61]
v_cndmask_b32 v227, v227, v20, s[62:63]
v_cmp_gt_i32 s[56:57], 16, v6
v_cmp_gt_i32 s[58:59], 17, v6
v_cmp_gt_i32 s[60:61], 18, v6
v_cmp_gt_i32 s[62:63], 19, v6
v_cndmask_b32 v228, v228, v20, s[56:57]
v_cndmask_b32 v229, v229, v20, s[58:59]
v_cndmask_b32 v230, v230, v20, s[60:61]
v_cndmask_b32 v231, v231, v20, s[62:63]
v_cmp_gt_i32 s[56:57], 32, v6
v_cmp_gt_i32 s[58:59], 33, v6
v_cmp_gt_i32 s[60:61], 34, v6
v_cmp_gt_i32 s[62:63], 35, v6
v_cndmask_b32 v232, v232, v20, s[56:57]
v_cndmask_b32 v233, v233, v20, s[58:59]
v_cndmask_b32 v234, v234, v20, s[60:61]
v_cndmask_b32 v235, v235, v20, s[62:63]
v_cmp_gt_i32 s[56:57], 48, v6
v_cmp_gt_i32 s[58:59], 49, v6
v_cmp_gt_i32 s[60:61], 50, v6
v_cmp_gt_i32 s[62:63], 51, v6
v_cndmask_b32 v236, v236, v20, s[56:57]
v_cndmask_b32 v237, v237, v20, s[58:59]
v_cndmask_b32 v238, v238, v20, s[60:61]
v_cndmask_b32 v239, v239, v20, s[62:63]
VE 8,192
Maav 0,196,68
s_add_u32 m0, s54, 49152
VE 9,193
Maav 32,192,72
buffer_load_dwordx4 v4, s[12:15], s39 offen offset:0 sc1 lds
Maav 32,196,76
s_add_u32 s37, s37, 1
Ra 224,2,20480
Vc 96,8,9
Maav 64,192,80
s_add_u32 s38, s38, 34816
Ve 10,194
Maav 64,196,84
VE 11,195
Maav 96,192,88
Ra 228,2,28672
Vc 97,10,11
Maav 96,196,92
buffer_load_dwordx4 v4, s[12:15], s39 offen offset:1024 sc1 lds
Maav 4,200,64
Ra 232,2,21504
v_or_b32_e64 v7, v96, v97
Maav 4,204,68
VE 12,208
Maav 36,200,72
VE 13,209
Maav 36,204,76
Ra 236,2,29696
Vc 104,12,13
Maav 68,200,80
buffer_load_dwordx4 v4, s[12:15], s39 offen offset:2048 sc1 lds
Maav 68,204,84
VE 14,210
Maav 100,200,88
VE 15,211
Maav 100,204,92
Ra 240,2,22528
Vc 105,14,15
Mvvv 48,16,64
Ra 244,2,30720
v_or3_b32 v7, v7, v104, v105
Mvvv 48,16,68
s_waitcnt lgkmcnt(6)
Ve 8,224
Maav 8,208,64
buffer_load_dwordx4 v4, s[12:15], s39 offen offset:3072 sc1 lds
Maav 8,212,68
s_add_u32 s39, s39, 34816
VE 9,225
Maav 40,208,72
Ra 248,2,23552
Vc 112,8,9
Maav 40,212,76
VE 10,226
Maav 72,208,80
global_load_dword v30, v[28:29], off
Maav 72,212,84
VE 11,227
Maav 104,208,88
Ra 252,2,31744
Vc 113,10,11
Maav 104,212,92
Ra 192,3,0
v_or3_b32 v7, v7, v112, v113
Maav 12,216,64
VE 12,196
Maav 12,220,68
s_add_u32 m0, s44, 131072
s_add_u32 s3, s5, 0
Ve 13,197
Maav 44,216,72
buffer_load_dwordx4 v24, s[24:27], s3 offen offset:0 lds
Maav 44,220,76
Ra 196,3,1024
Vc 98,12,13
Maav 76,216,80
VE 14,198
Maav 76,220,84
VE 15,199
Maav 108,216,88
s_add_u32 s3, s5, 27648
Ra 200,3,2048
Vc 99,14,15
Maav 108,220,92
buffer_load_dwordx4 v24, s[24:27], s3 offen offset:1024 lds
Mvvv 52,16,72
Ra 204,3,3072
v_or3_b32 v7, v7, v98, v99
Mvvv 52,16,76
s_waitcnt lgkmcnt(8)
Ve 8,212
Maav 16,224,64
VE 9,213
Maav 16,228,68
s_add_u32 s3, s5, 55296
Ra 208,3,4096
Vc 106,8,9
Maav 48,224,72
buffer_load_dwordx4 v25, s[24:27], s3 offen offset:2048 lds
Maav 48,228,76
VE 10,214
Maav 80,224,80
VE 11,215
Maav 80,228,84
Ra 212,3,5120
Vc 107,10,11
Maav 112,224,88
s_add_u32 s3, s5, 82944
Ra 216,3,6144
v_or3_b32 v7, v7, v106, v107
Maav 112,228,92
buffer_load_dwordx4 v25, s[24:27], s3 offen offset:3072 lds
Maav 20,232,64
VE 12,228
Maav 20,236,68
VE 13,229
Maav 52,232,72
Ra 220,3,7168
Vc 114,12,13
Maav 52,236,76
VE 14,230
Maav 84,232,80
s_add_u32 m0, s44, 147456
s_add_u32 s3, s5, 458752
VE 15,231
Maav 84,236,84
buffer_load_dwordx4 v24, s[24:27], s3 offen offset:0 lds
Maav 116,232,88
VE 8,200
Maav 116,236,92
VE 9,201
Mvvv 56,16,80
VE 10,202
Mvvv 56,16,84
s_waitcnt lgkmcnt(8)
Ve 11,203
Maav 24,240,64
s_add_u32 s3, s5, 486400
Vc 115,14,15
Vc 100,8,9
Maav 24,244,68
buffer_load_dwordx4 v24, s[24:27], s3 offen offset:1024 lds
Maav 56,240,72
VE 12,216
Maav 56,244,76
VE 13,217
Maav 88,240,80
s_add_u32 s3, s5, 514048
Vc 101,10,11
Vc 108,12,13
Maav 88,244,84
buffer_load_dwordx4 v25, s[24:27], s3 offen offset:2048 lds
Maav 120,240,88
VE 14,218
Maav 120,244,92
VE 15,219
Maav 28,248,64
Vc 109,14,15
v_or3_b32 v7, v7, v114, v115
Maav 28,252,68
s_add_u32 s3, s5, 541696
VE 8,232
Maav 60,248,72
buffer_load_dwordx4 v25, s[24:27], s3 offen offset:3072 lds
Maav 60,252,76
VE 9,233
Maav 92,248,80
Vc 116,8,9
v_or3_b32 v7, v7, v100, v101
Maav 92,252,84
VE 10,234
Maav 124,248,88
VE 11,235
Maav 124,252,92
Vc 117,10,11
v_or3_b32 v7, v7, v108, v109
Mvvv 60,16,88
s_waitcnt lgkmcnt(4)
v_or3_b32 v7, v7, v116, v117
Mvvv 60,16,92
Ve 12,204
Cvaa 128,192,128,32
s_add_u32 m0, s53, 32768
VE 13,205
Mvaa 128,196,132
buffer_load_dwordx4 v4, s[12:15], s38 offen offset:0 sc1 lds
Mvaa 128,200,136
Ra 224,3,8192
Vc 102,12,13
Mvaa 128,204,140
VE 14,206
Cvaa 144,192,144,36
VE 15,207
Mvaa 144,196,148
Ra 228,3,9216
Vc 103,14,15
Mvaa 144,200,152
Ra 232,3,10240
v_or3_b32 v7, v7, v102, v103
Mvaa 144,204,156
s_waitcnt lgkmcnt(3)
Ra 236,3,11264
Ra 240,3,12288
Cvaa 132,208,128,32
buffer_load_dwordx4 v4, s[12:15], s38 offen offset:1024 sc1 lds
Mvaa 132,212,132
Ve 8,220
Mvaa 132,216,136
VE 9,221
Mvaa 132,220,140
Ra 244,3,13312
Vc 110,8,9
Cvaa 148,208,144,36
VE 10,222
Mvaa 148,212,148
buffer_load_dwordx4 v4, s[12:15], s38 offen offset:2048 sc1 lds
Mvaa 148,216,152
VE 11,223
Mvaa 148,220,156
s_waitcnt lgkmcnt(2)
Ra 248,3,14336
Ra 252,3,15360
Cvaa 136,224,128,32
Ra 192,2,49152
Vc 111,10,11
Mvaa 136,228,132
Ra 196,2,57344
v_or3_b32 v7, v7, v110, v111
Mvaa 136,232,136
Ve 12,236
Mvaa 136,236,140
buffer_load_dwordx4 v4, s[12:15], s38 offen offset:3072 sc1 lds
Cvaa 152,224,144,36
VE 13,237
Mvaa 152,228,148
Ra 200,2,50176
Vc 118,12,13
Mvaa 152,232,152
VE 14,238
Mvaa 152,236,156
s_waitcnt lgkmcnt(3)
Ra 204,2,58368
Ra 208,2,51200
Cvaa 140,240,128,32
Ve 15,239
Mvaa 140,244,132
Ra 212,2,59392
Vc 119,14,15
Mvaa 140,248,136
Ra 216,2,52224
v_or3_b32 v7, v7, v118, v119
Mvaa 140,252,140
s_waitcnt vmcnt(12)
Ra 220,2,60416
v_and_b32 v1, 0x40004000, v7
Cvaa 156,240,144,36
s_cmp_eq_u32 s37, s45
v_cmp_ne_u32 vcc, 0, v1
Mvaa 156,244,148
s_barrier
Mvaa 156,248,152
s_waitcnt lgkmcnt(4)
Mvaa 156,252,156
s_cbranch_vccnz L_k2_fb_tr
L_k2_fbr_tr:
Maav 0,192,96
s_cbranch_scc1 L_k2_mk_tr
L_k2_mkr_tr:
Ve 8,128
Maav 0,196,100
s_add_u32 m0, s53, 16384
VE 9,129
Maav 32,192,104
buffer_load_dwordx4 v4, s[12:15], s39 offen offset:0 sc1 lds
Maav 32,196,108
s_add_u32 s37, s37, 1
Ra 224,2,53248
Vc 64,8,9
Maav 64,192,112
s_add_u32 s38, s38, 34816
Ve 10,130
Maav 64,196,116
s_xor_b32 s53, s53, 65536
VE 11,131
Maav 4,200,96
s_xor_b32 s54, s54, 65536
Ra 228,2,61440
Vc 65,10,11
Maav 4,204,100
Ra 232,2,54272
v_or_b32_e64 v7, v64, v65
Maav 36,200,104
VE 12,144
Maav 36,204,108
VE 13,145
Maav 68,200,112
Ra 236,2,62464
Vc 72,12,13
Maav 68,204,116
VE 14,146
Mvvv 48,16,96
VE 15,147
Mvvv 48,16,100
s_waitcnt lgkmcnt(4)
Ra 240,2,55296
Vc 73,14,15
Maav 8,208,96
buffer_load_dwordx4 v4, s[12:15], s39 offen offset:1024 sc1 lds
Maav 8,212,100
Ra 244,2,63488
v_or3_b32 v7, v7, v72, v73
Maav 40,208,104
Ve 8,132
Maav 40,212,108
VE 9,133
Maav 72,208,112
Ra 248,2,56320
Vc 66,8,9
Maav 72,212,116
VE 10,134
Maav 12,216,96
VE 11,135
Maav 12,220,100
Ra 252,2,64512
Vc 67,10,11
Maav 44,216,104
Ra 192,3,32768
v_or3_b32 v7, v7, v66, v67
Maav 44,220,108
VE 12,148
Maav 76,216,112
VE 13,149
Maav 76,220,116
Ra 196,3,33792
Vc 74,12,13
Mvvv 52,16,104
VE 14,150
Mvvv 52,16,108
s_waitcnt lgkmcnt(6)
Ve 15,151
Maav 16,224,96
buffer_load_dwordx4 v4, s[12:15], s39 offen offset:2048 sc1 lds
Maav 16,228,100
Ra 200,3,34816
Vc 75,14,15
Maav 48,224,104
Ra 204,3,35840
v_or3_b32 v7, v7, v74, v75
Maav 48,228,108
VE 8,136
Maav 80,224,112
Ra 208,3,36864
Ra 212,3,37888
Maav 80,228,116
Ra 216,3,38912
Ra 220,3,39936
Maav 20,232,96
Maav 20,236,100
Maav 52,232,104
Maav 52,236,108
Maav 84,232,112
Maav 84,236,116
buffer_load_dwordx4 v4, s[12:15], s39 offen offset:3072 sc1 lds
Mvvv 56,16,112
s_add_u32 s39, s39, 34816
Mvvv 56,16,116
s_waitcnt lgkmcnt(8)
Maav 24,240,96
Maav 24,244,100
Maav 56,240,104
Maav 56,244,108
Maav 88,240,112
Maav 88,244,116
Maav 28,248,96
Maav 28,252,100
Maav 60,248,104
Maav 60,252,108
Maav 92,248,112
s_waitcnt lgkmcnt(4)
Maav 92,252,116
s_getpc_b64 s[56:57]
L_cpf4:
s_add_u32 s56, s56, (L_k2_fin-L_cpf4)&0xffffffff
s_addc_u32 s57, s57, ((L_k2_fin-L_cpf4)>>32)&0xffffffff
s_lshr_b32 s58, s2, 3
s_lshl_b32 s58, s58, 2
s_add_u32 s58, s58, s32
s_lshl_b32 s58, s58, 10
v_and_b32 v162, 7, v0
v_lshlrev_b32 v162, 7, v162
v_add_u32 v162, s58, v162
v_min_u32 v162, L_p4_end-L_k2_fin-4, v162
v_mov_b32 v161, s57
v_add_co_u32 v160, vcc, s56, v162
s_nop 1
v_addc_co_u32 v161, vcc, 0, v161, vcc
global_load_dword v164, v[160:161], off
s_waitcnt vmcnt(9)
s_lshl_b32 s3, s34, 20
s_lshl_b32 s47, s33, 15
s_add_u32 s3, s3, s47
s_lshl_b32 s47, s32, 10
v_lshlrev_b32 v248, 4, v0
v_add_u32_e64 v249, s47, v248
s_sub_u32 s47, 7168, s47
v_add_u32 v248, s47, v248
v_rcp_f32 v250, v56
v_rcp_f32 v252, v60
v_mov_b32 v251, v250
v_mov_b32_e64 v253, v252
Ar 240,96
Ar 241,97
Ar 242,98
Ar 243,99
Ar 244,100
Ar 245,101
Ar 246,102
Ar 247,103
v_pk_mul_f32 v[240:241], v[240:241], v[252:253]
v_pk_mul_f32 v[242:243], v[242:243], v[252:253]
v_pk_mul_f32 v[244:245], v[244:245], v[252:253]
v_pk_mul_f32 v[246:247], v[246:247], v[252:253]
Vc 28,240,241
Vc 29,242,243
Vc 30,244,245
Vc 31,246,247
buffer_store_dwordx4 v[28:31], v249, s[16:19], s3 offen sc1
Ar 240,64
Ar 241,65
Ar 242,66
Ar 243,67
Ar 244,68
Ar 245,69
Ar 246,70
Ar 247,71
v_pk_mul_f32 v[240:241], v[240:241], v[250:251]
v_pk_mul_f32 v[242:243], v[242:243], v[250:251]
v_pk_mul_f32 v[244:245], v[244:245], v[250:251]
v_pk_mul_f32 v[246:247], v[246:247], v[250:251]
Vc 24,240,241
Vc 25,242,243
Vc 26,244,245
Vc 27,246,247
buffer_store_dwordx4 v[24:27], v248, s[16:19], s3 offen sc1
s_add_u32 s3, s3, 8192
Ar 240,104
Ar 241,105
Ar 242,106
Ar 243,107
Ar 244,108
Ar 245,109
Ar 246,110
Ar 247,111
v_pk_mul_f32 v[240:241], v[240:241], v[252:253]
v_pk_mul_f32 v[242:243], v[242:243], v[252:253]
v_pk_mul_f32 v[244:245], v[244:245], v[252:253]
v_pk_mul_f32 v[246:247], v[246:247], v[252:253]
Vc 28,240,241
Vc 29,242,243
Vc 30,244,245
Vc 31,246,247
buffer_store_dwordx4 v[28:31], v249, s[16:19], s3 offen sc1
Ar 240,72
Ar 241,73
Ar 242,74
Ar 243,75
Ar 244,76
Ar 245,77
Ar 246,78
Ar 247,79
v_pk_mul_f32 v[240:241], v[240:241], v[250:251]
v_pk_mul_f32 v[242:243], v[242:243], v[250:251]
v_pk_mul_f32 v[244:245], v[244:245], v[250:251]
v_pk_mul_f32 v[246:247], v[246:247], v[250:251]
Vc 24,240,241
Vc 25,242,243
Vc 26,244,245
Vc 27,246,247
buffer_store_dwordx4 v[24:27], v248, s[16:19], s3 offen sc1
s_add_u32 s3, s3, 8192
Ar 240,112
Ar 241,113
Ar 242,114
Ar 243,115
Ar 244,116
Ar 245,117
Ar 246,118
Ar 247,119
v_pk_mul_f32 v[240:241], v[240:241], v[252:253]
v_pk_mul_f32 v[242:243], v[242:243], v[252:253]
v_pk_mul_f32 v[244:245], v[244:245], v[252:253]
v_pk_mul_f32 v[246:247], v[246:247], v[252:253]
Vc 28,240,241
Vc 29,242,243
Vc 30,244,245
Vc 31,246,247
buffer_store_dwordx4 v[28:31], v249, s[16:19], s3 offen sc1
Ar 240,80
Ar 241,81
Ar 242,82
Ar 243,83
Ar 244,84
Ar 245,85
Ar 246,86
Ar 247,87
v_pk_mul_f32 v[240:241], v[240:241], v[250:251]
v_pk_mul_f32 v[242:243], v[242:243], v[250:251]
v_pk_mul_f32 v[244:245], v[244:245], v[250:251]
v_pk_mul_f32 v[246:247], v[246:247], v[250:251]
Vc 24,240,241
Vc 25,242,243
Vc 26,244,245
Vc 27,246,247
buffer_store_dwordx4 v[24:27], v248, s[16:19], s3 offen sc1
s_add_u32 s3, s3, 8192
Ar 240,120
Ar 241,121
Ar 242,122
Ar 243,123
Ar 244,124
Ar 245,125
Ar 246,126
Ar 247,127
v_pk_mul_f32 v[240:241], v[240:241], v[252:253]
v_pk_mul_f32 v[242:243], v[242:243], v[252:253]
v_pk_mul_f32 v[244:245], v[244:245], v[252:253]
v_pk_mul_f32 v[246:247], v[246:247], v[252:253]
Vc 28,240,241
Vc 29,242,243
Vc 30,244,245
Vc 31,246,247
buffer_store_dwordx4 v[28:31], v249, s[16:19], s3 offen sc1
Ar 240,88
Ar 241,89
Ar 242,90
Ar 243,91
Ar 244,92
Ar 245,93
Ar 246,94
Ar 247,95
v_pk_mul_f32 v[240:241], v[240:241], v[250:251]
v_pk_mul_f32 v[242:243], v[242:243], v[250:251]
v_pk_mul_f32 v[244:245], v[244:245], v[250:251]
v_pk_mul_f32 v[246:247], v[246:247], v[250:251]
Vc 24,240,241
Vc 25,242,243
Vc 26,244,245
Vc 27,246,247
buffer_store_dwordx4 v[24:27], v248, s[16:19], s3 offen sc1
s_add_u32 s52, s37, 2
s_load_dwordx2 s[94:95], s[0:1], 40
s_load_dwordx2 s[40:41], s[0:1], 0
s_load_dwordx4 s[8:11], s[0:1], 80
s_waitcnt vmcnt(8) lgkmcnt(0)
s_cmp_eq_u32 s34, 7
s_cbranch_scc1 L_k2_fin
L_k2_nloop:
v_xor_b32 v2, 65536, v2
v_xor_b32 v3, 65536, v3
Cvaa 192,192,128,32
s_mov_b32 m0, s53
Ve 9,137
Mvaa 192,196,132
buffer_load_dwordx4 v4, s[12:15], s38 offen offset:0 sc1 lds
Mvaa 192,200,136
Ra 224,2,40960
Vc 68,8,9
Mvaa 192,204,140
VE 10,138
Cvaa 208,192,144,36
VE 11,139
Mvaa 208,196,148
Ra 228,2,41984
Vc 69,10,11
Mvaa 208,200,152
Ra 232,2,43008
v_or3_b32 v7, v7, v68, v69
Mvaa 208,204,156
s_waitcnt lgkmcnt(3)
Ra 236,2,44032
Ra 240,2,45056
Cvaa 196,208,128,32
buffer_load_dwordx4 v4, s[12:15], s38 offen offset:1024 sc1 lds
Mvaa 196,212,132
Ve 12,152
Mvaa 196,216,136
VE 13,153
Mvaa 196,220,140
Ra 244,2,46080
Vc 76,12,13
Cvaa 212,208,144,36
VE 14,154
Mvaa 212,212,148
buffer_load_dwordx4 v4, s[12:15], s38 offen offset:2048 sc1 lds
Mvaa 212,216,152
VE 15,155
Mvaa 212,220,156
s_waitcnt lgkmcnt(2)
Ra 248,2,47104
Ra 252,2,48128
Cvaa 200,224,128,32
Ra 192,2,16384
Vc 77,14,15
Mvaa 200,228,132
Ra 196,2,24576
v_or3_b32 v7, v7, v76, v77
Mvaa 200,232,136
Ve 8,140
Mvaa 200,236,140
buffer_load_dwordx4 v4, s[12:15], s38 offen offset:3072 sc1 lds
Cvaa 216,224,144,36
VE 9,141
Mvaa 216,228,148
Ra 200,2,17408
Vc 70,8,9
Mvaa 216,232,152
VE 10,142
Mvaa 216,236,156
s_waitcnt lgkmcnt(3)
Ra 204,2,25600
Ra 208,2,18432
Cvaa 204,240,128,32
Ve 11,143
Mvaa 204,244,132
s_cmp_lt_u32 s37, s52
Ra 212,2,26624
Vc 71,10,11
Mvaa 204,248,136
s_cbranch_scc1 L_nw_ne
s_waitcnt vmcnt(12)
L_nw_ne:
Ra 216,2,19456
v_or3_b32 v7, v7, v70, v71
Mvaa 204,252,140
Ve 12,156
Cvaa 220,240,144,36
VE 13,157
Mvaa 220,244,148
s_barrier
Ra 220,2,27648
Vc 78,12,13
Mvaa 220,248,152
s_waitcnt lgkmcnt(4)
Ve 14,158
Ve 15,159
s_nop 0
Vc 79,14,15
v_or3_b32 v7, v7, v78, v79
v_and_b32 v1, 0x40004000, v7
v_cmp_ne_u32 vcc, 0, v1
Mvaa 220,252,156
s_cbranch_vccnz L_k2_fb_ne
L_k2_fbr_ne:
Maav 0,192,64
Ve 8,192
Maav 0,196,68
s_add_u32 m0, s54, 49152
VE 9,193
Maav 32,192,72
buffer_load_dwordx4 v4, s[12:15], s39 offen offset:0 sc1 lds
Maav 32,196,76
s_cmp_eq_u32 s37, s52
Ra 224,2,20480
Vc 96,8,9
Maav 4,200,64
s_cbranch_scc1 L_pubB
L_pubBr:
VE 10,194
Maav 4,204,68
s_add_u32 s37, s37, 1
Ve 11,195
Maav 36,200,72
s_add_u32 s38, s38, 34816
Ra 228,2,28672
Vc 97,10,11
Maav 36,204,76
Ra 232,2,21504
v_or_b32_e64 v7, v96, v97
Mvvv 48,16,64
VE 12,208
Mvvv 48,16,68
s_waitcnt lgkmcnt(3)
Ra 236,2,29696
Ra 240,2,22528
Maav 8,208,64
buffer_load_dwordx4 v4, s[12:15], s39 offen offset:1024 sc1 lds
Maav 8,212,68
Ve 13,209
Maav 40,208,72
Ra 244,2,30720
Vc 104,12,13
Maav 40,212,76
VE 14,210
Maav 12,216,64
VE 15,211
Maav 12,220,68
Ra 248,2,23552
Vc 105,14,15
Maav 44,216,72
Ra 252,2,31744
v_or3_b32 v7, v7, v104, v105
Maav 44,220,76
VE 8,196
Mvvv 52,16,72
buffer_load_dwordx4 v4, s[12:15], s39 offen offset:2048 sc1 lds
Mvvv 52,16,76
s_waitcnt lgkmcnt(4)
Ve 9,197
Maav 16,224,64
Ra 192,3,0
Vc 98,8,9
Maav 16,228,68
VE 10,198
Maav 48,224,72
VE 11,199
Maav 48,228,76
Ra 196,3,1024
Vc 99,10,11
Maav 20,232,64
Ra 200,3,2048
v_or3_b32 v7, v7, v98, v99
Maav 20,236,68
Ra 204,3,3072
Ra 208,3,4096
Maav 52,232,72
buffer_load_dwordx4 v4, s[12:15], s39 offen offset:3072 sc1 lds
Maav 52,236,76
s_waitcnt lgkmcnt(5)
Ve 12,212
Maav 24,240,64
s_add_u32 s39, s39, 34816
VE 13,213
Maav 24,244,68
Ra 212,3,5120
Vc 106,12,13
Maav 56,240,72
VE 14,214
Maav 56,244,76
VE 15,215
Maav 28,248,64
Ra 216,3,6144
Vc 107,14,15
Maav 28,252,68
Ra 220,3,7168
v_or3_b32 v7, v7, v106, v107
Maav 60,248,72
s_waitcnt lgkmcnt(4)
Ve 8,200
Maav 60,252,76
VE 9,201
Cvaa 128,192,128,32
s_add_u32 m0, s53, 32768
Ra 224,3,8192
Vc 100,8,9
Mvaa 128,196,132
buffer_load_dwordx4 v4, s[12:15], s38 offen offset:0 sc1 lds
Mvaa 128,200,136
VE 10,202
Mvaa 128,204,140
VE 11,203
Cvaa 144,192,144,36
Ra 228,3,9216
Vc 101,10,11
Mvaa 144,196,148
Ra 232,3,10240
v_or3_b32 v7, v7, v100, v101
Mvaa 144,200,152
VE 12,216
Mvaa 144,204,156
s_waitcnt lgkmcnt(3)
Ra 236,3,11264
Ra 240,3,12288
Cvaa 132,208,128,32
buffer_load_dwordx4 v4, s[12:15], s38 offen offset:1024 sc1 lds
Mvaa 132,212,132
Ve 13,217
Mvaa 132,216,136
Ra 244,3,13312
Vc 108,12,13
Mvaa 132,220,140
VE 14,218
Cvaa 148,208,144,36
VE 15,219
Mvaa 148,212,148
buffer_load_dwordx4 v4, s[12:15], s38 offen offset:2048 sc1 lds
Mvaa 148,216,152
Ra 248,3,14336
Vc 109,14,15
Mvaa 148,220,156
s_waitcnt lgkmcnt(3)
Ra 252,3,15360
v_or3_b32 v7, v7, v108, v109
Cvaa 136,224,128,32
Ve 8,204
Mvaa 136,228,132
VE 9,205
Mvaa 136,232,136
Ra 192,2,49152
Vc 102,8,9
Mvaa 136,236,140
buffer_load_dwordx4 v4, s[12:15], s38 offen offset:3072 sc1 lds
Cvaa 152,224,144,36
VE 10,206
Mvaa 152,228,148
VE 11,207
Mvaa 152,232,152
Ra 196,2,57344
Vc 103,10,11
Mvaa 152,236,156
s_waitcnt lgkmcnt(2)
Ra 200,2,50176
Ra 204,2,58368
Cvaa 140,240,128,32
Ra 208,2,51200
v_or3_b32 v7, v7, v102, v103
Mvaa 140,244,132
s_cmp_lt_u32 s37, s52
VE 12,220
Mvaa 140,248,136
s_cbranch_scc1 L_nw_no
s_waitcnt vmcnt(12)
L_nw_no:
VE 13,221
Mvaa 140,252,140
Ra 212,2,59392
Vc 110,12,13
Cvaa 156,240,144,36
s_cmp_eq_u32 s37, s45
Ve 14,222
Mvaa 156,244,148
s_barrier
Ve 15,223
Mvaa 156,248,152
s_waitcnt lgkmcnt(2)
Ra 216,2,52224
Vc 111,14,15
v_or3_b32 v7, v7, v110, v111
v_and_b32 v1, 0x40004000, v7
v_cmp_ne_u32 vcc, 0, v1
Mvaa 156,252,156
s_cbranch_vccnz L_k2_fb_no
L_k2_fbr_no:
Ra 220,2,60416
Maav 0,192,96
s_cbranch_scc1 L_k2_mk_no
L_k2_mkr_no:
VE 8,128
Maav 0,196,100
s_add_u32 m0, s53, 16384
VE 9,129
Maav 32,192,104
buffer_load_dwordx4 v4, s[12:15], s39 offen offset:0 sc1 lds
Maav 32,196,108
s_add_u32 s37, s37, 1
Ra 224,2,53248
Vc 64,8,9
Maav 4,200,96
s_add_u32 s38, s38, 34816
Ve 10,130
Maav 4,204,100
s_xor_b32 s53, s53, 65536
VE 11,131
Maav 36,200,104
s_xor_b32 s54, s54, 65536
Ra 228,2,61440
Vc 65,10,11
Maav 36,204,108
Ra 232,2,54272
v_or_b32_e64 v7, v64, v65
Mvvv 48,16,96
VE 12,144
Mvvv 48,16,100
s_waitcnt lgkmcnt(3)
Ra 236,2,62464
Ra 240,2,55296
Maav 8,208,96
buffer_load_dwordx4 v4, s[12:15], s39 offen offset:1024 sc1 lds
Maav 8,212,100
Ve 13,145
Maav 40,208,104
Ra 244,2,63488
Vc 72,12,13
Maav 40,212,108
VE 14,146
Maav 12,216,96
VE 15,147
Maav 12,220,100
Ra 248,2,56320
Vc 73,14,15
Maav 44,216,104
Ra 252,2,64512
v_or3_b32 v7, v7, v72, v73
Maav 44,220,108
VE 8,132
Mvvv 52,16,104
buffer_load_dwordx4 v4, s[12:15], s39 offen offset:2048 sc1 lds
Mvvv 52,16,108
s_waitcnt lgkmcnt(4)
Ve 9,133
Maav 16,224,96
Ra 192,3,32768
Vc 66,8,9
Maav 16,228,100
VE 10,134
Maav 48,224,104
VE 11,135
Maav 48,228,108
Ra 196,3,33792
Vc 67,10,11
Maav 20,232,96
Ra 200,3,34816
v_or3_b32 v7, v7, v66, v67
Maav 20,236,100
Ra 204,3,35840
Ra 208,3,36864
Maav 52,232,104
buffer_load_dwordx4 v4, s[12:15], s39 offen offset:3072 sc1 lds
Maav 52,236,108
s_waitcnt lgkmcnt(5)
Ve 12,148
Maav 24,240,96
s_add_u32 s39, s39, 34816
VE 13,149
Maav 24,244,100
Ra 212,3,37888
Vc 74,12,13
Maav 56,240,104
VE 14,150
Maav 56,244,108
VE 15,151
Maav 28,248,96
Ra 216,3,38912
Vc 75,14,15
Maav 28,252,100
s_cmp_lg_u32 s37, s36
Ra 220,3,39936
v_or3_b32 v7, v7, v74, v75
Maav 60,248,104
s_waitcnt lgkmcnt(4)
VE 8,136
Maav 60,252,108
s_cbranch_scc1 L_k2_nloop
L_k2_fin:
s_getpc_b64 s[56:57]
L_cpf5:
s_add_u32 s56, s56, (L_p4_entry-L_cpf5)&0xffffffff
s_addc_u32 s57, s57, ((L_p4_entry-L_cpf5)>>32)&0xffffffff
s_lshl_b32 s58, s32, 13
v_lshlrev_b32 v162, 7, v0
v_add_u32_e64 v162, s58, v162
v_min_u32 v162, L_p4_end-L_p4_entry-4, v162
v_mov_b32 v161, s57
v_add_co_u32 v160, vcc, s56, v162
s_nop 1
v_addc_co_u32 v161, vcc, 0, v161, vcc
global_load_dword v164, v[160:161], off
v_xor_b32 v2, 65536, v2
v_xor_b32 v3, 65536, v3
s_lshr_b32 s3, s42, 4
s_mul_i32 s3, s3, 33792
s_and_b32 s47, s42, 15
s_lshl_b32 s47, s47, 4
s_add_u32 s3, s3, s47
v_mov_b32 v28, s3
s_lshr_b32 s3, s43, 4
s_mul_i32 s3, s3, 33792
s_and_b32 s47, s43, 15
s_lshl_b32 s47, s47, 4
s_add_u32 s3, s3, s47
v_mov_b32 v29, s3
v_lshrrev_b32 v24, 4, v0
v_and_b32 v25, 15, v0
v_cmp_eq_u32 vcc, 1, v25
s_lshl_b32 s3, s32, 4
v_add_u32 v26, s3, v24
v_cndmask_b32 v28, v28, v29, vcc
v_lshl_add_u32 v28, v24, 8, v28
v_mul_u32_u24 v26, 7168, v26
v_lshlrev_b32 v24, 1, v24
v_xor_b32 v24, v24, v25
v_xor_b32_e64 v25, 8, v24
v_lshl_add_u32 v24, v24, 4, v26
v_lshl_add_u32 v25, v25, 4, v26
s_lshl_b32 s3, s92, 12
buffer_load_dwordx4 a[160:163], v28, s[20:23], s3 offen offset:0 sc1
buffer_load_dwordx4 a[164:167], v28, s[20:23], s3 offen offset:1024 sc1
buffer_load_dwordx4 a[168:171], v28, s[20:23], s3 offen offset:2048 sc1
buffer_load_dwordx4 a[172:175], v28, s[20:23], s3 offen offset:3072 sc1
Cvaa 192,192,128,32
s_add_u32 m0, s54, 0
s_add_u32 s3, s5, 0
Ve 9,137
Mvaa 192,196,132
buffer_load_dwordx4 v24, s[68:71], s3 offen offset:0 lds
Mvaa 192,200,136
Ra 224,2,40960
Ra 228,2,41984
Mvaa 192,204,140
s_waitcnt lgkmcnt(2)
Ra 232,2,43008
Ra 236,2,44032
Cvaa 196,208,128,32
s_add_u32 s3, s5, 27648
Ra 240,2,45056
Vc 68,8,9
Mvaa 196,212,132
buffer_load_dwordx4 v24, s[68:71], s3 offen offset:1024 lds
Mvaa 196,216,136
Ra 244,2,46080
Ra 248,2,47104
Mvaa 196,220,140
s_waitcnt lgkmcnt(3)
s_add_u32 s3, s5, 55296
Ra 252,2,48128
Ra 192,2,16384
Cvaa 200,224,128,32
buffer_load_dwordx4 v25, s[68:71], s3 offen offset:2048 lds
Mvaa 200,228,132
s_cmp_lt_u32 s37, s52
Ve 10,138
Mvaa 200,232,136
s_cbranch_scc1 L_nw_nl
s_waitcnt vmcnt(15)
L_nw_nl:
Ra 196,2,24576
Ra 200,2,17408
Mvaa 200,236,140
s_waitcnt lgkmcnt(3)
s_add_u32 s3, s5, 82944
Ra 204,2,25600
Ra 208,2,18432
Cvaa 204,240,128,32
buffer_load_dwordx4 v25, s[68:71], s3 offen offset:3072 lds
Mvaa 204,244,132
s_barrier
VE 11,139
Mvaa 204,248,136
s_waitcnt lgkmcnt(1)
Ra 212,2,26624
Vc 69,10,11
Ve 12,152
Ve 13,153
Ve 14,154
Ve 15,155
Ve 8,140
Ve 9,141
Ve 10,142
VE 11,143
Vc 76,12,13
Ve 12,156
Ve 13,157
Vc 77,14,15
Ve 14,158
Ve 15,159
Vc 70,8,9
Vc 71,10,11
Vc 78,12,13
Vc 79,14,15
v_or3_b32 v7, v7, v68, v69
v_or3_b32 v7, v7, v76, v77
v_or3_b32 v7, v7, v70, v71
v_or3_b32 v7, v7, v78, v79
v_and_b32 v1, 0x40004000, v7
v_cmp_ne_u32 vcc, 0, v1
Mvaa 204,252,140
s_cbranch_vccnz L_k2_fb_nl
L_k2_fbr_nl:
Ra 216,2,19456
Ra 220,2,27648
Maav 0,192,64
v_cmp_gt_i32 s[56:57], 0, v6
v_cmp_gt_i32 s[58:59], 1, v6
v_cmp_gt_i32 s[60:61], 2, v6
v_cmp_gt_i32 s[62:63], 3, v6
s_nop 3
s_nop 0
v_cndmask_b32 v192, v192, v20, s[56:57]
v_cndmask_b32 v193, v193, v20, s[58:59]
v_cndmask_b32 v194, v194, v20, s[60:61]
v_cndmask_b32 v195, v195, v20, s[62:63]
v_cmp_gt_i32 s[56:57], 16, v6
v_cmp_gt_i32 s[58:59], 17, v6
v_cmp_gt_i32 s[60:61], 18, v6
v_cmp_gt_i32 s[62:63], 19, v6
v_cndmask_b32 v196, v196, v20, s[56:57]
v_cndmask_b32 v197, v197, v20, s[58:59]
v_cndmask_b32 v198, v198, v20, s[60:61]
v_cndmask_b32 v199, v199, v20, s[62:63]
v_cmp_gt_i32 s[56:57], 32, v6
v_cmp_gt_i32 s[58:59], 33, v6
v_cmp_gt_i32 s[60:61], 34, v6
v_cmp_gt_i32 s[62:63], 35, v6
v_cndmask_b32 v200, v200, v20, s[56:57]
v_cndmask_b32 v201, v201, v20, s[58:59]
v_cndmask_b32 v202, v202, v20, s[60:61]
v_cndmask_b32 v203, v203, v20, s[62:63]
v_cmp_gt_i32 s[56:57], 48, v6
v_cmp_gt_i32 s[58:59], 49, v6
v_cmp_gt_i32 s[60:61], 50, v6
v_cmp_gt_i32 s[62:63], 51, v6
v_cndmask_b32 v204, v204, v20, s[56:57]
v_cndmask_b32 v205, v205, v20, s[58:59]
v_cndmask_b32 v206, v206, v20, s[60:61]
v_cndmask_b32 v207, v207, v20, s[62:63]
VE 8,192
Maav 0,196,68
s_add_u32 m0, s54, 16384
s_add_u32 s3, s5, 458752
VE 9,193
Maav 32,192,72
buffer_load_dwordx4 v24, s[68:71], s3 offen offset:0 lds
Maav 32,196,76
s_mov_b32 s60, s8
Ra 224,2,20480
Vc 96,8,9
Maav 4,200,64
s_and_b32 s61, s9, 0xffff
s_mov_b32 s62, 7340032
Ve 10,194
Maav 4,204,68
s_mov_b32 s63, 0x20000
s_mov_b32 s56, s40
Ve 11,195
Maav 36,200,72
s_and_b32 s57, s41, 0xffff
Ra 228,2,28672
Vc 97,10,11
Maav 36,204,76
s_mov_b32 s58, 4194304
Ra 232,2,21504
v_or_b32_e64 v7, v96, v97
Mvvv 48,16,64
s_mov_b32 s59, 0x20000
s_bfe_u32 s6, s2, 0x20001
VE 12,196
Mvvv 48,16,68
s_waitcnt lgkmcnt(3)
s_add_u32 s3, s5, 486400
Ra 236,2,29696
Ra 240,2,22528
Maav 8,208,64
buffer_load_dwordx4 v24, s[68:71], s3 offen offset:1024 lds
Maav 8,212,68
s_lshr_b32 s7, s34, 1
s_xor_b32 s7, s7, 2
Ve 13,197
Maav 40,208,72
s_lshl_b32 s45, s7, 2
Ra 244,2,30720
Vc 98,12,13
Maav 40,212,76
s_add_u32 s46, s45, s6
s_sub_u32 s46, 15, s46
Ve 14,198
Maav 12,216,64
s_sub_u32 s45, 12, s45
s_add_u32 s45, s45, s6
VE 15,199
Maav 12,220,68
s_cmp_lt_u32 s7, 2
s_cselect_b32 s45, s46, s45
Ra 248,2,23552
Vc 99,14,15
Maav 44,216,72
s_and_b32 s46, s2, 1
Ra 252,2,31744
v_or3_b32 v7, v7, v98, v99
Maav 44,220,76
s_add_u32 s3, s5, 514048
Ve 8,200
Mvvv 52,16,72
buffer_load_dwordx4 v25, s[68:71], s3 offen offset:2048 lds
Mvvv 52,16,76
s_waitcnt lgkmcnt(4)
Ve 9,201
Maav 16,224,64
s_bfe_u32 s6, s2, 0x30003
Ra 192,2,49152
Vc 100,8,9
Maav 16,228,68
s_lshl_b32 s6, s6, 1
s_add_u32 s46, s46, s6
VE 10,202
Maav 48,224,72
s_mov_b32 s48, 0
s_mov_b32 s49, 15360
Ve 11,203
Maav 48,228,76
s_mov_b32 s50, 30720
Ra 196,2,57344
Vc 101,10,11
Maav 20,232,64
s_mov_b32 s51, 46080
Ra 200,2,50176
v_or3_b32 v7, v7, v100, v101
Maav 20,236,68
s_add_u32 s3, s5, 541696
Ra 204,2,58368
Ra 208,2,51200
Maav 52,232,72
buffer_load_dwordx4 v25, s[68:71], s3 offen offset:3072 lds
Maav 52,236,76
s_waitcnt lgkmcnt(5)
Ve 12,204
Maav 24,240,64
s_lshl_b32 s35, s32, 13
s_add_u32 s35, s35, 131072
Ve 13,205
Maav 24,244,68
s_and_b32 s52, s46, 1
Ra 212,2,59392
Vc 102,12,13
Maav 56,240,72
s_lshl_b32 s37, s45, 20
s_lshl_b32 s7, s52, 19
Ve 14,206
Maav 56,244,76
s_add_u32 s37, s37, s7
s_add_u32 s37, s37, 46137344
Ve 15,207
Maav 28,248,64
s_lshr_b32 s7, s46, 1
Ra 216,2,52224
Vc 103,14,15
Maav 28,252,68
s_lshl_b32 s7, s7, 8
Ra 220,2,60416
v_or3_b32 v7, v7, v102, v103
Maav 60,248,72
s_waitcnt lgkmcnt(4)
Maav 60,252,76
s_lshl_b32 s6, s52, 22
s_add_u32 s6, s6, s7
v_and_b32 v1, 0x40004000, v7
v_cmp_ne_u32 vcc, 0, v1
s_cbranch_vccnz L_k2_fb_fi
L_k2_fbr_fi:
Maav 0,192,96
Ra 224,2,53248
Ra 228,2,61440
Maav 0,196,100
Ra 232,2,54272
Ra 236,2,62464
Maav 4,200,96
Ra 240,2,55296
Ra 244,2,63488
Maav 4,204,100
Ra 248,2,56320
Ra 252,2,64512
Mvvv 48,16,96
s_add_u32 s12, s94, s6
s_addc_u32 s13, s95, 0
s_and_b32 s13, s13, 0xffff
Mvvv 48,16,100
s_waitcnt lgkmcnt(8)
Maav 8,208,96
s_mov_b32 s14, 0
s_mov_b32 s15, 0x20000
s_sub_u32 s14, 4194304, s7
Maav 8,212,100
s_mov_b32 s28, s94
s_and_b32 s29, s95, 0xffff
s_mov_b32 s30, 8388608
Maav 12,216,96
s_mov_b32 s31, 0x20000
s_lshl_b32 s7, s46, 7
s_lshl_b32 s36, s45, 18
Maav 12,220,100
s_waitcnt lgkmcnt(4)
Maav 16,224,96
s_add_u32 s36, s36, s7
s_and_b32 s94, s7, 128
s_lshl_b32 s38, s45, 7
Maav 16,228,100
s_lshl_b32 s6, s52, 6
s_add_u32 s38, s38, s6
s_add_u32 s38, s38, 5300224
Maav 20,232,96
s_lshl_b32 s52, s32, 11
s_lshl_b32 s6, s32, 16
s_add_u32 s6, s6, s94
Maav 20,236,100
s_waitcnt lgkmcnt(0)
Maav 24,240,96
s_xor_b32 s6, s6, 128
s_lshl_b32 s7, s32, 5
s_mov_b32 s68, s10
Maav 24,244,100
s_and_b32 s69, s11, 0xffff
s_mov_b32 s70, 4194304
s_mov_b32 s71, 0x20000
s_add_u32 s8, s66, s37
s_addc_u32 s9, s67, 0
s_and_b32 s9, s9, 0xffff
Maav 28,248,96
s_mov_b32 s10, 524288
s_mov_b32 s11, 0x20000
v_lshlrev_b32 v112, 4, v0
v_lshrrev_b32_e64 v121, 4, v0
Maav 28,252,100
v_and_b32 v122, 7, v0
v_lshrrev_b32 v123, 3, v0
v_lshlrev_b32 v124, 1, v121
s_nop 7
s_lshl_b32 s3, s55, 20
s_lshl_b32 s47, s33, 15
s_add_u32 s3, s3, s47
s_lshl_b32 s47, s32, 10
v_lshlrev_b32 v248, 4, v0
v_add_u32 v249, s47, v248
s_sub_u32 s47, 7168, s47
v_add_u32 v248, s47, v248
v_rcp_f32 v250, v48
v_rcp_f32 v252, v52
v_mov_b32 v251, v250
v_mov_b32_e64 v253, v252
Ar 240,32
Ar 241,33
Ar 242,34
Ar 243,35
Ar 244,36
Ar 245,37
Ar 246,38
Ar 247,39
v_pk_mul_f32 v[240:241], v[240:241], v[252:253]
v_pk_mul_f32 v[242:243], v[242:243], v[252:253]
v_pk_mul_f32 v[244:245], v[244:245], v[252:253]
v_pk_mul_f32 v[246:247], v[246:247], v[252:253]
Vc 28,240,241
Vc 29,242,243
Vc 30,244,245
Vc 31,246,247
buffer_store_dwordx4 v[28:31], v249, s[16:19], s3 offen sc1
Ar 240,0
Ar 241,1
Ar 242,2
Ar 243,3
Ar 244,4
Ar 245,5
Ar 246,6
Ar 247,7
v_pk_mul_f32 v[240:241], v[240:241], v[250:251]
v_pk_mul_f32 v[242:243], v[242:243], v[250:251]
v_pk_mul_f32 v[244:245], v[244:245], v[250:251]
v_pk_mul_f32 v[246:247], v[246:247], v[250:251]
Vc 24,240,241
Vc 25,242,243
Vc 26,244,245
Vc 27,246,247
buffer_store_dwordx4 v[24:27], v248, s[16:19], s3 offen sc1
s_add_u32 s3, s3, 8192
Ar 240,40
Ar 241,41
Ar 242,42
Ar 243,43
Ar 244,44
Ar 245,45
Ar 246,46
Ar 247,47
v_pk_mul_f32 v[240:241], v[240:241], v[252:253]
v_pk_mul_f32 v[242:243], v[242:243], v[252:253]
v_pk_mul_f32 v[244:245], v[244:245], v[252:253]
v_pk_mul_f32 v[246:247], v[246:247], v[252:253]
Vc 28,240,241
Vc 29,242,243
Vc 30,244,245
Vc 31,246,247
buffer_store_dwordx4 v[28:31], v249, s[16:19], s3 offen sc1
Ar 240,8
Ar 241,9
Ar 242,10
Ar 243,11
Ar 244,12
Ar 245,13
Ar 246,14
Ar 247,15
v_pk_mul_f32 v[240:241], v[240:241], v[250:251]
v_pk_mul_f32 v[242:243], v[242:243], v[250:251]
v_pk_mul_f32 v[244:245], v[244:245], v[250:251]
v_pk_mul_f32 v[246:247], v[246:247], v[250:251]
Vc 24,240,241
Vc 25,242,243
Vc 26,244,245
Vc 27,246,247
buffer_store_dwordx4 v[24:27], v248, s[16:19], s3 offen sc1
s_add_u32 s3, s3, 8192
Ar 240,48
Ar 241,49
Ar 242,50
Ar 243,51
Ar 244,52
Ar 245,53
Ar 246,54
Ar 247,55
v_pk_mul_f32 v[240:241], v[240:241], v[252:253]
v_pk_mul_f32 v[242:243], v[242:243], v[252:253]
v_pk_mul_f32 v[244:245], v[244:245], v[252:253]
v_pk_mul_f32 v[246:247], v[246:247], v[252:253]
Vc 28,240,241
Vc 29,242,243
Vc 30,244,245
Vc 31,246,247
buffer_store_dwordx4 v[28:31], v249, s[16:19], s3 offen sc1
Ar 240,16
Ar 241,17
Ar 242,18
Ar 243,19
Ar 244,20
Ar 245,21
Ar 246,22
Ar 247,23
v_pk_mul_f32 v[240:241], v[240:241], v[250:251]
v_pk_mul_f32 v[242:243], v[242:243], v[250:251]
v_pk_mul_f32 v[244:245], v[244:245], v[250:251]
v_pk_mul_f32 v[246:247], v[246:247], v[250:251]
Vc 24,240,241
Vc 25,242,243
Vc 26,244,245
Vc 27,246,247
buffer_store_dwordx4 v[24:27], v248, s[16:19], s3 offen sc1
s_add_u32 s3, s3, 8192
Ar 240,56
Ar 241,57
Ar 242,58
Ar 243,59
Ar 244,60
Ar 245,61
Ar 246,62
Ar 247,63
v_pk_mul_f32 v[240:241], v[240:241], v[252:253]
v_pk_mul_f32 v[242:243], v[242:243], v[252:253]
v_pk_mul_f32 v[244:245], v[244:245], v[252:253]
v_pk_mul_f32 v[246:247], v[246:247], v[252:253]
Vc 28,240,241
Vc 29,242,243
Vc 30,244,245
Vc 31,246,247
buffer_store_dwordx4 v[28:31], v249, s[16:19], s3 offen sc1
Ar 240,24
Ar 241,25
Ar 242,26
Ar 243,27
Ar 244,28
Ar 245,29
Ar 246,30
Ar 247,31
v_pk_mul_f32 v[240:241], v[240:241], v[250:251]
v_pk_mul_f32 v[242:243], v[242:243], v[250:251]
v_pk_mul_f32 v[244:245], v[244:245], v[250:251]
v_pk_mul_f32 v[246:247], v[246:247], v[250:251]
Vc 24,240,241
Vc 25,242,243
Vc 26,244,245
Vc 27,246,247
buffer_store_dwordx4 v[24:27], v248, s[16:19], s3 offen sc1
s_cmp_lt_u32 s34, 1
s_cbranch_scc1 L_noffn
v_lshrrev_b32_e64 v24, 4, v0
v_bfe_u32 v25, v0, 2, 2
v_lshl_add_u32 v26, v24, 3, v25
v_lshlrev_b32 v26, 8, v26
v_and_b32 v27, 3, v0
v_lshl_add_u32 v26, v27, 3, v26
v_and_b32_e64 v27, 1, v24
v_lshl_add_u32 v25, v27, 2, v25
s_lshl_b32 s3, s32, 1
v_xor_b32 v25, s3, v25
v_lshl_add_u32 v26, v25, 5, v26
s_sub_u32 s3, s54, s44
v_add_u32 v30, s3, v26
v_xor_b32_e64 v31, 32, v30
v_add_u32 v26, 131072, v26
v_xor_b32 v27, 32, v26
s_waitcnt vmcnt(8) lgkmcnt(0)
s_barrier
s_nop 0
ds_read_b64_tr_b16 v[128:129], v26 offset:0
ds_read_b64_tr_b16 v[130:131], v26 offset:1024
ds_read_b64_tr_b16 v[132:133], v27 offset:0
ds_read_b64_tr_b16 v[134:135], v27 offset:1024
ds_read_b64_tr_b16 v[136:137], v26 offset:8192
ds_read_b64_tr_b16 v[138:139], v26 offset:9216
ds_read_b64_tr_b16 v[140:141], v27 offset:8192
ds_read_b64_tr_b16 v[142:143], v27 offset:9216
ds_read_b64_tr_b16 v[144:145], v26 offset:16384
ds_read_b64_tr_b16 v[146:147], v26 offset:17408
ds_read_b64_tr_b16 v[148:149], v27 offset:16384
ds_read_b64_tr_b16 v[150:151], v27 offset:17408
ds_read_b64_tr_b16 v[152:153], v26 offset:24576
ds_read_b64_tr_b16 v[154:155], v26 offset:25600
ds_read_b64_tr_b16 v[156:157], v27 offset:24576
s_waitcnt lgkmcnt(9)
s_nop 0
ds_read_b64_tr_b16 v[158:159], v27 offset:25600
ds_read_b64_tr_b16 v[160:161], v30 offset:0
ds_read_b64_tr_b16 v[162:163], v30 offset:1024
ds_read_b64_tr_b16 v[164:165], v31 offset:0
ds_read_b64_tr_b16 v[166:167], v31 offset:1024
ds_read_b64_tr_b16 v[168:169], v30 offset:8192
s_waitcnt lgkmcnt(9)
s_nop 0
ds_read_b64_tr_b16 v[170:171], v30 offset:9216
ds_read_b64_tr_b16 v[172:173], v31 offset:8192
ds_read_b64_tr_b16 v[174:175], v31 offset:9216
ds_read_b64_tr_b16 v[176:177], v30 offset:16384
ds_read_b64_tr_b16 v[178:179], v30 offset:17408
ds_read_b64_tr_b16 v[180:181], v31 offset:16384
s_waitcnt lgkmcnt(9)
ds_read_b64_tr_b16 v[182:183], v31 offset:17408
ds_read_b64_tr_b16 v[184:185], v30 offset:24576
ds_read_b64_tr_b16 v[186:187], v30 offset:25600
ds_read_b64_tr_b16 v[188:189], v31 offset:24576
ds_read_b64_tr_b16 v[190:191], v31 offset:25600
v_and_b32 v25, 15, v0
v_mul_u32_u24 v28, 14336, v25
v_lshl_add_u32 v28, v24, 4, v28
v_mov_b32 v29, 2146435072
v_cmp_gt_u32 vcc, 2, v25
s_mul_i32 s3, s92, 57344
s_lshl_b32 s47, s4, 9
s_add_u32 s3, s3, s47
v_cndmask_b32 v28, v29, v28, vcc
s_lshl_b32 s47, s32, 7
s_add_u32 s3, s3, s47
s_add_u32 s3, s3, 6291456
Zvva 224,128,160
Zvva 228,132,160
Mvva 224,136,164
Mvva 228,140,164
Mvva 224,144,168
Mvva 228,148,168
Mvva 224,152,172
Mvva 228,156,172
s_waitcnt lgkmcnt(0)
Zvva 232,160,160
Zvva 236,164,160
Mvva 232,168,164
Mvva 236,172,164
Mvva 232,176,168
Mvva 236,180,168
Mvva 232,184,172
Mvva 236,188,172
L_noffn:
v_xor_b32 v124, v124, v122
v_lshlrev_b32_e64 v124, 4, v124
v_lshl_add_u32 v113, v123, 11, v124
v_add_u32 v114, s6, v113
v_lshrrev_b32 v124, 2, v0
v_bfe_u32 v126, v0, 3, 2
v_lshlrev_b32 v124, 7, v124
v_and_b32 v125, 3, v0
v_lshl_add_u32 v124, v125, 3, v124
v_lshl_add_u32 v115, v126, 5, v124
v_xor_b32 v116, 32, v115
v_xor_b32 v117, 64, v115
v_xor_b32 v118, 96, v115
v_add_u32 v120, s7, v123
v_lshlrev_b32 v119, 11, v120
v_lshl_add_u32 v119, v122, 4, v119
v_mov_b32 v126, 0
v_lshlrev_b32 v127, 2, v122
v_mov_b32 v24, 1
v_mul_u32_u24 v25, s65, v0
s_waitcnt vmcnt(0)
s_barrier
s_mov_b64 exec, 3
buffer_store_dword v24, v25, s[20:23], s64 offen sc1
s_mov_b64 exec, -1
L_p4_entry:
s_cmp_ge_u32 s34, 1
s_nop 0
s_cselect_b32 s3, s3, 8388608
s_add_u32 s7, s3, 28672
buffer_store_dwordx4 v[224:227], v28, s[20:23], s3 offen offset:0 sc1
buffer_store_dwordx4 v[228:231], v28, s[20:23], s3 offen offset:64 sc1
buffer_store_dwordx4 v[232:235], v28, s[20:23], s7 offen offset:0 sc1
buffer_store_dwordx4 v[236:239], v28, s[20:23], s7 offen offset:64 sc1
s_lshl_b32 s33, s4, 3
s_add_u32 s33, s33, s92
s_mov_b32 s65, s33
s_mov_b32 s3, s36
buffer_load_dwordx4 v[18:21], v119, s[56:59], s3 offen
s_add_u32 s3, s3, 16384
buffer_load_dwordx4 v[22:25], v119, s[56:59], s3 offen
s_add_u32 s3, s3, 16384
buffer_load_dwordx4 v[26:29], v119, s[56:59], s3 offen
s_add_u32 s3, s3, 16384
buffer_load_dwordx4 v[30:33], v119, s[56:59], s3 offen
s_lshl_b32 s3, s45, 10
s_add_u32 s3, s3, 5259264
v_lshlrev_b32 v124, 3, v120
buffer_load_dwordx2 v[34:35], v124, s[20:23], s3 offen offset:0 sc1
buffer_load_dwordx2 v[36:37], v124, s[20:23], s3 offen offset:64 sc1
buffer_load_dwordx2 v[38:39], v124, s[20:23], s3 offen offset:128 sc1
buffer_load_dwordx2 v[40:41], v124, s[20:23], s3 offen offset:192 sc1
v_and_b32 v10, 15, v0
v_lshlrev_b32 v10, 2, v10
s_add_u32 s95, s32, 32
s_lshl_b32 s95, s95, 16
s_add_u32 s95, s95, s94
s_xor_b32 s95, s95, 128
s_add_u32 m0, s44, 0
s_nop 0
s_nop 0
buffer_load_dwordx4 v114, s[12:15], s48 offen offset:0 lds
buffer_load_dwordx4 v114, s[12:15], s49 offen offset:1024 lds
buffer_load_dwordx4 v114, s[12:15], s50 offen offset:2048 lds
buffer_load_dwordx4 v114, s[12:15], s51 offen offset:3072 lds
v_xor_b32 v114, 128, v114
s_add_u32 m0, s44, 16384
s_nop 0
s_nop 0
buffer_load_dwordx4 v114, s[12:15], s48 offen offset:0 lds
buffer_load_dwordx4 v114, s[12:15], s49 offen offset:1024 lds
buffer_load_dwordx4 v114, s[12:15], s50 offen offset:2048 lds
buffer_load_dwordx4 v114, s[12:15], s51 offen offset:3072 lds
v_xor_b32 v114, 128, v114
v_add_u32 v114, 262144, v114
buffer_load_dword v124, v10, s[20:23], s38 offen sc1
v_add_u32 v12, 65536, v115
v_add_u32 v13, 65536, v116
v_add_u32 v14, 65536, v117
v_add_u32 v15, 65536, v118
s_and_b32 s39, s93, 15
s_lshr_b32 s37, s93, 4
s_lshl_b32 s54, s37, 2
s_add_u32 s54, s54, s32
s_lshl_b32 s3, s54, 17
s_lshl_b32 s7, s39, 7
s_add_u32 s3, s3, s7
s_cmp_lt_u32 s93, 224
s_cselect_b32 s3, s3, 2146435072
v_add_u32 v125, s3, v113
s_mov_b32 s40, 0
s_waitcnt vmcnt(9)
v_lshlrev_b32_e64 v42, 16, v18
v_and_b32 v43, 0xffff0000, v18
v_lshlrev_b32_e64 v44, 16, v19
v_and_b32 v45, 0xffff0000, v19
v_lshlrev_b32_e64 v46, 16, v20
v_and_b32 v47, 0xffff0000, v20
v_lshlrev_b32_e64 v48, 16, v21
v_and_b32 v49, 0xffff0000, v21
v_pk_add_f32 v[42:43], v[42:43], v[34:35] op_sel_hi:[1,0] neg_lo:[0,1] neg_hi:[0,1]
v_pk_add_f32 v[44:45], v[44:45], v[34:35] op_sel_hi:[1,0] neg_lo:[0,1] neg_hi:[0,1]
v_pk_add_f32 v[46:47], v[46:47], v[34:35] op_sel_hi:[1,0] neg_lo:[0,1] neg_hi:[0,1]
v_pk_add_f32 v[48:49], v[48:49], v[34:35] op_sel_hi:[1,0] neg_lo:[0,1] neg_hi:[0,1]
Vc 2,42,43
v_lshlrev_b32_e64 v42, 16, v2
v_and_b32 v43, 0xffff0000, v2
Vc 3,44,45
v_lshlrev_b32_e64 v44, 16, v3
v_and_b32 v45, 0xffff0000, v3
Vc 4,46,47
v_lshlrev_b32_e64 v46, 16, v4
v_and_b32 v47, 0xffff0000, v4
Vc 5,48,49
v_lshlrev_b32_e64 v48, 16, v5
v_and_b32 v49, 0xffff0000, v5
v_pk_mul_f32 v[42:43], v[42:43], v[34:35] op_sel:[0,1] op_sel_hi:[1,1]
v_pk_mul_f32 v[44:45], v[44:45], v[34:35] op_sel:[0,1] op_sel_hi:[1,1]
v_pk_mul_f32 v[46:47], v[46:47], v[34:35] op_sel:[0,1] op_sel_hi:[1,1]
v_pk_mul_f32 v[48:49], v[48:49], v[34:35] op_sel:[0,1] op_sel_hi:[1,1]
Vc 2,42,43
v_lshlrev_b32_e64 v42, 16, v2
v_and_b32 v43, 0xffff0000, v2
Vc 3,44,45
v_lshlrev_b32_e64 v44, 16, v3
v_and_b32 v45, 0xffff0000, v3
Vc 4,46,47
v_lshlrev_b32_e64 v46, 16, v4
v_and_b32 v47, 0xffff0000, v4
Vc 5,48,49
v_lshlrev_b32_e64 v48, 16, v5
v_and_b32 v49, 0xffff0000, v5
v_mul_f32 v2, 0xbfb8aa3b, v42
v_mul_f32 v3, 0xbfb8aa3b, v43
v_mul_f32 v4, 0xbfb8aa3b, v44
v_mul_f32 v5, 0xbfb8aa3b, v45
v_mul_f32 v6, 0xbfb8aa3b, v46
v_mul_f32 v7, 0xbfb8aa3b, v47
v_mul_f32 v8, 0xbfb8aa3b, v48
v_mul_f32 v9, 0xbfb8aa3b, v49
Ve 2,2
Ve 3,3
Ve 4,4
Ve 5,5
Ve 6,6
Ve 7,7
Ve 8,8
Ve 9,9
v_add_f32 v2, 1.0, v2
v_add_f32 v3, 1.0, v3
v_add_f32 v4, 1.0, v4
v_add_f32 v5, 1.0, v5
v_add_f32 v6, 1.0, v6
v_add_f32 v7, 1.0, v7
v_add_f32 v8, 1.0, v8
v_add_f32 v9, 1.0, v9
v_rcp_f32 v2, v2
v_rcp_f32 v3, v3
v_rcp_f32 v4, v4
v_rcp_f32 v5, v5
v_rcp_f32 v6, v6
v_rcp_f32 v7, v7
v_rcp_f32 v8, v8
v_rcp_f32 v9, v9
v_pk_mul_f32 v[42:43], v[42:43], v[2:3]
v_pk_mul_f32 v[44:45], v[44:45], v[4:5]
v_pk_mul_f32 v[46:47], v[46:47], v[6:7]
v_pk_mul_f32 v[48:49], v[48:49], v[8:9]
Vc 2,42,43
v_lshlrev_b32_e64 v42, 16, v2
v_and_b32 v43, 0xffff0000, v2
Vc 3,44,45
v_lshlrev_b32_e64 v44, 16, v3
v_and_b32 v45, 0xffff0000, v3
Vc 4,46,47
v_lshlrev_b32_e64 v46, 16, v4
v_and_b32 v47, 0xffff0000, v4
Vc 5,48,49
v_lshlrev_b32_e64 v48, 16, v5
v_and_b32 v49, 0xffff0000, v5
s_waitcnt vmcnt(0)
v_cmp_ne_u32 vcc, 1, v124
s_cbranch_vccnz L_spinC
s_nop 0
L_spinCr:
buffer_load_dwordx4 a[0:3], v112, s[8:11], s52 offen offset:0 sc1
buffer_load_dwordx4 a[4:7], v112, s[8:11], s52 offen offset:1024 sc1
s_add_u32 s52, s52, 8192
buffer_load_dwordx4 a[8:11], v112, s[8:11], s52 offen offset:0 sc1
buffer_load_dwordx4 a[12:15], v112, s[8:11], s52 offen offset:1024 sc1
s_add_u32 s52, s52, 8192
buffer_load_dwordx4 a[16:19], v112, s[8:11], s52 offen offset:0 sc1
buffer_load_dwordx4 a[20:23], v112, s[8:11], s52 offen offset:1024 sc1
s_add_u32 s52, s52, 8192
buffer_load_dwordx4 a[24:27], v112, s[8:11], s52 offen offset:0 sc1
buffer_load_dwordx4 a[28:31], v112, s[8:11], s52 offen offset:1024 sc1
s_add_u32 s52, s52, 8192
buffer_load_dwordx4 a[32:35], v112, s[8:11], s52 offen offset:0 sc1
buffer_load_dwordx4 a[36:39], v112, s[8:11], s52 offen offset:1024 sc1
s_add_u32 s52, s52, 8192
buffer_load_dwordx4 a[40:43], v112, s[8:11], s52 offen offset:0 sc1
buffer_load_dwordx4 a[44:47], v112, s[8:11], s52 offen offset:1024 sc1
s_add_u32 s52, s52, 8192
v_lshlrev_b32_e64 v50, 16, v22
v_and_b32 v51, 0xffff0000, v22
v_lshlrev_b32_e64 v52, 16, v23
v_and_b32 v53, 0xffff0000, v23
v_lshlrev_b32_e64 v54, 16, v24
v_and_b32 v55, 0xffff0000, v24
v_lshlrev_b32_e64 v56, 16, v25
v_and_b32 v57, 0xffff0000, v25
v_pk_add_f32 v[50:51], v[50:51], v[36:37] op_sel_hi:[1,0] neg_lo:[0,1] neg_hi:[0,1]
v_pk_add_f32 v[52:53], v[52:53], v[36:37] op_sel_hi:[1,0] neg_lo:[0,1] neg_hi:[0,1]
v_pk_add_f32 v[54:55], v[54:55], v[36:37] op_sel_hi:[1,0] neg_lo:[0,1] neg_hi:[0,1]
v_pk_add_f32 v[56:57], v[56:57], v[36:37] op_sel_hi:[1,0] neg_lo:[0,1] neg_hi:[0,1]
Vc 2,50,51
v_lshlrev_b32_e64 v50, 16, v2
v_and_b32 v51, 0xffff0000, v2
Vc 3,52,53
v_lshlrev_b32_e64 v52, 16, v3
v_and_b32 v53, 0xffff0000, v3
Vc 4,54,55
v_lshlrev_b32_e64 v54, 16, v4
v_and_b32 v55, 0xffff0000, v4
Vc 5,56,57
v_lshlrev_b32_e64 v56, 16, v5
v_and_b32 v57, 0xffff0000, v5
v_pk_mul_f32 v[50:51], v[50:51], v[36:37] op_sel:[0,1] op_sel_hi:[1,1]
v_pk_mul_f32 v[52:53], v[52:53], v[36:37] op_sel:[0,1] op_sel_hi:[1,1]
v_pk_mul_f32 v[54:55], v[54:55], v[36:37] op_sel:[0,1] op_sel_hi:[1,1]
v_pk_mul_f32 v[56:57], v[56:57], v[36:37] op_sel:[0,1] op_sel_hi:[1,1]
Vc 2,50,51
v_lshlrev_b32_e64 v50, 16, v2
v_and_b32 v51, 0xffff0000, v2
Vc 3,52,53
v_lshlrev_b32_e64 v52, 16, v3
v_and_b32 v53, 0xffff0000, v3
Vc 4,54,55
v_lshlrev_b32_e64 v54, 16, v4
v_and_b32 v55, 0xffff0000, v4
Vc 5,56,57
v_lshlrev_b32_e64 v56, 16, v5
v_and_b32 v57, 0xffff0000, v5
v_mul_f32 v2, 0xbfb8aa3b, v50
v_mul_f32 v3, 0xbfb8aa3b, v51
v_mul_f32 v4, 0xbfb8aa3b, v52
v_mul_f32 v5, 0xbfb8aa3b, v53
v_mul_f32 v6, 0xbfb8aa3b, v54
v_mul_f32 v7, 0xbfb8aa3b, v55
v_mul_f32 v8, 0xbfb8aa3b, v56
v_mul_f32 v9, 0xbfb8aa3b, v57
Ve 2,2
Ve 3,3
Ve 4,4
Ve 5,5
Ve 6,6
Ve 7,7
Ve 8,8
Ve 9,9
v_add_f32 v2, 1.0, v2
v_add_f32 v3, 1.0, v3
v_add_f32 v4, 1.0, v4
v_add_f32 v5, 1.0, v5
v_add_f32 v6, 1.0, v6
v_add_f32 v7, 1.0, v7
v_add_f32 v8, 1.0, v8
v_add_f32 v9, 1.0, v9
v_rcp_f32 v2, v2
v_rcp_f32 v3, v3
v_rcp_f32 v4, v4
v_rcp_f32 v5, v5
v_rcp_f32 v6, v6
v_rcp_f32 v7, v7
v_rcp_f32 v8, v8
v_rcp_f32 v9, v9
v_pk_mul_f32 v[50:51], v[50:51], v[2:3]
v_pk_mul_f32 v[52:53], v[52:53], v[4:5]
v_pk_mul_f32 v[54:55], v[54:55], v[6:7]
v_pk_mul_f32 v[56:57], v[56:57], v[8:9]
Vc 2,50,51
v_lshlrev_b32_e64 v50, 16, v2
v_and_b32 v51, 0xffff0000, v2
Vc 3,52,53
v_lshlrev_b32_e64 v52, 16, v3
v_and_b32 v53, 0xffff0000, v3
Vc 4,54,55
v_lshlrev_b32_e64 v54, 16, v4
v_and_b32 v55, 0xffff0000, v4
Vc 5,56,57
v_lshlrev_b32_e64 v56, 16, v5
v_and_b32 v57, 0xffff0000, v5
v_lshlrev_b32_e64 v58, 16, v26
v_and_b32 v59, 0xffff0000, v26
v_lshlrev_b32_e64 v60, 16, v27
v_and_b32 v61, 0xffff0000, v27
v_lshlrev_b32_e64 v62, 16, v28
v_and_b32 v63, 0xffff0000, v28
v_lshlrev_b32_e64 v64, 16, v29
v_and_b32 v65, 0xffff0000, v29
v_pk_add_f32 v[58:59], v[58:59], v[38:39] op_sel_hi:[1,0] neg_lo:[0,1] neg_hi:[0,1]
v_pk_add_f32 v[60:61], v[60:61], v[38:39] op_sel_hi:[1,0] neg_lo:[0,1] neg_hi:[0,1]
v_pk_add_f32 v[62:63], v[62:63], v[38:39] op_sel_hi:[1,0] neg_lo:[0,1] neg_hi:[0,1]
v_pk_add_f32 v[64:65], v[64:65], v[38:39] op_sel_hi:[1,0] neg_lo:[0,1] neg_hi:[0,1]
Vc 2,58,59
v_lshlrev_b32_e64 v58, 16, v2
v_and_b32 v59, 0xffff0000, v2
Vc 3,60,61
v_lshlrev_b32_e64 v60, 16, v3
v_and_b32 v61, 0xffff0000, v3
Vc 4,62,63
v_lshlrev_b32_e64 v62, 16, v4
v_and_b32 v63, 0xffff0000, v4
Vc 5,64,65
v_lshlrev_b32_e64 v64, 16, v5
v_and_b32 v65, 0xffff0000, v5
v_pk_mul_f32 v[58:59], v[58:59], v[38:39] op_sel:[0,1] op_sel_hi:[1,1]
v_pk_mul_f32 v[60:61], v[60:61], v[38:39] op_sel:[0,1] op_sel_hi:[1,1]
v_pk_mul_f32 v[62:63], v[62:63], v[38:39] op_sel:[0,1] op_sel_hi:[1,1]
v_pk_mul_f32 v[64:65], v[64:65], v[38:39] op_sel:[0,1] op_sel_hi:[1,1]
Vc 2,58,59
v_lshlrev_b32_e64 v58, 16, v2
v_and_b32 v59, 0xffff0000, v2
Vc 3,60,61
v_lshlrev_b32_e64 v60, 16, v3
v_and_b32 v61, 0xffff0000, v3
Vc 4,62,63
v_lshlrev_b32_e64 v62, 16, v4
v_and_b32 v63, 0xffff0000, v4
Vc 5,64,65
v_lshlrev_b32_e64 v64, 16, v5
v_and_b32 v65, 0xffff0000, v5
v_mul_f32 v2, 0xbfb8aa3b, v58
v_mul_f32 v3, 0xbfb8aa3b, v59
v_mul_f32 v4, 0xbfb8aa3b, v60
v_mul_f32 v5, 0xbfb8aa3b, v61
v_mul_f32 v6, 0xbfb8aa3b, v62
v_mul_f32 v7, 0xbfb8aa3b, v63
v_mul_f32 v8, 0xbfb8aa3b, v64
v_mul_f32 v9, 0xbfb8aa3b, v65
Ve 2,2
Ve 3,3
Ve 4,4
Ve 5,5
Ve 6,6
Ve 7,7
Ve 8,8
Ve 9,9
v_add_f32 v2, 1.0, v2
v_add_f32 v3, 1.0, v3
v_add_f32 v4, 1.0, v4
v_add_f32 v5, 1.0, v5
v_add_f32 v6, 1.0, v6
v_add_f32 v7, 1.0, v7
v_add_f32 v8, 1.0, v8
v_add_f32 v9, 1.0, v9
v_rcp_f32 v2, v2
v_rcp_f32 v3, v3
v_rcp_f32 v4, v4
v_rcp_f32 v5, v5
v_rcp_f32 v6, v6
v_rcp_f32 v7, v7
v_rcp_f32 v8, v8
v_rcp_f32 v9, v9
v_pk_mul_f32 v[58:59], v[58:59], v[2:3]
v_pk_mul_f32 v[60:61], v[60:61], v[4:5]
v_pk_mul_f32 v[62:63], v[62:63], v[6:7]
v_pk_mul_f32 v[64:65], v[64:65], v[8:9]
Vc 2,58,59
v_lshlrev_b32_e64 v58, 16, v2
v_and_b32 v59, 0xffff0000, v2
Vc 3,60,61
v_lshlrev_b32_e64 v60, 16, v3
v_and_b32 v61, 0xffff0000, v3
Vc 4,62,63
v_lshlrev_b32_e64 v62, 16, v4
v_and_b32 v63, 0xffff0000, v4
Vc 5,64,65
v_lshlrev_b32_e64 v64, 16, v5
v_and_b32 v65, 0xffff0000, v5
L_nogt:
buffer_load_dwordx4 a[48:51], v112, s[8:11], s52 offen offset:0 sc1
buffer_load_dwordx4 a[52:55], v112, s[8:11], s52 offen offset:1024 sc1
s_add_u32 s52, s52, 8192
buffer_load_dwordx4 a[56:59], v112, s[8:11], s52 offen offset:0 sc1
buffer_load_dwordx4 a[60:63], v112, s[8:11], s52 offen offset:1024 sc1
s_add_u32 s52, s52, 8192
s_add_u32 m0, s44, 32768
s_nop 0
buffer_load_dwordx4 v114, s[12:15], s48 offen offset:0 lds
buffer_load_dwordx4 v114, s[12:15], s49 offen offset:1024 lds
buffer_load_dwordx4 v114, s[12:15], s50 offen offset:2048 lds
buffer_load_dwordx4 v114, s[12:15], s51 offen offset:3072 lds
v_xor_b32 v114, 128, v114
s_cmp_lg_u32 s40, 0
s_cbranch_scc1 L_nowd
s_add_u32 m0, s35, 0
s_nop 0
s_nop 0
buffer_load_dwordx4 v125, s[60:63], s48 offen offset:0 lds
buffer_load_dwordx4 v125, s[60:63], s49 offen offset:1024 lds
buffer_load_dwordx4 v125, s[60:63], s50 offen offset:2048 lds
buffer_load_dwordx4 v125, s[60:63], s51 offen offset:3072 lds
v_add_u32 v125, 65536, v125
s_add_u32 m0, s35, 4096
s_nop 0
buffer_load_dwordx4 v125, s[60:63], s48 offen offset:0 lds
buffer_load_dwordx4 v125, s[60:63], s49 offen offset:1024 lds
buffer_load_dwordx4 v125, s[60:63], s50 offen offset:2048 lds
buffer_load_dwordx4 v125, s[60:63], s51 offen offset:3072 lds
L_nowd:
s_cmp_lt_u32 s2, 128
s_cbranch_scc1 L_noc3b
s_bfe_u32 s3, s2, 0x40003
s_lshl_b32 s3, s3, 2
s_add_u32 s3, s3, s32
s_lshl_b32 s3, s3, 15
s_and_b32 s7, s2, 1
s_lshl_b32 s7, s7, 22
s_add_u32 s3, s3, s7
s_add_u32 s3, s3, 384
v_and_b32 v1, 15, v0
v_lshlrev_b32 v1, 11, v1
v_lshrrev_b32_e64 v11, 5, v0
v_lshl_add_u32 v1, v11, 10, v1
buffer_load_dword v11, v1, s[28:31], s3 offen
L_noc3b:
s_barrier
s_nop 0
ds_read_b64_tr_b16 v[192:193], v115 offset:0
ds_read_b64_tr_b16 v[194:195], v115 offset:2048
ds_read_b64_tr_b16 v[196:197], v115 offset:4096
ds_read_b64_tr_b16 v[198:199], v115 offset:6144
ds_read_b64_tr_b16 v[200:201], v115 offset:8192
ds_read_b64_tr_b16 v[202:203], v115 offset:10240
ds_read_b64_tr_b16 v[204:205], v115 offset:12288
ds_read_b64_tr_b16 v[206:207], v115 offset:14336
ds_read_b64_tr_b16 v[208:209], v116 offset:0
ds_read_b64_tr_b16 v[210:211], v116 offset:2048
ds_read_b64_tr_b16 v[212:213], v116 offset:4096
ds_read_b64_tr_b16 v[214:215], v116 offset:6144
ds_read_b64_tr_b16 v[216:217], v116 offset:8192
ds_read_b64_tr_b16 v[218:219], v116 offset:10240
ds_read_b64_tr_b16 v[220:221], v116 offset:12288
s_waitcnt lgkmcnt(9)
ds_read_b64_tr_b16 v[222:223], v116 offset:14336
s_waitcnt vmcnt(12)
s_waitcnt lgkmcnt(8)
Zvva 160,192,0
ds_read_b64_tr_b16 v[224:225], v117 offset:0
ds_read_b64_tr_b16 v[226:227], v117 offset:2048
v_mov_b32 v125, 1
Mvva 160,196,8
s_sub_u32 s65, s65, s33
s_lshl_b32 s65, s65, 2
v_mul_lo_u32 v124, v0, s65
Mvva 160,200,16
s_add_u32 m0, s44, 49152
ds_read_b64_tr_b16 v[228:229], v117 offset:4096
ds_read_b64_tr_b16 v[230:231], v117 offset:6144
Mvva 160,204,24
buffer_load_dwordx4 v114, s[12:15], s48 offen offset:0 lds
Zvva 176,192,4
s_waitcnt lgkmcnt(4)
ds_read_b64_tr_b16 v[232:233], v117 offset:8192
ds_read_b64_tr_b16 v[234:235], v117 offset:10240
Mvva 176,196,12
s_lshl_b32 s6, s33, 2
v_add_u32_e64 v124, s6, v124
Mvva 176,200,20
ds_read_b64_tr_b16 v[236:237], v117 offset:12288
ds_read_b64_tr_b16 v[238:239], v117 offset:14336
Mvva 176,204,28
buffer_load_dwordx4 v114, s[12:15], s49 offen offset:1024 lds
Zvva 164,208,0
ds_read_b64_tr_b16 v[240:241], v118 offset:0
ds_read_b64_tr_b16 v[242:243], v118 offset:2048
Mvva 164,212,8
s_mov_b32 s6, 5447680
s_cmp_eq_u32 s32, 0
s_cselect_b32 s6, s6, s64
s_cmp_ge_u32 s34, 1
s_cselect_b32 s6, s6, 2146435072
Mvva 164,216,16
s_waitcnt lgkmcnt(2)
ds_read_b64_tr_b16 v[244:245], v118 offset:4096
ds_read_b64_tr_b16 v[246:247], v118 offset:6144
Mvva 164,220,24
buffer_load_dwordx4 v114, s[12:15], s50 offen offset:2048 lds
Zvva 180,208,4
ds_read_b64_tr_b16 v[248:249], v118 offset:8192
ds_read_b64_tr_b16 v[250:251], v118 offset:10240
Mvva 180,212,12
s_mov_b64 exec, 3
buffer_store_dword v125, v124, s[20:23], s6 offen sc1
s_mov_b64 exec, -1
Mvva 180,216,20
s_barrier
ds_read_b64_tr_b16 v[252:253], v118 offset:12288
ds_read_b64_tr_b16 v[254:255], v118 offset:14336
Mvva 180,220,28
buffer_load_dwordx4 v114, s[12:15], s51 offen offset:3072 lds
v_xor_b32 v114, 128, v114
v_add_u32 v114, 262144, v114
Zvva 168,224,0
ds_read_b64_tr_b16 v[192:193], v115 offset:16384
ds_read_b64_tr_b16 v[194:195], v115 offset:18432
Mvva 168,228,8
s_lshl_b32 s40, s45, 2
s_add_u32 s40, s40, s32
s_lshr_b32 s3, s42, 5
s_lshr_b32 s47, s43, 5
s_cmp_eq_u32 s3, s40
s_cselect_b32 s53, 1, 0
s_cmp_eq_u32 s47, s40
s_cselect_b32 s53, 1, s53
s_mov_b32 s40, 0
Mvva 168,232,16
ds_read_b64_tr_b16 v[196:197], v115 offset:20480
ds_read_b64_tr_b16 v[198:199], v115 offset:22528
Mvva 168,236,24
buffer_load_dwordx4 a[64:67], v112, s[8:11], s52 offen offset:0 sc1
Zvva 184,224,4
s_waitcnt lgkmcnt(4)
ds_read_b64_tr_b16 v[200:201], v115 offset:24576
ds_read_b64_tr_b16 v[202:203], v115 offset:26624
Mvva 184,228,12
s_lshl_b32 s41, s46, 7
s_add_u32 s41, s41, 5449728
s_lshl_b32 s55, s46, 13
Mvva 184,232,20
ds_read_b64_tr_b16 v[204:205], v115 offset:28672
ds_read_b64_tr_b16 v[206:207], v115 offset:30720
Mvva 184,236,28
buffer_load_dwordx4 a[68:71], v112, s[8:11], s52 offen offset:1024 sc1
s_add_u32 s52, s52, 8192
Zvva 172,240,0
ds_read_b64_tr_b16 v[208:209], v116 offset:16384
ds_read_b64_tr_b16 v[210:211], v116 offset:18432
Mvva 172,244,8
s_add_u32 s55, s55, 5308416
s_add_u32 s16, s66, 88080384
s_addc_u32 s17, s67, 0
s_and_b32 s17, s17, 0xffff
Mvva 172,248,16
ds_read_b64_tr_b16 v[212:213], v116 offset:20480
ds_read_b64_tr_b16 v[214:215], v116 offset:22528
Mvva 172,252,24
buffer_load_dwordx4 a[72:75], v112, s[8:11], s52 offen offset:0 sc1
Zvva 188,240,4
s_waitcnt lgkmcnt(4)
ds_read_b64_tr_b16 v[216:217], v116 offset:24576
ds_read_b64_tr_b16 v[218:219], v116 offset:26624
Mvva 188,244,12
s_mov_b32 s18, 8388608
s_mov_b32 s19, 0x20000
s_lshl_b32 s24, s2, 2
Mvva 188,248,20
ds_read_b64_tr_b16 v[220:221], v116 offset:28672
ds_read_b64_tr_b16 v[222:223], v116 offset:30720
Mvva 188,252,28
buffer_load_dwordx4 a[76:79], v112, s[8:11], s52 offen offset:1024 sc1
s_add_u32 s52, s52, 8192
Zvva 128,192,0
ds_read_b64_tr_b16 v[224:225], v117 offset:16384
ds_read_b64_tr_b16 v[226:227], v117 offset:18432
Mvva 128,196,8
s_add_u32 s24, s24, s32
s_lshl_b32 s25, s24, 13
s_xor_b32 s26, s25, 32768
Mvva 128,200,16
s_add_u32 m0, s44, 65536
ds_read_b64_tr_b16 v[228:229], v117 offset:20480
ds_read_b64_tr_b16 v[230:231], v117 offset:22528
Mvva 128,204,24
buffer_load_dwordx4 v114, s[12:15], s48 offen offset:0 lds
Zvva 144,192,4
s_waitcnt lgkmcnt(4)
ds_read_b64_tr_b16 v[232:233], v117 offset:24576
ds_read_b64_tr_b16 v[234:235], v117 offset:26624
Mvva 144,196,12
s_lshl_b32 s24, s24, 2
s_xor_b32 s27, s24, 16
s_add_u32 s24, s24, 5452800
Mvva 144,200,20
ds_read_b64_tr_b16 v[236:237], v117 offset:28672
ds_read_b64_tr_b16 v[238:239], v117 offset:30720
Mvva 144,204,28
buffer_load_dwordx4 v114, s[12:15], s49 offen offset:1024 lds
Zvva 132,208,0
ds_read_b64_tr_b16 v[240:241], v118 offset:16384
ds_read_b64_tr_b16 v[242:243], v118 offset:18432
Mvva 132,212,8
s_add_u32 s27, s27, 5452800
v_add_u32 v106, s35, v115
v_add_u32 v107, s35, v116
v_add_u32 v108, s35, v117
Mvva 132,216,16
s_waitcnt lgkmcnt(2)
ds_read_b64_tr_b16 v[244:245], v118 offset:20480
ds_read_b64_tr_b16 v[246:247], v118 offset:22528
v_add_u32 v109, s35, v118
Mvva 132,220,24
buffer_load_dwordx4 v114, s[12:15], s50 offen offset:2048 lds
Zvva 148,208,4
s_waitcnt vmcnt(12)
ds_read_b64_tr_b16 v[248:249], v118 offset:24576
ds_read_b64_tr_b16 v[250:251], v118 offset:26624
v_and_b32 v2, 1, v121
Mvva 148,212,12
v_lshlrev_b32 v2, 8, v2
v_and_b32 v3, 15, v0
v_lshl_add_u32 v2, v3, 3, v2
Mvva 148,216,20
s_barrier
ds_read_b64_tr_b16 v[252:253], v118 offset:28672
ds_read_b64_tr_b16 v[254:255], v118 offset:30720
v_add_u32 v2, s35, v2
Mvva 148,220,28
buffer_load_dwordx4 v114, s[12:15], s51 offen offset:3072 lds
v_xor_b32 v114, 128, v114
Zvva 136,224,0
ds_read_b64_tr_b16 v[192:193], v115 offset:32768
ds_read_b64_tr_b16 v[194:195], v115 offset:34816
v_and_b32_e64 v4, 1, v0
Mvva 136,228,8
v_lshlrev_b32 v4, 8, v4
v_add_u32 v4, s35, v4
v_lshl_add_u32 v3, v121, 3, v4
Mvva 136,232,16
ds_read_b64_tr_b16 v[196:197], v115 offset:36864
ds_read_b64_tr_b16 v[198:199], v115 offset:38912
v_lshl_add_u32 v4, v121, 4, v4
Mvva 136,236,24
buffer_load_dwordx4 a[80:83], v112, s[8:11], s52 offen offset:0 sc1
Zvva 152,224,4
s_waitcnt lgkmcnt(4)
ds_read_b64_tr_b16 v[200:201], v115 offset:40960
ds_read_b64_tr_b16 v[202:203], v115 offset:43008
v_lshlrev_b32 v5, 3, v0
Mvva 152,228,12
v_add_u32 v6, 133120, v5
v_mov_b32_e64 v7, 1
Mvva 152,232,20
ds_read_b64_tr_b16 v[204:205], v115 offset:45056
ds_read_b64_tr_b16 v[206:207], v115 offset:47104
Mvva 152,236,28
buffer_load_dwordx4 a[84:87], v112, s[8:11], s52 offen offset:1024 sc1
s_add_u32 s52, s52, 8192
Zvva 140,240,0
ds_read_b64_tr_b16 v[208:209], v116 offset:32768
ds_read_b64_tr_b16 v[210:211], v116 offset:34816
Mvva 140,244,8
s_lshl_b32 s4, s39, 4
s_add_u32 s4, s4, s37
s_lshl_b32 s4, s4, 9
Mvva 140,248,16
ds_read_b64_tr_b16 v[212:213], v116 offset:36864
ds_read_b64_tr_b16 v[214:215], v116 offset:38912
Mvva 140,252,24
buffer_load_dwordx4 a[88:91], v112, s[8:11], s52 offen offset:0 sc1
Zvva 156,240,4
s_waitcnt lgkmcnt(4)
ds_read_b64_tr_b16 v[216:217], v116 offset:40960
ds_read_b64_tr_b16 v[218:219], v116 offset:43008
Mvva 156,244,12
s_add_u32 s4, s4, 5308416
s_lshl_b32 s6, s39, 5
s_add_u32 s6, s6, s37
Mvva 156,248,20
ds_read_b64_tr_b16 v[220:221], v116 offset:45056
ds_read_b64_tr_b16 v[222:223], v116 offset:47104
Mvva 156,252,28
buffer_load_dwordx4 a[92:95], v112, s[8:11], s52 offen offset:1024 sc1
s_add_u32 s52, s52, 8192
Mvva 160,192,32
ds_read_b64_tr_b16 v[224:225], v117 offset:32768
ds_read_b64_tr_b16 v[226:227], v117 offset:34816
Mvva 160,196,40
s_lshl_b32 s6, s6, 2
s_add_u32 s6, s6, 5449728
s_cmp_eq_u32 s32, 0
s_cselect_b32 s4, s4, s64
s_cselect_b32 s6, s6, s64
Mvva 160,200,48
s_add_u32 m0, s44, 81920
ds_read_b64_tr_b16 v[228:229], v117 offset:36864
ds_read_b64_tr_b16 v[230:231], v117 offset:38912
Mvva 160,204,56
buffer_load_dwordx4 v114, s[12:15], s48 offen offset:0 lds
Mvva 176,192,36
s_waitcnt lgkmcnt(4)
ds_read_b64_tr_b16 v[232:233], v117 offset:40960
ds_read_b64_tr_b16 v[234:235], v117 offset:43008
Mvva 176,196,44
s_cmp_lt_u32 s93, 224
s_cselect_b32 s4, s4, 2146435072
s_cselect_b32 s6, s6, 2146435072
Mvva 176,200,52
ds_read_b64_tr_b16 v[236:237], v117 offset:45056
ds_read_b64_tr_b16 v[238:239], v117 offset:47104
Mvva 176,204,60
buffer_load_dwordx4 v114, s[12:15], s49 offen offset:1024 lds
Mvva 164,208,32
ds_read_b64_tr_b16 v[240:241], v118 offset:32768
ds_read_b64_tr_b16 v[242:243], v118 offset:34816
Mvva 164,212,40
Mvva 164,216,48
s_waitcnt lgkmcnt(2)
ds_read_b64_tr_b16 v[244:245], v118 offset:36864
ds_read_b64_tr_b16 v[246:247], v118 offset:38912
Mvva 164,220,56
buffer_load_dwordx4 v114, s[12:15], s50 offen offset:2048 lds
Mvva 180,208,36
s_waitcnt vmcnt(15)
ds_read_b64_tr_b16 v[248:249], v118 offset:40960
ds_read_b64_tr_b16 v[250:251], v118 offset:43008
Mvva 180,212,44
Mvva 180,216,52
s_barrier
ds_read_b64_tr_b16 v[252:253], v118 offset:45056
ds_read_b64_tr_b16 v[254:255], v118 offset:47104
Mvva 180,220,60
buffer_load_dwordx4 v114, s[12:15], s51 offen offset:3072 lds
v_xor_b32 v114, 128, v114
v_add_u32 v114, 262144, v114
Mvva 168,224,32
ds_read_b64_tr_b16 v[192:193], v115 offset:49152
ds_read_b64_tr_b16 v[194:195], v115 offset:51200
Mvva 168,228,40
Mvva 168,232,48
ds_read_b64_tr_b16 v[196:197], v115 offset:53248
ds_read_b64_tr_b16 v[198:199], v115 offset:55296
Mvva 168,236,56
buffer_load_dwordx4 a[96:99], v112, s[8:11], s52 offen offset:0 sc1
Mvva 184,224,36
s_waitcnt lgkmcnt(4)
ds_read_b64_tr_b16 v[200:201], v115 offset:57344
ds_read_b64_tr_b16 v[202:203], v115 offset:59392
Mvva 184,228,44
Mvva 184,232,52
ds_read_b64_tr_b16 v[204:205], v115 offset:61440
ds_read_b64_tr_b16 v[206:207], v115 offset:63488
Mvva 184,236,60
buffer_load_dwordx4 a[100:103], v112, s[8:11], s52 offen offset:1024 sc1
s_add_u32 s52, s52, 8192
Mvva 172,240,32
ds_read_b64_tr_b16 v[208:209], v116 offset:49152
ds_read_b64_tr_b16 v[210:211], v116 offset:51200
Mvva 172,244,40
Mvva 172,248,48
ds_read_b64_tr_b16 v[212:213], v116 offset:53248
ds_read_b64_tr_b16 v[214:215], v116 offset:55296
Mvva 172,252,56
buffer_load_dwordx4 a[104:107], v112, s[8:11], s52 offen offset:0 sc1
Mvva 188,240,36
s_waitcnt lgkmcnt(4)
ds_read_b64_tr_b16 v[216:217], v116 offset:57344
ds_read_b64_tr_b16 v[218:219], v116 offset:59392
Mvva 188,244,44
Mvva 188,248,52
ds_read_b64_tr_b16 v[220:221], v116 offset:61440
ds_read_b64_tr_b16 v[222:223], v116 offset:63488
Mvva 188,252,60
buffer_load_dwordx4 a[108:111], v112, s[8:11], s52 offen offset:1024 sc1
s_add_u32 s52, s52, 8192
Mvva 128,192,32
ds_read_b64_tr_b16 v[224:225], v117 offset:49152
ds_read_b64_tr_b16 v[226:227], v117 offset:51200
Mvva 128,196,40
Mvva 128,200,48
s_add_u32 m0, s44, 98304
ds_read_b64_tr_b16 v[228:229], v117 offset:53248
ds_read_b64_tr_b16 v[230:231], v117 offset:55296
Mvva 128,204,56
buffer_load_dwordx4 v114, s[12:15], s48 offen offset:0 lds
Mvva 144,192,36
s_waitcnt lgkmcnt(4)
ds_read_b64_tr_b16 v[232:233], v117 offset:57344
ds_read_b64_tr_b16 v[234:235], v117 offset:59392
Mvva 144,196,44
Mvva 144,200,52
ds_read_b64_tr_b16 v[236:237], v117 offset:61440
ds_read_b64_tr_b16 v[238:239], v117 offset:63488
Mvva 144,204,60
buffer_load_dwordx4 v114, s[12:15], s49 offen offset:1024 lds
Mvva 132,208,32
ds_read_b64_tr_b16 v[240:241], v118 offset:49152
ds_read_b64_tr_b16 v[242:243], v118 offset:51200
Mvva 132,212,40
Mvva 132,216,48
s_waitcnt lgkmcnt(2)
ds_read_b64_tr_b16 v[244:245], v118 offset:53248
ds_read_b64_tr_b16 v[246:247], v118 offset:55296
Mvva 132,220,56
buffer_load_dwordx4 v114, s[12:15], s50 offen offset:2048 lds
Mvva 148,208,36
s_waitcnt vmcnt(15)
ds_read_b64_tr_b16 v[248:249], v118 offset:57344
ds_read_b64_tr_b16 v[250:251], v118 offset:59392
Mvva 148,212,44
Mvva 148,216,52
s_barrier
ds_read_b64_tr_b16 v[252:253], v118 offset:61440
ds_read_b64_tr_b16 v[254:255], v118 offset:63488
Mvva 148,220,60
buffer_load_dwordx4 v114, s[12:15], s51 offen offset:3072 lds
v_xor_b32 v114, 128, v114
Mvva 136,224,32
ds_read_b64_tr_b16 v[192:193], v12 offset:0
ds_read_b64_tr_b16 v[194:195], v12 offset:2048
Mvva 136,228,40
Mvva 136,232,48
ds_read_b64_tr_b16 v[196:197], v12 offset:4096
ds_read_b64_tr_b16 v[198:199], v12 offset:6144
Mvva 136,236,56
buffer_load_dwordx4 a[112:115], v112, s[8:11], s52 offen offset:0 sc1
Mvva 152,224,36
s_waitcnt lgkmcnt(4)
ds_read_b64_tr_b16 v[200:201], v12 offset:8192
ds_read_b64_tr_b16 v[202:203], v12 offset:10240
Mvva 152,228,44
Mvva 152,232,52
ds_read_b64_tr_b16 v[204:205], v12 offset:12288
ds_read_b64_tr_b16 v[206:207], v12 offset:14336
Mvva 152,236,60
buffer_load_dwordx4 a[116:119], v112, s[8:11], s52 offen offset:1024 sc1
s_add_u32 s52, s52, 8192
Mvva 140,240,32
ds_read_b64_tr_b16 v[208:209], v13 offset:0
ds_read_b64_tr_b16 v[210:211], v13 offset:2048
Mvva 140,244,40
Mvva 140,248,48
ds_read_b64_tr_b16 v[212:213], v13 offset:4096
ds_read_b64_tr_b16 v[214:215], v13 offset:6144
Mvva 140,252,56
buffer_load_dwordx4 a[120:123], v112, s[8:11], s52 offen offset:0 sc1
Mvva 156,240,36
s_waitcnt lgkmcnt(4)
ds_read_b64_tr_b16 v[216:217], v13 offset:8192
ds_read_b64_tr_b16 v[218:219], v13 offset:10240
Mvva 156,244,44
Mvva 156,248,52
s_waitcnt vmcnt(15)
ds_read_b64_tr_b16 v[220:221], v13 offset:12288
ds_read_b64_tr_b16 v[222:223], v13 offset:14336
Mvva 156,252,60
buffer_load_dwordx4 a[124:127], v112, s[8:11], s52 offen offset:1024 sc1
s_add_u32 s52, s52, 8192
Mvva 160,192,64
ds_read_b64_tr_b16 v[224:225], v14 offset:0
ds_read_b64_tr_b16 v[226:227], v14 offset:2048
Mvva 160,196,72
Mvva 160,200,80
s_add_u32 m0, s44, 114688
ds_read_b64_tr_b16 v[228:229], v14 offset:4096
ds_read_b64_tr_b16 v[230:231], v14 offset:6144
Mvva 160,204,88
buffer_load_dwordx4 v114, s[12:15], s48 offen offset:0 lds
Mvva 176,192,68
s_waitcnt lgkmcnt(4)
ds_read_b64_tr_b16 v[232:233], v14 offset:8192
ds_read_b64_tr_b16 v[234:235], v14 offset:10240
Mvva 176,196,76
Mvva 176,200,84
ds_read_b64_tr_b16 v[236:237], v14 offset:12288
ds_read_b64_tr_b16 v[238:239], v14 offset:14336
Mvva 176,204,92
buffer_load_dwordx4 v114, s[12:15], s49 offen offset:1024 lds
Mvva 164,208,64
ds_read_b64_tr_b16 v[240:241], v15 offset:0
ds_read_b64_tr_b16 v[242:243], v15 offset:2048
Mvva 164,212,72
Mvva 164,216,80
s_waitcnt lgkmcnt(2)
ds_read_b64_tr_b16 v[244:245], v15 offset:4096
ds_read_b64_tr_b16 v[246:247], v15 offset:6144
Mvva 164,220,88
buffer_load_dwordx4 v114, s[12:15], s50 offen offset:2048 lds
Mvva 180,208,68
s_waitcnt vmcnt(15)
ds_read_b64_tr_b16 v[248:249], v15 offset:8192
ds_read_b64_tr_b16 v[250:251], v15 offset:10240
Mvva 180,212,76
Mvva 180,216,84
s_barrier
ds_read_b64_tr_b16 v[252:253], v15 offset:12288
ds_read_b64_tr_b16 v[254:255], v15 offset:14336
Mvva 180,220,92
buffer_load_dwordx4 v114, s[12:15], s51 offen offset:3072 lds
v_xor_b32 v114, 128, v114
v_add_u32 v114, 262144, v114
Mvva 168,224,64
ds_read_b64_tr_b16 v[192:193], v12 offset:16384
ds_read_b64_tr_b16 v[194:195], v12 offset:18432
Mvva 168,228,72
Mvva 168,232,80
ds_read_b64_tr_b16 v[196:197], v12 offset:20480
ds_read_b64_tr_b16 v[198:199], v12 offset:22528
Mvva 168,236,88
buffer_load_dwordx4 a[128:131], v112, s[8:11], s52 offen offset:0 sc1
Mvva 184,224,68
s_waitcnt lgkmcnt(4)
ds_read_b64_tr_b16 v[200:201], v12 offset:24576
ds_read_b64_tr_b16 v[202:203], v12 offset:26624
Mvva 184,228,76
Mvva 184,232,84
ds_read_b64_tr_b16 v[204:205], v12 offset:28672
ds_read_b64_tr_b16 v[206:207], v12 offset:30720
Mvva 184,236,92
buffer_load_dwordx4 a[132:135], v112, s[8:11], s52 offen offset:1024 sc1
s_add_u32 s52, s52, 8192
Mvva 172,240,64
ds_read_b64_tr_b16 v[208:209], v13 offset:16384
ds_read_b64_tr_b16 v[210:211], v13 offset:18432
Mvva 172,244,72
Mvva 172,248,80
ds_read_b64_tr_b16 v[212:213], v13 offset:20480
ds_read_b64_tr_b16 v[214:215], v13 offset:22528
Mvva 172,252,88
buffer_load_dwordx4 a[136:139], v112, s[8:11], s52 offen offset:0 sc1
Mvva 188,240,68
s_waitcnt lgkmcnt(4)
ds_read_b64_tr_b16 v[216:217], v13 offset:24576
ds_read_b64_tr_b16 v[218:219], v13 offset:26624
Mvva 188,244,76
Mvva 188,248,84
ds_read_b64_tr_b16 v[220:221], v13 offset:28672
ds_read_b64_tr_b16 v[222:223], v13 offset:30720
Mvva 188,252,92
buffer_load_dwordx4 a[140:143], v112, s[8:11], s52 offen offset:1024 sc1
s_add_u32 s52, s52, 8192
Mvva 128,192,64
ds_read_b64_tr_b16 v[224:225], v14 offset:16384
ds_read_b64_tr_b16 v[226:227], v14 offset:18432
Mvva 128,196,72
s_cmp_lt_u32 s93, 224
s_cbranch_scc1 L_f2A
L_f2Ar:
Mvva 128,200,80
s_add_u32 m0, s44, 0
ds_read_b64_tr_b16 v[228:229], v14 offset:20480
ds_read_b64_tr_b16 v[230:231], v14 offset:22528
Mvva 128,204,88
buffer_load_dwordx4 v114, s[12:15], s48 offen offset:0 lds
Mvva 144,192,68
s_waitcnt lgkmcnt(4)
ds_read_b64_tr_b16 v[232:233], v14 offset:24576
ds_read_b64_tr_b16 v[234:235], v14 offset:26624
Mvva 144,196,76
Mvva 144,200,84
ds_read_b64_tr_b16 v[236:237], v14 offset:28672
ds_read_b64_tr_b16 v[238:239], v14 offset:30720
Mvva 144,204,92
buffer_load_dwordx4 v114, s[12:15], s49 offen offset:1024 lds
Mvva 132,208,64
ds_read_b64_tr_b16 v[240:241], v15 offset:16384
ds_read_b64_tr_b16 v[242:243], v15 offset:18432
Mvva 132,212,72
Mvva 132,216,80
s_waitcnt lgkmcnt(2)
ds_read_b64_tr_b16 v[244:245], v15 offset:20480
ds_read_b64_tr_b16 v[246:247], v15 offset:22528
Mvva 132,220,88
buffer_load_dwordx4 v114, s[12:15], s50 offen offset:2048 lds
Mvva 148,208,68
s_waitcnt vmcnt(15)
ds_read_b64_tr_b16 v[248:249], v15 offset:24576
ds_read_b64_tr_b16 v[250:251], v15 offset:26624
Mvva 148,212,76
Mvva 148,216,84
s_barrier
ds_read_b64_tr_b16 v[252:253], v15 offset:28672
ds_read_b64_tr_b16 v[254:255], v15 offset:30720
Mvva 148,220,92
buffer_load_dwordx4 v114, s[12:15], s51 offen offset:3072 lds
v_xor_b32 v114, 128, v114
Mvva 136,224,64
ds_read_b64_tr_b16 v[192:193], v12 offset:32768
ds_read_b64_tr_b16 v[194:195], v12 offset:34816
Mvva 136,228,72
Mvva 136,232,80
ds_read_b64_tr_b16 v[196:197], v12 offset:36864
ds_read_b64_tr_b16 v[198:199], v12 offset:38912
Mvva 136,236,88
buffer_load_dwordx4 a[144:147], v112, s[8:11], s52 offen offset:0 sc1
Mvva 152,224,68
s_waitcnt lgkmcnt(4)
ds_read_b64_tr_b16 v[200:201], v12 offset:40960
ds_read_b64_tr_b16 v[202:203], v12 offset:43008
Mvva 152,228,76
Mvva 152,232,84
ds_read_b64_tr_b16 v[204:205], v12 offset:45056
ds_read_b64_tr_b16 v[206:207], v12 offset:47104
Mvva 152,236,92
buffer_load_dwordx4 a[148:151], v112, s[8:11], s52 offen offset:1024 sc1
s_add_u32 s52, s52, 8192
Mvva 140,240,64
ds_read_b64_tr_b16 v[208:209], v13 offset:32768
ds_read_b64_tr_b16 v[210:211], v13 offset:34816
Mvva 140,244,72
Mvva 140,248,80
ds_read_b64_tr_b16 v[212:213], v13 offset:36864
ds_read_b64_tr_b16 v[214:215], v13 offset:38912
Mvva 140,252,88
buffer_load_dwordx4 a[152:155], v112, s[8:11], s52 offen offset:0 sc1
Mvva 156,240,68
s_waitcnt lgkmcnt(4)
ds_read_b64_tr_b16 v[216:217], v13 offset:40960
ds_read_b64_tr_b16 v[218:219], v13 offset:43008
Mvva 156,244,76
Mvva 156,248,84
s_waitcnt vmcnt(15)
ds_read_b64_tr_b16 v[220:221], v13 offset:45056
ds_read_b64_tr_b16 v[222:223], v13 offset:47104
Mvva 156,252,92
buffer_load_dwordx4 a[156:159], v112, s[8:11], s52 offen offset:1024 sc1
s_add_u32 s52, s52, 8192
Mvva 160,192,96
ds_read_b64_tr_b16 v[224:225], v14 offset:32768
ds_read_b64_tr_b16 v[226:227], v14 offset:34816
Mvva 160,196,104
Mvva 160,200,112
s_add_u32 m0, s44, 16384
ds_read_b64_tr_b16 v[228:229], v14 offset:36864
ds_read_b64_tr_b16 v[230:231], v14 offset:38912
Mvva 160,204,120
buffer_load_dwordx4 v114, s[12:15], s48 offen offset:0 lds
Mvva 176,192,100
s_waitcnt lgkmcnt(4)
ds_read_b64_tr_b16 v[232:233], v14 offset:40960
ds_read_b64_tr_b16 v[234:235], v14 offset:43008
Mvva 176,196,108
Mvva 176,200,116
ds_read_b64_tr_b16 v[236:237], v14 offset:45056
ds_read_b64_tr_b16 v[238:239], v14 offset:47104
Mvva 176,204,124
buffer_load_dwordx4 v114, s[12:15], s49 offen offset:1024 lds
Mvva 164,208,96
ds_read_b64_tr_b16 v[240:241], v15 offset:32768
ds_read_b64_tr_b16 v[242:243], v15 offset:34816
Mvva 164,212,104
Mvva 164,216,112
s_waitcnt lgkmcnt(2)
ds_read_b64_tr_b16 v[244:245], v15 offset:36864
ds_read_b64_tr_b16 v[246:247], v15 offset:38912
Mvva 164,220,120
buffer_load_dwordx4 v114, s[12:15], s50 offen offset:2048 lds
Mvva 180,208,100
s_waitcnt vmcnt(15)
ds_read_b64_tr_b16 v[248:249], v15 offset:40960
ds_read_b64_tr_b16 v[250:251], v15 offset:43008
Mvva 180,212,108
Mvva 180,216,116
s_barrier
ds_read_b64_tr_b16 v[252:253], v15 offset:45056
ds_read_b64_tr_b16 v[254:255], v15 offset:47104
Mvva 180,220,124
buffer_load_dwordx4 v114, s[12:15], s51 offen offset:3072 lds
v_xor_b32 v114, 128, v114
v_add_u32 v114, 262144, v114
Mvva 168,224,96
ds_read_b64_tr_b16 v[192:193], v12 offset:49152
ds_read_b64_tr_b16 v[194:195], v12 offset:51200
Mvva 168,228,104
Mvva 168,232,112
ds_read_b64_tr_b16 v[196:197], v12 offset:53248
ds_read_b64_tr_b16 v[198:199], v12 offset:55296
Mvva 168,236,120
buffer_load_dwordx4 a[160:163], v112, s[8:11], s52 offen offset:0 sc1
Mvva 184,224,100
s_waitcnt lgkmcnt(4)
ds_read_b64_tr_b16 v[200:201], v12 offset:57344
ds_read_b64_tr_b16 v[202:203], v12 offset:59392
Mvva 184,228,108
Mvva 184,232,116
ds_read_b64_tr_b16 v[204:205], v12 offset:61440
ds_read_b64_tr_b16 v[206:207], v12 offset:63488
Mvva 184,236,124
buffer_load_dwordx4 a[164:167], v112, s[8:11], s52 offen offset:1024 sc1
s_add_u32 s52, s52, 8192
Mvva 172,240,96
ds_read_b64_tr_b16 v[208:209], v13 offset:49152
ds_read_b64_tr_b16 v[210:211], v13 offset:51200
Mvva 172,244,104
Mvva 172,248,112
ds_read_b64_tr_b16 v[212:213], v13 offset:53248
ds_read_b64_tr_b16 v[214:215], v13 offset:55296
Mvva 172,252,120
buffer_load_dwordx4 a[168:171], v112, s[8:11], s52 offen offset:0 sc1
Mvva 188,240,100
s_waitcnt lgkmcnt(4)
ds_read_b64_tr_b16 v[216:217], v13 offset:57344
ds_read_b64_tr_b16 v[218:219], v13 offset:59392
Mvva 188,244,108
Mvva 188,248,116
ds_read_b64_tr_b16 v[220:221], v13 offset:61440
ds_read_b64_tr_b16 v[222:223], v13 offset:63488
Mvva 188,252,124
buffer_load_dwordx4 a[172:175], v112, s[8:11], s52 offen offset:1024 sc1
s_add_u32 s52, s52, 8192
Mvva 128,192,96
ds_read_b64_tr_b16 v[224:225], v14 offset:49152
ds_read_b64_tr_b16 v[226:227], v14 offset:51200
Mvva 128,196,104
Mvva 128,200,112
s_add_u32 m0, s44, 32768
ds_read_b64_tr_b16 v[228:229], v14 offset:53248
ds_read_b64_tr_b16 v[230:231], v14 offset:55296
Mvva 128,204,120
buffer_load_dwordx4 v114, s[12:15], s48 offen offset:0 lds
Mvva 144,192,100
s_waitcnt lgkmcnt(4)
ds_read_b64_tr_b16 v[232:233], v14 offset:57344
ds_read_b64_tr_b16 v[234:235], v14 offset:59392
Mvva 144,196,108
Mvva 144,200,116
ds_read_b64_tr_b16 v[236:237], v14 offset:61440
ds_read_b64_tr_b16 v[238:239], v14 offset:63488
Mvva 144,204,124
buffer_load_dwordx4 v114, s[12:15], s49 offen offset:1024 lds
Mvva 132,208,96
ds_read_b64_tr_b16 v[240:241], v15 offset:49152
ds_read_b64_tr_b16 v[242:243], v15 offset:51200
Mvva 132,212,104
Mvva 132,216,112
s_waitcnt lgkmcnt(2)
ds_read_b64_tr_b16 v[244:245], v15 offset:53248
ds_read_b64_tr_b16 v[246:247], v15 offset:55296
Mvva 132,220,120
buffer_load_dwordx4 v114, s[12:15], s50 offen offset:2048 lds
Mvva 148,208,100
s_waitcnt vmcnt(15)
ds_read_b64_tr_b16 v[248:249], v15 offset:57344
ds_read_b64_tr_b16 v[250:251], v15 offset:59392
Mvva 148,212,108
s_cmp_lt_u32 s93, 224
s_cbranch_scc1 L_f2B
L_f2Br:
Mvva 148,216,116
s_barrier
ds_read_b64_tr_b16 v[252:253], v15 offset:61440
ds_read_b64_tr_b16 v[254:255], v15 offset:63488
Mvva 148,220,124
buffer_load_dwordx4 v114, s[12:15], s51 offen offset:3072 lds
v_xor_b32 v114, 128, v114
Mvva 136,224,96
ds_read_b64_tr_b16 v[192:193], v115 offset:0
ds_read_b64_tr_b16 v[194:195], v115 offset:2048
Mvva 136,228,104
Mvva 136,232,112
ds_read_b64_tr_b16 v[196:197], v115 offset:4096
ds_read_b64_tr_b16 v[198:199], v115 offset:6144
Mvva 136,236,120
buffer_load_dwordx4 a[176:179], v112, s[8:11], s52 offen offset:0 sc1
Mvva 152,224,100
s_waitcnt lgkmcnt(4)
ds_read_b64_tr_b16 v[200:201], v115 offset:8192
ds_read_b64_tr_b16 v[202:203], v115 offset:10240
Mvva 152,228,108
Mvva 152,232,116
ds_read_b64_tr_b16 v[204:205], v115 offset:12288
ds_read_b64_tr_b16 v[206:207], v115 offset:14336
Mvva 152,236,124
buffer_load_dwordx4 a[180:183], v112, s[8:11], s52 offen offset:1024 sc1
s_add_u32 s52, s52, 8192
Mvva 140,240,96
ds_read_b64_tr_b16 v[208:209], v116 offset:0
ds_read_b64_tr_b16 v[210:211], v116 offset:2048
Mvva 140,244,104
Mvva 140,248,112
ds_read_b64_tr_b16 v[212:213], v116 offset:4096
ds_read_b64_tr_b16 v[214:215], v116 offset:6144
Mvva 140,252,120
buffer_load_dwordx4 a[184:187], v112, s[8:11], s52 offen offset:0 sc1
Mvva 156,240,100
s_waitcnt lgkmcnt(4)
ds_read_b64_tr_b16 v[216:217], v116 offset:8192
ds_read_b64_tr_b16 v[218:219], v116 offset:10240
Mvva 156,244,108
Mvva 156,248,116
s_waitcnt vmcnt(15)
ds_read_b64_tr_b16 v[220:221], v116 offset:12288
ds_read_b64_tr_b16 v[222:223], v116 offset:14336
Mvva 156,252,124
buffer_load_dwordx4 a[188:191], v112, s[8:11], s52 offen offset:1024 sc1
s_add_u32 s52, s52, 8192
Mvva 160,192,128
ds_read_b64_tr_b16 v[224:225], v117 offset:0
ds_read_b64_tr_b16 v[226:227], v117 offset:2048
Mvva 160,196,136
Mvva 160,200,144
s_add_u32 m0, s44, 49152
ds_read_b64_tr_b16 v[228:229], v117 offset:4096
ds_read_b64_tr_b16 v[230:231], v117 offset:6144
Mvva 160,204,152
buffer_load_dwordx4 v114, s[12:15], s48 offen offset:0 lds
Mvva 176,192,132
s_waitcnt lgkmcnt(4)
ds_read_b64_tr_b16 v[232:233], v117 offset:8192
ds_read_b64_tr_b16 v[234:235], v117 offset:10240
Mvva 176,196,140
Mvva 176,200,148
ds_read_b64_tr_b16 v[236:237], v117 offset:12288
ds_read_b64_tr_b16 v[238:239], v117 offset:14336
Mvva 176,204,156
buffer_load_dwordx4 v114, s[12:15], s49 offen offset:1024 lds
Mvva 164,208,128
ds_read_b64_tr_b16 v[240:241], v118 offset:0
ds_read_b64_tr_b16 v[242:243], v118 offset:2048
Mvva 164,212,136
Mvva 164,216,144
s_waitcnt lgkmcnt(2)
ds_read_b64_tr_b16 v[244:245], v118 offset:4096
ds_read_b64_tr_b16 v[246:247], v118 offset:6144
Mvva 164,220,152
buffer_load_dwordx4 v114, s[12:15], s50 offen offset:2048 lds
Mvva 180,208,132
s_waitcnt vmcnt(15)
ds_read_b64_tr_b16 v[248:249], v118 offset:8192
ds_read_b64_tr_b16 v[250:251], v118 offset:10240
Mvva 180,212,140
Mvva 180,216,148
s_barrier
ds_read_b64_tr_b16 v[252:253], v118 offset:12288
ds_read_b64_tr_b16 v[254:255], v118 offset:14336
Mvva 180,220,156
buffer_load_dwordx4 v114, s[12:15], s51 offen offset:3072 lds
v_xor_b32 v114, 128, v114
v_add_u32 v114, 262144, v114
Mvva 168,224,128
ds_read_b64_tr_b16 v[192:193], v115 offset:16384
ds_read_b64_tr_b16 v[194:195], v115 offset:18432
Mvva 168,228,136
Mvva 168,232,144
ds_read_b64_tr_b16 v[196:197], v115 offset:20480
ds_read_b64_tr_b16 v[198:199], v115 offset:22528
Mvva 168,236,152
buffer_load_dwordx4 a[192:195], v112, s[8:11], s52 offen offset:0 sc1
Mvva 184,224,132
s_waitcnt lgkmcnt(4)
ds_read_b64_tr_b16 v[200:201], v115 offset:24576
ds_read_b64_tr_b16 v[202:203], v115 offset:26624
Mvva 184,228,140
Mvva 184,232,148
ds_read_b64_tr_b16 v[204:205], v115 offset:28672
ds_read_b64_tr_b16 v[206:207], v115 offset:30720
Mvva 184,236,156
buffer_load_dwordx4 a[196:199], v112, s[8:11], s52 offen offset:1024 sc1
s_add_u32 s52, s52, 8192
Mvva 172,240,128
ds_read_b64_tr_b16 v[208:209], v116 offset:16384
ds_read_b64_tr_b16 v[210:211], v116 offset:18432
Mvva 172,244,136
Mvva 172,248,144
ds_read_b64_tr_b16 v[212:213], v116 offset:20480
ds_read_b64_tr_b16 v[214:215], v116 offset:22528
Mvva 172,252,152
buffer_load_dwordx4 a[200:203], v112, s[8:11], s52 offen offset:0 sc1
Mvva 188,240,132
s_waitcnt lgkmcnt(4)
ds_read_b64_tr_b16 v[216:217], v116 offset:24576
ds_read_b64_tr_b16 v[218:219], v116 offset:26624
Mvva 188,244,140
Mvva 188,248,148
ds_read_b64_tr_b16 v[220:221], v116 offset:28672
ds_read_b64_tr_b16 v[222:223], v116 offset:30720
Mvva 188,252,156
buffer_load_dwordx4 a[204:207], v112, s[8:11], s52 offen offset:1024 sc1
s_add_u32 s52, s52, 8192
Mvva 128,192,128
ds_read_b64_tr_b16 v[224:225], v117 offset:16384
ds_read_b64_tr_b16 v[226:227], v117 offset:18432
Mvva 128,196,136
Mvva 128,200,144
s_add_u32 m0, s44, 65536
ds_read_b64_tr_b16 v[228:229], v117 offset:20480
ds_read_b64_tr_b16 v[230:231], v117 offset:22528
Mvva 128,204,152
buffer_load_dwordx4 v114, s[12:15], s48 offen offset:0 lds
Mvva 144,192,132
s_waitcnt lgkmcnt(4)
ds_read_b64_tr_b16 v[232:233], v117 offset:24576
ds_read_b64_tr_b16 v[234:235], v117 offset:26624
Mvva 144,196,140
Mvva 144,200,148
ds_read_b64_tr_b16 v[236:237], v117 offset:28672
ds_read_b64_tr_b16 v[238:239], v117 offset:30720
Mvva 144,204,156
buffer_load_dwordx4 v114, s[12:15], s49 offen offset:1024 lds
Mvva 132,208,128
ds_read_b64_tr_b16 v[240:241], v118 offset:16384
ds_read_b64_tr_b16 v[242:243], v118 offset:18432
Mvva 132,212,136
Mvva 132,216,144
s_waitcnt lgkmcnt(2)
ds_read_b64_tr_b16 v[244:245], v118 offset:20480
ds_read_b64_tr_b16 v[246:247], v118 offset:22528
Mvva 132,220,152
buffer_load_dwordx4 v114, s[12:15], s50 offen offset:2048 lds
Mvva 148,208,132
s_waitcnt vmcnt(15)
ds_read_b64_tr_b16 v[248:249], v118 offset:24576
ds_read_b64_tr_b16 v[250:251], v118 offset:26624
Mvva 148,212,140
Mvva 148,216,148
s_barrier
ds_read_b64_tr_b16 v[252:253], v118 offset:28672
ds_read_b64_tr_b16 v[254:255], v118 offset:30720
Mvva 148,220,156
buffer_load_dwordx4 v114, s[12:15], s51 offen offset:3072 lds
v_xor_b32 v114, 128, v114
Mvva 136,224,128
ds_read_b64_tr_b16 v[192:193], v115 offset:32768
ds_read_b64_tr_b16 v[194:195], v115 offset:34816
Mvva 136,228,136
s_cmp_ge_u32 s2, 128
s_cbranch_scc1 L_c31
L_c31r:
Mvva 136,232,144
ds_read_b64_tr_b16 v[196:197], v115 offset:36864
ds_read_b64_tr_b16 v[198:199], v115 offset:38912
Mvva 136,236,152
buffer_load_dwordx4 a[208:211], v112, s[8:11], s52 offen offset:0 sc1
Mvva 152,224,132
s_waitcnt lgkmcnt(4)
ds_read_b64_tr_b16 v[200:201], v115 offset:40960
ds_read_b64_tr_b16 v[202:203], v115 offset:43008
Mvva 152,228,140
Mvva 152,232,148
ds_read_b64_tr_b16 v[204:205], v115 offset:45056
ds_read_b64_tr_b16 v[206:207], v115 offset:47104
Mvva 152,236,156
buffer_load_dwordx4 a[212:215], v112, s[8:11], s52 offen offset:1024 sc1
s_add_u32 s52, s52, 8192
Mvva 140,240,128
ds_read_b64_tr_b16 v[208:209], v116 offset:32768
ds_read_b64_tr_b16 v[210:211], v116 offset:34816
Mvva 140,244,136
Mvva 140,248,144
ds_read_b64_tr_b16 v[212:213], v116 offset:36864
ds_read_b64_tr_b16 v[214:215], v116 offset:38912
Mvva 140,252,152
buffer_load_dwordx4 a[216:219], v112, s[8:11], s52 offen offset:0 sc1
Mvva 156,240,132
s_waitcnt lgkmcnt(4)
ds_read_b64_tr_b16 v[216:217], v116 offset:40960
ds_read_b64_tr_b16 v[218:219], v116 offset:43008
Mvva 156,244,140
s_waitcnt vmcnt(16)
Va 74,74,78
Va 75,75,79
v_add_f32_e64 v76, v76, v80
Mvva 156,248,148
s_waitcnt vmcnt(15)
ds_read_b64_tr_b16 v[220:221], v116 offset:45056
ds_read_b64_tr_b16 v[222:223], v116 offset:47104
Va 77,77,81
Mvva 156,252,156
buffer_load_dwordx4 a[220:223], v112, s[8:11], s52 offen offset:1024 sc1
s_add_u32 s52, s52, 8192
Mvva 160,192,160
ds_read_b64_tr_b16 v[224:225], v117 offset:32768
ds_read_b64_tr_b16 v[226:227], v117 offset:34816
v_add_f32_e64 v74, v74, v82
Mvva 160,196,168
Va 75,75,83
Va 76,76,84
v_add_f32_e64 v77, v77, v85
Mvva 160,200,176
s_add_u32 m0, s44, 81920
ds_read_b64_tr_b16 v[228:229], v117 offset:36864
ds_read_b64_tr_b16 v[230:231], v117 offset:38912
v_add_f32_e64 v74, v74, v86
Mvva 160,204,184
buffer_load_dwordx4 v114, s[12:15], s48 offen offset:0 lds
Mvva 176,192,164
s_waitcnt lgkmcnt(4)
ds_read_b64_tr_b16 v[232:233], v117 offset:40960
ds_read_b64_tr_b16 v[234:235], v117 offset:43008
Va 75,75,87
Mvva 176,196,172
Va 76,76,88
Va 77,77,89
v_add_f32_e64 v74, v74, v90
Mvva 176,200,180
ds_read_b64_tr_b16 v[236:237], v117 offset:45056
ds_read_b64_tr_b16 v[238:239], v117 offset:47104
v_add_f32_e64 v75, v75, v91
Mvva 176,204,188
buffer_load_dwordx4 v114, s[12:15], s49 offen offset:1024 lds
Mvva 164,208,160
ds_read_b64_tr_b16 v[240:241], v118 offset:32768
ds_read_b64_tr_b16 v[242:243], v118 offset:34816
v_add_f32_e64 v76, v76, v92
Mvva 164,212,168
Va 77,77,93
Va 74,74,94
v_add_f32_e64 v75, v75, v95
Mvva 164,216,176
s_waitcnt lgkmcnt(2)
ds_read_b64_tr_b16 v[244:245], v118 offset:36864
ds_read_b64_tr_b16 v[246:247], v118 offset:38912
Va 76,76,96
Mvva 164,220,184
buffer_load_dwordx4 v114, s[12:15], s50 offen offset:2048 lds
Mvva 180,208,164
s_waitcnt vmcnt(15)
ds_read_b64_tr_b16 v[248:249], v118 offset:40960
ds_read_b64_tr_b16 v[250:251], v118 offset:43008
Va 77,77,97
Mvva 180,212,172
Va 74,74,98
Va 75,75,99
v_add_f32_e64 v76, v76, v100
Mvva 180,216,180
s_barrier
ds_read_b64_tr_b16 v[252:253], v118 offset:45056
ds_read_b64_tr_b16 v[254:255], v118 offset:47104
Va 77,77,101
Mvva 180,220,188
buffer_load_dwordx4 v114, s[12:15], s51 offen offset:3072 lds
v_xor_b32 v114, 128, v114
v_add_u32 v114, 262144, v114
Mvva 168,224,160
ds_read_b64_tr_b16 v[192:193], v115 offset:49152
ds_read_b64_tr_b16 v[194:195], v115 offset:51200
v_add_f32_e64 v74, v74, v102
Mvva 168,228,168
Va 75,75,103
Va 76,76,104
v_add_f32_e64 v77, v77, v105
Mvva 168,232,176
ds_read_b64_tr_b16 v[196:197], v115 offset:53248
ds_read_b64_tr_b16 v[198:199], v115 offset:55296
Mvva 168,236,184
buffer_load_dwordx4 a[224:227], v112, s[8:11], s52 offen offset:0 sc1
Mvva 184,224,164
s_waitcnt lgkmcnt(4)
ds_read_b64_tr_b16 v[200:201], v115 offset:57344
ds_read_b64_tr_b16 v[202:203], v115 offset:59392
Mvva 184,228,172
ds_read_b64_tr_b16 v[90:91], v106 offset:0
ds_read_b64_tr_b16 v[92:93], v106 offset:2048
ds_read_b64_tr_b16 v[94:95], v107 offset:0
Mvva 184,232,180
ds_read_b64_tr_b16 v[204:205], v115 offset:61440
ds_read_b64_tr_b16 v[206:207], v115 offset:63488
Mvva 184,236,188
buffer_load_dwordx4 a[228:231], v112, s[8:11], s52 offen offset:1024 sc1
s_add_u32 s52, s52, 8192
Mvva 172,240,160
ds_read_b64_tr_b16 v[208:209], v116 offset:49152
ds_read_b64_tr_b16 v[210:211], v116 offset:51200
Mvva 172,244,168
ds_read_b64_tr_b16 v[96:97], v107 offset:2048
ds_read_b64_tr_b16 v[98:99], v108 offset:0
s_waitcnt lgkmcnt(9)
ds_read_b64_tr_b16 v[100:101], v108 offset:2048
Mvva 172,248,176
ds_read_b64_tr_b16 v[212:213], v116 offset:53248
ds_read_b64_tr_b16 v[214:215], v116 offset:55296
Mvva 172,252,184
buffer_load_dwordx4 a[232:235], v112, s[8:11], s52 offen offset:0 sc1
Mvva 188,240,164
s_waitcnt lgkmcnt(7)
ds_read_b64_tr_b16 v[216:217], v116 offset:57344
ds_read_b64_tr_b16 v[218:219], v116 offset:59392
Mvva 188,244,172
ds_read_b64_tr_b16 v[102:103], v109 offset:0
ds_read_b64_tr_b16 v[104:105], v109 offset:2048
Vc 8,74,75
Mvva 188,248,180
ds_read_b64_tr_b16 v[220:221], v116 offset:61440
ds_read_b64_tr_b16 v[222:223], v116 offset:63488
v_lshlrev_b32 v74, 16, v8
Mvva 188,252,188
buffer_load_dwordx4 a[236:239], v112, s[8:11], s52 offen offset:1024 sc1
s_add_u32 s52, s52, 8192
Mvva 128,192,160
ds_read_b64_tr_b16 v[224:225], v117 offset:49152
ds_read_b64_tr_b16 v[226:227], v117 offset:51200
v_and_b32 v75, 0xffff0000, v8
Mvva 128,196,168
Vc 8,76,77
v_lshlrev_b32_e64 v76, 16, v8
v_and_b32 v77, 0xffff0000, v8
Mvva 128,200,176
s_add_u32 m0, s44, 98304
s_waitcnt lgkmcnt(9)
ds_read_b64_tr_b16 v[228:229], v117 offset:53248
ds_read_b64_tr_b16 v[230:231], v117 offset:55296
v_mov_b32 v78, v74
Mvva 128,204,184
buffer_load_dwordx4 v114, s[12:15], s48 offen offset:0 lds
Mvva 144,192,164
s_waitcnt lgkmcnt(4)
ds_read_b64_tr_b16 v[232:233], v117 offset:57344
ds_read_b64_tr_b16 v[234:235], v117 offset:59392
v_mov_b32 v79, v75
Mvva 144,196,172
v_mov_b32 v80, v76
v_mov_b32 v81, v77
v_permlane32_swap_b32 v78, v74
Mvva 144,200,180
ds_read_b64_tr_b16 v[236:237], v117 offset:61440
ds_read_b64_tr_b16 v[238:239], v117 offset:63488
v_permlane32_swap_b32 v79, v75
Mvva 144,204,188
buffer_load_dwordx4 v114, s[12:15], s49 offen offset:1024 lds
Mvva 132,208,160
ds_read_b64_tr_b16 v[240:241], v118 offset:49152
ds_read_b64_tr_b16 v[242:243], v118 offset:51200
v_permlane32_swap_b32 v80, v76
Mvva 132,212,168
v_permlane32_swap_b32 v81, v77
v_mul_f32 v82, 0xbfb8aa3b, v78
v_mul_f32 v83, 0xbfb8aa3b, v79
Mvva 132,216,176
s_waitcnt lgkmcnt(2)
ds_read_b64_tr_b16 v[244:245], v118 offset:53248
ds_read_b64_tr_b16 v[246:247], v118 offset:55296
v_mul_f32 v84, 0xbfb8aa3b, v80
Mvva 132,220,184
buffer_load_dwordx4 v114, s[12:15], s50 offen offset:2048 lds
Mvva 148,208,164
s_waitcnt vmcnt(15)
ds_read_b64_tr_b16 v[248:249], v118 offset:57344
ds_read_b64_tr_b16 v[250:251], v118 offset:59392
v_mul_f32 v85, 0xbfb8aa3b, v81
Mvva 148,212,172
VE 82,82
Mvva 148,216,180
s_barrier
ds_read_b64_tr_b16 v[252:253], v118 offset:61440
ds_read_b64_tr_b16 v[254:255], v118 offset:63488
Mvva 148,220,188
buffer_load_dwordx4 v114, s[12:15], s51 offen offset:3072 lds
v_xor_b32 v114, 128, v114
Mvva 136,224,160
ds_read_b64_tr_b16 v[192:193], v12 offset:0
ds_read_b64_tr_b16 v[194:195], v12 offset:2048
Mvva 136,228,168
Ve 83,83
Mvva 136,232,176
ds_read_b64_tr_b16 v[196:197], v12 offset:4096
ds_read_b64_tr_b16 v[198:199], v12 offset:6144
Mvva 136,236,184
buffer_load_dwordx4 a[240:243], v112, s[8:11], s52 offen offset:0 sc1
Mvva 152,224,164
s_waitcnt lgkmcnt(4)
ds_read_b64_tr_b16 v[200:201], v12 offset:8192
ds_read_b64_tr_b16 v[202:203], v12 offset:10240
Mvva 152,228,172
Ve 84,84
Mvva 152,232,180
ds_read_b64_tr_b16 v[204:205], v12 offset:12288
ds_read_b64_tr_b16 v[206:207], v12 offset:14336
Mvva 152,236,188
buffer_load_dwordx4 a[244:247], v112, s[8:11], s52 offen offset:1024 sc1
s_add_u32 s52, s52, 8192
Mvva 140,240,160
ds_read_b64_tr_b16 v[208:209], v13 offset:0
ds_read_b64_tr_b16 v[210:211], v13 offset:2048
Mvva 140,244,168
Ve 85,85
v_add_f32 v82, 1.0, v82
Mvva 140,248,176
ds_read_b64_tr_b16 v[212:213], v13 offset:4096
ds_read_b64_tr_b16 v[214:215], v13 offset:6144
v_add_f32_e64 v83, 1.0, v83
Mvva 140,252,184
buffer_load_dwordx4 a[248:251], v112, s[8:11], s52 offen offset:0 sc1
Mvva 156,240,164
s_waitcnt lgkmcnt(4)
ds_read_b64_tr_b16 v[216:217], v13 offset:8192
ds_read_b64_tr_b16 v[218:219], v13 offset:10240
v_add_f32 v84, 1.0, v84
Mvva 156,244,172
v_add_f32 v85, 1.0, v85
v_rcp_f32 v82, v82
Mvva 156,248,180
s_waitcnt vmcnt(15)
ds_read_b64_tr_b16 v[220:221], v13 offset:12288
ds_read_b64_tr_b16 v[222:223], v13 offset:14336
Mvva 156,252,188
buffer_load_dwordx4 a[252:255], v112, s[8:11], s52 offen offset:1024 sc1
s_add_u32 s52, s52, 8192
Mvva 160,192,192
ds_read_b64_tr_b16 v[224:225], v14 offset:0
ds_read_b64_tr_b16 v[226:227], v14 offset:2048
Mvva 160,196,200
v_rcp_f32 v83, v83
Mvva 160,200,208
s_add_u32 m0, s44, 114688
ds_read_b64_tr_b16 v[228:229], v14 offset:4096
ds_read_b64_tr_b16 v[230:231], v14 offset:6144
Mvva 160,204,216
buffer_load_dwordx4 v114, s[12:15], s48 offen offset:0 lds
Mvva 176,192,196
s_waitcnt lgkmcnt(4)
ds_read_b64_tr_b16 v[232:233], v14 offset:8192
ds_read_b64_tr_b16 v[234:235], v14 offset:10240
Mvva 176,196,204
v_rcp_f32 v84, v84
Mvva 176,200,212
ds_read_b64_tr_b16 v[236:237], v14 offset:12288
ds_read_b64_tr_b16 v[238:239], v14 offset:14336
Mvva 176,204,220
buffer_load_dwordx4 v114, s[12:15], s49 offen offset:1024 lds
Mvva 164,208,192
ds_read_b64_tr_b16 v[240:241], v15 offset:0
ds_read_b64_tr_b16 v[242:243], v15 offset:2048
Mvva 164,212,200
v_rcp_f32 v85, v85
Vm 78,78,82
Mvva 164,216,208
s_waitcnt lgkmcnt(2)
ds_read_b64_tr_b16 v[244:245], v15 offset:4096
ds_read_b64_tr_b16 v[246:247], v15 offset:6144
Vm 79,79,83
Mvva 164,220,216
buffer_load_dwordx4 v114, s[12:15], s50 offen offset:2048 lds
Mvva 180,208,196
s_waitcnt vmcnt(15)
ds_read_b64_tr_b16 v[248:249], v15 offset:8192
ds_read_b64_tr_b16 v[250:251], v15 offset:10240
Vm 80,80,84
Mvva 180,212,204
v_mul_f32_e64 v81, v81, v85
Vc 8,78,79
v_lshlrev_b32_e64 v78, 16, v8
Mvva 180,216,212
s_barrier
ds_read_b64_tr_b16 v[252:253], v15 offset:12288
ds_read_b64_tr_b16 v[254:255], v15 offset:14336
v_and_b32 v79, 0xffff0000, v8
Mvva 180,220,220
buffer_load_dwordx4 v114, s[12:15], s51 offen offset:3072 lds
v_xor_b32 v114, 128, v114
v_add_u32 v114, 262144, v114
Mvva 168,224,192
ds_read_b64_tr_b16 v[192:193], v12 offset:16384
ds_read_b64_tr_b16 v[194:195], v12 offset:18432
Vc 8,80,81
Mvva 168,228,200
v_lshlrev_b32 v80, 16, v8
v_and_b32 v81, 0xffff0000, v8
v_mul_f32_e64 v74, v74, v78
Mvva 168,232,208
ds_read_b64_tr_b16 v[196:197], v12 offset:20480
ds_read_b64_tr_b16 v[198:199], v12 offset:22528
v_mul_f32_e64 v75, v75, v79
Mvva 168,236,216
buffer_load_dwordx4 a[0:3], v112, s[8:11], s52 offen offset:0 sc1
Mvva 184,224,196
s_waitcnt lgkmcnt(4)
ds_read_b64_tr_b16 v[200:201], v12 offset:24576
ds_read_b64_tr_b16 v[202:203], v12 offset:26624
Vm 76,76,80
Mvva 184,228,204
v_mul_f32_e64 v77, v77, v81
Vc 8,74,75
Vc 9,76,77
Mvva 184,232,212
ds_read_b64_tr_b16 v[204:205], v12 offset:28672
ds_read_b64_tr_b16 v[206:207], v12 offset:30720
Mvva 184,236,220
buffer_load_dwordx4 a[4:7], v112, s[8:11], s52 offen offset:1024 sc1
s_add_u32 s52, s52, 8192
Mvva 172,240,192
ds_read_b64_tr_b16 v[208:209], v13 offset:16384
ds_read_b64_tr_b16 v[210:211], v13 offset:18432
Mvva 172,244,200
ds_write_b64 v2, v[8:9]
ds_read_b64 v[74:75], v3 offset:0
ds_read_b64 v[76:77], v3 offset:32
Mvva 172,248,208
ds_read_b64_tr_b16 v[212:213], v13 offset:20480
ds_read_b64_tr_b16 v[214:215], v13 offset:22528
Mvva 172,252,216
buffer_load_dwordx4 a[8:11], v112, s[8:11], s52 offen offset:0 sc1
Mvva 188,240,196
s_waitcnt lgkmcnt(7)
ds_read_b64_tr_b16 v[216:217], v13 offset:24576
ds_read_b64_tr_b16 v[218:219], v13 offset:26624
Mvva 188,244,204
ds_read_b64 v[78:79], v3 offset:64
ds_read_b64 v[80:81], v3 offset:96
Mvva 188,248,212
ds_read_b64_tr_b16 v[220:221], v13 offset:28672
ds_read_b64_tr_b16 v[222:223], v13 offset:30720
Mvva 188,252,220
buffer_load_dwordx4 a[12:15], v112, s[8:11], s52 offen offset:1024 sc1
s_add_u32 s52, s52, 8192
Mvva 128,192,192
ds_read_b64_tr_b16 v[224:225], v14 offset:16384
ds_read_b64_tr_b16 v[226:227], v14 offset:18432
Mvva 128,196,200
Mvva 128,200,208
s_add_u32 m0, s44, 0
s_waitcnt lgkmcnt(9)
ds_read_b64_tr_b16 v[228:229], v14 offset:20480
ds_read_b64_tr_b16 v[230:231], v14 offset:22528
Mvva 128,204,216
buffer_load_dwordx4 v114, s[12:15], s48 offen offset:0 lds
Mvva 144,192,196
s_waitcnt lgkmcnt(4)
ds_read_b64_tr_b16 v[232:233], v14 offset:24576
ds_read_b64_tr_b16 v[234:235], v14 offset:26624
Mvva 144,196,204
Zvvv 82,90,74
Mvva 144,200,212
ds_read_b64_tr_b16 v[236:237], v14 offset:28672
ds_read_b64_tr_b16 v[238:239], v14 offset:30720
Mvva 144,204,220
buffer_load_dwordx4 v114, s[12:15], s49 offen offset:1024 lds
Mvva 132,208,192
ds_read_b64_tr_b16 v[240:241], v15 offset:16384
ds_read_b64_tr_b16 v[242:243], v15 offset:18432
Mvva 132,212,200
Zvvv 86,94,74
Mvva 132,216,208
s_waitcnt lgkmcnt(2)
ds_read_b64_tr_b16 v[244:245], v15 offset:20480
ds_read_b64_tr_b16 v[246:247], v15 offset:22528
Mvva 132,220,216
buffer_load_dwordx4 v114, s[12:15], s50 offen offset:2048 lds
Mvva 148,208,196
s_waitcnt vmcnt(15)
ds_read_b64_tr_b16 v[248:249], v15 offset:24576
ds_read_b64_tr_b16 v[250:251], v15 offset:26624
Mvva 148,212,204
ds_read_b64_tr_b16 v[90:91], v106 offset:4096
ds_read_b64_tr_b16 v[92:93], v106 offset:6144
ds_read_b64_tr_b16 v[94:95], v107 offset:4096
Mvva 148,216,212
s_barrier
ds_read_b64_tr_b16 v[252:253], v15 offset:28672
ds_read_b64_tr_b16 v[254:255], v15 offset:30720
Mvva 148,220,220
buffer_load_dwordx4 v114, s[12:15], s51 offen offset:3072 lds
v_add_u32 v114, 262144, v114
Mvva 136,224,192
ds_read_b64_tr_b16 v[192:193], v12 offset:32768
ds_read_b64_tr_b16 v[194:195], v12 offset:34816
Mvva 136,228,200
ds_read_b64_tr_b16 v[96:97], v107 offset:6144
Mvva 136,232,208
ds_read_b64_tr_b16 v[196:197], v12 offset:36864
s_waitcnt lgkmcnt(9)
ds_read_b64_tr_b16 v[198:199], v12 offset:38912
Mvva 136,236,216
buffer_load_dwordx4 a[16:19], v112, s[8:11], s52 offen offset:0 sc1
Mvva 152,224,196
s_waitcnt lgkmcnt(5)
ds_read_b64_tr_b16 v[200:201], v12 offset:40960
ds_read_b64_tr_b16 v[202:203], v12 offset:43008
Mvva 152,228,204
Mvva 152,232,212
ds_read_b64_tr_b16 v[204:205], v12 offset:45056
ds_read_b64_tr_b16 v[206:207], v12 offset:47104
Mvva 152,236,220
buffer_load_dwordx4 a[20:23], v112, s[8:11], s52 offen offset:1024 sc1
s_add_u32 s52, s52, 8192
Mvva 140,240,192
ds_read_b64_tr_b16 v[208:209], v13 offset:32768
ds_read_b64_tr_b16 v[210:211], v13 offset:34816
Mvva 140,244,200
s_waitcnt lgkmcnt(8)
Mvvv 82,90,78
Mvva 140,248,208
ds_read_b64_tr_b16 v[212:213], v13 offset:36864
ds_read_b64_tr_b16 v[214:215], v13 offset:38912
Mvva 140,252,216
buffer_load_dwordx4 a[24:27], v112, s[8:11], s52 offen offset:0 sc1
Mvva 156,240,196
s_waitcnt lgkmcnt(4)
ds_read_b64_tr_b16 v[216:217], v13 offset:40960
ds_read_b64_tr_b16 v[218:219], v13 offset:43008
Mvva 156,244,204
Mvvv 86,94,78
Mvva 156,248,212
s_waitcnt vmcnt(15)
ds_read_b64_tr_b16 v[220:221], v13 offset:45056
ds_read_b64_tr_b16 v[222:223], v13 offset:47104
Mvva 156,252,220
buffer_load_dwordx4 a[28:31], v112, s[8:11], s52 offen offset:1024 sc1
s_add_u32 s52, s52, 8192
Mvva 160,192,224
s_add_u32 m0, s44, 16384
ds_read_b64_tr_b16 v[224:225], v14 offset:32768
ds_read_b64_tr_b16 v[226:227], v14 offset:34816
Mvva 160,196,232
buffer_load_dwordx4 v114, s[12:15], s48 offen offset:0 lds
Mvva 160,200,240
ds_read_b64_tr_b16 v[228:229], v14 offset:36864
ds_read_b64_tr_b16 v[230:231], v14 offset:38912
Mvva 160,204,248
Mvva 176,192,228
s_waitcnt lgkmcnt(4)
ds_read_b64_tr_b16 v[232:233], v14 offset:40960
ds_read_b64_tr_b16 v[234:235], v14 offset:43008
Mvva 176,196,236
buffer_load_dwordx4 v114, s[12:15], s49 offen offset:1024 lds
Mvva 176,200,244
ds_read_b64_tr_b16 v[236:237], v14 offset:45056
ds_read_b64_tr_b16 v[238:239], v14 offset:47104
Mvva 176,204,252
buffer_load_dwordx4 v114, s[12:15], s50 offen offset:2048 lds
Mvva 164,208,224
ds_read_b64_tr_b16 v[240:241], v15 offset:32768
ds_read_b64_tr_b16 v[242:243], v15 offset:34816
Mvva 164,212,232
buffer_load_dwordx4 v114, s[12:15], s51 offen offset:3072 lds
v_add_u32 v114, 262144, v114
Mvva 164,216,240
s_waitcnt lgkmcnt(2)
ds_read_b64_tr_b16 v[244:245], v15 offset:36864
ds_read_b64_tr_b16 v[246:247], v15 offset:38912
Mvva 164,220,248
ds_write_b128 v4, v[82:85] offset:2048
ds_write_b128 v4, v[86:89] offset:2112
Mvva 180,208,228
s_waitcnt vmcnt(16)
ds_read_b64_tr_b16 v[248:249], v15 offset:40960
ds_read_b64_tr_b16 v[250:251], v15 offset:43008
Mvva 180,212,236
buffer_load_dwordx4 a[32:35], v112, s[8:11], s52 offen offset:0 sc1
Mvva 180,216,244
s_barrier
ds_read_b64_tr_b16 v[252:253], v15 offset:45056
ds_read_b64_tr_b16 v[254:255], v15 offset:47104
Mvva 180,220,252
buffer_load_dwordx4 a[36:39], v112, s[8:11], s52 offen offset:1024 sc1
s_add_u32 s52, s52, 8192
Mvva 168,224,224
ds_read_b64_tr_b16 v[192:193], v12 offset:49152
ds_read_b64_tr_b16 v[194:195], v12 offset:51200
Mvva 168,228,232
buffer_load_dwordx4 a[40:43], v112, s[8:11], s52 offen offset:0 sc1
Mvva 168,232,240
ds_read_b64_tr_b16 v[196:197], v12 offset:53248
ds_read_b64_tr_b16 v[198:199], v12 offset:55296
Mvva 168,236,248
Mvva 184,224,228
s_waitcnt lgkmcnt(4)
ds_read_b64_tr_b16 v[200:201], v12 offset:57344
ds_read_b64_tr_b16 v[202:203], v12 offset:59392
Mvva 184,228,236
buffer_load_dwordx4 a[44:47], v112, s[8:11], s52 offen offset:1024 sc1
s_add_u32 s52, s52, 8192
Mvva 184,232,244
ds_read_b64_tr_b16 v[204:205], v12 offset:61440
ds_read_b64_tr_b16 v[206:207], v12 offset:63488
Mvva 184,236,252
buffer_load_dwordx4 a[48:51], v112, s[8:11], s52 offen offset:0 sc1
Mvva 172,240,224
ds_read_b64_tr_b16 v[208:209], v13 offset:49152
ds_read_b64_tr_b16 v[210:211], v13 offset:51200
Mvva 172,244,232
buffer_load_dwordx4 a[52:55], v112, s[8:11], s52 offen offset:1024 sc1
s_add_u32 s52, s52, 8192
Mvva 172,248,240
ds_read_b64_tr_b16 v[212:213], v13 offset:53248
ds_read_b64_tr_b16 v[214:215], v13 offset:55296
Mvva 172,252,248
Zvvv 82,98,74
Mvva 188,240,228
s_waitcnt lgkmcnt(4)
ds_read_b64_tr_b16 v[216:217], v13 offset:57344
ds_read_b64_tr_b16 v[218:219], v13 offset:59392
Mvva 188,244,236
buffer_load_dwordx4 a[56:59], v112, s[8:11], s52 offen offset:0 sc1
Mvva 188,248,244
ds_read_b64_tr_b16 v[220:221], v13 offset:61440
ds_read_b64_tr_b16 v[222:223], v13 offset:63488
Mvva 188,252,252
buffer_load_dwordx4 a[60:63], v112, s[8:11], s52 offen offset:1024 sc1
s_add_u32 s52, s52, 8192
Mvva 128,192,224
s_add_u32 m0, s44, 32768
ds_read_b64_tr_b16 v[224:225], v14 offset:49152
ds_read_b64_tr_b16 v[226:227], v14 offset:51200
Mvva 128,196,232
buffer_load_dwordx4 v114, s[12:15], s48 offen offset:0 lds
Mvva 128,200,240
ds_read_b64_tr_b16 v[228:229], v14 offset:53248
ds_read_b64_tr_b16 v[230:231], v14 offset:55296
Mvva 128,204,248
Zvvv 86,102,74
Mvva 144,192,228
s_waitcnt lgkmcnt(4)
ds_read_b64_tr_b16 v[232:233], v14 offset:57344
ds_read_b64_tr_b16 v[234:235], v14 offset:59392
Mvva 144,196,236
buffer_load_dwordx4 v114, s[12:15], s49 offen offset:1024 lds
Mvva 144,200,244
ds_read_b64_tr_b16 v[236:237], v14 offset:61440
ds_read_b64_tr_b16 v[238:239], v14 offset:63488
Mvva 144,204,252
buffer_load_dwordx4 v114, s[12:15], s50 offen offset:2048 lds
Mvva 132,208,224
ds_read_b64_tr_b16 v[240:241], v15 offset:49152
ds_read_b64_tr_b16 v[242:243], v15 offset:51200
Mvva 132,212,232
buffer_load_dwordx4 v114, s[12:15], s51 offen offset:3072 lds
v_add_u32 v114, 262144, v114
Mvva 132,216,240
s_waitcnt lgkmcnt(2)
ds_read_b64_tr_b16 v[244:245], v15 offset:53248
ds_read_b64_tr_b16 v[246:247], v15 offset:55296
Mvva 132,220,248
ds_read_b64_tr_b16 v[98:99], v108 offset:4096
ds_read_b64_tr_b16 v[100:101], v108 offset:6144
ds_read_b64_tr_b16 v[102:103], v109 offset:4096
Mvva 148,208,228
s_waitcnt vmcnt(20)
ds_read_b64_tr_b16 v[248:249], v15 offset:57344
ds_read_b64_tr_b16 v[250:251], v15 offset:59392
Mvva 148,212,236
buffer_load_dwordx4 a[64:67], v112, s[8:11], s52 offen offset:0 sc1
Mvva 148,216,244
s_barrier
ds_read_b64_tr_b16 v[252:253], v15 offset:61440
ds_read_b64_tr_b16 v[254:255], v15 offset:63488
Mvva 148,220,252
buffer_load_dwordx4 a[68:71], v112, s[8:11], s52 offen offset:1024 sc1
s_add_u32 s52, s52, 8192
Mvva 136,224,224
ds_read_b64_tr_b16 v[192:193], v115 offset:0
ds_read_b64_tr_b16 v[194:195], v115 offset:2048
Mvva 136,228,232
buffer_load_dwordx4 a[72:75], v112, s[8:11], s52 offen offset:0 sc1
Mvva 136,232,240
ds_read_b64_tr_b16 v[196:197], v115 offset:4096
ds_read_b64_tr_b16 v[198:199], v115 offset:6144
Mvva 136,236,248
s_waitcnt lgkmcnt(9)
ds_read_b64_tr_b16 v[104:105], v109 offset:6144
Mvva 152,224,228
s_waitcnt lgkmcnt(5)
ds_read_b64_tr_b16 v[200:201], v115 offset:8192
ds_read_b64_tr_b16 v[202:203], v115 offset:10240
Mvva 152,228,236
buffer_load_dwordx4 a[76:79], v112, s[8:11], s52 offen offset:1024 sc1
s_add_u32 s52, s52, 8192
Mvva 152,232,244
ds_read_b64_tr_b16 v[204:205], v115 offset:12288
ds_read_b64_tr_b16 v[206:207], v115 offset:14336
Mvva 152,236,252
buffer_load_dwordx4 a[80:83], v112, s[8:11], s52 offen offset:0 sc1
Mvva 140,240,224
ds_read_b64_tr_b16 v[208:209], v116 offset:0
ds_read_b64_tr_b16 v[210:211], v116 offset:2048
Mvva 140,244,232
buffer_load_dwordx4 a[84:87], v112, s[8:11], s52 offen offset:1024 sc1
s_add_u32 s52, s52, 8192
Mvva 140,248,240
ds_read_b64_tr_b16 v[212:213], v116 offset:4096
ds_read_b64_tr_b16 v[214:215], v116 offset:6144
Mvva 140,252,248
Mvva 156,240,228
s_waitcnt lgkmcnt(4)
ds_read_b64_tr_b16 v[216:217], v116 offset:8192
ds_read_b64_tr_b16 v[218:219], v116 offset:10240
Mvva 156,244,236
buffer_load_dwordx4 a[88:91], v112, s[8:11], s52 offen offset:0 sc1
Mvva 156,248,244
s_waitcnt vmcnt(23)
ds_read_b64_tr_b16 v[220:221], v116 offset:12288
ds_read_b64_tr_b16 v[222:223], v116 offset:14336
Mvva 156,252,252
buffer_load_dwordx4 a[92:95], v112, s[8:11], s52 offen offset:1024 sc1
s_add_u32 s52, s52, 8192
Mvva 160,192,0
s_add_u32 m0, s44, 49152
ds_read_b64_tr_b16 v[224:225], v117 offset:0
ds_read_b64_tr_b16 v[226:227], v117 offset:2048
Mvva 160,196,8
buffer_load_dwordx4 v114, s[12:15], s48 offen offset:0 lds
Mvva 160,200,16
ds_read_b64_tr_b16 v[228:229], v117 offset:4096
ds_read_b64_tr_b16 v[230:231], v117 offset:6144
Mvva 160,204,24
Mvvv 82,98,78
Mvva 176,192,4
s_waitcnt lgkmcnt(4)
ds_read_b64_tr_b16 v[232:233], v117 offset:8192
ds_read_b64_tr_b16 v[234:235], v117 offset:10240
Mvva 176,196,12
buffer_load_dwordx4 v114, s[12:15], s49 offen offset:1024 lds
Mvva 176,200,20
ds_read_b64_tr_b16 v[236:237], v117 offset:12288
ds_read_b64_tr_b16 v[238:239], v117 offset:14336
Mvva 176,204,28
buffer_load_dwordx4 v114, s[12:15], s50 offen offset:2048 lds
Mvva 164,208,0
ds_read_b64_tr_b16 v[240:241], v118 offset:0
ds_read_b64_tr_b16 v[242:243], v118 offset:2048
Mvva 164,212,8
buffer_load_dwordx4 v114, s[12:15], s51 offen offset:3072 lds
v_add_u32 v114, 262144, v114
Mvva 164,216,16
s_waitcnt lgkmcnt(2)
ds_read_b64_tr_b16 v[244:245], v118 offset:4096
ds_read_b64_tr_b16 v[246:247], v118 offset:6144
Mvva 164,220,24
Mvvv 86,102,78
Mvva 180,208,4
s_waitcnt vmcnt(24)
ds_read_b64_tr_b16 v[248:249], v118 offset:8192
ds_read_b64_tr_b16 v[250:251], v118 offset:10240
Mvva 180,212,12
buffer_load_dwordx4 a[96:99], v112, s[8:11], s52 offen offset:0 sc1
Mvva 180,216,20
s_barrier
ds_read_b64_tr_b16 v[252:253], v118 offset:12288
ds_read_b64_tr_b16 v[254:255], v118 offset:14336
Mvva 180,220,28
buffer_load_dwordx4 a[100:103], v112, s[8:11], s52 offen offset:1024 sc1
s_add_u32 s52, s52, 8192
Mvva 168,224,0
ds_read_b64_tr_b16 v[192:193], v115 offset:16384
ds_read_b64_tr_b16 v[194:195], v115 offset:18432
Mvva 168,228,8
buffer_load_dwordx4 a[104:107], v112, s[8:11], s52 offen offset:0 sc1
Mvva 168,232,16
ds_read_b64_tr_b16 v[196:197], v115 offset:20480
ds_read_b64_tr_b16 v[198:199], v115 offset:22528
Mvva 168,236,24
Mvva 184,224,4
s_waitcnt lgkmcnt(4)
ds_read_b64_tr_b16 v[200:201], v115 offset:24576
ds_read_b64_tr_b16 v[202:203], v115 offset:26624
Mvva 184,228,12
buffer_load_dwordx4 a[108:111], v112, s[8:11], s52 offen offset:1024 sc1
s_add_u32 s52, s52, 8192
Mvva 184,232,20
ds_read_b64_tr_b16 v[204:205], v115 offset:28672
ds_read_b64_tr_b16 v[206:207], v115 offset:30720
Mvva 184,236,28
buffer_load_dwordx4 a[112:115], v112, s[8:11], s52 offen offset:0 sc1
Mvva 172,240,0
ds_read_b64_tr_b16 v[208:209], v116 offset:16384
ds_read_b64_tr_b16 v[210:211], v116 offset:18432
Mvva 172,244,8
buffer_load_dwordx4 a[116:119], v112, s[8:11], s52 offen offset:1024 sc1
s_add_u32 s52, s52, 8192
Mvva 172,248,16
ds_read_b64_tr_b16 v[212:213], v116 offset:20480
ds_read_b64_tr_b16 v[214:215], v116 offset:22528
Mvva 172,252,24
ds_write_b128 v4, v[82:85] offset:2176
ds_write_b128 v4, v[86:89] offset:2240
Mvva 188,240,4
s_waitcnt lgkmcnt(6)
ds_read_b64_tr_b16 v[216:217], v116 offset:24576
ds_read_b64_tr_b16 v[218:219], v116 offset:26624
Mvva 188,244,12
buffer_load_dwordx4 a[120:123], v112, s[8:11], s52 offen offset:0 sc1
Mvva 188,248,20
s_waitcnt vmcnt(23)
ds_read_b64_tr_b16 v[220:221], v116 offset:28672
ds_read_b64_tr_b16 v[222:223], v116 offset:30720
Mvva 188,252,28
buffer_load_dwordx4 a[124:127], v112, s[8:11], s52 offen offset:1024 sc1
s_add_u32 s52, s52, 8192
Mvva 160,192,32
s_add_u32 m0, s44, 65536
ds_read_b64_tr_b16 v[224:225], v117 offset:16384
ds_read_b64_tr_b16 v[226:227], v117 offset:18432
Mvva 160,196,40
buffer_load_dwordx4 v114, s[12:15], s48 offen offset:0 lds
Mvva 160,200,48
ds_read_b64_tr_b16 v[228:229], v117 offset:20480
ds_read_b64_tr_b16 v[230:231], v117 offset:22528
Mvva 160,204,56
Mvva 176,192,36
s_waitcnt lgkmcnt(4)
ds_read_b64_tr_b16 v[232:233], v117 offset:24576
ds_read_b64_tr_b16 v[234:235], v117 offset:26624
Mvva 176,196,44
buffer_load_dwordx4 v114, s[12:15], s49 offen offset:1024 lds
Mvva 176,200,52
ds_read_b64_tr_b16 v[236:237], v117 offset:28672
ds_read_b64_tr_b16 v[238:239], v117 offset:30720
Mvva 176,204,60
buffer_load_dwordx4 v114, s[12:15], s50 offen offset:2048 lds
Mvva 164,208,32
ds_read_b64_tr_b16 v[240:241], v118 offset:16384
ds_read_b64_tr_b16 v[242:243], v118 offset:18432
Mvva 164,212,40
buffer_load_dwordx4 v114, s[12:15], s51 offen offset:3072 lds
v_add_u32 v114, 262144, v114
Mvva 164,216,48
s_waitcnt lgkmcnt(2)
ds_read_b64_tr_b16 v[244:245], v118 offset:20480
ds_read_b64_tr_b16 v[246:247], v118 offset:22528
Mvva 164,220,56
Mvva 180,208,36
s_waitcnt vmcnt(24)
ds_read_b64_tr_b16 v[248:249], v118 offset:24576
ds_read_b64_tr_b16 v[250:251], v118 offset:26624
Mvva 180,212,44
buffer_load_dwordx4 a[128:131], v112, s[8:11], s52 offen offset:0 sc1
Mvva 180,216,52
s_barrier
ds_read_b64_tr_b16 v[252:253], v118 offset:28672
ds_read_b64_tr_b16 v[254:255], v118 offset:30720
Mvva 180,220,60
buffer_load_dwordx4 a[132:135], v112, s[8:11], s52 offen offset:1024 sc1
s_add_u32 s52, s52, 8192
Mvva 168,224,32
ds_read_b64_tr_b16 v[192:193], v115 offset:32768
ds_read_b64_tr_b16 v[194:195], v115 offset:34816
Mvva 168,228,40
buffer_load_dwordx4 a[136:139], v112, s[8:11], s52 offen offset:0 sc1
Mvva 168,232,48
ds_read_b64_tr_b16 v[196:197], v115 offset:36864
ds_read_b64_tr_b16 v[198:199], v115 offset:38912
Mvva 168,236,56
ds_read_b64 v[74:75], v6 offset:0
ds_read_b64 v[76:77], v6 offset:8192
ds_read_b64 v[78:79], v6 offset:16384
Mvva 184,224,36
s_waitcnt lgkmcnt(7)
ds_read_b64_tr_b16 v[200:201], v115 offset:40960
ds_read_b64_tr_b16 v[202:203], v115 offset:43008
Mvva 184,228,44
buffer_load_dwordx4 a[140:143], v112, s[8:11], s52 offen offset:1024 sc1
s_add_u32 s52, s52, 8192
Mvva 184,232,52
ds_read_b64_tr_b16 v[204:205], v115 offset:45056
ds_read_b64_tr_b16 v[206:207], v115 offset:47104
Mvva 184,236,60
buffer_load_dwordx4 a[144:147], v112, s[8:11], s52 offen offset:0 sc1
Mvva 172,240,32
ds_read_b64_tr_b16 v[208:209], v116 offset:32768
ds_read_b64_tr_b16 v[210:211], v116 offset:34816
Mvva 172,244,40
buffer_load_dwordx4 a[148:151], v112, s[8:11], s52 offen offset:1024 sc1
s_add_u32 s52, s52, 8192
Mvva 172,248,48
ds_read_b64_tr_b16 v[212:213], v116 offset:36864
ds_read_b64_tr_b16 v[214:215], v116 offset:38912
Mvva 172,252,56
s_waitcnt lgkmcnt(9)
ds_read_b64 v[80:81], v6 offset:24576
Mvva 188,240,36
s_waitcnt lgkmcnt(5)
ds_read_b64_tr_b16 v[216:217], v116 offset:40960
ds_read_b64_tr_b16 v[218:219], v116 offset:43008
Mvva 188,244,44
buffer_load_dwordx4 a[152:155], v112, s[8:11], s52 offen offset:0 sc1
Mvva 188,248,52
s_waitcnt vmcnt(23)
ds_read_b64_tr_b16 v[220:221], v116 offset:45056
ds_read_b64_tr_b16 v[222:223], v116 offset:47104
Mvva 188,252,60
buffer_load_dwordx4 a[156:159], v112, s[8:11], s52 offen offset:1024 sc1
s_add_u32 s52, s52, 8192
Mvva 160,192,64
s_add_u32 m0, s44, 81920
ds_read_b64_tr_b16 v[224:225], v117 offset:32768
ds_read_b64_tr_b16 v[226:227], v117 offset:34816
Mvva 160,196,72
buffer_load_dwordx4 v114, s[12:15], s48 offen offset:0 lds
Mvva 160,200,80
ds_read_b64_tr_b16 v[228:229], v117 offset:36864
ds_read_b64_tr_b16 v[230:231], v117 offset:38912
Mvva 160,204,88
Mvva 176,192,68
s_waitcnt lgkmcnt(4)
ds_read_b64_tr_b16 v[232:233], v117 offset:40960
ds_read_b64_tr_b16 v[234:235], v117 offset:43008
Mvva 176,196,76
buffer_load_dwordx4 v114, s[12:15], s49 offen offset:1024 lds
Mvva 176,200,84
ds_read_b64_tr_b16 v[236:237], v117 offset:45056
ds_read_b64_tr_b16 v[238:239], v117 offset:47104
Mvva 176,204,92
buffer_load_dwordx4 v114, s[12:15], s50 offen offset:2048 lds
Mvva 164,208,64
ds_read_b64_tr_b16 v[240:241], v118 offset:32768
ds_read_b64_tr_b16 v[242:243], v118 offset:34816
Mvva 164,212,72
buffer_load_dwordx4 v114, s[12:15], s51 offen offset:3072 lds
v_add_u32 v114, 262144, v114
Mvva 164,216,80
s_waitcnt lgkmcnt(2)
ds_read_b64_tr_b16 v[244:245], v118 offset:36864
ds_read_b64_tr_b16 v[246:247], v118 offset:38912
Mvva 164,220,88
Va 74,74,76
Va 78,78,80
Va 75,75,77
Mvva 180,208,68
s_waitcnt vmcnt(24)
ds_read_b64_tr_b16 v[248:249], v118 offset:40960
ds_read_b64_tr_b16 v[250:251], v118 offset:43008
Va 79,79,81
Mvva 180,212,76
buffer_load_dwordx4 a[160:163], v112, s[8:11], s52 offen offset:0 sc1
Mvva 180,216,84
s_barrier
ds_read_b64_tr_b16 v[252:253], v118 offset:45056
ds_read_b64_tr_b16 v[254:255], v118 offset:47104
Va 74,74,78
Mvva 180,220,92
buffer_load_dwordx4 a[164:167], v112, s[8:11], s52 offen offset:1024 sc1
s_add_u32 s52, s52, 8192
Mvva 168,224,64
ds_read_b64_tr_b16 v[192:193], v115 offset:49152
ds_read_b64_tr_b16 v[194:195], v115 offset:51200
v_add_f32_e64 v75, v75, v79
Mvva 168,228,72
buffer_load_dwordx4 a[168:171], v112, s[8:11], s52 offen offset:0 sc1
Mvva 168,232,80
ds_read_b64_tr_b16 v[196:197], v115 offset:53248
ds_read_b64_tr_b16 v[198:199], v115 offset:55296
Mvva 168,236,88
buffer_store_dwordx2 v[74:75], v5, s[20:23], s4 offen sc1
Mvva 184,224,68
s_waitcnt lgkmcnt(4)
ds_read_b64_tr_b16 v[200:201], v115 offset:57344
ds_read_b64_tr_b16 v[202:203], v115 offset:59392
Mvva 184,228,76
buffer_load_dwordx4 a[172:175], v112, s[8:11], s52 offen offset:1024 sc1
s_add_u32 s52, s52, 8192
Mvva 184,232,84
ds_read_b64_tr_b16 v[204:205], v115 offset:61440
ds_read_b64_tr_b16 v[206:207], v115 offset:63488
Mvva 184,236,92
buffer_load_dwordx4 a[176:179], v112, s[8:11], s52 offen offset:0 sc1
Mvva 172,240,64
ds_read_b64_tr_b16 v[208:209], v116 offset:49152
ds_read_b64_tr_b16 v[210:211], v116 offset:51200
Mvva 172,244,72
buffer_load_dwordx4 a[180:183], v112, s[8:11], s52 offen offset:1024 sc1
s_add_u32 s52, s52, 8192
Mvva 172,248,80
ds_read_b64_tr_b16 v[212:213], v116 offset:53248
ds_read_b64_tr_b16 v[214:215], v116 offset:55296
Mvva 172,252,88
Mvva 188,240,68
s_waitcnt lgkmcnt(4)
ds_read_b64_tr_b16 v[216:217], v116 offset:57344
ds_read_b64_tr_b16 v[218:219], v116 offset:59392
Mvva 188,244,76
buffer_load_dwordx4 a[184:187], v112, s[8:11], s52 offen offset:0 sc1
Mvva 188,248,84
s_waitcnt vmcnt(24)
ds_read_b64_tr_b16 v[220:221], v116 offset:61440
ds_read_b64_tr_b16 v[222:223], v116 offset:63488
Mvva 188,252,92
buffer_load_dwordx4 a[188:191], v112, s[8:11], s52 offen offset:1024 sc1
s_add_u32 s52, s52, 8192
Mvva 160,192,96
s_add_u32 m0, s44, 98304
ds_read_b64_tr_b16 v[224:225], v117 offset:49152
ds_read_b64_tr_b16 v[226:227], v117 offset:51200
Mvva 160,196,104
buffer_load_dwordx4 v114, s[12:15], s48 offen offset:0 lds
Mvva 160,200,112
ds_read_b64_tr_b16 v[228:229], v117 offset:53248
ds_read_b64_tr_b16 v[230:231], v117 offset:55296
Mvva 160,204,120
Mvva 176,192,100
s_waitcnt lgkmcnt(4)
ds_read_b64_tr_b16 v[232:233], v117 offset:57344
ds_read_b64_tr_b16 v[234:235], v117 offset:59392
Mvva 176,196,108
buffer_load_dwordx4 v114, s[12:15], s49 offen offset:1024 lds
Mvva 176,200,116
ds_read_b64_tr_b16 v[236:237], v117 offset:61440
ds_read_b64_tr_b16 v[238:239], v117 offset:63488
Mvva 176,204,124
buffer_load_dwordx4 v114, s[12:15], s50 offen offset:2048 lds
Mvva 164,208,96
ds_read_b64_tr_b16 v[240:241], v118 offset:49152
ds_read_b64_tr_b16 v[242:243], v118 offset:51200
Mvva 164,212,104
buffer_load_dwordx4 v114, s[12:15], s51 offen offset:3072 lds
v_add_u32 v114, 262144, v114
Mvva 164,216,112
s_waitcnt lgkmcnt(2)
ds_read_b64_tr_b16 v[244:245], v118 offset:53248
ds_read_b64_tr_b16 v[246:247], v118 offset:55296
Mvva 164,220,120
Mvva 180,208,100
s_waitcnt vmcnt(25)
ds_read_b64_tr_b16 v[248:249], v118 offset:57344
ds_read_b64_tr_b16 v[250:251], v118 offset:59392
Mvva 180,212,108
buffer_load_dwordx4 a[192:195], v112, s[8:11], s52 offen offset:0 sc1
Mvva 180,216,116
s_barrier
ds_read_b64_tr_b16 v[252:253], v118 offset:61440
ds_read_b64_tr_b16 v[254:255], v118 offset:63488
Mvva 180,220,124
buffer_load_dwordx4 a[196:199], v112, s[8:11], s52 offen offset:1024 sc1
s_add_u32 s52, s52, 8192
Mvva 168,224,96
ds_read_b64_tr_b16 v[192:193], v12 offset:0
ds_read_b64_tr_b16 v[194:195], v12 offset:2048
Mvva 168,228,104
buffer_load_dwordx4 a[200:203], v112, s[8:11], s52 offen offset:0 sc1
Mvva 168,232,112
ds_read_b64_tr_b16 v[196:197], v12 offset:4096
ds_read_b64_tr_b16 v[198:199], v12 offset:6144
Mvva 168,236,120
Mvva 184,224,100
s_waitcnt lgkmcnt(4)
ds_read_b64_tr_b16 v[200:201], v12 offset:8192
ds_read_b64_tr_b16 v[202:203], v12 offset:10240
Mvva 184,228,108
buffer_load_dwordx4 a[204:207], v112, s[8:11], s52 offen offset:1024 sc1
s_add_u32 s52, s52, 8192
Mvva 184,232,116
ds_read_b64_tr_b16 v[204:205], v12 offset:12288
ds_read_b64_tr_b16 v[206:207], v12 offset:14336
Mvva 184,236,124
buffer_load_dwordx4 a[208:211], v112, s[8:11], s52 offen offset:0 sc1
Mvva 172,240,96
ds_read_b64_tr_b16 v[208:209], v13 offset:0
ds_read_b64_tr_b16 v[210:211], v13 offset:2048
Mvva 172,244,104
buffer_load_dwordx4 a[212:215], v112, s[8:11], s52 offen offset:1024 sc1
s_add_u32 s52, s52, 8192
Mvva 172,248,112
ds_read_b64_tr_b16 v[212:213], v13 offset:4096
ds_read_b64_tr_b16 v[214:215], v13 offset:6144
Mvva 172,252,120
Mvva 188,240,100
s_waitcnt lgkmcnt(4)
ds_read_b64_tr_b16 v[216:217], v13 offset:8192
ds_read_b64_tr_b16 v[218:219], v13 offset:10240
Mvva 188,244,108
buffer_load_dwordx4 a[216:219], v112, s[8:11], s52 offen offset:0 sc1
Mvva 188,248,116
s_waitcnt vmcnt(24)
ds_read_b64_tr_b16 v[220:221], v13 offset:12288
ds_read_b64_tr_b16 v[222:223], v13 offset:14336
Mvva 188,252,124
buffer_load_dwordx4 a[220:223], v112, s[8:11], s52 offen offset:1024 sc1
s_add_u32 s52, s52, 8192
Mvva 160,192,128
s_add_u32 m0, s44, 114688
ds_read_b64_tr_b16 v[224:225], v14 offset:0
ds_read_b64_tr_b16 v[226:227], v14 offset:2048
Mvva 160,196,136
buffer_load_dwordx4 v114, s[12:15], s48 offen offset:0 lds
Mvva 160,200,144
ds_read_b64_tr_b16 v[228:229], v14 offset:4096
ds_read_b64_tr_b16 v[230:231], v14 offset:6144
Mvva 160,204,152
Mvva 176,192,132
s_waitcnt lgkmcnt(4)
ds_read_b64_tr_b16 v[232:233], v14 offset:8192
ds_read_b64_tr_b16 v[234:235], v14 offset:10240
Mvva 176,196,140
buffer_load_dwordx4 v114, s[12:15], s49 offen offset:1024 lds
Mvva 176,200,148
ds_read_b64_tr_b16 v[236:237], v14 offset:12288
ds_read_b64_tr_b16 v[238:239], v14 offset:14336
Mvva 176,204,156
buffer_load_dwordx4 v114, s[12:15], s50 offen offset:2048 lds
Mvva 164,208,128
ds_read_b64_tr_b16 v[240:241], v15 offset:0
ds_read_b64_tr_b16 v[242:243], v15 offset:2048
Mvva 164,212,136
buffer_load_dwordx4 v114, s[12:15], s51 offen offset:3072 lds
s_xor_b32 s95, s95, 128
v_add_u32 v114, s95, v113
Mvva 164,216,144
s_waitcnt lgkmcnt(2)
ds_read_b64_tr_b16 v[244:245], v15 offset:4096
ds_read_b64_tr_b16 v[246:247], v15 offset:6144
Mvva 164,220,152
Mvva 180,208,132
s_waitcnt vmcnt(25)
ds_read_b64_tr_b16 v[248:249], v15 offset:8192
ds_read_b64_tr_b16 v[250:251], v15 offset:10240
Mvva 180,212,140
buffer_load_dwordx4 a[224:227], v112, s[8:11], s52 offen offset:0 sc1
Mvva 180,216,148
s_barrier
ds_read_b64_tr_b16 v[252:253], v15 offset:12288
ds_read_b64_tr_b16 v[254:255], v15 offset:14336
Mvva 180,220,156
buffer_load_dwordx4 a[228:231], v112, s[8:11], s52 offen offset:1024 sc1
s_add_u32 s52, s52, 8192
Mvva 168,224,128
ds_read_b64_tr_b16 v[192:193], v12 offset:16384
ds_read_b64_tr_b16 v[194:195], v12 offset:18432
Mvva 168,228,136
buffer_load_dwordx4 a[232:235], v112, s[8:11], s52 offen offset:0 sc1
Mvva 168,232,144
ds_read_b64_tr_b16 v[196:197], v12 offset:20480
ds_read_b64_tr_b16 v[198:199], v12 offset:22528
Mvva 168,236,152
s_waitcnt vmcnt(24)
s_mov_b64 exec, 1
buffer_store_dword v7, v126, s[20:23], s6 offen sc1
s_mov_b64 exec, -1
Mvva 184,224,132
s_waitcnt lgkmcnt(4)
ds_read_b64_tr_b16 v[200:201], v12 offset:24576
ds_read_b64_tr_b16 v[202:203], v12 offset:26624
Mvva 184,228,140
buffer_load_dwordx4 a[236:239], v112, s[8:11], s52 offen offset:1024 sc1
s_add_u32 s52, s52, 8192
Mvva 184,232,148
ds_read_b64_tr_b16 v[204:205], v12 offset:28672
ds_read_b64_tr_b16 v[206:207], v12 offset:30720
Mvva 184,236,156
buffer_load_dwordx4 a[240:243], v112, s[8:11], s52 offen offset:0 sc1
Mvva 172,240,128
ds_read_b64_tr_b16 v[208:209], v13 offset:16384
ds_read_b64_tr_b16 v[210:211], v13 offset:18432
Mvva 172,244,136
buffer_load_dwordx4 a[244:247], v112, s[8:11], s52 offen offset:1024 sc1
s_add_u32 s52, s52, 8192
Mvva 172,248,144
ds_read_b64_tr_b16 v[212:213], v13 offset:20480
ds_read_b64_tr_b16 v[214:215], v13 offset:22528
Mvva 172,252,152
v_lshlrev_b32 v66, 16, v30
v_and_b32 v67, 0xffff0000, v30
v_lshlrev_b32_e64 v68, 16, v31
Mvva 188,240,132
s_waitcnt lgkmcnt(4)
ds_read_b64_tr_b16 v[216:217], v13 offset:24576
ds_read_b64_tr_b16 v[218:219], v13 offset:26624
v_and_b32 v69, 0xffff0000, v31
Mvva 188,244,140
buffer_load_dwordx4 a[248:251], v112, s[8:11], s52 offen offset:0 sc1
Mvva 188,248,148
s_waitcnt vmcnt(24)
ds_read_b64_tr_b16 v[220:221], v13 offset:28672
ds_read_b64_tr_b16 v[222:223], v13 offset:30720
v_lshlrev_b32_e64 v70, 16, v32
Mvva 188,252,156
buffer_load_dwordx4 a[252:255], v112, s[8:11], s52 offen offset:1024 sc1
s_add_u32 s52, s52, 8192
Mvva 160,192,160
s_add_u32 m0, s44, 0
ds_read_b64_tr_b16 v[224:225], v14 offset:16384
ds_read_b64_tr_b16 v[226:227], v14 offset:18432
Mvva 160,196,168
buffer_load_dwordx4 v114, s[12:15], s48 offen offset:0 lds
Mvva 160,200,176
ds_read_b64_tr_b16 v[228:229], v14 offset:20480
ds_read_b64_tr_b16 v[230:231], v14 offset:22528
Mvva 160,204,184
v_and_b32 v71, 0xffff0000, v32
v_lshlrev_b32 v72, 16, v33
Mvva 176,192,164
s_waitcnt lgkmcnt(4)
ds_read_b64_tr_b16 v[232:233], v14 offset:24576
ds_read_b64_tr_b16 v[234:235], v14 offset:26624
Mvva 176,196,172
buffer_load_dwordx4 v114, s[12:15], s49 offen offset:1024 lds
Mvva 176,200,180
ds_read_b64_tr_b16 v[236:237], v14 offset:28672
ds_read_b64_tr_b16 v[238:239], v14 offset:30720
Mvva 176,204,188
buffer_load_dwordx4 v114, s[12:15], s50 offen offset:2048 lds
Mvva 164,208,160
ds_read_b64_tr_b16 v[240:241], v15 offset:16384
ds_read_b64_tr_b16 v[242:243], v15 offset:18432
Mvva 164,212,168
buffer_load_dwordx4 v114, s[12:15], s51 offen offset:3072 lds
v_add_u32 v114, 262144, v114
Mvva 164,216,176
s_waitcnt lgkmcnt(2)
ds_read_b64_tr_b16 v[244:245], v15 offset:20480
ds_read_b64_tr_b16 v[246:247], v15 offset:22528
Mvva 164,220,184
v_and_b32 v73, 0xffff0000, v33
v_sub_f32_e64 v66, v66, v40
Mvva 180,208,164
s_waitcnt vmcnt(25)
s_add_u32 m0, s44, 16384
ds_read_b64_tr_b16 v[248:249], v15 offset:24576
ds_read_b64_tr_b16 v[250:251], v15 offset:26624
Mvva 180,212,172
buffer_load_dwordx4 v114, s[12:15], s48 offen offset:0 lds
Mvva 180,216,180
s_barrier
ds_read_b64_tr_b16 v[252:253], v15 offset:28672
ds_read_b64_tr_b16 v[254:255], v15 offset:30720
Mvva 180,220,188
buffer_load_dwordx4 v114, s[12:15], s49 offen offset:1024 lds
Mvva 168,224,160
ds_read_b64_tr_b16 v[192:193], v12 offset:32768
ds_read_b64_tr_b16 v[194:195], v12 offset:34816
Mvva 168,228,168
buffer_load_dwordx4 v114, s[12:15], s50 offen offset:2048 lds
Mvva 168,232,176
ds_read_b64_tr_b16 v[196:197], v12 offset:36864
ds_read_b64_tr_b16 v[198:199], v12 offset:38912
Mvva 168,236,184
Vs 67,67,40
Vs 68,68,40
Mvva 184,224,164
s_waitcnt lgkmcnt(4)
ds_read_b64_tr_b16 v[200:201], v12 offset:40960
ds_read_b64_tr_b16 v[202:203], v12 offset:43008
Mvva 184,228,172
buffer_load_dwordx4 v114, s[12:15], s51 offen offset:3072 lds
v_add_u32 v114, 262144, v114
Mvva 184,232,180
s_add_u32 m0, s44, 32768
ds_read_b64_tr_b16 v[204:205], v12 offset:45056
ds_read_b64_tr_b16 v[206:207], v12 offset:47104
Mvva 184,236,188
buffer_load_dwordx4 v114, s[12:15], s48 offen offset:0 lds
Mvva 172,240,160
ds_read_b64_tr_b16 v[208:209], v13 offset:32768
ds_read_b64_tr_b16 v[210:211], v13 offset:34816
Mvva 172,244,168
buffer_load_dwordx4 v114, s[12:15], s49 offen offset:1024 lds
Mvva 172,248,176
ds_read_b64_tr_b16 v[212:213], v13 offset:36864
ds_read_b64_tr_b16 v[214:215], v13 offset:38912
Mvva 172,252,184
Vs 69,69,40
v_sub_f32_e64 v70, v70, v40
Mvva 188,240,164
s_waitcnt lgkmcnt(4)
ds_read_b64_tr_b16 v[216:217], v13 offset:40960
ds_read_b64_tr_b16 v[218:219], v13 offset:43008
Mvva 188,244,172
buffer_load_dwordx4 v114, s[12:15], s50 offen offset:2048 lds
Mvva 188,248,180
s_waitcnt vmcnt(24)
ds_read_b64_tr_b16 v[220:221], v13 offset:45056
ds_read_b64_tr_b16 v[222:223], v13 offset:47104
Mvva 188,252,188
buffer_load_dwordx4 v114, s[12:15], s51 offen offset:3072 lds
v_add_u32 v114, 262144, v114
Mvva 160,192,192
ds_read_b64_tr_b16 v[224:225], v14 offset:32768
ds_read_b64_tr_b16 v[226:227], v14 offset:34816
Mvva 160,196,200
Vs 71,71,40
Vs 72,72,40
Mvva 160,200,208
s_add_u32 m0, s44, 49152
ds_read_b64_tr_b16 v[228:229], v14 offset:36864
ds_read_b64_tr_b16 v[230:231], v14 offset:38912
Mvva 160,204,216
buffer_load_dwordx4 v114, s[12:15], s48 offen offset:0 lds
Mvva 176,192,196
s_waitcnt lgkmcnt(4)
ds_read_b64_tr_b16 v[232:233], v14 offset:40960
ds_read_b64_tr_b16 v[234:235], v14 offset:43008
Mvva 176,196,204
Vs 73,73,40
Vc 2,66,67
Mvva 176,200,212
ds_read_b64_tr_b16 v[236:237], v14 offset:45056
ds_read_b64_tr_b16 v[238:239], v14 offset:47104
Mvva 176,204,220
buffer_load_dwordx4 v114, s[12:15], s49 offen offset:1024 lds
Mvva 164,208,192
ds_read_b64_tr_b16 v[240:241], v15 offset:32768
ds_read_b64_tr_b16 v[242:243], v15 offset:34816
Mvva 164,212,200
v_lshlrev_b32_e64 v66, 16, v2
v_and_b32 v67, 0xffff0000, v2
Mvva 164,216,208
s_waitcnt lgkmcnt(2)
ds_read_b64_tr_b16 v[244:245], v15 offset:36864
ds_read_b64_tr_b16 v[246:247], v15 offset:38912
Mvva 164,220,216
buffer_load_dwordx4 v114, s[12:15], s50 offen offset:2048 lds
Mvva 180,208,196
s_waitcnt vmcnt(24)
ds_read_b64_tr_b16 v[248:249], v15 offset:40960
ds_read_b64_tr_b16 v[250:251], v15 offset:43008
Mvva 180,212,204
Vc 3,68,69
v_lshlrev_b32_e64 v68, 16, v3
Mvva 180,216,212
s_barrier
ds_read_b64_tr_b16 v[252:253], v15 offset:45056
ds_read_b64_tr_b16 v[254:255], v15 offset:47104
Mvva 180,220,220
buffer_load_dwordx4 v114, s[12:15], s51 offen offset:3072 lds
v_add_u32 v114, 262144, v114
Mvva 168,224,192
ds_read_b64_tr_b16 v[192:193], v12 offset:49152
ds_read_b64_tr_b16 v[194:195], v12 offset:51200
Mvva 168,228,200
v_and_b32 v69, 0xffff0000, v3
Vc 4,70,71
Mvva 168,232,208
s_add_u32 m0, s44, 65536
ds_read_b64_tr_b16 v[196:197], v12 offset:53248
ds_read_b64_tr_b16 v[198:199], v12 offset:55296
Mvva 168,236,216
buffer_load_dwordx4 v114, s[12:15], s48 offen offset:0 lds
Mvva 184,224,196
s_waitcnt lgkmcnt(4)
ds_read_b64_tr_b16 v[200:201], v12 offset:57344
ds_read_b64_tr_b16 v[202:203], v12 offset:59392
Mvva 184,228,204
v_lshlrev_b32_e64 v70, 16, v4
v_and_b32 v71, 0xffff0000, v4
Mvva 184,232,212
ds_read_b64_tr_b16 v[204:205], v12 offset:61440
ds_read_b64_tr_b16 v[206:207], v12 offset:63488
Mvva 184,236,220
buffer_load_dwordx4 v114, s[12:15], s49 offen offset:1024 lds
Mvva 172,240,192
ds_read_b64_tr_b16 v[208:209], v13 offset:49152
ds_read_b64_tr_b16 v[210:211], v13 offset:51200
Mvva 172,244,200
Vc 5,72,73
v_lshlrev_b32_e64 v72, 16, v5
Mvva 172,248,208
ds_read_b64_tr_b16 v[212:213], v13 offset:53248
ds_read_b64_tr_b16 v[214:215], v13 offset:55296
Mvva 172,252,216
buffer_load_dwordx4 v114, s[12:15], s50 offen offset:2048 lds
Mvva 188,240,196
s_waitcnt lgkmcnt(4)
ds_read_b64_tr_b16 v[216:217], v13 offset:57344
ds_read_b64_tr_b16 v[218:219], v13 offset:59392
Mvva 188,244,204
v_and_b32 v73, 0xffff0000, v5
Vm 66,66,41
Mvva 188,248,212
s_waitcnt vmcnt(19)
ds_read_b64_tr_b16 v[220:221], v13 offset:61440
ds_read_b64_tr_b16 v[222:223], v13 offset:63488
Mvva 188,252,220
buffer_load_dwordx4 v114, s[12:15], s51 offen offset:3072 lds
v_add_u32 v114, 262144, v114
Mvva 160,192,224
ds_read_b64_tr_b16 v[224:225], v14 offset:49152
ds_read_b64_tr_b16 v[226:227], v14 offset:51200
Mvva 160,196,232
Vm 67,67,41
v_mul_f32_e64 v68, v68, v41
Mvva 160,200,240
ds_read_b64_tr_b16 v[228:229], v14 offset:53248
ds_read_b64_tr_b16 v[230:231], v14 offset:55296
Mvva 160,204,248
Vm 69,69,41
Vm 70,70,41
Mvva 176,192,228
s_waitcnt lgkmcnt(4)
s_add_u32 m0, s44, 81920
ds_read_b64_tr_b16 v[232:233], v14 offset:57344
ds_read_b64_tr_b16 v[234:235], v14 offset:59392
Mvva 176,196,236
buffer_load_dwordx4 v114, s[12:15], s48 offen offset:0 lds
Mvva 176,200,244
ds_read_b64_tr_b16 v[236:237], v14 offset:61440
ds_read_b64_tr_b16 v[238:239], v14 offset:63488
Mvva 176,204,252
Vm 71,71,41
v_mul_f32_e64 v72, v72, v41
Mvva 164,208,224
ds_read_b64_tr_b16 v[240:241], v15 offset:49152
ds_read_b64_tr_b16 v[242:243], v15 offset:51200
Mvva 164,212,232
v_mul_f32_e64 v73, v73, v41
Vc 2,66,67
Mvva 164,216,240
s_waitcnt lgkmcnt(2)
ds_read_b64_tr_b16 v[244:245], v15 offset:53248
ds_read_b64_tr_b16 v[246:247], v15 offset:55296
Mvva 164,220,248
v_lshlrev_b32 v66, 16, v2
v_and_b32 v67, 0xffff0000, v2
Mvva 180,208,228
s_waitcnt vmcnt(17)
ds_read_b64_tr_b16 v[248:249], v15 offset:57344
ds_read_b64_tr_b16 v[250:251], v15 offset:59392
Mvva 180,212,236
buffer_load_dwordx4 v114, s[12:15], s49 offen offset:1024 lds
Mvva 180,216,244
s_barrier
ds_read_b64_tr_b16 v[252:253], v15 offset:61440
ds_read_b64_tr_b16 v[254:255], v15 offset:63488
Mvva 180,220,252
Vc 3,68,69
v_lshlrev_b32_e64 v68, 16, v3
Mvva 168,224,224
ds_read_b64_tr_b16 v[192:193], v115 offset:0
ds_read_b64_tr_b16 v[194:195], v115 offset:2048
Mvva 168,228,232
v_and_b32 v69, 0xffff0000, v3
Vc 4,70,71
Mvva 168,232,240
ds_read_b64_tr_b16 v[196:197], v115 offset:4096
ds_read_b64_tr_b16 v[198:199], v115 offset:6144
Mvva 168,236,248
v_lshlrev_b32_e64 v70, 16, v4
v_and_b32 v71, 0xffff0000, v4
Mvva 184,224,228
s_waitcnt lgkmcnt(4)
ds_read_b64_tr_b16 v[200:201], v115 offset:8192
ds_read_b64_tr_b16 v[202:203], v115 offset:10240
Mvva 184,228,236
buffer_load_dwordx4 v114, s[12:15], s50 offen offset:2048 lds
Mvva 184,232,244
ds_read_b64_tr_b16 v[204:205], v115 offset:12288
ds_read_b64_tr_b16 v[206:207], v115 offset:14336
Mvva 184,236,252
Vc 5,72,73
v_lshlrev_b32 v72, 16, v5
Mvva 172,240,224
ds_read_b64_tr_b16 v[208:209], v116 offset:0
ds_read_b64_tr_b16 v[210:211], v116 offset:2048
Mvva 172,244,232
v_and_b32 v73, 0xffff0000, v5
v_mul_f32 v2, 0xbfb8aa3b, v66
Mvva 172,248,240
ds_read_b64_tr_b16 v[212:213], v116 offset:4096
ds_read_b64_tr_b16 v[214:215], v116 offset:6144
Mvva 172,252,248
v_mul_f32 v3, 0xbfb8aa3b, v67
v_mul_f32 v4, 0xbfb8aa3b, v68
Mvva 188,240,228
s_waitcnt lgkmcnt(4)
ds_read_b64_tr_b16 v[216:217], v116 offset:8192
ds_read_b64_tr_b16 v[218:219], v116 offset:10240
Mvva 188,244,236
buffer_load_dwordx4 v114, s[12:15], s51 offen offset:3072 lds
v_add_u32 v114, 262144, v114
Mvva 188,248,244
ds_read_b64_tr_b16 v[220:221], v116 offset:12288
ds_read_b64_tr_b16 v[222:223], v116 offset:14336
Mvva 188,252,252
v_mul_f32 v5, 0xbfb8aa3b, v69
v_mul_f32 v6, 0xbfb8aa3b, v70
Mvva 128,192,0
ds_read_b64_tr_b16 v[224:225], v117 offset:0
ds_read_b64_tr_b16 v[226:227], v117 offset:2048
Mvva 128,196,8
v_mul_f32 v7, 0xbfb8aa3b, v71
v_mul_f32 v8, 0xbfb8aa3b, v72
Mvva 128,200,16
ds_read_b64_tr_b16 v[228:229], v117 offset:4096
ds_read_b64_tr_b16 v[230:231], v117 offset:6144
Mvva 128,204,24
v_mul_f32 v9, 0xbfb8aa3b, v73
Mvva 144,192,4
s_waitcnt lgkmcnt(4)
s_add_u32 m0, s44, 98304
ds_read_b64_tr_b16 v[232:233], v117 offset:8192
ds_read_b64_tr_b16 v[234:235], v117 offset:10240
Mvva 144,196,12
buffer_load_dwordx4 v114, s[12:15], s48 offen offset:0 lds
Mvva 144,200,20
ds_read_b64_tr_b16 v[236:237], v117 offset:12288
ds_read_b64_tr_b16 v[238:239], v117 offset:14336
Mvva 144,204,28
v_add_u32 v10, 4096, v112
Mvva 132,208,0
ds_read_b64_tr_b16 v[240:241], v118 offset:0
ds_read_b64_tr_b16 v[242:243], v118 offset:2048
Mvva 132,212,8
buffer_store_dwordx4 v[160:163], v112, s[16:19], s26 offen offset:0 sc1
Mvva 132,216,16
s_waitcnt lgkmcnt(2)
ds_read_b64_tr_b16 v[244:245], v118 offset:4096
ds_read_b64_tr_b16 v[246:247], v118 offset:6144
Mvva 132,220,24
buffer_store_dwordx4 v[164:167], v112, s[16:19], s26 offen offset:1024 sc1
Mvva 148,208,4
s_waitcnt vmcnt(19)
ds_read_b64_tr_b16 v[248:249], v118 offset:8192
ds_read_b64_tr_b16 v[250:251], v118 offset:10240
Mvva 148,212,12
buffer_load_dwordx4 v114, s[12:15], s49 offen offset:1024 lds
Mvva 148,216,20
s_barrier
ds_read_b64_tr_b16 v[252:253], v118 offset:12288
ds_read_b64_tr_b16 v[254:255], v118 offset:14336
Mvva 148,220,28
buffer_store_dwordx4 v[168:171], v112, s[16:19], s26 offen offset:2048 sc1
Mvva 136,224,0
ds_read_b64_tr_b16 v[192:193], v115 offset:16384
ds_read_b64_tr_b16 v[194:195], v115 offset:18432
Mvva 136,228,8
buffer_store_dwordx4 v[172:175], v112, s[16:19], s26 offen offset:3072 sc1
Mvva 136,232,16
ds_read_b64_tr_b16 v[196:197], v115 offset:20480
ds_read_b64_tr_b16 v[198:199], v115 offset:22528
Mvva 136,236,24
buffer_store_dwordx4 v[176:179], v10, s[16:19], s26 offen offset:0 sc1
Mvva 152,224,4
s_waitcnt lgkmcnt(4)
ds_read_b64_tr_b16 v[200:201], v115 offset:24576
ds_read_b64_tr_b16 v[202:203], v115 offset:26624
Mvva 152,228,12
buffer_load_dwordx4 v114, s[12:15], s50 offen offset:2048 lds
Mvva 152,232,20
ds_read_b64_tr_b16 v[204:205], v115 offset:28672
ds_read_b64_tr_b16 v[206:207], v115 offset:30720
Mvva 152,236,28
buffer_store_dwordx4 v[180:183], v10, s[16:19], s26 offen offset:1024 sc1
Mvva 140,240,0
ds_read_b64_tr_b16 v[208:209], v116 offset:16384
ds_read_b64_tr_b16 v[210:211], v116 offset:18432
Mvva 140,244,8
buffer_store_dwordx4 v[184:187], v10, s[16:19], s26 offen offset:2048 sc1
Mvva 140,248,16
ds_read_b64_tr_b16 v[212:213], v116 offset:20480
ds_read_b64_tr_b16 v[214:215], v116 offset:22528
Mvva 140,252,24
buffer_store_dwordx4 v[188:191], v10, s[16:19], s26 offen offset:3072 sc1
Mvva 156,240,4
s_waitcnt lgkmcnt(4)
ds_read_b64_tr_b16 v[216:217], v116 offset:24576
ds_read_b64_tr_b16 v[218:219], v116 offset:26624
Mvva 156,244,12
buffer_load_dwordx4 v114, s[12:15], s51 offen offset:3072 lds
v_add_u32 v114, 262144, v114
Mvva 156,248,20
ds_read_b64_tr_b16 v[220:221], v116 offset:28672
ds_read_b64_tr_b16 v[222:223], v116 offset:30720
Mvva 156,252,28
v_mov_b32 v16, 1
Mvva 128,192,32
ds_read_b64_tr_b16 v[224:225], v117 offset:16384
ds_read_b64_tr_b16 v[226:227], v117 offset:18432
Mvva 128,196,40
VE 2,2
Mvva 128,200,48
ds_read_b64_tr_b16 v[228:229], v117 offset:20480
ds_read_b64_tr_b16 v[230:231], v117 offset:22528
Mvva 128,204,56
VE 3,3
Mvva 144,192,36
s_waitcnt lgkmcnt(4)
s_add_u32 m0, s44, 114688
ds_read_b64_tr_b16 v[232:233], v117 offset:24576
ds_read_b64_tr_b16 v[234:235], v117 offset:26624
Mvva 144,196,44
buffer_load_dwordx4 v114, s[12:15], s48 offen offset:0 lds
Mvva 144,200,52
ds_read_b64_tr_b16 v[236:237], v117 offset:28672
ds_read_b64_tr_b16 v[238:239], v117 offset:30720
Mvva 144,204,60
Ve 4,4
Mvva 132,208,32
ds_read_b64_tr_b16 v[240:241], v118 offset:16384
ds_read_b64_tr_b16 v[242:243], v118 offset:18432
Mvva 132,212,40
VE 5,5
Mvva 132,216,48
s_waitcnt lgkmcnt(2)
ds_read_b64_tr_b16 v[244:245], v118 offset:20480
ds_read_b64_tr_b16 v[246:247], v118 offset:22528
Mvva 132,220,56
Ve 6,6
Mvva 148,208,36
s_waitcnt vmcnt(25)
ds_read_b64_tr_b16 v[248:249], v118 offset:24576
ds_read_b64_tr_b16 v[250:251], v118 offset:26624
Mvva 148,212,44
buffer_load_dwordx4 v114, s[12:15], s49 offen offset:1024 lds
Mvva 148,216,52
s_barrier
ds_read_b64_tr_b16 v[252:253], v118 offset:28672
ds_read_b64_tr_b16 v[254:255], v118 offset:30720
Mvva 148,220,60
VE 7,7
Mvva 136,224,32
ds_read_b64_tr_b16 v[192:193], v115 offset:32768
ds_read_b64_tr_b16 v[194:195], v115 offset:34816
Mvva 136,228,40
s_cmp_lg_u32 s53, 0
s_cbranch_scc1 L_yA
L_yAr:
Mvva 136,232,48
ds_read_b64_tr_b16 v[196:197], v115 offset:36864
ds_read_b64_tr_b16 v[198:199], v115 offset:38912
Mvva 136,236,56
VE 8,8
Mvva 152,224,36
s_waitcnt lgkmcnt(4)
ds_read_b64_tr_b16 v[200:201], v115 offset:40960
ds_read_b64_tr_b16 v[202:203], v115 offset:43008
Mvva 152,228,44
buffer_load_dwordx4 v114, s[12:15], s50 offen offset:2048 lds
Mvva 152,232,52
ds_read_b64_tr_b16 v[204:205], v115 offset:45056
ds_read_b64_tr_b16 v[206:207], v115 offset:47104
Mvva 152,236,60
Ve 9,9
Mvva 140,240,32
ds_read_b64_tr_b16 v[208:209], v116 offset:32768
ds_read_b64_tr_b16 v[210:211], v116 offset:34816
Mvva 140,244,40
v_add_f32 v2, 1.0, v2
v_add_f32 v3, 1.0, v3
Mvva 140,248,48
ds_read_b64_tr_b16 v[212:213], v116 offset:36864
ds_read_b64_tr_b16 v[214:215], v116 offset:38912
Mvva 140,252,56
v_add_f32 v4, 1.0, v4
v_add_f32 v5, 1.0, v5
Mvva 156,240,36
s_waitcnt lgkmcnt(4)
ds_read_b64_tr_b16 v[216:217], v116 offset:40960
ds_read_b64_tr_b16 v[218:219], v116 offset:43008
Mvva 156,244,44
buffer_load_dwordx4 v114, s[12:15], s51 offen offset:3072 lds
v_add_u32 v114, 262144, v114
Mvva 156,248,52
ds_read_b64_tr_b16 v[220:221], v116 offset:45056
ds_read_b64_tr_b16 v[222:223], v116 offset:47104
Mvva 156,252,60
v_add_f32 v6, 1.0, v6
v_add_f32_e64 v7, 1.0, v7
Mvva 128,192,64
ds_read_b64_tr_b16 v[224:225], v117 offset:32768
ds_read_b64_tr_b16 v[226:227], v117 offset:34816
Mvva 128,196,72
v_add_f32 v8, 1.0, v8
v_add_f32 v9, 1.0, v9
Mvva 128,200,80
ds_read_b64_tr_b16 v[228:229], v117 offset:36864
ds_read_b64_tr_b16 v[230:231], v117 offset:38912
Mvva 128,204,88
v_rcp_f32_e64 v2, v2
Mvva 144,192,68
s_waitcnt lgkmcnt(4)
ds_read_b64_tr_b16 v[232:233], v117 offset:40960
ds_read_b64_tr_b16 v[234:235], v117 offset:43008
Mvva 144,196,76
v_rcp_f32 v3, v3
Mvva 144,200,84
ds_read_b64_tr_b16 v[236:237], v117 offset:45056
ds_read_b64_tr_b16 v[238:239], v117 offset:47104
Mvva 144,204,92
v_rcp_f32_e64 v4, v4
Mvva 132,208,64
ds_read_b64_tr_b16 v[240:241], v118 offset:32768
ds_read_b64_tr_b16 v[242:243], v118 offset:34816
Mvva 132,212,72
v_rcp_f32_e64 v5, v5
Mvva 132,216,80
s_waitcnt lgkmcnt(2)
ds_read_b64_tr_b16 v[244:245], v118 offset:36864
ds_read_b64_tr_b16 v[246:247], v118 offset:38912
Mvva 132,220,88
v_rcp_f32 v6, v6
Mvva 148,208,68
s_waitcnt vmcnt(24)
ds_read_b64_tr_b16 v[248:249], v118 offset:40960
ds_read_b64_tr_b16 v[250:251], v118 offset:43008
Mvva 148,212,76
v_rcp_f32 v7, v7
Mvva 148,216,84
s_barrier
ds_read_b64_tr_b16 v[252:253], v118 offset:45056
ds_read_b64_tr_b16 v[254:255], v118 offset:47104
Mvva 148,220,92
v_rcp_f32 v8, v8
Mvva 136,224,64
ds_read_b64_tr_b16 v[192:193], v115 offset:49152
ds_read_b64_tr_b16 v[194:195], v115 offset:51200
Mvva 136,228,72
v_rcp_f32_e64 v9, v9
Mvva 136,232,80
ds_read_b64_tr_b16 v[196:197], v115 offset:53248
ds_read_b64_tr_b16 v[198:199], v115 offset:55296
Mvva 136,236,88
Vm 66,66,2
Vm 67,67,3
Mvva 152,224,68
s_waitcnt lgkmcnt(4)
ds_read_b64_tr_b16 v[200:201], v115 offset:57344
ds_read_b64_tr_b16 v[202:203], v115 offset:59392
Mvva 152,228,76
Vm 68,68,4
v_mul_f32_e64 v69, v69, v5
Mvva 152,232,84
ds_read_b64_tr_b16 v[204:205], v115 offset:61440
ds_read_b64_tr_b16 v[206:207], v115 offset:63488
Mvva 152,236,92
Vm 70,70,6
Vm 71,71,7
Mvva 140,240,64
ds_read_b64_tr_b16 v[208:209], v116 offset:49152
ds_read_b64_tr_b16 v[210:211], v116 offset:51200
Mvva 140,244,72
Vm 72,72,8
Vm 73,73,9
Mvva 140,248,80
ds_read_b64_tr_b16 v[212:213], v116 offset:53248
ds_read_b64_tr_b16 v[214:215], v116 offset:55296
Mvva 140,252,88
Vc 2,66,67
v_lshlrev_b32_e64 v66, 16, v2
Mvva 156,240,68
s_waitcnt lgkmcnt(4)
ds_read_b64_tr_b16 v[216:217], v116 offset:57344
ds_read_b64_tr_b16 v[218:219], v116 offset:59392
Mvva 156,244,76
v_and_b32 v67, 0xffff0000, v2
Vc 3,68,69
Mvva 156,248,84
ds_read_b64_tr_b16 v[220:221], v116 offset:61440
ds_read_b64_tr_b16 v[222:223], v116 offset:63488
Mvva 156,252,92
v_lshlrev_b32 v68, 16, v3
v_and_b32 v69, 0xffff0000, v3
Mvva 128,192,96
ds_read_b64_tr_b16 v[224:225], v117 offset:49152
ds_read_b64_tr_b16 v[226:227], v117 offset:51200
Mvva 128,196,104
Vc 4,70,71
v_lshlrev_b32_e64 v70, 16, v4
Mvva 128,200,112
ds_read_b64_tr_b16 v[228:229], v117 offset:53248
ds_read_b64_tr_b16 v[230:231], v117 offset:55296
Mvva 128,204,120
v_and_b32 v71, 0xffff0000, v4
Vc 5,72,73
Mvva 144,192,100
s_waitcnt lgkmcnt(4)
ds_read_b64_tr_b16 v[232:233], v117 offset:57344
ds_read_b64_tr_b16 v[234:235], v117 offset:59392
Mvva 144,196,108
v_lshlrev_b32 v72, 16, v5
v_and_b32 v73, 0xffff0000, v5
Mvva 144,200,116
ds_read_b64_tr_b16 v[236:237], v117 offset:61440
ds_read_b64_tr_b16 v[238:239], v117 offset:63488
Mvva 144,204,124
s_waitcnt vmcnt(5)
s_mov_b64 exec, 1
buffer_store_dword v16, v126, s[20:23], s27 offen sc1
s_mov_b64 exec, -1
Mvva 132,208,96
ds_read_b64_tr_b16 v[240:241], v118 offset:49152
ds_read_b64_tr_b16 v[242:243], v118 offset:51200
Mvva 132,212,104
Mvva 132,216,112
s_waitcnt lgkmcnt(2)
ds_read_b64_tr_b16 v[244:245], v118 offset:53248
ds_read_b64_tr_b16 v[246:247], v118 offset:55296
Mvva 132,220,120
Mvva 148,208,100
ds_read_b64_tr_b16 v[248:249], v118 offset:57344
ds_read_b64_tr_b16 v[250:251], v118 offset:59392
Mvva 148,212,108
Mvva 148,216,116
s_barrier
ds_read_b64_tr_b16 v[252:253], v118 offset:61440
ds_read_b64_tr_b16 v[254:255], v118 offset:63488
Mvva 148,220,124
Mvva 136,224,96
ds_read_b64_tr_b16 v[192:193], v12 offset:0
ds_read_b64_tr_b16 v[194:195], v12 offset:2048
Mvva 136,228,104
Mvva 136,232,112
ds_read_b64_tr_b16 v[196:197], v12 offset:4096
ds_read_b64_tr_b16 v[198:199], v12 offset:6144
Mvva 136,236,120
Mvva 152,224,100
s_waitcnt lgkmcnt(4)
ds_read_b64_tr_b16 v[200:201], v12 offset:8192
ds_read_b64_tr_b16 v[202:203], v12 offset:10240
Mvva 152,228,108
Mvva 152,232,116
ds_read_b64_tr_b16 v[204:205], v12 offset:12288
ds_read_b64_tr_b16 v[206:207], v12 offset:14336
Mvva 152,236,124
s_cmp_lg_u32 s53, 0
s_cbranch_scc1 L_yB
L_yBr:
Mvva 140,240,96
ds_read_b64_tr_b16 v[208:209], v13 offset:0
ds_read_b64_tr_b16 v[210:211], v13 offset:2048
Mvva 140,244,104
Mvva 140,248,112
ds_read_b64_tr_b16 v[212:213], v13 offset:4096
ds_read_b64_tr_b16 v[214:215], v13 offset:6144
Mvva 140,252,120
Mvva 156,240,100
s_waitcnt lgkmcnt(4)
ds_read_b64_tr_b16 v[216:217], v13 offset:8192
ds_read_b64_tr_b16 v[218:219], v13 offset:10240
Mvva 156,244,108
Mvva 156,248,116
ds_read_b64_tr_b16 v[220:221], v13 offset:12288
ds_read_b64_tr_b16 v[222:223], v13 offset:14336
Mvva 156,252,124
Mvva 128,192,128
ds_read_b64_tr_b16 v[224:225], v14 offset:0
ds_read_b64_tr_b16 v[226:227], v14 offset:2048
Mvva 128,196,136
Mvva 128,200,144
ds_read_b64_tr_b16 v[228:229], v14 offset:4096
ds_read_b64_tr_b16 v[230:231], v14 offset:6144
Mvva 128,204,152
Mvva 144,192,132
s_waitcnt lgkmcnt(4)
ds_read_b64_tr_b16 v[232:233], v14 offset:8192
ds_read_b64_tr_b16 v[234:235], v14 offset:10240
Mvva 144,196,140
Mvva 144,200,148
ds_read_b64_tr_b16 v[236:237], v14 offset:12288
ds_read_b64_tr_b16 v[238:239], v14 offset:14336
Mvva 144,204,156
Mvva 132,208,128
ds_read_b64_tr_b16 v[240:241], v15 offset:0
ds_read_b64_tr_b16 v[242:243], v15 offset:2048
Mvva 132,212,136
Mvva 132,216,144
s_waitcnt lgkmcnt(2)
ds_read_b64_tr_b16 v[244:245], v15 offset:4096
ds_read_b64_tr_b16 v[246:247], v15 offset:6144
Mvva 132,220,152
Mvva 148,208,132
ds_read_b64_tr_b16 v[248:249], v15 offset:8192
ds_read_b64_tr_b16 v[250:251], v15 offset:10240
Mvva 148,212,140
Mvva 148,216,148
s_barrier
ds_read_b64_tr_b16 v[252:253], v15 offset:12288
ds_read_b64_tr_b16 v[254:255], v15 offset:14336
Mvva 148,220,156
Mvva 136,224,128
ds_read_b64_tr_b16 v[192:193], v12 offset:16384
ds_read_b64_tr_b16 v[194:195], v12 offset:18432
Mvva 136,228,136
Mvva 136,232,144
ds_read_b64_tr_b16 v[196:197], v12 offset:20480
ds_read_b64_tr_b16 v[198:199], v12 offset:22528
Mvva 136,236,152
Mvva 152,224,132
s_waitcnt lgkmcnt(4)
ds_read_b64_tr_b16 v[200:201], v12 offset:24576
ds_read_b64_tr_b16 v[202:203], v12 offset:26624
Mvva 152,228,140
buffer_load_dword v17, v126, s[20:23], s24 offen sc1
Mvva 152,232,148
ds_read_b64_tr_b16 v[204:205], v12 offset:28672
ds_read_b64_tr_b16 v[206:207], v12 offset:30720
Mvva 152,236,156
Mvva 140,240,128
ds_read_b64_tr_b16 v[208:209], v13 offset:16384
ds_read_b64_tr_b16 v[210:211], v13 offset:18432
Mvva 140,244,136
Mvva 140,248,144
ds_read_b64_tr_b16 v[212:213], v13 offset:20480
ds_read_b64_tr_b16 v[214:215], v13 offset:22528
Mvva 140,252,152
Mvva 156,240,132
s_waitcnt lgkmcnt(4)
ds_read_b64_tr_b16 v[216:217], v13 offset:24576
ds_read_b64_tr_b16 v[218:219], v13 offset:26624
Mvva 156,244,140
Mvva 156,248,148
ds_read_b64_tr_b16 v[220:221], v13 offset:28672
ds_read_b64_tr_b16 v[222:223], v13 offset:30720
Mvva 156,252,156
Mvva 128,192,160
ds_read_b64_tr_b16 v[224:225], v14 offset:16384
ds_read_b64_tr_b16 v[226:227], v14 offset:18432
Mvva 128,196,168
Mvva 128,200,176
ds_read_b64_tr_b16 v[228:229], v14 offset:20480
ds_read_b64_tr_b16 v[230:231], v14 offset:22528
Mvva 128,204,184
Mvva 144,192,164
s_waitcnt lgkmcnt(4)
ds_read_b64_tr_b16 v[232:233], v14 offset:24576
ds_read_b64_tr_b16 v[234:235], v14 offset:26624
Mvva 144,196,172
Mvva 144,200,180
ds_read_b64_tr_b16 v[236:237], v14 offset:28672
ds_read_b64_tr_b16 v[238:239], v14 offset:30720
Mvva 144,204,188
Mvva 132,208,160
ds_read_b64_tr_b16 v[240:241], v15 offset:16384
ds_read_b64_tr_b16 v[242:243], v15 offset:18432
Mvva 132,212,168
Mvva 132,216,176
s_waitcnt lgkmcnt(2)
ds_read_b64_tr_b16 v[244:245], v15 offset:20480
ds_read_b64_tr_b16 v[246:247], v15 offset:22528
Mvva 132,220,184
Mvva 148,208,164
s_waitcnt vmcnt(6)
ds_read_b64_tr_b16 v[248:249], v15 offset:24576
ds_read_b64_tr_b16 v[250:251], v15 offset:26624
Mvva 148,212,172
Mvva 148,216,180
s_barrier
ds_read_b64_tr_b16 v[252:253], v15 offset:28672
ds_read_b64_tr_b16 v[254:255], v15 offset:30720
Mvva 148,220,188
Mvva 136,224,160
ds_read_b64_tr_b16 v[192:193], v12 offset:32768
ds_read_b64_tr_b16 v[194:195], v12 offset:34816
Mvva 136,228,168
s_cmp_lg_u32 s40, 0
s_cbranch_scc1 L_yC
L_yCr:
Mvva 136,232,176
ds_read_b64_tr_b16 v[196:197], v12 offset:36864
ds_read_b64_tr_b16 v[198:199], v12 offset:38912
Mvva 136,236,184
Mvva 152,224,164
s_waitcnt lgkmcnt(4)
ds_read_b64_tr_b16 v[200:201], v12 offset:40960
ds_read_b64_tr_b16 v[202:203], v12 offset:43008
Mvva 152,228,172
Mvva 152,232,180
ds_read_b64_tr_b16 v[204:205], v12 offset:45056
ds_read_b64_tr_b16 v[206:207], v12 offset:47104
Mvva 152,236,188
Mvva 140,240,160
ds_read_b64_tr_b16 v[208:209], v13 offset:32768
ds_read_b64_tr_b16 v[210:211], v13 offset:34816
Mvva 140,244,168
Mvva 140,248,176
ds_read_b64_tr_b16 v[212:213], v13 offset:36864
ds_read_b64_tr_b16 v[214:215], v13 offset:38912
Mvva 140,252,184
s_waitcnt vmcnt(0)
v_cmp_ne_u32 vcc, 1, v17
s_mov_b32 s33, 0
s_cbranch_vccnz L_xno
s_nop 0
buffer_load_dwordx4 v[160:163], v112, s[16:19], s25 offen offset:0 sc1
buffer_load_dwordx4 v[164:167], v112, s[16:19], s25 offen offset:1024 sc1
buffer_load_dwordx4 v[168:171], v112, s[16:19], s25 offen offset:2048 sc1
buffer_load_dwordx4 v[172:175], v112, s[16:19], s25 offen offset:3072 sc1
buffer_load_dwordx4 v[176:179], v10, s[16:19], s25 offen offset:0 sc1
buffer_load_dwordx4 v[180:183], v10, s[16:19], s25 offen offset:1024 sc1
buffer_load_dwordx4 v[184:187], v10, s[16:19], s25 offen offset:2048 sc1
buffer_load_dwordx4 v[188:191], v10, s[16:19], s25 offen offset:3072 sc1
s_mov_b32 s33, 1
L_xno:
Mvva 156,240,164
s_waitcnt lgkmcnt(4)
ds_read_b64_tr_b16 v[216:217], v13 offset:40960
ds_read_b64_tr_b16 v[218:219], v13 offset:43008
Mvva 156,244,172
Mvva 156,248,180
ds_read_b64_tr_b16 v[220:221], v13 offset:45056
ds_read_b64_tr_b16 v[222:223], v13 offset:47104
Mvva 156,252,188
Mvva 128,192,192
ds_read_b64_tr_b16 v[224:225], v14 offset:32768
ds_read_b64_tr_b16 v[226:227], v14 offset:34816
Mvva 128,196,200
Mvva 128,200,208
ds_read_b64_tr_b16 v[228:229], v14 offset:36864
ds_read_b64_tr_b16 v[230:231], v14 offset:38912
Mvva 128,204,216
Mvva 144,192,196
s_waitcnt lgkmcnt(4)
ds_read_b64_tr_b16 v[232:233], v14 offset:40960
ds_read_b64_tr_b16 v[234:235], v14 offset:43008
Mvva 144,196,204
Mvva 144,200,212
ds_read_b64_tr_b16 v[236:237], v14 offset:45056
ds_read_b64_tr_b16 v[238:239], v14 offset:47104
Mvva 144,204,220
Mvva 132,208,192
ds_read_b64_tr_b16 v[240:241], v15 offset:32768
ds_read_b64_tr_b16 v[242:243], v15 offset:34816
Mvva 132,212,200
Mvva 132,216,208
s_waitcnt lgkmcnt(2)
ds_read_b64_tr_b16 v[244:245], v15 offset:36864
ds_read_b64_tr_b16 v[246:247], v15 offset:38912
Mvva 132,220,216
Mvva 148,208,196
ds_read_b64_tr_b16 v[248:249], v15 offset:40960
ds_read_b64_tr_b16 v[250:251], v15 offset:43008
Mvva 148,212,204
Mvva 148,216,212
s_barrier
ds_read_b64_tr_b16 v[252:253], v15 offset:45056
ds_read_b64_tr_b16 v[254:255], v15 offset:47104
Mvva 148,220,220
Mvva 136,224,192
ds_read_b64_tr_b16 v[192:193], v12 offset:49152
ds_read_b64_tr_b16 v[194:195], v12 offset:51200
Mvva 136,228,200
Mvva 136,232,208
ds_read_b64_tr_b16 v[196:197], v12 offset:53248
ds_read_b64_tr_b16 v[198:199], v12 offset:55296
Mvva 136,236,216
Mvva 152,224,196
s_waitcnt lgkmcnt(4)
ds_read_b64_tr_b16 v[200:201], v12 offset:57344
ds_read_b64_tr_b16 v[202:203], v12 offset:59392
Mvva 152,228,204
Mvva 152,232,212
ds_read_b64_tr_b16 v[204:205], v12 offset:61440
ds_read_b64_tr_b16 v[206:207], v12 offset:63488
Mvva 152,236,220
Mvva 140,240,192
ds_read_b64_tr_b16 v[208:209], v13 offset:49152
ds_read_b64_tr_b16 v[210:211], v13 offset:51200
Mvva 140,244,200
Mvva 140,248,208
ds_read_b64_tr_b16 v[212:213], v13 offset:53248
ds_read_b64_tr_b16 v[214:215], v13 offset:55296
Mvva 140,252,216
Mvva 156,240,196
s_waitcnt lgkmcnt(4)
ds_read_b64_tr_b16 v[216:217], v13 offset:57344
ds_read_b64_tr_b16 v[218:219], v13 offset:59392
Mvva 156,244,204
Mvva 156,248,212
ds_read_b64_tr_b16 v[220:221], v13 offset:61440
ds_read_b64_tr_b16 v[222:223], v13 offset:63488
Mvva 156,252,220
Mvva 128,192,224
ds_read_b64_tr_b16 v[224:225], v14 offset:49152
ds_read_b64_tr_b16 v[226:227], v14 offset:51200
Mvva 128,196,232
Mvva 128,200,240
ds_read_b64_tr_b16 v[228:229], v14 offset:53248
ds_read_b64_tr_b16 v[230:231], v14 offset:55296
Mvva 128,204,248
Mvva 144,192,228
s_waitcnt lgkmcnt(4)
ds_read_b64_tr_b16 v[232:233], v14 offset:57344
ds_read_b64_tr_b16 v[234:235], v14 offset:59392
Mvva 144,196,236
Mvva 144,200,244
ds_read_b64_tr_b16 v[236:237], v14 offset:61440
ds_read_b64_tr_b16 v[238:239], v14 offset:63488
Mvva 144,204,252
Mvva 132,208,224
ds_read_b64_tr_b16 v[240:241], v15 offset:49152
ds_read_b64_tr_b16 v[242:243], v15 offset:51200
Mvva 132,212,232
Mvva 132,216,240
s_waitcnt lgkmcnt(2)
ds_read_b64_tr_b16 v[244:245], v15 offset:53248
ds_read_b64_tr_b16 v[246:247], v15 offset:55296
Mvva 132,220,248
Mvva 148,208,228
ds_read_b64_tr_b16 v[248:249], v15 offset:57344
ds_read_b64_tr_b16 v[250:251], v15 offset:59392
Mvva 148,212,236
Mvva 148,216,244
ds_read_b64_tr_b16 v[252:253], v15 offset:61440
ds_read_b64_tr_b16 v[254:255], v15 offset:63488
Mvva 148,220,252
Mvva 136,224,224
Mvva 136,228,232
Mvva 136,232,240
Mvva 136,236,248
Mvva 152,224,228
s_waitcnt lgkmcnt(0)
Mvva 152,228,236
Mvva 152,232,244
Mvva 152,236,252
Mvva 140,240,224
Mvva 140,244,232
Mvva 140,248,240
Mvva 140,252,248
Mvva 156,240,228
Mvva 156,244,236
Mvva 156,248,244
Mvva 156,252,252
s_cmp_lg_u32 s53, s40
s_cbranch_scc1 L_ysl
L_yslr:
v_and_b32 v124, 15, v0
v_lshlrev_b32 v74, 8, v124
v_add_u32 v74, s35, v74
v_xor_b32 v124, v124, v121
v_lshl_add_u32 v74, v124, 4, v74
v_xor_b32_e64 v75, 64, v74
v_xor_b32 v76, 128, v74
v_xor_b32 v77, 192, v74
v_lshlrev_b32 v125, 1, v122
v_xor_b32 v124, v123, v125
v_lshlrev_b32 v12, 8, v123
v_add_u32 v12, s35, v12
v_lshl_add_u32 v12, v124, 4, v12
v_xor_b32_e64 v13, 16, v12
v_xor_b32 v14, 128, v12
v_xor_b32 v15, 144, v12
s_cmp_eq_u32 s33, 0
s_cbranch_scc1 L_spinX
L_spinXr:
v_lshlrev_b32_e64 v80, 16, v18
v_and_b32 v81, 0xffff0000, v18
v_lshlrev_b32_e64 v82, 16, v19
v_and_b32 v83, 0xffff0000, v19
v_lshlrev_b32_e64 v84, 16, v20
v_and_b32 v85, 0xffff0000, v20
v_lshlrev_b32_e64 v86, 16, v21
v_and_b32 v87, 0xffff0000, v21
v_lshlrev_b32_e64 v88, 16, v22
v_and_b32 v89, 0xffff0000, v22
v_lshlrev_b32_e64 v90, 16, v23
v_and_b32 v91, 0xffff0000, v23
v_lshlrev_b32_e64 v92, 16, v24
v_and_b32 v93, 0xffff0000, v24
v_lshlrev_b32_e64 v94, 16, v25
v_and_b32 v95, 0xffff0000, v25
v_lshlrev_b32_e64 v96, 16, v26
v_and_b32 v97, 0xffff0000, v26
v_lshlrev_b32_e64 v98, 16, v27
v_and_b32 v99, 0xffff0000, v27
v_lshlrev_b32_e64 v100, 16, v28
v_and_b32 v101, 0xffff0000, v28
v_lshlrev_b32_e64 v102, 16, v29
v_and_b32 v103, 0xffff0000, v29
v_lshlrev_b32_e64 v104, 16, v30
v_and_b32 v105, 0xffff0000, v30
v_lshlrev_b32_e64 v106, 16, v31
v_and_b32 v107, 0xffff0000, v31
v_lshlrev_b32_e64 v108, 16, v32
v_and_b32 v109, 0xffff0000, v32
v_lshlrev_b32_e64 v110, 16, v33
v_and_b32 v111, 0xffff0000, v33
s_waitcnt vmcnt(0)
s_nop 0
v_pk_add_f32 v[128:129], v[128:129], v[160:161]
v_pk_add_f32 v[130:131], v[130:131], v[162:163]
ds_write_b128 v74, v[128:131] offset:0
v_pk_add_f32 v[132:133], v[132:133], v[164:165]
v_pk_add_f32 v[134:135], v[134:135], v[166:167]
ds_write_b128 v75, v[132:135] offset:0
v_pk_add_f32 v[136:137], v[136:137], v[168:169]
v_pk_add_f32 v[138:139], v[138:139], v[170:171]
ds_write_b128 v76, v[136:139] offset:0
v_pk_add_f32 v[140:141], v[140:141], v[172:173]
v_pk_add_f32 v[142:143], v[142:143], v[174:175]
ds_write_b128 v77, v[140:143] offset:0
v_pk_add_f32 v[144:145], v[144:145], v[176:177]
v_pk_add_f32 v[146:147], v[146:147], v[178:179]
ds_write_b128 v74, v[144:147] offset:4096
v_pk_add_f32 v[148:149], v[148:149], v[180:181]
v_pk_add_f32 v[150:151], v[150:151], v[182:183]
ds_write_b128 v75, v[148:151] offset:4096
v_pk_add_f32 v[152:153], v[152:153], v[184:185]
v_pk_add_f32 v[154:155], v[154:155], v[186:187]
ds_write_b128 v76, v[152:155] offset:4096
v_pk_add_f32 v[156:157], v[156:157], v[188:189]
v_pk_add_f32 v[158:159], v[158:159], v[190:191]
ds_write_b128 v77, v[156:159] offset:4096
Rv 192,12,0
Rv 196,13,0
Rv 200,14,2048
Rv 204,15,2048
Rv 208,12,4096
Rv 212,13,4096
Rv 216,14,6144
s_waitcnt lgkmcnt(9)
Rv 220,15,6144
s_waitcnt lgkmcnt(6)
Vc 224,192,193
v_lshlrev_b32_e64 v192, 16, v224
v_and_b32 v193, 0xffff0000, v224
Vc 225,194,195
v_lshlrev_b32_e64 v194, 16, v225
v_and_b32 v195, 0xffff0000, v225
Vc 226,196,197
v_lshlrev_b32_e64 v196, 16, v226
v_and_b32 v197, 0xffff0000, v226
Vc 227,198,199
v_lshlrev_b32_e64 v198, 16, v227
v_and_b32 v199, 0xffff0000, v227
v_pk_mul_f32 v[192:193], v[192:193], v[42:43]
v_pk_mul_f32 v[194:195], v[194:195], v[44:45]
v_pk_mul_f32 v[196:197], v[196:197], v[46:47]
v_pk_mul_f32 v[198:199], v[198:199], v[48:49]
Vc 224,192,193
v_lshlrev_b32_e64 v192, 16, v224
v_and_b32 v193, 0xffff0000, v224
Vc 225,194,195
v_lshlrev_b32_e64 v194, 16, v225
v_and_b32 v195, 0xffff0000, v225
Vc 226,196,197
v_lshlrev_b32_e64 v196, 16, v226
v_and_b32 v197, 0xffff0000, v226
Vc 227,198,199
v_lshlrev_b32_e64 v198, 16, v227
v_and_b32 v199, 0xffff0000, v227
v_pk_add_f32 v[192:193], v[192:193], v[80:81]
v_pk_add_f32 v[194:195], v[194:195], v[82:83]
v_pk_add_f32 v[196:197], v[196:197], v[84:85]
v_pk_add_f32 v[198:199], v[198:199], v[86:87]
Vc 224,192,193
Vc 225,194,195
Vc 226,196,197
Vc 227,198,199
buffer_store_dwordx4 v[224:227], v119, s[68:71], s36 offen sc1
s_add_u32 s36, s36, 16384
s_waitcnt lgkmcnt(4)
Vc 228,200,201
v_lshlrev_b32 v200, 16, v228
v_and_b32 v201, 0xffff0000, v228
Vc 229,202,203
v_lshlrev_b32_e64 v202, 16, v229
v_and_b32 v203, 0xffff0000, v229
Vc 230,204,205
v_lshlrev_b32_e64 v204, 16, v230
v_and_b32 v205, 0xffff0000, v230
Vc 231,206,207
v_lshlrev_b32_e64 v206, 16, v231
v_and_b32 v207, 0xffff0000, v231
v_pk_mul_f32 v[200:201], v[200:201], v[50:51]
v_pk_mul_f32 v[202:203], v[202:203], v[52:53]
v_pk_mul_f32 v[204:205], v[204:205], v[54:55]
v_pk_mul_f32 v[206:207], v[206:207], v[56:57]
Vc 228,200,201
v_lshlrev_b32_e64 v200, 16, v228
v_and_b32 v201, 0xffff0000, v228
Vc 229,202,203
v_lshlrev_b32_e64 v202, 16, v229
v_and_b32 v203, 0xffff0000, v229
Vc 230,204,205
v_lshlrev_b32_e64 v204, 16, v230
v_and_b32 v205, 0xffff0000, v230
Vc 231,206,207
v_lshlrev_b32_e64 v206, 16, v231
v_and_b32 v207, 0xffff0000, v231
v_pk_add_f32 v[200:201], v[200:201], v[88:89]
v_pk_add_f32 v[202:203], v[202:203], v[90:91]
v_pk_add_f32 v[204:205], v[204:205], v[92:93]
v_pk_add_f32 v[206:207], v[206:207], v[94:95]
Vc 228,200,201
Vc 229,202,203
Vc 230,204,205
Vc 231,206,207
buffer_store_dwordx4 v[228:231], v119, s[68:71], s36 offen sc1
s_add_u32 s36, s36, 16384
s_waitcnt lgkmcnt(2)
Vc 232,208,209
v_lshlrev_b32 v208, 16, v232
v_and_b32 v209, 0xffff0000, v232
Vc 233,210,211
v_lshlrev_b32_e64 v210, 16, v233
v_and_b32 v211, 0xffff0000, v233
Vc 234,212,213
v_lshlrev_b32_e64 v212, 16, v234
v_and_b32 v213, 0xffff0000, v234
Vc 235,214,215
v_lshlrev_b32_e64 v214, 16, v235
v_and_b32 v215, 0xffff0000, v235
v_pk_mul_f32 v[208:209], v[208:209], v[58:59]
v_pk_mul_f32 v[210:211], v[210:211], v[60:61]
v_pk_mul_f32 v[212:213], v[212:213], v[62:63]
v_pk_mul_f32 v[214:215], v[214:215], v[64:65]
Vc 232,208,209
v_lshlrev_b32_e64 v208, 16, v232
v_and_b32 v209, 0xffff0000, v232
Vc 233,210,211
v_lshlrev_b32_e64 v210, 16, v233
v_and_b32 v211, 0xffff0000, v233
Vc 234,212,213
v_lshlrev_b32_e64 v212, 16, v234
v_and_b32 v213, 0xffff0000, v234
Vc 235,214,215
v_lshlrev_b32_e64 v214, 16, v235
v_and_b32 v215, 0xffff0000, v235
v_pk_add_f32 v[208:209], v[208:209], v[96:97]
v_pk_add_f32 v[210:211], v[210:211], v[98:99]
v_pk_add_f32 v[212:213], v[212:213], v[100:101]
v_pk_add_f32 v[214:215], v[214:215], v[102:103]
Vc 232,208,209
Vc 233,210,211
Vc 234,212,213
Vc 235,214,215
buffer_store_dwordx4 v[232:235], v119, s[68:71], s36 offen sc1
s_add_u32 s36, s36, 16384
s_waitcnt lgkmcnt(0)
Vc 236,216,217
v_lshlrev_b32 v216, 16, v236
v_and_b32 v217, 0xffff0000, v236
Vc 237,218,219
v_lshlrev_b32_e64 v218, 16, v237
v_and_b32 v219, 0xffff0000, v237
Vc 238,220,221
v_lshlrev_b32_e64 v220, 16, v238
v_and_b32 v221, 0xffff0000, v238
Vc 239,222,223
v_lshlrev_b32_e64 v222, 16, v239
v_and_b32 v223, 0xffff0000, v239
v_pk_mul_f32 v[216:217], v[216:217], v[66:67]
v_pk_mul_f32 v[218:219], v[218:219], v[68:69]
v_pk_mul_f32 v[220:221], v[220:221], v[70:71]
v_pk_mul_f32 v[222:223], v[222:223], v[72:73]
Vc 236,216,217
v_lshlrev_b32_e64 v216, 16, v236
v_and_b32 v217, 0xffff0000, v236
Vc 237,218,219
v_lshlrev_b32_e64 v218, 16, v237
v_and_b32 v219, 0xffff0000, v237
Vc 238,220,221
v_lshlrev_b32_e64 v220, 16, v238
v_and_b32 v221, 0xffff0000, v238
Vc 239,222,223
v_lshlrev_b32_e64 v222, 16, v239
v_and_b32 v223, 0xffff0000, v239
v_pk_add_f32 v[216:217], v[216:217], v[104:105]
v_pk_add_f32 v[218:219], v[218:219], v[106:107]
v_pk_add_f32 v[220:221], v[220:221], v[108:109]
v_pk_add_f32 v[222:223], v[222:223], v[110:111]
Vc 236,216,217
Vc 237,218,219
Vc 238,220,221
Vc 239,222,223
buffer_store_dwordx4 v[236:239], v119, s[68:71], s36 offen sc1
L_k2_end:
s_endpgm
L_spinC:
s_add_u32 m0, s35, 0
s_nop 0
s_nop 0
buffer_load_dwordx4 v125, s[60:63], s48 offen offset:0 lds
buffer_load_dwordx4 v125, s[60:63], s49 offen offset:1024 lds
buffer_load_dwordx4 v125, s[60:63], s50 offen offset:2048 lds
buffer_load_dwordx4 v125, s[60:63], s51 offen offset:3072 lds
v_add_u32 v125, 65536, v125
s_add_u32 m0, s35, 4096
s_nop 0
buffer_load_dwordx4 v125, s[60:63], s48 offen offset:0 lds
buffer_load_dwordx4 v125, s[60:63], s49 offen offset:1024 lds
buffer_load_dwordx4 v125, s[60:63], s50 offen offset:2048 lds
buffer_load_dwordx4 v125, s[60:63], s51 offen offset:3072 lds
s_mov_b32 s40, 1
s_mov_b32 s47, 0x400000
L_spinC_l:
buffer_load_dword v124, v10, s[20:23], s38 offen sc1
s_sub_u32 s47, s47, 1
s_waitcnt vmcnt(0)
s_cmp_eq_u32 s47, 0
s_cbranch_scc1 L_spinC_lx
v_cmp_ne_u32 vcc, 1, v124
s_cbranch_vccz L_spinC_lx
s_sleep 4
s_branch L_spinC_l
L_spinC_lx:
s_branch L_spinCr
L_c31:
s_bfe_u32 s3, s2, 0x40003
s_lshl_b32 s3, s3, 2
s_add_u32 s3, s3, s32
s_lshl_b32 s3, s3, 15
s_and_b32 s7, s2, 1
s_lshl_b32 s7, s7, 22
s_add_u32 s3, s3, s7
s_add_u32 s3, s3, 2097536
v_and_b32 v1, 15, v0
v_lshlrev_b32 v1, 11, v1
v_lshrrev_b32 v11, 5, v0
v_lshl_add_u32 v1, v11, 10, v1
buffer_load_dword v11, v1, s[28:31], s3 offen
s_branch L_c31r
L_f2A:
s_lshr_b32 s5, s54, 1
s_lshl_b32 s5, s5, 5
s_add_u32 s5, s5, 5447680
buffer_load_dword v125, v127, s[20:23], s5 offen sc1
s_branch L_f2Ar
L_f2B:
s_waitcnt vmcnt(16)
v_cmp_ne_u32 vcc, 1, v125
s_cbranch_vccz L_f2lx
s_mov_b32 s47, 0x400000
L_f2l:
buffer_load_dword v125, v127, s[20:23], s5 offen sc1
s_sub_u32 s47, s47, 1
s_waitcnt vmcnt(0)
s_cmp_eq_u32 s47, 0
s_cbranch_scc1 L_f2lx
v_cmp_ne_u32 vcc, 1, v125
s_cbranch_vccz L_f2lx
s_sleep 8
s_branch L_f2l
L_f2lx:
s_lshl_b32 s3, s54, 8
s_add_u32 s3, s3, 6291456
v_mul_u32_u24 v124, 14336, v121
v_and_b32_e64 v125, 15, v0
v_lshl_add_u32 v124, v125, 4, v124
buffer_load_dwordx4 v[74:77], v124, s[20:23], s3 offen sc1
s_add_u32 s3, s3, 57344
buffer_load_dwordx4 v[78:81], v124, s[20:23], s3 offen sc1
s_add_u32 s3, s3, 57344
buffer_load_dwordx4 v[82:85], v124, s[20:23], s3 offen sc1
s_add_u32 s3, s3, 57344
buffer_load_dwordx4 v[86:89], v124, s[20:23], s3 offen sc1
s_add_u32 s3, s3, 57344
buffer_load_dwordx4 v[90:93], v124, s[20:23], s3 offen sc1
s_add_u32 s3, s3, 57344
buffer_load_dwordx4 v[94:97], v124, s[20:23], s3 offen sc1
s_add_u32 s3, s3, 57344
buffer_load_dwordx4 v[98:101], v124, s[20:23], s3 offen sc1
s_add_u32 s3, s3, 57344
buffer_load_dwordx4 v[102:105], v124, s[20:23], s3 offen sc1
s_branch L_f2Br
L_yA:
v_min_u32 v127, 13, v0
v_lshlrev_b32_e64 v127, 2, v127
buffer_load_dword v74, v127, s[20:23], s41 offen sc1
s_branch L_yAr
L_yB:
s_waitcnt vmcnt(1)
v_cmp_ne_u32 vcc, 1, v74
s_cbranch_vccnz L_yBr
s_mov_b32 s40, 1
v_lshlrev_b32 v124, 2, v0
v_lshlrev_b32 v125, 1, v0
s_lshl_b32 s7, s45, 2
s_add_u32 s7, s7, s32
s_lshr_b32 s3, s42, 5
s_cmp_lg_u32 s3, s7
s_cbranch_scc1 L_f_yl1
s_add_u32 s3, s55, 0
s_nop 0
s_add_u32 s7, s3, 4096
buffer_load_dword v76, v124, s[20:23], s3 offen offset:0 sc1
buffer_load_dword v77, v124, s[20:23], s3 offen offset:512 sc1
buffer_load_dword v78, v124, s[20:23], s3 offen offset:1024 sc1
buffer_load_dword v79, v124, s[20:23], s3 offen offset:1536 sc1
buffer_load_dword v80, v124, s[20:23], s3 offen offset:2048 sc1
buffer_load_dword v81, v124, s[20:23], s3 offen offset:2560 sc1
buffer_load_dword v82, v124, s[20:23], s3 offen offset:3072 sc1
buffer_load_dword v83, v124, s[20:23], s3 offen offset:3584 sc1
buffer_load_dword v84, v124, s[20:23], s7 offen offset:0 sc1
buffer_load_dword v85, v124, s[20:23], s7 offen offset:512 sc1
buffer_load_dword v86, v124, s[20:23], s7 offen offset:1024 sc1
buffer_load_dword v87, v124, s[20:23], s7 offen offset:1536 sc1
buffer_load_dword v88, v124, s[20:23], s7 offen offset:2048 sc1
buffer_load_dword v89, v124, s[20:23], s7 offen offset:2560 sc1
s_lshl_b32 s3, s42, 11
s_lshl_b32 s7, s46, 7
s_add_u32 s3, s3, s7
buffer_load_ushort v90, v125, s[56:59], s3 offen
s_lshl_b32 s3, s42, 3
s_add_u32 s3, s3, 5259264
buffer_load_dwordx2 v[92:93], v126, s[20:23], s3 offen sc1
L_f_yl1:
s_lshl_b32 s7, s45, 2
s_add_u32 s7, s7, s32
s_lshr_b32 s3, s43, 5
s_cmp_lg_u32 s3, s7
s_cbranch_scc1 L_f_yl2
s_nop 0
s_add_u32 s3, s55, 256
s_add_u32 s7, s3, 4096
buffer_load_dword v94, v124, s[20:23], s3 offen offset:0 sc1
buffer_load_dword v95, v124, s[20:23], s3 offen offset:512 sc1
buffer_load_dword v96, v124, s[20:23], s3 offen offset:1024 sc1
buffer_load_dword v97, v124, s[20:23], s3 offen offset:1536 sc1
buffer_load_dword v98, v124, s[20:23], s3 offen offset:2048 sc1
buffer_load_dword v99, v124, s[20:23], s3 offen offset:2560 sc1
buffer_load_dword v100, v124, s[20:23], s3 offen offset:3072 sc1
buffer_load_dword v101, v124, s[20:23], s3 offen offset:3584 sc1
buffer_load_dword v102, v124, s[20:23], s7 offen offset:0 sc1
buffer_load_dword v103, v124, s[20:23], s7 offen offset:512 sc1
buffer_load_dword v104, v124, s[20:23], s7 offen offset:1024 sc1
buffer_load_dword v105, v124, s[20:23], s7 offen offset:1536 sc1
buffer_load_dword v106, v124, s[20:23], s7 offen offset:2048 sc1
buffer_load_dword v107, v124, s[20:23], s7 offen offset:2560 sc1
s_lshl_b32 s3, s43, 11
s_lshl_b32 s7, s46, 7
s_add_u32 s3, s3, s7
buffer_load_ushort v108, v125, s[56:59], s3 offen
s_lshl_b32 s3, s43, 3
s_add_u32 s3, s3, 5259264
buffer_load_dwordx2 v[110:111], v126, s[20:23], s3 offen sc1
L_f_yl2:
s_branch L_yBr
L_yC:
s_waitcnt vmcnt(1)
s_lshl_b32 s7, s45, 2
s_add_u32 s7, s7, s32
s_lshr_b32 s3, s42, 5
s_cmp_lg_u32 s3, s7
s_cbranch_scc1 L_f_ys3
s_nop 0
v_pk_add_f32 v[76:77], v[76:77], v[78:79]
v_pk_add_f32 v[76:77], v[76:77], v[80:81]
v_pk_add_f32 v[76:77], v[76:77], v[82:83]
v_pk_add_f32 v[76:77], v[76:77], v[84:85]
v_pk_add_f32 v[76:77], v[76:77], v[86:87]
v_pk_add_f32 v[76:77], v[76:77], v[88:89]
Va 76,76,77
v_lshlrev_b32 v90, 16, v90
v_sub_f32_e64 v90, v90, v92
Vc 76,76,76
v_lshlrev_b32_e64 v76, 16, v76
Vc 90,90,90
v_lshlrev_b32 v90, 16, v90
v_mul_f32 v76, s100, v76
v_mul_f32_e64 v90, v90, v93
Vc 76,76,76
v_lshlrev_b32_e64 v76, 16, v76
Vc 90,90,90
v_lshlrev_b32 v90, 16, v90
Va 90,90,76
Vc 90,90,90
v_lshlrev_b32_e64 v90, 16, v90
v_mul_f32 v76, 0xbfb8aa3b, v90
Ve 76,76
s_nop 0
v_add_f32 v76, 1.0, v76
v_rcp_f32 v76, v76
s_nop 0
Vm 90,90,76
Vc 90,90,90
v_lshlrev_b32 v90, 16, v90
v_lshlrev_b32 v124, 2, v0
v_add_u32 v124, s35, v124
v_lshlrev_b32 v125, 5, v122
v_add_u32 v125, s35, v125
s_waitcnt lgkmcnt(0)
ds_write_b32 v124, v90
s_and_b32 s3, s42, 7
s_lshl_b32 s3, s3, 3
s_lshl_b64 s[4:5], 0xff, s3
s_bfe_u32 s3, s42, 0x20003
s_mov_b64 exec, s[4:5]
s_cmp_lg_u32 s3, 0
s_cbranch_scc1 L_f_yp4
ds_read_b64 v[42:43], v125
ds_read_b64 v[44:45], v125 offset:8
ds_read_b64 v[46:47], v125 offset:16
ds_read_b64 v[48:49], v125 offset:24
L_f_yp4:
s_cmp_lg_u32 s3, 1
s_cbranch_scc1 L_f_yp5
ds_read_b64 v[50:51], v125
ds_read_b64 v[52:53], v125 offset:8
ds_read_b64 v[54:55], v125 offset:16
ds_read_b64 v[56:57], v125 offset:24
L_f_yp5:
s_cmp_lg_u32 s3, 2
s_cbranch_scc1 L_f_yp6
ds_read_b64 v[58:59], v125
ds_read_b64 v[60:61], v125 offset:8
ds_read_b64 v[62:63], v125 offset:16
ds_read_b64 v[64:65], v125 offset:24
L_f_yp6:
s_cmp_lg_u32 s3, 3
s_cbranch_scc1 L_f_yp7
ds_read_b64 v[66:67], v125
ds_read_b64 v[68:69], v125 offset:8
s_waitcnt lgkmcnt(9)
ds_read_b64 v[70:71], v125 offset:16
ds_read_b64 v[72:73], v125 offset:24
L_f_yp7:
s_mov_b64 exec, -1
s_waitcnt lgkmcnt(0)
L_f_ys3:
s_lshl_b32 s7, s45, 2
s_add_u32 s7, s7, s32
s_lshr_b32 s3, s43, 5
s_cmp_lg_u32 s3, s7
s_cbranch_scc1 L_f_ys8
s_nop 0
v_pk_add_f32 v[94:95], v[94:95], v[96:97]
v_pk_add_f32 v[94:95], v[94:95], v[98:99]
v_pk_add_f32 v[94:95], v[94:95], v[100:101]
v_pk_add_f32 v[94:95], v[94:95], v[102:103]
v_pk_add_f32 v[94:95], v[94:95], v[104:105]
v_pk_add_f32 v[94:95], v[94:95], v[106:107]
Va 94,94,95
v_lshlrev_b32 v108, 16, v108
v_sub_f32_e64 v108, v108, v110
Vc 94,94,94
v_lshlrev_b32_e64 v94, 16, v94
Vc 108,108,108
v_lshlrev_b32 v108, 16, v108
v_mul_f32 v94, s101, v94
v_mul_f32_e64 v108, v108, v111
Vc 94,94,94
v_lshlrev_b32_e64 v94, 16, v94
Vc 108,108,108
v_lshlrev_b32 v108, 16, v108
Va 108,108,94
Vc 108,108,108
v_lshlrev_b32_e64 v108, 16, v108
v_mul_f32 v94, 0xbfb8aa3b, v108
Ve 94,94
s_nop 0
v_add_f32 v94, 1.0, v94
v_rcp_f32 v94, v94
s_nop 0
Vm 108,108,94
Vc 108,108,108
v_lshlrev_b32 v108, 16, v108
v_lshlrev_b32 v124, 2, v0
v_add_u32 v124, s35, v124
v_lshlrev_b32 v125, 5, v122
v_add_u32 v125, s35, v125
s_waitcnt lgkmcnt(0)
ds_write_b32 v124, v108
s_and_b32 s3, s43, 7
s_lshl_b32 s3, s3, 3
s_lshl_b64 s[4:5], 0xff, s3
s_bfe_u32 s3, s43, 0x20003
s_mov_b64 exec, s[4:5]
s_cmp_lg_u32 s3, 0
s_cbranch_scc1 L_f_yp9
ds_read_b64 v[42:43], v125
ds_read_b64 v[44:45], v125 offset:8
ds_read_b64 v[46:47], v125 offset:16
ds_read_b64 v[48:49], v125 offset:24
L_f_yp9:
s_cmp_lg_u32 s3, 1
s_cbranch_scc1 L_f_yp10
ds_read_b64 v[50:51], v125
ds_read_b64 v[52:53], v125 offset:8
ds_read_b64 v[54:55], v125 offset:16
ds_read_b64 v[56:57], v125 offset:24
L_f_yp10:
s_cmp_lg_u32 s3, 2
s_cbranch_scc1 L_f_yp11
ds_read_b64 v[58:59], v125
ds_read_b64 v[60:61], v125 offset:8
ds_read_b64 v[62:63], v125 offset:16
ds_read_b64 v[64:65], v125 offset:24
L_f_yp11:
s_cmp_lg_u32 s3, 3
s_cbranch_scc1 L_f_yp12
ds_read_b64 v[66:67], v125
ds_read_b64 v[68:69], v125 offset:8
s_waitcnt lgkmcnt(9)
ds_read_b64 v[70:71], v125 offset:16
ds_read_b64 v[72:73], v125 offset:24
L_f_yp12:
s_mov_b64 exec, -1
s_waitcnt lgkmcnt(0)
L_f_ys8:
s_branch L_yCr
L_p4_end:
L_spinAk:
s_mov_b32 s47, 0x400000
L_spinAk_l:
s_sleep 8
buffer_load_dword v1, v7, s[28:31], 0 offen sc1
s_waitcnt vmcnt(0)
v_readfirstlane_b32 s3, v1
s_sub_u32 s47, s47, 1
s_cmp_eq_u32 s47, 0
s_cbranch_scc1 L_spinArk
s_cmp_lt_u32 s3, 256
s_cbranch_scc1 L_spinAk_l
s_branch L_spinArk
L_spinAv:
s_mov_b32 s47, 0x400000
L_spinAv_l:
s_sleep 8
buffer_load_dword v1, v7, s[28:31], 0 offen sc1
s_waitcnt vmcnt(0)
v_readfirstlane_b32 s3, v1
s_sub_u32 s47, s47, 1
s_cmp_eq_u32 s47, 0
s_cbranch_scc1 L_spinArv
s_cmp_lt_u32 s3, 256
s_cbranch_scc1 L_spinAv_l
s_branch L_spinArv
L_spinB:
s_mov_b32 s59, 0x400000
L_spinB_l:
s_sleep 4
buffer_load_dword v12, v1, s[20:23], s6 offen sc1
s_sub_u32 s59, s59, 1
s_cmp_eq_u32 s59, 0
s_cbranch_scc1 L_spinBx
s_waitcnt vmcnt(0)
v_cmp_ne_u32 vcc, 1, v12
s_cbranch_vccnz L_spinB_l
L_spinBx:
s_waitcnt vmcnt(0)
s_branch L_spinBr
L_k2_fb_we:
s_nop 7
s_nop 0
v_max3_f32 v21, v128, v129, v130
v_max3_f32 v21, v21, v131, v132
v_max3_f32 v21, v21, v133, v134
v_max3_f32 v21, v21, v135, v136
v_max3_f32 v21, v21, v137, v138
v_max3_f32 v21, v21, v139, v140
v_max3_f32 v21, v21, v141, v142
v_max_f32 v21, v21, v143
v_mov_b32 v1, v21
s_nop 1
v_permlane16_swap_b32 v1, v21
v_max_f32 v21, v21, v1
v_mov_b32 v1, v21
s_nop 1
v_permlane32_swap_b32 v1, v21
v_max_f32_e64 v21, v21, v1
v_add_f32 v21, 0x41f80000, v21
v_max_f32 v21, 0, v21
Vs 128,128,21
Vs 129,129,21
Vs 130,130,21
Vs 131,131,21
Vs 132,132,21
Vs 133,133,21
Vs 134,134,21
Vs 135,135,21
Vs 136,136,21
Vs 137,137,21
Vs 138,138,21
Vs 139,139,21
Vs 140,140,21
Vs 141,141,21
Vs 142,142,21
Vs 143,143,21
Vs 192,192,21
Vs 193,193,21
Vs 194,194,21
Vs 195,195,21
Vs 196,196,21
Vs 197,197,21
Vs 198,198,21
Vs 199,199,21
Vs 200,200,21
Vs 201,201,21
Vs 202,202,21
Vs 203,203,21
Vs 204,204,21
Vs 205,205,21
Vs 206,206,21
Vs 207,207,21
Vs 32,32,21
Vs 33,33,21
Vs 34,34,21
v_sub_f32_e64 v35, v35, v21
v_exp_f32 v22, -v21
s_nop 0
Vm 48,48,22
Vm 49,49,22
Vm 50,50,22
v_mul_f32_e64 v51, v51, v22
Ar 8,0
Ar 9,1
Ar 10,2
Ar 11,3
Ar 12,4
Ar 13,5
Ar 14,6
Ar 15,7
Vm 8,8,22
Vm 9,9,22
Vm 10,10,22
Vm 11,11,22
Vm 12,12,22
Vm 13,13,22
Vm 14,14,22
Vm 15,15,22
Aw 0,8
Aw 1,9
Aw 2,10
Aw 3,11
Aw 4,12
Aw 5,13
Aw 6,14
Aw 7,15
Ar 8,8
Ar 9,9
Ar 10,10
Ar 11,11
Ar 12,12
Ar 13,13
Ar 14,14
Ar 15,15
Vm 8,8,22
Vm 9,9,22
Vm 10,10,22
Vm 11,11,22
Vm 12,12,22
Vm 13,13,22
Vm 14,14,22
Vm 15,15,22
Aw 8,8
Aw 9,9
Aw 10,10
Aw 11,11
Aw 12,12
Aw 13,13
Aw 14,14
Aw 15,15
Ar 8,16
Ar 9,17
Ar 10,18
Ar 11,19
Ar 12,20
Ar 13,21
Ar 14,22
Ar 15,23
Vm 8,8,22
Vm 9,9,22
Vm 10,10,22
Vm 11,11,22
Vm 12,12,22
Vm 13,13,22
Vm 14,14,22
Vm 15,15,22
Aw 16,8
Aw 17,9
Aw 18,10
Aw 19,11
Aw 20,12
Aw 21,13
Aw 22,14
Aw 23,15
Ar 8,24
Ar 9,25
Ar 10,26
Ar 11,27
Ar 12,28
Ar 13,29
Ar 14,30
Ar 15,31
Vm 8,8,22
Vm 9,9,22
Vm 10,10,22
Vm 11,11,22
Vm 12,12,22
Vm 13,13,22
Vm 14,14,22
Vm 15,15,22
Aw 24,8
Aw 25,9
Aw 26,10
Aw 27,11
Aw 28,12
Aw 29,13
Aw 30,14
Aw 31,15
v_max3_f32 v21, v144, v145, v146
v_max3_f32 v21, v21, v147, v148
v_max3_f32 v21, v21, v149, v150
v_max3_f32 v21, v21, v151, v152
v_max3_f32 v21, v21, v153, v154
v_max3_f32 v21, v21, v155, v156
v_max3_f32 v21, v21, v157, v158
v_max_f32 v21, v21, v159
v_mov_b32 v1, v21
s_nop 1
v_permlane16_swap_b32 v1, v21
v_max_f32 v21, v21, v1
v_mov_b32 v1, v21
s_nop 1
v_permlane32_swap_b32 v1, v21
v_max_f32_e64 v21, v21, v1
v_add_f32 v21, 0x41f80000, v21
v_max_f32 v21, 0, v21
Vs 144,144,21
Vs 145,145,21
Vs 146,146,21
Vs 147,147,21
Vs 148,148,21
Vs 149,149,21
Vs 150,150,21
Vs 151,151,21
Vs 152,152,21
Vs 153,153,21
Vs 154,154,21
Vs 155,155,21
Vs 156,156,21
Vs 157,157,21
Vs 158,158,21
Vs 159,159,21
Vs 208,208,21
Vs 209,209,21
Vs 210,210,21
Vs 211,211,21
Vs 212,212,21
Vs 213,213,21
Vs 214,214,21
Vs 215,215,21
Vs 216,216,21
Vs 217,217,21
Vs 218,218,21
Vs 219,219,21
Vs 220,220,21
Vs 221,221,21
Vs 222,222,21
Vs 223,223,21
Vs 36,36,21
Vs 37,37,21
Vs 38,38,21
v_sub_f32_e64 v39, v39, v21
v_exp_f32 v22, -v21
s_nop 0
Vm 52,52,22
Vm 53,53,22
Vm 54,54,22
v_mul_f32_e64 v55, v55, v22
Ar 8,32
Ar 9,33
Ar 10,34
Ar 11,35
Ar 12,36
Ar 13,37
Ar 14,38
Ar 15,39
Vm 8,8,22
Vm 9,9,22
Vm 10,10,22
Vm 11,11,22
Vm 12,12,22
Vm 13,13,22
Vm 14,14,22
Vm 15,15,22
Aw 32,8
Aw 33,9
Aw 34,10
Aw 35,11
Aw 36,12
Aw 37,13
Aw 38,14
Aw 39,15
Ar 8,40
Ar 9,41
Ar 10,42
Ar 11,43
Ar 12,44
Ar 13,45
Ar 14,46
Ar 15,47
Vm 8,8,22
Vm 9,9,22
Vm 10,10,22
Vm 11,11,22
Vm 12,12,22
Vm 13,13,22
Vm 14,14,22
Vm 15,15,22
Aw 40,8
Aw 41,9
Aw 42,10
Aw 43,11
Aw 44,12
Aw 45,13
Aw 46,14
Aw 47,15
Ar 8,48
Ar 9,49
Ar 10,50
Ar 11,51
Ar 12,52
Ar 13,53
Ar 14,54
Ar 15,55
Vm 8,8,22
Vm 9,9,22
Vm 10,10,22
Vm 11,11,22
Vm 12,12,22
Vm 13,13,22
Vm 14,14,22
Vm 15,15,22
Aw 48,8
Aw 49,9
Aw 50,10
Aw 51,11
Aw 52,12
Aw 53,13
Aw 54,14
Aw 55,15
Ar 8,56
Ar 9,57
Ar 10,58
Ar 11,59
Ar 12,60
Ar 13,61
Ar 14,62
Ar 15,63
Vm 8,8,22
Vm 9,9,22
Vm 10,10,22
Vm 11,11,22
Vm 12,12,22
Vm 13,13,22
Vm 14,14,22
Vm 15,15,22
Aw 56,8
Aw 57,9
Aw 58,10
Aw 59,11
Aw 60,12
Aw 61,13
Aw 62,14
Aw 63,15
v_max3_f32 v21, v160, v161, v162
v_max3_f32 v21, v21, v163, v164
v_max3_f32 v21, v21, v165, v166
v_max3_f32 v21, v21, v167, v168
v_max3_f32 v21, v21, v169, v170
v_max3_f32 v21, v21, v171, v172
v_max3_f32 v21, v21, v173, v174
v_max_f32 v21, v21, v175
v_mov_b32 v1, v21
s_nop 1
v_permlane16_swap_b32 v1, v21
v_max_f32 v21, v21, v1
v_mov_b32 v1, v21
s_nop 1
v_permlane32_swap_b32 v1, v21
v_max_f32_e64 v21, v21, v1
v_add_f32 v21, 0x41f80000, v21
v_max_f32 v21, 0, v21
Vs 160,160,21
Vs 161,161,21
Vs 162,162,21
Vs 163,163,21
Vs 164,164,21
Vs 165,165,21
Vs 166,166,21
Vs 167,167,21
Vs 168,168,21
Vs 169,169,21
Vs 170,170,21
Vs 171,171,21
Vs 172,172,21
Vs 173,173,21
Vs 174,174,21
Vs 175,175,21
Vs 224,224,21
Vs 225,225,21
Vs 226,226,21
Vs 227,227,21
Vs 228,228,21
Vs 229,229,21
Vs 230,230,21
Vs 231,231,21
Vs 232,232,21
Vs 233,233,21
Vs 234,234,21
Vs 235,235,21
Vs 236,236,21
Vs 237,237,21
Vs 238,238,21
Vs 239,239,21
Vs 40,40,21
Vs 41,41,21
Vs 42,42,21
v_sub_f32_e64 v43, v43, v21
v_exp_f32 v22, -v21
s_nop 0
Vm 56,56,22
Vm 57,57,22
Vm 58,58,22
v_mul_f32_e64 v59, v59, v22
Ar 8,64
Ar 9,65
Ar 10,66
Ar 11,67
Ar 12,68
Ar 13,69
Ar 14,70
Ar 15,71
Vm 8,8,22
Vm 9,9,22
Vm 10,10,22
Vm 11,11,22
Vm 12,12,22
Vm 13,13,22
Vm 14,14,22
Vm 15,15,22
Aw 64,8
Aw 65,9
Aw 66,10
Aw 67,11
Aw 68,12
Aw 69,13
Aw 70,14
Aw 71,15
Ar 8,72
Ar 9,73
Ar 10,74
Ar 11,75
Ar 12,76
Ar 13,77
Ar 14,78
Ar 15,79
Vm 8,8,22
Vm 9,9,22
Vm 10,10,22
Vm 11,11,22
Vm 12,12,22
Vm 13,13,22
Vm 14,14,22
Vm 15,15,22
Aw 72,8
Aw 73,9
Aw 74,10
Aw 75,11
Aw 76,12
Aw 77,13
Aw 78,14
Aw 79,15
Ar 8,80
Ar 9,81
Ar 10,82
Ar 11,83
Ar 12,84
Ar 13,85
Ar 14,86
Ar 15,87
Vm 8,8,22
Vm 9,9,22
Vm 10,10,22
Vm 11,11,22
Vm 12,12,22
Vm 13,13,22
Vm 14,14,22
Vm 15,15,22
Aw 80,8
Aw 81,9
Aw 82,10
Aw 83,11
Aw 84,12
Aw 85,13
Aw 86,14
Aw 87,15
Ar 8,88
Ar 9,89
Ar 10,90
Ar 11,91
Ar 12,92
Ar 13,93
Ar 14,94
Ar 15,95
Vm 8,8,22
Vm 9,9,22
Vm 10,10,22
Vm 11,11,22
Vm 12,12,22
Vm 13,13,22
Vm 14,14,22
Vm 15,15,22
Aw 88,8
Aw 89,9
Aw 90,10
Aw 91,11
Aw 92,12
Aw 93,13
Aw 94,14
Aw 95,15
v_max3_f32 v21, v176, v177, v178
v_max3_f32 v21, v21, v179, v180
v_max3_f32 v21, v21, v181, v182
v_max3_f32 v21, v21, v183, v184
v_max3_f32 v21, v21, v185, v186
v_max3_f32 v21, v21, v187, v188
v_max3_f32 v21, v21, v189, v190
v_max_f32 v21, v21, v191
v_mov_b32 v1, v21
s_nop 1
v_permlane16_swap_b32 v1, v21
v_max_f32 v21, v21, v1
v_mov_b32 v1, v21
s_nop 1
v_permlane32_swap_b32 v1, v21
v_max_f32_e64 v21, v21, v1
v_add_f32 v21, 0x41f80000, v21
v_max_f32 v21, 0, v21
Vs 176,176,21
Vs 177,177,21
Vs 178,178,21
Vs 179,179,21
Vs 180,180,21
Vs 181,181,21
Vs 182,182,21
Vs 183,183,21
Vs 184,184,21
Vs 185,185,21
Vs 186,186,21
Vs 187,187,21
Vs 188,188,21
Vs 189,189,21
Vs 190,190,21
Vs 191,191,21
Vs 240,240,21
Vs 241,241,21
Vs 242,242,21
Vs 243,243,21
Vs 244,244,21
Vs 245,245,21
Vs 246,246,21
Vs 247,247,21
Vs 248,248,21
Vs 249,249,21
Vs 250,250,21
Vs 251,251,21
Vs 252,252,21
Vs 253,253,21
Vs 254,254,21
Vs 255,255,21
Vs 44,44,21
Vs 45,45,21
Vs 46,46,21
v_sub_f32_e64 v47, v47, v21
v_exp_f32 v22, -v21
s_nop 0
Vm 60,60,22
Vm 61,61,22
Vm 62,62,22
v_mul_f32_e64 v63, v63, v22
Ar 8,96
Ar 9,97
Ar 10,98
Ar 11,99
Ar 12,100
Ar 13,101
Ar 14,102
Ar 15,103
Vm 8,8,22
Vm 9,9,22
Vm 10,10,22
Vm 11,11,22
Vm 12,12,22
Vm 13,13,22
Vm 14,14,22
Vm 15,15,22
Aw 96,8
Aw 97,9
Aw 98,10
Aw 99,11
Aw 100,12
Aw 101,13
Aw 102,14
Aw 103,15
Ar 8,104
Ar 9,105
Ar 10,106
Ar 11,107
Ar 12,108
Ar 13,109
Ar 14,110
Ar 15,111
Vm 8,8,22
Vm 9,9,22
Vm 10,10,22
Vm 11,11,22
Vm 12,12,22
Vm 13,13,22
Vm 14,14,22
Vm 15,15,22
Aw 104,8
Aw 105,9
Aw 106,10
Aw 107,11
Aw 108,12
Aw 109,13
Aw 110,14
Aw 111,15
Ar 8,112
Ar 9,113
Ar 10,114
Ar 11,115
Ar 12,116
Ar 13,117
Ar 14,118
Ar 15,119
Vm 8,8,22
Vm 9,9,22
Vm 10,10,22
Vm 11,11,22
Vm 12,12,22
Vm 13,13,22
Vm 14,14,22
Vm 15,15,22
Aw 112,8
Aw 113,9
Aw 114,10
Aw 115,11
Aw 116,12
Aw 117,13
Aw 118,14
Aw 119,15
Ar 8,120
Ar 9,121
Ar 10,122
Ar 11,123
Ar 12,124
Ar 13,125
Ar 14,126
Ar 15,127
Vm 8,8,22
Vm 9,9,22
Vm 10,10,22
Vm 11,11,22
Vm 12,12,22
Vm 13,13,22
Vm 14,14,22
Vm 15,15,22
Aw 120,8
Aw 121,9
Aw 122,10
Aw 123,11
Aw 124,12
Aw 125,13
Aw 126,14
Aw 127,15
Ve 8,128
Ve 9,129
s_nop 0
Vc 64,8,9
Ve 8,130
Ve 9,131
s_nop 0
Vc 65,8,9
Ve 8,144
Ve 9,145
s_nop 0
Vc 72,8,9
Ve 8,146
Ve 9,147
s_nop 0
Vc 73,8,9
Ve 8,160
Ve 9,161
s_nop 0
Vc 80,8,9
Ve 8,162
Ve 9,163
s_nop 0
Vc 81,8,9
Ve 8,176
Ve 9,177
s_nop 0
Vc 88,8,9
Ve 8,178
Ve 9,179
s_nop 0
Vc 89,8,9
Ve 8,132
Ve 9,133
s_nop 0
Vc 66,8,9
Ve 8,134
Ve 9,135
s_nop 0
Vc 67,8,9
Ve 8,148
Ve 9,149
s_nop 0
Vc 74,8,9
Ve 8,150
Ve 9,151
s_nop 0
Vc 75,8,9
Ve 8,164
Ve 9,165
s_nop 0
Vc 82,8,9
Ve 8,166
Ve 9,167
s_nop 0
Vc 83,8,9
Ve 8,180
Ve 9,181
s_nop 0
Vc 90,8,9
Ve 8,182
Ve 9,183
s_nop 0
Vc 91,8,9
Ve 8,136
Ve 9,137
s_nop 0
Vc 68,8,9
Ve 8,138
Ve 9,139
s_nop 0
Vc 69,8,9
Ve 8,152
Ve 9,153
s_nop 0
Vc 76,8,9
Ve 8,154
Ve 9,155
s_nop 0
Vc 77,8,9
Ve 8,168
Ve 9,169
s_nop 0
Vc 84,8,9
Ve 8,170
Ve 9,171
s_nop 0
Vc 85,8,9
Ve 8,184
Ve 9,185
s_nop 0
Vc 92,8,9
Ve 8,186
Ve 9,187
s_nop 0
Vc 93,8,9
Ve 8,140
Ve 9,141
s_nop 0
Vc 70,8,9
Ve 8,142
Ve 9,143
s_nop 0
Vc 71,8,9
Ve 8,156
Ve 9,157
s_nop 0
Vc 78,8,9
Ve 8,158
Ve 9,159
s_nop 0
Vc 79,8,9
Ve 8,172
Ve 9,173
s_nop 0
Vc 86,8,9
Ve 8,174
Ve 9,175
s_nop 0
Vc 87,8,9
Ve 8,188
Ve 9,189
s_nop 0
Vc 94,8,9
Ve 8,190
Ve 9,191
s_nop 0
Vc 95,8,9
s_nop 1
s_branch L_k2_fbr_we
L_k2_fb_wo:
s_nop 7
s_nop 0
v_max3_f32 v21, v192, v193, v194
v_max3_f32 v21, v21, v195, v196
v_max3_f32 v21, v21, v197, v198
v_max3_f32 v21, v21, v199, v200
v_max3_f32 v21, v21, v201, v202
v_max3_f32 v21, v21, v203, v204
v_max3_f32 v21, v21, v205, v206
v_max_f32 v21, v21, v207
v_mov_b32 v1, v21
s_nop 1
v_permlane16_swap_b32 v1, v21
v_max_f32 v21, v21, v1
v_mov_b32 v1, v21
s_nop 1
v_permlane32_swap_b32 v1, v21
v_max_f32_e64 v21, v21, v1
v_add_f32 v21, 0x41f80000, v21
v_max_f32 v21, 0, v21
Vs 192,192,21
Vs 193,193,21
Vs 194,194,21
Vs 195,195,21
Vs 196,196,21
Vs 197,197,21
Vs 198,198,21
Vs 199,199,21
Vs 200,200,21
Vs 201,201,21
Vs 202,202,21
Vs 203,203,21
Vs 204,204,21
Vs 205,205,21
Vs 206,206,21
Vs 207,207,21
Vs 128,128,21
Vs 129,129,21
Vs 130,130,21
Vs 131,131,21
Vs 132,132,21
Vs 133,133,21
Vs 134,134,21
Vs 135,135,21
Vs 136,136,21
Vs 137,137,21
Vs 138,138,21
Vs 139,139,21
Vs 140,140,21
Vs 141,141,21
Vs 142,142,21
Vs 143,143,21
Vs 32,32,21
Vs 33,33,21
Vs 34,34,21
v_sub_f32_e64 v35, v35, v21
v_exp_f32 v22, -v21
s_nop 0
Vm 48,48,22
Vm 49,49,22
Vm 50,50,22
v_mul_f32_e64 v51, v51, v22
Ar 8,0
Ar 9,1
Ar 10,2
Ar 11,3
Ar 12,4
Ar 13,5
Ar 14,6
Ar 15,7
Vm 8,8,22
Vm 9,9,22
Vm 10,10,22
Vm 11,11,22
Vm 12,12,22
Vm 13,13,22
Vm 14,14,22
Vm 15,15,22
Aw 0,8
Aw 1,9
Aw 2,10
Aw 3,11
Aw 4,12
Aw 5,13
Aw 6,14
Aw 7,15
Ar 8,8
Ar 9,9
Ar 10,10
Ar 11,11
Ar 12,12
Ar 13,13
Ar 14,14
Ar 15,15
Vm 8,8,22
Vm 9,9,22
Vm 10,10,22
Vm 11,11,22
Vm 12,12,22
Vm 13,13,22
Vm 14,14,22
Vm 15,15,22
Aw 8,8
Aw 9,9
Aw 10,10
Aw 11,11
Aw 12,12
Aw 13,13
Aw 14,14
Aw 15,15
Ar 8,16
Ar 9,17
Ar 10,18
Ar 11,19
Ar 12,20
Ar 13,21
Ar 14,22
Ar 15,23
Vm 8,8,22
Vm 9,9,22
Vm 10,10,22
Vm 11,11,22
Vm 12,12,22
Vm 13,13,22
Vm 14,14,22
Vm 15,15,22
Aw 16,8
Aw 17,9
Aw 18,10
Aw 19,11
Aw 20,12
Aw 21,13
Aw 22,14
Aw 23,15
Ar 8,24
Ar 9,25
Ar 10,26
Ar 11,27
Ar 12,28
Ar 13,29
Ar 14,30
Ar 15,31
Vm 8,8,22
Vm 9,9,22
Vm 10,10,22
Vm 11,11,22
Vm 12,12,22
Vm 13,13,22
Vm 14,14,22
Vm 15,15,22
Aw 24,8
Aw 25,9
Aw 26,10
Aw 27,11
Aw 28,12
Aw 29,13
Aw 30,14
Aw 31,15
v_max3_f32 v21, v208, v209, v210
v_max3_f32 v21, v21, v211, v212
v_max3_f32 v21, v21, v213, v214
v_max3_f32 v21, v21, v215, v216
v_max3_f32 v21, v21, v217, v218
v_max3_f32 v21, v21, v219, v220
v_max3_f32 v21, v21, v221, v222
v_max_f32 v21, v21, v223
v_mov_b32 v1, v21
s_nop 1
v_permlane16_swap_b32 v1, v21
v_max_f32 v21, v21, v1
v_mov_b32 v1, v21
s_nop 1
v_permlane32_swap_b32 v1, v21
v_max_f32_e64 v21, v21, v1
v_add_f32 v21, 0x41f80000, v21
v_max_f32 v21, 0, v21
Vs 208,208,21
Vs 209,209,21
Vs 210,210,21
Vs 211,211,21
Vs 212,212,21
Vs 213,213,21
Vs 214,214,21
Vs 215,215,21
Vs 216,216,21
Vs 217,217,21
Vs 218,218,21
Vs 219,219,21
Vs 220,220,21
Vs 221,221,21
Vs 222,222,21
Vs 223,223,21
Vs 144,144,21
Vs 145,145,21
Vs 146,146,21
Vs 147,147,21
Vs 148,148,21
Vs 149,149,21
Vs 150,150,21
Vs 151,151,21
Vs 152,152,21
Vs 153,153,21
Vs 154,154,21
Vs 155,155,21
Vs 156,156,21
Vs 157,157,21
Vs 158,158,21
Vs 159,159,21
Vs 36,36,21
Vs 37,37,21
Vs 38,38,21
v_sub_f32_e64 v39, v39, v21
v_exp_f32 v22, -v21
s_nop 0
Vm 52,52,22
Vm 53,53,22
Vm 54,54,22
v_mul_f32_e64 v55, v55, v22
Ar 8,32
Ar 9,33
Ar 10,34
Ar 11,35
Ar 12,36
Ar 13,37
Ar 14,38
Ar 15,39
Vm 8,8,22
Vm 9,9,22
Vm 10,10,22
Vm 11,11,22
Vm 12,12,22
Vm 13,13,22
Vm 14,14,22
Vm 15,15,22
Aw 32,8
Aw 33,9
Aw 34,10
Aw 35,11
Aw 36,12
Aw 37,13
Aw 38,14
Aw 39,15
Ar 8,40
Ar 9,41
Ar 10,42
Ar 11,43
Ar 12,44
Ar 13,45
Ar 14,46
Ar 15,47
Vm 8,8,22
Vm 9,9,22
Vm 10,10,22
Vm 11,11,22
Vm 12,12,22
Vm 13,13,22
Vm 14,14,22
Vm 15,15,22
Aw 40,8
Aw 41,9
Aw 42,10
Aw 43,11
Aw 44,12
Aw 45,13
Aw 46,14
Aw 47,15
Ar 8,48
Ar 9,49
Ar 10,50
Ar 11,51
Ar 12,52
Ar 13,53
Ar 14,54
Ar 15,55
Vm 8,8,22
Vm 9,9,22
Vm 10,10,22
Vm 11,11,22
Vm 12,12,22
Vm 13,13,22
Vm 14,14,22
Vm 15,15,22
Aw 48,8
Aw 49,9
Aw 50,10
Aw 51,11
Aw 52,12
Aw 53,13
Aw 54,14
Aw 55,15
Ar 8,56
Ar 9,57
Ar 10,58
Ar 11,59
Ar 12,60
Ar 13,61
Ar 14,62
Ar 15,63
Vm 8,8,22
Vm 9,9,22
Vm 10,10,22
Vm 11,11,22
Vm 12,12,22
Vm 13,13,22
Vm 14,14,22
Vm 15,15,22
Aw 56,8
Aw 57,9
Aw 58,10
Aw 59,11
Aw 60,12
Aw 61,13
Aw 62,14
Aw 63,15
v_max3_f32 v21, v224, v225, v226
v_max3_f32 v21, v21, v227, v228
v_max3_f32 v21, v21, v229, v230
v_max3_f32 v21, v21, v231, v232
v_max3_f32 v21, v21, v233, v234
v_max3_f32 v21, v21, v235, v236
v_max3_f32 v21, v21, v237, v238
v_max_f32 v21, v21, v239
v_mov_b32 v1, v21
s_nop 1
v_permlane16_swap_b32 v1, v21
v_max_f32 v21, v21, v1
v_mov_b32 v1, v21
s_nop 1
v_permlane32_swap_b32 v1, v21
v_max_f32_e64 v21, v21, v1
v_add_f32 v21, 0x41f80000, v21
v_max_f32 v21, 0, v21
Vs 224,224,21
Vs 225,225,21
Vs 226,226,21
Vs 227,227,21
Vs 228,228,21
Vs 229,229,21
Vs 230,230,21
Vs 231,231,21
Vs 232,232,21
Vs 233,233,21
Vs 234,234,21
Vs 235,235,21
Vs 236,236,21
Vs 237,237,21
Vs 238,238,21
Vs 239,239,21
Vs 160,160,21
Vs 161,161,21
Vs 162,162,21
Vs 163,163,21
Vs 164,164,21
Vs 165,165,21
Vs 166,166,21
Vs 167,167,21
Vs 168,168,21
Vs 169,169,21
Vs 170,170,21
Vs 171,171,21
Vs 172,172,21
Vs 173,173,21
Vs 174,174,21
Vs 175,175,21
Vs 40,40,21
Vs 41,41,21
Vs 42,42,21
v_sub_f32_e64 v43, v43, v21
v_exp_f32 v22, -v21
s_nop 0
Vm 56,56,22
Vm 57,57,22
Vm 58,58,22
v_mul_f32_e64 v59, v59, v22
Ar 8,64
Ar 9,65
Ar 10,66
Ar 11,67
Ar 12,68
Ar 13,69
Ar 14,70
Ar 15,71
Vm 8,8,22
Vm 9,9,22
Vm 10,10,22
Vm 11,11,22
Vm 12,12,22
Vm 13,13,22
Vm 14,14,22
Vm 15,15,22
Aw 64,8
Aw 65,9
Aw 66,10
Aw 67,11
Aw 68,12
Aw 69,13
Aw 70,14
Aw 71,15
Ar 8,72
Ar 9,73
Ar 10,74
Ar 11,75
Ar 12,76
Ar 13,77
Ar 14,78
Ar 15,79
Vm 8,8,22
Vm 9,9,22
Vm 10,10,22
Vm 11,11,22
Vm 12,12,22
Vm 13,13,22
Vm 14,14,22
Vm 15,15,22
Aw 72,8
Aw 73,9
Aw 74,10
Aw 75,11
Aw 76,12
Aw 77,13
Aw 78,14
Aw 79,15
Ar 8,80
Ar 9,81
Ar 10,82
Ar 11,83
Ar 12,84
Ar 13,85
Ar 14,86
Ar 15,87
Vm 8,8,22
Vm 9,9,22
Vm 10,10,22
Vm 11,11,22
Vm 12,12,22
Vm 13,13,22
Vm 14,14,22
Vm 15,15,22
Aw 80,8
Aw 81,9
Aw 82,10
Aw 83,11
Aw 84,12
Aw 85,13
Aw 86,14
Aw 87,15
Ar 8,88
Ar 9,89
Ar 10,90
Ar 11,91
Ar 12,92
Ar 13,93
Ar 14,94
Ar 15,95
Vm 8,8,22
Vm 9,9,22
Vm 10,10,22
Vm 11,11,22
Vm 12,12,22
Vm 13,13,22
Vm 14,14,22
Vm 15,15,22
Aw 88,8
Aw 89,9
Aw 90,10
Aw 91,11
Aw 92,12
Aw 93,13
Aw 94,14
Aw 95,15
v_max3_f32 v21, v240, v241, v242
v_max3_f32 v21, v21, v243, v244
v_max3_f32 v21, v21, v245, v246
v_max3_f32 v21, v21, v247, v248
v_max3_f32 v21, v21, v249, v250
v_max3_f32 v21, v21, v251, v252
v_max3_f32 v21, v21, v253, v254
v_max_f32 v21, v21, v255
v_mov_b32 v1, v21
s_nop 1
v_permlane16_swap_b32 v1, v21
v_max_f32 v21, v21, v1
v_mov_b32 v1, v21
s_nop 1
v_permlane32_swap_b32 v1, v21
v_max_f32_e64 v21, v21, v1
v_add_f32 v21, 0x41f80000, v21
v_max_f32 v21, 0, v21
Vs 240,240,21
Vs 241,241,21
Vs 242,242,21
Vs 243,243,21
Vs 244,244,21
Vs 245,245,21
Vs 246,246,21
Vs 247,247,21
Vs 248,248,21
Vs 249,249,21
Vs 250,250,21
Vs 251,251,21
Vs 252,252,21
Vs 253,253,21
Vs 254,254,21
Vs 255,255,21
Vs 176,176,21
Vs 177,177,21
Vs 178,178,21
Vs 179,179,21
Vs 180,180,21
Vs 181,181,21
Vs 182,182,21
Vs 183,183,21
Vs 184,184,21
Vs 185,185,21
Vs 186,186,21
Vs 187,187,21
Vs 188,188,21
Vs 189,189,21
Vs 190,190,21
Vs 191,191,21
Vs 44,44,21
Vs 45,45,21
Vs 46,46,21
v_sub_f32_e64 v47, v47, v21
v_exp_f32 v22, -v21
s_nop 0
Vm 60,60,22
Vm 61,61,22
Vm 62,62,22
v_mul_f32_e64 v63, v63, v22
Ar 8,96
Ar 9,97
Ar 10,98
Ar 11,99
Ar 12,100
Ar 13,101
Ar 14,102
Ar 15,103
Vm 8,8,22
Vm 9,9,22
Vm 10,10,22
Vm 11,11,22
Vm 12,12,22
Vm 13,13,22
Vm 14,14,22
Vm 15,15,22
Aw 96,8
Aw 97,9
Aw 98,10
Aw 99,11
Aw 100,12
Aw 101,13
Aw 102,14
Aw 103,15
Ar 8,104
Ar 9,105
Ar 10,106
Ar 11,107
Ar 12,108
Ar 13,109
Ar 14,110
Ar 15,111
Vm 8,8,22
Vm 9,9,22
Vm 10,10,22
Vm 11,11,22
Vm 12,12,22
Vm 13,13,22
Vm 14,14,22
Vm 15,15,22
Aw 104,8
Aw 105,9
Aw 106,10
Aw 107,11
Aw 108,12
Aw 109,13
Aw 110,14
Aw 111,15
Ar 8,112
Ar 9,113
Ar 10,114
Ar 11,115
Ar 12,116
Ar 13,117
Ar 14,118
Ar 15,119
Vm 8,8,22
Vm 9,9,22
Vm 10,10,22
Vm 11,11,22
Vm 12,12,22
Vm 13,13,22
Vm 14,14,22
Vm 15,15,22
Aw 112,8
Aw 113,9
Aw 114,10
Aw 115,11
Aw 116,12
Aw 117,13
Aw 118,14
Aw 119,15
Ar 8,120
Ar 9,121
Ar 10,122
Ar 11,123
Ar 12,124
Ar 13,125
Ar 14,126
Ar 15,127
Vm 8,8,22
Vm 9,9,22
Vm 10,10,22
Vm 11,11,22
Vm 12,12,22
Vm 13,13,22
Vm 14,14,22
Vm 15,15,22
Aw 120,8
Aw 121,9
Aw 122,10
Aw 123,11
Aw 124,12
Aw 125,13
Aw 126,14
Aw 127,15
Ve 8,192
Ve 9,193
s_nop 0
Vc 96,8,9
Ve 8,194
Ve 9,195
s_nop 0
Vc 97,8,9
Ve 8,208
Ve 9,209
s_nop 0
Vc 104,8,9
Ve 8,210
Ve 9,211
s_nop 0
Vc 105,8,9
Ve 8,224
Ve 9,225
s_nop 0
Vc 112,8,9
Ve 8,226
Ve 9,227
s_nop 0
Vc 113,8,9
Ve 8,240
Ve 9,241
s_nop 0
Vc 120,8,9
Ve 8,242
Ve 9,243
s_nop 0
Vc 121,8,9
Ve 8,196
Ve 9,197
s_nop 0
Vc 98,8,9
Ve 8,198
Ve 9,199
s_nop 0
Vc 99,8,9
Ve 8,212
Ve 9,213
s_nop 0
Vc 106,8,9
Ve 8,214
Ve 9,215
s_nop 0
Vc 107,8,9
Ve 8,228
Ve 9,229
s_nop 0
Vc 114,8,9
Ve 8,230
Ve 9,231
s_nop 0
Vc 115,8,9
Ve 8,244
Ve 9,245
s_nop 0
Vc 122,8,9
Ve 8,246
Ve 9,247
s_nop 0
Vc 123,8,9
Ve 8,200
Ve 9,201
s_nop 0
Vc 100,8,9
Ve 8,202
Ve 9,203
s_nop 0
Vc 101,8,9
Ve 8,216
Ve 9,217
s_nop 0
Vc 108,8,9
Ve 8,218
Ve 9,219
s_nop 0
Vc 109,8,9
Ve 8,232
Ve 9,233
s_nop 0
Vc 116,8,9
Ve 8,234
Ve 9,235
s_nop 0
Vc 117,8,9
Ve 8,248
Ve 9,249
s_nop 0
Vc 124,8,9
Ve 8,250
Ve 9,251
s_nop 0
Vc 125,8,9
Ve 8,204
Ve 9,205
s_nop 0
Vc 102,8,9
Ve 8,206
Ve 9,207
s_nop 0
Vc 103,8,9
Ve 8,220
Ve 9,221
s_nop 0
Vc 110,8,9
Ve 8,222
Ve 9,223
s_nop 0
Vc 111,8,9
Ve 8,236
Ve 9,237
s_nop 0
Vc 118,8,9
Ve 8,238
Ve 9,239
s_nop 0
Vc 119,8,9
Ve 8,252
Ve 9,253
s_nop 0
Vc 126,8,9
Ve 8,254
Ve 9,255
s_nop 0
Vc 127,8,9
s_nop 1
s_branch L_k2_fbr_wo
L_k2_fb_wl:
s_nop 7
s_nop 0
v_max3_f32 v21, v128, v129, v130
v_max3_f32 v21, v21, v131, v132
v_max3_f32 v21, v21, v133, v134
v_max3_f32 v21, v21, v135, v136
v_max3_f32 v21, v21, v137, v138
v_max3_f32 v21, v21, v139, v140
v_max3_f32 v21, v21, v141, v142
v_max_f32 v21, v21, v143
v_mov_b32 v1, v21
s_nop 1
v_permlane16_swap_b32 v1, v21
v_max_f32 v21, v21, v1
v_mov_b32 v1, v21
s_nop 1
v_permlane32_swap_b32 v1, v21
v_max_f32_e64 v21, v21, v1
v_add_f32 v21, 0x41f80000, v21
v_max_f32 v21, 0, v21
Vs 128,128,21
Vs 129,129,21
Vs 130,130,21
Vs 131,131,21
Vs 132,132,21
Vs 133,133,21
Vs 134,134,21
Vs 135,135,21
Vs 136,136,21
Vs 137,137,21
Vs 138,138,21
Vs 139,139,21
Vs 140,140,21
Vs 141,141,21
Vs 142,142,21
Vs 143,143,21
Vs 192,192,21
Vs 193,193,21
Vs 194,194,21
Vs 195,195,21
Vs 196,196,21
Vs 197,197,21
Vs 198,198,21
Vs 199,199,21
Vs 200,200,21
Vs 201,201,21
Vs 202,202,21
Vs 203,203,21
Vs 204,204,21
Vs 205,205,21
Vs 206,206,21
Vs 207,207,21
Vs 32,32,21
Vs 33,33,21
Vs 34,34,21
v_sub_f32_e64 v35, v35, v21
v_exp_f32 v22, -v21
s_nop 0
Vm 48,48,22
Vm 49,49,22
Vm 50,50,22
v_mul_f32_e64 v51, v51, v22
Ar 8,0
Ar 9,1
Ar 10,2
Ar 11,3
Ar 12,4
Ar 13,5
Ar 14,6
Ar 15,7
Vm 8,8,22
Vm 9,9,22
Vm 10,10,22
Vm 11,11,22
Vm 12,12,22
Vm 13,13,22
Vm 14,14,22
Vm 15,15,22
Aw 0,8
Aw 1,9
Aw 2,10
Aw 3,11
Aw 4,12
Aw 5,13
Aw 6,14
Aw 7,15
Ar 8,8
Ar 9,9
Ar 10,10
Ar 11,11
Ar 12,12
Ar 13,13
Ar 14,14
Ar 15,15
Vm 8,8,22
Vm 9,9,22
Vm 10,10,22
Vm 11,11,22
Vm 12,12,22
Vm 13,13,22
Vm 14,14,22
Vm 15,15,22
Aw 8,8
Aw 9,9
Aw 10,10
Aw 11,11
Aw 12,12
Aw 13,13
Aw 14,14
Aw 15,15
Ar 8,16
Ar 9,17
Ar 10,18
Ar 11,19
Ar 12,20
Ar 13,21
Ar 14,22
Ar 15,23
Vm 8,8,22
Vm 9,9,22
Vm 10,10,22
Vm 11,11,22
Vm 12,12,22
Vm 13,13,22
Vm 14,14,22
Vm 15,15,22
Aw 16,8
Aw 17,9
Aw 18,10
Aw 19,11
Aw 20,12
Aw 21,13
Aw 22,14
Aw 23,15
Ar 8,24
Ar 9,25
Ar 10,26
Ar 11,27
Ar 12,28
Ar 13,29
Ar 14,30
Ar 15,31
Vm 8,8,22
Vm 9,9,22
Vm 10,10,22
Vm 11,11,22
Vm 12,12,22
Vm 13,13,22
Vm 14,14,22
Vm 15,15,22
Aw 24,8
Aw 25,9
Aw 26,10
Aw 27,11
Aw 28,12
Aw 29,13
Aw 30,14
Aw 31,15
v_max3_f32 v21, v144, v145, v146
v_max3_f32 v21, v21, v147, v148
v_max3_f32 v21, v21, v149, v150
v_max3_f32 v21, v21, v151, v152
v_max3_f32 v21, v21, v153, v154
v_max3_f32 v21, v21, v155, v156
v_max3_f32 v21, v21, v157, v158
v_max_f32 v21, v21, v159
v_mov_b32 v1, v21
s_nop 1
v_permlane16_swap_b32 v1, v21
v_max_f32 v21, v21, v1
v_mov_b32 v1, v21
s_nop 1
v_permlane32_swap_b32 v1, v21
v_max_f32_e64 v21, v21, v1
v_add_f32 v21, 0x41f80000, v21
v_max_f32 v21, 0, v21
Vs 144,144,21
Vs 145,145,21
Vs 146,146,21
Vs 147,147,21
Vs 148,148,21
Vs 149,149,21
Vs 150,150,21
Vs 151,151,21
Vs 152,152,21
Vs 153,153,21
Vs 154,154,21
Vs 155,155,21
Vs 156,156,21
Vs 157,157,21
Vs 158,158,21
Vs 159,159,21
Vs 208,208,21
Vs 209,209,21
Vs 210,210,21
Vs 211,211,21
Vs 212,212,21
Vs 213,213,21
Vs 214,214,21
Vs 215,215,21
Vs 216,216,21
Vs 217,217,21
Vs 218,218,21
Vs 219,219,21
Vs 220,220,21
Vs 221,221,21
Vs 222,222,21
Vs 223,223,21
Vs 36,36,21
Vs 37,37,21
Vs 38,38,21
v_sub_f32_e64 v39, v39, v21
v_exp_f32 v22, -v21
s_nop 0
Vm 52,52,22
Vm 53,53,22
Vm 54,54,22
v_mul_f32_e64 v55, v55, v22
Ar 8,32
Ar 9,33
Ar 10,34
Ar 11,35
Ar 12,36
Ar 13,37
Ar 14,38
Ar 15,39
Vm 8,8,22
Vm 9,9,22
Vm 10,10,22
Vm 11,11,22
Vm 12,12,22
Vm 13,13,22
Vm 14,14,22
Vm 15,15,22
Aw 32,8
Aw 33,9
Aw 34,10
Aw 35,11
Aw 36,12
Aw 37,13
Aw 38,14
Aw 39,15
Ar 8,40
Ar 9,41
Ar 10,42
Ar 11,43
Ar 12,44
Ar 13,45
Ar 14,46
Ar 15,47
Vm 8,8,22
Vm 9,9,22
Vm 10,10,22
Vm 11,11,22
Vm 12,12,22
Vm 13,13,22
Vm 14,14,22
Vm 15,15,22
Aw 40,8
Aw 41,9
Aw 42,10
Aw 43,11
Aw 44,12
Aw 45,13
Aw 46,14
Aw 47,15
Ar 8,48
Ar 9,49
Ar 10,50
Ar 11,51
Ar 12,52
Ar 13,53
Ar 14,54
Ar 15,55
Vm 8,8,22
Vm 9,9,22
Vm 10,10,22
Vm 11,11,22
Vm 12,12,22
Vm 13,13,22
Vm 14,14,22
Vm 15,15,22
Aw 48,8
Aw 49,9
Aw 50,10
Aw 51,11
Aw 52,12
Aw 53,13
Aw 54,14
Aw 55,15
Ar 8,56
Ar 9,57
Ar 10,58
Ar 11,59
Ar 12,60
Ar 13,61
Ar 14,62
Ar 15,63
Vm 8,8,22
Vm 9,9,22
Vm 10,10,22
Vm 11,11,22
Vm 12,12,22
Vm 13,13,22
Vm 14,14,22
Vm 15,15,22
Aw 56,8
Aw 57,9
Aw 58,10
Aw 59,11
Aw 60,12
Aw 61,13
Aw 62,14
Aw 63,15
v_max3_f32 v21, v160, v161, v162
v_max3_f32 v21, v21, v163, v164
v_max3_f32 v21, v21, v165, v166
v_max3_f32 v21, v21, v167, v168
v_max3_f32 v21, v21, v169, v170
v_max3_f32 v21, v21, v171, v172
v_max3_f32 v21, v21, v173, v174
v_max_f32 v21, v21, v175
v_mov_b32 v1, v21
s_nop 1
v_permlane16_swap_b32 v1, v21
v_max_f32 v21, v21, v1
v_mov_b32 v1, v21
s_nop 1
v_permlane32_swap_b32 v1, v21
v_max_f32_e64 v21, v21, v1
v_add_f32 v21, 0x41f80000, v21
v_max_f32 v21, 0, v21
Vs 160,160,21
Vs 161,161,21
Vs 162,162,21
Vs 163,163,21
Vs 164,164,21
Vs 165,165,21
Vs 166,166,21
Vs 167,167,21
Vs 168,168,21
Vs 169,169,21
Vs 170,170,21
Vs 171,171,21
Vs 172,172,21
Vs 173,173,21
Vs 174,174,21
Vs 175,175,21
Vs 224,224,21
Vs 225,225,21
Vs 226,226,21
Vs 227,227,21
Vs 228,228,21
Vs 229,229,21
Vs 230,230,21
Vs 231,231,21
Vs 232,232,21
Vs 233,233,21
Vs 234,234,21
Vs 235,235,21
Vs 236,236,21
Vs 237,237,21
Vs 238,238,21
Vs 239,239,21
Vs 40,40,21
Vs 41,41,21
Vs 42,42,21
v_sub_f32_e64 v43, v43, v21
v_exp_f32 v22, -v21
s_nop 0
Vm 56,56,22
Vm 57,57,22
Vm 58,58,22
v_mul_f32_e64 v59, v59, v22
Ar 8,64
Ar 9,65
Ar 10,66
Ar 11,67
Ar 12,68
Ar 13,69
Ar 14,70
Ar 15,71
Vm 8,8,22
Vm 9,9,22
Vm 10,10,22
Vm 11,11,22
Vm 12,12,22
Vm 13,13,22
Vm 14,14,22
Vm 15,15,22
Aw 64,8
Aw 65,9
Aw 66,10
Aw 67,11
Aw 68,12
Aw 69,13
Aw 70,14
Aw 71,15
Ar 8,72
Ar 9,73
Ar 10,74
Ar 11,75
Ar 12,76
Ar 13,77
Ar 14,78
Ar 15,79
Vm 8,8,22
Vm 9,9,22
Vm 10,10,22
Vm 11,11,22
Vm 12,12,22
Vm 13,13,22
Vm 14,14,22
Vm 15,15,22
Aw 72,8
Aw 73,9
Aw 74,10
Aw 75,11
Aw 76,12
Aw 77,13
Aw 78,14
Aw 79,15
Ar 8,80
Ar 9,81
Ar 10,82
Ar 11,83
Ar 12,84
Ar 13,85
Ar 14,86
Ar 15,87
Vm 8,8,22
Vm 9,9,22
Vm 10,10,22
Vm 11,11,22
Vm 12,12,22
Vm 13,13,22
Vm 14,14,22
Vm 15,15,22
Aw 80,8
Aw 81,9
Aw 82,10
Aw 83,11
Aw 84,12
Aw 85,13
Aw 86,14
Aw 87,15
Ar 8,88
Ar 9,89
Ar 10,90
Ar 11,91
Ar 12,92
Ar 13,93
Ar 14,94
Ar 15,95
Vm 8,8,22
Vm 9,9,22
Vm 10,10,22
Vm 11,11,22
Vm 12,12,22
Vm 13,13,22
Vm 14,14,22
Vm 15,15,22
Aw 88,8
Aw 89,9
Aw 90,10
Aw 91,11
Aw 92,12
Aw 93,13
Aw 94,14
Aw 95,15
v_max3_f32 v21, v176, v177, v178
v_max3_f32 v21, v21, v179, v180
v_max3_f32 v21, v21, v181, v182
v_max3_f32 v21, v21, v183, v184
v_max3_f32 v21, v21, v185, v186
v_max3_f32 v21, v21, v187, v188
v_max3_f32 v21, v21, v189, v190
v_max_f32 v21, v21, v191
v_mov_b32 v1, v21
s_nop 1
v_permlane16_swap_b32 v1, v21
v_max_f32 v21, v21, v1
v_mov_b32 v1, v21
s_nop 1
v_permlane32_swap_b32 v1, v21
v_max_f32_e64 v21, v21, v1
v_add_f32 v21, 0x41f80000, v21
v_max_f32 v21, 0, v21
Vs 176,176,21
Vs 177,177,21
Vs 178,178,21
Vs 179,179,21
Vs 180,180,21
Vs 181,181,21
Vs 182,182,21
Vs 183,183,21
Vs 184,184,21
Vs 185,185,21
Vs 186,186,21
Vs 187,187,21
Vs 188,188,21
Vs 189,189,21
Vs 190,190,21
Vs 191,191,21
Vs 44,44,21
Vs 45,45,21
Vs 46,46,21
v_sub_f32_e64 v47, v47, v21
v_exp_f32 v22, -v21
s_nop 0
Vm 60,60,22
Vm 61,61,22
Vm 62,62,22
v_mul_f32_e64 v63, v63, v22
Ar 8,96
Ar 9,97
Ar 10,98
Ar 11,99
Ar 12,100
Ar 13,101
Ar 14,102
Ar 15,103
Vm 8,8,22
Vm 9,9,22
Vm 10,10,22
Vm 11,11,22
Vm 12,12,22
Vm 13,13,22
Vm 14,14,22
Vm 15,15,22
Aw 96,8
Aw 97,9
Aw 98,10
Aw 99,11
Aw 100,12
Aw 101,13
Aw 102,14
Aw 103,15
Ar 8,104
Ar 9,105
Ar 10,106
Ar 11,107
Ar 12,108
Ar 13,109
Ar 14,110
Ar 15,111
Vm 8,8,22
Vm 9,9,22
Vm 10,10,22
Vm 11,11,22
Vm 12,12,22
Vm 13,13,22
Vm 14,14,22
Vm 15,15,22
Aw 104,8
Aw 105,9
Aw 106,10
Aw 107,11
Aw 108,12
Aw 109,13
Aw 110,14
Aw 111,15
Ar 8,112
Ar 9,113
Ar 10,114
Ar 11,115
Ar 12,116
Ar 13,117
Ar 14,118
Ar 15,119
Vm 8,8,22
Vm 9,9,22
Vm 10,10,22
Vm 11,11,22
Vm 12,12,22
Vm 13,13,22
Vm 14,14,22
Vm 15,15,22
Aw 112,8
Aw 113,9
Aw 114,10
Aw 115,11
Aw 116,12
Aw 117,13
Aw 118,14
Aw 119,15
Ar 8,120
Ar 9,121
Ar 10,122
Ar 11,123
Ar 12,124
Ar 13,125
Ar 14,126
Ar 15,127
Vm 8,8,22
Vm 9,9,22
Vm 10,10,22
Vm 11,11,22
Vm 12,12,22
Vm 13,13,22
Vm 14,14,22
Vm 15,15,22
Aw 120,8
Aw 121,9
Aw 122,10
Aw 123,11
Aw 124,12
Aw 125,13
Aw 126,14
Aw 127,15
Ve 8,128
Ve 9,129
s_nop 0
Vc 64,8,9
Ve 8,130
Ve 9,131
s_nop 0
Vc 65,8,9
Ve 8,144
Ve 9,145
s_nop 0
Vc 72,8,9
Ve 8,146
Ve 9,147
s_nop 0
Vc 73,8,9
Ve 8,160
Ve 9,161
s_nop 0
Vc 80,8,9
Ve 8,162
Ve 9,163
s_nop 0
Vc 81,8,9
Ve 8,176
Ve 9,177
s_nop 0
Vc 88,8,9
Ve 8,178
Ve 9,179
s_nop 0
Vc 89,8,9
Ve 8,132
Ve 9,133
s_nop 0
Vc 66,8,9
Ve 8,134
Ve 9,135
s_nop 0
Vc 67,8,9
Ve 8,148
Ve 9,149
s_nop 0
Vc 74,8,9
Ve 8,150
Ve 9,151
s_nop 0
Vc 75,8,9
Ve 8,164
Ve 9,165
s_nop 0
Vc 82,8,9
Ve 8,166
Ve 9,167
s_nop 0
Vc 83,8,9
Ve 8,180
Ve 9,181
s_nop 0
Vc 90,8,9
Ve 8,182
Ve 9,183
s_nop 0
Vc 91,8,9
Ve 8,136
Ve 9,137
s_nop 0
Vc 68,8,9
Ve 8,138
Ve 9,139
s_nop 0
Vc 69,8,9
Ve 8,152
Ve 9,153
s_nop 0
Vc 76,8,9
Ve 8,154
Ve 9,155
s_nop 0
Vc 77,8,9
Ve 8,168
Ve 9,169
s_nop 0
Vc 84,8,9
Ve 8,170
Ve 9,171
s_nop 0
Vc 85,8,9
Ve 8,184
Ve 9,185
s_nop 0
Vc 92,8,9
Ve 8,186
Ve 9,187
s_nop 0
Vc 93,8,9
Ve 8,140
Ve 9,141
s_nop 0
Vc 70,8,9
Ve 8,142
Ve 9,143
s_nop 0
Vc 71,8,9
Ve 8,156
Ve 9,157
s_nop 0
Vc 78,8,9
Ve 8,158
Ve 9,159
s_nop 0
Vc 79,8,9
Ve 8,172
Ve 9,173
s_nop 0
Vc 86,8,9
Ve 8,174
Ve 9,175
s_nop 0
Vc 87,8,9
Ve 8,188
Ve 9,189
s_nop 0
Vc 94,8,9
Ve 8,190
Ve 9,191
s_nop 0
Vc 95,8,9
s_nop 1
s_branch L_k2_fbr_wl
L_k2_fb_tr:
s_nop 7
s_nop 0
v_max3_f32 v21, v192, v193, v194
v_max3_f32 v21, v21, v195, v196
v_max3_f32 v21, v21, v197, v198
v_max3_f32 v21, v21, v199, v200
v_max3_f32 v21, v21, v201, v202
v_max3_f32 v21, v21, v203, v204
v_max3_f32 v21, v21, v205, v206
v_max_f32 v21, v21, v207
v_mov_b32 v1, v21
s_nop 1
v_permlane16_swap_b32 v1, v21
v_max_f32 v21, v21, v1
v_mov_b32 v1, v21
s_nop 1
v_permlane32_swap_b32 v1, v21
v_max_f32_e64 v21, v21, v1
v_add_f32 v21, 0x41f80000, v21
v_max_f32 v21, 0, v21
Vs 192,192,21
Vs 193,193,21
Vs 194,194,21
Vs 195,195,21
Vs 196,196,21
Vs 197,197,21
Vs 198,198,21
Vs 199,199,21
Vs 200,200,21
Vs 201,201,21
Vs 202,202,21
Vs 203,203,21
Vs 204,204,21
Vs 205,205,21
Vs 206,206,21
Vs 207,207,21
Vs 128,128,21
Vs 129,129,21
Vs 130,130,21
Vs 131,131,21
Vs 132,132,21
Vs 133,133,21
Vs 134,134,21
Vs 135,135,21
Vs 136,136,21
Vs 137,137,21
Vs 138,138,21
Vs 139,139,21
Vs 140,140,21
Vs 141,141,21
Vs 142,142,21
Vs 143,143,21
Vs 32,32,21
Vs 33,33,21
Vs 34,34,21
v_sub_f32_e64 v35, v35, v21
v_exp_f32 v22, -v21
s_nop 0
Vm 48,48,22
Vm 49,49,22
Vm 50,50,22
v_mul_f32_e64 v51, v51, v22
Ar 8,0
Ar 9,1
Ar 10,2
Ar 11,3
Ar 12,4
Ar 13,5
Ar 14,6
Ar 15,7
Vm 8,8,22
Vm 9,9,22
Vm 10,10,22
Vm 11,11,22
Vm 12,12,22
Vm 13,13,22
Vm 14,14,22
Vm 15,15,22
Aw 0,8
Aw 1,9
Aw 2,10
Aw 3,11
Aw 4,12
Aw 5,13
Aw 6,14
Aw 7,15
Ar 8,8
Ar 9,9
Ar 10,10
Ar 11,11
Ar 12,12
Ar 13,13
Ar 14,14
Ar 15,15
Vm 8,8,22
Vm 9,9,22
Vm 10,10,22
Vm 11,11,22
Vm 12,12,22
Vm 13,13,22
Vm 14,14,22
Vm 15,15,22
Aw 8,8
Aw 9,9
Aw 10,10
Aw 11,11
Aw 12,12
Aw 13,13
Aw 14,14
Aw 15,15
Ar 8,16
Ar 9,17
Ar 10,18
Ar 11,19
Ar 12,20
Ar 13,21
Ar 14,22
Ar 15,23
Vm 8,8,22
Vm 9,9,22
Vm 10,10,22
Vm 11,11,22
Vm 12,12,22
Vm 13,13,22
Vm 14,14,22
Vm 15,15,22
Aw 16,8
Aw 17,9
Aw 18,10
Aw 19,11
Aw 20,12
Aw 21,13
Aw 22,14
Aw 23,15
Ar 8,24
Ar 9,25
Ar 10,26
Ar 11,27
Ar 12,28
Ar 13,29
Ar 14,30
Ar 15,31
Vm 8,8,22
Vm 9,9,22
Vm 10,10,22
Vm 11,11,22
Vm 12,12,22
Vm 13,13,22
Vm 14,14,22
Vm 15,15,22
Aw 24,8
Aw 25,9
Aw 26,10
Aw 27,11
Aw 28,12
Aw 29,13
Aw 30,14
Aw 31,15
v_max3_f32 v21, v208, v209, v210
v_max3_f32 v21, v21, v211, v212
v_max3_f32 v21, v21, v213, v214
v_max3_f32 v21, v21, v215, v216
v_max3_f32 v21, v21, v217, v218
v_max3_f32 v21, v21, v219, v220
v_max3_f32 v21, v21, v221, v222
v_max_f32 v21, v21, v223
v_mov_b32 v1, v21
s_nop 1
v_permlane16_swap_b32 v1, v21
v_max_f32 v21, v21, v1
v_mov_b32 v1, v21
s_nop 1
v_permlane32_swap_b32 v1, v21
v_max_f32_e64 v21, v21, v1
v_add_f32 v21, 0x41f80000, v21
v_max_f32 v21, 0, v21
Vs 208,208,21
Vs 209,209,21
Vs 210,210,21
Vs 211,211,21
Vs 212,212,21
Vs 213,213,21
Vs 214,214,21
Vs 215,215,21
Vs 216,216,21
Vs 217,217,21
Vs 218,218,21
Vs 219,219,21
Vs 220,220,21
Vs 221,221,21
Vs 222,222,21
Vs 223,223,21
Vs 144,144,21
Vs 145,145,21
Vs 146,146,21
Vs 147,147,21
Vs 148,148,21
Vs 149,149,21
Vs 150,150,21
Vs 151,151,21
Vs 152,152,21
Vs 153,153,21
Vs 154,154,21
Vs 155,155,21
Vs 156,156,21
Vs 157,157,21
Vs 158,158,21
Vs 159,159,21
Vs 36,36,21
Vs 37,37,21
Vs 38,38,21
v_sub_f32_e64 v39, v39, v21
v_exp_f32 v22, -v21
s_nop 0
Vm 52,52,22
Vm 53,53,22
Vm 54,54,22
v_mul_f32_e64 v55, v55, v22
Ar 8,32
Ar 9,33
Ar 10,34
Ar 11,35
Ar 12,36
Ar 13,37
Ar 14,38
Ar 15,39
Vm 8,8,22
Vm 9,9,22
Vm 10,10,22
Vm 11,11,22
Vm 12,12,22
Vm 13,13,22
Vm 14,14,22
Vm 15,15,22
Aw 32,8
Aw 33,9
Aw 34,10
Aw 35,11
Aw 36,12
Aw 37,13
Aw 38,14
Aw 39,15
Ar 8,40
Ar 9,41
Ar 10,42
Ar 11,43
Ar 12,44
Ar 13,45
Ar 14,46
Ar 15,47
Vm 8,8,22
Vm 9,9,22
Vm 10,10,22
Vm 11,11,22
Vm 12,12,22
Vm 13,13,22
Vm 14,14,22
Vm 15,15,22
Aw 40,8
Aw 41,9
Aw 42,10
Aw 43,11
Aw 44,12
Aw 45,13
Aw 46,14
Aw 47,15
Ar 8,48
Ar 9,49
Ar 10,50
Ar 11,51
Ar 12,52
Ar 13,53
Ar 14,54
Ar 15,55
Vm 8,8,22
Vm 9,9,22
Vm 10,10,22
Vm 11,11,22
Vm 12,12,22
Vm 13,13,22
Vm 14,14,22
Vm 15,15,22
Aw 48,8
Aw 49,9
Aw 50,10
Aw 51,11
Aw 52,12
Aw 53,13
Aw 54,14
Aw 55,15
Ar 8,56
Ar 9,57
Ar 10,58
Ar 11,59
Ar 12,60
Ar 13,61
Ar 14,62
Ar 15,63
Vm 8,8,22
Vm 9,9,22
Vm 10,10,22
Vm 11,11,22
Vm 12,12,22
Vm 13,13,22
Vm 14,14,22
Vm 15,15,22
Aw 56,8
Aw 57,9
Aw 58,10
Aw 59,11
Aw 60,12
Aw 61,13
Aw 62,14
Aw 63,15
v_max3_f32 v21, v224, v225, v226
v_max3_f32 v21, v21, v227, v228
v_max3_f32 v21, v21, v229, v230
v_max3_f32 v21, v21, v231, v232
v_max3_f32 v21, v21, v233, v234
v_max3_f32 v21, v21, v235, v236
v_max3_f32 v21, v21, v237, v238
v_max_f32 v21, v21, v239
v_mov_b32 v1, v21
s_nop 1
v_permlane16_swap_b32 v1, v21
v_max_f32 v21, v21, v1
v_mov_b32 v1, v21
s_nop 1
v_permlane32_swap_b32 v1, v21
v_max_f32_e64 v21, v21, v1
v_add_f32 v21, 0x41f80000, v21
v_max_f32 v21, 0, v21
Vs 224,224,21
Vs 225,225,21
Vs 226,226,21
Vs 227,227,21
Vs 228,228,21
Vs 229,229,21
Vs 230,230,21
Vs 231,231,21
Vs 232,232,21
Vs 233,233,21
Vs 234,234,21
Vs 235,235,21
Vs 236,236,21
Vs 237,237,21
Vs 238,238,21
Vs 239,239,21
Vs 40,40,21
Vs 41,41,21
Vs 42,42,21
v_sub_f32_e64 v43, v43, v21
v_exp_f32 v22, -v21
s_nop 0
Vm 56,56,22
Vm 57,57,22
Vm 58,58,22
v_mul_f32_e64 v59, v59, v22
Ar 8,64
Ar 9,65
Ar 10,66
Ar 11,67
Ar 12,68
Ar 13,69
Ar 14,70
Ar 15,71
Vm 8,8,22
Vm 9,9,22
Vm 10,10,22
Vm 11,11,22
Vm 12,12,22
Vm 13,13,22
Vm 14,14,22
Vm 15,15,22
Aw 64,8
Aw 65,9
Aw 66,10
Aw 67,11
Aw 68,12
Aw 69,13
Aw 70,14
Aw 71,15
Ar 8,72
Ar 9,73
Ar 10,74
Ar 11,75
Ar 12,76
Ar 13,77
Ar 14,78
Ar 15,79
Vm 8,8,22
Vm 9,9,22
Vm 10,10,22
Vm 11,11,22
Vm 12,12,22
Vm 13,13,22
Vm 14,14,22
Vm 15,15,22
Aw 72,8
Aw 73,9
Aw 74,10
Aw 75,11
Aw 76,12
Aw 77,13
Aw 78,14
Aw 79,15
Ar 8,80
Ar 9,81
Ar 10,82
Ar 11,83
Ar 12,84
Ar 13,85
Ar 14,86
Ar 15,87
Vm 8,8,22
Vm 9,9,22
Vm 10,10,22
Vm 11,11,22
Vm 12,12,22
Vm 13,13,22
Vm 14,14,22
Vm 15,15,22
Aw 80,8
Aw 81,9
Aw 82,10
Aw 83,11
Aw 84,12
Aw 85,13
Aw 86,14
Aw 87,15
Ar 8,88
Ar 9,89
Ar 10,90
Ar 11,91
Ar 12,92
Ar 13,93
Ar 14,94
Ar 15,95
Vm 8,8,22
Vm 9,9,22
Vm 10,10,22
Vm 11,11,22
Vm 12,12,22
Vm 13,13,22
Vm 14,14,22
Vm 15,15,22
Aw 88,8
Aw 89,9
Aw 90,10
Aw 91,11
Aw 92,12
Aw 93,13
Aw 94,14
Aw 95,15
Ve 8,192
Ve 9,193
s_nop 0
Vc 96,8,9
Ve 8,194
Ve 9,195
s_nop 0
Vc 97,8,9
Ve 8,208
Ve 9,209
s_nop 0
Vc 104,8,9
Ve 8,210
Ve 9,211
s_nop 0
Vc 105,8,9
Ve 8,224
Ve 9,225
s_nop 0
Vc 112,8,9
Ve 8,226
Ve 9,227
s_nop 0
Vc 113,8,9
Ve 8,196
Ve 9,197
s_nop 0
Vc 98,8,9
Ve 8,198
Ve 9,199
s_nop 0
Vc 99,8,9
Ve 8,212
Ve 9,213
s_nop 0
Vc 106,8,9
Ve 8,214
Ve 9,215
s_nop 0
Vc 107,8,9
Ve 8,228
Ve 9,229
s_nop 0
Vc 114,8,9
Ve 8,230
Ve 9,231
s_nop 0
Vc 115,8,9
Ve 8,200
Ve 9,201
s_nop 0
Vc 100,8,9
Ve 8,202
Ve 9,203
s_nop 0
Vc 101,8,9
Ve 8,216
Ve 9,217
s_nop 0
Vc 108,8,9
Ve 8,218
Ve 9,219
s_nop 0
Vc 109,8,9
Ve 8,232
Ve 9,233
s_nop 0
Vc 116,8,9
Ve 8,234
Ve 9,235
s_nop 0
Vc 117,8,9
Ve 8,204
Ve 9,205
s_nop 0
Vc 102,8,9
Ve 8,206
Ve 9,207
s_nop 0
Vc 103,8,9
Ve 8,220
Ve 9,221
s_nop 0
Vc 110,8,9
Ve 8,222
Ve 9,223
s_nop 0
Vc 111,8,9
Ve 8,236
Ve 9,237
s_nop 0
Vc 118,8,9
Ve 8,238
Ve 9,239
s_nop 0
Vc 119,8,9
s_nop 1
s_branch L_k2_fbr_tr
L_k2_fb_ne:
s_nop 7
s_nop 0
v_max3_f32 v21, v128, v129, v130
v_max3_f32 v21, v21, v131, v132
v_max3_f32 v21, v21, v133, v134
v_max3_f32 v21, v21, v135, v136
v_max3_f32 v21, v21, v137, v138
v_max3_f32 v21, v21, v139, v140
v_max3_f32 v21, v21, v141, v142
v_max_f32 v21, v21, v143
v_mov_b32 v1, v21
s_nop 1
v_permlane16_swap_b32 v1, v21
v_max_f32 v21, v21, v1
v_mov_b32 v1, v21
s_nop 1
v_permlane32_swap_b32 v1, v21
v_max_f32_e64 v21, v21, v1
v_add_f32 v21, 0x41f80000, v21
v_max_f32 v21, 0, v21
Vs 128,128,21
Vs 129,129,21
Vs 130,130,21
Vs 131,131,21
Vs 132,132,21
Vs 133,133,21
Vs 134,134,21
Vs 135,135,21
Vs 136,136,21
Vs 137,137,21
Vs 138,138,21
Vs 139,139,21
Vs 140,140,21
Vs 141,141,21
Vs 142,142,21
Vs 143,143,21
Vs 192,192,21
Vs 193,193,21
Vs 194,194,21
Vs 195,195,21
Vs 196,196,21
Vs 197,197,21
Vs 198,198,21
Vs 199,199,21
Vs 200,200,21
Vs 201,201,21
Vs 202,202,21
Vs 203,203,21
Vs 204,204,21
Vs 205,205,21
Vs 206,206,21
Vs 207,207,21
Vs 32,32,21
Vs 33,33,21
Vs 34,34,21
v_sub_f32_e64 v35, v35, v21
v_exp_f32 v22, -v21
s_nop 0
Vm 48,48,22
Vm 49,49,22
Vm 50,50,22
v_mul_f32_e64 v51, v51, v22
Ar 8,0
Ar 9,1
Ar 10,2
Ar 11,3
Ar 12,4
Ar 13,5
Ar 14,6
Ar 15,7
Vm 8,8,22
Vm 9,9,22
Vm 10,10,22
Vm 11,11,22
Vm 12,12,22
Vm 13,13,22
Vm 14,14,22
Vm 15,15,22
Aw 0,8
Aw 1,9
Aw 2,10
Aw 3,11
Aw 4,12
Aw 5,13
Aw 6,14
Aw 7,15
Ar 8,8
Ar 9,9
Ar 10,10
Ar 11,11
Ar 12,12
Ar 13,13
Ar 14,14
Ar 15,15
Vm 8,8,22
Vm 9,9,22
Vm 10,10,22
Vm 11,11,22
Vm 12,12,22
Vm 13,13,22
Vm 14,14,22
Vm 15,15,22
Aw 8,8
Aw 9,9
Aw 10,10
Aw 11,11
Aw 12,12
Aw 13,13
Aw 14,14
Aw 15,15
Ar 8,16
Ar 9,17
Ar 10,18
Ar 11,19
Ar 12,20
Ar 13,21
Ar 14,22
Ar 15,23
Vm 8,8,22
Vm 9,9,22
Vm 10,10,22
Vm 11,11,22
Vm 12,12,22
Vm 13,13,22
Vm 14,14,22
Vm 15,15,22
Aw 16,8
Aw 17,9
Aw 18,10
Aw 19,11
Aw 20,12
Aw 21,13
Aw 22,14
Aw 23,15
Ar 8,24
Ar 9,25
Ar 10,26
Ar 11,27
Ar 12,28
Ar 13,29
Ar 14,30
Ar 15,31
Vm 8,8,22
Vm 9,9,22
Vm 10,10,22
Vm 11,11,22
Vm 12,12,22
Vm 13,13,22
Vm 14,14,22
Vm 15,15,22
Aw 24,8
Aw 25,9
Aw 26,10
Aw 27,11
Aw 28,12
Aw 29,13
Aw 30,14
Aw 31,15
v_max3_f32 v21, v144, v145, v146
v_max3_f32 v21, v21, v147, v148
v_max3_f32 v21, v21, v149, v150
v_max3_f32 v21, v21, v151, v152
v_max3_f32 v21, v21, v153, v154
v_max3_f32 v21, v21, v155, v156
v_max3_f32 v21, v21, v157, v158
v_max_f32 v21, v21, v159
v_mov_b32 v1, v21
s_nop 1
v_permlane16_swap_b32 v1, v21
v_max_f32 v21, v21, v1
v_mov_b32 v1, v21
s_nop 1
v_permlane32_swap_b32 v1, v21
v_max_f32_e64 v21, v21, v1
v_add_f32 v21, 0x41f80000, v21
v_max_f32 v21, 0, v21
Vs 144,144,21
Vs 145,145,21
Vs 146,146,21
Vs 147,147,21
Vs 148,148,21
Vs 149,149,21
Vs 150,150,21
Vs 151,151,21
Vs 152,152,21
Vs 153,153,21
Vs 154,154,21
Vs 155,155,21
Vs 156,156,21
Vs 157,157,21
Vs 158,158,21
Vs 159,159,21
Vs 208,208,21
Vs 209,209,21
Vs 210,210,21
Vs 211,211,21
Vs 212,212,21
Vs 213,213,21
Vs 214,214,21
Vs 215,215,21
Vs 216,216,21
Vs 217,217,21
Vs 218,218,21
Vs 219,219,21
Vs 220,220,21
Vs 221,221,21
Vs 222,222,21
Vs 223,223,21
Vs 36,36,21
Vs 37,37,21
Vs 38,38,21
v_sub_f32_e64 v39, v39, v21
v_exp_f32 v22, -v21
s_nop 0
Vm 52,52,22
Vm 53,53,22
Vm 54,54,22
v_mul_f32_e64 v55, v55, v22
Ar 8,32
Ar 9,33
Ar 10,34
Ar 11,35
Ar 12,36
Ar 13,37
Ar 14,38
Ar 15,39
Vm 8,8,22
Vm 9,9,22
Vm 10,10,22
Vm 11,11,22
Vm 12,12,22
Vm 13,13,22
Vm 14,14,22
Vm 15,15,22
Aw 32,8
Aw 33,9
Aw 34,10
Aw 35,11
Aw 36,12
Aw 37,13
Aw 38,14
Aw 39,15
Ar 8,40
Ar 9,41
Ar 10,42
Ar 11,43
Ar 12,44
Ar 13,45
Ar 14,46
Ar 15,47
Vm 8,8,22
Vm 9,9,22
Vm 10,10,22
Vm 11,11,22
Vm 12,12,22
Vm 13,13,22
Vm 14,14,22
Vm 15,15,22
Aw 40,8
Aw 41,9
Aw 42,10
Aw 43,11
Aw 44,12
Aw 45,13
Aw 46,14
Aw 47,15
Ar 8,48
Ar 9,49
Ar 10,50
Ar 11,51
Ar 12,52
Ar 13,53
Ar 14,54
Ar 15,55
Vm 8,8,22
Vm 9,9,22
Vm 10,10,22
Vm 11,11,22
Vm 12,12,22
Vm 13,13,22
Vm 14,14,22
Vm 15,15,22
Aw 48,8
Aw 49,9
Aw 50,10
Aw 51,11
Aw 52,12
Aw 53,13
Aw 54,14
Aw 55,15
Ar 8,56
Ar 9,57
Ar 10,58
Ar 11,59
Ar 12,60
Ar 13,61
Ar 14,62
Ar 15,63
Vm 8,8,22
Vm 9,9,22
Vm 10,10,22
Vm 11,11,22
Vm 12,12,22
Vm 13,13,22
Vm 14,14,22
Vm 15,15,22
Aw 56,8
Aw 57,9
Aw 58,10
Aw 59,11
Aw 60,12
Aw 61,13
Aw 62,14
Aw 63,15
Ve 8,128
Ve 9,129
s_nop 0
Vc 64,8,9
Ve 8,130
Ve 9,131
s_nop 0
Vc 65,8,9
Ve 8,144
Ve 9,145
s_nop 0
Vc 72,8,9
Ve 8,146
Ve 9,147
s_nop 0
Vc 73,8,9
Ve 8,132
Ve 9,133
s_nop 0
Vc 66,8,9
Ve 8,134
Ve 9,135
s_nop 0
Vc 67,8,9
Ve 8,148
Ve 9,149
s_nop 0
Vc 74,8,9
Ve 8,150
Ve 9,151
s_nop 0
Vc 75,8,9
Ve 8,136
Ve 9,137
s_nop 0
Vc 68,8,9
Ve 8,138
Ve 9,139
s_nop 0
Vc 69,8,9
Ve 8,152
Ve 9,153
s_nop 0
Vc 76,8,9
Ve 8,154
Ve 9,155
s_nop 0
Vc 77,8,9
Ve 8,140
Ve 9,141
s_nop 0
Vc 70,8,9
Ve 8,142
Ve 9,143
s_nop 0
Vc 71,8,9
Ve 8,156
Ve 9,157
s_nop 0
Vc 78,8,9
Ve 8,158
Ve 9,159
s_nop 0
Vc 79,8,9
s_nop 1
s_branch L_k2_fbr_ne
L_k2_fb_no:
s_nop 7
s_nop 0
v_max3_f32 v21, v192, v193, v194
v_max3_f32 v21, v21, v195, v196
v_max3_f32 v21, v21, v197, v198
v_max3_f32 v21, v21, v199, v200
v_max3_f32 v21, v21, v201, v202
v_max3_f32 v21, v21, v203, v204
v_max3_f32 v21, v21, v205, v206
v_max_f32 v21, v21, v207
v_mov_b32 v1, v21
s_nop 1
v_permlane16_swap_b32 v1, v21
v_max_f32 v21, v21, v1
v_mov_b32 v1, v21
s_nop 1
v_permlane32_swap_b32 v1, v21
v_max_f32_e64 v21, v21, v1
v_add_f32 v21, 0x41f80000, v21
v_max_f32 v21, 0, v21
Vs 192,192,21
Vs 193,193,21
Vs 194,194,21
Vs 195,195,21
Vs 196,196,21
Vs 197,197,21
Vs 198,198,21
Vs 199,199,21
Vs 200,200,21
Vs 201,201,21
Vs 202,202,21
Vs 203,203,21
Vs 204,204,21
Vs 205,205,21
Vs 206,206,21
Vs 207,207,21
Vs 128,128,21
Vs 129,129,21
Vs 130,130,21
Vs 131,131,21
Vs 132,132,21
Vs 133,133,21
Vs 134,134,21
Vs 135,135,21
Vs 136,136,21
Vs 137,137,21
Vs 138,138,21
Vs 139,139,21
Vs 140,140,21
Vs 141,141,21
Vs 142,142,21
Vs 143,143,21
Vs 32,32,21
Vs 33,33,21
Vs 34,34,21
v_sub_f32_e64 v35, v35, v21
v_exp_f32 v22, -v21
s_nop 0
Vm 48,48,22
Vm 49,49,22
Vm 50,50,22
v_mul_f32_e64 v51, v51, v22
Ar 8,0
Ar 9,1
Ar 10,2
Ar 11,3
Ar 12,4
Ar 13,5
Ar 14,6
Ar 15,7
Vm 8,8,22
Vm 9,9,22
Vm 10,10,22
Vm 11,11,22
Vm 12,12,22
Vm 13,13,22
Vm 14,14,22
Vm 15,15,22
Aw 0,8
Aw 1,9
Aw 2,10
Aw 3,11
Aw 4,12
Aw 5,13
Aw 6,14
Aw 7,15
Ar 8,8
Ar 9,9
Ar 10,10
Ar 11,11
Ar 12,12
Ar 13,13
Ar 14,14
Ar 15,15
Vm 8,8,22
Vm 9,9,22
Vm 10,10,22
Vm 11,11,22
Vm 12,12,22
Vm 13,13,22
Vm 14,14,22
Vm 15,15,22
Aw 8,8
Aw 9,9
Aw 10,10
Aw 11,11
Aw 12,12
Aw 13,13
Aw 14,14
Aw 15,15
Ar 8,16
Ar 9,17
Ar 10,18
Ar 11,19
Ar 12,20
Ar 13,21
Ar 14,22
Ar 15,23
Vm 8,8,22
Vm 9,9,22
Vm 10,10,22
Vm 11,11,22
Vm 12,12,22
Vm 13,13,22
Vm 14,14,22
Vm 15,15,22
Aw 16,8
Aw 17,9
Aw 18,10
Aw 19,11
Aw 20,12
Aw 21,13
Aw 22,14
Aw 23,15
Ar 8,24
Ar 9,25
Ar 10,26
Ar 11,27
Ar 12,28
Ar 13,29
Ar 14,30
Ar 15,31
Vm 8,8,22
Vm 9,9,22
Vm 10,10,22
Vm 11,11,22
Vm 12,12,22
Vm 13,13,22
Vm 14,14,22
Vm 15,15,22
Aw 24,8
Aw 25,9
Aw 26,10
Aw 27,11
Aw 28,12
Aw 29,13
Aw 30,14
Aw 31,15
v_max3_f32 v21, v208, v209, v210
v_max3_f32 v21, v21, v211, v212
v_max3_f32 v21, v21, v213, v214
v_max3_f32 v21, v21, v215, v216
v_max3_f32 v21, v21, v217, v218
v_max3_f32 v21, v21, v219, v220
v_max3_f32 v21, v21, v221, v222
v_max_f32 v21, v21, v223
v_mov_b32 v1, v21
s_nop 1
v_permlane16_swap_b32 v1, v21
v_max_f32 v21, v21, v1
v_mov_b32 v1, v21
s_nop 1
v_permlane32_swap_b32 v1, v21
v_max_f32_e64 v21, v21, v1
v_add_f32 v21, 0x41f80000, v21
v_max_f32 v21, 0, v21
Vs 208,208,21
Vs 209,209,21
Vs 210,210,21
Vs 211,211,21
Vs 212,212,21
Vs 213,213,21
Vs 214,214,21
Vs 215,215,21
Vs 216,216,21
Vs 217,217,21
Vs 218,218,21
Vs 219,219,21
Vs 220,220,21
Vs 221,221,21
Vs 222,222,21
Vs 223,223,21
Vs 144,144,21
Vs 145,145,21
Vs 146,146,21
Vs 147,147,21
Vs 148,148,21
Vs 149,149,21
Vs 150,150,21
Vs 151,151,21
Vs 152,152,21
Vs 153,153,21
Vs 154,154,21
Vs 155,155,21
Vs 156,156,21
Vs 157,157,21
Vs 158,158,21
Vs 159,159,21
Vs 36,36,21
Vs 37,37,21
Vs 38,38,21
v_sub_f32_e64 v39, v39, v21
v_exp_f32 v22, -v21
s_nop 0
Vm 52,52,22
Vm 53,53,22
Vm 54,54,22
v_mul_f32_e64 v55, v55, v22
Ar 8,32
Ar 9,33
Ar 10,34
Ar 11,35
Ar 12,36
Ar 13,37
Ar 14,38
Ar 15,39
Vm 8,8,22
Vm 9,9,22
Vm 10,10,22
Vm 11,11,22
Vm 12,12,22
Vm 13,13,22
Vm 14,14,22
Vm 15,15,22
Aw 32,8
Aw 33,9
Aw 34,10
Aw 35,11
Aw 36,12
Aw 37,13
Aw 38,14
Aw 39,15
Ar 8,40
Ar 9,41
Ar 10,42
Ar 11,43
Ar 12,44
Ar 13,45
Ar 14,46
Ar 15,47
Vm 8,8,22
Vm 9,9,22
Vm 10,10,22
Vm 11,11,22
Vm 12,12,22
Vm 13,13,22
Vm 14,14,22
Vm 15,15,22
Aw 40,8
Aw 41,9
Aw 42,10
Aw 43,11
Aw 44,12
Aw 45,13
Aw 46,14
Aw 47,15
Ar 8,48
Ar 9,49
Ar 10,50
Ar 11,51
Ar 12,52
Ar 13,53
Ar 14,54
Ar 15,55
Vm 8,8,22
Vm 9,9,22
Vm 10,10,22
Vm 11,11,22
Vm 12,12,22
Vm 13,13,22
Vm 14,14,22
Vm 15,15,22
Aw 48,8
Aw 49,9
Aw 50,10
Aw 51,11
Aw 52,12
Aw 53,13
Aw 54,14
Aw 55,15
Ar 8,56
Ar 9,57
Ar 10,58
Ar 11,59
Ar 12,60
Ar 13,61
Ar 14,62
Ar 15,63
Vm 8,8,22
Vm 9,9,22
Vm 10,10,22
Vm 11,11,22
Vm 12,12,22
Vm 13,13,22
Vm 14,14,22
Vm 15,15,22
Aw 56,8
Aw 57,9
Aw 58,10
Aw 59,11
Aw 60,12
Aw 61,13
Aw 62,14
Aw 63,15
Ve 8,192
Ve 9,193
s_nop 0
Vc 96,8,9
Ve 8,194
Ve 9,195
s_nop 0
Vc 97,8,9
Ve 8,208
Ve 9,209
s_nop 0
Vc 104,8,9
Ve 8,210
Ve 9,211
s_nop 0
Vc 105,8,9
Ve 8,196
Ve 9,197
s_nop 0
Vc 98,8,9
Ve 8,198
Ve 9,199
s_nop 0
Vc 99,8,9
Ve 8,212
Ve 9,213
s_nop 0
Vc 106,8,9
Ve 8,214
Ve 9,215
s_nop 0
Vc 107,8,9
Ve 8,200
Ve 9,201
s_nop 0
Vc 100,8,9
Ve 8,202
Ve 9,203
s_nop 0
Vc 101,8,9
Ve 8,216
Ve 9,217
s_nop 0
Vc 108,8,9
Ve 8,218
Ve 9,219
s_nop 0
Vc 109,8,9
Ve 8,204
Ve 9,205
s_nop 0
Vc 102,8,9
Ve 8,206
Ve 9,207
s_nop 0
Vc 103,8,9
Ve 8,220
Ve 9,221
s_nop 0
Vc 110,8,9
Ve 8,222
Ve 9,223
s_nop 0
Vc 111,8,9
s_nop 1
s_branch L_k2_fbr_no
L_k2_fb_nl:
s_nop 7
s_nop 0
v_max3_f32 v21, v128, v129, v130
v_max3_f32 v21, v21, v131, v132
v_max3_f32 v21, v21, v133, v134
v_max3_f32 v21, v21, v135, v136
v_max3_f32 v21, v21, v137, v138
v_max3_f32 v21, v21, v139, v140
v_max3_f32 v21, v21, v141, v142
v_max_f32 v21, v21, v143
v_mov_b32 v1, v21
s_nop 1
v_permlane16_swap_b32 v1, v21
v_max_f32 v21, v21, v1
v_mov_b32 v1, v21
s_nop 1
v_permlane32_swap_b32 v1, v21
v_max_f32_e64 v21, v21, v1
v_add_f32 v21, 0x41f80000, v21
v_max_f32 v21, 0, v21
Vs 128,128,21
Vs 129,129,21
Vs 130,130,21
Vs 131,131,21
Vs 132,132,21
Vs 133,133,21
Vs 134,134,21
Vs 135,135,21
Vs 136,136,21
Vs 137,137,21
Vs 138,138,21
Vs 139,139,21
Vs 140,140,21
Vs 141,141,21
Vs 142,142,21
Vs 143,143,21
Vs 192,192,21
Vs 193,193,21
Vs 194,194,21
Vs 195,195,21
Vs 196,196,21
Vs 197,197,21
Vs 198,198,21
Vs 199,199,21
Vs 200,200,21
Vs 201,201,21
Vs 202,202,21
Vs 203,203,21
Vs 204,204,21
Vs 205,205,21
Vs 206,206,21
Vs 207,207,21
Vs 32,32,21
Vs 33,33,21
Vs 34,34,21
v_sub_f32_e64 v35, v35, v21
v_exp_f32 v22, -v21
s_nop 0
Vm 48,48,22
Vm 49,49,22
Vm 50,50,22
v_mul_f32_e64 v51, v51, v22
Ar 8,0
Ar 9,1
Ar 10,2
Ar 11,3
Ar 12,4
Ar 13,5
Ar 14,6
Ar 15,7
Vm 8,8,22
Vm 9,9,22
Vm 10,10,22
Vm 11,11,22
Vm 12,12,22
Vm 13,13,22
Vm 14,14,22
Vm 15,15,22
Aw 0,8
Aw 1,9
Aw 2,10
Aw 3,11
Aw 4,12
Aw 5,13
Aw 6,14
Aw 7,15
Ar 8,8
Ar 9,9
Ar 10,10
Ar 11,11
Ar 12,12
Ar 13,13
Ar 14,14
Ar 15,15
Vm 8,8,22
Vm 9,9,22
Vm 10,10,22
Vm 11,11,22
Vm 12,12,22
Vm 13,13,22
Vm 14,14,22
Vm 15,15,22
Aw 8,8
Aw 9,9
Aw 10,10
Aw 11,11
Aw 12,12
Aw 13,13
Aw 14,14
Aw 15,15
Ar 8,16
Ar 9,17
Ar 10,18
Ar 11,19
Ar 12,20
Ar 13,21
Ar 14,22
Ar 15,23
Vm 8,8,22
Vm 9,9,22
Vm 10,10,22
Vm 11,11,22
Vm 12,12,22
Vm 13,13,22
Vm 14,14,22
Vm 15,15,22
Aw 16,8
Aw 17,9
Aw 18,10
Aw 19,11
Aw 20,12
Aw 21,13
Aw 22,14
Aw 23,15
Ar 8,24
Ar 9,25
Ar 10,26
Ar 11,27
Ar 12,28
Ar 13,29
Ar 14,30
Ar 15,31
Vm 8,8,22
Vm 9,9,22
Vm 10,10,22
Vm 11,11,22
Vm 12,12,22
Vm 13,13,22
Vm 14,14,22
Vm 15,15,22
Aw 24,8
Aw 25,9
Aw 26,10
Aw 27,11
Aw 28,12
Aw 29,13
Aw 30,14
Aw 31,15
v_max3_f32 v21, v144, v145, v146
v_max3_f32 v21, v21, v147, v148
v_max3_f32 v21, v21, v149, v150
v_max3_f32 v21, v21, v151, v152
v_max3_f32 v21, v21, v153, v154
v_max3_f32 v21, v21, v155, v156
v_max3_f32 v21, v21, v157, v158
v_max_f32 v21, v21, v159
v_mov_b32 v1, v21
s_nop 1
v_permlane16_swap_b32 v1, v21
v_max_f32 v21, v21, v1
v_mov_b32 v1, v21
s_nop 1
v_permlane32_swap_b32 v1, v21
v_max_f32_e64 v21, v21, v1
v_add_f32 v21, 0x41f80000, v21
v_max_f32 v21, 0, v21
Vs 144,144,21
Vs 145,145,21
Vs 146,146,21
Vs 147,147,21
Vs 148,148,21
Vs 149,149,21
Vs 150,150,21
Vs 151,151,21
Vs 152,152,21
Vs 153,153,21
Vs 154,154,21
Vs 155,155,21
Vs 156,156,21
Vs 157,157,21
Vs 158,158,21
Vs 159,159,21
Vs 36,36,21
Vs 37,37,21
Vs 38,38,21
v_sub_f32_e64 v39, v39, v21
v_exp_f32 v22, -v21
s_nop 0
Vm 52,52,22
Vm 53,53,22
Vm 54,54,22
v_mul_f32_e64 v55, v55, v22
Ar 8,32
Ar 9,33
Ar 10,34
Ar 11,35
Ar 12,36
Ar 13,37
Ar 14,38
Ar 15,39
Vm 8,8,22
Vm 9,9,22
Vm 10,10,22
Vm 11,11,22
Vm 12,12,22
Vm 13,13,22
Vm 14,14,22
Vm 15,15,22
Aw 32,8
Aw 33,9
Aw 34,10
Aw 35,11
Aw 36,12
Aw 37,13
Aw 38,14
Aw 39,15
Ar 8,40
Ar 9,41
Ar 10,42
Ar 11,43
Ar 12,44
Ar 13,45
Ar 14,46
Ar 15,47
Vm 8,8,22
Vm 9,9,22
Vm 10,10,22
Vm 11,11,22
Vm 12,12,22
Vm 13,13,22
Vm 14,14,22
Vm 15,15,22
Aw 40,8
Aw 41,9
Aw 42,10
Aw 43,11
Aw 44,12
Aw 45,13
Aw 46,14
Aw 47,15
Ar 8,48
Ar 9,49
Ar 10,50
Ar 11,51
Ar 12,52
Ar 13,53
Ar 14,54
Ar 15,55
Vm 8,8,22
Vm 9,9,22
Vm 10,10,22
Vm 11,11,22
Vm 12,12,22
Vm 13,13,22
Vm 14,14,22
Vm 15,15,22
Aw 48,8
Aw 49,9
Aw 50,10
Aw 51,11
Aw 52,12
Aw 53,13
Aw 54,14
Aw 55,15
Ar 8,56
Ar 9,57
Ar 10,58
Ar 11,59
Ar 12,60
Ar 13,61
Ar 14,62
Ar 15,63
Vm 8,8,22
Vm 9,9,22
Vm 10,10,22
Vm 11,11,22
Vm 12,12,22
Vm 13,13,22
Vm 14,14,22
Vm 15,15,22
Aw 56,8
Aw 57,9
Aw 58,10
Aw 59,11
Aw 60,12
Aw 61,13
Aw 62,14
Aw 63,15
Ve 8,128
Ve 9,129
s_nop 0
Vc 64,8,9
Ve 8,130
Ve 9,131
s_nop 0
Vc 65,8,9
Ve 8,144
Ve 9,145
s_nop 0
Vc 72,8,9
Ve 8,146
Ve 9,147
s_nop 0
Vc 73,8,9
Ve 8,132
Ve 9,133
s_nop 0
Vc 66,8,9
Ve 8,134
Ve 9,135
s_nop 0
Vc 67,8,9
Ve 8,148
Ve 9,149
s_nop 0
Vc 74,8,9
Ve 8,150
Ve 9,151
s_nop 0
Vc 75,8,9
Ve 8,136
Ve 9,137
s_nop 0
Vc 68,8,9
Ve 8,138
Ve 9,139
s_nop 0
Vc 69,8,9
Ve 8,152
Ve 9,153
s_nop 0
Vc 76,8,9
Ve 8,154
Ve 9,155
s_nop 0
Vc 77,8,9
Ve 8,140
Ve 9,141
s_nop 0
Vc 70,8,9
Ve 8,142
Ve 9,143
s_nop 0
Vc 71,8,9
Ve 8,156
Ve 9,157
s_nop 0
Vc 78,8,9
Ve 8,158
Ve 9,159
s_nop 0
Vc 79,8,9
s_nop 1
s_branch L_k2_fbr_nl
L_k2_fb_fi:
s_nop 7
s_nop 0
v_max3_f32 v21, v192, v193, v194
v_max3_f32 v21, v21, v195, v196
v_max3_f32 v21, v21, v197, v198
v_max3_f32 v21, v21, v199, v200
v_max3_f32 v21, v21, v201, v202
v_max3_f32 v21, v21, v203, v204
v_max3_f32 v21, v21, v205, v206
v_max_f32 v21, v21, v207
v_mov_b32 v1, v21
s_nop 1
v_permlane16_swap_b32 v1, v21
v_max_f32 v21, v21, v1
v_mov_b32 v1, v21
s_nop 1
v_permlane32_swap_b32 v1, v21
v_max_f32_e64 v21, v21, v1
v_add_f32 v21, 0x41f80000, v21
v_max_f32 v21, 0, v21
Vs 192,192,21
Vs 193,193,21
Vs 194,194,21
Vs 195,195,21
Vs 196,196,21
Vs 197,197,21
Vs 198,198,21
Vs 199,199,21
Vs 200,200,21
Vs 201,201,21
Vs 202,202,21
Vs 203,203,21
Vs 204,204,21
Vs 205,205,21
Vs 206,206,21
Vs 207,207,21
Vs 32,32,21
Vs 33,33,21
Vs 34,34,21
v_sub_f32_e64 v35, v35, v21
v_exp_f32 v22, -v21
s_nop 0
Vm 48,48,22
Vm 49,49,22
Vm 50,50,22
v_mul_f32_e64 v51, v51, v22
Ar 8,0
Ar 9,1
Ar 10,2
Ar 11,3
Ar 12,4
Ar 13,5
Ar 14,6
Ar 15,7
Vm 8,8,22
Vm 9,9,22
Vm 10,10,22
Vm 11,11,22
Vm 12,12,22
Vm 13,13,22
Vm 14,14,22
Vm 15,15,22
Aw 0,8
Aw 1,9
Aw 2,10
Aw 3,11
Aw 4,12
Aw 5,13
Aw 6,14
Aw 7,15
Ar 8,8
Ar 9,9
Ar 10,10
Ar 11,11
Ar 12,12
Ar 13,13
Ar 14,14
Ar 15,15
Vm 8,8,22
Vm 9,9,22
Vm 10,10,22
Vm 11,11,22
Vm 12,12,22
Vm 13,13,22
Vm 14,14,22
Vm 15,15,22
Aw 8,8
Aw 9,9
Aw 10,10
Aw 11,11
Aw 12,12
Aw 13,13
Aw 14,14
Aw 15,15
Ar 8,16
Ar 9,17
Ar 10,18
Ar 11,19
Ar 12,20
Ar 13,21
Ar 14,22
Ar 15,23
Vm 8,8,22
Vm 9,9,22
Vm 10,10,22
Vm 11,11,22
Vm 12,12,22
Vm 13,13,22
Vm 14,14,22
Vm 15,15,22
Aw 16,8
Aw 17,9
Aw 18,10
Aw 19,11
Aw 20,12
Aw 21,13
Aw 22,14
Aw 23,15
Ar 8,24
Ar 9,25
Ar 10,26
Ar 11,27
Ar 12,28
Ar 13,29
Ar 14,30
Ar 15,31
Vm 8,8,22
Vm 9,9,22
Vm 10,10,22
Vm 11,11,22
Vm 12,12,22
Vm 13,13,22
Vm 14,14,22
Vm 15,15,22
Aw 24,8
Aw 25,9
Aw 26,10
Aw 27,11
Aw 28,12
Aw 29,13
Aw 30,14
Aw 31,15
Ve 8,192
Ve 9,193
s_nop 0
Vc 96,8,9
Ve 8,194
Ve 9,195
s_nop 0
Vc 97,8,9
Ve 8,196
Ve 9,197
s_nop 0
Vc 98,8,9
Ve 8,198
Ve 9,199
s_nop 0
Vc 99,8,9
Ve 8,200
Ve 9,201
s_nop 0
Vc 100,8,9
Ve 8,202
Ve 9,203
s_nop 0
Vc 101,8,9
Ve 8,204
Ve 9,205
s_nop 0
Vc 102,8,9
Ve 8,206
Ve 9,207
s_nop 0
Vc 103,8,9
s_nop 1
s_branch L_k2_fbr_fi
L_spinX:
s_mov_b32 s47, 0x400000
L_spinXl:
buffer_load_dword v17, v126, s[20:23], s24 offen sc1
s_sub_u32 s47, s47, 1
s_waitcnt vmcnt(0)
s_cmp_eq_u32 s47, 0
s_cbranch_scc1 L_spinXlx
v_cmp_ne_u32 vcc, 1, v17
s_cbranch_vccz L_spinXlx
s_sleep 1
s_branch L_spinXl
L_spinXlx:
buffer_load_dwordx4 v[160:163], v112, s[16:19], s25 offen offset:0 sc1
buffer_load_dwordx4 v[164:167], v112, s[16:19], s25 offen offset:1024 sc1
buffer_load_dwordx4 v[168:171], v112, s[16:19], s25 offen offset:2048 sc1
buffer_load_dwordx4 v[172:175], v112, s[16:19], s25 offen offset:3072 sc1
buffer_load_dwordx4 v[176:179], v10, s[16:19], s25 offen offset:0 sc1
buffer_load_dwordx4 v[180:183], v10, s[16:19], s25 offen offset:1024 sc1
buffer_load_dwordx4 v[184:187], v10, s[16:19], s25 offen offset:2048 sc1
buffer_load_dwordx4 v[188:191], v10, s[16:19], s25 offen offset:3072 sc1
s_branch L_spinXr
L_ysl:
s_mov_b32 s47, 0x400000
L_ysll:
buffer_load_dword v124, v127, s[20:23], s41 offen sc1
s_sub_u32 s47, s47, 1
s_waitcnt vmcnt(0)
s_cmp_eq_u32 s47, 0
s_cbranch_scc1 L_ysllx
v_cmp_ne_u32 vcc, 1, v124
s_cbranch_vccz L_ysllx
s_sleep 8
s_branch L_ysll
L_ysllx:
v_lshlrev_b32 v124, 2, v0
v_lshlrev_b32 v125, 1, v0
s_lshl_b32 s7, s45, 2
s_add_u32 s7, s7, s32
s_lshr_b32 s3, s42, 5
s_cmp_lg_u32 s3, s7
s_cbranch_scc1 L_f_yl13
s_add_u32 s3, s55, 0
s_nop 0
s_add_u32 s7, s3, 4096
buffer_load_dword v76, v124, s[20:23], s3 offen offset:0 sc1
buffer_load_dword v77, v124, s[20:23], s3 offen offset:512 sc1
buffer_load_dword v78, v124, s[20:23], s3 offen offset:1024 sc1
buffer_load_dword v79, v124, s[20:23], s3 offen offset:1536 sc1
buffer_load_dword v80, v124, s[20:23], s3 offen offset:2048 sc1
buffer_load_dword v81, v124, s[20:23], s3 offen offset:2560 sc1
buffer_load_dword v82, v124, s[20:23], s3 offen offset:3072 sc1
buffer_load_dword v83, v124, s[20:23], s3 offen offset:3584 sc1
buffer_load_dword v84, v124, s[20:23], s7 offen offset:0 sc1
buffer_load_dword v85, v124, s[20:23], s7 offen offset:512 sc1
buffer_load_dword v86, v124, s[20:23], s7 offen offset:1024 sc1
buffer_load_dword v87, v124, s[20:23], s7 offen offset:1536 sc1
buffer_load_dword v88, v124, s[20:23], s7 offen offset:2048 sc1
buffer_load_dword v89, v124, s[20:23], s7 offen offset:2560 sc1
s_lshl_b32 s3, s42, 11
s_lshl_b32 s7, s46, 7
s_add_u32 s3, s3, s7
buffer_load_ushort v90, v125, s[56:59], s3 offen
s_lshl_b32 s3, s42, 3
s_add_u32 s3, s3, 5259264
buffer_load_dwordx2 v[92:93], v126, s[20:23], s3 offen sc1
L_f_yl13:
s_lshl_b32 s7, s45, 2
s_add_u32 s7, s7, s32
s_lshr_b32 s3, s43, 5
s_cmp_lg_u32 s3, s7
s_cbranch_scc1 L_f_yl14
s_nop 0
s_add_u32 s3, s55, 256
s_add_u32 s7, s3, 4096
buffer_load_dword v94, v124, s[20:23], s3 offen offset:0 sc1
buffer_load_dword v95, v124, s[20:23], s3 offen offset:512 sc1
buffer_load_dword v96, v124, s[20:23], s3 offen offset:1024 sc1
buffer_load_dword v97, v124, s[20:23], s3 offen offset:1536 sc1
buffer_load_dword v98, v124, s[20:23], s3 offen offset:2048 sc1
buffer_load_dword v99, v124, s[20:23], s3 offen offset:2560 sc1
buffer_load_dword v100, v124, s[20:23], s3 offen offset:3072 sc1
buffer_load_dword v101, v124, s[20:23], s3 offen offset:3584 sc1
buffer_load_dword v102, v124, s[20:23], s7 offen offset:0 sc1
buffer_load_dword v103, v124, s[20:23], s7 offen offset:512 sc1
buffer_load_dword v104, v124, s[20:23], s7 offen offset:1024 sc1
buffer_load_dword v105, v124, s[20:23], s7 offen offset:1536 sc1
buffer_load_dword v106, v124, s[20:23], s7 offen offset:2048 sc1
buffer_load_dword v107, v124, s[20:23], s7 offen offset:2560 sc1
s_lshl_b32 s3, s43, 11
s_lshl_b32 s7, s46, 7
s_add_u32 s3, s3, s7
buffer_load_ushort v108, v125, s[56:59], s3 offen
s_lshl_b32 s3, s43, 3
s_add_u32 s3, s3, 5259264
buffer_load_dwordx2 v[110:111], v126, s[20:23], s3 offen sc1
L_f_yl14:
s_waitcnt vmcnt(0)
s_lshl_b32 s7, s45, 2
s_add_u32 s7, s7, s32
s_lshr_b32 s3, s42, 5
s_cmp_lg_u32 s3, s7
s_cbranch_scc1 L_f_ys15
v_pk_add_f32 v[76:77], v[76:77], v[78:79]
v_pk_add_f32 v[76:77], v[76:77], v[80:81]
v_pk_add_f32 v[76:77], v[76:77], v[82:83]
v_pk_add_f32 v[76:77], v[76:77], v[84:85]
v_pk_add_f32 v[76:77], v[76:77], v[86:87]
v_pk_add_f32 v[76:77], v[76:77], v[88:89]
Va 76,76,77
v_lshlrev_b32 v90, 16, v90
v_sub_f32_e64 v90, v90, v92
Vc 76,76,76
v_lshlrev_b32_e64 v76, 16, v76
Vc 90,90,90
v_lshlrev_b32 v90, 16, v90
v_mul_f32 v76, s100, v76
v_mul_f32_e64 v90, v90, v93
Vc 76,76,76
v_lshlrev_b32_e64 v76, 16, v76
Vc 90,90,90
v_lshlrev_b32 v90, 16, v90
Va 90,90,76
Vc 90,90,90
v_lshlrev_b32_e64 v90, 16, v90
v_mul_f32 v76, 0xbfb8aa3b, v90
Ve 76,76
s_nop 0
v_add_f32 v76, 1.0, v76
v_rcp_f32 v76, v76
s_nop 0
Vm 90,90,76
Vc 90,90,90
v_lshlrev_b32 v90, 16, v90
v_lshlrev_b32 v124, 2, v0
v_add_u32 v124, s35, v124
v_lshlrev_b32 v125, 5, v122
v_add_u32 v125, s35, v125
s_waitcnt lgkmcnt(0)
ds_write_b32 v124, v90
s_and_b32 s3, s42, 7
s_lshl_b32 s3, s3, 3
s_lshl_b64 s[4:5], 0xff, s3
s_bfe_u32 s3, s42, 0x20003
s_mov_b64 exec, s[4:5]
s_cmp_lg_u32 s3, 0
s_cbranch_scc1 L_f_yp16
ds_read_b64 v[42:43], v125
ds_read_b64 v[44:45], v125 offset:8
ds_read_b64 v[46:47], v125 offset:16
ds_read_b64 v[48:49], v125 offset:24
L_f_yp16:
s_cmp_lg_u32 s3, 1
s_cbranch_scc1 L_f_yp17
ds_read_b64 v[50:51], v125
ds_read_b64 v[52:53], v125 offset:8
ds_read_b64 v[54:55], v125 offset:16
ds_read_b64 v[56:57], v125 offset:24
L_f_yp17:
s_cmp_lg_u32 s3, 2
s_cbranch_scc1 L_f_yp18
ds_read_b64 v[58:59], v125
ds_read_b64 v[60:61], v125 offset:8
ds_read_b64 v[62:63], v125 offset:16
ds_read_b64 v[64:65], v125 offset:24
L_f_yp18:
s_cmp_lg_u32 s3, 3
s_cbranch_scc1 L_f_yp19
ds_read_b64 v[66:67], v125
ds_read_b64 v[68:69], v125 offset:8
s_waitcnt lgkmcnt(9)
ds_read_b64 v[70:71], v125 offset:16
ds_read_b64 v[72:73], v125 offset:24
L_f_yp19:
s_mov_b64 exec, -1
s_waitcnt lgkmcnt(0)
L_f_ys15:
s_lshl_b32 s7, s45, 2
s_add_u32 s7, s7, s32
s_lshr_b32 s3, s43, 5
s_cmp_lg_u32 s3, s7
s_cbranch_scc1 L_f_ys20
s_nop 0
v_pk_add_f32 v[94:95], v[94:95], v[96:97]
v_pk_add_f32 v[94:95], v[94:95], v[98:99]
v_pk_add_f32 v[94:95], v[94:95], v[100:101]
v_pk_add_f32 v[94:95], v[94:95], v[102:103]
v_pk_add_f32 v[94:95], v[94:95], v[104:105]
v_pk_add_f32 v[94:95], v[94:95], v[106:107]
Va 94,94,95
v_lshlrev_b32 v108, 16, v108
v_sub_f32_e64 v108, v108, v110
Vc 94,94,94
v_lshlrev_b32_e64 v94, 16, v94
Vc 108,108,108
v_lshlrev_b32 v108, 16, v108
v_mul_f32 v94, s101, v94
v_mul_f32_e64 v108, v108, v111
Vc 94,94,94
v_lshlrev_b32_e64 v94, 16, v94
Vc 108,108,108
v_lshlrev_b32 v108, 16, v108
Va 108,108,94
Vc 108,108,108
v_lshlrev_b32_e64 v108, 16, v108
v_mul_f32 v94, 0xbfb8aa3b, v108
Ve 94,94
s_nop 0
v_add_f32 v94, 1.0, v94
v_rcp_f32 v94, v94
s_nop 0
Vm 108,108,94
Vc 108,108,108
v_lshlrev_b32 v108, 16, v108
v_lshlrev_b32 v124, 2, v0
v_add_u32 v124, s35, v124
v_lshlrev_b32 v125, 5, v122
v_add_u32 v125, s35, v125
s_waitcnt lgkmcnt(0)
ds_write_b32 v124, v108
s_and_b32 s3, s43, 7
s_lshl_b32 s3, s3, 3
s_lshl_b64 s[4:5], 0xff, s3
s_bfe_u32 s3, s43, 0x20003
s_mov_b64 exec, s[4:5]
s_cmp_lg_u32 s3, 0
s_cbranch_scc1 L_f_yp21
ds_read_b64 v[42:43], v125
ds_read_b64 v[44:45], v125 offset:8
ds_read_b64 v[46:47], v125 offset:16
ds_read_b64 v[48:49], v125 offset:24
L_f_yp21:
s_cmp_lg_u32 s3, 1
s_cbranch_scc1 L_f_yp22
ds_read_b64 v[50:51], v125
ds_read_b64 v[52:53], v125 offset:8
ds_read_b64 v[54:55], v125 offset:16
ds_read_b64 v[56:57], v125 offset:24
L_f_yp22:
s_cmp_lg_u32 s3, 2
s_cbranch_scc1 L_f_yp23
ds_read_b64 v[58:59], v125
ds_read_b64 v[60:61], v125 offset:8
ds_read_b64 v[62:63], v125 offset:16
ds_read_b64 v[64:65], v125 offset:24
L_f_yp23:
s_cmp_lg_u32 s3, 3
s_cbranch_scc1 L_f_yp24
ds_read_b64 v[66:67], v125
ds_read_b64 v[68:69], v125 offset:8
s_waitcnt lgkmcnt(9)
ds_read_b64 v[70:71], v125 offset:16
ds_read_b64 v[72:73], v125 offset:24
L_f_yp24:
s_mov_b64 exec, -1
s_waitcnt lgkmcnt(0)
L_f_ys20:
s_branch L_yslr
.section .rodata,"a"
.p2align 6
.amdhsa_kernel recurrent_scan__compressed_kv_cla__moe_arch_mod__prompt_kernel
  .amdhsa_next_free_vgpr 512
  .amdhsa_next_free_sgpr 102
  .amdhsa_accum_offset 256
  .amdhsa_group_segment_fixed_size 0
  .amdhsa_kernarg_size 112
  .amdhsa_user_sgpr_count 2
  .amdhsa_user_sgpr_kernarg_segment_ptr 1
  .amdhsa_system_sgpr_workgroup_id_x 1
.end_amdhsa_kernel
```

```asm
; @launch grid=(256,1,1) block=(256,1,1) lds=163840
.amdgcn_target "amdgcn-amd-amdhsa--gfx950"
.macro Va d,x,y
v_add_f32 v\d, v\x, v\y
.endm
.macro Vc d,x,y
v_cvt_pk_bf16_f32 v\d, v\x, v\y
.endm
.macro Ra d,x,o
ds_read_b128 a[\d:\d+3], v\x offset:\o
.endm
.macro Ta d,x,o
ds_read_b64_tr_b16 a[\d:\d+1], v\x offset:\o
.endm
.macro Zvaa d,x,y
v_mfma_f32_16x16x32_bf16 v[\d:\d+3], a[\x:\x+3], a[\y:\y+3], 0
.endm
.macro Mvaa d,x,y
v_mfma_f32_16x16x32_bf16 v[\d:\d+3], a[\x:\x+3], a[\y:\y+3], v[\d:\d+3]
.endm
.macro Rv d,x,o
ds_read_b128 v[\d:\d+3], v\x offset:\o
.endm
.macro Zaaa d,x,y
v_mfma_f32_16x16x32_bf16 a[\d:\d+3], a[\x:\x+3], a[\y:\y+3], 0
.endm
.macro Maaa d,x,y
v_mfma_f32_16x16x32_bf16 a[\d:\d+3], a[\x:\x+3], a[\y:\y+3], a[\d:\d+3]
.endm
.macro Ar d,x
v_accvgpr_read_b32 v\d, a\x
.endm
.macro Ve d,x
v_exp_f32 v\d, v\x
.endm
.macro Aw d,x
v_accvgpr_write_b32 a\d, v\x
.endm
.macro Vs d,x,y
v_sub_f32 v\d, v\x, v\y
.endm
.macro Cvaa d,x,y,c
v_mfma_f32_16x16x32_bf16 v[\d:\d+3], a[\x:\x+3], a[\y:\y+3], v[\c:\c+3]
.endm
.macro VE d,x
v_exp_f32_e64 v\d, v\x
.endm
.macro Maav d,x,y
v_mfma_f32_16x16x32_bf16 a[\d:\d+3], a[\x:\x+3], v[\y:\y+3], a[\d:\d+3]
.endm
.macro Mvvv d,x,y
v_mfma_f32_16x16x32_bf16 v[\d:\d+3], v[\x:\x+3], v[\y:\y+3], v[\d:\d+3]
.endm
.macro Zvva d,x,y
v_mfma_f32_16x16x32_bf16 v[\d:\d+3], v[\x:\x+3], a[\y:\y+3], 0
.endm
.macro Mvva d,x,y
v_mfma_f32_16x16x32_bf16 v[\d:\d+3], v[\x:\x+3], a[\y:\y+3], v[\d:\d+3]
.endm
.macro Vm d,x,y
v_mul_f32 v\d, v\x, v\y
.endm
.macro Zvvv d,x,y
v_mfma_f32_16x16x32_bf16 v[\d:\d+3], v[\x:\x+3], v[\y:\y+3], 0
.endm
.text
.globl recurrent_scan__compressed_kv_cla__moe_arch_mod__prompt_kernel
.p2align 8
.type recurrent_scan__compressed_kv_cla__moe_arch_mod__prompt_kernel,@function
recurrent_scan__compressed_kv_cla__moe_arch_mod__prompt_kernel:
s_cmp_ge_u32 s2, 256
s_cbranch_scc1 L_k2_end
s_load_dwordx4 s[4:7], s[0:1], 0
s_load_dwordx2 s[44:45], s[0:1], 56
s_load_dwordx4 s[40:43], s[0:1], 24
s_load_dwordx4 s[64:67], s[0:1], 96
v_lshrrev_b32 v1, 6, v0
v_and_b32 v0, 63, v0
v_readfirstlane_b32 s32, v1
s_getpc_b64 s[68:69]
L_cpf1:
s_add_u32 s68, s68, (recurrent_scan__compressed_kv_cla__moe_arch_mod__prompt_kernel-L_cpf1)&0xffffffff
s_addc_u32 s69, s69, ((recurrent_scan__compressed_kv_cla__moe_arch_mod__prompt_kernel-L_cpf1)>>32)&0xffffffff
s_lshr_b32 s70, s2, 3
s_lshl_b32 s70, s70, 2
s_add_u32 s70, s70, s32
s_lshl_b32 s70, s70, 10
v_and_b32 v122, 7, v0
v_lshlrev_b32 v122, 7, v122
v_add_u32 v122, s70, v122
v_min_u32 v122, L_k2_fin-recurrent_scan__compressed_kv_cla__moe_arch_mod__prompt_kernel-4, v122
v_mov_b32 v121, s69
v_add_co_u32 v120, vcc, s68, v122
s_nop 1
v_addc_co_u32 v121, vcc, 0, v121, vcc
global_load_dword v124, v[120:121], off
v_lshrrev_b32 v33, 5, v0
v_and_b32 v31, 31, v0
v_lshlrev_b32_e64 v36, 4, v31
v_lshl_add_u32 v35, v33, 11, v36
s_lshl_b32 s36, s2, 14
s_lshl_b32 s37, s32, 12
s_add_u32 s36, s36, s37
s_mov_b32 s18, 4194304
s_mov_b32 s19, 0x20000
s_bfe_u32 s33, s2, 0x30003
s_lshr_b32 s35, s2, 7
s_bfe_u32 s3, s2, 0x10006
s_and_b32 s34, s2, 7
s_lshl_b32 s34, s34, 1
s_add_u32 s34, s34, s3
s_waitcnt lgkmcnt(0)
s_mov_b32 s16, s4
s_and_b32 s17, s5, 0xffff
buffer_load_dwordx4 v[48:51], v35, s[16:19], s36 offen offset:0
buffer_load_dwordx4 v[52:55], v35, s[16:19], s36 offen offset:512
buffer_load_dwordx4 v[56:59], v35, s[16:19], s36 offen offset:1024
buffer_load_dwordx4 v[60:63], v35, s[16:19], s36 offen offset:1536
s_cmp_eq_u32 s35, 0
s_cselect_b32 s40, s40, s42
s_cselect_b32 s41, s41, s43
s_lshl_b32 s3, s34, 9
s_add_u32 s12, s40, s3
s_addc_u32 s13, s41, 0
s_and_b32 s13, s13, 0xffff
s_mov_b32 s14, 0
s_mov_b32 s15, 0x20000
s_sub_u32 s14, 4194304, s3
s_lshl_b32 s3, s33, 18
s_add_u32 s8, s6, s3
s_addc_u32 s9, s7, 0
s_and_b32 s9, s9, 0xffff
s_mov_b32 s10, 262144
s_mov_b32 s11, 0x20000
s_and_b32 s58, s2, 7
s_mov_b32 s52, 0
s_mov_b32 s53, 15360
s_mov_b32 s54, 30720
s_mov_b32 s55, 46080
s_lshl_b32 s57, s32, 13
s_add_u32 s56, s57, 32768
s_lshl_b32 s3, s58, 2
s_add_u32 s3, s3, s32
s_lshl_b32 s3, s3, 4
v_add_u32 v30, s3, v33
v_lshlrev_b32 v30, 13, v30
v_lshlrev_b32 v34, 5, v33
v_xor_b32 v34, v34, v36
v_add_u32 v6, v34, v30
v_xor_b32_e64 v7, 64, v6
v_xor_b32 v8, 65664, v6
v_xor_b32 v9, 65728, v6
s_add_u32 m0, s57, 0
s_nop 0
buffer_load_dwordx4 v6, s[12:15], s52 offen offset:0 lds
buffer_load_dwordx4 v7, s[12:15], s53 offen offset:1024 lds
buffer_load_dwordx4 v6, s[12:15], s54 offen offset:2048 lds
buffer_load_dwordx4 v7, s[12:15], s55 offen offset:3072 lds
s_add_u32 m0, s57, 4096
s_nop 0
s_nop 0
buffer_load_dwordx4 v8, s[12:15], s52 offen offset:0 lds
buffer_load_dwordx4 v9, s[12:15], s53 offen offset:1024 lds
buffer_load_dwordx4 v8, s[12:15], s54 offen offset:2048 lds
buffer_load_dwordx4 v9, s[12:15], s55 offen offset:3072 lds
v_xor_b32 v6, 524288, v6
v_xor_b32 v7, 524288, v7
v_xor_b32 v8, 524288, v8
v_xor_b32 v9, 524288, v9
s_mov_b32 s48, 0
s_mov_b32 s49, 7168
s_mov_b32 s50, 14336
s_mov_b32 s51, 21504
v_lshrrev_b32 v30, 3, v0
v_lshlrev_b32 v30, 10, v30
s_lshl_b32 s3, s32, 16
s_lshl_b32 s39, s58, 7
s_add_u32 s3, s3, s39
v_and_b32 v31, 7, v0
v_lshrrev_b32 v32, 4, v0
v_xor_b32_e64 v31, v31, v32
v_lshl_add_u32 v30, v31, 4, v30
v_add_u32 v2, s3, v30
v_xor_b32 v3, 64, v2
v_xor_b32 v4, 32768, v2
v_xor_b32 v5, 32832, v2
s_cmp_lt_u32 s32, 2
s_cselect_b32 s60, s8, s12
s_cselect_b32 s61, s9, s13
s_cselect_b32 s62, s10, s14
s_mov_b32 s63, 0x20000
s_mov_b32 s59, 524288
s_cselect_b32 s59, 128, s59
s_cselect_b64 vcc, -1, 0
s_cselect_b32 s38, 32, 16
s_lshr_b32 s3, s2, 6
s_cmp_lt_u32 s32, 2
s_cselect_b32 s3, s3, s33
s_lshl_b32 s3, s3, 1
s_and_b32 s39, s32, 1
s_add_u32 s3, s3, s39
s_lshl_b32 s3, s3, 15
s_xor_b32 s39, s58, 2
s_mul_i32 s39, s39, s59
s_add_u32 s3, s3, s39
v_lshlrev_b32 v37, 10, v0
v_lshrrev_b32 v38, 2, v0
v_lshlrev_b32 v38, 13, v38
v_and_b32 v39, 3, v0
v_lshl_add_u32 v38, v39, 7, v38
v_cndmask_b32 v47, v38, v37, vcc
v_add_u32 v47, s3, v47
v_cmp_gt_u32 vcc, s38, v0
v_mov_b32 v37, 2146435072
s_nop 0
v_cndmask_b32 v47, v37, v47, vcc
s_mov_b32 s20, s66
s_and_b32 s21, s67, 0xffff
s_mov_b32 s22, 8388608
s_mov_b32 s23, 0x20000
s_add_u32 s24, s66, 8388608
s_addc_u32 s25, s67, 0
s_and_b32 s25, s25, 0xffff
s_mov_b32 s26, 35717120
s_mov_b32 s27, 0x20000
v_lshrrev_b32 v32, 4, v0
v_and_b32 v30, 15, v0
s_lshr_b32 s3, s32, 1
s_lshl_b32 s3, s3, 14
s_add_u32 s3, s3, 32768
v_lshlrev_b32 v31, 7, v30
v_add_u32 v31, s3, v31
v_lshrrev_b32 v34, 1, v30
v_xor_b32_e64 v34, v34, v32
v_lshl_add_u32 v10, v34, 4, v31
v_xor_b32 v11, 64, v10
v_lshrrev_b32 v30, 2, v30
v_lshl_add_u32 v31, v32, 3, v30
v_lshlrev_b32 v31, 9, v31
v_and_b32 v34, 3, v0
v_lshl_add_u32 v31, v34, 3, v31
s_and_b32 s3, s32, 1
s_lshl_b32 s3, s3, 8
v_add_u32 v31, s3, v31
v_and_b32 v34, 1, v32
v_lshl_add_u32 v30, v34, 2, v30
v_lshl_add_u32 v16, v30, 5, v31
v_xor_b32 v17, 32, v16
v_xor_b32 v18, 64, v16
v_xor_b32 v19, 96, v16
v_xor_b32 v20, 128, v16
v_xor_b32 v21, 160, v16
v_xor_b32 v22, 192, v16
v_xor_b32 v23, 224, v16
v_add_u32 v12, 65536, v10
v_add_u32 v13, 65536, v11
v_add_u32 v14, 65536, v16
v_add_u32 v15, 65536, v17
v_add_u32 v24, 65536, v18
v_add_u32 v25, 65536, v19
v_add_u32 v26, 65536, v20
v_add_u32 v27, 65536, v21
v_add_u32 v28, 65536, v22
v_add_u32 v29, 65536, v23
s_mov_b32 s28, s44
s_nop 0
s_and_b32 s29, s45, 0xffff
s_mov_b32 s30, 2048
s_mov_b32 s31, 0x20000
buffer_load_dwordx4 v[64:67], v36, s[28:31], 0 offen offset:0
buffer_load_dwordx4 v[68:71], v36, s[28:31], 0 offen offset:512
buffer_load_dwordx4 v[72:75], v36, s[28:31], 0 offen offset:1024
buffer_load_dwordx4 v[76:79], v36, s[28:31], 0 offen offset:1536
s_waitcnt vmcnt(12)
v_lshlrev_b32 v80, 16, v48
v_and_b32 v81, 0xffff0000, v48
v_lshlrev_b32_e64 v82, 16, v49
v_and_b32 v83, 0xffff0000, v49
v_lshlrev_b32_e64 v84, 16, v50
v_and_b32 v85, 0xffff0000, v50
v_lshlrev_b32_e64 v86, 16, v51
v_and_b32 v87, 0xffff0000, v51
v_lshlrev_b32_e64 v88, 16, v52
v_and_b32 v89, 0xffff0000, v52
v_lshlrev_b32_e64 v90, 16, v53
v_and_b32 v91, 0xffff0000, v53
v_lshlrev_b32_e64 v92, 16, v54
v_and_b32 v93, 0xffff0000, v54
v_lshlrev_b32_e64 v94, 16, v55
v_and_b32 v95, 0xffff0000, v55
v_lshlrev_b32_e64 v96, 16, v56
v_and_b32 v97, 0xffff0000, v56
v_lshlrev_b32_e64 v98, 16, v57
v_and_b32 v99, 0xffff0000, v57
v_lshlrev_b32_e64 v100, 16, v58
v_and_b32 v101, 0xffff0000, v58
v_lshlrev_b32_e64 v102, 16, v59
v_and_b32 v103, 0xffff0000, v59
v_lshlrev_b32_e64 v104, 16, v60
v_and_b32 v105, 0xffff0000, v60
v_lshlrev_b32_e64 v106, 16, v61
v_and_b32 v107, 0xffff0000, v61
v_lshlrev_b32_e64 v108, 16, v62
v_and_b32 v109, 0xffff0000, v62
v_lshlrev_b32_e64 v110, 16, v63
v_and_b32 v111, 0xffff0000, v63
v_pk_add_f32 v[40:41], v[80:81], v[82:83]
v_pk_add_f32 v[42:43], v[84:85], v[86:87]
v_pk_add_f32 v[40:41], v[40:41], v[88:89]
v_pk_add_f32 v[42:43], v[42:43], v[90:91]
v_pk_add_f32 v[40:41], v[40:41], v[92:93]
v_pk_add_f32 v[42:43], v[42:43], v[94:95]
v_pk_add_f32 v[40:41], v[40:41], v[96:97]
v_pk_add_f32 v[42:43], v[42:43], v[98:99]
v_pk_add_f32 v[40:41], v[40:41], v[100:101]
v_pk_add_f32 v[42:43], v[42:43], v[102:103]
v_pk_add_f32 v[40:41], v[40:41], v[104:105]
v_pk_add_f32 v[42:43], v[42:43], v[106:107]
v_pk_add_f32 v[40:41], v[40:41], v[108:109]
v_pk_add_f32 v[42:43], v[42:43], v[110:111]
v_pk_add_f32 v[40:41], v[40:41], v[42:43]
Va 38,40,41
s_nop 1
v_add_f32_dpp v38, v38, v38 quad_perm:[1,0,3,2] row_mask:0xf bank_mask:0xf
s_nop 1
v_add_f32_dpp v38, v38, v38 quad_perm:[2,3,0,1] row_mask:0xf bank_mask:0xf
s_nop 1
v_add_f32_dpp v38, v38, v38 row_half_mirror row_mask:0xf bank_mask:0xf
s_nop 1
v_add_f32_dpp v38, v38, v38 row_mirror row_mask:0xf bank_mask:0xf
v_mov_b32 v37, v38
s_nop 1
v_permlane16_swap_b32 v37, v38
Va 38,38,37
s_add_u32 m0, s56, 0
s_nop 0
buffer_load_dwordx4 v2, s[8:11], s48 offen offset:0 lds
buffer_load_dwordx4 v3, s[8:11], s49 offen offset:1024 lds
buffer_load_dwordx4 v2, s[8:11], s50 offen offset:2048 lds
buffer_load_dwordx4 v3, s[8:11], s51 offen offset:3072 lds
s_add_u32 m0, s56, 4096
s_nop 0
buffer_load_dwordx4 v4, s[8:11], s48 offen offset:0 lds
buffer_load_dwordx4 v5, s[8:11], s49 offen offset:1024 lds
buffer_load_dwordx4 v4, s[8:11], s50 offen offset:2048 lds
buffer_load_dwordx4 v5, s[8:11], s51 offen offset:3072 lds
v_xor_b32 v2, 128, v2
v_xor_b32 v3, 128, v3
v_xor_b32 v4, 128, v4
v_xor_b32 v5, 128, v5
v_mul_f32 v38, 0xba800000, v38
v_mov_b32_e64 v39, v38
v_pk_add_f32 v[112:113], v[80:81], v[38:39]
v_pk_mul_f32 v[40:41], v[112:113], v[112:113]
v_pk_add_f32 v[114:115], v[82:83], v[38:39]
v_pk_mul_f32 v[42:43], v[114:115], v[114:115]
v_pk_add_f32 v[116:117], v[84:85], v[38:39]
v_pk_fma_f32 v[40:41], v[116:117], v[116:117], v[40:41]
v_pk_add_f32 v[118:119], v[86:87], v[38:39]
v_pk_fma_f32 v[42:43], v[118:119], v[118:119], v[42:43]
v_pk_add_f32 v[112:113], v[88:89], v[38:39]
v_pk_fma_f32 v[40:41], v[112:113], v[112:113], v[40:41]
v_pk_add_f32 v[114:115], v[90:91], v[38:39]
v_pk_fma_f32 v[42:43], v[114:115], v[114:115], v[42:43]
v_pk_add_f32 v[116:117], v[92:93], v[38:39]
v_pk_fma_f32 v[40:41], v[116:117], v[116:117], v[40:41]
v_pk_add_f32 v[118:119], v[94:95], v[38:39]
v_pk_fma_f32 v[42:43], v[118:119], v[118:119], v[42:43]
v_pk_add_f32 v[112:113], v[96:97], v[38:39]
v_pk_fma_f32 v[40:41], v[112:113], v[112:113], v[40:41]
v_pk_add_f32 v[114:115], v[98:99], v[38:39]
v_pk_fma_f32 v[42:43], v[114:115], v[114:115], v[42:43]
v_pk_add_f32 v[116:117], v[100:101], v[38:39]
v_pk_fma_f32 v[40:41], v[116:117], v[116:117], v[40:41]
v_pk_add_f32 v[118:119], v[102:103], v[38:39]
v_pk_fma_f32 v[42:43], v[118:119], v[118:119], v[42:43]
v_pk_add_f32 v[112:113], v[104:105], v[38:39]
v_pk_fma_f32 v[40:41], v[112:113], v[112:113], v[40:41]
v_pk_add_f32 v[114:115], v[106:107], v[38:39]
v_pk_fma_f32 v[42:43], v[114:115], v[114:115], v[42:43]
v_pk_add_f32 v[116:117], v[108:109], v[38:39]
v_pk_fma_f32 v[40:41], v[116:117], v[116:117], v[40:41]
v_pk_add_f32 v[118:119], v[110:111], v[38:39]
v_pk_fma_f32 v[42:43], v[118:119], v[118:119], v[42:43]
v_pk_add_f32 v[40:41], v[40:41], v[42:43]
Va 40,40,41
s_nop 1
v_add_f32_dpp v40, v40, v40 quad_perm:[1,0,3,2] row_mask:0xf bank_mask:0xf
s_nop 1
v_add_f32_dpp v40, v40, v40 quad_perm:[2,3,0,1] row_mask:0xf bank_mask:0xf
s_nop 1
v_add_f32_dpp v40, v40, v40 row_half_mirror row_mask:0xf bank_mask:0xf
s_nop 1
v_add_f32_dpp v40, v40, v40 row_mirror row_mask:0xf bank_mask:0xf
v_mov_b32 v37, v40
s_nop 1
v_permlane16_swap_b32 v37, v40
v_add_f32_e64 v40, v40, v37
v_mul_f32 v40, 0x3a800000, v40
Vc 44,38,40
v_lshlrev_b32_e64 v38, 16, v44
v_and_b32 v40, 0xffff0000, v44
v_add_f32 v40, 0x3727c5ac, v40
Vc 44,40,40
v_lshlrev_b32 v40, 16, v44
v_sqrt_f32 v40, v40
v_mov_b32_e64 v39, v38
Vc 44,40,40
v_lshlrev_b32 v44, 16, v44
v_rcp_f32 v40, v44
v_pk_add_f32 v[80:81], v[80:81], v[38:39]
v_pk_add_f32 v[82:83], v[82:83], v[38:39]
v_pk_add_f32 v[84:85], v[84:85], v[38:39]
v_pk_add_f32 v[86:87], v[86:87], v[38:39]
v_pk_add_f32 v[88:89], v[88:89], v[38:39]
v_pk_add_f32 v[90:91], v[90:91], v[38:39]
v_pk_add_f32 v[92:93], v[92:93], v[38:39]
v_pk_add_f32 v[94:95], v[94:95], v[38:39]
v_pk_add_f32 v[96:97], v[96:97], v[38:39]
v_pk_add_f32 v[98:99], v[98:99], v[38:39]
v_pk_add_f32 v[100:101], v[100:101], v[38:39]
v_pk_add_f32 v[102:103], v[102:103], v[38:39]
v_pk_add_f32 v[104:105], v[104:105], v[38:39]
v_pk_add_f32 v[106:107], v[106:107], v[38:39]
v_pk_add_f32 v[108:109], v[108:109], v[38:39]
v_pk_add_f32 v[110:111], v[110:111], v[38:39]
v_fma_f32 v45, -v44, v40, 1.0
v_fma_f32 v40, v45, v40, v40
v_mov_b32_e64 v41, v40
Vc 48,80,81
Vc 49,82,83
Vc 50,84,85
Vc 51,86,87
Vc 52,88,89
Vc 53,90,91
Vc 54,92,93
Vc 55,94,95
Vc 56,96,97
Vc 57,98,99
Vc 58,100,101
Vc 59,102,103
Vc 60,104,105
Vc 61,106,107
Vc 62,108,109
Vc 63,110,111
v_lshlrev_b32_e64 v80, 16, v48
v_and_b32 v81, 0xffff0000, v48
v_lshlrev_b32_e64 v82, 16, v49
v_and_b32 v83, 0xffff0000, v49
v_lshlrev_b32_e64 v84, 16, v50
v_and_b32 v85, 0xffff0000, v50
v_lshlrev_b32_e64 v86, 16, v51
v_and_b32 v87, 0xffff0000, v51
v_lshlrev_b32_e64 v88, 16, v52
v_and_b32 v89, 0xffff0000, v52
v_lshlrev_b32_e64 v90, 16, v53
v_and_b32 v91, 0xffff0000, v53
v_lshlrev_b32_e64 v92, 16, v54
v_and_b32 v93, 0xffff0000, v54
v_lshlrev_b32_e64 v94, 16, v55
v_and_b32 v95, 0xffff0000, v55
v_lshlrev_b32_e64 v96, 16, v56
v_and_b32 v97, 0xffff0000, v56
v_lshlrev_b32_e64 v98, 16, v57
v_and_b32 v99, 0xffff0000, v57
v_lshlrev_b32_e64 v100, 16, v58
v_and_b32 v101, 0xffff0000, v58
v_lshlrev_b32_e64 v102, 16, v59
v_and_b32 v103, 0xffff0000, v59
v_lshlrev_b32_e64 v104, 16, v60
v_and_b32 v105, 0xffff0000, v60
v_lshlrev_b32_e64 v106, 16, v61
v_and_b32 v107, 0xffff0000, v61
v_lshlrev_b32_e64 v108, 16, v62
v_and_b32 v109, 0xffff0000, v62
v_lshlrev_b32_e64 v110, 16, v63
v_and_b32 v111, 0xffff0000, v63
v_pk_mul_f32 v[80:81], v[80:81], v[40:41]
v_pk_mul_f32 v[82:83], v[82:83], v[40:41]
v_pk_mul_f32 v[84:85], v[84:85], v[40:41]
v_pk_mul_f32 v[86:87], v[86:87], v[40:41]
v_pk_mul_f32 v[88:89], v[88:89], v[40:41]
v_pk_mul_f32 v[90:91], v[90:91], v[40:41]
v_pk_mul_f32 v[92:93], v[92:93], v[40:41]
v_pk_mul_f32 v[94:95], v[94:95], v[40:41]
v_pk_mul_f32 v[96:97], v[96:97], v[40:41]
v_pk_mul_f32 v[98:99], v[98:99], v[40:41]
v_pk_mul_f32 v[100:101], v[100:101], v[40:41]
v_pk_mul_f32 v[102:103], v[102:103], v[40:41]
v_pk_mul_f32 v[104:105], v[104:105], v[40:41]
v_pk_mul_f32 v[106:107], v[106:107], v[40:41]
v_pk_mul_f32 v[108:109], v[108:109], v[40:41]
v_pk_mul_f32 v[110:111], v[110:111], v[40:41]
Vc 48,80,81
Vc 49,82,83
Vc 50,84,85
Vc 51,86,87
Vc 52,88,89
Vc 53,90,91
Vc 54,92,93
Vc 55,94,95
Vc 56,96,97
Vc 57,98,99
Vc 58,100,101
Vc 59,102,103
Vc 60,104,105
Vc 61,106,107
Vc 62,108,109
Vc 63,110,111
s_mul_i32 s3, s32, 4128
s_add_u32 s3, s3, 131072
v_mul_u32_u24 v42, 2064, v33
v_add3_u32 v42, v42, v36, s3
ds_write_b128 v42, v[48:51] offset:0
ds_write_b128 v42, v[52:55] offset:512
ds_write_b128 v42, v[56:59] offset:1024
ds_write_b128 v42, v[60:63] offset:1536
s_waitcnt vmcnt(8)
v_lshlrev_b32 v80, 16, v48
v_and_b32 v81, 0xffff0000, v48
v_lshlrev_b32_e64 v112, 16, v64
v_and_b32 v113, 0xffff0000, v64
v_pk_mul_f32 v[42:43], v[80:81], v[112:113]
v_lshlrev_b32_e64 v82, 16, v49
v_and_b32 v83, 0xffff0000, v49
v_lshlrev_b32_e64 v114, 16, v65
v_and_b32 v115, 0xffff0000, v65
v_pk_mul_f32 v[44:45], v[82:83], v[114:115]
v_lshlrev_b32_e64 v84, 16, v50
v_and_b32 v85, 0xffff0000, v50
v_lshlrev_b32_e64 v116, 16, v66
v_and_b32 v117, 0xffff0000, v66
v_pk_fma_f32 v[42:43], v[84:85], v[116:117], v[42:43]
v_lshlrev_b32_e64 v86, 16, v51
v_and_b32 v87, 0xffff0000, v51
v_lshlrev_b32_e64 v118, 16, v67
v_and_b32 v119, 0xffff0000, v67
v_pk_fma_f32 v[44:45], v[86:87], v[118:119], v[44:45]
v_lshlrev_b32_e64 v88, 16, v52
v_and_b32 v89, 0xffff0000, v52
v_lshlrev_b32_e64 v112, 16, v68
v_and_b32 v113, 0xffff0000, v68
v_pk_fma_f32 v[42:43], v[88:89], v[112:113], v[42:43]
v_lshlrev_b32_e64 v90, 16, v53
v_and_b32 v91, 0xffff0000, v53
v_lshlrev_b32_e64 v114, 16, v69
v_and_b32 v115, 0xffff0000, v69
v_pk_fma_f32 v[44:45], v[90:91], v[114:115], v[44:45]
v_lshlrev_b32_e64 v92, 16, v54
v_and_b32 v93, 0xffff0000, v54
v_lshlrev_b32_e64 v116, 16, v70
v_and_b32 v117, 0xffff0000, v70
v_pk_fma_f32 v[42:43], v[92:93], v[116:117], v[42:43]
v_lshlrev_b32_e64 v94, 16, v55
v_and_b32 v95, 0xffff0000, v55
v_lshlrev_b32_e64 v118, 16, v71
v_and_b32 v119, 0xffff0000, v71
v_pk_fma_f32 v[44:45], v[94:95], v[118:119], v[44:45]
v_lshlrev_b32_e64 v96, 16, v56
v_and_b32 v97, 0xffff0000, v56
v_lshlrev_b32_e64 v112, 16, v72
v_and_b32 v113, 0xffff0000, v72
v_pk_fma_f32 v[42:43], v[96:97], v[112:113], v[42:43]
v_lshlrev_b32_e64 v98, 16, v57
v_and_b32 v99, 0xffff0000, v57
v_lshlrev_b32_e64 v114, 16, v73
v_and_b32 v115, 0xffff0000, v73
v_pk_fma_f32 v[44:45], v[98:99], v[114:115], v[44:45]
v_lshlrev_b32_e64 v100, 16, v58
v_and_b32 v101, 0xffff0000, v58
v_lshlrev_b32_e64 v116, 16, v74
v_and_b32 v117, 0xffff0000, v74
v_pk_fma_f32 v[42:43], v[100:101], v[116:117], v[42:43]
v_lshlrev_b32_e64 v102, 16, v59
v_and_b32 v103, 0xffff0000, v59
v_lshlrev_b32_e64 v118, 16, v75
v_and_b32 v119, 0xffff0000, v75
v_pk_fma_f32 v[44:45], v[102:103], v[118:119], v[44:45]
v_lshlrev_b32_e64 v104, 16, v60
v_and_b32 v105, 0xffff0000, v60
v_lshlrev_b32_e64 v112, 16, v76
v_and_b32 v113, 0xffff0000, v76
v_pk_fma_f32 v[42:43], v[104:105], v[112:113], v[42:43]
v_lshlrev_b32_e64 v106, 16, v61
v_and_b32 v107, 0xffff0000, v61
v_lshlrev_b32_e64 v114, 16, v77
v_and_b32 v115, 0xffff0000, v77
v_pk_fma_f32 v[44:45], v[106:107], v[114:115], v[44:45]
v_lshlrev_b32_e64 v108, 16, v62
v_and_b32 v109, 0xffff0000, v62
v_lshlrev_b32_e64 v116, 16, v78
v_and_b32 v117, 0xffff0000, v78
v_pk_fma_f32 v[42:43], v[108:109], v[116:117], v[42:43]
v_lshlrev_b32_e64 v110, 16, v63
v_and_b32 v111, 0xffff0000, v63
v_lshlrev_b32_e64 v118, 16, v79
v_and_b32 v119, 0xffff0000, v79
v_pk_fma_f32 v[44:45], v[110:111], v[118:119], v[44:45]
v_pk_add_f32 v[42:43], v[42:43], v[44:45]
Va 45,42,43
s_nop 1
v_add_f32_dpp v45, v45, v45 quad_perm:[1,0,3,2] row_mask:0xf bank_mask:0xf
s_nop 1
v_add_f32_dpp v45, v45, v45 quad_perm:[2,3,0,1] row_mask:0xf bank_mask:0xf
s_nop 1
v_add_f32_dpp v45, v45, v45 row_half_mirror row_mask:0xf bank_mask:0xf
s_nop 1
v_add_f32_dpp v45, v45, v45 row_mirror row_mask:0xf bank_mask:0xf
v_mov_b32 v37, v45
s_nop 1
v_permlane16_swap_b32 v37, v45
v_add_f32_e64 v45, v45, v37
Vc 45,45,45
v_ashrrev_i32_e64 v46, 31, v45
v_or_b32 v46, 0x80000000, v46
v_xor_b32_e64 v45, v45, v46
v_and_b32 v45, 0xffff0000, v45
s_lshr_b32 s3, s36, 11
v_add_u32 v46, s3, v33
v_sub_u32 v44, 0xffff, v46
v_or_b32 v45, v45, v44
v_lshlrev_b32 v44, 2, v46
v_lshlrev_b32_e64 v46, 3, v46
v_xor_b32 v38, 0x80000000, v38
v_mov_b32_e64 v39, v40
s_mov_b32 s3, 5242880
s_mov_b32 s39, 5259264
s_mov_b32 exec_lo, 1
s_mov_b32 exec_hi, 1
buffer_store_dword v45, v44, s[20:23], s3 offen sc1
buffer_store_dwordx2 v[38:39], v46, s[20:23], s39 offen sc1
s_mov_b64 exec, -1
s_load_dwordx2 s[4:5], s[0:1], 16
s_load_dwordx4 s[40:43], s[0:1], 64
s_load_dwordx2 s[92:93], s[0:1], 40
s_load_dwordx2 s[94:95], s[0:1], 80
s_load_dwordx2 s[100:101], s[0:1], 0
s_mov_b32 s28, s64
s_and_b32 s29, s65, 0xffff
s_mov_b32 s30, 256
s_mov_b32 s31, 0x20000
s_waitcnt vmcnt(2)
s_waitcnt lgkmcnt(0)
s_barrier
s_nop 0
Ra 224,10,0
Ra 228,11,0
Ra 232,10,2048
Ra 236,11,2048
Ta 0,16,0
Ta 2,16,2048
Ta 4,16,16384
Ta 6,16,18432
Ta 8,17,0
Ta 10,17,2048
Ta 12,17,16384
Ta 14,17,18432
Ta 16,18,0
Ta 18,18,2048
Ta 20,18,16384
s_waitcnt lgkmcnt(9)
s_nop 0
Ta 22,18,18432
Ta 24,19,0
Ta 26,19,2048
Ta 28,19,16384
Ta 30,19,18432
Ta 32,20,0
s_waitcnt lgkmcnt(9)
s_nop 0
Ta 34,20,2048
Ta 36,20,16384
Ta 38,20,18432
Ta 40,21,0
Ta 42,21,2048
Ta 44,21,16384
s_waitcnt lgkmcnt(9)
s_nop 0
Ta 46,21,18432
Ta 48,22,0
Ta 50,22,2048
Ta 52,22,16384
Ta 54,22,18432
Ta 56,23,0
s_waitcnt lgkmcnt(9)
Ta 58,23,2048
Ta 60,23,16384
Ta 62,23,18432
s_cmp_lg_u32 s35, 0
s_cbranch_scc1 L_k1_vpath
Zvaa 48,0,224
v_and_b32 v46, 7, v0
v_mul_u32_u24 v30, 2064, v46
Mvaa 48,4,228
s_add_u32 m0, s57, 65536
Zvaa 52,8,224
buffer_load_dwordx4 v6, s[12:15], s52 offen offset:0 lds
Mvaa 52,12,228
Ra 240,10,4096
Zvaa 56,16,224
buffer_load_dwordx4 v7, s[12:15], s53 offen offset:1024 lds
Mvaa 56,20,228
v_lshrrev_b32_e64 v31, 3, v0
Zvaa 60,24,224
buffer_load_dwordx4 v6, s[12:15], s54 offen offset:2048 lds
Mvaa 60,28,228
Ra 244,11,4096
Zvaa 64,32,224
buffer_load_dwordx4 v7, s[12:15], s55 offen offset:3072 lds
Mvaa 64,36,228
s_add_u32 m0, s57, 69632
s_waitcnt lgkmcnt(10)
Zvaa 68,40,224
buffer_load_dwordx4 v8, s[12:15], s52 offen offset:0 lds
Mvaa 68,44,228
Ra 248,10,6144
s_waitcnt lgkmcnt(7)
Zvaa 72,48,224
buffer_load_dwordx4 v9, s[12:15], s53 offen offset:1024 lds
Mvaa 72,52,228
s_lshl_b32 s3, s32, 9
s_add_u32 s3, s3, 131072
v_lshl_add_u32 v30, v31, 4, v30
s_waitcnt lgkmcnt(3)
Zvaa 76,56,224
buffer_load_dwordx4 v8, s[12:15], s54 offen offset:2048 lds
Mvaa 76,60,228
Ra 252,11,6144
Zvaa 80,0,232
buffer_load_dwordx4 v9, s[12:15], s55 offen offset:3072 lds
Mvaa 80,4,236
s_add_u32 m0, s56, 65536
v_xor_b32 v6, 1572864, v6
v_xor_b32 v7, 1572864, v7
Zvaa 84,8,232
buffer_load_dwordx4 v2, s[8:11], s48 offen offset:0 lds
Mvaa 84,12,236
v_xor_b32 v8, 1572864, v8
v_xor_b32 v9, 1572864, v9
Zvaa 88,16,232
buffer_load_dwordx4 v3, s[8:11], s49 offen offset:1024 lds
Mvaa 88,20,236
v_add_u32 v30, s3, v30
v_lshlrev_b32 v31, 8, v31
Zvaa 92,24,232
buffer_load_dwordx4 v2, s[8:11], s50 offen offset:2048 lds
Mvaa 92,28,236
v_lshl_add_u32 v46, v46, 4, v31
Zvaa 96,32,232
buffer_load_dwordx4 v3, s[8:11], s51 offen offset:3072 lds
Mvaa 96,36,236
s_add_u32 m0, s56, 69632
Zvaa 100,40,232
buffer_load_dwordx4 v4, s[8:11], s48 offen offset:0 lds
Mvaa 100,44,236
Rv 34,30,128
Rv 38,30,256
Zvaa 104,48,232
buffer_load_dwordx4 v5, s[8:11], s49 offen offset:1024 lds
Mvaa 104,52,236
Rv 42,30,384
Rv 30,30,0
Zvaa 108,56,232
s_waitcnt lgkmcnt(4)
buffer_load_dwordx4 v4, s[8:11], s50 offen offset:2048 lds
Mvaa 108,60,236
s_lshr_b32 s3, s2, 1
s_mul_i32 s3, s3, 33792
s_add_u32 s3, s3, s57
Zvaa 112,0,240
buffer_load_dwordx4 v5, s[8:11], s51 offen offset:3072 lds
Mvaa 112,4,244
v_xor_b32 v2, 384, v2
v_xor_b32 v3, 384, v3
Zvaa 116,8,240
s_and_b32 s39, s2, 1
s_lshl_b32 s39, s39, 7
s_add_u32 s3, s3, s39
Mvaa 116,12,244
Ra 224,10,8192
v_xor_b32 v4, 384, v4
Zvaa 120,16,240
s_add_u32 s39, s3, 4096
Mvaa 120,20,244
v_xor_b32 v5, 384, v5
Zvaa 124,24,240
Mvaa 124,28,244
Ra 228,11,8192
Zvaa 128,32,240
Mvaa 128,36,244
Zvaa 132,40,240
Mvaa 132,44,244
Ra 232,10,10240
Zvaa 136,48,240
buffer_load_dword v1, v47, s[60:63], 0 offen
Mvaa 136,52,244
s_mul_i32 vcc_lo, s59, 1
v_xor_b32 v47, vcc_lo, v47
Zvaa 140,56,240
Mvaa 140,60,244
Ra 236,11,10240
Zvaa 144,0,248
Mvaa 144,4,252
Zvaa 148,8,248
Mvaa 148,12,252
Zvaa 152,16,248
Mvaa 152,20,252
Zvaa 156,24,248
Mvaa 156,28,252
Zvaa 160,32,248
Mvaa 160,36,252
Zvaa 164,40,248
Mvaa 164,44,252
Zvaa 168,48,248
Mvaa 168,52,252
s_waitcnt vmcnt(9)
Zvaa 172,56,248
s_waitcnt lgkmcnt(0)
s_barrier
Mvaa 172,60,252
s_add_u32 m0, s57, 0
Zvaa 176,0,224
buffer_load_dwordx4 v6, s[12:15], s52 offen offset:0 lds
Mvaa 176,4,228
Ta 64,14,0
Ta 66,14,2048
Zvaa 180,8,224
Mvaa 180,12,228
Ra 240,10,12288
Zvaa 184,16,224
buffer_load_dwordx4 v7, s[12:15], s53 offen offset:1024 lds
Mvaa 184,20,228
Ta 68,14,16384
Ta 70,14,18432
Zvaa 188,24,224
Mvaa 188,28,228
Ra 244,11,12288
Zvaa 192,32,224
buffer_load_dwordx4 v6, s[12:15], s54 offen offset:2048 lds
Mvaa 192,36,228
Ta 72,15,0
Ta 74,15,2048
Zvaa 196,40,224
Mvaa 196,44,228
Ra 248,10,14336
Zvaa 200,48,224
buffer_load_dwordx4 v7, s[12:15], s55 offen offset:3072 lds
Mvaa 200,52,228
Ta 76,15,16384
Ta 78,15,18432
Zvaa 204,56,224
Mvaa 204,60,228
s_add_u32 m0, s57, 4096
Ra 252,11,14336
Zvaa 208,0,232
buffer_load_dwordx4 v8, s[12:15], s52 offen offset:0 lds
Mvaa 208,4,236
Zvaa 212,8,232
Mvaa 212,12,236
Ta 80,24,0
Ta 82,24,2048
Zvaa 216,16,232
buffer_load_dwordx4 v9, s[12:15], s53 offen offset:1024 lds
Mvaa 216,20,236
Ta 84,24,16384
s_waitcnt lgkmcnt(9)
Ta 86,24,18432
Zvaa 220,24,232
Mvaa 220,28,236
Ta 88,25,0
Ta 90,25,2048
Zvaa 224,32,232
buffer_load_dwordx4 v8, s[12:15], s54 offen offset:2048 lds
Mvaa 224,36,236
Zvaa 228,40,232
Mvaa 228,44,236
Ta 92,25,16384
Ta 94,25,18432
Zvaa 232,48,232
buffer_load_dwordx4 v9, s[12:15], s55 offen offset:3072 lds
Mvaa 232,52,236
s_waitcnt vmcnt(9)
Ta 96,26,0
s_waitcnt lgkmcnt(9)
Ta 98,26,2048
Zvaa 236,56,232
s_barrier
v_xor_b32 v6, 524288, v6
v_xor_b32 v7, 524288, v7
Mvaa 236,60,236
s_add_u32 m0, s56, 0
Ta 100,26,16384
Ta 102,26,18432
Zvaa 240,0,240
buffer_load_dwordx4 v2, s[8:11], s48 offen offset:0 lds
Mvaa 240,4,244
v_xor_b32 v8, 524288, v8
v_xor_b32 v9, 524288, v9
Zvaa 244,8,240
Mvaa 244,12,244
Ra 224,12,0
Zvaa 248,16,240
buffer_load_dwordx4 v3, s[8:11], s49 offen offset:1024 lds
Mvaa 248,20,244
Ta 104,27,0
Ta 106,27,2048
Zvaa 252,24,240
Mvaa 252,28,244
s_waitcnt lgkmcnt(9)
Ra 228,13,0
Zaaa 128,32,240
buffer_load_dwordx4 v2, s[8:11], s50 offen offset:2048 lds
Maaa 128,36,244
Ta 108,27,16384
Ta 110,27,18432
Zaaa 132,40,240
Maaa 132,44,244
Ra 232,12,2048
Zaaa 136,48,240
buffer_load_dwordx4 v3, s[8:11], s51 offen offset:3072 lds
Maaa 136,52,244
Ta 112,28,0
Ta 114,28,2048
Zaaa 140,56,240
Maaa 140,60,244
s_add_u32 m0, s56, 4096
s_waitcnt lgkmcnt(9)
Ra 236,13,2048
Zaaa 144,0,248
buffer_load_dwordx4 v4, s[8:11], s48 offen offset:0 lds
Maaa 144,4,252
Zaaa 148,8,248
Maaa 148,12,252
Ta 116,28,16384
Ta 118,28,18432
Zaaa 152,16,248
buffer_load_dwordx4 v5, s[8:11], s49 offen offset:1024 lds
Maaa 152,20,252
Ta 120,29,0
Ta 122,29,2048
Zaaa 156,24,248
Maaa 156,28,252
Ta 124,29,16384
s_waitcnt lgkmcnt(9)
Ta 126,29,18432
Zaaa 160,32,248
buffer_load_dwordx4 v4, s[8:11], s50 offen offset:2048 lds
Maaa 160,36,252
Zaaa 164,40,248
Maaa 164,44,252
Zaaa 168,48,248
buffer_load_dwordx4 v5, s[8:11], s51 offen offset:3072 lds
Maaa 168,52,252
v_xor_b32 v2, 128, v2
v_xor_b32 v3, 128, v3
Zaaa 172,56,248
s_waitcnt lgkmcnt(6)
buffer_load_dword v1, v47, s[60:63], 0 offen
v_xor_b32 v4, 128, v4
v_xor_b32 v5, 128, v5
Maaa 172,60,252
s_waitcnt lgkmcnt(0)
s_mul_i32 vcc_lo, s59, 7
v_xor_b32 v47, vcc_lo, v47
Mvaa 48,64,224
buffer_store_dwordx4 v[30:33], v46, s[20:23], s3 offen offset:0 sc1
Mvaa 48,68,228
buffer_store_dwordx4 v[34:37], v46, s[20:23], s3 offen offset:2048 sc1
Mvaa 52,72,224
buffer_store_dwordx4 v[38:41], v46, s[20:23], s39 offen offset:0 sc1
Mvaa 52,76,228
Ra 240,12,4096
Mvaa 56,80,224
buffer_store_dwordx4 v[42:45], v46, s[20:23], s39 offen offset:2048 sc1
Mvaa 56,84,228
s_lshl_b32 s3, s34, 1
s_and_b32 s36, s32, 1
s_add_u32 s3, s3, s36
Mvaa 60,88,224
s_mul_i32 s3, s3, 1116160
s_mul_i32 s36, s33, 139264
s_add_u32 s3, s3, s36
Mvaa 60,92,228
Ra 244,13,4096
Mvaa 64,96,224
s_lshr_b32 s36, s32, 1
s_mul_i32 s36, s36, 69632
s_add_u32 s3, s3, s36
Mvaa 64,100,228
s_add_u32 s38, s3, 0
s_lshl_b32 s39, s34, 7
s_lshl_b32 s36, s33, 2
Mvaa 68,104,224
s_add_u32 s39, s39, s36
s_add_u32 s39, s39, 5296128
v_mov_b32_e64 v30, 1
Mvaa 68,108,228
Ra 248,12,6144
Mvaa 72,112,224
v_mov_b32_e64 v31, 0
Mvaa 72,116,228
s_cmp_eq_u32 s32, 0
s_cselect_b32 s39, s39, 2146435072
Mvaa 76,120,224
s_mov_b64 exec, 1
buffer_store_dword v31, v31, s[20:23], s39 offen sc1
s_mov_b64 exec, -1
Mvaa 76,124,228
Ra 252,13,6144
Mvaa 80,64,232
s_and_b32 s33, s2, 7
s_lshl_b32 s33, s33, 2
s_bfe_u32 s3, s2, 0x20003
Mvaa 80,68,236
s_add_u32 s33, s33, s3
s_lshr_b32 s34, s2, 5
s_lshl_b32 s64, s34, 7
Mvaa 84,72,232
s_lshl_b32 s3, s33, 2
s_add_u32 s64, s64, s3
s_add_u32 s64, s64, 5300224
Mvaa 84,76,236
s_lshl_b32 s65, s34, 8
s_sub_u32 s65, 1920, s65
v_mul_u32_u24 v32, s65, v0
Mvaa 88,80,232
s_cmp_eq_u32 s32, 0
s_cselect_b32 s64, s64, 2146435072
Mvaa 88,84,236
s_mov_b64 exec, 3
buffer_store_dword v31, v32, s[20:23], s64 offen sc1
s_mov_b64 exec, -1
Mvaa 92,88,232
s_lshl_b32 s3, s2, 2
s_add_u32 s3, s3, 5447680
v_lshlrev_b32_e64 v32, 10, v0
Mvaa 92,92,236
s_cmp_eq_u32 s32, 0
s_cselect_b32 s3, s3, 2146435072
Mvaa 96,96,232
s_mov_b64 exec, 0x1ff
buffer_store_dword v31, v32, s[20:23], s3 offen sc1
s_mov_b64 exec, -1
Mvaa 96,100,236
s_lshl_b32 s35, s34, 1
s_sub_u32 s36, 32, s35
s_add_u32 s35, s35, 2
Mvaa 100,104,232
s_lshl_b32 s44, s32, 12
s_lshl_b32 s58, s32, 1
s_sub_u32 s58, 7, s58
Mvaa 100,108,236
s_mul_i32 s58, s58, 33792
s_sub_u32 s3, 15, s34
s_lshl_b32 s45, s3, 3
Mvaa 104,112,232
s_add_u32 s45, s45, s32
s_lshl_b32 s46, s34, 3
s_add_u32 s46, s46, s32
Mvaa 104,116,236
s_mov_b32 s68, s42
s_and_b32 s69, s43, 0xffff
s_mov_b32 s70, 7340032
Mvaa 108,120,232
s_waitcnt lgkmcnt(0)
Mvaa 108,124,236
s_mov_b32 s71, 0x20000
s_cmp_eq_u32 s32, 0
s_cselect_b32 s37, 0, 2146435072
Mvaa 112,64,240
s_lshl_b32 s3, s33, 8
s_add_u32 s16, s4, s3
s_addc_u32 s17, s5, 0
s_and_b32 s17, s17, 0xffff
Mvaa 112,68,244
s_mov_b32 s18, 0
s_mov_b32 s19, 0x20000
s_sub_u32 s18, 8388608, s3
Mvaa 116,72,240
v_and_b32 v33, 15, v0
v_lshrrev_b32 v32, 1, v33
Mvaa 116,76,244
Ra 224,12,8192
Mvaa 120,80,240
v_and_b32 v33, 1, v0
v_lshlrev_b32 v32, 13, v32
Mvaa 120,84,244
v_lshl_add_u32 v45, v33, 7, v32
Mvaa 124,88,240
s_lshl_b32 s3, s32, 3
s_add_u32 s3, s3, s34
s_mul_i32 s47, s3, 65536
Mvaa 124,92,244
Ra 228,13,8192
Mvaa 128,96,240
s_bfe_u32 s6, s2, 131075
s_lshl_b32 s3, s32, 8
s_or_b32 s6, s6, s3
Mvaa 128,100,244
Mvaa 132,104,240
Mvaa 132,108,244
Ra 232,12,10240
Mvaa 136,112,240
Mvaa 136,116,244
Mvaa 140,120,240
Mvaa 140,124,244
Ra 236,13,10240
Mvaa 144,64,248
Mvaa 144,68,252
Mvaa 148,72,248
Mvaa 148,76,252
Mvaa 152,80,248
Mvaa 152,84,252
Mvaa 156,88,248
Mvaa 156,92,252
Mvaa 160,96,248
Mvaa 160,100,252
Mvaa 164,104,248
Mvaa 164,108,252
Mvaa 168,112,248
Mvaa 168,116,252
s_waitcnt vmcnt(16)
Mvaa 172,120,248
s_waitcnt lgkmcnt(0)
s_barrier
Mvaa 172,124,252
s_add_u32 m0, s57, 65536
Mvaa 176,64,224
buffer_load_dwordx4 v6, s[12:15], s52 offen offset:0 lds
Mvaa 176,68,228
Ta 0,16,0
Ta 2,16,2048
Mvaa 180,72,224
Mvaa 180,76,228
Ra 240,12,12288
Mvaa 184,80,224
buffer_load_dwordx4 v7, s[12:15], s53 offen offset:1024 lds
Mvaa 184,84,228
Ta 4,16,16384
Ta 6,16,18432
Mvaa 188,88,224
Mvaa 188,92,228
Ra 244,13,12288
Mvaa 192,96,224
buffer_load_dwordx4 v6, s[12:15], s54 offen offset:2048 lds
Mvaa 192,100,228
Ta 8,17,0
Ta 10,17,2048
Mvaa 196,104,224
Mvaa 196,108,228
Ra 248,12,14336
Mvaa 200,112,224
buffer_load_dwordx4 v7, s[12:15], s55 offen offset:3072 lds
Mvaa 200,116,228
Ta 12,17,16384
Ta 14,17,18432
Mvaa 204,120,224
Mvaa 204,124,228
s_add_u32 m0, s57, 69632
Ra 252,13,14336
Mvaa 208,64,232
buffer_load_dwordx4 v8, s[12:15], s52 offen offset:0 lds
Mvaa 208,68,236
Mvaa 212,72,232
Mvaa 212,76,236
Ta 16,18,0
Ta 18,18,2048
Mvaa 216,80,232
buffer_load_dwordx4 v9, s[12:15], s53 offen offset:1024 lds
Mvaa 216,84,236
Ta 20,18,16384
s_waitcnt lgkmcnt(9)
Ta 22,18,18432
Mvaa 220,88,232
Mvaa 220,92,236
Ta 24,19,0
Ta 26,19,2048
Mvaa 224,96,232
buffer_load_dwordx4 v8, s[12:15], s54 offen offset:2048 lds
Mvaa 224,100,236
Mvaa 228,104,232
Mvaa 228,108,236
Ta 28,19,16384
Ta 30,19,18432
Mvaa 232,112,232
buffer_load_dwordx4 v9, s[12:15], s55 offen offset:3072 lds
Mvaa 232,116,236
s_waitcnt vmcnt(16)
Ta 32,20,0
s_waitcnt lgkmcnt(9)
Ta 34,20,2048
Mvaa 236,120,232
s_barrier
v_xor_b32 v6, 3670016, v6
v_xor_b32 v7, 3670016, v7
Mvaa 236,124,236
s_add_u32 m0, s56, 65536
Ta 36,20,16384
Ta 38,20,18432
Mvaa 240,64,240
buffer_load_dwordx4 v2, s[8:11], s48 offen offset:0 lds
Mvaa 240,68,244
v_xor_b32 v8, 3670016, v8
v_xor_b32 v9, 3670016, v9
Mvaa 244,72,240
Mvaa 244,76,244
Ra 224,10,0
Mvaa 248,80,240
buffer_load_dwordx4 v3, s[8:11], s49 offen offset:1024 lds
Mvaa 248,84,244
Ta 40,21,0
Ta 42,21,2048
Mvaa 252,88,240
Mvaa 252,92,244
s_waitcnt lgkmcnt(9)
Ra 228,11,0
Maaa 128,96,240
buffer_load_dwordx4 v2, s[8:11], s50 offen offset:2048 lds
Maaa 128,100,244
Ta 44,21,16384
Ta 46,21,18432
Maaa 132,104,240
Maaa 132,108,244
Ra 232,10,2048
Maaa 136,112,240
buffer_load_dwordx4 v3, s[8:11], s51 offen offset:3072 lds
Maaa 136,116,244
Ta 48,22,0
Ta 50,22,2048
Maaa 140,120,240
Maaa 140,124,244
s_add_u32 m0, s56, 69632
s_waitcnt lgkmcnt(9)
Ra 236,11,2048
Maaa 144,64,248
buffer_load_dwordx4 v4, s[8:11], s48 offen offset:0 lds
Maaa 144,68,252
Maaa 148,72,248
Maaa 148,76,252
Ta 52,22,16384
Ta 54,22,18432
Maaa 152,80,248
buffer_load_dwordx4 v5, s[8:11], s49 offen offset:1024 lds
Maaa 152,84,252
Ta 56,23,0
Ta 58,23,2048
Maaa 156,88,248
Maaa 156,92,252
Ta 60,23,16384
s_waitcnt lgkmcnt(9)
Ta 62,23,18432
Maaa 160,96,248
buffer_load_dwordx4 v4, s[8:11], s50 offen offset:2048 lds
Maaa 160,100,252
Maaa 164,104,248
Maaa 164,108,252
Maaa 168,112,248
buffer_load_dwordx4 v5, s[8:11], s51 offen offset:3072 lds
Maaa 168,116,252
v_xor_b32 v2, 896, v2
v_xor_b32 v3, 896, v3
Maaa 172,120,248
s_waitcnt lgkmcnt(6)
buffer_load_dword v1, v47, s[60:63], 0 offen
v_xor_b32 v4, 896, v4
v_xor_b32 v5, 896, v5
Maaa 172,124,252
s_waitcnt lgkmcnt(0)
s_mul_i32 vcc_lo, s59, 1
v_xor_b32 v47, vcc_lo, v47
Mvaa 48,0,224
Mvaa 48,4,228
Mvaa 52,8,224
Mvaa 52,12,228
Ra 240,10,4096
Mvaa 56,16,224
Mvaa 56,20,228
Mvaa 60,24,224
Mvaa 60,28,228
Ra 244,11,4096
Mvaa 64,32,224
Mvaa 64,36,228
Mvaa 68,40,224
Mvaa 68,44,228
Ra 248,10,6144
Mvaa 72,48,224
Mvaa 72,52,228
Mvaa 76,56,224
Mvaa 76,60,228
Ra 252,11,6144
Mvaa 80,0,232
Mvaa 80,4,236
Mvaa 84,8,232
Mvaa 84,12,236
Mvaa 88,16,232
Mvaa 88,20,236
Mvaa 92,24,232
Mvaa 92,28,236
Mvaa 96,32,232
Mvaa 96,36,236
Mvaa 100,40,232
Mvaa 100,44,236
Mvaa 104,48,232
Mvaa 104,52,236
Mvaa 108,56,232
s_waitcnt lgkmcnt(0)
Mvaa 108,60,236
Mvaa 112,0,240
Mvaa 112,4,244
Mvaa 116,8,240
Mvaa 116,12,244
Ra 224,10,8192
Mvaa 120,16,240
Mvaa 120,20,244
Mvaa 124,24,240
Mvaa 124,28,244
Ra 228,11,8192
Mvaa 128,32,240
Mvaa 128,36,244
Mvaa 132,40,240
Mvaa 132,44,244
Ra 232,10,10240
Mvaa 136,48,240
Mvaa 136,52,244
Mvaa 140,56,240
Mvaa 140,60,244
Ra 236,11,10240
Mvaa 144,0,248
Mvaa 144,4,252
Mvaa 148,8,248
Mvaa 148,12,252
Mvaa 152,16,248
Mvaa 152,20,252
Mvaa 156,24,248
Mvaa 156,28,252
Mvaa 160,32,248
Mvaa 160,36,252
Mvaa 164,40,248
Mvaa 164,44,252
Mvaa 168,48,248
Mvaa 168,52,252
s_waitcnt vmcnt(9)
Mvaa 172,56,248
s_waitcnt lgkmcnt(0)
s_barrier
Mvaa 172,60,252
s_add_u32 m0, s57, 0
Mvaa 176,0,224
buffer_load_dwordx4 v6, s[12:15], s52 offen offset:0 lds
Mvaa 176,4,228
Ta 64,14,0
Ta 66,14,2048
Mvaa 180,8,224
Mvaa 180,12,228
Ra 240,10,12288
Mvaa 184,16,224
buffer_load_dwordx4 v7, s[12:15], s53 offen offset:1024 lds
Mvaa 184,20,228
Ta 68,14,16384
Ta 70,14,18432
Mvaa 188,24,224
Mvaa 188,28,228
Ra 244,11,12288
Mvaa 192,32,224
buffer_load_dwordx4 v6, s[12:15], s54 offen offset:2048 lds
Mvaa 192,36,228
Ta 72,15,0
Ta 74,15,2048
Mvaa 196,40,224
Mvaa 196,44,228
Ra 248,10,14336
Mvaa 200,48,224
buffer_load_dwordx4 v7, s[12:15], s55 offen offset:3072 lds
Mvaa 200,52,228
Ta 76,15,16384
Ta 78,15,18432
Mvaa 204,56,224
s_cmp_eq_u32 s6, 0
s_cselect_b32 s3, 0, 2146435072
Mvaa 204,60,228
s_add_u32 m0, s57, 4096
Ra 252,11,14336
Mvaa 208,0,232
buffer_load_dwordx4 v8, s[12:15], s52 offen offset:0 lds
Mvaa 208,4,236
s_mov_b64 exec, 1
buffer_atomic_add v30, v31, s[28:31], s3 offen sc1
s_mov_b64 exec, -1
Mvaa 212,8,232
Mvaa 212,12,236
Ta 80,24,0
Ta 82,24,2048
Mvaa 216,16,232
buffer_load_dwordx4 v9, s[12:15], s53 offen offset:1024 lds
Mvaa 216,20,236
Ta 84,24,16384
s_waitcnt lgkmcnt(9)
Ta 86,24,18432
Mvaa 220,24,232
Mvaa 220,28,236
Ta 88,25,0
Ta 90,25,2048
Mvaa 224,32,232
buffer_load_dwordx4 v8, s[12:15], s54 offen offset:2048 lds
Mvaa 224,36,236
Mvaa 228,40,232
Mvaa 228,44,236
Ta 92,25,16384
Ta 94,25,18432
Mvaa 232,48,232
buffer_load_dwordx4 v9, s[12:15], s55 offen offset:3072 lds
Mvaa 232,52,236
s_waitcnt vmcnt(10)
Ta 96,26,0
s_waitcnt lgkmcnt(9)
Ta 98,26,2048
Mvaa 236,56,232
s_barrier
v_xor_b32 v6, 524288, v6
v_xor_b32 v7, 524288, v7
Mvaa 236,60,236
s_add_u32 m0, s56, 0
Ta 100,26,16384
Ta 102,26,18432
Mvaa 240,0,240
buffer_load_dwordx4 v2, s[8:11], s48 offen offset:0 lds
Mvaa 240,4,244
v_xor_b32 v8, 524288, v8
v_xor_b32 v9, 524288, v9
Mvaa 244,8,240
Mvaa 244,12,244
Ra 224,12,0
Mvaa 248,16,240
buffer_load_dwordx4 v3, s[8:11], s49 offen offset:1024 lds
Mvaa 248,20,244
Ta 104,27,0
Ta 106,27,2048
Mvaa 252,24,240
Mvaa 252,28,244
s_waitcnt lgkmcnt(9)
Ra 228,13,0
Maaa 128,32,240
buffer_load_dwordx4 v2, s[8:11], s50 offen offset:2048 lds
Maaa 128,36,244
Ta 108,27,16384
Ta 110,27,18432
Maaa 132,40,240
Maaa 132,44,244
Ra 232,12,2048
Maaa 136,48,240
buffer_load_dwordx4 v3, s[8:11], s51 offen offset:3072 lds
Maaa 136,52,244
Ta 112,28,0
Ta 114,28,2048
Maaa 140,56,240
Maaa 140,60,244
s_add_u32 m0, s56, 4096
s_waitcnt lgkmcnt(9)
Ra 236,13,2048
Maaa 144,0,248
buffer_load_dwordx4 v4, s[8:11], s48 offen offset:0 lds
Maaa 144,4,252
Maaa 148,8,248
Maaa 148,12,252
Ta 116,28,16384
Ta 118,28,18432
Maaa 152,16,248
buffer_load_dwordx4 v5, s[8:11], s49 offen offset:1024 lds
Maaa 152,20,252
Ta 120,29,0
Ta 122,29,2048
Maaa 156,24,248
Maaa 156,28,252
Ta 124,29,16384
s_waitcnt lgkmcnt(9)
Ta 126,29,18432
Maaa 160,32,248
buffer_load_dwordx4 v4, s[8:11], s50 offen offset:2048 lds
Maaa 160,36,252
Maaa 164,40,248
Maaa 164,44,252
Maaa 168,48,248
buffer_load_dwordx4 v5, s[8:11], s51 offen offset:3072 lds
Maaa 168,52,252
v_xor_b32 v2, 128, v2
v_xor_b32 v3, 128, v3
Maaa 172,56,248
s_waitcnt lgkmcnt(6)
buffer_load_dword v1, v47, s[60:63], 0 offen
v_xor_b32 v4, 128, v4
v_xor_b32 v5, 128, v5
Maaa 172,60,252
s_waitcnt lgkmcnt(0)
s_mul_i32 vcc_lo, s59, 3
v_xor_b32 v47, vcc_lo, v47
Mvaa 48,64,224
buffer_load_dword v44, v45, s[16:19], s47 offen
Mvaa 48,68,228
s_add_u32 s47, s47, 2097152
Mvaa 52,72,224
Mvaa 52,76,228
Ra 240,12,4096
Mvaa 56,80,224
Mvaa 56,84,228
Mvaa 60,88,224
Mvaa 60,92,228
Ra 244,13,4096
Mvaa 64,96,224
Mvaa 64,100,228
Mvaa 68,104,224
Mvaa 68,108,228
Ra 248,12,6144
Mvaa 72,112,224
Mvaa 72,116,228
Mvaa 76,120,224
Mvaa 76,124,228
Ra 252,13,6144
Mvaa 80,64,232
Mvaa 80,68,236
Mvaa 84,72,232
Mvaa 84,76,236
Mvaa 88,80,232
Mvaa 88,84,236
Mvaa 92,88,232
Mvaa 92,92,236
Mvaa 96,96,232
Mvaa 96,100,236
Mvaa 100,104,232
s_cmp_eq_u32 s6, 1
s_cselect_b32 s3, 0, 2146435072
Mvaa 100,108,236
s_mov_b64 exec, 1
buffer_atomic_add v30, v31, s[28:31], s3 offen sc1
s_mov_b64 exec, -1
Mvaa 104,112,232
Mvaa 104,116,236
Mvaa 108,120,232
s_waitcnt lgkmcnt(0)
Mvaa 108,124,236
Mvaa 112,64,240
Mvaa 112,68,244
Mvaa 116,72,240
Mvaa 116,76,244
Ra 224,12,8192
Mvaa 120,80,240
Mvaa 120,84,244
Mvaa 124,88,240
Mvaa 124,92,244
Ra 228,13,8192
Mvaa 128,96,240
Mvaa 128,100,244
Mvaa 132,104,240
Mvaa 132,108,244
Ra 232,12,10240
Mvaa 136,112,240
Mvaa 136,116,244
Mvaa 140,120,240
Mvaa 140,124,244
Ra 236,13,10240
Mvaa 144,64,248
Mvaa 144,68,252
Mvaa 148,72,248
Mvaa 148,76,252
Mvaa 152,80,248
Mvaa 152,84,252
Mvaa 156,88,248
Mvaa 156,92,252
Mvaa 160,96,248
Mvaa 160,100,252
Mvaa 164,104,248
Mvaa 164,108,252
Mvaa 168,112,248
Mvaa 168,116,252
s_waitcnt vmcnt(11)
Mvaa 172,120,248
s_waitcnt lgkmcnt(0)
s_barrier
Mvaa 172,124,252
s_add_u32 m0, s57, 65536
Mvaa 176,64,224
buffer_load_dwordx4 v6, s[12:15], s52 offen offset:0 lds
Mvaa 176,68,228
Ta 0,16,0
Ta 2,16,2048
Mvaa 180,72,224
Mvaa 180,76,228
Ra 240,12,12288
Mvaa 184,80,224
buffer_load_dwordx4 v7, s[12:15], s53 offen offset:1024 lds
Mvaa 184,84,228
Ta 4,16,16384
Ta 6,16,18432
Mvaa 188,88,224
Mvaa 188,92,228
Ra 244,13,12288
Mvaa 192,96,224
buffer_load_dwordx4 v6, s[12:15], s54 offen offset:2048 lds
Mvaa 192,100,228
Ta 8,17,0
Ta 10,17,2048
Mvaa 196,104,224
Mvaa 196,108,228
Ra 248,12,14336
Mvaa 200,112,224
buffer_load_dwordx4 v7, s[12:15], s55 offen offset:3072 lds
Mvaa 200,116,228
Ta 12,17,16384
Ta 14,17,18432
Mvaa 204,120,224
Mvaa 204,124,228
s_add_u32 m0, s57, 69632
Ra 252,13,14336
Mvaa 208,64,232
buffer_load_dwordx4 v8, s[12:15], s52 offen offset:0 lds
Mvaa 208,68,236
Mvaa 212,72,232
Mvaa 212,76,236
Ta 16,18,0
Ta 18,18,2048
Mvaa 216,80,232
buffer_load_dwordx4 v9, s[12:15], s53 offen offset:1024 lds
Mvaa 216,84,236
Ta 20,18,16384
s_waitcnt lgkmcnt(9)
Ta 22,18,18432
Mvaa 220,88,232
Mvaa 220,92,236
Ta 24,19,0
Ta 26,19,2048
Mvaa 224,96,232
buffer_load_dwordx4 v8, s[12:15], s54 offen offset:2048 lds
Mvaa 224,100,236
Mvaa 228,104,232
Mvaa 228,108,236
Ta 28,19,16384
Ta 30,19,18432
Mvaa 232,112,232
buffer_load_dwordx4 v9, s[12:15], s55 offen offset:3072 lds
Mvaa 232,116,236
s_waitcnt vmcnt(11)
Ta 32,20,0
s_waitcnt lgkmcnt(9)
Ta 34,20,2048
Mvaa 236,120,232
s_barrier
v_xor_b32 v6, 1572864, v6
v_xor_b32 v7, 1572864, v7
Mvaa 236,124,236
s_add_u32 m0, s56, 65536
Ta 36,20,16384
Ta 38,20,18432
Mvaa 240,64,240
buffer_load_dwordx4 v2, s[8:11], s48 offen offset:0 lds
Mvaa 240,68,244
v_xor_b32 v8, 1572864, v8
v_xor_b32 v9, 1572864, v9
Mvaa 244,72,240
Mvaa 244,76,244
Ra 224,10,0
Mvaa 248,80,240
buffer_load_dwordx4 v3, s[8:11], s49 offen offset:1024 lds
Mvaa 248,84,244
Ta 40,21,0
Ta 42,21,2048
Mvaa 252,88,240
Mvaa 252,92,244
s_waitcnt lgkmcnt(9)
Ra 228,11,0
Maaa 128,96,240
buffer_load_dwordx4 v2, s[8:11], s50 offen offset:2048 lds
Maaa 128,100,244
Ta 44,21,16384
Ta 46,21,18432
Maaa 132,104,240
s_cmp_eq_u32 s6, 2
s_cselect_b32 s3, 0, 2146435072
Maaa 132,108,244
Ra 232,10,2048
Maaa 136,112,240
buffer_load_dwordx4 v3, s[8:11], s51 offen offset:3072 lds
Maaa 136,116,244
Ta 48,22,0
Ta 50,22,2048
Maaa 140,120,240
s_mov_b64 exec, 1
buffer_atomic_add v30, v31, s[28:31], s3 offen sc1
s_mov_b64 exec, -1
Maaa 140,124,244
s_add_u32 m0, s56, 69632
s_waitcnt lgkmcnt(9)
Ra 236,11,2048
Maaa 144,64,248
buffer_load_dwordx4 v4, s[8:11], s48 offen offset:0 lds
Maaa 144,68,252
Maaa 148,72,248
Maaa 148,76,252
Ta 52,22,16384
Ta 54,22,18432
Maaa 152,80,248
buffer_load_dwordx4 v5, s[8:11], s49 offen offset:1024 lds
Maaa 152,84,252
Ta 56,23,0
Ta 58,23,2048
Maaa 156,88,248
Maaa 156,92,252
Ta 60,23,16384
s_waitcnt lgkmcnt(9)
Ta 62,23,18432
Maaa 160,96,248
buffer_load_dwordx4 v4, s[8:11], s50 offen offset:2048 lds
Maaa 160,100,252
Maaa 164,104,248
Maaa 164,108,252
Maaa 168,112,248
buffer_load_dwordx4 v5, s[8:11], s51 offen offset:3072 lds
Maaa 168,116,252
v_xor_b32 v2, 384, v2
v_xor_b32 v3, 384, v3
Maaa 172,120,248
s_waitcnt lgkmcnt(6)
buffer_load_dword v1, v47, s[60:63], 0 offen
v_xor_b32 v4, 384, v4
v_xor_b32 v5, 384, v5
Maaa 172,124,252
s_waitcnt lgkmcnt(0)
s_mul_i32 vcc_lo, s59, 1
v_xor_b32_e64 v47, vcc_lo, v47
Mvaa 48,0,224
buffer_load_dword v44, v45, s[16:19], s47 offen
Mvaa 48,4,228
s_add_u32 s47, s47, 2097152
Mvaa 52,8,224
Mvaa 52,12,228
Ra 240,10,4096
Mvaa 56,16,224
Mvaa 56,20,228
Mvaa 60,24,224
Mvaa 60,28,228
Ra 244,11,4096
Mvaa 64,32,224
Mvaa 64,36,228
Mvaa 68,40,224
Mvaa 68,44,228
Ra 248,10,6144
Mvaa 72,48,224
Mvaa 72,52,228
Mvaa 76,56,224
Mvaa 76,60,228
Ra 252,11,6144
Mvaa 80,0,232
Mvaa 80,4,236
Mvaa 84,8,232
Mvaa 84,12,236
Mvaa 88,16,232
Mvaa 88,20,236
Mvaa 92,24,232
Mvaa 92,28,236
Mvaa 96,32,232
Mvaa 96,36,236
Mvaa 100,40,232
Mvaa 100,44,236
Mvaa 104,48,232
Mvaa 104,52,236
Mvaa 108,56,232
s_waitcnt lgkmcnt(0)
Mvaa 108,60,236
Mvaa 112,0,240
Mvaa 112,4,244
Mvaa 116,8,240
Mvaa 116,12,244
Ra 224,10,8192
Mvaa 120,16,240
Mvaa 120,20,244
Mvaa 124,24,240
Mvaa 124,28,244
Ra 228,11,8192
Mvaa 128,32,240
Mvaa 128,36,244
Mvaa 132,40,240
Mvaa 132,44,244
Ra 232,10,10240
Mvaa 136,48,240
Mvaa 136,52,244
Mvaa 140,56,240
Mvaa 140,60,244
Ra 236,11,10240
Mvaa 144,0,248
Mvaa 144,4,252
Mvaa 148,8,248
Mvaa 148,12,252
Mvaa 152,16,248
s_cmp_eq_u32 s6, 3
s_cselect_b32 s3, 0, 2146435072
Mvaa 152,20,252
s_mov_b64 exec, 1
buffer_atomic_add v30, v31, s[28:31], s3 offen sc1
s_mov_b64 exec, -1
Mvaa 156,24,248
Mvaa 156,28,252
Mvaa 160,32,248
Mvaa 160,36,252
Mvaa 164,40,248
Mvaa 164,44,252
Mvaa 168,48,248
Mvaa 168,52,252
s_waitcnt vmcnt(12)
Mvaa 172,56,248
s_waitcnt lgkmcnt(0)
s_barrier
Mvaa 172,60,252
s_add_u32 m0, s57, 0
Mvaa 176,0,224
buffer_load_dwordx4 v6, s[12:15], s52 offen offset:0 lds
Mvaa 176,4,228
Ta 64,14,0
Ta 66,14,2048
Mvaa 180,8,224
Mvaa 180,12,228
Ra 240,10,12288
Mvaa 184,16,224
buffer_load_dwordx4 v7, s[12:15], s53 offen offset:1024 lds
Mvaa 184,20,228
Ta 68,14,16384
Ta 70,14,18432
Mvaa 188,24,224
Mvaa 188,28,228
Ra 244,11,12288
Mvaa 192,32,224
buffer_load_dwordx4 v6, s[12:15], s54 offen offset:2048 lds
Mvaa 192,36,228
Ta 72,15,0
Ta 74,15,2048
Mvaa 196,40,224
Mvaa 196,44,228
Ra 248,10,14336
Mvaa 200,48,224
buffer_load_dwordx4 v7, s[12:15], s55 offen offset:3072 lds
Mvaa 200,52,228
Ta 76,15,16384
Ta 78,15,18432
Mvaa 204,56,224
Mvaa 204,60,228
s_add_u32 m0, s57, 4096
Ra 252,11,14336
Mvaa 208,0,232
buffer_load_dwordx4 v8, s[12:15], s52 offen offset:0 lds
Mvaa 208,4,236
Mvaa 212,8,232
Mvaa 212,12,236
Ta 80,24,0
Ta 82,24,2048
Mvaa 216,16,232
buffer_load_dwordx4 v9, s[12:15], s53 offen offset:1024 lds
Mvaa 216,20,236
Ta 84,24,16384
s_waitcnt lgkmcnt(9)
Ta 86,24,18432
Mvaa 220,24,232
Mvaa 220,28,236
Ta 88,25,0
Ta 90,25,2048
Mvaa 224,32,232
buffer_load_dwordx4 v8, s[12:15], s54 offen offset:2048 lds
Mvaa 224,36,236
Mvaa 228,40,232
Mvaa 228,44,236
Ta 92,25,16384
Ta 94,25,18432
Mvaa 232,48,232
buffer_load_dwordx4 v9, s[12:15], s55 offen offset:3072 lds
Mvaa 232,52,236
s_waitcnt vmcnt(11)
Ta 96,26,0
s_waitcnt lgkmcnt(9)
Ta 98,26,2048
Mvaa 236,56,232
s_barrier
v_xor_b32 v6, 524288, v6
v_xor_b32 v7, 524288, v7
Mvaa 236,60,236
s_add_u32 m0, s56, 0
Ta 100,26,16384
Ta 102,26,18432
Mvaa 240,0,240
buffer_load_dwordx4 v2, s[8:11], s48 offen offset:0 lds
Mvaa 240,4,244
v_xor_b32 v8, 524288, v8
v_xor_b32 v9, 524288, v9
Mvaa 244,8,240
Mvaa 244,12,244
Ra 224,12,0
Mvaa 248,16,240
buffer_load_dwordx4 v3, s[8:11], s49 offen offset:1024 lds
Mvaa 248,20,244
Ta 104,27,0
Ta 106,27,2048
Mvaa 252,24,240
Mvaa 252,28,244
s_waitcnt lgkmcnt(9)
Ra 228,13,0
Maaa 128,32,240
buffer_load_dwordx4 v2, s[8:11], s50 offen offset:2048 lds
Maaa 128,36,244
Ta 108,27,16384
Ta 110,27,18432
Maaa 132,40,240
Maaa 132,44,244
Ra 232,12,2048
Maaa 136,48,240
buffer_load_dwordx4 v3, s[8:11], s51 offen offset:3072 lds
Maaa 136,52,244
Ta 112,28,0
Ta 114,28,2048
Maaa 140,56,240
Maaa 140,60,244
s_add_u32 m0, s56, 4096
s_waitcnt lgkmcnt(9)
Ra 236,13,2048
Maaa 144,0,248
buffer_load_dwordx4 v4, s[8:11], s48 offen offset:0 lds
Maaa 144,4,252
Maaa 148,8,248
Maaa 148,12,252
Ta 116,28,16384
Ta 118,28,18432
Maaa 152,16,248
buffer_load_dwordx4 v5, s[8:11], s49 offen offset:1024 lds
Maaa 152,20,252
Ta 120,29,0
Ta 122,29,2048
Maaa 156,24,248
Maaa 156,28,252
Ta 124,29,16384
s_waitcnt lgkmcnt(9)
Ta 126,29,18432
Maaa 160,32,248
buffer_load_dwordx4 v4, s[8:11], s50 offen offset:2048 lds
Maaa 160,36,252
Maaa 164,40,248
Maaa 164,44,252
Maaa 168,48,248
buffer_load_dwordx4 v5, s[8:11], s51 offen offset:3072 lds
Maaa 168,52,252
v_xor_b32 v2, 128, v2
v_xor_b32 v3, 128, v3
Maaa 172,56,248
s_waitcnt lgkmcnt(6)
buffer_load_dword v1, v47, s[60:63], 0 offen
v_xor_b32 v4, 128, v4
v_xor_b32 v5, 128, v5
Maaa 172,60,252
s_waitcnt lgkmcnt(0)
s_mul_i32 vcc_lo, s59, 7
v_xor_b32 v47, vcc_lo, v47
Mvaa 48,64,224
buffer_load_dword v44, v45, s[16:19], s47 offen
Mvaa 48,68,228
s_add_u32 s47, s47, 2097152
v_lshrrev_b32 v32, 4, v0
v_and_b32 v33, 15, v0
Mvaa 52,72,224
s_lshl_b32 s3, s32, 4
v_add_u32 v34, s3, v32
v_lshlrev_b32_e64 v36, 1, v32
Mvaa 52,76,228
Ra 240,12,4096
Mvaa 56,80,224
v_xor_b32 v36, v36, v33
v_xor_b32 v37, 8, v36
Mvaa 56,84,228
Mvaa 60,88,224
Mvaa 60,92,228
Ra 244,13,4096
Mvaa 64,96,224
s_getpc_b64 s[6:7]
L_cpf2:
s_add_u32 s6, s6, (L_phase2-L_cpf2)&0xffffffff
s_addc_u32 s7, s7, ((L_phase2-L_cpf2)>>32)&0xffffffff
Mvaa 64,100,228
s_lshr_b32 s3, s2, 3
s_lshl_b32 s3, s3, 2
s_add_u32 s3, s3, s32
Mvaa 68,104,224
s_lshl_b32 s3, s3, 10
v_and_b32 v42, 7, v0
v_lshlrev_b32_e64 v42, 7, v42
Mvaa 68,108,228
Ra 248,12,6144
Mvaa 72,112,224
v_add_u32_e64 v42, s3, v42
v_min_u32 v42, L_k2_fin-L_phase2-4, v42
Mvaa 72,116,228
v_mov_b32_e64 v41, s7
Mvaa 76,120,224
v_add_co_u32 v40, vcc, s6, v42
s_nop 1
v_addc_co_u32 v41, vcc, 0, v41, vcc
Mvaa 76,124,228
Ra 252,13,6144
Mvaa 80,64,232
global_load_dword v38, v[40:41], off
Mvaa 80,68,236
Mvaa 84,72,232
Mvaa 84,76,236
Mvaa 88,80,232
Mvaa 88,84,236
Mvaa 92,88,232
Mvaa 92,92,236
Mvaa 96,96,232
Mvaa 96,100,236
Mvaa 100,104,232
Mvaa 100,108,236
Mvaa 104,112,232
Mvaa 104,116,236
Mvaa 108,120,232
s_waitcnt lgkmcnt(0)
Mvaa 108,124,236
Mvaa 112,64,240
Mvaa 112,68,244
Mvaa 116,72,240
Mvaa 116,76,244
Ra 224,12,8192
Mvaa 120,80,240
Mvaa 120,84,244
Mvaa 124,88,240
Mvaa 124,92,244
Ra 228,13,8192
Mvaa 128,96,240
Mvaa 128,100,244
Mvaa 132,104,240
Mvaa 132,108,244
Ra 232,12,10240
Mvaa 136,112,240
Mvaa 136,116,244
Mvaa 140,120,240
Mvaa 140,124,244
Ra 236,13,10240
Mvaa 144,64,248
Mvaa 144,68,252
Mvaa 148,72,248
Mvaa 148,76,252
Mvaa 152,80,248
Mvaa 152,84,252
Mvaa 156,88,248
Mvaa 156,92,252
Mvaa 160,96,248
Mvaa 160,100,252
Mvaa 164,104,248
Mvaa 164,108,252
Mvaa 168,112,248
Mvaa 168,116,252
s_waitcnt vmcnt(11)
Mvaa 172,120,248
s_waitcnt lgkmcnt(0)
s_barrier
Mvaa 172,124,252
s_add_u32 m0, s57, 65536
Mvaa 176,64,224
buffer_load_dwordx4 v6, s[12:15], s52 offen offset:0 lds
Mvaa 176,68,228
Ta 0,16,0
Ta 2,16,2048
Mvaa 180,72,224
Mvaa 180,76,228
Ra 240,12,12288
Mvaa 184,80,224
buffer_load_dwordx4 v7, s[12:15], s53 offen offset:1024 lds
Mvaa 184,84,228
Ta 4,16,16384
Ta 6,16,18432
Mvaa 188,88,224
Mvaa 188,92,228
Ra 244,13,12288
Mvaa 192,96,224
buffer_load_dwordx4 v6, s[12:15], s54 offen offset:2048 lds
Mvaa 192,100,228
Ta 8,17,0
Ta 10,17,2048
Mvaa 196,104,224
Mvaa 196,108,228
Ra 248,12,14336
Mvaa 200,112,224
buffer_load_dwordx4 v7, s[12:15], s55 offen offset:3072 lds
Mvaa 200,116,228
Ta 12,17,16384
Ta 14,17,18432
Mvaa 204,120,224
Mvaa 204,124,228
s_add_u32 m0, s57, 69632
Ra 252,13,14336
Mvaa 208,64,232
buffer_load_dwordx4 v8, s[12:15], s52 offen offset:0 lds
Mvaa 208,68,236
Mvaa 212,72,232
Mvaa 212,76,236
Ta 16,18,0
Ta 18,18,2048
Mvaa 216,80,232
buffer_load_dwordx4 v9, s[12:15], s53 offen offset:1024 lds
Mvaa 216,84,236
Ta 20,18,16384
s_waitcnt lgkmcnt(9)
Ta 22,18,18432
Mvaa 220,88,232
Mvaa 220,92,236
Ta 24,19,0
Ta 26,19,2048
Mvaa 224,96,232
buffer_load_dwordx4 v8, s[12:15], s54 offen offset:2048 lds
Mvaa 224,100,236
Mvaa 228,104,232
Mvaa 228,108,236
Ta 28,19,16384
Ta 30,19,18432
Mvaa 232,112,232
buffer_load_dwordx4 v9, s[12:15], s55 offen offset:3072 lds
Mvaa 232,116,236
s_waitcnt vmcnt(11)
Ta 32,20,0
s_waitcnt lgkmcnt(9)
Ta 34,20,2048
Mvaa 236,120,232
s_barrier
Mvaa 236,124,236
s_add_u32 m0, s56, 65536
Ta 36,20,16384
Ta 38,20,18432
Mvaa 240,64,240
buffer_load_dwordx4 v2, s[8:11], s48 offen offset:0 lds
Mvaa 240,68,244
Mvaa 244,72,240
Mvaa 244,76,244
Ra 224,10,0
Mvaa 248,80,240
buffer_load_dwordx4 v3, s[8:11], s49 offen offset:1024 lds
Mvaa 248,84,244
Ta 40,21,0
Ta 42,21,2048
Mvaa 252,88,240
Mvaa 252,92,244
s_waitcnt lgkmcnt(9)
Ra 228,11,0
Maaa 128,96,240
buffer_load_dwordx4 v2, s[8:11], s50 offen offset:2048 lds
Maaa 128,100,244
Ta 44,21,16384
Ta 46,21,18432
Maaa 132,104,240
Maaa 132,108,244
Ra 232,10,2048
Maaa 136,112,240
buffer_load_dwordx4 v3, s[8:11], s51 offen offset:3072 lds
Maaa 136,116,244
Ta 48,22,0
Ta 50,22,2048
Maaa 140,120,240
Maaa 140,124,244
s_add_u32 m0, s56, 69632
s_waitcnt lgkmcnt(9)
Ra 236,11,2048
Maaa 144,64,248
buffer_load_dwordx4 v4, s[8:11], s48 offen offset:0 lds
Maaa 144,68,252
Maaa 148,72,248
Maaa 148,76,252
Ta 52,22,16384
Ta 54,22,18432
Maaa 152,80,248
buffer_load_dwordx4 v5, s[8:11], s49 offen offset:1024 lds
Maaa 152,84,252
Ta 56,23,0
Ta 58,23,2048
Maaa 156,88,248
Maaa 156,92,252
Ta 60,23,16384
s_waitcnt lgkmcnt(9)
Ta 62,23,18432
Maaa 160,96,248
buffer_load_dwordx4 v4, s[8:11], s50 offen offset:2048 lds
Maaa 160,100,252
Maaa 164,104,248
Maaa 164,108,252
Maaa 168,112,248
buffer_load_dwordx4 v5, s[8:11], s51 offen offset:3072 lds
Maaa 168,116,252
Maaa 172,120,248
s_waitcnt lgkmcnt(6)
Maaa 172,124,252
s_waitcnt lgkmcnt(0)
Mvaa 48,0,224
buffer_load_dword v1, v31, s[28:31], s37 offen sc1
Mvaa 48,4,228
s_mov_b32 s8, s16
s_mov_b32 s9, s17
s_mov_b32 s10, s18
Mvaa 52,8,224
s_add_u32 s16, s66, 46137344
s_addc_u32 s17, s67, 0
s_and_b32 s17, s17, 0xffff
Mvaa 52,12,228
Ra 240,10,4096
Mvaa 56,16,224
s_mov_b32 s18, 16777216
s_mov_b32 s19, 0x20000
s_mov_b32 s48, 0
Mvaa 56,20,228
s_mov_b32 s49, 31744
s_mov_b32 s50, 63488
s_mov_b32 s51, 95232
Mvaa 60,24,224
v_lshlrev_b32 v35, 13, v34
Mvaa 60,28,228
Ra 244,11,4096
Mvaa 64,32,224
s_and_b32 s52, s33, 0
s_lshl_b32 s3, s52, 19
s_lshl_b32 s52, s52, 11
Mvaa 64,36,228
s_add_u32 s53, s52, s58
v_add_u32_e64 v35, s3, v35
v_lshl_add_u32 v8, v36, 4, v35
Mvaa 68,40,224
v_lshl_add_u32 v9, v37, 4, v35
v_lshlrev_b32_e64 v2, 4, v0
Mvaa 68,44,228
Ra 248,10,6144
Mvaa 72,48,224
v_add_u32 v3, 65536, v2
v_add_u32_e64 v4, s44, v2
Mvaa 72,52,228
v_mov_b32 v7, 0
v_lshlrev_b32 v35, 2, v32
Mvaa 76,56,224
v_sub_u32_e64 v35, v33, v35
Mvaa 76,60,228
Ra 252,11,6144
Mvaa 80,0,232
s_lshl_b32 s3, s32, 4
v_add_u32 v5, s3, v35
Mvaa 80,4,236
s_sub_u32 s3, 48, s3
v_add_u32 v6, s3, v35
Mvaa 84,8,232
s_mul_i32 s3, s33, 1116160
s_add_u32 s3, s3, 8388608
s_add_u32 s12, s66, s3
s_addc_u32 s13, s67, 0
s_and_b32 s13, s13, 0xffff
Mvaa 84,12,236
s_mov_b32 s14, 0
s_mov_b32 s15, 0x20000
s_mul_i32 s14, s36, 34816
Mvaa 88,16,232
buffer_load_dword v44, v45, s[8:11], s47 offen
Mvaa 88,20,236
s_add_u32 s47, s47, 2097152
v_lshrrev_b32 v42, 2, v33
v_lshl_add_u32 v43, v32, 3, v42
Mvaa 92,24,232
v_lshlrev_b32 v43, 8, v43
v_and_b32 v46, 3, v0
Mvaa 92,28,236
v_lshl_add_u32 v43, v46, 3, v43
v_and_b32_e64 v46, 1, v32
Mvaa 96,32,232
v_lshl_add_u32 v42, v46, 2, v42
v_lshl_add_u32 v16, v42, 5, v43
Mvaa 96,36,236
v_xor_b32 v17, 32, v16
v_xor_b32 v18, 64, v16
Mvaa 100,40,232
v_xor_b32 v19, 96, v16
v_xor_b32 v20, 128, v16
Mvaa 100,44,236
v_xor_b32 v21, 160, v16
v_xor_b32 v22, 192, v16
Mvaa 104,48,232
v_xor_b32 v23, 224, v16
Mvaa 104,52,236
Mvaa 108,56,232
s_waitcnt lgkmcnt(0)
Mvaa 108,60,236
Mvaa 112,0,240
Mvaa 112,4,244
Mvaa 116,8,240
Mvaa 116,12,244
Ra 224,10,8192
Mvaa 120,16,240
Mvaa 120,20,244
Mvaa 124,24,240
Mvaa 124,28,244
Ra 228,11,8192
Mvaa 128,32,240
Mvaa 128,36,244
Mvaa 132,40,240
Mvaa 132,44,244
Ra 232,10,10240
Mvaa 136,48,240
Mvaa 136,52,244
Mvaa 140,56,240
Mvaa 140,60,244
Ra 236,11,10240
Mvaa 144,0,248
Mvaa 144,4,252
Mvaa 148,8,248
Mvaa 148,12,252
Mvaa 152,16,248
Mvaa 152,20,252
Mvaa 156,24,248
Mvaa 156,28,252
Mvaa 160,32,248
Mvaa 160,36,252
Mvaa 164,40,248
Mvaa 164,44,252
Mvaa 168,48,248
Mvaa 168,52,252
s_waitcnt vmcnt(10)
Mvaa 172,56,248
s_waitcnt lgkmcnt(0)
s_barrier
Mvaa 172,60,252
s_add_u32 m0, s44, 0
Mvaa 176,0,224
buffer_load_dwordx4 v8, s[8:11], s48 offen offset:0 lds
Mvaa 176,4,228
Ta 64,14,0
Ta 66,14,2048
Mvaa 180,8,224
Mvaa 180,12,228
Ra 240,10,12288
Mvaa 184,16,224
buffer_load_dwordx4 v8, s[8:11], s49 offen offset:1024 lds
Mvaa 184,20,228
Ta 68,14,16384
Ta 70,14,18432
Mvaa 188,24,224
Mvaa 188,28,228
Ra 244,11,12288
Mvaa 192,32,224
buffer_load_dwordx4 v9, s[8:11], s50 offen offset:2048 lds
Mvaa 192,36,228
Ta 72,15,0
Ta 74,15,2048
Mvaa 196,40,224
Mvaa 196,44,228
Ra 248,10,14336
Mvaa 200,48,224
buffer_load_dwordx4 v9, s[8:11], s51 offen offset:3072 lds
Mvaa 200,52,228
Ta 76,15,16384
Ta 78,15,18432
Mvaa 204,56,224
v_xor_b32 v8, 524288, v8
v_xor_b32 v9, 524288, v9
Mvaa 204,60,228
s_add_u32 m0, s44, 16384
Ra 252,11,14336
Mvaa 208,0,232
buffer_load_dwordx4 v8, s[8:11], s48 offen offset:0 lds
Mvaa 208,4,236
Mvaa 212,8,232
Mvaa 212,12,236
Ta 80,24,0
Ta 82,24,2048
Mvaa 216,16,232
buffer_load_dwordx4 v8, s[8:11], s49 offen offset:1024 lds
Mvaa 216,20,236
Ta 84,24,16384
s_waitcnt lgkmcnt(9)
Ta 86,24,18432
Mvaa 220,24,232
Mvaa 220,28,236
Ta 88,25,0
Ta 90,25,2048
Mvaa 224,32,232
buffer_load_dwordx4 v9, s[8:11], s50 offen offset:2048 lds
Mvaa 224,36,236
Mvaa 228,40,232
s_mul_i32 s3, s45, 33792
v_add_u32_e64 v10, s3, v2
Mvaa 228,44,236
Ta 92,25,16384
Ta 94,25,18432
Mvaa 232,48,232
buffer_load_dwordx4 v9, s[8:11], s51 offen offset:3072 lds
Mvaa 232,52,236
s_waitcnt vmcnt(10)
Ta 96,26,0
s_waitcnt lgkmcnt(9)
Ta 98,26,2048
Mvaa 236,56,232
s_barrier
v_xor_b32 v8, 1572864, v8
v_xor_b32 v9, 1572864, v9
Mvaa 236,60,236
s_add_u32 m0, s44, 32768
Ta 100,26,16384
Ta 102,26,18432
Mvaa 240,0,240
buffer_load_dwordx4 v8, s[8:11], s48 offen offset:0 lds
Mvaa 240,4,244
s_mul_i32 s3, s46, 33792
v_add_u32 v11, s3, v2
Mvaa 244,8,240
Mvaa 244,12,244
Ra 224,12,0
Mvaa 248,16,240
buffer_load_dwordx4 v8, s[8:11], s49 offen offset:1024 lds
Mvaa 248,20,244
Ta 104,27,0
Ta 106,27,2048
Mvaa 252,24,240
Mvaa 252,28,244
s_waitcnt lgkmcnt(9)
Ra 228,13,0
Maaa 128,32,240
buffer_load_dwordx4 v9, s[8:11], s50 offen offset:2048 lds
Maaa 128,36,244
Ta 108,27,16384
Ta 110,27,18432
Maaa 132,40,240
Maaa 132,44,244
Ra 232,12,2048
Maaa 136,48,240
buffer_load_dwordx4 v9, s[8:11], s51 offen offset:3072 lds
Maaa 136,52,244
Ta 112,28,0
Ta 114,28,2048
Maaa 140,56,240
v_xor_b32 v8, 524288, v8
v_xor_b32 v9, 524288, v9
Maaa 140,60,244
s_add_u32 m0, s44, 49152
s_waitcnt lgkmcnt(9)
Ra 236,13,2048
Maaa 144,0,248
buffer_load_dwordx4 v8, s[8:11], s48 offen offset:0 lds
Maaa 144,4,252
Maaa 148,8,248
Maaa 148,12,252
Ta 116,28,16384
Ta 118,28,18432
Maaa 152,16,248
buffer_load_dwordx4 v8, s[8:11], s49 offen offset:1024 lds
Maaa 152,20,252
Ta 120,29,0
Ta 122,29,2048
Maaa 156,24,248
Maaa 156,28,252
Ta 124,29,16384
s_waitcnt lgkmcnt(9)
Ta 126,29,18432
Maaa 160,32,248
buffer_load_dwordx4 v9, s[8:11], s50 offen offset:2048 lds
Maaa 160,36,252
Maaa 164,40,248
Maaa 164,44,252
Maaa 168,48,248
buffer_load_dwordx4 v9, s[8:11], s51 offen offset:3072 lds
Maaa 168,52,252
v_xor_b32 v8, 3670016, v8
v_xor_b32 v9, 3670016, v9
Maaa 172,56,248
s_waitcnt lgkmcnt(6)
Maaa 172,60,252
s_waitcnt lgkmcnt(0)
Mvaa 48,64,224
v_mov_b32 v14, v40
v_mov_b32_e64 v15, v41
Mvaa 48,68,228
Mvaa 52,72,224
Mvaa 52,76,228
Ra 240,12,4096
Mvaa 56,80,224
Mvaa 56,84,228
Mvaa 60,88,224
Mvaa 60,92,228
Ra 244,13,4096
Mvaa 64,96,224
Vc 24,48,49
Vc 25,50,51
Mvaa 64,100,228
Vc 26,52,53
Vc 27,54,55
Mvaa 68,104,224
Mvaa 68,108,228
Ra 248,12,6144
Mvaa 72,112,224
Vc 28,56,57
Vc 29,58,59
Mvaa 72,116,228
Vc 30,60,61
Vc 31,62,63
Mvaa 76,120,224
Mvaa 76,124,228
Ra 252,13,6144
Mvaa 80,64,232
Vc 32,64,65
Vc 33,66,67
Mvaa 80,68,236
Vc 34,68,69
Vc 35,70,71
Mvaa 84,72,232
Mvaa 84,76,236
Mvaa 88,80,232
Vc 36,72,73
Vc 37,74,75
Mvaa 88,84,236
Vc 38,76,77
Vc 39,78,79
Mvaa 92,88,232
Mvaa 92,92,236
Mvaa 96,96,232
Vc 40,80,81
Vc 41,82,83
Mvaa 96,100,236
Vc 42,84,85
Vc 43,86,87
Mvaa 100,104,232
s_waitcnt vmcnt(12)
Mvaa 100,108,236
s_add_u32 s59, s38, 0
Mvaa 104,112,232
v_readfirstlane_b32 s3, v1
s_nop 0
s_or_b32 s3, s3, s37
s_cmp_lt_u32 s3, 256
s_cbranch_scc1 L_spinAk
L_spinArk:
s_barrier
Mvaa 104,116,236
buffer_store_dwordx4 v[24:27], v2, s[24:27], s59 offen offset:0 sc1
Mvaa 108,120,232
s_waitcnt lgkmcnt(0)
Mvaa 108,124,236
Vc 44,88,89
Vc 45,90,91
Mvaa 112,64,240
buffer_load_dwordx4 a[0:3], v10, s[20:23], s53 offen offset:0 sc1
Mvaa 112,68,244
Vc 46,92,93
Vc 47,94,95
Mvaa 116,72,240
Vc 48,96,97
Vc 49,98,99
Mvaa 116,76,244
Ra 224,12,8192
Mvaa 120,80,240
Vc 50,100,101
Vc 51,102,103
Mvaa 120,84,244
Vc 52,104,105
Vc 53,106,107
Mvaa 124,88,240
buffer_load_dwordx4 a[4:7], v10, s[20:23], s52 offen offset:0 sc1
Mvaa 124,92,244
Ra 228,13,8192
Mvaa 128,96,240
Vc 54,108,109
Vc 55,110,111
Mvaa 128,100,244
Vc 56,112,113
Vc 57,114,115
Mvaa 132,104,240
Vc 58,116,117
Vc 59,118,119
Mvaa 132,108,244
Ra 232,12,10240
Mvaa 136,112,240
buffer_load_dwordx4 a[8:11], v11, s[20:23], s53 offen offset:0 sc1
Mvaa 136,116,244
buffer_store_dwordx4 v[28:31], v2, s[24:27], s59 offen offset:1024 sc1
Mvaa 140,120,240
Vc 60,120,121
Vc 61,122,123
Mvaa 140,124,244
Ra 236,13,10240
Mvaa 144,64,248
Vc 62,124,125
Vc 63,126,127
Mvaa 144,68,252
Vc 64,128,129
Vc 65,130,131
Mvaa 148,72,248
buffer_load_dwordx4 a[12:15], v11, s[20:23], s52 offen offset:0 sc1
Mvaa 148,76,252
Vc 66,132,133
Vc 67,134,135
Mvaa 152,80,248
Vc 68,136,137
Vc 69,138,139
Mvaa 152,84,252
Vc 70,140,141
Vc 71,142,143
Mvaa 156,88,248
Mvaa 156,92,252
Mvaa 160,96,248
buffer_load_dwordx4 a[16:19], v10, s[20:23], s53 offen offset:1024 sc1
Mvaa 160,100,252
Vc 72,144,145
Vc 73,146,147
Mvaa 164,104,248
Vc 74,148,149
Vc 75,150,151
Mvaa 164,108,252
buffer_store_dwordx4 v[32:35], v2, s[24:27], s59 offen offset:2048 sc1
Mvaa 168,112,248
Vc 76,152,153
Vc 77,154,155
Mvaa 168,116,252
Vc 78,156,157
Vc 79,158,159
Mvaa 172,120,248
s_waitcnt lgkmcnt(0)
buffer_load_dwordx4 a[20:23], v10, s[20:23], s52 offen offset:1024 sc1
Mvaa 172,124,252
Mvaa 176,64,224
Vc 80,160,161
Vc 81,162,163
Mvaa 176,68,228
Vc 82,164,165
Vc 83,166,167
Mvaa 180,72,224
Mvaa 180,76,228
Ra 240,12,12288
Mvaa 184,80,224
buffer_load_dwordx4 a[24:27], v11, s[20:23], s53 offen offset:1024 sc1
Mvaa 184,84,228
Vc 84,168,169
Vc 85,170,171
Mvaa 188,88,224
Vc 86,172,173
Vc 87,174,175
Mvaa 188,92,228
Ra 244,13,12288
Mvaa 192,96,224
Vc 88,176,177
Vc 89,178,179
Mvaa 192,100,228
Vc 90,180,181
Vc 91,182,183
Mvaa 196,104,224
buffer_load_dwordx4 a[28:31], v11, s[20:23], s52 offen offset:1024 sc1
Mvaa 196,108,228
Ra 248,12,14336
s_xor_b32 s52, s52, 2048
Mvaa 200,112,224
s_add_u32 s53, s52, s58
Mvaa 200,116,228
Vc 92,184,185
Vc 93,186,187
Mvaa 204,120,224
Vc 94,188,189
Vc 95,190,191
Mvaa 204,124,228
Ra 252,13,14336
Mvaa 208,64,232
buffer_load_dwordx4 a[32:35], v10, s[20:23], s53 offen offset:0 sc1
Mvaa 208,68,236
buffer_store_dwordx4 v[36:39], v2, s[24:27], s59 offen offset:3072 sc1
Mvaa 212,72,232
Vc 96,192,193
Vc 97,194,195
Mvaa 212,76,236
Vc 98,196,197
Vc 99,198,199
Mvaa 216,80,232
Vc 100,200,201
Vc 101,202,203
Mvaa 216,84,236
Vc 102,204,205
Vc 103,206,207
Mvaa 220,88,232
buffer_load_dwordx4 a[36:39], v10, s[20:23], s52 offen offset:0 sc1
Mvaa 220,92,236
Mvaa 224,96,232
Vc 104,208,209
Vc 105,210,211
Mvaa 224,100,236
Vc 106,212,213
Vc 107,214,215
Mvaa 228,104,232
Mvaa 228,108,236
Mvaa 232,112,232
buffer_load_dwordx4 a[40:43], v11, s[20:23], s53 offen offset:0 sc1
Mvaa 232,116,236
Vc 108,216,217
Vc 109,218,219
Mvaa 236,120,232
s_waitcnt lgkmcnt(0)
Mvaa 236,124,236
Vc 110,220,221
Vc 111,222,223
Mvaa 240,64,240
s_add_u32 s59, s38, 4096
Mvaa 240,68,244
buffer_store_dwordx4 v[40:43], v2, s[24:27], s59 offen offset:0 sc1
Mvaa 244,72,240
buffer_load_dwordx4 a[44:47], v11, s[20:23], s52 offen offset:0 sc1
Mvaa 244,76,244
Vc 112,224,225
Vc 113,226,227
Mvaa 248,80,240
Vc 114,228,229
Vc 115,230,231
Mvaa 248,84,244
Vc 116,232,233
Vc 117,234,235
Mvaa 252,88,240
Vc 118,236,237
Vc 119,238,239
Mvaa 252,92,244
Maaa 128,96,240
buffer_load_dwordx4 a[48:51], v10, s[20:23], s53 offen offset:1024 sc1
Maaa 128,100,244
Ta 192,16,0
Ta 194,16,1024
Maaa 132,104,240
Vc 120,240,241
Vc 121,242,243
Maaa 132,108,244
Ta 196,16,8192
Ta 198,16,9216
Maaa 136,112,240
Vc 122,244,245
Vc 123,246,247
Maaa 136,116,244
Ta 200,17,0
Ta 202,17,1024
Maaa 140,120,240
buffer_load_dwordx4 a[52:55], v10, s[20:23], s52 offen offset:1024 sc1
Maaa 140,124,244
Ta 204,17,8192
Ta 206,17,9216
Maaa 144,64,248
Vc 124,248,249
Vc 125,250,251
Maaa 144,68,252
Ta 208,18,0
Ta 210,18,1024
Maaa 148,72,248
Vc 126,252,253
Vc 127,254,255
Maaa 148,76,252
Ta 212,18,8192
Ta 214,18,9216
Maaa 152,80,248
buffer_load_dwordx4 a[56:59], v11, s[20:23], s53 offen offset:1024 sc1
Maaa 152,84,252
Ta 216,19,0
Ta 218,19,1024
Maaa 156,88,248
buffer_store_dwordx4 v[44:47], v2, s[24:27], s59 offen offset:1024 sc1
Maaa 156,92,252
Ta 220,19,8192
s_waitcnt lgkmcnt(9)
Ta 222,19,9216
Maaa 160,96,248
Maaa 160,100,252
Maaa 164,104,248
buffer_load_dwordx4 a[60:63], v11, s[20:23], s52 offen offset:1024 sc1
Maaa 164,108,252
s_xor_b32 s52, s52, 6144
s_add_u32 s53, s52, s58
Maaa 168,112,248
Maaa 168,116,252
Maaa 172,120,248
Maaa 172,124,252
s_branch L_phase2
L_k1_vpath:
Zvaa 48,224,0
v_and_b32_e64 v46, 7, v0
v_mul_u32_u24 v30, 2064, v46
Mvaa 48,228,4
s_add_u32 m0, s57, 65536
Zvaa 52,232,0
buffer_load_dwordx4 v6, s[12:15], s52 offen offset:0 lds
Mvaa 52,236,4
Ra 240,10,4096
Zvaa 56,224,8
buffer_load_dwordx4 v7, s[12:15], s53 offen offset:1024 lds
Mvaa 56,228,12
v_lshrrev_b32_e64 v31, 3, v0
Zvaa 60,232,8
buffer_load_dwordx4 v6, s[12:15], s54 offen offset:2048 lds
Mvaa 60,236,12
Ra 244,11,4096
Zvaa 64,224,16
buffer_load_dwordx4 v7, s[12:15], s55 offen offset:3072 lds
Mvaa 64,228,20
s_add_u32 m0, s57, 69632
Zvaa 68,232,16
buffer_load_dwordx4 v8, s[12:15], s52 offen offset:0 lds
Mvaa 68,236,20
Ra 248,10,6144
Zvaa 72,224,24
buffer_load_dwordx4 v9, s[12:15], s53 offen offset:1024 lds
Mvaa 72,228,28
s_lshl_b32 s3, s32, 9
s_add_u32 s3, s3, 131072
v_lshl_add_u32 v30, v31, 4, v30
Zvaa 76,232,24
buffer_load_dwordx4 v8, s[12:15], s54 offen offset:2048 lds
Mvaa 76,236,28
s_waitcnt lgkmcnt(9)
Ra 252,11,6144
Zvaa 80,224,32
buffer_load_dwordx4 v9, s[12:15], s55 offen offset:3072 lds
Mvaa 80,228,36
s_add_u32 m0, s56, 65536
v_xor_b32 v6, 1572864, v6
v_xor_b32 v7, 1572864, v7
Zvaa 84,232,32
buffer_load_dwordx4 v2, s[8:11], s48 offen offset:0 lds
Mvaa 84,236,36
v_xor_b32 v8, 1572864, v8
v_xor_b32 v9, 1572864, v9
Zvaa 88,224,40
buffer_load_dwordx4 v3, s[8:11], s49 offen offset:1024 lds
Mvaa 88,228,44
v_add_u32 v30, s3, v30
v_lshlrev_b32 v31, 8, v31
Zvaa 92,232,40
buffer_load_dwordx4 v2, s[8:11], s50 offen offset:2048 lds
Mvaa 92,236,44
v_lshl_add_u32 v46, v46, 4, v31
s_waitcnt lgkmcnt(8)
Zvaa 96,224,48
buffer_load_dwordx4 v3, s[8:11], s51 offen offset:3072 lds
Mvaa 96,228,52
s_add_u32 m0, s56, 69632
Zvaa 100,232,48
buffer_load_dwordx4 v4, s[8:11], s48 offen offset:0 lds
Mvaa 100,236,52
Rv 34,30,128
Rv 38,30,256
s_waitcnt lgkmcnt(6)
Zvaa 104,224,56
buffer_load_dwordx4 v5, s[8:11], s49 offen offset:1024 lds
Mvaa 104,228,60
Rv 42,30,384
Rv 30,30,0
Zvaa 108,232,56
s_waitcnt lgkmcnt(4)
buffer_load_dwordx4 v4, s[8:11], s50 offen offset:2048 lds
Mvaa 108,236,60
s_lshr_b32 s3, s2, 1
s_mul_i32 s3, s3, 33792
s_add_u32 s3, s3, s57
Zvaa 112,240,0
buffer_load_dwordx4 v5, s[8:11], s51 offen offset:3072 lds
Mvaa 112,244,4
v_xor_b32 v2, 384, v2
v_xor_b32 v3, 384, v3
Zvaa 116,248,0
s_and_b32 s39, s2, 1
s_lshl_b32 s39, s39, 7
s_add_u32 s3, s3, s39
Mvaa 116,252,4
Ra 224,10,8192
v_xor_b32 v4, 384, v4
Zvaa 120,240,8
s_add_u32 s39, s3, 4096
Mvaa 120,244,12
v_xor_b32 v5, 384, v5
Zvaa 124,248,8
Mvaa 124,252,12
Ra 228,11,8192
Zvaa 128,240,16
Mvaa 128,244,20
Zvaa 132,248,16
Mvaa 132,252,20
Ra 232,10,10240
Zvaa 136,240,24
buffer_load_dword v1, v47, s[60:63], 0 offen
Mvaa 136,244,28
s_mul_i32 vcc_lo, s59, 1
v_xor_b32 v47, vcc_lo, v47
Zvaa 140,248,24
Mvaa 140,252,28
Ra 236,11,10240
Zvaa 144,240,32
Mvaa 144,244,36
Zvaa 148,248,32
Mvaa 148,252,36
Zvaa 152,240,40
Mvaa 152,244,44
Zvaa 156,248,40
Mvaa 156,252,44
Zvaa 160,240,48
Mvaa 160,244,52
Zvaa 164,248,48
Mvaa 164,252,52
Zvaa 168,240,56
Mvaa 168,244,60
s_waitcnt vmcnt(9)
Zvaa 172,248,56
s_waitcnt lgkmcnt(0)
s_barrier
Mvaa 172,252,60
s_add_u32 m0, s57, 0
Zvaa 176,224,0
buffer_load_dwordx4 v6, s[12:15], s52 offen offset:0 lds
Mvaa 176,228,4
Ta 64,14,0
Ta 66,14,2048
Zvaa 180,232,0
Mvaa 180,236,4
Ra 240,10,12288
Zvaa 184,224,8
buffer_load_dwordx4 v7, s[12:15], s53 offen offset:1024 lds
Mvaa 184,228,12
Ta 68,14,16384
Ta 70,14,18432
Zvaa 188,232,8
Mvaa 188,236,12
Ra 244,11,12288
Zvaa 192,224,16
buffer_load_dwordx4 v6, s[12:15], s54 offen offset:2048 lds
Mvaa 192,228,20
Ta 72,15,0
Ta 74,15,2048
Zvaa 196,232,16
Mvaa 196,236,20
Ra 248,10,14336
Zvaa 200,224,24
buffer_load_dwordx4 v7, s[12:15], s55 offen offset:3072 lds
Mvaa 200,228,28
Ta 76,15,16384
Ta 78,15,18432
Zvaa 204,232,24
Mvaa 204,236,28
s_add_u32 m0, s57, 4096
Ra 252,11,14336
Zvaa 208,224,32
buffer_load_dwordx4 v8, s[12:15], s52 offen offset:0 lds
Mvaa 208,228,36
Zvaa 212,232,32
Mvaa 212,236,36
Ta 80,24,0
Ta 82,24,2048
Zvaa 216,224,40
buffer_load_dwordx4 v9, s[12:15], s53 offen offset:1024 lds
Mvaa 216,228,44
Ta 84,24,16384
s_waitcnt lgkmcnt(9)
Ta 86,24,18432
Zvaa 220,232,40
Mvaa 220,236,44
Ta 88,25,0
Ta 90,25,2048
Zvaa 224,224,48
buffer_load_dwordx4 v8, s[12:15], s54 offen offset:2048 lds
Mvaa 224,228,52
Zvaa 228,232,48
Mvaa 228,236,52
Ta 92,25,16384
Ta 94,25,18432
Zvaa 232,224,56
buffer_load_dwordx4 v9, s[12:15], s55 offen offset:3072 lds
Mvaa 232,228,60
s_waitcnt vmcnt(9)
Ta 96,26,0
s_waitcnt lgkmcnt(9)
Ta 98,26,2048
Zvaa 236,232,56
s_barrier
v_xor_b32 v6, 524288, v6
v_xor_b32 v7, 524288, v7
Mvaa 236,236,60
s_add_u32 m0, s56, 0
Ta 100,26,16384
Ta 102,26,18432
Zvaa 240,240,0
buffer_load_dwordx4 v2, s[8:11], s48 offen offset:0 lds
Mvaa 240,244,4
v_xor_b32 v8, 524288, v8
v_xor_b32 v9, 524288, v9
Zvaa 244,248,0
Mvaa 244,252,4
Ra 224,12,0
Zvaa 248,240,8
buffer_load_dwordx4 v3, s[8:11], s49 offen offset:1024 lds
Mvaa 248,244,12
Ta 104,27,0
Ta 106,27,2048
Zvaa 252,248,8
Mvaa 252,252,12
s_waitcnt lgkmcnt(9)
Ra 228,13,0
Zaaa 128,240,16
buffer_load_dwordx4 v2, s[8:11], s50 offen offset:2048 lds
Maaa 128,244,20
Ta 108,27,16384
Ta 110,27,18432
Zaaa 132,248,16
Maaa 132,252,20
Ra 232,12,2048
Zaaa 136,240,24
buffer_load_dwordx4 v3, s[8:11], s51 offen offset:3072 lds
Maaa 136,244,28
Ta 112,28,0
Ta 114,28,2048
Zaaa 140,248,24
Maaa 140,252,28
s_add_u32 m0, s56, 4096
s_waitcnt lgkmcnt(9)
Ra 236,13,2048
Zaaa 144,240,32
buffer_load_dwordx4 v4, s[8:11], s48 offen offset:0 lds
Maaa 144,244,36
Zaaa 148,248,32
Maaa 148,252,36
Ta 116,28,16384
Ta 118,28,18432
Zaaa 152,240,40
buffer_load_dwordx4 v5, s[8:11], s49 offen offset:1024 lds
Maaa 152,244,44
Ta 120,29,0
Ta 122,29,2048
Zaaa 156,248,40
Maaa 156,252,44
Ta 124,29,16384
s_waitcnt lgkmcnt(9)
Ta 126,29,18432
Zaaa 160,240,48
buffer_load_dwordx4 v4, s[8:11], s50 offen offset:2048 lds
Maaa 160,244,52
Zaaa 164,248,48
Maaa 164,252,52
Zaaa 168,240,56
buffer_load_dwordx4 v5, s[8:11], s51 offen offset:3072 lds
Maaa 168,244,60
v_xor_b32 v2, 128, v2
v_xor_b32 v3, 128, v3
Zaaa 172,248,56
s_waitcnt lgkmcnt(6)
buffer_load_dword v1, v47, s[60:63], 0 offen
v_xor_b32 v4, 128, v4
v_xor_b32 v5, 128, v5
Maaa 172,252,60
s_waitcnt lgkmcnt(0)
s_mul_i32 vcc_lo, s59, 7
v_xor_b32 v47, vcc_lo, v47
Mvaa 48,224,64
buffer_store_dwordx4 v[30:33], v46, s[20:23], s3 offen offset:0 sc1
Mvaa 48,228,68
buffer_store_dwordx4 v[34:37], v46, s[20:23], s3 offen offset:2048 sc1
Mvaa 52,232,64
buffer_store_dwordx4 v[38:41], v46, s[20:23], s39 offen offset:0 sc1
Mvaa 52,236,68
Ra 240,12,4096
Mvaa 56,224,72
buffer_store_dwordx4 v[42:45], v46, s[20:23], s39 offen offset:2048 sc1
Mvaa 56,228,76
s_lshl_b32 s3, s34, 1
s_and_b32 s36, s32, 1
s_add_u32 s3, s3, s36
Mvaa 60,232,72
s_mul_i32 s3, s3, 1116160
s_mul_i32 s36, s33, 139264
s_add_u32 s3, s3, s36
Mvaa 60,236,76
Ra 244,13,4096
Mvaa 64,224,80
s_lshr_b32 s36, s32, 1
s_mul_i32 s36, s36, 69632
s_add_u32 s3, s3, s36
Mvaa 64,228,84
s_add_u32 s38, s3, 17408
s_lshl_b32 s39, s34, 7
s_lshl_b32 s36, s33, 2
Mvaa 68,232,80
s_add_u32 s39, s39, s36
s_add_u32 s39, s39, 5296160
v_mov_b32 v30, 1
Mvaa 68,236,84
Ra 248,12,6144
Mvaa 72,224,88
v_mov_b32_e64 v31, 0
Mvaa 72,228,92
s_cmp_eq_u32 s32, 0
s_cselect_b32 s39, s39, 2146435072
Mvaa 76,232,88
s_mov_b64 exec, 1
buffer_store_dword v31, v31, s[20:23], s39 offen sc1
s_mov_b64 exec, -1
Mvaa 76,236,92
Ra 252,13,6144
Mvaa 80,224,96
s_and_b32 s33, s2, 7
s_lshl_b32 s33, s33, 2
s_bfe_u32 s3, s2, 0x20003
Mvaa 80,228,100
s_add_u32 s33, s33, s3
s_lshr_b32 s34, s2, 5
s_lshl_b32 s64, s34, 7
Mvaa 84,232,96
s_lshl_b32 s3, s33, 2
s_add_u32 s64, s64, s3
s_add_u32 s64, s64, 5300224
Mvaa 84,236,100
s_lshl_b32 s65, s34, 8
s_sub_u32 s65, 1920, s65
v_mul_u32_u24 v32, s65, v0
Mvaa 88,224,104
s_cmp_eq_u32 s32, 0
s_cselect_b32 s64, s64, 2146435072
Mvaa 88,228,108
s_mov_b64 exec, 3
buffer_store_dword v31, v32, s[20:23], s64 offen sc1
s_mov_b64 exec, -1
Mvaa 92,232,104
s_lshl_b32 s3, s2, 2
s_add_u32 s3, s3, 5447680
v_lshlrev_b32_e64 v32, 10, v0
Mvaa 92,236,108
s_cmp_eq_u32 s32, 0
s_cselect_b32 s3, s3, 2146435072
Mvaa 96,224,112
s_mov_b64 exec, 0x1ff
buffer_store_dword v31, v32, s[20:23], s3 offen sc1
s_mov_b64 exec, -1
Mvaa 96,228,116
s_lshl_b32 s35, s34, 1
s_sub_u32 s36, 32, s35
s_add_u32 s35, s35, 2
Mvaa 100,232,112
s_lshl_b32 s44, s32, 12
s_lshl_b32 s58, s32, 1
s_sub_u32 s58, 7, s58
Mvaa 100,236,116
s_mul_i32 s58, s58, 33792
s_sub_u32 s3, 15, s34
s_lshl_b32 s45, s3, 3
Mvaa 104,224,120
s_add_u32 s45, s45, s32
s_lshl_b32 s46, s34, 3
s_add_u32 s46, s46, s32
Mvaa 104,228,124
s_mov_b32 s68, s42
s_and_b32 s69, s43, 0xffff
s_mov_b32 s70, 7340032
Mvaa 108,232,120
s_waitcnt lgkmcnt(0)
Mvaa 108,236,124
s_mov_b32 s71, 0x20000
s_cmp_eq_u32 s32, 0
s_cselect_b32 s37, 0, 2146435072
Mvaa 112,240,64
s_lshl_b32 s3, s33, 8
s_add_u32 s16, s4, s3
s_addc_u32 s17, s5, 0
s_and_b32 s17, s17, 0xffff
Mvaa 112,244,68
s_mov_b32 s18, 0
s_mov_b32 s19, 0x20000
s_sub_u32 s18, 8388608, s3
Mvaa 116,248,64
v_and_b32 v33, 15, v0
v_lshrrev_b32 v32, 1, v33
Mvaa 116,252,68
Ra 224,12,8192
Mvaa 120,240,72
v_and_b32 v33, 1, v0
v_lshlrev_b32 v32, 13, v32
Mvaa 120,244,76
v_lshl_add_u32 v45, v33, 7, v32
Mvaa 124,248,72
s_lshl_b32 s3, s32, 3
s_add_u32 s3, s3, s34
s_mul_i32 s47, s3, 65536
Mvaa 124,252,76
Ra 228,13,8192
Mvaa 128,240,80
s_bfe_u32 s6, s2, 131075
s_lshl_b32 s3, s32, 8
s_or_b32 s6, s6, s3
Mvaa 128,244,84
Mvaa 132,248,80
Mvaa 132,252,84
Ra 232,12,10240
Mvaa 136,240,88
Mvaa 136,244,92
Mvaa 140,248,88
Mvaa 140,252,92
Ra 236,13,10240
Mvaa 144,240,96
Mvaa 144,244,100
Mvaa 148,248,96
Mvaa 148,252,100
Mvaa 152,240,104
Mvaa 152,244,108
Mvaa 156,248,104
Mvaa 156,252,108
Mvaa 160,240,112
Mvaa 160,244,116
Mvaa 164,248,112
Mvaa 164,252,116
Mvaa 168,240,120
Mvaa 168,244,124
s_waitcnt vmcnt(16)
Mvaa 172,248,120
s_waitcnt lgkmcnt(0)
s_barrier
Mvaa 172,252,124
s_add_u32 m0, s57, 65536
Mvaa 176,224,64
buffer_load_dwordx4 v6, s[12:15], s52 offen offset:0 lds
Mvaa 176,228,68
Ta 0,16,0
Ta 2,16,2048
Mvaa 180,232,64
Mvaa 180,236,68
Ra 240,12,12288
Mvaa 184,224,72
buffer_load_dwordx4 v7, s[12:15], s53 offen offset:1024 lds
Mvaa 184,228,76
Ta 4,16,16384
Ta 6,16,18432
Mvaa 188,232,72
Mvaa 188,236,76
Ra 244,13,12288
Mvaa 192,224,80
buffer_load_dwordx4 v6, s[12:15], s54 offen offset:2048 lds
Mvaa 192,228,84
Ta 8,17,0
Ta 10,17,2048
Mvaa 196,232,80
Mvaa 196,236,84
Ra 248,12,14336
Mvaa 200,224,88
buffer_load_dwordx4 v7, s[12:15], s55 offen offset:3072 lds
Mvaa 200,228,92
Ta 12,17,16384
Ta 14,17,18432
Mvaa 204,232,88
Mvaa 204,236,92
s_add_u32 m0, s57, 69632
Ra 252,13,14336
Mvaa 208,224,96
buffer_load_dwordx4 v8, s[12:15], s52 offen offset:0 lds
Mvaa 208,228,100
Mvaa 212,232,96
Mvaa 212,236,100
Ta 16,18,0
Ta 18,18,2048
Mvaa 216,224,104
buffer_load_dwordx4 v9, s[12:15], s53 offen offset:1024 lds
Mvaa 216,228,108
Ta 20,18,16384
s_waitcnt lgkmcnt(9)
Ta 22,18,18432
Mvaa 220,232,104
Mvaa 220,236,108
Ta 24,19,0
Ta 26,19,2048
Mvaa 224,224,112
buffer_load_dwordx4 v8, s[12:15], s54 offen offset:2048 lds
Mvaa 224,228,116
Mvaa 228,232,112
Mvaa 228,236,116
Ta 28,19,16384
Ta 30,19,18432
Mvaa 232,224,120
buffer_load_dwordx4 v9, s[12:15], s55 offen offset:3072 lds
Mvaa 232,228,124
s_waitcnt vmcnt(16)
Ta 32,20,0
s_waitcnt lgkmcnt(9)
Ta 34,20,2048
Mvaa 236,232,120
s_barrier
v_xor_b32 v6, 3670016, v6
v_xor_b32 v7, 3670016, v7
Mvaa 236,236,124
s_add_u32 m0, s56, 65536
Ta 36,20,16384
Ta 38,20,18432
Mvaa 240,240,64
buffer_load_dwordx4 v2, s[8:11], s48 offen offset:0 lds
Mvaa 240,244,68
v_xor_b32 v8, 3670016, v8
v_xor_b32 v9, 3670016, v9
Mvaa 244,248,64
Mvaa 244,252,68
Ra 224,10,0
Mvaa 248,240,72
buffer_load_dwordx4 v3, s[8:11], s49 offen offset:1024 lds
Mvaa 248,244,76
Ta 40,21,0
Ta 42,21,2048
Mvaa 252,248,72
Mvaa 252,252,76
s_waitcnt lgkmcnt(9)
Ra 228,11,0
Maaa 128,240,80
buffer_load_dwordx4 v2, s[8:11], s50 offen offset:2048 lds
Maaa 128,244,84
Ta 44,21,16384
Ta 46,21,18432
Maaa 132,248,80
Maaa 132,252,84
Ra 232,10,2048
Maaa 136,240,88
buffer_load_dwordx4 v3, s[8:11], s51 offen offset:3072 lds
Maaa 136,244,92
Ta 48,22,0
Ta 50,22,2048
Maaa 140,248,88
Maaa 140,252,92
s_add_u32 m0, s56, 69632
s_waitcnt lgkmcnt(9)
Ra 236,11,2048
Maaa 144,240,96
buffer_load_dwordx4 v4, s[8:11], s48 offen offset:0 lds
Maaa 144,244,100
Maaa 148,248,96
Maaa 148,252,100
Ta 52,22,16384
Ta 54,22,18432
Maaa 152,240,104
buffer_load_dwordx4 v5, s[8:11], s49 offen offset:1024 lds
Maaa 152,244,108
Ta 56,23,0
Ta 58,23,2048
Maaa 156,248,104
Maaa 156,252,108
Ta 60,23,16384
s_waitcnt lgkmcnt(9)
Ta 62,23,18432
Maaa 160,240,112
buffer_load_dwordx4 v4, s[8:11], s50 offen offset:2048 lds
Maaa 160,244,116
Maaa 164,248,112
Maaa 164,252,116
Maaa 168,240,120
buffer_load_dwordx4 v5, s[8:11], s51 offen offset:3072 lds
Maaa 168,244,124
v_xor_b32 v2, 896, v2
v_xor_b32 v3, 896, v3
Maaa 172,248,120
s_waitcnt lgkmcnt(6)
buffer_load_dword v1, v47, s[60:63], 0 offen
v_xor_b32 v4, 896, v4
v_xor_b32 v5, 896, v5
Maaa 172,252,124
s_waitcnt lgkmcnt(0)
s_mul_i32 vcc_lo, s59, 1
v_xor_b32 v47, vcc_lo, v47
Mvaa 48,224,0
Mvaa 48,228,4
Mvaa 52,232,0
Mvaa 52,236,4
Ra 240,10,4096
Mvaa 56,224,8
Mvaa 56,228,12
Mvaa 60,232,8
Mvaa 60,236,12
Ra 244,11,4096
Mvaa 64,224,16
Mvaa 64,228,20
Mvaa 68,232,16
Mvaa 68,236,20
Ra 248,10,6144
Mvaa 72,224,24
Mvaa 72,228,28
Mvaa 76,232,24
Mvaa 76,236,28
Ra 252,11,6144
Mvaa 80,224,32
Mvaa 80,228,36
Mvaa 84,232,32
Mvaa 84,236,36
Mvaa 88,224,40
Mvaa 88,228,44
Mvaa 92,232,40
Mvaa 92,236,44
Mvaa 96,224,48
Mvaa 96,228,52
Mvaa 100,232,48
Mvaa 100,236,52
Mvaa 104,224,56
Mvaa 104,228,60
Mvaa 108,232,56
s_waitcnt lgkmcnt(0)
Mvaa 108,236,60
Mvaa 112,240,0
Mvaa 112,244,4
Mvaa 116,248,0
Mvaa 116,252,4
Ra 224,10,8192
Mvaa 120,240,8
Mvaa 120,244,12
Mvaa 124,248,8
Mvaa 124,252,12
Ra 228,11,8192
Mvaa 128,240,16
Mvaa 128,244,20
Mvaa 132,248,16
Mvaa 132,252,20
Ra 232,10,10240
Mvaa 136,240,24
Mvaa 136,244,28
Mvaa 140,248,24
Mvaa 140,252,28
Ra 236,11,10240
Mvaa 144,240,32
Mvaa 144,244,36
Mvaa 148,248,32
Mvaa 148,252,36
Mvaa 152,240,40
Mvaa 152,244,44
Mvaa 156,248,40
Mvaa 156,252,44
Mvaa 160,240,48
Mvaa 160,244,52
Mvaa 164,248,48
Mvaa 164,252,52
Mvaa 168,240,56
Mvaa 168,244,60
s_waitcnt vmcnt(9)
Mvaa 172,248,56
s_waitcnt lgkmcnt(0)
s_barrier
Mvaa 172,252,60
s_add_u32 m0, s57, 0
Mvaa 176,224,0
buffer_load_dwordx4 v6, s[12:15], s52 offen offset:0 lds
Mvaa 176,228,4
Ta 64,14,0
Ta 66,14,2048
Mvaa 180,232,0
Mvaa 180,236,4
Ra 240,10,12288
Mvaa 184,224,8
buffer_load_dwordx4 v7, s[12:15], s53 offen offset:1024 lds
Mvaa 184,228,12
Ta 68,14,16384
Ta 70,14,18432
Mvaa 188,232,8
Mvaa 188,236,12
Ra 244,11,12288
Mvaa 192,224,16
buffer_load_dwordx4 v6, s[12:15], s54 offen offset:2048 lds
Mvaa 192,228,20
Ta 72,15,0
Ta 74,15,2048
Mvaa 196,232,16
Mvaa 196,236,20
Ra 248,10,14336
Mvaa 200,224,24
buffer_load_dwordx4 v7, s[12:15], s55 offen offset:3072 lds
Mvaa 200,228,28
Ta 76,15,16384
Ta 78,15,18432
Mvaa 204,232,24
s_cmp_eq_u32 s6, 0
s_cselect_b32 s3, 0, 2146435072
Mvaa 204,236,28
s_add_u32 m0, s57, 4096
Ra 252,11,14336
Mvaa 208,224,32
buffer_load_dwordx4 v8, s[12:15], s52 offen offset:0 lds
Mvaa 208,228,36
s_mov_b64 exec, 1
buffer_atomic_add v30, v31, s[28:31], s3 offen sc1
s_mov_b64 exec, -1
Mvaa 212,232,32
Mvaa 212,236,36
Ta 80,24,0
Ta 82,24,2048
Mvaa 216,224,40
buffer_load_dwordx4 v9, s[12:15], s53 offen offset:1024 lds
Mvaa 216,228,44
Ta 84,24,16384
s_waitcnt lgkmcnt(9)
Ta 86,24,18432
Mvaa 220,232,40
Mvaa 220,236,44
Ta 88,25,0
Ta 90,25,2048
Mvaa 224,224,48
buffer_load_dwordx4 v8, s[12:15], s54 offen offset:2048 lds
Mvaa 224,228,52
Mvaa 228,232,48
Mvaa 228,236,52
Ta 92,25,16384
Ta 94,25,18432
Mvaa 232,224,56
buffer_load_dwordx4 v9, s[12:15], s55 offen offset:3072 lds
Mvaa 232,228,60
s_waitcnt vmcnt(10)
Ta 96,26,0
s_waitcnt lgkmcnt(9)
Ta 98,26,2048
Mvaa 236,232,56
s_barrier
v_xor_b32 v6, 524288, v6
v_xor_b32 v7, 524288, v7
Mvaa 236,236,60
s_add_u32 m0, s56, 0
Ta 100,26,16384
Ta 102,26,18432
Mvaa 240,240,0
buffer_load_dwordx4 v2, s[8:11], s48 offen offset:0 lds
Mvaa 240,244,4
v_xor_b32 v8, 524288, v8
v_xor_b32 v9, 524288, v9
Mvaa 244,248,0
Mvaa 244,252,4
Ra 224,12,0
Mvaa 248,240,8
buffer_load_dwordx4 v3, s[8:11], s49 offen offset:1024 lds
Mvaa 248,244,12
Ta 104,27,0
Ta 106,27,2048
Mvaa 252,248,8
Mvaa 252,252,12
s_waitcnt lgkmcnt(9)
Ra 228,13,0
Maaa 128,240,16
buffer_load_dwordx4 v2, s[8:11], s50 offen offset:2048 lds
Maaa 128,244,20
Ta 108,27,16384
Ta 110,27,18432
Maaa 132,248,16
Maaa 132,252,20
Ra 232,12,2048
Maaa 136,240,24
buffer_load_dwordx4 v3, s[8:11], s51 offen offset:3072 lds
Maaa 136,244,28
Ta 112,28,0
Ta 114,28,2048
Maaa 140,248,24
Maaa 140,252,28
s_add_u32 m0, s56, 4096
s_waitcnt lgkmcnt(9)
Ra 236,13,2048
Maaa 144,240,32
buffer_load_dwordx4 v4, s[8:11], s48 offen offset:0 lds
Maaa 144,244,36
Maaa 148,248,32
Maaa 148,252,36
Ta 116,28,16384
Ta 118,28,18432
Maaa 152,240,40
buffer_load_dwordx4 v5, s[8:11], s49 offen offset:1024 lds
Maaa 152,244,44
Ta 120,29,0
Ta 122,29,2048
Maaa 156,248,40
Maaa 156,252,44
Ta 124,29,16384
s_waitcnt lgkmcnt(9)
Ta 126,29,18432
Maaa 160,240,48
buffer_load_dwordx4 v4, s[8:11], s50 offen offset:2048 lds
Maaa 160,244,52
Maaa 164,248,48
Maaa 164,252,52
Maaa 168,240,56
buffer_load_dwordx4 v5, s[8:11], s51 offen offset:3072 lds
Maaa 168,244,60
v_xor_b32 v2, 128, v2
v_xor_b32 v3, 128, v3
Maaa 172,248,56
s_waitcnt lgkmcnt(6)
buffer_load_dword v1, v47, s[60:63], 0 offen
v_xor_b32 v4, 128, v4
v_xor_b32 v5, 128, v5
Maaa 172,252,60
s_waitcnt lgkmcnt(0)
s_mul_i32 vcc_lo, s59, 3
v_xor_b32 v47, vcc_lo, v47
Mvaa 48,224,64
buffer_load_dword v44, v45, s[16:19], s47 offen
Mvaa 48,228,68
s_add_u32 s47, s47, 2097152
Mvaa 52,232,64
Mvaa 52,236,68
Ra 240,12,4096
Mvaa 56,224,72
Mvaa 56,228,76
Mvaa 60,232,72
Mvaa 60,236,76
Ra 244,13,4096
Mvaa 64,224,80
Mvaa 64,228,84
Mvaa 68,232,80
Mvaa 68,236,84
Ra 248,12,6144
Mvaa 72,224,88
Mvaa 72,228,92
Mvaa 76,232,88
Mvaa 76,236,92
Ra 252,13,6144
Mvaa 80,224,96
Mvaa 80,228,100
Mvaa 84,232,96
Mvaa 84,236,100
Mvaa 88,224,104
Mvaa 88,228,108
Mvaa 92,232,104
Mvaa 92,236,108
Mvaa 96,224,112
Mvaa 96,228,116
Mvaa 100,232,112
s_cmp_eq_u32 s6, 1
s_cselect_b32 s3, 0, 2146435072
Mvaa 100,236,116
s_mov_b64 exec, 1
buffer_atomic_add v30, v31, s[28:31], s3 offen sc1
s_mov_b64 exec, -1
Mvaa 104,224,120
Mvaa 104,228,124
Mvaa 108,232,120
s_waitcnt lgkmcnt(0)
Mvaa 108,236,124
Mvaa 112,240,64
Mvaa 112,244,68
Mvaa 116,248,64
Mvaa 116,252,68
Ra 224,12,8192
Mvaa 120,240,72
Mvaa 120,244,76
Mvaa 124,248,72
Mvaa 124,252,76
Ra 228,13,8192
Mvaa 128,240,80
Mvaa 128,244,84
Mvaa 132,248,80
Mvaa 132,252,84
Ra 232,12,10240
Mvaa 136,240,88
Mvaa 136,244,92
Mvaa 140,248,88
Mvaa 140,252,92
Ra 236,13,10240
Mvaa 144,240,96
Mvaa 144,244,100
Mvaa 148,248,96
Mvaa 148,252,100
Mvaa 152,240,104
Mvaa 152,244,108
Mvaa 156,248,104
Mvaa 156,252,108
Mvaa 160,240,112
Mvaa 160,244,116
Mvaa 164,248,112
Mvaa 164,252,116
Mvaa 168,240,120
Mvaa 168,244,124
s_waitcnt vmcnt(11)
Mvaa 172,248,120
s_waitcnt lgkmcnt(0)
s_barrier
Mvaa 172,252,124
s_add_u32 m0, s57, 65536
Mvaa 176,224,64
buffer_load_dwordx4 v6, s[12:15], s52 offen offset:0 lds
Mvaa 176,228,68
Ta 0,16,0
Ta 2,16,2048
Mvaa 180,232,64
Mvaa 180,236,68
Ra 240,12,12288
Mvaa 184,224,72
buffer_load_dwordx4 v7, s[12:15], s53 offen offset:1024 lds
Mvaa 184,228,76
Ta 4,16,16384
Ta 6,16,18432
Mvaa 188,232,72
Mvaa 188,236,76
Ra 244,13,12288
Mvaa 192,224,80
buffer_load_dwordx4 v6, s[12:15], s54 offen offset:2048 lds
Mvaa 192,228,84
Ta 8,17,0
Ta 10,17,2048
Mvaa 196,232,80
Mvaa 196,236,84
Ra 248,12,14336
Mvaa 200,224,88
buffer_load_dwordx4 v7, s[12:15], s55 offen offset:3072 lds
Mvaa 200,228,92
Ta 12,17,16384
Ta 14,17,18432
Mvaa 204,232,88
Mvaa 204,236,92
s_add_u32 m0, s57, 69632
Ra 252,13,14336
Mvaa 208,224,96
buffer_load_dwordx4 v8, s[12:15], s52 offen offset:0 lds
Mvaa 208,228,100
Mvaa 212,232,96
Mvaa 212,236,100
Ta 16,18,0
Ta 18,18,2048
Mvaa 216,224,104
buffer_load_dwordx4 v9, s[12:15], s53 offen offset:1024 lds
Mvaa 216,228,108
Ta 20,18,16384
s_waitcnt lgkmcnt(9)
Ta 22,18,18432
Mvaa 220,232,104
Mvaa 220,236,108
Ta 24,19,0
Ta 26,19,2048
Mvaa 224,224,112
buffer_load_dwordx4 v8, s[12:15], s54 offen offset:2048 lds
Mvaa 224,228,116
Mvaa 228,232,112
Mvaa 228,236,116
Ta 28,19,16384
Ta 30,19,18432
Mvaa 232,224,120
buffer_load_dwordx4 v9, s[12:15], s55 offen offset:3072 lds
Mvaa 232,228,124
s_waitcnt vmcnt(11)
Ta 32,20,0
s_waitcnt lgkmcnt(9)
Ta 34,20,2048
Mvaa 236,232,120
s_barrier
v_xor_b32 v6, 1572864, v6
v_xor_b32 v7, 1572864, v7
Mvaa 236,236,124
s_add_u32 m0, s56, 65536
Ta 36,20,16384
Ta 38,20,18432
Mvaa 240,240,64
buffer_load_dwordx4 v2, s[8:11], s48 offen offset:0 lds
Mvaa 240,244,68
v_xor_b32 v8, 1572864, v8
v_xor_b32 v9, 1572864, v9
Mvaa 244,248,64
Mvaa 244,252,68
Ra 224,10,0
Mvaa 248,240,72
buffer_load_dwordx4 v3, s[8:11], s49 offen offset:1024 lds
Mvaa 248,244,76
Ta 40,21,0
Ta 42,21,2048
Mvaa 252,248,72
Mvaa 252,252,76
s_waitcnt lgkmcnt(9)
Ra 228,11,0
Maaa 128,240,80
buffer_load_dwordx4 v2, s[8:11], s50 offen offset:2048 lds
Maaa 128,244,84
Ta 44,21,16384
Ta 46,21,18432
Maaa 132,248,80
s_cmp_eq_u32 s6, 2
s_cselect_b32 s3, 0, 2146435072
Maaa 132,252,84
Ra 232,10,2048
Maaa 136,240,88
buffer_load_dwordx4 v3, s[8:11], s51 offen offset:3072 lds
Maaa 136,244,92
Ta 48,22,0
Ta 50,22,2048
Maaa 140,248,88
s_mov_b64 exec, 1
buffer_atomic_add v30, v31, s[28:31], s3 offen sc1
s_mov_b64 exec, -1
Maaa 140,252,92
s_add_u32 m0, s56, 69632
s_waitcnt lgkmcnt(9)
Ra 236,11,2048
Maaa 144,240,96
buffer_load_dwordx4 v4, s[8:11], s48 offen offset:0 lds
Maaa 144,244,100
Maaa 148,248,96
Maaa 148,252,100
Ta 52,22,16384
Ta 54,22,18432
Maaa 152,240,104
buffer_load_dwordx4 v5, s[8:11], s49 offen offset:1024 lds
Maaa 152,244,108
Ta 56,23,0
Ta 58,23,2048
Maaa 156,248,104
Maaa 156,252,108
Ta 60,23,16384
s_waitcnt lgkmcnt(9)
Ta 62,23,18432
Maaa 160,240,112
buffer_load_dwordx4 v4, s[8:11], s50 offen offset:2048 lds
Maaa 160,244,116
Maaa 164,248,112
Maaa 164,252,116
Maaa 168,240,120
buffer_load_dwordx4 v5, s[8:11], s51 offen offset:3072 lds
Maaa 168,244,124
v_xor_b32 v2, 384, v2
v_xor_b32 v3, 384, v3
Maaa 172,248,120
s_waitcnt lgkmcnt(6)
buffer_load_dword v1, v47, s[60:63], 0 offen
v_xor_b32 v4, 384, v4
v_xor_b32 v5, 384, v5
Maaa 172,252,124
s_waitcnt lgkmcnt(0)
s_mul_i32 vcc_lo, s59, 1
v_xor_b32_e64 v47, vcc_lo, v47
Mvaa 48,224,0
buffer_load_dword v44, v45, s[16:19], s47 offen
Mvaa 48,228,4
s_add_u32 s47, s47, 2097152
Mvaa 52,232,0
Mvaa 52,236,4
Ra 240,10,4096
Mvaa 56,224,8
Mvaa 56,228,12
Mvaa 60,232,8
Mvaa 60,236,12
Ra 244,11,4096
Mvaa 64,224,16
Mvaa 64,228,20
Mvaa 68,232,16
Mvaa 68,236,20
Ra 248,10,6144
Mvaa 72,224,24
Mvaa 72,228,28
Mvaa 76,232,24
Mvaa 76,236,28
Ra 252,11,6144
Mvaa 80,224,32
Mvaa 80,228,36
Mvaa 84,232,32
Mvaa 84,236,36
Mvaa 88,224,40
Mvaa 88,228,44
Mvaa 92,232,40
Mvaa 92,236,44
Mvaa 96,224,48
Mvaa 96,228,52
Mvaa 100,232,48
Mvaa 100,236,52
Mvaa 104,224,56
Mvaa 104,228,60
Mvaa 108,232,56
s_waitcnt lgkmcnt(0)
Mvaa 108,236,60
Mvaa 112,240,0
Mvaa 112,244,4
Mvaa 116,248,0
Mvaa 116,252,4
Ra 224,10,8192
Mvaa 120,240,8
Mvaa 120,244,12
Mvaa 124,248,8
Mvaa 124,252,12
Ra 228,11,8192
Mvaa 128,240,16
Mvaa 128,244,20
Mvaa 132,248,16
Mvaa 132,252,20
Ra 232,10,10240
Mvaa 136,240,24
Mvaa 136,244,28
Mvaa 140,248,24
Mvaa 140,252,28
Ra 236,11,10240
Mvaa 144,240,32
Mvaa 144,244,36
Mvaa 148,248,32
Mvaa 148,252,36
Mvaa 152,240,40
s_cmp_eq_u32 s6, 3
s_cselect_b32 s3, 0, 2146435072
Mvaa 152,244,44
s_mov_b64 exec, 1
buffer_atomic_add v30, v31, s[28:31], s3 offen sc1
s_mov_b64 exec, -1
Mvaa 156,248,40
Mvaa 156,252,44
Mvaa 160,240,48
Mvaa 160,244,52
Mvaa 164,248,48
Mvaa 164,252,52
Mvaa 168,240,56
Mvaa 168,244,60
s_waitcnt vmcnt(12)
Mvaa 172,248,56
s_waitcnt lgkmcnt(0)
s_barrier
Mvaa 172,252,60
s_add_u32 m0, s57, 0
Mvaa 176,224,0
buffer_load_dwordx4 v6, s[12:15], s52 offen offset:0 lds
Mvaa 176,228,4
Ta 64,14,0
Ta 66,14,2048
Mvaa 180,232,0
Mvaa 180,236,4
Ra 240,10,12288
Mvaa 184,224,8
buffer_load_dwordx4 v7, s[12:15], s53 offen offset:1024 lds
Mvaa 184,228,12
Ta 68,14,16384
Ta 70,14,18432
Mvaa 188,232,8
Mvaa 188,236,12
Ra 244,11,12288
Mvaa 192,224,16
buffer_load_dwordx4 v6, s[12:15], s54 offen offset:2048 lds
Mvaa 192,228,20
Ta 72,15,0
Ta 74,15,2048
Mvaa 196,232,16
Mvaa 196,236,20
Ra 248,10,14336
Mvaa 200,224,24
buffer_load_dwordx4 v7, s[12:15], s55 offen offset:3072 lds
Mvaa 200,228,28
Ta 76,15,16384
Ta 78,15,18432
Mvaa 204,232,24
Mvaa 204,236,28
s_add_u32 m0, s57, 4096
Ra 252,11,14336
Mvaa 208,224,32
buffer_load_dwordx4 v8, s[12:15], s52 offen offset:0 lds
Mvaa 208,228,36
Mvaa 212,232,32
Mvaa 212,236,36
Ta 80,24,0
Ta 82,24,2048
Mvaa 216,224,40
buffer_load_dwordx4 v9, s[12:15], s53 offen offset:1024 lds
Mvaa 216,228,44
Ta 84,24,16384
s_waitcnt lgkmcnt(9)
Ta 86,24,18432
Mvaa 220,232,40
Mvaa 220,236,44
Ta 88,25,0
Ta 90,25,2048
Mvaa 224,224,48
buffer_load_dwordx4 v8, s[12:15], s54 offen offset:2048 lds
Mvaa 224,228,52
Mvaa 228,232,48
Mvaa 228,236,52
Ta 92,25,16384
Ta 94,25,18432
Mvaa 232,224,56
buffer_load_dwordx4 v9, s[12:15], s55 offen offset:3072 lds
Mvaa 232,228,60
s_waitcnt vmcnt(11)
Ta 96,26,0
s_waitcnt lgkmcnt(9)
Ta 98,26,2048
Mvaa 236,232,56
s_barrier
v_xor_b32 v6, 524288, v6
v_xor_b32 v7, 524288, v7
Mvaa 236,236,60
s_add_u32 m0, s56, 0
Ta 100,26,16384
Ta 102,26,18432
Mvaa 240,240,0
buffer_load_dwordx4 v2, s[8:11], s48 offen offset:0 lds
Mvaa 240,244,4
v_xor_b32 v8, 524288, v8
v_xor_b32 v9, 524288, v9
Mvaa 244,248,0
Mvaa 244,252,4
Ra 224,12,0
Mvaa 248,240,8
buffer_load_dwordx4 v3, s[8:11], s49 offen offset:1024 lds
Mvaa 248,244,12
Ta 104,27,0
Ta 106,27,2048
Mvaa 252,248,8
Mvaa 252,252,12
s_waitcnt lgkmcnt(9)
Ra 228,13,0
Maaa 128,240,16
buffer_load_dwordx4 v2, s[8:11], s50 offen offset:2048 lds
Maaa 128,244,20
Ta 108,27,16384
Ta 110,27,18432
Maaa 132,248,16
Maaa 132,252,20
Ra 232,12,2048
Maaa 136,240,24
buffer_load_dwordx4 v3, s[8:11], s51 offen offset:3072 lds
Maaa 136,244,28
Ta 112,28,0
Ta 114,28,2048
Maaa 140,248,24
Maaa 140,252,28
s_add_u32 m0, s56, 4096
s_waitcnt lgkmcnt(9)
Ra 236,13,2048
Maaa 144,240,32
buffer_load_dwordx4 v4, s[8:11], s48 offen offset:0 lds
Maaa 144,244,36
Maaa 148,248,32
Maaa 148,252,36
Ta 116,28,16384
Ta 118,28,18432
Maaa 152,240,40
buffer_load_dwordx4 v5, s[8:11], s49 offen offset:1024 lds
Maaa 152,244,44
Ta 120,29,0
Ta 122,29,2048
Maaa 156,248,40
Maaa 156,252,44
Ta 124,29,16384
s_waitcnt lgkmcnt(9)
Ta 126,29,18432
Maaa 160,240,48
buffer_load_dwordx4 v4, s[8:11], s50 offen offset:2048 lds
Maaa 160,244,52
Maaa 164,248,48
Maaa 164,252,52
Maaa 168,240,56
buffer_load_dwordx4 v5, s[8:11], s51 offen offset:3072 lds
Maaa 168,244,60
v_xor_b32 v2, 128, v2
v_xor_b32 v3, 128, v3
Maaa 172,248,56
s_waitcnt lgkmcnt(6)
buffer_load_dword v1, v47, s[60:63], 0 offen
v_xor_b32 v4, 128, v4
v_xor_b32 v5, 128, v5
Maaa 172,252,60
s_waitcnt lgkmcnt(0)
s_mul_i32 vcc_lo, s59, 7
v_xor_b32 v47, vcc_lo, v47
Mvaa 48,224,64
buffer_load_dword v44, v45, s[16:19], s47 offen
Mvaa 48,228,68
s_add_u32 s47, s47, 2097152
v_lshrrev_b32 v32, 4, v0
v_and_b32 v33, 15, v0
Mvaa 52,232,64
s_lshl_b32 s3, s32, 4
v_add_u32 v34, s3, v32
v_lshlrev_b32_e64 v36, 1, v32
Mvaa 52,236,68
Ra 240,12,4096
Mvaa 56,224,72
v_xor_b32 v36, v36, v33
v_xor_b32 v37, 8, v36
Mvaa 56,228,76
Mvaa 60,232,72
Mvaa 60,236,76
Ra 244,13,4096
Mvaa 64,224,80
s_getpc_b64 s[6:7]
L_cpf3:
s_add_u32 s6, s6, (L_phase2-L_cpf3)&0xffffffff
s_addc_u32 s7, s7, ((L_phase2-L_cpf3)>>32)&0xffffffff
Mvaa 64,228,84
s_lshr_b32 s3, s2, 3
s_lshl_b32 s3, s3, 2
s_add_u32 s3, s3, s32
Mvaa 68,232,80
s_lshl_b32 s3, s3, 10
v_and_b32 v42, 7, v0
v_lshlrev_b32_e64 v42, 7, v42
Mvaa 68,236,84
Ra 248,12,6144
Mvaa 72,224,88
v_add_u32_e64 v42, s3, v42
v_min_u32 v42, L_k2_fin-L_phase2-4, v42
Mvaa 72,228,92
v_mov_b32_e64 v41, s7
Mvaa 76,232,88
v_add_co_u32 v40, vcc, s6, v42
s_nop 1
v_addc_co_u32 v41, vcc, 0, v41, vcc
Mvaa 76,236,92
Ra 252,13,6144
Mvaa 80,224,96
global_load_dword v38, v[40:41], off
Mvaa 80,228,100
Mvaa 84,232,96
Mvaa 84,236,100
Mvaa 88,224,104
Mvaa 88,228,108
Mvaa 92,232,104
Mvaa 92,236,108
Mvaa 96,224,112
Mvaa 96,228,116
Mvaa 100,232,112
Mvaa 100,236,116
Mvaa 104,224,120
Mvaa 104,228,124
Mvaa 108,232,120
s_waitcnt lgkmcnt(0)
Mvaa 108,236,124
Mvaa 112,240,64
Mvaa 112,244,68
Mvaa 116,248,64
Mvaa 116,252,68
Ra 224,12,8192
Mvaa 120,240,72
Mvaa 120,244,76
Mvaa 124,248,72
Mvaa 124,252,76
Ra 228,13,8192
Mvaa 128,240,80
Mvaa 128,244,84
Mvaa 132,248,80
Mvaa 132,252,84
Ra 232,12,10240
Mvaa 136,240,88
Mvaa 136,244,92
Mvaa 140,248,88
Mvaa 140,252,92
Ra 236,13,10240
Mvaa 144,240,96
Mvaa 144,244,100
Mvaa 148,248,96
Mvaa 148,252,100
Mvaa 152,240,104
Mvaa 152,244,108
Mvaa 156,248,104
Mvaa 156,252,108
Mvaa 160,240,112
Mvaa 160,244,116
Mvaa 164,248,112
Mvaa 164,252,116
Mvaa 168,240,120
Mvaa 168,244,124
s_waitcnt vmcnt(11)
Mvaa 172,248,120
s_waitcnt lgkmcnt(0)
s_barrier
Mvaa 172,252,124
s_add_u32 m0, s57, 65536
Mvaa 176,224,64
buffer_load_dwordx4 v6, s[12:15], s52 offen offset:0 lds
Mvaa 176,228,68
Ta 0,16,0
Ta 2,16,2048
Mvaa 180,232,64
Mvaa 180,236,68
Ra 240,12,12288
Mvaa 184,224,72
buffer_load_dwordx4 v7, s[12:15], s53 offen offset:1024 lds
Mvaa 184,228,76
Ta 4,16,16384
Ta 6,16,18432
Mvaa 188,232,72
Mvaa 188,236,76
Ra 244,13,12288
Mvaa 192,224,80
buffer_load_dwordx4 v6, s[12:15], s54 offen offset:2048 lds
Mvaa 192,228,84
Ta 8,17,0
Ta 10,17,2048
Mvaa 196,232,80
Mvaa 196,236,84
Ra 248,12,14336
Mvaa 200,224,88
buffer_load_dwordx4 v7, s[12:15], s55 offen offset:3072 lds
Mvaa 200,228,92
Ta 12,17,16384
Ta 14,17,18432
Mvaa 204,232,88
Mvaa 204,236,92
s_add_u32 m0, s57, 69632
Ra 252,13,14336
Mvaa 208,224,96
buffer_load_dwordx4 v8, s[12:15], s52 offen offset:0 lds
Mvaa 208,228,100
Mvaa 212,232,96
Mvaa 212,236,100
Ta 16,18,0
Ta 18,18,2048
Mvaa 216,224,104
buffer_load_dwordx4 v9, s[12:15], s53 offen offset:1024 lds
Mvaa 216,228,108
Ta 20,18,16384
s_waitcnt lgkmcnt(9)
Ta 22,18,18432
Mvaa 220,232,104
Mvaa 220,236,108
Ta 24,19,0
Ta 26,19,2048
Mvaa 224,224,112
buffer_load_dwordx4 v8, s[12:15], s54 offen offset:2048 lds
Mvaa 224,228,116
Mvaa 228,232,112
Mvaa 228,236,116
Ta 28,19,16384
Ta 30,19,18432
Mvaa 232,224,120
buffer_load_dwordx4 v9, s[12:15], s55 offen offset:3072 lds
Mvaa 232,228,124
s_waitcnt vmcnt(11)
Ta 32,20,0
s_waitcnt lgkmcnt(9)
Ta 34,20,2048
Mvaa 236,232,120
s_barrier
Mvaa 236,236,124
s_add_u32 m0, s56, 65536
Ta 36,20,16384
Ta 38,20,18432
Mvaa 240,240,64
buffer_load_dwordx4 v2, s[8:11], s48 offen offset:0 lds
Mvaa 240,244,68
Mvaa 244,248,64
Mvaa 244,252,68
Ra 224,10,0
Mvaa 248,240,72
buffer_load_dwordx4 v3, s[8:11], s49 offen offset:1024 lds
Mvaa 248,244,76
Ta 40,21,0
Ta 42,21,2048
Mvaa 252,248,72
Mvaa 252,252,76
s_waitcnt lgkmcnt(9)
Ra 228,11,0
Maaa 128,240,80
buffer_load_dwordx4 v2, s[8:11], s50 offen offset:2048 lds
Maaa 128,244,84
Ta 44,21,16384
Ta 46,21,18432
Maaa 132,248,80
Maaa 132,252,84
Ra 232,10,2048
Maaa 136,240,88
buffer_load_dwordx4 v3, s[8:11], s51 offen offset:3072 lds
Maaa 136,244,92
Ta 48,22,0
Ta 50,22,2048
Maaa 140,248,88
Maaa 140,252,92
s_add_u32 m0, s56, 69632
s_waitcnt lgkmcnt(9)
Ra 236,11,2048
Maaa 144,240,96
buffer_load_dwordx4 v4, s[8:11], s48 offen offset:0 lds
Maaa 144,244,100
Maaa 148,248,96
Maaa 148,252,100
Ta 52,22,16384
Ta 54,22,18432
Maaa 152,240,104
buffer_load_dwordx4 v5, s[8:11], s49 offen offset:1024 lds
Maaa 152,244,108
Ta 56,23,0
Ta 58,23,2048
Maaa 156,248,104
Maaa 156,252,108
Ta 60,23,16384
s_waitcnt lgkmcnt(9)
Ta 62,23,18432
Maaa 160,240,112
buffer_load_dwordx4 v4, s[8:11], s50 offen offset:2048 lds
Maaa 160,244,116
Maaa 164,248,112
Maaa 164,252,116
Maaa 168,240,120
buffer_load_dwordx4 v5, s[8:11], s51 offen offset:3072 lds
Maaa 168,244,124
Maaa 172,248,120
s_waitcnt lgkmcnt(6)
Maaa 172,252,124
s_waitcnt lgkmcnt(0)
Mvaa 48,224,0
buffer_load_dword v1, v31, s[28:31], s37 offen sc1
Mvaa 48,228,4
s_mov_b32 s8, s16
s_mov_b32 s9, s17
s_mov_b32 s10, s18
Mvaa 52,232,0
s_add_u32 s16, s66, 46137344
s_addc_u32 s17, s67, 0
s_and_b32 s17, s17, 0xffff
Mvaa 52,236,4
Ra 240,10,4096
Mvaa 56,224,8
s_mov_b32 s18, 16777216
s_mov_b32 s19, 0x20000
s_mov_b32 s48, 0
Mvaa 56,228,12
s_mov_b32 s49, 31744
s_mov_b32 s50, 63488
s_mov_b32 s51, 95232
Mvaa 60,232,8
v_lshlrev_b32 v35, 13, v34
Mvaa 60,236,12
Ra 244,11,4096
Mvaa 64,224,16
s_and_b32 s52, s33, 0
s_lshl_b32 s3, s52, 19
s_lshl_b32 s52, s52, 11
Mvaa 64,228,20
s_add_u32 s53, s52, s58
v_add_u32_e64 v35, s3, v35
v_lshl_add_u32 v8, v36, 4, v35
Mvaa 68,232,16
v_lshl_add_u32 v9, v37, 4, v35
v_lshlrev_b32_e64 v2, 4, v0
Mvaa 68,236,20
Ra 248,10,6144
Mvaa 72,224,24
v_add_u32 v3, 65536, v2
v_add_u32_e64 v4, s44, v2
Mvaa 72,228,28
v_mov_b32 v7, 0
v_lshlrev_b32 v35, 2, v32
Mvaa 76,232,24
v_sub_u32_e64 v35, v33, v35
Mvaa 76,236,28
Ra 252,11,6144
Mvaa 80,224,32
s_lshl_b32 s3, s32, 4
v_add_u32 v5, s3, v35
Mvaa 80,228,36
s_sub_u32 s3, 48, s3
v_add_u32 v6, s3, v35
Mvaa 84,232,32
s_mul_i32 s3, s33, 1116160
s_add_u32 s3, s3, 8388608
s_add_u32 s12, s66, s3
s_addc_u32 s13, s67, 0
s_and_b32 s13, s13, 0xffff
Mvaa 84,236,36
s_mov_b32 s14, 0
s_mov_b32 s15, 0x20000
s_mul_i32 s14, s36, 34816
Mvaa 88,224,40
buffer_load_dword v44, v45, s[8:11], s47 offen
Mvaa 88,228,44
s_add_u32 s47, s47, 2097152
v_lshrrev_b32 v42, 2, v33
v_lshl_add_u32 v43, v32, 3, v42
Mvaa 92,232,40
v_lshlrev_b32 v43, 8, v43
v_and_b32 v46, 3, v0
Mvaa 92,236,44
v_lshl_add_u32 v43, v46, 3, v43
v_and_b32_e64 v46, 1, v32
Mvaa 96,224,48
v_lshl_add_u32 v42, v46, 2, v42
v_lshl_add_u32 v16, v42, 5, v43
Mvaa 96,228,52
v_xor_b32 v17, 32, v16
v_xor_b32 v18, 64, v16
Mvaa 100,232,48
v_xor_b32 v19, 96, v16
v_xor_b32 v20, 128, v16
Mvaa 100,236,52
v_xor_b32 v21, 160, v16
v_xor_b32 v22, 192, v16
Mvaa 104,224,56
v_xor_b32 v23, 224, v16
Mvaa 104,228,60
Mvaa 108,232,56
s_waitcnt lgkmcnt(0)
Mvaa 108,236,60
Mvaa 112,240,0
Mvaa 112,244,4
Mvaa 116,248,0
Mvaa 116,252,4
Ra 224,10,8192
Mvaa 120,240,8
Mvaa 120,244,12
Mvaa 124,248,8
Mvaa 124,252,12
Ra 228,11,8192
Mvaa 128,240,16
Mvaa 128,244,20
Mvaa 132,248,16
Mvaa 132,252,20
Ra 232,10,10240
Mvaa 136,240,24
Mvaa 136,244,28
Mvaa 140,248,24
Mvaa 140,252,28
Ra 236,11,10240
Mvaa 144,240,32
Mvaa 144,244,36
Mvaa 148,248,32
Mvaa 148,252,36
Mvaa 152,240,40
Mvaa 152,244,44
Mvaa 156,248,40
Mvaa 156,252,44
Mvaa 160,240,48
Mvaa 160,244,52
Mvaa 164,248,48
Mvaa 164,252,52
Mvaa 168,240,56
Mvaa 168,244,60
s_waitcnt vmcnt(10)
Mvaa 172,248,56
s_waitcnt lgkmcnt(0)
s_barrier
Mvaa 172,252,60
s_add_u32 m0, s44, 0
Mvaa 176,224,0
buffer_load_dwordx4 v8, s[8:11], s48 offen offset:0 lds
Mvaa 176,228,4
Ta 64,14,0
Ta 66,14,2048
Mvaa 180,232,0
Mvaa 180,236,4
Ra 240,10,12288
Mvaa 184,224,8
buffer_load_dwordx4 v8, s[8:11], s49 offen offset:1024 lds
Mvaa 184,228,12
Ta 68,14,16384
Ta 70,14,18432
Mvaa 188,232,8
Mvaa 188,236,12
Ra 244,11,12288
Mvaa 192,224,16
buffer_load_dwordx4 v9, s[8:11], s50 offen offset:2048 lds
Mvaa 192,228,20
Ta 72,15,0
Ta 74,15,2048
Mvaa 196,232,16
Mvaa 196,236,20
Ra 248,10,14336
Mvaa 200,224,24
buffer_load_dwordx4 v9, s[8:11], s51 offen offset:3072 lds
Mvaa 200,228,28
Ta 76,15,16384
Ta 78,15,18432
Mvaa 204,232,24
v_xor_b32 v8, 524288, v8
v_xor_b32 v9, 524288, v9
Mvaa 204,236,28
s_add_u32 m0, s44, 16384
Ra 252,11,14336
Mvaa 208,224,32
buffer_load_dwordx4 v8, s[8:11], s48 offen offset:0 lds
Mvaa 208,228,36
Mvaa 212,232,32
Mvaa 212,236,36
Ta 80,24,0
Ta 82,24,2048
Mvaa 216,224,40
buffer_load_dwordx4 v8, s[8:11], s49 offen offset:1024 lds
Mvaa 216,228,44
Ta 84,24,16384
s_waitcnt lgkmcnt(9)
Ta 86,24,18432
Mvaa 220,232,40
Mvaa 220,236,44
Ta 88,25,0
Ta 90,25,2048
Mvaa 224,224,48
buffer_load_dwordx4 v9, s[8:11], s50 offen offset:2048 lds
Mvaa 224,228,52
Mvaa 228,232,48
s_mul_i32 s3, s45, 33792
v_add_u32_e64 v10, s3, v2
Mvaa 228,236,52
Ta 92,25,16384
Ta 94,25,18432
Mvaa 232,224,56
buffer_load_dwordx4 v9, s[8:11], s51 offen offset:3072 lds
Mvaa 232,228,60
s_waitcnt vmcnt(10)
Ta 96,26,0
s_waitcnt lgkmcnt(9)
Ta 98,26,2048
Mvaa 236,232,56
s_barrier
v_xor_b32 v8, 1572864, v8
v_xor_b32 v9, 1572864, v9
Mvaa 236,236,60
s_add_u32 m0, s44, 32768
Ta 100,26,16384
Ta 102,26,18432
Mvaa 240,240,0
buffer_load_dwordx4 v8, s[8:11], s48 offen offset:0 lds
Mvaa 240,244,4
s_mul_i32 s3, s46, 33792
v_add_u32 v11, s3, v2
Mvaa 244,248,0
Mvaa 244,252,4
Ra 224,12,0
Mvaa 248,240,8
buffer_load_dwordx4 v8, s[8:11], s49 offen offset:1024 lds
Mvaa 248,244,12
Ta 104,27,0
Ta 106,27,2048
Mvaa 252,248,8
Mvaa 252,252,12
s_waitcnt lgkmcnt(9)
Ra 228,13,0
Maaa 128,240,16
buffer_load_dwordx4 v9, s[8:11], s50 offen offset:2048 lds
Maaa 128,244,20
Ta 108,27,16384
Ta 110,27,18432
Maaa 132,248,16
Maaa 132,252,20
Ra 232,12,2048
Maaa 136,240,24
buffer_load_dwordx4 v9, s[8:11], s51 offen offset:3072 lds
Maaa 136,244,28
Ta 112,28,0
Ta 114,28,2048
Maaa 140,248,24
v_xor_b32 v8, 524288, v8
v_xor_b32 v9, 524288, v9
Maaa 140,252,28
s_add_u32 m0, s44, 49152
s_waitcnt lgkmcnt(9)
Ra 236,13,2048
Maaa 144,240,32
buffer_load_dwordx4 v8, s[8:11], s48 offen offset:0 lds
Maaa 144,244,36
Maaa 148,248,32
Maaa 148,252,36
Ta 116,28,16384
Ta 118,28,18432
Maaa 152,240,40
buffer_load_dwordx4 v8, s[8:11], s49 offen offset:1024 lds
Maaa 152,244,44
Ta 120,29,0
Ta 122,29,2048
Maaa 156,248,40
Maaa 156,252,44
Ta 124,29,16384
s_waitcnt lgkmcnt(9)
Ta 126,29,18432
Maaa 160,240,48
buffer_load_dwordx4 v9, s[8:11], s50 offen offset:2048 lds
Maaa 160,244,52
Maaa 164,248,48
Maaa 164,252,52
Maaa 168,240,56
buffer_load_dwordx4 v9, s[8:11], s51 offen offset:3072 lds
Maaa 168,244,60
v_xor_b32 v8, 3670016, v8
v_xor_b32 v9, 3670016, v9
Maaa 172,248,56
s_waitcnt lgkmcnt(6)
Maaa 172,252,60
s_waitcnt lgkmcnt(0)
Mvaa 48,224,64
v_mov_b32 v14, v40
v_mov_b32_e64 v15, v41
Mvaa 48,228,68
Mvaa 52,232,64
Mvaa 52,236,68
Ra 240,12,4096
Mvaa 56,224,72
Mvaa 56,228,76
Mvaa 60,232,72
Mvaa 60,236,76
Ra 244,13,4096
Mvaa 64,224,80
Vc 24,48,49
Vc 25,50,51
Mvaa 64,228,84
Vc 26,52,53
Vc 27,54,55
Mvaa 68,232,80
Mvaa 68,236,84
Ra 248,12,6144
Mvaa 72,224,88
Vc 28,56,57
Vc 29,58,59
Mvaa 72,228,92
Vc 30,60,61
Vc 31,62,63
Mvaa 76,232,88
Mvaa 76,236,92
Ra 252,13,6144
Mvaa 80,224,96
Vc 32,64,65
Vc 33,66,67
Mvaa 80,228,100
Vc 34,68,69
Vc 35,70,71
Mvaa 84,232,96
Mvaa 84,236,100
Mvaa 88,224,104
Vc 36,72,73
Vc 37,74,75
Mvaa 88,228,108
Vc 38,76,77
Vc 39,78,79
Mvaa 92,232,104
Mvaa 92,236,108
Mvaa 96,224,112
Vc 40,80,81
Vc 41,82,83
Mvaa 96,228,116
Vc 42,84,85
Vc 43,86,87
Mvaa 100,232,112
s_waitcnt vmcnt(12)
Mvaa 100,236,116
s_add_u32 s59, s38, 0
Mvaa 104,224,120
v_readfirstlane_b32 s3, v1
s_nop 0
s_or_b32 s3, s3, s37
s_cmp_lt_u32 s3, 256
s_cbranch_scc1 L_spinAv
L_spinArv:
s_barrier
Mvaa 104,228,124
buffer_store_dwordx4 v[24:27], v2, s[24:27], s59 offen offset:0 sc1
Mvaa 108,232,120
s_waitcnt lgkmcnt(0)
Mvaa 108,236,124
Vc 44,88,89
Vc 45,90,91
Mvaa 112,240,64
buffer_load_dwordx4 a[0:3], v10, s[20:23], s53 offen offset:0 sc1
Mvaa 112,244,68
Vc 46,92,93
Vc 47,94,95
Mvaa 116,248,64
Vc 48,96,97
Vc 49,98,99
Mvaa 116,252,68
Ra 224,12,8192
Mvaa 120,240,72
Vc 50,100,101
Vc 51,102,103
Mvaa 120,244,76
Vc 52,104,105
Vc 53,106,107
Mvaa 124,248,72
buffer_load_dwordx4 a[4:7], v10, s[20:23], s52 offen offset:0 sc1
Mvaa 124,252,76
Ra 228,13,8192
Mvaa 128,240,80
Vc 54,108,109
Vc 55,110,111
Mvaa 128,244,84
Vc 56,112,113
Vc 57,114,115
Mvaa 132,248,80
Vc 58,116,117
Vc 59,118,119
Mvaa 132,252,84
Ra 232,12,10240
Mvaa 136,240,88
buffer_load_dwordx4 a[8:11], v11, s[20:23], s53 offen offset:0 sc1
Mvaa 136,244,92
buffer_store_dwordx4 v[28:31], v2, s[24:27], s59 offen offset:1024 sc1
Mvaa 140,248,88
Vc 60,120,121
Vc 61,122,123
Mvaa 140,252,92
Ra 236,13,10240
Mvaa 144,240,96
Vc 62,124,125
Vc 63,126,127
Mvaa 144,244,100
Vc 64,128,129
Vc 65,130,131
Mvaa 148,248,96
buffer_load_dwordx4 a[12:15], v11, s[20:23], s52 offen offset:0 sc1
Mvaa 148,252,100
Vc 66,132,133
Vc 67,134,135
Mvaa 152,240,104
Vc 68,136,137
Vc 69,138,139
Mvaa 152,244,108
Vc 70,140,141
Vc 71,142,143
Mvaa 156,248,104
Mvaa 156,252,108
Mvaa 160,240,112
buffer_load_dwordx4 a[16:19], v10, s[20:23], s53 offen offset:1024 sc1
Mvaa 160,244,116
Vc 72,144,145
Vc 73,146,147
Mvaa 164,248,112
Vc 74,148,149
Vc 75,150,151
Mvaa 164,252,116
buffer_store_dwordx4 v[32:35], v2, s[24:27], s59 offen offset:2048 sc1
Mvaa 168,240,120
Vc 76,152,153
Vc 77,154,155
Mvaa 168,244,124
Vc 78,156,157
Vc 79,158,159
Mvaa 172,248,120
s_waitcnt lgkmcnt(0)
buffer_load_dwordx4 a[20:23], v10, s[20:23], s52 offen offset:1024 sc1
Mvaa 172,252,124
Mvaa 176,224,64
Vc 80,160,161
Vc 81,162,163
Mvaa 176,228,68
Vc 82,164,165
Vc 83,166,167
Mvaa 180,232,64
Mvaa 180,236,68
Ra 240,12,12288
Mvaa 184,224,72
buffer_load_dwordx4 a[24:27], v11, s[20:23], s53 offen offset:1024 sc1
Mvaa 184,228,76
Vc 84,168,169
Vc 85,170,171
Mvaa 188,232,72
Vc 86,172,173
Vc 87,174,175
Mvaa 188,236,76
Ra 244,13,12288
Mvaa 192,224,80
Vc 88,176,177
Vc 89,178,179
Mvaa 192,228,84
Vc 90,180,181
Vc 91,182,183
Mvaa 196,232,80
buffer_load_dwordx4 a[28:31], v11, s[20:23], s52 offen offset:1024 sc1
Mvaa 196,236,84
Ra 248,12,14336
s_xor_b32 s52, s52, 2048
Mvaa 200,224,88
s_add_u32 s53, s52, s58
Mvaa 200,228,92
Vc 92,184,185
Vc 93,186,187
Mvaa 204,232,88
Vc 94,188,189
Vc 95,190,191
Mvaa 204,236,92
Ra 252,13,14336
Mvaa 208,224,96
buffer_load_dwordx4 a[32:35], v10, s[20:23], s53 offen offset:0 sc1
Mvaa 208,228,100
buffer_store_dwordx4 v[36:39], v2, s[24:27], s59 offen offset:3072 sc1
Mvaa 212,232,96
Vc 96,192,193
Vc 97,194,195
Mvaa 212,236,100
Vc 98,196,197
Vc 99,198,199
Mvaa 216,224,104
Vc 100,200,201
Vc 101,202,203
Mvaa 216,228,108
Vc 102,204,205
Vc 103,206,207
Mvaa 220,232,104
buffer_load_dwordx4 a[36:39], v10, s[20:23], s52 offen offset:0 sc1
Mvaa 220,236,108
Mvaa 224,224,112
Vc 104,208,209
Vc 105,210,211
Mvaa 224,228,116
Vc 106,212,213
Vc 107,214,215
Mvaa 228,232,112
Mvaa 228,236,116
Mvaa 232,224,120
buffer_load_dwordx4 a[40:43], v11, s[20:23], s53 offen offset:0 sc1
Mvaa 232,228,124
Vc 108,216,217
Vc 109,218,219
Mvaa 236,232,120
s_waitcnt lgkmcnt(0)
Mvaa 236,236,124
Vc 110,220,221
Vc 111,222,223
Mvaa 240,240,64
s_add_u32 s59, s38, 4096
Mvaa 240,244,68
buffer_store_dwordx4 v[40:43], v2, s[24:27], s59 offen offset:0 sc1
Mvaa 244,248,64
buffer_load_dwordx4 a[44:47], v11, s[20:23], s52 offen offset:0 sc1
Mvaa 244,252,68
Vc 112,224,225
Vc 113,226,227
Mvaa 248,240,72
Vc 114,228,229
Vc 115,230,231
Mvaa 248,244,76
Vc 116,232,233
Vc 117,234,235
Mvaa 252,248,72
Vc 118,236,237
Vc 119,238,239
Mvaa 252,252,76
Maaa 128,240,80
buffer_load_dwordx4 a[48:51], v10, s[20:23], s53 offen offset:1024 sc1
Maaa 128,244,84
Ta 192,16,0
Ta 194,16,1024
Maaa 132,248,80
Vc 120,240,241
Vc 121,242,243
Maaa 132,252,84
Ta 196,16,8192
Ta 198,16,9216
Maaa 136,240,88
Vc 122,244,245
Vc 123,246,247
Maaa 136,244,92
Ta 200,17,0
Ta 202,17,1024
Maaa 140,248,88
buffer_load_dwordx4 a[52:55], v10, s[20:23], s52 offen offset:1024 sc1
Maaa 140,252,92
Ta 204,17,8192
Ta 206,17,9216
Maaa 144,240,96
Vc 124,248,249
Vc 125,250,251
Maaa 144,244,100
Ta 208,18,0
Ta 210,18,1024
Maaa 148,248,96
Vc 126,252,253
Vc 127,254,255
Maaa 148,252,100
Ta 212,18,8192
Ta 214,18,9216
Maaa 152,240,104
buffer_load_dwordx4 a[56:59], v11, s[20:23], s53 offen offset:1024 sc1
Maaa 152,244,108
Ta 216,19,0
Ta 218,19,1024
Maaa 156,248,104
buffer_store_dwordx4 v[44:47], v2, s[24:27], s59 offen offset:1024 sc1
Maaa 156,252,108
Ta 220,19,8192
s_waitcnt lgkmcnt(9)
Ta 222,19,9216
Maaa 160,240,112
Maaa 160,244,116
Maaa 164,248,112
buffer_load_dwordx4 a[60:63], v11, s[20:23], s52 offen offset:1024 sc1
Maaa 164,252,116
s_xor_b32 s52, s52, 6144
s_add_u32 s53, s52, s58
Maaa 168,240,120
Maaa 168,244,124
Maaa 172,248,120
Maaa 172,252,124
L_phase2:
s_nop 7
s_waitcnt vmcnt(11) lgkmcnt(0)
Zvaa 128,192,0
buffer_store_dwordx4 v[48:51], v2, s[24:27], s59 offen offset:2048 sc1
Mvaa 128,196,16
Ta 224,20,0
Ta 226,20,1024
Zvaa 160,192,4
buffer_load_dwordx4 a[64:67], v10, s[20:23], s53 offen offset:0 sc1
Mvaa 160,196,20
s_mov_b32 s60, s40
s_and_b32 s61, s41, 0xffff
s_mov_b32 s62, 7340032
Zvaa 192,192,8
Ta 228,20,8192
Ta 230,20,9216
Mvaa 192,196,24
buffer_load_dwordx4 a[68:71], v10, s[20:23], s52 offen offset:0 sc1
Zvaa 224,192,12
s_mov_b32 s63, 0x20000
Mvaa 224,196,28
Ta 232,21,0
Ta 234,21,1024
Zvaa 132,200,0
global_load_dword v13, v[14:15], off
Mvaa 132,204,16
buffer_load_dwordx4 a[72:75], v11, s[20:23], s53 offen offset:0 sc1
Zvaa 164,200,4
Ta 236,21,8192
Ta 238,21,9216
Mvaa 164,204,20
Zvaa 196,200,8
buffer_load_dwordx4 a[76:79], v11, s[20:23], s52 offen offset:0 sc1
Mvaa 196,204,24
Ta 240,22,0
Ta 242,22,1024
Zvaa 228,200,12
Mvaa 228,204,28
Zvaa 136,208,0
s_waitcnt lgkmcnt(6)
Ta 244,22,8192
Ta 246,22,9216
Mvaa 136,212,16
buffer_load_dwordx4 a[80:83], v10, s[20:23], s53 offen offset:1024 sc1
Zvaa 168,208,4
Mvaa 168,212,20
Ta 248,23,0
Ta 250,23,1024
Zvaa 200,208,8
buffer_load_dwordx4 a[84:87], v10, s[20:23], s52 offen offset:1024 sc1
Mvaa 200,212,24
Zvaa 232,208,12
Ta 252,23,8192
Ta 254,23,9216
Mvaa 232,212,28
Zvaa 140,216,0
buffer_load_dwordx4 a[88:91], v11, s[20:23], s53 offen offset:1024 sc1
Mvaa 140,220,16
Zvaa 172,216,4
buffer_load_dwordx4 a[92:95], v11, s[20:23], s52 offen offset:1024 sc1
Mvaa 172,220,20
s_xor_b32 s52, s52, 2048
s_add_u32 s53, s52, s58
Zvaa 204,216,8
buffer_store_dwordx4 v[52:55], v2, s[24:27], s59 offen offset:3072 sc1
Mvaa 204,220,24
Zvaa 236,216,12
s_waitcnt lgkmcnt(0)
Mvaa 236,220,28
s_barrier
Zvaa 144,224,0
Mvaa 144,228,16
s_add_u32 m0, s44, 0
Ta 192,16,16384
Ta 194,16,17408
Zvaa 176,224,4
buffer_load_dwordx4 v8, s[8:11], s48 offen offset:0 lds
Mvaa 176,228,20
Zvaa 208,224,8
Ta 196,16,24576
Ta 198,16,25600
Mvaa 208,228,24
Zvaa 240,224,12
buffer_load_dwordx4 v8, s[8:11], s49 offen offset:1024 lds
Mvaa 240,228,28
Ta 200,17,16384
Ta 202,17,17408
Zvaa 148,232,0
Mvaa 148,236,16
Zvaa 180,232,4
Ta 204,17,24576
Ta 206,17,25600
Mvaa 180,236,20
buffer_load_dwordx4 a[96:99], v10, s[20:23], s53 offen offset:0 sc1
Zvaa 212,232,8
Mvaa 212,236,24
Ta 208,18,16384
Ta 210,18,17408
Zvaa 244,232,12
Mvaa 244,236,28
Zvaa 152,240,0
s_waitcnt lgkmcnt(6)
Ta 212,18,24576
Ta 214,18,25600
Mvaa 152,244,16
buffer_load_dwordx4 a[100:103], v10, s[20:23], s52 offen offset:0 sc1
Zvaa 184,240,4
Mvaa 184,244,20
Ta 216,19,16384
Ta 218,19,17408
Zvaa 216,240,8
Mvaa 216,244,24
buffer_load_dwordx4 a[104:107], v11, s[20:23], s53 offen offset:0 sc1
Zvaa 248,240,12
Ta 220,19,24576
Ta 222,19,25600
Mvaa 248,244,28
s_add_u32 s59, s38, 8192
Zvaa 156,248,0
buffer_store_dwordx4 v[56:59], v2, s[24:27], s59 offen offset:0 sc1
Mvaa 156,252,16
buffer_load_dwordx4 a[108:111], v11, s[20:23], s52 offen offset:0 sc1
Zvaa 188,248,4
Ar 48,128
Ar 49,129
Mvaa 188,252,20
Ar 50,130
Ar 51,131
Zvaa 220,248,8
Ar 52,132
Ar 53,133
Mvaa 220,252,24
Ar 54,134
Ar 55,135
Zvaa 252,248,12
s_waitcnt vmcnt(18) lgkmcnt(0)
Vc 24,48,49
Vc 25,50,51
Mvaa 252,252,28
Vc 26,52,53
Vc 27,54,55
Mvaa 128,192,32
Mvaa 128,196,48
Ta 224,20,16384
Ta 226,20,17408
Mvaa 160,192,36
buffer_load_dwordx4 v9, s[8:11], s50 offen offset:2048 lds
Mvaa 160,196,52
Mvaa 192,192,40
Ta 228,20,24576
Ta 230,20,25600
Mvaa 192,196,56
Mvaa 224,192,44
buffer_load_dwordx4 v9, s[8:11], s51 offen offset:3072 lds
Mvaa 224,196,60
Ta 232,21,16384
Ta 234,21,17408
Mvaa 132,200,32
v_xor_b32 v8, 524288, v8
v_xor_b32 v9, 524288, v9
Mvaa 132,204,48
Mvaa 164,200,36
Ta 236,21,24576
Ta 238,21,25600
Mvaa 164,204,52
buffer_load_dwordx4 a[112:115], v10, s[20:23], s53 offen offset:1024 sc1
Mvaa 196,200,40
Mvaa 196,204,56
Ta 240,22,16384
Ta 242,22,17408
Mvaa 228,200,44
Mvaa 228,204,60
Mvaa 136,208,32
s_waitcnt lgkmcnt(6)
Ta 244,22,24576
Ta 246,22,25600
Mvaa 136,212,48
buffer_load_dwordx4 a[116:119], v10, s[20:23], s52 offen offset:1024 sc1
Mvaa 168,208,36
buffer_store_dwordx4 v[60:63], v2, s[24:27], s59 offen offset:1024 sc1
Mvaa 168,212,52
Ta 248,23,16384
Ta 250,23,17408
Mvaa 200,208,40
Ar 48,136
Ar 49,137
Mvaa 200,212,56
buffer_load_dwordx4 a[120:123], v11, s[20:23], s53 offen offset:1024 sc1
Mvaa 232,208,44
Ta 252,23,24576
Ta 254,23,25600
Mvaa 232,212,60
Ar 50,138
Ar 51,139
Mvaa 140,216,32
Ar 52,140
Ar 53,141
Mvaa 140,220,48
buffer_load_dwordx4 a[124:127], v11, s[20:23], s52 offen offset:1024 sc1
Mvaa 172,216,36
s_xor_b32 s52, s52, 14336
s_add_u32 s53, s52, s58
Mvaa 172,220,52
Ar 54,142
Ar 55,143
Mvaa 204,216,40
Vc 28,48,49
Vc 29,50,51
Mvaa 204,220,56
Vc 30,52,53
Vc 31,54,55
Mvaa 236,216,44
s_waitcnt lgkmcnt(0)
Mvaa 236,220,60
s_barrier
Mvaa 144,224,32
Mvaa 144,228,48
s_add_u32 m0, s44, 16384
Ta 192,16,32768
Ta 194,16,33792
Mvaa 176,224,36
buffer_load_dwordx4 v8, s[8:11], s48 offen offset:0 lds
Mvaa 176,228,52
Mvaa 208,224,40
Ta 196,16,40960
Ta 198,16,41984
Mvaa 208,228,56
Mvaa 240,224,44
buffer_load_dwordx4 v8, s[8:11], s49 offen offset:1024 lds
Mvaa 240,228,60
Ta 200,17,32768
Ta 202,17,33792
Mvaa 148,232,32
Mvaa 148,236,48
Mvaa 180,232,36
Ta 204,17,40960
Ta 206,17,41984
Mvaa 180,236,52
buffer_load_dwordx4 a[0:3], v10, s[20:23], s53 offen offset:0 sc1
Mvaa 212,232,40
buffer_store_dwordx4 v[64:67], v2, s[24:27], s59 offen offset:2048 sc1
Mvaa 212,236,56
Ta 208,18,32768
Ta 210,18,33792
Mvaa 244,232,44
Ar 48,144
Ar 49,145
Mvaa 244,236,60
Ar 50,146
Ar 51,147
Mvaa 152,240,32
s_waitcnt lgkmcnt(6)
Ta 212,18,40960
Ta 214,18,41984
Mvaa 152,244,48
buffer_load_dwordx4 a[4:7], v10, s[20:23], s52 offen offset:0 sc1
Mvaa 184,240,36
Ar 52,148
Ar 53,149
Mvaa 184,244,52
Ta 216,19,32768
Ta 218,19,33792
Mvaa 216,240,40
Ar 54,150
Ar 55,151
Mvaa 216,244,56
buffer_load_dwordx4 a[8:11], v11, s[20:23], s53 offen offset:0 sc1
Mvaa 248,240,44
Ta 220,19,40960
Ta 222,19,41984
Mvaa 248,244,60
Vc 32,48,49
Vc 33,50,51
Mvaa 156,248,32
Vc 34,52,53
Vc 35,54,55
Mvaa 156,252,48
buffer_load_dwordx4 a[12:15], v11, s[20:23], s52 offen offset:0 sc1
Mvaa 188,248,36
Mvaa 188,252,52
Mvaa 220,248,40
Mvaa 220,252,56
Mvaa 252,248,44
s_waitcnt vmcnt(22) lgkmcnt(0)
Mvaa 252,252,60
Mvaa 128,192,64
Mvaa 128,196,80
Ta 224,20,32768
Ta 226,20,33792
Mvaa 160,192,68
buffer_load_dwordx4 v9, s[8:11], s50 offen offset:2048 lds
Mvaa 160,196,84
Mvaa 192,192,72
Ta 228,20,40960
Ta 230,20,41984
Mvaa 192,196,88
Mvaa 224,192,76
buffer_load_dwordx4 v9, s[8:11], s51 offen offset:3072 lds
Mvaa 224,196,92
Ta 232,21,32768
Ta 234,21,33792
Mvaa 132,200,64
v_xor_b32 v8, 1572864, v8
v_xor_b32 v9, 1572864, v9
Mvaa 132,204,80
buffer_store_dwordx4 v[68:71], v2, s[24:27], s59 offen offset:3072 sc1
Mvaa 164,200,68
Ta 236,21,40960
Ta 238,21,41984
Mvaa 164,204,84
buffer_load_dwordx4 a[16:19], v10, s[20:23], s53 offen offset:1024 sc1
Mvaa 196,200,72
Ar 48,152
Ar 49,153
Mvaa 196,204,88
Ta 240,22,32768
Ta 242,22,33792
Mvaa 228,200,76
Ar 50,154
Ar 51,155
Mvaa 228,204,92
Ar 52,156
Ar 53,157
Mvaa 136,208,64
s_waitcnt lgkmcnt(6)
Ta 244,22,40960
Ta 246,22,41984
Mvaa 136,212,80
buffer_load_dwordx4 a[20:23], v10, s[20:23], s52 offen offset:1024 sc1
Mvaa 168,208,68
Ar 54,158
Ar 55,159
Mvaa 168,212,84
Ta 248,23,32768
Ta 250,23,33792
Mvaa 200,208,72
Vc 36,48,49
Vc 37,50,51
Mvaa 200,212,88
buffer_load_dwordx4 a[24:27], v11, s[20:23], s53 offen offset:1024 sc1
Mvaa 232,208,76
Ta 252,23,40960
Ta 254,23,41984
Mvaa 232,212,92
Vc 38,52,53
Vc 39,54,55
Mvaa 140,216,64
Mvaa 140,220,80
buffer_load_dwordx4 a[28:31], v11, s[20:23], s52 offen offset:1024 sc1
Mvaa 172,216,68
s_xor_b32 s52, s52, 2048
s_add_u32 s53, s52, s58
Mvaa 172,220,84
Mvaa 204,216,72
Mvaa 204,220,88
Mvaa 236,216,76
s_waitcnt lgkmcnt(0)
Mvaa 236,220,92
s_barrier
Mvaa 144,224,64
s_add_u32 s59, s38, 12288
Mvaa 144,228,80
s_add_u32 m0, s44, 32768
Ta 192,16,49152
Ta 194,16,50176
Mvaa 176,224,68
buffer_load_dwordx4 v8, s[8:11], s48 offen offset:0 lds
Mvaa 176,228,84
buffer_store_dwordx4 v[72:75], v2, s[24:27], s59 offen offset:0 sc1
Mvaa 208,224,72
Ta 196,16,57344
Ta 198,16,58368
Mvaa 208,228,88
Ar 48,160
Ar 49,161
Mvaa 240,224,76
buffer_load_dwordx4 v8, s[8:11], s49 offen offset:1024 lds
Mvaa 240,228,92
Ta 200,17,49152
Ta 202,17,50176
Mvaa 148,232,64
Ar 50,162
Ar 51,163
Mvaa 148,236,80
Ar 52,164
Ar 53,165
Mvaa 180,232,68
Ta 204,17,57344
Ta 206,17,58368
Mvaa 180,236,84
buffer_load_dwordx4 a[32:35], v10, s[20:23], s53 offen offset:0 sc1
Mvaa 212,232,72
Ar 54,166
Ar 55,167
Mvaa 212,236,88
Ta 208,18,49152
Ta 210,18,50176
Mvaa 244,232,76
Vc 40,48,49
Vc 41,50,51
Mvaa 244,236,92
Vc 42,52,53
Vc 43,54,55
Mvaa 152,240,64
s_waitcnt lgkmcnt(6)
Ta 212,18,57344
Ta 214,18,58368
Mvaa 152,244,80
buffer_load_dwordx4 a[36:39], v10, s[20:23], s52 offen offset:0 sc1
Mvaa 184,240,68
global_load_dword v13, v[14:15], off
Mvaa 184,244,84
Ta 216,19,49152
Ta 218,19,50176
Mvaa 216,240,72
Mvaa 216,244,88
buffer_load_dwordx4 a[40:43], v11, s[20:23], s53 offen offset:0 sc1
Mvaa 248,240,76
Ta 220,19,57344
Ta 222,19,58368
Mvaa 248,244,92
Mvaa 156,248,64
Mvaa 156,252,80
buffer_load_dwordx4 a[44:47], v11, s[20:23], s52 offen offset:0 sc1
Mvaa 188,248,68
Mvaa 188,252,84
buffer_store_dwordx4 v[76:79], v2, s[24:27], s59 offen offset:1024 sc1
Mvaa 220,248,72
Ar 48,168
Ar 49,169
Mvaa 220,252,88
Ar 50,170
Ar 51,171
Mvaa 252,248,76
s_waitcnt vmcnt(23) lgkmcnt(0)
Ar 52,172
Ar 53,173
Mvaa 252,252,92
Ar 54,174
Ar 55,175
Mvaa 128,192,96
Vc 44,48,49
Vc 45,50,51
Mvaa 128,196,112
Ta 224,20,49152
Ta 226,20,50176
Mvaa 160,192,100
buffer_load_dwordx4 v9, s[8:11], s50 offen offset:2048 lds
Mvaa 160,196,116
Vc 46,52,53
Vc 47,54,55
Mvaa 192,192,104
Ta 228,20,57344
Ta 230,20,58368
Mvaa 192,196,120
s_lshl_b32 s3, s32, 11
s_add_u32 s3, s3, 5242880
Mvaa 224,192,108
buffer_load_dwordx4 v9, s[8:11], s51 offen offset:3072 lds
Mvaa 224,196,124
Ta 232,21,49152
Ta 234,21,50176
Mvaa 132,200,96
v_xor_b32 v8, 524288, v8
v_xor_b32 v9, 524288, v9
Mvaa 132,204,112
buffer_load_dwordx4 v[56:59], v2, s[20:23], s3 offen offset:0 sc1
Mvaa 164,200,100
Ta 236,21,57344
Ta 238,21,58368
Mvaa 164,204,116
buffer_load_dwordx4 a[48:51], v10, s[20:23], s53 offen offset:1024 sc1
Mvaa 196,200,104
buffer_load_dwordx4 v[60:63], v2, s[20:23], s3 offen offset:1024 sc1
Mvaa 196,204,120
Ta 240,22,49152
Ta 242,22,50176
Mvaa 228,200,108
Mvaa 228,204,124
Mvaa 136,208,96
s_waitcnt lgkmcnt(6)
Ta 244,22,57344
Ta 246,22,58368
Mvaa 136,212,112
buffer_load_dwordx4 a[52:55], v10, s[20:23], s52 offen offset:1024 sc1
Mvaa 168,208,100
Mvaa 168,212,116
Ta 248,23,49152
Ta 250,23,50176
Mvaa 200,208,104
Mvaa 200,212,120
buffer_load_dwordx4 a[56:59], v11, s[20:23], s53 offen offset:1024 sc1
Mvaa 232,208,108
Ta 252,23,57344
Ta 254,23,58368
Mvaa 232,212,124
buffer_store_dwordx4 v[80:83], v2, s[24:27], s59 offen offset:2048 sc1
Mvaa 140,216,96
Mvaa 140,220,112
buffer_load_dwordx4 a[60:63], v11, s[20:23], s52 offen offset:1024 sc1
Mvaa 172,216,100
s_xor_b32 s52, s52, 6144
s_add_u32 s53, s52, s58
Mvaa 172,220,116
Mvaa 204,216,104
Mvaa 204,220,120
Mvaa 236,216,108
s_waitcnt lgkmcnt(0)
Mvaa 236,220,124
s_barrier
Mvaa 144,224,96
Mvaa 144,228,112
s_add_u32 m0, s44, 49152
Ta 192,16,0
Ta 194,16,1024
Mvaa 176,224,100
buffer_load_dwordx4 v8, s[8:11], s48 offen offset:0 lds
Mvaa 176,228,116
Mvaa 208,224,104
Ta 196,16,8192
Ta 198,16,9216
Mvaa 208,228,120
Mvaa 240,224,108
buffer_load_dwordx4 v8, s[8:11], s49 offen offset:1024 lds
Mvaa 240,228,124
Ta 200,17,0
Ta 202,17,1024
Mvaa 148,232,96
Mvaa 148,236,112
Mvaa 180,232,100
Ta 204,17,8192
Ta 206,17,9216
Mvaa 180,236,116
buffer_load_dwordx4 a[64:67], v10, s[20:23], s53 offen offset:0 sc1
Mvaa 212,232,104
Mvaa 212,236,120
Ta 208,18,0
Ta 210,18,1024
Mvaa 244,232,108
Mvaa 244,236,124
Mvaa 152,240,96
s_waitcnt lgkmcnt(6)
Ta 212,18,8192
Ta 214,18,9216
Mvaa 152,244,112
buffer_load_dwordx4 a[68:71], v10, s[20:23], s52 offen offset:0 sc1
Mvaa 184,240,100
buffer_store_dwordx4 v[84:87], v2, s[24:27], s59 offen offset:3072 sc1
Mvaa 184,244,116
Ta 216,19,0
Ta 218,19,1024
Mvaa 216,240,104
Mvaa 216,244,120
buffer_load_dwordx4 a[72:75], v11, s[20:23], s53 offen offset:0 sc1
Mvaa 248,240,108
Ta 220,19,8192
Ta 222,19,9216
Mvaa 248,244,124
Mvaa 156,248,96
Mvaa 156,252,112
buffer_load_dwordx4 a[76:79], v11, s[20:23], s52 offen offset:0 sc1
Mvaa 188,248,100
Mvaa 188,252,116
Mvaa 220,248,104
Mvaa 220,252,120
Mvaa 252,248,108
s_waitcnt vmcnt(25) lgkmcnt(0)
Mvaa 252,252,124
Mvaa 128,192,0
Mvaa 128,196,16
Ta 224,20,0
Ta 226,20,1024
Mvaa 160,192,4
buffer_load_dwordx4 v9, s[8:11], s50 offen offset:2048 lds
Mvaa 160,196,20
Mvaa 192,192,8
Ta 228,20,8192
Ta 230,20,9216
Mvaa 192,196,24
Mvaa 224,192,12
buffer_load_dwordx4 v9, s[8:11], s51 offen offset:3072 lds
Mvaa 224,196,28
Ta 232,21,0
Ta 234,21,1024
Mvaa 132,200,0
v_xor_b32 v8, 7864320, v8
v_xor_b32 v9, 7864320, v9
Mvaa 132,204,16
Mvaa 164,200,4
Ta 236,21,8192
Ta 238,21,9216
Mvaa 164,204,20
buffer_load_dwordx4 a[80:83], v10, s[20:23], s53 offen offset:1024 sc1
Mvaa 196,200,8
s_add_u32 s59, s38, 34816
Mvaa 196,204,24
Ta 240,22,0
Ta 242,22,1024
Mvaa 228,200,12
buffer_store_dwordx4 v[88:91], v2, s[24:27], s59 offen offset:0 sc1
Mvaa 228,204,28
Mvaa 136,208,0
s_waitcnt lgkmcnt(6)
Ta 244,22,8192
Ta 246,22,9216
Mvaa 136,212,16
buffer_load_dwordx4 a[84:87], v10, s[20:23], s52 offen offset:1024 sc1
Mvaa 168,208,4
Mvaa 168,212,20
Ta 248,23,0
Ta 250,23,1024
Mvaa 200,208,8
Mvaa 200,212,24
buffer_load_dwordx4 a[88:91], v11, s[20:23], s53 offen offset:1024 sc1
Mvaa 232,208,12
Ta 252,23,8192
Ta 254,23,9216
Mvaa 232,212,28
Mvaa 140,216,0
Mvaa 140,220,16
buffer_load_dwordx4 a[92:95], v11, s[20:23], s52 offen offset:1024 sc1
Mvaa 172,216,4
s_xor_b32 s52, s52, 2048
s_add_u32 s53, s52, s58
Mvaa 172,220,20
Mvaa 204,216,8
Mvaa 204,220,24
Mvaa 236,216,12
s_waitcnt lgkmcnt(0)
Mvaa 236,220,28
s_barrier
Mvaa 144,224,0
Mvaa 144,228,16
s_add_u32 m0, s44, 0
Ta 192,16,16384
Ta 194,16,17408
Mvaa 176,224,4
buffer_load_dwordx4 v8, s[8:11], s48 offen offset:0 lds
Mvaa 176,228,20
Mvaa 208,224,8
Ta 196,16,24576
Ta 198,16,25600
Mvaa 208,228,24
Mvaa 240,224,12
buffer_load_dwordx4 v8, s[8:11], s49 offen offset:1024 lds
Mvaa 240,228,28
Ta 200,17,16384
Ta 202,17,17408
Mvaa 148,232,0
buffer_store_dwordx4 v[92:95], v2, s[24:27], s59 offen offset:1024 sc1
Mvaa 148,236,16
Mvaa 180,232,4
Ta 204,17,24576
Ta 206,17,25600
Mvaa 180,236,20
buffer_load_dwordx4 a[96:99], v10, s[20:23], s53 offen offset:0 sc1
Mvaa 212,232,8
Mvaa 212,236,24
Ta 208,18,16384
Ta 210,18,17408
Mvaa 244,232,12
Mvaa 244,236,28
Mvaa 152,240,0
s_waitcnt lgkmcnt(6)
Ta 212,18,24576
Ta 214,18,25600
Mvaa 152,244,16
buffer_load_dwordx4 a[100:103], v10, s[20:23], s52 offen offset:0 sc1
Mvaa 184,240,4
Mvaa 184,244,20
Ta 216,19,16384
Ta 218,19,17408
Mvaa 216,240,8
Mvaa 216,244,24
buffer_load_dwordx4 a[104:107], v11, s[20:23], s53 offen offset:0 sc1
Mvaa 248,240,12
Ta 220,19,24576
Ta 222,19,25600
Mvaa 248,244,28
Mvaa 156,248,0
Mvaa 156,252,16
buffer_load_dwordx4 a[108:111], v11, s[20:23], s52 offen offset:0 sc1
Mvaa 188,248,4
Mvaa 188,252,20
Mvaa 220,248,8
Mvaa 220,252,24
Mvaa 252,248,12
s_waitcnt vmcnt(21) lgkmcnt(0)
Mvaa 252,252,28
Mvaa 128,192,32
buffer_store_dwordx4 v[96:99], v2, s[24:27], s59 offen offset:2048 sc1
Mvaa 128,196,48
Ta 224,20,16384
Ta 226,20,17408
Mvaa 160,192,36
buffer_load_dwordx4 v9, s[8:11], s50 offen offset:2048 lds
Mvaa 160,196,52
Mvaa 192,192,40
Ta 228,20,24576
Ta 230,20,25600
Mvaa 192,196,56
Mvaa 224,192,44
buffer_load_dwordx4 v9, s[8:11], s51 offen offset:3072 lds
Mvaa 224,196,60
Ta 232,21,16384
Ta 234,21,17408
Mvaa 132,200,32
v_xor_b32 v8, 524288, v8
v_xor_b32 v9, 524288, v9
Mvaa 132,204,48
Mvaa 164,200,36
Ta 236,21,24576
Ta 238,21,25600
Mvaa 164,204,52
buffer_load_dwordx4 a[112:115], v10, s[20:23], s53 offen offset:1024 sc1
Mvaa 196,200,40
Mvaa 196,204,56
Ta 240,22,16384
Ta 242,22,17408
Mvaa 228,200,44
Mvaa 228,204,60
Mvaa 136,208,32
s_waitcnt lgkmcnt(6)
Ta 244,22,24576
Ta 246,22,25600
Mvaa 136,212,48
buffer_load_dwordx4 a[116:119], v10, s[20:23], s52 offen offset:1024 sc1
Mvaa 168,208,36
Mvaa 168,212,52
Ta 248,23,16384
Ta 250,23,17408
Mvaa 200,208,40
Mvaa 200,212,56
buffer_load_dwordx4 a[120:123], v11, s[20:23], s53 offen offset:1024 sc1
Mvaa 232,208,44
Ta 252,23,24576
Ta 254,23,25600
Mvaa 232,212,60
Mvaa 140,216,32
Mvaa 140,220,48
buffer_load_dwordx4 a[124:127], v11, s[20:23], s52 offen offset:1024 sc1
Mvaa 172,216,36
s_xor_b32 s52, s52, 30720
s_add_u32 s53, s52, s58
Mvaa 172,220,52
buffer_store_dwordx4 v[100:103], v2, s[24:27], s59 offen offset:3072 sc1
Mvaa 204,216,40
Mvaa 204,220,56
Mvaa 236,216,44
s_waitcnt lgkmcnt(0)
Mvaa 236,220,60
s_barrier
Mvaa 144,224,32
Mvaa 144,228,48
s_add_u32 m0, s44, 16384
Ta 192,16,32768
Ta 194,16,33792
Mvaa 176,224,36
buffer_load_dwordx4 v8, s[8:11], s48 offen offset:0 lds
Mvaa 176,228,52
Mvaa 208,224,40
Ta 196,16,40960
Ta 198,16,41984
Mvaa 208,228,56
Mvaa 240,224,44
buffer_load_dwordx4 v8, s[8:11], s49 offen offset:1024 lds
Mvaa 240,228,60
Ta 200,17,32768
Ta 202,17,33792
Mvaa 148,232,32
Mvaa 148,236,48
Mvaa 180,232,36
Ta 204,17,40960
Ta 206,17,41984
Mvaa 180,236,52
buffer_load_dwordx4 a[0:3], v10, s[20:23], s53 offen offset:0 sc1
Mvaa 212,232,40
Mvaa 212,236,56
Ta 208,18,32768
Ta 210,18,33792
Mvaa 244,232,44
Mvaa 244,236,60
Mvaa 152,240,32
s_waitcnt lgkmcnt(6)
Ta 212,18,40960
Ta 214,18,41984
Mvaa 152,244,48
buffer_load_dwordx4 a[4:7], v10, s[20:23], s52 offen offset:0 sc1
Mvaa 184,240,36
Mvaa 184,244,52
Ta 216,19,32768
Ta 218,19,33792
Mvaa 216,240,40
Mvaa 216,244,56
buffer_load_dwordx4 a[8:11], v11, s[20:23], s53 offen offset:0 sc1
Mvaa 248,240,44
Ta 220,19,40960
Ta 222,19,41984
Mvaa 248,244,60
s_add_u32 s59, s38, 38912
Mvaa 156,248,32
buffer_store_dwordx4 v[104:107], v2, s[24:27], s59 offen offset:0 sc1
Mvaa 156,252,48
buffer_load_dwordx4 a[12:15], v11, s[20:23], s52 offen offset:0 sc1
Mvaa 188,248,36
Mvaa 188,252,52
Mvaa 220,248,40
Mvaa 220,252,56
Mvaa 252,248,44
s_waitcnt vmcnt(22) lgkmcnt(0)
Mvaa 252,252,60
Mvaa 128,192,64
v_max_u32 v14, v56, v57
v_min_u32_e64 v15, v56, v57
Mvaa 128,196,80
Ta 224,20,32768
Ta 226,20,33792
Mvaa 160,192,68
buffer_load_dwordx4 v9, s[8:11], s50 offen offset:2048 lds
Mvaa 160,196,84
v_med3_u32 v15, v14, v15, v58
v_max_u32_e64 v14, v14, v58
Mvaa 192,192,72
Ta 228,20,40960
Ta 230,20,41984
Mvaa 192,196,88
v_med3_u32 v15, v14, v15, v59
v_max_u32_e64 v14, v14, v59
Mvaa 224,192,76
buffer_load_dwordx4 v9, s[8:11], s51 offen offset:3072 lds
Mvaa 224,196,92
Ta 232,21,32768
Ta 234,21,33792
Mvaa 132,200,64
v_xor_b32 v8, 1572864, v8
v_xor_b32 v9, 1572864, v9
Mvaa 132,204,80
v_med3_u32 v15, v14, v15, v60
v_max_u32_e64 v14, v14, v60
Mvaa 164,200,68
Ta 236,21,40960
Ta 238,21,41984
Mvaa 164,204,84
buffer_load_dwordx4 a[16:19], v10, s[20:23], s53 offen offset:1024 sc1
Mvaa 196,200,72
v_med3_u32 v15, v14, v15, v61
v_max_u32_e64 v14, v14, v61
Mvaa 196,204,88
Ta 240,22,32768
Ta 242,22,33792
Mvaa 228,200,76
v_med3_u32 v15, v14, v15, v62
v_max_u32_e64 v14, v14, v62
Mvaa 228,204,92
v_med3_u32 v15, v14, v15, v63
v_max_u32_e64 v14, v14, v63
Mvaa 136,208,64
s_waitcnt lgkmcnt(6)
Ta 244,22,40960
Ta 246,22,41984
Mvaa 136,212,80
buffer_load_dwordx4 a[20:23], v10, s[20:23], s52 offen offset:1024 sc1
Mvaa 168,208,68
buffer_store_dwordx4 v[108:111], v2, s[24:27], s59 offen offset:1024 sc1
Mvaa 168,212,84
Ta 248,23,32768
Ta 250,23,33792
Mvaa 200,208,72
s_lshl_b32 s3, s32, 9
s_add_u32 s3, s3, 131072
v_lshlrev_b32_e64 v13, 3, v0
Mvaa 200,212,88
buffer_load_dwordx4 a[24:27], v11, s[20:23], s53 offen offset:1024 sc1
Mvaa 232,208,76
Ta 252,23,40960
Ta 254,23,41984
Mvaa 232,212,92
v_add_u32_e64 v56, s3, v13
v_add_u32 v13, 131072, v13
Mvaa 140,216,64
ds_write_b64 v56, v[14:15]
Mvaa 140,220,80
buffer_load_dwordx4 a[28:31], v11, s[20:23], s52 offen offset:1024 sc1
Mvaa 172,216,68
s_xor_b32 s52, s52, 2048
s_add_u32 s53, s52, s58
Mvaa 172,220,84
Mvaa 204,216,72
Mvaa 204,220,88
Mvaa 236,216,76
s_waitcnt lgkmcnt(0)
Mvaa 236,220,92
s_barrier
Mvaa 144,224,64
Mvaa 144,228,80
s_add_u32 m0, s44, 32768
Ta 192,16,49152
Ta 194,16,50176
Mvaa 176,224,68
buffer_load_dwordx4 v8, s[8:11], s48 offen offset:0 lds
Mvaa 176,228,84
Mvaa 208,224,72
Ta 196,16,57344
Ta 198,16,58368
Mvaa 208,228,88
Mvaa 240,224,76
buffer_load_dwordx4 v8, s[8:11], s49 offen offset:1024 lds
Mvaa 240,228,92
Ta 200,17,49152
Ta 202,17,50176
Mvaa 148,232,64
Mvaa 148,236,80
Mvaa 180,232,68
Ta 204,17,57344
Ta 206,17,58368
Mvaa 180,236,84
buffer_load_dwordx4 a[32:35], v10, s[20:23], s53 offen offset:0 sc1
Mvaa 212,232,72
buffer_store_dwordx4 v[112:115], v2, s[24:27], s59 offen offset:2048 sc1
Mvaa 212,236,88
Ta 208,18,49152
Ta 210,18,50176
Mvaa 244,232,76
Mvaa 244,236,92
Mvaa 152,240,64
s_waitcnt lgkmcnt(6)
Ta 212,18,57344
Ta 214,18,58368
Mvaa 152,244,80
buffer_load_dwordx4 a[36:39], v10, s[20:23], s52 offen offset:0 sc1
Mvaa 184,240,68
Mvaa 184,244,84
Ta 216,19,49152
Ta 218,19,50176
Mvaa 216,240,72
Mvaa 216,244,88
buffer_load_dwordx4 a[40:43], v11, s[20:23], s53 offen offset:0 sc1
Mvaa 248,240,76
Ta 220,19,57344
Ta 222,19,58368
Mvaa 248,244,92
Mvaa 156,248,64
Mvaa 156,252,80
buffer_load_dwordx4 a[44:47], v11, s[20:23], s52 offen offset:0 sc1
Mvaa 188,248,68
Mvaa 188,252,84
Mvaa 220,248,72
Mvaa 220,252,88
Mvaa 252,248,76
s_waitcnt vmcnt(22) lgkmcnt(0)
Mvaa 252,252,92
Mvaa 128,192,96
Mvaa 128,196,112
Ta 224,20,49152
Ta 226,20,50176
Mvaa 160,192,100
buffer_load_dwordx4 v9, s[8:11], s50 offen offset:2048 lds
Mvaa 160,196,116
Mvaa 192,192,104
Ta 228,20,57344
Ta 230,20,58368
Mvaa 192,196,120
Mvaa 224,192,108
buffer_load_dwordx4 v9, s[8:11], s51 offen offset:3072 lds
Mvaa 224,196,124
Ta 232,21,49152
Ta 234,21,50176
Mvaa 132,200,96
v_xor_b32 v8, 524288, v8
v_xor_b32 v9, 524288, v9
Mvaa 132,204,112
buffer_store_dwordx4 v[116:119], v2, s[24:27], s59 offen offset:3072 sc1
Mvaa 164,200,100
Ta 236,21,57344
Ta 238,21,58368
Mvaa 164,204,116
buffer_load_dwordx4 a[48:51], v10, s[20:23], s53 offen offset:1024 sc1
Mvaa 196,200,104
Mvaa 196,204,120
Ta 240,22,49152
Ta 242,22,50176
Mvaa 228,200,108
Mvaa 228,204,124
Mvaa 136,208,96
s_waitcnt lgkmcnt(6)
Ta 244,22,57344
Ta 246,22,58368
Mvaa 136,212,112
buffer_load_dwordx4 a[52:55], v10, s[20:23], s52 offen offset:1024 sc1
Mvaa 168,208,100
Mvaa 168,212,116
Ta 248,23,49152
Ta 250,23,50176
Mvaa 200,208,104
Mvaa 200,212,120
buffer_load_dwordx4 a[56:59], v11, s[20:23], s53 offen offset:1024 sc1
Mvaa 232,208,108
Ta 252,23,57344
Ta 254,23,58368
Mvaa 232,212,124
Mvaa 140,216,96
Mvaa 140,220,112
buffer_load_dwordx4 a[60:63], v11, s[20:23], s52 offen offset:1024 sc1
Mvaa 172,216,100
s_xor_b32 s52, s52, 6144
s_add_u32 s53, s52, s58
Mvaa 172,220,116
Mvaa 204,216,104
Mvaa 204,220,120
Mvaa 236,216,108
s_waitcnt lgkmcnt(0)
Mvaa 236,220,124
s_barrier
Mvaa 144,224,96
s_add_u32 s59, s38, 43008
Mvaa 144,228,112
s_add_u32 m0, s44, 49152
Ta 192,16,0
Ta 194,16,1024
Mvaa 176,224,100
buffer_load_dwordx4 v8, s[8:11], s48 offen offset:0 lds
Mvaa 176,228,116
buffer_store_dwordx4 v[120:123], v2, s[24:27], s59 offen offset:0 sc1
Mvaa 208,224,104
Ta 196,16,8192
Ta 198,16,9216
Mvaa 208,228,120
ds_read_b64 v[56:57], v13 offset:0
ds_read_b64 v[58:59], v13 offset:512
Mvaa 240,224,108
buffer_load_dwordx4 v8, s[8:11], s49 offen offset:1024 lds
Mvaa 240,228,124
Ta 200,17,0
Ta 202,17,1024
Mvaa 148,232,96
ds_read_b64 v[60:61], v13 offset:1024
ds_read_b64 v[62:63], v13 offset:1536
Mvaa 148,236,112
Mvaa 180,232,100
Ta 204,17,8192
Ta 206,17,9216
Mvaa 180,236,116
buffer_load_dwordx4 a[64:67], v10, s[20:23], s53 offen offset:0 sc1
Mvaa 212,232,104
s_waitcnt lgkmcnt(2)
v_max_u32 v14, v56, v57
v_min_u32 v15, v56, v57
Mvaa 212,236,120
Ta 208,18,0
Ta 210,18,1024
Mvaa 244,232,108
v_med3_u32 v15, v14, v15, v58
v_max_u32_e64 v14, v14, v58
Mvaa 244,236,124
v_med3_u32 v15, v14, v15, v59
v_max_u32_e64 v14, v14, v59
Mvaa 152,240,96
s_waitcnt lgkmcnt(6)
Ta 212,18,8192
Ta 214,18,9216
Mvaa 152,244,112
buffer_load_dwordx4 a[68:71], v10, s[20:23], s52 offen offset:0 sc1
Mvaa 184,240,100
v_med3_u32 v15, v14, v15, v60
v_max_u32 v14, v14, v60
Mvaa 184,244,116
Ta 216,19,0
Ta 218,19,1024
Mvaa 216,240,104
v_med3_u32 v15, v14, v15, v61
v_max_u32_e64 v14, v14, v61
Mvaa 216,244,120
buffer_load_dwordx4 a[72:75], v11, s[20:23], s53 offen offset:0 sc1
Mvaa 248,240,108
Ta 220,19,8192
Ta 222,19,9216
Mvaa 248,244,124
v_med3_u32 v15, v14, v15, v62
v_max_u32_e64 v14, v14, v62
Mvaa 156,248,96
v_med3_u32 v15, v14, v15, v63
v_max_u32_e64 v14, v14, v63
Mvaa 156,252,112
buffer_load_dwordx4 a[76:79], v11, s[20:23], s52 offen offset:0 sc1
Mvaa 188,248,100
v_mov_b32_e64 v13, v14
Mvaa 188,252,116
buffer_store_dwordx4 v[124:127], v2, s[24:27], s59 offen offset:1024 sc1
Mvaa 220,248,104
v_max_u32_dpp v13, v13, v13 quad_perm:[1,0,3,2] row_mask:0xf bank_mask:0xf
Mvaa 220,252,120
Mvaa 252,248,108
s_waitcnt vmcnt(22) lgkmcnt(0)
Mvaa 252,252,124
Mvaa 128,192,0
v_max_u32_dpp v13, v13, v13 quad_perm:[2,3,0,1] row_mask:0xf bank_mask:0xf
Mvaa 128,196,16
Ta 224,20,0
Ta 226,20,1024
Mvaa 160,192,4
buffer_load_dwordx4 v9, s[8:11], s50 offen offset:2048 lds
Mvaa 160,196,20
v_max_u32_dpp v13, v13, v13 row_half_mirror row_mask:0xf bank_mask:0xf
Mvaa 192,192,8
Ta 228,20,8192
Ta 230,20,9216
Mvaa 192,196,24
v_max_u32_dpp v13, v13, v13 row_mirror row_mask:0xf bank_mask:0xf
Mvaa 224,192,12
buffer_load_dwordx4 v9, s[8:11], s51 offen offset:3072 lds
Mvaa 224,196,28
Ta 232,21,0
Ta 234,21,1024
Mvaa 132,200,0
v_xor_b32 v8, 3670016, v8
v_xor_b32 v9, 3670016, v9
Mvaa 132,204,16
v_readlane_b32 s3, v13, 0
v_readlane_b32 s47, v13, 16
Mvaa 164,200,4
Ta 236,21,8192
Ta 238,21,9216
Mvaa 164,204,20
buffer_load_dwordx4 a[80:83], v10, s[20:23], s53 offen offset:1024 sc1
Mvaa 196,200,8
v_readlane_b32 s4, v13, 32
v_readlane_b32 s5, v13, 48
Mvaa 196,204,24
Ta 240,22,0
Ta 242,22,1024
Mvaa 228,200,12
s_max_u32 s3, s3, s47
s_max_u32 s4, s4, s5
s_max_u32 s40, s3, s4
Mvaa 228,204,28
v_cmp_eq_u32 vcc, s40, v14
Mvaa 136,208,0
s_waitcnt lgkmcnt(6)
Ta 244,22,8192
Ta 246,22,9216
Mvaa 136,212,16
buffer_load_dwordx4 a[84:87], v10, s[20:23], s52 offen offset:1024 sc1
Mvaa 168,208,4
v_cndmask_b32 v13, v14, v15, vcc
Mvaa 168,212,20
Ta 248,23,0
Ta 250,23,1024
Mvaa 200,208,8
v_max_u32_dpp v13, v13, v13 quad_perm:[1,0,3,2] row_mask:0xf bank_mask:0xf
Mvaa 200,212,24
buffer_load_dwordx4 a[88:91], v11, s[20:23], s53 offen offset:1024 sc1
Mvaa 232,208,12
Ta 252,23,8192
Ta 254,23,9216
Mvaa 232,212,28
buffer_store_dwordx4 v[24:27], v2, s[24:27], s59 offen offset:2048 sc1
Mvaa 140,216,0
v_max_u32_dpp v13, v13, v13 quad_perm:[2,3,0,1] row_mask:0xf bank_mask:0xf
Mvaa 140,220,16
buffer_load_dwordx4 a[92:95], v11, s[20:23], s52 offen offset:1024 sc1
Mvaa 172,216,4
s_xor_b32 s52, s52, 2048
s_add_u32 s53, s52, s58
Mvaa 172,220,20
v_max_u32_dpp v13, v13, v13 row_half_mirror row_mask:0xf bank_mask:0xf
Mvaa 204,216,8
s_nop 0
v_max_u32_dpp v13, v13, v13 row_mirror row_mask:0xf bank_mask:0xf
Mvaa 204,220,24
Mvaa 236,216,12
s_waitcnt lgkmcnt(0)
Mvaa 236,220,28
s_barrier
Mvaa 144,224,0
v_readlane_b32 s3, v13, 0
v_readlane_b32 s47, v13, 16
Mvaa 144,228,16
s_add_u32 m0, s44, 0
Ta 192,16,16384
Ta 194,16,17408
Mvaa 176,224,4
buffer_load_dwordx4 v8, s[8:11], s48 offen offset:0 lds
Mvaa 176,228,20
v_readlane_b32 s4, v13, 32
v_readlane_b32 s5, v13, 48
Mvaa 208,224,8
Ta 196,16,24576
Ta 198,16,25600
Mvaa 208,228,24
s_max_u32 s3, s3, s47
s_max_u32 s4, s4, s5
s_max_u32 s41, s3, s4
Mvaa 240,224,12
buffer_load_dwordx4 v8, s[8:11], s49 offen offset:1024 lds
Mvaa 240,228,28
Ta 200,17,16384
Ta 202,17,17408
Mvaa 148,232,0
s_and_b32 s3, s40, 0xffff
s_sub_u32 s42, 0xffff, s3
s_and_b32 s3, s41, 0xffff
Mvaa 148,236,16
s_sub_u32 s43, 0xffff, s3
v_mov_b32 v60, s40
v_not_b32_e64 v61, v60
Mvaa 180,232,4
Ta 204,17,24576
Ta 206,17,25600
Mvaa 180,236,20
buffer_load_dwordx4 a[96:99], v10, s[20:23], s53 offen offset:0 sc1
Mvaa 212,232,8
v_ashrrev_i32_e64 v61, 31, v61
v_or_b32 v61, 0x80000000, v61
Mvaa 212,236,24
Ta 208,18,16384
Ta 210,18,17408
Mvaa 244,232,12
v_xor_b32_e64 v60, v60, v61
v_and_b32 v60, 0xffff0000, v60
Mvaa 244,236,28
v_mul_f32 v60, 0xbfb8aa3b, v60
Mvaa 152,240,0
s_waitcnt lgkmcnt(6)
Ta 212,18,24576
Ta 214,18,25600
Mvaa 152,244,16
buffer_load_dwordx4 a[100:103], v10, s[20:23], s52 offen offset:0 sc1
Mvaa 184,240,4
buffer_store_dwordx4 v[28:31], v2, s[24:27], s59 offen offset:3072 sc1
Mvaa 184,244,20
Ta 216,19,16384
Ta 218,19,17408
Mvaa 216,240,8
Ve 60,60
Mvaa 216,244,24
buffer_load_dwordx4 a[104:107], v11, s[20:23], s53 offen offset:0 sc1
Mvaa 248,240,12
Ta 220,19,24576
Ta 222,19,25600
Mvaa 248,244,28
v_add_f32_e64 v60, 1.0, v60
Mvaa 156,248,0
v_rcp_f32_e64 v60, v60
Mvaa 156,252,16
buffer_load_dwordx4 a[108:111], v11, s[20:23], s52 offen offset:0 sc1
Mvaa 188,248,4
Vc 60,60,60
v_and_b32 v64, 0xffff0000, v60
Mvaa 188,252,20
v_mov_b32 v60, s41
v_not_b32 v61, v60
Mvaa 220,248,8
v_ashrrev_i32_e64 v61, 31, v61
v_or_b32 v61, 0x80000000, v61
Mvaa 220,252,24
v_xor_b32_e64 v60, v60, v61
v_and_b32 v60, 0xffff0000, v60
Mvaa 252,248,12
s_waitcnt vmcnt(22) lgkmcnt(0)
v_mul_f32 v60, 0xbfb8aa3b, v60
Mvaa 252,252,28
Ve 60,60
Mvaa 128,192,32
v_add_f32_e64 v60, 1.0, v60
Mvaa 128,196,48
Ta 224,20,16384
Ta 226,20,17408
Mvaa 160,192,36
buffer_load_dwordx4 v9, s[8:11], s50 offen offset:2048 lds
Mvaa 160,196,52
v_rcp_f32_e64 v60, v60
Mvaa 192,192,40
Ta 228,20,24576
Ta 230,20,25600
Mvaa 192,196,56
Vc 60,60,60
v_and_b32 v65, 0xffff0000, v60
Mvaa 224,192,44
buffer_load_dwordx4 v9, s[8:11], s51 offen offset:3072 lds
Mvaa 224,196,60
Ta 232,21,16384
Ta 234,21,17408
Mvaa 132,200,32
v_xor_b32 v8, 524288, v8
v_xor_b32 v9, 524288, v9
Mvaa 132,204,48
v_mov_b32 v48, 0
v_mov_b32 v49, 0
Mvaa 164,200,36
Ta 236,21,24576
Ta 238,21,25600
Mvaa 164,204,52
buffer_load_dwordx4 a[112:115], v10, s[20:23], s53 offen offset:1024 sc1
Mvaa 196,200,40
s_add_u32 s59, s38, 47104
Mvaa 196,204,56
Ta 240,22,16384
Ta 242,22,17408
Mvaa 228,200,44
buffer_store_dwordx4 v[32:35], v2, s[24:27], s59 offen offset:0 sc1
Mvaa 228,204,60
v_mov_b32 v50, 0
v_mov_b32 v51, 0
Mvaa 136,208,32
s_waitcnt lgkmcnt(6)
Ta 244,22,24576
Ta 246,22,25600
Mvaa 136,212,48
buffer_load_dwordx4 a[116:119], v10, s[20:23], s52 offen offset:1024 sc1
Mvaa 168,208,36
v_mov_b32 v52, 0
v_mov_b32_e64 v53, 0
Mvaa 168,212,52
Ta 248,23,16384
Ta 250,23,17408
Mvaa 200,208,40
v_mov_b32 v54, 0
v_mov_b32 v55, 0
Mvaa 200,212,56
buffer_load_dwordx4 a[120:123], v11, s[20:23], s53 offen offset:1024 sc1
Mvaa 232,208,44
Ta 252,23,24576
Ta 254,23,25600
Mvaa 232,212,60
v_mov_b32 v56, 0
v_mov_b32 v57, 0
Mvaa 140,216,32
v_mov_b32 v58, 0
v_mov_b32 v59, 0
Mvaa 140,220,48
buffer_load_dwordx4 a[124:127], v11, s[20:23], s52 offen offset:1024 sc1
Mvaa 172,216,36
s_xor_b32 s52, s52, 14336
s_add_u32 s53, s52, s58
Mvaa 172,220,52
v_mov_b32 v60, 0
v_mov_b32_e64 v61, 0
Mvaa 204,216,40
v_mov_b32 v62, 0
v_mov_b32 v63, 0
Mvaa 204,220,56
Mvaa 236,216,44
s_waitcnt lgkmcnt(0)
Mvaa 236,220,60
s_barrier
Mvaa 144,224,32
s_mul_i32 s3, s34, s34
s_mul_i32 s47, s33, 48
s_add_u32 s3, s3, s47
Mvaa 144,228,48
s_add_u32 m0, s44, 16384
Ta 192,16,32768
Ta 194,16,33792
Mvaa 176,224,36
buffer_load_dwordx4 v8, s[8:11], s48 offen offset:0 lds
Mvaa 176,228,52
s_lshl_b32 s3, s3, 2
s_add_u32 s3, s3, s32
s_lshl_b32 s3, s3, 7
Mvaa 208,224,40
Ta 196,16,40960
Ta 198,16,41984
Mvaa 208,228,56
s_sub_u32 s3, s3, 8704
s_cmp_ge_u32 s34, 4
s_cselect_b32 s3, s3, 0
s_cselect_b32 s40, 512, 0
s_cselect_b32 s47, 786432, 0
Mvaa 240,224,44
buffer_load_dwordx4 v8, s[8:11], s49 offen offset:1024 lds
Mvaa 240,228,60
Ta 200,17,32768
Ta 202,17,33792
Mvaa 148,232,32
buffer_store_dwordx4 v[36:39], v2, s[24:27], s59 offen offset:1024 sc1
Mvaa 148,236,48
v_subrev_u32_e64 v31, 0, v0
v_mul_lo_u32 v31, v31, s47
Mvaa 180,232,36
Ta 204,17,40960
Ta 206,17,41984
Mvaa 180,236,52
buffer_load_dwordx4 a[0:3], v10, s[20:23], s53 offen offset:0 sc1
Mvaa 212,232,40
v_min_u32 v31, 6553600, v31
v_mov_b32_e64 v28, s94
Mvaa 212,236,56
Ta 208,18,32768
Ta 210,18,33792
Mvaa 244,232,44
v_mov_b32 v29, s95
v_mov_b32 v30, v31
Mvaa 244,236,60
v_subrev_u32_e64 v31, 10, v0
v_mul_lo_u32 v31, v31, s47
Mvaa 152,240,32
s_waitcnt lgkmcnt(6)
Ta 212,18,40960
Ta 214,18,41984
Mvaa 152,244,48
buffer_load_dwordx4 a[4:7], v10, s[20:23], s52 offen offset:0 sc1
Mvaa 184,240,36
v_min_u32 v31, 6553600, v31
v_mov_b32 v14, s68
Mvaa 184,244,52
Ta 216,19,32768
Ta 218,19,33792
Mvaa 216,240,40
v_mov_b32_e64 v15, s69
Mvaa 216,244,56
buffer_load_dwordx4 a[8:11], v11, s[20:23], s53 offen offset:0 sc1
Mvaa 248,240,44
Ta 220,19,40960
Ta 222,19,41984
Mvaa 248,244,60
v_cmp_le_u32 vcc, 10, v0
Mvaa 156,248,32
s_nop 0
v_cndmask_b32 v28, v28, v14, vcc
v_cndmask_b32 v29, v29, v15, vcc
Mvaa 156,252,48
buffer_load_dwordx4 a[12:15], v11, s[20:23], s52 offen offset:0 sc1
Mvaa 188,248,36
v_cndmask_b32 v30, v30, v31, vcc
Mvaa 188,252,52
v_subrev_u32 v31, 20, v0
v_mul_lo_u32 v31, v31, s47
Mvaa 220,248,40
v_min_u32 v31, 7602176, v31
v_mov_b32_e64 v14, s92
Mvaa 220,252,56
v_mov_b32_e64 v15, s93
Mvaa 252,248,44
s_waitcnt vmcnt(21) lgkmcnt(0)
Mvaa 252,252,60
Mvaa 128,192,64
buffer_store_dwordx4 v[40:43], v2, s[24:27], s59 offen offset:2048 sc1
Mvaa 128,196,80
Ta 224,20,32768
Ta 226,20,33792
Mvaa 160,192,68
buffer_load_dwordx4 v9, s[8:11], s50 offen offset:2048 lds
Mvaa 160,196,84
v_cmp_le_u32 vcc, 20, v0
Mvaa 192,192,72
Ta 228,20,40960
Ta 230,20,41984
Mvaa 192,196,88
v_cndmask_b32 v28, v28, v14, vcc
v_cndmask_b32 v29, v29, v15, vcc
Mvaa 224,192,76
buffer_load_dwordx4 v9, s[8:11], s51 offen offset:3072 lds
Mvaa 224,196,92
Ta 232,21,32768
Ta 234,21,33792
Mvaa 132,200,64
v_xor_b32 v8, 1572864, v8
v_xor_b32 v9, 1572864, v9
Mvaa 132,204,80
v_cndmask_b32 v30, v30, v31, vcc
Mvaa 164,200,68
Ta 236,21,40960
Ta 238,21,41984
Mvaa 164,204,84
buffer_load_dwordx4 a[16:19], v10, s[20:23], s53 offen offset:1024 sc1
Mvaa 196,200,72
v_add_u32 v30, s3, v30
v_ashrrev_i32_e64 v31, 31, v30
Mvaa 196,204,88
Ta 240,22,32768
Ta 242,22,33792
Mvaa 228,200,76
v_lshl_add_u64 v[28:29], v[30:31], 0, v[28:29]
Mvaa 228,204,92
s_mov_b32 s41, 0
v_readfirstlane_b32 s100, v64
v_readfirstlane_b32 s101, v65
Mvaa 136,208,64
s_waitcnt lgkmcnt(6)
Ta 244,22,40960
Ta 246,22,41984
Mvaa 136,212,80
buffer_load_dwordx4 a[20:23], v10, s[20:23], s52 offen offset:1024 sc1
Mvaa 168,208,68
Mvaa 168,212,84
Ta 248,23,32768
Ta 250,23,33792
Mvaa 200,208,72
Mvaa 200,212,88
buffer_load_dwordx4 a[24:27], v11, s[20:23], s53 offen offset:1024 sc1
Mvaa 232,208,76
Ta 252,23,40960
Ta 254,23,41984
Mvaa 232,212,92
Mvaa 140,216,64
Mvaa 140,220,80
buffer_load_dwordx4 a[28:31], v11, s[20:23], s52 offen offset:1024 sc1
Mvaa 172,216,68
s_xor_b32 s52, s52, 2048
s_add_u32 s53, s52, s58
Mvaa 172,220,84
buffer_store_dwordx4 v[44:47], v2, s[24:27], s59 offen offset:3072 sc1
Mvaa 204,216,72
v_mov_b32 v12, 1
v_and_b32_e64 v1, 15, v0
Mvaa 204,220,88
v_lshlrev_b32_e64 v1, 2, v1
Mvaa 236,216,76
s_waitcnt lgkmcnt(0)
Mvaa 236,220,92
s_barrier
Mvaa 144,224,64
s_lshr_b32 s6, s33, 1
s_lshl_b32 s6, s6, 7
s_add_u32 s6, s6, 5296128
Mvaa 144,228,80
s_add_u32 m0, s44, 32768
Ta 192,16,49152
Ta 194,16,50176
Mvaa 176,224,68
buffer_load_dwordx4 v8, s[8:11], s48 offen offset:0 lds
Mvaa 176,228,84
s_cmp_eq_u32 s32, 0
s_cselect_b32 s6, s6, 2146435072
Mvaa 208,224,72
Ta 196,16,57344
Ta 198,16,58368
Mvaa 208,228,88
Mvaa 240,224,76
buffer_load_dwordx4 v8, s[8:11], s49 offen offset:1024 lds
Mvaa 240,228,92
Ta 200,17,49152
Ta 202,17,50176
Mvaa 148,232,64
Mvaa 148,236,80
Mvaa 180,232,68
Ta 204,17,57344
Ta 206,17,58368
Mvaa 180,236,84
buffer_load_dwordx4 a[32:35], v10, s[20:23], s53 offen offset:0 sc1
Mvaa 212,232,72
Mvaa 212,236,88
Ta 208,18,49152
Ta 210,18,50176
Mvaa 244,232,76
Mvaa 244,236,92
Mvaa 152,240,64
s_waitcnt lgkmcnt(6)
Ta 212,18,57344
Ta 214,18,58368
Mvaa 152,244,80
buffer_load_dwordx4 a[36:39], v10, s[20:23], s52 offen offset:0 sc1
Mvaa 184,240,68
Mvaa 184,244,84
Ta 216,19,49152
Ta 218,19,50176
Mvaa 216,240,72
Mvaa 216,244,88
buffer_load_dwordx4 a[40:43], v11, s[20:23], s53 offen offset:0 sc1
Mvaa 248,240,76
Ta 220,19,57344
Ta 222,19,58368
Mvaa 248,244,92
Mvaa 156,248,64
Mvaa 156,252,80
buffer_load_dwordx4 a[44:47], v11, s[20:23], s52 offen offset:0 sc1
Mvaa 188,248,68
Mvaa 188,252,84
Mvaa 220,248,72
Mvaa 220,252,88
Mvaa 252,248,76
s_waitcnt vmcnt(21) lgkmcnt(0)
Mvaa 252,252,92
Mvaa 128,192,96
Mvaa 128,196,112
Ta 224,20,49152
Ta 226,20,50176
Mvaa 160,192,100
buffer_load_dwordx4 v9, s[8:11], s50 offen offset:2048 lds
Mvaa 160,196,116
Mvaa 192,192,104
Ta 228,20,57344
Ta 230,20,58368
Mvaa 192,196,120
Mvaa 224,192,108
buffer_load_dwordx4 v9, s[8:11], s51 offen offset:3072 lds
Mvaa 224,196,124
Ta 232,21,49152
Ta 234,21,50176
Mvaa 132,200,96
v_xor_b32 v8, 524288, v8
v_xor_b32 v9, 524288, v9
Mvaa 132,204,112
Mvaa 164,200,100
Ta 236,21,57344
Ta 238,21,58368
Mvaa 164,204,116
buffer_load_dwordx4 a[48:51], v10, s[20:23], s53 offen offset:1024 sc1
Mvaa 196,200,104
Mvaa 196,204,120
Ta 240,22,49152
Ta 242,22,50176
Mvaa 228,200,108
Mvaa 228,204,124
Mvaa 136,208,96
s_waitcnt lgkmcnt(6)
Ta 244,22,57344
Ta 246,22,58368
Mvaa 136,212,112
buffer_load_dwordx4 a[52:55], v10, s[20:23], s52 offen offset:1024 sc1
Mvaa 168,208,100
Mvaa 168,212,116
Ta 248,23,49152
Ta 250,23,50176
Mvaa 200,208,104
Mvaa 200,212,120
buffer_load_dwordx4 a[56:59], v11, s[20:23], s53 offen offset:1024 sc1
Mvaa 232,208,108
Ta 252,23,57344
Ta 254,23,58368
Mvaa 232,212,124
Mvaa 140,216,96
Mvaa 140,220,112
buffer_load_dwordx4 a[60:63], v11, s[20:23], s52 offen offset:1024 sc1
Mvaa 172,216,100
s_xor_b32 s52, s52, 6144
s_add_u32 s53, s52, s58
Mvaa 172,220,116
Mvaa 204,216,104
Mvaa 204,220,120
Mvaa 236,216,108
s_waitcnt lgkmcnt(0)
Mvaa 236,220,124
s_barrier
Mvaa 144,224,96
Mvaa 144,228,112
s_add_u32 m0, s44, 49152
Ta 192,16,0
Ta 194,16,1024
Mvaa 176,224,100
buffer_load_dwordx4 v8, s[8:11], s48 offen offset:0 lds
Mvaa 176,228,116
Mvaa 208,224,104
Ta 196,16,8192
Ta 198,16,9216
Mvaa 208,228,120
Mvaa 240,224,108
buffer_load_dwordx4 v8, s[8:11], s49 offen offset:1024 lds
Mvaa 240,228,124
Ta 200,17,0
Ta 202,17,1024
Mvaa 148,232,96
Mvaa 148,236,112
Mvaa 180,232,100
Ta 204,17,8192
Ta 206,17,9216
Mvaa 180,236,116
buffer_load_dwordx4 a[64:67], v10, s[20:23], s53 offen offset:0 sc1
Mvaa 212,232,104
Mvaa 212,236,120
Ta 208,18,0
Ta 210,18,1024
Mvaa 244,232,108
Mvaa 244,236,124
Mvaa 152,240,96
s_waitcnt lgkmcnt(6)
Ta 212,18,8192
Ta 214,18,9216
Mvaa 152,244,112
buffer_load_dwordx4 a[68:71], v10, s[20:23], s52 offen offset:0 sc1
Mvaa 184,240,100
Mvaa 184,244,116
Ta 216,19,0
Ta 218,19,1024
Mvaa 216,240,104
Mvaa 216,244,120
buffer_load_dwordx4 a[72:75], v11, s[20:23], s53 offen offset:0 sc1
Mvaa 248,240,108
Ta 220,19,8192
Ta 222,19,9216
Mvaa 248,244,124
Mvaa 156,248,96
Mvaa 156,252,112
buffer_load_dwordx4 a[76:79], v11, s[20:23], s52 offen offset:0 sc1
Mvaa 188,248,100
Mvaa 188,252,116
Mvaa 220,248,104
Mvaa 220,252,120
Mvaa 252,248,108
s_waitcnt vmcnt(19) lgkmcnt(0)
Mvaa 252,252,124
Mvaa 128,192,0
Mvaa 128,196,16
Ta 224,20,0
Ta 226,20,1024
Mvaa 160,192,4
buffer_load_dwordx4 v9, s[8:11], s50 offen offset:2048 lds
Mvaa 160,196,20
Mvaa 192,192,8
Ta 228,20,8192
Ta 230,20,9216
Mvaa 192,196,24
Mvaa 224,192,12
buffer_load_dwordx4 v9, s[8:11], s51 offen offset:3072 lds
Mvaa 224,196,28
Ta 232,21,0
Ta 234,21,1024
Mvaa 132,200,0
v_xor_b32 v8, 7864320, v8
v_xor_b32 v9, 7864320, v9
Mvaa 132,204,16
Mvaa 164,200,4
Ta 236,21,8192
Ta 238,21,9216
Mvaa 164,204,20
buffer_load_dwordx4 a[80:83], v10, s[20:23], s53 offen offset:1024 sc1
Mvaa 196,200,8
Mvaa 196,204,24
Ta 240,22,0
Ta 242,22,1024
Mvaa 228,200,12
Mvaa 228,204,28
Mvaa 136,208,0
s_waitcnt lgkmcnt(6)
Ta 244,22,8192
Ta 246,22,9216
Mvaa 136,212,16
buffer_load_dwordx4 a[84:87], v10, s[20:23], s52 offen offset:1024 sc1
Mvaa 168,208,4
Mvaa 168,212,20
Ta 248,23,0
Ta 250,23,1024
Mvaa 200,208,8
Mvaa 200,212,24
buffer_load_dwordx4 a[88:91], v11, s[20:23], s53 offen offset:1024 sc1
Mvaa 232,208,12
Ta 252,23,8192
Ta 254,23,9216
Mvaa 232,212,28
Mvaa 140,216,0
Mvaa 140,220,16
buffer_load_dwordx4 a[92:95], v11, s[20:23], s52 offen offset:1024 sc1
Mvaa 172,216,4
s_xor_b32 s52, s52, 2048
s_add_u32 s53, s52, s58
Mvaa 172,220,20
Mvaa 204,216,8
Mvaa 204,220,24
Mvaa 236,216,12
s_waitcnt vmcnt(24) lgkmcnt(0)
Mvaa 236,220,28
s_barrier
Mvaa 144,224,0
s_mov_b64 exec, 1
buffer_store_dword v12, v7, s[20:23], s39 offen sc1
s_mov_b64 exec, -1
Mvaa 144,228,16
Ta 192,16,16384
Ta 194,16,17408
Mvaa 176,224,4
buffer_load_dwordx4 a[96:99], v10, s[20:23], s53 offen offset:0 sc1
Mvaa 176,228,20
s_mov_b32 s24, s60
s_mov_b32 s25, s61
s_mov_b32 s26, s62
Mvaa 208,224,8
Ta 196,16,24576
Ta 198,16,25600
Mvaa 208,228,24
s_add_u32 s93, s2, 224
s_and_b32 s93, s93, 255
s_mul_i32 s92, s93, 2341
Mvaa 240,224,12
s_lshr_b32 s92, s92, 16
s_mul_i32 s47, s92, 28
s_sub_u32 s4, s93, s47
Mvaa 240,228,28
Ta 200,17,16384
Ta 202,17,17408
Mvaa 148,232,0
s_mul_i32 s5, s92, 917504
s_lshl_b32 s47, s4, 8
s_add_u32 s5, s5, s47
Mvaa 148,236,16
buffer_load_dwordx4 a[100:103], v10, s[20:23], s52 offen offset:0 sc1
Mvaa 180,232,4
Ta 204,17,24576
Ta 206,17,25600
Mvaa 180,236,20
v_lshrrev_b32 v24, 4, v0
v_and_b32_e64 v25, 15, v0
Mvaa 212,232,8
s_lshl_b32 s3, s32, 4
v_add_u32 v26, s3, v24
v_mul_u32_u24 v26, 7168, v26
Mvaa 212,236,24
Ta 208,18,16384
Ta 210,18,17408
Mvaa 244,232,12
v_lshlrev_b32 v24, 1, v24
v_xor_b32 v24, v24, v25
Mvaa 244,236,28
v_lshl_add_u32 v24, v24, 4, v26
v_xor_b32 v25, 128, v24
Mvaa 152,240,0
s_waitcnt lgkmcnt(6)
Ta 212,18,24576
Ta 214,18,25600
Mvaa 152,244,16
buffer_load_dwordx4 a[104:107], v11, s[20:23], s53 offen offset:0 sc1
Mvaa 184,240,4
s_mov_b32 s94, 1040356334
s_mov_b32 s95, 1040356334
s_sub_u32 s55, 15, s34
Mvaa 184,244,20
Ta 216,19,16384
Ta 218,19,17408
Mvaa 216,240,8
s_sub_u32 s45, s36, 3
s_sub_u32 s46, s35, 3
s_mov_b32 s54, s44
Mvaa 216,244,24
s_sub_u32 s35, s35, 2
s_sub_u32 s36, s36, 2
Mvaa 248,240,12
Ta 220,19,24576
Ta 222,19,25600
Mvaa 248,244,28
Mvaa 156,248,0
buffer_load_dwordx4 a[108:111], v11, s[20:23], s52 offen offset:0 sc1
Mvaa 156,252,16
Mvaa 188,248,4
Mvaa 188,252,20
Mvaa 220,248,8
Mvaa 220,252,24
Mvaa 252,248,12
s_waitcnt vmcnt(17) lgkmcnt(0)
Mvaa 252,252,28
Mvaa 128,192,32
v_accvgpr_write_b32 a0, 0
v_accvgpr_write_b32 a1, 0
Mvaa 128,196,48
Ta 224,20,16384
Ta 226,20,17408
Mvaa 160,192,36
buffer_load_dwordx4 a[112:115], v10, s[20:23], s53 offen offset:1024 sc1
Mvaa 160,196,52
v_accvgpr_write_b32 a2, 0
v_accvgpr_write_b32 a3, 0
Mvaa 192,192,40
Ta 228,20,24576
Ta 230,20,25600
Mvaa 192,196,56
v_accvgpr_write_b32 a4, 0
v_accvgpr_write_b32 a5, 0
Mvaa 224,192,44
v_accvgpr_write_b32 a6, 0
v_accvgpr_write_b32 a7, 0
Mvaa 224,196,60
Ta 232,21,16384
Ta 234,21,17408
Mvaa 132,200,32
v_accvgpr_write_b32 a8, 0
v_accvgpr_write_b32 a9, 0
Mvaa 132,204,48
buffer_load_dwordx4 a[116:119], v10, s[20:23], s52 offen offset:1024 sc1
Mvaa 164,200,36
Ta 236,21,24576
Ta 238,21,25600
Mvaa 164,204,52
v_accvgpr_write_b32 a10, 0
v_accvgpr_write_b32 a11, 0
Mvaa 196,200,40
v_accvgpr_write_b32 a12, 0
v_accvgpr_write_b32 a13, 0
Mvaa 196,204,56
Ta 240,22,16384
Ta 242,22,17408
Mvaa 228,200,44
v_accvgpr_write_b32 a14, 0
v_accvgpr_write_b32 a15, 0
Mvaa 228,204,60
Mvaa 136,208,32
s_waitcnt lgkmcnt(6)
Ta 244,22,24576
Ta 246,22,25600
Mvaa 136,212,48
buffer_load_dwordx4 a[120:123], v11, s[20:23], s53 offen offset:1024 sc1
Mvaa 168,208,36
Mvaa 168,212,52
Ta 248,23,16384
Ta 250,23,17408
Mvaa 200,208,40
Mvaa 200,212,56
Mvaa 232,208,44
Ta 252,23,24576
Ta 254,23,25600
Mvaa 232,212,60
Mvaa 140,216,32
buffer_load_dwordx4 a[124:127], v11, s[20:23], s52 offen offset:1024 sc1
Mvaa 140,220,48
Mvaa 172,216,36
Mvaa 172,220,52
Mvaa 204,216,40
Mvaa 204,220,56
Mvaa 236,216,44
s_waitcnt lgkmcnt(0)
Mvaa 236,220,60
s_barrier
Mvaa 144,224,32
v_accvgpr_write_b32 a16, 0
v_accvgpr_write_b32 a17, 0
Mvaa 144,228,48
Ta 192,16,32768
Ta 194,16,33792
Mvaa 176,224,36
v_accvgpr_write_b32 a18, 0
v_accvgpr_write_b32 a19, 0
Mvaa 176,228,52
v_accvgpr_write_b32 a20, 0
v_accvgpr_write_b32 a21, 0
Mvaa 208,224,40
Ta 196,16,40960
Ta 198,16,41984
Mvaa 208,228,56
v_accvgpr_write_b32 a22, 0
v_accvgpr_write_b32 a23, 0
Mvaa 240,224,44
v_accvgpr_write_b32 a24, 0
v_accvgpr_write_b32 a25, 0
Mvaa 240,228,60
Ta 200,17,32768
Ta 202,17,33792
Mvaa 148,232,32
v_accvgpr_write_b32 a26, 0
v_accvgpr_write_b32 a27, 0
Mvaa 148,236,48
v_accvgpr_write_b32 a28, 0
v_accvgpr_write_b32 a29, 0
Mvaa 180,232,36
Ta 204,17,40960
Ta 206,17,41984
Mvaa 180,236,52
buffer_load_dword v12, v1, s[20:23], s6 offen sc1
Mvaa 212,232,40
s_add_u32 m0, s44, 65536
s_mov_b32 s7, 0
Mvaa 212,236,56
Ta 208,18,32768
Ta 210,18,33792
Mvaa 244,232,44
v_accvgpr_write_b32 a30, 0
v_accvgpr_write_b32 a31, 0
Mvaa 244,236,60
Mvaa 152,240,32
s_waitcnt lgkmcnt(6)
Ta 212,18,40960
Ta 214,18,41984
Mvaa 152,244,48
Mvaa 184,240,36
Mvaa 184,244,52
Ta 216,19,32768
Ta 218,19,33792
Mvaa 216,240,40
Mvaa 216,244,56
Mvaa 248,240,44
Ta 220,19,40960
Ta 222,19,41984
Mvaa 248,244,60
Mvaa 156,248,32
Mvaa 156,252,48
Mvaa 188,248,36
Mvaa 188,252,52
Mvaa 220,248,40
Mvaa 220,252,56
Mvaa 252,248,44
s_waitcnt vmcnt(10) lgkmcnt(0)
Mvaa 252,252,60
Mvaa 128,192,64
v_accvgpr_write_b32 a32, 0
v_accvgpr_write_b32 a33, 0
Mvaa 128,196,80
Ta 224,20,32768
Ta 226,20,33792
Mvaa 160,192,68
v_accvgpr_write_b32 a34, 0
v_accvgpr_write_b32 a35, 0
Mvaa 160,196,84
v_accvgpr_write_b32 a36, 0
v_accvgpr_write_b32 a37, 0
Mvaa 192,192,72
Ta 228,20,40960
Ta 230,20,41984
Mvaa 192,196,88
v_accvgpr_write_b32 a38, 0
v_accvgpr_write_b32 a39, 0
Mvaa 224,192,76
v_accvgpr_write_b32 a40, 0
v_accvgpr_write_b32 a41, 0
Mvaa 224,196,92
Ta 232,21,32768
Ta 234,21,33792
Mvaa 132,200,64
v_accvgpr_write_b32 a42, 0
v_accvgpr_write_b32 a43, 0
Mvaa 132,204,80
v_accvgpr_write_b32 a44, 0
v_accvgpr_write_b32 a45, 0
Mvaa 164,200,68
Ta 236,21,40960
Ta 238,21,41984
Mvaa 164,204,84
v_accvgpr_write_b32 a46, 0
v_accvgpr_write_b32 a47, 0
Mvaa 196,200,72
Mvaa 196,204,88
Ta 240,22,32768
Ta 242,22,33792
Mvaa 228,200,76
Mvaa 228,204,92
Mvaa 136,208,64
s_waitcnt lgkmcnt(6)
Ta 244,22,40960
Ta 246,22,41984
Mvaa 136,212,80
Mvaa 168,208,68
Mvaa 168,212,84
Ta 248,23,32768
Ta 250,23,33792
Mvaa 200,208,72
Mvaa 200,212,88
Mvaa 232,208,76
Ta 252,23,40960
Ta 254,23,41984
Mvaa 232,212,92
Mvaa 140,216,64
Mvaa 140,220,80
Mvaa 172,216,68
Mvaa 172,220,84
Mvaa 204,216,72
Mvaa 204,220,88
Mvaa 236,216,76
s_waitcnt vmcnt(0) lgkmcnt(0)
Mvaa 236,220,92
s_cmp_lg_u32 s32, 0
s_cbranch_scc1 L_spinBr
v_cmp_ne_u32 vcc, 1, v12
s_cbranch_vccnz L_spinB
L_spinBr:
s_barrier
Mvaa 144,224,64
buffer_load_dwordx4 v4, s[12:15], s7 offen offset:0 sc1 lds
Mvaa 144,228,80
Ta 192,16,49152
Ta 194,16,50176
Mvaa 176,224,68
v_accvgpr_write_b32 a48, 0
v_accvgpr_write_b32 a49, 0
Mvaa 176,228,84
buffer_load_dwordx4 v4, s[12:15], s7 offen offset:1024 sc1 lds
Mvaa 208,224,72
Ta 196,16,57344
Ta 198,16,58368
Mvaa 208,228,88
v_accvgpr_write_b32 a50, 0
v_accvgpr_write_b32 a51, 0
Mvaa 240,224,76
buffer_load_dwordx4 v4, s[12:15], s7 offen offset:2048 sc1 lds
Mvaa 240,228,92
Ta 200,17,49152
Ta 202,17,50176
Mvaa 148,232,64
v_accvgpr_write_b32 a52, 0
v_accvgpr_write_b32 a53, 0
Mvaa 148,236,80
buffer_load_dwordx4 v4, s[12:15], s7 offen offset:3072 sc1 lds
Mvaa 180,232,68
Ta 204,17,57344
Ta 206,17,58368
Mvaa 180,236,84
s_add_u32 m0, s44, 98304
s_mov_b32 s7, 34816
Mvaa 212,232,72
buffer_load_dwordx4 v4, s[12:15], s7 offen offset:0 sc1 lds
Mvaa 212,236,88
Ta 208,18,49152
Ta 210,18,50176
Mvaa 244,232,76
v_accvgpr_write_b32 a54, 0
v_accvgpr_write_b32 a55, 0
Mvaa 244,236,92
buffer_load_dwordx4 v4, s[12:15], s7 offen offset:1024 sc1 lds
Mvaa 152,240,64
s_waitcnt lgkmcnt(6)
Ta 212,18,57344
Ta 214,18,58368
Mvaa 152,244,80
v_accvgpr_write_b32 a56, 0
v_accvgpr_write_b32 a57, 0
Mvaa 184,240,68
buffer_load_dwordx4 v4, s[12:15], s7 offen offset:2048 sc1 lds
Mvaa 184,244,84
Ta 216,19,49152
Ta 218,19,50176
Mvaa 216,240,72
v_accvgpr_write_b32 a58, 0
v_accvgpr_write_b32 a59, 0
Mvaa 216,244,88
buffer_load_dwordx4 v4, s[12:15], s7 offen offset:3072 sc1 lds
Mvaa 248,240,76
Ta 220,19,57344
Ta 222,19,58368
Mvaa 248,244,92
s_add_u32 m0, s44, 81920
s_mov_b32 s7, 17408
Mvaa 156,248,64
buffer_load_dwordx4 v4, s[12:15], s7 offen offset:0 sc1 lds
Mvaa 156,252,80
v_accvgpr_write_b32 a60, 0
v_accvgpr_write_b32 a61, 0
Mvaa 188,248,68
buffer_load_dwordx4 v4, s[12:15], s7 offen offset:1024 sc1 lds
Mvaa 188,252,84
v_accvgpr_write_b32 a62, 0
v_accvgpr_write_b32 a63, 0
Mvaa 220,248,72
Mvaa 220,252,88
Mvaa 252,248,76
s_waitcnt lgkmcnt(0)
Mvaa 252,252,92
Mvaa 128,192,96
buffer_load_dwordx4 v4, s[12:15], s7 offen offset:2048 sc1 lds
Mvaa 128,196,112
Ta 224,20,49152
Ta 226,20,50176
Mvaa 160,192,100
buffer_load_dwordx4 v4, s[12:15], s7 offen offset:3072 sc1 lds
Mvaa 160,196,116
s_add_u32 m0, s44, 114688
s_mov_b32 s7, 52224
Mvaa 192,192,104
Ta 228,20,57344
Ta 230,20,58368
Mvaa 192,196,120
buffer_load_dwordx4 v4, s[12:15], s7 offen offset:0 sc1 lds
Mvaa 224,192,108
buffer_load_dwordx4 v4, s[12:15], s7 offen offset:1024 sc1 lds
Mvaa 224,196,124
Ta 232,21,49152
Ta 234,21,50176
Mvaa 132,200,96
v_accvgpr_write_b32 a64, 0
v_accvgpr_write_b32 a65, 0
Mvaa 132,204,112
buffer_load_dwordx4 v4, s[12:15], s7 offen offset:2048 sc1 lds
Mvaa 164,200,100
Ta 236,21,57344
Ta 238,21,58368
Mvaa 164,204,116
v_accvgpr_write_b32 a66, 0
v_accvgpr_write_b32 a67, 0
Mvaa 196,200,104
buffer_load_dwordx4 v4, s[12:15], s7 offen offset:3072 sc1 lds
Mvaa 196,204,120
Ta 240,22,49152
Ta 242,22,50176
Mvaa 228,200,108
s_add_u32 m0, s44, 0
s_mov_b32 s7, 69632
Mvaa 228,204,124
buffer_load_dwordx4 v4, s[12:15], s7 offen offset:0 sc1 lds
Mvaa 136,208,96
s_waitcnt lgkmcnt(6)
Ta 244,22,57344
Ta 246,22,58368
Mvaa 136,212,112
buffer_load_dwordx4 v4, s[12:15], s7 offen offset:1024 sc1 lds
Mvaa 168,208,100
v_accvgpr_write_b32 a68, 0
v_accvgpr_write_b32 a69, 0
Mvaa 168,212,116
Ta 248,23,49152
Ta 250,23,50176
Mvaa 200,208,104
buffer_load_dwordx4 v4, s[12:15], s7 offen offset:2048 sc1 lds
Mvaa 200,212,120
v_accvgpr_write_b32 a70, 0
v_accvgpr_write_b32 a71, 0
Mvaa 232,208,108
Ta 252,23,57344
Ta 254,23,58368
Mvaa 232,212,124
buffer_load_dwordx4 v4, s[12:15], s7 offen offset:3072 sc1 lds
Mvaa 140,216,96
s_add_u32 m0, s44, 16384
s_mov_b32 s7, 87040
Mvaa 140,220,112
v_accvgpr_write_b32 a72, 0
v_accvgpr_write_b32 a73, 0
Mvaa 172,216,100
buffer_load_dwordx4 v4, s[12:15], s7 offen offset:0 sc1 lds
Mvaa 172,220,116
v_accvgpr_write_b32 a74, 0
v_accvgpr_write_b32 a75, 0
Mvaa 204,216,104
v_accvgpr_write_b32 a76, 0
v_accvgpr_write_b32 a77, 0
Mvaa 204,220,120
v_accvgpr_write_b32 a78, 0
v_accvgpr_write_b32 a79, 0
Mvaa 236,216,108
s_waitcnt vmcnt(17) lgkmcnt(0)
v_accvgpr_write_b32 a80, 0
v_accvgpr_write_b32 a81, 0
Mvaa 236,220,124
s_barrier
v_accvgpr_write_b32 a82, 0
v_accvgpr_write_b32 a83, 0
Mvaa 144,224,96
buffer_load_dwordx4 v4, s[12:15], s7 offen offset:1024 sc1 lds
Mvaa 144,228,112
buffer_load_dwordx4 v4, s[12:15], s7 offen offset:2048 sc1 lds
Mvaa 148,232,96
Ra 192,3,0
Ra 196,3,1024
Mvaa 148,236,112
buffer_load_dwordx4 v4, s[12:15], s7 offen offset:3072 sc1 lds
Mvaa 152,240,96
s_add_u32 m0, s44, 32768
s_mov_b32 s7, 104448
Mvaa 152,244,112
Ra 200,3,2048
Ra 204,3,3072
Mvaa 156,248,96
buffer_load_dwordx4 v4, s[12:15], s7 offen offset:0 sc1 lds
Mvaa 156,252,112
Ra 208,3,4096
Ra 212,3,5120
Mvaa 176,224,100
buffer_load_dwordx4 v4, s[12:15], s7 offen offset:1024 sc1 lds
Mvaa 176,228,116
Ra 216,3,6144
Ra 220,3,7168
Mvaa 180,232,100
Mvaa 180,236,116
buffer_load_dwordx4 v4, s[12:15], s7 offen offset:2048 sc1 lds
Mvaa 184,240,100
v_mul_f32 v128, s94, v128
v_mul_f32_e64 v129, s94, v129
Mvaa 184,244,116
v_mul_f32 v130, s94, v130
v_mul_f32 v131, s94, v131
Mvaa 188,248,100
buffer_load_dwordx4 v4, s[12:15], s7 offen offset:3072 sc1 lds
Mvaa 188,252,116
v_mul_f32 v132, s94, v132
v_mul_f32 v133, s94, v133
Mvaa 208,224,104
v_mul_f32 v134, s94, v134
v_mul_f32 v135, s94, v135
Mvaa 208,228,120
Vc 128,128,129
Vc 129,130,131
Mvaa 212,232,104
Vc 130,132,133
Vc 131,134,135
Mvaa 212,236,120
Aw 128,128
Aw 129,129
Mvaa 216,240,104
Aw 130,130
Aw 131,131
Mvaa 216,244,120
v_mul_f32 v136, s94, v136
v_mul_f32 v137, s94, v137
Mvaa 220,248,104
v_mul_f32 v138, s94, v138
v_mul_f32 v139, s94, v139
Mvaa 220,252,120
v_mul_f32 v140, s94, v140
v_mul_f32 v141, s94, v141
Mvaa 240,224,108
v_mul_f32 v142, s94, v142
v_mul_f32 v143, s94, v143
Mvaa 240,228,124
Vc 136,136,137
Vc 137,138,139
Mvaa 244,232,108
Vc 138,140,141
Vc 139,142,143
Mvaa 244,236,124
Aw 132,136
Aw 133,137
Mvaa 248,240,108
Aw 134,138
Aw 135,139
Mvaa 248,244,124
v_mul_f32 v144, s94, v144
v_mul_f32 v145, s94, v145
Mvaa 252,248,108
v_mul_f32 v146, s94, v146
v_mul_f32 v147, s94, v147
Mvaa 252,252,124
v_mul_f32 v148, s94, v148
v_mul_f32 v149, s94, v149
Ra 224,3,8192
Ra 228,3,9216
Ra 232,3,10240
Ra 236,3,11264
Ra 240,3,12288
Ra 244,3,13312
Ra 248,3,14336
s_waitcnt lgkmcnt(9)
Ra 252,3,15360
v_mul_f32 v150, s94, v150
v_mul_f32_e64 v151, s94, v151
Vc 144,144,145
Vc 145,146,147
Vc 146,148,149
Vc 147,150,151
Aw 136,144
Aw 137,145
Aw 138,146
Aw 139,147
v_mul_f32 v152, s94, v152
v_mul_f32 v153, s94, v153
v_mul_f32 v154, s94, v154
v_mul_f32 v155, s94, v155
v_mul_f32 v156, s94, v156
v_mul_f32 v157, s94, v157
v_mul_f32 v158, s94, v158
v_mul_f32 v159, s94, v159
Vc 152,152,153
Vc 153,154,155
Vc 154,156,157
Vc 155,158,159
Aw 140,152
Aw 141,153
Aw 142,154
Aw 143,155
Zvaa 128,192,128
v_mul_f32 v160, s94, v160
v_mul_f32 v161, s94, v161
v_mul_f32 v162, s94, v162
v_mul_f32 v163, s94, v163
Mvaa 128,196,132
v_mul_f32 v164, s94, v164
v_mul_f32 v165, s94, v165
v_mul_f32 v166, s94, v166
v_mul_f32 v167, s94, v167
Mvaa 128,200,136
Vc 160,160,161
Vc 161,162,163
Vc 162,164,165
Vc 163,166,167
Mvaa 128,204,140
Aw 144,160
Aw 145,161
Aw 146,162
Aw 147,163
s_waitcnt lgkmcnt(8)
Zvaa 132,208,128
v_mul_f32 v168, s94, v168
v_mul_f32 v169, s94, v169
v_mul_f32 v170, s94, v170
v_mul_f32_e64 v171, s94, v171
Mvaa 132,212,132
v_mul_f32 v172, s94, v172
v_mul_f32 v173, s94, v173
v_mul_f32 v174, s94, v174
v_mul_f32 v175, s94, v175
Mvaa 132,216,136
Vc 168,168,169
Vc 169,170,171
Vc 170,172,173
Vc 171,174,175
Mvaa 132,220,140
Aw 148,168
Aw 149,169
Aw 150,170
Aw 151,171
s_waitcnt lgkmcnt(4)
Zvaa 136,224,128
v_mul_f32 v176, s94, v176
v_mul_f32 v177, s94, v177
v_mul_f32 v178, s94, v178
v_mul_f32_e64 v179, s94, v179
Mvaa 136,228,132
v_mul_f32 v180, s94, v180
v_mul_f32 v181, s94, v181
v_mul_f32 v182, s94, v182
v_mul_f32 v183, s94, v183
Mvaa 136,232,136
Vc 176,176,177
Vc 177,178,179
Vc 178,180,181
Vc 179,182,183
Mvaa 136,236,140
Aw 152,176
Aw 153,177
Aw 154,178
Aw 155,179
s_waitcnt lgkmcnt(0)
Zvaa 140,240,128
v_mul_f32 v184, s94, v184
v_mul_f32 v185, s94, v185
v_mul_f32 v186, s94, v186
v_mul_f32_e64 v187, s94, v187
Mvaa 140,244,132
v_mul_f32 v188, s94, v188
v_mul_f32 v189, s94, v189
v_mul_f32 v190, s94, v190
v_mul_f32 v191, s94, v191
Mvaa 140,248,136
Vc 184,184,185
Vc 185,186,187
Vc 186,188,189
Vc 187,190,191
Mvaa 140,252,140
Aw 156,184
Aw 157,185
Aw 158,186
Aw 159,187
Zvaa 144,192,144
v_mul_f32 v192, s94, v192
v_mul_f32 v193, s94, v193
v_mul_f32 v194, s94, v194
v_mul_f32 v195, s94, v195
Mvaa 144,196,148
v_mul_f32 v196, s94, v196
v_mul_f32 v197, s94, v197
v_mul_f32 v198, s94, v198
v_mul_f32 v199, s94, v199
Mvaa 144,200,152
Vc 192,192,193
Vc 193,194,195
Vc 194,196,197
Vc 195,198,199
Mvaa 144,204,156
Aw 160,192
Aw 161,193
Aw 162,194
Aw 163,195
Zvaa 148,208,144
v_mul_f32 v200, s94, v200
v_mul_f32 v201, s94, v201
v_mul_f32 v202, s94, v202
v_mul_f32 v203, s94, v203
Mvaa 148,212,148
v_mul_f32 v204, s94, v204
v_mul_f32 v205, s94, v205
v_mul_f32 v206, s94, v206
v_mul_f32 v207, s94, v207
Mvaa 148,216,152
Vc 200,200,201
Vc 201,202,203
Vc 202,204,205
Vc 203,206,207
Mvaa 148,220,156
Aw 164,200
Aw 165,201
Aw 166,202
Aw 167,203
Zvaa 152,224,144
v_mul_f32 v208, s94, v208
v_mul_f32 v209, s94, v209
v_mul_f32 v210, s94, v210
v_mul_f32 v211, s94, v211
Mvaa 152,228,148
v_mul_f32 v212, s94, v212
v_mul_f32 v213, s94, v213
v_mul_f32 v214, s94, v214
v_mul_f32 v215, s94, v215
Mvaa 152,232,152
Vc 208,208,209
Vc 209,210,211
Vc 210,212,213
Vc 211,214,215
Mvaa 152,236,156
Aw 168,208
Aw 169,209
Aw 170,210
Aw 171,211
Zvaa 156,240,144
v_mul_f32 v216, s94, v216
v_mul_f32 v217, s94, v217
v_mul_f32 v218, s94, v218
v_mul_f32 v219, s94, v219
Mvaa 156,244,148
v_mul_f32 v220, s94, v220
v_mul_f32 v221, s94, v221
v_mul_f32 v222, s94, v222
v_mul_f32 v223, s94, v223
Mvaa 156,248,152
Vc 216,216,217
Vc 217,218,219
Vc 218,220,221
Vc 219,222,223
Mvaa 156,252,156
Aw 172,216
Aw 173,217
Aw 174,218
Aw 175,219
Zvaa 160,192,160
v_mul_f32 v224, s94, v224
v_mul_f32 v225, s94, v225
v_mul_f32 v226, s94, v226
v_mul_f32 v227, s94, v227
Mvaa 160,196,164
v_mul_f32 v228, s94, v228
v_mul_f32 v229, s94, v229
v_mul_f32 v230, s94, v230
v_mul_f32 v231, s94, v231
Mvaa 160,200,168
Vc 224,224,225
Vc 225,226,227
Vc 226,228,229
Vc 227,230,231
Mvaa 160,204,172
Aw 176,224
Aw 177,225
Aw 178,226
Aw 179,227
Zvaa 164,208,160
v_mul_f32 v232, s94, v232
v_mul_f32 v233, s94, v233
v_mul_f32 v234, s94, v234
v_mul_f32 v235, s94, v235
Mvaa 164,212,164
v_mul_f32 v236, s94, v236
v_mul_f32 v237, s94, v237
v_mul_f32 v238, s94, v238
v_mul_f32 v239, s94, v239
Mvaa 164,216,168
Vc 232,232,233
Vc 233,234,235
Vc 234,236,237
Vc 235,238,239
Mvaa 164,220,172
Aw 180,232
Aw 181,233
Aw 182,234
Aw 183,235
Zvaa 168,224,160
v_mul_f32 v240, s94, v240
v_mul_f32 v241, s94, v241
v_mul_f32 v242, s94, v242
v_mul_f32 v243, s94, v243
Mvaa 168,228,164
v_mul_f32 v244, s94, v244
v_mul_f32 v245, s94, v245
v_mul_f32 v246, s94, v246
v_mul_f32 v247, s94, v247
Mvaa 168,232,168
Vc 240,240,241
Vc 241,242,243
Vc 242,244,245
Vc 243,246,247
Mvaa 168,236,172
Aw 184,240
Aw 185,241
Aw 186,242
Aw 187,243
Zvaa 172,240,160
v_mul_f32 v248, s94, v248
v_mul_f32 v249, s94, v249
v_mul_f32 v250, s94, v250
v_mul_f32 v251, s94, v251
Mvaa 172,244,164
v_mul_f32 v252, s94, v252
v_mul_f32 v253, s94, v253
v_mul_f32 v254, s94, v254
v_mul_f32 v255, s94, v255
Mvaa 172,248,168
Vc 248,248,249
Vc 249,250,251
Vc 250,252,253
Vc 251,254,255
Mvaa 172,252,172
Aw 188,248
Aw 189,249
Aw 190,250
Aw 191,251
Zvaa 176,192,176
v_accvgpr_write_b32 a84, 0
v_accvgpr_write_b32 a85, 0
v_accvgpr_write_b32 a86, 0
v_accvgpr_write_b32 a87, 0
Mvaa 176,196,180
v_accvgpr_write_b32 a88, 0
v_accvgpr_write_b32 a89, 0
v_accvgpr_write_b32 a90, 0
v_accvgpr_write_b32 a91, 0
Mvaa 176,200,184
v_accvgpr_write_b32 a92, 0
v_accvgpr_write_b32 a93, 0
v_accvgpr_write_b32 a94, 0
v_accvgpr_write_b32 a95, 0
Mvaa 176,204,188
v_accvgpr_write_b32 a96, 0
v_accvgpr_write_b32 a97, 0
v_accvgpr_write_b32 a98, 0
v_accvgpr_write_b32 a99, 0
Zvaa 180,208,176
v_accvgpr_write_b32 a100, 0
v_accvgpr_write_b32 a101, 0
v_accvgpr_write_b32 a102, 0
v_accvgpr_write_b32 a103, 0
Mvaa 180,212,180
v_accvgpr_write_b32 a104, 0
v_accvgpr_write_b32 a105, 0
v_accvgpr_write_b32 a106, 0
v_accvgpr_write_b32 a107, 0
Mvaa 180,216,184
v_accvgpr_write_b32 a108, 0
v_accvgpr_write_b32 a109, 0
v_accvgpr_write_b32 a110, 0
v_accvgpr_write_b32 a111, 0
Mvaa 180,220,188
v_accvgpr_write_b32 a112, 0
v_accvgpr_write_b32 a113, 0
v_accvgpr_write_b32 a114, 0
v_accvgpr_write_b32 a115, 0
s_waitcnt vmcnt(16)
s_barrier
s_add_u32 s53, s44, 65536
Zvaa 184,224,176
Ra 192,3,32768
v_accvgpr_write_b32 a116, 0
v_accvgpr_write_b32 a117, 0
v_accvgpr_write_b32 a118, 0
v_accvgpr_write_b32 a119, 0
Mvaa 184,228,180
Ra 196,3,33792
v_accvgpr_write_b32 a120, 0
v_accvgpr_write_b32 a121, 0
v_accvgpr_write_b32 a122, 0
v_accvgpr_write_b32 a123, 0
Mvaa 184,232,184
Ra 200,3,34816
v_accvgpr_write_b32 a124, 0
v_accvgpr_write_b32 a125, 0
v_accvgpr_write_b32 a126, 0
v_accvgpr_write_b32 a127, 0
Mvaa 184,236,188
Ra 204,3,35840
v_and_b32 v16, 3, v0
v_subrev_u32 v16, 1, v16
v_ashrrev_i32_e64 v16, 31, v16
v_and_b32 v16, 0x3f803f80, v16
Zvaa 188,240,176
Ra 208,3,36864
v_mov_b32 v17, v16
v_mov_b32 v18, v16
v_mov_b32_e64 v19, v16
v_mov_b32 v20, 0xff800000
Mvaa 188,244,180
Ra 212,3,37888
v_max3_f32 v22, v128, v129, v130
v_max3_f32 v22, v22, v131, v132
v_max3_f32 v22, v22, v133, v134
v_max3_f32 v22, v22, v135, v136
Mvaa 188,248,184
Ra 216,3,38912
v_max3_f32 v22, v22, v137, v138
v_max3_f32 v22, v22, v139, v140
v_max3_f32 v22, v22, v141, v142
v_max_f32_e64 v22, v22, v143
Mvaa 188,252,188
Ra 220,3,39936
v_mov_b32 v1, v22
s_nop 1
v_permlane16_swap_b32 v1, v22
v_max_f32 v22, v22, v1
v_mov_b32 v1, v22
s_nop 1
v_permlane32_swap_b32 v1, v22
v_max_f32 v22, v22, v1
v_add_f32 v22, 0x41f80000, v22
Vs 128,128,22
Vs 129,129,22
Vs 130,130,22
Vs 131,131,22
Vs 132,132,22
Vs 133,133,22
Vs 134,134,22
Vs 135,135,22
Vs 136,136,22
Vs 137,137,22
Vs 138,138,22
Vs 139,139,22
Vs 140,140,22
Vs 141,141,22
Vs 142,142,22
Vs 143,143,22
v_sub_f32 v32, 0, v22
v_sub_f32 v33, 0, v22
v_sub_f32 v34, 0, v22
v_sub_f32 v35, 0, v22
v_max3_f32 v22, v144, v145, v146
v_max3_f32 v22, v22, v147, v148
v_max3_f32 v22, v22, v149, v150
v_max3_f32 v22, v22, v151, v152
v_max3_f32 v22, v22, v153, v154
v_max3_f32 v22, v22, v155, v156
v_max3_f32 v22, v22, v157, v158
v_max_f32 v22, v22, v159
v_mov_b32 v1, v22
s_nop 1
v_permlane16_swap_b32 v1, v22
v_max_f32 v22, v22, v1
v_mov_b32 v1, v22
s_nop 1
v_permlane32_swap_b32 v1, v22
v_max_f32_e64 v22, v22, v1
v_add_f32 v22, 0x41f80000, v22
Vs 144,144,22
Vs 145,145,22
Vs 146,146,22
Vs 147,147,22
Vs 148,148,22
Vs 149,149,22
Vs 150,150,22
Vs 151,151,22
Vs 152,152,22
Vs 153,153,22
Vs 154,154,22
Vs 155,155,22
Vs 156,156,22
Vs 157,157,22
Vs 158,158,22
Vs 159,159,22
v_sub_f32 v36, 0, v22
v_sub_f32 v37, 0, v22
v_sub_f32 v38, 0, v22
v_sub_f32 v39, 0, v22
s_mov_b32 s38, 139264
s_mov_b32 s39, 121856
s_cmp_lg_u32 s34, 0
s_cbranch_scc1 L_k2_nomask0
v_cmp_gt_i32 s[56:57], 0, v5
v_cmp_gt_i32 s[58:59], 1, v5
v_cmp_gt_i32 s[60:61], 2, v5
v_cmp_gt_i32 s[62:63], 3, v5
s_nop 3
s_nop 0
v_cndmask_b32 v176, v176, v20, s[56:57]
v_cndmask_b32 v177, v177, v20, s[58:59]
v_cndmask_b32 v178, v178, v20, s[60:61]
v_cndmask_b32 v179, v179, v20, s[62:63]
v_cmp_gt_i32 s[56:57], 16, v5
v_cmp_gt_i32 s[58:59], 17, v5
v_cmp_gt_i32 s[60:61], 18, v5
v_cmp_gt_i32 s[62:63], 19, v5
v_cndmask_b32 v180, v180, v20, s[56:57]
v_cndmask_b32 v181, v181, v20, s[58:59]
v_cndmask_b32 v182, v182, v20, s[60:61]
v_cndmask_b32 v183, v183, v20, s[62:63]
v_cmp_gt_i32 s[56:57], 32, v5
v_cmp_gt_i32 s[58:59], 33, v5
v_cmp_gt_i32 s[60:61], 34, v5
v_cmp_gt_i32 s[62:63], 35, v5
v_cndmask_b32 v184, v184, v20, s[56:57]
v_cndmask_b32 v185, v185, v20, s[58:59]
v_cndmask_b32 v186, v186, v20, s[60:61]
v_cndmask_b32 v187, v187, v20, s[62:63]
v_cmp_gt_i32 s[56:57], 48, v5
v_cmp_gt_i32 s[58:59], 49, v5
v_cmp_gt_i32 s[60:61], 50, v5
v_cmp_gt_i32 s[62:63], 51, v5
v_cndmask_b32 v188, v188, v20, s[56:57]
v_cndmask_b32 v189, v189, v20, s[58:59]
v_cndmask_b32 v190, v190, v20, s[60:61]
v_cndmask_b32 v191, v191, v20, s[62:63]
L_k2_nomask0:
s_mov_b32 s37, 0
s_nop 0
v_max3_f32 v22, v160, v161, v162
v_max3_f32 v22, v22, v163, v164
v_max3_f32 v22, v22, v165, v166
v_max3_f32 v22, v22, v167, v168
v_max3_f32 v22, v22, v169, v170
v_max3_f32 v22, v22, v171, v172
v_max3_f32 v22, v22, v173, v174
v_max_f32 v22, v22, v175
v_mov_b32 v1, v22
s_nop 1
v_permlane16_swap_b32 v1, v22
v_max_f32 v22, v22, v1
v_mov_b32 v1, v22
s_nop 1
v_permlane32_swap_b32 v1, v22
v_max_f32_e64 v22, v22, v1
v_add_f32 v22, 0x41f80000, v22
Vs 160,160,22
Vs 161,161,22
Vs 162,162,22
Vs 163,163,22
Vs 164,164,22
Vs 165,165,22
Vs 166,166,22
Vs 167,167,22
Vs 168,168,22
Vs 169,169,22
Vs 170,170,22
Vs 171,171,22
Vs 172,172,22
Vs 173,173,22
Vs 174,174,22
Vs 175,175,22
v_sub_f32 v40, 0, v22
v_sub_f32 v41, 0, v22
v_sub_f32 v42, 0, v22
v_sub_f32 v43, 0, v22
v_max3_f32 v22, v176, v177, v178
v_max3_f32 v22, v22, v179, v180
v_max3_f32 v22, v22, v181, v182
v_max3_f32 v22, v22, v183, v184
v_max3_f32 v22, v22, v185, v186
v_max3_f32 v22, v22, v187, v188
v_max3_f32 v22, v22, v189, v190
v_max_f32 v22, v22, v191
v_mov_b32 v1, v22
s_nop 1
v_permlane16_swap_b32 v1, v22
v_max_f32 v22, v22, v1
v_mov_b32 v1, v22
s_nop 1
v_permlane32_swap_b32 v1, v22
v_max_f32_e64 v22, v22, v1
v_add_f32 v22, 0x41f80000, v22
Vs 176,176,22
Vs 177,177,22
Vs 178,178,22
Vs 179,179,22
Vs 180,180,22
Vs 181,181,22
Vs 182,182,22
Vs 183,183,22
Vs 184,184,22
Vs 185,185,22
Vs 186,186,22
Vs 187,187,22
Vs 188,188,22
Vs 189,189,22
Vs 190,190,22
Vs 191,191,22
v_sub_f32 v44, 0, v22
v_sub_f32 v45, 0, v22
v_sub_f32 v46, 0, v22
v_sub_f32 v47, 0, v22
Ve 8,128
Ve 9,129
Ve 10,130
Ve 11,131
Vc 64,8,9
Ve 12,144
Ve 13,145
Vc 65,10,11
Ve 14,146
Ve 15,147
Vc 72,12,13
Ve 8,160
Ve 9,161
Vc 73,14,15
Ve 10,162
Ve 11,163
Vc 80,8,9
Ve 12,176
Ve 13,177
Vc 81,10,11
Ve 14,178
Ve 15,179
Vc 88,12,13
Ve 8,132
Ve 9,133
Vc 89,14,15
Ve 10,134
Ve 11,135
Vc 66,8,9
Ve 12,148
Ve 13,149
Vc 67,10,11
Ve 14,150
Ve 15,151
Vc 74,12,13
Ve 8,164
Ve 9,165
Vc 75,14,15
Ve 10,166
Ve 11,167
Vc 82,8,9
Ve 12,180
Ve 13,181
Vc 83,10,11
Ve 14,182
Ve 15,183
Vc 90,12,13
Vc 91,14,15
v_or_b32_e64 v7, v64, v65
v_or3_b32 v7, v7, v72, v73
v_or3_b32 v7, v7, v80, v81
v_or3_b32 v7, v7, v88, v89
v_or3_b32 v7, v7, v66, v67
v_or3_b32 v7, v7, v74, v75
v_or3_b32 v7, v7, v82, v83
v_or3_b32 v7, v7, v90, v91
s_waitcnt lgkmcnt(4)
s_cmp_eq_u32 s34, 0
s_cbranch_scc1 L_k2_wlast
s_branch L_k2_wloop
L_k2_mk_wo:
v_cmp_gt_i32 s[56:57], 0, v5
v_cmp_gt_i32 s[58:59], 1, v5
v_cmp_gt_i32 s[60:61], 2, v5
v_cmp_gt_i32 s[62:63], 3, v5
s_nop 3
s_nop 0
v_cndmask_b32 v176, v176, v20, s[56:57]
v_cndmask_b32 v177, v177, v20, s[58:59]
v_cndmask_b32 v178, v178, v20, s[60:61]
v_cndmask_b32 v179, v179, v20, s[62:63]
v_cmp_gt_i32 s[56:57], 16, v5
v_cmp_gt_i32 s[58:59], 17, v5
v_cmp_gt_i32 s[60:61], 18, v5
v_cmp_gt_i32 s[62:63], 19, v5
v_cndmask_b32 v180, v180, v20, s[56:57]
v_cndmask_b32 v181, v181, v20, s[58:59]
v_cndmask_b32 v182, v182, v20, s[60:61]
v_cndmask_b32 v183, v183, v20, s[62:63]
v_cmp_gt_i32 s[56:57], 32, v5
v_cmp_gt_i32 s[58:59], 33, v5
v_cmp_gt_i32 s[60:61], 34, v5
v_cmp_gt_i32 s[62:63], 35, v5
v_cndmask_b32 v184, v184, v20, s[56:57]
v_cndmask_b32 v185, v185, v20, s[58:59]
v_cndmask_b32 v186, v186, v20, s[60:61]
v_cndmask_b32 v187, v187, v20, s[62:63]
v_cmp_gt_i32 s[56:57], 48, v5
v_cmp_gt_i32 s[58:59], 49, v5
v_cmp_gt_i32 s[60:61], 50, v5
v_cmp_gt_i32 s[62:63], 51, v5
v_cndmask_b32 v188, v188, v20, s[56:57]
v_cndmask_b32 v189, v189, v20, s[58:59]
v_cndmask_b32 v190, v190, v20, s[60:61]
v_cndmask_b32 v191, v191, v20, s[62:63]
s_branch L_k2_mkr_wo
L_k2_mk_tr:
v_cmp_gt_i32 s[56:57], 0, v5
v_cmp_gt_i32 s[58:59], 1, v5
v_cmp_gt_i32 s[60:61], 2, v5
v_cmp_gt_i32 s[62:63], 3, v5
s_nop 3
v_cndmask_b32 v144, v144, v20, s[56:57]
v_cndmask_b32 v145, v145, v20, s[58:59]
v_cndmask_b32 v146, v146, v20, s[60:61]
v_cndmask_b32 v147, v147, v20, s[62:63]
v_cmp_gt_i32 s[56:57], 16, v5
v_cmp_gt_i32 s[58:59], 17, v5
v_cmp_gt_i32 s[60:61], 18, v5
v_cmp_gt_i32 s[62:63], 19, v5
v_cndmask_b32 v148, v148, v20, s[56:57]
v_cndmask_b32 v149, v149, v20, s[58:59]
v_cndmask_b32 v150, v150, v20, s[60:61]
v_cndmask_b32 v151, v151, v20, s[62:63]
v_cmp_gt_i32 s[56:57], 32, v5
v_cmp_gt_i32 s[58:59], 33, v5
v_cmp_gt_i32 s[60:61], 34, v5
v_cmp_gt_i32 s[62:63], 35, v5
v_cndmask_b32 v152, v152, v20, s[56:57]
v_cndmask_b32 v153, v153, v20, s[58:59]
v_cndmask_b32 v154, v154, v20, s[60:61]
v_cndmask_b32 v155, v155, v20, s[62:63]
v_cmp_gt_i32 s[56:57], 48, v5
v_cmp_gt_i32 s[58:59], 49, v5
v_cmp_gt_i32 s[60:61], 50, v5
v_cmp_gt_i32 s[62:63], 51, v5
v_cndmask_b32 v156, v156, v20, s[56:57]
v_cndmask_b32 v157, v157, v20, s[58:59]
v_cndmask_b32 v158, v158, v20, s[60:61]
v_cndmask_b32 v159, v159, v20, s[62:63]
s_branch L_k2_mkr_tr
L_k2_mk_no:
v_cmp_gt_i32 s[56:57], 0, v5
v_cmp_gt_i32 s[58:59], 1, v5
v_cmp_gt_i32 s[60:61], 2, v5
v_cmp_gt_i32 s[62:63], 3, v5
s_nop 3
v_cndmask_b32 v144, v144, v20, s[56:57]
v_cndmask_b32 v145, v145, v20, s[58:59]
v_cndmask_b32 v146, v146, v20, s[60:61]
v_cndmask_b32 v147, v147, v20, s[62:63]
v_cmp_gt_i32 s[56:57], 16, v5
v_cmp_gt_i32 s[58:59], 17, v5
v_cmp_gt_i32 s[60:61], 18, v5
v_cmp_gt_i32 s[62:63], 19, v5
v_cndmask_b32 v148, v148, v20, s[56:57]
v_cndmask_b32 v149, v149, v20, s[58:59]
v_cndmask_b32 v150, v150, v20, s[60:61]
v_cndmask_b32 v151, v151, v20, s[62:63]
v_cmp_gt_i32 s[56:57], 32, v5
v_cmp_gt_i32 s[58:59], 33, v5
v_cmp_gt_i32 s[60:61], 34, v5
v_cmp_gt_i32 s[62:63], 35, v5
v_cndmask_b32 v152, v152, v20, s[56:57]
v_cndmask_b32 v153, v153, v20, s[58:59]
v_cndmask_b32 v154, v154, v20, s[60:61]
v_cndmask_b32 v155, v155, v20, s[62:63]
v_cmp_gt_i32 s[56:57], 48, v5
v_cmp_gt_i32 s[58:59], 49, v5
v_cmp_gt_i32 s[60:61], 50, v5
v_cmp_gt_i32 s[62:63], 51, v5
v_cndmask_b32 v156, v156, v20, s[56:57]
v_cndmask_b32 v157, v157, v20, s[58:59]
v_cndmask_b32 v158, v158, v20, s[60:61]
v_cndmask_b32 v159, v159, v20, s[62:63]
s_branch L_k2_mkr_no
L_pubB:
v_mov_b32 v24, 1
v_mov_b32 v25, 0
s_mov_b64 exec, 1
buffer_store_dword v24, v25, s[20:23], s64 offen sc1
s_mov_b64 exec, -1
s_branch L_pubBr
L_k2_wloop:
v_xor_b32 v2, 65536, v2
v_xor_b32 v3, 65536, v3
Cvaa 192,192,128,32
s_mov_b32 m0, s53
Ra 224,2,40960
v_lshl_add_u64 v[28:29], s[40:41], 0, v[28:29]
Mvaa 192,196,132
buffer_load_dwordx4 v4, s[12:15], s38 offen offset:0 sc1 lds
Mvaa 192,200,136
Ve 8,136
Mvaa 192,204,140
VE 9,137
Cvaa 208,192,144,36
Ra 228,2,41984
Vc 68,8,9
Mvaa 208,196,148
VE 10,138
Mvaa 208,200,152
VE 11,139
Mvaa 208,204,156
Ra 232,2,43008
Vc 69,10,11
Cvaa 224,192,160,40
Ra 236,2,44032
v_or3_b32 v7, v7, v68, v69
Mvaa 224,196,164
VE 12,152
Mvaa 224,200,168
VE 13,153
Mvaa 224,204,172
Ra 240,2,45056
Vc 76,12,13
Cvaa 240,192,176,44
VE 14,154
Mvaa 240,196,180
VE 15,155
Mvaa 240,200,184
Ra 244,2,46080
Vc 77,14,15
Mvaa 240,204,188
s_waitcnt lgkmcnt(6)
Ra 248,2,47104
v_or3_b32 v7, v7, v76, v77
Cvaa 196,208,128,32
buffer_load_dwordx4 v4, s[12:15], s38 offen offset:1024 sc1 lds
Mvaa 196,212,132
Ve 8,168
Mvaa 196,216,136
VE 9,169
Mvaa 196,220,140
Ra 252,2,48128
Vc 84,8,9
Cvaa 212,208,144,36
VE 10,170
Mvaa 212,212,148
VE 11,171
Mvaa 212,216,152
Ra 192,2,16384
Vc 85,10,11
Mvaa 212,220,156
Ra 196,2,24576
v_or3_b32 v7, v7, v84, v85
Cvaa 228,208,160,40
VE 12,184
Mvaa 228,212,164
VE 13,185
Mvaa 228,216,168
Ra 200,2,17408
Vc 92,12,13
Mvaa 228,220,172
VE 14,186
Cvaa 244,208,176,44
VE 15,187
Mvaa 244,212,180
buffer_load_dwordx4 v4, s[12:15], s38 offen offset:2048 sc1 lds
Mvaa 244,216,184
Ra 204,2,25600
Vc 93,14,15
Mvaa 244,220,188
s_waitcnt lgkmcnt(8)
Ve 8,140
Cvaa 200,224,128,32
Ra 208,2,18432
v_or3_b32 v7, v7, v92, v93
Mvaa 200,228,132
VE 9,141
Mvaa 200,232,136
Ra 212,2,26624
Vc 70,8,9
Mvaa 200,236,140
VE 10,142
Cvaa 216,224,144,36
VE 11,143
Mvaa 216,228,148
Ra 216,2,19456
Vc 71,10,11
Mvaa 216,232,152
Ra 220,2,27648
v_or3_b32 v7, v7, v70, v71
Mvaa 216,236,156
VE 12,156
Cvaa 232,224,160,40
VE 13,157
Mvaa 232,228,164
VE 14,158
Mvaa 232,232,168
VE 15,159
Mvaa 232,236,172
buffer_load_dwordx4 v4, s[12:15], s38 offen offset:3072 sc1 lds
Cvaa 248,224,176,44
VE 8,172
Mvaa 248,228,180
VE 9,173
Mvaa 248,232,184
Vc 78,12,13
Vc 79,14,15
Mvaa 248,236,188
s_waitcnt lgkmcnt(8)
Ve 10,174
Cvaa 204,240,128,32
VE 11,175
Mvaa 204,244,132
Vc 86,8,9
Vc 87,10,11
Mvaa 204,248,136
VE 12,188
Mvaa 204,252,140
VE 13,189
Cvaa 220,240,144,36
Vc 94,12,13
v_or3_b32 v7, v7, v78, v79
Mvaa 220,244,148
VE 14,190
Mvaa 220,248,152
VE 15,191
Mvaa 220,252,156
Vc 95,14,15
v_or3_b32 v7, v7, v86, v87
Cvaa 236,240,160,40
v_or3_b32 v7, v7, v94, v95
v_and_b32 v1, 0x40004000, v7
Mvaa 236,244,164
v_cmp_ne_u32 vcc, 0, v1
Mvaa 236,248,168
Mvaa 236,252,172
s_waitcnt vmcnt(12)
Cvaa 252,240,176,44
Mvaa 252,244,180
s_barrier
Mvaa 252,248,184
s_waitcnt lgkmcnt(4)
Mvaa 252,252,188
s_cbranch_vccnz L_k2_fb_we
L_k2_fbr_we:
Maav 0,192,64
Ve 8,192
Maav 0,196,68
s_add_u32 m0, s54, 49152
VE 9,193
Maav 32,192,72
buffer_load_dwordx4 v4, s[12:15], s39 offen offset:0 sc1 lds
Maav 32,196,76
s_add_u32 s37, s37, 1
Ra 224,2,20480
Vc 96,8,9
Maav 64,192,80
s_add_u32 s38, s38, 34816
Ve 10,194
Maav 64,196,84
VE 11,195
Maav 96,192,88
Ra 228,2,28672
Vc 97,10,11
Maav 96,196,92
Ra 232,2,21504
v_or_b32_e64 v7, v96, v97
Maav 4,200,64
VE 12,208
Maav 4,204,68
VE 13,209
Maav 36,200,72
Ra 236,2,29696
Vc 104,12,13
Maav 36,204,76
VE 14,210
Maav 68,200,80
VE 15,211
Maav 68,204,84
Ra 240,2,22528
Vc 105,14,15
Maav 100,200,88
Ra 244,2,30720
v_or3_b32 v7, v7, v104, v105
Maav 100,204,92
buffer_load_dwordx4 v4, s[12:15], s39 offen offset:1024 sc1 lds
Mvvv 48,16,64
VE 8,224
Mvvv 48,16,68
s_waitcnt lgkmcnt(6)
Ve 9,225
Maav 8,208,64
Ra 248,2,23552
Vc 112,8,9
Maav 8,212,68
VE 10,226
Maav 40,208,72
VE 11,227
Maav 40,212,76
Ra 252,2,31744
Vc 113,10,11
Maav 72,208,80
Ra 192,3,0
v_or3_b32 v7, v7, v112, v113
Maav 72,212,84
VE 12,240
Maav 104,208,88
VE 13,241
Maav 104,212,92
Ra 196,3,1024
Vc 120,12,13
Maav 12,216,64
VE 14,242
Maav 12,220,68
VE 15,243
Maav 44,216,72
Ra 200,3,2048
Vc 121,14,15
Maav 44,220,76
buffer_load_dwordx4 v4, s[12:15], s39 offen offset:2048 sc1 lds
Maav 76,216,80
Ra 204,3,3072
v_or3_b32 v7, v7, v120, v121
Maav 76,220,84
VE 8,196
Maav 108,216,88
VE 9,197
Maav 108,220,92
VE 10,198
Mvvv 52,16,72
VE 11,199
Mvvv 52,16,76
s_waitcnt lgkmcnt(8)
Ve 12,212
Maav 16,224,64
Ra 208,3,4096
Vc 98,8,9
Maav 16,228,68
Ra 212,3,5120
Vc 99,10,11
Maav 48,224,72
Ra 216,3,6144
v_or3_b32 v7, v7, v98, v99
Maav 48,228,76
VE 13,213
Maav 80,224,80
Ra 220,3,7168
Vc 106,12,13
Maav 80,228,84
VE 14,214
Maav 112,224,88
buffer_load_dwordx4 v4, s[12:15], s39 offen offset:3072 sc1 lds
Maav 112,228,92
s_add_u32 s39, s39, 34816
VE 15,215
Maav 20,232,64
VE 8,228
Maav 20,236,68
VE 9,229
Maav 52,232,72
VE 10,230
Maav 52,236,76
VE 11,231
Maav 84,232,80
Vc 107,14,15
Vc 114,8,9
Maav 84,236,84
VE 12,244
Maav 116,232,88
VE 13,245
Maav 116,236,92
Vc 115,10,11
Vc 122,12,13
Mvvv 56,16,80
VE 14,246
Mvvv 56,16,84
s_waitcnt lgkmcnt(8)
Ve 15,247
Maav 24,240,64
Vc 123,14,15
v_or3_b32 v7, v7, v106, v107
Maav 24,244,68
v_or3_b32 v7, v7, v114, v115
v_or3_b32 v7, v7, v122, v123
Maav 56,240,72
global_load_dword v30, v[28:29], off
Maav 56,244,76
Maav 88,240,80
Maav 88,244,84
Maav 120,240,88
Maav 120,244,92
Maav 28,248,64
Maav 28,252,68
Maav 60,248,72
Maav 60,252,76
Maav 92,248,80
Maav 92,252,84
Maav 124,248,88
Maav 124,252,92
Mvvv 60,16,88
s_waitcnt lgkmcnt(4)
Mvvv 60,16,92
Ve 8,200
Cvaa 128,192,128,32
s_add_u32 m0, s53, 32768
Ra 224,3,8192
v_lshl_add_u64 v[28:29], s[40:41], 0, v[28:29]
Mvaa 128,196,132
buffer_load_dwordx4 v4, s[12:15], s38 offen offset:0 sc1 lds
Mvaa 128,200,136
VE 9,201
Mvaa 128,204,140
Ra 228,3,9216
Vc 100,8,9
Cvaa 144,192,144,36
VE 10,202
Mvaa 144,196,148
VE 11,203
Mvaa 144,200,152
Ra 232,3,10240
Vc 101,10,11
Mvaa 144,204,156
Ra 236,3,11264
v_or3_b32 v7, v7, v100, v101
Cvaa 160,192,160,40
VE 12,216
Mvaa 160,196,164
VE 13,217
Mvaa 160,200,168
Ra 240,3,12288
Vc 108,12,13
Mvaa 160,204,172
VE 14,218
Cvaa 176,192,176,44
VE 15,219
Mvaa 176,196,180
Ra 244,3,13312
Vc 109,14,15
Mvaa 176,200,184
Ra 248,3,14336
v_or3_b32 v7, v7, v108, v109
Mvaa 176,204,188
s_waitcnt lgkmcnt(7)
Ve 8,232
Cvaa 132,208,128,32
buffer_load_dwordx4 v4, s[12:15], s38 offen offset:1024 sc1 lds
Mvaa 132,212,132
VE 9,233
Mvaa 132,216,136
Ra 252,3,15360
Vc 116,8,9
Mvaa 132,220,140
VE 10,234
Cvaa 148,208,144,36
VE 11,235
Mvaa 148,212,148
Ra 192,2,49152
Vc 117,10,11
Mvaa 148,216,152
Ra 196,2,57344
v_or3_b32 v7, v7, v116, v117
Mvaa 148,220,156
VE 12,248
Cvaa 164,208,160,40
VE 13,249
Mvaa 164,212,164
Ra 200,2,50176
Vc 124,12,13
Mvaa 164,216,168
VE 14,250
Mvaa 164,220,172
VE 15,251
Cvaa 180,208,176,44
Ra 204,2,58368
Vc 125,14,15
Mvaa 180,212,180
buffer_load_dwordx4 v4, s[12:15], s38 offen offset:2048 sc1 lds
Mvaa 180,216,184
VE 8,204
Mvaa 180,220,188
s_waitcnt lgkmcnt(8)
Ve 9,205
Cvaa 136,224,128,32
Ra 208,2,51200
Vc 102,8,9
Mvaa 136,228,132
Ra 212,2,59392
v_or3_b32 v7, v7, v124, v125
Mvaa 136,232,136
VE 10,206
Mvaa 136,236,140
VE 11,207
Cvaa 152,224,144,36
Ra 216,2,52224
Vc 103,10,11
Mvaa 152,228,148
Ra 220,2,60416
v_or3_b32 v7, v7, v102, v103
Mvaa 152,232,152
VE 12,220
Mvaa 152,236,156
VE 13,221
Cvaa 168,224,160,40
VE 14,222
Mvaa 168,228,164
VE 15,223
Mvaa 168,232,168
VE 8,236
Mvaa 168,236,172
buffer_load_dwordx4 v4, s[12:15], s38 offen offset:3072 sc1 lds
Cvaa 184,224,176,44
VE 9,237
Mvaa 184,228,180
Vc 110,12,13
Vc 111,14,15
Mvaa 184,232,184
VE 10,238
Mvaa 184,236,188
s_waitcnt lgkmcnt(8)
Ve 11,239
Cvaa 140,240,128,32
Vc 118,8,9
Vc 119,10,11
Mvaa 140,244,132
VE 12,252
Mvaa 140,248,136
VE 13,253
Mvaa 140,252,140
Vc 126,12,13
v_or3_b32 v7, v7, v110, v111
Cvaa 156,240,144,36
VE 14,254
Mvaa 156,244,148
VE 15,255
Mvaa 156,248,152
Vc 127,14,15
v_or3_b32 v7, v7, v118, v119
Mvaa 156,252,156
v_or3_b32 v7, v7, v126, v127
v_and_b32 v1, 0x40004000, v7
Cvaa 172,240,160,40
v_cmp_ne_u32 vcc, 0, v1
Mvaa 172,244,164
Mvaa 172,248,168
Mvaa 172,252,172
s_waitcnt vmcnt(12)
Cvaa 188,240,176,44
s_cmp_eq_u32 s37, s46
Mvaa 188,244,180
s_barrier
Mvaa 188,248,184
s_waitcnt lgkmcnt(4)
Mvaa 188,252,188
s_cbranch_vccnz L_k2_fb_wo
L_k2_fbr_wo:
Maav 0,192,96
s_cbranch_scc1 L_k2_mk_wo
L_k2_mkr_wo:
Ve 8,128
Maav 0,196,100
s_add_u32 m0, s53, 16384
VE 9,129
Maav 32,192,104
buffer_load_dwordx4 v4, s[12:15], s39 offen offset:0 sc1 lds
Maav 32,196,108
s_add_u32 s37, s37, 1
Ra 224,2,53248
Vc 64,8,9
Maav 64,192,112
s_add_u32 s38, s38, 34816
Ve 10,130
Maav 64,196,116
s_xor_b32 s53, s53, 65536
VE 11,131
Maav 96,192,120
s_xor_b32 s54, s54, 65536
Ra 228,2,61440
Vc 65,10,11
Maav 96,196,124
Ra 232,2,54272
v_or_b32_e64 v7, v64, v65
Maav 4,200,96
VE 12,144
Maav 4,204,100
VE 13,145
Maav 36,200,104
Ra 236,2,62464
Vc 72,12,13
Maav 36,204,108
VE 14,146
Maav 68,200,112
VE 15,147
Maav 68,204,116
Ra 240,2,55296
Vc 73,14,15
Maav 100,200,120
Ra 244,2,63488
v_or3_b32 v7, v7, v72, v73
Maav 100,204,124
buffer_load_dwordx4 v4, s[12:15], s39 offen offset:1024 sc1 lds
Mvvv 48,16,96
VE 8,160
Mvvv 48,16,100
s_waitcnt lgkmcnt(6)
Ve 9,161
Maav 8,208,96
Ra 248,2,56320
Vc 80,8,9
Maav 8,212,100
VE 10,162
Maav 40,208,104
VE 11,163
Maav 40,212,108
Ra 252,2,64512
Vc 81,10,11
Maav 72,208,112
Ra 192,3,32768
v_or3_b32 v7, v7, v80, v81
Maav 72,212,116
VE 12,176
Maav 104,208,120
VE 13,177
Maav 104,212,124
Ra 196,3,33792
Vc 88,12,13
Maav 12,216,96
VE 14,178
Maav 12,220,100
VE 15,179
Maav 44,216,104
Ra 200,3,34816
Vc 89,14,15
Maav 44,220,108
buffer_load_dwordx4 v4, s[12:15], s39 offen offset:2048 sc1 lds
Maav 76,216,112
Ra 204,3,35840
v_or3_b32 v7, v7, v88, v89
Maav 76,220,116
VE 8,132
Maav 108,216,120
VE 9,133
Maav 108,220,124
VE 10,134
Mvvv 52,16,104
VE 11,135
Mvvv 52,16,108
s_waitcnt lgkmcnt(8)
Ve 12,148
Maav 16,224,96
Ra 208,3,36864
Vc 66,8,9
Maav 16,228,100
Ra 212,3,37888
Vc 67,10,11
Maav 48,224,104
Ra 216,3,38912
v_or3_b32 v7, v7, v66, v67
Maav 48,228,108
VE 13,149
Maav 80,224,112
Ra 220,3,39936
Vc 74,12,13
Maav 80,228,116
VE 14,150
Maav 112,224,120
buffer_load_dwordx4 v4, s[12:15], s39 offen offset:3072 sc1 lds
Maav 112,228,124
s_add_u32 s39, s39, 34816
VE 15,151
Maav 20,232,96
VE 8,164
Maav 20,236,100
VE 9,165
Maav 52,232,104
VE 10,166
Maav 52,236,108
VE 11,167
Maav 84,232,112
Vc 75,14,15
Vc 82,8,9
Maav 84,236,116
VE 12,180
Maav 116,232,120
VE 13,181
Maav 116,236,124
Vc 83,10,11
Vc 90,12,13
Mvvv 56,16,112
VE 14,182
Mvvv 56,16,116
s_waitcnt lgkmcnt(8)
Ve 15,183
Maav 24,240,96
Vc 91,14,15
v_or3_b32 v7, v7, v74, v75
Maav 24,244,100
v_or3_b32 v7, v7, v82, v83
v_or3_b32 v7, v7, v90, v91
Maav 56,240,104
global_load_dword v30, v[28:29], off
Maav 56,244,108
Maav 88,240,112
Maav 88,244,116
Maav 120,240,120
Maav 120,244,124
Maav 28,248,96
Maav 28,252,100
Maav 60,248,104
Maav 60,252,108
Maav 92,248,112
Maav 92,252,116
Maav 124,248,120
Maav 124,252,124
s_cmp_lg_u32 s37, s35
Mvvv 60,16,120
s_waitcnt lgkmcnt(4)
Mvvv 60,16,124
s_cbranch_scc1 L_k2_wloop
L_k2_wlast:
v_xor_b32 v2, 65536, v2
v_xor_b32 v3, 65536, v3
Cvaa 192,192,128,32
s_mov_b32 m0, s53
Ra 224,2,40960
v_lshl_add_u64 v[28:29], s[40:41], 0, v[28:29]
Mvaa 192,196,132
buffer_load_dwordx4 v4, s[12:15], s38 offen offset:0 sc1 lds
Mvaa 192,200,136
VE 8,136
Mvaa 192,204,140
VE 9,137
Cvaa 208,192,144,36
Ra 228,2,41984
Vc 68,8,9
Mvaa 208,196,148
VE 10,138
Mvaa 208,200,152
VE 11,139
Mvaa 208,204,156
Ra 232,2,43008
Vc 69,10,11
Cvaa 224,192,160,40
Ra 236,2,44032
v_or3_b32 v7, v7, v68, v69
Mvaa 224,196,164
VE 12,152
Mvaa 224,200,168
VE 13,153
Mvaa 224,204,172
s_waitcnt lgkmcnt(4)
Ra 240,2,45056
Vc 76,12,13
Cvaa 196,208,128,32
buffer_load_dwordx4 v4, s[12:15], s38 offen offset:1024 sc1 lds
Mvaa 196,212,132
Ve 14,154
Mvaa 196,216,136
VE 15,155
Mvaa 196,220,140
Ra 244,2,46080
Vc 77,14,15
Cvaa 212,208,144,36
Ra 248,2,47104
v_or3_b32 v7, v7, v76, v77
Mvaa 212,212,148
VE 8,168
Mvaa 212,216,152
VE 9,169
Mvaa 212,220,156
Ra 252,2,48128
Vc 84,8,9
Cvaa 228,208,160,40
VE 10,170
Mvaa 228,212,164
buffer_load_dwordx4 v4, s[12:15], s38 offen offset:2048 sc1 lds
Mvaa 228,216,168
VE 11,171
Mvaa 228,220,172
s_waitcnt lgkmcnt(4)
Ra 192,2,16384
Vc 85,10,11
Cvaa 200,224,128,32
Ra 196,2,24576
v_or3_b32 v7, v7, v84, v85
Mvaa 200,228,132
Ve 12,184
Mvaa 200,232,136
VE 13,185
Mvaa 200,236,140
Ra 200,2,17408
Vc 92,12,13
Cvaa 216,224,144,36
VE 14,186
Mvaa 216,228,148
VE 15,187
Mvaa 216,232,152
Ra 204,2,25600
Vc 93,14,15
Mvaa 216,236,156
buffer_load_dwordx4 v4, s[12:15], s38 offen offset:3072 sc1 lds
Cvaa 232,224,160,40
Ra 208,2,18432
v_or3_b32 v7, v7, v92, v93
Mvaa 232,228,164
VE 8,140
Mvaa 232,232,168
VE 9,141
Mvaa 232,236,172
s_waitcnt lgkmcnt(5)
Ra 212,2,26624
Vc 70,8,9
Cvaa 204,240,128,32
Ve 10,142
Mvaa 204,244,132
VE 11,143
Mvaa 204,248,136
Ra 216,2,19456
Vc 71,10,11
Mvaa 204,252,140
Ra 220,2,27648
v_or3_b32 v7, v7, v70, v71
Cvaa 220,240,144,36
VE 12,156
Mvaa 220,244,148
VE 13,157
Mvaa 220,248,152
VE 14,158
Mvaa 220,252,156
s_waitcnt vmcnt(12)
Ve 15,159
Cvaa 236,240,160,40
VE 8,172
Mvaa 236,244,164
s_barrier
Ve 9,173
Mvaa 236,248,168
s_waitcnt lgkmcnt(4)
Vc 78,12,13
Vc 79,14,15
Ve 10,174
Ve 11,175
Ve 12,188
Ve 13,189
Ve 14,190
VE 15,191
Vc 86,8,9
Vc 87,10,11
Vc 94,12,13
Vc 95,14,15
v_or3_b32 v7, v7, v78, v79
v_or3_b32 v7, v7, v86, v87
v_or3_b32 v7, v7, v94, v95
v_and_b32 v1, 0x40004000, v7
v_cmp_ne_u32 vcc, 0, v1
Mvaa 236,252,172
s_cbranch_vccnz L_k2_fb_wl
L_k2_fbr_wl:
Maav 0,192,64
v_cmp_gt_i32 s[56:57], 0, v6
v_cmp_gt_i32 s[58:59], 1, v6
v_cmp_gt_i32 s[60:61], 2, v6
v_cmp_gt_i32 s[62:63], 3, v6
s_nop 3
s_nop 0
v_cndmask_b32 v224, v224, v20, s[56:57]
v_cndmask_b32 v225, v225, v20, s[58:59]
v_cndmask_b32 v226, v226, v20, s[60:61]
v_cndmask_b32 v227, v227, v20, s[62:63]
v_cmp_gt_i32 s[56:57], 16, v6
v_cmp_gt_i32 s[58:59], 17, v6
v_cmp_gt_i32 s[60:61], 18, v6
v_cmp_gt_i32 s[62:63], 19, v6
v_cndmask_b32 v228, v228, v20, s[56:57]
v_cndmask_b32 v229, v229, v20, s[58:59]
v_cndmask_b32 v230, v230, v20, s[60:61]
v_cndmask_b32 v231, v231, v20, s[62:63]
v_cmp_gt_i32 s[56:57], 32, v6
v_cmp_gt_i32 s[58:59], 33, v6
v_cmp_gt_i32 s[60:61], 34, v6
v_cmp_gt_i32 s[62:63], 35, v6
v_cndmask_b32 v232, v232, v20, s[56:57]
v_cndmask_b32 v233, v233, v20, s[58:59]
v_cndmask_b32 v234, v234, v20, s[60:61]
v_cndmask_b32 v235, v235, v20, s[62:63]
v_cmp_gt_i32 s[56:57], 48, v6
v_cmp_gt_i32 s[58:59], 49, v6
v_cmp_gt_i32 s[60:61], 50, v6
v_cmp_gt_i32 s[62:63], 51, v6
v_cndmask_b32 v236, v236, v20, s[56:57]
v_cndmask_b32 v237, v237, v20, s[58:59]
v_cndmask_b32 v238, v238, v20, s[60:61]
v_cndmask_b32 v239, v239, v20, s[62:63]
VE 8,192
Maav 0,196,68
s_add_u32 m0, s54, 49152
VE 9,193
Maav 32,192,72
buffer_load_dwordx4 v4, s[12:15], s39 offen offset:0 sc1 lds
Maav 32,196,76
s_add_u32 s37, s37, 1
Ra 224,2,20480
Vc 96,8,9
Maav 64,192,80
s_add_u32 s38, s38, 34816
Ve 10,194
Maav 64,196,84
VE 11,195
Maav 96,192,88
Ra 228,2,28672
Vc 97,10,11
Maav 96,196,92
buffer_load_dwordx4 v4, s[12:15], s39 offen offset:1024 sc1 lds
Maav 4,200,64
Ra 232,2,21504
v_or_b32_e64 v7, v96, v97
Maav 4,204,68
VE 12,208
Maav 36,200,72
VE 13,209
Maav 36,204,76
Ra 236,2,29696
Vc 104,12,13
Maav 68,200,80
buffer_load_dwordx4 v4, s[12:15], s39 offen offset:2048 sc1 lds
Maav 68,204,84
VE 14,210
Maav 100,200,88
VE 15,211
Maav 100,204,92
Ra 240,2,22528
Vc 105,14,15
Mvvv 48,16,64
Ra 244,2,30720
v_or3_b32 v7, v7, v104, v105
Mvvv 48,16,68
s_waitcnt lgkmcnt(6)
Ve 8,224
Maav 8,208,64
buffer_load_dwordx4 v4, s[12:15], s39 offen offset:3072 sc1 lds
Maav 8,212,68
s_add_u32 s39, s39, 34816
VE 9,225
Maav 40,208,72
Ra 248,2,23552
Vc 112,8,9
Maav 40,212,76
VE 10,226
Maav 72,208,80
global_load_dword v30, v[28:29], off
Maav 72,212,84
VE 11,227
Maav 104,208,88
Ra 252,2,31744
Vc 113,10,11
Maav 104,212,92
Ra 192,3,0
v_or3_b32 v7, v7, v112, v113
Maav 12,216,64
VE 12,196
Maav 12,220,68
s_add_u32 m0, s44, 131072
s_add_u32 s3, s5, 0
Ve 13,197
Maav 44,216,72
buffer_load_dwordx4 v24, s[24:27], s3 offen offset:0 lds
Maav 44,220,76
Ra 196,3,1024
Vc 98,12,13
Maav 76,216,80
VE 14,198
Maav 76,220,84
VE 15,199
Maav 108,216,88
s_add_u32 s3, s5, 27648
Ra 200,3,2048
Vc 99,14,15
Maav 108,220,92
buffer_load_dwordx4 v24, s[24:27], s3 offen offset:1024 lds
Mvvv 52,16,72
Ra 204,3,3072
v_or3_b32 v7, v7, v98, v99
Mvvv 52,16,76
s_waitcnt lgkmcnt(8)
Ve 8,212
Maav 16,224,64
VE 9,213
Maav 16,228,68
s_add_u32 s3, s5, 55296
Ra 208,3,4096
Vc 106,8,9
Maav 48,224,72
buffer_load_dwordx4 v25, s[24:27], s3 offen offset:2048 lds
Maav 48,228,76
VE 10,214
Maav 80,224,80
VE 11,215
Maav 80,228,84
Ra 212,3,5120
Vc 107,10,11
Maav 112,224,88
s_add_u32 s3, s5, 82944
Ra 216,3,6144
v_or3_b32 v7, v7, v106, v107
Maav 112,228,92
buffer_load_dwordx4 v25, s[24:27], s3 offen offset:3072 lds
Maav 20,232,64
VE 12,228
Maav 20,236,68
VE 13,229
Maav 52,232,72
Ra 220,3,7168
Vc 114,12,13
Maav 52,236,76
VE 14,230
Maav 84,232,80
s_add_u32 m0, s44, 147456
s_add_u32 s3, s5, 458752
VE 15,231
Maav 84,236,84
buffer_load_dwordx4 v24, s[24:27], s3 offen offset:0 lds
Maav 116,232,88
VE 8,200
Maav 116,236,92
VE 9,201
Mvvv 56,16,80
VE 10,202
Mvvv 56,16,84
s_waitcnt lgkmcnt(8)
Ve 11,203
Maav 24,240,64
s_add_u32 s3, s5, 486400
Vc 115,14,15
Vc 100,8,9
Maav 24,244,68
buffer_load_dwordx4 v24, s[24:27], s3 offen offset:1024 lds
Maav 56,240,72
VE 12,216
Maav 56,244,76
VE 13,217
Maav 88,240,80
s_add_u32 s3, s5, 514048
Vc 101,10,11
Vc 108,12,13
Maav 88,244,84
buffer_load_dwordx4 v25, s[24:27], s3 offen offset:2048 lds
Maav 120,240,88
VE 14,218
Maav 120,244,92
VE 15,219
Maav 28,248,64
Vc 109,14,15
v_or3_b32 v7, v7, v114, v115
Maav 28,252,68
s_add_u32 s3, s5, 541696
VE 8,232
Maav 60,248,72
buffer_load_dwordx4 v25, s[24:27], s3 offen offset:3072 lds
Maav 60,252,76
VE 9,233
Maav 92,248,80
Vc 116,8,9
v_or3_b32 v7, v7, v100, v101
Maav 92,252,84
VE 10,234
Maav 124,248,88
VE 11,235
Maav 124,252,92
Vc 117,10,11
v_or3_b32 v7, v7, v108, v109
Mvvv 60,16,88
s_waitcnt lgkmcnt(4)
v_or3_b32 v7, v7, v116, v117
Mvvv 60,16,92
Ve 12,204
Cvaa 128,192,128,32
s_add_u32 m0, s53, 32768
VE 13,205
Mvaa 128,196,132
buffer_load_dwordx4 v4, s[12:15], s38 offen offset:0 sc1 lds
Mvaa 128,200,136
Ra 224,3,8192
Vc 102,12,13
Mvaa 128,204,140
VE 14,206
Cvaa 144,192,144,36
VE 15,207
Mvaa 144,196,148
Ra 228,3,9216
Vc 103,14,15
Mvaa 144,200,152
Ra 232,3,10240
v_or3_b32 v7, v7, v102, v103
Mvaa 144,204,156
s_waitcnt lgkmcnt(3)
Ra 236,3,11264
Ra 240,3,12288
Cvaa 132,208,128,32
buffer_load_dwordx4 v4, s[12:15], s38 offen offset:1024 sc1 lds
Mvaa 132,212,132
Ve 8,220
Mvaa 132,216,136
VE 9,221
Mvaa 132,220,140
Ra 244,3,13312
Vc 110,8,9
Cvaa 148,208,144,36
VE 10,222
Mvaa 148,212,148
buffer_load_dwordx4 v4, s[12:15], s38 offen offset:2048 sc1 lds
Mvaa 148,216,152
VE 11,223
Mvaa 148,220,156
s_waitcnt lgkmcnt(2)
Ra 248,3,14336
Ra 252,3,15360
Cvaa 136,224,128,32
Ra 192,2,49152
Vc 111,10,11
Mvaa 136,228,132
Ra 196,2,57344
v_or3_b32 v7, v7, v110, v111
Mvaa 136,232,136
Ve 12,236
Mvaa 136,236,140
buffer_load_dwordx4 v4, s[12:15], s38 offen offset:3072 sc1 lds
Cvaa 152,224,144,36
VE 13,237
Mvaa 152,228,148
Ra 200,2,50176
Vc 118,12,13
Mvaa 152,232,152
VE 14,238
Mvaa 152,236,156
s_waitcnt lgkmcnt(3)
Ra 204,2,58368
Ra 208,2,51200
Cvaa 140,240,128,32
Ve 15,239
Mvaa 140,244,132
Ra 212,2,59392
Vc 119,14,15
Mvaa 140,248,136
Ra 216,2,52224
v_or3_b32 v7, v7, v118, v119
Mvaa 140,252,140
s_waitcnt vmcnt(12)
Ra 220,2,60416
v_and_b32 v1, 0x40004000, v7
Cvaa 156,240,144,36
s_cmp_eq_u32 s37, s45
v_cmp_ne_u32 vcc, 0, v1
Mvaa 156,244,148
s_barrier
Mvaa 156,248,152
s_waitcnt lgkmcnt(4)
Mvaa 156,252,156
s_cbranch_vccnz L_k2_fb_tr
L_k2_fbr_tr:
Maav 0,192,96
s_cbranch_scc1 L_k2_mk_tr
L_k2_mkr_tr:
Ve 8,128
Maav 0,196,100
s_add_u32 m0, s53, 16384
VE 9,129
Maav 32,192,104
buffer_load_dwordx4 v4, s[12:15], s39 offen offset:0 sc1 lds
Maav 32,196,108
s_add_u32 s37, s37, 1
Ra 224,2,53248
Vc 64,8,9
Maav 64,192,112
s_add_u32 s38, s38, 34816
Ve 10,130
Maav 64,196,116
s_xor_b32 s53, s53, 65536
VE 11,131
Maav 4,200,96
s_xor_b32 s54, s54, 65536
Ra 228,2,61440
Vc 65,10,11
Maav 4,204,100
Ra 232,2,54272
v_or_b32_e64 v7, v64, v65
Maav 36,200,104
VE 12,144
Maav 36,204,108
VE 13,145
Maav 68,200,112
Ra 236,2,62464
Vc 72,12,13
Maav 68,204,116
VE 14,146
Mvvv 48,16,96
VE 15,147
Mvvv 48,16,100
s_waitcnt lgkmcnt(4)
Ra 240,2,55296
Vc 73,14,15
Maav 8,208,96
buffer_load_dwordx4 v4, s[12:15], s39 offen offset:1024 sc1 lds
Maav 8,212,100
Ra 244,2,63488
v_or3_b32 v7, v7, v72, v73
Maav 40,208,104
Ve 8,132
Maav 40,212,108
VE 9,133
Maav 72,208,112
Ra 248,2,56320
Vc 66,8,9
Maav 72,212,116
VE 10,134
Maav 12,216,96
VE 11,135
Maav 12,220,100
Ra 252,2,64512
Vc 67,10,11
Maav 44,216,104
Ra 192,3,32768
v_or3_b32 v7, v7, v66, v67
Maav 44,220,108
VE 12,148
Maav 76,216,112
VE 13,149
Maav 76,220,116
Ra 196,3,33792
Vc 74,12,13
Mvvv 52,16,104
VE 14,150
Mvvv 52,16,108
s_waitcnt lgkmcnt(6)
Ve 15,151
Maav 16,224,96
buffer_load_dwordx4 v4, s[12:15], s39 offen offset:2048 sc1 lds
Maav 16,228,100
Ra 200,3,34816
Vc 75,14,15
Maav 48,224,104
Ra 204,3,35840
v_or3_b32 v7, v7, v74, v75
Maav 48,228,108
VE 8,136
Maav 80,224,112
Ra 208,3,36864
Ra 212,3,37888
Maav 80,228,116
Ra 216,3,38912
Ra 220,3,39936
Maav 20,232,96
Maav 20,236,100
Maav 52,232,104
Maav 52,236,108
Maav 84,232,112
Maav 84,236,116
buffer_load_dwordx4 v4, s[12:15], s39 offen offset:3072 sc1 lds
Mvvv 56,16,112
s_add_u32 s39, s39, 34816
Mvvv 56,16,116
s_waitcnt lgkmcnt(8)
Maav 24,240,96
Maav 24,244,100
Maav 56,240,104
Maav 56,244,108
Maav 88,240,112
Maav 88,244,116
Maav 28,248,96
Maav 28,252,100
Maav 60,248,104
Maav 60,252,108
Maav 92,248,112
s_waitcnt lgkmcnt(4)
Maav 92,252,116
s_getpc_b64 s[56:57]
L_cpf4:
s_add_u32 s56, s56, (L_k2_fin-L_cpf4)&0xffffffff
s_addc_u32 s57, s57, ((L_k2_fin-L_cpf4)>>32)&0xffffffff
s_lshr_b32 s58, s2, 3
s_lshl_b32 s58, s58, 2
s_add_u32 s58, s58, s32
s_lshl_b32 s58, s58, 10
v_and_b32 v162, 7, v0
v_lshlrev_b32 v162, 7, v162
v_add_u32 v162, s58, v162
v_min_u32 v162, L_p4_end-L_k2_fin-4, v162
v_mov_b32 v161, s57
v_add_co_u32 v160, vcc, s56, v162
s_nop 1
v_addc_co_u32 v161, vcc, 0, v161, vcc
global_load_dword v164, v[160:161], off
s_waitcnt vmcnt(9)
s_lshl_b32 s3, s34, 20
s_lshl_b32 s47, s33, 15
s_add_u32 s3, s3, s47
s_lshl_b32 s47, s32, 10
v_lshlrev_b32 v248, 4, v0
v_add_u32_e64 v249, s47, v248
s_sub_u32 s47, 7168, s47
v_add_u32 v248, s47, v248
v_rcp_f32 v250, v56
v_rcp_f32 v252, v60
v_mov_b32 v251, v250
v_mov_b32_e64 v253, v252
Ar 240,96
Ar 241,97
Ar 242,98
Ar 243,99
Ar 244,100
Ar 245,101
Ar 246,102
Ar 247,103
v_pk_mul_f32 v[240:241], v[240:241], v[252:253]
v_pk_mul_f32 v[242:243], v[242:243], v[252:253]
v_pk_mul_f32 v[244:245], v[244:245], v[252:253]
v_pk_mul_f32 v[246:247], v[246:247], v[252:253]
Vc 28,240,241
Vc 29,242,243
Vc 30,244,245
Vc 31,246,247
buffer_store_dwordx4 v[28:31], v249, s[16:19], s3 offen sc1
Ar 240,64
Ar 241,65
Ar 242,66
Ar 243,67
Ar 244,68
Ar 245,69
Ar 246,70
Ar 247,71
v_pk_mul_f32 v[240:241], v[240:241], v[250:251]
v_pk_mul_f32 v[242:243], v[242:243], v[250:251]
v_pk_mul_f32 v[244:245], v[244:245], v[250:251]
v_pk_mul_f32 v[246:247], v[246:247], v[250:251]
Vc 24,240,241
Vc 25,242,243
Vc 26,244,245
Vc 27,246,247
buffer_store_dwordx4 v[24:27], v248, s[16:19], s3 offen sc1
s_add_u32 s3, s3, 8192
Ar 240,104
Ar 241,105
Ar 242,106
Ar 243,107
Ar 244,108
Ar 245,109
Ar 246,110
Ar 247,111
v_pk_mul_f32 v[240:241], v[240:241], v[252:253]
v_pk_mul_f32 v[242:243], v[242:243], v[252:253]
v_pk_mul_f32 v[244:245], v[244:245], v[252:253]
v_pk_mul_f32 v[246:247], v[246:247], v[252:253]
Vc 28,240,241
Vc 29,242,243
Vc 30,244,245
Vc 31,246,247
buffer_store_dwordx4 v[28:31], v249, s[16:19], s3 offen sc1
Ar 240,72
Ar 241,73
Ar 242,74
Ar 243,75
Ar 244,76
Ar 245,77
Ar 246,78
Ar 247,79
v_pk_mul_f32 v[240:241], v[240:241], v[250:251]
v_pk_mul_f32 v[242:243], v[242:243], v[250:251]
v_pk_mul_f32 v[244:245], v[244:245], v[250:251]
v_pk_mul_f32 v[246:247], v[246:247], v[250:251]
Vc 24,240,241
Vc 25,242,243
Vc 26,244,245
Vc 27,246,247
buffer_store_dwordx4 v[24:27], v248, s[16:19], s3 offen sc1
s_add_u32 s3, s3, 8192
Ar 240,112
Ar 241,113
Ar 242,114
Ar 243,115
Ar 244,116
Ar 245,117
Ar 246,118
Ar 247,119
v_pk_mul_f32 v[240:241], v[240:241], v[252:253]
v_pk_mul_f32 v[242:243], v[242:243], v[252:253]
v_pk_mul_f32 v[244:245], v[244:245], v[252:253]
v_pk_mul_f32 v[246:247], v[246:247], v[252:253]
Vc 28,240,241
Vc 29,242,243
Vc 30,244,245
Vc 31,246,247
buffer_store_dwordx4 v[28:31], v249, s[16:19], s3 offen sc1
Ar 240,80
Ar 241,81
Ar 242,82
Ar 243,83
Ar 244,84
Ar 245,85
Ar 246,86
Ar 247,87
v_pk_mul_f32 v[240:241], v[240:241], v[250:251]
v_pk_mul_f32 v[242:243], v[242:243], v[250:251]
v_pk_mul_f32 v[244:245], v[244:245], v[250:251]
v_pk_mul_f32 v[246:247], v[246:247], v[250:251]
Vc 24,240,241
Vc 25,242,243
Vc 26,244,245
Vc 27,246,247
buffer_store_dwordx4 v[24:27], v248, s[16:19], s3 offen sc1
s_add_u32 s3, s3, 8192
Ar 240,120
Ar 241,121
Ar 242,122
Ar 243,123
Ar 244,124
Ar 245,125
Ar 246,126
Ar 247,127
v_pk_mul_f32 v[240:241], v[240:241], v[252:253]
v_pk_mul_f32 v[242:243], v[242:243], v[252:253]
v_pk_mul_f32 v[244:245], v[244:245], v[252:253]
v_pk_mul_f32 v[246:247], v[246:247], v[252:253]
Vc 28,240,241
Vc 29,242,243
Vc 30,244,245
Vc 31,246,247
buffer_store_dwordx4 v[28:31], v249, s[16:19], s3 offen sc1
Ar 240,88
Ar 241,89
Ar 242,90
Ar 243,91
Ar 244,92
Ar 245,93
Ar 246,94
Ar 247,95
v_pk_mul_f32 v[240:241], v[240:241], v[250:251]
v_pk_mul_f32 v[242:243], v[242:243], v[250:251]
v_pk_mul_f32 v[244:245], v[244:245], v[250:251]
v_pk_mul_f32 v[246:247], v[246:247], v[250:251]
Vc 24,240,241
Vc 25,242,243
Vc 26,244,245
Vc 27,246,247
buffer_store_dwordx4 v[24:27], v248, s[16:19], s3 offen sc1
s_add_u32 s52, s37, 2
s_load_dwordx2 s[94:95], s[0:1], 40
s_load_dwordx2 s[40:41], s[0:1], 0
s_load_dwordx4 s[8:11], s[0:1], 80
s_waitcnt vmcnt(8) lgkmcnt(0)
s_cmp_eq_u32 s34, 7
s_cbranch_scc1 L_k2_fin
L_k2_nloop:
v_xor_b32 v2, 65536, v2
v_xor_b32 v3, 65536, v3
Cvaa 192,192,128,32
s_mov_b32 m0, s53
Ve 9,137
Mvaa 192,196,132
buffer_load_dwordx4 v4, s[12:15], s38 offen offset:0 sc1 lds
Mvaa 192,200,136
Ra 224,2,40960
Vc 68,8,9
Mvaa 192,204,140
VE 10,138
Cvaa 208,192,144,36
VE 11,139
Mvaa 208,196,148
Ra 228,2,41984
Vc 69,10,11
Mvaa 208,200,152
Ra 232,2,43008
v_or3_b32 v7, v7, v68, v69
Mvaa 208,204,156
s_waitcnt lgkmcnt(3)
Ra 236,2,44032
Ra 240,2,45056
Cvaa 196,208,128,32
buffer_load_dwordx4 v4, s[12:15], s38 offen offset:1024 sc1 lds
Mvaa 196,212,132
Ve 12,152
Mvaa 196,216,136
VE 13,153
Mvaa 196,220,140
Ra 244,2,46080
Vc 76,12,13
Cvaa 212,208,144,36
VE 14,154
Mvaa 212,212,148
buffer_load_dwordx4 v4, s[12:15], s38 offen offset:2048 sc1 lds
Mvaa 212,216,152
VE 15,155
Mvaa 212,220,156
s_waitcnt lgkmcnt(2)
Ra 248,2,47104
Ra 252,2,48128
Cvaa 200,224,128,32
Ra 192,2,16384
Vc 77,14,15
Mvaa 200,228,132
Ra 196,2,24576
v_or3_b32 v7, v7, v76, v77
Mvaa 200,232,136
Ve 8,140
Mvaa 200,236,140
buffer_load_dwordx4 v4, s[12:15], s38 offen offset:3072 sc1 lds
Cvaa 216,224,144,36
VE 9,141
Mvaa 216,228,148
Ra 200,2,17408
Vc 70,8,9
Mvaa 216,232,152
VE 10,142
Mvaa 216,236,156
s_waitcnt lgkmcnt(3)
Ra 204,2,25600
Ra 208,2,18432
Cvaa 204,240,128,32
Ve 11,143
Mvaa 204,244,132
s_cmp_lt_u32 s37, s52
Ra 212,2,26624
Vc 71,10,11
Mvaa 204,248,136
s_cbranch_scc1 L_nw_ne
s_waitcnt vmcnt(12)
L_nw_ne:
Ra 216,2,19456
v_or3_b32 v7, v7, v70, v71
Mvaa 204,252,140
Ve 12,156
Cvaa 220,240,144,36
VE 13,157
Mvaa 220,244,148
s_barrier
Ra 220,2,27648
Vc 78,12,13
Mvaa 220,248,152
s_waitcnt lgkmcnt(4)
Ve 14,158
Ve 15,159
s_nop 0
Vc 79,14,15
v_or3_b32 v7, v7, v78, v79
v_and_b32 v1, 0x40004000, v7
v_cmp_ne_u32 vcc, 0, v1
Mvaa 220,252,156
s_cbranch_vccnz L_k2_fb_ne
L_k2_fbr_ne:
Maav 0,192,64
Ve 8,192
Maav 0,196,68
s_add_u32 m0, s54, 49152
VE 9,193
Maav 32,192,72
buffer_load_dwordx4 v4, s[12:15], s39 offen offset:0 sc1 lds
Maav 32,196,76
s_cmp_eq_u32 s37, s52
Ra 224,2,20480
Vc 96,8,9
Maav 4,200,64
s_cbranch_scc1 L_pubB
L_pubBr:
VE 10,194
Maav 4,204,68
s_add_u32 s37, s37, 1
Ve 11,195
Maav 36,200,72
s_add_u32 s38, s38, 34816
Ra 228,2,28672
Vc 97,10,11
Maav 36,204,76
Ra 232,2,21504
v_or_b32_e64 v7, v96, v97
Mvvv 48,16,64
VE 12,208
Mvvv 48,16,68
s_waitcnt lgkmcnt(3)
Ra 236,2,29696
Ra 240,2,22528
Maav 8,208,64
buffer_load_dwordx4 v4, s[12:15], s39 offen offset:1024 sc1 lds
Maav 8,212,68
Ve 13,209
Maav 40,208,72
Ra 244,2,30720
Vc 104,12,13
Maav 40,212,76
VE 14,210
Maav 12,216,64
VE 15,211
Maav 12,220,68
Ra 248,2,23552
Vc 105,14,15
Maav 44,216,72
Ra 252,2,31744
v_or3_b32 v7, v7, v104, v105
Maav 44,220,76
VE 8,196
Mvvv 52,16,72
buffer_load_dwordx4 v4, s[12:15], s39 offen offset:2048 sc1 lds
Mvvv 52,16,76
s_waitcnt lgkmcnt(4)
Ve 9,197
Maav 16,224,64
Ra 192,3,0
Vc 98,8,9
Maav 16,228,68
VE 10,198
Maav 48,224,72
VE 11,199
Maav 48,228,76
Ra 196,3,1024
Vc 99,10,11
Maav 20,232,64
Ra 200,3,2048
v_or3_b32 v7, v7, v98, v99
Maav 20,236,68
Ra 204,3,3072
Ra 208,3,4096
Maav 52,232,72
buffer_load_dwordx4 v4, s[12:15], s39 offen offset:3072 sc1 lds
Maav 52,236,76
s_waitcnt lgkmcnt(5)
Ve 12,212
Maav 24,240,64
s_add_u32 s39, s39, 34816
VE 13,213
Maav 24,244,68
Ra 212,3,5120
Vc 106,12,13
Maav 56,240,72
VE 14,214
Maav 56,244,76
VE 15,215
Maav 28,248,64
Ra 216,3,6144
Vc 107,14,15
Maav 28,252,68
Ra 220,3,7168
v_or3_b32 v7, v7, v106, v107
Maav 60,248,72
s_waitcnt lgkmcnt(4)
Ve 8,200
Maav 60,252,76
VE 9,201
Cvaa 128,192,128,32
s_add_u32 m0, s53, 32768
Ra 224,3,8192
Vc 100,8,9
Mvaa 128,196,132
buffer_load_dwordx4 v4, s[12:15], s38 offen offset:0 sc1 lds
Mvaa 128,200,136
VE 10,202
Mvaa 128,204,140
VE 11,203
Cvaa 144,192,144,36
Ra 228,3,9216
Vc 101,10,11
Mvaa 144,196,148
Ra 232,3,10240
v_or3_b32 v7, v7, v100, v101
Mvaa 144,200,152
VE 12,216
Mvaa 144,204,156
s_waitcnt lgkmcnt(3)
Ra 236,3,11264
Ra 240,3,12288
Cvaa 132,208,128,32
buffer_load_dwordx4 v4, s[12:15], s38 offen offset:1024 sc1 lds
Mvaa 132,212,132
Ve 13,217
Mvaa 132,216,136
Ra 244,3,13312
Vc 108,12,13
Mvaa 132,220,140
VE 14,218
Cvaa 148,208,144,36
VE 15,219
Mvaa 148,212,148
buffer_load_dwordx4 v4, s[12:15], s38 offen offset:2048 sc1 lds
Mvaa 148,216,152
Ra 248,3,14336
Vc 109,14,15
Mvaa 148,220,156
s_waitcnt lgkmcnt(3)
Ra 252,3,15360
v_or3_b32 v7, v7, v108, v109
Cvaa 136,224,128,32
Ve 8,204
Mvaa 136,228,132
VE 9,205
Mvaa 136,232,136
Ra 192,2,49152
Vc 102,8,9
Mvaa 136,236,140
buffer_load_dwordx4 v4, s[12:15], s38 offen offset:3072 sc1 lds
Cvaa 152,224,144,36
VE 10,206
Mvaa 152,228,148
VE 11,207
Mvaa 152,232,152
Ra 196,2,57344
Vc 103,10,11
Mvaa 152,236,156
s_waitcnt lgkmcnt(2)
Ra 200,2,50176
Ra 204,2,58368
Cvaa 140,240,128,32
Ra 208,2,51200
v_or3_b32 v7, v7, v102, v103
Mvaa 140,244,132
s_cmp_lt_u32 s37, s52
VE 12,220
Mvaa 140,248,136
s_cbranch_scc1 L_nw_no
s_waitcnt vmcnt(12)
L_nw_no:
VE 13,221
Mvaa 140,252,140
Ra 212,2,59392
Vc 110,12,13
Cvaa 156,240,144,36
s_cmp_eq_u32 s37, s45
Ve 14,222
Mvaa 156,244,148
s_barrier
Ve 15,223
Mvaa 156,248,152
s_waitcnt lgkmcnt(2)
Ra 216,2,52224
Vc 111,14,15
v_or3_b32 v7, v7, v110, v111
v_and_b32 v1, 0x40004000, v7
v_cmp_ne_u32 vcc, 0, v1
Mvaa 156,252,156
s_cbranch_vccnz L_k2_fb_no
L_k2_fbr_no:
Ra 220,2,60416
Maav 0,192,96
s_cbranch_scc1 L_k2_mk_no
L_k2_mkr_no:
VE 8,128
Maav 0,196,100
s_add_u32 m0, s53, 16384
VE 9,129
Maav 32,192,104
buffer_load_dwordx4 v4, s[12:15], s39 offen offset:0 sc1 lds
Maav 32,196,108
s_add_u32 s37, s37, 1
Ra 224,2,53248
Vc 64,8,9
Maav 4,200,96
s_add_u32 s38, s38, 34816
Ve 10,130
Maav 4,204,100
s_xor_b32 s53, s53, 65536
VE 11,131
Maav 36,200,104
s_xor_b32 s54, s54, 65536
Ra 228,2,61440
Vc 65,10,11
Maav 36,204,108
Ra 232,2,54272
v_or_b32_e64 v7, v64, v65
Mvvv 48,16,96
VE 12,144
Mvvv 48,16,100
s_waitcnt lgkmcnt(3)
Ra 236,2,62464
Ra 240,2,55296
Maav 8,208,96
buffer_load_dwordx4 v4, s[12:15], s39 offen offset:1024 sc1 lds
Maav 8,212,100
Ve 13,145
Maav 40,208,104
Ra 244,2,63488
Vc 72,12,13
Maav 40,212,108
VE 14,146
Maav 12,216,96
VE 15,147
Maav 12,220,100
Ra 248,2,56320
Vc 73,14,15
Maav 44,216,104
Ra 252,2,64512
v_or3_b32 v7, v7, v72, v73
Maav 44,220,108
VE 8,132
Mvvv 52,16,104
buffer_load_dwordx4 v4, s[12:15], s39 offen offset:2048 sc1 lds
Mvvv 52,16,108
s_waitcnt lgkmcnt(4)
Ve 9,133
Maav 16,224,96
Ra 192,3,32768
Vc 66,8,9
Maav 16,228,100
VE 10,134
Maav 48,224,104
VE 11,135
Maav 48,228,108
Ra 196,3,33792
Vc 67,10,11
Maav 20,232,96
Ra 200,3,34816
v_or3_b32 v7, v7, v66, v67
Maav 20,236,100
Ra 204,3,35840
Ra 208,3,36864
Maav 52,232,104
buffer_load_dwordx4 v4, s[12:15], s39 offen offset:3072 sc1 lds
Maav 52,236,108
s_waitcnt lgkmcnt(5)
Ve 12,148
Maav 24,240,96
s_add_u32 s39, s39, 34816
VE 13,149
Maav 24,244,100
Ra 212,3,37888
Vc 74,12,13
Maav 56,240,104
VE 14,150
Maav 56,244,108
VE 15,151
Maav 28,248,96
Ra 216,3,38912
Vc 75,14,15
Maav 28,252,100
s_cmp_lg_u32 s37, s36
Ra 220,3,39936
v_or3_b32 v7, v7, v74, v75
Maav 60,248,104
s_waitcnt lgkmcnt(4)
VE 8,136
Maav 60,252,108
s_cbranch_scc1 L_k2_nloop
L_k2_fin:
s_getpc_b64 s[56:57]
L_cpf5:
s_add_u32 s56, s56, (L_p4_entry-L_cpf5)&0xffffffff
s_addc_u32 s57, s57, ((L_p4_entry-L_cpf5)>>32)&0xffffffff
s_lshl_b32 s58, s32, 13
v_lshlrev_b32 v162, 7, v0
v_add_u32_e64 v162, s58, v162
v_min_u32 v162, L_p4_end-L_p4_entry-4, v162
v_mov_b32 v161, s57
v_add_co_u32 v160, vcc, s56, v162
s_nop 1
v_addc_co_u32 v161, vcc, 0, v161, vcc
global_load_dword v164, v[160:161], off
v_xor_b32 v2, 65536, v2
v_xor_b32 v3, 65536, v3
s_lshr_b32 s3, s42, 4
s_mul_i32 s3, s3, 33792
s_and_b32 s47, s42, 15
s_lshl_b32 s47, s47, 4
s_add_u32 s3, s3, s47
v_mov_b32 v28, s3
s_lshr_b32 s3, s43, 4
s_mul_i32 s3, s3, 33792
s_and_b32 s47, s43, 15
s_lshl_b32 s47, s47, 4
s_add_u32 s3, s3, s47
v_mov_b32 v29, s3
v_lshrrev_b32 v24, 4, v0
v_and_b32 v25, 15, v0
v_cmp_eq_u32 vcc, 1, v25
s_lshl_b32 s3, s32, 4
v_add_u32 v26, s3, v24
v_cndmask_b32 v28, v28, v29, vcc
v_lshl_add_u32 v28, v24, 8, v28
v_mul_u32_u24 v26, 7168, v26
v_lshlrev_b32 v24, 1, v24
v_xor_b32 v24, v24, v25
v_xor_b32_e64 v25, 8, v24
v_lshl_add_u32 v24, v24, 4, v26
v_lshl_add_u32 v25, v25, 4, v26
s_lshl_b32 s3, s92, 12
buffer_load_dwordx4 a[160:163], v28, s[20:23], s3 offen offset:0 sc1
buffer_load_dwordx4 a[164:167], v28, s[20:23], s3 offen offset:1024 sc1
buffer_load_dwordx4 a[168:171], v28, s[20:23], s3 offen offset:2048 sc1
buffer_load_dwordx4 a[172:175], v28, s[20:23], s3 offen offset:3072 sc1
Cvaa 192,192,128,32
s_add_u32 m0, s54, 0
s_add_u32 s3, s5, 0
Ve 9,137
Mvaa 192,196,132
buffer_load_dwordx4 v24, s[68:71], s3 offen offset:0 lds
Mvaa 192,200,136
Ra 224,2,40960
Ra 228,2,41984
Mvaa 192,204,140
s_waitcnt lgkmcnt(2)
Ra 232,2,43008
Ra 236,2,44032
Cvaa 196,208,128,32
s_add_u32 s3, s5, 27648
Ra 240,2,45056
Vc 68,8,9
Mvaa 196,212,132
buffer_load_dwordx4 v24, s[68:71], s3 offen offset:1024 lds
Mvaa 196,216,136
Ra 244,2,46080
Ra 248,2,47104
Mvaa 196,220,140
s_waitcnt lgkmcnt(3)
s_add_u32 s3, s5, 55296
Ra 252,2,48128
Ra 192,2,16384
Cvaa 200,224,128,32
buffer_load_dwordx4 v25, s[68:71], s3 offen offset:2048 lds
Mvaa 200,228,132
s_cmp_lt_u32 s37, s52
Ve 10,138
Mvaa 200,232,136
s_cbranch_scc1 L_nw_nl
s_waitcnt vmcnt(15)
L_nw_nl:
Ra 196,2,24576
Ra 200,2,17408
Mvaa 200,236,140
s_waitcnt lgkmcnt(3)
s_add_u32 s3, s5, 82944
Ra 204,2,25600
Ra 208,2,18432
Cvaa 204,240,128,32
buffer_load_dwordx4 v25, s[68:71], s3 offen offset:3072 lds
Mvaa 204,244,132
s_barrier
VE 11,139
Mvaa 204,248,136
s_waitcnt lgkmcnt(1)
Ra 212,2,26624
Vc 69,10,11
Ve 12,152
Ve 13,153
Ve 14,154
Ve 15,155
Ve 8,140
Ve 9,141
Ve 10,142
VE 11,143
Vc 76,12,13
Ve 12,156
Ve 13,157
Vc 77,14,15
Ve 14,158
Ve 15,159
Vc 70,8,9
Vc 71,10,11
Vc 78,12,13
Vc 79,14,15
v_or3_b32 v7, v7, v68, v69
v_or3_b32 v7, v7, v76, v77
v_or3_b32 v7, v7, v70, v71
v_or3_b32 v7, v7, v78, v79
v_and_b32 v1, 0x40004000, v7
v_cmp_ne_u32 vcc, 0, v1
Mvaa 204,252,140
s_cbranch_vccnz L_k2_fb_nl
L_k2_fbr_nl:
Ra 216,2,19456
Ra 220,2,27648
Maav 0,192,64
v_cmp_gt_i32 s[56:57], 0, v6
v_cmp_gt_i32 s[58:59], 1, v6
v_cmp_gt_i32 s[60:61], 2, v6
v_cmp_gt_i32 s[62:63], 3, v6
s_nop 3
s_nop 0
v_cndmask_b32 v192, v192, v20, s[56:57]
v_cndmask_b32 v193, v193, v20, s[58:59]
v_cndmask_b32 v194, v194, v20, s[60:61]
v_cndmask_b32 v195, v195, v20, s[62:63]
v_cmp_gt_i32 s[56:57], 16, v6
v_cmp_gt_i32 s[58:59], 17, v6
v_cmp_gt_i32 s[60:61], 18, v6
v_cmp_gt_i32 s[62:63], 19, v6
v_cndmask_b32 v196, v196, v20, s[56:57]
v_cndmask_b32 v197, v197, v20, s[58:59]
v_cndmask_b32 v198, v198, v20, s[60:61]
v_cndmask_b32 v199, v199, v20, s[62:63]
v_cmp_gt_i32 s[56:57], 32, v6
v_cmp_gt_i32 s[58:59], 33, v6
v_cmp_gt_i32 s[60:61], 34, v6
v_cmp_gt_i32 s[62:63], 35, v6
v_cndmask_b32 v200, v200, v20, s[56:57]
v_cndmask_b32 v201, v201, v20, s[58:59]
v_cndmask_b32 v202, v202, v20, s[60:61]
v_cndmask_b32 v203, v203, v20, s[62:63]
v_cmp_gt_i32 s[56:57], 48, v6
v_cmp_gt_i32 s[58:59], 49, v6
v_cmp_gt_i32 s[60:61], 50, v6
v_cmp_gt_i32 s[62:63], 51, v6
v_cndmask_b32 v204, v204, v20, s[56:57]
v_cndmask_b32 v205, v205, v20, s[58:59]
v_cndmask_b32 v206, v206, v20, s[60:61]
v_cndmask_b32 v207, v207, v20, s[62:63]
VE 8,192
Maav 0,196,68
s_add_u32 m0, s54, 16384
s_add_u32 s3, s5, 458752
VE 9,193
Maav 32,192,72
buffer_load_dwordx4 v24, s[68:71], s3 offen offset:0 lds
Maav 32,196,76
s_mov_b32 s60, s8
Ra 224,2,20480
Vc 96,8,9
Maav 4,200,64
s_and_b32 s61, s9, 0xffff
s_mov_b32 s62, 7340032
Ve 10,194
Maav 4,204,68
s_mov_b32 s63, 0x20000
s_mov_b32 s56, s40
Ve 11,195
Maav 36,200,72
s_and_b32 s57, s41, 0xffff
Ra 228,2,28672
Vc 97,10,11
Maav 36,204,76
s_mov_b32 s58, 4194304
Ra 232,2,21504
v_or_b32_e64 v7, v96, v97
Mvvv 48,16,64
s_mov_b32 s59, 0x20000
s_bfe_u32 s6, s2, 0x20001
VE 12,196
Mvvv 48,16,68
s_waitcnt lgkmcnt(3)
s_add_u32 s3, s5, 486400
Ra 236,2,29696
Ra 240,2,22528
Maav 8,208,64
buffer_load_dwordx4 v24, s[68:71], s3 offen offset:1024 lds
Maav 8,212,68
s_lshr_b32 s7, s34, 1
s_xor_b32 s7, s7, 2
Ve 13,197
Maav 40,208,72
s_lshl_b32 s45, s7, 2
Ra 244,2,30720
Vc 98,12,13
Maav 40,212,76
s_add_u32 s46, s45, s6
s_sub_u32 s46, 15, s46
Ve 14,198
Maav 12,216,64
s_sub_u32 s45, 12, s45
s_add_u32 s45, s45, s6
VE 15,199
Maav 12,220,68
s_cmp_lt_u32 s7, 2
s_cselect_b32 s45, s46, s45
Ra 248,2,23552
Vc 99,14,15
Maav 44,216,72
s_and_b32 s46, s2, 1
Ra 252,2,31744
v_or3_b32 v7, v7, v98, v99
Maav 44,220,76
s_add_u32 s3, s5, 514048
Ve 8,200
Mvvv 52,16,72
buffer_load_dwordx4 v25, s[68:71], s3 offen offset:2048 lds
Mvvv 52,16,76
s_waitcnt lgkmcnt(4)
Ve 9,201
Maav 16,224,64
s_bfe_u32 s6, s2, 0x30003
Ra 192,2,49152
Vc 100,8,9
Maav 16,228,68
s_lshl_b32 s6, s6, 1
s_add_u32 s46, s46, s6
VE 10,202
Maav 48,224,72
s_mov_b32 s48, 0
s_mov_b32 s49, 15360
Ve 11,203
Maav 48,228,76
s_mov_b32 s50, 30720
Ra 196,2,57344
Vc 101,10,11
Maav 20,232,64
s_mov_b32 s51, 46080
Ra 200,2,50176
v_or3_b32 v7, v7, v100, v101
Maav 20,236,68
s_add_u32 s3, s5, 541696
Ra 204,2,58368
Ra 208,2,51200
Maav 52,232,72
buffer_load_dwordx4 v25, s[68:71], s3 offen offset:3072 lds
Maav 52,236,76
s_waitcnt lgkmcnt(5)
Ve 12,204
Maav 24,240,64
s_lshl_b32 s35, s32, 13
s_add_u32 s35, s35, 131072
Ve 13,205
Maav 24,244,68
s_and_b32 s52, s46, 1
Ra 212,2,59392
Vc 102,12,13
Maav 56,240,72
s_lshl_b32 s37, s45, 20
s_lshl_b32 s7, s52, 19
Ve 14,206
Maav 56,244,76
s_add_u32 s37, s37, s7
s_add_u32 s37, s37, 46137344
Ve 15,207
Maav 28,248,64
s_lshr_b32 s7, s46, 1
Ra 216,2,52224
Vc 103,14,15
Maav 28,252,68
s_lshl_b32 s7, s7, 8
Ra 220,2,60416
v_or3_b32 v7, v7, v102, v103
Maav 60,248,72
s_waitcnt lgkmcnt(4)
Maav 60,252,76
s_lshl_b32 s6, s52, 22
s_add_u32 s6, s6, s7
v_and_b32 v1, 0x40004000, v7
v_cmp_ne_u32 vcc, 0, v1
s_cbranch_vccnz L_k2_fb_fi
L_k2_fbr_fi:
Maav 0,192,96
Ra 224,2,53248
Ra 228,2,61440
Maav 0,196,100
Ra 232,2,54272
Ra 236,2,62464
Maav 4,200,96
Ra 240,2,55296
Ra 244,2,63488
Maav 4,204,100
Ra 248,2,56320
Ra 252,2,64512
Mvvv 48,16,96
s_add_u32 s12, s94, s6
s_addc_u32 s13, s95, 0
s_and_b32 s13, s13, 0xffff
Mvvv 48,16,100
s_waitcnt lgkmcnt(8)
Maav 8,208,96
s_mov_b32 s14, 0
s_mov_b32 s15, 0x20000
s_sub_u32 s14, 4194304, s7
Maav 8,212,100
s_mov_b32 s28, s94
s_and_b32 s29, s95, 0xffff
s_mov_b32 s30, 8388608
Maav 12,216,96
s_mov_b32 s31, 0x20000
s_lshl_b32 s7, s46, 7
s_lshl_b32 s36, s45, 18
Maav 12,220,100
s_waitcnt lgkmcnt(4)
Maav 16,224,96
s_add_u32 s36, s36, s7
s_and_b32 s94, s7, 128
s_lshl_b32 s38, s45, 7
Maav 16,228,100
s_lshl_b32 s6, s52, 6
s_add_u32 s38, s38, s6
s_add_u32 s38, s38, 5300224
Maav 20,232,96
s_lshl_b32 s52, s32, 11
s_lshl_b32 s6, s32, 16
s_add_u32 s6, s6, s94
Maav 20,236,100
s_waitcnt lgkmcnt(0)
Maav 24,240,96
s_xor_b32 s6, s6, 128
s_lshl_b32 s7, s32, 5
s_mov_b32 s68, s10
Maav 24,244,100
s_and_b32 s69, s11, 0xffff
s_mov_b32 s70, 4194304
s_mov_b32 s71, 0x20000
s_add_u32 s8, s66, s37
s_addc_u32 s9, s67, 0
s_and_b32 s9, s9, 0xffff
Maav 28,248,96
s_mov_b32 s10, 524288
s_mov_b32 s11, 0x20000
v_lshlrev_b32 v112, 4, v0
v_lshrrev_b32_e64 v121, 4, v0
Maav 28,252,100
v_and_b32 v122, 7, v0
v_lshrrev_b32 v123, 3, v0
v_lshlrev_b32 v124, 1, v121
s_nop 7
s_lshl_b32 s3, s55, 20
s_lshl_b32 s47, s33, 15
s_add_u32 s3, s3, s47
s_lshl_b32 s47, s32, 10
v_lshlrev_b32 v248, 4, v0
v_add_u32 v249, s47, v248
s_sub_u32 s47, 7168, s47
v_add_u32 v248, s47, v248
v_rcp_f32 v250, v48
v_rcp_f32 v252, v52
v_mov_b32 v251, v250
v_mov_b32_e64 v253, v252
Ar 240,32
Ar 241,33
Ar 242,34
Ar 243,35
Ar 244,36
Ar 245,37
Ar 246,38
Ar 247,39
v_pk_mul_f32 v[240:241], v[240:241], v[252:253]
v_pk_mul_f32 v[242:243], v[242:243], v[252:253]
v_pk_mul_f32 v[244:245], v[244:245], v[252:253]
v_pk_mul_f32 v[246:247], v[246:247], v[252:253]
Vc 28,240,241
Vc 29,242,243
Vc 30,244,245
Vc 31,246,247
buffer_store_dwordx4 v[28:31], v249, s[16:19], s3 offen sc1
Ar 240,0
Ar 241,1
Ar 242,2
Ar 243,3
Ar 244,4
Ar 245,5
Ar 246,6
Ar 247,7
v_pk_mul_f32 v[240:241], v[240:241], v[250:251]
v_pk_mul_f32 v[242:243], v[242:243], v[250:251]
v_pk_mul_f32 v[244:245], v[244:245], v[250:251]
v_pk_mul_f32 v[246:247], v[246:247], v[250:251]
Vc 24,240,241
Vc 25,242,243
Vc 26,244,245
Vc 27,246,247
buffer_store_dwordx4 v[24:27], v248, s[16:19], s3 offen sc1
s_add_u32 s3, s3, 8192
Ar 240,40
Ar 241,41
Ar 242,42
Ar 243,43
Ar 244,44
Ar 245,45
Ar 246,46
Ar 247,47
v_pk_mul_f32 v[240:241], v[240:241], v[252:253]
v_pk_mul_f32 v[242:243], v[242:243], v[252:253]
v_pk_mul_f32 v[244:245], v[244:245], v[252:253]
v_pk_mul_f32 v[246:247], v[246:247], v[252:253]
Vc 28,240,241
Vc 29,242,243
Vc 30,244,245
Vc 31,246,247
buffer_store_dwordx4 v[28:31], v249, s[16:19], s3 offen sc1
Ar 240,8
Ar 241,9
Ar 242,10
Ar 243,11
Ar 244,12
Ar 245,13
Ar 246,14
Ar 247,15
v_pk_mul_f32 v[240:241], v[240:241], v[250:251]
v_pk_mul_f32 v[242:243], v[242:243], v[250:251]
v_pk_mul_f32 v[244:245], v[244:245], v[250:251]
v_pk_mul_f32 v[246:247], v[246:247], v[250:251]
Vc 24,240,241
Vc 25,242,243
Vc 26,244,245
Vc 27,246,247
buffer_store_dwordx4 v[24:27], v248, s[16:19], s3 offen sc1
s_add_u32 s3, s3, 8192
Ar 240,48
Ar 241,49
Ar 242,50
Ar 243,51
Ar 244,52
Ar 245,53
Ar 246,54
Ar 247,55
v_pk_mul_f32 v[240:241], v[240:241], v[252:253]
v_pk_mul_f32 v[242:243], v[242:243], v[252:253]
v_pk_mul_f32 v[244:245], v[244:245], v[252:253]
v_pk_mul_f32 v[246:247], v[246:247], v[252:253]
Vc 28,240,241
Vc 29,242,243
Vc 30,244,245
Vc 31,246,247
buffer_store_dwordx4 v[28:31], v249, s[16:19], s3 offen sc1
Ar 240,16
Ar 241,17
Ar 242,18
Ar 243,19
Ar 244,20
Ar 245,21
Ar 246,22
Ar 247,23
v_pk_mul_f32 v[240:241], v[240:241], v[250:251]
v_pk_mul_f32 v[242:243], v[242:243], v[250:251]
v_pk_mul_f32 v[244:245], v[244:245], v[250:251]
v_pk_mul_f32 v[246:247], v[246:247], v[250:251]
Vc 24,240,241
Vc 25,242,243
Vc 26,244,245
Vc 27,246,247
buffer_store_dwordx4 v[24:27], v248, s[16:19], s3 offen sc1
s_add_u32 s3, s3, 8192
Ar 240,56
Ar 241,57
Ar 242,58
Ar 243,59
Ar 244,60
Ar 245,61
Ar 246,62
Ar 247,63
v_pk_mul_f32 v[240:241], v[240:241], v[252:253]
v_pk_mul_f32 v[242:243], v[242:243], v[252:253]
v_pk_mul_f32 v[244:245], v[244:245], v[252:253]
v_pk_mul_f32 v[246:247], v[246:247], v[252:253]
Vc 28,240,241
Vc 29,242,243
Vc 30,244,245
Vc 31,246,247
buffer_store_dwordx4 v[28:31], v249, s[16:19], s3 offen sc1
Ar 240,24
Ar 241,25
Ar 242,26
Ar 243,27
Ar 244,28
Ar 245,29
Ar 246,30
Ar 247,31
v_pk_mul_f32 v[240:241], v[240:241], v[250:251]
v_pk_mul_f32 v[242:243], v[242:243], v[250:251]
v_pk_mul_f32 v[244:245], v[244:245], v[250:251]
v_pk_mul_f32 v[246:247], v[246:247], v[250:251]
Vc 24,240,241
Vc 25,242,243
Vc 26,244,245
Vc 27,246,247
buffer_store_dwordx4 v[24:27], v248, s[16:19], s3 offen sc1
s_cmp_lt_u32 s34, 1
s_cbranch_scc1 L_noffn
v_lshrrev_b32_e64 v24, 4, v0
v_bfe_u32 v25, v0, 2, 2
v_lshl_add_u32 v26, v24, 3, v25
v_lshlrev_b32 v26, 8, v26
v_and_b32 v27, 3, v0
v_lshl_add_u32 v26, v27, 3, v26
v_and_b32_e64 v27, 1, v24
v_lshl_add_u32 v25, v27, 2, v25
s_lshl_b32 s3, s32, 1
v_xor_b32 v25, s3, v25
v_lshl_add_u32 v26, v25, 5, v26
s_sub_u32 s3, s54, s44
v_add_u32 v30, s3, v26
v_xor_b32_e64 v31, 32, v30
v_add_u32 v26, 131072, v26
v_xor_b32 v27, 32, v26
s_waitcnt vmcnt(8) lgkmcnt(0)
s_barrier
s_nop 0
ds_read_b64_tr_b16 v[128:129], v26 offset:0
ds_read_b64_tr_b16 v[130:131], v26 offset:1024
ds_read_b64_tr_b16 v[132:133], v27 offset:0
ds_read_b64_tr_b16 v[134:135], v27 offset:1024
ds_read_b64_tr_b16 v[136:137], v26 offset:8192
ds_read_b64_tr_b16 v[138:139], v26 offset:9216
ds_read_b64_tr_b16 v[140:141], v27 offset:8192
ds_read_b64_tr_b16 v[142:143], v27 offset:9216
ds_read_b64_tr_b16 v[144:145], v26 offset:16384
ds_read_b64_tr_b16 v[146:147], v26 offset:17408
ds_read_b64_tr_b16 v[148:149], v27 offset:16384
ds_read_b64_tr_b16 v[150:151], v27 offset:17408
ds_read_b64_tr_b16 v[152:153], v26 offset:24576
ds_read_b64_tr_b16 v[154:155], v26 offset:25600
ds_read_b64_tr_b16 v[156:157], v27 offset:24576
s_waitcnt lgkmcnt(9)
s_nop 0
ds_read_b64_tr_b16 v[158:159], v27 offset:25600
ds_read_b64_tr_b16 v[160:161], v30 offset:0
ds_read_b64_tr_b16 v[162:163], v30 offset:1024
ds_read_b64_tr_b16 v[164:165], v31 offset:0
ds_read_b64_tr_b16 v[166:167], v31 offset:1024
ds_read_b64_tr_b16 v[168:169], v30 offset:8192
s_waitcnt lgkmcnt(9)
s_nop 0
ds_read_b64_tr_b16 v[170:171], v30 offset:9216
ds_read_b64_tr_b16 v[172:173], v31 offset:8192
ds_read_b64_tr_b16 v[174:175], v31 offset:9216
ds_read_b64_tr_b16 v[176:177], v30 offset:16384
ds_read_b64_tr_b16 v[178:179], v30 offset:17408
ds_read_b64_tr_b16 v[180:181], v31 offset:16384
s_waitcnt lgkmcnt(9)
ds_read_b64_tr_b16 v[182:183], v31 offset:17408
ds_read_b64_tr_b16 v[184:185], v30 offset:24576
ds_read_b64_tr_b16 v[186:187], v30 offset:25600
ds_read_b64_tr_b16 v[188:189], v31 offset:24576
ds_read_b64_tr_b16 v[190:191], v31 offset:25600
v_and_b32 v25, 15, v0
v_mul_u32_u24 v28, 14336, v25
v_lshl_add_u32 v28, v24, 4, v28
v_mov_b32 v29, 2146435072
v_cmp_gt_u32 vcc, 2, v25
s_mul_i32 s3, s92, 57344
s_lshl_b32 s47, s4, 9
s_add_u32 s3, s3, s47
v_cndmask_b32 v28, v29, v28, vcc
s_lshl_b32 s47, s32, 7
s_add_u32 s3, s3, s47
s_add_u32 s3, s3, 6291456
Zvva 224,128,160
Zvva 228,132,160
Mvva 224,136,164
Mvva 228,140,164
Mvva 224,144,168
Mvva 228,148,168
Mvva 224,152,172
Mvva 228,156,172
s_waitcnt lgkmcnt(0)
Zvva 232,160,160
Zvva 236,164,160
Mvva 232,168,164
Mvva 236,172,164
Mvva 232,176,168
Mvva 236,180,168
Mvva 232,184,172
Mvva 236,188,172
L_noffn:
v_xor_b32 v124, v124, v122
v_lshlrev_b32_e64 v124, 4, v124
v_lshl_add_u32 v113, v123, 11, v124
v_add_u32 v114, s6, v113
v_lshrrev_b32 v124, 2, v0
v_bfe_u32 v126, v0, 3, 2
v_lshlrev_b32 v124, 7, v124
v_and_b32 v125, 3, v0
v_lshl_add_u32 v124, v125, 3, v124
v_lshl_add_u32 v115, v126, 5, v124
v_xor_b32 v116, 32, v115
v_xor_b32 v117, 64, v115
v_xor_b32 v118, 96, v115
v_add_u32 v120, s7, v123
v_lshlrev_b32 v119, 11, v120
v_lshl_add_u32 v119, v122, 4, v119
v_mov_b32 v126, 0
v_lshlrev_b32 v127, 2, v122
v_mov_b32 v24, 1
v_mul_u32_u24 v25, s65, v0
s_waitcnt vmcnt(0)
s_barrier
s_mov_b64 exec, 3
buffer_store_dword v24, v25, s[20:23], s64 offen sc1
s_mov_b64 exec, -1
L_p4_entry:
s_cmp_ge_u32 s34, 1
s_nop 0
s_cselect_b32 s3, s3, 8388608
s_add_u32 s7, s3, 28672
buffer_store_dwordx4 v[224:227], v28, s[20:23], s3 offen offset:0 sc1
buffer_store_dwordx4 v[228:231], v28, s[20:23], s3 offen offset:64 sc1
buffer_store_dwordx4 v[232:235], v28, s[20:23], s7 offen offset:0 sc1
buffer_store_dwordx4 v[236:239], v28, s[20:23], s7 offen offset:64 sc1
s_lshl_b32 s33, s4, 3
s_add_u32 s33, s33, s92
s_mov_b32 s65, s33
s_mov_b32 s3, s36
buffer_load_dwordx4 v[18:21], v119, s[56:59], s3 offen
s_add_u32 s3, s3, 16384
buffer_load_dwordx4 v[22:25], v119, s[56:59], s3 offen
s_add_u32 s3, s3, 16384
buffer_load_dwordx4 v[26:29], v119, s[56:59], s3 offen
s_add_u32 s3, s3, 16384
buffer_load_dwordx4 v[30:33], v119, s[56:59], s3 offen
s_lshl_b32 s3, s45, 10
s_add_u32 s3, s3, 5259264
v_lshlrev_b32 v124, 3, v120
buffer_load_dwordx2 v[34:35], v124, s[20:23], s3 offen offset:0 sc1
buffer_load_dwordx2 v[36:37], v124, s[20:23], s3 offen offset:64 sc1
buffer_load_dwordx2 v[38:39], v124, s[20:23], s3 offen offset:128 sc1
buffer_load_dwordx2 v[40:41], v124, s[20:23], s3 offen offset:192 sc1
v_and_b32 v10, 15, v0
v_lshlrev_b32 v10, 2, v10
s_add_u32 s95, s32, 32
s_lshl_b32 s95, s95, 16
s_add_u32 s95, s95, s94
s_xor_b32 s95, s95, 128
s_add_u32 m0, s44, 0
s_nop 0
s_nop 0
buffer_load_dwordx4 v114, s[12:15], s48 offen offset:0 lds
buffer_load_dwordx4 v114, s[12:15], s49 offen offset:1024 lds
buffer_load_dwordx4 v114, s[12:15], s50 offen offset:2048 lds
buffer_load_dwordx4 v114, s[12:15], s51 offen offset:3072 lds
v_xor_b32 v114, 128, v114
s_add_u32 m0, s44, 16384
s_nop 0
s_nop 0
buffer_load_dwordx4 v114, s[12:15], s48 offen offset:0 lds
buffer_load_dwordx4 v114, s[12:15], s49 offen offset:1024 lds
buffer_load_dwordx4 v114, s[12:15], s50 offen offset:2048 lds
buffer_load_dwordx4 v114, s[12:15], s51 offen offset:3072 lds
v_xor_b32 v114, 128, v114
v_add_u32 v114, 262144, v114
buffer_load_dword v124, v10, s[20:23], s38 offen sc1
v_add_u32 v12, 65536, v115
v_add_u32 v13, 65536, v116
v_add_u32 v14, 65536, v117
v_add_u32 v15, 65536, v118
s_and_b32 s39, s93, 15
s_lshr_b32 s37, s93, 4
s_lshl_b32 s54, s37, 2
s_add_u32 s54, s54, s32
s_lshl_b32 s3, s54, 17
s_lshl_b32 s7, s39, 7
s_add_u32 s3, s3, s7
s_cmp_lt_u32 s93, 224
s_cselect_b32 s3, s3, 2146435072
v_add_u32 v125, s3, v113
s_mov_b32 s40, 0
s_waitcnt vmcnt(9)
v_lshlrev_b32_e64 v42, 16, v18
v_and_b32 v43, 0xffff0000, v18
v_lshlrev_b32_e64 v44, 16, v19
v_and_b32 v45, 0xffff0000, v19
v_lshlrev_b32_e64 v46, 16, v20
v_and_b32 v47, 0xffff0000, v20
v_lshlrev_b32_e64 v48, 16, v21
v_and_b32 v49, 0xffff0000, v21
v_pk_add_f32 v[42:43], v[42:43], v[34:35] op_sel_hi:[1,0] neg_lo:[0,1] neg_hi:[0,1]
v_pk_add_f32 v[44:45], v[44:45], v[34:35] op_sel_hi:[1,0] neg_lo:[0,1] neg_hi:[0,1]
v_pk_add_f32 v[46:47], v[46:47], v[34:35] op_sel_hi:[1,0] neg_lo:[0,1] neg_hi:[0,1]
v_pk_add_f32 v[48:49], v[48:49], v[34:35] op_sel_hi:[1,0] neg_lo:[0,1] neg_hi:[0,1]
Vc 2,42,43
v_lshlrev_b32_e64 v42, 16, v2
v_and_b32 v43, 0xffff0000, v2
Vc 3,44,45
v_lshlrev_b32_e64 v44, 16, v3
v_and_b32 v45, 0xffff0000, v3
Vc 4,46,47
v_lshlrev_b32_e64 v46, 16, v4
v_and_b32 v47, 0xffff0000, v4
Vc 5,48,49
v_lshlrev_b32_e64 v48, 16, v5
v_and_b32 v49, 0xffff0000, v5
v_pk_mul_f32 v[42:43], v[42:43], v[34:35] op_sel:[0,1] op_sel_hi:[1,1]
v_pk_mul_f32 v[44:45], v[44:45], v[34:35] op_sel:[0,1] op_sel_hi:[1,1]
v_pk_mul_f32 v[46:47], v[46:47], v[34:35] op_sel:[0,1] op_sel_hi:[1,1]
v_pk_mul_f32 v[48:49], v[48:49], v[34:35] op_sel:[0,1] op_sel_hi:[1,1]
Vc 2,42,43
v_lshlrev_b32_e64 v42, 16, v2
v_and_b32 v43, 0xffff0000, v2
Vc 3,44,45
v_lshlrev_b32_e64 v44, 16, v3
v_and_b32 v45, 0xffff0000, v3
Vc 4,46,47
v_lshlrev_b32_e64 v46, 16, v4
v_and_b32 v47, 0xffff0000, v4
Vc 5,48,49
v_lshlrev_b32_e64 v48, 16, v5
v_and_b32 v49, 0xffff0000, v5
v_mul_f32 v2, 0xbfb8aa3b, v42
v_mul_f32 v3, 0xbfb8aa3b, v43
v_mul_f32 v4, 0xbfb8aa3b, v44
v_mul_f32 v5, 0xbfb8aa3b, v45
v_mul_f32 v6, 0xbfb8aa3b, v46
v_mul_f32 v7, 0xbfb8aa3b, v47
v_mul_f32 v8, 0xbfb8aa3b, v48
v_mul_f32 v9, 0xbfb8aa3b, v49
Ve 2,2
Ve 3,3
Ve 4,4
Ve 5,5
Ve 6,6
Ve 7,7
Ve 8,8
Ve 9,9
v_add_f32 v2, 1.0, v2
v_add_f32 v3, 1.0, v3
v_add_f32 v4, 1.0, v4
v_add_f32 v5, 1.0, v5
v_add_f32 v6, 1.0, v6
v_add_f32 v7, 1.0, v7
v_add_f32 v8, 1.0, v8
v_add_f32 v9, 1.0, v9
v_rcp_f32 v2, v2
v_rcp_f32 v3, v3
v_rcp_f32 v4, v4
v_rcp_f32 v5, v5
v_rcp_f32 v6, v6
v_rcp_f32 v7, v7
v_rcp_f32 v8, v8
v_rcp_f32 v9, v9
v_pk_mul_f32 v[42:43], v[42:43], v[2:3]
v_pk_mul_f32 v[44:45], v[44:45], v[4:5]
v_pk_mul_f32 v[46:47], v[46:47], v[6:7]
v_pk_mul_f32 v[48:49], v[48:49], v[8:9]
Vc 2,42,43
v_lshlrev_b32_e64 v42, 16, v2
v_and_b32 v43, 0xffff0000, v2
Vc 3,44,45
v_lshlrev_b32_e64 v44, 16, v3
v_and_b32 v45, 0xffff0000, v3
Vc 4,46,47
v_lshlrev_b32_e64 v46, 16, v4
v_and_b32 v47, 0xffff0000, v4
Vc 5,48,49
v_lshlrev_b32_e64 v48, 16, v5
v_and_b32 v49, 0xffff0000, v5
s_waitcnt vmcnt(0)
v_cmp_ne_u32 vcc, 1, v124
s_cbranch_vccnz L_spinC
s_nop 0
L_spinCr:
buffer_load_dwordx4 a[0:3], v112, s[8:11], s52 offen offset:0 sc1
buffer_load_dwordx4 a[4:7], v112, s[8:11], s52 offen offset:1024 sc1
s_add_u32 s52, s52, 8192
buffer_load_dwordx4 a[8:11], v112, s[8:11], s52 offen offset:0 sc1
buffer_load_dwordx4 a[12:15], v112, s[8:11], s52 offen offset:1024 sc1
s_add_u32 s52, s52, 8192
buffer_load_dwordx4 a[16:19], v112, s[8:11], s52 offen offset:0 sc1
buffer_load_dwordx4 a[20:23], v112, s[8:11], s52 offen offset:1024 sc1
s_add_u32 s52, s52, 8192
buffer_load_dwordx4 a[24:27], v112, s[8:11], s52 offen offset:0 sc1
buffer_load_dwordx4 a[28:31], v112, s[8:11], s52 offen offset:1024 sc1
s_add_u32 s52, s52, 8192
buffer_load_dwordx4 a[32:35], v112, s[8:11], s52 offen offset:0 sc1
buffer_load_dwordx4 a[36:39], v112, s[8:11], s52 offen offset:1024 sc1
s_add_u32 s52, s52, 8192
buffer_load_dwordx4 a[40:43], v112, s[8:11], s52 offen offset:0 sc1
buffer_load_dwordx4 a[44:47], v112, s[8:11], s52 offen offset:1024 sc1
s_add_u32 s52, s52, 8192
v_lshlrev_b32_e64 v50, 16, v22
v_and_b32 v51, 0xffff0000, v22
v_lshlrev_b32_e64 v52, 16, v23
v_and_b32 v53, 0xffff0000, v23
v_lshlrev_b32_e64 v54, 16, v24
v_and_b32 v55, 0xffff0000, v24
v_lshlrev_b32_e64 v56, 16, v25
v_and_b32 v57, 0xffff0000, v25
v_pk_add_f32 v[50:51], v[50:51], v[36:37] op_sel_hi:[1,0] neg_lo:[0,1] neg_hi:[0,1]
v_pk_add_f32 v[52:53], v[52:53], v[36:37] op_sel_hi:[1,0] neg_lo:[0,1] neg_hi:[0,1]
v_pk_add_f32 v[54:55], v[54:55], v[36:37] op_sel_hi:[1,0] neg_lo:[0,1] neg_hi:[0,1]
v_pk_add_f32 v[56:57], v[56:57], v[36:37] op_sel_hi:[1,0] neg_lo:[0,1] neg_hi:[0,1]
Vc 2,50,51
v_lshlrev_b32_e64 v50, 16, v2
v_and_b32 v51, 0xffff0000, v2
Vc 3,52,53
v_lshlrev_b32_e64 v52, 16, v3
v_and_b32 v53, 0xffff0000, v3
Vc 4,54,55
v_lshlrev_b32_e64 v54, 16, v4
v_and_b32 v55, 0xffff0000, v4
Vc 5,56,57
v_lshlrev_b32_e64 v56, 16, v5
v_and_b32 v57, 0xffff0000, v5
v_pk_mul_f32 v[50:51], v[50:51], v[36:37] op_sel:[0,1] op_sel_hi:[1,1]
v_pk_mul_f32 v[52:53], v[52:53], v[36:37] op_sel:[0,1] op_sel_hi:[1,1]
v_pk_mul_f32 v[54:55], v[54:55], v[36:37] op_sel:[0,1] op_sel_hi:[1,1]
v_pk_mul_f32 v[56:57], v[56:57], v[36:37] op_sel:[0,1] op_sel_hi:[1,1]
Vc 2,50,51
v_lshlrev_b32_e64 v50, 16, v2
v_and_b32 v51, 0xffff0000, v2
Vc 3,52,53
v_lshlrev_b32_e64 v52, 16, v3
v_and_b32 v53, 0xffff0000, v3
Vc 4,54,55
v_lshlrev_b32_e64 v54, 16, v4
v_and_b32 v55, 0xffff0000, v4
Vc 5,56,57
v_lshlrev_b32_e64 v56, 16, v5
v_and_b32 v57, 0xffff0000, v5
v_mul_f32 v2, 0xbfb8aa3b, v50
v_mul_f32 v3, 0xbfb8aa3b, v51
v_mul_f32 v4, 0xbfb8aa3b, v52
v_mul_f32 v5, 0xbfb8aa3b, v53
v_mul_f32 v6, 0xbfb8aa3b, v54
v_mul_f32 v7, 0xbfb8aa3b, v55
v_mul_f32 v8, 0xbfb8aa3b, v56
v_mul_f32 v9, 0xbfb8aa3b, v57
Ve 2,2
Ve 3,3
Ve 4,4
Ve 5,5
Ve 6,6
Ve 7,7
Ve 8,8
Ve 9,9
v_add_f32 v2, 1.0, v2
v_add_f32 v3, 1.0, v3
v_add_f32 v4, 1.0, v4
v_add_f32 v5, 1.0, v5
v_add_f32 v6, 1.0, v6
v_add_f32 v7, 1.0, v7
v_add_f32 v8, 1.0, v8
v_add_f32 v9, 1.0, v9
v_rcp_f32 v2, v2
v_rcp_f32 v3, v3
v_rcp_f32 v4, v4
v_rcp_f32 v5, v5
v_rcp_f32 v6, v6
v_rcp_f32 v7, v7
v_rcp_f32 v8, v8
v_rcp_f32 v9, v9
v_pk_mul_f32 v[50:51], v[50:51], v[2:3]
v_pk_mul_f32 v[52:53], v[52:53], v[4:5]
v_pk_mul_f32 v[54:55], v[54:55], v[6:7]
v_pk_mul_f32 v[56:57], v[56:57], v[8:9]
Vc 2,50,51
v_lshlrev_b32_e64 v50, 16, v2
v_and_b32 v51, 0xffff0000, v2
Vc 3,52,53
v_lshlrev_b32_e64 v52, 16, v3
v_and_b32 v53, 0xffff0000, v3
Vc 4,54,55
v_lshlrev_b32_e64 v54, 16, v4
v_and_b32 v55, 0xffff0000, v4
Vc 5,56,57
v_lshlrev_b32_e64 v56, 16, v5
v_and_b32 v57, 0xffff0000, v5
v_lshlrev_b32_e64 v58, 16, v26
v_and_b32 v59, 0xffff0000, v26
v_lshlrev_b32_e64 v60, 16, v27
v_and_b32 v61, 0xffff0000, v27
v_lshlrev_b32_e64 v62, 16, v28
v_and_b32 v63, 0xffff0000, v28
v_lshlrev_b32_e64 v64, 16, v29
v_and_b32 v65, 0xffff0000, v29
v_pk_add_f32 v[58:59], v[58:59], v[38:39] op_sel_hi:[1,0] neg_lo:[0,1] neg_hi:[0,1]
v_pk_add_f32 v[60:61], v[60:61], v[38:39] op_sel_hi:[1,0] neg_lo:[0,1] neg_hi:[0,1]
v_pk_add_f32 v[62:63], v[62:63], v[38:39] op_sel_hi:[1,0] neg_lo:[0,1] neg_hi:[0,1]
v_pk_add_f32 v[64:65], v[64:65], v[38:39] op_sel_hi:[1,0] neg_lo:[0,1] neg_hi:[0,1]
Vc 2,58,59
v_lshlrev_b32_e64 v58, 16, v2
v_and_b32 v59, 0xffff0000, v2
Vc 3,60,61
v_lshlrev_b32_e64 v60, 16, v3
v_and_b32 v61, 0xffff0000, v3
Vc 4,62,63
v_lshlrev_b32_e64 v62, 16, v4
v_and_b32 v63, 0xffff0000, v4
Vc 5,64,65
v_lshlrev_b32_e64 v64, 16, v5
v_and_b32 v65, 0xffff0000, v5
v_pk_mul_f32 v[58:59], v[58:59], v[38:39] op_sel:[0,1] op_sel_hi:[1,1]
v_pk_mul_f32 v[60:61], v[60:61], v[38:39] op_sel:[0,1] op_sel_hi:[1,1]
v_pk_mul_f32 v[62:63], v[62:63], v[38:39] op_sel:[0,1] op_sel_hi:[1,1]
v_pk_mul_f32 v[64:65], v[64:65], v[38:39] op_sel:[0,1] op_sel_hi:[1,1]
Vc 2,58,59
v_lshlrev_b32_e64 v58, 16, v2
v_and_b32 v59, 0xffff0000, v2
Vc 3,60,61
v_lshlrev_b32_e64 v60, 16, v3
v_and_b32 v61, 0xffff0000, v3
Vc 4,62,63
v_lshlrev_b32_e64 v62, 16, v4
v_and_b32 v63, 0xffff0000, v4
Vc 5,64,65
v_lshlrev_b32_e64 v64, 16, v5
v_and_b32 v65, 0xffff0000, v5
v_mul_f32 v2, 0xbfb8aa3b, v58
v_mul_f32 v3, 0xbfb8aa3b, v59
v_mul_f32 v4, 0xbfb8aa3b, v60
v_mul_f32 v5, 0xbfb8aa3b, v61
v_mul_f32 v6, 0xbfb8aa3b, v62
v_mul_f32 v7, 0xbfb8aa3b, v63
v_mul_f32 v8, 0xbfb8aa3b, v64
v_mul_f32 v9, 0xbfb8aa3b, v65
Ve 2,2
Ve 3,3
Ve 4,4
Ve 5,5
Ve 6,6
Ve 7,7
Ve 8,8
Ve 9,9
v_add_f32 v2, 1.0, v2
v_add_f32 v3, 1.0, v3
v_add_f32 v4, 1.0, v4
v_add_f32 v5, 1.0, v5
v_add_f32 v6, 1.0, v6
v_add_f32 v7, 1.0, v7
v_add_f32 v8, 1.0, v8
v_add_f32 v9, 1.0, v9
v_rcp_f32 v2, v2
v_rcp_f32 v3, v3
v_rcp_f32 v4, v4
v_rcp_f32 v5, v5
v_rcp_f32 v6, v6
v_rcp_f32 v7, v7
v_rcp_f32 v8, v8
v_rcp_f32 v9, v9
v_pk_mul_f32 v[58:59], v[58:59], v[2:3]
v_pk_mul_f32 v[60:61], v[60:61], v[4:5]
v_pk_mul_f32 v[62:63], v[62:63], v[6:7]
v_pk_mul_f32 v[64:65], v[64:65], v[8:9]
Vc 2,58,59
v_lshlrev_b32_e64 v58, 16, v2
v_and_b32 v59, 0xffff0000, v2
Vc 3,60,61
v_lshlrev_b32_e64 v60, 16, v3
v_and_b32 v61, 0xffff0000, v3
Vc 4,62,63
v_lshlrev_b32_e64 v62, 16, v4
v_and_b32 v63, 0xffff0000, v4
Vc 5,64,65
v_lshlrev_b32_e64 v64, 16, v5
v_and_b32 v65, 0xffff0000, v5
L_nogt:
buffer_load_dwordx4 a[48:51], v112, s[8:11], s52 offen offset:0 sc1
buffer_load_dwordx4 a[52:55], v112, s[8:11], s52 offen offset:1024 sc1
s_add_u32 s52, s52, 8192
buffer_load_dwordx4 a[56:59], v112, s[8:11], s52 offen offset:0 sc1
buffer_load_dwordx4 a[60:63], v112, s[8:11], s52 offen offset:1024 sc1
s_add_u32 s52, s52, 8192
s_add_u32 m0, s44, 32768
s_nop 0
buffer_load_dwordx4 v114, s[12:15], s48 offen offset:0 lds
buffer_load_dwordx4 v114, s[12:15], s49 offen offset:1024 lds
buffer_load_dwordx4 v114, s[12:15], s50 offen offset:2048 lds
buffer_load_dwordx4 v114, s[12:15], s51 offen offset:3072 lds
v_xor_b32 v114, 128, v114
s_cmp_lg_u32 s40, 0
s_cbranch_scc1 L_nowd
s_add_u32 m0, s35, 0
s_nop 0
s_nop 0
buffer_load_dwordx4 v125, s[60:63], s48 offen offset:0 lds
buffer_load_dwordx4 v125, s[60:63], s49 offen offset:1024 lds
buffer_load_dwordx4 v125, s[60:63], s50 offen offset:2048 lds
buffer_load_dwordx4 v125, s[60:63], s51 offen offset:3072 lds
v_add_u32 v125, 65536, v125
s_add_u32 m0, s35, 4096
s_nop 0
buffer_load_dwordx4 v125, s[60:63], s48 offen offset:0 lds
buffer_load_dwordx4 v125, s[60:63], s49 offen offset:1024 lds
buffer_load_dwordx4 v125, s[60:63], s50 offen offset:2048 lds
buffer_load_dwordx4 v125, s[60:63], s51 offen offset:3072 lds
L_nowd:
s_cmp_lt_u32 s2, 128
s_cbranch_scc1 L_noc3b
s_bfe_u32 s3, s2, 0x40003
s_lshl_b32 s3, s3, 2
s_add_u32 s3, s3, s32
s_lshl_b32 s3, s3, 15
s_and_b32 s7, s2, 1
s_lshl_b32 s7, s7, 22
s_add_u32 s3, s3, s7
s_add_u32 s3, s3, 384
v_and_b32 v1, 15, v0
v_lshlrev_b32 v1, 11, v1
v_lshrrev_b32_e64 v11, 5, v0
v_lshl_add_u32 v1, v11, 10, v1
buffer_load_dword v11, v1, s[28:31], s3 offen
L_noc3b:
s_barrier
s_nop 0
ds_read_b64_tr_b16 v[192:193], v115 offset:0
ds_read_b64_tr_b16 v[194:195], v115 offset:2048
ds_read_b64_tr_b16 v[196:197], v115 offset:4096
ds_read_b64_tr_b16 v[198:199], v115 offset:6144
ds_read_b64_tr_b16 v[200:201], v115 offset:8192
ds_read_b64_tr_b16 v[202:203], v115 offset:10240
ds_read_b64_tr_b16 v[204:205], v115 offset:12288
ds_read_b64_tr_b16 v[206:207], v115 offset:14336
ds_read_b64_tr_b16 v[208:209], v116 offset:0
ds_read_b64_tr_b16 v[210:211], v116 offset:2048
ds_read_b64_tr_b16 v[212:213], v116 offset:4096
ds_read_b64_tr_b16 v[214:215], v116 offset:6144
ds_read_b64_tr_b16 v[216:217], v116 offset:8192
ds_read_b64_tr_b16 v[218:219], v116 offset:10240
ds_read_b64_tr_b16 v[220:221], v116 offset:12288
s_waitcnt lgkmcnt(9)
ds_read_b64_tr_b16 v[222:223], v116 offset:14336
s_waitcnt vmcnt(12)
s_waitcnt lgkmcnt(8)
Zvva 160,192,0
ds_read_b64_tr_b16 v[224:225], v117 offset:0
ds_read_b64_tr_b16 v[226:227], v117 offset:2048
v_mov_b32 v125, 1
Mvva 160,196,8
s_sub_u32 s65, s65, s33
s_lshl_b32 s65, s65, 2
v_mul_lo_u32 v124, v0, s65
Mvva 160,200,16
s_add_u32 m0, s44, 49152
ds_read_b64_tr_b16 v[228:229], v117 offset:4096
ds_read_b64_tr_b16 v[230:231], v117 offset:6144
Mvva 160,204,24
buffer_load_dwordx4 v114, s[12:15], s48 offen offset:0 lds
Zvva 176,192,4
s_waitcnt lgkmcnt(4)
ds_read_b64_tr_b16 v[232:233], v117 offset:8192
ds_read_b64_tr_b16 v[234:235], v117 offset:10240
Mvva 176,196,12
s_lshl_b32 s6, s33, 2
v_add_u32_e64 v124, s6, v124
Mvva 176,200,20
ds_read_b64_tr_b16 v[236:237], v117 offset:12288
ds_read_b64_tr_b16 v[238:239], v117 offset:14336
Mvva 176,204,28
buffer_load_dwordx4 v114, s[12:15], s49 offen offset:1024 lds
Zvva 164,208,0
ds_read_b64_tr_b16 v[240:241], v118 offset:0
ds_read_b64_tr_b16 v[242:243], v118 offset:2048
Mvva 164,212,8
s_mov_b32 s6, 5447680
s_cmp_eq_u32 s32, 0
s_cselect_b32 s6, s6, s64
s_cmp_ge_u32 s34, 1
s_cselect_b32 s6, s6, 2146435072
Mvva 164,216,16
s_waitcnt lgkmcnt(2)
ds_read_b64_tr_b16 v[244:245], v118 offset:4096
ds_read_b64_tr_b16 v[246:247], v118 offset:6144
Mvva 164,220,24
buffer_load_dwordx4 v114, s[12:15], s50 offen offset:2048 lds
Zvva 180,208,4
ds_read_b64_tr_b16 v[248:249], v118 offset:8192
ds_read_b64_tr_b16 v[250:251], v118 offset:10240
Mvva 180,212,12
s_mov_b64 exec, 3
buffer_store_dword v125, v124, s[20:23], s6 offen sc1
s_mov_b64 exec, -1
Mvva 180,216,20
s_barrier
ds_read_b64_tr_b16 v[252:253], v118 offset:12288
ds_read_b64_tr_b16 v[254:255], v118 offset:14336
Mvva 180,220,28
buffer_load_dwordx4 v114, s[12:15], s51 offen offset:3072 lds
v_xor_b32 v114, 128, v114
v_add_u32 v114, 262144, v114
Zvva 168,224,0
ds_read_b64_tr_b16 v[192:193], v115 offset:16384
ds_read_b64_tr_b16 v[194:195], v115 offset:18432
Mvva 168,228,8
s_lshl_b32 s40, s45, 2
s_add_u32 s40, s40, s32
s_lshr_b32 s3, s42, 5
s_lshr_b32 s47, s43, 5
s_cmp_eq_u32 s3, s40
s_cselect_b32 s53, 1, 0
s_cmp_eq_u32 s47, s40
s_cselect_b32 s53, 1, s53
s_mov_b32 s40, 0
Mvva 168,232,16
ds_read_b64_tr_b16 v[196:197], v115 offset:20480
ds_read_b64_tr_b16 v[198:199], v115 offset:22528
Mvva 168,236,24
buffer_load_dwordx4 a[64:67], v112, s[8:11], s52 offen offset:0 sc1
Zvva 184,224,4
s_waitcnt lgkmcnt(4)
ds_read_b64_tr_b16 v[200:201], v115 offset:24576
ds_read_b64_tr_b16 v[202:203], v115 offset:26624
Mvva 184,228,12
s_lshl_b32 s41, s46, 7
s_add_u32 s41, s41, 5449728
s_lshl_b32 s55, s46, 13
Mvva 184,232,20
ds_read_b64_tr_b16 v[204:205], v115 offset:28672
ds_read_b64_tr_b16 v[206:207], v115 offset:30720
Mvva 184,236,28
buffer_load_dwordx4 a[68:71], v112, s[8:11], s52 offen offset:1024 sc1
s_add_u32 s52, s52, 8192
Zvva 172,240,0
ds_read_b64_tr_b16 v[208:209], v116 offset:16384
ds_read_b64_tr_b16 v[210:211], v116 offset:18432
Mvva 172,244,8
s_add_u32 s55, s55, 5308416
s_add_u32 s16, s66, 88080384
s_addc_u32 s17, s67, 0
s_and_b32 s17, s17, 0xffff
Mvva 172,248,16
ds_read_b64_tr_b16 v[212:213], v116 offset:20480
ds_read_b64_tr_b16 v[214:215], v116 offset:22528
Mvva 172,252,24
buffer_load_dwordx4 a[72:75], v112, s[8:11], s52 offen offset:0 sc1
Zvva 188,240,4
s_waitcnt lgkmcnt(4)
ds_read_b64_tr_b16 v[216:217], v116 offset:24576
ds_read_b64_tr_b16 v[218:219], v116 offset:26624
Mvva 188,244,12
s_mov_b32 s18, 8388608
s_mov_b32 s19, 0x20000
s_lshl_b32 s24, s2, 2
Mvva 188,248,20
ds_read_b64_tr_b16 v[220:221], v116 offset:28672
ds_read_b64_tr_b16 v[222:223], v116 offset:30720
Mvva 188,252,28
buffer_load_dwordx4 a[76:79], v112, s[8:11], s52 offen offset:1024 sc1
s_add_u32 s52, s52, 8192
Zvva 128,192,0
ds_read_b64_tr_b16 v[224:225], v117 offset:16384
ds_read_b64_tr_b16 v[226:227], v117 offset:18432
Mvva 128,196,8
s_add_u32 s24, s24, s32
s_lshl_b32 s25, s24, 13
s_xor_b32 s26, s25, 32768
Mvva 128,200,16
s_add_u32 m0, s44, 65536
ds_read_b64_tr_b16 v[228:229], v117 offset:20480
ds_read_b64_tr_b16 v[230:231], v117 offset:22528
Mvva 128,204,24
buffer_load_dwordx4 v114, s[12:15], s48 offen offset:0 lds
Zvva 144,192,4
s_waitcnt lgkmcnt(4)
ds_read_b64_tr_b16 v[232:233], v117 offset:24576
ds_read_b64_tr_b16 v[234:235], v117 offset:26624
Mvva 144,196,12
s_lshl_b32 s24, s24, 2
s_xor_b32 s27, s24, 16
s_add_u32 s24, s24, 5452800
Mvva 144,200,20
ds_read_b64_tr_b16 v[236:237], v117 offset:28672
ds_read_b64_tr_b16 v[238:239], v117 offset:30720
Mvva 144,204,28
buffer_load_dwordx4 v114, s[12:15], s49 offen offset:1024 lds
Zvva 132,208,0
ds_read_b64_tr_b16 v[240:241], v118 offset:16384
ds_read_b64_tr_b16 v[242:243], v118 offset:18432
Mvva 132,212,8
s_add_u32 s27, s27, 5452800
v_add_u32 v106, s35, v115
v_add_u32 v107, s35, v116
v_add_u32 v108, s35, v117
Mvva 132,216,16
s_waitcnt lgkmcnt(2)
ds_read_b64_tr_b16 v[244:245], v118 offset:20480
ds_read_b64_tr_b16 v[246:247], v118 offset:22528
v_add_u32 v109, s35, v118
Mvva 132,220,24
buffer_load_dwordx4 v114, s[12:15], s50 offen offset:2048 lds
Zvva 148,208,4
s_waitcnt vmcnt(12)
ds_read_b64_tr_b16 v[248:249], v118 offset:24576
ds_read_b64_tr_b16 v[250:251], v118 offset:26624
v_and_b32 v2, 1, v121
Mvva 148,212,12
v_lshlrev_b32 v2, 8, v2
v_and_b32 v3, 15, v0
v_lshl_add_u32 v2, v3, 3, v2
Mvva 148,216,20
s_barrier
ds_read_b64_tr_b16 v[252:253], v118 offset:28672
ds_read_b64_tr_b16 v[254:255], v118 offset:30720
v_add_u32 v2, s35, v2
Mvva 148,220,28
buffer_load_dwordx4 v114, s[12:15], s51 offen offset:3072 lds
v_xor_b32 v114, 128, v114
Zvva 136,224,0
ds_read_b64_tr_b16 v[192:193], v115 offset:32768
ds_read_b64_tr_b16 v[194:195], v115 offset:34816
v_and_b32_e64 v4, 1, v0
Mvva 136,228,8
v_lshlrev_b32 v4, 8, v4
v_add_u32 v4, s35, v4
v_lshl_add_u32 v3, v121, 3, v4
Mvva 136,232,16
ds_read_b64_tr_b16 v[196:197], v115 offset:36864
ds_read_b64_tr_b16 v[198:199], v115 offset:38912
v_lshl_add_u32 v4, v121, 4, v4
Mvva 136,236,24
buffer_load_dwordx4 a[80:83], v112, s[8:11], s52 offen offset:0 sc1
Zvva 152,224,4
s_waitcnt lgkmcnt(4)
ds_read_b64_tr_b16 v[200:201], v115 offset:40960
ds_read_b64_tr_b16 v[202:203], v115 offset:43008
v_lshlrev_b32 v5, 3, v0
Mvva 152,228,12
v_add_u32 v6, 133120, v5
v_mov_b32_e64 v7, 1
Mvva 152,232,20
ds_read_b64_tr_b16 v[204:205], v115 offset:45056
ds_read_b64_tr_b16 v[206:207], v115 offset:47104
Mvva 152,236,28
buffer_load_dwordx4 a[84:87], v112, s[8:11], s52 offen offset:1024 sc1
s_add_u32 s52, s52, 8192
Zvva 140,240,0
ds_read_b64_tr_b16 v[208:209], v116 offset:32768
ds_read_b64_tr_b16 v[210:211], v116 offset:34816
Mvva 140,244,8
s_lshl_b32 s4, s39, 4
s_add_u32 s4, s4, s37
s_lshl_b32 s4, s4, 9
Mvva 140,248,16
ds_read_b64_tr_b16 v[212:213], v116 offset:36864
ds_read_b64_tr_b16 v[214:215], v116 offset:38912
Mvva 140,252,24
buffer_load_dwordx4 a[88:91], v112, s[8:11], s52 offen offset:0 sc1
Zvva 156,240,4
s_waitcnt lgkmcnt(4)
ds_read_b64_tr_b16 v[216:217], v116 offset:40960
ds_read_b64_tr_b16 v[218:219], v116 offset:43008
Mvva 156,244,12
s_add_u32 s4, s4, 5308416
s_lshl_b32 s6, s39, 5
s_add_u32 s6, s6, s37
Mvva 156,248,20
ds_read_b64_tr_b16 v[220:221], v116 offset:45056
ds_read_b64_tr_b16 v[222:223], v116 offset:47104
Mvva 156,252,28
buffer_load_dwordx4 a[92:95], v112, s[8:11], s52 offen offset:1024 sc1
s_add_u32 s52, s52, 8192
Mvva 160,192,32
ds_read_b64_tr_b16 v[224:225], v117 offset:32768
ds_read_b64_tr_b16 v[226:227], v117 offset:34816
Mvva 160,196,40
s_lshl_b32 s6, s6, 2
s_add_u32 s6, s6, 5449728
s_cmp_eq_u32 s32, 0
s_cselect_b32 s4, s4, s64
s_cselect_b32 s6, s6, s64
Mvva 160,200,48
s_add_u32 m0, s44, 81920
ds_read_b64_tr_b16 v[228:229], v117 offset:36864
ds_read_b64_tr_b16 v[230:231], v117 offset:38912
Mvva 160,204,56
buffer_load_dwordx4 v114, s[12:15], s48 offen offset:0 lds
Mvva 176,192,36
s_waitcnt lgkmcnt(4)
ds_read_b64_tr_b16 v[232:233], v117 offset:40960
ds_read_b64_tr_b16 v[234:235], v117 offset:43008
Mvva 176,196,44
s_cmp_lt_u32 s93, 224
s_cselect_b32 s4, s4, 2146435072
s_cselect_b32 s6, s6, 2146435072
Mvva 176,200,52
ds_read_b64_tr_b16 v[236:237], v117 offset:45056
ds_read_b64_tr_b16 v[238:239], v117 offset:47104
Mvva 176,204,60
buffer_load_dwordx4 v114, s[12:15], s49 offen offset:1024 lds
Mvva 164,208,32
ds_read_b64_tr_b16 v[240:241], v118 offset:32768
ds_read_b64_tr_b16 v[242:243], v118 offset:34816
Mvva 164,212,40
Mvva 164,216,48
s_waitcnt lgkmcnt(2)
ds_read_b64_tr_b16 v[244:245], v118 offset:36864
ds_read_b64_tr_b16 v[246:247], v118 offset:38912
Mvva 164,220,56
buffer_load_dwordx4 v114, s[12:15], s50 offen offset:2048 lds
Mvva 180,208,36
s_waitcnt vmcnt(15)
ds_read_b64_tr_b16 v[248:249], v118 offset:40960
ds_read_b64_tr_b16 v[250:251], v118 offset:43008
Mvva 180,212,44
Mvva 180,216,52
s_barrier
ds_read_b64_tr_b16 v[252:253], v118 offset:45056
ds_read_b64_tr_b16 v[254:255], v118 offset:47104
Mvva 180,220,60
buffer_load_dwordx4 v114, s[12:15], s51 offen offset:3072 lds
v_xor_b32 v114, 128, v114
v_add_u32 v114, 262144, v114
Mvva 168,224,32
ds_read_b64_tr_b16 v[192:193], v115 offset:49152
ds_read_b64_tr_b16 v[194:195], v115 offset:51200
Mvva 168,228,40
Mvva 168,232,48
ds_read_b64_tr_b16 v[196:197], v115 offset:53248
ds_read_b64_tr_b16 v[198:199], v115 offset:55296
Mvva 168,236,56
buffer_load_dwordx4 a[96:99], v112, s[8:11], s52 offen offset:0 sc1
Mvva 184,224,36
s_waitcnt lgkmcnt(4)
ds_read_b64_tr_b16 v[200:201], v115 offset:57344
ds_read_b64_tr_b16 v[202:203], v115 offset:59392
Mvva 184,228,44
Mvva 184,232,52
ds_read_b64_tr_b16 v[204:205], v115 offset:61440
ds_read_b64_tr_b16 v[206:207], v115 offset:63488
Mvva 184,236,60
buffer_load_dwordx4 a[100:103], v112, s[8:11], s52 offen offset:1024 sc1
s_add_u32 s52, s52, 8192
Mvva 172,240,32
ds_read_b64_tr_b16 v[208:209], v116 offset:49152
ds_read_b64_tr_b16 v[210:211], v116 offset:51200
Mvva 172,244,40
Mvva 172,248,48
ds_read_b64_tr_b16 v[212:213], v116 offset:53248
ds_read_b64_tr_b16 v[214:215], v116 offset:55296
Mvva 172,252,56
buffer_load_dwordx4 a[104:107], v112, s[8:11], s52 offen offset:0 sc1
Mvva 188,240,36
s_waitcnt lgkmcnt(4)
ds_read_b64_tr_b16 v[216:217], v116 offset:57344
ds_read_b64_tr_b16 v[218:219], v116 offset:59392
Mvva 188,244,44
Mvva 188,248,52
ds_read_b64_tr_b16 v[220:221], v116 offset:61440
ds_read_b64_tr_b16 v[222:223], v116 offset:63488
Mvva 188,252,60
buffer_load_dwordx4 a[108:111], v112, s[8:11], s52 offen offset:1024 sc1
s_add_u32 s52, s52, 8192
Mvva 128,192,32
ds_read_b64_tr_b16 v[224:225], v117 offset:49152
ds_read_b64_tr_b16 v[226:227], v117 offset:51200
Mvva 128,196,40
Mvva 128,200,48
s_add_u32 m0, s44, 98304
ds_read_b64_tr_b16 v[228:229], v117 offset:53248
ds_read_b64_tr_b16 v[230:231], v117 offset:55296
Mvva 128,204,56
buffer_load_dwordx4 v114, s[12:15], s48 offen offset:0 lds
Mvva 144,192,36
s_waitcnt lgkmcnt(4)
ds_read_b64_tr_b16 v[232:233], v117 offset:57344
ds_read_b64_tr_b16 v[234:235], v117 offset:59392
Mvva 144,196,44
Mvva 144,200,52
ds_read_b64_tr_b16 v[236:237], v117 offset:61440
ds_read_b64_tr_b16 v[238:239], v117 offset:63488
Mvva 144,204,60
buffer_load_dwordx4 v114, s[12:15], s49 offen offset:1024 lds
Mvva 132,208,32
ds_read_b64_tr_b16 v[240:241], v118 offset:49152
ds_read_b64_tr_b16 v[242:243], v118 offset:51200
Mvva 132,212,40
Mvva 132,216,48
s_waitcnt lgkmcnt(2)
ds_read_b64_tr_b16 v[244:245], v118 offset:53248
ds_read_b64_tr_b16 v[246:247], v118 offset:55296
Mvva 132,220,56
buffer_load_dwordx4 v114, s[12:15], s50 offen offset:2048 lds
Mvva 148,208,36
s_waitcnt vmcnt(15)
ds_read_b64_tr_b16 v[248:249], v118 offset:57344
ds_read_b64_tr_b16 v[250:251], v118 offset:59392
Mvva 148,212,44
Mvva 148,216,52
s_barrier
ds_read_b64_tr_b16 v[252:253], v118 offset:61440
ds_read_b64_tr_b16 v[254:255], v118 offset:63488
Mvva 148,220,60
buffer_load_dwordx4 v114, s[12:15], s51 offen offset:3072 lds
v_xor_b32 v114, 128, v114
Mvva 136,224,32
ds_read_b64_tr_b16 v[192:193], v12 offset:0
ds_read_b64_tr_b16 v[194:195], v12 offset:2048
Mvva 136,228,40
Mvva 136,232,48
ds_read_b64_tr_b16 v[196:197], v12 offset:4096
ds_read_b64_tr_b16 v[198:199], v12 offset:6144
Mvva 136,236,56
buffer_load_dwordx4 a[112:115], v112, s[8:11], s52 offen offset:0 sc1
Mvva 152,224,36
s_waitcnt lgkmcnt(4)
ds_read_b64_tr_b16 v[200:201], v12 offset:8192
ds_read_b64_tr_b16 v[202:203], v12 offset:10240
Mvva 152,228,44
Mvva 152,232,52
ds_read_b64_tr_b16 v[204:205], v12 offset:12288
ds_read_b64_tr_b16 v[206:207], v12 offset:14336
Mvva 152,236,60
buffer_load_dwordx4 a[116:119], v112, s[8:11], s52 offen offset:1024 sc1
s_add_u32 s52, s52, 8192
Mvva 140,240,32
ds_read_b64_tr_b16 v[208:209], v13 offset:0
ds_read_b64_tr_b16 v[210:211], v13 offset:2048
Mvva 140,244,40
Mvva 140,248,48
ds_read_b64_tr_b16 v[212:213], v13 offset:4096
ds_read_b64_tr_b16 v[214:215], v13 offset:6144
Mvva 140,252,56
buffer_load_dwordx4 a[120:123], v112, s[8:11], s52 offen offset:0 sc1
Mvva 156,240,36
s_waitcnt lgkmcnt(4)
ds_read_b64_tr_b16 v[216:217], v13 offset:8192
ds_read_b64_tr_b16 v[218:219], v13 offset:10240
Mvva 156,244,44
Mvva 156,248,52
s_waitcnt vmcnt(15)
ds_read_b64_tr_b16 v[220:221], v13 offset:12288
ds_read_b64_tr_b16 v[222:223], v13 offset:14336
Mvva 156,252,60
buffer_load_dwordx4 a[124:127], v112, s[8:11], s52 offen offset:1024 sc1
s_add_u32 s52, s52, 8192
Mvva 160,192,64
ds_read_b64_tr_b16 v[224:225], v14 offset:0
ds_read_b64_tr_b16 v[226:227], v14 offset:2048
Mvva 160,196,72
Mvva 160,200,80
s_add_u32 m0, s44, 114688
ds_read_b64_tr_b16 v[228:229], v14 offset:4096
ds_read_b64_tr_b16 v[230:231], v14 offset:6144
Mvva 160,204,88
buffer_load_dwordx4 v114, s[12:15], s48 offen offset:0 lds
Mvva 176,192,68
s_waitcnt lgkmcnt(4)
ds_read_b64_tr_b16 v[232:233], v14 offset:8192
ds_read_b64_tr_b16 v[234:235], v14 offset:10240
Mvva 176,196,76
Mvva 176,200,84
ds_read_b64_tr_b16 v[236:237], v14 offset:12288
ds_read_b64_tr_b16 v[238:239], v14 offset:14336
Mvva 176,204,92
buffer_load_dwordx4 v114, s[12:15], s49 offen offset:1024 lds
Mvva 164,208,64
ds_read_b64_tr_b16 v[240:241], v15 offset:0
ds_read_b64_tr_b16 v[242:243], v15 offset:2048
Mvva 164,212,72
Mvva 164,216,80
s_waitcnt lgkmcnt(2)
ds_read_b64_tr_b16 v[244:245], v15 offset:4096
ds_read_b64_tr_b16 v[246:247], v15 offset:6144
Mvva 164,220,88
buffer_load_dwordx4 v114, s[12:15], s50 offen offset:2048 lds
Mvva 180,208,68
s_waitcnt vmcnt(15)
ds_read_b64_tr_b16 v[248:249], v15 offset:8192
ds_read_b64_tr_b16 v[250:251], v15 offset:10240
Mvva 180,212,76
Mvva 180,216,84
s_barrier
ds_read_b64_tr_b16 v[252:253], v15 offset:12288
ds_read_b64_tr_b16 v[254:255], v15 offset:14336
Mvva 180,220,92
buffer_load_dwordx4 v114, s[12:15], s51 offen offset:3072 lds
v_xor_b32 v114, 128, v114
v_add_u32 v114, 262144, v114
Mvva 168,224,64
ds_read_b64_tr_b16 v[192:193], v12 offset:16384
ds_read_b64_tr_b16 v[194:195], v12 offset:18432
Mvva 168,228,72
Mvva 168,232,80
ds_read_b64_tr_b16 v[196:197], v12 offset:20480
ds_read_b64_tr_b16 v[198:199], v12 offset:22528
Mvva 168,236,88
buffer_load_dwordx4 a[128:131], v112, s[8:11], s52 offen offset:0 sc1
Mvva 184,224,68
s_waitcnt lgkmcnt(4)
ds_read_b64_tr_b16 v[200:201], v12 offset:24576
ds_read_b64_tr_b16 v[202:203], v12 offset:26624
Mvva 184,228,76
Mvva 184,232,84
ds_read_b64_tr_b16 v[204:205], v12 offset:28672
ds_read_b64_tr_b16 v[206:207], v12 offset:30720
Mvva 184,236,92
buffer_load_dwordx4 a[132:135], v112, s[8:11], s52 offen offset:1024 sc1
s_add_u32 s52, s52, 8192
Mvva 172,240,64
ds_read_b64_tr_b16 v[208:209], v13 offset:16384
ds_read_b64_tr_b16 v[210:211], v13 offset:18432
Mvva 172,244,72
Mvva 172,248,80
ds_read_b64_tr_b16 v[212:213], v13 offset:20480
ds_read_b64_tr_b16 v[214:215], v13 offset:22528
Mvva 172,252,88
buffer_load_dwordx4 a[136:139], v112, s[8:11], s52 offen offset:0 sc1
Mvva 188,240,68
s_waitcnt lgkmcnt(4)
ds_read_b64_tr_b16 v[216:217], v13 offset:24576
ds_read_b64_tr_b16 v[218:219], v13 offset:26624
Mvva 188,244,76
Mvva 188,248,84
ds_read_b64_tr_b16 v[220:221], v13 offset:28672
ds_read_b64_tr_b16 v[222:223], v13 offset:30720
Mvva 188,252,92
buffer_load_dwordx4 a[140:143], v112, s[8:11], s52 offen offset:1024 sc1
s_add_u32 s52, s52, 8192
Mvva 128,192,64
ds_read_b64_tr_b16 v[224:225], v14 offset:16384
ds_read_b64_tr_b16 v[226:227], v14 offset:18432
Mvva 128,196,72
s_cmp_lt_u32 s93, 224
s_cbranch_scc1 L_f2A
L_f2Ar:
Mvva 128,200,80
s_add_u32 m0, s44, 0
ds_read_b64_tr_b16 v[228:229], v14 offset:20480
ds_read_b64_tr_b16 v[230:231], v14 offset:22528
Mvva 128,204,88
buffer_load_dwordx4 v114, s[12:15], s48 offen offset:0 lds
Mvva 144,192,68
s_waitcnt lgkmcnt(4)
ds_read_b64_tr_b16 v[232:233], v14 offset:24576
ds_read_b64_tr_b16 v[234:235], v14 offset:26624
Mvva 144,196,76
Mvva 144,200,84
ds_read_b64_tr_b16 v[236:237], v14 offset:28672
ds_read_b64_tr_b16 v[238:239], v14 offset:30720
Mvva 144,204,92
buffer_load_dwordx4 v114, s[12:15], s49 offen offset:1024 lds
Mvva 132,208,64
ds_read_b64_tr_b16 v[240:241], v15 offset:16384
ds_read_b64_tr_b16 v[242:243], v15 offset:18432
Mvva 132,212,72
Mvva 132,216,80
s_waitcnt lgkmcnt(2)
ds_read_b64_tr_b16 v[244:245], v15 offset:20480
ds_read_b64_tr_b16 v[246:247], v15 offset:22528
Mvva 132,220,88
buffer_load_dwordx4 v114, s[12:15], s50 offen offset:2048 lds
Mvva 148,208,68
s_waitcnt vmcnt(15)
ds_read_b64_tr_b16 v[248:249], v15 offset:24576
ds_read_b64_tr_b16 v[250:251], v15 offset:26624
Mvva 148,212,76
Mvva 148,216,84
s_barrier
ds_read_b64_tr_b16 v[252:253], v15 offset:28672
ds_read_b64_tr_b16 v[254:255], v15 offset:30720
Mvva 148,220,92
buffer_load_dwordx4 v114, s[12:15], s51 offen offset:3072 lds
v_xor_b32 v114, 128, v114
Mvva 136,224,64
ds_read_b64_tr_b16 v[192:193], v12 offset:32768
ds_read_b64_tr_b16 v[194:195], v12 offset:34816
Mvva 136,228,72
Mvva 136,232,80
ds_read_b64_tr_b16 v[196:197], v12 offset:36864
ds_read_b64_tr_b16 v[198:199], v12 offset:38912
Mvva 136,236,88
buffer_load_dwordx4 a[144:147], v112, s[8:11], s52 offen offset:0 sc1
Mvva 152,224,68
s_waitcnt lgkmcnt(4)
ds_read_b64_tr_b16 v[200:201], v12 offset:40960
ds_read_b64_tr_b16 v[202:203], v12 offset:43008
Mvva 152,228,76
Mvva 152,232,84
ds_read_b64_tr_b16 v[204:205], v12 offset:45056
ds_read_b64_tr_b16 v[206:207], v12 offset:47104
Mvva 152,236,92
buffer_load_dwordx4 a[148:151], v112, s[8:11], s52 offen offset:1024 sc1
s_add_u32 s52, s52, 8192
Mvva 140,240,64
ds_read_b64_tr_b16 v[208:209], v13 offset:32768
ds_read_b64_tr_b16 v[210:211], v13 offset:34816
Mvva 140,244,72
Mvva 140,248,80
ds_read_b64_tr_b16 v[212:213], v13 offset:36864
ds_read_b64_tr_b16 v[214:215], v13 offset:38912
Mvva 140,252,88
buffer_load_dwordx4 a[152:155], v112, s[8:11], s52 offen offset:0 sc1
Mvva 156,240,68
s_waitcnt lgkmcnt(4)
ds_read_b64_tr_b16 v[216:217], v13 offset:40960
ds_read_b64_tr_b16 v[218:219], v13 offset:43008
Mvva 156,244,76
Mvva 156,248,84
s_waitcnt vmcnt(15)
ds_read_b64_tr_b16 v[220:221], v13 offset:45056
ds_read_b64_tr_b16 v[222:223], v13 offset:47104
Mvva 156,252,92
buffer_load_dwordx4 a[156:159], v112, s[8:11], s52 offen offset:1024 sc1
s_add_u32 s52, s52, 8192
Mvva 160,192,96
ds_read_b64_tr_b16 v[224:225], v14 offset:32768
ds_read_b64_tr_b16 v[226:227], v14 offset:34816
Mvva 160,196,104
Mvva 160,200,112
s_add_u32 m0, s44, 16384
ds_read_b64_tr_b16 v[228:229], v14 offset:36864
ds_read_b64_tr_b16 v[230:231], v14 offset:38912
Mvva 160,204,120
buffer_load_dwordx4 v114, s[12:15], s48 offen offset:0 lds
Mvva 176,192,100
s_waitcnt lgkmcnt(4)
ds_read_b64_tr_b16 v[232:233], v14 offset:40960
ds_read_b64_tr_b16 v[234:235], v14 offset:43008
Mvva 176,196,108
Mvva 176,200,116
ds_read_b64_tr_b16 v[236:237], v14 offset:45056
ds_read_b64_tr_b16 v[238:239], v14 offset:47104
Mvva 176,204,124
buffer_load_dwordx4 v114, s[12:15], s49 offen offset:1024 lds
Mvva 164,208,96
ds_read_b64_tr_b16 v[240:241], v15 offset:32768
ds_read_b64_tr_b16 v[242:243], v15 offset:34816
Mvva 164,212,104
Mvva 164,216,112
s_waitcnt lgkmcnt(2)
ds_read_b64_tr_b16 v[244:245], v15 offset:36864
ds_read_b64_tr_b16 v[246:247], v15 offset:38912
Mvva 164,220,120
buffer_load_dwordx4 v114, s[12:15], s50 offen offset:2048 lds
Mvva 180,208,100
s_waitcnt vmcnt(15)
ds_read_b64_tr_b16 v[248:249], v15 offset:40960
ds_read_b64_tr_b16 v[250:251], v15 offset:43008
Mvva 180,212,108
Mvva 180,216,116
s_barrier
ds_read_b64_tr_b16 v[252:253], v15 offset:45056
ds_read_b64_tr_b16 v[254:255], v15 offset:47104
Mvva 180,220,124
buffer_load_dwordx4 v114, s[12:15], s51 offen offset:3072 lds
v_xor_b32 v114, 128, v114
v_add_u32 v114, 262144, v114
Mvva 168,224,96
ds_read_b64_tr_b16 v[192:193], v12 offset:49152
ds_read_b64_tr_b16 v[194:195], v12 offset:51200
Mvva 168,228,104
Mvva 168,232,112
ds_read_b64_tr_b16 v[196:197], v12 offset:53248
ds_read_b64_tr_b16 v[198:199], v12 offset:55296
Mvva 168,236,120
buffer_load_dwordx4 a[160:163], v112, s[8:11], s52 offen offset:0 sc1
Mvva 184,224,100
s_waitcnt lgkmcnt(4)
ds_read_b64_tr_b16 v[200:201], v12 offset:57344
ds_read_b64_tr_b16 v[202:203], v12 offset:59392
Mvva 184,228,108
Mvva 184,232,116
ds_read_b64_tr_b16 v[204:205], v12 offset:61440
ds_read_b64_tr_b16 v[206:207], v12 offset:63488
Mvva 184,236,124
buffer_load_dwordx4 a[164:167], v112, s[8:11], s52 offen offset:1024 sc1
s_add_u32 s52, s52, 8192
Mvva 172,240,96
ds_read_b64_tr_b16 v[208:209], v13 offset:49152
ds_read_b64_tr_b16 v[210:211], v13 offset:51200
Mvva 172,244,104
Mvva 172,248,112
ds_read_b64_tr_b16 v[212:213], v13 offset:53248
ds_read_b64_tr_b16 v[214:215], v13 offset:55296
Mvva 172,252,120
buffer_load_dwordx4 a[168:171], v112, s[8:11], s52 offen offset:0 sc1
Mvva 188,240,100
s_waitcnt lgkmcnt(4)
ds_read_b64_tr_b16 v[216:217], v13 offset:57344
ds_read_b64_tr_b16 v[218:219], v13 offset:59392
Mvva 188,244,108
Mvva 188,248,116
ds_read_b64_tr_b16 v[220:221], v13 offset:61440
ds_read_b64_tr_b16 v[222:223], v13 offset:63488
Mvva 188,252,124
buffer_load_dwordx4 a[172:175], v112, s[8:11], s52 offen offset:1024 sc1
s_add_u32 s52, s52, 8192
Mvva 128,192,96
ds_read_b64_tr_b16 v[224:225], v14 offset:49152
ds_read_b64_tr_b16 v[226:227], v14 offset:51200
Mvva 128,196,104
Mvva 128,200,112
s_add_u32 m0, s44, 32768
ds_read_b64_tr_b16 v[228:229], v14 offset:53248
ds_read_b64_tr_b16 v[230:231], v14 offset:55296
Mvva 128,204,120
buffer_load_dwordx4 v114, s[12:15], s48 offen offset:0 lds
Mvva 144,192,100
s_waitcnt lgkmcnt(4)
ds_read_b64_tr_b16 v[232:233], v14 offset:57344
ds_read_b64_tr_b16 v[234:235], v14 offset:59392
Mvva 144,196,108
Mvva 144,200,116
ds_read_b64_tr_b16 v[236:237], v14 offset:61440
ds_read_b64_tr_b16 v[238:239], v14 offset:63488
Mvva 144,204,124
buffer_load_dwordx4 v114, s[12:15], s49 offen offset:1024 lds
Mvva 132,208,96
ds_read_b64_tr_b16 v[240:241], v15 offset:49152
ds_read_b64_tr_b16 v[242:243], v15 offset:51200
Mvva 132,212,104
Mvva 132,216,112
s_waitcnt lgkmcnt(2)
ds_read_b64_tr_b16 v[244:245], v15 offset:53248
ds_read_b64_tr_b16 v[246:247], v15 offset:55296
Mvva 132,220,120
buffer_load_dwordx4 v114, s[12:15], s50 offen offset:2048 lds
Mvva 148,208,100
s_waitcnt vmcnt(15)
ds_read_b64_tr_b16 v[248:249], v15 offset:57344
ds_read_b64_tr_b16 v[250:251], v15 offset:59392
Mvva 148,212,108
s_cmp_lt_u32 s93, 224
s_cbranch_scc1 L_f2B
L_f2Br:
Mvva 148,216,116
s_barrier
ds_read_b64_tr_b16 v[252:253], v15 offset:61440
ds_read_b64_tr_b16 v[254:255], v15 offset:63488
Mvva 148,220,124
buffer_load_dwordx4 v114, s[12:15], s51 offen offset:3072 lds
v_xor_b32 v114, 128, v114
Mvva 136,224,96
ds_read_b64_tr_b16 v[192:193], v115 offset:0
ds_read_b64_tr_b16 v[194:195], v115 offset:2048
Mvva 136,228,104
Mvva 136,232,112
ds_read_b64_tr_b16 v[196:197], v115 offset:4096
ds_read_b64_tr_b16 v[198:199], v115 offset:6144
Mvva 136,236,120
buffer_load_dwordx4 a[176:179], v112, s[8:11], s52 offen offset:0 sc1
Mvva 152,224,100
s_waitcnt lgkmcnt(4)
ds_read_b64_tr_b16 v[200:201], v115 offset:8192
ds_read_b64_tr_b16 v[202:203], v115 offset:10240
Mvva 152,228,108
Mvva 152,232,116
ds_read_b64_tr_b16 v[204:205], v115 offset:12288
ds_read_b64_tr_b16 v[206:207], v115 offset:14336
Mvva 152,236,124
buffer_load_dwordx4 a[180:183], v112, s[8:11], s52 offen offset:1024 sc1
s_add_u32 s52, s52, 8192
Mvva 140,240,96
ds_read_b64_tr_b16 v[208:209], v116 offset:0
ds_read_b64_tr_b16 v[210:211], v116 offset:2048
Mvva 140,244,104
Mvva 140,248,112
ds_read_b64_tr_b16 v[212:213], v116 offset:4096
ds_read_b64_tr_b16 v[214:215], v116 offset:6144
Mvva 140,252,120
buffer_load_dwordx4 a[184:187], v112, s[8:11], s52 offen offset:0 sc1
Mvva 156,240,100
s_waitcnt lgkmcnt(4)
ds_read_b64_tr_b16 v[216:217], v116 offset:8192
ds_read_b64_tr_b16 v[218:219], v116 offset:10240
Mvva 156,244,108
Mvva 156,248,116
s_waitcnt vmcnt(15)
ds_read_b64_tr_b16 v[220:221], v116 offset:12288
ds_read_b64_tr_b16 v[222:223], v116 offset:14336
Mvva 156,252,124
buffer_load_dwordx4 a[188:191], v112, s[8:11], s52 offen offset:1024 sc1
s_add_u32 s52, s52, 8192
Mvva 160,192,128
ds_read_b64_tr_b16 v[224:225], v117 offset:0
ds_read_b64_tr_b16 v[226:227], v117 offset:2048
Mvva 160,196,136
Mvva 160,200,144
s_add_u32 m0, s44, 49152
ds_read_b64_tr_b16 v[228:229], v117 offset:4096
ds_read_b64_tr_b16 v[230:231], v117 offset:6144
Mvva 160,204,152
buffer_load_dwordx4 v114, s[12:15], s48 offen offset:0 lds
Mvva 176,192,132
s_waitcnt lgkmcnt(4)
ds_read_b64_tr_b16 v[232:233], v117 offset:8192
ds_read_b64_tr_b16 v[234:235], v117 offset:10240
Mvva 176,196,140
Mvva 176,200,148
ds_read_b64_tr_b16 v[236:237], v117 offset:12288
ds_read_b64_tr_b16 v[238:239], v117 offset:14336
Mvva 176,204,156
buffer_load_dwordx4 v114, s[12:15], s49 offen offset:1024 lds
Mvva 164,208,128
ds_read_b64_tr_b16 v[240:241], v118 offset:0
ds_read_b64_tr_b16 v[242:243], v118 offset:2048
Mvva 164,212,136
Mvva 164,216,144
s_waitcnt lgkmcnt(2)
ds_read_b64_tr_b16 v[244:245], v118 offset:4096
ds_read_b64_tr_b16 v[246:247], v118 offset:6144
Mvva 164,220,152
buffer_load_dwordx4 v114, s[12:15], s50 offen offset:2048 lds
Mvva 180,208,132
s_waitcnt vmcnt(15)
ds_read_b64_tr_b16 v[248:249], v118 offset:8192
ds_read_b64_tr_b16 v[250:251], v118 offset:10240
Mvva 180,212,140
Mvva 180,216,148
s_barrier
ds_read_b64_tr_b16 v[252:253], v118 offset:12288
ds_read_b64_tr_b16 v[254:255], v118 offset:14336
Mvva 180,220,156
buffer_load_dwordx4 v114, s[12:15], s51 offen offset:3072 lds
v_xor_b32 v114, 128, v114
v_add_u32 v114, 262144, v114
Mvva 168,224,128
ds_read_b64_tr_b16 v[192:193], v115 offset:16384
ds_read_b64_tr_b16 v[194:195], v115 offset:18432
Mvva 168,228,136
Mvva 168,232,144
ds_read_b64_tr_b16 v[196:197], v115 offset:20480
ds_read_b64_tr_b16 v[198:199], v115 offset:22528
Mvva 168,236,152
buffer_load_dwordx4 a[192:195], v112, s[8:11], s52 offen offset:0 sc1
Mvva 184,224,132
s_waitcnt lgkmcnt(4)
ds_read_b64_tr_b16 v[200:201], v115 offset:24576
ds_read_b64_tr_b16 v[202:203], v115 offset:26624
Mvva 184,228,140
Mvva 184,232,148
ds_read_b64_tr_b16 v[204:205], v115 offset:28672
ds_read_b64_tr_b16 v[206:207], v115 offset:30720
Mvva 184,236,156
buffer_load_dwordx4 a[196:199], v112, s[8:11], s52 offen offset:1024 sc1
s_add_u32 s52, s52, 8192
Mvva 172,240,128
ds_read_b64_tr_b16 v[208:209], v116 offset:16384
ds_read_b64_tr_b16 v[210:211], v116 offset:18432
Mvva 172,244,136
Mvva 172,248,144
ds_read_b64_tr_b16 v[212:213], v116 offset:20480
ds_read_b64_tr_b16 v[214:215], v116 offset:22528
Mvva 172,252,152
buffer_load_dwordx4 a[200:203], v112, s[8:11], s52 offen offset:0 sc1
Mvva 188,240,132
s_waitcnt lgkmcnt(4)
ds_read_b64_tr_b16 v[216:217], v116 offset:24576
ds_read_b64_tr_b16 v[218:219], v116 offset:26624
Mvva 188,244,140
Mvva 188,248,148
ds_read_b64_tr_b16 v[220:221], v116 offset:28672
ds_read_b64_tr_b16 v[222:223], v116 offset:30720
Mvva 188,252,156
buffer_load_dwordx4 a[204:207], v112, s[8:11], s52 offen offset:1024 sc1
s_add_u32 s52, s52, 8192
Mvva 128,192,128
ds_read_b64_tr_b16 v[224:225], v117 offset:16384
ds_read_b64_tr_b16 v[226:227], v117 offset:18432
Mvva 128,196,136
Mvva 128,200,144
s_add_u32 m0, s44, 65536
ds_read_b64_tr_b16 v[228:229], v117 offset:20480
ds_read_b64_tr_b16 v[230:231], v117 offset:22528
Mvva 128,204,152
buffer_load_dwordx4 v114, s[12:15], s48 offen offset:0 lds
Mvva 144,192,132
s_waitcnt lgkmcnt(4)
ds_read_b64_tr_b16 v[232:233], v117 offset:24576
ds_read_b64_tr_b16 v[234:235], v117 offset:26624
Mvva 144,196,140
Mvva 144,200,148
ds_read_b64_tr_b16 v[236:237], v117 offset:28672
ds_read_b64_tr_b16 v[238:239], v117 offset:30720
Mvva 144,204,156
buffer_load_dwordx4 v114, s[12:15], s49 offen offset:1024 lds
Mvva 132,208,128
ds_read_b64_tr_b16 v[240:241], v118 offset:16384
ds_read_b64_tr_b16 v[242:243], v118 offset:18432
Mvva 132,212,136
Mvva 132,216,144
s_waitcnt lgkmcnt(2)
ds_read_b64_tr_b16 v[244:245], v118 offset:20480
ds_read_b64_tr_b16 v[246:247], v118 offset:22528
Mvva 132,220,152
buffer_load_dwordx4 v114, s[12:15], s50 offen offset:2048 lds
Mvva 148,208,132
s_waitcnt vmcnt(15)
ds_read_b64_tr_b16 v[248:249], v118 offset:24576
ds_read_b64_tr_b16 v[250:251], v118 offset:26624
Mvva 148,212,140
Mvva 148,216,148
s_barrier
ds_read_b64_tr_b16 v[252:253], v118 offset:28672
ds_read_b64_tr_b16 v[254:255], v118 offset:30720
Mvva 148,220,156
buffer_load_dwordx4 v114, s[12:15], s51 offen offset:3072 lds
v_xor_b32 v114, 128, v114
Mvva 136,224,128
ds_read_b64_tr_b16 v[192:193], v115 offset:32768
ds_read_b64_tr_b16 v[194:195], v115 offset:34816
Mvva 136,228,136
s_cmp_ge_u32 s2, 128
s_cbranch_scc1 L_c31
L_c31r:
Mvva 136,232,144
ds_read_b64_tr_b16 v[196:197], v115 offset:36864
ds_read_b64_tr_b16 v[198:199], v115 offset:38912
Mvva 136,236,152
buffer_load_dwordx4 a[208:211], v112, s[8:11], s52 offen offset:0 sc1
Mvva 152,224,132
s_waitcnt lgkmcnt(4)
ds_read_b64_tr_b16 v[200:201], v115 offset:40960
ds_read_b64_tr_b16 v[202:203], v115 offset:43008
Mvva 152,228,140
Mvva 152,232,148
ds_read_b64_tr_b16 v[204:205], v115 offset:45056
ds_read_b64_tr_b16 v[206:207], v115 offset:47104
Mvva 152,236,156
buffer_load_dwordx4 a[212:215], v112, s[8:11], s52 offen offset:1024 sc1
s_add_u32 s52, s52, 8192
Mvva 140,240,128
ds_read_b64_tr_b16 v[208:209], v116 offset:32768
ds_read_b64_tr_b16 v[210:211], v116 offset:34816
Mvva 140,244,136
Mvva 140,248,144
ds_read_b64_tr_b16 v[212:213], v116 offset:36864
ds_read_b64_tr_b16 v[214:215], v116 offset:38912
Mvva 140,252,152
buffer_load_dwordx4 a[216:219], v112, s[8:11], s52 offen offset:0 sc1
Mvva 156,240,132
s_waitcnt lgkmcnt(4)
ds_read_b64_tr_b16 v[216:217], v116 offset:40960
ds_read_b64_tr_b16 v[218:219], v116 offset:43008
Mvva 156,244,140
s_waitcnt vmcnt(16)
Va 74,74,78
Va 75,75,79
v_add_f32_e64 v76, v76, v80
Mvva 156,248,148
s_waitcnt vmcnt(15)
ds_read_b64_tr_b16 v[220:221], v116 offset:45056
ds_read_b64_tr_b16 v[222:223], v116 offset:47104
Va 77,77,81
Mvva 156,252,156
buffer_load_dwordx4 a[220:223], v112, s[8:11], s52 offen offset:1024 sc1
s_add_u32 s52, s52, 8192
Mvva 160,192,160
ds_read_b64_tr_b16 v[224:225], v117 offset:32768
ds_read_b64_tr_b16 v[226:227], v117 offset:34816
v_add_f32_e64 v74, v74, v82
Mvva 160,196,168
Va 75,75,83
Va 76,76,84
v_add_f32_e64 v77, v77, v85
Mvva 160,200,176
s_add_u32 m0, s44, 81920
ds_read_b64_tr_b16 v[228:229], v117 offset:36864
ds_read_b64_tr_b16 v[230:231], v117 offset:38912
v_add_f32_e64 v74, v74, v86
Mvva 160,204,184
buffer_load_dwordx4 v114, s[12:15], s48 offen offset:0 lds
Mvva 176,192,164
s_waitcnt lgkmcnt(4)
ds_read_b64_tr_b16 v[232:233], v117 offset:40960
ds_read_b64_tr_b16 v[234:235], v117 offset:43008
Va 75,75,87
Mvva 176,196,172
Va 76,76,88
Va 77,77,89
v_add_f32_e64 v74, v74, v90
Mvva 176,200,180
ds_read_b64_tr_b16 v[236:237], v117 offset:45056
ds_read_b64_tr_b16 v[238:239], v117 offset:47104
v_add_f32_e64 v75, v75, v91
Mvva 176,204,188
buffer_load_dwordx4 v114, s[12:15], s49 offen offset:1024 lds
Mvva 164,208,160
ds_read_b64_tr_b16 v[240:241], v118 offset:32768
ds_read_b64_tr_b16 v[242:243], v118 offset:34816
v_add_f32_e64 v76, v76, v92
Mvva 164,212,168
Va 77,77,93
Va 74,74,94
v_add_f32_e64 v75, v75, v95
Mvva 164,216,176
s_waitcnt lgkmcnt(2)
ds_read_b64_tr_b16 v[244:245], v118 offset:36864
ds_read_b64_tr_b16 v[246:247], v118 offset:38912
Va 76,76,96
Mvva 164,220,184
buffer_load_dwordx4 v114, s[12:15], s50 offen offset:2048 lds
Mvva 180,208,164
s_waitcnt vmcnt(15)
ds_read_b64_tr_b16 v[248:249], v118 offset:40960
ds_read_b64_tr_b16 v[250:251], v118 offset:43008
Va 77,77,97
Mvva 180,212,172
Va 74,74,98
Va 75,75,99
v_add_f32_e64 v76, v76, v100
Mvva 180,216,180
s_barrier
ds_read_b64_tr_b16 v[252:253], v118 offset:45056
ds_read_b64_tr_b16 v[254:255], v118 offset:47104
Va 77,77,101
Mvva 180,220,188
buffer_load_dwordx4 v114, s[12:15], s51 offen offset:3072 lds
v_xor_b32 v114, 128, v114
v_add_u32 v114, 262144, v114
Mvva 168,224,160
ds_read_b64_tr_b16 v[192:193], v115 offset:49152
ds_read_b64_tr_b16 v[194:195], v115 offset:51200
v_add_f32_e64 v74, v74, v102
Mvva 168,228,168
Va 75,75,103
Va 76,76,104
v_add_f32_e64 v77, v77, v105
Mvva 168,232,176
ds_read_b64_tr_b16 v[196:197], v115 offset:53248
ds_read_b64_tr_b16 v[198:199], v115 offset:55296
Mvva 168,236,184
buffer_load_dwordx4 a[224:227], v112, s[8:11], s52 offen offset:0 sc1
Mvva 184,224,164
s_waitcnt lgkmcnt(4)
ds_read_b64_tr_b16 v[200:201], v115 offset:57344
ds_read_b64_tr_b16 v[202:203], v115 offset:59392
Mvva 184,228,172
ds_read_b64_tr_b16 v[90:91], v106 offset:0
ds_read_b64_tr_b16 v[92:93], v106 offset:2048
ds_read_b64_tr_b16 v[94:95], v107 offset:0
Mvva 184,232,180
ds_read_b64_tr_b16 v[204:205], v115 offset:61440
ds_read_b64_tr_b16 v[206:207], v115 offset:63488
Mvva 184,236,188
buffer_load_dwordx4 a[228:231], v112, s[8:11], s52 offen offset:1024 sc1
s_add_u32 s52, s52, 8192
Mvva 172,240,160
ds_read_b64_tr_b16 v[208:209], v116 offset:49152
ds_read_b64_tr_b16 v[210:211], v116 offset:51200
Mvva 172,244,168
ds_read_b64_tr_b16 v[96:97], v107 offset:2048
ds_read_b64_tr_b16 v[98:99], v108 offset:0
s_waitcnt lgkmcnt(9)
ds_read_b64_tr_b16 v[100:101], v108 offset:2048
Mvva 172,248,176
ds_read_b64_tr_b16 v[212:213], v116 offset:53248
ds_read_b64_tr_b16 v[214:215], v116 offset:55296
Mvva 172,252,184
buffer_load_dwordx4 a[232:235], v112, s[8:11], s52 offen offset:0 sc1
Mvva 188,240,164
s_waitcnt lgkmcnt(7)
ds_read_b64_tr_b16 v[216:217], v116 offset:57344
ds_read_b64_tr_b16 v[218:219], v116 offset:59392
Mvva 188,244,172
ds_read_b64_tr_b16 v[102:103], v109 offset:0
ds_read_b64_tr_b16 v[104:105], v109 offset:2048
Vc 8,74,75
Mvva 188,248,180
ds_read_b64_tr_b16 v[220:221], v116 offset:61440
ds_read_b64_tr_b16 v[222:223], v116 offset:63488
v_lshlrev_b32 v74, 16, v8
Mvva 188,252,188
buffer_load_dwordx4 a[236:239], v112, s[8:11], s52 offen offset:1024 sc1
s_add_u32 s52, s52, 8192
Mvva 128,192,160
ds_read_b64_tr_b16 v[224:225], v117 offset:49152
ds_read_b64_tr_b16 v[226:227], v117 offset:51200
v_and_b32 v75, 0xffff0000, v8
Mvva 128,196,168
Vc 8,76,77
v_lshlrev_b32_e64 v76, 16, v8
v_and_b32 v77, 0xffff0000, v8
Mvva 128,200,176
s_add_u32 m0, s44, 98304
s_waitcnt lgkmcnt(9)
ds_read_b64_tr_b16 v[228:229], v117 offset:53248
ds_read_b64_tr_b16 v[230:231], v117 offset:55296
v_mov_b32 v78, v74
Mvva 128,204,184
buffer_load_dwordx4 v114, s[12:15], s48 offen offset:0 lds
Mvva 144,192,164
s_waitcnt lgkmcnt(4)
ds_read_b64_tr_b16 v[232:233], v117 offset:57344
ds_read_b64_tr_b16 v[234:235], v117 offset:59392
v_mov_b32 v79, v75
Mvva 144,196,172
v_mov_b32 v80, v76
v_mov_b32 v81, v77
v_permlane32_swap_b32 v78, v74
Mvva 144,200,180
ds_read_b64_tr_b16 v[236:237], v117 offset:61440
ds_read_b64_tr_b16 v[238:239], v117 offset:63488
v_permlane32_swap_b32 v79, v75
Mvva 144,204,188
buffer_load_dwordx4 v114, s[12:15], s49 offen offset:1024 lds
Mvva 132,208,160
ds_read_b64_tr_b16 v[240:241], v118 offset:49152
ds_read_b64_tr_b16 v[242:243], v118 offset:51200
v_permlane32_swap_b32 v80, v76
Mvva 132,212,168
v_permlane32_swap_b32 v81, v77
v_mul_f32 v82, 0xbfb8aa3b, v78
v_mul_f32 v83, 0xbfb8aa3b, v79
Mvva 132,216,176
s_waitcnt lgkmcnt(2)
ds_read_b64_tr_b16 v[244:245], v118 offset:53248
ds_read_b64_tr_b16 v[246:247], v118 offset:55296
v_mul_f32 v84, 0xbfb8aa3b, v80
Mvva 132,220,184
buffer_load_dwordx4 v114, s[12:15], s50 offen offset:2048 lds
Mvva 148,208,164
s_waitcnt vmcnt(15)
ds_read_b64_tr_b16 v[248:249], v118 offset:57344
ds_read_b64_tr_b16 v[250:251], v118 offset:59392
v_mul_f32 v85, 0xbfb8aa3b, v81
Mvva 148,212,172
VE 82,82
Mvva 148,216,180
s_barrier
ds_read_b64_tr_b16 v[252:253], v118 offset:61440
ds_read_b64_tr_b16 v[254:255], v118 offset:63488
Mvva 148,220,188
buffer_load_dwordx4 v114, s[12:15], s51 offen offset:3072 lds
v_xor_b32 v114, 128, v114
Mvva 136,224,160
ds_read_b64_tr_b16 v[192:193], v12 offset:0
ds_read_b64_tr_b16 v[194:195], v12 offset:2048
Mvva 136,228,168
Ve 83,83
Mvva 136,232,176
ds_read_b64_tr_b16 v[196:197], v12 offset:4096
ds_read_b64_tr_b16 v[198:199], v12 offset:6144
Mvva 136,236,184
buffer_load_dwordx4 a[240:243], v112, s[8:11], s52 offen offset:0 sc1
Mvva 152,224,164
s_waitcnt lgkmcnt(4)
ds_read_b64_tr_b16 v[200:201], v12 offset:8192
ds_read_b64_tr_b16 v[202:203], v12 offset:10240
Mvva 152,228,172
Ve 84,84
Mvva 152,232,180
ds_read_b64_tr_b16 v[204:205], v12 offset:12288
ds_read_b64_tr_b16 v[206:207], v12 offset:14336
Mvva 152,236,188
buffer_load_dwordx4 a[244:247], v112, s[8:11], s52 offen offset:1024 sc1
s_add_u32 s52, s52, 8192
Mvva 140,240,160
ds_read_b64_tr_b16 v[208:209], v13 offset:0
ds_read_b64_tr_b16 v[210:211], v13 offset:2048
Mvva 140,244,168
Ve 85,85
v_add_f32 v82, 1.0, v82
Mvva 140,248,176
ds_read_b64_tr_b16 v[212:213], v13 offset:4096
ds_read_b64_tr_b16 v[214:215], v13 offset:6144
v_add_f32_e64 v83, 1.0, v83
Mvva 140,252,184
buffer_load_dwordx4 a[248:251], v112, s[8:11], s52 offen offset:0 sc1
Mvva 156,240,164
s_waitcnt lgkmcnt(4)
ds_read_b64_tr_b16 v[216:217], v13 offset:8192
ds_read_b64_tr_b16 v[218:219], v13 offset:10240
v_add_f32 v84, 1.0, v84
Mvva 156,244,172
v_add_f32 v85, 1.0, v85
v_rcp_f32 v82, v82
Mvva 156,248,180
s_waitcnt vmcnt(15)
ds_read_b64_tr_b16 v[220:221], v13 offset:12288
ds_read_b64_tr_b16 v[222:223], v13 offset:14336
Mvva 156,252,188
buffer_load_dwordx4 a[252:255], v112, s[8:11], s52 offen offset:1024 sc1
s_add_u32 s52, s52, 8192
Mvva 160,192,192
ds_read_b64_tr_b16 v[224:225], v14 offset:0
ds_read_b64_tr_b16 v[226:227], v14 offset:2048
Mvva 160,196,200
v_rcp_f32 v83, v83
Mvva 160,200,208
s_add_u32 m0, s44, 114688
ds_read_b64_tr_b16 v[228:229], v14 offset:4096
ds_read_b64_tr_b16 v[230:231], v14 offset:6144
Mvva 160,204,216
buffer_load_dwordx4 v114, s[12:15], s48 offen offset:0 lds
Mvva 176,192,196
s_waitcnt lgkmcnt(4)
ds_read_b64_tr_b16 v[232:233], v14 offset:8192
ds_read_b64_tr_b16 v[234:235], v14 offset:10240
Mvva 176,196,204
v_rcp_f32 v84, v84
Mvva 176,200,212
ds_read_b64_tr_b16 v[236:237], v14 offset:12288
ds_read_b64_tr_b16 v[238:239], v14 offset:14336
Mvva 176,204,220
buffer_load_dwordx4 v114, s[12:15], s49 offen offset:1024 lds
Mvva 164,208,192
ds_read_b64_tr_b16 v[240:241], v15 offset:0
ds_read_b64_tr_b16 v[242:243], v15 offset:2048
Mvva 164,212,200
v_rcp_f32 v85, v85
Vm 78,78,82
Mvva 164,216,208
s_waitcnt lgkmcnt(2)
ds_read_b64_tr_b16 v[244:245], v15 offset:4096
ds_read_b64_tr_b16 v[246:247], v15 offset:6144
Vm 79,79,83
Mvva 164,220,216
buffer_load_dwordx4 v114, s[12:15], s50 offen offset:2048 lds
Mvva 180,208,196
s_waitcnt vmcnt(15)
ds_read_b64_tr_b16 v[248:249], v15 offset:8192
ds_read_b64_tr_b16 v[250:251], v15 offset:10240
Vm 80,80,84
Mvva 180,212,204
v_mul_f32_e64 v81, v81, v85
Vc 8,78,79
v_lshlrev_b32_e64 v78, 16, v8
Mvva 180,216,212
s_barrier
ds_read_b64_tr_b16 v[252:253], v15 offset:12288
ds_read_b64_tr_b16 v[254:255], v15 offset:14336
v_and_b32 v79, 0xffff0000, v8
Mvva 180,220,220
buffer_load_dwordx4 v114, s[12:15], s51 offen offset:3072 lds
v_xor_b32 v114, 128, v114
v_add_u32 v114, 262144, v114
Mvva 168,224,192
ds_read_b64_tr_b16 v[192:193], v12 offset:16384
ds_read_b64_tr_b16 v[194:195], v12 offset:18432
Vc 8,80,81
Mvva 168,228,200
v_lshlrev_b32 v80, 16, v8
v_and_b32 v81, 0xffff0000, v8
v_mul_f32_e64 v74, v74, v78
Mvva 168,232,208
ds_read_b64_tr_b16 v[196:197], v12 offset:20480
ds_read_b64_tr_b16 v[198:199], v12 offset:22528
v_mul_f32_e64 v75, v75, v79
Mvva 168,236,216
buffer_load_dwordx4 a[0:3], v112, s[8:11], s52 offen offset:0 sc1
Mvva 184,224,196
s_waitcnt lgkmcnt(4)
ds_read_b64_tr_b16 v[200:201], v12 offset:24576
ds_read_b64_tr_b16 v[202:203], v12 offset:26624
Vm 76,76,80
Mvva 184,228,204
v_mul_f32_e64 v77, v77, v81
Vc 8,74,75
Vc 9,76,77
Mvva 184,232,212
ds_read_b64_tr_b16 v[204:205], v12 offset:28672
ds_read_b64_tr_b16 v[206:207], v12 offset:30720
Mvva 184,236,220
buffer_load_dwordx4 a[4:7], v112, s[8:11], s52 offen offset:1024 sc1
s_add_u32 s52, s52, 8192
Mvva 172,240,192
ds_read_b64_tr_b16 v[208:209], v13 offset:16384
ds_read_b64_tr_b16 v[210:211], v13 offset:18432
Mvva 172,244,200
ds_write_b64 v2, v[8:9]
ds_read_b64 v[74:75], v3 offset:0
ds_read_b64 v[76:77], v3 offset:32
Mvva 172,248,208
ds_read_b64_tr_b16 v[212:213], v13 offset:20480
ds_read_b64_tr_b16 v[214:215], v13 offset:22528
Mvva 172,252,216
buffer_load_dwordx4 a[8:11], v112, s[8:11], s52 offen offset:0 sc1
Mvva 188,240,196
s_waitcnt lgkmcnt(7)
ds_read_b64_tr_b16 v[216:217], v13 offset:24576
ds_read_b64_tr_b16 v[218:219], v13 offset:26624
Mvva 188,244,204
ds_read_b64 v[78:79], v3 offset:64
ds_read_b64 v[80:81], v3 offset:96
Mvva 188,248,212
ds_read_b64_tr_b16 v[220:221], v13 offset:28672
ds_read_b64_tr_b16 v[222:223], v13 offset:30720
Mvva 188,252,220
buffer_load_dwordx4 a[12:15], v112, s[8:11], s52 offen offset:1024 sc1
s_add_u32 s52, s52, 8192
Mvva 128,192,192
ds_read_b64_tr_b16 v[224:225], v14 offset:16384
ds_read_b64_tr_b16 v[226:227], v14 offset:18432
Mvva 128,196,200
Mvva 128,200,208
s_add_u32 m0, s44, 0
s_waitcnt lgkmcnt(9)
ds_read_b64_tr_b16 v[228:229], v14 offset:20480
ds_read_b64_tr_b16 v[230:231], v14 offset:22528
Mvva 128,204,216
buffer_load_dwordx4 v114, s[12:15], s48 offen offset:0 lds
Mvva 144,192,196
s_waitcnt lgkmcnt(4)
ds_read_b64_tr_b16 v[232:233], v14 offset:24576
ds_read_b64_tr_b16 v[234:235], v14 offset:26624
Mvva 144,196,204
Zvvv 82,90,74
Mvva 144,200,212
ds_read_b64_tr_b16 v[236:237], v14 offset:28672
ds_read_b64_tr_b16 v[238:239], v14 offset:30720
Mvva 144,204,220
buffer_load_dwordx4 v114, s[12:15], s49 offen offset:1024 lds
Mvva 132,208,192
ds_read_b64_tr_b16 v[240:241], v15 offset:16384
ds_read_b64_tr_b16 v[242:243], v15 offset:18432
Mvva 132,212,200
Zvvv 86,94,74
Mvva 132,216,208
s_waitcnt lgkmcnt(2)
ds_read_b64_tr_b16 v[244:245], v15 offset:20480
ds_read_b64_tr_b16 v[246:247], v15 offset:22528
Mvva 132,220,216
buffer_load_dwordx4 v114, s[12:15], s50 offen offset:2048 lds
Mvva 148,208,196
s_waitcnt vmcnt(15)
ds_read_b64_tr_b16 v[248:249], v15 offset:24576
ds_read_b64_tr_b16 v[250:251], v15 offset:26624
Mvva 148,212,204
ds_read_b64_tr_b16 v[90:91], v106 offset:4096
ds_read_b64_tr_b16 v[92:93], v106 offset:6144
ds_read_b64_tr_b16 v[94:95], v107 offset:4096
Mvva 148,216,212
s_barrier
ds_read_b64_tr_b16 v[252:253], v15 offset:28672
ds_read_b64_tr_b16 v[254:255], v15 offset:30720
Mvva 148,220,220
buffer_load_dwordx4 v114, s[12:15], s51 offen offset:3072 lds
v_add_u32 v114, 262144, v114
Mvva 136,224,192
ds_read_b64_tr_b16 v[192:193], v12 offset:32768
ds_read_b64_tr_b16 v[194:195], v12 offset:34816
Mvva 136,228,200
ds_read_b64_tr_b16 v[96:97], v107 offset:6144
Mvva 136,232,208
ds_read_b64_tr_b16 v[196:197], v12 offset:36864
s_waitcnt lgkmcnt(9)
ds_read_b64_tr_b16 v[198:199], v12 offset:38912
Mvva 136,236,216
buffer_load_dwordx4 a[16:19], v112, s[8:11], s52 offen offset:0 sc1
Mvva 152,224,196
s_waitcnt lgkmcnt(5)
ds_read_b64_tr_b16 v[200:201], v12 offset:40960
ds_read_b64_tr_b16 v[202:203], v12 offset:43008
Mvva 152,228,204
Mvva 152,232,212
ds_read_b64_tr_b16 v[204:205], v12 offset:45056
ds_read_b64_tr_b16 v[206:207], v12 offset:47104
Mvva 152,236,220
buffer_load_dwordx4 a[20:23], v112, s[8:11], s52 offen offset:1024 sc1
s_add_u32 s52, s52, 8192
Mvva 140,240,192
ds_read_b64_tr_b16 v[208:209], v13 offset:32768
ds_read_b64_tr_b16 v[210:211], v13 offset:34816
Mvva 140,244,200
s_waitcnt lgkmcnt(8)
Mvvv 82,90,78
Mvva 140,248,208
ds_read_b64_tr_b16 v[212:213], v13 offset:36864
ds_read_b64_tr_b16 v[214:215], v13 offset:38912
Mvva 140,252,216
buffer_load_dwordx4 a[24:27], v112, s[8:11], s52 offen offset:0 sc1
Mvva 156,240,196
s_waitcnt lgkmcnt(4)
ds_read_b64_tr_b16 v[216:217], v13 offset:40960
ds_read_b64_tr_b16 v[218:219], v13 offset:43008
Mvva 156,244,204
Mvvv 86,94,78
Mvva 156,248,212
s_waitcnt vmcnt(15)
ds_read_b64_tr_b16 v[220:221], v13 offset:45056
ds_read_b64_tr_b16 v[222:223], v13 offset:47104
Mvva 156,252,220
buffer_load_dwordx4 a[28:31], v112, s[8:11], s52 offen offset:1024 sc1
s_add_u32 s52, s52, 8192
Mvva 160,192,224
s_add_u32 m0, s44, 16384
ds_read_b64_tr_b16 v[224:225], v14 offset:32768
ds_read_b64_tr_b16 v[226:227], v14 offset:34816
Mvva 160,196,232
buffer_load_dwordx4 v114, s[12:15], s48 offen offset:0 lds
Mvva 160,200,240
ds_read_b64_tr_b16 v[228:229], v14 offset:36864
ds_read_b64_tr_b16 v[230:231], v14 offset:38912
Mvva 160,204,248
Mvva 176,192,228
s_waitcnt lgkmcnt(4)
ds_read_b64_tr_b16 v[232:233], v14 offset:40960
ds_read_b64_tr_b16 v[234:235], v14 offset:43008
Mvva 176,196,236
buffer_load_dwordx4 v114, s[12:15], s49 offen offset:1024 lds
Mvva 176,200,244
ds_read_b64_tr_b16 v[236:237], v14 offset:45056
ds_read_b64_tr_b16 v[238:239], v14 offset:47104
Mvva 176,204,252
buffer_load_dwordx4 v114, s[12:15], s50 offen offset:2048 lds
Mvva 164,208,224
ds_read_b64_tr_b16 v[240:241], v15 offset:32768
ds_read_b64_tr_b16 v[242:243], v15 offset:34816
Mvva 164,212,232
buffer_load_dwordx4 v114, s[12:15], s51 offen offset:3072 lds
v_add_u32 v114, 262144, v114
Mvva 164,216,240
s_waitcnt lgkmcnt(2)
ds_read_b64_tr_b16 v[244:245], v15 offset:36864
ds_read_b64_tr_b16 v[246:247], v15 offset:38912
Mvva 164,220,248
ds_write_b128 v4, v[82:85] offset:2048
ds_write_b128 v4, v[86:89] offset:2112
Mvva 180,208,228
s_waitcnt vmcnt(16)
ds_read_b64_tr_b16 v[248:249], v15 offset:40960
ds_read_b64_tr_b16 v[250:251], v15 offset:43008
Mvva 180,212,236
buffer_load_dwordx4 a[32:35], v112, s[8:11], s52 offen offset:0 sc1
Mvva 180,216,244
s_barrier
ds_read_b64_tr_b16 v[252:253], v15 offset:45056
ds_read_b64_tr_b16 v[254:255], v15 offset:47104
Mvva 180,220,252
buffer_load_dwordx4 a[36:39], v112, s[8:11], s52 offen offset:1024 sc1
s_add_u32 s52, s52, 8192
Mvva 168,224,224
ds_read_b64_tr_b16 v[192:193], v12 offset:49152
ds_read_b64_tr_b16 v[194:195], v12 offset:51200
Mvva 168,228,232
buffer_load_dwordx4 a[40:43], v112, s[8:11], s52 offen offset:0 sc1
Mvva 168,232,240
ds_read_b64_tr_b16 v[196:197], v12 offset:53248
ds_read_b64_tr_b16 v[198:199], v12 offset:55296
Mvva 168,236,248
Mvva 184,224,228
s_waitcnt lgkmcnt(4)
ds_read_b64_tr_b16 v[200:201], v12 offset:57344
ds_read_b64_tr_b16 v[202:203], v12 offset:59392
Mvva 184,228,236
buffer_load_dwordx4 a[44:47], v112, s[8:11], s52 offen offset:1024 sc1
s_add_u32 s52, s52, 8192
Mvva 184,232,244
ds_read_b64_tr_b16 v[204:205], v12 offset:61440
ds_read_b64_tr_b16 v[206:207], v12 offset:63488
Mvva 184,236,252
buffer_load_dwordx4 a[48:51], v112, s[8:11], s52 offen offset:0 sc1
Mvva 172,240,224
ds_read_b64_tr_b16 v[208:209], v13 offset:49152
ds_read_b64_tr_b16 v[210:211], v13 offset:51200
Mvva 172,244,232
buffer_load_dwordx4 a[52:55], v112, s[8:11], s52 offen offset:1024 sc1
s_add_u32 s52, s52, 8192
Mvva 172,248,240
ds_read_b64_tr_b16 v[212:213], v13 offset:53248
ds_read_b64_tr_b16 v[214:215], v13 offset:55296
Mvva 172,252,248
Zvvv 82,98,74
Mvva 188,240,228
s_waitcnt lgkmcnt(4)
ds_read_b64_tr_b16 v[216:217], v13 offset:57344
ds_read_b64_tr_b16 v[218:219], v13 offset:59392
Mvva 188,244,236
buffer_load_dwordx4 a[56:59], v112, s[8:11], s52 offen offset:0 sc1
Mvva 188,248,244
ds_read_b64_tr_b16 v[220:221], v13 offset:61440
ds_read_b64_tr_b16 v[222:223], v13 offset:63488
Mvva 188,252,252
buffer_load_dwordx4 a[60:63], v112, s[8:11], s52 offen offset:1024 sc1
s_add_u32 s52, s52, 8192
Mvva 128,192,224
s_add_u32 m0, s44, 32768
ds_read_b64_tr_b16 v[224:225], v14 offset:49152
ds_read_b64_tr_b16 v[226:227], v14 offset:51200
Mvva 128,196,232
buffer_load_dwordx4 v114, s[12:15], s48 offen offset:0 lds
Mvva 128,200,240
ds_read_b64_tr_b16 v[228:229], v14 offset:53248
ds_read_b64_tr_b16 v[230:231], v14 offset:55296
Mvva 128,204,248
Zvvv 86,102,74
Mvva 144,192,228
s_waitcnt lgkmcnt(4)
ds_read_b64_tr_b16 v[232:233], v14 offset:57344
ds_read_b64_tr_b16 v[234:235], v14 offset:59392
Mvva 144,196,236
buffer_load_dwordx4 v114, s[12:15], s49 offen offset:1024 lds
Mvva 144,200,244
ds_read_b64_tr_b16 v[236:237], v14 offset:61440
ds_read_b64_tr_b16 v[238:239], v14 offset:63488
Mvva 144,204,252
buffer_load_dwordx4 v114, s[12:15], s50 offen offset:2048 lds
Mvva 132,208,224
ds_read_b64_tr_b16 v[240:241], v15 offset:49152
ds_read_b64_tr_b16 v[242:243], v15 offset:51200
Mvva 132,212,232
buffer_load_dwordx4 v114, s[12:15], s51 offen offset:3072 lds
v_add_u32 v114, 262144, v114
Mvva 132,216,240
s_waitcnt lgkmcnt(2)
ds_read_b64_tr_b16 v[244:245], v15 offset:53248
ds_read_b64_tr_b16 v[246:247], v15 offset:55296
Mvva 132,220,248
ds_read_b64_tr_b16 v[98:99], v108 offset:4096
ds_read_b64_tr_b16 v[100:101], v108 offset:6144
ds_read_b64_tr_b16 v[102:103], v109 offset:4096
Mvva 148,208,228
s_waitcnt vmcnt(20)
ds_read_b64_tr_b16 v[248:249], v15 offset:57344
ds_read_b64_tr_b16 v[250:251], v15 offset:59392
Mvva 148,212,236
buffer_load_dwordx4 a[64:67], v112, s[8:11], s52 offen offset:0 sc1
Mvva 148,216,244
s_barrier
ds_read_b64_tr_b16 v[252:253], v15 offset:61440
ds_read_b64_tr_b16 v[254:255], v15 offset:63488
Mvva 148,220,252
buffer_load_dwordx4 a[68:71], v112, s[8:11], s52 offen offset:1024 sc1
s_add_u32 s52, s52, 8192
Mvva 136,224,224
ds_read_b64_tr_b16 v[192:193], v115 offset:0
ds_read_b64_tr_b16 v[194:195], v115 offset:2048
Mvva 136,228,232
buffer_load_dwordx4 a[72:75], v112, s[8:11], s52 offen offset:0 sc1
Mvva 136,232,240
ds_read_b64_tr_b16 v[196:197], v115 offset:4096
ds_read_b64_tr_b16 v[198:199], v115 offset:6144
Mvva 136,236,248
s_waitcnt lgkmcnt(9)
ds_read_b64_tr_b16 v[104:105], v109 offset:6144
Mvva 152,224,228
s_waitcnt lgkmcnt(5)
ds_read_b64_tr_b16 v[200:201], v115 offset:8192
ds_read_b64_tr_b16 v[202:203], v115 offset:10240
Mvva 152,228,236
buffer_load_dwordx4 a[76:79], v112, s[8:11], s52 offen offset:1024 sc1
s_add_u32 s52, s52, 8192
Mvva 152,232,244
ds_read_b64_tr_b16 v[204:205], v115 offset:12288
ds_read_b64_tr_b16 v[206:207], v115 offset:14336
Mvva 152,236,252
buffer_load_dwordx4 a[80:83], v112, s[8:11], s52 offen offset:0 sc1
Mvva 140,240,224
ds_read_b64_tr_b16 v[208:209], v116 offset:0
ds_read_b64_tr_b16 v[210:211], v116 offset:2048
Mvva 140,244,232
buffer_load_dwordx4 a[84:87], v112, s[8:11], s52 offen offset:1024 sc1
s_add_u32 s52, s52, 8192
Mvva 140,248,240
ds_read_b64_tr_b16 v[212:213], v116 offset:4096
ds_read_b64_tr_b16 v[214:215], v116 offset:6144
Mvva 140,252,248
Mvva 156,240,228
s_waitcnt lgkmcnt(4)
ds_read_b64_tr_b16 v[216:217], v116 offset:8192
ds_read_b64_tr_b16 v[218:219], v116 offset:10240
Mvva 156,244,236
buffer_load_dwordx4 a[88:91], v112, s[8:11], s52 offen offset:0 sc1
Mvva 156,248,244
s_waitcnt vmcnt(23)
ds_read_b64_tr_b16 v[220:221], v116 offset:12288
ds_read_b64_tr_b16 v[222:223], v116 offset:14336
Mvva 156,252,252
buffer_load_dwordx4 a[92:95], v112, s[8:11], s52 offen offset:1024 sc1
s_add_u32 s52, s52, 8192
Mvva 160,192,0
s_add_u32 m0, s44, 49152
ds_read_b64_tr_b16 v[224:225], v117 offset:0
ds_read_b64_tr_b16 v[226:227], v117 offset:2048
Mvva 160,196,8
buffer_load_dwordx4 v114, s[12:15], s48 offen offset:0 lds
Mvva 160,200,16
ds_read_b64_tr_b16 v[228:229], v117 offset:4096
ds_read_b64_tr_b16 v[230:231], v117 offset:6144
Mvva 160,204,24
Mvvv 82,98,78
Mvva 176,192,4
s_waitcnt lgkmcnt(4)
ds_read_b64_tr_b16 v[232:233], v117 offset:8192
ds_read_b64_tr_b16 v[234:235], v117 offset:10240
Mvva 176,196,12
buffer_load_dwordx4 v114, s[12:15], s49 offen offset:1024 lds
Mvva 176,200,20
ds_read_b64_tr_b16 v[236:237], v117 offset:12288
ds_read_b64_tr_b16 v[238:239], v117 offset:14336
Mvva 176,204,28
buffer_load_dwordx4 v114, s[12:15], s50 offen offset:2048 lds
Mvva 164,208,0
ds_read_b64_tr_b16 v[240:241], v118 offset:0
ds_read_b64_tr_b16 v[242:243], v118 offset:2048
Mvva 164,212,8
buffer_load_dwordx4 v114, s[12:15], s51 offen offset:3072 lds
v_add_u32 v114, 262144, v114
Mvva 164,216,16
s_waitcnt lgkmcnt(2)
ds_read_b64_tr_b16 v[244:245], v118 offset:4096
ds_read_b64_tr_b16 v[246:247], v118 offset:6144
Mvva 164,220,24
Mvvv 86,102,78
Mvva 180,208,4
s_waitcnt vmcnt(24)
ds_read_b64_tr_b16 v[248:249], v118 offset:8192
ds_read_b64_tr_b16 v[250:251], v118 offset:10240
Mvva 180,212,12
buffer_load_dwordx4 a[96:99], v112, s[8:11], s52 offen offset:0 sc1
Mvva 180,216,20
s_barrier
ds_read_b64_tr_b16 v[252:253], v118 offset:12288
ds_read_b64_tr_b16 v[254:255], v118 offset:14336
Mvva 180,220,28
buffer_load_dwordx4 a[100:103], v112, s[8:11], s52 offen offset:1024 sc1
s_add_u32 s52, s52, 8192
Mvva 168,224,0
ds_read_b64_tr_b16 v[192:193], v115 offset:16384
ds_read_b64_tr_b16 v[194:195], v115 offset:18432
Mvva 168,228,8
buffer_load_dwordx4 a[104:107], v112, s[8:11], s52 offen offset:0 sc1
Mvva 168,232,16
ds_read_b64_tr_b16 v[196:197], v115 offset:20480
ds_read_b64_tr_b16 v[198:199], v115 offset:22528
Mvva 168,236,24
Mvva 184,224,4
s_waitcnt lgkmcnt(4)
ds_read_b64_tr_b16 v[200:201], v115 offset:24576
ds_read_b64_tr_b16 v[202:203], v115 offset:26624
Mvva 184,228,12
buffer_load_dwordx4 a[108:111], v112, s[8:11], s52 offen offset:1024 sc1
s_add_u32 s52, s52, 8192
Mvva 184,232,20
ds_read_b64_tr_b16 v[204:205], v115 offset:28672
ds_read_b64_tr_b16 v[206:207], v115 offset:30720
Mvva 184,236,28
buffer_load_dwordx4 a[112:115], v112, s[8:11], s52 offen offset:0 sc1
Mvva 172,240,0
ds_read_b64_tr_b16 v[208:209], v116 offset:16384
ds_read_b64_tr_b16 v[210:211], v116 offset:18432
Mvva 172,244,8
buffer_load_dwordx4 a[116:119], v112, s[8:11], s52 offen offset:1024 sc1
s_add_u32 s52, s52, 8192
Mvva 172,248,16
ds_read_b64_tr_b16 v[212:213], v116 offset:20480
ds_read_b64_tr_b16 v[214:215], v116 offset:22528
Mvva 172,252,24
ds_write_b128 v4, v[82:85] offset:2176
ds_write_b128 v4, v[86:89] offset:2240
Mvva 188,240,4
s_waitcnt lgkmcnt(6)
ds_read_b64_tr_b16 v[216:217], v116 offset:24576
ds_read_b64_tr_b16 v[218:219], v116 offset:26624
Mvva 188,244,12
buffer_load_dwordx4 a[120:123], v112, s[8:11], s52 offen offset:0 sc1
Mvva 188,248,20
s_waitcnt vmcnt(23)
ds_read_b64_tr_b16 v[220:221], v116 offset:28672
ds_read_b64_tr_b16 v[222:223], v116 offset:30720
Mvva 188,252,28
buffer_load_dwordx4 a[124:127], v112, s[8:11], s52 offen offset:1024 sc1
s_add_u32 s52, s52, 8192
Mvva 160,192,32
s_add_u32 m0, s44, 65536
ds_read_b64_tr_b16 v[224:225], v117 offset:16384
ds_read_b64_tr_b16 v[226:227], v117 offset:18432
Mvva 160,196,40
buffer_load_dwordx4 v114, s[12:15], s48 offen offset:0 lds
Mvva 160,200,48
ds_read_b64_tr_b16 v[228:229], v117 offset:20480
ds_read_b64_tr_b16 v[230:231], v117 offset:22528
Mvva 160,204,56
Mvva 176,192,36
s_waitcnt lgkmcnt(4)
ds_read_b64_tr_b16 v[232:233], v117 offset:24576
ds_read_b64_tr_b16 v[234:235], v117 offset:26624
Mvva 176,196,44
buffer_load_dwordx4 v114, s[12:15], s49 offen offset:1024 lds
Mvva 176,200,52
ds_read_b64_tr_b16 v[236:237], v117 offset:28672
ds_read_b64_tr_b16 v[238:239], v117 offset:30720
Mvva 176,204,60
buffer_load_dwordx4 v114, s[12:15], s50 offen offset:2048 lds
Mvva 164,208,32
ds_read_b64_tr_b16 v[240:241], v118 offset:16384
ds_read_b64_tr_b16 v[242:243], v118 offset:18432
Mvva 164,212,40
buffer_load_dwordx4 v114, s[12:15], s51 offen offset:3072 lds
v_add_u32 v114, 262144, v114
Mvva 164,216,48
s_waitcnt lgkmcnt(2)
ds_read_b64_tr_b16 v[244:245], v118 offset:20480
ds_read_b64_tr_b16 v[246:247], v118 offset:22528
Mvva 164,220,56
Mvva 180,208,36
s_waitcnt vmcnt(24)
ds_read_b64_tr_b16 v[248:249], v118 offset:24576
ds_read_b64_tr_b16 v[250:251], v118 offset:26624
Mvva 180,212,44
buffer_load_dwordx4 a[128:131], v112, s[8:11], s52 offen offset:0 sc1
Mvva 180,216,52
s_barrier
ds_read_b64_tr_b16 v[252:253], v118 offset:28672
ds_read_b64_tr_b16 v[254:255], v118 offset:30720
Mvva 180,220,60
buffer_load_dwordx4 a[132:135], v112, s[8:11], s52 offen offset:1024 sc1
s_add_u32 s52, s52, 8192
Mvva 168,224,32
ds_read_b64_tr_b16 v[192:193], v115 offset:32768
ds_read_b64_tr_b16 v[194:195], v115 offset:34816
Mvva 168,228,40
buffer_load_dwordx4 a[136:139], v112, s[8:11], s52 offen offset:0 sc1
Mvva 168,232,48
ds_read_b64_tr_b16 v[196:197], v115 offset:36864
ds_read_b64_tr_b16 v[198:199], v115 offset:38912
Mvva 168,236,56
ds_read_b64 v[74:75], v6 offset:0
ds_read_b64 v[76:77], v6 offset:8192
ds_read_b64 v[78:79], v6 offset:16384
Mvva 184,224,36
s_waitcnt lgkmcnt(7)
ds_read_b64_tr_b16 v[200:201], v115 offset:40960
ds_read_b64_tr_b16 v[202:203], v115 offset:43008
Mvva 184,228,44
buffer_load_dwordx4 a[140:143], v112, s[8:11], s52 offen offset:1024 sc1
s_add_u32 s52, s52, 8192
Mvva 184,232,52
ds_read_b64_tr_b16 v[204:205], v115 offset:45056
ds_read_b64_tr_b16 v[206:207], v115 offset:47104
Mvva 184,236,60
buffer_load_dwordx4 a[144:147], v112, s[8:11], s52 offen offset:0 sc1
Mvva 172,240,32
ds_read_b64_tr_b16 v[208:209], v116 offset:32768
ds_read_b64_tr_b16 v[210:211], v116 offset:34816
Mvva 172,244,40
buffer_load_dwordx4 a[148:151], v112, s[8:11], s52 offen offset:1024 sc1
s_add_u32 s52, s52, 8192
Mvva 172,248,48
ds_read_b64_tr_b16 v[212:213], v116 offset:36864
ds_read_b64_tr_b16 v[214:215], v116 offset:38912
Mvva 172,252,56
s_waitcnt lgkmcnt(9)
ds_read_b64 v[80:81], v6 offset:24576
Mvva 188,240,36
s_waitcnt lgkmcnt(5)
ds_read_b64_tr_b16 v[216:217], v116 offset:40960
ds_read_b64_tr_b16 v[218:219], v116 offset:43008
Mvva 188,244,44
buffer_load_dwordx4 a[152:155], v112, s[8:11], s52 offen offset:0 sc1
Mvva 188,248,52
s_waitcnt vmcnt(23)
ds_read_b64_tr_b16 v[220:221], v116 offset:45056
ds_read_b64_tr_b16 v[222:223], v116 offset:47104
Mvva 188,252,60
buffer_load_dwordx4 a[156:159], v112, s[8:11], s52 offen offset:1024 sc1
s_add_u32 s52, s52, 8192
Mvva 160,192,64
s_add_u32 m0, s44, 81920
ds_read_b64_tr_b16 v[224:225], v117 offset:32768
ds_read_b64_tr_b16 v[226:227], v117 offset:34816
Mvva 160,196,72
buffer_load_dwordx4 v114, s[12:15], s48 offen offset:0 lds
Mvva 160,200,80
ds_read_b64_tr_b16 v[228:229], v117 offset:36864
ds_read_b64_tr_b16 v[230:231], v117 offset:38912
Mvva 160,204,88
Mvva 176,192,68
s_waitcnt lgkmcnt(4)
ds_read_b64_tr_b16 v[232:233], v117 offset:40960
ds_read_b64_tr_b16 v[234:235], v117 offset:43008
Mvva 176,196,76
buffer_load_dwordx4 v114, s[12:15], s49 offen offset:1024 lds
Mvva 176,200,84
ds_read_b64_tr_b16 v[236:237], v117 offset:45056
ds_read_b64_tr_b16 v[238:239], v117 offset:47104
Mvva 176,204,92
buffer_load_dwordx4 v114, s[12:15], s50 offen offset:2048 lds
Mvva 164,208,64
ds_read_b64_tr_b16 v[240:241], v118 offset:32768
ds_read_b64_tr_b16 v[242:243], v118 offset:34816
Mvva 164,212,72
buffer_load_dwordx4 v114, s[12:15], s51 offen offset:3072 lds
v_add_u32 v114, 262144, v114
Mvva 164,216,80
s_waitcnt lgkmcnt(2)
ds_read_b64_tr_b16 v[244:245], v118 offset:36864
ds_read_b64_tr_b16 v[246:247], v118 offset:38912
Mvva 164,220,88
Va 74,74,76
Va 78,78,80
Va 75,75,77
Mvva 180,208,68
s_waitcnt vmcnt(24)
ds_read_b64_tr_b16 v[248:249], v118 offset:40960
ds_read_b64_tr_b16 v[250:251], v118 offset:43008
Va 79,79,81
Mvva 180,212,76
buffer_load_dwordx4 a[160:163], v112, s[8:11], s52 offen offset:0 sc1
Mvva 180,216,84
s_barrier
ds_read_b64_tr_b16 v[252:253], v118 offset:45056
ds_read_b64_tr_b16 v[254:255], v118 offset:47104
Va 74,74,78
Mvva 180,220,92
buffer_load_dwordx4 a[164:167], v112, s[8:11], s52 offen offset:1024 sc1
s_add_u32 s52, s52, 8192
Mvva 168,224,64
ds_read_b64_tr_b16 v[192:193], v115 offset:49152
ds_read_b64_tr_b16 v[194:195], v115 offset:51200
v_add_f32_e64 v75, v75, v79
Mvva 168,228,72
buffer_load_dwordx4 a[168:171], v112, s[8:11], s52 offen offset:0 sc1
Mvva 168,232,80
ds_read_b64_tr_b16 v[196:197], v115 offset:53248
ds_read_b64_tr_b16 v[198:199], v115 offset:55296
Mvva 168,236,88
buffer_store_dwordx2 v[74:75], v5, s[20:23], s4 offen sc1
Mvva 184,224,68
s_waitcnt lgkmcnt(4)
ds_read_b64_tr_b16 v[200:201], v115 offset:57344
ds_read_b64_tr_b16 v[202:203], v115 offset:59392
Mvva 184,228,76
buffer_load_dwordx4 a[172:175], v112, s[8:11], s52 offen offset:1024 sc1
s_add_u32 s52, s52, 8192
Mvva 184,232,84
ds_read_b64_tr_b16 v[204:205], v115 offset:61440
ds_read_b64_tr_b16 v[206:207], v115 offset:63488
Mvva 184,236,92
buffer_load_dwordx4 a[176:179], v112, s[8:11], s52 offen offset:0 sc1
Mvva 172,240,64
ds_read_b64_tr_b16 v[208:209], v116 offset:49152
ds_read_b64_tr_b16 v[210:211], v116 offset:51200
Mvva 172,244,72
buffer_load_dwordx4 a[180:183], v112, s[8:11], s52 offen offset:1024 sc1
s_add_u32 s52, s52, 8192
Mvva 172,248,80
ds_read_b64_tr_b16 v[212:213], v116 offset:53248
ds_read_b64_tr_b16 v[214:215], v116 offset:55296
Mvva 172,252,88
Mvva 188,240,68
s_waitcnt lgkmcnt(4)
ds_read_b64_tr_b16 v[216:217], v116 offset:57344
ds_read_b64_tr_b16 v[218:219], v116 offset:59392
Mvva 188,244,76
buffer_load_dwordx4 a[184:187], v112, s[8:11], s52 offen offset:0 sc1
Mvva 188,248,84
s_waitcnt vmcnt(24)
ds_read_b64_tr_b16 v[220:221], v116 offset:61440
ds_read_b64_tr_b16 v[222:223], v116 offset:63488
Mvva 188,252,92
buffer_load_dwordx4 a[188:191], v112, s[8:11], s52 offen offset:1024 sc1
s_add_u32 s52, s52, 8192
Mvva 160,192,96
s_add_u32 m0, s44, 98304
ds_read_b64_tr_b16 v[224:225], v117 offset:49152
ds_read_b64_tr_b16 v[226:227], v117 offset:51200
Mvva 160,196,104
buffer_load_dwordx4 v114, s[12:15], s48 offen offset:0 lds
Mvva 160,200,112
ds_read_b64_tr_b16 v[228:229], v117 offset:53248
ds_read_b64_tr_b16 v[230:231], v117 offset:55296
Mvva 160,204,120
Mvva 176,192,100
s_waitcnt lgkmcnt(4)
ds_read_b64_tr_b16 v[232:233], v117 offset:57344
ds_read_b64_tr_b16 v[234:235], v117 offset:59392
Mvva 176,196,108
buffer_load_dwordx4 v114, s[12:15], s49 offen offset:1024 lds
Mvva 176,200,116
ds_read_b64_tr_b16 v[236:237], v117 offset:61440
ds_read_b64_tr_b16 v[238:239], v117 offset:63488
Mvva 176,204,124
buffer_load_dwordx4 v114, s[12:15], s50 offen offset:2048 lds
Mvva 164,208,96
ds_read_b64_tr_b16 v[240:241], v118 offset:49152
ds_read_b64_tr_b16 v[242:243], v118 offset:51200
Mvva 164,212,104
buffer_load_dwordx4 v114, s[12:15], s51 offen offset:3072 lds
v_add_u32 v114, 262144, v114
Mvva 164,216,112
s_waitcnt lgkmcnt(2)
ds_read_b64_tr_b16 v[244:245], v118 offset:53248
ds_read_b64_tr_b16 v[246:247], v118 offset:55296
Mvva 164,220,120
Mvva 180,208,100
s_waitcnt vmcnt(25)
ds_read_b64_tr_b16 v[248:249], v118 offset:57344
ds_read_b64_tr_b16 v[250:251], v118 offset:59392
Mvva 180,212,108
buffer_load_dwordx4 a[192:195], v112, s[8:11], s52 offen offset:0 sc1
Mvva 180,216,116
s_barrier
ds_read_b64_tr_b16 v[252:253], v118 offset:61440
ds_read_b64_tr_b16 v[254:255], v118 offset:63488
Mvva 180,220,124
buffer_load_dwordx4 a[196:199], v112, s[8:11], s52 offen offset:1024 sc1
s_add_u32 s52, s52, 8192
Mvva 168,224,96
ds_read_b64_tr_b16 v[192:193], v12 offset:0
ds_read_b64_tr_b16 v[194:195], v12 offset:2048
Mvva 168,228,104
buffer_load_dwordx4 a[200:203], v112, s[8:11], s52 offen offset:0 sc1
Mvva 168,232,112
ds_read_b64_tr_b16 v[196:197], v12 offset:4096
ds_read_b64_tr_b16 v[198:199], v12 offset:6144
Mvva 168,236,120
Mvva 184,224,100
s_waitcnt lgkmcnt(4)
ds_read_b64_tr_b16 v[200:201], v12 offset:8192
ds_read_b64_tr_b16 v[202:203], v12 offset:10240
Mvva 184,228,108
buffer_load_dwordx4 a[204:207], v112, s[8:11], s52 offen offset:1024 sc1
s_add_u32 s52, s52, 8192
Mvva 184,232,116
ds_read_b64_tr_b16 v[204:205], v12 offset:12288
ds_read_b64_tr_b16 v[206:207], v12 offset:14336
Mvva 184,236,124
buffer_load_dwordx4 a[208:211], v112, s[8:11], s52 offen offset:0 sc1
Mvva 172,240,96
ds_read_b64_tr_b16 v[208:209], v13 offset:0
ds_read_b64_tr_b16 v[210:211], v13 offset:2048
Mvva 172,244,104
buffer_load_dwordx4 a[212:215], v112, s[8:11], s52 offen offset:1024 sc1
s_add_u32 s52, s52, 8192
Mvva 172,248,112
ds_read_b64_tr_b16 v[212:213], v13 offset:4096
ds_read_b64_tr_b16 v[214:215], v13 offset:6144
Mvva 172,252,120
Mvva 188,240,100
s_waitcnt lgkmcnt(4)
ds_read_b64_tr_b16 v[216:217], v13 offset:8192
ds_read_b64_tr_b16 v[218:219], v13 offset:10240
Mvva 188,244,108
buffer_load_dwordx4 a[216:219], v112, s[8:11], s52 offen offset:0 sc1
Mvva 188,248,116
s_waitcnt vmcnt(24)
ds_read_b64_tr_b16 v[220:221], v13 offset:12288
ds_read_b64_tr_b16 v[222:223], v13 offset:14336
Mvva 188,252,124
buffer_load_dwordx4 a[220:223], v112, s[8:11], s52 offen offset:1024 sc1
s_add_u32 s52, s52, 8192
Mvva 160,192,128
s_add_u32 m0, s44, 114688
ds_read_b64_tr_b16 v[224:225], v14 offset:0
ds_read_b64_tr_b16 v[226:227], v14 offset:2048
Mvva 160,196,136
buffer_load_dwordx4 v114, s[12:15], s48 offen offset:0 lds
Mvva 160,200,144
ds_read_b64_tr_b16 v[228:229], v14 offset:4096
ds_read_b64_tr_b16 v[230:231], v14 offset:6144
Mvva 160,204,152
Mvva 176,192,132
s_waitcnt lgkmcnt(4)
ds_read_b64_tr_b16 v[232:233], v14 offset:8192
ds_read_b64_tr_b16 v[234:235], v14 offset:10240
Mvva 176,196,140
buffer_load_dwordx4 v114, s[12:15], s49 offen offset:1024 lds
Mvva 176,200,148
ds_read_b64_tr_b16 v[236:237], v14 offset:12288
ds_read_b64_tr_b16 v[238:239], v14 offset:14336
Mvva 176,204,156
buffer_load_dwordx4 v114, s[12:15], s50 offen offset:2048 lds
Mvva 164,208,128
ds_read_b64_tr_b16 v[240:241], v15 offset:0
ds_read_b64_tr_b16 v[242:243], v15 offset:2048
Mvva 164,212,136
buffer_load_dwordx4 v114, s[12:15], s51 offen offset:3072 lds
s_xor_b32 s95, s95, 128
v_add_u32 v114, s95, v113
Mvva 164,216,144
s_waitcnt lgkmcnt(2)
ds_read_b64_tr_b16 v[244:245], v15 offset:4096
ds_read_b64_tr_b16 v[246:247], v15 offset:6144
Mvva 164,220,152
Mvva 180,208,132
s_waitcnt vmcnt(25)
ds_read_b64_tr_b16 v[248:249], v15 offset:8192
ds_read_b64_tr_b16 v[250:251], v15 offset:10240
Mvva 180,212,140
buffer_load_dwordx4 a[224:227], v112, s[8:11], s52 offen offset:0 sc1
Mvva 180,216,148
s_barrier
ds_read_b64_tr_b16 v[252:253], v15 offset:12288
ds_read_b64_tr_b16 v[254:255], v15 offset:14336
Mvva 180,220,156
buffer_load_dwordx4 a[228:231], v112, s[8:11], s52 offen offset:1024 sc1
s_add_u32 s52, s52, 8192
Mvva 168,224,128
ds_read_b64_tr_b16 v[192:193], v12 offset:16384
ds_read_b64_tr_b16 v[194:195], v12 offset:18432
Mvva 168,228,136
buffer_load_dwordx4 a[232:235], v112, s[8:11], s52 offen offset:0 sc1
Mvva 168,232,144
ds_read_b64_tr_b16 v[196:197], v12 offset:20480
ds_read_b64_tr_b16 v[198:199], v12 offset:22528
Mvva 168,236,152
s_waitcnt vmcnt(24)
s_mov_b64 exec, 1
buffer_store_dword v7, v126, s[20:23], s6 offen sc1
s_mov_b64 exec, -1
Mvva 184,224,132
s_waitcnt lgkmcnt(4)
ds_read_b64_tr_b16 v[200:201], v12 offset:24576
ds_read_b64_tr_b16 v[202:203], v12 offset:26624
Mvva 184,228,140
buffer_load_dwordx4 a[236:239], v112, s[8:11], s52 offen offset:1024 sc1
s_add_u32 s52, s52, 8192
Mvva 184,232,148
ds_read_b64_tr_b16 v[204:205], v12 offset:28672
ds_read_b64_tr_b16 v[206:207], v12 offset:30720
Mvva 184,236,156
buffer_load_dwordx4 a[240:243], v112, s[8:11], s52 offen offset:0 sc1
Mvva 172,240,128
ds_read_b64_tr_b16 v[208:209], v13 offset:16384
ds_read_b64_tr_b16 v[210:211], v13 offset:18432
Mvva 172,244,136
buffer_load_dwordx4 a[244:247], v112, s[8:11], s52 offen offset:1024 sc1
s_add_u32 s52, s52, 8192
Mvva 172,248,144
ds_read_b64_tr_b16 v[212:213], v13 offset:20480
ds_read_b64_tr_b16 v[214:215], v13 offset:22528
Mvva 172,252,152
v_lshlrev_b32 v66, 16, v30
v_and_b32 v67, 0xffff0000, v30
v_lshlrev_b32_e64 v68, 16, v31
Mvva 188,240,132
s_waitcnt lgkmcnt(4)
ds_read_b64_tr_b16 v[216:217], v13 offset:24576
ds_read_b64_tr_b16 v[218:219], v13 offset:26624
v_and_b32 v69, 0xffff0000, v31
Mvva 188,244,140
buffer_load_dwordx4 a[248:251], v112, s[8:11], s52 offen offset:0 sc1
Mvva 188,248,148
s_waitcnt vmcnt(24)
ds_read_b64_tr_b16 v[220:221], v13 offset:28672
ds_read_b64_tr_b16 v[222:223], v13 offset:30720
v_lshlrev_b32_e64 v70, 16, v32
Mvva 188,252,156
buffer_load_dwordx4 a[252:255], v112, s[8:11], s52 offen offset:1024 sc1
s_add_u32 s52, s52, 8192
Mvva 160,192,160
s_add_u32 m0, s44, 0
ds_read_b64_tr_b16 v[224:225], v14 offset:16384
ds_read_b64_tr_b16 v[226:227], v14 offset:18432
Mvva 160,196,168
buffer_load_dwordx4 v114, s[12:15], s48 offen offset:0 lds
Mvva 160,200,176
ds_read_b64_tr_b16 v[228:229], v14 offset:20480
ds_read_b64_tr_b16 v[230:231], v14 offset:22528
Mvva 160,204,184
v_and_b32 v71, 0xffff0000, v32
v_lshlrev_b32 v72, 16, v33
Mvva 176,192,164
s_waitcnt lgkmcnt(4)
ds_read_b64_tr_b16 v[232:233], v14 offset:24576
ds_read_b64_tr_b16 v[234:235], v14 offset:26624
Mvva 176,196,172
buffer_load_dwordx4 v114, s[12:15], s49 offen offset:1024 lds
Mvva 176,200,180
ds_read_b64_tr_b16 v[236:237], v14 offset:28672
ds_read_b64_tr_b16 v[238:239], v14 offset:30720
Mvva 176,204,188
buffer_load_dwordx4 v114, s[12:15], s50 offen offset:2048 lds
Mvva 164,208,160
ds_read_b64_tr_b16 v[240:241], v15 offset:16384
ds_read_b64_tr_b16 v[242:243], v15 offset:18432
Mvva 164,212,168
buffer_load_dwordx4 v114, s[12:15], s51 offen offset:3072 lds
v_add_u32 v114, 262144, v114
Mvva 164,216,176
s_waitcnt lgkmcnt(2)
ds_read_b64_tr_b16 v[244:245], v15 offset:20480
ds_read_b64_tr_b16 v[246:247], v15 offset:22528
Mvva 164,220,184
v_and_b32 v73, 0xffff0000, v33
v_sub_f32_e64 v66, v66, v40
Mvva 180,208,164
s_waitcnt vmcnt(25)
s_add_u32 m0, s44, 16384
ds_read_b64_tr_b16 v[248:249], v15 offset:24576
ds_read_b64_tr_b16 v[250:251], v15 offset:26624
Mvva 180,212,172
buffer_load_dwordx4 v114, s[12:15], s48 offen offset:0 lds
Mvva 180,216,180
s_barrier
ds_read_b64_tr_b16 v[252:253], v15 offset:28672
ds_read_b64_tr_b16 v[254:255], v15 offset:30720
Mvva 180,220,188
buffer_load_dwordx4 v114, s[12:15], s49 offen offset:1024 lds
Mvva 168,224,160
ds_read_b64_tr_b16 v[192:193], v12 offset:32768
ds_read_b64_tr_b16 v[194:195], v12 offset:34816
Mvva 168,228,168
buffer_load_dwordx4 v114, s[12:15], s50 offen offset:2048 lds
Mvva 168,232,176
ds_read_b64_tr_b16 v[196:197], v12 offset:36864
ds_read_b64_tr_b16 v[198:199], v12 offset:38912
Mvva 168,236,184
Vs 67,67,40
Vs 68,68,40
Mvva 184,224,164
s_waitcnt lgkmcnt(4)
ds_read_b64_tr_b16 v[200:201], v12 offset:40960
ds_read_b64_tr_b16 v[202:203], v12 offset:43008
Mvva 184,228,172
buffer_load_dwordx4 v114, s[12:15], s51 offen offset:3072 lds
v_add_u32 v114, 262144, v114
Mvva 184,232,180
s_add_u32 m0, s44, 32768
ds_read_b64_tr_b16 v[204:205], v12 offset:45056
ds_read_b64_tr_b16 v[206:207], v12 offset:47104
Mvva 184,236,188
buffer_load_dwordx4 v114, s[12:15], s48 offen offset:0 lds
Mvva 172,240,160
ds_read_b64_tr_b16 v[208:209], v13 offset:32768
ds_read_b64_tr_b16 v[210:211], v13 offset:34816
Mvva 172,244,168
buffer_load_dwordx4 v114, s[12:15], s49 offen offset:1024 lds
Mvva 172,248,176
ds_read_b64_tr_b16 v[212:213], v13 offset:36864
ds_read_b64_tr_b16 v[214:215], v13 offset:38912
Mvva 172,252,184
Vs 69,69,40
v_sub_f32_e64 v70, v70, v40
Mvva 188,240,164
s_waitcnt lgkmcnt(4)
ds_read_b64_tr_b16 v[216:217], v13 offset:40960
ds_read_b64_tr_b16 v[218:219], v13 offset:43008
Mvva 188,244,172
buffer_load_dwordx4 v114, s[12:15], s50 offen offset:2048 lds
Mvva 188,248,180
s_waitcnt vmcnt(24)
ds_read_b64_tr_b16 v[220:221], v13 offset:45056
ds_read_b64_tr_b16 v[222:223], v13 offset:47104
Mvva 188,252,188
buffer_load_dwordx4 v114, s[12:15], s51 offen offset:3072 lds
v_add_u32 v114, 262144, v114
Mvva 160,192,192
ds_read_b64_tr_b16 v[224:225], v14 offset:32768
ds_read_b64_tr_b16 v[226:227], v14 offset:34816
Mvva 160,196,200
Vs 71,71,40
Vs 72,72,40
Mvva 160,200,208
s_add_u32 m0, s44, 49152
ds_read_b64_tr_b16 v[228:229], v14 offset:36864
ds_read_b64_tr_b16 v[230:231], v14 offset:38912
Mvva 160,204,216
buffer_load_dwordx4 v114, s[12:15], s48 offen offset:0 lds
Mvva 176,192,196
s_waitcnt lgkmcnt(4)
ds_read_b64_tr_b16 v[232:233], v14 offset:40960
ds_read_b64_tr_b16 v[234:235], v14 offset:43008
Mvva 176,196,204
Vs 73,73,40
Vc 2,66,67
Mvva 176,200,212
ds_read_b64_tr_b16 v[236:237], v14 offset:45056
ds_read_b64_tr_b16 v[238:239], v14 offset:47104
Mvva 176,204,220
buffer_load_dwordx4 v114, s[12:15], s49 offen offset:1024 lds
Mvva 164,208,192
ds_read_b64_tr_b16 v[240:241], v15 offset:32768
ds_read_b64_tr_b16 v[242:243], v15 offset:34816
Mvva 164,212,200
v_lshlrev_b32_e64 v66, 16, v2
v_and_b32 v67, 0xffff0000, v2
Mvva 164,216,208
s_waitcnt lgkmcnt(2)
ds_read_b64_tr_b16 v[244:245], v15 offset:36864
ds_read_b64_tr_b16 v[246:247], v15 offset:38912
Mvva 164,220,216
buffer_load_dwordx4 v114, s[12:15], s50 offen offset:2048 lds
Mvva 180,208,196
s_waitcnt vmcnt(24)
ds_read_b64_tr_b16 v[248:249], v15 offset:40960
ds_read_b64_tr_b16 v[250:251], v15 offset:43008
Mvva 180,212,204
Vc 3,68,69
v_lshlrev_b32_e64 v68, 16, v3
Mvva 180,216,212
s_barrier
ds_read_b64_tr_b16 v[252:253], v15 offset:45056
ds_read_b64_tr_b16 v[254:255], v15 offset:47104
Mvva 180,220,220
buffer_load_dwordx4 v114, s[12:15], s51 offen offset:3072 lds
v_add_u32 v114, 262144, v114
Mvva 168,224,192
ds_read_b64_tr_b16 v[192:193], v12 offset:49152
ds_read_b64_tr_b16 v[194:195], v12 offset:51200
Mvva 168,228,200
v_and_b32 v69, 0xffff0000, v3
Vc 4,70,71
Mvva 168,232,208
s_add_u32 m0, s44, 65536
ds_read_b64_tr_b16 v[196:197], v12 offset:53248
ds_read_b64_tr_b16 v[198:199], v12 offset:55296
Mvva 168,236,216
buffer_load_dwordx4 v114, s[12:15], s48 offen offset:0 lds
Mvva 184,224,196
s_waitcnt lgkmcnt(4)
ds_read_b64_tr_b16 v[200:201], v12 offset:57344
ds_read_b64_tr_b16 v[202:203], v12 offset:59392
Mvva 184,228,204
v_lshlrev_b32_e64 v70, 16, v4
v_and_b32 v71, 0xffff0000, v4
Mvva 184,232,212
ds_read_b64_tr_b16 v[204:205], v12 offset:61440
ds_read_b64_tr_b16 v[206:207], v12 offset:63488
Mvva 184,236,220
buffer_load_dwordx4 v114, s[12:15], s49 offen offset:1024 lds
Mvva 172,240,192
ds_read_b64_tr_b16 v[208:209], v13 offset:49152
ds_read_b64_tr_b16 v[210:211], v13 offset:51200
Mvva 172,244,200
Vc 5,72,73
v_lshlrev_b32_e64 v72, 16, v5
Mvva 172,248,208
ds_read_b64_tr_b16 v[212:213], v13 offset:53248
ds_read_b64_tr_b16 v[214:215], v13 offset:55296
Mvva 172,252,216
buffer_load_dwordx4 v114, s[12:15], s50 offen offset:2048 lds
Mvva 188,240,196
s_waitcnt lgkmcnt(4)
ds_read_b64_tr_b16 v[216:217], v13 offset:57344
ds_read_b64_tr_b16 v[218:219], v13 offset:59392
Mvva 188,244,204
v_and_b32 v73, 0xffff0000, v5
Vm 66,66,41
Mvva 188,248,212
s_waitcnt vmcnt(19)
ds_read_b64_tr_b16 v[220:221], v13 offset:61440
ds_read_b64_tr_b16 v[222:223], v13 offset:63488
Mvva 188,252,220
buffer_load_dwordx4 v114, s[12:15], s51 offen offset:3072 lds
v_add_u32 v114, 262144, v114
Mvva 160,192,224
ds_read_b64_tr_b16 v[224:225], v14 offset:49152
ds_read_b64_tr_b16 v[226:227], v14 offset:51200
Mvva 160,196,232
Vm 67,67,41
v_mul_f32_e64 v68, v68, v41
Mvva 160,200,240
ds_read_b64_tr_b16 v[228:229], v14 offset:53248
ds_read_b64_tr_b16 v[230:231], v14 offset:55296
Mvva 160,204,248
Vm 69,69,41
Vm 70,70,41
Mvva 176,192,228
s_waitcnt lgkmcnt(4)
s_add_u32 m0, s44, 81920
ds_read_b64_tr_b16 v[232:233], v14 offset:57344
ds_read_b64_tr_b16 v[234:235], v14 offset:59392
Mvva 176,196,236
buffer_load_dwordx4 v114, s[12:15], s48 offen offset:0 lds
Mvva 176,200,244
ds_read_b64_tr_b16 v[236:237], v14 offset:61440
ds_read_b64_tr_b16 v[238:239], v14 offset:63488
Mvva 176,204,252
Vm 71,71,41
v_mul_f32_e64 v72, v72, v41
Mvva 164,208,224
ds_read_b64_tr_b16 v[240:241], v15 offset:49152
ds_read_b64_tr_b16 v[242:243], v15 offset:51200
Mvva 164,212,232
v_mul_f32_e64 v73, v73, v41
Vc 2,66,67
Mvva 164,216,240
s_waitcnt lgkmcnt(2)
ds_read_b64_tr_b16 v[244:245], v15 offset:53248
ds_read_b64_tr_b16 v[246:247], v15 offset:55296
Mvva 164,220,248
v_lshlrev_b32 v66, 16, v2
v_and_b32 v67, 0xffff0000, v2
Mvva 180,208,228
s_waitcnt vmcnt(17)
ds_read_b64_tr_b16 v[248:249], v15 offset:57344
ds_read_b64_tr_b16 v[250:251], v15 offset:59392
Mvva 180,212,236
buffer_load_dwordx4 v114, s[12:15], s49 offen offset:1024 lds
Mvva 180,216,244
s_barrier
ds_read_b64_tr_b16 v[252:253], v15 offset:61440
ds_read_b64_tr_b16 v[254:255], v15 offset:63488
Mvva 180,220,252
Vc 3,68,69
v_lshlrev_b32_e64 v68, 16, v3
Mvva 168,224,224
ds_read_b64_tr_b16 v[192:193], v115 offset:0
ds_read_b64_tr_b16 v[194:195], v115 offset:2048
Mvva 168,228,232
v_and_b32 v69, 0xffff0000, v3
Vc 4,70,71
Mvva 168,232,240
ds_read_b64_tr_b16 v[196:197], v115 offset:4096
ds_read_b64_tr_b16 v[198:199], v115 offset:6144
Mvva 168,236,248
v_lshlrev_b32_e64 v70, 16, v4
v_and_b32 v71, 0xffff0000, v4
Mvva 184,224,228
s_waitcnt lgkmcnt(4)
ds_read_b64_tr_b16 v[200:201], v115 offset:8192
ds_read_b64_tr_b16 v[202:203], v115 offset:10240
Mvva 184,228,236
buffer_load_dwordx4 v114, s[12:15], s50 offen offset:2048 lds
Mvva 184,232,244
ds_read_b64_tr_b16 v[204:205], v115 offset:12288
ds_read_b64_tr_b16 v[206:207], v115 offset:14336
Mvva 184,236,252
Vc 5,72,73
v_lshlrev_b32 v72, 16, v5
Mvva 172,240,224
ds_read_b64_tr_b16 v[208:209], v116 offset:0
ds_read_b64_tr_b16 v[210:211], v116 offset:2048
Mvva 172,244,232
v_and_b32 v73, 0xffff0000, v5
v_mul_f32 v2, 0xbfb8aa3b, v66
Mvva 172,248,240
ds_read_b64_tr_b16 v[212:213], v116 offset:4096
ds_read_b64_tr_b16 v[214:215], v116 offset:6144
Mvva 172,252,248
v_mul_f32 v3, 0xbfb8aa3b, v67
v_mul_f32 v4, 0xbfb8aa3b, v68
Mvva 188,240,228
s_waitcnt lgkmcnt(4)
ds_read_b64_tr_b16 v[216:217], v116 offset:8192
ds_read_b64_tr_b16 v[218:219], v116 offset:10240
Mvva 188,244,236
buffer_load_dwordx4 v114, s[12:15], s51 offen offset:3072 lds
v_add_u32 v114, 262144, v114
Mvva 188,248,244
ds_read_b64_tr_b16 v[220:221], v116 offset:12288
ds_read_b64_tr_b16 v[222:223], v116 offset:14336
Mvva 188,252,252
v_mul_f32 v5, 0xbfb8aa3b, v69
v_mul_f32 v6, 0xbfb8aa3b, v70
Mvva 128,192,0
ds_read_b64_tr_b16 v[224:225], v117 offset:0
ds_read_b64_tr_b16 v[226:227], v117 offset:2048
Mvva 128,196,8
v_mul_f32 v7, 0xbfb8aa3b, v71
v_mul_f32 v8, 0xbfb8aa3b, v72
Mvva 128,200,16
ds_read_b64_tr_b16 v[228:229], v117 offset:4096
ds_read_b64_tr_b16 v[230:231], v117 offset:6144
Mvva 128,204,24
v_mul_f32 v9, 0xbfb8aa3b, v73
Mvva 144,192,4
s_waitcnt lgkmcnt(4)
s_add_u32 m0, s44, 98304
ds_read_b64_tr_b16 v[232:233], v117 offset:8192
ds_read_b64_tr_b16 v[234:235], v117 offset:10240
Mvva 144,196,12
buffer_load_dwordx4 v114, s[12:15], s48 offen offset:0 lds
Mvva 144,200,20
ds_read_b64_tr_b16 v[236:237], v117 offset:12288
ds_read_b64_tr_b16 v[238:239], v117 offset:14336
Mvva 144,204,28
v_add_u32 v10, 4096, v112
Mvva 132,208,0
ds_read_b64_tr_b16 v[240:241], v118 offset:0
ds_read_b64_tr_b16 v[242:243], v118 offset:2048
Mvva 132,212,8
buffer_store_dwordx4 v[160:163], v112, s[16:19], s26 offen offset:0 sc1
Mvva 132,216,16
s_waitcnt lgkmcnt(2)
ds_read_b64_tr_b16 v[244:245], v118 offset:4096
ds_read_b64_tr_b16 v[246:247], v118 offset:6144
Mvva 132,220,24
buffer_store_dwordx4 v[164:167], v112, s[16:19], s26 offen offset:1024 sc1
Mvva 148,208,4
s_waitcnt vmcnt(19)
ds_read_b64_tr_b16 v[248:249], v118 offset:8192
ds_read_b64_tr_b16 v[250:251], v118 offset:10240
Mvva 148,212,12
buffer_load_dwordx4 v114, s[12:15], s49 offen offset:1024 lds
Mvva 148,216,20
s_barrier
ds_read_b64_tr_b16 v[252:253], v118 offset:12288
ds_read_b64_tr_b16 v[254:255], v118 offset:14336
Mvva 148,220,28
buffer_store_dwordx4 v[168:171], v112, s[16:19], s26 offen offset:2048 sc1
Mvva 136,224,0
ds_read_b64_tr_b16 v[192:193], v115 offset:16384
ds_read_b64_tr_b16 v[194:195], v115 offset:18432
Mvva 136,228,8
buffer_store_dwordx4 v[172:175], v112, s[16:19], s26 offen offset:3072 sc1
Mvva 136,232,16
ds_read_b64_tr_b16 v[196:197], v115 offset:20480
ds_read_b64_tr_b16 v[198:199], v115 offset:22528
Mvva 136,236,24
buffer_store_dwordx4 v[176:179], v10, s[16:19], s26 offen offset:0 sc1
Mvva 152,224,4
s_waitcnt lgkmcnt(4)
ds_read_b64_tr_b16 v[200:201], v115 offset:24576
ds_read_b64_tr_b16 v[202:203], v115 offset:26624
Mvva 152,228,12
buffer_load_dwordx4 v114, s[12:15], s50 offen offset:2048 lds
Mvva 152,232,20
ds_read_b64_tr_b16 v[204:205], v115 offset:28672
ds_read_b64_tr_b16 v[206:207], v115 offset:30720
Mvva 152,236,28
buffer_store_dwordx4 v[180:183], v10, s[16:19], s26 offen offset:1024 sc1
Mvva 140,240,0
ds_read_b64_tr_b16 v[208:209], v116 offset:16384
ds_read_b64_tr_b16 v[210:211], v116 offset:18432
Mvva 140,244,8
buffer_store_dwordx4 v[184:187], v10, s[16:19], s26 offen offset:2048 sc1
Mvva 140,248,16
ds_read_b64_tr_b16 v[212:213], v116 offset:20480
ds_read_b64_tr_b16 v[214:215], v116 offset:22528
Mvva 140,252,24
buffer_store_dwordx4 v[188:191], v10, s[16:19], s26 offen offset:3072 sc1
Mvva 156,240,4
s_waitcnt lgkmcnt(4)
ds_read_b64_tr_b16 v[216:217], v116 offset:24576
ds_read_b64_tr_b16 v[218:219], v116 offset:26624
Mvva 156,244,12
buffer_load_dwordx4 v114, s[12:15], s51 offen offset:3072 lds
v_add_u32 v114, 262144, v114
Mvva 156,248,20
ds_read_b64_tr_b16 v[220:221], v116 offset:28672
ds_read_b64_tr_b16 v[222:223], v116 offset:30720
Mvva 156,252,28
v_mov_b32 v16, 1
Mvva 128,192,32
ds_read_b64_tr_b16 v[224:225], v117 offset:16384
ds_read_b64_tr_b16 v[226:227], v117 offset:18432
Mvva 128,196,40
VE 2,2
Mvva 128,200,48
ds_read_b64_tr_b16 v[228:229], v117 offset:20480
ds_read_b64_tr_b16 v[230:231], v117 offset:22528
Mvva 128,204,56
VE 3,3
Mvva 144,192,36
s_waitcnt lgkmcnt(4)
s_add_u32 m0, s44, 114688
ds_read_b64_tr_b16 v[232:233], v117 offset:24576
ds_read_b64_tr_b16 v[234:235], v117 offset:26624
Mvva 144,196,44
buffer_load_dwordx4 v114, s[12:15], s48 offen offset:0 lds
Mvva 144,200,52
ds_read_b64_tr_b16 v[236:237], v117 offset:28672
ds_read_b64_tr_b16 v[238:239], v117 offset:30720
Mvva 144,204,60
Ve 4,4
Mvva 132,208,32
ds_read_b64_tr_b16 v[240:241], v118 offset:16384
ds_read_b64_tr_b16 v[242:243], v118 offset:18432
Mvva 132,212,40
VE 5,5
Mvva 132,216,48
s_waitcnt lgkmcnt(2)
ds_read_b64_tr_b16 v[244:245], v118 offset:20480
ds_read_b64_tr_b16 v[246:247], v118 offset:22528
Mvva 132,220,56
Ve 6,6
Mvva 148,208,36
s_waitcnt vmcnt(25)
ds_read_b64_tr_b16 v[248:249], v118 offset:24576
ds_read_b64_tr_b16 v[250:251], v118 offset:26624
Mvva 148,212,44
buffer_load_dwordx4 v114, s[12:15], s49 offen offset:1024 lds
Mvva 148,216,52
s_barrier
ds_read_b64_tr_b16 v[252:253], v118 offset:28672
ds_read_b64_tr_b16 v[254:255], v118 offset:30720
Mvva 148,220,60
VE 7,7
Mvva 136,224,32
ds_read_b64_tr_b16 v[192:193], v115 offset:32768
ds_read_b64_tr_b16 v[194:195], v115 offset:34816
Mvva 136,228,40
s_cmp_lg_u32 s53, 0
s_cbranch_scc1 L_yA
L_yAr:
Mvva 136,232,48
ds_read_b64_tr_b16 v[196:197], v115 offset:36864
ds_read_b64_tr_b16 v[198:199], v115 offset:38912
Mvva 136,236,56
VE 8,8
Mvva 152,224,36
s_waitcnt lgkmcnt(4)
ds_read_b64_tr_b16 v[200:201], v115 offset:40960
ds_read_b64_tr_b16 v[202:203], v115 offset:43008
Mvva 152,228,44
buffer_load_dwordx4 v114, s[12:15], s50 offen offset:2048 lds
Mvva 152,232,52
ds_read_b64_tr_b16 v[204:205], v115 offset:45056
ds_read_b64_tr_b16 v[206:207], v115 offset:47104
Mvva 152,236,60
Ve 9,9
Mvva 140,240,32
ds_read_b64_tr_b16 v[208:209], v116 offset:32768
ds_read_b64_tr_b16 v[210:211], v116 offset:34816
Mvva 140,244,40
v_add_f32 v2, 1.0, v2
v_add_f32 v3, 1.0, v3
Mvva 140,248,48
ds_read_b64_tr_b16 v[212:213], v116 offset:36864
ds_read_b64_tr_b16 v[214:215], v116 offset:38912
Mvva 140,252,56
v_add_f32 v4, 1.0, v4
v_add_f32 v5, 1.0, v5
Mvva 156,240,36
s_waitcnt lgkmcnt(4)
ds_read_b64_tr_b16 v[216:217], v116 offset:40960
ds_read_b64_tr_b16 v[218:219], v116 offset:43008
Mvva 156,244,44
buffer_load_dwordx4 v114, s[12:15], s51 offen offset:3072 lds
v_add_u32 v114, 262144, v114
Mvva 156,248,52
ds_read_b64_tr_b16 v[220:221], v116 offset:45056
ds_read_b64_tr_b16 v[222:223], v116 offset:47104
Mvva 156,252,60
v_add_f32 v6, 1.0, v6
v_add_f32_e64 v7, 1.0, v7
Mvva 128,192,64
ds_read_b64_tr_b16 v[224:225], v117 offset:32768
ds_read_b64_tr_b16 v[226:227], v117 offset:34816
Mvva 128,196,72
v_add_f32 v8, 1.0, v8
v_add_f32 v9, 1.0, v9
Mvva 128,200,80
ds_read_b64_tr_b16 v[228:229], v117 offset:36864
ds_read_b64_tr_b16 v[230:231], v117 offset:38912
Mvva 128,204,88
v_rcp_f32_e64 v2, v2
Mvva 144,192,68
s_waitcnt lgkmcnt(4)
ds_read_b64_tr_b16 v[232:233], v117 offset:40960
ds_read_b64_tr_b16 v[234:235], v117 offset:43008
Mvva 144,196,76
v_rcp_f32 v3, v3
Mvva 144,200,84
ds_read_b64_tr_b16 v[236:237], v117 offset:45056
ds_read_b64_tr_b16 v[238:239], v117 offset:47104
Mvva 144,204,92
v_rcp_f32_e64 v4, v4
Mvva 132,208,64
ds_read_b64_tr_b16 v[240:241], v118 offset:32768
ds_read_b64_tr_b16 v[242:243], v118 offset:34816
Mvva 132,212,72
v_rcp_f32_e64 v5, v5
Mvva 132,216,80
s_waitcnt lgkmcnt(2)
ds_read_b64_tr_b16 v[244:245], v118 offset:36864
ds_read_b64_tr_b16 v[246:247], v118 offset:38912
Mvva 132,220,88
v_rcp_f32 v6, v6
Mvva 148,208,68
s_waitcnt vmcnt(24)
ds_read_b64_tr_b16 v[248:249], v118 offset:40960
ds_read_b64_tr_b16 v[250:251], v118 offset:43008
Mvva 148,212,76
v_rcp_f32 v7, v7
Mvva 148,216,84
s_barrier
ds_read_b64_tr_b16 v[252:253], v118 offset:45056
ds_read_b64_tr_b16 v[254:255], v118 offset:47104
Mvva 148,220,92
v_rcp_f32 v8, v8
Mvva 136,224,64
ds_read_b64_tr_b16 v[192:193], v115 offset:49152
ds_read_b64_tr_b16 v[194:195], v115 offset:51200
Mvva 136,228,72
v_rcp_f32_e64 v9, v9
Mvva 136,232,80
ds_read_b64_tr_b16 v[196:197], v115 offset:53248
ds_read_b64_tr_b16 v[198:199], v115 offset:55296
Mvva 136,236,88
Vm 66,66,2
Vm 67,67,3
Mvva 152,224,68
s_waitcnt lgkmcnt(4)
ds_read_b64_tr_b16 v[200:201], v115 offset:57344
ds_read_b64_tr_b16 v[202:203], v115 offset:59392
Mvva 152,228,76
Vm 68,68,4
v_mul_f32_e64 v69, v69, v5
Mvva 152,232,84
ds_read_b64_tr_b16 v[204:205], v115 offset:61440
ds_read_b64_tr_b16 v[206:207], v115 offset:63488
Mvva 152,236,92
Vm 70,70,6
Vm 71,71,7
Mvva 140,240,64
ds_read_b64_tr_b16 v[208:209], v116 offset:49152
ds_read_b64_tr_b16 v[210:211], v116 offset:51200
Mvva 140,244,72
Vm 72,72,8
Vm 73,73,9
Mvva 140,248,80
ds_read_b64_tr_b16 v[212:213], v116 offset:53248
ds_read_b64_tr_b16 v[214:215], v116 offset:55296
Mvva 140,252,88
Vc 2,66,67
v_lshlrev_b32_e64 v66, 16, v2
Mvva 156,240,68
s_waitcnt lgkmcnt(4)
ds_read_b64_tr_b16 v[216:217], v116 offset:57344
ds_read_b64_tr_b16 v[218:219], v116 offset:59392
Mvva 156,244,76
v_and_b32 v67, 0xffff0000, v2
Vc 3,68,69
Mvva 156,248,84
ds_read_b64_tr_b16 v[220:221], v116 offset:61440
ds_read_b64_tr_b16 v[222:223], v116 offset:63488
Mvva 156,252,92
v_lshlrev_b32 v68, 16, v3
v_and_b32 v69, 0xffff0000, v3
Mvva 128,192,96
ds_read_b64_tr_b16 v[224:225], v117 offset:49152
ds_read_b64_tr_b16 v[226:227], v117 offset:51200
Mvva 128,196,104
Vc 4,70,71
v_lshlrev_b32_e64 v70, 16, v4
Mvva 128,200,112
ds_read_b64_tr_b16 v[228:229], v117 offset:53248
ds_read_b64_tr_b16 v[230:231], v117 offset:55296
Mvva 128,204,120
v_and_b32 v71, 0xffff0000, v4
Vc 5,72,73
Mvva 144,192,100
s_waitcnt lgkmcnt(4)
ds_read_b64_tr_b16 v[232:233], v117 offset:57344
ds_read_b64_tr_b16 v[234:235], v117 offset:59392
Mvva 144,196,108
v_lshlrev_b32 v72, 16, v5
v_and_b32 v73, 0xffff0000, v5
Mvva 144,200,116
ds_read_b64_tr_b16 v[236:237], v117 offset:61440
ds_read_b64_tr_b16 v[238:239], v117 offset:63488
Mvva 144,204,124
s_waitcnt vmcnt(5)
s_mov_b64 exec, 1
buffer_store_dword v16, v126, s[20:23], s27 offen sc1
s_mov_b64 exec, -1
Mvva 132,208,96
ds_read_b64_tr_b16 v[240:241], v118 offset:49152
ds_read_b64_tr_b16 v[242:243], v118 offset:51200
Mvva 132,212,104
Mvva 132,216,112
s_waitcnt lgkmcnt(2)
ds_read_b64_tr_b16 v[244:245], v118 offset:53248
ds_read_b64_tr_b16 v[246:247], v118 offset:55296
Mvva 132,220,120
Mvva 148,208,100
ds_read_b64_tr_b16 v[248:249], v118 offset:57344
ds_read_b64_tr_b16 v[250:251], v118 offset:59392
Mvva 148,212,108
Mvva 148,216,116
s_barrier
ds_read_b64_tr_b16 v[252:253], v118 offset:61440
ds_read_b64_tr_b16 v[254:255], v118 offset:63488
Mvva 148,220,124
Mvva 136,224,96
ds_read_b64_tr_b16 v[192:193], v12 offset:0
ds_read_b64_tr_b16 v[194:195], v12 offset:2048
Mvva 136,228,104
Mvva 136,232,112
ds_read_b64_tr_b16 v[196:197], v12 offset:4096
ds_read_b64_tr_b16 v[198:199], v12 offset:6144
Mvva 136,236,120
Mvva 152,224,100
s_waitcnt lgkmcnt(4)
ds_read_b64_tr_b16 v[200:201], v12 offset:8192
ds_read_b64_tr_b16 v[202:203], v12 offset:10240
Mvva 152,228,108
Mvva 152,232,116
ds_read_b64_tr_b16 v[204:205], v12 offset:12288
ds_read_b64_tr_b16 v[206:207], v12 offset:14336
Mvva 152,236,124
s_cmp_lg_u32 s53, 0
s_cbranch_scc1 L_yB
L_yBr:
Mvva 140,240,96
ds_read_b64_tr_b16 v[208:209], v13 offset:0
ds_read_b64_tr_b16 v[210:211], v13 offset:2048
Mvva 140,244,104
Mvva 140,248,112
ds_read_b64_tr_b16 v[212:213], v13 offset:4096
ds_read_b64_tr_b16 v[214:215], v13 offset:6144
Mvva 140,252,120
Mvva 156,240,100
s_waitcnt lgkmcnt(4)
ds_read_b64_tr_b16 v[216:217], v13 offset:8192
ds_read_b64_tr_b16 v[218:219], v13 offset:10240
Mvva 156,244,108
Mvva 156,248,116
ds_read_b64_tr_b16 v[220:221], v13 offset:12288
ds_read_b64_tr_b16 v[222:223], v13 offset:14336
Mvva 156,252,124
Mvva 128,192,128
ds_read_b64_tr_b16 v[224:225], v14 offset:0
ds_read_b64_tr_b16 v[226:227], v14 offset:2048
Mvva 128,196,136
Mvva 128,200,144
ds_read_b64_tr_b16 v[228:229], v14 offset:4096
ds_read_b64_tr_b16 v[230:231], v14 offset:6144
Mvva 128,204,152
Mvva 144,192,132
s_waitcnt lgkmcnt(4)
ds_read_b64_tr_b16 v[232:233], v14 offset:8192
ds_read_b64_tr_b16 v[234:235], v14 offset:10240
Mvva 144,196,140
Mvva 144,200,148
ds_read_b64_tr_b16 v[236:237], v14 offset:12288
ds_read_b64_tr_b16 v[238:239], v14 offset:14336
Mvva 144,204,156
Mvva 132,208,128
ds_read_b64_tr_b16 v[240:241], v15 offset:0
ds_read_b64_tr_b16 v[242:243], v15 offset:2048
Mvva 132,212,136
Mvva 132,216,144
s_waitcnt lgkmcnt(2)
ds_read_b64_tr_b16 v[244:245], v15 offset:4096
ds_read_b64_tr_b16 v[246:247], v15 offset:6144
Mvva 132,220,152
Mvva 148,208,132
ds_read_b64_tr_b16 v[248:249], v15 offset:8192
ds_read_b64_tr_b16 v[250:251], v15 offset:10240
Mvva 148,212,140
Mvva 148,216,148
s_barrier
ds_read_b64_tr_b16 v[252:253], v15 offset:12288
ds_read_b64_tr_b16 v[254:255], v15 offset:14336
Mvva 148,220,156
Mvva 136,224,128
ds_read_b64_tr_b16 v[192:193], v12 offset:16384
ds_read_b64_tr_b16 v[194:195], v12 offset:18432
Mvva 136,228,136
Mvva 136,232,144
ds_read_b64_tr_b16 v[196:197], v12 offset:20480
ds_read_b64_tr_b16 v[198:199], v12 offset:22528
Mvva 136,236,152
Mvva 152,224,132
s_waitcnt lgkmcnt(4)
ds_read_b64_tr_b16 v[200:201], v12 offset:24576
ds_read_b64_tr_b16 v[202:203], v12 offset:26624
Mvva 152,228,140
buffer_load_dword v17, v126, s[20:23], s24 offen sc1
Mvva 152,232,148
ds_read_b64_tr_b16 v[204:205], v12 offset:28672
ds_read_b64_tr_b16 v[206:207], v12 offset:30720
Mvva 152,236,156
Mvva 140,240,128
ds_read_b64_tr_b16 v[208:209], v13 offset:16384
ds_read_b64_tr_b16 v[210:211], v13 offset:18432
Mvva 140,244,136
Mvva 140,248,144
ds_read_b64_tr_b16 v[212:213], v13 offset:20480
ds_read_b64_tr_b16 v[214:215], v13 offset:22528
Mvva 140,252,152
Mvva 156,240,132
s_waitcnt lgkmcnt(4)
ds_read_b64_tr_b16 v[216:217], v13 offset:24576
ds_read_b64_tr_b16 v[218:219], v13 offset:26624
Mvva 156,244,140
Mvva 156,248,148
ds_read_b64_tr_b16 v[220:221], v13 offset:28672
ds_read_b64_tr_b16 v[222:223], v13 offset:30720
Mvva 156,252,156
Mvva 128,192,160
ds_read_b64_tr_b16 v[224:225], v14 offset:16384
ds_read_b64_tr_b16 v[226:227], v14 offset:18432
Mvva 128,196,168
Mvva 128,200,176
ds_read_b64_tr_b16 v[228:229], v14 offset:20480
ds_read_b64_tr_b16 v[230:231], v14 offset:22528
Mvva 128,204,184
Mvva 144,192,164
s_waitcnt lgkmcnt(4)
ds_read_b64_tr_b16 v[232:233], v14 offset:24576
ds_read_b64_tr_b16 v[234:235], v14 offset:26624
Mvva 144,196,172
Mvva 144,200,180
ds_read_b64_tr_b16 v[236:237], v14 offset:28672
ds_read_b64_tr_b16 v[238:239], v14 offset:30720
Mvva 144,204,188
Mvva 132,208,160
ds_read_b64_tr_b16 v[240:241], v15 offset:16384
ds_read_b64_tr_b16 v[242:243], v15 offset:18432
Mvva 132,212,168
Mvva 132,216,176
s_waitcnt lgkmcnt(2)
ds_read_b64_tr_b16 v[244:245], v15 offset:20480
ds_read_b64_tr_b16 v[246:247], v15 offset:22528
Mvva 132,220,184
Mvva 148,208,164
s_waitcnt vmcnt(6)
ds_read_b64_tr_b16 v[248:249], v15 offset:24576
ds_read_b64_tr_b16 v[250:251], v15 offset:26624
Mvva 148,212,172
Mvva 148,216,180
s_barrier
ds_read_b64_tr_b16 v[252:253], v15 offset:28672
ds_read_b64_tr_b16 v[254:255], v15 offset:30720
Mvva 148,220,188
Mvva 136,224,160
ds_read_b64_tr_b16 v[192:193], v12 offset:32768
ds_read_b64_tr_b16 v[194:195], v12 offset:34816
Mvva 136,228,168
s_cmp_lg_u32 s40, 0
s_cbranch_scc1 L_yC
L_yCr:
Mvva 136,232,176
ds_read_b64_tr_b16 v[196:197], v12 offset:36864
ds_read_b64_tr_b16 v[198:199], v12 offset:38912
Mvva 136,236,184
Mvva 152,224,164
s_waitcnt lgkmcnt(4)
ds_read_b64_tr_b16 v[200:201], v12 offset:40960
ds_read_b64_tr_b16 v[202:203], v12 offset:43008
Mvva 152,228,172
Mvva 152,232,180
ds_read_b64_tr_b16 v[204:205], v12 offset:45056
ds_read_b64_tr_b16 v[206:207], v12 offset:47104
Mvva 152,236,188
Mvva 140,240,160
ds_read_b64_tr_b16 v[208:209], v13 offset:32768
ds_read_b64_tr_b16 v[210:211], v13 offset:34816
Mvva 140,244,168
Mvva 140,248,176
ds_read_b64_tr_b16 v[212:213], v13 offset:36864
ds_read_b64_tr_b16 v[214:215], v13 offset:38912
Mvva 140,252,184
s_waitcnt vmcnt(0)
v_cmp_ne_u32 vcc, 1, v17
s_mov_b32 s33, 0
s_cbranch_vccnz L_xno
s_nop 0
buffer_load_dwordx4 v[160:163], v112, s[16:19], s25 offen offset:0 sc1
buffer_load_dwordx4 v[164:167], v112, s[16:19], s25 offen offset:1024 sc1
buffer_load_dwordx4 v[168:171], v112, s[16:19], s25 offen offset:2048 sc1
buffer_load_dwordx4 v[172:175], v112, s[16:19], s25 offen offset:3072 sc1
buffer_load_dwordx4 v[176:179], v10, s[16:19], s25 offen offset:0 sc1
buffer_load_dwordx4 v[180:183], v10, s[16:19], s25 offen offset:1024 sc1
buffer_load_dwordx4 v[184:187], v10, s[16:19], s25 offen offset:2048 sc1
buffer_load_dwordx4 v[188:191], v10, s[16:19], s25 offen offset:3072 sc1
s_mov_b32 s33, 1
L_xno:
Mvva 156,240,164
s_waitcnt lgkmcnt(4)
ds_read_b64_tr_b16 v[216:217], v13 offset:40960
ds_read_b64_tr_b16 v[218:219], v13 offset:43008
Mvva 156,244,172
Mvva 156,248,180
ds_read_b64_tr_b16 v[220:221], v13 offset:45056
ds_read_b64_tr_b16 v[222:223], v13 offset:47104
Mvva 156,252,188
Mvva 128,192,192
ds_read_b64_tr_b16 v[224:225], v14 offset:32768
ds_read_b64_tr_b16 v[226:227], v14 offset:34816
Mvva 128,196,200
Mvva 128,200,208
ds_read_b64_tr_b16 v[228:229], v14 offset:36864
ds_read_b64_tr_b16 v[230:231], v14 offset:38912
Mvva 128,204,216
Mvva 144,192,196
s_waitcnt lgkmcnt(4)
ds_read_b64_tr_b16 v[232:233], v14 offset:40960
ds_read_b64_tr_b16 v[234:235], v14 offset:43008
Mvva 144,196,204
Mvva 144,200,212
ds_read_b64_tr_b16 v[236:237], v14 offset:45056
ds_read_b64_tr_b16 v[238:239], v14 offset:47104
Mvva 144,204,220
Mvva 132,208,192
ds_read_b64_tr_b16 v[240:241], v15 offset:32768
ds_read_b64_tr_b16 v[242:243], v15 offset:34816
Mvva 132,212,200
Mvva 132,216,208
s_waitcnt lgkmcnt(2)
ds_read_b64_tr_b16 v[244:245], v15 offset:36864
ds_read_b64_tr_b16 v[246:247], v15 offset:38912
Mvva 132,220,216
Mvva 148,208,196
ds_read_b64_tr_b16 v[248:249], v15 offset:40960
ds_read_b64_tr_b16 v[250:251], v15 offset:43008
Mvva 148,212,204
Mvva 148,216,212
s_barrier
ds_read_b64_tr_b16 v[252:253], v15 offset:45056
ds_read_b64_tr_b16 v[254:255], v15 offset:47104
Mvva 148,220,220
Mvva 136,224,192
ds_read_b64_tr_b16 v[192:193], v12 offset:49152
ds_read_b64_tr_b16 v[194:195], v12 offset:51200
Mvva 136,228,200
Mvva 136,232,208
ds_read_b64_tr_b16 v[196:197], v12 offset:53248
ds_read_b64_tr_b16 v[198:199], v12 offset:55296
Mvva 136,236,216
Mvva 152,224,196
s_waitcnt lgkmcnt(4)
ds_read_b64_tr_b16 v[200:201], v12 offset:57344
ds_read_b64_tr_b16 v[202:203], v12 offset:59392
Mvva 152,228,204
Mvva 152,232,212
ds_read_b64_tr_b16 v[204:205], v12 offset:61440
ds_read_b64_tr_b16 v[206:207], v12 offset:63488
Mvva 152,236,220
Mvva 140,240,192
ds_read_b64_tr_b16 v[208:209], v13 offset:49152
ds_read_b64_tr_b16 v[210:211], v13 offset:51200
Mvva 140,244,200
Mvva 140,248,208
ds_read_b64_tr_b16 v[212:213], v13 offset:53248
ds_read_b64_tr_b16 v[214:215], v13 offset:55296
Mvva 140,252,216
Mvva 156,240,196
s_waitcnt lgkmcnt(4)
ds_read_b64_tr_b16 v[216:217], v13 offset:57344
ds_read_b64_tr_b16 v[218:219], v13 offset:59392
Mvva 156,244,204
Mvva 156,248,212
ds_read_b64_tr_b16 v[220:221], v13 offset:61440
ds_read_b64_tr_b16 v[222:223], v13 offset:63488
Mvva 156,252,220
Mvva 128,192,224
ds_read_b64_tr_b16 v[224:225], v14 offset:49152
ds_read_b64_tr_b16 v[226:227], v14 offset:51200
Mvva 128,196,232
Mvva 128,200,240
ds_read_b64_tr_b16 v[228:229], v14 offset:53248
ds_read_b64_tr_b16 v[230:231], v14 offset:55296
Mvva 128,204,248
Mvva 144,192,228
s_waitcnt lgkmcnt(4)
ds_read_b64_tr_b16 v[232:233], v14 offset:57344
ds_read_b64_tr_b16 v[234:235], v14 offset:59392
Mvva 144,196,236
Mvva 144,200,244
ds_read_b64_tr_b16 v[236:237], v14 offset:61440
ds_read_b64_tr_b16 v[238:239], v14 offset:63488
Mvva 144,204,252
Mvva 132,208,224
ds_read_b64_tr_b16 v[240:241], v15 offset:49152
ds_read_b64_tr_b16 v[242:243], v15 offset:51200
Mvva 132,212,232
Mvva 132,216,240
s_waitcnt lgkmcnt(2)
ds_read_b64_tr_b16 v[244:245], v15 offset:53248
ds_read_b64_tr_b16 v[246:247], v15 offset:55296
Mvva 132,220,248
Mvva 148,208,228
ds_read_b64_tr_b16 v[248:249], v15 offset:57344
ds_read_b64_tr_b16 v[250:251], v15 offset:59392
Mvva 148,212,236
Mvva 148,216,244
ds_read_b64_tr_b16 v[252:253], v15 offset:61440
ds_read_b64_tr_b16 v[254:255], v15 offset:63488
Mvva 148,220,252
Mvva 136,224,224
Mvva 136,228,232
Mvva 136,232,240
Mvva 136,236,248
Mvva 152,224,228
s_waitcnt lgkmcnt(0)
Mvva 152,228,236
Mvva 152,232,244
Mvva 152,236,252
Mvva 140,240,224
Mvva 140,244,232
Mvva 140,248,240
Mvva 140,252,248
Mvva 156,240,228
Mvva 156,244,236
Mvva 156,248,244
Mvva 156,252,252
s_cmp_lg_u32 s53, s40
s_cbranch_scc1 L_ysl
L_yslr:
v_and_b32 v124, 15, v0
v_lshlrev_b32 v74, 8, v124
v_add_u32 v74, s35, v74
v_xor_b32 v124, v124, v121
v_lshl_add_u32 v74, v124, 4, v74
v_xor_b32_e64 v75, 64, v74
v_xor_b32 v76, 128, v74
v_xor_b32 v77, 192, v74
v_lshlrev_b32 v125, 1, v122
v_xor_b32 v124, v123, v125
v_lshlrev_b32 v12, 8, v123
v_add_u32 v12, s35, v12
v_lshl_add_u32 v12, v124, 4, v12
v_xor_b32_e64 v13, 16, v12
v_xor_b32 v14, 128, v12
v_xor_b32 v15, 144, v12
s_cmp_eq_u32 s33, 0
s_cbranch_scc1 L_spinX
L_spinXr:
v_lshlrev_b32_e64 v80, 16, v18
v_and_b32 v81, 0xffff0000, v18
v_lshlrev_b32_e64 v82, 16, v19
v_and_b32 v83, 0xffff0000, v19
v_lshlrev_b32_e64 v84, 16, v20
v_and_b32 v85, 0xffff0000, v20
v_lshlrev_b32_e64 v86, 16, v21
v_and_b32 v87, 0xffff0000, v21
v_lshlrev_b32_e64 v88, 16, v22
v_and_b32 v89, 0xffff0000, v22
v_lshlrev_b32_e64 v90, 16, v23
v_and_b32 v91, 0xffff0000, v23
v_lshlrev_b32_e64 v92, 16, v24
v_and_b32 v93, 0xffff0000, v24
v_lshlrev_b32_e64 v94, 16, v25
v_and_b32 v95, 0xffff0000, v25
v_lshlrev_b32_e64 v96, 16, v26
v_and_b32 v97, 0xffff0000, v26
v_lshlrev_b32_e64 v98, 16, v27
v_and_b32 v99, 0xffff0000, v27
v_lshlrev_b32_e64 v100, 16, v28
v_and_b32 v101, 0xffff0000, v28
v_lshlrev_b32_e64 v102, 16, v29
v_and_b32 v103, 0xffff0000, v29
v_lshlrev_b32_e64 v104, 16, v30
v_and_b32 v105, 0xffff0000, v30
v_lshlrev_b32_e64 v106, 16, v31
v_and_b32 v107, 0xffff0000, v31
v_lshlrev_b32_e64 v108, 16, v32
v_and_b32 v109, 0xffff0000, v32
v_lshlrev_b32_e64 v110, 16, v33
v_and_b32 v111, 0xffff0000, v33
s_waitcnt vmcnt(0)
s_nop 0
v_pk_add_f32 v[128:129], v[128:129], v[160:161]
v_pk_add_f32 v[130:131], v[130:131], v[162:163]
ds_write_b128 v74, v[128:131] offset:0
v_pk_add_f32 v[132:133], v[132:133], v[164:165]
v_pk_add_f32 v[134:135], v[134:135], v[166:167]
ds_write_b128 v75, v[132:135] offset:0
v_pk_add_f32 v[136:137], v[136:137], v[168:169]
v_pk_add_f32 v[138:139], v[138:139], v[170:171]
ds_write_b128 v76, v[136:139] offset:0
v_pk_add_f32 v[140:141], v[140:141], v[172:173]
v_pk_add_f32 v[142:143], v[142:143], v[174:175]
ds_write_b128 v77, v[140:143] offset:0
v_pk_add_f32 v[144:145], v[144:145], v[176:177]
v_pk_add_f32 v[146:147], v[146:147], v[178:179]
ds_write_b128 v74, v[144:147] offset:4096
v_pk_add_f32 v[148:149], v[148:149], v[180:181]
v_pk_add_f32 v[150:151], v[150:151], v[182:183]
ds_write_b128 v75, v[148:151] offset:4096
v_pk_add_f32 v[152:153], v[152:153], v[184:185]
v_pk_add_f32 v[154:155], v[154:155], v[186:187]
ds_write_b128 v76, v[152:155] offset:4096
v_pk_add_f32 v[156:157], v[156:157], v[188:189]
v_pk_add_f32 v[158:159], v[158:159], v[190:191]
ds_write_b128 v77, v[156:159] offset:4096
Rv 192,12,0
Rv 196,13,0
Rv 200,14,2048
Rv 204,15,2048
Rv 208,12,4096
Rv 212,13,4096
Rv 216,14,6144
s_waitcnt lgkmcnt(9)
Rv 220,15,6144
s_waitcnt lgkmcnt(6)
Vc 224,192,193
v_lshlrev_b32_e64 v192, 16, v224
v_and_b32 v193, 0xffff0000, v224
Vc 225,194,195
v_lshlrev_b32_e64 v194, 16, v225
v_and_b32 v195, 0xffff0000, v225
Vc 226,196,197
v_lshlrev_b32_e64 v196, 16, v226
v_and_b32 v197, 0xffff0000, v226
Vc 227,198,199
v_lshlrev_b32_e64 v198, 16, v227
v_and_b32 v199, 0xffff0000, v227
v_pk_mul_f32 v[192:193], v[192:193], v[42:43]
v_pk_mul_f32 v[194:195], v[194:195], v[44:45]
v_pk_mul_f32 v[196:197], v[196:197], v[46:47]
v_pk_mul_f32 v[198:199], v[198:199], v[48:49]
Vc 224,192,193
v_lshlrev_b32_e64 v192, 16, v224
v_and_b32 v193, 0xffff0000, v224
Vc 225,194,195
v_lshlrev_b32_e64 v194, 16, v225
v_and_b32 v195, 0xffff0000, v225
Vc 226,196,197
v_lshlrev_b32_e64 v196, 16, v226
v_and_b32 v197, 0xffff0000, v226
Vc 227,198,199
v_lshlrev_b32_e64 v198, 16, v227
v_and_b32 v199, 0xffff0000, v227
v_pk_add_f32 v[192:193], v[192:193], v[80:81]
v_pk_add_f32 v[194:195], v[194:195], v[82:83]
v_pk_add_f32 v[196:197], v[196:197], v[84:85]
v_pk_add_f32 v[198:199], v[198:199], v[86:87]
Vc 224,192,193
Vc 225,194,195
Vc 226,196,197
Vc 227,198,199
buffer_store_dwordx4 v[224:227], v119, s[68:71], s36 offen sc1
s_add_u32 s36, s36, 16384
s_waitcnt lgkmcnt(4)
Vc 228,200,201
v_lshlrev_b32 v200, 16, v228
v_and_b32 v201, 0xffff0000, v228
Vc 229,202,203
v_lshlrev_b32_e64 v202, 16, v229
v_and_b32 v203, 0xffff0000, v229
Vc 230,204,205
v_lshlrev_b32_e64 v204, 16, v230
v_and_b32 v205, 0xffff0000, v230
Vc 231,206,207
v_lshlrev_b32_e64 v206, 16, v231
v_and_b32 v207, 0xffff0000, v231
v_pk_mul_f32 v[200:201], v[200:201], v[50:51]
v_pk_mul_f32 v[202:203], v[202:203], v[52:53]
v_pk_mul_f32 v[204:205], v[204:205], v[54:55]
v_pk_mul_f32 v[206:207], v[206:207], v[56:57]
Vc 228,200,201
v_lshlrev_b32_e64 v200, 16, v228
v_and_b32 v201, 0xffff0000, v228
Vc 229,202,203
v_lshlrev_b32_e64 v202, 16, v229
v_and_b32 v203, 0xffff0000, v229
Vc 230,204,205
v_lshlrev_b32_e64 v204, 16, v230
v_and_b32 v205, 0xffff0000, v230
Vc 231,206,207
v_lshlrev_b32_e64 v206, 16, v231
v_and_b32 v207, 0xffff0000, v231
v_pk_add_f32 v[200:201], v[200:201], v[88:89]
v_pk_add_f32 v[202:203], v[202:203], v[90:91]
v_pk_add_f32 v[204:205], v[204:205], v[92:93]
v_pk_add_f32 v[206:207], v[206:207], v[94:95]
Vc 228,200,201
Vc 229,202,203
Vc 230,204,205
Vc 231,206,207
buffer_store_dwordx4 v[228:231], v119, s[68:71], s36 offen sc1
s_add_u32 s36, s36, 16384
s_waitcnt lgkmcnt(2)
Vc 232,208,209
v_lshlrev_b32 v208, 16, v232
v_and_b32 v209, 0xffff0000, v232
Vc 233,210,211
v_lshlrev_b32_e64 v210, 16, v233
v_and_b32 v211, 0xffff0000, v233
Vc 234,212,213
v_lshlrev_b32_e64 v212, 16, v234
v_and_b32 v213, 0xffff0000, v234
Vc 235,214,215
v_lshlrev_b32_e64 v214, 16, v235
v_and_b32 v215, 0xffff0000, v235
v_pk_mul_f32 v[208:209], v[208:209], v[58:59]
v_pk_mul_f32 v[210:211], v[210:211], v[60:61]
v_pk_mul_f32 v[212:213], v[212:213], v[62:63]
v_pk_mul_f32 v[214:215], v[214:215], v[64:65]
Vc 232,208,209
v_lshlrev_b32_e64 v208, 16, v232
v_and_b32 v209, 0xffff0000, v232
Vc 233,210,211
v_lshlrev_b32_e64 v210, 16, v233
v_and_b32 v211, 0xffff0000, v233
Vc 234,212,213
v_lshlrev_b32_e64 v212, 16, v234
v_and_b32 v213, 0xffff0000, v234
Vc 235,214,215
v_lshlrev_b32_e64 v214, 16, v235
v_and_b32 v215, 0xffff0000, v235
v_pk_add_f32 v[208:209], v[208:209], v[96:97]
v_pk_add_f32 v[210:211], v[210:211], v[98:99]
v_pk_add_f32 v[212:213], v[212:213], v[100:101]
v_pk_add_f32 v[214:215], v[214:215], v[102:103]
Vc 232,208,209
Vc 233,210,211
Vc 234,212,213
Vc 235,214,215
buffer_store_dwordx4 v[232:235], v119, s[68:71], s36 offen sc1
s_add_u32 s36, s36, 16384
s_waitcnt lgkmcnt(0)
Vc 236,216,217
v_lshlrev_b32 v216, 16, v236
v_and_b32 v217, 0xffff0000, v236
Vc 237,218,219
v_lshlrev_b32_e64 v218, 16, v237
v_and_b32 v219, 0xffff0000, v237
Vc 238,220,221
v_lshlrev_b32_e64 v220, 16, v238
v_and_b32 v221, 0xffff0000, v238
Vc 239,222,223
v_lshlrev_b32_e64 v222, 16, v239
v_and_b32 v223, 0xffff0000, v239
v_pk_mul_f32 v[216:217], v[216:217], v[66:67]
v_pk_mul_f32 v[218:219], v[218:219], v[68:69]
v_pk_mul_f32 v[220:221], v[220:221], v[70:71]
v_pk_mul_f32 v[222:223], v[222:223], v[72:73]
Vc 236,216,217
v_lshlrev_b32_e64 v216, 16, v236
v_and_b32 v217, 0xffff0000, v236
Vc 237,218,219
v_lshlrev_b32_e64 v218, 16, v237
v_and_b32 v219, 0xffff0000, v237
Vc 238,220,221
v_lshlrev_b32_e64 v220, 16, v238
v_and_b32 v221, 0xffff0000, v238
Vc 239,222,223
v_lshlrev_b32_e64 v222, 16, v239
v_and_b32 v223, 0xffff0000, v239
v_pk_add_f32 v[216:217], v[216:217], v[104:105]
v_pk_add_f32 v[218:219], v[218:219], v[106:107]
v_pk_add_f32 v[220:221], v[220:221], v[108:109]
v_pk_add_f32 v[222:223], v[222:223], v[110:111]
Vc 236,216,217
Vc 237,218,219
Vc 238,220,221
Vc 239,222,223
buffer_store_dwordx4 v[236:239], v119, s[68:71], s36 offen sc1
L_k2_end:
s_endpgm
L_spinC:
s_add_u32 m0, s35, 0
s_nop 0
s_nop 0
buffer_load_dwordx4 v125, s[60:63], s48 offen offset:0 lds
buffer_load_dwordx4 v125, s[60:63], s49 offen offset:1024 lds
buffer_load_dwordx4 v125, s[60:63], s50 offen offset:2048 lds
buffer_load_dwordx4 v125, s[60:63], s51 offen offset:3072 lds
v_add_u32 v125, 65536, v125
s_add_u32 m0, s35, 4096
s_nop 0
buffer_load_dwordx4 v125, s[60:63], s48 offen offset:0 lds
buffer_load_dwordx4 v125, s[60:63], s49 offen offset:1024 lds
buffer_load_dwordx4 v125, s[60:63], s50 offen offset:2048 lds
buffer_load_dwordx4 v125, s[60:63], s51 offen offset:3072 lds
s_mov_b32 s40, 1
s_mov_b32 s47, 0x400000
L_spinC_l:
buffer_load_dword v124, v10, s[20:23], s38 offen sc1
s_sub_u32 s47, s47, 1
s_waitcnt vmcnt(0)
s_cmp_eq_u32 s47, 0
s_cbranch_scc1 L_spinC_lx
v_cmp_ne_u32 vcc, 1, v124
s_cbranch_vccz L_spinC_lx
s_sleep 4
s_branch L_spinC_l
L_spinC_lx:
s_branch L_spinCr
L_c31:
s_bfe_u32 s3, s2, 0x40003
s_lshl_b32 s3, s3, 2
s_add_u32 s3, s3, s32
s_lshl_b32 s3, s3, 15
s_and_b32 s7, s2, 1
s_lshl_b32 s7, s7, 22
s_add_u32 s3, s3, s7
s_add_u32 s3, s3, 2097536
v_and_b32 v1, 15, v0
v_lshlrev_b32 v1, 11, v1
v_lshrrev_b32 v11, 5, v0
v_lshl_add_u32 v1, v11, 10, v1
buffer_load_dword v11, v1, s[28:31], s3 offen
s_branch L_c31r
L_f2A:
s_lshr_b32 s5, s54, 1
s_lshl_b32 s5, s5, 5
s_add_u32 s5, s5, 5447680
buffer_load_dword v125, v127, s[20:23], s5 offen sc1
s_branch L_f2Ar
L_f2B:
s_waitcnt vmcnt(16)
v_cmp_ne_u32 vcc, 1, v125
s_cbranch_vccz L_f2lx
s_mov_b32 s47, 0x400000
L_f2l:
buffer_load_dword v125, v127, s[20:23], s5 offen sc1
s_sub_u32 s47, s47, 1
s_waitcnt vmcnt(0)
s_cmp_eq_u32 s47, 0
s_cbranch_scc1 L_f2lx
v_cmp_ne_u32 vcc, 1, v125
s_cbranch_vccz L_f2lx
s_sleep 8
s_branch L_f2l
L_f2lx:
s_lshl_b32 s3, s54, 8
s_add_u32 s3, s3, 6291456
v_mul_u32_u24 v124, 14336, v121
v_and_b32_e64 v125, 15, v0
v_lshl_add_u32 v124, v125, 4, v124
buffer_load_dwordx4 v[74:77], v124, s[20:23], s3 offen sc1
s_add_u32 s3, s3, 57344
buffer_load_dwordx4 v[78:81], v124, s[20:23], s3 offen sc1
s_add_u32 s3, s3, 57344
buffer_load_dwordx4 v[82:85], v124, s[20:23], s3 offen sc1
s_add_u32 s3, s3, 57344
buffer_load_dwordx4 v[86:89], v124, s[20:23], s3 offen sc1
s_add_u32 s3, s3, 57344
buffer_load_dwordx4 v[90:93], v124, s[20:23], s3 offen sc1
s_add_u32 s3, s3, 57344
buffer_load_dwordx4 v[94:97], v124, s[20:23], s3 offen sc1
s_add_u32 s3, s3, 57344
buffer_load_dwordx4 v[98:101], v124, s[20:23], s3 offen sc1
s_add_u32 s3, s3, 57344
buffer_load_dwordx4 v[102:105], v124, s[20:23], s3 offen sc1
s_branch L_f2Br
L_yA:
v_min_u32 v127, 13, v0
v_lshlrev_b32_e64 v127, 2, v127
buffer_load_dword v74, v127, s[20:23], s41 offen sc1
s_branch L_yAr
L_yB:
s_waitcnt vmcnt(1)
v_cmp_ne_u32 vcc, 1, v74
s_cbranch_vccnz L_yBr
s_mov_b32 s40, 1
v_lshlrev_b32 v124, 2, v0
v_lshlrev_b32 v125, 1, v0
s_lshl_b32 s7, s45, 2
s_add_u32 s7, s7, s32
s_lshr_b32 s3, s42, 5
s_cmp_lg_u32 s3, s7
s_cbranch_scc1 L_f_yl1
s_add_u32 s3, s55, 0
s_nop 0
s_add_u32 s7, s3, 4096
buffer_load_dword v76, v124, s[20:23], s3 offen offset:0 sc1
buffer_load_dword v77, v124, s[20:23], s3 offen offset:512 sc1
buffer_load_dword v78, v124, s[20:23], s3 offen offset:1024 sc1
buffer_load_dword v79, v124, s[20:23], s3 offen offset:1536 sc1
buffer_load_dword v80, v124, s[20:23], s3 offen offset:2048 sc1
buffer_load_dword v81, v124, s[20:23], s3 offen offset:2560 sc1
buffer_load_dword v82, v124, s[20:23], s3 offen offset:3072 sc1
buffer_load_dword v83, v124, s[20:23], s3 offen offset:3584 sc1
buffer_load_dword v84, v124, s[20:23], s7 offen offset:0 sc1
buffer_load_dword v85, v124, s[20:23], s7 offen offset:512 sc1
buffer_load_dword v86, v124, s[20:23], s7 offen offset:1024 sc1
buffer_load_dword v87, v124, s[20:23], s7 offen offset:1536 sc1
buffer_load_dword v88, v124, s[20:23], s7 offen offset:2048 sc1
buffer_load_dword v89, v124, s[20:23], s7 offen offset:2560 sc1
s_lshl_b32 s3, s42, 11
s_lshl_b32 s7, s46, 7
s_add_u32 s3, s3, s7
buffer_load_ushort v90, v125, s[56:59], s3 offen
s_lshl_b32 s3, s42, 3
s_add_u32 s3, s3, 5259264
buffer_load_dwordx2 v[92:93], v126, s[20:23], s3 offen sc1
L_f_yl1:
s_lshl_b32 s7, s45, 2
s_add_u32 s7, s7, s32
s_lshr_b32 s3, s43, 5
s_cmp_lg_u32 s3, s7
s_cbranch_scc1 L_f_yl2
s_nop 0
s_add_u32 s3, s55, 256
s_add_u32 s7, s3, 4096
buffer_load_dword v94, v124, s[20:23], s3 offen offset:0 sc1
buffer_load_dword v95, v124, s[20:23], s3 offen offset:512 sc1
buffer_load_dword v96, v124, s[20:23], s3 offen offset:1024 sc1
buffer_load_dword v97, v124, s[20:23], s3 offen offset:1536 sc1
buffer_load_dword v98, v124, s[20:23], s3 offen offset:2048 sc1
buffer_load_dword v99, v124, s[20:23], s3 offen offset:2560 sc1
buffer_load_dword v100, v124, s[20:23], s3 offen offset:3072 sc1
buffer_load_dword v101, v124, s[20:23], s3 offen offset:3584 sc1
buffer_load_dword v102, v124, s[20:23], s7 offen offset:0 sc1
buffer_load_dword v103, v124, s[20:23], s7 offen offset:512 sc1
buffer_load_dword v104, v124, s[20:23], s7 offen offset:1024 sc1
buffer_load_dword v105, v124, s[20:23], s7 offen offset:1536 sc1
buffer_load_dword v106, v124, s[20:23], s7 offen offset:2048 sc1
buffer_load_dword v107, v124, s[20:23], s7 offen offset:2560 sc1
s_lshl_b32 s3, s43, 11
s_lshl_b32 s7, s46, 7
s_add_u32 s3, s3, s7
buffer_load_ushort v108, v125, s[56:59], s3 offen
s_lshl_b32 s3, s43, 3
s_add_u32 s3, s3, 5259264
buffer_load_dwordx2 v[110:111], v126, s[20:23], s3 offen sc1
L_f_yl2:
s_branch L_yBr
L_yC:
s_waitcnt vmcnt(1)
s_lshl_b32 s7, s45, 2
s_add_u32 s7, s7, s32
s_lshr_b32 s3, s42, 5
s_cmp_lg_u32 s3, s7
s_cbranch_scc1 L_f_ys3
s_nop 0
v_pk_add_f32 v[76:77], v[76:77], v[78:79]
v_pk_add_f32 v[76:77], v[76:77], v[80:81]
v_pk_add_f32 v[76:77], v[76:77], v[82:83]
v_pk_add_f32 v[76:77], v[76:77], v[84:85]
v_pk_add_f32 v[76:77], v[76:77], v[86:87]
v_pk_add_f32 v[76:77], v[76:77], v[88:89]
Va 76,76,77
v_lshlrev_b32 v90, 16, v90
v_sub_f32_e64 v90, v90, v92
Vc 76,76,76
v_lshlrev_b32_e64 v76, 16, v76
Vc 90,90,90
v_lshlrev_b32 v90, 16, v90
v_mul_f32 v76, s100, v76
v_mul_f32_e64 v90, v90, v93
Vc 76,76,76
v_lshlrev_b32_e64 v76, 16, v76
Vc 90,90,90
v_lshlrev_b32 v90, 16, v90
Va 90,90,76
Vc 90,90,90
v_lshlrev_b32_e64 v90, 16, v90
v_mul_f32 v76, 0xbfb8aa3b, v90
Ve 76,76
s_nop 0
v_add_f32 v76, 1.0, v76
v_rcp_f32 v76, v76
s_nop 0
Vm 90,90,76
Vc 90,90,90
v_lshlrev_b32 v90, 16, v90
v_lshlrev_b32 v124, 2, v0
v_add_u32 v124, s35, v124
v_lshlrev_b32 v125, 5, v122
v_add_u32 v125, s35, v125
s_waitcnt lgkmcnt(0)
ds_write_b32 v124, v90
s_and_b32 s3, s42, 7
s_lshl_b32 s3, s3, 3
s_lshl_b64 s[4:5], 0xff, s3
s_bfe_u32 s3, s42, 0x20003
s_mov_b64 exec, s[4:5]
s_cmp_lg_u32 s3, 0
s_cbranch_scc1 L_f_yp4
ds_read_b64 v[42:43], v125
ds_read_b64 v[44:45], v125 offset:8
ds_read_b64 v[46:47], v125 offset:16
ds_read_b64 v[48:49], v125 offset:24
L_f_yp4:
s_cmp_lg_u32 s3, 1
s_cbranch_scc1 L_f_yp5
ds_read_b64 v[50:51], v125
ds_read_b64 v[52:53], v125 offset:8
ds_read_b64 v[54:55], v125 offset:16
ds_read_b64 v[56:57], v125 offset:24
L_f_yp5:
s_cmp_lg_u32 s3, 2
s_cbranch_scc1 L_f_yp6
ds_read_b64 v[58:59], v125
ds_read_b64 v[60:61], v125 offset:8
ds_read_b64 v[62:63], v125 offset:16
ds_read_b64 v[64:65], v125 offset:24
L_f_yp6:
s_cmp_lg_u32 s3, 3
s_cbranch_scc1 L_f_yp7
ds_read_b64 v[66:67], v125
ds_read_b64 v[68:69], v125 offset:8
s_waitcnt lgkmcnt(9)
ds_read_b64 v[70:71], v125 offset:16
ds_read_b64 v[72:73], v125 offset:24
L_f_yp7:
s_mov_b64 exec, -1
s_waitcnt lgkmcnt(0)
L_f_ys3:
s_lshl_b32 s7, s45, 2
s_add_u32 s7, s7, s32
s_lshr_b32 s3, s43, 5
s_cmp_lg_u32 s3, s7
s_cbranch_scc1 L_f_ys8
s_nop 0
v_pk_add_f32 v[94:95], v[94:95], v[96:97]
v_pk_add_f32 v[94:95], v[94:95], v[98:99]
v_pk_add_f32 v[94:95], v[94:95], v[100:101]
v_pk_add_f32 v[94:95], v[94:95], v[102:103]
v_pk_add_f32 v[94:95], v[94:95], v[104:105]
v_pk_add_f32 v[94:95], v[94:95], v[106:107]
Va 94,94,95
v_lshlrev_b32 v108, 16, v108
v_sub_f32_e64 v108, v108, v110
Vc 94,94,94
v_lshlrev_b32_e64 v94, 16, v94
Vc 108,108,108
v_lshlrev_b32 v108, 16, v108
v_mul_f32 v94, s101, v94
v_mul_f32_e64 v108, v108, v111
Vc 94,94,94
v_lshlrev_b32_e64 v94, 16, v94
Vc 108,108,108
v_lshlrev_b32 v108, 16, v108
Va 108,108,94
Vc 108,108,108
v_lshlrev_b32_e64 v108, 16, v108
v_mul_f32 v94, 0xbfb8aa3b, v108
Ve 94,94
s_nop 0
v_add_f32 v94, 1.0, v94
v_rcp_f32 v94, v94
s_nop 0
Vm 108,108,94
Vc 108,108,108
v_lshlrev_b32 v108, 16, v108
v_lshlrev_b32 v124, 2, v0
v_add_u32 v124, s35, v124
v_lshlrev_b32 v125, 5, v122
v_add_u32 v125, s35, v125
s_waitcnt lgkmcnt(0)
ds_write_b32 v124, v108
s_and_b32 s3, s43, 7
s_lshl_b32 s3, s3, 3
s_lshl_b64 s[4:5], 0xff, s3
s_bfe_u32 s3, s43, 0x20003
s_mov_b64 exec, s[4:5]
s_cmp_lg_u32 s3, 0
s_cbranch_scc1 L_f_yp9
ds_read_b64 v[42:43], v125
ds_read_b64 v[44:45], v125 offset:8
ds_read_b64 v[46:47], v125 offset:16
ds_read_b64 v[48:49], v125 offset:24
L_f_yp9:
s_cmp_lg_u32 s3, 1
s_cbranch_scc1 L_f_yp10
ds_read_b64 v[50:51], v125
ds_read_b64 v[52:53], v125 offset:8
ds_read_b64 v[54:55], v125 offset:16
ds_read_b64 v[56:57], v125 offset:24
L_f_yp10:
s_cmp_lg_u32 s3, 2
s_cbranch_scc1 L_f_yp11
ds_read_b64 v[58:59], v125
ds_read_b64 v[60:61], v125 offset:8
ds_read_b64 v[62:63], v125 offset:16
ds_read_b64 v[64:65], v125 offset:24
L_f_yp11:
s_cmp_lg_u32 s3, 3
s_cbranch_scc1 L_f_yp12
ds_read_b64 v[66:67], v125
ds_read_b64 v[68:69], v125 offset:8
s_waitcnt lgkmcnt(9)
ds_read_b64 v[70:71], v125 offset:16
ds_read_b64 v[72:73], v125 offset:24
L_f_yp12:
s_mov_b64 exec, -1
s_waitcnt lgkmcnt(0)
L_f_ys8:
s_branch L_yCr
L_p4_end:
L_spinAk:
s_mov_b32 s47, 0x400000
L_spinAk_l:
s_sleep 8
buffer_load_dword v1, v7, s[28:31], 0 offen sc1
s_waitcnt vmcnt(0)
v_readfirstlane_b32 s3, v1
s_sub_u32 s47, s47, 1
s_cmp_eq_u32 s47, 0
s_cbranch_scc1 L_spinArk
s_cmp_lt_u32 s3, 256
s_cbranch_scc1 L_spinAk_l
s_branch L_spinArk
L_spinAv:
s_mov_b32 s47, 0x400000
L_spinAv_l:
s_sleep 8
buffer_load_dword v1, v7, s[28:31], 0 offen sc1
s_waitcnt vmcnt(0)
v_readfirstlane_b32 s3, v1
s_sub_u32 s47, s47, 1
s_cmp_eq_u32 s47, 0
s_cbranch_scc1 L_spinArv
s_cmp_lt_u32 s3, 256
s_cbranch_scc1 L_spinAv_l
s_branch L_spinArv
L_spinB:
s_mov_b32 s59, 0x400000
L_spinB_l:
s_sleep 4
buffer_load_dword v12, v1, s[20:23], s6 offen sc1
s_sub_u32 s59, s59, 1
s_cmp_eq_u32 s59, 0
s_cbranch_scc1 L_spinBx
s_waitcnt vmcnt(0)
v_cmp_ne_u32 vcc, 1, v12
s_cbranch_vccnz L_spinB_l
L_spinBx:
s_waitcnt vmcnt(0)
s_branch L_spinBr
L_k2_fb_we:
s_nop 7
s_nop 0
v_max3_f32 v21, v128, v129, v130
v_max3_f32 v21, v21, v131, v132
v_max3_f32 v21, v21, v133, v134
v_max3_f32 v21, v21, v135, v136
v_max3_f32 v21, v21, v137, v138
v_max3_f32 v21, v21, v139, v140
v_max3_f32 v21, v21, v141, v142
v_max_f32 v21, v21, v143
v_mov_b32 v1, v21
s_nop 1
v_permlane16_swap_b32 v1, v21
v_max_f32 v21, v21, v1
v_mov_b32 v1, v21
s_nop 1
v_permlane32_swap_b32 v1, v21
v_max_f32_e64 v21, v21, v1
v_add_f32 v21, 0x41f80000, v21
v_max_f32 v21, 0, v21
Vs 128,128,21
Vs 129,129,21
Vs 130,130,21
Vs 131,131,21
Vs 132,132,21
Vs 133,133,21
Vs 134,134,21
Vs 135,135,21
Vs 136,136,21
Vs 137,137,21
Vs 138,138,21
Vs 139,139,21
Vs 140,140,21
Vs 141,141,21
Vs 142,142,21
Vs 143,143,21
Vs 192,192,21
Vs 193,193,21
Vs 194,194,21
Vs 195,195,21
Vs 196,196,21
Vs 197,197,21
Vs 198,198,21
Vs 199,199,21
Vs 200,200,21
Vs 201,201,21
Vs 202,202,21
Vs 203,203,21
Vs 204,204,21
Vs 205,205,21
Vs 206,206,21
Vs 207,207,21
Vs 32,32,21
Vs 33,33,21
Vs 34,34,21
v_sub_f32_e64 v35, v35, v21
v_exp_f32 v22, -v21
s_nop 0
Vm 48,48,22
Vm 49,49,22
Vm 50,50,22
v_mul_f32_e64 v51, v51, v22
Ar 8,0
Ar 9,1
Ar 10,2
Ar 11,3
Ar 12,4
Ar 13,5
Ar 14,6
Ar 15,7
Vm 8,8,22
Vm 9,9,22
Vm 10,10,22
Vm 11,11,22
Vm 12,12,22
Vm 13,13,22
Vm 14,14,22
Vm 15,15,22
Aw 0,8
Aw 1,9
Aw 2,10
Aw 3,11
Aw 4,12
Aw 5,13
Aw 6,14
Aw 7,15
Ar 8,8
Ar 9,9
Ar 10,10
Ar 11,11
Ar 12,12
Ar 13,13
Ar 14,14
Ar 15,15
Vm 8,8,22
Vm 9,9,22
Vm 10,10,22
Vm 11,11,22
Vm 12,12,22
Vm 13,13,22
Vm 14,14,22
Vm 15,15,22
Aw 8,8
Aw 9,9
Aw 10,10
Aw 11,11
Aw 12,12
Aw 13,13
Aw 14,14
Aw 15,15
Ar 8,16
Ar 9,17
Ar 10,18
Ar 11,19
Ar 12,20
Ar 13,21
Ar 14,22
Ar 15,23
Vm 8,8,22
Vm 9,9,22
Vm 10,10,22
Vm 11,11,22
Vm 12,12,22
Vm 13,13,22
Vm 14,14,22
Vm 15,15,22
Aw 16,8
Aw 17,9
Aw 18,10
Aw 19,11
Aw 20,12
Aw 21,13
Aw 22,14
Aw 23,15
Ar 8,24
Ar 9,25
Ar 10,26
Ar 11,27
Ar 12,28
Ar 13,29
Ar 14,30
Ar 15,31
Vm 8,8,22
Vm 9,9,22
Vm 10,10,22
Vm 11,11,22
Vm 12,12,22
Vm 13,13,22
Vm 14,14,22
Vm 15,15,22
Aw 24,8
Aw 25,9
Aw 26,10
Aw 27,11
Aw 28,12
Aw 29,13
Aw 30,14
Aw 31,15
v_max3_f32 v21, v144, v145, v146
v_max3_f32 v21, v21, v147, v148
v_max3_f32 v21, v21, v149, v150
v_max3_f32 v21, v21, v151, v152
v_max3_f32 v21, v21, v153, v154
v_max3_f32 v21, v21, v155, v156
v_max3_f32 v21, v21, v157, v158
v_max_f32 v21, v21, v159
v_mov_b32 v1, v21
s_nop 1
v_permlane16_swap_b32 v1, v21
v_max_f32 v21, v21, v1
v_mov_b32 v1, v21
s_nop 1
v_permlane32_swap_b32 v1, v21
v_max_f32_e64 v21, v21, v1
v_add_f32 v21, 0x41f80000, v21
v_max_f32 v21, 0, v21
Vs 144,144,21
Vs 145,145,21
Vs 146,146,21
Vs 147,147,21
Vs 148,148,21
Vs 149,149,21
Vs 150,150,21
Vs 151,151,21
Vs 152,152,21
Vs 153,153,21
Vs 154,154,21
Vs 155,155,21
Vs 156,156,21
Vs 157,157,21
Vs 158,158,21
Vs 159,159,21
Vs 208,208,21
Vs 209,209,21
Vs 210,210,21
Vs 211,211,21
Vs 212,212,21
Vs 213,213,21
Vs 214,214,21
Vs 215,215,21
Vs 216,216,21
Vs 217,217,21
Vs 218,218,21
Vs 219,219,21
Vs 220,220,21
Vs 221,221,21
Vs 222,222,21
Vs 223,223,21
Vs 36,36,21
Vs 37,37,21
Vs 38,38,21
v_sub_f32_e64 v39, v39, v21
v_exp_f32 v22, -v21
s_nop 0
Vm 52,52,22
Vm 53,53,22
Vm 54,54,22
v_mul_f32_e64 v55, v55, v22
Ar 8,32
Ar 9,33
Ar 10,34
Ar 11,35
Ar 12,36
Ar 13,37
Ar 14,38
Ar 15,39
Vm 8,8,22
Vm 9,9,22
Vm 10,10,22
Vm 11,11,22
Vm 12,12,22
Vm 13,13,22
Vm 14,14,22
Vm 15,15,22
Aw 32,8
Aw 33,9
Aw 34,10
Aw 35,11
Aw 36,12
Aw 37,13
Aw 38,14
Aw 39,15
Ar 8,40
Ar 9,41
Ar 10,42
Ar 11,43
Ar 12,44
Ar 13,45
Ar 14,46
Ar 15,47
Vm 8,8,22
Vm 9,9,22
Vm 10,10,22
Vm 11,11,22
Vm 12,12,22
Vm 13,13,22
Vm 14,14,22
Vm 15,15,22
Aw 40,8
Aw 41,9
Aw 42,10
Aw 43,11
Aw 44,12
Aw 45,13
Aw 46,14
Aw 47,15
Ar 8,48
Ar 9,49
Ar 10,50
Ar 11,51
Ar 12,52
Ar 13,53
Ar 14,54
Ar 15,55
Vm 8,8,22
Vm 9,9,22
Vm 10,10,22
Vm 11,11,22
Vm 12,12,22
Vm 13,13,22
Vm 14,14,22
Vm 15,15,22
Aw 48,8
Aw 49,9
Aw 50,10
Aw 51,11
Aw 52,12
Aw 53,13
Aw 54,14
Aw 55,15
Ar 8,56
Ar 9,57
Ar 10,58
Ar 11,59
Ar 12,60
Ar 13,61
Ar 14,62
Ar 15,63
Vm 8,8,22
Vm 9,9,22
Vm 10,10,22
Vm 11,11,22
Vm 12,12,22
Vm 13,13,22
Vm 14,14,22
Vm 15,15,22
Aw 56,8
Aw 57,9
Aw 58,10
Aw 59,11
Aw 60,12
Aw 61,13
Aw 62,14
Aw 63,15
v_max3_f32 v21, v160, v161, v162
v_max3_f32 v21, v21, v163, v164
v_max3_f32 v21, v21, v165, v166
v_max3_f32 v21, v21, v167, v168
v_max3_f32 v21, v21, v169, v170
v_max3_f32 v21, v21, v171, v172
v_max3_f32 v21, v21, v173, v174
v_max_f32 v21, v21, v175
v_mov_b32 v1, v21
s_nop 1
v_permlane16_swap_b32 v1, v21
v_max_f32 v21, v21, v1
v_mov_b32 v1, v21
s_nop 1
v_permlane32_swap_b32 v1, v21
v_max_f32_e64 v21, v21, v1
v_add_f32 v21, 0x41f80000, v21
v_max_f32 v21, 0, v21
Vs 160,160,21
Vs 161,161,21
Vs 162,162,21
Vs 163,163,21
Vs 164,164,21
Vs 165,165,21
Vs 166,166,21
Vs 167,167,21
Vs 168,168,21
Vs 169,169,21
Vs 170,170,21
Vs 171,171,21
Vs 172,172,21
Vs 173,173,21
Vs 174,174,21
Vs 175,175,21
Vs 224,224,21
Vs 225,225,21
Vs 226,226,21
Vs 227,227,21
Vs 228,228,21
Vs 229,229,21
Vs 230,230,21
Vs 231,231,21
Vs 232,232,21
Vs 233,233,21
Vs 234,234,21
Vs 235,235,21
Vs 236,236,21
Vs 237,237,21
Vs 238,238,21
Vs 239,239,21
Vs 40,40,21
Vs 41,41,21
Vs 42,42,21
v_sub_f32_e64 v43, v43, v21
v_exp_f32 v22, -v21
s_nop 0
Vm 56,56,22
Vm 57,57,22
Vm 58,58,22
v_mul_f32_e64 v59, v59, v22
Ar 8,64
Ar 9,65
Ar 10,66
Ar 11,67
Ar 12,68
Ar 13,69
Ar 14,70
Ar 15,71
Vm 8,8,22
Vm 9,9,22
Vm 10,10,22
Vm 11,11,22
Vm 12,12,22
Vm 13,13,22
Vm 14,14,22
Vm 15,15,22
Aw 64,8
Aw 65,9
Aw 66,10
Aw 67,11
Aw 68,12
Aw 69,13
Aw 70,14
Aw 71,15
Ar 8,72
Ar 9,73
Ar 10,74
Ar 11,75
Ar 12,76
Ar 13,77
Ar 14,78
Ar 15,79
Vm 8,8,22
Vm 9,9,22
Vm 10,10,22
Vm 11,11,22
Vm 12,12,22
Vm 13,13,22
Vm 14,14,22
Vm 15,15,22
Aw 72,8
Aw 73,9
Aw 74,10
Aw 75,11
Aw 76,12
Aw 77,13
Aw 78,14
Aw 79,15
Ar 8,80
Ar 9,81
Ar 10,82
Ar 11,83
Ar 12,84
Ar 13,85
Ar 14,86
Ar 15,87
Vm 8,8,22
Vm 9,9,22
Vm 10,10,22
Vm 11,11,22
Vm 12,12,22
Vm 13,13,22
Vm 14,14,22
Vm 15,15,22
Aw 80,8
Aw 81,9
Aw 82,10
Aw 83,11
Aw 84,12
Aw 85,13
Aw 86,14
Aw 87,15
Ar 8,88
Ar 9,89
Ar 10,90
Ar 11,91
Ar 12,92
Ar 13,93
Ar 14,94
Ar 15,95
Vm 8,8,22
Vm 9,9,22
Vm 10,10,22
Vm 11,11,22
Vm 12,12,22
Vm 13,13,22
Vm 14,14,22
Vm 15,15,22
Aw 88,8
Aw 89,9
Aw 90,10
Aw 91,11
Aw 92,12
Aw 93,13
Aw 94,14
Aw 95,15
v_max3_f32 v21, v176, v177, v178
v_max3_f32 v21, v21, v179, v180
v_max3_f32 v21, v21, v181, v182
v_max3_f32 v21, v21, v183, v184
v_max3_f32 v21, v21, v185, v186
v_max3_f32 v21, v21, v187, v188
v_max3_f32 v21, v21, v189, v190
v_max_f32 v21, v21, v191
v_mov_b32 v1, v21
s_nop 1
v_permlane16_swap_b32 v1, v21
v_max_f32 v21, v21, v1
v_mov_b32 v1, v21
s_nop 1
v_permlane32_swap_b32 v1, v21
v_max_f32_e64 v21, v21, v1
v_add_f32 v21, 0x41f80000, v21
v_max_f32 v21, 0, v21
Vs 176,176,21
Vs 177,177,21
Vs 178,178,21
Vs 179,179,21
Vs 180,180,21
Vs 181,181,21
Vs 182,182,21
Vs 183,183,21
Vs 184,184,21
Vs 185,185,21
Vs 186,186,21
Vs 187,187,21
Vs 188,188,21
Vs 189,189,21
Vs 190,190,21
Vs 191,191,21
Vs 240,240,21
Vs 241,241,21
Vs 242,242,21
Vs 243,243,21
Vs 244,244,21
Vs 245,245,21
Vs 246,246,21
Vs 247,247,21
Vs 248,248,21
Vs 249,249,21
Vs 250,250,21
Vs 251,251,21
Vs 252,252,21
Vs 253,253,21
Vs 254,254,21
Vs 255,255,21
Vs 44,44,21
Vs 45,45,21
Vs 46,46,21
v_sub_f32_e64 v47, v47, v21
v_exp_f32 v22, -v21
s_nop 0
Vm 60,60,22
Vm 61,61,22
Vm 62,62,22
v_mul_f32_e64 v63, v63, v22
Ar 8,96
Ar 9,97
Ar 10,98
Ar 11,99
Ar 12,100
Ar 13,101
Ar 14,102
Ar 15,103
Vm 8,8,22
Vm 9,9,22
Vm 10,10,22
Vm 11,11,22
Vm 12,12,22
Vm 13,13,22
Vm 14,14,22
Vm 15,15,22
Aw 96,8
Aw 97,9
Aw 98,10
Aw 99,11
Aw 100,12
Aw 101,13
Aw 102,14
Aw 103,15
Ar 8,104
Ar 9,105
Ar 10,106
Ar 11,107
Ar 12,108
Ar 13,109
Ar 14,110
Ar 15,111
Vm 8,8,22
Vm 9,9,22
Vm 10,10,22
Vm 11,11,22
Vm 12,12,22
Vm 13,13,22
Vm 14,14,22
Vm 15,15,22
Aw 104,8
Aw 105,9
Aw 106,10
Aw 107,11
Aw 108,12
Aw 109,13
Aw 110,14
Aw 111,15
Ar 8,112
Ar 9,113
Ar 10,114
Ar 11,115
Ar 12,116
Ar 13,117
Ar 14,118
Ar 15,119
Vm 8,8,22
Vm 9,9,22
Vm 10,10,22
Vm 11,11,22
Vm 12,12,22
Vm 13,13,22
Vm 14,14,22
Vm 15,15,22
Aw 112,8
Aw 113,9
Aw 114,10
Aw 115,11
Aw 116,12
Aw 117,13
Aw 118,14
Aw 119,15
Ar 8,120
Ar 9,121
Ar 10,122
Ar 11,123
Ar 12,124
Ar 13,125
Ar 14,126
Ar 15,127
Vm 8,8,22
Vm 9,9,22
Vm 10,10,22
Vm 11,11,22
Vm 12,12,22
Vm 13,13,22
Vm 14,14,22
Vm 15,15,22
Aw 120,8
Aw 121,9
Aw 122,10
Aw 123,11
Aw 124,12
Aw 125,13
Aw 126,14
Aw 127,15
Ve 8,128
Ve 9,129
s_nop 0
Vc 64,8,9
Ve 8,130
Ve 9,131
s_nop 0
Vc 65,8,9
Ve 8,144
Ve 9,145
s_nop 0
Vc 72,8,9
Ve 8,146
Ve 9,147
s_nop 0
Vc 73,8,9
Ve 8,160
Ve 9,161
s_nop 0
Vc 80,8,9
Ve 8,162
Ve 9,163
s_nop 0
Vc 81,8,9
Ve 8,176
Ve 9,177
s_nop 0
Vc 88,8,9
Ve 8,178
Ve 9,179
s_nop 0
Vc 89,8,9
Ve 8,132
Ve 9,133
s_nop 0
Vc 66,8,9
Ve 8,134
Ve 9,135
s_nop 0
Vc 67,8,9
Ve 8,148
Ve 9,149
s_nop 0
Vc 74,8,9
Ve 8,150
Ve 9,151
s_nop 0
Vc 75,8,9
Ve 8,164
Ve 9,165
s_nop 0
Vc 82,8,9
Ve 8,166
Ve 9,167
s_nop 0
Vc 83,8,9
Ve 8,180
Ve 9,181
s_nop 0
Vc 90,8,9
Ve 8,182
Ve 9,183
s_nop 0
Vc 91,8,9
Ve 8,136
Ve 9,137
s_nop 0
Vc 68,8,9
Ve 8,138
Ve 9,139
s_nop 0
Vc 69,8,9
Ve 8,152
Ve 9,153
s_nop 0
Vc 76,8,9
Ve 8,154
Ve 9,155
s_nop 0
Vc 77,8,9
Ve 8,168
Ve 9,169
s_nop 0
Vc 84,8,9
Ve 8,170
Ve 9,171
s_nop 0
Vc 85,8,9
Ve 8,184
Ve 9,185
s_nop 0
Vc 92,8,9
Ve 8,186
Ve 9,187
s_nop 0
Vc 93,8,9
Ve 8,140
Ve 9,141
s_nop 0
Vc 70,8,9
Ve 8,142
Ve 9,143
s_nop 0
Vc 71,8,9
Ve 8,156
Ve 9,157
s_nop 0
Vc 78,8,9
Ve 8,158
Ve 9,159
s_nop 0
Vc 79,8,9
Ve 8,172
Ve 9,173
s_nop 0
Vc 86,8,9
Ve 8,174
Ve 9,175
s_nop 0
Vc 87,8,9
Ve 8,188
Ve 9,189
s_nop 0
Vc 94,8,9
Ve 8,190
Ve 9,191
s_nop 0
Vc 95,8,9
s_nop 1
s_branch L_k2_fbr_we
L_k2_fb_wo:
s_nop 7
s_nop 0
v_max3_f32 v21, v192, v193, v194
v_max3_f32 v21, v21, v195, v196
v_max3_f32 v21, v21, v197, v198
v_max3_f32 v21, v21, v199, v200
v_max3_f32 v21, v21, v201, v202
v_max3_f32 v21, v21, v203, v204
v_max3_f32 v21, v21, v205, v206
v_max_f32 v21, v21, v207
v_mov_b32 v1, v21
s_nop 1
v_permlane16_swap_b32 v1, v21
v_max_f32 v21, v21, v1
v_mov_b32 v1, v21
s_nop 1
v_permlane32_swap_b32 v1, v21
v_max_f32_e64 v21, v21, v1
v_add_f32 v21, 0x41f80000, v21
v_max_f32 v21, 0, v21
Vs 192,192,21
Vs 193,193,21
Vs 194,194,21
Vs 195,195,21
Vs 196,196,21
Vs 197,197,21
Vs 198,198,21
Vs 199,199,21
Vs 200,200,21
Vs 201,201,21
Vs 202,202,21
Vs 203,203,21
Vs 204,204,21
Vs 205,205,21
Vs 206,206,21
Vs 207,207,21
Vs 128,128,21
Vs 129,129,21
Vs 130,130,21
Vs 131,131,21
Vs 132,132,21
Vs 133,133,21
Vs 134,134,21
Vs 135,135,21
Vs 136,136,21
Vs 137,137,21
Vs 138,138,21
Vs 139,139,21
Vs 140,140,21
Vs 141,141,21
Vs 142,142,21
Vs 143,143,21
Vs 32,32,21
Vs 33,33,21
Vs 34,34,21
v_sub_f32_e64 v35, v35, v21
v_exp_f32 v22, -v21
s_nop 0
Vm 48,48,22
Vm 49,49,22
Vm 50,50,22
v_mul_f32_e64 v51, v51, v22
Ar 8,0
Ar 9,1
Ar 10,2
Ar 11,3
Ar 12,4
Ar 13,5
Ar 14,6
Ar 15,7
Vm 8,8,22
Vm 9,9,22
Vm 10,10,22
Vm 11,11,22
Vm 12,12,22
Vm 13,13,22
Vm 14,14,22
Vm 15,15,22
Aw 0,8
Aw 1,9
Aw 2,10
Aw 3,11
Aw 4,12
Aw 5,13
Aw 6,14
Aw 7,15
Ar 8,8
Ar 9,9
Ar 10,10
Ar 11,11
Ar 12,12
Ar 13,13
Ar 14,14
Ar 15,15
Vm 8,8,22
Vm 9,9,22
Vm 10,10,22
Vm 11,11,22
Vm 12,12,22
Vm 13,13,22
Vm 14,14,22
Vm 15,15,22
Aw 8,8
Aw 9,9
Aw 10,10
Aw 11,11
Aw 12,12
Aw 13,13
Aw 14,14
Aw 15,15
Ar 8,16
Ar 9,17
Ar 10,18
Ar 11,19
Ar 12,20
Ar 13,21
Ar 14,22
Ar 15,23
Vm 8,8,22
Vm 9,9,22
Vm 10,10,22
Vm 11,11,22
Vm 12,12,22
Vm 13,13,22
Vm 14,14,22
Vm 15,15,22
Aw 16,8
Aw 17,9
Aw 18,10
Aw 19,11
Aw 20,12
Aw 21,13
Aw 22,14
Aw 23,15
Ar 8,24
Ar 9,25
Ar 10,26
Ar 11,27
Ar 12,28
Ar 13,29
Ar 14,30
Ar 15,31
Vm 8,8,22
Vm 9,9,22
Vm 10,10,22
Vm 11,11,22
Vm 12,12,22
Vm 13,13,22
Vm 14,14,22
Vm 15,15,22
Aw 24,8
Aw 25,9
Aw 26,10
Aw 27,11
Aw 28,12
Aw 29,13
Aw 30,14
Aw 31,15
v_max3_f32 v21, v208, v209, v210
v_max3_f32 v21, v21, v211, v212
v_max3_f32 v21, v21, v213, v214
v_max3_f32 v21, v21, v215, v216
v_max3_f32 v21, v21, v217, v218
v_max3_f32 v21, v21, v219, v220
v_max3_f32 v21, v21, v221, v222
v_max_f32 v21, v21, v223
v_mov_b32 v1, v21
s_nop 1
v_permlane16_swap_b32 v1, v21
v_max_f32 v21, v21, v1
v_mov_b32 v1, v21
s_nop 1
v_permlane32_swap_b32 v1, v21
v_max_f32_e64 v21, v21, v1
v_add_f32 v21, 0x41f80000, v21
v_max_f32 v21, 0, v21
Vs 208,208,21
Vs 209,209,21
Vs 210,210,21
Vs 211,211,21
Vs 212,212,21
Vs 213,213,21
Vs 214,214,21
Vs 215,215,21
Vs 216,216,21
Vs 217,217,21
Vs 218,218,21
Vs 219,219,21
Vs 220,220,21
Vs 221,221,21
Vs 222,222,21
Vs 223,223,21
Vs 144,144,21
Vs 145,145,21
Vs 146,146,21
Vs 147,147,21
Vs 148,148,21
Vs 149,149,21
Vs 150,150,21
Vs 151,151,21
Vs 152,152,21
Vs 153,153,21
Vs 154,154,21
Vs 155,155,21
Vs 156,156,21
Vs 157,157,21
Vs 158,158,21
Vs 159,159,21
Vs 36,36,21
Vs 37,37,21
Vs 38,38,21
v_sub_f32_e64 v39, v39, v21
v_exp_f32 v22, -v21
s_nop 0
Vm 52,52,22
Vm 53,53,22
Vm 54,54,22
v_mul_f32_e64 v55, v55, v22
Ar 8,32
Ar 9,33
Ar 10,34
Ar 11,35
Ar 12,36
Ar 13,37
Ar 14,38
Ar 15,39
Vm 8,8,22
Vm 9,9,22
Vm 10,10,22
Vm 11,11,22
Vm 12,12,22
Vm 13,13,22
Vm 14,14,22
Vm 15,15,22
Aw 32,8
Aw 33,9
Aw 34,10
Aw 35,11
Aw 36,12
Aw 37,13
Aw 38,14
Aw 39,15
Ar 8,40
Ar 9,41
Ar 10,42
Ar 11,43
Ar 12,44
Ar 13,45
Ar 14,46
Ar 15,47
Vm 8,8,22
Vm 9,9,22
Vm 10,10,22
Vm 11,11,22
Vm 12,12,22
Vm 13,13,22
Vm 14,14,22
Vm 15,15,22
Aw 40,8
Aw 41,9
Aw 42,10
Aw 43,11
Aw 44,12
Aw 45,13
Aw 46,14
Aw 47,15
Ar 8,48
Ar 9,49
Ar 10,50
Ar 11,51
Ar 12,52
Ar 13,53
Ar 14,54
Ar 15,55
Vm 8,8,22
Vm 9,9,22
Vm 10,10,22
Vm 11,11,22
Vm 12,12,22
Vm 13,13,22
Vm 14,14,22
Vm 15,15,22
Aw 48,8
Aw 49,9
Aw 50,10
Aw 51,11
Aw 52,12
Aw 53,13
Aw 54,14
Aw 55,15
Ar 8,56
Ar 9,57
Ar 10,58
Ar 11,59
Ar 12,60
Ar 13,61
Ar 14,62
Ar 15,63
Vm 8,8,22
Vm 9,9,22
Vm 10,10,22
Vm 11,11,22
Vm 12,12,22
Vm 13,13,22
Vm 14,14,22
Vm 15,15,22
Aw 56,8
Aw 57,9
Aw 58,10
Aw 59,11
Aw 60,12
Aw 61,13
Aw 62,14
Aw 63,15
v_max3_f32 v21, v224, v225, v226
v_max3_f32 v21, v21, v227, v228
v_max3_f32 v21, v21, v229, v230
v_max3_f32 v21, v21, v231, v232
v_max3_f32 v21, v21, v233, v234
v_max3_f32 v21, v21, v235, v236
v_max3_f32 v21, v21, v237, v238
v_max_f32 v21, v21, v239
v_mov_b32 v1, v21
s_nop 1
v_permlane16_swap_b32 v1, v21
v_max_f32 v21, v21, v1
v_mov_b32 v1, v21
s_nop 1
v_permlane32_swap_b32 v1, v21
v_max_f32_e64 v21, v21, v1
v_add_f32 v21, 0x41f80000, v21
v_max_f32 v21, 0, v21
Vs 224,224,21
Vs 225,225,21
Vs 226,226,21
Vs 227,227,21
Vs 228,228,21
Vs 229,229,21
Vs 230,230,21
Vs 231,231,21
Vs 232,232,21
Vs 233,233,21
Vs 234,234,21
Vs 235,235,21
Vs 236,236,21
Vs 237,237,21
Vs 238,238,21
Vs 239,239,21
Vs 160,160,21
Vs 161,161,21
Vs 162,162,21
Vs 163,163,21
Vs 164,164,21
Vs 165,165,21
Vs 166,166,21
Vs 167,167,21
Vs 168,168,21
Vs 169,169,21
Vs 170,170,21
Vs 171,171,21
Vs 172,172,21
Vs 173,173,21
Vs 174,174,21
Vs 175,175,21
Vs 40,40,21
Vs 41,41,21
Vs 42,42,21
v_sub_f32_e64 v43, v43, v21
v_exp_f32 v22, -v21
s_nop 0
Vm 56,56,22
Vm 57,57,22
Vm 58,58,22
v_mul_f32_e64 v59, v59, v22
Ar 8,64
Ar 9,65
Ar 10,66
Ar 11,67
Ar 12,68
Ar 13,69
Ar 14,70
Ar 15,71
Vm 8,8,22
Vm 9,9,22
Vm 10,10,22
Vm 11,11,22
Vm 12,12,22
Vm 13,13,22
Vm 14,14,22
Vm 15,15,22
Aw 64,8
Aw 65,9
Aw 66,10
Aw 67,11
Aw 68,12
Aw 69,13
Aw 70,14
Aw 71,15
Ar 8,72
Ar 9,73
Ar 10,74
Ar 11,75
Ar 12,76
Ar 13,77
Ar 14,78
Ar 15,79
Vm 8,8,22
Vm 9,9,22
Vm 10,10,22
Vm 11,11,22
Vm 12,12,22
Vm 13,13,22
Vm 14,14,22
Vm 15,15,22
Aw 72,8
Aw 73,9
Aw 74,10
Aw 75,11
Aw 76,12
Aw 77,13
Aw 78,14
Aw 79,15
Ar 8,80
Ar 9,81
Ar 10,82
Ar 11,83
Ar 12,84
Ar 13,85
Ar 14,86
Ar 15,87
Vm 8,8,22
Vm 9,9,22
Vm 10,10,22
Vm 11,11,22
Vm 12,12,22
Vm 13,13,22
Vm 14,14,22
Vm 15,15,22
Aw 80,8
Aw 81,9
Aw 82,10
Aw 83,11
Aw 84,12
Aw 85,13
Aw 86,14
Aw 87,15
Ar 8,88
Ar 9,89
Ar 10,90
Ar 11,91
Ar 12,92
Ar 13,93
Ar 14,94
Ar 15,95
Vm 8,8,22
Vm 9,9,22
Vm 10,10,22
Vm 11,11,22
Vm 12,12,22
Vm 13,13,22
Vm 14,14,22
Vm 15,15,22
Aw 88,8
Aw 89,9
Aw 90,10
Aw 91,11
Aw 92,12
Aw 93,13
Aw 94,14
Aw 95,15
v_max3_f32 v21, v240, v241, v242
v_max3_f32 v21, v21, v243, v244
v_max3_f32 v21, v21, v245, v246
v_max3_f32 v21, v21, v247, v248
v_max3_f32 v21, v21, v249, v250
v_max3_f32 v21, v21, v251, v252
v_max3_f32 v21, v21, v253, v254
v_max_f32 v21, v21, v255
v_mov_b32 v1, v21
s_nop 1
v_permlane16_swap_b32 v1, v21
v_max_f32 v21, v21, v1
v_mov_b32 v1, v21
s_nop 1
v_permlane32_swap_b32 v1, v21
v_max_f32_e64 v21, v21, v1
v_add_f32 v21, 0x41f80000, v21
v_max_f32 v21, 0, v21
Vs 240,240,21
Vs 241,241,21
Vs 242,242,21
Vs 243,243,21
Vs 244,244,21
Vs 245,245,21
Vs 246,246,21
Vs 247,247,21
Vs 248,248,21
Vs 249,249,21
Vs 250,250,21
Vs 251,251,21
Vs 252,252,21
Vs 253,253,21
Vs 254,254,21
Vs 255,255,21
Vs 176,176,21
Vs 177,177,21
Vs 178,178,21
Vs 179,179,21
Vs 180,180,21
Vs 181,181,21
Vs 182,182,21
Vs 183,183,21
Vs 184,184,21
Vs 185,185,21
Vs 186,186,21
Vs 187,187,21
Vs 188,188,21
Vs 189,189,21
Vs 190,190,21
Vs 191,191,21
Vs 44,44,21
Vs 45,45,21
Vs 46,46,21
v_sub_f32_e64 v47, v47, v21
v_exp_f32 v22, -v21
s_nop 0
Vm 60,60,22
Vm 61,61,22
Vm 62,62,22
v_mul_f32_e64 v63, v63, v22
Ar 8,96
Ar 9,97
Ar 10,98
Ar 11,99
Ar 12,100
Ar 13,101
Ar 14,102
Ar 15,103
Vm 8,8,22
Vm 9,9,22
Vm 10,10,22
Vm 11,11,22
Vm 12,12,22
Vm 13,13,22
Vm 14,14,22
Vm 15,15,22
Aw 96,8
Aw 97,9
Aw 98,10
Aw 99,11
Aw 100,12
Aw 101,13
Aw 102,14
Aw 103,15
Ar 8,104
Ar 9,105
Ar 10,106
Ar 11,107
Ar 12,108
Ar 13,109
Ar 14,110
Ar 15,111
Vm 8,8,22
Vm 9,9,22
Vm 10,10,22
Vm 11,11,22
Vm 12,12,22
Vm 13,13,22
Vm 14,14,22
Vm 15,15,22
Aw 104,8
Aw 105,9
Aw 106,10
Aw 107,11
Aw 108,12
Aw 109,13
Aw 110,14
Aw 111,15
Ar 8,112
Ar 9,113
Ar 10,114
Ar 11,115
Ar 12,116
Ar 13,117
Ar 14,118
Ar 15,119
Vm 8,8,22
Vm 9,9,22
Vm 10,10,22
Vm 11,11,22
Vm 12,12,22
Vm 13,13,22
Vm 14,14,22
Vm 15,15,22
Aw 112,8
Aw 113,9
Aw 114,10
Aw 115,11
Aw 116,12
Aw 117,13
Aw 118,14
Aw 119,15
Ar 8,120
Ar 9,121
Ar 10,122
Ar 11,123
Ar 12,124
Ar 13,125
Ar 14,126
Ar 15,127
Vm 8,8,22
Vm 9,9,22
Vm 10,10,22
Vm 11,11,22
Vm 12,12,22
Vm 13,13,22
Vm 14,14,22
Vm 15,15,22
Aw 120,8
Aw 121,9
Aw 122,10
Aw 123,11
Aw 124,12
Aw 125,13
Aw 126,14
Aw 127,15
Ve 8,192
Ve 9,193
s_nop 0
Vc 96,8,9
Ve 8,194
Ve 9,195
s_nop 0
Vc 97,8,9
Ve 8,208
Ve 9,209
s_nop 0
Vc 104,8,9
Ve 8,210
Ve 9,211
s_nop 0
Vc 105,8,9
Ve 8,224
Ve 9,225
s_nop 0
Vc 112,8,9
Ve 8,226
Ve 9,227
s_nop 0
Vc 113,8,9
Ve 8,240
Ve 9,241
s_nop 0
Vc 120,8,9
Ve 8,242
Ve 9,243
s_nop 0
Vc 121,8,9
Ve 8,196
Ve 9,197
s_nop 0
Vc 98,8,9
Ve 8,198
Ve 9,199
s_nop 0
Vc 99,8,9
Ve 8,212
Ve 9,213
s_nop 0
Vc 106,8,9
Ve 8,214
Ve 9,215
s_nop 0
Vc 107,8,9
Ve 8,228
Ve 9,229
s_nop 0
Vc 114,8,9
Ve 8,230
Ve 9,231
s_nop 0
Vc 115,8,9
Ve 8,244
Ve 9,245
s_nop 0
Vc 122,8,9
Ve 8,246
Ve 9,247
s_nop 0
Vc 123,8,9
Ve 8,200
Ve 9,201
s_nop 0
Vc 100,8,9
Ve 8,202
Ve 9,203
s_nop 0
Vc 101,8,9
Ve 8,216
Ve 9,217
s_nop 0
Vc 108,8,9
Ve 8,218
Ve 9,219
s_nop 0
Vc 109,8,9
Ve 8,232
Ve 9,233
s_nop 0
Vc 116,8,9
Ve 8,234
Ve 9,235
s_nop 0
Vc 117,8,9
Ve 8,248
Ve 9,249
s_nop 0
Vc 124,8,9
Ve 8,250
Ve 9,251
s_nop 0
Vc 125,8,9
Ve 8,204
Ve 9,205
s_nop 0
Vc 102,8,9
Ve 8,206
Ve 9,207
s_nop 0
Vc 103,8,9
Ve 8,220
Ve 9,221
s_nop 0
Vc 110,8,9
Ve 8,222
Ve 9,223
s_nop 0
Vc 111,8,9
Ve 8,236
Ve 9,237
s_nop 0
Vc 118,8,9
Ve 8,238
Ve 9,239
s_nop 0
Vc 119,8,9
Ve 8,252
Ve 9,253
s_nop 0
Vc 126,8,9
Ve 8,254
Ve 9,255
s_nop 0
Vc 127,8,9
s_nop 1
s_branch L_k2_fbr_wo
L_k2_fb_wl:
s_nop 7
s_nop 0
v_max3_f32 v21, v128, v129, v130
v_max3_f32 v21, v21, v131, v132
v_max3_f32 v21, v21, v133, v134
v_max3_f32 v21, v21, v135, v136
v_max3_f32 v21, v21, v137, v138
v_max3_f32 v21, v21, v139, v140
v_max3_f32 v21, v21, v141, v142
v_max_f32 v21, v21, v143
v_mov_b32 v1, v21
s_nop 1
v_permlane16_swap_b32 v1, v21
v_max_f32 v21, v21, v1
v_mov_b32 v1, v21
s_nop 1
v_permlane32_swap_b32 v1, v21
v_max_f32_e64 v21, v21, v1
v_add_f32 v21, 0x41f80000, v21
v_max_f32 v21, 0, v21
Vs 128,128,21
Vs 129,129,21
Vs 130,130,21
Vs 131,131,21
Vs 132,132,21
Vs 133,133,21
Vs 134,134,21
Vs 135,135,21
Vs 136,136,21
Vs 137,137,21
Vs 138,138,21
Vs 139,139,21
Vs 140,140,21
Vs 141,141,21
Vs 142,142,21
Vs 143,143,21
Vs 192,192,21
Vs 193,193,21
Vs 194,194,21
Vs 195,195,21
Vs 196,196,21
Vs 197,197,21
Vs 198,198,21
Vs 199,199,21
Vs 200,200,21
Vs 201,201,21
Vs 202,202,21
Vs 203,203,21
Vs 204,204,21
Vs 205,205,21
Vs 206,206,21
Vs 207,207,21
Vs 32,32,21
Vs 33,33,21
Vs 34,34,21
v_sub_f32_e64 v35, v35, v21
v_exp_f32 v22, -v21
s_nop 0
Vm 48,48,22
Vm 49,49,22
Vm 50,50,22
v_mul_f32_e64 v51, v51, v22
Ar 8,0
Ar 9,1
Ar 10,2
Ar 11,3
Ar 12,4
Ar 13,5
Ar 14,6
Ar 15,7
Vm 8,8,22
Vm 9,9,22
Vm 10,10,22
Vm 11,11,22
Vm 12,12,22
Vm 13,13,22
Vm 14,14,22
Vm 15,15,22
Aw 0,8
Aw 1,9
Aw 2,10
Aw 3,11
Aw 4,12
Aw 5,13
Aw 6,14
Aw 7,15
Ar 8,8
Ar 9,9
Ar 10,10
Ar 11,11
Ar 12,12
Ar 13,13
Ar 14,14
Ar 15,15
Vm 8,8,22
Vm 9,9,22
Vm 10,10,22
Vm 11,11,22
Vm 12,12,22
Vm 13,13,22
Vm 14,14,22
Vm 15,15,22
Aw 8,8
Aw 9,9
Aw 10,10
Aw 11,11
Aw 12,12
Aw 13,13
Aw 14,14
Aw 15,15
Ar 8,16
Ar 9,17
Ar 10,18
Ar 11,19
Ar 12,20
Ar 13,21
Ar 14,22
Ar 15,23
Vm 8,8,22
Vm 9,9,22
Vm 10,10,22
Vm 11,11,22
Vm 12,12,22
Vm 13,13,22
Vm 14,14,22
Vm 15,15,22
Aw 16,8
Aw 17,9
Aw 18,10
Aw 19,11
Aw 20,12
Aw 21,13
Aw 22,14
Aw 23,15
Ar 8,24
Ar 9,25
Ar 10,26
Ar 11,27
Ar 12,28
Ar 13,29
Ar 14,30
Ar 15,31
Vm 8,8,22
Vm 9,9,22
Vm 10,10,22
Vm 11,11,22
Vm 12,12,22
Vm 13,13,22
Vm 14,14,22
Vm 15,15,22
Aw 24,8
Aw 25,9
Aw 26,10
Aw 27,11
Aw 28,12
Aw 29,13
Aw 30,14
Aw 31,15
v_max3_f32 v21, v144, v145, v146
v_max3_f32 v21, v21, v147, v148
v_max3_f32 v21, v21, v149, v150
v_max3_f32 v21, v21, v151, v152
v_max3_f32 v21, v21, v153, v154
v_max3_f32 v21, v21, v155, v156
v_max3_f32 v21, v21, v157, v158
v_max_f32 v21, v21, v159
v_mov_b32 v1, v21
s_nop 1
v_permlane16_swap_b32 v1, v21
v_max_f32 v21, v21, v1
v_mov_b32 v1, v21
s_nop 1
v_permlane32_swap_b32 v1, v21
v_max_f32_e64 v21, v21, v1
v_add_f32 v21, 0x41f80000, v21
v_max_f32 v21, 0, v21
Vs 144,144,21
Vs 145,145,21
Vs 146,146,21
Vs 147,147,21
Vs 148,148,21
Vs 149,149,21
Vs 150,150,21
Vs 151,151,21
Vs 152,152,21
Vs 153,153,21
Vs 154,154,21
Vs 155,155,21
Vs 156,156,21
Vs 157,157,21
Vs 158,158,21
Vs 159,159,21
Vs 208,208,21
Vs 209,209,21
Vs 210,210,21
Vs 211,211,21
Vs 212,212,21
Vs 213,213,21
Vs 214,214,21
Vs 215,215,21
Vs 216,216,21
Vs 217,217,21
Vs 218,218,21
Vs 219,219,21
Vs 220,220,21
Vs 221,221,21
Vs 222,222,21
Vs 223,223,21
Vs 36,36,21
Vs 37,37,21
Vs 38,38,21
v_sub_f32_e64 v39, v39, v21
v_exp_f32 v22, -v21
s_nop 0
Vm 52,52,22
Vm 53,53,22
Vm 54,54,22
v_mul_f32_e64 v55, v55, v22
Ar 8,32
Ar 9,33
Ar 10,34
Ar 11,35
Ar 12,36
Ar 13,37
Ar 14,38
Ar 15,39
Vm 8,8,22
Vm 9,9,22
Vm 10,10,22
Vm 11,11,22
Vm 12,12,22
Vm 13,13,22
Vm 14,14,22
Vm 15,15,22
Aw 32,8
Aw 33,9
Aw 34,10
Aw 35,11
Aw 36,12
Aw 37,13
Aw 38,14
Aw 39,15
Ar 8,40
Ar 9,41
Ar 10,42
Ar 11,43
Ar 12,44
Ar 13,45
Ar 14,46
Ar 15,47
Vm 8,8,22
Vm 9,9,22
Vm 10,10,22
Vm 11,11,22
Vm 12,12,22
Vm 13,13,22
Vm 14,14,22
Vm 15,15,22
Aw 40,8
Aw 41,9
Aw 42,10
Aw 43,11
Aw 44,12
Aw 45,13
Aw 46,14
Aw 47,15
Ar 8,48
Ar 9,49
Ar 10,50
Ar 11,51
Ar 12,52
Ar 13,53
Ar 14,54
Ar 15,55
Vm 8,8,22
Vm 9,9,22
Vm 10,10,22
Vm 11,11,22
Vm 12,12,22
Vm 13,13,22
Vm 14,14,22
Vm 15,15,22
Aw 48,8
Aw 49,9
Aw 50,10
Aw 51,11
Aw 52,12
Aw 53,13
Aw 54,14
Aw 55,15
Ar 8,56
Ar 9,57
Ar 10,58
Ar 11,59
Ar 12,60
Ar 13,61
Ar 14,62
Ar 15,63
Vm 8,8,22
Vm 9,9,22
Vm 10,10,22
Vm 11,11,22
Vm 12,12,22
Vm 13,13,22
Vm 14,14,22
Vm 15,15,22
Aw 56,8
Aw 57,9
Aw 58,10
Aw 59,11
Aw 60,12
Aw 61,13
Aw 62,14
Aw 63,15
v_max3_f32 v21, v160, v161, v162
v_max3_f32 v21, v21, v163, v164
v_max3_f32 v21, v21, v165, v166
v_max3_f32 v21, v21, v167, v168
v_max3_f32 v21, v21, v169, v170
v_max3_f32 v21, v21, v171, v172
v_max3_f32 v21, v21, v173, v174
v_max_f32 v21, v21, v175
v_mov_b32 v1, v21
s_nop 1
v_permlane16_swap_b32 v1, v21
v_max_f32 v21, v21, v1
v_mov_b32 v1, v21
s_nop 1
v_permlane32_swap_b32 v1, v21
v_max_f32_e64 v21, v21, v1
v_add_f32 v21, 0x41f80000, v21
v_max_f32 v21, 0, v21
Vs 160,160,21
Vs 161,161,21
Vs 162,162,21
Vs 163,163,21
Vs 164,164,21
Vs 165,165,21
Vs 166,166,21
Vs 167,167,21
Vs 168,168,21
Vs 169,169,21
Vs 170,170,21
Vs 171,171,21
Vs 172,172,21
Vs 173,173,21
Vs 174,174,21
Vs 175,175,21
Vs 224,224,21
Vs 225,225,21
Vs 226,226,21
Vs 227,227,21
Vs 228,228,21
Vs 229,229,21
Vs 230,230,21
Vs 231,231,21
Vs 232,232,21
Vs 233,233,21
Vs 234,234,21
Vs 235,235,21
Vs 236,236,21
Vs 237,237,21
Vs 238,238,21
Vs 239,239,21
Vs 40,40,21
Vs 41,41,21
Vs 42,42,21
v_sub_f32_e64 v43, v43, v21
v_exp_f32 v22, -v21
s_nop 0
Vm 56,56,22
Vm 57,57,22
Vm 58,58,22
v_mul_f32_e64 v59, v59, v22
Ar 8,64
Ar 9,65
Ar 10,66
Ar 11,67
Ar 12,68
Ar 13,69
Ar 14,70
Ar 15,71
Vm 8,8,22
Vm 9,9,22
Vm 10,10,22
Vm 11,11,22
Vm 12,12,22
Vm 13,13,22
Vm 14,14,22
Vm 15,15,22
Aw 64,8
Aw 65,9
Aw 66,10
Aw 67,11
Aw 68,12
Aw 69,13
Aw 70,14
Aw 71,15
Ar 8,72
Ar 9,73
Ar 10,74
Ar 11,75
Ar 12,76
Ar 13,77
Ar 14,78
Ar 15,79
Vm 8,8,22
Vm 9,9,22
Vm 10,10,22
Vm 11,11,22
Vm 12,12,22
Vm 13,13,22
Vm 14,14,22
Vm 15,15,22
Aw 72,8
Aw 73,9
Aw 74,10
Aw 75,11
Aw 76,12
Aw 77,13
Aw 78,14
Aw 79,15
Ar 8,80
Ar 9,81
Ar 10,82
Ar 11,83
Ar 12,84
Ar 13,85
Ar 14,86
Ar 15,87
Vm 8,8,22
Vm 9,9,22
Vm 10,10,22
Vm 11,11,22
Vm 12,12,22
Vm 13,13,22
Vm 14,14,22
Vm 15,15,22
Aw 80,8
Aw 81,9
Aw 82,10
Aw 83,11
Aw 84,12
Aw 85,13
Aw 86,14
Aw 87,15
Ar 8,88
Ar 9,89
Ar 10,90
Ar 11,91
Ar 12,92
Ar 13,93
Ar 14,94
Ar 15,95
Vm 8,8,22
Vm 9,9,22
Vm 10,10,22
Vm 11,11,22
Vm 12,12,22
Vm 13,13,22
Vm 14,14,22
Vm 15,15,22
Aw 88,8
Aw 89,9
Aw 90,10
Aw 91,11
Aw 92,12
Aw 93,13
Aw 94,14
Aw 95,15
v_max3_f32 v21, v176, v177, v178
v_max3_f32 v21, v21, v179, v180
v_max3_f32 v21, v21, v181, v182
v_max3_f32 v21, v21, v183, v184
v_max3_f32 v21, v21, v185, v186
v_max3_f32 v21, v21, v187, v188
v_max3_f32 v21, v21, v189, v190
v_max_f32 v21, v21, v191
v_mov_b32 v1, v21
s_nop 1
v_permlane16_swap_b32 v1, v21
v_max_f32 v21, v21, v1
v_mov_b32 v1, v21
s_nop 1
v_permlane32_swap_b32 v1, v21
v_max_f32_e64 v21, v21, v1
v_add_f32 v21, 0x41f80000, v21
v_max_f32 v21, 0, v21
Vs 176,176,21
Vs 177,177,21
Vs 178,178,21
Vs 179,179,21
Vs 180,180,21
Vs 181,181,21
Vs 182,182,21
Vs 183,183,21
Vs 184,184,21
Vs 185,185,21
Vs 186,186,21
Vs 187,187,21
Vs 188,188,21
Vs 189,189,21
Vs 190,190,21
Vs 191,191,21
Vs 44,44,21
Vs 45,45,21
Vs 46,46,21
v_sub_f32_e64 v47, v47, v21
v_exp_f32 v22, -v21
s_nop 0
Vm 60,60,22
Vm 61,61,22
Vm 62,62,22
v_mul_f32_e64 v63, v63, v22
Ar 8,96
Ar 9,97
Ar 10,98
Ar 11,99
Ar 12,100
Ar 13,101
Ar 14,102
Ar 15,103
Vm 8,8,22
Vm 9,9,22
Vm 10,10,22
Vm 11,11,22
Vm 12,12,22
Vm 13,13,22
Vm 14,14,22
Vm 15,15,22
Aw 96,8
Aw 97,9
Aw 98,10
Aw 99,11
Aw 100,12
Aw 101,13
Aw 102,14
Aw 103,15
Ar 8,104
Ar 9,105
Ar 10,106
Ar 11,107
Ar 12,108
Ar 13,109
Ar 14,110
Ar 15,111
Vm 8,8,22
Vm 9,9,22
Vm 10,10,22
Vm 11,11,22
Vm 12,12,22
Vm 13,13,22
Vm 14,14,22
Vm 15,15,22
Aw 104,8
Aw 105,9
Aw 106,10
Aw 107,11
Aw 108,12
Aw 109,13
Aw 110,14
Aw 111,15
Ar 8,112
Ar 9,113
Ar 10,114
Ar 11,115
Ar 12,116
Ar 13,117
Ar 14,118
Ar 15,119
Vm 8,8,22
Vm 9,9,22
Vm 10,10,22
Vm 11,11,22
Vm 12,12,22
Vm 13,13,22
Vm 14,14,22
Vm 15,15,22
Aw 112,8
Aw 113,9
Aw 114,10
Aw 115,11
Aw 116,12
Aw 117,13
Aw 118,14
Aw 119,15
Ar 8,120
Ar 9,121
Ar 10,122
Ar 11,123
Ar 12,124
Ar 13,125
Ar 14,126
Ar 15,127
Vm 8,8,22
Vm 9,9,22
Vm 10,10,22
Vm 11,11,22
Vm 12,12,22
Vm 13,13,22
Vm 14,14,22
Vm 15,15,22
Aw 120,8
Aw 121,9
Aw 122,10
Aw 123,11
Aw 124,12
Aw 125,13
Aw 126,14
Aw 127,15
Ve 8,128
Ve 9,129
s_nop 0
Vc 64,8,9
Ve 8,130
Ve 9,131
s_nop 0
Vc 65,8,9
Ve 8,144
Ve 9,145
s_nop 0
Vc 72,8,9
Ve 8,146
Ve 9,147
s_nop 0
Vc 73,8,9
Ve 8,160
Ve 9,161
s_nop 0
Vc 80,8,9
Ve 8,162
Ve 9,163
s_nop 0
Vc 81,8,9
Ve 8,176
Ve 9,177
s_nop 0
Vc 88,8,9
Ve 8,178
Ve 9,179
s_nop 0
Vc 89,8,9
Ve 8,132
Ve 9,133
s_nop 0
Vc 66,8,9
Ve 8,134
Ve 9,135
s_nop 0
Vc 67,8,9
Ve 8,148
Ve 9,149
s_nop 0
Vc 74,8,9
Ve 8,150
Ve 9,151
s_nop 0
Vc 75,8,9
Ve 8,164
Ve 9,165
s_nop 0
Vc 82,8,9
Ve 8,166
Ve 9,167
s_nop 0
Vc 83,8,9
Ve 8,180
Ve 9,181
s_nop 0
Vc 90,8,9
Ve 8,182
Ve 9,183
s_nop 0
Vc 91,8,9
Ve 8,136
Ve 9,137
s_nop 0
Vc 68,8,9
Ve 8,138
Ve 9,139
s_nop 0
Vc 69,8,9
Ve 8,152
Ve 9,153
s_nop 0
Vc 76,8,9
Ve 8,154
Ve 9,155
s_nop 0
Vc 77,8,9
Ve 8,168
Ve 9,169
s_nop 0
Vc 84,8,9
Ve 8,170
Ve 9,171
s_nop 0
Vc 85,8,9
Ve 8,184
Ve 9,185
s_nop 0
Vc 92,8,9
Ve 8,186
Ve 9,187
s_nop 0
Vc 93,8,9
Ve 8,140
Ve 9,141
s_nop 0
Vc 70,8,9
Ve 8,142
Ve 9,143
s_nop 0
Vc 71,8,9
Ve 8,156
Ve 9,157
s_nop 0
Vc 78,8,9
Ve 8,158
Ve 9,159
s_nop 0
Vc 79,8,9
Ve 8,172
Ve 9,173
s_nop 0
Vc 86,8,9
Ve 8,174
Ve 9,175
s_nop 0
Vc 87,8,9
Ve 8,188
Ve 9,189
s_nop 0
Vc 94,8,9
Ve 8,190
Ve 9,191
s_nop 0
Vc 95,8,9
s_nop 1
s_branch L_k2_fbr_wl
L_k2_fb_tr:
s_nop 7
s_nop 0
v_max3_f32 v21, v192, v193, v194
v_max3_f32 v21, v21, v195, v196
v_max3_f32 v21, v21, v197, v198
v_max3_f32 v21, v21, v199, v200
v_max3_f32 v21, v21, v201, v202
v_max3_f32 v21, v21, v203, v204
v_max3_f32 v21, v21, v205, v206
v_max_f32 v21, v21, v207
v_mov_b32 v1, v21
s_nop 1
v_permlane16_swap_b32 v1, v21
v_max_f32 v21, v21, v1
v_mov_b32 v1, v21
s_nop 1
v_permlane32_swap_b32 v1, v21
v_max_f32_e64 v21, v21, v1
v_add_f32 v21, 0x41f80000, v21
v_max_f32 v21, 0, v21
Vs 192,192,21
Vs 193,193,21
Vs 194,194,21
Vs 195,195,21
Vs 196,196,21
Vs 197,197,21
Vs 198,198,21
Vs 199,199,21
Vs 200,200,21
Vs 201,201,21
Vs 202,202,21
Vs 203,203,21
Vs 204,204,21
Vs 205,205,21
Vs 206,206,21
Vs 207,207,21
Vs 128,128,21
Vs 129,129,21
Vs 130,130,21
Vs 131,131,21
Vs 132,132,21
Vs 133,133,21
Vs 134,134,21
Vs 135,135,21
Vs 136,136,21
Vs 137,137,21
Vs 138,138,21
Vs 139,139,21
Vs 140,140,21
Vs 141,141,21
Vs 142,142,21
Vs 143,143,21
Vs 32,32,21
Vs 33,33,21
Vs 34,34,21
v_sub_f32_e64 v35, v35, v21
v_exp_f32 v22, -v21
s_nop 0
Vm 48,48,22
Vm 49,49,22
Vm 50,50,22
v_mul_f32_e64 v51, v51, v22
Ar 8,0
Ar 9,1
Ar 10,2
Ar 11,3
Ar 12,4
Ar 13,5
Ar 14,6
Ar 15,7
Vm 8,8,22
Vm 9,9,22
Vm 10,10,22
Vm 11,11,22
Vm 12,12,22
Vm 13,13,22
Vm 14,14,22
Vm 15,15,22
Aw 0,8
Aw 1,9
Aw 2,10
Aw 3,11
Aw 4,12
Aw 5,13
Aw 6,14
Aw 7,15
Ar 8,8
Ar 9,9
Ar 10,10
Ar 11,11
Ar 12,12
Ar 13,13
Ar 14,14
Ar 15,15
Vm 8,8,22
Vm 9,9,22
Vm 10,10,22
Vm 11,11,22
Vm 12,12,22
Vm 13,13,22
Vm 14,14,22
Vm 15,15,22
Aw 8,8
Aw 9,9
Aw 10,10
Aw 11,11
Aw 12,12
Aw 13,13
Aw 14,14
Aw 15,15
Ar 8,16
Ar 9,17
Ar 10,18
Ar 11,19
Ar 12,20
Ar 13,21
Ar 14,22
Ar 15,23
Vm 8,8,22
Vm 9,9,22
Vm 10,10,22
Vm 11,11,22
Vm 12,12,22
Vm 13,13,22
Vm 14,14,22
Vm 15,15,22
Aw 16,8
Aw 17,9
Aw 18,10
Aw 19,11
Aw 20,12
Aw 21,13
Aw 22,14
Aw 23,15
Ar 8,24
Ar 9,25
Ar 10,26
Ar 11,27
Ar 12,28
Ar 13,29
Ar 14,30
Ar 15,31
Vm 8,8,22
Vm 9,9,22
Vm 10,10,22
Vm 11,11,22
Vm 12,12,22
Vm 13,13,22
Vm 14,14,22
Vm 15,15,22
Aw 24,8
Aw 25,9
Aw 26,10
Aw 27,11
Aw 28,12
Aw 29,13
Aw 30,14
Aw 31,15
v_max3_f32 v21, v208, v209, v210
v_max3_f32 v21, v21, v211, v212
v_max3_f32 v21, v21, v213, v214
v_max3_f32 v21, v21, v215, v216
v_max3_f32 v21, v21, v217, v218
v_max3_f32 v21, v21, v219, v220
v_max3_f32 v21, v21, v221, v222
v_max_f32 v21, v21, v223
v_mov_b32 v1, v21
s_nop 1
v_permlane16_swap_b32 v1, v21
v_max_f32 v21, v21, v1
v_mov_b32 v1, v21
s_nop 1
v_permlane32_swap_b32 v1, v21
v_max_f32_e64 v21, v21, v1
v_add_f32 v21, 0x41f80000, v21
v_max_f32 v21, 0, v21
Vs 208,208,21
Vs 209,209,21
Vs 210,210,21
Vs 211,211,21
Vs 212,212,21
Vs 213,213,21
Vs 214,214,21
Vs 215,215,21
Vs 216,216,21
Vs 217,217,21
Vs 218,218,21
Vs 219,219,21
Vs 220,220,21
Vs 221,221,21
Vs 222,222,21
Vs 223,223,21
Vs 144,144,21
Vs 145,145,21
Vs 146,146,21
Vs 147,147,21
Vs 148,148,21
Vs 149,149,21
Vs 150,150,21
Vs 151,151,21
Vs 152,152,21
Vs 153,153,21
Vs 154,154,21
Vs 155,155,21
Vs 156,156,21
Vs 157,157,21
Vs 158,158,21
Vs 159,159,21
Vs 36,36,21
Vs 37,37,21
Vs 38,38,21
v_sub_f32_e64 v39, v39, v21
v_exp_f32 v22, -v21
s_nop 0
Vm 52,52,22
Vm 53,53,22
Vm 54,54,22
v_mul_f32_e64 v55, v55, v22
Ar 8,32
Ar 9,33
Ar 10,34
Ar 11,35
Ar 12,36
Ar 13,37
Ar 14,38
Ar 15,39
Vm 8,8,22
Vm 9,9,22
Vm 10,10,22
Vm 11,11,22
Vm 12,12,22
Vm 13,13,22
Vm 14,14,22
Vm 15,15,22
Aw 32,8
Aw 33,9
Aw 34,10
Aw 35,11
Aw 36,12
Aw 37,13
Aw 38,14
Aw 39,15
Ar 8,40
Ar 9,41
Ar 10,42
Ar 11,43
Ar 12,44
Ar 13,45
Ar 14,46
Ar 15,47
Vm 8,8,22
Vm 9,9,22
Vm 10,10,22
Vm 11,11,22
Vm 12,12,22
Vm 13,13,22
Vm 14,14,22
Vm 15,15,22
Aw 40,8
Aw 41,9
Aw 42,10
Aw 43,11
Aw 44,12
Aw 45,13
Aw 46,14
Aw 47,15
Ar 8,48
Ar 9,49
Ar 10,50
Ar 11,51
Ar 12,52
Ar 13,53
Ar 14,54
Ar 15,55
Vm 8,8,22
Vm 9,9,22
Vm 10,10,22
Vm 11,11,22
Vm 12,12,22
Vm 13,13,22
Vm 14,14,22
Vm 15,15,22
Aw 48,8
Aw 49,9
Aw 50,10
Aw 51,11
Aw 52,12
Aw 53,13
Aw 54,14
Aw 55,15
Ar 8,56
Ar 9,57
Ar 10,58
Ar 11,59
Ar 12,60
Ar 13,61
Ar 14,62
Ar 15,63
Vm 8,8,22
Vm 9,9,22
Vm 10,10,22
Vm 11,11,22
Vm 12,12,22
Vm 13,13,22
Vm 14,14,22
Vm 15,15,22
Aw 56,8
Aw 57,9
Aw 58,10
Aw 59,11
Aw 60,12
Aw 61,13
Aw 62,14
Aw 63,15
v_max3_f32 v21, v224, v225, v226
v_max3_f32 v21, v21, v227, v228
v_max3_f32 v21, v21, v229, v230
v_max3_f32 v21, v21, v231, v232
v_max3_f32 v21, v21, v233, v234
v_max3_f32 v21, v21, v235, v236
v_max3_f32 v21, v21, v237, v238
v_max_f32 v21, v21, v239
v_mov_b32 v1, v21
s_nop 1
v_permlane16_swap_b32 v1, v21
v_max_f32 v21, v21, v1
v_mov_b32 v1, v21
s_nop 1
v_permlane32_swap_b32 v1, v21
v_max_f32_e64 v21, v21, v1
v_add_f32 v21, 0x41f80000, v21
v_max_f32 v21, 0, v21
Vs 224,224,21
Vs 225,225,21
Vs 226,226,21
Vs 227,227,21
Vs 228,228,21
Vs 229,229,21
Vs 230,230,21
Vs 231,231,21
Vs 232,232,21
Vs 233,233,21
Vs 234,234,21
Vs 235,235,21
Vs 236,236,21
Vs 237,237,21
Vs 238,238,21
Vs 239,239,21
Vs 40,40,21
Vs 41,41,21
Vs 42,42,21
v_sub_f32_e64 v43, v43, v21
v_exp_f32 v22, -v21
s_nop 0
Vm 56,56,22
Vm 57,57,22
Vm 58,58,22
v_mul_f32_e64 v59, v59, v22
Ar 8,64
Ar 9,65
Ar 10,66
Ar 11,67
Ar 12,68
Ar 13,69
Ar 14,70
Ar 15,71
Vm 8,8,22
Vm 9,9,22
Vm 10,10,22
Vm 11,11,22
Vm 12,12,22
Vm 13,13,22
Vm 14,14,22
Vm 15,15,22
Aw 64,8
Aw 65,9
Aw 66,10
Aw 67,11
Aw 68,12
Aw 69,13
Aw 70,14
Aw 71,15
Ar 8,72
Ar 9,73
Ar 10,74
Ar 11,75
Ar 12,76
Ar 13,77
Ar 14,78
Ar 15,79
Vm 8,8,22
Vm 9,9,22
Vm 10,10,22
Vm 11,11,22
Vm 12,12,22
Vm 13,13,22
Vm 14,14,22
Vm 15,15,22
Aw 72,8
Aw 73,9
Aw 74,10
Aw 75,11
Aw 76,12
Aw 77,13
Aw 78,14
Aw 79,15
Ar 8,80
Ar 9,81
Ar 10,82
Ar 11,83
Ar 12,84
Ar 13,85
Ar 14,86
Ar 15,87
Vm 8,8,22
Vm 9,9,22
Vm 10,10,22
Vm 11,11,22
Vm 12,12,22
Vm 13,13,22
Vm 14,14,22
Vm 15,15,22
Aw 80,8
Aw 81,9
Aw 82,10
Aw 83,11
Aw 84,12
Aw 85,13
Aw 86,14
Aw 87,15
Ar 8,88
Ar 9,89
Ar 10,90
Ar 11,91
Ar 12,92
Ar 13,93
Ar 14,94
Ar 15,95
Vm 8,8,22
Vm 9,9,22
Vm 10,10,22
Vm 11,11,22
Vm 12,12,22
Vm 13,13,22
Vm 14,14,22
Vm 15,15,22
Aw 88,8
Aw 89,9
Aw 90,10
Aw 91,11
Aw 92,12
Aw 93,13
Aw 94,14
Aw 95,15
Ve 8,192
Ve 9,193
s_nop 0
Vc 96,8,9
Ve 8,194
Ve 9,195
s_nop 0
Vc 97,8,9
Ve 8,208
Ve 9,209
s_nop 0
Vc 104,8,9
Ve 8,210
Ve 9,211
s_nop 0
Vc 105,8,9
Ve 8,224
Ve 9,225
s_nop 0
Vc 112,8,9
Ve 8,226
Ve 9,227
s_nop 0
Vc 113,8,9
Ve 8,196
Ve 9,197
s_nop 0
Vc 98,8,9
Ve 8,198
Ve 9,199
s_nop 0
Vc 99,8,9
Ve 8,212
Ve 9,213
s_nop 0
Vc 106,8,9
Ve 8,214
Ve 9,215
s_nop 0
Vc 107,8,9
Ve 8,228
Ve 9,229
s_nop 0
Vc 114,8,9
Ve 8,230
Ve 9,231
s_nop 0
Vc 115,8,9
Ve 8,200
Ve 9,201
s_nop 0
Vc 100,8,9
Ve 8,202
Ve 9,203
s_nop 0
Vc 101,8,9
Ve 8,216
Ve 9,217
s_nop 0
Vc 108,8,9
Ve 8,218
Ve 9,219
s_nop 0
Vc 109,8,9
Ve 8,232
Ve 9,233
s_nop 0
Vc 116,8,9
Ve 8,234
Ve 9,235
s_nop 0
Vc 117,8,9
Ve 8,204
Ve 9,205
s_nop 0
Vc 102,8,9
Ve 8,206
Ve 9,207
s_nop 0
Vc 103,8,9
Ve 8,220
Ve 9,221
s_nop 0
Vc 110,8,9
Ve 8,222
Ve 9,223
s_nop 0
Vc 111,8,9
Ve 8,236
Ve 9,237
s_nop 0
Vc 118,8,9
Ve 8,238
Ve 9,239
s_nop 0
Vc 119,8,9
s_nop 1
s_branch L_k2_fbr_tr
L_k2_fb_ne:
s_nop 7
s_nop 0
v_max3_f32 v21, v128, v129, v130
v_max3_f32 v21, v21, v131, v132
v_max3_f32 v21, v21, v133, v134
v_max3_f32 v21, v21, v135, v136
v_max3_f32 v21, v21, v137, v138
v_max3_f32 v21, v21, v139, v140
v_max3_f32 v21, v21, v141, v142
v_max_f32 v21, v21, v143
v_mov_b32 v1, v21
s_nop 1
v_permlane16_swap_b32 v1, v21
v_max_f32 v21, v21, v1
v_mov_b32 v1, v21
s_nop 1
v_permlane32_swap_b32 v1, v21
v_max_f32_e64 v21, v21, v1
v_add_f32 v21, 0x41f80000, v21
v_max_f32 v21, 0, v21
Vs 128,128,21
Vs 129,129,21
Vs 130,130,21
Vs 131,131,21
Vs 132,132,21
Vs 133,133,21
Vs 134,134,21
Vs 135,135,21
Vs 136,136,21
Vs 137,137,21
Vs 138,138,21
Vs 139,139,21
Vs 140,140,21
Vs 141,141,21
Vs 142,142,21
Vs 143,143,21
Vs 192,192,21
Vs 193,193,21
Vs 194,194,21
Vs 195,195,21
Vs 196,196,21
Vs 197,197,21
Vs 198,198,21
Vs 199,199,21
Vs 200,200,21
Vs 201,201,21
Vs 202,202,21
Vs 203,203,21
Vs 204,204,21
Vs 205,205,21
Vs 206,206,21
Vs 207,207,21
Vs 32,32,21
Vs 33,33,21
Vs 34,34,21
v_sub_f32_e64 v35, v35, v21
v_exp_f32 v22, -v21
s_nop 0
Vm 48,48,22
Vm 49,49,22
Vm 50,50,22
v_mul_f32_e64 v51, v51, v22
Ar 8,0
Ar 9,1
Ar 10,2
Ar 11,3
Ar 12,4
Ar 13,5
Ar 14,6
Ar 15,7
Vm 8,8,22
Vm 9,9,22
Vm 10,10,22
Vm 11,11,22
Vm 12,12,22
Vm 13,13,22
Vm 14,14,22
Vm 15,15,22
Aw 0,8
Aw 1,9
Aw 2,10
Aw 3,11
Aw 4,12
Aw 5,13
Aw 6,14
Aw 7,15
Ar 8,8
Ar 9,9
Ar 10,10
Ar 11,11
Ar 12,12
Ar 13,13
Ar 14,14
Ar 15,15
Vm 8,8,22
Vm 9,9,22
Vm 10,10,22
Vm 11,11,22
Vm 12,12,22
Vm 13,13,22
Vm 14,14,22
Vm 15,15,22
Aw 8,8
Aw 9,9
Aw 10,10
Aw 11,11
Aw 12,12
Aw 13,13
Aw 14,14
Aw 15,15
Ar 8,16
Ar 9,17
Ar 10,18
Ar 11,19
Ar 12,20
Ar 13,21
Ar 14,22
Ar 15,23
Vm 8,8,22
Vm 9,9,22
Vm 10,10,22
Vm 11,11,22
Vm 12,12,22
Vm 13,13,22
Vm 14,14,22
Vm 15,15,22
Aw 16,8
Aw 17,9
Aw 18,10
Aw 19,11
Aw 20,12
Aw 21,13
Aw 22,14
Aw 23,15
Ar 8,24
Ar 9,25
Ar 10,26
Ar 11,27
Ar 12,28
Ar 13,29
Ar 14,30
Ar 15,31
Vm 8,8,22
Vm 9,9,22
Vm 10,10,22
Vm 11,11,22
Vm 12,12,22
Vm 13,13,22
Vm 14,14,22
Vm 15,15,22
Aw 24,8
Aw 25,9
Aw 26,10
Aw 27,11
Aw 28,12
Aw 29,13
Aw 30,14
Aw 31,15
v_max3_f32 v21, v144, v145, v146
v_max3_f32 v21, v21, v147, v148
v_max3_f32 v21, v21, v149, v150
v_max3_f32 v21, v21, v151, v152
v_max3_f32 v21, v21, v153, v154
v_max3_f32 v21, v21, v155, v156
v_max3_f32 v21, v21, v157, v158
v_max_f32 v21, v21, v159
v_mov_b32 v1, v21
s_nop 1
v_permlane16_swap_b32 v1, v21
v_max_f32 v21, v21, v1
v_mov_b32 v1, v21
s_nop 1
v_permlane32_swap_b32 v1, v21
v_max_f32_e64 v21, v21, v1
v_add_f32 v21, 0x41f80000, v21
v_max_f32 v21, 0, v21
Vs 144,144,21
Vs 145,145,21
Vs 146,146,21
Vs 147,147,21
Vs 148,148,21
Vs 149,149,21
Vs 150,150,21
Vs 151,151,21
Vs 152,152,21
Vs 153,153,21
Vs 154,154,21
Vs 155,155,21
Vs 156,156,21
Vs 157,157,21
Vs 158,158,21
Vs 159,159,21
Vs 208,208,21
Vs 209,209,21
Vs 210,210,21
Vs 211,211,21
Vs 212,212,21
Vs 213,213,21
Vs 214,214,21
Vs 215,215,21
Vs 216,216,21
Vs 217,217,21
Vs 218,218,21
Vs 219,219,21
Vs 220,220,21
Vs 221,221,21
Vs 222,222,21
Vs 223,223,21
Vs 36,36,21
Vs 37,37,21
Vs 38,38,21
v_sub_f32_e64 v39, v39, v21
v_exp_f32 v22, -v21
s_nop 0
Vm 52,52,22
Vm 53,53,22
Vm 54,54,22
v_mul_f32_e64 v55, v55, v22
Ar 8,32
Ar 9,33
Ar 10,34
Ar 11,35
Ar 12,36
Ar 13,37
Ar 14,38
Ar 15,39
Vm 8,8,22
Vm 9,9,22
Vm 10,10,22
Vm 11,11,22
Vm 12,12,22
Vm 13,13,22
Vm 14,14,22
Vm 15,15,22
Aw 32,8
Aw 33,9
Aw 34,10
Aw 35,11
Aw 36,12
Aw 37,13
Aw 38,14
Aw 39,15
Ar 8,40
Ar 9,41
Ar 10,42
Ar 11,43
Ar 12,44
Ar 13,45
Ar 14,46
Ar 15,47
Vm 8,8,22
Vm 9,9,22
Vm 10,10,22
Vm 11,11,22
Vm 12,12,22
Vm 13,13,22
Vm 14,14,22
Vm 15,15,22
Aw 40,8
Aw 41,9
Aw 42,10
Aw 43,11
Aw 44,12
Aw 45,13
Aw 46,14
Aw 47,15
Ar 8,48
Ar 9,49
Ar 10,50
Ar 11,51
Ar 12,52
Ar 13,53
Ar 14,54
Ar 15,55
Vm 8,8,22
Vm 9,9,22
Vm 10,10,22
Vm 11,11,22
Vm 12,12,22
Vm 13,13,22
Vm 14,14,22
Vm 15,15,22
Aw 48,8
Aw 49,9
Aw 50,10
Aw 51,11
Aw 52,12
Aw 53,13
Aw 54,14
Aw 55,15
Ar 8,56
Ar 9,57
Ar 10,58
Ar 11,59
Ar 12,60
Ar 13,61
Ar 14,62
Ar 15,63
Vm 8,8,22
Vm 9,9,22
Vm 10,10,22
Vm 11,11,22
Vm 12,12,22
Vm 13,13,22
Vm 14,14,22
Vm 15,15,22
Aw 56,8
Aw 57,9
Aw 58,10
Aw 59,11
Aw 60,12
Aw 61,13
Aw 62,14
Aw 63,15
Ve 8,128
Ve 9,129
s_nop 0
Vc 64,8,9
Ve 8,130
Ve 9,131
s_nop 0
Vc 65,8,9
Ve 8,144
Ve 9,145
s_nop 0
Vc 72,8,9
Ve 8,146
Ve 9,147
s_nop 0
Vc 73,8,9
Ve 8,132
Ve 9,133
s_nop 0
Vc 66,8,9
Ve 8,134
Ve 9,135
s_nop 0
Vc 67,8,9
Ve 8,148
Ve 9,149
s_nop 0
Vc 74,8,9
Ve 8,150
Ve 9,151
s_nop 0
Vc 75,8,9
Ve 8,136
Ve 9,137
s_nop 0
Vc 68,8,9
Ve 8,138
Ve 9,139
s_nop 0
Vc 69,8,9
Ve 8,152
Ve 9,153
s_nop 0
Vc 76,8,9
Ve 8,154
Ve 9,155
s_nop 0
Vc 77,8,9
Ve 8,140
Ve 9,141
s_nop 0
Vc 70,8,9
Ve 8,142
Ve 9,143
s_nop 0
Vc 71,8,9
Ve 8,156
Ve 9,157
s_nop 0
Vc 78,8,9
Ve 8,158
Ve 9,159
s_nop 0
Vc 79,8,9
s_nop 1
s_branch L_k2_fbr_ne
L_k2_fb_no:
s_nop 7
s_nop 0
v_max3_f32 v21, v192, v193, v194
v_max3_f32 v21, v21, v195, v196
v_max3_f32 v21, v21, v197, v198
v_max3_f32 v21, v21, v199, v200
v_max3_f32 v21, v21, v201, v202
v_max3_f32 v21, v21, v203, v204
v_max3_f32 v21, v21, v205, v206
v_max_f32 v21, v21, v207
v_mov_b32 v1, v21
s_nop 1
v_permlane16_swap_b32 v1, v21
v_max_f32 v21, v21, v1
v_mov_b32 v1, v21
s_nop 1
v_permlane32_swap_b32 v1, v21
v_max_f32_e64 v21, v21, v1
v_add_f32 v21, 0x41f80000, v21
v_max_f32 v21, 0, v21
Vs 192,192,21
Vs 193,193,21
Vs 194,194,21
Vs 195,195,21
Vs 196,196,21
Vs 197,197,21
Vs 198,198,21
Vs 199,199,21
Vs 200,200,21
Vs 201,201,21
Vs 202,202,21
Vs 203,203,21
Vs 204,204,21
Vs 205,205,21
Vs 206,206,21
Vs 207,207,21
Vs 128,128,21
Vs 129,129,21
Vs 130,130,21
Vs 131,131,21
Vs 132,132,21
Vs 133,133,21
Vs 134,134,21
Vs 135,135,21
Vs 136,136,21
Vs 137,137,21
Vs 138,138,21
Vs 139,139,21
Vs 140,140,21
Vs 141,141,21
Vs 142,142,21
Vs 143,143,21
Vs 32,32,21
Vs 33,33,21
Vs 34,34,21
v_sub_f32_e64 v35, v35, v21
v_exp_f32 v22, -v21
s_nop 0
Vm 48,48,22
Vm 49,49,22
Vm 50,50,22
v_mul_f32_e64 v51, v51, v22
Ar 8,0
Ar 9,1
Ar 10,2
Ar 11,3
Ar 12,4
Ar 13,5
Ar 14,6
Ar 15,7
Vm 8,8,22
Vm 9,9,22
Vm 10,10,22
Vm 11,11,22
Vm 12,12,22
Vm 13,13,22
Vm 14,14,22
Vm 15,15,22
Aw 0,8
Aw 1,9
Aw 2,10
Aw 3,11
Aw 4,12
Aw 5,13
Aw 6,14
Aw 7,15
Ar 8,8
Ar 9,9
Ar 10,10
Ar 11,11
Ar 12,12
Ar 13,13
Ar 14,14
Ar 15,15
Vm 8,8,22
Vm 9,9,22
Vm 10,10,22
Vm 11,11,22
Vm 12,12,22
Vm 13,13,22
Vm 14,14,22
Vm 15,15,22
Aw 8,8
Aw 9,9
Aw 10,10
Aw 11,11
Aw 12,12
Aw 13,13
Aw 14,14
Aw 15,15
Ar 8,16
Ar 9,17
Ar 10,18
Ar 11,19
Ar 12,20
Ar 13,21
Ar 14,22
Ar 15,23
Vm 8,8,22
Vm 9,9,22
Vm 10,10,22
Vm 11,11,22
Vm 12,12,22
Vm 13,13,22
Vm 14,14,22
Vm 15,15,22
Aw 16,8
Aw 17,9
Aw 18,10
Aw 19,11
Aw 20,12
Aw 21,13
Aw 22,14
Aw 23,15
Ar 8,24
Ar 9,25
Ar 10,26
Ar 11,27
Ar 12,28
Ar 13,29
Ar 14,30
Ar 15,31
Vm 8,8,22
Vm 9,9,22
Vm 10,10,22
Vm 11,11,22
Vm 12,12,22
Vm 13,13,22
Vm 14,14,22
Vm 15,15,22
Aw 24,8
Aw 25,9
Aw 26,10
Aw 27,11
Aw 28,12
Aw 29,13
Aw 30,14
Aw 31,15
v_max3_f32 v21, v208, v209, v210
v_max3_f32 v21, v21, v211, v212
v_max3_f32 v21, v21, v213, v214
v_max3_f32 v21, v21, v215, v216
v_max3_f32 v21, v21, v217, v218
v_max3_f32 v21, v21, v219, v220
v_max3_f32 v21, v21, v221, v222
v_max_f32 v21, v21, v223
v_mov_b32 v1, v21
s_nop 1
v_permlane16_swap_b32 v1, v21
v_max_f32 v21, v21, v1
v_mov_b32 v1, v21
s_nop 1
v_permlane32_swap_b32 v1, v21
v_max_f32_e64 v21, v21, v1
v_add_f32 v21, 0x41f80000, v21
v_max_f32 v21, 0, v21
Vs 208,208,21
Vs 209,209,21
Vs 210,210,21
Vs 211,211,21
Vs 212,212,21
Vs 213,213,21
Vs 214,214,21
Vs 215,215,21
Vs 216,216,21
Vs 217,217,21
Vs 218,218,21
Vs 219,219,21
Vs 220,220,21
Vs 221,221,21
Vs 222,222,21
Vs 223,223,21
Vs 144,144,21
Vs 145,145,21
Vs 146,146,21
Vs 147,147,21
Vs 148,148,21
Vs 149,149,21
Vs 150,150,21
Vs 151,151,21
Vs 152,152,21
Vs 153,153,21
Vs 154,154,21
Vs 155,155,21
Vs 156,156,21
Vs 157,157,21
Vs 158,158,21
Vs 159,159,21
Vs 36,36,21
Vs 37,37,21
Vs 38,38,21
v_sub_f32_e64 v39, v39, v21
v_exp_f32 v22, -v21
s_nop 0
Vm 52,52,22
Vm 53,53,22
Vm 54,54,22
v_mul_f32_e64 v55, v55, v22
Ar 8,32
Ar 9,33
Ar 10,34
Ar 11,35
Ar 12,36
Ar 13,37
Ar 14,38
Ar 15,39
Vm 8,8,22
Vm 9,9,22
Vm 10,10,22
Vm 11,11,22
Vm 12,12,22
Vm 13,13,22
Vm 14,14,22
Vm 15,15,22
Aw 32,8
Aw 33,9
Aw 34,10
Aw 35,11
Aw 36,12
Aw 37,13
Aw 38,14
Aw 39,15
Ar 8,40
Ar 9,41
Ar 10,42
Ar 11,43
Ar 12,44
Ar 13,45
Ar 14,46
Ar 15,47
Vm 8,8,22
Vm 9,9,22
Vm 10,10,22
Vm 11,11,22
Vm 12,12,22
Vm 13,13,22
Vm 14,14,22
Vm 15,15,22
Aw 40,8
Aw 41,9
Aw 42,10
Aw 43,11
Aw 44,12
Aw 45,13
Aw 46,14
Aw 47,15
Ar 8,48
Ar 9,49
Ar 10,50
Ar 11,51
Ar 12,52
Ar 13,53
Ar 14,54
Ar 15,55
Vm 8,8,22
Vm 9,9,22
Vm 10,10,22
Vm 11,11,22
Vm 12,12,22
Vm 13,13,22
Vm 14,14,22
Vm 15,15,22
Aw 48,8
Aw 49,9
Aw 50,10
Aw 51,11
Aw 52,12
Aw 53,13
Aw 54,14
Aw 55,15
Ar 8,56
Ar 9,57
Ar 10,58
Ar 11,59
Ar 12,60
Ar 13,61
Ar 14,62
Ar 15,63
Vm 8,8,22
Vm 9,9,22
Vm 10,10,22
Vm 11,11,22
Vm 12,12,22
Vm 13,13,22
Vm 14,14,22
Vm 15,15,22
Aw 56,8
Aw 57,9
Aw 58,10
Aw 59,11
Aw 60,12
Aw 61,13
Aw 62,14
Aw 63,15
Ve 8,192
Ve 9,193
s_nop 0
Vc 96,8,9
Ve 8,194
Ve 9,195
s_nop 0
Vc 97,8,9
Ve 8,208
Ve 9,209
s_nop 0
Vc 104,8,9
Ve 8,210
Ve 9,211
s_nop 0
Vc 105,8,9
Ve 8,196
Ve 9,197
s_nop 0
Vc 98,8,9
Ve 8,198
Ve 9,199
s_nop 0
Vc 99,8,9
Ve 8,212
Ve 9,213
s_nop 0
Vc 106,8,9
Ve 8,214
Ve 9,215
s_nop 0
Vc 107,8,9
Ve 8,200
Ve 9,201
s_nop 0
Vc 100,8,9
Ve 8,202
Ve 9,203
s_nop 0
Vc 101,8,9
Ve 8,216
Ve 9,217
s_nop 0
Vc 108,8,9
Ve 8,218
Ve 9,219
s_nop 0
Vc 109,8,9
Ve 8,204
Ve 9,205
s_nop 0
Vc 102,8,9
Ve 8,206
Ve 9,207
s_nop 0
Vc 103,8,9
Ve 8,220
Ve 9,221
s_nop 0
Vc 110,8,9
Ve 8,222
Ve 9,223
s_nop 0
Vc 111,8,9
s_nop 1
s_branch L_k2_fbr_no
L_k2_fb_nl:
s_nop 7
s_nop 0
v_max3_f32 v21, v128, v129, v130
v_max3_f32 v21, v21, v131, v132
v_max3_f32 v21, v21, v133, v134
v_max3_f32 v21, v21, v135, v136
v_max3_f32 v21, v21, v137, v138
v_max3_f32 v21, v21, v139, v140
v_max3_f32 v21, v21, v141, v142
v_max_f32 v21, v21, v143
v_mov_b32 v1, v21
s_nop 1
v_permlane16_swap_b32 v1, v21
v_max_f32 v21, v21, v1
v_mov_b32 v1, v21
s_nop 1
v_permlane32_swap_b32 v1, v21
v_max_f32_e64 v21, v21, v1
v_add_f32 v21, 0x41f80000, v21
v_max_f32 v21, 0, v21
Vs 128,128,21
Vs 129,129,21
Vs 130,130,21
Vs 131,131,21
Vs 132,132,21
Vs 133,133,21
Vs 134,134,21
Vs 135,135,21
Vs 136,136,21
Vs 137,137,21
Vs 138,138,21
Vs 139,139,21
Vs 140,140,21
Vs 141,141,21
Vs 142,142,21
Vs 143,143,21
Vs 192,192,21
Vs 193,193,21
Vs 194,194,21
Vs 195,195,21
Vs 196,196,21
Vs 197,197,21
Vs 198,198,21
Vs 199,199,21
Vs 200,200,21
Vs 201,201,21
Vs 202,202,21
Vs 203,203,21
Vs 204,204,21
Vs 205,205,21
Vs 206,206,21
Vs 207,207,21
Vs 32,32,21
Vs 33,33,21
Vs 34,34,21
v_sub_f32_e64 v35, v35, v21
v_exp_f32 v22, -v21
s_nop 0
Vm 48,48,22
Vm 49,49,22
Vm 50,50,22
v_mul_f32_e64 v51, v51, v22
Ar 8,0
Ar 9,1
Ar 10,2
Ar 11,3
Ar 12,4
Ar 13,5
Ar 14,6
Ar 15,7
Vm 8,8,22
Vm 9,9,22
Vm 10,10,22
Vm 11,11,22
Vm 12,12,22
Vm 13,13,22
Vm 14,14,22
Vm 15,15,22
Aw 0,8
Aw 1,9
Aw 2,10
Aw 3,11
Aw 4,12
Aw 5,13
Aw 6,14
Aw 7,15
Ar 8,8
Ar 9,9
Ar 10,10
Ar 11,11
Ar 12,12
Ar 13,13
Ar 14,14
Ar 15,15
Vm 8,8,22
Vm 9,9,22
Vm 10,10,22
Vm 11,11,22
Vm 12,12,22
Vm 13,13,22
Vm 14,14,22
Vm 15,15,22
Aw 8,8
Aw 9,9
Aw 10,10
Aw 11,11
Aw 12,12
Aw 13,13
Aw 14,14
Aw 15,15
Ar 8,16
Ar 9,17
Ar 10,18
Ar 11,19
Ar 12,20
Ar 13,21
Ar 14,22
Ar 15,23
Vm 8,8,22
Vm 9,9,22
Vm 10,10,22
Vm 11,11,22
Vm 12,12,22
Vm 13,13,22
Vm 14,14,22
Vm 15,15,22
Aw 16,8
Aw 17,9
Aw 18,10
Aw 19,11
Aw 20,12
Aw 21,13
Aw 22,14
Aw 23,15
Ar 8,24
Ar 9,25
Ar 10,26
Ar 11,27
Ar 12,28
Ar 13,29
Ar 14,30
Ar 15,31
Vm 8,8,22
Vm 9,9,22
Vm 10,10,22
Vm 11,11,22
Vm 12,12,22
Vm 13,13,22
Vm 14,14,22
Vm 15,15,22
Aw 24,8
Aw 25,9
Aw 26,10
Aw 27,11
Aw 28,12
Aw 29,13
Aw 30,14
Aw 31,15
v_max3_f32 v21, v144, v145, v146
v_max3_f32 v21, v21, v147, v148
v_max3_f32 v21, v21, v149, v150
v_max3_f32 v21, v21, v151, v152
v_max3_f32 v21, v21, v153, v154
v_max3_f32 v21, v21, v155, v156
v_max3_f32 v21, v21, v157, v158
v_max_f32 v21, v21, v159
v_mov_b32 v1, v21
s_nop 1
v_permlane16_swap_b32 v1, v21
v_max_f32 v21, v21, v1
v_mov_b32 v1, v21
s_nop 1
v_permlane32_swap_b32 v1, v21
v_max_f32_e64 v21, v21, v1
v_add_f32 v21, 0x41f80000, v21
v_max_f32 v21, 0, v21
Vs 144,144,21
Vs 145,145,21
Vs 146,146,21
Vs 147,147,21
Vs 148,148,21
Vs 149,149,21
Vs 150,150,21
Vs 151,151,21
Vs 152,152,21
Vs 153,153,21
Vs 154,154,21
Vs 155,155,21
Vs 156,156,21
Vs 157,157,21
Vs 158,158,21
Vs 159,159,21
Vs 36,36,21
Vs 37,37,21
Vs 38,38,21
v_sub_f32_e64 v39, v39, v21
v_exp_f32 v22, -v21
s_nop 0
Vm 52,52,22
Vm 53,53,22
Vm 54,54,22
v_mul_f32_e64 v55, v55, v22
Ar 8,32
Ar 9,33
Ar 10,34
Ar 11,35
Ar 12,36
Ar 13,37
Ar 14,38
Ar 15,39
Vm 8,8,22
Vm 9,9,22
Vm 10,10,22
Vm 11,11,22
Vm 12,12,22
Vm 13,13,22
Vm 14,14,22
Vm 15,15,22
Aw 32,8
Aw 33,9
Aw 34,10
Aw 35,11
Aw 36,12
Aw 37,13
Aw 38,14
Aw 39,15
Ar 8,40
Ar 9,41
Ar 10,42
Ar 11,43
Ar 12,44
Ar 13,45
Ar 14,46
Ar 15,47
Vm 8,8,22
Vm 9,9,22
Vm 10,10,22
Vm 11,11,22
Vm 12,12,22
Vm 13,13,22
Vm 14,14,22
Vm 15,15,22
Aw 40,8
Aw 41,9
Aw 42,10
Aw 43,11
Aw 44,12
Aw 45,13
Aw 46,14
Aw 47,15
Ar 8,48
Ar 9,49
Ar 10,50
Ar 11,51
Ar 12,52
Ar 13,53
Ar 14,54
Ar 15,55
Vm 8,8,22
Vm 9,9,22
Vm 10,10,22
Vm 11,11,22
Vm 12,12,22
Vm 13,13,22
Vm 14,14,22
Vm 15,15,22
Aw 48,8
Aw 49,9
Aw 50,10
Aw 51,11
Aw 52,12
Aw 53,13
Aw 54,14
Aw 55,15
Ar 8,56
Ar 9,57
Ar 10,58
Ar 11,59
Ar 12,60
Ar 13,61
Ar 14,62
Ar 15,63
Vm 8,8,22
Vm 9,9,22
Vm 10,10,22
Vm 11,11,22
Vm 12,12,22
Vm 13,13,22
Vm 14,14,22
Vm 15,15,22
Aw 56,8
Aw 57,9
Aw 58,10
Aw 59,11
Aw 60,12
Aw 61,13
Aw 62,14
Aw 63,15
Ve 8,128
Ve 9,129
s_nop 0
Vc 64,8,9
Ve 8,130
Ve 9,131
s_nop 0
Vc 65,8,9
Ve 8,144
Ve 9,145
s_nop 0
Vc 72,8,9
Ve 8,146
Ve 9,147
s_nop 0
Vc 73,8,9
Ve 8,132
Ve 9,133
s_nop 0
Vc 66,8,9
Ve 8,134
Ve 9,135
s_nop 0
Vc 67,8,9
Ve 8,148
Ve 9,149
s_nop 0
Vc 74,8,9
Ve 8,150
Ve 9,151
s_nop 0
Vc 75,8,9
Ve 8,136
Ve 9,137
s_nop 0
Vc 68,8,9
Ve 8,138
Ve 9,139
s_nop 0
Vc 69,8,9
Ve 8,152
Ve 9,153
s_nop 0
Vc 76,8,9
Ve 8,154
Ve 9,155
s_nop 0
Vc 77,8,9
Ve 8,140
Ve 9,141
s_nop 0
Vc 70,8,9
Ve 8,142
Ve 9,143
s_nop 0
Vc 71,8,9
Ve 8,156
Ve 9,157
s_nop 0
Vc 78,8,9
Ve 8,158
Ve 9,159
s_nop 0
Vc 79,8,9
s_nop 1
s_branch L_k2_fbr_nl
L_k2_fb_fi:
s_nop 7
s_nop 0
v_max3_f32 v21, v192, v193, v194
v_max3_f32 v21, v21, v195, v196
v_max3_f32 v21, v21, v197, v198
v_max3_f32 v21, v21, v199, v200
v_max3_f32 v21, v21, v201, v202
v_max3_f32 v21, v21, v203, v204
v_max3_f32 v21, v21, v205, v206
v_max_f32 v21, v21, v207
v_mov_b32 v1, v21
s_nop 1
v_permlane16_swap_b32 v1, v21
v_max_f32 v21, v21, v1
v_mov_b32 v1, v21
s_nop 1
v_permlane32_swap_b32 v1, v21
v_max_f32_e64 v21, v21, v1
v_add_f32 v21, 0x41f80000, v21
v_max_f32 v21, 0, v21
Vs 192,192,21
Vs 193,193,21
Vs 194,194,21
Vs 195,195,21
Vs 196,196,21
Vs 197,197,21
Vs 198,198,21
Vs 199,199,21
Vs 200,200,21
Vs 201,201,21
Vs 202,202,21
Vs 203,203,21
Vs 204,204,21
Vs 205,205,21
Vs 206,206,21
Vs 207,207,21
Vs 32,32,21
Vs 33,33,21
Vs 34,34,21
v_sub_f32_e64 v35, v35, v21
v_exp_f32 v22, -v21
s_nop 0
Vm 48,48,22
Vm 49,49,22
Vm 50,50,22
v_mul_f32_e64 v51, v51, v22
Ar 8,0
Ar 9,1
Ar 10,2
Ar 11,3
Ar 12,4
Ar 13,5
Ar 14,6
Ar 15,7
Vm 8,8,22
Vm 9,9,22
Vm 10,10,22
Vm 11,11,22
Vm 12,12,22
Vm 13,13,22
Vm 14,14,22
Vm 15,15,22
Aw 0,8
Aw 1,9
Aw 2,10
Aw 3,11
Aw 4,12
Aw 5,13
Aw 6,14
Aw 7,15
Ar 8,8
Ar 9,9
Ar 10,10
Ar 11,11
Ar 12,12
Ar 13,13
Ar 14,14
Ar 15,15
Vm 8,8,22
Vm 9,9,22
Vm 10,10,22
Vm 11,11,22
Vm 12,12,22
Vm 13,13,22
Vm 14,14,22
Vm 15,15,22
Aw 8,8
Aw 9,9
Aw 10,10
Aw 11,11
Aw 12,12
Aw 13,13
Aw 14,14
Aw 15,15
Ar 8,16
Ar 9,17
Ar 10,18
Ar 11,19
Ar 12,20
Ar 13,21
Ar 14,22
Ar 15,23
Vm 8,8,22
Vm 9,9,22
Vm 10,10,22
Vm 11,11,22
Vm 12,12,22
Vm 13,13,22
Vm 14,14,22
Vm 15,15,22
Aw 16,8
Aw 17,9
Aw 18,10
Aw 19,11
Aw 20,12
Aw 21,13
Aw 22,14
Aw 23,15
Ar 8,24
Ar 9,25
Ar 10,26
Ar 11,27
Ar 12,28
Ar 13,29
Ar 14,30
Ar 15,31
Vm 8,8,22
Vm 9,9,22
Vm 10,10,22
Vm 11,11,22
Vm 12,12,22
Vm 13,13,22
Vm 14,14,22
Vm 15,15,22
Aw 24,8
Aw 25,9
Aw 26,10
Aw 27,11
Aw 28,12
Aw 29,13
Aw 30,14
Aw 31,15
Ve 8,192
Ve 9,193
s_nop 0
Vc 96,8,9
Ve 8,194
Ve 9,195
s_nop 0
Vc 97,8,9
Ve 8,196
Ve 9,197
s_nop 0
Vc 98,8,9
Ve 8,198
Ve 9,199
s_nop 0
Vc 99,8,9
Ve 8,200
Ve 9,201
s_nop 0
Vc 100,8,9
Ve 8,202
Ve 9,203
s_nop 0
Vc 101,8,9
Ve 8,204
Ve 9,205
s_nop 0
Vc 102,8,9
Ve 8,206
Ve 9,207
s_nop 0
Vc 103,8,9
s_nop 1
s_branch L_k2_fbr_fi
L_spinX:
s_mov_b32 s47, 0x400000
L_spinXl:
buffer_load_dword v17, v126, s[20:23], s24 offen sc1
s_sub_u32 s47, s47, 1
s_waitcnt vmcnt(0)
s_cmp_eq_u32 s47, 0
s_cbranch_scc1 L_spinXlx
v_cmp_ne_u32 vcc, 1, v17
s_cbranch_vccz L_spinXlx
s_sleep 1
s_branch L_spinXl
L_spinXlx:
buffer_load_dwordx4 v[160:163], v112, s[16:19], s25 offen offset:0 sc1
buffer_load_dwordx4 v[164:167], v112, s[16:19], s25 offen offset:1024 sc1
buffer_load_dwordx4 v[168:171], v112, s[16:19], s25 offen offset:2048 sc1
buffer_load_dwordx4 v[172:175], v112, s[16:19], s25 offen offset:3072 sc1
buffer_load_dwordx4 v[176:179], v10, s[16:19], s25 offen offset:0 sc1
buffer_load_dwordx4 v[180:183], v10, s[16:19], s25 offen offset:1024 sc1
buffer_load_dwordx4 v[184:187], v10, s[16:19], s25 offen offset:2048 sc1
buffer_load_dwordx4 v[188:191], v10, s[16:19], s25 offen offset:3072 sc1
s_branch L_spinXr
L_ysl:
s_mov_b32 s47, 0x400000
L_ysll:
buffer_load_dword v124, v127, s[20:23], s41 offen sc1
s_sub_u32 s47, s47, 1
s_waitcnt vmcnt(0)
s_cmp_eq_u32 s47, 0
s_cbranch_scc1 L_ysllx
v_cmp_ne_u32 vcc, 1, v124
s_cbranch_vccz L_ysllx
s_sleep 8
s_branch L_ysll
L_ysllx:
v_lshlrev_b32 v124, 2, v0
v_lshlrev_b32 v125, 1, v0
s_lshl_b32 s7, s45, 2
s_add_u32 s7, s7, s32
s_lshr_b32 s3, s42, 5
s_cmp_lg_u32 s3, s7
s_cbranch_scc1 L_f_yl13
s_add_u32 s3, s55, 0
s_nop 0
s_add_u32 s7, s3, 4096
buffer_load_dword v76, v124, s[20:23], s3 offen offset:0 sc1
buffer_load_dword v77, v124, s[20:23], s3 offen offset:512 sc1
buffer_load_dword v78, v124, s[20:23], s3 offen offset:1024 sc1
buffer_load_dword v79, v124, s[20:23], s3 offen offset:1536 sc1
buffer_load_dword v80, v124, s[20:23], s3 offen offset:2048 sc1
buffer_load_dword v81, v124, s[20:23], s3 offen offset:2560 sc1
buffer_load_dword v82, v124, s[20:23], s3 offen offset:3072 sc1
buffer_load_dword v83, v124, s[20:23], s3 offen offset:3584 sc1
buffer_load_dword v84, v124, s[20:23], s7 offen offset:0 sc1
buffer_load_dword v85, v124, s[20:23], s7 offen offset:512 sc1
buffer_load_dword v86, v124, s[20:23], s7 offen offset:1024 sc1
buffer_load_dword v87, v124, s[20:23], s7 offen offset:1536 sc1
buffer_load_dword v88, v124, s[20:23], s7 offen offset:2048 sc1
buffer_load_dword v89, v124, s[20:23], s7 offen offset:2560 sc1
s_lshl_b32 s3, s42, 11
s_lshl_b32 s7, s46, 7
s_add_u32 s3, s3, s7
buffer_load_ushort v90, v125, s[56:59], s3 offen
s_lshl_b32 s3, s42, 3
s_add_u32 s3, s3, 5259264
buffer_load_dwordx2 v[92:93], v126, s[20:23], s3 offen sc1
L_f_yl13:
s_lshl_b32 s7, s45, 2
s_add_u32 s7, s7, s32
s_lshr_b32 s3, s43, 5
s_cmp_lg_u32 s3, s7
s_cbranch_scc1 L_f_yl14
s_nop 0
s_add_u32 s3, s55, 256
s_add_u32 s7, s3, 4096
buffer_load_dword v94, v124, s[20:23], s3 offen offset:0 sc1
buffer_load_dword v95, v124, s[20:23], s3 offen offset:512 sc1
buffer_load_dword v96, v124, s[20:23], s3 offen offset:1024 sc1
buffer_load_dword v97, v124, s[20:23], s3 offen offset:1536 sc1
buffer_load_dword v98, v124, s[20:23], s3 offen offset:2048 sc1
buffer_load_dword v99, v124, s[20:23], s3 offen offset:2560 sc1
buffer_load_dword v100, v124, s[20:23], s3 offen offset:3072 sc1
buffer_load_dword v101, v124, s[20:23], s3 offen offset:3584 sc1
buffer_load_dword v102, v124, s[20:23], s7 offen offset:0 sc1
buffer_load_dword v103, v124, s[20:23], s7 offen offset:512 sc1
buffer_load_dword v104, v124, s[20:23], s7 offen offset:1024 sc1
buffer_load_dword v105, v124, s[20:23], s7 offen offset:1536 sc1
buffer_load_dword v106, v124, s[20:23], s7 offen offset:2048 sc1
buffer_load_dword v107, v124, s[20:23], s7 offen offset:2560 sc1
s_lshl_b32 s3, s43, 11
s_lshl_b32 s7, s46, 7
s_add_u32 s3, s3, s7
buffer_load_ushort v108, v125, s[56:59], s3 offen
s_lshl_b32 s3, s43, 3
s_add_u32 s3, s3, 5259264
buffer_load_dwordx2 v[110:111], v126, s[20:23], s3 offen sc1
L_f_yl14:
s_waitcnt vmcnt(0)
s_lshl_b32 s7, s45, 2
s_add_u32 s7, s7, s32
s_lshr_b32 s3, s42, 5
s_cmp_lg_u32 s3, s7
s_cbranch_scc1 L_f_ys15
v_pk_add_f32 v[76:77], v[76:77], v[78:79]
v_pk_add_f32 v[76:77], v[76:77], v[80:81]
v_pk_add_f32 v[76:77], v[76:77], v[82:83]
v_pk_add_f32 v[76:77], v[76:77], v[84:85]
v_pk_add_f32 v[76:77], v[76:77], v[86:87]
v_pk_add_f32 v[76:77], v[76:77], v[88:89]
Va 76,76,77
v_lshlrev_b32 v90, 16, v90
v_sub_f32_e64 v90, v90, v92
Vc 76,76,76
v_lshlrev_b32_e64 v76, 16, v76
Vc 90,90,90
v_lshlrev_b32 v90, 16, v90
v_mul_f32 v76, s100, v76
v_mul_f32_e64 v90, v90, v93
Vc 76,76,76
v_lshlrev_b32_e64 v76, 16, v76
Vc 90,90,90
v_lshlrev_b32 v90, 16, v90
Va 90,90,76
Vc 90,90,90
v_lshlrev_b32_e64 v90, 16, v90
v_mul_f32 v76, 0xbfb8aa3b, v90
Ve 76,76
s_nop 0
v_add_f32 v76, 1.0, v76
v_rcp_f32 v76, v76
s_nop 0
Vm 90,90,76
Vc 90,90,90
v_lshlrev_b32 v90, 16, v90
v_lshlrev_b32 v124, 2, v0
v_add_u32 v124, s35, v124
v_lshlrev_b32 v125, 5, v122
v_add_u32 v125, s35, v125
s_waitcnt lgkmcnt(0)
ds_write_b32 v124, v90
s_and_b32 s3, s42, 7
s_lshl_b32 s3, s3, 3
s_lshl_b64 s[4:5], 0xff, s3
s_bfe_u32 s3, s42, 0x20003
s_mov_b64 exec, s[4:5]
s_cmp_lg_u32 s3, 0
s_cbranch_scc1 L_f_yp16
ds_read_b64 v[42:43], v125
ds_read_b64 v[44:45], v125 offset:8
ds_read_b64 v[46:47], v125 offset:16
ds_read_b64 v[48:49], v125 offset:24
L_f_yp16:
s_cmp_lg_u32 s3, 1
s_cbranch_scc1 L_f_yp17
ds_read_b64 v[50:51], v125
ds_read_b64 v[52:53], v125 offset:8
ds_read_b64 v[54:55], v125 offset:16
ds_read_b64 v[56:57], v125 offset:24
L_f_yp17:
s_cmp_lg_u32 s3, 2
s_cbranch_scc1 L_f_yp18
ds_read_b64 v[58:59], v125
ds_read_b64 v[60:61], v125 offset:8
ds_read_b64 v[62:63], v125 offset:16
ds_read_b64 v[64:65], v125 offset:24
L_f_yp18:
s_cmp_lg_u32 s3, 3
s_cbranch_scc1 L_f_yp19
ds_read_b64 v[66:67], v125
ds_read_b64 v[68:69], v125 offset:8
s_waitcnt lgkmcnt(9)
ds_read_b64 v[70:71], v125 offset:16
ds_read_b64 v[72:73], v125 offset:24
L_f_yp19:
s_mov_b64 exec, -1
s_waitcnt lgkmcnt(0)
L_f_ys15:
s_lshl_b32 s7, s45, 2
s_add_u32 s7, s7, s32
s_lshr_b32 s3, s43, 5
s_cmp_lg_u32 s3, s7
s_cbranch_scc1 L_f_ys20
s_nop 0
v_pk_add_f32 v[94:95], v[94:95], v[96:97]
v_pk_add_f32 v[94:95], v[94:95], v[98:99]
v_pk_add_f32 v[94:95], v[94:95], v[100:101]
v_pk_add_f32 v[94:95], v[94:95], v[102:103]
v_pk_add_f32 v[94:95], v[94:95], v[104:105]
v_pk_add_f32 v[94:95], v[94:95], v[106:107]
Va 94,94,95
v_lshlrev_b32 v108, 16, v108
v_sub_f32_e64 v108, v108, v110
Vc 94,94,94
v_lshlrev_b32_e64 v94, 16, v94
Vc 108,108,108
v_lshlrev_b32 v108, 16, v108
v_mul_f32 v94, s101, v94
v_mul_f32_e64 v108, v108, v111
Vc 94,94,94
v_lshlrev_b32_e64 v94, 16, v94
Vc 108,108,108
v_lshlrev_b32 v108, 16, v108
Va 108,108,94
Vc 108,108,108
v_lshlrev_b32_e64 v108, 16, v108
v_mul_f32 v94, 0xbfb8aa3b, v108
Ve 94,94
s_nop 0
v_add_f32 v94, 1.0, v94
v_rcp_f32 v94, v94
s_nop 0
Vm 108,108,94
Vc 108,108,108
v_lshlrev_b32 v108, 16, v108
v_lshlrev_b32 v124, 2, v0
v_add_u32 v124, s35, v124
v_lshlrev_b32 v125, 5, v122
v_add_u32 v125, s35, v125
s_waitcnt lgkmcnt(0)
ds_write_b32 v124, v108
s_and_b32 s3, s43, 7
s_lshl_b32 s3, s3, 3
s_lshl_b64 s[4:5], 0xff, s3
s_bfe_u32 s3, s43, 0x20003
s_mov_b64 exec, s[4:5]
s_cmp_lg_u32 s3, 0
s_cbranch_scc1 L_f_yp21
ds_read_b64 v[42:43], v125
ds_read_b64 v[44:45], v125 offset:8
ds_read_b64 v[46:47], v125 offset:16
ds_read_b64 v[48:49], v125 offset:24
L_f_yp21:
s_cmp_lg_u32 s3, 1
s_cbranch_scc1 L_f_yp22
ds_read_b64 v[50:51], v125
ds_read_b64 v[52:53], v125 offset:8
ds_read_b64 v[54:55], v125 offset:16
ds_read_b64 v[56:57], v125 offset:24
L_f_yp22:
s_cmp_lg_u32 s3, 2
s_cbranch_scc1 L_f_yp23
ds_read_b64 v[58:59], v125
ds_read_b64 v[60:61], v125 offset:8
ds_read_b64 v[62:63], v125 offset:16
ds_read_b64 v[64:65], v125 offset:24
L_f_yp23:
s_cmp_lg_u32 s3, 3
s_cbranch_scc1 L_f_yp24
ds_read_b64 v[66:67], v125
ds_read_b64 v[68:69], v125 offset:8
s_waitcnt lgkmcnt(9)
ds_read_b64 v[70:71], v125 offset:16
ds_read_b64 v[72:73], v125 offset:24
L_f_yp24:
s_mov_b64 exec, -1
s_waitcnt lgkmcnt(0)
L_f_ys20:
s_branch L_yslr
.section .rodata,"a"
.p2align 6
.amdhsa_kernel recurrent_scan__compressed_kv_cla__moe_arch_mod__prompt_kernel
  .amdhsa_next_free_vgpr 512
  .amdhsa_next_free_sgpr 102
  .amdhsa_accum_offset 256
  .amdhsa_group_segment_fixed_size 0
  .amdhsa_kernarg_size 112
  .amdhsa_user_sgpr_count 2
  .amdhsa_user_sgpr_kernarg_segment_ptr 1
  .amdhsa_system_sgpr_workgroup_id_x 1
.end_amdhsa_kernel
```

```asm
; @launch grid=(256,1,1) block=(256,1,1) lds=163840
.amdgcn_target "amdgcn-amd-amdhsa--gfx950"
.macro Va d,x,y
v_add_f32 v\d, v\x, v\y
.endm
.macro Vc d,x,y
v_cvt_pk_bf16_f32 v\d, v\x, v\y
.endm
.macro Ra d,x,o
ds_read_b128 a[\d:\d+3], v\x offset:\o
.endm
.macro Ta d,x,o
ds_read_b64_tr_b16 a[\d:\d+1], v\x offset:\o
.endm
.macro Zvaa d,x,y
v_mfma_f32_16x16x32_bf16 v[\d:\d+3], a[\x:\x+3], a[\y:\y+3], 0
.endm
.macro Mvaa d,x,y
v_mfma_f32_16x16x32_bf16 v[\d:\d+3], a[\x:\x+3], a[\y:\y+3], v[\d:\d+3]
.endm
.macro Rv d,x,o
ds_read_b128 v[\d:\d+3], v\x offset:\o
.endm
.macro Zaaa d,x,y
v_mfma_f32_16x16x32_bf16 a[\d:\d+3], a[\x:\x+3], a[\y:\y+3], 0
.endm
.macro Maaa d,x,y
v_mfma_f32_16x16x32_bf16 a[\d:\d+3], a[\x:\x+3], a[\y:\y+3], a[\d:\d+3]
.endm
.macro Ar d,x
v_accvgpr_read_b32 v\d, a\x
.endm
.macro Ve d,x
v_exp_f32 v\d, v\x
.endm
.macro Aw d,x
v_accvgpr_write_b32 a\d, v\x
.endm
.macro Vs d,x,y
v_sub_f32 v\d, v\x, v\y
.endm
.macro Cvaa d,x,y,c
v_mfma_f32_16x16x32_bf16 v[\d:\d+3], a[\x:\x+3], a[\y:\y+3], v[\c:\c+3]
.endm
.macro VE d,x
v_exp_f32_e64 v\d, v\x
.endm
.macro Maav d,x,y
v_mfma_f32_16x16x32_bf16 a[\d:\d+3], a[\x:\x+3], v[\y:\y+3], a[\d:\d+3]
.endm
.macro Mvvv d,x,y
v_mfma_f32_16x16x32_bf16 v[\d:\d+3], v[\x:\x+3], v[\y:\y+3], v[\d:\d+3]
.endm
.macro Zvva d,x,y
v_mfma_f32_16x16x32_bf16 v[\d:\d+3], v[\x:\x+3], a[\y:\y+3], 0
.endm
.macro Mvva d,x,y
v_mfma_f32_16x16x32_bf16 v[\d:\d+3], v[\x:\x+3], a[\y:\y+3], v[\d:\d+3]
.endm
.macro Vm d,x,y
v_mul_f32 v\d, v\x, v\y
.endm
.macro Zvvv d,x,y
v_mfma_f32_16x16x32_bf16 v[\d:\d+3], v[\x:\x+3], v[\y:\y+3], 0
.endm
.text
.globl recurrent_scan__compressed_kv_cla__moe_arch_mod__prompt_kernel
.p2align 8
.type recurrent_scan__compressed_kv_cla__moe_arch_mod__prompt_kernel,@function
recurrent_scan__compressed_kv_cla__moe_arch_mod__prompt_kernel:
s_cmp_ge_u32 s2, 256
s_cbranch_scc1 L_k2_end
s_load_dwordx4 s[4:7], s[0:1], 0
s_load_dwordx2 s[44:45], s[0:1], 56
s_load_dwordx4 s[40:43], s[0:1], 24
s_load_dwordx4 s[64:67], s[0:1], 96
v_lshrrev_b32 v1, 6, v0
v_and_b32 v0, 63, v0
v_readfirstlane_b32 s32, v1
s_getpc_b64 s[68:69]
L_cpf1:
s_add_u32 s68, s68, (recurrent_scan__compressed_kv_cla__moe_arch_mod__prompt_kernel-L_cpf1)&0xffffffff
s_addc_u32 s69, s69, ((recurrent_scan__compressed_kv_cla__moe_arch_mod__prompt_kernel-L_cpf1)>>32)&0xffffffff
s_lshr_b32 s70, s2, 3
s_lshl_b32 s70, s70, 2
s_add_u32 s70, s70, s32
s_lshl_b32 s70, s70, 10
v_and_b32 v122, 7, v0
v_lshlrev_b32 v122, 7, v122
v_add_u32 v122, s70, v122
v_min_u32 v122, L_k2_fin-recurrent_scan__compressed_kv_cla__moe_arch_mod__prompt_kernel-4, v122
v_mov_b32 v121, s69
v_add_co_u32 v120, vcc, s68, v122
s_nop 1
v_addc_co_u32 v121, vcc, 0, v121, vcc
global_load_dword v124, v[120:121], off
v_lshrrev_b32 v33, 5, v0
v_and_b32 v31, 31, v0
v_lshlrev_b32_e64 v36, 4, v31
v_lshl_add_u32 v35, v33, 11, v36
s_lshl_b32 s36, s2, 14
s_lshl_b32 s37, s32, 12
s_add_u32 s36, s36, s37
s_mov_b32 s18, 4194304
s_mov_b32 s19, 0x20000
s_bfe_u32 s33, s2, 0x30003
s_lshr_b32 s35, s2, 7
s_bfe_u32 s3, s2, 0x10006
s_and_b32 s34, s2, 7
s_lshl_b32 s34, s34, 1
s_add_u32 s34, s34, s3
s_waitcnt lgkmcnt(0)
s_mov_b32 s16, s4
s_and_b32 s17, s5, 0xffff
buffer_load_dwordx4 v[48:51], v35, s[16:19], s36 offen offset:0
buffer_load_dwordx4 v[52:55], v35, s[16:19], s36 offen offset:512
buffer_load_dwordx4 v[56:59], v35, s[16:19], s36 offen offset:1024
buffer_load_dwordx4 v[60:63], v35, s[16:19], s36 offen offset:1536
s_cmp_eq_u32 s35, 0
s_cselect_b32 s40, s40, s42
s_cselect_b32 s41, s41, s43
s_lshl_b32 s3, s34, 9
s_add_u32 s12, s40, s3
s_addc_u32 s13, s41, 0
s_and_b32 s13, s13, 0xffff
s_mov_b32 s14, 0
s_mov_b32 s15, 0x20000
s_sub_u32 s14, 4194304, s3
s_lshl_b32 s3, s33, 18
s_add_u32 s8, s6, s3
s_addc_u32 s9, s7, 0
s_and_b32 s9, s9, 0xffff
s_mov_b32 s10, 262144
s_mov_b32 s11, 0x20000
s_and_b32 s58, s2, 7
s_mov_b32 s52, 0
s_mov_b32 s53, 15360
s_mov_b32 s54, 30720
s_mov_b32 s55, 46080
s_lshl_b32 s57, s32, 13
s_add_u32 s56, s57, 32768
s_lshl_b32 s3, s58, 2
s_add_u32 s3, s3, s32
s_lshl_b32 s3, s3, 4
v_add_u32 v30, s3, v33
v_lshlrev_b32 v30, 13, v30
v_lshlrev_b32 v34, 5, v33
v_xor_b32 v34, v34, v36
v_add_u32 v6, v34, v30
v_xor_b32_e64 v7, 64, v6
v_xor_b32 v8, 65664, v6
v_xor_b32 v9, 65728, v6
s_add_u32 m0, s57, 0
s_nop 0
buffer_load_dwordx4 v6, s[12:15], s52 offen offset:0 lds
buffer_load_dwordx4 v7, s[12:15], s53 offen offset:1024 lds
buffer_load_dwordx4 v6, s[12:15], s54 offen offset:2048 lds
buffer_load_dwordx4 v7, s[12:15], s55 offen offset:3072 lds
s_add_u32 m0, s57, 4096
s_nop 0
s_nop 0
buffer_load_dwordx4 v8, s[12:15], s52 offen offset:0 lds
buffer_load_dwordx4 v9, s[12:15], s53 offen offset:1024 lds
buffer_load_dwordx4 v8, s[12:15], s54 offen offset:2048 lds
buffer_load_dwordx4 v9, s[12:15], s55 offen offset:3072 lds
v_xor_b32 v6, 524288, v6
v_xor_b32 v7, 524288, v7
v_xor_b32 v8, 524288, v8
v_xor_b32 v9, 524288, v9
s_mov_b32 s48, 0
s_mov_b32 s49, 7168
s_mov_b32 s50, 14336
s_mov_b32 s51, 21504
v_lshrrev_b32 v30, 3, v0
v_lshlrev_b32 v30, 10, v30
s_lshl_b32 s3, s32, 16
s_lshl_b32 s39, s58, 7
s_add_u32 s3, s3, s39
v_and_b32 v31, 7, v0
v_lshrrev_b32 v32, 4, v0
v_xor_b32_e64 v31, v31, v32
v_lshl_add_u32 v30, v31, 4, v30
v_add_u32 v2, s3, v30
v_xor_b32 v3, 64, v2
v_xor_b32 v4, 32768, v2
v_xor_b32 v5, 32832, v2
s_cmp_lt_u32 s32, 2
s_cselect_b32 s60, s8, s12
s_cselect_b32 s61, s9, s13
s_cselect_b32 s62, s10, s14
s_mov_b32 s63, 0x20000
s_mov_b32 s59, 524288
s_cselect_b32 s59, 128, s59
s_cselect_b64 vcc, -1, 0
s_cselect_b32 s38, 32, 16
s_lshr_b32 s3, s2, 6
s_cmp_lt_u32 s32, 2
s_cselect_b32 s3, s3, s33
s_lshl_b32 s3, s3, 1
s_and_b32 s39, s32, 1
s_add_u32 s3, s3, s39
s_lshl_b32 s3, s3, 15
s_xor_b32 s39, s58, 2
s_mul_i32 s39, s39, s59
s_add_u32 s3, s3, s39
v_lshlrev_b32 v37, 10, v0
v_lshrrev_b32 v38, 2, v0
v_lshlrev_b32 v38, 13, v38
v_and_b32 v39, 3, v0
v_lshl_add_u32 v38, v39, 7, v38
v_cndmask_b32 v47, v38, v37, vcc
v_add_u32 v47, s3, v47
v_cmp_gt_u32 vcc, s38, v0
v_mov_b32 v37, 2146435072
s_nop 0
v_cndmask_b32 v47, v37, v47, vcc
s_mov_b32 s20, s66
s_and_b32 s21, s67, 0xffff
s_mov_b32 s22, 8388608
s_mov_b32 s23, 0x20000
s_add_u32 s24, s66, 8388608
s_addc_u32 s25, s67, 0
s_and_b32 s25, s25, 0xffff
s_mov_b32 s26, 35717120
s_mov_b32 s27, 0x20000
v_lshrrev_b32 v32, 4, v0
v_and_b32 v30, 15, v0
s_lshr_b32 s3, s32, 1
s_lshl_b32 s3, s3, 14
s_add_u32 s3, s3, 32768
v_lshlrev_b32 v31, 7, v30
v_add_u32 v31, s3, v31
v_lshrrev_b32 v34, 1, v30
v_xor_b32_e64 v34, v34, v32
v_lshl_add_u32 v10, v34, 4, v31
v_xor_b32 v11, 64, v10
v_lshrrev_b32 v30, 2, v30
v_lshl_add_u32 v31, v32, 3, v30
v_lshlrev_b32 v31, 9, v31
v_and_b32 v34, 3, v0
v_lshl_add_u32 v31, v34, 3, v31
s_and_b32 s3, s32, 1
s_lshl_b32 s3, s3, 8
v_add_u32 v31, s3, v31
v_and_b32 v34, 1, v32
v_lshl_add_u32 v30, v34, 2, v30
v_lshl_add_u32 v16, v30, 5, v31
v_xor_b32 v17, 32, v16
v_xor_b32 v18, 64, v16
v_xor_b32 v19, 96, v16
v_xor_b32 v20, 128, v16
v_xor_b32 v21, 160, v16
v_xor_b32 v22, 192, v16
v_xor_b32 v23, 224, v16
v_add_u32 v12, 65536, v10
v_add_u32 v13, 65536, v11
v_add_u32 v14, 65536, v16
v_add_u32 v15, 65536, v17
v_add_u32 v24, 65536, v18
v_add_u32 v25, 65536, v19
v_add_u32 v26, 65536, v20
v_add_u32 v27, 65536, v21
v_add_u32 v28, 65536, v22
v_add_u32 v29, 65536, v23
s_mov_b32 s28, s44
s_nop 0
s_and_b32 s29, s45, 0xffff
s_mov_b32 s30, 2048
s_mov_b32 s31, 0x20000
buffer_load_dwordx4 v[64:67], v36, s[28:31], 0 offen offset:0
buffer_load_dwordx4 v[68:71], v36, s[28:31], 0 offen offset:512
buffer_load_dwordx4 v[72:75], v36, s[28:31], 0 offen offset:1024
buffer_load_dwordx4 v[76:79], v36, s[28:31], 0 offen offset:1536
s_waitcnt vmcnt(12)
v_lshlrev_b32 v80, 16, v48
v_and_b32 v81, 0xffff0000, v48
v_lshlrev_b32_e64 v82, 16, v49
v_and_b32 v83, 0xffff0000, v49
v_lshlrev_b32_e64 v84, 16, v50
v_and_b32 v85, 0xffff0000, v50
v_lshlrev_b32_e64 v86, 16, v51
v_and_b32 v87, 0xffff0000, v51
v_lshlrev_b32_e64 v88, 16, v52
v_and_b32 v89, 0xffff0000, v52
v_lshlrev_b32_e64 v90, 16, v53
v_and_b32 v91, 0xffff0000, v53
v_lshlrev_b32_e64 v92, 16, v54
v_and_b32 v93, 0xffff0000, v54
v_lshlrev_b32_e64 v94, 16, v55
v_and_b32 v95, 0xffff0000, v55
v_lshlrev_b32_e64 v96, 16, v56
v_and_b32 v97, 0xffff0000, v56
v_lshlrev_b32_e64 v98, 16, v57
v_and_b32 v99, 0xffff0000, v57
v_lshlrev_b32_e64 v100, 16, v58
v_and_b32 v101, 0xffff0000, v58
v_lshlrev_b32_e64 v102, 16, v59
v_and_b32 v103, 0xffff0000, v59
v_lshlrev_b32_e64 v104, 16, v60
v_and_b32 v105, 0xffff0000, v60
v_lshlrev_b32_e64 v106, 16, v61
v_and_b32 v107, 0xffff0000, v61
v_lshlrev_b32_e64 v108, 16, v62
v_and_b32 v109, 0xffff0000, v62
v_lshlrev_b32_e64 v110, 16, v63
v_and_b32 v111, 0xffff0000, v63
v_pk_add_f32 v[40:41], v[80:81], v[82:83]
v_pk_add_f32 v[42:43], v[84:85], v[86:87]
v_pk_add_f32 v[40:41], v[40:41], v[88:89]
v_pk_add_f32 v[42:43], v[42:43], v[90:91]
v_pk_add_f32 v[40:41], v[40:41], v[92:93]
v_pk_add_f32 v[42:43], v[42:43], v[94:95]
v_pk_add_f32 v[40:41], v[40:41], v[96:97]
v_pk_add_f32 v[42:43], v[42:43], v[98:99]
v_pk_add_f32 v[40:41], v[40:41], v[100:101]
v_pk_add_f32 v[42:43], v[42:43], v[102:103]
v_pk_add_f32 v[40:41], v[40:41], v[104:105]
v_pk_add_f32 v[42:43], v[42:43], v[106:107]
v_pk_add_f32 v[40:41], v[40:41], v[108:109]
v_pk_add_f32 v[42:43], v[42:43], v[110:111]
v_pk_add_f32 v[40:41], v[40:41], v[42:43]
Va 38,40,41
s_nop 1
v_add_f32_dpp v38, v38, v38 quad_perm:[1,0,3,2] row_mask:0xf bank_mask:0xf
s_nop 1
v_add_f32_dpp v38, v38, v38 quad_perm:[2,3,0,1] row_mask:0xf bank_mask:0xf
s_nop 1
v_add_f32_dpp v38, v38, v38 row_half_mirror row_mask:0xf bank_mask:0xf
s_nop 1
v_add_f32_dpp v38, v38, v38 row_mirror row_mask:0xf bank_mask:0xf
v_mov_b32 v37, v38
s_nop 1
v_permlane16_swap_b32 v37, v38
Va 38,38,37
s_add_u32 m0, s56, 0
s_nop 0
buffer_load_dwordx4 v2, s[8:11], s48 offen offset:0 lds
buffer_load_dwordx4 v3, s[8:11], s49 offen offset:1024 lds
buffer_load_dwordx4 v2, s[8:11], s50 offen offset:2048 lds
buffer_load_dwordx4 v3, s[8:11], s51 offen offset:3072 lds
s_add_u32 m0, s56, 4096
s_nop 0
buffer_load_dwordx4 v4, s[8:11], s48 offen offset:0 lds
buffer_load_dwordx4 v5, s[8:11], s49 offen offset:1024 lds
buffer_load_dwordx4 v4, s[8:11], s50 offen offset:2048 lds
buffer_load_dwordx4 v5, s[8:11], s51 offen offset:3072 lds
v_xor_b32 v2, 128, v2
v_xor_b32 v3, 128, v3
v_xor_b32 v4, 128, v4
v_xor_b32 v5, 128, v5
v_mul_f32 v38, 0xba800000, v38
v_mov_b32_e64 v39, v38
v_pk_add_f32 v[112:113], v[80:81], v[38:39]
v_pk_mul_f32 v[40:41], v[112:113], v[112:113]
v_pk_add_f32 v[114:115], v[82:83], v[38:39]
v_pk_mul_f32 v[42:43], v[114:115], v[114:115]
v_pk_add_f32 v[116:117], v[84:85], v[38:39]
v_pk_fma_f32 v[40:41], v[116:117], v[116:117], v[40:41]
v_pk_add_f32 v[118:119], v[86:87], v[38:39]
v_pk_fma_f32 v[42:43], v[118:119], v[118:119], v[42:43]
v_pk_add_f32 v[112:113], v[88:89], v[38:39]
v_pk_fma_f32 v[40:41], v[112:113], v[112:113], v[40:41]
v_pk_add_f32 v[114:115], v[90:91], v[38:39]
v_pk_fma_f32 v[42:43], v[114:115], v[114:115], v[42:43]
v_pk_add_f32 v[116:117], v[92:93], v[38:39]
v_pk_fma_f32 v[40:41], v[116:117], v[116:117], v[40:41]
v_pk_add_f32 v[118:119], v[94:95], v[38:39]
v_pk_fma_f32 v[42:43], v[118:119], v[118:119], v[42:43]
v_pk_add_f32 v[112:113], v[96:97], v[38:39]
v_pk_fma_f32 v[40:41], v[112:113], v[112:113], v[40:41]
v_pk_add_f32 v[114:115], v[98:99], v[38:39]
v_pk_fma_f32 v[42:43], v[114:115], v[114:115], v[42:43]
v_pk_add_f32 v[116:117], v[100:101], v[38:39]
v_pk_fma_f32 v[40:41], v[116:117], v[116:117], v[40:41]
v_pk_add_f32 v[118:119], v[102:103], v[38:39]
v_pk_fma_f32 v[42:43], v[118:119], v[118:119], v[42:43]
v_pk_add_f32 v[112:113], v[104:105], v[38:39]
v_pk_fma_f32 v[40:41], v[112:113], v[112:113], v[40:41]
v_pk_add_f32 v[114:115], v[106:107], v[38:39]
v_pk_fma_f32 v[42:43], v[114:115], v[114:115], v[42:43]
v_pk_add_f32 v[116:117], v[108:109], v[38:39]
v_pk_fma_f32 v[40:41], v[116:117], v[116:117], v[40:41]
v_pk_add_f32 v[118:119], v[110:111], v[38:39]
v_pk_fma_f32 v[42:43], v[118:119], v[118:119], v[42:43]
v_pk_add_f32 v[40:41], v[40:41], v[42:43]
Va 40,40,41
s_nop 1
v_add_f32_dpp v40, v40, v40 quad_perm:[1,0,3,2] row_mask:0xf bank_mask:0xf
s_nop 1
v_add_f32_dpp v40, v40, v40 quad_perm:[2,3,0,1] row_mask:0xf bank_mask:0xf
s_nop 1
v_add_f32_dpp v40, v40, v40 row_half_mirror row_mask:0xf bank_mask:0xf
s_nop 1
v_add_f32_dpp v40, v40, v40 row_mirror row_mask:0xf bank_mask:0xf
v_mov_b32 v37, v40
s_nop 1
v_permlane16_swap_b32 v37, v40
v_add_f32_e64 v40, v40, v37
v_mul_f32 v40, 0x3a800000, v40
Vc 44,38,40
v_lshlrev_b32_e64 v38, 16, v44
v_and_b32 v40, 0xffff0000, v44
v_add_f32 v40, 0x3727c5ac, v40
Vc 44,40,40
v_lshlrev_b32 v40, 16, v44
v_sqrt_f32 v40, v40
v_mov_b32_e64 v39, v38
Vc 44,40,40
v_lshlrev_b32 v44, 16, v44
v_rcp_f32 v40, v44
v_pk_add_f32 v[80:81], v[80:81], v[38:39]
v_pk_add_f32 v[82:83], v[82:83], v[38:39]
v_pk_add_f32 v[84:85], v[84:85], v[38:39]
v_pk_add_f32 v[86:87], v[86:87], v[38:39]
v_pk_add_f32 v[88:89], v[88:89], v[38:39]
v_pk_add_f32 v[90:91], v[90:91], v[38:39]
v_pk_add_f32 v[92:93], v[92:93], v[38:39]
v_pk_add_f32 v[94:95], v[94:95], v[38:39]
v_pk_add_f32 v[96:97], v[96:97], v[38:39]
v_pk_add_f32 v[98:99], v[98:99], v[38:39]
v_pk_add_f32 v[100:101], v[100:101], v[38:39]
v_pk_add_f32 v[102:103], v[102:103], v[38:39]
v_pk_add_f32 v[104:105], v[104:105], v[38:39]
v_pk_add_f32 v[106:107], v[106:107], v[38:39]
v_pk_add_f32 v[108:109], v[108:109], v[38:39]
v_pk_add_f32 v[110:111], v[110:111], v[38:39]
v_fma_f32 v45, -v44, v40, 1.0
v_fma_f32 v40, v45, v40, v40
v_mov_b32_e64 v41, v40
Vc 48,80,81
Vc 49,82,83
Vc 50,84,85
Vc 51,86,87
Vc 52,88,89
Vc 53,90,91
Vc 54,92,93
Vc 55,94,95
Vc 56,96,97
Vc 57,98,99
Vc 58,100,101
Vc 59,102,103
Vc 60,104,105
Vc 61,106,107
Vc 62,108,109
Vc 63,110,111
v_lshlrev_b32_e64 v80, 16, v48
v_and_b32 v81, 0xffff0000, v48
v_lshlrev_b32_e64 v82, 16, v49
v_and_b32 v83, 0xffff0000, v49
v_lshlrev_b32_e64 v84, 16, v50
v_and_b32 v85, 0xffff0000, v50
v_lshlrev_b32_e64 v86, 16, v51
v_and_b32 v87, 0xffff0000, v51
v_lshlrev_b32_e64 v88, 16, v52
v_and_b32 v89, 0xffff0000, v52
v_lshlrev_b32_e64 v90, 16, v53
v_and_b32 v91, 0xffff0000, v53
v_lshlrev_b32_e64 v92, 16, v54
v_and_b32 v93, 0xffff0000, v54
v_lshlrev_b32_e64 v94, 16, v55
v_and_b32 v95, 0xffff0000, v55
v_lshlrev_b32_e64 v96, 16, v56
v_and_b32 v97, 0xffff0000, v56
v_lshlrev_b32_e64 v98, 16, v57
v_and_b32 v99, 0xffff0000, v57
v_lshlrev_b32_e64 v100, 16, v58
v_and_b32 v101, 0xffff0000, v58
v_lshlrev_b32_e64 v102, 16, v59
v_and_b32 v103, 0xffff0000, v59
v_lshlrev_b32_e64 v104, 16, v60
v_and_b32 v105, 0xffff0000, v60
v_lshlrev_b32_e64 v106, 16, v61
v_and_b32 v107, 0xffff0000, v61
v_lshlrev_b32_e64 v108, 16, v62
v_and_b32 v109, 0xffff0000, v62
v_lshlrev_b32_e64 v110, 16, v63
v_and_b32 v111, 0xffff0000, v63
v_pk_mul_f32 v[80:81], v[80:81], v[40:41]
v_pk_mul_f32 v[82:83], v[82:83], v[40:41]
v_pk_mul_f32 v[84:85], v[84:85], v[40:41]
v_pk_mul_f32 v[86:87], v[86:87], v[40:41]
v_pk_mul_f32 v[88:89], v[88:89], v[40:41]
v_pk_mul_f32 v[90:91], v[90:91], v[40:41]
v_pk_mul_f32 v[92:93], v[92:93], v[40:41]
v_pk_mul_f32 v[94:95], v[94:95], v[40:41]
v_pk_mul_f32 v[96:97], v[96:97], v[40:41]
v_pk_mul_f32 v[98:99], v[98:99], v[40:41]
v_pk_mul_f32 v[100:101], v[100:101], v[40:41]
v_pk_mul_f32 v[102:103], v[102:103], v[40:41]
v_pk_mul_f32 v[104:105], v[104:105], v[40:41]
v_pk_mul_f32 v[106:107], v[106:107], v[40:41]
v_pk_mul_f32 v[108:109], v[108:109], v[40:41]
v_pk_mul_f32 v[110:111], v[110:111], v[40:41]
Vc 48,80,81
Vc 49,82,83
Vc 50,84,85
Vc 51,86,87
Vc 52,88,89
Vc 53,90,91
Vc 54,92,93
Vc 55,94,95
Vc 56,96,97
Vc 57,98,99
Vc 58,100,101
Vc 59,102,103
Vc 60,104,105
Vc 61,106,107
Vc 62,108,109
Vc 63,110,111
s_mul_i32 s3, s32, 4128
s_add_u32 s3, s3, 131072
v_mul_u32_u24 v42, 2064, v33
v_add3_u32 v42, v42, v36, s3
ds_write_b128 v42, v[48:51] offset:0
ds_write_b128 v42, v[52:55] offset:512
ds_write_b128 v42, v[56:59] offset:1024
ds_write_b128 v42, v[60:63] offset:1536
s_waitcnt vmcnt(8)
v_lshlrev_b32 v80, 16, v48
v_and_b32 v81, 0xffff0000, v48
v_lshlrev_b32_e64 v112, 16, v64
v_and_b32 v113, 0xffff0000, v64
v_pk_mul_f32 v[42:43], v[80:81], v[112:113]
v_lshlrev_b32_e64 v82, 16, v49
v_and_b32 v83, 0xffff0000, v49
v_lshlrev_b32_e64 v114, 16, v65
v_and_b32 v115, 0xffff0000, v65
v_pk_mul_f32 v[44:45], v[82:83], v[114:115]
v_lshlrev_b32_e64 v84, 16, v50
v_and_b32 v85, 0xffff0000, v50
v_lshlrev_b32_e64 v116, 16, v66
v_and_b32 v117, 0xffff0000, v66
v_pk_fma_f32 v[42:43], v[84:85], v[116:117], v[42:43]
v_lshlrev_b32_e64 v86, 16, v51
v_and_b32 v87, 0xffff0000, v51
v_lshlrev_b32_e64 v118, 16, v67
v_and_b32 v119, 0xffff0000, v67
v_pk_fma_f32 v[44:45], v[86:87], v[118:119], v[44:45]
v_lshlrev_b32_e64 v88, 16, v52
v_and_b32 v89, 0xffff0000, v52
v_lshlrev_b32_e64 v112, 16, v68
v_and_b32 v113, 0xffff0000, v68
v_pk_fma_f32 v[42:43], v[88:89], v[112:113], v[42:43]
v_lshlrev_b32_e64 v90, 16, v53
v_and_b32 v91, 0xffff0000, v53
v_lshlrev_b32_e64 v114, 16, v69
v_and_b32 v115, 0xffff0000, v69
v_pk_fma_f32 v[44:45], v[90:91], v[114:115], v[44:45]
v_lshlrev_b32_e64 v92, 16, v54
v_and_b32 v93, 0xffff0000, v54
v_lshlrev_b32_e64 v116, 16, v70
v_and_b32 v117, 0xffff0000, v70
v_pk_fma_f32 v[42:43], v[92:93], v[116:117], v[42:43]
v_lshlrev_b32_e64 v94, 16, v55
v_and_b32 v95, 0xffff0000, v55
v_lshlrev_b32_e64 v118, 16, v71
v_and_b32 v119, 0xffff0000, v71
v_pk_fma_f32 v[44:45], v[94:95], v[118:119], v[44:45]
v_lshlrev_b32_e64 v96, 16, v56
v_and_b32 v97, 0xffff0000, v56
v_lshlrev_b32_e64 v112, 16, v72
v_and_b32 v113, 0xffff0000, v72
v_pk_fma_f32 v[42:43], v[96:97], v[112:113], v[42:43]
v_lshlrev_b32_e64 v98, 16, v57
v_and_b32 v99, 0xffff0000, v57
v_lshlrev_b32_e64 v114, 16, v73
v_and_b32 v115, 0xffff0000, v73
v_pk_fma_f32 v[44:45], v[98:99], v[114:115], v[44:45]
v_lshlrev_b32_e64 v100, 16, v58
v_and_b32 v101, 0xffff0000, v58
v_lshlrev_b32_e64 v116, 16, v74
v_and_b32 v117, 0xffff0000, v74
v_pk_fma_f32 v[42:43], v[100:101], v[116:117], v[42:43]
v_lshlrev_b32_e64 v102, 16, v59
v_and_b32 v103, 0xffff0000, v59
v_lshlrev_b32_e64 v118, 16, v75
v_and_b32 v119, 0xffff0000, v75
v_pk_fma_f32 v[44:45], v[102:103], v[118:119], v[44:45]
v_lshlrev_b32_e64 v104, 16, v60
v_and_b32 v105, 0xffff0000, v60
v_lshlrev_b32_e64 v112, 16, v76
v_and_b32 v113, 0xffff0000, v76
v_pk_fma_f32 v[42:43], v[104:105], v[112:113], v[42:43]
v_lshlrev_b32_e64 v106, 16, v61
v_and_b32 v107, 0xffff0000, v61
v_lshlrev_b32_e64 v114, 16, v77
v_and_b32 v115, 0xffff0000, v77
v_pk_fma_f32 v[44:45], v[106:107], v[114:115], v[44:45]
v_lshlrev_b32_e64 v108, 16, v62
v_and_b32 v109, 0xffff0000, v62
v_lshlrev_b32_e64 v116, 16, v78
v_and_b32 v117, 0xffff0000, v78
v_pk_fma_f32 v[42:43], v[108:109], v[116:117], v[42:43]
v_lshlrev_b32_e64 v110, 16, v63
v_and_b32 v111, 0xffff0000, v63
v_lshlrev_b32_e64 v118, 16, v79
v_and_b32 v119, 0xffff0000, v79
v_pk_fma_f32 v[44:45], v[110:111], v[118:119], v[44:45]
v_pk_add_f32 v[42:43], v[42:43], v[44:45]
Va 45,42,43
s_nop 1
v_add_f32_dpp v45, v45, v45 quad_perm:[1,0,3,2] row_mask:0xf bank_mask:0xf
s_nop 1
v_add_f32_dpp v45, v45, v45 quad_perm:[2,3,0,1] row_mask:0xf bank_mask:0xf
s_nop 1
v_add_f32_dpp v45, v45, v45 row_half_mirror row_mask:0xf bank_mask:0xf
s_nop 1
v_add_f32_dpp v45, v45, v45 row_mirror row_mask:0xf bank_mask:0xf
v_mov_b32 v37, v45
s_nop 1
v_permlane16_swap_b32 v37, v45
v_add_f32_e64 v45, v45, v37
Vc 45,45,45
v_ashrrev_i32_e64 v46, 31, v45
v_or_b32 v46, 0x80000000, v46
v_xor_b32_e64 v45, v45, v46
v_and_b32 v45, 0xffff0000, v45
s_lshr_b32 s3, s36, 11
v_add_u32 v46, s3, v33
v_sub_u32 v44, 0xffff, v46
v_or_b32 v45, v45, v44
v_lshlrev_b32 v44, 2, v46
v_lshlrev_b32_e64 v46, 3, v46
v_xor_b32 v38, 0x80000000, v38
v_mov_b32_e64 v39, v40
s_mov_b32 s3, 5242880
s_mov_b32 s39, 5259264
s_mov_b32 exec_lo, 1
s_mov_b32 exec_hi, 1
buffer_store_dword v45, v44, s[20:23], s3 offen sc1
buffer_store_dwordx2 v[38:39], v46, s[20:23], s39 offen sc1
s_mov_b64 exec, -1
s_load_dwordx2 s[4:5], s[0:1], 16
s_load_dwordx4 s[40:43], s[0:1], 64
s_load_dwordx2 s[92:93], s[0:1], 40
s_load_dwordx2 s[94:95], s[0:1], 80
s_load_dwordx2 s[100:101], s[0:1], 0
s_mov_b32 s28, s64
s_and_b32 s29, s65, 0xffff
s_mov_b32 s30, 256
s_mov_b32 s31, 0x20000
s_waitcnt vmcnt(2)
s_waitcnt lgkmcnt(0)
s_barrier
s_nop 0
Ra 224,10,0
Ra 228,11,0
Ra 232,10,2048
Ra 236,11,2048
Ta 0,16,0
Ta 2,16,2048
Ta 4,16,16384
Ta 6,16,18432
Ta 8,17,0
Ta 10,17,2048
Ta 12,17,16384
Ta 14,17,18432
Ta 16,18,0
Ta 18,18,2048
Ta 20,18,16384
s_waitcnt lgkmcnt(9)
s_nop 0
Ta 22,18,18432
Ta 24,19,0
Ta 26,19,2048
Ta 28,19,16384
Ta 30,19,18432
Ta 32,20,0
s_waitcnt lgkmcnt(9)
s_nop 0
Ta 34,20,2048
Ta 36,20,16384
Ta 38,20,18432
Ta 40,21,0
Ta 42,21,2048
Ta 44,21,16384
s_waitcnt lgkmcnt(9)
s_nop 0
Ta 46,21,18432
Ta 48,22,0
Ta 50,22,2048
Ta 52,22,16384
Ta 54,22,18432
Ta 56,23,0
s_waitcnt lgkmcnt(9)
Ta 58,23,2048
Ta 60,23,16384
Ta 62,23,18432
s_cmp_lg_u32 s35, 0
s_cbranch_scc1 L_k1_vpath
Zvaa 48,0,224
v_and_b32 v46, 7, v0
v_mul_u32_u24 v30, 2064, v46
Mvaa 48,4,228
s_add_u32 m0, s57, 65536
Zvaa 52,8,224
buffer_load_dwordx4 v6, s[12:15], s52 offen offset:0 lds
Mvaa 52,12,228
Ra 240,10,4096
Zvaa 56,16,224
buffer_load_dwordx4 v7, s[12:15], s53 offen offset:1024 lds
Mvaa 56,20,228
v_lshrrev_b32_e64 v31, 3, v0
Zvaa 60,24,224
buffer_load_dwordx4 v6, s[12:15], s54 offen offset:2048 lds
Mvaa 60,28,228
Ra 244,11,4096
Zvaa 64,32,224
buffer_load_dwordx4 v7, s[12:15], s55 offen offset:3072 lds
Mvaa 64,36,228
s_add_u32 m0, s57, 69632
s_waitcnt lgkmcnt(10)
Zvaa 68,40,224
buffer_load_dwordx4 v8, s[12:15], s52 offen offset:0 lds
Mvaa 68,44,228
Ra 248,10,6144
s_waitcnt lgkmcnt(7)
Zvaa 72,48,224
buffer_load_dwordx4 v9, s[12:15], s53 offen offset:1024 lds
Mvaa 72,52,228
s_lshl_b32 s3, s32, 9
s_add_u32 s3, s3, 131072
v_lshl_add_u32 v30, v31, 4, v30
s_waitcnt lgkmcnt(3)
Zvaa 76,56,224
buffer_load_dwordx4 v8, s[12:15], s54 offen offset:2048 lds
Mvaa 76,60,228
Ra 252,11,6144
Zvaa 80,0,232
buffer_load_dwordx4 v9, s[12:15], s55 offen offset:3072 lds
Mvaa 80,4,236
s_add_u32 m0, s56, 65536
v_xor_b32 v6, 1572864, v6
v_xor_b32 v7, 1572864, v7
Zvaa 84,8,232
buffer_load_dwordx4 v2, s[8:11], s48 offen offset:0 lds
Mvaa 84,12,236
v_xor_b32 v8, 1572864, v8
v_xor_b32 v9, 1572864, v9
Zvaa 88,16,232
buffer_load_dwordx4 v3, s[8:11], s49 offen offset:1024 lds
Mvaa 88,20,236
v_add_u32 v30, s3, v30
v_lshlrev_b32 v31, 8, v31
Zvaa 92,24,232
buffer_load_dwordx4 v2, s[8:11], s50 offen offset:2048 lds
Mvaa 92,28,236
v_lshl_add_u32 v46, v46, 4, v31
Zvaa 96,32,232
buffer_load_dwordx4 v3, s[8:11], s51 offen offset:3072 lds
Mvaa 96,36,236
s_add_u32 m0, s56, 69632
Zvaa 100,40,232
buffer_load_dwordx4 v4, s[8:11], s48 offen offset:0 lds
Mvaa 100,44,236
Rv 34,30,128
Rv 38,30,256
Zvaa 104,48,232
buffer_load_dwordx4 v5, s[8:11], s49 offen offset:1024 lds
Mvaa 104,52,236
Rv 42,30,384
Rv 30,30,0
Zvaa 108,56,232
s_waitcnt lgkmcnt(4)
buffer_load_dwordx4 v4, s[8:11], s50 offen offset:2048 lds
Mvaa 108,60,236
s_lshr_b32 s3, s2, 1
s_mul_i32 s3, s3, 33792
s_add_u32 s3, s3, s57
Zvaa 112,0,240
buffer_load_dwordx4 v5, s[8:11], s51 offen offset:3072 lds
Mvaa 112,4,244
v_xor_b32 v2, 384, v2
v_xor_b32 v3, 384, v3
Zvaa 116,8,240
s_and_b32 s39, s2, 1
s_lshl_b32 s39, s39, 7
s_add_u32 s3, s3, s39
Mvaa 116,12,244
Ra 224,10,8192
v_xor_b32 v4, 384, v4
Zvaa 120,16,240
s_add_u32 s39, s3, 4096
Mvaa 120,20,244
v_xor_b32 v5, 384, v5
Zvaa 124,24,240
Mvaa 124,28,244
Ra 228,11,8192
Zvaa 128,32,240
Mvaa 128,36,244
Zvaa 132,40,240
Mvaa 132,44,244
Ra 232,10,10240
Zvaa 136,48,240
buffer_load_dword v1, v47, s[60:63], 0 offen
Mvaa 136,52,244
s_mul_i32 vcc_lo, s59, 1
v_xor_b32 v47, vcc_lo, v47
Zvaa 140,56,240
Mvaa 140,60,244
Ra 236,11,10240
Zvaa 144,0,248
Mvaa 144,4,252
Zvaa 148,8,248
Mvaa 148,12,252
Zvaa 152,16,248
Mvaa 152,20,252
Zvaa 156,24,248
Mvaa 156,28,252
Zvaa 160,32,248
Mvaa 160,36,252
Zvaa 164,40,248
Mvaa 164,44,252
Zvaa 168,48,248
Mvaa 168,52,252
s_waitcnt vmcnt(9)
Zvaa 172,56,248
s_waitcnt lgkmcnt(0)
s_barrier
Mvaa 172,60,252
s_add_u32 m0, s57, 0
Zvaa 176,0,224
buffer_load_dwordx4 v6, s[12:15], s52 offen offset:0 lds
Mvaa 176,4,228
Ta 64,14,0
Ta 66,14,2048
Zvaa 180,8,224
Mvaa 180,12,228
Ra 240,10,12288
Zvaa 184,16,224
buffer_load_dwordx4 v7, s[12:15], s53 offen offset:1024 lds
Mvaa 184,20,228
Ta 68,14,16384
Ta 70,14,18432
Zvaa 188,24,224
Mvaa 188,28,228
Ra 244,11,12288
Zvaa 192,32,224
buffer_load_dwordx4 v6, s[12:15], s54 offen offset:2048 lds
Mvaa 192,36,228
Ta 72,15,0
Ta 74,15,2048
Zvaa 196,40,224
Mvaa 196,44,228
Ra 248,10,14336
Zvaa 200,48,224
buffer_load_dwordx4 v7, s[12:15], s55 offen offset:3072 lds
Mvaa 200,52,228
Ta 76,15,16384
Ta 78,15,18432
Zvaa 204,56,224
Mvaa 204,60,228
s_add_u32 m0, s57, 4096
Ra 252,11,14336
Zvaa 208,0,232
buffer_load_dwordx4 v8, s[12:15], s52 offen offset:0 lds
Mvaa 208,4,236
Zvaa 212,8,232
Mvaa 212,12,236
Ta 80,24,0
Ta 82,24,2048
Zvaa 216,16,232
buffer_load_dwordx4 v9, s[12:15], s53 offen offset:1024 lds
Mvaa 216,20,236
Ta 84,24,16384
s_waitcnt lgkmcnt(9)
Ta 86,24,18432
Zvaa 220,24,232
Mvaa 220,28,236
Ta 88,25,0
Ta 90,25,2048
Zvaa 224,32,232
buffer_load_dwordx4 v8, s[12:15], s54 offen offset:2048 lds
Mvaa 224,36,236
Zvaa 228,40,232
Mvaa 228,44,236
Ta 92,25,16384
Ta 94,25,18432
Zvaa 232,48,232
buffer_load_dwordx4 v9, s[12:15], s55 offen offset:3072 lds
Mvaa 232,52,236
s_waitcnt vmcnt(9)
Ta 96,26,0
s_waitcnt lgkmcnt(9)
Ta 98,26,2048
Zvaa 236,56,232
s_barrier
v_xor_b32 v6, 524288, v6
v_xor_b32 v7, 524288, v7
Mvaa 236,60,236
s_add_u32 m0, s56, 0
Ta 100,26,16384
Ta 102,26,18432
Zvaa 240,0,240
buffer_load_dwordx4 v2, s[8:11], s48 offen offset:0 lds
Mvaa 240,4,244
v_xor_b32 v8, 524288, v8
v_xor_b32 v9, 524288, v9
Zvaa 244,8,240
Mvaa 244,12,244
Ra 224,12,0
Zvaa 248,16,240
buffer_load_dwordx4 v3, s[8:11], s49 offen offset:1024 lds
Mvaa 248,20,244
Ta 104,27,0
Ta 106,27,2048
Zvaa 252,24,240
Mvaa 252,28,244
s_waitcnt lgkmcnt(9)
Ra 228,13,0
Zaaa 128,32,240
buffer_load_dwordx4 v2, s[8:11], s50 offen offset:2048 lds
Maaa 128,36,244
Ta 108,27,16384
Ta 110,27,18432
Zaaa 132,40,240
Maaa 132,44,244
Ra 232,12,2048
Zaaa 136,48,240
buffer_load_dwordx4 v3, s[8:11], s51 offen offset:3072 lds
Maaa 136,52,244
Ta 112,28,0
Ta 114,28,2048
Zaaa 140,56,240
Maaa 140,60,244
s_add_u32 m0, s56, 4096
s_waitcnt lgkmcnt(9)
Ra 236,13,2048
Zaaa 144,0,248
buffer_load_dwordx4 v4, s[8:11], s48 offen offset:0 lds
Maaa 144,4,252
Zaaa 148,8,248
Maaa 148,12,252
Ta 116,28,16384
Ta 118,28,18432
Zaaa 152,16,248
buffer_load_dwordx4 v5, s[8:11], s49 offen offset:1024 lds
Maaa 152,20,252
Ta 120,29,0
Ta 122,29,2048
Zaaa 156,24,248
Maaa 156,28,252
Ta 124,29,16384
s_waitcnt lgkmcnt(9)
Ta 126,29,18432
Zaaa 160,32,248
buffer_load_dwordx4 v4, s[8:11], s50 offen offset:2048 lds
Maaa 160,36,252
Zaaa 164,40,248
Maaa 164,44,252
Zaaa 168,48,248
buffer_load_dwordx4 v5, s[8:11], s51 offen offset:3072 lds
Maaa 168,52,252
v_xor_b32 v2, 128, v2
v_xor_b32 v3, 128, v3
Zaaa 172,56,248
s_waitcnt lgkmcnt(6)
buffer_load_dword v1, v47, s[60:63], 0 offen
v_xor_b32 v4, 128, v4
v_xor_b32 v5, 128, v5
Maaa 172,60,252
s_waitcnt lgkmcnt(0)
s_mul_i32 vcc_lo, s59, 7
v_xor_b32 v47, vcc_lo, v47
Mvaa 48,64,224
buffer_store_dwordx4 v[30:33], v46, s[20:23], s3 offen offset:0 sc1
Mvaa 48,68,228
buffer_store_dwordx4 v[34:37], v46, s[20:23], s3 offen offset:2048 sc1
Mvaa 52,72,224
buffer_store_dwordx4 v[38:41], v46, s[20:23], s39 offen offset:0 sc1
Mvaa 52,76,228
Ra 240,12,4096
Mvaa 56,80,224
buffer_store_dwordx4 v[42:45], v46, s[20:23], s39 offen offset:2048 sc1
Mvaa 56,84,228
s_lshl_b32 s3, s34, 1
s_and_b32 s36, s32, 1
s_add_u32 s3, s3, s36
Mvaa 60,88,224
s_mul_i32 s3, s3, 1116160
s_mul_i32 s36, s33, 139264
s_add_u32 s3, s3, s36
Mvaa 60,92,228
Ra 244,13,4096
Mvaa 64,96,224
s_lshr_b32 s36, s32, 1
s_mul_i32 s36, s36, 69632
s_add_u32 s3, s3, s36
Mvaa 64,100,228
s_add_u32 s38, s3, 0
s_lshl_b32 s39, s34, 7
s_lshl_b32 s36, s33, 2
Mvaa 68,104,224
s_add_u32 s39, s39, s36
s_add_u32 s39, s39, 5296128
v_mov_b32_e64 v30, 1
Mvaa 68,108,228
Ra 248,12,6144
Mvaa 72,112,224
v_mov_b32_e64 v31, 0
Mvaa 72,116,228
s_cmp_eq_u32 s32, 0
s_cselect_b32 s39, s39, 2146435072
Mvaa 76,120,224
s_mov_b64 exec, 1
buffer_store_dword v31, v31, s[20:23], s39 offen sc1
s_mov_b64 exec, -1
Mvaa 76,124,228
Ra 252,13,6144
Mvaa 80,64,232
s_and_b32 s33, s2, 7
s_lshl_b32 s33, s33, 2
s_bfe_u32 s3, s2, 0x20003
Mvaa 80,68,236
s_add_u32 s33, s33, s3
s_lshr_b32 s34, s2, 5
s_lshl_b32 s64, s34, 7
Mvaa 84,72,232
s_lshl_b32 s3, s33, 2
s_add_u32 s64, s64, s3
s_add_u32 s64, s64, 5300224
Mvaa 84,76,236
s_lshl_b32 s65, s34, 8
s_sub_u32 s65, 1920, s65
v_mul_u32_u24 v32, s65, v0
Mvaa 88,80,232
s_cmp_eq_u32 s32, 0
s_cselect_b32 s64, s64, 2146435072
Mvaa 88,84,236
s_mov_b64 exec, 3
buffer_store_dword v31, v32, s[20:23], s64 offen sc1
s_mov_b64 exec, -1
Mvaa 92,88,232
s_lshl_b32 s3, s2, 2
s_add_u32 s3, s3, 5447680
v_lshlrev_b32_e64 v32, 10, v0
Mvaa 92,92,236
s_cmp_eq_u32 s32, 0
s_cselect_b32 s3, s3, 2146435072
Mvaa 96,96,232
s_mov_b64 exec, 0x1ff
buffer_store_dword v31, v32, s[20:23], s3 offen sc1
s_mov_b64 exec, -1
Mvaa 96,100,236
s_lshl_b32 s35, s34, 1
s_sub_u32 s36, 32, s35
s_add_u32 s35, s35, 2
Mvaa 100,104,232
s_lshl_b32 s44, s32, 12
s_lshl_b32 s58, s32, 1
s_sub_u32 s58, 7, s58
Mvaa 100,108,236
s_mul_i32 s58, s58, 33792
s_sub_u32 s3, 15, s34
s_lshl_b32 s45, s3, 3
Mvaa 104,112,232
s_add_u32 s45, s45, s32
s_lshl_b32 s46, s34, 3
s_add_u32 s46, s46, s32
Mvaa 104,116,236
s_mov_b32 s68, s42
s_and_b32 s69, s43, 0xffff
s_mov_b32 s70, 7340032
Mvaa 108,120,232
s_waitcnt lgkmcnt(0)
Mvaa 108,124,236
s_mov_b32 s71, 0x20000
s_cmp_eq_u32 s32, 0
s_cselect_b32 s37, 0, 2146435072
Mvaa 112,64,240
s_lshl_b32 s3, s33, 8
s_add_u32 s16, s4, s3
s_addc_u32 s17, s5, 0
s_and_b32 s17, s17, 0xffff
Mvaa 112,68,244
s_mov_b32 s18, 0
s_mov_b32 s19, 0x20000
s_sub_u32 s18, 8388608, s3
Mvaa 116,72,240
v_and_b32 v33, 15, v0
v_lshrrev_b32 v32, 1, v33
Mvaa 116,76,244
Ra 224,12,8192
Mvaa 120,80,240
v_and_b32 v33, 1, v0
v_lshlrev_b32 v32, 13, v32
Mvaa 120,84,244
v_lshl_add_u32 v45, v33, 7, v32
Mvaa 124,88,240
s_lshl_b32 s3, s32, 3
s_add_u32 s3, s3, s34
s_mul_i32 s47, s3, 65536
Mvaa 124,92,244
Ra 228,13,8192
Mvaa 128,96,240
s_bfe_u32 s6, s2, 131075
s_lshl_b32 s3, s32, 8
s_or_b32 s6, s6, s3
Mvaa 128,100,244
Mvaa 132,104,240
Mvaa 132,108,244
Ra 232,12,10240
Mvaa 136,112,240
Mvaa 136,116,244
Mvaa 140,120,240
Mvaa 140,124,244
Ra 236,13,10240
Mvaa 144,64,248
Mvaa 144,68,252
Mvaa 148,72,248
Mvaa 148,76,252
Mvaa 152,80,248
Mvaa 152,84,252
Mvaa 156,88,248
Mvaa 156,92,252
Mvaa 160,96,248
Mvaa 160,100,252
Mvaa 164,104,248
Mvaa 164,108,252
Mvaa 168,112,248
Mvaa 168,116,252
s_waitcnt vmcnt(16)
Mvaa 172,120,248
s_waitcnt lgkmcnt(0)
s_barrier
Mvaa 172,124,252
s_add_u32 m0, s57, 65536
Mvaa 176,64,224
buffer_load_dwordx4 v6, s[12:15], s52 offen offset:0 lds
Mvaa 176,68,228
Ta 0,16,0
Ta 2,16,2048
Mvaa 180,72,224
Mvaa 180,76,228
Ra 240,12,12288
Mvaa 184,80,224
buffer_load_dwordx4 v7, s[12:15], s53 offen offset:1024 lds
Mvaa 184,84,228
Ta 4,16,16384
Ta 6,16,18432
Mvaa 188,88,224
Mvaa 188,92,228
Ra 244,13,12288
Mvaa 192,96,224
buffer_load_dwordx4 v6, s[12:15], s54 offen offset:2048 lds
Mvaa 192,100,228
Ta 8,17,0
Ta 10,17,2048
Mvaa 196,104,224
Mvaa 196,108,228
Ra 248,12,14336
Mvaa 200,112,224
buffer_load_dwordx4 v7, s[12:15], s55 offen offset:3072 lds
Mvaa 200,116,228
Ta 12,17,16384
Ta 14,17,18432
Mvaa 204,120,224
Mvaa 204,124,228
s_add_u32 m0, s57, 69632
Ra 252,13,14336
Mvaa 208,64,232
buffer_load_dwordx4 v8, s[12:15], s52 offen offset:0 lds
Mvaa 208,68,236
Mvaa 212,72,232
Mvaa 212,76,236
Ta 16,18,0
Ta 18,18,2048
Mvaa 216,80,232
buffer_load_dwordx4 v9, s[12:15], s53 offen offset:1024 lds
Mvaa 216,84,236
Ta 20,18,16384
s_waitcnt lgkmcnt(9)
Ta 22,18,18432
Mvaa 220,88,232
Mvaa 220,92,236
Ta 24,19,0
Ta 26,19,2048
Mvaa 224,96,232
buffer_load_dwordx4 v8, s[12:15], s54 offen offset:2048 lds
Mvaa 224,100,236
Mvaa 228,104,232
Mvaa 228,108,236
Ta 28,19,16384
Ta 30,19,18432
Mvaa 232,112,232
buffer_load_dwordx4 v9, s[12:15], s55 offen offset:3072 lds
Mvaa 232,116,236
s_waitcnt vmcnt(16)
Ta 32,20,0
s_waitcnt lgkmcnt(9)
Ta 34,20,2048
Mvaa 236,120,232
s_barrier
v_xor_b32 v6, 3670016, v6
v_xor_b32 v7, 3670016, v7
Mvaa 236,124,236
s_add_u32 m0, s56, 65536
Ta 36,20,16384
Ta 38,20,18432
Mvaa 240,64,240
buffer_load_dwordx4 v2, s[8:11], s48 offen offset:0 lds
Mvaa 240,68,244
v_xor_b32 v8, 3670016, v8
v_xor_b32 v9, 3670016, v9
Mvaa 244,72,240
Mvaa 244,76,244
Ra 224,10,0
Mvaa 248,80,240
buffer_load_dwordx4 v3, s[8:11], s49 offen offset:1024 lds
Mvaa 248,84,244
Ta 40,21,0
Ta 42,21,2048
Mvaa 252,88,240
Mvaa 252,92,244
s_waitcnt lgkmcnt(9)
Ra 228,11,0
Maaa 128,96,240
buffer_load_dwordx4 v2, s[8:11], s50 offen offset:2048 lds
Maaa 128,100,244
Ta 44,21,16384
Ta 46,21,18432
Maaa 132,104,240
Maaa 132,108,244
Ra 232,10,2048
Maaa 136,112,240
buffer_load_dwordx4 v3, s[8:11], s51 offen offset:3072 lds
Maaa 136,116,244
Ta 48,22,0
Ta 50,22,2048
Maaa 140,120,240
Maaa 140,124,244
s_add_u32 m0, s56, 69632
s_waitcnt lgkmcnt(9)
Ra 236,11,2048
Maaa 144,64,248
buffer_load_dwordx4 v4, s[8:11], s48 offen offset:0 lds
Maaa 144,68,252
Maaa 148,72,248
Maaa 148,76,252
Ta 52,22,16384
Ta 54,22,18432
Maaa 152,80,248
buffer_load_dwordx4 v5, s[8:11], s49 offen offset:1024 lds
Maaa 152,84,252
Ta 56,23,0
Ta 58,23,2048
Maaa 156,88,248
Maaa 156,92,252
Ta 60,23,16384
s_waitcnt lgkmcnt(9)
Ta 62,23,18432
Maaa 160,96,248
buffer_load_dwordx4 v4, s[8:11], s50 offen offset:2048 lds
Maaa 160,100,252
Maaa 164,104,248
Maaa 164,108,252
Maaa 168,112,248
buffer_load_dwordx4 v5, s[8:11], s51 offen offset:3072 lds
Maaa 168,116,252
v_xor_b32 v2, 896, v2
v_xor_b32 v3, 896, v3
Maaa 172,120,248
s_waitcnt lgkmcnt(6)
buffer_load_dword v1, v47, s[60:63], 0 offen
v_xor_b32 v4, 896, v4
v_xor_b32 v5, 896, v5
Maaa 172,124,252
s_waitcnt lgkmcnt(0)
s_mul_i32 vcc_lo, s59, 1
v_xor_b32 v47, vcc_lo, v47
Mvaa 48,0,224
Mvaa 48,4,228
Mvaa 52,8,224
Mvaa 52,12,228
Ra 240,10,4096
Mvaa 56,16,224
Mvaa 56,20,228
Mvaa 60,24,224
Mvaa 60,28,228
Ra 244,11,4096
Mvaa 64,32,224
Mvaa 64,36,228
Mvaa 68,40,224
Mvaa 68,44,228
Ra 248,10,6144
Mvaa 72,48,224
Mvaa 72,52,228
Mvaa 76,56,224
Mvaa 76,60,228
Ra 252,11,6144
Mvaa 80,0,232
Mvaa 80,4,236
Mvaa 84,8,232
Mvaa 84,12,236
Mvaa 88,16,232
Mvaa 88,20,236
Mvaa 92,24,232
Mvaa 92,28,236
Mvaa 96,32,232
Mvaa 96,36,236
Mvaa 100,40,232
Mvaa 100,44,236
Mvaa 104,48,232
Mvaa 104,52,236
Mvaa 108,56,232
s_waitcnt lgkmcnt(0)
Mvaa 108,60,236
Mvaa 112,0,240
Mvaa 112,4,244
Mvaa 116,8,240
Mvaa 116,12,244
Ra 224,10,8192
Mvaa 120,16,240
Mvaa 120,20,244
Mvaa 124,24,240
Mvaa 124,28,244
Ra 228,11,8192
Mvaa 128,32,240
Mvaa 128,36,244
Mvaa 132,40,240
Mvaa 132,44,244
Ra 232,10,10240
Mvaa 136,48,240
Mvaa 136,52,244
Mvaa 140,56,240
Mvaa 140,60,244
Ra 236,11,10240
Mvaa 144,0,248
Mvaa 144,4,252
Mvaa 148,8,248
Mvaa 148,12,252
Mvaa 152,16,248
Mvaa 152,20,252
Mvaa 156,24,248
Mvaa 156,28,252
Mvaa 160,32,248
Mvaa 160,36,252
Mvaa 164,40,248
Mvaa 164,44,252
Mvaa 168,48,248
Mvaa 168,52,252
s_waitcnt vmcnt(9)
Mvaa 172,56,248
s_waitcnt lgkmcnt(0)
s_barrier
Mvaa 172,60,252
s_add_u32 m0, s57, 0
Mvaa 176,0,224
buffer_load_dwordx4 v6, s[12:15], s52 offen offset:0 lds
Mvaa 176,4,228
Ta 64,14,0
Ta 66,14,2048
Mvaa 180,8,224
Mvaa 180,12,228
Ra 240,10,12288
Mvaa 184,16,224
buffer_load_dwordx4 v7, s[12:15], s53 offen offset:1024 lds
Mvaa 184,20,228
Ta 68,14,16384
Ta 70,14,18432
Mvaa 188,24,224
Mvaa 188,28,228
Ra 244,11,12288
Mvaa 192,32,224
buffer_load_dwordx4 v6, s[12:15], s54 offen offset:2048 lds
Mvaa 192,36,228
Ta 72,15,0
Ta 74,15,2048
Mvaa 196,40,224
Mvaa 196,44,228
Ra 248,10,14336
Mvaa 200,48,224
buffer_load_dwordx4 v7, s[12:15], s55 offen offset:3072 lds
Mvaa 200,52,228
Ta 76,15,16384
Ta 78,15,18432
Mvaa 204,56,224
s_cmp_eq_u32 s6, 0
s_cselect_b32 s3, 0, 2146435072
Mvaa 204,60,228
s_add_u32 m0, s57, 4096
Ra 252,11,14336
Mvaa 208,0,232
buffer_load_dwordx4 v8, s[12:15], s52 offen offset:0 lds
Mvaa 208,4,236
s_mov_b64 exec, 1
buffer_atomic_add v30, v31, s[28:31], s3 offen sc1
s_mov_b64 exec, -1
Mvaa 212,8,232
Mvaa 212,12,236
Ta 80,24,0
Ta 82,24,2048
Mvaa 216,16,232
buffer_load_dwordx4 v9, s[12:15], s53 offen offset:1024 lds
Mvaa 216,20,236
Ta 84,24,16384
s_waitcnt lgkmcnt(9)
Ta 86,24,18432
Mvaa 220,24,232
Mvaa 220,28,236
Ta 88,25,0
Ta 90,25,2048
Mvaa 224,32,232
buffer_load_dwordx4 v8, s[12:15], s54 offen offset:2048 lds
Mvaa 224,36,236
Mvaa 228,40,232
Mvaa 228,44,236
Ta 92,25,16384
Ta 94,25,18432
Mvaa 232,48,232
buffer_load_dwordx4 v9, s[12:15], s55 offen offset:3072 lds
Mvaa 232,52,236
s_waitcnt vmcnt(10)
Ta 96,26,0
s_waitcnt lgkmcnt(9)
Ta 98,26,2048
Mvaa 236,56,232
s_barrier
v_xor_b32 v6, 524288, v6
v_xor_b32 v7, 524288, v7
Mvaa 236,60,236
s_add_u32 m0, s56, 0
Ta 100,26,16384
Ta 102,26,18432
Mvaa 240,0,240
buffer_load_dwordx4 v2, s[8:11], s48 offen offset:0 lds
Mvaa 240,4,244
v_xor_b32 v8, 524288, v8
v_xor_b32 v9, 524288, v9
Mvaa 244,8,240
Mvaa 244,12,244
Ra 224,12,0
Mvaa 248,16,240
buffer_load_dwordx4 v3, s[8:11], s49 offen offset:1024 lds
Mvaa 248,20,244
Ta 104,27,0
Ta 106,27,2048
Mvaa 252,24,240
Mvaa 252,28,244
s_waitcnt lgkmcnt(9)
Ra 228,13,0
Maaa 128,32,240
buffer_load_dwordx4 v2, s[8:11], s50 offen offset:2048 lds
Maaa 128,36,244
Ta 108,27,16384
Ta 110,27,18432
Maaa 132,40,240
Maaa 132,44,244
Ra 232,12,2048
Maaa 136,48,240
buffer_load_dwordx4 v3, s[8:11], s51 offen offset:3072 lds
Maaa 136,52,244
Ta 112,28,0
Ta 114,28,2048
Maaa 140,56,240
Maaa 140,60,244
s_add_u32 m0, s56, 4096
s_waitcnt lgkmcnt(9)
Ra 236,13,2048
Maaa 144,0,248
buffer_load_dwordx4 v4, s[8:11], s48 offen offset:0 lds
Maaa 144,4,252
Maaa 148,8,248
Maaa 148,12,252
Ta 116,28,16384
Ta 118,28,18432
Maaa 152,16,248
buffer_load_dwordx4 v5, s[8:11], s49 offen offset:1024 lds
Maaa 152,20,252
Ta 120,29,0
Ta 122,29,2048
Maaa 156,24,248
Maaa 156,28,252
Ta 124,29,16384
s_waitcnt lgkmcnt(9)
Ta 126,29,18432
Maaa 160,32,248
buffer_load_dwordx4 v4, s[8:11], s50 offen offset:2048 lds
Maaa 160,36,252
Maaa 164,40,248
Maaa 164,44,252
Maaa 168,48,248
buffer_load_dwordx4 v5, s[8:11], s51 offen offset:3072 lds
Maaa 168,52,252
v_xor_b32 v2, 128, v2
v_xor_b32 v3, 128, v3
Maaa 172,56,248
s_waitcnt lgkmcnt(6)
buffer_load_dword v1, v47, s[60:63], 0 offen
v_xor_b32 v4, 128, v4
v_xor_b32 v5, 128, v5
Maaa 172,60,252
s_waitcnt lgkmcnt(0)
s_mul_i32 vcc_lo, s59, 3
v_xor_b32 v47, vcc_lo, v47
Mvaa 48,64,224
buffer_load_dword v44, v45, s[16:19], s47 offen
Mvaa 48,68,228
s_add_u32 s47, s47, 2097152
Mvaa 52,72,224
Mvaa 52,76,228
Ra 240,12,4096
Mvaa 56,80,224
Mvaa 56,84,228
Mvaa 60,88,224
Mvaa 60,92,228
Ra 244,13,4096
Mvaa 64,96,224
Mvaa 64,100,228
Mvaa 68,104,224
Mvaa 68,108,228
Ra 248,12,6144
Mvaa 72,112,224
Mvaa 72,116,228
Mvaa 76,120,224
Mvaa 76,124,228
Ra 252,13,6144
Mvaa 80,64,232
Mvaa 80,68,236
Mvaa 84,72,232
Mvaa 84,76,236
Mvaa 88,80,232
Mvaa 88,84,236
Mvaa 92,88,232
Mvaa 92,92,236
Mvaa 96,96,232
Mvaa 96,100,236
Mvaa 100,104,232
s_cmp_eq_u32 s6, 1
s_cselect_b32 s3, 0, 2146435072
Mvaa 100,108,236
s_mov_b64 exec, 1
buffer_atomic_add v30, v31, s[28:31], s3 offen sc1
s_mov_b64 exec, -1
Mvaa 104,112,232
Mvaa 104,116,236
Mvaa 108,120,232
s_waitcnt lgkmcnt(0)
Mvaa 108,124,236
Mvaa 112,64,240
Mvaa 112,68,244
Mvaa 116,72,240
Mvaa 116,76,244
Ra 224,12,8192
Mvaa 120,80,240
Mvaa 120,84,244
Mvaa 124,88,240
Mvaa 124,92,244
Ra 228,13,8192
Mvaa 128,96,240
Mvaa 128,100,244
Mvaa 132,104,240
Mvaa 132,108,244
Ra 232,12,10240
Mvaa 136,112,240
Mvaa 136,116,244
Mvaa 140,120,240
Mvaa 140,124,244
Ra 236,13,10240
Mvaa 144,64,248
Mvaa 144,68,252
Mvaa 148,72,248
Mvaa 148,76,252
Mvaa 152,80,248
Mvaa 152,84,252
Mvaa 156,88,248
Mvaa 156,92,252
Mvaa 160,96,248
Mvaa 160,100,252
Mvaa 164,104,248
Mvaa 164,108,252
Mvaa 168,112,248
Mvaa 168,116,252
s_waitcnt vmcnt(11)
Mvaa 172,120,248
s_waitcnt lgkmcnt(0)
s_barrier
Mvaa 172,124,252
s_add_u32 m0, s57, 65536
Mvaa 176,64,224
buffer_load_dwordx4 v6, s[12:15], s52 offen offset:0 lds
Mvaa 176,68,228
Ta 0,16,0
Ta 2,16,2048
Mvaa 180,72,224
Mvaa 180,76,228
Ra 240,12,12288
Mvaa 184,80,224
buffer_load_dwordx4 v7, s[12:15], s53 offen offset:1024 lds
Mvaa 184,84,228
Ta 4,16,16384
Ta 6,16,18432
Mvaa 188,88,224
Mvaa 188,92,228
Ra 244,13,12288
Mvaa 192,96,224
buffer_load_dwordx4 v6, s[12:15], s54 offen offset:2048 lds
Mvaa 192,100,228
Ta 8,17,0
Ta 10,17,2048
Mvaa 196,104,224
Mvaa 196,108,228
Ra 248,12,14336
Mvaa 200,112,224
buffer_load_dwordx4 v7, s[12:15], s55 offen offset:3072 lds
Mvaa 200,116,228
Ta 12,17,16384
Ta 14,17,18432
Mvaa 204,120,224
Mvaa 204,124,228
s_add_u32 m0, s57, 69632
Ra 252,13,14336
Mvaa 208,64,232
buffer_load_dwordx4 v8, s[12:15], s52 offen offset:0 lds
Mvaa 208,68,236
Mvaa 212,72,232
Mvaa 212,76,236
Ta 16,18,0
Ta 18,18,2048
Mvaa 216,80,232
buffer_load_dwordx4 v9, s[12:15], s53 offen offset:1024 lds
Mvaa 216,84,236
Ta 20,18,16384
s_waitcnt lgkmcnt(9)
Ta 22,18,18432
Mvaa 220,88,232
Mvaa 220,92,236
Ta 24,19,0
Ta 26,19,2048
Mvaa 224,96,232
buffer_load_dwordx4 v8, s[12:15], s54 offen offset:2048 lds
Mvaa 224,100,236
Mvaa 228,104,232
Mvaa 228,108,236
Ta 28,19,16384
Ta 30,19,18432
Mvaa 232,112,232
buffer_load_dwordx4 v9, s[12:15], s55 offen offset:3072 lds
Mvaa 232,116,236
s_waitcnt vmcnt(11)
Ta 32,20,0
s_waitcnt lgkmcnt(9)
Ta 34,20,2048
Mvaa 236,120,232
s_barrier
v_xor_b32 v6, 1572864, v6
v_xor_b32 v7, 1572864, v7
Mvaa 236,124,236
s_add_u32 m0, s56, 65536
Ta 36,20,16384
Ta 38,20,18432
Mvaa 240,64,240
buffer_load_dwordx4 v2, s[8:11], s48 offen offset:0 lds
Mvaa 240,68,244
v_xor_b32 v8, 1572864, v8
v_xor_b32 v9, 1572864, v9
Mvaa 244,72,240
Mvaa 244,76,244
Ra 224,10,0
Mvaa 248,80,240
buffer_load_dwordx4 v3, s[8:11], s49 offen offset:1024 lds
Mvaa 248,84,244
Ta 40,21,0
Ta 42,21,2048
Mvaa 252,88,240
Mvaa 252,92,244
s_waitcnt lgkmcnt(9)
Ra 228,11,0
Maaa 128,96,240
buffer_load_dwordx4 v2, s[8:11], s50 offen offset:2048 lds
Maaa 128,100,244
Ta 44,21,16384
Ta 46,21,18432
Maaa 132,104,240
s_cmp_eq_u32 s6, 2
s_cselect_b32 s3, 0, 2146435072
Maaa 132,108,244
Ra 232,10,2048
Maaa 136,112,240
buffer_load_dwordx4 v3, s[8:11], s51 offen offset:3072 lds
Maaa 136,116,244
Ta 48,22,0
Ta 50,22,2048
Maaa 140,120,240
s_mov_b64 exec, 1
buffer_atomic_add v30, v31, s[28:31], s3 offen sc1
s_mov_b64 exec, -1
Maaa 140,124,244
s_add_u32 m0, s56, 69632
s_waitcnt lgkmcnt(9)
Ra 236,11,2048
Maaa 144,64,248
buffer_load_dwordx4 v4, s[8:11], s48 offen offset:0 lds
Maaa 144,68,252
Maaa 148,72,248
Maaa 148,76,252
Ta 52,22,16384
Ta 54,22,18432
Maaa 152,80,248
buffer_load_dwordx4 v5, s[8:11], s49 offen offset:1024 lds
Maaa 152,84,252
Ta 56,23,0
Ta 58,23,2048
Maaa 156,88,248
Maaa 156,92,252
Ta 60,23,16384
s_waitcnt lgkmcnt(9)
Ta 62,23,18432
Maaa 160,96,248
buffer_load_dwordx4 v4, s[8:11], s50 offen offset:2048 lds
Maaa 160,100,252
Maaa 164,104,248
Maaa 164,108,252
Maaa 168,112,248
buffer_load_dwordx4 v5, s[8:11], s51 offen offset:3072 lds
Maaa 168,116,252
v_xor_b32 v2, 384, v2
v_xor_b32 v3, 384, v3
Maaa 172,120,248
s_waitcnt lgkmcnt(6)
buffer_load_dword v1, v47, s[60:63], 0 offen
v_xor_b32 v4, 384, v4
v_xor_b32 v5, 384, v5
Maaa 172,124,252
s_waitcnt lgkmcnt(0)
s_mul_i32 vcc_lo, s59, 1
v_xor_b32_e64 v47, vcc_lo, v47
Mvaa 48,0,224
buffer_load_dword v44, v45, s[16:19], s47 offen
Mvaa 48,4,228
s_add_u32 s47, s47, 2097152
Mvaa 52,8,224
Mvaa 52,12,228
Ra 240,10,4096
Mvaa 56,16,224
Mvaa 56,20,228
Mvaa 60,24,224
Mvaa 60,28,228
Ra 244,11,4096
Mvaa 64,32,224
Mvaa 64,36,228
Mvaa 68,40,224
Mvaa 68,44,228
Ra 248,10,6144
Mvaa 72,48,224
Mvaa 72,52,228
Mvaa 76,56,224
Mvaa 76,60,228
Ra 252,11,6144
Mvaa 80,0,232
Mvaa 80,4,236
Mvaa 84,8,232
Mvaa 84,12,236
Mvaa 88,16,232
Mvaa 88,20,236
Mvaa 92,24,232
Mvaa 92,28,236
Mvaa 96,32,232
Mvaa 96,36,236
Mvaa 100,40,232
Mvaa 100,44,236
Mvaa 104,48,232
Mvaa 104,52,236
Mvaa 108,56,232
s_waitcnt lgkmcnt(0)
Mvaa 108,60,236
Mvaa 112,0,240
Mvaa 112,4,244
Mvaa 116,8,240
Mvaa 116,12,244
Ra 224,10,8192
Mvaa 120,16,240
Mvaa 120,20,244
Mvaa 124,24,240
Mvaa 124,28,244
Ra 228,11,8192
Mvaa 128,32,240
Mvaa 128,36,244
Mvaa 132,40,240
Mvaa 132,44,244
Ra 232,10,10240
Mvaa 136,48,240
Mvaa 136,52,244
Mvaa 140,56,240
Mvaa 140,60,244
Ra 236,11,10240
Mvaa 144,0,248
Mvaa 144,4,252
Mvaa 148,8,248
Mvaa 148,12,252
Mvaa 152,16,248
s_cmp_eq_u32 s6, 3
s_cselect_b32 s3, 0, 2146435072
Mvaa 152,20,252
s_mov_b64 exec, 1
buffer_atomic_add v30, v31, s[28:31], s3 offen sc1
s_mov_b64 exec, -1
Mvaa 156,24,248
Mvaa 156,28,252
Mvaa 160,32,248
Mvaa 160,36,252
Mvaa 164,40,248
Mvaa 164,44,252
Mvaa 168,48,248
Mvaa 168,52,252
s_waitcnt vmcnt(12)
Mvaa 172,56,248
s_waitcnt lgkmcnt(0)
s_barrier
Mvaa 172,60,252
s_add_u32 m0, s57, 0
Mvaa 176,0,224
buffer_load_dwordx4 v6, s[12:15], s52 offen offset:0 lds
Mvaa 176,4,228
Ta 64,14,0
Ta 66,14,2048
Mvaa 180,8,224
Mvaa 180,12,228
Ra 240,10,12288
Mvaa 184,16,224
buffer_load_dwordx4 v7, s[12:15], s53 offen offset:1024 lds
Mvaa 184,20,228
Ta 68,14,16384
Ta 70,14,18432
Mvaa 188,24,224
Mvaa 188,28,228
Ra 244,11,12288
Mvaa 192,32,224
buffer_load_dwordx4 v6, s[12:15], s54 offen offset:2048 lds
Mvaa 192,36,228
Ta 72,15,0
Ta 74,15,2048
Mvaa 196,40,224
Mvaa 196,44,228
Ra 248,10,14336
Mvaa 200,48,224
buffer_load_dwordx4 v7, s[12:15], s55 offen offset:3072 lds
Mvaa 200,52,228
Ta 76,15,16384
Ta 78,15,18432
Mvaa 204,56,224
Mvaa 204,60,228
s_add_u32 m0, s57, 4096
Ra 252,11,14336
Mvaa 208,0,232
buffer_load_dwordx4 v8, s[12:15], s52 offen offset:0 lds
Mvaa 208,4,236
Mvaa 212,8,232
Mvaa 212,12,236
Ta 80,24,0
Ta 82,24,2048
Mvaa 216,16,232
buffer_load_dwordx4 v9, s[12:15], s53 offen offset:1024 lds
Mvaa 216,20,236
Ta 84,24,16384
s_waitcnt lgkmcnt(9)
Ta 86,24,18432
Mvaa 220,24,232
Mvaa 220,28,236
Ta 88,25,0
Ta 90,25,2048
Mvaa 224,32,232
buffer_load_dwordx4 v8, s[12:15], s54 offen offset:2048 lds
Mvaa 224,36,236
Mvaa 228,40,232
Mvaa 228,44,236
Ta 92,25,16384
Ta 94,25,18432
Mvaa 232,48,232
buffer_load_dwordx4 v9, s[12:15], s55 offen offset:3072 lds
Mvaa 232,52,236
s_waitcnt vmcnt(11)
Ta 96,26,0
s_waitcnt lgkmcnt(9)
Ta 98,26,2048
Mvaa 236,56,232
s_barrier
v_xor_b32 v6, 524288, v6
v_xor_b32 v7, 524288, v7
Mvaa 236,60,236
s_add_u32 m0, s56, 0
Ta 100,26,16384
Ta 102,26,18432
Mvaa 240,0,240
buffer_load_dwordx4 v2, s[8:11], s48 offen offset:0 lds
Mvaa 240,4,244
v_xor_b32 v8, 524288, v8
v_xor_b32 v9, 524288, v9
Mvaa 244,8,240
Mvaa 244,12,244
Ra 224,12,0
Mvaa 248,16,240
buffer_load_dwordx4 v3, s[8:11], s49 offen offset:1024 lds
Mvaa 248,20,244
Ta 104,27,0
Ta 106,27,2048
Mvaa 252,24,240
Mvaa 252,28,244
s_waitcnt lgkmcnt(9)
Ra 228,13,0
Maaa 128,32,240
buffer_load_dwordx4 v2, s[8:11], s50 offen offset:2048 lds
Maaa 128,36,244
Ta 108,27,16384
Ta 110,27,18432
Maaa 132,40,240
Maaa 132,44,244
Ra 232,12,2048
Maaa 136,48,240
buffer_load_dwordx4 v3, s[8:11], s51 offen offset:3072 lds
Maaa 136,52,244
Ta 112,28,0
Ta 114,28,2048
Maaa 140,56,240
Maaa 140,60,244
s_add_u32 m0, s56, 4096
s_waitcnt lgkmcnt(9)
Ra 236,13,2048
Maaa 144,0,248
buffer_load_dwordx4 v4, s[8:11], s48 offen offset:0 lds
Maaa 144,4,252
Maaa 148,8,248
Maaa 148,12,252
Ta 116,28,16384
Ta 118,28,18432
Maaa 152,16,248
buffer_load_dwordx4 v5, s[8:11], s49 offen offset:1024 lds
Maaa 152,20,252
Ta 120,29,0
Ta 122,29,2048
Maaa 156,24,248
Maaa 156,28,252
Ta 124,29,16384
s_waitcnt lgkmcnt(9)
Ta 126,29,18432
Maaa 160,32,248
buffer_load_dwordx4 v4, s[8:11], s50 offen offset:2048 lds
Maaa 160,36,252
Maaa 164,40,248
Maaa 164,44,252
Maaa 168,48,248
buffer_load_dwordx4 v5, s[8:11], s51 offen offset:3072 lds
Maaa 168,52,252
v_xor_b32 v2, 128, v2
v_xor_b32 v3, 128, v3
Maaa 172,56,248
s_waitcnt lgkmcnt(6)
buffer_load_dword v1, v47, s[60:63], 0 offen
v_xor_b32 v4, 128, v4
v_xor_b32 v5, 128, v5
Maaa 172,60,252
s_waitcnt lgkmcnt(0)
s_mul_i32 vcc_lo, s59, 7
v_xor_b32 v47, vcc_lo, v47
Mvaa 48,64,224
buffer_load_dword v44, v45, s[16:19], s47 offen
Mvaa 48,68,228
s_add_u32 s47, s47, 2097152
v_lshrrev_b32 v32, 4, v0
v_and_b32 v33, 15, v0
Mvaa 52,72,224
s_lshl_b32 s3, s32, 4
v_add_u32 v34, s3, v32
v_lshlrev_b32_e64 v36, 1, v32
Mvaa 52,76,228
Ra 240,12,4096
Mvaa 56,80,224
v_xor_b32 v36, v36, v33
v_xor_b32 v37, 8, v36
Mvaa 56,84,228
Mvaa 60,88,224
Mvaa 60,92,228
Ra 244,13,4096
Mvaa 64,96,224
s_getpc_b64 s[6:7]
L_cpf2:
s_add_u32 s6, s6, (L_phase2-L_cpf2)&0xffffffff
s_addc_u32 s7, s7, ((L_phase2-L_cpf2)>>32)&0xffffffff
Mvaa 64,100,228
s_lshr_b32 s3, s2, 3
s_lshl_b32 s3, s3, 2
s_add_u32 s3, s3, s32
Mvaa 68,104,224
s_lshl_b32 s3, s3, 10
v_and_b32 v42, 7, v0
v_lshlrev_b32_e64 v42, 7, v42
Mvaa 68,108,228
Ra 248,12,6144
Mvaa 72,112,224
v_add_u32_e64 v42, s3, v42
v_min_u32 v42, L_k2_fin-L_phase2-4, v42
Mvaa 72,116,228
v_mov_b32_e64 v41, s7
Mvaa 76,120,224
v_add_co_u32 v40, vcc, s6, v42
s_nop 1
v_addc_co_u32 v41, vcc, 0, v41, vcc
Mvaa 76,124,228
Ra 252,13,6144
Mvaa 80,64,232
global_load_dword v38, v[40:41], off
Mvaa 80,68,236
Mvaa 84,72,232
Mvaa 84,76,236
Mvaa 88,80,232
Mvaa 88,84,236
Mvaa 92,88,232
Mvaa 92,92,236
Mvaa 96,96,232
Mvaa 96,100,236
Mvaa 100,104,232
Mvaa 100,108,236
Mvaa 104,112,232
Mvaa 104,116,236
Mvaa 108,120,232
s_waitcnt lgkmcnt(0)
Mvaa 108,124,236
Mvaa 112,64,240
Mvaa 112,68,244
Mvaa 116,72,240
Mvaa 116,76,244
Ra 224,12,8192
Mvaa 120,80,240
Mvaa 120,84,244
Mvaa 124,88,240
Mvaa 124,92,244
Ra 228,13,8192
Mvaa 128,96,240
Mvaa 128,100,244
Mvaa 132,104,240
Mvaa 132,108,244
Ra 232,12,10240
Mvaa 136,112,240
Mvaa 136,116,244
Mvaa 140,120,240
Mvaa 140,124,244
Ra 236,13,10240
Mvaa 144,64,248
Mvaa 144,68,252
Mvaa 148,72,248
Mvaa 148,76,252
Mvaa 152,80,248
Mvaa 152,84,252
Mvaa 156,88,248
Mvaa 156,92,252
Mvaa 160,96,248
Mvaa 160,100,252
Mvaa 164,104,248
Mvaa 164,108,252
Mvaa 168,112,248
Mvaa 168,116,252
s_waitcnt vmcnt(11)
Mvaa 172,120,248
s_waitcnt lgkmcnt(0)
s_barrier
Mvaa 172,124,252
s_add_u32 m0, s57, 65536
Mvaa 176,64,224
buffer_load_dwordx4 v6, s[12:15], s52 offen offset:0 lds
Mvaa 176,68,228
Ta 0,16,0
Ta 2,16,2048
Mvaa 180,72,224
Mvaa 180,76,228
Ra 240,12,12288
Mvaa 184,80,224
buffer_load_dwordx4 v7, s[12:15], s53 offen offset:1024 lds
Mvaa 184,84,228
Ta 4,16,16384
Ta 6,16,18432
Mvaa 188,88,224
Mvaa 188,92,228
Ra 244,13,12288
Mvaa 192,96,224
buffer_load_dwordx4 v6, s[12:15], s54 offen offset:2048 lds
Mvaa 192,100,228
Ta 8,17,0
Ta 10,17,2048
Mvaa 196,104,224
Mvaa 196,108,228
Ra 248,12,14336
Mvaa 200,112,224
buffer_load_dwordx4 v7, s[12:15], s55 offen offset:3072 lds
Mvaa 200,116,228
Ta 12,17,16384
Ta 14,17,18432
Mvaa 204,120,224
Mvaa 204,124,228
s_add_u32 m0, s57, 69632
Ra 252,13,14336
Mvaa 208,64,232
buffer_load_dwordx4 v8, s[12:15], s52 offen offset:0 lds
Mvaa 208,68,236
Mvaa 212,72,232
Mvaa 212,76,236
Ta 16,18,0
Ta 18,18,2048
Mvaa 216,80,232
buffer_load_dwordx4 v9, s[12:15], s53 offen offset:1024 lds
Mvaa 216,84,236
Ta 20,18,16384
s_waitcnt lgkmcnt(9)
Ta 22,18,18432
Mvaa 220,88,232
Mvaa 220,92,236
Ta 24,19,0
Ta 26,19,2048
Mvaa 224,96,232
buffer_load_dwordx4 v8, s[12:15], s54 offen offset:2048 lds
Mvaa 224,100,236
Mvaa 228,104,232
Mvaa 228,108,236
Ta 28,19,16384
Ta 30,19,18432
Mvaa 232,112,232
buffer_load_dwordx4 v9, s[12:15], s55 offen offset:3072 lds
Mvaa 232,116,236
s_waitcnt vmcnt(11)
Ta 32,20,0
s_waitcnt lgkmcnt(9)
Ta 34,20,2048
Mvaa 236,120,232
s_barrier
Mvaa 236,124,236
s_add_u32 m0, s56, 65536
Ta 36,20,16384
Ta 38,20,18432
Mvaa 240,64,240
buffer_load_dwordx4 v2, s[8:11], s48 offen offset:0 lds
Mvaa 240,68,244
Mvaa 244,72,240
Mvaa 244,76,244
Ra 224,10,0
Mvaa 248,80,240
buffer_load_dwordx4 v3, s[8:11], s49 offen offset:1024 lds
Mvaa 248,84,244
Ta 40,21,0
Ta 42,21,2048
Mvaa 252,88,240
Mvaa 252,92,244
s_waitcnt lgkmcnt(9)
Ra 228,11,0
Maaa 128,96,240
buffer_load_dwordx4 v2, s[8:11], s50 offen offset:2048 lds
Maaa 128,100,244
Ta 44,21,16384
Ta 46,21,18432
Maaa 132,104,240
Maaa 132,108,244
Ra 232,10,2048
Maaa 136,112,240
buffer_load_dwordx4 v3, s[8:11], s51 offen offset:3072 lds
Maaa 136,116,244
Ta 48,22,0
Ta 50,22,2048
Maaa 140,120,240
Maaa 140,124,244
s_add_u32 m0, s56, 69632
s_waitcnt lgkmcnt(9)
Ra 236,11,2048
Maaa 144,64,248
buffer_load_dwordx4 v4, s[8:11], s48 offen offset:0 lds
Maaa 144,68,252
Maaa 148,72,248
Maaa 148,76,252
Ta 52,22,16384
Ta 54,22,18432
Maaa 152,80,248
buffer_load_dwordx4 v5, s[8:11], s49 offen offset:1024 lds
Maaa 152,84,252
Ta 56,23,0
Ta 58,23,2048
Maaa 156,88,248
Maaa 156,92,252
Ta 60,23,16384
s_waitcnt lgkmcnt(9)
Ta 62,23,18432
Maaa 160,96,248
buffer_load_dwordx4 v4, s[8:11], s50 offen offset:2048 lds
Maaa 160,100,252
Maaa 164,104,248
Maaa 164,108,252
Maaa 168,112,248
buffer_load_dwordx4 v5, s[8:11], s51 offen offset:3072 lds
Maaa 168,116,252
Maaa 172,120,248
s_waitcnt lgkmcnt(6)
Maaa 172,124,252
s_waitcnt lgkmcnt(0)
Mvaa 48,0,224
buffer_load_dword v1, v31, s[28:31], s37 offen sc1
Mvaa 48,4,228
s_mov_b32 s8, s16
s_mov_b32 s9, s17
s_mov_b32 s10, s18
Mvaa 52,8,224
s_add_u32 s16, s66, 46137344
s_addc_u32 s17, s67, 0
s_and_b32 s17, s17, 0xffff
Mvaa 52,12,228
Ra 240,10,4096
Mvaa 56,16,224
s_mov_b32 s18, 16777216
s_mov_b32 s19, 0x20000
s_mov_b32 s48, 0
Mvaa 56,20,228
s_mov_b32 s49, 31744
s_mov_b32 s50, 63488
s_mov_b32 s51, 95232
Mvaa 60,24,224
v_lshlrev_b32 v35, 13, v34
Mvaa 60,28,228
Ra 244,11,4096
Mvaa 64,32,224
s_and_b32 s52, s33, 0
s_lshl_b32 s3, s52, 19
s_lshl_b32 s52, s52, 11
Mvaa 64,36,228
s_add_u32 s53, s52, s58
v_add_u32_e64 v35, s3, v35
v_lshl_add_u32 v8, v36, 4, v35
Mvaa 68,40,224
v_lshl_add_u32 v9, v37, 4, v35
v_lshlrev_b32_e64 v2, 4, v0
Mvaa 68,44,228
Ra 248,10,6144
Mvaa 72,48,224
v_add_u32 v3, 65536, v2
v_add_u32_e64 v4, s44, v2
Mvaa 72,52,228
v_mov_b32 v7, 0
v_lshlrev_b32 v35, 2, v32
Mvaa 76,56,224
v_sub_u32_e64 v35, v33, v35
Mvaa 76,60,228
Ra 252,11,6144
Mvaa 80,0,232
s_lshl_b32 s3, s32, 4
v_add_u32 v5, s3, v35
Mvaa 80,4,236
s_sub_u32 s3, 48, s3
v_add_u32 v6, s3, v35
Mvaa 84,8,232
s_mul_i32 s3, s33, 1116160
s_add_u32 s3, s3, 8388608
s_add_u32 s12, s66, s3
s_addc_u32 s13, s67, 0
s_and_b32 s13, s13, 0xffff
Mvaa 84,12,236
s_mov_b32 s14, 0
s_mov_b32 s15, 0x20000
s_mul_i32 s14, s36, 34816
Mvaa 88,16,232
buffer_load_dword v44, v45, s[8:11], s47 offen
Mvaa 88,20,236
s_add_u32 s47, s47, 2097152
v_lshrrev_b32 v42, 2, v33
v_lshl_add_u32 v43, v32, 3, v42
Mvaa 92,24,232
v_lshlrev_b32 v43, 8, v43
v_and_b32 v46, 3, v0
Mvaa 92,28,236
v_lshl_add_u32 v43, v46, 3, v43
v_and_b32_e64 v46, 1, v32
Mvaa 96,32,232
v_lshl_add_u32 v42, v46, 2, v42
v_lshl_add_u32 v16, v42, 5, v43
Mvaa 96,36,236
v_xor_b32 v17, 32, v16
v_xor_b32 v18, 64, v16
Mvaa 100,40,232
v_xor_b32 v19, 96, v16
v_xor_b32 v20, 128, v16
Mvaa 100,44,236
v_xor_b32 v21, 160, v16
v_xor_b32 v22, 192, v16
Mvaa 104,48,232
v_xor_b32 v23, 224, v16
Mvaa 104,52,236
Mvaa 108,56,232
s_waitcnt lgkmcnt(0)
Mvaa 108,60,236
Mvaa 112,0,240
Mvaa 112,4,244
Mvaa 116,8,240
Mvaa 116,12,244
Ra 224,10,8192
Mvaa 120,16,240
Mvaa 120,20,244
Mvaa 124,24,240
Mvaa 124,28,244
Ra 228,11,8192
Mvaa 128,32,240
Mvaa 128,36,244
Mvaa 132,40,240
Mvaa 132,44,244
Ra 232,10,10240
Mvaa 136,48,240
Mvaa 136,52,244
Mvaa 140,56,240
Mvaa 140,60,244
Ra 236,11,10240
Mvaa 144,0,248
Mvaa 144,4,252
Mvaa 148,8,248
Mvaa 148,12,252
Mvaa 152,16,248
Mvaa 152,20,252
Mvaa 156,24,248
Mvaa 156,28,252
Mvaa 160,32,248
Mvaa 160,36,252
Mvaa 164,40,248
Mvaa 164,44,252
Mvaa 168,48,248
Mvaa 168,52,252
s_waitcnt vmcnt(10)
Mvaa 172,56,248
s_waitcnt lgkmcnt(0)
s_barrier
Mvaa 172,60,252
s_add_u32 m0, s44, 0
Mvaa 176,0,224
buffer_load_dwordx4 v8, s[8:11], s48 offen offset:0 lds
Mvaa 176,4,228
Ta 64,14,0
Ta 66,14,2048
Mvaa 180,8,224
Mvaa 180,12,228
Ra 240,10,12288
Mvaa 184,16,224
buffer_load_dwordx4 v8, s[8:11], s49 offen offset:1024 lds
Mvaa 184,20,228
Ta 68,14,16384
Ta 70,14,18432
Mvaa 188,24,224
Mvaa 188,28,228
Ra 244,11,12288
Mvaa 192,32,224
buffer_load_dwordx4 v9, s[8:11], s50 offen offset:2048 lds
Mvaa 192,36,228
Ta 72,15,0
Ta 74,15,2048
Mvaa 196,40,224
Mvaa 196,44,228
Ra 248,10,14336
Mvaa 200,48,224
buffer_load_dwordx4 v9, s[8:11], s51 offen offset:3072 lds
Mvaa 200,52,228
Ta 76,15,16384
Ta 78,15,18432
Mvaa 204,56,224
v_xor_b32 v8, 524288, v8
v_xor_b32 v9, 524288, v9
Mvaa 204,60,228
s_add_u32 m0, s44, 16384
Ra 252,11,14336
Mvaa 208,0,232
buffer_load_dwordx4 v8, s[8:11], s48 offen offset:0 lds
Mvaa 208,4,236
Mvaa 212,8,232
Mvaa 212,12,236
Ta 80,24,0
Ta 82,24,2048
Mvaa 216,16,232
buffer_load_dwordx4 v8, s[8:11], s49 offen offset:1024 lds
Mvaa 216,20,236
Ta 84,24,16384
s_waitcnt lgkmcnt(9)
Ta 86,24,18432
Mvaa 220,24,232
Mvaa 220,28,236
Ta 88,25,0
Ta 90,25,2048
Mvaa 224,32,232
buffer_load_dwordx4 v9, s[8:11], s50 offen offset:2048 lds
Mvaa 224,36,236
Mvaa 228,40,232
s_mul_i32 s3, s45, 33792
v_add_u32_e64 v10, s3, v2
Mvaa 228,44,236
Ta 92,25,16384
Ta 94,25,18432
Mvaa 232,48,232
buffer_load_dwordx4 v9, s[8:11], s51 offen offset:3072 lds
Mvaa 232,52,236
s_waitcnt vmcnt(10)
Ta 96,26,0
s_waitcnt lgkmcnt(9)
Ta 98,26,2048
Mvaa 236,56,232
s_barrier
v_xor_b32 v8, 1572864, v8
v_xor_b32 v9, 1572864, v9
Mvaa 236,60,236
s_add_u32 m0, s44, 32768
Ta 100,26,16384
Ta 102,26,18432
Mvaa 240,0,240
buffer_load_dwordx4 v8, s[8:11], s48 offen offset:0 lds
Mvaa 240,4,244
s_mul_i32 s3, s46, 33792
v_add_u32 v11, s3, v2
Mvaa 244,8,240
Mvaa 244,12,244
Ra 224,12,0
Mvaa 248,16,240
buffer_load_dwordx4 v8, s[8:11], s49 offen offset:1024 lds
Mvaa 248,20,244
Ta 104,27,0
Ta 106,27,2048
Mvaa 252,24,240
Mvaa 252,28,244
s_waitcnt lgkmcnt(9)
Ra 228,13,0
Maaa 128,32,240
buffer_load_dwordx4 v9, s[8:11], s50 offen offset:2048 lds
Maaa 128,36,244
Ta 108,27,16384
Ta 110,27,18432
Maaa 132,40,240
Maaa 132,44,244
Ra 232,12,2048
Maaa 136,48,240
buffer_load_dwordx4 v9, s[8:11], s51 offen offset:3072 lds
Maaa 136,52,244
Ta 112,28,0
Ta 114,28,2048
Maaa 140,56,240
v_xor_b32 v8, 524288, v8
v_xor_b32 v9, 524288, v9
Maaa 140,60,244
s_add_u32 m0, s44, 49152
s_waitcnt lgkmcnt(9)
Ra 236,13,2048
Maaa 144,0,248
buffer_load_dwordx4 v8, s[8:11], s48 offen offset:0 lds
Maaa 144,4,252
Maaa 148,8,248
Maaa 148,12,252
Ta 116,28,16384
Ta 118,28,18432
Maaa 152,16,248
buffer_load_dwordx4 v8, s[8:11], s49 offen offset:1024 lds
Maaa 152,20,252
Ta 120,29,0
Ta 122,29,2048
Maaa 156,24,248
Maaa 156,28,252
Ta 124,29,16384
s_waitcnt lgkmcnt(9)
Ta 126,29,18432
Maaa 160,32,248
buffer_load_dwordx4 v9, s[8:11], s50 offen offset:2048 lds
Maaa 160,36,252
Maaa 164,40,248
Maaa 164,44,252
Maaa 168,48,248
buffer_load_dwordx4 v9, s[8:11], s51 offen offset:3072 lds
Maaa 168,52,252
v_xor_b32 v8, 3670016, v8
v_xor_b32 v9, 3670016, v9
Maaa 172,56,248
s_waitcnt lgkmcnt(6)
Maaa 172,60,252
s_waitcnt lgkmcnt(0)
Mvaa 48,64,224
v_mov_b32 v14, v40
v_mov_b32_e64 v15, v41
Mvaa 48,68,228
Mvaa 52,72,224
Mvaa 52,76,228
Ra 240,12,4096
Mvaa 56,80,224
Mvaa 56,84,228
Mvaa 60,88,224
Mvaa 60,92,228
Ra 244,13,4096
Mvaa 64,96,224
Vc 24,48,49
Vc 25,50,51
Mvaa 64,100,228
Vc 26,52,53
Vc 27,54,55
Mvaa 68,104,224
Mvaa 68,108,228
Ra 248,12,6144
Mvaa 72,112,224
Vc 28,56,57
Vc 29,58,59
Mvaa 72,116,228
Vc 30,60,61
Vc 31,62,63
Mvaa 76,120,224
Mvaa 76,124,228
Ra 252,13,6144
Mvaa 80,64,232
Vc 32,64,65
Vc 33,66,67
Mvaa 80,68,236
Vc 34,68,69
Vc 35,70,71
Mvaa 84,72,232
Mvaa 84,76,236
Mvaa 88,80,232
Vc 36,72,73
Vc 37,74,75
Mvaa 88,84,236
Vc 38,76,77
Vc 39,78,79
Mvaa 92,88,232
Mvaa 92,92,236
Mvaa 96,96,232
Vc 40,80,81
Vc 41,82,83
Mvaa 96,100,236
Vc 42,84,85
Vc 43,86,87
Mvaa 100,104,232
s_waitcnt vmcnt(12)
Mvaa 100,108,236
s_add_u32 s59, s38, 0
Mvaa 104,112,232
v_readfirstlane_b32 s3, v1
s_nop 0
s_or_b32 s3, s3, s37
s_cmp_lt_u32 s3, 256
s_cbranch_scc1 L_spinAk
L_spinArk:
s_barrier
Mvaa 104,116,236
buffer_store_dwordx4 v[24:27], v2, s[24:27], s59 offen offset:0 sc1
Mvaa 108,120,232
s_waitcnt lgkmcnt(0)
Mvaa 108,124,236
Vc 44,88,89
Vc 45,90,91
Mvaa 112,64,240
buffer_load_dwordx4 a[0:3], v10, s[20:23], s53 offen offset:0 sc1
Mvaa 112,68,244
Vc 46,92,93
Vc 47,94,95
Mvaa 116,72,240
Vc 48,96,97
Vc 49,98,99
Mvaa 116,76,244
Ra 224,12,8192
Mvaa 120,80,240
Vc 50,100,101
Vc 51,102,103
Mvaa 120,84,244
Vc 52,104,105
Vc 53,106,107
Mvaa 124,88,240
buffer_load_dwordx4 a[4:7], v10, s[20:23], s52 offen offset:0 sc1
Mvaa 124,92,244
Ra 228,13,8192
Mvaa 128,96,240
Vc 54,108,109
Vc 55,110,111
Mvaa 128,100,244
Vc 56,112,113
Vc 57,114,115
Mvaa 132,104,240
Vc 58,116,117
Vc 59,118,119
Mvaa 132,108,244
Ra 232,12,10240
Mvaa 136,112,240
buffer_load_dwordx4 a[8:11], v11, s[20:23], s53 offen offset:0 sc1
Mvaa 136,116,244
buffer_store_dwordx4 v[28:31], v2, s[24:27], s59 offen offset:1024 sc1
Mvaa 140,120,240
Vc 60,120,121
Vc 61,122,123
Mvaa 140,124,244
Ra 236,13,10240
Mvaa 144,64,248
Vc 62,124,125
Vc 63,126,127
Mvaa 144,68,252
Vc 64,128,129
Vc 65,130,131
Mvaa 148,72,248
buffer_load_dwordx4 a[12:15], v11, s[20:23], s52 offen offset:0 sc1
Mvaa 148,76,252
Vc 66,132,133
Vc 67,134,135
Mvaa 152,80,248
Vc 68,136,137
Vc 69,138,139
Mvaa 152,84,252
Vc 70,140,141
Vc 71,142,143
Mvaa 156,88,248
Mvaa 156,92,252
Mvaa 160,96,248
buffer_load_dwordx4 a[16:19], v10, s[20:23], s53 offen offset:1024 sc1
Mvaa 160,100,252
Vc 72,144,145
Vc 73,146,147
Mvaa 164,104,248
Vc 74,148,149
Vc 75,150,151
Mvaa 164,108,252
buffer_store_dwordx4 v[32:35], v2, s[24:27], s59 offen offset:2048 sc1
Mvaa 168,112,248
Vc 76,152,153
Vc 77,154,155
Mvaa 168,116,252
Vc 78,156,157
Vc 79,158,159
Mvaa 172,120,248
s_waitcnt lgkmcnt(0)
buffer_load_dwordx4 a[20:23], v10, s[20:23], s52 offen offset:1024 sc1
Mvaa 172,124,252
Mvaa 176,64,224
Vc 80,160,161
Vc 81,162,163
Mvaa 176,68,228
Vc 82,164,165
Vc 83,166,167
Mvaa 180,72,224
Mvaa 180,76,228
Ra 240,12,12288
Mvaa 184,80,224
buffer_load_dwordx4 a[24:27], v11, s[20:23], s53 offen offset:1024 sc1
Mvaa 184,84,228
Vc 84,168,169
Vc 85,170,171
Mvaa 188,88,224
Vc 86,172,173
Vc 87,174,175
Mvaa 188,92,228
Ra 244,13,12288
Mvaa 192,96,224
Vc 88,176,177
Vc 89,178,179
Mvaa 192,100,228
Vc 90,180,181
Vc 91,182,183
Mvaa 196,104,224
buffer_load_dwordx4 a[28:31], v11, s[20:23], s52 offen offset:1024 sc1
Mvaa 196,108,228
Ra 248,12,14336
s_xor_b32 s52, s52, 2048
Mvaa 200,112,224
s_add_u32 s53, s52, s58
Mvaa 200,116,228
Vc 92,184,185
Vc 93,186,187
Mvaa 204,120,224
Vc 94,188,189
Vc 95,190,191
Mvaa 204,124,228
Ra 252,13,14336
Mvaa 208,64,232
buffer_load_dwordx4 a[32:35], v10, s[20:23], s53 offen offset:0 sc1
Mvaa 208,68,236
buffer_store_dwordx4 v[36:39], v2, s[24:27], s59 offen offset:3072 sc1
Mvaa 212,72,232
Vc 96,192,193
Vc 97,194,195
Mvaa 212,76,236
Vc 98,196,197
Vc 99,198,199
Mvaa 216,80,232
Vc 100,200,201
Vc 101,202,203
Mvaa 216,84,236
Vc 102,204,205
Vc 103,206,207
Mvaa 220,88,232
buffer_load_dwordx4 a[36:39], v10, s[20:23], s52 offen offset:0 sc1
Mvaa 220,92,236
Mvaa 224,96,232
Vc 104,208,209
Vc 105,210,211
Mvaa 224,100,236
Vc 106,212,213
Vc 107,214,215
Mvaa 228,104,232
Mvaa 228,108,236
Mvaa 232,112,232
buffer_load_dwordx4 a[40:43], v11, s[20:23], s53 offen offset:0 sc1
Mvaa 232,116,236
Vc 108,216,217
Vc 109,218,219
Mvaa 236,120,232
s_waitcnt lgkmcnt(0)
Mvaa 236,124,236
Vc 110,220,221
Vc 111,222,223
Mvaa 240,64,240
s_add_u32 s59, s38, 4096
Mvaa 240,68,244
buffer_store_dwordx4 v[40:43], v2, s[24:27], s59 offen offset:0 sc1
Mvaa 244,72,240
buffer_load_dwordx4 a[44:47], v11, s[20:23], s52 offen offset:0 sc1
Mvaa 244,76,244
Vc 112,224,225
Vc 113,226,227
Mvaa 248,80,240
Vc 114,228,229
Vc 115,230,231
Mvaa 248,84,244
Vc 116,232,233
Vc 117,234,235
Mvaa 252,88,240
Vc 118,236,237
Vc 119,238,239
Mvaa 252,92,244
Maaa 128,96,240
buffer_load_dwordx4 a[48:51], v10, s[20:23], s53 offen offset:1024 sc1
Maaa 128,100,244
Ta 192,16,0
Ta 194,16,1024
Maaa 132,104,240
Vc 120,240,241
Vc 121,242,243
Maaa 132,108,244
Ta 196,16,8192
Ta 198,16,9216
Maaa 136,112,240
Vc 122,244,245
Vc 123,246,247
Maaa 136,116,244
Ta 200,17,0
Ta 202,17,1024
Maaa 140,120,240
buffer_load_dwordx4 a[52:55], v10, s[20:23], s52 offen offset:1024 sc1
Maaa 140,124,244
Ta 204,17,8192
Ta 206,17,9216
Maaa 144,64,248
Vc 124,248,249
Vc 125,250,251
Maaa 144,68,252
Ta 208,18,0
Ta 210,18,1024
Maaa 148,72,248
Vc 126,252,253
Vc 127,254,255
Maaa 148,76,252
Ta 212,18,8192
Ta 214,18,9216
Maaa 152,80,248
buffer_load_dwordx4 a[56:59], v11, s[20:23], s53 offen offset:1024 sc1
Maaa 152,84,252
Ta 216,19,0
Ta 218,19,1024
Maaa 156,88,248
buffer_store_dwordx4 v[44:47], v2, s[24:27], s59 offen offset:1024 sc1
Maaa 156,92,252
Ta 220,19,8192
s_waitcnt lgkmcnt(9)
Ta 222,19,9216
Maaa 160,96,248
Maaa 160,100,252
Maaa 164,104,248
buffer_load_dwordx4 a[60:63], v11, s[20:23], s52 offen offset:1024 sc1
Maaa 164,108,252
s_xor_b32 s52, s52, 6144
s_add_u32 s53, s52, s58
Maaa 168,112,248
Maaa 168,116,252
Maaa 172,120,248
Maaa 172,124,252
s_branch L_phase2
L_k1_vpath:
Zvaa 48,224,0
v_and_b32_e64 v46, 7, v0
v_mul_u32_u24 v30, 2064, v46
Mvaa 48,228,4
s_add_u32 m0, s57, 65536
Zvaa 52,232,0
buffer_load_dwordx4 v6, s[12:15], s52 offen offset:0 lds
Mvaa 52,236,4
Ra 240,10,4096
Zvaa 56,224,8
buffer_load_dwordx4 v7, s[12:15], s53 offen offset:1024 lds
Mvaa 56,228,12
v_lshrrev_b32_e64 v31, 3, v0
Zvaa 60,232,8
buffer_load_dwordx4 v6, s[12:15], s54 offen offset:2048 lds
Mvaa 60,236,12
Ra 244,11,4096
Zvaa 64,224,16
buffer_load_dwordx4 v7, s[12:15], s55 offen offset:3072 lds
Mvaa 64,228,20
s_add_u32 m0, s57, 69632
Zvaa 68,232,16
buffer_load_dwordx4 v8, s[12:15], s52 offen offset:0 lds
Mvaa 68,236,20
Ra 248,10,6144
Zvaa 72,224,24
buffer_load_dwordx4 v9, s[12:15], s53 offen offset:1024 lds
Mvaa 72,228,28
s_lshl_b32 s3, s32, 9
s_add_u32 s3, s3, 131072
v_lshl_add_u32 v30, v31, 4, v30
Zvaa 76,232,24
buffer_load_dwordx4 v8, s[12:15], s54 offen offset:2048 lds
Mvaa 76,236,28
s_waitcnt lgkmcnt(9)
Ra 252,11,6144
Zvaa 80,224,32
buffer_load_dwordx4 v9, s[12:15], s55 offen offset:3072 lds
Mvaa 80,228,36
s_add_u32 m0, s56, 65536
v_xor_b32 v6, 1572864, v6
v_xor_b32 v7, 1572864, v7
Zvaa 84,232,32
buffer_load_dwordx4 v2, s[8:11], s48 offen offset:0 lds
Mvaa 84,236,36
v_xor_b32 v8, 1572864, v8
v_xor_b32 v9, 1572864, v9
Zvaa 88,224,40
buffer_load_dwordx4 v3, s[8:11], s49 offen offset:1024 lds
Mvaa 88,228,44
v_add_u32 v30, s3, v30
v_lshlrev_b32 v31, 8, v31
Zvaa 92,232,40
buffer_load_dwordx4 v2, s[8:11], s50 offen offset:2048 lds
Mvaa 92,236,44
v_lshl_add_u32 v46, v46, 4, v31
s_waitcnt lgkmcnt(8)
Zvaa 96,224,48
buffer_load_dwordx4 v3, s[8:11], s51 offen offset:3072 lds
Mvaa 96,228,52
s_add_u32 m0, s56, 69632
Zvaa 100,232,48
buffer_load_dwordx4 v4, s[8:11], s48 offen offset:0 lds
Mvaa 100,236,52
Rv 34,30,128
Rv 38,30,256
s_waitcnt lgkmcnt(6)
Zvaa 104,224,56
buffer_load_dwordx4 v5, s[8:11], s49 offen offset:1024 lds
Mvaa 104,228,60
Rv 42,30,384
Rv 30,30,0
Zvaa 108,232,56
s_waitcnt lgkmcnt(4)
buffer_load_dwordx4 v4, s[8:11], s50 offen offset:2048 lds
Mvaa 108,236,60
s_lshr_b32 s3, s2, 1
s_mul_i32 s3, s3, 33792
s_add_u32 s3, s3, s57
Zvaa 112,240,0
buffer_load_dwordx4 v5, s[8:11], s51 offen offset:3072 lds
Mvaa 112,244,4
v_xor_b32 v2, 384, v2
v_xor_b32 v3, 384, v3
Zvaa 116,248,0
s_and_b32 s39, s2, 1
s_lshl_b32 s39, s39, 7
s_add_u32 s3, s3, s39
Mvaa 116,252,4
Ra 224,10,8192
v_xor_b32 v4, 384, v4
Zvaa 120,240,8
s_add_u32 s39, s3, 4096
Mvaa 120,244,12
v_xor_b32 v5, 384, v5
Zvaa 124,248,8
Mvaa 124,252,12
Ra 228,11,8192
Zvaa 128,240,16
Mvaa 128,244,20
Zvaa 132,248,16
Mvaa 132,252,20
Ra 232,10,10240
Zvaa 136,240,24
buffer_load_dword v1, v47, s[60:63], 0 offen
Mvaa 136,244,28
s_mul_i32 vcc_lo, s59, 1
v_xor_b32 v47, vcc_lo, v47
Zvaa 140,248,24
Mvaa 140,252,28
Ra 236,11,10240
Zvaa 144,240,32
Mvaa 144,244,36
Zvaa 148,248,32
Mvaa 148,252,36
Zvaa 152,240,40
Mvaa 152,244,44
Zvaa 156,248,40
Mvaa 156,252,44
Zvaa 160,240,48
Mvaa 160,244,52
Zvaa 164,248,48
Mvaa 164,252,52
Zvaa 168,240,56
Mvaa 168,244,60
s_waitcnt vmcnt(9)
Zvaa 172,248,56
s_waitcnt lgkmcnt(0)
s_barrier
Mvaa 172,252,60
s_add_u32 m0, s57, 0
Zvaa 176,224,0
buffer_load_dwordx4 v6, s[12:15], s52 offen offset:0 lds
Mvaa 176,228,4
Ta 64,14,0
Ta 66,14,2048
Zvaa 180,232,0
Mvaa 180,236,4
Ra 240,10,12288
Zvaa 184,224,8
buffer_load_dwordx4 v7, s[12:15], s53 offen offset:1024 lds
Mvaa 184,228,12
Ta 68,14,16384
Ta 70,14,18432
Zvaa 188,232,8
Mvaa 188,236,12
Ra 244,11,12288
Zvaa 192,224,16
buffer_load_dwordx4 v6, s[12:15], s54 offen offset:2048 lds
Mvaa 192,228,20
Ta 72,15,0
Ta 74,15,2048
Zvaa 196,232,16
Mvaa 196,236,20
Ra 248,10,14336
Zvaa 200,224,24
buffer_load_dwordx4 v7, s[12:15], s55 offen offset:3072 lds
Mvaa 200,228,28
Ta 76,15,16384
Ta 78,15,18432
Zvaa 204,232,24
Mvaa 204,236,28
s_add_u32 m0, s57, 4096
Ra 252,11,14336
Zvaa 208,224,32
buffer_load_dwordx4 v8, s[12:15], s52 offen offset:0 lds
Mvaa 208,228,36
Zvaa 212,232,32
Mvaa 212,236,36
Ta 80,24,0
Ta 82,24,2048
Zvaa 216,224,40
buffer_load_dwordx4 v9, s[12:15], s53 offen offset:1024 lds
Mvaa 216,228,44
Ta 84,24,16384
s_waitcnt lgkmcnt(9)
Ta 86,24,18432
Zvaa 220,232,40
Mvaa 220,236,44
Ta 88,25,0
Ta 90,25,2048
Zvaa 224,224,48
buffer_load_dwordx4 v8, s[12:15], s54 offen offset:2048 lds
Mvaa 224,228,52
Zvaa 228,232,48
Mvaa 228,236,52
Ta 92,25,16384
Ta 94,25,18432
Zvaa 232,224,56
buffer_load_dwordx4 v9, s[12:15], s55 offen offset:3072 lds
Mvaa 232,228,60
s_waitcnt vmcnt(9)
Ta 96,26,0
s_waitcnt lgkmcnt(9)
Ta 98,26,2048
Zvaa 236,232,56
s_barrier
v_xor_b32 v6, 524288, v6
v_xor_b32 v7, 524288, v7
Mvaa 236,236,60
s_add_u32 m0, s56, 0
Ta 100,26,16384
Ta 102,26,18432
Zvaa 240,240,0
buffer_load_dwordx4 v2, s[8:11], s48 offen offset:0 lds
Mvaa 240,244,4
v_xor_b32 v8, 524288, v8
v_xor_b32 v9, 524288, v9
Zvaa 244,248,0
Mvaa 244,252,4
Ra 224,12,0
Zvaa 248,240,8
buffer_load_dwordx4 v3, s[8:11], s49 offen offset:1024 lds
Mvaa 248,244,12
Ta 104,27,0
Ta 106,27,2048
Zvaa 252,248,8
Mvaa 252,252,12
s_waitcnt lgkmcnt(9)
Ra 228,13,0
Zaaa 128,240,16
buffer_load_dwordx4 v2, s[8:11], s50 offen offset:2048 lds
Maaa 128,244,20
Ta 108,27,16384
Ta 110,27,18432
Zaaa 132,248,16
Maaa 132,252,20
Ra 232,12,2048
Zaaa 136,240,24
buffer_load_dwordx4 v3, s[8:11], s51 offen offset:3072 lds
Maaa 136,244,28
Ta 112,28,0
Ta 114,28,2048
Zaaa 140,248,24
Maaa 140,252,28
s_add_u32 m0, s56, 4096
s_waitcnt lgkmcnt(9)
Ra 236,13,2048
Zaaa 144,240,32
buffer_load_dwordx4 v4, s[8:11], s48 offen offset:0 lds
Maaa 144,244,36
Zaaa 148,248,32
Maaa 148,252,36
Ta 116,28,16384
Ta 118,28,18432
Zaaa 152,240,40
buffer_load_dwordx4 v5, s[8:11], s49 offen offset:1024 lds
Maaa 152,244,44
Ta 120,29,0
Ta 122,29,2048
Zaaa 156,248,40
Maaa 156,252,44
Ta 124,29,16384
s_waitcnt lgkmcnt(9)
Ta 126,29,18432
Zaaa 160,240,48
buffer_load_dwordx4 v4, s[8:11], s50 offen offset:2048 lds
Maaa 160,244,52
Zaaa 164,248,48
Maaa 164,252,52
Zaaa 168,240,56
buffer_load_dwordx4 v5, s[8:11], s51 offen offset:3072 lds
Maaa 168,244,60
v_xor_b32 v2, 128, v2
v_xor_b32 v3, 128, v3
Zaaa 172,248,56
s_waitcnt lgkmcnt(6)
buffer_load_dword v1, v47, s[60:63], 0 offen
v_xor_b32 v4, 128, v4
v_xor_b32 v5, 128, v5
Maaa 172,252,60
s_waitcnt lgkmcnt(0)
s_mul_i32 vcc_lo, s59, 7
v_xor_b32 v47, vcc_lo, v47
Mvaa 48,224,64
buffer_store_dwordx4 v[30:33], v46, s[20:23], s3 offen offset:0 sc1
Mvaa 48,228,68
buffer_store_dwordx4 v[34:37], v46, s[20:23], s3 offen offset:2048 sc1
Mvaa 52,232,64
buffer_store_dwordx4 v[38:41], v46, s[20:23], s39 offen offset:0 sc1
Mvaa 52,236,68
Ra 240,12,4096
Mvaa 56,224,72
buffer_store_dwordx4 v[42:45], v46, s[20:23], s39 offen offset:2048 sc1
Mvaa 56,228,76
s_lshl_b32 s3, s34, 1
s_and_b32 s36, s32, 1
s_add_u32 s3, s3, s36
Mvaa 60,232,72
s_mul_i32 s3, s3, 1116160
s_mul_i32 s36, s33, 139264
s_add_u32 s3, s3, s36
Mvaa 60,236,76
Ra 244,13,4096
Mvaa 64,224,80
s_lshr_b32 s36, s32, 1
s_mul_i32 s36, s36, 69632
s_add_u32 s3, s3, s36
Mvaa 64,228,84
s_add_u32 s38, s3, 17408
s_lshl_b32 s39, s34, 7
s_lshl_b32 s36, s33, 2
Mvaa 68,232,80
s_add_u32 s39, s39, s36
s_add_u32 s39, s39, 5296160
v_mov_b32 v30, 1
Mvaa 68,236,84
Ra 248,12,6144
Mvaa 72,224,88
v_mov_b32_e64 v31, 0
Mvaa 72,228,92
s_cmp_eq_u32 s32, 0
s_cselect_b32 s39, s39, 2146435072
Mvaa 76,232,88
s_mov_b64 exec, 1
buffer_store_dword v31, v31, s[20:23], s39 offen sc1
s_mov_b64 exec, -1
Mvaa 76,236,92
Ra 252,13,6144
Mvaa 80,224,96
s_and_b32 s33, s2, 7
s_lshl_b32 s33, s33, 2
s_bfe_u32 s3, s2, 0x20003
Mvaa 80,228,100
s_add_u32 s33, s33, s3
s_lshr_b32 s34, s2, 5
s_lshl_b32 s64, s34, 7
Mvaa 84,232,96
s_lshl_b32 s3, s33, 2
s_add_u32 s64, s64, s3
s_add_u32 s64, s64, 5300224
Mvaa 84,236,100
s_lshl_b32 s65, s34, 8
s_sub_u32 s65, 1920, s65
v_mul_u32_u24 v32, s65, v0
Mvaa 88,224,104
s_cmp_eq_u32 s32, 0
s_cselect_b32 s64, s64, 2146435072
Mvaa 88,228,108
s_mov_b64 exec, 3
buffer_store_dword v31, v32, s[20:23], s64 offen sc1
s_mov_b64 exec, -1
Mvaa 92,232,104
s_lshl_b32 s3, s2, 2
s_add_u32 s3, s3, 5447680
v_lshlrev_b32_e64 v32, 10, v0
Mvaa 92,236,108
s_cmp_eq_u32 s32, 0
s_cselect_b32 s3, s3, 2146435072
Mvaa 96,224,112
s_mov_b64 exec, 0x1ff
buffer_store_dword v31, v32, s[20:23], s3 offen sc1
s_mov_b64 exec, -1
Mvaa 96,228,116
s_lshl_b32 s35, s34, 1
s_sub_u32 s36, 32, s35
s_add_u32 s35, s35, 2
Mvaa 100,232,112
s_lshl_b32 s44, s32, 12
s_lshl_b32 s58, s32, 1
s_sub_u32 s58, 7, s58
Mvaa 100,236,116
s_mul_i32 s58, s58, 33792
s_sub_u32 s3, 15, s34
s_lshl_b32 s45, s3, 3
Mvaa 104,224,120
s_add_u32 s45, s45, s32
s_lshl_b32 s46, s34, 3
s_add_u32 s46, s46, s32
Mvaa 104,228,124
s_mov_b32 s68, s42
s_and_b32 s69, s43, 0xffff
s_mov_b32 s70, 7340032
Mvaa 108,232,120
s_waitcnt lgkmcnt(0)
Mvaa 108,236,124
s_mov_b32 s71, 0x20000
s_cmp_eq_u32 s32, 0
s_cselect_b32 s37, 0, 2146435072
Mvaa 112,240,64
s_lshl_b32 s3, s33, 8
s_add_u32 s16, s4, s3
s_addc_u32 s17, s5, 0
s_and_b32 s17, s17, 0xffff
Mvaa 112,244,68
s_mov_b32 s18, 0
s_mov_b32 s19, 0x20000
s_sub_u32 s18, 8388608, s3
Mvaa 116,248,64
v_and_b32 v33, 15, v0
v_lshrrev_b32 v32, 1, v33
Mvaa 116,252,68
Ra 224,12,8192
Mvaa 120,240,72
v_and_b32 v33, 1, v0
v_lshlrev_b32 v32, 13, v32
Mvaa 120,244,76
v_lshl_add_u32 v45, v33, 7, v32
Mvaa 124,248,72
s_lshl_b32 s3, s32, 3
s_add_u32 s3, s3, s34
s_mul_i32 s47, s3, 65536
Mvaa 124,252,76
Ra 228,13,8192
Mvaa 128,240,80
s_bfe_u32 s6, s2, 131075
s_lshl_b32 s3, s32, 8
s_or_b32 s6, s6, s3
Mvaa 128,244,84
Mvaa 132,248,80
Mvaa 132,252,84
Ra 232,12,10240
Mvaa 136,240,88
Mvaa 136,244,92
Mvaa 140,248,88
Mvaa 140,252,92
Ra 236,13,10240
Mvaa 144,240,96
Mvaa 144,244,100
Mvaa 148,248,96
Mvaa 148,252,100
Mvaa 152,240,104
Mvaa 152,244,108
Mvaa 156,248,104
Mvaa 156,252,108
Mvaa 160,240,112
Mvaa 160,244,116
Mvaa 164,248,112
Mvaa 164,252,116
Mvaa 168,240,120
Mvaa 168,244,124
s_waitcnt vmcnt(16)
Mvaa 172,248,120
s_waitcnt lgkmcnt(0)
s_barrier
Mvaa 172,252,124
s_add_u32 m0, s57, 65536
Mvaa 176,224,64
buffer_load_dwordx4 v6, s[12:15], s52 offen offset:0 lds
Mvaa 176,228,68
Ta 0,16,0
Ta 2,16,2048
Mvaa 180,232,64
Mvaa 180,236,68
Ra 240,12,12288
Mvaa 184,224,72
buffer_load_dwordx4 v7, s[12:15], s53 offen offset:1024 lds
Mvaa 184,228,76
Ta 4,16,16384
Ta 6,16,18432
Mvaa 188,232,72
Mvaa 188,236,76
Ra 244,13,12288
Mvaa 192,224,80
buffer_load_dwordx4 v6, s[12:15], s54 offen offset:2048 lds
Mvaa 192,228,84
Ta 8,17,0
Ta 10,17,2048
Mvaa 196,232,80
Mvaa 196,236,84
Ra 248,12,14336
Mvaa 200,224,88
buffer_load_dwordx4 v7, s[12:15], s55 offen offset:3072 lds
Mvaa 200,228,92
Ta 12,17,16384
Ta 14,17,18432
Mvaa 204,232,88
Mvaa 204,236,92
s_add_u32 m0, s57, 69632
Ra 252,13,14336
Mvaa 208,224,96
buffer_load_dwordx4 v8, s[12:15], s52 offen offset:0 lds
Mvaa 208,228,100
Mvaa 212,232,96
Mvaa 212,236,100
Ta 16,18,0
Ta 18,18,2048
Mvaa 216,224,104
buffer_load_dwordx4 v9, s[12:15], s53 offen offset:1024 lds
Mvaa 216,228,108
Ta 20,18,16384
s_waitcnt lgkmcnt(9)
Ta 22,18,18432
Mvaa 220,232,104
Mvaa 220,236,108
Ta 24,19,0
Ta 26,19,2048
Mvaa 224,224,112
buffer_load_dwordx4 v8, s[12:15], s54 offen offset:2048 lds
Mvaa 224,228,116
Mvaa 228,232,112
Mvaa 228,236,116
Ta 28,19,16384
Ta 30,19,18432
Mvaa 232,224,120
buffer_load_dwordx4 v9, s[12:15], s55 offen offset:3072 lds
Mvaa 232,228,124
s_waitcnt vmcnt(16)
Ta 32,20,0
s_waitcnt lgkmcnt(9)
Ta 34,20,2048
Mvaa 236,232,120
s_barrier
v_xor_b32 v6, 3670016, v6
v_xor_b32 v7, 3670016, v7
Mvaa 236,236,124
s_add_u32 m0, s56, 65536
Ta 36,20,16384
Ta 38,20,18432
Mvaa 240,240,64
buffer_load_dwordx4 v2, s[8:11], s48 offen offset:0 lds
Mvaa 240,244,68
v_xor_b32 v8, 3670016, v8
v_xor_b32 v9, 3670016, v9
Mvaa 244,248,64
Mvaa 244,252,68
Ra 224,10,0
Mvaa 248,240,72
buffer_load_dwordx4 v3, s[8:11], s49 offen offset:1024 lds
Mvaa 248,244,76
Ta 40,21,0
Ta 42,21,2048
Mvaa 252,248,72
Mvaa 252,252,76
s_waitcnt lgkmcnt(9)
Ra 228,11,0
Maaa 128,240,80
buffer_load_dwordx4 v2, s[8:11], s50 offen offset:2048 lds
Maaa 128,244,84
Ta 44,21,16384
Ta 46,21,18432
Maaa 132,248,80
Maaa 132,252,84
Ra 232,10,2048
Maaa 136,240,88
buffer_load_dwordx4 v3, s[8:11], s51 offen offset:3072 lds
Maaa 136,244,92
Ta 48,22,0
Ta 50,22,2048
Maaa 140,248,88
Maaa 140,252,92
s_add_u32 m0, s56, 69632
s_waitcnt lgkmcnt(9)
Ra 236,11,2048
Maaa 144,240,96
buffer_load_dwordx4 v4, s[8:11], s48 offen offset:0 lds
Maaa 144,244,100
Maaa 148,248,96
Maaa 148,252,100
Ta 52,22,16384
Ta 54,22,18432
Maaa 152,240,104
buffer_load_dwordx4 v5, s[8:11], s49 offen offset:1024 lds
Maaa 152,244,108
Ta 56,23,0
Ta 58,23,2048
Maaa 156,248,104
Maaa 156,252,108
Ta 60,23,16384
s_waitcnt lgkmcnt(9)
Ta 62,23,18432
Maaa 160,240,112
buffer_load_dwordx4 v4, s[8:11], s50 offen offset:2048 lds
Maaa 160,244,116
Maaa 164,248,112
Maaa 164,252,116
Maaa 168,240,120
buffer_load_dwordx4 v5, s[8:11], s51 offen offset:3072 lds
Maaa 168,244,124
v_xor_b32 v2, 896, v2
v_xor_b32 v3, 896, v3
Maaa 172,248,120
s_waitcnt lgkmcnt(6)
buffer_load_dword v1, v47, s[60:63], 0 offen
v_xor_b32 v4, 896, v4
v_xor_b32 v5, 896, v5
Maaa 172,252,124
s_waitcnt lgkmcnt(0)
s_mul_i32 vcc_lo, s59, 1
v_xor_b32 v47, vcc_lo, v47
Mvaa 48,224,0
Mvaa 48,228,4
Mvaa 52,232,0
Mvaa 52,236,4
Ra 240,10,4096
Mvaa 56,224,8
Mvaa 56,228,12
Mvaa 60,232,8
Mvaa 60,236,12
Ra 244,11,4096
Mvaa 64,224,16
Mvaa 64,228,20
Mvaa 68,232,16
Mvaa 68,236,20
Ra 248,10,6144
Mvaa 72,224,24
Mvaa 72,228,28
Mvaa 76,232,24
Mvaa 76,236,28
Ra 252,11,6144
Mvaa 80,224,32
Mvaa 80,228,36
Mvaa 84,232,32
Mvaa 84,236,36
Mvaa 88,224,40
Mvaa 88,228,44
Mvaa 92,232,40
Mvaa 92,236,44
Mvaa 96,224,48
Mvaa 96,228,52
Mvaa 100,232,48
Mvaa 100,236,52
Mvaa 104,224,56
Mvaa 104,228,60
Mvaa 108,232,56
s_waitcnt lgkmcnt(0)
Mvaa 108,236,60
Mvaa 112,240,0
Mvaa 112,244,4
Mvaa 116,248,0
Mvaa 116,252,4
Ra 224,10,8192
Mvaa 120,240,8
Mvaa 120,244,12
Mvaa 124,248,8
Mvaa 124,252,12
Ra 228,11,8192
Mvaa 128,240,16
Mvaa 128,244,20
Mvaa 132,248,16
Mvaa 132,252,20
Ra 232,10,10240
Mvaa 136,240,24
Mvaa 136,244,28
Mvaa 140,248,24
Mvaa 140,252,28
Ra 236,11,10240
Mvaa 144,240,32
Mvaa 144,244,36
Mvaa 148,248,32
Mvaa 148,252,36
Mvaa 152,240,40
Mvaa 152,244,44
Mvaa 156,248,40
Mvaa 156,252,44
Mvaa 160,240,48
Mvaa 160,244,52
Mvaa 164,248,48
Mvaa 164,252,52
Mvaa 168,240,56
Mvaa 168,244,60
s_waitcnt vmcnt(9)
Mvaa 172,248,56
s_waitcnt lgkmcnt(0)
s_barrier
Mvaa 172,252,60
s_add_u32 m0, s57, 0
Mvaa 176,224,0
buffer_load_dwordx4 v6, s[12:15], s52 offen offset:0 lds
Mvaa 176,228,4
Ta 64,14,0
Ta 66,14,2048
Mvaa 180,232,0
Mvaa 180,236,4
Ra 240,10,12288
Mvaa 184,224,8
buffer_load_dwordx4 v7, s[12:15], s53 offen offset:1024 lds
Mvaa 184,228,12
Ta 68,14,16384
Ta 70,14,18432
Mvaa 188,232,8
Mvaa 188,236,12
Ra 244,11,12288
Mvaa 192,224,16
buffer_load_dwordx4 v6, s[12:15], s54 offen offset:2048 lds
Mvaa 192,228,20
Ta 72,15,0
Ta 74,15,2048
Mvaa 196,232,16
Mvaa 196,236,20
Ra 248,10,14336
Mvaa 200,224,24
buffer_load_dwordx4 v7, s[12:15], s55 offen offset:3072 lds
Mvaa 200,228,28
Ta 76,15,16384
Ta 78,15,18432
Mvaa 204,232,24
s_cmp_eq_u32 s6, 0
s_cselect_b32 s3, 0, 2146435072
Mvaa 204,236,28
s_add_u32 m0, s57, 4096
Ra 252,11,14336
Mvaa 208,224,32
buffer_load_dwordx4 v8, s[12:15], s52 offen offset:0 lds
Mvaa 208,228,36
s_mov_b64 exec, 1
buffer_atomic_add v30, v31, s[28:31], s3 offen sc1
s_mov_b64 exec, -1
Mvaa 212,232,32
Mvaa 212,236,36
Ta 80,24,0
Ta 82,24,2048
Mvaa 216,224,40
buffer_load_dwordx4 v9, s[12:15], s53 offen offset:1024 lds
Mvaa 216,228,44
Ta 84,24,16384
s_waitcnt lgkmcnt(9)
Ta 86,24,18432
Mvaa 220,232,40
Mvaa 220,236,44
Ta 88,25,0
Ta 90,25,2048
Mvaa 224,224,48
buffer_load_dwordx4 v8, s[12:15], s54 offen offset:2048 lds
Mvaa 224,228,52
Mvaa 228,232,48
Mvaa 228,236,52
Ta 92,25,16384
Ta 94,25,18432
Mvaa 232,224,56
buffer_load_dwordx4 v9, s[12:15], s55 offen offset:3072 lds
Mvaa 232,228,60
s_waitcnt vmcnt(10)
Ta 96,26,0
s_waitcnt lgkmcnt(9)
Ta 98,26,2048
Mvaa 236,232,56
s_barrier
v_xor_b32 v6, 524288, v6
v_xor_b32 v7, 524288, v7
Mvaa 236,236,60
s_add_u32 m0, s56, 0
Ta 100,26,16384
Ta 102,26,18432
Mvaa 240,240,0
buffer_load_dwordx4 v2, s[8:11], s48 offen offset:0 lds
Mvaa 240,244,4
v_xor_b32 v8, 524288, v8
v_xor_b32 v9, 524288, v9
Mvaa 244,248,0
Mvaa 244,252,4
Ra 224,12,0
Mvaa 248,240,8
buffer_load_dwordx4 v3, s[8:11], s49 offen offset:1024 lds
Mvaa 248,244,12
Ta 104,27,0
Ta 106,27,2048
Mvaa 252,248,8
Mvaa 252,252,12
s_waitcnt lgkmcnt(9)
Ra 228,13,0
Maaa 128,240,16
buffer_load_dwordx4 v2, s[8:11], s50 offen offset:2048 lds
Maaa 128,244,20
Ta 108,27,16384
Ta 110,27,18432
Maaa 132,248,16
Maaa 132,252,20
Ra 232,12,2048
Maaa 136,240,24
buffer_load_dwordx4 v3, s[8:11], s51 offen offset:3072 lds
Maaa 136,244,28
Ta 112,28,0
Ta 114,28,2048
Maaa 140,248,24
Maaa 140,252,28
s_add_u32 m0, s56, 4096
s_waitcnt lgkmcnt(9)
Ra 236,13,2048
Maaa 144,240,32
buffer_load_dwordx4 v4, s[8:11], s48 offen offset:0 lds
Maaa 144,244,36
Maaa 148,248,32
Maaa 148,252,36
Ta 116,28,16384
Ta 118,28,18432
Maaa 152,240,40
buffer_load_dwordx4 v5, s[8:11], s49 offen offset:1024 lds
Maaa 152,244,44
Ta 120,29,0
Ta 122,29,2048
Maaa 156,248,40
Maaa 156,252,44
Ta 124,29,16384
s_waitcnt lgkmcnt(9)
Ta 126,29,18432
Maaa 160,240,48
buffer_load_dwordx4 v4, s[8:11], s50 offen offset:2048 lds
Maaa 160,244,52
Maaa 164,248,48
Maaa 164,252,52
Maaa 168,240,56
buffer_load_dwordx4 v5, s[8:11], s51 offen offset:3072 lds
Maaa 168,244,60
v_xor_b32 v2, 128, v2
v_xor_b32 v3, 128, v3
Maaa 172,248,56
s_waitcnt lgkmcnt(6)
buffer_load_dword v1, v47, s[60:63], 0 offen
v_xor_b32 v4, 128, v4
v_xor_b32 v5, 128, v5
Maaa 172,252,60
s_waitcnt lgkmcnt(0)
s_mul_i32 vcc_lo, s59, 3
v_xor_b32 v47, vcc_lo, v47
Mvaa 48,224,64
buffer_load_dword v44, v45, s[16:19], s47 offen
Mvaa 48,228,68
s_add_u32 s47, s47, 2097152
Mvaa 52,232,64
Mvaa 52,236,68
Ra 240,12,4096
Mvaa 56,224,72
Mvaa 56,228,76
Mvaa 60,232,72
Mvaa 60,236,76
Ra 244,13,4096
Mvaa 64,224,80
Mvaa 64,228,84
Mvaa 68,232,80
Mvaa 68,236,84
Ra 248,12,6144
Mvaa 72,224,88
Mvaa 72,228,92
Mvaa 76,232,88
Mvaa 76,236,92
Ra 252,13,6144
Mvaa 80,224,96
Mvaa 80,228,100
Mvaa 84,232,96
Mvaa 84,236,100
Mvaa 88,224,104
Mvaa 88,228,108
Mvaa 92,232,104
Mvaa 92,236,108
Mvaa 96,224,112
Mvaa 96,228,116
Mvaa 100,232,112
s_cmp_eq_u32 s6, 1
s_cselect_b32 s3, 0, 2146435072
Mvaa 100,236,116
s_mov_b64 exec, 1
buffer_atomic_add v30, v31, s[28:31], s3 offen sc1
s_mov_b64 exec, -1
Mvaa 104,224,120
Mvaa 104,228,124
Mvaa 108,232,120
s_waitcnt lgkmcnt(0)
Mvaa 108,236,124
Mvaa 112,240,64
Mvaa 112,244,68
Mvaa 116,248,64
Mvaa 116,252,68
Ra 224,12,8192
Mvaa 120,240,72
Mvaa 120,244,76
Mvaa 124,248,72
Mvaa 124,252,76
Ra 228,13,8192
Mvaa 128,240,80
Mvaa 128,244,84
Mvaa 132,248,80
Mvaa 132,252,84
Ra 232,12,10240
Mvaa 136,240,88
Mvaa 136,244,92
Mvaa 140,248,88
Mvaa 140,252,92
Ra 236,13,10240
Mvaa 144,240,96
Mvaa 144,244,100
Mvaa 148,248,96
Mvaa 148,252,100
Mvaa 152,240,104
Mvaa 152,244,108
Mvaa 156,248,104
Mvaa 156,252,108
Mvaa 160,240,112
Mvaa 160,244,116
Mvaa 164,248,112
Mvaa 164,252,116
Mvaa 168,240,120
Mvaa 168,244,124
s_waitcnt vmcnt(11)
Mvaa 172,248,120
s_waitcnt lgkmcnt(0)
s_barrier
Mvaa 172,252,124
s_add_u32 m0, s57, 65536
Mvaa 176,224,64
buffer_load_dwordx4 v6, s[12:15], s52 offen offset:0 lds
Mvaa 176,228,68
Ta 0,16,0
Ta 2,16,2048
Mvaa 180,232,64
Mvaa 180,236,68
Ra 240,12,12288
Mvaa 184,224,72
buffer_load_dwordx4 v7, s[12:15], s53 offen offset:1024 lds
Mvaa 184,228,76
Ta 4,16,16384
Ta 6,16,18432
Mvaa 188,232,72
Mvaa 188,236,76
Ra 244,13,12288
Mvaa 192,224,80
buffer_load_dwordx4 v6, s[12:15], s54 offen offset:2048 lds
Mvaa 192,228,84
Ta 8,17,0
Ta 10,17,2048
Mvaa 196,232,80
Mvaa 196,236,84
Ra 248,12,14336
Mvaa 200,224,88
buffer_load_dwordx4 v7, s[12:15], s55 offen offset:3072 lds
Mvaa 200,228,92
Ta 12,17,16384
Ta 14,17,18432
Mvaa 204,232,88
Mvaa 204,236,92
s_add_u32 m0, s57, 69632
Ra 252,13,14336
Mvaa 208,224,96
buffer_load_dwordx4 v8, s[12:15], s52 offen offset:0 lds
Mvaa 208,228,100
Mvaa 212,232,96
Mvaa 212,236,100
Ta 16,18,0
Ta 18,18,2048
Mvaa 216,224,104
buffer_load_dwordx4 v9, s[12:15], s53 offen offset:1024 lds
Mvaa 216,228,108
Ta 20,18,16384
s_waitcnt lgkmcnt(9)
Ta 22,18,18432
Mvaa 220,232,104
Mvaa 220,236,108
Ta 24,19,0
Ta 26,19,2048
Mvaa 224,224,112
buffer_load_dwordx4 v8, s[12:15], s54 offen offset:2048 lds
Mvaa 224,228,116
Mvaa 228,232,112
Mvaa 228,236,116
Ta 28,19,16384
Ta 30,19,18432
Mvaa 232,224,120
buffer_load_dwordx4 v9, s[12:15], s55 offen offset:3072 lds
Mvaa 232,228,124
s_waitcnt vmcnt(11)
Ta 32,20,0
s_waitcnt lgkmcnt(9)
Ta 34,20,2048
Mvaa 236,232,120
s_barrier
v_xor_b32 v6, 1572864, v6
v_xor_b32 v7, 1572864, v7
Mvaa 236,236,124
s_add_u32 m0, s56, 65536
Ta 36,20,16384
Ta 38,20,18432
Mvaa 240,240,64
buffer_load_dwordx4 v2, s[8:11], s48 offen offset:0 lds
Mvaa 240,244,68
v_xor_b32 v8, 1572864, v8
v_xor_b32 v9, 1572864, v9
Mvaa 244,248,64
Mvaa 244,252,68
Ra 224,10,0
Mvaa 248,240,72
buffer_load_dwordx4 v3, s[8:11], s49 offen offset:1024 lds
Mvaa 248,244,76
Ta 40,21,0
Ta 42,21,2048
Mvaa 252,248,72
Mvaa 252,252,76
s_waitcnt lgkmcnt(9)
Ra 228,11,0
Maaa 128,240,80
buffer_load_dwordx4 v2, s[8:11], s50 offen offset:2048 lds
Maaa 128,244,84
Ta 44,21,16384
Ta 46,21,18432
Maaa 132,248,80
s_cmp_eq_u32 s6, 2
s_cselect_b32 s3, 0, 2146435072
Maaa 132,252,84
Ra 232,10,2048
Maaa 136,240,88
buffer_load_dwordx4 v3, s[8:11], s51 offen offset:3072 lds
Maaa 136,244,92
Ta 48,22,0
Ta 50,22,2048
Maaa 140,248,88
s_mov_b64 exec, 1
buffer_atomic_add v30, v31, s[28:31], s3 offen sc1
s_mov_b64 exec, -1
Maaa 140,252,92
s_add_u32 m0, s56, 69632
s_waitcnt lgkmcnt(9)
Ra 236,11,2048
Maaa 144,240,96
buffer_load_dwordx4 v4, s[8:11], s48 offen offset:0 lds
Maaa 144,244,100
Maaa 148,248,96
Maaa 148,252,100
Ta 52,22,16384
Ta 54,22,18432
Maaa 152,240,104
buffer_load_dwordx4 v5, s[8:11], s49 offen offset:1024 lds
Maaa 152,244,108
Ta 56,23,0
Ta 58,23,2048
Maaa 156,248,104
Maaa 156,252,108
Ta 60,23,16384
s_waitcnt lgkmcnt(9)
Ta 62,23,18432
Maaa 160,240,112
buffer_load_dwordx4 v4, s[8:11], s50 offen offset:2048 lds
Maaa 160,244,116
Maaa 164,248,112
Maaa 164,252,116
Maaa 168,240,120
buffer_load_dwordx4 v5, s[8:11], s51 offen offset:3072 lds
Maaa 168,244,124
v_xor_b32 v2, 384, v2
v_xor_b32 v3, 384, v3
Maaa 172,248,120
s_waitcnt lgkmcnt(6)
buffer_load_dword v1, v47, s[60:63], 0 offen
v_xor_b32 v4, 384, v4
v_xor_b32 v5, 384, v5
Maaa 172,252,124
s_waitcnt lgkmcnt(0)
s_mul_i32 vcc_lo, s59, 1
v_xor_b32_e64 v47, vcc_lo, v47
Mvaa 48,224,0
buffer_load_dword v44, v45, s[16:19], s47 offen
Mvaa 48,228,4
s_add_u32 s47, s47, 2097152
Mvaa 52,232,0
Mvaa 52,236,4
Ra 240,10,4096
Mvaa 56,224,8
Mvaa 56,228,12
Mvaa 60,232,8
Mvaa 60,236,12
Ra 244,11,4096
Mvaa 64,224,16
Mvaa 64,228,20
Mvaa 68,232,16
Mvaa 68,236,20
Ra 248,10,6144
Mvaa 72,224,24
Mvaa 72,228,28
Mvaa 76,232,24
Mvaa 76,236,28
Ra 252,11,6144
Mvaa 80,224,32
Mvaa 80,228,36
Mvaa 84,232,32
Mvaa 84,236,36
Mvaa 88,224,40
Mvaa 88,228,44
Mvaa 92,232,40
Mvaa 92,236,44
Mvaa 96,224,48
Mvaa 96,228,52
Mvaa 100,232,48
Mvaa 100,236,52
Mvaa 104,224,56
Mvaa 104,228,60
Mvaa 108,232,56
s_waitcnt lgkmcnt(0)
Mvaa 108,236,60
Mvaa 112,240,0
Mvaa 112,244,4
Mvaa 116,248,0
Mvaa 116,252,4
Ra 224,10,8192
Mvaa 120,240,8
Mvaa 120,244,12
Mvaa 124,248,8
Mvaa 124,252,12
Ra 228,11,8192
Mvaa 128,240,16
Mvaa 128,244,20
Mvaa 132,248,16
Mvaa 132,252,20
Ra 232,10,10240
Mvaa 136,240,24
Mvaa 136,244,28
Mvaa 140,248,24
Mvaa 140,252,28
Ra 236,11,10240
Mvaa 144,240,32
Mvaa 144,244,36
Mvaa 148,248,32
Mvaa 148,252,36
Mvaa 152,240,40
s_cmp_eq_u32 s6, 3
s_cselect_b32 s3, 0, 2146435072
Mvaa 152,244,44
s_mov_b64 exec, 1
buffer_atomic_add v30, v31, s[28:31], s3 offen sc1
s_mov_b64 exec, -1
Mvaa 156,248,40
Mvaa 156,252,44
Mvaa 160,240,48
Mvaa 160,244,52
Mvaa 164,248,48
Mvaa 164,252,52
Mvaa 168,240,56
Mvaa 168,244,60
s_waitcnt vmcnt(12)
Mvaa 172,248,56
s_waitcnt lgkmcnt(0)
s_barrier
Mvaa 172,252,60
s_add_u32 m0, s57, 0
Mvaa 176,224,0
buffer_load_dwordx4 v6, s[12:15], s52 offen offset:0 lds
Mvaa 176,228,4
Ta 64,14,0
Ta 66,14,2048
Mvaa 180,232,0
Mvaa 180,236,4
Ra 240,10,12288
Mvaa 184,224,8
buffer_load_dwordx4 v7, s[12:15], s53 offen offset:1024 lds
Mvaa 184,228,12
Ta 68,14,16384
Ta 70,14,18432
Mvaa 188,232,8
Mvaa 188,236,12
Ra 244,11,12288
Mvaa 192,224,16
buffer_load_dwordx4 v6, s[12:15], s54 offen offset:2048 lds
Mvaa 192,228,20
Ta 72,15,0
Ta 74,15,2048
Mvaa 196,232,16
Mvaa 196,236,20
Ra 248,10,14336
Mvaa 200,224,24
buffer_load_dwordx4 v7, s[12:15], s55 offen offset:3072 lds
Mvaa 200,228,28
Ta 76,15,16384
Ta 78,15,18432
Mvaa 204,232,24
Mvaa 204,236,28
s_add_u32 m0, s57, 4096
Ra 252,11,14336
Mvaa 208,224,32
buffer_load_dwordx4 v8, s[12:15], s52 offen offset:0 lds
Mvaa 208,228,36
Mvaa 212,232,32
Mvaa 212,236,36
Ta 80,24,0
Ta 82,24,2048
Mvaa 216,224,40
buffer_load_dwordx4 v9, s[12:15], s53 offen offset:1024 lds
Mvaa 216,228,44
Ta 84,24,16384
s_waitcnt lgkmcnt(9)
Ta 86,24,18432
Mvaa 220,232,40
Mvaa 220,236,44
Ta 88,25,0
Ta 90,25,2048
Mvaa 224,224,48
buffer_load_dwordx4 v8, s[12:15], s54 offen offset:2048 lds
Mvaa 224,228,52
Mvaa 228,232,48
Mvaa 228,236,52
Ta 92,25,16384
Ta 94,25,18432
Mvaa 232,224,56
buffer_load_dwordx4 v9, s[12:15], s55 offen offset:3072 lds
Mvaa 232,228,60
s_waitcnt vmcnt(11)
Ta 96,26,0
s_waitcnt lgkmcnt(9)
Ta 98,26,2048
Mvaa 236,232,56
s_barrier
v_xor_b32 v6, 524288, v6
v_xor_b32 v7, 524288, v7
Mvaa 236,236,60
s_add_u32 m0, s56, 0
Ta 100,26,16384
Ta 102,26,18432
Mvaa 240,240,0
buffer_load_dwordx4 v2, s[8:11], s48 offen offset:0 lds
Mvaa 240,244,4
v_xor_b32 v8, 524288, v8
v_xor_b32 v9, 524288, v9
Mvaa 244,248,0
Mvaa 244,252,4
Ra 224,12,0
Mvaa 248,240,8
buffer_load_dwordx4 v3, s[8:11], s49 offen offset:1024 lds
Mvaa 248,244,12
Ta 104,27,0
Ta 106,27,2048
Mvaa 252,248,8
Mvaa 252,252,12
s_waitcnt lgkmcnt(9)
Ra 228,13,0
Maaa 128,240,16
buffer_load_dwordx4 v2, s[8:11], s50 offen offset:2048 lds
Maaa 128,244,20
Ta 108,27,16384
Ta 110,27,18432
Maaa 132,248,16
Maaa 132,252,20
Ra 232,12,2048
Maaa 136,240,24
buffer_load_dwordx4 v3, s[8:11], s51 offen offset:3072 lds
Maaa 136,244,28
Ta 112,28,0
Ta 114,28,2048
Maaa 140,248,24
Maaa 140,252,28
s_add_u32 m0, s56, 4096
s_waitcnt lgkmcnt(9)
Ra 236,13,2048
Maaa 144,240,32
buffer_load_dwordx4 v4, s[8:11], s48 offen offset:0 lds
Maaa 144,244,36
Maaa 148,248,32
Maaa 148,252,36
Ta 116,28,16384
Ta 118,28,18432
Maaa 152,240,40
buffer_load_dwordx4 v5, s[8:11], s49 offen offset:1024 lds
Maaa 152,244,44
Ta 120,29,0
Ta 122,29,2048
Maaa 156,248,40
Maaa 156,252,44
Ta 124,29,16384
s_waitcnt lgkmcnt(9)
Ta 126,29,18432
Maaa 160,240,48
buffer_load_dwordx4 v4, s[8:11], s50 offen offset:2048 lds
Maaa 160,244,52
Maaa 164,248,48
Maaa 164,252,52
Maaa 168,240,56
buffer_load_dwordx4 v5, s[8:11], s51 offen offset:3072 lds
Maaa 168,244,60
v_xor_b32 v2, 128, v2
v_xor_b32 v3, 128, v3
Maaa 172,248,56
s_waitcnt lgkmcnt(6)
buffer_load_dword v1, v47, s[60:63], 0 offen
v_xor_b32 v4, 128, v4
v_xor_b32 v5, 128, v5
Maaa 172,252,60
s_waitcnt lgkmcnt(0)
s_mul_i32 vcc_lo, s59, 7
v_xor_b32 v47, vcc_lo, v47
Mvaa 48,224,64
buffer_load_dword v44, v45, s[16:19], s47 offen
Mvaa 48,228,68
s_add_u32 s47, s47, 2097152
v_lshrrev_b32 v32, 4, v0
v_and_b32 v33, 15, v0
Mvaa 52,232,64
s_lshl_b32 s3, s32, 4
v_add_u32 v34, s3, v32
v_lshlrev_b32_e64 v36, 1, v32
Mvaa 52,236,68
Ra 240,12,4096
Mvaa 56,224,72
v_xor_b32 v36, v36, v33
v_xor_b32 v37, 8, v36
Mvaa 56,228,76
Mvaa 60,232,72
Mvaa 60,236,76
Ra 244,13,4096
Mvaa 64,224,80
s_getpc_b64 s[6:7]
L_cpf3:
s_add_u32 s6, s6, (L_phase2-L_cpf3)&0xffffffff
s_addc_u32 s7, s7, ((L_phase2-L_cpf3)>>32)&0xffffffff
Mvaa 64,228,84
s_lshr_b32 s3, s2, 3
s_lshl_b32 s3, s3, 2
s_add_u32 s3, s3, s32
Mvaa 68,232,80
s_lshl_b32 s3, s3, 10
v_and_b32 v42, 7, v0
v_lshlrev_b32_e64 v42, 7, v42
Mvaa 68,236,84
Ra 248,12,6144
Mvaa 72,224,88
v_add_u32_e64 v42, s3, v42
v_min_u32 v42, L_k2_fin-L_phase2-4, v42
Mvaa 72,228,92
v_mov_b32_e64 v41, s7
Mvaa 76,232,88
v_add_co_u32 v40, vcc, s6, v42
s_nop 1
v_addc_co_u32 v41, vcc, 0, v41, vcc
Mvaa 76,236,92
Ra 252,13,6144
Mvaa 80,224,96
global_load_dword v38, v[40:41], off
Mvaa 80,228,100
Mvaa 84,232,96
Mvaa 84,236,100
Mvaa 88,224,104
Mvaa 88,228,108
Mvaa 92,232,104
Mvaa 92,236,108
Mvaa 96,224,112
Mvaa 96,228,116
Mvaa 100,232,112
Mvaa 100,236,116
Mvaa 104,224,120
Mvaa 104,228,124
Mvaa 108,232,120
s_waitcnt lgkmcnt(0)
Mvaa 108,236,124
Mvaa 112,240,64
Mvaa 112,244,68
Mvaa 116,248,64
Mvaa 116,252,68
Ra 224,12,8192
Mvaa 120,240,72
Mvaa 120,244,76
Mvaa 124,248,72
Mvaa 124,252,76
Ra 228,13,8192
Mvaa 128,240,80
Mvaa 128,244,84
Mvaa 132,248,80
Mvaa 132,252,84
Ra 232,12,10240
Mvaa 136,240,88
Mvaa 136,244,92
Mvaa 140,248,88
Mvaa 140,252,92
Ra 236,13,10240
Mvaa 144,240,96
Mvaa 144,244,100
Mvaa 148,248,96
Mvaa 148,252,100
Mvaa 152,240,104
Mvaa 152,244,108
Mvaa 156,248,104
Mvaa 156,252,108
Mvaa 160,240,112
Mvaa 160,244,116
Mvaa 164,248,112
Mvaa 164,252,116
Mvaa 168,240,120
Mvaa 168,244,124
s_waitcnt vmcnt(11)
Mvaa 172,248,120
s_waitcnt lgkmcnt(0)
s_barrier
Mvaa 172,252,124
s_add_u32 m0, s57, 65536
Mvaa 176,224,64
buffer_load_dwordx4 v6, s[12:15], s52 offen offset:0 lds
Mvaa 176,228,68
Ta 0,16,0
Ta 2,16,2048
Mvaa 180,232,64
Mvaa 180,236,68
Ra 240,12,12288
Mvaa 184,224,72
buffer_load_dwordx4 v7, s[12:15], s53 offen offset:1024 lds
Mvaa 184,228,76
Ta 4,16,16384
Ta 6,16,18432
Mvaa 188,232,72
Mvaa 188,236,76
Ra 244,13,12288
Mvaa 192,224,80
buffer_load_dwordx4 v6, s[12:15], s54 offen offset:2048 lds
Mvaa 192,228,84
Ta 8,17,0
Ta 10,17,2048
Mvaa 196,232,80
Mvaa 196,236,84
Ra 248,12,14336
Mvaa 200,224,88
buffer_load_dwordx4 v7, s[12:15], s55 offen offset:3072 lds
Mvaa 200,228,92
Ta 12,17,16384
Ta 14,17,18432
Mvaa 204,232,88
Mvaa 204,236,92
s_add_u32 m0, s57, 69632
Ra 252,13,14336
Mvaa 208,224,96
buffer_load_dwordx4 v8, s[12:15], s52 offen offset:0 lds
Mvaa 208,228,100
Mvaa 212,232,96
Mvaa 212,236,100
Ta 16,18,0
Ta 18,18,2048
Mvaa 216,224,104
buffer_load_dwordx4 v9, s[12:15], s53 offen offset:1024 lds
Mvaa 216,228,108
Ta 20,18,16384
s_waitcnt lgkmcnt(9)
Ta 22,18,18432
Mvaa 220,232,104
Mvaa 220,236,108
Ta 24,19,0
Ta 26,19,2048
Mvaa 224,224,112
buffer_load_dwordx4 v8, s[12:15], s54 offen offset:2048 lds
Mvaa 224,228,116
Mvaa 228,232,112
Mvaa 228,236,116
Ta 28,19,16384
Ta 30,19,18432
Mvaa 232,224,120
buffer_load_dwordx4 v9, s[12:15], s55 offen offset:3072 lds
Mvaa 232,228,124
s_waitcnt vmcnt(11)
Ta 32,20,0
s_waitcnt lgkmcnt(9)
Ta 34,20,2048
Mvaa 236,232,120
s_barrier
Mvaa 236,236,124
s_add_u32 m0, s56, 65536
Ta 36,20,16384
Ta 38,20,18432
Mvaa 240,240,64
buffer_load_dwordx4 v2, s[8:11], s48 offen offset:0 lds
Mvaa 240,244,68
Mvaa 244,248,64
Mvaa 244,252,68
Ra 224,10,0
Mvaa 248,240,72
buffer_load_dwordx4 v3, s[8:11], s49 offen offset:1024 lds
Mvaa 248,244,76
Ta 40,21,0
Ta 42,21,2048
Mvaa 252,248,72
Mvaa 252,252,76
s_waitcnt lgkmcnt(9)
Ra 228,11,0
Maaa 128,240,80
buffer_load_dwordx4 v2, s[8:11], s50 offen offset:2048 lds
Maaa 128,244,84
Ta 44,21,16384
Ta 46,21,18432
Maaa 132,248,80
Maaa 132,252,84
Ra 232,10,2048
Maaa 136,240,88
buffer_load_dwordx4 v3, s[8:11], s51 offen offset:3072 lds
Maaa 136,244,92
Ta 48,22,0
Ta 50,22,2048
Maaa 140,248,88
Maaa 140,252,92
s_add_u32 m0, s56, 69632
s_waitcnt lgkmcnt(9)
Ra 236,11,2048
Maaa 144,240,96
buffer_load_dwordx4 v4, s[8:11], s48 offen offset:0 lds
Maaa 144,244,100
Maaa 148,248,96
Maaa 148,252,100
Ta 52,22,16384
Ta 54,22,18432
Maaa 152,240,104
buffer_load_dwordx4 v5, s[8:11], s49 offen offset:1024 lds
Maaa 152,244,108
Ta 56,23,0
Ta 58,23,2048
Maaa 156,248,104
Maaa 156,252,108
Ta 60,23,16384
s_waitcnt lgkmcnt(9)
Ta 62,23,18432
Maaa 160,240,112
buffer_load_dwordx4 v4, s[8:11], s50 offen offset:2048 lds
Maaa 160,244,116
Maaa 164,248,112
Maaa 164,252,116
Maaa 168,240,120
buffer_load_dwordx4 v5, s[8:11], s51 offen offset:3072 lds
Maaa 168,244,124
Maaa 172,248,120
s_waitcnt lgkmcnt(6)
Maaa 172,252,124
s_waitcnt lgkmcnt(0)
Mvaa 48,224,0
buffer_load_dword v1, v31, s[28:31], s37 offen sc1
Mvaa 48,228,4
s_mov_b32 s8, s16
s_mov_b32 s9, s17
s_mov_b32 s10, s18
Mvaa 52,232,0
s_add_u32 s16, s66, 46137344
s_addc_u32 s17, s67, 0
s_and_b32 s17, s17, 0xffff
Mvaa 52,236,4
Ra 240,10,4096
Mvaa 56,224,8
s_mov_b32 s18, 16777216
s_mov_b32 s19, 0x20000
s_mov_b32 s48, 0
Mvaa 56,228,12
s_mov_b32 s49, 31744
s_mov_b32 s50, 63488
s_mov_b32 s51, 95232
Mvaa 60,232,8
v_lshlrev_b32 v35, 13, v34
Mvaa 60,236,12
Ra 244,11,4096
Mvaa 64,224,16
s_and_b32 s52, s33, 0
s_lshl_b32 s3, s52, 19
s_lshl_b32 s52, s52, 11
Mvaa 64,228,20
s_add_u32 s53, s52, s58
v_add_u32_e64 v35, s3, v35
v_lshl_add_u32 v8, v36, 4, v35
Mvaa 68,232,16
v_lshl_add_u32 v9, v37, 4, v35
v_lshlrev_b32_e64 v2, 4, v0
Mvaa 68,236,20
Ra 248,10,6144
Mvaa 72,224,24
v_add_u32 v3, 65536, v2
v_add_u32_e64 v4, s44, v2
Mvaa 72,228,28
v_mov_b32 v7, 0
v_lshlrev_b32 v35, 2, v32
Mvaa 76,232,24
v_sub_u32_e64 v35, v33, v35
Mvaa 76,236,28
Ra 252,11,6144
Mvaa 80,224,32
s_lshl_b32 s3, s32, 4
v_add_u32 v5, s3, v35
Mvaa 80,228,36
s_sub_u32 s3, 48, s3
v_add_u32 v6, s3, v35
Mvaa 84,232,32
s_mul_i32 s3, s33, 1116160
s_add_u32 s3, s3, 8388608
s_add_u32 s12, s66, s3
s_addc_u32 s13, s67, 0
s_and_b32 s13, s13, 0xffff
Mvaa 84,236,36
s_mov_b32 s14, 0
s_mov_b32 s15, 0x20000
s_mul_i32 s14, s36, 34816
Mvaa 88,224,40
buffer_load_dword v44, v45, s[8:11], s47 offen
Mvaa 88,228,44
s_add_u32 s47, s47, 2097152
v_lshrrev_b32 v42, 2, v33
v_lshl_add_u32 v43, v32, 3, v42
Mvaa 92,232,40
v_lshlrev_b32 v43, 8, v43
v_and_b32 v46, 3, v0
Mvaa 92,236,44
v_lshl_add_u32 v43, v46, 3, v43
v_and_b32_e64 v46, 1, v32
Mvaa 96,224,48
v_lshl_add_u32 v42, v46, 2, v42
v_lshl_add_u32 v16, v42, 5, v43
Mvaa 96,228,52
v_xor_b32 v17, 32, v16
v_xor_b32 v18, 64, v16
Mvaa 100,232,48
v_xor_b32 v19, 96, v16
v_xor_b32 v20, 128, v16
Mvaa 100,236,52
v_xor_b32 v21, 160, v16
v_xor_b32 v22, 192, v16
Mvaa 104,224,56
v_xor_b32 v23, 224, v16
Mvaa 104,228,60
Mvaa 108,232,56
s_waitcnt lgkmcnt(0)
Mvaa 108,236,60
Mvaa 112,240,0
Mvaa 112,244,4
Mvaa 116,248,0
Mvaa 116,252,4
Ra 224,10,8192
Mvaa 120,240,8
Mvaa 120,244,12
Mvaa 124,248,8
Mvaa 124,252,12
Ra 228,11,8192
Mvaa 128,240,16
Mvaa 128,244,20
Mvaa 132,248,16
Mvaa 132,252,20
Ra 232,10,10240
Mvaa 136,240,24
Mvaa 136,244,28
Mvaa 140,248,24
Mvaa 140,252,28
Ra 236,11,10240
Mvaa 144,240,32
Mvaa 144,244,36
Mvaa 148,248,32
Mvaa 148,252,36
Mvaa 152,240,40
Mvaa 152,244,44
Mvaa 156,248,40
Mvaa 156,252,44
Mvaa 160,240,48
Mvaa 160,244,52
Mvaa 164,248,48
Mvaa 164,252,52
Mvaa 168,240,56
Mvaa 168,244,60
s_waitcnt vmcnt(10)
Mvaa 172,248,56
s_waitcnt lgkmcnt(0)
s_barrier
Mvaa 172,252,60
s_add_u32 m0, s44, 0
Mvaa 176,224,0
buffer_load_dwordx4 v8, s[8:11], s48 offen offset:0 lds
Mvaa 176,228,4
Ta 64,14,0
Ta 66,14,2048
Mvaa 180,232,0
Mvaa 180,236,4
Ra 240,10,12288
Mvaa 184,224,8
buffer_load_dwordx4 v8, s[8:11], s49 offen offset:1024 lds
Mvaa 184,228,12
Ta 68,14,16384
Ta 70,14,18432
Mvaa 188,232,8
Mvaa 188,236,12
Ra 244,11,12288
Mvaa 192,224,16
buffer_load_dwordx4 v9, s[8:11], s50 offen offset:2048 lds
Mvaa 192,228,20
Ta 72,15,0
Ta 74,15,2048
Mvaa 196,232,16
Mvaa 196,236,20
Ra 248,10,14336
Mvaa 200,224,24
buffer_load_dwordx4 v9, s[8:11], s51 offen offset:3072 lds
Mvaa 200,228,28
Ta 76,15,16384
Ta 78,15,18432
Mvaa 204,232,24
v_xor_b32 v8, 524288, v8
v_xor_b32 v9, 524288, v9
Mvaa 204,236,28
s_add_u32 m0, s44, 16384
Ra 252,11,14336
Mvaa 208,224,32
buffer_load_dwordx4 v8, s[8:11], s48 offen offset:0 lds
Mvaa 208,228,36
Mvaa 212,232,32
Mvaa 212,236,36
Ta 80,24,0
Ta 82,24,2048
Mvaa 216,224,40
buffer_load_dwordx4 v8, s[8:11], s49 offen offset:1024 lds
Mvaa 216,228,44
Ta 84,24,16384
s_waitcnt lgkmcnt(9)
Ta 86,24,18432
Mvaa 220,232,40
Mvaa 220,236,44
Ta 88,25,0
Ta 90,25,2048
Mvaa 224,224,48
buffer_load_dwordx4 v9, s[8:11], s50 offen offset:2048 lds
Mvaa 224,228,52
Mvaa 228,232,48
s_mul_i32 s3, s45, 33792
v_add_u32_e64 v10, s3, v2
Mvaa 228,236,52
Ta 92,25,16384
Ta 94,25,18432
Mvaa 232,224,56
buffer_load_dwordx4 v9, s[8:11], s51 offen offset:3072 lds
Mvaa 232,228,60
s_waitcnt vmcnt(10)
Ta 96,26,0
s_waitcnt lgkmcnt(9)
Ta 98,26,2048
Mvaa 236,232,56
s_barrier
v_xor_b32 v8, 1572864, v8
v_xor_b32 v9, 1572864, v9
Mvaa 236,236,60
s_add_u32 m0, s44, 32768
Ta 100,26,16384
Ta 102,26,18432
Mvaa 240,240,0
buffer_load_dwordx4 v8, s[8:11], s48 offen offset:0 lds
Mvaa 240,244,4
s_mul_i32 s3, s46, 33792
v_add_u32 v11, s3, v2
Mvaa 244,248,0
Mvaa 244,252,4
Ra 224,12,0
Mvaa 248,240,8
buffer_load_dwordx4 v8, s[8:11], s49 offen offset:1024 lds
Mvaa 248,244,12
Ta 104,27,0
Ta 106,27,2048
Mvaa 252,248,8
Mvaa 252,252,12
s_waitcnt lgkmcnt(9)
Ra 228,13,0
Maaa 128,240,16
buffer_load_dwordx4 v9, s[8:11], s50 offen offset:2048 lds
Maaa 128,244,20
Ta 108,27,16384
Ta 110,27,18432
Maaa 132,248,16
Maaa 132,252,20
Ra 232,12,2048
Maaa 136,240,24
buffer_load_dwordx4 v9, s[8:11], s51 offen offset:3072 lds
Maaa 136,244,28
Ta 112,28,0
Ta 114,28,2048
Maaa 140,248,24
v_xor_b32 v8, 524288, v8
v_xor_b32 v9, 524288, v9
Maaa 140,252,28
s_add_u32 m0, s44, 49152
s_waitcnt lgkmcnt(9)
Ra 236,13,2048
Maaa 144,240,32
buffer_load_dwordx4 v8, s[8:11], s48 offen offset:0 lds
Maaa 144,244,36
Maaa 148,248,32
Maaa 148,252,36
Ta 116,28,16384
Ta 118,28,18432
Maaa 152,240,40
buffer_load_dwordx4 v8, s[8:11], s49 offen offset:1024 lds
Maaa 152,244,44
Ta 120,29,0
Ta 122,29,2048
Maaa 156,248,40
Maaa 156,252,44
Ta 124,29,16384
s_waitcnt lgkmcnt(9)
Ta 126,29,18432
Maaa 160,240,48
buffer_load_dwordx4 v9, s[8:11], s50 offen offset:2048 lds
Maaa 160,244,52
Maaa 164,248,48
Maaa 164,252,52
Maaa 168,240,56
buffer_load_dwordx4 v9, s[8:11], s51 offen offset:3072 lds
Maaa 168,244,60
v_xor_b32 v8, 3670016, v8
v_xor_b32 v9, 3670016, v9
Maaa 172,248,56
s_waitcnt lgkmcnt(6)
Maaa 172,252,60
s_waitcnt lgkmcnt(0)
Mvaa 48,224,64
v_mov_b32 v14, v40
v_mov_b32_e64 v15, v41
Mvaa 48,228,68
Mvaa 52,232,64
Mvaa 52,236,68
Ra 240,12,4096
Mvaa 56,224,72
Mvaa 56,228,76
Mvaa 60,232,72
Mvaa 60,236,76
Ra 244,13,4096
Mvaa 64,224,80
Vc 24,48,49
Vc 25,50,51
Mvaa 64,228,84
Vc 26,52,53
Vc 27,54,55
Mvaa 68,232,80
Mvaa 68,236,84
Ra 248,12,6144
Mvaa 72,224,88
Vc 28,56,57
Vc 29,58,59
Mvaa 72,228,92
Vc 30,60,61
Vc 31,62,63
Mvaa 76,232,88
Mvaa 76,236,92
Ra 252,13,6144
Mvaa 80,224,96
Vc 32,64,65
Vc 33,66,67
Mvaa 80,228,100
Vc 34,68,69
Vc 35,70,71
Mvaa 84,232,96
Mvaa 84,236,100
Mvaa 88,224,104
Vc 36,72,73
Vc 37,74,75
Mvaa 88,228,108
Vc 38,76,77
Vc 39,78,79
Mvaa 92,232,104
Mvaa 92,236,108
Mvaa 96,224,112
Vc 40,80,81
Vc 41,82,83
Mvaa 96,228,116
Vc 42,84,85
Vc 43,86,87
Mvaa 100,232,112
s_waitcnt vmcnt(12)
Mvaa 100,236,116
s_add_u32 s59, s38, 0
Mvaa 104,224,120
v_readfirstlane_b32 s3, v1
s_nop 0
s_or_b32 s3, s3, s37
s_cmp_lt_u32 s3, 256
s_cbranch_scc1 L_spinAv
L_spinArv:
s_barrier
Mvaa 104,228,124
buffer_store_dwordx4 v[24:27], v2, s[24:27], s59 offen offset:0 sc1
Mvaa 108,232,120
s_waitcnt lgkmcnt(0)
Mvaa 108,236,124
Vc 44,88,89
Vc 45,90,91
Mvaa 112,240,64
buffer_load_dwordx4 a[0:3], v10, s[20:23], s53 offen offset:0 sc1
Mvaa 112,244,68
Vc 46,92,93
Vc 47,94,95
Mvaa 116,248,64
Vc 48,96,97
Vc 49,98,99
Mvaa 116,252,68
Ra 224,12,8192
Mvaa 120,240,72
Vc 50,100,101
Vc 51,102,103
Mvaa 120,244,76
Vc 52,104,105
Vc 53,106,107
Mvaa 124,248,72
buffer_load_dwordx4 a[4:7], v10, s[20:23], s52 offen offset:0 sc1
Mvaa 124,252,76
Ra 228,13,8192
Mvaa 128,240,80
Vc 54,108,109
Vc 55,110,111
Mvaa 128,244,84
Vc 56,112,113
Vc 57,114,115
Mvaa 132,248,80
Vc 58,116,117
Vc 59,118,119
Mvaa 132,252,84
Ra 232,12,10240
Mvaa 136,240,88
buffer_load_dwordx4 a[8:11], v11, s[20:23], s53 offen offset:0 sc1
Mvaa 136,244,92
buffer_store_dwordx4 v[28:31], v2, s[24:27], s59 offen offset:1024 sc1
Mvaa 140,248,88
Vc 60,120,121
Vc 61,122,123
Mvaa 140,252,92
Ra 236,13,10240
Mvaa 144,240,96
Vc 62,124,125
Vc 63,126,127
Mvaa 144,244,100
Vc 64,128,129
Vc 65,130,131
Mvaa 148,248,96
buffer_load_dwordx4 a[12:15], v11, s[20:23], s52 offen offset:0 sc1
Mvaa 148,252,100
Vc 66,132,133
Vc 67,134,135
Mvaa 152,240,104
Vc 68,136,137
Vc 69,138,139
Mvaa 152,244,108
Vc 70,140,141
Vc 71,142,143
Mvaa 156,248,104
Mvaa 156,252,108
Mvaa 160,240,112
buffer_load_dwordx4 a[16:19], v10, s[20:23], s53 offen offset:1024 sc1
Mvaa 160,244,116
Vc 72,144,145
Vc 73,146,147
Mvaa 164,248,112
Vc 74,148,149
Vc 75,150,151
Mvaa 164,252,116
buffer_store_dwordx4 v[32:35], v2, s[24:27], s59 offen offset:2048 sc1
Mvaa 168,240,120
Vc 76,152,153
Vc 77,154,155
Mvaa 168,244,124
Vc 78,156,157
Vc 79,158,159
Mvaa 172,248,120
s_waitcnt lgkmcnt(0)
buffer_load_dwordx4 a[20:23], v10, s[20:23], s52 offen offset:1024 sc1
Mvaa 172,252,124
Mvaa 176,224,64
Vc 80,160,161
Vc 81,162,163
Mvaa 176,228,68
Vc 82,164,165
Vc 83,166,167
Mvaa 180,232,64
Mvaa 180,236,68
Ra 240,12,12288
Mvaa 184,224,72
buffer_load_dwordx4 a[24:27], v11, s[20:23], s53 offen offset:1024 sc1
Mvaa 184,228,76
Vc 84,168,169
Vc 85,170,171
Mvaa 188,232,72
Vc 86,172,173
Vc 87,174,175
Mvaa 188,236,76
Ra 244,13,12288
Mvaa 192,224,80
Vc 88,176,177
Vc 89,178,179
Mvaa 192,228,84
Vc 90,180,181
Vc 91,182,183
Mvaa 196,232,80
buffer_load_dwordx4 a[28:31], v11, s[20:23], s52 offen offset:1024 sc1
Mvaa 196,236,84
Ra 248,12,14336
s_xor_b32 s52, s52, 2048
Mvaa 200,224,88
s_add_u32 s53, s52, s58
Mvaa 200,228,92
Vc 92,184,185
Vc 93,186,187
Mvaa 204,232,88
Vc 94,188,189
Vc 95,190,191
Mvaa 204,236,92
Ra 252,13,14336
Mvaa 208,224,96
buffer_load_dwordx4 a[32:35], v10, s[20:23], s53 offen offset:0 sc1
Mvaa 208,228,100
buffer_store_dwordx4 v[36:39], v2, s[24:27], s59 offen offset:3072 sc1
Mvaa 212,232,96
Vc 96,192,193
Vc 97,194,195
Mvaa 212,236,100
Vc 98,196,197
Vc 99,198,199
Mvaa 216,224,104
Vc 100,200,201
Vc 101,202,203
Mvaa 216,228,108
Vc 102,204,205
Vc 103,206,207
Mvaa 220,232,104
buffer_load_dwordx4 a[36:39], v10, s[20:23], s52 offen offset:0 sc1
Mvaa 220,236,108
Mvaa 224,224,112
Vc 104,208,209
Vc 105,210,211
Mvaa 224,228,116
Vc 106,212,213
Vc 107,214,215
Mvaa 228,232,112
Mvaa 228,236,116
Mvaa 232,224,120
buffer_load_dwordx4 a[40:43], v11, s[20:23], s53 offen offset:0 sc1
Mvaa 232,228,124
Vc 108,216,217
Vc 109,218,219
Mvaa 236,232,120
s_waitcnt lgkmcnt(0)
Mvaa 236,236,124
Vc 110,220,221
Vc 111,222,223
Mvaa 240,240,64
s_add_u32 s59, s38, 4096
Mvaa 240,244,68
buffer_store_dwordx4 v[40:43], v2, s[24:27], s59 offen offset:0 sc1
Mvaa 244,248,64
buffer_load_dwordx4 a[44:47], v11, s[20:23], s52 offen offset:0 sc1
Mvaa 244,252,68
Vc 112,224,225
Vc 113,226,227
Mvaa 248,240,72
Vc 114,228,229
Vc 115,230,231
Mvaa 248,244,76
Vc 116,232,233
Vc 117,234,235
Mvaa 252,248,72
Vc 118,236,237
Vc 119,238,239
Mvaa 252,252,76
Maaa 128,240,80
buffer_load_dwordx4 a[48:51], v10, s[20:23], s53 offen offset:1024 sc1
Maaa 128,244,84
Ta 192,16,0
Ta 194,16,1024
Maaa 132,248,80
Vc 120,240,241
Vc 121,242,243
Maaa 132,252,84
Ta 196,16,8192
Ta 198,16,9216
Maaa 136,240,88
Vc 122,244,245
Vc 123,246,247
Maaa 136,244,92
Ta 200,17,0
Ta 202,17,1024
Maaa 140,248,88
buffer_load_dwordx4 a[52:55], v10, s[20:23], s52 offen offset:1024 sc1
Maaa 140,252,92
Ta 204,17,8192
Ta 206,17,9216
Maaa 144,240,96
Vc 124,248,249
Vc 125,250,251
Maaa 144,244,100
Ta 208,18,0
Ta 210,18,1024
Maaa 148,248,96
Vc 126,252,253
Vc 127,254,255
Maaa 148,252,100
Ta 212,18,8192
Ta 214,18,9216
Maaa 152,240,104
buffer_load_dwordx4 a[56:59], v11, s[20:23], s53 offen offset:1024 sc1
Maaa 152,244,108
Ta 216,19,0
Ta 218,19,1024
Maaa 156,248,104
buffer_store_dwordx4 v[44:47], v2, s[24:27], s59 offen offset:1024 sc1
Maaa 156,252,108
Ta 220,19,8192
s_waitcnt lgkmcnt(9)
Ta 222,19,9216
Maaa 160,240,112
Maaa 160,244,116
Maaa 164,248,112
buffer_load_dwordx4 a[60:63], v11, s[20:23], s52 offen offset:1024 sc1
Maaa 164,252,116
s_xor_b32 s52, s52, 6144
s_add_u32 s53, s52, s58
Maaa 168,240,120
Maaa 168,244,124
Maaa 172,248,120
Maaa 172,252,124
L_phase2:
s_nop 7
s_waitcnt vmcnt(11) lgkmcnt(0)
Zvaa 128,192,0
buffer_store_dwordx4 v[48:51], v2, s[24:27], s59 offen offset:2048 sc1
Mvaa 128,196,16
Ta 224,20,0
Ta 226,20,1024
Zvaa 160,192,4
buffer_load_dwordx4 a[64:67], v10, s[20:23], s53 offen offset:0 sc1
Mvaa 160,196,20
s_mov_b32 s60, s40
s_and_b32 s61, s41, 0xffff
s_mov_b32 s62, 7340032
Zvaa 192,192,8
Ta 228,20,8192
Ta 230,20,9216
Mvaa 192,196,24
buffer_load_dwordx4 a[68:71], v10, s[20:23], s52 offen offset:0 sc1
Zvaa 224,192,12
s_mov_b32 s63, 0x20000
Mvaa 224,196,28
Ta 232,21,0
Ta 234,21,1024
Zvaa 132,200,0
global_load_dword v13, v[14:15], off
Mvaa 132,204,16
buffer_load_dwordx4 a[72:75], v11, s[20:23], s53 offen offset:0 sc1
Zvaa 164,200,4
Ta 236,21,8192
Ta 238,21,9216
Mvaa 164,204,20
Zvaa 196,200,8
buffer_load_dwordx4 a[76:79], v11, s[20:23], s52 offen offset:0 sc1
Mvaa 196,204,24
Ta 240,22,0
Ta 242,22,1024
Zvaa 228,200,12
Mvaa 228,204,28
Zvaa 136,208,0
s_waitcnt lgkmcnt(6)
Ta 244,22,8192
Ta 246,22,9216
Mvaa 136,212,16
buffer_load_dwordx4 a[80:83], v10, s[20:23], s53 offen offset:1024 sc1
Zvaa 168,208,4
Mvaa 168,212,20
Ta 248,23,0
Ta 250,23,1024
Zvaa 200,208,8
buffer_load_dwordx4 a[84:87], v10, s[20:23], s52 offen offset:1024 sc1
Mvaa 200,212,24
Zvaa 232,208,12
Ta 252,23,8192
Ta 254,23,9216
Mvaa 232,212,28
Zvaa 140,216,0
buffer_load_dwordx4 a[88:91], v11, s[20:23], s53 offen offset:1024 sc1
Mvaa 140,220,16
Zvaa 172,216,4
buffer_load_dwordx4 a[92:95], v11, s[20:23], s52 offen offset:1024 sc1
Mvaa 172,220,20
s_xor_b32 s52, s52, 2048
s_add_u32 s53, s52, s58
Zvaa 204,216,8
buffer_store_dwordx4 v[52:55], v2, s[24:27], s59 offen offset:3072 sc1
Mvaa 204,220,24
Zvaa 236,216,12
s_waitcnt lgkmcnt(0)
Mvaa 236,220,28
s_barrier
Zvaa 144,224,0
Mvaa 144,228,16
s_add_u32 m0, s44, 0
Ta 192,16,16384
Ta 194,16,17408
Zvaa 176,224,4
buffer_load_dwordx4 v8, s[8:11], s48 offen offset:0 lds
Mvaa 176,228,20
Zvaa 208,224,8
Ta 196,16,24576
Ta 198,16,25600
Mvaa 208,228,24
Zvaa 240,224,12
buffer_load_dwordx4 v8, s[8:11], s49 offen offset:1024 lds
Mvaa 240,228,28
Ta 200,17,16384
Ta 202,17,17408
Zvaa 148,232,0
Mvaa 148,236,16
Zvaa 180,232,4
Ta 204,17,24576
Ta 206,17,25600
Mvaa 180,236,20
buffer_load_dwordx4 a[96:99], v10, s[20:23], s53 offen offset:0 sc1
Zvaa 212,232,8
Mvaa 212,236,24
Ta 208,18,16384
Ta 210,18,17408
Zvaa 244,232,12
Mvaa 244,236,28
Zvaa 152,240,0
s_waitcnt lgkmcnt(6)
Ta 212,18,24576
Ta 214,18,25600
Mvaa 152,244,16
buffer_load_dwordx4 a[100:103], v10, s[20:23], s52 offen offset:0 sc1
Zvaa 184,240,4
Mvaa 184,244,20
Ta 216,19,16384
Ta 218,19,17408
Zvaa 216,240,8
Mvaa 216,244,24
buffer_load_dwordx4 a[104:107], v11, s[20:23], s53 offen offset:0 sc1
Zvaa 248,240,12
Ta 220,19,24576
Ta 222,19,25600
Mvaa 248,244,28
s_add_u32 s59, s38, 8192
Zvaa 156,248,0
buffer_store_dwordx4 v[56:59], v2, s[24:27], s59 offen offset:0 sc1
Mvaa 156,252,16
buffer_load_dwordx4 a[108:111], v11, s[20:23], s52 offen offset:0 sc1
Zvaa 188,248,4
Ar 48,128
Ar 49,129
Mvaa 188,252,20
Ar 50,130
Ar 51,131
Zvaa 220,248,8
Ar 52,132
Ar 53,133
Mvaa 220,252,24
Ar 54,134
Ar 55,135
Zvaa 252,248,12
s_waitcnt vmcnt(18) lgkmcnt(0)
Vc 24,48,49
Vc 25,50,51
Mvaa 252,252,28
Vc 26,52,53
Vc 27,54,55
Mvaa 128,192,32
Mvaa 128,196,48
Ta 224,20,16384
Ta 226,20,17408
Mvaa 160,192,36
buffer_load_dwordx4 v9, s[8:11], s50 offen offset:2048 lds
Mvaa 160,196,52
Mvaa 192,192,40
Ta 228,20,24576
Ta 230,20,25600
Mvaa 192,196,56
Mvaa 224,192,44
buffer_load_dwordx4 v9, s[8:11], s51 offen offset:3072 lds
Mvaa 224,196,60
Ta 232,21,16384
Ta 234,21,17408
Mvaa 132,200,32
v_xor_b32 v8, 524288, v8
v_xor_b32 v9, 524288, v9
Mvaa 132,204,48
Mvaa 164,200,36
Ta 236,21,24576
Ta 238,21,25600
Mvaa 164,204,52
buffer_load_dwordx4 a[112:115], v10, s[20:23], s53 offen offset:1024 sc1
Mvaa 196,200,40
Mvaa 196,204,56
Ta 240,22,16384
Ta 242,22,17408
Mvaa 228,200,44
Mvaa 228,204,60
Mvaa 136,208,32
s_waitcnt lgkmcnt(6)
Ta 244,22,24576
Ta 246,22,25600
Mvaa 136,212,48
buffer_load_dwordx4 a[116:119], v10, s[20:23], s52 offen offset:1024 sc1
Mvaa 168,208,36
buffer_store_dwordx4 v[60:63], v2, s[24:27], s59 offen offset:1024 sc1
Mvaa 168,212,52
Ta 248,23,16384
Ta 250,23,17408
Mvaa 200,208,40
Ar 48,136
Ar 49,137
Mvaa 200,212,56
buffer_load_dwordx4 a[120:123], v11, s[20:23], s53 offen offset:1024 sc1
Mvaa 232,208,44
Ta 252,23,24576
Ta 254,23,25600
Mvaa 232,212,60
Ar 50,138
Ar 51,139
Mvaa 140,216,32
Ar 52,140
Ar 53,141
Mvaa 140,220,48
buffer_load_dwordx4 a[124:127], v11, s[20:23], s52 offen offset:1024 sc1
Mvaa 172,216,36
s_xor_b32 s52, s52, 14336
s_add_u32 s53, s52, s58
Mvaa 172,220,52
Ar 54,142
Ar 55,143
Mvaa 204,216,40
Vc 28,48,49
Vc 29,50,51
Mvaa 204,220,56
Vc 30,52,53
Vc 31,54,55
Mvaa 236,216,44
s_waitcnt lgkmcnt(0)
Mvaa 236,220,60
s_barrier
Mvaa 144,224,32
Mvaa 144,228,48
s_add_u32 m0, s44, 16384
Ta 192,16,32768
Ta 194,16,33792
Mvaa 176,224,36
buffer_load_dwordx4 v8, s[8:11], s48 offen offset:0 lds
Mvaa 176,228,52
Mvaa 208,224,40
Ta 196,16,40960
Ta 198,16,41984
Mvaa 208,228,56
Mvaa 240,224,44
buffer_load_dwordx4 v8, s[8:11], s49 offen offset:1024 lds
Mvaa 240,228,60
Ta 200,17,32768
Ta 202,17,33792
Mvaa 148,232,32
Mvaa 148,236,48
Mvaa 180,232,36
Ta 204,17,40960
Ta 206,17,41984
Mvaa 180,236,52
buffer_load_dwordx4 a[0:3], v10, s[20:23], s53 offen offset:0 sc1
Mvaa 212,232,40
buffer_store_dwordx4 v[64:67], v2, s[24:27], s59 offen offset:2048 sc1
Mvaa 212,236,56
Ta 208,18,32768
Ta 210,18,33792
Mvaa 244,232,44
Ar 48,144
Ar 49,145
Mvaa 244,236,60
Ar 50,146
Ar 51,147
Mvaa 152,240,32
s_waitcnt lgkmcnt(6)
Ta 212,18,40960
Ta 214,18,41984
Mvaa 152,244,48
buffer_load_dwordx4 a[4:7], v10, s[20:23], s52 offen offset:0 sc1
Mvaa 184,240,36
Ar 52,148
Ar 53,149
Mvaa 184,244,52
Ta 216,19,32768
Ta 218,19,33792
Mvaa 216,240,40
Ar 54,150
Ar 55,151
Mvaa 216,244,56
buffer_load_dwordx4 a[8:11], v11, s[20:23], s53 offen offset:0 sc1
Mvaa 248,240,44
Ta 220,19,40960
Ta 222,19,41984
Mvaa 248,244,60
Vc 32,48,49
Vc 33,50,51
Mvaa 156,248,32
Vc 34,52,53
Vc 35,54,55
Mvaa 156,252,48
buffer_load_dwordx4 a[12:15], v11, s[20:23], s52 offen offset:0 sc1
Mvaa 188,248,36
Mvaa 188,252,52
Mvaa 220,248,40
Mvaa 220,252,56
Mvaa 252,248,44
s_waitcnt vmcnt(22) lgkmcnt(0)
Mvaa 252,252,60
Mvaa 128,192,64
Mvaa 128,196,80
Ta 224,20,32768
Ta 226,20,33792
Mvaa 160,192,68
buffer_load_dwordx4 v9, s[8:11], s50 offen offset:2048 lds
Mvaa 160,196,84
Mvaa 192,192,72
Ta 228,20,40960
Ta 230,20,41984
Mvaa 192,196,88
Mvaa 224,192,76
buffer_load_dwordx4 v9, s[8:11], s51 offen offset:3072 lds
Mvaa 224,196,92
Ta 232,21,32768
Ta 234,21,33792
Mvaa 132,200,64
v_xor_b32 v8, 1572864, v8
v_xor_b32 v9, 1572864, v9
Mvaa 132,204,80
buffer_store_dwordx4 v[68:71], v2, s[24:27], s59 offen offset:3072 sc1
Mvaa 164,200,68
Ta 236,21,40960
Ta 238,21,41984
Mvaa 164,204,84
buffer_load_dwordx4 a[16:19], v10, s[20:23], s53 offen offset:1024 sc1
Mvaa 196,200,72
Ar 48,152
Ar 49,153
Mvaa 196,204,88
Ta 240,22,32768
Ta 242,22,33792
Mvaa 228,200,76
Ar 50,154
Ar 51,155
Mvaa 228,204,92
Ar 52,156
Ar 53,157
Mvaa 136,208,64
s_waitcnt lgkmcnt(6)
Ta 244,22,40960
Ta 246,22,41984
Mvaa 136,212,80
buffer_load_dwordx4 a[20:23], v10, s[20:23], s52 offen offset:1024 sc1
Mvaa 168,208,68
Ar 54,158
Ar 55,159
Mvaa 168,212,84
Ta 248,23,32768
Ta 250,23,33792
Mvaa 200,208,72
Vc 36,48,49
Vc 37,50,51
Mvaa 200,212,88
buffer_load_dwordx4 a[24:27], v11, s[20:23], s53 offen offset:1024 sc1
Mvaa 232,208,76
Ta 252,23,40960
Ta 254,23,41984
Mvaa 232,212,92
Vc 38,52,53
Vc 39,54,55
Mvaa 140,216,64
Mvaa 140,220,80
buffer_load_dwordx4 a[28:31], v11, s[20:23], s52 offen offset:1024 sc1
Mvaa 172,216,68
s_xor_b32 s52, s52, 2048
s_add_u32 s53, s52, s58
Mvaa 172,220,84
Mvaa 204,216,72
Mvaa 204,220,88
Mvaa 236,216,76
s_waitcnt lgkmcnt(0)
Mvaa 236,220,92
s_barrier
Mvaa 144,224,64
s_add_u32 s59, s38, 12288
Mvaa 144,228,80
s_add_u32 m0, s44, 32768
Ta 192,16,49152
Ta 194,16,50176
Mvaa 176,224,68
buffer_load_dwordx4 v8, s[8:11], s48 offen offset:0 lds
Mvaa 176,228,84
buffer_store_dwordx4 v[72:75], v2, s[24:27], s59 offen offset:0 sc1
Mvaa 208,224,72
Ta 196,16,57344
Ta 198,16,58368
Mvaa 208,228,88
Ar 48,160
Ar 49,161
Mvaa 240,224,76
buffer_load_dwordx4 v8, s[8:11], s49 offen offset:1024 lds
Mvaa 240,228,92
Ta 200,17,49152
Ta 202,17,50176
Mvaa 148,232,64
Ar 50,162
Ar 51,163
Mvaa 148,236,80
Ar 52,164
Ar 53,165
Mvaa 180,232,68
Ta 204,17,57344
Ta 206,17,58368
Mvaa 180,236,84
buffer_load_dwordx4 a[32:35], v10, s[20:23], s53 offen offset:0 sc1
Mvaa 212,232,72
Ar 54,166
Ar 55,167
Mvaa 212,236,88
Ta 208,18,49152
Ta 210,18,50176
Mvaa 244,232,76
Vc 40,48,49
Vc 41,50,51
Mvaa 244,236,92
Vc 42,52,53
Vc 43,54,55
Mvaa 152,240,64
s_waitcnt lgkmcnt(6)
Ta 212,18,57344
Ta 214,18,58368
Mvaa 152,244,80
buffer_load_dwordx4 a[36:39], v10, s[20:23], s52 offen offset:0 sc1
Mvaa 184,240,68
global_load_dword v13, v[14:15], off
Mvaa 184,244,84
Ta 216,19,49152
Ta 218,19,50176
Mvaa 216,240,72
Mvaa 216,244,88
buffer_load_dwordx4 a[40:43], v11, s[20:23], s53 offen offset:0 sc1
Mvaa 248,240,76
Ta 220,19,57344
Ta 222,19,58368
Mvaa 248,244,92
Mvaa 156,248,64
Mvaa 156,252,80
buffer_load_dwordx4 a[44:47], v11, s[20:23], s52 offen offset:0 sc1
Mvaa 188,248,68
Mvaa 188,252,84
buffer_store_dwordx4 v[76:79], v2, s[24:27], s59 offen offset:1024 sc1
Mvaa 220,248,72
Ar 48,168
Ar 49,169
Mvaa 220,252,88
Ar 50,170
Ar 51,171
Mvaa 252,248,76
s_waitcnt vmcnt(23) lgkmcnt(0)
Ar 52,172
Ar 53,173
Mvaa 252,252,92
Ar 54,174
Ar 55,175
Mvaa 128,192,96
Vc 44,48,49
Vc 45,50,51
Mvaa 128,196,112
Ta 224,20,49152
Ta 226,20,50176
Mvaa 160,192,100
buffer_load_dwordx4 v9, s[8:11], s50 offen offset:2048 lds
Mvaa 160,196,116
Vc 46,52,53
Vc 47,54,55
Mvaa 192,192,104
Ta 228,20,57344
Ta 230,20,58368
Mvaa 192,196,120
s_lshl_b32 s3, s32, 11
s_add_u32 s3, s3, 5242880
Mvaa 224,192,108
buffer_load_dwordx4 v9, s[8:11], s51 offen offset:3072 lds
Mvaa 224,196,124
Ta 232,21,49152
Ta 234,21,50176
Mvaa 132,200,96
v_xor_b32 v8, 524288, v8
v_xor_b32 v9, 524288, v9
Mvaa 132,204,112
buffer_load_dwordx4 v[56:59], v2, s[20:23], s3 offen offset:0 sc1
Mvaa 164,200,100
Ta 236,21,57344
Ta 238,21,58368
Mvaa 164,204,116
buffer_load_dwordx4 a[48:51], v10, s[20:23], s53 offen offset:1024 sc1
Mvaa 196,200,104
buffer_load_dwordx4 v[60:63], v2, s[20:23], s3 offen offset:1024 sc1
Mvaa 196,204,120
Ta 240,22,49152
Ta 242,22,50176
Mvaa 228,200,108
Mvaa 228,204,124
Mvaa 136,208,96
s_waitcnt lgkmcnt(6)
Ta 244,22,57344
Ta 246,22,58368
Mvaa 136,212,112
buffer_load_dwordx4 a[52:55], v10, s[20:23], s52 offen offset:1024 sc1
Mvaa 168,208,100
Mvaa 168,212,116
Ta 248,23,49152
Ta 250,23,50176
Mvaa 200,208,104
Mvaa 200,212,120
buffer_load_dwordx4 a[56:59], v11, s[20:23], s53 offen offset:1024 sc1
Mvaa 232,208,108
Ta 252,23,57344
Ta 254,23,58368
Mvaa 232,212,124
buffer_store_dwordx4 v[80:83], v2, s[24:27], s59 offen offset:2048 sc1
Mvaa 140,216,96
Mvaa 140,220,112
buffer_load_dwordx4 a[60:63], v11, s[20:23], s52 offen offset:1024 sc1
Mvaa 172,216,100
s_xor_b32 s52, s52, 6144
s_add_u32 s53, s52, s58
Mvaa 172,220,116
Mvaa 204,216,104
Mvaa 204,220,120
Mvaa 236,216,108
s_waitcnt lgkmcnt(0)
Mvaa 236,220,124
s_barrier
Mvaa 144,224,96
Mvaa 144,228,112
s_add_u32 m0, s44, 49152
Ta 192,16,0
Ta 194,16,1024
Mvaa 176,224,100
buffer_load_dwordx4 v8, s[8:11], s48 offen offset:0 lds
Mvaa 176,228,116
Mvaa 208,224,104
Ta 196,16,8192
Ta 198,16,9216
Mvaa 208,228,120
Mvaa 240,224,108
buffer_load_dwordx4 v8, s[8:11], s49 offen offset:1024 lds
Mvaa 240,228,124
Ta 200,17,0
Ta 202,17,1024
Mvaa 148,232,96
Mvaa 148,236,112
Mvaa 180,232,100
Ta 204,17,8192
Ta 206,17,9216
Mvaa 180,236,116
buffer_load_dwordx4 a[64:67], v10, s[20:23], s53 offen offset:0 sc1
Mvaa 212,232,104
Mvaa 212,236,120
Ta 208,18,0
Ta 210,18,1024
Mvaa 244,232,108
Mvaa 244,236,124
Mvaa 152,240,96
s_waitcnt lgkmcnt(6)
Ta 212,18,8192
Ta 214,18,9216
Mvaa 152,244,112
buffer_load_dwordx4 a[68:71], v10, s[20:23], s52 offen offset:0 sc1
Mvaa 184,240,100
buffer_store_dwordx4 v[84:87], v2, s[24:27], s59 offen offset:3072 sc1
Mvaa 184,244,116
Ta 216,19,0
Ta 218,19,1024
Mvaa 216,240,104
Mvaa 216,244,120
buffer_load_dwordx4 a[72:75], v11, s[20:23], s53 offen offset:0 sc1
Mvaa 248,240,108
Ta 220,19,8192
Ta 222,19,9216
Mvaa 248,244,124
Mvaa 156,248,96
Mvaa 156,252,112
buffer_load_dwordx4 a[76:79], v11, s[20:23], s52 offen offset:0 sc1
Mvaa 188,248,100
Mvaa 188,252,116
Mvaa 220,248,104
Mvaa 220,252,120
Mvaa 252,248,108
s_waitcnt vmcnt(25) lgkmcnt(0)
Mvaa 252,252,124
Mvaa 128,192,0
Mvaa 128,196,16
Ta 224,20,0
Ta 226,20,1024
Mvaa 160,192,4
buffer_load_dwordx4 v9, s[8:11], s50 offen offset:2048 lds
Mvaa 160,196,20
Mvaa 192,192,8
Ta 228,20,8192
Ta 230,20,9216
Mvaa 192,196,24
Mvaa 224,192,12
buffer_load_dwordx4 v9, s[8:11], s51 offen offset:3072 lds
Mvaa 224,196,28
Ta 232,21,0
Ta 234,21,1024
Mvaa 132,200,0
v_xor_b32 v8, 7864320, v8
v_xor_b32 v9, 7864320, v9
Mvaa 132,204,16
Mvaa 164,200,4
Ta 236,21,8192
Ta 238,21,9216
Mvaa 164,204,20
buffer_load_dwordx4 a[80:83], v10, s[20:23], s53 offen offset:1024 sc1
Mvaa 196,200,8
s_add_u32 s59, s38, 34816
Mvaa 196,204,24
Ta 240,22,0
Ta 242,22,1024
Mvaa 228,200,12
buffer_store_dwordx4 v[88:91], v2, s[24:27], s59 offen offset:0 sc1
Mvaa 228,204,28
Mvaa 136,208,0
s_waitcnt lgkmcnt(6)
Ta 244,22,8192
Ta 246,22,9216
Mvaa 136,212,16
buffer_load_dwordx4 a[84:87], v10, s[20:23], s52 offen offset:1024 sc1
Mvaa 168,208,4
Mvaa 168,212,20
Ta 248,23,0
Ta 250,23,1024
Mvaa 200,208,8
Mvaa 200,212,24
buffer_load_dwordx4 a[88:91], v11, s[20:23], s53 offen offset:1024 sc1
Mvaa 232,208,12
Ta 252,23,8192
Ta 254,23,9216
Mvaa 232,212,28
Mvaa 140,216,0
Mvaa 140,220,16
buffer_load_dwordx4 a[92:95], v11, s[20:23], s52 offen offset:1024 sc1
Mvaa 172,216,4
s_xor_b32 s52, s52, 2048
s_add_u32 s53, s52, s58
Mvaa 172,220,20
Mvaa 204,216,8
Mvaa 204,220,24
Mvaa 236,216,12
s_waitcnt lgkmcnt(0)
Mvaa 236,220,28
s_barrier
Mvaa 144,224,0
Mvaa 144,228,16
s_add_u32 m0, s44, 0
Ta 192,16,16384
Ta 194,16,17408
Mvaa 176,224,4
buffer_load_dwordx4 v8, s[8:11], s48 offen offset:0 lds
Mvaa 176,228,20
Mvaa 208,224,8
Ta 196,16,24576
Ta 198,16,25600
Mvaa 208,228,24
Mvaa 240,224,12
buffer_load_dwordx4 v8, s[8:11], s49 offen offset:1024 lds
Mvaa 240,228,28
Ta 200,17,16384
Ta 202,17,17408
Mvaa 148,232,0
buffer_store_dwordx4 v[92:95], v2, s[24:27], s59 offen offset:1024 sc1
Mvaa 148,236,16
Mvaa 180,232,4
Ta 204,17,24576
Ta 206,17,25600
Mvaa 180,236,20
buffer_load_dwordx4 a[96:99], v10, s[20:23], s53 offen offset:0 sc1
Mvaa 212,232,8
Mvaa 212,236,24
Ta 208,18,16384
Ta 210,18,17408
Mvaa 244,232,12
Mvaa 244,236,28
Mvaa 152,240,0
s_waitcnt lgkmcnt(6)
Ta 212,18,24576
Ta 214,18,25600
Mvaa 152,244,16
buffer_load_dwordx4 a[100:103], v10, s[20:23], s52 offen offset:0 sc1
Mvaa 184,240,4
Mvaa 184,244,20
Ta 216,19,16384
Ta 218,19,17408
Mvaa 216,240,8
Mvaa 216,244,24
buffer_load_dwordx4 a[104:107], v11, s[20:23], s53 offen offset:0 sc1
Mvaa 248,240,12
Ta 220,19,24576
Ta 222,19,25600
Mvaa 248,244,28
Mvaa 156,248,0
Mvaa 156,252,16
buffer_load_dwordx4 a[108:111], v11, s[20:23], s52 offen offset:0 sc1
Mvaa 188,248,4
Mvaa 188,252,20
Mvaa 220,248,8
Mvaa 220,252,24
Mvaa 252,248,12
s_waitcnt vmcnt(21) lgkmcnt(0)
Mvaa 252,252,28
Mvaa 128,192,32
buffer_store_dwordx4 v[96:99], v2, s[24:27], s59 offen offset:2048 sc1
Mvaa 128,196,48
Ta 224,20,16384
Ta 226,20,17408
Mvaa 160,192,36
buffer_load_dwordx4 v9, s[8:11], s50 offen offset:2048 lds
Mvaa 160,196,52
Mvaa 192,192,40
Ta 228,20,24576
Ta 230,20,25600
Mvaa 192,196,56
Mvaa 224,192,44
buffer_load_dwordx4 v9, s[8:11], s51 offen offset:3072 lds
Mvaa 224,196,60
Ta 232,21,16384
Ta 234,21,17408
Mvaa 132,200,32
v_xor_b32 v8, 524288, v8
v_xor_b32 v9, 524288, v9
Mvaa 132,204,48
Mvaa 164,200,36
Ta 236,21,24576
Ta 238,21,25600
Mvaa 164,204,52
buffer_load_dwordx4 a[112:115], v10, s[20:23], s53 offen offset:1024 sc1
Mvaa 196,200,40
Mvaa 196,204,56
Ta 240,22,16384
Ta 242,22,17408
Mvaa 228,200,44
Mvaa 228,204,60
Mvaa 136,208,32
s_waitcnt lgkmcnt(6)
Ta 244,22,24576
Ta 246,22,25600
Mvaa 136,212,48
buffer_load_dwordx4 a[116:119], v10, s[20:23], s52 offen offset:1024 sc1
Mvaa 168,208,36
Mvaa 168,212,52
Ta 248,23,16384
Ta 250,23,17408
Mvaa 200,208,40
Mvaa 200,212,56
buffer_load_dwordx4 a[120:123], v11, s[20:23], s53 offen offset:1024 sc1
Mvaa 232,208,44
Ta 252,23,24576
Ta 254,23,25600
Mvaa 232,212,60
Mvaa 140,216,32
Mvaa 140,220,48
buffer_load_dwordx4 a[124:127], v11, s[20:23], s52 offen offset:1024 sc1
Mvaa 172,216,36
s_xor_b32 s52, s52, 30720
s_add_u32 s53, s52, s58
Mvaa 172,220,52
buffer_store_dwordx4 v[100:103], v2, s[24:27], s59 offen offset:3072 sc1
Mvaa 204,216,40
Mvaa 204,220,56
Mvaa 236,216,44
s_waitcnt lgkmcnt(0)
Mvaa 236,220,60
s_barrier
Mvaa 144,224,32
Mvaa 144,228,48
s_add_u32 m0, s44, 16384
Ta 192,16,32768
Ta 194,16,33792
Mvaa 176,224,36
buffer_load_dwordx4 v8, s[8:11], s48 offen offset:0 lds
Mvaa 176,228,52
Mvaa 208,224,40
Ta 196,16,40960
Ta 198,16,41984
Mvaa 208,228,56
Mvaa 240,224,44
buffer_load_dwordx4 v8, s[8:11], s49 offen offset:1024 lds
Mvaa 240,228,60
Ta 200,17,32768
Ta 202,17,33792
Mvaa 148,232,32
Mvaa 148,236,48
Mvaa 180,232,36
Ta 204,17,40960
Ta 206,17,41984
Mvaa 180,236,52
buffer_load_dwordx4 a[0:3], v10, s[20:23], s53 offen offset:0 sc1
Mvaa 212,232,40
Mvaa 212,236,56
Ta 208,18,32768
Ta 210,18,33792
Mvaa 244,232,44
Mvaa 244,236,60
Mvaa 152,240,32
s_waitcnt lgkmcnt(6)
Ta 212,18,40960
Ta 214,18,41984
Mvaa 152,244,48
buffer_load_dwordx4 a[4:7], v10, s[20:23], s52 offen offset:0 sc1
Mvaa 184,240,36
Mvaa 184,244,52
Ta 216,19,32768
Ta 218,19,33792
Mvaa 216,240,40
Mvaa 216,244,56
buffer_load_dwordx4 a[8:11], v11, s[20:23], s53 offen offset:0 sc1
Mvaa 248,240,44
Ta 220,19,40960
Ta 222,19,41984
Mvaa 248,244,60
s_add_u32 s59, s38, 38912
Mvaa 156,248,32
buffer_store_dwordx4 v[104:107], v2, s[24:27], s59 offen offset:0 sc1
Mvaa 156,252,48
buffer_load_dwordx4 a[12:15], v11, s[20:23], s52 offen offset:0 sc1
Mvaa 188,248,36
Mvaa 188,252,52
Mvaa 220,248,40
Mvaa 220,252,56
Mvaa 252,248,44
s_waitcnt vmcnt(22) lgkmcnt(0)
Mvaa 252,252,60
Mvaa 128,192,64
v_max_u32 v14, v56, v57
v_min_u32_e64 v15, v56, v57
Mvaa 128,196,80
Ta 224,20,32768
Ta 226,20,33792
Mvaa 160,192,68
buffer_load_dwordx4 v9, s[8:11], s50 offen offset:2048 lds
Mvaa 160,196,84
v_med3_u32 v15, v14, v15, v58
v_max_u32_e64 v14, v14, v58
Mvaa 192,192,72
Ta 228,20,40960
Ta 230,20,41984
Mvaa 192,196,88
v_med3_u32 v15, v14, v15, v59
v_max_u32_e64 v14, v14, v59
Mvaa 224,192,76
buffer_load_dwordx4 v9, s[8:11], s51 offen offset:3072 lds
Mvaa 224,196,92
Ta 232,21,32768
Ta 234,21,33792
Mvaa 132,200,64
v_xor_b32 v8, 1572864, v8
v_xor_b32 v9, 1572864, v9
Mvaa 132,204,80
v_med3_u32 v15, v14, v15, v60
v_max_u32_e64 v14, v14, v60
Mvaa 164,200,68
Ta 236,21,40960
Ta 238,21,41984
Mvaa 164,204,84
buffer_load_dwordx4 a[16:19], v10, s[20:23], s53 offen offset:1024 sc1
Mvaa 196,200,72
v_med3_u32 v15, v14, v15, v61
v_max_u32_e64 v14, v14, v61
Mvaa 196,204,88
Ta 240,22,32768
Ta 242,22,33792
Mvaa 228,200,76
v_med3_u32 v15, v14, v15, v62
v_max_u32_e64 v14, v14, v62
Mvaa 228,204,92
v_med3_u32 v15, v14, v15, v63
v_max_u32_e64 v14, v14, v63
Mvaa 136,208,64
s_waitcnt lgkmcnt(6)
Ta 244,22,40960
Ta 246,22,41984
Mvaa 136,212,80
buffer_load_dwordx4 a[20:23], v10, s[20:23], s52 offen offset:1024 sc1
Mvaa 168,208,68
buffer_store_dwordx4 v[108:111], v2, s[24:27], s59 offen offset:1024 sc1
Mvaa 168,212,84
Ta 248,23,32768
Ta 250,23,33792
Mvaa 200,208,72
s_lshl_b32 s3, s32, 9
s_add_u32 s3, s3, 131072
v_lshlrev_b32_e64 v13, 3, v0
Mvaa 200,212,88
buffer_load_dwordx4 a[24:27], v11, s[20:23], s53 offen offset:1024 sc1
Mvaa 232,208,76
Ta 252,23,40960
Ta 254,23,41984
Mvaa 232,212,92
v_add_u32_e64 v56, s3, v13
v_add_u32 v13, 131072, v13
Mvaa 140,216,64
ds_write_b64 v56, v[14:15]
Mvaa 140,220,80
buffer_load_dwordx4 a[28:31], v11, s[20:23], s52 offen offset:1024 sc1
Mvaa 172,216,68
s_xor_b32 s52, s52, 2048
s_add_u32 s53, s52, s58
Mvaa 172,220,84
Mvaa 204,216,72
Mvaa 204,220,88
Mvaa 236,216,76
s_waitcnt lgkmcnt(0)
Mvaa 236,220,92
s_barrier
Mvaa 144,224,64
Mvaa 144,228,80
s_add_u32 m0, s44, 32768
Ta 192,16,49152
Ta 194,16,50176
Mvaa 176,224,68
buffer_load_dwordx4 v8, s[8:11], s48 offen offset:0 lds
Mvaa 176,228,84
Mvaa 208,224,72
Ta 196,16,57344
Ta 198,16,58368
Mvaa 208,228,88
Mvaa 240,224,76
buffer_load_dwordx4 v8, s[8:11], s49 offen offset:1024 lds
Mvaa 240,228,92
Ta 200,17,49152
Ta 202,17,50176
Mvaa 148,232,64
Mvaa 148,236,80
Mvaa 180,232,68
Ta 204,17,57344
Ta 206,17,58368
Mvaa 180,236,84
buffer_load_dwordx4 a[32:35], v10, s[20:23], s53 offen offset:0 sc1
Mvaa 212,232,72
buffer_store_dwordx4 v[112:115], v2, s[24:27], s59 offen offset:2048 sc1
Mvaa 212,236,88
Ta 208,18,49152
Ta 210,18,50176
Mvaa 244,232,76
Mvaa 244,236,92
Mvaa 152,240,64
s_waitcnt lgkmcnt(6)
Ta 212,18,57344
Ta 214,18,58368
Mvaa 152,244,80
buffer_load_dwordx4 a[36:39], v10, s[20:23], s52 offen offset:0 sc1
Mvaa 184,240,68
Mvaa 184,244,84
Ta 216,19,49152
Ta 218,19,50176
Mvaa 216,240,72
Mvaa 216,244,88
buffer_load_dwordx4 a[40:43], v11, s[20:23], s53 offen offset:0 sc1
Mvaa 248,240,76
Ta 220,19,57344
Ta 222,19,58368
Mvaa 248,244,92
Mvaa 156,248,64
Mvaa 156,252,80
buffer_load_dwordx4 a[44:47], v11, s[20:23], s52 offen offset:0 sc1
Mvaa 188,248,68
Mvaa 188,252,84
Mvaa 220,248,72
Mvaa 220,252,88
Mvaa 252,248,76
s_waitcnt vmcnt(22) lgkmcnt(0)
Mvaa 252,252,92
Mvaa 128,192,96
Mvaa 128,196,112
Ta 224,20,49152
Ta 226,20,50176
Mvaa 160,192,100
buffer_load_dwordx4 v9, s[8:11], s50 offen offset:2048 lds
Mvaa 160,196,116
Mvaa 192,192,104
Ta 228,20,57344
Ta 230,20,58368
Mvaa 192,196,120
Mvaa 224,192,108
buffer_load_dwordx4 v9, s[8:11], s51 offen offset:3072 lds
Mvaa 224,196,124
Ta 232,21,49152
Ta 234,21,50176
Mvaa 132,200,96
v_xor_b32 v8, 524288, v8
v_xor_b32 v9, 524288, v9
Mvaa 132,204,112
buffer_store_dwordx4 v[116:119], v2, s[24:27], s59 offen offset:3072 sc1
Mvaa 164,200,100
Ta 236,21,57344
Ta 238,21,58368
Mvaa 164,204,116
buffer_load_dwordx4 a[48:51], v10, s[20:23], s53 offen offset:1024 sc1
Mvaa 196,200,104
Mvaa 196,204,120
Ta 240,22,49152
Ta 242,22,50176
Mvaa 228,200,108
Mvaa 228,204,124
Mvaa 136,208,96
s_waitcnt lgkmcnt(6)
Ta 244,22,57344
Ta 246,22,58368
Mvaa 136,212,112
buffer_load_dwordx4 a[52:55], v10, s[20:23], s52 offen offset:1024 sc1
Mvaa 168,208,100
Mvaa 168,212,116
Ta 248,23,49152
Ta 250,23,50176
Mvaa 200,208,104
Mvaa 200,212,120
buffer_load_dwordx4 a[56:59], v11, s[20:23], s53 offen offset:1024 sc1
Mvaa 232,208,108
Ta 252,23,57344
Ta 254,23,58368
Mvaa 232,212,124
Mvaa 140,216,96
Mvaa 140,220,112
buffer_load_dwordx4 a[60:63], v11, s[20:23], s52 offen offset:1024 sc1
Mvaa 172,216,100
s_xor_b32 s52, s52, 6144
s_add_u32 s53, s52, s58
Mvaa 172,220,116
Mvaa 204,216,104
Mvaa 204,220,120
Mvaa 236,216,108
s_waitcnt lgkmcnt(0)
Mvaa 236,220,124
s_barrier
Mvaa 144,224,96
s_add_u32 s59, s38, 43008
Mvaa 144,228,112
s_add_u32 m0, s44, 49152
Ta 192,16,0
Ta 194,16,1024
Mvaa 176,224,100
buffer_load_dwordx4 v8, s[8:11], s48 offen offset:0 lds
Mvaa 176,228,116
buffer_store_dwordx4 v[120:123], v2, s[24:27], s59 offen offset:0 sc1
Mvaa 208,224,104
Ta 196,16,8192
Ta 198,16,9216
Mvaa 208,228,120
ds_read_b64 v[56:57], v13 offset:0
ds_read_b64 v[58:59], v13 offset:512
Mvaa 240,224,108
buffer_load_dwordx4 v8, s[8:11], s49 offen offset:1024 lds
Mvaa 240,228,124
Ta 200,17,0
Ta 202,17,1024
Mvaa 148,232,96
ds_read_b64 v[60:61], v13 offset:1024
ds_read_b64 v[62:63], v13 offset:1536
Mvaa 148,236,112
Mvaa 180,232,100
Ta 204,17,8192
Ta 206,17,9216
Mvaa 180,236,116
buffer_load_dwordx4 a[64:67], v10, s[20:23], s53 offen offset:0 sc1
Mvaa 212,232,104
s_waitcnt lgkmcnt(2)
v_max_u32 v14, v56, v57
v_min_u32 v15, v56, v57
Mvaa 212,236,120
Ta 208,18,0
Ta 210,18,1024
Mvaa 244,232,108
v_med3_u32 v15, v14, v15, v58
v_max_u32_e64 v14, v14, v58
Mvaa 244,236,124
v_med3_u32 v15, v14, v15, v59
v_max_u32_e64 v14, v14, v59
Mvaa 152,240,96
s_waitcnt lgkmcnt(6)
Ta 212,18,8192
Ta 214,18,9216
Mvaa 152,244,112
buffer_load_dwordx4 a[68:71], v10, s[20:23], s52 offen offset:0 sc1
Mvaa 184,240,100
v_med3_u32 v15, v14, v15, v60
v_max_u32 v14, v14, v60
Mvaa 184,244,116
Ta 216,19,0
Ta 218,19,1024
Mvaa 216,240,104
v_med3_u32 v15, v14, v15, v61
v_max_u32_e64 v14, v14, v61
Mvaa 216,244,120
buffer_load_dwordx4 a[72:75], v11, s[20:23], s53 offen offset:0 sc1
Mvaa 248,240,108
Ta 220,19,8192
Ta 222,19,9216
Mvaa 248,244,124
v_med3_u32 v15, v14, v15, v62
v_max_u32_e64 v14, v14, v62
Mvaa 156,248,96
v_med3_u32 v15, v14, v15, v63
v_max_u32_e64 v14, v14, v63
Mvaa 156,252,112
buffer_load_dwordx4 a[76:79], v11, s[20:23], s52 offen offset:0 sc1
Mvaa 188,248,100
v_mov_b32_e64 v13, v14
Mvaa 188,252,116
buffer_store_dwordx4 v[124:127], v2, s[24:27], s59 offen offset:1024 sc1
Mvaa 220,248,104
v_max_u32_dpp v13, v13, v13 quad_perm:[1,0,3,2] row_mask:0xf bank_mask:0xf
Mvaa 220,252,120
Mvaa 252,248,108
s_waitcnt vmcnt(22) lgkmcnt(0)
Mvaa 252,252,124
Mvaa 128,192,0
v_max_u32_dpp v13, v13, v13 quad_perm:[2,3,0,1] row_mask:0xf bank_mask:0xf
Mvaa 128,196,16
Ta 224,20,0
Ta 226,20,1024
Mvaa 160,192,4
buffer_load_dwordx4 v9, s[8:11], s50 offen offset:2048 lds
Mvaa 160,196,20
v_max_u32_dpp v13, v13, v13 row_half_mirror row_mask:0xf bank_mask:0xf
Mvaa 192,192,8
Ta 228,20,8192
Ta 230,20,9216
Mvaa 192,196,24
v_max_u32_dpp v13, v13, v13 row_mirror row_mask:0xf bank_mask:0xf
Mvaa 224,192,12
buffer_load_dwordx4 v9, s[8:11], s51 offen offset:3072 lds
Mvaa 224,196,28
Ta 232,21,0
Ta 234,21,1024
Mvaa 132,200,0
v_xor_b32 v8, 3670016, v8
v_xor_b32 v9, 3670016, v9
Mvaa 132,204,16
v_readlane_b32 s3, v13, 0
v_readlane_b32 s47, v13, 16
Mvaa 164,200,4
Ta 236,21,8192
Ta 238,21,9216
Mvaa 164,204,20
buffer_load_dwordx4 a[80:83], v10, s[20:23], s53 offen offset:1024 sc1
Mvaa 196,200,8
v_readlane_b32 s4, v13, 32
v_readlane_b32 s5, v13, 48
Mvaa 196,204,24
Ta 240,22,0
Ta 242,22,1024
Mvaa 228,200,12
s_max_u32 s3, s3, s47
s_max_u32 s4, s4, s5
s_max_u32 s40, s3, s4
Mvaa 228,204,28
v_cmp_eq_u32 vcc, s40, v14
Mvaa 136,208,0
s_waitcnt lgkmcnt(6)
Ta 244,22,8192
Ta 246,22,9216
Mvaa 136,212,16
buffer_load_dwordx4 a[84:87], v10, s[20:23], s52 offen offset:1024 sc1
Mvaa 168,208,4
v_cndmask_b32 v13, v14, v15, vcc
Mvaa 168,212,20
Ta 248,23,0
Ta 250,23,1024
Mvaa 200,208,8
v_max_u32_dpp v13, v13, v13 quad_perm:[1,0,3,2] row_mask:0xf bank_mask:0xf
Mvaa 200,212,24
buffer_load_dwordx4 a[88:91], v11, s[20:23], s53 offen offset:1024 sc1
Mvaa 232,208,12
Ta 252,23,8192
Ta 254,23,9216
Mvaa 232,212,28
buffer_store_dwordx4 v[24:27], v2, s[24:27], s59 offen offset:2048 sc1
Mvaa 140,216,0
v_max_u32_dpp v13, v13, v13 quad_perm:[2,3,0,1] row_mask:0xf bank_mask:0xf
Mvaa 140,220,16
buffer_load_dwordx4 a[92:95], v11, s[20:23], s52 offen offset:1024 sc1
Mvaa 172,216,4
s_xor_b32 s52, s52, 2048
s_add_u32 s53, s52, s58
Mvaa 172,220,20
v_max_u32_dpp v13, v13, v13 row_half_mirror row_mask:0xf bank_mask:0xf
Mvaa 204,216,8
s_nop 0
v_max_u32_dpp v13, v13, v13 row_mirror row_mask:0xf bank_mask:0xf
Mvaa 204,220,24
Mvaa 236,216,12
s_waitcnt lgkmcnt(0)
Mvaa 236,220,28
s_barrier
Mvaa 144,224,0
v_readlane_b32 s3, v13, 0
v_readlane_b32 s47, v13, 16
Mvaa 144,228,16
s_add_u32 m0, s44, 0
Ta 192,16,16384
Ta 194,16,17408
Mvaa 176,224,4
buffer_load_dwordx4 v8, s[8:11], s48 offen offset:0 lds
Mvaa 176,228,20
v_readlane_b32 s4, v13, 32
v_readlane_b32 s5, v13, 48
Mvaa 208,224,8
Ta 196,16,24576
Ta 198,16,25600
Mvaa 208,228,24
s_max_u32 s3, s3, s47
s_max_u32 s4, s4, s5
s_max_u32 s41, s3, s4
Mvaa 240,224,12
buffer_load_dwordx4 v8, s[8:11], s49 offen offset:1024 lds
Mvaa 240,228,28
Ta 200,17,16384
Ta 202,17,17408
Mvaa 148,232,0
s_and_b32 s3, s40, 0xffff
s_sub_u32 s42, 0xffff, s3
s_and_b32 s3, s41, 0xffff
Mvaa 148,236,16
s_sub_u32 s43, 0xffff, s3
v_mov_b32 v60, s40
v_not_b32_e64 v61, v60
Mvaa 180,232,4
Ta 204,17,24576
Ta 206,17,25600
Mvaa 180,236,20
buffer_load_dwordx4 a[96:99], v10, s[20:23], s53 offen offset:0 sc1
Mvaa 212,232,8
v_ashrrev_i32_e64 v61, 31, v61
v_or_b32 v61, 0x80000000, v61
Mvaa 212,236,24
Ta 208,18,16384
Ta 210,18,17408
Mvaa 244,232,12
v_xor_b32_e64 v60, v60, v61
v_and_b32 v60, 0xffff0000, v60
Mvaa 244,236,28
v_mul_f32 v60, 0xbfb8aa3b, v60
Mvaa 152,240,0
s_waitcnt lgkmcnt(6)
Ta 212,18,24576
Ta 214,18,25600
Mvaa 152,244,16
buffer_load_dwordx4 a[100:103], v10, s[20:23], s52 offen offset:0 sc1
Mvaa 184,240,4
buffer_store_dwordx4 v[28:31], v2, s[24:27], s59 offen offset:3072 sc1
Mvaa 184,244,20
Ta 216,19,16384
Ta 218,19,17408
Mvaa 216,240,8
Ve 60,60
Mvaa 216,244,24
buffer_load_dwordx4 a[104:107], v11, s[20:23], s53 offen offset:0 sc1
Mvaa 248,240,12
Ta 220,19,24576
Ta 222,19,25600
Mvaa 248,244,28
v_add_f32_e64 v60, 1.0, v60
Mvaa 156,248,0
v_rcp_f32_e64 v60, v60
Mvaa 156,252,16
buffer_load_dwordx4 a[108:111], v11, s[20:23], s52 offen offset:0 sc1
Mvaa 188,248,4
Vc 60,60,60
v_and_b32 v64, 0xffff0000, v60
Mvaa 188,252,20
v_mov_b32 v60, s41
v_not_b32 v61, v60
Mvaa 220,248,8
v_ashrrev_i32_e64 v61, 31, v61
v_or_b32 v61, 0x80000000, v61
Mvaa 220,252,24
v_xor_b32_e64 v60, v60, v61
v_and_b32 v60, 0xffff0000, v60
Mvaa 252,248,12
s_waitcnt vmcnt(22) lgkmcnt(0)
v_mul_f32 v60, 0xbfb8aa3b, v60
Mvaa 252,252,28
Ve 60,60
Mvaa 128,192,32
v_add_f32_e64 v60, 1.0, v60
Mvaa 128,196,48
Ta 224,20,16384
Ta 226,20,17408
Mvaa 160,192,36
buffer_load_dwordx4 v9, s[8:11], s50 offen offset:2048 lds
Mvaa 160,196,52
v_rcp_f32_e64 v60, v60
Mvaa 192,192,40
Ta 228,20,24576
Ta 230,20,25600
Mvaa 192,196,56
Vc 60,60,60
v_and_b32 v65, 0xffff0000, v60
Mvaa 224,192,44
buffer_load_dwordx4 v9, s[8:11], s51 offen offset:3072 lds
Mvaa 224,196,60
Ta 232,21,16384
Ta 234,21,17408
Mvaa 132,200,32
v_xor_b32 v8, 524288, v8
v_xor_b32 v9, 524288, v9
Mvaa 132,204,48
v_mov_b32 v48, 0
v_mov_b32 v49, 0
Mvaa 164,200,36
Ta 236,21,24576
Ta 238,21,25600
Mvaa 164,204,52
buffer_load_dwordx4 a[112:115], v10, s[20:23], s53 offen offset:1024 sc1
Mvaa 196,200,40
s_add_u32 s59, s38, 47104
Mvaa 196,204,56
Ta 240,22,16384
Ta 242,22,17408
Mvaa 228,200,44
buffer_store_dwordx4 v[32:35], v2, s[24:27], s59 offen offset:0 sc1
Mvaa 228,204,60
v_mov_b32 v50, 0
v_mov_b32 v51, 0
Mvaa 136,208,32
s_waitcnt lgkmcnt(6)
Ta 244,22,24576
Ta 246,22,25600
Mvaa 136,212,48
buffer_load_dwordx4 a[116:119], v10, s[20:23], s52 offen offset:1024 sc1
Mvaa 168,208,36
v_mov_b32 v52, 0
v_mov_b32_e64 v53, 0
Mvaa 168,212,52
Ta 248,23,16384
Ta 250,23,17408
Mvaa 200,208,40
v_mov_b32 v54, 0
v_mov_b32 v55, 0
Mvaa 200,212,56
buffer_load_dwordx4 a[120:123], v11, s[20:23], s53 offen offset:1024 sc1
Mvaa 232,208,44
Ta 252,23,24576
Ta 254,23,25600
Mvaa 232,212,60
v_mov_b32 v56, 0
v_mov_b32 v57, 0
Mvaa 140,216,32
v_mov_b32 v58, 0
v_mov_b32 v59, 0
Mvaa 140,220,48
buffer_load_dwordx4 a[124:127], v11, s[20:23], s52 offen offset:1024 sc1
Mvaa 172,216,36
s_xor_b32 s52, s52, 14336
s_add_u32 s53, s52, s58
Mvaa 172,220,52
v_mov_b32 v60, 0
v_mov_b32_e64 v61, 0
Mvaa 204,216,40
v_mov_b32 v62, 0
v_mov_b32 v63, 0
Mvaa 204,220,56
Mvaa 236,216,44
s_waitcnt lgkmcnt(0)
Mvaa 236,220,60
s_barrier
Mvaa 144,224,32
s_mul_i32 s3, s34, s34
s_mul_i32 s47, s33, 48
s_add_u32 s3, s3, s47
Mvaa 144,228,48
s_add_u32 m0, s44, 16384
Ta 192,16,32768
Ta 194,16,33792
Mvaa 176,224,36
buffer_load_dwordx4 v8, s[8:11], s48 offen offset:0 lds
Mvaa 176,228,52
s_lshl_b32 s3, s3, 2
s_add_u32 s3, s3, s32
s_lshl_b32 s3, s3, 7
Mvaa 208,224,40
Ta 196,16,40960
Ta 198,16,41984
Mvaa 208,228,56
s_sub_u32 s3, s3, 8704
s_cmp_ge_u32 s34, 4
s_cselect_b32 s3, s3, 0
s_cselect_b32 s40, 512, 0
s_cselect_b32 s47, 786432, 0
Mvaa 240,224,44
buffer_load_dwordx4 v8, s[8:11], s49 offen offset:1024 lds
Mvaa 240,228,60
Ta 200,17,32768
Ta 202,17,33792
Mvaa 148,232,32
buffer_store_dwordx4 v[36:39], v2, s[24:27], s59 offen offset:1024 sc1
Mvaa 148,236,48
v_subrev_u32_e64 v31, 0, v0
v_mul_lo_u32 v31, v31, s47
Mvaa 180,232,36
Ta 204,17,40960
Ta 206,17,41984
Mvaa 180,236,52
buffer_load_dwordx4 a[0:3], v10, s[20:23], s53 offen offset:0 sc1
Mvaa 212,232,40
v_min_u32 v31, 6553600, v31
v_mov_b32_e64 v28, s94
Mvaa 212,236,56
Ta 208,18,32768
Ta 210,18,33792
Mvaa 244,232,44
v_mov_b32 v29, s95
v_mov_b32 v30, v31
Mvaa 244,236,60
v_subrev_u32_e64 v31, 10, v0
v_mul_lo_u32 v31, v31, s47
Mvaa 152,240,32
s_waitcnt lgkmcnt(6)
Ta 212,18,40960
Ta 214,18,41984
Mvaa 152,244,48
buffer_load_dwordx4 a[4:7], v10, s[20:23], s52 offen offset:0 sc1
Mvaa 184,240,36
v_min_u32 v31, 6553600, v31
v_mov_b32 v14, s68
Mvaa 184,244,52
Ta 216,19,32768
Ta 218,19,33792
Mvaa 216,240,40
v_mov_b32_e64 v15, s69
Mvaa 216,244,56
buffer_load_dwordx4 a[8:11], v11, s[20:23], s53 offen offset:0 sc1
Mvaa 248,240,44
Ta 220,19,40960
Ta 222,19,41984
Mvaa 248,244,60
v_cmp_le_u32 vcc, 10, v0
Mvaa 156,248,32
s_nop 0
v_cndmask_b32 v28, v28, v14, vcc
v_cndmask_b32 v29, v29, v15, vcc
Mvaa 156,252,48
buffer_load_dwordx4 a[12:15], v11, s[20:23], s52 offen offset:0 sc1
Mvaa 188,248,36
v_cndmask_b32 v30, v30, v31, vcc
Mvaa 188,252,52
v_subrev_u32 v31, 20, v0
v_mul_lo_u32 v31, v31, s47
Mvaa 220,248,40
v_min_u32 v31, 7602176, v31
v_mov_b32_e64 v14, s92
Mvaa 220,252,56
v_mov_b32_e64 v15, s93
Mvaa 252,248,44
s_waitcnt vmcnt(21) lgkmcnt(0)
Mvaa 252,252,60
Mvaa 128,192,64
buffer_store_dwordx4 v[40:43], v2, s[24:27], s59 offen offset:2048 sc1
Mvaa 128,196,80
Ta 224,20,32768
Ta 226,20,33792
Mvaa 160,192,68
buffer_load_dwordx4 v9, s[8:11], s50 offen offset:2048 lds
Mvaa 160,196,84
v_cmp_le_u32 vcc, 20, v0
Mvaa 192,192,72
Ta 228,20,40960
Ta 230,20,41984
Mvaa 192,196,88
v_cndmask_b32 v28, v28, v14, vcc
v_cndmask_b32 v29, v29, v15, vcc
Mvaa 224,192,76
buffer_load_dwordx4 v9, s[8:11], s51 offen offset:3072 lds
Mvaa 224,196,92
Ta 232,21,32768
Ta 234,21,33792
Mvaa 132,200,64
v_xor_b32 v8, 1572864, v8
v_xor_b32 v9, 1572864, v9
Mvaa 132,204,80
v_cndmask_b32 v30, v30, v31, vcc
Mvaa 164,200,68
Ta 236,21,40960
Ta 238,21,41984
Mvaa 164,204,84
buffer_load_dwordx4 a[16:19], v10, s[20:23], s53 offen offset:1024 sc1
Mvaa 196,200,72
v_add_u32 v30, s3, v30
v_ashrrev_i32_e64 v31, 31, v30
Mvaa 196,204,88
Ta 240,22,32768
Ta 242,22,33792
Mvaa 228,200,76
v_lshl_add_u64 v[28:29], v[30:31], 0, v[28:29]
Mvaa 228,204,92
s_mov_b32 s41, 0
v_readfirstlane_b32 s100, v64
v_readfirstlane_b32 s101, v65
Mvaa 136,208,64
s_waitcnt lgkmcnt(6)
Ta 244,22,40960
Ta 246,22,41984
Mvaa 136,212,80
buffer_load_dwordx4 a[20:23], v10, s[20:23], s52 offen offset:1024 sc1
Mvaa 168,208,68
Mvaa 168,212,84
Ta 248,23,32768
Ta 250,23,33792
Mvaa 200,208,72
Mvaa 200,212,88
buffer_load_dwordx4 a[24:27], v11, s[20:23], s53 offen offset:1024 sc1
Mvaa 232,208,76
Ta 252,23,40960
Ta 254,23,41984
Mvaa 232,212,92
Mvaa 140,216,64
Mvaa 140,220,80
buffer_load_dwordx4 a[28:31], v11, s[20:23], s52 offen offset:1024 sc1
Mvaa 172,216,68
s_xor_b32 s52, s52, 2048
s_add_u32 s53, s52, s58
Mvaa 172,220,84
buffer_store_dwordx4 v[44:47], v2, s[24:27], s59 offen offset:3072 sc1
Mvaa 204,216,72
v_mov_b32 v12, 1
v_and_b32_e64 v1, 15, v0
Mvaa 204,220,88
v_lshlrev_b32_e64 v1, 2, v1
Mvaa 236,216,76
s_waitcnt lgkmcnt(0)
Mvaa 236,220,92
s_barrier
Mvaa 144,224,64
s_lshr_b32 s6, s33, 1
s_lshl_b32 s6, s6, 7
s_add_u32 s6, s6, 5296128
Mvaa 144,228,80
s_add_u32 m0, s44, 32768
Ta 192,16,49152
Ta 194,16,50176
Mvaa 176,224,68
buffer_load_dwordx4 v8, s[8:11], s48 offen offset:0 lds
Mvaa 176,228,84
s_cmp_eq_u32 s32, 0
s_cselect_b32 s6, s6, 2146435072
Mvaa 208,224,72
Ta 196,16,57344
Ta 198,16,58368
Mvaa 208,228,88
Mvaa 240,224,76
buffer_load_dwordx4 v8, s[8:11], s49 offen offset:1024 lds
Mvaa 240,228,92
Ta 200,17,49152
Ta 202,17,50176
Mvaa 148,232,64
Mvaa 148,236,80
Mvaa 180,232,68
Ta 204,17,57344
Ta 206,17,58368
Mvaa 180,236,84
buffer_load_dwordx4 a[32:35], v10, s[20:23], s53 offen offset:0 sc1
Mvaa 212,232,72
Mvaa 212,236,88
Ta 208,18,49152
Ta 210,18,50176
Mvaa 244,232,76
Mvaa 244,236,92
Mvaa 152,240,64
s_waitcnt lgkmcnt(6)
Ta 212,18,57344
Ta 214,18,58368
Mvaa 152,244,80
buffer_load_dwordx4 a[36:39], v10, s[20:23], s52 offen offset:0 sc1
Mvaa 184,240,68
Mvaa 184,244,84
Ta 216,19,49152
Ta 218,19,50176
Mvaa 216,240,72
Mvaa 216,244,88
buffer_load_dwordx4 a[40:43], v11, s[20:23], s53 offen offset:0 sc1
Mvaa 248,240,76
Ta 220,19,57344
Ta 222,19,58368
Mvaa 248,244,92
Mvaa 156,248,64
Mvaa 156,252,80
buffer_load_dwordx4 a[44:47], v11, s[20:23], s52 offen offset:0 sc1
Mvaa 188,248,68
Mvaa 188,252,84
Mvaa 220,248,72
Mvaa 220,252,88
Mvaa 252,248,76
s_waitcnt vmcnt(21) lgkmcnt(0)
Mvaa 252,252,92
Mvaa 128,192,96
v_accvgpr_write_b32 a64, 0
v_accvgpr_write_b32 a65, 0
Mvaa 128,196,112
Ta 224,20,49152
Ta 226,20,50176
Mvaa 160,192,100
buffer_load_dwordx4 v9, s[8:11], s50 offen offset:2048 lds
Mvaa 160,196,116
v_accvgpr_write_b32 a66, 0
v_accvgpr_write_b32 a67, 0
Mvaa 192,192,104
Ta 228,20,57344
Ta 230,20,58368
Mvaa 192,196,120
v_accvgpr_write_b32 a68, 0
v_accvgpr_write_b32 a69, 0
Mvaa 224,192,108
buffer_load_dwordx4 v9, s[8:11], s51 offen offset:3072 lds
Mvaa 224,196,124
Ta 232,21,49152
Ta 234,21,50176
Mvaa 132,200,96
v_xor_b32 v8, 524288, v8
v_xor_b32 v9, 524288, v9
Mvaa 132,204,112
v_accvgpr_write_b32 a70, 0
v_accvgpr_write_b32 a71, 0
Mvaa 164,200,100
Ta 236,21,57344
Ta 238,21,58368
Mvaa 164,204,116
buffer_load_dwordx4 a[48:51], v10, s[20:23], s53 offen offset:1024 sc1
Mvaa 196,200,104
v_accvgpr_write_b32 a72, 0
v_accvgpr_write_b32 a73, 0
Mvaa 196,204,120
Ta 240,22,49152
Ta 242,22,50176
Mvaa 228,200,108
v_accvgpr_write_b32 a74, 0
v_accvgpr_write_b32 a75, 0
Mvaa 228,204,124
v_accvgpr_write_b32 a76, 0
v_accvgpr_write_b32 a77, 0
Mvaa 136,208,96
s_waitcnt lgkmcnt(6)
Ta 244,22,57344
Ta 246,22,58368
Mvaa 136,212,112
buffer_load_dwordx4 a[52:55], v10, s[20:23], s52 offen offset:1024 sc1
Mvaa 168,208,100
v_accvgpr_write_b32 a78, 0
v_accvgpr_write_b32 a79, 0
Mvaa 168,212,116
Ta 248,23,49152
Ta 250,23,50176
Mvaa 200,208,104
Mvaa 200,212,120
buffer_load_dwordx4 a[56:59], v11, s[20:23], s53 offen offset:1024 sc1
Mvaa 232,208,108
Ta 252,23,57344
Ta 254,23,58368
Mvaa 232,212,124
Mvaa 140,216,96
Mvaa 140,220,112
buffer_load_dwordx4 a[60:63], v11, s[20:23], s52 offen offset:1024 sc1
Mvaa 172,216,100
s_xor_b32 s52, s52, 6144
s_add_u32 s53, s52, s58
Mvaa 172,220,116
Mvaa 204,216,104
Mvaa 204,220,120
Mvaa 236,216,108
s_waitcnt lgkmcnt(0)
Mvaa 236,220,124
s_barrier
Mvaa 144,224,96
v_accvgpr_write_b32 a80, 0
v_accvgpr_write_b32 a81, 0
Mvaa 144,228,112
s_add_u32 m0, s44, 49152
Ta 192,16,0
Ta 194,16,1024
Mvaa 176,224,100
buffer_load_dwordx4 v8, s[8:11], s48 offen offset:0 lds
Mvaa 176,228,116
v_accvgpr_write_b32 a82, 0
v_accvgpr_write_b32 a83, 0
Mvaa 208,224,104
Ta 196,16,8192
Ta 198,16,9216
Mvaa 208,228,120
v_accvgpr_write_b32 a84, 0
v_accvgpr_write_b32 a85, 0
Mvaa 240,224,108
buffer_load_dwordx4 v8, s[8:11], s49 offen offset:1024 lds
Mvaa 240,228,124
Ta 200,17,0
Ta 202,17,1024
Mvaa 148,232,96
v_accvgpr_write_b32 a86, 0
v_accvgpr_write_b32 a87, 0
Mvaa 148,236,112
v_accvgpr_write_b32 a88, 0
v_accvgpr_write_b32 a89, 0
Mvaa 180,232,100
Ta 204,17,8192
Ta 206,17,9216
Mvaa 180,236,116
buffer_load_dwordx4 a[128:131], v10, s[20:23], s53 offen offset:0 sc1
Mvaa 212,232,104
v_accvgpr_write_b32 a90, 0
v_accvgpr_write_b32 a91, 0
Mvaa 212,236,120
Ta 208,18,0
Ta 210,18,1024
Mvaa 244,232,108
v_accvgpr_write_b32 a92, 0
v_accvgpr_write_b32 a93, 0
Mvaa 244,236,124
v_accvgpr_write_b32 a94, 0
v_accvgpr_write_b32 a95, 0
Mvaa 152,240,96
s_waitcnt lgkmcnt(6)
Ta 212,18,8192
Ta 214,18,9216
Mvaa 152,244,112
buffer_load_dwordx4 a[144:147], v10, s[20:23], s52 offen offset:0 sc1
Mvaa 184,240,100
Mvaa 184,244,116
Ta 216,19,0
Ta 218,19,1024
Mvaa 216,240,104
Mvaa 216,244,120
buffer_load_dwordx4 a[160:163], v11, s[20:23], s53 offen offset:0 sc1
Mvaa 248,240,108
Ta 220,19,8192
Ta 222,19,9216
Mvaa 248,244,124
Mvaa 156,248,96
Mvaa 156,252,112
buffer_load_dwordx4 a[176:179], v11, s[20:23], s52 offen offset:0 sc1
Mvaa 188,248,100
Mvaa 188,252,116
Mvaa 220,248,104
Mvaa 220,252,120
Mvaa 252,248,108
s_waitcnt vmcnt(19) lgkmcnt(0)
Mvaa 252,252,124
Mvaa 128,192,0
v_accvgpr_write_b32 a96, 0
v_accvgpr_write_b32 a97, 0
Mvaa 128,196,16
Ta 224,20,0
Ta 226,20,1024
Mvaa 160,192,4
buffer_load_dwordx4 v9, s[8:11], s50 offen offset:2048 lds
Mvaa 160,196,20
v_accvgpr_write_b32 a98, 0
v_accvgpr_write_b32 a99, 0
Mvaa 192,192,8
Ta 228,20,8192
Ta 230,20,9216
Mvaa 192,196,24
v_accvgpr_write_b32 a100, 0
v_accvgpr_write_b32 a101, 0
Mvaa 224,192,12
buffer_load_dwordx4 v9, s[8:11], s51 offen offset:3072 lds
Mvaa 224,196,28
Ta 232,21,0
Ta 234,21,1024
Mvaa 132,200,0
v_xor_b32 v8, 7864320, v8
v_xor_b32 v9, 7864320, v9
Mvaa 132,204,16
v_accvgpr_write_b32 a102, 0
v_accvgpr_write_b32 a103, 0
Mvaa 164,200,4
Ta 236,21,8192
Ta 238,21,9216
Mvaa 164,204,20
buffer_load_dwordx4 a[132:135], v10, s[20:23], s53 offen offset:1024 sc1
Mvaa 196,200,8
v_accvgpr_write_b32 a104, 0
v_accvgpr_write_b32 a105, 0
Mvaa 196,204,24
Ta 240,22,0
Ta 242,22,1024
Mvaa 228,200,12
v_accvgpr_write_b32 a106, 0
v_accvgpr_write_b32 a107, 0
Mvaa 228,204,28
v_accvgpr_write_b32 a108, 0
v_accvgpr_write_b32 a109, 0
Mvaa 136,208,0
s_waitcnt lgkmcnt(6)
Ta 244,22,8192
Ta 246,22,9216
Mvaa 136,212,16
buffer_load_dwordx4 a[148:151], v10, s[20:23], s52 offen offset:1024 sc1
Mvaa 168,208,4
v_accvgpr_write_b32 a110, 0
v_accvgpr_write_b32 a111, 0
Mvaa 168,212,20
Ta 248,23,0
Ta 250,23,1024
Mvaa 200,208,8
Mvaa 200,212,24
buffer_load_dwordx4 a[164:167], v11, s[20:23], s53 offen offset:1024 sc1
Mvaa 232,208,12
Ta 252,23,8192
Ta 254,23,9216
Mvaa 232,212,28
Mvaa 140,216,0
Mvaa 140,220,16
buffer_load_dwordx4 a[180:183], v11, s[20:23], s52 offen offset:1024 sc1
Mvaa 172,216,4
s_xor_b32 s52, s52, 2048
s_add_u32 s53, s52, s58
Mvaa 172,220,20
Mvaa 204,216,8
Mvaa 204,220,24
Mvaa 236,216,12
s_waitcnt vmcnt(24) lgkmcnt(0)
Mvaa 236,220,28
s_barrier
Mvaa 144,224,0
s_mov_b64 exec, 1
buffer_store_dword v12, v7, s[20:23], s39 offen sc1
s_mov_b64 exec, -1
Mvaa 144,228,16
Ta 192,16,16384
Ta 194,16,17408
Mvaa 176,224,4
buffer_load_dwordx4 a[136:139], v10, s[20:23], s53 offen offset:0 sc1
Mvaa 176,228,20
s_mov_b32 s24, s60
s_mov_b32 s25, s61
s_mov_b32 s26, s62
Mvaa 208,224,8
Ta 196,16,24576
Ta 198,16,25600
Mvaa 208,228,24
s_add_u32 s93, s2, 224
s_and_b32 s93, s93, 255
s_mul_i32 s92, s93, 2341
Mvaa 240,224,12
s_lshr_b32 s92, s92, 16
s_mul_i32 s47, s92, 28
s_sub_u32 s4, s93, s47
Mvaa 240,228,28
Ta 200,17,16384
Ta 202,17,17408
Mvaa 148,232,0
s_mul_i32 s5, s92, 917504
s_lshl_b32 s47, s4, 8
s_add_u32 s5, s5, s47
Mvaa 148,236,16
buffer_load_dwordx4 a[152:155], v10, s[20:23], s52 offen offset:0 sc1
Mvaa 180,232,4
Ta 204,17,24576
Ta 206,17,25600
Mvaa 180,236,20
v_lshrrev_b32 v24, 4, v0
v_and_b32_e64 v25, 15, v0
Mvaa 212,232,8
s_lshl_b32 s3, s32, 4
v_add_u32 v26, s3, v24
v_mul_u32_u24 v26, 7168, v26
Mvaa 212,236,24
Ta 208,18,16384
Ta 210,18,17408
Mvaa 244,232,12
v_lshlrev_b32 v24, 1, v24
v_xor_b32 v24, v24, v25
Mvaa 244,236,28
v_lshl_add_u32 v24, v24, 4, v26
v_xor_b32 v25, 128, v24
Mvaa 152,240,0
s_waitcnt lgkmcnt(6)
Ta 212,18,24576
Ta 214,18,25600
Mvaa 152,244,16
buffer_load_dwordx4 a[168:171], v11, s[20:23], s53 offen offset:0 sc1
Mvaa 184,240,4
s_mov_b32 s94, 1040356334
s_mov_b32 s95, 1040356334
s_sub_u32 s55, 15, s34
Mvaa 184,244,20
Ta 216,19,16384
Ta 218,19,17408
Mvaa 216,240,8
s_sub_u32 s45, s36, 3
s_sub_u32 s46, s35, 3
s_mov_b32 s54, s44
Mvaa 216,244,24
s_sub_u32 s35, s35, 2
s_sub_u32 s36, s36, 2
Mvaa 248,240,12
Ta 220,19,24576
Ta 222,19,25600
Mvaa 248,244,28
v_accvgpr_write_b32 a112, 0
v_accvgpr_write_b32 a113, 0
Mvaa 156,248,0
buffer_load_dwordx4 a[184:187], v11, s[20:23], s52 offen offset:0 sc1
Mvaa 156,252,16
v_accvgpr_write_b32 a114, 0
v_accvgpr_write_b32 a115, 0
Mvaa 188,248,4
v_accvgpr_write_b32 a116, 0
v_accvgpr_write_b32 a117, 0
Mvaa 188,252,20
v_accvgpr_write_b32 a118, 0
v_accvgpr_write_b32 a119, 0
Mvaa 220,248,8
v_accvgpr_write_b32 a120, 0
v_accvgpr_write_b32 a121, 0
Mvaa 220,252,24
v_accvgpr_write_b32 a122, 0
v_accvgpr_write_b32 a123, 0
Mvaa 252,248,12
s_waitcnt vmcnt(17) lgkmcnt(0)
v_accvgpr_write_b32 a124, 0
v_accvgpr_write_b32 a125, 0
Mvaa 252,252,28
v_accvgpr_write_b32 a126, 0
v_accvgpr_write_b32 a127, 0
Mvaa 128,192,32
v_accvgpr_write_b32 a0, 0
v_accvgpr_write_b32 a1, 0
Mvaa 128,196,48
Ta 224,20,16384
Ta 226,20,17408
Mvaa 160,192,36
buffer_load_dwordx4 a[140:143], v10, s[20:23], s53 offen offset:1024 sc1
Mvaa 160,196,52
v_accvgpr_write_b32 a2, 0
v_accvgpr_write_b32 a3, 0
Mvaa 192,192,40
Ta 228,20,24576
Ta 230,20,25600
Mvaa 192,196,56
v_accvgpr_write_b32 a4, 0
v_accvgpr_write_b32 a5, 0
Mvaa 224,192,44
v_accvgpr_write_b32 a6, 0
v_accvgpr_write_b32 a7, 0
Mvaa 224,196,60
Ta 232,21,16384
Ta 234,21,17408
Mvaa 132,200,32
v_accvgpr_write_b32 a8, 0
v_accvgpr_write_b32 a9, 0
Mvaa 132,204,48
buffer_load_dwordx4 a[156:159], v10, s[20:23], s52 offen offset:1024 sc1
Mvaa 164,200,36
Ta 236,21,24576
Ta 238,21,25600
Mvaa 164,204,52
v_accvgpr_write_b32 a10, 0
v_accvgpr_write_b32 a11, 0
Mvaa 196,200,40
v_accvgpr_write_b32 a12, 0
v_accvgpr_write_b32 a13, 0
Mvaa 196,204,56
Ta 240,22,16384
Ta 242,22,17408
Mvaa 228,200,44
v_accvgpr_write_b32 a14, 0
v_accvgpr_write_b32 a15, 0
Mvaa 228,204,60
Mvaa 136,208,32
s_waitcnt lgkmcnt(6)
Ta 244,22,24576
Ta 246,22,25600
Mvaa 136,212,48
buffer_load_dwordx4 a[172:175], v11, s[20:23], s53 offen offset:1024 sc1
Mvaa 168,208,36
Mvaa 168,212,52
Ta 248,23,16384
Ta 250,23,17408
Mvaa 200,208,40
Mvaa 200,212,56
Mvaa 232,208,44
Ta 252,23,24576
Ta 254,23,25600
Mvaa 232,212,60
Mvaa 140,216,32
buffer_load_dwordx4 a[188:191], v11, s[20:23], s52 offen offset:1024 sc1
Mvaa 140,220,48
Mvaa 172,216,36
Mvaa 172,220,52
Mvaa 204,216,40
Mvaa 204,220,56
Mvaa 236,216,44
s_waitcnt lgkmcnt(0)
Mvaa 236,220,60
s_barrier
Mvaa 144,224,32
v_accvgpr_write_b32 a16, 0
v_accvgpr_write_b32 a17, 0
Mvaa 144,228,48
Ta 192,16,32768
Ta 194,16,33792
Mvaa 176,224,36
v_accvgpr_write_b32 a18, 0
v_accvgpr_write_b32 a19, 0
Mvaa 176,228,52
v_accvgpr_write_b32 a20, 0
v_accvgpr_write_b32 a21, 0
Mvaa 208,224,40
Ta 196,16,40960
Ta 198,16,41984
Mvaa 208,228,56
v_accvgpr_write_b32 a22, 0
v_accvgpr_write_b32 a23, 0
Mvaa 240,224,44
v_accvgpr_write_b32 a24, 0
v_accvgpr_write_b32 a25, 0
Mvaa 240,228,60
Ta 200,17,32768
Ta 202,17,33792
Mvaa 148,232,32
v_accvgpr_write_b32 a26, 0
v_accvgpr_write_b32 a27, 0
Mvaa 148,236,48
v_accvgpr_write_b32 a28, 0
v_accvgpr_write_b32 a29, 0
Mvaa 180,232,36
Ta 204,17,40960
Ta 206,17,41984
Mvaa 180,236,52
buffer_load_dword v12, v1, s[20:23], s6 offen sc1
Mvaa 212,232,40
s_add_u32 m0, s44, 65536
s_mov_b32 s7, 0
Mvaa 212,236,56
Ta 208,18,32768
Ta 210,18,33792
Mvaa 244,232,44
v_accvgpr_write_b32 a30, 0
v_accvgpr_write_b32 a31, 0
Mvaa 244,236,60
Mvaa 152,240,32
s_waitcnt lgkmcnt(6)
Ta 212,18,40960
Ta 214,18,41984
Mvaa 152,244,48
Mvaa 184,240,36
Mvaa 184,244,52
Ta 216,19,32768
Ta 218,19,33792
Mvaa 216,240,40
Mvaa 216,244,56
Mvaa 248,240,44
Ta 220,19,40960
Ta 222,19,41984
Mvaa 248,244,60
Mvaa 156,248,32
Mvaa 156,252,48
Mvaa 188,248,36
Mvaa 188,252,52
Mvaa 220,248,40
Mvaa 220,252,56
Mvaa 252,248,44
s_waitcnt vmcnt(10) lgkmcnt(0)
Mvaa 252,252,60
Mvaa 128,192,128
v_accvgpr_write_b32 a32, 0
v_accvgpr_write_b32 a33, 0
Mvaa 128,196,132
Ta 224,20,32768
Ta 226,20,33792
Mvaa 160,192,144
v_accvgpr_write_b32 a34, 0
v_accvgpr_write_b32 a35, 0
Mvaa 160,196,148
v_accvgpr_write_b32 a36, 0
v_accvgpr_write_b32 a37, 0
Mvaa 192,192,160
Ta 228,20,40960
Ta 230,20,41984
Mvaa 192,196,164
v_accvgpr_write_b32 a38, 0
v_accvgpr_write_b32 a39, 0
Mvaa 224,192,176
v_accvgpr_write_b32 a40, 0
v_accvgpr_write_b32 a41, 0
Mvaa 224,196,180
Ta 232,21,32768
Ta 234,21,33792
Mvaa 132,200,128
v_accvgpr_write_b32 a42, 0
v_accvgpr_write_b32 a43, 0
Mvaa 132,204,132
v_accvgpr_write_b32 a44, 0
v_accvgpr_write_b32 a45, 0
Mvaa 164,200,144
Ta 236,21,40960
Ta 238,21,41984
Mvaa 164,204,148
v_accvgpr_write_b32 a46, 0
v_accvgpr_write_b32 a47, 0
Mvaa 196,200,160
Mvaa 196,204,164
Ta 240,22,32768
Ta 242,22,33792
Mvaa 228,200,176
Mvaa 228,204,180
Mvaa 136,208,128
s_waitcnt lgkmcnt(6)
Ta 244,22,40960
Ta 246,22,41984
Mvaa 136,212,132
Mvaa 168,208,144
Mvaa 168,212,148
Ta 248,23,32768
Ta 250,23,33792
Mvaa 200,208,160
Mvaa 200,212,164
Mvaa 232,208,176
Ta 252,23,40960
Ta 254,23,41984
Mvaa 232,212,180
Mvaa 140,216,128
Mvaa 140,220,132
Mvaa 172,216,144
Mvaa 172,220,148
Mvaa 204,216,160
Mvaa 204,220,164
Mvaa 236,216,176
s_waitcnt vmcnt(0) lgkmcnt(0)
Mvaa 236,220,180
s_cmp_lg_u32 s32, 0
s_cbranch_scc1 L_spinBr
v_cmp_ne_u32 vcc, 1, v12
s_cbranch_vccnz L_spinB
L_spinBr:
s_barrier
Mvaa 144,224,128
buffer_load_dwordx4 v4, s[12:15], s7 offen offset:0 sc1 lds
Mvaa 144,228,132
Ta 192,16,49152
Ta 194,16,50176
Mvaa 176,224,144
v_accvgpr_write_b32 a48, 0
v_accvgpr_write_b32 a49, 0
Mvaa 176,228,148
buffer_load_dwordx4 v4, s[12:15], s7 offen offset:1024 sc1 lds
Mvaa 208,224,160
Ta 196,16,57344
Ta 198,16,58368
Mvaa 208,228,164
v_accvgpr_write_b32 a50, 0
v_accvgpr_write_b32 a51, 0
Mvaa 240,224,176
buffer_load_dwordx4 v4, s[12:15], s7 offen offset:2048 sc1 lds
Mvaa 240,228,180
Ta 200,17,49152
Ta 202,17,50176
Mvaa 148,232,128
v_accvgpr_write_b32 a52, 0
v_accvgpr_write_b32 a53, 0
Mvaa 148,236,132
buffer_load_dwordx4 v4, s[12:15], s7 offen offset:3072 sc1 lds
Mvaa 180,232,144
Ta 204,17,57344
Ta 206,17,58368
Mvaa 180,236,148
s_add_u32 m0, s44, 98304
s_mov_b32 s7, 34816
Mvaa 212,232,160
buffer_load_dwordx4 v4, s[12:15], s7 offen offset:0 sc1 lds
Mvaa 212,236,164
Ta 208,18,49152
Ta 210,18,50176
Mvaa 244,232,176
v_accvgpr_write_b32 a54, 0
v_accvgpr_write_b32 a55, 0
Mvaa 244,236,180
buffer_load_dwordx4 v4, s[12:15], s7 offen offset:1024 sc1 lds
Mvaa 152,240,128
s_waitcnt lgkmcnt(6)
Ta 212,18,57344
Ta 214,18,58368
Mvaa 152,244,132
v_accvgpr_write_b32 a56, 0
v_accvgpr_write_b32 a57, 0
Mvaa 184,240,144
buffer_load_dwordx4 v4, s[12:15], s7 offen offset:2048 sc1 lds
Mvaa 184,244,148
Ta 216,19,49152
Ta 218,19,50176
Mvaa 216,240,160
v_accvgpr_write_b32 a58, 0
v_accvgpr_write_b32 a59, 0
Mvaa 216,244,164
buffer_load_dwordx4 v4, s[12:15], s7 offen offset:3072 sc1 lds
Mvaa 248,240,176
Ta 220,19,57344
Ta 222,19,58368
Mvaa 248,244,180
s_add_u32 m0, s44, 81920
s_mov_b32 s7, 17408
Mvaa 156,248,128
buffer_load_dwordx4 v4, s[12:15], s7 offen offset:0 sc1 lds
Mvaa 156,252,132
v_accvgpr_write_b32 a60, 0
v_accvgpr_write_b32 a61, 0
Mvaa 188,248,144
buffer_load_dwordx4 v4, s[12:15], s7 offen offset:1024 sc1 lds
Mvaa 188,252,148
v_accvgpr_write_b32 a62, 0
v_accvgpr_write_b32 a63, 0
Mvaa 220,248,160
Mvaa 220,252,164
Mvaa 252,248,176
s_waitcnt lgkmcnt(0)
Mvaa 252,252,180
Mvaa 128,192,136
buffer_load_dwordx4 v4, s[12:15], s7 offen offset:2048 sc1 lds
Mvaa 128,196,140
Ta 224,20,49152
Ta 226,20,50176
Mvaa 160,192,152
buffer_load_dwordx4 v4, s[12:15], s7 offen offset:3072 sc1 lds
Mvaa 160,196,156
s_add_u32 m0, s44, 114688
s_mov_b32 s7, 52224
Mvaa 192,192,168
Ta 228,20,57344
Ta 230,20,58368
Mvaa 192,196,172
buffer_load_dwordx4 v4, s[12:15], s7 offen offset:0 sc1 lds
Mvaa 224,192,184
buffer_load_dwordx4 v4, s[12:15], s7 offen offset:1024 sc1 lds
Mvaa 224,196,188
Ta 232,21,49152
Ta 234,21,50176
Mvaa 132,200,136
Mvaa 132,204,140
buffer_load_dwordx4 v4, s[12:15], s7 offen offset:2048 sc1 lds
Mvaa 164,200,152
Ta 236,21,57344
Ta 238,21,58368
Mvaa 164,204,156
Mvaa 196,200,168
buffer_load_dwordx4 v4, s[12:15], s7 offen offset:3072 sc1 lds
Mvaa 196,204,172
Ta 240,22,49152
Ta 242,22,50176
Mvaa 228,200,184
s_add_u32 m0, s44, 0
s_mov_b32 s7, 69632
Mvaa 228,204,188
buffer_load_dwordx4 v4, s[12:15], s7 offen offset:0 sc1 lds
Mvaa 136,208,136
s_waitcnt lgkmcnt(6)
Ta 244,22,57344
Ta 246,22,58368
Mvaa 136,212,140
buffer_load_dwordx4 v4, s[12:15], s7 offen offset:1024 sc1 lds
Mvaa 168,208,152
Mvaa 168,212,156
Ta 248,23,49152
Ta 250,23,50176
Mvaa 200,208,168
buffer_load_dwordx4 v4, s[12:15], s7 offen offset:2048 sc1 lds
Mvaa 200,212,172
Mvaa 232,208,184
Ta 252,23,57344
Ta 254,23,58368
Mvaa 232,212,188
buffer_load_dwordx4 v4, s[12:15], s7 offen offset:3072 sc1 lds
Mvaa 140,216,136
s_add_u32 m0, s44, 16384
s_mov_b32 s7, 87040
Mvaa 140,220,140
Mvaa 172,216,152
buffer_load_dwordx4 v4, s[12:15], s7 offen offset:0 sc1 lds
Mvaa 172,220,156
Mvaa 204,216,168
Mvaa 204,220,172
Mvaa 236,216,184
s_waitcnt vmcnt(17) lgkmcnt(0)
Mvaa 236,220,188
s_barrier
Mvaa 144,224,136
buffer_load_dwordx4 v4, s[12:15], s7 offen offset:1024 sc1 lds
Mvaa 144,228,140
buffer_load_dwordx4 v4, s[12:15], s7 offen offset:2048 sc1 lds
Mvaa 148,232,136
Ra 192,3,0
Ra 196,3,1024
Mvaa 148,236,140
buffer_load_dwordx4 v4, s[12:15], s7 offen offset:3072 sc1 lds
Mvaa 152,240,136
s_add_u32 m0, s44, 32768
s_mov_b32 s7, 104448
Mvaa 152,244,140
Ra 200,3,2048
Ra 204,3,3072
Mvaa 156,248,136
buffer_load_dwordx4 v4, s[12:15], s7 offen offset:0 sc1 lds
Mvaa 156,252,140
Ra 208,3,4096
Ra 212,3,5120
Mvaa 176,224,152
buffer_load_dwordx4 v4, s[12:15], s7 offen offset:1024 sc1 lds
Mvaa 176,228,156
Ra 216,3,6144
Ra 220,3,7168
Mvaa 180,232,152
Mvaa 180,236,156
buffer_load_dwordx4 v4, s[12:15], s7 offen offset:2048 sc1 lds
Mvaa 184,240,152
v_mul_f32 v128, s94, v128
v_mul_f32_e64 v129, s94, v129
Mvaa 184,244,156
v_mul_f32 v130, s94, v130
v_mul_f32 v131, s94, v131
Mvaa 188,248,152
buffer_load_dwordx4 v4, s[12:15], s7 offen offset:3072 sc1 lds
Mvaa 188,252,156
v_mul_f32 v132, s94, v132
v_mul_f32 v133, s94, v133
Mvaa 208,224,168
v_mul_f32 v134, s94, v134
v_mul_f32 v135, s94, v135
Mvaa 208,228,172
Vc 128,128,129
Vc 129,130,131
Mvaa 212,232,168
Vc 130,132,133
Vc 131,134,135
Mvaa 212,236,172
Aw 128,128
Aw 129,129
Mvaa 216,240,168
Aw 130,130
Aw 131,131
Mvaa 216,244,172
v_mul_f32 v136, s94, v136
v_mul_f32 v137, s94, v137
Mvaa 220,248,168
v_mul_f32 v138, s94, v138
v_mul_f32 v139, s94, v139
Mvaa 220,252,172
v_mul_f32 v140, s94, v140
v_mul_f32 v141, s94, v141
Mvaa 240,224,184
v_mul_f32 v142, s94, v142
v_mul_f32 v143, s94, v143
Mvaa 240,228,188
Vc 136,136,137
Vc 137,138,139
Mvaa 244,232,184
Vc 138,140,141
Vc 139,142,143
Mvaa 244,236,188
Aw 132,136
Aw 133,137
Mvaa 248,240,184
Aw 134,138
Aw 135,139
Mvaa 248,244,188
v_mul_f32 v144, s94, v144
v_mul_f32 v145, s94, v145
Mvaa 252,248,184
v_mul_f32 v146, s94, v146
v_mul_f32 v147, s94, v147
Mvaa 252,252,188
v_mul_f32 v148, s94, v148
v_mul_f32 v149, s94, v149
Ra 224,3,8192
Ra 228,3,9216
Ra 232,3,10240
Ra 236,3,11264
Ra 240,3,12288
Ra 244,3,13312
Ra 248,3,14336
s_waitcnt lgkmcnt(9)
Ra 252,3,15360
v_mul_f32 v150, s94, v150
v_mul_f32_e64 v151, s94, v151
Vc 144,144,145
Vc 145,146,147
Vc 146,148,149
Vc 147,150,151
Aw 136,144
Aw 137,145
Aw 138,146
Aw 139,147
v_mul_f32 v152, s94, v152
v_mul_f32 v153, s94, v153
v_mul_f32 v154, s94, v154
v_mul_f32 v155, s94, v155
v_mul_f32 v156, s94, v156
v_mul_f32 v157, s94, v157
v_mul_f32 v158, s94, v158
v_mul_f32 v159, s94, v159
Vc 152,152,153
Vc 153,154,155
Vc 154,156,157
Vc 155,158,159
Aw 140,152
Aw 141,153
Aw 142,154
Aw 143,155
Zvaa 128,192,128
v_mul_f32 v160, s94, v160
v_mul_f32 v161, s94, v161
Mvaa 128,196,132
v_mul_f32 v162, s94, v162
v_mul_f32 v163, s94, v163
Mvaa 128,200,136
v_mul_f32 v164, s94, v164
v_mul_f32 v165, s94, v165
Mvaa 128,204,140
v_mul_f32 v166, s94, v166
v_mul_f32 v167, s94, v167
Vc 160,160,161
Vc 161,162,163
Vc 162,164,165
Vc 163,166,167
Aw 144,160
Aw 145,161
v_max3_f32 v22, v128, v129, v130
v_max_f32 v22, v22, v131
v_mov_b32 v1, v22
Aw 146,162
Aw 147,163
v_permlane16_swap_b32 v1, v22
v_max_f32 v22, v22, v1
v_mov_b32 v1, v22
v_mul_f32 v168, s94, v168
v_mul_f32 v169, s94, v169
v_permlane32_swap_b32 v1, v22
v_max_f32_e64 v22, v22, v1
v_add_f32 v22, 0x41f80000, v22
v_sub_f32 v32, 0, v22
v_sub_f32 v33, 0, v22
v_sub_f32 v34, 0, v22
v_sub_f32 v35, 0, v22
Vs 128,128,22
Vs 129,129,22
Vs 130,130,22
Vs 131,131,22
s_waitcnt lgkmcnt(8)
Cvaa 132,208,128,32
v_mul_f32 v170, s94, v170
v_mul_f32 v171, s94, v171
v_mul_f32 v172, s94, v172
v_mul_f32_e64 v173, s94, v173
Mvaa 132,212,132
v_mul_f32 v174, s94, v174
v_mul_f32 v175, s94, v175
Vc 168,168,169
Vc 169,170,171
Mvaa 132,216,136
Vc 170,172,173
Vc 171,174,175
Aw 148,168
Aw 149,169
Mvaa 132,220,140
Aw 150,170
Aw 151,171
v_mul_f32 v176, s94, v176
v_mul_f32 v177, s94, v177
s_waitcnt lgkmcnt(4)
Cvaa 136,224,128,32
v_mul_f32 v178, s94, v178
v_mul_f32 v179, s94, v179
v_mul_f32 v180, s94, v180
v_mul_f32_e64 v181, s94, v181
Mvaa 136,228,132
v_mul_f32 v182, s94, v182
v_mul_f32 v183, s94, v183
Vc 176,176,177
Vc 177,178,179
Mvaa 136,232,136
Vc 178,180,181
Vc 179,182,183
Aw 152,176
Aw 153,177
Mvaa 136,236,140
Aw 154,178
Aw 155,179
v_mul_f32 v184, s94, v184
v_mul_f32 v185, s94, v185
s_waitcnt lgkmcnt(0)
Cvaa 140,240,128,32
v_mul_f32 v186, s94, v186
v_mul_f32 v187, s94, v187
v_mul_f32 v188, s94, v188
v_mul_f32_e64 v189, s94, v189
Mvaa 140,244,132
v_mul_f32 v190, s94, v190
v_mul_f32 v191, s94, v191
Vc 184,184,185
Vc 185,186,187
Mvaa 140,248,136
Vc 186,188,189
Vc 187,190,191
Aw 156,184
Aw 157,185
Mvaa 140,252,140
Aw 158,186
Aw 159,187
Zvaa 144,192,144
v_mul_f32 v192, s94, v192
v_mul_f32 v193, s94, v193
Mvaa 144,196,148
v_mul_f32 v194, s94, v194
v_mul_f32 v195, s94, v195
Mvaa 144,200,152
v_mul_f32 v196, s94, v196
v_mul_f32 v197, s94, v197
Mvaa 144,204,156
v_mul_f32 v198, s94, v198
v_mul_f32 v199, s94, v199
Vc 192,192,193
Vc 193,194,195
Vc 194,196,197
Vc 195,198,199
Aw 160,192
Aw 161,193
v_max3_f32 v22, v144, v145, v146
v_max_f32 v22, v22, v147
v_mov_b32 v1, v22
Aw 162,194
Aw 163,195
v_permlane16_swap_b32 v1, v22
v_max_f32 v22, v22, v1
v_mov_b32 v1, v22
v_mul_f32 v200, s94, v200
v_mul_f32 v201, s94, v201
v_permlane32_swap_b32 v1, v22
v_max_f32_e64 v22, v22, v1
v_add_f32 v22, 0x41f80000, v22
v_sub_f32 v36, 0, v22
v_sub_f32 v37, 0, v22
v_sub_f32 v38, 0, v22
v_sub_f32 v39, 0, v22
Vs 144,144,22
Vs 145,145,22
Vs 146,146,22
Vs 147,147,22
Cvaa 148,208,144,36
v_mul_f32 v202, s94, v202
v_mul_f32 v203, s94, v203
v_mul_f32 v204, s94, v204
v_mul_f32 v205, s94, v205
Mvaa 148,212,148
v_mul_f32 v206, s94, v206
v_mul_f32 v207, s94, v207
Vc 200,200,201
Vc 201,202,203
Mvaa 148,216,152
Vc 202,204,205
Vc 203,206,207
Aw 164,200
Aw 165,201
Mvaa 148,220,156
Aw 166,202
Aw 167,203
v_mul_f32 v208, s94, v208
v_mul_f32 v209, s94, v209
Cvaa 152,224,144,36
v_mul_f32 v210, s94, v210
v_mul_f32 v211, s94, v211
v_mul_f32 v212, s94, v212
v_mul_f32 v213, s94, v213
Mvaa 152,228,148
v_mul_f32 v214, s94, v214
v_mul_f32 v215, s94, v215
Vc 208,208,209
Vc 209,210,211
Mvaa 152,232,152
Vc 210,212,213
Vc 211,214,215
Aw 168,208
Aw 169,209
Mvaa 152,236,156
Aw 170,210
Aw 171,211
v_mul_f32 v216, s94, v216
v_mul_f32 v217, s94, v217
Cvaa 156,240,144,36
v_mul_f32 v218, s94, v218
v_mul_f32 v219, s94, v219
v_mul_f32 v220, s94, v220
v_mul_f32 v221, s94, v221
Mvaa 156,244,148
v_mul_f32 v222, s94, v222
v_mul_f32 v223, s94, v223
Vc 216,216,217
Vc 217,218,219
Mvaa 156,248,152
Vc 218,220,221
Vc 219,222,223
Aw 172,216
Aw 173,217
Mvaa 156,252,156
Aw 174,218
Aw 175,219
Zvaa 160,192,160
v_mul_f32 v224, s94, v224
v_mul_f32 v225, s94, v225
Mvaa 160,196,164
v_mul_f32 v226, s94, v226
v_mul_f32 v227, s94, v227
Mvaa 160,200,168
v_mul_f32 v228, s94, v228
v_mul_f32 v229, s94, v229
Mvaa 160,204,172
v_mul_f32 v230, s94, v230
v_mul_f32 v231, s94, v231
Vc 224,224,225
Vc 225,226,227
Vc 226,228,229
Vc 227,230,231
Aw 176,224
Aw 177,225
v_max3_f32 v22, v160, v161, v162
v_max_f32 v22, v22, v163
v_mov_b32 v1, v22
Aw 178,226
Aw 179,227
v_permlane16_swap_b32 v1, v22
v_max_f32 v22, v22, v1
v_mov_b32 v1, v22
v_mul_f32 v232, s94, v232
v_mul_f32 v233, s94, v233
v_permlane32_swap_b32 v1, v22
v_max_f32_e64 v22, v22, v1
v_add_f32 v22, 0x41f80000, v22
v_sub_f32 v40, 0, v22
v_sub_f32 v41, 0, v22
v_sub_f32 v42, 0, v22
v_sub_f32 v43, 0, v22
Vs 160,160,22
Vs 161,161,22
Vs 162,162,22
Vs 163,163,22
Cvaa 164,208,160,40
v_mul_f32 v234, s94, v234
v_mul_f32 v235, s94, v235
v_mul_f32 v236, s94, v236
v_mul_f32 v237, s94, v237
Mvaa 164,212,164
v_mul_f32 v238, s94, v238
v_mul_f32 v239, s94, v239
Vc 232,232,233
Vc 233,234,235
Mvaa 164,216,168
Vc 234,236,237
Vc 235,238,239
Aw 180,232
Aw 181,233
Mvaa 164,220,172
Aw 182,234
Aw 183,235
v_mul_f32 v240, s94, v240
v_mul_f32 v241, s94, v241
Cvaa 168,224,160,40
v_mul_f32 v242, s94, v242
v_mul_f32 v243, s94, v243
v_mul_f32 v244, s94, v244
v_mul_f32 v245, s94, v245
Mvaa 168,228,164
v_mul_f32 v246, s94, v246
v_mul_f32 v247, s94, v247
Vc 240,240,241
Vc 241,242,243
Mvaa 168,232,168
Vc 242,244,245
Vc 243,246,247
Aw 184,240
Aw 185,241
Mvaa 168,236,172
Aw 186,242
Aw 187,243
v_mul_f32 v248, s94, v248
v_mul_f32 v249, s94, v249
Cvaa 172,240,160,40
v_mul_f32 v250, s94, v250
v_mul_f32 v251, s94, v251
v_mul_f32 v252, s94, v252
v_mul_f32 v253, s94, v253
Mvaa 172,244,164
v_mul_f32 v254, s94, v254
v_mul_f32 v255, s94, v255
Vc 248,248,249
Vc 249,250,251
Mvaa 172,248,168
Vc 250,252,253
Vc 251,254,255
Aw 188,248
Aw 189,249
Mvaa 172,252,172
Aw 190,250
Aw 191,251
Zvaa 176,192,176
v_mov_b32 v20, 0xff800000
v_and_b32_e64 v16, 3, v0
Mvaa 176,196,180
v_subrev_u32 v16, 1, v16
v_ashrrev_i32 v16, 31, v16
Mvaa 176,200,184
v_and_b32 v16, 0x3f803f80, v16
v_mov_b32_e64 v17, v16
Mvaa 176,204,188
v_mov_b32 v18, v16
v_mov_b32 v19, v16
Ve 8,128
Ve 9,129
Ve 10,130
Ve 11,131
Vc 64,8,9
s_cmp_lg_u32 s34, 0
s_cbranch_scc1 L_k2_nomaskA
v_cmp_gt_i32 s[56:57], 0, v5
v_cmp_gt_i32 s[58:59], 1, v5
v_cmp_gt_i32 s[60:61], 2, v5
v_cmp_gt_i32 s[62:63], 3, v5
s_nop 3
v_cndmask_b32 v176, v176, v20, s[56:57]
v_cndmask_b32 v177, v177, v20, s[58:59]
v_cndmask_b32 v178, v178, v20, s[60:61]
v_cndmask_b32 v179, v179, v20, s[62:63]
L_k2_nomaskA:
v_max3_f32 v22, v176, v177, v178
v_max_f32 v22, v22, v179
v_mov_b32 v1, v22
Ve 12,144
s_nop 0
v_permlane16_swap_b32 v1, v22
v_max_f32 v22, v22, v1
v_mov_b32 v1, v22
Ve 13,145
s_nop 0
v_permlane32_swap_b32 v1, v22
v_max_f32 v22, v22, v1
v_add_f32 v22, 0x41f80000, v22
v_sub_f32 v44, 0, v22
v_sub_f32 v45, 0, v22
v_sub_f32 v46, 0, v22
v_sub_f32 v47, 0, v22
Vs 176,176,22
Vs 177,177,22
Vs 178,178,22
Vs 179,179,22
Cvaa 180,208,176,44
Vc 65,10,11
VE 14,146
Mvaa 180,212,180
VE 15,147
Vc 72,12,13
Mvaa 180,216,184
Ve 8,160
Ve 9,161
Mvaa 180,220,188
Vc 73,14,15
v_or_b32 v7, v64, v65
Ve 10,162
s_waitcnt vmcnt(16)
s_barrier
s_add_u32 s53, s44, 65536
Cvaa 184,224,176,44
Ra 192,3,32768
VE 11,163
Vc 80,8,9
Mvaa 184,228,180
Ra 196,3,33792
Ve 12,132
Ve 13,133
Mvaa 184,232,184
Ra 200,3,34816
Vc 81,10,11
v_or3_b32 v7, v7, v72, v73
VE 14,134
Mvaa 184,236,188
Ra 204,3,35840
VE 15,135
Vc 66,12,13
Cvaa 188,240,176,44
Ra 208,3,36864
Ve 8,148
Ve 9,149
Mvaa 188,244,180
Ra 212,3,37888
Vc 67,14,15
v_or3_b32 v7, v7, v80, v81
VE 10,150
Mvaa 188,248,184
Ra 216,3,38912
VE 11,151
Vc 74,8,9
Mvaa 188,252,188
Ra 220,3,39936
Ve 12,164
Ve 13,165
Vc 75,10,11
v_or3_b32 v7, v7, v66, v67
Ve 14,166
Ve 15,167
Vc 82,12,13
v_or3_b32 v7, v7, v74, v75
Vc 83,14,15
v_or3_b32 v7, v7, v82, v83
s_mov_b32 s38, 139264
s_mov_b32 s39, 121856
s_cmp_lg_u32 s34, 0
s_cbranch_scc1 L_k2_nomask0
v_cmp_gt_i32 s[56:57], 16, v5
v_cmp_gt_i32 s[58:59], 17, v5
v_cmp_gt_i32 s[60:61], 18, v5
v_cmp_gt_i32 s[62:63], 19, v5
s_nop 3
s_nop 0
v_cndmask_b32 v180, v180, v20, s[56:57]
v_cndmask_b32 v181, v181, v20, s[58:59]
v_cndmask_b32 v182, v182, v20, s[60:61]
v_cndmask_b32 v183, v183, v20, s[62:63]
v_cmp_gt_i32 s[56:57], 32, v5
v_cmp_gt_i32 s[58:59], 33, v5
v_cmp_gt_i32 s[60:61], 34, v5
v_cmp_gt_i32 s[62:63], 35, v5
v_cndmask_b32 v184, v184, v20, s[56:57]
v_cndmask_b32 v185, v185, v20, s[58:59]
v_cndmask_b32 v186, v186, v20, s[60:61]
v_cndmask_b32 v187, v187, v20, s[62:63]
v_cmp_gt_i32 s[56:57], 48, v5
v_cmp_gt_i32 s[58:59], 49, v5
v_cmp_gt_i32 s[60:61], 50, v5
v_cmp_gt_i32 s[62:63], 51, v5
v_cndmask_b32 v188, v188, v20, s[56:57]
v_cndmask_b32 v189, v189, v20, s[58:59]
v_cndmask_b32 v190, v190, v20, s[60:61]
v_cndmask_b32 v191, v191, v20, s[62:63]
L_k2_nomask0:
s_mov_b32 s37, 0
Ve 8,176
Ve 9,177
Ve 10,178
VE 11,179
Vc 88,8,9
Ve 12,180
Ve 13,181
Vc 89,10,11
Ve 14,182
Ve 15,183
Vc 90,12,13
Vc 91,14,15
v_or3_b32 v7, v7, v88, v89
v_or3_b32 v7, v7, v90, v91
s_waitcnt lgkmcnt(4)
s_cmp_eq_u32 s34, 0
s_cbranch_scc1 L_k2_wlast
s_branch L_k2_wloop
L_k2_mk_wo:
v_cmp_gt_i32 s[56:57], 0, v5
v_cmp_gt_i32 s[58:59], 1, v5
v_cmp_gt_i32 s[60:61], 2, v5
v_cmp_gt_i32 s[62:63], 3, v5
s_nop 3
s_nop 0
v_cndmask_b32 v176, v176, v20, s[56:57]
v_cndmask_b32 v177, v177, v20, s[58:59]
v_cndmask_b32 v178, v178, v20, s[60:61]
v_cndmask_b32 v179, v179, v20, s[62:63]
v_cmp_gt_i32 s[56:57], 16, v5
v_cmp_gt_i32 s[58:59], 17, v5
v_cmp_gt_i32 s[60:61], 18, v5
v_cmp_gt_i32 s[62:63], 19, v5
v_cndmask_b32 v180, v180, v20, s[56:57]
v_cndmask_b32 v181, v181, v20, s[58:59]
v_cndmask_b32 v182, v182, v20, s[60:61]
v_cndmask_b32 v183, v183, v20, s[62:63]
v_cmp_gt_i32 s[56:57], 32, v5
v_cmp_gt_i32 s[58:59], 33, v5
v_cmp_gt_i32 s[60:61], 34, v5
v_cmp_gt_i32 s[62:63], 35, v5
v_cndmask_b32 v184, v184, v20, s[56:57]
v_cndmask_b32 v185, v185, v20, s[58:59]
v_cndmask_b32 v186, v186, v20, s[60:61]
v_cndmask_b32 v187, v187, v20, s[62:63]
v_cmp_gt_i32 s[56:57], 48, v5
v_cmp_gt_i32 s[58:59], 49, v5
v_cmp_gt_i32 s[60:61], 50, v5
v_cmp_gt_i32 s[62:63], 51, v5
v_cndmask_b32 v188, v188, v20, s[56:57]
v_cndmask_b32 v189, v189, v20, s[58:59]
v_cndmask_b32 v190, v190, v20, s[60:61]
v_cndmask_b32 v191, v191, v20, s[62:63]
s_branch L_k2_mkr_wo
L_k2_mk_tr:
v_cmp_gt_i32 s[56:57], 0, v5
v_cmp_gt_i32 s[58:59], 1, v5
v_cmp_gt_i32 s[60:61], 2, v5
v_cmp_gt_i32 s[62:63], 3, v5
s_nop 3
v_cndmask_b32 v144, v144, v20, s[56:57]
v_cndmask_b32 v145, v145, v20, s[58:59]
v_cndmask_b32 v146, v146, v20, s[60:61]
v_cndmask_b32 v147, v147, v20, s[62:63]
v_cmp_gt_i32 s[56:57], 16, v5
v_cmp_gt_i32 s[58:59], 17, v5
v_cmp_gt_i32 s[60:61], 18, v5
v_cmp_gt_i32 s[62:63], 19, v5
v_cndmask_b32 v148, v148, v20, s[56:57]
v_cndmask_b32 v149, v149, v20, s[58:59]
v_cndmask_b32 v150, v150, v20, s[60:61]
v_cndmask_b32 v151, v151, v20, s[62:63]
v_cmp_gt_i32 s[56:57], 32, v5
v_cmp_gt_i32 s[58:59], 33, v5
v_cmp_gt_i32 s[60:61], 34, v5
v_cmp_gt_i32 s[62:63], 35, v5
v_cndmask_b32 v152, v152, v20, s[56:57]
v_cndmask_b32 v153, v153, v20, s[58:59]
v_cndmask_b32 v154, v154, v20, s[60:61]
v_cndmask_b32 v155, v155, v20, s[62:63]
v_cmp_gt_i32 s[56:57], 48, v5
v_cmp_gt_i32 s[58:59], 49, v5
v_cmp_gt_i32 s[60:61], 50, v5
v_cmp_gt_i32 s[62:63], 51, v5
v_cndmask_b32 v156, v156, v20, s[56:57]
v_cndmask_b32 v157, v157, v20, s[58:59]
v_cndmask_b32 v158, v158, v20, s[60:61]
v_cndmask_b32 v159, v159, v20, s[62:63]
s_branch L_k2_mkr_tr
L_k2_mk_no:
v_cmp_gt_i32 s[56:57], 0, v5
v_cmp_gt_i32 s[58:59], 1, v5
v_cmp_gt_i32 s[60:61], 2, v5
v_cmp_gt_i32 s[62:63], 3, v5
s_nop 3
v_cndmask_b32 v144, v144, v20, s[56:57]
v_cndmask_b32 v145, v145, v20, s[58:59]
v_cndmask_b32 v146, v146, v20, s[60:61]
v_cndmask_b32 v147, v147, v20, s[62:63]
v_cmp_gt_i32 s[56:57], 16, v5
v_cmp_gt_i32 s[58:59], 17, v5
v_cmp_gt_i32 s[60:61], 18, v5
v_cmp_gt_i32 s[62:63], 19, v5
v_cndmask_b32 v148, v148, v20, s[56:57]
v_cndmask_b32 v149, v149, v20, s[58:59]
v_cndmask_b32 v150, v150, v20, s[60:61]
v_cndmask_b32 v151, v151, v20, s[62:63]
v_cmp_gt_i32 s[56:57], 32, v5
v_cmp_gt_i32 s[58:59], 33, v5
v_cmp_gt_i32 s[60:61], 34, v5
v_cmp_gt_i32 s[62:63], 35, v5
v_cndmask_b32 v152, v152, v20, s[56:57]
v_cndmask_b32 v153, v153, v20, s[58:59]
v_cndmask_b32 v154, v154, v20, s[60:61]
v_cndmask_b32 v155, v155, v20, s[62:63]
v_cmp_gt_i32 s[56:57], 48, v5
v_cmp_gt_i32 s[58:59], 49, v5
v_cmp_gt_i32 s[60:61], 50, v5
v_cmp_gt_i32 s[62:63], 51, v5
v_cndmask_b32 v156, v156, v20, s[56:57]
v_cndmask_b32 v157, v157, v20, s[58:59]
v_cndmask_b32 v158, v158, v20, s[60:61]
v_cndmask_b32 v159, v159, v20, s[62:63]
s_branch L_k2_mkr_no
L_pubB:
v_mov_b32 v24, 1
v_mov_b32 v25, 0
s_mov_b64 exec, 1
buffer_store_dword v24, v25, s[20:23], s64 offen sc1
s_mov_b64 exec, -1
s_branch L_pubBr
L_k2_wloop:
v_xor_b32 v2, 65536, v2
v_xor_b32 v3, 65536, v3
Cvaa 192,192,128,32
s_mov_b32 m0, s53
Ra 224,2,40960
v_lshl_add_u64 v[28:29], s[40:41], 0, v[28:29]
Mvaa 192,196,132
buffer_load_dwordx4 v4, s[12:15], s38 offen offset:0 sc1 lds
Mvaa 192,200,136
Ve 8,136
Mvaa 192,204,140
VE 9,137
Cvaa 208,192,144,36
Ra 228,2,41984
Vc 68,8,9
Mvaa 208,196,148
VE 10,138
Mvaa 208,200,152
VE 11,139
Mvaa 208,204,156
Ra 232,2,43008
Vc 69,10,11
Cvaa 224,192,160,40
Ra 236,2,44032
v_or3_b32 v7, v7, v68, v69
Mvaa 224,196,164
VE 12,152
Mvaa 224,200,168
VE 13,153
Mvaa 224,204,172
Ra 240,2,45056
Vc 76,12,13
Cvaa 240,192,176,44
VE 14,154
Mvaa 240,196,180
VE 15,155
Mvaa 240,200,184
Ra 244,2,46080
Vc 77,14,15
Mvaa 240,204,188
s_waitcnt lgkmcnt(6)
Ra 248,2,47104
v_or3_b32 v7, v7, v76, v77
Cvaa 196,208,128,32
buffer_load_dwordx4 v4, s[12:15], s38 offen offset:1024 sc1 lds
Mvaa 196,212,132
Ve 8,168
Mvaa 196,216,136
VE 9,169
Mvaa 196,220,140
Ra 252,2,48128
Vc 84,8,9
Cvaa 212,208,144,36
VE 10,170
Mvaa 212,212,148
VE 11,171
Mvaa 212,216,152
Ra 192,2,16384
Vc 85,10,11
Mvaa 212,220,156
Ra 196,2,24576
v_or3_b32 v7, v7, v84, v85
Cvaa 228,208,160,40
VE 12,184
Mvaa 228,212,164
VE 13,185
Mvaa 228,216,168
Ra 200,2,17408
Vc 92,12,13
Mvaa 228,220,172
VE 14,186
Cvaa 244,208,176,44
VE 15,187
Mvaa 244,212,180
buffer_load_dwordx4 v4, s[12:15], s38 offen offset:2048 sc1 lds
Mvaa 244,216,184
Ra 204,2,25600
Vc 93,14,15
Mvaa 244,220,188
s_waitcnt lgkmcnt(8)
Ve 8,140
Cvaa 200,224,128,32
Ra 208,2,18432
v_or3_b32 v7, v7, v92, v93
Mvaa 200,228,132
VE 9,141
Mvaa 200,232,136
Ra 212,2,26624
Vc 70,8,9
Mvaa 200,236,140
VE 10,142
Cvaa 216,224,144,36
VE 11,143
Mvaa 216,228,148
Ra 216,2,19456
Vc 71,10,11
Mvaa 216,232,152
Ra 220,2,27648
v_or3_b32 v7, v7, v70, v71
Mvaa 216,236,156
VE 12,156
Cvaa 232,224,160,40
VE 13,157
Mvaa 232,228,164
VE 14,158
Mvaa 232,232,168
VE 15,159
Mvaa 232,236,172
buffer_load_dwordx4 v4, s[12:15], s38 offen offset:3072 sc1 lds
Cvaa 248,224,176,44
VE 8,172
Mvaa 248,228,180
VE 9,173
Mvaa 248,232,184
Vc 78,12,13
Vc 79,14,15
Mvaa 248,236,188
s_waitcnt lgkmcnt(8)
Ve 10,174
Cvaa 204,240,128,32
VE 11,175
Mvaa 204,244,132
Vc 86,8,9
Vc 87,10,11
Mvaa 204,248,136
VE 12,188
Mvaa 204,252,140
VE 13,189
Cvaa 220,240,144,36
Vc 94,12,13
v_or3_b32 v7, v7, v78, v79
Mvaa 220,244,148
VE 14,190
Mvaa 220,248,152
VE 15,191
Mvaa 220,252,156
Vc 95,14,15
v_or3_b32 v7, v7, v86, v87
Cvaa 236,240,160,40
v_or3_b32 v7, v7, v94, v95
v_and_b32 v1, 0x40004000, v7
Mvaa 236,244,164
v_cmp_ne_u32 vcc, 0, v1
Mvaa 236,248,168
Mvaa 236,252,172
s_waitcnt vmcnt(12)
Cvaa 252,240,176,44
Mvaa 252,244,180
s_barrier
Mvaa 252,248,184
s_waitcnt lgkmcnt(4)
Mvaa 252,252,188
s_cbranch_vccnz L_k2_fb_we
L_k2_fbr_we:
Maav 0,192,64
Ve 8,192
Maav 0,196,68
s_add_u32 m0, s54, 49152
VE 9,193
Maav 32,192,72
buffer_load_dwordx4 v4, s[12:15], s39 offen offset:0 sc1 lds
Maav 32,196,76
s_add_u32 s37, s37, 1
Ra 224,2,20480
Vc 96,8,9
Maav 64,192,80
s_add_u32 s38, s38, 34816
Ve 10,194
Maav 64,196,84
VE 11,195
Maav 96,192,88
Ra 228,2,28672
Vc 97,10,11
Maav 96,196,92
Ra 232,2,21504
v_or_b32_e64 v7, v96, v97
Maav 4,200,64
VE 12,208
Maav 4,204,68
VE 13,209
Maav 36,200,72
Ra 236,2,29696
Vc 104,12,13
Maav 36,204,76
VE 14,210
Maav 68,200,80
VE 15,211
Maav 68,204,84
Ra 240,2,22528
Vc 105,14,15
Maav 100,200,88
Ra 244,2,30720
v_or3_b32 v7, v7, v104, v105
Maav 100,204,92
buffer_load_dwordx4 v4, s[12:15], s39 offen offset:1024 sc1 lds
Mvvv 48,16,64
VE 8,224
Mvvv 48,16,68
s_waitcnt lgkmcnt(6)
Ve 9,225
Maav 8,208,64
Ra 248,2,23552
Vc 112,8,9
Maav 8,212,68
VE 10,226
Maav 40,208,72
VE 11,227
Maav 40,212,76
Ra 252,2,31744
Vc 113,10,11
Maav 72,208,80
Ra 192,3,0
v_or3_b32 v7, v7, v112, v113
Maav 72,212,84
VE 12,240
Maav 104,208,88
VE 13,241
Maav 104,212,92
Ra 196,3,1024
Vc 120,12,13
Maav 12,216,64
VE 14,242
Maav 12,220,68
VE 15,243
Maav 44,216,72
Ra 200,3,2048
Vc 121,14,15
Maav 44,220,76
buffer_load_dwordx4 v4, s[12:15], s39 offen offset:2048 sc1 lds
Maav 76,216,80
Ra 204,3,3072
v_or3_b32 v7, v7, v120, v121
Maav 76,220,84
VE 8,196
Maav 108,216,88
VE 9,197
Maav 108,220,92
VE 10,198
Mvvv 52,16,72
VE 11,199
Mvvv 52,16,76
s_waitcnt lgkmcnt(8)
Ve 12,212
Maav 16,224,64
Ra 208,3,4096
Vc 98,8,9
Maav 16,228,68
Ra 212,3,5120
Vc 99,10,11
Maav 48,224,72
Ra 216,3,6144
v_or3_b32 v7, v7, v98, v99
Maav 48,228,76
VE 13,213
Maav 80,224,80
Ra 220,3,7168
Vc 106,12,13
Maav 80,228,84
VE 14,214
Maav 112,224,88
buffer_load_dwordx4 v4, s[12:15], s39 offen offset:3072 sc1 lds
Maav 112,228,92
s_add_u32 s39, s39, 34816
VE 15,215
Maav 20,232,64
VE 8,228
Maav 20,236,68
VE 9,229
Maav 52,232,72
VE 10,230
Maav 52,236,76
VE 11,231
Maav 84,232,80
Vc 107,14,15
Vc 114,8,9
Maav 84,236,84
VE 12,244
Maav 116,232,88
VE 13,245
Maav 116,236,92
Vc 115,10,11
Vc 122,12,13
Mvvv 56,16,80
VE 14,246
Mvvv 56,16,84
s_waitcnt lgkmcnt(8)
Ve 15,247
Maav 24,240,64
Vc 123,14,15
v_or3_b32 v7, v7, v106, v107
Maav 24,244,68
v_or3_b32 v7, v7, v114, v115
v_or3_b32 v7, v7, v122, v123
Maav 56,240,72
global_load_dword v30, v[28:29], off
Maav 56,244,76
Maav 88,240,80
Maav 88,244,84
Maav 120,240,88
Maav 120,244,92
Maav 28,248,64
Maav 28,252,68
Maav 60,248,72
Maav 60,252,76
Maav 92,248,80
Maav 92,252,84
Maav 124,248,88
Maav 124,252,92
Mvvv 60,16,88
s_waitcnt lgkmcnt(4)
Mvvv 60,16,92
Ve 8,200
Cvaa 128,192,128,32
s_add_u32 m0, s53, 32768
Ra 224,3,8192
v_lshl_add_u64 v[28:29], s[40:41], 0, v[28:29]
Mvaa 128,196,132
buffer_load_dwordx4 v4, s[12:15], s38 offen offset:0 sc1 lds
Mvaa 128,200,136
VE 9,201
Mvaa 128,204,140
Ra 228,3,9216
Vc 100,8,9
Cvaa 144,192,144,36
VE 10,202
Mvaa 144,196,148
VE 11,203
Mvaa 144,200,152
Ra 232,3,10240
Vc 101,10,11
Mvaa 144,204,156
Ra 236,3,11264
v_or3_b32 v7, v7, v100, v101
Cvaa 160,192,160,40
VE 12,216
Mvaa 160,196,164
VE 13,217
Mvaa 160,200,168
Ra 240,3,12288
Vc 108,12,13
Mvaa 160,204,172
VE 14,218
Cvaa 176,192,176,44
VE 15,219
Mvaa 176,196,180
Ra 244,3,13312
Vc 109,14,15
Mvaa 176,200,184
Ra 248,3,14336
v_or3_b32 v7, v7, v108, v109
Mvaa 176,204,188
s_waitcnt lgkmcnt(7)
Ve 8,232
Cvaa 132,208,128,32
buffer_load_dwordx4 v4, s[12:15], s38 offen offset:1024 sc1 lds
Mvaa 132,212,132
VE 9,233
Mvaa 132,216,136
Ra 252,3,15360
Vc 116,8,9
Mvaa 132,220,140
VE 10,234
Cvaa 148,208,144,36
VE 11,235
Mvaa 148,212,148
Ra 192,2,49152
Vc 117,10,11
Mvaa 148,216,152
Ra 196,2,57344
v_or3_b32 v7, v7, v116, v117
Mvaa 148,220,156
VE 12,248
Cvaa 164,208,160,40
VE 13,249
Mvaa 164,212,164
Ra 200,2,50176
Vc 124,12,13
Mvaa 164,216,168
VE 14,250
Mvaa 164,220,172
VE 15,251
Cvaa 180,208,176,44
Ra 204,2,58368
Vc 125,14,15
Mvaa 180,212,180
buffer_load_dwordx4 v4, s[12:15], s38 offen offset:2048 sc1 lds
Mvaa 180,216,184
VE 8,204
Mvaa 180,220,188
s_waitcnt lgkmcnt(8)
Ve 9,205
Cvaa 136,224,128,32
Ra 208,2,51200
Vc 102,8,9
Mvaa 136,228,132
Ra 212,2,59392
v_or3_b32 v7, v7, v124, v125
Mvaa 136,232,136
VE 10,206
Mvaa 136,236,140
VE 11,207
Cvaa 152,224,144,36
Ra 216,2,52224
Vc 103,10,11
Mvaa 152,228,148
Ra 220,2,60416
v_or3_b32 v7, v7, v102, v103
Mvaa 152,232,152
VE 12,220
Mvaa 152,236,156
VE 13,221
Cvaa 168,224,160,40
VE 14,222
Mvaa 168,228,164
VE 15,223
Mvaa 168,232,168
VE 8,236
Mvaa 168,236,172
buffer_load_dwordx4 v4, s[12:15], s38 offen offset:3072 sc1 lds
Cvaa 184,224,176,44
VE 9,237
Mvaa 184,228,180
Vc 110,12,13
Vc 111,14,15
Mvaa 184,232,184
VE 10,238
Mvaa 184,236,188
s_waitcnt lgkmcnt(8)
Ve 11,239
Cvaa 140,240,128,32
Vc 118,8,9
Vc 119,10,11
Mvaa 140,244,132
VE 12,252
Mvaa 140,248,136
VE 13,253
Mvaa 140,252,140
Vc 126,12,13
v_or3_b32 v7, v7, v110, v111
Cvaa 156,240,144,36
VE 14,254
Mvaa 156,244,148
VE 15,255
Mvaa 156,248,152
Vc 127,14,15
v_or3_b32 v7, v7, v118, v119
Mvaa 156,252,156
v_or3_b32 v7, v7, v126, v127
v_and_b32 v1, 0x40004000, v7
Cvaa 172,240,160,40
v_cmp_ne_u32 vcc, 0, v1
Mvaa 172,244,164
Mvaa 172,248,168
Mvaa 172,252,172
s_waitcnt vmcnt(12)
Cvaa 188,240,176,44
s_cmp_eq_u32 s37, s46
Mvaa 188,244,180
s_barrier
Mvaa 188,248,184
s_waitcnt lgkmcnt(4)
Mvaa 188,252,188
s_cbranch_vccnz L_k2_fb_wo
L_k2_fbr_wo:
Maav 0,192,96
s_cbranch_scc1 L_k2_mk_wo
L_k2_mkr_wo:
Ve 8,128
Maav 0,196,100
s_add_u32 m0, s53, 16384
VE 9,129
Maav 32,192,104
buffer_load_dwordx4 v4, s[12:15], s39 offen offset:0 sc1 lds
Maav 32,196,108
s_add_u32 s37, s37, 1
Ra 224,2,53248
Vc 64,8,9
Maav 64,192,112
s_add_u32 s38, s38, 34816
Ve 10,130
Maav 64,196,116
s_xor_b32 s53, s53, 65536
VE 11,131
Maav 96,192,120
s_xor_b32 s54, s54, 65536
Ra 228,2,61440
Vc 65,10,11
Maav 96,196,124
Ra 232,2,54272
v_or_b32_e64 v7, v64, v65
Maav 4,200,96
VE 12,144
Maav 4,204,100
VE 13,145
Maav 36,200,104
Ra 236,2,62464
Vc 72,12,13
Maav 36,204,108
VE 14,146
Maav 68,200,112
VE 15,147
Maav 68,204,116
Ra 240,2,55296
Vc 73,14,15
Maav 100,200,120
Ra 244,2,63488
v_or3_b32 v7, v7, v72, v73
Maav 100,204,124
buffer_load_dwordx4 v4, s[12:15], s39 offen offset:1024 sc1 lds
Mvvv 48,16,96
VE 8,160
Mvvv 48,16,100
s_waitcnt lgkmcnt(6)
Ve 9,161
Maav 8,208,96
Ra 248,2,56320
Vc 80,8,9
Maav 8,212,100
VE 10,162
Maav 40,208,104
VE 11,163
Maav 40,212,108
Ra 252,2,64512
Vc 81,10,11
Maav 72,208,112
Ra 192,3,32768
v_or3_b32 v7, v7, v80, v81
Maav 72,212,116
VE 12,176
Maav 104,208,120
VE 13,177
Maav 104,212,124
Ra 196,3,33792
Vc 88,12,13
Maav 12,216,96
VE 14,178
Maav 12,220,100
VE 15,179
Maav 44,216,104
Ra 200,3,34816
Vc 89,14,15
Maav 44,220,108
buffer_load_dwordx4 v4, s[12:15], s39 offen offset:2048 sc1 lds
Maav 76,216,112
Ra 204,3,35840
v_or3_b32 v7, v7, v88, v89
Maav 76,220,116
VE 8,132
Maav 108,216,120
VE 9,133
Maav 108,220,124
VE 10,134
Mvvv 52,16,104
VE 11,135
Mvvv 52,16,108
s_waitcnt lgkmcnt(8)
Ve 12,148
Maav 16,224,96
Ra 208,3,36864
Vc 66,8,9
Maav 16,228,100
Ra 212,3,37888
Vc 67,10,11
Maav 48,224,104
Ra 216,3,38912
v_or3_b32 v7, v7, v66, v67
Maav 48,228,108
VE 13,149
Maav 80,224,112
Ra 220,3,39936
Vc 74,12,13
Maav 80,228,116
VE 14,150
Maav 112,224,120
buffer_load_dwordx4 v4, s[12:15], s39 offen offset:3072 sc1 lds
Maav 112,228,124
s_add_u32 s39, s39, 34816
VE 15,151
Maav 20,232,96
VE 8,164
Maav 20,236,100
VE 9,165
Maav 52,232,104
VE 10,166
Maav 52,236,108
VE 11,167
Maav 84,232,112
Vc 75,14,15
Vc 82,8,9
Maav 84,236,116
VE 12,180
Maav 116,232,120
VE 13,181
Maav 116,236,124
Vc 83,10,11
Vc 90,12,13
Mvvv 56,16,112
VE 14,182
Mvvv 56,16,116
s_waitcnt lgkmcnt(8)
Ve 15,183
Maav 24,240,96
Vc 91,14,15
v_or3_b32 v7, v7, v74, v75
Maav 24,244,100
v_or3_b32 v7, v7, v82, v83
v_or3_b32 v7, v7, v90, v91
Maav 56,240,104
global_load_dword v30, v[28:29], off
Maav 56,244,108
Maav 88,240,112
Maav 88,244,116
Maav 120,240,120
Maav 120,244,124
Maav 28,248,96
Maav 28,252,100
Maav 60,248,104
Maav 60,252,108
Maav 92,248,112
Maav 92,252,116
Maav 124,248,120
Maav 124,252,124
s_cmp_lg_u32 s37, s35
Mvvv 60,16,120
s_waitcnt lgkmcnt(4)
Mvvv 60,16,124
s_cbranch_scc1 L_k2_wloop
L_k2_wlast:
v_xor_b32 v2, 65536, v2
v_xor_b32 v3, 65536, v3
Cvaa 192,192,128,32
s_mov_b32 m0, s53
Ra 224,2,40960
v_lshl_add_u64 v[28:29], s[40:41], 0, v[28:29]
Mvaa 192,196,132
buffer_load_dwordx4 v4, s[12:15], s38 offen offset:0 sc1 lds
Mvaa 192,200,136
VE 8,136
Mvaa 192,204,140
VE 9,137
Cvaa 208,192,144,36
Ra 228,2,41984
Vc 68,8,9
Mvaa 208,196,148
VE 10,138
Mvaa 208,200,152
VE 11,139
Mvaa 208,204,156
Ra 232,2,43008
Vc 69,10,11
Cvaa 224,192,160,40
Ra 236,2,44032
v_or3_b32 v7, v7, v68, v69
Mvaa 224,196,164
VE 12,152
Mvaa 224,200,168
VE 13,153
Mvaa 224,204,172
s_waitcnt lgkmcnt(4)
Ra 240,2,45056
Vc 76,12,13
Cvaa 196,208,128,32
buffer_load_dwordx4 v4, s[12:15], s38 offen offset:1024 sc1 lds
Mvaa 196,212,132
Ve 14,154
Mvaa 196,216,136
VE 15,155
Mvaa 196,220,140
Ra 244,2,46080
Vc 77,14,15
Cvaa 212,208,144,36
Ra 248,2,47104
v_or3_b32 v7, v7, v76, v77
Mvaa 212,212,148
VE 8,168
Mvaa 212,216,152
VE 9,169
Mvaa 212,220,156
Ra 252,2,48128
Vc 84,8,9
Cvaa 228,208,160,40
VE 10,170
Mvaa 228,212,164
buffer_load_dwordx4 v4, s[12:15], s38 offen offset:2048 sc1 lds
Mvaa 228,216,168
VE 11,171
Mvaa 228,220,172
s_waitcnt lgkmcnt(4)
Ra 192,2,16384
Vc 85,10,11
Cvaa 200,224,128,32
Ra 196,2,24576
v_or3_b32 v7, v7, v84, v85
Mvaa 200,228,132
Ve 12,184
Mvaa 200,232,136
VE 13,185
Mvaa 200,236,140
Ra 200,2,17408
Vc 92,12,13
Cvaa 216,224,144,36
VE 14,186
Mvaa 216,228,148
VE 15,187
Mvaa 216,232,152
Ra 204,2,25600
Vc 93,14,15
Mvaa 216,236,156
buffer_load_dwordx4 v4, s[12:15], s38 offen offset:3072 sc1 lds
Cvaa 232,224,160,40
Ra 208,2,18432
v_or3_b32 v7, v7, v92, v93
Mvaa 232,228,164
VE 8,140
Mvaa 232,232,168
VE 9,141
Mvaa 232,236,172
s_waitcnt lgkmcnt(5)
Ra 212,2,26624
Vc 70,8,9
Cvaa 204,240,128,32
Ve 10,142
Mvaa 204,244,132
VE 11,143
Mvaa 204,248,136
Ra 216,2,19456
Vc 71,10,11
Mvaa 204,252,140
Ra 220,2,27648
v_or3_b32 v7, v7, v70, v71
Cvaa 220,240,144,36
VE 12,156
Mvaa 220,244,148
VE 13,157
Mvaa 220,248,152
VE 14,158
Mvaa 220,252,156
s_waitcnt vmcnt(12)
Ve 15,159
Cvaa 236,240,160,40
VE 8,172
Mvaa 236,244,164
s_barrier
Ve 9,173
Mvaa 236,248,168
s_waitcnt lgkmcnt(4)
Vc 78,12,13
Vc 79,14,15
Ve 10,174
Ve 11,175
Ve 12,188
Ve 13,189
Ve 14,190
VE 15,191
Vc 86,8,9
Vc 87,10,11
Vc 94,12,13
Vc 95,14,15
v_or3_b32 v7, v7, v78, v79
v_or3_b32 v7, v7, v86, v87
v_or3_b32 v7, v7, v94, v95
v_and_b32 v1, 0x40004000, v7
v_cmp_ne_u32 vcc, 0, v1
Mvaa 236,252,172
s_cbranch_vccnz L_k2_fb_wl
L_k2_fbr_wl:
Maav 0,192,64
v_cmp_gt_i32 s[56:57], 0, v6
v_cmp_gt_i32 s[58:59], 1, v6
v_cmp_gt_i32 s[60:61], 2, v6
v_cmp_gt_i32 s[62:63], 3, v6
s_nop 3
s_nop 0
v_cndmask_b32 v224, v224, v20, s[56:57]
v_cndmask_b32 v225, v225, v20, s[58:59]
v_cndmask_b32 v226, v226, v20, s[60:61]
v_cndmask_b32 v227, v227, v20, s[62:63]
v_cmp_gt_i32 s[56:57], 16, v6
v_cmp_gt_i32 s[58:59], 17, v6
v_cmp_gt_i32 s[60:61], 18, v6
v_cmp_gt_i32 s[62:63], 19, v6
v_cndmask_b32 v228, v228, v20, s[56:57]
v_cndmask_b32 v229, v229, v20, s[58:59]
v_cndmask_b32 v230, v230, v20, s[60:61]
v_cndmask_b32 v231, v231, v20, s[62:63]
v_cmp_gt_i32 s[56:57], 32, v6
v_cmp_gt_i32 s[58:59], 33, v6
v_cmp_gt_i32 s[60:61], 34, v6
v_cmp_gt_i32 s[62:63], 35, v6
v_cndmask_b32 v232, v232, v20, s[56:57]
v_cndmask_b32 v233, v233, v20, s[58:59]
v_cndmask_b32 v234, v234, v20, s[60:61]
v_cndmask_b32 v235, v235, v20, s[62:63]
v_cmp_gt_i32 s[56:57], 48, v6
v_cmp_gt_i32 s[58:59], 49, v6
v_cmp_gt_i32 s[60:61], 50, v6
v_cmp_gt_i32 s[62:63], 51, v6
v_cndmask_b32 v236, v236, v20, s[56:57]
v_cndmask_b32 v237, v237, v20, s[58:59]
v_cndmask_b32 v238, v238, v20, s[60:61]
v_cndmask_b32 v239, v239, v20, s[62:63]
VE 8,192
Maav 0,196,68
s_add_u32 m0, s54, 49152
VE 9,193
Maav 32,192,72
buffer_load_dwordx4 v4, s[12:15], s39 offen offset:0 sc1 lds
Maav 32,196,76
s_add_u32 s37, s37, 1
Ra 224,2,20480
Vc 96,8,9
Maav 64,192,80
s_add_u32 s38, s38, 34816
Ve 10,194
Maav 64,196,84
VE 11,195
Maav 96,192,88
Ra 228,2,28672
Vc 97,10,11
Maav 96,196,92
buffer_load_dwordx4 v4, s[12:15], s39 offen offset:1024 sc1 lds
Maav 4,200,64
Ra 232,2,21504
v_or_b32_e64 v7, v96, v97
Maav 4,204,68
VE 12,208
Maav 36,200,72
VE 13,209
Maav 36,204,76
Ra 236,2,29696
Vc 104,12,13
Maav 68,200,80
buffer_load_dwordx4 v4, s[12:15], s39 offen offset:2048 sc1 lds
Maav 68,204,84
VE 14,210
Maav 100,200,88
VE 15,211
Maav 100,204,92
Ra 240,2,22528
Vc 105,14,15
Mvvv 48,16,64
Ra 244,2,30720
v_or3_b32 v7, v7, v104, v105
Mvvv 48,16,68
s_waitcnt lgkmcnt(6)
Ve 8,224
Maav 8,208,64
buffer_load_dwordx4 v4, s[12:15], s39 offen offset:3072 sc1 lds
Maav 8,212,68
s_add_u32 s39, s39, 34816
VE 9,225
Maav 40,208,72
Ra 248,2,23552
Vc 112,8,9
Maav 40,212,76
VE 10,226
Maav 72,208,80
global_load_dword v30, v[28:29], off
Maav 72,212,84
VE 11,227
Maav 104,208,88
Ra 252,2,31744
Vc 113,10,11
Maav 104,212,92
Ra 192,3,0
v_or3_b32 v7, v7, v112, v113
Maav 12,216,64
VE 12,196
Maav 12,220,68
s_add_u32 m0, s44, 131072
s_add_u32 s3, s5, 0
Ve 13,197
Maav 44,216,72
buffer_load_dwordx4 v24, s[24:27], s3 offen offset:0 lds
Maav 44,220,76
Ra 196,3,1024
Vc 98,12,13
Maav 76,216,80
VE 14,198
Maav 76,220,84
VE 15,199
Maav 108,216,88
s_add_u32 s3, s5, 27648
Ra 200,3,2048
Vc 99,14,15
Maav 108,220,92
buffer_load_dwordx4 v24, s[24:27], s3 offen offset:1024 lds
Mvvv 52,16,72
Ra 204,3,3072
v_or3_b32 v7, v7, v98, v99
Mvvv 52,16,76
s_waitcnt lgkmcnt(8)
Ve 8,212
Maav 16,224,64
VE 9,213
Maav 16,228,68
s_add_u32 s3, s5, 55296
Ra 208,3,4096
Vc 106,8,9
Maav 48,224,72
buffer_load_dwordx4 v25, s[24:27], s3 offen offset:2048 lds
Maav 48,228,76
VE 10,214
Maav 80,224,80
VE 11,215
Maav 80,228,84
Ra 212,3,5120
Vc 107,10,11
Maav 112,224,88
s_add_u32 s3, s5, 82944
Ra 216,3,6144
v_or3_b32 v7, v7, v106, v107
Maav 112,228,92
buffer_load_dwordx4 v25, s[24:27], s3 offen offset:3072 lds
Maav 20,232,64
VE 12,228
Maav 20,236,68
VE 13,229
Maav 52,232,72
Ra 220,3,7168
Vc 114,12,13
Maav 52,236,76
VE 14,230
Maav 84,232,80
s_add_u32 m0, s44, 147456
s_add_u32 s3, s5, 458752
VE 15,231
Maav 84,236,84
buffer_load_dwordx4 v24, s[24:27], s3 offen offset:0 lds
Maav 116,232,88
VE 8,200
Maav 116,236,92
VE 9,201
Mvvv 56,16,80
VE 10,202
Mvvv 56,16,84
s_waitcnt lgkmcnt(8)
Ve 11,203
Maav 24,240,64
s_add_u32 s3, s5, 486400
Vc 115,14,15
Vc 100,8,9
Maav 24,244,68
buffer_load_dwordx4 v24, s[24:27], s3 offen offset:1024 lds
Maav 56,240,72
VE 12,216
Maav 56,244,76
VE 13,217
Maav 88,240,80
s_add_u32 s3, s5, 514048
Vc 101,10,11
Vc 108,12,13
Maav 88,244,84
buffer_load_dwordx4 v25, s[24:27], s3 offen offset:2048 lds
Maav 120,240,88
VE 14,218
Maav 120,244,92
VE 15,219
Maav 28,248,64
Vc 109,14,15
v_or3_b32 v7, v7, v114, v115
Maav 28,252,68
s_add_u32 s3, s5, 541696
VE 8,232
Maav 60,248,72
buffer_load_dwordx4 v25, s[24:27], s3 offen offset:3072 lds
Maav 60,252,76
VE 9,233
Maav 92,248,80
Vc 116,8,9
v_or3_b32 v7, v7, v100, v101
Maav 92,252,84
VE 10,234
Maav 124,248,88
VE 11,235
Maav 124,252,92
Vc 117,10,11
v_or3_b32 v7, v7, v108, v109
Mvvv 60,16,88
s_waitcnt lgkmcnt(4)
v_or3_b32 v7, v7, v116, v117
Mvvv 60,16,92
Ve 12,204
Cvaa 128,192,128,32
s_add_u32 m0, s53, 32768
VE 13,205
Mvaa 128,196,132
buffer_load_dwordx4 v4, s[12:15], s38 offen offset:0 sc1 lds
Mvaa 128,200,136
Ra 224,3,8192
Vc 102,12,13
Mvaa 128,204,140
VE 14,206
Cvaa 144,192,144,36
VE 15,207
Mvaa 144,196,148
Ra 228,3,9216
Vc 103,14,15
Mvaa 144,200,152
Ra 232,3,10240
v_or3_b32 v7, v7, v102, v103
Mvaa 144,204,156
s_waitcnt lgkmcnt(3)
Ra 236,3,11264
Ra 240,3,12288
Cvaa 132,208,128,32
buffer_load_dwordx4 v4, s[12:15], s38 offen offset:1024 sc1 lds
Mvaa 132,212,132
Ve 8,220
Mvaa 132,216,136
VE 9,221
Mvaa 132,220,140
Ra 244,3,13312
Vc 110,8,9
Cvaa 148,208,144,36
VE 10,222
Mvaa 148,212,148
buffer_load_dwordx4 v4, s[12:15], s38 offen offset:2048 sc1 lds
Mvaa 148,216,152
VE 11,223
Mvaa 148,220,156
s_waitcnt lgkmcnt(2)
Ra 248,3,14336
Ra 252,3,15360
Cvaa 136,224,128,32
Ra 192,2,49152
Vc 111,10,11
Mvaa 136,228,132
Ra 196,2,57344
v_or3_b32 v7, v7, v110, v111
Mvaa 136,232,136
Ve 12,236
Mvaa 136,236,140
buffer_load_dwordx4 v4, s[12:15], s38 offen offset:3072 sc1 lds
Cvaa 152,224,144,36
VE 13,237
Mvaa 152,228,148
Ra 200,2,50176
Vc 118,12,13
Mvaa 152,232,152
VE 14,238
Mvaa 152,236,156
s_waitcnt lgkmcnt(3)
Ra 204,2,58368
Ra 208,2,51200
Cvaa 140,240,128,32
Ve 15,239
Mvaa 140,244,132
Ra 212,2,59392
Vc 119,14,15
Mvaa 140,248,136
Ra 216,2,52224
v_or3_b32 v7, v7, v118, v119
Mvaa 140,252,140
s_waitcnt vmcnt(12)
Ra 220,2,60416
v_and_b32 v1, 0x40004000, v7
Cvaa 156,240,144,36
s_cmp_eq_u32 s37, s45
v_cmp_ne_u32 vcc, 0, v1
Mvaa 156,244,148
s_barrier
Mvaa 156,248,152
s_waitcnt lgkmcnt(4)
Mvaa 156,252,156
s_cbranch_vccnz L_k2_fb_tr
L_k2_fbr_tr:
Maav 0,192,96
s_cbranch_scc1 L_k2_mk_tr
L_k2_mkr_tr:
Ve 8,128
Maav 0,196,100
s_add_u32 m0, s53, 16384
VE 9,129
Maav 32,192,104
buffer_load_dwordx4 v4, s[12:15], s39 offen offset:0 sc1 lds
Maav 32,196,108
s_add_u32 s37, s37, 1
Ra 224,2,53248
Vc 64,8,9
Maav 64,192,112
s_add_u32 s38, s38, 34816
Ve 10,130
Maav 64,196,116
s_xor_b32 s53, s53, 65536
VE 11,131
Maav 4,200,96
s_xor_b32 s54, s54, 65536
Ra 228,2,61440
Vc 65,10,11
Maav 4,204,100
Ra 232,2,54272
v_or_b32_e64 v7, v64, v65
Maav 36,200,104
VE 12,144
Maav 36,204,108
VE 13,145
Maav 68,200,112
Ra 236,2,62464
Vc 72,12,13
Maav 68,204,116
VE 14,146
Mvvv 48,16,96
VE 15,147
Mvvv 48,16,100
s_waitcnt lgkmcnt(4)
Ra 240,2,55296
Vc 73,14,15
Maav 8,208,96
buffer_load_dwordx4 v4, s[12:15], s39 offen offset:1024 sc1 lds
Maav 8,212,100
Ra 244,2,63488
v_or3_b32 v7, v7, v72, v73
Maav 40,208,104
Ve 8,132
Maav 40,212,108
VE 9,133
Maav 72,208,112
Ra 248,2,56320
Vc 66,8,9
Maav 72,212,116
VE 10,134
Maav 12,216,96
VE 11,135
Maav 12,220,100
Ra 252,2,64512
Vc 67,10,11
Maav 44,216,104
Ra 192,3,32768
v_or3_b32 v7, v7, v66, v67
Maav 44,220,108
VE 12,148
Maav 76,216,112
VE 13,149
Maav 76,220,116
Ra 196,3,33792
Vc 74,12,13
Mvvv 52,16,104
VE 14,150
Mvvv 52,16,108
s_waitcnt lgkmcnt(6)
Ve 15,151
Maav 16,224,96
buffer_load_dwordx4 v4, s[12:15], s39 offen offset:2048 sc1 lds
Maav 16,228,100
Ra 200,3,34816
Vc 75,14,15
Maav 48,224,104
Ra 204,3,35840
v_or3_b32 v7, v7, v74, v75
Maav 48,228,108
VE 8,136
Maav 80,224,112
Ra 208,3,36864
Ra 212,3,37888
Maav 80,228,116
Ra 216,3,38912
Ra 220,3,39936
Maav 20,232,96
Maav 20,236,100
Maav 52,232,104
Maav 52,236,108
Maav 84,232,112
Maav 84,236,116
buffer_load_dwordx4 v4, s[12:15], s39 offen offset:3072 sc1 lds
Mvvv 56,16,112
s_add_u32 s39, s39, 34816
Mvvv 56,16,116
s_waitcnt lgkmcnt(8)
Maav 24,240,96
Maav 24,244,100
Maav 56,240,104
Maav 56,244,108
Maav 88,240,112
Maav 88,244,116
Maav 28,248,96
Maav 28,252,100
Maav 60,248,104
Maav 60,252,108
Maav 92,248,112
s_waitcnt lgkmcnt(4)
Maav 92,252,116
s_getpc_b64 s[56:57]
L_cpf4:
s_add_u32 s56, s56, (L_k2_fin-L_cpf4)&0xffffffff
s_addc_u32 s57, s57, ((L_k2_fin-L_cpf4)>>32)&0xffffffff
s_lshr_b32 s58, s2, 3
s_lshl_b32 s58, s58, 2
s_add_u32 s58, s58, s32
s_lshl_b32 s58, s58, 10
v_and_b32 v162, 7, v0
v_lshlrev_b32 v162, 7, v162
v_add_u32 v162, s58, v162
v_min_u32 v162, L_p4_end-L_k2_fin-4, v162
v_mov_b32 v161, s57
v_add_co_u32 v160, vcc, s56, v162
s_nop 1
v_addc_co_u32 v161, vcc, 0, v161, vcc
global_load_dword v164, v[160:161], off
s_waitcnt vmcnt(9)
s_lshl_b32 s3, s34, 20
s_lshl_b32 s47, s33, 15
s_add_u32 s3, s3, s47
s_lshl_b32 s47, s32, 10
v_lshlrev_b32 v248, 4, v0
v_add_u32_e64 v249, s47, v248
s_sub_u32 s47, 7168, s47
v_add_u32 v248, s47, v248
v_rcp_f32 v250, v56
v_rcp_f32 v252, v60
v_mov_b32 v251, v250
v_mov_b32_e64 v253, v252
Ar 240,96
Ar 241,97
Ar 242,98
Ar 243,99
Ar 244,100
Ar 245,101
Ar 246,102
Ar 247,103
v_pk_mul_f32 v[240:241], v[240:241], v[252:253]
v_pk_mul_f32 v[242:243], v[242:243], v[252:253]
v_pk_mul_f32 v[244:245], v[244:245], v[252:253]
v_pk_mul_f32 v[246:247], v[246:247], v[252:253]
Vc 28,240,241
Vc 29,242,243
Vc 30,244,245
Vc 31,246,247
buffer_store_dwordx4 v[28:31], v249, s[16:19], s3 offen sc1
Ar 240,64
Ar 241,65
Ar 242,66
Ar 243,67
Ar 244,68
Ar 245,69
Ar 246,70
Ar 247,71
v_pk_mul_f32 v[240:241], v[240:241], v[250:251]
v_pk_mul_f32 v[242:243], v[242:243], v[250:251]
v_pk_mul_f32 v[244:245], v[244:245], v[250:251]
v_pk_mul_f32 v[246:247], v[246:247], v[250:251]
Vc 24,240,241
Vc 25,242,243
Vc 26,244,245
Vc 27,246,247
buffer_store_dwordx4 v[24:27], v248, s[16:19], s3 offen sc1
s_add_u32 s3, s3, 8192
Ar 240,104
Ar 241,105
Ar 242,106
Ar 243,107
Ar 244,108
Ar 245,109
Ar 246,110
Ar 247,111
v_pk_mul_f32 v[240:241], v[240:241], v[252:253]
v_pk_mul_f32 v[242:243], v[242:243], v[252:253]
v_pk_mul_f32 v[244:245], v[244:245], v[252:253]
v_pk_mul_f32 v[246:247], v[246:247], v[252:253]
Vc 28,240,241
Vc 29,242,243
Vc 30,244,245
Vc 31,246,247
buffer_store_dwordx4 v[28:31], v249, s[16:19], s3 offen sc1
Ar 240,72
Ar 241,73
Ar 242,74
Ar 243,75
Ar 244,76
Ar 245,77
Ar 246,78
Ar 247,79
v_pk_mul_f32 v[240:241], v[240:241], v[250:251]
v_pk_mul_f32 v[242:243], v[242:243], v[250:251]
v_pk_mul_f32 v[244:245], v[244:245], v[250:251]
v_pk_mul_f32 v[246:247], v[246:247], v[250:251]
Vc 24,240,241
Vc 25,242,243
Vc 26,244,245
Vc 27,246,247
buffer_store_dwordx4 v[24:27], v248, s[16:19], s3 offen sc1
s_add_u32 s3, s3, 8192
Ar 240,112
Ar 241,113
Ar 242,114
Ar 243,115
Ar 244,116
Ar 245,117
Ar 246,118
Ar 247,119
v_pk_mul_f32 v[240:241], v[240:241], v[252:253]
v_pk_mul_f32 v[242:243], v[242:243], v[252:253]
v_pk_mul_f32 v[244:245], v[244:245], v[252:253]
v_pk_mul_f32 v[246:247], v[246:247], v[252:253]
Vc 28,240,241
Vc 29,242,243
Vc 30,244,245
Vc 31,246,247
buffer_store_dwordx4 v[28:31], v249, s[16:19], s3 offen sc1
Ar 240,80
Ar 241,81
Ar 242,82
Ar 243,83
Ar 244,84
Ar 245,85
Ar 246,86
Ar 247,87
v_pk_mul_f32 v[240:241], v[240:241], v[250:251]
v_pk_mul_f32 v[242:243], v[242:243], v[250:251]
v_pk_mul_f32 v[244:245], v[244:245], v[250:251]
v_pk_mul_f32 v[246:247], v[246:247], v[250:251]
Vc 24,240,241
Vc 25,242,243
Vc 26,244,245
Vc 27,246,247
buffer_store_dwordx4 v[24:27], v248, s[16:19], s3 offen sc1
s_add_u32 s3, s3, 8192
Ar 240,120
Ar 241,121
Ar 242,122
Ar 243,123
Ar 244,124
Ar 245,125
Ar 246,126
Ar 247,127
v_pk_mul_f32 v[240:241], v[240:241], v[252:253]
v_pk_mul_f32 v[242:243], v[242:243], v[252:253]
v_pk_mul_f32 v[244:245], v[244:245], v[252:253]
v_pk_mul_f32 v[246:247], v[246:247], v[252:253]
Vc 28,240,241
Vc 29,242,243
Vc 30,244,245
Vc 31,246,247
buffer_store_dwordx4 v[28:31], v249, s[16:19], s3 offen sc1
Ar 240,88
Ar 241,89
Ar 242,90
Ar 243,91
Ar 244,92
Ar 245,93
Ar 246,94
Ar 247,95
v_pk_mul_f32 v[240:241], v[240:241], v[250:251]
v_pk_mul_f32 v[242:243], v[242:243], v[250:251]
v_pk_mul_f32 v[244:245], v[244:245], v[250:251]
v_pk_mul_f32 v[246:247], v[246:247], v[250:251]
Vc 24,240,241
Vc 25,242,243
Vc 26,244,245
Vc 27,246,247
buffer_store_dwordx4 v[24:27], v248, s[16:19], s3 offen sc1
s_add_u32 s52, s37, 2
s_load_dwordx2 s[94:95], s[0:1], 40
s_load_dwordx2 s[40:41], s[0:1], 0
s_load_dwordx4 s[8:11], s[0:1], 80
s_waitcnt vmcnt(8) lgkmcnt(0)
s_cmp_eq_u32 s34, 7
s_cbranch_scc1 L_k2_fin
L_k2_nloop:
v_xor_b32 v2, 65536, v2
v_xor_b32 v3, 65536, v3
Cvaa 192,192,128,32
s_mov_b32 m0, s53
Ve 9,137
Mvaa 192,196,132
buffer_load_dwordx4 v4, s[12:15], s38 offen offset:0 sc1 lds
Mvaa 192,200,136
Ra 224,2,40960
Vc 68,8,9
Mvaa 192,204,140
VE 10,138
Cvaa 208,192,144,36
VE 11,139
Mvaa 208,196,148
Ra 228,2,41984
Vc 69,10,11
Mvaa 208,200,152
Ra 232,2,43008
v_or3_b32 v7, v7, v68, v69
Mvaa 208,204,156
s_waitcnt lgkmcnt(3)
Ra 236,2,44032
Ra 240,2,45056
Cvaa 196,208,128,32
buffer_load_dwordx4 v4, s[12:15], s38 offen offset:1024 sc1 lds
Mvaa 196,212,132
Ve 12,152
Mvaa 196,216,136
VE 13,153
Mvaa 196,220,140
Ra 244,2,46080
Vc 76,12,13
Cvaa 212,208,144,36
VE 14,154
Mvaa 212,212,148
buffer_load_dwordx4 v4, s[12:15], s38 offen offset:2048 sc1 lds
Mvaa 212,216,152
VE 15,155
Mvaa 212,220,156
s_waitcnt lgkmcnt(2)
Ra 248,2,47104
Ra 252,2,48128
Cvaa 200,224,128,32
Ra 192,2,16384
Vc 77,14,15
Mvaa 200,228,132
Ra 196,2,24576
v_or3_b32 v7, v7, v76, v77
Mvaa 200,232,136
Ve 8,140
Mvaa 200,236,140
buffer_load_dwordx4 v4, s[12:15], s38 offen offset:3072 sc1 lds
Cvaa 216,224,144,36
VE 9,141
Mvaa 216,228,148
Ra 200,2,17408
Vc 70,8,9
Mvaa 216,232,152
VE 10,142
Mvaa 216,236,156
s_waitcnt lgkmcnt(3)
Ra 204,2,25600
Ra 208,2,18432
Cvaa 204,240,128,32
Ve 11,143
Mvaa 204,244,132
s_cmp_lt_u32 s37, s52
Ra 212,2,26624
Vc 71,10,11
Mvaa 204,248,136
s_cbranch_scc1 L_nw_ne
s_waitcnt vmcnt(12)
L_nw_ne:
Ra 216,2,19456
v_or3_b32 v7, v7, v70, v71
Mvaa 204,252,140
Ve 12,156
Cvaa 220,240,144,36
VE 13,157
Mvaa 220,244,148
s_barrier
Ra 220,2,27648
Vc 78,12,13
Mvaa 220,248,152
s_waitcnt lgkmcnt(4)
Ve 14,158
Ve 15,159
s_nop 0
Vc 79,14,15
v_or3_b32 v7, v7, v78, v79
v_and_b32 v1, 0x40004000, v7
v_cmp_ne_u32 vcc, 0, v1
Mvaa 220,252,156
s_cbranch_vccnz L_k2_fb_ne
L_k2_fbr_ne:
Maav 0,192,64
Ve 8,192
Maav 0,196,68
s_add_u32 m0, s54, 49152
VE 9,193
Maav 32,192,72
buffer_load_dwordx4 v4, s[12:15], s39 offen offset:0 sc1 lds
Maav 32,196,76
s_cmp_eq_u32 s37, s52
Ra 224,2,20480
Vc 96,8,9
Maav 4,200,64
s_cbranch_scc1 L_pubB
L_pubBr:
VE 10,194
Maav 4,204,68
s_add_u32 s37, s37, 1
Ve 11,195
Maav 36,200,72
s_add_u32 s38, s38, 34816
Ra 228,2,28672
Vc 97,10,11
Maav 36,204,76
Ra 232,2,21504
v_or_b32_e64 v7, v96, v97
Mvvv 48,16,64
VE 12,208
Mvvv 48,16,68
s_waitcnt lgkmcnt(3)
Ra 236,2,29696
Ra 240,2,22528
Maav 8,208,64
buffer_load_dwordx4 v4, s[12:15], s39 offen offset:1024 sc1 lds
Maav 8,212,68
Ve 13,209
Maav 40,208,72
Ra 244,2,30720
Vc 104,12,13
Maav 40,212,76
VE 14,210
Maav 12,216,64
VE 15,211
Maav 12,220,68
Ra 248,2,23552
Vc 105,14,15
Maav 44,216,72
Ra 252,2,31744
v_or3_b32 v7, v7, v104, v105
Maav 44,220,76
VE 8,196
Mvvv 52,16,72
buffer_load_dwordx4 v4, s[12:15], s39 offen offset:2048 sc1 lds
Mvvv 52,16,76
s_waitcnt lgkmcnt(4)
Ve 9,197
Maav 16,224,64
Ra 192,3,0
Vc 98,8,9
Maav 16,228,68
VE 10,198
Maav 48,224,72
VE 11,199
Maav 48,228,76
Ra 196,3,1024
Vc 99,10,11
Maav 20,232,64
Ra 200,3,2048
v_or3_b32 v7, v7, v98, v99
Maav 20,236,68
Ra 204,3,3072
Ra 208,3,4096
Maav 52,232,72
buffer_load_dwordx4 v4, s[12:15], s39 offen offset:3072 sc1 lds
Maav 52,236,76
s_waitcnt lgkmcnt(5)
Ve 12,212
Maav 24,240,64
s_add_u32 s39, s39, 34816
VE 13,213
Maav 24,244,68
Ra 212,3,5120
Vc 106,12,13
Maav 56,240,72
VE 14,214
Maav 56,244,76
VE 15,215
Maav 28,248,64
Ra 216,3,6144
Vc 107,14,15
Maav 28,252,68
Ra 220,3,7168
v_or3_b32 v7, v7, v106, v107
Maav 60,248,72
s_waitcnt lgkmcnt(4)
Ve 8,200
Maav 60,252,76
VE 9,201
Cvaa 128,192,128,32
s_add_u32 m0, s53, 32768
Ra 224,3,8192
Vc 100,8,9
Mvaa 128,196,132
buffer_load_dwordx4 v4, s[12:15], s38 offen offset:0 sc1 lds
Mvaa 128,200,136
VE 10,202
Mvaa 128,204,140
VE 11,203
Cvaa 144,192,144,36
Ra 228,3,9216
Vc 101,10,11
Mvaa 144,196,148
Ra 232,3,10240
v_or3_b32 v7, v7, v100, v101
Mvaa 144,200,152
VE 12,216
Mvaa 144,204,156
s_waitcnt lgkmcnt(3)
Ra 236,3,11264
Ra 240,3,12288
Cvaa 132,208,128,32
buffer_load_dwordx4 v4, s[12:15], s38 offen offset:1024 sc1 lds
Mvaa 132,212,132
Ve 13,217
Mvaa 132,216,136
Ra 244,3,13312
Vc 108,12,13
Mvaa 132,220,140
VE 14,218
Cvaa 148,208,144,36
VE 15,219
Mvaa 148,212,148
buffer_load_dwordx4 v4, s[12:15], s38 offen offset:2048 sc1 lds
Mvaa 148,216,152
Ra 248,3,14336
Vc 109,14,15
Mvaa 148,220,156
s_waitcnt lgkmcnt(3)
Ra 252,3,15360
v_or3_b32 v7, v7, v108, v109
Cvaa 136,224,128,32
Ve 8,204
Mvaa 136,228,132
VE 9,205
Mvaa 136,232,136
Ra 192,2,49152
Vc 102,8,9
Mvaa 136,236,140
buffer_load_dwordx4 v4, s[12:15], s38 offen offset:3072 sc1 lds
Cvaa 152,224,144,36
VE 10,206
Mvaa 152,228,148
VE 11,207
Mvaa 152,232,152
Ra 196,2,57344
Vc 103,10,11
Mvaa 152,236,156
s_waitcnt lgkmcnt(2)
Ra 200,2,50176
Ra 204,2,58368
Cvaa 140,240,128,32
Ra 208,2,51200
v_or3_b32 v7, v7, v102, v103
Mvaa 140,244,132
s_cmp_lt_u32 s37, s52
VE 12,220
Mvaa 140,248,136
s_cbranch_scc1 L_nw_no
s_waitcnt vmcnt(12)
L_nw_no:
VE 13,221
Mvaa 140,252,140
Ra 212,2,59392
Vc 110,12,13
Cvaa 156,240,144,36
s_cmp_eq_u32 s37, s45
Ve 14,222
Mvaa 156,244,148
s_barrier
Ve 15,223
Mvaa 156,248,152
s_waitcnt lgkmcnt(2)
Ra 216,2,52224
Vc 111,14,15
v_or3_b32 v7, v7, v110, v111
v_and_b32 v1, 0x40004000, v7
v_cmp_ne_u32 vcc, 0, v1
Mvaa 156,252,156
s_cbranch_vccnz L_k2_fb_no
L_k2_fbr_no:
Ra 220,2,60416
Maav 0,192,96
s_cbranch_scc1 L_k2_mk_no
L_k2_mkr_no:
VE 8,128
Maav 0,196,100
s_add_u32 m0, s53, 16384
VE 9,129
Maav 32,192,104
buffer_load_dwordx4 v4, s[12:15], s39 offen offset:0 sc1 lds
Maav 32,196,108
s_add_u32 s37, s37, 1
Ra 224,2,53248
Vc 64,8,9
Maav 4,200,96
s_add_u32 s38, s38, 34816
Ve 10,130
Maav 4,204,100
s_xor_b32 s53, s53, 65536
VE 11,131
Maav 36,200,104
s_xor_b32 s54, s54, 65536
Ra 228,2,61440
Vc 65,10,11
Maav 36,204,108
Ra 232,2,54272
v_or_b32_e64 v7, v64, v65
Mvvv 48,16,96
VE 12,144
Mvvv 48,16,100
s_waitcnt lgkmcnt(3)
Ra 236,2,62464
Ra 240,2,55296
Maav 8,208,96
buffer_load_dwordx4 v4, s[12:15], s39 offen offset:1024 sc1 lds
Maav 8,212,100
Ve 13,145
Maav 40,208,104
Ra 244,2,63488
Vc 72,12,13
Maav 40,212,108
VE 14,146
Maav 12,216,96
VE 15,147
Maav 12,220,100
Ra 248,2,56320
Vc 73,14,15
Maav 44,216,104
Ra 252,2,64512
v_or3_b32 v7, v7, v72, v73
Maav 44,220,108
VE 8,132
Mvvv 52,16,104
buffer_load_dwordx4 v4, s[12:15], s39 offen offset:2048 sc1 lds
Mvvv 52,16,108
s_waitcnt lgkmcnt(4)
Ve 9,133
Maav 16,224,96
Ra 192,3,32768
Vc 66,8,9
Maav 16,228,100
VE 10,134
Maav 48,224,104
VE 11,135
Maav 48,228,108
Ra 196,3,33792
Vc 67,10,11
Maav 20,232,96
Ra 200,3,34816
v_or3_b32 v7, v7, v66, v67
Maav 20,236,100
Ra 204,3,35840
Ra 208,3,36864
Maav 52,232,104
buffer_load_dwordx4 v4, s[12:15], s39 offen offset:3072 sc1 lds
Maav 52,236,108
s_waitcnt lgkmcnt(5)
Ve 12,148
Maav 24,240,96
s_add_u32 s39, s39, 34816
VE 13,149
Maav 24,244,100
Ra 212,3,37888
Vc 74,12,13
Maav 56,240,104
VE 14,150
Maav 56,244,108
VE 15,151
Maav 28,248,96
Ra 216,3,38912
Vc 75,14,15
Maav 28,252,100
s_cmp_lg_u32 s37, s36
Ra 220,3,39936
v_or3_b32 v7, v7, v74, v75
Maav 60,248,104
s_waitcnt lgkmcnt(4)
VE 8,136
Maav 60,252,108
s_cbranch_scc1 L_k2_nloop
L_k2_fin:
s_getpc_b64 s[56:57]
L_cpf5:
s_add_u32 s56, s56, (L_p4_entry-L_cpf5)&0xffffffff
s_addc_u32 s57, s57, ((L_p4_entry-L_cpf5)>>32)&0xffffffff
s_lshl_b32 s58, s32, 13
v_lshlrev_b32 v162, 7, v0
v_add_u32_e64 v162, s58, v162
v_min_u32 v162, L_p4_end-L_p4_entry-4, v162
v_mov_b32 v161, s57
v_add_co_u32 v160, vcc, s56, v162
s_nop 1
v_addc_co_u32 v161, vcc, 0, v161, vcc
global_load_dword v164, v[160:161], off
v_xor_b32 v2, 65536, v2
v_xor_b32 v3, 65536, v3
s_lshr_b32 s3, s42, 4
s_mul_i32 s3, s3, 33792
s_and_b32 s47, s42, 15
s_lshl_b32 s47, s47, 4
s_add_u32 s3, s3, s47
v_mov_b32 v28, s3
s_lshr_b32 s3, s43, 4
s_mul_i32 s3, s3, 33792
s_and_b32 s47, s43, 15
s_lshl_b32 s47, s47, 4
s_add_u32 s3, s3, s47
v_mov_b32 v29, s3
v_lshrrev_b32 v24, 4, v0
v_and_b32 v25, 15, v0
v_cmp_eq_u32 vcc, 1, v25
s_lshl_b32 s3, s32, 4
v_add_u32 v26, s3, v24
v_cndmask_b32 v28, v28, v29, vcc
v_lshl_add_u32 v28, v24, 8, v28
v_mul_u32_u24 v26, 7168, v26
v_lshlrev_b32 v24, 1, v24
v_xor_b32 v24, v24, v25
v_xor_b32_e64 v25, 8, v24
v_lshl_add_u32 v24, v24, 4, v26
v_lshl_add_u32 v25, v25, 4, v26
s_lshl_b32 s3, s92, 12
buffer_load_dwordx4 a[160:163], v28, s[20:23], s3 offen offset:0 sc1
buffer_load_dwordx4 a[164:167], v28, s[20:23], s3 offen offset:1024 sc1
buffer_load_dwordx4 a[168:171], v28, s[20:23], s3 offen offset:2048 sc1
buffer_load_dwordx4 a[172:175], v28, s[20:23], s3 offen offset:3072 sc1
Cvaa 192,192,128,32
s_add_u32 m0, s54, 0
s_add_u32 s3, s5, 0
Ve 9,137
Mvaa 192,196,132
buffer_load_dwordx4 v24, s[68:71], s3 offen offset:0 lds
Mvaa 192,200,136
Ra 224,2,40960
Ra 228,2,41984
Mvaa 192,204,140
s_waitcnt lgkmcnt(2)
Ra 232,2,43008
Ra 236,2,44032
Cvaa 196,208,128,32
s_add_u32 s3, s5, 27648
Ra 240,2,45056
Vc 68,8,9
Mvaa 196,212,132
buffer_load_dwordx4 v24, s[68:71], s3 offen offset:1024 lds
Mvaa 196,216,136
Ra 244,2,46080
Ra 248,2,47104
Mvaa 196,220,140
s_waitcnt lgkmcnt(3)
s_add_u32 s3, s5, 55296
Ra 252,2,48128
Ra 192,2,16384
Cvaa 200,224,128,32
buffer_load_dwordx4 v25, s[68:71], s3 offen offset:2048 lds
Mvaa 200,228,132
s_cmp_lt_u32 s37, s52
Ve 10,138
Mvaa 200,232,136
s_cbranch_scc1 L_nw_nl
s_waitcnt vmcnt(15)
L_nw_nl:
Ra 196,2,24576
Ra 200,2,17408
Mvaa 200,236,140
s_waitcnt lgkmcnt(3)
s_add_u32 s3, s5, 82944
Ra 204,2,25600
Ra 208,2,18432
Cvaa 204,240,128,32
buffer_load_dwordx4 v25, s[68:71], s3 offen offset:3072 lds
Mvaa 204,244,132
s_barrier
VE 11,139
Mvaa 204,248,136
s_waitcnt lgkmcnt(1)
Ra 212,2,26624
Vc 69,10,11
Ve 12,152
Ve 13,153
Ve 14,154
Ve 15,155
Ve 8,140
Ve 9,141
Ve 10,142
VE 11,143
Vc 76,12,13
Ve 12,156
Ve 13,157
Vc 77,14,15
Ve 14,158
Ve 15,159
Vc 70,8,9
Vc 71,10,11
Vc 78,12,13
Vc 79,14,15
v_or3_b32 v7, v7, v68, v69
v_or3_b32 v7, v7, v76, v77
v_or3_b32 v7, v7, v70, v71
v_or3_b32 v7, v7, v78, v79
v_and_b32 v1, 0x40004000, v7
v_cmp_ne_u32 vcc, 0, v1
Mvaa 204,252,140
s_cbranch_vccnz L_k2_fb_nl
L_k2_fbr_nl:
Ra 216,2,19456
Ra 220,2,27648
Maav 0,192,64
v_cmp_gt_i32 s[56:57], 0, v6
v_cmp_gt_i32 s[58:59], 1, v6
v_cmp_gt_i32 s[60:61], 2, v6
v_cmp_gt_i32 s[62:63], 3, v6
s_nop 3
s_nop 0
v_cndmask_b32 v192, v192, v20, s[56:57]
v_cndmask_b32 v193, v193, v20, s[58:59]
v_cndmask_b32 v194, v194, v20, s[60:61]
v_cndmask_b32 v195, v195, v20, s[62:63]
v_cmp_gt_i32 s[56:57], 16, v6
v_cmp_gt_i32 s[58:59], 17, v6
v_cmp_gt_i32 s[60:61], 18, v6
v_cmp_gt_i32 s[62:63], 19, v6
v_cndmask_b32 v196, v196, v20, s[56:57]
v_cndmask_b32 v197, v197, v20, s[58:59]
v_cndmask_b32 v198, v198, v20, s[60:61]
v_cndmask_b32 v199, v199, v20, s[62:63]
v_cmp_gt_i32 s[56:57], 32, v6
v_cmp_gt_i32 s[58:59], 33, v6
v_cmp_gt_i32 s[60:61], 34, v6
v_cmp_gt_i32 s[62:63], 35, v6
v_cndmask_b32 v200, v200, v20, s[56:57]
v_cndmask_b32 v201, v201, v20, s[58:59]
v_cndmask_b32 v202, v202, v20, s[60:61]
v_cndmask_b32 v203, v203, v20, s[62:63]
v_cmp_gt_i32 s[56:57], 48, v6
v_cmp_gt_i32 s[58:59], 49, v6
v_cmp_gt_i32 s[60:61], 50, v6
v_cmp_gt_i32 s[62:63], 51, v6
v_cndmask_b32 v204, v204, v20, s[56:57]
v_cndmask_b32 v205, v205, v20, s[58:59]
v_cndmask_b32 v206, v206, v20, s[60:61]
v_cndmask_b32 v207, v207, v20, s[62:63]
VE 8,192
Maav 0,196,68
s_add_u32 m0, s54, 16384
s_add_u32 s3, s5, 458752
VE 9,193
Maav 32,192,72
buffer_load_dwordx4 v24, s[68:71], s3 offen offset:0 lds
Maav 32,196,76
s_mov_b32 s60, s8
Ra 224,2,20480
Vc 96,8,9
Maav 4,200,64
s_and_b32 s61, s9, 0xffff
s_mov_b32 s62, 7340032
Ve 10,194
Maav 4,204,68
s_mov_b32 s63, 0x20000
s_mov_b32 s56, s40
Ve 11,195
Maav 36,200,72
s_and_b32 s57, s41, 0xffff
Ra 228,2,28672
Vc 97,10,11
Maav 36,204,76
s_mov_b32 s58, 4194304
Ra 232,2,21504
v_or_b32_e64 v7, v96, v97
Mvvv 48,16,64
s_mov_b32 s59, 0x20000
s_bfe_u32 s6, s2, 0x20001
VE 12,196
Mvvv 48,16,68
s_waitcnt lgkmcnt(3)
s_add_u32 s3, s5, 486400
Ra 236,2,29696
Ra 240,2,22528
Maav 8,208,64
buffer_load_dwordx4 v24, s[68:71], s3 offen offset:1024 lds
Maav 8,212,68
s_lshr_b32 s7, s34, 1
s_xor_b32 s7, s7, 2
Ve 13,197
Maav 40,208,72
s_lshl_b32 s45, s7, 2
Ra 244,2,30720
Vc 98,12,13
Maav 40,212,76
s_add_u32 s46, s45, s6
s_sub_u32 s46, 15, s46
Ve 14,198
Maav 12,216,64
s_sub_u32 s45, 12, s45
s_add_u32 s45, s45, s6
VE 15,199
Maav 12,220,68
s_cmp_lt_u32 s7, 2
s_cselect_b32 s45, s46, s45
Ra 248,2,23552
Vc 99,14,15
Maav 44,216,72
s_and_b32 s46, s2, 1
Ra 252,2,31744
v_or3_b32 v7, v7, v98, v99
Maav 44,220,76
s_add_u32 s3, s5, 514048
Ve 8,200
Mvvv 52,16,72
buffer_load_dwordx4 v25, s[68:71], s3 offen offset:2048 lds
Mvvv 52,16,76
s_waitcnt lgkmcnt(4)
Ve 9,201
Maav 16,224,64
s_bfe_u32 s6, s2, 0x30003
Ra 192,2,49152
Vc 100,8,9
Maav 16,228,68
s_lshl_b32 s6, s6, 1
s_add_u32 s46, s46, s6
VE 10,202
Maav 48,224,72
s_mov_b32 s48, 0
s_mov_b32 s49, 15360
Ve 11,203
Maav 48,228,76
s_mov_b32 s50, 30720
Ra 196,2,57344
Vc 101,10,11
Maav 20,232,64
s_mov_b32 s51, 46080
Ra 200,2,50176
v_or3_b32 v7, v7, v100, v101
Maav 20,236,68
s_add_u32 s3, s5, 541696
Ra 204,2,58368
Ra 208,2,51200
Maav 52,232,72
buffer_load_dwordx4 v25, s[68:71], s3 offen offset:3072 lds
Maav 52,236,76
s_waitcnt lgkmcnt(5)
Ve 12,204
Maav 24,240,64
s_lshl_b32 s35, s32, 13
s_add_u32 s35, s35, 131072
Ve 13,205
Maav 24,244,68
s_and_b32 s52, s46, 1
Ra 212,2,59392
Vc 102,12,13
Maav 56,240,72
s_lshl_b32 s37, s45, 20
s_lshl_b32 s7, s52, 19
Ve 14,206
Maav 56,244,76
s_add_u32 s37, s37, s7
s_add_u32 s37, s37, 46137344
Ve 15,207
Maav 28,248,64
s_lshr_b32 s7, s46, 1
Ra 216,2,52224
Vc 103,14,15
Maav 28,252,68
s_lshl_b32 s7, s7, 8
Ra 220,2,60416
v_or3_b32 v7, v7, v102, v103
Maav 60,248,72
s_waitcnt lgkmcnt(4)
Maav 60,252,76
s_lshl_b32 s6, s52, 22
s_add_u32 s6, s6, s7
v_and_b32 v1, 0x40004000, v7
v_cmp_ne_u32 vcc, 0, v1
s_cbranch_vccnz L_k2_fb_fi
L_k2_fbr_fi:
Maav 0,192,96
Ra 224,2,53248
Ra 228,2,61440
Maav 0,196,100
Ra 232,2,54272
Ra 236,2,62464
Maav 4,200,96
Ra 240,2,55296
Ra 244,2,63488
Maav 4,204,100
Ra 248,2,56320
Ra 252,2,64512
Mvvv 48,16,96
s_add_u32 s12, s94, s6
s_addc_u32 s13, s95, 0
s_and_b32 s13, s13, 0xffff
Mvvv 48,16,100
s_waitcnt lgkmcnt(8)
Maav 8,208,96
s_mov_b32 s14, 0
s_mov_b32 s15, 0x20000
s_sub_u32 s14, 4194304, s7
Maav 8,212,100
s_mov_b32 s28, s94
s_and_b32 s29, s95, 0xffff
s_mov_b32 s30, 8388608
Maav 12,216,96
s_mov_b32 s31, 0x20000
s_lshl_b32 s7, s46, 7
s_lshl_b32 s36, s45, 18
Maav 12,220,100
s_waitcnt lgkmcnt(4)
Maav 16,224,96
s_add_u32 s36, s36, s7
s_and_b32 s94, s7, 128
s_lshl_b32 s38, s45, 7
Maav 16,228,100
s_lshl_b32 s6, s52, 6
s_add_u32 s38, s38, s6
s_add_u32 s38, s38, 5300224
Maav 20,232,96
s_lshl_b32 s52, s32, 11
s_lshl_b32 s6, s32, 16
s_add_u32 s6, s6, s94
Maav 20,236,100
s_waitcnt lgkmcnt(0)
Maav 24,240,96
s_xor_b32 s6, s6, 128
s_lshl_b32 s7, s32, 5
s_mov_b32 s68, s10
Maav 24,244,100
s_and_b32 s69, s11, 0xffff
s_mov_b32 s70, 4194304
s_mov_b32 s71, 0x20000
s_add_u32 s8, s66, s37
s_addc_u32 s9, s67, 0
s_and_b32 s9, s9, 0xffff
Maav 28,248,96
s_mov_b32 s10, 524288
s_mov_b32 s11, 0x20000
v_lshlrev_b32 v112, 4, v0
v_lshrrev_b32_e64 v121, 4, v0
Maav 28,252,100
v_and_b32 v122, 7, v0
v_lshrrev_b32 v123, 3, v0
v_lshlrev_b32 v124, 1, v121
s_nop 7
s_lshl_b32 s3, s55, 20
s_lshl_b32 s47, s33, 15
s_add_u32 s3, s3, s47
s_lshl_b32 s47, s32, 10
v_lshlrev_b32 v248, 4, v0
v_add_u32 v249, s47, v248
s_sub_u32 s47, 7168, s47
v_add_u32 v248, s47, v248
v_rcp_f32 v250, v48
v_rcp_f32 v252, v52
v_mov_b32 v251, v250
v_mov_b32_e64 v253, v252
Ar 240,32
Ar 241,33
Ar 242,34
Ar 243,35
Ar 244,36
Ar 245,37
Ar 246,38
Ar 247,39
v_pk_mul_f32 v[240:241], v[240:241], v[252:253]
v_pk_mul_f32 v[242:243], v[242:243], v[252:253]
v_pk_mul_f32 v[244:245], v[244:245], v[252:253]
v_pk_mul_f32 v[246:247], v[246:247], v[252:253]
Vc 28,240,241
Vc 29,242,243
Vc 30,244,245
Vc 31,246,247
buffer_store_dwordx4 v[28:31], v249, s[16:19], s3 offen sc1
Ar 240,0
Ar 241,1
Ar 242,2
Ar 243,3
Ar 244,4
Ar 245,5
Ar 246,6
Ar 247,7
v_pk_mul_f32 v[240:241], v[240:241], v[250:251]
v_pk_mul_f32 v[242:243], v[242:243], v[250:251]
v_pk_mul_f32 v[244:245], v[244:245], v[250:251]
v_pk_mul_f32 v[246:247], v[246:247], v[250:251]
Vc 24,240,241
Vc 25,242,243
Vc 26,244,245
Vc 27,246,247
buffer_store_dwordx4 v[24:27], v248, s[16:19], s3 offen sc1
s_add_u32 s3, s3, 8192
Ar 240,40
Ar 241,41
Ar 242,42
Ar 243,43
Ar 244,44
Ar 245,45
Ar 246,46
Ar 247,47
v_pk_mul_f32 v[240:241], v[240:241], v[252:253]
v_pk_mul_f32 v[242:243], v[242:243], v[252:253]
v_pk_mul_f32 v[244:245], v[244:245], v[252:253]
v_pk_mul_f32 v[246:247], v[246:247], v[252:253]
Vc 28,240,241
Vc 29,242,243
Vc 30,244,245
Vc 31,246,247
buffer_store_dwordx4 v[28:31], v249, s[16:19], s3 offen sc1
Ar 240,8
Ar 241,9
Ar 242,10
Ar 243,11
Ar 244,12
Ar 245,13
Ar 246,14
Ar 247,15
v_pk_mul_f32 v[240:241], v[240:241], v[250:251]
v_pk_mul_f32 v[242:243], v[242:243], v[250:251]
v_pk_mul_f32 v[244:245], v[244:245], v[250:251]
v_pk_mul_f32 v[246:247], v[246:247], v[250:251]
Vc 24,240,241
Vc 25,242,243
Vc 26,244,245
Vc 27,246,247
buffer_store_dwordx4 v[24:27], v248, s[16:19], s3 offen sc1
s_add_u32 s3, s3, 8192
Ar 240,48
Ar 241,49
Ar 242,50
Ar 243,51
Ar 244,52
Ar 245,53
Ar 246,54
Ar 247,55
v_pk_mul_f32 v[240:241], v[240:241], v[252:253]
v_pk_mul_f32 v[242:243], v[242:243], v[252:253]
v_pk_mul_f32 v[244:245], v[244:245], v[252:253]
v_pk_mul_f32 v[246:247], v[246:247], v[252:253]
Vc 28,240,241
Vc 29,242,243
Vc 30,244,245
Vc 31,246,247
buffer_store_dwordx4 v[28:31], v249, s[16:19], s3 offen sc1
Ar 240,16
Ar 241,17
Ar 242,18
Ar 243,19
Ar 244,20
Ar 245,21
Ar 246,22
Ar 247,23
v_pk_mul_f32 v[240:241], v[240:241], v[250:251]
v_pk_mul_f32 v[242:243], v[242:243], v[250:251]
v_pk_mul_f32 v[244:245], v[244:245], v[250:251]
v_pk_mul_f32 v[246:247], v[246:247], v[250:251]
Vc 24,240,241
Vc 25,242,243
Vc 26,244,245
Vc 27,246,247
buffer_store_dwordx4 v[24:27], v248, s[16:19], s3 offen sc1
s_add_u32 s3, s3, 8192
Ar 240,56
Ar 241,57
Ar 242,58
Ar 243,59
Ar 244,60
Ar 245,61
Ar 246,62
Ar 247,63
v_pk_mul_f32 v[240:241], v[240:241], v[252:253]
v_pk_mul_f32 v[242:243], v[242:243], v[252:253]
v_pk_mul_f32 v[244:245], v[244:245], v[252:253]
v_pk_mul_f32 v[246:247], v[246:247], v[252:253]
Vc 28,240,241
Vc 29,242,243
Vc 30,244,245
Vc 31,246,247
buffer_store_dwordx4 v[28:31], v249, s[16:19], s3 offen sc1
Ar 240,24
Ar 241,25
Ar 242,26
Ar 243,27
Ar 244,28
Ar 245,29
Ar 246,30
Ar 247,31
v_pk_mul_f32 v[240:241], v[240:241], v[250:251]
v_pk_mul_f32 v[242:243], v[242:243], v[250:251]
v_pk_mul_f32 v[244:245], v[244:245], v[250:251]
v_pk_mul_f32 v[246:247], v[246:247], v[250:251]
Vc 24,240,241
Vc 25,242,243
Vc 26,244,245
Vc 27,246,247
buffer_store_dwordx4 v[24:27], v248, s[16:19], s3 offen sc1
s_cmp_lt_u32 s34, 1
s_cbranch_scc1 L_noffn
v_lshrrev_b32_e64 v24, 4, v0
v_bfe_u32 v25, v0, 2, 2
v_lshl_add_u32 v26, v24, 3, v25
v_lshlrev_b32 v26, 8, v26
v_and_b32 v27, 3, v0
v_lshl_add_u32 v26, v27, 3, v26
v_and_b32_e64 v27, 1, v24
v_lshl_add_u32 v25, v27, 2, v25
s_lshl_b32 s3, s32, 1
v_xor_b32 v25, s3, v25
v_lshl_add_u32 v26, v25, 5, v26
s_sub_u32 s3, s54, s44
v_add_u32 v30, s3, v26
v_xor_b32_e64 v31, 32, v30
v_add_u32 v26, 131072, v26
v_xor_b32 v27, 32, v26
s_waitcnt vmcnt(8) lgkmcnt(0)
s_barrier
s_nop 0
ds_read_b64_tr_b16 v[128:129], v26 offset:0
ds_read_b64_tr_b16 v[130:131], v26 offset:1024
ds_read_b64_tr_b16 v[132:133], v27 offset:0
ds_read_b64_tr_b16 v[134:135], v27 offset:1024
ds_read_b64_tr_b16 v[136:137], v26 offset:8192
ds_read_b64_tr_b16 v[138:139], v26 offset:9216
ds_read_b64_tr_b16 v[140:141], v27 offset:8192
ds_read_b64_tr_b16 v[142:143], v27 offset:9216
ds_read_b64_tr_b16 v[144:145], v26 offset:16384
ds_read_b64_tr_b16 v[146:147], v26 offset:17408
ds_read_b64_tr_b16 v[148:149], v27 offset:16384
ds_read_b64_tr_b16 v[150:151], v27 offset:17408
ds_read_b64_tr_b16 v[152:153], v26 offset:24576
ds_read_b64_tr_b16 v[154:155], v26 offset:25600
ds_read_b64_tr_b16 v[156:157], v27 offset:24576
s_waitcnt lgkmcnt(9)
s_nop 0
ds_read_b64_tr_b16 v[158:159], v27 offset:25600
ds_read_b64_tr_b16 v[160:161], v30 offset:0
ds_read_b64_tr_b16 v[162:163], v30 offset:1024
ds_read_b64_tr_b16 v[164:165], v31 offset:0
ds_read_b64_tr_b16 v[166:167], v31 offset:1024
ds_read_b64_tr_b16 v[168:169], v30 offset:8192
s_waitcnt lgkmcnt(9)
s_nop 0
ds_read_b64_tr_b16 v[170:171], v30 offset:9216
ds_read_b64_tr_b16 v[172:173], v31 offset:8192
ds_read_b64_tr_b16 v[174:175], v31 offset:9216
ds_read_b64_tr_b16 v[176:177], v30 offset:16384
ds_read_b64_tr_b16 v[178:179], v30 offset:17408
ds_read_b64_tr_b16 v[180:181], v31 offset:16384
s_waitcnt lgkmcnt(9)
ds_read_b64_tr_b16 v[182:183], v31 offset:17408
ds_read_b64_tr_b16 v[184:185], v30 offset:24576
ds_read_b64_tr_b16 v[186:187], v30 offset:25600
ds_read_b64_tr_b16 v[188:189], v31 offset:24576
ds_read_b64_tr_b16 v[190:191], v31 offset:25600
v_and_b32 v25, 15, v0
v_mul_u32_u24 v28, 14336, v25
v_lshl_add_u32 v28, v24, 4, v28
v_mov_b32 v29, 2146435072
v_cmp_gt_u32 vcc, 2, v25
s_mul_i32 s3, s92, 57344
s_lshl_b32 s47, s4, 9
s_add_u32 s3, s3, s47
v_cndmask_b32 v28, v29, v28, vcc
s_lshl_b32 s47, s32, 7
s_add_u32 s3, s3, s47
s_add_u32 s3, s3, 6291456
Zvva 224,128,160
Zvva 228,132,160
Mvva 224,136,164
Mvva 228,140,164
Mvva 224,144,168
Mvva 228,148,168
Mvva 224,152,172
Mvva 228,156,172
s_waitcnt lgkmcnt(0)
Zvva 232,160,160
Zvva 236,164,160
Mvva 232,168,164
Mvva 236,172,164
Mvva 232,176,168
Mvva 236,180,168
Mvva 232,184,172
Mvva 236,188,172
L_noffn:
v_xor_b32 v124, v124, v122
v_lshlrev_b32_e64 v124, 4, v124
v_lshl_add_u32 v113, v123, 11, v124
v_add_u32 v114, s6, v113
v_lshrrev_b32 v124, 2, v0
v_bfe_u32 v126, v0, 3, 2
v_lshlrev_b32 v124, 7, v124
v_and_b32 v125, 3, v0
v_lshl_add_u32 v124, v125, 3, v124
v_lshl_add_u32 v115, v126, 5, v124
v_xor_b32 v116, 32, v115
v_xor_b32 v117, 64, v115
v_xor_b32 v118, 96, v115
v_add_u32 v120, s7, v123
v_lshlrev_b32 v119, 11, v120
v_lshl_add_u32 v119, v122, 4, v119
v_mov_b32 v126, 0
v_lshlrev_b32 v127, 2, v122
v_mov_b32 v24, 1
v_mul_u32_u24 v25, s65, v0
s_waitcnt vmcnt(0)
s_barrier
s_mov_b64 exec, 3
buffer_store_dword v24, v25, s[20:23], s64 offen sc1
s_mov_b64 exec, -1
L_p4_entry:
s_cmp_ge_u32 s34, 1
s_nop 0
s_cselect_b32 s3, s3, 8388608
s_add_u32 s7, s3, 28672
buffer_store_dwordx4 v[224:227], v28, s[20:23], s3 offen offset:0 sc1
buffer_store_dwordx4 v[228:231], v28, s[20:23], s3 offen offset:64 sc1
buffer_store_dwordx4 v[232:235], v28, s[20:23], s7 offen offset:0 sc1
buffer_store_dwordx4 v[236:239], v28, s[20:23], s7 offen offset:64 sc1
s_lshl_b32 s33, s4, 3
s_add_u32 s33, s33, s92
s_mov_b32 s65, s33
s_mov_b32 s3, s36
buffer_load_dwordx4 v[18:21], v119, s[56:59], s3 offen
s_add_u32 s3, s3, 16384
buffer_load_dwordx4 v[22:25], v119, s[56:59], s3 offen
s_add_u32 s3, s3, 16384
buffer_load_dwordx4 v[26:29], v119, s[56:59], s3 offen
s_add_u32 s3, s3, 16384
buffer_load_dwordx4 v[30:33], v119, s[56:59], s3 offen
s_lshl_b32 s3, s45, 10
s_add_u32 s3, s3, 5259264
v_lshlrev_b32 v124, 3, v120
buffer_load_dwordx2 v[34:35], v124, s[20:23], s3 offen offset:0 sc1
buffer_load_dwordx2 v[36:37], v124, s[20:23], s3 offen offset:64 sc1
buffer_load_dwordx2 v[38:39], v124, s[20:23], s3 offen offset:128 sc1
buffer_load_dwordx2 v[40:41], v124, s[20:23], s3 offen offset:192 sc1
v_and_b32 v10, 15, v0
v_lshlrev_b32 v10, 2, v10
s_add_u32 s95, s32, 32
s_lshl_b32 s95, s95, 16
s_add_u32 s95, s95, s94
s_xor_b32 s95, s95, 128
s_add_u32 m0, s44, 0
s_nop 0
s_nop 0
buffer_load_dwordx4 v114, s[12:15], s48 offen offset:0 lds
buffer_load_dwordx4 v114, s[12:15], s49 offen offset:1024 lds
buffer_load_dwordx4 v114, s[12:15], s50 offen offset:2048 lds
buffer_load_dwordx4 v114, s[12:15], s51 offen offset:3072 lds
v_xor_b32 v114, 128, v114
s_add_u32 m0, s44, 16384
s_nop 0
s_nop 0
buffer_load_dwordx4 v114, s[12:15], s48 offen offset:0 lds
buffer_load_dwordx4 v114, s[12:15], s49 offen offset:1024 lds
buffer_load_dwordx4 v114, s[12:15], s50 offen offset:2048 lds
buffer_load_dwordx4 v114, s[12:15], s51 offen offset:3072 lds
v_xor_b32 v114, 128, v114
v_add_u32 v114, 262144, v114
buffer_load_dword v124, v10, s[20:23], s38 offen sc1
v_add_u32 v12, 65536, v115
v_add_u32 v13, 65536, v116
v_add_u32 v14, 65536, v117
v_add_u32 v15, 65536, v118
s_and_b32 s39, s93, 15
s_lshr_b32 s37, s93, 4
s_lshl_b32 s54, s37, 2
s_add_u32 s54, s54, s32
s_lshl_b32 s3, s54, 17
s_lshl_b32 s7, s39, 7
s_add_u32 s3, s3, s7
s_cmp_lt_u32 s93, 224
s_cselect_b32 s3, s3, 2146435072
v_add_u32 v125, s3, v113
s_mov_b32 s40, 0
s_waitcnt vmcnt(9)
v_lshlrev_b32_e64 v42, 16, v18
v_and_b32 v43, 0xffff0000, v18
v_lshlrev_b32_e64 v44, 16, v19
v_and_b32 v45, 0xffff0000, v19
v_lshlrev_b32_e64 v46, 16, v20
v_and_b32 v47, 0xffff0000, v20
v_lshlrev_b32_e64 v48, 16, v21
v_and_b32 v49, 0xffff0000, v21
v_pk_add_f32 v[42:43], v[42:43], v[34:35] op_sel_hi:[1,0] neg_lo:[0,1] neg_hi:[0,1]
v_pk_add_f32 v[44:45], v[44:45], v[34:35] op_sel_hi:[1,0] neg_lo:[0,1] neg_hi:[0,1]
v_pk_add_f32 v[46:47], v[46:47], v[34:35] op_sel_hi:[1,0] neg_lo:[0,1] neg_hi:[0,1]
v_pk_add_f32 v[48:49], v[48:49], v[34:35] op_sel_hi:[1,0] neg_lo:[0,1] neg_hi:[0,1]
Vc 2,42,43
v_lshlrev_b32_e64 v42, 16, v2
v_and_b32 v43, 0xffff0000, v2
Vc 3,44,45
v_lshlrev_b32_e64 v44, 16, v3
v_and_b32 v45, 0xffff0000, v3
Vc 4,46,47
v_lshlrev_b32_e64 v46, 16, v4
v_and_b32 v47, 0xffff0000, v4
Vc 5,48,49
v_lshlrev_b32_e64 v48, 16, v5
v_and_b32 v49, 0xffff0000, v5
v_pk_mul_f32 v[42:43], v[42:43], v[34:35] op_sel:[0,1] op_sel_hi:[1,1]
v_pk_mul_f32 v[44:45], v[44:45], v[34:35] op_sel:[0,1] op_sel_hi:[1,1]
v_pk_mul_f32 v[46:47], v[46:47], v[34:35] op_sel:[0,1] op_sel_hi:[1,1]
v_pk_mul_f32 v[48:49], v[48:49], v[34:35] op_sel:[0,1] op_sel_hi:[1,1]
Vc 2,42,43
v_lshlrev_b32_e64 v42, 16, v2
v_and_b32 v43, 0xffff0000, v2
Vc 3,44,45
v_lshlrev_b32_e64 v44, 16, v3
v_and_b32 v45, 0xffff0000, v3
Vc 4,46,47
v_lshlrev_b32_e64 v46, 16, v4
v_and_b32 v47, 0xffff0000, v4
Vc 5,48,49
v_lshlrev_b32_e64 v48, 16, v5
v_and_b32 v49, 0xffff0000, v5
v_mul_f32 v2, 0xbfb8aa3b, v42
v_mul_f32 v3, 0xbfb8aa3b, v43
v_mul_f32 v4, 0xbfb8aa3b, v44
v_mul_f32 v5, 0xbfb8aa3b, v45
v_mul_f32 v6, 0xbfb8aa3b, v46
v_mul_f32 v7, 0xbfb8aa3b, v47
v_mul_f32 v8, 0xbfb8aa3b, v48
v_mul_f32 v9, 0xbfb8aa3b, v49
Ve 2,2
Ve 3,3
Ve 4,4
Ve 5,5
Ve 6,6
Ve 7,7
Ve 8,8
Ve 9,9
v_add_f32 v2, 1.0, v2
v_add_f32 v3, 1.0, v3
v_add_f32 v4, 1.0, v4
v_add_f32 v5, 1.0, v5
v_add_f32 v6, 1.0, v6
v_add_f32 v7, 1.0, v7
v_add_f32 v8, 1.0, v8
v_add_f32 v9, 1.0, v9
v_rcp_f32 v2, v2
v_rcp_f32 v3, v3
v_rcp_f32 v4, v4
v_rcp_f32 v5, v5
v_rcp_f32 v6, v6
v_rcp_f32 v7, v7
v_rcp_f32 v8, v8
v_rcp_f32 v9, v9
v_pk_mul_f32 v[42:43], v[42:43], v[2:3]
v_pk_mul_f32 v[44:45], v[44:45], v[4:5]
v_pk_mul_f32 v[46:47], v[46:47], v[6:7]
v_pk_mul_f32 v[48:49], v[48:49], v[8:9]
Vc 2,42,43
v_lshlrev_b32_e64 v42, 16, v2
v_and_b32 v43, 0xffff0000, v2
Vc 3,44,45
v_lshlrev_b32_e64 v44, 16, v3
v_and_b32 v45, 0xffff0000, v3
Vc 4,46,47
v_lshlrev_b32_e64 v46, 16, v4
v_and_b32 v47, 0xffff0000, v4
Vc 5,48,49
v_lshlrev_b32_e64 v48, 16, v5
v_and_b32 v49, 0xffff0000, v5
s_waitcnt vmcnt(0)
v_cmp_ne_u32 vcc, 1, v124
s_cbranch_vccnz L_spinC
s_nop 0
L_spinCr:
buffer_load_dwordx4 a[0:3], v112, s[8:11], s52 offen offset:0 sc1
buffer_load_dwordx4 a[4:7], v112, s[8:11], s52 offen offset:1024 sc1
s_add_u32 s52, s52, 8192
buffer_load_dwordx4 a[8:11], v112, s[8:11], s52 offen offset:0 sc1
buffer_load_dwordx4 a[12:15], v112, s[8:11], s52 offen offset:1024 sc1
s_add_u32 s52, s52, 8192
buffer_load_dwordx4 a[16:19], v112, s[8:11], s52 offen offset:0 sc1
buffer_load_dwordx4 a[20:23], v112, s[8:11], s52 offen offset:1024 sc1
s_add_u32 s52, s52, 8192
buffer_load_dwordx4 a[24:27], v112, s[8:11], s52 offen offset:0 sc1
buffer_load_dwordx4 a[28:31], v112, s[8:11], s52 offen offset:1024 sc1
s_add_u32 s52, s52, 8192
buffer_load_dwordx4 a[32:35], v112, s[8:11], s52 offen offset:0 sc1
buffer_load_dwordx4 a[36:39], v112, s[8:11], s52 offen offset:1024 sc1
s_add_u32 s52, s52, 8192
buffer_load_dwordx4 a[40:43], v112, s[8:11], s52 offen offset:0 sc1
buffer_load_dwordx4 a[44:47], v112, s[8:11], s52 offen offset:1024 sc1
s_add_u32 s52, s52, 8192
v_lshlrev_b32_e64 v50, 16, v22
v_and_b32 v51, 0xffff0000, v22
v_lshlrev_b32_e64 v52, 16, v23
v_and_b32 v53, 0xffff0000, v23
v_lshlrev_b32_e64 v54, 16, v24
v_and_b32 v55, 0xffff0000, v24
v_lshlrev_b32_e64 v56, 16, v25
v_and_b32 v57, 0xffff0000, v25
v_pk_add_f32 v[50:51], v[50:51], v[36:37] op_sel_hi:[1,0] neg_lo:[0,1] neg_hi:[0,1]
v_pk_add_f32 v[52:53], v[52:53], v[36:37] op_sel_hi:[1,0] neg_lo:[0,1] neg_hi:[0,1]
v_pk_add_f32 v[54:55], v[54:55], v[36:37] op_sel_hi:[1,0] neg_lo:[0,1] neg_hi:[0,1]
v_pk_add_f32 v[56:57], v[56:57], v[36:37] op_sel_hi:[1,0] neg_lo:[0,1] neg_hi:[0,1]
Vc 2,50,51
v_lshlrev_b32_e64 v50, 16, v2
v_and_b32 v51, 0xffff0000, v2
Vc 3,52,53
v_lshlrev_b32_e64 v52, 16, v3
v_and_b32 v53, 0xffff0000, v3
Vc 4,54,55
v_lshlrev_b32_e64 v54, 16, v4
v_and_b32 v55, 0xffff0000, v4
Vc 5,56,57
v_lshlrev_b32_e64 v56, 16, v5
v_and_b32 v57, 0xffff0000, v5
v_pk_mul_f32 v[50:51], v[50:51], v[36:37] op_sel:[0,1] op_sel_hi:[1,1]
v_pk_mul_f32 v[52:53], v[52:53], v[36:37] op_sel:[0,1] op_sel_hi:[1,1]
v_pk_mul_f32 v[54:55], v[54:55], v[36:37] op_sel:[0,1] op_sel_hi:[1,1]
v_pk_mul_f32 v[56:57], v[56:57], v[36:37] op_sel:[0,1] op_sel_hi:[1,1]
Vc 2,50,51
v_lshlrev_b32_e64 v50, 16, v2
v_and_b32 v51, 0xffff0000, v2
Vc 3,52,53
v_lshlrev_b32_e64 v52, 16, v3
v_and_b32 v53, 0xffff0000, v3
Vc 4,54,55
v_lshlrev_b32_e64 v54, 16, v4
v_and_b32 v55, 0xffff0000, v4
Vc 5,56,57
v_lshlrev_b32_e64 v56, 16, v5
v_and_b32 v57, 0xffff0000, v5
v_mul_f32 v2, 0xbfb8aa3b, v50
v_mul_f32 v3, 0xbfb8aa3b, v51
v_mul_f32 v4, 0xbfb8aa3b, v52
v_mul_f32 v5, 0xbfb8aa3b, v53
v_mul_f32 v6, 0xbfb8aa3b, v54
v_mul_f32 v7, 0xbfb8aa3b, v55
v_mul_f32 v8, 0xbfb8aa3b, v56
v_mul_f32 v9, 0xbfb8aa3b, v57
Ve 2,2
Ve 3,3
Ve 4,4
Ve 5,5
Ve 6,6
Ve 7,7
Ve 8,8
Ve 9,9
v_add_f32 v2, 1.0, v2
v_add_f32 v3, 1.0, v3
v_add_f32 v4, 1.0, v4
v_add_f32 v5, 1.0, v5
v_add_f32 v6, 1.0, v6
v_add_f32 v7, 1.0, v7
v_add_f32 v8, 1.0, v8
v_add_f32 v9, 1.0, v9
v_rcp_f32 v2, v2
v_rcp_f32 v3, v3
v_rcp_f32 v4, v4
v_rcp_f32 v5, v5
v_rcp_f32 v6, v6
v_rcp_f32 v7, v7
v_rcp_f32 v8, v8
v_rcp_f32 v9, v9
v_pk_mul_f32 v[50:51], v[50:51], v[2:3]
v_pk_mul_f32 v[52:53], v[52:53], v[4:5]
v_pk_mul_f32 v[54:55], v[54:55], v[6:7]
v_pk_mul_f32 v[56:57], v[56:57], v[8:9]
Vc 2,50,51
v_lshlrev_b32_e64 v50, 16, v2
v_and_b32 v51, 0xffff0000, v2
Vc 3,52,53
v_lshlrev_b32_e64 v52, 16, v3
v_and_b32 v53, 0xffff0000, v3
Vc 4,54,55
v_lshlrev_b32_e64 v54, 16, v4
v_and_b32 v55, 0xffff0000, v4
Vc 5,56,57
v_lshlrev_b32_e64 v56, 16, v5
v_and_b32 v57, 0xffff0000, v5
v_lshlrev_b32_e64 v58, 16, v26
v_and_b32 v59, 0xffff0000, v26
v_lshlrev_b32_e64 v60, 16, v27
v_and_b32 v61, 0xffff0000, v27
v_lshlrev_b32_e64 v62, 16, v28
v_and_b32 v63, 0xffff0000, v28
v_lshlrev_b32_e64 v64, 16, v29
v_and_b32 v65, 0xffff0000, v29
v_pk_add_f32 v[58:59], v[58:59], v[38:39] op_sel_hi:[1,0] neg_lo:[0,1] neg_hi:[0,1]
v_pk_add_f32 v[60:61], v[60:61], v[38:39] op_sel_hi:[1,0] neg_lo:[0,1] neg_hi:[0,1]
v_pk_add_f32 v[62:63], v[62:63], v[38:39] op_sel_hi:[1,0] neg_lo:[0,1] neg_hi:[0,1]
v_pk_add_f32 v[64:65], v[64:65], v[38:39] op_sel_hi:[1,0] neg_lo:[0,1] neg_hi:[0,1]
Vc 2,58,59
v_lshlrev_b32_e64 v58, 16, v2
v_and_b32 v59, 0xffff0000, v2
Vc 3,60,61
v_lshlrev_b32_e64 v60, 16, v3
v_and_b32 v61, 0xffff0000, v3
Vc 4,62,63
v_lshlrev_b32_e64 v62, 16, v4
v_and_b32 v63, 0xffff0000, v4
Vc 5,64,65
v_lshlrev_b32_e64 v64, 16, v5
v_and_b32 v65, 0xffff0000, v5
v_pk_mul_f32 v[58:59], v[58:59], v[38:39] op_sel:[0,1] op_sel_hi:[1,1]
v_pk_mul_f32 v[60:61], v[60:61], v[38:39] op_sel:[0,1] op_sel_hi:[1,1]
v_pk_mul_f32 v[62:63], v[62:63], v[38:39] op_sel:[0,1] op_sel_hi:[1,1]
v_pk_mul_f32 v[64:65], v[64:65], v[38:39] op_sel:[0,1] op_sel_hi:[1,1]
Vc 2,58,59
v_lshlrev_b32_e64 v58, 16, v2
v_and_b32 v59, 0xffff0000, v2
Vc 3,60,61
v_lshlrev_b32_e64 v60, 16, v3
v_and_b32 v61, 0xffff0000, v3
Vc 4,62,63
v_lshlrev_b32_e64 v62, 16, v4
v_and_b32 v63, 0xffff0000, v4
Vc 5,64,65
v_lshlrev_b32_e64 v64, 16, v5
v_and_b32 v65, 0xffff0000, v5
v_mul_f32 v2, 0xbfb8aa3b, v58
v_mul_f32 v3, 0xbfb8aa3b, v59
v_mul_f32 v4, 0xbfb8aa3b, v60
v_mul_f32 v5, 0xbfb8aa3b, v61
v_mul_f32 v6, 0xbfb8aa3b, v62
v_mul_f32 v7, 0xbfb8aa3b, v63
v_mul_f32 v8, 0xbfb8aa3b, v64
v_mul_f32 v9, 0xbfb8aa3b, v65
Ve 2,2
Ve 3,3
Ve 4,4
Ve 5,5
Ve 6,6
Ve 7,7
Ve 8,8
Ve 9,9
v_add_f32 v2, 1.0, v2
v_add_f32 v3, 1.0, v3
v_add_f32 v4, 1.0, v4
v_add_f32 v5, 1.0, v5
v_add_f32 v6, 1.0, v6
v_add_f32 v7, 1.0, v7
v_add_f32 v8, 1.0, v8
v_add_f32 v9, 1.0, v9
v_rcp_f32 v2, v2
v_rcp_f32 v3, v3
v_rcp_f32 v4, v4
v_rcp_f32 v5, v5
v_rcp_f32 v6, v6
v_rcp_f32 v7, v7
v_rcp_f32 v8, v8
v_rcp_f32 v9, v9
v_pk_mul_f32 v[58:59], v[58:59], v[2:3]
v_pk_mul_f32 v[60:61], v[60:61], v[4:5]
v_pk_mul_f32 v[62:63], v[62:63], v[6:7]
v_pk_mul_f32 v[64:65], v[64:65], v[8:9]
Vc 2,58,59
v_lshlrev_b32_e64 v58, 16, v2
v_and_b32 v59, 0xffff0000, v2
Vc 3,60,61
v_lshlrev_b32_e64 v60, 16, v3
v_and_b32 v61, 0xffff0000, v3
Vc 4,62,63
v_lshlrev_b32_e64 v62, 16, v4
v_and_b32 v63, 0xffff0000, v4
Vc 5,64,65
v_lshlrev_b32_e64 v64, 16, v5
v_and_b32 v65, 0xffff0000, v5
L_nogt:
buffer_load_dwordx4 a[48:51], v112, s[8:11], s52 offen offset:0 sc1
buffer_load_dwordx4 a[52:55], v112, s[8:11], s52 offen offset:1024 sc1
s_add_u32 s52, s52, 8192
buffer_load_dwordx4 a[56:59], v112, s[8:11], s52 offen offset:0 sc1
buffer_load_dwordx4 a[60:63], v112, s[8:11], s52 offen offset:1024 sc1
s_add_u32 s52, s52, 8192
s_add_u32 m0, s44, 32768
s_nop 0
buffer_load_dwordx4 v114, s[12:15], s48 offen offset:0 lds
buffer_load_dwordx4 v114, s[12:15], s49 offen offset:1024 lds
buffer_load_dwordx4 v114, s[12:15], s50 offen offset:2048 lds
buffer_load_dwordx4 v114, s[12:15], s51 offen offset:3072 lds
v_xor_b32 v114, 128, v114
s_cmp_lg_u32 s40, 0
s_cbranch_scc1 L_nowd
s_add_u32 m0, s35, 0
s_nop 0
s_nop 0
buffer_load_dwordx4 v125, s[60:63], s48 offen offset:0 lds
buffer_load_dwordx4 v125, s[60:63], s49 offen offset:1024 lds
buffer_load_dwordx4 v125, s[60:63], s50 offen offset:2048 lds
buffer_load_dwordx4 v125, s[60:63], s51 offen offset:3072 lds
v_add_u32 v125, 65536, v125
s_add_u32 m0, s35, 4096
s_nop 0
buffer_load_dwordx4 v125, s[60:63], s48 offen offset:0 lds
buffer_load_dwordx4 v125, s[60:63], s49 offen offset:1024 lds
buffer_load_dwordx4 v125, s[60:63], s50 offen offset:2048 lds
buffer_load_dwordx4 v125, s[60:63], s51 offen offset:3072 lds
L_nowd:
s_cmp_lt_u32 s2, 128
s_cbranch_scc1 L_noc3b
s_bfe_u32 s3, s2, 0x40003
s_lshl_b32 s3, s3, 2
s_add_u32 s3, s3, s32
s_lshl_b32 s3, s3, 15
s_and_b32 s7, s2, 1
s_lshl_b32 s7, s7, 22
s_add_u32 s3, s3, s7
s_add_u32 s3, s3, 384
v_and_b32 v1, 15, v0
v_lshlrev_b32 v1, 11, v1
v_lshrrev_b32_e64 v11, 5, v0
v_lshl_add_u32 v1, v11, 10, v1
buffer_load_dword v11, v1, s[28:31], s3 offen
L_noc3b:
s_barrier
s_nop 0
ds_read_b64_tr_b16 v[192:193], v115 offset:0
ds_read_b64_tr_b16 v[194:195], v115 offset:2048
ds_read_b64_tr_b16 v[196:197], v115 offset:4096
ds_read_b64_tr_b16 v[198:199], v115 offset:6144
ds_read_b64_tr_b16 v[200:201], v115 offset:8192
ds_read_b64_tr_b16 v[202:203], v115 offset:10240
ds_read_b64_tr_b16 v[204:205], v115 offset:12288
ds_read_b64_tr_b16 v[206:207], v115 offset:14336
ds_read_b64_tr_b16 v[208:209], v116 offset:0
ds_read_b64_tr_b16 v[210:211], v116 offset:2048
ds_read_b64_tr_b16 v[212:213], v116 offset:4096
ds_read_b64_tr_b16 v[214:215], v116 offset:6144
ds_read_b64_tr_b16 v[216:217], v116 offset:8192
ds_read_b64_tr_b16 v[218:219], v116 offset:10240
ds_read_b64_tr_b16 v[220:221], v116 offset:12288
s_waitcnt lgkmcnt(9)
ds_read_b64_tr_b16 v[222:223], v116 offset:14336
s_waitcnt vmcnt(12)
s_waitcnt lgkmcnt(8)
Zvva 160,192,0
ds_read_b64_tr_b16 v[224:225], v117 offset:0
ds_read_b64_tr_b16 v[226:227], v117 offset:2048
v_mov_b32 v125, 1
Mvva 160,196,8
s_sub_u32 s65, s65, s33
s_lshl_b32 s65, s65, 2
v_mul_lo_u32 v124, v0, s65
Mvva 160,200,16
s_add_u32 m0, s44, 49152
ds_read_b64_tr_b16 v[228:229], v117 offset:4096
ds_read_b64_tr_b16 v[230:231], v117 offset:6144
Mvva 160,204,24
buffer_load_dwordx4 v114, s[12:15], s48 offen offset:0 lds
Zvva 176,192,4
s_waitcnt lgkmcnt(4)
ds_read_b64_tr_b16 v[232:233], v117 offset:8192
ds_read_b64_tr_b16 v[234:235], v117 offset:10240
Mvva 176,196,12
s_lshl_b32 s6, s33, 2
v_add_u32_e64 v124, s6, v124
Mvva 176,200,20
ds_read_b64_tr_b16 v[236:237], v117 offset:12288
ds_read_b64_tr_b16 v[238:239], v117 offset:14336
Mvva 176,204,28
buffer_load_dwordx4 v114, s[12:15], s49 offen offset:1024 lds
Zvva 164,208,0
ds_read_b64_tr_b16 v[240:241], v118 offset:0
ds_read_b64_tr_b16 v[242:243], v118 offset:2048
Mvva 164,212,8
s_mov_b32 s6, 5447680
s_cmp_eq_u32 s32, 0
s_cselect_b32 s6, s6, s64
s_cmp_ge_u32 s34, 1
s_cselect_b32 s6, s6, 2146435072
Mvva 164,216,16
s_waitcnt lgkmcnt(2)
ds_read_b64_tr_b16 v[244:245], v118 offset:4096
ds_read_b64_tr_b16 v[246:247], v118 offset:6144
Mvva 164,220,24
buffer_load_dwordx4 v114, s[12:15], s50 offen offset:2048 lds
Zvva 180,208,4
ds_read_b64_tr_b16 v[248:249], v118 offset:8192
ds_read_b64_tr_b16 v[250:251], v118 offset:10240
Mvva 180,212,12
s_mov_b64 exec, 3
buffer_store_dword v125, v124, s[20:23], s6 offen sc1
s_mov_b64 exec, -1
Mvva 180,216,20
s_barrier
ds_read_b64_tr_b16 v[252:253], v118 offset:12288
ds_read_b64_tr_b16 v[254:255], v118 offset:14336
Mvva 180,220,28
buffer_load_dwordx4 v114, s[12:15], s51 offen offset:3072 lds
v_xor_b32 v114, 128, v114
v_add_u32 v114, 262144, v114
Zvva 168,224,0
ds_read_b64_tr_b16 v[192:193], v115 offset:16384
ds_read_b64_tr_b16 v[194:195], v115 offset:18432
Mvva 168,228,8
s_lshl_b32 s40, s45, 2
s_add_u32 s40, s40, s32
s_lshr_b32 s3, s42, 5
s_lshr_b32 s47, s43, 5
s_cmp_eq_u32 s3, s40
s_cselect_b32 s53, 1, 0
s_cmp_eq_u32 s47, s40
s_cselect_b32 s53, 1, s53
s_mov_b32 s40, 0
Mvva 168,232,16
ds_read_b64_tr_b16 v[196:197], v115 offset:20480
ds_read_b64_tr_b16 v[198:199], v115 offset:22528
Mvva 168,236,24
buffer_load_dwordx4 a[64:67], v112, s[8:11], s52 offen offset:0 sc1
Zvva 184,224,4
s_waitcnt lgkmcnt(4)
ds_read_b64_tr_b16 v[200:201], v115 offset:24576
ds_read_b64_tr_b16 v[202:203], v115 offset:26624
Mvva 184,228,12
s_lshl_b32 s41, s46, 7
s_add_u32 s41, s41, 5449728
s_lshl_b32 s55, s46, 13
Mvva 184,232,20
ds_read_b64_tr_b16 v[204:205], v115 offset:28672
ds_read_b64_tr_b16 v[206:207], v115 offset:30720
Mvva 184,236,28
buffer_load_dwordx4 a[68:71], v112, s[8:11], s52 offen offset:1024 sc1
s_add_u32 s52, s52, 8192
Zvva 172,240,0
ds_read_b64_tr_b16 v[208:209], v116 offset:16384
ds_read_b64_tr_b16 v[210:211], v116 offset:18432
Mvva 172,244,8
s_add_u32 s55, s55, 5308416
s_add_u32 s16, s66, 88080384
s_addc_u32 s17, s67, 0
s_and_b32 s17, s17, 0xffff
Mvva 172,248,16
ds_read_b64_tr_b16 v[212:213], v116 offset:20480
ds_read_b64_tr_b16 v[214:215], v116 offset:22528
Mvva 172,252,24
buffer_load_dwordx4 a[72:75], v112, s[8:11], s52 offen offset:0 sc1
Zvva 188,240,4
s_waitcnt lgkmcnt(4)
ds_read_b64_tr_b16 v[216:217], v116 offset:24576
ds_read_b64_tr_b16 v[218:219], v116 offset:26624
Mvva 188,244,12
s_mov_b32 s18, 8388608
s_mov_b32 s19, 0x20000
s_lshl_b32 s24, s2, 2
Mvva 188,248,20
ds_read_b64_tr_b16 v[220:221], v116 offset:28672
ds_read_b64_tr_b16 v[222:223], v116 offset:30720
Mvva 188,252,28
buffer_load_dwordx4 a[76:79], v112, s[8:11], s52 offen offset:1024 sc1
s_add_u32 s52, s52, 8192
Zvva 128,192,0
ds_read_b64_tr_b16 v[224:225], v117 offset:16384
ds_read_b64_tr_b16 v[226:227], v117 offset:18432
Mvva 128,196,8
s_add_u32 s24, s24, s32
s_lshl_b32 s25, s24, 13
s_xor_b32 s26, s25, 32768
Mvva 128,200,16
s_add_u32 m0, s44, 65536
ds_read_b64_tr_b16 v[228:229], v117 offset:20480
ds_read_b64_tr_b16 v[230:231], v117 offset:22528
Mvva 128,204,24
buffer_load_dwordx4 v114, s[12:15], s48 offen offset:0 lds
Zvva 144,192,4
s_waitcnt lgkmcnt(4)
ds_read_b64_tr_b16 v[232:233], v117 offset:24576
ds_read_b64_tr_b16 v[234:235], v117 offset:26624
Mvva 144,196,12
s_lshl_b32 s24, s24, 2
s_xor_b32 s27, s24, 16
s_add_u32 s24, s24, 5452800
Mvva 144,200,20
ds_read_b64_tr_b16 v[236:237], v117 offset:28672
ds_read_b64_tr_b16 v[238:239], v117 offset:30720
Mvva 144,204,28
buffer_load_dwordx4 v114, s[12:15], s49 offen offset:1024 lds
Zvva 132,208,0
ds_read_b64_tr_b16 v[240:241], v118 offset:16384
ds_read_b64_tr_b16 v[242:243], v118 offset:18432
Mvva 132,212,8
s_add_u32 s27, s27, 5452800
v_add_u32 v106, s35, v115
v_add_u32 v107, s35, v116
v_add_u32 v108, s35, v117
Mvva 132,216,16
s_waitcnt lgkmcnt(2)
ds_read_b64_tr_b16 v[244:245], v118 offset:20480
ds_read_b64_tr_b16 v[246:247], v118 offset:22528
v_add_u32 v109, s35, v118
Mvva 132,220,24
buffer_load_dwordx4 v114, s[12:15], s50 offen offset:2048 lds
Zvva 148,208,4
s_waitcnt vmcnt(12)
ds_read_b64_tr_b16 v[248:249], v118 offset:24576
ds_read_b64_tr_b16 v[250:251], v118 offset:26624
v_and_b32 v2, 1, v121
Mvva 148,212,12
v_lshlrev_b32 v2, 8, v2
v_and_b32 v3, 15, v0
v_lshl_add_u32 v2, v3, 3, v2
Mvva 148,216,20
s_barrier
ds_read_b64_tr_b16 v[252:253], v118 offset:28672
ds_read_b64_tr_b16 v[254:255], v118 offset:30720
v_add_u32 v2, s35, v2
Mvva 148,220,28
buffer_load_dwordx4 v114, s[12:15], s51 offen offset:3072 lds
v_xor_b32 v114, 128, v114
Zvva 136,224,0
ds_read_b64_tr_b16 v[192:193], v115 offset:32768
ds_read_b64_tr_b16 v[194:195], v115 offset:34816
v_and_b32_e64 v4, 1, v0
Mvva 136,228,8
v_lshlrev_b32 v4, 8, v4
v_add_u32 v4, s35, v4
v_lshl_add_u32 v3, v121, 3, v4
Mvva 136,232,16
ds_read_b64_tr_b16 v[196:197], v115 offset:36864
ds_read_b64_tr_b16 v[198:199], v115 offset:38912
v_lshl_add_u32 v4, v121, 4, v4
Mvva 136,236,24
buffer_load_dwordx4 a[80:83], v112, s[8:11], s52 offen offset:0 sc1
Zvva 152,224,4
s_waitcnt lgkmcnt(4)
ds_read_b64_tr_b16 v[200:201], v115 offset:40960
ds_read_b64_tr_b16 v[202:203], v115 offset:43008
v_lshlrev_b32 v5, 3, v0
Mvva 152,228,12
v_add_u32 v6, 133120, v5
v_mov_b32_e64 v7, 1
Mvva 152,232,20
ds_read_b64_tr_b16 v[204:205], v115 offset:45056
ds_read_b64_tr_b16 v[206:207], v115 offset:47104
Mvva 152,236,28
buffer_load_dwordx4 a[84:87], v112, s[8:11], s52 offen offset:1024 sc1
s_add_u32 s52, s52, 8192
Zvva 140,240,0
ds_read_b64_tr_b16 v[208:209], v116 offset:32768
ds_read_b64_tr_b16 v[210:211], v116 offset:34816
Mvva 140,244,8
s_lshl_b32 s4, s39, 4
s_add_u32 s4, s4, s37
s_lshl_b32 s4, s4, 9
Mvva 140,248,16
ds_read_b64_tr_b16 v[212:213], v116 offset:36864
ds_read_b64_tr_b16 v[214:215], v116 offset:38912
Mvva 140,252,24
buffer_load_dwordx4 a[88:91], v112, s[8:11], s52 offen offset:0 sc1
Zvva 156,240,4
s_waitcnt lgkmcnt(4)
ds_read_b64_tr_b16 v[216:217], v116 offset:40960
ds_read_b64_tr_b16 v[218:219], v116 offset:43008
Mvva 156,244,12
s_add_u32 s4, s4, 5308416
s_lshl_b32 s6, s39, 5
s_add_u32 s6, s6, s37
Mvva 156,248,20
ds_read_b64_tr_b16 v[220:221], v116 offset:45056
ds_read_b64_tr_b16 v[222:223], v116 offset:47104
Mvva 156,252,28
buffer_load_dwordx4 a[92:95], v112, s[8:11], s52 offen offset:1024 sc1
s_add_u32 s52, s52, 8192
Mvva 160,192,32
ds_read_b64_tr_b16 v[224:225], v117 offset:32768
ds_read_b64_tr_b16 v[226:227], v117 offset:34816
Mvva 160,196,40
s_lshl_b32 s6, s6, 2
s_add_u32 s6, s6, 5449728
s_cmp_eq_u32 s32, 0
s_cselect_b32 s4, s4, s64
s_cselect_b32 s6, s6, s64
Mvva 160,200,48
s_add_u32 m0, s44, 81920
ds_read_b64_tr_b16 v[228:229], v117 offset:36864
ds_read_b64_tr_b16 v[230:231], v117 offset:38912
Mvva 160,204,56
buffer_load_dwordx4 v114, s[12:15], s48 offen offset:0 lds
Mvva 176,192,36
s_waitcnt lgkmcnt(4)
ds_read_b64_tr_b16 v[232:233], v117 offset:40960
ds_read_b64_tr_b16 v[234:235], v117 offset:43008
Mvva 176,196,44
s_cmp_lt_u32 s93, 224
s_cselect_b32 s4, s4, 2146435072
s_cselect_b32 s6, s6, 2146435072
Mvva 176,200,52
ds_read_b64_tr_b16 v[236:237], v117 offset:45056
ds_read_b64_tr_b16 v[238:239], v117 offset:47104
Mvva 176,204,60
buffer_load_dwordx4 v114, s[12:15], s49 offen offset:1024 lds
Mvva 164,208,32
ds_read_b64_tr_b16 v[240:241], v118 offset:32768
ds_read_b64_tr_b16 v[242:243], v118 offset:34816
Mvva 164,212,40
Mvva 164,216,48
s_waitcnt lgkmcnt(2)
ds_read_b64_tr_b16 v[244:245], v118 offset:36864
ds_read_b64_tr_b16 v[246:247], v118 offset:38912
Mvva 164,220,56
buffer_load_dwordx4 v114, s[12:15], s50 offen offset:2048 lds
Mvva 180,208,36
s_waitcnt vmcnt(15)
ds_read_b64_tr_b16 v[248:249], v118 offset:40960
ds_read_b64_tr_b16 v[250:251], v118 offset:43008
Mvva 180,212,44
Mvva 180,216,52
s_barrier
ds_read_b64_tr_b16 v[252:253], v118 offset:45056
ds_read_b64_tr_b16 v[254:255], v118 offset:47104
Mvva 180,220,60
buffer_load_dwordx4 v114, s[12:15], s51 offen offset:3072 lds
v_xor_b32 v114, 128, v114
v_add_u32 v114, 262144, v114
Mvva 168,224,32
ds_read_b64_tr_b16 v[192:193], v115 offset:49152
ds_read_b64_tr_b16 v[194:195], v115 offset:51200
Mvva 168,228,40
Mvva 168,232,48
ds_read_b64_tr_b16 v[196:197], v115 offset:53248
ds_read_b64_tr_b16 v[198:199], v115 offset:55296
Mvva 168,236,56
buffer_load_dwordx4 a[96:99], v112, s[8:11], s52 offen offset:0 sc1
Mvva 184,224,36
s_waitcnt lgkmcnt(4)
ds_read_b64_tr_b16 v[200:201], v115 offset:57344
ds_read_b64_tr_b16 v[202:203], v115 offset:59392
Mvva 184,228,44
Mvva 184,232,52
ds_read_b64_tr_b16 v[204:205], v115 offset:61440
ds_read_b64_tr_b16 v[206:207], v115 offset:63488
Mvva 184,236,60
buffer_load_dwordx4 a[100:103], v112, s[8:11], s52 offen offset:1024 sc1
s_add_u32 s52, s52, 8192
Mvva 172,240,32
ds_read_b64_tr_b16 v[208:209], v116 offset:49152
ds_read_b64_tr_b16 v[210:211], v116 offset:51200
Mvva 172,244,40
Mvva 172,248,48
ds_read_b64_tr_b16 v[212:213], v116 offset:53248
ds_read_b64_tr_b16 v[214:215], v116 offset:55296
Mvva 172,252,56
buffer_load_dwordx4 a[104:107], v112, s[8:11], s52 offen offset:0 sc1
Mvva 188,240,36
s_waitcnt lgkmcnt(4)
ds_read_b64_tr_b16 v[216:217], v116 offset:57344
ds_read_b64_tr_b16 v[218:219], v116 offset:59392
Mvva 188,244,44
Mvva 188,248,52
ds_read_b64_tr_b16 v[220:221], v116 offset:61440
ds_read_b64_tr_b16 v[222:223], v116 offset:63488
Mvva 188,252,60
buffer_load_dwordx4 a[108:111], v112, s[8:11], s52 offen offset:1024 sc1
s_add_u32 s52, s52, 8192
Mvva 128,192,32
ds_read_b64_tr_b16 v[224:225], v117 offset:49152
ds_read_b64_tr_b16 v[226:227], v117 offset:51200
Mvva 128,196,40
Mvva 128,200,48
s_add_u32 m0, s44, 98304
ds_read_b64_tr_b16 v[228:229], v117 offset:53248
ds_read_b64_tr_b16 v[230:231], v117 offset:55296
Mvva 128,204,56
buffer_load_dwordx4 v114, s[12:15], s48 offen offset:0 lds
Mvva 144,192,36
s_waitcnt lgkmcnt(4)
ds_read_b64_tr_b16 v[232:233], v117 offset:57344
ds_read_b64_tr_b16 v[234:235], v117 offset:59392
Mvva 144,196,44
Mvva 144,200,52
ds_read_b64_tr_b16 v[236:237], v117 offset:61440
ds_read_b64_tr_b16 v[238:239], v117 offset:63488
Mvva 144,204,60
buffer_load_dwordx4 v114, s[12:15], s49 offen offset:1024 lds
Mvva 132,208,32
ds_read_b64_tr_b16 v[240:241], v118 offset:49152
ds_read_b64_tr_b16 v[242:243], v118 offset:51200
Mvva 132,212,40
Mvva 132,216,48
s_waitcnt lgkmcnt(2)
ds_read_b64_tr_b16 v[244:245], v118 offset:53248
ds_read_b64_tr_b16 v[246:247], v118 offset:55296
Mvva 132,220,56
buffer_load_dwordx4 v114, s[12:15], s50 offen offset:2048 lds
Mvva 148,208,36
s_waitcnt vmcnt(15)
ds_read_b64_tr_b16 v[248:249], v118 offset:57344
ds_read_b64_tr_b16 v[250:251], v118 offset:59392
Mvva 148,212,44
Mvva 148,216,52
s_barrier
ds_read_b64_tr_b16 v[252:253], v118 offset:61440
ds_read_b64_tr_b16 v[254:255], v118 offset:63488
Mvva 148,220,60
buffer_load_dwordx4 v114, s[12:15], s51 offen offset:3072 lds
v_xor_b32 v114, 128, v114
Mvva 136,224,32
ds_read_b64_tr_b16 v[192:193], v12 offset:0
ds_read_b64_tr_b16 v[194:195], v12 offset:2048
Mvva 136,228,40
Mvva 136,232,48
ds_read_b64_tr_b16 v[196:197], v12 offset:4096
ds_read_b64_tr_b16 v[198:199], v12 offset:6144
Mvva 136,236,56
buffer_load_dwordx4 a[112:115], v112, s[8:11], s52 offen offset:0 sc1
Mvva 152,224,36
s_waitcnt lgkmcnt(4)
ds_read_b64_tr_b16 v[200:201], v12 offset:8192
ds_read_b64_tr_b16 v[202:203], v12 offset:10240
Mvva 152,228,44
Mvva 152,232,52
ds_read_b64_tr_b16 v[204:205], v12 offset:12288
ds_read_b64_tr_b16 v[206:207], v12 offset:14336
Mvva 152,236,60
buffer_load_dwordx4 a[116:119], v112, s[8:11], s52 offen offset:1024 sc1
s_add_u32 s52, s52, 8192
Mvva 140,240,32
ds_read_b64_tr_b16 v[208:209], v13 offset:0
ds_read_b64_tr_b16 v[210:211], v13 offset:2048
Mvva 140,244,40
Mvva 140,248,48
ds_read_b64_tr_b16 v[212:213], v13 offset:4096
ds_read_b64_tr_b16 v[214:215], v13 offset:6144
Mvva 140,252,56
buffer_load_dwordx4 a[120:123], v112, s[8:11], s52 offen offset:0 sc1
Mvva 156,240,36
s_waitcnt lgkmcnt(4)
ds_read_b64_tr_b16 v[216:217], v13 offset:8192
ds_read_b64_tr_b16 v[218:219], v13 offset:10240
Mvva 156,244,44
Mvva 156,248,52
s_waitcnt vmcnt(15)
ds_read_b64_tr_b16 v[220:221], v13 offset:12288
ds_read_b64_tr_b16 v[222:223], v13 offset:14336
Mvva 156,252,60
buffer_load_dwordx4 a[124:127], v112, s[8:11], s52 offen offset:1024 sc1
s_add_u32 s52, s52, 8192
Mvva 160,192,64
ds_read_b64_tr_b16 v[224:225], v14 offset:0
ds_read_b64_tr_b16 v[226:227], v14 offset:2048
Mvva 160,196,72
Mvva 160,200,80
s_add_u32 m0, s44, 114688
ds_read_b64_tr_b16 v[228:229], v14 offset:4096
ds_read_b64_tr_b16 v[230:231], v14 offset:6144
Mvva 160,204,88
buffer_load_dwordx4 v114, s[12:15], s48 offen offset:0 lds
Mvva 176,192,68
s_waitcnt lgkmcnt(4)
ds_read_b64_tr_b16 v[232:233], v14 offset:8192
ds_read_b64_tr_b16 v[234:235], v14 offset:10240
Mvva 176,196,76
Mvva 176,200,84
ds_read_b64_tr_b16 v[236:237], v14 offset:12288
ds_read_b64_tr_b16 v[238:239], v14 offset:14336
Mvva 176,204,92
buffer_load_dwordx4 v114, s[12:15], s49 offen offset:1024 lds
Mvva 164,208,64
ds_read_b64_tr_b16 v[240:241], v15 offset:0
ds_read_b64_tr_b16 v[242:243], v15 offset:2048
Mvva 164,212,72
Mvva 164,216,80
s_waitcnt lgkmcnt(2)
ds_read_b64_tr_b16 v[244:245], v15 offset:4096
ds_read_b64_tr_b16 v[246:247], v15 offset:6144
Mvva 164,220,88
buffer_load_dwordx4 v114, s[12:15], s50 offen offset:2048 lds
Mvva 180,208,68
s_waitcnt vmcnt(15)
ds_read_b64_tr_b16 v[248:249], v15 offset:8192
ds_read_b64_tr_b16 v[250:251], v15 offset:10240
Mvva 180,212,76
Mvva 180,216,84
s_barrier
ds_read_b64_tr_b16 v[252:253], v15 offset:12288
ds_read_b64_tr_b16 v[254:255], v15 offset:14336
Mvva 180,220,92
buffer_load_dwordx4 v114, s[12:15], s51 offen offset:3072 lds
v_xor_b32 v114, 128, v114
v_add_u32 v114, 262144, v114
Mvva 168,224,64
ds_read_b64_tr_b16 v[192:193], v12 offset:16384
ds_read_b64_tr_b16 v[194:195], v12 offset:18432
Mvva 168,228,72
Mvva 168,232,80
ds_read_b64_tr_b16 v[196:197], v12 offset:20480
ds_read_b64_tr_b16 v[198:199], v12 offset:22528
Mvva 168,236,88
buffer_load_dwordx4 a[128:131], v112, s[8:11], s52 offen offset:0 sc1
Mvva 184,224,68
s_waitcnt lgkmcnt(4)
ds_read_b64_tr_b16 v[200:201], v12 offset:24576
ds_read_b64_tr_b16 v[202:203], v12 offset:26624
Mvva 184,228,76
Mvva 184,232,84
ds_read_b64_tr_b16 v[204:205], v12 offset:28672
ds_read_b64_tr_b16 v[206:207], v12 offset:30720
Mvva 184,236,92
buffer_load_dwordx4 a[132:135], v112, s[8:11], s52 offen offset:1024 sc1
s_add_u32 s52, s52, 8192
Mvva 172,240,64
ds_read_b64_tr_b16 v[208:209], v13 offset:16384
ds_read_b64_tr_b16 v[210:211], v13 offset:18432
Mvva 172,244,72
Mvva 172,248,80
ds_read_b64_tr_b16 v[212:213], v13 offset:20480
ds_read_b64_tr_b16 v[214:215], v13 offset:22528
Mvva 172,252,88
buffer_load_dwordx4 a[136:139], v112, s[8:11], s52 offen offset:0 sc1
Mvva 188,240,68
s_waitcnt lgkmcnt(4)
ds_read_b64_tr_b16 v[216:217], v13 offset:24576
ds_read_b64_tr_b16 v[218:219], v13 offset:26624
Mvva 188,244,76
Mvva 188,248,84
ds_read_b64_tr_b16 v[220:221], v13 offset:28672
ds_read_b64_tr_b16 v[222:223], v13 offset:30720
Mvva 188,252,92
buffer_load_dwordx4 a[140:143], v112, s[8:11], s52 offen offset:1024 sc1
s_add_u32 s52, s52, 8192
Mvva 128,192,64
ds_read_b64_tr_b16 v[224:225], v14 offset:16384
ds_read_b64_tr_b16 v[226:227], v14 offset:18432
Mvva 128,196,72
s_cmp_lt_u32 s93, 224
s_cbranch_scc1 L_f2A
L_f2Ar:
Mvva 128,200,80
s_add_u32 m0, s44, 0
ds_read_b64_tr_b16 v[228:229], v14 offset:20480
ds_read_b64_tr_b16 v[230:231], v14 offset:22528
Mvva 128,204,88
buffer_load_dwordx4 v114, s[12:15], s48 offen offset:0 lds
Mvva 144,192,68
s_waitcnt lgkmcnt(4)
ds_read_b64_tr_b16 v[232:233], v14 offset:24576
ds_read_b64_tr_b16 v[234:235], v14 offset:26624
Mvva 144,196,76
Mvva 144,200,84
ds_read_b64_tr_b16 v[236:237], v14 offset:28672
ds_read_b64_tr_b16 v[238:239], v14 offset:30720
Mvva 144,204,92
buffer_load_dwordx4 v114, s[12:15], s49 offen offset:1024 lds
Mvva 132,208,64
ds_read_b64_tr_b16 v[240:241], v15 offset:16384
ds_read_b64_tr_b16 v[242:243], v15 offset:18432
Mvva 132,212,72
Mvva 132,216,80
s_waitcnt lgkmcnt(2)
ds_read_b64_tr_b16 v[244:245], v15 offset:20480
ds_read_b64_tr_b16 v[246:247], v15 offset:22528
Mvva 132,220,88
buffer_load_dwordx4 v114, s[12:15], s50 offen offset:2048 lds
Mvva 148,208,68
s_waitcnt vmcnt(15)
ds_read_b64_tr_b16 v[248:249], v15 offset:24576
ds_read_b64_tr_b16 v[250:251], v15 offset:26624
Mvva 148,212,76
Mvva 148,216,84
s_barrier
ds_read_b64_tr_b16 v[252:253], v15 offset:28672
ds_read_b64_tr_b16 v[254:255], v15 offset:30720
Mvva 148,220,92
buffer_load_dwordx4 v114, s[12:15], s51 offen offset:3072 lds
v_xor_b32 v114, 128, v114
Mvva 136,224,64
ds_read_b64_tr_b16 v[192:193], v12 offset:32768
ds_read_b64_tr_b16 v[194:195], v12 offset:34816
Mvva 136,228,72
Mvva 136,232,80
ds_read_b64_tr_b16 v[196:197], v12 offset:36864
ds_read_b64_tr_b16 v[198:199], v12 offset:38912
Mvva 136,236,88
buffer_load_dwordx4 a[144:147], v112, s[8:11], s52 offen offset:0 sc1
Mvva 152,224,68
s_waitcnt lgkmcnt(4)
ds_read_b64_tr_b16 v[200:201], v12 offset:40960
ds_read_b64_tr_b16 v[202:203], v12 offset:43008
Mvva 152,228,76
Mvva 152,232,84
ds_read_b64_tr_b16 v[204:205], v12 offset:45056
ds_read_b64_tr_b16 v[206:207], v12 offset:47104
Mvva 152,236,92
buffer_load_dwordx4 a[148:151], v112, s[8:11], s52 offen offset:1024 sc1
s_add_u32 s52, s52, 8192
Mvva 140,240,64
ds_read_b64_tr_b16 v[208:209], v13 offset:32768
ds_read_b64_tr_b16 v[210:211], v13 offset:34816
Mvva 140,244,72
Mvva 140,248,80
ds_read_b64_tr_b16 v[212:213], v13 offset:36864
ds_read_b64_tr_b16 v[214:215], v13 offset:38912
Mvva 140,252,88
buffer_load_dwordx4 a[152:155], v112, s[8:11], s52 offen offset:0 sc1
Mvva 156,240,68
s_waitcnt lgkmcnt(4)
ds_read_b64_tr_b16 v[216:217], v13 offset:40960
ds_read_b64_tr_b16 v[218:219], v13 offset:43008
Mvva 156,244,76
Mvva 156,248,84
s_waitcnt vmcnt(15)
ds_read_b64_tr_b16 v[220:221], v13 offset:45056
ds_read_b64_tr_b16 v[222:223], v13 offset:47104
Mvva 156,252,92
buffer_load_dwordx4 a[156:159], v112, s[8:11], s52 offen offset:1024 sc1
s_add_u32 s52, s52, 8192
Mvva 160,192,96
ds_read_b64_tr_b16 v[224:225], v14 offset:32768
ds_read_b64_tr_b16 v[226:227], v14 offset:34816
Mvva 160,196,104
Mvva 160,200,112
s_add_u32 m0, s44, 16384
ds_read_b64_tr_b16 v[228:229], v14 offset:36864
ds_read_b64_tr_b16 v[230:231], v14 offset:38912
Mvva 160,204,120
buffer_load_dwordx4 v114, s[12:15], s48 offen offset:0 lds
Mvva 176,192,100
s_waitcnt lgkmcnt(4)
ds_read_b64_tr_b16 v[232:233], v14 offset:40960
ds_read_b64_tr_b16 v[234:235], v14 offset:43008
Mvva 176,196,108
Mvva 176,200,116
ds_read_b64_tr_b16 v[236:237], v14 offset:45056
ds_read_b64_tr_b16 v[238:239], v14 offset:47104
Mvva 176,204,124
buffer_load_dwordx4 v114, s[12:15], s49 offen offset:1024 lds
Mvva 164,208,96
ds_read_b64_tr_b16 v[240:241], v15 offset:32768
ds_read_b64_tr_b16 v[242:243], v15 offset:34816
Mvva 164,212,104
Mvva 164,216,112
s_waitcnt lgkmcnt(2)
ds_read_b64_tr_b16 v[244:245], v15 offset:36864
ds_read_b64_tr_b16 v[246:247], v15 offset:38912
Mvva 164,220,120
buffer_load_dwordx4 v114, s[12:15], s50 offen offset:2048 lds
Mvva 180,208,100
s_waitcnt vmcnt(15)
ds_read_b64_tr_b16 v[248:249], v15 offset:40960
ds_read_b64_tr_b16 v[250:251], v15 offset:43008
Mvva 180,212,108
Mvva 180,216,116
s_barrier
ds_read_b64_tr_b16 v[252:253], v15 offset:45056
ds_read_b64_tr_b16 v[254:255], v15 offset:47104
Mvva 180,220,124
buffer_load_dwordx4 v114, s[12:15], s51 offen offset:3072 lds
v_xor_b32 v114, 128, v114
v_add_u32 v114, 262144, v114
Mvva 168,224,96
ds_read_b64_tr_b16 v[192:193], v12 offset:49152
ds_read_b64_tr_b16 v[194:195], v12 offset:51200
Mvva 168,228,104
Mvva 168,232,112
ds_read_b64_tr_b16 v[196:197], v12 offset:53248
ds_read_b64_tr_b16 v[198:199], v12 offset:55296
Mvva 168,236,120
buffer_load_dwordx4 a[160:163], v112, s[8:11], s52 offen offset:0 sc1
Mvva 184,224,100
s_waitcnt lgkmcnt(4)
ds_read_b64_tr_b16 v[200:201], v12 offset:57344
ds_read_b64_tr_b16 v[202:203], v12 offset:59392
Mvva 184,228,108
Mvva 184,232,116
ds_read_b64_tr_b16 v[204:205], v12 offset:61440
ds_read_b64_tr_b16 v[206:207], v12 offset:63488
Mvva 184,236,124
buffer_load_dwordx4 a[164:167], v112, s[8:11], s52 offen offset:1024 sc1
s_add_u32 s52, s52, 8192
Mvva 172,240,96
ds_read_b64_tr_b16 v[208:209], v13 offset:49152
ds_read_b64_tr_b16 v[210:211], v13 offset:51200
Mvva 172,244,104
Mvva 172,248,112
ds_read_b64_tr_b16 v[212:213], v13 offset:53248
ds_read_b64_tr_b16 v[214:215], v13 offset:55296
Mvva 172,252,120
buffer_load_dwordx4 a[168:171], v112, s[8:11], s52 offen offset:0 sc1
Mvva 188,240,100
s_waitcnt lgkmcnt(4)
ds_read_b64_tr_b16 v[216:217], v13 offset:57344
ds_read_b64_tr_b16 v[218:219], v13 offset:59392
Mvva 188,244,108
Mvva 188,248,116
ds_read_b64_tr_b16 v[220:221], v13 offset:61440
ds_read_b64_tr_b16 v[222:223], v13 offset:63488
Mvva 188,252,124
buffer_load_dwordx4 a[172:175], v112, s[8:11], s52 offen offset:1024 sc1
s_add_u32 s52, s52, 8192
Mvva 128,192,96
ds_read_b64_tr_b16 v[224:225], v14 offset:49152
ds_read_b64_tr_b16 v[226:227], v14 offset:51200
Mvva 128,196,104
Mvva 128,200,112
s_add_u32 m0, s44, 32768
ds_read_b64_tr_b16 v[228:229], v14 offset:53248
ds_read_b64_tr_b16 v[230:231], v14 offset:55296
Mvva 128,204,120
buffer_load_dwordx4 v114, s[12:15], s48 offen offset:0 lds
Mvva 144,192,100
s_waitcnt lgkmcnt(4)
ds_read_b64_tr_b16 v[232:233], v14 offset:57344
ds_read_b64_tr_b16 v[234:235], v14 offset:59392
Mvva 144,196,108
Mvva 144,200,116
ds_read_b64_tr_b16 v[236:237], v14 offset:61440
ds_read_b64_tr_b16 v[238:239], v14 offset:63488
Mvva 144,204,124
buffer_load_dwordx4 v114, s[12:15], s49 offen offset:1024 lds
Mvva 132,208,96
ds_read_b64_tr_b16 v[240:241], v15 offset:49152
ds_read_b64_tr_b16 v[242:243], v15 offset:51200
Mvva 132,212,104
Mvva 132,216,112
s_waitcnt lgkmcnt(2)
ds_read_b64_tr_b16 v[244:245], v15 offset:53248
ds_read_b64_tr_b16 v[246:247], v15 offset:55296
Mvva 132,220,120
buffer_load_dwordx4 v114, s[12:15], s50 offen offset:2048 lds
Mvva 148,208,100
s_waitcnt vmcnt(15)
ds_read_b64_tr_b16 v[248:249], v15 offset:57344
ds_read_b64_tr_b16 v[250:251], v15 offset:59392
Mvva 148,212,108
s_cmp_lt_u32 s93, 224
s_cbranch_scc1 L_f2B
L_f2Br:
Mvva 148,216,116
s_barrier
ds_read_b64_tr_b16 v[252:253], v15 offset:61440
ds_read_b64_tr_b16 v[254:255], v15 offset:63488
Mvva 148,220,124
buffer_load_dwordx4 v114, s[12:15], s51 offen offset:3072 lds
v_xor_b32 v114, 128, v114
Mvva 136,224,96
ds_read_b64_tr_b16 v[192:193], v115 offset:0
ds_read_b64_tr_b16 v[194:195], v115 offset:2048
Mvva 136,228,104
Mvva 136,232,112
ds_read_b64_tr_b16 v[196:197], v115 offset:4096
ds_read_b64_tr_b16 v[198:199], v115 offset:6144
Mvva 136,236,120
buffer_load_dwordx4 a[176:179], v112, s[8:11], s52 offen offset:0 sc1
Mvva 152,224,100
s_waitcnt lgkmcnt(4)
ds_read_b64_tr_b16 v[200:201], v115 offset:8192
ds_read_b64_tr_b16 v[202:203], v115 offset:10240
Mvva 152,228,108
Mvva 152,232,116
ds_read_b64_tr_b16 v[204:205], v115 offset:12288
ds_read_b64_tr_b16 v[206:207], v115 offset:14336
Mvva 152,236,124
buffer_load_dwordx4 a[180:183], v112, s[8:11], s52 offen offset:1024 sc1
s_add_u32 s52, s52, 8192
Mvva 140,240,96
ds_read_b64_tr_b16 v[208:209], v116 offset:0
ds_read_b64_tr_b16 v[210:211], v116 offset:2048
Mvva 140,244,104
Mvva 140,248,112
ds_read_b64_tr_b16 v[212:213], v116 offset:4096
ds_read_b64_tr_b16 v[214:215], v116 offset:6144
Mvva 140,252,120
buffer_load_dwordx4 a[184:187], v112, s[8:11], s52 offen offset:0 sc1
Mvva 156,240,100
s_waitcnt lgkmcnt(4)
ds_read_b64_tr_b16 v[216:217], v116 offset:8192
ds_read_b64_tr_b16 v[218:219], v116 offset:10240
Mvva 156,244,108
Mvva 156,248,116
s_waitcnt vmcnt(15)
ds_read_b64_tr_b16 v[220:221], v116 offset:12288
ds_read_b64_tr_b16 v[222:223], v116 offset:14336
Mvva 156,252,124
buffer_load_dwordx4 a[188:191], v112, s[8:11], s52 offen offset:1024 sc1
s_add_u32 s52, s52, 8192
Mvva 160,192,128
ds_read_b64_tr_b16 v[224:225], v117 offset:0
ds_read_b64_tr_b16 v[226:227], v117 offset:2048
Mvva 160,196,136
Mvva 160,200,144
s_add_u32 m0, s44, 49152
ds_read_b64_tr_b16 v[228:229], v117 offset:4096
ds_read_b64_tr_b16 v[230:231], v117 offset:6144
Mvva 160,204,152
buffer_load_dwordx4 v114, s[12:15], s48 offen offset:0 lds
Mvva 176,192,132
s_waitcnt lgkmcnt(4)
ds_read_b64_tr_b16 v[232:233], v117 offset:8192
ds_read_b64_tr_b16 v[234:235], v117 offset:10240
Mvva 176,196,140
Mvva 176,200,148
ds_read_b64_tr_b16 v[236:237], v117 offset:12288
ds_read_b64_tr_b16 v[238:239], v117 offset:14336
Mvva 176,204,156
buffer_load_dwordx4 v114, s[12:15], s49 offen offset:1024 lds
Mvva 164,208,128
ds_read_b64_tr_b16 v[240:241], v118 offset:0
ds_read_b64_tr_b16 v[242:243], v118 offset:2048
Mvva 164,212,136
Mvva 164,216,144
s_waitcnt lgkmcnt(2)
ds_read_b64_tr_b16 v[244:245], v118 offset:4096
ds_read_b64_tr_b16 v[246:247], v118 offset:6144
Mvva 164,220,152
buffer_load_dwordx4 v114, s[12:15], s50 offen offset:2048 lds
Mvva 180,208,132
s_waitcnt vmcnt(15)
ds_read_b64_tr_b16 v[248:249], v118 offset:8192
ds_read_b64_tr_b16 v[250:251], v118 offset:10240
Mvva 180,212,140
Mvva 180,216,148
s_barrier
ds_read_b64_tr_b16 v[252:253], v118 offset:12288
ds_read_b64_tr_b16 v[254:255], v118 offset:14336
Mvva 180,220,156
buffer_load_dwordx4 v114, s[12:15], s51 offen offset:3072 lds
v_xor_b32 v114, 128, v114
v_add_u32 v114, 262144, v114
Mvva 168,224,128
ds_read_b64_tr_b16 v[192:193], v115 offset:16384
ds_read_b64_tr_b16 v[194:195], v115 offset:18432
Mvva 168,228,136
Mvva 168,232,144
ds_read_b64_tr_b16 v[196:197], v115 offset:20480
ds_read_b64_tr_b16 v[198:199], v115 offset:22528
Mvva 168,236,152
buffer_load_dwordx4 a[192:195], v112, s[8:11], s52 offen offset:0 sc1
Mvva 184,224,132
s_waitcnt lgkmcnt(4)
ds_read_b64_tr_b16 v[200:201], v115 offset:24576
ds_read_b64_tr_b16 v[202:203], v115 offset:26624
Mvva 184,228,140
Mvva 184,232,148
ds_read_b64_tr_b16 v[204:205], v115 offset:28672
ds_read_b64_tr_b16 v[206:207], v115 offset:30720
Mvva 184,236,156
buffer_load_dwordx4 a[196:199], v112, s[8:11], s52 offen offset:1024 sc1
s_add_u32 s52, s52, 8192
Mvva 172,240,128
ds_read_b64_tr_b16 v[208:209], v116 offset:16384
ds_read_b64_tr_b16 v[210:211], v116 offset:18432
Mvva 172,244,136
Mvva 172,248,144
ds_read_b64_tr_b16 v[212:213], v116 offset:20480
ds_read_b64_tr_b16 v[214:215], v116 offset:22528
Mvva 172,252,152
buffer_load_dwordx4 a[200:203], v112, s[8:11], s52 offen offset:0 sc1
Mvva 188,240,132
s_waitcnt lgkmcnt(4)
ds_read_b64_tr_b16 v[216:217], v116 offset:24576
ds_read_b64_tr_b16 v[218:219], v116 offset:26624
Mvva 188,244,140
Mvva 188,248,148
ds_read_b64_tr_b16 v[220:221], v116 offset:28672
ds_read_b64_tr_b16 v[222:223], v116 offset:30720
Mvva 188,252,156
buffer_load_dwordx4 a[204:207], v112, s[8:11], s52 offen offset:1024 sc1
s_add_u32 s52, s52, 8192
Mvva 128,192,128
ds_read_b64_tr_b16 v[224:225], v117 offset:16384
ds_read_b64_tr_b16 v[226:227], v117 offset:18432
Mvva 128,196,136
Mvva 128,200,144
s_add_u32 m0, s44, 65536
ds_read_b64_tr_b16 v[228:229], v117 offset:20480
ds_read_b64_tr_b16 v[230:231], v117 offset:22528
Mvva 128,204,152
buffer_load_dwordx4 v114, s[12:15], s48 offen offset:0 lds
Mvva 144,192,132
s_waitcnt lgkmcnt(4)
ds_read_b64_tr_b16 v[232:233], v117 offset:24576
ds_read_b64_tr_b16 v[234:235], v117 offset:26624
Mvva 144,196,140
Mvva 144,200,148
ds_read_b64_tr_b16 v[236:237], v117 offset:28672
ds_read_b64_tr_b16 v[238:239], v117 offset:30720
Mvva 144,204,156
buffer_load_dwordx4 v114, s[12:15], s49 offen offset:1024 lds
Mvva 132,208,128
ds_read_b64_tr_b16 v[240:241], v118 offset:16384
ds_read_b64_tr_b16 v[242:243], v118 offset:18432
Mvva 132,212,136
Mvva 132,216,144
s_waitcnt lgkmcnt(2)
ds_read_b64_tr_b16 v[244:245], v118 offset:20480
ds_read_b64_tr_b16 v[246:247], v118 offset:22528
Mvva 132,220,152
buffer_load_dwordx4 v114, s[12:15], s50 offen offset:2048 lds
Mvva 148,208,132
s_waitcnt vmcnt(15)
ds_read_b64_tr_b16 v[248:249], v118 offset:24576
ds_read_b64_tr_b16 v[250:251], v118 offset:26624
Mvva 148,212,140
Mvva 148,216,148
s_barrier
ds_read_b64_tr_b16 v[252:253], v118 offset:28672
ds_read_b64_tr_b16 v[254:255], v118 offset:30720
Mvva 148,220,156
buffer_load_dwordx4 v114, s[12:15], s51 offen offset:3072 lds
v_xor_b32 v114, 128, v114
Mvva 136,224,128
ds_read_b64_tr_b16 v[192:193], v115 offset:32768
ds_read_b64_tr_b16 v[194:195], v115 offset:34816
Mvva 136,228,136
s_cmp_ge_u32 s2, 128
s_cbranch_scc1 L_c31
L_c31r:
Mvva 136,232,144
ds_read_b64_tr_b16 v[196:197], v115 offset:36864
ds_read_b64_tr_b16 v[198:199], v115 offset:38912
Mvva 136,236,152
buffer_load_dwordx4 a[208:211], v112, s[8:11], s52 offen offset:0 sc1
Mvva 152,224,132
s_waitcnt lgkmcnt(4)
ds_read_b64_tr_b16 v[200:201], v115 offset:40960
ds_read_b64_tr_b16 v[202:203], v115 offset:43008
Mvva 152,228,140
Mvva 152,232,148
ds_read_b64_tr_b16 v[204:205], v115 offset:45056
ds_read_b64_tr_b16 v[206:207], v115 offset:47104
Mvva 152,236,156
buffer_load_dwordx4 a[212:215], v112, s[8:11], s52 offen offset:1024 sc1
s_add_u32 s52, s52, 8192
Mvva 140,240,128
ds_read_b64_tr_b16 v[208:209], v116 offset:32768
ds_read_b64_tr_b16 v[210:211], v116 offset:34816
Mvva 140,244,136
Mvva 140,248,144
ds_read_b64_tr_b16 v[212:213], v116 offset:36864
ds_read_b64_tr_b16 v[214:215], v116 offset:38912
Mvva 140,252,152
buffer_load_dwordx4 a[216:219], v112, s[8:11], s52 offen offset:0 sc1
Mvva 156,240,132
s_waitcnt lgkmcnt(4)
ds_read_b64_tr_b16 v[216:217], v116 offset:40960
ds_read_b64_tr_b16 v[218:219], v116 offset:43008
Mvva 156,244,140
s_waitcnt vmcnt(16)
Va 74,74,78
Va 75,75,79
v_add_f32_e64 v76, v76, v80
Mvva 156,248,148
s_waitcnt vmcnt(15)
ds_read_b64_tr_b16 v[220:221], v116 offset:45056
ds_read_b64_tr_b16 v[222:223], v116 offset:47104
Va 77,77,81
Mvva 156,252,156
buffer_load_dwordx4 a[220:223], v112, s[8:11], s52 offen offset:1024 sc1
s_add_u32 s52, s52, 8192
Mvva 160,192,160
ds_read_b64_tr_b16 v[224:225], v117 offset:32768
ds_read_b64_tr_b16 v[226:227], v117 offset:34816
v_add_f32_e64 v74, v74, v82
Mvva 160,196,168
Va 75,75,83
Va 76,76,84
v_add_f32_e64 v77, v77, v85
Mvva 160,200,176
s_add_u32 m0, s44, 81920
ds_read_b64_tr_b16 v[228:229], v117 offset:36864
ds_read_b64_tr_b16 v[230:231], v117 offset:38912
v_add_f32_e64 v74, v74, v86
Mvva 160,204,184
buffer_load_dwordx4 v114, s[12:15], s48 offen offset:0 lds
Mvva 176,192,164
s_waitcnt lgkmcnt(4)
ds_read_b64_tr_b16 v[232:233], v117 offset:40960
ds_read_b64_tr_b16 v[234:235], v117 offset:43008
Va 75,75,87
Mvva 176,196,172
Va 76,76,88
Va 77,77,89
v_add_f32_e64 v74, v74, v90
Mvva 176,200,180
ds_read_b64_tr_b16 v[236:237], v117 offset:45056
ds_read_b64_tr_b16 v[238:239], v117 offset:47104
v_add_f32_e64 v75, v75, v91
Mvva 176,204,188
buffer_load_dwordx4 v114, s[12:15], s49 offen offset:1024 lds
Mvva 164,208,160
ds_read_b64_tr_b16 v[240:241], v118 offset:32768
ds_read_b64_tr_b16 v[242:243], v118 offset:34816
v_add_f32_e64 v76, v76, v92
Mvva 164,212,168
Va 77,77,93
Va 74,74,94
v_add_f32_e64 v75, v75, v95
Mvva 164,216,176
s_waitcnt lgkmcnt(2)
ds_read_b64_tr_b16 v[244:245], v118 offset:36864
ds_read_b64_tr_b16 v[246:247], v118 offset:38912
Va 76,76,96
Mvva 164,220,184
buffer_load_dwordx4 v114, s[12:15], s50 offen offset:2048 lds
Mvva 180,208,164
s_waitcnt vmcnt(15)
ds_read_b64_tr_b16 v[248:249], v118 offset:40960
ds_read_b64_tr_b16 v[250:251], v118 offset:43008
Va 77,77,97
Mvva 180,212,172
Va 74,74,98
Va 75,75,99
v_add_f32_e64 v76, v76, v100
Mvva 180,216,180
s_barrier
ds_read_b64_tr_b16 v[252:253], v118 offset:45056
ds_read_b64_tr_b16 v[254:255], v118 offset:47104
Va 77,77,101
Mvva 180,220,188
buffer_load_dwordx4 v114, s[12:15], s51 offen offset:3072 lds
v_xor_b32 v114, 128, v114
v_add_u32 v114, 262144, v114
Mvva 168,224,160
ds_read_b64_tr_b16 v[192:193], v115 offset:49152
ds_read_b64_tr_b16 v[194:195], v115 offset:51200
v_add_f32_e64 v74, v74, v102
Mvva 168,228,168
Va 75,75,103
Va 76,76,104
v_add_f32_e64 v77, v77, v105
Mvva 168,232,176
ds_read_b64_tr_b16 v[196:197], v115 offset:53248
ds_read_b64_tr_b16 v[198:199], v115 offset:55296
Mvva 168,236,184
buffer_load_dwordx4 a[224:227], v112, s[8:11], s52 offen offset:0 sc1
Mvva 184,224,164
s_waitcnt lgkmcnt(4)
ds_read_b64_tr_b16 v[200:201], v115 offset:57344
ds_read_b64_tr_b16 v[202:203], v115 offset:59392
Mvva 184,228,172
ds_read_b64_tr_b16 v[90:91], v106 offset:0
ds_read_b64_tr_b16 v[92:93], v106 offset:2048
ds_read_b64_tr_b16 v[94:95], v107 offset:0
Mvva 184,232,180
ds_read_b64_tr_b16 v[204:205], v115 offset:61440
ds_read_b64_tr_b16 v[206:207], v115 offset:63488
Mvva 184,236,188
buffer_load_dwordx4 a[228:231], v112, s[8:11], s52 offen offset:1024 sc1
s_add_u32 s52, s52, 8192
Mvva 172,240,160
ds_read_b64_tr_b16 v[208:209], v116 offset:49152
ds_read_b64_tr_b16 v[210:211], v116 offset:51200
Mvva 172,244,168
ds_read_b64_tr_b16 v[96:97], v107 offset:2048
ds_read_b64_tr_b16 v[98:99], v108 offset:0
s_waitcnt lgkmcnt(9)
ds_read_b64_tr_b16 v[100:101], v108 offset:2048
Mvva 172,248,176
ds_read_b64_tr_b16 v[212:213], v116 offset:53248
ds_read_b64_tr_b16 v[214:215], v116 offset:55296
Mvva 172,252,184
buffer_load_dwordx4 a[232:235], v112, s[8:11], s52 offen offset:0 sc1
Mvva 188,240,164
s_waitcnt lgkmcnt(7)
ds_read_b64_tr_b16 v[216:217], v116 offset:57344
ds_read_b64_tr_b16 v[218:219], v116 offset:59392
Mvva 188,244,172
ds_read_b64_tr_b16 v[102:103], v109 offset:0
ds_read_b64_tr_b16 v[104:105], v109 offset:2048
Vc 8,74,75
Mvva 188,248,180
ds_read_b64_tr_b16 v[220:221], v116 offset:61440
ds_read_b64_tr_b16 v[222:223], v116 offset:63488
v_lshlrev_b32 v74, 16, v8
Mvva 188,252,188
buffer_load_dwordx4 a[236:239], v112, s[8:11], s52 offen offset:1024 sc1
s_add_u32 s52, s52, 8192
Mvva 128,192,160
ds_read_b64_tr_b16 v[224:225], v117 offset:49152
ds_read_b64_tr_b16 v[226:227], v117 offset:51200
v_and_b32 v75, 0xffff0000, v8
Mvva 128,196,168
Vc 8,76,77
v_lshlrev_b32_e64 v76, 16, v8
v_and_b32 v77, 0xffff0000, v8
Mvva 128,200,176
s_add_u32 m0, s44, 98304
s_waitcnt lgkmcnt(9)
ds_read_b64_tr_b16 v[228:229], v117 offset:53248
ds_read_b64_tr_b16 v[230:231], v117 offset:55296
v_mov_b32 v78, v74
Mvva 128,204,184
buffer_load_dwordx4 v114, s[12:15], s48 offen offset:0 lds
Mvva 144,192,164
s_waitcnt lgkmcnt(4)
ds_read_b64_tr_b16 v[232:233], v117 offset:57344
ds_read_b64_tr_b16 v[234:235], v117 offset:59392
v_mov_b32 v79, v75
Mvva 144,196,172
v_mov_b32 v80, v76
v_mov_b32 v81, v77
v_permlane32_swap_b32 v78, v74
Mvva 144,200,180
ds_read_b64_tr_b16 v[236:237], v117 offset:61440
ds_read_b64_tr_b16 v[238:239], v117 offset:63488
v_permlane32_swap_b32 v79, v75
Mvva 144,204,188
buffer_load_dwordx4 v114, s[12:15], s49 offen offset:1024 lds
Mvva 132,208,160
ds_read_b64_tr_b16 v[240:241], v118 offset:49152
ds_read_b64_tr_b16 v[242:243], v118 offset:51200
v_permlane32_swap_b32 v80, v76
Mvva 132,212,168
v_permlane32_swap_b32 v81, v77
v_mul_f32 v82, 0xbfb8aa3b, v78
v_mul_f32 v83, 0xbfb8aa3b, v79
Mvva 132,216,176
s_waitcnt lgkmcnt(2)
ds_read_b64_tr_b16 v[244:245], v118 offset:53248
ds_read_b64_tr_b16 v[246:247], v118 offset:55296
v_mul_f32 v84, 0xbfb8aa3b, v80
Mvva 132,220,184
buffer_load_dwordx4 v114, s[12:15], s50 offen offset:2048 lds
Mvva 148,208,164
s_waitcnt vmcnt(15)
ds_read_b64_tr_b16 v[248:249], v118 offset:57344
ds_read_b64_tr_b16 v[250:251], v118 offset:59392
v_mul_f32 v85, 0xbfb8aa3b, v81
Mvva 148,212,172
VE 82,82
Mvva 148,216,180
s_barrier
ds_read_b64_tr_b16 v[252:253], v118 offset:61440
ds_read_b64_tr_b16 v[254:255], v118 offset:63488
Mvva 148,220,188
buffer_load_dwordx4 v114, s[12:15], s51 offen offset:3072 lds
v_xor_b32 v114, 128, v114
Mvva 136,224,160
ds_read_b64_tr_b16 v[192:193], v12 offset:0
ds_read_b64_tr_b16 v[194:195], v12 offset:2048
Mvva 136,228,168
Ve 83,83
Mvva 136,232,176
ds_read_b64_tr_b16 v[196:197], v12 offset:4096
ds_read_b64_tr_b16 v[198:199], v12 offset:6144
Mvva 136,236,184
buffer_load_dwordx4 a[240:243], v112, s[8:11], s52 offen offset:0 sc1
Mvva 152,224,164
s_waitcnt lgkmcnt(4)
ds_read_b64_tr_b16 v[200:201], v12 offset:8192
ds_read_b64_tr_b16 v[202:203], v12 offset:10240
Mvva 152,228,172
Ve 84,84
Mvva 152,232,180
ds_read_b64_tr_b16 v[204:205], v12 offset:12288
ds_read_b64_tr_b16 v[206:207], v12 offset:14336
Mvva 152,236,188
buffer_load_dwordx4 a[244:247], v112, s[8:11], s52 offen offset:1024 sc1
s_add_u32 s52, s52, 8192
Mvva 140,240,160
ds_read_b64_tr_b16 v[208:209], v13 offset:0
ds_read_b64_tr_b16 v[210:211], v13 offset:2048
Mvva 140,244,168
Ve 85,85
v_add_f32 v82, 1.0, v82
Mvva 140,248,176
ds_read_b64_tr_b16 v[212:213], v13 offset:4096
ds_read_b64_tr_b16 v[214:215], v13 offset:6144
v_add_f32_e64 v83, 1.0, v83
Mvva 140,252,184
buffer_load_dwordx4 a[248:251], v112, s[8:11], s52 offen offset:0 sc1
Mvva 156,240,164
s_waitcnt lgkmcnt(4)
ds_read_b64_tr_b16 v[216:217], v13 offset:8192
ds_read_b64_tr_b16 v[218:219], v13 offset:10240
v_add_f32 v84, 1.0, v84
Mvva 156,244,172
v_add_f32 v85, 1.0, v85
v_rcp_f32 v82, v82
Mvva 156,248,180
s_waitcnt vmcnt(15)
ds_read_b64_tr_b16 v[220:221], v13 offset:12288
ds_read_b64_tr_b16 v[222:223], v13 offset:14336
Mvva 156,252,188
buffer_load_dwordx4 a[252:255], v112, s[8:11], s52 offen offset:1024 sc1
s_add_u32 s52, s52, 8192
Mvva 160,192,192
ds_read_b64_tr_b16 v[224:225], v14 offset:0
ds_read_b64_tr_b16 v[226:227], v14 offset:2048
Mvva 160,196,200
v_rcp_f32 v83, v83
Mvva 160,200,208
s_add_u32 m0, s44, 114688
ds_read_b64_tr_b16 v[228:229], v14 offset:4096
ds_read_b64_tr_b16 v[230:231], v14 offset:6144
Mvva 160,204,216
buffer_load_dwordx4 v114, s[12:15], s48 offen offset:0 lds
Mvva 176,192,196
s_waitcnt lgkmcnt(4)
ds_read_b64_tr_b16 v[232:233], v14 offset:8192
ds_read_b64_tr_b16 v[234:235], v14 offset:10240
Mvva 176,196,204
v_rcp_f32 v84, v84
Mvva 176,200,212
ds_read_b64_tr_b16 v[236:237], v14 offset:12288
ds_read_b64_tr_b16 v[238:239], v14 offset:14336
Mvva 176,204,220
buffer_load_dwordx4 v114, s[12:15], s49 offen offset:1024 lds
Mvva 164,208,192
ds_read_b64_tr_b16 v[240:241], v15 offset:0
ds_read_b64_tr_b16 v[242:243], v15 offset:2048
Mvva 164,212,200
v_rcp_f32 v85, v85
Vm 78,78,82
Mvva 164,216,208
s_waitcnt lgkmcnt(2)
ds_read_b64_tr_b16 v[244:245], v15 offset:4096
ds_read_b64_tr_b16 v[246:247], v15 offset:6144
Vm 79,79,83
Mvva 164,220,216
buffer_load_dwordx4 v114, s[12:15], s50 offen offset:2048 lds
Mvva 180,208,196
s_waitcnt vmcnt(15)
ds_read_b64_tr_b16 v[248:249], v15 offset:8192
ds_read_b64_tr_b16 v[250:251], v15 offset:10240
Vm 80,80,84
Mvva 180,212,204
v_mul_f32_e64 v81, v81, v85
Vc 8,78,79
v_lshlrev_b32_e64 v78, 16, v8
Mvva 180,216,212
s_barrier
ds_read_b64_tr_b16 v[252:253], v15 offset:12288
ds_read_b64_tr_b16 v[254:255], v15 offset:14336
v_and_b32 v79, 0xffff0000, v8
Mvva 180,220,220
buffer_load_dwordx4 v114, s[12:15], s51 offen offset:3072 lds
v_xor_b32 v114, 128, v114
v_add_u32 v114, 262144, v114
Mvva 168,224,192
ds_read_b64_tr_b16 v[192:193], v12 offset:16384
ds_read_b64_tr_b16 v[194:195], v12 offset:18432
Vc 8,80,81
Mvva 168,228,200
v_lshlrev_b32 v80, 16, v8
v_and_b32 v81, 0xffff0000, v8
v_mul_f32_e64 v74, v74, v78
Mvva 168,232,208
ds_read_b64_tr_b16 v[196:197], v12 offset:20480
ds_read_b64_tr_b16 v[198:199], v12 offset:22528
v_mul_f32_e64 v75, v75, v79
Mvva 168,236,216
buffer_load_dwordx4 a[0:3], v112, s[8:11], s52 offen offset:0 sc1
Mvva 184,224,196
s_waitcnt lgkmcnt(4)
ds_read_b64_tr_b16 v[200:201], v12 offset:24576
ds_read_b64_tr_b16 v[202:203], v12 offset:26624
Vm 76,76,80
Mvva 184,228,204
v_mul_f32_e64 v77, v77, v81
Vc 8,74,75
Vc 9,76,77
Mvva 184,232,212
ds_read_b64_tr_b16 v[204:205], v12 offset:28672
ds_read_b64_tr_b16 v[206:207], v12 offset:30720
Mvva 184,236,220
buffer_load_dwordx4 a[4:7], v112, s[8:11], s52 offen offset:1024 sc1
s_add_u32 s52, s52, 8192
Mvva 172,240,192
ds_read_b64_tr_b16 v[208:209], v13 offset:16384
ds_read_b64_tr_b16 v[210:211], v13 offset:18432
Mvva 172,244,200
ds_write_b64 v2, v[8:9]
ds_read_b64 v[74:75], v3 offset:0
ds_read_b64 v[76:77], v3 offset:32
Mvva 172,248,208
ds_read_b64_tr_b16 v[212:213], v13 offset:20480
ds_read_b64_tr_b16 v[214:215], v13 offset:22528
Mvva 172,252,216
buffer_load_dwordx4 a[8:11], v112, s[8:11], s52 offen offset:0 sc1
Mvva 188,240,196
s_waitcnt lgkmcnt(7)
ds_read_b64_tr_b16 v[216:217], v13 offset:24576
ds_read_b64_tr_b16 v[218:219], v13 offset:26624
Mvva 188,244,204
ds_read_b64 v[78:79], v3 offset:64
ds_read_b64 v[80:81], v3 offset:96
Mvva 188,248,212
ds_read_b64_tr_b16 v[220:221], v13 offset:28672
ds_read_b64_tr_b16 v[222:223], v13 offset:30720
Mvva 188,252,220
buffer_load_dwordx4 a[12:15], v112, s[8:11], s52 offen offset:1024 sc1
s_add_u32 s52, s52, 8192
Mvva 128,192,192
ds_read_b64_tr_b16 v[224:225], v14 offset:16384
ds_read_b64_tr_b16 v[226:227], v14 offset:18432
Mvva 128,196,200
Mvva 128,200,208
s_add_u32 m0, s44, 0
s_waitcnt lgkmcnt(9)
ds_read_b64_tr_b16 v[228:229], v14 offset:20480
ds_read_b64_tr_b16 v[230:231], v14 offset:22528
Mvva 128,204,216
buffer_load_dwordx4 v114, s[12:15], s48 offen offset:0 lds
Mvva 144,192,196
s_waitcnt lgkmcnt(4)
ds_read_b64_tr_b16 v[232:233], v14 offset:24576
ds_read_b64_tr_b16 v[234:235], v14 offset:26624
Mvva 144,196,204
Zvvv 82,90,74
Mvva 144,200,212
ds_read_b64_tr_b16 v[236:237], v14 offset:28672
ds_read_b64_tr_b16 v[238:239], v14 offset:30720
Mvva 144,204,220
buffer_load_dwordx4 v114, s[12:15], s49 offen offset:1024 lds
Mvva 132,208,192
ds_read_b64_tr_b16 v[240:241], v15 offset:16384
ds_read_b64_tr_b16 v[242:243], v15 offset:18432
Mvva 132,212,200
Zvvv 86,94,74
Mvva 132,216,208
s_waitcnt lgkmcnt(2)
ds_read_b64_tr_b16 v[244:245], v15 offset:20480
ds_read_b64_tr_b16 v[246:247], v15 offset:22528
Mvva 132,220,216
buffer_load_dwordx4 v114, s[12:15], s50 offen offset:2048 lds
Mvva 148,208,196
s_waitcnt vmcnt(15)
ds_read_b64_tr_b16 v[248:249], v15 offset:24576
ds_read_b64_tr_b16 v[250:251], v15 offset:26624
Mvva 148,212,204
ds_read_b64_tr_b16 v[90:91], v106 offset:4096
ds_read_b64_tr_b16 v[92:93], v106 offset:6144
ds_read_b64_tr_b16 v[94:95], v107 offset:4096
Mvva 148,216,212
s_barrier
ds_read_b64_tr_b16 v[252:253], v15 offset:28672
ds_read_b64_tr_b16 v[254:255], v15 offset:30720
Mvva 148,220,220
buffer_load_dwordx4 v114, s[12:15], s51 offen offset:3072 lds
v_add_u32 v114, 262144, v114
Mvva 136,224,192
ds_read_b64_tr_b16 v[192:193], v12 offset:32768
ds_read_b64_tr_b16 v[194:195], v12 offset:34816
Mvva 136,228,200
ds_read_b64_tr_b16 v[96:97], v107 offset:6144
Mvva 136,232,208
ds_read_b64_tr_b16 v[196:197], v12 offset:36864
s_waitcnt lgkmcnt(9)
ds_read_b64_tr_b16 v[198:199], v12 offset:38912
Mvva 136,236,216
buffer_load_dwordx4 a[16:19], v112, s[8:11], s52 offen offset:0 sc1
Mvva 152,224,196
s_waitcnt lgkmcnt(5)
ds_read_b64_tr_b16 v[200:201], v12 offset:40960
ds_read_b64_tr_b16 v[202:203], v12 offset:43008
Mvva 152,228,204
Mvva 152,232,212
ds_read_b64_tr_b16 v[204:205], v12 offset:45056
ds_read_b64_tr_b16 v[206:207], v12 offset:47104
Mvva 152,236,220
buffer_load_dwordx4 a[20:23], v112, s[8:11], s52 offen offset:1024 sc1
s_add_u32 s52, s52, 8192
Mvva 140,240,192
ds_read_b64_tr_b16 v[208:209], v13 offset:32768
ds_read_b64_tr_b16 v[210:211], v13 offset:34816
Mvva 140,244,200
s_waitcnt lgkmcnt(8)
Mvvv 82,90,78
Mvva 140,248,208
ds_read_b64_tr_b16 v[212:213], v13 offset:36864
ds_read_b64_tr_b16 v[214:215], v13 offset:38912
Mvva 140,252,216
buffer_load_dwordx4 a[24:27], v112, s[8:11], s52 offen offset:0 sc1
Mvva 156,240,196
s_waitcnt lgkmcnt(4)
ds_read_b64_tr_b16 v[216:217], v13 offset:40960
ds_read_b64_tr_b16 v[218:219], v13 offset:43008
Mvva 156,244,204
Mvvv 86,94,78
Mvva 156,248,212
s_waitcnt vmcnt(15)
ds_read_b64_tr_b16 v[220:221], v13 offset:45056
ds_read_b64_tr_b16 v[222:223], v13 offset:47104
Mvva 156,252,220
buffer_load_dwordx4 a[28:31], v112, s[8:11], s52 offen offset:1024 sc1
s_add_u32 s52, s52, 8192
Mvva 160,192,224
s_add_u32 m0, s44, 16384
ds_read_b64_tr_b16 v[224:225], v14 offset:32768
ds_read_b64_tr_b16 v[226:227], v14 offset:34816
Mvva 160,196,232
buffer_load_dwordx4 v114, s[12:15], s48 offen offset:0 lds
Mvva 160,200,240
ds_read_b64_tr_b16 v[228:229], v14 offset:36864
ds_read_b64_tr_b16 v[230:231], v14 offset:38912
Mvva 160,204,248
Mvva 176,192,228
s_waitcnt lgkmcnt(4)
ds_read_b64_tr_b16 v[232:233], v14 offset:40960
ds_read_b64_tr_b16 v[234:235], v14 offset:43008
Mvva 176,196,236
buffer_load_dwordx4 v114, s[12:15], s49 offen offset:1024 lds
Mvva 176,200,244
ds_read_b64_tr_b16 v[236:237], v14 offset:45056
ds_read_b64_tr_b16 v[238:239], v14 offset:47104
Mvva 176,204,252
buffer_load_dwordx4 v114, s[12:15], s50 offen offset:2048 lds
Mvva 164,208,224
ds_read_b64_tr_b16 v[240:241], v15 offset:32768
ds_read_b64_tr_b16 v[242:243], v15 offset:34816
Mvva 164,212,232
buffer_load_dwordx4 v114, s[12:15], s51 offen offset:3072 lds
v_add_u32 v114, 262144, v114
Mvva 164,216,240
s_waitcnt lgkmcnt(2)
ds_read_b64_tr_b16 v[244:245], v15 offset:36864
ds_read_b64_tr_b16 v[246:247], v15 offset:38912
Mvva 164,220,248
ds_write_b128 v4, v[82:85] offset:2048
ds_write_b128 v4, v[86:89] offset:2112
Mvva 180,208,228
s_waitcnt vmcnt(16)
ds_read_b64_tr_b16 v[248:249], v15 offset:40960
ds_read_b64_tr_b16 v[250:251], v15 offset:43008
Mvva 180,212,236
buffer_load_dwordx4 a[32:35], v112, s[8:11], s52 offen offset:0 sc1
Mvva 180,216,244
s_barrier
ds_read_b64_tr_b16 v[252:253], v15 offset:45056
ds_read_b64_tr_b16 v[254:255], v15 offset:47104
Mvva 180,220,252
buffer_load_dwordx4 a[36:39], v112, s[8:11], s52 offen offset:1024 sc1
s_add_u32 s52, s52, 8192
Mvva 168,224,224
ds_read_b64_tr_b16 v[192:193], v12 offset:49152
ds_read_b64_tr_b16 v[194:195], v12 offset:51200
Mvva 168,228,232
buffer_load_dwordx4 a[40:43], v112, s[8:11], s52 offen offset:0 sc1
Mvva 168,232,240
ds_read_b64_tr_b16 v[196:197], v12 offset:53248
ds_read_b64_tr_b16 v[198:199], v12 offset:55296
Mvva 168,236,248
Mvva 184,224,228
s_waitcnt lgkmcnt(4)
ds_read_b64_tr_b16 v[200:201], v12 offset:57344
ds_read_b64_tr_b16 v[202:203], v12 offset:59392
Mvva 184,228,236
buffer_load_dwordx4 a[44:47], v112, s[8:11], s52 offen offset:1024 sc1
s_add_u32 s52, s52, 8192
Mvva 184,232,244
ds_read_b64_tr_b16 v[204:205], v12 offset:61440
ds_read_b64_tr_b16 v[206:207], v12 offset:63488
Mvva 184,236,252
buffer_load_dwordx4 a[48:51], v112, s[8:11], s52 offen offset:0 sc1
Mvva 172,240,224
ds_read_b64_tr_b16 v[208:209], v13 offset:49152
ds_read_b64_tr_b16 v[210:211], v13 offset:51200
Mvva 172,244,232
buffer_load_dwordx4 a[52:55], v112, s[8:11], s52 offen offset:1024 sc1
s_add_u32 s52, s52, 8192
Mvva 172,248,240
ds_read_b64_tr_b16 v[212:213], v13 offset:53248
ds_read_b64_tr_b16 v[214:215], v13 offset:55296
Mvva 172,252,248
Zvvv 82,98,74
Mvva 188,240,228
s_waitcnt lgkmcnt(4)
ds_read_b64_tr_b16 v[216:217], v13 offset:57344
ds_read_b64_tr_b16 v[218:219], v13 offset:59392
Mvva 188,244,236
buffer_load_dwordx4 a[56:59], v112, s[8:11], s52 offen offset:0 sc1
Mvva 188,248,244
ds_read_b64_tr_b16 v[220:221], v13 offset:61440
ds_read_b64_tr_b16 v[222:223], v13 offset:63488
Mvva 188,252,252
buffer_load_dwordx4 a[60:63], v112, s[8:11], s52 offen offset:1024 sc1
s_add_u32 s52, s52, 8192
Mvva 128,192,224
s_add_u32 m0, s44, 32768
ds_read_b64_tr_b16 v[224:225], v14 offset:49152
ds_read_b64_tr_b16 v[226:227], v14 offset:51200
Mvva 128,196,232
buffer_load_dwordx4 v114, s[12:15], s48 offen offset:0 lds
Mvva 128,200,240
ds_read_b64_tr_b16 v[228:229], v14 offset:53248
ds_read_b64_tr_b16 v[230:231], v14 offset:55296
Mvva 128,204,248
Zvvv 86,102,74
Mvva 144,192,228
s_waitcnt lgkmcnt(4)
ds_read_b64_tr_b16 v[232:233], v14 offset:57344
ds_read_b64_tr_b16 v[234:235], v14 offset:59392
Mvva 144,196,236
buffer_load_dwordx4 v114, s[12:15], s49 offen offset:1024 lds
Mvva 144,200,244
ds_read_b64_tr_b16 v[236:237], v14 offset:61440
ds_read_b64_tr_b16 v[238:239], v14 offset:63488
Mvva 144,204,252
buffer_load_dwordx4 v114, s[12:15], s50 offen offset:2048 lds
Mvva 132,208,224
ds_read_b64_tr_b16 v[240:241], v15 offset:49152
ds_read_b64_tr_b16 v[242:243], v15 offset:51200
Mvva 132,212,232
buffer_load_dwordx4 v114, s[12:15], s51 offen offset:3072 lds
v_add_u32 v114, 262144, v114
Mvva 132,216,240
s_waitcnt lgkmcnt(2)
ds_read_b64_tr_b16 v[244:245], v15 offset:53248
ds_read_b64_tr_b16 v[246:247], v15 offset:55296
Mvva 132,220,248
ds_read_b64_tr_b16 v[98:99], v108 offset:4096
ds_read_b64_tr_b16 v[100:101], v108 offset:6144
ds_read_b64_tr_b16 v[102:103], v109 offset:4096
Mvva 148,208,228
s_waitcnt vmcnt(20)
ds_read_b64_tr_b16 v[248:249], v15 offset:57344
ds_read_b64_tr_b16 v[250:251], v15 offset:59392
Mvva 148,212,236
buffer_load_dwordx4 a[64:67], v112, s[8:11], s52 offen offset:0 sc1
Mvva 148,216,244
s_barrier
ds_read_b64_tr_b16 v[252:253], v15 offset:61440
ds_read_b64_tr_b16 v[254:255], v15 offset:63488
Mvva 148,220,252
buffer_load_dwordx4 a[68:71], v112, s[8:11], s52 offen offset:1024 sc1
s_add_u32 s52, s52, 8192
Mvva 136,224,224
ds_read_b64_tr_b16 v[192:193], v115 offset:0
ds_read_b64_tr_b16 v[194:195], v115 offset:2048
Mvva 136,228,232
buffer_load_dwordx4 a[72:75], v112, s[8:11], s52 offen offset:0 sc1
Mvva 136,232,240
ds_read_b64_tr_b16 v[196:197], v115 offset:4096
ds_read_b64_tr_b16 v[198:199], v115 offset:6144
Mvva 136,236,248
s_waitcnt lgkmcnt(9)
ds_read_b64_tr_b16 v[104:105], v109 offset:6144
Mvva 152,224,228
s_waitcnt lgkmcnt(5)
ds_read_b64_tr_b16 v[200:201], v115 offset:8192
ds_read_b64_tr_b16 v[202:203], v115 offset:10240
Mvva 152,228,236
buffer_load_dwordx4 a[76:79], v112, s[8:11], s52 offen offset:1024 sc1
s_add_u32 s52, s52, 8192
Mvva 152,232,244
ds_read_b64_tr_b16 v[204:205], v115 offset:12288
ds_read_b64_tr_b16 v[206:207], v115 offset:14336
Mvva 152,236,252
buffer_load_dwordx4 a[80:83], v112, s[8:11], s52 offen offset:0 sc1
Mvva 140,240,224
ds_read_b64_tr_b16 v[208:209], v116 offset:0
ds_read_b64_tr_b16 v[210:211], v116 offset:2048
Mvva 140,244,232
buffer_load_dwordx4 a[84:87], v112, s[8:11], s52 offen offset:1024 sc1
s_add_u32 s52, s52, 8192
Mvva 140,248,240
ds_read_b64_tr_b16 v[212:213], v116 offset:4096
ds_read_b64_tr_b16 v[214:215], v116 offset:6144
Mvva 140,252,248
Mvva 156,240,228
s_waitcnt lgkmcnt(4)
ds_read_b64_tr_b16 v[216:217], v116 offset:8192
ds_read_b64_tr_b16 v[218:219], v116 offset:10240
Mvva 156,244,236
buffer_load_dwordx4 a[88:91], v112, s[8:11], s52 offen offset:0 sc1
Mvva 156,248,244
s_waitcnt vmcnt(23)
ds_read_b64_tr_b16 v[220:221], v116 offset:12288
ds_read_b64_tr_b16 v[222:223], v116 offset:14336
Mvva 156,252,252
buffer_load_dwordx4 a[92:95], v112, s[8:11], s52 offen offset:1024 sc1
s_add_u32 s52, s52, 8192
Mvva 160,192,0
s_add_u32 m0, s44, 49152
ds_read_b64_tr_b16 v[224:225], v117 offset:0
ds_read_b64_tr_b16 v[226:227], v117 offset:2048
Mvva 160,196,8
buffer_load_dwordx4 v114, s[12:15], s48 offen offset:0 lds
Mvva 160,200,16
ds_read_b64_tr_b16 v[228:229], v117 offset:4096
ds_read_b64_tr_b16 v[230:231], v117 offset:6144
Mvva 160,204,24
Mvvv 82,98,78
Mvva 176,192,4
s_waitcnt lgkmcnt(4)
ds_read_b64_tr_b16 v[232:233], v117 offset:8192
ds_read_b64_tr_b16 v[234:235], v117 offset:10240
Mvva 176,196,12
buffer_load_dwordx4 v114, s[12:15], s49 offen offset:1024 lds
Mvva 176,200,20
ds_read_b64_tr_b16 v[236:237], v117 offset:12288
ds_read_b64_tr_b16 v[238:239], v117 offset:14336
Mvva 176,204,28
buffer_load_dwordx4 v114, s[12:15], s50 offen offset:2048 lds
Mvva 164,208,0
ds_read_b64_tr_b16 v[240:241], v118 offset:0
ds_read_b64_tr_b16 v[242:243], v118 offset:2048
Mvva 164,212,8
buffer_load_dwordx4 v114, s[12:15], s51 offen offset:3072 lds
v_add_u32 v114, 262144, v114
Mvva 164,216,16
s_waitcnt lgkmcnt(2)
ds_read_b64_tr_b16 v[244:245], v118 offset:4096
ds_read_b64_tr_b16 v[246:247], v118 offset:6144
Mvva 164,220,24
Mvvv 86,102,78
Mvva 180,208,4
s_waitcnt vmcnt(24)
ds_read_b64_tr_b16 v[248:249], v118 offset:8192
ds_read_b64_tr_b16 v[250:251], v118 offset:10240
Mvva 180,212,12
buffer_load_dwordx4 a[96:99], v112, s[8:11], s52 offen offset:0 sc1
Mvva 180,216,20
s_barrier
ds_read_b64_tr_b16 v[252:253], v118 offset:12288
ds_read_b64_tr_b16 v[254:255], v118 offset:14336
Mvva 180,220,28
buffer_load_dwordx4 a[100:103], v112, s[8:11], s52 offen offset:1024 sc1
s_add_u32 s52, s52, 8192
Mvva 168,224,0
ds_read_b64_tr_b16 v[192:193], v115 offset:16384
ds_read_b64_tr_b16 v[194:195], v115 offset:18432
Mvva 168,228,8
buffer_load_dwordx4 a[104:107], v112, s[8:11], s52 offen offset:0 sc1
Mvva 168,232,16
ds_read_b64_tr_b16 v[196:197], v115 offset:20480
ds_read_b64_tr_b16 v[198:199], v115 offset:22528
Mvva 168,236,24
Mvva 184,224,4
s_waitcnt lgkmcnt(4)
ds_read_b64_tr_b16 v[200:201], v115 offset:24576
ds_read_b64_tr_b16 v[202:203], v115 offset:26624
Mvva 184,228,12
buffer_load_dwordx4 a[108:111], v112, s[8:11], s52 offen offset:1024 sc1
s_add_u32 s52, s52, 8192
Mvva 184,232,20
ds_read_b64_tr_b16 v[204:205], v115 offset:28672
ds_read_b64_tr_b16 v[206:207], v115 offset:30720
Mvva 184,236,28
buffer_load_dwordx4 a[112:115], v112, s[8:11], s52 offen offset:0 sc1
Mvva 172,240,0
ds_read_b64_tr_b16 v[208:209], v116 offset:16384
ds_read_b64_tr_b16 v[210:211], v116 offset:18432
Mvva 172,244,8
buffer_load_dwordx4 a[116:119], v112, s[8:11], s52 offen offset:1024 sc1
s_add_u32 s52, s52, 8192
Mvva 172,248,16
ds_read_b64_tr_b16 v[212:213], v116 offset:20480
ds_read_b64_tr_b16 v[214:215], v116 offset:22528
Mvva 172,252,24
ds_write_b128 v4, v[82:85] offset:2176
ds_write_b128 v4, v[86:89] offset:2240
Mvva 188,240,4
s_waitcnt lgkmcnt(6)
ds_read_b64_tr_b16 v[216:217], v116 offset:24576
ds_read_b64_tr_b16 v[218:219], v116 offset:26624
Mvva 188,244,12
buffer_load_dwordx4 a[120:123], v112, s[8:11], s52 offen offset:0 sc1
Mvva 188,248,20
s_waitcnt vmcnt(23)
ds_read_b64_tr_b16 v[220:221], v116 offset:28672
ds_read_b64_tr_b16 v[222:223], v116 offset:30720
Mvva 188,252,28
buffer_load_dwordx4 a[124:127], v112, s[8:11], s52 offen offset:1024 sc1
s_add_u32 s52, s52, 8192
Mvva 160,192,32
s_add_u32 m0, s44, 65536
ds_read_b64_tr_b16 v[224:225], v117 offset:16384
ds_read_b64_tr_b16 v[226:227], v117 offset:18432
Mvva 160,196,40
buffer_load_dwordx4 v114, s[12:15], s48 offen offset:0 lds
Mvva 160,200,48
ds_read_b64_tr_b16 v[228:229], v117 offset:20480
ds_read_b64_tr_b16 v[230:231], v117 offset:22528
Mvva 160,204,56
Mvva 176,192,36
s_waitcnt lgkmcnt(4)
ds_read_b64_tr_b16 v[232:233], v117 offset:24576
ds_read_b64_tr_b16 v[234:235], v117 offset:26624
Mvva 176,196,44
buffer_load_dwordx4 v114, s[12:15], s49 offen offset:1024 lds
Mvva 176,200,52
ds_read_b64_tr_b16 v[236:237], v117 offset:28672
ds_read_b64_tr_b16 v[238:239], v117 offset:30720
Mvva 176,204,60
buffer_load_dwordx4 v114, s[12:15], s50 offen offset:2048 lds
Mvva 164,208,32
ds_read_b64_tr_b16 v[240:241], v118 offset:16384
ds_read_b64_tr_b16 v[242:243], v118 offset:18432
Mvva 164,212,40
buffer_load_dwordx4 v114, s[12:15], s51 offen offset:3072 lds
v_add_u32 v114, 262144, v114
Mvva 164,216,48
s_waitcnt lgkmcnt(2)
ds_read_b64_tr_b16 v[244:245], v118 offset:20480
ds_read_b64_tr_b16 v[246:247], v118 offset:22528
Mvva 164,220,56
Mvva 180,208,36
s_waitcnt vmcnt(24)
ds_read_b64_tr_b16 v[248:249], v118 offset:24576
ds_read_b64_tr_b16 v[250:251], v118 offset:26624
Mvva 180,212,44
buffer_load_dwordx4 a[128:131], v112, s[8:11], s52 offen offset:0 sc1
Mvva 180,216,52
s_barrier
ds_read_b64_tr_b16 v[252:253], v118 offset:28672
ds_read_b64_tr_b16 v[254:255], v118 offset:30720
Mvva 180,220,60
buffer_load_dwordx4 a[132:135], v112, s[8:11], s52 offen offset:1024 sc1
s_add_u32 s52, s52, 8192
Mvva 168,224,32
ds_read_b64_tr_b16 v[192:193], v115 offset:32768
ds_read_b64_tr_b16 v[194:195], v115 offset:34816
Mvva 168,228,40
buffer_load_dwordx4 a[136:139], v112, s[8:11], s52 offen offset:0 sc1
Mvva 168,232,48
ds_read_b64_tr_b16 v[196:197], v115 offset:36864
ds_read_b64_tr_b16 v[198:199], v115 offset:38912
Mvva 168,236,56
ds_read_b64 v[74:75], v6 offset:0
ds_read_b64 v[76:77], v6 offset:8192
ds_read_b64 v[78:79], v6 offset:16384
Mvva 184,224,36
s_waitcnt lgkmcnt(7)
ds_read_b64_tr_b16 v[200:201], v115 offset:40960
ds_read_b64_tr_b16 v[202:203], v115 offset:43008
Mvva 184,228,44
buffer_load_dwordx4 a[140:143], v112, s[8:11], s52 offen offset:1024 sc1
s_add_u32 s52, s52, 8192
Mvva 184,232,52
ds_read_b64_tr_b16 v[204:205], v115 offset:45056
ds_read_b64_tr_b16 v[206:207], v115 offset:47104
Mvva 184,236,60
buffer_load_dwordx4 a[144:147], v112, s[8:11], s52 offen offset:0 sc1
Mvva 172,240,32
ds_read_b64_tr_b16 v[208:209], v116 offset:32768
ds_read_b64_tr_b16 v[210:211], v116 offset:34816
Mvva 172,244,40
buffer_load_dwordx4 a[148:151], v112, s[8:11], s52 offen offset:1024 sc1
s_add_u32 s52, s52, 8192
Mvva 172,248,48
ds_read_b64_tr_b16 v[212:213], v116 offset:36864
ds_read_b64_tr_b16 v[214:215], v116 offset:38912
Mvva 172,252,56
s_waitcnt lgkmcnt(9)
ds_read_b64 v[80:81], v6 offset:24576
Mvva 188,240,36
s_waitcnt lgkmcnt(5)
ds_read_b64_tr_b16 v[216:217], v116 offset:40960
ds_read_b64_tr_b16 v[218:219], v116 offset:43008
Mvva 188,244,44
buffer_load_dwordx4 a[152:155], v112, s[8:11], s52 offen offset:0 sc1
Mvva 188,248,52
s_waitcnt vmcnt(23)
ds_read_b64_tr_b16 v[220:221], v116 offset:45056
ds_read_b64_tr_b16 v[222:223], v116 offset:47104
Mvva 188,252,60
buffer_load_dwordx4 a[156:159], v112, s[8:11], s52 offen offset:1024 sc1
s_add_u32 s52, s52, 8192
Mvva 160,192,64
s_add_u32 m0, s44, 81920
ds_read_b64_tr_b16 v[224:225], v117 offset:32768
ds_read_b64_tr_b16 v[226:227], v117 offset:34816
Mvva 160,196,72
buffer_load_dwordx4 v114, s[12:15], s48 offen offset:0 lds
Mvva 160,200,80
ds_read_b64_tr_b16 v[228:229], v117 offset:36864
ds_read_b64_tr_b16 v[230:231], v117 offset:38912
Mvva 160,204,88
Mvva 176,192,68
s_waitcnt lgkmcnt(4)
ds_read_b64_tr_b16 v[232:233], v117 offset:40960
ds_read_b64_tr_b16 v[234:235], v117 offset:43008
Mvva 176,196,76
buffer_load_dwordx4 v114, s[12:15], s49 offen offset:1024 lds
Mvva 176,200,84
ds_read_b64_tr_b16 v[236:237], v117 offset:45056
ds_read_b64_tr_b16 v[238:239], v117 offset:47104
Mvva 176,204,92
buffer_load_dwordx4 v114, s[12:15], s50 offen offset:2048 lds
Mvva 164,208,64
ds_read_b64_tr_b16 v[240:241], v118 offset:32768
ds_read_b64_tr_b16 v[242:243], v118 offset:34816
Mvva 164,212,72
buffer_load_dwordx4 v114, s[12:15], s51 offen offset:3072 lds
v_add_u32 v114, 262144, v114
Mvva 164,216,80
s_waitcnt lgkmcnt(2)
ds_read_b64_tr_b16 v[244:245], v118 offset:36864
ds_read_b64_tr_b16 v[246:247], v118 offset:38912
Mvva 164,220,88
Va 74,74,76
Va 78,78,80
Va 75,75,77
Mvva 180,208,68
s_waitcnt vmcnt(24)
ds_read_b64_tr_b16 v[248:249], v118 offset:40960
ds_read_b64_tr_b16 v[250:251], v118 offset:43008
Va 79,79,81
Mvva 180,212,76
buffer_load_dwordx4 a[160:163], v112, s[8:11], s52 offen offset:0 sc1
Mvva 180,216,84
s_barrier
ds_read_b64_tr_b16 v[252:253], v118 offset:45056
ds_read_b64_tr_b16 v[254:255], v118 offset:47104
Va 74,74,78
Mvva 180,220,92
buffer_load_dwordx4 a[164:167], v112, s[8:11], s52 offen offset:1024 sc1
s_add_u32 s52, s52, 8192
Mvva 168,224,64
ds_read_b64_tr_b16 v[192:193], v115 offset:49152
ds_read_b64_tr_b16 v[194:195], v115 offset:51200
v_add_f32_e64 v75, v75, v79
Mvva 168,228,72
buffer_load_dwordx4 a[168:171], v112, s[8:11], s52 offen offset:0 sc1
Mvva 168,232,80
ds_read_b64_tr_b16 v[196:197], v115 offset:53248
ds_read_b64_tr_b16 v[198:199], v115 offset:55296
Mvva 168,236,88
buffer_store_dwordx2 v[74:75], v5, s[20:23], s4 offen sc1
Mvva 184,224,68
s_waitcnt lgkmcnt(4)
ds_read_b64_tr_b16 v[200:201], v115 offset:57344
ds_read_b64_tr_b16 v[202:203], v115 offset:59392
Mvva 184,228,76
buffer_load_dwordx4 a[172:175], v112, s[8:11], s52 offen offset:1024 sc1
s_add_u32 s52, s52, 8192
Mvva 184,232,84
ds_read_b64_tr_b16 v[204:205], v115 offset:61440
ds_read_b64_tr_b16 v[206:207], v115 offset:63488
Mvva 184,236,92
buffer_load_dwordx4 a[176:179], v112, s[8:11], s52 offen offset:0 sc1
Mvva 172,240,64
ds_read_b64_tr_b16 v[208:209], v116 offset:49152
ds_read_b64_tr_b16 v[210:211], v116 offset:51200
Mvva 172,244,72
buffer_load_dwordx4 a[180:183], v112, s[8:11], s52 offen offset:1024 sc1
s_add_u32 s52, s52, 8192
Mvva 172,248,80
ds_read_b64_tr_b16 v[212:213], v116 offset:53248
ds_read_b64_tr_b16 v[214:215], v116 offset:55296
Mvva 172,252,88
Mvva 188,240,68
s_waitcnt lgkmcnt(4)
ds_read_b64_tr_b16 v[216:217], v116 offset:57344
ds_read_b64_tr_b16 v[218:219], v116 offset:59392
Mvva 188,244,76
buffer_load_dwordx4 a[184:187], v112, s[8:11], s52 offen offset:0 sc1
Mvva 188,248,84
s_waitcnt vmcnt(24)
ds_read_b64_tr_b16 v[220:221], v116 offset:61440
ds_read_b64_tr_b16 v[222:223], v116 offset:63488
Mvva 188,252,92
buffer_load_dwordx4 a[188:191], v112, s[8:11], s52 offen offset:1024 sc1
s_add_u32 s52, s52, 8192
Mvva 160,192,96
s_add_u32 m0, s44, 98304
ds_read_b64_tr_b16 v[224:225], v117 offset:49152
ds_read_b64_tr_b16 v[226:227], v117 offset:51200
Mvva 160,196,104
buffer_load_dwordx4 v114, s[12:15], s48 offen offset:0 lds
Mvva 160,200,112
ds_read_b64_tr_b16 v[228:229], v117 offset:53248
ds_read_b64_tr_b16 v[230:231], v117 offset:55296
Mvva 160,204,120
Mvva 176,192,100
s_waitcnt lgkmcnt(4)
ds_read_b64_tr_b16 v[232:233], v117 offset:57344
ds_read_b64_tr_b16 v[234:235], v117 offset:59392
Mvva 176,196,108
buffer_load_dwordx4 v114, s[12:15], s49 offen offset:1024 lds
Mvva 176,200,116
ds_read_b64_tr_b16 v[236:237], v117 offset:61440
ds_read_b64_tr_b16 v[238:239], v117 offset:63488
Mvva 176,204,124
buffer_load_dwordx4 v114, s[12:15], s50 offen offset:2048 lds
Mvva 164,208,96
ds_read_b64_tr_b16 v[240:241], v118 offset:49152
ds_read_b64_tr_b16 v[242:243], v118 offset:51200
Mvva 164,212,104
buffer_load_dwordx4 v114, s[12:15], s51 offen offset:3072 lds
v_add_u32 v114, 262144, v114
Mvva 164,216,112
s_waitcnt lgkmcnt(2)
ds_read_b64_tr_b16 v[244:245], v118 offset:53248
ds_read_b64_tr_b16 v[246:247], v118 offset:55296
Mvva 164,220,120
Mvva 180,208,100
s_waitcnt vmcnt(25)
ds_read_b64_tr_b16 v[248:249], v118 offset:57344
ds_read_b64_tr_b16 v[250:251], v118 offset:59392
Mvva 180,212,108
buffer_load_dwordx4 a[192:195], v112, s[8:11], s52 offen offset:0 sc1
Mvva 180,216,116
s_barrier
ds_read_b64_tr_b16 v[252:253], v118 offset:61440
ds_read_b64_tr_b16 v[254:255], v118 offset:63488
Mvva 180,220,124
buffer_load_dwordx4 a[196:199], v112, s[8:11], s52 offen offset:1024 sc1
s_add_u32 s52, s52, 8192
Mvva 168,224,96
ds_read_b64_tr_b16 v[192:193], v12 offset:0
ds_read_b64_tr_b16 v[194:195], v12 offset:2048
Mvva 168,228,104
buffer_load_dwordx4 a[200:203], v112, s[8:11], s52 offen offset:0 sc1
Mvva 168,232,112
ds_read_b64_tr_b16 v[196:197], v12 offset:4096
ds_read_b64_tr_b16 v[198:199], v12 offset:6144
Mvva 168,236,120
Mvva 184,224,100
s_waitcnt lgkmcnt(4)
ds_read_b64_tr_b16 v[200:201], v12 offset:8192
ds_read_b64_tr_b16 v[202:203], v12 offset:10240
Mvva 184,228,108
buffer_load_dwordx4 a[204:207], v112, s[8:11], s52 offen offset:1024 sc1
s_add_u32 s52, s52, 8192
Mvva 184,232,116
ds_read_b64_tr_b16 v[204:205], v12 offset:12288
ds_read_b64_tr_b16 v[206:207], v12 offset:14336
Mvva 184,236,124
buffer_load_dwordx4 a[208:211], v112, s[8:11], s52 offen offset:0 sc1
Mvva 172,240,96
ds_read_b64_tr_b16 v[208:209], v13 offset:0
ds_read_b64_tr_b16 v[210:211], v13 offset:2048
Mvva 172,244,104
buffer_load_dwordx4 a[212:215], v112, s[8:11], s52 offen offset:1024 sc1
s_add_u32 s52, s52, 8192
Mvva 172,248,112
ds_read_b64_tr_b16 v[212:213], v13 offset:4096
ds_read_b64_tr_b16 v[214:215], v13 offset:6144
Mvva 172,252,120
Mvva 188,240,100
s_waitcnt lgkmcnt(4)
ds_read_b64_tr_b16 v[216:217], v13 offset:8192
ds_read_b64_tr_b16 v[218:219], v13 offset:10240
Mvva 188,244,108
buffer_load_dwordx4 a[216:219], v112, s[8:11], s52 offen offset:0 sc1
Mvva 188,248,116
s_waitcnt vmcnt(24)
ds_read_b64_tr_b16 v[220:221], v13 offset:12288
ds_read_b64_tr_b16 v[222:223], v13 offset:14336
Mvva 188,252,124
buffer_load_dwordx4 a[220:223], v112, s[8:11], s52 offen offset:1024 sc1
s_add_u32 s52, s52, 8192
Mvva 160,192,128
s_add_u32 m0, s44, 114688
ds_read_b64_tr_b16 v[224:225], v14 offset:0
ds_read_b64_tr_b16 v[226:227], v14 offset:2048
Mvva 160,196,136
buffer_load_dwordx4 v114, s[12:15], s48 offen offset:0 lds
Mvva 160,200,144
ds_read_b64_tr_b16 v[228:229], v14 offset:4096
ds_read_b64_tr_b16 v[230:231], v14 offset:6144
Mvva 160,204,152
Mvva 176,192,132
s_waitcnt lgkmcnt(4)
ds_read_b64_tr_b16 v[232:233], v14 offset:8192
ds_read_b64_tr_b16 v[234:235], v14 offset:10240
Mvva 176,196,140
buffer_load_dwordx4 v114, s[12:15], s49 offen offset:1024 lds
Mvva 176,200,148
ds_read_b64_tr_b16 v[236:237], v14 offset:12288
ds_read_b64_tr_b16 v[238:239], v14 offset:14336
Mvva 176,204,156
buffer_load_dwordx4 v114, s[12:15], s50 offen offset:2048 lds
Mvva 164,208,128
ds_read_b64_tr_b16 v[240:241], v15 offset:0
ds_read_b64_tr_b16 v[242:243], v15 offset:2048
Mvva 164,212,136
buffer_load_dwordx4 v114, s[12:15], s51 offen offset:3072 lds
s_xor_b32 s95, s95, 128
v_add_u32 v114, s95, v113
Mvva 164,216,144
s_waitcnt lgkmcnt(2)
ds_read_b64_tr_b16 v[244:245], v15 offset:4096
ds_read_b64_tr_b16 v[246:247], v15 offset:6144
Mvva 164,220,152
Mvva 180,208,132
s_waitcnt vmcnt(25)
ds_read_b64_tr_b16 v[248:249], v15 offset:8192
ds_read_b64_tr_b16 v[250:251], v15 offset:10240
Mvva 180,212,140
buffer_load_dwordx4 a[224:227], v112, s[8:11], s52 offen offset:0 sc1
Mvva 180,216,148
s_barrier
ds_read_b64_tr_b16 v[252:253], v15 offset:12288
ds_read_b64_tr_b16 v[254:255], v15 offset:14336
Mvva 180,220,156
buffer_load_dwordx4 a[228:231], v112, s[8:11], s52 offen offset:1024 sc1
s_add_u32 s52, s52, 8192
Mvva 168,224,128
ds_read_b64_tr_b16 v[192:193], v12 offset:16384
ds_read_b64_tr_b16 v[194:195], v12 offset:18432
Mvva 168,228,136
buffer_load_dwordx4 a[232:235], v112, s[8:11], s52 offen offset:0 sc1
Mvva 168,232,144
ds_read_b64_tr_b16 v[196:197], v12 offset:20480
ds_read_b64_tr_b16 v[198:199], v12 offset:22528
Mvva 168,236,152
s_waitcnt vmcnt(24)
s_mov_b64 exec, 1
buffer_store_dword v7, v126, s[20:23], s6 offen sc1
s_mov_b64 exec, -1
Mvva 184,224,132
s_waitcnt lgkmcnt(4)
ds_read_b64_tr_b16 v[200:201], v12 offset:24576
ds_read_b64_tr_b16 v[202:203], v12 offset:26624
Mvva 184,228,140
buffer_load_dwordx4 a[236:239], v112, s[8:11], s52 offen offset:1024 sc1
s_add_u32 s52, s52, 8192
Mvva 184,232,148
ds_read_b64_tr_b16 v[204:205], v12 offset:28672
ds_read_b64_tr_b16 v[206:207], v12 offset:30720
Mvva 184,236,156
buffer_load_dwordx4 a[240:243], v112, s[8:11], s52 offen offset:0 sc1
Mvva 172,240,128
ds_read_b64_tr_b16 v[208:209], v13 offset:16384
ds_read_b64_tr_b16 v[210:211], v13 offset:18432
Mvva 172,244,136
buffer_load_dwordx4 a[244:247], v112, s[8:11], s52 offen offset:1024 sc1
s_add_u32 s52, s52, 8192
Mvva 172,248,144
ds_read_b64_tr_b16 v[212:213], v13 offset:20480
ds_read_b64_tr_b16 v[214:215], v13 offset:22528
Mvva 172,252,152
v_lshlrev_b32 v66, 16, v30
v_and_b32 v67, 0xffff0000, v30
v_lshlrev_b32_e64 v68, 16, v31
Mvva 188,240,132
s_waitcnt lgkmcnt(4)
ds_read_b64_tr_b16 v[216:217], v13 offset:24576
ds_read_b64_tr_b16 v[218:219], v13 offset:26624
v_and_b32 v69, 0xffff0000, v31
Mvva 188,244,140
buffer_load_dwordx4 a[248:251], v112, s[8:11], s52 offen offset:0 sc1
Mvva 188,248,148
s_waitcnt vmcnt(24)
ds_read_b64_tr_b16 v[220:221], v13 offset:28672
ds_read_b64_tr_b16 v[222:223], v13 offset:30720
v_lshlrev_b32_e64 v70, 16, v32
Mvva 188,252,156
buffer_load_dwordx4 a[252:255], v112, s[8:11], s52 offen offset:1024 sc1
s_add_u32 s52, s52, 8192
Mvva 160,192,160
s_add_u32 m0, s44, 0
ds_read_b64_tr_b16 v[224:225], v14 offset:16384
ds_read_b64_tr_b16 v[226:227], v14 offset:18432
Mvva 160,196,168
buffer_load_dwordx4 v114, s[12:15], s48 offen offset:0 lds
Mvva 160,200,176
ds_read_b64_tr_b16 v[228:229], v14 offset:20480
ds_read_b64_tr_b16 v[230:231], v14 offset:22528
Mvva 160,204,184
v_and_b32 v71, 0xffff0000, v32
v_lshlrev_b32 v72, 16, v33
Mvva 176,192,164
s_waitcnt lgkmcnt(4)
ds_read_b64_tr_b16 v[232:233], v14 offset:24576
ds_read_b64_tr_b16 v[234:235], v14 offset:26624
Mvva 176,196,172
buffer_load_dwordx4 v114, s[12:15], s49 offen offset:1024 lds
Mvva 176,200,180
ds_read_b64_tr_b16 v[236:237], v14 offset:28672
ds_read_b64_tr_b16 v[238:239], v14 offset:30720
Mvva 176,204,188
buffer_load_dwordx4 v114, s[12:15], s50 offen offset:2048 lds
Mvva 164,208,160
ds_read_b64_tr_b16 v[240:241], v15 offset:16384
ds_read_b64_tr_b16 v[242:243], v15 offset:18432
Mvva 164,212,168
buffer_load_dwordx4 v114, s[12:15], s51 offen offset:3072 lds
v_add_u32 v114, 262144, v114
Mvva 164,216,176
s_waitcnt lgkmcnt(2)
ds_read_b64_tr_b16 v[244:245], v15 offset:20480
ds_read_b64_tr_b16 v[246:247], v15 offset:22528
Mvva 164,220,184
v_and_b32 v73, 0xffff0000, v33
v_sub_f32_e64 v66, v66, v40
Mvva 180,208,164
s_waitcnt vmcnt(25)
s_add_u32 m0, s44, 16384
ds_read_b64_tr_b16 v[248:249], v15 offset:24576
ds_read_b64_tr_b16 v[250:251], v15 offset:26624
Mvva 180,212,172
buffer_load_dwordx4 v114, s[12:15], s48 offen offset:0 lds
Mvva 180,216,180
s_barrier
ds_read_b64_tr_b16 v[252:253], v15 offset:28672
ds_read_b64_tr_b16 v[254:255], v15 offset:30720
Mvva 180,220,188
buffer_load_dwordx4 v114, s[12:15], s49 offen offset:1024 lds
Mvva 168,224,160
ds_read_b64_tr_b16 v[192:193], v12 offset:32768
ds_read_b64_tr_b16 v[194:195], v12 offset:34816
Mvva 168,228,168
buffer_load_dwordx4 v114, s[12:15], s50 offen offset:2048 lds
Mvva 168,232,176
ds_read_b64_tr_b16 v[196:197], v12 offset:36864
ds_read_b64_tr_b16 v[198:199], v12 offset:38912
Mvva 168,236,184
Vs 67,67,40
Vs 68,68,40
Mvva 184,224,164
s_waitcnt lgkmcnt(4)
ds_read_b64_tr_b16 v[200:201], v12 offset:40960
ds_read_b64_tr_b16 v[202:203], v12 offset:43008
Mvva 184,228,172
buffer_load_dwordx4 v114, s[12:15], s51 offen offset:3072 lds
v_add_u32 v114, 262144, v114
Mvva 184,232,180
s_add_u32 m0, s44, 32768
ds_read_b64_tr_b16 v[204:205], v12 offset:45056
ds_read_b64_tr_b16 v[206:207], v12 offset:47104
Mvva 184,236,188
buffer_load_dwordx4 v114, s[12:15], s48 offen offset:0 lds
Mvva 172,240,160
ds_read_b64_tr_b16 v[208:209], v13 offset:32768
ds_read_b64_tr_b16 v[210:211], v13 offset:34816
Mvva 172,244,168
buffer_load_dwordx4 v114, s[12:15], s49 offen offset:1024 lds
Mvva 172,248,176
ds_read_b64_tr_b16 v[212:213], v13 offset:36864
ds_read_b64_tr_b16 v[214:215], v13 offset:38912
Mvva 172,252,184
Vs 69,69,40
v_sub_f32_e64 v70, v70, v40
Mvva 188,240,164
s_waitcnt lgkmcnt(4)
ds_read_b64_tr_b16 v[216:217], v13 offset:40960
ds_read_b64_tr_b16 v[218:219], v13 offset:43008
Mvva 188,244,172
buffer_load_dwordx4 v114, s[12:15], s50 offen offset:2048 lds
Mvva 188,248,180
s_waitcnt vmcnt(24)
ds_read_b64_tr_b16 v[220:221], v13 offset:45056
ds_read_b64_tr_b16 v[222:223], v13 offset:47104
Mvva 188,252,188
buffer_load_dwordx4 v114, s[12:15], s51 offen offset:3072 lds
v_add_u32 v114, 262144, v114
Mvva 160,192,192
ds_read_b64_tr_b16 v[224:225], v14 offset:32768
ds_read_b64_tr_b16 v[226:227], v14 offset:34816
Mvva 160,196,200
Vs 71,71,40
Vs 72,72,40
Mvva 160,200,208
s_add_u32 m0, s44, 49152
ds_read_b64_tr_b16 v[228:229], v14 offset:36864
ds_read_b64_tr_b16 v[230:231], v14 offset:38912
Mvva 160,204,216
buffer_load_dwordx4 v114, s[12:15], s48 offen offset:0 lds
Mvva 176,192,196
s_waitcnt lgkmcnt(4)
ds_read_b64_tr_b16 v[232:233], v14 offset:40960
ds_read_b64_tr_b16 v[234:235], v14 offset:43008
Mvva 176,196,204
Vs 73,73,40
Vc 2,66,67
Mvva 176,200,212
ds_read_b64_tr_b16 v[236:237], v14 offset:45056
ds_read_b64_tr_b16 v[238:239], v14 offset:47104
Mvva 176,204,220
buffer_load_dwordx4 v114, s[12:15], s49 offen offset:1024 lds
Mvva 164,208,192
ds_read_b64_tr_b16 v[240:241], v15 offset:32768
ds_read_b64_tr_b16 v[242:243], v15 offset:34816
Mvva 164,212,200
v_lshlrev_b32_e64 v66, 16, v2
v_and_b32 v67, 0xffff0000, v2
Mvva 164,216,208
s_waitcnt lgkmcnt(2)
ds_read_b64_tr_b16 v[244:245], v15 offset:36864
ds_read_b64_tr_b16 v[246:247], v15 offset:38912
Mvva 164,220,216
buffer_load_dwordx4 v114, s[12:15], s50 offen offset:2048 lds
Mvva 180,208,196
s_waitcnt vmcnt(24)
ds_read_b64_tr_b16 v[248:249], v15 offset:40960
ds_read_b64_tr_b16 v[250:251], v15 offset:43008
Mvva 180,212,204
Vc 3,68,69
v_lshlrev_b32_e64 v68, 16, v3
Mvva 180,216,212
s_barrier
ds_read_b64_tr_b16 v[252:253], v15 offset:45056
ds_read_b64_tr_b16 v[254:255], v15 offset:47104
Mvva 180,220,220
buffer_load_dwordx4 v114, s[12:15], s51 offen offset:3072 lds
v_add_u32 v114, 262144, v114
Mvva 168,224,192
ds_read_b64_tr_b16 v[192:193], v12 offset:49152
ds_read_b64_tr_b16 v[194:195], v12 offset:51200
Mvva 168,228,200
v_and_b32 v69, 0xffff0000, v3
Vc 4,70,71
Mvva 168,232,208
s_add_u32 m0, s44, 65536
ds_read_b64_tr_b16 v[196:197], v12 offset:53248
ds_read_b64_tr_b16 v[198:199], v12 offset:55296
Mvva 168,236,216
buffer_load_dwordx4 v114, s[12:15], s48 offen offset:0 lds
Mvva 184,224,196
s_waitcnt lgkmcnt(4)
ds_read_b64_tr_b16 v[200:201], v12 offset:57344
ds_read_b64_tr_b16 v[202:203], v12 offset:59392
Mvva 184,228,204
v_lshlrev_b32_e64 v70, 16, v4
v_and_b32 v71, 0xffff0000, v4
Mvva 184,232,212
ds_read_b64_tr_b16 v[204:205], v12 offset:61440
ds_read_b64_tr_b16 v[206:207], v12 offset:63488
Mvva 184,236,220
buffer_load_dwordx4 v114, s[12:15], s49 offen offset:1024 lds
Mvva 172,240,192
ds_read_b64_tr_b16 v[208:209], v13 offset:49152
ds_read_b64_tr_b16 v[210:211], v13 offset:51200
Mvva 172,244,200
Vc 5,72,73
v_lshlrev_b32_e64 v72, 16, v5
Mvva 172,248,208
ds_read_b64_tr_b16 v[212:213], v13 offset:53248
ds_read_b64_tr_b16 v[214:215], v13 offset:55296
Mvva 172,252,216
buffer_load_dwordx4 v114, s[12:15], s50 offen offset:2048 lds
Mvva 188,240,196
s_waitcnt lgkmcnt(4)
ds_read_b64_tr_b16 v[216:217], v13 offset:57344
ds_read_b64_tr_b16 v[218:219], v13 offset:59392
Mvva 188,244,204
v_and_b32 v73, 0xffff0000, v5
Vm 66,66,41
Mvva 188,248,212
s_waitcnt vmcnt(19)
ds_read_b64_tr_b16 v[220:221], v13 offset:61440
ds_read_b64_tr_b16 v[222:223], v13 offset:63488
Mvva 188,252,220
buffer_load_dwordx4 v114, s[12:15], s51 offen offset:3072 lds
v_add_u32 v114, 262144, v114
Mvva 160,192,224
ds_read_b64_tr_b16 v[224:225], v14 offset:49152
ds_read_b64_tr_b16 v[226:227], v14 offset:51200
Mvva 160,196,232
Vm 67,67,41
v_mul_f32_e64 v68, v68, v41
Mvva 160,200,240
ds_read_b64_tr_b16 v[228:229], v14 offset:53248
ds_read_b64_tr_b16 v[230:231], v14 offset:55296
Mvva 160,204,248
Vm 69,69,41
Vm 70,70,41
Mvva 176,192,228
s_waitcnt lgkmcnt(4)
s_add_u32 m0, s44, 81920
ds_read_b64_tr_b16 v[232:233], v14 offset:57344
ds_read_b64_tr_b16 v[234:235], v14 offset:59392
Mvva 176,196,236
buffer_load_dwordx4 v114, s[12:15], s48 offen offset:0 lds
Mvva 176,200,244
ds_read_b64_tr_b16 v[236:237], v14 offset:61440
ds_read_b64_tr_b16 v[238:239], v14 offset:63488
Mvva 176,204,252
Vm 71,71,41
v_mul_f32_e64 v72, v72, v41
Mvva 164,208,224
ds_read_b64_tr_b16 v[240:241], v15 offset:49152
ds_read_b64_tr_b16 v[242:243], v15 offset:51200
Mvva 164,212,232
v_mul_f32_e64 v73, v73, v41
Vc 2,66,67
Mvva 164,216,240
s_waitcnt lgkmcnt(2)
ds_read_b64_tr_b16 v[244:245], v15 offset:53248
ds_read_b64_tr_b16 v[246:247], v15 offset:55296
Mvva 164,220,248
v_lshlrev_b32 v66, 16, v2
v_and_b32 v67, 0xffff0000, v2
Mvva 180,208,228
s_waitcnt vmcnt(17)
ds_read_b64_tr_b16 v[248:249], v15 offset:57344
ds_read_b64_tr_b16 v[250:251], v15 offset:59392
Mvva 180,212,236
buffer_load_dwordx4 v114, s[12:15], s49 offen offset:1024 lds
Mvva 180,216,244
s_barrier
ds_read_b64_tr_b16 v[252:253], v15 offset:61440
ds_read_b64_tr_b16 v[254:255], v15 offset:63488
Mvva 180,220,252
Vc 3,68,69
v_lshlrev_b32_e64 v68, 16, v3
Mvva 168,224,224
ds_read_b64_tr_b16 v[192:193], v115 offset:0
ds_read_b64_tr_b16 v[194:195], v115 offset:2048
Mvva 168,228,232
v_and_b32 v69, 0xffff0000, v3
Vc 4,70,71
Mvva 168,232,240
ds_read_b64_tr_b16 v[196:197], v115 offset:4096
ds_read_b64_tr_b16 v[198:199], v115 offset:6144
Mvva 168,236,248
v_lshlrev_b32_e64 v70, 16, v4
v_and_b32 v71, 0xffff0000, v4
Mvva 184,224,228
s_waitcnt lgkmcnt(4)
ds_read_b64_tr_b16 v[200:201], v115 offset:8192
ds_read_b64_tr_b16 v[202:203], v115 offset:10240
Mvva 184,228,236
buffer_load_dwordx4 v114, s[12:15], s50 offen offset:2048 lds
Mvva 184,232,244
ds_read_b64_tr_b16 v[204:205], v115 offset:12288
ds_read_b64_tr_b16 v[206:207], v115 offset:14336
Mvva 184,236,252
Vc 5,72,73
v_lshlrev_b32 v72, 16, v5
Mvva 172,240,224
ds_read_b64_tr_b16 v[208:209], v116 offset:0
ds_read_b64_tr_b16 v[210:211], v116 offset:2048
Mvva 172,244,232
v_and_b32 v73, 0xffff0000, v5
v_mul_f32 v2, 0xbfb8aa3b, v66
Mvva 172,248,240
ds_read_b64_tr_b16 v[212:213], v116 offset:4096
ds_read_b64_tr_b16 v[214:215], v116 offset:6144
Mvva 172,252,248
v_mul_f32 v3, 0xbfb8aa3b, v67
v_mul_f32 v4, 0xbfb8aa3b, v68
Mvva 188,240,228
s_waitcnt lgkmcnt(4)
ds_read_b64_tr_b16 v[216:217], v116 offset:8192
ds_read_b64_tr_b16 v[218:219], v116 offset:10240
Mvva 188,244,236
buffer_load_dwordx4 v114, s[12:15], s51 offen offset:3072 lds
v_add_u32 v114, 262144, v114
Mvva 188,248,244
ds_read_b64_tr_b16 v[220:221], v116 offset:12288
ds_read_b64_tr_b16 v[222:223], v116 offset:14336
Mvva 188,252,252
v_mul_f32 v5, 0xbfb8aa3b, v69
v_mul_f32 v6, 0xbfb8aa3b, v70
Mvva 128,192,0
ds_read_b64_tr_b16 v[224:225], v117 offset:0
ds_read_b64_tr_b16 v[226:227], v117 offset:2048
Mvva 128,196,8
v_mul_f32 v7, 0xbfb8aa3b, v71
v_mul_f32 v8, 0xbfb8aa3b, v72
Mvva 128,200,16
ds_read_b64_tr_b16 v[228:229], v117 offset:4096
ds_read_b64_tr_b16 v[230:231], v117 offset:6144
Mvva 128,204,24
v_mul_f32 v9, 0xbfb8aa3b, v73
Mvva 144,192,4
s_waitcnt lgkmcnt(4)
s_add_u32 m0, s44, 98304
ds_read_b64_tr_b16 v[232:233], v117 offset:8192
ds_read_b64_tr_b16 v[234:235], v117 offset:10240
Mvva 144,196,12
buffer_load_dwordx4 v114, s[12:15], s48 offen offset:0 lds
Mvva 144,200,20
ds_read_b64_tr_b16 v[236:237], v117 offset:12288
ds_read_b64_tr_b16 v[238:239], v117 offset:14336
Mvva 144,204,28
v_add_u32 v10, 4096, v112
Mvva 132,208,0
ds_read_b64_tr_b16 v[240:241], v118 offset:0
ds_read_b64_tr_b16 v[242:243], v118 offset:2048
Mvva 132,212,8
buffer_store_dwordx4 v[160:163], v112, s[16:19], s26 offen offset:0 sc1
Mvva 132,216,16
s_waitcnt lgkmcnt(2)
ds_read_b64_tr_b16 v[244:245], v118 offset:4096
ds_read_b64_tr_b16 v[246:247], v118 offset:6144
Mvva 132,220,24
buffer_store_dwordx4 v[164:167], v112, s[16:19], s26 offen offset:1024 sc1
Mvva 148,208,4
s_waitcnt vmcnt(19)
ds_read_b64_tr_b16 v[248:249], v118 offset:8192
ds_read_b64_tr_b16 v[250:251], v118 offset:10240
Mvva 148,212,12
buffer_load_dwordx4 v114, s[12:15], s49 offen offset:1024 lds
Mvva 148,216,20
s_barrier
ds_read_b64_tr_b16 v[252:253], v118 offset:12288
ds_read_b64_tr_b16 v[254:255], v118 offset:14336
Mvva 148,220,28
buffer_store_dwordx4 v[168:171], v112, s[16:19], s26 offen offset:2048 sc1
Mvva 136,224,0
ds_read_b64_tr_b16 v[192:193], v115 offset:16384
ds_read_b64_tr_b16 v[194:195], v115 offset:18432
Mvva 136,228,8
buffer_store_dwordx4 v[172:175], v112, s[16:19], s26 offen offset:3072 sc1
Mvva 136,232,16
ds_read_b64_tr_b16 v[196:197], v115 offset:20480
ds_read_b64_tr_b16 v[198:199], v115 offset:22528
Mvva 136,236,24
buffer_store_dwordx4 v[176:179], v10, s[16:19], s26 offen offset:0 sc1
Mvva 152,224,4
s_waitcnt lgkmcnt(4)
ds_read_b64_tr_b16 v[200:201], v115 offset:24576
ds_read_b64_tr_b16 v[202:203], v115 offset:26624
Mvva 152,228,12
buffer_load_dwordx4 v114, s[12:15], s50 offen offset:2048 lds
Mvva 152,232,20
ds_read_b64_tr_b16 v[204:205], v115 offset:28672
ds_read_b64_tr_b16 v[206:207], v115 offset:30720
Mvva 152,236,28
buffer_store_dwordx4 v[180:183], v10, s[16:19], s26 offen offset:1024 sc1
Mvva 140,240,0
ds_read_b64_tr_b16 v[208:209], v116 offset:16384
ds_read_b64_tr_b16 v[210:211], v116 offset:18432
Mvva 140,244,8
buffer_store_dwordx4 v[184:187], v10, s[16:19], s26 offen offset:2048 sc1
Mvva 140,248,16
ds_read_b64_tr_b16 v[212:213], v116 offset:20480
ds_read_b64_tr_b16 v[214:215], v116 offset:22528
Mvva 140,252,24
buffer_store_dwordx4 v[188:191], v10, s[16:19], s26 offen offset:3072 sc1
Mvva 156,240,4
s_waitcnt lgkmcnt(4)
ds_read_b64_tr_b16 v[216:217], v116 offset:24576
ds_read_b64_tr_b16 v[218:219], v116 offset:26624
Mvva 156,244,12
buffer_load_dwordx4 v114, s[12:15], s51 offen offset:3072 lds
v_add_u32 v114, 262144, v114
Mvva 156,248,20
ds_read_b64_tr_b16 v[220:221], v116 offset:28672
ds_read_b64_tr_b16 v[222:223], v116 offset:30720
Mvva 156,252,28
v_mov_b32 v16, 1
Mvva 128,192,32
ds_read_b64_tr_b16 v[224:225], v117 offset:16384
ds_read_b64_tr_b16 v[226:227], v117 offset:18432
Mvva 128,196,40
VE 2,2
Mvva 128,200,48
ds_read_b64_tr_b16 v[228:229], v117 offset:20480
ds_read_b64_tr_b16 v[230:231], v117 offset:22528
Mvva 128,204,56
VE 3,3
Mvva 144,192,36
s_waitcnt lgkmcnt(4)
s_add_u32 m0, s44, 114688
ds_read_b64_tr_b16 v[232:233], v117 offset:24576
ds_read_b64_tr_b16 v[234:235], v117 offset:26624
Mvva 144,196,44
buffer_load_dwordx4 v114, s[12:15], s48 offen offset:0 lds
Mvva 144,200,52
ds_read_b64_tr_b16 v[236:237], v117 offset:28672
ds_read_b64_tr_b16 v[238:239], v117 offset:30720
Mvva 144,204,60
Ve 4,4
Mvva 132,208,32
ds_read_b64_tr_b16 v[240:241], v118 offset:16384
ds_read_b64_tr_b16 v[242:243], v118 offset:18432
Mvva 132,212,40
VE 5,5
Mvva 132,216,48
s_waitcnt lgkmcnt(2)
ds_read_b64_tr_b16 v[244:245], v118 offset:20480
ds_read_b64_tr_b16 v[246:247], v118 offset:22528
Mvva 132,220,56
Ve 6,6
Mvva 148,208,36
s_waitcnt vmcnt(25)
ds_read_b64_tr_b16 v[248:249], v118 offset:24576
ds_read_b64_tr_b16 v[250:251], v118 offset:26624
Mvva 148,212,44
buffer_load_dwordx4 v114, s[12:15], s49 offen offset:1024 lds
Mvva 148,216,52
s_barrier
ds_read_b64_tr_b16 v[252:253], v118 offset:28672
ds_read_b64_tr_b16 v[254:255], v118 offset:30720
Mvva 148,220,60
VE 7,7
Mvva 136,224,32
ds_read_b64_tr_b16 v[192:193], v115 offset:32768
ds_read_b64_tr_b16 v[194:195], v115 offset:34816
Mvva 136,228,40
s_cmp_lg_u32 s53, 0
s_cbranch_scc1 L_yA
L_yAr:
Mvva 136,232,48
ds_read_b64_tr_b16 v[196:197], v115 offset:36864
ds_read_b64_tr_b16 v[198:199], v115 offset:38912
Mvva 136,236,56
VE 8,8
Mvva 152,224,36
s_waitcnt lgkmcnt(4)
ds_read_b64_tr_b16 v[200:201], v115 offset:40960
ds_read_b64_tr_b16 v[202:203], v115 offset:43008
Mvva 152,228,44
buffer_load_dwordx4 v114, s[12:15], s50 offen offset:2048 lds
Mvva 152,232,52
ds_read_b64_tr_b16 v[204:205], v115 offset:45056
ds_read_b64_tr_b16 v[206:207], v115 offset:47104
Mvva 152,236,60
Ve 9,9
Mvva 140,240,32
ds_read_b64_tr_b16 v[208:209], v116 offset:32768
ds_read_b64_tr_b16 v[210:211], v116 offset:34816
Mvva 140,244,40
v_add_f32 v2, 1.0, v2
v_add_f32 v3, 1.0, v3
Mvva 140,248,48
ds_read_b64_tr_b16 v[212:213], v116 offset:36864
ds_read_b64_tr_b16 v[214:215], v116 offset:38912
Mvva 140,252,56
v_add_f32 v4, 1.0, v4
v_add_f32 v5, 1.0, v5
Mvva 156,240,36
s_waitcnt lgkmcnt(4)
ds_read_b64_tr_b16 v[216:217], v116 offset:40960
ds_read_b64_tr_b16 v[218:219], v116 offset:43008
Mvva 156,244,44
buffer_load_dwordx4 v114, s[12:15], s51 offen offset:3072 lds
v_add_u32 v114, 262144, v114
Mvva 156,248,52
ds_read_b64_tr_b16 v[220:221], v116 offset:45056
ds_read_b64_tr_b16 v[222:223], v116 offset:47104
Mvva 156,252,60
v_add_f32 v6, 1.0, v6
v_add_f32_e64 v7, 1.0, v7
Mvva 128,192,64
ds_read_b64_tr_b16 v[224:225], v117 offset:32768
ds_read_b64_tr_b16 v[226:227], v117 offset:34816
Mvva 128,196,72
v_add_f32 v8, 1.0, v8
v_add_f32 v9, 1.0, v9
Mvva 128,200,80
ds_read_b64_tr_b16 v[228:229], v117 offset:36864
ds_read_b64_tr_b16 v[230:231], v117 offset:38912
Mvva 128,204,88
v_rcp_f32_e64 v2, v2
Mvva 144,192,68
s_waitcnt lgkmcnt(4)
ds_read_b64_tr_b16 v[232:233], v117 offset:40960
ds_read_b64_tr_b16 v[234:235], v117 offset:43008
Mvva 144,196,76
v_rcp_f32 v3, v3
Mvva 144,200,84
ds_read_b64_tr_b16 v[236:237], v117 offset:45056
ds_read_b64_tr_b16 v[238:239], v117 offset:47104
Mvva 144,204,92
v_rcp_f32_e64 v4, v4
Mvva 132,208,64
ds_read_b64_tr_b16 v[240:241], v118 offset:32768
ds_read_b64_tr_b16 v[242:243], v118 offset:34816
Mvva 132,212,72
v_rcp_f32_e64 v5, v5
Mvva 132,216,80
s_waitcnt lgkmcnt(2)
ds_read_b64_tr_b16 v[244:245], v118 offset:36864
ds_read_b64_tr_b16 v[246:247], v118 offset:38912
Mvva 132,220,88
v_rcp_f32 v6, v6
Mvva 148,208,68
s_waitcnt vmcnt(24)
ds_read_b64_tr_b16 v[248:249], v118 offset:40960
ds_read_b64_tr_b16 v[250:251], v118 offset:43008
Mvva 148,212,76
v_rcp_f32 v7, v7
Mvva 148,216,84
s_barrier
ds_read_b64_tr_b16 v[252:253], v118 offset:45056
ds_read_b64_tr_b16 v[254:255], v118 offset:47104
Mvva 148,220,92
v_rcp_f32 v8, v8
Mvva 136,224,64
ds_read_b64_tr_b16 v[192:193], v115 offset:49152
ds_read_b64_tr_b16 v[194:195], v115 offset:51200
Mvva 136,228,72
v_rcp_f32_e64 v9, v9
Mvva 136,232,80
ds_read_b64_tr_b16 v[196:197], v115 offset:53248
ds_read_b64_tr_b16 v[198:199], v115 offset:55296
Mvva 136,236,88
Vm 66,66,2
Vm 67,67,3
Mvva 152,224,68
s_waitcnt lgkmcnt(4)
ds_read_b64_tr_b16 v[200:201], v115 offset:57344
ds_read_b64_tr_b16 v[202:203], v115 offset:59392
Mvva 152,228,76
Vm 68,68,4
v_mul_f32_e64 v69, v69, v5
Mvva 152,232,84
ds_read_b64_tr_b16 v[204:205], v115 offset:61440
ds_read_b64_tr_b16 v[206:207], v115 offset:63488
Mvva 152,236,92
Vm 70,70,6
Vm 71,71,7
Mvva 140,240,64
ds_read_b64_tr_b16 v[208:209], v116 offset:49152
ds_read_b64_tr_b16 v[210:211], v116 offset:51200
Mvva 140,244,72
Vm 72,72,8
Vm 73,73,9
Mvva 140,248,80
ds_read_b64_tr_b16 v[212:213], v116 offset:53248
ds_read_b64_tr_b16 v[214:215], v116 offset:55296
Mvva 140,252,88
Vc 2,66,67
v_lshlrev_b32_e64 v66, 16, v2
Mvva 156,240,68
s_waitcnt lgkmcnt(4)
ds_read_b64_tr_b16 v[216:217], v116 offset:57344
ds_read_b64_tr_b16 v[218:219], v116 offset:59392
Mvva 156,244,76
v_and_b32 v67, 0xffff0000, v2
Vc 3,68,69
Mvva 156,248,84
ds_read_b64_tr_b16 v[220:221], v116 offset:61440
ds_read_b64_tr_b16 v[222:223], v116 offset:63488
Mvva 156,252,92
v_lshlrev_b32 v68, 16, v3
v_and_b32 v69, 0xffff0000, v3
Mvva 128,192,96
ds_read_b64_tr_b16 v[224:225], v117 offset:49152
ds_read_b64_tr_b16 v[226:227], v117 offset:51200
Mvva 128,196,104
Vc 4,70,71
v_lshlrev_b32_e64 v70, 16, v4
Mvva 128,200,112
ds_read_b64_tr_b16 v[228:229], v117 offset:53248
ds_read_b64_tr_b16 v[230:231], v117 offset:55296
Mvva 128,204,120
v_and_b32 v71, 0xffff0000, v4
Vc 5,72,73
Mvva 144,192,100
s_waitcnt lgkmcnt(4)
ds_read_b64_tr_b16 v[232:233], v117 offset:57344
ds_read_b64_tr_b16 v[234:235], v117 offset:59392
Mvva 144,196,108
v_lshlrev_b32 v72, 16, v5
v_and_b32 v73, 0xffff0000, v5
Mvva 144,200,116
ds_read_b64_tr_b16 v[236:237], v117 offset:61440
ds_read_b64_tr_b16 v[238:239], v117 offset:63488
Mvva 144,204,124
s_waitcnt vmcnt(5)
s_mov_b64 exec, 1
buffer_store_dword v16, v126, s[20:23], s27 offen sc1
s_mov_b64 exec, -1
Mvva 132,208,96
ds_read_b64_tr_b16 v[240:241], v118 offset:49152
ds_read_b64_tr_b16 v[242:243], v118 offset:51200
Mvva 132,212,104
Mvva 132,216,112
s_waitcnt lgkmcnt(2)
ds_read_b64_tr_b16 v[244:245], v118 offset:53248
ds_read_b64_tr_b16 v[246:247], v118 offset:55296
Mvva 132,220,120
Mvva 148,208,100
ds_read_b64_tr_b16 v[248:249], v118 offset:57344
ds_read_b64_tr_b16 v[250:251], v118 offset:59392
Mvva 148,212,108
Mvva 148,216,116
s_barrier
ds_read_b64_tr_b16 v[252:253], v118 offset:61440
ds_read_b64_tr_b16 v[254:255], v118 offset:63488
Mvva 148,220,124
Mvva 136,224,96
ds_read_b64_tr_b16 v[192:193], v12 offset:0
ds_read_b64_tr_b16 v[194:195], v12 offset:2048
Mvva 136,228,104
Mvva 136,232,112
ds_read_b64_tr_b16 v[196:197], v12 offset:4096
ds_read_b64_tr_b16 v[198:199], v12 offset:6144
Mvva 136,236,120
Mvva 152,224,100
s_waitcnt lgkmcnt(4)
ds_read_b64_tr_b16 v[200:201], v12 offset:8192
ds_read_b64_tr_b16 v[202:203], v12 offset:10240
Mvva 152,228,108
Mvva 152,232,116
ds_read_b64_tr_b16 v[204:205], v12 offset:12288
ds_read_b64_tr_b16 v[206:207], v12 offset:14336
Mvva 152,236,124
s_cmp_lg_u32 s53, 0
s_cbranch_scc1 L_yB
L_yBr:
Mvva 140,240,96
ds_read_b64_tr_b16 v[208:209], v13 offset:0
ds_read_b64_tr_b16 v[210:211], v13 offset:2048
Mvva 140,244,104
Mvva 140,248,112
ds_read_b64_tr_b16 v[212:213], v13 offset:4096
ds_read_b64_tr_b16 v[214:215], v13 offset:6144
Mvva 140,252,120
Mvva 156,240,100
s_waitcnt lgkmcnt(4)
ds_read_b64_tr_b16 v[216:217], v13 offset:8192
ds_read_b64_tr_b16 v[218:219], v13 offset:10240
Mvva 156,244,108
Mvva 156,248,116
ds_read_b64_tr_b16 v[220:221], v13 offset:12288
ds_read_b64_tr_b16 v[222:223], v13 offset:14336
Mvva 156,252,124
Mvva 128,192,128
ds_read_b64_tr_b16 v[224:225], v14 offset:0
ds_read_b64_tr_b16 v[226:227], v14 offset:2048
Mvva 128,196,136
Mvva 128,200,144
ds_read_b64_tr_b16 v[228:229], v14 offset:4096
ds_read_b64_tr_b16 v[230:231], v14 offset:6144
Mvva 128,204,152
Mvva 144,192,132
s_waitcnt lgkmcnt(4)
ds_read_b64_tr_b16 v[232:233], v14 offset:8192
ds_read_b64_tr_b16 v[234:235], v14 offset:10240
Mvva 144,196,140
Mvva 144,200,148
ds_read_b64_tr_b16 v[236:237], v14 offset:12288
ds_read_b64_tr_b16 v[238:239], v14 offset:14336
Mvva 144,204,156
Mvva 132,208,128
ds_read_b64_tr_b16 v[240:241], v15 offset:0
ds_read_b64_tr_b16 v[242:243], v15 offset:2048
Mvva 132,212,136
Mvva 132,216,144
s_waitcnt lgkmcnt(2)
ds_read_b64_tr_b16 v[244:245], v15 offset:4096
ds_read_b64_tr_b16 v[246:247], v15 offset:6144
Mvva 132,220,152
Mvva 148,208,132
ds_read_b64_tr_b16 v[248:249], v15 offset:8192
ds_read_b64_tr_b16 v[250:251], v15 offset:10240
Mvva 148,212,140
Mvva 148,216,148
s_barrier
ds_read_b64_tr_b16 v[252:253], v15 offset:12288
ds_read_b64_tr_b16 v[254:255], v15 offset:14336
Mvva 148,220,156
Mvva 136,224,128
ds_read_b64_tr_b16 v[192:193], v12 offset:16384
ds_read_b64_tr_b16 v[194:195], v12 offset:18432
Mvva 136,228,136
Mvva 136,232,144
ds_read_b64_tr_b16 v[196:197], v12 offset:20480
ds_read_b64_tr_b16 v[198:199], v12 offset:22528
Mvva 136,236,152
Mvva 152,224,132
s_waitcnt lgkmcnt(4)
ds_read_b64_tr_b16 v[200:201], v12 offset:24576
ds_read_b64_tr_b16 v[202:203], v12 offset:26624
Mvva 152,228,140
buffer_load_dword v17, v126, s[20:23], s24 offen sc1
Mvva 152,232,148
ds_read_b64_tr_b16 v[204:205], v12 offset:28672
ds_read_b64_tr_b16 v[206:207], v12 offset:30720
Mvva 152,236,156
Mvva 140,240,128
ds_read_b64_tr_b16 v[208:209], v13 offset:16384
ds_read_b64_tr_b16 v[210:211], v13 offset:18432
Mvva 140,244,136
Mvva 140,248,144
ds_read_b64_tr_b16 v[212:213], v13 offset:20480
ds_read_b64_tr_b16 v[214:215], v13 offset:22528
Mvva 140,252,152
Mvva 156,240,132
s_waitcnt lgkmcnt(4)
ds_read_b64_tr_b16 v[216:217], v13 offset:24576
ds_read_b64_tr_b16 v[218:219], v13 offset:26624
Mvva 156,244,140
Mvva 156,248,148
ds_read_b64_tr_b16 v[220:221], v13 offset:28672
ds_read_b64_tr_b16 v[222:223], v13 offset:30720
Mvva 156,252,156
Mvva 128,192,160
ds_read_b64_tr_b16 v[224:225], v14 offset:16384
ds_read_b64_tr_b16 v[226:227], v14 offset:18432
Mvva 128,196,168
Mvva 128,200,176
ds_read_b64_tr_b16 v[228:229], v14 offset:20480
ds_read_b64_tr_b16 v[230:231], v14 offset:22528
Mvva 128,204,184
Mvva 144,192,164
s_waitcnt lgkmcnt(4)
ds_read_b64_tr_b16 v[232:233], v14 offset:24576
ds_read_b64_tr_b16 v[234:235], v14 offset:26624
Mvva 144,196,172
Mvva 144,200,180
ds_read_b64_tr_b16 v[236:237], v14 offset:28672
ds_read_b64_tr_b16 v[238:239], v14 offset:30720
Mvva 144,204,188
Mvva 132,208,160
ds_read_b64_tr_b16 v[240:241], v15 offset:16384
ds_read_b64_tr_b16 v[242:243], v15 offset:18432
Mvva 132,212,168
Mvva 132,216,176
s_waitcnt lgkmcnt(2)
ds_read_b64_tr_b16 v[244:245], v15 offset:20480
ds_read_b64_tr_b16 v[246:247], v15 offset:22528
Mvva 132,220,184
Mvva 148,208,164
s_waitcnt vmcnt(6)
ds_read_b64_tr_b16 v[248:249], v15 offset:24576
ds_read_b64_tr_b16 v[250:251], v15 offset:26624
Mvva 148,212,172
Mvva 148,216,180
s_barrier
ds_read_b64_tr_b16 v[252:253], v15 offset:28672
ds_read_b64_tr_b16 v[254:255], v15 offset:30720
Mvva 148,220,188
Mvva 136,224,160
ds_read_b64_tr_b16 v[192:193], v12 offset:32768
ds_read_b64_tr_b16 v[194:195], v12 offset:34816
Mvva 136,228,168
s_cmp_lg_u32 s40, 0
s_cbranch_scc1 L_yC
L_yCr:
Mvva 136,232,176
ds_read_b64_tr_b16 v[196:197], v12 offset:36864
ds_read_b64_tr_b16 v[198:199], v12 offset:38912
Mvva 136,236,184
Mvva 152,224,164
s_waitcnt lgkmcnt(4)
ds_read_b64_tr_b16 v[200:201], v12 offset:40960
ds_read_b64_tr_b16 v[202:203], v12 offset:43008
Mvva 152,228,172
Mvva 152,232,180
ds_read_b64_tr_b16 v[204:205], v12 offset:45056
ds_read_b64_tr_b16 v[206:207], v12 offset:47104
Mvva 152,236,188
Mvva 140,240,160
ds_read_b64_tr_b16 v[208:209], v13 offset:32768
ds_read_b64_tr_b16 v[210:211], v13 offset:34816
Mvva 140,244,168
Mvva 140,248,176
ds_read_b64_tr_b16 v[212:213], v13 offset:36864
ds_read_b64_tr_b16 v[214:215], v13 offset:38912
Mvva 140,252,184
s_waitcnt vmcnt(0)
v_cmp_ne_u32 vcc, 1, v17
s_mov_b32 s33, 0
s_cbranch_vccnz L_xno
s_nop 0
buffer_load_dwordx4 v[160:163], v112, s[16:19], s25 offen offset:0 sc1
buffer_load_dwordx4 v[164:167], v112, s[16:19], s25 offen offset:1024 sc1
buffer_load_dwordx4 v[168:171], v112, s[16:19], s25 offen offset:2048 sc1
buffer_load_dwordx4 v[172:175], v112, s[16:19], s25 offen offset:3072 sc1
buffer_load_dwordx4 v[176:179], v10, s[16:19], s25 offen offset:0 sc1
buffer_load_dwordx4 v[180:183], v10, s[16:19], s25 offen offset:1024 sc1
buffer_load_dwordx4 v[184:187], v10, s[16:19], s25 offen offset:2048 sc1
buffer_load_dwordx4 v[188:191], v10, s[16:19], s25 offen offset:3072 sc1
s_mov_b32 s33, 1
L_xno:
Mvva 156,240,164
s_waitcnt lgkmcnt(4)
ds_read_b64_tr_b16 v[216:217], v13 offset:40960
ds_read_b64_tr_b16 v[218:219], v13 offset:43008
Mvva 156,244,172
Mvva 156,248,180
ds_read_b64_tr_b16 v[220:221], v13 offset:45056
ds_read_b64_tr_b16 v[222:223], v13 offset:47104
Mvva 156,252,188
Mvva 128,192,192
ds_read_b64_tr_b16 v[224:225], v14 offset:32768
ds_read_b64_tr_b16 v[226:227], v14 offset:34816
Mvva 128,196,200
Mvva 128,200,208
ds_read_b64_tr_b16 v[228:229], v14 offset:36864
ds_read_b64_tr_b16 v[230:231], v14 offset:38912
Mvva 128,204,216
Mvva 144,192,196
s_waitcnt lgkmcnt(4)
ds_read_b64_tr_b16 v[232:233], v14 offset:40960
ds_read_b64_tr_b16 v[234:235], v14 offset:43008
Mvva 144,196,204
Mvva 144,200,212
ds_read_b64_tr_b16 v[236:237], v14 offset:45056
ds_read_b64_tr_b16 v[238:239], v14 offset:47104
Mvva 144,204,220
Mvva 132,208,192
ds_read_b64_tr_b16 v[240:241], v15 offset:32768
ds_read_b64_tr_b16 v[242:243], v15 offset:34816
Mvva 132,212,200
Mvva 132,216,208
s_waitcnt lgkmcnt(2)
ds_read_b64_tr_b16 v[244:245], v15 offset:36864
ds_read_b64_tr_b16 v[246:247], v15 offset:38912
Mvva 132,220,216
Mvva 148,208,196
ds_read_b64_tr_b16 v[248:249], v15 offset:40960
ds_read_b64_tr_b16 v[250:251], v15 offset:43008
Mvva 148,212,204
Mvva 148,216,212
s_barrier
ds_read_b64_tr_b16 v[252:253], v15 offset:45056
ds_read_b64_tr_b16 v[254:255], v15 offset:47104
Mvva 148,220,220
Mvva 136,224,192
ds_read_b64_tr_b16 v[192:193], v12 offset:49152
ds_read_b64_tr_b16 v[194:195], v12 offset:51200
Mvva 136,228,200
Mvva 136,232,208
ds_read_b64_tr_b16 v[196:197], v12 offset:53248
ds_read_b64_tr_b16 v[198:199], v12 offset:55296
Mvva 136,236,216
Mvva 152,224,196
s_waitcnt lgkmcnt(4)
ds_read_b64_tr_b16 v[200:201], v12 offset:57344
ds_read_b64_tr_b16 v[202:203], v12 offset:59392
Mvva 152,228,204
Mvva 152,232,212
ds_read_b64_tr_b16 v[204:205], v12 offset:61440
ds_read_b64_tr_b16 v[206:207], v12 offset:63488
Mvva 152,236,220
Mvva 140,240,192
ds_read_b64_tr_b16 v[208:209], v13 offset:49152
ds_read_b64_tr_b16 v[210:211], v13 offset:51200
Mvva 140,244,200
Mvva 140,248,208
ds_read_b64_tr_b16 v[212:213], v13 offset:53248
ds_read_b64_tr_b16 v[214:215], v13 offset:55296
Mvva 140,252,216
Mvva 156,240,196
s_waitcnt lgkmcnt(4)
ds_read_b64_tr_b16 v[216:217], v13 offset:57344
ds_read_b64_tr_b16 v[218:219], v13 offset:59392
Mvva 156,244,204
Mvva 156,248,212
ds_read_b64_tr_b16 v[220:221], v13 offset:61440
ds_read_b64_tr_b16 v[222:223], v13 offset:63488
Mvva 156,252,220
Mvva 128,192,224
ds_read_b64_tr_b16 v[224:225], v14 offset:49152
ds_read_b64_tr_b16 v[226:227], v14 offset:51200
Mvva 128,196,232
Mvva 128,200,240
ds_read_b64_tr_b16 v[228:229], v14 offset:53248
ds_read_b64_tr_b16 v[230:231], v14 offset:55296
Mvva 128,204,248
Mvva 144,192,228
s_waitcnt lgkmcnt(4)
ds_read_b64_tr_b16 v[232:233], v14 offset:57344
ds_read_b64_tr_b16 v[234:235], v14 offset:59392
Mvva 144,196,236
Mvva 144,200,244
ds_read_b64_tr_b16 v[236:237], v14 offset:61440
ds_read_b64_tr_b16 v[238:239], v14 offset:63488
Mvva 144,204,252
Mvva 132,208,224
ds_read_b64_tr_b16 v[240:241], v15 offset:49152
ds_read_b64_tr_b16 v[242:243], v15 offset:51200
Mvva 132,212,232
Mvva 132,216,240
s_waitcnt lgkmcnt(2)
ds_read_b64_tr_b16 v[244:245], v15 offset:53248
ds_read_b64_tr_b16 v[246:247], v15 offset:55296
Mvva 132,220,248
Mvva 148,208,228
ds_read_b64_tr_b16 v[248:249], v15 offset:57344
ds_read_b64_tr_b16 v[250:251], v15 offset:59392
Mvva 148,212,236
Mvva 148,216,244
ds_read_b64_tr_b16 v[252:253], v15 offset:61440
ds_read_b64_tr_b16 v[254:255], v15 offset:63488
Mvva 148,220,252
Mvva 136,224,224
Mvva 136,228,232
Mvva 136,232,240
Mvva 136,236,248
Mvva 152,224,228
s_waitcnt lgkmcnt(0)
Mvva 152,228,236
Mvva 152,232,244
Mvva 152,236,252
Mvva 140,240,224
Mvva 140,244,232
Mvva 140,248,240
Mvva 140,252,248
Mvva 156,240,228
Mvva 156,244,236
Mvva 156,248,244
Mvva 156,252,252
s_cmp_lg_u32 s53, s40
s_cbranch_scc1 L_ysl
L_yslr:
v_and_b32 v124, 15, v0
v_lshlrev_b32 v74, 8, v124
v_add_u32 v74, s35, v74
v_xor_b32 v124, v124, v121
v_lshl_add_u32 v74, v124, 4, v74
v_xor_b32_e64 v75, 64, v74
v_xor_b32 v76, 128, v74
v_xor_b32 v77, 192, v74
v_lshlrev_b32 v125, 1, v122
v_xor_b32 v124, v123, v125
v_lshlrev_b32 v12, 8, v123
v_add_u32 v12, s35, v12
v_lshl_add_u32 v12, v124, 4, v12
v_xor_b32_e64 v13, 16, v12
v_xor_b32 v14, 128, v12
v_xor_b32 v15, 144, v12
s_cmp_eq_u32 s33, 0
s_cbranch_scc1 L_spinX
L_spinXr:
v_lshlrev_b32_e64 v80, 16, v18
v_and_b32 v81, 0xffff0000, v18
v_lshlrev_b32_e64 v82, 16, v19
v_and_b32 v83, 0xffff0000, v19
v_lshlrev_b32_e64 v84, 16, v20
v_and_b32 v85, 0xffff0000, v20
v_lshlrev_b32_e64 v86, 16, v21
v_and_b32 v87, 0xffff0000, v21
v_lshlrev_b32_e64 v88, 16, v22
v_and_b32 v89, 0xffff0000, v22
v_lshlrev_b32_e64 v90, 16, v23
v_and_b32 v91, 0xffff0000, v23
v_lshlrev_b32_e64 v92, 16, v24
v_and_b32 v93, 0xffff0000, v24
v_lshlrev_b32_e64 v94, 16, v25
v_and_b32 v95, 0xffff0000, v25
v_lshlrev_b32_e64 v96, 16, v26
v_and_b32 v97, 0xffff0000, v26
v_lshlrev_b32_e64 v98, 16, v27
v_and_b32 v99, 0xffff0000, v27
v_lshlrev_b32_e64 v100, 16, v28
v_and_b32 v101, 0xffff0000, v28
v_lshlrev_b32_e64 v102, 16, v29
v_and_b32 v103, 0xffff0000, v29
v_lshlrev_b32_e64 v104, 16, v30
v_and_b32 v105, 0xffff0000, v30
v_lshlrev_b32_e64 v106, 16, v31
v_and_b32 v107, 0xffff0000, v31
v_lshlrev_b32_e64 v108, 16, v32
v_and_b32 v109, 0xffff0000, v32
v_lshlrev_b32_e64 v110, 16, v33
v_and_b32 v111, 0xffff0000, v33
s_waitcnt vmcnt(0)
s_nop 0
v_pk_add_f32 v[128:129], v[128:129], v[160:161]
v_pk_add_f32 v[130:131], v[130:131], v[162:163]
ds_write_b128 v74, v[128:131] offset:0
v_pk_add_f32 v[132:133], v[132:133], v[164:165]
v_pk_add_f32 v[134:135], v[134:135], v[166:167]
ds_write_b128 v75, v[132:135] offset:0
v_pk_add_f32 v[136:137], v[136:137], v[168:169]
v_pk_add_f32 v[138:139], v[138:139], v[170:171]
ds_write_b128 v76, v[136:139] offset:0
v_pk_add_f32 v[140:141], v[140:141], v[172:173]
v_pk_add_f32 v[142:143], v[142:143], v[174:175]
ds_write_b128 v77, v[140:143] offset:0
v_pk_add_f32 v[144:145], v[144:145], v[176:177]
v_pk_add_f32 v[146:147], v[146:147], v[178:179]
ds_write_b128 v74, v[144:147] offset:4096
v_pk_add_f32 v[148:149], v[148:149], v[180:181]
v_pk_add_f32 v[150:151], v[150:151], v[182:183]
ds_write_b128 v75, v[148:151] offset:4096
v_pk_add_f32 v[152:153], v[152:153], v[184:185]
v_pk_add_f32 v[154:155], v[154:155], v[186:187]
ds_write_b128 v76, v[152:155] offset:4096
v_pk_add_f32 v[156:157], v[156:157], v[188:189]
v_pk_add_f32 v[158:159], v[158:159], v[190:191]
ds_write_b128 v77, v[156:159] offset:4096
Rv 192,12,0
Rv 196,13,0
Rv 200,14,2048
Rv 204,15,2048
Rv 208,12,4096
Rv 212,13,4096
Rv 216,14,6144
s_waitcnt lgkmcnt(9)
Rv 220,15,6144
s_waitcnt lgkmcnt(6)
Vc 224,192,193
v_lshlrev_b32_e64 v192, 16, v224
v_and_b32 v193, 0xffff0000, v224
Vc 225,194,195
v_lshlrev_b32_e64 v194, 16, v225
v_and_b32 v195, 0xffff0000, v225
Vc 226,196,197
v_lshlrev_b32_e64 v196, 16, v226
v_and_b32 v197, 0xffff0000, v226
Vc 227,198,199
v_lshlrev_b32_e64 v198, 16, v227
v_and_b32 v199, 0xffff0000, v227
v_pk_mul_f32 v[192:193], v[192:193], v[42:43]
v_pk_mul_f32 v[194:195], v[194:195], v[44:45]
v_pk_mul_f32 v[196:197], v[196:197], v[46:47]
v_pk_mul_f32 v[198:199], v[198:199], v[48:49]
Vc 224,192,193
v_lshlrev_b32_e64 v192, 16, v224
v_and_b32 v193, 0xffff0000, v224
Vc 225,194,195
v_lshlrev_b32_e64 v194, 16, v225
v_and_b32 v195, 0xffff0000, v225
Vc 226,196,197
v_lshlrev_b32_e64 v196, 16, v226
v_and_b32 v197, 0xffff0000, v226
Vc 227,198,199
v_lshlrev_b32_e64 v198, 16, v227
v_and_b32 v199, 0xffff0000, v227
v_pk_add_f32 v[192:193], v[192:193], v[80:81]
v_pk_add_f32 v[194:195], v[194:195], v[82:83]
v_pk_add_f32 v[196:197], v[196:197], v[84:85]
v_pk_add_f32 v[198:199], v[198:199], v[86:87]
Vc 224,192,193
Vc 225,194,195
Vc 226,196,197
Vc 227,198,199
buffer_store_dwordx4 v[224:227], v119, s[68:71], s36 offen sc1
s_add_u32 s36, s36, 16384
s_waitcnt lgkmcnt(4)
Vc 228,200,201
v_lshlrev_b32 v200, 16, v228
v_and_b32 v201, 0xffff0000, v228
Vc 229,202,203
v_lshlrev_b32_e64 v202, 16, v229
v_and_b32 v203, 0xffff0000, v229
Vc 230,204,205
v_lshlrev_b32_e64 v204, 16, v230
v_and_b32 v205, 0xffff0000, v230
Vc 231,206,207
v_lshlrev_b32_e64 v206, 16, v231
v_and_b32 v207, 0xffff0000, v231
v_pk_mul_f32 v[200:201], v[200:201], v[50:51]
v_pk_mul_f32 v[202:203], v[202:203], v[52:53]
v_pk_mul_f32 v[204:205], v[204:205], v[54:55]
v_pk_mul_f32 v[206:207], v[206:207], v[56:57]
Vc 228,200,201
v_lshlrev_b32_e64 v200, 16, v228
v_and_b32 v201, 0xffff0000, v228
Vc 229,202,203
v_lshlrev_b32_e64 v202, 16, v229
v_and_b32 v203, 0xffff0000, v229
Vc 230,204,205
v_lshlrev_b32_e64 v204, 16, v230
v_and_b32 v205, 0xffff0000, v230
Vc 231,206,207
v_lshlrev_b32_e64 v206, 16, v231
v_and_b32 v207, 0xffff0000, v231
v_pk_add_f32 v[200:201], v[200:201], v[88:89]
v_pk_add_f32 v[202:203], v[202:203], v[90:91]
v_pk_add_f32 v[204:205], v[204:205], v[92:93]
v_pk_add_f32 v[206:207], v[206:207], v[94:95]
Vc 228,200,201
Vc 229,202,203
Vc 230,204,205
Vc 231,206,207
buffer_store_dwordx4 v[228:231], v119, s[68:71], s36 offen sc1
s_add_u32 s36, s36, 16384
s_waitcnt lgkmcnt(2)
Vc 232,208,209
v_lshlrev_b32 v208, 16, v232
v_and_b32 v209, 0xffff0000, v232
Vc 233,210,211
v_lshlrev_b32_e64 v210, 16, v233
v_and_b32 v211, 0xffff0000, v233
Vc 234,212,213
v_lshlrev_b32_e64 v212, 16, v234
v_and_b32 v213, 0xffff0000, v234
Vc 235,214,215
v_lshlrev_b32_e64 v214, 16, v235
v_and_b32 v215, 0xffff0000, v235
v_pk_mul_f32 v[208:209], v[208:209], v[58:59]
v_pk_mul_f32 v[210:211], v[210:211], v[60:61]
v_pk_mul_f32 v[212:213], v[212:213], v[62:63]
v_pk_mul_f32 v[214:215], v[214:215], v[64:65]
Vc 232,208,209
v_lshlrev_b32_e64 v208, 16, v232
v_and_b32 v209, 0xffff0000, v232
Vc 233,210,211
v_lshlrev_b32_e64 v210, 16, v233
v_and_b32 v211, 0xffff0000, v233
Vc 234,212,213
v_lshlrev_b32_e64 v212, 16, v234
v_and_b32 v213, 0xffff0000, v234
Vc 235,214,215
v_lshlrev_b32_e64 v214, 16, v235
v_and_b32 v215, 0xffff0000, v235
v_pk_add_f32 v[208:209], v[208:209], v[96:97]
v_pk_add_f32 v[210:211], v[210:211], v[98:99]
v_pk_add_f32 v[212:213], v[212:213], v[100:101]
v_pk_add_f32 v[214:215], v[214:215], v[102:103]
Vc 232,208,209
Vc 233,210,211
Vc 234,212,213
Vc 235,214,215
buffer_store_dwordx4 v[232:235], v119, s[68:71], s36 offen sc1
s_add_u32 s36, s36, 16384
s_waitcnt lgkmcnt(0)
Vc 236,216,217
v_lshlrev_b32 v216, 16, v236
v_and_b32 v217, 0xffff0000, v236
Vc 237,218,219
v_lshlrev_b32_e64 v218, 16, v237
v_and_b32 v219, 0xffff0000, v237
Vc 238,220,221
v_lshlrev_b32_e64 v220, 16, v238
v_and_b32 v221, 0xffff0000, v238
Vc 239,222,223
v_lshlrev_b32_e64 v222, 16, v239
v_and_b32 v223, 0xffff0000, v239
v_pk_mul_f32 v[216:217], v[216:217], v[66:67]
v_pk_mul_f32 v[218:219], v[218:219], v[68:69]
v_pk_mul_f32 v[220:221], v[220:221], v[70:71]
v_pk_mul_f32 v[222:223], v[222:223], v[72:73]
Vc 236,216,217
v_lshlrev_b32_e64 v216, 16, v236
v_and_b32 v217, 0xffff0000, v236
Vc 237,218,219
v_lshlrev_b32_e64 v218, 16, v237
v_and_b32 v219, 0xffff0000, v237
Vc 238,220,221
v_lshlrev_b32_e64 v220, 16, v238
v_and_b32 v221, 0xffff0000, v238
Vc 239,222,223
v_lshlrev_b32_e64 v222, 16, v239
v_and_b32 v223, 0xffff0000, v239
v_pk_add_f32 v[216:217], v[216:217], v[104:105]
v_pk_add_f32 v[218:219], v[218:219], v[106:107]
v_pk_add_f32 v[220:221], v[220:221], v[108:109]
v_pk_add_f32 v[222:223], v[222:223], v[110:111]
Vc 236,216,217
Vc 237,218,219
Vc 238,220,221
Vc 239,222,223
buffer_store_dwordx4 v[236:239], v119, s[68:71], s36 offen sc1
L_k2_end:
s_endpgm
L_spinC:
s_add_u32 m0, s35, 0
s_nop 0
s_nop 0
buffer_load_dwordx4 v125, s[60:63], s48 offen offset:0 lds
buffer_load_dwordx4 v125, s[60:63], s49 offen offset:1024 lds
buffer_load_dwordx4 v125, s[60:63], s50 offen offset:2048 lds
buffer_load_dwordx4 v125, s[60:63], s51 offen offset:3072 lds
v_add_u32 v125, 65536, v125
s_add_u32 m0, s35, 4096
s_nop 0
buffer_load_dwordx4 v125, s[60:63], s48 offen offset:0 lds
buffer_load_dwordx4 v125, s[60:63], s49 offen offset:1024 lds
buffer_load_dwordx4 v125, s[60:63], s50 offen offset:2048 lds
buffer_load_dwordx4 v125, s[60:63], s51 offen offset:3072 lds
s_mov_b32 s40, 1
s_mov_b32 s47, 0x400000
L_spinC_l:
buffer_load_dword v124, v10, s[20:23], s38 offen sc1
s_sub_u32 s47, s47, 1
s_waitcnt vmcnt(0)
s_cmp_eq_u32 s47, 0
s_cbranch_scc1 L_spinC_lx
v_cmp_ne_u32 vcc, 1, v124
s_cbranch_vccz L_spinC_lx
s_sleep 4
s_branch L_spinC_l
L_spinC_lx:
s_branch L_spinCr
L_c31:
s_bfe_u32 s3, s2, 0x40003
s_lshl_b32 s3, s3, 2
s_add_u32 s3, s3, s32
s_lshl_b32 s3, s3, 15
s_and_b32 s7, s2, 1
s_lshl_b32 s7, s7, 22
s_add_u32 s3, s3, s7
s_add_u32 s3, s3, 2097536
v_and_b32 v1, 15, v0
v_lshlrev_b32 v1, 11, v1
v_lshrrev_b32 v11, 5, v0
v_lshl_add_u32 v1, v11, 10, v1
buffer_load_dword v11, v1, s[28:31], s3 offen
s_branch L_c31r
L_f2A:
s_lshr_b32 s5, s54, 1
s_lshl_b32 s5, s5, 5
s_add_u32 s5, s5, 5447680
buffer_load_dword v125, v127, s[20:23], s5 offen sc1
s_branch L_f2Ar
L_f2B:
s_waitcnt vmcnt(16)
v_cmp_ne_u32 vcc, 1, v125
s_cbranch_vccz L_f2lx
s_mov_b32 s47, 0x400000
L_f2l:
buffer_load_dword v125, v127, s[20:23], s5 offen sc1
s_sub_u32 s47, s47, 1
s_waitcnt vmcnt(0)
s_cmp_eq_u32 s47, 0
s_cbranch_scc1 L_f2lx
v_cmp_ne_u32 vcc, 1, v125
s_cbranch_vccz L_f2lx
s_sleep 8
s_branch L_f2l
L_f2lx:
s_lshl_b32 s3, s54, 8
s_add_u32 s3, s3, 6291456
v_mul_u32_u24 v124, 14336, v121
v_and_b32_e64 v125, 15, v0
v_lshl_add_u32 v124, v125, 4, v124
buffer_load_dwordx4 v[74:77], v124, s[20:23], s3 offen sc1
s_add_u32 s3, s3, 57344
buffer_load_dwordx4 v[78:81], v124, s[20:23], s3 offen sc1
s_add_u32 s3, s3, 57344
buffer_load_dwordx4 v[82:85], v124, s[20:23], s3 offen sc1
s_add_u32 s3, s3, 57344
buffer_load_dwordx4 v[86:89], v124, s[20:23], s3 offen sc1
s_add_u32 s3, s3, 57344
buffer_load_dwordx4 v[90:93], v124, s[20:23], s3 offen sc1
s_add_u32 s3, s3, 57344
buffer_load_dwordx4 v[94:97], v124, s[20:23], s3 offen sc1
s_add_u32 s3, s3, 57344
buffer_load_dwordx4 v[98:101], v124, s[20:23], s3 offen sc1
s_add_u32 s3, s3, 57344
buffer_load_dwordx4 v[102:105], v124, s[20:23], s3 offen sc1
s_branch L_f2Br
L_yA:
v_min_u32 v127, 13, v0
v_lshlrev_b32_e64 v127, 2, v127
buffer_load_dword v74, v127, s[20:23], s41 offen sc1
s_branch L_yAr
L_yB:
s_waitcnt vmcnt(1)
v_cmp_ne_u32 vcc, 1, v74
s_cbranch_vccnz L_yBr
s_mov_b32 s40, 1
v_lshlrev_b32 v124, 2, v0
v_lshlrev_b32 v125, 1, v0
s_lshl_b32 s7, s45, 2
s_add_u32 s7, s7, s32
s_lshr_b32 s3, s42, 5
s_cmp_lg_u32 s3, s7
s_cbranch_scc1 L_f_yl1
s_add_u32 s3, s55, 0
s_nop 0
s_add_u32 s7, s3, 4096
buffer_load_dword v76, v124, s[20:23], s3 offen offset:0 sc1
buffer_load_dword v77, v124, s[20:23], s3 offen offset:512 sc1
buffer_load_dword v78, v124, s[20:23], s3 offen offset:1024 sc1
buffer_load_dword v79, v124, s[20:23], s3 offen offset:1536 sc1
buffer_load_dword v80, v124, s[20:23], s3 offen offset:2048 sc1
buffer_load_dword v81, v124, s[20:23], s3 offen offset:2560 sc1
buffer_load_dword v82, v124, s[20:23], s3 offen offset:3072 sc1
buffer_load_dword v83, v124, s[20:23], s3 offen offset:3584 sc1
buffer_load_dword v84, v124, s[20:23], s7 offen offset:0 sc1
buffer_load_dword v85, v124, s[20:23], s7 offen offset:512 sc1
buffer_load_dword v86, v124, s[20:23], s7 offen offset:1024 sc1
buffer_load_dword v87, v124, s[20:23], s7 offen offset:1536 sc1
buffer_load_dword v88, v124, s[20:23], s7 offen offset:2048 sc1
buffer_load_dword v89, v124, s[20:23], s7 offen offset:2560 sc1
s_lshl_b32 s3, s42, 11
s_lshl_b32 s7, s46, 7
s_add_u32 s3, s3, s7
buffer_load_ushort v90, v125, s[56:59], s3 offen
s_lshl_b32 s3, s42, 3
s_add_u32 s3, s3, 5259264
buffer_load_dwordx2 v[92:93], v126, s[20:23], s3 offen sc1
L_f_yl1:
s_lshl_b32 s7, s45, 2
s_add_u32 s7, s7, s32
s_lshr_b32 s3, s43, 5
s_cmp_lg_u32 s3, s7
s_cbranch_scc1 L_f_yl2
s_nop 0
s_add_u32 s3, s55, 256
s_add_u32 s7, s3, 4096
buffer_load_dword v94, v124, s[20:23], s3 offen offset:0 sc1
buffer_load_dword v95, v124, s[20:23], s3 offen offset:512 sc1
buffer_load_dword v96, v124, s[20:23], s3 offen offset:1024 sc1
buffer_load_dword v97, v124, s[20:23], s3 offen offset:1536 sc1
buffer_load_dword v98, v124, s[20:23], s3 offen offset:2048 sc1
buffer_load_dword v99, v124, s[20:23], s3 offen offset:2560 sc1
buffer_load_dword v100, v124, s[20:23], s3 offen offset:3072 sc1
buffer_load_dword v101, v124, s[20:23], s3 offen offset:3584 sc1
buffer_load_dword v102, v124, s[20:23], s7 offen offset:0 sc1
buffer_load_dword v103, v124, s[20:23], s7 offen offset:512 sc1
buffer_load_dword v104, v124, s[20:23], s7 offen offset:1024 sc1
buffer_load_dword v105, v124, s[20:23], s7 offen offset:1536 sc1
buffer_load_dword v106, v124, s[20:23], s7 offen offset:2048 sc1
buffer_load_dword v107, v124, s[20:23], s7 offen offset:2560 sc1
s_lshl_b32 s3, s43, 11
s_lshl_b32 s7, s46, 7
s_add_u32 s3, s3, s7
buffer_load_ushort v108, v125, s[56:59], s3 offen
s_lshl_b32 s3, s43, 3
s_add_u32 s3, s3, 5259264
buffer_load_dwordx2 v[110:111], v126, s[20:23], s3 offen sc1
L_f_yl2:
s_branch L_yBr
L_yC:
s_waitcnt vmcnt(1)
s_lshl_b32 s7, s45, 2
s_add_u32 s7, s7, s32
s_lshr_b32 s3, s42, 5
s_cmp_lg_u32 s3, s7
s_cbranch_scc1 L_f_ys3
s_nop 0
v_pk_add_f32 v[76:77], v[76:77], v[78:79]
v_pk_add_f32 v[76:77], v[76:77], v[80:81]
v_pk_add_f32 v[76:77], v[76:77], v[82:83]
v_pk_add_f32 v[76:77], v[76:77], v[84:85]
v_pk_add_f32 v[76:77], v[76:77], v[86:87]
v_pk_add_f32 v[76:77], v[76:77], v[88:89]
Va 76,76,77
v_lshlrev_b32 v90, 16, v90
v_sub_f32_e64 v90, v90, v92
Vc 76,76,76
v_lshlrev_b32_e64 v76, 16, v76
Vc 90,90,90
v_lshlrev_b32 v90, 16, v90
v_mul_f32 v76, s100, v76
v_mul_f32_e64 v90, v90, v93
Vc 76,76,76
v_lshlrev_b32_e64 v76, 16, v76
Vc 90,90,90
v_lshlrev_b32 v90, 16, v90
Va 90,90,76
Vc 90,90,90
v_lshlrev_b32_e64 v90, 16, v90
v_mul_f32 v76, 0xbfb8aa3b, v90
Ve 76,76
s_nop 0
v_add_f32 v76, 1.0, v76
v_rcp_f32 v76, v76
s_nop 0
Vm 90,90,76
Vc 90,90,90
v_lshlrev_b32 v90, 16, v90
v_lshlrev_b32 v124, 2, v0
v_add_u32 v124, s35, v124
v_lshlrev_b32 v125, 5, v122
v_add_u32 v125, s35, v125
s_waitcnt lgkmcnt(0)
ds_write_b32 v124, v90
s_and_b32 s3, s42, 7
s_lshl_b32 s3, s3, 3
s_lshl_b64 s[4:5], 0xff, s3
s_bfe_u32 s3, s42, 0x20003
s_mov_b64 exec, s[4:5]
s_cmp_lg_u32 s3, 0
s_cbranch_scc1 L_f_yp4
ds_read_b64 v[42:43], v125
ds_read_b64 v[44:45], v125 offset:8
ds_read_b64 v[46:47], v125 offset:16
ds_read_b64 v[48:49], v125 offset:24
L_f_yp4:
s_cmp_lg_u32 s3, 1
s_cbranch_scc1 L_f_yp5
ds_read_b64 v[50:51], v125
ds_read_b64 v[52:53], v125 offset:8
ds_read_b64 v[54:55], v125 offset:16
ds_read_b64 v[56:57], v125 offset:24
L_f_yp5:
s_cmp_lg_u32 s3, 2
s_cbranch_scc1 L_f_yp6
ds_read_b64 v[58:59], v125
ds_read_b64 v[60:61], v125 offset:8
ds_read_b64 v[62:63], v125 offset:16
ds_read_b64 v[64:65], v125 offset:24
L_f_yp6:
s_cmp_lg_u32 s3, 3
s_cbranch_scc1 L_f_yp7
ds_read_b64 v[66:67], v125
ds_read_b64 v[68:69], v125 offset:8
s_waitcnt lgkmcnt(9)
ds_read_b64 v[70:71], v125 offset:16
ds_read_b64 v[72:73], v125 offset:24
L_f_yp7:
s_mov_b64 exec, -1
s_waitcnt lgkmcnt(0)
L_f_ys3:
s_lshl_b32 s7, s45, 2
s_add_u32 s7, s7, s32
s_lshr_b32 s3, s43, 5
s_cmp_lg_u32 s3, s7
s_cbranch_scc1 L_f_ys8
s_nop 0
v_pk_add_f32 v[94:95], v[94:95], v[96:97]
v_pk_add_f32 v[94:95], v[94:95], v[98:99]
v_pk_add_f32 v[94:95], v[94:95], v[100:101]
v_pk_add_f32 v[94:95], v[94:95], v[102:103]
v_pk_add_f32 v[94:95], v[94:95], v[104:105]
v_pk_add_f32 v[94:95], v[94:95], v[106:107]
Va 94,94,95
v_lshlrev_b32 v108, 16, v108
v_sub_f32_e64 v108, v108, v110
Vc 94,94,94
v_lshlrev_b32_e64 v94, 16, v94
Vc 108,108,108
v_lshlrev_b32 v108, 16, v108
v_mul_f32 v94, s101, v94
v_mul_f32_e64 v108, v108, v111
Vc 94,94,94
v_lshlrev_b32_e64 v94, 16, v94
Vc 108,108,108
v_lshlrev_b32 v108, 16, v108
Va 108,108,94
Vc 108,108,108
v_lshlrev_b32_e64 v108, 16, v108
v_mul_f32 v94, 0xbfb8aa3b, v108
Ve 94,94
s_nop 0
v_add_f32 v94, 1.0, v94
v_rcp_f32 v94, v94
s_nop 0
Vm 108,108,94
Vc 108,108,108
v_lshlrev_b32 v108, 16, v108
v_lshlrev_b32 v124, 2, v0
v_add_u32 v124, s35, v124
v_lshlrev_b32 v125, 5, v122
v_add_u32 v125, s35, v125
s_waitcnt lgkmcnt(0)
ds_write_b32 v124, v108
s_and_b32 s3, s43, 7
s_lshl_b32 s3, s3, 3
s_lshl_b64 s[4:5], 0xff, s3
s_bfe_u32 s3, s43, 0x20003
s_mov_b64 exec, s[4:5]
s_cmp_lg_u32 s3, 0
s_cbranch_scc1 L_f_yp9
ds_read_b64 v[42:43], v125
ds_read_b64 v[44:45], v125 offset:8
ds_read_b64 v[46:47], v125 offset:16
ds_read_b64 v[48:49], v125 offset:24
L_f_yp9:
s_cmp_lg_u32 s3, 1
s_cbranch_scc1 L_f_yp10
ds_read_b64 v[50:51], v125
ds_read_b64 v[52:53], v125 offset:8
ds_read_b64 v[54:55], v125 offset:16
ds_read_b64 v[56:57], v125 offset:24
L_f_yp10:
s_cmp_lg_u32 s3, 2
s_cbranch_scc1 L_f_yp11
ds_read_b64 v[58:59], v125
ds_read_b64 v[60:61], v125 offset:8
ds_read_b64 v[62:63], v125 offset:16
ds_read_b64 v[64:65], v125 offset:24
L_f_yp11:
s_cmp_lg_u32 s3, 3
s_cbranch_scc1 L_f_yp12
ds_read_b64 v[66:67], v125
ds_read_b64 v[68:69], v125 offset:8
s_waitcnt lgkmcnt(9)
ds_read_b64 v[70:71], v125 offset:16
ds_read_b64 v[72:73], v125 offset:24
L_f_yp12:
s_mov_b64 exec, -1
s_waitcnt lgkmcnt(0)
L_f_ys8:
s_branch L_yCr
L_p4_end:
L_spinAk:
s_mov_b32 s47, 0x400000
L_spinAk_l:
s_sleep 8
buffer_load_dword v1, v7, s[28:31], 0 offen sc1
s_waitcnt vmcnt(0)
v_readfirstlane_b32 s3, v1
s_sub_u32 s47, s47, 1
s_cmp_eq_u32 s47, 0
s_cbranch_scc1 L_spinArk
s_cmp_lt_u32 s3, 256
s_cbranch_scc1 L_spinAk_l
s_branch L_spinArk
L_spinAv:
s_mov_b32 s47, 0x400000
L_spinAv_l:
s_sleep 8
buffer_load_dword v1, v7, s[28:31], 0 offen sc1
s_waitcnt vmcnt(0)
v_readfirstlane_b32 s3, v1
s_sub_u32 s47, s47, 1
s_cmp_eq_u32 s47, 0
s_cbranch_scc1 L_spinArv
s_cmp_lt_u32 s3, 256
s_cbranch_scc1 L_spinAv_l
s_branch L_spinArv
L_spinB:
s_mov_b32 s59, 0x400000
L_spinB_l:
s_sleep 4
buffer_load_dword v12, v1, s[20:23], s6 offen sc1
s_sub_u32 s59, s59, 1
s_cmp_eq_u32 s59, 0
s_cbranch_scc1 L_spinBx
s_waitcnt vmcnt(0)
v_cmp_ne_u32 vcc, 1, v12
s_cbranch_vccnz L_spinB_l
L_spinBx:
s_waitcnt vmcnt(0)
s_branch L_spinBr
L_k2_fb_we:
s_nop 7
s_nop 0
v_max3_f32 v21, v128, v129, v130
v_max3_f32 v21, v21, v131, v132
v_max3_f32 v21, v21, v133, v134
v_max3_f32 v21, v21, v135, v136
v_max3_f32 v21, v21, v137, v138
v_max3_f32 v21, v21, v139, v140
v_max3_f32 v21, v21, v141, v142
v_max_f32 v21, v21, v143
v_mov_b32 v1, v21
s_nop 1
v_permlane16_swap_b32 v1, v21
v_max_f32 v21, v21, v1
v_mov_b32 v1, v21
s_nop 1
v_permlane32_swap_b32 v1, v21
v_max_f32_e64 v21, v21, v1
v_add_f32 v21, 0x41f80000, v21
v_max_f32 v21, 0, v21
Vs 128,128,21
Vs 129,129,21
Vs 130,130,21
Vs 131,131,21
Vs 132,132,21
Vs 133,133,21
Vs 134,134,21
Vs 135,135,21
Vs 136,136,21
Vs 137,137,21
Vs 138,138,21
Vs 139,139,21
Vs 140,140,21
Vs 141,141,21
Vs 142,142,21
Vs 143,143,21
Vs 192,192,21
Vs 193,193,21
Vs 194,194,21
Vs 195,195,21
Vs 196,196,21
Vs 197,197,21
Vs 198,198,21
Vs 199,199,21
Vs 200,200,21
Vs 201,201,21
Vs 202,202,21
Vs 203,203,21
Vs 204,204,21
Vs 205,205,21
Vs 206,206,21
Vs 207,207,21
Vs 32,32,21
Vs 33,33,21
Vs 34,34,21
v_sub_f32_e64 v35, v35, v21
v_exp_f32 v22, -v21
s_nop 0
Vm 48,48,22
Vm 49,49,22
Vm 50,50,22
v_mul_f32_e64 v51, v51, v22
Ar 8,0
Ar 9,1
Ar 10,2
Ar 11,3
Ar 12,4
Ar 13,5
Ar 14,6
Ar 15,7
Vm 8,8,22
Vm 9,9,22
Vm 10,10,22
Vm 11,11,22
Vm 12,12,22
Vm 13,13,22
Vm 14,14,22
Vm 15,15,22
Aw 0,8
Aw 1,9
Aw 2,10
Aw 3,11
Aw 4,12
Aw 5,13
Aw 6,14
Aw 7,15
Ar 8,8
Ar 9,9
Ar 10,10
Ar 11,11
Ar 12,12
Ar 13,13
Ar 14,14
Ar 15,15
Vm 8,8,22
Vm 9,9,22
Vm 10,10,22
Vm 11,11,22
Vm 12,12,22
Vm 13,13,22
Vm 14,14,22
Vm 15,15,22
Aw 8,8
Aw 9,9
Aw 10,10
Aw 11,11
Aw 12,12
Aw 13,13
Aw 14,14
Aw 15,15
Ar 8,16
Ar 9,17
Ar 10,18
Ar 11,19
Ar 12,20
Ar 13,21
Ar 14,22
Ar 15,23
Vm 8,8,22
Vm 9,9,22
Vm 10,10,22
Vm 11,11,22
Vm 12,12,22
Vm 13,13,22
Vm 14,14,22
Vm 15,15,22
Aw 16,8
Aw 17,9
Aw 18,10
Aw 19,11
Aw 20,12
Aw 21,13
Aw 22,14
Aw 23,15
Ar 8,24
Ar 9,25
Ar 10,26
Ar 11,27
Ar 12,28
Ar 13,29
Ar 14,30
Ar 15,31
Vm 8,8,22
Vm 9,9,22
Vm 10,10,22
Vm 11,11,22
Vm 12,12,22
Vm 13,13,22
Vm 14,14,22
Vm 15,15,22
Aw 24,8
Aw 25,9
Aw 26,10
Aw 27,11
Aw 28,12
Aw 29,13
Aw 30,14
Aw 31,15
v_max3_f32 v21, v144, v145, v146
v_max3_f32 v21, v21, v147, v148
v_max3_f32 v21, v21, v149, v150
v_max3_f32 v21, v21, v151, v152
v_max3_f32 v21, v21, v153, v154
v_max3_f32 v21, v21, v155, v156
v_max3_f32 v21, v21, v157, v158
v_max_f32 v21, v21, v159
v_mov_b32 v1, v21
s_nop 1
v_permlane16_swap_b32 v1, v21
v_max_f32 v21, v21, v1
v_mov_b32 v1, v21
s_nop 1
v_permlane32_swap_b32 v1, v21
v_max_f32_e64 v21, v21, v1
v_add_f32 v21, 0x41f80000, v21
v_max_f32 v21, 0, v21
Vs 144,144,21
Vs 145,145,21
Vs 146,146,21
Vs 147,147,21
Vs 148,148,21
Vs 149,149,21
Vs 150,150,21
Vs 151,151,21
Vs 152,152,21
Vs 153,153,21
Vs 154,154,21
Vs 155,155,21
Vs 156,156,21
Vs 157,157,21
Vs 158,158,21
Vs 159,159,21
Vs 208,208,21
Vs 209,209,21
Vs 210,210,21
Vs 211,211,21
Vs 212,212,21
Vs 213,213,21
Vs 214,214,21
Vs 215,215,21
Vs 216,216,21
Vs 217,217,21
Vs 218,218,21
Vs 219,219,21
Vs 220,220,21
Vs 221,221,21
Vs 222,222,21
Vs 223,223,21
Vs 36,36,21
Vs 37,37,21
Vs 38,38,21
v_sub_f32_e64 v39, v39, v21
v_exp_f32 v22, -v21
s_nop 0
Vm 52,52,22
Vm 53,53,22
Vm 54,54,22
v_mul_f32_e64 v55, v55, v22
Ar 8,32
Ar 9,33
Ar 10,34
Ar 11,35
Ar 12,36
Ar 13,37
Ar 14,38
Ar 15,39
Vm 8,8,22
Vm 9,9,22
Vm 10,10,22
Vm 11,11,22
Vm 12,12,22
Vm 13,13,22
Vm 14,14,22
Vm 15,15,22
Aw 32,8
Aw 33,9
Aw 34,10
Aw 35,11
Aw 36,12
Aw 37,13
Aw 38,14
Aw 39,15
Ar 8,40
Ar 9,41
Ar 10,42
Ar 11,43
Ar 12,44
Ar 13,45
Ar 14,46
Ar 15,47
Vm 8,8,22
Vm 9,9,22
Vm 10,10,22
Vm 11,11,22
Vm 12,12,22
Vm 13,13,22
Vm 14,14,22
Vm 15,15,22
Aw 40,8
Aw 41,9
Aw 42,10
Aw 43,11
Aw 44,12
Aw 45,13
Aw 46,14
Aw 47,15
Ar 8,48
Ar 9,49
Ar 10,50
Ar 11,51
Ar 12,52
Ar 13,53
Ar 14,54
Ar 15,55
Vm 8,8,22
Vm 9,9,22
Vm 10,10,22
Vm 11,11,22
Vm 12,12,22
Vm 13,13,22
Vm 14,14,22
Vm 15,15,22
Aw 48,8
Aw 49,9
Aw 50,10
Aw 51,11
Aw 52,12
Aw 53,13
Aw 54,14
Aw 55,15
Ar 8,56
Ar 9,57
Ar 10,58
Ar 11,59
Ar 12,60
Ar 13,61
Ar 14,62
Ar 15,63
Vm 8,8,22
Vm 9,9,22
Vm 10,10,22
Vm 11,11,22
Vm 12,12,22
Vm 13,13,22
Vm 14,14,22
Vm 15,15,22
Aw 56,8
Aw 57,9
Aw 58,10
Aw 59,11
Aw 60,12
Aw 61,13
Aw 62,14
Aw 63,15
v_max3_f32 v21, v160, v161, v162
v_max3_f32 v21, v21, v163, v164
v_max3_f32 v21, v21, v165, v166
v_max3_f32 v21, v21, v167, v168
v_max3_f32 v21, v21, v169, v170
v_max3_f32 v21, v21, v171, v172
v_max3_f32 v21, v21, v173, v174
v_max_f32 v21, v21, v175
v_mov_b32 v1, v21
s_nop 1
v_permlane16_swap_b32 v1, v21
v_max_f32 v21, v21, v1
v_mov_b32 v1, v21
s_nop 1
v_permlane32_swap_b32 v1, v21
v_max_f32_e64 v21, v21, v1
v_add_f32 v21, 0x41f80000, v21
v_max_f32 v21, 0, v21
Vs 160,160,21
Vs 161,161,21
Vs 162,162,21
Vs 163,163,21
Vs 164,164,21
Vs 165,165,21
Vs 166,166,21
Vs 167,167,21
Vs 168,168,21
Vs 169,169,21
Vs 170,170,21
Vs 171,171,21
Vs 172,172,21
Vs 173,173,21
Vs 174,174,21
Vs 175,175,21
Vs 224,224,21
Vs 225,225,21
Vs 226,226,21
Vs 227,227,21
Vs 228,228,21
Vs 229,229,21
Vs 230,230,21
Vs 231,231,21
Vs 232,232,21
Vs 233,233,21
Vs 234,234,21
Vs 235,235,21
Vs 236,236,21
Vs 237,237,21
Vs 238,238,21
Vs 239,239,21
Vs 40,40,21
Vs 41,41,21
Vs 42,42,21
v_sub_f32_e64 v43, v43, v21
v_exp_f32 v22, -v21
s_nop 0
Vm 56,56,22
Vm 57,57,22
Vm 58,58,22
v_mul_f32_e64 v59, v59, v22
Ar 8,64
Ar 9,65
Ar 10,66
Ar 11,67
Ar 12,68
Ar 13,69
Ar 14,70
Ar 15,71
Vm 8,8,22
Vm 9,9,22
Vm 10,10,22
Vm 11,11,22
Vm 12,12,22
Vm 13,13,22
Vm 14,14,22
Vm 15,15,22
Aw 64,8
Aw 65,9
Aw 66,10
Aw 67,11
Aw 68,12
Aw 69,13
Aw 70,14
Aw 71,15
Ar 8,72
Ar 9,73
Ar 10,74
Ar 11,75
Ar 12,76
Ar 13,77
Ar 14,78
Ar 15,79
Vm 8,8,22
Vm 9,9,22
Vm 10,10,22
Vm 11,11,22
Vm 12,12,22
Vm 13,13,22
Vm 14,14,22
Vm 15,15,22
Aw 72,8
Aw 73,9
Aw 74,10
Aw 75,11
Aw 76,12
Aw 77,13
Aw 78,14
Aw 79,15
Ar 8,80
Ar 9,81
Ar 10,82
Ar 11,83
Ar 12,84
Ar 13,85
Ar 14,86
Ar 15,87
Vm 8,8,22
Vm 9,9,22
Vm 10,10,22
Vm 11,11,22
Vm 12,12,22
Vm 13,13,22
Vm 14,14,22
Vm 15,15,22
Aw 80,8
Aw 81,9
Aw 82,10
Aw 83,11
Aw 84,12
Aw 85,13
Aw 86,14
Aw 87,15
Ar 8,88
Ar 9,89
Ar 10,90
Ar 11,91
Ar 12,92
Ar 13,93
Ar 14,94
Ar 15,95
Vm 8,8,22
Vm 9,9,22
Vm 10,10,22
Vm 11,11,22
Vm 12,12,22
Vm 13,13,22
Vm 14,14,22
Vm 15,15,22
Aw 88,8
Aw 89,9
Aw 90,10
Aw 91,11
Aw 92,12
Aw 93,13
Aw 94,14
Aw 95,15
v_max3_f32 v21, v176, v177, v178
v_max3_f32 v21, v21, v179, v180
v_max3_f32 v21, v21, v181, v182
v_max3_f32 v21, v21, v183, v184
v_max3_f32 v21, v21, v185, v186
v_max3_f32 v21, v21, v187, v188
v_max3_f32 v21, v21, v189, v190
v_max_f32 v21, v21, v191
v_mov_b32 v1, v21
s_nop 1
v_permlane16_swap_b32 v1, v21
v_max_f32 v21, v21, v1
v_mov_b32 v1, v21
s_nop 1
v_permlane32_swap_b32 v1, v21
v_max_f32_e64 v21, v21, v1
v_add_f32 v21, 0x41f80000, v21
v_max_f32 v21, 0, v21
Vs 176,176,21
Vs 177,177,21
Vs 178,178,21
Vs 179,179,21
Vs 180,180,21
Vs 181,181,21
Vs 182,182,21
Vs 183,183,21
Vs 184,184,21
Vs 185,185,21
Vs 186,186,21
Vs 187,187,21
Vs 188,188,21
Vs 189,189,21
Vs 190,190,21
Vs 191,191,21
Vs 240,240,21
Vs 241,241,21
Vs 242,242,21
Vs 243,243,21
Vs 244,244,21
Vs 245,245,21
Vs 246,246,21
Vs 247,247,21
Vs 248,248,21
Vs 249,249,21
Vs 250,250,21
Vs 251,251,21
Vs 252,252,21
Vs 253,253,21
Vs 254,254,21
Vs 255,255,21
Vs 44,44,21
Vs 45,45,21
Vs 46,46,21
v_sub_f32_e64 v47, v47, v21
v_exp_f32 v22, -v21
s_nop 0
Vm 60,60,22
Vm 61,61,22
Vm 62,62,22
v_mul_f32_e64 v63, v63, v22
Ar 8,96
Ar 9,97
Ar 10,98
Ar 11,99
Ar 12,100
Ar 13,101
Ar 14,102
Ar 15,103
Vm 8,8,22
Vm 9,9,22
Vm 10,10,22
Vm 11,11,22
Vm 12,12,22
Vm 13,13,22
Vm 14,14,22
Vm 15,15,22
Aw 96,8
Aw 97,9
Aw 98,10
Aw 99,11
Aw 100,12
Aw 101,13
Aw 102,14
Aw 103,15
Ar 8,104
Ar 9,105
Ar 10,106
Ar 11,107
Ar 12,108
Ar 13,109
Ar 14,110
Ar 15,111
Vm 8,8,22
Vm 9,9,22
Vm 10,10,22
Vm 11,11,22
Vm 12,12,22
Vm 13,13,22
Vm 14,14,22
Vm 15,15,22
Aw 104,8
Aw 105,9
Aw 106,10
Aw 107,11
Aw 108,12
Aw 109,13
Aw 110,14
Aw 111,15
Ar 8,112
Ar 9,113
Ar 10,114
Ar 11,115
Ar 12,116
Ar 13,117
Ar 14,118
Ar 15,119
Vm 8,8,22
Vm 9,9,22
Vm 10,10,22
Vm 11,11,22
Vm 12,12,22
Vm 13,13,22
Vm 14,14,22
Vm 15,15,22
Aw 112,8
Aw 113,9
Aw 114,10
Aw 115,11
Aw 116,12
Aw 117,13
Aw 118,14
Aw 119,15
Ar 8,120
Ar 9,121
Ar 10,122
Ar 11,123
Ar 12,124
Ar 13,125
Ar 14,126
Ar 15,127
Vm 8,8,22
Vm 9,9,22
Vm 10,10,22
Vm 11,11,22
Vm 12,12,22
Vm 13,13,22
Vm 14,14,22
Vm 15,15,22
Aw 120,8
Aw 121,9
Aw 122,10
Aw 123,11
Aw 124,12
Aw 125,13
Aw 126,14
Aw 127,15
Ve 8,128
Ve 9,129
s_nop 0
Vc 64,8,9
Ve 8,130
Ve 9,131
s_nop 0
Vc 65,8,9
Ve 8,144
Ve 9,145
s_nop 0
Vc 72,8,9
Ve 8,146
Ve 9,147
s_nop 0
Vc 73,8,9
Ve 8,160
Ve 9,161
s_nop 0
Vc 80,8,9
Ve 8,162
Ve 9,163
s_nop 0
Vc 81,8,9
Ve 8,176
Ve 9,177
s_nop 0
Vc 88,8,9
Ve 8,178
Ve 9,179
s_nop 0
Vc 89,8,9
Ve 8,132
Ve 9,133
s_nop 0
Vc 66,8,9
Ve 8,134
Ve 9,135
s_nop 0
Vc 67,8,9
Ve 8,148
Ve 9,149
s_nop 0
Vc 74,8,9
Ve 8,150
Ve 9,151
s_nop 0
Vc 75,8,9
Ve 8,164
Ve 9,165
s_nop 0
Vc 82,8,9
Ve 8,166
Ve 9,167
s_nop 0
Vc 83,8,9
Ve 8,180
Ve 9,181
s_nop 0
Vc 90,8,9
Ve 8,182
Ve 9,183
s_nop 0
Vc 91,8,9
Ve 8,136
Ve 9,137
s_nop 0
Vc 68,8,9
Ve 8,138
Ve 9,139
s_nop 0
Vc 69,8,9
Ve 8,152
Ve 9,153
s_nop 0
Vc 76,8,9
Ve 8,154
Ve 9,155
s_nop 0
Vc 77,8,9
Ve 8,168
Ve 9,169
s_nop 0
Vc 84,8,9
Ve 8,170
Ve 9,171
s_nop 0
Vc 85,8,9
Ve 8,184
Ve 9,185
s_nop 0
Vc 92,8,9
Ve 8,186
Ve 9,187
s_nop 0
Vc 93,8,9
Ve 8,140
Ve 9,141
s_nop 0
Vc 70,8,9
Ve 8,142
Ve 9,143
s_nop 0
Vc 71,8,9
Ve 8,156
Ve 9,157
s_nop 0
Vc 78,8,9
Ve 8,158
Ve 9,159
s_nop 0
Vc 79,8,9
Ve 8,172
Ve 9,173
s_nop 0
Vc 86,8,9
Ve 8,174
Ve 9,175
s_nop 0
Vc 87,8,9
Ve 8,188
Ve 9,189
s_nop 0
Vc 94,8,9
Ve 8,190
Ve 9,191
s_nop 0
Vc 95,8,9
s_nop 1
s_branch L_k2_fbr_we
L_k2_fb_wo:
s_nop 7
s_nop 0
v_max3_f32 v21, v192, v193, v194
v_max3_f32 v21, v21, v195, v196
v_max3_f32 v21, v21, v197, v198
v_max3_f32 v21, v21, v199, v200
v_max3_f32 v21, v21, v201, v202
v_max3_f32 v21, v21, v203, v204
v_max3_f32 v21, v21, v205, v206
v_max_f32 v21, v21, v207
v_mov_b32 v1, v21
s_nop 1
v_permlane16_swap_b32 v1, v21
v_max_f32 v21, v21, v1
v_mov_b32 v1, v21
s_nop 1
v_permlane32_swap_b32 v1, v21
v_max_f32_e64 v21, v21, v1
v_add_f32 v21, 0x41f80000, v21
v_max_f32 v21, 0, v21
Vs 192,192,21
Vs 193,193,21
Vs 194,194,21
Vs 195,195,21
Vs 196,196,21
Vs 197,197,21
Vs 198,198,21
Vs 199,199,21
Vs 200,200,21
Vs 201,201,21
Vs 202,202,21
Vs 203,203,21
Vs 204,204,21
Vs 205,205,21
Vs 206,206,21
Vs 207,207,21
Vs 128,128,21
Vs 129,129,21
Vs 130,130,21
Vs 131,131,21
Vs 132,132,21
Vs 133,133,21
Vs 134,134,21
Vs 135,135,21
Vs 136,136,21
Vs 137,137,21
Vs 138,138,21
Vs 139,139,21
Vs 140,140,21
Vs 141,141,21
Vs 142,142,21
Vs 143,143,21
Vs 32,32,21
Vs 33,33,21
Vs 34,34,21
v_sub_f32_e64 v35, v35, v21
v_exp_f32 v22, -v21
s_nop 0
Vm 48,48,22
Vm 49,49,22
Vm 50,50,22
v_mul_f32_e64 v51, v51, v22
Ar 8,0
Ar 9,1
Ar 10,2
Ar 11,3
Ar 12,4
Ar 13,5
Ar 14,6
Ar 15,7
Vm 8,8,22
Vm 9,9,22
Vm 10,10,22
Vm 11,11,22
Vm 12,12,22
Vm 13,13,22
Vm 14,14,22
Vm 15,15,22
Aw 0,8
Aw 1,9
Aw 2,10
Aw 3,11
Aw 4,12
Aw 5,13
Aw 6,14
Aw 7,15
Ar 8,8
Ar 9,9
Ar 10,10
Ar 11,11
Ar 12,12
Ar 13,13
Ar 14,14
Ar 15,15
Vm 8,8,22
Vm 9,9,22
Vm 10,10,22
Vm 11,11,22
Vm 12,12,22
Vm 13,13,22
Vm 14,14,22
Vm 15,15,22
Aw 8,8
Aw 9,9
Aw 10,10
Aw 11,11
Aw 12,12
Aw 13,13
Aw 14,14
Aw 15,15
Ar 8,16
Ar 9,17
Ar 10,18
Ar 11,19
Ar 12,20
Ar 13,21
Ar 14,22
Ar 15,23
Vm 8,8,22
Vm 9,9,22
Vm 10,10,22
Vm 11,11,22
Vm 12,12,22
Vm 13,13,22
Vm 14,14,22
Vm 15,15,22
Aw 16,8
Aw 17,9
Aw 18,10
Aw 19,11
Aw 20,12
Aw 21,13
Aw 22,14
Aw 23,15
Ar 8,24
Ar 9,25
Ar 10,26
Ar 11,27
Ar 12,28
Ar 13,29
Ar 14,30
Ar 15,31
Vm 8,8,22
Vm 9,9,22
Vm 10,10,22
Vm 11,11,22
Vm 12,12,22
Vm 13,13,22
Vm 14,14,22
Vm 15,15,22
Aw 24,8
Aw 25,9
Aw 26,10
Aw 27,11
Aw 28,12
Aw 29,13
Aw 30,14
Aw 31,15
v_max3_f32 v21, v208, v209, v210
v_max3_f32 v21, v21, v211, v212
v_max3_f32 v21, v21, v213, v214
v_max3_f32 v21, v21, v215, v216
v_max3_f32 v21, v21, v217, v218
v_max3_f32 v21, v21, v219, v220
v_max3_f32 v21, v21, v221, v222
v_max_f32 v21, v21, v223
v_mov_b32 v1, v21
s_nop 1
v_permlane16_swap_b32 v1, v21
v_max_f32 v21, v21, v1
v_mov_b32 v1, v21
s_nop 1
v_permlane32_swap_b32 v1, v21
v_max_f32_e64 v21, v21, v1
v_add_f32 v21, 0x41f80000, v21
v_max_f32 v21, 0, v21
Vs 208,208,21
Vs 209,209,21
Vs 210,210,21
Vs 211,211,21
Vs 212,212,21
Vs 213,213,21
Vs 214,214,21
Vs 215,215,21
Vs 216,216,21
Vs 217,217,21
Vs 218,218,21
Vs 219,219,21
Vs 220,220,21
Vs 221,221,21
Vs 222,222,21
Vs 223,223,21
Vs 144,144,21
Vs 145,145,21
Vs 146,146,21
Vs 147,147,21
Vs 148,148,21
Vs 149,149,21
Vs 150,150,21
Vs 151,151,21
Vs 152,152,21
Vs 153,153,21
Vs 154,154,21
Vs 155,155,21
Vs 156,156,21
Vs 157,157,21
Vs 158,158,21
Vs 159,159,21
Vs 36,36,21
Vs 37,37,21
Vs 38,38,21
v_sub_f32_e64 v39, v39, v21
v_exp_f32 v22, -v21
s_nop 0
Vm 52,52,22
Vm 53,53,22
Vm 54,54,22
v_mul_f32_e64 v55, v55, v22
Ar 8,32
Ar 9,33
Ar 10,34
Ar 11,35
Ar 12,36
Ar 13,37
Ar 14,38
Ar 15,39
Vm 8,8,22
Vm 9,9,22
Vm 10,10,22
Vm 11,11,22
Vm 12,12,22
Vm 13,13,22
Vm 14,14,22
Vm 15,15,22
Aw 32,8
Aw 33,9
Aw 34,10
Aw 35,11
Aw 36,12
Aw 37,13
Aw 38,14
Aw 39,15
Ar 8,40
Ar 9,41
Ar 10,42
Ar 11,43
Ar 12,44
Ar 13,45
Ar 14,46
Ar 15,47
Vm 8,8,22
Vm 9,9,22
Vm 10,10,22
Vm 11,11,22
Vm 12,12,22
Vm 13,13,22
Vm 14,14,22
Vm 15,15,22
Aw 40,8
Aw 41,9
Aw 42,10
Aw 43,11
Aw 44,12
Aw 45,13
Aw 46,14
Aw 47,15
Ar 8,48
Ar 9,49
Ar 10,50
Ar 11,51
Ar 12,52
Ar 13,53
Ar 14,54
Ar 15,55
Vm 8,8,22
Vm 9,9,22
Vm 10,10,22
Vm 11,11,22
Vm 12,12,22
Vm 13,13,22
Vm 14,14,22
Vm 15,15,22
Aw 48,8
Aw 49,9
Aw 50,10
Aw 51,11
Aw 52,12
Aw 53,13
Aw 54,14
Aw 55,15
Ar 8,56
Ar 9,57
Ar 10,58
Ar 11,59
Ar 12,60
Ar 13,61
Ar 14,62
Ar 15,63
Vm 8,8,22
Vm 9,9,22
Vm 10,10,22
Vm 11,11,22
Vm 12,12,22
Vm 13,13,22
Vm 14,14,22
Vm 15,15,22
Aw 56,8
Aw 57,9
Aw 58,10
Aw 59,11
Aw 60,12
Aw 61,13
Aw 62,14
Aw 63,15
v_max3_f32 v21, v224, v225, v226
v_max3_f32 v21, v21, v227, v228
v_max3_f32 v21, v21, v229, v230
v_max3_f32 v21, v21, v231, v232
v_max3_f32 v21, v21, v233, v234
v_max3_f32 v21, v21, v235, v236
v_max3_f32 v21, v21, v237, v238
v_max_f32 v21, v21, v239
v_mov_b32 v1, v21
s_nop 1
v_permlane16_swap_b32 v1, v21
v_max_f32 v21, v21, v1
v_mov_b32 v1, v21
s_nop 1
v_permlane32_swap_b32 v1, v21
v_max_f32_e64 v21, v21, v1
v_add_f32 v21, 0x41f80000, v21
v_max_f32 v21, 0, v21
Vs 224,224,21
Vs 225,225,21
Vs 226,226,21
Vs 227,227,21
Vs 228,228,21
Vs 229,229,21
Vs 230,230,21
Vs 231,231,21
Vs 232,232,21
Vs 233,233,21
Vs 234,234,21
Vs 235,235,21
Vs 236,236,21
Vs 237,237,21
Vs 238,238,21
Vs 239,239,21
Vs 160,160,21
Vs 161,161,21
Vs 162,162,21
Vs 163,163,21
Vs 164,164,21
Vs 165,165,21
Vs 166,166,21
Vs 167,167,21
Vs 168,168,21
Vs 169,169,21
Vs 170,170,21
Vs 171,171,21
Vs 172,172,21
Vs 173,173,21
Vs 174,174,21
Vs 175,175,21
Vs 40,40,21
Vs 41,41,21
Vs 42,42,21
v_sub_f32_e64 v43, v43, v21
v_exp_f32 v22, -v21
s_nop 0
Vm 56,56,22
Vm 57,57,22
Vm 58,58,22
v_mul_f32_e64 v59, v59, v22
Ar 8,64
Ar 9,65
Ar 10,66
Ar 11,67
Ar 12,68
Ar 13,69
Ar 14,70
Ar 15,71
Vm 8,8,22
Vm 9,9,22
Vm 10,10,22
Vm 11,11,22
Vm 12,12,22
Vm 13,13,22
Vm 14,14,22
Vm 15,15,22
Aw 64,8
Aw 65,9
Aw 66,10
Aw 67,11
Aw 68,12
Aw 69,13
Aw 70,14
Aw 71,15
Ar 8,72
Ar 9,73
Ar 10,74
Ar 11,75
Ar 12,76
Ar 13,77
Ar 14,78
Ar 15,79
Vm 8,8,22
Vm 9,9,22
Vm 10,10,22
Vm 11,11,22
Vm 12,12,22
Vm 13,13,22
Vm 14,14,22
Vm 15,15,22
Aw 72,8
Aw 73,9
Aw 74,10
Aw 75,11
Aw 76,12
Aw 77,13
Aw 78,14
Aw 79,15
Ar 8,80
Ar 9,81
Ar 10,82
Ar 11,83
Ar 12,84
Ar 13,85
Ar 14,86
Ar 15,87
Vm 8,8,22
Vm 9,9,22
Vm 10,10,22
Vm 11,11,22
Vm 12,12,22
Vm 13,13,22
Vm 14,14,22
Vm 15,15,22
Aw 80,8
Aw 81,9
Aw 82,10
Aw 83,11
Aw 84,12
Aw 85,13
Aw 86,14
Aw 87,15
Ar 8,88
Ar 9,89
Ar 10,90
Ar 11,91
Ar 12,92
Ar 13,93
Ar 14,94
Ar 15,95
Vm 8,8,22
Vm 9,9,22
Vm 10,10,22
Vm 11,11,22
Vm 12,12,22
Vm 13,13,22
Vm 14,14,22
Vm 15,15,22
Aw 88,8
Aw 89,9
Aw 90,10
Aw 91,11
Aw 92,12
Aw 93,13
Aw 94,14
Aw 95,15
v_max3_f32 v21, v240, v241, v242
v_max3_f32 v21, v21, v243, v244
v_max3_f32 v21, v21, v245, v246
v_max3_f32 v21, v21, v247, v248
v_max3_f32 v21, v21, v249, v250
v_max3_f32 v21, v21, v251, v252
v_max3_f32 v21, v21, v253, v254
v_max_f32 v21, v21, v255
v_mov_b32 v1, v21
s_nop 1
v_permlane16_swap_b32 v1, v21
v_max_f32 v21, v21, v1
v_mov_b32 v1, v21
s_nop 1
v_permlane32_swap_b32 v1, v21
v_max_f32_e64 v21, v21, v1
v_add_f32 v21, 0x41f80000, v21
v_max_f32 v21, 0, v21
Vs 240,240,21
Vs 241,241,21
Vs 242,242,21
Vs 243,243,21
Vs 244,244,21
Vs 245,245,21
Vs 246,246,21
Vs 247,247,21
Vs 248,248,21
Vs 249,249,21
Vs 250,250,21
Vs 251,251,21
Vs 252,252,21
Vs 253,253,21
Vs 254,254,21
Vs 255,255,21
Vs 176,176,21
Vs 177,177,21
Vs 178,178,21
Vs 179,179,21
Vs 180,180,21
Vs 181,181,21
Vs 182,182,21
Vs 183,183,21
Vs 184,184,21
Vs 185,185,21
Vs 186,186,21
Vs 187,187,21
Vs 188,188,21
Vs 189,189,21
Vs 190,190,21
Vs 191,191,21
Vs 44,44,21
Vs 45,45,21
Vs 46,46,21
v_sub_f32_e64 v47, v47, v21
v_exp_f32 v22, -v21
s_nop 0
Vm 60,60,22
Vm 61,61,22
Vm 62,62,22
v_mul_f32_e64 v63, v63, v22
Ar 8,96
Ar 9,97
Ar 10,98
Ar 11,99
Ar 12,100
Ar 13,101
Ar 14,102
Ar 15,103
Vm 8,8,22
Vm 9,9,22
Vm 10,10,22
Vm 11,11,22
Vm 12,12,22
Vm 13,13,22
Vm 14,14,22
Vm 15,15,22
Aw 96,8
Aw 97,9
Aw 98,10
Aw 99,11
Aw 100,12
Aw 101,13
Aw 102,14
Aw 103,15
Ar 8,104
Ar 9,105
Ar 10,106
Ar 11,107
Ar 12,108
Ar 13,109
Ar 14,110
Ar 15,111
Vm 8,8,22
Vm 9,9,22
Vm 10,10,22
Vm 11,11,22
Vm 12,12,22
Vm 13,13,22
Vm 14,14,22
Vm 15,15,22
Aw 104,8
Aw 105,9
Aw 106,10
Aw 107,11
Aw 108,12
Aw 109,13
Aw 110,14
Aw 111,15
Ar 8,112
Ar 9,113
Ar 10,114
Ar 11,115
Ar 12,116
Ar 13,117
Ar 14,118
Ar 15,119
Vm 8,8,22
Vm 9,9,22
Vm 10,10,22
Vm 11,11,22
Vm 12,12,22
Vm 13,13,22
Vm 14,14,22
Vm 15,15,22
Aw 112,8
Aw 113,9
Aw 114,10
Aw 115,11
Aw 116,12
Aw 117,13
Aw 118,14
Aw 119,15
Ar 8,120
Ar 9,121
Ar 10,122
Ar 11,123
Ar 12,124
Ar 13,125
Ar 14,126
Ar 15,127
Vm 8,8,22
Vm 9,9,22
Vm 10,10,22
Vm 11,11,22
Vm 12,12,22
Vm 13,13,22
Vm 14,14,22
Vm 15,15,22
Aw 120,8
Aw 121,9
Aw 122,10
Aw 123,11
Aw 124,12
Aw 125,13
Aw 126,14
Aw 127,15
Ve 8,192
Ve 9,193
s_nop 0
Vc 96,8,9
Ve 8,194
Ve 9,195
s_nop 0
Vc 97,8,9
Ve 8,208
Ve 9,209
s_nop 0
Vc 104,8,9
Ve 8,210
Ve 9,211
s_nop 0
Vc 105,8,9
Ve 8,224
Ve 9,225
s_nop 0
Vc 112,8,9
Ve 8,226
Ve 9,227
s_nop 0
Vc 113,8,9
Ve 8,240
Ve 9,241
s_nop 0
Vc 120,8,9
Ve 8,242
Ve 9,243
s_nop 0
Vc 121,8,9
Ve 8,196
Ve 9,197
s_nop 0
Vc 98,8,9
Ve 8,198
Ve 9,199
s_nop 0
Vc 99,8,9
Ve 8,212
Ve 9,213
s_nop 0
Vc 106,8,9
Ve 8,214
Ve 9,215
s_nop 0
Vc 107,8,9
Ve 8,228
Ve 9,229
s_nop 0
Vc 114,8,9
Ve 8,230
Ve 9,231
s_nop 0
Vc 115,8,9
Ve 8,244
Ve 9,245
s_nop 0
Vc 122,8,9
Ve 8,246
Ve 9,247
s_nop 0
Vc 123,8,9
Ve 8,200
Ve 9,201
s_nop 0
Vc 100,8,9
Ve 8,202
Ve 9,203
s_nop 0
Vc 101,8,9
Ve 8,216
Ve 9,217
s_nop 0
Vc 108,8,9
Ve 8,218
Ve 9,219
s_nop 0
Vc 109,8,9
Ve 8,232
Ve 9,233
s_nop 0
Vc 116,8,9
Ve 8,234
Ve 9,235
s_nop 0
Vc 117,8,9
Ve 8,248
Ve 9,249
s_nop 0
Vc 124,8,9
Ve 8,250
Ve 9,251
s_nop 0
Vc 125,8,9
Ve 8,204
Ve 9,205
s_nop 0
Vc 102,8,9
Ve 8,206
Ve 9,207
s_nop 0
Vc 103,8,9
Ve 8,220
Ve 9,221
s_nop 0
Vc 110,8,9
Ve 8,222
Ve 9,223
s_nop 0
Vc 111,8,9
Ve 8,236
Ve 9,237
s_nop 0
Vc 118,8,9
Ve 8,238
Ve 9,239
s_nop 0
Vc 119,8,9
Ve 8,252
Ve 9,253
s_nop 0
Vc 126,8,9
Ve 8,254
Ve 9,255
s_nop 0
Vc 127,8,9
s_nop 1
s_branch L_k2_fbr_wo
L_k2_fb_wl:
s_nop 7
s_nop 0
v_max3_f32 v21, v128, v129, v130
v_max3_f32 v21, v21, v131, v132
v_max3_f32 v21, v21, v133, v134
v_max3_f32 v21, v21, v135, v136
v_max3_f32 v21, v21, v137, v138
v_max3_f32 v21, v21, v139, v140
v_max3_f32 v21, v21, v141, v142
v_max_f32 v21, v21, v143
v_mov_b32 v1, v21
s_nop 1
v_permlane16_swap_b32 v1, v21
v_max_f32 v21, v21, v1
v_mov_b32 v1, v21
s_nop 1
v_permlane32_swap_b32 v1, v21
v_max_f32_e64 v21, v21, v1
v_add_f32 v21, 0x41f80000, v21
v_max_f32 v21, 0, v21
Vs 128,128,21
Vs 129,129,21
Vs 130,130,21
Vs 131,131,21
Vs 132,132,21
Vs 133,133,21
Vs 134,134,21
Vs 135,135,21
Vs 136,136,21
Vs 137,137,21
Vs 138,138,21
Vs 139,139,21
Vs 140,140,21
Vs 141,141,21
Vs 142,142,21
Vs 143,143,21
Vs 192,192,21
Vs 193,193,21
Vs 194,194,21
Vs 195,195,21
Vs 196,196,21
Vs 197,197,21
Vs 198,198,21
Vs 199,199,21
Vs 200,200,21
Vs 201,201,21
Vs 202,202,21
Vs 203,203,21
Vs 204,204,21
Vs 205,205,21
Vs 206,206,21
Vs 207,207,21
Vs 32,32,21
Vs 33,33,21
Vs 34,34,21
v_sub_f32_e64 v35, v35, v21
v_exp_f32 v22, -v21
s_nop 0
Vm 48,48,22
Vm 49,49,22
Vm 50,50,22
v_mul_f32_e64 v51, v51, v22
Ar 8,0
Ar 9,1
Ar 10,2
Ar 11,3
Ar 12,4
Ar 13,5
Ar 14,6
Ar 15,7
Vm 8,8,22
Vm 9,9,22
Vm 10,10,22
Vm 11,11,22
Vm 12,12,22
Vm 13,13,22
Vm 14,14,22
Vm 15,15,22
Aw 0,8
Aw 1,9
Aw 2,10
Aw 3,11
Aw 4,12
Aw 5,13
Aw 6,14
Aw 7,15
Ar 8,8
Ar 9,9
Ar 10,10
Ar 11,11
Ar 12,12
Ar 13,13
Ar 14,14
Ar 15,15
Vm 8,8,22
Vm 9,9,22
Vm 10,10,22
Vm 11,11,22
Vm 12,12,22
Vm 13,13,22
Vm 14,14,22
Vm 15,15,22
Aw 8,8
Aw 9,9
Aw 10,10
Aw 11,11
Aw 12,12
Aw 13,13
Aw 14,14
Aw 15,15
Ar 8,16
Ar 9,17
Ar 10,18
Ar 11,19
Ar 12,20
Ar 13,21
Ar 14,22
Ar 15,23
Vm 8,8,22
Vm 9,9,22
Vm 10,10,22
Vm 11,11,22
Vm 12,12,22
Vm 13,13,22
Vm 14,14,22
Vm 15,15,22
Aw 16,8
Aw 17,9
Aw 18,10
Aw 19,11
Aw 20,12
Aw 21,13
Aw 22,14
Aw 23,15
Ar 8,24
Ar 9,25
Ar 10,26
Ar 11,27
Ar 12,28
Ar 13,29
Ar 14,30
Ar 15,31
Vm 8,8,22
Vm 9,9,22
Vm 10,10,22
Vm 11,11,22
Vm 12,12,22
Vm 13,13,22
Vm 14,14,22
Vm 15,15,22
Aw 24,8
Aw 25,9
Aw 26,10
Aw 27,11
Aw 28,12
Aw 29,13
Aw 30,14
Aw 31,15
v_max3_f32 v21, v144, v145, v146
v_max3_f32 v21, v21, v147, v148
v_max3_f32 v21, v21, v149, v150
v_max3_f32 v21, v21, v151, v152
v_max3_f32 v21, v21, v153, v154
v_max3_f32 v21, v21, v155, v156
v_max3_f32 v21, v21, v157, v158
v_max_f32 v21, v21, v159
v_mov_b32 v1, v21
s_nop 1
v_permlane16_swap_b32 v1, v21
v_max_f32 v21, v21, v1
v_mov_b32 v1, v21
s_nop 1
v_permlane32_swap_b32 v1, v21
v_max_f32_e64 v21, v21, v1
v_add_f32 v21, 0x41f80000, v21
v_max_f32 v21, 0, v21
Vs 144,144,21
Vs 145,145,21
Vs 146,146,21
Vs 147,147,21
Vs 148,148,21
Vs 149,149,21
Vs 150,150,21
Vs 151,151,21
Vs 152,152,21
Vs 153,153,21
Vs 154,154,21
Vs 155,155,21
Vs 156,156,21
Vs 157,157,21
Vs 158,158,21
Vs 159,159,21
Vs 208,208,21
Vs 209,209,21
Vs 210,210,21
Vs 211,211,21
Vs 212,212,21
Vs 213,213,21
Vs 214,214,21
Vs 215,215,21
Vs 216,216,21
Vs 217,217,21
Vs 218,218,21
Vs 219,219,21
Vs 220,220,21
Vs 221,221,21
Vs 222,222,21
Vs 223,223,21
Vs 36,36,21
Vs 37,37,21
Vs 38,38,21
v_sub_f32_e64 v39, v39, v21
v_exp_f32 v22, -v21
s_nop 0
Vm 52,52,22
Vm 53,53,22
Vm 54,54,22
v_mul_f32_e64 v55, v55, v22
Ar 8,32
Ar 9,33
Ar 10,34
Ar 11,35
Ar 12,36
Ar 13,37
Ar 14,38
Ar 15,39
Vm 8,8,22
Vm 9,9,22
Vm 10,10,22
Vm 11,11,22
Vm 12,12,22
Vm 13,13,22
Vm 14,14,22
Vm 15,15,22
Aw 32,8
Aw 33,9
Aw 34,10
Aw 35,11
Aw 36,12
Aw 37,13
Aw 38,14
Aw 39,15
Ar 8,40
Ar 9,41
Ar 10,42
Ar 11,43
Ar 12,44
Ar 13,45
Ar 14,46
Ar 15,47
Vm 8,8,22
Vm 9,9,22
Vm 10,10,22
Vm 11,11,22
Vm 12,12,22
Vm 13,13,22
Vm 14,14,22
Vm 15,15,22
Aw 40,8
Aw 41,9
Aw 42,10
Aw 43,11
Aw 44,12
Aw 45,13
Aw 46,14
Aw 47,15
Ar 8,48
Ar 9,49
Ar 10,50
Ar 11,51
Ar 12,52
Ar 13,53
Ar 14,54
Ar 15,55
Vm 8,8,22
Vm 9,9,22
Vm 10,10,22
Vm 11,11,22
Vm 12,12,22
Vm 13,13,22
Vm 14,14,22
Vm 15,15,22
Aw 48,8
Aw 49,9
Aw 50,10
Aw 51,11
Aw 52,12
Aw 53,13
Aw 54,14
Aw 55,15
Ar 8,56
Ar 9,57
Ar 10,58
Ar 11,59
Ar 12,60
Ar 13,61
Ar 14,62
Ar 15,63
Vm 8,8,22
Vm 9,9,22
Vm 10,10,22
Vm 11,11,22
Vm 12,12,22
Vm 13,13,22
Vm 14,14,22
Vm 15,15,22
Aw 56,8
Aw 57,9
Aw 58,10
Aw 59,11
Aw 60,12
Aw 61,13
Aw 62,14
Aw 63,15
v_max3_f32 v21, v160, v161, v162
v_max3_f32 v21, v21, v163, v164
v_max3_f32 v21, v21, v165, v166
v_max3_f32 v21, v21, v167, v168
v_max3_f32 v21, v21, v169, v170
v_max3_f32 v21, v21, v171, v172
v_max3_f32 v21, v21, v173, v174
v_max_f32 v21, v21, v175
v_mov_b32 v1, v21
s_nop 1
v_permlane16_swap_b32 v1, v21
v_max_f32 v21, v21, v1
v_mov_b32 v1, v21
s_nop 1
v_permlane32_swap_b32 v1, v21
v_max_f32_e64 v21, v21, v1
v_add_f32 v21, 0x41f80000, v21
v_max_f32 v21, 0, v21
Vs 160,160,21
Vs 161,161,21
Vs 162,162,21
Vs 163,163,21
Vs 164,164,21
Vs 165,165,21
Vs 166,166,21
Vs 167,167,21
Vs 168,168,21
Vs 169,169,21
Vs 170,170,21
Vs 171,171,21
Vs 172,172,21
Vs 173,173,21
Vs 174,174,21
Vs 175,175,21
Vs 224,224,21
Vs 225,225,21
Vs 226,226,21
Vs 227,227,21
Vs 228,228,21
Vs 229,229,21
Vs 230,230,21
Vs 231,231,21
Vs 232,232,21
Vs 233,233,21
Vs 234,234,21
Vs 235,235,21
Vs 236,236,21
Vs 237,237,21
Vs 238,238,21
Vs 239,239,21
Vs 40,40,21
Vs 41,41,21
Vs 42,42,21
v_sub_f32_e64 v43, v43, v21
v_exp_f32 v22, -v21
s_nop 0
Vm 56,56,22
Vm 57,57,22
Vm 58,58,22
v_mul_f32_e64 v59, v59, v22
Ar 8,64
Ar 9,65
Ar 10,66
Ar 11,67
Ar 12,68
Ar 13,69
Ar 14,70
Ar 15,71
Vm 8,8,22
Vm 9,9,22
Vm 10,10,22
Vm 11,11,22
Vm 12,12,22
Vm 13,13,22
Vm 14,14,22
Vm 15,15,22
Aw 64,8
Aw 65,9
Aw 66,10
Aw 67,11
Aw 68,12
Aw 69,13
Aw 70,14
Aw 71,15
Ar 8,72
Ar 9,73
Ar 10,74
Ar 11,75
Ar 12,76
Ar 13,77
Ar 14,78
Ar 15,79
Vm 8,8,22
Vm 9,9,22
Vm 10,10,22
Vm 11,11,22
Vm 12,12,22
Vm 13,13,22
Vm 14,14,22
Vm 15,15,22
Aw 72,8
Aw 73,9
Aw 74,10
Aw 75,11
Aw 76,12
Aw 77,13
Aw 78,14
Aw 79,15
Ar 8,80
Ar 9,81
Ar 10,82
Ar 11,83
Ar 12,84
Ar 13,85
Ar 14,86
Ar 15,87
Vm 8,8,22
Vm 9,9,22
Vm 10,10,22
Vm 11,11,22
Vm 12,12,22
Vm 13,13,22
Vm 14,14,22
Vm 15,15,22
Aw 80,8
Aw 81,9
Aw 82,10
Aw 83,11
Aw 84,12
Aw 85,13
Aw 86,14
Aw 87,15
Ar 8,88
Ar 9,89
Ar 10,90
Ar 11,91
Ar 12,92
Ar 13,93
Ar 14,94
Ar 15,95
Vm 8,8,22
Vm 9,9,22
Vm 10,10,22
Vm 11,11,22
Vm 12,12,22
Vm 13,13,22
Vm 14,14,22
Vm 15,15,22
Aw 88,8
Aw 89,9
Aw 90,10
Aw 91,11
Aw 92,12
Aw 93,13
Aw 94,14
Aw 95,15
v_max3_f32 v21, v176, v177, v178
v_max3_f32 v21, v21, v179, v180
v_max3_f32 v21, v21, v181, v182
v_max3_f32 v21, v21, v183, v184
v_max3_f32 v21, v21, v185, v186
v_max3_f32 v21, v21, v187, v188
v_max3_f32 v21, v21, v189, v190
v_max_f32 v21, v21, v191
v_mov_b32 v1, v21
s_nop 1
v_permlane16_swap_b32 v1, v21
v_max_f32 v21, v21, v1
v_mov_b32 v1, v21
s_nop 1
v_permlane32_swap_b32 v1, v21
v_max_f32_e64 v21, v21, v1
v_add_f32 v21, 0x41f80000, v21
v_max_f32 v21, 0, v21
Vs 176,176,21
Vs 177,177,21
Vs 178,178,21
Vs 179,179,21
Vs 180,180,21
Vs 181,181,21
Vs 182,182,21
Vs 183,183,21
Vs 184,184,21
Vs 185,185,21
Vs 186,186,21
Vs 187,187,21
Vs 188,188,21
Vs 189,189,21
Vs 190,190,21
Vs 191,191,21
Vs 44,44,21
Vs 45,45,21
Vs 46,46,21
v_sub_f32_e64 v47, v47, v21
v_exp_f32 v22, -v21
s_nop 0
Vm 60,60,22
Vm 61,61,22
Vm 62,62,22
v_mul_f32_e64 v63, v63, v22
Ar 8,96
Ar 9,97
Ar 10,98
Ar 11,99
Ar 12,100
Ar 13,101
Ar 14,102
Ar 15,103
Vm 8,8,22
Vm 9,9,22
Vm 10,10,22
Vm 11,11,22
Vm 12,12,22
Vm 13,13,22
Vm 14,14,22
Vm 15,15,22
Aw 96,8
Aw 97,9
Aw 98,10
Aw 99,11
Aw 100,12
Aw 101,13
Aw 102,14
Aw 103,15
Ar 8,104
Ar 9,105
Ar 10,106
Ar 11,107
Ar 12,108
Ar 13,109
Ar 14,110
Ar 15,111
Vm 8,8,22
Vm 9,9,22
Vm 10,10,22
Vm 11,11,22
Vm 12,12,22
Vm 13,13,22
Vm 14,14,22
Vm 15,15,22
Aw 104,8
Aw 105,9
Aw 106,10
Aw 107,11
Aw 108,12
Aw 109,13
Aw 110,14
Aw 111,15
Ar 8,112
Ar 9,113
Ar 10,114
Ar 11,115
Ar 12,116
Ar 13,117
Ar 14,118
Ar 15,119
Vm 8,8,22
Vm 9,9,22
Vm 10,10,22
Vm 11,11,22
Vm 12,12,22
Vm 13,13,22
Vm 14,14,22
Vm 15,15,22
Aw 112,8
Aw 113,9
Aw 114,10
Aw 115,11
Aw 116,12
Aw 117,13
Aw 118,14
Aw 119,15
Ar 8,120
Ar 9,121
Ar 10,122
Ar 11,123
Ar 12,124
Ar 13,125
Ar 14,126
Ar 15,127
Vm 8,8,22
Vm 9,9,22
Vm 10,10,22
Vm 11,11,22
Vm 12,12,22
Vm 13,13,22
Vm 14,14,22
Vm 15,15,22
Aw 120,8
Aw 121,9
Aw 122,10
Aw 123,11
Aw 124,12
Aw 125,13
Aw 126,14
Aw 127,15
Ve 8,128
Ve 9,129
s_nop 0
Vc 64,8,9
Ve 8,130
Ve 9,131
s_nop 0
Vc 65,8,9
Ve 8,144
Ve 9,145
s_nop 0
Vc 72,8,9
Ve 8,146
Ve 9,147
s_nop 0
Vc 73,8,9
Ve 8,160
Ve 9,161
s_nop 0
Vc 80,8,9
Ve 8,162
Ve 9,163
s_nop 0
Vc 81,8,9
Ve 8,176
Ve 9,177
s_nop 0
Vc 88,8,9
Ve 8,178
Ve 9,179
s_nop 0
Vc 89,8,9
Ve 8,132
Ve 9,133
s_nop 0
Vc 66,8,9
Ve 8,134
Ve 9,135
s_nop 0
Vc 67,8,9
Ve 8,148
Ve 9,149
s_nop 0
Vc 74,8,9
Ve 8,150
Ve 9,151
s_nop 0
Vc 75,8,9
Ve 8,164
Ve 9,165
s_nop 0
Vc 82,8,9
Ve 8,166
Ve 9,167
s_nop 0
Vc 83,8,9
Ve 8,180
Ve 9,181
s_nop 0
Vc 90,8,9
Ve 8,182
Ve 9,183
s_nop 0
Vc 91,8,9
Ve 8,136
Ve 9,137
s_nop 0
Vc 68,8,9
Ve 8,138
Ve 9,139
s_nop 0
Vc 69,8,9
Ve 8,152
Ve 9,153
s_nop 0
Vc 76,8,9
Ve 8,154
Ve 9,155
s_nop 0
Vc 77,8,9
Ve 8,168
Ve 9,169
s_nop 0
Vc 84,8,9
Ve 8,170
Ve 9,171
s_nop 0
Vc 85,8,9
Ve 8,184
Ve 9,185
s_nop 0
Vc 92,8,9
Ve 8,186
Ve 9,187
s_nop 0
Vc 93,8,9
Ve 8,140
Ve 9,141
s_nop 0
Vc 70,8,9
Ve 8,142
Ve 9,143
s_nop 0
Vc 71,8,9
Ve 8,156
Ve 9,157
s_nop 0
Vc 78,8,9
Ve 8,158
Ve 9,159
s_nop 0
Vc 79,8,9
Ve 8,172
Ve 9,173
s_nop 0
Vc 86,8,9
Ve 8,174
Ve 9,175
s_nop 0
Vc 87,8,9
Ve 8,188
Ve 9,189
s_nop 0
Vc 94,8,9
Ve 8,190
Ve 9,191
s_nop 0
Vc 95,8,9
s_nop 1
s_branch L_k2_fbr_wl
L_k2_fb_tr:
s_nop 7
s_nop 0
v_max3_f32 v21, v192, v193, v194
v_max3_f32 v21, v21, v195, v196
v_max3_f32 v21, v21, v197, v198
v_max3_f32 v21, v21, v199, v200
v_max3_f32 v21, v21, v201, v202
v_max3_f32 v21, v21, v203, v204
v_max3_f32 v21, v21, v205, v206
v_max_f32 v21, v21, v207
v_mov_b32 v1, v21
s_nop 1
v_permlane16_swap_b32 v1, v21
v_max_f32 v21, v21, v1
v_mov_b32 v1, v21
s_nop 1
v_permlane32_swap_b32 v1, v21
v_max_f32_e64 v21, v21, v1
v_add_f32 v21, 0x41f80000, v21
v_max_f32 v21, 0, v21
Vs 192,192,21
Vs 193,193,21
Vs 194,194,21
Vs 195,195,21
Vs 196,196,21
Vs 197,197,21
Vs 198,198,21
Vs 199,199,21
Vs 200,200,21
Vs 201,201,21
Vs 202,202,21
Vs 203,203,21
Vs 204,204,21
Vs 205,205,21
Vs 206,206,21
Vs 207,207,21
Vs 128,128,21
Vs 129,129,21
Vs 130,130,21
Vs 131,131,21
Vs 132,132,21
Vs 133,133,21
Vs 134,134,21
Vs 135,135,21
Vs 136,136,21
Vs 137,137,21
Vs 138,138,21
Vs 139,139,21
Vs 140,140,21
Vs 141,141,21
Vs 142,142,21
Vs 143,143,21
Vs 32,32,21
Vs 33,33,21
Vs 34,34,21
v_sub_f32_e64 v35, v35, v21
v_exp_f32 v22, -v21
s_nop 0
Vm 48,48,22
Vm 49,49,22
Vm 50,50,22
v_mul_f32_e64 v51, v51, v22
Ar 8,0
Ar 9,1
Ar 10,2
Ar 11,3
Ar 12,4
Ar 13,5
Ar 14,6
Ar 15,7
Vm 8,8,22
Vm 9,9,22
Vm 10,10,22
Vm 11,11,22
Vm 12,12,22
Vm 13,13,22
Vm 14,14,22
Vm 15,15,22
Aw 0,8
Aw 1,9
Aw 2,10
Aw 3,11
Aw 4,12
Aw 5,13
Aw 6,14
Aw 7,15
Ar 8,8
Ar 9,9
Ar 10,10
Ar 11,11
Ar 12,12
Ar 13,13
Ar 14,14
Ar 15,15
Vm 8,8,22
Vm 9,9,22
Vm 10,10,22
Vm 11,11,22
Vm 12,12,22
Vm 13,13,22
Vm 14,14,22
Vm 15,15,22
Aw 8,8
Aw 9,9
Aw 10,10
Aw 11,11
Aw 12,12
Aw 13,13
Aw 14,14
Aw 15,15
Ar 8,16
Ar 9,17
Ar 10,18
Ar 11,19
Ar 12,20
Ar 13,21
Ar 14,22
Ar 15,23
Vm 8,8,22
Vm 9,9,22
Vm 10,10,22
Vm 11,11,22
Vm 12,12,22
Vm 13,13,22
Vm 14,14,22
Vm 15,15,22
Aw 16,8
Aw 17,9
Aw 18,10
Aw 19,11
Aw 20,12
Aw 21,13
Aw 22,14
Aw 23,15
Ar 8,24
Ar 9,25
Ar 10,26
Ar 11,27
Ar 12,28
Ar 13,29
Ar 14,30
Ar 15,31
Vm 8,8,22
Vm 9,9,22
Vm 10,10,22
Vm 11,11,22
Vm 12,12,22
Vm 13,13,22
Vm 14,14,22
Vm 15,15,22
Aw 24,8
Aw 25,9
Aw 26,10
Aw 27,11
Aw 28,12
Aw 29,13
Aw 30,14
Aw 31,15
v_max3_f32 v21, v208, v209, v210
v_max3_f32 v21, v21, v211, v212
v_max3_f32 v21, v21, v213, v214
v_max3_f32 v21, v21, v215, v216
v_max3_f32 v21, v21, v217, v218
v_max3_f32 v21, v21, v219, v220
v_max3_f32 v21, v21, v221, v222
v_max_f32 v21, v21, v223
v_mov_b32 v1, v21
s_nop 1
v_permlane16_swap_b32 v1, v21
v_max_f32 v21, v21, v1
v_mov_b32 v1, v21
s_nop 1
v_permlane32_swap_b32 v1, v21
v_max_f32_e64 v21, v21, v1
v_add_f32 v21, 0x41f80000, v21
v_max_f32 v21, 0, v21
Vs 208,208,21
Vs 209,209,21
Vs 210,210,21
Vs 211,211,21
Vs 212,212,21
Vs 213,213,21
Vs 214,214,21
Vs 215,215,21
Vs 216,216,21
Vs 217,217,21
Vs 218,218,21
Vs 219,219,21
Vs 220,220,21
Vs 221,221,21
Vs 222,222,21
Vs 223,223,21
Vs 144,144,21
Vs 145,145,21
Vs 146,146,21
Vs 147,147,21
Vs 148,148,21
Vs 149,149,21
Vs 150,150,21
Vs 151,151,21
Vs 152,152,21
Vs 153,153,21
Vs 154,154,21
Vs 155,155,21
Vs 156,156,21
Vs 157,157,21
Vs 158,158,21
Vs 159,159,21
Vs 36,36,21
Vs 37,37,21
Vs 38,38,21
v_sub_f32_e64 v39, v39, v21
v_exp_f32 v22, -v21
s_nop 0
Vm 52,52,22
Vm 53,53,22
Vm 54,54,22
v_mul_f32_e64 v55, v55, v22
Ar 8,32
Ar 9,33
Ar 10,34
Ar 11,35
Ar 12,36
Ar 13,37
Ar 14,38
Ar 15,39
Vm 8,8,22
Vm 9,9,22
Vm 10,10,22
Vm 11,11,22
Vm 12,12,22
Vm 13,13,22
Vm 14,14,22
Vm 15,15,22
Aw 32,8
Aw 33,9
Aw 34,10
Aw 35,11
Aw 36,12
Aw 37,13
Aw 38,14
Aw 39,15
Ar 8,40
Ar 9,41
Ar 10,42
Ar 11,43
Ar 12,44
Ar 13,45
Ar 14,46
Ar 15,47
Vm 8,8,22
Vm 9,9,22
Vm 10,10,22
Vm 11,11,22
Vm 12,12,22
Vm 13,13,22
Vm 14,14,22
Vm 15,15,22
Aw 40,8
Aw 41,9
Aw 42,10
Aw 43,11
Aw 44,12
Aw 45,13
Aw 46,14
Aw 47,15
Ar 8,48
Ar 9,49
Ar 10,50
Ar 11,51
Ar 12,52
Ar 13,53
Ar 14,54
Ar 15,55
Vm 8,8,22
Vm 9,9,22
Vm 10,10,22
Vm 11,11,22
Vm 12,12,22
Vm 13,13,22
Vm 14,14,22
Vm 15,15,22
Aw 48,8
Aw 49,9
Aw 50,10
Aw 51,11
Aw 52,12
Aw 53,13
Aw 54,14
Aw 55,15
Ar 8,56
Ar 9,57
Ar 10,58
Ar 11,59
Ar 12,60
Ar 13,61
Ar 14,62
Ar 15,63
Vm 8,8,22
Vm 9,9,22
Vm 10,10,22
Vm 11,11,22
Vm 12,12,22
Vm 13,13,22
Vm 14,14,22
Vm 15,15,22
Aw 56,8
Aw 57,9
Aw 58,10
Aw 59,11
Aw 60,12
Aw 61,13
Aw 62,14
Aw 63,15
v_max3_f32 v21, v224, v225, v226
v_max3_f32 v21, v21, v227, v228
v_max3_f32 v21, v21, v229, v230
v_max3_f32 v21, v21, v231, v232
v_max3_f32 v21, v21, v233, v234
v_max3_f32 v21, v21, v235, v236
v_max3_f32 v21, v21, v237, v238
v_max_f32 v21, v21, v239
v_mov_b32 v1, v21
s_nop 1
v_permlane16_swap_b32 v1, v21
v_max_f32 v21, v21, v1
v_mov_b32 v1, v21
s_nop 1
v_permlane32_swap_b32 v1, v21
v_max_f32_e64 v21, v21, v1
v_add_f32 v21, 0x41f80000, v21
v_max_f32 v21, 0, v21
Vs 224,224,21
Vs 225,225,21
Vs 226,226,21
Vs 227,227,21
Vs 228,228,21
Vs 229,229,21
Vs 230,230,21
Vs 231,231,21
Vs 232,232,21
Vs 233,233,21
Vs 234,234,21
Vs 235,235,21
Vs 236,236,21
Vs 237,237,21
Vs 238,238,21
Vs 239,239,21
Vs 40,40,21
Vs 41,41,21
Vs 42,42,21
v_sub_f32_e64 v43, v43, v21
v_exp_f32 v22, -v21
s_nop 0
Vm 56,56,22
Vm 57,57,22
Vm 58,58,22
v_mul_f32_e64 v59, v59, v22
Ar 8,64
Ar 9,65
Ar 10,66
Ar 11,67
Ar 12,68
Ar 13,69
Ar 14,70
Ar 15,71
Vm 8,8,22
Vm 9,9,22
Vm 10,10,22
Vm 11,11,22
Vm 12,12,22
Vm 13,13,22
Vm 14,14,22
Vm 15,15,22
Aw 64,8
Aw 65,9
Aw 66,10
Aw 67,11
Aw 68,12
Aw 69,13
Aw 70,14
Aw 71,15
Ar 8,72
Ar 9,73
Ar 10,74
Ar 11,75
Ar 12,76
Ar 13,77
Ar 14,78
Ar 15,79
Vm 8,8,22
Vm 9,9,22
Vm 10,10,22
Vm 11,11,22
Vm 12,12,22
Vm 13,13,22
Vm 14,14,22
Vm 15,15,22
Aw 72,8
Aw 73,9
Aw 74,10
Aw 75,11
Aw 76,12
Aw 77,13
Aw 78,14
Aw 79,15
Ar 8,80
Ar 9,81
Ar 10,82
Ar 11,83
Ar 12,84
Ar 13,85
Ar 14,86
Ar 15,87
Vm 8,8,22
Vm 9,9,22
Vm 10,10,22
Vm 11,11,22
Vm 12,12,22
Vm 13,13,22
Vm 14,14,22
Vm 15,15,22
Aw 80,8
Aw 81,9
Aw 82,10
Aw 83,11
Aw 84,12
Aw 85,13
Aw 86,14
Aw 87,15
Ar 8,88
Ar 9,89
Ar 10,90
Ar 11,91
Ar 12,92
Ar 13,93
Ar 14,94
Ar 15,95
Vm 8,8,22
Vm 9,9,22
Vm 10,10,22
Vm 11,11,22
Vm 12,12,22
Vm 13,13,22
Vm 14,14,22
Vm 15,15,22
Aw 88,8
Aw 89,9
Aw 90,10
Aw 91,11
Aw 92,12
Aw 93,13
Aw 94,14
Aw 95,15
Ve 8,192
Ve 9,193
s_nop 0
Vc 96,8,9
Ve 8,194
Ve 9,195
s_nop 0
Vc 97,8,9
Ve 8,208
Ve 9,209
s_nop 0
Vc 104,8,9
Ve 8,210
Ve 9,211
s_nop 0
Vc 105,8,9
Ve 8,224
Ve 9,225
s_nop 0
Vc 112,8,9
Ve 8,226
Ve 9,227
s_nop 0
Vc 113,8,9
Ve 8,196
Ve 9,197
s_nop 0
Vc 98,8,9
Ve 8,198
Ve 9,199
s_nop 0
Vc 99,8,9
Ve 8,212
Ve 9,213
s_nop 0
Vc 106,8,9
Ve 8,214
Ve 9,215
s_nop 0
Vc 107,8,9
Ve 8,228
Ve 9,229
s_nop 0
Vc 114,8,9
Ve 8,230
Ve 9,231
s_nop 0
Vc 115,8,9
Ve 8,200
Ve 9,201
s_nop 0
Vc 100,8,9
Ve 8,202
Ve 9,203
s_nop 0
Vc 101,8,9
Ve 8,216
Ve 9,217
s_nop 0
Vc 108,8,9
Ve 8,218
Ve 9,219
s_nop 0
Vc 109,8,9
Ve 8,232
Ve 9,233
s_nop 0
Vc 116,8,9
Ve 8,234
Ve 9,235
s_nop 0
Vc 117,8,9
Ve 8,204
Ve 9,205
s_nop 0
Vc 102,8,9
Ve 8,206
Ve 9,207
s_nop 0
Vc 103,8,9
Ve 8,220
Ve 9,221
s_nop 0
Vc 110,8,9
Ve 8,222
Ve 9,223
s_nop 0
Vc 111,8,9
Ve 8,236
Ve 9,237
s_nop 0
Vc 118,8,9
Ve 8,238
Ve 9,239
s_nop 0
Vc 119,8,9
s_nop 1
s_branch L_k2_fbr_tr
L_k2_fb_ne:
s_nop 7
s_nop 0
v_max3_f32 v21, v128, v129, v130
v_max3_f32 v21, v21, v131, v132
v_max3_f32 v21, v21, v133, v134
v_max3_f32 v21, v21, v135, v136
v_max3_f32 v21, v21, v137, v138
v_max3_f32 v21, v21, v139, v140
v_max3_f32 v21, v21, v141, v142
v_max_f32 v21, v21, v143
v_mov_b32 v1, v21
s_nop 1
v_permlane16_swap_b32 v1, v21
v_max_f32 v21, v21, v1
v_mov_b32 v1, v21
s_nop 1
v_permlane32_swap_b32 v1, v21
v_max_f32_e64 v21, v21, v1
v_add_f32 v21, 0x41f80000, v21
v_max_f32 v21, 0, v21
Vs 128,128,21
Vs 129,129,21
Vs 130,130,21
Vs 131,131,21
Vs 132,132,21
Vs 133,133,21
Vs 134,134,21
Vs 135,135,21
Vs 136,136,21
Vs 137,137,21
Vs 138,138,21
Vs 139,139,21
Vs 140,140,21
Vs 141,141,21
Vs 142,142,21
Vs 143,143,21
Vs 192,192,21
Vs 193,193,21
Vs 194,194,21
Vs 195,195,21
Vs 196,196,21
Vs 197,197,21
Vs 198,198,21
Vs 199,199,21
Vs 200,200,21
Vs 201,201,21
Vs 202,202,21
Vs 203,203,21
Vs 204,204,21
Vs 205,205,21
Vs 206,206,21
Vs 207,207,21
Vs 32,32,21
Vs 33,33,21
Vs 34,34,21
v_sub_f32_e64 v35, v35, v21
v_exp_f32 v22, -v21
s_nop 0
Vm 48,48,22
Vm 49,49,22
Vm 50,50,22
v_mul_f32_e64 v51, v51, v22
Ar 8,0
Ar 9,1
Ar 10,2
Ar 11,3
Ar 12,4
Ar 13,5
Ar 14,6
Ar 15,7
Vm 8,8,22
Vm 9,9,22
Vm 10,10,22
Vm 11,11,22
Vm 12,12,22
Vm 13,13,22
Vm 14,14,22
Vm 15,15,22
Aw 0,8
Aw 1,9
Aw 2,10
Aw 3,11
Aw 4,12
Aw 5,13
Aw 6,14
Aw 7,15
Ar 8,8
Ar 9,9
Ar 10,10
Ar 11,11
Ar 12,12
Ar 13,13
Ar 14,14
Ar 15,15
Vm 8,8,22
Vm 9,9,22
Vm 10,10,22
Vm 11,11,22
Vm 12,12,22
Vm 13,13,22
Vm 14,14,22
Vm 15,15,22
Aw 8,8
Aw 9,9
Aw 10,10
Aw 11,11
Aw 12,12
Aw 13,13
Aw 14,14
Aw 15,15
Ar 8,16
Ar 9,17
Ar 10,18
Ar 11,19
Ar 12,20
Ar 13,21
Ar 14,22
Ar 15,23
Vm 8,8,22
Vm 9,9,22
Vm 10,10,22
Vm 11,11,22
Vm 12,12,22
Vm 13,13,22
Vm 14,14,22
Vm 15,15,22
Aw 16,8
Aw 17,9
Aw 18,10
Aw 19,11
Aw 20,12
Aw 21,13
Aw 22,14
Aw 23,15
Ar 8,24
Ar 9,25
Ar 10,26
Ar 11,27
Ar 12,28
Ar 13,29
Ar 14,30
Ar 15,31
Vm 8,8,22
Vm 9,9,22
Vm 10,10,22
Vm 11,11,22
Vm 12,12,22
Vm 13,13,22
Vm 14,14,22
Vm 15,15,22
Aw 24,8
Aw 25,9
Aw 26,10
Aw 27,11
Aw 28,12
Aw 29,13
Aw 30,14
Aw 31,15
v_max3_f32 v21, v144, v145, v146
v_max3_f32 v21, v21, v147, v148
v_max3_f32 v21, v21, v149, v150
v_max3_f32 v21, v21, v151, v152
v_max3_f32 v21, v21, v153, v154
v_max3_f32 v21, v21, v155, v156
v_max3_f32 v21, v21, v157, v158
v_max_f32 v21, v21, v159
v_mov_b32 v1, v21
s_nop 1
v_permlane16_swap_b32 v1, v21
v_max_f32 v21, v21, v1
v_mov_b32 v1, v21
s_nop 1
v_permlane32_swap_b32 v1, v21
v_max_f32_e64 v21, v21, v1
v_add_f32 v21, 0x41f80000, v21
v_max_f32 v21, 0, v21
Vs 144,144,21
Vs 145,145,21
Vs 146,146,21
Vs 147,147,21
Vs 148,148,21
Vs 149,149,21
Vs 150,150,21
Vs 151,151,21
Vs 152,152,21
Vs 153,153,21
Vs 154,154,21
Vs 155,155,21
Vs 156,156,21
Vs 157,157,21
Vs 158,158,21
Vs 159,159,21
Vs 208,208,21
Vs 209,209,21
Vs 210,210,21
Vs 211,211,21
Vs 212,212,21
Vs 213,213,21
Vs 214,214,21
Vs 215,215,21
Vs 216,216,21
Vs 217,217,21
Vs 218,218,21
Vs 219,219,21
Vs 220,220,21
Vs 221,221,21
Vs 222,222,21
Vs 223,223,21
Vs 36,36,21
Vs 37,37,21
Vs 38,38,21
v_sub_f32_e64 v39, v39, v21
v_exp_f32 v22, -v21
s_nop 0
Vm 52,52,22
Vm 53,53,22
Vm 54,54,22
v_mul_f32_e64 v55, v55, v22
Ar 8,32
Ar 9,33
Ar 10,34
Ar 11,35
Ar 12,36
Ar 13,37
Ar 14,38
Ar 15,39
Vm 8,8,22
Vm 9,9,22
Vm 10,10,22
Vm 11,11,22
Vm 12,12,22
Vm 13,13,22
Vm 14,14,22
Vm 15,15,22
Aw 32,8
Aw 33,9
Aw 34,10
Aw 35,11
Aw 36,12
Aw 37,13
Aw 38,14
Aw 39,15
Ar 8,40
Ar 9,41
Ar 10,42
Ar 11,43
Ar 12,44
Ar 13,45
Ar 14,46
Ar 15,47
Vm 8,8,22
Vm 9,9,22
Vm 10,10,22
Vm 11,11,22
Vm 12,12,22
Vm 13,13,22
Vm 14,14,22
Vm 15,15,22
Aw 40,8
Aw 41,9
Aw 42,10
Aw 43,11
Aw 44,12
Aw 45,13
Aw 46,14
Aw 47,15
Ar 8,48
Ar 9,49
Ar 10,50
Ar 11,51
Ar 12,52
Ar 13,53
Ar 14,54
Ar 15,55
Vm 8,8,22
Vm 9,9,22
Vm 10,10,22
Vm 11,11,22
Vm 12,12,22
Vm 13,13,22
Vm 14,14,22
Vm 15,15,22
Aw 48,8
Aw 49,9
Aw 50,10
Aw 51,11
Aw 52,12
Aw 53,13
Aw 54,14
Aw 55,15
Ar 8,56
Ar 9,57
Ar 10,58
Ar 11,59
Ar 12,60
Ar 13,61
Ar 14,62
Ar 15,63
Vm 8,8,22
Vm 9,9,22
Vm 10,10,22
Vm 11,11,22
Vm 12,12,22
Vm 13,13,22
Vm 14,14,22
Vm 15,15,22
Aw 56,8
Aw 57,9
Aw 58,10
Aw 59,11
Aw 60,12
Aw 61,13
Aw 62,14
Aw 63,15
Ve 8,128
Ve 9,129
s_nop 0
Vc 64,8,9
Ve 8,130
Ve 9,131
s_nop 0
Vc 65,8,9
Ve 8,144
Ve 9,145
s_nop 0
Vc 72,8,9
Ve 8,146
Ve 9,147
s_nop 0
Vc 73,8,9
Ve 8,132
Ve 9,133
s_nop 0
Vc 66,8,9
Ve 8,134
Ve 9,135
s_nop 0
Vc 67,8,9
Ve 8,148
Ve 9,149
s_nop 0
Vc 74,8,9
Ve 8,150
Ve 9,151
s_nop 0
Vc 75,8,9
Ve 8,136
Ve 9,137
s_nop 0
Vc 68,8,9
Ve 8,138
Ve 9,139
s_nop 0
Vc 69,8,9
Ve 8,152
Ve 9,153
s_nop 0
Vc 76,8,9
Ve 8,154
Ve 9,155
s_nop 0
Vc 77,8,9
Ve 8,140
Ve 9,141
s_nop 0
Vc 70,8,9
Ve 8,142
Ve 9,143
s_nop 0
Vc 71,8,9
Ve 8,156
Ve 9,157
s_nop 0
Vc 78,8,9
Ve 8,158
Ve 9,159
s_nop 0
Vc 79,8,9
s_nop 1
s_branch L_k2_fbr_ne
L_k2_fb_no:
s_nop 7
s_nop 0
v_max3_f32 v21, v192, v193, v194
v_max3_f32 v21, v21, v195, v196
v_max3_f32 v21, v21, v197, v198
v_max3_f32 v21, v21, v199, v200
v_max3_f32 v21, v21, v201, v202
v_max3_f32 v21, v21, v203, v204
v_max3_f32 v21, v21, v205, v206
v_max_f32 v21, v21, v207
v_mov_b32 v1, v21
s_nop 1
v_permlane16_swap_b32 v1, v21
v_max_f32 v21, v21, v1
v_mov_b32 v1, v21
s_nop 1
v_permlane32_swap_b32 v1, v21
v_max_f32_e64 v21, v21, v1
v_add_f32 v21, 0x41f80000, v21
v_max_f32 v21, 0, v21
Vs 192,192,21
Vs 193,193,21
Vs 194,194,21
Vs 195,195,21
Vs 196,196,21
Vs 197,197,21
Vs 198,198,21
Vs 199,199,21
Vs 200,200,21
Vs 201,201,21
Vs 202,202,21
Vs 203,203,21
Vs 204,204,21
Vs 205,205,21
Vs 206,206,21
Vs 207,207,21
Vs 128,128,21
Vs 129,129,21
Vs 130,130,21
Vs 131,131,21
Vs 132,132,21
Vs 133,133,21
Vs 134,134,21
Vs 135,135,21
Vs 136,136,21
Vs 137,137,21
Vs 138,138,21
Vs 139,139,21
Vs 140,140,21
Vs 141,141,21
Vs 142,142,21
Vs 143,143,21
Vs 32,32,21
Vs 33,33,21
Vs 34,34,21
v_sub_f32_e64 v35, v35, v21
v_exp_f32 v22, -v21
s_nop 0
Vm 48,48,22
Vm 49,49,22
Vm 50,50,22
v_mul_f32_e64 v51, v51, v22
Ar 8,0
Ar 9,1
Ar 10,2
Ar 11,3
Ar 12,4
Ar 13,5
Ar 14,6
Ar 15,7
Vm 8,8,22
Vm 9,9,22
Vm 10,10,22
Vm 11,11,22
Vm 12,12,22
Vm 13,13,22
Vm 14,14,22
Vm 15,15,22
Aw 0,8
Aw 1,9
Aw 2,10
Aw 3,11
Aw 4,12
Aw 5,13
Aw 6,14
Aw 7,15
Ar 8,8
Ar 9,9
Ar 10,10
Ar 11,11
Ar 12,12
Ar 13,13
Ar 14,14
Ar 15,15
Vm 8,8,22
Vm 9,9,22
Vm 10,10,22
Vm 11,11,22
Vm 12,12,22
Vm 13,13,22
Vm 14,14,22
Vm 15,15,22
Aw 8,8
Aw 9,9
Aw 10,10
Aw 11,11
Aw 12,12
Aw 13,13
Aw 14,14
Aw 15,15
Ar 8,16
Ar 9,17
Ar 10,18
Ar 11,19
Ar 12,20
Ar 13,21
Ar 14,22
Ar 15,23
Vm 8,8,22
Vm 9,9,22
Vm 10,10,22
Vm 11,11,22
Vm 12,12,22
Vm 13,13,22
Vm 14,14,22
Vm 15,15,22
Aw 16,8
Aw 17,9
Aw 18,10
Aw 19,11
Aw 20,12
Aw 21,13
Aw 22,14
Aw 23,15
Ar 8,24
Ar 9,25
Ar 10,26
Ar 11,27
Ar 12,28
Ar 13,29
Ar 14,30
Ar 15,31
Vm 8,8,22
Vm 9,9,22
Vm 10,10,22
Vm 11,11,22
Vm 12,12,22
Vm 13,13,22
Vm 14,14,22
Vm 15,15,22
Aw 24,8
Aw 25,9
Aw 26,10
Aw 27,11
Aw 28,12
Aw 29,13
Aw 30,14
Aw 31,15
v_max3_f32 v21, v208, v209, v210
v_max3_f32 v21, v21, v211, v212
v_max3_f32 v21, v21, v213, v214
v_max3_f32 v21, v21, v215, v216
v_max3_f32 v21, v21, v217, v218
v_max3_f32 v21, v21, v219, v220
v_max3_f32 v21, v21, v221, v222
v_max_f32 v21, v21, v223
v_mov_b32 v1, v21
s_nop 1
v_permlane16_swap_b32 v1, v21
v_max_f32 v21, v21, v1
v_mov_b32 v1, v21
s_nop 1
v_permlane32_swap_b32 v1, v21
v_max_f32_e64 v21, v21, v1
v_add_f32 v21, 0x41f80000, v21
v_max_f32 v21, 0, v21
Vs 208,208,21
Vs 209,209,21
Vs 210,210,21
Vs 211,211,21
Vs 212,212,21
Vs 213,213,21
Vs 214,214,21
Vs 215,215,21
Vs 216,216,21
Vs 217,217,21
Vs 218,218,21
Vs 219,219,21
Vs 220,220,21
Vs 221,221,21
Vs 222,222,21
Vs 223,223,21
Vs 144,144,21
Vs 145,145,21
Vs 146,146,21
Vs 147,147,21
Vs 148,148,21
Vs 149,149,21
Vs 150,150,21
Vs 151,151,21
Vs 152,152,21
Vs 153,153,21
Vs 154,154,21
Vs 155,155,21
Vs 156,156,21
Vs 157,157,21
Vs 158,158,21
Vs 159,159,21
Vs 36,36,21
Vs 37,37,21
Vs 38,38,21
v_sub_f32_e64 v39, v39, v21
v_exp_f32 v22, -v21
s_nop 0
Vm 52,52,22
Vm 53,53,22
Vm 54,54,22
v_mul_f32_e64 v55, v55, v22
Ar 8,32
Ar 9,33
Ar 10,34
Ar 11,35
Ar 12,36
Ar 13,37
Ar 14,38
Ar 15,39
Vm 8,8,22
Vm 9,9,22
Vm 10,10,22
Vm 11,11,22
Vm 12,12,22
Vm 13,13,22
Vm 14,14,22
Vm 15,15,22
Aw 32,8
Aw 33,9
Aw 34,10
Aw 35,11
Aw 36,12
Aw 37,13
Aw 38,14
Aw 39,15
Ar 8,40
Ar 9,41
Ar 10,42
Ar 11,43
Ar 12,44
Ar 13,45
Ar 14,46
Ar 15,47
Vm 8,8,22
Vm 9,9,22
Vm 10,10,22
Vm 11,11,22
Vm 12,12,22
Vm 13,13,22
Vm 14,14,22
Vm 15,15,22
Aw 40,8
Aw 41,9
Aw 42,10
Aw 43,11
Aw 44,12
Aw 45,13
Aw 46,14
Aw 47,15
Ar 8,48
Ar 9,49
Ar 10,50
Ar 11,51
Ar 12,52
Ar 13,53
Ar 14,54
Ar 15,55
Vm 8,8,22
Vm 9,9,22
Vm 10,10,22
Vm 11,11,22
Vm 12,12,22
Vm 13,13,22
Vm 14,14,22
Vm 15,15,22
Aw 48,8
Aw 49,9
Aw 50,10
Aw 51,11
Aw 52,12
Aw 53,13
Aw 54,14
Aw 55,15
Ar 8,56
Ar 9,57
Ar 10,58
Ar 11,59
Ar 12,60
Ar 13,61
Ar 14,62
Ar 15,63
Vm 8,8,22
Vm 9,9,22
Vm 10,10,22
Vm 11,11,22
Vm 12,12,22
Vm 13,13,22
Vm 14,14,22
Vm 15,15,22
Aw 56,8
Aw 57,9
Aw 58,10
Aw 59,11
Aw 60,12
Aw 61,13
Aw 62,14
Aw 63,15
Ve 8,192
Ve 9,193
s_nop 0
Vc 96,8,9
Ve 8,194
Ve 9,195
s_nop 0
Vc 97,8,9
Ve 8,208
Ve 9,209
s_nop 0
Vc 104,8,9
Ve 8,210
Ve 9,211
s_nop 0
Vc 105,8,9
Ve 8,196
Ve 9,197
s_nop 0
Vc 98,8,9
Ve 8,198
Ve 9,199
s_nop 0
Vc 99,8,9
Ve 8,212
Ve 9,213
s_nop 0
Vc 106,8,9
Ve 8,214
Ve 9,215
s_nop 0
Vc 107,8,9
Ve 8,200
Ve 9,201
s_nop 0
Vc 100,8,9
Ve 8,202
Ve 9,203
s_nop 0
Vc 101,8,9
Ve 8,216
Ve 9,217
s_nop 0
Vc 108,8,9
Ve 8,218
Ve 9,219
s_nop 0
Vc 109,8,9
Ve 8,204
Ve 9,205
s_nop 0
Vc 102,8,9
Ve 8,206
Ve 9,207
s_nop 0
Vc 103,8,9
Ve 8,220
Ve 9,221
s_nop 0
Vc 110,8,9
Ve 8,222
Ve 9,223
s_nop 0
Vc 111,8,9
s_nop 1
s_branch L_k2_fbr_no
L_k2_fb_nl:
s_nop 7
s_nop 0
v_max3_f32 v21, v128, v129, v130
v_max3_f32 v21, v21, v131, v132
v_max3_f32 v21, v21, v133, v134
v_max3_f32 v21, v21, v135, v136
v_max3_f32 v21, v21, v137, v138
v_max3_f32 v21, v21, v139, v140
v_max3_f32 v21, v21, v141, v142
v_max_f32 v21, v21, v143
v_mov_b32 v1, v21
s_nop 1
v_permlane16_swap_b32 v1, v21
v_max_f32 v21, v21, v1
v_mov_b32 v1, v21
s_nop 1
v_permlane32_swap_b32 v1, v21
v_max_f32_e64 v21, v21, v1
v_add_f32 v21, 0x41f80000, v21
v_max_f32 v21, 0, v21
Vs 128,128,21
Vs 129,129,21
Vs 130,130,21
Vs 131,131,21
Vs 132,132,21
Vs 133,133,21
Vs 134,134,21
Vs 135,135,21
Vs 136,136,21
Vs 137,137,21
Vs 138,138,21
Vs 139,139,21
Vs 140,140,21
Vs 141,141,21
Vs 142,142,21
Vs 143,143,21
Vs 192,192,21
Vs 193,193,21
Vs 194,194,21
Vs 195,195,21
Vs 196,196,21
Vs 197,197,21
Vs 198,198,21
Vs 199,199,21
Vs 200,200,21
Vs 201,201,21
Vs 202,202,21
Vs 203,203,21
Vs 204,204,21
Vs 205,205,21
Vs 206,206,21
Vs 207,207,21
Vs 32,32,21
Vs 33,33,21
Vs 34,34,21
v_sub_f32_e64 v35, v35, v21
v_exp_f32 v22, -v21
s_nop 0
Vm 48,48,22
Vm 49,49,22
Vm 50,50,22
v_mul_f32_e64 v51, v51, v22
Ar 8,0
Ar 9,1
Ar 10,2
Ar 11,3
Ar 12,4
Ar 13,5
Ar 14,6
Ar 15,7
Vm 8,8,22
Vm 9,9,22
Vm 10,10,22
Vm 11,11,22
Vm 12,12,22
Vm 13,13,22
Vm 14,14,22
Vm 15,15,22
Aw 0,8
Aw 1,9
Aw 2,10
Aw 3,11
Aw 4,12
Aw 5,13
Aw 6,14
Aw 7,15
Ar 8,8
Ar 9,9
Ar 10,10
Ar 11,11
Ar 12,12
Ar 13,13
Ar 14,14
Ar 15,15
Vm 8,8,22
Vm 9,9,22
Vm 10,10,22
Vm 11,11,22
Vm 12,12,22
Vm 13,13,22
Vm 14,14,22
Vm 15,15,22
Aw 8,8
Aw 9,9
Aw 10,10
Aw 11,11
Aw 12,12
Aw 13,13
Aw 14,14
Aw 15,15
Ar 8,16
Ar 9,17
Ar 10,18
Ar 11,19
Ar 12,20
Ar 13,21
Ar 14,22
Ar 15,23
Vm 8,8,22
Vm 9,9,22
Vm 10,10,22
Vm 11,11,22
Vm 12,12,22
Vm 13,13,22
Vm 14,14,22
Vm 15,15,22
Aw 16,8
Aw 17,9
Aw 18,10
Aw 19,11
Aw 20,12
Aw 21,13
Aw 22,14
Aw 23,15
Ar 8,24
Ar 9,25
Ar 10,26
Ar 11,27
Ar 12,28
Ar 13,29
Ar 14,30
Ar 15,31
Vm 8,8,22
Vm 9,9,22
Vm 10,10,22
Vm 11,11,22
Vm 12,12,22
Vm 13,13,22
Vm 14,14,22
Vm 15,15,22
Aw 24,8
Aw 25,9
Aw 26,10
Aw 27,11
Aw 28,12
Aw 29,13
Aw 30,14
Aw 31,15
v_max3_f32 v21, v144, v145, v146
v_max3_f32 v21, v21, v147, v148
v_max3_f32 v21, v21, v149, v150
v_max3_f32 v21, v21, v151, v152
v_max3_f32 v21, v21, v153, v154
v_max3_f32 v21, v21, v155, v156
v_max3_f32 v21, v21, v157, v158
v_max_f32 v21, v21, v159
v_mov_b32 v1, v21
s_nop 1
v_permlane16_swap_b32 v1, v21
v_max_f32 v21, v21, v1
v_mov_b32 v1, v21
s_nop 1
v_permlane32_swap_b32 v1, v21
v_max_f32_e64 v21, v21, v1
v_add_f32 v21, 0x41f80000, v21
v_max_f32 v21, 0, v21
Vs 144,144,21
Vs 145,145,21
Vs 146,146,21
Vs 147,147,21
Vs 148,148,21
Vs 149,149,21
Vs 150,150,21
Vs 151,151,21
Vs 152,152,21
Vs 153,153,21
Vs 154,154,21
Vs 155,155,21
Vs 156,156,21
Vs 157,157,21
Vs 158,158,21
Vs 159,159,21
Vs 36,36,21
Vs 37,37,21
Vs 38,38,21
v_sub_f32_e64 v39, v39, v21
v_exp_f32 v22, -v21
s_nop 0
Vm 52,52,22
Vm 53,53,22
Vm 54,54,22
v_mul_f32_e64 v55, v55, v22
Ar 8,32
Ar 9,33
Ar 10,34
Ar 11,35
Ar 12,36
Ar 13,37
Ar 14,38
Ar 15,39
Vm 8,8,22
Vm 9,9,22
Vm 10,10,22
Vm 11,11,22
Vm 12,12,22
Vm 13,13,22
Vm 14,14,22
Vm 15,15,22
Aw 32,8
Aw 33,9
Aw 34,10
Aw 35,11
Aw 36,12
Aw 37,13
Aw 38,14
Aw 39,15
Ar 8,40
Ar 9,41
Ar 10,42
Ar 11,43
Ar 12,44
Ar 13,45
Ar 14,46
Ar 15,47
Vm 8,8,22
Vm 9,9,22
Vm 10,10,22
Vm 11,11,22
Vm 12,12,22
Vm 13,13,22
Vm 14,14,22
Vm 15,15,22
Aw 40,8
Aw 41,9
Aw 42,10
Aw 43,11
Aw 44,12
Aw 45,13
Aw 46,14
Aw 47,15
Ar 8,48
Ar 9,49
Ar 10,50
Ar 11,51
Ar 12,52
Ar 13,53
Ar 14,54
Ar 15,55
Vm 8,8,22
Vm 9,9,22
Vm 10,10,22
Vm 11,11,22
Vm 12,12,22
Vm 13,13,22
Vm 14,14,22
Vm 15,15,22
Aw 48,8
Aw 49,9
Aw 50,10
Aw 51,11
Aw 52,12
Aw 53,13
Aw 54,14
Aw 55,15
Ar 8,56
Ar 9,57
Ar 10,58
Ar 11,59
Ar 12,60
Ar 13,61
Ar 14,62
Ar 15,63
Vm 8,8,22
Vm 9,9,22
Vm 10,10,22
Vm 11,11,22
Vm 12,12,22
Vm 13,13,22
Vm 14,14,22
Vm 15,15,22
Aw 56,8
Aw 57,9
Aw 58,10
Aw 59,11
Aw 60,12
Aw 61,13
Aw 62,14
Aw 63,15
Ve 8,128
Ve 9,129
s_nop 0
Vc 64,8,9
Ve 8,130
Ve 9,131
s_nop 0
Vc 65,8,9
Ve 8,144
Ve 9,145
s_nop 0
Vc 72,8,9
Ve 8,146
Ve 9,147
s_nop 0
Vc 73,8,9
Ve 8,132
Ve 9,133
s_nop 0
Vc 66,8,9
Ve 8,134
Ve 9,135
s_nop 0
Vc 67,8,9
Ve 8,148
Ve 9,149
s_nop 0
Vc 74,8,9
Ve 8,150
Ve 9,151
s_nop 0
Vc 75,8,9
Ve 8,136
Ve 9,137
s_nop 0
Vc 68,8,9
Ve 8,138
Ve 9,139
s_nop 0
Vc 69,8,9
Ve 8,152
Ve 9,153
s_nop 0
Vc 76,8,9
Ve 8,154
Ve 9,155
s_nop 0
Vc 77,8,9
Ve 8,140
Ve 9,141
s_nop 0
Vc 70,8,9
Ve 8,142
Ve 9,143
s_nop 0
Vc 71,8,9
Ve 8,156
Ve 9,157
s_nop 0
Vc 78,8,9
Ve 8,158
Ve 9,159
s_nop 0
Vc 79,8,9
s_nop 1
s_branch L_k2_fbr_nl
L_k2_fb_fi:
s_nop 7
s_nop 0
v_max3_f32 v21, v192, v193, v194
v_max3_f32 v21, v21, v195, v196
v_max3_f32 v21, v21, v197, v198
v_max3_f32 v21, v21, v199, v200
v_max3_f32 v21, v21, v201, v202
v_max3_f32 v21, v21, v203, v204
v_max3_f32 v21, v21, v205, v206
v_max_f32 v21, v21, v207
v_mov_b32 v1, v21
s_nop 1
v_permlane16_swap_b32 v1, v21
v_max_f32 v21, v21, v1
v_mov_b32 v1, v21
s_nop 1
v_permlane32_swap_b32 v1, v21
v_max_f32_e64 v21, v21, v1
v_add_f32 v21, 0x41f80000, v21
v_max_f32 v21, 0, v21
Vs 192,192,21
Vs 193,193,21
Vs 194,194,21
Vs 195,195,21
Vs 196,196,21
Vs 197,197,21
Vs 198,198,21
Vs 199,199,21
Vs 200,200,21
Vs 201,201,21
Vs 202,202,21
Vs 203,203,21
Vs 204,204,21
Vs 205,205,21
Vs 206,206,21
Vs 207,207,21
Vs 32,32,21
Vs 33,33,21
Vs 34,34,21
v_sub_f32_e64 v35, v35, v21
v_exp_f32 v22, -v21
s_nop 0
Vm 48,48,22
Vm 49,49,22
Vm 50,50,22
v_mul_f32_e64 v51, v51, v22
Ar 8,0
Ar 9,1
Ar 10,2
Ar 11,3
Ar 12,4
Ar 13,5
Ar 14,6
Ar 15,7
Vm 8,8,22
Vm 9,9,22
Vm 10,10,22
Vm 11,11,22
Vm 12,12,22
Vm 13,13,22
Vm 14,14,22
Vm 15,15,22
Aw 0,8
Aw 1,9
Aw 2,10
Aw 3,11
Aw 4,12
Aw 5,13
Aw 6,14
Aw 7,15
Ar 8,8
Ar 9,9
Ar 10,10
Ar 11,11
Ar 12,12
Ar 13,13
Ar 14,14
Ar 15,15
Vm 8,8,22
Vm 9,9,22
Vm 10,10,22
Vm 11,11,22
Vm 12,12,22
Vm 13,13,22
Vm 14,14,22
Vm 15,15,22
Aw 8,8
Aw 9,9
Aw 10,10
Aw 11,11
Aw 12,12
Aw 13,13
Aw 14,14
Aw 15,15
Ar 8,16
Ar 9,17
Ar 10,18
Ar 11,19
Ar 12,20
Ar 13,21
Ar 14,22
Ar 15,23
Vm 8,8,22
Vm 9,9,22
Vm 10,10,22
Vm 11,11,22
Vm 12,12,22
Vm 13,13,22
Vm 14,14,22
Vm 15,15,22
Aw 16,8
Aw 17,9
Aw 18,10
Aw 19,11
Aw 20,12
Aw 21,13
Aw 22,14
Aw 23,15
Ar 8,24
Ar 9,25
Ar 10,26
Ar 11,27
Ar 12,28
Ar 13,29
Ar 14,30
Ar 15,31
Vm 8,8,22
Vm 9,9,22
Vm 10,10,22
Vm 11,11,22
Vm 12,12,22
Vm 13,13,22
Vm 14,14,22
Vm 15,15,22
Aw 24,8
Aw 25,9
Aw 26,10
Aw 27,11
Aw 28,12
Aw 29,13
Aw 30,14
Aw 31,15
Ve 8,192
Ve 9,193
s_nop 0
Vc 96,8,9
Ve 8,194
Ve 9,195
s_nop 0
Vc 97,8,9
Ve 8,196
Ve 9,197
s_nop 0
Vc 98,8,9
Ve 8,198
Ve 9,199
s_nop 0
Vc 99,8,9
Ve 8,200
Ve 9,201
s_nop 0
Vc 100,8,9
Ve 8,202
Ve 9,203
s_nop 0
Vc 101,8,9
Ve 8,204
Ve 9,205
s_nop 0
Vc 102,8,9
Ve 8,206
Ve 9,207
s_nop 0
Vc 103,8,9
s_nop 1
s_branch L_k2_fbr_fi
L_spinX:
s_mov_b32 s47, 0x400000
L_spinXl:
buffer_load_dword v17, v126, s[20:23], s24 offen sc1
s_sub_u32 s47, s47, 1
s_waitcnt vmcnt(0)
s_cmp_eq_u32 s47, 0
s_cbranch_scc1 L_spinXlx
v_cmp_ne_u32 vcc, 1, v17
s_cbranch_vccz L_spinXlx
s_sleep 1
s_branch L_spinXl
L_spinXlx:
buffer_load_dwordx4 v[160:163], v112, s[16:19], s25 offen offset:0 sc1
buffer_load_dwordx4 v[164:167], v112, s[16:19], s25 offen offset:1024 sc1
buffer_load_dwordx4 v[168:171], v112, s[16:19], s25 offen offset:2048 sc1
buffer_load_dwordx4 v[172:175], v112, s[16:19], s25 offen offset:3072 sc1
buffer_load_dwordx4 v[176:179], v10, s[16:19], s25 offen offset:0 sc1
buffer_load_dwordx4 v[180:183], v10, s[16:19], s25 offen offset:1024 sc1
buffer_load_dwordx4 v[184:187], v10, s[16:19], s25 offen offset:2048 sc1
buffer_load_dwordx4 v[188:191], v10, s[16:19], s25 offen offset:3072 sc1
s_branch L_spinXr
L_ysl:
s_mov_b32 s47, 0x400000
L_ysll:
buffer_load_dword v124, v127, s[20:23], s41 offen sc1
s_sub_u32 s47, s47, 1
s_waitcnt vmcnt(0)
s_cmp_eq_u32 s47, 0
s_cbranch_scc1 L_ysllx
v_cmp_ne_u32 vcc, 1, v124
s_cbranch_vccz L_ysllx
s_sleep 8
s_branch L_ysll
L_ysllx:
v_lshlrev_b32 v124, 2, v0
v_lshlrev_b32 v125, 1, v0
s_lshl_b32 s7, s45, 2
s_add_u32 s7, s7, s32
s_lshr_b32 s3, s42, 5
s_cmp_lg_u32 s3, s7
s_cbranch_scc1 L_f_yl13
s_add_u32 s3, s55, 0
s_nop 0
s_add_u32 s7, s3, 4096
buffer_load_dword v76, v124, s[20:23], s3 offen offset:0 sc1
buffer_load_dword v77, v124, s[20:23], s3 offen offset:512 sc1
buffer_load_dword v78, v124, s[20:23], s3 offen offset:1024 sc1
buffer_load_dword v79, v124, s[20:23], s3 offen offset:1536 sc1
buffer_load_dword v80, v124, s[20:23], s3 offen offset:2048 sc1
buffer_load_dword v81, v124, s[20:23], s3 offen offset:2560 sc1
buffer_load_dword v82, v124, s[20:23], s3 offen offset:3072 sc1
buffer_load_dword v83, v124, s[20:23], s3 offen offset:3584 sc1
buffer_load_dword v84, v124, s[20:23], s7 offen offset:0 sc1
buffer_load_dword v85, v124, s[20:23], s7 offen offset:512 sc1
buffer_load_dword v86, v124, s[20:23], s7 offen offset:1024 sc1
buffer_load_dword v87, v124, s[20:23], s7 offen offset:1536 sc1
buffer_load_dword v88, v124, s[20:23], s7 offen offset:2048 sc1
buffer_load_dword v89, v124, s[20:23], s7 offen offset:2560 sc1
s_lshl_b32 s3, s42, 11
s_lshl_b32 s7, s46, 7
s_add_u32 s3, s3, s7
buffer_load_ushort v90, v125, s[56:59], s3 offen
s_lshl_b32 s3, s42, 3
s_add_u32 s3, s3, 5259264
buffer_load_dwordx2 v[92:93], v126, s[20:23], s3 offen sc1
L_f_yl13:
s_lshl_b32 s7, s45, 2
s_add_u32 s7, s7, s32
s_lshr_b32 s3, s43, 5
s_cmp_lg_u32 s3, s7
s_cbranch_scc1 L_f_yl14
s_nop 0
s_add_u32 s3, s55, 256
s_add_u32 s7, s3, 4096
buffer_load_dword v94, v124, s[20:23], s3 offen offset:0 sc1
buffer_load_dword v95, v124, s[20:23], s3 offen offset:512 sc1
buffer_load_dword v96, v124, s[20:23], s3 offen offset:1024 sc1
buffer_load_dword v97, v124, s[20:23], s3 offen offset:1536 sc1
buffer_load_dword v98, v124, s[20:23], s3 offen offset:2048 sc1
buffer_load_dword v99, v124, s[20:23], s3 offen offset:2560 sc1
buffer_load_dword v100, v124, s[20:23], s3 offen offset:3072 sc1
buffer_load_dword v101, v124, s[20:23], s3 offen offset:3584 sc1
buffer_load_dword v102, v124, s[20:23], s7 offen offset:0 sc1
buffer_load_dword v103, v124, s[20:23], s7 offen offset:512 sc1
buffer_load_dword v104, v124, s[20:23], s7 offen offset:1024 sc1
buffer_load_dword v105, v124, s[20:23], s7 offen offset:1536 sc1
buffer_load_dword v106, v124, s[20:23], s7 offen offset:2048 sc1
buffer_load_dword v107, v124, s[20:23], s7 offen offset:2560 sc1
s_lshl_b32 s3, s43, 11
s_lshl_b32 s7, s46, 7
s_add_u32 s3, s3, s7
buffer_load_ushort v108, v125, s[56:59], s3 offen
s_lshl_b32 s3, s43, 3
s_add_u32 s3, s3, 5259264
buffer_load_dwordx2 v[110:111], v126, s[20:23], s3 offen sc1
L_f_yl14:
s_waitcnt vmcnt(0)
s_lshl_b32 s7, s45, 2
s_add_u32 s7, s7, s32
s_lshr_b32 s3, s42, 5
s_cmp_lg_u32 s3, s7
s_cbranch_scc1 L_f_ys15
v_pk_add_f32 v[76:77], v[76:77], v[78:79]
v_pk_add_f32 v[76:77], v[76:77], v[80:81]
v_pk_add_f32 v[76:77], v[76:77], v[82:83]
v_pk_add_f32 v[76:77], v[76:77], v[84:85]
v_pk_add_f32 v[76:77], v[76:77], v[86:87]
v_pk_add_f32 v[76:77], v[76:77], v[88:89]
Va 76,76,77
v_lshlrev_b32 v90, 16, v90
v_sub_f32_e64 v90, v90, v92
Vc 76,76,76
v_lshlrev_b32_e64 v76, 16, v76
Vc 90,90,90
v_lshlrev_b32 v90, 16, v90
v_mul_f32 v76, s100, v76
v_mul_f32_e64 v90, v90, v93
Vc 76,76,76
v_lshlrev_b32_e64 v76, 16, v76
Vc 90,90,90
v_lshlrev_b32 v90, 16, v90
Va 90,90,76
Vc 90,90,90
v_lshlrev_b32_e64 v90, 16, v90
v_mul_f32 v76, 0xbfb8aa3b, v90
Ve 76,76
s_nop 0
v_add_f32 v76, 1.0, v76
v_rcp_f32 v76, v76
s_nop 0
Vm 90,90,76
Vc 90,90,90
v_lshlrev_b32 v90, 16, v90
v_lshlrev_b32 v124, 2, v0
v_add_u32 v124, s35, v124
v_lshlrev_b32 v125, 5, v122
v_add_u32 v125, s35, v125
s_waitcnt lgkmcnt(0)
ds_write_b32 v124, v90
s_and_b32 s3, s42, 7
s_lshl_b32 s3, s3, 3
s_lshl_b64 s[4:5], 0xff, s3
s_bfe_u32 s3, s42, 0x20003
s_mov_b64 exec, s[4:5]
s_cmp_lg_u32 s3, 0
s_cbranch_scc1 L_f_yp16
ds_read_b64 v[42:43], v125
ds_read_b64 v[44:45], v125 offset:8
ds_read_b64 v[46:47], v125 offset:16
ds_read_b64 v[48:49], v125 offset:24
L_f_yp16:
s_cmp_lg_u32 s3, 1
s_cbranch_scc1 L_f_yp17
ds_read_b64 v[50:51], v125
ds_read_b64 v[52:53], v125 offset:8
ds_read_b64 v[54:55], v125 offset:16
ds_read_b64 v[56:57], v125 offset:24
L_f_yp17:
s_cmp_lg_u32 s3, 2
s_cbranch_scc1 L_f_yp18
ds_read_b64 v[58:59], v125
ds_read_b64 v[60:61], v125 offset:8
ds_read_b64 v[62:63], v125 offset:16
ds_read_b64 v[64:65], v125 offset:24
L_f_yp18:
s_cmp_lg_u32 s3, 3
s_cbranch_scc1 L_f_yp19
ds_read_b64 v[66:67], v125
ds_read_b64 v[68:69], v125 offset:8
s_waitcnt lgkmcnt(9)
ds_read_b64 v[70:71], v125 offset:16
ds_read_b64 v[72:73], v125 offset:24
L_f_yp19:
s_mov_b64 exec, -1
s_waitcnt lgkmcnt(0)
L_f_ys15:
s_lshl_b32 s7, s45, 2
s_add_u32 s7, s7, s32
s_lshr_b32 s3, s43, 5
s_cmp_lg_u32 s3, s7
s_cbranch_scc1 L_f_ys20
s_nop 0
v_pk_add_f32 v[94:95], v[94:95], v[96:97]
v_pk_add_f32 v[94:95], v[94:95], v[98:99]
v_pk_add_f32 v[94:95], v[94:95], v[100:101]
v_pk_add_f32 v[94:95], v[94:95], v[102:103]
v_pk_add_f32 v[94:95], v[94:95], v[104:105]
v_pk_add_f32 v[94:95], v[94:95], v[106:107]
Va 94,94,95
v_lshlrev_b32 v108, 16, v108
v_sub_f32_e64 v108, v108, v110
Vc 94,94,94
v_lshlrev_b32_e64 v94, 16, v94
Vc 108,108,108
v_lshlrev_b32 v108, 16, v108
v_mul_f32 v94, s101, v94
v_mul_f32_e64 v108, v108, v111
Vc 94,94,94
v_lshlrev_b32_e64 v94, 16, v94
Vc 108,108,108
v_lshlrev_b32 v108, 16, v108
Va 108,108,94
Vc 108,108,108
v_lshlrev_b32_e64 v108, 16, v108
v_mul_f32 v94, 0xbfb8aa3b, v108
Ve 94,94
s_nop 0
v_add_f32 v94, 1.0, v94
v_rcp_f32 v94, v94
s_nop 0
Vm 108,108,94
Vc 108,108,108
v_lshlrev_b32 v108, 16, v108
v_lshlrev_b32 v124, 2, v0
v_add_u32 v124, s35, v124
v_lshlrev_b32 v125, 5, v122
v_add_u32 v125, s35, v125
s_waitcnt lgkmcnt(0)
ds_write_b32 v124, v108
s_and_b32 s3, s43, 7
s_lshl_b32 s3, s3, 3
s_lshl_b64 s[4:5], 0xff, s3
s_bfe_u32 s3, s43, 0x20003
s_mov_b64 exec, s[4:5]
s_cmp_lg_u32 s3, 0
s_cbranch_scc1 L_f_yp21
ds_read_b64 v[42:43], v125
ds_read_b64 v[44:45], v125 offset:8
ds_read_b64 v[46:47], v125 offset:16
ds_read_b64 v[48:49], v125 offset:24
L_f_yp21:
s_cmp_lg_u32 s3, 1
s_cbranch_scc1 L_f_yp22
ds_read_b64 v[50:51], v125
ds_read_b64 v[52:53], v125 offset:8
ds_read_b64 v[54:55], v125 offset:16
ds_read_b64 v[56:57], v125 offset:24
L_f_yp22:
s_cmp_lg_u32 s3, 2
s_cbranch_scc1 L_f_yp23
ds_read_b64 v[58:59], v125
ds_read_b64 v[60:61], v125 offset:8
ds_read_b64 v[62:63], v125 offset:16
ds_read_b64 v[64:65], v125 offset:24
L_f_yp23:
s_cmp_lg_u32 s3, 3
s_cbranch_scc1 L_f_yp24
ds_read_b64 v[66:67], v125
ds_read_b64 v[68:69], v125 offset:8
s_waitcnt lgkmcnt(9)
ds_read_b64 v[70:71], v125 offset:16
ds_read_b64 v[72:73], v125 offset:24
L_f_yp24:
s_mov_b64 exec, -1
s_waitcnt lgkmcnt(0)
L_f_ys20:
s_branch L_yslr
.section .rodata,"a"
.p2align 6
.amdhsa_kernel recurrent_scan__compressed_kv_cla__moe_arch_mod__prompt_kernel
  .amdhsa_next_free_vgpr 512
  .amdhsa_next_free_sgpr 102
  .amdhsa_accum_offset 256
  .amdhsa_group_segment_fixed_size 0
  .amdhsa_kernarg_size 112
  .amdhsa_user_sgpr_count 2
  .amdhsa_user_sgpr_kernarg_segment_ptr 1
  .amdhsa_system_sgpr_workgroup_id_x 1
.end_amdhsa_kernel
```
